```python
import torch

def _softmax(x, axis=-1):
    return torch.softmax(x, dim=axis)
def _gelu(x):
    return torch.nn.functional.gelu(x, approximate="tanh")
def _silu(x):
    return torch.nn.functional.silu(x)
def _sigmoid(x):
    return torch.sigmoid(x)
def _layernorm(x, axis=-1, eps=1e-5):
    m = x.mean(dim=axis, keepdim=True)
    v = x.var(dim=axis, keepdim=True, unbiased=False)
    return (x - m) / torch.sqrt(v + eps)
def _scatter_add(tgt, idx, src, axis=0):
    return tgt.clone().index_add_(axis, idx, src)
def _segment_sum(src, seg, n):
    out = torch.zeros((n,) + src.shape[1:], dtype=src.dtype)
    return out.index_add_(0, seg, src)
def _pad(x, pw):
    flat = tuple(v for pair in reversed(pw) for v in pair)
    return torch.nn.functional.pad(x, flat)

kernel_name = 'standalone__gqa_softmax__near_ridge'

def setup_inputs():

    _w = (lambda a: (lambda t: t.to(torch.bfloat16) if t.is_floating_point() else t)(torch.as_tensor(a)))
    B, Hq, Hkv, Sq, Sk, D = 16, 32, 32, 848, 512, 192
    return {
        "q": _w((lambda *s: torch.randn(*s, dtype=torch.bfloat16) * 0.8)(B, Hq, Sq, D)),
        "k": _w((lambda *s: torch.randn(*s, dtype=torch.bfloat16) * 0.8)(B, Hkv, Sk, D)),
        "v": _w((lambda *s: torch.randn(*s, dtype=torch.bfloat16) * 0.05)(B, Hkv, Sk, D)),
    }

def reference(q, k, v):
    B, Hq, Sq, D = q.shape
    Hkv = k.shape[1]
    rep = Hq // Hkv
    k = (lambda x, n, axis: torch.repeat_interleave(x, n, dim=axis))(k, rep, axis=1)
    v = (lambda x, n, axis: torch.repeat_interleave(x, n, dim=axis))(v, rep, axis=1)
    scale = D ** -0.5
    scores = torch.einsum("bhqd,bhkd->bhqk", q, k) * scale
    p = _softmax(scores, axis=-1)
    return torch.einsum("bhqk,bhkd->bhqd", p, v)
```

```asm
; @launch grid=(256,1,1) block=(256,1,1) lds=163840
.amdgcn_target "amdgcn-amd-amdhsa--gfx950"
.text
.globl standalone__gqa_softmax__near_ridge_kernel
.p2align 8
.type standalone__gqa_softmax__near_ridge_kernel,@function
standalone__gqa_softmax__near_ridge_kernel:
    s_cmp_ge_u32 s2, 256
    s_cbranch_scc1 L_end
    s_load_dwordx4 s[84:87], s[0:1], 0
    s_load_dwordx4 s[88:91], s[0:1], 16
    v_lshrrev_b32 v30, 6, v0
    v_and_b32 v0, 63, v0
    v_readfirstlane_b32 s3, v30
    s_getpc_b64 s[92:93]
L_pc:
    s_lshr_b32 s62, s2, 3
    s_mul_i32 s62, s62, 3072
    v_min_u32 v144, 23, v0
    v_lshlrev_b32 v144, 7, v144
    v_add_u32 v144, s62, v144
    v_min_u32 v144, L_codeend-L_pc-4, v144
    s_cmp_lg_u32 s3, 0
    s_cbranch_scc1 L_nopre
    global_load_dword v31, v144, s[92:93]
L_nopre:
    v_lshrrev_b32 v144, 3, v0
    v_mul_u32_u24 v7, 384, v144
    v_lshrrev_b32 v145, 1, v144
    v_lshlrev_b32 v145, 1, v145
    v_and_b32 v146, 7, v0
    v_xor_b32 v145, v145, v146
    s_and_b32 s62, s3, 1
    s_mul_i32 s62, s62, 5
    v_xor_b32 v145, s62, v145
    v_lshl_add_u32 v7, v145, 4, v7
    v_add_u32 v7, 2048, v7
    v_subrev_u32 v8, 896, v7
    v_subrev_u32 v9, 1792, v7
    v_mov_b32 v10, v7
    v_mov_b32 v11, v8
    v_mov_b32 v12, v9
    s_mov_b32 s36, 0x3dd53b95
    s_mov_b32 s37, 0x45800000
    s_and_b32 s62, s2, 7
    s_lshr_b32 s63, s2, 3
    s_and_b32 s49, s63, 3
    s_lshr_b32 s63, s63, 2
    s_mov_b32 s43, s63
    s_lshl_b32 s62, s62, 3
    s_add_u32 s62, s62, s63
    s_lshl_b32 s64, s62, 3
    s_waitcnt lgkmcnt(0)
    s_mul_i32 s65, s64, 196608
    s_sub_u32 s12, s84, 2048
    s_subb_u32 s13, s85, 0
    s_and_b32 s13, s13, 0xffff
    s_mov_b32 s15, 0x20000
    s_sub_u32 s4, s86, 2048
    s_subb_u32 s5, s87, 0
    s_and_b32 s5, s5, 0xffff
    s_mov_b32 s7, 0x20000
    s_sub_u32 s8, s88, 2048
    s_subb_u32 s9, s89, 0
    s_and_b32 s9, s9, 0xffff
    s_mov_b32 s11, 0x20000
    s_mov_b32 s14, 166725632
    s_add_u32 s6, s65, 1574912
    s_mov_b32 s10, s6
    s_mov_b32 s16, s90
    s_and_b32 s17, s91, 0xffff
    s_mov_b32 s18, 166723584
    s_mov_b32 s19, 0x20000
    s_mov_b32 s20, s4
    s_mov_b32 s24, s8
    s_mov_b32 s21, s5
    s_mov_b32 s25, s9
    s_mov_b32 s22, s6
    s_mov_b32 s26, s10
    s_mov_b32 s23, s7
    s_mov_b32 s27, s11
    s_mul_i32 s31, s3, 3072
    s_add_u32 s32, s31, 12288
    s_mul_i32 s35, s3, 6144
    s_add_u32 s28, s65, s31
    s_mov_b32 s29, s28
    s_mov_b32 s30, 12288
    s_mul_i32 s48, s64, 325632
    s_mov_b32 s69, 0
    s_mov_b32 s62, 0x39c3c374
    s_mov_b32 s63, 0x74d1b2d4
    s_lshl_b32 s64, s43, 3
    s_lshr_b64 s[62:63], s[62:63], s64
    s_and_b32 s39, s62, 0xff
    s_mov_b32 s62, 0xacaaaad2
    s_mov_b32 s63, 0xd2b4d4b2
    s_lshr_b64 s[62:63], s[62:63], s64
    s_and_b32 s62, s62, 0xff
    s_lshl_b32 s62, s62, 8
    s_or_b32 s39, s39, s62
    s_lshr_b32 s62, s39, s69
    s_and_b32 s62, s62, 1
    s_lshl_b32 s62, s62, 1
    s_add_u32 s62, s62, s49
    s_and_b32 s62, s62, 3
    s_add_u32 s63, s69, 8
    s_lshr_b32 s63, s39, s63
    s_and_b32 s63, s63, 1
    s_xor_b32 s62, s62, s63
    s_mul_i32 s63, s3, 3
    s_lshl_b32 s64, s3, 2
    s_mov_b32 s40, 1
    s_add_u32 s65, s63, 17
    s_cmp_eq_u32 s3, 0
    s_cselect_b32 s65, 16, s65
    s_cselect_b32 s42, 1, 0
    s_cmp_eq_u32 s62, 1
    s_cselect_b32 s64, s65, s64
    s_cselect_b32 s40, s42, s40
    s_add_u32 s65, s63, 29
    s_cmp_eq_u32 s62, 2
    s_cselect_b32 s64, s65, s64
    s_cselect_b32 s40, 0, s40
    s_add_u32 s65, s63, 41
    s_cmp_eq_u32 s62, 3
    s_cselect_b32 s64, s65, s64
    s_cselect_b32 s40, 0, s40
    s_mul_i32 s64, s64, 6144
    s_add_u32 s42, s48, s64
    s_cmp_eq_u32 s40, 0
    s_cbranch_scc1 L_start3
L_start4:
    v_xor_b32 v156, 80, v7
    v_xor_b32 v157, 80, v8
    v_xor_b32 v158, 80, v9
    s_add_u32 m0, s31, 98304
    s_nop 0
    buffer_load_dwordx4 v7, s[4:7], s28 offen offset:0 lds
    buffer_load_dwordx4 v8, s[4:7], s28 offen offset:1024 lds
    buffer_load_dwordx4 v9, s[4:7], s28 offen offset:2048 lds
    s_add_u32 s28, s28, 12288
    s_mov_b32 s41, s42
    s_mov_b32 s65, 24576
    s_and_b32 s63, s3, 1
    s_mul_i32 s63, s63, 3072
    s_add_u32 s67, s41, 0
    s_add_u32 s68, s67, s63
    s_add_u32 s64, s65, s35
    s_add_u32 s64, s64, 0
    s_add_u32 m0, s64, s63
    s_nop 0
    buffer_load_dwordx4 v7, s[12:15], s68 offen offset:0 nt lds
    buffer_load_dwordx4 v8, s[12:15], s68 offen offset:1024 nt lds
    buffer_load_dwordx4 v9, s[12:15], s68 offen offset:2048 nt lds
    s_sub_u32 s63, 3072, s63
    s_add_u32 s68, s67, s63
    s_add_u32 m0, s64, s63
    s_nop 0
    buffer_load_dwordx4 v156, s[12:15], s68 offen offset:0 nt lds
    buffer_load_dwordx4 v157, s[12:15], s68 offen offset:1024 nt lds
    buffer_load_dwordx4 v158, s[12:15], s68 offen offset:2048 nt lds
    s_mov_b32 s65, 49152
    s_and_b32 s63, s3, 1
    s_mul_i32 s63, s63, 3072
    s_add_u32 s67, s41, 6144
    s_add_u32 s68, s67, s63
    s_add_u32 s64, s65, s35
    s_add_u32 s64, s64, 0
    s_add_u32 m0, s64, s63
    s_nop 0
    buffer_load_dwordx4 v7, s[12:15], s68 offen offset:0 nt lds
    buffer_load_dwordx4 v8, s[12:15], s68 offen offset:1024 nt lds
    buffer_load_dwordx4 v9, s[12:15], s68 offen offset:2048 nt lds
    s_sub_u32 s63, 3072, s63
    s_add_u32 s68, s67, s63
    s_add_u32 m0, s64, s63
    s_nop 0
    buffer_load_dwordx4 v156, s[12:15], s68 offen offset:0 nt lds
    buffer_load_dwordx4 v157, s[12:15], s68 offen offset:1024 nt lds
    buffer_load_dwordx4 v158, s[12:15], s68 offen offset:2048 nt lds
    v_and_b32 v144, 15, v0
    v_lshrrev_b32 v145, 4, v0
    v_lshrrev_b32 v146, 3, v144
    v_mul_u32_u24 v1, 3072, v146
    v_and_b32 v147, 7, v144
    v_lshl_add_u32 v1, v147, 7, v1
    v_bfe_u32 v147, v144, 1, 2
    v_lshlrev_b32 v147, 1, v147
    v_mul_u32_u24 v148, 5, v146
    v_xor_b32 v147, v147, v148
    v_xor_b32 v147, v147, v145
    v_lshl_add_u32 v1, v147, 4, v1
    v_lshrrev_b32 v146, 1, v145
    v_mul_u32_u24 v3, 3072, v146
    v_and_b32 v147, 1, v145
    v_bfe_u32 v148, v0, 2, 2
    v_lshl_add_u32 v144, v147, 2, v148
    v_lshl_add_u32 v3, v144, 7, v3
    v_lshrrev_b32 v144, 1, v144
    v_lshlrev_b32 v144, 1, v144
    v_mul_u32_u24 v146, 5, v146
    v_xor_b32 v144, v144, v146
    v_bfe_u32 v147, v0, 1, 1
    v_xor_b32 v144, v144, v147
    v_lshl_add_u32 v3, v144, 4, v3
    v_and_b32 v147, 1, v0
    v_lshl_add_u32 v3, v147, 3, v3
    v_add_u32 v3, 12288, v3
    v_lshrrev_b32 v144, 3, v0
    v_and_b32 v145, 15, v0
    v_lshrrev_b32 v146, 4, v0
    v_lshrrev_b32 v147, 1, v146
    v_and_b32 v148, 7, v145
    v_xor_b32 v147, v147, v148
    v_lshlrev_b32 v15, 7, v145
    v_lshl_add_u32 v15, v147, 4, v15
    v_and_b32 v146, 1, v146
    v_lshl_add_u32 v15, v146, 3, v15
    s_lshl_b32 s63, s3, 12
    s_add_u32 s63, s63, 147456
    v_add_u32 v15, s63, v15
    v_and_b32 v145, 7, v0
    v_xor_b32 v146, v145, v144
    v_lshlrev_b32 v14, 7, v144
    v_lshl_add_u32 v14, v146, 4, v14
    v_add_u32 v14, s63, v14
    v_mul_u32_u24 v13, 384, v144
    v_lshl_add_u32 v13, v145, 4, v13
    v_mov_b32 v24, 0x3f803f80
    v_mov_b32 v25, 0x3f803f80
    v_mov_b32 v26, 0x3f803f80
    v_mov_b32 v27, 0x3f803f80
    v_xor_b32 v2, 64, v1
    v_xor_b32 v4, 32, v3
    v_xor_b32 v5, 64, v3
    v_xor_b32 v6, 96, v3
    v_add_u32 v28, s35, v1
    v_add_u32 v29, s35, v2
    v_add_u32 v144, s35, v1
    v_add_u32 v144, 49152, v144
    v_add_u32 v145, s35, v2
    v_add_u32 v145, 49152, v145
    v_add_u32 v146, s35, v1
    v_add_u32 v146, 98304, v146
    v_add_u32 v147, s35, v2
    v_add_u32 v147, 98304, v147
    v_add_u32 v1, 98304, v1
    v_add_u32 v2, 98304, v2
    s_mov_b32 s34, 98304
    s_mov_b32 s33, 0
    s_waitcnt vmcnt(12)
    s_barrier
    ds_read_b128 a[192:195], v1 offset:0
    ds_read_b128 a[196:199], v2 offset:0
    ds_read_b128 a[200:203], v1 offset:1024
    ds_read_b128 a[204:207], v2 offset:1024
    ds_read_b128 a[208:211], v1 offset:2048
    ds_read_b128 a[212:215], v2 offset:2048
    ds_read_b128 a[216:219], v1 offset:6144
    ds_read_b128 a[220:223], v2 offset:6144
    ds_read_b128 a[224:227], v1 offset:7168
    ds_read_b128 a[228:231], v2 offset:7168
    ds_read_b128 a[232:235], v1 offset:8192
    ds_read_b128 a[236:239], v2 offset:8192
    s_waitcnt vmcnt(6)
    ds_read_b128 a[96:99], v28 offset:24576
    s_mov_b32 s65, 73728
    s_and_b32 s63, s3, 1
    s_mul_i32 s63, s63, 3072
    s_add_u32 s67, s41, 12288
    s_add_u32 s68, s67, s63
    s_add_u32 s64, s65, s35
    s_add_u32 s64, s64, 0
    s_add_u32 m0, s64, s63
    ds_read_b128 a[100:103], v29 offset:24576
    ds_read_b128 a[104:107], v28 offset:25600
    ds_read_b128 a[108:111], v29 offset:25600
    ds_read_b128 a[112:115], v28 offset:26624
    ds_read_b128 a[116:119], v29 offset:26624
    s_waitcnt lgkmcnt(5)
    v_mfma_f32_16x16x32_bf16 v[32:35], a[192:195], a[96:99], 0
    buffer_load_dwordx4 v7, s[12:15], s68 offen offset:0 nt lds
    s_waitcnt lgkmcnt(4)
    v_mfma_f32_16x16x32_bf16 v[32:35], a[196:199], a[100:103], v[32:35]
    buffer_load_dwordx4 v8, s[12:15], s68 offen offset:1024 nt lds
    s_waitcnt lgkmcnt(3)
    v_mfma_f32_16x16x32_bf16 v[32:35], a[200:203], a[104:107], v[32:35]
    buffer_load_dwordx4 v9, s[12:15], s68 offen offset:2048 nt lds
    s_sub_u32 s63, 3072, s63
    s_add_u32 s68, s67, s63
    s_add_u32 m0, s64, s63
    s_waitcnt lgkmcnt(2)
    v_mfma_f32_16x16x32_bf16 v[32:35], a[204:207], a[108:111], v[32:35]
    buffer_load_dwordx4 v156, s[12:15], s68 offen offset:0 nt lds
    s_waitcnt lgkmcnt(1)
    v_mfma_f32_16x16x32_bf16 v[32:35], a[208:211], a[112:115], v[32:35]
    buffer_load_dwordx4 v157, s[12:15], s68 offen offset:1024 nt lds
    s_waitcnt lgkmcnt(0)
    v_mfma_f32_16x16x32_bf16 v[32:35], a[212:215], a[116:119], v[32:35]
    buffer_load_dwordx4 v158, s[12:15], s68 offen offset:2048 nt lds
    s_mov_b32 s65, 122880
    s_and_b32 s63, s3, 1
    s_mul_i32 s63, s63, 3072
    s_add_u32 s67, s41, 18432
    s_add_u32 s68, s67, s63
    s_add_u32 s64, s65, s35
    s_add_u32 s64, s64, 0
    s_add_u32 m0, s64, s63
    v_mfma_f32_16x16x32_bf16 v[36:39], a[216:219], a[96:99], 0
    v_mfma_f32_16x16x32_bf16 v[36:39], a[220:223], a[100:103], v[36:39]
    v_mfma_f32_16x16x32_bf16 v[36:39], a[224:227], a[104:107], v[36:39]
    v_mfma_f32_16x16x32_bf16 v[36:39], a[228:231], a[108:111], v[36:39]
    v_mfma_f32_16x16x32_bf16 v[36:39], a[232:235], a[112:115], v[36:39]
    v_mfma_f32_16x16x32_bf16 v[36:39], a[236:239], a[116:119], v[36:39]
    s_waitcnt vmcnt(6)
    ds_read_b128 a[120:123], v144 offset:0
    ds_read_b128 a[124:127], v145 offset:0
    ds_read_b128 a[128:131], v144 offset:1024
    ds_read_b128 a[132:135], v145 offset:1024
    ds_read_b128 a[136:139], v144 offset:2048
    ds_read_b128 a[140:143], v145 offset:2048
    s_waitcnt lgkmcnt(5)
    v_mfma_f32_16x16x32_bf16 v[40:43], a[192:195], a[120:123], 0
    buffer_load_dwordx4 v7, s[12:15], s68 offen offset:0 nt lds
    s_waitcnt lgkmcnt(4)
    v_mfma_f32_16x16x32_bf16 v[40:43], a[196:199], a[124:127], v[40:43]
    buffer_load_dwordx4 v8, s[12:15], s68 offen offset:1024 nt lds
    s_waitcnt lgkmcnt(3)
    v_mfma_f32_16x16x32_bf16 v[40:43], a[200:203], a[128:131], v[40:43]
    buffer_load_dwordx4 v9, s[12:15], s68 offen offset:2048 nt lds
    s_sub_u32 s63, 3072, s63
    s_add_u32 s68, s67, s63
    s_add_u32 m0, s64, s63
    s_waitcnt lgkmcnt(2)
    v_mfma_f32_16x16x32_bf16 v[40:43], a[204:207], a[132:135], v[40:43]
    buffer_load_dwordx4 v156, s[12:15], s68 offen offset:0 nt lds
    s_waitcnt lgkmcnt(1)
    v_mfma_f32_16x16x32_bf16 v[40:43], a[208:211], a[136:139], v[40:43]
    buffer_load_dwordx4 v157, s[12:15], s68 offen offset:1024 nt lds
    s_waitcnt lgkmcnt(0)
    v_mfma_f32_16x16x32_bf16 v[40:43], a[212:215], a[140:143], v[40:43]
    buffer_load_dwordx4 v158, s[12:15], s68 offen offset:2048 nt lds
    s_add_u32 m0, s31, 110592
    v_mfma_f32_16x16x32_bf16 v[44:47], a[216:219], a[120:123], 0
    v_mfma_f32_16x16x32_bf16 v[44:47], a[220:223], a[124:127], v[44:47]
    v_mfma_f32_16x16x32_bf16 v[44:47], a[224:227], a[128:131], v[44:47]
    v_mfma_f32_16x16x32_bf16 v[44:47], a[228:231], a[132:135], v[44:47]
    v_mfma_f32_16x16x32_bf16 v[44:47], a[232:235], a[136:139], v[44:47]
    v_mfma_f32_16x16x32_bf16 v[44:47], a[236:239], a[140:143], v[44:47]
    s_waitcnt vmcnt(6)
    ds_read_b128 a[144:147], v144 offset:24576
    ds_read_b128 a[148:151], v145 offset:24576
    ds_read_b128 a[152:155], v144 offset:25600
    ds_read_b128 a[156:159], v145 offset:25600
    ds_read_b128 a[160:163], v144 offset:26624
    ds_read_b128 a[164:167], v145 offset:26624
    s_waitcnt lgkmcnt(5)
    v_mfma_f32_16x16x32_bf16 v[48:51], a[192:195], a[144:147], 0
    buffer_load_dwordx4 v7, s[4:7], s28 offen offset:0 lds
    s_waitcnt lgkmcnt(4)
    v_mfma_f32_16x16x32_bf16 v[48:51], a[196:199], a[148:151], v[48:51]
    buffer_load_dwordx4 v8, s[4:7], s28 offen offset:1024 lds
    s_waitcnt lgkmcnt(3)
    v_mfma_f32_16x16x32_bf16 v[48:51], a[200:203], a[152:155], v[48:51]
    buffer_load_dwordx4 v9, s[4:7], s28 offen offset:2048 lds
    s_add_u32 s28, s28, 12288
    s_add_u32 m0, s33, s31
    s_waitcnt lgkmcnt(2)
    v_mfma_f32_16x16x32_bf16 v[48:51], a[204:207], a[156:159], v[48:51]
    s_waitcnt lgkmcnt(1)
    v_mfma_f32_16x16x32_bf16 v[48:51], a[208:211], a[160:163], v[48:51]
    s_waitcnt lgkmcnt(0)
    v_mfma_f32_16x16x32_bf16 v[48:51], a[212:215], a[164:167], v[48:51]
    v_mfma_f32_16x16x32_bf16 v[52:55], a[216:219], a[144:147], 0
    v_mfma_f32_16x16x32_bf16 v[52:55], a[220:223], a[148:151], v[52:55]
    v_mfma_f32_16x16x32_bf16 v[52:55], a[224:227], a[152:155], v[52:55]
    v_mfma_f32_16x16x32_bf16 v[52:55], a[228:231], a[156:159], v[52:55]
    v_mfma_f32_16x16x32_bf16 v[52:55], a[232:235], a[160:163], v[52:55]
    v_mfma_f32_16x16x32_bf16 v[52:55], a[236:239], a[164:167], v[52:55]
    s_waitcnt vmcnt(3)
    ds_read_b128 a[168:171], v146 offset:24576
    ds_read_b128 a[172:175], v147 offset:24576
    ds_read_b128 a[176:179], v146 offset:25600
    ds_read_b128 a[180:183], v147 offset:25600
    ds_read_b128 a[184:187], v146 offset:26624
    ds_read_b128 a[188:191], v147 offset:26624
    s_waitcnt lgkmcnt(5)
    v_mfma_f32_16x16x32_bf16 v[56:59], a[192:195], a[168:171], 0
    buffer_load_dwordx4 v7, s[20:23], s28 offen offset:0 lds
    s_waitcnt lgkmcnt(4)
    v_mfma_f32_16x16x32_bf16 v[56:59], a[196:199], a[172:175], v[56:59]
    buffer_load_dwordx4 v8, s[20:23], s28 offen offset:1024 lds
    s_waitcnt lgkmcnt(3)
    v_mfma_f32_16x16x32_bf16 v[56:59], a[200:203], a[176:179], v[56:59]
    buffer_load_dwordx4 v9, s[20:23], s28 offen offset:2048 lds
    s_add_u32 m0, s33, s32
    s_waitcnt lgkmcnt(2)
    v_mfma_f32_16x16x32_bf16 v[56:59], a[204:207], a[180:183], v[56:59]
    buffer_load_dwordx4 v10, s[24:27], s29 offen offset:0 lds
    s_waitcnt lgkmcnt(1)
    v_mfma_f32_16x16x32_bf16 v[56:59], a[208:211], a[184:187], v[56:59]
    buffer_load_dwordx4 v11, s[24:27], s29 offen offset:1024 lds
    s_waitcnt lgkmcnt(0)
    v_mfma_f32_16x16x32_bf16 v[56:59], a[212:215], a[188:191], v[56:59]
    buffer_load_dwordx4 v12, s[24:27], s29 offen offset:2048 lds
    s_add_u32 s28, s28, s30
    s_add_u32 s29, s29, s30
    s_add_u32 s33, s33, 24576
    s_cmp_eq_u32 s33, 147456
    s_cselect_b32 s33, 0, s33
    v_mfma_f32_16x16x32_bf16 v[60:63], a[216:219], a[168:171], 0
    s_add_u32 s62, s34, 49152
    s_cmp_eq_u32 s62, 147456
    s_cselect_b32 s62, 0, s62
    v_mfma_f32_16x16x32_bf16 v[60:63], a[220:223], a[172:175], v[60:63]
    s_sub_u32 s57, s62, s34
    s_mov_b32 s34, s62
    v_mfma_f32_16x16x32_bf16 v[60:63], a[224:227], a[176:179], v[60:63]
    v_mfma_f32_16x16x32_bf16 v[60:63], a[228:231], a[180:183], v[60:63]
    v_mfma_f32_16x16x32_bf16 v[60:63], a[232:235], a[184:187], v[60:63]
    v_mfma_f32_16x16x32_bf16 v[60:63], a[236:239], a[188:191], v[60:63]
    s_waitcnt vmcnt(6)
    s_barrier
    ds_read_b128 a[192:195], v1 offset:12288
    ds_read_b128 a[196:199], v2 offset:12288
    ds_read_b128 a[200:203], v1 offset:13312
    ds_read_b128 a[204:207], v2 offset:13312
    ds_read_b128 a[208:211], v1 offset:14336
    ds_read_b128 a[212:215], v2 offset:14336
    ds_read_b128 a[216:219], v1 offset:18432
    ds_read_b128 a[220:223], v2 offset:18432
    ds_read_b128 a[224:227], v1 offset:19456
    ds_read_b128 a[228:231], v2 offset:19456
    ds_read_b128 a[232:235], v1 offset:20480
    ds_read_b128 a[236:239], v2 offset:20480
    v_max3_f32 v152, v32, v33, v34
    v_max3_f32 v152, v152, v35, v36
    v_max3_f32 v152, v152, v37, v38
    v_max_f32 v152, v152, v39
    v_max3_f32 v154, v40, v41, v42
    v_mov_b32 v153, v152
    v_max3_f32 v154, v154, v43, v44
    v_max3_f32 v154, v154, v45, v46
    v_permlane32_swap_b32 v153, v152
    v_max_f32 v152, v152, v153
    v_max_f32 v154, v154, v47
    v_mov_b32 v153, v152
    v_mov_b32 v155, v154
    v_add_u32 v1, s57, v1
    v_permlane16_swap_b32 v153, v152
    v_permlane32_swap_b32 v155, v154
    v_max_f32 v152, v152, v153
    v_max_f32 v154, v154, v155
    v_mul_f32_e64 v16, -s36, v152
    v_mov_b32 v155, v154
    s_waitcnt lgkmcnt(11)
    v_mfma_f32_16x16x32_bf16 v[64:67], a[192:195], a[96:99], 0
    s_add_u32 s69, s69, 1
    v_permlane16_swap_b32 v155, v154
    s_waitcnt lgkmcnt(6)
    v_mfma_f32_16x16x32_bf16 v[64:67], a[196:199], a[100:103], v[64:67]
    s_add_u32 s48, s48, 325632
    v_max3_f32 v152, v48, v49, v50
    v_max_f32 v154, v154, v155
    v_mfma_f32_16x16x32_bf16 v[64:67], a[200:203], a[104:107], v[64:67]
    s_lshr_b32 s62, s39, s69
    v_max3_f32 v152, v152, v51, v52
    v_mul_f32_e64 v17, -s36, v154
    v_mfma_f32_16x16x32_bf16 v[64:67], a[204:207], a[108:111], v[64:67]
    s_and_b32 s62, s62, 1
    v_max3_f32 v152, v152, v53, v54
    v_max_f32 v152, v152, v55
    v_mfma_f32_16x16x32_bf16 v[64:67], a[208:211], a[112:115], v[64:67]
    s_lshl_b32 s62, s62, 1
    v_fma_f32 v32, v32, s36, v16
    v_fma_f32 v33, v33, s36, v16
    v_mfma_f32_16x16x32_bf16 v[64:67], a[212:215], a[116:119], v[64:67]
    s_add_u32 s62, s62, s49
    v_fma_f32 v34, v34, s36, v16
    v_fma_f32 v35, v35, s36, v16
    v_mfma_f32_16x16x32_bf16 v[72:75], a[192:195], a[120:123], 0
    s_and_b32 s62, s62, 3
    v_fma_f32 v40, v40, s36, v17
    v_fma_f32 v41, v41, s36, v17
    v_mfma_f32_16x16x32_bf16 v[72:75], a[196:199], a[124:127], v[72:75]
    s_add_u32 s63, s69, 8
    v_fma_f32 v36, v36, s36, v16
    v_fma_f32 v37, v37, s36, v16
    v_mfma_f32_16x16x32_bf16 v[72:75], a[200:203], a[128:131], v[72:75]
    s_lshr_b32 s63, s39, s63
    v_mov_b32 v153, v152
    v_max3_f32 v154, v56, v57, v58
    v_mfma_f32_16x16x32_bf16 v[72:75], a[204:207], a[132:135], v[72:75]
    s_and_b32 s63, s63, 1
    v_exp_f32 v144, v32
    v_mfma_f32_16x16x32_bf16 v[72:75], a[208:211], a[136:139], v[72:75]
    s_xor_b32 s62, s62, s63
    v_exp_f32 v145, v33
    v_mfma_f32_16x16x32_bf16 v[72:75], a[212:215], a[140:143], v[72:75]
    s_mul_i32 s63, s3, 3
    v_exp_f32 v146, v34
    v_mfma_f32_16x16x32_bf16 v[80:83], a[192:195], a[144:147], 0
    s_lshl_b32 s64, s3, 2
    v_exp_f32 v147, v35
    v_mfma_f32_16x16x32_bf16 v[80:83], a[196:199], a[148:151], v[80:83]
    s_mov_b32 s40, 1
    v_exp_f32 v148, v40
    v_mfma_f32_16x16x32_bf16 v[80:83], a[200:203], a[152:155], v[80:83]
    s_add_u32 s65, s63, 17
    v_exp_f32 v149, v41
    v_mfma_f32_16x16x32_bf16 v[80:83], a[204:207], a[156:159], v[80:83]
    s_cmp_eq_u32 s3, 0
    v_exp_f32 v150, v36
    v_mfma_f32_16x16x32_bf16 v[80:83], a[208:211], a[160:163], v[80:83]
    s_cselect_b32 s65, 16, s65
    v_exp_f32 v151, v37
    v_mfma_f32_16x16x32_bf16 v[80:83], a[212:215], a[164:167], v[80:83]
    s_cselect_b32 s41, 1, 0
    v_permlane32_swap_b32 v153, v152
    v_mfma_f32_16x16x32_bf16 v[88:91], a[192:195], a[168:171], 0
    s_cmp_eq_u32 s62, 1
    v_max3_f32 v154, v154, v59, v60
    v_max_f32 v152, v152, v153
    v_mfma_f32_16x16x32_bf16 v[88:91], a[196:199], a[172:175], v[88:91]
    s_cselect_b32 s64, s65, s64
    v_max3_f32 v154, v154, v61, v62
    v_mov_b32 v153, v152
    v_mfma_f32_16x16x32_bf16 v[88:91], a[200:203], a[176:179], v[88:91]
    s_cselect_b32 s40, s41, s40
    v_max_f32 v154, v154, v63
    v_cvt_pk_bf16_f32 v96, v144, v145
    v_mfma_f32_16x16x32_bf16 v[88:91], a[204:207], a[180:183], v[88:91]
    s_add_u32 s65, s63, 29
    v_cvt_pk_bf16_f32 v97, v146, v147
    v_cvt_pk_bf16_f32 v100, v148, v149
    v_mfma_f32_16x16x32_bf16 v[88:91], a[208:211], a[184:187], v[88:91]
    s_cmp_eq_u32 s62, 2
    v_cvt_pk_bf16_f32 v98, v150, v151
    v_fma_f32 v38, v38, s36, v16
    v_mfma_f32_16x16x32_bf16 v[88:91], a[212:215], a[188:191], v[88:91]
    s_cselect_b32 s64, s65, s64
    v_fma_f32 v39, v39, s36, v16
    v_fma_f32 v42, v42, s36, v17
    s_waitcnt lgkmcnt(0)
    v_mfma_f32_16x16x32_bf16 v[68:71], a[216:219], a[96:99], 0
    s_cselect_b32 s40, 0, s40
    v_fma_f32 v43, v43, s36, v17
    v_fma_f32 v44, v44, s36, v17
    v_mfma_f32_16x16x32_bf16 v[68:71], a[220:223], a[100:103], v[68:71]
    s_add_u32 s65, s63, 41
    v_fma_f32 v45, v45, s36, v17
    v_fma_f32 v46, v46, s36, v17
    v_mfma_f32_16x16x32_bf16 v[68:71], a[224:227], a[104:107], v[68:71]
    s_cmp_eq_u32 s62, 3
    v_fma_f32 v47, v47, s36, v17
    v_mov_b32 v155, v154
    v_mfma_f32_16x16x32_bf16 v[68:71], a[228:231], a[108:111], v[68:71]
    s_cselect_b32 s64, s65, s64
    v_permlane16_swap_b32 v153, v152
    v_mfma_f32_16x16x32_bf16 v[68:71], a[232:235], a[112:115], v[68:71]
    s_cselect_b32 s40, 0, s40
    v_exp_f32 v144, v38
    v_mfma_f32_16x16x32_bf16 v[68:71], a[236:239], a[116:119], v[68:71]
    s_mul_i32 s64, s64, 6144
    v_exp_f32 v145, v39
    v_mfma_f32_16x16x32_bf16 v[76:79], a[216:219], a[120:123], 0
    s_add_u32 s41, s48, s64
    v_exp_f32 v146, v42
    v_mfma_f32_16x16x32_bf16 v[76:79], a[220:223], a[124:127], v[76:79]
    s_cmp_ge_u32 s69, 8
    v_exp_f32 v147, v43
    v_mfma_f32_16x16x32_bf16 v[76:79], a[224:227], a[128:131], v[76:79]
    s_cselect_b32 s41, 166725632, s41
    v_exp_f32 v148, v44
    v_mfma_f32_16x16x32_bf16 v[76:79], a[228:231], a[132:135], v[76:79]
    s_add_u32 m0, s33, s31
    v_exp_f32 v149, v45
    v_mfma_f32_16x16x32_bf16 v[76:79], a[232:235], a[136:139], v[76:79]
    buffer_load_dwordx4 v7, s[20:23], s28 offen offset:0 lds
    v_mfma_f32_16x16x32_bf16 v[76:79], a[236:239], a[140:143], v[76:79]
    buffer_load_dwordx4 v8, s[20:23], s28 offen offset:1024 lds
    v_mfma_f32_16x16x32_bf16 v[84:87], a[216:219], a[144:147], 0
    buffer_load_dwordx4 v9, s[20:23], s28 offen offset:2048 lds
    s_add_u32 m0, s33, s32
    v_mfma_f32_16x16x32_bf16 v[84:87], a[220:223], a[148:151], v[84:87]
    buffer_load_dwordx4 v10, s[24:27], s29 offen offset:0 lds
    v_mfma_f32_16x16x32_bf16 v[84:87], a[224:227], a[152:155], v[84:87]
    buffer_load_dwordx4 v11, s[24:27], s29 offen offset:1024 lds
    v_mfma_f32_16x16x32_bf16 v[84:87], a[228:231], a[156:159], v[84:87]
    buffer_load_dwordx4 v12, s[24:27], s29 offen offset:2048 lds
    s_add_u32 s28, s28, s30
    s_add_u32 s29, s29, s30
    v_mfma_f32_16x16x32_bf16 v[84:87], a[232:235], a[160:163], v[84:87]
    s_add_u32 s33, s33, 24576
    s_cmp_eq_u32 s33, 147456
    s_cselect_b32 s33, 0, s33
    v_mfma_f32_16x16x32_bf16 v[84:87], a[236:239], a[164:167], v[84:87]
    s_add_u32 m0, s33, s31
    v_exp_f32 v150, v46
    v_mfma_f32_16x16x32_bf16 v[92:95], a[216:219], a[168:171], 0
    buffer_load_dwordx4 v7, s[20:23], s28 offen offset:0 lds
    v_mfma_f32_16x16x32_bf16 v[92:95], a[220:223], a[172:175], v[92:95]
    buffer_load_dwordx4 v8, s[20:23], s28 offen offset:1024 lds
    v_mfma_f32_16x16x32_bf16 v[92:95], a[224:227], a[176:179], v[92:95]
    buffer_load_dwordx4 v9, s[20:23], s28 offen offset:2048 lds
    s_add_u32 m0, s33, s32
    v_mfma_f32_16x16x32_bf16 v[92:95], a[228:231], a[180:183], v[92:95]
    buffer_load_dwordx4 v10, s[24:27], s29 offen offset:0 lds
    v_mfma_f32_16x16x32_bf16 v[92:95], a[232:235], a[184:187], v[92:95]
    buffer_load_dwordx4 v11, s[24:27], s29 offen offset:1024 lds
    v_mfma_f32_16x16x32_bf16 v[92:95], a[236:239], a[188:191], v[92:95]
    buffer_load_dwordx4 v12, s[24:27], s29 offen offset:2048 lds
    s_add_u32 s28, s28, s30
    v_exp_f32 v151, v47
    s_add_u32 s29, s29, s30
    v_max_f32 v152, v152, v153
    v_permlane32_swap_b32 v155, v154
    s_add_u32 s33, s33, 24576
    v_mul_f32_e64 v18, -s36, v152
    v_max_f32 v154, v154, v155
    s_cmp_eq_u32 s33, 147456
    v_mov_b32 v155, v154
    v_cvt_pk_bf16_f32 v99, v144, v145
    v_cvt_pk_bf16_f32 v101, v146, v147
    v_cvt_pk_bf16_f32 v102, v148, v149
    v_mfma_f32_16x16x32_bf16 v[128:131], v[24:27], v[96:99], 0
    v_cvt_pk_bf16_f32 v103, v150, v151
    v_fma_f32 v48, v48, s36, v18
    v_fma_f32 v49, v49, s36, v18
    v_mfma_f32_16x16x32_bf16 v[132:135], v[24:27], v[100:103], 0
    v_fma_f32 v50, v50, s36, v18
    v_fma_f32 v51, v51, s36, v18
    v_fma_f32 v52, v52, s36, v18
    v_fma_f32 v53, v53, s36, v18
    v_fma_f32 v54, v54, s36, v18
    v_fma_f32 v55, v55, s36, v18
    s_cselect_b32 s33, 0, s33
    v_permlane16_swap_b32 v155, v154
    v_exp_f32 v144, v48
    v_exp_f32 v145, v49
    v_exp_f32 v146, v50
    v_exp_f32 v147, v51
    v_exp_f32 v148, v52
    v_exp_f32 v149, v53
    v_exp_f32 v150, v54
    v_exp_f32 v151, v55
    s_add_u32 m0, s33, s31
    v_max_f32 v154, v154, v155
    v_mul_f32_e64 v19, -s36, v154
    v_cvt_pk_bf16_f32 v104, v144, v145
    v_cvt_pk_bf16_f32 v105, v146, v147
    v_cvt_pk_bf16_f32 v106, v148, v149
    v_cvt_pk_bf16_f32 v107, v150, v151
    buffer_load_dwordx4 v7, s[20:23], s28 offen offset:0 lds
    buffer_load_dwordx4 v8, s[20:23], s28 offen offset:1024 lds
    v_mfma_f32_16x16x32_bf16 v[136:139], v[24:27], v[104:107], 0
    buffer_load_dwordx4 v9, s[20:23], s28 offen offset:2048 lds
    s_add_u32 m0, s33, s32
    v_fma_f32 v56, v56, s36, v19
    v_fma_f32 v57, v57, s36, v19
    v_fma_f32 v58, v58, s36, v19
    v_fma_f32 v59, v59, s36, v19
    v_fma_f32 v60, v60, s36, v19
    v_fma_f32 v61, v61, s36, v19
    v_fma_f32 v62, v62, s36, v19
    v_fma_f32 v63, v63, s36, v19
    v_exp_f32 v144, v56
    v_exp_f32 v145, v57
    v_exp_f32 v146, v58
    v_exp_f32 v147, v59
    v_exp_f32 v148, v60
    v_exp_f32 v149, v61
    v_exp_f32 v150, v62
    v_exp_f32 v151, v63
    v_cvt_pk_bf16_f32 v108, v144, v145
    v_cvt_pk_bf16_f32 v109, v146, v147
    v_cvt_pk_bf16_f32 v110, v148, v149
    v_cvt_pk_bf16_f32 v111, v150, v151
    buffer_load_dwordx4 v10, s[24:27], s29 offen offset:0 lds
    buffer_load_dwordx4 v11, s[24:27], s29 offen offset:1024 lds
    v_mfma_f32_16x16x32_bf16 v[140:143], v[24:27], v[108:111], 0
    buffer_load_dwordx4 v12, s[24:27], s29 offen offset:2048 lds
    s_waitcnt vmcnt(18)
    s_barrier
    s_add_u32 s28, s28, s30
    v_fma_f32 v64, v64, s36, v16
    v_fma_f32 v65, v65, s36, v16
    v_fma_f32 v66, v66, s36, v16
    v_fma_f32 v67, v67, s36, v16
    v_fma_f32 v72, v72, s36, v17
    v_fma_f32 v73, v73, s36, v17
    s_add_u32 s29, s29, s30
    ds_read_b64_tr_b16 a[240:241], v3 offset:0
    ds_read_b64_tr_b16 a[242:243], v3 offset:6144
    ds_read_b64_tr_b16 a[244:245], v4 offset:0
    ds_read_b64_tr_b16 a[246:247], v4 offset:6144
    v_exp_f32 v144, v64
    v_exp_f32 v145, v65
    v_exp_f32 v146, v66
    v_exp_f32 v147, v67
    v_exp_f32 v148, v72
    v_exp_f32 v149, v73
    s_add_u32 s33, s33, 24576
    s_cmp_eq_u32 s33, 147456
    ds_read_b64_tr_b16 a[248:249], v5 offset:0
    ds_read_b64_tr_b16 a[250:251], v5 offset:6144
    ds_read_b64_tr_b16 a[252:253], v6 offset:0
    ds_read_b64_tr_b16 a[254:255], v6 offset:6144
    s_cselect_b32 s33, 0, s33
    v_cvt_pk_bf16_f32 v112, v144, v145
    v_cvt_pk_bf16_f32 v113, v146, v147
    v_cvt_pk_bf16_f32 v116, v148, v149
    v_add_u32 v2, s57, v2
    s_waitcnt lgkmcnt(6)
    v_mfma_f32_16x16x32_bf16 v[160:163], a[240:243], v[96:99], 0
    s_add_u32 m0, s33, s31
    ds_read_b128 a[192:195], v1 offset:0
    ds_read_b128 a[196:199], v2 offset:0
    v_mfma_f32_16x16x32_bf16 v[208:211], a[240:243], v[100:103], 0
    ds_read_b128 a[200:203], v1 offset:1024
    ds_read_b128 a[204:207], v2 offset:1024
    v_mfma_f32_16x16x32_bf16 a[0:3], a[240:243], v[104:107], 0
    ds_read_b128 a[208:211], v1 offset:2048
    ds_read_b128 a[212:215], v2 offset:2048
    v_mfma_f32_16x16x32_bf16 a[48:51], a[240:243], v[108:111], 0
    buffer_load_dwordx4 v7, s[20:23], s28 offen offset:0 lds
    s_waitcnt lgkmcnt(10)
    v_mfma_f32_16x16x32_bf16 v[164:167], a[244:247], v[96:99], 0
    ds_read_b64_tr_b16 a[240:241], v3 offset:1024
    ds_read_b64_tr_b16 a[242:243], v3 offset:7168
    v_mfma_f32_16x16x32_bf16 v[212:215], a[244:247], v[100:103], 0
    ds_read_b128 a[216:219], v1 offset:6144
    ds_read_b128 a[220:223], v2 offset:6144
    v_mfma_f32_16x16x32_bf16 a[4:7], a[244:247], v[104:107], 0
    ds_read_b128 a[224:227], v1 offset:7168
    ds_read_b128 a[228:231], v2 offset:7168
    v_mfma_f32_16x16x32_bf16 a[52:55], a[244:247], v[108:111], 0
    s_waitcnt lgkmcnt(12)
    ds_read_b64_tr_b16 a[244:245], v4 offset:1024
    ds_read_b64_tr_b16 a[246:247], v4 offset:7168
    v_mfma_f32_16x16x32_bf16 v[168:171], a[248:251], v[96:99], 0
    ds_read_b128 a[232:235], v1 offset:8192
    ds_read_b128 a[236:239], v2 offset:8192
    v_mfma_f32_16x16x32_bf16 v[216:219], a[248:251], v[100:103], 0
    v_fma_f32 v68, v68, s36, v16
    v_fma_f32 v69, v69, s36, v16
    v_mfma_f32_16x16x32_bf16 a[8:11], a[248:251], v[104:107], 0
    v_exp_f32 v150, v68
    v_mfma_f32_16x16x32_bf16 a[56:59], a[248:251], v[108:111], 0
    ds_read_b64_tr_b16 a[248:249], v5 offset:1024
    ds_read_b64_tr_b16 a[250:251], v5 offset:7168
    v_mfma_f32_16x16x32_bf16 v[172:175], a[252:255], v[96:99], 0
    v_exp_f32 v151, v69
    v_mfma_f32_16x16x32_bf16 v[220:223], a[252:255], v[100:103], 0
    v_cvt_pk_bf16_f32 v114, v150, v151
    v_fma_f32 v70, v70, s36, v16
    v_mfma_f32_16x16x32_bf16 a[12:15], a[252:255], v[104:107], 0
    v_fma_f32 v71, v71, s36, v16
    v_fma_f32 v74, v74, s36, v17
    v_mfma_f32_16x16x32_bf16 a[60:63], a[252:255], v[108:111], 0
    buffer_load_dwordx4 v8, s[20:23], s28 offen offset:1024 lds
    s_waitcnt lgkmcnt(4)
    v_mfma_f32_16x16x32_bf16 v[176:179], a[240:243], v[96:99], 0
    ds_read_b64_tr_b16 a[252:253], v6 offset:1024
    ds_read_b64_tr_b16 a[254:255], v6 offset:7168
    v_mfma_f32_16x16x32_bf16 v[224:227], a[240:243], v[100:103], 0
    v_fma_f32 v75, v75, s36, v17
    v_fma_f32 v76, v76, s36, v17
    v_mfma_f32_16x16x32_bf16 a[16:19], a[240:243], v[104:107], 0
    v_fma_f32 v77, v77, s36, v17
    v_fma_f32 v78, v78, s36, v17
    v_mfma_f32_16x16x32_bf16 a[64:67], a[240:243], v[108:111], 0
    ds_read_b64_tr_b16 a[240:241], v3 offset:2048
    ds_read_b64_tr_b16 a[242:243], v3 offset:8192
    v_mfma_f32_16x16x32_bf16 v[180:183], a[244:247], v[96:99], 0
    v_fma_f32 v79, v79, s36, v17
    v_fma_f32 v80, v80, s36, v18
    v_mfma_f32_16x16x32_bf16 v[228:231], a[244:247], v[100:103], 0
    v_exp_f32 v144, v70
    v_mfma_f32_16x16x32_bf16 a[20:23], a[244:247], v[104:107], 0
    v_exp_f32 v145, v71
    v_mfma_f32_16x16x32_bf16 a[68:71], a[244:247], v[108:111], 0
    s_waitcnt lgkmcnt(4)
    ds_read_b64_tr_b16 a[244:245], v4 offset:2048
    ds_read_b64_tr_b16 a[246:247], v4 offset:8192
    v_mfma_f32_16x16x32_bf16 v[184:187], a[248:251], v[96:99], 0
    v_exp_f32 v146, v74
    v_mfma_f32_16x16x32_bf16 v[232:235], a[248:251], v[100:103], 0
    v_exp_f32 v147, v75
    v_mfma_f32_16x16x32_bf16 a[24:27], a[248:251], v[104:107], 0
    v_exp_f32 v148, v76
    v_mfma_f32_16x16x32_bf16 a[72:75], a[248:251], v[108:111], 0
    s_waitcnt lgkmcnt(3)
    ds_read_b64_tr_b16 a[248:249], v5 offset:2048
    ds_read_b64_tr_b16 a[250:251], v5 offset:8192
    v_mfma_f32_16x16x32_bf16 v[188:191], a[252:255], v[96:99], 0
    buffer_load_dwordx4 v9, s[20:23], s28 offen offset:2048 lds
    v_mfma_f32_16x16x32_bf16 v[236:239], a[252:255], v[100:103], 0
    s_add_u32 m0, s33, s32
    v_exp_f32 v149, v77
    v_mfma_f32_16x16x32_bf16 a[28:31], a[252:255], v[104:107], 0
    v_exp_f32 v150, v78
    v_mfma_f32_16x16x32_bf16 a[76:79], a[252:255], v[108:111], 0
    s_waitcnt lgkmcnt(2)
    ds_read_b64_tr_b16 a[252:253], v6 offset:2048
    ds_read_b64_tr_b16 a[254:255], v6 offset:8192
    v_mfma_f32_16x16x32_bf16 v[192:195], a[240:243], v[96:99], 0
    v_exp_f32 v151, v79
    v_mfma_f32_16x16x32_bf16 v[240:243], a[240:243], v[100:103], 0
    v_cvt_pk_bf16_f32 v115, v144, v145
    v_cvt_pk_bf16_f32 v117, v146, v147
    v_mfma_f32_16x16x32_bf16 a[32:35], a[240:243], v[104:107], 0
    v_cvt_pk_bf16_f32 v118, v148, v149
    v_cvt_pk_bf16_f32 v119, v150, v151
    v_mfma_f32_16x16x32_bf16 a[80:83], a[240:243], v[108:111], 0
    v_fma_f32 v81, v81, s36, v18
    v_fma_f32 v82, v82, s36, v18
    v_mfma_f32_16x16x32_bf16 v[196:199], a[244:247], v[96:99], 0
    v_fma_f32 v83, v83, s36, v18
    v_fma_f32 v84, v84, s36, v18
    v_mfma_f32_16x16x32_bf16 v[244:247], a[244:247], v[100:103], 0
    v_fma_f32 v85, v85, s36, v18
    v_fma_f32 v86, v86, s36, v18
    v_mfma_f32_16x16x32_bf16 a[36:39], a[244:247], v[104:107], 0
    v_fma_f32 v87, v87, s36, v18
    v_fma_f32 v88, v88, s36, v19
    v_mfma_f32_16x16x32_bf16 a[84:87], a[244:247], v[108:111], 0
    s_waitcnt lgkmcnt(1)
    v_exp_f32 v144, v80
    v_mfma_f32_16x16x32_bf16 v[200:203], a[248:251], v[96:99], 0
    buffer_load_dwordx4 v10, s[24:27], s29 offen offset:0 lds
    v_mfma_f32_16x16x32_bf16 v[248:251], a[248:251], v[100:103], 0
    v_exp_f32 v145, v81
    v_mfma_f32_16x16x32_bf16 a[40:43], a[248:251], v[104:107], 0
    v_exp_f32 v146, v82
    v_mfma_f32_16x16x32_bf16 a[88:91], a[248:251], v[108:111], 0
    s_waitcnt lgkmcnt(0)
    v_exp_f32 v147, v83
    v_mfma_f32_16x16x32_bf16 v[204:207], a[252:255], v[96:99], 0
    v_exp_f32 v148, v84
    v_mfma_f32_16x16x32_bf16 v[252:255], a[252:255], v[100:103], 0
    v_exp_f32 v149, v85
    v_mfma_f32_16x16x32_bf16 a[44:47], a[252:255], v[104:107], 0
    v_exp_f32 v150, v86
    v_mfma_f32_16x16x32_bf16 a[92:95], a[252:255], v[108:111], 0
    v_exp_f32 v151, v87
    v_mfma_f32_16x16x32_bf16 v[32:35], a[192:195], a[96:99], 0
    v_cvt_pk_bf16_f32 v120, v144, v145
    v_cvt_pk_bf16_f32 v121, v146, v147
    v_mfma_f32_16x16x32_bf16 v[32:35], a[196:199], a[100:103], v[32:35]
    v_cvt_pk_bf16_f32 v122, v148, v149
    v_cvt_pk_bf16_f32 v123, v150, v151
    v_mfma_f32_16x16x32_bf16 v[32:35], a[200:203], a[104:107], v[32:35]
    v_fma_f32 v89, v89, s36, v19
    v_fma_f32 v90, v90, s36, v19
    v_mfma_f32_16x16x32_bf16 v[32:35], a[204:207], a[108:111], v[32:35]
    v_fma_f32 v91, v91, s36, v19
    v_fma_f32 v92, v92, s36, v19
    v_mfma_f32_16x16x32_bf16 v[32:35], a[208:211], a[112:115], v[32:35]
    v_fma_f32 v93, v93, s36, v19
    v_fma_f32 v94, v94, s36, v19
    v_mfma_f32_16x16x32_bf16 v[32:35], a[212:215], a[116:119], v[32:35]
    buffer_load_dwordx4 v11, s[24:27], s29 offen offset:1024 lds
    v_mfma_f32_16x16x32_bf16 v[40:43], a[192:195], a[120:123], 0
    v_fma_f32 v95, v95, s36, v19
    v_mov_b32 v20, v128
    v_mfma_f32_16x16x32_bf16 v[128:131], v[24:27], v[112:115], 0
    v_exp_f32 v144, v88
    v_mfma_f32_16x16x32_bf16 v[40:43], a[196:199], a[124:127], v[40:43]
    v_exp_f32 v145, v89
    v_mfma_f32_16x16x32_bf16 v[40:43], a[200:203], a[128:131], v[40:43]
    v_exp_f32 v146, v90
    v_mfma_f32_16x16x32_bf16 v[40:43], a[204:207], a[132:135], v[40:43]
    v_exp_f32 v147, v91
    v_mfma_f32_16x16x32_bf16 v[40:43], a[208:211], a[136:139], v[40:43]
    v_exp_f32 v148, v92
    v_mfma_f32_16x16x32_bf16 v[40:43], a[212:215], a[140:143], v[40:43]
    v_exp_f32 v149, v93
    v_mfma_f32_16x16x32_bf16 v[48:51], a[192:195], a[144:147], 0
    v_exp_f32 v150, v94
    v_mfma_f32_16x16x32_bf16 v[48:51], a[196:199], a[148:151], v[48:51]
    v_exp_f32 v151, v95
    v_mfma_f32_16x16x32_bf16 v[48:51], a[200:203], a[152:155], v[48:51]
    v_cvt_pk_bf16_f32 v124, v144, v145
    v_cvt_pk_bf16_f32 v125, v146, v147
    v_mfma_f32_16x16x32_bf16 v[48:51], a[204:207], a[156:159], v[48:51]
    v_cvt_pk_bf16_f32 v126, v148, v149
    v_cvt_pk_bf16_f32 v127, v150, v151
    v_mfma_f32_16x16x32_bf16 v[48:51], a[208:211], a[160:163], v[48:51]
    buffer_load_dwordx4 v12, s[24:27], s29 offen offset:2048 lds
    v_mfma_f32_16x16x32_bf16 v[48:51], a[212:215], a[164:167], v[48:51]
    s_add_u32 s28, s28, s30
    v_mov_b32 v21, v132
    v_mov_b32 v22, v136
    v_mfma_f32_16x16x32_bf16 v[132:135], v[24:27], v[116:119], 0
    s_add_u32 s29, s29, s30
    v_mov_b32 v23, v140
    v_mfma_f32_16x16x32_bf16 v[136:139], v[24:27], v[120:123], 0
    s_add_u32 s33, s33, 24576
    v_mfma_f32_16x16x32_bf16 v[140:143], v[24:27], v[124:127], 0
    s_cmp_eq_u32 s33, 147456
    v_mfma_f32_16x16x32_bf16 v[56:59], a[192:195], a[168:171], 0
    s_cselect_b32 s33, 0, s33
    v_mfma_f32_16x16x32_bf16 v[56:59], a[196:199], a[172:175], v[56:59]
    v_mfma_f32_16x16x32_bf16 v[56:59], a[200:203], a[176:179], v[56:59]
    v_mfma_f32_16x16x32_bf16 v[56:59], a[204:207], a[180:183], v[56:59]
    v_max3_f32 v30, v128, v132, v136
    v_mfma_f32_16x16x32_bf16 v[56:59], a[208:211], a[184:187], v[56:59]
    v_max_f32 v30, v30, v140
    v_cmp_lt_f32 vcc, s37, v30
    v_mfma_f32_16x16x32_bf16 v[56:59], a[212:215], a[188:191], v[56:59]
    v_mfma_f32_16x16x32_bf16 v[36:39], a[216:219], a[96:99], 0
    v_mfma_f32_16x16x32_bf16 v[36:39], a[220:223], a[100:103], v[36:39]
    v_mfma_f32_16x16x32_bf16 v[36:39], a[224:227], a[104:107], v[36:39]
    v_mfma_f32_16x16x32_bf16 v[36:39], a[228:231], a[108:111], v[36:39]
    s_cbranch_vccnz L_rs_start4a
L_ret_start4a:
    v_fma_f32 v32, v32, s36, v16
    v_fma_f32 v33, v33, s36, v16
    v_mfma_f32_16x16x32_bf16 v[36:39], a[232:235], a[112:115], v[36:39]
    v_fma_f32 v34, v34, s36, v16
    v_fma_f32 v35, v35, s36, v16
    v_mfma_f32_16x16x32_bf16 v[36:39], a[236:239], a[116:119], v[36:39]
    v_fma_f32 v40, v40, s36, v17
    v_fma_f32 v41, v41, s36, v17
    v_mfma_f32_16x16x32_bf16 v[44:47], a[216:219], a[120:123], 0
    v_exp_f32 v144, v32
    v_mfma_f32_16x16x32_bf16 v[44:47], a[220:223], a[124:127], v[44:47]
    v_exp_f32 v145, v33
    v_mfma_f32_16x16x32_bf16 v[44:47], a[224:227], a[128:131], v[44:47]
    v_exp_f32 v146, v34
    v_mfma_f32_16x16x32_bf16 v[44:47], a[228:231], a[132:135], v[44:47]
    v_exp_f32 v147, v35
    s_waitcnt vmcnt(18)
    s_barrier
    v_mfma_f32_16x16x32_bf16 v[44:47], a[232:235], a[136:139], v[44:47]
    v_exp_f32 v148, v40
    v_mfma_f32_16x16x32_bf16 v[44:47], a[236:239], a[140:143], v[44:47]
    ds_read_b64_tr_b16 a[240:241], v3 offset:24576
    ds_read_b64_tr_b16 a[242:243], v3 offset:30720
    v_mfma_f32_16x16x32_bf16 v[52:55], a[216:219], a[144:147], 0
    v_exp_f32 v149, v41
    v_mfma_f32_16x16x32_bf16 v[52:55], a[220:223], a[148:151], v[52:55]
    ds_read_b64_tr_b16 a[244:245], v4 offset:24576
    ds_read_b64_tr_b16 a[246:247], v4 offset:30720
    v_mfma_f32_16x16x32_bf16 v[52:55], a[224:227], a[152:155], v[52:55]
    v_cvt_pk_bf16_f32 v96, v144, v145
    v_cvt_pk_bf16_f32 v97, v146, v147
    v_mfma_f32_16x16x32_bf16 v[52:55], a[228:231], a[156:159], v[52:55]
    ds_read_b64_tr_b16 a[248:249], v5 offset:24576
    ds_read_b64_tr_b16 a[250:251], v5 offset:30720
    v_mfma_f32_16x16x32_bf16 v[52:55], a[232:235], a[160:163], v[52:55]
    v_cvt_pk_bf16_f32 v100, v148, v149
    v_mfma_f32_16x16x32_bf16 v[52:55], a[236:239], a[164:167], v[52:55]
    ds_read_b64_tr_b16 a[252:253], v6 offset:24576
    ds_read_b64_tr_b16 a[254:255], v6 offset:30720
    v_mfma_f32_16x16x32_bf16 v[60:63], a[216:219], a[168:171], 0
    v_mfma_f32_16x16x32_bf16 v[60:63], a[220:223], a[172:175], v[60:63]
    v_mfma_f32_16x16x32_bf16 v[60:63], a[224:227], a[176:179], v[60:63]
    v_mfma_f32_16x16x32_bf16 v[60:63], a[228:231], a[180:183], v[60:63]
    v_mfma_f32_16x16x32_bf16 v[60:63], a[232:235], a[184:187], v[60:63]
    v_mfma_f32_16x16x32_bf16 v[60:63], a[236:239], a[188:191], v[60:63]
    s_waitcnt lgkmcnt(4)
    v_mfma_f32_16x16x32_bf16 v[160:163], a[240:243], v[112:115], v[160:163]
    s_add_u32 s62, s34, 49152
    ds_read_b128 a[192:195], v1 offset:24576
    ds_read_b128 a[196:199], v2 offset:24576
    v_mfma_f32_16x16x32_bf16 v[208:211], a[240:243], v[116:119], v[208:211]
    s_cmp_eq_u32 s62, 147456
    ds_read_b128 a[200:203], v1 offset:25600
    ds_read_b128 a[204:207], v2 offset:25600
    v_mfma_f32_16x16x32_bf16 a[0:3], a[240:243], v[120:123], a[0:3]
    s_cselect_b32 s62, 0, s62
    ds_read_b128 a[208:211], v1 offset:26624
    ds_read_b128 a[212:215], v2 offset:26624
    v_mfma_f32_16x16x32_bf16 a[48:51], a[240:243], v[124:127], a[48:51]
    s_sub_u32 s58, s62, s34
    ds_read_b64_tr_b16 a[240:241], v3 offset:25600
    ds_read_b64_tr_b16 a[242:243], v3 offset:31744
    v_mfma_f32_16x16x32_bf16 v[164:167], a[244:247], v[112:115], v[164:167]
    s_mov_b32 s34, s62
    ds_read_b128 a[216:219], v1 offset:30720
    ds_read_b128 a[220:223], v2 offset:30720
    v_mfma_f32_16x16x32_bf16 v[212:215], a[244:247], v[116:119], v[212:215]
    s_add_u32 m0, s33, s31
    ds_read_b128 a[224:227], v1 offset:31744
    ds_read_b128 a[228:231], v2 offset:31744
    v_mfma_f32_16x16x32_bf16 a[4:7], a[244:247], v[120:123], a[4:7]
    buffer_load_dwordx4 v7, s[20:23], s28 offen offset:0 lds
    v_mfma_f32_16x16x32_bf16 a[52:55], a[244:247], v[124:127], a[52:55]
    s_waitcnt lgkmcnt(12)
    ds_read_b64_tr_b16 a[244:245], v4 offset:25600
    ds_read_b64_tr_b16 a[246:247], v4 offset:31744
    v_mfma_f32_16x16x32_bf16 v[168:171], a[248:251], v[112:115], v[168:171]
    ds_read_b128 a[232:235], v1 offset:32768
    ds_read_b128 a[236:239], v2 offset:32768
    v_mfma_f32_16x16x32_bf16 v[216:219], a[248:251], v[116:119], v[216:219]
    v_fma_f32 v36, v36, s36, v16
    v_fma_f32 v37, v37, s36, v16
    v_mfma_f32_16x16x32_bf16 a[8:11], a[248:251], v[120:123], a[8:11]
    v_exp_f32 v150, v36
    v_mfma_f32_16x16x32_bf16 a[56:59], a[248:251], v[124:127], a[56:59]
    ds_read_b64_tr_b16 a[248:249], v5 offset:25600
    ds_read_b64_tr_b16 a[250:251], v5 offset:31744
    v_mfma_f32_16x16x32_bf16 v[172:175], a[252:255], v[112:115], v[172:175]
    v_exp_f32 v151, v37
    v_mfma_f32_16x16x32_bf16 v[220:223], a[252:255], v[116:119], v[220:223]
    v_cvt_pk_bf16_f32 v98, v150, v151
    v_fma_f32 v38, v38, s36, v16
    v_mfma_f32_16x16x32_bf16 a[12:15], a[252:255], v[120:123], a[12:15]
    v_fma_f32 v39, v39, s36, v16
    v_fma_f32 v42, v42, s36, v17
    v_mfma_f32_16x16x32_bf16 a[60:63], a[252:255], v[124:127], a[60:63]
    buffer_load_dwordx4 v8, s[20:23], s28 offen offset:1024 lds
    s_waitcnt lgkmcnt(4)
    v_mfma_f32_16x16x32_bf16 v[176:179], a[240:243], v[112:115], v[176:179]
    ds_read_b64_tr_b16 a[252:253], v6 offset:25600
    ds_read_b64_tr_b16 a[254:255], v6 offset:31744
    v_mfma_f32_16x16x32_bf16 v[224:227], a[240:243], v[116:119], v[224:227]
    v_fma_f32 v43, v43, s36, v17
    v_fma_f32 v44, v44, s36, v17
    v_mfma_f32_16x16x32_bf16 a[16:19], a[240:243], v[120:123], a[16:19]
    v_fma_f32 v45, v45, s36, v17
    v_fma_f32 v46, v46, s36, v17
    v_mfma_f32_16x16x32_bf16 a[64:67], a[240:243], v[124:127], a[64:67]
    ds_read_b64_tr_b16 a[240:241], v3 offset:26624
    ds_read_b64_tr_b16 a[242:243], v3 offset:32768
    v_mfma_f32_16x16x32_bf16 v[180:183], a[244:247], v[112:115], v[180:183]
    v_fma_f32 v47, v47, s36, v17
    v_fma_f32 v48, v48, s36, v18
    v_mfma_f32_16x16x32_bf16 v[228:231], a[244:247], v[116:119], v[228:231]
    v_exp_f32 v144, v38
    v_mfma_f32_16x16x32_bf16 a[20:23], a[244:247], v[120:123], a[20:23]
    v_exp_f32 v145, v39
    v_mfma_f32_16x16x32_bf16 a[68:71], a[244:247], v[124:127], a[68:71]
    s_waitcnt lgkmcnt(4)
    ds_read_b64_tr_b16 a[244:245], v4 offset:26624
    ds_read_b64_tr_b16 a[246:247], v4 offset:32768
    v_mfma_f32_16x16x32_bf16 v[184:187], a[248:251], v[112:115], v[184:187]
    v_exp_f32 v146, v42
    v_mfma_f32_16x16x32_bf16 v[232:235], a[248:251], v[116:119], v[232:235]
    v_exp_f32 v147, v43
    v_mfma_f32_16x16x32_bf16 a[24:27], a[248:251], v[120:123], a[24:27]
    v_exp_f32 v148, v44
    v_mfma_f32_16x16x32_bf16 a[72:75], a[248:251], v[124:127], a[72:75]
    s_waitcnt lgkmcnt(3)
    ds_read_b64_tr_b16 a[248:249], v5 offset:26624
    ds_read_b64_tr_b16 a[250:251], v5 offset:32768
    v_mfma_f32_16x16x32_bf16 v[188:191], a[252:255], v[112:115], v[188:191]
    buffer_load_dwordx4 v9, s[20:23], s28 offen offset:2048 lds
    v_mfma_f32_16x16x32_bf16 v[236:239], a[252:255], v[116:119], v[236:239]
    s_add_u32 m0, s33, s32
    v_exp_f32 v149, v45
    v_mfma_f32_16x16x32_bf16 a[28:31], a[252:255], v[120:123], a[28:31]
    v_exp_f32 v150, v46
    v_mfma_f32_16x16x32_bf16 a[76:79], a[252:255], v[124:127], a[76:79]
    s_waitcnt lgkmcnt(2)
    ds_read_b64_tr_b16 a[252:253], v6 offset:26624
    ds_read_b64_tr_b16 a[254:255], v6 offset:32768
    v_mfma_f32_16x16x32_bf16 v[192:195], a[240:243], v[112:115], v[192:195]
    v_exp_f32 v151, v47
    v_mfma_f32_16x16x32_bf16 v[240:243], a[240:243], v[116:119], v[240:243]
    v_cvt_pk_bf16_f32 v99, v144, v145
    v_cvt_pk_bf16_f32 v101, v146, v147
    v_mfma_f32_16x16x32_bf16 a[32:35], a[240:243], v[120:123], a[32:35]
    v_cvt_pk_bf16_f32 v102, v148, v149
    v_cvt_pk_bf16_f32 v103, v150, v151
    v_mfma_f32_16x16x32_bf16 a[80:83], a[240:243], v[124:127], a[80:83]
    v_fma_f32 v49, v49, s36, v18
    v_fma_f32 v50, v50, s36, v18
    v_mfma_f32_16x16x32_bf16 v[196:199], a[244:247], v[112:115], v[196:199]
    v_fma_f32 v51, v51, s36, v18
    v_fma_f32 v52, v52, s36, v18
    v_mfma_f32_16x16x32_bf16 v[244:247], a[244:247], v[116:119], v[244:247]
    v_fma_f32 v53, v53, s36, v18
    v_fma_f32 v54, v54, s36, v18
    v_mfma_f32_16x16x32_bf16 a[36:39], a[244:247], v[120:123], a[36:39]
    v_fma_f32 v55, v55, s36, v18
    v_fma_f32 v56, v56, s36, v19
    v_mfma_f32_16x16x32_bf16 a[84:87], a[244:247], v[124:127], a[84:87]
    s_waitcnt lgkmcnt(1)
    v_exp_f32 v144, v48
    v_mfma_f32_16x16x32_bf16 v[200:203], a[248:251], v[112:115], v[200:203]
    buffer_load_dwordx4 v10, s[24:27], s29 offen offset:0 lds
    v_mfma_f32_16x16x32_bf16 v[248:251], a[248:251], v[116:119], v[248:251]
    v_exp_f32 v145, v49
    v_mfma_f32_16x16x32_bf16 a[40:43], a[248:251], v[120:123], a[40:43]
    v_exp_f32 v146, v50
    v_mfma_f32_16x16x32_bf16 a[88:91], a[248:251], v[124:127], a[88:91]
    s_waitcnt lgkmcnt(0)
    v_exp_f32 v147, v51
    v_mfma_f32_16x16x32_bf16 v[204:207], a[252:255], v[112:115], v[204:207]
    v_exp_f32 v148, v52
    v_mfma_f32_16x16x32_bf16 v[252:255], a[252:255], v[116:119], v[252:255]
    v_exp_f32 v149, v53
    v_mfma_f32_16x16x32_bf16 a[44:47], a[252:255], v[120:123], a[44:47]
    v_exp_f32 v150, v54
    v_mfma_f32_16x16x32_bf16 a[92:95], a[252:255], v[124:127], a[92:95]
    v_exp_f32 v151, v55
    v_mfma_f32_16x16x32_bf16 v[64:67], a[192:195], a[96:99], 0
    v_cvt_pk_bf16_f32 v104, v144, v145
    v_cvt_pk_bf16_f32 v105, v146, v147
    v_mfma_f32_16x16x32_bf16 v[64:67], a[196:199], a[100:103], v[64:67]
    v_cvt_pk_bf16_f32 v106, v148, v149
    v_cvt_pk_bf16_f32 v107, v150, v151
    v_mfma_f32_16x16x32_bf16 v[64:67], a[200:203], a[104:107], v[64:67]
    v_fma_f32 v57, v57, s36, v19
    v_fma_f32 v58, v58, s36, v19
    v_mfma_f32_16x16x32_bf16 v[64:67], a[204:207], a[108:111], v[64:67]
    v_fma_f32 v59, v59, s36, v19
    v_fma_f32 v60, v60, s36, v19
    v_mfma_f32_16x16x32_bf16 v[64:67], a[208:211], a[112:115], v[64:67]
    v_fma_f32 v61, v61, s36, v19
    v_fma_f32 v62, v62, s36, v19
    v_mfma_f32_16x16x32_bf16 v[64:67], a[212:215], a[116:119], v[64:67]
    buffer_load_dwordx4 v11, s[24:27], s29 offen offset:1024 lds
    v_mfma_f32_16x16x32_bf16 v[72:75], a[192:195], a[120:123], 0
    v_fma_f32 v63, v63, s36, v19
    v_add_f32 v20, v20, v128
    v_mfma_f32_16x16x32_bf16 v[128:131], v[24:27], v[96:99], 0
    v_exp_f32 v144, v56
    v_mfma_f32_16x16x32_bf16 v[72:75], a[196:199], a[124:127], v[72:75]
    v_exp_f32 v145, v57
    v_mfma_f32_16x16x32_bf16 v[72:75], a[200:203], a[128:131], v[72:75]
    v_exp_f32 v146, v58
    v_mfma_f32_16x16x32_bf16 v[72:75], a[204:207], a[132:135], v[72:75]
    v_exp_f32 v147, v59
    v_mfma_f32_16x16x32_bf16 v[72:75], a[208:211], a[136:139], v[72:75]
    v_exp_f32 v148, v60
    v_mfma_f32_16x16x32_bf16 v[72:75], a[212:215], a[140:143], v[72:75]
    v_exp_f32 v149, v61
    v_mfma_f32_16x16x32_bf16 v[80:83], a[192:195], a[144:147], 0
    v_exp_f32 v150, v62
    v_mfma_f32_16x16x32_bf16 v[80:83], a[196:199], a[148:151], v[80:83]
    v_exp_f32 v151, v63
    v_mfma_f32_16x16x32_bf16 v[80:83], a[200:203], a[152:155], v[80:83]
    v_cvt_pk_bf16_f32 v108, v144, v145
    v_cvt_pk_bf16_f32 v109, v146, v147
    v_mfma_f32_16x16x32_bf16 v[80:83], a[204:207], a[156:159], v[80:83]
    v_cvt_pk_bf16_f32 v110, v148, v149
    v_cvt_pk_bf16_f32 v111, v150, v151
    v_mfma_f32_16x16x32_bf16 v[80:83], a[208:211], a[160:163], v[80:83]
    buffer_load_dwordx4 v12, s[24:27], s29 offen offset:2048 lds
    v_mfma_f32_16x16x32_bf16 v[80:83], a[212:215], a[164:167], v[80:83]
    s_add_u32 s28, s28, s30
    v_add_f32 v21, v21, v132
    v_add_f32 v22, v22, v136
    v_mfma_f32_16x16x32_bf16 v[132:135], v[24:27], v[100:103], 0
    s_add_u32 s29, s29, s30
    v_add_f32 v23, v23, v140
    v_add_u32 v3, s58, v3
    v_mfma_f32_16x16x32_bf16 v[136:139], v[24:27], v[104:107], 0
    s_add_u32 s33, s33, 24576
    v_add_u32 v4, s58, v4
    v_add_u32 v5, s58, v5
    v_mfma_f32_16x16x32_bf16 v[140:143], v[24:27], v[108:111], 0
    s_cmp_eq_u32 s33, 147456
    v_add_u32 v6, s58, v6
    v_add_u32 v1, s58, v1
    v_mfma_f32_16x16x32_bf16 v[88:91], a[192:195], a[168:171], 0
    s_cselect_b32 s33, 0, s33
    v_max3_f32 v30, v128, v132, v136
    v_add_u32 v2, s58, v2
    v_mfma_f32_16x16x32_bf16 v[88:91], a[196:199], a[172:175], v[88:91]
    v_max_f32 v30, v30, v140
    v_cmp_lt_f32 vcc, s37, v30
    v_mfma_f32_16x16x32_bf16 v[88:91], a[200:203], a[176:179], v[88:91]
    v_mfma_f32_16x16x32_bf16 v[88:91], a[204:207], a[180:183], v[88:91]
    v_mfma_f32_16x16x32_bf16 v[88:91], a[208:211], a[184:187], v[88:91]
    v_mfma_f32_16x16x32_bf16 v[88:91], a[212:215], a[188:191], v[88:91]
    v_mfma_f32_16x16x32_bf16 v[68:71], a[216:219], a[96:99], 0
    s_cbranch_vccnz L_rs_start4b
L_ret_start4b:
    v_fma_f32 v64, v64, s36, v16
    v_fma_f32 v65, v65, s36, v16
    v_mfma_f32_16x16x32_bf16 v[68:71], a[220:223], a[100:103], v[68:71]
    v_fma_f32 v66, v66, s36, v16
    v_fma_f32 v67, v67, s36, v16
    v_mfma_f32_16x16x32_bf16 v[68:71], a[224:227], a[104:107], v[68:71]
    v_fma_f32 v72, v72, s36, v17
    v_fma_f32 v73, v73, s36, v17
    v_mfma_f32_16x16x32_bf16 v[68:71], a[228:231], a[108:111], v[68:71]
    v_exp_f32 v144, v64
    v_mfma_f32_16x16x32_bf16 v[68:71], a[232:235], a[112:115], v[68:71]
    v_exp_f32 v145, v65
    v_mfma_f32_16x16x32_bf16 v[68:71], a[236:239], a[116:119], v[68:71]
    v_exp_f32 v146, v66
    v_mfma_f32_16x16x32_bf16 v[76:79], a[216:219], a[120:123], 0
    v_exp_f32 v147, v67
    v_mfma_f32_16x16x32_bf16 v[76:79], a[220:223], a[124:127], v[76:79]
    v_exp_f32 v148, v72
    v_mfma_f32_16x16x32_bf16 v[76:79], a[224:227], a[128:131], v[76:79]
    v_exp_f32 v149, v73
    v_mfma_f32_16x16x32_bf16 v[76:79], a[228:231], a[132:135], v[76:79]
    v_cvt_pk_bf16_f32 v112, v144, v145
    v_cvt_pk_bf16_f32 v113, v146, v147
    s_waitcnt vmcnt(18)
    s_barrier
    v_mfma_f32_16x16x32_bf16 v[76:79], a[232:235], a[136:139], v[76:79]
    v_cvt_pk_bf16_f32 v116, v148, v149
    v_mfma_f32_16x16x32_bf16 v[76:79], a[236:239], a[140:143], v[76:79]
    ds_read_b64_tr_b16 a[240:241], v3 offset:0
    ds_read_b64_tr_b16 a[242:243], v3 offset:6144
    v_mfma_f32_16x16x32_bf16 v[84:87], a[216:219], a[144:147], 0
    v_mfma_f32_16x16x32_bf16 v[84:87], a[220:223], a[148:151], v[84:87]
    ds_read_b64_tr_b16 a[244:245], v4 offset:0
    ds_read_b64_tr_b16 a[246:247], v4 offset:6144
    v_mfma_f32_16x16x32_bf16 v[84:87], a[224:227], a[152:155], v[84:87]
    v_mfma_f32_16x16x32_bf16 v[84:87], a[228:231], a[156:159], v[84:87]
    ds_read_b64_tr_b16 a[248:249], v5 offset:0
    ds_read_b64_tr_b16 a[250:251], v5 offset:6144
    v_mfma_f32_16x16x32_bf16 v[84:87], a[232:235], a[160:163], v[84:87]
    v_mfma_f32_16x16x32_bf16 v[84:87], a[236:239], a[164:167], v[84:87]
    ds_read_b64_tr_b16 a[252:253], v6 offset:0
    ds_read_b64_tr_b16 a[254:255], v6 offset:6144
    v_mfma_f32_16x16x32_bf16 v[92:95], a[216:219], a[168:171], 0
    v_mfma_f32_16x16x32_bf16 v[92:95], a[220:223], a[172:175], v[92:95]
    v_mfma_f32_16x16x32_bf16 v[92:95], a[224:227], a[176:179], v[92:95]
    v_mfma_f32_16x16x32_bf16 v[92:95], a[228:231], a[180:183], v[92:95]
    v_mfma_f32_16x16x32_bf16 v[92:95], a[232:235], a[184:187], v[92:95]
    v_mfma_f32_16x16x32_bf16 v[92:95], a[236:239], a[188:191], v[92:95]
    s_mov_b32 s38, 0
    s_branch L_loop4
L_start3:
    v_xor_b32 v156, 80, v7
    v_xor_b32 v157, 80, v8
    v_xor_b32 v158, 80, v9
    s_add_u32 m0, s31, 98304
    s_nop 0
    buffer_load_dwordx4 v7, s[4:7], s28 offen offset:0 lds
    buffer_load_dwordx4 v8, s[4:7], s28 offen offset:1024 lds
    buffer_load_dwordx4 v9, s[4:7], s28 offen offset:2048 lds
    s_add_u32 s28, s28, 12288
    s_mov_b32 s41, s42
    s_mov_b32 s65, 24576
    s_and_b32 s63, s3, 1
    s_mul_i32 s63, s63, 3072
    s_add_u32 s67, s41, 0
    s_add_u32 s68, s67, s63
    s_add_u32 s64, s65, s35
    s_add_u32 s64, s64, 0
    s_add_u32 m0, s64, s63
    s_nop 0
    buffer_load_dwordx4 v7, s[12:15], s68 offen offset:0 nt lds
    buffer_load_dwordx4 v8, s[12:15], s68 offen offset:1024 nt lds
    buffer_load_dwordx4 v9, s[12:15], s68 offen offset:2048 nt lds
    s_sub_u32 s63, 3072, s63
    s_add_u32 s68, s67, s63
    s_add_u32 m0, s64, s63
    s_nop 0
    buffer_load_dwordx4 v156, s[12:15], s68 offen offset:0 nt lds
    buffer_load_dwordx4 v157, s[12:15], s68 offen offset:1024 nt lds
    buffer_load_dwordx4 v158, s[12:15], s68 offen offset:2048 nt lds
    s_mov_b32 s65, 49152
    s_and_b32 s63, s3, 1
    s_mul_i32 s63, s63, 3072
    s_add_u32 s67, s41, 6144
    s_add_u32 s68, s67, s63
    s_add_u32 s64, s65, s35
    s_add_u32 s64, s64, 0
    s_add_u32 m0, s64, s63
    s_nop 0
    buffer_load_dwordx4 v7, s[12:15], s68 offen offset:0 nt lds
    buffer_load_dwordx4 v8, s[12:15], s68 offen offset:1024 nt lds
    buffer_load_dwordx4 v9, s[12:15], s68 offen offset:2048 nt lds
    s_sub_u32 s63, 3072, s63
    s_add_u32 s68, s67, s63
    s_add_u32 m0, s64, s63
    s_nop 0
    buffer_load_dwordx4 v156, s[12:15], s68 offen offset:0 nt lds
    buffer_load_dwordx4 v157, s[12:15], s68 offen offset:1024 nt lds
    buffer_load_dwordx4 v158, s[12:15], s68 offen offset:2048 nt lds
    v_and_b32 v144, 15, v0
    v_lshrrev_b32 v145, 4, v0
    v_lshrrev_b32 v146, 3, v144
    v_mul_u32_u24 v1, 3072, v146
    v_and_b32 v147, 7, v144
    v_lshl_add_u32 v1, v147, 7, v1
    v_bfe_u32 v147, v144, 1, 2
    v_lshlrev_b32 v147, 1, v147
    v_mul_u32_u24 v148, 5, v146
    v_xor_b32 v147, v147, v148
    v_xor_b32 v147, v147, v145
    v_lshl_add_u32 v1, v147, 4, v1
    v_lshrrev_b32 v146, 1, v145
    v_mul_u32_u24 v3, 3072, v146
    v_and_b32 v147, 1, v145
    v_bfe_u32 v148, v0, 2, 2
    v_lshl_add_u32 v144, v147, 2, v148
    v_lshl_add_u32 v3, v144, 7, v3
    v_lshrrev_b32 v144, 1, v144
    v_lshlrev_b32 v144, 1, v144
    v_mul_u32_u24 v146, 5, v146
    v_xor_b32 v144, v144, v146
    v_bfe_u32 v147, v0, 1, 1
    v_xor_b32 v144, v144, v147
    v_lshl_add_u32 v3, v144, 4, v3
    v_and_b32 v147, 1, v0
    v_lshl_add_u32 v3, v147, 3, v3
    v_add_u32 v3, 12288, v3
    v_lshrrev_b32 v144, 3, v0
    v_and_b32 v145, 15, v0
    v_lshrrev_b32 v146, 4, v0
    v_lshrrev_b32 v147, 1, v146
    v_and_b32 v148, 7, v145
    v_xor_b32 v147, v147, v148
    v_lshlrev_b32 v15, 7, v145
    v_lshl_add_u32 v15, v147, 4, v15
    v_and_b32 v146, 1, v146
    v_lshl_add_u32 v15, v146, 3, v15
    s_lshl_b32 s63, s3, 12
    s_add_u32 s63, s63, 147456
    v_add_u32 v15, s63, v15
    v_and_b32 v145, 7, v0
    v_xor_b32 v146, v145, v144
    v_lshlrev_b32 v14, 7, v144
    v_lshl_add_u32 v14, v146, 4, v14
    v_add_u32 v14, s63, v14
    v_mul_u32_u24 v13, 384, v144
    v_lshl_add_u32 v13, v145, 4, v13
    v_mov_b32 v24, 0x3f803f80
    v_mov_b32 v25, 0x3f803f80
    v_mov_b32 v26, 0x3f803f80
    v_mov_b32 v27, 0x3f803f80
    v_xor_b32 v2, 64, v1
    v_xor_b32 v4, 32, v3
    v_xor_b32 v5, 64, v3
    v_xor_b32 v6, 96, v3
    v_add_u32 v28, s35, v1
    v_add_u32 v29, s35, v2
    v_add_u32 v144, s35, v1
    v_add_u32 v144, 49152, v144
    v_add_u32 v145, s35, v2
    v_add_u32 v145, 49152, v145
    v_add_u32 v146, s35, v1
    v_add_u32 v146, 98304, v146
    v_add_u32 v147, s35, v2
    v_add_u32 v147, 98304, v147
    v_add_u32 v1, 98304, v1
    v_add_u32 v2, 98304, v2
    s_mov_b32 s34, 98304
    s_mov_b32 s33, 0
    s_waitcnt vmcnt(12)
    s_barrier
    ds_read_b128 a[192:195], v1 offset:0
    ds_read_b128 a[196:199], v2 offset:0
    ds_read_b128 a[200:203], v1 offset:1024
    ds_read_b128 a[204:207], v2 offset:1024
    ds_read_b128 a[208:211], v1 offset:2048
    ds_read_b128 a[212:215], v2 offset:2048
    ds_read_b128 a[216:219], v1 offset:6144
    ds_read_b128 a[220:223], v2 offset:6144
    ds_read_b128 a[224:227], v1 offset:7168
    ds_read_b128 a[228:231], v2 offset:7168
    ds_read_b128 a[232:235], v1 offset:8192
    ds_read_b128 a[236:239], v2 offset:8192
    s_waitcnt vmcnt(6)
    ds_read_b128 a[96:99], v28 offset:24576
    s_mov_b32 s65, 73728
    s_and_b32 s63, s3, 1
    s_mul_i32 s63, s63, 3072
    s_add_u32 s67, s41, 12288
    s_add_u32 s68, s67, s63
    s_add_u32 s64, s65, s35
    s_add_u32 s64, s64, 0
    s_add_u32 m0, s64, s63
    ds_read_b128 a[100:103], v29 offset:24576
    ds_read_b128 a[104:107], v28 offset:25600
    ds_read_b128 a[108:111], v29 offset:25600
    ds_read_b128 a[112:115], v28 offset:26624
    ds_read_b128 a[116:119], v29 offset:26624
    s_waitcnt lgkmcnt(5)
    v_mfma_f32_16x16x32_bf16 v[32:35], a[192:195], a[96:99], 0
    buffer_load_dwordx4 v7, s[12:15], s68 offen offset:0 nt lds
    s_waitcnt lgkmcnt(4)
    v_mfma_f32_16x16x32_bf16 v[32:35], a[196:199], a[100:103], v[32:35]
    buffer_load_dwordx4 v8, s[12:15], s68 offen offset:1024 nt lds
    s_waitcnt lgkmcnt(3)
    v_mfma_f32_16x16x32_bf16 v[32:35], a[200:203], a[104:107], v[32:35]
    buffer_load_dwordx4 v9, s[12:15], s68 offen offset:2048 nt lds
    s_sub_u32 s63, 3072, s63
    s_add_u32 s68, s67, s63
    s_add_u32 m0, s64, s63
    s_waitcnt lgkmcnt(2)
    v_mfma_f32_16x16x32_bf16 v[32:35], a[204:207], a[108:111], v[32:35]
    buffer_load_dwordx4 v156, s[12:15], s68 offen offset:0 nt lds
    s_waitcnt lgkmcnt(1)
    v_mfma_f32_16x16x32_bf16 v[32:35], a[208:211], a[112:115], v[32:35]
    buffer_load_dwordx4 v157, s[12:15], s68 offen offset:1024 nt lds
    s_waitcnt lgkmcnt(0)
    v_mfma_f32_16x16x32_bf16 v[32:35], a[212:215], a[116:119], v[32:35]
    buffer_load_dwordx4 v158, s[12:15], s68 offen offset:2048 nt lds
    s_add_u32 m0, s31, 110592
    v_mfma_f32_16x16x32_bf16 v[36:39], a[216:219], a[96:99], 0
    v_mfma_f32_16x16x32_bf16 v[36:39], a[220:223], a[100:103], v[36:39]
    v_mfma_f32_16x16x32_bf16 v[36:39], a[224:227], a[104:107], v[36:39]
    v_mfma_f32_16x16x32_bf16 v[36:39], a[228:231], a[108:111], v[36:39]
    v_mfma_f32_16x16x32_bf16 v[36:39], a[232:235], a[112:115], v[36:39]
    v_mfma_f32_16x16x32_bf16 v[36:39], a[236:239], a[116:119], v[36:39]
    s_waitcnt vmcnt(6)
    ds_read_b128 a[120:123], v144 offset:0
    ds_read_b128 a[124:127], v145 offset:0
    ds_read_b128 a[128:131], v144 offset:1024
    ds_read_b128 a[132:135], v145 offset:1024
    ds_read_b128 a[136:139], v144 offset:2048
    ds_read_b128 a[140:143], v145 offset:2048
    s_waitcnt lgkmcnt(5)
    v_mfma_f32_16x16x32_bf16 v[40:43], a[192:195], a[120:123], 0
    buffer_load_dwordx4 v7, s[4:7], s28 offen offset:0 lds
    s_waitcnt lgkmcnt(4)
    v_mfma_f32_16x16x32_bf16 v[40:43], a[196:199], a[124:127], v[40:43]
    buffer_load_dwordx4 v8, s[4:7], s28 offen offset:1024 lds
    s_waitcnt lgkmcnt(3)
    v_mfma_f32_16x16x32_bf16 v[40:43], a[200:203], a[128:131], v[40:43]
    buffer_load_dwordx4 v9, s[4:7], s28 offen offset:2048 lds
    s_add_u32 s28, s28, 12288
    s_add_u32 m0, s33, s31
    s_waitcnt lgkmcnt(2)
    v_mfma_f32_16x16x32_bf16 v[40:43], a[204:207], a[132:135], v[40:43]
    s_waitcnt lgkmcnt(1)
    v_mfma_f32_16x16x32_bf16 v[40:43], a[208:211], a[136:139], v[40:43]
    s_waitcnt lgkmcnt(0)
    v_mfma_f32_16x16x32_bf16 v[40:43], a[212:215], a[140:143], v[40:43]
    v_mfma_f32_16x16x32_bf16 v[44:47], a[216:219], a[120:123], 0
    v_mfma_f32_16x16x32_bf16 v[44:47], a[220:223], a[124:127], v[44:47]
    v_mfma_f32_16x16x32_bf16 v[44:47], a[224:227], a[128:131], v[44:47]
    v_mfma_f32_16x16x32_bf16 v[44:47], a[228:231], a[132:135], v[44:47]
    v_mfma_f32_16x16x32_bf16 v[44:47], a[232:235], a[136:139], v[44:47]
    v_mfma_f32_16x16x32_bf16 v[44:47], a[236:239], a[140:143], v[44:47]
    s_waitcnt vmcnt(3)
    ds_read_b128 a[144:147], v144 offset:24576
    ds_read_b128 a[148:151], v145 offset:24576
    ds_read_b128 a[152:155], v144 offset:25600
    ds_read_b128 a[156:159], v145 offset:25600
    ds_read_b128 a[160:163], v144 offset:26624
    ds_read_b128 a[164:167], v145 offset:26624
    s_waitcnt lgkmcnt(5)
    v_mfma_f32_16x16x32_bf16 v[48:51], a[192:195], a[144:147], 0
    buffer_load_dwordx4 v7, s[20:23], s28 offen offset:0 lds
    s_waitcnt lgkmcnt(4)
    v_mfma_f32_16x16x32_bf16 v[48:51], a[196:199], a[148:151], v[48:51]
    buffer_load_dwordx4 v8, s[20:23], s28 offen offset:1024 lds
    s_waitcnt lgkmcnt(3)
    v_mfma_f32_16x16x32_bf16 v[48:51], a[200:203], a[152:155], v[48:51]
    buffer_load_dwordx4 v9, s[20:23], s28 offen offset:2048 lds
    s_add_u32 m0, s33, s32
    s_waitcnt lgkmcnt(2)
    v_mfma_f32_16x16x32_bf16 v[48:51], a[204:207], a[156:159], v[48:51]
    buffer_load_dwordx4 v10, s[24:27], s29 offen offset:0 lds
    s_waitcnt lgkmcnt(1)
    v_mfma_f32_16x16x32_bf16 v[48:51], a[208:211], a[160:163], v[48:51]
    buffer_load_dwordx4 v11, s[24:27], s29 offen offset:1024 lds
    s_waitcnt lgkmcnt(0)
    v_mfma_f32_16x16x32_bf16 v[48:51], a[212:215], a[164:167], v[48:51]
    buffer_load_dwordx4 v12, s[24:27], s29 offen offset:2048 lds
    s_add_u32 s28, s28, s30
    s_add_u32 s29, s29, s30
    s_add_u32 s33, s33, 24576
    s_cmp_eq_u32 s33, 147456
    s_cselect_b32 s33, 0, s33
    v_mfma_f32_16x16x32_bf16 v[52:55], a[216:219], a[144:147], 0
    s_add_u32 s62, s34, 49152
    s_cmp_eq_u32 s62, 147456
    s_cselect_b32 s62, 0, s62
    v_mfma_f32_16x16x32_bf16 v[52:55], a[220:223], a[148:151], v[52:55]
    s_sub_u32 s57, s62, s34
    s_mov_b32 s34, s62
    v_mfma_f32_16x16x32_bf16 v[52:55], a[224:227], a[152:155], v[52:55]
    v_mfma_f32_16x16x32_bf16 v[52:55], a[228:231], a[156:159], v[52:55]
    v_mfma_f32_16x16x32_bf16 v[52:55], a[232:235], a[160:163], v[52:55]
    v_mfma_f32_16x16x32_bf16 v[52:55], a[236:239], a[164:167], v[52:55]
    s_waitcnt vmcnt(6)
    s_barrier
    ds_read_b128 a[192:195], v1 offset:12288
    ds_read_b128 a[196:199], v2 offset:12288
    ds_read_b128 a[200:203], v1 offset:13312
    ds_read_b128 a[204:207], v2 offset:13312
    ds_read_b128 a[208:211], v1 offset:14336
    ds_read_b128 a[212:215], v2 offset:14336
    ds_read_b128 a[216:219], v1 offset:18432
    ds_read_b128 a[220:223], v2 offset:18432
    ds_read_b128 a[224:227], v1 offset:19456
    ds_read_b128 a[228:231], v2 offset:19456
    ds_read_b128 a[232:235], v1 offset:20480
    ds_read_b128 a[236:239], v2 offset:20480
    v_max3_f32 v152, v32, v33, v34
    v_max3_f32 v152, v152, v35, v36
    v_max3_f32 v152, v152, v37, v38
    v_max_f32 v152, v152, v39
    v_max3_f32 v154, v40, v41, v42
    v_mov_b32 v153, v152
    v_max3_f32 v154, v154, v43, v44
    v_max3_f32 v154, v154, v45, v46
    v_permlane32_swap_b32 v153, v152
    v_max_f32 v152, v152, v153
    v_max_f32 v154, v154, v47
    v_mov_b32 v153, v152
    v_mov_b32 v155, v154
    v_add_u32 v1, s57, v1
    v_permlane16_swap_b32 v153, v152
    v_permlane32_swap_b32 v155, v154
    v_max_f32 v152, v152, v153
    v_max_f32 v154, v154, v155
    v_mul_f32_e64 v16, -s36, v152
    v_mov_b32 v155, v154
    s_waitcnt lgkmcnt(11)
    v_mfma_f32_16x16x32_bf16 v[64:67], a[192:195], a[96:99], 0
    s_add_u32 s69, s69, 1
    v_permlane16_swap_b32 v155, v154
    s_waitcnt lgkmcnt(6)
    v_mfma_f32_16x16x32_bf16 v[64:67], a[196:199], a[100:103], v[64:67]
    s_add_u32 s48, s48, 325632
    v_max3_f32 v152, v48, v49, v50
    v_max_f32 v154, v154, v155
    v_mfma_f32_16x16x32_bf16 v[64:67], a[200:203], a[104:107], v[64:67]
    s_lshr_b32 s62, s39, s69
    v_max3_f32 v152, v152, v51, v52
    v_mul_f32_e64 v17, -s36, v154
    v_mfma_f32_16x16x32_bf16 v[64:67], a[204:207], a[108:111], v[64:67]
    s_and_b32 s62, s62, 1
    v_max3_f32 v152, v152, v53, v54
    v_max_f32 v152, v152, v55
    v_mfma_f32_16x16x32_bf16 v[64:67], a[208:211], a[112:115], v[64:67]
    s_lshl_b32 s62, s62, 1
    v_fma_f32 v32, v32, s36, v16
    v_fma_f32 v33, v33, s36, v16
    v_mfma_f32_16x16x32_bf16 v[64:67], a[212:215], a[116:119], v[64:67]
    s_add_u32 s62, s62, s49
    v_fma_f32 v34, v34, s36, v16
    v_fma_f32 v35, v35, s36, v16
    v_mfma_f32_16x16x32_bf16 v[72:75], a[192:195], a[120:123], 0
    s_and_b32 s62, s62, 3
    v_fma_f32 v40, v40, s36, v17
    v_fma_f32 v41, v41, s36, v17
    v_mfma_f32_16x16x32_bf16 v[72:75], a[196:199], a[124:127], v[72:75]
    s_add_u32 s63, s69, 8
    v_fma_f32 v36, v36, s36, v16
    v_fma_f32 v37, v37, s36, v16
    v_mfma_f32_16x16x32_bf16 v[72:75], a[200:203], a[128:131], v[72:75]
    s_lshr_b32 s63, s39, s63
    v_mov_b32 v153, v152
    v_fma_f32 v38, v38, s36, v16
    v_mfma_f32_16x16x32_bf16 v[72:75], a[204:207], a[132:135], v[72:75]
    s_and_b32 s63, s63, 1
    v_exp_f32 v144, v32
    v_mfma_f32_16x16x32_bf16 v[72:75], a[208:211], a[136:139], v[72:75]
    s_xor_b32 s62, s62, s63
    v_exp_f32 v145, v33
    v_mfma_f32_16x16x32_bf16 v[72:75], a[212:215], a[140:143], v[72:75]
    s_mul_i32 s63, s3, 3
    v_exp_f32 v146, v34
    v_mfma_f32_16x16x32_bf16 v[80:83], a[192:195], a[144:147], 0
    s_lshl_b32 s64, s3, 2
    v_exp_f32 v147, v35
    v_mfma_f32_16x16x32_bf16 v[80:83], a[196:199], a[148:151], v[80:83]
    s_mov_b32 s40, 1
    v_exp_f32 v148, v40
    v_mfma_f32_16x16x32_bf16 v[80:83], a[200:203], a[152:155], v[80:83]
    s_add_u32 s65, s63, 17
    v_exp_f32 v149, v41
    v_mfma_f32_16x16x32_bf16 v[80:83], a[204:207], a[156:159], v[80:83]
    s_cmp_eq_u32 s3, 0
    v_exp_f32 v150, v36
    v_mfma_f32_16x16x32_bf16 v[80:83], a[208:211], a[160:163], v[80:83]
    s_cselect_b32 s65, 16, s65
    v_exp_f32 v151, v37
    v_mfma_f32_16x16x32_bf16 v[80:83], a[212:215], a[164:167], v[80:83]
    s_cselect_b32 s41, 1, 0
    v_permlane32_swap_b32 v153, v152
    s_waitcnt lgkmcnt(0)
    v_mfma_f32_16x16x32_bf16 v[68:71], a[216:219], a[96:99], 0
    s_cmp_eq_u32 s62, 1
    v_max_f32 v152, v152, v153
    s_cselect_b32 s64, s65, s64
    v_mfma_f32_16x16x32_bf16 v[68:71], a[220:223], a[100:103], v[68:71]
    s_cselect_b32 s40, s41, s40
    s_add_u32 s65, s63, 29
    s_cmp_eq_u32 s62, 2
    v_mfma_f32_16x16x32_bf16 v[68:71], a[224:227], a[104:107], v[68:71]
    s_cselect_b32 s64, s65, s64
    s_cselect_b32 s40, 0, s40
    s_add_u32 s65, s63, 41
    v_mfma_f32_16x16x32_bf16 v[68:71], a[228:231], a[108:111], v[68:71]
    s_cmp_eq_u32 s62, 3
    s_cselect_b32 s64, s65, s64
    s_cselect_b32 s40, 0, s40
    v_mfma_f32_16x16x32_bf16 v[68:71], a[232:235], a[112:115], v[68:71]
    s_mul_i32 s64, s64, 6144
    s_add_u32 s41, s48, s64
    s_cmp_ge_u32 s69, 8
    v_mfma_f32_16x16x32_bf16 v[68:71], a[236:239], a[116:119], v[68:71]
    s_cselect_b32 s41, 166725632, s41
    s_add_u32 m0, s33, s31
    v_mov_b32 v153, v152
    v_mfma_f32_16x16x32_bf16 v[76:79], a[216:219], a[120:123], 0
    buffer_load_dwordx4 v7, s[20:23], s28 offen offset:0 lds
    v_mfma_f32_16x16x32_bf16 v[76:79], a[220:223], a[124:127], v[76:79]
    buffer_load_dwordx4 v8, s[20:23], s28 offen offset:1024 lds
    v_mfma_f32_16x16x32_bf16 v[76:79], a[224:227], a[128:131], v[76:79]
    buffer_load_dwordx4 v9, s[20:23], s28 offen offset:2048 lds
    s_add_u32 m0, s33, s32
    v_mfma_f32_16x16x32_bf16 v[76:79], a[228:231], a[132:135], v[76:79]
    buffer_load_dwordx4 v10, s[24:27], s29 offen offset:0 lds
    v_mfma_f32_16x16x32_bf16 v[76:79], a[232:235], a[136:139], v[76:79]
    buffer_load_dwordx4 v11, s[24:27], s29 offen offset:1024 lds
    v_mfma_f32_16x16x32_bf16 v[76:79], a[236:239], a[140:143], v[76:79]
    buffer_load_dwordx4 v12, s[24:27], s29 offen offset:2048 lds
    s_add_u32 s28, s28, s30
    s_add_u32 s29, s29, s30
    v_mfma_f32_16x16x32_bf16 v[84:87], a[216:219], a[144:147], 0
    s_add_u32 s33, s33, 24576
    s_cmp_eq_u32 s33, 147456
    s_cselect_b32 s33, 0, s33
    v_mfma_f32_16x16x32_bf16 v[84:87], a[220:223], a[148:151], v[84:87]
    s_add_u32 m0, s33, s31
    v_cvt_pk_bf16_f32 v96, v144, v145
    v_cvt_pk_bf16_f32 v97, v146, v147
    v_mfma_f32_16x16x32_bf16 v[84:87], a[224:227], a[152:155], v[84:87]
    buffer_load_dwordx4 v7, s[20:23], s28 offen offset:0 lds
    v_mfma_f32_16x16x32_bf16 v[84:87], a[228:231], a[156:159], v[84:87]
    buffer_load_dwordx4 v8, s[20:23], s28 offen offset:1024 lds
    v_mfma_f32_16x16x32_bf16 v[84:87], a[232:235], a[160:163], v[84:87]
    buffer_load_dwordx4 v9, s[20:23], s28 offen offset:2048 lds
    s_add_u32 m0, s33, s32
    v_mfma_f32_16x16x32_bf16 v[84:87], a[236:239], a[164:167], v[84:87]
    buffer_load_dwordx4 v10, s[24:27], s29 offen offset:0 lds
    buffer_load_dwordx4 v11, s[24:27], s29 offen offset:1024 lds
    buffer_load_dwordx4 v12, s[24:27], s29 offen offset:2048 lds
    s_add_u32 s28, s28, s30
    s_add_u32 s29, s29, s30
    s_add_u32 s33, s33, 24576
    s_cmp_eq_u32 s33, 147456
    v_cvt_pk_bf16_f32 v100, v148, v149
    v_cvt_pk_bf16_f32 v98, v150, v151
    v_fma_f32 v39, v39, s36, v16
    v_fma_f32 v42, v42, s36, v17
    v_fma_f32 v43, v43, s36, v17
    v_fma_f32 v44, v44, s36, v17
    v_fma_f32 v45, v45, s36, v17
    v_fma_f32 v46, v46, s36, v17
    v_fma_f32 v47, v47, s36, v17
    s_cselect_b32 s33, 0, s33
    v_permlane16_swap_b32 v153, v152
    v_exp_f32 v144, v38
    v_exp_f32 v145, v39
    v_exp_f32 v146, v42
    v_exp_f32 v147, v43
    v_exp_f32 v148, v44
    v_exp_f32 v149, v45
    v_exp_f32 v150, v46
    v_exp_f32 v151, v47
    s_add_u32 m0, s33, s31
    v_max_f32 v152, v152, v153
    v_mul_f32_e64 v18, -s36, v152
    v_cvt_pk_bf16_f32 v99, v144, v145
    buffer_load_dwordx4 v7, s[20:23], s28 offen offset:0 lds
    buffer_load_dwordx4 v8, s[20:23], s28 offen offset:1024 lds
    v_mfma_f32_16x16x32_bf16 v[128:131], v[24:27], v[96:99], 0
    buffer_load_dwordx4 v9, s[20:23], s28 offen offset:2048 lds
    s_add_u32 m0, s33, s32
    v_cvt_pk_bf16_f32 v101, v146, v147
    v_cvt_pk_bf16_f32 v102, v148, v149
    v_cvt_pk_bf16_f32 v103, v150, v151
    buffer_load_dwordx4 v10, s[24:27], s29 offen offset:0 lds
    buffer_load_dwordx4 v11, s[24:27], s29 offen offset:1024 lds
    v_mfma_f32_16x16x32_bf16 v[132:135], v[24:27], v[100:103], 0
    buffer_load_dwordx4 v12, s[24:27], s29 offen offset:2048 lds
    s_waitcnt vmcnt(18)
    s_barrier
    ds_read_b64_tr_b16 a[240:241], v3 offset:0
    ds_read_b64_tr_b16 a[242:243], v3 offset:6144
    ds_read_b64_tr_b16 a[244:245], v4 offset:0
    ds_read_b64_tr_b16 a[246:247], v4 offset:6144
    v_fma_f32 v48, v48, s36, v18
    v_fma_f32 v49, v49, s36, v18
    v_fma_f32 v50, v50, s36, v18
    v_fma_f32 v51, v51, s36, v18
    v_fma_f32 v52, v52, s36, v18
    v_fma_f32 v53, v53, s36, v18
    v_fma_f32 v54, v54, s36, v18
    v_fma_f32 v55, v55, s36, v18
    v_exp_f32 v144, v48
    v_exp_f32 v145, v49
    v_exp_f32 v146, v50
    v_exp_f32 v147, v51
    v_exp_f32 v148, v52
    v_exp_f32 v149, v53
    v_exp_f32 v150, v54
    v_exp_f32 v151, v55
    v_cvt_pk_bf16_f32 v104, v144, v145
    v_cvt_pk_bf16_f32 v105, v146, v147
    v_cvt_pk_bf16_f32 v106, v148, v149
    v_cvt_pk_bf16_f32 v107, v150, v151
    ds_read_b64_tr_b16 a[248:249], v5 offset:0
    ds_read_b64_tr_b16 a[250:251], v5 offset:6144
    v_mfma_f32_16x16x32_bf16 v[136:139], v[24:27], v[104:107], 0
    ds_read_b64_tr_b16 a[252:253], v6 offset:0
    ds_read_b64_tr_b16 a[254:255], v6 offset:6144
    s_add_u32 s28, s28, s30
    v_fma_f32 v64, v64, s36, v16
    v_fma_f32 v65, v65, s36, v16
    v_fma_f32 v66, v66, s36, v16
    v_fma_f32 v67, v67, s36, v16
    v_fma_f32 v72, v72, s36, v17
    v_fma_f32 v73, v73, s36, v17
    s_add_u32 s29, s29, s30
    v_exp_f32 v144, v64
    v_exp_f32 v145, v65
    v_exp_f32 v146, v66
    v_exp_f32 v147, v67
    v_exp_f32 v148, v72
    v_exp_f32 v149, v73
    s_add_u32 s33, s33, 24576
    s_cmp_eq_u32 s33, 147456
    s_cselect_b32 s33, 0, s33
    v_cvt_pk_bf16_f32 v112, v144, v145
    v_cvt_pk_bf16_f32 v113, v146, v147
    v_cvt_pk_bf16_f32 v116, v148, v149
    v_add_u32 v2, s57, v2
    s_waitcnt lgkmcnt(4)
    v_mfma_f32_16x16x32_bf16 v[160:163], a[240:243], v[96:99], 0
    s_add_u32 m0, s33, s31
    ds_read_b128 a[192:195], v1 offset:0
    ds_read_b128 a[196:199], v2 offset:0
    v_mfma_f32_16x16x32_bf16 v[208:211], a[240:243], v[100:103], 0
    ds_read_b128 a[200:203], v1 offset:1024
    ds_read_b128 a[204:207], v2 offset:1024
    v_mfma_f32_16x16x32_bf16 a[0:3], a[240:243], v[104:107], 0
    ds_read_b64_tr_b16 a[240:241], v3 offset:1024
    ds_read_b64_tr_b16 a[242:243], v3 offset:7168
    v_mfma_f32_16x16x32_bf16 v[164:167], a[244:247], v[96:99], 0
    buffer_load_dwordx4 v7, s[20:23], s28 offen offset:0 lds
    v_mfma_f32_16x16x32_bf16 v[212:215], a[244:247], v[100:103], 0
    ds_read_b128 a[208:211], v1 offset:2048
    ds_read_b128 a[212:215], v2 offset:2048
    v_mfma_f32_16x16x32_bf16 a[4:7], a[244:247], v[104:107], 0
    s_waitcnt lgkmcnt(8)
    ds_read_b64_tr_b16 a[244:245], v4 offset:1024
    ds_read_b64_tr_b16 a[246:247], v4 offset:7168
    v_mfma_f32_16x16x32_bf16 v[168:171], a[248:251], v[96:99], 0
    ds_read_b128 a[216:219], v1 offset:6144
    ds_read_b128 a[220:223], v2 offset:6144
    v_mfma_f32_16x16x32_bf16 v[216:219], a[248:251], v[100:103], 0
    ds_read_b128 a[224:227], v1 offset:7168
    ds_read_b128 a[228:231], v2 offset:7168
    v_mfma_f32_16x16x32_bf16 a[8:11], a[248:251], v[104:107], 0
    ds_read_b64_tr_b16 a[248:249], v5 offset:1024
    ds_read_b64_tr_b16 a[250:251], v5 offset:7168
    v_mfma_f32_16x16x32_bf16 v[172:175], a[252:255], v[96:99], 0
    ds_read_b128 a[232:235], v1 offset:8192
    ds_read_b128 a[236:239], v2 offset:8192
    v_mfma_f32_16x16x32_bf16 v[220:223], a[252:255], v[100:103], 0
    v_fma_f32 v68, v68, s36, v16
    v_fma_f32 v69, v69, s36, v16
    v_mfma_f32_16x16x32_bf16 a[12:15], a[252:255], v[104:107], 0
    s_waitcnt lgkmcnt(12)
    ds_read_b64_tr_b16 a[252:253], v6 offset:1024
    ds_read_b64_tr_b16 a[254:255], v6 offset:7168
    v_mfma_f32_16x16x32_bf16 v[176:179], a[240:243], v[96:99], 0
    buffer_load_dwordx4 v8, s[20:23], s28 offen offset:1024 lds
    v_mfma_f32_16x16x32_bf16 v[224:227], a[240:243], v[100:103], 0
    v_exp_f32 v150, v68
    v_mfma_f32_16x16x32_bf16 a[16:19], a[240:243], v[104:107], 0
    s_waitcnt lgkmcnt(8)
    ds_read_b64_tr_b16 a[240:241], v3 offset:2048
    ds_read_b64_tr_b16 a[242:243], v3 offset:8192
    v_mfma_f32_16x16x32_bf16 v[180:183], a[244:247], v[96:99], 0
    v_exp_f32 v151, v69
    v_mfma_f32_16x16x32_bf16 v[228:231], a[244:247], v[100:103], 0
    v_cvt_pk_bf16_f32 v114, v150, v151
    v_fma_f32 v70, v70, s36, v16
    v_mfma_f32_16x16x32_bf16 a[20:23], a[244:247], v[104:107], 0
    s_waitcnt lgkmcnt(4)
    ds_read_b64_tr_b16 a[244:245], v4 offset:2048
    ds_read_b64_tr_b16 a[246:247], v4 offset:8192
    v_mfma_f32_16x16x32_bf16 v[184:187], a[248:251], v[96:99], 0
    v_fma_f32 v71, v71, s36, v16
    v_fma_f32 v74, v74, s36, v17
    v_mfma_f32_16x16x32_bf16 v[232:235], a[248:251], v[100:103], 0
    v_fma_f32 v75, v75, s36, v17
    v_fma_f32 v76, v76, s36, v17
    v_mfma_f32_16x16x32_bf16 a[24:27], a[248:251], v[104:107], 0
    s_waitcnt lgkmcnt(4)
    ds_read_b64_tr_b16 a[248:249], v5 offset:2048
    ds_read_b64_tr_b16 a[250:251], v5 offset:8192
    v_mfma_f32_16x16x32_bf16 v[188:191], a[252:255], v[96:99], 0
    buffer_load_dwordx4 v9, s[20:23], s28 offen offset:2048 lds
    v_mfma_f32_16x16x32_bf16 v[236:239], a[252:255], v[100:103], 0
    s_add_u32 m0, s33, s32
    v_fma_f32 v77, v77, s36, v17
    v_fma_f32 v78, v78, s36, v17
    v_mfma_f32_16x16x32_bf16 a[28:31], a[252:255], v[104:107], 0
    s_waitcnt lgkmcnt(4)
    ds_read_b64_tr_b16 a[252:253], v6 offset:2048
    ds_read_b64_tr_b16 a[254:255], v6 offset:8192
    v_mfma_f32_16x16x32_bf16 v[192:195], a[240:243], v[96:99], 0
    v_fma_f32 v79, v79, s36, v17
    v_fma_f32 v80, v80, s36, v18
    v_mfma_f32_16x16x32_bf16 v[240:243], a[240:243], v[100:103], 0
    v_exp_f32 v144, v70
    v_mfma_f32_16x16x32_bf16 a[32:35], a[240:243], v[104:107], 0
    s_waitcnt lgkmcnt(4)
    v_exp_f32 v145, v71
    v_mfma_f32_16x16x32_bf16 v[196:199], a[244:247], v[96:99], 0
    v_exp_f32 v146, v74
    v_mfma_f32_16x16x32_bf16 v[244:247], a[244:247], v[100:103], 0
    v_exp_f32 v147, v75
    v_mfma_f32_16x16x32_bf16 a[36:39], a[244:247], v[104:107], 0
    s_waitcnt lgkmcnt(2)
    v_exp_f32 v148, v76
    v_mfma_f32_16x16x32_bf16 v[200:203], a[248:251], v[96:99], 0
    buffer_load_dwordx4 v10, s[24:27], s29 offen offset:0 lds
    v_mfma_f32_16x16x32_bf16 v[248:251], a[248:251], v[100:103], 0
    v_exp_f32 v149, v77
    v_mfma_f32_16x16x32_bf16 a[40:43], a[248:251], v[104:107], 0
    s_waitcnt lgkmcnt(0)
    v_exp_f32 v150, v78
    v_mfma_f32_16x16x32_bf16 v[204:207], a[252:255], v[96:99], 0
    v_exp_f32 v151, v79
    v_mfma_f32_16x16x32_bf16 v[252:255], a[252:255], v[100:103], 0
    v_cvt_pk_bf16_f32 v115, v144, v145
    v_cvt_pk_bf16_f32 v117, v146, v147
    v_mfma_f32_16x16x32_bf16 a[44:47], a[252:255], v[104:107], 0
    v_cvt_pk_bf16_f32 v118, v148, v149
    v_cvt_pk_bf16_f32 v119, v150, v151
    v_mfma_f32_16x16x32_bf16 v[32:35], a[192:195], a[96:99], 0
    v_fma_f32 v81, v81, s36, v18
    v_fma_f32 v82, v82, s36, v18
    v_mfma_f32_16x16x32_bf16 v[32:35], a[196:199], a[100:103], v[32:35]
    v_fma_f32 v83, v83, s36, v18
    v_fma_f32 v84, v84, s36, v18
    v_mfma_f32_16x16x32_bf16 v[32:35], a[200:203], a[104:107], v[32:35]
    v_fma_f32 v85, v85, s36, v18
    v_fma_f32 v86, v86, s36, v18
    v_mfma_f32_16x16x32_bf16 v[32:35], a[204:207], a[108:111], v[32:35]
    buffer_load_dwordx4 v11, s[24:27], s29 offen offset:1024 lds
    v_mfma_f32_16x16x32_bf16 v[32:35], a[208:211], a[112:115], v[32:35]
    v_fma_f32 v87, v87, s36, v18
    v_mov_b32 v20, v128
    v_mfma_f32_16x16x32_bf16 v[128:131], v[24:27], v[112:115], 0
    v_exp_f32 v144, v80
    v_mfma_f32_16x16x32_bf16 v[32:35], a[212:215], a[116:119], v[32:35]
    v_exp_f32 v145, v81
    v_mfma_f32_16x16x32_bf16 v[40:43], a[192:195], a[120:123], 0
    v_exp_f32 v146, v82
    v_mfma_f32_16x16x32_bf16 v[40:43], a[196:199], a[124:127], v[40:43]
    v_exp_f32 v147, v83
    v_mfma_f32_16x16x32_bf16 v[40:43], a[200:203], a[128:131], v[40:43]
    v_exp_f32 v148, v84
    v_mfma_f32_16x16x32_bf16 v[40:43], a[204:207], a[132:135], v[40:43]
    v_exp_f32 v149, v85
    v_mfma_f32_16x16x32_bf16 v[40:43], a[208:211], a[136:139], v[40:43]
    v_exp_f32 v150, v86
    v_mfma_f32_16x16x32_bf16 v[40:43], a[212:215], a[140:143], v[40:43]
    buffer_load_dwordx4 v12, s[24:27], s29 offen offset:2048 lds
    v_mfma_f32_16x16x32_bf16 v[48:51], a[192:195], a[144:147], 0
    s_add_u32 s28, s28, s30
    v_exp_f32 v151, v87
    v_mfma_f32_16x16x32_bf16 v[48:51], a[196:199], a[148:151], v[48:51]
    s_add_u32 s29, s29, s30
    v_cvt_pk_bf16_f32 v120, v144, v145
    v_cvt_pk_bf16_f32 v121, v146, v147
    v_mfma_f32_16x16x32_bf16 v[48:51], a[200:203], a[152:155], v[48:51]
    s_add_u32 s33, s33, 24576
    v_cvt_pk_bf16_f32 v122, v148, v149
    v_cvt_pk_bf16_f32 v123, v150, v151
    v_mfma_f32_16x16x32_bf16 v[48:51], a[204:207], a[156:159], v[48:51]
    s_cmp_eq_u32 s33, 147456
    v_mov_b32 v21, v132
    v_mov_b32 v22, v136
    v_mfma_f32_16x16x32_bf16 v[132:135], v[24:27], v[116:119], 0
    s_cselect_b32 s33, 0, s33
    v_mfma_f32_16x16x32_bf16 v[136:139], v[24:27], v[120:123], 0
    v_mfma_f32_16x16x32_bf16 v[48:51], a[208:211], a[160:163], v[48:51]
    v_mfma_f32_16x16x32_bf16 v[48:51], a[212:215], a[164:167], v[48:51]
    v_mfma_f32_16x16x32_bf16 v[36:39], a[216:219], a[96:99], 0
    v_mfma_f32_16x16x32_bf16 v[36:39], a[220:223], a[100:103], v[36:39]
    v_mfma_f32_16x16x32_bf16 v[36:39], a[224:227], a[104:107], v[36:39]
    v_mfma_f32_16x16x32_bf16 v[36:39], a[228:231], a[108:111], v[36:39]
    s_waitcnt vmcnt(18)
    s_barrier
    v_max3_f32 v30, v128, v132, v136
    v_cmp_lt_f32 vcc, s37, v30
    v_mfma_f32_16x16x32_bf16 v[36:39], a[232:235], a[112:115], v[36:39]
    v_mfma_f32_16x16x32_bf16 v[36:39], a[236:239], a[116:119], v[36:39]
    ds_read_b64_tr_b16 a[240:241], v3 offset:24576
    ds_read_b64_tr_b16 a[242:243], v3 offset:30720
    v_mfma_f32_16x16x32_bf16 v[44:47], a[216:219], a[120:123], 0
    s_cbranch_vccnz L_rs_start3a
L_ret_start3a:
    ds_read_b64_tr_b16 a[244:245], v4 offset:24576
    ds_read_b64_tr_b16 a[246:247], v4 offset:30720
    v_mfma_f32_16x16x32_bf16 v[44:47], a[220:223], a[124:127], v[44:47]
    v_fma_f32 v32, v32, s36, v16
    v_fma_f32 v33, v33, s36, v16
    v_mfma_f32_16x16x32_bf16 v[44:47], a[224:227], a[128:131], v[44:47]
    ds_read_b64_tr_b16 a[248:249], v5 offset:24576
    ds_read_b64_tr_b16 a[250:251], v5 offset:30720
    v_mfma_f32_16x16x32_bf16 v[44:47], a[228:231], a[132:135], v[44:47]
    ds_read_b64_tr_b16 a[252:253], v6 offset:24576
    ds_read_b64_tr_b16 a[254:255], v6 offset:30720
    v_mfma_f32_16x16x32_bf16 v[44:47], a[232:235], a[136:139], v[44:47]
    v_fma_f32 v34, v34, s36, v16
    v_fma_f32 v35, v35, s36, v16
    v_mfma_f32_16x16x32_bf16 v[44:47], a[236:239], a[140:143], v[44:47]
    v_fma_f32 v40, v40, s36, v17
    v_fma_f32 v41, v41, s36, v17
    v_mfma_f32_16x16x32_bf16 v[52:55], a[216:219], a[144:147], 0
    v_exp_f32 v144, v32
    v_mfma_f32_16x16x32_bf16 v[52:55], a[220:223], a[148:151], v[52:55]
    v_exp_f32 v145, v33
    v_mfma_f32_16x16x32_bf16 v[52:55], a[224:227], a[152:155], v[52:55]
    v_exp_f32 v146, v34
    v_mfma_f32_16x16x32_bf16 v[52:55], a[228:231], a[156:159], v[52:55]
    v_exp_f32 v147, v35
    v_mfma_f32_16x16x32_bf16 v[52:55], a[232:235], a[160:163], v[52:55]
    v_exp_f32 v148, v40
    v_mfma_f32_16x16x32_bf16 v[52:55], a[236:239], a[164:167], v[52:55]
    v_exp_f32 v149, v41
    v_cvt_pk_bf16_f32 v96, v144, v145
    v_cvt_pk_bf16_f32 v97, v146, v147
    v_cvt_pk_bf16_f32 v100, v148, v149
    s_waitcnt lgkmcnt(0)
    v_mfma_f32_16x16x32_bf16 v[160:163], a[240:243], v[112:115], v[160:163]
    s_add_u32 s62, s34, 49152
    ds_read_b128 a[192:195], v1 offset:24576
    ds_read_b128 a[196:199], v2 offset:24576
    v_mfma_f32_16x16x32_bf16 v[208:211], a[240:243], v[116:119], v[208:211]
    s_cmp_eq_u32 s62, 147456
    ds_read_b128 a[200:203], v1 offset:25600
    ds_read_b128 a[204:207], v2 offset:25600
    v_mfma_f32_16x16x32_bf16 a[0:3], a[240:243], v[120:123], a[0:3]
    s_cselect_b32 s62, 0, s62
    ds_read_b64_tr_b16 a[240:241], v3 offset:25600
    ds_read_b64_tr_b16 a[242:243], v3 offset:31744
    v_mfma_f32_16x16x32_bf16 v[164:167], a[244:247], v[112:115], v[164:167]
    s_sub_u32 s58, s62, s34
    ds_read_b128 a[208:211], v1 offset:26624
    ds_read_b128 a[212:215], v2 offset:26624
    v_mfma_f32_16x16x32_bf16 v[212:215], a[244:247], v[116:119], v[212:215]
    s_mov_b32 s34, s62
    ds_read_b128 a[216:219], v1 offset:30720
    ds_read_b128 a[220:223], v2 offset:30720
    v_mfma_f32_16x16x32_bf16 a[4:7], a[244:247], v[120:123], a[4:7]
    s_add_u32 m0, s33, s31
    ds_read_b64_tr_b16 a[244:245], v4 offset:25600
    ds_read_b64_tr_b16 a[246:247], v4 offset:31744
    v_mfma_f32_16x16x32_bf16 v[168:171], a[248:251], v[112:115], v[168:171]
    buffer_load_dwordx4 v7, s[20:23], s28 offen offset:0 lds
    v_mfma_f32_16x16x32_bf16 v[216:219], a[248:251], v[116:119], v[216:219]
    ds_read_b128 a[224:227], v1 offset:31744
    ds_read_b128 a[228:231], v2 offset:31744
    v_mfma_f32_16x16x32_bf16 a[8:11], a[248:251], v[120:123], a[8:11]
    ds_read_b64_tr_b16 a[248:249], v5 offset:25600
    ds_read_b64_tr_b16 a[250:251], v5 offset:31744
    v_mfma_f32_16x16x32_bf16 v[172:175], a[252:255], v[112:115], v[172:175]
    ds_read_b128 a[232:235], v1 offset:32768
    ds_read_b128 a[236:239], v2 offset:32768
    v_mfma_f32_16x16x32_bf16 v[220:223], a[252:255], v[116:119], v[220:223]
    v_fma_f32 v36, v36, s36, v16
    v_fma_f32 v37, v37, s36, v16
    v_mfma_f32_16x16x32_bf16 a[12:15], a[252:255], v[120:123], a[12:15]
    s_waitcnt lgkmcnt(11)
    ds_read_b64_tr_b16 a[252:253], v6 offset:25600
    ds_read_b64_tr_b16 a[254:255], v6 offset:31744
    v_mfma_f32_16x16x32_bf16 v[176:179], a[240:243], v[112:115], v[176:179]
    buffer_load_dwordx4 v8, s[20:23], s28 offen offset:1024 lds
    v_mfma_f32_16x16x32_bf16 v[224:227], a[240:243], v[116:119], v[224:227]
    v_exp_f32 v150, v36
    v_mfma_f32_16x16x32_bf16 a[16:19], a[240:243], v[120:123], a[16:19]
    s_waitcnt lgkmcnt(8)
    ds_read_b64_tr_b16 a[240:241], v3 offset:26624
    ds_read_b64_tr_b16 a[242:243], v3 offset:32768
    v_mfma_f32_16x16x32_bf16 v[180:183], a[244:247], v[112:115], v[180:183]
    v_exp_f32 v151, v37
    v_mfma_f32_16x16x32_bf16 v[228:231], a[244:247], v[116:119], v[228:231]
    v_cvt_pk_bf16_f32 v98, v150, v151
    v_fma_f32 v38, v38, s36, v16
    v_mfma_f32_16x16x32_bf16 a[20:23], a[244:247], v[120:123], a[20:23]
    s_waitcnt lgkmcnt(4)
    ds_read_b64_tr_b16 a[244:245], v4 offset:26624
    ds_read_b64_tr_b16 a[246:247], v4 offset:32768
    v_mfma_f32_16x16x32_bf16 v[184:187], a[248:251], v[112:115], v[184:187]
    v_fma_f32 v39, v39, s36, v16
    v_fma_f32 v42, v42, s36, v17
    v_mfma_f32_16x16x32_bf16 v[232:235], a[248:251], v[116:119], v[232:235]
    v_fma_f32 v43, v43, s36, v17
    v_fma_f32 v44, v44, s36, v17
    v_mfma_f32_16x16x32_bf16 a[24:27], a[248:251], v[120:123], a[24:27]
    s_waitcnt lgkmcnt(4)
    ds_read_b64_tr_b16 a[248:249], v5 offset:26624
    ds_read_b64_tr_b16 a[250:251], v5 offset:32768
    v_mfma_f32_16x16x32_bf16 v[188:191], a[252:255], v[112:115], v[188:191]
    buffer_load_dwordx4 v9, s[20:23], s28 offen offset:2048 lds
    v_mfma_f32_16x16x32_bf16 v[236:239], a[252:255], v[116:119], v[236:239]
    s_add_u32 m0, s33, s32
    v_fma_f32 v45, v45, s36, v17
    v_fma_f32 v46, v46, s36, v17
    v_mfma_f32_16x16x32_bf16 a[28:31], a[252:255], v[120:123], a[28:31]
    s_waitcnt lgkmcnt(4)
    ds_read_b64_tr_b16 a[252:253], v6 offset:26624
    ds_read_b64_tr_b16 a[254:255], v6 offset:32768
    v_mfma_f32_16x16x32_bf16 v[192:195], a[240:243], v[112:115], v[192:195]
    v_fma_f32 v47, v47, s36, v17
    v_fma_f32 v48, v48, s36, v18
    v_mfma_f32_16x16x32_bf16 v[240:243], a[240:243], v[116:119], v[240:243]
    v_exp_f32 v144, v38
    v_mfma_f32_16x16x32_bf16 a[32:35], a[240:243], v[120:123], a[32:35]
    s_waitcnt lgkmcnt(4)
    v_exp_f32 v145, v39
    v_mfma_f32_16x16x32_bf16 v[196:199], a[244:247], v[112:115], v[196:199]
    v_exp_f32 v146, v42
    v_mfma_f32_16x16x32_bf16 v[244:247], a[244:247], v[116:119], v[244:247]
    v_exp_f32 v147, v43
    v_mfma_f32_16x16x32_bf16 a[36:39], a[244:247], v[120:123], a[36:39]
    s_waitcnt lgkmcnt(2)
    v_exp_f32 v148, v44
    v_mfma_f32_16x16x32_bf16 v[200:203], a[248:251], v[112:115], v[200:203]
    buffer_load_dwordx4 v10, s[24:27], s29 offen offset:0 lds
    v_mfma_f32_16x16x32_bf16 v[248:251], a[248:251], v[116:119], v[248:251]
    v_exp_f32 v149, v45
    v_mfma_f32_16x16x32_bf16 a[40:43], a[248:251], v[120:123], a[40:43]
    s_waitcnt lgkmcnt(0)
    v_exp_f32 v150, v46
    v_mfma_f32_16x16x32_bf16 v[204:207], a[252:255], v[112:115], v[204:207]
    v_exp_f32 v151, v47
    v_mfma_f32_16x16x32_bf16 v[252:255], a[252:255], v[116:119], v[252:255]
    v_cvt_pk_bf16_f32 v99, v144, v145
    v_cvt_pk_bf16_f32 v101, v146, v147
    v_mfma_f32_16x16x32_bf16 a[44:47], a[252:255], v[120:123], a[44:47]
    v_cvt_pk_bf16_f32 v102, v148, v149
    v_cvt_pk_bf16_f32 v103, v150, v151
    v_mfma_f32_16x16x32_bf16 v[64:67], a[192:195], a[96:99], 0
    v_fma_f32 v49, v49, s36, v18
    v_fma_f32 v50, v50, s36, v18
    v_mfma_f32_16x16x32_bf16 v[64:67], a[196:199], a[100:103], v[64:67]
    v_fma_f32 v51, v51, s36, v18
    v_fma_f32 v52, v52, s36, v18
    v_mfma_f32_16x16x32_bf16 v[64:67], a[200:203], a[104:107], v[64:67]
    v_fma_f32 v53, v53, s36, v18
    v_fma_f32 v54, v54, s36, v18
    v_mfma_f32_16x16x32_bf16 v[64:67], a[204:207], a[108:111], v[64:67]
    buffer_load_dwordx4 v11, s[24:27], s29 offen offset:1024 lds
    v_mfma_f32_16x16x32_bf16 v[64:67], a[208:211], a[112:115], v[64:67]
    v_fma_f32 v55, v55, s36, v18
    v_add_f32 v20, v20, v128
    v_mfma_f32_16x16x32_bf16 v[128:131], v[24:27], v[96:99], 0
    v_exp_f32 v144, v48
    v_mfma_f32_16x16x32_bf16 v[64:67], a[212:215], a[116:119], v[64:67]
    v_exp_f32 v145, v49
    v_mfma_f32_16x16x32_bf16 v[72:75], a[192:195], a[120:123], 0
    v_exp_f32 v146, v50
    v_mfma_f32_16x16x32_bf16 v[72:75], a[196:199], a[124:127], v[72:75]
    v_exp_f32 v147, v51
    v_mfma_f32_16x16x32_bf16 v[72:75], a[200:203], a[128:131], v[72:75]
    v_exp_f32 v148, v52
    v_mfma_f32_16x16x32_bf16 v[72:75], a[204:207], a[132:135], v[72:75]
    v_exp_f32 v149, v53
    v_mfma_f32_16x16x32_bf16 v[72:75], a[208:211], a[136:139], v[72:75]
    v_exp_f32 v150, v54
    v_mfma_f32_16x16x32_bf16 v[72:75], a[212:215], a[140:143], v[72:75]
    buffer_load_dwordx4 v12, s[24:27], s29 offen offset:2048 lds
    v_mfma_f32_16x16x32_bf16 v[80:83], a[192:195], a[144:147], 0
    s_add_u32 s28, s28, s30
    v_exp_f32 v151, v55
    v_mfma_f32_16x16x32_bf16 v[80:83], a[196:199], a[148:151], v[80:83]
    s_add_u32 s29, s29, s30
    v_cvt_pk_bf16_f32 v104, v144, v145
    v_cvt_pk_bf16_f32 v105, v146, v147
    v_mfma_f32_16x16x32_bf16 v[80:83], a[200:203], a[152:155], v[80:83]
    s_add_u32 s33, s33, 24576
    v_cvt_pk_bf16_f32 v106, v148, v149
    v_cvt_pk_bf16_f32 v107, v150, v151
    v_mfma_f32_16x16x32_bf16 v[80:83], a[204:207], a[156:159], v[80:83]
    s_cmp_eq_u32 s33, 147456
    v_add_f32 v21, v21, v132
    v_add_f32 v22, v22, v136
    v_mfma_f32_16x16x32_bf16 v[132:135], v[24:27], v[100:103], 0
    s_cselect_b32 s33, 0, s33
    v_add_u32 v3, s58, v3
    v_add_u32 v4, s58, v4
    v_mfma_f32_16x16x32_bf16 v[136:139], v[24:27], v[104:107], 0
    v_add_u32 v5, s58, v5
    v_add_u32 v6, s58, v6
    v_mfma_f32_16x16x32_bf16 v[80:83], a[208:211], a[160:163], v[80:83]
    v_add_u32 v1, s58, v1
    v_add_u32 v2, s58, v2
    v_mfma_f32_16x16x32_bf16 v[80:83], a[212:215], a[164:167], v[80:83]
    v_mfma_f32_16x16x32_bf16 v[68:71], a[216:219], a[96:99], 0
    v_mfma_f32_16x16x32_bf16 v[68:71], a[220:223], a[100:103], v[68:71]
    v_max3_f32 v30, v128, v132, v136
    v_cmp_lt_f32 vcc, s37, v30
    v_mfma_f32_16x16x32_bf16 v[68:71], a[224:227], a[104:107], v[68:71]
    v_mfma_f32_16x16x32_bf16 v[68:71], a[228:231], a[108:111], v[68:71]
    s_waitcnt vmcnt(18)
    s_barrier
    v_mfma_f32_16x16x32_bf16 v[68:71], a[232:235], a[112:115], v[68:71]
    s_cbranch_vccnz L_rs_start3b
L_ret_start3b:
    v_fma_f32 v64, v64, s36, v16
    v_fma_f32 v65, v65, s36, v16
    v_mfma_f32_16x16x32_bf16 v[68:71], a[236:239], a[116:119], v[68:71]
    ds_read_b64_tr_b16 a[240:241], v3 offset:0
    ds_read_b64_tr_b16 a[242:243], v3 offset:6144
    v_mfma_f32_16x16x32_bf16 v[76:79], a[216:219], a[120:123], 0
    v_fma_f32 v66, v66, s36, v16
    v_fma_f32 v67, v67, s36, v16
    v_mfma_f32_16x16x32_bf16 v[76:79], a[220:223], a[124:127], v[76:79]
    ds_read_b64_tr_b16 a[244:245], v4 offset:0
    ds_read_b64_tr_b16 a[246:247], v4 offset:6144
    v_mfma_f32_16x16x32_bf16 v[76:79], a[224:227], a[128:131], v[76:79]
    ds_read_b64_tr_b16 a[248:249], v5 offset:0
    ds_read_b64_tr_b16 a[250:251], v5 offset:6144
    v_mfma_f32_16x16x32_bf16 v[76:79], a[228:231], a[132:135], v[76:79]
    v_fma_f32 v72, v72, s36, v17
    v_fma_f32 v73, v73, s36, v17
    v_mfma_f32_16x16x32_bf16 v[76:79], a[232:235], a[136:139], v[76:79]
    ds_read_b64_tr_b16 a[252:253], v6 offset:0
    ds_read_b64_tr_b16 a[254:255], v6 offset:6144
    v_mfma_f32_16x16x32_bf16 v[76:79], a[236:239], a[140:143], v[76:79]
    v_exp_f32 v144, v64
    v_mfma_f32_16x16x32_bf16 v[84:87], a[216:219], a[144:147], 0
    v_exp_f32 v145, v65
    v_mfma_f32_16x16x32_bf16 v[84:87], a[220:223], a[148:151], v[84:87]
    v_exp_f32 v146, v66
    v_mfma_f32_16x16x32_bf16 v[84:87], a[224:227], a[152:155], v[84:87]
    v_exp_f32 v147, v67
    v_mfma_f32_16x16x32_bf16 v[84:87], a[228:231], a[156:159], v[84:87]
    v_exp_f32 v148, v72
    v_mfma_f32_16x16x32_bf16 v[84:87], a[232:235], a[160:163], v[84:87]
    v_exp_f32 v149, v73
    v_mfma_f32_16x16x32_bf16 v[84:87], a[236:239], a[164:167], v[84:87]
    v_cvt_pk_bf16_f32 v112, v144, v145
    v_cvt_pk_bf16_f32 v113, v146, v147
    v_cvt_pk_bf16_f32 v116, v148, v149
    s_mov_b32 s38, 0
    s_branch L_loop3
L_loop4:
    s_bitcmp1_b32 s3, 1
    s_cbranch_scc1 L_loop4w1
    .p2align 6
L_loop4w0:
    s_waitcnt lgkmcnt(4)
    v_mfma_f32_16x16x32_bf16 v[160:163], a[240:243], v[96:99], v[160:163]
    s_add_u32 m0, s33, s31
    ds_read_b128 a[192:195], v1 offset:0
    ds_read_b128 a[196:199], v2 offset:0
    v_mfma_f32_16x16x32_bf16 v[208:211], a[240:243], v[100:103], v[208:211]
    ds_read_b128 a[200:203], v1 offset:1024
    ds_read_b128 a[204:207], v2 offset:1024
    v_mfma_f32_16x16x32_bf16 a[0:3], a[240:243], v[104:107], a[0:3]
    ds_read_b128 a[208:211], v1 offset:2048
    ds_read_b128 a[212:215], v2 offset:2048
    v_mfma_f32_16x16x32_bf16 a[48:51], a[240:243], v[108:111], a[48:51]
    buffer_load_dwordx4 v7, s[20:23], s28 offen offset:0 lds
    v_mfma_f32_16x16x32_bf16 v[164:167], a[244:247], v[96:99], v[164:167]
    ds_read_b64_tr_b16 a[240:241], v3 offset:1024
    ds_read_b64_tr_b16 a[242:243], v3 offset:7168
    v_mfma_f32_16x16x32_bf16 v[212:215], a[244:247], v[100:103], v[212:215]
    ds_read_b128 a[216:219], v1 offset:6144
    ds_read_b128 a[220:223], v2 offset:6144
    v_mfma_f32_16x16x32_bf16 a[4:7], a[244:247], v[104:107], a[4:7]
    ds_read_b128 a[224:227], v1 offset:7168
    ds_read_b128 a[228:231], v2 offset:7168
    v_mfma_f32_16x16x32_bf16 a[52:55], a[244:247], v[108:111], a[52:55]
    s_waitcnt lgkmcnt(12)
    ds_read_b64_tr_b16 a[244:245], v4 offset:1024
    ds_read_b64_tr_b16 a[246:247], v4 offset:7168
    v_mfma_f32_16x16x32_bf16 v[168:171], a[248:251], v[96:99], v[168:171]
    ds_read_b128 a[232:235], v1 offset:8192
    ds_read_b128 a[236:239], v2 offset:8192
    v_mfma_f32_16x16x32_bf16 v[216:219], a[248:251], v[100:103], v[216:219]
    v_fma_f32 v68, v68, s36, v16
    v_fma_f32 v69, v69, s36, v16
    v_mfma_f32_16x16x32_bf16 a[8:11], a[248:251], v[104:107], a[8:11]
    v_exp_f32 v150, v68
    v_mfma_f32_16x16x32_bf16 a[56:59], a[248:251], v[108:111], a[56:59]
    ds_read_b64_tr_b16 a[248:249], v5 offset:1024
    ds_read_b64_tr_b16 a[250:251], v5 offset:7168
    v_mfma_f32_16x16x32_bf16 v[172:175], a[252:255], v[96:99], v[172:175]
    v_exp_f32 v151, v69
    v_mfma_f32_16x16x32_bf16 v[220:223], a[252:255], v[100:103], v[220:223]
    v_cvt_pk_bf16_f32 v114, v150, v151
    v_fma_f32 v70, v70, s36, v16
    v_mfma_f32_16x16x32_bf16 a[12:15], a[252:255], v[104:107], a[12:15]
    v_fma_f32 v71, v71, s36, v16
    v_fma_f32 v74, v74, s36, v17
    v_mfma_f32_16x16x32_bf16 a[60:63], a[252:255], v[108:111], a[60:63]
    buffer_load_dwordx4 v8, s[20:23], s28 offen offset:1024 lds
    s_waitcnt lgkmcnt(4)
    v_mfma_f32_16x16x32_bf16 v[176:179], a[240:243], v[96:99], v[176:179]
    ds_read_b64_tr_b16 a[252:253], v6 offset:1024
    ds_read_b64_tr_b16 a[254:255], v6 offset:7168
    v_mfma_f32_16x16x32_bf16 v[224:227], a[240:243], v[100:103], v[224:227]
    v_fma_f32 v75, v75, s36, v17
    v_fma_f32 v76, v76, s36, v17
    v_mfma_f32_16x16x32_bf16 a[16:19], a[240:243], v[104:107], a[16:19]
    v_fma_f32 v77, v77, s36, v17
    v_fma_f32 v78, v78, s36, v17
    v_mfma_f32_16x16x32_bf16 a[64:67], a[240:243], v[108:111], a[64:67]
    ds_read_b64_tr_b16 a[240:241], v3 offset:2048
    ds_read_b64_tr_b16 a[242:243], v3 offset:8192
    v_mfma_f32_16x16x32_bf16 v[180:183], a[244:247], v[96:99], v[180:183]
    v_fma_f32 v79, v79, s36, v17
    v_fma_f32 v80, v80, s36, v18
    v_mfma_f32_16x16x32_bf16 v[228:231], a[244:247], v[100:103], v[228:231]
    v_exp_f32 v144, v70
    v_mfma_f32_16x16x32_bf16 a[20:23], a[244:247], v[104:107], a[20:23]
    v_exp_f32 v145, v71
    v_mfma_f32_16x16x32_bf16 a[68:71], a[244:247], v[108:111], a[68:71]
    s_waitcnt lgkmcnt(4)
    ds_read_b64_tr_b16 a[244:245], v4 offset:2048
    ds_read_b64_tr_b16 a[246:247], v4 offset:8192
    v_mfma_f32_16x16x32_bf16 v[184:187], a[248:251], v[96:99], v[184:187]
    v_exp_f32 v146, v74
    v_mfma_f32_16x16x32_bf16 v[232:235], a[248:251], v[100:103], v[232:235]
    v_exp_f32 v147, v75
    v_mfma_f32_16x16x32_bf16 a[24:27], a[248:251], v[104:107], a[24:27]
    v_exp_f32 v148, v76
    v_mfma_f32_16x16x32_bf16 a[72:75], a[248:251], v[108:111], a[72:75]
    s_waitcnt lgkmcnt(3)
    ds_read_b64_tr_b16 a[248:249], v5 offset:2048
    ds_read_b64_tr_b16 a[250:251], v5 offset:8192
    v_mfma_f32_16x16x32_bf16 v[188:191], a[252:255], v[96:99], v[188:191]
    buffer_load_dwordx4 v9, s[20:23], s28 offen offset:2048 lds
    v_mfma_f32_16x16x32_bf16 v[236:239], a[252:255], v[100:103], v[236:239]
    s_add_u32 m0, s33, s32
    v_exp_f32 v149, v77
    v_mfma_f32_16x16x32_bf16 a[28:31], a[252:255], v[104:107], a[28:31]
    v_exp_f32 v150, v78
    v_mfma_f32_16x16x32_bf16 a[76:79], a[252:255], v[108:111], a[76:79]
    s_waitcnt lgkmcnt(2)
    ds_read_b64_tr_b16 a[252:253], v6 offset:2048
    ds_read_b64_tr_b16 a[254:255], v6 offset:8192
    v_mfma_f32_16x16x32_bf16 v[192:195], a[240:243], v[96:99], v[192:195]
    v_exp_f32 v151, v79
    v_mfma_f32_16x16x32_bf16 v[240:243], a[240:243], v[100:103], v[240:243]
    v_cvt_pk_bf16_f32 v115, v144, v145
    v_cvt_pk_bf16_f32 v117, v146, v147
    v_mfma_f32_16x16x32_bf16 a[32:35], a[240:243], v[104:107], a[32:35]
    v_cvt_pk_bf16_f32 v118, v148, v149
    v_cvt_pk_bf16_f32 v119, v150, v151
    v_mfma_f32_16x16x32_bf16 a[80:83], a[240:243], v[108:111], a[80:83]
    v_fma_f32 v81, v81, s36, v18
    v_fma_f32 v82, v82, s36, v18
    v_mfma_f32_16x16x32_bf16 v[196:199], a[244:247], v[96:99], v[196:199]
    v_fma_f32 v83, v83, s36, v18
    v_fma_f32 v84, v84, s36, v18
    v_mfma_f32_16x16x32_bf16 v[244:247], a[244:247], v[100:103], v[244:247]
    v_fma_f32 v85, v85, s36, v18
    v_fma_f32 v86, v86, s36, v18
    v_mfma_f32_16x16x32_bf16 a[36:39], a[244:247], v[104:107], a[36:39]
    v_fma_f32 v87, v87, s36, v18
    v_fma_f32 v88, v88, s36, v19
    v_mfma_f32_16x16x32_bf16 a[84:87], a[244:247], v[108:111], a[84:87]
    s_waitcnt lgkmcnt(1)
    v_exp_f32 v144, v80
    v_mfma_f32_16x16x32_bf16 v[200:203], a[248:251], v[96:99], v[200:203]
    buffer_load_dwordx4 v10, s[24:27], s29 offen offset:0 lds
    v_mfma_f32_16x16x32_bf16 v[248:251], a[248:251], v[100:103], v[248:251]
    v_exp_f32 v145, v81
    v_mfma_f32_16x16x32_bf16 a[40:43], a[248:251], v[104:107], a[40:43]
    v_exp_f32 v146, v82
    v_mfma_f32_16x16x32_bf16 a[88:91], a[248:251], v[108:111], a[88:91]
    s_waitcnt lgkmcnt(0)
    v_exp_f32 v147, v83
    v_mfma_f32_16x16x32_bf16 v[204:207], a[252:255], v[96:99], v[204:207]
    v_exp_f32 v148, v84
    v_mfma_f32_16x16x32_bf16 v[252:255], a[252:255], v[100:103], v[252:255]
    v_exp_f32 v149, v85
    v_mfma_f32_16x16x32_bf16 a[44:47], a[252:255], v[104:107], a[44:47]
    v_exp_f32 v150, v86
    v_mfma_f32_16x16x32_bf16 a[92:95], a[252:255], v[108:111], a[92:95]
    v_exp_f32 v151, v87
    v_mfma_f32_16x16x32_bf16 v[32:35], a[192:195], a[96:99], 0
    v_cvt_pk_bf16_f32 v120, v144, v145
    v_cvt_pk_bf16_f32 v121, v146, v147
    v_mfma_f32_16x16x32_bf16 v[32:35], a[196:199], a[100:103], v[32:35]
    v_cvt_pk_bf16_f32 v122, v148, v149
    v_cvt_pk_bf16_f32 v123, v150, v151
    v_mfma_f32_16x16x32_bf16 v[32:35], a[200:203], a[104:107], v[32:35]
    v_fma_f32 v89, v89, s36, v19
    v_fma_f32 v90, v90, s36, v19
    v_mfma_f32_16x16x32_bf16 v[32:35], a[204:207], a[108:111], v[32:35]
    v_fma_f32 v91, v91, s36, v19
    v_fma_f32 v92, v92, s36, v19
    v_mfma_f32_16x16x32_bf16 v[32:35], a[208:211], a[112:115], v[32:35]
    v_fma_f32 v93, v93, s36, v19
    v_fma_f32 v94, v94, s36, v19
    v_mfma_f32_16x16x32_bf16 v[32:35], a[212:215], a[116:119], v[32:35]
    buffer_load_dwordx4 v11, s[24:27], s29 offen offset:1024 lds
    v_mfma_f32_16x16x32_bf16 v[40:43], a[192:195], a[120:123], 0
    v_fma_f32 v95, v95, s36, v19
    v_add_f32 v20, v20, v128
    v_mfma_f32_16x16x32_bf16 v[128:131], v[24:27], v[112:115], 0
    v_exp_f32 v144, v88
    v_mfma_f32_16x16x32_bf16 v[40:43], a[196:199], a[124:127], v[40:43]
    v_exp_f32 v145, v89
    v_mfma_f32_16x16x32_bf16 v[40:43], a[200:203], a[128:131], v[40:43]
    v_exp_f32 v146, v90
    v_mfma_f32_16x16x32_bf16 v[40:43], a[204:207], a[132:135], v[40:43]
    v_exp_f32 v147, v91
    v_mfma_f32_16x16x32_bf16 v[40:43], a[208:211], a[136:139], v[40:43]
    v_exp_f32 v148, v92
    v_mfma_f32_16x16x32_bf16 v[40:43], a[212:215], a[140:143], v[40:43]
    v_exp_f32 v149, v93
    v_mfma_f32_16x16x32_bf16 v[48:51], a[192:195], a[144:147], 0
    v_exp_f32 v150, v94
    v_mfma_f32_16x16x32_bf16 v[48:51], a[196:199], a[148:151], v[48:51]
    v_exp_f32 v151, v95
    v_mfma_f32_16x16x32_bf16 v[48:51], a[200:203], a[152:155], v[48:51]
    v_cvt_pk_bf16_f32 v124, v144, v145
    v_cvt_pk_bf16_f32 v125, v146, v147
    v_mfma_f32_16x16x32_bf16 v[48:51], a[204:207], a[156:159], v[48:51]
    v_cvt_pk_bf16_f32 v126, v148, v149
    v_cvt_pk_bf16_f32 v127, v150, v151
    v_mfma_f32_16x16x32_bf16 v[48:51], a[208:211], a[160:163], v[48:51]
    buffer_load_dwordx4 v12, s[24:27], s29 offen offset:2048 lds
    v_mfma_f32_16x16x32_bf16 v[48:51], a[212:215], a[164:167], v[48:51]
    s_add_u32 s28, s28, s30
    v_add_f32 v21, v21, v132
    v_add_f32 v22, v22, v136
    v_mfma_f32_16x16x32_bf16 v[132:135], v[24:27], v[116:119], 0
    s_add_u32 s29, s29, s30
    v_add_f32 v23, v23, v140
    v_mfma_f32_16x16x32_bf16 v[136:139], v[24:27], v[120:123], 0
    s_add_u32 s33, s33, 24576
    v_mfma_f32_16x16x32_bf16 v[140:143], v[24:27], v[124:127], 0
    s_cmp_eq_u32 s33, 147456
    v_mfma_f32_16x16x32_bf16 v[56:59], a[192:195], a[168:171], 0
    s_cselect_b32 s33, 0, s33
    v_mfma_f32_16x16x32_bf16 v[56:59], a[196:199], a[172:175], v[56:59]
    v_mfma_f32_16x16x32_bf16 v[56:59], a[200:203], a[176:179], v[56:59]
    v_mfma_f32_16x16x32_bf16 v[56:59], a[204:207], a[180:183], v[56:59]
    v_max3_f32 v30, v128, v132, v136
    v_mfma_f32_16x16x32_bf16 v[56:59], a[208:211], a[184:187], v[56:59]
    v_max_f32 v30, v30, v140
    v_cmp_lt_f32 vcc, s37, v30
    v_mfma_f32_16x16x32_bf16 v[56:59], a[212:215], a[188:191], v[56:59]
    v_mfma_f32_16x16x32_bf16 v[36:39], a[216:219], a[96:99], 0
    v_mfma_f32_16x16x32_bf16 v[36:39], a[220:223], a[100:103], v[36:39]
    v_mfma_f32_16x16x32_bf16 v[36:39], a[224:227], a[104:107], v[36:39]
    v_mfma_f32_16x16x32_bf16 v[36:39], a[228:231], a[108:111], v[36:39]
    s_cbranch_vccnz L_rs_loop4w0a
L_ret_loop4w0a:
    s_cmp_ge_u32 s38, 4
    s_cbranch_scc1 L_mode4w0
L_modeback4w0:
    v_mfma_f32_16x16x32_bf16 v[36:39], a[232:235], a[112:115], v[36:39]
    v_fma_f32 v32, v32, s36, v16
    v_fma_f32 v33, v33, s36, v16
    v_mfma_f32_16x16x32_bf16 v[36:39], a[236:239], a[116:119], v[36:39]
    v_fma_f32 v34, v34, s36, v16
    v_fma_f32 v35, v35, s36, v16
    v_mfma_f32_16x16x32_bf16 v[44:47], a[216:219], a[120:123], 0
    v_fma_f32 v40, v40, s36, v17
    v_fma_f32 v41, v41, s36, v17
    v_mfma_f32_16x16x32_bf16 v[44:47], a[220:223], a[124:127], v[44:47]
    v_exp_f32 v144, v32
    v_mfma_f32_16x16x32_bf16 v[44:47], a[224:227], a[128:131], v[44:47]
    v_exp_f32 v145, v33
    v_mfma_f32_16x16x32_bf16 v[44:47], a[228:231], a[132:135], v[44:47]
    v_exp_f32 v146, v34
    s_waitcnt vmcnt(18)
    s_barrier
    v_mfma_f32_16x16x32_bf16 v[44:47], a[232:235], a[136:139], v[44:47]
    v_exp_f32 v147, v35
    v_mfma_f32_16x16x32_bf16 v[44:47], a[236:239], a[140:143], v[44:47]
    ds_read_b64_tr_b16 a[240:241], v3 offset:24576
    ds_read_b64_tr_b16 a[242:243], v3 offset:30720
    v_mfma_f32_16x16x32_bf16 v[52:55], a[216:219], a[144:147], 0
    v_exp_f32 v148, v40
    v_mfma_f32_16x16x32_bf16 v[52:55], a[220:223], a[148:151], v[52:55]
    ds_read_b64_tr_b16 a[244:245], v4 offset:24576
    ds_read_b64_tr_b16 a[246:247], v4 offset:30720
    v_mfma_f32_16x16x32_bf16 v[52:55], a[224:227], a[152:155], v[52:55]
    v_exp_f32 v149, v41
    v_mfma_f32_16x16x32_bf16 v[52:55], a[228:231], a[156:159], v[52:55]
    ds_read_b64_tr_b16 a[248:249], v5 offset:24576
    ds_read_b64_tr_b16 a[250:251], v5 offset:30720
    v_mfma_f32_16x16x32_bf16 v[52:55], a[232:235], a[160:163], v[52:55]
    v_cvt_pk_bf16_f32 v96, v144, v145
    v_cvt_pk_bf16_f32 v97, v146, v147
    v_mfma_f32_16x16x32_bf16 v[52:55], a[236:239], a[164:167], v[52:55]
    ds_read_b64_tr_b16 a[252:253], v6 offset:24576
    ds_read_b64_tr_b16 a[254:255], v6 offset:30720
    v_mfma_f32_16x16x32_bf16 v[60:63], a[216:219], a[168:171], 0
    v_cvt_pk_bf16_f32 v100, v148, v149
    v_mfma_f32_16x16x32_bf16 v[60:63], a[220:223], a[172:175], v[60:63]
    v_mfma_f32_16x16x32_bf16 v[60:63], a[224:227], a[176:179], v[60:63]
    v_mfma_f32_16x16x32_bf16 v[60:63], a[228:231], a[180:183], v[60:63]
    v_mfma_f32_16x16x32_bf16 v[60:63], a[232:235], a[184:187], v[60:63]
    v_mfma_f32_16x16x32_bf16 v[60:63], a[236:239], a[188:191], v[60:63]
    s_waitcnt lgkmcnt(4)
    v_mfma_f32_16x16x32_bf16 v[160:163], a[240:243], v[112:115], v[160:163]
    s_add_u32 s62, s34, 49152
    ds_read_b128 a[196:199], v2 offset:24576
    ds_read_b128 a[192:195], v1 offset:24576
    v_mfma_f32_16x16x32_bf16 v[208:211], a[240:243], v[116:119], v[208:211]
    s_cmp_eq_u32 s62, 147456
    ds_read_b128 a[200:203], v1 offset:25600
    ds_read_b128 a[204:207], v2 offset:25600
    v_mfma_f32_16x16x32_bf16 a[0:3], a[240:243], v[120:123], a[0:3]
    s_cselect_b32 s62, 0, s62
    ds_read_b128 a[208:211], v1 offset:26624
    ds_read_b128 a[212:215], v2 offset:26624
    v_mfma_f32_16x16x32_bf16 a[48:51], a[240:243], v[124:127], a[48:51]
    s_sub_u32 s58, s62, s34
    ds_read_b64_tr_b16 a[240:241], v3 offset:25600
    ds_read_b64_tr_b16 a[242:243], v3 offset:31744
    v_mfma_f32_16x16x32_bf16 v[164:167], a[244:247], v[112:115], v[164:167]
    s_mov_b32 s34, s62
    ds_read_b128 a[216:219], v1 offset:30720
    ds_read_b128 a[220:223], v2 offset:30720
    v_mfma_f32_16x16x32_bf16 v[212:215], a[244:247], v[116:119], v[212:215]
    s_add_u32 m0, s33, s31
    ds_read_b128 a[224:227], v1 offset:31744
    ds_read_b128 a[228:231], v2 offset:31744
    v_mfma_f32_16x16x32_bf16 a[4:7], a[244:247], v[120:123], a[4:7]
    buffer_load_dwordx4 v7, s[20:23], s28 offen offset:0 lds
    v_mfma_f32_16x16x32_bf16 a[52:55], a[244:247], v[124:127], a[52:55]
    s_waitcnt lgkmcnt(12)
    ds_read_b64_tr_b16 a[246:247], v4 offset:31744
    ds_read_b64_tr_b16 a[244:245], v4 offset:25600
    v_mfma_f32_16x16x32_bf16 v[168:171], a[248:251], v[112:115], v[168:171]
    ds_read_b128 a[232:235], v1 offset:32768
    ds_read_b128 a[236:239], v2 offset:32768
    v_mfma_f32_16x16x32_bf16 v[216:219], a[248:251], v[116:119], v[216:219]
    v_fma_f32 v37, v37, s36, v16
    v_fma_f32 v44, v44, s36, v17
    v_mfma_f32_16x16x32_bf16 a[8:11], a[248:251], v[120:123], a[8:11]
    v_exp_f32 v151, v37
    v_mfma_f32_16x16x32_bf16 a[56:59], a[248:251], v[124:127], a[56:59]
    ds_read_b64_tr_b16 a[250:251], v5 offset:31744
    ds_read_b64_tr_b16 a[248:249], v5 offset:25600
    v_mfma_f32_16x16x32_bf16 v[172:175], a[252:255], v[112:115], v[172:175]
    v_exp_f32 v148, v44
    v_mfma_f32_16x16x32_bf16 v[220:223], a[252:255], v[116:119], v[220:223]
    v_fma_f32 v43, v43, s36, v17
    v_fma_f32 v36, v36, s36, v16
    v_mfma_f32_16x16x32_bf16 a[12:15], a[252:255], v[120:123], a[12:15]
    v_exp_f32 v150, v36
    v_mfma_f32_16x16x32_bf16 a[60:63], a[252:255], v[124:127], a[60:63]
    buffer_load_dwordx4 v8, s[20:23], s28 offen offset:1024 lds
    s_waitcnt lgkmcnt(4)
    v_mfma_f32_16x16x32_bf16 v[176:179], a[240:243], v[112:115], v[176:179]
    ds_read_b64_tr_b16 a[254:255], v6 offset:31744
    ds_read_b64_tr_b16 a[252:253], v6 offset:25600
    v_mfma_f32_16x16x32_bf16 v[224:227], a[240:243], v[116:119], v[224:227]
    v_exp_f32 v147, v43
    v_mfma_f32_16x16x32_bf16 a[16:19], a[240:243], v[120:123], a[16:19]
    v_fma_f32 v38, v38, s36, v16
    v_fma_f32 v42, v42, s36, v17
    v_mfma_f32_16x16x32_bf16 a[64:67], a[240:243], v[124:127], a[64:67]
    ds_read_b64_tr_b16 a[240:241], v3 offset:26624
    ds_read_b64_tr_b16 a[242:243], v3 offset:32768
    v_mfma_f32_16x16x32_bf16 v[180:183], a[244:247], v[112:115], v[180:183]
    v_exp_f32 v146, v42
    v_mfma_f32_16x16x32_bf16 v[228:231], a[244:247], v[116:119], v[228:231]
    v_exp_f32 v144, v38
    v_mfma_f32_16x16x32_bf16 a[20:23], a[244:247], v[120:123], a[20:23]
    v_fma_f32 v47, v47, s36, v17
    v_fma_f32 v45, v45, s36, v17
    v_mfma_f32_16x16x32_bf16 a[68:71], a[244:247], v[124:127], a[68:71]
    s_waitcnt lgkmcnt(4)
    ds_read_b64_tr_b16 a[244:245], v4 offset:26624
    ds_read_b64_tr_b16 a[246:247], v4 offset:32768
    v_mfma_f32_16x16x32_bf16 v[184:187], a[248:251], v[112:115], v[184:187]
    v_exp_f32 v149, v45
    v_mfma_f32_16x16x32_bf16 v[232:235], a[248:251], v[116:119], v[232:235]
    v_fma_f32 v39, v39, s36, v16
    v_fma_f32 v52, v52, s36, v18
    v_mfma_f32_16x16x32_bf16 a[24:27], a[248:251], v[120:123], a[24:27]
    v_exp_f32 v145, v39
    v_mfma_f32_16x16x32_bf16 a[72:75], a[248:251], v[124:127], a[72:75]
    s_waitcnt lgkmcnt(3)
    ds_read_b64_tr_b16 a[250:251], v5 offset:32768
    ds_read_b64_tr_b16 a[248:249], v5 offset:26624
    v_mfma_f32_16x16x32_bf16 v[188:191], a[252:255], v[112:115], v[188:191]
    buffer_load_dwordx4 v9, s[20:23], s28 offen offset:2048 lds
    v_mfma_f32_16x16x32_bf16 v[236:239], a[252:255], v[116:119], v[236:239]
    s_add_u32 m0, s33, s32
    v_fma_f32 v51, v51, s36, v18
    v_fma_f32 v54, v54, s36, v18
    v_mfma_f32_16x16x32_bf16 a[28:31], a[252:255], v[120:123], a[28:31]
    v_fma_f32 v46, v46, s36, v17
    v_fma_f32 v49, v49, s36, v18
    v_mfma_f32_16x16x32_bf16 a[76:79], a[252:255], v[124:127], a[76:79]
    s_waitcnt lgkmcnt(2)
    ds_read_b64_tr_b16 a[254:255], v6 offset:32768
    ds_read_b64_tr_b16 a[252:253], v6 offset:26624
    v_mfma_f32_16x16x32_bf16 v[192:195], a[240:243], v[112:115], v[192:195]
    v_cvt_pk_bf16_f32 v98, v150, v151
    v_fma_f32 v48, v48, s36, v18
    v_mfma_f32_16x16x32_bf16 v[240:243], a[240:243], v[116:119], v[240:243]
    v_exp_f32 v151, v47
    v_mfma_f32_16x16x32_bf16 a[32:35], a[240:243], v[120:123], a[32:35]
    v_exp_f32 v150, v46
    v_mfma_f32_16x16x32_bf16 a[80:83], a[240:243], v[124:127], a[80:83]
    v_cvt_pk_bf16_f32 v103, v150, v151
    v_cvt_pk_bf16_f32 v99, v144, v145
    v_mfma_f32_16x16x32_bf16 v[196:199], a[244:247], v[112:115], v[196:199]
    v_exp_f32 v145, v49
    v_mfma_f32_16x16x32_bf16 v[244:247], a[244:247], v[116:119], v[244:247]
    v_exp_f32 v150, v54
    v_mfma_f32_16x16x32_bf16 a[36:39], a[244:247], v[120:123], a[36:39]
    v_exp_f32 v144, v48
    v_mfma_f32_16x16x32_bf16 a[84:87], a[244:247], v[124:127], a[84:87]
    s_waitcnt lgkmcnt(1)
    v_fma_f32 v55, v55, s36, v18
    v_cvt_pk_bf16_f32 v101, v146, v147
    v_mfma_f32_16x16x32_bf16 v[200:203], a[248:251], v[112:115], v[200:203]
    buffer_load_dwordx4 v10, s[24:27], s29 offen offset:0 lds
    v_mfma_f32_16x16x32_bf16 v[248:251], a[248:251], v[116:119], v[248:251]
    v_exp_f32 v151, v55
    v_mfma_f32_16x16x32_bf16 a[40:43], a[248:251], v[120:123], a[40:43]
    v_exp_f32 v147, v51
    v_mfma_f32_16x16x32_bf16 a[88:91], a[248:251], v[124:127], a[88:91]
    s_waitcnt lgkmcnt(0)
    v_fma_f32 v53, v53, s36, v18
    v_fma_f32 v56, v56, s36, v19
    v_mfma_f32_16x16x32_bf16 v[204:207], a[252:255], v[112:115], v[204:207]
    v_fma_f32 v50, v50, s36, v18
    v_cvt_pk_bf16_f32 v102, v148, v149
    v_mfma_f32_16x16x32_bf16 v[252:255], a[252:255], v[116:119], v[252:255]
    v_exp_f32 v149, v53
    v_mfma_f32_16x16x32_bf16 a[44:47], a[252:255], v[120:123], a[44:47]
    v_exp_f32 v146, v50
    v_mfma_f32_16x16x32_bf16 a[92:95], a[252:255], v[124:127], a[92:95]
    v_exp_f32 v148, v52
    v_mfma_f32_16x16x32_bf16 v[64:67], a[192:195], a[96:99], 0
    v_cvt_pk_bf16_f32 v106, v148, v149
    v_cvt_pk_bf16_f32 v104, v144, v145
    v_mfma_f32_16x16x32_bf16 v[64:67], a[196:199], a[100:103], v[64:67]
    v_exp_f32 v144, v56
    v_mfma_f32_16x16x32_bf16 v[64:67], a[200:203], a[104:107], v[64:67]
    v_cvt_pk_bf16_f32 v105, v146, v147
    v_fma_f32 v62, v62, s36, v19
    v_mfma_f32_16x16x32_bf16 v[64:67], a[204:207], a[108:111], v[64:67]
    v_fma_f32 v60, v60, s36, v19
    v_fma_f32 v63, v63, s36, v19
    v_mfma_f32_16x16x32_bf16 v[64:67], a[208:211], a[112:115], v[64:67]
    v_exp_f32 v148, v60
    v_mfma_f32_16x16x32_bf16 v[64:67], a[212:215], a[116:119], v[64:67]
    buffer_load_dwordx4 v11, s[24:27], s29 offen offset:1024 lds
    v_mfma_f32_16x16x32_bf16 v[72:75], a[192:195], a[120:123], 0
    v_fma_f32 v58, v58, s36, v19
    v_fma_f32 v61, v61, s36, v19
    v_mfma_f32_16x16x32_bf16 v[72:75], a[196:199], a[124:127], v[72:75]
    v_exp_f32 v146, v58
    v_mfma_f32_16x16x32_bf16 v[72:75], a[200:203], a[128:131], v[72:75]
    v_exp_f32 v149, v61
    v_mfma_f32_16x16x32_bf16 v[72:75], a[204:207], a[132:135], v[72:75]
    v_cvt_pk_bf16_f32 v107, v150, v151
    v_fma_f32 v59, v59, s36, v19
    v_mfma_f32_16x16x32_bf16 v[72:75], a[208:211], a[136:139], v[72:75]
    v_exp_f32 v150, v62
    v_mfma_f32_16x16x32_bf16 v[72:75], a[212:215], a[140:143], v[72:75]
    v_exp_f32 v147, v59
    v_mfma_f32_16x16x32_bf16 v[80:83], a[192:195], a[144:147], 0
    v_exp_f32 v151, v63
    v_mfma_f32_16x16x32_bf16 v[80:83], a[196:199], a[148:151], v[80:83]
    v_fma_f32 v57, v57, s36, v19
    v_cvt_pk_bf16_f32 v110, v148, v149
    v_mfma_f32_16x16x32_bf16 v[80:83], a[200:203], a[152:155], v[80:83]
    v_exp_f32 v145, v57
    v_mfma_f32_16x16x32_bf16 v[80:83], a[204:207], a[156:159], v[80:83]
    v_cvt_pk_bf16_f32 v108, v144, v145
    v_cvt_pk_bf16_f32 v109, v146, v147
    v_mfma_f32_16x16x32_bf16 v[80:83], a[208:211], a[160:163], v[80:83]
    v_add_f32 v20, v20, v128
    v_add_f32 v22, v22, v136
    v_mfma_f32_16x16x32_bf16 v[128:131], v[24:27], v[96:99], 0
    buffer_load_dwordx4 v12, s[24:27], s29 offen offset:2048 lds
    v_mfma_f32_16x16x32_bf16 v[136:139], v[24:27], v[104:107], 0
    s_add_u32 s28, s28, s30
    v_add_f32 v21, v21, v132
    v_cvt_pk_bf16_f32 v111, v150, v151
    v_mfma_f32_16x16x32_bf16 v[132:135], v[24:27], v[100:103], 0
    s_add_u32 s29, s29, s30
    v_add_f32 v23, v23, v140
    v_add_u32 v3, s58, v3
    v_mfma_f32_16x16x32_bf16 v[140:143], v[24:27], v[108:111], 0
    s_add_u32 s33, s33, 24576
    v_add_u32 v2, s58, v2
    v_add_u32 v5, s58, v5
    v_mfma_f32_16x16x32_bf16 v[80:83], a[212:215], a[164:167], v[80:83]
    s_cmp_eq_u32 s33, 147456
    v_max3_f32 v30, v128, v132, v136
    v_add_u32 v1, s58, v1
    v_mfma_f32_16x16x32_bf16 v[88:91], a[192:195], a[168:171], 0
    s_cselect_b32 s33, 0, s33
    v_max_f32 v30, v30, v140
    v_cmp_lt_f32 vcc, s37, v30
    v_mfma_f32_16x16x32_bf16 v[88:91], a[196:199], a[172:175], v[88:91]
    v_add_u32 v4, s58, v4
    v_add_u32 v6, s58, v6
    v_mfma_f32_16x16x32_bf16 v[88:91], a[200:203], a[176:179], v[88:91]
    v_mfma_f32_16x16x32_bf16 v[88:91], a[204:207], a[180:183], v[88:91]
    s_cbranch_vccnz L_rs_loop4w0b
L_ret_loop4w0b:
    s_add_u32 s38, s38, 1
    s_cmp_lt_u32 s38, 6
    v_mfma_f32_16x16x32_bf16 v[88:91], a[208:211], a[184:187], v[88:91]
    v_fma_f32 v72, v72, s36, v17
    v_fma_f32 v67, v67, s36, v16
    v_mfma_f32_16x16x32_bf16 v[88:91], a[212:215], a[188:191], v[88:91]
    v_exp_f32 v147, v67
    v_mfma_f32_16x16x32_bf16 v[68:71], a[216:219], a[96:99], 0
    v_exp_f32 v148, v72
    v_mfma_f32_16x16x32_bf16 v[68:71], a[220:223], a[100:103], v[68:71]
    v_fma_f32 v66, v66, s36, v16
    v_fma_f32 v65, v65, s36, v16
    v_mfma_f32_16x16x32_bf16 v[68:71], a[224:227], a[104:107], v[68:71]
    v_exp_f32 v146, v66
    v_mfma_f32_16x16x32_bf16 v[68:71], a[228:231], a[108:111], v[68:71]
    v_exp_f32 v145, v65
    v_mfma_f32_16x16x32_bf16 v[68:71], a[232:235], a[112:115], v[68:71]
    v_fma_f32 v73, v73, s36, v17
    v_fma_f32 v64, v64, s36, v16
    v_mfma_f32_16x16x32_bf16 v[68:71], a[236:239], a[116:119], v[68:71]
    v_exp_f32 v144, v64
    v_mfma_f32_16x16x32_bf16 v[76:79], a[216:219], a[120:123], 0
    v_exp_f32 v149, v73
    v_mfma_f32_16x16x32_bf16 v[76:79], a[220:223], a[124:127], v[76:79]
    v_cvt_pk_bf16_f32 v116, v148, v149
    v_cvt_pk_bf16_f32 v113, v146, v147
    v_mfma_f32_16x16x32_bf16 v[76:79], a[224:227], a[128:131], v[76:79]
    v_cvt_pk_bf16_f32 v112, v144, v145
    v_mfma_f32_16x16x32_bf16 v[76:79], a[228:231], a[132:135], v[76:79]
    v_mfma_f32_16x16x32_bf16 v[76:79], a[232:235], a[136:139], v[76:79]
    s_waitcnt vmcnt(18)
    s_barrier
    v_mfma_f32_16x16x32_bf16 v[76:79], a[236:239], a[140:143], v[76:79]
    v_mfma_f32_16x16x32_bf16 v[84:87], a[216:219], a[144:147], 0
    ds_read_b64_tr_b16 a[240:241], v3 offset:0
    ds_read_b64_tr_b16 a[242:243], v3 offset:6144
    v_mfma_f32_16x16x32_bf16 v[84:87], a[220:223], a[148:151], v[84:87]
    v_mfma_f32_16x16x32_bf16 v[84:87], a[224:227], a[152:155], v[84:87]
    ds_read_b64_tr_b16 a[246:247], v4 offset:6144
    ds_read_b64_tr_b16 a[244:245], v4 offset:0
    v_mfma_f32_16x16x32_bf16 v[84:87], a[228:231], a[156:159], v[84:87]
    v_mfma_f32_16x16x32_bf16 v[84:87], a[232:235], a[160:163], v[84:87]
    ds_read_b64_tr_b16 a[248:249], v5 offset:0
    ds_read_b64_tr_b16 a[250:251], v5 offset:6144
    v_mfma_f32_16x16x32_bf16 v[84:87], a[236:239], a[164:167], v[84:87]
    v_mfma_f32_16x16x32_bf16 v[92:95], a[216:219], a[168:171], 0
    ds_read_b64_tr_b16 a[254:255], v6 offset:6144
    ds_read_b64_tr_b16 a[252:253], v6 offset:0
    v_mfma_f32_16x16x32_bf16 v[92:95], a[220:223], a[172:175], v[92:95]
    v_mfma_f32_16x16x32_bf16 v[92:95], a[224:227], a[176:179], v[92:95]
    v_mfma_f32_16x16x32_bf16 v[92:95], a[228:231], a[180:183], v[92:95]
    v_mfma_f32_16x16x32_bf16 v[92:95], a[232:235], a[184:187], v[92:95]
    v_mfma_f32_16x16x32_bf16 v[92:95], a[236:239], a[188:191], v[92:95]
    s_cbranch_scc1 L_loop4w0
    s_cmp_ge_u32 s69, 8
    s_cbranch_scc1 L_end4
    s_cmp_eq_u32 s40, 0
    s_cbranch_scc1 L_tr43
    s_branch L_tr44
    .p2align 6
L_loop4w1:
    s_waitcnt lgkmcnt(4)
    v_mfma_f32_16x16x32_bf16 v[160:163], a[240:243], v[96:99], v[160:163]
    s_add_u32 m0, s33, s31
    ds_read_b128 a[192:195], v1 offset:0
    ds_read_b128 a[196:199], v2 offset:0
    v_mfma_f32_16x16x32_bf16 v[208:211], a[240:243], v[100:103], v[208:211]
    ds_read_b128 a[200:203], v1 offset:1024
    ds_read_b128 a[204:207], v2 offset:1024
    v_mfma_f32_16x16x32_bf16 a[0:3], a[240:243], v[104:107], a[0:3]
    ds_read_b128 a[208:211], v1 offset:2048
    ds_read_b128 a[212:215], v2 offset:2048
    v_mfma_f32_16x16x32_bf16 a[48:51], a[240:243], v[108:111], a[48:51]
    buffer_load_dwordx4 v7, s[20:23], s28 offen offset:0 lds
    v_mfma_f32_16x16x32_bf16 v[164:167], a[244:247], v[96:99], v[164:167]
    ds_read_b64_tr_b16 a[242:243], v3 offset:7168
    ds_read_b64_tr_b16 a[240:241], v3 offset:1024
    v_mfma_f32_16x16x32_bf16 v[212:215], a[244:247], v[100:103], v[212:215]
    ds_read_b128 a[216:219], v1 offset:6144
    ds_read_b128 a[220:223], v2 offset:6144
    v_mfma_f32_16x16x32_bf16 a[4:7], a[244:247], v[104:107], a[4:7]
    ds_read_b128 a[224:227], v1 offset:7168
    ds_read_b128 a[228:231], v2 offset:7168
    v_mfma_f32_16x16x32_bf16 a[52:55], a[244:247], v[108:111], a[52:55]
    s_waitcnt lgkmcnt(12)
    ds_read_b64_tr_b16 a[244:245], v4 offset:1024
    ds_read_b64_tr_b16 a[246:247], v4 offset:7168
    v_mfma_f32_16x16x32_bf16 v[168:171], a[248:251], v[96:99], v[168:171]
    ds_read_b128 a[232:235], v1 offset:8192
    ds_read_b128 a[236:239], v2 offset:8192
    v_mfma_f32_16x16x32_bf16 v[216:219], a[248:251], v[100:103], v[216:219]
    v_fma_f32 v68, v68, s36, v16
    v_fma_f32 v77, v77, s36, v17
    v_mfma_f32_16x16x32_bf16 a[8:11], a[248:251], v[104:107], a[8:11]
    v_exp_f32 v150, v68
    v_mfma_f32_16x16x32_bf16 a[56:59], a[248:251], v[108:111], a[56:59]
    ds_read_b64_tr_b16 a[248:249], v5 offset:1024
    ds_read_b64_tr_b16 a[250:251], v5 offset:7168
    v_mfma_f32_16x16x32_bf16 v[172:175], a[252:255], v[96:99], v[172:175]
    v_fma_f32 v76, v76, s36, v17
    v_fma_f32 v74, v74, s36, v17
    v_mfma_f32_16x16x32_bf16 v[220:223], a[252:255], v[100:103], v[220:223]
    v_fma_f32 v69, v69, s36, v16
    v_fma_f32 v79, v79, s36, v17
    v_mfma_f32_16x16x32_bf16 a[12:15], a[252:255], v[104:107], a[12:15]
    v_fma_f32 v75, v75, s36, v17
    v_fma_f32 v71, v71, s36, v16
    v_mfma_f32_16x16x32_bf16 a[60:63], a[252:255], v[108:111], a[60:63]
    buffer_load_dwordx4 v8, s[20:23], s28 offen offset:1024 lds
    s_waitcnt lgkmcnt(4)
    v_mfma_f32_16x16x32_bf16 v[176:179], a[240:243], v[96:99], v[176:179]
    ds_read_b64_tr_b16 a[254:255], v6 offset:7168
    ds_read_b64_tr_b16 a[252:253], v6 offset:1024
    v_mfma_f32_16x16x32_bf16 v[224:227], a[240:243], v[100:103], v[224:227]
    v_fma_f32 v80, v80, s36, v18
    v_fma_f32 v78, v78, s36, v17
    v_mfma_f32_16x16x32_bf16 a[16:19], a[240:243], v[104:107], a[16:19]
    v_fma_f32 v70, v70, s36, v16
    v_fma_f32 v83, v83, s36, v18
    v_mfma_f32_16x16x32_bf16 a[64:67], a[240:243], v[108:111], a[64:67]
    ds_read_b64_tr_b16 a[240:241], v3 offset:2048
    ds_read_b64_tr_b16 a[242:243], v3 offset:8192
    v_mfma_f32_16x16x32_bf16 v[180:183], a[244:247], v[96:99], v[180:183]
    v_exp_f32 v151, v69
    v_mfma_f32_16x16x32_bf16 v[228:231], a[244:247], v[100:103], v[228:231]
    v_cvt_pk_bf16_f32 v114, v150, v151
    v_fma_f32 v82, v82, s36, v18
    v_mfma_f32_16x16x32_bf16 a[20:23], a[244:247], v[104:107], a[20:23]
    v_exp_f32 v149, v77
    v_mfma_f32_16x16x32_bf16 a[68:71], a[244:247], v[108:111], a[68:71]
    s_waitcnt lgkmcnt(4)
    ds_read_b64_tr_b16 a[246:247], v4 offset:8192
    ds_read_b64_tr_b16 a[244:245], v4 offset:2048
    v_mfma_f32_16x16x32_bf16 v[184:187], a[248:251], v[96:99], v[184:187]
    v_fma_f32 v85, v85, s36, v18
    v_fma_f32 v86, v86, s36, v18
    v_mfma_f32_16x16x32_bf16 v[232:235], a[248:251], v[100:103], v[232:235]
    v_exp_f32 v147, v75
    v_mfma_f32_16x16x32_bf16 a[24:27], a[248:251], v[104:107], a[24:27]
    v_fma_f32 v84, v84, s36, v18
    v_fma_f32 v92, v92, s36, v19
    v_mfma_f32_16x16x32_bf16 a[72:75], a[248:251], v[108:111], a[72:75]
    s_waitcnt lgkmcnt(3)
    ds_read_b64_tr_b16 a[250:251], v5 offset:8192
    ds_read_b64_tr_b16 a[248:249], v5 offset:2048
    v_mfma_f32_16x16x32_bf16 v[188:191], a[252:255], v[96:99], v[188:191]
    buffer_load_dwordx4 v9, s[20:23], s28 offen offset:2048 lds
    v_mfma_f32_16x16x32_bf16 v[236:239], a[252:255], v[100:103], v[236:239]
    s_add_u32 m0, s33, s32
    v_exp_f32 v145, v71
    v_mfma_f32_16x16x32_bf16 a[28:31], a[252:255], v[104:107], a[28:31]
    v_fma_f32 v94, v94, s36, v19
    v_fma_f32 v81, v81, s36, v18
    v_mfma_f32_16x16x32_bf16 a[76:79], a[252:255], v[108:111], a[76:79]
    s_waitcnt lgkmcnt(2)
    ds_read_b64_tr_b16 a[254:255], v6 offset:8192
    ds_read_b64_tr_b16 a[252:253], v6 offset:2048
    v_mfma_f32_16x16x32_bf16 v[192:195], a[240:243], v[96:99], v[192:195]
    v_fma_f32 v88, v88, s36, v19
    v_fma_f32 v87, v87, s36, v18
    v_mfma_f32_16x16x32_bf16 v[240:243], a[240:243], v[100:103], v[240:243]
    v_exp_f32 v151, v79
    v_mfma_f32_16x16x32_bf16 a[32:35], a[240:243], v[104:107], a[32:35]
    v_fma_f32 v91, v91, s36, v19
    v_fma_f32 v95, v95, s36, v19
    v_mfma_f32_16x16x32_bf16 a[80:83], a[240:243], v[108:111], a[80:83]
    v_exp_f32 v150, v78
    v_mfma_f32_16x16x32_bf16 v[196:199], a[244:247], v[96:99], v[196:199]
    v_cvt_pk_bf16_f32 v119, v150, v151
    v_fma_f32 v93, v93, s36, v19
    v_mfma_f32_16x16x32_bf16 v[244:247], a[244:247], v[100:103], v[244:247]
    v_exp_f32 v144, v70
    v_mfma_f32_16x16x32_bf16 a[36:39], a[244:247], v[104:107], a[36:39]
    v_cvt_pk_bf16_f32 v115, v144, v145
    v_fma_f32 v89, v89, s36, v19
    v_mfma_f32_16x16x32_bf16 a[84:87], a[244:247], v[108:111], a[84:87]
    s_waitcnt lgkmcnt(1)
    v_exp_f32 v148, v76
    v_mfma_f32_16x16x32_bf16 v[200:203], a[248:251], v[96:99], v[200:203]
    buffer_load_dwordx4 v10, s[24:27], s29 offen offset:0 lds
    v_mfma_f32_16x16x32_bf16 v[248:251], a[248:251], v[100:103], v[248:251]
    v_cvt_pk_bf16_f32 v118, v148, v149
    v_fma_f32 v90, v90, s36, v19
    v_mfma_f32_16x16x32_bf16 a[40:43], a[248:251], v[104:107], a[40:43]
    v_exp_f32 v148, v84
    v_mfma_f32_16x16x32_bf16 a[88:91], a[248:251], v[108:111], a[88:91]
    s_waitcnt lgkmcnt(0)
    v_exp_f32 v146, v74
    v_mfma_f32_16x16x32_bf16 v[204:207], a[252:255], v[96:99], v[204:207]
    v_cvt_pk_bf16_f32 v117, v146, v147
    v_add_f32 v20, v20, v128
    v_mfma_f32_16x16x32_bf16 v[128:131], v[24:27], v[112:115], 0
    v_exp_f32 v146, v82
    v_mfma_f32_16x16x32_bf16 v[252:255], a[252:255], v[100:103], v[252:255]
    v_exp_f32 v151, v87
    v_mfma_f32_16x16x32_bf16 a[44:47], a[252:255], v[104:107], a[44:47]
    v_exp_f32 v144, v80
    v_mfma_f32_16x16x32_bf16 a[92:95], a[252:255], v[108:111], a[92:95]
    v_exp_f32 v147, v83
    v_mfma_f32_16x16x32_bf16 v[32:35], a[192:195], a[96:99], 0
    v_cvt_pk_bf16_f32 v121, v146, v147
    v_add_f32 v23, v23, v140
    v_mfma_f32_16x16x32_bf16 v[32:35], a[196:199], a[100:103], v[32:35]
    v_exp_f32 v150, v86
    v_mfma_f32_16x16x32_bf16 v[32:35], a[200:203], a[104:107], v[32:35]
    v_cvt_pk_bf16_f32 v123, v150, v151
    v_add_f32 v22, v22, v136
    v_mfma_f32_16x16x32_bf16 v[32:35], a[204:207], a[108:111], v[32:35]
    v_exp_f32 v146, v90
    v_mfma_f32_16x16x32_bf16 v[32:35], a[208:211], a[112:115], v[32:35]
    buffer_load_dwordx4 v11, s[24:27], s29 offen offset:1024 lds
    v_mfma_f32_16x16x32_bf16 v[32:35], a[212:215], a[116:119], v[32:35]
    v_exp_f32 v145, v81
    v_mfma_f32_16x16x32_bf16 v[40:43], a[192:195], a[120:123], 0
    v_cvt_pk_bf16_f32 v120, v144, v145
    v_add_f32 v21, v21, v132
    v_mfma_f32_16x16x32_bf16 v[132:135], v[24:27], v[116:119], 0
    v_exp_f32 v149, v85
    v_mfma_f32_16x16x32_bf16 v[40:43], a[196:199], a[124:127], v[40:43]
    v_cvt_pk_bf16_f32 v122, v148, v149
    v_mfma_f32_16x16x32_bf16 v[40:43], a[200:203], a[128:131], v[40:43]
    v_exp_f32 v149, v93
    v_mfma_f32_16x16x32_bf16 v[136:139], v[24:27], v[120:123], 0
    v_exp_f32 v148, v92
    v_mfma_f32_16x16x32_bf16 v[40:43], a[204:207], a[132:135], v[40:43]
    v_cvt_pk_bf16_f32 v126, v148, v149
    v_mfma_f32_16x16x32_bf16 v[40:43], a[208:211], a[136:139], v[40:43]
    v_exp_f32 v147, v91
    v_mfma_f32_16x16x32_bf16 v[40:43], a[212:215], a[140:143], v[40:43]
    v_exp_f32 v145, v89
    v_mfma_f32_16x16x32_bf16 v[48:51], a[192:195], a[144:147], 0
    v_max3_f32 v30, v128, v132, v136
    v_cvt_pk_bf16_f32 v125, v146, v147
    v_mfma_f32_16x16x32_bf16 v[48:51], a[196:199], a[148:151], v[48:51]
    v_exp_f32 v144, v88
    v_mfma_f32_16x16x32_bf16 v[48:51], a[200:203], a[152:155], v[48:51]
    buffer_load_dwordx4 v12, s[24:27], s29 offen offset:2048 lds
    v_mfma_f32_16x16x32_bf16 v[48:51], a[204:207], a[156:159], v[48:51]
    s_add_u32 s28, s28, s30
    v_cvt_pk_bf16_f32 v124, v144, v145
    v_mfma_f32_16x16x32_bf16 v[48:51], a[208:211], a[160:163], v[48:51]
    s_add_u32 s29, s29, s30
    v_exp_f32 v150, v94
    v_mfma_f32_16x16x32_bf16 v[48:51], a[212:215], a[164:167], v[48:51]
    s_add_u32 s33, s33, 24576
    v_exp_f32 v151, v95
    v_mfma_f32_16x16x32_bf16 v[56:59], a[192:195], a[168:171], 0
    s_cmp_eq_u32 s33, 147456
    v_cvt_pk_bf16_f32 v127, v150, v151
    v_mfma_f32_16x16x32_bf16 v[56:59], a[196:199], a[172:175], v[56:59]
    s_cselect_b32 s33, 0, s33
    v_mfma_f32_16x16x32_bf16 v[140:143], v[24:27], v[124:127], 0
    v_mfma_f32_16x16x32_bf16 v[56:59], a[200:203], a[176:179], v[56:59]
    v_mfma_f32_16x16x32_bf16 v[56:59], a[204:207], a[180:183], v[56:59]
    v_mfma_f32_16x16x32_bf16 v[56:59], a[208:211], a[184:187], v[56:59]
    v_mfma_f32_16x16x32_bf16 v[56:59], a[212:215], a[188:191], v[56:59]
    v_mfma_f32_16x16x32_bf16 v[36:39], a[216:219], a[96:99], 0
    v_mfma_f32_16x16x32_bf16 v[36:39], a[220:223], a[100:103], v[36:39]
    v_mfma_f32_16x16x32_bf16 v[36:39], a[224:227], a[104:107], v[36:39]
    v_mfma_f32_16x16x32_bf16 v[36:39], a[228:231], a[108:111], v[36:39]
    v_max_f32 v30, v30, v140
    v_cmp_lt_f32 vcc, s37, v30
    v_mfma_f32_16x16x32_bf16 v[36:39], a[232:235], a[112:115], v[36:39]
    v_mfma_f32_16x16x32_bf16 v[36:39], a[236:239], a[116:119], v[36:39]
    s_waitcnt vmcnt(18)
    s_barrier
    v_mfma_f32_16x16x32_bf16 v[44:47], a[216:219], a[120:123], 0
    s_cbranch_vccnz L_rs_loop4w1a
L_ret_loop4w1a:
    s_cmp_ge_u32 s38, 4
    s_cbranch_scc1 L_mode4w1
L_modeback4w1:
    v_mfma_f32_16x16x32_bf16 v[44:47], a[220:223], a[124:127], v[44:47]
    v_fma_f32 v35, v35, s36, v16
    v_fma_f32 v41, v41, s36, v17
    v_mfma_f32_16x16x32_bf16 v[44:47], a[224:227], a[128:131], v[44:47]
    v_fma_f32 v40, v40, s36, v17
    v_fma_f32 v32, v32, s36, v16
    v_mfma_f32_16x16x32_bf16 v[44:47], a[228:231], a[132:135], v[44:47]
    v_fma_f32 v34, v34, s36, v16
    v_fma_f32 v33, v33, s36, v16
    v_mfma_f32_16x16x32_bf16 v[44:47], a[232:235], a[136:139], v[44:47]
    v_exp_f32 v145, v33
    v_mfma_f32_16x16x32_bf16 v[44:47], a[236:239], a[140:143], v[44:47]
    v_exp_f32 v144, v32
    v_mfma_f32_16x16x32_bf16 v[52:55], a[216:219], a[144:147], 0
    ds_read_b64_tr_b16 a[240:241], v3 offset:24576
    ds_read_b64_tr_b16 a[242:243], v3 offset:30720
    v_mfma_f32_16x16x32_bf16 v[52:55], a[220:223], a[148:151], v[52:55]
    v_cvt_pk_bf16_f32 v96, v144, v145
    v_mfma_f32_16x16x32_bf16 v[52:55], a[224:227], a[152:155], v[52:55]
    ds_read_b64_tr_b16 a[244:245], v4 offset:24576
    ds_read_b64_tr_b16 a[246:247], v4 offset:30720
    v_mfma_f32_16x16x32_bf16 v[52:55], a[228:231], a[156:159], v[52:55]
    v_exp_f32 v149, v41
    v_mfma_f32_16x16x32_bf16 v[52:55], a[232:235], a[160:163], v[52:55]
    ds_read_b64_tr_b16 a[250:251], v5 offset:30720
    ds_read_b64_tr_b16 a[248:249], v5 offset:24576
    v_mfma_f32_16x16x32_bf16 v[52:55], a[236:239], a[164:167], v[52:55]
    v_exp_f32 v146, v34
    v_mfma_f32_16x16x32_bf16 v[60:63], a[216:219], a[168:171], 0
    ds_read_b64_tr_b16 a[254:255], v6 offset:30720
    ds_read_b64_tr_b16 a[252:253], v6 offset:24576
    v_mfma_f32_16x16x32_bf16 v[60:63], a[220:223], a[172:175], v[60:63]
    v_exp_f32 v147, v35
    v_mfma_f32_16x16x32_bf16 v[60:63], a[224:227], a[176:179], v[60:63]
    v_cvt_pk_bf16_f32 v97, v146, v147
    v_mfma_f32_16x16x32_bf16 v[60:63], a[228:231], a[180:183], v[60:63]
    v_exp_f32 v148, v40
    v_mfma_f32_16x16x32_bf16 v[60:63], a[232:235], a[184:187], v[60:63]
    v_cvt_pk_bf16_f32 v100, v148, v149
    v_mfma_f32_16x16x32_bf16 v[60:63], a[236:239], a[188:191], v[60:63]
    s_waitcnt lgkmcnt(4)
    v_mfma_f32_16x16x32_bf16 v[160:163], a[240:243], v[112:115], v[160:163]
    s_add_u32 s62, s34, 49152
    ds_read_b128 a[192:195], v1 offset:24576
    ds_read_b128 a[196:199], v2 offset:24576
    v_mfma_f32_16x16x32_bf16 v[208:211], a[240:243], v[116:119], v[208:211]
    s_cmp_eq_u32 s62, 147456
    ds_read_b128 a[200:203], v1 offset:25600
    ds_read_b128 a[204:207], v2 offset:25600
    v_mfma_f32_16x16x32_bf16 a[0:3], a[240:243], v[120:123], a[0:3]
    s_cselect_b32 s62, 0, s62
    ds_read_b128 a[208:211], v1 offset:26624
    ds_read_b128 a[212:215], v2 offset:26624
    v_mfma_f32_16x16x32_bf16 a[48:51], a[240:243], v[124:127], a[48:51]
    s_sub_u32 s58, s62, s34
    ds_read_b64_tr_b16 a[240:241], v3 offset:25600
    ds_read_b64_tr_b16 a[242:243], v3 offset:31744
    v_mfma_f32_16x16x32_bf16 v[164:167], a[244:247], v[112:115], v[164:167]
    s_mov_b32 s34, s62
    ds_read_b128 a[216:219], v1 offset:30720
    ds_read_b128 a[220:223], v2 offset:30720
    v_mfma_f32_16x16x32_bf16 v[212:215], a[244:247], v[116:119], v[212:215]
    s_add_u32 m0, s33, s31
    ds_read_b128 a[224:227], v1 offset:31744
    ds_read_b128 a[228:231], v2 offset:31744
    v_mfma_f32_16x16x32_bf16 a[4:7], a[244:247], v[120:123], a[4:7]
    buffer_load_dwordx4 v7, s[20:23], s28 offen offset:0 lds
    v_mfma_f32_16x16x32_bf16 a[52:55], a[244:247], v[124:127], a[52:55]
    s_waitcnt lgkmcnt(12)
    ds_read_b64_tr_b16 a[244:245], v4 offset:25600
    ds_read_b64_tr_b16 a[246:247], v4 offset:31744
    v_mfma_f32_16x16x32_bf16 v[168:171], a[248:251], v[112:115], v[168:171]
    ds_read_b128 a[232:235], v1 offset:32768
    ds_read_b128 a[236:239], v2 offset:32768
    v_mfma_f32_16x16x32_bf16 v[216:219], a[248:251], v[116:119], v[216:219]
    v_fma_f32 v36, v36, s36, v16
    v_fma_f32 v37, v37, s36, v16
    v_mfma_f32_16x16x32_bf16 a[8:11], a[248:251], v[120:123], a[8:11]
    v_exp_f32 v150, v36
    v_mfma_f32_16x16x32_bf16 a[56:59], a[248:251], v[124:127], a[56:59]
    ds_read_b64_tr_b16 a[248:249], v5 offset:25600
    ds_read_b64_tr_b16 a[250:251], v5 offset:31744
    v_mfma_f32_16x16x32_bf16 v[172:175], a[252:255], v[112:115], v[172:175]
    v_exp_f32 v151, v37
    v_mfma_f32_16x16x32_bf16 v[220:223], a[252:255], v[116:119], v[220:223]
    v_cvt_pk_bf16_f32 v98, v150, v151
    v_fma_f32 v38, v38, s36, v16
    v_mfma_f32_16x16x32_bf16 a[12:15], a[252:255], v[120:123], a[12:15]
    v_fma_f32 v39, v39, s36, v16
    v_fma_f32 v42, v42, s36, v17
    v_mfma_f32_16x16x32_bf16 a[60:63], a[252:255], v[124:127], a[60:63]
    buffer_load_dwordx4 v8, s[20:23], s28 offen offset:1024 lds
    s_waitcnt lgkmcnt(4)
    v_mfma_f32_16x16x32_bf16 v[176:179], a[240:243], v[112:115], v[176:179]
    ds_read_b64_tr_b16 a[252:253], v6 offset:25600
    ds_read_b64_tr_b16 a[254:255], v6 offset:31744
    v_mfma_f32_16x16x32_bf16 v[224:227], a[240:243], v[116:119], v[224:227]
    v_fma_f32 v43, v43, s36, v17
    v_fma_f32 v44, v44, s36, v17
    v_mfma_f32_16x16x32_bf16 a[16:19], a[240:243], v[120:123], a[16:19]
    v_fma_f32 v45, v45, s36, v17
    v_fma_f32 v46, v46, s36, v17
    v_mfma_f32_16x16x32_bf16 a[64:67], a[240:243], v[124:127], a[64:67]
    ds_read_b64_tr_b16 a[240:241], v3 offset:26624
    ds_read_b64_tr_b16 a[242:243], v3 offset:32768
    v_mfma_f32_16x16x32_bf16 v[180:183], a[244:247], v[112:115], v[180:183]
    v_fma_f32 v47, v47, s36, v17
    v_fma_f32 v48, v48, s36, v18
    v_mfma_f32_16x16x32_bf16 v[228:231], a[244:247], v[116:119], v[228:231]
    v_exp_f32 v144, v38
    v_mfma_f32_16x16x32_bf16 a[20:23], a[244:247], v[120:123], a[20:23]
    v_exp_f32 v145, v39
    v_mfma_f32_16x16x32_bf16 a[68:71], a[244:247], v[124:127], a[68:71]
    s_waitcnt lgkmcnt(4)
    ds_read_b64_tr_b16 a[244:245], v4 offset:26624
    ds_read_b64_tr_b16 a[246:247], v4 offset:32768
    v_mfma_f32_16x16x32_bf16 v[184:187], a[248:251], v[112:115], v[184:187]
    v_exp_f32 v146, v42
    v_mfma_f32_16x16x32_bf16 v[232:235], a[248:251], v[116:119], v[232:235]
    v_exp_f32 v147, v43
    v_mfma_f32_16x16x32_bf16 a[24:27], a[248:251], v[120:123], a[24:27]
    v_exp_f32 v148, v44
    v_mfma_f32_16x16x32_bf16 a[72:75], a[248:251], v[124:127], a[72:75]
    s_waitcnt lgkmcnt(3)
    ds_read_b64_tr_b16 a[248:249], v5 offset:26624
    ds_read_b64_tr_b16 a[250:251], v5 offset:32768
    v_mfma_f32_16x16x32_bf16 v[188:191], a[252:255], v[112:115], v[188:191]
    buffer_load_dwordx4 v9, s[20:23], s28 offen offset:2048 lds
    v_mfma_f32_16x16x32_bf16 v[236:239], a[252:255], v[116:119], v[236:239]
    s_add_u32 m0, s33, s32
    v_exp_f32 v149, v45
    v_mfma_f32_16x16x32_bf16 a[28:31], a[252:255], v[120:123], a[28:31]
    v_exp_f32 v150, v46
    v_mfma_f32_16x16x32_bf16 a[76:79], a[252:255], v[124:127], a[76:79]
    s_waitcnt lgkmcnt(2)
    ds_read_b64_tr_b16 a[252:253], v6 offset:26624
    ds_read_b64_tr_b16 a[254:255], v6 offset:32768
    v_mfma_f32_16x16x32_bf16 v[192:195], a[240:243], v[112:115], v[192:195]
    v_exp_f32 v151, v47
    v_mfma_f32_16x16x32_bf16 v[240:243], a[240:243], v[116:119], v[240:243]
    v_cvt_pk_bf16_f32 v99, v144, v145
    v_cvt_pk_bf16_f32 v101, v146, v147
    v_mfma_f32_16x16x32_bf16 a[32:35], a[240:243], v[120:123], a[32:35]
    v_cvt_pk_bf16_f32 v102, v148, v149
    v_cvt_pk_bf16_f32 v103, v150, v151
    v_mfma_f32_16x16x32_bf16 a[80:83], a[240:243], v[124:127], a[80:83]
    v_fma_f32 v49, v49, s36, v18
    v_fma_f32 v50, v50, s36, v18
    v_mfma_f32_16x16x32_bf16 v[196:199], a[244:247], v[112:115], v[196:199]
    v_fma_f32 v51, v51, s36, v18
    v_fma_f32 v52, v52, s36, v18
    v_mfma_f32_16x16x32_bf16 v[244:247], a[244:247], v[116:119], v[244:247]
    v_fma_f32 v53, v53, s36, v18
    v_fma_f32 v54, v54, s36, v18
    v_mfma_f32_16x16x32_bf16 a[36:39], a[244:247], v[120:123], a[36:39]
    v_fma_f32 v55, v55, s36, v18
    v_fma_f32 v56, v56, s36, v19
    v_mfma_f32_16x16x32_bf16 a[84:87], a[244:247], v[124:127], a[84:87]
    s_waitcnt lgkmcnt(1)
    v_exp_f32 v144, v48
    v_mfma_f32_16x16x32_bf16 v[200:203], a[248:251], v[112:115], v[200:203]
    buffer_load_dwordx4 v10, s[24:27], s29 offen offset:0 lds
    v_mfma_f32_16x16x32_bf16 v[248:251], a[248:251], v[116:119], v[248:251]
    v_exp_f32 v145, v49
    v_mfma_f32_16x16x32_bf16 a[40:43], a[248:251], v[120:123], a[40:43]
    v_exp_f32 v146, v50
    v_mfma_f32_16x16x32_bf16 a[88:91], a[248:251], v[124:127], a[88:91]
    s_waitcnt lgkmcnt(0)
    v_exp_f32 v147, v51
    v_mfma_f32_16x16x32_bf16 v[204:207], a[252:255], v[112:115], v[204:207]
    v_exp_f32 v148, v52
    v_mfma_f32_16x16x32_bf16 v[252:255], a[252:255], v[116:119], v[252:255]
    v_exp_f32 v149, v53
    v_mfma_f32_16x16x32_bf16 a[44:47], a[252:255], v[120:123], a[44:47]
    v_exp_f32 v150, v54
    v_mfma_f32_16x16x32_bf16 a[92:95], a[252:255], v[124:127], a[92:95]
    v_exp_f32 v151, v55
    v_mfma_f32_16x16x32_bf16 v[64:67], a[192:195], a[96:99], 0
    v_cvt_pk_bf16_f32 v104, v144, v145
    v_cvt_pk_bf16_f32 v105, v146, v147
    v_mfma_f32_16x16x32_bf16 v[64:67], a[196:199], a[100:103], v[64:67]
    v_cvt_pk_bf16_f32 v106, v148, v149
    v_cvt_pk_bf16_f32 v107, v150, v151
    v_mfma_f32_16x16x32_bf16 v[64:67], a[200:203], a[104:107], v[64:67]
    v_fma_f32 v57, v57, s36, v19
    v_fma_f32 v58, v58, s36, v19
    v_mfma_f32_16x16x32_bf16 v[64:67], a[204:207], a[108:111], v[64:67]
    v_fma_f32 v59, v59, s36, v19
    v_fma_f32 v60, v60, s36, v19
    v_mfma_f32_16x16x32_bf16 v[64:67], a[208:211], a[112:115], v[64:67]
    v_fma_f32 v61, v61, s36, v19
    v_fma_f32 v62, v62, s36, v19
    v_mfma_f32_16x16x32_bf16 v[64:67], a[212:215], a[116:119], v[64:67]
    buffer_load_dwordx4 v11, s[24:27], s29 offen offset:1024 lds
    v_mfma_f32_16x16x32_bf16 v[72:75], a[192:195], a[120:123], 0
    v_fma_f32 v63, v63, s36, v19
    v_add_f32 v20, v20, v128
    v_mfma_f32_16x16x32_bf16 v[128:131], v[24:27], v[96:99], 0
    v_exp_f32 v144, v56
    v_mfma_f32_16x16x32_bf16 v[72:75], a[196:199], a[124:127], v[72:75]
    v_exp_f32 v145, v57
    v_mfma_f32_16x16x32_bf16 v[72:75], a[200:203], a[128:131], v[72:75]
    v_exp_f32 v146, v58
    v_mfma_f32_16x16x32_bf16 v[72:75], a[204:207], a[132:135], v[72:75]
    v_exp_f32 v147, v59
    v_mfma_f32_16x16x32_bf16 v[72:75], a[208:211], a[136:139], v[72:75]
    v_exp_f32 v148, v60
    v_mfma_f32_16x16x32_bf16 v[72:75], a[212:215], a[140:143], v[72:75]
    v_exp_f32 v149, v61
    v_mfma_f32_16x16x32_bf16 v[80:83], a[192:195], a[144:147], 0
    v_exp_f32 v150, v62
    v_mfma_f32_16x16x32_bf16 v[80:83], a[196:199], a[148:151], v[80:83]
    v_exp_f32 v151, v63
    v_mfma_f32_16x16x32_bf16 v[80:83], a[200:203], a[152:155], v[80:83]
    v_cvt_pk_bf16_f32 v108, v144, v145
    v_cvt_pk_bf16_f32 v109, v146, v147
    v_mfma_f32_16x16x32_bf16 v[80:83], a[204:207], a[156:159], v[80:83]
    v_cvt_pk_bf16_f32 v110, v148, v149
    v_cvt_pk_bf16_f32 v111, v150, v151
    v_mfma_f32_16x16x32_bf16 v[80:83], a[208:211], a[160:163], v[80:83]
    buffer_load_dwordx4 v12, s[24:27], s29 offen offset:2048 lds
    v_mfma_f32_16x16x32_bf16 v[80:83], a[212:215], a[164:167], v[80:83]
    s_add_u32 s28, s28, s30
    v_add_f32 v21, v21, v132
    v_add_f32 v22, v22, v136
    v_mfma_f32_16x16x32_bf16 v[132:135], v[24:27], v[100:103], 0
    s_add_u32 s29, s29, s30
    v_add_f32 v23, v23, v140
    v_add_u32 v3, s58, v3
    v_mfma_f32_16x16x32_bf16 v[136:139], v[24:27], v[104:107], 0
    s_add_u32 s33, s33, 24576
    v_add_u32 v4, s58, v4
    v_add_u32 v5, s58, v5
    v_mfma_f32_16x16x32_bf16 v[140:143], v[24:27], v[108:111], 0
    s_cmp_eq_u32 s33, 147456
    v_add_u32 v6, s58, v6
    v_add_u32 v1, s58, v1
    v_mfma_f32_16x16x32_bf16 v[88:91], a[192:195], a[168:171], 0
    s_cselect_b32 s33, 0, s33
    v_max3_f32 v30, v128, v132, v136
    v_add_u32 v2, s58, v2
    v_mfma_f32_16x16x32_bf16 v[88:91], a[196:199], a[172:175], v[88:91]
    v_max_f32 v30, v30, v140
    v_cmp_lt_f32 vcc, s37, v30
    v_mfma_f32_16x16x32_bf16 v[88:91], a[200:203], a[176:179], v[88:91]
    v_mfma_f32_16x16x32_bf16 v[88:91], a[204:207], a[180:183], v[88:91]
    v_mfma_f32_16x16x32_bf16 v[88:91], a[208:211], a[184:187], v[88:91]
    v_mfma_f32_16x16x32_bf16 v[88:91], a[212:215], a[188:191], v[88:91]
    v_mfma_f32_16x16x32_bf16 v[68:71], a[216:219], a[96:99], 0
    s_cbranch_vccnz L_rs_loop4w1b
L_ret_loop4w1b:
    s_add_u32 s38, s38, 1
    s_cmp_lt_u32 s38, 6
    v_mfma_f32_16x16x32_bf16 v[68:71], a[220:223], a[100:103], v[68:71]
    v_fma_f32 v64, v64, s36, v16
    v_fma_f32 v65, v65, s36, v16
    v_mfma_f32_16x16x32_bf16 v[68:71], a[224:227], a[104:107], v[68:71]
    v_fma_f32 v66, v66, s36, v16
    v_fma_f32 v67, v67, s36, v16
    v_mfma_f32_16x16x32_bf16 v[68:71], a[228:231], a[108:111], v[68:71]
    v_fma_f32 v72, v72, s36, v17
    v_fma_f32 v73, v73, s36, v17
    v_mfma_f32_16x16x32_bf16 v[68:71], a[232:235], a[112:115], v[68:71]
    v_exp_f32 v144, v64
    s_waitcnt vmcnt(18)
    s_barrier
    v_mfma_f32_16x16x32_bf16 v[68:71], a[236:239], a[116:119], v[68:71]
    v_exp_f32 v145, v65
    v_mfma_f32_16x16x32_bf16 v[76:79], a[216:219], a[120:123], 0
    v_exp_f32 v146, v66
    v_mfma_f32_16x16x32_bf16 v[76:79], a[220:223], a[124:127], v[76:79]
    v_exp_f32 v147, v67
    v_mfma_f32_16x16x32_bf16 v[76:79], a[224:227], a[128:131], v[76:79]
    v_exp_f32 v148, v72
    v_mfma_f32_16x16x32_bf16 v[76:79], a[228:231], a[132:135], v[76:79]
    v_exp_f32 v149, v73
    v_mfma_f32_16x16x32_bf16 v[76:79], a[232:235], a[136:139], v[76:79]
    v_cvt_pk_bf16_f32 v112, v144, v145
    v_cvt_pk_bf16_f32 v113, v146, v147
    v_mfma_f32_16x16x32_bf16 v[76:79], a[236:239], a[140:143], v[76:79]
    ds_read_b64_tr_b16 a[240:241], v3 offset:0
    ds_read_b64_tr_b16 a[242:243], v3 offset:6144
    v_mfma_f32_16x16x32_bf16 v[84:87], a[216:219], a[144:147], 0
    v_cvt_pk_bf16_f32 v116, v148, v149
    v_mfma_f32_16x16x32_bf16 v[84:87], a[220:223], a[148:151], v[84:87]
    ds_read_b64_tr_b16 a[244:245], v4 offset:0
    ds_read_b64_tr_b16 a[246:247], v4 offset:6144
    v_mfma_f32_16x16x32_bf16 v[84:87], a[224:227], a[152:155], v[84:87]
    v_mfma_f32_16x16x32_bf16 v[84:87], a[228:231], a[156:159], v[84:87]
    ds_read_b64_tr_b16 a[248:249], v5 offset:0
    ds_read_b64_tr_b16 a[250:251], v5 offset:6144
    v_mfma_f32_16x16x32_bf16 v[84:87], a[232:235], a[160:163], v[84:87]
    v_mfma_f32_16x16x32_bf16 v[84:87], a[236:239], a[164:167], v[84:87]
    ds_read_b64_tr_b16 a[252:253], v6 offset:0
    ds_read_b64_tr_b16 a[254:255], v6 offset:6144
    v_mfma_f32_16x16x32_bf16 v[92:95], a[216:219], a[168:171], 0
    v_mfma_f32_16x16x32_bf16 v[92:95], a[220:223], a[172:175], v[92:95]
    v_mfma_f32_16x16x32_bf16 v[92:95], a[224:227], a[176:179], v[92:95]
    v_mfma_f32_16x16x32_bf16 v[92:95], a[228:231], a[180:183], v[92:95]
    v_mfma_f32_16x16x32_bf16 v[92:95], a[232:235], a[184:187], v[92:95]
    v_mfma_f32_16x16x32_bf16 v[92:95], a[236:239], a[188:191], v[92:95]
    s_cbranch_scc1 L_loop4w1
    s_cmp_ge_u32 s69, 8
    s_cbranch_scc1 L_end4
    s_cmp_eq_u32 s40, 0
    s_cbranch_scc1 L_tr43
    s_branch L_tr44
L_tr43:
    s_waitcnt vmcnt(6)
    s_waitcnt lgkmcnt(4)
    v_mfma_f32_16x16x32_bf16 v[160:163], a[240:243], v[96:99], v[160:163]
    s_add_u32 s65, s34, 24576
    v_add_u32 v28, s35, v1
    v_add_u32 v29, s35, v2
    ds_read_b128 a[96:99], v28 offset:24576
    ds_read_b128 a[100:103], v29 offset:24576
    ds_read_b128 a[104:107], v28 offset:25600
    ds_read_b128 a[108:111], v29 offset:25600
    ds_read_b128 a[112:115], v28 offset:26624
    ds_read_b128 a[116:119], v29 offset:26624
    v_mfma_f32_16x16x32_bf16 v[208:211], a[240:243], v[100:103], v[208:211]
    s_add_u32 s62, s34, 49152
    v_fma_f32 v68, v68, s36, v16
    v_fma_f32 v69, v69, s36, v16
    v_mfma_f32_16x16x32_bf16 a[0:3], a[240:243], v[104:107], a[0:3]
    s_cmp_eq_u32 s62, 147456
    v_exp_f32 v150, v68
    v_mfma_f32_16x16x32_bf16 a[48:51], a[240:243], v[108:111], a[48:51]
    s_cselect_b32 s62, 0, s62
    ds_read_b64_tr_b16 a[240:241], v3 offset:1024
    ds_read_b64_tr_b16 a[242:243], v3 offset:7168
    v_mfma_f32_16x16x32_bf16 v[164:167], a[244:247], v[96:99], v[164:167]
    s_sub_u32 s56, s62, s34
    v_exp_f32 v151, v69
    v_mfma_f32_16x16x32_bf16 v[212:215], a[244:247], v[100:103], v[212:215]
    s_mov_b32 s34, s62
    v_cvt_pk_bf16_f32 v114, v150, v151
    v_fma_f32 v70, v70, s36, v16
    v_mfma_f32_16x16x32_bf16 a[4:7], a[244:247], v[104:107], a[4:7]
    s_and_b32 s63, s3, 1
    v_fma_f32 v71, v71, s36, v16
    v_fma_f32 v74, v74, s36, v17
    v_mfma_f32_16x16x32_bf16 a[52:55], a[244:247], v[108:111], a[52:55]
    s_mul_i32 s63, s63, 3072
    ds_read_b64_tr_b16 a[244:245], v4 offset:1024
    ds_read_b64_tr_b16 a[246:247], v4 offset:7168
    s_waitcnt lgkmcnt(10)
    v_mfma_f32_16x16x32_bf16 v[168:171], a[248:251], v[96:99], v[168:171]
    s_add_u32 s67, s41, 12288
    v_fma_f32 v75, v75, s36, v17
    v_fma_f32 v76, v76, s36, v17
    v_mfma_f32_16x16x32_bf16 v[216:219], a[248:251], v[100:103], v[216:219]
    s_add_u32 s68, s67, s63
    v_fma_f32 v77, v77, s36, v17
    v_fma_f32 v78, v78, s36, v17
    v_mfma_f32_16x16x32_bf16 a[8:11], a[248:251], v[104:107], a[8:11]
    s_add_u32 s64, s65, s35
    v_fma_f32 v79, v79, s36, v17
    v_fma_f32 v80, v80, s36, v18
    v_mfma_f32_16x16x32_bf16 a[56:59], a[248:251], v[108:111], a[56:59]
    s_add_u32 s64, s64, 0
    ds_read_b64_tr_b16 a[248:249], v5 offset:1024
    ds_read_b64_tr_b16 a[250:251], v5 offset:7168
    v_mfma_f32_16x16x32_bf16 v[172:175], a[252:255], v[96:99], v[172:175]
    s_add_u32 m0, s64, s63
    v_exp_f32 v144, v70
    v_mfma_f32_16x16x32_bf16 v[220:223], a[252:255], v[100:103], v[220:223]
    s_waitcnt lgkmcnt(4)
    buffer_load_dwordx4 v7, s[12:15], s68 offen offset:0 nt lds
    v_mfma_f32_16x16x32_bf16 a[12:15], a[252:255], v[104:107], a[12:15]
    buffer_load_dwordx4 v8, s[12:15], s68 offen offset:1024 nt lds
    v_mfma_f32_16x16x32_bf16 a[60:63], a[252:255], v[108:111], a[60:63]
    buffer_load_dwordx4 v9, s[12:15], s68 offen offset:2048 nt lds
    v_mfma_f32_16x16x32_bf16 v[176:179], a[240:243], v[96:99], v[176:179]
    s_sub_u32 s63, 3072, s63
    ds_read_b64_tr_b16 a[252:253], v6 offset:1024
    ds_read_b64_tr_b16 a[254:255], v6 offset:7168
    v_mfma_f32_16x16x32_bf16 v[224:227], a[240:243], v[100:103], v[224:227]
    s_add_u32 s68, s67, s63
    v_exp_f32 v145, v71
    v_mfma_f32_16x16x32_bf16 a[16:19], a[240:243], v[104:107], a[16:19]
    s_add_u32 m0, s64, s63
    v_exp_f32 v146, v74
    v_mfma_f32_16x16x32_bf16 a[64:67], a[240:243], v[108:111], a[64:67]
    s_waitcnt lgkmcnt(2)
    ds_read_b64_tr_b16 a[240:241], v3 offset:2048
    ds_read_b64_tr_b16 a[242:243], v3 offset:8192
    v_mfma_f32_16x16x32_bf16 v[180:183], a[244:247], v[96:99], v[180:183]
    v_exp_f32 v147, v75
    v_mfma_f32_16x16x32_bf16 v[228:231], a[244:247], v[100:103], v[228:231]
    v_exp_f32 v148, v76
    v_mfma_f32_16x16x32_bf16 a[20:23], a[244:247], v[104:107], a[20:23]
    v_exp_f32 v149, v77
    v_mfma_f32_16x16x32_bf16 a[68:71], a[244:247], v[108:111], a[68:71]
    ds_read_b64_tr_b16 a[244:245], v4 offset:2048
    ds_read_b64_tr_b16 a[246:247], v4 offset:8192
    v_mfma_f32_16x16x32_bf16 v[184:187], a[248:251], v[96:99], v[184:187]
    v_exp_f32 v150, v78
    v_mfma_f32_16x16x32_bf16 v[232:235], a[248:251], v[100:103], v[232:235]
    v_exp_f32 v151, v79
    v_mfma_f32_16x16x32_bf16 a[24:27], a[248:251], v[104:107], a[24:27]
    v_cvt_pk_bf16_f32 v115, v144, v145
    v_cvt_pk_bf16_f32 v117, v146, v147
    v_mfma_f32_16x16x32_bf16 a[72:75], a[248:251], v[108:111], a[72:75]
    s_waitcnt lgkmcnt(3)
    ds_read_b64_tr_b16 a[248:249], v5 offset:2048
    ds_read_b64_tr_b16 a[250:251], v5 offset:8192
    v_mfma_f32_16x16x32_bf16 v[188:191], a[252:255], v[96:99], v[188:191]
    v_cvt_pk_bf16_f32 v118, v148, v149
    v_cvt_pk_bf16_f32 v119, v150, v151
    v_mfma_f32_16x16x32_bf16 v[236:239], a[252:255], v[100:103], v[236:239]
    v_fma_f32 v81, v81, s36, v18
    v_fma_f32 v82, v82, s36, v18
    v_mfma_f32_16x16x32_bf16 a[28:31], a[252:255], v[104:107], a[28:31]
    v_fma_f32 v83, v83, s36, v18
    v_fma_f32 v84, v84, s36, v18
    v_mfma_f32_16x16x32_bf16 a[76:79], a[252:255], v[108:111], a[76:79]
    s_waitcnt lgkmcnt(3)
    ds_read_b64_tr_b16 a[252:253], v6 offset:2048
    ds_read_b64_tr_b16 a[254:255], v6 offset:8192
    v_mfma_f32_16x16x32_bf16 v[192:195], a[240:243], v[96:99], v[192:195]
    v_fma_f32 v85, v85, s36, v18
    v_fma_f32 v86, v86, s36, v18
    v_mfma_f32_16x16x32_bf16 v[240:243], a[240:243], v[100:103], v[240:243]
    v_fma_f32 v87, v87, s36, v18
    v_fma_f32 v88, v88, s36, v19
    v_mfma_f32_16x16x32_bf16 a[32:35], a[240:243], v[104:107], a[32:35]
    v_exp_f32 v144, v80
    v_mfma_f32_16x16x32_bf16 a[80:83], a[240:243], v[108:111], a[80:83]
    s_waitcnt lgkmcnt(2)
    v_exp_f32 v145, v81
    v_mfma_f32_16x16x32_bf16 v[196:199], a[244:247], v[96:99], v[196:199]
    v_exp_f32 v146, v82
    v_mfma_f32_16x16x32_bf16 v[244:247], a[244:247], v[100:103], v[244:247]
    v_exp_f32 v147, v83
    v_mfma_f32_16x16x32_bf16 a[36:39], a[244:247], v[104:107], a[36:39]
    v_exp_f32 v148, v84
    v_mfma_f32_16x16x32_bf16 a[84:87], a[244:247], v[108:111], a[84:87]
    v_exp_f32 v149, v85
    v_mfma_f32_16x16x32_bf16 v[200:203], a[248:251], v[96:99], v[200:203]
    v_exp_f32 v150, v86
    v_mfma_f32_16x16x32_bf16 v[248:251], a[248:251], v[100:103], v[248:251]
    v_exp_f32 v151, v87
    v_mfma_f32_16x16x32_bf16 a[40:43], a[248:251], v[104:107], a[40:43]
    v_cvt_pk_bf16_f32 v120, v144, v145
    v_cvt_pk_bf16_f32 v121, v146, v147
    v_mfma_f32_16x16x32_bf16 a[88:91], a[248:251], v[108:111], a[88:91]
    s_waitcnt lgkmcnt(0)
    v_cvt_pk_bf16_f32 v122, v148, v149
    v_cvt_pk_bf16_f32 v123, v150, v151
    v_mfma_f32_16x16x32_bf16 v[204:207], a[252:255], v[96:99], v[204:207]
    v_fma_f32 v89, v89, s36, v19
    v_fma_f32 v90, v90, s36, v19
    v_mfma_f32_16x16x32_bf16 v[252:255], a[252:255], v[100:103], v[252:255]
    v_fma_f32 v91, v91, s36, v19
    v_fma_f32 v92, v92, s36, v19
    v_mfma_f32_16x16x32_bf16 a[44:47], a[252:255], v[104:107], a[44:47]
    v_fma_f32 v93, v93, s36, v19
    v_fma_f32 v94, v94, s36, v19
    v_mfma_f32_16x16x32_bf16 a[92:95], a[252:255], v[108:111], a[92:95]
    v_fma_f32 v95, v95, s36, v19
    v_exp_f32 v144, v88
    v_exp_f32 v145, v89
    v_exp_f32 v146, v90
    v_exp_f32 v147, v91
    v_exp_f32 v148, v92
    v_exp_f32 v149, v93
    v_exp_f32 v150, v94
    v_exp_f32 v151, v95
    v_xor_b32 v156, 80, v7
    v_xor_b32 v157, 80, v8
    v_cvt_pk_bf16_f32 v124, v144, v145
    v_cvt_pk_bf16_f32 v125, v146, v147
    v_cvt_pk_bf16_f32 v126, v148, v149
    v_cvt_pk_bf16_f32 v127, v150, v151
    v_add_f32 v20, v20, v128
    v_mfma_f32_16x16x32_bf16 v[128:131], v[24:27], v[112:115], 0
    buffer_load_dwordx4 v156, s[12:15], s68 offen offset:0 nt lds
    buffer_load_dwordx4 v157, s[12:15], s68 offen offset:1024 nt lds
    v_add_f32 v21, v21, v132
    v_mfma_f32_16x16x32_bf16 v[132:135], v[24:27], v[116:119], 0
    v_add_f32 v22, v22, v136
    v_xor_b32 v158, 80, v9
    v_mfma_f32_16x16x32_bf16 v[136:139], v[24:27], v[120:123], 0
    buffer_load_dwordx4 v158, s[12:15], s68 offen offset:2048 nt lds
    s_add_u32 m0, s33, s31
    v_add_f32 v23, v23, v140
    v_mfma_f32_16x16x32_bf16 v[140:143], v[24:27], v[124:127], 0
    buffer_load_dwordx4 v7, s[20:23], s28 offen offset:0 lds
    buffer_load_dwordx4 v8, s[20:23], s28 offen offset:1024 lds
    buffer_load_dwordx4 v9, s[20:23], s28 offen offset:2048 lds
    s_add_u32 m0, s33, s32
    v_max3_f32 v30, v128, v132, v136
    v_add_u32 v154, s56, v28
    v_add_u32 v155, s56, v29
    v_add_u32 v3, s56, v3
    v_max_f32 v30, v30, v140
    v_cmp_lt_f32 vcc, s37, v30
    v_add_u32 v4, s56, v4
    v_add_u32 v5, s56, v5
    v_add_u32 v6, s56, v6
    buffer_load_dwordx4 v10, s[24:27], s29 offen offset:0 lds
    buffer_load_dwordx4 v11, s[24:27], s29 offen offset:1024 lds
    buffer_load_dwordx4 v12, s[24:27], s29 offen offset:2048 lds
    s_waitcnt vmcnt(12)
    s_barrier
    s_cbranch_vccnz L_rs_tr43A
L_ret_tr43A:
    ds_read_b128 a[120:123], v154 offset:0
    ds_read_b128 a[124:127], v155 offset:0
    ds_read_b128 a[128:131], v154 offset:1024
    ds_read_b128 a[132:135], v155 offset:1024
    ds_read_b128 a[136:139], v154 offset:2048
    ds_read_b128 a[140:143], v155 offset:2048
    ds_read_b64_tr_b16 a[240:241], v3 offset:24576
    ds_read_b64_tr_b16 a[242:243], v3 offset:30720
    ds_read_b64_tr_b16 a[244:245], v4 offset:24576
    ds_read_b64_tr_b16 a[246:247], v4 offset:30720
    ds_read_b64_tr_b16 a[248:249], v5 offset:24576
    ds_read_b64_tr_b16 a[250:251], v5 offset:30720
    ds_read_b64_tr_b16 a[252:253], v6 offset:24576
    ds_read_b64_tr_b16 a[254:255], v6 offset:30720
    s_add_u32 s28, s28, s30
    s_add_u32 s29, s29, s30
    s_add_u32 s33, s33, 24576
    s_cmp_eq_u32 s33, 147456
    s_cselect_b32 s33, 0, s33
    s_add_u32 s84, s42, 0
    s_add_u32 s85, s42, 6144
    s_add_u32 s86, s42, 12288
    s_add_u32 s87, s42, 18432
    s_waitcnt lgkmcnt(6)
    v_mfma_f32_16x16x32_bf16 v[160:163], a[240:243], v[112:115], v[160:163]
    s_add_u32 m0, s33, s31
    v_add_f32 v20, v20, v128
    v_add_f32 v21, v21, v132
    v_mfma_f32_16x16x32_bf16 v[208:211], a[240:243], v[116:119], v[208:211]
    v_rcp_f32 v130, v20
    v_mfma_f32_16x16x32_bf16 a[0:3], a[240:243], v[120:123], a[0:3]
    v_rcp_f32 v134, v21
    v_mov_b32 v96, v15
    v_mul_f32 v160, v160, v130
    v_mfma_f32_16x16x32_bf16 a[48:51], a[240:243], v[124:127], a[48:51]
    ds_read_b64_tr_b16 a[240:241], v3 offset:25600
    ds_read_b64_tr_b16 a[242:243], v3 offset:31744
    v_mul_f32 v161, v161, v130
    v_mul_f32 v162, v162, v130
    s_waitcnt lgkmcnt(6)
    v_mfma_f32_16x16x32_bf16 v[164:167], a[244:247], v[112:115], v[164:167]
    v_mul_f32 v163, v163, v130
    v_mul_f32 v208, v208, v134
    v_mul_f32 v209, v209, v134
    v_mul_f32 v210, v210, v134
    v_mfma_f32_16x16x32_bf16 v[212:215], a[244:247], v[116:119], v[212:215]
    v_mul_f32 v211, v211, v134
    v_cvt_pk_bf16_f32 v80, v160, v161
    v_cvt_pk_bf16_f32 v81, v162, v163
    v_cvt_pk_bf16_f32 v82, v208, v209
    v_mfma_f32_16x16x32_bf16 a[4:7], a[244:247], v[120:123], a[4:7]
    v_cvt_pk_bf16_f32 v83, v210, v211
    v_mul_f32 v164, v164, v130
    v_mul_f32 v165, v165, v130
    v_mul_f32 v166, v166, v130
    v_mfma_f32_16x16x32_bf16 a[52:55], a[244:247], v[124:127], a[52:55]
    ds_read_b64_tr_b16 a[244:245], v4 offset:25600
    ds_read_b64_tr_b16 a[246:247], v4 offset:31744
    v_mul_f32 v167, v167, v130
    v_mul_f32 v212, v212, v134
    s_waitcnt lgkmcnt(4)
    v_mfma_f32_16x16x32_bf16 v[168:171], a[248:251], v[112:115], v[168:171]
    v_mul_f32 v213, v213, v134
    v_mul_f32 v214, v214, v134
    v_mul_f32 v215, v215, v134
    v_xor_b32 v97, 32, v15
    v_mfma_f32_16x16x32_bf16 v[216:219], a[248:251], v[116:119], v[216:219]
    v_cvt_pk_bf16_f32 v84, v164, v165
    v_cvt_pk_bf16_f32 v85, v166, v167
    v_cvt_pk_bf16_f32 v86, v212, v213
    v_cvt_pk_bf16_f32 v87, v214, v215
    v_mfma_f32_16x16x32_bf16 a[8:11], a[248:251], v[120:123], a[8:11]
    v_mul_f32 v168, v168, v130
    v_mul_f32 v169, v169, v130
    v_mul_f32 v170, v170, v130
    v_mul_f32 v171, v171, v130
    v_mfma_f32_16x16x32_bf16 a[56:59], a[248:251], v[124:127], a[56:59]
    ds_read_b64_tr_b16 a[248:249], v5 offset:25600
    ds_read_b64_tr_b16 a[250:251], v5 offset:31744
    v_mul_f32 v216, v216, v134
    v_mul_f32 v217, v217, v134
    v_mfma_f32_16x16x32_bf16 v[172:175], a[252:255], v[112:115], v[172:175]
    buffer_load_dwordx4 v7, s[20:23], s28 offen offset:0 lds
    s_waitcnt vmcnt(7)
    ds_read_b128 a[144:147], v28 offset:24576
    ds_read_b128 a[148:151], v29 offset:24576
    ds_read_b128 a[152:155], v28 offset:25600
    ds_read_b128 a[156:159], v29 offset:25600
    ds_read_b128 a[160:163], v28 offset:26624
    ds_read_b128 a[164:167], v29 offset:26624
    v_mfma_f32_16x16x32_bf16 v[220:223], a[252:255], v[116:119], v[220:223]
    v_mul_f32 v218, v218, v134
    v_mul_f32 v219, v219, v134
    v_mfma_f32_16x16x32_bf16 a[12:15], a[252:255], v[120:123], a[12:15]
    v_xor_b32 v98, 64, v15
    v_cvt_pk_bf16_f32 v88, v168, v169
    v_mfma_f32_16x16x32_bf16 a[60:63], a[252:255], v[124:127], a[60:63]
    s_waitcnt lgkmcnt(8)
    ds_read_b64_tr_b16 a[252:253], v6 offset:25600
    ds_read_b64_tr_b16 a[254:255], v6 offset:31744
    v_mfma_f32_16x16x32_bf16 v[176:179], a[240:243], v[112:115], v[176:179]
    v_cvt_pk_bf16_f32 v89, v170, v171
    v_cvt_pk_bf16_f32 v90, v216, v217
    v_cvt_pk_bf16_f32 v91, v218, v219
    v_mul_f32 v172, v172, v130
    v_mfma_f32_16x16x32_bf16 v[224:227], a[240:243], v[116:119], v[224:227]
    buffer_load_dwordx4 v8, s[20:23], s28 offen offset:1024 lds
    v_mul_f32 v173, v173, v130
    v_mfma_f32_16x16x32_bf16 a[16:19], a[240:243], v[120:123], a[16:19]
    v_mul_f32 v174, v174, v130
    v_mul_f32 v175, v175, v130
    v_mul_f32 v220, v220, v134
    v_mul_f32 v221, v221, v134
    v_mfma_f32_16x16x32_bf16 a[64:67], a[240:243], v[124:127], a[64:67]
    ds_read_b64_tr_b16 a[240:241], v3 offset:26624
    ds_read_b64_tr_b16 a[242:243], v3 offset:32768
    v_mul_f32 v222, v222, v134
    v_mul_f32 v223, v223, v134
    v_mfma_f32_16x16x32_bf16 v[180:183], a[244:247], v[112:115], v[180:183]
    v_xor_b32 v99, 96, v15
    v_cvt_pk_bf16_f32 v92, v172, v173
    v_cvt_pk_bf16_f32 v93, v174, v175
    v_cvt_pk_bf16_f32 v94, v220, v221
    v_mfma_f32_16x16x32_bf16 v[228:231], a[244:247], v[116:119], v[228:231]
    buffer_load_dwordx4 v9, s[20:23], s28 offen offset:2048 lds
    v_cvt_pk_bf16_f32 v95, v222, v223
    v_mfma_f32_16x16x32_bf16 a[20:23], a[244:247], v[120:123], a[20:23]
    s_add_u32 m0, s33, s32
    v_add_f32 v22, v22, v136
    v_add_f32 v23, v23, v140
    v_rcp_f32 v138, v22
    v_mfma_f32_16x16x32_bf16 a[68:71], a[244:247], v[124:127], a[68:71]
    s_waitcnt lgkmcnt(2)
    ds_read_b64_tr_b16 a[244:245], v4 offset:26624
    ds_read_b64_tr_b16 a[246:247], v4 offset:32768
    v_rcp_f32 v142, v23
    v_mfma_f32_16x16x32_bf16 v[184:187], a[248:251], v[112:115], v[184:187]
    v_accvgpr_read_b32 v64, a0
    v_accvgpr_read_b32 v65, a1
    v_accvgpr_read_b32 v66, a2
    v_accvgpr_read_b32 v67, a3
    v_mfma_f32_16x16x32_bf16 v[232:235], a[248:251], v[116:119], v[232:235]
    buffer_load_dwordx4 v10, s[24:27], s29 offen offset:0 lds
    v_accvgpr_read_b32 v68, a48
    v_mfma_f32_16x16x32_bf16 a[24:27], a[248:251], v[120:123], a[24:27]
    v_accvgpr_read_b32 v69, a49
    v_accvgpr_read_b32 v70, a50
    v_accvgpr_read_b32 v71, a51
    v_mul_f32 v64, v64, v138
    v_mfma_f32_16x16x32_bf16 a[72:75], a[248:251], v[124:127], a[72:75]
    ds_read_b64_tr_b16 a[248:249], v5 offset:26624
    ds_read_b64_tr_b16 a[250:251], v5 offset:32768
    v_mul_f32 v65, v65, v138
    v_mul_f32 v66, v66, v138
    v_mfma_f32_16x16x32_bf16 v[188:191], a[252:255], v[112:115], v[188:191]
    v_mul_f32 v67, v67, v138
    v_mul_f32 v68, v68, v142
    v_mul_f32 v69, v69, v142
    v_mul_f32 v70, v70, v142
    v_mfma_f32_16x16x32_bf16 v[236:239], a[252:255], v[116:119], v[236:239]
    buffer_load_dwordx4 v11, s[24:27], s29 offen offset:1024 lds
    v_mul_f32 v71, v71, v142
    v_mfma_f32_16x16x32_bf16 a[28:31], a[252:255], v[120:123], a[28:31]
    v_accvgpr_read_b32 v72, a4
    v_accvgpr_read_b32 v73, a5
    v_accvgpr_read_b32 v74, a6
    v_accvgpr_read_b32 v75, a7
    ds_read_b128 a[192:195], v1 offset:0
    v_mfma_f32_16x16x32_bf16 a[76:79], a[252:255], v[124:127], a[76:79]
    s_waitcnt lgkmcnt(3)
    ds_read_b64_tr_b16 a[252:253], v6 offset:26624
    ds_read_b64_tr_b16 a[254:255], v6 offset:32768
    ds_read_b128 a[196:199], v2 offset:0
    v_mfma_f32_16x16x32_bf16 v[192:195], a[240:243], v[112:115], v[192:195]
    v_accvgpr_read_b32 v76, a52
    v_accvgpr_read_b32 v77, a53
    ds_read_b128 a[200:203], v1 offset:1024
    v_mfma_f32_16x16x32_bf16 v[240:243], a[240:243], v[116:119], v[240:243]
    buffer_load_dwordx4 v12, s[24:27], s29 offen offset:2048 lds
    ds_read_b128 a[204:207], v2 offset:1024
    v_mfma_f32_16x16x32_bf16 a[32:35], a[240:243], v[120:123], a[32:35]
    s_add_u32 s28, s28, s30
    v_accvgpr_read_b32 v78, a54
    v_accvgpr_read_b32 v79, a55
    ds_read_b128 a[208:211], v1 offset:2048
    v_mfma_f32_16x16x32_bf16 a[80:83], a[240:243], v[124:127], a[80:83]
    s_add_u32 s29, s29, s30
    ds_read_b128 a[212:215], v2 offset:2048
    v_mfma_f32_16x16x32_bf16 v[196:199], a[244:247], v[112:115], v[196:199]
    s_add_u32 s33, s33, 24576
    v_mul_f32 v72, v72, v138
    v_mul_f32 v73, v73, v138
    ds_read_b128 a[216:219], v1 offset:6144
    v_mfma_f32_16x16x32_bf16 v[244:247], a[244:247], v[116:119], v[244:247]
    s_cmp_eq_u32 s33, 147456
    v_mul_f32 v74, v74, v138
    v_mul_f32 v75, v75, v138
    ds_read_b128 a[220:223], v2 offset:6144
    v_mfma_f32_16x16x32_bf16 a[36:39], a[244:247], v[120:123], a[36:39]
    s_cselect_b32 s33, 0, s33
    ds_read_b128 a[224:227], v1 offset:7168
    v_mfma_f32_16x16x32_bf16 a[84:87], a[244:247], v[124:127], a[84:87]
    s_add_u32 s62, s34, 49152
    v_mul_f32 v76, v76, v142
    v_mul_f32 v77, v77, v142
    ds_read_b128 a[228:231], v2 offset:7168
    s_waitcnt lgkmcnt(6)
    v_mfma_f32_16x16x32_bf16 v[200:203], a[248:251], v[112:115], v[200:203]
    s_cmp_eq_u32 s62, 147456
    v_mul_f32 v78, v78, v142
    v_mul_f32 v79, v79, v142
    ds_read_b128 a[232:235], v1 offset:8192
    v_mfma_f32_16x16x32_bf16 v[248:251], a[248:251], v[116:119], v[248:251]
    s_cselect_b32 s62, 0, s62
    ds_read_b128 a[236:239], v2 offset:8192
    v_mfma_f32_16x16x32_bf16 a[40:43], a[248:251], v[120:123], a[40:43]
    s_sub_u32 s57, s62, s34
    v_add_u32 v3, s57, v3
    v_add_u32 v4, s57, v4
    v_mfma_f32_16x16x32_bf16 a[88:91], a[248:251], v[124:127], a[88:91]
    s_mov_b32 s34, s62
    v_add_u32 v5, s57, v5
    v_add_u32 v6, s57, v6
    v_add_u32 v1, s56, v1
    v_mfma_f32_16x16x32_bf16 v[204:207], a[252:255], v[112:115], v[204:207]
    v_add_u32 v2, s56, v2
    v_mfma_f32_16x16x32_bf16 v[252:255], a[252:255], v[116:119], v[252:255]
    ds_write2st64_b64 v96, v[80:81], v[82:83] offset0:0 offset1:4
    v_mfma_f32_16x16x32_bf16 a[44:47], a[252:255], v[120:123], a[44:47]
    v_cvt_pk_bf16_f32 v80, v64, v65
    v_cvt_pk_bf16_f32 v81, v66, v67
    v_cvt_pk_bf16_f32 v82, v68, v69
    v_mfma_f32_16x16x32_bf16 a[92:95], a[252:255], v[124:127], a[92:95]
    v_cvt_pk_bf16_f32 v83, v70, v71
    v_accvgpr_read_b32 v64, a8
    v_accvgpr_read_b32 v65, a9
    v_accvgpr_read_b32 v66, a10
    v_mfma_f32_16x16x32_bf16 v[32:35], a[192:195], a[96:99], 0
    v_accvgpr_read_b32 v67, a11
    v_accvgpr_read_b32 v68, a56
    v_accvgpr_read_b32 v69, a57
    v_accvgpr_read_b32 v70, a58
    v_mfma_f32_16x16x32_bf16 v[32:35], a[196:199], a[100:103], v[32:35]
    v_accvgpr_read_b32 v71, a59
    v_mul_f32 v64, v64, v138
    v_mul_f32 v65, v65, v138
    v_mul_f32 v66, v66, v138
    v_mfma_f32_16x16x32_bf16 v[32:35], a[200:203], a[104:107], v[32:35]
    v_mul_f32 v67, v67, v138
    v_mul_f32 v68, v68, v142
    v_mul_f32 v69, v69, v142
    v_mul_f32 v70, v70, v142
    v_mfma_f32_16x16x32_bf16 v[32:35], a[204:207], a[108:111], v[32:35]
    s_waitcnt lgkmcnt(0)
    v_mul_f32 v71, v71, v142
    v_mfma_f32_16x16x32_bf16 v[32:35], a[208:211], a[112:115], v[32:35]
    ds_write2st64_b64 v97, v[84:85], v[86:87] offset0:0 offset1:4
    v_mfma_f32_16x16x32_bf16 v[32:35], a[212:215], a[116:119], v[32:35]
    v_cvt_pk_bf16_f32 v84, v72, v73
    v_cvt_pk_bf16_f32 v85, v74, v75
    v_cvt_pk_bf16_f32 v86, v76, v77
    v_mfma_f32_16x16x32_bf16 v[36:39], a[216:219], a[96:99], 0
    v_cvt_pk_bf16_f32 v87, v78, v79
    v_accvgpr_read_b32 v72, a12
    v_accvgpr_read_b32 v73, a13
    v_accvgpr_read_b32 v74, a14
    v_mfma_f32_16x16x32_bf16 v[36:39], a[220:223], a[100:103], v[36:39]
    v_accvgpr_read_b32 v75, a15
    v_accvgpr_read_b32 v76, a60
    v_accvgpr_read_b32 v77, a61
    v_accvgpr_read_b32 v78, a62
    v_mfma_f32_16x16x32_bf16 v[36:39], a[224:227], a[104:107], v[36:39]
    v_accvgpr_read_b32 v79, a63
    v_mul_f32 v72, v72, v138
    v_mul_f32 v73, v73, v138
    v_mul_f32 v74, v74, v138
    v_mfma_f32_16x16x32_bf16 v[36:39], a[228:231], a[108:111], v[36:39]
    v_mul_f32 v75, v75, v138
    v_mul_f32 v76, v76, v142
    v_mul_f32 v77, v77, v142
    v_mul_f32 v78, v78, v142
    v_mfma_f32_16x16x32_bf16 v[36:39], a[232:235], a[112:115], v[36:39]
    v_mul_f32 v79, v79, v142
    v_mfma_f32_16x16x32_bf16 v[36:39], a[236:239], a[116:119], v[36:39]
    ds_write2st64_b64 v98, v[88:89], v[90:91] offset0:0 offset1:4
    v_mfma_f32_16x16x32_bf16 v[40:43], a[192:195], a[120:123], 0
    v_cvt_pk_bf16_f32 v88, v64, v65
    v_cvt_pk_bf16_f32 v89, v66, v67
    v_cvt_pk_bf16_f32 v90, v68, v69
    v_mfma_f32_16x16x32_bf16 v[40:43], a[196:199], a[124:127], v[40:43]
    v_cvt_pk_bf16_f32 v91, v70, v71
    v_accvgpr_read_b32 v64, a16
    v_accvgpr_read_b32 v65, a17
    v_accvgpr_read_b32 v66, a18
    v_mfma_f32_16x16x32_bf16 v[40:43], a[200:203], a[128:131], v[40:43]
    v_accvgpr_read_b32 v67, a19
    v_accvgpr_read_b32 v68, a64
    v_accvgpr_read_b32 v69, a65
    v_accvgpr_read_b32 v70, a66
    v_mfma_f32_16x16x32_bf16 v[40:43], a[204:207], a[132:135], v[40:43]
    v_accvgpr_read_b32 v71, a67
    v_mfma_f32_16x16x32_bf16 v[40:43], a[208:211], a[136:139], v[40:43]
    ds_write2st64_b64 v99, v[92:93], v[94:95] offset0:0 offset1:4
    v_mfma_f32_16x16x32_bf16 v[40:43], a[212:215], a[140:143], v[40:43]
    ds_read_b128 v[144:147], v14 offset:0
    ds_read_b128 v[148:151], v14 offset:1024
    ds_read_b128 v[152:155], v14 offset:2048
    ds_read_b128 v[156:159], v14 offset:3072
    v_mfma_f32_16x16x32_bf16 v[44:47], a[216:219], a[120:123], 0
    v_cvt_pk_bf16_f32 v92, v72, v73
    v_cvt_pk_bf16_f32 v93, v74, v75
    v_cvt_pk_bf16_f32 v94, v76, v77
    v_mfma_f32_16x16x32_bf16 v[44:47], a[220:223], a[124:127], v[44:47]
    v_cvt_pk_bf16_f32 v95, v78, v79
    v_accvgpr_read_b32 v72, a20
    v_accvgpr_read_b32 v73, a21
    v_accvgpr_read_b32 v74, a22
    v_mfma_f32_16x16x32_bf16 v[44:47], a[224:227], a[128:131], v[44:47]
    v_accvgpr_read_b32 v75, a23
    v_accvgpr_read_b32 v76, a68
    v_accvgpr_read_b32 v77, a69
    v_accvgpr_read_b32 v78, a70
    v_mfma_f32_16x16x32_bf16 v[44:47], a[228:231], a[132:135], v[44:47]
    v_accvgpr_read_b32 v79, a71
    v_mfma_f32_16x16x32_bf16 v[44:47], a[232:235], a[136:139], v[44:47]
    ds_write2st64_b64 v96, v[80:81], v[82:83] offset0:0 offset1:4
    v_mfma_f32_16x16x32_bf16 v[44:47], a[236:239], a[140:143], v[44:47]
    s_waitcnt lgkmcnt(4)
    buffer_store_dwordx4 v[144:147], v13, s[16:19], s84 offen offset:0 nt
    v_mfma_f32_16x16x32_bf16 v[48:51], a[192:195], a[144:147], 0
    ds_write2st64_b64 v97, v[84:85], v[86:87] offset0:0 offset1:4
    v_mfma_f32_16x16x32_bf16 v[48:51], a[196:199], a[148:151], v[48:51]
    ds_write2st64_b64 v98, v[88:89], v[90:91] offset0:0 offset1:4
    v_mfma_f32_16x16x32_bf16 v[48:51], a[200:203], a[152:155], v[48:51]
    s_waitcnt lgkmcnt(3)
    buffer_store_dwordx4 v[148:151], v13, s[16:19], s84 offen offset:3072 nt
    v_mfma_f32_16x16x32_bf16 v[48:51], a[204:207], a[156:159], v[48:51]
    ds_write2st64_b64 v99, v[92:93], v[94:95] offset0:0 offset1:4
    v_mfma_f32_16x16x32_bf16 v[48:51], a[208:211], a[160:163], v[48:51]
    ds_read_b128 v[144:147], v14 offset:0
    ds_read_b128 v[148:151], v14 offset:1024
    v_mfma_f32_16x16x32_bf16 v[48:51], a[212:215], a[164:167], v[48:51]
    buffer_store_dwordx4 v[152:155], v13, s[16:19], s85 offen offset:0 nt
    v_mfma_f32_16x16x32_bf16 v[52:55], a[216:219], a[144:147], 0
    ds_read_b128 v[152:155], v14 offset:2048
    v_mfma_f32_16x16x32_bf16 v[52:55], a[220:223], a[148:151], v[52:55]
    buffer_store_dwordx4 v[156:159], v13, s[16:19], s85 offen offset:3072 nt
    v_mfma_f32_16x16x32_bf16 v[52:55], a[224:227], a[152:155], v[52:55]
    ds_read_b128 v[156:159], v14 offset:3072
    v_mfma_f32_16x16x32_bf16 v[52:55], a[228:231], a[156:159], v[52:55]
    v_mfma_f32_16x16x32_bf16 v[52:55], a[232:235], a[160:163], v[52:55]
    s_waitcnt lgkmcnt(3)
    buffer_store_dwordx4 v[144:147], v13, s[16:19], s86 offen offset:0 nt
    v_mfma_f32_16x16x32_bf16 v[52:55], a[236:239], a[164:167], v[52:55]
    s_barrier
    v_pk_mul_f32 v[176:177], v[176:177], v[130:131] op_sel_hi:[1,0]
    v_pk_mul_f32 v[178:179], v[178:179], v[130:131] op_sel_hi:[1,0]
    v_pk_mul_f32 v[224:225], v[224:225], v[134:135] op_sel_hi:[1,0]
    v_pk_mul_f32 v[226:227], v[226:227], v[134:135] op_sel_hi:[1,0]
    v_cvt_pk_bf16_f32 v80, v176, v177
    v_cvt_pk_bf16_f32 v81, v178, v179
    v_cvt_pk_bf16_f32 v82, v224, v225
    v_cvt_pk_bf16_f32 v83, v226, v227
    v_pk_mul_f32 v[180:181], v[180:181], v[130:131] op_sel_hi:[1,0]
    v_pk_mul_f32 v[182:183], v[182:183], v[130:131] op_sel_hi:[1,0]
    v_pk_mul_f32 v[228:229], v[228:229], v[134:135] op_sel_hi:[1,0]
    v_pk_mul_f32 v[230:231], v[230:231], v[134:135] op_sel_hi:[1,0]
    v_cvt_pk_bf16_f32 v84, v180, v181
    v_cvt_pk_bf16_f32 v85, v182, v183
    v_cvt_pk_bf16_f32 v86, v228, v229
    v_cvt_pk_bf16_f32 v87, v230, v231
    v_pk_mul_f32 v[184:185], v[184:185], v[130:131] op_sel_hi:[1,0]
    v_pk_mul_f32 v[186:187], v[186:187], v[130:131] op_sel_hi:[1,0]
    v_pk_mul_f32 v[232:233], v[232:233], v[134:135] op_sel_hi:[1,0]
    v_pk_mul_f32 v[234:235], v[234:235], v[134:135] op_sel_hi:[1,0]
    v_cvt_pk_bf16_f32 v88, v184, v185
    v_cvt_pk_bf16_f32 v89, v186, v187
    v_cvt_pk_bf16_f32 v90, v232, v233
    v_cvt_pk_bf16_f32 v91, v234, v235
    v_pk_mul_f32 v[188:189], v[188:189], v[130:131] op_sel_hi:[1,0]
    v_pk_mul_f32 v[190:191], v[190:191], v[130:131] op_sel_hi:[1,0]
    v_pk_mul_f32 v[236:237], v[236:237], v[134:135] op_sel_hi:[1,0]
    v_pk_mul_f32 v[238:239], v[238:239], v[134:135] op_sel_hi:[1,0]
    v_cvt_pk_bf16_f32 v92, v188, v189
    v_cvt_pk_bf16_f32 v93, v190, v191
    v_cvt_pk_bf16_f32 v94, v236, v237
    v_cvt_pk_bf16_f32 v95, v238, v239
    v_pk_mul_f32 v[64:65], v[64:65], v[138:139] op_sel_hi:[1,0]
    v_pk_mul_f32 v[66:67], v[66:67], v[138:139] op_sel_hi:[1,0]
    v_pk_mul_f32 v[68:69], v[68:69], v[142:143] op_sel_hi:[1,0]
    v_pk_mul_f32 v[70:71], v[70:71], v[142:143] op_sel_hi:[1,0]
    v_pk_mul_f32 v[72:73], v[72:73], v[138:139] op_sel_hi:[1,0]
    v_pk_mul_f32 v[74:75], v[74:75], v[138:139] op_sel_hi:[1,0]
    v_pk_mul_f32 v[76:77], v[76:77], v[142:143] op_sel_hi:[1,0]
    v_pk_mul_f32 v[78:79], v[78:79], v[142:143] op_sel_hi:[1,0]
    v_pk_mul_f32 v[192:193], v[192:193], v[130:131] op_sel_hi:[1,0]
    v_pk_mul_f32 v[194:195], v[194:195], v[130:131] op_sel_hi:[1,0]
    v_pk_mul_f32 v[240:241], v[240:241], v[134:135] op_sel_hi:[1,0]
    v_pk_mul_f32 v[242:243], v[242:243], v[134:135] op_sel_hi:[1,0]
    v_pk_mul_f32 v[196:197], v[196:197], v[130:131] op_sel_hi:[1,0]
    v_pk_mul_f32 v[198:199], v[198:199], v[130:131] op_sel_hi:[1,0]
    v_pk_mul_f32 v[244:245], v[244:245], v[134:135] op_sel_hi:[1,0]
    v_pk_mul_f32 v[246:247], v[246:247], v[134:135] op_sel_hi:[1,0]
    v_pk_mul_f32 v[200:201], v[200:201], v[130:131] op_sel_hi:[1,0]
    v_pk_mul_f32 v[202:203], v[202:203], v[130:131] op_sel_hi:[1,0]
    v_pk_mul_f32 v[248:249], v[248:249], v[134:135] op_sel_hi:[1,0]
    v_pk_mul_f32 v[250:251], v[250:251], v[134:135] op_sel_hi:[1,0]
    v_pk_mul_f32 v[204:205], v[204:205], v[130:131] op_sel_hi:[1,0]
    v_pk_mul_f32 v[206:207], v[206:207], v[130:131] op_sel_hi:[1,0]
    v_pk_mul_f32 v[252:253], v[252:253], v[134:135] op_sel_hi:[1,0]
    v_pk_mul_f32 v[254:255], v[254:255], v[134:135] op_sel_hi:[1,0]
    ds_write2st64_b64 v96, v[80:81], v[82:83] offset0:0 offset1:4
    s_waitcnt lgkmcnt(1)
    buffer_store_dwordx4 v[148:151], v13, s[16:19], s86 offen offset:3072 nt
    ds_write2st64_b64 v97, v[84:85], v[86:87] offset0:0 offset1:4
    ds_write2st64_b64 v98, v[88:89], v[90:91] offset0:0 offset1:4
    ds_write2st64_b64 v99, v[92:93], v[94:95] offset0:0 offset1:4
    buffer_store_dwordx4 v[152:155], v13, s[16:19], s87 offen offset:0 nt
    ds_read_b128 v[144:147], v14 offset:0
    ds_read_b128 v[148:151], v14 offset:1024
    ds_read_b128 v[152:155], v14 offset:2048
    v_cvt_pk_bf16_f32 v80, v64, v65
    v_cvt_pk_bf16_f32 v81, v66, v67
    v_cvt_pk_bf16_f32 v82, v68, v69
    v_cvt_pk_bf16_f32 v83, v70, v71
    v_cvt_pk_bf16_f32 v84, v72, v73
    v_cvt_pk_bf16_f32 v85, v74, v75
    v_cvt_pk_bf16_f32 v86, v76, v77
    v_cvt_pk_bf16_f32 v87, v78, v79
    v_accvgpr_read_b32 v64, a24
    v_accvgpr_read_b32 v65, a25
    v_accvgpr_read_b32 v66, a26
    v_accvgpr_read_b32 v67, a27
    v_accvgpr_read_b32 v68, a72
    v_accvgpr_read_b32 v69, a73
    v_accvgpr_read_b32 v70, a74
    v_accvgpr_read_b32 v71, a75
    v_pk_mul_f32 v[64:65], v[64:65], v[138:139] op_sel_hi:[1,0]
    v_pk_mul_f32 v[66:67], v[66:67], v[138:139] op_sel_hi:[1,0]
    v_pk_mul_f32 v[68:69], v[68:69], v[142:143] op_sel_hi:[1,0]
    v_pk_mul_f32 v[70:71], v[70:71], v[142:143] op_sel_hi:[1,0]
    v_accvgpr_read_b32 v72, a28
    v_accvgpr_read_b32 v73, a29
    v_accvgpr_read_b32 v74, a30
    v_accvgpr_read_b32 v75, a31
    v_accvgpr_read_b32 v76, a76
    v_accvgpr_read_b32 v77, a77
    v_accvgpr_read_b32 v78, a78
    v_accvgpr_read_b32 v79, a79
    v_cvt_pk_bf16_f32 v88, v64, v65
    v_cvt_pk_bf16_f32 v89, v66, v67
    v_cvt_pk_bf16_f32 v90, v68, v69
    v_cvt_pk_bf16_f32 v91, v70, v71
    v_pk_mul_f32 v[72:73], v[72:73], v[138:139] op_sel_hi:[1,0]
    v_pk_mul_f32 v[74:75], v[74:75], v[138:139] op_sel_hi:[1,0]
    v_pk_mul_f32 v[76:77], v[76:77], v[142:143] op_sel_hi:[1,0]
    v_pk_mul_f32 v[78:79], v[78:79], v[142:143] op_sel_hi:[1,0]
    v_cvt_pk_bf16_f32 v92, v72, v73
    v_cvt_pk_bf16_f32 v93, v74, v75
    v_cvt_pk_bf16_f32 v94, v76, v77
    v_cvt_pk_bf16_f32 v95, v78, v79
    v_accvgpr_read_b32 v64, a32
    v_accvgpr_read_b32 v65, a33
    v_accvgpr_read_b32 v66, a34
    v_accvgpr_read_b32 v67, a35
    v_accvgpr_read_b32 v68, a80
    v_accvgpr_read_b32 v69, a81
    v_accvgpr_read_b32 v70, a82
    v_accvgpr_read_b32 v71, a83
    v_pk_mul_f32 v[64:65], v[64:65], v[138:139] op_sel_hi:[1,0]
    v_pk_mul_f32 v[66:67], v[66:67], v[138:139] op_sel_hi:[1,0]
    v_pk_mul_f32 v[68:69], v[68:69], v[142:143] op_sel_hi:[1,0]
    v_pk_mul_f32 v[70:71], v[70:71], v[142:143] op_sel_hi:[1,0]
    v_accvgpr_read_b32 v72, a36
    v_accvgpr_read_b32 v73, a37
    v_accvgpr_read_b32 v74, a38
    v_accvgpr_read_b32 v75, a39
    v_accvgpr_read_b32 v76, a84
    v_accvgpr_read_b32 v77, a85
    v_accvgpr_read_b32 v78, a86
    v_accvgpr_read_b32 v79, a87
    v_pk_mul_f32 v[72:73], v[72:73], v[138:139] op_sel_hi:[1,0]
    v_pk_mul_f32 v[74:75], v[74:75], v[138:139] op_sel_hi:[1,0]
    v_pk_mul_f32 v[76:77], v[76:77], v[142:143] op_sel_hi:[1,0]
    v_pk_mul_f32 v[78:79], v[78:79], v[142:143] op_sel_hi:[1,0]
    buffer_store_dwordx4 v[156:159], v13, s[16:19], s87 offen offset:3072 nt
    s_waitcnt lgkmcnt(0)
    buffer_store_dwordx4 v[144:147], v13, s[16:19], s84 offen offset:128 nt
    ds_read_b128 v[156:159], v14 offset:3072
    ds_write2st64_b64 v96, v[80:81], v[82:83] offset0:0 offset1:4
    ds_write2st64_b64 v97, v[84:85], v[86:87] offset0:0 offset1:4
    ds_write2st64_b64 v98, v[88:89], v[90:91] offset0:0 offset1:4
    buffer_store_dwordx4 v[148:151], v13, s[16:19], s84 offen offset:3200 nt
    ds_write2st64_b64 v99, v[92:93], v[94:95] offset0:0 offset1:4
    ds_read_b128 v[144:147], v14 offset:0
    ds_read_b128 v[148:151], v14 offset:1024
    v_cvt_pk_bf16_f32 v80, v192, v193
    v_cvt_pk_bf16_f32 v81, v194, v195
    v_cvt_pk_bf16_f32 v82, v240, v241
    v_cvt_pk_bf16_f32 v83, v242, v243
    v_cvt_pk_bf16_f32 v84, v196, v197
    v_cvt_pk_bf16_f32 v85, v198, v199
    v_cvt_pk_bf16_f32 v86, v244, v245
    v_cvt_pk_bf16_f32 v87, v246, v247
    v_cvt_pk_bf16_f32 v88, v200, v201
    v_cvt_pk_bf16_f32 v89, v202, v203
    v_cvt_pk_bf16_f32 v90, v248, v249
    v_cvt_pk_bf16_f32 v91, v250, v251
    v_cvt_pk_bf16_f32 v92, v204, v205
    v_cvt_pk_bf16_f32 v93, v206, v207
    v_cvt_pk_bf16_f32 v94, v252, v253
    v_cvt_pk_bf16_f32 v95, v254, v255
    buffer_store_dwordx4 v[152:155], v13, s[16:19], s85 offen offset:128 nt
    s_waitcnt lgkmcnt(1)
    buffer_store_dwordx4 v[156:159], v13, s[16:19], s85 offen offset:3200 nt
    ds_read_b128 v[152:155], v14 offset:2048
    ds_read_b128 v[156:159], v14 offset:3072
    ds_write2st64_b64 v96, v[80:81], v[82:83] offset0:0 offset1:4
    ds_write2st64_b64 v97, v[84:85], v[86:87] offset0:0 offset1:4
    ds_write2st64_b64 v98, v[88:89], v[90:91] offset0:0 offset1:4
    buffer_store_dwordx4 v[144:147], v13, s[16:19], s86 offen offset:128 nt
    ds_write2st64_b64 v99, v[92:93], v[94:95] offset0:0 offset1:4
    ds_read_b128 v[144:147], v14 offset:0
    v_cvt_pk_bf16_f32 v80, v64, v65
    v_cvt_pk_bf16_f32 v81, v66, v67
    v_cvt_pk_bf16_f32 v82, v68, v69
    v_cvt_pk_bf16_f32 v83, v70, v71
    v_cvt_pk_bf16_f32 v84, v72, v73
    v_cvt_pk_bf16_f32 v85, v74, v75
    v_cvt_pk_bf16_f32 v86, v76, v77
    v_cvt_pk_bf16_f32 v87, v78, v79
    v_accvgpr_read_b32 v64, a40
    v_accvgpr_read_b32 v65, a41
    v_accvgpr_read_b32 v66, a42
    v_accvgpr_read_b32 v67, a43
    v_accvgpr_read_b32 v68, a88
    v_accvgpr_read_b32 v69, a89
    v_accvgpr_read_b32 v70, a90
    v_accvgpr_read_b32 v71, a91
    v_pk_mul_f32 v[64:65], v[64:65], v[138:139] op_sel_hi:[1,0]
    v_pk_mul_f32 v[66:67], v[66:67], v[138:139] op_sel_hi:[1,0]
    v_pk_mul_f32 v[68:69], v[68:69], v[142:143] op_sel_hi:[1,0]
    v_pk_mul_f32 v[70:71], v[70:71], v[142:143] op_sel_hi:[1,0]
    v_accvgpr_read_b32 v72, a44
    v_accvgpr_read_b32 v73, a45
    v_accvgpr_read_b32 v74, a46
    v_accvgpr_read_b32 v75, a47
    v_accvgpr_read_b32 v76, a92
    v_accvgpr_read_b32 v77, a93
    v_accvgpr_read_b32 v78, a94
    v_accvgpr_read_b32 v79, a95
    v_cvt_pk_bf16_f32 v88, v64, v65
    v_cvt_pk_bf16_f32 v89, v66, v67
    v_cvt_pk_bf16_f32 v90, v68, v69
    v_cvt_pk_bf16_f32 v91, v70, v71
    v_pk_mul_f32 v[72:73], v[72:73], v[138:139] op_sel_hi:[1,0]
    v_pk_mul_f32 v[74:75], v[74:75], v[138:139] op_sel_hi:[1,0]
    v_pk_mul_f32 v[76:77], v[76:77], v[142:143] op_sel_hi:[1,0]
    v_pk_mul_f32 v[78:79], v[78:79], v[142:143] op_sel_hi:[1,0]
    v_cvt_pk_bf16_f32 v92, v72, v73
    v_cvt_pk_bf16_f32 v93, v74, v75
    v_cvt_pk_bf16_f32 v94, v76, v77
    v_cvt_pk_bf16_f32 v95, v78, v79
    s_waitcnt lgkmcnt(0)
    buffer_store_dwordx4 v[148:151], v13, s[16:19], s86 offen offset:3200 nt
    buffer_store_dwordx4 v[152:155], v13, s[16:19], s87 offen offset:128 nt
    ds_read_b128 v[148:151], v14 offset:1024
    ds_read_b128 v[152:155], v14 offset:2048
    buffer_store_dwordx4 v[156:159], v13, s[16:19], s87 offen offset:3200 nt
    buffer_store_dwordx4 v[144:147], v13, s[16:19], s84 offen offset:256 nt
    ds_read_b128 v[156:159], v14 offset:3072
    ds_write2st64_b64 v96, v[80:81], v[82:83] offset0:0 offset1:4
    ds_write2st64_b64 v97, v[84:85], v[86:87] offset0:0 offset1:4
    ds_write2st64_b64 v98, v[88:89], v[90:91] offset0:0 offset1:4
    s_waitcnt lgkmcnt(4)
    buffer_store_dwordx4 v[148:151], v13, s[16:19], s84 offen offset:3328 nt
    ds_write2st64_b64 v99, v[92:93], v[94:95] offset0:0 offset1:4
    ds_read_b128 v[144:147], v14 offset:0
    ds_read_b128 v[148:151], v14 offset:1024
    buffer_store_dwordx4 v[152:155], v13, s[16:19], s85 offen offset:256 nt
    s_waitcnt lgkmcnt(4)
    buffer_store_dwordx4 v[156:159], v13, s[16:19], s85 offen offset:3328 nt
    ds_read_b128 v[152:155], v14 offset:2048
    ds_read_b128 v[156:159], v14 offset:3072
    s_waitcnt lgkmcnt(2)
    buffer_store_dwordx4 v[144:147], v13, s[16:19], s86 offen offset:256 nt
    buffer_store_dwordx4 v[148:151], v13, s[16:19], s86 offen offset:3328 nt
    s_waitcnt lgkmcnt(0)
    buffer_store_dwordx4 v[152:155], v13, s[16:19], s87 offen offset:256 nt
    buffer_store_dwordx4 v[156:159], v13, s[16:19], s87 offen offset:3328 nt
    s_mov_b32 s42, s41
    ds_read_b128 a[192:195], v1 offset:24576
    ds_read_b128 a[196:199], v2 offset:24576
    ds_read_b128 a[200:203], v1 offset:25600
    ds_read_b128 a[204:207], v2 offset:25600
    ds_read_b128 a[208:211], v1 offset:26624
    ds_read_b128 a[212:215], v2 offset:26624
    ds_read_b128 a[216:219], v1 offset:30720
    ds_read_b128 a[220:223], v2 offset:30720
    ds_read_b128 a[224:227], v1 offset:31744
    ds_read_b128 a[228:231], v2 offset:31744
    ds_read_b128 a[232:235], v1 offset:32768
    ds_read_b128 a[236:239], v2 offset:32768
    v_max3_f32 v152, v32, v33, v34
    v_max3_f32 v152, v152, v35, v36
    v_max3_f32 v152, v152, v37, v38
    v_max_f32 v152, v152, v39
    v_max3_f32 v154, v40, v41, v42
    v_mov_b32 v153, v152
    v_max3_f32 v154, v154, v43, v44
    v_max3_f32 v154, v154, v45, v46
    v_permlane32_swap_b32 v153, v152
    v_max_f32 v152, v152, v153
    v_max_f32 v154, v154, v47
    v_mov_b32 v153, v152
    v_mov_b32 v155, v154
    v_add_u32 v1, s57, v1
    v_permlane16_swap_b32 v153, v152
    v_permlane32_swap_b32 v155, v154
    v_max_f32 v152, v152, v153
    v_max_f32 v154, v154, v155
    v_mul_f32_e64 v16, -s36, v152
    v_mov_b32 v155, v154
    s_waitcnt lgkmcnt(11)
    v_mfma_f32_16x16x32_bf16 v[64:67], a[192:195], a[96:99], 0
    s_add_u32 s69, s69, 1
    v_permlane16_swap_b32 v155, v154
    s_waitcnt lgkmcnt(6)
    v_mfma_f32_16x16x32_bf16 v[64:67], a[196:199], a[100:103], v[64:67]
    s_add_u32 s48, s48, 325632
    v_max3_f32 v152, v48, v49, v50
    v_max_f32 v154, v154, v155
    v_mfma_f32_16x16x32_bf16 v[64:67], a[200:203], a[104:107], v[64:67]
    s_lshr_b32 s62, s39, s69
    v_max3_f32 v152, v152, v51, v52
    v_mul_f32_e64 v17, -s36, v154
    v_mfma_f32_16x16x32_bf16 v[64:67], a[204:207], a[108:111], v[64:67]
    s_and_b32 s62, s62, 1
    v_max3_f32 v152, v152, v53, v54
    v_max_f32 v152, v152, v55
    v_mfma_f32_16x16x32_bf16 v[64:67], a[208:211], a[112:115], v[64:67]
    s_lshl_b32 s62, s62, 1
    v_fma_f32 v32, v32, s36, v16
    v_fma_f32 v33, v33, s36, v16
    v_mfma_f32_16x16x32_bf16 v[64:67], a[212:215], a[116:119], v[64:67]
    s_add_u32 s62, s62, s49
    v_fma_f32 v34, v34, s36, v16
    v_fma_f32 v35, v35, s36, v16
    v_mfma_f32_16x16x32_bf16 v[72:75], a[192:195], a[120:123], 0
    s_and_b32 s62, s62, 3
    v_fma_f32 v40, v40, s36, v17
    v_fma_f32 v41, v41, s36, v17
    v_mfma_f32_16x16x32_bf16 v[72:75], a[196:199], a[124:127], v[72:75]
    s_add_u32 s63, s69, 8
    v_fma_f32 v36, v36, s36, v16
    v_fma_f32 v37, v37, s36, v16
    v_mfma_f32_16x16x32_bf16 v[72:75], a[200:203], a[128:131], v[72:75]
    s_lshr_b32 s63, s39, s63
    v_mov_b32 v153, v152
    v_fma_f32 v38, v38, s36, v16
    v_mfma_f32_16x16x32_bf16 v[72:75], a[204:207], a[132:135], v[72:75]
    s_and_b32 s63, s63, 1
    v_exp_f32 v144, v32
    v_mfma_f32_16x16x32_bf16 v[72:75], a[208:211], a[136:139], v[72:75]
    s_xor_b32 s62, s62, s63
    v_exp_f32 v145, v33
    v_mfma_f32_16x16x32_bf16 v[72:75], a[212:215], a[140:143], v[72:75]
    s_mul_i32 s63, s3, 3
    v_exp_f32 v146, v34
    v_mfma_f32_16x16x32_bf16 v[80:83], a[192:195], a[144:147], 0
    s_lshl_b32 s64, s3, 2
    v_exp_f32 v147, v35
    v_mfma_f32_16x16x32_bf16 v[80:83], a[196:199], a[148:151], v[80:83]
    s_mov_b32 s40, 1
    v_exp_f32 v148, v40
    v_mfma_f32_16x16x32_bf16 v[80:83], a[200:203], a[152:155], v[80:83]
    s_add_u32 s65, s63, 17
    v_exp_f32 v149, v41
    v_mfma_f32_16x16x32_bf16 v[80:83], a[204:207], a[156:159], v[80:83]
    s_cmp_eq_u32 s3, 0
    v_exp_f32 v150, v36
    v_mfma_f32_16x16x32_bf16 v[80:83], a[208:211], a[160:163], v[80:83]
    s_cselect_b32 s65, 16, s65
    v_exp_f32 v151, v37
    v_mfma_f32_16x16x32_bf16 v[80:83], a[212:215], a[164:167], v[80:83]
    s_cselect_b32 s41, 1, 0
    v_permlane32_swap_b32 v153, v152
    s_waitcnt lgkmcnt(0)
    v_mfma_f32_16x16x32_bf16 v[68:71], a[216:219], a[96:99], 0
    s_cmp_eq_u32 s62, 1
    v_max_f32 v152, v152, v153
    v_mov_b32 v153, v152
    v_mfma_f32_16x16x32_bf16 v[68:71], a[220:223], a[100:103], v[68:71]
    s_cselect_b32 s64, s65, s64
    v_cvt_pk_bf16_f32 v96, v144, v145
    v_cvt_pk_bf16_f32 v97, v146, v147
    v_mfma_f32_16x16x32_bf16 v[68:71], a[224:227], a[104:107], v[68:71]
    s_cselect_b32 s40, s41, s40
    v_cvt_pk_bf16_f32 v100, v148, v149
    v_cvt_pk_bf16_f32 v98, v150, v151
    v_mfma_f32_16x16x32_bf16 v[68:71], a[228:231], a[108:111], v[68:71]
    s_add_u32 s65, s63, 29
    v_fma_f32 v39, v39, s36, v16
    v_fma_f32 v42, v42, s36, v17
    v_mfma_f32_16x16x32_bf16 v[68:71], a[232:235], a[112:115], v[68:71]
    s_cmp_eq_u32 s62, 2
    v_fma_f32 v43, v43, s36, v17
    v_fma_f32 v44, v44, s36, v17
    v_mfma_f32_16x16x32_bf16 v[68:71], a[236:239], a[116:119], v[68:71]
    s_cselect_b32 s64, s65, s64
    s_cselect_b32 s40, 0, s40
    s_add_u32 s65, s63, 41
    v_mfma_f32_16x16x32_bf16 v[76:79], a[216:219], a[120:123], 0
    s_cmp_eq_u32 s62, 3
    s_cselect_b32 s64, s65, s64
    s_cselect_b32 s40, 0, s40
    v_mfma_f32_16x16x32_bf16 v[76:79], a[220:223], a[124:127], v[76:79]
    s_mul_i32 s64, s64, 6144
    s_add_u32 s41, s48, s64
    s_cmp_ge_u32 s69, 8
    v_mfma_f32_16x16x32_bf16 v[76:79], a[224:227], a[128:131], v[76:79]
    s_cselect_b32 s41, 166725632, s41
    s_add_u32 m0, s33, s31
    v_fma_f32 v45, v45, s36, v17
    v_mfma_f32_16x16x32_bf16 v[76:79], a[228:231], a[132:135], v[76:79]
    buffer_load_dwordx4 v7, s[20:23], s28 offen offset:0 lds
    v_mfma_f32_16x16x32_bf16 v[76:79], a[232:235], a[136:139], v[76:79]
    buffer_load_dwordx4 v8, s[20:23], s28 offen offset:1024 lds
    v_mfma_f32_16x16x32_bf16 v[76:79], a[236:239], a[140:143], v[76:79]
    buffer_load_dwordx4 v9, s[20:23], s28 offen offset:2048 lds
    s_add_u32 m0, s33, s32
    v_mfma_f32_16x16x32_bf16 v[84:87], a[216:219], a[144:147], 0
    buffer_load_dwordx4 v10, s[24:27], s29 offen offset:0 lds
    v_mfma_f32_16x16x32_bf16 v[84:87], a[220:223], a[148:151], v[84:87]
    buffer_load_dwordx4 v11, s[24:27], s29 offen offset:1024 lds
    v_mfma_f32_16x16x32_bf16 v[84:87], a[224:227], a[152:155], v[84:87]
    buffer_load_dwordx4 v12, s[24:27], s29 offen offset:2048 lds
    s_add_u32 s28, s28, s30
    s_add_u32 s29, s29, s30
    v_mfma_f32_16x16x32_bf16 v[84:87], a[228:231], a[156:159], v[84:87]
    s_add_u32 s33, s33, 24576
    s_cmp_eq_u32 s33, 147456
    v_fma_f32 v46, v46, s36, v17
    v_mfma_f32_16x16x32_bf16 v[84:87], a[232:235], a[160:163], v[84:87]
    s_cselect_b32 s33, 0, s33
    v_fma_f32 v47, v47, s36, v17
    s_add_u32 m0, s33, s31
    v_mfma_f32_16x16x32_bf16 v[84:87], a[236:239], a[164:167], v[84:87]
    buffer_load_dwordx4 v7, s[20:23], s28 offen offset:0 lds
    buffer_load_dwordx4 v8, s[20:23], s28 offen offset:1024 lds
    buffer_load_dwordx4 v9, s[20:23], s28 offen offset:2048 lds
    s_add_u32 m0, s33, s32
    v_permlane16_swap_b32 v153, v152
    v_exp_f32 v144, v38
    v_exp_f32 v145, v39
    v_exp_f32 v146, v42
    v_exp_f32 v147, v43
    v_exp_f32 v148, v44
    v_exp_f32 v149, v45
    v_exp_f32 v150, v46
    v_exp_f32 v151, v47
    v_max_f32 v152, v152, v153
    v_mul_f32_e64 v18, -s36, v152
    v_cvt_pk_bf16_f32 v99, v144, v145
    buffer_load_dwordx4 v10, s[24:27], s29 offen offset:0 lds
    buffer_load_dwordx4 v11, s[24:27], s29 offen offset:1024 lds
    v_mfma_f32_16x16x32_bf16 v[128:131], v[24:27], v[96:99], 0
    buffer_load_dwordx4 v12, s[24:27], s29 offen offset:2048 lds
    s_add_u32 s28, s28, s30
    v_cvt_pk_bf16_f32 v101, v146, v147
    v_cvt_pk_bf16_f32 v102, v148, v149
    v_cvt_pk_bf16_f32 v103, v150, v151
    v_fma_f32 v48, v48, s36, v18
    v_fma_f32 v49, v49, s36, v18
    v_mfma_f32_16x16x32_bf16 v[132:135], v[24:27], v[100:103], 0
    v_fma_f32 v50, v50, s36, v18
    v_fma_f32 v51, v51, s36, v18
    v_fma_f32 v52, v52, s36, v18
    v_fma_f32 v53, v53, s36, v18
    v_fma_f32 v54, v54, s36, v18
    v_fma_f32 v55, v55, s36, v18
    v_exp_f32 v144, v48
    v_exp_f32 v145, v49
    s_waitcnt vmcnt(42)
    s_barrier
    v_exp_f32 v146, v50
    v_exp_f32 v147, v51
    v_exp_f32 v148, v52
    v_exp_f32 v149, v53
    v_exp_f32 v150, v54
    v_exp_f32 v151, v55
    v_cvt_pk_bf16_f32 v104, v144, v145
    v_cvt_pk_bf16_f32 v105, v146, v147
    v_cvt_pk_bf16_f32 v106, v148, v149
    v_cvt_pk_bf16_f32 v107, v150, v151
    ds_read_b64_tr_b16 a[240:241], v3 offset:0
    ds_read_b64_tr_b16 a[242:243], v3 offset:6144
    v_mfma_f32_16x16x32_bf16 v[136:139], v[24:27], v[104:107], 0
    ds_read_b64_tr_b16 a[244:245], v4 offset:0
    ds_read_b64_tr_b16 a[246:247], v4 offset:6144
    ds_read_b64_tr_b16 a[248:249], v5 offset:0
    ds_read_b64_tr_b16 a[250:251], v5 offset:6144
    ds_read_b64_tr_b16 a[252:253], v6 offset:0
    ds_read_b64_tr_b16 a[254:255], v6 offset:6144
    v_fma_f32 v64, v64, s36, v16
    v_fma_f32 v65, v65, s36, v16
    v_fma_f32 v66, v66, s36, v16
    v_fma_f32 v67, v67, s36, v16
    v_fma_f32 v72, v72, s36, v17
    v_fma_f32 v73, v73, s36, v17
    s_add_u32 s29, s29, s30
    v_exp_f32 v144, v64
    v_exp_f32 v145, v65
    v_exp_f32 v146, v66
    v_exp_f32 v147, v67
    v_exp_f32 v148, v72
    v_exp_f32 v149, v73
    s_add_u32 s33, s33, 24576
    s_cmp_eq_u32 s33, 147456
    s_cselect_b32 s33, 0, s33
    v_cvt_pk_bf16_f32 v112, v144, v145
    v_cvt_pk_bf16_f32 v113, v146, v147
    v_cvt_pk_bf16_f32 v116, v148, v149
    v_add_u32 v2, s57, v2
    s_waitcnt lgkmcnt(6)
    v_mfma_f32_16x16x32_bf16 v[160:163], a[240:243], v[96:99], 0
    s_add_u32 m0, s33, s31
    ds_read_b128 a[192:195], v1 offset:0
    ds_read_b128 a[196:199], v2 offset:0
    v_mfma_f32_16x16x32_bf16 v[208:211], a[240:243], v[100:103], 0
    ds_read_b128 a[200:203], v1 offset:1024
    ds_read_b128 a[204:207], v2 offset:1024
    v_mfma_f32_16x16x32_bf16 a[0:3], a[240:243], v[104:107], 0
    s_waitcnt lgkmcnt(4)
    ds_read_b64_tr_b16 a[240:241], v3 offset:1024
    ds_read_b64_tr_b16 a[242:243], v3 offset:7168
    v_mfma_f32_16x16x32_bf16 v[164:167], a[244:247], v[96:99], 0
    buffer_load_dwordx4 v7, s[20:23], s28 offen offset:0 lds
    v_mfma_f32_16x16x32_bf16 v[212:215], a[244:247], v[100:103], 0
    ds_read_b128 a[208:211], v1 offset:2048
    ds_read_b128 a[212:215], v2 offset:2048
    v_mfma_f32_16x16x32_bf16 a[4:7], a[244:247], v[104:107], 0
    ds_read_b64_tr_b16 a[244:245], v4 offset:1024
    ds_read_b64_tr_b16 a[246:247], v4 offset:7168
    v_mfma_f32_16x16x32_bf16 v[168:171], a[248:251], v[96:99], 0
    ds_read_b128 a[216:219], v1 offset:6144
    ds_read_b128 a[220:223], v2 offset:6144
    v_mfma_f32_16x16x32_bf16 v[216:219], a[248:251], v[100:103], 0
    ds_read_b128 a[224:227], v1 offset:7168
    ds_read_b128 a[228:231], v2 offset:7168
    v_mfma_f32_16x16x32_bf16 a[8:11], a[248:251], v[104:107], 0
    ds_read_b64_tr_b16 a[248:249], v5 offset:1024
    ds_read_b64_tr_b16 a[250:251], v5 offset:7168
    v_mfma_f32_16x16x32_bf16 v[172:175], a[252:255], v[96:99], 0
    ds_read_b128 a[232:235], v1 offset:8192
    ds_read_b128 a[236:239], v2 offset:8192
    v_mfma_f32_16x16x32_bf16 v[220:223], a[252:255], v[100:103], 0
    v_fma_f32 v68, v68, s36, v16
    v_fma_f32 v69, v69, s36, v16
    v_mfma_f32_16x16x32_bf16 a[12:15], a[252:255], v[104:107], 0
    s_waitcnt lgkmcnt(12)
    ds_read_b64_tr_b16 a[252:253], v6 offset:1024
    ds_read_b64_tr_b16 a[254:255], v6 offset:7168
    v_mfma_f32_16x16x32_bf16 v[176:179], a[240:243], v[96:99], 0
    buffer_load_dwordx4 v8, s[20:23], s28 offen offset:1024 lds
    v_mfma_f32_16x16x32_bf16 v[224:227], a[240:243], v[100:103], 0
    v_exp_f32 v150, v68
    v_mfma_f32_16x16x32_bf16 a[16:19], a[240:243], v[104:107], 0
    s_waitcnt lgkmcnt(8)
    ds_read_b64_tr_b16 a[240:241], v3 offset:2048
    ds_read_b64_tr_b16 a[242:243], v3 offset:8192
    v_mfma_f32_16x16x32_bf16 v[180:183], a[244:247], v[96:99], 0
    v_exp_f32 v151, v69
    v_mfma_f32_16x16x32_bf16 v[228:231], a[244:247], v[100:103], 0
    v_cvt_pk_bf16_f32 v114, v150, v151
    v_fma_f32 v70, v70, s36, v16
    v_mfma_f32_16x16x32_bf16 a[20:23], a[244:247], v[104:107], 0
    s_waitcnt lgkmcnt(4)
    ds_read_b64_tr_b16 a[244:245], v4 offset:2048
    ds_read_b64_tr_b16 a[246:247], v4 offset:8192
    v_mfma_f32_16x16x32_bf16 v[184:187], a[248:251], v[96:99], 0
    v_fma_f32 v71, v71, s36, v16
    v_fma_f32 v74, v74, s36, v17
    v_mfma_f32_16x16x32_bf16 v[232:235], a[248:251], v[100:103], 0
    v_fma_f32 v75, v75, s36, v17
    v_fma_f32 v76, v76, s36, v17
    v_mfma_f32_16x16x32_bf16 a[24:27], a[248:251], v[104:107], 0
    s_waitcnt lgkmcnt(4)
    ds_read_b64_tr_b16 a[248:249], v5 offset:2048
    ds_read_b64_tr_b16 a[250:251], v5 offset:8192
    v_mfma_f32_16x16x32_bf16 v[188:191], a[252:255], v[96:99], 0
    buffer_load_dwordx4 v9, s[20:23], s28 offen offset:2048 lds
    v_mfma_f32_16x16x32_bf16 v[236:239], a[252:255], v[100:103], 0
    s_add_u32 m0, s33, s32
    v_fma_f32 v77, v77, s36, v17
    v_fma_f32 v78, v78, s36, v17
    v_mfma_f32_16x16x32_bf16 a[28:31], a[252:255], v[104:107], 0
    s_waitcnt lgkmcnt(4)
    ds_read_b64_tr_b16 a[252:253], v6 offset:2048
    ds_read_b64_tr_b16 a[254:255], v6 offset:8192
    v_mfma_f32_16x16x32_bf16 v[192:195], a[240:243], v[96:99], 0
    v_fma_f32 v79, v79, s36, v17
    v_fma_f32 v80, v80, s36, v18
    v_mfma_f32_16x16x32_bf16 v[240:243], a[240:243], v[100:103], 0
    v_exp_f32 v144, v70
    v_mfma_f32_16x16x32_bf16 a[32:35], a[240:243], v[104:107], 0
    s_waitcnt lgkmcnt(4)
    v_exp_f32 v145, v71
    v_mfma_f32_16x16x32_bf16 v[196:199], a[244:247], v[96:99], 0
    v_exp_f32 v146, v74
    v_mfma_f32_16x16x32_bf16 v[244:247], a[244:247], v[100:103], 0
    v_exp_f32 v147, v75
    v_mfma_f32_16x16x32_bf16 a[36:39], a[244:247], v[104:107], 0
    s_waitcnt lgkmcnt(2)
    v_exp_f32 v148, v76
    v_mfma_f32_16x16x32_bf16 v[200:203], a[248:251], v[96:99], 0
    buffer_load_dwordx4 v10, s[24:27], s29 offen offset:0 lds
    v_mfma_f32_16x16x32_bf16 v[248:251], a[248:251], v[100:103], 0
    v_exp_f32 v149, v77
    v_mfma_f32_16x16x32_bf16 a[40:43], a[248:251], v[104:107], 0
    s_waitcnt lgkmcnt(0)
    v_exp_f32 v150, v78
    v_mfma_f32_16x16x32_bf16 v[204:207], a[252:255], v[96:99], 0
    v_exp_f32 v151, v79
    v_mfma_f32_16x16x32_bf16 v[252:255], a[252:255], v[100:103], 0
    v_cvt_pk_bf16_f32 v115, v144, v145
    v_cvt_pk_bf16_f32 v117, v146, v147
    v_mfma_f32_16x16x32_bf16 a[44:47], a[252:255], v[104:107], 0
    v_cvt_pk_bf16_f32 v118, v148, v149
    v_cvt_pk_bf16_f32 v119, v150, v151
    v_mfma_f32_16x16x32_bf16 v[32:35], a[192:195], a[96:99], 0
    v_fma_f32 v81, v81, s36, v18
    v_fma_f32 v82, v82, s36, v18
    v_mfma_f32_16x16x32_bf16 v[32:35], a[196:199], a[100:103], v[32:35]
    v_fma_f32 v83, v83, s36, v18
    v_fma_f32 v84, v84, s36, v18
    v_mfma_f32_16x16x32_bf16 v[32:35], a[200:203], a[104:107], v[32:35]
    v_fma_f32 v85, v85, s36, v18
    v_fma_f32 v86, v86, s36, v18
    v_mfma_f32_16x16x32_bf16 v[32:35], a[204:207], a[108:111], v[32:35]
    buffer_load_dwordx4 v11, s[24:27], s29 offen offset:1024 lds
    v_mfma_f32_16x16x32_bf16 v[32:35], a[208:211], a[112:115], v[32:35]
    v_fma_f32 v87, v87, s36, v18
    v_mov_b32 v20, v128
    v_mfma_f32_16x16x32_bf16 v[128:131], v[24:27], v[112:115], 0
    v_exp_f32 v144, v80
    v_mfma_f32_16x16x32_bf16 v[32:35], a[212:215], a[116:119], v[32:35]
    v_exp_f32 v145, v81
    v_mfma_f32_16x16x32_bf16 v[40:43], a[192:195], a[120:123], 0
    v_exp_f32 v146, v82
    v_mfma_f32_16x16x32_bf16 v[40:43], a[196:199], a[124:127], v[40:43]
    v_exp_f32 v147, v83
    v_mfma_f32_16x16x32_bf16 v[40:43], a[200:203], a[128:131], v[40:43]
    v_exp_f32 v148, v84
    v_mfma_f32_16x16x32_bf16 v[40:43], a[204:207], a[132:135], v[40:43]
    v_exp_f32 v149, v85
    v_mfma_f32_16x16x32_bf16 v[40:43], a[208:211], a[136:139], v[40:43]
    v_exp_f32 v150, v86
    v_mfma_f32_16x16x32_bf16 v[40:43], a[212:215], a[140:143], v[40:43]
    buffer_load_dwordx4 v12, s[24:27], s29 offen offset:2048 lds
    v_mfma_f32_16x16x32_bf16 v[48:51], a[192:195], a[144:147], 0
    s_add_u32 s28, s28, s30
    v_exp_f32 v151, v87
    v_mfma_f32_16x16x32_bf16 v[48:51], a[196:199], a[148:151], v[48:51]
    s_add_u32 s29, s29, s30
    v_cvt_pk_bf16_f32 v120, v144, v145
    v_cvt_pk_bf16_f32 v121, v146, v147
    v_mfma_f32_16x16x32_bf16 v[48:51], a[200:203], a[152:155], v[48:51]
    s_add_u32 s33, s33, 24576
    v_cvt_pk_bf16_f32 v122, v148, v149
    v_cvt_pk_bf16_f32 v123, v150, v151
    v_mfma_f32_16x16x32_bf16 v[48:51], a[204:207], a[156:159], v[48:51]
    s_cmp_eq_u32 s33, 147456
    v_mov_b32 v21, v132
    v_mov_b32 v22, v136
    v_mfma_f32_16x16x32_bf16 v[132:135], v[24:27], v[116:119], 0
    s_cselect_b32 s33, 0, s33
    v_mfma_f32_16x16x32_bf16 v[136:139], v[24:27], v[120:123], 0
    v_mfma_f32_16x16x32_bf16 v[48:51], a[208:211], a[160:163], v[48:51]
    v_mfma_f32_16x16x32_bf16 v[48:51], a[212:215], a[164:167], v[48:51]
    v_mfma_f32_16x16x32_bf16 v[36:39], a[216:219], a[96:99], 0
    v_mfma_f32_16x16x32_bf16 v[36:39], a[220:223], a[100:103], v[36:39]
    v_mfma_f32_16x16x32_bf16 v[36:39], a[224:227], a[104:107], v[36:39]
    v_mfma_f32_16x16x32_bf16 v[36:39], a[228:231], a[108:111], v[36:39]
    s_waitcnt vmcnt(42)
    s_barrier
    v_max3_f32 v30, v128, v132, v136
    v_cmp_lt_f32 vcc, s37, v30
    v_mfma_f32_16x16x32_bf16 v[36:39], a[232:235], a[112:115], v[36:39]
    v_mfma_f32_16x16x32_bf16 v[36:39], a[236:239], a[116:119], v[36:39]
    ds_read_b64_tr_b16 a[240:241], v3 offset:24576
    ds_read_b64_tr_b16 a[242:243], v3 offset:30720
    v_mfma_f32_16x16x32_bf16 v[44:47], a[216:219], a[120:123], 0
    s_cbranch_vccnz L_rs_tr43a
L_ret_tr43a:
    ds_read_b64_tr_b16 a[244:245], v4 offset:24576
    ds_read_b64_tr_b16 a[246:247], v4 offset:30720
    v_mfma_f32_16x16x32_bf16 v[44:47], a[220:223], a[124:127], v[44:47]
    v_fma_f32 v32, v32, s36, v16
    v_fma_f32 v33, v33, s36, v16
    v_mfma_f32_16x16x32_bf16 v[44:47], a[224:227], a[128:131], v[44:47]
    ds_read_b64_tr_b16 a[248:249], v5 offset:24576
    ds_read_b64_tr_b16 a[250:251], v5 offset:30720
    v_mfma_f32_16x16x32_bf16 v[44:47], a[228:231], a[132:135], v[44:47]
    ds_read_b64_tr_b16 a[252:253], v6 offset:24576
    ds_read_b64_tr_b16 a[254:255], v6 offset:30720
    v_mfma_f32_16x16x32_bf16 v[44:47], a[232:235], a[136:139], v[44:47]
    v_fma_f32 v34, v34, s36, v16
    v_fma_f32 v35, v35, s36, v16
    v_mfma_f32_16x16x32_bf16 v[44:47], a[236:239], a[140:143], v[44:47]
    v_fma_f32 v40, v40, s36, v17
    v_fma_f32 v41, v41, s36, v17
    v_mfma_f32_16x16x32_bf16 v[52:55], a[216:219], a[144:147], 0
    v_exp_f32 v144, v32
    v_mfma_f32_16x16x32_bf16 v[52:55], a[220:223], a[148:151], v[52:55]
    v_exp_f32 v145, v33
    v_mfma_f32_16x16x32_bf16 v[52:55], a[224:227], a[152:155], v[52:55]
    v_exp_f32 v146, v34
    v_mfma_f32_16x16x32_bf16 v[52:55], a[228:231], a[156:159], v[52:55]
    v_exp_f32 v147, v35
    v_mfma_f32_16x16x32_bf16 v[52:55], a[232:235], a[160:163], v[52:55]
    v_exp_f32 v148, v40
    v_mfma_f32_16x16x32_bf16 v[52:55], a[236:239], a[164:167], v[52:55]
    v_exp_f32 v149, v41
    v_cvt_pk_bf16_f32 v96, v144, v145
    v_cvt_pk_bf16_f32 v97, v146, v147
    v_cvt_pk_bf16_f32 v100, v148, v149
    s_waitcnt lgkmcnt(0)
    v_mfma_f32_16x16x32_bf16 v[160:163], a[240:243], v[112:115], v[160:163]
    s_add_u32 s62, s34, 49152
    ds_read_b128 a[192:195], v1 offset:24576
    ds_read_b128 a[196:199], v2 offset:24576
    v_mfma_f32_16x16x32_bf16 v[208:211], a[240:243], v[116:119], v[208:211]
    s_cmp_eq_u32 s62, 147456
    ds_read_b128 a[200:203], v1 offset:25600
    ds_read_b128 a[204:207], v2 offset:25600
    v_mfma_f32_16x16x32_bf16 a[0:3], a[240:243], v[120:123], a[0:3]
    s_cselect_b32 s62, 0, s62
    ds_read_b64_tr_b16 a[240:241], v3 offset:25600
    ds_read_b64_tr_b16 a[242:243], v3 offset:31744
    v_mfma_f32_16x16x32_bf16 v[164:167], a[244:247], v[112:115], v[164:167]
    s_sub_u32 s58, s62, s34
    ds_read_b128 a[208:211], v1 offset:26624
    ds_read_b128 a[212:215], v2 offset:26624
    v_mfma_f32_16x16x32_bf16 v[212:215], a[244:247], v[116:119], v[212:215]
    s_mov_b32 s34, s62
    ds_read_b128 a[216:219], v1 offset:30720
    ds_read_b128 a[220:223], v2 offset:30720
    v_mfma_f32_16x16x32_bf16 a[4:7], a[244:247], v[120:123], a[4:7]
    s_add_u32 m0, s33, s31
    ds_read_b64_tr_b16 a[244:245], v4 offset:25600
    ds_read_b64_tr_b16 a[246:247], v4 offset:31744
    v_mfma_f32_16x16x32_bf16 v[168:171], a[248:251], v[112:115], v[168:171]
    buffer_load_dwordx4 v7, s[20:23], s28 offen offset:0 lds
    v_mfma_f32_16x16x32_bf16 v[216:219], a[248:251], v[116:119], v[216:219]
    ds_read_b128 a[224:227], v1 offset:31744
    ds_read_b128 a[228:231], v2 offset:31744
    v_mfma_f32_16x16x32_bf16 a[8:11], a[248:251], v[120:123], a[8:11]
    ds_read_b64_tr_b16 a[248:249], v5 offset:25600
    ds_read_b64_tr_b16 a[250:251], v5 offset:31744
    v_mfma_f32_16x16x32_bf16 v[172:175], a[252:255], v[112:115], v[172:175]
    ds_read_b128 a[232:235], v1 offset:32768
    ds_read_b128 a[236:239], v2 offset:32768
    v_mfma_f32_16x16x32_bf16 v[220:223], a[252:255], v[116:119], v[220:223]
    v_fma_f32 v36, v36, s36, v16
    v_fma_f32 v37, v37, s36, v16
    v_mfma_f32_16x16x32_bf16 a[12:15], a[252:255], v[120:123], a[12:15]
    s_waitcnt lgkmcnt(11)
    ds_read_b64_tr_b16 a[252:253], v6 offset:25600
    ds_read_b64_tr_b16 a[254:255], v6 offset:31744
    v_mfma_f32_16x16x32_bf16 v[176:179], a[240:243], v[112:115], v[176:179]
    buffer_load_dwordx4 v8, s[20:23], s28 offen offset:1024 lds
    v_mfma_f32_16x16x32_bf16 v[224:227], a[240:243], v[116:119], v[224:227]
    v_exp_f32 v150, v36
    v_mfma_f32_16x16x32_bf16 a[16:19], a[240:243], v[120:123], a[16:19]
    s_waitcnt lgkmcnt(8)
    ds_read_b64_tr_b16 a[240:241], v3 offset:26624
    ds_read_b64_tr_b16 a[242:243], v3 offset:32768
    v_mfma_f32_16x16x32_bf16 v[180:183], a[244:247], v[112:115], v[180:183]
    v_exp_f32 v151, v37
    v_mfma_f32_16x16x32_bf16 v[228:231], a[244:247], v[116:119], v[228:231]
    v_cvt_pk_bf16_f32 v98, v150, v151
    v_fma_f32 v38, v38, s36, v16
    v_mfma_f32_16x16x32_bf16 a[20:23], a[244:247], v[120:123], a[20:23]
    s_waitcnt lgkmcnt(4)
    ds_read_b64_tr_b16 a[244:245], v4 offset:26624
    ds_read_b64_tr_b16 a[246:247], v4 offset:32768
    v_mfma_f32_16x16x32_bf16 v[184:187], a[248:251], v[112:115], v[184:187]
    v_fma_f32 v39, v39, s36, v16
    v_fma_f32 v42, v42, s36, v17
    v_mfma_f32_16x16x32_bf16 v[232:235], a[248:251], v[116:119], v[232:235]
    v_fma_f32 v43, v43, s36, v17
    v_fma_f32 v44, v44, s36, v17
    v_mfma_f32_16x16x32_bf16 a[24:27], a[248:251], v[120:123], a[24:27]
    s_waitcnt lgkmcnt(4)
    ds_read_b64_tr_b16 a[248:249], v5 offset:26624
    ds_read_b64_tr_b16 a[250:251], v5 offset:32768
    v_mfma_f32_16x16x32_bf16 v[188:191], a[252:255], v[112:115], v[188:191]
    buffer_load_dwordx4 v9, s[20:23], s28 offen offset:2048 lds
    v_mfma_f32_16x16x32_bf16 v[236:239], a[252:255], v[116:119], v[236:239]
    s_add_u32 m0, s33, s32
    v_fma_f32 v45, v45, s36, v17
    v_fma_f32 v46, v46, s36, v17
    v_mfma_f32_16x16x32_bf16 a[28:31], a[252:255], v[120:123], a[28:31]
    s_waitcnt lgkmcnt(4)
    ds_read_b64_tr_b16 a[252:253], v6 offset:26624
    ds_read_b64_tr_b16 a[254:255], v6 offset:32768
    v_mfma_f32_16x16x32_bf16 v[192:195], a[240:243], v[112:115], v[192:195]
    v_fma_f32 v47, v47, s36, v17
    v_fma_f32 v48, v48, s36, v18
    v_mfma_f32_16x16x32_bf16 v[240:243], a[240:243], v[116:119], v[240:243]
    v_exp_f32 v144, v38
    v_mfma_f32_16x16x32_bf16 a[32:35], a[240:243], v[120:123], a[32:35]
    s_waitcnt lgkmcnt(4)
    v_exp_f32 v145, v39
    v_mfma_f32_16x16x32_bf16 v[196:199], a[244:247], v[112:115], v[196:199]
    v_exp_f32 v146, v42
    v_mfma_f32_16x16x32_bf16 v[244:247], a[244:247], v[116:119], v[244:247]
    v_exp_f32 v147, v43
    v_mfma_f32_16x16x32_bf16 a[36:39], a[244:247], v[120:123], a[36:39]
    s_waitcnt lgkmcnt(2)
    v_exp_f32 v148, v44
    v_mfma_f32_16x16x32_bf16 v[200:203], a[248:251], v[112:115], v[200:203]
    buffer_load_dwordx4 v10, s[24:27], s29 offen offset:0 lds
    v_mfma_f32_16x16x32_bf16 v[248:251], a[248:251], v[116:119], v[248:251]
    v_exp_f32 v149, v45
    v_mfma_f32_16x16x32_bf16 a[40:43], a[248:251], v[120:123], a[40:43]
    s_waitcnt lgkmcnt(0)
    v_exp_f32 v150, v46
    v_mfma_f32_16x16x32_bf16 v[204:207], a[252:255], v[112:115], v[204:207]
    v_exp_f32 v151, v47
    v_mfma_f32_16x16x32_bf16 v[252:255], a[252:255], v[116:119], v[252:255]
    v_cvt_pk_bf16_f32 v99, v144, v145
    v_cvt_pk_bf16_f32 v101, v146, v147
    v_mfma_f32_16x16x32_bf16 a[44:47], a[252:255], v[120:123], a[44:47]
    v_cvt_pk_bf16_f32 v102, v148, v149
    v_cvt_pk_bf16_f32 v103, v150, v151
    v_mfma_f32_16x16x32_bf16 v[64:67], a[192:195], a[96:99], 0
    v_fma_f32 v49, v49, s36, v18
    v_fma_f32 v50, v50, s36, v18
    v_mfma_f32_16x16x32_bf16 v[64:67], a[196:199], a[100:103], v[64:67]
    v_fma_f32 v51, v51, s36, v18
    v_fma_f32 v52, v52, s36, v18
    v_mfma_f32_16x16x32_bf16 v[64:67], a[200:203], a[104:107], v[64:67]
    v_fma_f32 v53, v53, s36, v18
    v_fma_f32 v54, v54, s36, v18
    v_mfma_f32_16x16x32_bf16 v[64:67], a[204:207], a[108:111], v[64:67]
    buffer_load_dwordx4 v11, s[24:27], s29 offen offset:1024 lds
    v_mfma_f32_16x16x32_bf16 v[64:67], a[208:211], a[112:115], v[64:67]
    v_fma_f32 v55, v55, s36, v18
    v_add_f32 v20, v20, v128
    v_mfma_f32_16x16x32_bf16 v[128:131], v[24:27], v[96:99], 0
    v_exp_f32 v144, v48
    v_mfma_f32_16x16x32_bf16 v[64:67], a[212:215], a[116:119], v[64:67]
    v_exp_f32 v145, v49
    v_mfma_f32_16x16x32_bf16 v[72:75], a[192:195], a[120:123], 0
    v_exp_f32 v146, v50
    v_mfma_f32_16x16x32_bf16 v[72:75], a[196:199], a[124:127], v[72:75]
    v_exp_f32 v147, v51
    v_mfma_f32_16x16x32_bf16 v[72:75], a[200:203], a[128:131], v[72:75]
    v_exp_f32 v148, v52
    v_mfma_f32_16x16x32_bf16 v[72:75], a[204:207], a[132:135], v[72:75]
    v_exp_f32 v149, v53
    v_mfma_f32_16x16x32_bf16 v[72:75], a[208:211], a[136:139], v[72:75]
    v_exp_f32 v150, v54
    v_mfma_f32_16x16x32_bf16 v[72:75], a[212:215], a[140:143], v[72:75]
    buffer_load_dwordx4 v12, s[24:27], s29 offen offset:2048 lds
    v_mfma_f32_16x16x32_bf16 v[80:83], a[192:195], a[144:147], 0
    s_add_u32 s28, s28, s30
    v_exp_f32 v151, v55
    v_mfma_f32_16x16x32_bf16 v[80:83], a[196:199], a[148:151], v[80:83]
    s_add_u32 s29, s29, s30
    v_cvt_pk_bf16_f32 v104, v144, v145
    v_cvt_pk_bf16_f32 v105, v146, v147
    v_mfma_f32_16x16x32_bf16 v[80:83], a[200:203], a[152:155], v[80:83]
    s_add_u32 s33, s33, 24576
    v_cvt_pk_bf16_f32 v106, v148, v149
    v_cvt_pk_bf16_f32 v107, v150, v151
    v_mfma_f32_16x16x32_bf16 v[80:83], a[204:207], a[156:159], v[80:83]
    s_cmp_eq_u32 s33, 147456
    v_add_f32 v21, v21, v132
    v_add_f32 v22, v22, v136
    v_mfma_f32_16x16x32_bf16 v[132:135], v[24:27], v[100:103], 0
    s_cselect_b32 s33, 0, s33
    v_add_u32 v3, s58, v3
    v_add_u32 v4, s58, v4
    v_mfma_f32_16x16x32_bf16 v[136:139], v[24:27], v[104:107], 0
    v_add_u32 v5, s58, v5
    v_add_u32 v6, s58, v6
    v_mfma_f32_16x16x32_bf16 v[80:83], a[208:211], a[160:163], v[80:83]
    v_add_u32 v1, s58, v1
    v_add_u32 v2, s58, v2
    v_mfma_f32_16x16x32_bf16 v[80:83], a[212:215], a[164:167], v[80:83]
    v_mfma_f32_16x16x32_bf16 v[68:71], a[216:219], a[96:99], 0
    v_mfma_f32_16x16x32_bf16 v[68:71], a[220:223], a[100:103], v[68:71]
    v_max3_f32 v30, v128, v132, v136
    v_cmp_lt_f32 vcc, s37, v30
    v_mfma_f32_16x16x32_bf16 v[68:71], a[224:227], a[104:107], v[68:71]
    v_mfma_f32_16x16x32_bf16 v[68:71], a[228:231], a[108:111], v[68:71]
    s_waitcnt vmcnt(18)
    s_barrier
    v_mfma_f32_16x16x32_bf16 v[68:71], a[232:235], a[112:115], v[68:71]
    s_cbranch_vccnz L_rs_tr43b
L_ret_tr43b:
    v_fma_f32 v64, v64, s36, v16
    v_fma_f32 v65, v65, s36, v16
    v_mfma_f32_16x16x32_bf16 v[68:71], a[236:239], a[116:119], v[68:71]
    ds_read_b64_tr_b16 a[240:241], v3 offset:0
    ds_read_b64_tr_b16 a[242:243], v3 offset:6144
    v_mfma_f32_16x16x32_bf16 v[76:79], a[216:219], a[120:123], 0
    v_fma_f32 v66, v66, s36, v16
    v_fma_f32 v67, v67, s36, v16
    v_mfma_f32_16x16x32_bf16 v[76:79], a[220:223], a[124:127], v[76:79]
    ds_read_b64_tr_b16 a[244:245], v4 offset:0
    ds_read_b64_tr_b16 a[246:247], v4 offset:6144
    v_mfma_f32_16x16x32_bf16 v[76:79], a[224:227], a[128:131], v[76:79]
    ds_read_b64_tr_b16 a[248:249], v5 offset:0
    ds_read_b64_tr_b16 a[250:251], v5 offset:6144
    v_mfma_f32_16x16x32_bf16 v[76:79], a[228:231], a[132:135], v[76:79]
    v_fma_f32 v72, v72, s36, v17
    v_fma_f32 v73, v73, s36, v17
    v_mfma_f32_16x16x32_bf16 v[76:79], a[232:235], a[136:139], v[76:79]
    ds_read_b64_tr_b16 a[252:253], v6 offset:0
    ds_read_b64_tr_b16 a[254:255], v6 offset:6144
    v_mfma_f32_16x16x32_bf16 v[76:79], a[236:239], a[140:143], v[76:79]
    v_exp_f32 v144, v64
    v_mfma_f32_16x16x32_bf16 v[84:87], a[216:219], a[144:147], 0
    v_exp_f32 v145, v65
    v_mfma_f32_16x16x32_bf16 v[84:87], a[220:223], a[148:151], v[84:87]
    v_exp_f32 v146, v66
    v_mfma_f32_16x16x32_bf16 v[84:87], a[224:227], a[152:155], v[84:87]
    v_exp_f32 v147, v67
    v_mfma_f32_16x16x32_bf16 v[84:87], a[228:231], a[156:159], v[84:87]
    v_exp_f32 v148, v72
    v_mfma_f32_16x16x32_bf16 v[84:87], a[232:235], a[160:163], v[84:87]
    v_exp_f32 v149, v73
    v_mfma_f32_16x16x32_bf16 v[84:87], a[236:239], a[164:167], v[84:87]
    v_cvt_pk_bf16_f32 v112, v144, v145
    v_cvt_pk_bf16_f32 v113, v146, v147
    v_cvt_pk_bf16_f32 v116, v148, v149
    s_mov_b32 s38, 0
    s_branch L_loop3
L_tr44:
    s_waitcnt vmcnt(6)
    s_waitcnt lgkmcnt(4)
    v_mfma_f32_16x16x32_bf16 v[160:163], a[240:243], v[96:99], v[160:163]
    s_add_u32 s65, s34, 24576
    v_add_u32 v28, s35, v1
    v_add_u32 v29, s35, v2
    ds_read_b128 a[96:99], v28 offset:24576
    ds_read_b128 a[100:103], v29 offset:24576
    ds_read_b128 a[104:107], v28 offset:25600
    ds_read_b128 a[108:111], v29 offset:25600
    ds_read_b128 a[112:115], v28 offset:26624
    ds_read_b128 a[116:119], v29 offset:26624
    v_mfma_f32_16x16x32_bf16 v[208:211], a[240:243], v[100:103], v[208:211]
    s_add_u32 s62, s34, 49152
    v_xor_b32 v156, 80, v7
    v_xor_b32 v157, 80, v8
    v_mfma_f32_16x16x32_bf16 a[0:3], a[240:243], v[104:107], a[0:3]
    s_cmp_eq_u32 s62, 147456
    v_fma_f32 v68, v68, s36, v16
    v_fma_f32 v69, v69, s36, v16
    v_mfma_f32_16x16x32_bf16 a[48:51], a[240:243], v[108:111], a[48:51]
    s_cselect_b32 s62, 0, s62
    ds_read_b64_tr_b16 a[240:241], v3 offset:1024
    ds_read_b64_tr_b16 a[242:243], v3 offset:7168
    v_mfma_f32_16x16x32_bf16 v[164:167], a[244:247], v[96:99], v[164:167]
    s_sub_u32 s56, s62, s34
    v_add_u32 v154, s56, v28
    v_add_u32 v155, s56, v29
    ds_read_b128 a[120:123], v154 offset:0
    ds_read_b128 a[124:127], v155 offset:0
    ds_read_b128 a[128:131], v154 offset:1024
    ds_read_b128 a[132:135], v155 offset:1024
    ds_read_b128 a[136:139], v154 offset:2048
    ds_read_b128 a[140:143], v155 offset:2048
    v_mfma_f32_16x16x32_bf16 v[212:215], a[244:247], v[100:103], v[212:215]
    s_mov_b32 s34, s62
    v_xor_b32 v158, 80, v9
    v_fma_f32 v70, v70, s36, v16
    v_mfma_f32_16x16x32_bf16 a[4:7], a[244:247], v[104:107], a[4:7]
    s_and_b32 s63, s3, 1
    v_exp_f32 v150, v68
    v_mfma_f32_16x16x32_bf16 a[52:55], a[244:247], v[108:111], a[52:55]
    s_mul_i32 s63, s63, 3072
    ds_read_b64_tr_b16 a[244:245], v4 offset:1024
    ds_read_b64_tr_b16 a[246:247], v4 offset:7168
    s_waitcnt lgkmcnt(10)
    v_mfma_f32_16x16x32_bf16 v[168:171], a[248:251], v[96:99], v[168:171]
    s_add_u32 s67, s41, 12288
    v_exp_f32 v151, v69
    v_mfma_f32_16x16x32_bf16 v[216:219], a[248:251], v[100:103], v[216:219]
    s_add_u32 s68, s67, s63
    v_cvt_pk_bf16_f32 v114, v150, v151
    v_fma_f32 v71, v71, s36, v16
    v_mfma_f32_16x16x32_bf16 a[8:11], a[248:251], v[104:107], a[8:11]
    s_add_u32 s64, s65, s35
    v_fma_f32 v74, v74, s36, v17
    v_fma_f32 v75, v75, s36, v17
    v_mfma_f32_16x16x32_bf16 a[56:59], a[248:251], v[108:111], a[56:59]
    s_add_u32 s64, s64, 0
    ds_read_b64_tr_b16 a[248:249], v5 offset:1024
    ds_read_b64_tr_b16 a[250:251], v5 offset:7168
    v_mfma_f32_16x16x32_bf16 v[172:175], a[252:255], v[96:99], v[172:175]
    s_add_u32 m0, s64, s63
    v_fma_f32 v76, v76, s36, v17
    v_fma_f32 v77, v77, s36, v17
    v_mfma_f32_16x16x32_bf16 v[220:223], a[252:255], v[100:103], v[220:223]
    buffer_load_dwordx4 v7, s[12:15], s68 offen offset:0 nt lds
    v_mfma_f32_16x16x32_bf16 a[12:15], a[252:255], v[104:107], a[12:15]
    buffer_load_dwordx4 v8, s[12:15], s68 offen offset:1024 nt lds
    v_mfma_f32_16x16x32_bf16 a[60:63], a[252:255], v[108:111], a[60:63]
    buffer_load_dwordx4 v9, s[12:15], s68 offen offset:2048 nt lds
    s_waitcnt lgkmcnt(2)
    v_mfma_f32_16x16x32_bf16 v[176:179], a[240:243], v[96:99], v[176:179]
    s_sub_u32 s63, 3072, s63
    ds_read_b64_tr_b16 a[252:253], v6 offset:1024
    ds_read_b64_tr_b16 a[254:255], v6 offset:7168
    v_mfma_f32_16x16x32_bf16 v[224:227], a[240:243], v[100:103], v[224:227]
    s_add_u32 s68, s67, s63
    v_fma_f32 v78, v78, s36, v17
    v_fma_f32 v79, v79, s36, v17
    v_mfma_f32_16x16x32_bf16 a[16:19], a[240:243], v[104:107], a[16:19]
    s_add_u32 m0, s64, s63
    v_exp_f32 v144, v70
    v_mfma_f32_16x16x32_bf16 a[64:67], a[240:243], v[108:111], a[64:67]
    buffer_load_dwordx4 v156, s[12:15], s68 offen offset:0 nt lds
    v_mfma_f32_16x16x32_bf16 v[180:183], a[244:247], v[96:99], v[180:183]
    buffer_load_dwordx4 v157, s[12:15], s68 offen offset:1024 nt lds
    v_mfma_f32_16x16x32_bf16 v[228:231], a[244:247], v[100:103], v[228:231]
    buffer_load_dwordx4 v158, s[12:15], s68 offen offset:2048 nt lds
    v_mfma_f32_16x16x32_bf16 a[20:23], a[244:247], v[104:107], a[20:23]
    s_and_b32 s63, s3, 1
    ds_read_b64_tr_b16 a[240:241], v3 offset:2048
    ds_read_b64_tr_b16 a[242:243], v3 offset:8192
    v_mfma_f32_16x16x32_bf16 a[68:71], a[244:247], v[108:111], a[68:71]
    s_mul_i32 s63, s63, 3072
    ds_read_b64_tr_b16 a[244:245], v4 offset:2048
    ds_read_b64_tr_b16 a[246:247], v4 offset:8192
    s_waitcnt lgkmcnt(6)
    v_mfma_f32_16x16x32_bf16 v[184:187], a[248:251], v[96:99], v[184:187]
    s_add_u32 s67, s41, 18432
    v_exp_f32 v145, v71
    v_mfma_f32_16x16x32_bf16 v[232:235], a[248:251], v[100:103], v[232:235]
    s_add_u32 s68, s67, s63
    v_exp_f32 v146, v74
    v_mfma_f32_16x16x32_bf16 a[24:27], a[248:251], v[104:107], a[24:27]
    s_add_u32 s64, s34, s35
    v_exp_f32 v147, v75
    v_mfma_f32_16x16x32_bf16 a[72:75], a[248:251], v[108:111], a[72:75]
    s_add_u32 s64, s64, 0
    ds_read_b64_tr_b16 a[248:249], v5 offset:2048
    ds_read_b64_tr_b16 a[250:251], v5 offset:8192
    s_waitcnt lgkmcnt(6)
    v_mfma_f32_16x16x32_bf16 v[188:191], a[252:255], v[96:99], v[188:191]
    s_add_u32 m0, s64, s63
    v_exp_f32 v148, v76
    v_mfma_f32_16x16x32_bf16 v[236:239], a[252:255], v[100:103], v[236:239]
    buffer_load_dwordx4 v7, s[12:15], s68 offen offset:0 nt lds
    v_mfma_f32_16x16x32_bf16 a[28:31], a[252:255], v[104:107], a[28:31]
    buffer_load_dwordx4 v8, s[12:15], s68 offen offset:1024 nt lds
    v_mfma_f32_16x16x32_bf16 a[76:79], a[252:255], v[108:111], a[76:79]
    buffer_load_dwordx4 v9, s[12:15], s68 offen offset:2048 nt lds
    s_waitcnt lgkmcnt(2)
    v_mfma_f32_16x16x32_bf16 v[192:195], a[240:243], v[96:99], v[192:195]
    s_sub_u32 s63, 3072, s63
    ds_read_b64_tr_b16 a[252:253], v6 offset:2048
    ds_read_b64_tr_b16 a[254:255], v6 offset:8192
    v_mfma_f32_16x16x32_bf16 v[240:243], a[240:243], v[100:103], v[240:243]
    s_add_u32 s68, s67, s63
    v_exp_f32 v149, v77
    s_add_u32 m0, s64, s63
    v_mfma_f32_16x16x32_bf16 a[32:35], a[240:243], v[104:107], a[32:35]
    buffer_load_dwordx4 v156, s[12:15], s68 offen offset:0 nt lds
    v_mfma_f32_16x16x32_bf16 a[80:83], a[240:243], v[108:111], a[80:83]
    buffer_load_dwordx4 v157, s[12:15], s68 offen offset:1024 nt lds
    v_mfma_f32_16x16x32_bf16 v[196:199], a[244:247], v[96:99], v[196:199]
    buffer_load_dwordx4 v158, s[12:15], s68 offen offset:2048 nt lds
    s_add_u32 m0, s33, s31
    v_mfma_f32_16x16x32_bf16 v[244:247], a[244:247], v[100:103], v[244:247]
    buffer_load_dwordx4 v7, s[20:23], s28 offen offset:0 lds
    v_mfma_f32_16x16x32_bf16 a[36:39], a[244:247], v[104:107], a[36:39]
    buffer_load_dwordx4 v8, s[20:23], s28 offen offset:1024 lds
    v_mfma_f32_16x16x32_bf16 a[84:87], a[244:247], v[108:111], a[84:87]
    buffer_load_dwordx4 v9, s[20:23], s28 offen offset:2048 lds
    s_add_u32 m0, s33, s32
    s_waitcnt lgkmcnt(0)
    v_mfma_f32_16x16x32_bf16 v[200:203], a[248:251], v[96:99], v[200:203]
    v_exp_f32 v150, v78
    v_mfma_f32_16x16x32_bf16 v[248:251], a[248:251], v[100:103], v[248:251]
    v_exp_f32 v151, v79
    v_mfma_f32_16x16x32_bf16 a[40:43], a[248:251], v[104:107], a[40:43]
    v_cvt_pk_bf16_f32 v115, v144, v145
    v_cvt_pk_bf16_f32 v117, v146, v147
    v_mfma_f32_16x16x32_bf16 a[88:91], a[248:251], v[108:111], a[88:91]
    v_cvt_pk_bf16_f32 v118, v148, v149
    v_cvt_pk_bf16_f32 v119, v150, v151
    v_mfma_f32_16x16x32_bf16 v[204:207], a[252:255], v[96:99], v[204:207]
    v_fma_f32 v80, v80, s36, v18
    v_fma_f32 v81, v81, s36, v18
    v_mfma_f32_16x16x32_bf16 v[252:255], a[252:255], v[100:103], v[252:255]
    buffer_load_dwordx4 v10, s[24:27], s29 offen offset:0 lds
    v_mfma_f32_16x16x32_bf16 a[44:47], a[252:255], v[104:107], a[44:47]
    v_fma_f32 v82, v82, s36, v18
    v_fma_f32 v83, v83, s36, v18
    v_mfma_f32_16x16x32_bf16 a[92:95], a[252:255], v[108:111], a[92:95]
    v_fma_f32 v84, v84, s36, v18
    v_fma_f32 v85, v85, s36, v18
    v_fma_f32 v86, v86, s36, v18
    v_fma_f32 v87, v87, s36, v18
    v_exp_f32 v144, v80
    v_exp_f32 v145, v81
    v_exp_f32 v146, v82
    v_exp_f32 v147, v83
    v_exp_f32 v148, v84
    v_exp_f32 v149, v85
    v_exp_f32 v150, v86
    v_exp_f32 v151, v87
    v_cvt_pk_bf16_f32 v120, v144, v145
    v_cvt_pk_bf16_f32 v121, v146, v147
    v_cvt_pk_bf16_f32 v122, v148, v149
    v_cvt_pk_bf16_f32 v123, v150, v151
    v_fma_f32 v88, v88, s36, v19
    v_fma_f32 v89, v89, s36, v19
    v_fma_f32 v90, v90, s36, v19
    v_fma_f32 v91, v91, s36, v19
    v_fma_f32 v92, v92, s36, v19
    v_fma_f32 v93, v93, s36, v19
    v_fma_f32 v94, v94, s36, v19
    v_fma_f32 v95, v95, s36, v19
    v_exp_f32 v144, v88
    v_exp_f32 v145, v89
    v_exp_f32 v146, v90
    v_exp_f32 v147, v91
    v_exp_f32 v148, v92
    v_exp_f32 v149, v93
    v_exp_f32 v150, v94
    v_exp_f32 v151, v95
    v_cvt_pk_bf16_f32 v124, v144, v145
    v_cvt_pk_bf16_f32 v125, v146, v147
    v_cvt_pk_bf16_f32 v126, v148, v149
    v_cvt_pk_bf16_f32 v127, v150, v151
    v_add_f32 v20, v20, v128
    v_mfma_f32_16x16x32_bf16 v[128:131], v[24:27], v[112:115], 0
    buffer_load_dwordx4 v11, s[24:27], s29 offen offset:1024 lds
    buffer_load_dwordx4 v12, s[24:27], s29 offen offset:2048 lds
    s_waitcnt vmcnt(18)
    s_barrier
    v_add_f32 v21, v21, v132
    v_mfma_f32_16x16x32_bf16 v[132:135], v[24:27], v[116:119], 0
    v_add_f32 v22, v22, v136
    v_add_f32 v23, v23, v140
    v_mfma_f32_16x16x32_bf16 v[136:139], v[24:27], v[120:123], 0
    s_add_u32 s28, s28, s30
    s_add_u32 s29, s29, s30
    s_add_u32 s33, s33, 24576
    v_mfma_f32_16x16x32_bf16 v[140:143], v[24:27], v[124:127], 0
    s_cmp_eq_u32 s33, 147456
    v_add_u32 v3, s56, v3
    v_add_u32 v4, s56, v4
    v_add_u32 v5, s56, v5
    v_max3_f32 v30, v128, v132, v136
    v_add_u32 v6, s56, v6
    s_cselect_b32 s33, 0, s33
    ds_read_b64_tr_b16 a[240:241], v3 offset:24576
    v_max_f32 v30, v30, v140
    v_cmp_lt_f32 vcc, s37, v30
    ds_read_b64_tr_b16 a[242:243], v3 offset:30720
    ds_read_b64_tr_b16 a[244:245], v4 offset:24576
    ds_read_b64_tr_b16 a[246:247], v4 offset:30720
    ds_read_b64_tr_b16 a[248:249], v5 offset:24576
    ds_read_b64_tr_b16 a[250:251], v5 offset:30720
    s_cbranch_vccnz L_rs_tr44A
L_ret_tr44A:
    ds_read_b64_tr_b16 a[252:253], v6 offset:24576
    ds_read_b64_tr_b16 a[254:255], v6 offset:30720
    s_add_u32 s84, s42, 0
    s_add_u32 s85, s42, 6144
    s_add_u32 s86, s42, 12288
    s_add_u32 s87, s42, 18432
    s_waitcnt lgkmcnt(6)
    v_mfma_f32_16x16x32_bf16 v[160:163], a[240:243], v[112:115], v[160:163]
    s_add_u32 m0, s33, s31
    v_add_f32 v20, v20, v128
    v_add_f32 v21, v21, v132
    v_mfma_f32_16x16x32_bf16 v[208:211], a[240:243], v[116:119], v[208:211]
    v_rcp_f32 v130, v20
    v_mfma_f32_16x16x32_bf16 a[0:3], a[240:243], v[120:123], a[0:3]
    v_rcp_f32 v134, v21
    v_mov_b32 v96, v15
    v_mul_f32 v160, v160, v130
    v_mfma_f32_16x16x32_bf16 a[48:51], a[240:243], v[124:127], a[48:51]
    ds_read_b64_tr_b16 a[240:241], v3 offset:25600
    ds_read_b64_tr_b16 a[242:243], v3 offset:31744
    v_mul_f32 v161, v161, v130
    v_mul_f32 v162, v162, v130
    s_waitcnt lgkmcnt(6)
    v_mfma_f32_16x16x32_bf16 v[164:167], a[244:247], v[112:115], v[164:167]
    v_mul_f32 v163, v163, v130
    v_mul_f32 v208, v208, v134
    v_mul_f32 v209, v209, v134
    v_mul_f32 v210, v210, v134
    v_mfma_f32_16x16x32_bf16 v[212:215], a[244:247], v[116:119], v[212:215]
    v_mul_f32 v211, v211, v134
    v_cvt_pk_bf16_f32 v80, v160, v161
    v_cvt_pk_bf16_f32 v81, v162, v163
    v_cvt_pk_bf16_f32 v82, v208, v209
    v_mfma_f32_16x16x32_bf16 a[4:7], a[244:247], v[120:123], a[4:7]
    v_cvt_pk_bf16_f32 v83, v210, v211
    v_mul_f32 v164, v164, v130
    v_mul_f32 v165, v165, v130
    v_mul_f32 v166, v166, v130
    v_mfma_f32_16x16x32_bf16 a[52:55], a[244:247], v[124:127], a[52:55]
    ds_read_b64_tr_b16 a[244:245], v4 offset:25600
    ds_read_b64_tr_b16 a[246:247], v4 offset:31744
    v_mul_f32 v167, v167, v130
    v_mul_f32 v212, v212, v134
    s_waitcnt lgkmcnt(4)
    v_mfma_f32_16x16x32_bf16 v[168:171], a[248:251], v[112:115], v[168:171]
    v_mul_f32 v213, v213, v134
    v_mul_f32 v214, v214, v134
    v_mul_f32 v215, v215, v134
    v_xor_b32 v97, 32, v15
    v_mfma_f32_16x16x32_bf16 v[216:219], a[248:251], v[116:119], v[216:219]
    v_cvt_pk_bf16_f32 v84, v164, v165
    v_cvt_pk_bf16_f32 v85, v166, v167
    v_cvt_pk_bf16_f32 v86, v212, v213
    v_cvt_pk_bf16_f32 v87, v214, v215
    v_mfma_f32_16x16x32_bf16 a[8:11], a[248:251], v[120:123], a[8:11]
    v_mul_f32 v168, v168, v130
    v_mul_f32 v169, v169, v130
    v_mul_f32 v170, v170, v130
    v_mul_f32 v171, v171, v130
    v_mfma_f32_16x16x32_bf16 a[56:59], a[248:251], v[124:127], a[56:59]
    ds_read_b64_tr_b16 a[248:249], v5 offset:25600
    ds_read_b64_tr_b16 a[250:251], v5 offset:31744
    v_mul_f32 v216, v216, v134
    v_mul_f32 v217, v217, v134
    v_mfma_f32_16x16x32_bf16 v[172:175], a[252:255], v[112:115], v[172:175]
    buffer_load_dwordx4 v7, s[20:23], s28 offen offset:0 lds
    s_waitcnt vmcnt(7)
    ds_read_b128 a[168:171], v154 offset:0
    ds_read_b128 a[172:175], v155 offset:0
    ds_read_b128 a[176:179], v154 offset:1024
    ds_read_b128 a[180:183], v155 offset:1024
    ds_read_b128 a[184:187], v154 offset:2048
    ds_read_b128 a[188:191], v155 offset:2048
    ds_read_b128 a[144:147], v28 offset:24576
    ds_read_b128 a[148:151], v29 offset:24576
    ds_read_b128 a[152:155], v28 offset:25600
    ds_read_b128 a[156:159], v29 offset:25600
    ds_read_b128 a[160:163], v28 offset:26624
    ds_read_b128 a[164:167], v29 offset:26624
    v_mfma_f32_16x16x32_bf16 v[220:223], a[252:255], v[116:119], v[220:223]
    v_mul_f32 v218, v218, v134
    v_mul_f32 v219, v219, v134
    v_mfma_f32_16x16x32_bf16 a[12:15], a[252:255], v[120:123], a[12:15]
    v_xor_b32 v98, 64, v15
    v_cvt_pk_bf16_f32 v88, v168, v169
    v_mfma_f32_16x16x32_bf16 a[60:63], a[252:255], v[124:127], a[60:63]
    buffer_load_dwordx4 v8, s[20:23], s28 offen offset:1024 lds
    ds_read_b64_tr_b16 a[252:253], v6 offset:25600
    ds_read_b64_tr_b16 a[254:255], v6 offset:31744
    s_waitcnt lgkmcnt(14)
    v_mfma_f32_16x16x32_bf16 v[176:179], a[240:243], v[112:115], v[176:179]
    v_cvt_pk_bf16_f32 v89, v170, v171
    v_cvt_pk_bf16_f32 v90, v216, v217
    v_mfma_f32_16x16x32_bf16 v[224:227], a[240:243], v[116:119], v[224:227]
    v_cvt_pk_bf16_f32 v91, v218, v219
    v_mul_f32 v172, v172, v130
    v_mfma_f32_16x16x32_bf16 a[16:19], a[240:243], v[120:123], a[16:19]
    v_mul_f32 v173, v173, v130
    v_mul_f32 v174, v174, v130
    v_mfma_f32_16x16x32_bf16 a[64:67], a[240:243], v[124:127], a[64:67]
    ds_read_b64_tr_b16 a[240:241], v3 offset:26624
    ds_read_b64_tr_b16 a[242:243], v3 offset:32768
    v_mfma_f32_16x16x32_bf16 v[180:183], a[244:247], v[112:115], v[180:183]
    v_mul_f32 v175, v175, v130
    v_mul_f32 v220, v220, v134
    v_mul_f32 v221, v221, v134
    v_mfma_f32_16x16x32_bf16 v[228:231], a[244:247], v[116:119], v[228:231]
    buffer_load_dwordx4 v9, s[20:23], s28 offen offset:2048 lds
    v_mul_f32 v222, v222, v134
    v_mfma_f32_16x16x32_bf16 a[20:23], a[244:247], v[120:123], a[20:23]
    s_add_u32 m0, s33, s32
    v_mul_f32 v223, v223, v134
    v_xor_b32 v99, 96, v15
    v_cvt_pk_bf16_f32 v92, v172, v173
    v_cvt_pk_bf16_f32 v93, v174, v175
    v_mfma_f32_16x16x32_bf16 a[68:71], a[244:247], v[124:127], a[68:71]
    ds_read_b64_tr_b16 a[244:245], v4 offset:26624
    ds_read_b64_tr_b16 a[246:247], v4 offset:32768
    v_cvt_pk_bf16_f32 v94, v220, v221
    v_cvt_pk_bf16_f32 v95, v222, v223
    v_mfma_f32_16x16x32_bf16 v[184:187], a[248:251], v[112:115], v[184:187]
    v_add_f32 v22, v22, v136
    v_add_f32 v23, v23, v140
    v_rcp_f32 v138, v22
    v_mfma_f32_16x16x32_bf16 v[232:235], a[248:251], v[116:119], v[232:235]
    buffer_load_dwordx4 v10, s[24:27], s29 offen offset:0 lds
    v_accvgpr_read_b32 v64, a0
    v_mfma_f32_16x16x32_bf16 a[24:27], a[248:251], v[120:123], a[24:27]
    v_rcp_f32 v142, v23
    v_accvgpr_read_b32 v65, a1
    v_accvgpr_read_b32 v66, a2
    v_mfma_f32_16x16x32_bf16 a[72:75], a[248:251], v[124:127], a[72:75]
    ds_read_b64_tr_b16 a[248:249], v5 offset:26624
    ds_read_b64_tr_b16 a[250:251], v5 offset:32768
    v_accvgpr_read_b32 v67, a3
    v_accvgpr_read_b32 v68, a48
    s_waitcnt lgkmcnt(4)
    v_mfma_f32_16x16x32_bf16 v[188:191], a[252:255], v[112:115], v[188:191]
    v_accvgpr_read_b32 v69, a49
    v_accvgpr_read_b32 v70, a50
    v_accvgpr_read_b32 v71, a51
    v_mul_f32 v64, v64, v138
    v_mfma_f32_16x16x32_bf16 v[236:239], a[252:255], v[116:119], v[236:239]
    buffer_load_dwordx4 v11, s[24:27], s29 offen offset:1024 lds
    v_mul_f32 v65, v65, v138
    v_mfma_f32_16x16x32_bf16 a[28:31], a[252:255], v[120:123], a[28:31]
    v_mul_f32 v66, v66, v138
    v_mul_f32 v67, v67, v138
    v_mul_f32 v68, v68, v142
    v_mul_f32 v69, v69, v142
    ds_read_b128 a[192:195], v1 offset:0
    v_mfma_f32_16x16x32_bf16 a[76:79], a[252:255], v[124:127], a[76:79]
    ds_read_b64_tr_b16 a[252:253], v6 offset:26624
    ds_read_b64_tr_b16 a[254:255], v6 offset:32768
    ds_read_b128 a[196:199], v2 offset:0
    v_mfma_f32_16x16x32_bf16 v[192:195], a[240:243], v[112:115], v[192:195]
    v_mul_f32 v70, v70, v142
    v_mul_f32 v71, v71, v142
    ds_read_b128 a[200:203], v1 offset:1024
    v_mfma_f32_16x16x32_bf16 v[240:243], a[240:243], v[116:119], v[240:243]
    buffer_load_dwordx4 v12, s[24:27], s29 offen offset:2048 lds
    ds_read_b128 a[204:207], v2 offset:1024
    v_mfma_f32_16x16x32_bf16 a[32:35], a[240:243], v[120:123], a[32:35]
    s_add_u32 s28, s28, s30
    v_accvgpr_read_b32 v72, a4
    v_accvgpr_read_b32 v73, a5
    ds_read_b128 a[208:211], v1 offset:2048
    v_mfma_f32_16x16x32_bf16 a[80:83], a[240:243], v[124:127], a[80:83]
    s_add_u32 s29, s29, s30
    ds_read_b128 a[212:215], v2 offset:2048
    s_waitcnt lgkmcnt(8)
    v_mfma_f32_16x16x32_bf16 v[196:199], a[244:247], v[112:115], v[196:199]
    s_add_u32 s33, s33, 24576
    v_accvgpr_read_b32 v74, a6
    v_accvgpr_read_b32 v75, a7
    ds_read_b128 a[216:219], v1 offset:6144
    v_mfma_f32_16x16x32_bf16 v[244:247], a[244:247], v[116:119], v[244:247]
    s_cmp_eq_u32 s33, 147456
    v_accvgpr_read_b32 v76, a52
    v_accvgpr_read_b32 v77, a53
    ds_read_b128 a[220:223], v2 offset:6144
    v_mfma_f32_16x16x32_bf16 a[36:39], a[244:247], v[120:123], a[36:39]
    s_cselect_b32 s33, 0, s33
    ds_read_b128 a[224:227], v1 offset:7168
    v_mfma_f32_16x16x32_bf16 a[84:87], a[244:247], v[124:127], a[84:87]
    s_add_u32 s62, s34, 49152
    v_accvgpr_read_b32 v78, a54
    v_accvgpr_read_b32 v79, a55
    ds_read_b128 a[228:231], v2 offset:7168
    v_mfma_f32_16x16x32_bf16 v[200:203], a[248:251], v[112:115], v[200:203]
    s_cmp_eq_u32 s62, 147456
    v_mul_f32 v72, v72, v138
    v_mul_f32 v73, v73, v138
    ds_read_b128 a[232:235], v1 offset:8192
    v_mfma_f32_16x16x32_bf16 v[248:251], a[248:251], v[116:119], v[248:251]
    s_cselect_b32 s62, 0, s62
    ds_read_b128 a[236:239], v2 offset:8192
    v_mfma_f32_16x16x32_bf16 a[40:43], a[248:251], v[120:123], a[40:43]
    s_sub_u32 s57, s62, s34
    v_mul_f32 v74, v74, v138
    v_mul_f32 v75, v75, v138
    v_mfma_f32_16x16x32_bf16 a[88:91], a[248:251], v[124:127], a[88:91]
    s_mov_b32 s34, s62
    v_mul_f32 v76, v76, v142
    v_mul_f32 v77, v77, v142
    v_mul_f32 v78, v78, v142
    s_waitcnt lgkmcnt(5)
    v_mfma_f32_16x16x32_bf16 v[204:207], a[252:255], v[112:115], v[204:207]
    v_mul_f32 v79, v79, v142
    v_add_u32 v3, s57, v3
    v_add_u32 v4, s57, v4
    v_add_u32 v5, s57, v5
    v_mfma_f32_16x16x32_bf16 v[252:255], a[252:255], v[116:119], v[252:255]
    v_add_u32 v6, s57, v6
    v_add_u32 v1, s56, v1
    v_add_u32 v2, s56, v2
    v_mfma_f32_16x16x32_bf16 a[44:47], a[252:255], v[120:123], a[44:47]
    ds_write2st64_b64 v96, v[80:81], v[82:83] offset0:0 offset1:4
    v_mfma_f32_16x16x32_bf16 a[92:95], a[252:255], v[124:127], a[92:95]
    v_cvt_pk_bf16_f32 v80, v64, v65
    v_cvt_pk_bf16_f32 v81, v66, v67
    v_cvt_pk_bf16_f32 v82, v68, v69
    v_mfma_f32_16x16x32_bf16 v[32:35], a[192:195], a[96:99], 0
    v_cvt_pk_bf16_f32 v83, v70, v71
    v_accvgpr_read_b32 v64, a8
    v_accvgpr_read_b32 v65, a9
    v_accvgpr_read_b32 v66, a10
    v_mfma_f32_16x16x32_bf16 v[32:35], a[196:199], a[100:103], v[32:35]
    v_accvgpr_read_b32 v67, a11
    v_accvgpr_read_b32 v68, a56
    v_accvgpr_read_b32 v69, a57
    v_accvgpr_read_b32 v70, a58
    v_mfma_f32_16x16x32_bf16 v[32:35], a[200:203], a[104:107], v[32:35]
    v_accvgpr_read_b32 v71, a59
    v_mul_f32 v64, v64, v138
    v_mul_f32 v65, v65, v138
    v_mul_f32 v66, v66, v138
    v_mfma_f32_16x16x32_bf16 v[32:35], a[204:207], a[108:111], v[32:35]
    v_mul_f32 v67, v67, v138
    v_mul_f32 v68, v68, v142
    v_mul_f32 v69, v69, v142
    v_mul_f32 v70, v70, v142
    v_mfma_f32_16x16x32_bf16 v[32:35], a[208:211], a[112:115], v[32:35]
    v_mul_f32 v71, v71, v142
    v_mfma_f32_16x16x32_bf16 v[32:35], a[212:215], a[116:119], v[32:35]
    ds_write2st64_b64 v97, v[84:85], v[86:87] offset0:0 offset1:4
    v_mfma_f32_16x16x32_bf16 v[36:39], a[216:219], a[96:99], 0
    s_waitcnt lgkmcnt(1)
    v_cvt_pk_bf16_f32 v84, v72, v73
    v_cvt_pk_bf16_f32 v85, v74, v75
    v_cvt_pk_bf16_f32 v86, v76, v77
    v_mfma_f32_16x16x32_bf16 v[36:39], a[220:223], a[100:103], v[36:39]
    v_cvt_pk_bf16_f32 v87, v78, v79
    v_accvgpr_read_b32 v72, a12
    v_accvgpr_read_b32 v73, a13
    v_accvgpr_read_b32 v74, a14
    v_mfma_f32_16x16x32_bf16 v[36:39], a[224:227], a[104:107], v[36:39]
    v_accvgpr_read_b32 v75, a15
    v_accvgpr_read_b32 v76, a60
    v_accvgpr_read_b32 v77, a61
    v_accvgpr_read_b32 v78, a62
    v_mfma_f32_16x16x32_bf16 v[36:39], a[228:231], a[108:111], v[36:39]
    v_accvgpr_read_b32 v79, a63
    v_mul_f32 v72, v72, v138
    v_mul_f32 v73, v73, v138
    v_mul_f32 v74, v74, v138
    v_mfma_f32_16x16x32_bf16 v[36:39], a[232:235], a[112:115], v[36:39]
    v_mul_f32 v75, v75, v138
    v_mul_f32 v76, v76, v142
    v_mul_f32 v77, v77, v142
    v_mul_f32 v78, v78, v142
    v_mfma_f32_16x16x32_bf16 v[36:39], a[236:239], a[116:119], v[36:39]
    v_mul_f32 v79, v79, v142
    v_mfma_f32_16x16x32_bf16 v[40:43], a[192:195], a[120:123], 0
    ds_write2st64_b64 v98, v[88:89], v[90:91] offset0:0 offset1:4
    v_mfma_f32_16x16x32_bf16 v[40:43], a[196:199], a[124:127], v[40:43]
    v_cvt_pk_bf16_f32 v88, v64, v65
    v_cvt_pk_bf16_f32 v89, v66, v67
    v_cvt_pk_bf16_f32 v90, v68, v69
    v_mfma_f32_16x16x32_bf16 v[40:43], a[200:203], a[128:131], v[40:43]
    v_cvt_pk_bf16_f32 v91, v70, v71
    v_accvgpr_read_b32 v64, a16
    v_accvgpr_read_b32 v65, a17
    v_accvgpr_read_b32 v66, a18
    v_mfma_f32_16x16x32_bf16 v[40:43], a[204:207], a[132:135], v[40:43]
    v_accvgpr_read_b32 v67, a19
    v_accvgpr_read_b32 v68, a64
    v_accvgpr_read_b32 v69, a65
    v_accvgpr_read_b32 v70, a66
    v_mfma_f32_16x16x32_bf16 v[40:43], a[208:211], a[136:139], v[40:43]
    v_accvgpr_read_b32 v71, a67
    v_mfma_f32_16x16x32_bf16 v[40:43], a[212:215], a[140:143], v[40:43]
    ds_write2st64_b64 v99, v[92:93], v[94:95] offset0:0 offset1:4
    v_mfma_f32_16x16x32_bf16 v[44:47], a[216:219], a[120:123], 0
    ds_read_b128 v[144:147], v14 offset:0
    ds_read_b128 v[148:151], v14 offset:1024
    ds_read_b128 v[152:155], v14 offset:2048
    ds_read_b128 v[156:159], v14 offset:3072
    v_mfma_f32_16x16x32_bf16 v[44:47], a[220:223], a[124:127], v[44:47]
    v_cvt_pk_bf16_f32 v92, v72, v73
    v_cvt_pk_bf16_f32 v93, v74, v75
    v_cvt_pk_bf16_f32 v94, v76, v77
    v_mfma_f32_16x16x32_bf16 v[44:47], a[224:227], a[128:131], v[44:47]
    v_cvt_pk_bf16_f32 v95, v78, v79
    v_accvgpr_read_b32 v72, a20
    v_accvgpr_read_b32 v73, a21
    v_accvgpr_read_b32 v74, a22
    v_mfma_f32_16x16x32_bf16 v[44:47], a[228:231], a[132:135], v[44:47]
    v_accvgpr_read_b32 v75, a23
    v_accvgpr_read_b32 v76, a68
    v_accvgpr_read_b32 v77, a69
    v_accvgpr_read_b32 v78, a70
    v_mfma_f32_16x16x32_bf16 v[44:47], a[232:235], a[136:139], v[44:47]
    v_accvgpr_read_b32 v79, a71
    v_mfma_f32_16x16x32_bf16 v[44:47], a[236:239], a[140:143], v[44:47]
    ds_write2st64_b64 v96, v[80:81], v[82:83] offset0:0 offset1:4
    v_mfma_f32_16x16x32_bf16 v[48:51], a[192:195], a[144:147], 0
    s_waitcnt lgkmcnt(4)
    buffer_store_dwordx4 v[144:147], v13, s[16:19], s84 offen offset:0 nt
    v_mfma_f32_16x16x32_bf16 v[48:51], a[196:199], a[148:151], v[48:51]
    ds_write2st64_b64 v97, v[84:85], v[86:87] offset0:0 offset1:4
    v_mfma_f32_16x16x32_bf16 v[48:51], a[200:203], a[152:155], v[48:51]
    ds_write2st64_b64 v98, v[88:89], v[90:91] offset0:0 offset1:4
    v_mfma_f32_16x16x32_bf16 v[48:51], a[204:207], a[156:159], v[48:51]
    s_waitcnt lgkmcnt(3)
    buffer_store_dwordx4 v[148:151], v13, s[16:19], s84 offen offset:3072 nt
    v_mfma_f32_16x16x32_bf16 v[48:51], a[208:211], a[160:163], v[48:51]
    ds_write2st64_b64 v99, v[92:93], v[94:95] offset0:0 offset1:4
    v_mfma_f32_16x16x32_bf16 v[48:51], a[212:215], a[164:167], v[48:51]
    ds_read_b128 v[144:147], v14 offset:0
    ds_read_b128 v[148:151], v14 offset:1024
    v_mfma_f32_16x16x32_bf16 v[52:55], a[216:219], a[144:147], 0
    buffer_store_dwordx4 v[152:155], v13, s[16:19], s85 offen offset:0 nt
    v_mfma_f32_16x16x32_bf16 v[52:55], a[220:223], a[148:151], v[52:55]
    ds_read_b128 v[152:155], v14 offset:2048
    v_mfma_f32_16x16x32_bf16 v[52:55], a[224:227], a[152:155], v[52:55]
    buffer_store_dwordx4 v[156:159], v13, s[16:19], s85 offen offset:3072 nt
    v_mfma_f32_16x16x32_bf16 v[52:55], a[228:231], a[156:159], v[52:55]
    ds_read_b128 v[156:159], v14 offset:3072
    v_mfma_f32_16x16x32_bf16 v[52:55], a[232:235], a[160:163], v[52:55]
    v_mfma_f32_16x16x32_bf16 v[52:55], a[236:239], a[164:167], v[52:55]
    s_waitcnt lgkmcnt(3)
    buffer_store_dwordx4 v[144:147], v13, s[16:19], s86 offen offset:0 nt
    v_mfma_f32_16x16x32_bf16 v[56:59], a[192:195], a[168:171], 0
    v_mfma_f32_16x16x32_bf16 v[56:59], a[196:199], a[172:175], v[56:59]
    v_mfma_f32_16x16x32_bf16 v[56:59], a[200:203], a[176:179], v[56:59]
    s_waitcnt lgkmcnt(1)
    buffer_store_dwordx4 v[148:151], v13, s[16:19], s86 offen offset:3072 nt
    v_mfma_f32_16x16x32_bf16 v[56:59], a[204:207], a[180:183], v[56:59]
    v_mfma_f32_16x16x32_bf16 v[56:59], a[208:211], a[184:187], v[56:59]
    buffer_store_dwordx4 v[152:155], v13, s[16:19], s87 offen offset:0 nt
    v_mfma_f32_16x16x32_bf16 v[56:59], a[212:215], a[188:191], v[56:59]
    v_mfma_f32_16x16x32_bf16 v[60:63], a[216:219], a[168:171], 0
    v_mfma_f32_16x16x32_bf16 v[60:63], a[220:223], a[172:175], v[60:63]
    s_waitcnt lgkmcnt(0)
    buffer_store_dwordx4 v[156:159], v13, s[16:19], s87 offen offset:3072 nt
    v_mfma_f32_16x16x32_bf16 v[60:63], a[224:227], a[176:179], v[60:63]
    v_mfma_f32_16x16x32_bf16 v[60:63], a[228:231], a[180:183], v[60:63]
    v_mfma_f32_16x16x32_bf16 v[60:63], a[232:235], a[184:187], v[60:63]
    v_mfma_f32_16x16x32_bf16 v[60:63], a[236:239], a[188:191], v[60:63]
    s_barrier
    v_pk_mul_f32 v[176:177], v[176:177], v[130:131] op_sel_hi:[1,0]
    v_pk_mul_f32 v[178:179], v[178:179], v[130:131] op_sel_hi:[1,0]
    v_pk_mul_f32 v[224:225], v[224:225], v[134:135] op_sel_hi:[1,0]
    v_pk_mul_f32 v[226:227], v[226:227], v[134:135] op_sel_hi:[1,0]
    v_cvt_pk_bf16_f32 v80, v176, v177
    v_cvt_pk_bf16_f32 v81, v178, v179
    v_cvt_pk_bf16_f32 v82, v224, v225
    v_cvt_pk_bf16_f32 v83, v226, v227
    v_pk_mul_f32 v[180:181], v[180:181], v[130:131] op_sel_hi:[1,0]
    v_pk_mul_f32 v[182:183], v[182:183], v[130:131] op_sel_hi:[1,0]
    v_pk_mul_f32 v[228:229], v[228:229], v[134:135] op_sel_hi:[1,0]
    v_pk_mul_f32 v[230:231], v[230:231], v[134:135] op_sel_hi:[1,0]
    v_cvt_pk_bf16_f32 v84, v180, v181
    v_cvt_pk_bf16_f32 v85, v182, v183
    v_cvt_pk_bf16_f32 v86, v228, v229
    v_cvt_pk_bf16_f32 v87, v230, v231
    v_pk_mul_f32 v[184:185], v[184:185], v[130:131] op_sel_hi:[1,0]
    v_pk_mul_f32 v[186:187], v[186:187], v[130:131] op_sel_hi:[1,0]
    v_pk_mul_f32 v[232:233], v[232:233], v[134:135] op_sel_hi:[1,0]
    v_pk_mul_f32 v[234:235], v[234:235], v[134:135] op_sel_hi:[1,0]
    v_cvt_pk_bf16_f32 v88, v184, v185
    v_cvt_pk_bf16_f32 v89, v186, v187
    v_cvt_pk_bf16_f32 v90, v232, v233
    v_cvt_pk_bf16_f32 v91, v234, v235
    v_pk_mul_f32 v[188:189], v[188:189], v[130:131] op_sel_hi:[1,0]
    v_pk_mul_f32 v[190:191], v[190:191], v[130:131] op_sel_hi:[1,0]
    v_pk_mul_f32 v[236:237], v[236:237], v[134:135] op_sel_hi:[1,0]
    v_pk_mul_f32 v[238:239], v[238:239], v[134:135] op_sel_hi:[1,0]
    v_cvt_pk_bf16_f32 v92, v188, v189
    v_cvt_pk_bf16_f32 v93, v190, v191
    v_cvt_pk_bf16_f32 v94, v236, v237
    v_cvt_pk_bf16_f32 v95, v238, v239
    v_pk_mul_f32 v[64:65], v[64:65], v[138:139] op_sel_hi:[1,0]
    v_pk_mul_f32 v[66:67], v[66:67], v[138:139] op_sel_hi:[1,0]
    v_pk_mul_f32 v[68:69], v[68:69], v[142:143] op_sel_hi:[1,0]
    v_pk_mul_f32 v[70:71], v[70:71], v[142:143] op_sel_hi:[1,0]
    v_pk_mul_f32 v[72:73], v[72:73], v[138:139] op_sel_hi:[1,0]
    v_pk_mul_f32 v[74:75], v[74:75], v[138:139] op_sel_hi:[1,0]
    v_pk_mul_f32 v[76:77], v[76:77], v[142:143] op_sel_hi:[1,0]
    v_pk_mul_f32 v[78:79], v[78:79], v[142:143] op_sel_hi:[1,0]
    v_pk_mul_f32 v[192:193], v[192:193], v[130:131] op_sel_hi:[1,0]
    v_pk_mul_f32 v[194:195], v[194:195], v[130:131] op_sel_hi:[1,0]
    v_pk_mul_f32 v[240:241], v[240:241], v[134:135] op_sel_hi:[1,0]
    v_pk_mul_f32 v[242:243], v[242:243], v[134:135] op_sel_hi:[1,0]
    v_pk_mul_f32 v[196:197], v[196:197], v[130:131] op_sel_hi:[1,0]
    v_pk_mul_f32 v[198:199], v[198:199], v[130:131] op_sel_hi:[1,0]
    v_pk_mul_f32 v[244:245], v[244:245], v[134:135] op_sel_hi:[1,0]
    v_pk_mul_f32 v[246:247], v[246:247], v[134:135] op_sel_hi:[1,0]
    v_pk_mul_f32 v[200:201], v[200:201], v[130:131] op_sel_hi:[1,0]
    v_pk_mul_f32 v[202:203], v[202:203], v[130:131] op_sel_hi:[1,0]
    v_pk_mul_f32 v[248:249], v[248:249], v[134:135] op_sel_hi:[1,0]
    v_pk_mul_f32 v[250:251], v[250:251], v[134:135] op_sel_hi:[1,0]
    v_pk_mul_f32 v[204:205], v[204:205], v[130:131] op_sel_hi:[1,0]
    v_pk_mul_f32 v[206:207], v[206:207], v[130:131] op_sel_hi:[1,0]
    v_pk_mul_f32 v[252:253], v[252:253], v[134:135] op_sel_hi:[1,0]
    v_pk_mul_f32 v[254:255], v[254:255], v[134:135] op_sel_hi:[1,0]
    ds_write2st64_b64 v96, v[80:81], v[82:83] offset0:0 offset1:4
    ds_write2st64_b64 v97, v[84:85], v[86:87] offset0:0 offset1:4
    ds_write2st64_b64 v98, v[88:89], v[90:91] offset0:0 offset1:4
    ds_write2st64_b64 v99, v[92:93], v[94:95] offset0:0 offset1:4
    ds_read_b128 v[144:147], v14 offset:0
    ds_read_b128 v[148:151], v14 offset:1024
    ds_read_b128 v[152:155], v14 offset:2048
    ds_read_b128 v[156:159], v14 offset:3072
    v_cvt_pk_bf16_f32 v80, v64, v65
    v_cvt_pk_bf16_f32 v81, v66, v67
    v_cvt_pk_bf16_f32 v82, v68, v69
    v_cvt_pk_bf16_f32 v83, v70, v71
    v_cvt_pk_bf16_f32 v84, v72, v73
    v_cvt_pk_bf16_f32 v85, v74, v75
    v_cvt_pk_bf16_f32 v86, v76, v77
    v_cvt_pk_bf16_f32 v87, v78, v79
    v_accvgpr_read_b32 v64, a24
    v_accvgpr_read_b32 v65, a25
    v_accvgpr_read_b32 v66, a26
    v_accvgpr_read_b32 v67, a27
    v_accvgpr_read_b32 v68, a72
    v_accvgpr_read_b32 v69, a73
    v_accvgpr_read_b32 v70, a74
    v_accvgpr_read_b32 v71, a75
    v_pk_mul_f32 v[64:65], v[64:65], v[138:139] op_sel_hi:[1,0]
    v_pk_mul_f32 v[66:67], v[66:67], v[138:139] op_sel_hi:[1,0]
    v_pk_mul_f32 v[68:69], v[68:69], v[142:143] op_sel_hi:[1,0]
    v_pk_mul_f32 v[70:71], v[70:71], v[142:143] op_sel_hi:[1,0]
    v_accvgpr_read_b32 v72, a28
    v_accvgpr_read_b32 v73, a29
    v_accvgpr_read_b32 v74, a30
    v_accvgpr_read_b32 v75, a31
    v_accvgpr_read_b32 v76, a76
    v_accvgpr_read_b32 v77, a77
    v_accvgpr_read_b32 v78, a78
    v_accvgpr_read_b32 v79, a79
    v_cvt_pk_bf16_f32 v88, v64, v65
    v_cvt_pk_bf16_f32 v89, v66, v67
    v_cvt_pk_bf16_f32 v90, v68, v69
    v_cvt_pk_bf16_f32 v91, v70, v71
    v_pk_mul_f32 v[72:73], v[72:73], v[138:139] op_sel_hi:[1,0]
    v_pk_mul_f32 v[74:75], v[74:75], v[138:139] op_sel_hi:[1,0]
    v_pk_mul_f32 v[76:77], v[76:77], v[142:143] op_sel_hi:[1,0]
    v_pk_mul_f32 v[78:79], v[78:79], v[142:143] op_sel_hi:[1,0]
    v_cvt_pk_bf16_f32 v92, v72, v73
    v_cvt_pk_bf16_f32 v93, v74, v75
    v_cvt_pk_bf16_f32 v94, v76, v77
    v_cvt_pk_bf16_f32 v95, v78, v79
    v_accvgpr_read_b32 v64, a32
    v_accvgpr_read_b32 v65, a33
    v_accvgpr_read_b32 v66, a34
    v_accvgpr_read_b32 v67, a35
    v_accvgpr_read_b32 v68, a80
    v_accvgpr_read_b32 v69, a81
    v_accvgpr_read_b32 v70, a82
    v_accvgpr_read_b32 v71, a83
    v_pk_mul_f32 v[64:65], v[64:65], v[138:139] op_sel_hi:[1,0]
    v_pk_mul_f32 v[66:67], v[66:67], v[138:139] op_sel_hi:[1,0]
    v_pk_mul_f32 v[68:69], v[68:69], v[142:143] op_sel_hi:[1,0]
    v_pk_mul_f32 v[70:71], v[70:71], v[142:143] op_sel_hi:[1,0]
    v_accvgpr_read_b32 v72, a36
    v_accvgpr_read_b32 v73, a37
    v_accvgpr_read_b32 v74, a38
    v_accvgpr_read_b32 v75, a39
    v_accvgpr_read_b32 v76, a84
    v_accvgpr_read_b32 v77, a85
    v_accvgpr_read_b32 v78, a86
    v_accvgpr_read_b32 v79, a87
    v_pk_mul_f32 v[72:73], v[72:73], v[138:139] op_sel_hi:[1,0]
    v_pk_mul_f32 v[74:75], v[74:75], v[138:139] op_sel_hi:[1,0]
    v_pk_mul_f32 v[76:77], v[76:77], v[142:143] op_sel_hi:[1,0]
    v_pk_mul_f32 v[78:79], v[78:79], v[142:143] op_sel_hi:[1,0]
    ds_write2st64_b64 v96, v[80:81], v[82:83] offset0:0 offset1:4
    s_waitcnt lgkmcnt(1)
    buffer_store_dwordx4 v[144:147], v13, s[16:19], s84 offen offset:128 nt
    ds_write2st64_b64 v97, v[84:85], v[86:87] offset0:0 offset1:4
    ds_write2st64_b64 v98, v[88:89], v[90:91] offset0:0 offset1:4
    ds_write2st64_b64 v99, v[92:93], v[94:95] offset0:0 offset1:4
    buffer_store_dwordx4 v[148:151], v13, s[16:19], s84 offen offset:3200 nt
    ds_read_b128 v[144:147], v14 offset:0
    ds_read_b128 v[148:151], v14 offset:1024
    v_cvt_pk_bf16_f32 v80, v192, v193
    v_cvt_pk_bf16_f32 v81, v194, v195
    v_cvt_pk_bf16_f32 v82, v240, v241
    v_cvt_pk_bf16_f32 v83, v242, v243
    v_cvt_pk_bf16_f32 v84, v196, v197
    v_cvt_pk_bf16_f32 v85, v198, v199
    v_cvt_pk_bf16_f32 v86, v244, v245
    v_cvt_pk_bf16_f32 v87, v246, v247
    v_cvt_pk_bf16_f32 v88, v200, v201
    v_cvt_pk_bf16_f32 v89, v202, v203
    v_cvt_pk_bf16_f32 v90, v248, v249
    v_cvt_pk_bf16_f32 v91, v250, v251
    v_cvt_pk_bf16_f32 v92, v204, v205
    v_cvt_pk_bf16_f32 v93, v206, v207
    v_cvt_pk_bf16_f32 v94, v252, v253
    v_cvt_pk_bf16_f32 v95, v254, v255
    buffer_store_dwordx4 v[152:155], v13, s[16:19], s85 offen offset:128 nt
    buffer_store_dwordx4 v[156:159], v13, s[16:19], s85 offen offset:3200 nt
    ds_read_b128 v[152:155], v14 offset:2048
    ds_read_b128 v[156:159], v14 offset:3072
    ds_write2st64_b64 v96, v[80:81], v[82:83] offset0:0 offset1:4
    ds_write2st64_b64 v97, v[84:85], v[86:87] offset0:0 offset1:4
    ds_write2st64_b64 v98, v[88:89], v[90:91] offset0:0 offset1:4
    s_waitcnt lgkmcnt(5)
    buffer_store_dwordx4 v[144:147], v13, s[16:19], s86 offen offset:128 nt
    ds_write2st64_b64 v99, v[92:93], v[94:95] offset0:0 offset1:4
    ds_read_b128 v[144:147], v14 offset:0
    v_cvt_pk_bf16_f32 v80, v64, v65
    v_cvt_pk_bf16_f32 v81, v66, v67
    v_cvt_pk_bf16_f32 v82, v68, v69
    v_cvt_pk_bf16_f32 v83, v70, v71
    v_cvt_pk_bf16_f32 v84, v72, v73
    v_cvt_pk_bf16_f32 v85, v74, v75
    v_cvt_pk_bf16_f32 v86, v76, v77
    v_cvt_pk_bf16_f32 v87, v78, v79
    v_accvgpr_read_b32 v64, a40
    v_accvgpr_read_b32 v65, a41
    v_accvgpr_read_b32 v66, a42
    v_accvgpr_read_b32 v67, a43
    v_accvgpr_read_b32 v68, a88
    v_accvgpr_read_b32 v69, a89
    v_accvgpr_read_b32 v70, a90
    v_accvgpr_read_b32 v71, a91
    v_pk_mul_f32 v[64:65], v[64:65], v[138:139] op_sel_hi:[1,0]
    v_pk_mul_f32 v[66:67], v[66:67], v[138:139] op_sel_hi:[1,0]
    v_pk_mul_f32 v[68:69], v[68:69], v[142:143] op_sel_hi:[1,0]
    v_pk_mul_f32 v[70:71], v[70:71], v[142:143] op_sel_hi:[1,0]
    v_accvgpr_read_b32 v72, a44
    v_accvgpr_read_b32 v73, a45
    v_accvgpr_read_b32 v74, a46
    v_accvgpr_read_b32 v75, a47
    v_accvgpr_read_b32 v76, a92
    v_accvgpr_read_b32 v77, a93
    v_accvgpr_read_b32 v78, a94
    v_accvgpr_read_b32 v79, a95
    v_cvt_pk_bf16_f32 v88, v64, v65
    v_cvt_pk_bf16_f32 v89, v66, v67
    v_cvt_pk_bf16_f32 v90, v68, v69
    v_cvt_pk_bf16_f32 v91, v70, v71
    v_pk_mul_f32 v[72:73], v[72:73], v[138:139] op_sel_hi:[1,0]
    v_pk_mul_f32 v[74:75], v[74:75], v[138:139] op_sel_hi:[1,0]
    v_pk_mul_f32 v[76:77], v[76:77], v[142:143] op_sel_hi:[1,0]
    v_pk_mul_f32 v[78:79], v[78:79], v[142:143] op_sel_hi:[1,0]
    v_cvt_pk_bf16_f32 v92, v72, v73
    v_cvt_pk_bf16_f32 v93, v74, v75
    v_cvt_pk_bf16_f32 v94, v76, v77
    v_cvt_pk_bf16_f32 v95, v78, v79
    buffer_store_dwordx4 v[148:151], v13, s[16:19], s86 offen offset:3200 nt
    s_waitcnt lgkmcnt(0)
    buffer_store_dwordx4 v[152:155], v13, s[16:19], s87 offen offset:128 nt
    ds_read_b128 v[148:151], v14 offset:1024
    ds_read_b128 v[152:155], v14 offset:2048
    buffer_store_dwordx4 v[156:159], v13, s[16:19], s87 offen offset:3200 nt
    buffer_store_dwordx4 v[144:147], v13, s[16:19], s84 offen offset:256 nt
    ds_read_b128 v[156:159], v14 offset:3072
    ds_write2st64_b64 v96, v[80:81], v[82:83] offset0:0 offset1:4
    ds_write2st64_b64 v97, v[84:85], v[86:87] offset0:0 offset1:4
    ds_write2st64_b64 v98, v[88:89], v[90:91] offset0:0 offset1:4
    s_waitcnt lgkmcnt(4)
    buffer_store_dwordx4 v[148:151], v13, s[16:19], s84 offen offset:3328 nt
    ds_write2st64_b64 v99, v[92:93], v[94:95] offset0:0 offset1:4
    ds_read_b128 v[144:147], v14 offset:0
    ds_read_b128 v[148:151], v14 offset:1024
    buffer_store_dwordx4 v[152:155], v13, s[16:19], s85 offen offset:256 nt
    s_waitcnt lgkmcnt(4)
    buffer_store_dwordx4 v[156:159], v13, s[16:19], s85 offen offset:3328 nt
    ds_read_b128 v[152:155], v14 offset:2048
    ds_read_b128 v[156:159], v14 offset:3072
    s_waitcnt lgkmcnt(2)
    buffer_store_dwordx4 v[144:147], v13, s[16:19], s86 offen offset:256 nt
    buffer_store_dwordx4 v[148:151], v13, s[16:19], s86 offen offset:3328 nt
    s_waitcnt lgkmcnt(0)
    buffer_store_dwordx4 v[152:155], v13, s[16:19], s87 offen offset:256 nt
    buffer_store_dwordx4 v[156:159], v13, s[16:19], s87 offen offset:3328 nt
    s_mov_b32 s42, s41
    ds_read_b128 a[192:195], v1 offset:24576
    ds_read_b128 a[196:199], v2 offset:24576
    ds_read_b128 a[200:203], v1 offset:25600
    ds_read_b128 a[204:207], v2 offset:25600
    ds_read_b128 a[208:211], v1 offset:26624
    ds_read_b128 a[212:215], v2 offset:26624
    ds_read_b128 a[216:219], v1 offset:30720
    ds_read_b128 a[220:223], v2 offset:30720
    ds_read_b128 a[224:227], v1 offset:31744
    ds_read_b128 a[228:231], v2 offset:31744
    ds_read_b128 a[232:235], v1 offset:32768
    ds_read_b128 a[236:239], v2 offset:32768
    v_max3_f32 v152, v32, v33, v34
    v_max3_f32 v152, v152, v35, v36
    v_max3_f32 v152, v152, v37, v38
    v_max_f32 v152, v152, v39
    v_max3_f32 v154, v40, v41, v42
    v_mov_b32 v153, v152
    v_max3_f32 v154, v154, v43, v44
    v_max3_f32 v154, v154, v45, v46
    v_permlane32_swap_b32 v153, v152
    v_max_f32 v152, v152, v153
    v_max_f32 v154, v154, v47
    v_mov_b32 v153, v152
    v_mov_b32 v155, v154
    v_add_u32 v1, s57, v1
    v_permlane16_swap_b32 v153, v152
    v_permlane32_swap_b32 v155, v154
    v_max_f32 v152, v152, v153
    v_max_f32 v154, v154, v155
    v_mul_f32_e64 v16, -s36, v152
    v_mov_b32 v155, v154
    s_waitcnt lgkmcnt(11)
    v_mfma_f32_16x16x32_bf16 v[64:67], a[192:195], a[96:99], 0
    s_add_u32 s69, s69, 1
    v_permlane16_swap_b32 v155, v154
    s_waitcnt lgkmcnt(6)
    v_mfma_f32_16x16x32_bf16 v[64:67], a[196:199], a[100:103], v[64:67]
    s_add_u32 s48, s48, 325632
    v_max3_f32 v152, v48, v49, v50
    v_max_f32 v154, v154, v155
    v_mfma_f32_16x16x32_bf16 v[64:67], a[200:203], a[104:107], v[64:67]
    s_lshr_b32 s62, s39, s69
    v_max3_f32 v152, v152, v51, v52
    v_mul_f32_e64 v17, -s36, v154
    v_mfma_f32_16x16x32_bf16 v[64:67], a[204:207], a[108:111], v[64:67]
    s_and_b32 s62, s62, 1
    v_max3_f32 v152, v152, v53, v54
    v_max_f32 v152, v152, v55
    v_mfma_f32_16x16x32_bf16 v[64:67], a[208:211], a[112:115], v[64:67]
    s_lshl_b32 s62, s62, 1
    v_fma_f32 v32, v32, s36, v16
    v_fma_f32 v33, v33, s36, v16
    v_mfma_f32_16x16x32_bf16 v[64:67], a[212:215], a[116:119], v[64:67]
    s_add_u32 s62, s62, s49
    v_fma_f32 v34, v34, s36, v16
    v_fma_f32 v35, v35, s36, v16
    v_mfma_f32_16x16x32_bf16 v[72:75], a[192:195], a[120:123], 0
    s_and_b32 s62, s62, 3
    v_fma_f32 v40, v40, s36, v17
    v_fma_f32 v41, v41, s36, v17
    v_mfma_f32_16x16x32_bf16 v[72:75], a[196:199], a[124:127], v[72:75]
    s_add_u32 s63, s69, 8
    v_fma_f32 v36, v36, s36, v16
    v_fma_f32 v37, v37, s36, v16
    v_mfma_f32_16x16x32_bf16 v[72:75], a[200:203], a[128:131], v[72:75]
    s_lshr_b32 s63, s39, s63
    v_mov_b32 v153, v152
    v_max3_f32 v154, v56, v57, v58
    v_mfma_f32_16x16x32_bf16 v[72:75], a[204:207], a[132:135], v[72:75]
    s_and_b32 s63, s63, 1
    v_exp_f32 v144, v32
    v_mfma_f32_16x16x32_bf16 v[72:75], a[208:211], a[136:139], v[72:75]
    s_xor_b32 s62, s62, s63
    v_exp_f32 v145, v33
    v_mfma_f32_16x16x32_bf16 v[72:75], a[212:215], a[140:143], v[72:75]
    s_mul_i32 s63, s3, 3
    v_exp_f32 v146, v34
    v_mfma_f32_16x16x32_bf16 v[80:83], a[192:195], a[144:147], 0
    s_lshl_b32 s64, s3, 2
    v_exp_f32 v147, v35
    v_mfma_f32_16x16x32_bf16 v[80:83], a[196:199], a[148:151], v[80:83]
    s_mov_b32 s40, 1
    v_exp_f32 v148, v40
    v_mfma_f32_16x16x32_bf16 v[80:83], a[200:203], a[152:155], v[80:83]
    s_add_u32 s65, s63, 17
    v_exp_f32 v149, v41
    v_mfma_f32_16x16x32_bf16 v[80:83], a[204:207], a[156:159], v[80:83]
    s_cmp_eq_u32 s3, 0
    v_exp_f32 v150, v36
    v_mfma_f32_16x16x32_bf16 v[80:83], a[208:211], a[160:163], v[80:83]
    s_cselect_b32 s65, 16, s65
    v_exp_f32 v151, v37
    v_mfma_f32_16x16x32_bf16 v[80:83], a[212:215], a[164:167], v[80:83]
    s_cselect_b32 s41, 1, 0
    v_permlane32_swap_b32 v153, v152
    v_mfma_f32_16x16x32_bf16 v[88:91], a[192:195], a[168:171], 0
    s_cmp_eq_u32 s62, 1
    v_max3_f32 v154, v154, v59, v60
    v_max_f32 v152, v152, v153
    v_mfma_f32_16x16x32_bf16 v[88:91], a[196:199], a[172:175], v[88:91]
    s_cselect_b32 s64, s65, s64
    v_max3_f32 v154, v154, v61, v62
    v_mov_b32 v153, v152
    v_mfma_f32_16x16x32_bf16 v[88:91], a[200:203], a[176:179], v[88:91]
    s_cselect_b32 s40, s41, s40
    v_max_f32 v154, v154, v63
    v_cvt_pk_bf16_f32 v96, v144, v145
    v_mfma_f32_16x16x32_bf16 v[88:91], a[204:207], a[180:183], v[88:91]
    s_add_u32 s65, s63, 29
    v_cvt_pk_bf16_f32 v97, v146, v147
    v_cvt_pk_bf16_f32 v100, v148, v149
    v_mfma_f32_16x16x32_bf16 v[88:91], a[208:211], a[184:187], v[88:91]
    s_cmp_eq_u32 s62, 2
    v_cvt_pk_bf16_f32 v98, v150, v151
    v_fma_f32 v38, v38, s36, v16
    v_mfma_f32_16x16x32_bf16 v[88:91], a[212:215], a[188:191], v[88:91]
    s_cselect_b32 s64, s65, s64
    v_fma_f32 v39, v39, s36, v16
    v_fma_f32 v42, v42, s36, v17
    s_waitcnt lgkmcnt(0)
    v_mfma_f32_16x16x32_bf16 v[68:71], a[216:219], a[96:99], 0
    s_cselect_b32 s40, 0, s40
    v_fma_f32 v43, v43, s36, v17
    v_fma_f32 v44, v44, s36, v17
    v_mfma_f32_16x16x32_bf16 v[68:71], a[220:223], a[100:103], v[68:71]
    s_add_u32 s65, s63, 41
    v_fma_f32 v45, v45, s36, v17
    v_fma_f32 v46, v46, s36, v17
    v_mfma_f32_16x16x32_bf16 v[68:71], a[224:227], a[104:107], v[68:71]
    s_cmp_eq_u32 s62, 3
    v_fma_f32 v47, v47, s36, v17
    v_mov_b32 v155, v154
    v_mfma_f32_16x16x32_bf16 v[68:71], a[228:231], a[108:111], v[68:71]
    s_cselect_b32 s64, s65, s64
    v_permlane16_swap_b32 v153, v152
    v_mfma_f32_16x16x32_bf16 v[68:71], a[232:235], a[112:115], v[68:71]
    s_cselect_b32 s40, 0, s40
    v_exp_f32 v144, v38
    v_mfma_f32_16x16x32_bf16 v[68:71], a[236:239], a[116:119], v[68:71]
    s_mul_i32 s64, s64, 6144
    v_exp_f32 v145, v39
    v_mfma_f32_16x16x32_bf16 v[76:79], a[216:219], a[120:123], 0
    s_add_u32 s41, s48, s64
    v_exp_f32 v146, v42
    v_mfma_f32_16x16x32_bf16 v[76:79], a[220:223], a[124:127], v[76:79]
    s_cmp_ge_u32 s69, 8
    v_exp_f32 v147, v43
    v_mfma_f32_16x16x32_bf16 v[76:79], a[224:227], a[128:131], v[76:79]
    s_cselect_b32 s41, 166725632, s41
    v_exp_f32 v148, v44
    v_mfma_f32_16x16x32_bf16 v[76:79], a[228:231], a[132:135], v[76:79]
    s_add_u32 m0, s33, s31
    v_exp_f32 v149, v45
    v_mfma_f32_16x16x32_bf16 v[76:79], a[232:235], a[136:139], v[76:79]
    buffer_load_dwordx4 v7, s[20:23], s28 offen offset:0 lds
    v_mfma_f32_16x16x32_bf16 v[76:79], a[236:239], a[140:143], v[76:79]
    buffer_load_dwordx4 v8, s[20:23], s28 offen offset:1024 lds
    v_mfma_f32_16x16x32_bf16 v[84:87], a[216:219], a[144:147], 0
    buffer_load_dwordx4 v9, s[20:23], s28 offen offset:2048 lds
    v_mfma_f32_16x16x32_bf16 v[84:87], a[220:223], a[148:151], v[84:87]
    s_add_u32 m0, s33, s32
    v_exp_f32 v150, v46
    v_mfma_f32_16x16x32_bf16 v[84:87], a[224:227], a[152:155], v[84:87]
    buffer_load_dwordx4 v10, s[24:27], s29 offen offset:0 lds
    v_mfma_f32_16x16x32_bf16 v[84:87], a[228:231], a[156:159], v[84:87]
    buffer_load_dwordx4 v11, s[24:27], s29 offen offset:1024 lds
    v_mfma_f32_16x16x32_bf16 v[84:87], a[232:235], a[160:163], v[84:87]
    buffer_load_dwordx4 v12, s[24:27], s29 offen offset:2048 lds
    s_add_u32 s28, s28, s30
    s_add_u32 s29, s29, s30
    v_mfma_f32_16x16x32_bf16 v[84:87], a[236:239], a[164:167], v[84:87]
    s_add_u32 s33, s33, 24576
    v_exp_f32 v151, v47
    s_cmp_eq_u32 s33, 147456
    v_mfma_f32_16x16x32_bf16 v[92:95], a[216:219], a[168:171], 0
    s_cselect_b32 s33, 0, s33
    v_max_f32 v152, v152, v153
    v_mul_f32_e64 v18, -s36, v152
    v_mfma_f32_16x16x32_bf16 v[92:95], a[220:223], a[172:175], v[92:95]
    s_add_u32 m0, s33, s31
    v_permlane32_swap_b32 v155, v154
    v_mfma_f32_16x16x32_bf16 v[92:95], a[224:227], a[176:179], v[92:95]
    buffer_load_dwordx4 v7, s[20:23], s28 offen offset:0 lds
    v_mfma_f32_16x16x32_bf16 v[92:95], a[228:231], a[180:183], v[92:95]
    buffer_load_dwordx4 v8, s[20:23], s28 offen offset:1024 lds
    v_mfma_f32_16x16x32_bf16 v[92:95], a[232:235], a[184:187], v[92:95]
    buffer_load_dwordx4 v9, s[20:23], s28 offen offset:2048 lds
    s_add_u32 m0, s33, s32
    v_mfma_f32_16x16x32_bf16 v[92:95], a[236:239], a[188:191], v[92:95]
    buffer_load_dwordx4 v10, s[24:27], s29 offen offset:0 lds
    buffer_load_dwordx4 v11, s[24:27], s29 offen offset:1024 lds
    buffer_load_dwordx4 v12, s[24:27], s29 offen offset:2048 lds
    s_add_u32 s28, s28, s30
    v_max_f32 v154, v154, v155
    v_mov_b32 v155, v154
    v_cvt_pk_bf16_f32 v99, v144, v145
    v_cvt_pk_bf16_f32 v101, v146, v147
    v_cvt_pk_bf16_f32 v102, v148, v149
    v_mfma_f32_16x16x32_bf16 v[128:131], v[24:27], v[96:99], 0
    v_cvt_pk_bf16_f32 v103, v150, v151
    v_fma_f32 v48, v48, s36, v18
    v_fma_f32 v49, v49, s36, v18
    v_mfma_f32_16x16x32_bf16 v[132:135], v[24:27], v[100:103], 0
    v_fma_f32 v50, v50, s36, v18
    v_fma_f32 v51, v51, s36, v18
    v_fma_f32 v52, v52, s36, v18
    v_fma_f32 v53, v53, s36, v18
    v_fma_f32 v54, v54, s36, v18
    v_fma_f32 v55, v55, s36, v18
    v_permlane16_swap_b32 v155, v154
    v_exp_f32 v144, v48
    v_exp_f32 v145, v49
    v_exp_f32 v146, v50
    v_exp_f32 v147, v51
    v_exp_f32 v148, v52
    v_exp_f32 v149, v53
    v_exp_f32 v150, v54
    v_exp_f32 v151, v55
    v_max_f32 v154, v154, v155
    v_mul_f32_e64 v19, -s36, v154
    v_cvt_pk_bf16_f32 v104, v144, v145
    v_cvt_pk_bf16_f32 v105, v146, v147
    v_cvt_pk_bf16_f32 v106, v148, v149
    v_cvt_pk_bf16_f32 v107, v150, v151
    v_fma_f32 v56, v56, s36, v19
    v_fma_f32 v57, v57, s36, v19
    v_mfma_f32_16x16x32_bf16 v[136:139], v[24:27], v[104:107], 0
    v_fma_f32 v58, v58, s36, v19
    v_fma_f32 v59, v59, s36, v19
    v_fma_f32 v60, v60, s36, v19
    v_fma_f32 v61, v61, s36, v19
    v_fma_f32 v62, v62, s36, v19
    v_fma_f32 v63, v63, s36, v19
    v_exp_f32 v144, v56
    v_exp_f32 v145, v57
    v_exp_f32 v146, v58
    v_exp_f32 v147, v59
    v_exp_f32 v148, v60
    v_exp_f32 v149, v61
    v_exp_f32 v150, v62
    v_exp_f32 v151, v63
    v_cvt_pk_bf16_f32 v108, v144, v145
    v_cvt_pk_bf16_f32 v109, v146, v147
    v_cvt_pk_bf16_f32 v110, v148, v149
    v_cvt_pk_bf16_f32 v111, v150, v151
    v_fma_f32 v64, v64, s36, v16
    v_fma_f32 v65, v65, s36, v16
    v_mfma_f32_16x16x32_bf16 v[140:143], v[24:27], v[108:111], 0
    v_fma_f32 v66, v66, s36, v16
    v_fma_f32 v67, v67, s36, v16
    v_fma_f32 v72, v72, s36, v17
    v_fma_f32 v73, v73, s36, v17
    s_add_u32 s29, s29, s30
    v_exp_f32 v144, v64
    v_exp_f32 v145, v65
    v_exp_f32 v146, v66
    v_exp_f32 v147, v67
    v_exp_f32 v148, v72
    v_exp_f32 v149, v73
    s_add_u32 s33, s33, 24576
    s_cmp_eq_u32 s33, 147456
    s_waitcnt vmcnt(42)
    s_barrier
    s_cselect_b32 s33, 0, s33
    v_cvt_pk_bf16_f32 v112, v144, v145
    v_cvt_pk_bf16_f32 v113, v146, v147
    v_cvt_pk_bf16_f32 v116, v148, v149
    v_add_u32 v2, s57, v2
    ds_read_b64_tr_b16 a[240:241], v3 offset:0
    ds_read_b64_tr_b16 a[242:243], v3 offset:6144
    ds_read_b64_tr_b16 a[244:245], v4 offset:0
    ds_read_b64_tr_b16 a[246:247], v4 offset:6144
    ds_read_b64_tr_b16 a[248:249], v5 offset:0
    ds_read_b64_tr_b16 a[250:251], v5 offset:6144
    ds_read_b64_tr_b16 a[252:253], v6 offset:0
    ds_read_b64_tr_b16 a[254:255], v6 offset:6144
    s_waitcnt lgkmcnt(6)
    v_mfma_f32_16x16x32_bf16 v[160:163], a[240:243], v[96:99], 0
    s_add_u32 m0, s33, s31
    ds_read_b128 a[192:195], v1 offset:0
    ds_read_b128 a[196:199], v2 offset:0
    v_mfma_f32_16x16x32_bf16 v[208:211], a[240:243], v[100:103], 0
    ds_read_b128 a[200:203], v1 offset:1024
    ds_read_b128 a[204:207], v2 offset:1024
    v_mfma_f32_16x16x32_bf16 a[0:3], a[240:243], v[104:107], 0
    ds_read_b128 a[208:211], v1 offset:2048
    ds_read_b128 a[212:215], v2 offset:2048
    v_mfma_f32_16x16x32_bf16 a[48:51], a[240:243], v[108:111], 0
    buffer_load_dwordx4 v7, s[20:23], s28 offen offset:0 lds
    s_waitcnt lgkmcnt(10)
    v_mfma_f32_16x16x32_bf16 v[164:167], a[244:247], v[96:99], 0
    ds_read_b64_tr_b16 a[240:241], v3 offset:1024
    ds_read_b64_tr_b16 a[242:243], v3 offset:7168
    v_mfma_f32_16x16x32_bf16 v[212:215], a[244:247], v[100:103], 0
    ds_read_b128 a[216:219], v1 offset:6144
    ds_read_b128 a[220:223], v2 offset:6144
    v_mfma_f32_16x16x32_bf16 a[4:7], a[244:247], v[104:107], 0
    ds_read_b128 a[224:227], v1 offset:7168
    ds_read_b128 a[228:231], v2 offset:7168
    v_mfma_f32_16x16x32_bf16 a[52:55], a[244:247], v[108:111], 0
    s_waitcnt lgkmcnt(12)
    ds_read_b64_tr_b16 a[244:245], v4 offset:1024
    ds_read_b64_tr_b16 a[246:247], v4 offset:7168
    v_mfma_f32_16x16x32_bf16 v[168:171], a[248:251], v[96:99], 0
    ds_read_b128 a[232:235], v1 offset:8192
    ds_read_b128 a[236:239], v2 offset:8192
    v_mfma_f32_16x16x32_bf16 v[216:219], a[248:251], v[100:103], 0
    v_fma_f32 v68, v68, s36, v16
    v_fma_f32 v69, v69, s36, v16
    v_mfma_f32_16x16x32_bf16 a[8:11], a[248:251], v[104:107], 0
    v_exp_f32 v150, v68
    v_mfma_f32_16x16x32_bf16 a[56:59], a[248:251], v[108:111], 0
    ds_read_b64_tr_b16 a[248:249], v5 offset:1024
    ds_read_b64_tr_b16 a[250:251], v5 offset:7168
    v_mfma_f32_16x16x32_bf16 v[172:175], a[252:255], v[96:99], 0
    v_exp_f32 v151, v69
    v_mfma_f32_16x16x32_bf16 v[220:223], a[252:255], v[100:103], 0
    v_cvt_pk_bf16_f32 v114, v150, v151
    v_fma_f32 v70, v70, s36, v16
    v_mfma_f32_16x16x32_bf16 a[12:15], a[252:255], v[104:107], 0
    v_fma_f32 v71, v71, s36, v16
    v_fma_f32 v74, v74, s36, v17
    v_mfma_f32_16x16x32_bf16 a[60:63], a[252:255], v[108:111], 0
    buffer_load_dwordx4 v8, s[20:23], s28 offen offset:1024 lds
    s_waitcnt lgkmcnt(4)
    v_mfma_f32_16x16x32_bf16 v[176:179], a[240:243], v[96:99], 0
    ds_read_b64_tr_b16 a[252:253], v6 offset:1024
    ds_read_b64_tr_b16 a[254:255], v6 offset:7168
    v_mfma_f32_16x16x32_bf16 v[224:227], a[240:243], v[100:103], 0
    v_fma_f32 v75, v75, s36, v17
    v_fma_f32 v76, v76, s36, v17
    v_mfma_f32_16x16x32_bf16 a[16:19], a[240:243], v[104:107], 0
    v_fma_f32 v77, v77, s36, v17
    v_fma_f32 v78, v78, s36, v17
    v_mfma_f32_16x16x32_bf16 a[64:67], a[240:243], v[108:111], 0
    ds_read_b64_tr_b16 a[240:241], v3 offset:2048
    ds_read_b64_tr_b16 a[242:243], v3 offset:8192
    v_mfma_f32_16x16x32_bf16 v[180:183], a[244:247], v[96:99], 0
    v_fma_f32 v79, v79, s36, v17
    v_fma_f32 v80, v80, s36, v18
    v_mfma_f32_16x16x32_bf16 v[228:231], a[244:247], v[100:103], 0
    v_exp_f32 v144, v70
    v_mfma_f32_16x16x32_bf16 a[20:23], a[244:247], v[104:107], 0
    v_exp_f32 v145, v71
    v_mfma_f32_16x16x32_bf16 a[68:71], a[244:247], v[108:111], 0
    s_waitcnt lgkmcnt(4)
    ds_read_b64_tr_b16 a[244:245], v4 offset:2048
    ds_read_b64_tr_b16 a[246:247], v4 offset:8192
    v_mfma_f32_16x16x32_bf16 v[184:187], a[248:251], v[96:99], 0
    v_exp_f32 v146, v74
    v_mfma_f32_16x16x32_bf16 v[232:235], a[248:251], v[100:103], 0
    v_exp_f32 v147, v75
    v_mfma_f32_16x16x32_bf16 a[24:27], a[248:251], v[104:107], 0
    v_exp_f32 v148, v76
    v_mfma_f32_16x16x32_bf16 a[72:75], a[248:251], v[108:111], 0
    s_waitcnt lgkmcnt(3)
    ds_read_b64_tr_b16 a[248:249], v5 offset:2048
    ds_read_b64_tr_b16 a[250:251], v5 offset:8192
    v_mfma_f32_16x16x32_bf16 v[188:191], a[252:255], v[96:99], 0
    buffer_load_dwordx4 v9, s[20:23], s28 offen offset:2048 lds
    v_mfma_f32_16x16x32_bf16 v[236:239], a[252:255], v[100:103], 0
    s_add_u32 m0, s33, s32
    v_exp_f32 v149, v77
    v_mfma_f32_16x16x32_bf16 a[28:31], a[252:255], v[104:107], 0
    v_exp_f32 v150, v78
    v_mfma_f32_16x16x32_bf16 a[76:79], a[252:255], v[108:111], 0
    s_waitcnt lgkmcnt(2)
    ds_read_b64_tr_b16 a[252:253], v6 offset:2048
    ds_read_b64_tr_b16 a[254:255], v6 offset:8192
    v_mfma_f32_16x16x32_bf16 v[192:195], a[240:243], v[96:99], 0
    v_exp_f32 v151, v79
    v_mfma_f32_16x16x32_bf16 v[240:243], a[240:243], v[100:103], 0
    v_cvt_pk_bf16_f32 v115, v144, v145
    v_cvt_pk_bf16_f32 v117, v146, v147
    v_mfma_f32_16x16x32_bf16 a[32:35], a[240:243], v[104:107], 0
    v_cvt_pk_bf16_f32 v118, v148, v149
    v_cvt_pk_bf16_f32 v119, v150, v151
    v_mfma_f32_16x16x32_bf16 a[80:83], a[240:243], v[108:111], 0
    v_fma_f32 v81, v81, s36, v18
    v_fma_f32 v82, v82, s36, v18
    v_mfma_f32_16x16x32_bf16 v[196:199], a[244:247], v[96:99], 0
    v_fma_f32 v83, v83, s36, v18
    v_fma_f32 v84, v84, s36, v18
    v_mfma_f32_16x16x32_bf16 v[244:247], a[244:247], v[100:103], 0
    v_fma_f32 v85, v85, s36, v18
    v_fma_f32 v86, v86, s36, v18
    v_mfma_f32_16x16x32_bf16 a[36:39], a[244:247], v[104:107], 0
    v_fma_f32 v87, v87, s36, v18
    v_fma_f32 v88, v88, s36, v19
    v_mfma_f32_16x16x32_bf16 a[84:87], a[244:247], v[108:111], 0
    s_waitcnt lgkmcnt(1)
    v_exp_f32 v144, v80
    v_mfma_f32_16x16x32_bf16 v[200:203], a[248:251], v[96:99], 0
    buffer_load_dwordx4 v10, s[24:27], s29 offen offset:0 lds
    v_mfma_f32_16x16x32_bf16 v[248:251], a[248:251], v[100:103], 0
    v_exp_f32 v145, v81
    v_mfma_f32_16x16x32_bf16 a[40:43], a[248:251], v[104:107], 0
    v_exp_f32 v146, v82
    v_mfma_f32_16x16x32_bf16 a[88:91], a[248:251], v[108:111], 0
    s_waitcnt lgkmcnt(0)
    v_exp_f32 v147, v83
    v_mfma_f32_16x16x32_bf16 v[204:207], a[252:255], v[96:99], 0
    v_exp_f32 v148, v84
    v_mfma_f32_16x16x32_bf16 v[252:255], a[252:255], v[100:103], 0
    v_exp_f32 v149, v85
    v_mfma_f32_16x16x32_bf16 a[44:47], a[252:255], v[104:107], 0
    v_exp_f32 v150, v86
    v_mfma_f32_16x16x32_bf16 a[92:95], a[252:255], v[108:111], 0
    v_exp_f32 v151, v87
    v_mfma_f32_16x16x32_bf16 v[32:35], a[192:195], a[96:99], 0
    v_cvt_pk_bf16_f32 v120, v144, v145
    v_cvt_pk_bf16_f32 v121, v146, v147
    v_mfma_f32_16x16x32_bf16 v[32:35], a[196:199], a[100:103], v[32:35]
    v_cvt_pk_bf16_f32 v122, v148, v149
    v_cvt_pk_bf16_f32 v123, v150, v151
    v_mfma_f32_16x16x32_bf16 v[32:35], a[200:203], a[104:107], v[32:35]
    v_fma_f32 v89, v89, s36, v19
    v_fma_f32 v90, v90, s36, v19
    v_mfma_f32_16x16x32_bf16 v[32:35], a[204:207], a[108:111], v[32:35]
    v_fma_f32 v91, v91, s36, v19
    v_fma_f32 v92, v92, s36, v19
    v_mfma_f32_16x16x32_bf16 v[32:35], a[208:211], a[112:115], v[32:35]
    v_fma_f32 v93, v93, s36, v19
    v_fma_f32 v94, v94, s36, v19
    v_mfma_f32_16x16x32_bf16 v[32:35], a[212:215], a[116:119], v[32:35]
    buffer_load_dwordx4 v11, s[24:27], s29 offen offset:1024 lds
    v_mfma_f32_16x16x32_bf16 v[40:43], a[192:195], a[120:123], 0
    v_fma_f32 v95, v95, s36, v19
    v_mov_b32 v20, v128
    v_mfma_f32_16x16x32_bf16 v[128:131], v[24:27], v[112:115], 0
    v_exp_f32 v144, v88
    v_mfma_f32_16x16x32_bf16 v[40:43], a[196:199], a[124:127], v[40:43]
    v_exp_f32 v145, v89
    v_mfma_f32_16x16x32_bf16 v[40:43], a[200:203], a[128:131], v[40:43]
    v_exp_f32 v146, v90
    v_mfma_f32_16x16x32_bf16 v[40:43], a[204:207], a[132:135], v[40:43]
    v_exp_f32 v147, v91
    v_mfma_f32_16x16x32_bf16 v[40:43], a[208:211], a[136:139], v[40:43]
    v_exp_f32 v148, v92
    v_mfma_f32_16x16x32_bf16 v[40:43], a[212:215], a[140:143], v[40:43]
    v_exp_f32 v149, v93
    v_mfma_f32_16x16x32_bf16 v[48:51], a[192:195], a[144:147], 0
    v_exp_f32 v150, v94
    v_mfma_f32_16x16x32_bf16 v[48:51], a[196:199], a[148:151], v[48:51]
    v_exp_f32 v151, v95
    v_mfma_f32_16x16x32_bf16 v[48:51], a[200:203], a[152:155], v[48:51]
    v_cvt_pk_bf16_f32 v124, v144, v145
    v_cvt_pk_bf16_f32 v125, v146, v147
    v_mfma_f32_16x16x32_bf16 v[48:51], a[204:207], a[156:159], v[48:51]
    v_cvt_pk_bf16_f32 v126, v148, v149
    v_cvt_pk_bf16_f32 v127, v150, v151
    v_mfma_f32_16x16x32_bf16 v[48:51], a[208:211], a[160:163], v[48:51]
    buffer_load_dwordx4 v12, s[24:27], s29 offen offset:2048 lds
    v_mfma_f32_16x16x32_bf16 v[48:51], a[212:215], a[164:167], v[48:51]
    s_add_u32 s28, s28, s30
    v_mov_b32 v21, v132
    v_mov_b32 v22, v136
    v_mfma_f32_16x16x32_bf16 v[132:135], v[24:27], v[116:119], 0
    s_add_u32 s29, s29, s30
    v_mov_b32 v23, v140
    v_mfma_f32_16x16x32_bf16 v[136:139], v[24:27], v[120:123], 0
    s_add_u32 s33, s33, 24576
    v_mfma_f32_16x16x32_bf16 v[140:143], v[24:27], v[124:127], 0
    s_cmp_eq_u32 s33, 147456
    v_mfma_f32_16x16x32_bf16 v[56:59], a[192:195], a[168:171], 0
    s_cselect_b32 s33, 0, s33
    v_mfma_f32_16x16x32_bf16 v[56:59], a[196:199], a[172:175], v[56:59]
    v_mfma_f32_16x16x32_bf16 v[56:59], a[200:203], a[176:179], v[56:59]
    v_mfma_f32_16x16x32_bf16 v[56:59], a[204:207], a[180:183], v[56:59]
    v_max3_f32 v30, v128, v132, v136
    v_mfma_f32_16x16x32_bf16 v[56:59], a[208:211], a[184:187], v[56:59]
    v_max_f32 v30, v30, v140
    v_cmp_lt_f32 vcc, s37, v30
    v_mfma_f32_16x16x32_bf16 v[56:59], a[212:215], a[188:191], v[56:59]
    v_mfma_f32_16x16x32_bf16 v[36:39], a[216:219], a[96:99], 0
    v_mfma_f32_16x16x32_bf16 v[36:39], a[220:223], a[100:103], v[36:39]
    v_mfma_f32_16x16x32_bf16 v[36:39], a[224:227], a[104:107], v[36:39]
    v_mfma_f32_16x16x32_bf16 v[36:39], a[228:231], a[108:111], v[36:39]
    s_cbranch_vccnz L_rs_tr44a
L_ret_tr44a:
    v_fma_f32 v32, v32, s36, v16
    v_fma_f32 v33, v33, s36, v16
    v_mfma_f32_16x16x32_bf16 v[36:39], a[232:235], a[112:115], v[36:39]
    v_fma_f32 v34, v34, s36, v16
    v_fma_f32 v35, v35, s36, v16
    v_mfma_f32_16x16x32_bf16 v[36:39], a[236:239], a[116:119], v[36:39]
    v_fma_f32 v40, v40, s36, v17
    v_fma_f32 v41, v41, s36, v17
    v_mfma_f32_16x16x32_bf16 v[44:47], a[216:219], a[120:123], 0
    v_exp_f32 v144, v32
    v_mfma_f32_16x16x32_bf16 v[44:47], a[220:223], a[124:127], v[44:47]
    v_exp_f32 v145, v33
    v_mfma_f32_16x16x32_bf16 v[44:47], a[224:227], a[128:131], v[44:47]
    v_exp_f32 v146, v34
    v_mfma_f32_16x16x32_bf16 v[44:47], a[228:231], a[132:135], v[44:47]
    v_exp_f32 v147, v35
    s_waitcnt vmcnt(42)
    s_barrier
    v_mfma_f32_16x16x32_bf16 v[44:47], a[232:235], a[136:139], v[44:47]
    v_exp_f32 v148, v40
    v_mfma_f32_16x16x32_bf16 v[44:47], a[236:239], a[140:143], v[44:47]
    ds_read_b64_tr_b16 a[240:241], v3 offset:24576
    ds_read_b64_tr_b16 a[242:243], v3 offset:30720
    v_mfma_f32_16x16x32_bf16 v[52:55], a[216:219], a[144:147], 0
    v_exp_f32 v149, v41
    v_mfma_f32_16x16x32_bf16 v[52:55], a[220:223], a[148:151], v[52:55]
    ds_read_b64_tr_b16 a[244:245], v4 offset:24576
    ds_read_b64_tr_b16 a[246:247], v4 offset:30720
    v_mfma_f32_16x16x32_bf16 v[52:55], a[224:227], a[152:155], v[52:55]
    v_cvt_pk_bf16_f32 v96, v144, v145
    v_cvt_pk_bf16_f32 v97, v146, v147
    v_mfma_f32_16x16x32_bf16 v[52:55], a[228:231], a[156:159], v[52:55]
    ds_read_b64_tr_b16 a[248:249], v5 offset:24576
    ds_read_b64_tr_b16 a[250:251], v5 offset:30720
    v_mfma_f32_16x16x32_bf16 v[52:55], a[232:235], a[160:163], v[52:55]
    v_cvt_pk_bf16_f32 v100, v148, v149
    v_mfma_f32_16x16x32_bf16 v[52:55], a[236:239], a[164:167], v[52:55]
    ds_read_b64_tr_b16 a[252:253], v6 offset:24576
    ds_read_b64_tr_b16 a[254:255], v6 offset:30720
    v_mfma_f32_16x16x32_bf16 v[60:63], a[216:219], a[168:171], 0
    v_mfma_f32_16x16x32_bf16 v[60:63], a[220:223], a[172:175], v[60:63]
    v_mfma_f32_16x16x32_bf16 v[60:63], a[224:227], a[176:179], v[60:63]
    v_mfma_f32_16x16x32_bf16 v[60:63], a[228:231], a[180:183], v[60:63]
    v_mfma_f32_16x16x32_bf16 v[60:63], a[232:235], a[184:187], v[60:63]
    v_mfma_f32_16x16x32_bf16 v[60:63], a[236:239], a[188:191], v[60:63]
    s_waitcnt lgkmcnt(4)
    v_mfma_f32_16x16x32_bf16 v[160:163], a[240:243], v[112:115], v[160:163]
    s_add_u32 s62, s34, 49152
    ds_read_b128 a[192:195], v1 offset:24576
    ds_read_b128 a[196:199], v2 offset:24576
    v_mfma_f32_16x16x32_bf16 v[208:211], a[240:243], v[116:119], v[208:211]
    s_cmp_eq_u32 s62, 147456
    ds_read_b128 a[200:203], v1 offset:25600
    ds_read_b128 a[204:207], v2 offset:25600
    v_mfma_f32_16x16x32_bf16 a[0:3], a[240:243], v[120:123], a[0:3]
    s_cselect_b32 s62, 0, s62
    ds_read_b128 a[208:211], v1 offset:26624
    ds_read_b128 a[212:215], v2 offset:26624
    v_mfma_f32_16x16x32_bf16 a[48:51], a[240:243], v[124:127], a[48:51]
    s_sub_u32 s58, s62, s34
    ds_read_b64_tr_b16 a[240:241], v3 offset:25600
    ds_read_b64_tr_b16 a[242:243], v3 offset:31744
    v_mfma_f32_16x16x32_bf16 v[164:167], a[244:247], v[112:115], v[164:167]
    s_mov_b32 s34, s62
    ds_read_b128 a[216:219], v1 offset:30720
    ds_read_b128 a[220:223], v2 offset:30720
    v_mfma_f32_16x16x32_bf16 v[212:215], a[244:247], v[116:119], v[212:215]
    s_add_u32 m0, s33, s31
    ds_read_b128 a[224:227], v1 offset:31744
    ds_read_b128 a[228:231], v2 offset:31744
    v_mfma_f32_16x16x32_bf16 a[4:7], a[244:247], v[120:123], a[4:7]
    buffer_load_dwordx4 v7, s[20:23], s28 offen offset:0 lds
    v_mfma_f32_16x16x32_bf16 a[52:55], a[244:247], v[124:127], a[52:55]
    s_waitcnt lgkmcnt(12)
    ds_read_b64_tr_b16 a[244:245], v4 offset:25600
    ds_read_b64_tr_b16 a[246:247], v4 offset:31744
    v_mfma_f32_16x16x32_bf16 v[168:171], a[248:251], v[112:115], v[168:171]
    ds_read_b128 a[232:235], v1 offset:32768
    ds_read_b128 a[236:239], v2 offset:32768
    v_mfma_f32_16x16x32_bf16 v[216:219], a[248:251], v[116:119], v[216:219]
    v_fma_f32 v36, v36, s36, v16
    v_fma_f32 v37, v37, s36, v16
    v_mfma_f32_16x16x32_bf16 a[8:11], a[248:251], v[120:123], a[8:11]
    v_exp_f32 v150, v36
    v_mfma_f32_16x16x32_bf16 a[56:59], a[248:251], v[124:127], a[56:59]
    ds_read_b64_tr_b16 a[248:249], v5 offset:25600
    ds_read_b64_tr_b16 a[250:251], v5 offset:31744
    v_mfma_f32_16x16x32_bf16 v[172:175], a[252:255], v[112:115], v[172:175]
    v_exp_f32 v151, v37
    v_mfma_f32_16x16x32_bf16 v[220:223], a[252:255], v[116:119], v[220:223]
    v_cvt_pk_bf16_f32 v98, v150, v151
    v_fma_f32 v38, v38, s36, v16
    v_mfma_f32_16x16x32_bf16 a[12:15], a[252:255], v[120:123], a[12:15]
    v_fma_f32 v39, v39, s36, v16
    v_fma_f32 v42, v42, s36, v17
    v_mfma_f32_16x16x32_bf16 a[60:63], a[252:255], v[124:127], a[60:63]
    buffer_load_dwordx4 v8, s[20:23], s28 offen offset:1024 lds
    s_waitcnt lgkmcnt(4)
    v_mfma_f32_16x16x32_bf16 v[176:179], a[240:243], v[112:115], v[176:179]
    ds_read_b64_tr_b16 a[252:253], v6 offset:25600
    ds_read_b64_tr_b16 a[254:255], v6 offset:31744
    v_mfma_f32_16x16x32_bf16 v[224:227], a[240:243], v[116:119], v[224:227]
    v_fma_f32 v43, v43, s36, v17
    v_fma_f32 v44, v44, s36, v17
    v_mfma_f32_16x16x32_bf16 a[16:19], a[240:243], v[120:123], a[16:19]
    v_fma_f32 v45, v45, s36, v17
    v_fma_f32 v46, v46, s36, v17
    v_mfma_f32_16x16x32_bf16 a[64:67], a[240:243], v[124:127], a[64:67]
    ds_read_b64_tr_b16 a[240:241], v3 offset:26624
    ds_read_b64_tr_b16 a[242:243], v3 offset:32768
    v_mfma_f32_16x16x32_bf16 v[180:183], a[244:247], v[112:115], v[180:183]
    v_fma_f32 v47, v47, s36, v17
    v_fma_f32 v48, v48, s36, v18
    v_mfma_f32_16x16x32_bf16 v[228:231], a[244:247], v[116:119], v[228:231]
    v_exp_f32 v144, v38
    v_mfma_f32_16x16x32_bf16 a[20:23], a[244:247], v[120:123], a[20:23]
    v_exp_f32 v145, v39
    v_mfma_f32_16x16x32_bf16 a[68:71], a[244:247], v[124:127], a[68:71]
    s_waitcnt lgkmcnt(4)
    ds_read_b64_tr_b16 a[244:245], v4 offset:26624
    ds_read_b64_tr_b16 a[246:247], v4 offset:32768
    v_mfma_f32_16x16x32_bf16 v[184:187], a[248:251], v[112:115], v[184:187]
    v_exp_f32 v146, v42
    v_mfma_f32_16x16x32_bf16 v[232:235], a[248:251], v[116:119], v[232:235]
    v_exp_f32 v147, v43
    v_mfma_f32_16x16x32_bf16 a[24:27], a[248:251], v[120:123], a[24:27]
    v_exp_f32 v148, v44
    v_mfma_f32_16x16x32_bf16 a[72:75], a[248:251], v[124:127], a[72:75]
    s_waitcnt lgkmcnt(3)
    ds_read_b64_tr_b16 a[248:249], v5 offset:26624
    ds_read_b64_tr_b16 a[250:251], v5 offset:32768
    v_mfma_f32_16x16x32_bf16 v[188:191], a[252:255], v[112:115], v[188:191]
    buffer_load_dwordx4 v9, s[20:23], s28 offen offset:2048 lds
    v_mfma_f32_16x16x32_bf16 v[236:239], a[252:255], v[116:119], v[236:239]
    s_add_u32 m0, s33, s32
    v_exp_f32 v149, v45
    v_mfma_f32_16x16x32_bf16 a[28:31], a[252:255], v[120:123], a[28:31]
    v_exp_f32 v150, v46
    v_mfma_f32_16x16x32_bf16 a[76:79], a[252:255], v[124:127], a[76:79]
    s_waitcnt lgkmcnt(2)
    ds_read_b64_tr_b16 a[252:253], v6 offset:26624
    ds_read_b64_tr_b16 a[254:255], v6 offset:32768
    v_mfma_f32_16x16x32_bf16 v[192:195], a[240:243], v[112:115], v[192:195]
    v_exp_f32 v151, v47
    v_mfma_f32_16x16x32_bf16 v[240:243], a[240:243], v[116:119], v[240:243]
    v_cvt_pk_bf16_f32 v99, v144, v145
    v_cvt_pk_bf16_f32 v101, v146, v147
    v_mfma_f32_16x16x32_bf16 a[32:35], a[240:243], v[120:123], a[32:35]
    v_cvt_pk_bf16_f32 v102, v148, v149
    v_cvt_pk_bf16_f32 v103, v150, v151
    v_mfma_f32_16x16x32_bf16 a[80:83], a[240:243], v[124:127], a[80:83]
    v_fma_f32 v49, v49, s36, v18
    v_fma_f32 v50, v50, s36, v18
    v_mfma_f32_16x16x32_bf16 v[196:199], a[244:247], v[112:115], v[196:199]
    v_fma_f32 v51, v51, s36, v18
    v_fma_f32 v52, v52, s36, v18
    v_mfma_f32_16x16x32_bf16 v[244:247], a[244:247], v[116:119], v[244:247]
    v_fma_f32 v53, v53, s36, v18
    v_fma_f32 v54, v54, s36, v18
    v_mfma_f32_16x16x32_bf16 a[36:39], a[244:247], v[120:123], a[36:39]
    v_fma_f32 v55, v55, s36, v18
    v_fma_f32 v56, v56, s36, v19
    v_mfma_f32_16x16x32_bf16 a[84:87], a[244:247], v[124:127], a[84:87]
    s_waitcnt lgkmcnt(1)
    v_exp_f32 v144, v48
    v_mfma_f32_16x16x32_bf16 v[200:203], a[248:251], v[112:115], v[200:203]
    buffer_load_dwordx4 v10, s[24:27], s29 offen offset:0 lds
    v_mfma_f32_16x16x32_bf16 v[248:251], a[248:251], v[116:119], v[248:251]
    v_exp_f32 v145, v49
    v_mfma_f32_16x16x32_bf16 a[40:43], a[248:251], v[120:123], a[40:43]
    v_exp_f32 v146, v50
    v_mfma_f32_16x16x32_bf16 a[88:91], a[248:251], v[124:127], a[88:91]
    s_waitcnt lgkmcnt(0)
    v_exp_f32 v147, v51
    v_mfma_f32_16x16x32_bf16 v[204:207], a[252:255], v[112:115], v[204:207]
    v_exp_f32 v148, v52
    v_mfma_f32_16x16x32_bf16 v[252:255], a[252:255], v[116:119], v[252:255]
    v_exp_f32 v149, v53
    v_mfma_f32_16x16x32_bf16 a[44:47], a[252:255], v[120:123], a[44:47]
    v_exp_f32 v150, v54
    v_mfma_f32_16x16x32_bf16 a[92:95], a[252:255], v[124:127], a[92:95]
    v_exp_f32 v151, v55
    v_mfma_f32_16x16x32_bf16 v[64:67], a[192:195], a[96:99], 0
    v_cvt_pk_bf16_f32 v104, v144, v145
    v_cvt_pk_bf16_f32 v105, v146, v147
    v_mfma_f32_16x16x32_bf16 v[64:67], a[196:199], a[100:103], v[64:67]
    v_cvt_pk_bf16_f32 v106, v148, v149
    v_cvt_pk_bf16_f32 v107, v150, v151
    v_mfma_f32_16x16x32_bf16 v[64:67], a[200:203], a[104:107], v[64:67]
    v_fma_f32 v57, v57, s36, v19
    v_fma_f32 v58, v58, s36, v19
    v_mfma_f32_16x16x32_bf16 v[64:67], a[204:207], a[108:111], v[64:67]
    v_fma_f32 v59, v59, s36, v19
    v_fma_f32 v60, v60, s36, v19
    v_mfma_f32_16x16x32_bf16 v[64:67], a[208:211], a[112:115], v[64:67]
    v_fma_f32 v61, v61, s36, v19
    v_fma_f32 v62, v62, s36, v19
    v_mfma_f32_16x16x32_bf16 v[64:67], a[212:215], a[116:119], v[64:67]
    buffer_load_dwordx4 v11, s[24:27], s29 offen offset:1024 lds
    v_mfma_f32_16x16x32_bf16 v[72:75], a[192:195], a[120:123], 0
    v_fma_f32 v63, v63, s36, v19
    v_add_f32 v20, v20, v128
    v_mfma_f32_16x16x32_bf16 v[128:131], v[24:27], v[96:99], 0
    v_exp_f32 v144, v56
    v_mfma_f32_16x16x32_bf16 v[72:75], a[196:199], a[124:127], v[72:75]
    v_exp_f32 v145, v57
    v_mfma_f32_16x16x32_bf16 v[72:75], a[200:203], a[128:131], v[72:75]
    v_exp_f32 v146, v58
    v_mfma_f32_16x16x32_bf16 v[72:75], a[204:207], a[132:135], v[72:75]
    v_exp_f32 v147, v59
    v_mfma_f32_16x16x32_bf16 v[72:75], a[208:211], a[136:139], v[72:75]
    v_exp_f32 v148, v60
    v_mfma_f32_16x16x32_bf16 v[72:75], a[212:215], a[140:143], v[72:75]
    v_exp_f32 v149, v61
    v_mfma_f32_16x16x32_bf16 v[80:83], a[192:195], a[144:147], 0
    v_exp_f32 v150, v62
    v_mfma_f32_16x16x32_bf16 v[80:83], a[196:199], a[148:151], v[80:83]
    v_exp_f32 v151, v63
    v_mfma_f32_16x16x32_bf16 v[80:83], a[200:203], a[152:155], v[80:83]
    v_cvt_pk_bf16_f32 v108, v144, v145
    v_cvt_pk_bf16_f32 v109, v146, v147
    v_mfma_f32_16x16x32_bf16 v[80:83], a[204:207], a[156:159], v[80:83]
    v_cvt_pk_bf16_f32 v110, v148, v149
    v_cvt_pk_bf16_f32 v111, v150, v151
    v_mfma_f32_16x16x32_bf16 v[80:83], a[208:211], a[160:163], v[80:83]
    buffer_load_dwordx4 v12, s[24:27], s29 offen offset:2048 lds
    v_mfma_f32_16x16x32_bf16 v[80:83], a[212:215], a[164:167], v[80:83]
    s_add_u32 s28, s28, s30
    v_add_f32 v21, v21, v132
    v_add_f32 v22, v22, v136
    v_mfma_f32_16x16x32_bf16 v[132:135], v[24:27], v[100:103], 0
    s_add_u32 s29, s29, s30
    v_add_f32 v23, v23, v140
    v_add_u32 v3, s58, v3
    v_mfma_f32_16x16x32_bf16 v[136:139], v[24:27], v[104:107], 0
    s_add_u32 s33, s33, 24576
    v_add_u32 v4, s58, v4
    v_add_u32 v5, s58, v5
    v_mfma_f32_16x16x32_bf16 v[140:143], v[24:27], v[108:111], 0
    s_cmp_eq_u32 s33, 147456
    v_add_u32 v6, s58, v6
    v_add_u32 v1, s58, v1
    v_mfma_f32_16x16x32_bf16 v[88:91], a[192:195], a[168:171], 0
    s_cselect_b32 s33, 0, s33
    v_max3_f32 v30, v128, v132, v136
    v_add_u32 v2, s58, v2
    v_mfma_f32_16x16x32_bf16 v[88:91], a[196:199], a[172:175], v[88:91]
    v_max_f32 v30, v30, v140
    v_cmp_lt_f32 vcc, s37, v30
    v_mfma_f32_16x16x32_bf16 v[88:91], a[200:203], a[176:179], v[88:91]
    v_mfma_f32_16x16x32_bf16 v[88:91], a[204:207], a[180:183], v[88:91]
    v_mfma_f32_16x16x32_bf16 v[88:91], a[208:211], a[184:187], v[88:91]
    v_mfma_f32_16x16x32_bf16 v[88:91], a[212:215], a[188:191], v[88:91]
    v_mfma_f32_16x16x32_bf16 v[68:71], a[216:219], a[96:99], 0
    s_cbranch_vccnz L_rs_tr44b
L_ret_tr44b:
    v_fma_f32 v64, v64, s36, v16
    v_fma_f32 v65, v65, s36, v16
    v_mfma_f32_16x16x32_bf16 v[68:71], a[220:223], a[100:103], v[68:71]
    v_fma_f32 v66, v66, s36, v16
    v_fma_f32 v67, v67, s36, v16
    v_mfma_f32_16x16x32_bf16 v[68:71], a[224:227], a[104:107], v[68:71]
    v_fma_f32 v72, v72, s36, v17
    v_fma_f32 v73, v73, s36, v17
    v_mfma_f32_16x16x32_bf16 v[68:71], a[228:231], a[108:111], v[68:71]
    v_exp_f32 v144, v64
    v_mfma_f32_16x16x32_bf16 v[68:71], a[232:235], a[112:115], v[68:71]
    v_exp_f32 v145, v65
    v_mfma_f32_16x16x32_bf16 v[68:71], a[236:239], a[116:119], v[68:71]
    v_exp_f32 v146, v66
    v_mfma_f32_16x16x32_bf16 v[76:79], a[216:219], a[120:123], 0
    v_exp_f32 v147, v67
    v_mfma_f32_16x16x32_bf16 v[76:79], a[220:223], a[124:127], v[76:79]
    v_exp_f32 v148, v72
    v_mfma_f32_16x16x32_bf16 v[76:79], a[224:227], a[128:131], v[76:79]
    v_exp_f32 v149, v73
    v_mfma_f32_16x16x32_bf16 v[76:79], a[228:231], a[132:135], v[76:79]
    v_cvt_pk_bf16_f32 v112, v144, v145
    v_cvt_pk_bf16_f32 v113, v146, v147
    s_waitcnt vmcnt(18)
    s_barrier
    v_mfma_f32_16x16x32_bf16 v[76:79], a[232:235], a[136:139], v[76:79]
    v_cvt_pk_bf16_f32 v116, v148, v149
    v_mfma_f32_16x16x32_bf16 v[76:79], a[236:239], a[140:143], v[76:79]
    ds_read_b64_tr_b16 a[240:241], v3 offset:0
    ds_read_b64_tr_b16 a[242:243], v3 offset:6144
    v_mfma_f32_16x16x32_bf16 v[84:87], a[216:219], a[144:147], 0
    v_mfma_f32_16x16x32_bf16 v[84:87], a[220:223], a[148:151], v[84:87]
    ds_read_b64_tr_b16 a[244:245], v4 offset:0
    ds_read_b64_tr_b16 a[246:247], v4 offset:6144
    v_mfma_f32_16x16x32_bf16 v[84:87], a[224:227], a[152:155], v[84:87]
    v_mfma_f32_16x16x32_bf16 v[84:87], a[228:231], a[156:159], v[84:87]
    ds_read_b64_tr_b16 a[248:249], v5 offset:0
    ds_read_b64_tr_b16 a[250:251], v5 offset:6144
    v_mfma_f32_16x16x32_bf16 v[84:87], a[232:235], a[160:163], v[84:87]
    v_mfma_f32_16x16x32_bf16 v[84:87], a[236:239], a[164:167], v[84:87]
    ds_read_b64_tr_b16 a[252:253], v6 offset:0
    ds_read_b64_tr_b16 a[254:255], v6 offset:6144
    v_mfma_f32_16x16x32_bf16 v[92:95], a[216:219], a[168:171], 0
    v_mfma_f32_16x16x32_bf16 v[92:95], a[220:223], a[172:175], v[92:95]
    v_mfma_f32_16x16x32_bf16 v[92:95], a[224:227], a[176:179], v[92:95]
    v_mfma_f32_16x16x32_bf16 v[92:95], a[228:231], a[180:183], v[92:95]
    v_mfma_f32_16x16x32_bf16 v[92:95], a[232:235], a[184:187], v[92:95]
    v_mfma_f32_16x16x32_bf16 v[92:95], a[236:239], a[188:191], v[92:95]
    s_mov_b32 s38, 0
    s_branch L_loop4
L_loop3:
    s_bitcmp1_b32 s3, 1
    s_cbranch_scc1 L_loop3w1
    .p2align 6
L_loop3w0:
    s_waitcnt lgkmcnt(4)
    v_mfma_f32_16x16x32_bf16 v[160:163], a[240:243], v[96:99], v[160:163]
    s_add_u32 m0, s33, s31
    ds_read_b128 a[192:195], v1 offset:0
    ds_read_b128 a[196:199], v2 offset:0
    v_mfma_f32_16x16x32_bf16 v[208:211], a[240:243], v[100:103], v[208:211]
    ds_read_b128 a[200:203], v1 offset:1024
    ds_read_b128 a[204:207], v2 offset:1024
    v_mfma_f32_16x16x32_bf16 a[0:3], a[240:243], v[104:107], a[0:3]
    ds_read_b64_tr_b16 a[240:241], v3 offset:1024
    ds_read_b64_tr_b16 a[242:243], v3 offset:7168
    v_mfma_f32_16x16x32_bf16 v[164:167], a[244:247], v[96:99], v[164:167]
    buffer_load_dwordx4 v7, s[20:23], s28 offen offset:0 lds
    v_mfma_f32_16x16x32_bf16 v[212:215], a[244:247], v[100:103], v[212:215]
    ds_read_b128 a[208:211], v1 offset:2048
    ds_read_b128 a[212:215], v2 offset:2048
    v_mfma_f32_16x16x32_bf16 a[4:7], a[244:247], v[104:107], a[4:7]
    s_waitcnt lgkmcnt(8)
    ds_read_b64_tr_b16 a[244:245], v4 offset:1024
    ds_read_b64_tr_b16 a[246:247], v4 offset:7168
    v_mfma_f32_16x16x32_bf16 v[168:171], a[248:251], v[96:99], v[168:171]
    ds_read_b128 a[216:219], v1 offset:6144
    ds_read_b128 a[220:223], v2 offset:6144
    v_mfma_f32_16x16x32_bf16 v[216:219], a[248:251], v[100:103], v[216:219]
    ds_read_b128 a[224:227], v1 offset:7168
    ds_read_b128 a[228:231], v2 offset:7168
    v_mfma_f32_16x16x32_bf16 a[8:11], a[248:251], v[104:107], a[8:11]
    ds_read_b64_tr_b16 a[248:249], v5 offset:1024
    ds_read_b64_tr_b16 a[250:251], v5 offset:7168
    v_mfma_f32_16x16x32_bf16 v[172:175], a[252:255], v[96:99], v[172:175]
    ds_read_b128 a[232:235], v1 offset:8192
    ds_read_b128 a[236:239], v2 offset:8192
    v_mfma_f32_16x16x32_bf16 v[220:223], a[252:255], v[100:103], v[220:223]
    v_fma_f32 v68, v68, s36, v16
    v_fma_f32 v69, v69, s36, v16
    v_mfma_f32_16x16x32_bf16 a[12:15], a[252:255], v[104:107], a[12:15]
    s_waitcnt lgkmcnt(12)
    ds_read_b64_tr_b16 a[252:253], v6 offset:1024
    ds_read_b64_tr_b16 a[254:255], v6 offset:7168
    v_mfma_f32_16x16x32_bf16 v[176:179], a[240:243], v[96:99], v[176:179]
    buffer_load_dwordx4 v8, s[20:23], s28 offen offset:1024 lds
    v_mfma_f32_16x16x32_bf16 v[224:227], a[240:243], v[100:103], v[224:227]
    v_exp_f32 v150, v68
    v_mfma_f32_16x16x32_bf16 a[16:19], a[240:243], v[104:107], a[16:19]
    s_waitcnt lgkmcnt(8)
    ds_read_b64_tr_b16 a[240:241], v3 offset:2048
    ds_read_b64_tr_b16 a[242:243], v3 offset:8192
    v_mfma_f32_16x16x32_bf16 v[180:183], a[244:247], v[96:99], v[180:183]
    v_exp_f32 v151, v69
    v_mfma_f32_16x16x32_bf16 v[228:231], a[244:247], v[100:103], v[228:231]
    v_cvt_pk_bf16_f32 v114, v150, v151
    v_fma_f32 v70, v70, s36, v16
    v_mfma_f32_16x16x32_bf16 a[20:23], a[244:247], v[104:107], a[20:23]
    s_waitcnt lgkmcnt(4)
    ds_read_b64_tr_b16 a[244:245], v4 offset:2048
    ds_read_b64_tr_b16 a[246:247], v4 offset:8192
    v_mfma_f32_16x16x32_bf16 v[184:187], a[248:251], v[96:99], v[184:187]
    v_fma_f32 v71, v71, s36, v16
    v_fma_f32 v74, v74, s36, v17
    v_mfma_f32_16x16x32_bf16 v[232:235], a[248:251], v[100:103], v[232:235]
    v_fma_f32 v75, v75, s36, v17
    v_fma_f32 v76, v76, s36, v17
    v_mfma_f32_16x16x32_bf16 a[24:27], a[248:251], v[104:107], a[24:27]
    s_waitcnt lgkmcnt(4)
    ds_read_b64_tr_b16 a[248:249], v5 offset:2048
    ds_read_b64_tr_b16 a[250:251], v5 offset:8192
    v_mfma_f32_16x16x32_bf16 v[188:191], a[252:255], v[96:99], v[188:191]
    buffer_load_dwordx4 v9, s[20:23], s28 offen offset:2048 lds
    v_mfma_f32_16x16x32_bf16 v[236:239], a[252:255], v[100:103], v[236:239]
    s_add_u32 m0, s33, s32
    v_fma_f32 v77, v77, s36, v17
    v_fma_f32 v78, v78, s36, v17
    v_mfma_f32_16x16x32_bf16 a[28:31], a[252:255], v[104:107], a[28:31]
    s_waitcnt lgkmcnt(4)
    ds_read_b64_tr_b16 a[252:253], v6 offset:2048
    ds_read_b64_tr_b16 a[254:255], v6 offset:8192
    v_mfma_f32_16x16x32_bf16 v[192:195], a[240:243], v[96:99], v[192:195]
    v_fma_f32 v79, v79, s36, v17
    v_fma_f32 v80, v80, s36, v18
    v_mfma_f32_16x16x32_bf16 v[240:243], a[240:243], v[100:103], v[240:243]
    v_exp_f32 v144, v70
    v_mfma_f32_16x16x32_bf16 a[32:35], a[240:243], v[104:107], a[32:35]
    s_waitcnt lgkmcnt(4)
    v_exp_f32 v145, v71
    v_mfma_f32_16x16x32_bf16 v[196:199], a[244:247], v[96:99], v[196:199]
    v_exp_f32 v146, v74
    v_mfma_f32_16x16x32_bf16 v[244:247], a[244:247], v[100:103], v[244:247]
    v_exp_f32 v147, v75
    v_mfma_f32_16x16x32_bf16 a[36:39], a[244:247], v[104:107], a[36:39]
    s_waitcnt lgkmcnt(2)
    v_exp_f32 v148, v76
    v_mfma_f32_16x16x32_bf16 v[200:203], a[248:251], v[96:99], v[200:203]
    buffer_load_dwordx4 v10, s[24:27], s29 offen offset:0 lds
    v_mfma_f32_16x16x32_bf16 v[248:251], a[248:251], v[100:103], v[248:251]
    v_exp_f32 v149, v77
    v_mfma_f32_16x16x32_bf16 a[40:43], a[248:251], v[104:107], a[40:43]
    s_waitcnt lgkmcnt(0)
    v_exp_f32 v150, v78
    v_mfma_f32_16x16x32_bf16 v[204:207], a[252:255], v[96:99], v[204:207]
    v_exp_f32 v151, v79
    v_mfma_f32_16x16x32_bf16 v[252:255], a[252:255], v[100:103], v[252:255]
    v_cvt_pk_bf16_f32 v115, v144, v145
    v_cvt_pk_bf16_f32 v117, v146, v147
    v_mfma_f32_16x16x32_bf16 a[44:47], a[252:255], v[104:107], a[44:47]
    v_cvt_pk_bf16_f32 v118, v148, v149
    v_cvt_pk_bf16_f32 v119, v150, v151
    v_mfma_f32_16x16x32_bf16 v[32:35], a[192:195], a[96:99], 0
    v_fma_f32 v81, v81, s36, v18
    v_fma_f32 v82, v82, s36, v18
    v_mfma_f32_16x16x32_bf16 v[32:35], a[196:199], a[100:103], v[32:35]
    v_fma_f32 v83, v83, s36, v18
    v_fma_f32 v84, v84, s36, v18
    v_mfma_f32_16x16x32_bf16 v[32:35], a[200:203], a[104:107], v[32:35]
    v_fma_f32 v85, v85, s36, v18
    v_fma_f32 v86, v86, s36, v18
    v_mfma_f32_16x16x32_bf16 v[32:35], a[204:207], a[108:111], v[32:35]
    buffer_load_dwordx4 v11, s[24:27], s29 offen offset:1024 lds
    v_mfma_f32_16x16x32_bf16 v[32:35], a[208:211], a[112:115], v[32:35]
    v_fma_f32 v87, v87, s36, v18
    v_add_f32 v20, v20, v128
    v_mfma_f32_16x16x32_bf16 v[128:131], v[24:27], v[112:115], 0
    v_exp_f32 v144, v80
    v_mfma_f32_16x16x32_bf16 v[32:35], a[212:215], a[116:119], v[32:35]
    v_exp_f32 v145, v81
    v_mfma_f32_16x16x32_bf16 v[40:43], a[192:195], a[120:123], 0
    v_exp_f32 v146, v82
    v_mfma_f32_16x16x32_bf16 v[40:43], a[196:199], a[124:127], v[40:43]
    v_exp_f32 v147, v83
    v_mfma_f32_16x16x32_bf16 v[40:43], a[200:203], a[128:131], v[40:43]
    v_exp_f32 v148, v84
    v_mfma_f32_16x16x32_bf16 v[40:43], a[204:207], a[132:135], v[40:43]
    v_exp_f32 v149, v85
    v_mfma_f32_16x16x32_bf16 v[40:43], a[208:211], a[136:139], v[40:43]
    v_exp_f32 v150, v86
    v_mfma_f32_16x16x32_bf16 v[40:43], a[212:215], a[140:143], v[40:43]
    buffer_load_dwordx4 v12, s[24:27], s29 offen offset:2048 lds
    v_mfma_f32_16x16x32_bf16 v[48:51], a[192:195], a[144:147], 0
    s_add_u32 s28, s28, s30
    v_exp_f32 v151, v87
    v_mfma_f32_16x16x32_bf16 v[48:51], a[196:199], a[148:151], v[48:51]
    s_add_u32 s29, s29, s30
    v_cvt_pk_bf16_f32 v120, v144, v145
    v_cvt_pk_bf16_f32 v121, v146, v147
    v_mfma_f32_16x16x32_bf16 v[48:51], a[200:203], a[152:155], v[48:51]
    s_add_u32 s33, s33, 24576
    v_cvt_pk_bf16_f32 v122, v148, v149
    v_cvt_pk_bf16_f32 v123, v150, v151
    v_mfma_f32_16x16x32_bf16 v[48:51], a[204:207], a[156:159], v[48:51]
    s_cmp_eq_u32 s33, 147456
    v_add_f32 v21, v21, v132
    v_add_f32 v22, v22, v136
    v_mfma_f32_16x16x32_bf16 v[132:135], v[24:27], v[116:119], 0
    s_cselect_b32 s33, 0, s33
    v_mfma_f32_16x16x32_bf16 v[136:139], v[24:27], v[120:123], 0
    v_mfma_f32_16x16x32_bf16 v[48:51], a[208:211], a[160:163], v[48:51]
    v_mfma_f32_16x16x32_bf16 v[48:51], a[212:215], a[164:167], v[48:51]
    v_mfma_f32_16x16x32_bf16 v[36:39], a[216:219], a[96:99], 0
    v_mfma_f32_16x16x32_bf16 v[36:39], a[220:223], a[100:103], v[36:39]
    v_mfma_f32_16x16x32_bf16 v[36:39], a[224:227], a[104:107], v[36:39]
    v_mfma_f32_16x16x32_bf16 v[36:39], a[228:231], a[108:111], v[36:39]
    s_waitcnt vmcnt(18)
    s_barrier
    v_max3_f32 v30, v128, v132, v136
    v_cmp_lt_f32 vcc, s37, v30
    v_mfma_f32_16x16x32_bf16 v[36:39], a[232:235], a[112:115], v[36:39]
    v_mfma_f32_16x16x32_bf16 v[36:39], a[236:239], a[116:119], v[36:39]
    ds_read_b64_tr_b16 a[240:241], v3 offset:24576
    ds_read_b64_tr_b16 a[242:243], v3 offset:30720
    v_mfma_f32_16x16x32_bf16 v[44:47], a[216:219], a[120:123], 0
    s_cbranch_vccnz L_rs_loop3w0a
L_ret_loop3w0a:
    s_cmp_ge_u32 s38, 4
    s_cbranch_scc1 L_mode3w0
L_modeback3w0:
    v_mfma_f32_16x16x32_bf16 v[44:47], a[220:223], a[124:127], v[44:47]
    ds_read_b64_tr_b16 a[244:245], v4 offset:24576
    ds_read_b64_tr_b16 a[246:247], v4 offset:30720
    v_mfma_f32_16x16x32_bf16 v[44:47], a[224:227], a[128:131], v[44:47]
    ds_read_b64_tr_b16 a[248:249], v5 offset:24576
    ds_read_b64_tr_b16 a[250:251], v5 offset:30720
    v_mfma_f32_16x16x32_bf16 v[44:47], a[228:231], a[132:135], v[44:47]
    ds_read_b64_tr_b16 a[252:253], v6 offset:24576
    ds_read_b64_tr_b16 a[254:255], v6 offset:30720
    v_mfma_f32_16x16x32_bf16 v[44:47], a[232:235], a[136:139], v[44:47]
    v_fma_f32 v32, v32, s36, v16
    v_fma_f32 v33, v33, s36, v16
    v_mfma_f32_16x16x32_bf16 v[44:47], a[236:239], a[140:143], v[44:47]
    v_fma_f32 v34, v34, s36, v16
    v_fma_f32 v35, v35, s36, v16
    v_mfma_f32_16x16x32_bf16 v[52:55], a[216:219], a[144:147], 0
    v_fma_f32 v40, v40, s36, v17
    v_fma_f32 v41, v41, s36, v17
    v_mfma_f32_16x16x32_bf16 v[52:55], a[220:223], a[148:151], v[52:55]
    v_exp_f32 v144, v32
    v_mfma_f32_16x16x32_bf16 v[52:55], a[224:227], a[152:155], v[52:55]
    v_exp_f32 v145, v33
    v_mfma_f32_16x16x32_bf16 v[52:55], a[228:231], a[156:159], v[52:55]
    v_exp_f32 v146, v34
    v_mfma_f32_16x16x32_bf16 v[52:55], a[232:235], a[160:163], v[52:55]
    v_exp_f32 v147, v35
    v_mfma_f32_16x16x32_bf16 v[52:55], a[236:239], a[164:167], v[52:55]
    v_exp_f32 v148, v40
    v_exp_f32 v149, v41
    v_cvt_pk_bf16_f32 v96, v144, v145
    v_cvt_pk_bf16_f32 v97, v146, v147
    v_cvt_pk_bf16_f32 v100, v148, v149
    s_waitcnt lgkmcnt(0)
    v_mfma_f32_16x16x32_bf16 v[160:163], a[240:243], v[112:115], v[160:163]
    s_add_u32 s62, s34, 49152
    ds_read_b128 a[192:195], v1 offset:24576
    ds_read_b128 a[196:199], v2 offset:24576
    v_mfma_f32_16x16x32_bf16 v[208:211], a[240:243], v[116:119], v[208:211]
    s_cmp_eq_u32 s62, 147456
    ds_read_b128 a[200:203], v1 offset:25600
    ds_read_b128 a[204:207], v2 offset:25600
    v_mfma_f32_16x16x32_bf16 a[0:3], a[240:243], v[120:123], a[0:3]
    s_cselect_b32 s62, 0, s62
    ds_read_b64_tr_b16 a[240:241], v3 offset:25600
    ds_read_b64_tr_b16 a[242:243], v3 offset:31744
    v_mfma_f32_16x16x32_bf16 v[164:167], a[244:247], v[112:115], v[164:167]
    s_sub_u32 s58, s62, s34
    ds_read_b128 a[208:211], v1 offset:26624
    ds_read_b128 a[212:215], v2 offset:26624
    v_mfma_f32_16x16x32_bf16 v[212:215], a[244:247], v[116:119], v[212:215]
    s_mov_b32 s34, s62
    ds_read_b128 a[216:219], v1 offset:30720
    ds_read_b128 a[220:223], v2 offset:30720
    v_mfma_f32_16x16x32_bf16 a[4:7], a[244:247], v[120:123], a[4:7]
    s_add_u32 m0, s33, s31
    ds_read_b64_tr_b16 a[244:245], v4 offset:25600
    ds_read_b64_tr_b16 a[246:247], v4 offset:31744
    v_mfma_f32_16x16x32_bf16 v[168:171], a[248:251], v[112:115], v[168:171]
    buffer_load_dwordx4 v7, s[20:23], s28 offen offset:0 lds
    v_mfma_f32_16x16x32_bf16 v[216:219], a[248:251], v[116:119], v[216:219]
    ds_read_b128 a[224:227], v1 offset:31744
    ds_read_b128 a[228:231], v2 offset:31744
    v_mfma_f32_16x16x32_bf16 a[8:11], a[248:251], v[120:123], a[8:11]
    ds_read_b64_tr_b16 a[248:249], v5 offset:25600
    ds_read_b64_tr_b16 a[250:251], v5 offset:31744
    v_mfma_f32_16x16x32_bf16 v[172:175], a[252:255], v[112:115], v[172:175]
    ds_read_b128 a[232:235], v1 offset:32768
    ds_read_b128 a[236:239], v2 offset:32768
    v_mfma_f32_16x16x32_bf16 v[220:223], a[252:255], v[116:119], v[220:223]
    v_fma_f32 v36, v36, s36, v16
    v_fma_f32 v37, v37, s36, v16
    v_mfma_f32_16x16x32_bf16 a[12:15], a[252:255], v[120:123], a[12:15]
    s_waitcnt lgkmcnt(11)
    ds_read_b64_tr_b16 a[252:253], v6 offset:25600
    ds_read_b64_tr_b16 a[254:255], v6 offset:31744
    v_mfma_f32_16x16x32_bf16 v[176:179], a[240:243], v[112:115], v[176:179]
    buffer_load_dwordx4 v8, s[20:23], s28 offen offset:1024 lds
    v_mfma_f32_16x16x32_bf16 v[224:227], a[240:243], v[116:119], v[224:227]
    v_exp_f32 v150, v36
    v_mfma_f32_16x16x32_bf16 a[16:19], a[240:243], v[120:123], a[16:19]
    s_waitcnt lgkmcnt(8)
    ds_read_b64_tr_b16 a[240:241], v3 offset:26624
    ds_read_b64_tr_b16 a[242:243], v3 offset:32768
    v_mfma_f32_16x16x32_bf16 v[180:183], a[244:247], v[112:115], v[180:183]
    v_exp_f32 v151, v37
    v_mfma_f32_16x16x32_bf16 v[228:231], a[244:247], v[116:119], v[228:231]
    v_cvt_pk_bf16_f32 v98, v150, v151
    v_fma_f32 v38, v38, s36, v16
    v_mfma_f32_16x16x32_bf16 a[20:23], a[244:247], v[120:123], a[20:23]
    s_waitcnt lgkmcnt(4)
    ds_read_b64_tr_b16 a[244:245], v4 offset:26624
    ds_read_b64_tr_b16 a[246:247], v4 offset:32768
    v_mfma_f32_16x16x32_bf16 v[184:187], a[248:251], v[112:115], v[184:187]
    v_fma_f32 v39, v39, s36, v16
    v_fma_f32 v42, v42, s36, v17
    v_mfma_f32_16x16x32_bf16 v[232:235], a[248:251], v[116:119], v[232:235]
    v_fma_f32 v43, v43, s36, v17
    v_fma_f32 v44, v44, s36, v17
    v_mfma_f32_16x16x32_bf16 a[24:27], a[248:251], v[120:123], a[24:27]
    s_waitcnt lgkmcnt(4)
    ds_read_b64_tr_b16 a[248:249], v5 offset:26624
    ds_read_b64_tr_b16 a[250:251], v5 offset:32768
    v_mfma_f32_16x16x32_bf16 v[188:191], a[252:255], v[112:115], v[188:191]
    buffer_load_dwordx4 v9, s[20:23], s28 offen offset:2048 lds
    v_mfma_f32_16x16x32_bf16 v[236:239], a[252:255], v[116:119], v[236:239]
    s_add_u32 m0, s33, s32
    v_fma_f32 v45, v45, s36, v17
    v_fma_f32 v46, v46, s36, v17
    v_mfma_f32_16x16x32_bf16 a[28:31], a[252:255], v[120:123], a[28:31]
    s_waitcnt lgkmcnt(4)
    ds_read_b64_tr_b16 a[252:253], v6 offset:26624
    ds_read_b64_tr_b16 a[254:255], v6 offset:32768
    v_mfma_f32_16x16x32_bf16 v[192:195], a[240:243], v[112:115], v[192:195]
    v_fma_f32 v47, v47, s36, v17
    v_fma_f32 v48, v48, s36, v18
    v_mfma_f32_16x16x32_bf16 v[240:243], a[240:243], v[116:119], v[240:243]
    v_exp_f32 v144, v38
    v_mfma_f32_16x16x32_bf16 a[32:35], a[240:243], v[120:123], a[32:35]
    s_waitcnt lgkmcnt(4)
    v_exp_f32 v145, v39
    v_mfma_f32_16x16x32_bf16 v[196:199], a[244:247], v[112:115], v[196:199]
    v_exp_f32 v146, v42
    v_mfma_f32_16x16x32_bf16 v[244:247], a[244:247], v[116:119], v[244:247]
    v_exp_f32 v147, v43
    v_mfma_f32_16x16x32_bf16 a[36:39], a[244:247], v[120:123], a[36:39]
    s_waitcnt lgkmcnt(2)
    v_exp_f32 v148, v44
    v_mfma_f32_16x16x32_bf16 v[200:203], a[248:251], v[112:115], v[200:203]
    buffer_load_dwordx4 v10, s[24:27], s29 offen offset:0 lds
    v_mfma_f32_16x16x32_bf16 v[248:251], a[248:251], v[116:119], v[248:251]
    v_exp_f32 v149, v45
    v_mfma_f32_16x16x32_bf16 a[40:43], a[248:251], v[120:123], a[40:43]
    s_waitcnt lgkmcnt(0)
    v_exp_f32 v150, v46
    v_mfma_f32_16x16x32_bf16 v[204:207], a[252:255], v[112:115], v[204:207]
    v_exp_f32 v151, v47
    v_mfma_f32_16x16x32_bf16 v[252:255], a[252:255], v[116:119], v[252:255]
    v_cvt_pk_bf16_f32 v99, v144, v145
    v_cvt_pk_bf16_f32 v101, v146, v147
    v_mfma_f32_16x16x32_bf16 a[44:47], a[252:255], v[120:123], a[44:47]
    v_cvt_pk_bf16_f32 v102, v148, v149
    v_cvt_pk_bf16_f32 v103, v150, v151
    v_mfma_f32_16x16x32_bf16 v[64:67], a[192:195], a[96:99], 0
    v_fma_f32 v49, v49, s36, v18
    v_fma_f32 v50, v50, s36, v18
    v_mfma_f32_16x16x32_bf16 v[64:67], a[196:199], a[100:103], v[64:67]
    v_fma_f32 v51, v51, s36, v18
    v_fma_f32 v52, v52, s36, v18
    v_mfma_f32_16x16x32_bf16 v[64:67], a[200:203], a[104:107], v[64:67]
    v_fma_f32 v53, v53, s36, v18
    v_fma_f32 v54, v54, s36, v18
    v_mfma_f32_16x16x32_bf16 v[64:67], a[204:207], a[108:111], v[64:67]
    buffer_load_dwordx4 v11, s[24:27], s29 offen offset:1024 lds
    v_mfma_f32_16x16x32_bf16 v[64:67], a[208:211], a[112:115], v[64:67]
    v_fma_f32 v55, v55, s36, v18
    v_add_f32 v20, v20, v128
    v_mfma_f32_16x16x32_bf16 v[128:131], v[24:27], v[96:99], 0
    v_exp_f32 v144, v48
    v_mfma_f32_16x16x32_bf16 v[64:67], a[212:215], a[116:119], v[64:67]
    v_exp_f32 v145, v49
    v_mfma_f32_16x16x32_bf16 v[72:75], a[192:195], a[120:123], 0
    v_exp_f32 v146, v50
    v_mfma_f32_16x16x32_bf16 v[72:75], a[196:199], a[124:127], v[72:75]
    v_exp_f32 v147, v51
    v_mfma_f32_16x16x32_bf16 v[72:75], a[200:203], a[128:131], v[72:75]
    v_exp_f32 v148, v52
    v_mfma_f32_16x16x32_bf16 v[72:75], a[204:207], a[132:135], v[72:75]
    v_exp_f32 v149, v53
    v_mfma_f32_16x16x32_bf16 v[72:75], a[208:211], a[136:139], v[72:75]
    v_exp_f32 v150, v54
    v_mfma_f32_16x16x32_bf16 v[72:75], a[212:215], a[140:143], v[72:75]
    buffer_load_dwordx4 v12, s[24:27], s29 offen offset:2048 lds
    v_mfma_f32_16x16x32_bf16 v[80:83], a[192:195], a[144:147], 0
    s_add_u32 s28, s28, s30
    v_exp_f32 v151, v55
    v_mfma_f32_16x16x32_bf16 v[80:83], a[196:199], a[148:151], v[80:83]
    s_add_u32 s29, s29, s30
    v_cvt_pk_bf16_f32 v104, v144, v145
    v_cvt_pk_bf16_f32 v105, v146, v147
    v_mfma_f32_16x16x32_bf16 v[80:83], a[200:203], a[152:155], v[80:83]
    s_add_u32 s33, s33, 24576
    v_cvt_pk_bf16_f32 v106, v148, v149
    v_cvt_pk_bf16_f32 v107, v150, v151
    v_mfma_f32_16x16x32_bf16 v[80:83], a[204:207], a[156:159], v[80:83]
    s_cmp_eq_u32 s33, 147456
    v_add_f32 v21, v21, v132
    v_add_f32 v22, v22, v136
    v_mfma_f32_16x16x32_bf16 v[132:135], v[24:27], v[100:103], 0
    s_cselect_b32 s33, 0, s33
    v_add_u32 v3, s58, v3
    v_add_u32 v4, s58, v4
    v_mfma_f32_16x16x32_bf16 v[136:139], v[24:27], v[104:107], 0
    v_add_u32 v5, s58, v5
    v_add_u32 v6, s58, v6
    v_mfma_f32_16x16x32_bf16 v[80:83], a[208:211], a[160:163], v[80:83]
    v_add_u32 v1, s58, v1
    v_add_u32 v2, s58, v2
    v_mfma_f32_16x16x32_bf16 v[80:83], a[212:215], a[164:167], v[80:83]
    v_mfma_f32_16x16x32_bf16 v[68:71], a[216:219], a[96:99], 0
    v_mfma_f32_16x16x32_bf16 v[68:71], a[220:223], a[100:103], v[68:71]
    v_max3_f32 v30, v128, v132, v136
    v_cmp_lt_f32 vcc, s37, v30
    v_mfma_f32_16x16x32_bf16 v[68:71], a[224:227], a[104:107], v[68:71]
    v_mfma_f32_16x16x32_bf16 v[68:71], a[228:231], a[108:111], v[68:71]
    s_waitcnt vmcnt(18)
    s_barrier
    v_mfma_f32_16x16x32_bf16 v[68:71], a[232:235], a[112:115], v[68:71]
    s_cbranch_vccnz L_rs_loop3w0b
L_ret_loop3w0b:
    s_add_u32 s38, s38, 1
    s_cmp_lt_u32 s38, 6
    v_mfma_f32_16x16x32_bf16 v[68:71], a[236:239], a[116:119], v[68:71]
    ds_read_b64_tr_b16 a[240:241], v3 offset:0
    ds_read_b64_tr_b16 a[242:243], v3 offset:6144
    v_mfma_f32_16x16x32_bf16 v[76:79], a[216:219], a[120:123], 0
    v_fma_f32 v64, v64, s36, v16
    v_fma_f32 v65, v65, s36, v16
    v_mfma_f32_16x16x32_bf16 v[76:79], a[220:223], a[124:127], v[76:79]
    ds_read_b64_tr_b16 a[244:245], v4 offset:0
    ds_read_b64_tr_b16 a[246:247], v4 offset:6144
    v_mfma_f32_16x16x32_bf16 v[76:79], a[224:227], a[128:131], v[76:79]
    ds_read_b64_tr_b16 a[248:249], v5 offset:0
    ds_read_b64_tr_b16 a[250:251], v5 offset:6144
    v_mfma_f32_16x16x32_bf16 v[76:79], a[228:231], a[132:135], v[76:79]
    v_fma_f32 v66, v66, s36, v16
    v_fma_f32 v67, v67, s36, v16
    v_mfma_f32_16x16x32_bf16 v[76:79], a[232:235], a[136:139], v[76:79]
    ds_read_b64_tr_b16 a[252:253], v6 offset:0
    ds_read_b64_tr_b16 a[254:255], v6 offset:6144
    v_mfma_f32_16x16x32_bf16 v[76:79], a[236:239], a[140:143], v[76:79]
    v_fma_f32 v72, v72, s36, v17
    v_fma_f32 v73, v73, s36, v17
    v_mfma_f32_16x16x32_bf16 v[84:87], a[216:219], a[144:147], 0
    v_exp_f32 v144, v64
    v_mfma_f32_16x16x32_bf16 v[84:87], a[220:223], a[148:151], v[84:87]
    v_exp_f32 v145, v65
    v_mfma_f32_16x16x32_bf16 v[84:87], a[224:227], a[152:155], v[84:87]
    v_exp_f32 v146, v66
    v_mfma_f32_16x16x32_bf16 v[84:87], a[228:231], a[156:159], v[84:87]
    v_exp_f32 v147, v67
    v_mfma_f32_16x16x32_bf16 v[84:87], a[232:235], a[160:163], v[84:87]
    v_exp_f32 v148, v72
    v_mfma_f32_16x16x32_bf16 v[84:87], a[236:239], a[164:167], v[84:87]
    v_exp_f32 v149, v73
    v_cvt_pk_bf16_f32 v112, v144, v145
    v_cvt_pk_bf16_f32 v113, v146, v147
    v_cvt_pk_bf16_f32 v116, v148, v149
    s_cbranch_scc1 L_loop3w0
    s_cmp_ge_u32 s69, 8
    s_cbranch_scc1 L_end3
    s_cmp_eq_u32 s40, 0
    s_cbranch_scc1 L_tr33
    s_branch L_tr34
    .p2align 6
L_loop3w1:
    s_waitcnt lgkmcnt(4)
    v_mfma_f32_16x16x32_bf16 v[160:163], a[240:243], v[96:99], v[160:163]
    s_add_u32 m0, s33, s31
    ds_read_b128 a[192:195], v1 offset:0
    ds_read_b128 a[196:199], v2 offset:0
    v_mfma_f32_16x16x32_bf16 v[208:211], a[240:243], v[100:103], v[208:211]
    ds_read_b128 a[200:203], v1 offset:1024
    ds_read_b128 a[204:207], v2 offset:1024
    v_mfma_f32_16x16x32_bf16 a[0:3], a[240:243], v[104:107], a[0:3]
    ds_read_b64_tr_b16 a[240:241], v3 offset:1024
    ds_read_b64_tr_b16 a[242:243], v3 offset:7168
    v_mfma_f32_16x16x32_bf16 v[164:167], a[244:247], v[96:99], v[164:167]
    buffer_load_dwordx4 v7, s[20:23], s28 offen offset:0 lds
    v_mfma_f32_16x16x32_bf16 v[212:215], a[244:247], v[100:103], v[212:215]
    ds_read_b128 a[208:211], v1 offset:2048
    ds_read_b128 a[212:215], v2 offset:2048
    v_mfma_f32_16x16x32_bf16 a[4:7], a[244:247], v[104:107], a[4:7]
    s_waitcnt lgkmcnt(8)
    ds_read_b64_tr_b16 a[244:245], v4 offset:1024
    ds_read_b64_tr_b16 a[246:247], v4 offset:7168
    v_mfma_f32_16x16x32_bf16 v[168:171], a[248:251], v[96:99], v[168:171]
    ds_read_b128 a[216:219], v1 offset:6144
    ds_read_b128 a[220:223], v2 offset:6144
    v_mfma_f32_16x16x32_bf16 v[216:219], a[248:251], v[100:103], v[216:219]
    ds_read_b128 a[224:227], v1 offset:7168
    ds_read_b128 a[228:231], v2 offset:7168
    v_mfma_f32_16x16x32_bf16 a[8:11], a[248:251], v[104:107], a[8:11]
    ds_read_b64_tr_b16 a[248:249], v5 offset:1024
    ds_read_b64_tr_b16 a[250:251], v5 offset:7168
    v_mfma_f32_16x16x32_bf16 v[172:175], a[252:255], v[96:99], v[172:175]
    ds_read_b128 a[232:235], v1 offset:8192
    ds_read_b128 a[236:239], v2 offset:8192
    v_mfma_f32_16x16x32_bf16 v[220:223], a[252:255], v[100:103], v[220:223]
    v_fma_f32 v68, v68, s36, v16
    v_fma_f32 v69, v69, s36, v16
    v_mfma_f32_16x16x32_bf16 a[12:15], a[252:255], v[104:107], a[12:15]
    s_waitcnt lgkmcnt(12)
    ds_read_b64_tr_b16 a[252:253], v6 offset:1024
    ds_read_b64_tr_b16 a[254:255], v6 offset:7168
    v_mfma_f32_16x16x32_bf16 v[176:179], a[240:243], v[96:99], v[176:179]
    buffer_load_dwordx4 v8, s[20:23], s28 offen offset:1024 lds
    v_mfma_f32_16x16x32_bf16 v[224:227], a[240:243], v[100:103], v[224:227]
    v_exp_f32 v150, v68
    v_mfma_f32_16x16x32_bf16 a[16:19], a[240:243], v[104:107], a[16:19]
    s_waitcnt lgkmcnt(8)
    ds_read_b64_tr_b16 a[240:241], v3 offset:2048
    ds_read_b64_tr_b16 a[242:243], v3 offset:8192
    v_mfma_f32_16x16x32_bf16 v[180:183], a[244:247], v[96:99], v[180:183]
    v_exp_f32 v151, v69
    v_mfma_f32_16x16x32_bf16 v[228:231], a[244:247], v[100:103], v[228:231]
    v_cvt_pk_bf16_f32 v114, v150, v151
    v_fma_f32 v70, v70, s36, v16
    v_mfma_f32_16x16x32_bf16 a[20:23], a[244:247], v[104:107], a[20:23]
    s_waitcnt lgkmcnt(4)
    ds_read_b64_tr_b16 a[244:245], v4 offset:2048
    ds_read_b64_tr_b16 a[246:247], v4 offset:8192
    v_mfma_f32_16x16x32_bf16 v[184:187], a[248:251], v[96:99], v[184:187]
    v_fma_f32 v71, v71, s36, v16
    v_fma_f32 v74, v74, s36, v17
    v_mfma_f32_16x16x32_bf16 v[232:235], a[248:251], v[100:103], v[232:235]
    v_fma_f32 v75, v75, s36, v17
    v_fma_f32 v76, v76, s36, v17
    v_mfma_f32_16x16x32_bf16 a[24:27], a[248:251], v[104:107], a[24:27]
    s_waitcnt lgkmcnt(4)
    ds_read_b64_tr_b16 a[248:249], v5 offset:2048
    ds_read_b64_tr_b16 a[250:251], v5 offset:8192
    v_mfma_f32_16x16x32_bf16 v[188:191], a[252:255], v[96:99], v[188:191]
    buffer_load_dwordx4 v9, s[20:23], s28 offen offset:2048 lds
    v_mfma_f32_16x16x32_bf16 v[236:239], a[252:255], v[100:103], v[236:239]
    s_add_u32 m0, s33, s32
    v_fma_f32 v77, v77, s36, v17
    v_fma_f32 v78, v78, s36, v17
    v_mfma_f32_16x16x32_bf16 a[28:31], a[252:255], v[104:107], a[28:31]
    s_waitcnt lgkmcnt(4)
    ds_read_b64_tr_b16 a[252:253], v6 offset:2048
    ds_read_b64_tr_b16 a[254:255], v6 offset:8192
    v_mfma_f32_16x16x32_bf16 v[192:195], a[240:243], v[96:99], v[192:195]
    v_fma_f32 v79, v79, s36, v17
    v_fma_f32 v80, v80, s36, v18
    v_mfma_f32_16x16x32_bf16 v[240:243], a[240:243], v[100:103], v[240:243]
    v_exp_f32 v144, v70
    v_mfma_f32_16x16x32_bf16 a[32:35], a[240:243], v[104:107], a[32:35]
    s_waitcnt lgkmcnt(4)
    v_exp_f32 v145, v71
    v_mfma_f32_16x16x32_bf16 v[196:199], a[244:247], v[96:99], v[196:199]
    v_exp_f32 v146, v74
    v_mfma_f32_16x16x32_bf16 v[244:247], a[244:247], v[100:103], v[244:247]
    v_exp_f32 v147, v75
    v_mfma_f32_16x16x32_bf16 a[36:39], a[244:247], v[104:107], a[36:39]
    s_waitcnt lgkmcnt(2)
    v_exp_f32 v148, v76
    v_mfma_f32_16x16x32_bf16 v[200:203], a[248:251], v[96:99], v[200:203]
    buffer_load_dwordx4 v10, s[24:27], s29 offen offset:0 lds
    v_mfma_f32_16x16x32_bf16 v[248:251], a[248:251], v[100:103], v[248:251]
    v_exp_f32 v149, v77
    v_mfma_f32_16x16x32_bf16 a[40:43], a[248:251], v[104:107], a[40:43]
    s_waitcnt lgkmcnt(0)
    v_exp_f32 v150, v78
    v_mfma_f32_16x16x32_bf16 v[204:207], a[252:255], v[96:99], v[204:207]
    v_exp_f32 v151, v79
    v_mfma_f32_16x16x32_bf16 v[252:255], a[252:255], v[100:103], v[252:255]
    v_cvt_pk_bf16_f32 v115, v144, v145
    v_cvt_pk_bf16_f32 v117, v146, v147
    v_mfma_f32_16x16x32_bf16 a[44:47], a[252:255], v[104:107], a[44:47]
    v_cvt_pk_bf16_f32 v118, v148, v149
    v_cvt_pk_bf16_f32 v119, v150, v151
    v_mfma_f32_16x16x32_bf16 v[32:35], a[192:195], a[96:99], 0
    v_fma_f32 v81, v81, s36, v18
    v_fma_f32 v82, v82, s36, v18
    v_mfma_f32_16x16x32_bf16 v[32:35], a[196:199], a[100:103], v[32:35]
    v_fma_f32 v83, v83, s36, v18
    v_fma_f32 v84, v84, s36, v18
    v_mfma_f32_16x16x32_bf16 v[32:35], a[200:203], a[104:107], v[32:35]
    v_fma_f32 v85, v85, s36, v18
    v_fma_f32 v86, v86, s36, v18
    v_mfma_f32_16x16x32_bf16 v[32:35], a[204:207], a[108:111], v[32:35]
    buffer_load_dwordx4 v11, s[24:27], s29 offen offset:1024 lds
    v_mfma_f32_16x16x32_bf16 v[32:35], a[208:211], a[112:115], v[32:35]
    v_fma_f32 v87, v87, s36, v18
    v_add_f32 v20, v20, v128
    v_mfma_f32_16x16x32_bf16 v[128:131], v[24:27], v[112:115], 0
    v_exp_f32 v144, v80
    v_mfma_f32_16x16x32_bf16 v[32:35], a[212:215], a[116:119], v[32:35]
    v_exp_f32 v145, v81
    v_mfma_f32_16x16x32_bf16 v[40:43], a[192:195], a[120:123], 0
    v_exp_f32 v146, v82
    v_mfma_f32_16x16x32_bf16 v[40:43], a[196:199], a[124:127], v[40:43]
    v_exp_f32 v147, v83
    v_mfma_f32_16x16x32_bf16 v[40:43], a[200:203], a[128:131], v[40:43]
    v_exp_f32 v148, v84
    v_mfma_f32_16x16x32_bf16 v[40:43], a[204:207], a[132:135], v[40:43]
    v_exp_f32 v149, v85
    v_mfma_f32_16x16x32_bf16 v[40:43], a[208:211], a[136:139], v[40:43]
    v_exp_f32 v150, v86
    v_mfma_f32_16x16x32_bf16 v[40:43], a[212:215], a[140:143], v[40:43]
    buffer_load_dwordx4 v12, s[24:27], s29 offen offset:2048 lds
    v_mfma_f32_16x16x32_bf16 v[48:51], a[192:195], a[144:147], 0
    s_add_u32 s28, s28, s30
    v_exp_f32 v151, v87
    v_mfma_f32_16x16x32_bf16 v[48:51], a[196:199], a[148:151], v[48:51]
    s_add_u32 s29, s29, s30
    v_cvt_pk_bf16_f32 v120, v144, v145
    v_cvt_pk_bf16_f32 v121, v146, v147
    v_mfma_f32_16x16x32_bf16 v[48:51], a[200:203], a[152:155], v[48:51]
    s_add_u32 s33, s33, 24576
    v_cvt_pk_bf16_f32 v122, v148, v149
    v_cvt_pk_bf16_f32 v123, v150, v151
    v_mfma_f32_16x16x32_bf16 v[48:51], a[204:207], a[156:159], v[48:51]
    s_cmp_eq_u32 s33, 147456
    v_add_f32 v21, v21, v132
    v_add_f32 v22, v22, v136
    v_mfma_f32_16x16x32_bf16 v[132:135], v[24:27], v[116:119], 0
    s_cselect_b32 s33, 0, s33
    v_mfma_f32_16x16x32_bf16 v[136:139], v[24:27], v[120:123], 0
    v_mfma_f32_16x16x32_bf16 v[48:51], a[208:211], a[160:163], v[48:51]
    s_waitcnt vmcnt(18)
    s_barrier
    v_mfma_f32_16x16x32_bf16 v[48:51], a[212:215], a[164:167], v[48:51]
    v_mfma_f32_16x16x32_bf16 v[36:39], a[216:219], a[96:99], 0
    v_mfma_f32_16x16x32_bf16 v[36:39], a[220:223], a[100:103], v[36:39]
    v_mfma_f32_16x16x32_bf16 v[36:39], a[224:227], a[104:107], v[36:39]
    v_mfma_f32_16x16x32_bf16 v[36:39], a[228:231], a[108:111], v[36:39]
    v_max3_f32 v30, v128, v132, v136
    v_cmp_lt_f32 vcc, s37, v30
    v_mfma_f32_16x16x32_bf16 v[36:39], a[232:235], a[112:115], v[36:39]
    v_mfma_f32_16x16x32_bf16 v[36:39], a[236:239], a[116:119], v[36:39]
    ds_read_b64_tr_b16 a[240:241], v3 offset:24576
    ds_read_b64_tr_b16 a[242:243], v3 offset:30720
    v_mfma_f32_16x16x32_bf16 v[44:47], a[216:219], a[120:123], 0
    s_cbranch_vccnz L_rs_loop3w1a
L_ret_loop3w1a:
    s_cmp_ge_u32 s38, 4
    s_cbranch_scc1 L_mode3w1
L_modeback3w1:
    v_mfma_f32_16x16x32_bf16 v[44:47], a[220:223], a[124:127], v[44:47]
    ds_read_b64_tr_b16 a[244:245], v4 offset:24576
    ds_read_b64_tr_b16 a[246:247], v4 offset:30720
    v_mfma_f32_16x16x32_bf16 v[44:47], a[224:227], a[128:131], v[44:47]
    ds_read_b64_tr_b16 a[248:249], v5 offset:24576
    ds_read_b64_tr_b16 a[250:251], v5 offset:30720
    v_mfma_f32_16x16x32_bf16 v[44:47], a[228:231], a[132:135], v[44:47]
    v_fma_f32 v32, v32, s36, v16
    v_fma_f32 v33, v33, s36, v16
    v_mfma_f32_16x16x32_bf16 v[44:47], a[232:235], a[136:139], v[44:47]
    ds_read_b64_tr_b16 a[252:253], v6 offset:24576
    ds_read_b64_tr_b16 a[254:255], v6 offset:30720
    v_mfma_f32_16x16x32_bf16 v[44:47], a[236:239], a[140:143], v[44:47]
    v_fma_f32 v34, v34, s36, v16
    v_fma_f32 v35, v35, s36, v16
    v_mfma_f32_16x16x32_bf16 v[52:55], a[216:219], a[144:147], 0
    v_fma_f32 v40, v40, s36, v17
    v_fma_f32 v41, v41, s36, v17
    v_mfma_f32_16x16x32_bf16 v[52:55], a[220:223], a[148:151], v[52:55]
    v_exp_f32 v144, v32
    v_mfma_f32_16x16x32_bf16 v[52:55], a[224:227], a[152:155], v[52:55]
    v_exp_f32 v145, v33
    v_mfma_f32_16x16x32_bf16 v[52:55], a[228:231], a[156:159], v[52:55]
    v_exp_f32 v146, v34
    v_mfma_f32_16x16x32_bf16 v[52:55], a[232:235], a[160:163], v[52:55]
    v_exp_f32 v147, v35
    v_mfma_f32_16x16x32_bf16 v[52:55], a[236:239], a[164:167], v[52:55]
    v_exp_f32 v148, v40
    v_exp_f32 v149, v41
    v_cvt_pk_bf16_f32 v96, v144, v145
    v_cvt_pk_bf16_f32 v97, v146, v147
    v_cvt_pk_bf16_f32 v100, v148, v149
    s_waitcnt lgkmcnt(1)
    v_mfma_f32_16x16x32_bf16 v[160:163], a[240:243], v[112:115], v[160:163]
    s_add_u32 s62, s34, 49152
    ds_read_b128 a[192:195], v1 offset:24576
    ds_read_b128 a[196:199], v2 offset:24576
    v_mfma_f32_16x16x32_bf16 v[208:211], a[240:243], v[116:119], v[208:211]
    s_cmp_eq_u32 s62, 147456
    ds_read_b128 a[200:203], v1 offset:25600
    ds_read_b128 a[204:207], v2 offset:25600
    v_mfma_f32_16x16x32_bf16 a[0:3], a[240:243], v[120:123], a[0:3]
    s_cselect_b32 s62, 0, s62
    ds_read_b64_tr_b16 a[240:241], v3 offset:25600
    ds_read_b64_tr_b16 a[242:243], v3 offset:31744
    v_mfma_f32_16x16x32_bf16 v[164:167], a[244:247], v[112:115], v[164:167]
    s_sub_u32 s58, s62, s34
    ds_read_b128 a[208:211], v1 offset:26624
    ds_read_b128 a[212:215], v2 offset:26624
    v_mfma_f32_16x16x32_bf16 v[212:215], a[244:247], v[116:119], v[212:215]
    s_mov_b32 s34, s62
    ds_read_b128 a[216:219], v1 offset:30720
    ds_read_b128 a[220:223], v2 offset:30720
    v_mfma_f32_16x16x32_bf16 a[4:7], a[244:247], v[120:123], a[4:7]
    s_add_u32 m0, s33, s31
    ds_read_b64_tr_b16 a[244:245], v4 offset:25600
    ds_read_b64_tr_b16 a[246:247], v4 offset:31744
    v_mfma_f32_16x16x32_bf16 v[168:171], a[248:251], v[112:115], v[168:171]
    buffer_load_dwordx4 v7, s[20:23], s28 offen offset:0 lds
    v_mfma_f32_16x16x32_bf16 v[216:219], a[248:251], v[116:119], v[216:219]
    ds_read_b128 a[224:227], v1 offset:31744
    ds_read_b128 a[228:231], v2 offset:31744
    v_mfma_f32_16x16x32_bf16 a[8:11], a[248:251], v[120:123], a[8:11]
    s_waitcnt lgkmcnt(13)
    ds_read_b64_tr_b16 a[248:249], v5 offset:25600
    ds_read_b64_tr_b16 a[250:251], v5 offset:31744
    v_mfma_f32_16x16x32_bf16 v[172:175], a[252:255], v[112:115], v[172:175]
    ds_read_b128 a[232:235], v1 offset:32768
    ds_read_b128 a[236:239], v2 offset:32768
    v_mfma_f32_16x16x32_bf16 v[220:223], a[252:255], v[116:119], v[220:223]
    v_fma_f32 v36, v36, s36, v16
    v_fma_f32 v37, v37, s36, v16
    v_mfma_f32_16x16x32_bf16 a[12:15], a[252:255], v[120:123], a[12:15]
    s_waitcnt lgkmcnt(10)
    ds_read_b64_tr_b16 a[252:253], v6 offset:25600
    ds_read_b64_tr_b16 a[254:255], v6 offset:31744
    v_mfma_f32_16x16x32_bf16 v[176:179], a[240:243], v[112:115], v[176:179]
    buffer_load_dwordx4 v8, s[20:23], s28 offen offset:1024 lds
    v_mfma_f32_16x16x32_bf16 v[224:227], a[240:243], v[116:119], v[224:227]
    v_exp_f32 v150, v36
    v_mfma_f32_16x16x32_bf16 a[16:19], a[240:243], v[120:123], a[16:19]
    s_waitcnt lgkmcnt(8)
    ds_read_b64_tr_b16 a[240:241], v3 offset:26624
    ds_read_b64_tr_b16 a[242:243], v3 offset:32768
    v_mfma_f32_16x16x32_bf16 v[180:183], a[244:247], v[112:115], v[180:183]
    v_exp_f32 v151, v37
    v_mfma_f32_16x16x32_bf16 v[228:231], a[244:247], v[116:119], v[228:231]
    v_cvt_pk_bf16_f32 v98, v150, v151
    v_fma_f32 v38, v38, s36, v16
    v_mfma_f32_16x16x32_bf16 a[20:23], a[244:247], v[120:123], a[20:23]
    s_waitcnt lgkmcnt(4)
    ds_read_b64_tr_b16 a[244:245], v4 offset:26624
    ds_read_b64_tr_b16 a[246:247], v4 offset:32768
    v_mfma_f32_16x16x32_bf16 v[184:187], a[248:251], v[112:115], v[184:187]
    v_fma_f32 v39, v39, s36, v16
    v_fma_f32 v42, v42, s36, v17
    v_mfma_f32_16x16x32_bf16 v[232:235], a[248:251], v[116:119], v[232:235]
    v_fma_f32 v43, v43, s36, v17
    v_fma_f32 v44, v44, s36, v17
    v_mfma_f32_16x16x32_bf16 a[24:27], a[248:251], v[120:123], a[24:27]
    s_waitcnt lgkmcnt(4)
    ds_read_b64_tr_b16 a[248:249], v5 offset:26624
    ds_read_b64_tr_b16 a[250:251], v5 offset:32768
    v_mfma_f32_16x16x32_bf16 v[188:191], a[252:255], v[112:115], v[188:191]
    buffer_load_dwordx4 v9, s[20:23], s28 offen offset:2048 lds
    v_mfma_f32_16x16x32_bf16 v[236:239], a[252:255], v[116:119], v[236:239]
    s_add_u32 m0, s33, s32
    v_fma_f32 v45, v45, s36, v17
    v_fma_f32 v46, v46, s36, v17
    v_mfma_f32_16x16x32_bf16 a[28:31], a[252:255], v[120:123], a[28:31]
    s_waitcnt lgkmcnt(4)
    ds_read_b64_tr_b16 a[252:253], v6 offset:26624
    ds_read_b64_tr_b16 a[254:255], v6 offset:32768
    v_mfma_f32_16x16x32_bf16 v[192:195], a[240:243], v[112:115], v[192:195]
    v_fma_f32 v47, v47, s36, v17
    v_fma_f32 v48, v48, s36, v18
    v_mfma_f32_16x16x32_bf16 v[240:243], a[240:243], v[116:119], v[240:243]
    v_exp_f32 v144, v38
    v_mfma_f32_16x16x32_bf16 a[32:35], a[240:243], v[120:123], a[32:35]
    s_waitcnt lgkmcnt(4)
    v_exp_f32 v145, v39
    v_mfma_f32_16x16x32_bf16 v[196:199], a[244:247], v[112:115], v[196:199]
    v_exp_f32 v146, v42
    v_mfma_f32_16x16x32_bf16 v[244:247], a[244:247], v[116:119], v[244:247]
    v_exp_f32 v147, v43
    v_mfma_f32_16x16x32_bf16 a[36:39], a[244:247], v[120:123], a[36:39]
    s_waitcnt lgkmcnt(2)
    v_exp_f32 v148, v44
    v_mfma_f32_16x16x32_bf16 v[200:203], a[248:251], v[112:115], v[200:203]
    buffer_load_dwordx4 v10, s[24:27], s29 offen offset:0 lds
    v_mfma_f32_16x16x32_bf16 v[248:251], a[248:251], v[116:119], v[248:251]
    v_exp_f32 v149, v45
    v_mfma_f32_16x16x32_bf16 a[40:43], a[248:251], v[120:123], a[40:43]
    s_waitcnt lgkmcnt(0)
    v_exp_f32 v150, v46
    v_mfma_f32_16x16x32_bf16 v[204:207], a[252:255], v[112:115], v[204:207]
    v_exp_f32 v151, v47
    v_mfma_f32_16x16x32_bf16 v[252:255], a[252:255], v[116:119], v[252:255]
    v_cvt_pk_bf16_f32 v99, v144, v145
    v_cvt_pk_bf16_f32 v101, v146, v147
    v_mfma_f32_16x16x32_bf16 a[44:47], a[252:255], v[120:123], a[44:47]
    v_cvt_pk_bf16_f32 v102, v148, v149
    v_cvt_pk_bf16_f32 v103, v150, v151
    v_mfma_f32_16x16x32_bf16 v[64:67], a[192:195], a[96:99], 0
    v_fma_f32 v49, v49, s36, v18
    v_fma_f32 v50, v50, s36, v18
    v_mfma_f32_16x16x32_bf16 v[64:67], a[196:199], a[100:103], v[64:67]
    v_fma_f32 v51, v51, s36, v18
    v_fma_f32 v52, v52, s36, v18
    v_mfma_f32_16x16x32_bf16 v[64:67], a[200:203], a[104:107], v[64:67]
    v_fma_f32 v53, v53, s36, v18
    v_fma_f32 v54, v54, s36, v18
    v_mfma_f32_16x16x32_bf16 v[64:67], a[204:207], a[108:111], v[64:67]
    buffer_load_dwordx4 v11, s[24:27], s29 offen offset:1024 lds
    v_mfma_f32_16x16x32_bf16 v[64:67], a[208:211], a[112:115], v[64:67]
    v_fma_f32 v55, v55, s36, v18
    v_add_f32 v20, v20, v128
    v_mfma_f32_16x16x32_bf16 v[128:131], v[24:27], v[96:99], 0
    v_exp_f32 v144, v48
    v_mfma_f32_16x16x32_bf16 v[64:67], a[212:215], a[116:119], v[64:67]
    v_exp_f32 v145, v49
    v_mfma_f32_16x16x32_bf16 v[72:75], a[192:195], a[120:123], 0
    v_exp_f32 v146, v50
    v_mfma_f32_16x16x32_bf16 v[72:75], a[196:199], a[124:127], v[72:75]
    v_exp_f32 v147, v51
    v_mfma_f32_16x16x32_bf16 v[72:75], a[200:203], a[128:131], v[72:75]
    v_exp_f32 v148, v52
    v_mfma_f32_16x16x32_bf16 v[72:75], a[204:207], a[132:135], v[72:75]
    v_exp_f32 v149, v53
    v_mfma_f32_16x16x32_bf16 v[72:75], a[208:211], a[136:139], v[72:75]
    v_exp_f32 v150, v54
    v_mfma_f32_16x16x32_bf16 v[72:75], a[212:215], a[140:143], v[72:75]
    buffer_load_dwordx4 v12, s[24:27], s29 offen offset:2048 lds
    v_mfma_f32_16x16x32_bf16 v[80:83], a[192:195], a[144:147], 0
    s_add_u32 s28, s28, s30
    v_exp_f32 v151, v55
    v_mfma_f32_16x16x32_bf16 v[80:83], a[196:199], a[148:151], v[80:83]
    s_add_u32 s29, s29, s30
    v_cvt_pk_bf16_f32 v104, v144, v145
    v_cvt_pk_bf16_f32 v105, v146, v147
    v_mfma_f32_16x16x32_bf16 v[80:83], a[200:203], a[152:155], v[80:83]
    s_add_u32 s33, s33, 24576
    v_cvt_pk_bf16_f32 v106, v148, v149
    v_cvt_pk_bf16_f32 v107, v150, v151
    v_mfma_f32_16x16x32_bf16 v[80:83], a[204:207], a[156:159], v[80:83]
    s_cmp_eq_u32 s33, 147456
    v_add_f32 v21, v21, v132
    v_add_f32 v22, v22, v136
    v_mfma_f32_16x16x32_bf16 v[132:135], v[24:27], v[100:103], 0
    s_cselect_b32 s33, 0, s33
    v_add_u32 v3, s58, v3
    v_add_u32 v4, s58, v4
    v_mfma_f32_16x16x32_bf16 v[136:139], v[24:27], v[104:107], 0
    v_add_u32 v5, s58, v5
    v_add_u32 v6, s58, v6
    v_mfma_f32_16x16x32_bf16 v[80:83], a[208:211], a[160:163], v[80:83]
    s_waitcnt vmcnt(18)
    s_barrier
    v_mfma_f32_16x16x32_bf16 v[80:83], a[212:215], a[164:167], v[80:83]
    v_add_u32 v1, s58, v1
    v_add_u32 v2, s58, v2
    v_max3_f32 v30, v128, v132, v136
    v_cmp_lt_f32 vcc, s37, v30
    v_mfma_f32_16x16x32_bf16 v[68:71], a[216:219], a[96:99], 0
    v_mfma_f32_16x16x32_bf16 v[68:71], a[220:223], a[100:103], v[68:71]
    v_mfma_f32_16x16x32_bf16 v[68:71], a[224:227], a[104:107], v[68:71]
    v_mfma_f32_16x16x32_bf16 v[68:71], a[228:231], a[108:111], v[68:71]
    v_mfma_f32_16x16x32_bf16 v[68:71], a[232:235], a[112:115], v[68:71]
    s_cbranch_vccnz L_rs_loop3w1b
L_ret_loop3w1b:
    s_add_u32 s38, s38, 1
    s_cmp_lt_u32 s38, 6
    v_mfma_f32_16x16x32_bf16 v[68:71], a[236:239], a[116:119], v[68:71]
    ds_read_b64_tr_b16 a[240:241], v3 offset:0
    ds_read_b64_tr_b16 a[242:243], v3 offset:6144
    v_mfma_f32_16x16x32_bf16 v[76:79], a[216:219], a[120:123], 0
    ds_read_b64_tr_b16 a[244:245], v4 offset:0
    ds_read_b64_tr_b16 a[246:247], v4 offset:6144
    v_mfma_f32_16x16x32_bf16 v[76:79], a[220:223], a[124:127], v[76:79]
    v_fma_f32 v64, v64, s36, v16
    v_fma_f32 v65, v65, s36, v16
    v_mfma_f32_16x16x32_bf16 v[76:79], a[224:227], a[128:131], v[76:79]
    ds_read_b64_tr_b16 a[248:249], v5 offset:0
    ds_read_b64_tr_b16 a[250:251], v5 offset:6144
    v_mfma_f32_16x16x32_bf16 v[76:79], a[228:231], a[132:135], v[76:79]
    ds_read_b64_tr_b16 a[252:253], v6 offset:0
    ds_read_b64_tr_b16 a[254:255], v6 offset:6144
    v_mfma_f32_16x16x32_bf16 v[76:79], a[232:235], a[136:139], v[76:79]
    v_fma_f32 v66, v66, s36, v16
    v_fma_f32 v67, v67, s36, v16
    v_mfma_f32_16x16x32_bf16 v[76:79], a[236:239], a[140:143], v[76:79]
    v_fma_f32 v72, v72, s36, v17
    v_fma_f32 v73, v73, s36, v17
    v_mfma_f32_16x16x32_bf16 v[84:87], a[216:219], a[144:147], 0
    v_exp_f32 v144, v64
    v_mfma_f32_16x16x32_bf16 v[84:87], a[220:223], a[148:151], v[84:87]
    v_exp_f32 v145, v65
    v_mfma_f32_16x16x32_bf16 v[84:87], a[224:227], a[152:155], v[84:87]
    v_exp_f32 v146, v66
    v_mfma_f32_16x16x32_bf16 v[84:87], a[228:231], a[156:159], v[84:87]
    v_exp_f32 v147, v67
    v_mfma_f32_16x16x32_bf16 v[84:87], a[232:235], a[160:163], v[84:87]
    v_exp_f32 v148, v72
    v_mfma_f32_16x16x32_bf16 v[84:87], a[236:239], a[164:167], v[84:87]
    v_exp_f32 v149, v73
    v_cvt_pk_bf16_f32 v112, v144, v145
    v_cvt_pk_bf16_f32 v113, v146, v147
    v_cvt_pk_bf16_f32 v116, v148, v149
    s_cbranch_scc1 L_loop3w1
    s_cmp_ge_u32 s69, 8
    s_cbranch_scc1 L_end3
    s_cmp_eq_u32 s40, 0
    s_cbranch_scc1 L_tr33
    s_branch L_tr34
L_tr34:
    s_waitcnt vmcnt(6)
    s_waitcnt lgkmcnt(4)
    v_mfma_f32_16x16x32_bf16 v[160:163], a[240:243], v[96:99], v[160:163]
    s_add_u32 s65, s34, 24576
    v_add_u32 v28, s35, v1
    v_add_u32 v29, s35, v2
    ds_read_b128 a[96:99], v28 offset:24576
    ds_read_b128 a[100:103], v29 offset:24576
    ds_read_b128 a[104:107], v28 offset:25600
    ds_read_b128 a[108:111], v29 offset:25600
    ds_read_b128 a[112:115], v28 offset:26624
    ds_read_b128 a[116:119], v29 offset:26624
    v_mfma_f32_16x16x32_bf16 v[208:211], a[240:243], v[100:103], v[208:211]
    s_add_u32 s62, s34, 49152
    v_xor_b32 v156, 80, v7
    v_xor_b32 v157, 80, v8
    v_mfma_f32_16x16x32_bf16 a[0:3], a[240:243], v[104:107], a[0:3]
    s_cmp_eq_u32 s62, 147456
    ds_read_b64_tr_b16 a[240:241], v3 offset:1024
    ds_read_b64_tr_b16 a[242:243], v3 offset:7168
    v_mfma_f32_16x16x32_bf16 v[164:167], a[244:247], v[96:99], v[164:167]
    s_cselect_b32 s62, 0, s62
    v_xor_b32 v158, 80, v9
    v_fma_f32 v68, v68, s36, v16
    v_mfma_f32_16x16x32_bf16 v[212:215], a[244:247], v[100:103], v[212:215]
    s_sub_u32 s56, s62, s34
    v_add_u32 v154, s56, v28
    v_add_u32 v155, s56, v29
    ds_read_b128 a[120:123], v154 offset:0
    ds_read_b128 a[124:127], v155 offset:0
    ds_read_b128 a[128:131], v154 offset:1024
    ds_read_b128 a[132:135], v155 offset:1024
    ds_read_b128 a[136:139], v154 offset:2048
    ds_read_b128 a[140:143], v155 offset:2048
    v_mfma_f32_16x16x32_bf16 a[4:7], a[244:247], v[104:107], a[4:7]
    s_mov_b32 s34, s62
    ds_read_b64_tr_b16 a[244:245], v4 offset:1024
    ds_read_b64_tr_b16 a[246:247], v4 offset:7168
    s_waitcnt lgkmcnt(15)
    v_mfma_f32_16x16x32_bf16 v[168:171], a[248:251], v[96:99], v[168:171]
    s_and_b32 s63, s3, 1
    v_fma_f32 v69, v69, s36, v16
    v_fma_f32 v70, v70, s36, v16
    v_mfma_f32_16x16x32_bf16 v[216:219], a[248:251], v[100:103], v[216:219]
    s_mul_i32 s63, s63, 3072
    v_exp_f32 v150, v68
    v_mfma_f32_16x16x32_bf16 a[8:11], a[248:251], v[104:107], a[8:11]
    s_add_u32 s67, s41, 12288
    ds_read_b64_tr_b16 a[248:249], v5 offset:1024
    ds_read_b64_tr_b16 a[250:251], v5 offset:7168
    v_mfma_f32_16x16x32_bf16 v[172:175], a[252:255], v[96:99], v[172:175]
    s_add_u32 s68, s67, s63
    v_exp_f32 v151, v69
    v_mfma_f32_16x16x32_bf16 v[220:223], a[252:255], v[100:103], v[220:223]
    s_add_u32 s64, s65, s35
    v_cvt_pk_bf16_f32 v114, v150, v151
    v_fma_f32 v71, v71, s36, v16
    v_mfma_f32_16x16x32_bf16 a[12:15], a[252:255], v[104:107], a[12:15]
    s_add_u32 s64, s64, 0
    ds_read_b64_tr_b16 a[252:253], v6 offset:1024
    ds_read_b64_tr_b16 a[254:255], v6 offset:7168
    s_waitcnt lgkmcnt(11)
    v_mfma_f32_16x16x32_bf16 v[176:179], a[240:243], v[96:99], v[176:179]
    s_add_u32 m0, s64, s63
    v_fma_f32 v74, v74, s36, v17
    v_fma_f32 v75, v75, s36, v17
    v_mfma_f32_16x16x32_bf16 v[224:227], a[240:243], v[100:103], v[224:227]
    buffer_load_dwordx4 v7, s[12:15], s68 offen offset:0 nt lds
    v_mfma_f32_16x16x32_bf16 a[16:19], a[240:243], v[104:107], a[16:19]
    buffer_load_dwordx4 v8, s[12:15], s68 offen offset:1024 nt lds
    s_waitcnt lgkmcnt(4)
    v_mfma_f32_16x16x32_bf16 v[180:183], a[244:247], v[96:99], v[180:183]
    buffer_load_dwordx4 v9, s[12:15], s68 offen offset:2048 nt lds
    v_mfma_f32_16x16x32_bf16 v[228:231], a[244:247], v[100:103], v[228:231]
    s_sub_u32 s63, 3072, s63
    ds_read_b64_tr_b16 a[240:241], v3 offset:2048
    ds_read_b64_tr_b16 a[242:243], v3 offset:8192
    v_mfma_f32_16x16x32_bf16 a[20:23], a[244:247], v[104:107], a[20:23]
    s_add_u32 s68, s67, s63
    ds_read_b64_tr_b16 a[244:245], v4 offset:2048
    ds_read_b64_tr_b16 a[246:247], v4 offset:8192
    s_waitcnt lgkmcnt(6)
    v_mfma_f32_16x16x32_bf16 v[184:187], a[248:251], v[96:99], v[184:187]
    s_add_u32 m0, s64, s63
    v_fma_f32 v76, v76, s36, v17
    v_fma_f32 v77, v77, s36, v17
    v_mfma_f32_16x16x32_bf16 v[232:235], a[248:251], v[100:103], v[232:235]
    buffer_load_dwordx4 v156, s[12:15], s68 offen offset:0 nt lds
    v_mfma_f32_16x16x32_bf16 a[24:27], a[248:251], v[104:107], a[24:27]
    buffer_load_dwordx4 v157, s[12:15], s68 offen offset:1024 nt lds
    s_waitcnt lgkmcnt(4)
    v_mfma_f32_16x16x32_bf16 v[188:191], a[252:255], v[96:99], v[188:191]
    buffer_load_dwordx4 v158, s[12:15], s68 offen offset:2048 nt lds
    s_and_b32 s63, s3, 1
    s_mul_i32 s63, s63, 3072
    v_mfma_f32_16x16x32_bf16 v[236:239], a[252:255], v[100:103], v[236:239]
    s_add_u32 s67, s41, 18432
    ds_read_b64_tr_b16 a[248:249], v5 offset:2048
    ds_read_b64_tr_b16 a[250:251], v5 offset:8192
    v_mfma_f32_16x16x32_bf16 a[28:31], a[252:255], v[104:107], a[28:31]
    s_add_u32 s68, s67, s63
    ds_read_b64_tr_b16 a[252:253], v6 offset:2048
    ds_read_b64_tr_b16 a[254:255], v6 offset:8192
    s_add_u32 s64, s34, s35
    s_add_u32 s64, s64, 0
    v_fma_f32 v78, v78, s36, v17
    s_waitcnt lgkmcnt(6)
    v_mfma_f32_16x16x32_bf16 v[192:195], a[240:243], v[96:99], v[192:195]
    s_add_u32 m0, s64, s63
    v_fma_f32 v79, v79, s36, v17
    v_fma_f32 v80, v80, s36, v18
    v_mfma_f32_16x16x32_bf16 v[240:243], a[240:243], v[100:103], v[240:243]
    buffer_load_dwordx4 v7, s[12:15], s68 offen offset:0 nt lds
    v_mfma_f32_16x16x32_bf16 a[32:35], a[240:243], v[104:107], a[32:35]
    buffer_load_dwordx4 v8, s[12:15], s68 offen offset:1024 nt lds
    s_waitcnt lgkmcnt(4)
    v_mfma_f32_16x16x32_bf16 v[196:199], a[244:247], v[96:99], v[196:199]
    buffer_load_dwordx4 v9, s[12:15], s68 offen offset:2048 nt lds
    s_sub_u32 s63, 3072, s63
    s_add_u32 s68, s67, s63
    v_mfma_f32_16x16x32_bf16 v[244:247], a[244:247], v[100:103], v[244:247]
    s_add_u32 m0, s64, s63
    v_exp_f32 v144, v70
    v_mfma_f32_16x16x32_bf16 a[36:39], a[244:247], v[104:107], a[36:39]
    buffer_load_dwordx4 v156, s[12:15], s68 offen offset:0 nt lds
    s_waitcnt lgkmcnt(2)
    v_mfma_f32_16x16x32_bf16 v[200:203], a[248:251], v[96:99], v[200:203]
    buffer_load_dwordx4 v157, s[12:15], s68 offen offset:1024 nt lds
    v_mfma_f32_16x16x32_bf16 v[248:251], a[248:251], v[100:103], v[248:251]
    buffer_load_dwordx4 v158, s[12:15], s68 offen offset:2048 nt lds
    s_add_u32 m0, s33, s31
    v_mfma_f32_16x16x32_bf16 a[40:43], a[248:251], v[104:107], a[40:43]
    buffer_load_dwordx4 v7, s[20:23], s28 offen offset:0 lds
    s_waitcnt lgkmcnt(0)
    v_mfma_f32_16x16x32_bf16 v[204:207], a[252:255], v[96:99], v[204:207]
    buffer_load_dwordx4 v8, s[20:23], s28 offen offset:1024 lds
    v_mfma_f32_16x16x32_bf16 v[252:255], a[252:255], v[100:103], v[252:255]
    buffer_load_dwordx4 v9, s[20:23], s28 offen offset:2048 lds
    s_add_u32 m0, s33, s32
    v_mfma_f32_16x16x32_bf16 a[44:47], a[252:255], v[104:107], a[44:47]
    buffer_load_dwordx4 v10, s[24:27], s29 offen offset:0 lds
    buffer_load_dwordx4 v11, s[24:27], s29 offen offset:1024 lds
    v_exp_f32 v145, v71
    v_exp_f32 v146, v74
    v_exp_f32 v147, v75
    v_exp_f32 v148, v76
    v_exp_f32 v149, v77
    v_exp_f32 v150, v78
    v_exp_f32 v151, v79
    v_cvt_pk_bf16_f32 v115, v144, v145
    v_cvt_pk_bf16_f32 v117, v146, v147
    v_cvt_pk_bf16_f32 v118, v148, v149
    v_cvt_pk_bf16_f32 v119, v150, v151
    v_fma_f32 v81, v81, s36, v18
    v_fma_f32 v82, v82, s36, v18
    v_fma_f32 v83, v83, s36, v18
    v_fma_f32 v84, v84, s36, v18
    v_fma_f32 v85, v85, s36, v18
    v_fma_f32 v86, v86, s36, v18
    v_fma_f32 v87, v87, s36, v18
    v_exp_f32 v144, v80
    v_exp_f32 v145, v81
    v_exp_f32 v146, v82
    v_exp_f32 v147, v83
    v_exp_f32 v148, v84
    v_exp_f32 v149, v85
    v_exp_f32 v150, v86
    v_exp_f32 v151, v87
    v_cvt_pk_bf16_f32 v120, v144, v145
    v_cvt_pk_bf16_f32 v121, v146, v147
    v_cvt_pk_bf16_f32 v122, v148, v149
    v_cvt_pk_bf16_f32 v123, v150, v151
    v_add_f32 v20, v20, v128
    v_mfma_f32_16x16x32_bf16 v[128:131], v[24:27], v[112:115], 0
    buffer_load_dwordx4 v12, s[24:27], s29 offen offset:2048 lds
    s_waitcnt vmcnt(18)
    s_barrier
    v_add_f32 v21, v21, v132
    v_mfma_f32_16x16x32_bf16 v[132:135], v[24:27], v[116:119], 0
    v_add_f32 v22, v22, v136
    s_add_u32 s28, s28, s30
    v_mfma_f32_16x16x32_bf16 v[136:139], v[24:27], v[120:123], 0
    s_add_u32 s29, s29, s30
    s_add_u32 s33, s33, 24576
    s_cmp_eq_u32 s33, 147456
    v_add_u32 v3, s56, v3
    v_add_u32 v4, s56, v4
    v_add_u32 v5, s56, v5
    v_add_u32 v6, s56, v6
    s_cselect_b32 s33, 0, s33
    v_max3_f32 v30, v128, v132, v136
    v_cmp_lt_f32 vcc, s37, v30
    ds_read_b64_tr_b16 a[240:241], v3 offset:24576
    ds_read_b64_tr_b16 a[242:243], v3 offset:30720
    ds_read_b64_tr_b16 a[244:245], v4 offset:24576
    ds_read_b64_tr_b16 a[246:247], v4 offset:30720
    ds_read_b64_tr_b16 a[248:249], v5 offset:24576
    s_cbranch_vccnz L_rs_tr34A
L_ret_tr34A:
    ds_read_b64_tr_b16 a[250:251], v5 offset:30720
    ds_read_b64_tr_b16 a[252:253], v6 offset:24576
    ds_read_b64_tr_b16 a[254:255], v6 offset:30720
    s_add_u32 s84, s42, 0
    s_add_u32 s85, s42, 6144
    s_add_u32 s86, s42, 12288
    s_waitcnt lgkmcnt(6)
    v_mfma_f32_16x16x32_bf16 v[160:163], a[240:243], v[112:115], v[160:163]
    s_add_u32 m0, s33, s31
    v_add_f32 v20, v20, v128
    v_add_f32 v21, v21, v132
    v_mfma_f32_16x16x32_bf16 v[208:211], a[240:243], v[116:119], v[208:211]
    v_rcp_f32 v130, v20
    v_mov_b32 v96, v15
    v_mfma_f32_16x16x32_bf16 a[0:3], a[240:243], v[120:123], a[0:3]
    s_waitcnt lgkmcnt(4)
    ds_read_b64_tr_b16 a[240:241], v3 offset:25600
    ds_read_b64_tr_b16 a[242:243], v3 offset:31744
    v_rcp_f32 v134, v21
    v_mfma_f32_16x16x32_bf16 v[164:167], a[244:247], v[112:115], v[164:167]
    v_mul_f32 v160, v160, v130
    v_mul_f32 v161, v161, v130
    v_mul_f32 v162, v162, v130
    v_mul_f32 v163, v163, v130
    v_mfma_f32_16x16x32_bf16 v[212:215], a[244:247], v[116:119], v[212:215]
    v_mul_f32 v208, v208, v134
    v_mul_f32 v209, v209, v134
    v_mul_f32 v210, v210, v134
    v_mul_f32 v211, v211, v134
    v_mfma_f32_16x16x32_bf16 a[4:7], a[244:247], v[120:123], a[4:7]
    ds_read_b64_tr_b16 a[244:245], v4 offset:25600
    ds_read_b64_tr_b16 a[246:247], v4 offset:31744
    v_cvt_pk_bf16_f32 v80, v160, v161
    v_cvt_pk_bf16_f32 v81, v162, v163
    s_waitcnt lgkmcnt(4)
    v_mfma_f32_16x16x32_bf16 v[168:171], a[248:251], v[112:115], v[168:171]
    v_cvt_pk_bf16_f32 v82, v208, v209
    v_cvt_pk_bf16_f32 v83, v210, v211
    v_mul_f32 v164, v164, v130
    v_mul_f32 v165, v165, v130
    v_mfma_f32_16x16x32_bf16 v[216:219], a[248:251], v[116:119], v[216:219]
    v_mul_f32 v166, v166, v130
    v_mul_f32 v167, v167, v130
    v_mul_f32 v212, v212, v134
    v_mul_f32 v213, v213, v134
    v_mfma_f32_16x16x32_bf16 a[8:11], a[248:251], v[120:123], a[8:11]
    ds_read_b64_tr_b16 a[248:249], v5 offset:25600
    ds_read_b64_tr_b16 a[250:251], v5 offset:31744
    v_mul_f32 v214, v214, v134
    v_mul_f32 v215, v215, v134
    v_mfma_f32_16x16x32_bf16 v[172:175], a[252:255], v[112:115], v[172:175]
    v_xor_b32 v97, 32, v15
    v_cvt_pk_bf16_f32 v84, v164, v165
    v_cvt_pk_bf16_f32 v85, v166, v167
    v_cvt_pk_bf16_f32 v86, v212, v213
    v_mfma_f32_16x16x32_bf16 v[220:223], a[252:255], v[116:119], v[220:223]
    v_cvt_pk_bf16_f32 v87, v214, v215
    v_mul_f32 v168, v168, v130
    v_mul_f32 v169, v169, v130
    v_mul_f32 v170, v170, v130
    v_mfma_f32_16x16x32_bf16 a[12:15], a[252:255], v[120:123], a[12:15]
    ds_read_b64_tr_b16 a[252:253], v6 offset:25600
    ds_read_b64_tr_b16 a[254:255], v6 offset:31744
    v_mul_f32 v171, v171, v130
    v_mul_f32 v216, v216, v134
    s_waitcnt lgkmcnt(4)
    v_mfma_f32_16x16x32_bf16 v[176:179], a[240:243], v[112:115], v[176:179]
    buffer_load_dwordx4 v7, s[20:23], s28 offen offset:0 lds
    s_waitcnt vmcnt(7)
    ds_read_b128 a[168:171], v154 offset:0
    ds_read_b128 a[172:175], v155 offset:0
    ds_read_b128 a[176:179], v154 offset:1024
    ds_read_b128 a[180:183], v155 offset:1024
    ds_read_b128 a[184:187], v154 offset:2048
    ds_read_b128 a[188:191], v155 offset:2048
    ds_read_b128 a[144:147], v28 offset:24576
    ds_read_b128 a[148:151], v29 offset:24576
    ds_read_b128 a[152:155], v28 offset:25600
    ds_read_b128 a[156:159], v29 offset:25600
    ds_read_b128 a[160:163], v28 offset:26624
    ds_read_b128 a[164:167], v29 offset:26624
    v_mfma_f32_16x16x32_bf16 v[224:227], a[240:243], v[116:119], v[224:227]
    v_mul_f32 v217, v217, v134
    v_mul_f32 v218, v218, v134
    v_mfma_f32_16x16x32_bf16 a[16:19], a[240:243], v[120:123], a[16:19]
    ds_read_b64_tr_b16 a[240:241], v3 offset:26624
    ds_read_b64_tr_b16 a[242:243], v3 offset:32768
    v_mfma_f32_16x16x32_bf16 v[180:183], a[244:247], v[112:115], v[180:183]
    buffer_load_dwordx4 v8, s[20:23], s28 offen offset:1024 lds
    v_mfma_f32_16x16x32_bf16 v[228:231], a[244:247], v[116:119], v[228:231]
    v_mul_f32 v219, v219, v134
    v_xor_b32 v98, 64, v15
    v_mfma_f32_16x16x32_bf16 a[20:23], a[244:247], v[120:123], a[20:23]
    s_waitcnt lgkmcnt(13)
    ds_read_b64_tr_b16 a[244:245], v4 offset:26624
    ds_read_b64_tr_b16 a[246:247], v4 offset:32768
    v_mfma_f32_16x16x32_bf16 v[184:187], a[248:251], v[112:115], v[184:187]
    v_cvt_pk_bf16_f32 v88, v168, v169
    v_cvt_pk_bf16_f32 v89, v170, v171
    ds_read_b128 a[192:195], v1 offset:0
    v_mfma_f32_16x16x32_bf16 v[232:235], a[248:251], v[116:119], v[232:235]
    v_cvt_pk_bf16_f32 v90, v216, v217
    v_cvt_pk_bf16_f32 v91, v218, v219
    ds_read_b128 a[196:199], v2 offset:0
    v_mfma_f32_16x16x32_bf16 a[24:27], a[248:251], v[120:123], a[24:27]
    buffer_load_dwordx4 v9, s[20:23], s28 offen offset:2048 lds
    ds_read_b64_tr_b16 a[248:249], v5 offset:26624
    ds_read_b64_tr_b16 a[250:251], v5 offset:32768
    ds_read_b128 a[200:203], v1 offset:1024
    ds_read_b128 a[204:207], v2 offset:1024
    v_mfma_f32_16x16x32_bf16 v[188:191], a[252:255], v[112:115], v[188:191]
    s_add_u32 m0, s33, s32
    v_mul_f32 v172, v172, v130
    v_mul_f32 v173, v173, v130
    ds_read_b128 a[208:211], v1 offset:2048
    v_mfma_f32_16x16x32_bf16 v[236:239], a[252:255], v[116:119], v[236:239]
    v_mul_f32 v174, v174, v130
    v_mul_f32 v175, v175, v130
    ds_read_b128 a[212:215], v2 offset:2048
    v_mfma_f32_16x16x32_bf16 a[28:31], a[252:255], v[120:123], a[28:31]
    buffer_load_dwordx4 v10, s[24:27], s29 offen offset:0 lds
    ds_read_b64_tr_b16 a[252:253], v6 offset:26624
    ds_read_b64_tr_b16 a[254:255], v6 offset:32768
    ds_read_b128 a[216:219], v1 offset:6144
    ds_read_b128 a[220:223], v2 offset:6144
    s_waitcnt lgkmcnt(11)
    v_mfma_f32_16x16x32_bf16 v[192:195], a[240:243], v[112:115], v[192:195]
    v_mul_f32 v220, v220, v134
    v_mul_f32 v221, v221, v134
    ds_read_b128 a[224:227], v1 offset:7168
    v_mfma_f32_16x16x32_bf16 v[240:243], a[240:243], v[116:119], v[240:243]
    v_mul_f32 v222, v222, v134
    v_mul_f32 v223, v223, v134
    ds_read_b128 a[228:231], v2 offset:7168
    v_mfma_f32_16x16x32_bf16 a[32:35], a[240:243], v[120:123], a[32:35]
    buffer_load_dwordx4 v11, s[24:27], s29 offen offset:1024 lds
    ds_read_b128 a[232:235], v1 offset:8192
    v_mfma_f32_16x16x32_bf16 v[196:199], a[244:247], v[112:115], v[196:199]
    ds_read_b128 a[236:239], v2 offset:8192
    v_mfma_f32_16x16x32_bf16 v[244:247], a[244:247], v[116:119], v[244:247]
    v_xor_b32 v99, 96, v15
    v_cvt_pk_bf16_f32 v92, v172, v173
    v_mfma_f32_16x16x32_bf16 a[36:39], a[244:247], v[120:123], a[36:39]
    s_waitcnt lgkmcnt(5)
    v_cvt_pk_bf16_f32 v93, v174, v175
    v_cvt_pk_bf16_f32 v94, v220, v221
    v_mfma_f32_16x16x32_bf16 v[200:203], a[248:251], v[112:115], v[200:203]
    v_cvt_pk_bf16_f32 v95, v222, v223
    v_add_f32 v22, v22, v136
    v_mfma_f32_16x16x32_bf16 v[248:251], a[248:251], v[116:119], v[248:251]
    v_rcp_f32 v138, v22
    v_mfma_f32_16x16x32_bf16 a[40:43], a[248:251], v[120:123], a[40:43]
    buffer_load_dwordx4 v12, s[24:27], s29 offen offset:2048 lds
    v_mfma_f32_16x16x32_bf16 v[204:207], a[252:255], v[112:115], v[204:207]
    s_add_u32 s28, s28, s30
    v_accvgpr_read_b32 v64, a0
    v_accvgpr_read_b32 v65, a1
    v_mfma_f32_16x16x32_bf16 v[252:255], a[252:255], v[116:119], v[252:255]
    s_add_u32 s29, s29, s30
    v_accvgpr_read_b32 v66, a2
    v_accvgpr_read_b32 v67, a3
    v_mfma_f32_16x16x32_bf16 a[44:47], a[252:255], v[120:123], a[44:47]
    s_add_u32 s33, s33, 24576
    v_mul_f32 v64, v64, v138
    v_mul_f32 v65, v65, v138
    v_mfma_f32_16x16x32_bf16 v[32:35], a[192:195], a[96:99], 0
    s_cmp_eq_u32 s33, 147456
    v_mul_f32 v66, v66, v138
    v_mul_f32 v67, v67, v138
    v_mul_f32 v176, v176, v130
    v_mul_f32 v177, v177, v130
    v_mfma_f32_16x16x32_bf16 v[32:35], a[196:199], a[100:103], v[32:35]
    s_cselect_b32 s33, 0, s33
    v_mul_f32 v178, v178, v130
    v_mul_f32 v179, v179, v130
    v_accvgpr_read_b32 v68, a4
    v_accvgpr_read_b32 v69, a5
    v_mfma_f32_16x16x32_bf16 v[32:35], a[200:203], a[104:107], v[32:35]
    s_add_u32 s62, s34, 49152
    v_accvgpr_read_b32 v70, a6
    v_accvgpr_read_b32 v71, a7
    v_mul_f32 v68, v68, v138
    v_mul_f32 v69, v69, v138
    v_mfma_f32_16x16x32_bf16 v[32:35], a[204:207], a[108:111], v[32:35]
    s_cmp_eq_u32 s62, 147456
    v_mul_f32 v70, v70, v138
    v_mul_f32 v71, v71, v138
    v_mul_f32 v180, v180, v130
    v_mul_f32 v181, v181, v130
    v_mfma_f32_16x16x32_bf16 v[32:35], a[208:211], a[112:115], v[32:35]
    s_cselect_b32 s62, 0, s62
    v_mul_f32 v182, v182, v130
    v_mul_f32 v183, v183, v130
    v_accvgpr_read_b32 v72, a8
    v_accvgpr_read_b32 v73, a9
    v_mfma_f32_16x16x32_bf16 v[32:35], a[212:215], a[116:119], v[32:35]
    s_sub_u32 s57, s62, s34
    v_accvgpr_read_b32 v74, a10
    v_accvgpr_read_b32 v75, a11
    v_mul_f32 v72, v72, v138
    v_mul_f32 v73, v73, v138
    v_mfma_f32_16x16x32_bf16 v[36:39], a[216:219], a[96:99], 0
    s_mov_b32 s34, s62
    v_mul_f32 v74, v74, v138
    v_mul_f32 v75, v75, v138
    v_mul_f32 v184, v184, v130
    v_mul_f32 v185, v185, v130
    s_waitcnt lgkmcnt(0)
    v_mfma_f32_16x16x32_bf16 v[36:39], a[220:223], a[100:103], v[36:39]
    v_mul_f32 v186, v186, v130
    v_mul_f32 v187, v187, v130
    v_accvgpr_read_b32 v76, a12
    v_accvgpr_read_b32 v77, a13
    v_mfma_f32_16x16x32_bf16 v[36:39], a[224:227], a[104:107], v[36:39]
    v_accvgpr_read_b32 v78, a14
    v_accvgpr_read_b32 v79, a15
    v_mul_f32 v76, v76, v138
    v_mul_f32 v77, v77, v138
    v_mfma_f32_16x16x32_bf16 v[36:39], a[228:231], a[108:111], v[36:39]
    v_mul_f32 v78, v78, v138
    v_mul_f32 v79, v79, v138
    v_mul_f32 v188, v188, v130
    v_mul_f32 v189, v189, v130
    v_mfma_f32_16x16x32_bf16 v[36:39], a[232:235], a[112:115], v[36:39]
    v_mul_f32 v190, v190, v130
    v_mul_f32 v191, v191, v130
    v_add_u32 v3, s57, v3
    v_add_u32 v4, s57, v4
    v_mfma_f32_16x16x32_bf16 v[36:39], a[236:239], a[116:119], v[36:39]
    v_add_u32 v5, s57, v5
    v_add_u32 v6, s57, v6
    v_add_u32 v1, s56, v1
    v_add_u32 v2, s56, v2
    v_mfma_f32_16x16x32_bf16 v[40:43], a[192:195], a[120:123], 0
    ds_write2st64_b64 v96, v[80:81], v[82:83] offset0:0 offset1:4
    v_mfma_f32_16x16x32_bf16 v[40:43], a[196:199], a[124:127], v[40:43]
    v_cvt_pk_bf16_f32 v80, v64, v65
    v_cvt_pk_bf16_f32 v81, v66, v67
    v_cvt_pk_bf16_f32 v82, v176, v177
    v_mfma_f32_16x16x32_bf16 v[40:43], a[200:203], a[128:131], v[40:43]
    v_cvt_pk_bf16_f32 v83, v178, v179
    v_accvgpr_read_b32 v64, a16
    v_accvgpr_read_b32 v65, a17
    v_accvgpr_read_b32 v66, a18
    v_mfma_f32_16x16x32_bf16 v[40:43], a[204:207], a[132:135], v[40:43]
    v_accvgpr_read_b32 v67, a19
    v_mfma_f32_16x16x32_bf16 v[40:43], a[208:211], a[136:139], v[40:43]
    ds_write2st64_b64 v97, v[84:85], v[86:87] offset0:0 offset1:4
    v_mfma_f32_16x16x32_bf16 v[40:43], a[212:215], a[140:143], v[40:43]
    v_cvt_pk_bf16_f32 v84, v68, v69
    v_cvt_pk_bf16_f32 v85, v70, v71
    v_cvt_pk_bf16_f32 v86, v180, v181
    v_mfma_f32_16x16x32_bf16 v[44:47], a[216:219], a[120:123], 0
    v_cvt_pk_bf16_f32 v87, v182, v183
    v_accvgpr_read_b32 v68, a20
    v_accvgpr_read_b32 v69, a21
    v_accvgpr_read_b32 v70, a22
    v_mfma_f32_16x16x32_bf16 v[44:47], a[220:223], a[124:127], v[44:47]
    v_accvgpr_read_b32 v71, a23
    v_mfma_f32_16x16x32_bf16 v[44:47], a[224:227], a[128:131], v[44:47]
    ds_write2st64_b64 v98, v[88:89], v[90:91] offset0:0 offset1:4
    v_mfma_f32_16x16x32_bf16 v[44:47], a[228:231], a[132:135], v[44:47]
    v_cvt_pk_bf16_f32 v88, v72, v73
    v_cvt_pk_bf16_f32 v89, v74, v75
    v_cvt_pk_bf16_f32 v90, v184, v185
    v_mfma_f32_16x16x32_bf16 v[44:47], a[232:235], a[136:139], v[44:47]
    v_cvt_pk_bf16_f32 v91, v186, v187
    v_accvgpr_read_b32 v72, a24
    v_accvgpr_read_b32 v73, a25
    v_accvgpr_read_b32 v74, a26
    v_mfma_f32_16x16x32_bf16 v[44:47], a[236:239], a[140:143], v[44:47]
    v_accvgpr_read_b32 v75, a27
    v_mfma_f32_16x16x32_bf16 v[48:51], a[192:195], a[144:147], 0
    ds_write2st64_b64 v99, v[92:93], v[94:95] offset0:0 offset1:4
    v_mfma_f32_16x16x32_bf16 v[48:51], a[196:199], a[148:151], v[48:51]
    ds_read_b128 v[144:147], v14 offset:0
    ds_read_b128 v[148:151], v14 offset:1024
    ds_read_b128 v[152:155], v14 offset:2048
    ds_read_b128 v[156:159], v14 offset:3072
    v_mfma_f32_16x16x32_bf16 v[48:51], a[200:203], a[152:155], v[48:51]
    v_cvt_pk_bf16_f32 v92, v76, v77
    v_cvt_pk_bf16_f32 v93, v78, v79
    v_cvt_pk_bf16_f32 v94, v188, v189
    v_mfma_f32_16x16x32_bf16 v[48:51], a[204:207], a[156:159], v[48:51]
    v_cvt_pk_bf16_f32 v95, v190, v191
    v_accvgpr_read_b32 v76, a28
    v_accvgpr_read_b32 v77, a29
    v_accvgpr_read_b32 v78, a30
    v_mfma_f32_16x16x32_bf16 v[48:51], a[208:211], a[160:163], v[48:51]
    v_accvgpr_read_b32 v79, a31
    v_mfma_f32_16x16x32_bf16 v[48:51], a[212:215], a[164:167], v[48:51]
    ds_write2st64_b64 v96, v[80:81], v[82:83] offset0:0 offset1:4
    v_mfma_f32_16x16x32_bf16 v[52:55], a[216:219], a[144:147], 0
    ds_write2st64_b64 v97, v[84:85], v[86:87] offset0:0 offset1:4
    v_mfma_f32_16x16x32_bf16 v[52:55], a[220:223], a[148:151], v[52:55]
    s_waitcnt lgkmcnt(5)
    buffer_store_dwordx4 v[144:147], v13, s[16:19], s84 offen offset:0 nt
    v_mfma_f32_16x16x32_bf16 v[52:55], a[224:227], a[152:155], v[52:55]
    ds_write2st64_b64 v98, v[88:89], v[90:91] offset0:0 offset1:4
    v_mfma_f32_16x16x32_bf16 v[52:55], a[228:231], a[156:159], v[52:55]
    ds_write2st64_b64 v99, v[92:93], v[94:95] offset0:0 offset1:4
    v_mfma_f32_16x16x32_bf16 v[52:55], a[232:235], a[160:163], v[52:55]
    s_waitcnt lgkmcnt(4)
    buffer_store_dwordx4 v[148:151], v13, s[16:19], s84 offen offset:3072 nt
    ds_read_b128 v[144:147], v14 offset:0
    ds_read_b128 v[148:151], v14 offset:1024
    v_mfma_f32_16x16x32_bf16 v[52:55], a[236:239], a[164:167], v[52:55]
    v_mfma_f32_16x16x32_bf16 v[56:59], a[192:195], a[168:171], 0
    v_mfma_f32_16x16x32_bf16 v[56:59], a[196:199], a[172:175], v[56:59]
    buffer_store_dwordx4 v[152:155], v13, s[16:19], s85 offen offset:0 nt
    v_mfma_f32_16x16x32_bf16 v[56:59], a[200:203], a[176:179], v[56:59]
    ds_read_b128 v[152:155], v14 offset:2048
    v_mfma_f32_16x16x32_bf16 v[56:59], a[204:207], a[180:183], v[56:59]
    buffer_store_dwordx4 v[156:159], v13, s[16:19], s85 offen offset:3072 nt
    v_mfma_f32_16x16x32_bf16 v[56:59], a[208:211], a[184:187], v[56:59]
    ds_read_b128 v[156:159], v14 offset:3072
    v_mfma_f32_16x16x32_bf16 v[56:59], a[212:215], a[188:191], v[56:59]
    v_mfma_f32_16x16x32_bf16 v[60:63], a[216:219], a[168:171], 0
    s_waitcnt lgkmcnt(2)
    buffer_store_dwordx4 v[144:147], v13, s[16:19], s86 offen offset:0 nt
    v_mfma_f32_16x16x32_bf16 v[60:63], a[220:223], a[172:175], v[60:63]
    v_mfma_f32_16x16x32_bf16 v[60:63], a[224:227], a[176:179], v[60:63]
    buffer_store_dwordx4 v[148:151], v13, s[16:19], s86 offen offset:3072 nt
    v_mfma_f32_16x16x32_bf16 v[60:63], a[228:231], a[180:183], v[60:63]
    v_mfma_f32_16x16x32_bf16 v[60:63], a[232:235], a[184:187], v[60:63]
    v_mfma_f32_16x16x32_bf16 v[60:63], a[236:239], a[188:191], v[60:63]
    s_waitcnt lgkmcnt(0)
    buffer_store_dwordx4 v[152:155], v13, s[16:19], s84 offen offset:128 nt
    s_barrier
    v_pk_mul_f32 v[224:225], v[224:225], v[134:135] op_sel_hi:[1,0]
    v_pk_mul_f32 v[226:227], v[226:227], v[134:135] op_sel_hi:[1,0]
    v_pk_mul_f32 v[64:65], v[64:65], v[138:139] op_sel_hi:[1,0]
    v_pk_mul_f32 v[66:67], v[66:67], v[138:139] op_sel_hi:[1,0]
    v_cvt_pk_bf16_f32 v80, v224, v225
    v_cvt_pk_bf16_f32 v81, v226, v227
    v_cvt_pk_bf16_f32 v82, v64, v65
    v_cvt_pk_bf16_f32 v83, v66, v67
    v_pk_mul_f32 v[228:229], v[228:229], v[134:135] op_sel_hi:[1,0]
    v_pk_mul_f32 v[230:231], v[230:231], v[134:135] op_sel_hi:[1,0]
    v_pk_mul_f32 v[68:69], v[68:69], v[138:139] op_sel_hi:[1,0]
    v_pk_mul_f32 v[70:71], v[70:71], v[138:139] op_sel_hi:[1,0]
    v_cvt_pk_bf16_f32 v84, v228, v229
    v_cvt_pk_bf16_f32 v85, v230, v231
    v_cvt_pk_bf16_f32 v86, v68, v69
    v_cvt_pk_bf16_f32 v87, v70, v71
    v_pk_mul_f32 v[232:233], v[232:233], v[134:135] op_sel_hi:[1,0]
    v_pk_mul_f32 v[234:235], v[234:235], v[134:135] op_sel_hi:[1,0]
    v_pk_mul_f32 v[72:73], v[72:73], v[138:139] op_sel_hi:[1,0]
    v_pk_mul_f32 v[74:75], v[74:75], v[138:139] op_sel_hi:[1,0]
    v_cvt_pk_bf16_f32 v88, v232, v233
    v_cvt_pk_bf16_f32 v89, v234, v235
    v_cvt_pk_bf16_f32 v90, v72, v73
    v_cvt_pk_bf16_f32 v91, v74, v75
    v_pk_mul_f32 v[236:237], v[236:237], v[134:135] op_sel_hi:[1,0]
    v_pk_mul_f32 v[238:239], v[238:239], v[134:135] op_sel_hi:[1,0]
    v_pk_mul_f32 v[76:77], v[76:77], v[138:139] op_sel_hi:[1,0]
    v_pk_mul_f32 v[78:79], v[78:79], v[138:139] op_sel_hi:[1,0]
    v_cvt_pk_bf16_f32 v92, v236, v237
    v_cvt_pk_bf16_f32 v93, v238, v239
    v_cvt_pk_bf16_f32 v94, v76, v77
    v_cvt_pk_bf16_f32 v95, v78, v79
    v_pk_mul_f32 v[192:193], v[192:193], v[130:131] op_sel_hi:[1,0]
    v_pk_mul_f32 v[194:195], v[194:195], v[130:131] op_sel_hi:[1,0]
    v_pk_mul_f32 v[240:241], v[240:241], v[134:135] op_sel_hi:[1,0]
    v_pk_mul_f32 v[242:243], v[242:243], v[134:135] op_sel_hi:[1,0]
    v_pk_mul_f32 v[196:197], v[196:197], v[130:131] op_sel_hi:[1,0]
    v_pk_mul_f32 v[198:199], v[198:199], v[130:131] op_sel_hi:[1,0]
    v_pk_mul_f32 v[244:245], v[244:245], v[134:135] op_sel_hi:[1,0]
    v_pk_mul_f32 v[246:247], v[246:247], v[134:135] op_sel_hi:[1,0]
    v_pk_mul_f32 v[200:201], v[200:201], v[130:131] op_sel_hi:[1,0]
    v_pk_mul_f32 v[202:203], v[202:203], v[130:131] op_sel_hi:[1,0]
    v_pk_mul_f32 v[248:249], v[248:249], v[134:135] op_sel_hi:[1,0]
    v_pk_mul_f32 v[250:251], v[250:251], v[134:135] op_sel_hi:[1,0]
    v_pk_mul_f32 v[204:205], v[204:205], v[130:131] op_sel_hi:[1,0]
    v_pk_mul_f32 v[206:207], v[206:207], v[130:131] op_sel_hi:[1,0]
    v_pk_mul_f32 v[252:253], v[252:253], v[134:135] op_sel_hi:[1,0]
    v_pk_mul_f32 v[254:255], v[254:255], v[134:135] op_sel_hi:[1,0]
    v_accvgpr_read_b32 v64, a32
    v_accvgpr_read_b32 v65, a33
    v_accvgpr_read_b32 v66, a34
    v_accvgpr_read_b32 v67, a35
    v_pk_mul_f32 v[64:65], v[64:65], v[138:139] op_sel_hi:[1,0]
    v_pk_mul_f32 v[66:67], v[66:67], v[138:139] op_sel_hi:[1,0]
    v_accvgpr_read_b32 v68, a36
    v_accvgpr_read_b32 v69, a37
    v_accvgpr_read_b32 v70, a38
    v_accvgpr_read_b32 v71, a39
    v_pk_mul_f32 v[68:69], v[68:69], v[138:139] op_sel_hi:[1,0]
    v_pk_mul_f32 v[70:71], v[70:71], v[138:139] op_sel_hi:[1,0]
    v_accvgpr_read_b32 v72, a40
    v_accvgpr_read_b32 v73, a41
    v_accvgpr_read_b32 v74, a42
    v_accvgpr_read_b32 v75, a43
    v_pk_mul_f32 v[72:73], v[72:73], v[138:139] op_sel_hi:[1,0]
    v_pk_mul_f32 v[74:75], v[74:75], v[138:139] op_sel_hi:[1,0]
    v_accvgpr_read_b32 v76, a44
    v_accvgpr_read_b32 v77, a45
    v_accvgpr_read_b32 v78, a46
    v_accvgpr_read_b32 v79, a47
    v_pk_mul_f32 v[76:77], v[76:77], v[138:139] op_sel_hi:[1,0]
    v_pk_mul_f32 v[78:79], v[78:79], v[138:139] op_sel_hi:[1,0]
    ds_write2st64_b64 v96, v[80:81], v[82:83] offset0:0 offset1:4
    buffer_store_dwordx4 v[156:159], v13, s[16:19], s84 offen offset:3200 nt
    ds_write2st64_b64 v97, v[84:85], v[86:87] offset0:0 offset1:4
    ds_write2st64_b64 v98, v[88:89], v[90:91] offset0:0 offset1:4
    ds_write2st64_b64 v99, v[92:93], v[94:95] offset0:0 offset1:4
    ds_read_b128 v[144:147], v14 offset:0
    ds_read_b128 v[148:151], v14 offset:1024
    ds_read_b128 v[152:155], v14 offset:2048
    ds_read_b128 v[156:159], v14 offset:3072
    v_cvt_pk_bf16_f32 v80, v192, v193
    v_cvt_pk_bf16_f32 v81, v194, v195
    v_cvt_pk_bf16_f32 v82, v240, v241
    v_cvt_pk_bf16_f32 v83, v242, v243
    v_cvt_pk_bf16_f32 v84, v196, v197
    v_cvt_pk_bf16_f32 v85, v198, v199
    v_cvt_pk_bf16_f32 v86, v244, v245
    v_cvt_pk_bf16_f32 v87, v246, v247
    v_cvt_pk_bf16_f32 v88, v200, v201
    v_cvt_pk_bf16_f32 v89, v202, v203
    v_cvt_pk_bf16_f32 v90, v248, v249
    v_cvt_pk_bf16_f32 v91, v250, v251
    v_cvt_pk_bf16_f32 v92, v204, v205
    v_cvt_pk_bf16_f32 v93, v206, v207
    v_cvt_pk_bf16_f32 v94, v252, v253
    v_cvt_pk_bf16_f32 v95, v254, v255
    ds_write2st64_b64 v96, v[80:81], v[82:83] offset0:0 offset1:4
    ds_write2st64_b64 v97, v[84:85], v[86:87] offset0:0 offset1:4
    ds_write2st64_b64 v98, v[88:89], v[90:91] offset0:0 offset1:4
    s_waitcnt lgkmcnt(6)
    buffer_store_dwordx4 v[144:147], v13, s[16:19], s85 offen offset:128 nt
    ds_write2st64_b64 v99, v[92:93], v[94:95] offset0:0 offset1:4
    ds_read_b128 v[144:147], v14 offset:0
    v_cvt_pk_bf16_f32 v80, v64, v65
    v_cvt_pk_bf16_f32 v81, v66, v67
    v_cvt_pk_bf16_f32 v84, v68, v69
    v_cvt_pk_bf16_f32 v85, v70, v71
    v_cvt_pk_bf16_f32 v88, v72, v73
    v_cvt_pk_bf16_f32 v89, v74, v75
    v_cvt_pk_bf16_f32 v92, v76, v77
    v_cvt_pk_bf16_f32 v93, v78, v79
    s_waitcnt lgkmcnt(5)
    buffer_store_dwordx4 v[148:151], v13, s[16:19], s85 offen offset:3200 nt
    buffer_store_dwordx4 v[152:155], v13, s[16:19], s86 offen offset:128 nt
    ds_read_b128 v[148:151], v14 offset:1024
    ds_read_b128 v[152:155], v14 offset:2048
    buffer_store_dwordx4 v[156:159], v13, s[16:19], s86 offen offset:3200 nt
    s_waitcnt lgkmcnt(2)
    buffer_store_dwordx4 v[144:147], v13, s[16:19], s84 offen offset:256 nt
    ds_read_b128 v[156:159], v14 offset:3072
    ds_write_b64 v96, v[80:81] offset:0
    ds_write_b64 v97, v[84:85] offset:0
    ds_write_b64 v98, v[88:89] offset:0
    ds_write_b64 v99, v[92:93] offset:0
    ds_read_b128 v[144:147], v14 offset:0
    s_waitcnt lgkmcnt(6)
    buffer_store_dwordx4 v[148:151], v13, s[16:19], s84 offen offset:3328 nt
    buffer_store_dwordx4 v[152:155], v13, s[16:19], s85 offen offset:256 nt
    ds_read_b128 v[148:151], v14 offset:1024
    s_waitcnt lgkmcnt(2)
    buffer_store_dwordx4 v[156:159], v13, s[16:19], s85 offen offset:3328 nt
    s_waitcnt lgkmcnt(1)
    buffer_store_dwordx4 v[144:147], v13, s[16:19], s86 offen offset:256 nt
    s_waitcnt lgkmcnt(0)
    buffer_store_dwordx4 v[148:151], v13, s[16:19], s86 offen offset:3328 nt
    s_mov_b32 s42, s41
    ds_read_b128 a[192:195], v1 offset:24576
    ds_read_b128 a[196:199], v2 offset:24576
    ds_read_b128 a[200:203], v1 offset:25600
    ds_read_b128 a[204:207], v2 offset:25600
    ds_read_b128 a[208:211], v1 offset:26624
    ds_read_b128 a[212:215], v2 offset:26624
    ds_read_b128 a[216:219], v1 offset:30720
    ds_read_b128 a[220:223], v2 offset:30720
    ds_read_b128 a[224:227], v1 offset:31744
    ds_read_b128 a[228:231], v2 offset:31744
    ds_read_b128 a[232:235], v1 offset:32768
    ds_read_b128 a[236:239], v2 offset:32768
    v_max3_f32 v152, v32, v33, v34
    v_max3_f32 v152, v152, v35, v36
    v_max3_f32 v152, v152, v37, v38
    v_max_f32 v152, v152, v39
    v_max3_f32 v154, v40, v41, v42
    v_mov_b32 v153, v152
    v_max3_f32 v154, v154, v43, v44
    v_max3_f32 v154, v154, v45, v46
    v_permlane32_swap_b32 v153, v152
    v_max_f32 v152, v152, v153
    v_max_f32 v154, v154, v47
    v_mov_b32 v153, v152
    v_mov_b32 v155, v154
    v_add_u32 v1, s57, v1
    v_permlane16_swap_b32 v153, v152
    v_permlane32_swap_b32 v155, v154
    v_max_f32 v152, v152, v153
    v_max_f32 v154, v154, v155
    v_mul_f32_e64 v16, -s36, v152
    v_mov_b32 v155, v154
    s_waitcnt lgkmcnt(11)
    v_mfma_f32_16x16x32_bf16 v[64:67], a[192:195], a[96:99], 0
    s_add_u32 s69, s69, 1
    v_permlane16_swap_b32 v155, v154
    s_waitcnt lgkmcnt(6)
    v_mfma_f32_16x16x32_bf16 v[64:67], a[196:199], a[100:103], v[64:67]
    s_add_u32 s48, s48, 325632
    v_max3_f32 v152, v48, v49, v50
    v_max_f32 v154, v154, v155
    v_mfma_f32_16x16x32_bf16 v[64:67], a[200:203], a[104:107], v[64:67]
    s_lshr_b32 s62, s39, s69
    v_max3_f32 v152, v152, v51, v52
    v_mul_f32_e64 v17, -s36, v154
    v_mfma_f32_16x16x32_bf16 v[64:67], a[204:207], a[108:111], v[64:67]
    s_and_b32 s62, s62, 1
    v_max3_f32 v152, v152, v53, v54
    v_max_f32 v152, v152, v55
    v_mfma_f32_16x16x32_bf16 v[64:67], a[208:211], a[112:115], v[64:67]
    s_lshl_b32 s62, s62, 1
    v_fma_f32 v32, v32, s36, v16
    v_fma_f32 v33, v33, s36, v16
    v_mfma_f32_16x16x32_bf16 v[64:67], a[212:215], a[116:119], v[64:67]
    s_add_u32 s62, s62, s49
    v_fma_f32 v34, v34, s36, v16
    v_fma_f32 v35, v35, s36, v16
    v_mfma_f32_16x16x32_bf16 v[72:75], a[192:195], a[120:123], 0
    s_and_b32 s62, s62, 3
    v_fma_f32 v40, v40, s36, v17
    v_fma_f32 v41, v41, s36, v17
    v_mfma_f32_16x16x32_bf16 v[72:75], a[196:199], a[124:127], v[72:75]
    s_add_u32 s63, s69, 8
    v_fma_f32 v36, v36, s36, v16
    v_fma_f32 v37, v37, s36, v16
    v_mfma_f32_16x16x32_bf16 v[72:75], a[200:203], a[128:131], v[72:75]
    s_lshr_b32 s63, s39, s63
    v_mov_b32 v153, v152
    v_max3_f32 v154, v56, v57, v58
    v_mfma_f32_16x16x32_bf16 v[72:75], a[204:207], a[132:135], v[72:75]
    s_and_b32 s63, s63, 1
    v_exp_f32 v144, v32
    v_mfma_f32_16x16x32_bf16 v[72:75], a[208:211], a[136:139], v[72:75]
    s_xor_b32 s62, s62, s63
    v_exp_f32 v145, v33
    v_mfma_f32_16x16x32_bf16 v[72:75], a[212:215], a[140:143], v[72:75]
    s_mul_i32 s63, s3, 3
    v_exp_f32 v146, v34
    v_mfma_f32_16x16x32_bf16 v[80:83], a[192:195], a[144:147], 0
    s_lshl_b32 s64, s3, 2
    v_exp_f32 v147, v35
    v_mfma_f32_16x16x32_bf16 v[80:83], a[196:199], a[148:151], v[80:83]
    s_mov_b32 s40, 1
    v_exp_f32 v148, v40
    v_mfma_f32_16x16x32_bf16 v[80:83], a[200:203], a[152:155], v[80:83]
    s_add_u32 s65, s63, 17
    v_exp_f32 v149, v41
    v_mfma_f32_16x16x32_bf16 v[80:83], a[204:207], a[156:159], v[80:83]
    s_cmp_eq_u32 s3, 0
    v_exp_f32 v150, v36
    v_mfma_f32_16x16x32_bf16 v[80:83], a[208:211], a[160:163], v[80:83]
    s_cselect_b32 s65, 16, s65
    v_exp_f32 v151, v37
    v_mfma_f32_16x16x32_bf16 v[80:83], a[212:215], a[164:167], v[80:83]
    s_cselect_b32 s41, 1, 0
    v_permlane32_swap_b32 v153, v152
    v_mfma_f32_16x16x32_bf16 v[88:91], a[192:195], a[168:171], 0
    s_cmp_eq_u32 s62, 1
    v_max3_f32 v154, v154, v59, v60
    v_max_f32 v152, v152, v153
    v_mfma_f32_16x16x32_bf16 v[88:91], a[196:199], a[172:175], v[88:91]
    s_cselect_b32 s64, s65, s64
    v_max3_f32 v154, v154, v61, v62
    v_mov_b32 v153, v152
    v_mfma_f32_16x16x32_bf16 v[88:91], a[200:203], a[176:179], v[88:91]
    s_cselect_b32 s40, s41, s40
    v_max_f32 v154, v154, v63
    v_cvt_pk_bf16_f32 v96, v144, v145
    v_mfma_f32_16x16x32_bf16 v[88:91], a[204:207], a[180:183], v[88:91]
    s_add_u32 s65, s63, 29
    v_cvt_pk_bf16_f32 v97, v146, v147
    v_cvt_pk_bf16_f32 v100, v148, v149
    v_mfma_f32_16x16x32_bf16 v[88:91], a[208:211], a[184:187], v[88:91]
    s_cmp_eq_u32 s62, 2
    v_cvt_pk_bf16_f32 v98, v150, v151
    v_fma_f32 v38, v38, s36, v16
    v_mfma_f32_16x16x32_bf16 v[88:91], a[212:215], a[188:191], v[88:91]
    s_cselect_b32 s64, s65, s64
    v_fma_f32 v39, v39, s36, v16
    v_fma_f32 v42, v42, s36, v17
    s_waitcnt lgkmcnt(0)
    v_mfma_f32_16x16x32_bf16 v[68:71], a[216:219], a[96:99], 0
    s_cselect_b32 s40, 0, s40
    v_fma_f32 v43, v43, s36, v17
    v_fma_f32 v44, v44, s36, v17
    v_mfma_f32_16x16x32_bf16 v[68:71], a[220:223], a[100:103], v[68:71]
    s_add_u32 s65, s63, 41
    v_fma_f32 v45, v45, s36, v17
    v_fma_f32 v46, v46, s36, v17
    v_mfma_f32_16x16x32_bf16 v[68:71], a[224:227], a[104:107], v[68:71]
    s_cmp_eq_u32 s62, 3
    v_fma_f32 v47, v47, s36, v17
    v_mov_b32 v155, v154
    v_mfma_f32_16x16x32_bf16 v[68:71], a[228:231], a[108:111], v[68:71]
    s_cselect_b32 s64, s65, s64
    v_permlane16_swap_b32 v153, v152
    v_mfma_f32_16x16x32_bf16 v[68:71], a[232:235], a[112:115], v[68:71]
    s_cselect_b32 s40, 0, s40
    v_exp_f32 v144, v38
    v_mfma_f32_16x16x32_bf16 v[68:71], a[236:239], a[116:119], v[68:71]
    s_mul_i32 s64, s64, 6144
    v_exp_f32 v145, v39
    v_mfma_f32_16x16x32_bf16 v[76:79], a[216:219], a[120:123], 0
    s_add_u32 s41, s48, s64
    v_exp_f32 v146, v42
    v_mfma_f32_16x16x32_bf16 v[76:79], a[220:223], a[124:127], v[76:79]
    s_cmp_ge_u32 s69, 8
    v_exp_f32 v147, v43
    v_mfma_f32_16x16x32_bf16 v[76:79], a[224:227], a[128:131], v[76:79]
    s_cselect_b32 s41, 166725632, s41
    v_exp_f32 v148, v44
    v_mfma_f32_16x16x32_bf16 v[76:79], a[228:231], a[132:135], v[76:79]
    s_add_u32 m0, s33, s31
    v_exp_f32 v149, v45
    v_mfma_f32_16x16x32_bf16 v[76:79], a[232:235], a[136:139], v[76:79]
    buffer_load_dwordx4 v7, s[20:23], s28 offen offset:0 lds
    v_mfma_f32_16x16x32_bf16 v[76:79], a[236:239], a[140:143], v[76:79]
    buffer_load_dwordx4 v8, s[20:23], s28 offen offset:1024 lds
    v_mfma_f32_16x16x32_bf16 v[84:87], a[216:219], a[144:147], 0
    buffer_load_dwordx4 v9, s[20:23], s28 offen offset:2048 lds
    v_mfma_f32_16x16x32_bf16 v[84:87], a[220:223], a[148:151], v[84:87]
    s_add_u32 m0, s33, s32
    v_exp_f32 v150, v46
    v_mfma_f32_16x16x32_bf16 v[84:87], a[224:227], a[152:155], v[84:87]
    buffer_load_dwordx4 v10, s[24:27], s29 offen offset:0 lds
    v_mfma_f32_16x16x32_bf16 v[84:87], a[228:231], a[156:159], v[84:87]
    buffer_load_dwordx4 v11, s[24:27], s29 offen offset:1024 lds
    v_mfma_f32_16x16x32_bf16 v[84:87], a[232:235], a[160:163], v[84:87]
    buffer_load_dwordx4 v12, s[24:27], s29 offen offset:2048 lds
    s_add_u32 s28, s28, s30
    s_add_u32 s29, s29, s30
    v_mfma_f32_16x16x32_bf16 v[84:87], a[236:239], a[164:167], v[84:87]
    s_add_u32 s33, s33, 24576
    v_exp_f32 v151, v47
    s_cmp_eq_u32 s33, 147456
    v_mfma_f32_16x16x32_bf16 v[92:95], a[216:219], a[168:171], 0
    s_cselect_b32 s33, 0, s33
    v_max_f32 v152, v152, v153
    v_mul_f32_e64 v18, -s36, v152
    v_mfma_f32_16x16x32_bf16 v[92:95], a[220:223], a[172:175], v[92:95]
    s_add_u32 m0, s33, s31
    v_permlane32_swap_b32 v155, v154
    v_mfma_f32_16x16x32_bf16 v[92:95], a[224:227], a[176:179], v[92:95]
    buffer_load_dwordx4 v7, s[20:23], s28 offen offset:0 lds
    v_mfma_f32_16x16x32_bf16 v[92:95], a[228:231], a[180:183], v[92:95]
    buffer_load_dwordx4 v8, s[20:23], s28 offen offset:1024 lds
    v_mfma_f32_16x16x32_bf16 v[92:95], a[232:235], a[184:187], v[92:95]
    buffer_load_dwordx4 v9, s[20:23], s28 offen offset:2048 lds
    s_add_u32 m0, s33, s32
    v_mfma_f32_16x16x32_bf16 v[92:95], a[236:239], a[188:191], v[92:95]
    buffer_load_dwordx4 v10, s[24:27], s29 offen offset:0 lds
    buffer_load_dwordx4 v11, s[24:27], s29 offen offset:1024 lds
    buffer_load_dwordx4 v12, s[24:27], s29 offen offset:2048 lds
    s_add_u32 s28, s28, s30
    v_max_f32 v154, v154, v155
    v_mov_b32 v155, v154
    v_cvt_pk_bf16_f32 v99, v144, v145
    v_cvt_pk_bf16_f32 v101, v146, v147
    v_cvt_pk_bf16_f32 v102, v148, v149
    v_mfma_f32_16x16x32_bf16 v[128:131], v[24:27], v[96:99], 0
    v_cvt_pk_bf16_f32 v103, v150, v151
    v_fma_f32 v48, v48, s36, v18
    v_fma_f32 v49, v49, s36, v18
    v_mfma_f32_16x16x32_bf16 v[132:135], v[24:27], v[100:103], 0
    v_fma_f32 v50, v50, s36, v18
    v_fma_f32 v51, v51, s36, v18
    v_fma_f32 v52, v52, s36, v18
    v_fma_f32 v53, v53, s36, v18
    v_fma_f32 v54, v54, s36, v18
    v_fma_f32 v55, v55, s36, v18
    v_permlane16_swap_b32 v155, v154
    v_exp_f32 v144, v48
    v_exp_f32 v145, v49
    v_exp_f32 v146, v50
    v_exp_f32 v147, v51
    v_exp_f32 v148, v52
    v_exp_f32 v149, v53
    v_exp_f32 v150, v54
    v_exp_f32 v151, v55
    v_max_f32 v154, v154, v155
    v_mul_f32_e64 v19, -s36, v154
    v_cvt_pk_bf16_f32 v104, v144, v145
    v_cvt_pk_bf16_f32 v105, v146, v147
    v_cvt_pk_bf16_f32 v106, v148, v149
    v_cvt_pk_bf16_f32 v107, v150, v151
    v_fma_f32 v56, v56, s36, v19
    v_fma_f32 v57, v57, s36, v19
    v_mfma_f32_16x16x32_bf16 v[136:139], v[24:27], v[104:107], 0
    v_fma_f32 v58, v58, s36, v19
    v_fma_f32 v59, v59, s36, v19
    v_fma_f32 v60, v60, s36, v19
    v_fma_f32 v61, v61, s36, v19
    v_fma_f32 v62, v62, s36, v19
    v_fma_f32 v63, v63, s36, v19
    v_exp_f32 v144, v56
    v_exp_f32 v145, v57
    v_exp_f32 v146, v58
    v_exp_f32 v147, v59
    v_exp_f32 v148, v60
    v_exp_f32 v149, v61
    v_exp_f32 v150, v62
    v_exp_f32 v151, v63
    v_cvt_pk_bf16_f32 v108, v144, v145
    v_cvt_pk_bf16_f32 v109, v146, v147
    v_cvt_pk_bf16_f32 v110, v148, v149
    v_cvt_pk_bf16_f32 v111, v150, v151
    v_fma_f32 v64, v64, s36, v16
    v_fma_f32 v65, v65, s36, v16
    v_mfma_f32_16x16x32_bf16 v[140:143], v[24:27], v[108:111], 0
    v_fma_f32 v66, v66, s36, v16
    v_fma_f32 v67, v67, s36, v16
    v_fma_f32 v72, v72, s36, v17
    v_fma_f32 v73, v73, s36, v17
    s_add_u32 s29, s29, s30
    v_exp_f32 v144, v64
    v_exp_f32 v145, v65
    v_exp_f32 v146, v66
    v_exp_f32 v147, v67
    v_exp_f32 v148, v72
    v_exp_f32 v149, v73
    s_add_u32 s33, s33, 24576
    s_cmp_eq_u32 s33, 147456
    s_waitcnt vmcnt(36)
    s_barrier
    s_cselect_b32 s33, 0, s33
    v_cvt_pk_bf16_f32 v112, v144, v145
    v_cvt_pk_bf16_f32 v113, v146, v147
    v_cvt_pk_bf16_f32 v116, v148, v149
    v_add_u32 v2, s57, v2
    ds_read_b64_tr_b16 a[240:241], v3 offset:0
    ds_read_b64_tr_b16 a[242:243], v3 offset:6144
    ds_read_b64_tr_b16 a[244:245], v4 offset:0
    ds_read_b64_tr_b16 a[246:247], v4 offset:6144
    ds_read_b64_tr_b16 a[248:249], v5 offset:0
    ds_read_b64_tr_b16 a[250:251], v5 offset:6144
    ds_read_b64_tr_b16 a[252:253], v6 offset:0
    ds_read_b64_tr_b16 a[254:255], v6 offset:6144
    s_waitcnt lgkmcnt(6)
    v_mfma_f32_16x16x32_bf16 v[160:163], a[240:243], v[96:99], 0
    s_add_u32 m0, s33, s31
    ds_read_b128 a[192:195], v1 offset:0
    ds_read_b128 a[196:199], v2 offset:0
    v_mfma_f32_16x16x32_bf16 v[208:211], a[240:243], v[100:103], 0
    ds_read_b128 a[200:203], v1 offset:1024
    ds_read_b128 a[204:207], v2 offset:1024
    v_mfma_f32_16x16x32_bf16 a[0:3], a[240:243], v[104:107], 0
    ds_read_b128 a[208:211], v1 offset:2048
    ds_read_b128 a[212:215], v2 offset:2048
    v_mfma_f32_16x16x32_bf16 a[48:51], a[240:243], v[108:111], 0
    buffer_load_dwordx4 v7, s[20:23], s28 offen offset:0 lds
    s_waitcnt lgkmcnt(10)
    v_mfma_f32_16x16x32_bf16 v[164:167], a[244:247], v[96:99], 0
    ds_read_b64_tr_b16 a[240:241], v3 offset:1024
    ds_read_b64_tr_b16 a[242:243], v3 offset:7168
    v_mfma_f32_16x16x32_bf16 v[212:215], a[244:247], v[100:103], 0
    ds_read_b128 a[216:219], v1 offset:6144
    ds_read_b128 a[220:223], v2 offset:6144
    v_mfma_f32_16x16x32_bf16 a[4:7], a[244:247], v[104:107], 0
    ds_read_b128 a[224:227], v1 offset:7168
    ds_read_b128 a[228:231], v2 offset:7168
    v_mfma_f32_16x16x32_bf16 a[52:55], a[244:247], v[108:111], 0
    s_waitcnt lgkmcnt(12)
    ds_read_b64_tr_b16 a[244:245], v4 offset:1024
    ds_read_b64_tr_b16 a[246:247], v4 offset:7168
    v_mfma_f32_16x16x32_bf16 v[168:171], a[248:251], v[96:99], 0
    ds_read_b128 a[232:235], v1 offset:8192
    ds_read_b128 a[236:239], v2 offset:8192
    v_mfma_f32_16x16x32_bf16 v[216:219], a[248:251], v[100:103], 0
    v_fma_f32 v68, v68, s36, v16
    v_fma_f32 v69, v69, s36, v16
    v_mfma_f32_16x16x32_bf16 a[8:11], a[248:251], v[104:107], 0
    v_exp_f32 v150, v68
    v_mfma_f32_16x16x32_bf16 a[56:59], a[248:251], v[108:111], 0
    ds_read_b64_tr_b16 a[248:249], v5 offset:1024
    ds_read_b64_tr_b16 a[250:251], v5 offset:7168
    v_mfma_f32_16x16x32_bf16 v[172:175], a[252:255], v[96:99], 0
    v_exp_f32 v151, v69
    v_mfma_f32_16x16x32_bf16 v[220:223], a[252:255], v[100:103], 0
    v_cvt_pk_bf16_f32 v114, v150, v151
    v_fma_f32 v70, v70, s36, v16
    v_mfma_f32_16x16x32_bf16 a[12:15], a[252:255], v[104:107], 0
    v_fma_f32 v71, v71, s36, v16
    v_fma_f32 v74, v74, s36, v17
    v_mfma_f32_16x16x32_bf16 a[60:63], a[252:255], v[108:111], 0
    buffer_load_dwordx4 v8, s[20:23], s28 offen offset:1024 lds
    s_waitcnt lgkmcnt(4)
    v_mfma_f32_16x16x32_bf16 v[176:179], a[240:243], v[96:99], 0
    ds_read_b64_tr_b16 a[252:253], v6 offset:1024
    ds_read_b64_tr_b16 a[254:255], v6 offset:7168
    v_mfma_f32_16x16x32_bf16 v[224:227], a[240:243], v[100:103], 0
    v_fma_f32 v75, v75, s36, v17
    v_fma_f32 v76, v76, s36, v17
    v_mfma_f32_16x16x32_bf16 a[16:19], a[240:243], v[104:107], 0
    v_fma_f32 v77, v77, s36, v17
    v_fma_f32 v78, v78, s36, v17
    v_mfma_f32_16x16x32_bf16 a[64:67], a[240:243], v[108:111], 0
    ds_read_b64_tr_b16 a[240:241], v3 offset:2048
    ds_read_b64_tr_b16 a[242:243], v3 offset:8192
    v_mfma_f32_16x16x32_bf16 v[180:183], a[244:247], v[96:99], 0
    v_fma_f32 v79, v79, s36, v17
    v_fma_f32 v80, v80, s36, v18
    v_mfma_f32_16x16x32_bf16 v[228:231], a[244:247], v[100:103], 0
    v_exp_f32 v144, v70
    v_mfma_f32_16x16x32_bf16 a[20:23], a[244:247], v[104:107], 0
    v_exp_f32 v145, v71
    v_mfma_f32_16x16x32_bf16 a[68:71], a[244:247], v[108:111], 0
    s_waitcnt lgkmcnt(4)
    ds_read_b64_tr_b16 a[244:245], v4 offset:2048
    ds_read_b64_tr_b16 a[246:247], v4 offset:8192
    v_mfma_f32_16x16x32_bf16 v[184:187], a[248:251], v[96:99], 0
    v_exp_f32 v146, v74
    v_mfma_f32_16x16x32_bf16 v[232:235], a[248:251], v[100:103], 0
    v_exp_f32 v147, v75
    v_mfma_f32_16x16x32_bf16 a[24:27], a[248:251], v[104:107], 0
    v_exp_f32 v148, v76
    v_mfma_f32_16x16x32_bf16 a[72:75], a[248:251], v[108:111], 0
    s_waitcnt lgkmcnt(3)
    ds_read_b64_tr_b16 a[248:249], v5 offset:2048
    ds_read_b64_tr_b16 a[250:251], v5 offset:8192
    v_mfma_f32_16x16x32_bf16 v[188:191], a[252:255], v[96:99], 0
    buffer_load_dwordx4 v9, s[20:23], s28 offen offset:2048 lds
    v_mfma_f32_16x16x32_bf16 v[236:239], a[252:255], v[100:103], 0
    s_add_u32 m0, s33, s32
    v_exp_f32 v149, v77
    v_mfma_f32_16x16x32_bf16 a[28:31], a[252:255], v[104:107], 0
    v_exp_f32 v150, v78
    v_mfma_f32_16x16x32_bf16 a[76:79], a[252:255], v[108:111], 0
    s_waitcnt lgkmcnt(2)
    ds_read_b64_tr_b16 a[252:253], v6 offset:2048
    ds_read_b64_tr_b16 a[254:255], v6 offset:8192
    v_mfma_f32_16x16x32_bf16 v[192:195], a[240:243], v[96:99], 0
    v_exp_f32 v151, v79
    v_mfma_f32_16x16x32_bf16 v[240:243], a[240:243], v[100:103], 0
    v_cvt_pk_bf16_f32 v115, v144, v145
    v_cvt_pk_bf16_f32 v117, v146, v147
    v_mfma_f32_16x16x32_bf16 a[32:35], a[240:243], v[104:107], 0
    v_cvt_pk_bf16_f32 v118, v148, v149
    v_cvt_pk_bf16_f32 v119, v150, v151
    v_mfma_f32_16x16x32_bf16 a[80:83], a[240:243], v[108:111], 0
    v_fma_f32 v81, v81, s36, v18
    v_fma_f32 v82, v82, s36, v18
    v_mfma_f32_16x16x32_bf16 v[196:199], a[244:247], v[96:99], 0
    v_fma_f32 v83, v83, s36, v18
    v_fma_f32 v84, v84, s36, v18
    v_mfma_f32_16x16x32_bf16 v[244:247], a[244:247], v[100:103], 0
    v_fma_f32 v85, v85, s36, v18
    v_fma_f32 v86, v86, s36, v18
    v_mfma_f32_16x16x32_bf16 a[36:39], a[244:247], v[104:107], 0
    v_fma_f32 v87, v87, s36, v18
    v_fma_f32 v88, v88, s36, v19
    v_mfma_f32_16x16x32_bf16 a[84:87], a[244:247], v[108:111], 0
    s_waitcnt lgkmcnt(1)
    v_exp_f32 v144, v80
    v_mfma_f32_16x16x32_bf16 v[200:203], a[248:251], v[96:99], 0
    buffer_load_dwordx4 v10, s[24:27], s29 offen offset:0 lds
    v_mfma_f32_16x16x32_bf16 v[248:251], a[248:251], v[100:103], 0
    v_exp_f32 v145, v81
    v_mfma_f32_16x16x32_bf16 a[40:43], a[248:251], v[104:107], 0
    v_exp_f32 v146, v82
    v_mfma_f32_16x16x32_bf16 a[88:91], a[248:251], v[108:111], 0
    s_waitcnt lgkmcnt(0)
    v_exp_f32 v147, v83
    v_mfma_f32_16x16x32_bf16 v[204:207], a[252:255], v[96:99], 0
    v_exp_f32 v148, v84
    v_mfma_f32_16x16x32_bf16 v[252:255], a[252:255], v[100:103], 0
    v_exp_f32 v149, v85
    v_mfma_f32_16x16x32_bf16 a[44:47], a[252:255], v[104:107], 0
    v_exp_f32 v150, v86
    v_mfma_f32_16x16x32_bf16 a[92:95], a[252:255], v[108:111], 0
    v_exp_f32 v151, v87
    v_mfma_f32_16x16x32_bf16 v[32:35], a[192:195], a[96:99], 0
    v_cvt_pk_bf16_f32 v120, v144, v145
    v_cvt_pk_bf16_f32 v121, v146, v147
    v_mfma_f32_16x16x32_bf16 v[32:35], a[196:199], a[100:103], v[32:35]
    v_cvt_pk_bf16_f32 v122, v148, v149
    v_cvt_pk_bf16_f32 v123, v150, v151
    v_mfma_f32_16x16x32_bf16 v[32:35], a[200:203], a[104:107], v[32:35]
    v_fma_f32 v89, v89, s36, v19
    v_fma_f32 v90, v90, s36, v19
    v_mfma_f32_16x16x32_bf16 v[32:35], a[204:207], a[108:111], v[32:35]
    v_fma_f32 v91, v91, s36, v19
    v_fma_f32 v92, v92, s36, v19
    v_mfma_f32_16x16x32_bf16 v[32:35], a[208:211], a[112:115], v[32:35]
    v_fma_f32 v93, v93, s36, v19
    v_fma_f32 v94, v94, s36, v19
    v_mfma_f32_16x16x32_bf16 v[32:35], a[212:215], a[116:119], v[32:35]
    buffer_load_dwordx4 v11, s[24:27], s29 offen offset:1024 lds
    v_mfma_f32_16x16x32_bf16 v[40:43], a[192:195], a[120:123], 0
    v_fma_f32 v95, v95, s36, v19
    v_mov_b32 v20, v128
    v_mfma_f32_16x16x32_bf16 v[128:131], v[24:27], v[112:115], 0
    v_exp_f32 v144, v88
    v_mfma_f32_16x16x32_bf16 v[40:43], a[196:199], a[124:127], v[40:43]
    v_exp_f32 v145, v89
    v_mfma_f32_16x16x32_bf16 v[40:43], a[200:203], a[128:131], v[40:43]
    v_exp_f32 v146, v90
    v_mfma_f32_16x16x32_bf16 v[40:43], a[204:207], a[132:135], v[40:43]
    v_exp_f32 v147, v91
    v_mfma_f32_16x16x32_bf16 v[40:43], a[208:211], a[136:139], v[40:43]
    v_exp_f32 v148, v92
    v_mfma_f32_16x16x32_bf16 v[40:43], a[212:215], a[140:143], v[40:43]
    v_exp_f32 v149, v93
    v_mfma_f32_16x16x32_bf16 v[48:51], a[192:195], a[144:147], 0
    v_exp_f32 v150, v94
    v_mfma_f32_16x16x32_bf16 v[48:51], a[196:199], a[148:151], v[48:51]
    v_exp_f32 v151, v95
    v_mfma_f32_16x16x32_bf16 v[48:51], a[200:203], a[152:155], v[48:51]
    v_cvt_pk_bf16_f32 v124, v144, v145
    v_cvt_pk_bf16_f32 v125, v146, v147
    v_mfma_f32_16x16x32_bf16 v[48:51], a[204:207], a[156:159], v[48:51]
    v_cvt_pk_bf16_f32 v126, v148, v149
    v_cvt_pk_bf16_f32 v127, v150, v151
    v_mfma_f32_16x16x32_bf16 v[48:51], a[208:211], a[160:163], v[48:51]
    buffer_load_dwordx4 v12, s[24:27], s29 offen offset:2048 lds
    v_mfma_f32_16x16x32_bf16 v[48:51], a[212:215], a[164:167], v[48:51]
    s_add_u32 s28, s28, s30
    v_mov_b32 v21, v132
    v_mov_b32 v22, v136
    v_mfma_f32_16x16x32_bf16 v[132:135], v[24:27], v[116:119], 0
    s_add_u32 s29, s29, s30
    v_mov_b32 v23, v140
    v_mfma_f32_16x16x32_bf16 v[136:139], v[24:27], v[120:123], 0
    s_add_u32 s33, s33, 24576
    v_mfma_f32_16x16x32_bf16 v[140:143], v[24:27], v[124:127], 0
    s_cmp_eq_u32 s33, 147456
    v_mfma_f32_16x16x32_bf16 v[56:59], a[192:195], a[168:171], 0
    s_cselect_b32 s33, 0, s33
    v_mfma_f32_16x16x32_bf16 v[56:59], a[196:199], a[172:175], v[56:59]
    v_mfma_f32_16x16x32_bf16 v[56:59], a[200:203], a[176:179], v[56:59]
    v_mfma_f32_16x16x32_bf16 v[56:59], a[204:207], a[180:183], v[56:59]
    v_max3_f32 v30, v128, v132, v136
    v_mfma_f32_16x16x32_bf16 v[56:59], a[208:211], a[184:187], v[56:59]
    v_max_f32 v30, v30, v140
    v_cmp_lt_f32 vcc, s37, v30
    v_mfma_f32_16x16x32_bf16 v[56:59], a[212:215], a[188:191], v[56:59]
    v_mfma_f32_16x16x32_bf16 v[36:39], a[216:219], a[96:99], 0
    v_mfma_f32_16x16x32_bf16 v[36:39], a[220:223], a[100:103], v[36:39]
    v_mfma_f32_16x16x32_bf16 v[36:39], a[224:227], a[104:107], v[36:39]
    v_mfma_f32_16x16x32_bf16 v[36:39], a[228:231], a[108:111], v[36:39]
    s_cbranch_vccnz L_rs_tr34a
L_ret_tr34a:
    v_fma_f32 v32, v32, s36, v16
    v_fma_f32 v33, v33, s36, v16
    v_mfma_f32_16x16x32_bf16 v[36:39], a[232:235], a[112:115], v[36:39]
    v_fma_f32 v34, v34, s36, v16
    v_fma_f32 v35, v35, s36, v16
    v_mfma_f32_16x16x32_bf16 v[36:39], a[236:239], a[116:119], v[36:39]
    v_fma_f32 v40, v40, s36, v17
    v_fma_f32 v41, v41, s36, v17
    v_mfma_f32_16x16x32_bf16 v[44:47], a[216:219], a[120:123], 0
    v_exp_f32 v144, v32
    v_mfma_f32_16x16x32_bf16 v[44:47], a[220:223], a[124:127], v[44:47]
    v_exp_f32 v145, v33
    v_mfma_f32_16x16x32_bf16 v[44:47], a[224:227], a[128:131], v[44:47]
    v_exp_f32 v146, v34
    v_mfma_f32_16x16x32_bf16 v[44:47], a[228:231], a[132:135], v[44:47]
    v_exp_f32 v147, v35
    s_waitcnt vmcnt(36)
    s_barrier
    v_mfma_f32_16x16x32_bf16 v[44:47], a[232:235], a[136:139], v[44:47]
    v_exp_f32 v148, v40
    v_mfma_f32_16x16x32_bf16 v[44:47], a[236:239], a[140:143], v[44:47]
    ds_read_b64_tr_b16 a[240:241], v3 offset:24576
    ds_read_b64_tr_b16 a[242:243], v3 offset:30720
    v_mfma_f32_16x16x32_bf16 v[52:55], a[216:219], a[144:147], 0
    v_exp_f32 v149, v41
    v_mfma_f32_16x16x32_bf16 v[52:55], a[220:223], a[148:151], v[52:55]
    ds_read_b64_tr_b16 a[244:245], v4 offset:24576
    ds_read_b64_tr_b16 a[246:247], v4 offset:30720
    v_mfma_f32_16x16x32_bf16 v[52:55], a[224:227], a[152:155], v[52:55]
    v_cvt_pk_bf16_f32 v96, v144, v145
    v_cvt_pk_bf16_f32 v97, v146, v147
    v_mfma_f32_16x16x32_bf16 v[52:55], a[228:231], a[156:159], v[52:55]
    ds_read_b64_tr_b16 a[248:249], v5 offset:24576
    ds_read_b64_tr_b16 a[250:251], v5 offset:30720
    v_mfma_f32_16x16x32_bf16 v[52:55], a[232:235], a[160:163], v[52:55]
    v_cvt_pk_bf16_f32 v100, v148, v149
    v_mfma_f32_16x16x32_bf16 v[52:55], a[236:239], a[164:167], v[52:55]
    ds_read_b64_tr_b16 a[252:253], v6 offset:24576
    ds_read_b64_tr_b16 a[254:255], v6 offset:30720
    v_mfma_f32_16x16x32_bf16 v[60:63], a[216:219], a[168:171], 0
    v_mfma_f32_16x16x32_bf16 v[60:63], a[220:223], a[172:175], v[60:63]
    v_mfma_f32_16x16x32_bf16 v[60:63], a[224:227], a[176:179], v[60:63]
    v_mfma_f32_16x16x32_bf16 v[60:63], a[228:231], a[180:183], v[60:63]
    v_mfma_f32_16x16x32_bf16 v[60:63], a[232:235], a[184:187], v[60:63]
    v_mfma_f32_16x16x32_bf16 v[60:63], a[236:239], a[188:191], v[60:63]
    s_waitcnt lgkmcnt(4)
    v_mfma_f32_16x16x32_bf16 v[160:163], a[240:243], v[112:115], v[160:163]
    s_add_u32 s62, s34, 49152
    ds_read_b128 a[192:195], v1 offset:24576
    ds_read_b128 a[196:199], v2 offset:24576
    v_mfma_f32_16x16x32_bf16 v[208:211], a[240:243], v[116:119], v[208:211]
    s_cmp_eq_u32 s62, 147456
    ds_read_b128 a[200:203], v1 offset:25600
    ds_read_b128 a[204:207], v2 offset:25600
    v_mfma_f32_16x16x32_bf16 a[0:3], a[240:243], v[120:123], a[0:3]
    s_cselect_b32 s62, 0, s62
    ds_read_b128 a[208:211], v1 offset:26624
    ds_read_b128 a[212:215], v2 offset:26624
    v_mfma_f32_16x16x32_bf16 a[48:51], a[240:243], v[124:127], a[48:51]
    s_sub_u32 s58, s62, s34
    ds_read_b64_tr_b16 a[240:241], v3 offset:25600
    ds_read_b64_tr_b16 a[242:243], v3 offset:31744
    v_mfma_f32_16x16x32_bf16 v[164:167], a[244:247], v[112:115], v[164:167]
    s_mov_b32 s34, s62
    ds_read_b128 a[216:219], v1 offset:30720
    ds_read_b128 a[220:223], v2 offset:30720
    v_mfma_f32_16x16x32_bf16 v[212:215], a[244:247], v[116:119], v[212:215]
    s_add_u32 m0, s33, s31
    ds_read_b128 a[224:227], v1 offset:31744
    ds_read_b128 a[228:231], v2 offset:31744
    v_mfma_f32_16x16x32_bf16 a[4:7], a[244:247], v[120:123], a[4:7]
    buffer_load_dwordx4 v7, s[20:23], s28 offen offset:0 lds
    v_mfma_f32_16x16x32_bf16 a[52:55], a[244:247], v[124:127], a[52:55]
    s_waitcnt lgkmcnt(12)
    ds_read_b64_tr_b16 a[244:245], v4 offset:25600
    ds_read_b64_tr_b16 a[246:247], v4 offset:31744
    v_mfma_f32_16x16x32_bf16 v[168:171], a[248:251], v[112:115], v[168:171]
    ds_read_b128 a[232:235], v1 offset:32768
    ds_read_b128 a[236:239], v2 offset:32768
    v_mfma_f32_16x16x32_bf16 v[216:219], a[248:251], v[116:119], v[216:219]
    v_fma_f32 v36, v36, s36, v16
    v_fma_f32 v37, v37, s36, v16
    v_mfma_f32_16x16x32_bf16 a[8:11], a[248:251], v[120:123], a[8:11]
    v_exp_f32 v150, v36
    v_mfma_f32_16x16x32_bf16 a[56:59], a[248:251], v[124:127], a[56:59]
    ds_read_b64_tr_b16 a[248:249], v5 offset:25600
    ds_read_b64_tr_b16 a[250:251], v5 offset:31744
    v_mfma_f32_16x16x32_bf16 v[172:175], a[252:255], v[112:115], v[172:175]
    v_exp_f32 v151, v37
    v_mfma_f32_16x16x32_bf16 v[220:223], a[252:255], v[116:119], v[220:223]
    v_cvt_pk_bf16_f32 v98, v150, v151
    v_fma_f32 v38, v38, s36, v16
    v_mfma_f32_16x16x32_bf16 a[12:15], a[252:255], v[120:123], a[12:15]
    v_fma_f32 v39, v39, s36, v16
    v_fma_f32 v42, v42, s36, v17
    v_mfma_f32_16x16x32_bf16 a[60:63], a[252:255], v[124:127], a[60:63]
    buffer_load_dwordx4 v8, s[20:23], s28 offen offset:1024 lds
    s_waitcnt lgkmcnt(4)
    v_mfma_f32_16x16x32_bf16 v[176:179], a[240:243], v[112:115], v[176:179]
    ds_read_b64_tr_b16 a[252:253], v6 offset:25600
    ds_read_b64_tr_b16 a[254:255], v6 offset:31744
    v_mfma_f32_16x16x32_bf16 v[224:227], a[240:243], v[116:119], v[224:227]
    v_fma_f32 v43, v43, s36, v17
    v_fma_f32 v44, v44, s36, v17
    v_mfma_f32_16x16x32_bf16 a[16:19], a[240:243], v[120:123], a[16:19]
    v_fma_f32 v45, v45, s36, v17
    v_fma_f32 v46, v46, s36, v17
    v_mfma_f32_16x16x32_bf16 a[64:67], a[240:243], v[124:127], a[64:67]
    ds_read_b64_tr_b16 a[240:241], v3 offset:26624
    ds_read_b64_tr_b16 a[242:243], v3 offset:32768
    v_mfma_f32_16x16x32_bf16 v[180:183], a[244:247], v[112:115], v[180:183]
    v_fma_f32 v47, v47, s36, v17
    v_fma_f32 v48, v48, s36, v18
    v_mfma_f32_16x16x32_bf16 v[228:231], a[244:247], v[116:119], v[228:231]
    v_exp_f32 v144, v38
    v_mfma_f32_16x16x32_bf16 a[20:23], a[244:247], v[120:123], a[20:23]
    v_exp_f32 v145, v39
    v_mfma_f32_16x16x32_bf16 a[68:71], a[244:247], v[124:127], a[68:71]
    s_waitcnt lgkmcnt(4)
    ds_read_b64_tr_b16 a[244:245], v4 offset:26624
    ds_read_b64_tr_b16 a[246:247], v4 offset:32768
    v_mfma_f32_16x16x32_bf16 v[184:187], a[248:251], v[112:115], v[184:187]
    v_exp_f32 v146, v42
    v_mfma_f32_16x16x32_bf16 v[232:235], a[248:251], v[116:119], v[232:235]
    v_exp_f32 v147, v43
    v_mfma_f32_16x16x32_bf16 a[24:27], a[248:251], v[120:123], a[24:27]
    v_exp_f32 v148, v44
    v_mfma_f32_16x16x32_bf16 a[72:75], a[248:251], v[124:127], a[72:75]
    s_waitcnt lgkmcnt(3)
    ds_read_b64_tr_b16 a[248:249], v5 offset:26624
    ds_read_b64_tr_b16 a[250:251], v5 offset:32768
    v_mfma_f32_16x16x32_bf16 v[188:191], a[252:255], v[112:115], v[188:191]
    buffer_load_dwordx4 v9, s[20:23], s28 offen offset:2048 lds
    v_mfma_f32_16x16x32_bf16 v[236:239], a[252:255], v[116:119], v[236:239]
    s_add_u32 m0, s33, s32
    v_exp_f32 v149, v45
    v_mfma_f32_16x16x32_bf16 a[28:31], a[252:255], v[120:123], a[28:31]
    v_exp_f32 v150, v46
    v_mfma_f32_16x16x32_bf16 a[76:79], a[252:255], v[124:127], a[76:79]
    s_waitcnt lgkmcnt(2)
    ds_read_b64_tr_b16 a[252:253], v6 offset:26624
    ds_read_b64_tr_b16 a[254:255], v6 offset:32768
    v_mfma_f32_16x16x32_bf16 v[192:195], a[240:243], v[112:115], v[192:195]
    v_exp_f32 v151, v47
    v_mfma_f32_16x16x32_bf16 v[240:243], a[240:243], v[116:119], v[240:243]
    v_cvt_pk_bf16_f32 v99, v144, v145
    v_cvt_pk_bf16_f32 v101, v146, v147
    v_mfma_f32_16x16x32_bf16 a[32:35], a[240:243], v[120:123], a[32:35]
    v_cvt_pk_bf16_f32 v102, v148, v149
    v_cvt_pk_bf16_f32 v103, v150, v151
    v_mfma_f32_16x16x32_bf16 a[80:83], a[240:243], v[124:127], a[80:83]
    v_fma_f32 v49, v49, s36, v18
    v_fma_f32 v50, v50, s36, v18
    v_mfma_f32_16x16x32_bf16 v[196:199], a[244:247], v[112:115], v[196:199]
    v_fma_f32 v51, v51, s36, v18
    v_fma_f32 v52, v52, s36, v18
    v_mfma_f32_16x16x32_bf16 v[244:247], a[244:247], v[116:119], v[244:247]
    v_fma_f32 v53, v53, s36, v18
    v_fma_f32 v54, v54, s36, v18
    v_mfma_f32_16x16x32_bf16 a[36:39], a[244:247], v[120:123], a[36:39]
    v_fma_f32 v55, v55, s36, v18
    v_fma_f32 v56, v56, s36, v19
    v_mfma_f32_16x16x32_bf16 a[84:87], a[244:247], v[124:127], a[84:87]
    s_waitcnt lgkmcnt(1)
    v_exp_f32 v144, v48
    v_mfma_f32_16x16x32_bf16 v[200:203], a[248:251], v[112:115], v[200:203]
    buffer_load_dwordx4 v10, s[24:27], s29 offen offset:0 lds
    v_mfma_f32_16x16x32_bf16 v[248:251], a[248:251], v[116:119], v[248:251]
    v_exp_f32 v145, v49
    v_mfma_f32_16x16x32_bf16 a[40:43], a[248:251], v[120:123], a[40:43]
    v_exp_f32 v146, v50
    v_mfma_f32_16x16x32_bf16 a[88:91], a[248:251], v[124:127], a[88:91]
    s_waitcnt lgkmcnt(0)
    v_exp_f32 v147, v51
    v_mfma_f32_16x16x32_bf16 v[204:207], a[252:255], v[112:115], v[204:207]
    v_exp_f32 v148, v52
    v_mfma_f32_16x16x32_bf16 v[252:255], a[252:255], v[116:119], v[252:255]
    v_exp_f32 v149, v53
    v_mfma_f32_16x16x32_bf16 a[44:47], a[252:255], v[120:123], a[44:47]
    v_exp_f32 v150, v54
    v_mfma_f32_16x16x32_bf16 a[92:95], a[252:255], v[124:127], a[92:95]
    v_exp_f32 v151, v55
    v_mfma_f32_16x16x32_bf16 v[64:67], a[192:195], a[96:99], 0
    v_cvt_pk_bf16_f32 v104, v144, v145
    v_cvt_pk_bf16_f32 v105, v146, v147
    v_mfma_f32_16x16x32_bf16 v[64:67], a[196:199], a[100:103], v[64:67]
    v_cvt_pk_bf16_f32 v106, v148, v149
    v_cvt_pk_bf16_f32 v107, v150, v151
    v_mfma_f32_16x16x32_bf16 v[64:67], a[200:203], a[104:107], v[64:67]
    v_fma_f32 v57, v57, s36, v19
    v_fma_f32 v58, v58, s36, v19
    v_mfma_f32_16x16x32_bf16 v[64:67], a[204:207], a[108:111], v[64:67]
    v_fma_f32 v59, v59, s36, v19
    v_fma_f32 v60, v60, s36, v19
    v_mfma_f32_16x16x32_bf16 v[64:67], a[208:211], a[112:115], v[64:67]
    v_fma_f32 v61, v61, s36, v19
    v_fma_f32 v62, v62, s36, v19
    v_mfma_f32_16x16x32_bf16 v[64:67], a[212:215], a[116:119], v[64:67]
    buffer_load_dwordx4 v11, s[24:27], s29 offen offset:1024 lds
    v_mfma_f32_16x16x32_bf16 v[72:75], a[192:195], a[120:123], 0
    v_fma_f32 v63, v63, s36, v19
    v_add_f32 v20, v20, v128
    v_mfma_f32_16x16x32_bf16 v[128:131], v[24:27], v[96:99], 0
    v_exp_f32 v144, v56
    v_mfma_f32_16x16x32_bf16 v[72:75], a[196:199], a[124:127], v[72:75]
    v_exp_f32 v145, v57
    v_mfma_f32_16x16x32_bf16 v[72:75], a[200:203], a[128:131], v[72:75]
    v_exp_f32 v146, v58
    v_mfma_f32_16x16x32_bf16 v[72:75], a[204:207], a[132:135], v[72:75]
    v_exp_f32 v147, v59
    v_mfma_f32_16x16x32_bf16 v[72:75], a[208:211], a[136:139], v[72:75]
    v_exp_f32 v148, v60
    v_mfma_f32_16x16x32_bf16 v[72:75], a[212:215], a[140:143], v[72:75]
    v_exp_f32 v149, v61
    v_mfma_f32_16x16x32_bf16 v[80:83], a[192:195], a[144:147], 0
    v_exp_f32 v150, v62
    v_mfma_f32_16x16x32_bf16 v[80:83], a[196:199], a[148:151], v[80:83]
    v_exp_f32 v151, v63
    v_mfma_f32_16x16x32_bf16 v[80:83], a[200:203], a[152:155], v[80:83]
    v_cvt_pk_bf16_f32 v108, v144, v145
    v_cvt_pk_bf16_f32 v109, v146, v147
    v_mfma_f32_16x16x32_bf16 v[80:83], a[204:207], a[156:159], v[80:83]
    v_cvt_pk_bf16_f32 v110, v148, v149
    v_cvt_pk_bf16_f32 v111, v150, v151
    v_mfma_f32_16x16x32_bf16 v[80:83], a[208:211], a[160:163], v[80:83]
    buffer_load_dwordx4 v12, s[24:27], s29 offen offset:2048 lds
    v_mfma_f32_16x16x32_bf16 v[80:83], a[212:215], a[164:167], v[80:83]
    s_add_u32 s28, s28, s30
    v_add_f32 v21, v21, v132
    v_add_f32 v22, v22, v136
    v_mfma_f32_16x16x32_bf16 v[132:135], v[24:27], v[100:103], 0
    s_add_u32 s29, s29, s30
    v_add_f32 v23, v23, v140
    v_add_u32 v3, s58, v3
    v_mfma_f32_16x16x32_bf16 v[136:139], v[24:27], v[104:107], 0
    s_add_u32 s33, s33, 24576
    v_add_u32 v4, s58, v4
    v_add_u32 v5, s58, v5
    v_mfma_f32_16x16x32_bf16 v[140:143], v[24:27], v[108:111], 0
    s_cmp_eq_u32 s33, 147456
    v_add_u32 v6, s58, v6
    v_add_u32 v1, s58, v1
    v_mfma_f32_16x16x32_bf16 v[88:91], a[192:195], a[168:171], 0
    s_cselect_b32 s33, 0, s33
    v_max3_f32 v30, v128, v132, v136
    v_add_u32 v2, s58, v2
    v_mfma_f32_16x16x32_bf16 v[88:91], a[196:199], a[172:175], v[88:91]
    v_max_f32 v30, v30, v140
    v_cmp_lt_f32 vcc, s37, v30
    v_mfma_f32_16x16x32_bf16 v[88:91], a[200:203], a[176:179], v[88:91]
    v_mfma_f32_16x16x32_bf16 v[88:91], a[204:207], a[180:183], v[88:91]
    v_mfma_f32_16x16x32_bf16 v[88:91], a[208:211], a[184:187], v[88:91]
    v_mfma_f32_16x16x32_bf16 v[88:91], a[212:215], a[188:191], v[88:91]
    v_mfma_f32_16x16x32_bf16 v[68:71], a[216:219], a[96:99], 0
    s_cbranch_vccnz L_rs_tr34b
L_ret_tr34b:
    v_fma_f32 v64, v64, s36, v16
    v_fma_f32 v65, v65, s36, v16
    v_mfma_f32_16x16x32_bf16 v[68:71], a[220:223], a[100:103], v[68:71]
    v_fma_f32 v66, v66, s36, v16
    v_fma_f32 v67, v67, s36, v16
    v_mfma_f32_16x16x32_bf16 v[68:71], a[224:227], a[104:107], v[68:71]
    v_fma_f32 v72, v72, s36, v17
    v_fma_f32 v73, v73, s36, v17
    v_mfma_f32_16x16x32_bf16 v[68:71], a[228:231], a[108:111], v[68:71]
    v_exp_f32 v144, v64
    v_mfma_f32_16x16x32_bf16 v[68:71], a[232:235], a[112:115], v[68:71]
    v_exp_f32 v145, v65
    v_mfma_f32_16x16x32_bf16 v[68:71], a[236:239], a[116:119], v[68:71]
    v_exp_f32 v146, v66
    v_mfma_f32_16x16x32_bf16 v[76:79], a[216:219], a[120:123], 0
    v_exp_f32 v147, v67
    v_mfma_f32_16x16x32_bf16 v[76:79], a[220:223], a[124:127], v[76:79]
    v_exp_f32 v148, v72
    v_mfma_f32_16x16x32_bf16 v[76:79], a[224:227], a[128:131], v[76:79]
    v_exp_f32 v149, v73
    v_mfma_f32_16x16x32_bf16 v[76:79], a[228:231], a[132:135], v[76:79]
    v_cvt_pk_bf16_f32 v112, v144, v145
    v_cvt_pk_bf16_f32 v113, v146, v147
    s_waitcnt vmcnt(18)
    s_barrier
    v_mfma_f32_16x16x32_bf16 v[76:79], a[232:235], a[136:139], v[76:79]
    v_cvt_pk_bf16_f32 v116, v148, v149
    v_mfma_f32_16x16x32_bf16 v[76:79], a[236:239], a[140:143], v[76:79]
    ds_read_b64_tr_b16 a[240:241], v3 offset:0
    ds_read_b64_tr_b16 a[242:243], v3 offset:6144
    v_mfma_f32_16x16x32_bf16 v[84:87], a[216:219], a[144:147], 0
    v_mfma_f32_16x16x32_bf16 v[84:87], a[220:223], a[148:151], v[84:87]
    ds_read_b64_tr_b16 a[244:245], v4 offset:0
    ds_read_b64_tr_b16 a[246:247], v4 offset:6144
    v_mfma_f32_16x16x32_bf16 v[84:87], a[224:227], a[152:155], v[84:87]
    v_mfma_f32_16x16x32_bf16 v[84:87], a[228:231], a[156:159], v[84:87]
    ds_read_b64_tr_b16 a[248:249], v5 offset:0
    ds_read_b64_tr_b16 a[250:251], v5 offset:6144
    v_mfma_f32_16x16x32_bf16 v[84:87], a[232:235], a[160:163], v[84:87]
    v_mfma_f32_16x16x32_bf16 v[84:87], a[236:239], a[164:167], v[84:87]
    ds_read_b64_tr_b16 a[252:253], v6 offset:0
    ds_read_b64_tr_b16 a[254:255], v6 offset:6144
    v_mfma_f32_16x16x32_bf16 v[92:95], a[216:219], a[168:171], 0
    v_mfma_f32_16x16x32_bf16 v[92:95], a[220:223], a[172:175], v[92:95]
    v_mfma_f32_16x16x32_bf16 v[92:95], a[224:227], a[176:179], v[92:95]
    v_mfma_f32_16x16x32_bf16 v[92:95], a[228:231], a[180:183], v[92:95]
    v_mfma_f32_16x16x32_bf16 v[92:95], a[232:235], a[184:187], v[92:95]
    v_mfma_f32_16x16x32_bf16 v[92:95], a[236:239], a[188:191], v[92:95]
    s_mov_b32 s38, 0
    s_branch L_loop4
L_tr33:
    s_waitcnt vmcnt(6)
    s_waitcnt lgkmcnt(4)
    v_mfma_f32_16x16x32_bf16 v[160:163], a[240:243], v[96:99], v[160:163]
    s_add_u32 s65, s34, 24576
    v_add_u32 v28, s35, v1
    v_add_u32 v29, s35, v2
    ds_read_b128 a[96:99], v28 offset:24576
    ds_read_b128 a[100:103], v29 offset:24576
    ds_read_b128 a[104:107], v28 offset:25600
    ds_read_b128 a[108:111], v29 offset:25600
    ds_read_b128 a[112:115], v28 offset:26624
    ds_read_b128 a[116:119], v29 offset:26624
    v_mfma_f32_16x16x32_bf16 v[208:211], a[240:243], v[100:103], v[208:211]
    s_add_u32 s62, s34, 49152
    v_fma_f32 v68, v68, s36, v16
    v_fma_f32 v69, v69, s36, v16
    v_mfma_f32_16x16x32_bf16 a[0:3], a[240:243], v[104:107], a[0:3]
    s_cmp_eq_u32 s62, 147456
    ds_read_b64_tr_b16 a[240:241], v3 offset:1024
    ds_read_b64_tr_b16 a[242:243], v3 offset:7168
    v_mfma_f32_16x16x32_bf16 v[164:167], a[244:247], v[96:99], v[164:167]
    s_cselect_b32 s62, 0, s62
    v_exp_f32 v150, v68
    v_mfma_f32_16x16x32_bf16 v[212:215], a[244:247], v[100:103], v[212:215]
    s_sub_u32 s56, s62, s34
    v_exp_f32 v151, v69
    v_mfma_f32_16x16x32_bf16 a[4:7], a[244:247], v[104:107], a[4:7]
    s_mov_b32 s34, s62
    ds_read_b64_tr_b16 a[244:245], v4 offset:1024
    ds_read_b64_tr_b16 a[246:247], v4 offset:7168
    s_waitcnt lgkmcnt(10)
    v_mfma_f32_16x16x32_bf16 v[168:171], a[248:251], v[96:99], v[168:171]
    s_and_b32 s63, s3, 1
    v_cvt_pk_bf16_f32 v114, v150, v151
    v_fma_f32 v70, v70, s36, v16
    v_mfma_f32_16x16x32_bf16 v[216:219], a[248:251], v[100:103], v[216:219]
    s_mul_i32 s63, s63, 3072
    v_fma_f32 v71, v71, s36, v16
    v_fma_f32 v74, v74, s36, v17
    v_mfma_f32_16x16x32_bf16 a[8:11], a[248:251], v[104:107], a[8:11]
    s_add_u32 s67, s41, 12288
    ds_read_b64_tr_b16 a[248:249], v5 offset:1024
    ds_read_b64_tr_b16 a[250:251], v5 offset:7168
    v_mfma_f32_16x16x32_bf16 v[172:175], a[252:255], v[96:99], v[172:175]
    s_add_u32 s68, s67, s63
    v_fma_f32 v75, v75, s36, v17
    v_fma_f32 v76, v76, s36, v17
    v_mfma_f32_16x16x32_bf16 v[220:223], a[252:255], v[100:103], v[220:223]
    s_add_u32 s64, s65, s35
    v_fma_f32 v77, v77, s36, v17
    v_fma_f32 v78, v78, s36, v17
    v_mfma_f32_16x16x32_bf16 a[12:15], a[252:255], v[104:107], a[12:15]
    s_add_u32 s64, s64, 0
    ds_read_b64_tr_b16 a[252:253], v6 offset:1024
    ds_read_b64_tr_b16 a[254:255], v6 offset:7168
    s_waitcnt lgkmcnt(6)
    v_mfma_f32_16x16x32_bf16 v[176:179], a[240:243], v[96:99], v[176:179]
    s_add_u32 m0, s64, s63
    v_fma_f32 v79, v79, s36, v17
    v_fma_f32 v80, v80, s36, v18
    v_mfma_f32_16x16x32_bf16 v[224:227], a[240:243], v[100:103], v[224:227]
    buffer_load_dwordx4 v7, s[12:15], s68 offen offset:0 nt lds
    v_mfma_f32_16x16x32_bf16 a[16:19], a[240:243], v[104:107], a[16:19]
    buffer_load_dwordx4 v8, s[12:15], s68 offen offset:1024 nt lds
    s_waitcnt lgkmcnt(4)
    v_mfma_f32_16x16x32_bf16 v[180:183], a[244:247], v[96:99], v[180:183]
    buffer_load_dwordx4 v9, s[12:15], s68 offen offset:2048 nt lds
    v_mfma_f32_16x16x32_bf16 v[228:231], a[244:247], v[100:103], v[228:231]
    s_sub_u32 s63, 3072, s63
    ds_read_b64_tr_b16 a[240:241], v3 offset:2048
    ds_read_b64_tr_b16 a[242:243], v3 offset:8192
    v_mfma_f32_16x16x32_bf16 a[20:23], a[244:247], v[104:107], a[20:23]
    s_add_u32 s68, s67, s63
    ds_read_b64_tr_b16 a[244:245], v4 offset:2048
    ds_read_b64_tr_b16 a[246:247], v4 offset:8192
    s_waitcnt lgkmcnt(6)
    v_mfma_f32_16x16x32_bf16 v[184:187], a[248:251], v[96:99], v[184:187]
    s_add_u32 m0, s64, s63
    v_exp_f32 v144, v70
    v_mfma_f32_16x16x32_bf16 v[232:235], a[248:251], v[100:103], v[232:235]
    v_exp_f32 v145, v71
    v_mfma_f32_16x16x32_bf16 a[24:27], a[248:251], v[104:107], a[24:27]
    s_waitcnt lgkmcnt(4)
    ds_read_b64_tr_b16 a[248:249], v5 offset:2048
    ds_read_b64_tr_b16 a[250:251], v5 offset:8192
    v_mfma_f32_16x16x32_bf16 v[188:191], a[252:255], v[96:99], v[188:191]
    v_exp_f32 v146, v74
    v_mfma_f32_16x16x32_bf16 v[236:239], a[252:255], v[100:103], v[236:239]
    v_exp_f32 v147, v75
    v_mfma_f32_16x16x32_bf16 a[28:31], a[252:255], v[104:107], a[28:31]
    ds_read_b64_tr_b16 a[252:253], v6 offset:2048
    ds_read_b64_tr_b16 a[254:255], v6 offset:8192
    v_exp_f32 v148, v76
    v_exp_f32 v149, v77
    v_exp_f32 v150, v78
    s_waitcnt lgkmcnt(6)
    v_mfma_f32_16x16x32_bf16 v[192:195], a[240:243], v[96:99], v[192:195]
    v_exp_f32 v151, v79
    v_mfma_f32_16x16x32_bf16 v[240:243], a[240:243], v[100:103], v[240:243]
    v_cvt_pk_bf16_f32 v115, v144, v145
    v_cvt_pk_bf16_f32 v117, v146, v147
    v_mfma_f32_16x16x32_bf16 a[32:35], a[240:243], v[104:107], a[32:35]
    s_waitcnt lgkmcnt(4)
    v_cvt_pk_bf16_f32 v118, v148, v149
    v_cvt_pk_bf16_f32 v119, v150, v151
    v_mfma_f32_16x16x32_bf16 v[196:199], a[244:247], v[96:99], v[196:199]
    v_fma_f32 v81, v81, s36, v18
    v_fma_f32 v82, v82, s36, v18
    v_mfma_f32_16x16x32_bf16 v[244:247], a[244:247], v[100:103], v[244:247]
    v_fma_f32 v83, v83, s36, v18
    v_fma_f32 v84, v84, s36, v18
    v_mfma_f32_16x16x32_bf16 a[36:39], a[244:247], v[104:107], a[36:39]
    s_waitcnt lgkmcnt(2)
    v_fma_f32 v85, v85, s36, v18
    v_fma_f32 v86, v86, s36, v18
    v_mfma_f32_16x16x32_bf16 v[200:203], a[248:251], v[96:99], v[200:203]
    v_fma_f32 v87, v87, s36, v18
    v_xor_b32 v156, 80, v7
    v_mfma_f32_16x16x32_bf16 v[248:251], a[248:251], v[100:103], v[248:251]
    buffer_load_dwordx4 v156, s[12:15], s68 offen offset:0 nt lds
    v_mfma_f32_16x16x32_bf16 a[40:43], a[248:251], v[104:107], a[40:43]
    s_waitcnt lgkmcnt(0)
    v_exp_f32 v144, v80
    v_mfma_f32_16x16x32_bf16 v[204:207], a[252:255], v[96:99], v[204:207]
    v_exp_f32 v145, v81
    v_mfma_f32_16x16x32_bf16 v[252:255], a[252:255], v[100:103], v[252:255]
    v_exp_f32 v146, v82
    v_mfma_f32_16x16x32_bf16 a[44:47], a[252:255], v[104:107], a[44:47]
    v_exp_f32 v147, v83
    v_exp_f32 v148, v84
    v_exp_f32 v149, v85
    v_exp_f32 v150, v86
    v_exp_f32 v151, v87
    v_xor_b32 v157, 80, v8
    v_cvt_pk_bf16_f32 v120, v144, v145
    v_cvt_pk_bf16_f32 v121, v146, v147
    v_cvt_pk_bf16_f32 v122, v148, v149
    v_cvt_pk_bf16_f32 v123, v150, v151
    v_xor_b32 v158, 80, v9
    v_add_f32 v20, v20, v128
    v_mfma_f32_16x16x32_bf16 v[128:131], v[24:27], v[112:115], 0
    buffer_load_dwordx4 v157, s[12:15], s68 offen offset:1024 nt lds
    buffer_load_dwordx4 v158, s[12:15], s68 offen offset:2048 nt lds
    s_add_u32 m0, s33, s31
    v_add_f32 v21, v21, v132
    v_mfma_f32_16x16x32_bf16 v[132:135], v[24:27], v[116:119], 0
    buffer_load_dwordx4 v7, s[20:23], s28 offen offset:0 lds
    buffer_load_dwordx4 v8, s[20:23], s28 offen offset:1024 lds
    buffer_load_dwordx4 v9, s[20:23], s28 offen offset:2048 lds
    s_add_u32 m0, s33, s32
    v_add_f32 v22, v22, v136
    v_mfma_f32_16x16x32_bf16 v[136:139], v[24:27], v[120:123], 0
    buffer_load_dwordx4 v10, s[24:27], s29 offen offset:0 lds
    buffer_load_dwordx4 v11, s[24:27], s29 offen offset:1024 lds
    buffer_load_dwordx4 v12, s[24:27], s29 offen offset:2048 lds
    s_waitcnt vmcnt(12)
    s_barrier
    s_add_u32 s28, s28, s30
    s_add_u32 s29, s29, s30
    s_add_u32 s33, s33, 24576
    v_max3_f32 v30, v128, v132, v136
    v_cmp_lt_f32 vcc, s37, v30
    v_add_u32 v154, s56, v28
    v_add_u32 v155, s56, v29
    s_cmp_eq_u32 s33, 147456
    ds_read_b128 a[120:123], v154 offset:0
    ds_read_b128 a[124:127], v155 offset:0
    s_cbranch_vccnz L_rs_tr33A
L_ret_tr33A:
    ds_read_b128 a[128:131], v154 offset:1024
    ds_read_b128 a[132:135], v155 offset:1024
    ds_read_b128 a[136:139], v154 offset:2048
    ds_read_b128 a[140:143], v155 offset:2048
    v_add_u32 v3, s56, v3
    v_add_u32 v4, s56, v4
    v_add_u32 v5, s56, v5
    v_add_u32 v6, s56, v6
    s_cselect_b32 s33, 0, s33
    ds_read_b64_tr_b16 a[240:241], v3 offset:24576
    ds_read_b64_tr_b16 a[242:243], v3 offset:30720
    ds_read_b64_tr_b16 a[244:245], v4 offset:24576
    ds_read_b64_tr_b16 a[246:247], v4 offset:30720
    ds_read_b64_tr_b16 a[248:249], v5 offset:24576
    ds_read_b64_tr_b16 a[250:251], v5 offset:30720
    ds_read_b64_tr_b16 a[252:253], v6 offset:24576
    ds_read_b64_tr_b16 a[254:255], v6 offset:30720
    s_add_u32 s84, s42, 0
    s_add_u32 s85, s42, 6144
    s_add_u32 s86, s42, 12288
    s_waitcnt lgkmcnt(6)
    v_mfma_f32_16x16x32_bf16 v[160:163], a[240:243], v[112:115], v[160:163]
    s_add_u32 m0, s33, s31
    v_add_f32 v20, v20, v128
    v_add_f32 v21, v21, v132
    v_mfma_f32_16x16x32_bf16 v[208:211], a[240:243], v[116:119], v[208:211]
    v_rcp_f32 v130, v20
    v_mov_b32 v96, v15
    v_mfma_f32_16x16x32_bf16 a[0:3], a[240:243], v[120:123], a[0:3]
    s_waitcnt lgkmcnt(4)
    ds_read_b64_tr_b16 a[240:241], v3 offset:25600
    ds_read_b64_tr_b16 a[242:243], v3 offset:31744
    v_rcp_f32 v134, v21
    v_mfma_f32_16x16x32_bf16 v[164:167], a[244:247], v[112:115], v[164:167]
    v_mul_f32 v160, v160, v130
    v_mul_f32 v161, v161, v130
    v_mul_f32 v162, v162, v130
    v_mul_f32 v163, v163, v130
    v_mfma_f32_16x16x32_bf16 v[212:215], a[244:247], v[116:119], v[212:215]
    v_mul_f32 v208, v208, v134
    v_mul_f32 v209, v209, v134
    v_mul_f32 v210, v210, v134
    v_mul_f32 v211, v211, v134
    v_mfma_f32_16x16x32_bf16 a[4:7], a[244:247], v[120:123], a[4:7]
    ds_read_b64_tr_b16 a[244:245], v4 offset:25600
    ds_read_b64_tr_b16 a[246:247], v4 offset:31744
    v_cvt_pk_bf16_f32 v80, v160, v161
    v_cvt_pk_bf16_f32 v81, v162, v163
    s_waitcnt lgkmcnt(4)
    v_mfma_f32_16x16x32_bf16 v[168:171], a[248:251], v[112:115], v[168:171]
    v_cvt_pk_bf16_f32 v82, v208, v209
    v_cvt_pk_bf16_f32 v83, v210, v211
    v_mul_f32 v164, v164, v130
    v_mul_f32 v165, v165, v130
    v_mfma_f32_16x16x32_bf16 v[216:219], a[248:251], v[116:119], v[216:219]
    v_mul_f32 v166, v166, v130
    v_mul_f32 v167, v167, v130
    v_mul_f32 v212, v212, v134
    v_mul_f32 v213, v213, v134
    v_mfma_f32_16x16x32_bf16 a[8:11], a[248:251], v[120:123], a[8:11]
    ds_read_b64_tr_b16 a[248:249], v5 offset:25600
    ds_read_b64_tr_b16 a[250:251], v5 offset:31744
    v_mul_f32 v214, v214, v134
    v_mul_f32 v215, v215, v134
    v_mfma_f32_16x16x32_bf16 v[172:175], a[252:255], v[112:115], v[172:175]
    v_xor_b32 v97, 32, v15
    v_cvt_pk_bf16_f32 v84, v164, v165
    v_cvt_pk_bf16_f32 v85, v166, v167
    v_cvt_pk_bf16_f32 v86, v212, v213
    v_mfma_f32_16x16x32_bf16 v[220:223], a[252:255], v[116:119], v[220:223]
    v_cvt_pk_bf16_f32 v87, v214, v215
    v_mul_f32 v168, v168, v130
    v_mul_f32 v169, v169, v130
    v_mul_f32 v170, v170, v130
    v_mfma_f32_16x16x32_bf16 a[12:15], a[252:255], v[120:123], a[12:15]
    ds_read_b64_tr_b16 a[252:253], v6 offset:25600
    ds_read_b64_tr_b16 a[254:255], v6 offset:31744
    v_mul_f32 v171, v171, v130
    v_mul_f32 v216, v216, v134
    s_waitcnt lgkmcnt(4)
    v_mfma_f32_16x16x32_bf16 v[176:179], a[240:243], v[112:115], v[176:179]
    buffer_load_dwordx4 v7, s[20:23], s28 offen offset:0 lds
    s_waitcnt vmcnt(7)
    ds_read_b128 a[144:147], v28 offset:24576
    ds_read_b128 a[148:151], v29 offset:24576
    ds_read_b128 a[152:155], v28 offset:25600
    ds_read_b128 a[156:159], v29 offset:25600
    ds_read_b128 a[160:163], v28 offset:26624
    ds_read_b128 a[164:167], v29 offset:26624
    v_mfma_f32_16x16x32_bf16 v[224:227], a[240:243], v[116:119], v[224:227]
    v_mul_f32 v217, v217, v134
    v_mul_f32 v218, v218, v134
    v_mfma_f32_16x16x32_bf16 a[16:19], a[240:243], v[120:123], a[16:19]
    ds_read_b64_tr_b16 a[240:241], v3 offset:26624
    ds_read_b64_tr_b16 a[242:243], v3 offset:32768
    v_mfma_f32_16x16x32_bf16 v[180:183], a[244:247], v[112:115], v[180:183]
    v_mul_f32 v219, v219, v134
    v_xor_b32 v98, 64, v15
    v_mfma_f32_16x16x32_bf16 v[228:231], a[244:247], v[116:119], v[228:231]
    v_cvt_pk_bf16_f32 v88, v168, v169
    v_cvt_pk_bf16_f32 v89, v170, v171
    v_cvt_pk_bf16_f32 v90, v216, v217
    v_cvt_pk_bf16_f32 v91, v218, v219
    v_mfma_f32_16x16x32_bf16 a[20:23], a[244:247], v[120:123], a[20:23]
    buffer_load_dwordx4 v8, s[20:23], s28 offen offset:1024 lds
    ds_read_b64_tr_b16 a[244:245], v4 offset:26624
    ds_read_b64_tr_b16 a[246:247], v4 offset:32768
    s_waitcnt lgkmcnt(10)
    v_mfma_f32_16x16x32_bf16 v[184:187], a[248:251], v[112:115], v[184:187]
    v_mul_f32 v172, v172, v130
    v_mul_f32 v173, v173, v130
    v_mul_f32 v174, v174, v130
    ds_read_b128 a[192:195], v1 offset:0
    v_mfma_f32_16x16x32_bf16 v[232:235], a[248:251], v[116:119], v[232:235]
    v_mul_f32 v175, v175, v130
    v_mul_f32 v220, v220, v134
    ds_read_b128 a[196:199], v2 offset:0
    v_mfma_f32_16x16x32_bf16 a[24:27], a[248:251], v[120:123], a[24:27]
    buffer_load_dwordx4 v9, s[20:23], s28 offen offset:2048 lds
    ds_read_b64_tr_b16 a[248:249], v5 offset:26624
    ds_read_b64_tr_b16 a[250:251], v5 offset:32768
    ds_read_b128 a[200:203], v1 offset:1024
    ds_read_b128 a[204:207], v2 offset:1024
    v_mfma_f32_16x16x32_bf16 v[188:191], a[252:255], v[112:115], v[188:191]
    s_add_u32 m0, s33, s32
    v_mul_f32 v221, v221, v134
    v_mul_f32 v222, v222, v134
    ds_read_b128 a[208:211], v1 offset:2048
    v_mfma_f32_16x16x32_bf16 v[236:239], a[252:255], v[116:119], v[236:239]
    v_mul_f32 v223, v223, v134
    v_xor_b32 v99, 96, v15
    ds_read_b128 a[212:215], v2 offset:2048
    v_mfma_f32_16x16x32_bf16 a[28:31], a[252:255], v[120:123], a[28:31]
    buffer_load_dwordx4 v10, s[24:27], s29 offen offset:0 lds
    ds_read_b64_tr_b16 a[252:253], v6 offset:26624
    ds_read_b64_tr_b16 a[254:255], v6 offset:32768
    ds_read_b128 a[216:219], v1 offset:6144
    ds_read_b128 a[220:223], v2 offset:6144
    s_waitcnt lgkmcnt(11)
    v_mfma_f32_16x16x32_bf16 v[192:195], a[240:243], v[112:115], v[192:195]
    v_cvt_pk_bf16_f32 v92, v172, v173
    v_cvt_pk_bf16_f32 v93, v174, v175
    ds_read_b128 a[224:227], v1 offset:7168
    v_mfma_f32_16x16x32_bf16 v[240:243], a[240:243], v[116:119], v[240:243]
    v_cvt_pk_bf16_f32 v94, v220, v221
    v_cvt_pk_bf16_f32 v95, v222, v223
    ds_read_b128 a[228:231], v2 offset:7168
    v_mfma_f32_16x16x32_bf16 a[32:35], a[240:243], v[120:123], a[32:35]
    buffer_load_dwordx4 v11, s[24:27], s29 offen offset:1024 lds
    ds_read_b128 a[232:235], v1 offset:8192
    v_mfma_f32_16x16x32_bf16 v[196:199], a[244:247], v[112:115], v[196:199]
    ds_read_b128 a[236:239], v2 offset:8192
    v_mfma_f32_16x16x32_bf16 v[244:247], a[244:247], v[116:119], v[244:247]
    v_add_f32 v22, v22, v136
    v_accvgpr_read_b32 v64, a0
    v_mfma_f32_16x16x32_bf16 a[36:39], a[244:247], v[120:123], a[36:39]
    s_waitcnt lgkmcnt(5)
    v_rcp_f32 v138, v22
    v_mfma_f32_16x16x32_bf16 v[200:203], a[248:251], v[112:115], v[200:203]
    v_accvgpr_read_b32 v65, a1
    v_accvgpr_read_b32 v66, a2
    v_mfma_f32_16x16x32_bf16 v[248:251], a[248:251], v[116:119], v[248:251]
    v_accvgpr_read_b32 v67, a3
    v_mul_f32 v64, v64, v138
    v_mfma_f32_16x16x32_bf16 a[40:43], a[248:251], v[120:123], a[40:43]
    buffer_load_dwordx4 v12, s[24:27], s29 offen offset:2048 lds
    v_mfma_f32_16x16x32_bf16 v[204:207], a[252:255], v[112:115], v[204:207]
    s_add_u32 s28, s28, s30
    v_mul_f32 v65, v65, v138
    v_mul_f32 v66, v66, v138
    v_mfma_f32_16x16x32_bf16 v[252:255], a[252:255], v[116:119], v[252:255]
    s_add_u32 s29, s29, s30
    v_mul_f32 v67, v67, v138
    v_mul_f32 v176, v176, v130
    v_mfma_f32_16x16x32_bf16 a[44:47], a[252:255], v[120:123], a[44:47]
    s_add_u32 s33, s33, 24576
    v_mul_f32 v177, v177, v130
    v_mul_f32 v178, v178, v130
    v_mfma_f32_16x16x32_bf16 v[32:35], a[192:195], a[96:99], 0
    s_cmp_eq_u32 s33, 147456
    v_mul_f32 v179, v179, v130
    v_accvgpr_read_b32 v68, a4
    v_accvgpr_read_b32 v69, a5
    v_accvgpr_read_b32 v70, a6
    v_mfma_f32_16x16x32_bf16 v[32:35], a[196:199], a[100:103], v[32:35]
    s_cselect_b32 s33, 0, s33
    v_accvgpr_read_b32 v71, a7
    v_mul_f32 v68, v68, v138
    v_mul_f32 v69, v69, v138
    v_mul_f32 v70, v70, v138
    v_mfma_f32_16x16x32_bf16 v[32:35], a[200:203], a[104:107], v[32:35]
    s_add_u32 s62, s34, 49152
    v_mul_f32 v71, v71, v138
    v_mul_f32 v180, v180, v130
    v_mul_f32 v181, v181, v130
    v_mul_f32 v182, v182, v130
    v_mfma_f32_16x16x32_bf16 v[32:35], a[204:207], a[108:111], v[32:35]
    s_cmp_eq_u32 s62, 147456
    v_mul_f32 v183, v183, v130
    v_accvgpr_read_b32 v72, a8
    v_accvgpr_read_b32 v73, a9
    v_accvgpr_read_b32 v74, a10
    v_mfma_f32_16x16x32_bf16 v[32:35], a[208:211], a[112:115], v[32:35]
    s_cselect_b32 s62, 0, s62
    v_accvgpr_read_b32 v75, a11
    v_mul_f32 v72, v72, v138
    v_mul_f32 v73, v73, v138
    v_mul_f32 v74, v74, v138
    v_mfma_f32_16x16x32_bf16 v[32:35], a[212:215], a[116:119], v[32:35]
    s_sub_u32 s57, s62, s34
    v_mul_f32 v75, v75, v138
    v_mul_f32 v184, v184, v130
    v_mul_f32 v185, v185, v130
    v_mul_f32 v186, v186, v130
    v_mfma_f32_16x16x32_bf16 v[36:39], a[216:219], a[96:99], 0
    s_mov_b32 s34, s62
    v_mul_f32 v187, v187, v130
    v_accvgpr_read_b32 v76, a12
    v_accvgpr_read_b32 v77, a13
    v_accvgpr_read_b32 v78, a14
    s_waitcnt lgkmcnt(0)
    v_mfma_f32_16x16x32_bf16 v[36:39], a[220:223], a[100:103], v[36:39]
    v_accvgpr_read_b32 v79, a15
    v_mul_f32 v76, v76, v138
    v_mul_f32 v77, v77, v138
    v_mul_f32 v78, v78, v138
    v_mfma_f32_16x16x32_bf16 v[36:39], a[224:227], a[104:107], v[36:39]
    v_mul_f32 v79, v79, v138
    v_mul_f32 v188, v188, v130
    v_mul_f32 v189, v189, v130
    v_mul_f32 v190, v190, v130
    v_mfma_f32_16x16x32_bf16 v[36:39], a[228:231], a[108:111], v[36:39]
    v_mul_f32 v191, v191, v130
    v_add_u32 v3, s57, v3
    v_add_u32 v4, s57, v4
    v_add_u32 v5, s57, v5
    v_mfma_f32_16x16x32_bf16 v[36:39], a[232:235], a[112:115], v[36:39]
    v_add_u32 v6, s57, v6
    v_add_u32 v1, s56, v1
    v_add_u32 v2, s56, v2
    v_mfma_f32_16x16x32_bf16 v[36:39], a[236:239], a[116:119], v[36:39]
    ds_write2st64_b64 v96, v[80:81], v[82:83] offset0:0 offset1:4
    v_mfma_f32_16x16x32_bf16 v[40:43], a[192:195], a[120:123], 0
    v_cvt_pk_bf16_f32 v80, v64, v65
    v_cvt_pk_bf16_f32 v81, v66, v67
    v_cvt_pk_bf16_f32 v82, v176, v177
    v_mfma_f32_16x16x32_bf16 v[40:43], a[196:199], a[124:127], v[40:43]
    v_cvt_pk_bf16_f32 v83, v178, v179
    v_accvgpr_read_b32 v64, a16
    v_accvgpr_read_b32 v65, a17
    v_accvgpr_read_b32 v66, a18
    v_mfma_f32_16x16x32_bf16 v[40:43], a[200:203], a[128:131], v[40:43]
    v_accvgpr_read_b32 v67, a19
    v_mfma_f32_16x16x32_bf16 v[40:43], a[204:207], a[132:135], v[40:43]
    ds_write2st64_b64 v97, v[84:85], v[86:87] offset0:0 offset1:4
    v_mfma_f32_16x16x32_bf16 v[40:43], a[208:211], a[136:139], v[40:43]
    v_cvt_pk_bf16_f32 v84, v68, v69
    v_cvt_pk_bf16_f32 v85, v70, v71
    v_cvt_pk_bf16_f32 v86, v180, v181
    v_mfma_f32_16x16x32_bf16 v[40:43], a[212:215], a[140:143], v[40:43]
    v_cvt_pk_bf16_f32 v87, v182, v183
    v_accvgpr_read_b32 v68, a20
    v_accvgpr_read_b32 v69, a21
    v_accvgpr_read_b32 v70, a22
    v_mfma_f32_16x16x32_bf16 v[44:47], a[216:219], a[120:123], 0
    v_accvgpr_read_b32 v71, a23
    v_mfma_f32_16x16x32_bf16 v[44:47], a[220:223], a[124:127], v[44:47]
    ds_write2st64_b64 v98, v[88:89], v[90:91] offset0:0 offset1:4
    v_mfma_f32_16x16x32_bf16 v[44:47], a[224:227], a[128:131], v[44:47]
    v_cvt_pk_bf16_f32 v88, v72, v73
    v_cvt_pk_bf16_f32 v89, v74, v75
    v_cvt_pk_bf16_f32 v90, v184, v185
    v_mfma_f32_16x16x32_bf16 v[44:47], a[228:231], a[132:135], v[44:47]
    v_cvt_pk_bf16_f32 v91, v186, v187
    v_accvgpr_read_b32 v72, a24
    v_accvgpr_read_b32 v73, a25
    v_accvgpr_read_b32 v74, a26
    v_mfma_f32_16x16x32_bf16 v[44:47], a[232:235], a[136:139], v[44:47]
    v_accvgpr_read_b32 v75, a27
    v_mfma_f32_16x16x32_bf16 v[44:47], a[236:239], a[140:143], v[44:47]
    ds_write2st64_b64 v99, v[92:93], v[94:95] offset0:0 offset1:4
    v_mfma_f32_16x16x32_bf16 v[48:51], a[192:195], a[144:147], 0
    ds_read_b128 v[144:147], v14 offset:0
    ds_read_b128 v[148:151], v14 offset:1024
    ds_read_b128 v[152:155], v14 offset:2048
    ds_read_b128 v[156:159], v14 offset:3072
    v_mfma_f32_16x16x32_bf16 v[48:51], a[196:199], a[148:151], v[48:51]
    v_cvt_pk_bf16_f32 v92, v76, v77
    v_cvt_pk_bf16_f32 v93, v78, v79
    v_cvt_pk_bf16_f32 v94, v188, v189
    v_mfma_f32_16x16x32_bf16 v[48:51], a[200:203], a[152:155], v[48:51]
    v_cvt_pk_bf16_f32 v95, v190, v191
    v_accvgpr_read_b32 v76, a28
    v_accvgpr_read_b32 v77, a29
    v_accvgpr_read_b32 v78, a30
    v_mfma_f32_16x16x32_bf16 v[48:51], a[204:207], a[156:159], v[48:51]
    v_accvgpr_read_b32 v79, a31
    v_mfma_f32_16x16x32_bf16 v[48:51], a[208:211], a[160:163], v[48:51]
    ds_write2st64_b64 v96, v[80:81], v[82:83] offset0:0 offset1:4
    v_mfma_f32_16x16x32_bf16 v[48:51], a[212:215], a[164:167], v[48:51]
    ds_write2st64_b64 v97, v[84:85], v[86:87] offset0:0 offset1:4
    v_mfma_f32_16x16x32_bf16 v[52:55], a[216:219], a[144:147], 0
    s_waitcnt lgkmcnt(5)
    buffer_store_dwordx4 v[144:147], v13, s[16:19], s84 offen offset:0 nt
    v_mfma_f32_16x16x32_bf16 v[52:55], a[220:223], a[148:151], v[52:55]
    ds_write2st64_b64 v98, v[88:89], v[90:91] offset0:0 offset1:4
    v_mfma_f32_16x16x32_bf16 v[52:55], a[224:227], a[152:155], v[52:55]
    ds_write2st64_b64 v99, v[92:93], v[94:95] offset0:0 offset1:4
    v_mfma_f32_16x16x32_bf16 v[52:55], a[228:231], a[156:159], v[52:55]
    s_waitcnt lgkmcnt(4)
    buffer_store_dwordx4 v[148:151], v13, s[16:19], s84 offen offset:3072 nt
    ds_read_b128 v[144:147], v14 offset:0
    ds_read_b128 v[148:151], v14 offset:1024
    v_mfma_f32_16x16x32_bf16 v[52:55], a[232:235], a[160:163], v[52:55]
    v_mfma_f32_16x16x32_bf16 v[52:55], a[236:239], a[164:167], v[52:55]
    s_barrier
    buffer_store_dwordx4 v[152:155], v13, s[16:19], s85 offen offset:0 nt
    v_pk_mul_f32 v[224:225], v[224:225], v[134:135] op_sel_hi:[1,0]
    v_pk_mul_f32 v[226:227], v[226:227], v[134:135] op_sel_hi:[1,0]
    v_pk_mul_f32 v[64:65], v[64:65], v[138:139] op_sel_hi:[1,0]
    v_pk_mul_f32 v[66:67], v[66:67], v[138:139] op_sel_hi:[1,0]
    v_cvt_pk_bf16_f32 v80, v224, v225
    v_cvt_pk_bf16_f32 v81, v226, v227
    v_cvt_pk_bf16_f32 v82, v64, v65
    v_cvt_pk_bf16_f32 v83, v66, v67
    v_pk_mul_f32 v[228:229], v[228:229], v[134:135] op_sel_hi:[1,0]
    v_pk_mul_f32 v[230:231], v[230:231], v[134:135] op_sel_hi:[1,0]
    v_pk_mul_f32 v[68:69], v[68:69], v[138:139] op_sel_hi:[1,0]
    v_pk_mul_f32 v[70:71], v[70:71], v[138:139] op_sel_hi:[1,0]
    v_cvt_pk_bf16_f32 v84, v228, v229
    v_cvt_pk_bf16_f32 v85, v230, v231
    v_cvt_pk_bf16_f32 v86, v68, v69
    v_cvt_pk_bf16_f32 v87, v70, v71
    v_pk_mul_f32 v[232:233], v[232:233], v[134:135] op_sel_hi:[1,0]
    v_pk_mul_f32 v[234:235], v[234:235], v[134:135] op_sel_hi:[1,0]
    v_pk_mul_f32 v[72:73], v[72:73], v[138:139] op_sel_hi:[1,0]
    v_pk_mul_f32 v[74:75], v[74:75], v[138:139] op_sel_hi:[1,0]
    v_cvt_pk_bf16_f32 v88, v232, v233
    v_cvt_pk_bf16_f32 v89, v234, v235
    v_cvt_pk_bf16_f32 v90, v72, v73
    v_cvt_pk_bf16_f32 v91, v74, v75
    v_pk_mul_f32 v[236:237], v[236:237], v[134:135] op_sel_hi:[1,0]
    v_pk_mul_f32 v[238:239], v[238:239], v[134:135] op_sel_hi:[1,0]
    v_pk_mul_f32 v[76:77], v[76:77], v[138:139] op_sel_hi:[1,0]
    v_pk_mul_f32 v[78:79], v[78:79], v[138:139] op_sel_hi:[1,0]
    v_cvt_pk_bf16_f32 v92, v236, v237
    v_cvt_pk_bf16_f32 v93, v238, v239
    v_cvt_pk_bf16_f32 v94, v76, v77
    v_cvt_pk_bf16_f32 v95, v78, v79
    v_pk_mul_f32 v[192:193], v[192:193], v[130:131] op_sel_hi:[1,0]
    v_pk_mul_f32 v[194:195], v[194:195], v[130:131] op_sel_hi:[1,0]
    v_pk_mul_f32 v[240:241], v[240:241], v[134:135] op_sel_hi:[1,0]
    v_pk_mul_f32 v[242:243], v[242:243], v[134:135] op_sel_hi:[1,0]
    v_pk_mul_f32 v[196:197], v[196:197], v[130:131] op_sel_hi:[1,0]
    v_pk_mul_f32 v[198:199], v[198:199], v[130:131] op_sel_hi:[1,0]
    v_pk_mul_f32 v[244:245], v[244:245], v[134:135] op_sel_hi:[1,0]
    v_pk_mul_f32 v[246:247], v[246:247], v[134:135] op_sel_hi:[1,0]
    v_pk_mul_f32 v[200:201], v[200:201], v[130:131] op_sel_hi:[1,0]
    v_pk_mul_f32 v[202:203], v[202:203], v[130:131] op_sel_hi:[1,0]
    v_pk_mul_f32 v[248:249], v[248:249], v[134:135] op_sel_hi:[1,0]
    v_pk_mul_f32 v[250:251], v[250:251], v[134:135] op_sel_hi:[1,0]
    v_pk_mul_f32 v[204:205], v[204:205], v[130:131] op_sel_hi:[1,0]
    v_pk_mul_f32 v[206:207], v[206:207], v[130:131] op_sel_hi:[1,0]
    v_pk_mul_f32 v[252:253], v[252:253], v[134:135] op_sel_hi:[1,0]
    v_pk_mul_f32 v[254:255], v[254:255], v[134:135] op_sel_hi:[1,0]
    v_accvgpr_read_b32 v64, a32
    v_accvgpr_read_b32 v65, a33
    v_accvgpr_read_b32 v66, a34
    v_accvgpr_read_b32 v67, a35
    v_pk_mul_f32 v[64:65], v[64:65], v[138:139] op_sel_hi:[1,0]
    v_pk_mul_f32 v[66:67], v[66:67], v[138:139] op_sel_hi:[1,0]
    v_accvgpr_read_b32 v68, a36
    v_accvgpr_read_b32 v69, a37
    v_accvgpr_read_b32 v70, a38
    v_accvgpr_read_b32 v71, a39
    v_pk_mul_f32 v[68:69], v[68:69], v[138:139] op_sel_hi:[1,0]
    v_pk_mul_f32 v[70:71], v[70:71], v[138:139] op_sel_hi:[1,0]
    v_accvgpr_read_b32 v72, a40
    v_accvgpr_read_b32 v73, a41
    v_accvgpr_read_b32 v74, a42
    v_accvgpr_read_b32 v75, a43
    v_pk_mul_f32 v[72:73], v[72:73], v[138:139] op_sel_hi:[1,0]
    v_pk_mul_f32 v[74:75], v[74:75], v[138:139] op_sel_hi:[1,0]
    v_accvgpr_read_b32 v76, a44
    v_accvgpr_read_b32 v77, a45
    v_accvgpr_read_b32 v78, a46
    v_accvgpr_read_b32 v79, a47
    v_pk_mul_f32 v[76:77], v[76:77], v[138:139] op_sel_hi:[1,0]
    v_pk_mul_f32 v[78:79], v[78:79], v[138:139] op_sel_hi:[1,0]
    ds_read_b128 v[152:155], v14 offset:2048
    buffer_store_dwordx4 v[156:159], v13, s[16:19], s85 offen offset:3072 nt
    s_waitcnt lgkmcnt(1)
    buffer_store_dwordx4 v[144:147], v13, s[16:19], s86 offen offset:0 nt
    ds_read_b128 v[156:159], v14 offset:3072
    ds_write2st64_b64 v96, v[80:81], v[82:83] offset0:0 offset1:4
    ds_write2st64_b64 v97, v[84:85], v[86:87] offset0:0 offset1:4
    ds_write2st64_b64 v98, v[88:89], v[90:91] offset0:0 offset1:4
    buffer_store_dwordx4 v[148:151], v13, s[16:19], s86 offen offset:3072 nt
    ds_write2st64_b64 v99, v[92:93], v[94:95] offset0:0 offset1:4
    ds_read_b128 v[144:147], v14 offset:0
    ds_read_b128 v[148:151], v14 offset:1024
    v_cvt_pk_bf16_f32 v80, v192, v193
    v_cvt_pk_bf16_f32 v81, v194, v195
    v_cvt_pk_bf16_f32 v82, v240, v241
    v_cvt_pk_bf16_f32 v83, v242, v243
    v_cvt_pk_bf16_f32 v84, v196, v197
    v_cvt_pk_bf16_f32 v85, v198, v199
    v_cvt_pk_bf16_f32 v86, v244, v245
    v_cvt_pk_bf16_f32 v87, v246, v247
    v_cvt_pk_bf16_f32 v88, v200, v201
    v_cvt_pk_bf16_f32 v89, v202, v203
    v_cvt_pk_bf16_f32 v90, v248, v249
    v_cvt_pk_bf16_f32 v91, v250, v251
    v_cvt_pk_bf16_f32 v92, v204, v205
    v_cvt_pk_bf16_f32 v93, v206, v207
    v_cvt_pk_bf16_f32 v94, v252, v253
    v_cvt_pk_bf16_f32 v95, v254, v255
    s_waitcnt lgkmcnt(5)
    buffer_store_dwordx4 v[152:155], v13, s[16:19], s84 offen offset:128 nt
    buffer_store_dwordx4 v[156:159], v13, s[16:19], s84 offen offset:3200 nt
    ds_read_b128 v[152:155], v14 offset:2048
    ds_read_b128 v[156:159], v14 offset:3072
    ds_write2st64_b64 v96, v[80:81], v[82:83] offset0:0 offset1:4
    ds_write2st64_b64 v97, v[84:85], v[86:87] offset0:0 offset1:4
    ds_write2st64_b64 v98, v[88:89], v[90:91] offset0:0 offset1:4
    s_waitcnt lgkmcnt(5)
    buffer_store_dwordx4 v[144:147], v13, s[16:19], s85 offen offset:128 nt
    ds_write2st64_b64 v99, v[92:93], v[94:95] offset0:0 offset1:4
    ds_read_b128 v[144:147], v14 offset:0
    v_cvt_pk_bf16_f32 v80, v64, v65
    v_cvt_pk_bf16_f32 v81, v66, v67
    v_cvt_pk_bf16_f32 v84, v68, v69
    v_cvt_pk_bf16_f32 v85, v70, v71
    v_cvt_pk_bf16_f32 v88, v72, v73
    v_cvt_pk_bf16_f32 v89, v74, v75
    v_cvt_pk_bf16_f32 v92, v76, v77
    v_cvt_pk_bf16_f32 v93, v78, v79
    buffer_store_dwordx4 v[148:151], v13, s[16:19], s85 offen offset:3200 nt
    s_waitcnt lgkmcnt(2)
    buffer_store_dwordx4 v[152:155], v13, s[16:19], s86 offen offset:128 nt
    ds_read_b128 v[148:151], v14 offset:1024
    ds_read_b128 v[152:155], v14 offset:2048
    buffer_store_dwordx4 v[156:159], v13, s[16:19], s86 offen offset:3200 nt
    s_waitcnt lgkmcnt(2)
    buffer_store_dwordx4 v[144:147], v13, s[16:19], s84 offen offset:256 nt
    ds_read_b128 v[156:159], v14 offset:3072
    ds_write_b64 v96, v[80:81] offset:0
    ds_write_b64 v97, v[84:85] offset:0
    ds_write_b64 v98, v[88:89] offset:0
    ds_write_b64 v99, v[92:93] offset:0
    ds_read_b128 v[144:147], v14 offset:0
    s_waitcnt lgkmcnt(6)
    buffer_store_dwordx4 v[148:151], v13, s[16:19], s84 offen offset:3328 nt
    buffer_store_dwordx4 v[152:155], v13, s[16:19], s85 offen offset:256 nt
    ds_read_b128 v[148:151], v14 offset:1024
    s_waitcnt lgkmcnt(2)
    buffer_store_dwordx4 v[156:159], v13, s[16:19], s85 offen offset:3328 nt
    s_waitcnt lgkmcnt(1)
    buffer_store_dwordx4 v[144:147], v13, s[16:19], s86 offen offset:256 nt
    s_waitcnt lgkmcnt(0)
    buffer_store_dwordx4 v[148:151], v13, s[16:19], s86 offen offset:3328 nt
    s_mov_b32 s42, s41
    ds_read_b128 a[192:195], v1 offset:24576
    ds_read_b128 a[196:199], v2 offset:24576
    ds_read_b128 a[200:203], v1 offset:25600
    ds_read_b128 a[204:207], v2 offset:25600
    ds_read_b128 a[208:211], v1 offset:26624
    ds_read_b128 a[212:215], v2 offset:26624
    ds_read_b128 a[216:219], v1 offset:30720
    ds_read_b128 a[220:223], v2 offset:30720
    ds_read_b128 a[224:227], v1 offset:31744
    ds_read_b128 a[228:231], v2 offset:31744
    ds_read_b128 a[232:235], v1 offset:32768
    ds_read_b128 a[236:239], v2 offset:32768
    v_max3_f32 v152, v32, v33, v34
    v_max3_f32 v152, v152, v35, v36
    v_max3_f32 v152, v152, v37, v38
    v_max_f32 v152, v152, v39
    v_max3_f32 v154, v40, v41, v42
    v_mov_b32 v153, v152
    v_max3_f32 v154, v154, v43, v44
    v_max3_f32 v154, v154, v45, v46
    v_permlane32_swap_b32 v153, v152
    v_max_f32 v152, v152, v153
    v_max_f32 v154, v154, v47
    v_mov_b32 v153, v152
    v_mov_b32 v155, v154
    v_add_u32 v1, s57, v1
    v_permlane16_swap_b32 v153, v152
    v_permlane32_swap_b32 v155, v154
    v_max_f32 v152, v152, v153
    v_max_f32 v154, v154, v155
    v_mul_f32_e64 v16, -s36, v152
    v_mov_b32 v155, v154
    s_waitcnt lgkmcnt(11)
    v_mfma_f32_16x16x32_bf16 v[64:67], a[192:195], a[96:99], 0
    s_add_u32 s69, s69, 1
    v_permlane16_swap_b32 v155, v154
    s_waitcnt lgkmcnt(6)
    v_mfma_f32_16x16x32_bf16 v[64:67], a[196:199], a[100:103], v[64:67]
    s_add_u32 s48, s48, 325632
    v_max3_f32 v152, v48, v49, v50
    v_max_f32 v154, v154, v155
    v_mfma_f32_16x16x32_bf16 v[64:67], a[200:203], a[104:107], v[64:67]
    s_lshr_b32 s62, s39, s69
    v_max3_f32 v152, v152, v51, v52
    v_mul_f32_e64 v17, -s36, v154
    v_mfma_f32_16x16x32_bf16 v[64:67], a[204:207], a[108:111], v[64:67]
    s_and_b32 s62, s62, 1
    v_max3_f32 v152, v152, v53, v54
    v_max_f32 v152, v152, v55
    v_mfma_f32_16x16x32_bf16 v[64:67], a[208:211], a[112:115], v[64:67]
    s_lshl_b32 s62, s62, 1
    v_fma_f32 v32, v32, s36, v16
    v_fma_f32 v33, v33, s36, v16
    v_mfma_f32_16x16x32_bf16 v[64:67], a[212:215], a[116:119], v[64:67]
    s_add_u32 s62, s62, s49
    v_fma_f32 v34, v34, s36, v16
    v_fma_f32 v35, v35, s36, v16
    v_mfma_f32_16x16x32_bf16 v[72:75], a[192:195], a[120:123], 0
    s_and_b32 s62, s62, 3
    v_fma_f32 v40, v40, s36, v17
    v_fma_f32 v41, v41, s36, v17
    v_mfma_f32_16x16x32_bf16 v[72:75], a[196:199], a[124:127], v[72:75]
    s_add_u32 s63, s69, 8
    v_fma_f32 v36, v36, s36, v16
    v_fma_f32 v37, v37, s36, v16
    v_mfma_f32_16x16x32_bf16 v[72:75], a[200:203], a[128:131], v[72:75]
    s_lshr_b32 s63, s39, s63
    v_mov_b32 v153, v152
    v_fma_f32 v38, v38, s36, v16
    v_mfma_f32_16x16x32_bf16 v[72:75], a[204:207], a[132:135], v[72:75]
    s_and_b32 s63, s63, 1
    v_exp_f32 v144, v32
    v_mfma_f32_16x16x32_bf16 v[72:75], a[208:211], a[136:139], v[72:75]
    s_xor_b32 s62, s62, s63
    v_exp_f32 v145, v33
    v_mfma_f32_16x16x32_bf16 v[72:75], a[212:215], a[140:143], v[72:75]
    s_mul_i32 s63, s3, 3
    v_exp_f32 v146, v34
    v_mfma_f32_16x16x32_bf16 v[80:83], a[192:195], a[144:147], 0
    s_lshl_b32 s64, s3, 2
    v_exp_f32 v147, v35
    v_mfma_f32_16x16x32_bf16 v[80:83], a[196:199], a[148:151], v[80:83]
    s_mov_b32 s40, 1
    v_exp_f32 v148, v40
    v_mfma_f32_16x16x32_bf16 v[80:83], a[200:203], a[152:155], v[80:83]
    s_add_u32 s65, s63, 17
    v_exp_f32 v149, v41
    v_mfma_f32_16x16x32_bf16 v[80:83], a[204:207], a[156:159], v[80:83]
    s_cmp_eq_u32 s3, 0
    v_exp_f32 v150, v36
    v_mfma_f32_16x16x32_bf16 v[80:83], a[208:211], a[160:163], v[80:83]
    s_cselect_b32 s65, 16, s65
    v_exp_f32 v151, v37
    v_mfma_f32_16x16x32_bf16 v[80:83], a[212:215], a[164:167], v[80:83]
    s_cselect_b32 s41, 1, 0
    v_permlane32_swap_b32 v153, v152
    s_waitcnt lgkmcnt(0)
    v_mfma_f32_16x16x32_bf16 v[68:71], a[216:219], a[96:99], 0
    s_cmp_eq_u32 s62, 1
    v_max_f32 v152, v152, v153
    v_mov_b32 v153, v152
    v_mfma_f32_16x16x32_bf16 v[68:71], a[220:223], a[100:103], v[68:71]
    s_cselect_b32 s64, s65, s64
    v_cvt_pk_bf16_f32 v96, v144, v145
    v_cvt_pk_bf16_f32 v97, v146, v147
    v_mfma_f32_16x16x32_bf16 v[68:71], a[224:227], a[104:107], v[68:71]
    s_cselect_b32 s40, s41, s40
    v_cvt_pk_bf16_f32 v100, v148, v149
    v_cvt_pk_bf16_f32 v98, v150, v151
    v_mfma_f32_16x16x32_bf16 v[68:71], a[228:231], a[108:111], v[68:71]
    s_add_u32 s65, s63, 29
    v_fma_f32 v39, v39, s36, v16
    v_fma_f32 v42, v42, s36, v17
    v_mfma_f32_16x16x32_bf16 v[68:71], a[232:235], a[112:115], v[68:71]
    s_cmp_eq_u32 s62, 2
    v_fma_f32 v43, v43, s36, v17
    v_fma_f32 v44, v44, s36, v17
    v_mfma_f32_16x16x32_bf16 v[68:71], a[236:239], a[116:119], v[68:71]
    s_cselect_b32 s64, s65, s64
    s_cselect_b32 s40, 0, s40
    s_add_u32 s65, s63, 41
    v_mfma_f32_16x16x32_bf16 v[76:79], a[216:219], a[120:123], 0
    s_cmp_eq_u32 s62, 3
    s_cselect_b32 s64, s65, s64
    s_cselect_b32 s40, 0, s40
    v_mfma_f32_16x16x32_bf16 v[76:79], a[220:223], a[124:127], v[76:79]
    s_mul_i32 s64, s64, 6144
    s_add_u32 s41, s48, s64
    s_cmp_ge_u32 s69, 8
    v_mfma_f32_16x16x32_bf16 v[76:79], a[224:227], a[128:131], v[76:79]
    s_cselect_b32 s41, 166725632, s41
    s_add_u32 m0, s33, s31
    v_fma_f32 v45, v45, s36, v17
    v_mfma_f32_16x16x32_bf16 v[76:79], a[228:231], a[132:135], v[76:79]
    buffer_load_dwordx4 v7, s[20:23], s28 offen offset:0 lds
    v_mfma_f32_16x16x32_bf16 v[76:79], a[232:235], a[136:139], v[76:79]
    buffer_load_dwordx4 v8, s[20:23], s28 offen offset:1024 lds
    v_mfma_f32_16x16x32_bf16 v[76:79], a[236:239], a[140:143], v[76:79]
    buffer_load_dwordx4 v9, s[20:23], s28 offen offset:2048 lds
    s_add_u32 m0, s33, s32
    v_mfma_f32_16x16x32_bf16 v[84:87], a[216:219], a[144:147], 0
    buffer_load_dwordx4 v10, s[24:27], s29 offen offset:0 lds
    v_mfma_f32_16x16x32_bf16 v[84:87], a[220:223], a[148:151], v[84:87]
    buffer_load_dwordx4 v11, s[24:27], s29 offen offset:1024 lds
    v_mfma_f32_16x16x32_bf16 v[84:87], a[224:227], a[152:155], v[84:87]
    buffer_load_dwordx4 v12, s[24:27], s29 offen offset:2048 lds
    s_add_u32 s28, s28, s30
    s_add_u32 s29, s29, s30
    v_mfma_f32_16x16x32_bf16 v[84:87], a[228:231], a[156:159], v[84:87]
    s_add_u32 s33, s33, 24576
    s_cmp_eq_u32 s33, 147456
    v_fma_f32 v46, v46, s36, v17
    v_mfma_f32_16x16x32_bf16 v[84:87], a[232:235], a[160:163], v[84:87]
    s_cselect_b32 s33, 0, s33
    v_fma_f32 v47, v47, s36, v17
    s_add_u32 m0, s33, s31
    v_mfma_f32_16x16x32_bf16 v[84:87], a[236:239], a[164:167], v[84:87]
    buffer_load_dwordx4 v7, s[20:23], s28 offen offset:0 lds
    buffer_load_dwordx4 v8, s[20:23], s28 offen offset:1024 lds
    buffer_load_dwordx4 v9, s[20:23], s28 offen offset:2048 lds
    s_add_u32 m0, s33, s32
    v_permlane16_swap_b32 v153, v152
    v_exp_f32 v144, v38
    v_exp_f32 v145, v39
    v_exp_f32 v146, v42
    v_exp_f32 v147, v43
    v_exp_f32 v148, v44
    v_exp_f32 v149, v45
    v_exp_f32 v150, v46
    v_exp_f32 v151, v47
    v_max_f32 v152, v152, v153
    v_mul_f32_e64 v18, -s36, v152
    v_cvt_pk_bf16_f32 v99, v144, v145
    buffer_load_dwordx4 v10, s[24:27], s29 offen offset:0 lds
    buffer_load_dwordx4 v11, s[24:27], s29 offen offset:1024 lds
    v_mfma_f32_16x16x32_bf16 v[128:131], v[24:27], v[96:99], 0
    buffer_load_dwordx4 v12, s[24:27], s29 offen offset:2048 lds
    s_add_u32 s28, s28, s30
    v_cvt_pk_bf16_f32 v101, v146, v147
    v_cvt_pk_bf16_f32 v102, v148, v149
    v_cvt_pk_bf16_f32 v103, v150, v151
    v_fma_f32 v48, v48, s36, v18
    v_fma_f32 v49, v49, s36, v18
    v_mfma_f32_16x16x32_bf16 v[132:135], v[24:27], v[100:103], 0
    v_fma_f32 v50, v50, s36, v18
    v_fma_f32 v51, v51, s36, v18
    v_fma_f32 v52, v52, s36, v18
    v_fma_f32 v53, v53, s36, v18
    v_fma_f32 v54, v54, s36, v18
    v_fma_f32 v55, v55, s36, v18
    v_exp_f32 v144, v48
    v_exp_f32 v145, v49
    s_waitcnt vmcnt(36)
    s_barrier
    v_exp_f32 v146, v50
    v_exp_f32 v147, v51
    v_exp_f32 v148, v52
    v_exp_f32 v149, v53
    v_exp_f32 v150, v54
    v_exp_f32 v151, v55
    v_cvt_pk_bf16_f32 v104, v144, v145
    v_cvt_pk_bf16_f32 v105, v146, v147
    v_cvt_pk_bf16_f32 v106, v148, v149
    v_cvt_pk_bf16_f32 v107, v150, v151
    ds_read_b64_tr_b16 a[240:241], v3 offset:0
    ds_read_b64_tr_b16 a[242:243], v3 offset:6144
    v_mfma_f32_16x16x32_bf16 v[136:139], v[24:27], v[104:107], 0
    ds_read_b64_tr_b16 a[244:245], v4 offset:0
    ds_read_b64_tr_b16 a[246:247], v4 offset:6144
    ds_read_b64_tr_b16 a[248:249], v5 offset:0
    ds_read_b64_tr_b16 a[250:251], v5 offset:6144
    ds_read_b64_tr_b16 a[252:253], v6 offset:0
    ds_read_b64_tr_b16 a[254:255], v6 offset:6144
    v_fma_f32 v64, v64, s36, v16
    v_fma_f32 v65, v65, s36, v16
    v_fma_f32 v66, v66, s36, v16
    v_fma_f32 v67, v67, s36, v16
    v_fma_f32 v72, v72, s36, v17
    v_fma_f32 v73, v73, s36, v17
    s_add_u32 s29, s29, s30
    v_exp_f32 v144, v64
    v_exp_f32 v145, v65
    v_exp_f32 v146, v66
    v_exp_f32 v147, v67
    v_exp_f32 v148, v72
    v_exp_f32 v149, v73
    s_add_u32 s33, s33, 24576
    s_cmp_eq_u32 s33, 147456
    s_cselect_b32 s33, 0, s33
    v_cvt_pk_bf16_f32 v112, v144, v145
    v_cvt_pk_bf16_f32 v113, v146, v147
    v_cvt_pk_bf16_f32 v116, v148, v149
    v_add_u32 v2, s57, v2
    s_waitcnt lgkmcnt(6)
    v_mfma_f32_16x16x32_bf16 v[160:163], a[240:243], v[96:99], 0
    s_add_u32 m0, s33, s31
    ds_read_b128 a[192:195], v1 offset:0
    ds_read_b128 a[196:199], v2 offset:0
    v_mfma_f32_16x16x32_bf16 v[208:211], a[240:243], v[100:103], 0
    ds_read_b128 a[200:203], v1 offset:1024
    ds_read_b128 a[204:207], v2 offset:1024
    v_mfma_f32_16x16x32_bf16 a[0:3], a[240:243], v[104:107], 0
    s_waitcnt lgkmcnt(4)
    ds_read_b64_tr_b16 a[240:241], v3 offset:1024
    ds_read_b64_tr_b16 a[242:243], v3 offset:7168
    v_mfma_f32_16x16x32_bf16 v[164:167], a[244:247], v[96:99], 0
    buffer_load_dwordx4 v7, s[20:23], s28 offen offset:0 lds
    v_mfma_f32_16x16x32_bf16 v[212:215], a[244:247], v[100:103], 0
    ds_read_b128 a[208:211], v1 offset:2048
    ds_read_b128 a[212:215], v2 offset:2048
    v_mfma_f32_16x16x32_bf16 a[4:7], a[244:247], v[104:107], 0
    ds_read_b64_tr_b16 a[244:245], v4 offset:1024
    ds_read_b64_tr_b16 a[246:247], v4 offset:7168
    v_mfma_f32_16x16x32_bf16 v[168:171], a[248:251], v[96:99], 0
    ds_read_b128 a[216:219], v1 offset:6144
    ds_read_b128 a[220:223], v2 offset:6144
    v_mfma_f32_16x16x32_bf16 v[216:219], a[248:251], v[100:103], 0
    ds_read_b128 a[224:227], v1 offset:7168
    ds_read_b128 a[228:231], v2 offset:7168
    v_mfma_f32_16x16x32_bf16 a[8:11], a[248:251], v[104:107], 0
    ds_read_b64_tr_b16 a[248:249], v5 offset:1024
    ds_read_b64_tr_b16 a[250:251], v5 offset:7168
    v_mfma_f32_16x16x32_bf16 v[172:175], a[252:255], v[96:99], 0
    ds_read_b128 a[232:235], v1 offset:8192
    ds_read_b128 a[236:239], v2 offset:8192
    v_mfma_f32_16x16x32_bf16 v[220:223], a[252:255], v[100:103], 0
    v_fma_f32 v68, v68, s36, v16
    v_fma_f32 v69, v69, s36, v16
    v_mfma_f32_16x16x32_bf16 a[12:15], a[252:255], v[104:107], 0
    s_waitcnt lgkmcnt(12)
    ds_read_b64_tr_b16 a[252:253], v6 offset:1024
    ds_read_b64_tr_b16 a[254:255], v6 offset:7168
    v_mfma_f32_16x16x32_bf16 v[176:179], a[240:243], v[96:99], 0
    buffer_load_dwordx4 v8, s[20:23], s28 offen offset:1024 lds
    v_mfma_f32_16x16x32_bf16 v[224:227], a[240:243], v[100:103], 0
    v_exp_f32 v150, v68
    v_mfma_f32_16x16x32_bf16 a[16:19], a[240:243], v[104:107], 0
    s_waitcnt lgkmcnt(8)
    ds_read_b64_tr_b16 a[240:241], v3 offset:2048
    ds_read_b64_tr_b16 a[242:243], v3 offset:8192
    v_mfma_f32_16x16x32_bf16 v[180:183], a[244:247], v[96:99], 0
    v_exp_f32 v151, v69
    v_mfma_f32_16x16x32_bf16 v[228:231], a[244:247], v[100:103], 0
    v_cvt_pk_bf16_f32 v114, v150, v151
    v_fma_f32 v70, v70, s36, v16
    v_mfma_f32_16x16x32_bf16 a[20:23], a[244:247], v[104:107], 0
    s_waitcnt lgkmcnt(4)
    ds_read_b64_tr_b16 a[244:245], v4 offset:2048
    ds_read_b64_tr_b16 a[246:247], v4 offset:8192
    v_mfma_f32_16x16x32_bf16 v[184:187], a[248:251], v[96:99], 0
    v_fma_f32 v71, v71, s36, v16
    v_fma_f32 v74, v74, s36, v17
    v_mfma_f32_16x16x32_bf16 v[232:235], a[248:251], v[100:103], 0
    v_fma_f32 v75, v75, s36, v17
    v_fma_f32 v76, v76, s36, v17
    v_mfma_f32_16x16x32_bf16 a[24:27], a[248:251], v[104:107], 0
    s_waitcnt lgkmcnt(4)
    ds_read_b64_tr_b16 a[248:249], v5 offset:2048
    ds_read_b64_tr_b16 a[250:251], v5 offset:8192
    v_mfma_f32_16x16x32_bf16 v[188:191], a[252:255], v[96:99], 0
    buffer_load_dwordx4 v9, s[20:23], s28 offen offset:2048 lds
    v_mfma_f32_16x16x32_bf16 v[236:239], a[252:255], v[100:103], 0
    s_add_u32 m0, s33, s32
    v_fma_f32 v77, v77, s36, v17
    v_fma_f32 v78, v78, s36, v17
    v_mfma_f32_16x16x32_bf16 a[28:31], a[252:255], v[104:107], 0
    s_waitcnt lgkmcnt(4)
    ds_read_b64_tr_b16 a[252:253], v6 offset:2048
    ds_read_b64_tr_b16 a[254:255], v6 offset:8192
    v_mfma_f32_16x16x32_bf16 v[192:195], a[240:243], v[96:99], 0
    v_fma_f32 v79, v79, s36, v17
    v_fma_f32 v80, v80, s36, v18
    v_mfma_f32_16x16x32_bf16 v[240:243], a[240:243], v[100:103], 0
    v_exp_f32 v144, v70
    v_mfma_f32_16x16x32_bf16 a[32:35], a[240:243], v[104:107], 0
    s_waitcnt lgkmcnt(4)
    v_exp_f32 v145, v71
    v_mfma_f32_16x16x32_bf16 v[196:199], a[244:247], v[96:99], 0
    v_exp_f32 v146, v74
    v_mfma_f32_16x16x32_bf16 v[244:247], a[244:247], v[100:103], 0
    v_exp_f32 v147, v75
    v_mfma_f32_16x16x32_bf16 a[36:39], a[244:247], v[104:107], 0
    s_waitcnt lgkmcnt(2)
    v_exp_f32 v148, v76
    v_mfma_f32_16x16x32_bf16 v[200:203], a[248:251], v[96:99], 0
    buffer_load_dwordx4 v10, s[24:27], s29 offen offset:0 lds
    v_mfma_f32_16x16x32_bf16 v[248:251], a[248:251], v[100:103], 0
    v_exp_f32 v149, v77
    v_mfma_f32_16x16x32_bf16 a[40:43], a[248:251], v[104:107], 0
    s_waitcnt lgkmcnt(0)
    v_exp_f32 v150, v78
    v_mfma_f32_16x16x32_bf16 v[204:207], a[252:255], v[96:99], 0
    v_exp_f32 v151, v79
    v_mfma_f32_16x16x32_bf16 v[252:255], a[252:255], v[100:103], 0
    v_cvt_pk_bf16_f32 v115, v144, v145
    v_cvt_pk_bf16_f32 v117, v146, v147
    v_mfma_f32_16x16x32_bf16 a[44:47], a[252:255], v[104:107], 0
    v_cvt_pk_bf16_f32 v118, v148, v149
    v_cvt_pk_bf16_f32 v119, v150, v151
    v_mfma_f32_16x16x32_bf16 v[32:35], a[192:195], a[96:99], 0
    v_fma_f32 v81, v81, s36, v18
    v_fma_f32 v82, v82, s36, v18
    v_mfma_f32_16x16x32_bf16 v[32:35], a[196:199], a[100:103], v[32:35]
    v_fma_f32 v83, v83, s36, v18
    v_fma_f32 v84, v84, s36, v18
    v_mfma_f32_16x16x32_bf16 v[32:35], a[200:203], a[104:107], v[32:35]
    v_fma_f32 v85, v85, s36, v18
    v_fma_f32 v86, v86, s36, v18
    v_mfma_f32_16x16x32_bf16 v[32:35], a[204:207], a[108:111], v[32:35]
    buffer_load_dwordx4 v11, s[24:27], s29 offen offset:1024 lds
    v_mfma_f32_16x16x32_bf16 v[32:35], a[208:211], a[112:115], v[32:35]
    v_fma_f32 v87, v87, s36, v18
    v_mov_b32 v20, v128
    v_mfma_f32_16x16x32_bf16 v[128:131], v[24:27], v[112:115], 0
    v_exp_f32 v144, v80
    v_mfma_f32_16x16x32_bf16 v[32:35], a[212:215], a[116:119], v[32:35]
    v_exp_f32 v145, v81
    v_mfma_f32_16x16x32_bf16 v[40:43], a[192:195], a[120:123], 0
    v_exp_f32 v146, v82
    v_mfma_f32_16x16x32_bf16 v[40:43], a[196:199], a[124:127], v[40:43]
    v_exp_f32 v147, v83
    v_mfma_f32_16x16x32_bf16 v[40:43], a[200:203], a[128:131], v[40:43]
    v_exp_f32 v148, v84
    v_mfma_f32_16x16x32_bf16 v[40:43], a[204:207], a[132:135], v[40:43]
    v_exp_f32 v149, v85
    v_mfma_f32_16x16x32_bf16 v[40:43], a[208:211], a[136:139], v[40:43]
    v_exp_f32 v150, v86
    v_mfma_f32_16x16x32_bf16 v[40:43], a[212:215], a[140:143], v[40:43]
    buffer_load_dwordx4 v12, s[24:27], s29 offen offset:2048 lds
    v_mfma_f32_16x16x32_bf16 v[48:51], a[192:195], a[144:147], 0
    s_add_u32 s28, s28, s30
    v_exp_f32 v151, v87
    v_mfma_f32_16x16x32_bf16 v[48:51], a[196:199], a[148:151], v[48:51]
    s_add_u32 s29, s29, s30
    v_cvt_pk_bf16_f32 v120, v144, v145
    v_cvt_pk_bf16_f32 v121, v146, v147
    v_mfma_f32_16x16x32_bf16 v[48:51], a[200:203], a[152:155], v[48:51]
    s_add_u32 s33, s33, 24576
    v_cvt_pk_bf16_f32 v122, v148, v149
    v_cvt_pk_bf16_f32 v123, v150, v151
    v_mfma_f32_16x16x32_bf16 v[48:51], a[204:207], a[156:159], v[48:51]
    s_cmp_eq_u32 s33, 147456
    v_mov_b32 v21, v132
    v_mov_b32 v22, v136
    v_mfma_f32_16x16x32_bf16 v[132:135], v[24:27], v[116:119], 0
    s_cselect_b32 s33, 0, s33
    v_mfma_f32_16x16x32_bf16 v[136:139], v[24:27], v[120:123], 0
    v_mfma_f32_16x16x32_bf16 v[48:51], a[208:211], a[160:163], v[48:51]
    v_mfma_f32_16x16x32_bf16 v[48:51], a[212:215], a[164:167], v[48:51]
    v_mfma_f32_16x16x32_bf16 v[36:39], a[216:219], a[96:99], 0
    v_mfma_f32_16x16x32_bf16 v[36:39], a[220:223], a[100:103], v[36:39]
    v_mfma_f32_16x16x32_bf16 v[36:39], a[224:227], a[104:107], v[36:39]
    v_mfma_f32_16x16x32_bf16 v[36:39], a[228:231], a[108:111], v[36:39]
    s_waitcnt vmcnt(36)
    s_barrier
    v_max3_f32 v30, v128, v132, v136
    v_cmp_lt_f32 vcc, s37, v30
    v_mfma_f32_16x16x32_bf16 v[36:39], a[232:235], a[112:115], v[36:39]
    v_mfma_f32_16x16x32_bf16 v[36:39], a[236:239], a[116:119], v[36:39]
    ds_read_b64_tr_b16 a[240:241], v3 offset:24576
    ds_read_b64_tr_b16 a[242:243], v3 offset:30720
    v_mfma_f32_16x16x32_bf16 v[44:47], a[216:219], a[120:123], 0
    s_cbranch_vccnz L_rs_tr33a
L_ret_tr33a:
    ds_read_b64_tr_b16 a[244:245], v4 offset:24576
    ds_read_b64_tr_b16 a[246:247], v4 offset:30720
    v_mfma_f32_16x16x32_bf16 v[44:47], a[220:223], a[124:127], v[44:47]
    v_fma_f32 v32, v32, s36, v16
    v_fma_f32 v33, v33, s36, v16
    v_mfma_f32_16x16x32_bf16 v[44:47], a[224:227], a[128:131], v[44:47]
    ds_read_b64_tr_b16 a[248:249], v5 offset:24576
    ds_read_b64_tr_b16 a[250:251], v5 offset:30720
    v_mfma_f32_16x16x32_bf16 v[44:47], a[228:231], a[132:135], v[44:47]
    ds_read_b64_tr_b16 a[252:253], v6 offset:24576
    ds_read_b64_tr_b16 a[254:255], v6 offset:30720
    v_mfma_f32_16x16x32_bf16 v[44:47], a[232:235], a[136:139], v[44:47]
    v_fma_f32 v34, v34, s36, v16
    v_fma_f32 v35, v35, s36, v16
    v_mfma_f32_16x16x32_bf16 v[44:47], a[236:239], a[140:143], v[44:47]
    v_fma_f32 v40, v40, s36, v17
    v_fma_f32 v41, v41, s36, v17
    v_mfma_f32_16x16x32_bf16 v[52:55], a[216:219], a[144:147], 0
    v_exp_f32 v144, v32
    v_mfma_f32_16x16x32_bf16 v[52:55], a[220:223], a[148:151], v[52:55]
    v_exp_f32 v145, v33
    v_mfma_f32_16x16x32_bf16 v[52:55], a[224:227], a[152:155], v[52:55]
    v_exp_f32 v146, v34
    v_mfma_f32_16x16x32_bf16 v[52:55], a[228:231], a[156:159], v[52:55]
    v_exp_f32 v147, v35
    v_mfma_f32_16x16x32_bf16 v[52:55], a[232:235], a[160:163], v[52:55]
    v_exp_f32 v148, v40
    v_mfma_f32_16x16x32_bf16 v[52:55], a[236:239], a[164:167], v[52:55]
    v_exp_f32 v149, v41
    v_cvt_pk_bf16_f32 v96, v144, v145
    v_cvt_pk_bf16_f32 v97, v146, v147
    v_cvt_pk_bf16_f32 v100, v148, v149
    s_waitcnt lgkmcnt(0)
    v_mfma_f32_16x16x32_bf16 v[160:163], a[240:243], v[112:115], v[160:163]
    s_add_u32 s62, s34, 49152
    ds_read_b128 a[192:195], v1 offset:24576
    ds_read_b128 a[196:199], v2 offset:24576
    v_mfma_f32_16x16x32_bf16 v[208:211], a[240:243], v[116:119], v[208:211]
    s_cmp_eq_u32 s62, 147456
    ds_read_b128 a[200:203], v1 offset:25600
    ds_read_b128 a[204:207], v2 offset:25600
    v_mfma_f32_16x16x32_bf16 a[0:3], a[240:243], v[120:123], a[0:3]
    s_cselect_b32 s62, 0, s62
    ds_read_b64_tr_b16 a[240:241], v3 offset:25600
    ds_read_b64_tr_b16 a[242:243], v3 offset:31744
    v_mfma_f32_16x16x32_bf16 v[164:167], a[244:247], v[112:115], v[164:167]
    s_sub_u32 s58, s62, s34
    ds_read_b128 a[208:211], v1 offset:26624
    ds_read_b128 a[212:215], v2 offset:26624
    v_mfma_f32_16x16x32_bf16 v[212:215], a[244:247], v[116:119], v[212:215]
    s_mov_b32 s34, s62
    ds_read_b128 a[216:219], v1 offset:30720
    ds_read_b128 a[220:223], v2 offset:30720
    v_mfma_f32_16x16x32_bf16 a[4:7], a[244:247], v[120:123], a[4:7]
    s_add_u32 m0, s33, s31
    ds_read_b64_tr_b16 a[244:245], v4 offset:25600
    ds_read_b64_tr_b16 a[246:247], v4 offset:31744
    v_mfma_f32_16x16x32_bf16 v[168:171], a[248:251], v[112:115], v[168:171]
    buffer_load_dwordx4 v7, s[20:23], s28 offen offset:0 lds
    v_mfma_f32_16x16x32_bf16 v[216:219], a[248:251], v[116:119], v[216:219]
    ds_read_b128 a[224:227], v1 offset:31744
    ds_read_b128 a[228:231], v2 offset:31744
    v_mfma_f32_16x16x32_bf16 a[8:11], a[248:251], v[120:123], a[8:11]
    ds_read_b64_tr_b16 a[248:249], v5 offset:25600
    ds_read_b64_tr_b16 a[250:251], v5 offset:31744
    v_mfma_f32_16x16x32_bf16 v[172:175], a[252:255], v[112:115], v[172:175]
    ds_read_b128 a[232:235], v1 offset:32768
    ds_read_b128 a[236:239], v2 offset:32768
    v_mfma_f32_16x16x32_bf16 v[220:223], a[252:255], v[116:119], v[220:223]
    v_fma_f32 v36, v36, s36, v16
    v_fma_f32 v37, v37, s36, v16
    v_mfma_f32_16x16x32_bf16 a[12:15], a[252:255], v[120:123], a[12:15]
    s_waitcnt lgkmcnt(11)
    ds_read_b64_tr_b16 a[252:253], v6 offset:25600
    ds_read_b64_tr_b16 a[254:255], v6 offset:31744
    v_mfma_f32_16x16x32_bf16 v[176:179], a[240:243], v[112:115], v[176:179]
    buffer_load_dwordx4 v8, s[20:23], s28 offen offset:1024 lds
    v_mfma_f32_16x16x32_bf16 v[224:227], a[240:243], v[116:119], v[224:227]
    v_exp_f32 v150, v36
    v_mfma_f32_16x16x32_bf16 a[16:19], a[240:243], v[120:123], a[16:19]
    s_waitcnt lgkmcnt(8)
    ds_read_b64_tr_b16 a[240:241], v3 offset:26624
    ds_read_b64_tr_b16 a[242:243], v3 offset:32768
    v_mfma_f32_16x16x32_bf16 v[180:183], a[244:247], v[112:115], v[180:183]
    v_exp_f32 v151, v37
    v_mfma_f32_16x16x32_bf16 v[228:231], a[244:247], v[116:119], v[228:231]
    v_cvt_pk_bf16_f32 v98, v150, v151
    v_fma_f32 v38, v38, s36, v16
    v_mfma_f32_16x16x32_bf16 a[20:23], a[244:247], v[120:123], a[20:23]
    s_waitcnt lgkmcnt(4)
    ds_read_b64_tr_b16 a[244:245], v4 offset:26624
    ds_read_b64_tr_b16 a[246:247], v4 offset:32768
    v_mfma_f32_16x16x32_bf16 v[184:187], a[248:251], v[112:115], v[184:187]
    v_fma_f32 v39, v39, s36, v16
    v_fma_f32 v42, v42, s36, v17
    v_mfma_f32_16x16x32_bf16 v[232:235], a[248:251], v[116:119], v[232:235]
    v_fma_f32 v43, v43, s36, v17
    v_fma_f32 v44, v44, s36, v17
    v_mfma_f32_16x16x32_bf16 a[24:27], a[248:251], v[120:123], a[24:27]
    s_waitcnt lgkmcnt(4)
    ds_read_b64_tr_b16 a[248:249], v5 offset:26624
    ds_read_b64_tr_b16 a[250:251], v5 offset:32768
    v_mfma_f32_16x16x32_bf16 v[188:191], a[252:255], v[112:115], v[188:191]
    buffer_load_dwordx4 v9, s[20:23], s28 offen offset:2048 lds
    v_mfma_f32_16x16x32_bf16 v[236:239], a[252:255], v[116:119], v[236:239]
    s_add_u32 m0, s33, s32
    v_fma_f32 v45, v45, s36, v17
    v_fma_f32 v46, v46, s36, v17
    v_mfma_f32_16x16x32_bf16 a[28:31], a[252:255], v[120:123], a[28:31]
    s_waitcnt lgkmcnt(4)
    ds_read_b64_tr_b16 a[252:253], v6 offset:26624
    ds_read_b64_tr_b16 a[254:255], v6 offset:32768
    v_mfma_f32_16x16x32_bf16 v[192:195], a[240:243], v[112:115], v[192:195]
    v_fma_f32 v47, v47, s36, v17
    v_fma_f32 v48, v48, s36, v18
    v_mfma_f32_16x16x32_bf16 v[240:243], a[240:243], v[116:119], v[240:243]
    v_exp_f32 v144, v38
    v_mfma_f32_16x16x32_bf16 a[32:35], a[240:243], v[120:123], a[32:35]
    s_waitcnt lgkmcnt(4)
    v_exp_f32 v145, v39
    v_mfma_f32_16x16x32_bf16 v[196:199], a[244:247], v[112:115], v[196:199]
    v_exp_f32 v146, v42
    v_mfma_f32_16x16x32_bf16 v[244:247], a[244:247], v[116:119], v[244:247]
    v_exp_f32 v147, v43
    v_mfma_f32_16x16x32_bf16 a[36:39], a[244:247], v[120:123], a[36:39]
    s_waitcnt lgkmcnt(2)
    v_exp_f32 v148, v44
    v_mfma_f32_16x16x32_bf16 v[200:203], a[248:251], v[112:115], v[200:203]
    buffer_load_dwordx4 v10, s[24:27], s29 offen offset:0 lds
    v_mfma_f32_16x16x32_bf16 v[248:251], a[248:251], v[116:119], v[248:251]
    v_exp_f32 v149, v45
    v_mfma_f32_16x16x32_bf16 a[40:43], a[248:251], v[120:123], a[40:43]
    s_waitcnt lgkmcnt(0)
    v_exp_f32 v150, v46
    v_mfma_f32_16x16x32_bf16 v[204:207], a[252:255], v[112:115], v[204:207]
    v_exp_f32 v151, v47
    v_mfma_f32_16x16x32_bf16 v[252:255], a[252:255], v[116:119], v[252:255]
    v_cvt_pk_bf16_f32 v99, v144, v145
    v_cvt_pk_bf16_f32 v101, v146, v147
    v_mfma_f32_16x16x32_bf16 a[44:47], a[252:255], v[120:123], a[44:47]
    v_cvt_pk_bf16_f32 v102, v148, v149
    v_cvt_pk_bf16_f32 v103, v150, v151
    v_mfma_f32_16x16x32_bf16 v[64:67], a[192:195], a[96:99], 0
    v_fma_f32 v49, v49, s36, v18
    v_fma_f32 v50, v50, s36, v18
    v_mfma_f32_16x16x32_bf16 v[64:67], a[196:199], a[100:103], v[64:67]
    v_fma_f32 v51, v51, s36, v18
    v_fma_f32 v52, v52, s36, v18
    v_mfma_f32_16x16x32_bf16 v[64:67], a[200:203], a[104:107], v[64:67]
    v_fma_f32 v53, v53, s36, v18
    v_fma_f32 v54, v54, s36, v18
    v_mfma_f32_16x16x32_bf16 v[64:67], a[204:207], a[108:111], v[64:67]
    buffer_load_dwordx4 v11, s[24:27], s29 offen offset:1024 lds
    v_mfma_f32_16x16x32_bf16 v[64:67], a[208:211], a[112:115], v[64:67]
    v_fma_f32 v55, v55, s36, v18
    v_add_f32 v20, v20, v128
    v_mfma_f32_16x16x32_bf16 v[128:131], v[24:27], v[96:99], 0
    v_exp_f32 v144, v48
    v_mfma_f32_16x16x32_bf16 v[64:67], a[212:215], a[116:119], v[64:67]
    v_exp_f32 v145, v49
    v_mfma_f32_16x16x32_bf16 v[72:75], a[192:195], a[120:123], 0
    v_exp_f32 v146, v50
    v_mfma_f32_16x16x32_bf16 v[72:75], a[196:199], a[124:127], v[72:75]
    v_exp_f32 v147, v51
    v_mfma_f32_16x16x32_bf16 v[72:75], a[200:203], a[128:131], v[72:75]
    v_exp_f32 v148, v52
    v_mfma_f32_16x16x32_bf16 v[72:75], a[204:207], a[132:135], v[72:75]
    v_exp_f32 v149, v53
    v_mfma_f32_16x16x32_bf16 v[72:75], a[208:211], a[136:139], v[72:75]
    v_exp_f32 v150, v54
    v_mfma_f32_16x16x32_bf16 v[72:75], a[212:215], a[140:143], v[72:75]
    buffer_load_dwordx4 v12, s[24:27], s29 offen offset:2048 lds
    v_mfma_f32_16x16x32_bf16 v[80:83], a[192:195], a[144:147], 0
    s_add_u32 s28, s28, s30
    v_exp_f32 v151, v55
    v_mfma_f32_16x16x32_bf16 v[80:83], a[196:199], a[148:151], v[80:83]
    s_add_u32 s29, s29, s30
    v_cvt_pk_bf16_f32 v104, v144, v145
    v_cvt_pk_bf16_f32 v105, v146, v147
    v_mfma_f32_16x16x32_bf16 v[80:83], a[200:203], a[152:155], v[80:83]
    s_add_u32 s33, s33, 24576
    v_cvt_pk_bf16_f32 v106, v148, v149
    v_cvt_pk_bf16_f32 v107, v150, v151
    v_mfma_f32_16x16x32_bf16 v[80:83], a[204:207], a[156:159], v[80:83]
    s_cmp_eq_u32 s33, 147456
    v_add_f32 v21, v21, v132
    v_add_f32 v22, v22, v136
    v_mfma_f32_16x16x32_bf16 v[132:135], v[24:27], v[100:103], 0
    s_cselect_b32 s33, 0, s33
    v_add_u32 v3, s58, v3
    v_add_u32 v4, s58, v4
    v_mfma_f32_16x16x32_bf16 v[136:139], v[24:27], v[104:107], 0
    v_add_u32 v5, s58, v5
    v_add_u32 v6, s58, v6
    v_mfma_f32_16x16x32_bf16 v[80:83], a[208:211], a[160:163], v[80:83]
    v_add_u32 v1, s58, v1
    v_add_u32 v2, s58, v2
    v_mfma_f32_16x16x32_bf16 v[80:83], a[212:215], a[164:167], v[80:83]
    v_mfma_f32_16x16x32_bf16 v[68:71], a[216:219], a[96:99], 0
    v_mfma_f32_16x16x32_bf16 v[68:71], a[220:223], a[100:103], v[68:71]
    v_max3_f32 v30, v128, v132, v136
    v_cmp_lt_f32 vcc, s37, v30
    v_mfma_f32_16x16x32_bf16 v[68:71], a[224:227], a[104:107], v[68:71]
    v_mfma_f32_16x16x32_bf16 v[68:71], a[228:231], a[108:111], v[68:71]
    s_waitcnt vmcnt(18)
    s_barrier
    v_mfma_f32_16x16x32_bf16 v[68:71], a[232:235], a[112:115], v[68:71]
    s_cbranch_vccnz L_rs_tr33b
L_ret_tr33b:
    v_fma_f32 v64, v64, s36, v16
    v_fma_f32 v65, v65, s36, v16
    v_mfma_f32_16x16x32_bf16 v[68:71], a[236:239], a[116:119], v[68:71]
    ds_read_b64_tr_b16 a[240:241], v3 offset:0
    ds_read_b64_tr_b16 a[242:243], v3 offset:6144
    v_mfma_f32_16x16x32_bf16 v[76:79], a[216:219], a[120:123], 0
    v_fma_f32 v66, v66, s36, v16
    v_fma_f32 v67, v67, s36, v16
    v_mfma_f32_16x16x32_bf16 v[76:79], a[220:223], a[124:127], v[76:79]
    ds_read_b64_tr_b16 a[244:245], v4 offset:0
    ds_read_b64_tr_b16 a[246:247], v4 offset:6144
    v_mfma_f32_16x16x32_bf16 v[76:79], a[224:227], a[128:131], v[76:79]
    ds_read_b64_tr_b16 a[248:249], v5 offset:0
    ds_read_b64_tr_b16 a[250:251], v5 offset:6144
    v_mfma_f32_16x16x32_bf16 v[76:79], a[228:231], a[132:135], v[76:79]
    v_fma_f32 v72, v72, s36, v17
    v_fma_f32 v73, v73, s36, v17
    v_mfma_f32_16x16x32_bf16 v[76:79], a[232:235], a[136:139], v[76:79]
    ds_read_b64_tr_b16 a[252:253], v6 offset:0
    ds_read_b64_tr_b16 a[254:255], v6 offset:6144
    v_mfma_f32_16x16x32_bf16 v[76:79], a[236:239], a[140:143], v[76:79]
    v_exp_f32 v144, v64
    v_mfma_f32_16x16x32_bf16 v[84:87], a[216:219], a[144:147], 0
    v_exp_f32 v145, v65
    v_mfma_f32_16x16x32_bf16 v[84:87], a[220:223], a[148:151], v[84:87]
    v_exp_f32 v146, v66
    v_mfma_f32_16x16x32_bf16 v[84:87], a[224:227], a[152:155], v[84:87]
    v_exp_f32 v147, v67
    v_mfma_f32_16x16x32_bf16 v[84:87], a[228:231], a[156:159], v[84:87]
    v_exp_f32 v148, v72
    v_mfma_f32_16x16x32_bf16 v[84:87], a[232:235], a[160:163], v[84:87]
    v_exp_f32 v149, v73
    v_mfma_f32_16x16x32_bf16 v[84:87], a[236:239], a[164:167], v[84:87]
    v_cvt_pk_bf16_f32 v112, v144, v145
    v_cvt_pk_bf16_f32 v113, v146, v147
    v_cvt_pk_bf16_f32 v116, v148, v149
    s_mov_b32 s38, 0
    s_branch L_loop3
L_end4:
    s_waitcnt lgkmcnt(4)
    v_mfma_f32_16x16x32_bf16 v[160:163], a[240:243], v[96:99], v[160:163]
    s_add_u32 s65, s34, 24576
    v_fma_f32 v68, v68, s36, v16
    v_fma_f32 v69, v69, s36, v16
    v_mfma_f32_16x16x32_bf16 v[208:211], a[240:243], v[100:103], v[208:211]
    s_add_u32 s62, s34, 49152
    v_exp_f32 v150, v68
    v_mfma_f32_16x16x32_bf16 a[0:3], a[240:243], v[104:107], a[0:3]
    s_cmp_eq_u32 s62, 147456
    v_exp_f32 v151, v69
    v_mfma_f32_16x16x32_bf16 a[48:51], a[240:243], v[108:111], a[48:51]
    s_cselect_b32 s62, 0, s62
    ds_read_b64_tr_b16 a[240:241], v3 offset:1024
    ds_read_b64_tr_b16 a[242:243], v3 offset:7168
    v_mfma_f32_16x16x32_bf16 v[164:167], a[244:247], v[96:99], v[164:167]
    s_sub_u32 s56, s62, s34
    v_cvt_pk_bf16_f32 v114, v150, v151
    v_fma_f32 v70, v70, s36, v16
    v_mfma_f32_16x16x32_bf16 v[212:215], a[244:247], v[100:103], v[212:215]
    s_mov_b32 s34, s62
    v_fma_f32 v71, v71, s36, v16
    v_fma_f32 v74, v74, s36, v17
    v_mfma_f32_16x16x32_bf16 a[4:7], a[244:247], v[104:107], a[4:7]
    v_fma_f32 v75, v75, s36, v17
    v_fma_f32 v76, v76, s36, v17
    v_mfma_f32_16x16x32_bf16 a[52:55], a[244:247], v[108:111], a[52:55]
    s_waitcnt lgkmcnt(2)
    ds_read_b64_tr_b16 a[244:245], v4 offset:1024
    ds_read_b64_tr_b16 a[246:247], v4 offset:7168
    v_mfma_f32_16x16x32_bf16 v[168:171], a[248:251], v[96:99], v[168:171]
    v_fma_f32 v77, v77, s36, v17
    v_fma_f32 v78, v78, s36, v17
    v_mfma_f32_16x16x32_bf16 v[216:219], a[248:251], v[100:103], v[216:219]
    v_fma_f32 v79, v79, s36, v17
    v_fma_f32 v80, v80, s36, v18
    v_mfma_f32_16x16x32_bf16 a[8:11], a[248:251], v[104:107], a[8:11]
    v_exp_f32 v144, v70
    v_mfma_f32_16x16x32_bf16 a[56:59], a[248:251], v[108:111], a[56:59]
    ds_read_b64_tr_b16 a[248:249], v5 offset:1024
    ds_read_b64_tr_b16 a[250:251], v5 offset:7168
    v_mfma_f32_16x16x32_bf16 v[172:175], a[252:255], v[96:99], v[172:175]
    v_exp_f32 v145, v71
    v_mfma_f32_16x16x32_bf16 v[220:223], a[252:255], v[100:103], v[220:223]
    v_exp_f32 v146, v74
    v_mfma_f32_16x16x32_bf16 a[12:15], a[252:255], v[104:107], a[12:15]
    v_exp_f32 v147, v75
    v_mfma_f32_16x16x32_bf16 a[60:63], a[252:255], v[108:111], a[60:63]
    s_waitcnt lgkmcnt(3)
    ds_read_b64_tr_b16 a[252:253], v6 offset:1024
    ds_read_b64_tr_b16 a[254:255], v6 offset:7168
    v_mfma_f32_16x16x32_bf16 v[176:179], a[240:243], v[96:99], v[176:179]
    v_exp_f32 v148, v76
    v_mfma_f32_16x16x32_bf16 v[224:227], a[240:243], v[100:103], v[224:227]
    v_exp_f32 v149, v77
    v_mfma_f32_16x16x32_bf16 a[16:19], a[240:243], v[104:107], a[16:19]
    v_exp_f32 v150, v78
    v_mfma_f32_16x16x32_bf16 a[64:67], a[240:243], v[108:111], a[64:67]
    s_waitcnt lgkmcnt(3)
    ds_read_b64_tr_b16 a[240:241], v3 offset:2048
    ds_read_b64_tr_b16 a[242:243], v3 offset:8192
    v_mfma_f32_16x16x32_bf16 v[180:183], a[244:247], v[96:99], v[180:183]
    v_exp_f32 v151, v79
    v_mfma_f32_16x16x32_bf16 v[228:231], a[244:247], v[100:103], v[228:231]
    v_cvt_pk_bf16_f32 v115, v144, v145
    v_cvt_pk_bf16_f32 v117, v146, v147
    v_mfma_f32_16x16x32_bf16 a[20:23], a[244:247], v[104:107], a[20:23]
    v_cvt_pk_bf16_f32 v118, v148, v149
    v_cvt_pk_bf16_f32 v119, v150, v151
    v_mfma_f32_16x16x32_bf16 a[68:71], a[244:247], v[108:111], a[68:71]
    s_waitcnt lgkmcnt(2)
    ds_read_b64_tr_b16 a[244:245], v4 offset:2048
    ds_read_b64_tr_b16 a[246:247], v4 offset:8192
    v_mfma_f32_16x16x32_bf16 v[184:187], a[248:251], v[96:99], v[184:187]
    v_fma_f32 v81, v81, s36, v18
    v_fma_f32 v82, v82, s36, v18
    v_mfma_f32_16x16x32_bf16 v[232:235], a[248:251], v[100:103], v[232:235]
    v_fma_f32 v83, v83, s36, v18
    v_fma_f32 v84, v84, s36, v18
    v_mfma_f32_16x16x32_bf16 a[24:27], a[248:251], v[104:107], a[24:27]
    v_fma_f32 v85, v85, s36, v18
    v_fma_f32 v86, v86, s36, v18
    v_mfma_f32_16x16x32_bf16 a[72:75], a[248:251], v[108:111], a[72:75]
    ds_read_b64_tr_b16 a[248:249], v5 offset:2048
    ds_read_b64_tr_b16 a[250:251], v5 offset:8192
    v_mfma_f32_16x16x32_bf16 v[188:191], a[252:255], v[96:99], v[188:191]
    v_fma_f32 v87, v87, s36, v18
    v_fma_f32 v88, v88, s36, v19
    v_mfma_f32_16x16x32_bf16 v[236:239], a[252:255], v[100:103], v[236:239]
    v_exp_f32 v144, v80
    v_mfma_f32_16x16x32_bf16 a[28:31], a[252:255], v[104:107], a[28:31]
    v_exp_f32 v145, v81
    v_mfma_f32_16x16x32_bf16 a[76:79], a[252:255], v[108:111], a[76:79]
    s_waitcnt lgkmcnt(3)
    ds_read_b64_tr_b16 a[252:253], v6 offset:2048
    ds_read_b64_tr_b16 a[254:255], v6 offset:8192
    v_mfma_f32_16x16x32_bf16 v[192:195], a[240:243], v[96:99], v[192:195]
    v_exp_f32 v146, v82
    v_mfma_f32_16x16x32_bf16 v[240:243], a[240:243], v[100:103], v[240:243]
    v_exp_f32 v147, v83
    v_mfma_f32_16x16x32_bf16 a[32:35], a[240:243], v[104:107], a[32:35]
    v_exp_f32 v148, v84
    v_mfma_f32_16x16x32_bf16 a[80:83], a[240:243], v[108:111], a[80:83]
    s_waitcnt lgkmcnt(3)
    v_exp_f32 v149, v85
    v_mfma_f32_16x16x32_bf16 v[196:199], a[244:247], v[96:99], v[196:199]
    v_exp_f32 v150, v86
    v_mfma_f32_16x16x32_bf16 v[244:247], a[244:247], v[100:103], v[244:247]
    v_exp_f32 v151, v87
    v_mfma_f32_16x16x32_bf16 a[36:39], a[244:247], v[104:107], a[36:39]
    v_cvt_pk_bf16_f32 v120, v144, v145
    v_cvt_pk_bf16_f32 v121, v146, v147
    v_mfma_f32_16x16x32_bf16 a[84:87], a[244:247], v[108:111], a[84:87]
    s_waitcnt lgkmcnt(1)
    v_cvt_pk_bf16_f32 v122, v148, v149
    v_cvt_pk_bf16_f32 v123, v150, v151
    v_mfma_f32_16x16x32_bf16 v[200:203], a[248:251], v[96:99], v[200:203]
    v_fma_f32 v89, v89, s36, v19
    v_fma_f32 v90, v90, s36, v19
    v_mfma_f32_16x16x32_bf16 v[248:251], a[248:251], v[100:103], v[248:251]
    v_fma_f32 v91, v91, s36, v19
    v_fma_f32 v92, v92, s36, v19
    v_mfma_f32_16x16x32_bf16 a[40:43], a[248:251], v[104:107], a[40:43]
    v_fma_f32 v93, v93, s36, v19
    v_fma_f32 v94, v94, s36, v19
    v_mfma_f32_16x16x32_bf16 a[88:91], a[248:251], v[108:111], a[88:91]
    v_fma_f32 v95, v95, s36, v19
    v_add_f32 v20, v20, v128
    v_mfma_f32_16x16x32_bf16 v[128:131], v[24:27], v[112:115], 0
    s_waitcnt lgkmcnt(0)
    v_exp_f32 v144, v88
    v_mfma_f32_16x16x32_bf16 v[204:207], a[252:255], v[96:99], v[204:207]
    v_exp_f32 v145, v89
    v_mfma_f32_16x16x32_bf16 v[252:255], a[252:255], v[100:103], v[252:255]
    v_exp_f32 v146, v90
    v_mfma_f32_16x16x32_bf16 a[44:47], a[252:255], v[104:107], a[44:47]
    v_exp_f32 v147, v91
    v_mfma_f32_16x16x32_bf16 a[92:95], a[252:255], v[108:111], a[92:95]
    v_exp_f32 v148, v92
    v_exp_f32 v149, v93
    v_exp_f32 v150, v94
    v_exp_f32 v151, v95
    v_cvt_pk_bf16_f32 v124, v144, v145
    v_cvt_pk_bf16_f32 v125, v146, v147
    v_cvt_pk_bf16_f32 v126, v148, v149
    v_cvt_pk_bf16_f32 v127, v150, v151
    v_add_f32 v21, v21, v132
    s_waitcnt vmcnt(0)
    s_barrier
    v_mfma_f32_16x16x32_bf16 v[132:135], v[24:27], v[116:119], 0
    v_add_f32 v22, v22, v136
    v_add_f32 v23, v23, v140
    v_mfma_f32_16x16x32_bf16 v[136:139], v[24:27], v[120:123], 0
    v_add_u32 v3, s56, v3
    v_add_u32 v4, s56, v4
    v_mfma_f32_16x16x32_bf16 v[140:143], v[24:27], v[124:127], 0
    ds_read_b64_tr_b16 a[240:241], v3 offset:24576
    ds_read_b64_tr_b16 a[242:243], v3 offset:30720
    v_add_u32 v5, s56, v5
    v_add_u32 v6, s56, v6
    ds_read_b64_tr_b16 a[244:245], v4 offset:24576
    v_max3_f32 v30, v128, v132, v136
    ds_read_b64_tr_b16 a[246:247], v4 offset:30720
    ds_read_b64_tr_b16 a[248:249], v5 offset:24576
    v_max_f32 v30, v30, v140
    v_cmp_lt_f32 vcc, s37, v30
    ds_read_b64_tr_b16 a[250:251], v5 offset:30720
    ds_read_b64_tr_b16 a[252:253], v6 offset:24576
    ds_read_b64_tr_b16 a[254:255], v6 offset:30720
    s_nop 1
    s_cbranch_vccnz L_rs_end4
L_ret_end4:
    s_add_u32 s84, s42, 0
    s_add_u32 s85, s42, 6144
    s_add_u32 s86, s42, 12288
    s_add_u32 s87, s42, 18432
    s_waitcnt lgkmcnt(6)
    v_mfma_f32_16x16x32_bf16 v[160:163], a[240:243], v[112:115], v[160:163]
    v_add_f32 v20, v20, v128
    v_add_f32 v21, v21, v132
    v_mfma_f32_16x16x32_bf16 v[208:211], a[240:243], v[116:119], v[208:211]
    v_rcp_f32 v130, v20
    v_mfma_f32_16x16x32_bf16 a[0:3], a[240:243], v[120:123], a[0:3]
    v_rcp_f32 v134, v21
    v_mov_b32 v96, v15
    v_xor_b32 v97, 32, v15
    v_mfma_f32_16x16x32_bf16 a[48:51], a[240:243], v[124:127], a[48:51]
    ds_read_b64_tr_b16 a[240:241], v3 offset:25600
    ds_read_b64_tr_b16 a[242:243], v3 offset:31744
    v_mul_f32 v160, v160, v130
    v_mul_f32 v161, v161, v130
    s_waitcnt lgkmcnt(5)
    v_mfma_f32_16x16x32_bf16 v[164:167], a[244:247], v[112:115], v[164:167]
    v_mul_f32 v162, v162, v130
    v_mul_f32 v163, v163, v130
    v_mul_f32 v208, v208, v134
    v_mul_f32 v209, v209, v134
    v_mfma_f32_16x16x32_bf16 v[212:215], a[244:247], v[116:119], v[212:215]
    v_mul_f32 v210, v210, v134
    v_mul_f32 v211, v211, v134
    v_cvt_pk_bf16_f32 v80, v160, v161
    v_cvt_pk_bf16_f32 v81, v162, v163
    v_mfma_f32_16x16x32_bf16 a[4:7], a[244:247], v[120:123], a[4:7]
    v_cvt_pk_bf16_f32 v82, v208, v209
    v_cvt_pk_bf16_f32 v83, v210, v211
    v_mul_f32 v164, v164, v130
    v_mul_f32 v165, v165, v130
    v_mfma_f32_16x16x32_bf16 a[52:55], a[244:247], v[124:127], a[52:55]
    ds_read_b64_tr_b16 a[244:245], v4 offset:25600
    ds_read_b64_tr_b16 a[246:247], v4 offset:31744
    v_mul_f32 v166, v166, v130
    v_mul_f32 v167, v167, v130
    s_waitcnt lgkmcnt(4)
    v_mfma_f32_16x16x32_bf16 v[168:171], a[248:251], v[112:115], v[168:171]
    v_mul_f32 v212, v212, v134
    v_mul_f32 v213, v213, v134
    v_mul_f32 v214, v214, v134
    v_mul_f32 v215, v215, v134
    v_mfma_f32_16x16x32_bf16 v[216:219], a[248:251], v[116:119], v[216:219]
    v_cvt_pk_bf16_f32 v84, v164, v165
    v_cvt_pk_bf16_f32 v85, v166, v167
    v_cvt_pk_bf16_f32 v86, v212, v213
    v_cvt_pk_bf16_f32 v87, v214, v215
    v_mfma_f32_16x16x32_bf16 a[8:11], a[248:251], v[120:123], a[8:11]
    v_mul_f32 v168, v168, v130
    v_mul_f32 v169, v169, v130
    v_mul_f32 v170, v170, v130
    v_mul_f32 v171, v171, v130
    v_mfma_f32_16x16x32_bf16 a[56:59], a[248:251], v[124:127], a[56:59]
    ds_read_b64_tr_b16 a[248:249], v5 offset:25600
    ds_read_b64_tr_b16 a[250:251], v5 offset:31744
    v_mul_f32 v216, v216, v134
    v_mul_f32 v217, v217, v134
    v_mfma_f32_16x16x32_bf16 v[172:175], a[252:255], v[112:115], v[172:175]
    v_mul_f32 v218, v218, v134
    v_mul_f32 v219, v219, v134
    v_xor_b32 v98, 64, v15
    v_cvt_pk_bf16_f32 v88, v168, v169
    v_mfma_f32_16x16x32_bf16 v[220:223], a[252:255], v[116:119], v[220:223]
    v_cvt_pk_bf16_f32 v89, v170, v171
    v_cvt_pk_bf16_f32 v90, v216, v217
    v_cvt_pk_bf16_f32 v91, v218, v219
    v_mul_f32 v172, v172, v130
    v_mfma_f32_16x16x32_bf16 a[12:15], a[252:255], v[120:123], a[12:15]
    v_mul_f32 v173, v173, v130
    v_mul_f32 v174, v174, v130
    v_mul_f32 v175, v175, v130
    v_mul_f32 v220, v220, v134
    v_mfma_f32_16x16x32_bf16 a[60:63], a[252:255], v[124:127], a[60:63]
    ds_read_b64_tr_b16 a[252:253], v6 offset:25600
    ds_read_b64_tr_b16 a[254:255], v6 offset:31744
    v_mul_f32 v221, v221, v134
    v_mul_f32 v222, v222, v134
    s_waitcnt lgkmcnt(4)
    v_mfma_f32_16x16x32_bf16 v[176:179], a[240:243], v[112:115], v[176:179]
    v_mul_f32 v223, v223, v134
    v_xor_b32 v99, 96, v15
    v_cvt_pk_bf16_f32 v92, v172, v173
    v_cvt_pk_bf16_f32 v93, v174, v175
    v_mfma_f32_16x16x32_bf16 v[224:227], a[240:243], v[116:119], v[224:227]
    v_cvt_pk_bf16_f32 v94, v220, v221
    v_cvt_pk_bf16_f32 v95, v222, v223
    v_add_f32 v22, v22, v136
    v_add_f32 v23, v23, v140
    v_mfma_f32_16x16x32_bf16 a[16:19], a[240:243], v[120:123], a[16:19]
    v_rcp_f32 v138, v22
    v_rcp_f32 v142, v23
    v_mfma_f32_16x16x32_bf16 a[64:67], a[240:243], v[124:127], a[64:67]
    ds_read_b64_tr_b16 a[240:241], v3 offset:26624
    ds_read_b64_tr_b16 a[242:243], v3 offset:32768
    v_accvgpr_read_b32 v64, a0
    v_accvgpr_read_b32 v65, a1
    v_mfma_f32_16x16x32_bf16 v[180:183], a[244:247], v[112:115], v[180:183]
    v_accvgpr_read_b32 v66, a2
    v_accvgpr_read_b32 v67, a3
    v_accvgpr_read_b32 v68, a48
    v_accvgpr_read_b32 v69, a49
    v_mfma_f32_16x16x32_bf16 v[228:231], a[244:247], v[116:119], v[228:231]
    v_accvgpr_read_b32 v70, a50
    v_accvgpr_read_b32 v71, a51
    v_mul_f32 v64, v64, v138
    v_mul_f32 v65, v65, v138
    v_mfma_f32_16x16x32_bf16 a[20:23], a[244:247], v[120:123], a[20:23]
    v_mul_f32 v66, v66, v138
    v_mul_f32 v67, v67, v138
    v_mul_f32 v68, v68, v142
    v_mul_f32 v69, v69, v142
    v_mfma_f32_16x16x32_bf16 a[68:71], a[244:247], v[124:127], a[68:71]
    ds_read_b64_tr_b16 a[244:245], v4 offset:26624
    ds_read_b64_tr_b16 a[246:247], v4 offset:32768
    v_mul_f32 v70, v70, v142
    v_mul_f32 v71, v71, v142
    s_waitcnt lgkmcnt(4)
    v_mfma_f32_16x16x32_bf16 v[184:187], a[248:251], v[112:115], v[184:187]
    v_accvgpr_read_b32 v72, a4
    v_accvgpr_read_b32 v73, a5
    v_accvgpr_read_b32 v74, a6
    v_accvgpr_read_b32 v75, a7
    v_mfma_f32_16x16x32_bf16 v[232:235], a[248:251], v[116:119], v[232:235]
    v_accvgpr_read_b32 v76, a52
    v_accvgpr_read_b32 v77, a53
    v_accvgpr_read_b32 v78, a54
    v_accvgpr_read_b32 v79, a55
    v_mfma_f32_16x16x32_bf16 a[24:27], a[248:251], v[120:123], a[24:27]
    v_mul_f32 v72, v72, v138
    v_mul_f32 v73, v73, v138
    v_mul_f32 v74, v74, v138
    v_mul_f32 v75, v75, v138
    v_mfma_f32_16x16x32_bf16 a[72:75], a[248:251], v[124:127], a[72:75]
    ds_read_b64_tr_b16 a[248:249], v5 offset:26624
    ds_read_b64_tr_b16 a[250:251], v5 offset:32768
    v_mul_f32 v76, v76, v142
    v_mul_f32 v77, v77, v142
    v_mfma_f32_16x16x32_bf16 v[188:191], a[252:255], v[112:115], v[188:191]
    v_mul_f32 v78, v78, v142
    v_mul_f32 v79, v79, v142
    v_mfma_f32_16x16x32_bf16 v[236:239], a[252:255], v[116:119], v[236:239]
    ds_write2st64_b64 v96, v[80:81], v[82:83] offset0:0 offset1:4
    v_mfma_f32_16x16x32_bf16 a[28:31], a[252:255], v[120:123], a[28:31]
    v_cvt_pk_bf16_f32 v80, v64, v65
    v_cvt_pk_bf16_f32 v81, v66, v67
    v_cvt_pk_bf16_f32 v82, v68, v69
    v_mfma_f32_16x16x32_bf16 a[76:79], a[252:255], v[124:127], a[76:79]
    ds_read_b64_tr_b16 a[252:253], v6 offset:26624
    ds_read_b64_tr_b16 a[254:255], v6 offset:32768
    v_cvt_pk_bf16_f32 v83, v70, v71
    v_accvgpr_read_b32 v64, a8
    s_waitcnt lgkmcnt(5)
    v_mfma_f32_16x16x32_bf16 v[192:195], a[240:243], v[112:115], v[192:195]
    v_accvgpr_read_b32 v65, a9
    v_accvgpr_read_b32 v66, a10
    v_accvgpr_read_b32 v67, a11
    v_accvgpr_read_b32 v68, a56
    v_mfma_f32_16x16x32_bf16 v[240:243], a[240:243], v[116:119], v[240:243]
    v_accvgpr_read_b32 v69, a57
    v_accvgpr_read_b32 v70, a58
    v_accvgpr_read_b32 v71, a59
    v_mul_f32 v64, v64, v138
    v_mfma_f32_16x16x32_bf16 a[32:35], a[240:243], v[120:123], a[32:35]
    v_mul_f32 v65, v65, v138
    v_mul_f32 v66, v66, v138
    v_mul_f32 v67, v67, v138
    v_mul_f32 v68, v68, v142
    v_mfma_f32_16x16x32_bf16 a[80:83], a[240:243], v[124:127], a[80:83]
    v_mul_f32 v69, v69, v142
    v_mul_f32 v70, v70, v142
    v_mul_f32 v71, v71, v142
    v_mfma_f32_16x16x32_bf16 v[196:199], a[244:247], v[112:115], v[196:199]
    ds_write2st64_b64 v97, v[84:85], v[86:87] offset0:0 offset1:4
    v_mfma_f32_16x16x32_bf16 v[244:247], a[244:247], v[116:119], v[244:247]
    v_cvt_pk_bf16_f32 v84, v72, v73
    v_cvt_pk_bf16_f32 v85, v74, v75
    v_cvt_pk_bf16_f32 v86, v76, v77
    v_mfma_f32_16x16x32_bf16 a[36:39], a[244:247], v[120:123], a[36:39]
    v_cvt_pk_bf16_f32 v87, v78, v79
    v_accvgpr_read_b32 v72, a12
    v_accvgpr_read_b32 v73, a13
    v_accvgpr_read_b32 v74, a14
    v_mfma_f32_16x16x32_bf16 a[84:87], a[244:247], v[124:127], a[84:87]
    v_accvgpr_read_b32 v75, a15
    v_accvgpr_read_b32 v76, a60
    v_accvgpr_read_b32 v77, a61
    v_accvgpr_read_b32 v78, a62
    s_waitcnt lgkmcnt(1)
    v_mfma_f32_16x16x32_bf16 v[200:203], a[248:251], v[112:115], v[200:203]
    v_accvgpr_read_b32 v79, a63
    v_mul_f32 v72, v72, v138
    v_mul_f32 v73, v73, v138
    v_mul_f32 v74, v74, v138
    v_mfma_f32_16x16x32_bf16 v[248:251], a[248:251], v[116:119], v[248:251]
    v_mul_f32 v75, v75, v138
    v_mul_f32 v76, v76, v142
    v_mul_f32 v77, v77, v142
    v_mul_f32 v78, v78, v142
    v_mfma_f32_16x16x32_bf16 a[40:43], a[248:251], v[120:123], a[40:43]
    v_mul_f32 v79, v79, v142
    v_mfma_f32_16x16x32_bf16 a[88:91], a[248:251], v[124:127], a[88:91]
    ds_write2st64_b64 v98, v[88:89], v[90:91] offset0:0 offset1:4
    v_mfma_f32_16x16x32_bf16 v[204:207], a[252:255], v[112:115], v[204:207]
    v_cvt_pk_bf16_f32 v88, v64, v65
    v_cvt_pk_bf16_f32 v89, v66, v67
    v_cvt_pk_bf16_f32 v90, v68, v69
    v_mfma_f32_16x16x32_bf16 v[252:255], a[252:255], v[116:119], v[252:255]
    v_cvt_pk_bf16_f32 v91, v70, v71
    v_accvgpr_read_b32 v64, a16
    v_accvgpr_read_b32 v65, a17
    v_accvgpr_read_b32 v66, a18
    v_mfma_f32_16x16x32_bf16 a[44:47], a[252:255], v[120:123], a[44:47]
    v_accvgpr_read_b32 v67, a19
    v_accvgpr_read_b32 v68, a64
    v_accvgpr_read_b32 v69, a65
    v_accvgpr_read_b32 v70, a66
    v_mfma_f32_16x16x32_bf16 a[92:95], a[252:255], v[124:127], a[92:95]
    ds_write2st64_b64 v99, v[92:93], v[94:95] offset0:0 offset1:4
    ds_read_b128 v[144:147], v14 offset:0
    ds_read_b128 v[148:151], v14 offset:1024
    ds_read_b128 v[152:155], v14 offset:2048
    ds_read_b128 v[156:159], v14 offset:3072
    ds_write2st64_b64 v96, v[80:81], v[82:83] offset0:0 offset1:4
    ds_write2st64_b64 v97, v[84:85], v[86:87] offset0:0 offset1:4
    ds_write2st64_b64 v98, v[88:89], v[90:91] offset0:0 offset1:4
    v_cvt_pk_bf16_f32 v92, v72, v73
    v_cvt_pk_bf16_f32 v93, v74, v75
    v_cvt_pk_bf16_f32 v94, v76, v77
    v_cvt_pk_bf16_f32 v95, v78, v79
    v_pk_mul_f32 v[176:177], v[176:177], v[130:131] op_sel_hi:[1,0]
    v_pk_mul_f32 v[178:179], v[178:179], v[130:131] op_sel_hi:[1,0]
    v_pk_mul_f32 v[224:225], v[224:225], v[134:135] op_sel_hi:[1,0]
    v_pk_mul_f32 v[226:227], v[226:227], v[134:135] op_sel_hi:[1,0]
    v_cvt_pk_bf16_f32 v80, v176, v177
    v_cvt_pk_bf16_f32 v81, v178, v179
    v_cvt_pk_bf16_f32 v82, v224, v225
    v_cvt_pk_bf16_f32 v83, v226, v227
    v_pk_mul_f32 v[180:181], v[180:181], v[130:131] op_sel_hi:[1,0]
    v_pk_mul_f32 v[182:183], v[182:183], v[130:131] op_sel_hi:[1,0]
    v_pk_mul_f32 v[228:229], v[228:229], v[134:135] op_sel_hi:[1,0]
    v_pk_mul_f32 v[230:231], v[230:231], v[134:135] op_sel_hi:[1,0]
    v_cvt_pk_bf16_f32 v84, v180, v181
    v_cvt_pk_bf16_f32 v85, v182, v183
    v_cvt_pk_bf16_f32 v86, v228, v229
    v_cvt_pk_bf16_f32 v87, v230, v231
    v_pk_mul_f32 v[184:185], v[184:185], v[130:131] op_sel_hi:[1,0]
    v_pk_mul_f32 v[186:187], v[186:187], v[130:131] op_sel_hi:[1,0]
    v_pk_mul_f32 v[232:233], v[232:233], v[134:135] op_sel_hi:[1,0]
    v_pk_mul_f32 v[234:235], v[234:235], v[134:135] op_sel_hi:[1,0]
    v_cvt_pk_bf16_f32 v88, v184, v185
    v_cvt_pk_bf16_f32 v89, v186, v187
    v_cvt_pk_bf16_f32 v90, v232, v233
    v_cvt_pk_bf16_f32 v91, v234, v235
    v_pk_mul_f32 v[188:189], v[188:189], v[130:131] op_sel_hi:[1,0]
    v_pk_mul_f32 v[190:191], v[190:191], v[130:131] op_sel_hi:[1,0]
    v_pk_mul_f32 v[236:237], v[236:237], v[134:135] op_sel_hi:[1,0]
    v_pk_mul_f32 v[238:239], v[238:239], v[134:135] op_sel_hi:[1,0]
    v_accvgpr_read_b32 v71, a67
    v_pk_mul_f32 v[64:65], v[64:65], v[138:139] op_sel_hi:[1,0]
    v_pk_mul_f32 v[66:67], v[66:67], v[138:139] op_sel_hi:[1,0]
    v_pk_mul_f32 v[68:69], v[68:69], v[142:143] op_sel_hi:[1,0]
    v_pk_mul_f32 v[70:71], v[70:71], v[142:143] op_sel_hi:[1,0]
    v_accvgpr_read_b32 v72, a20
    v_accvgpr_read_b32 v73, a21
    v_accvgpr_read_b32 v74, a22
    v_accvgpr_read_b32 v75, a23
    v_accvgpr_read_b32 v76, a68
    v_accvgpr_read_b32 v77, a69
    v_accvgpr_read_b32 v78, a70
    v_accvgpr_read_b32 v79, a71
    v_pk_mul_f32 v[72:73], v[72:73], v[138:139] op_sel_hi:[1,0]
    v_pk_mul_f32 v[74:75], v[74:75], v[138:139] op_sel_hi:[1,0]
    v_pk_mul_f32 v[76:77], v[76:77], v[142:143] op_sel_hi:[1,0]
    v_pk_mul_f32 v[78:79], v[78:79], v[142:143] op_sel_hi:[1,0]
    v_pk_mul_f32 v[192:193], v[192:193], v[130:131] op_sel_hi:[1,0]
    v_pk_mul_f32 v[194:195], v[194:195], v[130:131] op_sel_hi:[1,0]
    v_pk_mul_f32 v[240:241], v[240:241], v[134:135] op_sel_hi:[1,0]
    v_pk_mul_f32 v[242:243], v[242:243], v[134:135] op_sel_hi:[1,0]
    v_pk_mul_f32 v[196:197], v[196:197], v[130:131] op_sel_hi:[1,0]
    v_pk_mul_f32 v[198:199], v[198:199], v[130:131] op_sel_hi:[1,0]
    v_pk_mul_f32 v[244:245], v[244:245], v[134:135] op_sel_hi:[1,0]
    v_pk_mul_f32 v[246:247], v[246:247], v[134:135] op_sel_hi:[1,0]
    v_pk_mul_f32 v[200:201], v[200:201], v[130:131] op_sel_hi:[1,0]
    v_pk_mul_f32 v[202:203], v[202:203], v[130:131] op_sel_hi:[1,0]
    v_pk_mul_f32 v[248:249], v[248:249], v[134:135] op_sel_hi:[1,0]
    v_pk_mul_f32 v[250:251], v[250:251], v[134:135] op_sel_hi:[1,0]
    v_pk_mul_f32 v[204:205], v[204:205], v[130:131] op_sel_hi:[1,0]
    v_pk_mul_f32 v[206:207], v[206:207], v[130:131] op_sel_hi:[1,0]
    v_pk_mul_f32 v[252:253], v[252:253], v[134:135] op_sel_hi:[1,0]
    v_pk_mul_f32 v[254:255], v[254:255], v[134:135] op_sel_hi:[1,0]
    ds_write2st64_b64 v99, v[92:93], v[94:95] offset0:0 offset1:4
    s_waitcnt lgkmcnt(1)
    buffer_store_dwordx4 v[144:147], v13, s[16:19], s84 offen offset:0 nt
    v_cvt_pk_bf16_f32 v92, v188, v189
    v_cvt_pk_bf16_f32 v93, v190, v191
    v_cvt_pk_bf16_f32 v94, v236, v237
    v_cvt_pk_bf16_f32 v95, v238, v239
    ds_read_b128 v[144:147], v14 offset:0
    buffer_store_dwordx4 v[148:151], v13, s[16:19], s84 offen offset:3072 nt
    buffer_store_dwordx4 v[152:155], v13, s[16:19], s85 offen offset:0 nt
    ds_read_b128 v[148:151], v14 offset:1024
    ds_read_b128 v[152:155], v14 offset:2048
    buffer_store_dwordx4 v[156:159], v13, s[16:19], s85 offen offset:3072 nt
    s_waitcnt lgkmcnt(2)
    buffer_store_dwordx4 v[144:147], v13, s[16:19], s86 offen offset:0 nt
    ds_read_b128 v[156:159], v14 offset:3072
    ds_write2st64_b64 v96, v[80:81], v[82:83] offset0:0 offset1:4
    ds_write2st64_b64 v97, v[84:85], v[86:87] offset0:0 offset1:4
    ds_write2st64_b64 v98, v[88:89], v[90:91] offset0:0 offset1:4
    s_waitcnt lgkmcnt(4)
    buffer_store_dwordx4 v[148:151], v13, s[16:19], s86 offen offset:3072 nt
    ds_write2st64_b64 v99, v[92:93], v[94:95] offset0:0 offset1:4
    ds_read_b128 v[144:147], v14 offset:0
    ds_read_b128 v[148:151], v14 offset:1024
    v_cvt_pk_bf16_f32 v80, v64, v65
    v_cvt_pk_bf16_f32 v81, v66, v67
    v_cvt_pk_bf16_f32 v82, v68, v69
    v_cvt_pk_bf16_f32 v83, v70, v71
    v_cvt_pk_bf16_f32 v84, v72, v73
    v_cvt_pk_bf16_f32 v85, v74, v75
    v_cvt_pk_bf16_f32 v86, v76, v77
    v_cvt_pk_bf16_f32 v87, v78, v79
    v_accvgpr_read_b32 v64, a24
    v_accvgpr_read_b32 v65, a25
    v_accvgpr_read_b32 v66, a26
    v_accvgpr_read_b32 v67, a27
    v_accvgpr_read_b32 v68, a72
    v_accvgpr_read_b32 v69, a73
    v_accvgpr_read_b32 v70, a74
    v_accvgpr_read_b32 v71, a75
    v_pk_mul_f32 v[64:65], v[64:65], v[138:139] op_sel_hi:[1,0]
    v_pk_mul_f32 v[66:67], v[66:67], v[138:139] op_sel_hi:[1,0]
    v_pk_mul_f32 v[68:69], v[68:69], v[142:143] op_sel_hi:[1,0]
    v_pk_mul_f32 v[70:71], v[70:71], v[142:143] op_sel_hi:[1,0]
    v_accvgpr_read_b32 v72, a28
    v_accvgpr_read_b32 v73, a29
    v_accvgpr_read_b32 v74, a30
    v_accvgpr_read_b32 v75, a31
    v_accvgpr_read_b32 v76, a76
    v_accvgpr_read_b32 v77, a77
    v_accvgpr_read_b32 v78, a78
    v_accvgpr_read_b32 v79, a79
    v_cvt_pk_bf16_f32 v88, v64, v65
    v_cvt_pk_bf16_f32 v89, v66, v67
    v_cvt_pk_bf16_f32 v90, v68, v69
    v_cvt_pk_bf16_f32 v91, v70, v71
    v_pk_mul_f32 v[72:73], v[72:73], v[138:139] op_sel_hi:[1,0]
    v_pk_mul_f32 v[74:75], v[74:75], v[138:139] op_sel_hi:[1,0]
    v_pk_mul_f32 v[76:77], v[76:77], v[142:143] op_sel_hi:[1,0]
    v_pk_mul_f32 v[78:79], v[78:79], v[142:143] op_sel_hi:[1,0]
    v_cvt_pk_bf16_f32 v92, v72, v73
    v_cvt_pk_bf16_f32 v93, v74, v75
    v_cvt_pk_bf16_f32 v94, v76, v77
    v_cvt_pk_bf16_f32 v95, v78, v79
    v_accvgpr_read_b32 v64, a32
    v_accvgpr_read_b32 v65, a33
    v_accvgpr_read_b32 v66, a34
    v_accvgpr_read_b32 v67, a35
    v_accvgpr_read_b32 v68, a80
    v_accvgpr_read_b32 v69, a81
    v_accvgpr_read_b32 v70, a82
    v_accvgpr_read_b32 v71, a83
    v_pk_mul_f32 v[64:65], v[64:65], v[138:139] op_sel_hi:[1,0]
    v_pk_mul_f32 v[66:67], v[66:67], v[138:139] op_sel_hi:[1,0]
    v_pk_mul_f32 v[68:69], v[68:69], v[142:143] op_sel_hi:[1,0]
    v_pk_mul_f32 v[70:71], v[70:71], v[142:143] op_sel_hi:[1,0]
    v_accvgpr_read_b32 v72, a36
    v_accvgpr_read_b32 v73, a37
    v_accvgpr_read_b32 v74, a38
    v_accvgpr_read_b32 v75, a39
    v_accvgpr_read_b32 v76, a84
    v_accvgpr_read_b32 v77, a85
    v_accvgpr_read_b32 v78, a86
    v_accvgpr_read_b32 v79, a87
    v_pk_mul_f32 v[72:73], v[72:73], v[138:139] op_sel_hi:[1,0]
    v_pk_mul_f32 v[74:75], v[74:75], v[138:139] op_sel_hi:[1,0]
    v_pk_mul_f32 v[76:77], v[76:77], v[142:143] op_sel_hi:[1,0]
    v_pk_mul_f32 v[78:79], v[78:79], v[142:143] op_sel_hi:[1,0]
    buffer_store_dwordx4 v[152:155], v13, s[16:19], s87 offen offset:0 nt
    s_waitcnt lgkmcnt(0)
    buffer_store_dwordx4 v[156:159], v13, s[16:19], s87 offen offset:3072 nt
    ds_read_b128 v[152:155], v14 offset:2048
    ds_read_b128 v[156:159], v14 offset:3072
    ds_write2st64_b64 v96, v[80:81], v[82:83] offset0:0 offset1:4
    ds_write2st64_b64 v97, v[84:85], v[86:87] offset0:0 offset1:4
    ds_write2st64_b64 v98, v[88:89], v[90:91] offset0:0 offset1:4
    buffer_store_dwordx4 v[144:147], v13, s[16:19], s84 offen offset:128 nt
    ds_write2st64_b64 v99, v[92:93], v[94:95] offset0:0 offset1:4
    ds_read_b128 v[144:147], v14 offset:0
    v_cvt_pk_bf16_f32 v80, v192, v193
    v_cvt_pk_bf16_f32 v81, v194, v195
    v_cvt_pk_bf16_f32 v82, v240, v241
    v_cvt_pk_bf16_f32 v83, v242, v243
    v_cvt_pk_bf16_f32 v84, v196, v197
    v_cvt_pk_bf16_f32 v85, v198, v199
    v_cvt_pk_bf16_f32 v86, v244, v245
    v_cvt_pk_bf16_f32 v87, v246, v247
    v_cvt_pk_bf16_f32 v88, v200, v201
    v_cvt_pk_bf16_f32 v89, v202, v203
    v_cvt_pk_bf16_f32 v90, v248, v249
    v_cvt_pk_bf16_f32 v91, v250, v251
    v_cvt_pk_bf16_f32 v92, v204, v205
    v_cvt_pk_bf16_f32 v93, v206, v207
    v_cvt_pk_bf16_f32 v94, v252, v253
    v_cvt_pk_bf16_f32 v95, v254, v255
    buffer_store_dwordx4 v[148:151], v13, s[16:19], s84 offen offset:3200 nt
    s_waitcnt lgkmcnt(1)
    buffer_store_dwordx4 v[152:155], v13, s[16:19], s85 offen offset:128 nt
    ds_read_b128 v[148:151], v14 offset:1024
    ds_read_b128 v[152:155], v14 offset:2048
    buffer_store_dwordx4 v[156:159], v13, s[16:19], s85 offen offset:3200 nt
    s_waitcnt lgkmcnt(2)
    buffer_store_dwordx4 v[144:147], v13, s[16:19], s86 offen offset:128 nt
    ds_read_b128 v[156:159], v14 offset:3072
    ds_write2st64_b64 v96, v[80:81], v[82:83] offset0:0 offset1:4
    ds_write2st64_b64 v97, v[84:85], v[86:87] offset0:0 offset1:4
    ds_write2st64_b64 v98, v[88:89], v[90:91] offset0:0 offset1:4
    s_waitcnt lgkmcnt(4)
    buffer_store_dwordx4 v[148:151], v13, s[16:19], s86 offen offset:3200 nt
    ds_write2st64_b64 v99, v[92:93], v[94:95] offset0:0 offset1:4
    ds_read_b128 v[144:147], v14 offset:0
    ds_read_b128 v[148:151], v14 offset:1024
    v_cvt_pk_bf16_f32 v80, v64, v65
    v_cvt_pk_bf16_f32 v81, v66, v67
    v_cvt_pk_bf16_f32 v82, v68, v69
    v_cvt_pk_bf16_f32 v83, v70, v71
    v_cvt_pk_bf16_f32 v84, v72, v73
    v_cvt_pk_bf16_f32 v85, v74, v75
    v_cvt_pk_bf16_f32 v86, v76, v77
    v_cvt_pk_bf16_f32 v87, v78, v79
    v_accvgpr_read_b32 v64, a40
    v_accvgpr_read_b32 v65, a41
    v_accvgpr_read_b32 v66, a42
    v_accvgpr_read_b32 v67, a43
    v_accvgpr_read_b32 v68, a88
    v_accvgpr_read_b32 v69, a89
    v_accvgpr_read_b32 v70, a90
    v_accvgpr_read_b32 v71, a91
    v_pk_mul_f32 v[64:65], v[64:65], v[138:139] op_sel_hi:[1,0]
    v_pk_mul_f32 v[66:67], v[66:67], v[138:139] op_sel_hi:[1,0]
    v_pk_mul_f32 v[68:69], v[68:69], v[142:143] op_sel_hi:[1,0]
    v_pk_mul_f32 v[70:71], v[70:71], v[142:143] op_sel_hi:[1,0]
    v_accvgpr_read_b32 v72, a44
    v_accvgpr_read_b32 v73, a45
    v_accvgpr_read_b32 v74, a46
    v_accvgpr_read_b32 v75, a47
    v_accvgpr_read_b32 v76, a92
    v_accvgpr_read_b32 v77, a93
    v_accvgpr_read_b32 v78, a94
    v_accvgpr_read_b32 v79, a95
    v_cvt_pk_bf16_f32 v88, v64, v65
    v_cvt_pk_bf16_f32 v89, v66, v67
    v_cvt_pk_bf16_f32 v90, v68, v69
    v_cvt_pk_bf16_f32 v91, v70, v71
    v_pk_mul_f32 v[72:73], v[72:73], v[138:139] op_sel_hi:[1,0]
    v_pk_mul_f32 v[74:75], v[74:75], v[138:139] op_sel_hi:[1,0]
    v_pk_mul_f32 v[76:77], v[76:77], v[142:143] op_sel_hi:[1,0]
    v_pk_mul_f32 v[78:79], v[78:79], v[142:143] op_sel_hi:[1,0]
    v_cvt_pk_bf16_f32 v92, v72, v73
    v_cvt_pk_bf16_f32 v93, v74, v75
    v_cvt_pk_bf16_f32 v94, v76, v77
    v_cvt_pk_bf16_f32 v95, v78, v79
    buffer_store_dwordx4 v[152:155], v13, s[16:19], s87 offen offset:128 nt
    s_waitcnt lgkmcnt(0)
    buffer_store_dwordx4 v[156:159], v13, s[16:19], s87 offen offset:3200 nt
    ds_read_b128 v[152:155], v14 offset:2048
    ds_read_b128 v[156:159], v14 offset:3072
    ds_write2st64_b64 v96, v[80:81], v[82:83] offset0:0 offset1:4
    ds_write2st64_b64 v97, v[84:85], v[86:87] offset0:0 offset1:4
    ds_write2st64_b64 v98, v[88:89], v[90:91] offset0:0 offset1:4
    buffer_store_dwordx4 v[144:147], v13, s[16:19], s84 offen offset:256 nt
    ds_write2st64_b64 v99, v[92:93], v[94:95] offset0:0 offset1:4
    ds_read_b128 v[144:147], v14 offset:0
    buffer_store_dwordx4 v[148:151], v13, s[16:19], s84 offen offset:3328 nt
    s_waitcnt lgkmcnt(3)
    buffer_store_dwordx4 v[152:155], v13, s[16:19], s85 offen offset:256 nt
    ds_read_b128 v[148:151], v14 offset:1024
    ds_read_b128 v[152:155], v14 offset:2048
    buffer_store_dwordx4 v[156:159], v13, s[16:19], s85 offen offset:3328 nt
    s_waitcnt lgkmcnt(2)
    buffer_store_dwordx4 v[144:147], v13, s[16:19], s86 offen offset:256 nt
    ds_read_b128 v[156:159], v14 offset:3072
    s_waitcnt lgkmcnt(1)
    buffer_store_dwordx4 v[148:151], v13, s[16:19], s86 offen offset:3328 nt
    buffer_store_dwordx4 v[152:155], v13, s[16:19], s87 offen offset:256 nt
    s_waitcnt lgkmcnt(0)
    buffer_store_dwordx4 v[156:159], v13, s[16:19], s87 offen offset:3328 nt
    s_branch L_fin
L_end3:
    s_waitcnt lgkmcnt(4)
    v_mfma_f32_16x16x32_bf16 v[160:163], a[240:243], v[96:99], v[160:163]
    s_add_u32 s65, s34, 24576
    v_fma_f32 v68, v68, s36, v16
    v_fma_f32 v69, v69, s36, v16
    v_mfma_f32_16x16x32_bf16 v[208:211], a[240:243], v[100:103], v[208:211]
    s_add_u32 s62, s34, 49152
    v_exp_f32 v150, v68
    v_mfma_f32_16x16x32_bf16 a[0:3], a[240:243], v[104:107], a[0:3]
    s_cmp_eq_u32 s62, 147456
    ds_read_b64_tr_b16 a[240:241], v3 offset:1024
    ds_read_b64_tr_b16 a[242:243], v3 offset:7168
    v_mfma_f32_16x16x32_bf16 v[164:167], a[244:247], v[96:99], v[164:167]
    s_cselect_b32 s62, 0, s62
    v_exp_f32 v151, v69
    v_mfma_f32_16x16x32_bf16 v[212:215], a[244:247], v[100:103], v[212:215]
    s_sub_u32 s56, s62, s34
    v_cvt_pk_bf16_f32 v114, v150, v151
    v_fma_f32 v70, v70, s36, v16
    v_mfma_f32_16x16x32_bf16 a[4:7], a[244:247], v[104:107], a[4:7]
    s_mov_b32 s34, s62
    ds_read_b64_tr_b16 a[244:245], v4 offset:1024
    ds_read_b64_tr_b16 a[246:247], v4 offset:7168
    s_waitcnt lgkmcnt(4)
    v_mfma_f32_16x16x32_bf16 v[168:171], a[248:251], v[96:99], v[168:171]
    v_fma_f32 v71, v71, s36, v16
    v_fma_f32 v74, v74, s36, v17
    v_mfma_f32_16x16x32_bf16 v[216:219], a[248:251], v[100:103], v[216:219]
    v_fma_f32 v75, v75, s36, v17
    v_fma_f32 v76, v76, s36, v17
    v_mfma_f32_16x16x32_bf16 a[8:11], a[248:251], v[104:107], a[8:11]
    ds_read_b64_tr_b16 a[248:249], v5 offset:1024
    ds_read_b64_tr_b16 a[250:251], v5 offset:7168
    v_mfma_f32_16x16x32_bf16 v[172:175], a[252:255], v[96:99], v[172:175]
    v_fma_f32 v77, v77, s36, v17
    v_fma_f32 v78, v78, s36, v17
    v_mfma_f32_16x16x32_bf16 v[220:223], a[252:255], v[100:103], v[220:223]
    v_fma_f32 v79, v79, s36, v17
    v_fma_f32 v80, v80, s36, v18
    v_mfma_f32_16x16x32_bf16 a[12:15], a[252:255], v[104:107], a[12:15]
    s_waitcnt lgkmcnt(4)
    ds_read_b64_tr_b16 a[252:253], v6 offset:1024
    ds_read_b64_tr_b16 a[254:255], v6 offset:7168
    v_mfma_f32_16x16x32_bf16 v[176:179], a[240:243], v[96:99], v[176:179]
    v_exp_f32 v144, v70
    v_mfma_f32_16x16x32_bf16 v[224:227], a[240:243], v[100:103], v[224:227]
    v_exp_f32 v145, v71
    v_mfma_f32_16x16x32_bf16 a[16:19], a[240:243], v[104:107], a[16:19]
    s_waitcnt lgkmcnt(4)
    ds_read_b64_tr_b16 a[240:241], v3 offset:2048
    ds_read_b64_tr_b16 a[242:243], v3 offset:8192
    v_mfma_f32_16x16x32_bf16 v[180:183], a[244:247], v[96:99], v[180:183]
    v_exp_f32 v146, v74
    v_mfma_f32_16x16x32_bf16 v[228:231], a[244:247], v[100:103], v[228:231]
    v_exp_f32 v147, v75
    v_mfma_f32_16x16x32_bf16 a[20:23], a[244:247], v[104:107], a[20:23]
    s_waitcnt lgkmcnt(4)
    ds_read_b64_tr_b16 a[244:245], v4 offset:2048
    ds_read_b64_tr_b16 a[246:247], v4 offset:8192
    v_mfma_f32_16x16x32_bf16 v[184:187], a[248:251], v[96:99], v[184:187]
    v_exp_f32 v148, v76
    v_mfma_f32_16x16x32_bf16 v[232:235], a[248:251], v[100:103], v[232:235]
    v_exp_f32 v149, v77
    v_mfma_f32_16x16x32_bf16 a[24:27], a[248:251], v[104:107], a[24:27]
    s_waitcnt lgkmcnt(4)
    ds_read_b64_tr_b16 a[248:249], v5 offset:2048
    ds_read_b64_tr_b16 a[250:251], v5 offset:8192
    v_mfma_f32_16x16x32_bf16 v[188:191], a[252:255], v[96:99], v[188:191]
    v_exp_f32 v150, v78
    v_mfma_f32_16x16x32_bf16 v[236:239], a[252:255], v[100:103], v[236:239]
    v_exp_f32 v151, v79
    v_mfma_f32_16x16x32_bf16 a[28:31], a[252:255], v[104:107], a[28:31]
    s_waitcnt lgkmcnt(4)
    ds_read_b64_tr_b16 a[252:253], v6 offset:2048
    ds_read_b64_tr_b16 a[254:255], v6 offset:8192
    v_mfma_f32_16x16x32_bf16 v[192:195], a[240:243], v[96:99], v[192:195]
    v_cvt_pk_bf16_f32 v115, v144, v145
    v_cvt_pk_bf16_f32 v117, v146, v147
    v_mfma_f32_16x16x32_bf16 v[240:243], a[240:243], v[100:103], v[240:243]
    v_cvt_pk_bf16_f32 v118, v148, v149
    v_cvt_pk_bf16_f32 v119, v150, v151
    v_mfma_f32_16x16x32_bf16 a[32:35], a[240:243], v[104:107], a[32:35]
    s_waitcnt lgkmcnt(4)
    v_fma_f32 v81, v81, s36, v18
    v_fma_f32 v82, v82, s36, v18
    v_mfma_f32_16x16x32_bf16 v[196:199], a[244:247], v[96:99], v[196:199]
    v_fma_f32 v83, v83, s36, v18
    v_fma_f32 v84, v84, s36, v18
    v_mfma_f32_16x16x32_bf16 v[244:247], a[244:247], v[100:103], v[244:247]
    v_fma_f32 v85, v85, s36, v18
    v_fma_f32 v86, v86, s36, v18
    v_mfma_f32_16x16x32_bf16 a[36:39], a[244:247], v[104:107], a[36:39]
    v_fma_f32 v87, v87, s36, v18
    v_add_f32 v20, v20, v128
    v_mfma_f32_16x16x32_bf16 v[128:131], v[24:27], v[112:115], 0
    s_waitcnt lgkmcnt(2)
    v_exp_f32 v144, v80
    v_mfma_f32_16x16x32_bf16 v[200:203], a[248:251], v[96:99], v[200:203]
    v_exp_f32 v145, v81
    v_mfma_f32_16x16x32_bf16 v[248:251], a[248:251], v[100:103], v[248:251]
    v_exp_f32 v146, v82
    v_mfma_f32_16x16x32_bf16 a[40:43], a[248:251], v[104:107], a[40:43]
    s_waitcnt lgkmcnt(0)
    v_exp_f32 v147, v83
    v_mfma_f32_16x16x32_bf16 v[204:207], a[252:255], v[96:99], v[204:207]
    v_exp_f32 v148, v84
    v_mfma_f32_16x16x32_bf16 v[252:255], a[252:255], v[100:103], v[252:255]
    v_exp_f32 v149, v85
    v_mfma_f32_16x16x32_bf16 a[44:47], a[252:255], v[104:107], a[44:47]
    v_exp_f32 v150, v86
    v_exp_f32 v151, v87
    v_cvt_pk_bf16_f32 v120, v144, v145
    v_cvt_pk_bf16_f32 v121, v146, v147
    v_cvt_pk_bf16_f32 v122, v148, v149
    v_cvt_pk_bf16_f32 v123, v150, v151
    v_add_f32 v21, v21, v132
    s_waitcnt vmcnt(0)
    s_barrier
    v_mfma_f32_16x16x32_bf16 v[132:135], v[24:27], v[116:119], 0
    v_add_f32 v22, v22, v136
    v_add_u32 v3, s56, v3
    v_mfma_f32_16x16x32_bf16 v[136:139], v[24:27], v[120:123], 0
    v_add_u32 v4, s56, v4
    v_add_u32 v5, s56, v5
    v_add_u32 v6, s56, v6
    ds_read_b64_tr_b16 a[240:241], v3 offset:24576
    ds_read_b64_tr_b16 a[242:243], v3 offset:30720
    ds_read_b64_tr_b16 a[244:245], v4 offset:24576
    ds_read_b64_tr_b16 a[246:247], v4 offset:30720
    ds_read_b64_tr_b16 a[248:249], v5 offset:24576
    v_max3_f32 v30, v128, v132, v136
    v_cmp_lt_f32 vcc, s37, v30
    ds_read_b64_tr_b16 a[250:251], v5 offset:30720
    ds_read_b64_tr_b16 a[252:253], v6 offset:24576
    ds_read_b64_tr_b16 a[254:255], v6 offset:30720
    s_nop 1
    s_cbranch_vccnz L_rs_end3
L_ret_end3:
    s_add_u32 s84, s42, 0
    s_add_u32 s85, s42, 6144
    s_add_u32 s86, s42, 12288
    s_waitcnt lgkmcnt(6)
    v_mfma_f32_16x16x32_bf16 v[160:163], a[240:243], v[112:115], v[160:163]
    v_add_f32 v20, v20, v128
    v_add_f32 v21, v21, v132
    v_mfma_f32_16x16x32_bf16 v[208:211], a[240:243], v[116:119], v[208:211]
    v_rcp_f32 v130, v20
    v_mov_b32 v96, v15
    v_mfma_f32_16x16x32_bf16 a[0:3], a[240:243], v[120:123], a[0:3]
    s_waitcnt lgkmcnt(4)
    ds_read_b64_tr_b16 a[240:241], v3 offset:25600
    ds_read_b64_tr_b16 a[242:243], v3 offset:31744
    v_rcp_f32 v134, v21
    v_mfma_f32_16x16x32_bf16 v[164:167], a[244:247], v[112:115], v[164:167]
    v_mul_f32 v160, v160, v130
    v_mul_f32 v161, v161, v130
    v_mul_f32 v162, v162, v130
    v_mul_f32 v163, v163, v130
    v_mfma_f32_16x16x32_bf16 v[212:215], a[244:247], v[116:119], v[212:215]
    v_mul_f32 v208, v208, v134
    v_mul_f32 v209, v209, v134
    v_mul_f32 v210, v210, v134
    v_mul_f32 v211, v211, v134
    v_mfma_f32_16x16x32_bf16 a[4:7], a[244:247], v[120:123], a[4:7]
    ds_read_b64_tr_b16 a[244:245], v4 offset:25600
    ds_read_b64_tr_b16 a[246:247], v4 offset:31744
    v_cvt_pk_bf16_f32 v80, v160, v161
    v_cvt_pk_bf16_f32 v81, v162, v163
    s_waitcnt lgkmcnt(4)
    v_mfma_f32_16x16x32_bf16 v[168:171], a[248:251], v[112:115], v[168:171]
    v_cvt_pk_bf16_f32 v82, v208, v209
    v_cvt_pk_bf16_f32 v83, v210, v211
    v_mul_f32 v164, v164, v130
    v_mul_f32 v165, v165, v130
    v_mfma_f32_16x16x32_bf16 v[216:219], a[248:251], v[116:119], v[216:219]
    v_mul_f32 v166, v166, v130
    v_mul_f32 v167, v167, v130
    v_mul_f32 v212, v212, v134
    v_mul_f32 v213, v213, v134
    v_mfma_f32_16x16x32_bf16 a[8:11], a[248:251], v[120:123], a[8:11]
    ds_read_b64_tr_b16 a[248:249], v5 offset:25600
    ds_read_b64_tr_b16 a[250:251], v5 offset:31744
    v_mul_f32 v214, v214, v134
    v_mul_f32 v215, v215, v134
    v_mfma_f32_16x16x32_bf16 v[172:175], a[252:255], v[112:115], v[172:175]
    v_xor_b32 v97, 32, v15
    v_cvt_pk_bf16_f32 v84, v164, v165
    v_cvt_pk_bf16_f32 v85, v166, v167
    v_cvt_pk_bf16_f32 v86, v212, v213
    v_mfma_f32_16x16x32_bf16 v[220:223], a[252:255], v[116:119], v[220:223]
    v_cvt_pk_bf16_f32 v87, v214, v215
    v_mul_f32 v168, v168, v130
    v_mul_f32 v169, v169, v130
    v_mul_f32 v170, v170, v130
    v_mfma_f32_16x16x32_bf16 a[12:15], a[252:255], v[120:123], a[12:15]
    ds_read_b64_tr_b16 a[252:253], v6 offset:25600
    ds_read_b64_tr_b16 a[254:255], v6 offset:31744
    v_mul_f32 v171, v171, v130
    v_mul_f32 v216, v216, v134
    s_waitcnt lgkmcnt(4)
    v_mfma_f32_16x16x32_bf16 v[176:179], a[240:243], v[112:115], v[176:179]
    v_mul_f32 v217, v217, v134
    v_mul_f32 v218, v218, v134
    v_mul_f32 v219, v219, v134
    v_xor_b32 v98, 64, v15
    v_mfma_f32_16x16x32_bf16 v[224:227], a[240:243], v[116:119], v[224:227]
    v_cvt_pk_bf16_f32 v88, v168, v169
    v_cvt_pk_bf16_f32 v89, v170, v171
    v_cvt_pk_bf16_f32 v90, v216, v217
    v_cvt_pk_bf16_f32 v91, v218, v219
    v_mfma_f32_16x16x32_bf16 a[16:19], a[240:243], v[120:123], a[16:19]
    ds_read_b64_tr_b16 a[240:241], v3 offset:26624
    ds_read_b64_tr_b16 a[242:243], v3 offset:32768
    v_mul_f32 v172, v172, v130
    v_mul_f32 v173, v173, v130
    v_mfma_f32_16x16x32_bf16 v[180:183], a[244:247], v[112:115], v[180:183]
    v_mul_f32 v174, v174, v130
    v_mul_f32 v175, v175, v130
    v_mul_f32 v220, v220, v134
    v_mul_f32 v221, v221, v134
    v_mfma_f32_16x16x32_bf16 v[228:231], a[244:247], v[116:119], v[228:231]
    v_mul_f32 v222, v222, v134
    v_mul_f32 v223, v223, v134
    v_xor_b32 v99, 96, v15
    v_cvt_pk_bf16_f32 v92, v172, v173
    v_mfma_f32_16x16x32_bf16 a[20:23], a[244:247], v[120:123], a[20:23]
    ds_read_b64_tr_b16 a[244:245], v4 offset:26624
    ds_read_b64_tr_b16 a[246:247], v4 offset:32768
    v_cvt_pk_bf16_f32 v93, v174, v175
    v_cvt_pk_bf16_f32 v94, v220, v221
    s_waitcnt lgkmcnt(4)
    v_mfma_f32_16x16x32_bf16 v[184:187], a[248:251], v[112:115], v[184:187]
    v_cvt_pk_bf16_f32 v95, v222, v223
    v_add_f32 v22, v22, v136
    v_rcp_f32 v138, v22
    v_mfma_f32_16x16x32_bf16 v[232:235], a[248:251], v[116:119], v[232:235]
    v_accvgpr_read_b32 v64, a0
    v_accvgpr_read_b32 v65, a1
    v_accvgpr_read_b32 v66, a2
    v_accvgpr_read_b32 v67, a3
    v_mfma_f32_16x16x32_bf16 a[24:27], a[248:251], v[120:123], a[24:27]
    ds_read_b64_tr_b16 a[248:249], v5 offset:26624
    ds_read_b64_tr_b16 a[250:251], v5 offset:32768
    v_mul_f32 v64, v64, v138
    v_mul_f32 v65, v65, v138
    v_mfma_f32_16x16x32_bf16 v[188:191], a[252:255], v[112:115], v[188:191]
    v_mul_f32 v66, v66, v138
    v_mul_f32 v67, v67, v138
    v_mul_f32 v176, v176, v130
    v_mul_f32 v177, v177, v130
    v_mfma_f32_16x16x32_bf16 v[236:239], a[252:255], v[116:119], v[236:239]
    v_mul_f32 v178, v178, v130
    v_mul_f32 v179, v179, v130
    v_accvgpr_read_b32 v68, a4
    v_accvgpr_read_b32 v69, a5
    v_mfma_f32_16x16x32_bf16 a[28:31], a[252:255], v[120:123], a[28:31]
    ds_read_b64_tr_b16 a[252:253], v6 offset:26624
    ds_read_b64_tr_b16 a[254:255], v6 offset:32768
    v_accvgpr_read_b32 v70, a6
    v_accvgpr_read_b32 v71, a7
    s_waitcnt lgkmcnt(4)
    v_mfma_f32_16x16x32_bf16 v[192:195], a[240:243], v[112:115], v[192:195]
    v_mul_f32 v68, v68, v138
    v_mul_f32 v69, v69, v138
    v_mul_f32 v70, v70, v138
    v_mul_f32 v71, v71, v138
    v_mfma_f32_16x16x32_bf16 v[240:243], a[240:243], v[116:119], v[240:243]
    v_mul_f32 v180, v180, v130
    v_mul_f32 v181, v181, v130
    v_mul_f32 v182, v182, v130
    v_mul_f32 v183, v183, v130
    v_mfma_f32_16x16x32_bf16 a[32:35], a[240:243], v[120:123], a[32:35]
    v_accvgpr_read_b32 v72, a8
    v_accvgpr_read_b32 v73, a9
    v_accvgpr_read_b32 v74, a10
    v_accvgpr_read_b32 v75, a11
    v_mfma_f32_16x16x32_bf16 v[196:199], a[244:247], v[112:115], v[196:199]
    v_mul_f32 v72, v72, v138
    v_mul_f32 v73, v73, v138
    v_mul_f32 v74, v74, v138
    v_mul_f32 v75, v75, v138
    v_mfma_f32_16x16x32_bf16 v[244:247], a[244:247], v[116:119], v[244:247]
    v_mul_f32 v184, v184, v130
    v_mul_f32 v185, v185, v130
    v_mul_f32 v186, v186, v130
    v_mul_f32 v187, v187, v130
    v_mfma_f32_16x16x32_bf16 a[36:39], a[244:247], v[120:123], a[36:39]
    v_accvgpr_read_b32 v76, a12
    v_accvgpr_read_b32 v77, a13
    v_accvgpr_read_b32 v78, a14
    v_accvgpr_read_b32 v79, a15
    s_waitcnt lgkmcnt(0)
    v_mfma_f32_16x16x32_bf16 v[200:203], a[248:251], v[112:115], v[200:203]
    v_mul_f32 v76, v76, v138
    v_mul_f32 v77, v77, v138
    v_mul_f32 v78, v78, v138
    v_mul_f32 v79, v79, v138
    v_mfma_f32_16x16x32_bf16 v[248:251], a[248:251], v[116:119], v[248:251]
    v_mul_f32 v188, v188, v130
    v_mul_f32 v189, v189, v130
    v_mul_f32 v190, v190, v130
    v_mul_f32 v191, v191, v130
    v_mfma_f32_16x16x32_bf16 a[40:43], a[248:251], v[120:123], a[40:43]
    ds_write2st64_b64 v96, v[80:81], v[82:83] offset0:0 offset1:4
    v_mfma_f32_16x16x32_bf16 v[204:207], a[252:255], v[112:115], v[204:207]
    v_cvt_pk_bf16_f32 v80, v64, v65
    v_cvt_pk_bf16_f32 v81, v66, v67
    v_cvt_pk_bf16_f32 v82, v176, v177
    v_mfma_f32_16x16x32_bf16 v[252:255], a[252:255], v[116:119], v[252:255]
    v_cvt_pk_bf16_f32 v83, v178, v179
    v_accvgpr_read_b32 v64, a16
    v_accvgpr_read_b32 v65, a17
    v_accvgpr_read_b32 v66, a18
    v_mfma_f32_16x16x32_bf16 a[44:47], a[252:255], v[120:123], a[44:47]
    ds_write2st64_b64 v97, v[84:85], v[86:87] offset0:0 offset1:4
    ds_write2st64_b64 v98, v[88:89], v[90:91] offset0:0 offset1:4
    ds_write2st64_b64 v99, v[92:93], v[94:95] offset0:0 offset1:4
    ds_read_b128 v[144:147], v14 offset:0
    ds_read_b128 v[148:151], v14 offset:1024
    ds_read_b128 v[152:155], v14 offset:2048
    ds_read_b128 v[156:159], v14 offset:3072
    ds_write2st64_b64 v96, v[80:81], v[82:83] offset0:0 offset1:4
    v_cvt_pk_bf16_f32 v84, v68, v69
    v_cvt_pk_bf16_f32 v85, v70, v71
    v_cvt_pk_bf16_f32 v86, v180, v181
    v_cvt_pk_bf16_f32 v87, v182, v183
    v_cvt_pk_bf16_f32 v88, v72, v73
    v_cvt_pk_bf16_f32 v89, v74, v75
    v_cvt_pk_bf16_f32 v90, v184, v185
    v_cvt_pk_bf16_f32 v91, v186, v187
    v_cvt_pk_bf16_f32 v92, v76, v77
    v_cvt_pk_bf16_f32 v93, v78, v79
    v_cvt_pk_bf16_f32 v94, v188, v189
    v_cvt_pk_bf16_f32 v95, v190, v191
    v_accvgpr_read_b32 v67, a19
    v_pk_mul_f32 v[224:225], v[224:225], v[134:135] op_sel_hi:[1,0]
    v_pk_mul_f32 v[226:227], v[226:227], v[134:135] op_sel_hi:[1,0]
    v_pk_mul_f32 v[64:65], v[64:65], v[138:139] op_sel_hi:[1,0]
    v_pk_mul_f32 v[66:67], v[66:67], v[138:139] op_sel_hi:[1,0]
    v_accvgpr_read_b32 v68, a20
    v_accvgpr_read_b32 v69, a21
    v_accvgpr_read_b32 v70, a22
    v_accvgpr_read_b32 v71, a23
    v_cvt_pk_bf16_f32 v80, v224, v225
    v_cvt_pk_bf16_f32 v81, v226, v227
    v_cvt_pk_bf16_f32 v82, v64, v65
    v_cvt_pk_bf16_f32 v83, v66, v67
    v_pk_mul_f32 v[228:229], v[228:229], v[134:135] op_sel_hi:[1,0]
    v_pk_mul_f32 v[230:231], v[230:231], v[134:135] op_sel_hi:[1,0]
    v_pk_mul_f32 v[68:69], v[68:69], v[138:139] op_sel_hi:[1,0]
    v_pk_mul_f32 v[70:71], v[70:71], v[138:139] op_sel_hi:[1,0]
    v_accvgpr_read_b32 v72, a24
    v_accvgpr_read_b32 v73, a25
    v_accvgpr_read_b32 v74, a26
    v_accvgpr_read_b32 v75, a27
    v_pk_mul_f32 v[232:233], v[232:233], v[134:135] op_sel_hi:[1,0]
    v_pk_mul_f32 v[234:235], v[234:235], v[134:135] op_sel_hi:[1,0]
    v_pk_mul_f32 v[72:73], v[72:73], v[138:139] op_sel_hi:[1,0]
    v_pk_mul_f32 v[74:75], v[74:75], v[138:139] op_sel_hi:[1,0]
    v_accvgpr_read_b32 v76, a28
    v_accvgpr_read_b32 v77, a29
    v_accvgpr_read_b32 v78, a30
    v_accvgpr_read_b32 v79, a31
    v_pk_mul_f32 v[236:237], v[236:237], v[134:135] op_sel_hi:[1,0]
    v_pk_mul_f32 v[238:239], v[238:239], v[134:135] op_sel_hi:[1,0]
    v_pk_mul_f32 v[76:77], v[76:77], v[138:139] op_sel_hi:[1,0]
    v_pk_mul_f32 v[78:79], v[78:79], v[138:139] op_sel_hi:[1,0]
    v_pk_mul_f32 v[192:193], v[192:193], v[130:131] op_sel_hi:[1,0]
    v_pk_mul_f32 v[194:195], v[194:195], v[130:131] op_sel_hi:[1,0]
    v_pk_mul_f32 v[240:241], v[240:241], v[134:135] op_sel_hi:[1,0]
    v_pk_mul_f32 v[242:243], v[242:243], v[134:135] op_sel_hi:[1,0]
    v_pk_mul_f32 v[196:197], v[196:197], v[130:131] op_sel_hi:[1,0]
    v_pk_mul_f32 v[198:199], v[198:199], v[130:131] op_sel_hi:[1,0]
    v_pk_mul_f32 v[244:245], v[244:245], v[134:135] op_sel_hi:[1,0]
    v_pk_mul_f32 v[246:247], v[246:247], v[134:135] op_sel_hi:[1,0]
    v_pk_mul_f32 v[200:201], v[200:201], v[130:131] op_sel_hi:[1,0]
    v_pk_mul_f32 v[202:203], v[202:203], v[130:131] op_sel_hi:[1,0]
    v_pk_mul_f32 v[248:249], v[248:249], v[134:135] op_sel_hi:[1,0]
    v_pk_mul_f32 v[250:251], v[250:251], v[134:135] op_sel_hi:[1,0]
    v_pk_mul_f32 v[204:205], v[204:205], v[130:131] op_sel_hi:[1,0]
    v_pk_mul_f32 v[206:207], v[206:207], v[130:131] op_sel_hi:[1,0]
    v_pk_mul_f32 v[252:253], v[252:253], v[134:135] op_sel_hi:[1,0]
    v_pk_mul_f32 v[254:255], v[254:255], v[134:135] op_sel_hi:[1,0]
    v_accvgpr_read_b32 v64, a32
    v_accvgpr_read_b32 v65, a33
    v_accvgpr_read_b32 v66, a34
    v_accvgpr_read_b32 v67, a35
    v_pk_mul_f32 v[64:65], v[64:65], v[138:139] op_sel_hi:[1,0]
    v_pk_mul_f32 v[66:67], v[66:67], v[138:139] op_sel_hi:[1,0]
    ds_write2st64_b64 v97, v[84:85], v[86:87] offset0:0 offset1:4
    s_waitcnt lgkmcnt(1)
    buffer_store_dwordx4 v[144:147], v13, s[16:19], s84 offen offset:0 nt
    ds_write2st64_b64 v98, v[88:89], v[90:91] offset0:0 offset1:4
    ds_write2st64_b64 v99, v[92:93], v[94:95] offset0:0 offset1:4
    ds_read_b128 v[144:147], v14 offset:0
    buffer_store_dwordx4 v[148:151], v13, s[16:19], s84 offen offset:3072 nt
    v_cvt_pk_bf16_f32 v84, v228, v229
    v_cvt_pk_bf16_f32 v85, v230, v231
    v_cvt_pk_bf16_f32 v86, v68, v69
    v_cvt_pk_bf16_f32 v87, v70, v71
    v_cvt_pk_bf16_f32 v88, v232, v233
    v_cvt_pk_bf16_f32 v89, v234, v235
    v_cvt_pk_bf16_f32 v90, v72, v73
    v_cvt_pk_bf16_f32 v91, v74, v75
    v_cvt_pk_bf16_f32 v92, v236, v237
    v_cvt_pk_bf16_f32 v93, v238, v239
    v_cvt_pk_bf16_f32 v94, v76, v77
    v_cvt_pk_bf16_f32 v95, v78, v79
    v_accvgpr_read_b32 v68, a36
    v_accvgpr_read_b32 v69, a37
    v_accvgpr_read_b32 v70, a38
    v_accvgpr_read_b32 v71, a39
    v_pk_mul_f32 v[68:69], v[68:69], v[138:139] op_sel_hi:[1,0]
    v_pk_mul_f32 v[70:71], v[70:71], v[138:139] op_sel_hi:[1,0]
    v_accvgpr_read_b32 v72, a40
    v_accvgpr_read_b32 v73, a41
    v_accvgpr_read_b32 v74, a42
    v_accvgpr_read_b32 v75, a43
    v_pk_mul_f32 v[72:73], v[72:73], v[138:139] op_sel_hi:[1,0]
    v_pk_mul_f32 v[74:75], v[74:75], v[138:139] op_sel_hi:[1,0]
    v_accvgpr_read_b32 v76, a44
    v_accvgpr_read_b32 v77, a45
    v_accvgpr_read_b32 v78, a46
    v_accvgpr_read_b32 v79, a47
    v_pk_mul_f32 v[76:77], v[76:77], v[138:139] op_sel_hi:[1,0]
    v_pk_mul_f32 v[78:79], v[78:79], v[138:139] op_sel_hi:[1,0]
    ds_read_b128 v[148:151], v14 offset:1024
    buffer_store_dwordx4 v[152:155], v13, s[16:19], s85 offen offset:0 nt
    buffer_store_dwordx4 v[156:159], v13, s[16:19], s85 offen offset:3072 nt
    ds_read_b128 v[152:155], v14 offset:2048
    ds_read_b128 v[156:159], v14 offset:3072
    ds_write2st64_b64 v96, v[80:81], v[82:83] offset0:0 offset1:4
    ds_write2st64_b64 v97, v[84:85], v[86:87] offset0:0 offset1:4
    ds_write2st64_b64 v98, v[88:89], v[90:91] offset0:0 offset1:4
    s_waitcnt lgkmcnt(6)
    buffer_store_dwordx4 v[144:147], v13, s[16:19], s86 offen offset:0 nt
    ds_write2st64_b64 v99, v[92:93], v[94:95] offset0:0 offset1:4
    ds_read_b128 v[144:147], v14 offset:0
    v_cvt_pk_bf16_f32 v80, v192, v193
    v_cvt_pk_bf16_f32 v81, v194, v195
    v_cvt_pk_bf16_f32 v82, v240, v241
    v_cvt_pk_bf16_f32 v83, v242, v243
    v_cvt_pk_bf16_f32 v84, v196, v197
    v_cvt_pk_bf16_f32 v85, v198, v199
    v_cvt_pk_bf16_f32 v86, v244, v245
    v_cvt_pk_bf16_f32 v87, v246, v247
    v_cvt_pk_bf16_f32 v88, v200, v201
    v_cvt_pk_bf16_f32 v89, v202, v203
    v_cvt_pk_bf16_f32 v90, v248, v249
    v_cvt_pk_bf16_f32 v91, v250, v251
    v_cvt_pk_bf16_f32 v92, v204, v205
    v_cvt_pk_bf16_f32 v93, v206, v207
    v_cvt_pk_bf16_f32 v94, v252, v253
    v_cvt_pk_bf16_f32 v95, v254, v255
    s_waitcnt lgkmcnt(4)
    buffer_store_dwordx4 v[148:151], v13, s[16:19], s86 offen offset:3072 nt
    buffer_store_dwordx4 v[152:155], v13, s[16:19], s84 offen offset:128 nt
    ds_read_b128 v[148:151], v14 offset:1024
    ds_read_b128 v[152:155], v14 offset:2048
    buffer_store_dwordx4 v[156:159], v13, s[16:19], s84 offen offset:3200 nt
    s_waitcnt lgkmcnt(2)
    buffer_store_dwordx4 v[144:147], v13, s[16:19], s85 offen offset:128 nt
    ds_read_b128 v[156:159], v14 offset:3072
    ds_write2st64_b64 v96, v[80:81], v[82:83] offset0:0 offset1:4
    ds_write2st64_b64 v97, v[84:85], v[86:87] offset0:0 offset1:4
    ds_write2st64_b64 v98, v[88:89], v[90:91] offset0:0 offset1:4
    s_waitcnt lgkmcnt(4)
    buffer_store_dwordx4 v[148:151], v13, s[16:19], s85 offen offset:3200 nt
    ds_write2st64_b64 v99, v[92:93], v[94:95] offset0:0 offset1:4
    ds_read_b128 v[144:147], v14 offset:0
    ds_read_b128 v[148:151], v14 offset:1024
    v_cvt_pk_bf16_f32 v80, v64, v65
    v_cvt_pk_bf16_f32 v81, v66, v67
    v_cvt_pk_bf16_f32 v84, v68, v69
    v_cvt_pk_bf16_f32 v85, v70, v71
    v_cvt_pk_bf16_f32 v88, v72, v73
    v_cvt_pk_bf16_f32 v89, v74, v75
    v_cvt_pk_bf16_f32 v92, v76, v77
    v_cvt_pk_bf16_f32 v93, v78, v79
    buffer_store_dwordx4 v[152:155], v13, s[16:19], s86 offen offset:128 nt
    s_waitcnt lgkmcnt(3)
    buffer_store_dwordx4 v[156:159], v13, s[16:19], s86 offen offset:3200 nt
    ds_read_b128 v[152:155], v14 offset:2048
    ds_read_b128 v[156:159], v14 offset:3072
    ds_write_b64 v96, v[80:81] offset:0
    ds_write_b64 v97, v[84:85] offset:0
    ds_write_b64 v98, v[88:89] offset:0
    ds_write_b64 v99, v[92:93] offset:0
    s_waitcnt lgkmcnt(6)
    buffer_store_dwordx4 v[144:147], v13, s[16:19], s84 offen offset:256 nt
    buffer_store_dwordx4 v[148:151], v13, s[16:19], s84 offen offset:3328 nt
    ds_read_b128 v[144:147], v14 offset:0
    ds_read_b128 v[148:151], v14 offset:1024
    s_waitcnt lgkmcnt(3)
    buffer_store_dwordx4 v[152:155], v13, s[16:19], s85 offen offset:256 nt
    buffer_store_dwordx4 v[156:159], v13, s[16:19], s85 offen offset:3328 nt
    s_waitcnt lgkmcnt(0)
    buffer_store_dwordx4 v[144:147], v13, s[16:19], s86 offen offset:256 nt
    buffer_store_dwordx4 v[148:151], v13, s[16:19], s86 offen offset:3328 nt
    s_branch L_fin
L_fin:
    s_waitcnt vmcnt(0)
L_end:
    s_endpgm
L_mode4w0:
    s_cmp_eq_u32 s38, 5
    s_cbranch_scc1 L_mode4w0_kv
    s_mov_b32 s46, s28
    s_mov_b32 s47, s29
    s_mov_b32 s20, s12
    s_mov_b32 s24, s12
    s_mov_b32 s21, s13
    s_mov_b32 s25, s13
    s_mov_b32 s22, s14
    s_mov_b32 s26, s14
    s_mov_b32 s23, s15
    s_mov_b32 s27, s15
    s_and_b32 s63, s3, 1
    s_mul_i32 s63, s63, 3072
    s_add_u32 s28, s41, s63
    s_add_u32 s31, s35, s63
    s_sub_u32 s63, 3072, s63
    s_add_u32 s29, s41, s63
    s_add_u32 s32, s35, s63
    s_mov_b32 s30, 6144
    v_xor_b32 v10, 80, v7
    v_xor_b32 v11, 80, v8
    v_xor_b32 v12, 80, v9
    s_branch L_modeback4w0
L_mode4w0_kv:
    s_mov_b32 s20, s4
    s_mov_b32 s24, s8
    s_mov_b32 s21, s5
    s_mov_b32 s25, s9
    s_mov_b32 s22, s6
    s_mov_b32 s26, s10
    s_mov_b32 s23, s7
    s_mov_b32 s27, s11
    s_mov_b32 s28, s46
    s_mov_b32 s29, s47
    s_mul_i32 s31, s3, 3072
    s_add_u32 s32, s31, 12288
    s_mov_b32 s30, 12288
    v_mov_b32 v10, v7
    v_mov_b32 v11, v8
    v_mov_b32 v12, v9
    s_branch L_modeback4w0
L_mode4w1:
    s_cmp_eq_u32 s38, 5
    s_cbranch_scc1 L_mode4w1_kv
    s_mov_b32 s46, s28
    s_mov_b32 s47, s29
    s_mov_b32 s20, s12
    s_mov_b32 s24, s12
    s_mov_b32 s21, s13
    s_mov_b32 s25, s13
    s_mov_b32 s22, s14
    s_mov_b32 s26, s14
    s_mov_b32 s23, s15
    s_mov_b32 s27, s15
    s_and_b32 s63, s3, 1
    s_mul_i32 s63, s63, 3072
    s_add_u32 s28, s41, s63
    s_add_u32 s31, s35, s63
    s_sub_u32 s63, 3072, s63
    s_add_u32 s29, s41, s63
    s_add_u32 s32, s35, s63
    s_mov_b32 s30, 6144
    v_xor_b32 v10, 80, v7
    v_xor_b32 v11, 80, v8
    v_xor_b32 v12, 80, v9
    s_branch L_modeback4w1
L_mode4w1_kv:
    s_mov_b32 s20, s4
    s_mov_b32 s24, s8
    s_mov_b32 s21, s5
    s_mov_b32 s25, s9
    s_mov_b32 s22, s6
    s_mov_b32 s26, s10
    s_mov_b32 s23, s7
    s_mov_b32 s27, s11
    s_mov_b32 s28, s46
    s_mov_b32 s29, s47
    s_mul_i32 s31, s3, 3072
    s_add_u32 s32, s31, 12288
    s_mov_b32 s30, 12288
    v_mov_b32 v10, v7
    v_mov_b32 v11, v8
    v_mov_b32 v12, v9
    s_branch L_modeback4w1
L_rare4_0:
    s_nop 15
    v_max3_f32 v144, v32, v33, v34
    v_max3_f32 v144, v144, v35, v36
    v_max3_f32 v144, v144, v37, v38
    v_max_f32 v144, v144, v39
    v_mov_b32 v145, v144
    s_nop 1
    v_permlane32_swap_b32 v145, v144
    v_max_f32 v144, v144, v145
    v_mov_b32 v145, v144
    s_nop 1
    v_permlane16_swap_b32 v145, v144
    v_max_f32 v144, v144, v145
    v_max_f32 v146, 0, v144
    v_sub_f32 v16, v16, v146
    v_sub_f32 v147, 0, v146
    v_exp_f32 v147, v147
    s_nop 0
    v_mul_f32 v20, v20, v147
    v_mul_f32 v160, v160, v147
    v_mul_f32 v161, v161, v147
    v_mul_f32 v162, v162, v147
    v_mul_f32 v163, v163, v147
    v_mul_f32 v164, v164, v147
    v_mul_f32 v165, v165, v147
    v_mul_f32 v166, v166, v147
    v_mul_f32 v167, v167, v147
    v_mul_f32 v168, v168, v147
    v_mul_f32 v169, v169, v147
    v_mul_f32 v170, v170, v147
    v_mul_f32 v171, v171, v147
    v_mul_f32 v172, v172, v147
    v_mul_f32 v173, v173, v147
    v_mul_f32 v174, v174, v147
    v_mul_f32 v175, v175, v147
    v_mul_f32 v176, v176, v147
    v_mul_f32 v177, v177, v147
    v_mul_f32 v178, v178, v147
    v_mul_f32 v179, v179, v147
    v_mul_f32 v180, v180, v147
    v_mul_f32 v181, v181, v147
    v_mul_f32 v182, v182, v147
    v_mul_f32 v183, v183, v147
    v_mul_f32 v184, v184, v147
    v_mul_f32 v185, v185, v147
    v_mul_f32 v186, v186, v147
    v_mul_f32 v187, v187, v147
    v_mul_f32 v188, v188, v147
    v_mul_f32 v189, v189, v147
    v_mul_f32 v190, v190, v147
    v_mul_f32 v191, v191, v147
    v_mul_f32 v192, v192, v147
    v_mul_f32 v193, v193, v147
    v_mul_f32 v194, v194, v147
    v_mul_f32 v195, v195, v147
    v_mul_f32 v196, v196, v147
    v_mul_f32 v197, v197, v147
    v_mul_f32 v198, v198, v147
    v_mul_f32 v199, v199, v147
    v_mul_f32 v200, v200, v147
    v_mul_f32 v201, v201, v147
    v_mul_f32 v202, v202, v147
    v_mul_f32 v203, v203, v147
    v_mul_f32 v204, v204, v147
    v_mul_f32 v205, v205, v147
    v_mul_f32 v206, v206, v147
    v_mul_f32 v207, v207, v147
    v_sub_f32 v32, v32, v146
    v_sub_f32 v33, v33, v146
    v_exp_f32 v152, v32
    v_exp_f32 v153, v33
    s_nop 0
    v_cvt_pk_bf16_f32 v96, v152, v153
    v_sub_f32 v34, v34, v146
    v_sub_f32 v35, v35, v146
    v_exp_f32 v152, v34
    v_exp_f32 v153, v35
    s_nop 0
    v_cvt_pk_bf16_f32 v97, v152, v153
    v_sub_f32 v36, v36, v146
    v_sub_f32 v37, v37, v146
    v_exp_f32 v152, v36
    v_exp_f32 v153, v37
    s_nop 0
    v_cvt_pk_bf16_f32 v98, v152, v153
    v_sub_f32 v38, v38, v146
    v_sub_f32 v39, v39, v146
    v_exp_f32 v152, v38
    v_exp_f32 v153, v39
    s_nop 0
    v_cvt_pk_bf16_f32 v99, v152, v153
    s_nop 1
    v_mfma_f32_16x16x32_bf16 v[128:131], v[24:27], v[96:99], 0
    v_max3_f32 v144, v40, v41, v42
    v_max3_f32 v144, v144, v43, v44
    v_max3_f32 v144, v144, v45, v46
    v_max_f32 v144, v144, v47
    v_mov_b32 v145, v144
    s_nop 1
    v_permlane32_swap_b32 v145, v144
    v_max_f32 v144, v144, v145
    v_mov_b32 v145, v144
    s_nop 1
    v_permlane16_swap_b32 v145, v144
    v_max_f32 v144, v144, v145
    v_max_f32 v146, 0, v144
    v_sub_f32 v17, v17, v146
    v_sub_f32 v147, 0, v146
    v_exp_f32 v147, v147
    s_nop 0
    v_mul_f32 v21, v21, v147
    v_mul_f32 v208, v208, v147
    v_mul_f32 v209, v209, v147
    v_mul_f32 v210, v210, v147
    v_mul_f32 v211, v211, v147
    v_mul_f32 v212, v212, v147
    v_mul_f32 v213, v213, v147
    v_mul_f32 v214, v214, v147
    v_mul_f32 v215, v215, v147
    v_mul_f32 v216, v216, v147
    v_mul_f32 v217, v217, v147
    v_mul_f32 v218, v218, v147
    v_mul_f32 v219, v219, v147
    v_mul_f32 v220, v220, v147
    v_mul_f32 v221, v221, v147
    v_mul_f32 v222, v222, v147
    v_mul_f32 v223, v223, v147
    v_mul_f32 v224, v224, v147
    v_mul_f32 v225, v225, v147
    v_mul_f32 v226, v226, v147
    v_mul_f32 v227, v227, v147
    v_mul_f32 v228, v228, v147
    v_mul_f32 v229, v229, v147
    v_mul_f32 v230, v230, v147
    v_mul_f32 v231, v231, v147
    v_mul_f32 v232, v232, v147
    v_mul_f32 v233, v233, v147
    v_mul_f32 v234, v234, v147
    v_mul_f32 v235, v235, v147
    v_mul_f32 v236, v236, v147
    v_mul_f32 v237, v237, v147
    v_mul_f32 v238, v238, v147
    v_mul_f32 v239, v239, v147
    v_mul_f32 v240, v240, v147
    v_mul_f32 v241, v241, v147
    v_mul_f32 v242, v242, v147
    v_mul_f32 v243, v243, v147
    v_mul_f32 v244, v244, v147
    v_mul_f32 v245, v245, v147
    v_mul_f32 v246, v246, v147
    v_mul_f32 v247, v247, v147
    v_mul_f32 v248, v248, v147
    v_mul_f32 v249, v249, v147
    v_mul_f32 v250, v250, v147
    v_mul_f32 v251, v251, v147
    v_mul_f32 v252, v252, v147
    v_mul_f32 v253, v253, v147
    v_mul_f32 v254, v254, v147
    v_mul_f32 v255, v255, v147
    v_sub_f32 v40, v40, v146
    v_sub_f32 v41, v41, v146
    v_exp_f32 v152, v40
    v_exp_f32 v153, v41
    s_nop 0
    v_cvt_pk_bf16_f32 v100, v152, v153
    v_sub_f32 v42, v42, v146
    v_sub_f32 v43, v43, v146
    v_exp_f32 v152, v42
    v_exp_f32 v153, v43
    s_nop 0
    v_cvt_pk_bf16_f32 v101, v152, v153
    v_sub_f32 v44, v44, v146
    v_sub_f32 v45, v45, v146
    v_exp_f32 v152, v44
    v_exp_f32 v153, v45
    s_nop 0
    v_cvt_pk_bf16_f32 v102, v152, v153
    v_sub_f32 v46, v46, v146
    v_sub_f32 v47, v47, v146
    v_exp_f32 v152, v46
    v_exp_f32 v153, v47
    s_nop 0
    v_cvt_pk_bf16_f32 v103, v152, v153
    s_nop 1
    v_mfma_f32_16x16x32_bf16 v[132:135], v[24:27], v[100:103], 0
    v_max3_f32 v144, v48, v49, v50
    v_max3_f32 v144, v144, v51, v52
    v_max3_f32 v144, v144, v53, v54
    v_max_f32 v144, v144, v55
    v_mov_b32 v145, v144
    s_nop 1
    v_permlane32_swap_b32 v145, v144
    v_max_f32 v144, v144, v145
    v_mov_b32 v145, v144
    s_nop 1
    v_permlane16_swap_b32 v145, v144
    v_max_f32 v144, v144, v145
    v_max_f32 v146, 0, v144
    v_sub_f32 v18, v18, v146
    v_sub_f32 v147, 0, v146
    v_exp_f32 v147, v147
    s_nop 0
    v_mul_f32 v22, v22, v147
    v_accvgpr_read_b32 v148, a0
    v_accvgpr_read_b32 v149, a1
    v_accvgpr_read_b32 v150, a2
    v_accvgpr_read_b32 v151, a3
    v_mul_f32 v148, v148, v147
    v_mul_f32 v149, v149, v147
    v_mul_f32 v150, v150, v147
    v_mul_f32 v151, v151, v147
    v_accvgpr_write_b32 a0, v148
    v_accvgpr_write_b32 a1, v149
    v_accvgpr_write_b32 a2, v150
    v_accvgpr_write_b32 a3, v151
    v_accvgpr_read_b32 v148, a4
    v_accvgpr_read_b32 v149, a5
    v_accvgpr_read_b32 v150, a6
    v_accvgpr_read_b32 v151, a7
    v_mul_f32 v148, v148, v147
    v_mul_f32 v149, v149, v147
    v_mul_f32 v150, v150, v147
    v_mul_f32 v151, v151, v147
    v_accvgpr_write_b32 a4, v148
    v_accvgpr_write_b32 a5, v149
    v_accvgpr_write_b32 a6, v150
    v_accvgpr_write_b32 a7, v151
    v_accvgpr_read_b32 v148, a8
    v_accvgpr_read_b32 v149, a9
    v_accvgpr_read_b32 v150, a10
    v_accvgpr_read_b32 v151, a11
    v_mul_f32 v148, v148, v147
    v_mul_f32 v149, v149, v147
    v_mul_f32 v150, v150, v147
    v_mul_f32 v151, v151, v147
    v_accvgpr_write_b32 a8, v148
    v_accvgpr_write_b32 a9, v149
    v_accvgpr_write_b32 a10, v150
    v_accvgpr_write_b32 a11, v151
    v_accvgpr_read_b32 v148, a12
    v_accvgpr_read_b32 v149, a13
    v_accvgpr_read_b32 v150, a14
    v_accvgpr_read_b32 v151, a15
    v_mul_f32 v148, v148, v147
    v_mul_f32 v149, v149, v147
    v_mul_f32 v150, v150, v147
    v_mul_f32 v151, v151, v147
    v_accvgpr_write_b32 a12, v148
    v_accvgpr_write_b32 a13, v149
    v_accvgpr_write_b32 a14, v150
    v_accvgpr_write_b32 a15, v151
    v_accvgpr_read_b32 v148, a16
    v_accvgpr_read_b32 v149, a17
    v_accvgpr_read_b32 v150, a18
    v_accvgpr_read_b32 v151, a19
    v_mul_f32 v148, v148, v147
    v_mul_f32 v149, v149, v147
    v_mul_f32 v150, v150, v147
    v_mul_f32 v151, v151, v147
    v_accvgpr_write_b32 a16, v148
    v_accvgpr_write_b32 a17, v149
    v_accvgpr_write_b32 a18, v150
    v_accvgpr_write_b32 a19, v151
    v_accvgpr_read_b32 v148, a20
    v_accvgpr_read_b32 v149, a21
    v_accvgpr_read_b32 v150, a22
    v_accvgpr_read_b32 v151, a23
    v_mul_f32 v148, v148, v147
    v_mul_f32 v149, v149, v147
    v_mul_f32 v150, v150, v147
    v_mul_f32 v151, v151, v147
    v_accvgpr_write_b32 a20, v148
    v_accvgpr_write_b32 a21, v149
    v_accvgpr_write_b32 a22, v150
    v_accvgpr_write_b32 a23, v151
    v_accvgpr_read_b32 v148, a24
    v_accvgpr_read_b32 v149, a25
    v_accvgpr_read_b32 v150, a26
    v_accvgpr_read_b32 v151, a27
    v_mul_f32 v148, v148, v147
    v_mul_f32 v149, v149, v147
    v_mul_f32 v150, v150, v147
    v_mul_f32 v151, v151, v147
    v_accvgpr_write_b32 a24, v148
    v_accvgpr_write_b32 a25, v149
    v_accvgpr_write_b32 a26, v150
    v_accvgpr_write_b32 a27, v151
    v_accvgpr_read_b32 v148, a28
    v_accvgpr_read_b32 v149, a29
    v_accvgpr_read_b32 v150, a30
    v_accvgpr_read_b32 v151, a31
    v_mul_f32 v148, v148, v147
    v_mul_f32 v149, v149, v147
    v_mul_f32 v150, v150, v147
    v_mul_f32 v151, v151, v147
    v_accvgpr_write_b32 a28, v148
    v_accvgpr_write_b32 a29, v149
    v_accvgpr_write_b32 a30, v150
    v_accvgpr_write_b32 a31, v151
    v_accvgpr_read_b32 v148, a32
    v_accvgpr_read_b32 v149, a33
    v_accvgpr_read_b32 v150, a34
    v_accvgpr_read_b32 v151, a35
    v_mul_f32 v148, v148, v147
    v_mul_f32 v149, v149, v147
    v_mul_f32 v150, v150, v147
    v_mul_f32 v151, v151, v147
    v_accvgpr_write_b32 a32, v148
    v_accvgpr_write_b32 a33, v149
    v_accvgpr_write_b32 a34, v150
    v_accvgpr_write_b32 a35, v151
    v_accvgpr_read_b32 v148, a36
    v_accvgpr_read_b32 v149, a37
    v_accvgpr_read_b32 v150, a38
    v_accvgpr_read_b32 v151, a39
    v_mul_f32 v148, v148, v147
    v_mul_f32 v149, v149, v147
    v_mul_f32 v150, v150, v147
    v_mul_f32 v151, v151, v147
    v_accvgpr_write_b32 a36, v148
    v_accvgpr_write_b32 a37, v149
    v_accvgpr_write_b32 a38, v150
    v_accvgpr_write_b32 a39, v151
    v_accvgpr_read_b32 v148, a40
    v_accvgpr_read_b32 v149, a41
    v_accvgpr_read_b32 v150, a42
    v_accvgpr_read_b32 v151, a43
    v_mul_f32 v148, v148, v147
    v_mul_f32 v149, v149, v147
    v_mul_f32 v150, v150, v147
    v_mul_f32 v151, v151, v147
    v_accvgpr_write_b32 a40, v148
    v_accvgpr_write_b32 a41, v149
    v_accvgpr_write_b32 a42, v150
    v_accvgpr_write_b32 a43, v151
    v_accvgpr_read_b32 v148, a44
    v_accvgpr_read_b32 v149, a45
    v_accvgpr_read_b32 v150, a46
    v_accvgpr_read_b32 v151, a47
    v_mul_f32 v148, v148, v147
    v_mul_f32 v149, v149, v147
    v_mul_f32 v150, v150, v147
    v_mul_f32 v151, v151, v147
    v_accvgpr_write_b32 a44, v148
    v_accvgpr_write_b32 a45, v149
    v_accvgpr_write_b32 a46, v150
    v_accvgpr_write_b32 a47, v151
    v_sub_f32 v48, v48, v146
    v_sub_f32 v49, v49, v146
    v_exp_f32 v152, v48
    v_exp_f32 v153, v49
    s_nop 0
    v_cvt_pk_bf16_f32 v104, v152, v153
    v_sub_f32 v50, v50, v146
    v_sub_f32 v51, v51, v146
    v_exp_f32 v152, v50
    v_exp_f32 v153, v51
    s_nop 0
    v_cvt_pk_bf16_f32 v105, v152, v153
    v_sub_f32 v52, v52, v146
    v_sub_f32 v53, v53, v146
    v_exp_f32 v152, v52
    v_exp_f32 v153, v53
    s_nop 0
    v_cvt_pk_bf16_f32 v106, v152, v153
    v_sub_f32 v54, v54, v146
    v_sub_f32 v55, v55, v146
    v_exp_f32 v152, v54
    v_exp_f32 v153, v55
    s_nop 0
    v_cvt_pk_bf16_f32 v107, v152, v153
    s_nop 1
    v_mfma_f32_16x16x32_bf16 v[136:139], v[24:27], v[104:107], 0
    v_max3_f32 v144, v56, v57, v58
    v_max3_f32 v144, v144, v59, v60
    v_max3_f32 v144, v144, v61, v62
    v_max_f32 v144, v144, v63
    v_mov_b32 v145, v144
    s_nop 1
    v_permlane32_swap_b32 v145, v144
    v_max_f32 v144, v144, v145
    v_mov_b32 v145, v144
    s_nop 1
    v_permlane16_swap_b32 v145, v144
    v_max_f32 v144, v144, v145
    v_max_f32 v146, 0, v144
    v_sub_f32 v19, v19, v146
    v_sub_f32 v147, 0, v146
    v_exp_f32 v147, v147
    s_nop 0
    v_mul_f32 v23, v23, v147
    v_accvgpr_read_b32 v148, a48
    v_accvgpr_read_b32 v149, a49
    v_accvgpr_read_b32 v150, a50
    v_accvgpr_read_b32 v151, a51
    v_mul_f32 v148, v148, v147
    v_mul_f32 v149, v149, v147
    v_mul_f32 v150, v150, v147
    v_mul_f32 v151, v151, v147
    v_accvgpr_write_b32 a48, v148
    v_accvgpr_write_b32 a49, v149
    v_accvgpr_write_b32 a50, v150
    v_accvgpr_write_b32 a51, v151
    v_accvgpr_read_b32 v148, a52
    v_accvgpr_read_b32 v149, a53
    v_accvgpr_read_b32 v150, a54
    v_accvgpr_read_b32 v151, a55
    v_mul_f32 v148, v148, v147
    v_mul_f32 v149, v149, v147
    v_mul_f32 v150, v150, v147
    v_mul_f32 v151, v151, v147
    v_accvgpr_write_b32 a52, v148
    v_accvgpr_write_b32 a53, v149
    v_accvgpr_write_b32 a54, v150
    v_accvgpr_write_b32 a55, v151
    v_accvgpr_read_b32 v148, a56
    v_accvgpr_read_b32 v149, a57
    v_accvgpr_read_b32 v150, a58
    v_accvgpr_read_b32 v151, a59
    v_mul_f32 v148, v148, v147
    v_mul_f32 v149, v149, v147
    v_mul_f32 v150, v150, v147
    v_mul_f32 v151, v151, v147
    v_accvgpr_write_b32 a56, v148
    v_accvgpr_write_b32 a57, v149
    v_accvgpr_write_b32 a58, v150
    v_accvgpr_write_b32 a59, v151
    v_accvgpr_read_b32 v148, a60
    v_accvgpr_read_b32 v149, a61
    v_accvgpr_read_b32 v150, a62
    v_accvgpr_read_b32 v151, a63
    v_mul_f32 v148, v148, v147
    v_mul_f32 v149, v149, v147
    v_mul_f32 v150, v150, v147
    v_mul_f32 v151, v151, v147
    v_accvgpr_write_b32 a60, v148
    v_accvgpr_write_b32 a61, v149
    v_accvgpr_write_b32 a62, v150
    v_accvgpr_write_b32 a63, v151
    v_accvgpr_read_b32 v148, a64
    v_accvgpr_read_b32 v149, a65
    v_accvgpr_read_b32 v150, a66
    v_accvgpr_read_b32 v151, a67
    v_mul_f32 v148, v148, v147
    v_mul_f32 v149, v149, v147
    v_mul_f32 v150, v150, v147
    v_mul_f32 v151, v151, v147
    v_accvgpr_write_b32 a64, v148
    v_accvgpr_write_b32 a65, v149
    v_accvgpr_write_b32 a66, v150
    v_accvgpr_write_b32 a67, v151
    v_accvgpr_read_b32 v148, a68
    v_accvgpr_read_b32 v149, a69
    v_accvgpr_read_b32 v150, a70
    v_accvgpr_read_b32 v151, a71
    v_mul_f32 v148, v148, v147
    v_mul_f32 v149, v149, v147
    v_mul_f32 v150, v150, v147
    v_mul_f32 v151, v151, v147
    v_accvgpr_write_b32 a68, v148
    v_accvgpr_write_b32 a69, v149
    v_accvgpr_write_b32 a70, v150
    v_accvgpr_write_b32 a71, v151
    v_accvgpr_read_b32 v148, a72
    v_accvgpr_read_b32 v149, a73
    v_accvgpr_read_b32 v150, a74
    v_accvgpr_read_b32 v151, a75
    v_mul_f32 v148, v148, v147
    v_mul_f32 v149, v149, v147
    v_mul_f32 v150, v150, v147
    v_mul_f32 v151, v151, v147
    v_accvgpr_write_b32 a72, v148
    v_accvgpr_write_b32 a73, v149
    v_accvgpr_write_b32 a74, v150
    v_accvgpr_write_b32 a75, v151
    v_accvgpr_read_b32 v148, a76
    v_accvgpr_read_b32 v149, a77
    v_accvgpr_read_b32 v150, a78
    v_accvgpr_read_b32 v151, a79
    v_mul_f32 v148, v148, v147
    v_mul_f32 v149, v149, v147
    v_mul_f32 v150, v150, v147
    v_mul_f32 v151, v151, v147
    v_accvgpr_write_b32 a76, v148
    v_accvgpr_write_b32 a77, v149
    v_accvgpr_write_b32 a78, v150
    v_accvgpr_write_b32 a79, v151
    v_accvgpr_read_b32 v148, a80
    v_accvgpr_read_b32 v149, a81
    v_accvgpr_read_b32 v150, a82
    v_accvgpr_read_b32 v151, a83
    v_mul_f32 v148, v148, v147
    v_mul_f32 v149, v149, v147
    v_mul_f32 v150, v150, v147
    v_mul_f32 v151, v151, v147
    v_accvgpr_write_b32 a80, v148
    v_accvgpr_write_b32 a81, v149
    v_accvgpr_write_b32 a82, v150
    v_accvgpr_write_b32 a83, v151
    v_accvgpr_read_b32 v148, a84
    v_accvgpr_read_b32 v149, a85
    v_accvgpr_read_b32 v150, a86
    v_accvgpr_read_b32 v151, a87
    v_mul_f32 v148, v148, v147
    v_mul_f32 v149, v149, v147
    v_mul_f32 v150, v150, v147
    v_mul_f32 v151, v151, v147
    v_accvgpr_write_b32 a84, v148
    v_accvgpr_write_b32 a85, v149
    v_accvgpr_write_b32 a86, v150
    v_accvgpr_write_b32 a87, v151
    v_accvgpr_read_b32 v148, a88
    v_accvgpr_read_b32 v149, a89
    v_accvgpr_read_b32 v150, a90
    v_accvgpr_read_b32 v151, a91
    v_mul_f32 v148, v148, v147
    v_mul_f32 v149, v149, v147
    v_mul_f32 v150, v150, v147
    v_mul_f32 v151, v151, v147
    v_accvgpr_write_b32 a88, v148
    v_accvgpr_write_b32 a89, v149
    v_accvgpr_write_b32 a90, v150
    v_accvgpr_write_b32 a91, v151
    v_accvgpr_read_b32 v148, a92
    v_accvgpr_read_b32 v149, a93
    v_accvgpr_read_b32 v150, a94
    v_accvgpr_read_b32 v151, a95
    v_mul_f32 v148, v148, v147
    v_mul_f32 v149, v149, v147
    v_mul_f32 v150, v150, v147
    v_mul_f32 v151, v151, v147
    v_accvgpr_write_b32 a92, v148
    v_accvgpr_write_b32 a93, v149
    v_accvgpr_write_b32 a94, v150
    v_accvgpr_write_b32 a95, v151
    v_sub_f32 v56, v56, v146
    v_sub_f32 v57, v57, v146
    v_exp_f32 v152, v56
    v_exp_f32 v153, v57
    s_nop 0
    v_cvt_pk_bf16_f32 v108, v152, v153
    v_sub_f32 v58, v58, v146
    v_sub_f32 v59, v59, v146
    v_exp_f32 v152, v58
    v_exp_f32 v153, v59
    s_nop 0
    v_cvt_pk_bf16_f32 v109, v152, v153
    v_sub_f32 v60, v60, v146
    v_sub_f32 v61, v61, v146
    v_exp_f32 v152, v60
    v_exp_f32 v153, v61
    s_nop 0
    v_cvt_pk_bf16_f32 v110, v152, v153
    v_sub_f32 v62, v62, v146
    v_sub_f32 v63, v63, v146
    v_exp_f32 v152, v62
    v_exp_f32 v153, v63
    s_nop 0
    v_cvt_pk_bf16_f32 v111, v152, v153
    s_nop 1
    v_mfma_f32_16x16x32_bf16 v[140:143], v[24:27], v[108:111], 0
    s_nop 15
    s_setpc_b64 s[44:45]
L_rare4_1:
    s_nop 15
    v_max3_f32 v144, v64, v65, v66
    v_max3_f32 v144, v144, v67, v68
    v_max3_f32 v144, v144, v69, v70
    v_max_f32 v144, v144, v71
    v_mov_b32 v145, v144
    s_nop 1
    v_permlane32_swap_b32 v145, v144
    v_max_f32 v144, v144, v145
    v_mov_b32 v145, v144
    s_nop 1
    v_permlane16_swap_b32 v145, v144
    v_max_f32 v144, v144, v145
    v_max_f32 v146, 0, v144
    v_sub_f32 v16, v16, v146
    v_sub_f32 v147, 0, v146
    v_exp_f32 v147, v147
    s_nop 0
    v_mul_f32 v20, v20, v147
    v_mul_f32 v160, v160, v147
    v_mul_f32 v161, v161, v147
    v_mul_f32 v162, v162, v147
    v_mul_f32 v163, v163, v147
    v_mul_f32 v164, v164, v147
    v_mul_f32 v165, v165, v147
    v_mul_f32 v166, v166, v147
    v_mul_f32 v167, v167, v147
    v_mul_f32 v168, v168, v147
    v_mul_f32 v169, v169, v147
    v_mul_f32 v170, v170, v147
    v_mul_f32 v171, v171, v147
    v_mul_f32 v172, v172, v147
    v_mul_f32 v173, v173, v147
    v_mul_f32 v174, v174, v147
    v_mul_f32 v175, v175, v147
    v_mul_f32 v176, v176, v147
    v_mul_f32 v177, v177, v147
    v_mul_f32 v178, v178, v147
    v_mul_f32 v179, v179, v147
    v_mul_f32 v180, v180, v147
    v_mul_f32 v181, v181, v147
    v_mul_f32 v182, v182, v147
    v_mul_f32 v183, v183, v147
    v_mul_f32 v184, v184, v147
    v_mul_f32 v185, v185, v147
    v_mul_f32 v186, v186, v147
    v_mul_f32 v187, v187, v147
    v_mul_f32 v188, v188, v147
    v_mul_f32 v189, v189, v147
    v_mul_f32 v190, v190, v147
    v_mul_f32 v191, v191, v147
    v_mul_f32 v192, v192, v147
    v_mul_f32 v193, v193, v147
    v_mul_f32 v194, v194, v147
    v_mul_f32 v195, v195, v147
    v_mul_f32 v196, v196, v147
    v_mul_f32 v197, v197, v147
    v_mul_f32 v198, v198, v147
    v_mul_f32 v199, v199, v147
    v_mul_f32 v200, v200, v147
    v_mul_f32 v201, v201, v147
    v_mul_f32 v202, v202, v147
    v_mul_f32 v203, v203, v147
    v_mul_f32 v204, v204, v147
    v_mul_f32 v205, v205, v147
    v_mul_f32 v206, v206, v147
    v_mul_f32 v207, v207, v147
    v_sub_f32 v64, v64, v146
    v_sub_f32 v65, v65, v146
    v_exp_f32 v152, v64
    v_exp_f32 v153, v65
    s_nop 0
    v_cvt_pk_bf16_f32 v112, v152, v153
    v_sub_f32 v66, v66, v146
    v_sub_f32 v67, v67, v146
    v_exp_f32 v152, v66
    v_exp_f32 v153, v67
    s_nop 0
    v_cvt_pk_bf16_f32 v113, v152, v153
    v_sub_f32 v68, v68, v146
    v_sub_f32 v69, v69, v146
    v_exp_f32 v152, v68
    v_exp_f32 v153, v69
    s_nop 0
    v_cvt_pk_bf16_f32 v114, v152, v153
    v_sub_f32 v70, v70, v146
    v_sub_f32 v71, v71, v146
    v_exp_f32 v152, v70
    v_exp_f32 v153, v71
    s_nop 0
    v_cvt_pk_bf16_f32 v115, v152, v153
    s_nop 1
    v_mfma_f32_16x16x32_bf16 v[128:131], v[24:27], v[112:115], 0
    v_max3_f32 v144, v72, v73, v74
    v_max3_f32 v144, v144, v75, v76
    v_max3_f32 v144, v144, v77, v78
    v_max_f32 v144, v144, v79
    v_mov_b32 v145, v144
    s_nop 1
    v_permlane32_swap_b32 v145, v144
    v_max_f32 v144, v144, v145
    v_mov_b32 v145, v144
    s_nop 1
    v_permlane16_swap_b32 v145, v144
    v_max_f32 v144, v144, v145
    v_max_f32 v146, 0, v144
    v_sub_f32 v17, v17, v146
    v_sub_f32 v147, 0, v146
    v_exp_f32 v147, v147
    s_nop 0
    v_mul_f32 v21, v21, v147
    v_mul_f32 v208, v208, v147
    v_mul_f32 v209, v209, v147
    v_mul_f32 v210, v210, v147
    v_mul_f32 v211, v211, v147
    v_mul_f32 v212, v212, v147
    v_mul_f32 v213, v213, v147
    v_mul_f32 v214, v214, v147
    v_mul_f32 v215, v215, v147
    v_mul_f32 v216, v216, v147
    v_mul_f32 v217, v217, v147
    v_mul_f32 v218, v218, v147
    v_mul_f32 v219, v219, v147
    v_mul_f32 v220, v220, v147
    v_mul_f32 v221, v221, v147
    v_mul_f32 v222, v222, v147
    v_mul_f32 v223, v223, v147
    v_mul_f32 v224, v224, v147
    v_mul_f32 v225, v225, v147
    v_mul_f32 v226, v226, v147
    v_mul_f32 v227, v227, v147
    v_mul_f32 v228, v228, v147
    v_mul_f32 v229, v229, v147
    v_mul_f32 v230, v230, v147
    v_mul_f32 v231, v231, v147
    v_mul_f32 v232, v232, v147
    v_mul_f32 v233, v233, v147
    v_mul_f32 v234, v234, v147
    v_mul_f32 v235, v235, v147
    v_mul_f32 v236, v236, v147
    v_mul_f32 v237, v237, v147
    v_mul_f32 v238, v238, v147
    v_mul_f32 v239, v239, v147
    v_mul_f32 v240, v240, v147
    v_mul_f32 v241, v241, v147
    v_mul_f32 v242, v242, v147
    v_mul_f32 v243, v243, v147
    v_mul_f32 v244, v244, v147
    v_mul_f32 v245, v245, v147
    v_mul_f32 v246, v246, v147
    v_mul_f32 v247, v247, v147
    v_mul_f32 v248, v248, v147
    v_mul_f32 v249, v249, v147
    v_mul_f32 v250, v250, v147
    v_mul_f32 v251, v251, v147
    v_mul_f32 v252, v252, v147
    v_mul_f32 v253, v253, v147
    v_mul_f32 v254, v254, v147
    v_mul_f32 v255, v255, v147
    v_sub_f32 v72, v72, v146
    v_sub_f32 v73, v73, v146
    v_exp_f32 v152, v72
    v_exp_f32 v153, v73
    s_nop 0
    v_cvt_pk_bf16_f32 v116, v152, v153
    v_sub_f32 v74, v74, v146
    v_sub_f32 v75, v75, v146
    v_exp_f32 v152, v74
    v_exp_f32 v153, v75
    s_nop 0
    v_cvt_pk_bf16_f32 v117, v152, v153
    v_sub_f32 v76, v76, v146
    v_sub_f32 v77, v77, v146
    v_exp_f32 v152, v76
    v_exp_f32 v153, v77
    s_nop 0
    v_cvt_pk_bf16_f32 v118, v152, v153
    v_sub_f32 v78, v78, v146
    v_sub_f32 v79, v79, v146
    v_exp_f32 v152, v78
    v_exp_f32 v153, v79
    s_nop 0
    v_cvt_pk_bf16_f32 v119, v152, v153
    s_nop 1
    v_mfma_f32_16x16x32_bf16 v[132:135], v[24:27], v[116:119], 0
    v_max3_f32 v144, v80, v81, v82
    v_max3_f32 v144, v144, v83, v84
    v_max3_f32 v144, v144, v85, v86
    v_max_f32 v144, v144, v87
    v_mov_b32 v145, v144
    s_nop 1
    v_permlane32_swap_b32 v145, v144
    v_max_f32 v144, v144, v145
    v_mov_b32 v145, v144
    s_nop 1
    v_permlane16_swap_b32 v145, v144
    v_max_f32 v144, v144, v145
    v_max_f32 v146, 0, v144
    v_sub_f32 v18, v18, v146
    v_sub_f32 v147, 0, v146
    v_exp_f32 v147, v147
    s_nop 0
    v_mul_f32 v22, v22, v147
    v_accvgpr_read_b32 v148, a0
    v_accvgpr_read_b32 v149, a1
    v_accvgpr_read_b32 v150, a2
    v_accvgpr_read_b32 v151, a3
    v_mul_f32 v148, v148, v147
    v_mul_f32 v149, v149, v147
    v_mul_f32 v150, v150, v147
    v_mul_f32 v151, v151, v147
    v_accvgpr_write_b32 a0, v148
    v_accvgpr_write_b32 a1, v149
    v_accvgpr_write_b32 a2, v150
    v_accvgpr_write_b32 a3, v151
    v_accvgpr_read_b32 v148, a4
    v_accvgpr_read_b32 v149, a5
    v_accvgpr_read_b32 v150, a6
    v_accvgpr_read_b32 v151, a7
    v_mul_f32 v148, v148, v147
    v_mul_f32 v149, v149, v147
    v_mul_f32 v150, v150, v147
    v_mul_f32 v151, v151, v147
    v_accvgpr_write_b32 a4, v148
    v_accvgpr_write_b32 a5, v149
    v_accvgpr_write_b32 a6, v150
    v_accvgpr_write_b32 a7, v151
    v_accvgpr_read_b32 v148, a8
    v_accvgpr_read_b32 v149, a9
    v_accvgpr_read_b32 v150, a10
    v_accvgpr_read_b32 v151, a11
    v_mul_f32 v148, v148, v147
    v_mul_f32 v149, v149, v147
    v_mul_f32 v150, v150, v147
    v_mul_f32 v151, v151, v147
    v_accvgpr_write_b32 a8, v148
    v_accvgpr_write_b32 a9, v149
    v_accvgpr_write_b32 a10, v150
    v_accvgpr_write_b32 a11, v151
    v_accvgpr_read_b32 v148, a12
    v_accvgpr_read_b32 v149, a13
    v_accvgpr_read_b32 v150, a14
    v_accvgpr_read_b32 v151, a15
    v_mul_f32 v148, v148, v147
    v_mul_f32 v149, v149, v147
    v_mul_f32 v150, v150, v147
    v_mul_f32 v151, v151, v147
    v_accvgpr_write_b32 a12, v148
    v_accvgpr_write_b32 a13, v149
    v_accvgpr_write_b32 a14, v150
    v_accvgpr_write_b32 a15, v151
    v_accvgpr_read_b32 v148, a16
    v_accvgpr_read_b32 v149, a17
    v_accvgpr_read_b32 v150, a18
    v_accvgpr_read_b32 v151, a19
    v_mul_f32 v148, v148, v147
    v_mul_f32 v149, v149, v147
    v_mul_f32 v150, v150, v147
    v_mul_f32 v151, v151, v147
    v_accvgpr_write_b32 a16, v148
    v_accvgpr_write_b32 a17, v149
    v_accvgpr_write_b32 a18, v150
    v_accvgpr_write_b32 a19, v151
    v_accvgpr_read_b32 v148, a20
    v_accvgpr_read_b32 v149, a21
    v_accvgpr_read_b32 v150, a22
    v_accvgpr_read_b32 v151, a23
    v_mul_f32 v148, v148, v147
    v_mul_f32 v149, v149, v147
    v_mul_f32 v150, v150, v147
    v_mul_f32 v151, v151, v147
    v_accvgpr_write_b32 a20, v148
    v_accvgpr_write_b32 a21, v149
    v_accvgpr_write_b32 a22, v150
    v_accvgpr_write_b32 a23, v151
    v_accvgpr_read_b32 v148, a24
    v_accvgpr_read_b32 v149, a25
    v_accvgpr_read_b32 v150, a26
    v_accvgpr_read_b32 v151, a27
    v_mul_f32 v148, v148, v147
    v_mul_f32 v149, v149, v147
    v_mul_f32 v150, v150, v147
    v_mul_f32 v151, v151, v147
    v_accvgpr_write_b32 a24, v148
    v_accvgpr_write_b32 a25, v149
    v_accvgpr_write_b32 a26, v150
    v_accvgpr_write_b32 a27, v151
    v_accvgpr_read_b32 v148, a28
    v_accvgpr_read_b32 v149, a29
    v_accvgpr_read_b32 v150, a30
    v_accvgpr_read_b32 v151, a31
    v_mul_f32 v148, v148, v147
    v_mul_f32 v149, v149, v147
    v_mul_f32 v150, v150, v147
    v_mul_f32 v151, v151, v147
    v_accvgpr_write_b32 a28, v148
    v_accvgpr_write_b32 a29, v149
    v_accvgpr_write_b32 a30, v150
    v_accvgpr_write_b32 a31, v151
    v_accvgpr_read_b32 v148, a32
    v_accvgpr_read_b32 v149, a33
    v_accvgpr_read_b32 v150, a34
    v_accvgpr_read_b32 v151, a35
    v_mul_f32 v148, v148, v147
    v_mul_f32 v149, v149, v147
    v_mul_f32 v150, v150, v147
    v_mul_f32 v151, v151, v147
    v_accvgpr_write_b32 a32, v148
    v_accvgpr_write_b32 a33, v149
    v_accvgpr_write_b32 a34, v150
    v_accvgpr_write_b32 a35, v151
    v_accvgpr_read_b32 v148, a36
    v_accvgpr_read_b32 v149, a37
    v_accvgpr_read_b32 v150, a38
    v_accvgpr_read_b32 v151, a39
    v_mul_f32 v148, v148, v147
    v_mul_f32 v149, v149, v147
    v_mul_f32 v150, v150, v147
    v_mul_f32 v151, v151, v147
    v_accvgpr_write_b32 a36, v148
    v_accvgpr_write_b32 a37, v149
    v_accvgpr_write_b32 a38, v150
    v_accvgpr_write_b32 a39, v151
    v_accvgpr_read_b32 v148, a40
    v_accvgpr_read_b32 v149, a41
    v_accvgpr_read_b32 v150, a42
    v_accvgpr_read_b32 v151, a43
    v_mul_f32 v148, v148, v147
    v_mul_f32 v149, v149, v147
    v_mul_f32 v150, v150, v147
    v_mul_f32 v151, v151, v147
    v_accvgpr_write_b32 a40, v148
    v_accvgpr_write_b32 a41, v149
    v_accvgpr_write_b32 a42, v150
    v_accvgpr_write_b32 a43, v151
    v_accvgpr_read_b32 v148, a44
    v_accvgpr_read_b32 v149, a45
    v_accvgpr_read_b32 v150, a46
    v_accvgpr_read_b32 v151, a47
    v_mul_f32 v148, v148, v147
    v_mul_f32 v149, v149, v147
    v_mul_f32 v150, v150, v147
    v_mul_f32 v151, v151, v147
    v_accvgpr_write_b32 a44, v148
    v_accvgpr_write_b32 a45, v149
    v_accvgpr_write_b32 a46, v150
    v_accvgpr_write_b32 a47, v151
    v_sub_f32 v80, v80, v146
    v_sub_f32 v81, v81, v146
    v_exp_f32 v152, v80
    v_exp_f32 v153, v81
    s_nop 0
    v_cvt_pk_bf16_f32 v120, v152, v153
    v_sub_f32 v82, v82, v146
    v_sub_f32 v83, v83, v146
    v_exp_f32 v152, v82
    v_exp_f32 v153, v83
    s_nop 0
    v_cvt_pk_bf16_f32 v121, v152, v153
    v_sub_f32 v84, v84, v146
    v_sub_f32 v85, v85, v146
    v_exp_f32 v152, v84
    v_exp_f32 v153, v85
    s_nop 0
    v_cvt_pk_bf16_f32 v122, v152, v153
    v_sub_f32 v86, v86, v146
    v_sub_f32 v87, v87, v146
    v_exp_f32 v152, v86
    v_exp_f32 v153, v87
    s_nop 0
    v_cvt_pk_bf16_f32 v123, v152, v153
    s_nop 1
    v_mfma_f32_16x16x32_bf16 v[136:139], v[24:27], v[120:123], 0
    v_max3_f32 v144, v88, v89, v90
    v_max3_f32 v144, v144, v91, v92
    v_max3_f32 v144, v144, v93, v94
    v_max_f32 v144, v144, v95
    v_mov_b32 v145, v144
    s_nop 1
    v_permlane32_swap_b32 v145, v144
    v_max_f32 v144, v144, v145
    v_mov_b32 v145, v144
    s_nop 1
    v_permlane16_swap_b32 v145, v144
    v_max_f32 v144, v144, v145
    v_max_f32 v146, 0, v144
    v_sub_f32 v19, v19, v146
    v_sub_f32 v147, 0, v146
    v_exp_f32 v147, v147
    s_nop 0
    v_mul_f32 v23, v23, v147
    v_accvgpr_read_b32 v148, a48
    v_accvgpr_read_b32 v149, a49
    v_accvgpr_read_b32 v150, a50
    v_accvgpr_read_b32 v151, a51
    v_mul_f32 v148, v148, v147
    v_mul_f32 v149, v149, v147
    v_mul_f32 v150, v150, v147
    v_mul_f32 v151, v151, v147
    v_accvgpr_write_b32 a48, v148
    v_accvgpr_write_b32 a49, v149
    v_accvgpr_write_b32 a50, v150
    v_accvgpr_write_b32 a51, v151
    v_accvgpr_read_b32 v148, a52
    v_accvgpr_read_b32 v149, a53
    v_accvgpr_read_b32 v150, a54
    v_accvgpr_read_b32 v151, a55
    v_mul_f32 v148, v148, v147
    v_mul_f32 v149, v149, v147
    v_mul_f32 v150, v150, v147
    v_mul_f32 v151, v151, v147
    v_accvgpr_write_b32 a52, v148
    v_accvgpr_write_b32 a53, v149
    v_accvgpr_write_b32 a54, v150
    v_accvgpr_write_b32 a55, v151
    v_accvgpr_read_b32 v148, a56
    v_accvgpr_read_b32 v149, a57
    v_accvgpr_read_b32 v150, a58
    v_accvgpr_read_b32 v151, a59
    v_mul_f32 v148, v148, v147
    v_mul_f32 v149, v149, v147
    v_mul_f32 v150, v150, v147
    v_mul_f32 v151, v151, v147
    v_accvgpr_write_b32 a56, v148
    v_accvgpr_write_b32 a57, v149
    v_accvgpr_write_b32 a58, v150
    v_accvgpr_write_b32 a59, v151
    v_accvgpr_read_b32 v148, a60
    v_accvgpr_read_b32 v149, a61
    v_accvgpr_read_b32 v150, a62
    v_accvgpr_read_b32 v151, a63
    v_mul_f32 v148, v148, v147
    v_mul_f32 v149, v149, v147
    v_mul_f32 v150, v150, v147
    v_mul_f32 v151, v151, v147
    v_accvgpr_write_b32 a60, v148
    v_accvgpr_write_b32 a61, v149
    v_accvgpr_write_b32 a62, v150
    v_accvgpr_write_b32 a63, v151
    v_accvgpr_read_b32 v148, a64
    v_accvgpr_read_b32 v149, a65
    v_accvgpr_read_b32 v150, a66
    v_accvgpr_read_b32 v151, a67
    v_mul_f32 v148, v148, v147
    v_mul_f32 v149, v149, v147
    v_mul_f32 v150, v150, v147
    v_mul_f32 v151, v151, v147
    v_accvgpr_write_b32 a64, v148
    v_accvgpr_write_b32 a65, v149
    v_accvgpr_write_b32 a66, v150
    v_accvgpr_write_b32 a67, v151
    v_accvgpr_read_b32 v148, a68
    v_accvgpr_read_b32 v149, a69
    v_accvgpr_read_b32 v150, a70
    v_accvgpr_read_b32 v151, a71
    v_mul_f32 v148, v148, v147
    v_mul_f32 v149, v149, v147
    v_mul_f32 v150, v150, v147
    v_mul_f32 v151, v151, v147
    v_accvgpr_write_b32 a68, v148
    v_accvgpr_write_b32 a69, v149
    v_accvgpr_write_b32 a70, v150
    v_accvgpr_write_b32 a71, v151
    v_accvgpr_read_b32 v148, a72
    v_accvgpr_read_b32 v149, a73
    v_accvgpr_read_b32 v150, a74
    v_accvgpr_read_b32 v151, a75
    v_mul_f32 v148, v148, v147
    v_mul_f32 v149, v149, v147
    v_mul_f32 v150, v150, v147
    v_mul_f32 v151, v151, v147
    v_accvgpr_write_b32 a72, v148
    v_accvgpr_write_b32 a73, v149
    v_accvgpr_write_b32 a74, v150
    v_accvgpr_write_b32 a75, v151
    v_accvgpr_read_b32 v148, a76
    v_accvgpr_read_b32 v149, a77
    v_accvgpr_read_b32 v150, a78
    v_accvgpr_read_b32 v151, a79
    v_mul_f32 v148, v148, v147
    v_mul_f32 v149, v149, v147
    v_mul_f32 v150, v150, v147
    v_mul_f32 v151, v151, v147
    v_accvgpr_write_b32 a76, v148
    v_accvgpr_write_b32 a77, v149
    v_accvgpr_write_b32 a78, v150
    v_accvgpr_write_b32 a79, v151
    v_accvgpr_read_b32 v148, a80
    v_accvgpr_read_b32 v149, a81
    v_accvgpr_read_b32 v150, a82
    v_accvgpr_read_b32 v151, a83
    v_mul_f32 v148, v148, v147
    v_mul_f32 v149, v149, v147
    v_mul_f32 v150, v150, v147
    v_mul_f32 v151, v151, v147
    v_accvgpr_write_b32 a80, v148
    v_accvgpr_write_b32 a81, v149
    v_accvgpr_write_b32 a82, v150
    v_accvgpr_write_b32 a83, v151
    v_accvgpr_read_b32 v148, a84
    v_accvgpr_read_b32 v149, a85
    v_accvgpr_read_b32 v150, a86
    v_accvgpr_read_b32 v151, a87
    v_mul_f32 v148, v148, v147
    v_mul_f32 v149, v149, v147
    v_mul_f32 v150, v150, v147
    v_mul_f32 v151, v151, v147
    v_accvgpr_write_b32 a84, v148
    v_accvgpr_write_b32 a85, v149
    v_accvgpr_write_b32 a86, v150
    v_accvgpr_write_b32 a87, v151
    v_accvgpr_read_b32 v148, a88
    v_accvgpr_read_b32 v149, a89
    v_accvgpr_read_b32 v150, a90
    v_accvgpr_read_b32 v151, a91
    v_mul_f32 v148, v148, v147
    v_mul_f32 v149, v149, v147
    v_mul_f32 v150, v150, v147
    v_mul_f32 v151, v151, v147
    v_accvgpr_write_b32 a88, v148
    v_accvgpr_write_b32 a89, v149
    v_accvgpr_write_b32 a90, v150
    v_accvgpr_write_b32 a91, v151
    v_accvgpr_read_b32 v148, a92
    v_accvgpr_read_b32 v149, a93
    v_accvgpr_read_b32 v150, a94
    v_accvgpr_read_b32 v151, a95
    v_mul_f32 v148, v148, v147
    v_mul_f32 v149, v149, v147
    v_mul_f32 v150, v150, v147
    v_mul_f32 v151, v151, v147
    v_accvgpr_write_b32 a92, v148
    v_accvgpr_write_b32 a93, v149
    v_accvgpr_write_b32 a94, v150
    v_accvgpr_write_b32 a95, v151
    v_sub_f32 v88, v88, v146
    v_sub_f32 v89, v89, v146
    v_exp_f32 v152, v88
    v_exp_f32 v153, v89
    s_nop 0
    v_cvt_pk_bf16_f32 v124, v152, v153
    v_sub_f32 v90, v90, v146
    v_sub_f32 v91, v91, v146
    v_exp_f32 v152, v90
    v_exp_f32 v153, v91
    s_nop 0
    v_cvt_pk_bf16_f32 v125, v152, v153
    v_sub_f32 v92, v92, v146
    v_sub_f32 v93, v93, v146
    v_exp_f32 v152, v92
    v_exp_f32 v153, v93
    s_nop 0
    v_cvt_pk_bf16_f32 v126, v152, v153
    v_sub_f32 v94, v94, v146
    v_sub_f32 v95, v95, v146
    v_exp_f32 v152, v94
    v_exp_f32 v153, v95
    s_nop 0
    v_cvt_pk_bf16_f32 v127, v152, v153
    s_nop 1
    v_mfma_f32_16x16x32_bf16 v[140:143], v[24:27], v[124:127], 0
    s_nop 15
    s_setpc_b64 s[44:45]
L_mode3w0:
    s_cmp_eq_u32 s38, 5
    s_cbranch_scc1 L_mode3w0_kv
    s_mov_b32 s46, s28
    s_mov_b32 s47, s29
    s_mov_b32 s20, s12
    s_mov_b32 s24, s12
    s_mov_b32 s21, s13
    s_mov_b32 s25, s13
    s_mov_b32 s22, s14
    s_mov_b32 s26, s14
    s_mov_b32 s23, s15
    s_mov_b32 s27, s15
    s_and_b32 s63, s3, 1
    s_mul_i32 s63, s63, 3072
    s_add_u32 s28, s41, s63
    s_add_u32 s31, s35, s63
    s_sub_u32 s63, 3072, s63
    s_add_u32 s29, s41, s63
    s_add_u32 s32, s35, s63
    s_mov_b32 s30, 6144
    v_xor_b32 v10, 80, v7
    v_xor_b32 v11, 80, v8
    v_xor_b32 v12, 80, v9
    s_branch L_modeback3w0
L_mode3w0_kv:
    s_mov_b32 s20, s4
    s_mov_b32 s24, s8
    s_mov_b32 s21, s5
    s_mov_b32 s25, s9
    s_mov_b32 s22, s6
    s_mov_b32 s26, s10
    s_mov_b32 s23, s7
    s_mov_b32 s27, s11
    s_mov_b32 s28, s46
    s_mov_b32 s29, s47
    s_mul_i32 s31, s3, 3072
    s_add_u32 s32, s31, 12288
    s_mov_b32 s30, 12288
    v_mov_b32 v10, v7
    v_mov_b32 v11, v8
    v_mov_b32 v12, v9
    s_branch L_modeback3w0
L_mode3w1:
    s_cmp_eq_u32 s38, 5
    s_cbranch_scc1 L_mode3w1_kv
    s_mov_b32 s46, s28
    s_mov_b32 s47, s29
    s_mov_b32 s20, s12
    s_mov_b32 s24, s12
    s_mov_b32 s21, s13
    s_mov_b32 s25, s13
    s_mov_b32 s22, s14
    s_mov_b32 s26, s14
    s_mov_b32 s23, s15
    s_mov_b32 s27, s15
    s_and_b32 s63, s3, 1
    s_mul_i32 s63, s63, 3072
    s_add_u32 s28, s41, s63
    s_add_u32 s31, s35, s63
    s_sub_u32 s63, 3072, s63
    s_add_u32 s29, s41, s63
    s_add_u32 s32, s35, s63
    s_mov_b32 s30, 6144
    v_xor_b32 v10, 80, v7
    v_xor_b32 v11, 80, v8
    v_xor_b32 v12, 80, v9
    s_branch L_modeback3w1
L_mode3w1_kv:
    s_mov_b32 s20, s4
    s_mov_b32 s24, s8
    s_mov_b32 s21, s5
    s_mov_b32 s25, s9
    s_mov_b32 s22, s6
    s_mov_b32 s26, s10
    s_mov_b32 s23, s7
    s_mov_b32 s27, s11
    s_mov_b32 s28, s46
    s_mov_b32 s29, s47
    s_mul_i32 s31, s3, 3072
    s_add_u32 s32, s31, 12288
    s_mov_b32 s30, 12288
    v_mov_b32 v10, v7
    v_mov_b32 v11, v8
    v_mov_b32 v12, v9
    s_branch L_modeback3w1
L_rare3_0:
    s_nop 15
    v_max3_f32 v144, v32, v33, v34
    v_max3_f32 v144, v144, v35, v36
    v_max3_f32 v144, v144, v37, v38
    v_max_f32 v144, v144, v39
    v_mov_b32 v145, v144
    s_nop 1
    v_permlane32_swap_b32 v145, v144
    v_max_f32 v144, v144, v145
    v_mov_b32 v145, v144
    s_nop 1
    v_permlane16_swap_b32 v145, v144
    v_max_f32 v144, v144, v145
    v_max_f32 v146, 0, v144
    v_sub_f32 v16, v16, v146
    v_sub_f32 v147, 0, v146
    v_exp_f32 v147, v147
    s_nop 0
    v_mul_f32 v20, v20, v147
    v_mul_f32 v160, v160, v147
    v_mul_f32 v161, v161, v147
    v_mul_f32 v162, v162, v147
    v_mul_f32 v163, v163, v147
    v_mul_f32 v164, v164, v147
    v_mul_f32 v165, v165, v147
    v_mul_f32 v166, v166, v147
    v_mul_f32 v167, v167, v147
    v_mul_f32 v168, v168, v147
    v_mul_f32 v169, v169, v147
    v_mul_f32 v170, v170, v147
    v_mul_f32 v171, v171, v147
    v_mul_f32 v172, v172, v147
    v_mul_f32 v173, v173, v147
    v_mul_f32 v174, v174, v147
    v_mul_f32 v175, v175, v147
    v_mul_f32 v176, v176, v147
    v_mul_f32 v177, v177, v147
    v_mul_f32 v178, v178, v147
    v_mul_f32 v179, v179, v147
    v_mul_f32 v180, v180, v147
    v_mul_f32 v181, v181, v147
    v_mul_f32 v182, v182, v147
    v_mul_f32 v183, v183, v147
    v_mul_f32 v184, v184, v147
    v_mul_f32 v185, v185, v147
    v_mul_f32 v186, v186, v147
    v_mul_f32 v187, v187, v147
    v_mul_f32 v188, v188, v147
    v_mul_f32 v189, v189, v147
    v_mul_f32 v190, v190, v147
    v_mul_f32 v191, v191, v147
    v_mul_f32 v192, v192, v147
    v_mul_f32 v193, v193, v147
    v_mul_f32 v194, v194, v147
    v_mul_f32 v195, v195, v147
    v_mul_f32 v196, v196, v147
    v_mul_f32 v197, v197, v147
    v_mul_f32 v198, v198, v147
    v_mul_f32 v199, v199, v147
    v_mul_f32 v200, v200, v147
    v_mul_f32 v201, v201, v147
    v_mul_f32 v202, v202, v147
    v_mul_f32 v203, v203, v147
    v_mul_f32 v204, v204, v147
    v_mul_f32 v205, v205, v147
    v_mul_f32 v206, v206, v147
    v_mul_f32 v207, v207, v147
    v_sub_f32 v32, v32, v146
    v_sub_f32 v33, v33, v146
    v_exp_f32 v152, v32
    v_exp_f32 v153, v33
    s_nop 0
    v_cvt_pk_bf16_f32 v96, v152, v153
    v_sub_f32 v34, v34, v146
    v_sub_f32 v35, v35, v146
    v_exp_f32 v152, v34
    v_exp_f32 v153, v35
    s_nop 0
    v_cvt_pk_bf16_f32 v97, v152, v153
    v_sub_f32 v36, v36, v146
    v_sub_f32 v37, v37, v146
    v_exp_f32 v152, v36
    v_exp_f32 v153, v37
    s_nop 0
    v_cvt_pk_bf16_f32 v98, v152, v153
    v_sub_f32 v38, v38, v146
    v_sub_f32 v39, v39, v146
    v_exp_f32 v152, v38
    v_exp_f32 v153, v39
    s_nop 0
    v_cvt_pk_bf16_f32 v99, v152, v153
    s_nop 1
    v_mfma_f32_16x16x32_bf16 v[128:131], v[24:27], v[96:99], 0
    v_max3_f32 v144, v40, v41, v42
    v_max3_f32 v144, v144, v43, v44
    v_max3_f32 v144, v144, v45, v46
    v_max_f32 v144, v144, v47
    v_mov_b32 v145, v144
    s_nop 1
    v_permlane32_swap_b32 v145, v144
    v_max_f32 v144, v144, v145
    v_mov_b32 v145, v144
    s_nop 1
    v_permlane16_swap_b32 v145, v144
    v_max_f32 v144, v144, v145
    v_max_f32 v146, 0, v144
    v_sub_f32 v17, v17, v146
    v_sub_f32 v147, 0, v146
    v_exp_f32 v147, v147
    s_nop 0
    v_mul_f32 v21, v21, v147
    v_mul_f32 v208, v208, v147
    v_mul_f32 v209, v209, v147
    v_mul_f32 v210, v210, v147
    v_mul_f32 v211, v211, v147
    v_mul_f32 v212, v212, v147
    v_mul_f32 v213, v213, v147
    v_mul_f32 v214, v214, v147
    v_mul_f32 v215, v215, v147
    v_mul_f32 v216, v216, v147
    v_mul_f32 v217, v217, v147
    v_mul_f32 v218, v218, v147
    v_mul_f32 v219, v219, v147
    v_mul_f32 v220, v220, v147
    v_mul_f32 v221, v221, v147
    v_mul_f32 v222, v222, v147
    v_mul_f32 v223, v223, v147
    v_mul_f32 v224, v224, v147
    v_mul_f32 v225, v225, v147
    v_mul_f32 v226, v226, v147
    v_mul_f32 v227, v227, v147
    v_mul_f32 v228, v228, v147
    v_mul_f32 v229, v229, v147
    v_mul_f32 v230, v230, v147
    v_mul_f32 v231, v231, v147
    v_mul_f32 v232, v232, v147
    v_mul_f32 v233, v233, v147
    v_mul_f32 v234, v234, v147
    v_mul_f32 v235, v235, v147
    v_mul_f32 v236, v236, v147
    v_mul_f32 v237, v237, v147
    v_mul_f32 v238, v238, v147
    v_mul_f32 v239, v239, v147
    v_mul_f32 v240, v240, v147
    v_mul_f32 v241, v241, v147
    v_mul_f32 v242, v242, v147
    v_mul_f32 v243, v243, v147
    v_mul_f32 v244, v244, v147
    v_mul_f32 v245, v245, v147
    v_mul_f32 v246, v246, v147
    v_mul_f32 v247, v247, v147
    v_mul_f32 v248, v248, v147
    v_mul_f32 v249, v249, v147
    v_mul_f32 v250, v250, v147
    v_mul_f32 v251, v251, v147
    v_mul_f32 v252, v252, v147
    v_mul_f32 v253, v253, v147
    v_mul_f32 v254, v254, v147
    v_mul_f32 v255, v255, v147
    v_sub_f32 v40, v40, v146
    v_sub_f32 v41, v41, v146
    v_exp_f32 v152, v40
    v_exp_f32 v153, v41
    s_nop 0
    v_cvt_pk_bf16_f32 v100, v152, v153
    v_sub_f32 v42, v42, v146
    v_sub_f32 v43, v43, v146
    v_exp_f32 v152, v42
    v_exp_f32 v153, v43
    s_nop 0
    v_cvt_pk_bf16_f32 v101, v152, v153
    v_sub_f32 v44, v44, v146
    v_sub_f32 v45, v45, v146
    v_exp_f32 v152, v44
    v_exp_f32 v153, v45
    s_nop 0
    v_cvt_pk_bf16_f32 v102, v152, v153
    v_sub_f32 v46, v46, v146
    v_sub_f32 v47, v47, v146
    v_exp_f32 v152, v46
    v_exp_f32 v153, v47
    s_nop 0
    v_cvt_pk_bf16_f32 v103, v152, v153
    s_nop 1
    v_mfma_f32_16x16x32_bf16 v[132:135], v[24:27], v[100:103], 0
    v_max3_f32 v144, v48, v49, v50
    v_max3_f32 v144, v144, v51, v52
    v_max3_f32 v144, v144, v53, v54
    v_max_f32 v144, v144, v55
    v_mov_b32 v145, v144
    s_nop 1
    v_permlane32_swap_b32 v145, v144
    v_max_f32 v144, v144, v145
    v_mov_b32 v145, v144
    s_nop 1
    v_permlane16_swap_b32 v145, v144
    v_max_f32 v144, v144, v145
    v_max_f32 v146, 0, v144
    v_sub_f32 v18, v18, v146
    v_sub_f32 v147, 0, v146
    v_exp_f32 v147, v147
    s_nop 0
    v_mul_f32 v22, v22, v147
    v_accvgpr_read_b32 v148, a0
    v_accvgpr_read_b32 v149, a1
    v_accvgpr_read_b32 v150, a2
    v_accvgpr_read_b32 v151, a3
    v_mul_f32 v148, v148, v147
    v_mul_f32 v149, v149, v147
    v_mul_f32 v150, v150, v147
    v_mul_f32 v151, v151, v147
    v_accvgpr_write_b32 a0, v148
    v_accvgpr_write_b32 a1, v149
    v_accvgpr_write_b32 a2, v150
    v_accvgpr_write_b32 a3, v151
    v_accvgpr_read_b32 v148, a4
    v_accvgpr_read_b32 v149, a5
    v_accvgpr_read_b32 v150, a6
    v_accvgpr_read_b32 v151, a7
    v_mul_f32 v148, v148, v147
    v_mul_f32 v149, v149, v147
    v_mul_f32 v150, v150, v147
    v_mul_f32 v151, v151, v147
    v_accvgpr_write_b32 a4, v148
    v_accvgpr_write_b32 a5, v149
    v_accvgpr_write_b32 a6, v150
    v_accvgpr_write_b32 a7, v151
    v_accvgpr_read_b32 v148, a8
    v_accvgpr_read_b32 v149, a9
    v_accvgpr_read_b32 v150, a10
    v_accvgpr_read_b32 v151, a11
    v_mul_f32 v148, v148, v147
    v_mul_f32 v149, v149, v147
    v_mul_f32 v150, v150, v147
    v_mul_f32 v151, v151, v147
    v_accvgpr_write_b32 a8, v148
    v_accvgpr_write_b32 a9, v149
    v_accvgpr_write_b32 a10, v150
    v_accvgpr_write_b32 a11, v151
    v_accvgpr_read_b32 v148, a12
    v_accvgpr_read_b32 v149, a13
    v_accvgpr_read_b32 v150, a14
    v_accvgpr_read_b32 v151, a15
    v_mul_f32 v148, v148, v147
    v_mul_f32 v149, v149, v147
    v_mul_f32 v150, v150, v147
    v_mul_f32 v151, v151, v147
    v_accvgpr_write_b32 a12, v148
    v_accvgpr_write_b32 a13, v149
    v_accvgpr_write_b32 a14, v150
    v_accvgpr_write_b32 a15, v151
    v_accvgpr_read_b32 v148, a16
    v_accvgpr_read_b32 v149, a17
    v_accvgpr_read_b32 v150, a18
    v_accvgpr_read_b32 v151, a19
    v_mul_f32 v148, v148, v147
    v_mul_f32 v149, v149, v147
    v_mul_f32 v150, v150, v147
    v_mul_f32 v151, v151, v147
    v_accvgpr_write_b32 a16, v148
    v_accvgpr_write_b32 a17, v149
    v_accvgpr_write_b32 a18, v150
    v_accvgpr_write_b32 a19, v151
    v_accvgpr_read_b32 v148, a20
    v_accvgpr_read_b32 v149, a21
    v_accvgpr_read_b32 v150, a22
    v_accvgpr_read_b32 v151, a23
    v_mul_f32 v148, v148, v147
    v_mul_f32 v149, v149, v147
    v_mul_f32 v150, v150, v147
    v_mul_f32 v151, v151, v147
    v_accvgpr_write_b32 a20, v148
    v_accvgpr_write_b32 a21, v149
    v_accvgpr_write_b32 a22, v150
    v_accvgpr_write_b32 a23, v151
    v_accvgpr_read_b32 v148, a24
    v_accvgpr_read_b32 v149, a25
    v_accvgpr_read_b32 v150, a26
    v_accvgpr_read_b32 v151, a27
    v_mul_f32 v148, v148, v147
    v_mul_f32 v149, v149, v147
    v_mul_f32 v150, v150, v147
    v_mul_f32 v151, v151, v147
    v_accvgpr_write_b32 a24, v148
    v_accvgpr_write_b32 a25, v149
    v_accvgpr_write_b32 a26, v150
    v_accvgpr_write_b32 a27, v151
    v_accvgpr_read_b32 v148, a28
    v_accvgpr_read_b32 v149, a29
    v_accvgpr_read_b32 v150, a30
    v_accvgpr_read_b32 v151, a31
    v_mul_f32 v148, v148, v147
    v_mul_f32 v149, v149, v147
    v_mul_f32 v150, v150, v147
    v_mul_f32 v151, v151, v147
    v_accvgpr_write_b32 a28, v148
    v_accvgpr_write_b32 a29, v149
    v_accvgpr_write_b32 a30, v150
    v_accvgpr_write_b32 a31, v151
    v_accvgpr_read_b32 v148, a32
    v_accvgpr_read_b32 v149, a33
    v_accvgpr_read_b32 v150, a34
    v_accvgpr_read_b32 v151, a35
    v_mul_f32 v148, v148, v147
    v_mul_f32 v149, v149, v147
    v_mul_f32 v150, v150, v147
    v_mul_f32 v151, v151, v147
    v_accvgpr_write_b32 a32, v148
    v_accvgpr_write_b32 a33, v149
    v_accvgpr_write_b32 a34, v150
    v_accvgpr_write_b32 a35, v151
    v_accvgpr_read_b32 v148, a36
    v_accvgpr_read_b32 v149, a37
    v_accvgpr_read_b32 v150, a38
    v_accvgpr_read_b32 v151, a39
    v_mul_f32 v148, v148, v147
    v_mul_f32 v149, v149, v147
    v_mul_f32 v150, v150, v147
    v_mul_f32 v151, v151, v147
    v_accvgpr_write_b32 a36, v148
    v_accvgpr_write_b32 a37, v149
    v_accvgpr_write_b32 a38, v150
    v_accvgpr_write_b32 a39, v151
    v_accvgpr_read_b32 v148, a40
    v_accvgpr_read_b32 v149, a41
    v_accvgpr_read_b32 v150, a42
    v_accvgpr_read_b32 v151, a43
    v_mul_f32 v148, v148, v147
    v_mul_f32 v149, v149, v147
    v_mul_f32 v150, v150, v147
    v_mul_f32 v151, v151, v147
    v_accvgpr_write_b32 a40, v148
    v_accvgpr_write_b32 a41, v149
    v_accvgpr_write_b32 a42, v150
    v_accvgpr_write_b32 a43, v151
    v_accvgpr_read_b32 v148, a44
    v_accvgpr_read_b32 v149, a45
    v_accvgpr_read_b32 v150, a46
    v_accvgpr_read_b32 v151, a47
    v_mul_f32 v148, v148, v147
    v_mul_f32 v149, v149, v147
    v_mul_f32 v150, v150, v147
    v_mul_f32 v151, v151, v147
    v_accvgpr_write_b32 a44, v148
    v_accvgpr_write_b32 a45, v149
    v_accvgpr_write_b32 a46, v150
    v_accvgpr_write_b32 a47, v151
    v_sub_f32 v48, v48, v146
    v_sub_f32 v49, v49, v146
    v_exp_f32 v152, v48
    v_exp_f32 v153, v49
    s_nop 0
    v_cvt_pk_bf16_f32 v104, v152, v153
    v_sub_f32 v50, v50, v146
    v_sub_f32 v51, v51, v146
    v_exp_f32 v152, v50
    v_exp_f32 v153, v51
    s_nop 0
    v_cvt_pk_bf16_f32 v105, v152, v153
    v_sub_f32 v52, v52, v146
    v_sub_f32 v53, v53, v146
    v_exp_f32 v152, v52
    v_exp_f32 v153, v53
    s_nop 0
    v_cvt_pk_bf16_f32 v106, v152, v153
    v_sub_f32 v54, v54, v146
    v_sub_f32 v55, v55, v146
    v_exp_f32 v152, v54
    v_exp_f32 v153, v55
    s_nop 0
    v_cvt_pk_bf16_f32 v107, v152, v153
    s_nop 1
    v_mfma_f32_16x16x32_bf16 v[136:139], v[24:27], v[104:107], 0
    s_nop 15
    s_setpc_b64 s[44:45]
L_rare3_1:
    s_nop 15
    v_max3_f32 v144, v64, v65, v66
    v_max3_f32 v144, v144, v67, v68
    v_max3_f32 v144, v144, v69, v70
    v_max_f32 v144, v144, v71
    v_mov_b32 v145, v144
    s_nop 1
    v_permlane32_swap_b32 v145, v144
    v_max_f32 v144, v144, v145
    v_mov_b32 v145, v144
    s_nop 1
    v_permlane16_swap_b32 v145, v144
    v_max_f32 v144, v144, v145
    v_max_f32 v146, 0, v144
    v_sub_f32 v16, v16, v146
    v_sub_f32 v147, 0, v146
    v_exp_f32 v147, v147
    s_nop 0
    v_mul_f32 v20, v20, v147
    v_mul_f32 v160, v160, v147
    v_mul_f32 v161, v161, v147
    v_mul_f32 v162, v162, v147
    v_mul_f32 v163, v163, v147
    v_mul_f32 v164, v164, v147
    v_mul_f32 v165, v165, v147
    v_mul_f32 v166, v166, v147
    v_mul_f32 v167, v167, v147
    v_mul_f32 v168, v168, v147
    v_mul_f32 v169, v169, v147
    v_mul_f32 v170, v170, v147
    v_mul_f32 v171, v171, v147
    v_mul_f32 v172, v172, v147
    v_mul_f32 v173, v173, v147
    v_mul_f32 v174, v174, v147
    v_mul_f32 v175, v175, v147
    v_mul_f32 v176, v176, v147
    v_mul_f32 v177, v177, v147
    v_mul_f32 v178, v178, v147
    v_mul_f32 v179, v179, v147
    v_mul_f32 v180, v180, v147
    v_mul_f32 v181, v181, v147
    v_mul_f32 v182, v182, v147
    v_mul_f32 v183, v183, v147
    v_mul_f32 v184, v184, v147
    v_mul_f32 v185, v185, v147
    v_mul_f32 v186, v186, v147
    v_mul_f32 v187, v187, v147
    v_mul_f32 v188, v188, v147
    v_mul_f32 v189, v189, v147
    v_mul_f32 v190, v190, v147
    v_mul_f32 v191, v191, v147
    v_mul_f32 v192, v192, v147
    v_mul_f32 v193, v193, v147
    v_mul_f32 v194, v194, v147
    v_mul_f32 v195, v195, v147
    v_mul_f32 v196, v196, v147
    v_mul_f32 v197, v197, v147
    v_mul_f32 v198, v198, v147
    v_mul_f32 v199, v199, v147
    v_mul_f32 v200, v200, v147
    v_mul_f32 v201, v201, v147
    v_mul_f32 v202, v202, v147
    v_mul_f32 v203, v203, v147
    v_mul_f32 v204, v204, v147
    v_mul_f32 v205, v205, v147
    v_mul_f32 v206, v206, v147
    v_mul_f32 v207, v207, v147
    v_sub_f32 v64, v64, v146
    v_sub_f32 v65, v65, v146
    v_exp_f32 v152, v64
    v_exp_f32 v153, v65
    s_nop 0
    v_cvt_pk_bf16_f32 v112, v152, v153
    v_sub_f32 v66, v66, v146
    v_sub_f32 v67, v67, v146
    v_exp_f32 v152, v66
    v_exp_f32 v153, v67
    s_nop 0
    v_cvt_pk_bf16_f32 v113, v152, v153
    v_sub_f32 v68, v68, v146
    v_sub_f32 v69, v69, v146
    v_exp_f32 v152, v68
    v_exp_f32 v153, v69
    s_nop 0
    v_cvt_pk_bf16_f32 v114, v152, v153
    v_sub_f32 v70, v70, v146
    v_sub_f32 v71, v71, v146
    v_exp_f32 v152, v70
    v_exp_f32 v153, v71
    s_nop 0
    v_cvt_pk_bf16_f32 v115, v152, v153
    s_nop 1
    v_mfma_f32_16x16x32_bf16 v[128:131], v[24:27], v[112:115], 0
    v_max3_f32 v144, v72, v73, v74
    v_max3_f32 v144, v144, v75, v76
    v_max3_f32 v144, v144, v77, v78
    v_max_f32 v144, v144, v79
    v_mov_b32 v145, v144
    s_nop 1
    v_permlane32_swap_b32 v145, v144
    v_max_f32 v144, v144, v145
    v_mov_b32 v145, v144
    s_nop 1
    v_permlane16_swap_b32 v145, v144
    v_max_f32 v144, v144, v145
    v_max_f32 v146, 0, v144
    v_sub_f32 v17, v17, v146
    v_sub_f32 v147, 0, v146
    v_exp_f32 v147, v147
    s_nop 0
    v_mul_f32 v21, v21, v147
    v_mul_f32 v208, v208, v147
    v_mul_f32 v209, v209, v147
    v_mul_f32 v210, v210, v147
    v_mul_f32 v211, v211, v147
    v_mul_f32 v212, v212, v147
    v_mul_f32 v213, v213, v147
    v_mul_f32 v214, v214, v147
    v_mul_f32 v215, v215, v147
    v_mul_f32 v216, v216, v147
    v_mul_f32 v217, v217, v147
    v_mul_f32 v218, v218, v147
    v_mul_f32 v219, v219, v147
    v_mul_f32 v220, v220, v147
    v_mul_f32 v221, v221, v147
    v_mul_f32 v222, v222, v147
    v_mul_f32 v223, v223, v147
    v_mul_f32 v224, v224, v147
    v_mul_f32 v225, v225, v147
    v_mul_f32 v226, v226, v147
    v_mul_f32 v227, v227, v147
    v_mul_f32 v228, v228, v147
    v_mul_f32 v229, v229, v147
    v_mul_f32 v230, v230, v147
    v_mul_f32 v231, v231, v147
    v_mul_f32 v232, v232, v147
    v_mul_f32 v233, v233, v147
    v_mul_f32 v234, v234, v147
    v_mul_f32 v235, v235, v147
    v_mul_f32 v236, v236, v147
    v_mul_f32 v237, v237, v147
    v_mul_f32 v238, v238, v147
    v_mul_f32 v239, v239, v147
    v_mul_f32 v240, v240, v147
    v_mul_f32 v241, v241, v147
    v_mul_f32 v242, v242, v147
    v_mul_f32 v243, v243, v147
    v_mul_f32 v244, v244, v147
    v_mul_f32 v245, v245, v147
    v_mul_f32 v246, v246, v147
    v_mul_f32 v247, v247, v147
    v_mul_f32 v248, v248, v147
    v_mul_f32 v249, v249, v147
    v_mul_f32 v250, v250, v147
    v_mul_f32 v251, v251, v147
    v_mul_f32 v252, v252, v147
    v_mul_f32 v253, v253, v147
    v_mul_f32 v254, v254, v147
    v_mul_f32 v255, v255, v147
    v_sub_f32 v72, v72, v146
    v_sub_f32 v73, v73, v146
    v_exp_f32 v152, v72
    v_exp_f32 v153, v73
    s_nop 0
    v_cvt_pk_bf16_f32 v116, v152, v153
    v_sub_f32 v74, v74, v146
    v_sub_f32 v75, v75, v146
    v_exp_f32 v152, v74
    v_exp_f32 v153, v75
    s_nop 0
    v_cvt_pk_bf16_f32 v117, v152, v153
    v_sub_f32 v76, v76, v146
    v_sub_f32 v77, v77, v146
    v_exp_f32 v152, v76
    v_exp_f32 v153, v77
    s_nop 0
    v_cvt_pk_bf16_f32 v118, v152, v153
    v_sub_f32 v78, v78, v146
    v_sub_f32 v79, v79, v146
    v_exp_f32 v152, v78
    v_exp_f32 v153, v79
    s_nop 0
    v_cvt_pk_bf16_f32 v119, v152, v153
    s_nop 1
    v_mfma_f32_16x16x32_bf16 v[132:135], v[24:27], v[116:119], 0
    v_max3_f32 v144, v80, v81, v82
    v_max3_f32 v144, v144, v83, v84
    v_max3_f32 v144, v144, v85, v86
    v_max_f32 v144, v144, v87
    v_mov_b32 v145, v144
    s_nop 1
    v_permlane32_swap_b32 v145, v144
    v_max_f32 v144, v144, v145
    v_mov_b32 v145, v144
    s_nop 1
    v_permlane16_swap_b32 v145, v144
    v_max_f32 v144, v144, v145
    v_max_f32 v146, 0, v144
    v_sub_f32 v18, v18, v146
    v_sub_f32 v147, 0, v146
    v_exp_f32 v147, v147
    s_nop 0
    v_mul_f32 v22, v22, v147
    v_accvgpr_read_b32 v148, a0
    v_accvgpr_read_b32 v149, a1
    v_accvgpr_read_b32 v150, a2
    v_accvgpr_read_b32 v151, a3
    v_mul_f32 v148, v148, v147
    v_mul_f32 v149, v149, v147
    v_mul_f32 v150, v150, v147
    v_mul_f32 v151, v151, v147
    v_accvgpr_write_b32 a0, v148
    v_accvgpr_write_b32 a1, v149
    v_accvgpr_write_b32 a2, v150
    v_accvgpr_write_b32 a3, v151
    v_accvgpr_read_b32 v148, a4
    v_accvgpr_read_b32 v149, a5
    v_accvgpr_read_b32 v150, a6
    v_accvgpr_read_b32 v151, a7
    v_mul_f32 v148, v148, v147
    v_mul_f32 v149, v149, v147
    v_mul_f32 v150, v150, v147
    v_mul_f32 v151, v151, v147
    v_accvgpr_write_b32 a4, v148
    v_accvgpr_write_b32 a5, v149
    v_accvgpr_write_b32 a6, v150
    v_accvgpr_write_b32 a7, v151
    v_accvgpr_read_b32 v148, a8
    v_accvgpr_read_b32 v149, a9
    v_accvgpr_read_b32 v150, a10
    v_accvgpr_read_b32 v151, a11
    v_mul_f32 v148, v148, v147
    v_mul_f32 v149, v149, v147
    v_mul_f32 v150, v150, v147
    v_mul_f32 v151, v151, v147
    v_accvgpr_write_b32 a8, v148
    v_accvgpr_write_b32 a9, v149
    v_accvgpr_write_b32 a10, v150
    v_accvgpr_write_b32 a11, v151
    v_accvgpr_read_b32 v148, a12
    v_accvgpr_read_b32 v149, a13
    v_accvgpr_read_b32 v150, a14
    v_accvgpr_read_b32 v151, a15
    v_mul_f32 v148, v148, v147
    v_mul_f32 v149, v149, v147
    v_mul_f32 v150, v150, v147
    v_mul_f32 v151, v151, v147
    v_accvgpr_write_b32 a12, v148
    v_accvgpr_write_b32 a13, v149
    v_accvgpr_write_b32 a14, v150
    v_accvgpr_write_b32 a15, v151
    v_accvgpr_read_b32 v148, a16
    v_accvgpr_read_b32 v149, a17
    v_accvgpr_read_b32 v150, a18
    v_accvgpr_read_b32 v151, a19
    v_mul_f32 v148, v148, v147
    v_mul_f32 v149, v149, v147
    v_mul_f32 v150, v150, v147
    v_mul_f32 v151, v151, v147
    v_accvgpr_write_b32 a16, v148
    v_accvgpr_write_b32 a17, v149
    v_accvgpr_write_b32 a18, v150
    v_accvgpr_write_b32 a19, v151
    v_accvgpr_read_b32 v148, a20
    v_accvgpr_read_b32 v149, a21
    v_accvgpr_read_b32 v150, a22
    v_accvgpr_read_b32 v151, a23
    v_mul_f32 v148, v148, v147
    v_mul_f32 v149, v149, v147
    v_mul_f32 v150, v150, v147
    v_mul_f32 v151, v151, v147
    v_accvgpr_write_b32 a20, v148
    v_accvgpr_write_b32 a21, v149
    v_accvgpr_write_b32 a22, v150
    v_accvgpr_write_b32 a23, v151
    v_accvgpr_read_b32 v148, a24
    v_accvgpr_read_b32 v149, a25
    v_accvgpr_read_b32 v150, a26
    v_accvgpr_read_b32 v151, a27
    v_mul_f32 v148, v148, v147
    v_mul_f32 v149, v149, v147
    v_mul_f32 v150, v150, v147
    v_mul_f32 v151, v151, v147
    v_accvgpr_write_b32 a24, v148
    v_accvgpr_write_b32 a25, v149
    v_accvgpr_write_b32 a26, v150
    v_accvgpr_write_b32 a27, v151
    v_accvgpr_read_b32 v148, a28
    v_accvgpr_read_b32 v149, a29
    v_accvgpr_read_b32 v150, a30
    v_accvgpr_read_b32 v151, a31
    v_mul_f32 v148, v148, v147
    v_mul_f32 v149, v149, v147
    v_mul_f32 v150, v150, v147
    v_mul_f32 v151, v151, v147
    v_accvgpr_write_b32 a28, v148
    v_accvgpr_write_b32 a29, v149
    v_accvgpr_write_b32 a30, v150
    v_accvgpr_write_b32 a31, v151
    v_accvgpr_read_b32 v148, a32
    v_accvgpr_read_b32 v149, a33
    v_accvgpr_read_b32 v150, a34
    v_accvgpr_read_b32 v151, a35
    v_mul_f32 v148, v148, v147
    v_mul_f32 v149, v149, v147
    v_mul_f32 v150, v150, v147
    v_mul_f32 v151, v151, v147
    v_accvgpr_write_b32 a32, v148
    v_accvgpr_write_b32 a33, v149
    v_accvgpr_write_b32 a34, v150
    v_accvgpr_write_b32 a35, v151
    v_accvgpr_read_b32 v148, a36
    v_accvgpr_read_b32 v149, a37
    v_accvgpr_read_b32 v150, a38
    v_accvgpr_read_b32 v151, a39
    v_mul_f32 v148, v148, v147
    v_mul_f32 v149, v149, v147
    v_mul_f32 v150, v150, v147
    v_mul_f32 v151, v151, v147
    v_accvgpr_write_b32 a36, v148
    v_accvgpr_write_b32 a37, v149
    v_accvgpr_write_b32 a38, v150
    v_accvgpr_write_b32 a39, v151
    v_accvgpr_read_b32 v148, a40
    v_accvgpr_read_b32 v149, a41
    v_accvgpr_read_b32 v150, a42
    v_accvgpr_read_b32 v151, a43
    v_mul_f32 v148, v148, v147
    v_mul_f32 v149, v149, v147
    v_mul_f32 v150, v150, v147
    v_mul_f32 v151, v151, v147
    v_accvgpr_write_b32 a40, v148
    v_accvgpr_write_b32 a41, v149
    v_accvgpr_write_b32 a42, v150
    v_accvgpr_write_b32 a43, v151
    v_accvgpr_read_b32 v148, a44
    v_accvgpr_read_b32 v149, a45
    v_accvgpr_read_b32 v150, a46
    v_accvgpr_read_b32 v151, a47
    v_mul_f32 v148, v148, v147
    v_mul_f32 v149, v149, v147
    v_mul_f32 v150, v150, v147
    v_mul_f32 v151, v151, v147
    v_accvgpr_write_b32 a44, v148
    v_accvgpr_write_b32 a45, v149
    v_accvgpr_write_b32 a46, v150
    v_accvgpr_write_b32 a47, v151
    v_sub_f32 v80, v80, v146
    v_sub_f32 v81, v81, v146
    v_exp_f32 v152, v80
    v_exp_f32 v153, v81
    s_nop 0
    v_cvt_pk_bf16_f32 v120, v152, v153
    v_sub_f32 v82, v82, v146
    v_sub_f32 v83, v83, v146
    v_exp_f32 v152, v82
    v_exp_f32 v153, v83
    s_nop 0
    v_cvt_pk_bf16_f32 v121, v152, v153
    v_sub_f32 v84, v84, v146
    v_sub_f32 v85, v85, v146
    v_exp_f32 v152, v84
    v_exp_f32 v153, v85
    s_nop 0
    v_cvt_pk_bf16_f32 v122, v152, v153
    v_sub_f32 v86, v86, v146
    v_sub_f32 v87, v87, v146
    v_exp_f32 v152, v86
    v_exp_f32 v153, v87
    s_nop 0
    v_cvt_pk_bf16_f32 v123, v152, v153
    s_nop 1
    v_mfma_f32_16x16x32_bf16 v[136:139], v[24:27], v[120:123], 0
    s_nop 15
    s_setpc_b64 s[44:45]
L_rs_start4a:
    s_call_b64 s[44:45], L_rare4_1
    s_branch L_ret_start4a
L_rs_start4b:
    s_call_b64 s[44:45], L_rare4_0
    s_branch L_ret_start4b
L_rs_loop4w0a:
    s_call_b64 s[44:45], L_rare4_1
    s_branch L_ret_loop4w0a
L_rs_loop4w0b:
    s_call_b64 s[44:45], L_rare4_0
    s_branch L_ret_loop4w0b
L_rs_loop4w1a:
    s_call_b64 s[44:45], L_rare4_1
    s_branch L_ret_loop4w1a
L_rs_loop4w1b:
    s_call_b64 s[44:45], L_rare4_0
    s_branch L_ret_loop4w1b
L_rs_end4:
    s_call_b64 s[44:45], L_rare4_1
    s_branch L_ret_end4
L_rs_start3a:
    s_call_b64 s[44:45], L_rare3_1
    s_branch L_ret_start3a
L_rs_start3b:
    s_call_b64 s[44:45], L_rare3_0
    s_branch L_ret_start3b
L_rs_loop3w0a:
    s_call_b64 s[44:45], L_rare3_1
    s_branch L_ret_loop3w0a
L_rs_loop3w0b:
    s_call_b64 s[44:45], L_rare3_0
    s_branch L_ret_loop3w0b
L_rs_loop3w1a:
    s_call_b64 s[44:45], L_rare3_1
    s_branch L_ret_loop3w1a
L_rs_loop3w1b:
    s_call_b64 s[44:45], L_rare3_0
    s_branch L_ret_loop3w1b
L_rs_end3:
    s_call_b64 s[44:45], L_rare3_1
    s_branch L_ret_end3
L_rs_tr43A:
    s_call_b64 s[44:45], L_rare4_1
    s_branch L_ret_tr43A
L_rs_tr43a:
    s_call_b64 s[44:45], L_rare3_1
    s_branch L_ret_tr43a
L_rs_tr43b:
    s_call_b64 s[44:45], L_rare3_0
    s_branch L_ret_tr43b
L_rs_tr34A:
    s_call_b64 s[44:45], L_rare3_1
    s_branch L_ret_tr34A
L_rs_tr34a:
    s_call_b64 s[44:45], L_rare4_1
    s_branch L_ret_tr34a
L_rs_tr34b:
    s_call_b64 s[44:45], L_rare4_0
    s_branch L_ret_tr34b
L_rs_tr33A:
    s_call_b64 s[44:45], L_rare3_1
    s_branch L_ret_tr33A
L_rs_tr33a:
    s_call_b64 s[44:45], L_rare3_1
    s_branch L_ret_tr33a
L_rs_tr33b:
    s_call_b64 s[44:45], L_rare3_0
    s_branch L_ret_tr33b
L_rs_tr44A:
    s_call_b64 s[44:45], L_rare4_1
    s_branch L_ret_tr44A
L_rs_tr44a:
    s_call_b64 s[44:45], L_rare4_1
    s_branch L_ret_tr44a
L_rs_tr44b:
    s_call_b64 s[44:45], L_rare4_0
    s_branch L_ret_tr44b
L_codeend:
.section .rodata,"a"
.p2align 6
.amdhsa_kernel standalone__gqa_softmax__near_ridge_kernel
  .amdhsa_next_free_vgpr 512
  .amdhsa_next_free_sgpr 102
  .amdhsa_accum_offset 256
  .amdhsa_group_segment_fixed_size 0
  .amdhsa_kernarg_size 48
  .amdhsa_user_sgpr_count 2
  .amdhsa_user_sgpr_kernarg_segment_ptr 1
  .amdhsa_system_sgpr_workgroup_id_x 1
.end_amdhsa_kernel
```

```asm
; @launch grid=(256,1,1) block=(256,1,1) lds=163840
.amdgcn_target "amdgcn-amd-amdhsa--gfx950"
.text
.globl standalone__gqa_softmax__near_ridge_kernel
.p2align 8
.type standalone__gqa_softmax__near_ridge_kernel,@function
standalone__gqa_softmax__near_ridge_kernel:
s_cmp_ge_u32 s2,256
s_cbranch_scc1 L_end
s_load_dwordx4 s[84:87],s[0:1],0
s_load_dwordx4 s[88:91],s[0:1],16
v_lshrrev_b32 v30,6,v0
v_and_b32 v0,63,v0
v_readfirstlane_b32 s3,v30
s_getpc_b64 s[92:93]
L_pc:
s_lshr_b32 s62,s2,3
s_mul_i32 s62,s62,3584
v_min_u32 v144,27,v0
v_lshlrev_b32 v144,7,v144
v_add_u32 v144,s62,v144
v_min_u32 v144,L_codeend-L_pc-4,v144
s_cmp_lg_u32 s3,0
s_cbranch_scc1 L_nopre
global_load_dword v23,v144,s[92:93]
L_nopre:
v_lshrrev_b32 v144,3,v0
v_mul_u32_u24 v8,384,v144
v_and_b32 v145,6,v144
v_and_b32 v146,7,v0
v_xor_b32 v145,v145,v146
v_lshl_add_u32 v8,v145,4,v8
s_and_b32 s62,s3,1
s_mul_i32 s62,s62,80
v_xor_b32 v9,80,v8
v_xor_b32 v7,s62,v8
v_mov_b32 v31,0x5d800000
s_mov_b32 s36,0x3dd53b95
s_mov_b32 s31,0
s_mov_b32 s32,1
s_and_b32 s62,s2,7
s_lshr_b32 s63,s2,3
s_and_b32 s49,s63,3
s_lshr_b32 s43,s63,2
s_lshl_b32 s62,s62,3
s_add_u32 s62,s62,s43
s_lshl_b32 s64,s62,3
s_mul_i32 s34,s64,196608
s_mul_i32 s33,s64,325632
s_mov_b32 s48,s33
s_mul_i32 s22,s3,3072
s_add_u32 s23,s22,36864
s_mul_i32 s24,s3,22528
s_add_u32 s24,s24,73728
s_add_u32 s20,s34,s22
s_mov_b32 s21,s20
s_mov_b32 s69,0
s_mov_b32 s62,0xaac3d274
s_mov_b32 s63,0xac39aac3
s_cmp_ge_u32 s43,4
s_cselect_b32 s62,0xd4b2b2d4,s62
s_cselect_b32 s63,0xd274b4d1,s63
s_and_b32 s64,s43,3
s_lshl_b32 s64,s64,4
s_lshr_b64 s[62:63],s[62:63],s64
s_and_b32 s39,s62,0xffff
s_lshr_b32 s62,s39,s69
s_and_b32 s62,s62,1
s_lshl_b32 s62,s62,1
s_add_u32 s62,s62,s49
s_and_b32 s62,s62,3
s_add_u32 s63,s69,8
s_lshr_b32 s63,s39,s63
s_and_b32 s63,s63,1
s_xor_b32 s62,s62,s63
s_mul_i32 s63,s3,3
s_lshl_b32 s64,s3,2
s_mov_b32 s40,1
s_add_u32 s65,s63,17
s_cmp_eq_u32 s3,0
s_cselect_b32 s65,16,s65
s_cselect_b32 s41,1,0
s_cmp_eq_u32 s62,1
s_cselect_b32 s64,s65,s64
s_cselect_b32 s40,s41,s40
s_add_u32 s65,s63,29
s_cmp_eq_u32 s62,2
s_cselect_b32 s64,s65,s64
s_cselect_b32 s40,0,s40
s_add_u32 s65,s63,41
s_cmp_eq_u32 s62,3
s_cselect_b32 s64,s65,s64
s_cselect_b32 s40,0,s40
s_mul_i32 s64,s64,6144
s_add_u32 s41,s48,s64
s_waitcnt lgkmcnt(0)
s_mov_b32 s4,s86
s_and_b32 s5,s87,0xffff
s_mov_b32 s7,0x20000
s_mov_b32 s12,s84
s_and_b32 s13,s85,0xffff
s_mov_b32 s15,0x20000
s_mov_b32 s8,s88
s_and_b32 s9,s89,0xffff
s_mov_b32 s11,0x20000
s_mov_b32 s16,s90
s_and_b32 s17,s91,0xffff
s_mov_b32 s19,0x20000
s_add_u32 s6,s34,1572864
s_mov_b32 s10,s6
s_mov_b32 s14,166723584
s_mov_b32 s18,166723584
s_cmp_eq_u32 s40,0
s_cbranch_scc1 L_start3
L_start4:
s_add_u32 m0,s22,0
s_nop 0
buffer_load_dwordx4 v7,s[4:7],s20 offen offset:0 lds
s_add_u32 m0,s22,896
s_nop 0
buffer_load_dwordx4 v7,s[4:7],s20 offen offset:128 lds
s_add_u32 m0,s22,1792
s_nop 0
buffer_load_dwordx4 v7,s[4:7],s20 offen offset:256 lds
s_add_u32 s20,s20,12288
s_mov_b32 s28,s41
s_add_u32 m0,s24,0
s_nop 0
buffer_load_dwordx4 v8,s[12:15],s28 offen offset:0 nt lds
s_add_u32 m0,s24,896
s_nop 0
buffer_load_dwordx4 v8,s[12:15],s28 offen offset:128 nt lds
s_add_u32 m0,s24,1792
s_nop 0
buffer_load_dwordx4 v8,s[12:15],s28 offen offset:256 nt lds
s_add_u32 s28,s28,3072
s_add_u32 m0,s24,3072
s_nop 0
buffer_load_dwordx4 v9,s[12:15],s28 offen offset:0 nt lds
s_add_u32 m0,s24,3968
s_nop 0
buffer_load_dwordx4 v9,s[12:15],s28 offen offset:128 nt lds
s_add_u32 m0,s24,4864
s_nop 0
buffer_load_dwordx4 v9,s[12:15],s28 offen offset:256 nt lds
s_add_u32 s28,s28,3072
s_add_u32 m0,s24,6144
s_nop 0
buffer_load_dwordx4 v8,s[12:15],s28 offen offset:0 nt lds
s_add_u32 m0,s24,7040
s_nop 0
buffer_load_dwordx4 v8,s[12:15],s28 offen offset:128 nt lds
s_add_u32 m0,s24,7936
s_nop 0
buffer_load_dwordx4 v8,s[12:15],s28 offen offset:256 nt lds
s_add_u32 s28,s28,3072
s_add_u32 m0,s24,9216
s_nop 0
buffer_load_dwordx4 v9,s[12:15],s28 offen offset:0 nt lds
s_add_u32 m0,s24,10112
s_nop 0
buffer_load_dwordx4 v9,s[12:15],s28 offen offset:128 nt lds
s_add_u32 m0,s24,11008
s_nop 0
buffer_load_dwordx4 v9,s[12:15],s28 offen offset:256 nt lds
s_add_u32 s28,s28,3072
v_and_b32 v144,15,v0
v_lshrrev_b32 v145,4,v0
v_lshrrev_b32 v146,3,v144
v_mul_u32_u24 v1,3072,v146
v_and_b32 v147,7,v144
v_lshl_add_u32 v1,v147,7,v1
v_bfe_u32 v147,v144,1,2
v_lshlrev_b32 v147,1,v147
v_mul_u32_u24 v148,5,v146
v_xor_b32 v147,v147,v148
v_xor_b32 v147,v147,v145
v_lshl_add_u32 v1,v147,4,v1
v_xor_b32 v2,64,v1
v_mul_u32_u24 v148,19456,v146
v_add_u32 v148,92160,v148
v_add_u32 v13,v148,v1
v_add_u32 v28,s24,v1
v_add_u32 v14,v148,v2
v_add_u32 v29,s24,v2
v_lshrrev_b32 v146,1,v145
v_mul_u32_u24 v3,3072,v146
v_and_b32 v147,1,v145
v_bfe_u32 v148,v0,2,2
v_lshl_add_u32 v144,v147,2,v148
v_lshl_add_u32 v3,v144,7,v3
v_lshrrev_b32 v144,1,v144
v_lshlrev_b32 v144,1,v144
v_mul_u32_u24 v146,5,v146
v_xor_b32 v144,v144,v146
v_bfe_u32 v147,v0,1,1
v_xor_b32 v144,v144,v147
v_lshl_add_u32 v3,v144,4,v3
v_and_b32 v147,1,v0
v_lshl_add_u32 v3,v147,3,v3
v_add_u32 v3,36864,v3
v_xor_b32 v4,32,v3
v_xor_b32 v5,64,v3
v_xor_b32 v6,96,v3
v_lshrrev_b32 v144,3,v0
v_and_b32 v145,7,v0
v_lshrrev_b32 v147,5,v0
v_xor_b32 v147,v147,v145
v_lshlrev_b32 v12,7,v145
v_lshl_add_u32 v12,v147,4,v12
v_bfe_u32 v146,v0,4,1
v_lshl_add_u32 v12,v146,3,v12
v_bfe_u32 v146,v0,3,1
v_mul_u32_u24 v146,3072,v146
v_add3_u32 v12,v12,v146,s24
v_xor_b32 v20,32,v12
v_xor_b32 v21,64,v12
v_xor_b32 v22,96,v12
v_xor_b32 v146,v145,v144
v_lshlrev_b32 v15,7,v144
v_lshl_add_u32 v15,v146,4,v15
v_add_u32 v15,s24,v15
v_mov_b32 v11,v15
v_mul_u32_u24 v10,384,v144
v_lshl_add_u32 v10,v145,4,v10
v_mov_b32 v24,0x3f803f80
v_mov_b32 v25,0x3f803f80
v_mov_b32 v26,0x3f803f80
v_mov_b32 v27,0x3f803f80
s_waitcnt vmcnt(12)
s_barrier
ds_read_b128 a[192:195],v1 offset:0
ds_read_b128 a[196:199],v2 offset:0
ds_read_b128 a[200:203],v1 offset:1024
ds_read_b128 a[204:207],v2 offset:1024
ds_read_b128 a[208:211],v1 offset:2048
ds_read_b128 a[212:215],v2 offset:2048
ds_read_b128 a[216:219],v1 offset:6144
ds_read_b128 a[220:223],v2 offset:6144
ds_read_b128 a[224:227],v1 offset:7168
ds_read_b128 a[228:231],v2 offset:7168
ds_read_b128 a[232:235],v1 offset:8192
ds_read_b128 a[236:239],v2 offset:8192
s_waitcnt vmcnt(6)
ds_read_b128 a[96:99],v28 offset:0
ds_read_b128 a[100:103],v29 offset:0
ds_read_b128 a[104:107],v28 offset:1024
ds_read_b128 a[108:111],v29 offset:1024
ds_read_b128 a[112:115],v28 offset:2048
ds_read_b128 a[116:119],v29 offset:2048
s_waitcnt lgkmcnt(5)
v_mfma_f32_16x16x32_bf16 v[32:35],a[192:195],a[96:99],0
s_lshl_b32 s64,s22,1
s_waitcnt lgkmcnt(4)
v_mfma_f32_16x16x32_bf16 v[32:35],a[196:199],a[100:103],v[32:35]
s_add_u32 s64,s64,49152
s_add_u32 m0,s24,12288
v_add_u32 v144,s64,v1
s_waitcnt lgkmcnt(3)
v_mfma_f32_16x16x32_bf16 v[32:35],a[200:203],a[104:107],v[32:35]
buffer_load_dwordx4 v8,s[12:15],s28 offen offset:0 nt lds
s_add_u32 m0,s24,13184
s_waitcnt lgkmcnt(2)
v_mfma_f32_16x16x32_bf16 v[32:35],a[204:207],a[108:111],v[32:35]
buffer_load_dwordx4 v8,s[12:15],s28 offen offset:128 nt lds
s_add_u32 m0,s24,14080
s_waitcnt lgkmcnt(1)
v_mfma_f32_16x16x32_bf16 v[32:35],a[208:211],a[112:115],v[32:35]
buffer_load_dwordx4 v8,s[12:15],s28 offen offset:256 nt lds
s_add_u32 s28,s28,3072
s_add_u32 m0,s24,15360
s_waitcnt lgkmcnt(0)
v_mfma_f32_16x16x32_bf16 v[32:35],a[212:215],a[116:119],v[32:35]
buffer_load_dwordx4 v9,s[12:15],s28 offen offset:0 nt lds
s_add_u32 m0,s24,16256
v_mfma_f32_16x16x32_bf16 v[36:39],a[216:219],a[96:99],0
buffer_load_dwordx4 v9,s[12:15],s28 offen offset:128 nt lds
s_add_u32 m0,s24,17152
v_mfma_f32_16x16x32_bf16 v[36:39],a[220:223],a[100:103],v[36:39]
buffer_load_dwordx4 v9,s[12:15],s28 offen offset:256 nt lds
s_add_u32 s28,s28,3072
s_lshl_b32 s65,s22,1
s_add_u32 m0,s65,49152
v_mfma_f32_16x16x32_bf16 v[36:39],a[224:227],a[104:107],v[36:39]
v_add_u32 v145,s64,v2
v_mfma_f32_16x16x32_bf16 v[36:39],a[228:231],a[108:111],v[36:39]
v_mfma_f32_16x16x32_bf16 v[36:39],a[232:235],a[112:115],v[36:39]
v_mfma_f32_16x16x32_bf16 v[36:39],a[236:239],a[116:119],v[36:39]
s_waitcnt vmcnt(6)
ds_read_b128 a[120:123],v28 offset:6144
ds_read_b128 a[124:127],v29 offset:6144
ds_read_b128 a[128:131],v28 offset:7168
ds_read_b128 a[132:135],v29 offset:7168
ds_read_b128 a[136:139],v28 offset:8192
ds_read_b128 a[140:143],v29 offset:8192
s_waitcnt lgkmcnt(5)
v_mfma_f32_16x16x32_bf16 v[40:43],a[192:195],a[120:123],0
buffer_load_dwordx4 v8,s[12:15],s28 offen offset:0 nt lds
s_add_u32 m0,s65,50048
s_waitcnt lgkmcnt(4)
v_mfma_f32_16x16x32_bf16 v[40:43],a[196:199],a[124:127],v[40:43]
buffer_load_dwordx4 v8,s[12:15],s28 offen offset:128 nt lds
s_add_u32 m0,s65,50944
s_waitcnt lgkmcnt(3)
v_mfma_f32_16x16x32_bf16 v[40:43],a[200:203],a[128:131],v[40:43]
buffer_load_dwordx4 v8,s[12:15],s28 offen offset:256 nt lds
s_add_u32 s28,s28,3072
s_add_u32 m0,s65,52224
s_waitcnt lgkmcnt(2)
v_mfma_f32_16x16x32_bf16 v[40:43],a[204:207],a[132:135],v[40:43]
buffer_load_dwordx4 v9,s[12:15],s28 offen offset:0 nt lds
s_add_u32 m0,s65,53120
s_waitcnt lgkmcnt(1)
v_mfma_f32_16x16x32_bf16 v[40:43],a[208:211],a[136:139],v[40:43]
buffer_load_dwordx4 v9,s[12:15],s28 offen offset:128 nt lds
s_add_u32 m0,s65,54016
s_waitcnt lgkmcnt(0)
v_mfma_f32_16x16x32_bf16 v[40:43],a[212:215],a[140:143],v[40:43]
buffer_load_dwordx4 v9,s[12:15],s28 offen offset:256 nt lds
s_add_u32 s28,s28,3072
s_add_u32 m0,s22,12288
v_mfma_f32_16x16x32_bf16 v[44:47],a[216:219],a[120:123],0
v_mfma_f32_16x16x32_bf16 v[44:47],a[220:223],a[124:127],v[44:47]
v_mfma_f32_16x16x32_bf16 v[44:47],a[224:227],a[128:131],v[44:47]
v_mfma_f32_16x16x32_bf16 v[44:47],a[228:231],a[132:135],v[44:47]
v_mfma_f32_16x16x32_bf16 v[44:47],a[232:235],a[136:139],v[44:47]
v_mfma_f32_16x16x32_bf16 v[44:47],a[236:239],a[140:143],v[44:47]
s_waitcnt vmcnt(6)
ds_read_b128 a[144:147],v28 offset:12288
ds_read_b128 a[148:151],v29 offset:12288
ds_read_b128 a[152:155],v28 offset:13312
ds_read_b128 a[156:159],v29 offset:13312
ds_read_b128 a[160:163],v28 offset:14336
ds_read_b128 a[164:167],v29 offset:14336
s_waitcnt lgkmcnt(5)
v_mfma_f32_16x16x32_bf16 v[48:51],a[192:195],a[144:147],0
buffer_load_dwordx4 v7,s[4:7],s20 offen offset:0 lds
s_add_u32 m0,s22,13184
s_waitcnt lgkmcnt(4)
v_mfma_f32_16x16x32_bf16 v[48:51],a[196:199],a[148:151],v[48:51]
buffer_load_dwordx4 v7,s[4:7],s20 offen offset:128 lds
s_add_u32 m0,s22,14080
s_waitcnt lgkmcnt(3)
v_mfma_f32_16x16x32_bf16 v[48:51],a[200:203],a[152:155],v[48:51]
buffer_load_dwordx4 v7,s[4:7],s20 offen offset:256 lds
s_add_u32 s20,s20,12288
s_add_u32 m0,s23,0
s_waitcnt lgkmcnt(2)
v_mfma_f32_16x16x32_bf16 v[48:51],a[204:207],a[156:159],v[48:51]
s_waitcnt lgkmcnt(1)
v_mfma_f32_16x16x32_bf16 v[48:51],a[208:211],a[160:163],v[48:51]
s_waitcnt lgkmcnt(0)
v_mfma_f32_16x16x32_bf16 v[48:51],a[212:215],a[164:167],v[48:51]
v_mfma_f32_16x16x32_bf16 v[52:55],a[216:219],a[144:147],0
v_mfma_f32_16x16x32_bf16 v[52:55],a[220:223],a[148:151],v[52:55]
v_mfma_f32_16x16x32_bf16 v[52:55],a[224:227],a[152:155],v[52:55]
v_mfma_f32_16x16x32_bf16 v[52:55],a[228:231],a[156:159],v[52:55]
v_mfma_f32_16x16x32_bf16 v[52:55],a[232:235],a[160:163],v[52:55]
v_mfma_f32_16x16x32_bf16 v[52:55],a[236:239],a[164:167],v[52:55]
s_waitcnt vmcnt(3)
ds_read_b128 a[168:171],v144 offset:0
ds_read_b128 a[172:175],v145 offset:0
ds_read_b128 a[176:179],v144 offset:1024
ds_read_b128 a[180:183],v145 offset:1024
ds_read_b128 a[184:187],v144 offset:2048
ds_read_b128 a[188:191],v145 offset:2048
s_waitcnt lgkmcnt(5)
v_mfma_f32_16x16x32_bf16 v[56:59],a[192:195],a[168:171],0
buffer_load_dwordx4 v7,s[8:11],s21 offen offset:0 lds
s_add_u32 m0,s23,896
s_waitcnt lgkmcnt(4)
v_mfma_f32_16x16x32_bf16 v[56:59],a[196:199],a[172:175],v[56:59]
buffer_load_dwordx4 v7,s[8:11],s21 offen offset:128 lds
s_add_u32 m0,s23,1792
s_waitcnt lgkmcnt(3)
v_mfma_f32_16x16x32_bf16 v[56:59],a[200:203],a[176:179],v[56:59]
buffer_load_dwordx4 v7,s[8:11],s21 offen offset:256 lds
s_add_u32 s21,s21,12288
s_add_u32 m0,s22,24576
s_waitcnt lgkmcnt(2)
v_mfma_f32_16x16x32_bf16 v[56:59],a[204:207],a[180:183],v[56:59]
buffer_load_dwordx4 v7,s[4:7],s20 offen offset:0 lds
s_add_u32 m0,s22,25472
s_waitcnt lgkmcnt(1)
v_mfma_f32_16x16x32_bf16 v[56:59],a[208:211],a[184:187],v[56:59]
buffer_load_dwordx4 v7,s[4:7],s20 offen offset:128 lds
s_add_u32 m0,s22,26368
s_waitcnt lgkmcnt(0)
v_mfma_f32_16x16x32_bf16 v[56:59],a[212:215],a[188:191],v[56:59]
buffer_load_dwordx4 v7,s[4:7],s20 offen offset:256 lds
s_add_u32 s20,s20,12288
s_mov_b32 s27,166723584
v_mfma_f32_16x16x32_bf16 v[60:63],a[216:219],a[168:171],0
s_mov_b32 s42,s41
s_add_u32 s69,s69,1
s_add_u32 s48,s48,325632
v_mfma_f32_16x16x32_bf16 v[60:63],a[220:223],a[172:175],v[60:63]
s_lshr_b32 s62,s39,s69
s_and_b32 s62,s62,1
s_lshl_b32 s62,s62,1
v_mfma_f32_16x16x32_bf16 v[60:63],a[224:227],a[176:179],v[60:63]
s_add_u32 s62,s62,s49
s_and_b32 s62,s62,3
s_add_u32 s63,s69,8
v_mfma_f32_16x16x32_bf16 v[60:63],a[228:231],a[180:183],v[60:63]
s_lshr_b32 s63,s39,s63
s_and_b32 s63,s63,1
s_xor_b32 s62,s62,s63
v_mfma_f32_16x16x32_bf16 v[60:63],a[232:235],a[184:187],v[60:63]
s_mul_i32 s63,s3,3
s_lshl_b32 s64,s3,2
s_mov_b32 s40,1
v_mfma_f32_16x16x32_bf16 v[60:63],a[236:239],a[188:191],v[60:63]
s_waitcnt vmcnt(6)
s_barrier
s_add_u32 s65,s63,17
s_cmp_eq_u32 s3,0
s_cselect_b32 s65,16,s65
s_cselect_b32 s41,1,0
s_cmp_eq_u32 s62,1
s_cselect_b32 s64,s65,s64
s_cselect_b32 s40,s41,s40
s_add_u32 s65,s63,29
s_cmp_eq_u32 s62,2
s_cselect_b32 s64,s65,s64
s_cselect_b32 s40,0,s40
s_add_u32 s65,s63,41
s_cmp_eq_u32 s62,3
s_cselect_b32 s64,s65,s64
s_cselect_b32 s40,0,s40
s_mul_i32 s64,s64,6144
s_add_u32 s41,s48,s64
s_cmp_ge_u32 s69,8
s_cselect_b32 s41,166723584,s41
s_mov_b32 s28,s41
s_mov_b32 s29,s24
s_add_u32 s25,s22,12288
s_add_u32 s26,s22,24576
ds_read_b128 a[192:195],v1 offset:12288
v_max3_f32 v144,v32,v33,v34
v_max3_f32 v146,v40,v41,v42
v_max3_f32 v144,v144,v35,v36
v_max3_f32 v146,v146,v43,v44
v_max3_f32 v144,v144,v37,v38
v_max3_f32 v146,v146,v45,v46
v_max_f32 v144,v144,v39
v_max_f32 v146,v146,v47
v_mov_b32 v145,v144
v_mov_b32 v147,v146
s_add_u32 m0,s23,12288
v_permlane32_swap_b32 v145,v144
v_permlane32_swap_b32 v147,v146
v_max_f32 v144,v144,v145
v_max_f32 v146,v146,v147
v_mov_b32 v145,v144
v_mov_b32 v147,v146
buffer_load_dwordx4 v7,s[8:11],s21 offen offset:0 lds
s_add_u32 m0,s23,13184
ds_read_b128 a[196:199],v2 offset:12288
v_permlane16_swap_b32 v145,v144
v_permlane16_swap_b32 v147,v146
v_max_f32 v144,v144,v145
v_max_f32 v146,v146,v147
v_mul_f32_e64 v16,-s36,v144
v_mul_f32_e64 v17,-s36,v146
v_max3_f32 v144,v48,v49,v50
s_waitcnt lgkmcnt(1)
v_mfma_f32_16x16x32_bf16 v[64:67],a[192:195],a[96:99],0
ds_read_b128 a[200:203],v1 offset:13312
v_max3_f32 v146,v56,v57,v58
v_max3_f32 v144,v144,v51,v52
v_max3_f32 v146,v146,v59,v60
v_max3_f32 v144,v144,v53,v54
v_max3_f32 v146,v146,v61,v62
v_max_f32 v144,v144,v55
v_max_f32 v146,v146,v63
v_mov_b32 v145,v144
v_mov_b32 v147,v146
v_fma_f32 v32,v32,s36,v16
v_permlane32_swap_b32 v145,v144
v_permlane32_swap_b32 v147,v146
v_max_f32 v144,v144,v145
v_max_f32 v146,v146,v147
v_mov_b32 v145,v144
v_mov_b32 v147,v146
v_fma_f32 v33,v33,s36,v16
v_permlane16_swap_b32 v145,v144
v_permlane16_swap_b32 v147,v146
s_waitcnt lgkmcnt(1)
v_mfma_f32_16x16x32_bf16 v[64:67],a[196:199],a[100:103],v[64:67]
buffer_load_dwordx4 v7,s[8:11],s21 offen offset:128 lds
s_add_u32 m0,s23,14080
ds_read_b128 a[204:207],v2 offset:13312
v_max_f32 v144,v144,v145
v_max_f32 v146,v146,v147
v_mul_f32_e64 v18,-s36,v144
v_mul_f32_e64 v19,-s36,v146
v_fma_f32 v34,v34,s36,v16
s_waitcnt lgkmcnt(1)
v_mfma_f32_16x16x32_bf16 v[64:67],a[200:203],a[104:107],v[64:67]
ds_read_b128 a[208:211],v1 offset:14336
v_fma_f32 v35,v35,s36,v16
v_fma_f32 v36,v36,s36,v16
v_fma_f32 v37,v37,s36,v16
v_fma_f32 v38,v38,s36,v16
v_fma_f32 v39,v39,s36,v16
v_fma_f32 v40,v40,s36,v17
v_fma_f32 v41,v41,s36,v17
v_fma_f32 v42,v42,s36,v17
v_fma_f32 v43,v43,s36,v17
v_fma_f32 v44,v44,s36,v17
v_fma_f32 v45,v45,s36,v17
v_fma_f32 v46,v46,s36,v17
v_fma_f32 v47,v47,s36,v17
v_fma_f32 v48,v48,s36,v18
v_fma_f32 v49,v49,s36,v18
v_fma_f32 v50,v50,s36,v18
v_fma_f32 v51,v51,s36,v18
v_fma_f32 v52,v52,s36,v18
v_fma_f32 v53,v53,s36,v18
v_fma_f32 v54,v54,s36,v18
v_fma_f32 v55,v55,s36,v18
v_fma_f32 v56,v56,s36,v19
v_fma_f32 v57,v57,s36,v19
v_fma_f32 v58,v58,s36,v19
v_fma_f32 v59,v59,s36,v19
v_fma_f32 v60,v60,s36,v19
s_waitcnt lgkmcnt(1)
v_mfma_f32_16x16x32_bf16 v[64:67],a[204:207],a[108:111],v[64:67]
ds_read_b128 a[212:215],v2 offset:14336
v_fma_f32 v61,v61,s36,v19
v_fma_f32 v62,v62,s36,v19
v_fma_f32 v63,v63,s36,v19
v_exp_f32 v32,v32
s_waitcnt lgkmcnt(1)
v_mfma_f32_16x16x32_bf16 v[64:67],a[208:211],a[112:115],v[64:67]
buffer_load_dwordx4 v7,s[8:11],s21 offen offset:256 lds
s_add_u32 s21,s21,12288
s_add_u32 m0,s22,0
ds_read_b128 a[216:219],v1 offset:18432
v_exp_f32 v33,v33
v_exp_f32 v34,v34
v_exp_f32 v35,v35
v_exp_f32 v36,v36
v_exp_f32 v37,v37
v_exp_f32 v38,v38
v_exp_f32 v39,v39
v_exp_f32 v40,v40
v_exp_f32 v41,v41
v_exp_f32 v42,v42
v_exp_f32 v43,v43
v_exp_f32 v44,v44
s_waitcnt lgkmcnt(1)
v_mfma_f32_16x16x32_bf16 v[64:67],a[212:215],a[116:119],v[64:67]
ds_read_b128 a[220:223],v2 offset:18432
v_exp_f32 v45,v45
v_mfma_f32_16x16x32_bf16 v[72:75],a[192:195],a[120:123],0
ds_read_b128 a[224:227],v1 offset:19456
v_exp_f32 v46,v46
v_mfma_f32_16x16x32_bf16 v[72:75],a[196:199],a[124:127],v[72:75]
ds_read_b128 a[228:231],v2 offset:19456
v_exp_f32 v47,v47
v_mfma_f32_16x16x32_bf16 v[72:75],a[200:203],a[128:131],v[72:75]
buffer_load_dwordx4 v7,s[4:7],s20 offen offset:0 lds
s_add_u32 m0,s22,896
v_mfma_f32_16x16x32_bf16 v[72:75],a[204:207],a[132:135],v[72:75]
ds_read_b128 a[232:235],v1 offset:20480
v_exp_f32 v48,v48
v_mfma_f32_16x16x32_bf16 v[72:75],a[208:211],a[136:139],v[72:75]
ds_read_b128 a[236:239],v2 offset:20480
v_exp_f32 v49,v49
v_mfma_f32_16x16x32_bf16 v[72:75],a[212:215],a[140:143],v[72:75]
v_exp_f32 v50,v50
v_mfma_f32_16x16x32_bf16 v[80:83],a[192:195],a[144:147],0
v_exp_f32 v51,v51
v_mfma_f32_16x16x32_bf16 v[80:83],a[196:199],a[148:151],v[80:83]
v_exp_f32 v52,v52
v_mfma_f32_16x16x32_bf16 v[80:83],a[200:203],a[152:155],v[80:83]
v_exp_f32 v53,v53
v_mfma_f32_16x16x32_bf16 v[80:83],a[204:207],a[156:159],v[80:83]
v_exp_f32 v54,v54
v_mfma_f32_16x16x32_bf16 v[80:83],a[208:211],a[160:163],v[80:83]
v_exp_f32 v55,v55
v_mfma_f32_16x16x32_bf16 v[80:83],a[212:215],a[164:167],v[80:83]
v_exp_f32 v56,v56
v_mfma_f32_16x16x32_bf16 v[88:91],a[192:195],a[168:171],0
v_exp_f32 v57,v57
v_mfma_f32_16x16x32_bf16 v[88:91],a[196:199],a[172:175],v[88:91]
v_exp_f32 v58,v58
v_mfma_f32_16x16x32_bf16 v[88:91],a[200:203],a[176:179],v[88:91]
buffer_load_dwordx4 v7,s[4:7],s20 offen offset:128 lds
s_add_u32 m0,s22,1792
v_mfma_f32_16x16x32_bf16 v[88:91],a[204:207],a[180:183],v[88:91]
v_exp_f32 v59,v59
v_mfma_f32_16x16x32_bf16 v[88:91],a[208:211],a[184:187],v[88:91]
v_exp_f32 v60,v60
v_mfma_f32_16x16x32_bf16 v[88:91],a[212:215],a[188:191],v[88:91]
s_waitcnt lgkmcnt(0)
v_exp_f32 v61,v61
v_mfma_f32_16x16x32_bf16 v[68:71],a[216:219],a[96:99],0
v_exp_f32 v62,v62
v_mfma_f32_16x16x32_bf16 v[68:71],a[220:223],a[100:103],v[68:71]
v_exp_f32 v63,v63
v_mfma_f32_16x16x32_bf16 v[68:71],a[224:227],a[104:107],v[68:71]
v_cvt_pk_bf16_f32 v96,v32,v33
v_cvt_pk_bf16_f32 v97,v34,v35
v_mfma_f32_16x16x32_bf16 v[68:71],a[228:231],a[108:111],v[68:71]
v_cvt_pk_bf16_f32 v98,v36,v37
v_cvt_pk_bf16_f32 v99,v38,v39
v_mfma_f32_16x16x32_bf16 v[68:71],a[232:235],a[112:115],v[68:71]
v_cvt_pk_bf16_f32 v100,v40,v41
v_cvt_pk_bf16_f32 v101,v42,v43
v_mfma_f32_16x16x32_bf16 v[128:131],v[24:27],v[96:99],0
v_cvt_pk_bf16_f32 v102,v44,v45
v_cvt_pk_bf16_f32 v103,v46,v47
v_mfma_f32_16x16x32_bf16 v[68:71],a[236:239],a[116:119],v[68:71]
v_cvt_pk_bf16_f32 v104,v48,v49
v_cvt_pk_bf16_f32 v105,v50,v51
v_mfma_f32_16x16x32_bf16 v[132:135],v[24:27],v[100:103],0
v_cvt_pk_bf16_f32 v106,v52,v53
v_cvt_pk_bf16_f32 v107,v54,v55
v_mfma_f32_16x16x32_bf16 v[76:79],a[216:219],a[120:123],0
buffer_load_dwordx4 v7,s[4:7],s20 offen offset:256 lds
s_add_u32 s20,s20,12288
v_mfma_f32_16x16x32_bf16 v[136:139],v[24:27],v[104:107],0
v_cvt_pk_bf16_f32 v108,v56,v57
v_cvt_pk_bf16_f32 v109,v58,v59
v_mfma_f32_16x16x32_bf16 v[76:79],a[220:223],a[124:127],v[76:79]
v_cvt_pk_bf16_f32 v110,v60,v61
v_cvt_pk_bf16_f32 v111,v62,v63
v_mfma_f32_16x16x32_bf16 v[76:79],a[224:227],a[128:131],v[76:79]
v_fma_f32 v64,v64,s36,v16
v_fma_f32 v65,v65,s36,v16
v_mfma_f32_16x16x32_bf16 v[140:143],v[24:27],v[108:111],0
v_fma_f32 v66,v66,s36,v16
v_fma_f32 v67,v67,s36,v16
v_mfma_f32_16x16x32_bf16 v[76:79],a[228:231],a[132:135],v[76:79]
v_fma_f32 v72,v72,s36,v17
v_fma_f32 v73,v73,s36,v17
v_mfma_f32_16x16x32_bf16 v[76:79],a[232:235],a[136:139],v[76:79]
v_fma_f32 v74,v74,s36,v17
v_fma_f32 v75,v75,s36,v17
v_mfma_f32_16x16x32_bf16 v[76:79],a[236:239],a[140:143],v[76:79]
v_exp_f32 v64,v64
v_mfma_f32_16x16x32_bf16 v[84:87],a[216:219],a[144:147],0
v_exp_f32 v65,v65
v_mfma_f32_16x16x32_bf16 v[84:87],a[220:223],a[148:151],v[84:87]
v_exp_f32 v66,v66
v_mfma_f32_16x16x32_bf16 v[84:87],a[224:227],a[152:155],v[84:87]
v_exp_f32 v67,v67
v_mfma_f32_16x16x32_bf16 v[84:87],a[228:231],a[156:159],v[84:87]
v_exp_f32 v72,v72
v_mfma_f32_16x16x32_bf16 v[84:87],a[232:235],a[160:163],v[84:87]
v_exp_f32 v73,v73
v_mfma_f32_16x16x32_bf16 v[84:87],a[236:239],a[164:167],v[84:87]
v_exp_f32 v74,v74
v_mfma_f32_16x16x32_bf16 v[92:95],a[216:219],a[168:171],0
v_exp_f32 v75,v75
v_mfma_f32_16x16x32_bf16 v[92:95],a[220:223],a[172:175],v[92:95]
v_cvt_pk_bf16_f32 v112,v64,v65
v_cvt_pk_bf16_f32 v113,v66,v67
v_mfma_f32_16x16x32_bf16 v[92:95],a[224:227],a[176:179],v[92:95]
v_cvt_pk_bf16_f32 v116,v72,v73
v_cvt_pk_bf16_f32 v117,v74,v75
v_mfma_f32_16x16x32_bf16 v[92:95],a[228:231],a[180:183],v[92:95]
v_mfma_f32_16x16x32_bf16 v[92:95],a[232:235],a[184:187],v[92:95]
v_mfma_f32_16x16x32_bf16 v[92:95],a[236:239],a[188:191],v[92:95]
s_waitcnt vmcnt(6)
s_barrier
ds_read_b64_tr_b16 a[240:241],v3 offset:0
ds_read_b64_tr_b16 a[242:243],v3 offset:6144
ds_read_b64_tr_b16 a[244:245],v4 offset:0
ds_read_b64_tr_b16 a[246:247],v4 offset:6144
ds_read_b64_tr_b16 a[248:249],v5 offset:0
ds_read_b64_tr_b16 a[250:251],v5 offset:6144
ds_read_b64_tr_b16 a[252:253],v6 offset:0
ds_read_b64_tr_b16 a[254:255],v6 offset:6144
s_waitcnt lgkmcnt(6)
v_mfma_f32_16x16x32_bf16 v[160:163],a[240:243],v[96:99],0
s_add_u32 m0,s23,24576
ds_read_b128 a[192:195],v1 offset:24576
v_fma_f32 v68,v68,s36,v16
v_mfma_f32_16x16x32_bf16 v[208:211],a[240:243],v[100:103],0
buffer_load_dwordx4 v7,s[8:11],s21 offen offset:0 lds
v_mfma_f32_16x16x32_bf16 a[0:3],a[240:243],v[104:107],0
s_add_u32 m0,s23,25472
ds_read_b128 a[196:199],v2 offset:24576
v_fma_f32 v69,v69,s36,v16
v_mfma_f32_16x16x32_bf16 a[48:51],a[240:243],v[108:111],0
s_waitcnt lgkmcnt(6)
ds_read_b64_tr_b16 a[240:241],v3 offset:1024
ds_read_b64_tr_b16 a[242:243],v3 offset:7168
v_mfma_f32_16x16x32_bf16 v[164:167],a[244:247],v[96:99],0
ds_read_b128 a[200:203],v1 offset:25600
v_fma_f32 v70,v70,s36,v16
v_mfma_f32_16x16x32_bf16 v[212:215],a[244:247],v[100:103],0
ds_read_b128 a[204:207],v2 offset:25600
v_fma_f32 v71,v71,s36,v16
v_mfma_f32_16x16x32_bf16 a[4:7],a[244:247],v[104:107],0
ds_read_b128 a[208:211],v1 offset:26624
v_fma_f32 v76,v76,s36,v17
v_mfma_f32_16x16x32_bf16 a[52:55],a[244:247],v[108:111],0
s_waitcnt lgkmcnt(7)
ds_read_b64_tr_b16 a[244:245],v4 offset:1024
ds_read_b64_tr_b16 a[246:247],v4 offset:7168
v_mfma_f32_16x16x32_bf16 v[168:171],a[248:251],v[96:99],0
ds_read_b128 a[212:215],v2 offset:26624
v_fma_f32 v77,v77,s36,v17
v_mfma_f32_16x16x32_bf16 v[216:219],a[248:251],v[100:103],0
buffer_load_dwordx4 v7,s[8:11],s21 offen offset:128 lds
v_mfma_f32_16x16x32_bf16 a[8:11],a[248:251],v[104:107],0
s_add_u32 m0,s23,26368
ds_read_b128 a[216:219],v1 offset:30720
v_fma_f32 v78,v78,s36,v17
v_mfma_f32_16x16x32_bf16 a[56:59],a[248:251],v[108:111],0
ds_read_b64_tr_b16 a[248:249],v5 offset:1024
ds_read_b64_tr_b16 a[250:251],v5 offset:7168
v_mfma_f32_16x16x32_bf16 v[172:175],a[252:255],v[96:99],0
ds_read_b128 a[220:223],v2 offset:30720
v_fma_f32 v79,v79,s36,v17
v_mfma_f32_16x16x32_bf16 v[220:223],a[252:255],v[100:103],0
ds_read_b128 a[224:227],v1 offset:31744
v_fma_f32 v80,v80,s36,v18
v_mfma_f32_16x16x32_bf16 a[12:15],a[252:255],v[104:107],0
ds_read_b128 a[228:231],v2 offset:31744
v_fma_f32 v81,v81,s36,v18
v_mfma_f32_16x16x32_bf16 a[60:63],a[252:255],v[108:111],0
s_waitcnt lgkmcnt(7)
ds_read_b64_tr_b16 a[252:253],v6 offset:1024
ds_read_b64_tr_b16 a[254:255],v6 offset:7168
v_mfma_f32_16x16x32_bf16 v[176:179],a[240:243],v[96:99],0
ds_read_b128 a[232:235],v1 offset:32768
v_fma_f32 v82,v82,s36,v18
v_mfma_f32_16x16x32_bf16 v[224:227],a[240:243],v[100:103],0
buffer_load_dwordx4 v7,s[8:11],s21 offen offset:256 lds
v_mfma_f32_16x16x32_bf16 a[16:19],a[240:243],v[104:107],0
s_add_u32 s21,s21,12288
ds_read_b128 a[236:239],v2 offset:32768
v_fma_f32 v83,v83,s36,v18
v_mfma_f32_16x16x32_bf16 a[64:67],a[240:243],v[108:111],0
s_add_u32 m0,s22,12288
ds_read_b64_tr_b16 a[240:241],v3 offset:2048
ds_read_b64_tr_b16 a[242:243],v3 offset:8192
v_mfma_f32_16x16x32_bf16 v[180:183],a[244:247],v[96:99],0
v_fma_f32 v84,v84,s36,v18
v_fma_f32 v85,v85,s36,v18
v_mfma_f32_16x16x32_bf16 v[228:231],a[244:247],v[100:103],0
v_fma_f32 v86,v86,s36,v18
v_fma_f32 v87,v87,s36,v18
v_mfma_f32_16x16x32_bf16 a[20:23],a[244:247],v[104:107],0
v_fma_f32 v88,v88,s36,v19
v_fma_f32 v89,v89,s36,v19
v_mfma_f32_16x16x32_bf16 a[68:71],a[244:247],v[108:111],0
s_waitcnt lgkmcnt(4)
ds_read_b64_tr_b16 a[244:245],v4 offset:2048
ds_read_b64_tr_b16 a[246:247],v4 offset:8192
v_mfma_f32_16x16x32_bf16 v[184:187],a[248:251],v[96:99],0
buffer_load_dwordx4 v7,s[4:7],s20 offen offset:0 lds
v_mfma_f32_16x16x32_bf16 v[232:235],a[248:251],v[100:103],0
s_add_u32 m0,s22,13184
v_fma_f32 v90,v90,s36,v19
v_fma_f32 v91,v91,s36,v19
v_mfma_f32_16x16x32_bf16 a[24:27],a[248:251],v[104:107],0
v_fma_f32 v92,v92,s36,v19
v_fma_f32 v93,v93,s36,v19
v_mfma_f32_16x16x32_bf16 a[72:75],a[248:251],v[108:111],0
ds_read_b64_tr_b16 a[248:249],v5 offset:2048
ds_read_b64_tr_b16 a[250:251],v5 offset:8192
v_mfma_f32_16x16x32_bf16 v[188:191],a[252:255],v[96:99],0
v_fma_f32 v94,v94,s36,v19
v_fma_f32 v95,v95,s36,v19
v_mfma_f32_16x16x32_bf16 v[236:239],a[252:255],v[100:103],0
v_exp_f32 v68,v68
v_mfma_f32_16x16x32_bf16 a[28:31],a[252:255],v[104:107],0
v_exp_f32 v69,v69
v_mfma_f32_16x16x32_bf16 a[76:79],a[252:255],v[108:111],0
s_waitcnt lgkmcnt(2)
ds_read_b64_tr_b16 a[252:253],v6 offset:2048
ds_read_b64_tr_b16 a[254:255],v6 offset:8192
v_mfma_f32_16x16x32_bf16 v[192:195],a[240:243],v[96:99],0
buffer_load_dwordx4 v7,s[4:7],s20 offen offset:128 lds
v_mfma_f32_16x16x32_bf16 v[240:243],a[240:243],v[100:103],0
s_add_u32 m0,s22,14080
v_exp_f32 v70,v70
v_mfma_f32_16x16x32_bf16 a[32:35],a[240:243],v[104:107],0
v_exp_f32 v71,v71
v_mfma_f32_16x16x32_bf16 a[80:83],a[240:243],v[108:111],0
v_exp_f32 v76,v76
v_mfma_f32_16x16x32_bf16 v[196:199],a[244:247],v[96:99],0
v_exp_f32 v77,v77
v_mfma_f32_16x16x32_bf16 v[244:247],a[244:247],v[100:103],0
v_exp_f32 v78,v78
v_mfma_f32_16x16x32_bf16 a[36:39],a[244:247],v[104:107],0
v_exp_f32 v79,v79
v_mfma_f32_16x16x32_bf16 a[84:87],a[244:247],v[108:111],0
s_waitcnt lgkmcnt(0)
v_exp_f32 v80,v80
v_mfma_f32_16x16x32_bf16 v[200:203],a[248:251],v[96:99],0
buffer_load_dwordx4 v7,s[4:7],s20 offen offset:256 lds
v_mfma_f32_16x16x32_bf16 v[248:251],a[248:251],v[100:103],0
s_add_u32 s20,s20,12288
v_exp_f32 v81,v81
v_mfma_f32_16x16x32_bf16 a[40:43],a[248:251],v[104:107],0
v_exp_f32 v82,v82
v_mfma_f32_16x16x32_bf16 a[88:91],a[248:251],v[108:111],0
v_exp_f32 v83,v83
v_mfma_f32_16x16x32_bf16 v[204:207],a[252:255],v[96:99],0
v_exp_f32 v84,v84
v_mfma_f32_16x16x32_bf16 v[252:255],a[252:255],v[100:103],0
v_exp_f32 v85,v85
v_mfma_f32_16x16x32_bf16 a[44:47],a[252:255],v[104:107],0
v_exp_f32 v86,v86
v_mfma_f32_16x16x32_bf16 a[92:95],a[252:255],v[108:111],0
v_exp_f32 v87,v87
v_mfma_f32_16x16x32_bf16 v[32:35],a[192:195],a[96:99],0
v_exp_f32 v88,v88
v_mfma_f32_16x16x32_bf16 v[32:35],a[196:199],a[100:103],v[32:35]
v_exp_f32 v89,v89
v_mfma_f32_16x16x32_bf16 v[32:35],a[200:203],a[104:107],v[32:35]
v_exp_f32 v90,v90
v_mfma_f32_16x16x32_bf16 v[32:35],a[204:207],a[108:111],v[32:35]
v_exp_f32 v91,v91
v_mfma_f32_16x16x32_bf16 v[32:35],a[208:211],a[112:115],v[32:35]
v_exp_f32 v92,v92
v_mfma_f32_16x16x32_bf16 v[32:35],a[212:215],a[116:119],v[32:35]
v_exp_f32 v93,v93
v_mfma_f32_16x16x32_bf16 v[40:43],a[192:195],a[120:123],0
v_exp_f32 v94,v94
v_mfma_f32_16x16x32_bf16 v[40:43],a[196:199],a[124:127],v[40:43]
v_exp_f32 v95,v95
v_mfma_f32_16x16x32_bf16 v[40:43],a[200:203],a[128:131],v[40:43]
v_cvt_pk_bf16_f32 v114,v68,v69
v_cvt_pk_bf16_f32 v115,v70,v71
v_mfma_f32_16x16x32_bf16 v[40:43],a[204:207],a[132:135],v[40:43]
v_cvt_pk_bf16_f32 v118,v76,v77
v_cvt_pk_bf16_f32 v119,v78,v79
v_mfma_f32_16x16x32_bf16 v[128:131],v[24:27],v[112:115],v[128:131]
v_cvt_pk_bf16_f32 v120,v80,v81
v_cvt_pk_bf16_f32 v121,v82,v83
v_mfma_f32_16x16x32_bf16 v[132:135],v[24:27],v[116:119],v[132:135]
v_cvt_pk_bf16_f32 v122,v84,v85
v_cvt_pk_bf16_f32 v123,v86,v87
v_mfma_f32_16x16x32_bf16 v[40:43],a[208:211],a[136:139],v[40:43]
v_cvt_pk_bf16_f32 v124,v88,v89
v_cvt_pk_bf16_f32 v125,v90,v91
v_mfma_f32_16x16x32_bf16 v[136:139],v[24:27],v[120:123],v[136:139]
v_cvt_pk_bf16_f32 v126,v92,v93
v_cvt_pk_bf16_f32 v127,v94,v95
v_mfma_f32_16x16x32_bf16 v[40:43],a[212:215],a[140:143],v[40:43]
v_fma_f32 v32,v32,s36,v16
v_fma_f32 v33,v33,s36,v16
v_mfma_f32_16x16x32_bf16 v[140:143],v[24:27],v[124:127],v[140:143]
v_fma_f32 v34,v34,s36,v16
v_fma_f32 v35,v35,s36,v16
v_mfma_f32_16x16x32_bf16 v[48:51],a[192:195],a[144:147],0
v_exp_f32 v32,v32
v_mfma_f32_16x16x32_bf16 v[48:51],a[196:199],a[148:151],v[48:51]
v_fma_f32 v40,v40,s36,v17
v_fma_f32 v41,v41,s36,v17
v_mfma_f32_16x16x32_bf16 v[48:51],a[200:203],a[152:155],v[48:51]
v_fma_f32 v42,v42,s36,v17
v_fma_f32 v43,v43,s36,v17
v_mfma_f32_16x16x32_bf16 v[48:51],a[204:207],a[156:159],v[48:51]
v_exp_f32 v33,v33
v_mfma_f32_16x16x32_bf16 v[48:51],a[208:211],a[160:163],v[48:51]
v_exp_f32 v34,v34
v_mfma_f32_16x16x32_bf16 v[48:51],a[212:215],a[164:167],v[48:51]
v_exp_f32 v35,v35
v_mfma_f32_16x16x32_bf16 v[56:59],a[192:195],a[168:171],0
v_exp_f32 v40,v40
v_mfma_f32_16x16x32_bf16 v[56:59],a[196:199],a[172:175],v[56:59]
v_exp_f32 v41,v41
v_mfma_f32_16x16x32_bf16 v[56:59],a[200:203],a[176:179],v[56:59]
v_exp_f32 v42,v42
v_mfma_f32_16x16x32_bf16 v[56:59],a[204:207],a[180:183],v[56:59]
v_exp_f32 v43,v43
v_mfma_f32_16x16x32_bf16 v[56:59],a[208:211],a[184:187],v[56:59]
v_cvt_pk_bf16_f32 v96,v32,v33
v_cvt_pk_bf16_f32 v97,v34,v35
v_mfma_f32_16x16x32_bf16 v[56:59],a[212:215],a[188:191],v[56:59]
v_cvt_pk_bf16_f32 v100,v40,v41
v_cvt_pk_bf16_f32 v101,v42,v43
v_mfma_f32_16x16x32_bf16 v[36:39],a[216:219],a[96:99],0
v_mfma_f32_16x16x32_bf16 v[36:39],a[220:223],a[100:103],v[36:39]
v_mfma_f32_16x16x32_bf16 v[36:39],a[224:227],a[104:107],v[36:39]
v_mfma_f32_16x16x32_bf16 v[36:39],a[228:231],a[108:111],v[36:39]
v_mfma_f32_16x16x32_bf16 v[36:39],a[232:235],a[112:115],v[36:39]
v_mfma_f32_16x16x32_bf16 v[36:39],a[236:239],a[116:119],v[36:39]
v_mfma_f32_16x16x32_bf16 v[44:47],a[216:219],a[120:123],0
v_mfma_f32_16x16x32_bf16 v[44:47],a[220:223],a[124:127],v[44:47]
v_mfma_f32_16x16x32_bf16 v[44:47],a[224:227],a[128:131],v[44:47]
v_mfma_f32_16x16x32_bf16 v[44:47],a[228:231],a[132:135],v[44:47]
v_mfma_f32_16x16x32_bf16 v[44:47],a[232:235],a[136:139],v[44:47]
s_waitcnt vmcnt(6)
s_barrier
v_mfma_f32_16x16x32_bf16 v[44:47],a[236:239],a[140:143],v[44:47]
v_mfma_f32_16x16x32_bf16 v[52:55],a[216:219],a[144:147],0
ds_read_b64_tr_b16 a[240:241],v3 offset:12288
ds_read_b64_tr_b16 a[242:243],v3 offset:18432
v_mfma_f32_16x16x32_bf16 v[52:55],a[220:223],a[148:151],v[52:55]
v_mfma_f32_16x16x32_bf16 v[52:55],a[224:227],a[152:155],v[52:55]
ds_read_b64_tr_b16 a[244:245],v4 offset:12288
ds_read_b64_tr_b16 a[246:247],v4 offset:18432
v_mfma_f32_16x16x32_bf16 v[52:55],a[228:231],a[156:159],v[52:55]
v_mfma_f32_16x16x32_bf16 v[52:55],a[232:235],a[160:163],v[52:55]
ds_read_b64_tr_b16 a[248:249],v5 offset:12288
ds_read_b64_tr_b16 a[250:251],v5 offset:18432
v_mfma_f32_16x16x32_bf16 v[52:55],a[236:239],a[164:167],v[52:55]
v_mfma_f32_16x16x32_bf16 v[60:63],a[216:219],a[168:171],0
ds_read_b64_tr_b16 a[252:253],v6 offset:12288
ds_read_b64_tr_b16 a[254:255],v6 offset:18432
v_mfma_f32_16x16x32_bf16 v[60:63],a[220:223],a[172:175],v[60:63]
v_mfma_f32_16x16x32_bf16 v[60:63],a[224:227],a[176:179],v[60:63]
v_mfma_f32_16x16x32_bf16 v[60:63],a[228:231],a[180:183],v[60:63]
v_mfma_f32_16x16x32_bf16 v[60:63],a[232:235],a[184:187],v[60:63]
v_mfma_f32_16x16x32_bf16 v[60:63],a[236:239],a[188:191],v[60:63]
s_waitcnt lgkmcnt(4)
v_mfma_f32_16x16x32_bf16 v[160:163],a[240:243],v[112:115],v[160:163]
s_add_u32 m0,s23,0
ds_read_b128 a[192:195],v1 offset:0
v_fma_f32 v36,v36,s36,v16
v_mfma_f32_16x16x32_bf16 v[208:211],a[240:243],v[116:119],v[208:211]
buffer_load_dwordx4 v7,s[8:11],s21 offen offset:0 lds
v_mfma_f32_16x16x32_bf16 a[0:3],a[240:243],v[120:123],a[0:3]
s_add_u32 m0,s23,896
ds_read_b128 a[196:199],v2 offset:0
v_fma_f32 v37,v37,s36,v16
v_mfma_f32_16x16x32_bf16 a[48:51],a[240:243],v[124:127],a[48:51]
ds_read_b64_tr_b16 a[240:241],v3 offset:13312
ds_read_b64_tr_b16 a[242:243],v3 offset:19456
v_mfma_f32_16x16x32_bf16 v[164:167],a[244:247],v[112:115],v[164:167]
ds_read_b128 a[200:203],v1 offset:1024
v_fma_f32 v38,v38,s36,v16
v_mfma_f32_16x16x32_bf16 v[212:215],a[244:247],v[116:119],v[212:215]
ds_read_b128 a[204:207],v2 offset:1024
v_fma_f32 v39,v39,s36,v16
v_mfma_f32_16x16x32_bf16 a[4:7],a[244:247],v[120:123],a[4:7]
ds_read_b128 a[208:211],v1 offset:2048
v_fma_f32 v44,v44,s36,v17
v_mfma_f32_16x16x32_bf16 a[52:55],a[244:247],v[124:127],a[52:55]
s_waitcnt lgkmcnt(7)
ds_read_b64_tr_b16 a[244:245],v4 offset:13312
ds_read_b64_tr_b16 a[246:247],v4 offset:19456
v_mfma_f32_16x16x32_bf16 v[168:171],a[248:251],v[112:115],v[168:171]
ds_read_b128 a[212:215],v2 offset:2048
v_fma_f32 v45,v45,s36,v17
v_mfma_f32_16x16x32_bf16 v[216:219],a[248:251],v[116:119],v[216:219]
buffer_load_dwordx4 v7,s[8:11],s21 offen offset:128 lds
v_mfma_f32_16x16x32_bf16 a[8:11],a[248:251],v[120:123],a[8:11]
s_add_u32 m0,s23,1792
ds_read_b128 a[216:219],v1 offset:6144
v_fma_f32 v46,v46,s36,v17
v_mfma_f32_16x16x32_bf16 a[56:59],a[248:251],v[124:127],a[56:59]
ds_read_b64_tr_b16 a[248:249],v5 offset:13312
ds_read_b64_tr_b16 a[250:251],v5 offset:19456
v_mfma_f32_16x16x32_bf16 v[172:175],a[252:255],v[112:115],v[172:175]
ds_read_b128 a[220:223],v2 offset:6144
v_fma_f32 v47,v47,s36,v17
v_mfma_f32_16x16x32_bf16 v[220:223],a[252:255],v[116:119],v[220:223]
ds_read_b128 a[224:227],v1 offset:7168
v_fma_f32 v48,v48,s36,v18
v_mfma_f32_16x16x32_bf16 a[12:15],a[252:255],v[120:123],a[12:15]
ds_read_b128 a[228:231],v2 offset:7168
v_fma_f32 v49,v49,s36,v18
v_mfma_f32_16x16x32_bf16 a[60:63],a[252:255],v[124:127],a[60:63]
s_waitcnt lgkmcnt(7)
ds_read_b64_tr_b16 a[252:253],v6 offset:13312
ds_read_b64_tr_b16 a[254:255],v6 offset:19456
v_mfma_f32_16x16x32_bf16 v[176:179],a[240:243],v[112:115],v[176:179]
ds_read_b128 a[232:235],v1 offset:8192
v_fma_f32 v50,v50,s36,v18
v_mfma_f32_16x16x32_bf16 v[224:227],a[240:243],v[116:119],v[224:227]
buffer_load_dwordx4 v7,s[8:11],s21 offen offset:256 lds
v_mfma_f32_16x16x32_bf16 a[16:19],a[240:243],v[120:123],a[16:19]
s_add_u32 s21,s21,12288
ds_read_b128 a[236:239],v2 offset:8192
v_fma_f32 v51,v51,s36,v18
v_mfma_f32_16x16x32_bf16 a[64:67],a[240:243],v[124:127],a[64:67]
s_add_u32 m0,s22,24576
ds_read_b64_tr_b16 a[240:241],v3 offset:14336
ds_read_b64_tr_b16 a[242:243],v3 offset:20480
v_mfma_f32_16x16x32_bf16 v[180:183],a[244:247],v[112:115],v[180:183]
v_fma_f32 v52,v52,s36,v18
v_fma_f32 v53,v53,s36,v18
v_mfma_f32_16x16x32_bf16 v[228:231],a[244:247],v[116:119],v[228:231]
v_fma_f32 v54,v54,s36,v18
v_fma_f32 v55,v55,s36,v18
v_mfma_f32_16x16x32_bf16 a[20:23],a[244:247],v[120:123],a[20:23]
v_fma_f32 v56,v56,s36,v19
v_fma_f32 v57,v57,s36,v19
v_mfma_f32_16x16x32_bf16 a[68:71],a[244:247],v[124:127],a[68:71]
s_waitcnt lgkmcnt(4)
ds_read_b64_tr_b16 a[244:245],v4 offset:14336
ds_read_b64_tr_b16 a[246:247],v4 offset:20480
v_mfma_f32_16x16x32_bf16 v[184:187],a[248:251],v[112:115],v[184:187]
buffer_load_dwordx4 v7,s[4:7],s20 offen offset:0 lds
v_mfma_f32_16x16x32_bf16 v[232:235],a[248:251],v[116:119],v[232:235]
s_add_u32 m0,s22,25472
v_fma_f32 v58,v58,s36,v19
v_fma_f32 v59,v59,s36,v19
v_mfma_f32_16x16x32_bf16 a[24:27],a[248:251],v[120:123],a[24:27]
v_fma_f32 v60,v60,s36,v19
v_fma_f32 v61,v61,s36,v19
v_mfma_f32_16x16x32_bf16 a[72:75],a[248:251],v[124:127],a[72:75]
ds_read_b64_tr_b16 a[248:249],v5 offset:14336
ds_read_b64_tr_b16 a[250:251],v5 offset:20480
v_mfma_f32_16x16x32_bf16 v[188:191],a[252:255],v[112:115],v[188:191]
v_fma_f32 v62,v62,s36,v19
v_fma_f32 v63,v63,s36,v19
v_mfma_f32_16x16x32_bf16 v[236:239],a[252:255],v[116:119],v[236:239]
v_exp_f32 v36,v36
v_mfma_f32_16x16x32_bf16 a[28:31],a[252:255],v[120:123],a[28:31]
v_exp_f32 v37,v37
v_mfma_f32_16x16x32_bf16 a[76:79],a[252:255],v[124:127],a[76:79]
s_waitcnt lgkmcnt(2)
ds_read_b64_tr_b16 a[252:253],v6 offset:14336
ds_read_b64_tr_b16 a[254:255],v6 offset:20480
v_mfma_f32_16x16x32_bf16 v[192:195],a[240:243],v[112:115],v[192:195]
buffer_load_dwordx4 v7,s[4:7],s20 offen offset:128 lds
v_mfma_f32_16x16x32_bf16 v[240:243],a[240:243],v[116:119],v[240:243]
s_add_u32 m0,s22,26368
v_exp_f32 v38,v38
v_mfma_f32_16x16x32_bf16 a[32:35],a[240:243],v[120:123],a[32:35]
v_exp_f32 v39,v39
v_mfma_f32_16x16x32_bf16 a[80:83],a[240:243],v[124:127],a[80:83]
v_exp_f32 v44,v44
v_mfma_f32_16x16x32_bf16 v[196:199],a[244:247],v[112:115],v[196:199]
v_exp_f32 v45,v45
v_mfma_f32_16x16x32_bf16 v[244:247],a[244:247],v[116:119],v[244:247]
v_exp_f32 v46,v46
v_mfma_f32_16x16x32_bf16 a[36:39],a[244:247],v[120:123],a[36:39]
v_exp_f32 v47,v47
v_mfma_f32_16x16x32_bf16 a[84:87],a[244:247],v[124:127],a[84:87]
s_waitcnt lgkmcnt(0)
v_exp_f32 v48,v48
v_mfma_f32_16x16x32_bf16 v[200:203],a[248:251],v[112:115],v[200:203]
buffer_load_dwordx4 v7,s[4:7],s20 offen offset:256 lds
v_mfma_f32_16x16x32_bf16 v[248:251],a[248:251],v[116:119],v[248:251]
s_add_u32 s20,s20,12288
v_exp_f32 v49,v49
v_mfma_f32_16x16x32_bf16 a[40:43],a[248:251],v[120:123],a[40:43]
v_exp_f32 v50,v50
v_mfma_f32_16x16x32_bf16 a[88:91],a[248:251],v[124:127],a[88:91]
v_exp_f32 v51,v51
v_mfma_f32_16x16x32_bf16 v[204:207],a[252:255],v[112:115],v[204:207]
v_exp_f32 v52,v52
v_mfma_f32_16x16x32_bf16 v[252:255],a[252:255],v[116:119],v[252:255]
v_exp_f32 v53,v53
v_mfma_f32_16x16x32_bf16 a[44:47],a[252:255],v[120:123],a[44:47]
v_exp_f32 v54,v54
v_mfma_f32_16x16x32_bf16 a[92:95],a[252:255],v[124:127],a[92:95]
v_exp_f32 v55,v55
v_mfma_f32_16x16x32_bf16 v[64:67],a[192:195],a[96:99],0
v_exp_f32 v56,v56
v_mfma_f32_16x16x32_bf16 v[64:67],a[196:199],a[100:103],v[64:67]
v_exp_f32 v57,v57
v_mfma_f32_16x16x32_bf16 v[64:67],a[200:203],a[104:107],v[64:67]
v_exp_f32 v58,v58
v_mfma_f32_16x16x32_bf16 v[64:67],a[204:207],a[108:111],v[64:67]
v_exp_f32 v59,v59
v_mfma_f32_16x16x32_bf16 v[64:67],a[208:211],a[112:115],v[64:67]
v_exp_f32 v60,v60
v_mfma_f32_16x16x32_bf16 v[64:67],a[212:215],a[116:119],v[64:67]
v_exp_f32 v61,v61
v_mfma_f32_16x16x32_bf16 v[72:75],a[192:195],a[120:123],0
v_exp_f32 v62,v62
v_mfma_f32_16x16x32_bf16 v[72:75],a[196:199],a[124:127],v[72:75]
v_exp_f32 v63,v63
v_mfma_f32_16x16x32_bf16 v[72:75],a[200:203],a[128:131],v[72:75]
v_cvt_pk_bf16_f32 v98,v36,v37
v_cvt_pk_bf16_f32 v99,v38,v39
v_mfma_f32_16x16x32_bf16 v[72:75],a[204:207],a[132:135],v[72:75]
v_cvt_pk_bf16_f32 v102,v44,v45
v_cvt_pk_bf16_f32 v103,v46,v47
v_mfma_f32_16x16x32_bf16 v[128:131],v[24:27],v[96:99],v[128:131]
v_cvt_pk_bf16_f32 v104,v48,v49
v_cvt_pk_bf16_f32 v105,v50,v51
v_mfma_f32_16x16x32_bf16 v[132:135],v[24:27],v[100:103],v[132:135]
v_cvt_pk_bf16_f32 v106,v52,v53
v_cvt_pk_bf16_f32 v107,v54,v55
v_mfma_f32_16x16x32_bf16 v[72:75],a[208:211],a[136:139],v[72:75]
v_cvt_pk_bf16_f32 v108,v56,v57
v_cvt_pk_bf16_f32 v109,v58,v59
v_mfma_f32_16x16x32_bf16 v[136:139],v[24:27],v[104:107],v[136:139]
v_cvt_pk_bf16_f32 v110,v60,v61
v_cvt_pk_bf16_f32 v111,v62,v63
v_mfma_f32_16x16x32_bf16 v[72:75],a[212:215],a[140:143],v[72:75]
v_fma_f32 v64,v64,s36,v16
v_fma_f32 v65,v65,s36,v16
v_mfma_f32_16x16x32_bf16 v[140:143],v[24:27],v[108:111],v[140:143]
v_fma_f32 v66,v66,s36,v16
v_fma_f32 v67,v67,s36,v16
v_mfma_f32_16x16x32_bf16 v[80:83],a[192:195],a[144:147],0
v_exp_f32 v64,v64
v_mfma_f32_16x16x32_bf16 v[80:83],a[196:199],a[148:151],v[80:83]
v_fma_f32 v72,v72,s36,v17
v_fma_f32 v73,v73,s36,v17
v_mfma_f32_16x16x32_bf16 v[80:83],a[200:203],a[152:155],v[80:83]
v_fma_f32 v74,v74,s36,v17
v_fma_f32 v75,v75,s36,v17
v_mfma_f32_16x16x32_bf16 v[80:83],a[204:207],a[156:159],v[80:83]
v_exp_f32 v65,v65
v_mfma_f32_16x16x32_bf16 v[80:83],a[208:211],a[160:163],v[80:83]
v_exp_f32 v66,v66
v_mfma_f32_16x16x32_bf16 v[80:83],a[212:215],a[164:167],v[80:83]
v_exp_f32 v67,v67
v_mfma_f32_16x16x32_bf16 v[88:91],a[192:195],a[168:171],0
v_exp_f32 v72,v72
v_mfma_f32_16x16x32_bf16 v[88:91],a[196:199],a[172:175],v[88:91]
v_exp_f32 v73,v73
v_mfma_f32_16x16x32_bf16 v[88:91],a[200:203],a[176:179],v[88:91]
v_exp_f32 v74,v74
v_mfma_f32_16x16x32_bf16 v[88:91],a[204:207],a[180:183],v[88:91]
v_exp_f32 v75,v75
v_mfma_f32_16x16x32_bf16 v[88:91],a[208:211],a[184:187],v[88:91]
v_cvt_pk_bf16_f32 v112,v64,v65
v_cvt_pk_bf16_f32 v113,v66,v67
v_mfma_f32_16x16x32_bf16 v[88:91],a[212:215],a[188:191],v[88:91]
v_cvt_pk_bf16_f32 v116,v72,v73
v_cvt_pk_bf16_f32 v117,v74,v75
v_mfma_f32_16x16x32_bf16 v[68:71],a[216:219],a[96:99],0
v_mfma_f32_16x16x32_bf16 v[68:71],a[220:223],a[100:103],v[68:71]
v_mfma_f32_16x16x32_bf16 v[68:71],a[224:227],a[104:107],v[68:71]
v_mfma_f32_16x16x32_bf16 v[68:71],a[228:231],a[108:111],v[68:71]
v_mfma_f32_16x16x32_bf16 v[68:71],a[232:235],a[112:115],v[68:71]
v_mfma_f32_16x16x32_bf16 v[68:71],a[236:239],a[116:119],v[68:71]
v_mfma_f32_16x16x32_bf16 v[76:79],a[216:219],a[120:123],0
v_mfma_f32_16x16x32_bf16 v[76:79],a[220:223],a[124:127],v[76:79]
v_mfma_f32_16x16x32_bf16 v[76:79],a[224:227],a[128:131],v[76:79]
v_mfma_f32_16x16x32_bf16 v[76:79],a[228:231],a[132:135],v[76:79]
v_mfma_f32_16x16x32_bf16 v[76:79],a[232:235],a[136:139],v[76:79]
s_waitcnt vmcnt(6)
s_barrier
v_mfma_f32_16x16x32_bf16 v[76:79],a[236:239],a[140:143],v[76:79]
v_mfma_f32_16x16x32_bf16 v[84:87],a[216:219],a[144:147],0
ds_read_b64_tr_b16 a[240:241],v3 offset:24576
ds_read_b64_tr_b16 a[242:243],v3 offset:30720
v_mfma_f32_16x16x32_bf16 v[84:87],a[220:223],a[148:151],v[84:87]
v_mfma_f32_16x16x32_bf16 v[84:87],a[224:227],a[152:155],v[84:87]
ds_read_b64_tr_b16 a[244:245],v4 offset:24576
ds_read_b64_tr_b16 a[246:247],v4 offset:30720
v_mfma_f32_16x16x32_bf16 v[84:87],a[228:231],a[156:159],v[84:87]
v_mfma_f32_16x16x32_bf16 v[84:87],a[232:235],a[160:163],v[84:87]
ds_read_b64_tr_b16 a[248:249],v5 offset:24576
ds_read_b64_tr_b16 a[250:251],v5 offset:30720
v_mfma_f32_16x16x32_bf16 v[84:87],a[236:239],a[164:167],v[84:87]
v_mfma_f32_16x16x32_bf16 v[92:95],a[216:219],a[168:171],0
ds_read_b64_tr_b16 a[252:253],v6 offset:24576
ds_read_b64_tr_b16 a[254:255],v6 offset:30720
v_mfma_f32_16x16x32_bf16 v[92:95],a[220:223],a[172:175],v[92:95]
v_mfma_f32_16x16x32_bf16 v[92:95],a[224:227],a[176:179],v[92:95]
v_mfma_f32_16x16x32_bf16 v[92:95],a[228:231],a[180:183],v[92:95]
v_mfma_f32_16x16x32_bf16 v[92:95],a[232:235],a[184:187],v[92:95]
v_mfma_f32_16x16x32_bf16 v[92:95],a[236:239],a[188:191],v[92:95]
s_mov_b32 s38,0
s_branch L_loop4
L_start3:
s_add_u32 m0,s22,0
s_nop 0
buffer_load_dwordx4 v7,s[4:7],s20 offen offset:0 lds
s_add_u32 m0,s22,896
s_nop 0
buffer_load_dwordx4 v7,s[4:7],s20 offen offset:128 lds
s_add_u32 m0,s22,1792
s_nop 0
buffer_load_dwordx4 v7,s[4:7],s20 offen offset:256 lds
s_add_u32 s20,s20,12288
s_mov_b32 s28,s41
s_add_u32 m0,s24,0
s_nop 0
buffer_load_dwordx4 v8,s[12:15],s28 offen offset:0 nt lds
s_add_u32 m0,s24,896
s_nop 0
buffer_load_dwordx4 v8,s[12:15],s28 offen offset:128 nt lds
s_add_u32 m0,s24,1792
s_nop 0
buffer_load_dwordx4 v8,s[12:15],s28 offen offset:256 nt lds
s_add_u32 s28,s28,3072
s_add_u32 m0,s24,3072
s_nop 0
buffer_load_dwordx4 v9,s[12:15],s28 offen offset:0 nt lds
s_add_u32 m0,s24,3968
s_nop 0
buffer_load_dwordx4 v9,s[12:15],s28 offen offset:128 nt lds
s_add_u32 m0,s24,4864
s_nop 0
buffer_load_dwordx4 v9,s[12:15],s28 offen offset:256 nt lds
s_add_u32 s28,s28,3072
s_add_u32 m0,s24,6144
s_nop 0
buffer_load_dwordx4 v8,s[12:15],s28 offen offset:0 nt lds
s_add_u32 m0,s24,7040
s_nop 0
buffer_load_dwordx4 v8,s[12:15],s28 offen offset:128 nt lds
s_add_u32 m0,s24,7936
s_nop 0
buffer_load_dwordx4 v8,s[12:15],s28 offen offset:256 nt lds
s_add_u32 s28,s28,3072
s_add_u32 m0,s24,9216
s_nop 0
buffer_load_dwordx4 v9,s[12:15],s28 offen offset:0 nt lds
s_add_u32 m0,s24,10112
s_nop 0
buffer_load_dwordx4 v9,s[12:15],s28 offen offset:128 nt lds
s_add_u32 m0,s24,11008
s_nop 0
buffer_load_dwordx4 v9,s[12:15],s28 offen offset:256 nt lds
s_add_u32 s28,s28,3072
v_and_b32 v144,15,v0
v_lshrrev_b32 v145,4,v0
v_lshrrev_b32 v146,3,v144
v_mul_u32_u24 v1,3072,v146
v_and_b32 v147,7,v144
v_lshl_add_u32 v1,v147,7,v1
v_bfe_u32 v147,v144,1,2
v_lshlrev_b32 v147,1,v147
v_mul_u32_u24 v148,5,v146
v_xor_b32 v147,v147,v148
v_xor_b32 v147,v147,v145
v_lshl_add_u32 v1,v147,4,v1
v_xor_b32 v2,64,v1
v_mul_u32_u24 v148,19456,v146
v_add_u32 v148,92160,v148
v_add_u32 v13,v148,v1
v_add_u32 v28,s24,v1
v_add_u32 v14,v148,v2
v_add_u32 v29,s24,v2
v_lshrrev_b32 v146,1,v145
v_mul_u32_u24 v3,3072,v146
v_and_b32 v147,1,v145
v_bfe_u32 v148,v0,2,2
v_lshl_add_u32 v144,v147,2,v148
v_lshl_add_u32 v3,v144,7,v3
v_lshrrev_b32 v144,1,v144
v_lshlrev_b32 v144,1,v144
v_mul_u32_u24 v146,5,v146
v_xor_b32 v144,v144,v146
v_bfe_u32 v147,v0,1,1
v_xor_b32 v144,v144,v147
v_lshl_add_u32 v3,v144,4,v3
v_and_b32 v147,1,v0
v_lshl_add_u32 v3,v147,3,v3
v_add_u32 v3,36864,v3
v_xor_b32 v4,32,v3
v_xor_b32 v5,64,v3
v_xor_b32 v6,96,v3
v_lshrrev_b32 v144,3,v0
v_and_b32 v145,7,v0
v_lshrrev_b32 v147,5,v0
v_xor_b32 v147,v147,v145
v_lshlrev_b32 v12,7,v145
v_lshl_add_u32 v12,v147,4,v12
v_bfe_u32 v146,v0,4,1
v_lshl_add_u32 v12,v146,3,v12
v_bfe_u32 v146,v0,3,1
v_mul_u32_u24 v146,3072,v146
v_add3_u32 v12,v12,v146,s24
v_xor_b32 v20,32,v12
v_xor_b32 v21,64,v12
v_xor_b32 v22,96,v12
v_xor_b32 v146,v145,v144
v_lshlrev_b32 v15,7,v144
v_lshl_add_u32 v15,v146,4,v15
v_add_u32 v15,s24,v15
v_mov_b32 v11,v15
v_mul_u32_u24 v10,384,v144
v_lshl_add_u32 v10,v145,4,v10
v_mov_b32 v24,0x3f803f80
v_mov_b32 v25,0x3f803f80
v_mov_b32 v26,0x3f803f80
v_mov_b32 v27,0x3f803f80
s_waitcnt vmcnt(12)
s_barrier
ds_read_b128 a[192:195],v1 offset:0
ds_read_b128 a[196:199],v2 offset:0
ds_read_b128 a[200:203],v1 offset:1024
ds_read_b128 a[204:207],v2 offset:1024
ds_read_b128 a[208:211],v1 offset:2048
ds_read_b128 a[212:215],v2 offset:2048
ds_read_b128 a[216:219],v1 offset:6144
ds_read_b128 a[220:223],v2 offset:6144
ds_read_b128 a[224:227],v1 offset:7168
ds_read_b128 a[228:231],v2 offset:7168
ds_read_b128 a[232:235],v1 offset:8192
ds_read_b128 a[236:239],v2 offset:8192
s_waitcnt vmcnt(6)
ds_read_b128 a[96:99],v28 offset:0
s_add_u32 m0,s24,12288
ds_read_b128 a[100:103],v29 offset:0
ds_read_b128 a[104:107],v28 offset:1024
ds_read_b128 a[108:111],v29 offset:1024
ds_read_b128 a[112:115],v28 offset:2048
ds_read_b128 a[116:119],v29 offset:2048
s_waitcnt lgkmcnt(5)
v_mfma_f32_16x16x32_bf16 v[32:35],a[192:195],a[96:99],0
buffer_load_dwordx4 v8,s[12:15],s28 offen offset:0 nt lds
s_add_u32 m0,s24,13184
s_waitcnt lgkmcnt(4)
v_mfma_f32_16x16x32_bf16 v[32:35],a[196:199],a[100:103],v[32:35]
buffer_load_dwordx4 v8,s[12:15],s28 offen offset:128 nt lds
s_add_u32 m0,s24,14080
s_waitcnt lgkmcnt(3)
v_mfma_f32_16x16x32_bf16 v[32:35],a[200:203],a[104:107],v[32:35]
buffer_load_dwordx4 v8,s[12:15],s28 offen offset:256 nt lds
s_add_u32 s28,s28,3072
s_add_u32 m0,s24,15360
s_waitcnt lgkmcnt(2)
v_mfma_f32_16x16x32_bf16 v[32:35],a[204:207],a[108:111],v[32:35]
buffer_load_dwordx4 v9,s[12:15],s28 offen offset:0 nt lds
s_add_u32 m0,s24,16256
s_waitcnt lgkmcnt(1)
v_mfma_f32_16x16x32_bf16 v[32:35],a[208:211],a[112:115],v[32:35]
buffer_load_dwordx4 v9,s[12:15],s28 offen offset:128 nt lds
s_add_u32 m0,s24,17152
s_waitcnt lgkmcnt(0)
v_mfma_f32_16x16x32_bf16 v[32:35],a[212:215],a[116:119],v[32:35]
buffer_load_dwordx4 v9,s[12:15],s28 offen offset:256 nt lds
s_add_u32 s28,s28,3072
s_add_u32 m0,s22,12288
v_mfma_f32_16x16x32_bf16 v[36:39],a[216:219],a[96:99],0
v_mfma_f32_16x16x32_bf16 v[36:39],a[220:223],a[100:103],v[36:39]
v_mfma_f32_16x16x32_bf16 v[36:39],a[224:227],a[104:107],v[36:39]
v_mfma_f32_16x16x32_bf16 v[36:39],a[228:231],a[108:111],v[36:39]
v_mfma_f32_16x16x32_bf16 v[36:39],a[232:235],a[112:115],v[36:39]
v_mfma_f32_16x16x32_bf16 v[36:39],a[236:239],a[116:119],v[36:39]
s_waitcnt vmcnt(6)
ds_read_b128 a[120:123],v28 offset:6144
ds_read_b128 a[124:127],v29 offset:6144
ds_read_b128 a[128:131],v28 offset:7168
ds_read_b128 a[132:135],v29 offset:7168
ds_read_b128 a[136:139],v28 offset:8192
ds_read_b128 a[140:143],v29 offset:8192
s_waitcnt lgkmcnt(5)
v_mfma_f32_16x16x32_bf16 v[40:43],a[192:195],a[120:123],0
buffer_load_dwordx4 v7,s[4:7],s20 offen offset:0 lds
s_add_u32 m0,s22,13184
s_waitcnt lgkmcnt(4)
v_mfma_f32_16x16x32_bf16 v[40:43],a[196:199],a[124:127],v[40:43]
buffer_load_dwordx4 v7,s[4:7],s20 offen offset:128 lds
s_add_u32 m0,s22,14080
s_waitcnt lgkmcnt(3)
v_mfma_f32_16x16x32_bf16 v[40:43],a[200:203],a[128:131],v[40:43]
buffer_load_dwordx4 v7,s[4:7],s20 offen offset:256 lds
s_add_u32 s20,s20,12288
s_add_u32 m0,s23,0
s_waitcnt lgkmcnt(2)
v_mfma_f32_16x16x32_bf16 v[40:43],a[204:207],a[132:135],v[40:43]
s_waitcnt lgkmcnt(1)
v_mfma_f32_16x16x32_bf16 v[40:43],a[208:211],a[136:139],v[40:43]
s_waitcnt lgkmcnt(0)
v_mfma_f32_16x16x32_bf16 v[40:43],a[212:215],a[140:143],v[40:43]
v_mfma_f32_16x16x32_bf16 v[44:47],a[216:219],a[120:123],0
v_mfma_f32_16x16x32_bf16 v[44:47],a[220:223],a[124:127],v[44:47]
v_mfma_f32_16x16x32_bf16 v[44:47],a[224:227],a[128:131],v[44:47]
v_mfma_f32_16x16x32_bf16 v[44:47],a[228:231],a[132:135],v[44:47]
v_mfma_f32_16x16x32_bf16 v[44:47],a[232:235],a[136:139],v[44:47]
v_mfma_f32_16x16x32_bf16 v[44:47],a[236:239],a[140:143],v[44:47]
s_waitcnt vmcnt(3)
ds_read_b128 a[144:147],v28 offset:12288
ds_read_b128 a[148:151],v29 offset:12288
ds_read_b128 a[152:155],v28 offset:13312
ds_read_b128 a[156:159],v29 offset:13312
ds_read_b128 a[160:163],v28 offset:14336
ds_read_b128 a[164:167],v29 offset:14336
s_waitcnt lgkmcnt(5)
v_mfma_f32_16x16x32_bf16 v[48:51],a[192:195],a[144:147],0
buffer_load_dwordx4 v7,s[8:11],s21 offen offset:0 lds
s_add_u32 m0,s23,896
s_waitcnt lgkmcnt(4)
v_mfma_f32_16x16x32_bf16 v[48:51],a[196:199],a[148:151],v[48:51]
buffer_load_dwordx4 v7,s[8:11],s21 offen offset:128 lds
s_add_u32 m0,s23,1792
s_waitcnt lgkmcnt(3)
v_mfma_f32_16x16x32_bf16 v[48:51],a[200:203],a[152:155],v[48:51]
buffer_load_dwordx4 v7,s[8:11],s21 offen offset:256 lds
s_add_u32 s21,s21,12288
s_add_u32 m0,s22,24576
s_waitcnt lgkmcnt(2)
v_mfma_f32_16x16x32_bf16 v[48:51],a[204:207],a[156:159],v[48:51]
buffer_load_dwordx4 v7,s[4:7],s20 offen offset:0 lds
s_add_u32 m0,s22,25472
s_waitcnt lgkmcnt(1)
v_mfma_f32_16x16x32_bf16 v[48:51],a[208:211],a[160:163],v[48:51]
buffer_load_dwordx4 v7,s[4:7],s20 offen offset:128 lds
s_add_u32 m0,s22,26368
s_waitcnt lgkmcnt(0)
v_mfma_f32_16x16x32_bf16 v[48:51],a[212:215],a[164:167],v[48:51]
buffer_load_dwordx4 v7,s[4:7],s20 offen offset:256 lds
s_add_u32 s20,s20,12288
s_mov_b32 s27,166723584
v_mfma_f32_16x16x32_bf16 v[52:55],a[216:219],a[144:147],0
s_mov_b32 s42,s41
s_add_u32 s69,s69,1
s_add_u32 s48,s48,325632
v_mfma_f32_16x16x32_bf16 v[52:55],a[220:223],a[148:151],v[52:55]
s_lshr_b32 s62,s39,s69
s_and_b32 s62,s62,1
s_lshl_b32 s62,s62,1
v_mfma_f32_16x16x32_bf16 v[52:55],a[224:227],a[152:155],v[52:55]
s_add_u32 s62,s62,s49
s_and_b32 s62,s62,3
s_add_u32 s63,s69,8
v_mfma_f32_16x16x32_bf16 v[52:55],a[228:231],a[156:159],v[52:55]
s_lshr_b32 s63,s39,s63
s_and_b32 s63,s63,1
s_xor_b32 s62,s62,s63
v_mfma_f32_16x16x32_bf16 v[52:55],a[232:235],a[160:163],v[52:55]
s_mul_i32 s63,s3,3
s_lshl_b32 s64,s3,2
s_mov_b32 s40,1
v_mfma_f32_16x16x32_bf16 v[52:55],a[236:239],a[164:167],v[52:55]
s_waitcnt vmcnt(6)
s_barrier
s_add_u32 s65,s63,17
s_cmp_eq_u32 s3,0
s_cselect_b32 s65,16,s65
s_cselect_b32 s41,1,0
s_cmp_eq_u32 s62,1
s_cselect_b32 s64,s65,s64
s_cselect_b32 s40,s41,s40
s_add_u32 s65,s63,29
s_cmp_eq_u32 s62,2
s_cselect_b32 s64,s65,s64
s_cselect_b32 s40,0,s40
s_add_u32 s65,s63,41
s_cmp_eq_u32 s62,3
s_cselect_b32 s64,s65,s64
s_cselect_b32 s40,0,s40
s_mul_i32 s64,s64,6144
s_add_u32 s41,s48,s64
s_cmp_ge_u32 s69,8
s_cselect_b32 s41,166723584,s41
s_mov_b32 s28,s41
s_mov_b32 s29,s24
s_add_u32 s25,s22,12288
s_add_u32 s26,s22,24576
ds_read_b128 a[192:195],v1 offset:12288
v_max3_f32 v144,v32,v33,v34
v_max3_f32 v144,v144,v35,v36
v_max3_f32 v144,v144,v37,v38
v_max_f32 v144,v144,v39
v_mov_b32 v145,v144
v_max3_f32 v146,v40,v41,v42
v_max3_f32 v146,v146,v43,v44
v_permlane32_swap_b32 v145,v144
s_add_u32 m0,s23,12288
v_max_f32 v144,v144,v145
v_mov_b32 v145,v144
v_max3_f32 v146,v146,v45,v46
v_max_f32 v146,v146,v47
v_permlane16_swap_b32 v145,v144
v_max_f32 v144,v144,v145
v_mul_f32_e64 v16,-s36,v144
v_max3_f32 v144,v48,v49,v50
v_max3_f32 v144,v144,v51,v52
v_max3_f32 v144,v144,v53,v54
v_max_f32 v144,v144,v55
v_mov_b32 v147,v146
v_mov_b32 v145,v144
v_fma_f32 v32,v32,s36,v16
v_permlane32_swap_b32 v147,v146
v_permlane32_swap_b32 v145,v144
v_max_f32 v146,v146,v147
v_max_f32 v144,v144,v145
v_mov_b32 v147,v146
v_mov_b32 v145,v144
v_fma_f32 v33,v33,s36,v16
v_permlane16_swap_b32 v147,v146
s_waitcnt lgkmcnt(0)
v_mfma_f32_16x16x32_bf16 v[64:67],a[192:195],a[96:99],0
buffer_load_dwordx4 v7,s[8:11],s21 offen offset:0 lds
s_add_u32 m0,s23,13184
ds_read_b128 a[196:199],v2 offset:12288
v_permlane16_swap_b32 v145,v144
v_max_f32 v146,v146,v147
v_max_f32 v144,v144,v145
v_mul_f32_e64 v17,-s36,v146
v_mul_f32_e64 v18,-s36,v144
v_fma_f32 v34,v34,s36,v16
v_fma_f32 v35,v35,s36,v16
v_fma_f32 v36,v36,s36,v16
v_fma_f32 v37,v37,s36,v16
v_fma_f32 v38,v38,s36,v16
v_fma_f32 v39,v39,s36,v16
v_fma_f32 v40,v40,s36,v17
v_fma_f32 v41,v41,s36,v17
v_fma_f32 v42,v42,s36,v17
v_fma_f32 v43,v43,s36,v17
v_fma_f32 v44,v44,s36,v17
v_fma_f32 v45,v45,s36,v17
v_fma_f32 v46,v46,s36,v17
v_fma_f32 v47,v47,s36,v17
v_fma_f32 v48,v48,s36,v18
v_fma_f32 v49,v49,s36,v18
v_fma_f32 v50,v50,s36,v18
v_fma_f32 v51,v51,s36,v18
v_fma_f32 v52,v52,s36,v18
v_fma_f32 v53,v53,s36,v18
v_fma_f32 v54,v54,s36,v18
v_fma_f32 v55,v55,s36,v18
v_exp_f32 v32,v32
v_exp_f32 v33,v33
v_exp_f32 v34,v34
s_waitcnt lgkmcnt(0)
v_mfma_f32_16x16x32_bf16 v[64:67],a[196:199],a[100:103],v[64:67]
buffer_load_dwordx4 v7,s[8:11],s21 offen offset:128 lds
s_add_u32 m0,s23,14080
ds_read_b128 a[200:203],v1 offset:13312
buffer_load_dwordx4 v7,s[8:11],s21 offen offset:256 lds
s_add_u32 s21,s21,12288
s_add_u32 m0,s22,0
ds_read_b128 a[204:207],v2 offset:13312
v_exp_f32 v35,v35
v_exp_f32 v36,v36
v_exp_f32 v37,v37
v_exp_f32 v38,v38
v_exp_f32 v39,v39
v_exp_f32 v40,v40
v_exp_f32 v41,v41
v_exp_f32 v42,v42
v_exp_f32 v43,v43
v_exp_f32 v44,v44
v_exp_f32 v45,v45
v_exp_f32 v46,v46
v_exp_f32 v47,v47
v_exp_f32 v48,v48
v_exp_f32 v49,v49
s_waitcnt lgkmcnt(1)
v_mfma_f32_16x16x32_bf16 v[64:67],a[200:203],a[104:107],v[64:67]
buffer_load_dwordx4 v7,s[4:7],s20 offen offset:0 lds
s_add_u32 m0,s22,896
s_waitcnt lgkmcnt(0)
v_mfma_f32_16x16x32_bf16 v[64:67],a[204:207],a[108:111],v[64:67]
ds_read_b128 a[208:211],v1 offset:14336
v_exp_f32 v50,v50
v_exp_f32 v51,v51
v_exp_f32 v52,v52
v_exp_f32 v53,v53
v_exp_f32 v54,v54
v_exp_f32 v55,v55
v_cvt_pk_bf16_f32 v96,v32,v33
v_cvt_pk_bf16_f32 v97,v34,v35
v_cvt_pk_bf16_f32 v98,v36,v37
v_cvt_pk_bf16_f32 v99,v38,v39
v_cvt_pk_bf16_f32 v100,v40,v41
v_cvt_pk_bf16_f32 v101,v42,v43
v_mfma_f32_16x16x32_bf16 v[128:131],v[24:27],v[96:99],0
ds_read_b128 a[212:215],v2 offset:14336
v_cvt_pk_bf16_f32 v102,v44,v45
v_cvt_pk_bf16_f32 v103,v46,v47
v_cvt_pk_bf16_f32 v104,v48,v49
v_cvt_pk_bf16_f32 v105,v50,v51
v_mfma_f32_16x16x32_bf16 v[132:135],v[24:27],v[100:103],0
ds_read_b128 a[216:219],v1 offset:18432
v_cvt_pk_bf16_f32 v106,v52,v53
v_cvt_pk_bf16_f32 v107,v54,v55
buffer_load_dwordx4 v7,s[4:7],s20 offen offset:128 lds
s_add_u32 m0,s22,1792
v_mfma_f32_16x16x32_bf16 v[136:139],v[24:27],v[104:107],0
s_waitcnt lgkmcnt(2)
ds_read_b128 a[220:223],v2 offset:18432
v_mfma_f32_16x16x32_bf16 v[64:67],a[208:211],a[112:115],v[64:67]
ds_read_b128 a[224:227],v1 offset:19456
ds_read_b128 a[228:231],v2 offset:19456
ds_read_b128 a[232:235],v1 offset:20480
ds_read_b128 a[236:239],v2 offset:20480
s_waitcnt lgkmcnt(6)
v_mfma_f32_16x16x32_bf16 v[64:67],a[212:215],a[116:119],v[64:67]
v_mfma_f32_16x16x32_bf16 v[72:75],a[192:195],a[120:123],0
v_mfma_f32_16x16x32_bf16 v[72:75],a[196:199],a[124:127],v[72:75]
v_mfma_f32_16x16x32_bf16 v[72:75],a[200:203],a[128:131],v[72:75]
buffer_load_dwordx4 v7,s[4:7],s20 offen offset:256 lds
s_add_u32 s20,s20,12288
v_mfma_f32_16x16x32_bf16 v[72:75],a[204:207],a[132:135],v[72:75]
v_mfma_f32_16x16x32_bf16 v[72:75],a[208:211],a[136:139],v[72:75]
v_mfma_f32_16x16x32_bf16 v[72:75],a[212:215],a[140:143],v[72:75]
v_fma_f32 v64,v64,s36,v16
v_fma_f32 v65,v65,s36,v16
v_mfma_f32_16x16x32_bf16 v[80:83],a[192:195],a[144:147],0
v_fma_f32 v66,v66,s36,v16
v_fma_f32 v67,v67,s36,v16
v_mfma_f32_16x16x32_bf16 v[80:83],a[196:199],a[148:151],v[80:83]
v_exp_f32 v64,v64
v_mfma_f32_16x16x32_bf16 v[80:83],a[200:203],a[152:155],v[80:83]
v_fma_f32 v72,v72,s36,v17
v_fma_f32 v73,v73,s36,v17
v_mfma_f32_16x16x32_bf16 v[80:83],a[204:207],a[156:159],v[80:83]
v_fma_f32 v74,v74,s36,v17
v_fma_f32 v75,v75,s36,v17
v_mfma_f32_16x16x32_bf16 v[80:83],a[208:211],a[160:163],v[80:83]
v_exp_f32 v65,v65
v_mfma_f32_16x16x32_bf16 v[80:83],a[212:215],a[164:167],v[80:83]
s_waitcnt lgkmcnt(0)
v_exp_f32 v66,v66
v_mfma_f32_16x16x32_bf16 v[68:71],a[216:219],a[96:99],0
v_exp_f32 v67,v67
v_mfma_f32_16x16x32_bf16 v[68:71],a[220:223],a[100:103],v[68:71]
v_exp_f32 v72,v72
v_mfma_f32_16x16x32_bf16 v[68:71],a[224:227],a[104:107],v[68:71]
s_waitcnt vmcnt(6)
s_barrier
v_exp_f32 v73,v73
v_mfma_f32_16x16x32_bf16 v[68:71],a[228:231],a[108:111],v[68:71]
v_exp_f32 v74,v74
v_mfma_f32_16x16x32_bf16 v[68:71],a[232:235],a[112:115],v[68:71]
ds_read_b64_tr_b16 a[240:241],v3 offset:0
ds_read_b64_tr_b16 a[242:243],v3 offset:6144
v_mfma_f32_16x16x32_bf16 v[68:71],a[236:239],a[116:119],v[68:71]
ds_read_b64_tr_b16 a[244:245],v4 offset:0
ds_read_b64_tr_b16 a[246:247],v4 offset:6144
v_mfma_f32_16x16x32_bf16 v[76:79],a[216:219],a[120:123],0
v_exp_f32 v75,v75
v_mfma_f32_16x16x32_bf16 v[76:79],a[220:223],a[124:127],v[76:79]
ds_read_b64_tr_b16 a[248:249],v5 offset:0
ds_read_b64_tr_b16 a[250:251],v5 offset:6144
v_mfma_f32_16x16x32_bf16 v[76:79],a[224:227],a[128:131],v[76:79]
ds_read_b64_tr_b16 a[252:253],v6 offset:0
ds_read_b64_tr_b16 a[254:255],v6 offset:6144
v_mfma_f32_16x16x32_bf16 v[76:79],a[228:231],a[132:135],v[76:79]
v_cvt_pk_bf16_f32 v112,v64,v65
v_cvt_pk_bf16_f32 v113,v66,v67
v_mfma_f32_16x16x32_bf16 v[76:79],a[232:235],a[136:139],v[76:79]
v_cvt_pk_bf16_f32 v116,v72,v73
v_cvt_pk_bf16_f32 v117,v74,v75
v_mfma_f32_16x16x32_bf16 v[76:79],a[236:239],a[140:143],v[76:79]
v_mfma_f32_16x16x32_bf16 v[84:87],a[216:219],a[144:147],0
v_mfma_f32_16x16x32_bf16 v[84:87],a[220:223],a[148:151],v[84:87]
v_mfma_f32_16x16x32_bf16 v[84:87],a[224:227],a[152:155],v[84:87]
v_mfma_f32_16x16x32_bf16 v[84:87],a[228:231],a[156:159],v[84:87]
v_mfma_f32_16x16x32_bf16 v[84:87],a[232:235],a[160:163],v[84:87]
v_mfma_f32_16x16x32_bf16 v[84:87],a[236:239],a[164:167],v[84:87]
s_waitcnt lgkmcnt(0)
v_mfma_f32_16x16x32_bf16 v[160:163],a[240:243],v[96:99],0
s_add_u32 m0,s23,24576
ds_read_b128 a[192:195],v1 offset:24576
v_fma_f32 v68,v68,s36,v16
v_mfma_f32_16x16x32_bf16 v[208:211],a[240:243],v[100:103],0
buffer_load_dwordx4 v7,s[8:11],s21 offen offset:0 lds
v_mfma_f32_16x16x32_bf16 a[0:3],a[240:243],v[104:107],0
s_add_u32 m0,s23,25472
ds_read_b64_tr_b16 a[240:241],v3 offset:1024
ds_read_b64_tr_b16 a[242:243],v3 offset:7168
v_mfma_f32_16x16x32_bf16 v[164:167],a[244:247],v[96:99],0
ds_read_b128 a[196:199],v2 offset:24576
v_fma_f32 v69,v69,s36,v16
v_mfma_f32_16x16x32_bf16 v[212:215],a[244:247],v[100:103],0
ds_read_b128 a[200:203],v1 offset:25600
v_fma_f32 v70,v70,s36,v16
v_mfma_f32_16x16x32_bf16 a[4:7],a[244:247],v[104:107],0
ds_read_b64_tr_b16 a[244:245],v4 offset:1024
ds_read_b64_tr_b16 a[246:247],v4 offset:7168
v_mfma_f32_16x16x32_bf16 v[168:171],a[248:251],v[96:99],0
ds_read_b128 a[204:207],v2 offset:25600
v_fma_f32 v71,v71,s36,v16
v_mfma_f32_16x16x32_bf16 v[216:219],a[248:251],v[100:103],0
buffer_load_dwordx4 v7,s[8:11],s21 offen offset:128 lds
v_mfma_f32_16x16x32_bf16 a[8:11],a[248:251],v[104:107],0
s_add_u32 m0,s23,26368
ds_read_b64_tr_b16 a[248:249],v5 offset:1024
ds_read_b64_tr_b16 a[250:251],v5 offset:7168
v_mfma_f32_16x16x32_bf16 v[172:175],a[252:255],v[96:99],0
ds_read_b128 a[208:211],v1 offset:26624
v_fma_f32 v76,v76,s36,v17
v_mfma_f32_16x16x32_bf16 v[220:223],a[252:255],v[100:103],0
ds_read_b128 a[212:215],v2 offset:26624
v_fma_f32 v77,v77,s36,v17
v_mfma_f32_16x16x32_bf16 a[12:15],a[252:255],v[104:107],0
s_waitcnt lgkmcnt(8)
ds_read_b64_tr_b16 a[252:253],v6 offset:1024
ds_read_b64_tr_b16 a[254:255],v6 offset:7168
v_mfma_f32_16x16x32_bf16 v[176:179],a[240:243],v[96:99],0
buffer_load_dwordx4 v7,s[8:11],s21 offen offset:256 lds
v_mfma_f32_16x16x32_bf16 v[224:227],a[240:243],v[100:103],0
s_add_u32 s21,s21,12288
ds_read_b128 a[216:219],v1 offset:30720
v_fma_f32 v78,v78,s36,v17
v_mfma_f32_16x16x32_bf16 a[16:19],a[240:243],v[104:107],0
s_add_u32 m0,s22,12288
ds_read_b64_tr_b16 a[240:241],v3 offset:2048
ds_read_b64_tr_b16 a[242:243],v3 offset:8192
s_waitcnt lgkmcnt(9)
v_mfma_f32_16x16x32_bf16 v[180:183],a[244:247],v[96:99],0
ds_read_b128 a[220:223],v2 offset:30720
v_fma_f32 v79,v79,s36,v17
v_mfma_f32_16x16x32_bf16 v[228:231],a[244:247],v[100:103],0
ds_read_b128 a[224:227],v1 offset:31744
v_fma_f32 v80,v80,s36,v18
v_mfma_f32_16x16x32_bf16 a[20:23],a[244:247],v[104:107],0
s_waitcnt lgkmcnt(8)
ds_read_b64_tr_b16 a[244:245],v4 offset:2048
ds_read_b64_tr_b16 a[246:247],v4 offset:8192
v_mfma_f32_16x16x32_bf16 v[184:187],a[248:251],v[96:99],0
buffer_load_dwordx4 v7,s[4:7],s20 offen offset:0 lds
v_mfma_f32_16x16x32_bf16 v[232:235],a[248:251],v[100:103],0
s_add_u32 m0,s22,13184
ds_read_b128 a[228:231],v2 offset:31744
v_fma_f32 v81,v81,s36,v18
v_mfma_f32_16x16x32_bf16 a[24:27],a[248:251],v[104:107],0
s_waitcnt lgkmcnt(8)
ds_read_b64_tr_b16 a[248:249],v5 offset:2048
ds_read_b64_tr_b16 a[250:251],v5 offset:8192
v_mfma_f32_16x16x32_bf16 v[188:191],a[252:255],v[96:99],0
ds_read_b128 a[232:235],v1 offset:32768
v_fma_f32 v82,v82,s36,v18
v_mfma_f32_16x16x32_bf16 v[236:239],a[252:255],v[100:103],0
ds_read_b128 a[236:239],v2 offset:32768
v_fma_f32 v83,v83,s36,v18
v_mfma_f32_16x16x32_bf16 a[28:31],a[252:255],v[104:107],0
s_waitcnt lgkmcnt(8)
ds_read_b64_tr_b16 a[252:253],v6 offset:2048
ds_read_b64_tr_b16 a[254:255],v6 offset:8192
v_mfma_f32_16x16x32_bf16 v[192:195],a[240:243],v[96:99],0
buffer_load_dwordx4 v7,s[4:7],s20 offen offset:128 lds
v_mfma_f32_16x16x32_bf16 v[240:243],a[240:243],v[100:103],0
s_add_u32 m0,s22,14080
v_fma_f32 v84,v84,s36,v18
v_fma_f32 v85,v85,s36,v18
v_mfma_f32_16x16x32_bf16 a[32:35],a[240:243],v[104:107],0
s_waitcnt lgkmcnt(7)
v_fma_f32 v86,v86,s36,v18
v_fma_f32 v87,v87,s36,v18
v_mfma_f32_16x16x32_bf16 v[196:199],a[244:247],v[96:99],0
v_exp_f32 v68,v68
v_mfma_f32_16x16x32_bf16 v[244:247],a[244:247],v[100:103],0
v_exp_f32 v69,v69
v_mfma_f32_16x16x32_bf16 a[36:39],a[244:247],v[104:107],0
s_waitcnt lgkmcnt(3)
v_exp_f32 v70,v70
v_mfma_f32_16x16x32_bf16 v[200:203],a[248:251],v[96:99],0
buffer_load_dwordx4 v7,s[4:7],s20 offen offset:256 lds
v_mfma_f32_16x16x32_bf16 v[248:251],a[248:251],v[100:103],0
s_add_u32 s20,s20,12288
v_exp_f32 v71,v71
v_mfma_f32_16x16x32_bf16 a[40:43],a[248:251],v[104:107],0
s_waitcnt lgkmcnt(0)
v_exp_f32 v76,v76
v_mfma_f32_16x16x32_bf16 v[204:207],a[252:255],v[96:99],0
v_exp_f32 v77,v77
v_mfma_f32_16x16x32_bf16 v[252:255],a[252:255],v[100:103],0
v_exp_f32 v78,v78
v_mfma_f32_16x16x32_bf16 a[44:47],a[252:255],v[104:107],0
v_exp_f32 v79,v79
v_mfma_f32_16x16x32_bf16 v[32:35],a[192:195],a[96:99],0
v_exp_f32 v80,v80
v_mfma_f32_16x16x32_bf16 v[32:35],a[196:199],a[100:103],v[32:35]
v_exp_f32 v81,v81
v_mfma_f32_16x16x32_bf16 v[32:35],a[200:203],a[104:107],v[32:35]
v_exp_f32 v82,v82
v_mfma_f32_16x16x32_bf16 v[32:35],a[204:207],a[108:111],v[32:35]
v_exp_f32 v83,v83
v_mfma_f32_16x16x32_bf16 v[32:35],a[208:211],a[112:115],v[32:35]
v_exp_f32 v84,v84
v_mfma_f32_16x16x32_bf16 v[32:35],a[212:215],a[116:119],v[32:35]
v_exp_f32 v85,v85
v_mfma_f32_16x16x32_bf16 v[40:43],a[192:195],a[120:123],0
v_exp_f32 v86,v86
v_mfma_f32_16x16x32_bf16 v[40:43],a[196:199],a[124:127],v[40:43]
v_exp_f32 v87,v87
v_mfma_f32_16x16x32_bf16 v[40:43],a[200:203],a[128:131],v[40:43]
v_cvt_pk_bf16_f32 v114,v68,v69
v_cvt_pk_bf16_f32 v115,v70,v71
v_mfma_f32_16x16x32_bf16 v[40:43],a[204:207],a[132:135],v[40:43]
v_cvt_pk_bf16_f32 v118,v76,v77
v_cvt_pk_bf16_f32 v119,v78,v79
v_mfma_f32_16x16x32_bf16 v[128:131],v[24:27],v[112:115],v[128:131]
v_cvt_pk_bf16_f32 v120,v80,v81
v_cvt_pk_bf16_f32 v121,v82,v83
v_mfma_f32_16x16x32_bf16 v[132:135],v[24:27],v[116:119],v[132:135]
v_cvt_pk_bf16_f32 v122,v84,v85
v_cvt_pk_bf16_f32 v123,v86,v87
v_mfma_f32_16x16x32_bf16 v[40:43],a[208:211],a[136:139],v[40:43]
v_fma_f32 v32,v32,s36,v16
v_fma_f32 v33,v33,s36,v16
v_mfma_f32_16x16x32_bf16 v[136:139],v[24:27],v[120:123],v[136:139]
v_fma_f32 v34,v34,s36,v16
v_fma_f32 v35,v35,s36,v16
v_mfma_f32_16x16x32_bf16 v[40:43],a[212:215],a[140:143],v[40:43]
v_exp_f32 v32,v32
v_mfma_f32_16x16x32_bf16 v[48:51],a[192:195],a[144:147],0
v_exp_f32 v33,v33
v_mfma_f32_16x16x32_bf16 v[48:51],a[196:199],a[148:151],v[48:51]
v_exp_f32 v34,v34
v_mfma_f32_16x16x32_bf16 v[48:51],a[200:203],a[152:155],v[48:51]
v_exp_f32 v35,v35
v_mfma_f32_16x16x32_bf16 v[48:51],a[204:207],a[156:159],v[48:51]
v_fma_f32 v40,v40,s36,v17
v_fma_f32 v41,v41,s36,v17
v_mfma_f32_16x16x32_bf16 v[48:51],a[208:211],a[160:163],v[48:51]
v_fma_f32 v42,v42,s36,v17
v_fma_f32 v43,v43,s36,v17
v_mfma_f32_16x16x32_bf16 v[48:51],a[212:215],a[164:167],v[48:51]
v_exp_f32 v40,v40
v_mfma_f32_16x16x32_bf16 v[36:39],a[216:219],a[96:99],0
v_exp_f32 v41,v41
v_mfma_f32_16x16x32_bf16 v[36:39],a[220:223],a[100:103],v[36:39]
v_exp_f32 v42,v42
v_mfma_f32_16x16x32_bf16 v[36:39],a[224:227],a[104:107],v[36:39]
v_exp_f32 v43,v43
v_mfma_f32_16x16x32_bf16 v[36:39],a[228:231],a[108:111],v[36:39]
v_cvt_pk_bf16_f32 v96,v32,v33
v_cvt_pk_bf16_f32 v97,v34,v35
s_waitcnt vmcnt(6)
s_barrier
v_mfma_f32_16x16x32_bf16 v[36:39],a[232:235],a[112:115],v[36:39]
v_cvt_pk_bf16_f32 v100,v40,v41
v_cvt_pk_bf16_f32 v101,v42,v43
v_mfma_f32_16x16x32_bf16 v[36:39],a[236:239],a[116:119],v[36:39]
ds_read_b64_tr_b16 a[240:241],v3 offset:12288
ds_read_b64_tr_b16 a[242:243],v3 offset:18432
v_mfma_f32_16x16x32_bf16 v[44:47],a[216:219],a[120:123],0
v_mfma_f32_16x16x32_bf16 v[44:47],a[220:223],a[124:127],v[44:47]
ds_read_b64_tr_b16 a[244:245],v4 offset:12288
ds_read_b64_tr_b16 a[246:247],v4 offset:18432
v_mfma_f32_16x16x32_bf16 v[44:47],a[224:227],a[128:131],v[44:47]
ds_read_b64_tr_b16 a[248:249],v5 offset:12288
ds_read_b64_tr_b16 a[250:251],v5 offset:18432
v_mfma_f32_16x16x32_bf16 v[44:47],a[228:231],a[132:135],v[44:47]
v_mfma_f32_16x16x32_bf16 v[44:47],a[232:235],a[136:139],v[44:47]
ds_read_b64_tr_b16 a[252:253],v6 offset:12288
ds_read_b64_tr_b16 a[254:255],v6 offset:18432
v_mfma_f32_16x16x32_bf16 v[44:47],a[236:239],a[140:143],v[44:47]
v_mfma_f32_16x16x32_bf16 v[52:55],a[216:219],a[144:147],0
v_mfma_f32_16x16x32_bf16 v[52:55],a[220:223],a[148:151],v[52:55]
v_mfma_f32_16x16x32_bf16 v[52:55],a[224:227],a[152:155],v[52:55]
v_mfma_f32_16x16x32_bf16 v[52:55],a[228:231],a[156:159],v[52:55]
v_mfma_f32_16x16x32_bf16 v[52:55],a[232:235],a[160:163],v[52:55]
v_mfma_f32_16x16x32_bf16 v[52:55],a[236:239],a[164:167],v[52:55]
s_waitcnt lgkmcnt(2)
v_mfma_f32_16x16x32_bf16 v[160:163],a[240:243],v[112:115],v[160:163]
s_add_u32 m0,s23,0
ds_read_b128 a[192:195],v1 offset:0
v_fma_f32 v36,v36,s36,v16
v_mfma_f32_16x16x32_bf16 v[208:211],a[240:243],v[116:119],v[208:211]
buffer_load_dwordx4 v7,s[8:11],s21 offen offset:0 lds
v_mfma_f32_16x16x32_bf16 a[0:3],a[240:243],v[120:123],a[0:3]
s_add_u32 m0,s23,896
ds_read_b64_tr_b16 a[240:241],v3 offset:13312
ds_read_b64_tr_b16 a[242:243],v3 offset:19456
v_mfma_f32_16x16x32_bf16 v[164:167],a[244:247],v[112:115],v[164:167]
ds_read_b128 a[196:199],v2 offset:0
v_fma_f32 v37,v37,s36,v16
v_mfma_f32_16x16x32_bf16 v[212:215],a[244:247],v[116:119],v[212:215]
ds_read_b128 a[200:203],v1 offset:1024
v_fma_f32 v38,v38,s36,v16
v_mfma_f32_16x16x32_bf16 a[4:7],a[244:247],v[120:123],a[4:7]
ds_read_b64_tr_b16 a[244:245],v4 offset:13312
ds_read_b64_tr_b16 a[246:247],v4 offset:19456
v_mfma_f32_16x16x32_bf16 v[168:171],a[248:251],v[112:115],v[168:171]
ds_read_b128 a[204:207],v2 offset:1024
v_fma_f32 v39,v39,s36,v16
v_mfma_f32_16x16x32_bf16 v[216:219],a[248:251],v[116:119],v[216:219]
buffer_load_dwordx4 v7,s[8:11],s21 offen offset:128 lds
v_mfma_f32_16x16x32_bf16 a[8:11],a[248:251],v[120:123],a[8:11]
s_add_u32 m0,s23,1792
ds_read_b64_tr_b16 a[248:249],v5 offset:13312
ds_read_b64_tr_b16 a[250:251],v5 offset:19456
s_waitcnt lgkmcnt(9)
v_mfma_f32_16x16x32_bf16 v[172:175],a[252:255],v[112:115],v[172:175]
ds_read_b128 a[208:211],v1 offset:2048
v_fma_f32 v44,v44,s36,v17
v_mfma_f32_16x16x32_bf16 v[220:223],a[252:255],v[116:119],v[220:223]
ds_read_b128 a[212:215],v2 offset:2048
v_fma_f32 v45,v45,s36,v17
v_mfma_f32_16x16x32_bf16 a[12:15],a[252:255],v[120:123],a[12:15]
s_waitcnt lgkmcnt(8)
ds_read_b64_tr_b16 a[252:253],v6 offset:13312
ds_read_b64_tr_b16 a[254:255],v6 offset:19456
v_mfma_f32_16x16x32_bf16 v[176:179],a[240:243],v[112:115],v[176:179]
buffer_load_dwordx4 v7,s[8:11],s21 offen offset:256 lds
v_mfma_f32_16x16x32_bf16 v[224:227],a[240:243],v[116:119],v[224:227]
s_add_u32 s21,s21,12288
ds_read_b128 a[216:219],v1 offset:6144
v_fma_f32 v46,v46,s36,v17
v_mfma_f32_16x16x32_bf16 a[16:19],a[240:243],v[120:123],a[16:19]
s_add_u32 m0,s22,24576
ds_read_b64_tr_b16 a[240:241],v3 offset:14336
ds_read_b64_tr_b16 a[242:243],v3 offset:20480
s_waitcnt lgkmcnt(9)
v_mfma_f32_16x16x32_bf16 v[180:183],a[244:247],v[112:115],v[180:183]
ds_read_b128 a[220:223],v2 offset:6144
v_fma_f32 v47,v47,s36,v17
v_mfma_f32_16x16x32_bf16 v[228:231],a[244:247],v[116:119],v[228:231]
ds_read_b128 a[224:227],v1 offset:7168
v_fma_f32 v48,v48,s36,v18
v_mfma_f32_16x16x32_bf16 a[20:23],a[244:247],v[120:123],a[20:23]
s_waitcnt lgkmcnt(8)
ds_read_b64_tr_b16 a[244:245],v4 offset:14336
ds_read_b64_tr_b16 a[246:247],v4 offset:20480
v_mfma_f32_16x16x32_bf16 v[184:187],a[248:251],v[112:115],v[184:187]
buffer_load_dwordx4 v7,s[4:7],s20 offen offset:0 lds
v_mfma_f32_16x16x32_bf16 v[232:235],a[248:251],v[116:119],v[232:235]
s_add_u32 m0,s22,25472
ds_read_b128 a[228:231],v2 offset:7168
v_fma_f32 v49,v49,s36,v18
v_mfma_f32_16x16x32_bf16 a[24:27],a[248:251],v[120:123],a[24:27]
s_waitcnt lgkmcnt(8)
ds_read_b64_tr_b16 a[248:249],v5 offset:14336
ds_read_b64_tr_b16 a[250:251],v5 offset:20480
v_mfma_f32_16x16x32_bf16 v[188:191],a[252:255],v[112:115],v[188:191]
ds_read_b128 a[232:235],v1 offset:8192
v_fma_f32 v50,v50,s36,v18
v_mfma_f32_16x16x32_bf16 v[236:239],a[252:255],v[116:119],v[236:239]
ds_read_b128 a[236:239],v2 offset:8192
v_fma_f32 v51,v51,s36,v18
v_mfma_f32_16x16x32_bf16 a[28:31],a[252:255],v[120:123],a[28:31]
s_waitcnt lgkmcnt(8)
ds_read_b64_tr_b16 a[252:253],v6 offset:14336
ds_read_b64_tr_b16 a[254:255],v6 offset:20480
v_mfma_f32_16x16x32_bf16 v[192:195],a[240:243],v[112:115],v[192:195]
buffer_load_dwordx4 v7,s[4:7],s20 offen offset:128 lds
v_mfma_f32_16x16x32_bf16 v[240:243],a[240:243],v[116:119],v[240:243]
s_add_u32 m0,s22,26368
v_fma_f32 v52,v52,s36,v18
v_fma_f32 v53,v53,s36,v18
v_mfma_f32_16x16x32_bf16 a[32:35],a[240:243],v[120:123],a[32:35]
s_waitcnt lgkmcnt(7)
v_fma_f32 v54,v54,s36,v18
v_fma_f32 v55,v55,s36,v18
v_mfma_f32_16x16x32_bf16 v[196:199],a[244:247],v[112:115],v[196:199]
v_exp_f32 v36,v36
v_mfma_f32_16x16x32_bf16 v[244:247],a[244:247],v[116:119],v[244:247]
v_exp_f32 v37,v37
v_mfma_f32_16x16x32_bf16 a[36:39],a[244:247],v[120:123],a[36:39]
s_waitcnt lgkmcnt(3)
v_exp_f32 v38,v38
v_mfma_f32_16x16x32_bf16 v[200:203],a[248:251],v[112:115],v[200:203]
buffer_load_dwordx4 v7,s[4:7],s20 offen offset:256 lds
v_mfma_f32_16x16x32_bf16 v[248:251],a[248:251],v[116:119],v[248:251]
s_add_u32 s20,s20,12288
v_exp_f32 v39,v39
v_mfma_f32_16x16x32_bf16 a[40:43],a[248:251],v[120:123],a[40:43]
s_waitcnt lgkmcnt(0)
v_exp_f32 v44,v44
v_mfma_f32_16x16x32_bf16 v[204:207],a[252:255],v[112:115],v[204:207]
v_exp_f32 v45,v45
v_mfma_f32_16x16x32_bf16 v[252:255],a[252:255],v[116:119],v[252:255]
v_exp_f32 v46,v46
v_mfma_f32_16x16x32_bf16 a[44:47],a[252:255],v[120:123],a[44:47]
v_exp_f32 v47,v47
v_mfma_f32_16x16x32_bf16 v[64:67],a[192:195],a[96:99],0
v_exp_f32 v48,v48
v_mfma_f32_16x16x32_bf16 v[64:67],a[196:199],a[100:103],v[64:67]
v_exp_f32 v49,v49
v_mfma_f32_16x16x32_bf16 v[64:67],a[200:203],a[104:107],v[64:67]
v_exp_f32 v50,v50
v_mfma_f32_16x16x32_bf16 v[64:67],a[204:207],a[108:111],v[64:67]
v_exp_f32 v51,v51
v_mfma_f32_16x16x32_bf16 v[64:67],a[208:211],a[112:115],v[64:67]
v_exp_f32 v52,v52
v_mfma_f32_16x16x32_bf16 v[64:67],a[212:215],a[116:119],v[64:67]
v_exp_f32 v53,v53
v_mfma_f32_16x16x32_bf16 v[72:75],a[192:195],a[120:123],0
v_exp_f32 v54,v54
v_mfma_f32_16x16x32_bf16 v[72:75],a[196:199],a[124:127],v[72:75]
v_exp_f32 v55,v55
v_mfma_f32_16x16x32_bf16 v[72:75],a[200:203],a[128:131],v[72:75]
v_cvt_pk_bf16_f32 v98,v36,v37
v_cvt_pk_bf16_f32 v99,v38,v39
v_mfma_f32_16x16x32_bf16 v[72:75],a[204:207],a[132:135],v[72:75]
v_cvt_pk_bf16_f32 v102,v44,v45
v_cvt_pk_bf16_f32 v103,v46,v47
v_mfma_f32_16x16x32_bf16 v[128:131],v[24:27],v[96:99],v[128:131]
v_cvt_pk_bf16_f32 v104,v48,v49
v_cvt_pk_bf16_f32 v105,v50,v51
v_mfma_f32_16x16x32_bf16 v[132:135],v[24:27],v[100:103],v[132:135]
v_cvt_pk_bf16_f32 v106,v52,v53
v_cvt_pk_bf16_f32 v107,v54,v55
v_mfma_f32_16x16x32_bf16 v[72:75],a[208:211],a[136:139],v[72:75]
v_fma_f32 v64,v64,s36,v16
v_fma_f32 v65,v65,s36,v16
v_mfma_f32_16x16x32_bf16 v[136:139],v[24:27],v[104:107],v[136:139]
v_fma_f32 v66,v66,s36,v16
v_fma_f32 v67,v67,s36,v16
v_mfma_f32_16x16x32_bf16 v[72:75],a[212:215],a[140:143],v[72:75]
v_exp_f32 v64,v64
v_mfma_f32_16x16x32_bf16 v[80:83],a[192:195],a[144:147],0
v_exp_f32 v65,v65
v_mfma_f32_16x16x32_bf16 v[80:83],a[196:199],a[148:151],v[80:83]
v_exp_f32 v66,v66
v_mfma_f32_16x16x32_bf16 v[80:83],a[200:203],a[152:155],v[80:83]
v_exp_f32 v67,v67
v_mfma_f32_16x16x32_bf16 v[80:83],a[204:207],a[156:159],v[80:83]
v_fma_f32 v72,v72,s36,v17
v_fma_f32 v73,v73,s36,v17
v_mfma_f32_16x16x32_bf16 v[80:83],a[208:211],a[160:163],v[80:83]
v_fma_f32 v74,v74,s36,v17
v_fma_f32 v75,v75,s36,v17
v_mfma_f32_16x16x32_bf16 v[80:83],a[212:215],a[164:167],v[80:83]
v_exp_f32 v72,v72
v_mfma_f32_16x16x32_bf16 v[68:71],a[216:219],a[96:99],0
v_exp_f32 v73,v73
v_mfma_f32_16x16x32_bf16 v[68:71],a[220:223],a[100:103],v[68:71]
v_exp_f32 v74,v74
v_mfma_f32_16x16x32_bf16 v[68:71],a[224:227],a[104:107],v[68:71]
v_exp_f32 v75,v75
v_mfma_f32_16x16x32_bf16 v[68:71],a[228:231],a[108:111],v[68:71]
v_cvt_pk_bf16_f32 v112,v64,v65
v_cvt_pk_bf16_f32 v113,v66,v67
s_waitcnt vmcnt(6)
s_barrier
v_mfma_f32_16x16x32_bf16 v[68:71],a[232:235],a[112:115],v[68:71]
v_cvt_pk_bf16_f32 v116,v72,v73
v_cvt_pk_bf16_f32 v117,v74,v75
v_mfma_f32_16x16x32_bf16 v[68:71],a[236:239],a[116:119],v[68:71]
ds_read_b64_tr_b16 a[240:241],v3 offset:24576
ds_read_b64_tr_b16 a[242:243],v3 offset:30720
v_mfma_f32_16x16x32_bf16 v[76:79],a[216:219],a[120:123],0
v_mfma_f32_16x16x32_bf16 v[76:79],a[220:223],a[124:127],v[76:79]
ds_read_b64_tr_b16 a[244:245],v4 offset:24576
ds_read_b64_tr_b16 a[246:247],v4 offset:30720
v_mfma_f32_16x16x32_bf16 v[76:79],a[224:227],a[128:131],v[76:79]
ds_read_b64_tr_b16 a[248:249],v5 offset:24576
ds_read_b64_tr_b16 a[250:251],v5 offset:30720
v_mfma_f32_16x16x32_bf16 v[76:79],a[228:231],a[132:135],v[76:79]
v_mfma_f32_16x16x32_bf16 v[76:79],a[232:235],a[136:139],v[76:79]
ds_read_b64_tr_b16 a[252:253],v6 offset:24576
ds_read_b64_tr_b16 a[254:255],v6 offset:30720
v_mfma_f32_16x16x32_bf16 v[76:79],a[236:239],a[140:143],v[76:79]
v_mfma_f32_16x16x32_bf16 v[84:87],a[216:219],a[144:147],0
v_mfma_f32_16x16x32_bf16 v[84:87],a[220:223],a[148:151],v[84:87]
v_mfma_f32_16x16x32_bf16 v[84:87],a[224:227],a[152:155],v[84:87]
v_mfma_f32_16x16x32_bf16 v[84:87],a[228:231],a[156:159],v[84:87]
v_mfma_f32_16x16x32_bf16 v[84:87],a[232:235],a[160:163],v[84:87]
v_mfma_f32_16x16x32_bf16 v[84:87],a[236:239],a[164:167],v[84:87]
s_mov_b32 s38,0
s_branch L_loop3
L_loop4:
s_bitcmp1_b32 s3,1
s_cbranch_scc1 L_loop4w1
.p2align 6
L_loop4w0:
s_waitcnt lgkmcnt(4)
v_mfma_f32_16x16x32_bf16 v[160:163],a[240:243],v[96:99],v[160:163]
s_add_u32 m0,s23,12288
ds_read_b128 a[192:195],v1 offset:12288
v_fma_f32 v68,v68,s36,v16
v_mfma_f32_16x16x32_bf16 v[208:211],a[240:243],v[100:103],v[208:211]
buffer_load_dwordx4 v7,s[8:11],s21 offen offset:0 lds
v_mfma_f32_16x16x32_bf16 a[0:3],a[240:243],v[104:107],a[0:3]
s_add_u32 m0,s23,13184
ds_read_b128 a[196:199],v2 offset:12288
v_fma_f32 v69,v69,s36,v16
v_mfma_f32_16x16x32_bf16 a[48:51],a[240:243],v[108:111],a[48:51]
ds_read_b64_tr_b16 a[240:241],v3 offset:25600
ds_read_b64_tr_b16 a[242:243],v3 offset:31744
v_mfma_f32_16x16x32_bf16 v[164:167],a[244:247],v[96:99],v[164:167]
ds_read_b128 a[200:203],v1 offset:13312
v_fma_f32 v70,v70,s36,v16
v_mfma_f32_16x16x32_bf16 v[212:215],a[244:247],v[100:103],v[212:215]
ds_read_b128 a[204:207],v2 offset:13312
v_fma_f32 v71,v71,s36,v16
v_mfma_f32_16x16x32_bf16 a[4:7],a[244:247],v[104:107],a[4:7]
ds_read_b128 a[208:211],v1 offset:14336
v_fma_f32 v76,v76,s36,v17
v_mfma_f32_16x16x32_bf16 a[52:55],a[244:247],v[108:111],a[52:55]
s_waitcnt lgkmcnt(7)
ds_read_b64_tr_b16 a[244:245],v4 offset:25600
ds_read_b64_tr_b16 a[246:247],v4 offset:31744
v_mfma_f32_16x16x32_bf16 v[168:171],a[248:251],v[96:99],v[168:171]
ds_read_b128 a[212:215],v2 offset:14336
v_fma_f32 v77,v77,s36,v17
v_mfma_f32_16x16x32_bf16 v[216:219],a[248:251],v[100:103],v[216:219]
buffer_load_dwordx4 v7,s[8:11],s21 offen offset:128 lds
v_mfma_f32_16x16x32_bf16 a[8:11],a[248:251],v[104:107],a[8:11]
s_add_u32 m0,s23,14080
ds_read_b128 a[216:219],v1 offset:18432
v_fma_f32 v78,v78,s36,v17
v_mfma_f32_16x16x32_bf16 a[56:59],a[248:251],v[108:111],a[56:59]
ds_read_b64_tr_b16 a[248:249],v5 offset:25600
ds_read_b64_tr_b16 a[250:251],v5 offset:31744
v_mfma_f32_16x16x32_bf16 v[172:175],a[252:255],v[96:99],v[172:175]
ds_read_b128 a[220:223],v2 offset:18432
v_fma_f32 v79,v79,s36,v17
v_mfma_f32_16x16x32_bf16 v[220:223],a[252:255],v[100:103],v[220:223]
ds_read_b128 a[224:227],v1 offset:19456
v_fma_f32 v80,v80,s36,v18
v_mfma_f32_16x16x32_bf16 a[12:15],a[252:255],v[104:107],a[12:15]
ds_read_b128 a[228:231],v2 offset:19456
v_fma_f32 v81,v81,s36,v18
v_mfma_f32_16x16x32_bf16 a[60:63],a[252:255],v[108:111],a[60:63]
s_waitcnt lgkmcnt(7)
ds_read_b64_tr_b16 a[252:253],v6 offset:25600
ds_read_b64_tr_b16 a[254:255],v6 offset:31744
v_mfma_f32_16x16x32_bf16 v[176:179],a[240:243],v[96:99],v[176:179]
ds_read_b128 a[232:235],v1 offset:20480
v_fma_f32 v82,v82,s36,v18
v_mfma_f32_16x16x32_bf16 v[224:227],a[240:243],v[100:103],v[224:227]
buffer_load_dwordx4 v7,s[8:11],s21 offen offset:256 lds
v_mfma_f32_16x16x32_bf16 a[16:19],a[240:243],v[104:107],a[16:19]
s_add_u32 s21,s21,12288
ds_read_b128 a[236:239],v2 offset:20480
v_fma_f32 v83,v83,s36,v18
v_mfma_f32_16x16x32_bf16 a[64:67],a[240:243],v[108:111],a[64:67]
s_add_u32 m0,s22,0
ds_read_b64_tr_b16 a[240:241],v3 offset:26624
ds_read_b64_tr_b16 a[242:243],v3 offset:32768
v_mfma_f32_16x16x32_bf16 v[180:183],a[244:247],v[96:99],v[180:183]
v_fma_f32 v84,v84,s36,v18
v_fma_f32 v85,v85,s36,v18
v_mfma_f32_16x16x32_bf16 v[228:231],a[244:247],v[100:103],v[228:231]
v_fma_f32 v86,v86,s36,v18
v_fma_f32 v87,v87,s36,v18
v_mfma_f32_16x16x32_bf16 a[20:23],a[244:247],v[104:107],a[20:23]
v_fma_f32 v88,v88,s36,v19
v_fma_f32 v89,v89,s36,v19
v_mfma_f32_16x16x32_bf16 a[68:71],a[244:247],v[108:111],a[68:71]
s_waitcnt lgkmcnt(4)
ds_read_b64_tr_b16 a[244:245],v4 offset:26624
ds_read_b64_tr_b16 a[246:247],v4 offset:32768
v_mfma_f32_16x16x32_bf16 v[184:187],a[248:251],v[96:99],v[184:187]
buffer_load_dwordx4 v7,s[4:7],s20 offen offset:0 lds
v_mfma_f32_16x16x32_bf16 v[232:235],a[248:251],v[100:103],v[232:235]
s_add_u32 m0,s22,896
v_fma_f32 v90,v90,s36,v19
v_fma_f32 v91,v91,s36,v19
v_mfma_f32_16x16x32_bf16 a[24:27],a[248:251],v[104:107],a[24:27]
v_fma_f32 v92,v92,s36,v19
v_fma_f32 v93,v93,s36,v19
v_mfma_f32_16x16x32_bf16 a[72:75],a[248:251],v[108:111],a[72:75]
ds_read_b64_tr_b16 a[248:249],v5 offset:26624
ds_read_b64_tr_b16 a[250:251],v5 offset:32768
v_mfma_f32_16x16x32_bf16 v[188:191],a[252:255],v[96:99],v[188:191]
v_fma_f32 v94,v94,s36,v19
v_fma_f32 v95,v95,s36,v19
v_mfma_f32_16x16x32_bf16 v[236:239],a[252:255],v[100:103],v[236:239]
v_exp_f32 v68,v68
v_mfma_f32_16x16x32_bf16 a[28:31],a[252:255],v[104:107],a[28:31]
v_exp_f32 v69,v69
v_mfma_f32_16x16x32_bf16 a[76:79],a[252:255],v[108:111],a[76:79]
s_waitcnt lgkmcnt(2)
ds_read_b64_tr_b16 a[252:253],v6 offset:26624
ds_read_b64_tr_b16 a[254:255],v6 offset:32768
v_mfma_f32_16x16x32_bf16 v[192:195],a[240:243],v[96:99],v[192:195]
buffer_load_dwordx4 v7,s[4:7],s20 offen offset:128 lds
v_mfma_f32_16x16x32_bf16 v[240:243],a[240:243],v[100:103],v[240:243]
s_add_u32 m0,s22,1792
v_exp_f32 v70,v70
v_mfma_f32_16x16x32_bf16 a[32:35],a[240:243],v[104:107],a[32:35]
v_exp_f32 v71,v71
v_mfma_f32_16x16x32_bf16 a[80:83],a[240:243],v[108:111],a[80:83]
v_exp_f32 v76,v76
v_mfma_f32_16x16x32_bf16 v[196:199],a[244:247],v[96:99],v[196:199]
v_exp_f32 v77,v77
v_mfma_f32_16x16x32_bf16 v[244:247],a[244:247],v[100:103],v[244:247]
ds_read_b128 v[152:155],v11 offset:0
v_cvt_pk_bf16_f32 v114,v68,v69
v_mfma_f32_16x16x32_bf16 a[36:39],a[244:247],v[104:107],a[36:39]
v_exp_f32 v78,v78
v_mfma_f32_16x16x32_bf16 a[84:87],a[244:247],v[108:111],a[84:87]
s_waitcnt lgkmcnt(1)
v_exp_f32 v79,v79
v_mfma_f32_16x16x32_bf16 v[200:203],a[248:251],v[96:99],v[200:203]
buffer_load_dwordx4 v7,s[4:7],s20 offen offset:256 lds
v_mfma_f32_16x16x32_bf16 v[248:251],a[248:251],v[100:103],v[248:251]
s_add_u32 s20,s20,12288
v_exp_f32 v80,v80
v_mfma_f32_16x16x32_bf16 a[40:43],a[248:251],v[104:107],a[40:43]
v_exp_f32 v81,v81
v_mfma_f32_16x16x32_bf16 a[88:91],a[248:251],v[108:111],a[88:91]
v_exp_f32 v82,v82
v_mfma_f32_16x16x32_bf16 v[204:207],a[252:255],v[96:99],v[204:207]
v_exp_f32 v83,v83
v_mfma_f32_16x16x32_bf16 v[252:255],a[252:255],v[100:103],v[252:255]
v_exp_f32 v84,v84
v_mfma_f32_16x16x32_bf16 a[44:47],a[252:255],v[104:107],a[44:47]
v_exp_f32 v85,v85
v_mfma_f32_16x16x32_bf16 a[92:95],a[252:255],v[108:111],a[92:95]
v_exp_f32 v86,v86
v_mfma_f32_16x16x32_bf16 v[32:35],a[192:195],a[96:99],0
v_exp_f32 v87,v87
v_mfma_f32_16x16x32_bf16 v[32:35],a[196:199],a[100:103],v[32:35]
v_exp_f32 v88,v88
v_mfma_f32_16x16x32_bf16 v[32:35],a[200:203],a[104:107],v[32:35]
v_exp_f32 v89,v89
v_mfma_f32_16x16x32_bf16 v[32:35],a[204:207],a[108:111],v[32:35]
v_exp_f32 v90,v90
v_mfma_f32_16x16x32_bf16 v[32:35],a[208:211],a[112:115],v[32:35]
v_exp_f32 v91,v91
v_mfma_f32_16x16x32_bf16 v[32:35],a[212:215],a[116:119],v[32:35]
s_waitcnt lgkmcnt(0)
buffer_store_dwordx4 v[152:155],v10,s[16:19],s27 offen offset:0 nt
v_mfma_f32_16x16x32_bf16 v[40:43],a[192:195],a[120:123],0
s_add_u32 m0,s29,0
v_exp_f32 v92,v92
v_mfma_f32_16x16x32_bf16 v[40:43],a[196:199],a[124:127],v[40:43]
v_exp_f32 v93,v93
v_mfma_f32_16x16x32_bf16 v[40:43],a[200:203],a[128:131],v[40:43]
ds_read_b128 v[156:159],v11 offset:1024
v_cvt_pk_bf16_f32 v115,v70,v71
v_mfma_f32_16x16x32_bf16 v[40:43],a[204:207],a[132:135],v[40:43]
v_exp_f32 v94,v94
v_mfma_f32_16x16x32_bf16 v[128:131],v[24:27],v[112:115],v[128:131]
v_exp_f32 v95,v95
v_mfma_f32_16x16x32_bf16 v[40:43],a[208:211],a[136:139],v[40:43]
v_cvt_pk_bf16_f32 v118,v76,v77
v_cvt_pk_bf16_f32 v119,v78,v79
v_mfma_f32_16x16x32_bf16 v[40:43],a[212:215],a[140:143],v[40:43]
v_cvt_pk_bf16_f32 v120,v80,v81
v_cvt_pk_bf16_f32 v121,v82,v83
v_mfma_f32_16x16x32_bf16 v[132:135],v[24:27],v[116:119],v[132:135]
buffer_load_dwordx4 v8,s[12:15],s28 offen offset:0 nt lds
v_mfma_f32_16x16x32_bf16 v[48:51],a[192:195],a[144:147],0
v_cvt_pk_bf16_f32 v122,v84,v85
v_cvt_pk_bf16_f32 v123,v86,v87
v_mfma_f32_16x16x32_bf16 v[48:51],a[196:199],a[148:151],v[48:51]
v_cvt_pk_bf16_f32 v124,v88,v89
v_cvt_pk_bf16_f32 v125,v90,v91
v_mfma_f32_16x16x32_bf16 v[136:139],v[24:27],v[120:123],v[136:139]
v_cvt_pk_bf16_f32 v126,v92,v93
v_cvt_pk_bf16_f32 v127,v94,v95
v_mfma_f32_16x16x32_bf16 v[48:51],a[200:203],a[152:155],v[48:51]
v_fma_f32 v32,v32,s36,v16
v_fma_f32 v33,v33,s36,v16
v_mfma_f32_16x16x32_bf16 v[140:143],v[24:27],v[124:127],v[140:143]
v_fma_f32 v34,v34,s36,v16
v_fma_f32 v35,v35,s36,v16
v_mfma_f32_16x16x32_bf16 v[48:51],a[204:207],a[156:159],v[48:51]
v_fma_f32 v40,v40,s36,v17
v_fma_f32 v41,v41,s36,v17
v_mfma_f32_16x16x32_bf16 v[48:51],a[208:211],a[160:163],v[48:51]
v_fma_f32 v42,v42,s36,v17
v_fma_f32 v43,v43,s36,v17
v_mfma_f32_16x16x32_bf16 v[48:51],a[212:215],a[164:167],v[48:51]
v_exp_f32 v32,v32
v_mfma_f32_16x16x32_bf16 v[56:59],a[192:195],a[168:171],0
s_waitcnt lgkmcnt(0)
buffer_store_dwordx4 v[156:159],v10,s[16:19],s27 offen offset:128 nt
v_mfma_f32_16x16x32_bf16 v[56:59],a[196:199],a[172:175],v[56:59]
s_add_u32 m0,s29,896
v_exp_f32 v33,v33
v_mfma_f32_16x16x32_bf16 v[56:59],a[200:203],a[176:179],v[56:59]
v_exp_f32 v34,v34
v_mfma_f32_16x16x32_bf16 v[56:59],a[204:207],a[180:183],v[56:59]
v_exp_f32 v35,v35
v_mfma_f32_16x16x32_bf16 v[56:59],a[208:211],a[184:187],v[56:59]
v_exp_f32 v40,v40
v_mfma_f32_16x16x32_bf16 v[56:59],a[212:215],a[188:191],v[56:59]
v_exp_f32 v41,v41
v_mfma_f32_16x16x32_bf16 v[36:39],a[216:219],a[96:99],0
v_exp_f32 v42,v42
v_mfma_f32_16x16x32_bf16 v[36:39],a[220:223],a[100:103],v[36:39]
v_exp_f32 v43,v43
v_mfma_f32_16x16x32_bf16 v[36:39],a[224:227],a[104:107],v[36:39]
buffer_load_dwordx4 v8,s[12:15],s28 offen offset:128 nt lds
v_mfma_f32_16x16x32_bf16 v[36:39],a[228:231],a[108:111],v[36:39]
v_cvt_pk_bf16_f32 v96,v32,v33
v_cvt_pk_bf16_f32 v97,v34,v35
v_mfma_f32_16x16x32_bf16 v[36:39],a[232:235],a[112:115],v[36:39]
v_cvt_pk_bf16_f32 v100,v40,v41
v_cvt_pk_bf16_f32 v101,v42,v43
v_mfma_f32_16x16x32_bf16 v[36:39],a[236:239],a[116:119],v[36:39]
v_mfma_f32_16x16x32_bf16 v[44:47],a[216:219],a[120:123],0
v_mfma_f32_16x16x32_bf16 v[44:47],a[220:223],a[124:127],v[44:47]
v_mfma_f32_16x16x32_bf16 v[44:47],a[224:227],a[128:131],v[44:47]
v_mfma_f32_16x16x32_bf16 v[44:47],a[228:231],a[132:135],v[44:47]
s_waitcnt vmcnt(10)
s_barrier
v_mfma_f32_16x16x32_bf16 v[44:47],a[232:235],a[136:139],v[44:47]
v_mfma_f32_16x16x32_bf16 v[44:47],a[236:239],a[140:143],v[44:47]
ds_read_b64_tr_b16 a[240:241],v3 offset:0
ds_read_b64_tr_b16 a[242:243],v3 offset:6144
v_mfma_f32_16x16x32_bf16 v[52:55],a[216:219],a[144:147],0
v_mfma_f32_16x16x32_bf16 v[52:55],a[220:223],a[148:151],v[52:55]
ds_read_b64_tr_b16 a[244:245],v4 offset:0
ds_read_b64_tr_b16 a[246:247],v4 offset:6144
v_mfma_f32_16x16x32_bf16 v[52:55],a[224:227],a[152:155],v[52:55]
v_mfma_f32_16x16x32_bf16 v[52:55],a[228:231],a[156:159],v[52:55]
ds_read_b64_tr_b16 a[248:249],v5 offset:0
ds_read_b64_tr_b16 a[250:251],v5 offset:6144
v_mfma_f32_16x16x32_bf16 v[52:55],a[232:235],a[160:163],v[52:55]
v_mfma_f32_16x16x32_bf16 v[52:55],a[236:239],a[164:167],v[52:55]
ds_read_b64_tr_b16 a[252:253],v6 offset:0
ds_read_b64_tr_b16 a[254:255],v6 offset:6144
v_mfma_f32_16x16x32_bf16 v[60:63],a[216:219],a[168:171],0
v_mfma_f32_16x16x32_bf16 v[60:63],a[220:223],a[172:175],v[60:63]
v_mfma_f32_16x16x32_bf16 v[60:63],a[224:227],a[176:179],v[60:63]
v_mfma_f32_16x16x32_bf16 v[60:63],a[228:231],a[180:183],v[60:63]
v_mfma_f32_16x16x32_bf16 v[60:63],a[232:235],a[184:187],v[60:63]
v_mfma_f32_16x16x32_bf16 v[60:63],a[236:239],a[188:191],v[60:63]
s_waitcnt lgkmcnt(4)
v_mfma_f32_16x16x32_bf16 v[160:163],a[240:243],v[112:115],v[160:163]
s_add_u32 m0,s23,24576
ds_read_b128 a[192:195],v1 offset:24576
v_fma_f32 v36,v36,s36,v16
v_mfma_f32_16x16x32_bf16 v[208:211],a[240:243],v[116:119],v[208:211]
buffer_load_dwordx4 v7,s[8:11],s21 offen offset:0 lds
v_mfma_f32_16x16x32_bf16 a[0:3],a[240:243],v[120:123],a[0:3]
s_add_u32 m0,s23,25472
ds_read_b128 a[196:199],v2 offset:24576
v_fma_f32 v37,v37,s36,v16
v_mfma_f32_16x16x32_bf16 a[48:51],a[240:243],v[124:127],a[48:51]
ds_read_b64_tr_b16 a[240:241],v3 offset:1024
ds_read_b64_tr_b16 a[242:243],v3 offset:7168
v_mfma_f32_16x16x32_bf16 v[164:167],a[244:247],v[112:115],v[164:167]
ds_read_b128 a[200:203],v1 offset:25600
v_fma_f32 v38,v38,s36,v16
v_mfma_f32_16x16x32_bf16 v[212:215],a[244:247],v[116:119],v[212:215]
ds_read_b128 a[204:207],v2 offset:25600
v_fma_f32 v39,v39,s36,v16
v_mfma_f32_16x16x32_bf16 a[4:7],a[244:247],v[120:123],a[4:7]
ds_read_b128 a[208:211],v1 offset:26624
v_fma_f32 v44,v44,s36,v17
v_mfma_f32_16x16x32_bf16 a[52:55],a[244:247],v[124:127],a[52:55]
s_waitcnt lgkmcnt(7)
ds_read_b64_tr_b16 a[244:245],v4 offset:1024
ds_read_b64_tr_b16 a[246:247],v4 offset:7168
v_mfma_f32_16x16x32_bf16 v[168:171],a[248:251],v[112:115],v[168:171]
ds_read_b128 a[212:215],v2 offset:26624
v_fma_f32 v45,v45,s36,v17
v_mfma_f32_16x16x32_bf16 v[216:219],a[248:251],v[116:119],v[216:219]
buffer_load_dwordx4 v7,s[8:11],s21 offen offset:128 lds
v_mfma_f32_16x16x32_bf16 a[8:11],a[248:251],v[120:123],a[8:11]
s_add_u32 m0,s23,26368
ds_read_b128 a[216:219],v1 offset:30720
v_fma_f32 v46,v46,s36,v17
v_mfma_f32_16x16x32_bf16 a[56:59],a[248:251],v[124:127],a[56:59]
ds_read_b64_tr_b16 a[248:249],v5 offset:1024
ds_read_b64_tr_b16 a[250:251],v5 offset:7168
v_mfma_f32_16x16x32_bf16 v[172:175],a[252:255],v[112:115],v[172:175]
ds_read_b128 a[220:223],v2 offset:30720
v_fma_f32 v47,v47,s36,v17
v_mfma_f32_16x16x32_bf16 v[220:223],a[252:255],v[116:119],v[220:223]
ds_read_b128 a[224:227],v1 offset:31744
v_fma_f32 v48,v48,s36,v18
v_mfma_f32_16x16x32_bf16 a[12:15],a[252:255],v[120:123],a[12:15]
ds_read_b128 a[228:231],v2 offset:31744
v_fma_f32 v49,v49,s36,v18
v_mfma_f32_16x16x32_bf16 a[60:63],a[252:255],v[124:127],a[60:63]
s_waitcnt lgkmcnt(7)
ds_read_b64_tr_b16 a[252:253],v6 offset:1024
ds_read_b64_tr_b16 a[254:255],v6 offset:7168
v_mfma_f32_16x16x32_bf16 v[176:179],a[240:243],v[112:115],v[176:179]
ds_read_b128 a[232:235],v1 offset:32768
v_fma_f32 v50,v50,s36,v18
v_mfma_f32_16x16x32_bf16 v[224:227],a[240:243],v[116:119],v[224:227]
buffer_load_dwordx4 v7,s[8:11],s21 offen offset:256 lds
v_mfma_f32_16x16x32_bf16 a[16:19],a[240:243],v[120:123],a[16:19]
s_add_u32 s21,s21,12288
ds_read_b128 a[236:239],v2 offset:32768
v_fma_f32 v51,v51,s36,v18
v_mfma_f32_16x16x32_bf16 a[64:67],a[240:243],v[124:127],a[64:67]
s_add_u32 m0,s22,12288
ds_read_b64_tr_b16 a[240:241],v3 offset:2048
ds_read_b64_tr_b16 a[242:243],v3 offset:8192
v_mfma_f32_16x16x32_bf16 v[180:183],a[244:247],v[112:115],v[180:183]
v_fma_f32 v52,v52,s36,v18
v_fma_f32 v53,v53,s36,v18
v_mfma_f32_16x16x32_bf16 v[228:231],a[244:247],v[116:119],v[228:231]
v_fma_f32 v54,v54,s36,v18
v_fma_f32 v55,v55,s36,v18
v_mfma_f32_16x16x32_bf16 a[20:23],a[244:247],v[120:123],a[20:23]
v_fma_f32 v56,v56,s36,v19
v_fma_f32 v57,v57,s36,v19
v_mfma_f32_16x16x32_bf16 a[68:71],a[244:247],v[124:127],a[68:71]
s_waitcnt lgkmcnt(4)
ds_read_b64_tr_b16 a[244:245],v4 offset:2048
ds_read_b64_tr_b16 a[246:247],v4 offset:8192
v_mfma_f32_16x16x32_bf16 v[184:187],a[248:251],v[112:115],v[184:187]
buffer_load_dwordx4 v7,s[4:7],s20 offen offset:0 lds
v_mfma_f32_16x16x32_bf16 v[232:235],a[248:251],v[116:119],v[232:235]
s_add_u32 m0,s22,13184
v_fma_f32 v58,v58,s36,v19
v_fma_f32 v59,v59,s36,v19
v_mfma_f32_16x16x32_bf16 a[24:27],a[248:251],v[120:123],a[24:27]
v_fma_f32 v60,v60,s36,v19
v_fma_f32 v61,v61,s36,v19
v_mfma_f32_16x16x32_bf16 a[72:75],a[248:251],v[124:127],a[72:75]
ds_read_b64_tr_b16 a[248:249],v5 offset:2048
ds_read_b64_tr_b16 a[250:251],v5 offset:8192
v_mfma_f32_16x16x32_bf16 v[188:191],a[252:255],v[112:115],v[188:191]
v_fma_f32 v62,v62,s36,v19
v_fma_f32 v63,v63,s36,v19
v_mfma_f32_16x16x32_bf16 v[236:239],a[252:255],v[116:119],v[236:239]
v_exp_f32 v36,v36
v_mfma_f32_16x16x32_bf16 a[28:31],a[252:255],v[120:123],a[28:31]
v_exp_f32 v37,v37
v_mfma_f32_16x16x32_bf16 a[76:79],a[252:255],v[124:127],a[76:79]
s_waitcnt lgkmcnt(2)
ds_read_b64_tr_b16 a[252:253],v6 offset:2048
ds_read_b64_tr_b16 a[254:255],v6 offset:8192
v_mfma_f32_16x16x32_bf16 v[192:195],a[240:243],v[112:115],v[192:195]
buffer_load_dwordx4 v7,s[4:7],s20 offen offset:128 lds
v_mfma_f32_16x16x32_bf16 v[240:243],a[240:243],v[116:119],v[240:243]
s_add_u32 m0,s22,14080
v_exp_f32 v38,v38
v_mfma_f32_16x16x32_bf16 a[32:35],a[240:243],v[120:123],a[32:35]
v_exp_f32 v39,v39
v_mfma_f32_16x16x32_bf16 a[80:83],a[240:243],v[124:127],a[80:83]
v_exp_f32 v44,v44
v_mfma_f32_16x16x32_bf16 v[196:199],a[244:247],v[112:115],v[196:199]
v_exp_f32 v45,v45
v_mfma_f32_16x16x32_bf16 v[244:247],a[244:247],v[116:119],v[244:247]
ds_read_b128 v[152:155],v11 offset:2048
v_cvt_pk_bf16_f32 v98,v36,v37
v_mfma_f32_16x16x32_bf16 a[36:39],a[244:247],v[120:123],a[36:39]
v_exp_f32 v46,v46
v_mfma_f32_16x16x32_bf16 a[84:87],a[244:247],v[124:127],a[84:87]
s_waitcnt lgkmcnt(1)
v_exp_f32 v47,v47
v_mfma_f32_16x16x32_bf16 v[200:203],a[248:251],v[112:115],v[200:203]
buffer_load_dwordx4 v7,s[4:7],s20 offen offset:256 lds
v_mfma_f32_16x16x32_bf16 v[248:251],a[248:251],v[116:119],v[248:251]
s_add_u32 s20,s20,12288
v_exp_f32 v48,v48
v_mfma_f32_16x16x32_bf16 a[40:43],a[248:251],v[120:123],a[40:43]
v_exp_f32 v49,v49
v_mfma_f32_16x16x32_bf16 a[88:91],a[248:251],v[124:127],a[88:91]
v_exp_f32 v50,v50
v_mfma_f32_16x16x32_bf16 v[204:207],a[252:255],v[112:115],v[204:207]
v_exp_f32 v51,v51
v_mfma_f32_16x16x32_bf16 v[252:255],a[252:255],v[116:119],v[252:255]
v_exp_f32 v52,v52
v_mfma_f32_16x16x32_bf16 a[44:47],a[252:255],v[120:123],a[44:47]
v_exp_f32 v53,v53
v_mfma_f32_16x16x32_bf16 a[92:95],a[252:255],v[124:127],a[92:95]
v_exp_f32 v54,v54
v_mfma_f32_16x16x32_bf16 v[64:67],a[192:195],a[96:99],0
v_exp_f32 v55,v55
v_mfma_f32_16x16x32_bf16 v[64:67],a[196:199],a[100:103],v[64:67]
v_exp_f32 v56,v56
v_mfma_f32_16x16x32_bf16 v[64:67],a[200:203],a[104:107],v[64:67]
v_exp_f32 v57,v57
v_mfma_f32_16x16x32_bf16 v[64:67],a[204:207],a[108:111],v[64:67]
v_exp_f32 v58,v58
v_mfma_f32_16x16x32_bf16 v[64:67],a[208:211],a[112:115],v[64:67]
v_exp_f32 v59,v59
v_mfma_f32_16x16x32_bf16 v[64:67],a[212:215],a[116:119],v[64:67]
s_waitcnt lgkmcnt(0)
buffer_store_dwordx4 v[152:155],v10,s[16:19],s27 offen offset:256 nt
v_mfma_f32_16x16x32_bf16 v[72:75],a[192:195],a[120:123],0
s_add_u32 m0,s29,1792
v_exp_f32 v60,v60
v_mfma_f32_16x16x32_bf16 v[72:75],a[196:199],a[124:127],v[72:75]
v_exp_f32 v61,v61
v_mfma_f32_16x16x32_bf16 v[72:75],a[200:203],a[128:131],v[72:75]
v_exp_f32 v62,v62
v_mfma_f32_16x16x32_bf16 v[72:75],a[204:207],a[132:135],v[72:75]
v_exp_f32 v63,v63
v_mfma_f32_16x16x32_bf16 v[72:75],a[208:211],a[136:139],v[72:75]
v_cvt_pk_bf16_f32 v99,v38,v39
v_cvt_pk_bf16_f32 v102,v44,v45
v_mfma_f32_16x16x32_bf16 v[72:75],a[212:215],a[140:143],v[72:75]
v_cvt_pk_bf16_f32 v103,v46,v47
v_cvt_pk_bf16_f32 v104,v48,v49
v_mfma_f32_16x16x32_bf16 v[128:131],v[24:27],v[96:99],v[128:131]
v_cvt_pk_bf16_f32 v105,v50,v51
v_cvt_pk_bf16_f32 v106,v52,v53
v_mfma_f32_16x16x32_bf16 v[132:135],v[24:27],v[100:103],v[132:135]
v_cvt_pk_bf16_f32 v107,v54,v55
v_cvt_pk_bf16_f32 v108,v56,v57
v_mfma_f32_16x16x32_bf16 v[80:83],a[192:195],a[144:147],0
v_cvt_pk_bf16_f32 v109,v58,v59
v_cvt_pk_bf16_f32 v110,v60,v61
v_mfma_f32_16x16x32_bf16 v[136:139],v[24:27],v[104:107],v[136:139]
v_cvt_pk_bf16_f32 v111,v62,v63
v_fma_f32 v64,v64,s36,v16
v_mfma_f32_16x16x32_bf16 v[80:83],a[196:199],a[148:151],v[80:83]
v_fma_f32 v65,v65,s36,v16
v_fma_f32 v66,v66,s36,v16
v_mfma_f32_16x16x32_bf16 v[140:143],v[24:27],v[108:111],v[140:143]
v_fma_f32 v67,v67,s36,v16
v_fma_f32 v72,v72,s36,v17
v_mfma_f32_16x16x32_bf16 v[80:83],a[200:203],a[152:155],v[80:83]
v_fma_f32 v73,v73,s36,v17
v_fma_f32 v74,v74,s36,v17
v_mfma_f32_16x16x32_bf16 v[80:83],a[204:207],a[156:159],v[80:83]
v_fma_f32 v75,v75,s36,v17
v_mfma_f32_16x16x32_bf16 v[80:83],a[208:211],a[160:163],v[80:83]
v_exp_f32 v64,v64
v_mfma_f32_16x16x32_bf16 v[80:83],a[212:215],a[164:167],v[80:83]
v_exp_f32 v65,v65
v_mfma_f32_16x16x32_bf16 v[88:91],a[192:195],a[168:171],0
buffer_load_dwordx4 v8,s[12:15],s28 offen offset:256 nt lds
v_mfma_f32_16x16x32_bf16 v[88:91],a[196:199],a[172:175],v[88:91]
s_add_u32 s27,s27,3072
v_exp_f32 v66,v66
v_mfma_f32_16x16x32_bf16 v[88:91],a[200:203],a[176:179],v[88:91]
s_add_u32 s28,s28,3072
v_exp_f32 v67,v67
v_mfma_f32_16x16x32_bf16 v[88:91],a[204:207],a[180:183],v[88:91]
s_add_u32 s29,s29,3072
v_exp_f32 v72,v72
v_mfma_f32_16x16x32_bf16 v[88:91],a[208:211],a[184:187],v[88:91]
v_exp_f32 v73,v73
v_mfma_f32_16x16x32_bf16 v[88:91],a[212:215],a[188:191],v[88:91]
v_exp_f32 v74,v74
v_mfma_f32_16x16x32_bf16 v[68:71],a[216:219],a[96:99],0
v_exp_f32 v75,v75
v_mfma_f32_16x16x32_bf16 v[68:71],a[220:223],a[100:103],v[68:71]
v_cvt_pk_bf16_f32 v112,v64,v65
v_cvt_pk_bf16_f32 v113,v66,v67
v_mfma_f32_16x16x32_bf16 v[68:71],a[224:227],a[104:107],v[68:71]
v_cvt_pk_bf16_f32 v116,v72,v73
v_cvt_pk_bf16_f32 v117,v74,v75
v_mfma_f32_16x16x32_bf16 v[68:71],a[228:231],a[108:111],v[68:71]
v_mfma_f32_16x16x32_bf16 v[68:71],a[232:235],a[112:115],v[68:71]
v_mfma_f32_16x16x32_bf16 v[68:71],a[236:239],a[116:119],v[68:71]
v_mfma_f32_16x16x32_bf16 v[76:79],a[216:219],a[120:123],0
v_mfma_f32_16x16x32_bf16 v[76:79],a[220:223],a[124:127],v[76:79]
v_mfma_f32_16x16x32_bf16 v[76:79],a[224:227],a[128:131],v[76:79]
v_mfma_f32_16x16x32_bf16 v[76:79],a[228:231],a[132:135],v[76:79]
s_waitcnt vmcnt(12)
s_barrier
v_mfma_f32_16x16x32_bf16 v[76:79],a[232:235],a[136:139],v[76:79]
v_mfma_f32_16x16x32_bf16 v[76:79],a[236:239],a[140:143],v[76:79]
ds_read_b64_tr_b16 a[240:241],v3 offset:12288
ds_read_b64_tr_b16 a[242:243],v3 offset:18432
v_mfma_f32_16x16x32_bf16 v[84:87],a[216:219],a[144:147],0
v_mfma_f32_16x16x32_bf16 v[84:87],a[220:223],a[148:151],v[84:87]
ds_read_b64_tr_b16 a[244:245],v4 offset:12288
ds_read_b64_tr_b16 a[246:247],v4 offset:18432
v_mfma_f32_16x16x32_bf16 v[84:87],a[224:227],a[152:155],v[84:87]
v_mfma_f32_16x16x32_bf16 v[84:87],a[228:231],a[156:159],v[84:87]
ds_read_b64_tr_b16 a[248:249],v5 offset:12288
ds_read_b64_tr_b16 a[250:251],v5 offset:18432
v_mfma_f32_16x16x32_bf16 v[84:87],a[232:235],a[160:163],v[84:87]
v_mfma_f32_16x16x32_bf16 v[84:87],a[236:239],a[164:167],v[84:87]
ds_read_b64_tr_b16 a[252:253],v6 offset:12288
ds_read_b64_tr_b16 a[254:255],v6 offset:18432
v_mfma_f32_16x16x32_bf16 v[92:95],a[216:219],a[168:171],0
v_mfma_f32_16x16x32_bf16 v[92:95],a[220:223],a[172:175],v[92:95]
v_mfma_f32_16x16x32_bf16 v[92:95],a[224:227],a[176:179],v[92:95]
v_mfma_f32_16x16x32_bf16 v[92:95],a[228:231],a[180:183],v[92:95]
v_mfma_f32_16x16x32_bf16 v[92:95],a[232:235],a[184:187],v[92:95]
v_mfma_f32_16x16x32_bf16 v[92:95],a[236:239],a[188:191],v[92:95]
s_waitcnt lgkmcnt(4)
v_mfma_f32_16x16x32_bf16 v[160:163],a[240:243],v[96:99],v[160:163]
s_add_u32 m0,s23,0
ds_read_b128 a[192:195],v1 offset:0
v_fma_f32 v68,v68,s36,v16
v_mfma_f32_16x16x32_bf16 v[208:211],a[240:243],v[100:103],v[208:211]
buffer_load_dwordx4 v7,s[8:11],s21 offen offset:0 lds
v_mfma_f32_16x16x32_bf16 a[0:3],a[240:243],v[104:107],a[0:3]
s_add_u32 m0,s23,896
ds_read_b128 a[196:199],v2 offset:0
v_fma_f32 v69,v69,s36,v16
v_mfma_f32_16x16x32_bf16 a[48:51],a[240:243],v[108:111],a[48:51]
ds_read_b64_tr_b16 a[240:241],v3 offset:13312
ds_read_b64_tr_b16 a[242:243],v3 offset:19456
v_mfma_f32_16x16x32_bf16 v[164:167],a[244:247],v[96:99],v[164:167]
ds_read_b128 a[200:203],v1 offset:1024
v_fma_f32 v70,v70,s36,v16
v_mfma_f32_16x16x32_bf16 v[212:215],a[244:247],v[100:103],v[212:215]
ds_read_b128 a[204:207],v2 offset:1024
v_fma_f32 v71,v71,s36,v16
v_mfma_f32_16x16x32_bf16 a[4:7],a[244:247],v[104:107],a[4:7]
ds_read_b128 a[208:211],v1 offset:2048
v_fma_f32 v76,v76,s36,v17
v_mfma_f32_16x16x32_bf16 a[52:55],a[244:247],v[108:111],a[52:55]
s_waitcnt lgkmcnt(7)
ds_read_b64_tr_b16 a[244:245],v4 offset:13312
ds_read_b64_tr_b16 a[246:247],v4 offset:19456
v_mfma_f32_16x16x32_bf16 v[168:171],a[248:251],v[96:99],v[168:171]
ds_read_b128 a[212:215],v2 offset:2048
v_fma_f32 v77,v77,s36,v17
v_mfma_f32_16x16x32_bf16 v[216:219],a[248:251],v[100:103],v[216:219]
buffer_load_dwordx4 v7,s[8:11],s21 offen offset:128 lds
v_mfma_f32_16x16x32_bf16 a[8:11],a[248:251],v[104:107],a[8:11]
s_add_u32 m0,s23,1792
ds_read_b128 a[216:219],v1 offset:6144
v_fma_f32 v78,v78,s36,v17
v_mfma_f32_16x16x32_bf16 a[56:59],a[248:251],v[108:111],a[56:59]
ds_read_b64_tr_b16 a[248:249],v5 offset:13312
ds_read_b64_tr_b16 a[250:251],v5 offset:19456
v_mfma_f32_16x16x32_bf16 v[172:175],a[252:255],v[96:99],v[172:175]
ds_read_b128 a[220:223],v2 offset:6144
v_fma_f32 v79,v79,s36,v17
v_mfma_f32_16x16x32_bf16 v[220:223],a[252:255],v[100:103],v[220:223]
ds_read_b128 a[224:227],v1 offset:7168
v_fma_f32 v80,v80,s36,v18
v_mfma_f32_16x16x32_bf16 a[12:15],a[252:255],v[104:107],a[12:15]
ds_read_b128 a[228:231],v2 offset:7168
v_fma_f32 v81,v81,s36,v18
v_mfma_f32_16x16x32_bf16 a[60:63],a[252:255],v[108:111],a[60:63]
s_waitcnt lgkmcnt(7)
ds_read_b64_tr_b16 a[252:253],v6 offset:13312
ds_read_b64_tr_b16 a[254:255],v6 offset:19456
v_mfma_f32_16x16x32_bf16 v[176:179],a[240:243],v[96:99],v[176:179]
ds_read_b128 a[232:235],v1 offset:8192
v_fma_f32 v82,v82,s36,v18
v_mfma_f32_16x16x32_bf16 v[224:227],a[240:243],v[100:103],v[224:227]
buffer_load_dwordx4 v7,s[8:11],s21 offen offset:256 lds
v_mfma_f32_16x16x32_bf16 a[16:19],a[240:243],v[104:107],a[16:19]
s_add_u32 s21,s21,12288
ds_read_b128 a[236:239],v2 offset:8192
v_fma_f32 v83,v83,s36,v18
v_mfma_f32_16x16x32_bf16 a[64:67],a[240:243],v[108:111],a[64:67]
s_add_u32 m0,s22,24576
ds_read_b64_tr_b16 a[240:241],v3 offset:14336
ds_read_b64_tr_b16 a[242:243],v3 offset:20480
v_mfma_f32_16x16x32_bf16 v[180:183],a[244:247],v[96:99],v[180:183]
v_fma_f32 v84,v84,s36,v18
v_fma_f32 v85,v85,s36,v18
v_mfma_f32_16x16x32_bf16 v[228:231],a[244:247],v[100:103],v[228:231]
v_fma_f32 v86,v86,s36,v18
v_fma_f32 v87,v87,s36,v18
v_mfma_f32_16x16x32_bf16 a[20:23],a[244:247],v[104:107],a[20:23]
v_fma_f32 v88,v88,s36,v19
v_fma_f32 v89,v89,s36,v19
v_mfma_f32_16x16x32_bf16 a[68:71],a[244:247],v[108:111],a[68:71]
s_waitcnt lgkmcnt(4)
ds_read_b64_tr_b16 a[244:245],v4 offset:14336
ds_read_b64_tr_b16 a[246:247],v4 offset:20480
v_mfma_f32_16x16x32_bf16 v[184:187],a[248:251],v[96:99],v[184:187]
buffer_load_dwordx4 v7,s[4:7],s20 offen offset:0 lds
v_mfma_f32_16x16x32_bf16 v[232:235],a[248:251],v[100:103],v[232:235]
s_add_u32 m0,s22,25472
v_fma_f32 v90,v90,s36,v19
v_fma_f32 v91,v91,s36,v19
v_mfma_f32_16x16x32_bf16 a[24:27],a[248:251],v[104:107],a[24:27]
v_fma_f32 v92,v92,s36,v19
v_fma_f32 v93,v93,s36,v19
v_mfma_f32_16x16x32_bf16 a[72:75],a[248:251],v[108:111],a[72:75]
ds_read_b64_tr_b16 a[248:249],v5 offset:14336
ds_read_b64_tr_b16 a[250:251],v5 offset:20480
v_mfma_f32_16x16x32_bf16 v[188:191],a[252:255],v[96:99],v[188:191]
v_fma_f32 v94,v94,s36,v19
v_fma_f32 v95,v95,s36,v19
v_mfma_f32_16x16x32_bf16 v[236:239],a[252:255],v[100:103],v[236:239]
v_exp_f32 v68,v68
v_mfma_f32_16x16x32_bf16 a[28:31],a[252:255],v[104:107],a[28:31]
v_exp_f32 v69,v69
v_mfma_f32_16x16x32_bf16 a[76:79],a[252:255],v[108:111],a[76:79]
s_waitcnt lgkmcnt(2)
ds_read_b64_tr_b16 a[252:253],v6 offset:14336
ds_read_b64_tr_b16 a[254:255],v6 offset:20480
v_mfma_f32_16x16x32_bf16 v[192:195],a[240:243],v[96:99],v[192:195]
buffer_load_dwordx4 v7,s[4:7],s20 offen offset:128 lds
v_mfma_f32_16x16x32_bf16 v[240:243],a[240:243],v[100:103],v[240:243]
s_add_u32 m0,s22,26368
v_exp_f32 v70,v70
v_mfma_f32_16x16x32_bf16 a[32:35],a[240:243],v[104:107],a[32:35]
v_exp_f32 v71,v71
v_mfma_f32_16x16x32_bf16 a[80:83],a[240:243],v[108:111],a[80:83]
v_exp_f32 v76,v76
v_mfma_f32_16x16x32_bf16 v[196:199],a[244:247],v[96:99],v[196:199]
v_exp_f32 v77,v77
v_mfma_f32_16x16x32_bf16 v[244:247],a[244:247],v[100:103],v[244:247]
ds_read_b128 v[156:159],v11 offset:3072
v_cvt_pk_bf16_f32 v114,v68,v69
v_mfma_f32_16x16x32_bf16 a[36:39],a[244:247],v[104:107],a[36:39]
v_exp_f32 v78,v78
v_mfma_f32_16x16x32_bf16 a[84:87],a[244:247],v[108:111],a[84:87]
s_waitcnt lgkmcnt(1)
v_exp_f32 v79,v79
v_mfma_f32_16x16x32_bf16 v[200:203],a[248:251],v[96:99],v[200:203]
buffer_load_dwordx4 v7,s[4:7],s20 offen offset:256 lds
v_mfma_f32_16x16x32_bf16 v[248:251],a[248:251],v[100:103],v[248:251]
s_add_u32 s20,s20,12288
v_exp_f32 v80,v80
v_mfma_f32_16x16x32_bf16 a[40:43],a[248:251],v[104:107],a[40:43]
v_exp_f32 v81,v81
v_mfma_f32_16x16x32_bf16 a[88:91],a[248:251],v[108:111],a[88:91]
v_exp_f32 v82,v82
v_mfma_f32_16x16x32_bf16 v[204:207],a[252:255],v[96:99],v[204:207]
v_exp_f32 v83,v83
v_mfma_f32_16x16x32_bf16 v[252:255],a[252:255],v[100:103],v[252:255]
v_exp_f32 v84,v84
v_mfma_f32_16x16x32_bf16 a[44:47],a[252:255],v[104:107],a[44:47]
v_exp_f32 v85,v85
v_mfma_f32_16x16x32_bf16 a[92:95],a[252:255],v[108:111],a[92:95]
v_exp_f32 v86,v86
v_mfma_f32_16x16x32_bf16 v[32:35],a[192:195],a[96:99],0
v_exp_f32 v87,v87
v_mfma_f32_16x16x32_bf16 v[32:35],a[196:199],a[100:103],v[32:35]
v_exp_f32 v88,v88
v_mfma_f32_16x16x32_bf16 v[32:35],a[200:203],a[104:107],v[32:35]
v_exp_f32 v89,v89
v_mfma_f32_16x16x32_bf16 v[32:35],a[204:207],a[108:111],v[32:35]
v_exp_f32 v90,v90
v_mfma_f32_16x16x32_bf16 v[32:35],a[208:211],a[112:115],v[32:35]
v_exp_f32 v91,v91
v_mfma_f32_16x16x32_bf16 v[32:35],a[212:215],a[116:119],v[32:35]
s_waitcnt lgkmcnt(0)
buffer_store_dwordx4 v[156:159],v10,s[16:19],s27 offen offset:0 nt
v_mfma_f32_16x16x32_bf16 v[40:43],a[192:195],a[120:123],0
s_add_u32 m0,s29,0
v_exp_f32 v92,v92
v_mfma_f32_16x16x32_bf16 v[40:43],a[196:199],a[124:127],v[40:43]
v_exp_f32 v93,v93
v_mfma_f32_16x16x32_bf16 v[40:43],a[200:203],a[128:131],v[40:43]
ds_read_b128 v[152:155],v11 offset:4096
v_cvt_pk_bf16_f32 v115,v70,v71
v_mfma_f32_16x16x32_bf16 v[40:43],a[204:207],a[132:135],v[40:43]
v_exp_f32 v94,v94
v_mfma_f32_16x16x32_bf16 v[128:131],v[24:27],v[112:115],v[128:131]
v_exp_f32 v95,v95
v_mfma_f32_16x16x32_bf16 v[40:43],a[208:211],a[136:139],v[40:43]
v_cvt_pk_bf16_f32 v118,v76,v77
v_cvt_pk_bf16_f32 v119,v78,v79
v_mfma_f32_16x16x32_bf16 v[40:43],a[212:215],a[140:143],v[40:43]
v_cvt_pk_bf16_f32 v120,v80,v81
v_cvt_pk_bf16_f32 v121,v82,v83
v_mfma_f32_16x16x32_bf16 v[132:135],v[24:27],v[116:119],v[132:135]
buffer_load_dwordx4 v9,s[12:15],s28 offen offset:0 nt lds
v_mfma_f32_16x16x32_bf16 v[48:51],a[192:195],a[144:147],0
v_cvt_pk_bf16_f32 v122,v84,v85
v_cvt_pk_bf16_f32 v123,v86,v87
v_mfma_f32_16x16x32_bf16 v[48:51],a[196:199],a[148:151],v[48:51]
v_cvt_pk_bf16_f32 v124,v88,v89
v_cvt_pk_bf16_f32 v125,v90,v91
v_mfma_f32_16x16x32_bf16 v[136:139],v[24:27],v[120:123],v[136:139]
v_cvt_pk_bf16_f32 v126,v92,v93
v_cvt_pk_bf16_f32 v127,v94,v95
v_mfma_f32_16x16x32_bf16 v[48:51],a[200:203],a[152:155],v[48:51]
v_fma_f32 v32,v32,s36,v16
v_fma_f32 v33,v33,s36,v16
v_mfma_f32_16x16x32_bf16 v[140:143],v[24:27],v[124:127],v[140:143]
v_fma_f32 v34,v34,s36,v16
v_fma_f32 v35,v35,s36,v16
v_mfma_f32_16x16x32_bf16 v[48:51],a[204:207],a[156:159],v[48:51]
v_fma_f32 v40,v40,s36,v17
v_fma_f32 v41,v41,s36,v17
v_mfma_f32_16x16x32_bf16 v[48:51],a[208:211],a[160:163],v[48:51]
v_fma_f32 v42,v42,s36,v17
v_fma_f32 v43,v43,s36,v17
v_mfma_f32_16x16x32_bf16 v[48:51],a[212:215],a[164:167],v[48:51]
v_exp_f32 v32,v32
v_mfma_f32_16x16x32_bf16 v[56:59],a[192:195],a[168:171],0
s_waitcnt lgkmcnt(0)
buffer_store_dwordx4 v[152:155],v10,s[16:19],s27 offen offset:128 nt
v_mfma_f32_16x16x32_bf16 v[56:59],a[196:199],a[172:175],v[56:59]
s_add_u32 m0,s29,896
v_exp_f32 v33,v33
v_mfma_f32_16x16x32_bf16 v[56:59],a[200:203],a[176:179],v[56:59]
v_exp_f32 v34,v34
v_mfma_f32_16x16x32_bf16 v[56:59],a[204:207],a[180:183],v[56:59]
v_exp_f32 v35,v35
v_mfma_f32_16x16x32_bf16 v[56:59],a[208:211],a[184:187],v[56:59]
v_exp_f32 v40,v40
v_mfma_f32_16x16x32_bf16 v[56:59],a[212:215],a[188:191],v[56:59]
v_exp_f32 v41,v41
v_mfma_f32_16x16x32_bf16 v[36:39],a[216:219],a[96:99],0
v_exp_f32 v42,v42
v_mfma_f32_16x16x32_bf16 v[36:39],a[220:223],a[100:103],v[36:39]
v_exp_f32 v43,v43
v_mfma_f32_16x16x32_bf16 v[36:39],a[224:227],a[104:107],v[36:39]
buffer_load_dwordx4 v9,s[12:15],s28 offen offset:128 nt lds
v_mfma_f32_16x16x32_bf16 v[36:39],a[228:231],a[108:111],v[36:39]
v_cvt_pk_bf16_f32 v96,v32,v33
v_cvt_pk_bf16_f32 v97,v34,v35
v_mfma_f32_16x16x32_bf16 v[36:39],a[232:235],a[112:115],v[36:39]
v_cvt_pk_bf16_f32 v100,v40,v41
v_cvt_pk_bf16_f32 v101,v42,v43
v_mfma_f32_16x16x32_bf16 v[36:39],a[236:239],a[116:119],v[36:39]
v_mfma_f32_16x16x32_bf16 v[44:47],a[216:219],a[120:123],0
v_mfma_f32_16x16x32_bf16 v[44:47],a[220:223],a[124:127],v[44:47]
v_mfma_f32_16x16x32_bf16 v[44:47],a[224:227],a[128:131],v[44:47]
v_mfma_f32_16x16x32_bf16 v[44:47],a[228:231],a[132:135],v[44:47]
s_waitcnt vmcnt(12)
s_barrier
v_mfma_f32_16x16x32_bf16 v[44:47],a[232:235],a[136:139],v[44:47]
v_mfma_f32_16x16x32_bf16 v[44:47],a[236:239],a[140:143],v[44:47]
ds_read_b64_tr_b16 a[240:241],v3 offset:24576
ds_read_b64_tr_b16 a[242:243],v3 offset:30720
v_mfma_f32_16x16x32_bf16 v[52:55],a[216:219],a[144:147],0
v_mfma_f32_16x16x32_bf16 v[52:55],a[220:223],a[148:151],v[52:55]
ds_read_b64_tr_b16 a[244:245],v4 offset:24576
ds_read_b64_tr_b16 a[246:247],v4 offset:30720
v_mfma_f32_16x16x32_bf16 v[52:55],a[224:227],a[152:155],v[52:55]
v_mfma_f32_16x16x32_bf16 v[52:55],a[228:231],a[156:159],v[52:55]
ds_read_b64_tr_b16 a[248:249],v5 offset:24576
ds_read_b64_tr_b16 a[250:251],v5 offset:30720
v_mfma_f32_16x16x32_bf16 v[52:55],a[232:235],a[160:163],v[52:55]
v_mfma_f32_16x16x32_bf16 v[52:55],a[236:239],a[164:167],v[52:55]
ds_read_b64_tr_b16 a[252:253],v6 offset:24576
ds_read_b64_tr_b16 a[254:255],v6 offset:30720
v_mfma_f32_16x16x32_bf16 v[60:63],a[216:219],a[168:171],0
v_mfma_f32_16x16x32_bf16 v[60:63],a[220:223],a[172:175],v[60:63]
v_mfma_f32_16x16x32_bf16 v[60:63],a[224:227],a[176:179],v[60:63]
v_mfma_f32_16x16x32_bf16 v[60:63],a[228:231],a[180:183],v[60:63]
v_mfma_f32_16x16x32_bf16 v[60:63],a[232:235],a[184:187],v[60:63]
v_mfma_f32_16x16x32_bf16 v[60:63],a[236:239],a[188:191],v[60:63]
s_waitcnt lgkmcnt(4)
v_mfma_f32_16x16x32_bf16 v[160:163],a[240:243],v[112:115],v[160:163]
s_add_u32 m0,s23,12288
ds_read_b128 a[192:195],v1 offset:12288
v_fma_f32 v36,v36,s36,v16
v_mfma_f32_16x16x32_bf16 v[208:211],a[240:243],v[116:119],v[208:211]
buffer_load_dwordx4 v7,s[8:11],s21 offen offset:0 lds
v_mfma_f32_16x16x32_bf16 a[0:3],a[240:243],v[120:123],a[0:3]
s_add_u32 m0,s23,13184
ds_read_b128 a[196:199],v2 offset:12288
v_fma_f32 v37,v37,s36,v16
v_mfma_f32_16x16x32_bf16 a[48:51],a[240:243],v[124:127],a[48:51]
ds_read_b64_tr_b16 a[240:241],v3 offset:25600
ds_read_b64_tr_b16 a[242:243],v3 offset:31744
v_mfma_f32_16x16x32_bf16 v[164:167],a[244:247],v[112:115],v[164:167]
ds_read_b128 a[200:203],v1 offset:13312
v_fma_f32 v38,v38,s36,v16
v_mfma_f32_16x16x32_bf16 v[212:215],a[244:247],v[116:119],v[212:215]
ds_read_b128 a[204:207],v2 offset:13312
v_fma_f32 v39,v39,s36,v16
v_mfma_f32_16x16x32_bf16 a[4:7],a[244:247],v[120:123],a[4:7]
ds_read_b128 a[208:211],v1 offset:14336
v_fma_f32 v44,v44,s36,v17
v_mfma_f32_16x16x32_bf16 a[52:55],a[244:247],v[124:127],a[52:55]
s_waitcnt lgkmcnt(7)
ds_read_b64_tr_b16 a[244:245],v4 offset:25600
ds_read_b64_tr_b16 a[246:247],v4 offset:31744
v_mfma_f32_16x16x32_bf16 v[168:171],a[248:251],v[112:115],v[168:171]
ds_read_b128 a[212:215],v2 offset:14336
v_fma_f32 v45,v45,s36,v17
v_mfma_f32_16x16x32_bf16 v[216:219],a[248:251],v[116:119],v[216:219]
buffer_load_dwordx4 v7,s[8:11],s21 offen offset:128 lds
v_mfma_f32_16x16x32_bf16 a[8:11],a[248:251],v[120:123],a[8:11]
s_add_u32 m0,s23,14080
ds_read_b128 a[216:219],v1 offset:18432
v_fma_f32 v46,v46,s36,v17
v_mfma_f32_16x16x32_bf16 a[56:59],a[248:251],v[124:127],a[56:59]
ds_read_b64_tr_b16 a[248:249],v5 offset:25600
ds_read_b64_tr_b16 a[250:251],v5 offset:31744
v_mfma_f32_16x16x32_bf16 v[172:175],a[252:255],v[112:115],v[172:175]
ds_read_b128 a[220:223],v2 offset:18432
v_fma_f32 v47,v47,s36,v17
v_mfma_f32_16x16x32_bf16 v[220:223],a[252:255],v[116:119],v[220:223]
ds_read_b128 a[224:227],v1 offset:19456
v_fma_f32 v48,v48,s36,v18
v_mfma_f32_16x16x32_bf16 a[12:15],a[252:255],v[120:123],a[12:15]
ds_read_b128 a[228:231],v2 offset:19456
v_fma_f32 v49,v49,s36,v18
v_mfma_f32_16x16x32_bf16 a[60:63],a[252:255],v[124:127],a[60:63]
s_waitcnt lgkmcnt(7)
ds_read_b64_tr_b16 a[252:253],v6 offset:25600
ds_read_b64_tr_b16 a[254:255],v6 offset:31744
v_mfma_f32_16x16x32_bf16 v[176:179],a[240:243],v[112:115],v[176:179]
ds_read_b128 a[232:235],v1 offset:20480
v_fma_f32 v50,v50,s36,v18
v_mfma_f32_16x16x32_bf16 v[224:227],a[240:243],v[116:119],v[224:227]
buffer_load_dwordx4 v7,s[8:11],s21 offen offset:256 lds
v_mfma_f32_16x16x32_bf16 a[16:19],a[240:243],v[120:123],a[16:19]
s_add_u32 s21,s21,12288
ds_read_b128 a[236:239],v2 offset:20480
v_fma_f32 v51,v51,s36,v18
v_mfma_f32_16x16x32_bf16 a[64:67],a[240:243],v[124:127],a[64:67]
s_add_u32 m0,s22,0
ds_read_b64_tr_b16 a[240:241],v3 offset:26624
ds_read_b64_tr_b16 a[242:243],v3 offset:32768
v_mfma_f32_16x16x32_bf16 v[180:183],a[244:247],v[112:115],v[180:183]
v_fma_f32 v52,v52,s36,v18
v_fma_f32 v53,v53,s36,v18
v_mfma_f32_16x16x32_bf16 v[228:231],a[244:247],v[116:119],v[228:231]
v_fma_f32 v54,v54,s36,v18
v_fma_f32 v55,v55,s36,v18
v_mfma_f32_16x16x32_bf16 a[20:23],a[244:247],v[120:123],a[20:23]
v_fma_f32 v56,v56,s36,v19
v_fma_f32 v57,v57,s36,v19
v_mfma_f32_16x16x32_bf16 a[68:71],a[244:247],v[124:127],a[68:71]
s_waitcnt lgkmcnt(4)
ds_read_b64_tr_b16 a[244:245],v4 offset:26624
ds_read_b64_tr_b16 a[246:247],v4 offset:32768
v_mfma_f32_16x16x32_bf16 v[184:187],a[248:251],v[112:115],v[184:187]
buffer_load_dwordx4 v7,s[4:7],s20 offen offset:0 lds
v_mfma_f32_16x16x32_bf16 v[232:235],a[248:251],v[116:119],v[232:235]
s_add_u32 m0,s22,896
v_fma_f32 v58,v58,s36,v19
v_fma_f32 v59,v59,s36,v19
v_mfma_f32_16x16x32_bf16 a[24:27],a[248:251],v[120:123],a[24:27]
v_fma_f32 v60,v60,s36,v19
v_fma_f32 v61,v61,s36,v19
v_mfma_f32_16x16x32_bf16 a[72:75],a[248:251],v[124:127],a[72:75]
ds_read_b64_tr_b16 a[248:249],v5 offset:26624
ds_read_b64_tr_b16 a[250:251],v5 offset:32768
v_mfma_f32_16x16x32_bf16 v[188:191],a[252:255],v[112:115],v[188:191]
v_fma_f32 v62,v62,s36,v19
v_fma_f32 v63,v63,s36,v19
v_mfma_f32_16x16x32_bf16 v[236:239],a[252:255],v[116:119],v[236:239]
v_exp_f32 v36,v36
v_mfma_f32_16x16x32_bf16 a[28:31],a[252:255],v[120:123],a[28:31]
v_exp_f32 v37,v37
v_mfma_f32_16x16x32_bf16 a[76:79],a[252:255],v[124:127],a[76:79]
s_waitcnt lgkmcnt(2)
ds_read_b64_tr_b16 a[252:253],v6 offset:26624
ds_read_b64_tr_b16 a[254:255],v6 offset:32768
v_mfma_f32_16x16x32_bf16 v[192:195],a[240:243],v[112:115],v[192:195]
buffer_load_dwordx4 v7,s[4:7],s20 offen offset:128 lds
v_mfma_f32_16x16x32_bf16 v[240:243],a[240:243],v[116:119],v[240:243]
s_add_u32 m0,s22,1792
v_exp_f32 v38,v38
v_mfma_f32_16x16x32_bf16 a[32:35],a[240:243],v[120:123],a[32:35]
v_exp_f32 v39,v39
v_mfma_f32_16x16x32_bf16 a[80:83],a[240:243],v[124:127],a[80:83]
v_exp_f32 v44,v44
v_mfma_f32_16x16x32_bf16 v[196:199],a[244:247],v[112:115],v[196:199]
v_exp_f32 v45,v45
v_mfma_f32_16x16x32_bf16 v[244:247],a[244:247],v[116:119],v[244:247]
ds_read_b128 v[156:159],v11 offset:5120
v_cvt_pk_bf16_f32 v98,v36,v37
v_mfma_f32_16x16x32_bf16 a[36:39],a[244:247],v[120:123],a[36:39]
v_exp_f32 v46,v46
v_mfma_f32_16x16x32_bf16 a[84:87],a[244:247],v[124:127],a[84:87]
s_waitcnt lgkmcnt(1)
v_exp_f32 v47,v47
v_mfma_f32_16x16x32_bf16 v[200:203],a[248:251],v[112:115],v[200:203]
buffer_load_dwordx4 v7,s[4:7],s20 offen offset:256 lds
v_mfma_f32_16x16x32_bf16 v[248:251],a[248:251],v[116:119],v[248:251]
s_add_u32 s20,s20,12288
v_exp_f32 v48,v48
v_mfma_f32_16x16x32_bf16 a[40:43],a[248:251],v[120:123],a[40:43]
v_exp_f32 v49,v49
v_mfma_f32_16x16x32_bf16 a[88:91],a[248:251],v[124:127],a[88:91]
v_exp_f32 v50,v50
v_mfma_f32_16x16x32_bf16 v[204:207],a[252:255],v[112:115],v[204:207]
v_exp_f32 v51,v51
v_mfma_f32_16x16x32_bf16 v[252:255],a[252:255],v[116:119],v[252:255]
v_exp_f32 v52,v52
v_mfma_f32_16x16x32_bf16 a[44:47],a[252:255],v[120:123],a[44:47]
v_exp_f32 v53,v53
v_mfma_f32_16x16x32_bf16 a[92:95],a[252:255],v[124:127],a[92:95]
v_exp_f32 v54,v54
v_mfma_f32_16x16x32_bf16 v[64:67],a[192:195],a[96:99],0
v_exp_f32 v55,v55
v_mfma_f32_16x16x32_bf16 v[64:67],a[196:199],a[100:103],v[64:67]
v_exp_f32 v56,v56
v_mfma_f32_16x16x32_bf16 v[64:67],a[200:203],a[104:107],v[64:67]
v_exp_f32 v57,v57
v_mfma_f32_16x16x32_bf16 v[64:67],a[204:207],a[108:111],v[64:67]
v_exp_f32 v58,v58
v_mfma_f32_16x16x32_bf16 v[64:67],a[208:211],a[112:115],v[64:67]
v_exp_f32 v59,v59
v_mfma_f32_16x16x32_bf16 v[64:67],a[212:215],a[116:119],v[64:67]
s_waitcnt lgkmcnt(0)
buffer_store_dwordx4 v[156:159],v10,s[16:19],s27 offen offset:256 nt
v_mfma_f32_16x16x32_bf16 v[72:75],a[192:195],a[120:123],0
s_add_u32 m0,s29,1792
v_exp_f32 v60,v60
v_mfma_f32_16x16x32_bf16 v[72:75],a[196:199],a[124:127],v[72:75]
v_exp_f32 v61,v61
v_mfma_f32_16x16x32_bf16 v[72:75],a[200:203],a[128:131],v[72:75]
v_exp_f32 v62,v62
v_mfma_f32_16x16x32_bf16 v[72:75],a[204:207],a[132:135],v[72:75]
v_exp_f32 v63,v63
v_mfma_f32_16x16x32_bf16 v[72:75],a[208:211],a[136:139],v[72:75]
v_cvt_pk_bf16_f32 v99,v38,v39
v_cvt_pk_bf16_f32 v102,v44,v45
v_mfma_f32_16x16x32_bf16 v[72:75],a[212:215],a[140:143],v[72:75]
v_cvt_pk_bf16_f32 v103,v46,v47
v_cvt_pk_bf16_f32 v104,v48,v49
v_mfma_f32_16x16x32_bf16 v[128:131],v[24:27],v[96:99],v[128:131]
v_cvt_pk_bf16_f32 v105,v50,v51
v_cvt_pk_bf16_f32 v106,v52,v53
v_mfma_f32_16x16x32_bf16 v[132:135],v[24:27],v[100:103],v[132:135]
v_cvt_pk_bf16_f32 v107,v54,v55
v_cvt_pk_bf16_f32 v108,v56,v57
v_mfma_f32_16x16x32_bf16 v[80:83],a[192:195],a[144:147],0
v_cvt_pk_bf16_f32 v109,v58,v59
v_cvt_pk_bf16_f32 v110,v60,v61
v_mfma_f32_16x16x32_bf16 v[136:139],v[24:27],v[104:107],v[136:139]
v_cvt_pk_bf16_f32 v111,v62,v63
v_fma_f32 v64,v64,s36,v16
v_mfma_f32_16x16x32_bf16 v[80:83],a[196:199],a[148:151],v[80:83]
v_fma_f32 v65,v65,s36,v16
v_fma_f32 v66,v66,s36,v16
v_mfma_f32_16x16x32_bf16 v[140:143],v[24:27],v[108:111],v[140:143]
v_fma_f32 v67,v67,s36,v16
v_fma_f32 v72,v72,s36,v17
v_mfma_f32_16x16x32_bf16 v[80:83],a[200:203],a[152:155],v[80:83]
v_fma_f32 v73,v73,s36,v17
v_fma_f32 v74,v74,s36,v17
v_mfma_f32_16x16x32_bf16 v[80:83],a[204:207],a[156:159],v[80:83]
v_fma_f32 v75,v75,s36,v17
v_mfma_f32_16x16x32_bf16 v[80:83],a[208:211],a[160:163],v[80:83]
v_exp_f32 v64,v64
v_mfma_f32_16x16x32_bf16 v[80:83],a[212:215],a[164:167],v[80:83]
v_exp_f32 v65,v65
v_mfma_f32_16x16x32_bf16 v[88:91],a[192:195],a[168:171],0
buffer_load_dwordx4 v9,s[12:15],s28 offen offset:256 nt lds
v_mfma_f32_16x16x32_bf16 v[88:91],a[196:199],a[172:175],v[88:91]
s_add_u32 s27,s27,3072
v_exp_f32 v66,v66
v_mfma_f32_16x16x32_bf16 v[88:91],a[200:203],a[176:179],v[88:91]
s_add_u32 s28,s28,3072
v_exp_f32 v67,v67
v_mfma_f32_16x16x32_bf16 v[88:91],a[204:207],a[180:183],v[88:91]
s_add_u32 s29,s29,3072
v_exp_f32 v72,v72
v_mfma_f32_16x16x32_bf16 v[88:91],a[208:211],a[184:187],v[88:91]
v_exp_f32 v73,v73
v_mfma_f32_16x16x32_bf16 v[88:91],a[212:215],a[188:191],v[88:91]
v_exp_f32 v74,v74
v_mfma_f32_16x16x32_bf16 v[68:71],a[216:219],a[96:99],0
v_exp_f32 v75,v75
v_mfma_f32_16x16x32_bf16 v[68:71],a[220:223],a[100:103],v[68:71]
v_cvt_pk_bf16_f32 v112,v64,v65
v_cvt_pk_bf16_f32 v113,v66,v67
v_mfma_f32_16x16x32_bf16 v[68:71],a[224:227],a[104:107],v[68:71]
v_cvt_pk_bf16_f32 v116,v72,v73
v_cvt_pk_bf16_f32 v117,v74,v75
v_mfma_f32_16x16x32_bf16 v[68:71],a[228:231],a[108:111],v[68:71]
v_mfma_f32_16x16x32_bf16 v[68:71],a[232:235],a[112:115],v[68:71]
v_mfma_f32_16x16x32_bf16 v[68:71],a[236:239],a[116:119],v[68:71]
v_mfma_f32_16x16x32_bf16 v[76:79],a[216:219],a[120:123],0
v_mfma_f32_16x16x32_bf16 v[76:79],a[220:223],a[124:127],v[76:79]
v_mfma_f32_16x16x32_bf16 v[76:79],a[224:227],a[128:131],v[76:79]
v_mfma_f32_16x16x32_bf16 v[76:79],a[228:231],a[132:135],v[76:79]
s_waitcnt vmcnt(12)
s_barrier
v_mfma_f32_16x16x32_bf16 v[76:79],a[232:235],a[136:139],v[76:79]
v_mfma_f32_16x16x32_bf16 v[76:79],a[236:239],a[140:143],v[76:79]
ds_read_b64_tr_b16 a[240:241],v3 offset:0
ds_read_b64_tr_b16 a[242:243],v3 offset:6144
v_mfma_f32_16x16x32_bf16 v[84:87],a[216:219],a[144:147],0
v_mfma_f32_16x16x32_bf16 v[84:87],a[220:223],a[148:151],v[84:87]
ds_read_b64_tr_b16 a[244:245],v4 offset:0
ds_read_b64_tr_b16 a[246:247],v4 offset:6144
v_mfma_f32_16x16x32_bf16 v[84:87],a[224:227],a[152:155],v[84:87]
v_mfma_f32_16x16x32_bf16 v[84:87],a[228:231],a[156:159],v[84:87]
ds_read_b64_tr_b16 a[248:249],v5 offset:0
ds_read_b64_tr_b16 a[250:251],v5 offset:6144
v_mfma_f32_16x16x32_bf16 v[84:87],a[232:235],a[160:163],v[84:87]
v_mfma_f32_16x16x32_bf16 v[84:87],a[236:239],a[164:167],v[84:87]
ds_read_b64_tr_b16 a[252:253],v6 offset:0
ds_read_b64_tr_b16 a[254:255],v6 offset:6144
v_mfma_f32_16x16x32_bf16 v[92:95],a[216:219],a[168:171],0
v_mfma_f32_16x16x32_bf16 v[92:95],a[220:223],a[172:175],v[92:95]
v_mfma_f32_16x16x32_bf16 v[92:95],a[224:227],a[176:179],v[92:95]
v_mfma_f32_16x16x32_bf16 v[92:95],a[228:231],a[180:183],v[92:95]
v_mfma_f32_16x16x32_bf16 v[92:95],a[232:235],a[184:187],v[92:95]
v_mfma_f32_16x16x32_bf16 v[92:95],a[236:239],a[188:191],v[92:95]
s_waitcnt lgkmcnt(4)
v_mfma_f32_16x16x32_bf16 v[160:163],a[240:243],v[96:99],v[160:163]
s_add_u32 m0,s23,24576
ds_read_b128 a[192:195],v1 offset:24576
v_fma_f32 v68,v68,s36,v16
v_mfma_f32_16x16x32_bf16 v[208:211],a[240:243],v[100:103],v[208:211]
buffer_load_dwordx4 v7,s[8:11],s21 offen offset:0 lds
v_mfma_f32_16x16x32_bf16 a[0:3],a[240:243],v[104:107],a[0:3]
s_add_u32 m0,s23,25472
ds_read_b128 a[196:199],v2 offset:24576
v_fma_f32 v69,v69,s36,v16
v_mfma_f32_16x16x32_bf16 a[48:51],a[240:243],v[108:111],a[48:51]
ds_read_b64_tr_b16 a[240:241],v3 offset:1024
ds_read_b64_tr_b16 a[242:243],v3 offset:7168
v_mfma_f32_16x16x32_bf16 v[164:167],a[244:247],v[96:99],v[164:167]
ds_read_b128 a[200:203],v1 offset:25600
v_fma_f32 v70,v70,s36,v16
v_mfma_f32_16x16x32_bf16 v[212:215],a[244:247],v[100:103],v[212:215]
ds_read_b128 a[204:207],v2 offset:25600
v_fma_f32 v71,v71,s36,v16
v_mfma_f32_16x16x32_bf16 a[4:7],a[244:247],v[104:107],a[4:7]
ds_read_b128 a[208:211],v1 offset:26624
v_fma_f32 v76,v76,s36,v17
v_mfma_f32_16x16x32_bf16 a[52:55],a[244:247],v[108:111],a[52:55]
s_waitcnt lgkmcnt(7)
ds_read_b64_tr_b16 a[244:245],v4 offset:1024
ds_read_b64_tr_b16 a[246:247],v4 offset:7168
v_mfma_f32_16x16x32_bf16 v[168:171],a[248:251],v[96:99],v[168:171]
ds_read_b128 a[212:215],v2 offset:26624
v_fma_f32 v77,v77,s36,v17
v_mfma_f32_16x16x32_bf16 v[216:219],a[248:251],v[100:103],v[216:219]
buffer_load_dwordx4 v7,s[8:11],s21 offen offset:128 lds
v_mfma_f32_16x16x32_bf16 a[8:11],a[248:251],v[104:107],a[8:11]
s_add_u32 m0,s23,26368
ds_read_b128 a[216:219],v1 offset:30720
v_fma_f32 v78,v78,s36,v17
v_mfma_f32_16x16x32_bf16 a[56:59],a[248:251],v[108:111],a[56:59]
ds_read_b64_tr_b16 a[248:249],v5 offset:1024
ds_read_b64_tr_b16 a[250:251],v5 offset:7168
v_mfma_f32_16x16x32_bf16 v[172:175],a[252:255],v[96:99],v[172:175]
ds_read_b128 a[220:223],v2 offset:30720
v_fma_f32 v79,v79,s36,v17
v_mfma_f32_16x16x32_bf16 v[220:223],a[252:255],v[100:103],v[220:223]
ds_read_b128 a[224:227],v1 offset:31744
v_fma_f32 v80,v80,s36,v18
v_mfma_f32_16x16x32_bf16 a[12:15],a[252:255],v[104:107],a[12:15]
ds_read_b128 a[228:231],v2 offset:31744
v_fma_f32 v81,v81,s36,v18
v_mfma_f32_16x16x32_bf16 a[60:63],a[252:255],v[108:111],a[60:63]
s_waitcnt lgkmcnt(7)
ds_read_b64_tr_b16 a[252:253],v6 offset:1024
ds_read_b64_tr_b16 a[254:255],v6 offset:7168
v_mfma_f32_16x16x32_bf16 v[176:179],a[240:243],v[96:99],v[176:179]
ds_read_b128 a[232:235],v1 offset:32768
v_fma_f32 v82,v82,s36,v18
v_mfma_f32_16x16x32_bf16 v[224:227],a[240:243],v[100:103],v[224:227]
buffer_load_dwordx4 v7,s[8:11],s21 offen offset:256 lds
v_mfma_f32_16x16x32_bf16 a[16:19],a[240:243],v[104:107],a[16:19]
s_add_u32 s21,s21,12288
ds_read_b128 a[236:239],v2 offset:32768
v_fma_f32 v83,v83,s36,v18
v_mfma_f32_16x16x32_bf16 a[64:67],a[240:243],v[108:111],a[64:67]
s_add_u32 m0,s25,0
ds_read_b64_tr_b16 a[240:241],v3 offset:2048
ds_read_b64_tr_b16 a[242:243],v3 offset:8192
v_mfma_f32_16x16x32_bf16 v[180:183],a[244:247],v[96:99],v[180:183]
v_fma_f32 v84,v84,s36,v18
v_fma_f32 v85,v85,s36,v18
v_mfma_f32_16x16x32_bf16 v[228:231],a[244:247],v[100:103],v[228:231]
v_fma_f32 v86,v86,s36,v18
v_fma_f32 v87,v87,s36,v18
v_mfma_f32_16x16x32_bf16 a[20:23],a[244:247],v[104:107],a[20:23]
v_fma_f32 v88,v88,s36,v19
v_fma_f32 v89,v89,s36,v19
v_mfma_f32_16x16x32_bf16 a[68:71],a[244:247],v[108:111],a[68:71]
s_waitcnt lgkmcnt(4)
ds_read_b64_tr_b16 a[244:245],v4 offset:2048
ds_read_b64_tr_b16 a[246:247],v4 offset:8192
v_mfma_f32_16x16x32_bf16 v[184:187],a[248:251],v[96:99],v[184:187]
buffer_load_dwordx4 v7,s[4:7],s20 offen offset:0 lds
v_mfma_f32_16x16x32_bf16 v[232:235],a[248:251],v[100:103],v[232:235]
s_add_u32 m0,s25,896
v_fma_f32 v90,v90,s36,v19
v_fma_f32 v91,v91,s36,v19
v_mfma_f32_16x16x32_bf16 a[24:27],a[248:251],v[104:107],a[24:27]
v_fma_f32 v92,v92,s36,v19
v_fma_f32 v93,v93,s36,v19
v_mfma_f32_16x16x32_bf16 a[72:75],a[248:251],v[108:111],a[72:75]
ds_read_b64_tr_b16 a[248:249],v5 offset:2048
ds_read_b64_tr_b16 a[250:251],v5 offset:8192
v_mfma_f32_16x16x32_bf16 v[188:191],a[252:255],v[96:99],v[188:191]
v_fma_f32 v94,v94,s36,v19
v_fma_f32 v95,v95,s36,v19
v_mfma_f32_16x16x32_bf16 v[236:239],a[252:255],v[100:103],v[236:239]
v_exp_f32 v68,v68
v_mfma_f32_16x16x32_bf16 a[28:31],a[252:255],v[104:107],a[28:31]
v_exp_f32 v69,v69
v_mfma_f32_16x16x32_bf16 a[76:79],a[252:255],v[108:111],a[76:79]
s_waitcnt lgkmcnt(2)
ds_read_b64_tr_b16 a[252:253],v6 offset:2048
ds_read_b64_tr_b16 a[254:255],v6 offset:8192
v_mfma_f32_16x16x32_bf16 v[192:195],a[240:243],v[96:99],v[192:195]
buffer_load_dwordx4 v7,s[4:7],s20 offen offset:128 lds
v_mfma_f32_16x16x32_bf16 v[240:243],a[240:243],v[100:103],v[240:243]
s_add_u32 m0,s25,1792
v_exp_f32 v70,v70
v_mfma_f32_16x16x32_bf16 a[32:35],a[240:243],v[104:107],a[32:35]
v_exp_f32 v71,v71
v_mfma_f32_16x16x32_bf16 a[80:83],a[240:243],v[108:111],a[80:83]
v_exp_f32 v76,v76
v_mfma_f32_16x16x32_bf16 v[196:199],a[244:247],v[96:99],v[196:199]
v_exp_f32 v77,v77
v_mfma_f32_16x16x32_bf16 v[244:247],a[244:247],v[100:103],v[244:247]
ds_read_b128 v[152:155],v11 offset:6144
v_cvt_pk_bf16_f32 v114,v68,v69
v_mfma_f32_16x16x32_bf16 a[36:39],a[244:247],v[104:107],a[36:39]
v_exp_f32 v78,v78
v_mfma_f32_16x16x32_bf16 a[84:87],a[244:247],v[108:111],a[84:87]
s_waitcnt lgkmcnt(1)
v_exp_f32 v79,v79
v_mfma_f32_16x16x32_bf16 v[200:203],a[248:251],v[96:99],v[200:203]
buffer_load_dwordx4 v7,s[4:7],s20 offen offset:256 lds
v_mfma_f32_16x16x32_bf16 v[248:251],a[248:251],v[100:103],v[248:251]
s_add_u32 s20,s20,12288
v_exp_f32 v80,v80
v_mfma_f32_16x16x32_bf16 a[40:43],a[248:251],v[104:107],a[40:43]
v_exp_f32 v81,v81
v_mfma_f32_16x16x32_bf16 a[88:91],a[248:251],v[108:111],a[88:91]
v_exp_f32 v82,v82
v_mfma_f32_16x16x32_bf16 v[204:207],a[252:255],v[96:99],v[204:207]
v_exp_f32 v83,v83
v_mfma_f32_16x16x32_bf16 v[252:255],a[252:255],v[100:103],v[252:255]
v_exp_f32 v84,v84
v_mfma_f32_16x16x32_bf16 a[44:47],a[252:255],v[104:107],a[44:47]
v_exp_f32 v85,v85
v_mfma_f32_16x16x32_bf16 a[92:95],a[252:255],v[108:111],a[92:95]
v_exp_f32 v86,v86
v_mfma_f32_16x16x32_bf16 v[32:35],a[192:195],a[96:99],0
v_exp_f32 v87,v87
v_mfma_f32_16x16x32_bf16 v[32:35],a[196:199],a[100:103],v[32:35]
v_exp_f32 v88,v88
v_mfma_f32_16x16x32_bf16 v[32:35],a[200:203],a[104:107],v[32:35]
v_exp_f32 v89,v89
v_mfma_f32_16x16x32_bf16 v[32:35],a[204:207],a[108:111],v[32:35]
v_exp_f32 v90,v90
v_mfma_f32_16x16x32_bf16 v[32:35],a[208:211],a[112:115],v[32:35]
v_exp_f32 v91,v91
v_mfma_f32_16x16x32_bf16 v[32:35],a[212:215],a[116:119],v[32:35]
s_waitcnt lgkmcnt(0)
buffer_store_dwordx4 v[152:155],v10,s[16:19],s27 offen offset:0 nt
v_mfma_f32_16x16x32_bf16 v[40:43],a[192:195],a[120:123],0
s_add_u32 m0,s29,0
v_exp_f32 v92,v92
v_mfma_f32_16x16x32_bf16 v[40:43],a[196:199],a[124:127],v[40:43]
v_exp_f32 v93,v93
v_mfma_f32_16x16x32_bf16 v[40:43],a[200:203],a[128:131],v[40:43]
ds_read_b128 v[156:159],v11 offset:7168
v_cvt_pk_bf16_f32 v115,v70,v71
v_mfma_f32_16x16x32_bf16 v[40:43],a[204:207],a[132:135],v[40:43]
v_exp_f32 v94,v94
v_mfma_f32_16x16x32_bf16 v[128:131],v[24:27],v[112:115],v[128:131]
v_exp_f32 v95,v95
v_mfma_f32_16x16x32_bf16 v[40:43],a[208:211],a[136:139],v[40:43]
v_cvt_pk_bf16_f32 v118,v76,v77
v_cvt_pk_bf16_f32 v119,v78,v79
v_mfma_f32_16x16x32_bf16 v[40:43],a[212:215],a[140:143],v[40:43]
v_cvt_pk_bf16_f32 v120,v80,v81
v_cvt_pk_bf16_f32 v121,v82,v83
v_mfma_f32_16x16x32_bf16 v[132:135],v[24:27],v[116:119],v[132:135]
buffer_load_dwordx4 v8,s[12:15],s28 offen offset:0 nt lds
v_mfma_f32_16x16x32_bf16 v[48:51],a[192:195],a[144:147],0
v_cvt_pk_bf16_f32 v122,v84,v85
v_cvt_pk_bf16_f32 v123,v86,v87
v_mfma_f32_16x16x32_bf16 v[48:51],a[196:199],a[148:151],v[48:51]
v_cvt_pk_bf16_f32 v124,v88,v89
v_cvt_pk_bf16_f32 v125,v90,v91
v_mfma_f32_16x16x32_bf16 v[136:139],v[24:27],v[120:123],v[136:139]
v_cvt_pk_bf16_f32 v126,v92,v93
v_cvt_pk_bf16_f32 v127,v94,v95
v_mfma_f32_16x16x32_bf16 v[48:51],a[200:203],a[152:155],v[48:51]
v_fma_f32 v32,v32,s36,v16
v_fma_f32 v33,v33,s36,v16
v_mfma_f32_16x16x32_bf16 v[140:143],v[24:27],v[124:127],v[140:143]
v_fma_f32 v34,v34,s36,v16
v_fma_f32 v35,v35,s36,v16
v_mfma_f32_16x16x32_bf16 v[48:51],a[204:207],a[156:159],v[48:51]
v_fma_f32 v40,v40,s36,v17
v_fma_f32 v41,v41,s36,v17
v_mfma_f32_16x16x32_bf16 v[48:51],a[208:211],a[160:163],v[48:51]
v_fma_f32 v42,v42,s36,v17
v_fma_f32 v43,v43,s36,v17
v_mfma_f32_16x16x32_bf16 v[48:51],a[212:215],a[164:167],v[48:51]
v_exp_f32 v32,v32
v_mfma_f32_16x16x32_bf16 v[56:59],a[192:195],a[168:171],0
s_waitcnt lgkmcnt(0)
buffer_store_dwordx4 v[156:159],v10,s[16:19],s27 offen offset:128 nt
v_mfma_f32_16x16x32_bf16 v[56:59],a[196:199],a[172:175],v[56:59]
s_add_u32 m0,s29,896
v_exp_f32 v33,v33
v_mfma_f32_16x16x32_bf16 v[56:59],a[200:203],a[176:179],v[56:59]
v_exp_f32 v34,v34
v_mfma_f32_16x16x32_bf16 v[56:59],a[204:207],a[180:183],v[56:59]
v_exp_f32 v35,v35
v_mfma_f32_16x16x32_bf16 v[56:59],a[208:211],a[184:187],v[56:59]
v_exp_f32 v40,v40
v_mfma_f32_16x16x32_bf16 v[56:59],a[212:215],a[188:191],v[56:59]
v_exp_f32 v41,v41
v_mfma_f32_16x16x32_bf16 v[36:39],a[216:219],a[96:99],0
v_exp_f32 v42,v42
v_mfma_f32_16x16x32_bf16 v[36:39],a[220:223],a[100:103],v[36:39]
v_exp_f32 v43,v43
v_mfma_f32_16x16x32_bf16 v[36:39],a[224:227],a[104:107],v[36:39]
buffer_load_dwordx4 v8,s[12:15],s28 offen offset:128 nt lds
v_mfma_f32_16x16x32_bf16 v[36:39],a[228:231],a[108:111],v[36:39]
v_cvt_pk_bf16_f32 v96,v32,v33
v_cvt_pk_bf16_f32 v97,v34,v35
v_mfma_f32_16x16x32_bf16 v[36:39],a[232:235],a[112:115],v[36:39]
v_cvt_pk_bf16_f32 v100,v40,v41
v_cvt_pk_bf16_f32 v101,v42,v43
v_mfma_f32_16x16x32_bf16 v[36:39],a[236:239],a[116:119],v[36:39]
v_mfma_f32_16x16x32_bf16 v[44:47],a[216:219],a[120:123],0
v_mfma_f32_16x16x32_bf16 v[44:47],a[220:223],a[124:127],v[44:47]
v_mfma_f32_16x16x32_bf16 v[44:47],a[224:227],a[128:131],v[44:47]
v_mfma_f32_16x16x32_bf16 v[44:47],a[228:231],a[132:135],v[44:47]
s_waitcnt vmcnt(12)
s_barrier
v_mfma_f32_16x16x32_bf16 v[44:47],a[232:235],a[136:139],v[44:47]
v_mfma_f32_16x16x32_bf16 v[44:47],a[236:239],a[140:143],v[44:47]
ds_read_b64_tr_b16 a[240:241],v3 offset:12288
ds_read_b64_tr_b16 a[242:243],v3 offset:18432
v_mfma_f32_16x16x32_bf16 v[52:55],a[216:219],a[144:147],0
v_mfma_f32_16x16x32_bf16 v[52:55],a[220:223],a[148:151],v[52:55]
ds_read_b64_tr_b16 a[244:245],v4 offset:12288
ds_read_b64_tr_b16 a[246:247],v4 offset:18432
v_mfma_f32_16x16x32_bf16 v[52:55],a[224:227],a[152:155],v[52:55]
v_mfma_f32_16x16x32_bf16 v[52:55],a[228:231],a[156:159],v[52:55]
ds_read_b64_tr_b16 a[248:249],v5 offset:12288
ds_read_b64_tr_b16 a[250:251],v5 offset:18432
v_mfma_f32_16x16x32_bf16 v[52:55],a[232:235],a[160:163],v[52:55]
v_mfma_f32_16x16x32_bf16 v[52:55],a[236:239],a[164:167],v[52:55]
ds_read_b64_tr_b16 a[252:253],v6 offset:12288
ds_read_b64_tr_b16 a[254:255],v6 offset:18432
v_mfma_f32_16x16x32_bf16 v[60:63],a[216:219],a[168:171],0
v_mfma_f32_16x16x32_bf16 v[60:63],a[220:223],a[172:175],v[60:63]
v_mfma_f32_16x16x32_bf16 v[60:63],a[224:227],a[176:179],v[60:63]
v_mfma_f32_16x16x32_bf16 v[60:63],a[228:231],a[180:183],v[60:63]
v_mfma_f32_16x16x32_bf16 v[60:63],a[232:235],a[184:187],v[60:63]
v_mfma_f32_16x16x32_bf16 v[60:63],a[236:239],a[188:191],v[60:63]
s_waitcnt lgkmcnt(4)
v_mfma_f32_16x16x32_bf16 v[160:163],a[240:243],v[112:115],v[160:163]
s_add_u32 m0,s23,0
ds_read_b128 a[192:195],v1 offset:0
v_fma_f32 v36,v36,s36,v16
v_mfma_f32_16x16x32_bf16 v[208:211],a[240:243],v[116:119],v[208:211]
buffer_load_dwordx4 v7,s[8:11],s21 offen offset:0 lds
v_mfma_f32_16x16x32_bf16 a[0:3],a[240:243],v[120:123],a[0:3]
s_add_u32 m0,s23,896
ds_read_b128 a[196:199],v2 offset:0
v_fma_f32 v37,v37,s36,v16
v_mfma_f32_16x16x32_bf16 a[48:51],a[240:243],v[124:127],a[48:51]
ds_read_b64_tr_b16 a[240:241],v3 offset:13312
ds_read_b64_tr_b16 a[242:243],v3 offset:19456
v_mfma_f32_16x16x32_bf16 v[164:167],a[244:247],v[112:115],v[164:167]
ds_read_b128 a[200:203],v1 offset:1024
v_fma_f32 v38,v38,s36,v16
v_mfma_f32_16x16x32_bf16 v[212:215],a[244:247],v[116:119],v[212:215]
ds_read_b128 a[204:207],v2 offset:1024
v_fma_f32 v39,v39,s36,v16
v_mfma_f32_16x16x32_bf16 a[4:7],a[244:247],v[120:123],a[4:7]
ds_read_b128 a[208:211],v1 offset:2048
v_fma_f32 v44,v44,s36,v17
v_mfma_f32_16x16x32_bf16 a[52:55],a[244:247],v[124:127],a[52:55]
s_waitcnt lgkmcnt(7)
ds_read_b64_tr_b16 a[244:245],v4 offset:13312
ds_read_b64_tr_b16 a[246:247],v4 offset:19456
v_mfma_f32_16x16x32_bf16 v[168:171],a[248:251],v[112:115],v[168:171]
ds_read_b128 a[212:215],v2 offset:2048
v_fma_f32 v45,v45,s36,v17
v_mfma_f32_16x16x32_bf16 v[216:219],a[248:251],v[116:119],v[216:219]
buffer_load_dwordx4 v7,s[8:11],s21 offen offset:128 lds
v_mfma_f32_16x16x32_bf16 a[8:11],a[248:251],v[120:123],a[8:11]
s_add_u32 m0,s23,1792
ds_read_b128 a[216:219],v1 offset:6144
v_fma_f32 v46,v46,s36,v17
v_mfma_f32_16x16x32_bf16 a[56:59],a[248:251],v[124:127],a[56:59]
ds_read_b64_tr_b16 a[248:249],v5 offset:13312
ds_read_b64_tr_b16 a[250:251],v5 offset:19456
v_mfma_f32_16x16x32_bf16 v[172:175],a[252:255],v[112:115],v[172:175]
ds_read_b128 a[220:223],v2 offset:6144
v_fma_f32 v47,v47,s36,v17
v_mfma_f32_16x16x32_bf16 v[220:223],a[252:255],v[116:119],v[220:223]
ds_read_b128 a[224:227],v1 offset:7168
v_fma_f32 v48,v48,s36,v18
v_mfma_f32_16x16x32_bf16 a[12:15],a[252:255],v[120:123],a[12:15]
ds_read_b128 a[228:231],v2 offset:7168
v_fma_f32 v49,v49,s36,v18
v_mfma_f32_16x16x32_bf16 a[60:63],a[252:255],v[124:127],a[60:63]
s_waitcnt lgkmcnt(7)
ds_read_b64_tr_b16 a[252:253],v6 offset:13312
ds_read_b64_tr_b16 a[254:255],v6 offset:19456
v_mfma_f32_16x16x32_bf16 v[176:179],a[240:243],v[112:115],v[176:179]
ds_read_b128 a[232:235],v1 offset:8192
v_fma_f32 v50,v50,s36,v18
v_mfma_f32_16x16x32_bf16 v[224:227],a[240:243],v[116:119],v[224:227]
buffer_load_dwordx4 v7,s[8:11],s21 offen offset:256 lds
v_mfma_f32_16x16x32_bf16 a[16:19],a[240:243],v[120:123],a[16:19]
s_add_u32 s21,s21,12288
ds_read_b128 a[236:239],v2 offset:8192
v_fma_f32 v51,v51,s36,v18
v_mfma_f32_16x16x32_bf16 a[64:67],a[240:243],v[124:127],a[64:67]
s_add_u32 m0,s26,0
ds_read_b64_tr_b16 a[240:241],v3 offset:14336
ds_read_b64_tr_b16 a[242:243],v3 offset:20480
v_mfma_f32_16x16x32_bf16 v[180:183],a[244:247],v[112:115],v[180:183]
v_fma_f32 v52,v52,s36,v18
v_fma_f32 v53,v53,s36,v18
v_mfma_f32_16x16x32_bf16 v[228:231],a[244:247],v[116:119],v[228:231]
v_fma_f32 v54,v54,s36,v18
v_fma_f32 v55,v55,s36,v18
v_mfma_f32_16x16x32_bf16 a[20:23],a[244:247],v[120:123],a[20:23]
v_fma_f32 v56,v56,s36,v19
v_fma_f32 v57,v57,s36,v19
v_mfma_f32_16x16x32_bf16 a[68:71],a[244:247],v[124:127],a[68:71]
s_waitcnt lgkmcnt(4)
ds_read_b64_tr_b16 a[244:245],v4 offset:14336
ds_read_b64_tr_b16 a[246:247],v4 offset:20480
v_mfma_f32_16x16x32_bf16 v[184:187],a[248:251],v[112:115],v[184:187]
buffer_load_dwordx4 v7,s[4:7],s20 offen offset:0 lds
v_mfma_f32_16x16x32_bf16 v[232:235],a[248:251],v[116:119],v[232:235]
s_add_u32 m0,s26,896
v_fma_f32 v58,v58,s36,v19
v_fma_f32 v59,v59,s36,v19
v_mfma_f32_16x16x32_bf16 a[24:27],a[248:251],v[120:123],a[24:27]
v_fma_f32 v60,v60,s36,v19
v_fma_f32 v61,v61,s36,v19
v_mfma_f32_16x16x32_bf16 a[72:75],a[248:251],v[124:127],a[72:75]
ds_read_b64_tr_b16 a[248:249],v5 offset:14336
ds_read_b64_tr_b16 a[250:251],v5 offset:20480
v_mfma_f32_16x16x32_bf16 v[188:191],a[252:255],v[112:115],v[188:191]
v_fma_f32 v62,v62,s36,v19
v_fma_f32 v63,v63,s36,v19
v_mfma_f32_16x16x32_bf16 v[236:239],a[252:255],v[116:119],v[236:239]
v_exp_f32 v36,v36
v_mfma_f32_16x16x32_bf16 a[28:31],a[252:255],v[120:123],a[28:31]
v_exp_f32 v37,v37
v_mfma_f32_16x16x32_bf16 a[76:79],a[252:255],v[124:127],a[76:79]
s_waitcnt lgkmcnt(2)
ds_read_b64_tr_b16 a[252:253],v6 offset:14336
ds_read_b64_tr_b16 a[254:255],v6 offset:20480
v_mfma_f32_16x16x32_bf16 v[192:195],a[240:243],v[112:115],v[192:195]
buffer_load_dwordx4 v7,s[4:7],s20 offen offset:128 lds
v_mfma_f32_16x16x32_bf16 v[240:243],a[240:243],v[116:119],v[240:243]
s_add_u32 m0,s26,1792
v_exp_f32 v38,v38
v_mfma_f32_16x16x32_bf16 a[32:35],a[240:243],v[120:123],a[32:35]
v_exp_f32 v39,v39
v_mfma_f32_16x16x32_bf16 a[80:83],a[240:243],v[124:127],a[80:83]
v_exp_f32 v44,v44
v_mfma_f32_16x16x32_bf16 v[196:199],a[244:247],v[112:115],v[196:199]
v_exp_f32 v45,v45
v_mfma_f32_16x16x32_bf16 v[244:247],a[244:247],v[116:119],v[244:247]
ds_read_b128 v[152:155],v11 offset:8192
v_cvt_pk_bf16_f32 v98,v36,v37
v_mfma_f32_16x16x32_bf16 a[36:39],a[244:247],v[120:123],a[36:39]
v_exp_f32 v46,v46
v_mfma_f32_16x16x32_bf16 a[84:87],a[244:247],v[124:127],a[84:87]
s_waitcnt lgkmcnt(1)
v_exp_f32 v47,v47
v_mfma_f32_16x16x32_bf16 v[200:203],a[248:251],v[112:115],v[200:203]
buffer_load_dwordx4 v7,s[4:7],s20 offen offset:256 lds
v_mfma_f32_16x16x32_bf16 v[248:251],a[248:251],v[116:119],v[248:251]
s_add_u32 s20,s20,12288
v_exp_f32 v48,v48
v_mfma_f32_16x16x32_bf16 a[40:43],a[248:251],v[120:123],a[40:43]
v_exp_f32 v49,v49
v_mfma_f32_16x16x32_bf16 a[88:91],a[248:251],v[124:127],a[88:91]
v_exp_f32 v50,v50
v_mfma_f32_16x16x32_bf16 v[204:207],a[252:255],v[112:115],v[204:207]
v_exp_f32 v51,v51
v_mfma_f32_16x16x32_bf16 v[252:255],a[252:255],v[116:119],v[252:255]
v_exp_f32 v52,v52
v_mfma_f32_16x16x32_bf16 a[44:47],a[252:255],v[120:123],a[44:47]
v_exp_f32 v53,v53
v_mfma_f32_16x16x32_bf16 a[92:95],a[252:255],v[124:127],a[92:95]
v_exp_f32 v54,v54
v_mfma_f32_16x16x32_bf16 v[64:67],a[192:195],a[96:99],0
v_exp_f32 v55,v55
v_mfma_f32_16x16x32_bf16 v[64:67],a[196:199],a[100:103],v[64:67]
v_exp_f32 v56,v56
v_mfma_f32_16x16x32_bf16 v[64:67],a[200:203],a[104:107],v[64:67]
v_exp_f32 v57,v57
v_mfma_f32_16x16x32_bf16 v[64:67],a[204:207],a[108:111],v[64:67]
v_exp_f32 v58,v58
v_mfma_f32_16x16x32_bf16 v[64:67],a[208:211],a[112:115],v[64:67]
v_exp_f32 v59,v59
v_mfma_f32_16x16x32_bf16 v[64:67],a[212:215],a[116:119],v[64:67]
s_waitcnt lgkmcnt(0)
buffer_store_dwordx4 v[152:155],v10,s[16:19],s27 offen offset:256 nt
v_mfma_f32_16x16x32_bf16 v[72:75],a[192:195],a[120:123],0
s_add_u32 m0,s29,1792
v_exp_f32 v60,v60
v_mfma_f32_16x16x32_bf16 v[72:75],a[196:199],a[124:127],v[72:75]
v_exp_f32 v61,v61
v_mfma_f32_16x16x32_bf16 v[72:75],a[200:203],a[128:131],v[72:75]
v_exp_f32 v62,v62
v_mfma_f32_16x16x32_bf16 v[72:75],a[204:207],a[132:135],v[72:75]
v_exp_f32 v63,v63
v_mfma_f32_16x16x32_bf16 v[72:75],a[208:211],a[136:139],v[72:75]
v_cvt_pk_bf16_f32 v99,v38,v39
v_cvt_pk_bf16_f32 v102,v44,v45
v_mfma_f32_16x16x32_bf16 v[72:75],a[212:215],a[140:143],v[72:75]
v_cvt_pk_bf16_f32 v103,v46,v47
v_cvt_pk_bf16_f32 v104,v48,v49
v_mfma_f32_16x16x32_bf16 v[128:131],v[24:27],v[96:99],v[128:131]
v_cvt_pk_bf16_f32 v105,v50,v51
v_cvt_pk_bf16_f32 v106,v52,v53
v_mfma_f32_16x16x32_bf16 v[132:135],v[24:27],v[100:103],v[132:135]
v_cvt_pk_bf16_f32 v107,v54,v55
v_cvt_pk_bf16_f32 v108,v56,v57
v_mfma_f32_16x16x32_bf16 v[80:83],a[192:195],a[144:147],0
v_cvt_pk_bf16_f32 v109,v58,v59
v_cvt_pk_bf16_f32 v110,v60,v61
v_mfma_f32_16x16x32_bf16 v[136:139],v[24:27],v[104:107],v[136:139]
v_cvt_pk_bf16_f32 v111,v62,v63
v_fma_f32 v64,v64,s36,v16
v_mfma_f32_16x16x32_bf16 v[80:83],a[196:199],a[148:151],v[80:83]
v_fma_f32 v65,v65,s36,v16
v_fma_f32 v66,v66,s36,v16
v_mfma_f32_16x16x32_bf16 v[140:143],v[24:27],v[108:111],v[140:143]
v_fma_f32 v67,v67,s36,v16
v_fma_f32 v72,v72,s36,v17
v_mfma_f32_16x16x32_bf16 v[80:83],a[200:203],a[152:155],v[80:83]
v_fma_f32 v73,v73,s36,v17
v_fma_f32 v74,v74,s36,v17
v_mfma_f32_16x16x32_bf16 v[80:83],a[204:207],a[156:159],v[80:83]
v_fma_f32 v75,v75,s36,v17
v_add_u32 v11,9216,v11
v_mfma_f32_16x16x32_bf16 v[80:83],a[208:211],a[160:163],v[80:83]
v_exp_f32 v64,v64
v_mfma_f32_16x16x32_bf16 v[80:83],a[212:215],a[164:167],v[80:83]
v_exp_f32 v65,v65
v_mfma_f32_16x16x32_bf16 v[88:91],a[192:195],a[168:171],0
buffer_load_dwordx4 v8,s[12:15],s28 offen offset:256 nt lds
v_mfma_f32_16x16x32_bf16 v[88:91],a[196:199],a[172:175],v[88:91]
s_add_u32 s27,s27,3072
v_exp_f32 v66,v66
v_mfma_f32_16x16x32_bf16 v[88:91],a[200:203],a[176:179],v[88:91]
s_add_u32 s28,s28,3072
v_exp_f32 v67,v67
v_mfma_f32_16x16x32_bf16 v[88:91],a[204:207],a[180:183],v[88:91]
s_add_u32 s29,s29,3072
s_add_u32 s25,s24,18432
s_add_u32 s26,s22,12288
s_add_u32 s38,s38,1
s_cmp_lt_u32 s38,2
v_mfma_f32_16x16x32_bf16 v[88:91],a[208:211],a[184:187],v[88:91]
v_exp_f32 v72,v72
v_mfma_f32_16x16x32_bf16 v[88:91],a[212:215],a[188:191],v[88:91]
v_exp_f32 v73,v73
v_mfma_f32_16x16x32_bf16 v[68:71],a[216:219],a[96:99],0
v_exp_f32 v74,v74
v_mfma_f32_16x16x32_bf16 v[68:71],a[220:223],a[100:103],v[68:71]
v_exp_f32 v75,v75
v_mfma_f32_16x16x32_bf16 v[68:71],a[224:227],a[104:107],v[68:71]
v_cvt_pk_bf16_f32 v112,v64,v65
v_cvt_pk_bf16_f32 v113,v66,v67
v_mfma_f32_16x16x32_bf16 v[68:71],a[228:231],a[108:111],v[68:71]
v_cvt_pk_bf16_f32 v116,v72,v73
v_cvt_pk_bf16_f32 v117,v74,v75
v_mfma_f32_16x16x32_bf16 v[68:71],a[232:235],a[112:115],v[68:71]
v_xor_b32 v8,80,v8
v_xor_b32 v9,80,v9
v_mfma_f32_16x16x32_bf16 v[68:71],a[236:239],a[116:119],v[68:71]
v_mfma_f32_16x16x32_bf16 v[76:79],a[216:219],a[120:123],0
v_mfma_f32_16x16x32_bf16 v[76:79],a[220:223],a[124:127],v[76:79]
v_mfma_f32_16x16x32_bf16 v[76:79],a[224:227],a[128:131],v[76:79]
v_mfma_f32_16x16x32_bf16 v[76:79],a[228:231],a[132:135],v[76:79]
s_waitcnt vmcnt(12)
s_barrier
v_mfma_f32_16x16x32_bf16 v[76:79],a[232:235],a[136:139],v[76:79]
v_mfma_f32_16x16x32_bf16 v[76:79],a[236:239],a[140:143],v[76:79]
ds_read_b64_tr_b16 a[240:241],v3 offset:24576
ds_read_b64_tr_b16 a[242:243],v3 offset:30720
v_mfma_f32_16x16x32_bf16 v[84:87],a[216:219],a[144:147],0
v_mfma_f32_16x16x32_bf16 v[84:87],a[220:223],a[148:151],v[84:87]
ds_read_b64_tr_b16 a[244:245],v4 offset:24576
ds_read_b64_tr_b16 a[246:247],v4 offset:30720
v_mfma_f32_16x16x32_bf16 v[84:87],a[224:227],a[152:155],v[84:87]
v_mfma_f32_16x16x32_bf16 v[84:87],a[228:231],a[156:159],v[84:87]
ds_read_b64_tr_b16 a[248:249],v5 offset:24576
ds_read_b64_tr_b16 a[250:251],v5 offset:30720
v_mfma_f32_16x16x32_bf16 v[84:87],a[232:235],a[160:163],v[84:87]
v_mfma_f32_16x16x32_bf16 v[84:87],a[236:239],a[164:167],v[84:87]
ds_read_b64_tr_b16 a[252:253],v6 offset:24576
ds_read_b64_tr_b16 a[254:255],v6 offset:30720
v_mfma_f32_16x16x32_bf16 v[92:95],a[216:219],a[168:171],0
v_mfma_f32_16x16x32_bf16 v[92:95],a[220:223],a[172:175],v[92:95]
v_mfma_f32_16x16x32_bf16 v[92:95],a[224:227],a[176:179],v[92:95]
v_mfma_f32_16x16x32_bf16 v[92:95],a[228:231],a[180:183],v[92:95]
v_mfma_f32_16x16x32_bf16 v[92:95],a[232:235],a[184:187],v[92:95]
v_mfma_f32_16x16x32_bf16 v[92:95],a[236:239],a[188:191],v[92:95]
s_cbranch_scc1 L_loop4w0
s_cmp_ge_u32 s69,8
s_cbranch_scc1 L_end4
s_cmp_eq_u32 s40,0
s_cbranch_scc1 L_tr43
s_branch L_tr44
.p2align 6
L_loop4w1:
s_waitcnt lgkmcnt(4)
v_mfma_f32_16x16x32_bf16 v[160:163],a[240:243],v[96:99],v[160:163]
s_add_u32 m0,s23,12288
ds_read_b128 a[192:195],v1 offset:12288
v_fma_f32 v78,v78,s36,v17
v_mfma_f32_16x16x32_bf16 v[208:211],a[240:243],v[100:103],v[208:211]
buffer_load_dwordx4 v7,s[8:11],s21 offen offset:0 lds
v_mfma_f32_16x16x32_bf16 a[0:3],a[240:243],v[104:107],a[0:3]
s_add_u32 m0,s23,13184
ds_read_b128 a[196:199],v2 offset:12288
v_fma_f32 v86,v86,s36,v18
v_mfma_f32_16x16x32_bf16 a[48:51],a[240:243],v[108:111],a[48:51]
ds_read_b64_tr_b16 a[240:241],v3 offset:25600
ds_read_b64_tr_b16 a[242:243],v3 offset:31744
v_mfma_f32_16x16x32_bf16 v[164:167],a[244:247],v[96:99],v[164:167]
ds_read_b128 a[200:203],v1 offset:13312
v_fma_f32 v85,v85,s36,v18
v_mfma_f32_16x16x32_bf16 v[212:215],a[244:247],v[100:103],v[212:215]
ds_read_b128 a[204:207],v2 offset:13312
v_fma_f32 v90,v90,s36,v19
v_mfma_f32_16x16x32_bf16 a[4:7],a[244:247],v[104:107],a[4:7]
ds_read_b128 a[208:211],v1 offset:14336
v_fma_f32 v88,v88,s36,v19
v_mfma_f32_16x16x32_bf16 a[52:55],a[244:247],v[108:111],a[52:55]
s_waitcnt lgkmcnt(7)
ds_read_b64_tr_b16 a[244:245],v4 offset:25600
ds_read_b64_tr_b16 a[246:247],v4 offset:31744
v_mfma_f32_16x16x32_bf16 v[168:171],a[248:251],v[96:99],v[168:171]
ds_read_b128 a[212:215],v2 offset:14336
v_fma_f32 v77,v77,s36,v17
v_mfma_f32_16x16x32_bf16 v[216:219],a[248:251],v[100:103],v[216:219]
buffer_load_dwordx4 v7,s[8:11],s21 offen offset:128 lds
v_mfma_f32_16x16x32_bf16 a[8:11],a[248:251],v[104:107],a[8:11]
s_add_u32 m0,s23,14080
ds_read_b128 a[216:219],v1 offset:18432
v_fma_f32 v83,v83,s36,v18
v_mfma_f32_16x16x32_bf16 a[56:59],a[248:251],v[108:111],a[56:59]
ds_read_b64_tr_b16 a[248:249],v5 offset:25600
ds_read_b64_tr_b16 a[250:251],v5 offset:31744
v_mfma_f32_16x16x32_bf16 v[172:175],a[252:255],v[96:99],v[172:175]
ds_read_b128 a[220:223],v2 offset:18432
v_fma_f32 v70,v70,s36,v16
v_mfma_f32_16x16x32_bf16 v[220:223],a[252:255],v[100:103],v[220:223]
ds_read_b128 a[224:227],v1 offset:19456
v_fma_f32 v76,v76,s36,v17
v_mfma_f32_16x16x32_bf16 a[12:15],a[252:255],v[104:107],a[12:15]
ds_read_b128 a[232:235],v1 offset:20480
v_fma_f32 v82,v82,s36,v18
v_mfma_f32_16x16x32_bf16 a[60:63],a[252:255],v[108:111],a[60:63]
s_waitcnt lgkmcnt(7)
ds_read_b64_tr_b16 a[254:255],v6 offset:31744
ds_read_b64_tr_b16 a[252:253],v6 offset:25600
v_mfma_f32_16x16x32_bf16 v[176:179],a[240:243],v[96:99],v[176:179]
ds_read_b128 a[228:231],v2 offset:19456
v_fma_f32 v89,v89,s36,v19
v_mfma_f32_16x16x32_bf16 v[224:227],a[240:243],v[100:103],v[224:227]
buffer_load_dwordx4 v7,s[8:11],s21 offen offset:256 lds
v_mfma_f32_16x16x32_bf16 a[16:19],a[240:243],v[104:107],a[16:19]
s_add_u32 s21,s21,12288
ds_read_b128 a[236:239],v2 offset:20480
v_fma_f32 v94,v94,s36,v19
v_mfma_f32_16x16x32_bf16 a[64:67],a[240:243],v[108:111],a[64:67]
s_add_u32 m0,s22,0
ds_read_b64_tr_b16 a[240:241],v3 offset:26624
ds_read_b64_tr_b16 a[242:243],v3 offset:32768
v_mfma_f32_16x16x32_bf16 v[180:183],a[244:247],v[96:99],v[180:183]
v_exp_f32 v76,v76
v_mfma_f32_16x16x32_bf16 v[228:231],a[244:247],v[100:103],v[228:231]
v_exp_f32 v70,v70
v_mfma_f32_16x16x32_bf16 a[20:23],a[244:247],v[104:107],a[20:23]
v_exp_f32 v83,v83
v_mfma_f32_16x16x32_bf16 a[68:71],a[244:247],v[108:111],a[68:71]
s_waitcnt lgkmcnt(4)
ds_read_b64_tr_b16 a[246:247],v4 offset:32768
ds_read_b64_tr_b16 a[244:245],v4 offset:26624
v_mfma_f32_16x16x32_bf16 v[184:187],a[248:251],v[96:99],v[184:187]
buffer_load_dwordx4 v7,s[4:7],s20 offen offset:0 lds
v_mfma_f32_16x16x32_bf16 v[232:235],a[248:251],v[100:103],v[232:235]
s_add_u32 m0,s22,896
v_exp_f32 v90,v90
v_mfma_f32_16x16x32_bf16 a[24:27],a[248:251],v[104:107],a[24:27]
v_exp_f32 v94,v94
v_mfma_f32_16x16x32_bf16 a[72:75],a[248:251],v[108:111],a[72:75]
ds_read_b64_tr_b16 a[250:251],v5 offset:32768
ds_read_b64_tr_b16 a[248:249],v5 offset:26624
v_mfma_f32_16x16x32_bf16 v[188:191],a[252:255],v[96:99],v[188:191]
v_exp_f32 v89,v89
v_mfma_f32_16x16x32_bf16 v[236:239],a[252:255],v[100:103],v[236:239]
v_exp_f32 v85,v85
v_mfma_f32_16x16x32_bf16 a[28:31],a[252:255],v[104:107],a[28:31]
v_exp_f32 v88,v88
v_mfma_f32_16x16x32_bf16 a[76:79],a[252:255],v[108:111],a[76:79]
s_waitcnt lgkmcnt(2)
ds_read_b64_tr_b16 a[252:253],v6 offset:26624
ds_read_b64_tr_b16 a[254:255],v6 offset:32768
v_mfma_f32_16x16x32_bf16 v[192:195],a[240:243],v[96:99],v[192:195]
buffer_load_dwordx4 v7,s[4:7],s20 offen offset:128 lds
v_mfma_f32_16x16x32_bf16 v[240:243],a[240:243],v[100:103],v[240:243]
s_add_u32 m0,s22,1792
v_exp_f32 v78,v78
v_mfma_f32_16x16x32_bf16 a[32:35],a[240:243],v[104:107],a[32:35]
v_exp_f32 v86,v86
v_mfma_f32_16x16x32_bf16 a[80:83],a[240:243],v[108:111],a[80:83]
v_exp_f32 v77,v77
v_mfma_f32_16x16x32_bf16 v[196:199],a[244:247],v[96:99],v[196:199]
v_exp_f32 v82,v82
v_mfma_f32_16x16x32_bf16 v[244:247],a[244:247],v[100:103],v[244:247]
ds_read_b128 v[156:159],v11 offset:0
v_fma_f32 v81,v81,s36,v18
v_mfma_f32_16x16x32_bf16 a[36:39],a[244:247],v[104:107],a[36:39]
v_exp_f32 v81,v81
v_mfma_f32_16x16x32_bf16 a[84:87],a[244:247],v[108:111],a[84:87]
s_waitcnt lgkmcnt(1)
v_fma_f32 v92,v92,s36,v19
v_fma_f32 v79,v79,s36,v17
v_mfma_f32_16x16x32_bf16 v[200:203],a[248:251],v[96:99],v[200:203]
buffer_load_dwordx4 v7,s[4:7],s20 offen offset:256 lds
v_mfma_f32_16x16x32_bf16 v[248:251],a[248:251],v[100:103],v[248:251]
s_add_u32 s20,s20,12288
v_exp_f32 v92,v92
v_mfma_f32_16x16x32_bf16 a[40:43],a[248:251],v[104:107],a[40:43]
v_exp_f32 v79,v79
v_mfma_f32_16x16x32_bf16 a[88:91],a[248:251],v[108:111],a[88:91]
v_fma_f32 v71,v71,s36,v16
v_fma_f32 v69,v69,s36,v16
v_mfma_f32_16x16x32_bf16 v[204:207],a[252:255],v[96:99],v[204:207]
v_exp_f32 v69,v69
v_mfma_f32_16x16x32_bf16 v[252:255],a[252:255],v[100:103],v[252:255]
v_exp_f32 v71,v71
v_mfma_f32_16x16x32_bf16 a[44:47],a[252:255],v[104:107],a[44:47]
v_fma_f32 v87,v87,s36,v18
v_fma_f32 v95,v95,s36,v19
v_mfma_f32_16x16x32_bf16 a[92:95],a[252:255],v[108:111],a[92:95]
v_exp_f32 v87,v87
v_mfma_f32_16x16x32_bf16 v[32:35],a[192:195],a[96:99],0
v_exp_f32 v95,v95
v_mfma_f32_16x16x32_bf16 v[32:35],a[196:199],a[100:103],v[32:35]
v_cvt_pk_bf16_f32 v123,v86,v87
v_fma_f32 v80,v80,s36,v18
v_mfma_f32_16x16x32_bf16 v[32:35],a[200:203],a[104:107],v[32:35]
v_exp_f32 v80,v80
v_mfma_f32_16x16x32_bf16 v[32:35],a[204:207],a[108:111],v[32:35]
v_cvt_pk_bf16_f32 v120,v80,v81
v_fma_f32 v84,v84,s36,v18
v_mfma_f32_16x16x32_bf16 v[32:35],a[208:211],a[112:115],v[32:35]
v_exp_f32 v84,v84
v_mfma_f32_16x16x32_bf16 v[32:35],a[212:215],a[116:119],v[32:35]
s_waitcnt lgkmcnt(0)
buffer_store_dwordx4 v[156:159],v10,s[16:19],s27 offen offset:0 nt
v_mfma_f32_16x16x32_bf16 v[40:43],a[192:195],a[120:123],0
s_add_u32 m0,s29,0
v_fma_f32 v68,v68,s36,v16
v_fma_f32 v93,v93,s36,v19
v_mfma_f32_16x16x32_bf16 v[40:43],a[196:199],a[124:127],v[40:43]
v_exp_f32 v68,v68
v_mfma_f32_16x16x32_bf16 v[40:43],a[200:203],a[128:131],v[40:43]
ds_read_b128 v[152:155],v11 offset:1024
v_fma_f32 v91,v91,s36,v19
v_mfma_f32_16x16x32_bf16 v[40:43],a[204:207],a[132:135],v[40:43]
v_exp_f32 v91,v91
v_mfma_f32_16x16x32_bf16 v[40:43],a[208:211],a[136:139],v[40:43]
v_exp_f32 v93,v93
v_mfma_f32_16x16x32_bf16 v[40:43],a[212:215],a[140:143],v[40:43]
v_cvt_pk_bf16_f32 v125,v90,v91
v_cvt_pk_bf16_f32 v127,v94,v95
v_mfma_f32_16x16x32_bf16 v[48:51],a[192:195],a[144:147],0
v_cvt_pk_bf16_f32 v121,v82,v83
v_cvt_pk_bf16_f32 v122,v84,v85
v_mfma_f32_16x16x32_bf16 v[48:51],a[196:199],a[148:151],v[48:51]
buffer_load_dwordx4 v8,s[12:15],s28 offen offset:0 nt lds
v_mfma_f32_16x16x32_bf16 v[136:139],v[24:27],v[120:123],v[136:139]
v_fma_f32 v43,v43,s36,v17
v_fma_f32 v34,v34,s36,v16
v_mfma_f32_16x16x32_bf16 v[48:51],a[200:203],a[152:155],v[48:51]
v_exp_f32 v43,v43
v_mfma_f32_16x16x32_bf16 v[48:51],a[204:207],a[156:159],v[48:51]
v_exp_f32 v34,v34
v_mfma_f32_16x16x32_bf16 v[48:51],a[208:211],a[160:163],v[48:51]
v_cvt_pk_bf16_f32 v115,v70,v71
v_cvt_pk_bf16_f32 v126,v92,v93
v_mfma_f32_16x16x32_bf16 v[48:51],a[212:215],a[164:167],v[48:51]
v_cvt_pk_bf16_f32 v118,v76,v77
v_fma_f32 v32,v32,s36,v16
v_mfma_f32_16x16x32_bf16 v[56:59],a[192:195],a[168:171],0
v_exp_f32 v32,v32
v_mfma_f32_16x16x32_bf16 v[56:59],a[196:199],a[172:175],v[56:59]
v_fma_f32 v35,v35,s36,v16
v_fma_f32 v42,v42,s36,v17
v_mfma_f32_16x16x32_bf16 v[56:59],a[200:203],a[176:179],v[56:59]
v_exp_f32 v42,v42
v_mfma_f32_16x16x32_bf16 v[56:59],a[204:207],a[180:183],v[56:59]
s_waitcnt lgkmcnt(0)
buffer_store_dwordx4 v[152:155],v10,s[16:19],s27 offen offset:128 nt
v_mfma_f32_16x16x32_bf16 v[56:59],a[208:211],a[184:187],v[56:59]
s_add_u32 m0,s29,896
v_exp_f32 v35,v35
v_mfma_f32_16x16x32_bf16 v[56:59],a[212:215],a[188:191],v[56:59]
v_cvt_pk_bf16_f32 v124,v88,v89
v_cvt_pk_bf16_f32 v114,v68,v69
v_mfma_f32_16x16x32_bf16 v[36:39],a[216:219],a[96:99],0
v_fma_f32 v33,v33,s36,v16
v_cvt_pk_bf16_f32 v119,v78,v79
v_mfma_f32_16x16x32_bf16 v[140:143],v[24:27],v[124:127],v[140:143]
v_exp_f32 v33,v33
v_mfma_f32_16x16x32_bf16 v[128:131],v[24:27],v[112:115],v[128:131]
v_fma_f32 v41,v41,s36,v17
v_cvt_pk_bf16_f32 v101,v42,v43
v_mfma_f32_16x16x32_bf16 v[132:135],v[24:27],v[116:119],v[132:135]
v_exp_f32 v41,v41
v_mfma_f32_16x16x32_bf16 v[36:39],a[220:223],a[100:103],v[36:39]
v_fma_f32 v40,v40,s36,v17
v_cvt_pk_bf16_f32 v96,v32,v33
v_mfma_f32_16x16x32_bf16 v[36:39],a[224:227],a[104:107],v[36:39]
buffer_load_dwordx4 v8,s[12:15],s28 offen offset:128 nt lds
v_mfma_f32_16x16x32_bf16 v[36:39],a[228:231],a[108:111],v[36:39]
v_exp_f32 v40,v40
s_waitcnt vmcnt(10)
s_barrier
v_mfma_f32_16x16x32_bf16 v[36:39],a[232:235],a[112:115],v[36:39]
v_cvt_pk_bf16_f32 v100,v40,v41
v_cvt_pk_bf16_f32 v97,v34,v35
v_mfma_f32_16x16x32_bf16 v[36:39],a[236:239],a[116:119],v[36:39]
v_mfma_f32_16x16x32_bf16 v[44:47],a[216:219],a[120:123],0
v_mfma_f32_16x16x32_bf16 v[44:47],a[220:223],a[124:127],v[44:47]
v_mfma_f32_16x16x32_bf16 v[44:47],a[224:227],a[128:131],v[44:47]
v_mfma_f32_16x16x32_bf16 v[44:47],a[228:231],a[132:135],v[44:47]
v_mfma_f32_16x16x32_bf16 v[44:47],a[232:235],a[136:139],v[44:47]
ds_read_b64_tr_b16 a[242:243],v3 offset:6144
ds_read_b64_tr_b16 a[240:241],v3 offset:0
v_mfma_f32_16x16x32_bf16 v[44:47],a[236:239],a[140:143],v[44:47]
v_mfma_f32_16x16x32_bf16 v[52:55],a[216:219],a[144:147],0
ds_read_b64_tr_b16 a[246:247],v4 offset:6144
ds_read_b64_tr_b16 a[244:245],v4 offset:0
v_mfma_f32_16x16x32_bf16 v[52:55],a[220:223],a[148:151],v[52:55]
v_mfma_f32_16x16x32_bf16 v[52:55],a[224:227],a[152:155],v[52:55]
ds_read_b64_tr_b16 a[248:249],v5 offset:0
ds_read_b64_tr_b16 a[250:251],v5 offset:6144
v_mfma_f32_16x16x32_bf16 v[52:55],a[228:231],a[156:159],v[52:55]
v_mfma_f32_16x16x32_bf16 v[52:55],a[232:235],a[160:163],v[52:55]
ds_read_b64_tr_b16 a[252:253],v6 offset:0
ds_read_b64_tr_b16 a[254:255],v6 offset:6144
v_mfma_f32_16x16x32_bf16 v[52:55],a[236:239],a[164:167],v[52:55]
v_mfma_f32_16x16x32_bf16 v[60:63],a[216:219],a[168:171],0
v_mfma_f32_16x16x32_bf16 v[60:63],a[220:223],a[172:175],v[60:63]
v_mfma_f32_16x16x32_bf16 v[60:63],a[224:227],a[176:179],v[60:63]
v_mfma_f32_16x16x32_bf16 v[60:63],a[228:231],a[180:183],v[60:63]
v_mfma_f32_16x16x32_bf16 v[60:63],a[232:235],a[184:187],v[60:63]
v_mfma_f32_16x16x32_bf16 v[60:63],a[236:239],a[188:191],v[60:63]
s_waitcnt lgkmcnt(2)
v_mfma_f32_16x16x32_bf16 v[160:163],a[240:243],v[112:115],v[160:163]
s_add_u32 m0,s23,24576
ds_read_b128 a[192:195],v1 offset:24576
v_fma_f32 v36,v36,s36,v16
v_mfma_f32_16x16x32_bf16 v[208:211],a[240:243],v[116:119],v[208:211]
buffer_load_dwordx4 v7,s[8:11],s21 offen offset:0 lds
v_mfma_f32_16x16x32_bf16 a[0:3],a[240:243],v[120:123],a[0:3]
s_add_u32 m0,s23,25472
ds_read_b128 a[196:199],v2 offset:24576
v_fma_f32 v37,v37,s36,v16
v_mfma_f32_16x16x32_bf16 a[48:51],a[240:243],v[124:127],a[48:51]
ds_read_b64_tr_b16 a[240:241],v3 offset:1024
ds_read_b64_tr_b16 a[242:243],v3 offset:7168
v_mfma_f32_16x16x32_bf16 v[164:167],a[244:247],v[112:115],v[164:167]
ds_read_b128 a[200:203],v1 offset:25600
v_fma_f32 v38,v38,s36,v16
v_mfma_f32_16x16x32_bf16 v[212:215],a[244:247],v[116:119],v[212:215]
ds_read_b128 a[204:207],v2 offset:25600
v_fma_f32 v39,v39,s36,v16
v_mfma_f32_16x16x32_bf16 a[4:7],a[244:247],v[120:123],a[4:7]
ds_read_b128 a[208:211],v1 offset:26624
v_fma_f32 v44,v44,s36,v17
v_mfma_f32_16x16x32_bf16 a[52:55],a[244:247],v[124:127],a[52:55]
ds_read_b64_tr_b16 a[244:245],v4 offset:1024
ds_read_b64_tr_b16 a[246:247],v4 offset:7168
v_mfma_f32_16x16x32_bf16 v[168:171],a[248:251],v[112:115],v[168:171]
ds_read_b128 a[212:215],v2 offset:26624
v_fma_f32 v45,v45,s36,v17
v_mfma_f32_16x16x32_bf16 v[216:219],a[248:251],v[116:119],v[216:219]
buffer_load_dwordx4 v7,s[8:11],s21 offen offset:128 lds
v_mfma_f32_16x16x32_bf16 a[8:11],a[248:251],v[120:123],a[8:11]
s_add_u32 m0,s23,26368
ds_read_b128 a[216:219],v1 offset:30720
v_fma_f32 v46,v46,s36,v17
v_mfma_f32_16x16x32_bf16 a[56:59],a[248:251],v[124:127],a[56:59]
s_waitcnt lgkmcnt(8)
ds_read_b64_tr_b16 a[248:249],v5 offset:1024
ds_read_b64_tr_b16 a[250:251],v5 offset:7168
v_mfma_f32_16x16x32_bf16 v[172:175],a[252:255],v[112:115],v[172:175]
ds_read_b128 a[220:223],v2 offset:30720
v_fma_f32 v47,v47,s36,v17
v_mfma_f32_16x16x32_bf16 v[220:223],a[252:255],v[116:119],v[220:223]
ds_read_b128 a[224:227],v1 offset:31744
v_fma_f32 v48,v48,s36,v18
v_mfma_f32_16x16x32_bf16 a[12:15],a[252:255],v[120:123],a[12:15]
ds_read_b128 a[228:231],v2 offset:31744
v_fma_f32 v49,v49,s36,v18
v_mfma_f32_16x16x32_bf16 a[60:63],a[252:255],v[124:127],a[60:63]
s_waitcnt lgkmcnt(7)
ds_read_b64_tr_b16 a[252:253],v6 offset:1024
ds_read_b64_tr_b16 a[254:255],v6 offset:7168
v_mfma_f32_16x16x32_bf16 v[176:179],a[240:243],v[112:115],v[176:179]
ds_read_b128 a[232:235],v1 offset:32768
v_fma_f32 v50,v50,s36,v18
v_mfma_f32_16x16x32_bf16 v[224:227],a[240:243],v[116:119],v[224:227]
buffer_load_dwordx4 v7,s[8:11],s21 offen offset:256 lds
v_mfma_f32_16x16x32_bf16 a[16:19],a[240:243],v[120:123],a[16:19]
s_add_u32 s21,s21,12288
ds_read_b128 a[236:239],v2 offset:32768
v_fma_f32 v51,v51,s36,v18
v_mfma_f32_16x16x32_bf16 a[64:67],a[240:243],v[124:127],a[64:67]
s_add_u32 m0,s22,12288
ds_read_b64_tr_b16 a[240:241],v3 offset:2048
ds_read_b64_tr_b16 a[242:243],v3 offset:8192
v_mfma_f32_16x16x32_bf16 v[180:183],a[244:247],v[112:115],v[180:183]
v_fma_f32 v52,v52,s36,v18
v_fma_f32 v53,v53,s36,v18
v_mfma_f32_16x16x32_bf16 v[228:231],a[244:247],v[116:119],v[228:231]
v_fma_f32 v54,v54,s36,v18
v_fma_f32 v55,v55,s36,v18
v_mfma_f32_16x16x32_bf16 a[20:23],a[244:247],v[120:123],a[20:23]
v_fma_f32 v56,v56,s36,v19
v_fma_f32 v57,v57,s36,v19
v_mfma_f32_16x16x32_bf16 a[68:71],a[244:247],v[124:127],a[68:71]
s_waitcnt lgkmcnt(4)
ds_read_b64_tr_b16 a[244:245],v4 offset:2048
ds_read_b64_tr_b16 a[246:247],v4 offset:8192
v_mfma_f32_16x16x32_bf16 v[184:187],a[248:251],v[112:115],v[184:187]
buffer_load_dwordx4 v7,s[4:7],s20 offen offset:0 lds
v_mfma_f32_16x16x32_bf16 v[232:235],a[248:251],v[116:119],v[232:235]
s_add_u32 m0,s22,13184
v_fma_f32 v58,v58,s36,v19
v_fma_f32 v59,v59,s36,v19
v_mfma_f32_16x16x32_bf16 a[24:27],a[248:251],v[120:123],a[24:27]
v_fma_f32 v60,v60,s36,v19
v_fma_f32 v61,v61,s36,v19
v_mfma_f32_16x16x32_bf16 a[72:75],a[248:251],v[124:127],a[72:75]
ds_read_b64_tr_b16 a[248:249],v5 offset:2048
ds_read_b64_tr_b16 a[250:251],v5 offset:8192
v_mfma_f32_16x16x32_bf16 v[188:191],a[252:255],v[112:115],v[188:191]
v_fma_f32 v62,v62,s36,v19
v_fma_f32 v63,v63,s36,v19
v_mfma_f32_16x16x32_bf16 v[236:239],a[252:255],v[116:119],v[236:239]
v_exp_f32 v36,v36
v_mfma_f32_16x16x32_bf16 a[28:31],a[252:255],v[120:123],a[28:31]
v_exp_f32 v37,v37
v_mfma_f32_16x16x32_bf16 a[76:79],a[252:255],v[124:127],a[76:79]
s_waitcnt lgkmcnt(2)
ds_read_b64_tr_b16 a[252:253],v6 offset:2048
ds_read_b64_tr_b16 a[254:255],v6 offset:8192
v_mfma_f32_16x16x32_bf16 v[192:195],a[240:243],v[112:115],v[192:195]
buffer_load_dwordx4 v7,s[4:7],s20 offen offset:128 lds
v_mfma_f32_16x16x32_bf16 v[240:243],a[240:243],v[116:119],v[240:243]
s_add_u32 m0,s22,14080
v_exp_f32 v38,v38
v_mfma_f32_16x16x32_bf16 a[32:35],a[240:243],v[120:123],a[32:35]
v_exp_f32 v39,v39
v_mfma_f32_16x16x32_bf16 a[80:83],a[240:243],v[124:127],a[80:83]
v_exp_f32 v44,v44
v_mfma_f32_16x16x32_bf16 v[196:199],a[244:247],v[112:115],v[196:199]
v_exp_f32 v45,v45
v_mfma_f32_16x16x32_bf16 v[244:247],a[244:247],v[116:119],v[244:247]
ds_read_b128 v[156:159],v11 offset:2048
v_cvt_pk_bf16_f32 v98,v36,v37
v_mfma_f32_16x16x32_bf16 a[36:39],a[244:247],v[120:123],a[36:39]
v_exp_f32 v46,v46
v_mfma_f32_16x16x32_bf16 a[84:87],a[244:247],v[124:127],a[84:87]
s_waitcnt lgkmcnt(1)
v_exp_f32 v47,v47
v_mfma_f32_16x16x32_bf16 v[200:203],a[248:251],v[112:115],v[200:203]
buffer_load_dwordx4 v7,s[4:7],s20 offen offset:256 lds
v_mfma_f32_16x16x32_bf16 v[248:251],a[248:251],v[116:119],v[248:251]
s_add_u32 s20,s20,12288
v_exp_f32 v48,v48
v_mfma_f32_16x16x32_bf16 a[40:43],a[248:251],v[120:123],a[40:43]
v_exp_f32 v49,v49
v_mfma_f32_16x16x32_bf16 a[88:91],a[248:251],v[124:127],a[88:91]
v_exp_f32 v50,v50
v_mfma_f32_16x16x32_bf16 v[204:207],a[252:255],v[112:115],v[204:207]
v_exp_f32 v51,v51
v_mfma_f32_16x16x32_bf16 v[252:255],a[252:255],v[116:119],v[252:255]
v_exp_f32 v52,v52
v_mfma_f32_16x16x32_bf16 a[44:47],a[252:255],v[120:123],a[44:47]
v_exp_f32 v53,v53
v_mfma_f32_16x16x32_bf16 a[92:95],a[252:255],v[124:127],a[92:95]
v_exp_f32 v54,v54
v_mfma_f32_16x16x32_bf16 v[64:67],a[192:195],a[96:99],0
v_exp_f32 v55,v55
v_mfma_f32_16x16x32_bf16 v[64:67],a[196:199],a[100:103],v[64:67]
v_exp_f32 v56,v56
v_mfma_f32_16x16x32_bf16 v[64:67],a[200:203],a[104:107],v[64:67]
v_exp_f32 v57,v57
v_mfma_f32_16x16x32_bf16 v[64:67],a[204:207],a[108:111],v[64:67]
v_exp_f32 v58,v58
v_mfma_f32_16x16x32_bf16 v[64:67],a[208:211],a[112:115],v[64:67]
v_exp_f32 v59,v59
v_mfma_f32_16x16x32_bf16 v[64:67],a[212:215],a[116:119],v[64:67]
s_waitcnt lgkmcnt(0)
buffer_store_dwordx4 v[156:159],v10,s[16:19],s27 offen offset:256 nt
v_mfma_f32_16x16x32_bf16 v[72:75],a[192:195],a[120:123],0
s_add_u32 m0,s29,1792
v_exp_f32 v60,v60
v_mfma_f32_16x16x32_bf16 v[72:75],a[196:199],a[124:127],v[72:75]
v_exp_f32 v61,v61
v_mfma_f32_16x16x32_bf16 v[72:75],a[200:203],a[128:131],v[72:75]
v_exp_f32 v62,v62
v_mfma_f32_16x16x32_bf16 v[72:75],a[204:207],a[132:135],v[72:75]
v_exp_f32 v63,v63
v_mfma_f32_16x16x32_bf16 v[72:75],a[208:211],a[136:139],v[72:75]
v_cvt_pk_bf16_f32 v99,v38,v39
v_cvt_pk_bf16_f32 v102,v44,v45
v_mfma_f32_16x16x32_bf16 v[72:75],a[212:215],a[140:143],v[72:75]
v_cvt_pk_bf16_f32 v103,v46,v47
v_cvt_pk_bf16_f32 v104,v48,v49
v_mfma_f32_16x16x32_bf16 v[128:131],v[24:27],v[96:99],v[128:131]
v_cvt_pk_bf16_f32 v105,v50,v51
v_cvt_pk_bf16_f32 v106,v52,v53
v_mfma_f32_16x16x32_bf16 v[132:135],v[24:27],v[100:103],v[132:135]
v_cvt_pk_bf16_f32 v107,v54,v55
v_cvt_pk_bf16_f32 v108,v56,v57
v_mfma_f32_16x16x32_bf16 v[80:83],a[192:195],a[144:147],0
v_cvt_pk_bf16_f32 v109,v58,v59
v_cvt_pk_bf16_f32 v110,v60,v61
v_mfma_f32_16x16x32_bf16 v[136:139],v[24:27],v[104:107],v[136:139]
v_cvt_pk_bf16_f32 v111,v62,v63
v_fma_f32 v64,v64,s36,v16
v_mfma_f32_16x16x32_bf16 v[80:83],a[196:199],a[148:151],v[80:83]
v_fma_f32 v65,v65,s36,v16
v_fma_f32 v66,v66,s36,v16
v_mfma_f32_16x16x32_bf16 v[140:143],v[24:27],v[108:111],v[140:143]
v_fma_f32 v67,v67,s36,v16
v_fma_f32 v72,v72,s36,v17
v_mfma_f32_16x16x32_bf16 v[80:83],a[200:203],a[152:155],v[80:83]
v_fma_f32 v73,v73,s36,v17
v_fma_f32 v74,v74,s36,v17
v_mfma_f32_16x16x32_bf16 v[80:83],a[204:207],a[156:159],v[80:83]
v_fma_f32 v75,v75,s36,v17
v_mfma_f32_16x16x32_bf16 v[80:83],a[208:211],a[160:163],v[80:83]
v_exp_f32 v64,v64
v_mfma_f32_16x16x32_bf16 v[80:83],a[212:215],a[164:167],v[80:83]
v_exp_f32 v65,v65
v_mfma_f32_16x16x32_bf16 v[88:91],a[192:195],a[168:171],0
buffer_load_dwordx4 v8,s[12:15],s28 offen offset:256 nt lds
v_mfma_f32_16x16x32_bf16 v[88:91],a[196:199],a[172:175],v[88:91]
s_add_u32 s27,s27,3072
v_exp_f32 v66,v66
v_mfma_f32_16x16x32_bf16 v[88:91],a[200:203],a[176:179],v[88:91]
s_add_u32 s28,s28,3072
v_exp_f32 v67,v67
v_mfma_f32_16x16x32_bf16 v[88:91],a[204:207],a[180:183],v[88:91]
s_add_u32 s29,s29,3072
v_exp_f32 v72,v72
v_mfma_f32_16x16x32_bf16 v[88:91],a[208:211],a[184:187],v[88:91]
v_exp_f32 v73,v73
v_mfma_f32_16x16x32_bf16 v[88:91],a[212:215],a[188:191],v[88:91]
v_exp_f32 v74,v74
v_mfma_f32_16x16x32_bf16 v[68:71],a[216:219],a[96:99],0
v_exp_f32 v75,v75
v_mfma_f32_16x16x32_bf16 v[68:71],a[220:223],a[100:103],v[68:71]
v_cvt_pk_bf16_f32 v112,v64,v65
v_cvt_pk_bf16_f32 v113,v66,v67
v_mfma_f32_16x16x32_bf16 v[68:71],a[224:227],a[104:107],v[68:71]
v_cvt_pk_bf16_f32 v116,v72,v73
v_cvt_pk_bf16_f32 v117,v74,v75
v_mfma_f32_16x16x32_bf16 v[68:71],a[228:231],a[108:111],v[68:71]
v_mfma_f32_16x16x32_bf16 v[68:71],a[232:235],a[112:115],v[68:71]
s_waitcnt vmcnt(12)
s_barrier
v_mfma_f32_16x16x32_bf16 v[68:71],a[236:239],a[116:119],v[68:71]
v_mfma_f32_16x16x32_bf16 v[76:79],a[216:219],a[120:123],0
v_mfma_f32_16x16x32_bf16 v[76:79],a[220:223],a[124:127],v[76:79]
v_mfma_f32_16x16x32_bf16 v[76:79],a[224:227],a[128:131],v[76:79]
v_mfma_f32_16x16x32_bf16 v[76:79],a[228:231],a[132:135],v[76:79]
v_mfma_f32_16x16x32_bf16 v[76:79],a[232:235],a[136:139],v[76:79]
v_mfma_f32_16x16x32_bf16 v[76:79],a[236:239],a[140:143],v[76:79]
ds_read_b64_tr_b16 a[240:241],v3 offset:12288
ds_read_b64_tr_b16 a[242:243],v3 offset:18432
v_mfma_f32_16x16x32_bf16 v[84:87],a[216:219],a[144:147],0
v_mfma_f32_16x16x32_bf16 v[84:87],a[220:223],a[148:151],v[84:87]
ds_read_b64_tr_b16 a[244:245],v4 offset:12288
ds_read_b64_tr_b16 a[246:247],v4 offset:18432
v_mfma_f32_16x16x32_bf16 v[84:87],a[224:227],a[152:155],v[84:87]
v_mfma_f32_16x16x32_bf16 v[84:87],a[228:231],a[156:159],v[84:87]
ds_read_b64_tr_b16 a[248:249],v5 offset:12288
ds_read_b64_tr_b16 a[250:251],v5 offset:18432
v_mfma_f32_16x16x32_bf16 v[84:87],a[232:235],a[160:163],v[84:87]
v_mfma_f32_16x16x32_bf16 v[84:87],a[236:239],a[164:167],v[84:87]
ds_read_b64_tr_b16 a[252:253],v6 offset:12288
ds_read_b64_tr_b16 a[254:255],v6 offset:18432
v_mfma_f32_16x16x32_bf16 v[92:95],a[216:219],a[168:171],0
v_mfma_f32_16x16x32_bf16 v[92:95],a[220:223],a[172:175],v[92:95]
v_mfma_f32_16x16x32_bf16 v[92:95],a[224:227],a[176:179],v[92:95]
v_mfma_f32_16x16x32_bf16 v[92:95],a[228:231],a[180:183],v[92:95]
v_mfma_f32_16x16x32_bf16 v[92:95],a[232:235],a[184:187],v[92:95]
v_mfma_f32_16x16x32_bf16 v[92:95],a[236:239],a[188:191],v[92:95]
s_waitcnt lgkmcnt(4)
v_mfma_f32_16x16x32_bf16 v[160:163],a[240:243],v[96:99],v[160:163]
s_add_u32 m0,s23,0
ds_read_b128 a[192:195],v1 offset:0
v_fma_f32 v78,v78,s36,v17
v_mfma_f32_16x16x32_bf16 v[208:211],a[240:243],v[100:103],v[208:211]
buffer_load_dwordx4 v7,s[8:11],s21 offen offset:0 lds
v_mfma_f32_16x16x32_bf16 a[0:3],a[240:243],v[104:107],a[0:3]
s_add_u32 m0,s23,896
ds_read_b128 a[196:199],v2 offset:0
v_fma_f32 v86,v86,s36,v18
v_mfma_f32_16x16x32_bf16 a[48:51],a[240:243],v[108:111],a[48:51]
ds_read_b64_tr_b16 a[240:241],v3 offset:13312
ds_read_b64_tr_b16 a[242:243],v3 offset:19456
v_mfma_f32_16x16x32_bf16 v[164:167],a[244:247],v[96:99],v[164:167]
ds_read_b128 a[200:203],v1 offset:1024
v_fma_f32 v85,v85,s36,v18
v_mfma_f32_16x16x32_bf16 v[212:215],a[244:247],v[100:103],v[212:215]
ds_read_b128 a[204:207],v2 offset:1024
v_fma_f32 v90,v90,s36,v19
v_mfma_f32_16x16x32_bf16 a[4:7],a[244:247],v[104:107],a[4:7]
ds_read_b128 a[208:211],v1 offset:2048
v_fma_f32 v88,v88,s36,v19
v_mfma_f32_16x16x32_bf16 a[52:55],a[244:247],v[108:111],a[52:55]
s_waitcnt lgkmcnt(7)
ds_read_b64_tr_b16 a[244:245],v4 offset:13312
ds_read_b64_tr_b16 a[246:247],v4 offset:19456
v_mfma_f32_16x16x32_bf16 v[168:171],a[248:251],v[96:99],v[168:171]
ds_read_b128 a[212:215],v2 offset:2048
v_fma_f32 v77,v77,s36,v17
v_mfma_f32_16x16x32_bf16 v[216:219],a[248:251],v[100:103],v[216:219]
buffer_load_dwordx4 v7,s[8:11],s21 offen offset:128 lds
v_mfma_f32_16x16x32_bf16 a[8:11],a[248:251],v[104:107],a[8:11]
s_add_u32 m0,s23,1792
ds_read_b128 a[216:219],v1 offset:6144
v_fma_f32 v83,v83,s36,v18
v_mfma_f32_16x16x32_bf16 a[56:59],a[248:251],v[108:111],a[56:59]
ds_read_b64_tr_b16 a[248:249],v5 offset:13312
ds_read_b64_tr_b16 a[250:251],v5 offset:19456
v_mfma_f32_16x16x32_bf16 v[172:175],a[252:255],v[96:99],v[172:175]
ds_read_b128 a[220:223],v2 offset:6144
v_fma_f32 v70,v70,s36,v16
v_mfma_f32_16x16x32_bf16 v[220:223],a[252:255],v[100:103],v[220:223]
ds_read_b128 a[224:227],v1 offset:7168
v_fma_f32 v76,v76,s36,v17
v_mfma_f32_16x16x32_bf16 a[12:15],a[252:255],v[104:107],a[12:15]
ds_read_b128 a[232:235],v1 offset:8192
v_fma_f32 v82,v82,s36,v18
v_mfma_f32_16x16x32_bf16 a[60:63],a[252:255],v[108:111],a[60:63]
s_waitcnt lgkmcnt(7)
ds_read_b64_tr_b16 a[254:255],v6 offset:19456
ds_read_b64_tr_b16 a[252:253],v6 offset:13312
v_mfma_f32_16x16x32_bf16 v[176:179],a[240:243],v[96:99],v[176:179]
ds_read_b128 a[228:231],v2 offset:7168
v_fma_f32 v89,v89,s36,v19
v_mfma_f32_16x16x32_bf16 v[224:227],a[240:243],v[100:103],v[224:227]
buffer_load_dwordx4 v7,s[8:11],s21 offen offset:256 lds
v_mfma_f32_16x16x32_bf16 a[16:19],a[240:243],v[104:107],a[16:19]
s_add_u32 s21,s21,12288
ds_read_b128 a[236:239],v2 offset:8192
v_fma_f32 v94,v94,s36,v19
v_mfma_f32_16x16x32_bf16 a[64:67],a[240:243],v[108:111],a[64:67]
s_add_u32 m0,s22,24576
ds_read_b64_tr_b16 a[240:241],v3 offset:14336
ds_read_b64_tr_b16 a[242:243],v3 offset:20480
v_mfma_f32_16x16x32_bf16 v[180:183],a[244:247],v[96:99],v[180:183]
v_exp_f32 v76,v76
v_mfma_f32_16x16x32_bf16 v[228:231],a[244:247],v[100:103],v[228:231]
v_exp_f32 v70,v70
v_mfma_f32_16x16x32_bf16 a[20:23],a[244:247],v[104:107],a[20:23]
v_exp_f32 v83,v83
v_mfma_f32_16x16x32_bf16 a[68:71],a[244:247],v[108:111],a[68:71]
s_waitcnt lgkmcnt(4)
ds_read_b64_tr_b16 a[246:247],v4 offset:20480
ds_read_b64_tr_b16 a[244:245],v4 offset:14336
v_mfma_f32_16x16x32_bf16 v[184:187],a[248:251],v[96:99],v[184:187]
buffer_load_dwordx4 v7,s[4:7],s20 offen offset:0 lds
v_mfma_f32_16x16x32_bf16 v[232:235],a[248:251],v[100:103],v[232:235]
s_add_u32 m0,s22,25472
v_exp_f32 v90,v90
v_mfma_f32_16x16x32_bf16 a[24:27],a[248:251],v[104:107],a[24:27]
v_exp_f32 v94,v94
v_mfma_f32_16x16x32_bf16 a[72:75],a[248:251],v[108:111],a[72:75]
ds_read_b64_tr_b16 a[250:251],v5 offset:20480
ds_read_b64_tr_b16 a[248:249],v5 offset:14336
v_mfma_f32_16x16x32_bf16 v[188:191],a[252:255],v[96:99],v[188:191]
v_exp_f32 v89,v89
v_mfma_f32_16x16x32_bf16 v[236:239],a[252:255],v[100:103],v[236:239]
v_exp_f32 v85,v85
v_mfma_f32_16x16x32_bf16 a[28:31],a[252:255],v[104:107],a[28:31]
v_exp_f32 v88,v88
v_mfma_f32_16x16x32_bf16 a[76:79],a[252:255],v[108:111],a[76:79]
s_waitcnt lgkmcnt(2)
ds_read_b64_tr_b16 a[252:253],v6 offset:14336
ds_read_b64_tr_b16 a[254:255],v6 offset:20480
v_mfma_f32_16x16x32_bf16 v[192:195],a[240:243],v[96:99],v[192:195]
buffer_load_dwordx4 v7,s[4:7],s20 offen offset:128 lds
v_mfma_f32_16x16x32_bf16 v[240:243],a[240:243],v[100:103],v[240:243]
s_add_u32 m0,s22,26368
v_exp_f32 v78,v78
v_mfma_f32_16x16x32_bf16 a[32:35],a[240:243],v[104:107],a[32:35]
v_exp_f32 v86,v86
v_mfma_f32_16x16x32_bf16 a[80:83],a[240:243],v[108:111],a[80:83]
v_exp_f32 v77,v77
v_mfma_f32_16x16x32_bf16 v[196:199],a[244:247],v[96:99],v[196:199]
v_exp_f32 v82,v82
v_mfma_f32_16x16x32_bf16 v[244:247],a[244:247],v[100:103],v[244:247]
ds_read_b128 v[152:155],v11 offset:3072
v_fma_f32 v81,v81,s36,v18
v_mfma_f32_16x16x32_bf16 a[36:39],a[244:247],v[104:107],a[36:39]
v_exp_f32 v81,v81
v_mfma_f32_16x16x32_bf16 a[84:87],a[244:247],v[108:111],a[84:87]
s_waitcnt lgkmcnt(1)
v_fma_f32 v92,v92,s36,v19
v_fma_f32 v79,v79,s36,v17
v_mfma_f32_16x16x32_bf16 v[200:203],a[248:251],v[96:99],v[200:203]
buffer_load_dwordx4 v7,s[4:7],s20 offen offset:256 lds
v_mfma_f32_16x16x32_bf16 v[248:251],a[248:251],v[100:103],v[248:251]
s_add_u32 s20,s20,12288
v_exp_f32 v92,v92
v_mfma_f32_16x16x32_bf16 a[40:43],a[248:251],v[104:107],a[40:43]
v_exp_f32 v79,v79
v_mfma_f32_16x16x32_bf16 a[88:91],a[248:251],v[108:111],a[88:91]
v_fma_f32 v71,v71,s36,v16
v_fma_f32 v69,v69,s36,v16
v_mfma_f32_16x16x32_bf16 v[204:207],a[252:255],v[96:99],v[204:207]
v_exp_f32 v69,v69
v_mfma_f32_16x16x32_bf16 v[252:255],a[252:255],v[100:103],v[252:255]
v_exp_f32 v71,v71
v_mfma_f32_16x16x32_bf16 a[44:47],a[252:255],v[104:107],a[44:47]
v_fma_f32 v87,v87,s36,v18
v_fma_f32 v95,v95,s36,v19
v_mfma_f32_16x16x32_bf16 a[92:95],a[252:255],v[108:111],a[92:95]
v_exp_f32 v87,v87
v_mfma_f32_16x16x32_bf16 v[32:35],a[192:195],a[96:99],0
v_exp_f32 v95,v95
v_mfma_f32_16x16x32_bf16 v[32:35],a[196:199],a[100:103],v[32:35]
v_cvt_pk_bf16_f32 v123,v86,v87
v_fma_f32 v80,v80,s36,v18
v_mfma_f32_16x16x32_bf16 v[32:35],a[200:203],a[104:107],v[32:35]
v_exp_f32 v80,v80
v_mfma_f32_16x16x32_bf16 v[32:35],a[204:207],a[108:111],v[32:35]
v_cvt_pk_bf16_f32 v120,v80,v81
v_fma_f32 v84,v84,s36,v18
v_mfma_f32_16x16x32_bf16 v[32:35],a[208:211],a[112:115],v[32:35]
v_exp_f32 v84,v84
v_mfma_f32_16x16x32_bf16 v[32:35],a[212:215],a[116:119],v[32:35]
s_waitcnt lgkmcnt(0)
buffer_store_dwordx4 v[152:155],v10,s[16:19],s27 offen offset:0 nt
v_mfma_f32_16x16x32_bf16 v[40:43],a[192:195],a[120:123],0
s_add_u32 m0,s29,0
v_fma_f32 v68,v68,s36,v16
v_fma_f32 v93,v93,s36,v19
v_mfma_f32_16x16x32_bf16 v[40:43],a[196:199],a[124:127],v[40:43]
v_exp_f32 v68,v68
v_mfma_f32_16x16x32_bf16 v[40:43],a[200:203],a[128:131],v[40:43]
ds_read_b128 v[156:159],v11 offset:4096
v_fma_f32 v91,v91,s36,v19
v_mfma_f32_16x16x32_bf16 v[40:43],a[204:207],a[132:135],v[40:43]
v_exp_f32 v91,v91
v_mfma_f32_16x16x32_bf16 v[40:43],a[208:211],a[136:139],v[40:43]
v_exp_f32 v93,v93
v_mfma_f32_16x16x32_bf16 v[40:43],a[212:215],a[140:143],v[40:43]
v_cvt_pk_bf16_f32 v125,v90,v91
v_cvt_pk_bf16_f32 v127,v94,v95
v_mfma_f32_16x16x32_bf16 v[48:51],a[192:195],a[144:147],0
v_cvt_pk_bf16_f32 v121,v82,v83
v_cvt_pk_bf16_f32 v122,v84,v85
v_mfma_f32_16x16x32_bf16 v[48:51],a[196:199],a[148:151],v[48:51]
buffer_load_dwordx4 v9,s[12:15],s28 offen offset:0 nt lds
v_mfma_f32_16x16x32_bf16 v[136:139],v[24:27],v[120:123],v[136:139]
v_fma_f32 v43,v43,s36,v17
v_fma_f32 v34,v34,s36,v16
v_mfma_f32_16x16x32_bf16 v[48:51],a[200:203],a[152:155],v[48:51]
v_exp_f32 v43,v43
v_mfma_f32_16x16x32_bf16 v[48:51],a[204:207],a[156:159],v[48:51]
v_exp_f32 v34,v34
v_mfma_f32_16x16x32_bf16 v[48:51],a[208:211],a[160:163],v[48:51]
v_cvt_pk_bf16_f32 v115,v70,v71
v_cvt_pk_bf16_f32 v126,v92,v93
v_mfma_f32_16x16x32_bf16 v[48:51],a[212:215],a[164:167],v[48:51]
v_cvt_pk_bf16_f32 v118,v76,v77
v_fma_f32 v32,v32,s36,v16
v_mfma_f32_16x16x32_bf16 v[56:59],a[192:195],a[168:171],0
v_exp_f32 v32,v32
v_mfma_f32_16x16x32_bf16 v[56:59],a[196:199],a[172:175],v[56:59]
v_fma_f32 v35,v35,s36,v16
v_fma_f32 v42,v42,s36,v17
v_mfma_f32_16x16x32_bf16 v[56:59],a[200:203],a[176:179],v[56:59]
v_exp_f32 v42,v42
v_mfma_f32_16x16x32_bf16 v[56:59],a[204:207],a[180:183],v[56:59]
s_waitcnt lgkmcnt(0)
buffer_store_dwordx4 v[156:159],v10,s[16:19],s27 offen offset:128 nt
v_mfma_f32_16x16x32_bf16 v[56:59],a[208:211],a[184:187],v[56:59]
s_add_u32 m0,s29,896
v_exp_f32 v35,v35
v_mfma_f32_16x16x32_bf16 v[56:59],a[212:215],a[188:191],v[56:59]
v_cvt_pk_bf16_f32 v124,v88,v89
v_cvt_pk_bf16_f32 v114,v68,v69
v_mfma_f32_16x16x32_bf16 v[36:39],a[216:219],a[96:99],0
v_fma_f32 v33,v33,s36,v16
v_cvt_pk_bf16_f32 v119,v78,v79
v_mfma_f32_16x16x32_bf16 v[140:143],v[24:27],v[124:127],v[140:143]
v_exp_f32 v33,v33
v_mfma_f32_16x16x32_bf16 v[128:131],v[24:27],v[112:115],v[128:131]
v_fma_f32 v41,v41,s36,v17
v_cvt_pk_bf16_f32 v101,v42,v43
v_mfma_f32_16x16x32_bf16 v[132:135],v[24:27],v[116:119],v[132:135]
v_exp_f32 v41,v41
v_mfma_f32_16x16x32_bf16 v[36:39],a[220:223],a[100:103],v[36:39]
v_fma_f32 v40,v40,s36,v17
v_cvt_pk_bf16_f32 v96,v32,v33
v_mfma_f32_16x16x32_bf16 v[36:39],a[224:227],a[104:107],v[36:39]
buffer_load_dwordx4 v9,s[12:15],s28 offen offset:128 nt lds
v_mfma_f32_16x16x32_bf16 v[36:39],a[228:231],a[108:111],v[36:39]
v_exp_f32 v40,v40
s_waitcnt vmcnt(12)
s_barrier
v_mfma_f32_16x16x32_bf16 v[36:39],a[232:235],a[112:115],v[36:39]
v_cvt_pk_bf16_f32 v100,v40,v41
v_cvt_pk_bf16_f32 v97,v34,v35
v_mfma_f32_16x16x32_bf16 v[36:39],a[236:239],a[116:119],v[36:39]
v_mfma_f32_16x16x32_bf16 v[44:47],a[216:219],a[120:123],0
v_mfma_f32_16x16x32_bf16 v[44:47],a[220:223],a[124:127],v[44:47]
v_mfma_f32_16x16x32_bf16 v[44:47],a[224:227],a[128:131],v[44:47]
v_mfma_f32_16x16x32_bf16 v[44:47],a[228:231],a[132:135],v[44:47]
v_mfma_f32_16x16x32_bf16 v[44:47],a[232:235],a[136:139],v[44:47]
ds_read_b64_tr_b16 a[242:243],v3 offset:30720
ds_read_b64_tr_b16 a[240:241],v3 offset:24576
v_mfma_f32_16x16x32_bf16 v[44:47],a[236:239],a[140:143],v[44:47]
v_mfma_f32_16x16x32_bf16 v[52:55],a[216:219],a[144:147],0
ds_read_b64_tr_b16 a[246:247],v4 offset:30720
ds_read_b64_tr_b16 a[244:245],v4 offset:24576
v_mfma_f32_16x16x32_bf16 v[52:55],a[220:223],a[148:151],v[52:55]
v_mfma_f32_16x16x32_bf16 v[52:55],a[224:227],a[152:155],v[52:55]
ds_read_b64_tr_b16 a[248:249],v5 offset:24576
ds_read_b64_tr_b16 a[250:251],v5 offset:30720
v_mfma_f32_16x16x32_bf16 v[52:55],a[228:231],a[156:159],v[52:55]
v_mfma_f32_16x16x32_bf16 v[52:55],a[232:235],a[160:163],v[52:55]
ds_read_b64_tr_b16 a[252:253],v6 offset:24576
ds_read_b64_tr_b16 a[254:255],v6 offset:30720
v_mfma_f32_16x16x32_bf16 v[52:55],a[236:239],a[164:167],v[52:55]
v_mfma_f32_16x16x32_bf16 v[60:63],a[216:219],a[168:171],0
v_mfma_f32_16x16x32_bf16 v[60:63],a[220:223],a[172:175],v[60:63]
v_mfma_f32_16x16x32_bf16 v[60:63],a[224:227],a[176:179],v[60:63]
v_mfma_f32_16x16x32_bf16 v[60:63],a[228:231],a[180:183],v[60:63]
v_mfma_f32_16x16x32_bf16 v[60:63],a[232:235],a[184:187],v[60:63]
v_mfma_f32_16x16x32_bf16 v[60:63],a[236:239],a[188:191],v[60:63]
s_waitcnt lgkmcnt(2)
v_mfma_f32_16x16x32_bf16 v[160:163],a[240:243],v[112:115],v[160:163]
s_add_u32 m0,s23,12288
ds_read_b128 a[192:195],v1 offset:12288
v_fma_f32 v36,v36,s36,v16
v_mfma_f32_16x16x32_bf16 v[208:211],a[240:243],v[116:119],v[208:211]
buffer_load_dwordx4 v7,s[8:11],s21 offen offset:0 lds
v_mfma_f32_16x16x32_bf16 a[0:3],a[240:243],v[120:123],a[0:3]
s_add_u32 m0,s23,13184
ds_read_b128 a[196:199],v2 offset:12288
v_fma_f32 v37,v37,s36,v16
v_mfma_f32_16x16x32_bf16 a[48:51],a[240:243],v[124:127],a[48:51]
ds_read_b64_tr_b16 a[240:241],v3 offset:25600
ds_read_b64_tr_b16 a[242:243],v3 offset:31744
v_mfma_f32_16x16x32_bf16 v[164:167],a[244:247],v[112:115],v[164:167]
ds_read_b128 a[200:203],v1 offset:13312
v_fma_f32 v38,v38,s36,v16
v_mfma_f32_16x16x32_bf16 v[212:215],a[244:247],v[116:119],v[212:215]
ds_read_b128 a[204:207],v2 offset:13312
v_fma_f32 v39,v39,s36,v16
v_mfma_f32_16x16x32_bf16 a[4:7],a[244:247],v[120:123],a[4:7]
ds_read_b128 a[208:211],v1 offset:14336
v_fma_f32 v44,v44,s36,v17
v_mfma_f32_16x16x32_bf16 a[52:55],a[244:247],v[124:127],a[52:55]
ds_read_b64_tr_b16 a[244:245],v4 offset:25600
ds_read_b64_tr_b16 a[246:247],v4 offset:31744
v_mfma_f32_16x16x32_bf16 v[168:171],a[248:251],v[112:115],v[168:171]
ds_read_b128 a[212:215],v2 offset:14336
v_fma_f32 v45,v45,s36,v17
v_mfma_f32_16x16x32_bf16 v[216:219],a[248:251],v[116:119],v[216:219]
buffer_load_dwordx4 v7,s[8:11],s21 offen offset:128 lds
v_mfma_f32_16x16x32_bf16 a[8:11],a[248:251],v[120:123],a[8:11]
s_add_u32 m0,s23,14080
ds_read_b128 a[216:219],v1 offset:18432
v_fma_f32 v46,v46,s36,v17
v_mfma_f32_16x16x32_bf16 a[56:59],a[248:251],v[124:127],a[56:59]
s_waitcnt lgkmcnt(8)
ds_read_b64_tr_b16 a[248:249],v5 offset:25600
ds_read_b64_tr_b16 a[250:251],v5 offset:31744
v_mfma_f32_16x16x32_bf16 v[172:175],a[252:255],v[112:115],v[172:175]
ds_read_b128 a[220:223],v2 offset:18432
v_fma_f32 v47,v47,s36,v17
v_mfma_f32_16x16x32_bf16 v[220:223],a[252:255],v[116:119],v[220:223]
ds_read_b128 a[224:227],v1 offset:19456
v_fma_f32 v48,v48,s36,v18
v_mfma_f32_16x16x32_bf16 a[12:15],a[252:255],v[120:123],a[12:15]
ds_read_b128 a[228:231],v2 offset:19456
v_fma_f32 v49,v49,s36,v18
v_mfma_f32_16x16x32_bf16 a[60:63],a[252:255],v[124:127],a[60:63]
s_waitcnt lgkmcnt(7)
ds_read_b64_tr_b16 a[252:253],v6 offset:25600
ds_read_b64_tr_b16 a[254:255],v6 offset:31744
v_mfma_f32_16x16x32_bf16 v[176:179],a[240:243],v[112:115],v[176:179]
ds_read_b128 a[232:235],v1 offset:20480
v_fma_f32 v50,v50,s36,v18
v_mfma_f32_16x16x32_bf16 v[224:227],a[240:243],v[116:119],v[224:227]
buffer_load_dwordx4 v7,s[8:11],s21 offen offset:256 lds
v_mfma_f32_16x16x32_bf16 a[16:19],a[240:243],v[120:123],a[16:19]
s_add_u32 s21,s21,12288
ds_read_b128 a[236:239],v2 offset:20480
v_fma_f32 v51,v51,s36,v18
v_mfma_f32_16x16x32_bf16 a[64:67],a[240:243],v[124:127],a[64:67]
s_add_u32 m0,s22,0
ds_read_b64_tr_b16 a[240:241],v3 offset:26624
ds_read_b64_tr_b16 a[242:243],v3 offset:32768
v_mfma_f32_16x16x32_bf16 v[180:183],a[244:247],v[112:115],v[180:183]
v_fma_f32 v52,v52,s36,v18
v_fma_f32 v53,v53,s36,v18
v_mfma_f32_16x16x32_bf16 v[228:231],a[244:247],v[116:119],v[228:231]
v_fma_f32 v54,v54,s36,v18
v_fma_f32 v55,v55,s36,v18
v_mfma_f32_16x16x32_bf16 a[20:23],a[244:247],v[120:123],a[20:23]
v_fma_f32 v56,v56,s36,v19
v_fma_f32 v57,v57,s36,v19
v_mfma_f32_16x16x32_bf16 a[68:71],a[244:247],v[124:127],a[68:71]
s_waitcnt lgkmcnt(4)
ds_read_b64_tr_b16 a[244:245],v4 offset:26624
ds_read_b64_tr_b16 a[246:247],v4 offset:32768
v_mfma_f32_16x16x32_bf16 v[184:187],a[248:251],v[112:115],v[184:187]
buffer_load_dwordx4 v7,s[4:7],s20 offen offset:0 lds
v_mfma_f32_16x16x32_bf16 v[232:235],a[248:251],v[116:119],v[232:235]
s_add_u32 m0,s22,896
v_fma_f32 v58,v58,s36,v19
v_fma_f32 v59,v59,s36,v19
v_mfma_f32_16x16x32_bf16 a[24:27],a[248:251],v[120:123],a[24:27]
v_fma_f32 v60,v60,s36,v19
v_fma_f32 v61,v61,s36,v19
v_mfma_f32_16x16x32_bf16 a[72:75],a[248:251],v[124:127],a[72:75]
ds_read_b64_tr_b16 a[248:249],v5 offset:26624
ds_read_b64_tr_b16 a[250:251],v5 offset:32768
v_mfma_f32_16x16x32_bf16 v[188:191],a[252:255],v[112:115],v[188:191]
v_fma_f32 v62,v62,s36,v19
v_fma_f32 v63,v63,s36,v19
v_mfma_f32_16x16x32_bf16 v[236:239],a[252:255],v[116:119],v[236:239]
v_exp_f32 v36,v36
v_mfma_f32_16x16x32_bf16 a[28:31],a[252:255],v[120:123],a[28:31]
v_exp_f32 v37,v37
v_mfma_f32_16x16x32_bf16 a[76:79],a[252:255],v[124:127],a[76:79]
s_waitcnt lgkmcnt(2)
ds_read_b64_tr_b16 a[252:253],v6 offset:26624
ds_read_b64_tr_b16 a[254:255],v6 offset:32768
v_mfma_f32_16x16x32_bf16 v[192:195],a[240:243],v[112:115],v[192:195]
buffer_load_dwordx4 v7,s[4:7],s20 offen offset:128 lds
v_mfma_f32_16x16x32_bf16 v[240:243],a[240:243],v[116:119],v[240:243]
s_add_u32 m0,s22,1792
v_exp_f32 v38,v38
v_mfma_f32_16x16x32_bf16 a[32:35],a[240:243],v[120:123],a[32:35]
v_exp_f32 v39,v39
v_mfma_f32_16x16x32_bf16 a[80:83],a[240:243],v[124:127],a[80:83]
v_exp_f32 v44,v44
v_mfma_f32_16x16x32_bf16 v[196:199],a[244:247],v[112:115],v[196:199]
v_exp_f32 v45,v45
v_mfma_f32_16x16x32_bf16 v[244:247],a[244:247],v[116:119],v[244:247]
ds_read_b128 v[152:155],v11 offset:5120
v_cvt_pk_bf16_f32 v98,v36,v37
v_mfma_f32_16x16x32_bf16 a[36:39],a[244:247],v[120:123],a[36:39]
v_exp_f32 v46,v46
v_mfma_f32_16x16x32_bf16 a[84:87],a[244:247],v[124:127],a[84:87]
s_waitcnt lgkmcnt(1)
v_exp_f32 v47,v47
v_mfma_f32_16x16x32_bf16 v[200:203],a[248:251],v[112:115],v[200:203]
buffer_load_dwordx4 v7,s[4:7],s20 offen offset:256 lds
v_mfma_f32_16x16x32_bf16 v[248:251],a[248:251],v[116:119],v[248:251]
s_add_u32 s20,s20,12288
v_exp_f32 v48,v48
v_mfma_f32_16x16x32_bf16 a[40:43],a[248:251],v[120:123],a[40:43]
v_exp_f32 v49,v49
v_mfma_f32_16x16x32_bf16 a[88:91],a[248:251],v[124:127],a[88:91]
v_exp_f32 v50,v50
v_mfma_f32_16x16x32_bf16 v[204:207],a[252:255],v[112:115],v[204:207]
v_exp_f32 v51,v51
v_mfma_f32_16x16x32_bf16 v[252:255],a[252:255],v[116:119],v[252:255]
v_exp_f32 v52,v52
v_mfma_f32_16x16x32_bf16 a[44:47],a[252:255],v[120:123],a[44:47]
v_exp_f32 v53,v53
v_mfma_f32_16x16x32_bf16 a[92:95],a[252:255],v[124:127],a[92:95]
v_exp_f32 v54,v54
v_mfma_f32_16x16x32_bf16 v[64:67],a[192:195],a[96:99],0
v_exp_f32 v55,v55
v_mfma_f32_16x16x32_bf16 v[64:67],a[196:199],a[100:103],v[64:67]
v_exp_f32 v56,v56
v_mfma_f32_16x16x32_bf16 v[64:67],a[200:203],a[104:107],v[64:67]
v_exp_f32 v57,v57
v_mfma_f32_16x16x32_bf16 v[64:67],a[204:207],a[108:111],v[64:67]
v_exp_f32 v58,v58
v_mfma_f32_16x16x32_bf16 v[64:67],a[208:211],a[112:115],v[64:67]
v_exp_f32 v59,v59
v_mfma_f32_16x16x32_bf16 v[64:67],a[212:215],a[116:119],v[64:67]
s_waitcnt lgkmcnt(0)
buffer_store_dwordx4 v[152:155],v10,s[16:19],s27 offen offset:256 nt
v_mfma_f32_16x16x32_bf16 v[72:75],a[192:195],a[120:123],0
s_add_u32 m0,s29,1792
v_exp_f32 v60,v60
v_mfma_f32_16x16x32_bf16 v[72:75],a[196:199],a[124:127],v[72:75]
v_exp_f32 v61,v61
v_mfma_f32_16x16x32_bf16 v[72:75],a[200:203],a[128:131],v[72:75]
v_exp_f32 v62,v62
v_mfma_f32_16x16x32_bf16 v[72:75],a[204:207],a[132:135],v[72:75]
v_exp_f32 v63,v63
v_mfma_f32_16x16x32_bf16 v[72:75],a[208:211],a[136:139],v[72:75]
v_cvt_pk_bf16_f32 v99,v38,v39
v_cvt_pk_bf16_f32 v102,v44,v45
v_mfma_f32_16x16x32_bf16 v[72:75],a[212:215],a[140:143],v[72:75]
v_cvt_pk_bf16_f32 v103,v46,v47
v_cvt_pk_bf16_f32 v104,v48,v49
v_mfma_f32_16x16x32_bf16 v[128:131],v[24:27],v[96:99],v[128:131]
v_cvt_pk_bf16_f32 v105,v50,v51
v_cvt_pk_bf16_f32 v106,v52,v53
v_mfma_f32_16x16x32_bf16 v[132:135],v[24:27],v[100:103],v[132:135]
v_cvt_pk_bf16_f32 v107,v54,v55
v_cvt_pk_bf16_f32 v108,v56,v57
v_mfma_f32_16x16x32_bf16 v[80:83],a[192:195],a[144:147],0
v_cvt_pk_bf16_f32 v109,v58,v59
v_cvt_pk_bf16_f32 v110,v60,v61
v_mfma_f32_16x16x32_bf16 v[136:139],v[24:27],v[104:107],v[136:139]
v_cvt_pk_bf16_f32 v111,v62,v63
v_fma_f32 v64,v64,s36,v16
v_mfma_f32_16x16x32_bf16 v[80:83],a[196:199],a[148:151],v[80:83]
v_fma_f32 v65,v65,s36,v16
v_fma_f32 v66,v66,s36,v16
v_mfma_f32_16x16x32_bf16 v[140:143],v[24:27],v[108:111],v[140:143]
v_fma_f32 v67,v67,s36,v16
v_fma_f32 v72,v72,s36,v17
v_mfma_f32_16x16x32_bf16 v[80:83],a[200:203],a[152:155],v[80:83]
v_fma_f32 v73,v73,s36,v17
v_fma_f32 v74,v74,s36,v17
v_mfma_f32_16x16x32_bf16 v[80:83],a[204:207],a[156:159],v[80:83]
v_fma_f32 v75,v75,s36,v17
v_mfma_f32_16x16x32_bf16 v[80:83],a[208:211],a[160:163],v[80:83]
v_exp_f32 v64,v64
v_mfma_f32_16x16x32_bf16 v[80:83],a[212:215],a[164:167],v[80:83]
v_exp_f32 v65,v65
v_mfma_f32_16x16x32_bf16 v[88:91],a[192:195],a[168:171],0
buffer_load_dwordx4 v9,s[12:15],s28 offen offset:256 nt lds
v_mfma_f32_16x16x32_bf16 v[88:91],a[196:199],a[172:175],v[88:91]
s_add_u32 s27,s27,3072
v_exp_f32 v66,v66
v_mfma_f32_16x16x32_bf16 v[88:91],a[200:203],a[176:179],v[88:91]
s_add_u32 s28,s28,3072
v_exp_f32 v67,v67
v_mfma_f32_16x16x32_bf16 v[88:91],a[204:207],a[180:183],v[88:91]
s_add_u32 s29,s29,3072
v_exp_f32 v72,v72
v_mfma_f32_16x16x32_bf16 v[88:91],a[208:211],a[184:187],v[88:91]
v_exp_f32 v73,v73
v_mfma_f32_16x16x32_bf16 v[88:91],a[212:215],a[188:191],v[88:91]
v_exp_f32 v74,v74
v_mfma_f32_16x16x32_bf16 v[68:71],a[216:219],a[96:99],0
v_exp_f32 v75,v75
v_mfma_f32_16x16x32_bf16 v[68:71],a[220:223],a[100:103],v[68:71]
v_cvt_pk_bf16_f32 v112,v64,v65
v_cvt_pk_bf16_f32 v113,v66,v67
v_mfma_f32_16x16x32_bf16 v[68:71],a[224:227],a[104:107],v[68:71]
v_cvt_pk_bf16_f32 v116,v72,v73
v_cvt_pk_bf16_f32 v117,v74,v75
v_mfma_f32_16x16x32_bf16 v[68:71],a[228:231],a[108:111],v[68:71]
v_mfma_f32_16x16x32_bf16 v[68:71],a[232:235],a[112:115],v[68:71]
s_waitcnt vmcnt(12)
s_barrier
v_mfma_f32_16x16x32_bf16 v[68:71],a[236:239],a[116:119],v[68:71]
v_mfma_f32_16x16x32_bf16 v[76:79],a[216:219],a[120:123],0
v_mfma_f32_16x16x32_bf16 v[76:79],a[220:223],a[124:127],v[76:79]
v_mfma_f32_16x16x32_bf16 v[76:79],a[224:227],a[128:131],v[76:79]
v_mfma_f32_16x16x32_bf16 v[76:79],a[228:231],a[132:135],v[76:79]
v_mfma_f32_16x16x32_bf16 v[76:79],a[232:235],a[136:139],v[76:79]
v_mfma_f32_16x16x32_bf16 v[76:79],a[236:239],a[140:143],v[76:79]
ds_read_b64_tr_b16 a[240:241],v3 offset:0
ds_read_b64_tr_b16 a[242:243],v3 offset:6144
v_mfma_f32_16x16x32_bf16 v[84:87],a[216:219],a[144:147],0
v_mfma_f32_16x16x32_bf16 v[84:87],a[220:223],a[148:151],v[84:87]
ds_read_b64_tr_b16 a[244:245],v4 offset:0
ds_read_b64_tr_b16 a[246:247],v4 offset:6144
v_mfma_f32_16x16x32_bf16 v[84:87],a[224:227],a[152:155],v[84:87]
v_mfma_f32_16x16x32_bf16 v[84:87],a[228:231],a[156:159],v[84:87]
ds_read_b64_tr_b16 a[248:249],v5 offset:0
ds_read_b64_tr_b16 a[250:251],v5 offset:6144
v_mfma_f32_16x16x32_bf16 v[84:87],a[232:235],a[160:163],v[84:87]
v_mfma_f32_16x16x32_bf16 v[84:87],a[236:239],a[164:167],v[84:87]
ds_read_b64_tr_b16 a[252:253],v6 offset:0
ds_read_b64_tr_b16 a[254:255],v6 offset:6144
v_mfma_f32_16x16x32_bf16 v[92:95],a[216:219],a[168:171],0
v_mfma_f32_16x16x32_bf16 v[92:95],a[220:223],a[172:175],v[92:95]
v_mfma_f32_16x16x32_bf16 v[92:95],a[224:227],a[176:179],v[92:95]
v_mfma_f32_16x16x32_bf16 v[92:95],a[228:231],a[180:183],v[92:95]
v_mfma_f32_16x16x32_bf16 v[92:95],a[232:235],a[184:187],v[92:95]
v_mfma_f32_16x16x32_bf16 v[92:95],a[236:239],a[188:191],v[92:95]
s_waitcnt lgkmcnt(4)
v_mfma_f32_16x16x32_bf16 v[160:163],a[240:243],v[96:99],v[160:163]
s_add_u32 m0,s23,24576
ds_read_b128 a[192:195],v1 offset:24576
v_fma_f32 v78,v78,s36,v17
v_mfma_f32_16x16x32_bf16 v[208:211],a[240:243],v[100:103],v[208:211]
buffer_load_dwordx4 v7,s[8:11],s21 offen offset:0 lds
v_mfma_f32_16x16x32_bf16 a[0:3],a[240:243],v[104:107],a[0:3]
s_add_u32 m0,s23,25472
ds_read_b128 a[196:199],v2 offset:24576
v_fma_f32 v86,v86,s36,v18
v_mfma_f32_16x16x32_bf16 a[48:51],a[240:243],v[108:111],a[48:51]
ds_read_b64_tr_b16 a[240:241],v3 offset:1024
ds_read_b64_tr_b16 a[242:243],v3 offset:7168
v_mfma_f32_16x16x32_bf16 v[164:167],a[244:247],v[96:99],v[164:167]
ds_read_b128 a[200:203],v1 offset:25600
v_fma_f32 v85,v85,s36,v18
v_mfma_f32_16x16x32_bf16 v[212:215],a[244:247],v[100:103],v[212:215]
ds_read_b128 a[204:207],v2 offset:25600
v_fma_f32 v90,v90,s36,v19
v_mfma_f32_16x16x32_bf16 a[4:7],a[244:247],v[104:107],a[4:7]
ds_read_b128 a[208:211],v1 offset:26624
v_fma_f32 v88,v88,s36,v19
v_mfma_f32_16x16x32_bf16 a[52:55],a[244:247],v[108:111],a[52:55]
s_waitcnt lgkmcnt(7)
ds_read_b64_tr_b16 a[244:245],v4 offset:1024
ds_read_b64_tr_b16 a[246:247],v4 offset:7168
v_mfma_f32_16x16x32_bf16 v[168:171],a[248:251],v[96:99],v[168:171]
ds_read_b128 a[212:215],v2 offset:26624
v_fma_f32 v77,v77,s36,v17
v_mfma_f32_16x16x32_bf16 v[216:219],a[248:251],v[100:103],v[216:219]
buffer_load_dwordx4 v7,s[8:11],s21 offen offset:128 lds
v_mfma_f32_16x16x32_bf16 a[8:11],a[248:251],v[104:107],a[8:11]
s_add_u32 m0,s23,26368
ds_read_b128 a[216:219],v1 offset:30720
v_fma_f32 v83,v83,s36,v18
v_mfma_f32_16x16x32_bf16 a[56:59],a[248:251],v[108:111],a[56:59]
ds_read_b64_tr_b16 a[248:249],v5 offset:1024
ds_read_b64_tr_b16 a[250:251],v5 offset:7168
v_mfma_f32_16x16x32_bf16 v[172:175],a[252:255],v[96:99],v[172:175]
ds_read_b128 a[220:223],v2 offset:30720
v_fma_f32 v70,v70,s36,v16
v_mfma_f32_16x16x32_bf16 v[220:223],a[252:255],v[100:103],v[220:223]
ds_read_b128 a[224:227],v1 offset:31744
v_fma_f32 v76,v76,s36,v17
v_mfma_f32_16x16x32_bf16 a[12:15],a[252:255],v[104:107],a[12:15]
ds_read_b128 a[232:235],v1 offset:32768
v_fma_f32 v82,v82,s36,v18
v_mfma_f32_16x16x32_bf16 a[60:63],a[252:255],v[108:111],a[60:63]
s_waitcnt lgkmcnt(7)
ds_read_b64_tr_b16 a[254:255],v6 offset:7168
ds_read_b64_tr_b16 a[252:253],v6 offset:1024
v_mfma_f32_16x16x32_bf16 v[176:179],a[240:243],v[96:99],v[176:179]
ds_read_b128 a[228:231],v2 offset:31744
v_fma_f32 v89,v89,s36,v19
v_mfma_f32_16x16x32_bf16 v[224:227],a[240:243],v[100:103],v[224:227]
buffer_load_dwordx4 v7,s[8:11],s21 offen offset:256 lds
v_mfma_f32_16x16x32_bf16 a[16:19],a[240:243],v[104:107],a[16:19]
s_add_u32 s21,s21,12288
ds_read_b128 a[236:239],v2 offset:32768
v_fma_f32 v94,v94,s36,v19
v_mfma_f32_16x16x32_bf16 a[64:67],a[240:243],v[108:111],a[64:67]
s_add_u32 m0,s25,0
ds_read_b64_tr_b16 a[240:241],v3 offset:2048
ds_read_b64_tr_b16 a[242:243],v3 offset:8192
v_mfma_f32_16x16x32_bf16 v[180:183],a[244:247],v[96:99],v[180:183]
v_exp_f32 v76,v76
v_mfma_f32_16x16x32_bf16 v[228:231],a[244:247],v[100:103],v[228:231]
v_exp_f32 v70,v70
v_mfma_f32_16x16x32_bf16 a[20:23],a[244:247],v[104:107],a[20:23]
v_exp_f32 v83,v83
v_mfma_f32_16x16x32_bf16 a[68:71],a[244:247],v[108:111],a[68:71]
s_waitcnt lgkmcnt(4)
ds_read_b64_tr_b16 a[246:247],v4 offset:8192
ds_read_b64_tr_b16 a[244:245],v4 offset:2048
v_mfma_f32_16x16x32_bf16 v[184:187],a[248:251],v[96:99],v[184:187]
buffer_load_dwordx4 v7,s[4:7],s20 offen offset:0 lds
v_mfma_f32_16x16x32_bf16 v[232:235],a[248:251],v[100:103],v[232:235]
s_add_u32 m0,s25,896
v_exp_f32 v90,v90
v_mfma_f32_16x16x32_bf16 a[24:27],a[248:251],v[104:107],a[24:27]
v_exp_f32 v94,v94
v_mfma_f32_16x16x32_bf16 a[72:75],a[248:251],v[108:111],a[72:75]
ds_read_b64_tr_b16 a[250:251],v5 offset:8192
ds_read_b64_tr_b16 a[248:249],v5 offset:2048
v_mfma_f32_16x16x32_bf16 v[188:191],a[252:255],v[96:99],v[188:191]
v_exp_f32 v89,v89
v_mfma_f32_16x16x32_bf16 v[236:239],a[252:255],v[100:103],v[236:239]
v_exp_f32 v85,v85
v_mfma_f32_16x16x32_bf16 a[28:31],a[252:255],v[104:107],a[28:31]
v_exp_f32 v88,v88
v_mfma_f32_16x16x32_bf16 a[76:79],a[252:255],v[108:111],a[76:79]
s_waitcnt lgkmcnt(2)
ds_read_b64_tr_b16 a[252:253],v6 offset:2048
ds_read_b64_tr_b16 a[254:255],v6 offset:8192
v_mfma_f32_16x16x32_bf16 v[192:195],a[240:243],v[96:99],v[192:195]
buffer_load_dwordx4 v7,s[4:7],s20 offen offset:128 lds
v_mfma_f32_16x16x32_bf16 v[240:243],a[240:243],v[100:103],v[240:243]
s_add_u32 m0,s25,1792
v_exp_f32 v78,v78
v_mfma_f32_16x16x32_bf16 a[32:35],a[240:243],v[104:107],a[32:35]
v_exp_f32 v86,v86
v_mfma_f32_16x16x32_bf16 a[80:83],a[240:243],v[108:111],a[80:83]
v_exp_f32 v77,v77
v_mfma_f32_16x16x32_bf16 v[196:199],a[244:247],v[96:99],v[196:199]
v_exp_f32 v82,v82
v_mfma_f32_16x16x32_bf16 v[244:247],a[244:247],v[100:103],v[244:247]
ds_read_b128 v[156:159],v11 offset:6144
v_fma_f32 v81,v81,s36,v18
v_mfma_f32_16x16x32_bf16 a[36:39],a[244:247],v[104:107],a[36:39]
v_exp_f32 v81,v81
v_mfma_f32_16x16x32_bf16 a[84:87],a[244:247],v[108:111],a[84:87]
s_waitcnt lgkmcnt(1)
v_fma_f32 v92,v92,s36,v19
v_fma_f32 v79,v79,s36,v17
v_mfma_f32_16x16x32_bf16 v[200:203],a[248:251],v[96:99],v[200:203]
buffer_load_dwordx4 v7,s[4:7],s20 offen offset:256 lds
v_mfma_f32_16x16x32_bf16 v[248:251],a[248:251],v[100:103],v[248:251]
s_add_u32 s20,s20,12288
v_exp_f32 v92,v92
v_mfma_f32_16x16x32_bf16 a[40:43],a[248:251],v[104:107],a[40:43]
v_exp_f32 v79,v79
v_mfma_f32_16x16x32_bf16 a[88:91],a[248:251],v[108:111],a[88:91]
v_fma_f32 v71,v71,s36,v16
v_fma_f32 v69,v69,s36,v16
v_mfma_f32_16x16x32_bf16 v[204:207],a[252:255],v[96:99],v[204:207]
v_exp_f32 v69,v69
v_mfma_f32_16x16x32_bf16 v[252:255],a[252:255],v[100:103],v[252:255]
v_exp_f32 v71,v71
v_mfma_f32_16x16x32_bf16 a[44:47],a[252:255],v[104:107],a[44:47]
v_fma_f32 v87,v87,s36,v18
v_fma_f32 v95,v95,s36,v19
v_mfma_f32_16x16x32_bf16 a[92:95],a[252:255],v[108:111],a[92:95]
v_exp_f32 v87,v87
v_mfma_f32_16x16x32_bf16 v[32:35],a[192:195],a[96:99],0
v_exp_f32 v95,v95
v_mfma_f32_16x16x32_bf16 v[32:35],a[196:199],a[100:103],v[32:35]
v_cvt_pk_bf16_f32 v123,v86,v87
v_fma_f32 v80,v80,s36,v18
v_mfma_f32_16x16x32_bf16 v[32:35],a[200:203],a[104:107],v[32:35]
v_exp_f32 v80,v80
v_mfma_f32_16x16x32_bf16 v[32:35],a[204:207],a[108:111],v[32:35]
v_cvt_pk_bf16_f32 v120,v80,v81
v_fma_f32 v84,v84,s36,v18
v_mfma_f32_16x16x32_bf16 v[32:35],a[208:211],a[112:115],v[32:35]
v_exp_f32 v84,v84
v_mfma_f32_16x16x32_bf16 v[32:35],a[212:215],a[116:119],v[32:35]
s_waitcnt lgkmcnt(0)
buffer_store_dwordx4 v[156:159],v10,s[16:19],s27 offen offset:0 nt
v_mfma_f32_16x16x32_bf16 v[40:43],a[192:195],a[120:123],0
s_add_u32 m0,s29,0
v_fma_f32 v68,v68,s36,v16
v_fma_f32 v93,v93,s36,v19
v_mfma_f32_16x16x32_bf16 v[40:43],a[196:199],a[124:127],v[40:43]
v_exp_f32 v68,v68
v_mfma_f32_16x16x32_bf16 v[40:43],a[200:203],a[128:131],v[40:43]
ds_read_b128 v[152:155],v11 offset:7168
v_fma_f32 v91,v91,s36,v19
v_mfma_f32_16x16x32_bf16 v[40:43],a[204:207],a[132:135],v[40:43]
v_exp_f32 v91,v91
v_mfma_f32_16x16x32_bf16 v[40:43],a[208:211],a[136:139],v[40:43]
v_exp_f32 v93,v93
v_mfma_f32_16x16x32_bf16 v[40:43],a[212:215],a[140:143],v[40:43]
v_cvt_pk_bf16_f32 v125,v90,v91
v_cvt_pk_bf16_f32 v127,v94,v95
v_mfma_f32_16x16x32_bf16 v[48:51],a[192:195],a[144:147],0
v_cvt_pk_bf16_f32 v121,v82,v83
v_cvt_pk_bf16_f32 v122,v84,v85
v_mfma_f32_16x16x32_bf16 v[48:51],a[196:199],a[148:151],v[48:51]
buffer_load_dwordx4 v8,s[12:15],s28 offen offset:0 nt lds
v_mfma_f32_16x16x32_bf16 v[136:139],v[24:27],v[120:123],v[136:139]
v_fma_f32 v43,v43,s36,v17
v_fma_f32 v34,v34,s36,v16
v_mfma_f32_16x16x32_bf16 v[48:51],a[200:203],a[152:155],v[48:51]
v_exp_f32 v43,v43
v_mfma_f32_16x16x32_bf16 v[48:51],a[204:207],a[156:159],v[48:51]
v_exp_f32 v34,v34
v_mfma_f32_16x16x32_bf16 v[48:51],a[208:211],a[160:163],v[48:51]
v_cvt_pk_bf16_f32 v115,v70,v71
v_cvt_pk_bf16_f32 v126,v92,v93
v_mfma_f32_16x16x32_bf16 v[48:51],a[212:215],a[164:167],v[48:51]
v_cvt_pk_bf16_f32 v118,v76,v77
v_fma_f32 v32,v32,s36,v16
v_mfma_f32_16x16x32_bf16 v[56:59],a[192:195],a[168:171],0
v_exp_f32 v32,v32
v_mfma_f32_16x16x32_bf16 v[56:59],a[196:199],a[172:175],v[56:59]
v_fma_f32 v35,v35,s36,v16
v_fma_f32 v42,v42,s36,v17
v_mfma_f32_16x16x32_bf16 v[56:59],a[200:203],a[176:179],v[56:59]
v_exp_f32 v42,v42
v_mfma_f32_16x16x32_bf16 v[56:59],a[204:207],a[180:183],v[56:59]
s_waitcnt lgkmcnt(0)
buffer_store_dwordx4 v[152:155],v10,s[16:19],s27 offen offset:128 nt
v_mfma_f32_16x16x32_bf16 v[56:59],a[208:211],a[184:187],v[56:59]
s_add_u32 m0,s29,896
v_exp_f32 v35,v35
v_mfma_f32_16x16x32_bf16 v[56:59],a[212:215],a[188:191],v[56:59]
v_cvt_pk_bf16_f32 v124,v88,v89
v_cvt_pk_bf16_f32 v114,v68,v69
v_mfma_f32_16x16x32_bf16 v[36:39],a[216:219],a[96:99],0
v_fma_f32 v33,v33,s36,v16
v_cvt_pk_bf16_f32 v119,v78,v79
v_mfma_f32_16x16x32_bf16 v[140:143],v[24:27],v[124:127],v[140:143]
v_exp_f32 v33,v33
v_mfma_f32_16x16x32_bf16 v[128:131],v[24:27],v[112:115],v[128:131]
v_fma_f32 v41,v41,s36,v17
v_cvt_pk_bf16_f32 v101,v42,v43
v_mfma_f32_16x16x32_bf16 v[132:135],v[24:27],v[116:119],v[132:135]
v_exp_f32 v41,v41
v_mfma_f32_16x16x32_bf16 v[36:39],a[220:223],a[100:103],v[36:39]
v_fma_f32 v40,v40,s36,v17
v_cvt_pk_bf16_f32 v96,v32,v33
v_mfma_f32_16x16x32_bf16 v[36:39],a[224:227],a[104:107],v[36:39]
buffer_load_dwordx4 v8,s[12:15],s28 offen offset:128 nt lds
v_mfma_f32_16x16x32_bf16 v[36:39],a[228:231],a[108:111],v[36:39]
v_exp_f32 v40,v40
s_waitcnt vmcnt(12)
s_barrier
v_mfma_f32_16x16x32_bf16 v[36:39],a[232:235],a[112:115],v[36:39]
v_cvt_pk_bf16_f32 v100,v40,v41
v_cvt_pk_bf16_f32 v97,v34,v35
v_mfma_f32_16x16x32_bf16 v[36:39],a[236:239],a[116:119],v[36:39]
v_mfma_f32_16x16x32_bf16 v[44:47],a[216:219],a[120:123],0
v_mfma_f32_16x16x32_bf16 v[44:47],a[220:223],a[124:127],v[44:47]
v_mfma_f32_16x16x32_bf16 v[44:47],a[224:227],a[128:131],v[44:47]
v_mfma_f32_16x16x32_bf16 v[44:47],a[228:231],a[132:135],v[44:47]
v_mfma_f32_16x16x32_bf16 v[44:47],a[232:235],a[136:139],v[44:47]
ds_read_b64_tr_b16 a[242:243],v3 offset:18432
ds_read_b64_tr_b16 a[240:241],v3 offset:12288
v_mfma_f32_16x16x32_bf16 v[44:47],a[236:239],a[140:143],v[44:47]
v_mfma_f32_16x16x32_bf16 v[52:55],a[216:219],a[144:147],0
ds_read_b64_tr_b16 a[246:247],v4 offset:18432
ds_read_b64_tr_b16 a[244:245],v4 offset:12288
v_mfma_f32_16x16x32_bf16 v[52:55],a[220:223],a[148:151],v[52:55]
v_mfma_f32_16x16x32_bf16 v[52:55],a[224:227],a[152:155],v[52:55]
ds_read_b64_tr_b16 a[248:249],v5 offset:12288
ds_read_b64_tr_b16 a[250:251],v5 offset:18432
v_mfma_f32_16x16x32_bf16 v[52:55],a[228:231],a[156:159],v[52:55]
v_mfma_f32_16x16x32_bf16 v[52:55],a[232:235],a[160:163],v[52:55]
ds_read_b64_tr_b16 a[252:253],v6 offset:12288
ds_read_b64_tr_b16 a[254:255],v6 offset:18432
v_mfma_f32_16x16x32_bf16 v[52:55],a[236:239],a[164:167],v[52:55]
v_mfma_f32_16x16x32_bf16 v[60:63],a[216:219],a[168:171],0
v_mfma_f32_16x16x32_bf16 v[60:63],a[220:223],a[172:175],v[60:63]
v_mfma_f32_16x16x32_bf16 v[60:63],a[224:227],a[176:179],v[60:63]
v_mfma_f32_16x16x32_bf16 v[60:63],a[228:231],a[180:183],v[60:63]
v_mfma_f32_16x16x32_bf16 v[60:63],a[232:235],a[184:187],v[60:63]
v_mfma_f32_16x16x32_bf16 v[60:63],a[236:239],a[188:191],v[60:63]
s_waitcnt lgkmcnt(2)
v_mfma_f32_16x16x32_bf16 v[160:163],a[240:243],v[112:115],v[160:163]
s_add_u32 m0,s23,0
ds_read_b128 a[192:195],v1 offset:0
v_fma_f32 v47,v47,s36,v17
v_mfma_f32_16x16x32_bf16 v[208:211],a[240:243],v[116:119],v[208:211]
buffer_load_dwordx4 v7,s[8:11],s21 offen offset:0 lds
v_mfma_f32_16x16x32_bf16 a[0:3],a[240:243],v[120:123],a[0:3]
s_add_u32 m0,s23,896
ds_read_b128 a[196:199],v2 offset:0
v_fma_f32 v36,v36,s36,v16
v_mfma_f32_16x16x32_bf16 a[48:51],a[240:243],v[124:127],a[48:51]
ds_read_b64_tr_b16 a[240:241],v3 offset:13312
ds_read_b64_tr_b16 a[242:243],v3 offset:19456
v_mfma_f32_16x16x32_bf16 v[164:167],a[244:247],v[112:115],v[164:167]
ds_read_b128 a[200:203],v1 offset:1024
v_fma_f32 v55,v55,s36,v18
v_mfma_f32_16x16x32_bf16 v[212:215],a[244:247],v[116:119],v[212:215]
ds_read_b128 a[208:211],v1 offset:2048
v_fma_f32 v50,v50,s36,v18
v_mfma_f32_16x16x32_bf16 a[4:7],a[244:247],v[120:123],a[4:7]
ds_read_b128 a[204:207],v2 offset:1024
v_fma_f32 v59,v59,s36,v19
v_mfma_f32_16x16x32_bf16 a[52:55],a[244:247],v[124:127],a[52:55]
ds_read_b64_tr_b16 a[244:245],v4 offset:13312
ds_read_b64_tr_b16 a[246:247],v4 offset:19456
v_mfma_f32_16x16x32_bf16 v[168:171],a[248:251],v[112:115],v[168:171]
ds_read_b128 a[212:215],v2 offset:2048
v_fma_f32 v57,v57,s36,v19
v_mfma_f32_16x16x32_bf16 v[216:219],a[248:251],v[116:119],v[216:219]
buffer_load_dwordx4 v7,s[8:11],s21 offen offset:128 lds
v_mfma_f32_16x16x32_bf16 a[8:11],a[248:251],v[120:123],a[8:11]
s_add_u32 m0,s23,1792
ds_read_b128 a[216:219],v1 offset:6144
v_fma_f32 v56,v56,s36,v19
v_mfma_f32_16x16x32_bf16 a[56:59],a[248:251],v[124:127],a[56:59]
s_waitcnt lgkmcnt(8)
ds_read_b64_tr_b16 a[250:251],v5 offset:19456
ds_read_b64_tr_b16 a[248:249],v5 offset:13312
v_mfma_f32_16x16x32_bf16 v[172:175],a[252:255],v[112:115],v[172:175]
ds_read_b128 a[220:223],v2 offset:6144
v_fma_f32 v60,v60,s36,v19
v_mfma_f32_16x16x32_bf16 v[220:223],a[252:255],v[116:119],v[220:223]
ds_read_b128 a[224:227],v1 offset:7168
v_fma_f32 v39,v39,s36,v16
v_mfma_f32_16x16x32_bf16 a[12:15],a[252:255],v[120:123],a[12:15]
ds_read_b128 a[228:231],v2 offset:7168
v_fma_f32 v45,v45,s36,v17
v_mfma_f32_16x16x32_bf16 a[60:63],a[252:255],v[124:127],a[60:63]
s_waitcnt lgkmcnt(7)
ds_read_b64_tr_b16 a[254:255],v6 offset:19456
ds_read_b64_tr_b16 a[252:253],v6 offset:13312
v_mfma_f32_16x16x32_bf16 v[176:179],a[240:243],v[112:115],v[176:179]
ds_read_b128 a[232:235],v1 offset:8192
v_fma_f32 v52,v52,s36,v18
v_mfma_f32_16x16x32_bf16 v[224:227],a[240:243],v[116:119],v[224:227]
buffer_load_dwordx4 v7,s[8:11],s21 offen offset:256 lds
v_mfma_f32_16x16x32_bf16 a[16:19],a[240:243],v[120:123],a[16:19]
s_add_u32 s21,s21,12288
ds_read_b128 a[236:239],v2 offset:8192
v_fma_f32 v54,v54,s36,v18
v_mfma_f32_16x16x32_bf16 a[64:67],a[240:243],v[124:127],a[64:67]
s_add_u32 m0,s26,0
ds_read_b64_tr_b16 a[242:243],v3 offset:20480
ds_read_b64_tr_b16 a[240:241],v3 offset:14336
v_mfma_f32_16x16x32_bf16 v[180:183],a[244:247],v[112:115],v[180:183]
v_exp_f32 v45,v45
v_mfma_f32_16x16x32_bf16 v[228:231],a[244:247],v[116:119],v[228:231]
v_exp_f32 v52,v52
v_mfma_f32_16x16x32_bf16 a[20:23],a[244:247],v[120:123],a[20:23]
v_exp_f32 v39,v39
v_mfma_f32_16x16x32_bf16 a[68:71],a[244:247],v[124:127],a[68:71]
s_waitcnt lgkmcnt(4)
ds_read_b64_tr_b16 a[244:245],v4 offset:14336
ds_read_b64_tr_b16 a[246:247],v4 offset:20480
v_mfma_f32_16x16x32_bf16 v[184:187],a[248:251],v[112:115],v[184:187]
buffer_load_dwordx4 v7,s[4:7],s20 offen offset:0 lds
v_mfma_f32_16x16x32_bf16 v[232:235],a[248:251],v[116:119],v[232:235]
s_add_u32 m0,s26,896
v_exp_f32 v50,v50
v_mfma_f32_16x16x32_bf16 a[24:27],a[248:251],v[120:123],a[24:27]
v_exp_f32 v59,v59
v_mfma_f32_16x16x32_bf16 a[72:75],a[248:251],v[124:127],a[72:75]
ds_read_b64_tr_b16 a[248:249],v5 offset:14336
ds_read_b64_tr_b16 a[250:251],v5 offset:20480
v_mfma_f32_16x16x32_bf16 v[188:191],a[252:255],v[112:115],v[188:191]
v_exp_f32 v56,v56
v_mfma_f32_16x16x32_bf16 v[236:239],a[252:255],v[116:119],v[236:239]
v_exp_f32 v36,v36
v_mfma_f32_16x16x32_bf16 a[28:31],a[252:255],v[120:123],a[28:31]
v_exp_f32 v57,v57
v_mfma_f32_16x16x32_bf16 a[76:79],a[252:255],v[124:127],a[76:79]
s_waitcnt lgkmcnt(2)
ds_read_b64_tr_b16 a[254:255],v6 offset:20480
ds_read_b64_tr_b16 a[252:253],v6 offset:14336
v_mfma_f32_16x16x32_bf16 v[192:195],a[240:243],v[112:115],v[192:195]
buffer_load_dwordx4 v7,s[4:7],s20 offen offset:128 lds
v_mfma_f32_16x16x32_bf16 v[240:243],a[240:243],v[116:119],v[240:243]
s_add_u32 m0,s26,1792
v_exp_f32 v54,v54
v_mfma_f32_16x16x32_bf16 a[32:35],a[240:243],v[120:123],a[32:35]
v_exp_f32 v47,v47
v_mfma_f32_16x16x32_bf16 a[80:83],a[240:243],v[124:127],a[80:83]
v_exp_f32 v55,v55
v_mfma_f32_16x16x32_bf16 v[196:199],a[244:247],v[112:115],v[196:199]
v_exp_f32 v60,v60
v_mfma_f32_16x16x32_bf16 v[244:247],a[244:247],v[116:119],v[244:247]
ds_read_b128 v[156:159],v11 offset:8192
v_fma_f32 v51,v51,s36,v18
v_mfma_f32_16x16x32_bf16 a[36:39],a[244:247],v[120:123],a[36:39]
v_exp_f32 v51,v51
v_mfma_f32_16x16x32_bf16 a[84:87],a[244:247],v[124:127],a[84:87]
s_waitcnt lgkmcnt(1)
v_fma_f32 v44,v44,s36,v17
v_fma_f32 v63,v63,s36,v19
v_mfma_f32_16x16x32_bf16 v[200:203],a[248:251],v[112:115],v[200:203]
buffer_load_dwordx4 v7,s[4:7],s20 offen offset:256 lds
v_mfma_f32_16x16x32_bf16 v[248:251],a[248:251],v[116:119],v[248:251]
s_add_u32 s20,s20,12288
v_exp_f32 v44,v44
v_mfma_f32_16x16x32_bf16 a[40:43],a[248:251],v[120:123],a[40:43]
v_exp_f32 v63,v63
v_mfma_f32_16x16x32_bf16 a[88:91],a[248:251],v[124:127],a[88:91]
v_fma_f32 v62,v62,s36,v19
v_fma_f32 v61,v61,s36,v19
v_mfma_f32_16x16x32_bf16 v[204:207],a[252:255],v[112:115],v[204:207]
v_exp_f32 v61,v61
v_mfma_f32_16x16x32_bf16 v[252:255],a[252:255],v[116:119],v[252:255]
v_exp_f32 v62,v62
v_mfma_f32_16x16x32_bf16 a[44:47],a[252:255],v[120:123],a[44:47]
v_fma_f32 v46,v46,s36,v17
v_cvt_pk_bf16_f32 v107,v54,v55
v_mfma_f32_16x16x32_bf16 a[92:95],a[252:255],v[124:127],a[92:95]
v_exp_f32 v46,v46
v_mfma_f32_16x16x32_bf16 v[64:67],a[192:195],a[96:99],0
v_cvt_pk_bf16_f32 v105,v50,v51
v_fma_f32 v58,v58,s36,v19
v_mfma_f32_16x16x32_bf16 v[64:67],a[196:199],a[100:103],v[64:67]
v_exp_f32 v58,v58
v_mfma_f32_16x16x32_bf16 v[64:67],a[200:203],a[104:107],v[64:67]
v_cvt_pk_bf16_f32 v109,v58,v59
v_fma_f32 v49,v49,s36,v18
v_mfma_f32_16x16x32_bf16 v[64:67],a[204:207],a[108:111],v[64:67]
v_exp_f32 v49,v49
v_mfma_f32_16x16x32_bf16 v[64:67],a[208:211],a[112:115],v[64:67]
v_fma_f32 v38,v38,s36,v16
v_fma_f32 v53,v53,s36,v18
v_mfma_f32_16x16x32_bf16 v[64:67],a[212:215],a[116:119],v[64:67]
s_waitcnt lgkmcnt(0)
buffer_store_dwordx4 v[156:159],v10,s[16:19],s27 offen offset:256 nt
v_mfma_f32_16x16x32_bf16 v[72:75],a[192:195],a[120:123],0
s_add_u32 m0,s29,1792
v_exp_f32 v53,v53
v_mfma_f32_16x16x32_bf16 v[72:75],a[196:199],a[124:127],v[72:75]
v_exp_f32 v38,v38
v_mfma_f32_16x16x32_bf16 v[72:75],a[200:203],a[128:131],v[72:75]
v_cvt_pk_bf16_f32 v103,v46,v47
v_fma_f32 v37,v37,s36,v16
v_mfma_f32_16x16x32_bf16 v[72:75],a[204:207],a[132:135],v[72:75]
v_exp_f32 v37,v37
v_mfma_f32_16x16x32_bf16 v[72:75],a[208:211],a[136:139],v[72:75]
v_cvt_pk_bf16_f32 v98,v36,v37
v_fma_f32 v48,v48,s36,v18
v_mfma_f32_16x16x32_bf16 v[72:75],a[212:215],a[140:143],v[72:75]
v_exp_f32 v48,v48
v_mfma_f32_16x16x32_bf16 v[80:83],a[192:195],a[144:147],0
v_cvt_pk_bf16_f32 v104,v48,v49
v_cvt_pk_bf16_f32 v108,v56,v57
v_mfma_f32_16x16x32_bf16 v[80:83],a[196:199],a[148:151],v[80:83]
v_fma_f32 v67,v67,s36,v16
v_cvt_pk_bf16_f32 v106,v52,v53
v_mfma_f32_16x16x32_bf16 v[80:83],a[200:203],a[152:155],v[80:83]
v_exp_f32 v67,v67
v_mfma_f32_16x16x32_bf16 v[136:139],v[24:27],v[104:107],v[136:139]
v_fma_f32 v66,v66,s36,v16
v_cvt_pk_bf16_f32 v99,v38,v39
v_mfma_f32_16x16x32_bf16 v[80:83],a[204:207],a[156:159],v[80:83]
v_exp_f32 v66,v66
v_mfma_f32_16x16x32_bf16 v[128:131],v[24:27],v[96:99],v[128:131]
v_cvt_pk_bf16_f32 v110,v60,v61
v_fma_f32 v65,v65,s36,v16
v_mfma_f32_16x16x32_bf16 v[80:83],a[208:211],a[160:163],v[80:83]
v_exp_f32 v65,v65
v_mfma_f32_16x16x32_bf16 v[80:83],a[212:215],a[164:167],v[80:83]
v_fma_f32 v75,v75,s36,v17
v_fma_f32 v64,v64,s36,v16
v_mfma_f32_16x16x32_bf16 v[88:91],a[192:195],a[168:171],0
v_exp_f32 v75,v75
v_mfma_f32_16x16x32_bf16 v[88:91],a[196:199],a[172:175],v[88:91]
v_exp_f32 v64,v64
v_mfma_f32_16x16x32_bf16 v[88:91],a[200:203],a[176:179],v[88:91]
buffer_load_dwordx4 v8,s[12:15],s28 offen offset:256 nt lds
v_mfma_f32_16x16x32_bf16 v[88:91],a[204:207],a[180:183],v[88:91]
s_add_u32 s27,s27,3072
v_cvt_pk_bf16_f32 v102,v44,v45
v_cvt_pk_bf16_f32 v111,v62,v63
v_mfma_f32_16x16x32_bf16 v[88:91],a[208:211],a[184:187],v[88:91]
s_add_u32 s28,s28,3072
v_fma_f32 v74,v74,s36,v17
v_add_u32 v11,9216,v11
v_mfma_f32_16x16x32_bf16 v[132:135],v[24:27],v[100:103],v[132:135]
s_add_u32 s29,s29,3072
s_add_u32 s25,s24,18432
s_add_u32 s26,s22,12288
s_add_u32 s38,s38,1
s_cmp_lt_u32 s38,2
v_mfma_f32_16x16x32_bf16 v[140:143],v[24:27],v[108:111],v[140:143]
v_exp_f32 v74,v74
v_mfma_f32_16x16x32_bf16 v[88:91],a[212:215],a[188:191],v[88:91]
v_xor_b32 v9,80,v9
v_fma_f32 v73,v73,s36,v17
v_mfma_f32_16x16x32_bf16 v[68:71],a[216:219],a[96:99],0
v_exp_f32 v73,v73
v_mfma_f32_16x16x32_bf16 v[68:71],a[220:223],a[100:103],v[68:71]
v_cvt_pk_bf16_f32 v113,v66,v67
v_cvt_pk_bf16_f32 v112,v64,v65
v_mfma_f32_16x16x32_bf16 v[68:71],a[224:227],a[104:107],v[68:71]
v_fma_f32 v72,v72,s36,v17
v_cvt_pk_bf16_f32 v117,v74,v75
v_mfma_f32_16x16x32_bf16 v[68:71],a[228:231],a[108:111],v[68:71]
v_exp_f32 v72,v72
s_waitcnt vmcnt(12)
s_barrier
v_mfma_f32_16x16x32_bf16 v[68:71],a[232:235],a[112:115],v[68:71]
v_cvt_pk_bf16_f32 v116,v72,v73
v_xor_b32 v8,80,v8
v_mfma_f32_16x16x32_bf16 v[68:71],a[236:239],a[116:119],v[68:71]
v_mfma_f32_16x16x32_bf16 v[76:79],a[216:219],a[120:123],0
v_mfma_f32_16x16x32_bf16 v[76:79],a[220:223],a[124:127],v[76:79]
v_mfma_f32_16x16x32_bf16 v[76:79],a[224:227],a[128:131],v[76:79]
v_mfma_f32_16x16x32_bf16 v[76:79],a[228:231],a[132:135],v[76:79]
v_mfma_f32_16x16x32_bf16 v[76:79],a[232:235],a[136:139],v[76:79]
ds_read_b64_tr_b16 a[240:241],v3 offset:24576
ds_read_b64_tr_b16 a[242:243],v3 offset:30720
v_mfma_f32_16x16x32_bf16 v[76:79],a[236:239],a[140:143],v[76:79]
v_mfma_f32_16x16x32_bf16 v[84:87],a[216:219],a[144:147],0
ds_read_b64_tr_b16 a[246:247],v4 offset:30720
ds_read_b64_tr_b16 a[244:245],v4 offset:24576
v_mfma_f32_16x16x32_bf16 v[84:87],a[220:223],a[148:151],v[84:87]
v_mfma_f32_16x16x32_bf16 v[84:87],a[224:227],a[152:155],v[84:87]
ds_read_b64_tr_b16 a[248:249],v5 offset:24576
ds_read_b64_tr_b16 a[250:251],v5 offset:30720
v_mfma_f32_16x16x32_bf16 v[84:87],a[228:231],a[156:159],v[84:87]
v_mfma_f32_16x16x32_bf16 v[84:87],a[232:235],a[160:163],v[84:87]
ds_read_b64_tr_b16 a[252:253],v6 offset:24576
ds_read_b64_tr_b16 a[254:255],v6 offset:30720
v_mfma_f32_16x16x32_bf16 v[84:87],a[236:239],a[164:167],v[84:87]
v_mfma_f32_16x16x32_bf16 v[92:95],a[216:219],a[168:171],0
v_mfma_f32_16x16x32_bf16 v[92:95],a[220:223],a[172:175],v[92:95]
v_mfma_f32_16x16x32_bf16 v[92:95],a[224:227],a[176:179],v[92:95]
v_mfma_f32_16x16x32_bf16 v[92:95],a[228:231],a[180:183],v[92:95]
v_mfma_f32_16x16x32_bf16 v[92:95],a[232:235],a[184:187],v[92:95]
v_mfma_f32_16x16x32_bf16 v[92:95],a[236:239],a[188:191],v[92:95]
s_cbranch_scc1 L_loop4w1
s_cmp_ge_u32 s69,8
s_cbranch_scc1 L_end4
s_cmp_eq_u32 s40,0
s_cbranch_scc1 L_tr43
s_branch L_tr44
L_tr43:
s_waitcnt vmcnt(36)
s_waitcnt lgkmcnt(4)
v_mfma_f32_16x16x32_bf16 v[160:163],a[240:243],v[96:99],v[160:163]
ds_read_b128 a[96:99],v28 offset:0
v_fma_f32 v68,v68,s36,v16
v_mfma_f32_16x16x32_bf16 v[208:211],a[240:243],v[100:103],v[208:211]
ds_read_b128 a[100:103],v29 offset:0
v_fma_f32 v69,v69,s36,v16
v_mfma_f32_16x16x32_bf16 a[0:3],a[240:243],v[104:107],a[0:3]
ds_read_b128 a[104:107],v28 offset:1024
v_fma_f32 v70,v70,s36,v16
v_mfma_f32_16x16x32_bf16 a[48:51],a[240:243],v[108:111],a[48:51]
ds_read_b128 a[108:111],v29 offset:1024
v_fma_f32 v71,v71,s36,v16
v_mfma_f32_16x16x32_bf16 v[164:167],a[244:247],v[96:99],v[164:167]
ds_read_b128 a[112:115],v28 offset:2048
v_fma_f32 v76,v76,s36,v17
v_mfma_f32_16x16x32_bf16 v[212:215],a[244:247],v[100:103],v[212:215]
ds_read_b128 a[116:119],v29 offset:2048
v_fma_f32 v77,v77,s36,v17
v_mfma_f32_16x16x32_bf16 a[4:7],a[244:247],v[104:107],a[4:7]
ds_read_b64_tr_b16 a[240:241],v3 offset:25600
ds_read_b64_tr_b16 a[242:243],v3 offset:31744
v_mfma_f32_16x16x32_bf16 a[52:55],a[244:247],v[108:111],a[52:55]
s_waitcnt lgkmcnt(8)
ds_read_b64_tr_b16 a[244:245],v4 offset:25600
ds_read_b64_tr_b16 a[246:247],v4 offset:31744
v_mfma_f32_16x16x32_bf16 v[168:171],a[248:251],v[96:99],v[168:171]
ds_read_b128 a[192:195],v13 offset:0
v_fma_f32 v78,v78,s36,v17
v_mfma_f32_16x16x32_bf16 v[216:219],a[248:251],v[100:103],v[216:219]
ds_read_b128 a[196:199],v14 offset:0
v_fma_f32 v79,v79,s36,v17
v_mfma_f32_16x16x32_bf16 a[8:11],a[248:251],v[104:107],a[8:11]
ds_read_b128 a[200:203],v13 offset:1024
v_fma_f32 v80,v80,s36,v18
v_mfma_f32_16x16x32_bf16 a[56:59],a[248:251],v[108:111],a[56:59]
ds_read_b64_tr_b16 a[248:249],v5 offset:25600
ds_read_b64_tr_b16 a[250:251],v5 offset:31744
v_mfma_f32_16x16x32_bf16 v[172:175],a[252:255],v[96:99],v[172:175]
ds_read_b128 a[204:207],v14 offset:1024
v_fma_f32 v81,v81,s36,v18
v_mfma_f32_16x16x32_bf16 v[220:223],a[252:255],v[100:103],v[220:223]
ds_read_b128 a[208:211],v13 offset:2048
v_fma_f32 v82,v82,s36,v18
v_mfma_f32_16x16x32_bf16 a[12:15],a[252:255],v[104:107],a[12:15]
ds_read_b128 a[212:215],v14 offset:2048
v_fma_f32 v83,v83,s36,v18
v_mfma_f32_16x16x32_bf16 a[60:63],a[252:255],v[108:111],a[60:63]
s_waitcnt lgkmcnt(9)
ds_read_b64_tr_b16 a[252:253],v6 offset:25600
ds_read_b64_tr_b16 a[254:255],v6 offset:31744
v_mfma_f32_16x16x32_bf16 v[176:179],a[240:243],v[96:99],v[176:179]
ds_read_b128 a[216:219],v13 offset:45056
v_fma_f32 v84,v84,s36,v18
v_mfma_f32_16x16x32_bf16 v[224:227],a[240:243],v[100:103],v[224:227]
ds_read_b128 a[220:223],v14 offset:45056
v_fma_f32 v85,v85,s36,v18
v_mfma_f32_16x16x32_bf16 a[16:19],a[240:243],v[104:107],a[16:19]
ds_read_b128 a[224:227],v13 offset:46080
v_fma_f32 v86,v86,s36,v18
v_mfma_f32_16x16x32_bf16 a[64:67],a[240:243],v[108:111],a[64:67]
s_waitcnt lgkmcnt(9)
ds_read_b64_tr_b16 a[240:241],v3 offset:26624
ds_read_b64_tr_b16 a[242:243],v3 offset:32768
v_mfma_f32_16x16x32_bf16 v[180:183],a[244:247],v[96:99],v[180:183]
ds_read_b128 a[228:231],v14 offset:46080
v_fma_f32 v87,v87,s36,v18
v_mfma_f32_16x16x32_bf16 v[228:231],a[244:247],v[100:103],v[228:231]
ds_read_b128 a[232:235],v13 offset:47104
v_fma_f32 v88,v88,s36,v19
v_mfma_f32_16x16x32_bf16 a[20:23],a[244:247],v[104:107],a[20:23]
ds_read_b128 a[236:239],v14 offset:47104
v_fma_f32 v89,v89,s36,v19
v_mfma_f32_16x16x32_bf16 a[68:71],a[244:247],v[108:111],a[68:71]
s_waitcnt lgkmcnt(8)
ds_read_b64_tr_b16 a[244:245],v4 offset:26624
ds_read_b64_tr_b16 a[246:247],v4 offset:32768
v_mfma_f32_16x16x32_bf16 v[184:187],a[248:251],v[96:99],v[184:187]
ds_read_b128 a[120:123],v28 offset:6144
v_fma_f32 v90,v90,s36,v19
v_mfma_f32_16x16x32_bf16 v[232:235],a[248:251],v[100:103],v[232:235]
ds_read_b128 a[124:127],v29 offset:6144
v_fma_f32 v91,v91,s36,v19
v_mfma_f32_16x16x32_bf16 a[24:27],a[248:251],v[104:107],a[24:27]
ds_read_b128 a[128:131],v28 offset:7168
v_fma_f32 v92,v92,s36,v19
v_mfma_f32_16x16x32_bf16 a[72:75],a[248:251],v[108:111],a[72:75]
ds_read_b64_tr_b16 a[248:249],v5 offset:26624
ds_read_b64_tr_b16 a[250:251],v5 offset:32768
v_mfma_f32_16x16x32_bf16 v[188:191],a[252:255],v[96:99],v[188:191]
ds_read_b128 a[132:135],v29 offset:7168
v_fma_f32 v93,v93,s36,v19
v_mfma_f32_16x16x32_bf16 v[236:239],a[252:255],v[100:103],v[236:239]
ds_read_b128 a[136:139],v28 offset:8192
v_fma_f32 v94,v94,s36,v19
v_mfma_f32_16x16x32_bf16 a[28:31],a[252:255],v[104:107],a[28:31]
ds_read_b128 a[140:143],v29 offset:8192
v_fma_f32 v95,v95,s36,v19
v_mfma_f32_16x16x32_bf16 a[76:79],a[252:255],v[108:111],a[76:79]
s_waitcnt lgkmcnt(9)
ds_read_b64_tr_b16 a[252:253],v6 offset:26624
ds_read_b64_tr_b16 a[254:255],v6 offset:32768
v_mfma_f32_16x16x32_bf16 v[192:195],a[240:243],v[96:99],v[192:195]
v_exp_f32 v68,v68
v_mfma_f32_16x16x32_bf16 v[240:243],a[240:243],v[100:103],v[240:243]
v_exp_f32 v69,v69
v_mfma_f32_16x16x32_bf16 a[32:35],a[240:243],v[104:107],a[32:35]
v_exp_f32 v70,v70
v_mfma_f32_16x16x32_bf16 a[80:83],a[240:243],v[108:111],a[80:83]
s_waitcnt lgkmcnt(6)
v_exp_f32 v71,v71
v_mfma_f32_16x16x32_bf16 v[196:199],a[244:247],v[96:99],v[196:199]
v_exp_f32 v76,v76
v_mfma_f32_16x16x32_bf16 v[244:247],a[244:247],v[100:103],v[244:247]
v_exp_f32 v77,v77
v_mfma_f32_16x16x32_bf16 a[36:39],a[244:247],v[104:107],a[36:39]
v_exp_f32 v78,v78
v_mfma_f32_16x16x32_bf16 a[84:87],a[244:247],v[108:111],a[84:87]
s_waitcnt lgkmcnt(1)
v_exp_f32 v79,v79
v_mfma_f32_16x16x32_bf16 v[200:203],a[248:251],v[96:99],v[200:203]
v_exp_f32 v80,v80
v_mfma_f32_16x16x32_bf16 v[248:251],a[248:251],v[100:103],v[248:251]
v_exp_f32 v81,v81
v_mfma_f32_16x16x32_bf16 a[40:43],a[248:251],v[104:107],a[40:43]
v_exp_f32 v82,v82
v_mfma_f32_16x16x32_bf16 a[88:91],a[248:251],v[108:111],a[88:91]
s_waitcnt lgkmcnt(0)
v_exp_f32 v83,v83
v_mfma_f32_16x16x32_bf16 v[204:207],a[252:255],v[96:99],v[204:207]
v_exp_f32 v84,v84
v_mfma_f32_16x16x32_bf16 v[252:255],a[252:255],v[100:103],v[252:255]
v_exp_f32 v85,v85
v_mfma_f32_16x16x32_bf16 a[44:47],a[252:255],v[104:107],a[44:47]
v_exp_f32 v86,v86
v_mfma_f32_16x16x32_bf16 a[92:95],a[252:255],v[108:111],a[92:95]
v_exp_f32 v87,v87
s_waitcnt vmcnt(5)
s_barrier
v_exp_f32 v88,v88
v_exp_f32 v89,v89
v_exp_f32 v90,v90
v_exp_f32 v91,v91
v_exp_f32 v92,v92
v_exp_f32 v93,v93
v_exp_f32 v94,v94
v_exp_f32 v95,v95
v_cvt_pk_bf16_f32 v114,v68,v69
v_cvt_pk_bf16_f32 v115,v70,v71
v_cvt_pk_bf16_f32 v118,v76,v77
v_cvt_pk_bf16_f32 v119,v78,v79
v_mfma_f32_16x16x32_bf16 v[128:131],v[24:27],v[112:115],v[128:131]
v_cvt_pk_bf16_f32 v120,v80,v81
v_cvt_pk_bf16_f32 v121,v82,v83
v_mfma_f32_16x16x32_bf16 v[132:135],v[24:27],v[116:119],v[132:135]
ds_read_b64_tr_b16 a[240:241],v3 offset:0
ds_read_b64_tr_b16 a[242:243],v3 offset:6144
v_cvt_pk_bf16_f32 v122,v84,v85
v_cvt_pk_bf16_f32 v123,v86,v87
v_cvt_pk_bf16_f32 v124,v88,v89
v_cvt_pk_bf16_f32 v125,v90,v91
v_mfma_f32_16x16x32_bf16 v[136:139],v[24:27],v[120:123],v[136:139]
ds_read_b64_tr_b16 a[244:245],v4 offset:0
ds_read_b64_tr_b16 a[246:247],v4 offset:6144
v_cvt_pk_bf16_f32 v126,v92,v93
v_cvt_pk_bf16_f32 v127,v94,v95
ds_read_b64_tr_b16 a[248:249],v5 offset:0
ds_read_b64_tr_b16 a[250:251],v5 offset:6144
v_mfma_f32_16x16x32_bf16 v[140:143],v[24:27],v[124:127],v[140:143]
s_waitcnt lgkmcnt(4)
ds_read_b64_tr_b16 a[252:253],v6 offset:0
ds_read_b64_tr_b16 a[254:255],v6 offset:6144
v_mfma_f32_16x16x32_bf16 v[160:163],a[240:243],v[112:115],v[160:163]
s_add_u32 s87,s42,18432
v_rcp_f32 v144,v128
v_mfma_f32_16x16x32_bf16 v[208:211],a[240:243],v[116:119],v[208:211]
v_rcp_f32 v146,v132
v_mfma_f32_16x16x32_bf16 a[0:3],a[240:243],v[120:123],a[0:3]
v_rcp_f32 v150,v140
v_mfma_f32_16x16x32_bf16 a[48:51],a[240:243],v[124:127],a[48:51]
s_waitcnt lgkmcnt(4)
ds_read_b64_tr_b16 a[240:241],v3 offset:1024
ds_read_b64_tr_b16 a[242:243],v3 offset:7168
v_mfma_f32_16x16x32_bf16 v[164:167],a[244:247],v[112:115],v[164:167]
v_rcp_f32 v148,v136
v_mfma_f32_16x16x32_bf16 v[212:215],a[244:247],v[116:119],v[212:215]
v_max3_f32 v30,v128,v132,v136
v_max_f32 v30,v30,v140
v_mfma_f32_16x16x32_bf16 a[4:7],a[244:247],v[120:123],a[4:7]
v_accvgpr_read_b32 v64,a48
v_accvgpr_read_b32 v65,a49
v_mfma_f32_16x16x32_bf16 a[52:55],a[244:247],v[124:127],a[52:55]
ds_read_b64_tr_b16 a[244:245],v4 offset:1024
ds_read_b64_tr_b16 a[246:247],v4 offset:7168
v_accvgpr_read_b32 v66,a50
v_accvgpr_read_b32 v67,a51
v_cmp_nlt_f32 vcc,v30,v31
v_pk_mul_f32 v[64:65],v[64:65],v[150:151] op_sel_hi:[1,0]
v_pk_mul_f32 v[160:161],v[160:161],v[144:145] op_sel_hi:[1,0]
v_pk_mul_f32 v[162:163],v[162:163],v[144:145] op_sel_hi:[1,0]
v_pk_mul_f32 v[66:67],v[66:67],v[150:151] op_sel_hi:[1,0]
v_accvgpr_read_b32 v68,a52
v_accvgpr_read_b32 v69,a53
s_waitcnt lgkmcnt(4)
v_mfma_f32_16x16x32_bf16 v[168:171],a[248:251],v[112:115],v[168:171]
s_cmp_lg_u64 vcc,0
v_accvgpr_read_b32 v70,a54
v_accvgpr_read_b32 v71,a55
v_mfma_f32_16x16x32_bf16 v[216:219],a[248:251],v[116:119],v[216:219]
s_cselect_b32 s62,s32,0
v_cvt_pk_bf16_f32 v80,v64,v65
v_cvt_pk_bf16_f32 v81,v66,v67
v_mfma_f32_16x16x32_bf16 a[8:11],a[248:251],v[120:123],a[8:11]
s_or_b32 s31,s31,s62
v_cvt_pk_bf16_f32 v82,v160,v161
v_cvt_pk_bf16_f32 v83,v162,v163
v_subrev_u32 v11,18432,v11
s_lshl_b32 s32,s32,1
s_add_u32 m0,s22,24576
ds_write2st64_b64 v12,v[80:81],v[82:83] offset0:36 offset1:0
v_pk_mul_f32 v[68:69],v[68:69],v[150:151] op_sel_hi:[1,0]
v_pk_mul_f32 v[70:71],v[70:71],v[150:151] op_sel_hi:[1,0]
v_pk_mul_f32 v[164:165],v[164:165],v[144:145] op_sel_hi:[1,0]
v_pk_mul_f32 v[166:167],v[166:167],v[144:145] op_sel_hi:[1,0]
v_cvt_pk_bf16_f32 v84,v68,v69
v_cvt_pk_bf16_f32 v85,v70,v71
v_mfma_f32_16x16x32_bf16 a[56:59],a[248:251],v[124:127],a[56:59]
buffer_load_dwordx4 v7,s[4:7],s20 offen offset:0 lds
s_add_u32 m0,s22,25472
v_mfma_f32_16x16x32_bf16 v[172:175],a[252:255],v[112:115],v[172:175]
ds_read_b64_tr_b16 a[248:249],v5 offset:1024
ds_read_b64_tr_b16 a[250:251],v5 offset:7168
v_mfma_f32_16x16x32_bf16 v[220:223],a[252:255],v[116:119],v[220:223]
v_cvt_pk_bf16_f32 v86,v164,v165
v_cvt_pk_bf16_f32 v87,v166,v167
v_mfma_f32_16x16x32_bf16 a[12:15],a[252:255],v[120:123],a[12:15]
ds_write2st64_b64 v20,v[84:85],v[86:87] offset0:36 offset1:0
v_pk_mul_f32 v[168:169],v[168:169],v[144:145] op_sel_hi:[1,0]
v_pk_mul_f32 v[170:171],v[170:171],v[144:145] op_sel_hi:[1,0]
v_accvgpr_read_b32 v72,a56
v_accvgpr_read_b32 v73,a57
v_pk_mul_f32 v[72:73],v[72:73],v[150:151] op_sel_hi:[1,0]
v_accvgpr_read_b32 v74,a58
v_accvgpr_read_b32 v75,a59
v_pk_mul_f32 v[74:75],v[74:75],v[150:151] op_sel_hi:[1,0]
v_cvt_pk_bf16_f32 v88,v72,v73
v_cvt_pk_bf16_f32 v89,v74,v75
v_mfma_f32_16x16x32_bf16 a[60:63],a[252:255],v[124:127],a[60:63]
ds_read_b64_tr_b16 a[252:253],v6 offset:1024
buffer_load_dwordx4 v7,s[4:7],s20 offen offset:128 lds
s_add_u32 m0,s22,26368
s_waitcnt lgkmcnt(4)
v_mfma_f32_16x16x32_bf16 v[176:179],a[240:243],v[112:115],v[176:179]
ds_read_b64_tr_b16 a[254:255],v6 offset:7168
v_cvt_pk_bf16_f32 v90,v168,v169
v_mfma_f32_16x16x32_bf16 v[224:227],a[240:243],v[116:119],v[224:227]
v_cvt_pk_bf16_f32 v91,v170,v171
v_accvgpr_read_b32 v76,a60
v_mfma_f32_16x16x32_bf16 a[16:19],a[240:243],v[120:123],a[16:19]
ds_write2st64_b64 v21,v[88:89],v[90:91] offset0:36 offset1:0
v_pk_mul_f32 v[172:173],v[172:173],v[144:145] op_sel_hi:[1,0]
v_pk_mul_f32 v[174:175],v[174:175],v[144:145] op_sel_hi:[1,0]
v_accvgpr_read_b32 v77,a61
v_pk_mul_f32 v[76:77],v[76:77],v[150:151] op_sel_hi:[1,0]
v_accvgpr_read_b32 v78,a62
v_accvgpr_read_b32 v79,a63
v_pk_mul_f32 v[78:79],v[78:79],v[150:151] op_sel_hi:[1,0]
v_cvt_pk_bf16_f32 v92,v76,v77
v_cvt_pk_bf16_f32 v93,v78,v79
v_mfma_f32_16x16x32_bf16 a[64:67],a[240:243],v[124:127],a[64:67]
ds_read_b64_tr_b16 a[240:241],v3 offset:2048
ds_read_b64_tr_b16 a[242:243],v3 offset:8192
v_mfma_f32_16x16x32_bf16 v[180:183],a[244:247],v[112:115],v[180:183]
v_cvt_pk_bf16_f32 v94,v172,v173
v_cvt_pk_bf16_f32 v95,v174,v175
ds_write2st64_b64 v22,v[92:93],v[94:95] offset0:36 offset1:0
v_pk_mul_f32 v[208:209],v[208:209],v[146:147] op_sel_hi:[1,0]
v_pk_mul_f32 v[210:211],v[210:211],v[146:147] op_sel_hi:[1,0]
v_pk_mul_f32 v[176:177],v[176:177],v[144:145] op_sel_hi:[1,0]
v_pk_mul_f32 v[178:179],v[178:179],v[144:145] op_sel_hi:[1,0]
v_accvgpr_read_b32 v64,a64
v_accvgpr_read_b32 v65,a65
v_mfma_f32_16x16x32_bf16 v[228:231],a[244:247],v[116:119],v[228:231]
ds_read_b128 v[152:155],v15 offset:18432
v_accvgpr_read_b32 v66,a66
v_mfma_f32_16x16x32_bf16 a[20:23],a[244:247],v[120:123],a[20:23]
ds_read_b128 v[156:159],v15 offset:21504
v_accvgpr_read_b32 v67,a67
v_mfma_f32_16x16x32_bf16 a[68:71],a[244:247],v[124:127],a[68:71]
s_waitcnt lgkmcnt(5)
ds_read_b64_tr_b16 a[244:245],v4 offset:2048
ds_read_b64_tr_b16 a[246:247],v4 offset:8192
v_mfma_f32_16x16x32_bf16 v[184:187],a[248:251],v[112:115],v[184:187]
v_cvt_pk_bf16_f32 v80,v208,v209
v_cvt_pk_bf16_f32 v81,v210,v211
v_cvt_pk_bf16_f32 v82,v176,v177
v_cvt_pk_bf16_f32 v83,v178,v179
v_pk_mul_f32 v[212:213],v[212:213],v[146:147] op_sel_hi:[1,0]
v_pk_mul_f32 v[214:215],v[214:215],v[146:147] op_sel_hi:[1,0]
v_pk_mul_f32 v[180:181],v[180:181],v[144:145] op_sel_hi:[1,0]
v_pk_mul_f32 v[182:183],v[182:183],v[144:145] op_sel_hi:[1,0]
v_accvgpr_read_b32 v68,a68
v_accvgpr_read_b32 v69,a69
v_mfma_f32_16x16x32_bf16 v[232:235],a[248:251],v[116:119],v[232:235]
buffer_load_dwordx4 v7,s[4:7],s20 offen offset:256 lds
s_add_u32 s20,s20,12288
s_add_u32 m0,s23,0
v_mfma_f32_16x16x32_bf16 a[24:27],a[248:251],v[120:123],a[24:27]
v_accvgpr_read_b32 v70,a70
v_accvgpr_read_b32 v71,a71
v_mfma_f32_16x16x32_bf16 a[72:75],a[248:251],v[124:127],a[72:75]
ds_read_b64_tr_b16 a[248:249],v5 offset:2048
ds_read_b64_tr_b16 a[250:251],v5 offset:8192
ds_write2st64_b64 v12,v[80:81],v[82:83] offset0:12 offset1:2
v_pk_mul_f32 v[216:217],v[216:217],v[146:147] op_sel_hi:[1,0]
v_pk_mul_f32 v[218:219],v[218:219],v[146:147] op_sel_hi:[1,0]
v_pk_mul_f32 v[184:185],v[184:185],v[144:145] op_sel_hi:[1,0]
v_pk_mul_f32 v[186:187],v[186:187],v[144:145] op_sel_hi:[1,0]
v_cvt_pk_bf16_f32 v84,v212,v213
v_accvgpr_read_b32 v72,a72
v_mfma_f32_16x16x32_bf16 v[188:191],a[252:255],v[112:115],v[188:191]
s_waitcnt lgkmcnt(3)
buffer_store_dwordx4 v[152:155],v10,s[16:19],s87 offen offset:0 nt
v_mfma_f32_16x16x32_bf16 v[236:239],a[252:255],v[116:119],v[236:239]
v_accvgpr_read_b32 v73,a73
v_accvgpr_read_b32 v74,a74
v_mfma_f32_16x16x32_bf16 a[28:31],a[252:255],v[120:123],a[28:31]
v_accvgpr_read_b32 v75,a75
v_cvt_pk_bf16_f32 v85,v214,v215
v_mfma_f32_16x16x32_bf16 a[76:79],a[252:255],v[124:127],a[76:79]
ds_read_b64_tr_b16 a[252:253],v6 offset:2048
ds_read_b64_tr_b16 a[254:255],v6 offset:8192
buffer_store_dwordx4 v[156:159],v10,s[16:19],s87 offen offset:3072 nt
v_pk_mul_f32 v[220:221],v[220:221],v[146:147] op_sel_hi:[1,0]
v_pk_mul_f32 v[222:223],v[222:223],v[146:147] op_sel_hi:[1,0]
v_pk_mul_f32 v[188:189],v[188:189],v[144:145] op_sel_hi:[1,0]
v_pk_mul_f32 v[190:191],v[190:191],v[144:145] op_sel_hi:[1,0]
v_cvt_pk_bf16_f32 v86,v180,v181
v_accvgpr_read_b32 v76,a76
v_mfma_f32_16x16x32_bf16 v[192:195],a[240:243],v[112:115],v[192:195]
v_accvgpr_read_b32 v77,a77
v_accvgpr_read_b32 v78,a78
v_mfma_f32_16x16x32_bf16 v[240:243],a[240:243],v[116:119],v[240:243]
s_waitcnt vmcnt(5)
ds_read_b128 a[144:147],v28 offset:12288
v_accvgpr_read_b32 v79,a79
v_cvt_pk_bf16_f32 v87,v182,v183
v_cvt_pk_bf16_f32 v88,v216,v217
v_cvt_pk_bf16_f32 v89,v218,v219
v_pk_mul_f32 v[64:65],v[64:65],v[150:151] op_sel_hi:[1,0]
v_pk_mul_f32 v[66:67],v[66:67],v[150:151] op_sel_hi:[1,0]
v_pk_mul_f32 v[224:225],v[224:225],v[146:147] op_sel_hi:[1,0]
v_pk_mul_f32 v[226:227],v[226:227],v[146:147] op_sel_hi:[1,0]
v_cvt_pk_bf16_f32 v80,v64,v65
v_cvt_pk_bf16_f32 v81,v66,v67
v_mfma_f32_16x16x32_bf16 a[32:35],a[240:243],v[120:123],a[32:35]
ds_read_b128 a[148:151],v29 offset:12288
v_cvt_pk_bf16_f32 v90,v184,v185
v_mfma_f32_16x16x32_bf16 a[80:83],a[240:243],v[124:127],a[80:83]
ds_read_b128 a[152:155],v28 offset:13312
v_cvt_pk_bf16_f32 v91,v186,v187
v_mfma_f32_16x16x32_bf16 v[196:199],a[244:247],v[112:115],v[196:199]
ds_read_b128 a[156:159],v29 offset:13312
s_waitcnt vmcnt(7)
s_waitcnt lgkmcnt(4)
s_barrier
v_mfma_f32_16x16x32_bf16 v[244:247],a[244:247],v[116:119],v[244:247]
ds_read_b128 a[160:163],v28 offset:14336
v_accvgpr_read_b32 v64,a80
v_accvgpr_read_b32 v65,a81
v_accvgpr_read_b32 v66,a82
v_accvgpr_read_b32 v67,a83
v_pk_mul_f32 v[68:69],v[68:69],v[150:151] op_sel_hi:[1,0]
v_pk_mul_f32 v[70:71],v[70:71],v[150:151] op_sel_hi:[1,0]
v_pk_mul_f32 v[228:229],v[228:229],v[146:147] op_sel_hi:[1,0]
v_pk_mul_f32 v[230:231],v[230:231],v[146:147] op_sel_hi:[1,0]
v_cvt_pk_bf16_f32 v92,v220,v221
v_cvt_pk_bf16_f32 v93,v222,v223
v_mfma_f32_16x16x32_bf16 a[36:39],a[244:247],v[120:123],a[36:39]
ds_read_b128 a[164:167],v29 offset:14336
v_cvt_pk_bf16_f32 v94,v188,v189
v_mfma_f32_16x16x32_bf16 a[84:87],a[244:247],v[124:127],a[84:87]
ds_write2st64_b64 v20,v[84:85],v[86:87] offset0:12 offset1:2
v_mfma_f32_16x16x32_bf16 v[200:203],a[248:251],v[112:115],v[200:203]
v_cvt_pk_bf16_f32 v84,v68,v69
v_cvt_pk_bf16_f32 v85,v70,v71
v_cvt_pk_bf16_f32 v95,v190,v191
v_cvt_pk_bf16_f32 v82,v224,v225
v_cvt_pk_bf16_f32 v83,v226,v227
v_pk_mul_f32 v[72:73],v[72:73],v[150:151] op_sel_hi:[1,0]
v_pk_mul_f32 v[74:75],v[74:75],v[150:151] op_sel_hi:[1,0]
v_pk_mul_f32 v[232:233],v[232:233],v[146:147] op_sel_hi:[1,0]
v_pk_mul_f32 v[234:235],v[234:235],v[146:147] op_sel_hi:[1,0]
v_accvgpr_read_b32 v68,a84
v_accvgpr_read_b32 v69,a85
v_mfma_f32_16x16x32_bf16 v[248:251],a[248:251],v[116:119],v[248:251]
buffer_load_dwordx4 v7,s[8:11],s21 offen offset:0 lds
s_add_u32 m0,s23,896
v_mfma_f32_16x16x32_bf16 a[40:43],a[248:251],v[120:123],a[40:43]
v_accvgpr_read_b32 v70,a86
v_accvgpr_read_b32 v71,a87
v_mfma_f32_16x16x32_bf16 a[88:91],a[248:251],v[124:127],a[88:91]
ds_write2st64_b64 v21,v[88:89],v[90:91] offset0:12 offset1:2
v_pk_mul_f32 v[76:77],v[76:77],v[150:151] op_sel_hi:[1,0]
v_pk_mul_f32 v[78:79],v[78:79],v[150:151] op_sel_hi:[1,0]
v_pk_mul_f32 v[236:237],v[236:237],v[146:147] op_sel_hi:[1,0]
v_pk_mul_f32 v[238:239],v[238:239],v[146:147] op_sel_hi:[1,0]
v_cvt_pk_bf16_f32 v88,v72,v73
v_cvt_pk_bf16_f32 v89,v74,v75
v_mfma_f32_16x16x32_bf16 v[204:207],a[252:255],v[112:115],v[204:207]
ds_write2st64_b64 v22,v[92:93],v[94:95] offset0:12 offset1:2
v_mfma_f32_16x16x32_bf16 v[252:255],a[252:255],v[116:119],v[252:255]
v_accvgpr_read_b32 v72,a88
v_accvgpr_read_b32 v73,a89
v_mfma_f32_16x16x32_bf16 a[44:47],a[252:255],v[120:123],a[44:47]
v_accvgpr_read_b32 v74,a90
v_accvgpr_read_b32 v75,a91
v_mfma_f32_16x16x32_bf16 a[92:95],a[252:255],v[124:127],a[92:95]
buffer_load_dwordx4 v7,s[8:11],s21 offen offset:128 lds
s_add_u32 m0,s23,1792
v_cvt_pk_bf16_f32 v92,v76,v77
v_cvt_pk_bf16_f32 v93,v78,v79
v_pk_mul_f32 v[64:65],v[64:65],v[150:151] op_sel_hi:[1,0]
v_pk_mul_f32 v[66:67],v[66:67],v[150:151] op_sel_hi:[1,0]
v_pk_mul_f32 v[192:193],v[192:193],v[144:145] op_sel_hi:[1,0]
v_pk_mul_f32 v[194:195],v[194:195],v[144:145] op_sel_hi:[1,0]
v_accvgpr_read_b32 v76,a92
v_accvgpr_read_b32 v77,a93
v_mfma_f32_16x16x32_bf16 v[32:35],a[192:195],a[96:99],0
ds_write2st64_b64 v12,v[80:81],v[82:83] offset0:36 offset1:14
v_mfma_f32_16x16x32_bf16 v[32:35],a[196:199],a[100:103],v[32:35]
v_accvgpr_read_b32 v78,a94
v_accvgpr_read_b32 v79,a95
v_mfma_f32_16x16x32_bf16 v[32:35],a[200:203],a[104:107],v[32:35]
v_cvt_pk_bf16_f32 v80,v64,v65
v_cvt_pk_bf16_f32 v81,v66,v67
v_accvgpr_read_b32 v64,a0
v_accvgpr_read_b32 v65,a1
v_accvgpr_read_b32 v66,a2
v_pk_mul_f32 v[68:69],v[68:69],v[150:151] op_sel_hi:[1,0]
v_pk_mul_f32 v[70:71],v[70:71],v[150:151] op_sel_hi:[1,0]
v_pk_mul_f32 v[196:197],v[196:197],v[144:145] op_sel_hi:[1,0]
v_pk_mul_f32 v[198:199],v[198:199],v[144:145] op_sel_hi:[1,0]
v_accvgpr_read_b32 v67,a3
v_cvt_pk_bf16_f32 v86,v228,v229
v_mfma_f32_16x16x32_bf16 v[32:35],a[204:207],a[108:111],v[32:35]
v_cvt_pk_bf16_f32 v87,v230,v231
v_cvt_pk_bf16_f32 v90,v232,v233
v_mfma_f32_16x16x32_bf16 v[32:35],a[208:211],a[112:115],v[32:35]
ds_write2st64_b64 v20,v[84:85],v[86:87] offset0:36 offset1:14
v_mfma_f32_16x16x32_bf16 v[32:35],a[212:215],a[116:119],v[32:35]
v_cvt_pk_bf16_f32 v84,v68,v69
v_cvt_pk_bf16_f32 v85,v70,v71
v_accvgpr_read_b32 v68,a4
v_accvgpr_read_b32 v69,a5
v_accvgpr_read_b32 v70,a6
v_pk_mul_f32 v[72:73],v[72:73],v[150:151] op_sel_hi:[1,0]
v_pk_mul_f32 v[74:75],v[74:75],v[150:151] op_sel_hi:[1,0]
v_pk_mul_f32 v[200:201],v[200:201],v[144:145] op_sel_hi:[1,0]
v_pk_mul_f32 v[202:203],v[202:203],v[144:145] op_sel_hi:[1,0]
v_accvgpr_read_b32 v71,a7
v_cvt_pk_bf16_f32 v91,v234,v235
v_mfma_f32_16x16x32_bf16 v[36:39],a[216:219],a[96:99],0
buffer_load_dwordx4 v7,s[8:11],s21 offen offset:256 lds
s_add_u32 s21,s21,12288
s_mov_b32 s27,s42
v_mfma_f32_16x16x32_bf16 v[36:39],a[220:223],a[100:103],v[36:39]
s_mov_b32 s42,s41
v_cvt_pk_bf16_f32 v94,v236,v237
v_cvt_pk_bf16_f32 v95,v238,v239
v_mfma_f32_16x16x32_bf16 v[36:39],a[224:227],a[104:107],v[36:39]
s_add_u32 s69,s69,1
ds_write2st64_b64 v21,v[88:89],v[90:91] offset0:36 offset1:14
s_add_u32 s48,s48,325632
s_lshr_b32 s62,s39,s69
s_and_b32 s62,s62,1
s_lshl_b32 s62,s62,1
v_mfma_f32_16x16x32_bf16 v[36:39],a[228:231],a[108:111],v[36:39]
s_add_u32 s62,s62,s49
v_cvt_pk_bf16_f32 v88,v72,v73
v_cvt_pk_bf16_f32 v89,v74,v75
v_accvgpr_read_b32 v72,a8
v_accvgpr_read_b32 v73,a9
v_accvgpr_read_b32 v74,a10
v_pk_mul_f32 v[76:77],v[76:77],v[150:151] op_sel_hi:[1,0]
v_pk_mul_f32 v[78:79],v[78:79],v[150:151] op_sel_hi:[1,0]
v_pk_mul_f32 v[204:205],v[204:205],v[144:145] op_sel_hi:[1,0]
v_pk_mul_f32 v[206:207],v[206:207],v[144:145] op_sel_hi:[1,0]
v_accvgpr_read_b32 v75,a11
v_cvt_pk_bf16_f32 v82,v192,v193
v_mfma_f32_16x16x32_bf16 v[36:39],a[232:235],a[112:115],v[36:39]
s_and_b32 s62,s62,3
ds_write2st64_b64 v22,v[92:93],v[94:95] offset0:36 offset1:14
s_add_u32 s63,s69,8
s_lshr_b32 s63,s39,s63
s_and_b32 s63,s63,1
s_xor_b32 s62,s62,s63
v_mfma_f32_16x16x32_bf16 v[36:39],a[236:239],a[116:119],v[36:39]
s_mul_i32 s63,s3,3
v_cvt_pk_bf16_f32 v92,v76,v77
v_cvt_pk_bf16_f32 v93,v78,v79
v_mfma_f32_16x16x32_bf16 v[40:43],a[192:195],a[120:123],0
s_lshl_b32 s64,s3,2
v_accvgpr_read_b32 v76,a12
v_accvgpr_read_b32 v77,a13
v_accvgpr_read_b32 v78,a14
v_accvgpr_read_b32 v79,a15
v_cvt_pk_bf16_f32 v83,v194,v195
v_pk_mul_f32 v[240:241],v[240:241],v[146:147] op_sel_hi:[1,0]
v_pk_mul_f32 v[242:243],v[242:243],v[146:147] op_sel_hi:[1,0]
v_pk_mul_f32 v[64:65],v[64:65],v[148:149] op_sel_hi:[1,0]
v_pk_mul_f32 v[66:67],v[66:67],v[148:149] op_sel_hi:[1,0]
v_cvt_pk_bf16_f32 v86,v196,v197
v_cvt_pk_bf16_f32 v87,v198,v199
v_mfma_f32_16x16x32_bf16 v[40:43],a[196:199],a[124:127],v[40:43]
s_mov_b32 s40,1
ds_read_b128 v[152:155],v15 offset:18432
v_cvt_pk_bf16_f32 v90,v200,v201
v_mfma_f32_16x16x32_bf16 v[40:43],a[200:203],a[128:131],v[40:43]
s_add_u32 s65,s63,17
ds_read_b128 v[156:159],v15 offset:21504
v_cvt_pk_bf16_f32 v91,v202,v203
v_mfma_f32_16x16x32_bf16 v[40:43],a[204:207],a[132:135],v[40:43]
s_cmp_eq_u32 s3,0
ds_write2st64_b64 v12,v[80:81],v[82:83] offset0:36 offset1:4
s_cselect_b32 s65,16,s65
s_cselect_b32 s41,1,0
s_cmp_eq_u32 s62,1
s_cselect_b32 s64,s65,s64
v_pk_mul_f32 v[244:245],v[244:245],v[146:147] op_sel_hi:[1,0]
v_pk_mul_f32 v[246:247],v[246:247],v[146:147] op_sel_hi:[1,0]
v_pk_mul_f32 v[68:69],v[68:69],v[148:149] op_sel_hi:[1,0]
v_pk_mul_f32 v[70:71],v[70:71],v[148:149] op_sel_hi:[1,0]
v_cvt_pk_bf16_f32 v82,v64,v65
v_cvt_pk_bf16_f32 v83,v66,v67
v_mfma_f32_16x16x32_bf16 v[40:43],a[208:211],a[136:139],v[40:43]
s_cselect_b32 s40,s41,s40
ds_write2st64_b64 v20,v[84:85],v[86:87] offset0:36 offset1:4
s_add_u32 s65,s63,29
s_cmp_eq_u32 s62,2
s_cselect_b32 s64,s65,s64
s_cselect_b32 s40,0,s40
v_mfma_f32_16x16x32_bf16 v[40:43],a[212:215],a[140:143],v[40:43]
s_add_u32 s65,s63,41
v_cvt_pk_bf16_f32 v86,v68,v69
v_cvt_pk_bf16_f32 v87,v70,v71
v_mfma_f32_16x16x32_bf16 v[44:47],a[216:219],a[120:123],0
s_cmp_eq_u32 s62,3
v_accvgpr_read_b32 v64,a16
v_accvgpr_read_b32 v65,a17
v_accvgpr_read_b32 v66,a18
v_accvgpr_read_b32 v67,a19
v_accvgpr_read_b32 v68,a32
v_pk_mul_f32 v[248:249],v[248:249],v[146:147] op_sel_hi:[1,0]
v_pk_mul_f32 v[250:251],v[250:251],v[146:147] op_sel_hi:[1,0]
v_pk_mul_f32 v[72:73],v[72:73],v[148:149] op_sel_hi:[1,0]
v_pk_mul_f32 v[74:75],v[74:75],v[148:149] op_sel_hi:[1,0]
v_accvgpr_read_b32 v69,a33
v_accvgpr_read_b32 v70,a34
v_mfma_f32_16x16x32_bf16 v[44:47],a[220:223],a[124:127],v[44:47]
s_cselect_b32 s64,s65,s64
ds_write2st64_b64 v21,v[88:89],v[90:91] offset0:36 offset1:4
s_cselect_b32 s40,0,s40
s_mul_i32 s64,s64,6144
s_add_u32 s41,s48,s64
s_cmp_ge_u32 s69,8
v_mfma_f32_16x16x32_bf16 v[44:47],a[224:227],a[128:131],v[44:47]
s_cselect_b32 s41,166723584,s41
v_accvgpr_read_b32 v71,a35
v_cvt_pk_bf16_f32 v94,v204,v205
v_mfma_f32_16x16x32_bf16 v[44:47],a[228:231],a[132:135],v[44:47]
s_mov_b32 s28,s41
v_cvt_pk_bf16_f32 v95,v206,v207
v_cvt_pk_bf16_f32 v90,v72,v73
v_mfma_f32_16x16x32_bf16 v[44:47],a[232:235],a[136:139],v[44:47]
s_mov_b32 s29,s24
ds_write2st64_b64 v22,v[92:93],v[94:95] offset0:36 offset1:4
s_add_u32 s25,s22,12288
s_add_u32 s26,s22,24576
v_pk_mul_f32 v[252:253],v[252:253],v[146:147] op_sel_hi:[1,0]
v_pk_mul_f32 v[254:255],v[254:255],v[146:147] op_sel_hi:[1,0]
v_pk_mul_f32 v[76:77],v[76:77],v[148:149] op_sel_hi:[1,0]
v_pk_mul_f32 v[78:79],v[78:79],v[148:149] op_sel_hi:[1,0]
v_cvt_pk_bf16_f32 v91,v74,v75
v_cvt_pk_bf16_f32 v94,v76,v77
v_mfma_f32_16x16x32_bf16 v[44:47],a[236:239],a[140:143],v[44:47]
s_waitcnt lgkmcnt(2)
buffer_store_dwordx4 v[152:155],v10,s[16:19],s87 offen offset:128 nt
v_mfma_f32_16x16x32_bf16 v[48:51],a[192:195],a[144:147],0
v_cvt_pk_bf16_f32 v95,v78,v79
v_accvgpr_read_b32 v72,a20
v_mfma_f32_16x16x32_bf16 v[48:51],a[196:199],a[148:151],v[48:51]
v_accvgpr_read_b32 v73,a21
v_accvgpr_read_b32 v74,a22
v_accvgpr_read_b32 v75,a23
v_accvgpr_read_b32 v76,a36
v_accvgpr_read_b32 v77,a37
v_pk_mul_f32 v[64:65],v[64:65],v[148:149] op_sel_hi:[1,0]
v_pk_mul_f32 v[66:67],v[66:67],v[148:149] op_sel_hi:[1,0]
v_pk_mul_f32 v[68:69],v[68:69],v[148:149] op_sel_hi:[1,0]
v_pk_mul_f32 v[70:71],v[70:71],v[148:149] op_sel_hi:[1,0]
v_accvgpr_read_b32 v78,a38
v_accvgpr_read_b32 v79,a39
v_mfma_f32_16x16x32_bf16 v[48:51],a[200:203],a[152:155],v[48:51]
ds_read_b128 v[152:155],v15 offset:18432
buffer_store_dwordx4 v[156:159],v10,s[16:19],s87 offen offset:3200 nt
v_mfma_f32_16x16x32_bf16 v[48:51],a[204:207],a[156:159],v[48:51]
v_cvt_pk_bf16_f32 v80,v240,v241
v_cvt_pk_bf16_f32 v81,v242,v243
v_mfma_f32_16x16x32_bf16 v[48:51],a[208:211],a[160:163],v[48:51]
v_cvt_pk_bf16_f32 v84,v244,v245
v_cvt_pk_bf16_f32 v85,v246,v247
v_cvt_pk_bf16_f32 v88,v248,v249
v_cvt_pk_bf16_f32 v89,v250,v251
v_cvt_pk_bf16_f32 v92,v252,v253
v_pk_mul_f32 v[72:73],v[72:73],v[148:149] op_sel_hi:[1,0]
v_pk_mul_f32 v[74:75],v[74:75],v[148:149] op_sel_hi:[1,0]
v_pk_mul_f32 v[76:77],v[76:77],v[148:149] op_sel_hi:[1,0]
v_pk_mul_f32 v[78:79],v[78:79],v[148:149] op_sel_hi:[1,0]
v_cvt_pk_bf16_f32 v93,v254,v255
ds_read_b128 v[156:159],v15 offset:21504
v_mfma_f32_16x16x32_bf16 v[48:51],a[212:215],a[164:167],v[48:51]
ds_write2st64_b64 v12,v[80:81],v[82:83] offset0:16 offset1:24
v_mfma_f32_16x16x32_bf16 v[52:55],a[216:219],a[144:147],0
v_cvt_pk_bf16_f32 v80,v64,v65
v_cvt_pk_bf16_f32 v81,v66,v67
v_mfma_f32_16x16x32_bf16 v[52:55],a[220:223],a[148:151],v[52:55]
v_cvt_pk_bf16_f32 v82,v68,v69
v_cvt_pk_bf16_f32 v83,v70,v71
v_mfma_f32_16x16x32_bf16 v[52:55],a[224:227],a[152:155],v[52:55]
ds_write2st64_b64 v20,v[84:85],v[86:87] offset0:16 offset1:24
v_accvgpr_read_b32 v64,a24
v_accvgpr_read_b32 v65,a25
v_pk_mul_f32 v[64:65],v[64:65],v[148:149] op_sel_hi:[1,0]
v_accvgpr_read_b32 v66,a26
v_accvgpr_read_b32 v67,a27
v_pk_mul_f32 v[66:67],v[66:67],v[148:149] op_sel_hi:[1,0]
v_accvgpr_read_b32 v68,a40
v_accvgpr_read_b32 v69,a41
v_pk_mul_f32 v[68:69],v[68:69],v[148:149] op_sel_hi:[1,0]
v_accvgpr_read_b32 v70,a42
v_accvgpr_read_b32 v71,a43
v_pk_mul_f32 v[70:71],v[70:71],v[148:149] op_sel_hi:[1,0]
v_cvt_pk_bf16_f32 v84,v72,v73
v_cvt_pk_bf16_f32 v85,v74,v75
v_mfma_f32_16x16x32_bf16 v[52:55],a[228:231],a[156:159],v[52:55]
ds_write2st64_b64 v21,v[88:89],v[90:91] offset0:16 offset1:24
v_mfma_f32_16x16x32_bf16 v[52:55],a[232:235],a[160:163],v[52:55]
v_cvt_pk_bf16_f32 v86,v76,v77
v_cvt_pk_bf16_f32 v87,v78,v79
v_mfma_f32_16x16x32_bf16 v[52:55],a[236:239],a[164:167],v[52:55]
v_accvgpr_read_b32 v72,a28
v_accvgpr_read_b32 v73,a29
v_accvgpr_read_b32 v74,a30
v_accvgpr_read_b32 v75,a31
v_accvgpr_read_b32 v76,a44
v_pk_mul_f32 v[72:73],v[72:73],v[148:149] op_sel_hi:[1,0]
v_pk_mul_f32 v[74:75],v[74:75],v[148:149] op_sel_hi:[1,0]
v_accvgpr_read_b32 v77,a45
v_pk_mul_f32 v[76:77],v[76:77],v[148:149] op_sel_hi:[1,0]
v_accvgpr_read_b32 v78,a46
v_accvgpr_read_b32 v79,a47
v_pk_mul_f32 v[78:79],v[78:79],v[148:149] op_sel_hi:[1,0]
v_cvt_pk_bf16_f32 v88,v64,v65
v_cvt_pk_bf16_f32 v89,v66,v67
v_cvt_pk_bf16_f32 v90,v68,v69
v_cvt_pk_bf16_f32 v91,v70,v71
ds_write2st64_b64 v22,v[92:93],v[94:95] offset0:16 offset1:24
v_cvt_pk_bf16_f32 v92,v72,v73
v_cvt_pk_bf16_f32 v93,v74,v75
v_cvt_pk_bf16_f32 v94,v76,v77
v_cvt_pk_bf16_f32 v95,v78,v79
ds_write2st64_b64 v12,v[80:81],v[82:83] offset0:26 offset1:28
ds_write2st64_b64 v20,v[84:85],v[86:87] offset0:26 offset1:28
ds_write2st64_b64 v21,v[88:89],v[90:91] offset0:26 offset1:28
ds_write2st64_b64 v22,v[92:93],v[94:95] offset0:26 offset1:28
s_waitcnt lgkmcnt(2)
buffer_store_dwordx4 v[152:155],v10,s[16:19],s87 offen offset:256 nt
buffer_store_dwordx4 v[156:159],v10,s[16:19],s87 offen offset:3328 nt
ds_read_b128 a[192:195],v1 offset:12288
v_max3_f32 v144,v32,v33,v34
v_max3_f32 v144,v144,v35,v36
v_max3_f32 v144,v144,v37,v38
v_max_f32 v144,v144,v39
v_mov_b32 v145,v144
v_max3_f32 v146,v40,v41,v42
v_max3_f32 v146,v146,v43,v44
v_permlane32_swap_b32 v145,v144
s_add_u32 m0,s23,12288
v_max_f32 v144,v144,v145
v_mov_b32 v145,v144
v_max3_f32 v146,v146,v45,v46
v_max_f32 v146,v146,v47
v_permlane16_swap_b32 v145,v144
v_max_f32 v144,v144,v145
v_mul_f32_e64 v16,-s36,v144
v_max3_f32 v144,v48,v49,v50
v_max3_f32 v144,v144,v51,v52
v_max3_f32 v144,v144,v53,v54
v_max_f32 v144,v144,v55
v_mov_b32 v147,v146
v_mov_b32 v145,v144
v_fma_f32 v32,v32,s36,v16
v_permlane32_swap_b32 v147,v146
v_permlane32_swap_b32 v145,v144
v_max_f32 v146,v146,v147
v_max_f32 v144,v144,v145
v_mov_b32 v147,v146
v_mov_b32 v145,v144
v_fma_f32 v33,v33,s36,v16
v_permlane16_swap_b32 v147,v146
s_waitcnt lgkmcnt(0)
v_mfma_f32_16x16x32_bf16 v[64:67],a[192:195],a[96:99],0
buffer_load_dwordx4 v7,s[8:11],s21 offen offset:0 lds
s_add_u32 m0,s23,13184
ds_read_b128 a[196:199],v2 offset:12288
v_permlane16_swap_b32 v145,v144
v_max_f32 v146,v146,v147
v_max_f32 v144,v144,v145
v_mul_f32_e64 v17,-s36,v146
v_mul_f32_e64 v18,-s36,v144
v_fma_f32 v34,v34,s36,v16
v_fma_f32 v35,v35,s36,v16
v_fma_f32 v36,v36,s36,v16
v_fma_f32 v37,v37,s36,v16
v_fma_f32 v38,v38,s36,v16
v_fma_f32 v39,v39,s36,v16
v_fma_f32 v40,v40,s36,v17
v_fma_f32 v41,v41,s36,v17
v_fma_f32 v42,v42,s36,v17
v_fma_f32 v43,v43,s36,v17
v_fma_f32 v44,v44,s36,v17
v_fma_f32 v45,v45,s36,v17
v_fma_f32 v46,v46,s36,v17
v_fma_f32 v47,v47,s36,v17
v_fma_f32 v48,v48,s36,v18
v_fma_f32 v49,v49,s36,v18
v_fma_f32 v50,v50,s36,v18
v_fma_f32 v51,v51,s36,v18
v_fma_f32 v52,v52,s36,v18
v_fma_f32 v53,v53,s36,v18
v_fma_f32 v54,v54,s36,v18
v_fma_f32 v55,v55,s36,v18
v_exp_f32 v32,v32
v_exp_f32 v33,v33
v_exp_f32 v34,v34
s_waitcnt lgkmcnt(0)
v_mfma_f32_16x16x32_bf16 v[64:67],a[196:199],a[100:103],v[64:67]
buffer_load_dwordx4 v7,s[8:11],s21 offen offset:128 lds
s_add_u32 m0,s23,14080
ds_read_b128 a[200:203],v1 offset:13312
buffer_load_dwordx4 v7,s[8:11],s21 offen offset:256 lds
s_add_u32 s21,s21,12288
s_add_u32 m0,s22,0
ds_read_b128 a[204:207],v2 offset:13312
v_exp_f32 v35,v35
v_exp_f32 v36,v36
v_exp_f32 v37,v37
v_exp_f32 v38,v38
v_exp_f32 v39,v39
v_exp_f32 v40,v40
v_exp_f32 v41,v41
v_exp_f32 v42,v42
v_exp_f32 v43,v43
v_exp_f32 v44,v44
v_exp_f32 v45,v45
v_exp_f32 v46,v46
v_exp_f32 v47,v47
v_exp_f32 v48,v48
v_exp_f32 v49,v49
s_waitcnt lgkmcnt(1)
v_mfma_f32_16x16x32_bf16 v[64:67],a[200:203],a[104:107],v[64:67]
buffer_load_dwordx4 v7,s[4:7],s20 offen offset:0 lds
s_add_u32 m0,s22,896
s_waitcnt lgkmcnt(0)
v_mfma_f32_16x16x32_bf16 v[64:67],a[204:207],a[108:111],v[64:67]
ds_read_b128 a[208:211],v1 offset:14336
v_exp_f32 v50,v50
v_exp_f32 v51,v51
v_exp_f32 v52,v52
v_exp_f32 v53,v53
v_exp_f32 v54,v54
v_exp_f32 v55,v55
v_cvt_pk_bf16_f32 v96,v32,v33
v_cvt_pk_bf16_f32 v97,v34,v35
v_cvt_pk_bf16_f32 v98,v36,v37
v_cvt_pk_bf16_f32 v99,v38,v39
v_cvt_pk_bf16_f32 v100,v40,v41
v_cvt_pk_bf16_f32 v101,v42,v43
v_mfma_f32_16x16x32_bf16 v[128:131],v[24:27],v[96:99],0
ds_read_b128 a[212:215],v2 offset:14336
v_cvt_pk_bf16_f32 v102,v44,v45
v_cvt_pk_bf16_f32 v103,v46,v47
v_cvt_pk_bf16_f32 v104,v48,v49
v_cvt_pk_bf16_f32 v105,v50,v51
v_mfma_f32_16x16x32_bf16 v[132:135],v[24:27],v[100:103],0
ds_read_b128 a[216:219],v1 offset:18432
v_cvt_pk_bf16_f32 v106,v52,v53
v_cvt_pk_bf16_f32 v107,v54,v55
buffer_load_dwordx4 v7,s[4:7],s20 offen offset:128 lds
s_add_u32 m0,s22,1792
v_mfma_f32_16x16x32_bf16 v[136:139],v[24:27],v[104:107],0
s_waitcnt lgkmcnt(2)
ds_read_b128 a[220:223],v2 offset:18432
v_mfma_f32_16x16x32_bf16 v[64:67],a[208:211],a[112:115],v[64:67]
ds_read_b128 a[224:227],v1 offset:19456
ds_read_b128 a[228:231],v2 offset:19456
ds_read_b128 a[232:235],v1 offset:20480
ds_read_b128 a[236:239],v2 offset:20480
s_waitcnt lgkmcnt(6)
v_mfma_f32_16x16x32_bf16 v[64:67],a[212:215],a[116:119],v[64:67]
v_mfma_f32_16x16x32_bf16 v[72:75],a[192:195],a[120:123],0
v_mfma_f32_16x16x32_bf16 v[72:75],a[196:199],a[124:127],v[72:75]
v_mfma_f32_16x16x32_bf16 v[72:75],a[200:203],a[128:131],v[72:75]
buffer_load_dwordx4 v7,s[4:7],s20 offen offset:256 lds
s_add_u32 s20,s20,12288
v_mfma_f32_16x16x32_bf16 v[72:75],a[204:207],a[132:135],v[72:75]
v_mfma_f32_16x16x32_bf16 v[72:75],a[208:211],a[136:139],v[72:75]
v_mfma_f32_16x16x32_bf16 v[72:75],a[212:215],a[140:143],v[72:75]
v_fma_f32 v64,v64,s36,v16
v_fma_f32 v65,v65,s36,v16
v_mfma_f32_16x16x32_bf16 v[80:83],a[192:195],a[144:147],0
v_fma_f32 v66,v66,s36,v16
v_fma_f32 v67,v67,s36,v16
v_mfma_f32_16x16x32_bf16 v[80:83],a[196:199],a[148:151],v[80:83]
v_exp_f32 v64,v64
v_mfma_f32_16x16x32_bf16 v[80:83],a[200:203],a[152:155],v[80:83]
v_fma_f32 v72,v72,s36,v17
v_fma_f32 v73,v73,s36,v17
v_mfma_f32_16x16x32_bf16 v[80:83],a[204:207],a[156:159],v[80:83]
v_fma_f32 v74,v74,s36,v17
v_fma_f32 v75,v75,s36,v17
v_mfma_f32_16x16x32_bf16 v[80:83],a[208:211],a[160:163],v[80:83]
v_exp_f32 v65,v65
v_mfma_f32_16x16x32_bf16 v[80:83],a[212:215],a[164:167],v[80:83]
s_waitcnt lgkmcnt(0)
v_exp_f32 v66,v66
v_mfma_f32_16x16x32_bf16 v[68:71],a[216:219],a[96:99],0
v_exp_f32 v67,v67
v_mfma_f32_16x16x32_bf16 v[68:71],a[220:223],a[100:103],v[68:71]
v_exp_f32 v72,v72
v_mfma_f32_16x16x32_bf16 v[68:71],a[224:227],a[104:107],v[68:71]
s_waitcnt vmcnt(10)
s_barrier
v_exp_f32 v73,v73
v_mfma_f32_16x16x32_bf16 v[68:71],a[228:231],a[108:111],v[68:71]
v_exp_f32 v74,v74
v_mfma_f32_16x16x32_bf16 v[68:71],a[232:235],a[112:115],v[68:71]
ds_read_b64_tr_b16 a[240:241],v3 offset:0
ds_read_b64_tr_b16 a[242:243],v3 offset:6144
v_mfma_f32_16x16x32_bf16 v[68:71],a[236:239],a[116:119],v[68:71]
ds_read_b64_tr_b16 a[244:245],v4 offset:0
ds_read_b64_tr_b16 a[246:247],v4 offset:6144
v_mfma_f32_16x16x32_bf16 v[76:79],a[216:219],a[120:123],0
v_exp_f32 v75,v75
v_mfma_f32_16x16x32_bf16 v[76:79],a[220:223],a[124:127],v[76:79]
ds_read_b64_tr_b16 a[248:249],v5 offset:0
ds_read_b64_tr_b16 a[250:251],v5 offset:6144
v_mfma_f32_16x16x32_bf16 v[76:79],a[224:227],a[128:131],v[76:79]
ds_read_b64_tr_b16 a[252:253],v6 offset:0
ds_read_b64_tr_b16 a[254:255],v6 offset:6144
v_mfma_f32_16x16x32_bf16 v[76:79],a[228:231],a[132:135],v[76:79]
v_cvt_pk_bf16_f32 v112,v64,v65
v_cvt_pk_bf16_f32 v113,v66,v67
v_mfma_f32_16x16x32_bf16 v[76:79],a[232:235],a[136:139],v[76:79]
v_cvt_pk_bf16_f32 v116,v72,v73
v_cvt_pk_bf16_f32 v117,v74,v75
v_mfma_f32_16x16x32_bf16 v[76:79],a[236:239],a[140:143],v[76:79]
v_mfma_f32_16x16x32_bf16 v[84:87],a[216:219],a[144:147],0
v_mfma_f32_16x16x32_bf16 v[84:87],a[220:223],a[148:151],v[84:87]
v_mfma_f32_16x16x32_bf16 v[84:87],a[224:227],a[152:155],v[84:87]
v_mfma_f32_16x16x32_bf16 v[84:87],a[228:231],a[156:159],v[84:87]
v_mfma_f32_16x16x32_bf16 v[84:87],a[232:235],a[160:163],v[84:87]
v_mfma_f32_16x16x32_bf16 v[84:87],a[236:239],a[164:167],v[84:87]
s_waitcnt lgkmcnt(0)
v_mfma_f32_16x16x32_bf16 v[160:163],a[240:243],v[96:99],0
s_add_u32 m0,s23,24576
ds_read_b128 a[192:195],v1 offset:24576
v_fma_f32 v68,v68,s36,v16
v_mfma_f32_16x16x32_bf16 v[208:211],a[240:243],v[100:103],0
buffer_load_dwordx4 v7,s[8:11],s21 offen offset:0 lds
v_mfma_f32_16x16x32_bf16 a[0:3],a[240:243],v[104:107],0
s_add_u32 m0,s23,25472
ds_read_b64_tr_b16 a[240:241],v3 offset:1024
ds_read_b64_tr_b16 a[242:243],v3 offset:7168
v_mfma_f32_16x16x32_bf16 v[164:167],a[244:247],v[96:99],0
ds_read_b128 a[196:199],v2 offset:24576
v_fma_f32 v69,v69,s36,v16
v_mfma_f32_16x16x32_bf16 v[212:215],a[244:247],v[100:103],0
ds_read_b128 a[200:203],v1 offset:25600
v_fma_f32 v70,v70,s36,v16
v_mfma_f32_16x16x32_bf16 a[4:7],a[244:247],v[104:107],0
ds_read_b64_tr_b16 a[244:245],v4 offset:1024
ds_read_b64_tr_b16 a[246:247],v4 offset:7168
v_mfma_f32_16x16x32_bf16 v[168:171],a[248:251],v[96:99],0
ds_read_b128 a[204:207],v2 offset:25600
v_fma_f32 v71,v71,s36,v16
v_mfma_f32_16x16x32_bf16 v[216:219],a[248:251],v[100:103],0
buffer_load_dwordx4 v7,s[8:11],s21 offen offset:128 lds
v_mfma_f32_16x16x32_bf16 a[8:11],a[248:251],v[104:107],0
s_add_u32 m0,s23,26368
ds_read_b64_tr_b16 a[248:249],v5 offset:1024
ds_read_b64_tr_b16 a[250:251],v5 offset:7168
v_mfma_f32_16x16x32_bf16 v[172:175],a[252:255],v[96:99],0
ds_read_b128 a[208:211],v1 offset:26624
v_fma_f32 v76,v76,s36,v17
v_mfma_f32_16x16x32_bf16 v[220:223],a[252:255],v[100:103],0
ds_read_b128 a[212:215],v2 offset:26624
v_fma_f32 v77,v77,s36,v17
v_mfma_f32_16x16x32_bf16 a[12:15],a[252:255],v[104:107],0
s_waitcnt lgkmcnt(8)
ds_read_b64_tr_b16 a[252:253],v6 offset:1024
ds_read_b64_tr_b16 a[254:255],v6 offset:7168
v_mfma_f32_16x16x32_bf16 v[176:179],a[240:243],v[96:99],0
buffer_load_dwordx4 v7,s[8:11],s21 offen offset:256 lds
v_mfma_f32_16x16x32_bf16 v[224:227],a[240:243],v[100:103],0
s_add_u32 s21,s21,12288
ds_read_b128 a[216:219],v1 offset:30720
v_fma_f32 v78,v78,s36,v17
v_mfma_f32_16x16x32_bf16 a[16:19],a[240:243],v[104:107],0
s_add_u32 m0,s22,12288
ds_read_b64_tr_b16 a[240:241],v3 offset:2048
ds_read_b64_tr_b16 a[242:243],v3 offset:8192
s_waitcnt lgkmcnt(9)
v_mfma_f32_16x16x32_bf16 v[180:183],a[244:247],v[96:99],0
ds_read_b128 a[220:223],v2 offset:30720
v_fma_f32 v79,v79,s36,v17
v_mfma_f32_16x16x32_bf16 v[228:231],a[244:247],v[100:103],0
ds_read_b128 a[224:227],v1 offset:31744
v_fma_f32 v80,v80,s36,v18
v_mfma_f32_16x16x32_bf16 a[20:23],a[244:247],v[104:107],0
s_waitcnt lgkmcnt(8)
ds_read_b64_tr_b16 a[244:245],v4 offset:2048
ds_read_b64_tr_b16 a[246:247],v4 offset:8192
v_mfma_f32_16x16x32_bf16 v[184:187],a[248:251],v[96:99],0
buffer_load_dwordx4 v7,s[4:7],s20 offen offset:0 lds
v_mfma_f32_16x16x32_bf16 v[232:235],a[248:251],v[100:103],0
s_add_u32 m0,s22,13184
ds_read_b128 a[228:231],v2 offset:31744
v_fma_f32 v81,v81,s36,v18
v_mfma_f32_16x16x32_bf16 a[24:27],a[248:251],v[104:107],0
s_waitcnt lgkmcnt(8)
ds_read_b64_tr_b16 a[248:249],v5 offset:2048
ds_read_b64_tr_b16 a[250:251],v5 offset:8192
v_mfma_f32_16x16x32_bf16 v[188:191],a[252:255],v[96:99],0
ds_read_b128 a[232:235],v1 offset:32768
v_fma_f32 v82,v82,s36,v18
v_mfma_f32_16x16x32_bf16 v[236:239],a[252:255],v[100:103],0
ds_read_b128 a[236:239],v2 offset:32768
v_fma_f32 v83,v83,s36,v18
v_mfma_f32_16x16x32_bf16 a[28:31],a[252:255],v[104:107],0
s_waitcnt lgkmcnt(8)
ds_read_b64_tr_b16 a[252:253],v6 offset:2048
ds_read_b64_tr_b16 a[254:255],v6 offset:8192
v_mfma_f32_16x16x32_bf16 v[192:195],a[240:243],v[96:99],0
buffer_load_dwordx4 v7,s[4:7],s20 offen offset:128 lds
v_mfma_f32_16x16x32_bf16 v[240:243],a[240:243],v[100:103],0
s_add_u32 m0,s22,14080
v_fma_f32 v84,v84,s36,v18
v_fma_f32 v85,v85,s36,v18
v_mfma_f32_16x16x32_bf16 a[32:35],a[240:243],v[104:107],0
s_waitcnt lgkmcnt(7)
v_fma_f32 v86,v86,s36,v18
v_fma_f32 v87,v87,s36,v18
v_mfma_f32_16x16x32_bf16 v[196:199],a[244:247],v[96:99],0
v_exp_f32 v68,v68
v_mfma_f32_16x16x32_bf16 v[244:247],a[244:247],v[100:103],0
v_exp_f32 v69,v69
v_mfma_f32_16x16x32_bf16 a[36:39],a[244:247],v[104:107],0
s_waitcnt lgkmcnt(3)
v_exp_f32 v70,v70
v_mfma_f32_16x16x32_bf16 v[200:203],a[248:251],v[96:99],0
buffer_load_dwordx4 v7,s[4:7],s20 offen offset:256 lds
v_mfma_f32_16x16x32_bf16 v[248:251],a[248:251],v[100:103],0
s_add_u32 s20,s20,12288
v_exp_f32 v71,v71
v_mfma_f32_16x16x32_bf16 a[40:43],a[248:251],v[104:107],0
s_waitcnt lgkmcnt(0)
v_exp_f32 v76,v76
v_mfma_f32_16x16x32_bf16 v[204:207],a[252:255],v[96:99],0
v_exp_f32 v77,v77
v_mfma_f32_16x16x32_bf16 v[252:255],a[252:255],v[100:103],0
v_exp_f32 v78,v78
v_mfma_f32_16x16x32_bf16 a[44:47],a[252:255],v[104:107],0
v_exp_f32 v79,v79
v_mfma_f32_16x16x32_bf16 v[32:35],a[192:195],a[96:99],0
v_exp_f32 v80,v80
v_mfma_f32_16x16x32_bf16 v[32:35],a[196:199],a[100:103],v[32:35]
v_exp_f32 v81,v81
v_mfma_f32_16x16x32_bf16 v[32:35],a[200:203],a[104:107],v[32:35]
v_exp_f32 v82,v82
v_mfma_f32_16x16x32_bf16 v[32:35],a[204:207],a[108:111],v[32:35]
v_exp_f32 v83,v83
v_mfma_f32_16x16x32_bf16 v[32:35],a[208:211],a[112:115],v[32:35]
v_exp_f32 v84,v84
v_mfma_f32_16x16x32_bf16 v[32:35],a[212:215],a[116:119],v[32:35]
v_exp_f32 v85,v85
v_mfma_f32_16x16x32_bf16 v[40:43],a[192:195],a[120:123],0
v_exp_f32 v86,v86
v_mfma_f32_16x16x32_bf16 v[40:43],a[196:199],a[124:127],v[40:43]
v_exp_f32 v87,v87
v_mfma_f32_16x16x32_bf16 v[40:43],a[200:203],a[128:131],v[40:43]
v_cvt_pk_bf16_f32 v114,v68,v69
v_cvt_pk_bf16_f32 v115,v70,v71
v_mfma_f32_16x16x32_bf16 v[40:43],a[204:207],a[132:135],v[40:43]
v_cvt_pk_bf16_f32 v118,v76,v77
v_cvt_pk_bf16_f32 v119,v78,v79
v_mfma_f32_16x16x32_bf16 v[128:131],v[24:27],v[112:115],v[128:131]
v_cvt_pk_bf16_f32 v120,v80,v81
v_cvt_pk_bf16_f32 v121,v82,v83
v_mfma_f32_16x16x32_bf16 v[132:135],v[24:27],v[116:119],v[132:135]
v_cvt_pk_bf16_f32 v122,v84,v85
v_cvt_pk_bf16_f32 v123,v86,v87
v_mfma_f32_16x16x32_bf16 v[40:43],a[208:211],a[136:139],v[40:43]
v_fma_f32 v32,v32,s36,v16
v_fma_f32 v33,v33,s36,v16
v_mfma_f32_16x16x32_bf16 v[136:139],v[24:27],v[120:123],v[136:139]
v_fma_f32 v34,v34,s36,v16
v_fma_f32 v35,v35,s36,v16
v_mfma_f32_16x16x32_bf16 v[40:43],a[212:215],a[140:143],v[40:43]
v_exp_f32 v32,v32
v_mfma_f32_16x16x32_bf16 v[48:51],a[192:195],a[144:147],0
v_exp_f32 v33,v33
v_mfma_f32_16x16x32_bf16 v[48:51],a[196:199],a[148:151],v[48:51]
v_exp_f32 v34,v34
v_mfma_f32_16x16x32_bf16 v[48:51],a[200:203],a[152:155],v[48:51]
v_exp_f32 v35,v35
v_mfma_f32_16x16x32_bf16 v[48:51],a[204:207],a[156:159],v[48:51]
v_fma_f32 v40,v40,s36,v17
v_fma_f32 v41,v41,s36,v17
v_mfma_f32_16x16x32_bf16 v[48:51],a[208:211],a[160:163],v[48:51]
v_fma_f32 v42,v42,s36,v17
v_fma_f32 v43,v43,s36,v17
v_mfma_f32_16x16x32_bf16 v[48:51],a[212:215],a[164:167],v[48:51]
v_exp_f32 v40,v40
v_mfma_f32_16x16x32_bf16 v[36:39],a[216:219],a[96:99],0
v_exp_f32 v41,v41
v_mfma_f32_16x16x32_bf16 v[36:39],a[220:223],a[100:103],v[36:39]
v_exp_f32 v42,v42
v_mfma_f32_16x16x32_bf16 v[36:39],a[224:227],a[104:107],v[36:39]
v_exp_f32 v43,v43
v_mfma_f32_16x16x32_bf16 v[36:39],a[228:231],a[108:111],v[36:39]
v_cvt_pk_bf16_f32 v96,v32,v33
v_cvt_pk_bf16_f32 v97,v34,v35
s_waitcnt vmcnt(6)
s_barrier
v_mfma_f32_16x16x32_bf16 v[36:39],a[232:235],a[112:115],v[36:39]
v_cvt_pk_bf16_f32 v100,v40,v41
v_cvt_pk_bf16_f32 v101,v42,v43
v_mfma_f32_16x16x32_bf16 v[36:39],a[236:239],a[116:119],v[36:39]
ds_read_b64_tr_b16 a[240:241],v3 offset:12288
ds_read_b64_tr_b16 a[242:243],v3 offset:18432
v_mfma_f32_16x16x32_bf16 v[44:47],a[216:219],a[120:123],0
v_mfma_f32_16x16x32_bf16 v[44:47],a[220:223],a[124:127],v[44:47]
ds_read_b64_tr_b16 a[244:245],v4 offset:12288
ds_read_b64_tr_b16 a[246:247],v4 offset:18432
v_mfma_f32_16x16x32_bf16 v[44:47],a[224:227],a[128:131],v[44:47]
ds_read_b64_tr_b16 a[248:249],v5 offset:12288
ds_read_b64_tr_b16 a[250:251],v5 offset:18432
v_mfma_f32_16x16x32_bf16 v[44:47],a[228:231],a[132:135],v[44:47]
v_mfma_f32_16x16x32_bf16 v[44:47],a[232:235],a[136:139],v[44:47]
ds_read_b64_tr_b16 a[252:253],v6 offset:12288
ds_read_b64_tr_b16 a[254:255],v6 offset:18432
v_mfma_f32_16x16x32_bf16 v[44:47],a[236:239],a[140:143],v[44:47]
v_mfma_f32_16x16x32_bf16 v[52:55],a[216:219],a[144:147],0
v_mfma_f32_16x16x32_bf16 v[52:55],a[220:223],a[148:151],v[52:55]
v_mfma_f32_16x16x32_bf16 v[52:55],a[224:227],a[152:155],v[52:55]
v_mfma_f32_16x16x32_bf16 v[52:55],a[228:231],a[156:159],v[52:55]
v_mfma_f32_16x16x32_bf16 v[52:55],a[232:235],a[160:163],v[52:55]
v_mfma_f32_16x16x32_bf16 v[52:55],a[236:239],a[164:167],v[52:55]
s_waitcnt lgkmcnt(2)
v_mfma_f32_16x16x32_bf16 v[160:163],a[240:243],v[112:115],v[160:163]
s_add_u32 m0,s23,0
ds_read_b128 a[192:195],v1 offset:0
v_fma_f32 v36,v36,s36,v16
v_mfma_f32_16x16x32_bf16 v[208:211],a[240:243],v[116:119],v[208:211]
buffer_load_dwordx4 v7,s[8:11],s21 offen offset:0 lds
v_mfma_f32_16x16x32_bf16 a[0:3],a[240:243],v[120:123],a[0:3]
s_add_u32 m0,s23,896
ds_read_b64_tr_b16 a[240:241],v3 offset:13312
ds_read_b64_tr_b16 a[242:243],v3 offset:19456
v_mfma_f32_16x16x32_bf16 v[164:167],a[244:247],v[112:115],v[164:167]
ds_read_b128 a[196:199],v2 offset:0
v_fma_f32 v37,v37,s36,v16
v_mfma_f32_16x16x32_bf16 v[212:215],a[244:247],v[116:119],v[212:215]
ds_read_b128 a[200:203],v1 offset:1024
v_fma_f32 v38,v38,s36,v16
v_mfma_f32_16x16x32_bf16 a[4:7],a[244:247],v[120:123],a[4:7]
ds_read_b64_tr_b16 a[244:245],v4 offset:13312
ds_read_b64_tr_b16 a[246:247],v4 offset:19456
v_mfma_f32_16x16x32_bf16 v[168:171],a[248:251],v[112:115],v[168:171]
ds_read_b128 a[204:207],v2 offset:1024
v_fma_f32 v39,v39,s36,v16
v_mfma_f32_16x16x32_bf16 v[216:219],a[248:251],v[116:119],v[216:219]
buffer_load_dwordx4 v7,s[8:11],s21 offen offset:128 lds
v_mfma_f32_16x16x32_bf16 a[8:11],a[248:251],v[120:123],a[8:11]
s_add_u32 m0,s23,1792
ds_read_b64_tr_b16 a[248:249],v5 offset:13312
ds_read_b64_tr_b16 a[250:251],v5 offset:19456
s_waitcnt lgkmcnt(9)
v_mfma_f32_16x16x32_bf16 v[172:175],a[252:255],v[112:115],v[172:175]
ds_read_b128 a[208:211],v1 offset:2048
v_fma_f32 v44,v44,s36,v17
v_mfma_f32_16x16x32_bf16 v[220:223],a[252:255],v[116:119],v[220:223]
ds_read_b128 a[212:215],v2 offset:2048
v_fma_f32 v45,v45,s36,v17
v_mfma_f32_16x16x32_bf16 a[12:15],a[252:255],v[120:123],a[12:15]
s_waitcnt lgkmcnt(8)
ds_read_b64_tr_b16 a[252:253],v6 offset:13312
ds_read_b64_tr_b16 a[254:255],v6 offset:19456
v_mfma_f32_16x16x32_bf16 v[176:179],a[240:243],v[112:115],v[176:179]
buffer_load_dwordx4 v7,s[8:11],s21 offen offset:256 lds
v_mfma_f32_16x16x32_bf16 v[224:227],a[240:243],v[116:119],v[224:227]
s_add_u32 s21,s21,12288
ds_read_b128 a[216:219],v1 offset:6144
v_fma_f32 v46,v46,s36,v17
v_mfma_f32_16x16x32_bf16 a[16:19],a[240:243],v[120:123],a[16:19]
s_add_u32 m0,s22,24576
ds_read_b64_tr_b16 a[240:241],v3 offset:14336
ds_read_b64_tr_b16 a[242:243],v3 offset:20480
s_waitcnt lgkmcnt(9)
v_mfma_f32_16x16x32_bf16 v[180:183],a[244:247],v[112:115],v[180:183]
ds_read_b128 a[220:223],v2 offset:6144
v_fma_f32 v47,v47,s36,v17
v_mfma_f32_16x16x32_bf16 v[228:231],a[244:247],v[116:119],v[228:231]
ds_read_b128 a[224:227],v1 offset:7168
v_fma_f32 v48,v48,s36,v18
v_mfma_f32_16x16x32_bf16 a[20:23],a[244:247],v[120:123],a[20:23]
s_waitcnt lgkmcnt(8)
ds_read_b64_tr_b16 a[244:245],v4 offset:14336
ds_read_b64_tr_b16 a[246:247],v4 offset:20480
v_mfma_f32_16x16x32_bf16 v[184:187],a[248:251],v[112:115],v[184:187]
buffer_load_dwordx4 v7,s[4:7],s20 offen offset:0 lds
v_mfma_f32_16x16x32_bf16 v[232:235],a[248:251],v[116:119],v[232:235]
s_add_u32 m0,s22,25472
ds_read_b128 a[228:231],v2 offset:7168
v_fma_f32 v49,v49,s36,v18
v_mfma_f32_16x16x32_bf16 a[24:27],a[248:251],v[120:123],a[24:27]
s_waitcnt lgkmcnt(8)
ds_read_b64_tr_b16 a[248:249],v5 offset:14336
ds_read_b64_tr_b16 a[250:251],v5 offset:20480
v_mfma_f32_16x16x32_bf16 v[188:191],a[252:255],v[112:115],v[188:191]
ds_read_b128 a[232:235],v1 offset:8192
v_fma_f32 v50,v50,s36,v18
v_mfma_f32_16x16x32_bf16 v[236:239],a[252:255],v[116:119],v[236:239]
ds_read_b128 a[236:239],v2 offset:8192
v_fma_f32 v51,v51,s36,v18
v_mfma_f32_16x16x32_bf16 a[28:31],a[252:255],v[120:123],a[28:31]
s_waitcnt lgkmcnt(8)
ds_read_b64_tr_b16 a[252:253],v6 offset:14336
ds_read_b64_tr_b16 a[254:255],v6 offset:20480
v_mfma_f32_16x16x32_bf16 v[192:195],a[240:243],v[112:115],v[192:195]
buffer_load_dwordx4 v7,s[4:7],s20 offen offset:128 lds
v_mfma_f32_16x16x32_bf16 v[240:243],a[240:243],v[116:119],v[240:243]
s_add_u32 m0,s22,26368
v_fma_f32 v52,v52,s36,v18
v_fma_f32 v53,v53,s36,v18
v_mfma_f32_16x16x32_bf16 a[32:35],a[240:243],v[120:123],a[32:35]
s_waitcnt lgkmcnt(7)
v_fma_f32 v54,v54,s36,v18
v_fma_f32 v55,v55,s36,v18
v_mfma_f32_16x16x32_bf16 v[196:199],a[244:247],v[112:115],v[196:199]
v_exp_f32 v36,v36
v_mfma_f32_16x16x32_bf16 v[244:247],a[244:247],v[116:119],v[244:247]
v_exp_f32 v37,v37
v_mfma_f32_16x16x32_bf16 a[36:39],a[244:247],v[120:123],a[36:39]
s_waitcnt lgkmcnt(3)
v_exp_f32 v38,v38
v_mfma_f32_16x16x32_bf16 v[200:203],a[248:251],v[112:115],v[200:203]
buffer_load_dwordx4 v7,s[4:7],s20 offen offset:256 lds
v_mfma_f32_16x16x32_bf16 v[248:251],a[248:251],v[116:119],v[248:251]
s_add_u32 s20,s20,12288
v_exp_f32 v39,v39
v_mfma_f32_16x16x32_bf16 a[40:43],a[248:251],v[120:123],a[40:43]
s_waitcnt lgkmcnt(0)
v_exp_f32 v44,v44
v_mfma_f32_16x16x32_bf16 v[204:207],a[252:255],v[112:115],v[204:207]
v_exp_f32 v45,v45
v_mfma_f32_16x16x32_bf16 v[252:255],a[252:255],v[116:119],v[252:255]
v_exp_f32 v46,v46
v_mfma_f32_16x16x32_bf16 a[44:47],a[252:255],v[120:123],a[44:47]
v_exp_f32 v47,v47
v_mfma_f32_16x16x32_bf16 v[64:67],a[192:195],a[96:99],0
v_exp_f32 v48,v48
v_mfma_f32_16x16x32_bf16 v[64:67],a[196:199],a[100:103],v[64:67]
v_exp_f32 v49,v49
v_mfma_f32_16x16x32_bf16 v[64:67],a[200:203],a[104:107],v[64:67]
v_exp_f32 v50,v50
v_mfma_f32_16x16x32_bf16 v[64:67],a[204:207],a[108:111],v[64:67]
v_exp_f32 v51,v51
v_mfma_f32_16x16x32_bf16 v[64:67],a[208:211],a[112:115],v[64:67]
v_exp_f32 v52,v52
v_mfma_f32_16x16x32_bf16 v[64:67],a[212:215],a[116:119],v[64:67]
v_exp_f32 v53,v53
v_mfma_f32_16x16x32_bf16 v[72:75],a[192:195],a[120:123],0
v_exp_f32 v54,v54
v_mfma_f32_16x16x32_bf16 v[72:75],a[196:199],a[124:127],v[72:75]
v_exp_f32 v55,v55
v_mfma_f32_16x16x32_bf16 v[72:75],a[200:203],a[128:131],v[72:75]
v_cvt_pk_bf16_f32 v98,v36,v37
v_cvt_pk_bf16_f32 v99,v38,v39
v_mfma_f32_16x16x32_bf16 v[72:75],a[204:207],a[132:135],v[72:75]
v_cvt_pk_bf16_f32 v102,v44,v45
v_cvt_pk_bf16_f32 v103,v46,v47
v_mfma_f32_16x16x32_bf16 v[128:131],v[24:27],v[96:99],v[128:131]
v_cvt_pk_bf16_f32 v104,v48,v49
v_cvt_pk_bf16_f32 v105,v50,v51
v_mfma_f32_16x16x32_bf16 v[132:135],v[24:27],v[100:103],v[132:135]
v_cvt_pk_bf16_f32 v106,v52,v53
v_cvt_pk_bf16_f32 v107,v54,v55
v_mfma_f32_16x16x32_bf16 v[72:75],a[208:211],a[136:139],v[72:75]
v_fma_f32 v64,v64,s36,v16
v_fma_f32 v65,v65,s36,v16
v_mfma_f32_16x16x32_bf16 v[136:139],v[24:27],v[104:107],v[136:139]
v_fma_f32 v66,v66,s36,v16
v_fma_f32 v67,v67,s36,v16
v_mfma_f32_16x16x32_bf16 v[72:75],a[212:215],a[140:143],v[72:75]
v_exp_f32 v64,v64
v_mfma_f32_16x16x32_bf16 v[80:83],a[192:195],a[144:147],0
v_exp_f32 v65,v65
v_mfma_f32_16x16x32_bf16 v[80:83],a[196:199],a[148:151],v[80:83]
v_exp_f32 v66,v66
v_mfma_f32_16x16x32_bf16 v[80:83],a[200:203],a[152:155],v[80:83]
v_exp_f32 v67,v67
v_mfma_f32_16x16x32_bf16 v[80:83],a[204:207],a[156:159],v[80:83]
v_fma_f32 v72,v72,s36,v17
v_fma_f32 v73,v73,s36,v17
v_mfma_f32_16x16x32_bf16 v[80:83],a[208:211],a[160:163],v[80:83]
v_fma_f32 v74,v74,s36,v17
v_fma_f32 v75,v75,s36,v17
v_mfma_f32_16x16x32_bf16 v[80:83],a[212:215],a[164:167],v[80:83]
v_exp_f32 v72,v72
v_mfma_f32_16x16x32_bf16 v[68:71],a[216:219],a[96:99],0
v_exp_f32 v73,v73
v_mfma_f32_16x16x32_bf16 v[68:71],a[220:223],a[100:103],v[68:71]
v_exp_f32 v74,v74
v_mfma_f32_16x16x32_bf16 v[68:71],a[224:227],a[104:107],v[68:71]
v_exp_f32 v75,v75
v_mfma_f32_16x16x32_bf16 v[68:71],a[228:231],a[108:111],v[68:71]
v_cvt_pk_bf16_f32 v112,v64,v65
v_cvt_pk_bf16_f32 v113,v66,v67
s_waitcnt vmcnt(6)
s_barrier
v_mfma_f32_16x16x32_bf16 v[68:71],a[232:235],a[112:115],v[68:71]
v_cvt_pk_bf16_f32 v116,v72,v73
v_cvt_pk_bf16_f32 v117,v74,v75
v_mfma_f32_16x16x32_bf16 v[68:71],a[236:239],a[116:119],v[68:71]
ds_read_b64_tr_b16 a[240:241],v3 offset:24576
ds_read_b64_tr_b16 a[242:243],v3 offset:30720
v_mfma_f32_16x16x32_bf16 v[76:79],a[216:219],a[120:123],0
v_mfma_f32_16x16x32_bf16 v[76:79],a[220:223],a[124:127],v[76:79]
ds_read_b64_tr_b16 a[244:245],v4 offset:24576
ds_read_b64_tr_b16 a[246:247],v4 offset:30720
v_mfma_f32_16x16x32_bf16 v[76:79],a[224:227],a[128:131],v[76:79]
ds_read_b64_tr_b16 a[248:249],v5 offset:24576
ds_read_b64_tr_b16 a[250:251],v5 offset:30720
v_mfma_f32_16x16x32_bf16 v[76:79],a[228:231],a[132:135],v[76:79]
v_mfma_f32_16x16x32_bf16 v[76:79],a[232:235],a[136:139],v[76:79]
ds_read_b64_tr_b16 a[252:253],v6 offset:24576
ds_read_b64_tr_b16 a[254:255],v6 offset:30720
v_mfma_f32_16x16x32_bf16 v[76:79],a[236:239],a[140:143],v[76:79]
v_mfma_f32_16x16x32_bf16 v[84:87],a[216:219],a[144:147],0
v_mfma_f32_16x16x32_bf16 v[84:87],a[220:223],a[148:151],v[84:87]
v_mfma_f32_16x16x32_bf16 v[84:87],a[224:227],a[152:155],v[84:87]
v_mfma_f32_16x16x32_bf16 v[84:87],a[228:231],a[156:159],v[84:87]
v_mfma_f32_16x16x32_bf16 v[84:87],a[232:235],a[160:163],v[84:87]
v_mfma_f32_16x16x32_bf16 v[84:87],a[236:239],a[164:167],v[84:87]
s_mov_b32 s38,0
s_branch L_loop3
L_tr44:
s_waitcnt vmcnt(36)
s_waitcnt lgkmcnt(4)
v_mfma_f32_16x16x32_bf16 v[160:163],a[240:243],v[96:99],v[160:163]
s_add_u32 m0,s24,0
ds_read_b128 a[96:99],v28 offset:0
v_fma_f32 v68,v68,s36,v16
v_mfma_f32_16x16x32_bf16 v[208:211],a[240:243],v[100:103],v[208:211]
ds_read_b128 a[100:103],v29 offset:0
v_fma_f32 v69,v69,s36,v16
v_mfma_f32_16x16x32_bf16 a[0:3],a[240:243],v[104:107],a[0:3]
ds_read_b128 a[104:107],v28 offset:1024
v_fma_f32 v70,v70,s36,v16
v_mfma_f32_16x16x32_bf16 a[48:51],a[240:243],v[108:111],a[48:51]
ds_read_b128 a[108:111],v29 offset:1024
v_fma_f32 v71,v71,s36,v16
v_mfma_f32_16x16x32_bf16 v[164:167],a[244:247],v[96:99],v[164:167]
ds_read_b128 a[112:115],v28 offset:2048
v_fma_f32 v76,v76,s36,v17
v_mfma_f32_16x16x32_bf16 v[212:215],a[244:247],v[100:103],v[212:215]
ds_read_b128 a[116:119],v29 offset:2048
v_fma_f32 v77,v77,s36,v17
v_mfma_f32_16x16x32_bf16 a[4:7],a[244:247],v[104:107],a[4:7]
ds_read_b64_tr_b16 a[240:241],v3 offset:25600
ds_read_b64_tr_b16 a[242:243],v3 offset:31744
v_mfma_f32_16x16x32_bf16 a[52:55],a[244:247],v[108:111],a[52:55]
s_waitcnt lgkmcnt(8)
ds_read_b64_tr_b16 a[244:245],v4 offset:25600
ds_read_b64_tr_b16 a[246:247],v4 offset:31744
v_mfma_f32_16x16x32_bf16 v[168:171],a[248:251],v[96:99],v[168:171]
ds_read_b128 a[192:195],v13 offset:0
v_fma_f32 v78,v78,s36,v17
v_mfma_f32_16x16x32_bf16 v[216:219],a[248:251],v[100:103],v[216:219]
ds_read_b128 a[196:199],v14 offset:0
v_fma_f32 v79,v79,s36,v17
v_mfma_f32_16x16x32_bf16 a[8:11],a[248:251],v[104:107],a[8:11]
ds_read_b128 a[200:203],v13 offset:1024
v_fma_f32 v80,v80,s36,v18
v_mfma_f32_16x16x32_bf16 a[56:59],a[248:251],v[108:111],a[56:59]
ds_read_b64_tr_b16 a[248:249],v5 offset:25600
ds_read_b64_tr_b16 a[250:251],v5 offset:31744
v_mfma_f32_16x16x32_bf16 v[172:175],a[252:255],v[96:99],v[172:175]
ds_read_b128 a[204:207],v14 offset:1024
v_fma_f32 v81,v81,s36,v18
v_mfma_f32_16x16x32_bf16 v[220:223],a[252:255],v[100:103],v[220:223]
ds_read_b128 a[208:211],v13 offset:2048
v_fma_f32 v82,v82,s36,v18
v_mfma_f32_16x16x32_bf16 a[12:15],a[252:255],v[104:107],a[12:15]
s_waitcnt lgkmcnt(11)
buffer_load_dwordx4 v8,s[12:15],s28 offen offset:0 nt lds
s_add_u32 m0,s24,896
v_mfma_f32_16x16x32_bf16 a[60:63],a[252:255],v[108:111],a[60:63]
s_waitcnt lgkmcnt(7)
ds_read_b64_tr_b16 a[252:253],v6 offset:25600
ds_read_b64_tr_b16 a[254:255],v6 offset:31744
v_mfma_f32_16x16x32_bf16 v[176:179],a[240:243],v[96:99],v[176:179]
ds_read_b128 a[212:215],v14 offset:2048
v_fma_f32 v83,v83,s36,v18
v_mfma_f32_16x16x32_bf16 v[224:227],a[240:243],v[100:103],v[224:227]
ds_read_b128 a[216:219],v13 offset:45056
v_fma_f32 v84,v84,s36,v18
v_mfma_f32_16x16x32_bf16 a[16:19],a[240:243],v[104:107],a[16:19]
ds_read_b128 a[220:223],v14 offset:45056
v_fma_f32 v85,v85,s36,v18
v_mfma_f32_16x16x32_bf16 a[64:67],a[240:243],v[108:111],a[64:67]
ds_read_b64_tr_b16 a[240:241],v3 offset:26624
ds_read_b64_tr_b16 a[242:243],v3 offset:32768
v_mfma_f32_16x16x32_bf16 v[180:183],a[244:247],v[96:99],v[180:183]
ds_read_b128 a[224:227],v13 offset:46080
v_fma_f32 v86,v86,s36,v18
v_mfma_f32_16x16x32_bf16 v[228:231],a[244:247],v[100:103],v[228:231]
buffer_load_dwordx4 v8,s[12:15],s28 offen offset:128 nt lds
s_add_u32 m0,s24,1792
v_mfma_f32_16x16x32_bf16 a[20:23],a[244:247],v[104:107],a[20:23]
ds_read_b128 a[228:231],v14 offset:46080
v_fma_f32 v87,v87,s36,v18
v_mfma_f32_16x16x32_bf16 a[68:71],a[244:247],v[108:111],a[68:71]
s_waitcnt lgkmcnt(7)
ds_read_b64_tr_b16 a[244:245],v4 offset:26624
ds_read_b64_tr_b16 a[246:247],v4 offset:32768
v_mfma_f32_16x16x32_bf16 v[184:187],a[248:251],v[96:99],v[184:187]
ds_read_b128 a[232:235],v13 offset:47104
v_fma_f32 v88,v88,s36,v19
v_mfma_f32_16x16x32_bf16 v[232:235],a[248:251],v[100:103],v[232:235]
ds_read_b128 a[236:239],v14 offset:47104
v_fma_f32 v89,v89,s36,v19
v_mfma_f32_16x16x32_bf16 a[24:27],a[248:251],v[104:107],a[24:27]
ds_read_b128 a[120:123],v28 offset:6144
v_fma_f32 v90,v90,s36,v19
v_mfma_f32_16x16x32_bf16 a[72:75],a[248:251],v[108:111],a[72:75]
ds_read_b64_tr_b16 a[248:249],v5 offset:26624
ds_read_b64_tr_b16 a[250:251],v5 offset:32768
v_mfma_f32_16x16x32_bf16 v[188:191],a[252:255],v[96:99],v[188:191]
ds_read_b128 a[124:127],v29 offset:6144
v_fma_f32 v91,v91,s36,v19
v_mfma_f32_16x16x32_bf16 v[236:239],a[252:255],v[100:103],v[236:239]
ds_read_b128 a[128:131],v28 offset:7168
v_fma_f32 v92,v92,s36,v19
v_mfma_f32_16x16x32_bf16 a[28:31],a[252:255],v[104:107],a[28:31]
buffer_load_dwordx4 v8,s[12:15],s28 offen offset:256 nt lds
s_add_u32 s28,s28,3072
s_add_u32 m0,s24,3072
v_mfma_f32_16x16x32_bf16 a[76:79],a[252:255],v[108:111],a[76:79]
s_waitcnt lgkmcnt(7)
ds_read_b64_tr_b16 a[252:253],v6 offset:26624
ds_read_b64_tr_b16 a[254:255],v6 offset:32768
v_mfma_f32_16x16x32_bf16 v[192:195],a[240:243],v[96:99],v[192:195]
ds_read_b128 a[132:135],v29 offset:7168
v_fma_f32 v93,v93,s36,v19
v_mfma_f32_16x16x32_bf16 v[240:243],a[240:243],v[100:103],v[240:243]
ds_read_b128 a[136:139],v28 offset:8192
v_fma_f32 v94,v94,s36,v19
v_mfma_f32_16x16x32_bf16 a[32:35],a[240:243],v[104:107],a[32:35]
ds_read_b128 a[140:143],v29 offset:8192
v_fma_f32 v95,v95,s36,v19
v_mfma_f32_16x16x32_bf16 a[80:83],a[240:243],v[108:111],a[80:83]
v_exp_f32 v68,v68
v_mfma_f32_16x16x32_bf16 v[196:199],a[244:247],v[96:99],v[196:199]
v_exp_f32 v69,v69
v_mfma_f32_16x16x32_bf16 v[244:247],a[244:247],v[100:103],v[244:247]
v_exp_f32 v70,v70
v_mfma_f32_16x16x32_bf16 a[36:39],a[244:247],v[104:107],a[36:39]
v_exp_f32 v71,v71
v_mfma_f32_16x16x32_bf16 a[84:87],a[244:247],v[108:111],a[84:87]
s_waitcnt lgkmcnt(4)
v_exp_f32 v76,v76
v_mfma_f32_16x16x32_bf16 v[200:203],a[248:251],v[96:99],v[200:203]
buffer_load_dwordx4 v9,s[12:15],s28 offen offset:0 nt lds
s_add_u32 m0,s24,3968
v_mfma_f32_16x16x32_bf16 v[248:251],a[248:251],v[100:103],v[248:251]
v_exp_f32 v77,v77
v_mfma_f32_16x16x32_bf16 a[40:43],a[248:251],v[104:107],a[40:43]
v_exp_f32 v78,v78
v_mfma_f32_16x16x32_bf16 a[88:91],a[248:251],v[108:111],a[88:91]
s_waitcnt lgkmcnt(0)
v_exp_f32 v79,v79
v_mfma_f32_16x16x32_bf16 v[204:207],a[252:255],v[96:99],v[204:207]
v_exp_f32 v80,v80
v_mfma_f32_16x16x32_bf16 v[252:255],a[252:255],v[100:103],v[252:255]
v_exp_f32 v81,v81
v_mfma_f32_16x16x32_bf16 a[44:47],a[252:255],v[104:107],a[44:47]
v_exp_f32 v82,v82
v_mfma_f32_16x16x32_bf16 a[92:95],a[252:255],v[108:111],a[92:95]
v_exp_f32 v83,v83
v_exp_f32 v84,v84
v_exp_f32 v85,v85
v_exp_f32 v86,v86
v_exp_f32 v87,v87
v_exp_f32 v88,v88
v_exp_f32 v89,v89
v_exp_f32 v90,v90
v_exp_f32 v91,v91
v_exp_f32 v92,v92
v_exp_f32 v93,v93
v_exp_f32 v94,v94
v_exp_f32 v95,v95
v_cvt_pk_bf16_f32 v114,v68,v69
v_cvt_pk_bf16_f32 v115,v70,v71
v_cvt_pk_bf16_f32 v118,v76,v77
v_cvt_pk_bf16_f32 v119,v78,v79
v_mfma_f32_16x16x32_bf16 v[128:131],v[24:27],v[112:115],v[128:131]
buffer_load_dwordx4 v9,s[12:15],s28 offen offset:128 nt lds
s_add_u32 m0,s24,4864
v_mfma_f32_16x16x32_bf16 v[132:135],v[24:27],v[116:119],v[132:135]
v_cvt_pk_bf16_f32 v120,v80,v81
v_cvt_pk_bf16_f32 v121,v82,v83
v_cvt_pk_bf16_f32 v122,v84,v85
v_cvt_pk_bf16_f32 v123,v86,v87
v_cvt_pk_bf16_f32 v124,v88,v89
v_cvt_pk_bf16_f32 v125,v90,v91
v_mfma_f32_16x16x32_bf16 v[136:139],v[24:27],v[120:123],v[136:139]
buffer_load_dwordx4 v9,s[12:15],s28 offen offset:256 nt lds
s_waitcnt vmcnt(11)
s_barrier
ds_read_b64_tr_b16 a[240:241],v3 offset:0
ds_read_b64_tr_b16 a[242:243],v3 offset:6144
ds_read_b64_tr_b16 a[244:245],v4 offset:0
v_cvt_pk_bf16_f32 v126,v92,v93
v_cvt_pk_bf16_f32 v127,v94,v95
s_add_u32 s28,s28,3072
ds_read_b64_tr_b16 a[246:247],v4 offset:6144
v_mfma_f32_16x16x32_bf16 v[140:143],v[24:27],v[124:127],v[140:143]
ds_read_b64_tr_b16 a[248:249],v5 offset:0
ds_read_b64_tr_b16 a[250:251],v5 offset:6144
ds_read_b64_tr_b16 a[252:253],v6 offset:0
ds_read_b64_tr_b16 a[254:255],v6 offset:6144
s_waitcnt lgkmcnt(6)
v_mfma_f32_16x16x32_bf16 v[160:163],a[240:243],v[112:115],v[160:163]
s_add_u32 s87,s42,18432
v_rcp_f32 v146,v132
v_mfma_f32_16x16x32_bf16 v[208:211],a[240:243],v[116:119],v[208:211]
v_rcp_f32 v150,v140
v_mfma_f32_16x16x32_bf16 a[0:3],a[240:243],v[120:123],a[0:3]
v_rcp_f32 v148,v136
v_mfma_f32_16x16x32_bf16 a[48:51],a[240:243],v[124:127],a[48:51]
s_waitcnt lgkmcnt(4)
ds_read_b64_tr_b16 a[240:241],v3 offset:1024
ds_read_b64_tr_b16 a[242:243],v3 offset:7168
v_mfma_f32_16x16x32_bf16 v[164:167],a[244:247],v[112:115],v[164:167]
v_rcp_f32 v144,v128
v_mfma_f32_16x16x32_bf16 v[212:215],a[244:247],v[116:119],v[212:215]
v_max3_f32 v30,v128,v132,v136
v_max_f32 v30,v30,v140
v_mfma_f32_16x16x32_bf16 a[4:7],a[244:247],v[120:123],a[4:7]
v_accvgpr_read_b32 v64,a48
v_accvgpr_read_b32 v65,a49
v_mfma_f32_16x16x32_bf16 a[52:55],a[244:247],v[124:127],a[52:55]
ds_read_b64_tr_b16 a[244:245],v4 offset:1024
ds_read_b64_tr_b16 a[246:247],v4 offset:7168
v_accvgpr_read_b32 v66,a50
v_accvgpr_read_b32 v67,a51
v_cmp_nlt_f32 vcc,v30,v31
v_pk_mul_f32 v[64:65],v[64:65],v[150:151] op_sel_hi:[1,0]
v_pk_mul_f32 v[208:209],v[208:209],v[146:147] op_sel_hi:[1,0]
v_pk_mul_f32 v[210:211],v[210:211],v[146:147] op_sel_hi:[1,0]
v_pk_mul_f32 v[66:67],v[66:67],v[150:151] op_sel_hi:[1,0]
v_accvgpr_read_b32 v68,a52
v_accvgpr_read_b32 v69,a53
s_waitcnt lgkmcnt(4)
v_mfma_f32_16x16x32_bf16 v[168:171],a[248:251],v[112:115],v[168:171]
s_cmp_lg_u64 vcc,0
v_accvgpr_read_b32 v70,a54
v_accvgpr_read_b32 v71,a55
v_mfma_f32_16x16x32_bf16 v[216:219],a[248:251],v[116:119],v[216:219]
s_cselect_b32 s62,s32,0
v_cvt_pk_bf16_f32 v80,v64,v65
v_cvt_pk_bf16_f32 v81,v66,v67
v_mfma_f32_16x16x32_bf16 a[8:11],a[248:251],v[120:123],a[8:11]
s_or_b32 s31,s31,s62
v_cvt_pk_bf16_f32 v82,v208,v209
v_cvt_pk_bf16_f32 v83,v210,v211
v_mfma_f32_16x16x32_bf16 a[56:59],a[248:251],v[124:127],a[56:59]
s_lshl_b32 s32,s32,1
ds_read_b64_tr_b16 a[248:249],v5 offset:1024
ds_read_b64_tr_b16 a[250:251],v5 offset:7168
ds_write2st64_b64 v12,v[80:81],v[82:83] offset0:36 offset1:12
s_add_u32 m0,s22,24576
v_pk_mul_f32 v[68:69],v[68:69],v[150:151] op_sel_hi:[1,0]
v_pk_mul_f32 v[70:71],v[70:71],v[150:151] op_sel_hi:[1,0]
v_pk_mul_f32 v[212:213],v[212:213],v[146:147] op_sel_hi:[1,0]
v_pk_mul_f32 v[214:215],v[214:215],v[146:147] op_sel_hi:[1,0]
v_accvgpr_read_b32 v72,a56
v_accvgpr_read_b32 v73,a57
v_mfma_f32_16x16x32_bf16 v[172:175],a[252:255],v[112:115],v[172:175]
buffer_load_dwordx4 v7,s[4:7],s20 offen offset:0 lds
s_add_u32 m0,s22,25472
v_mfma_f32_16x16x32_bf16 v[220:223],a[252:255],v[116:119],v[220:223]
v_accvgpr_read_b32 v74,a58
v_accvgpr_read_b32 v75,a59
v_mfma_f32_16x16x32_bf16 a[12:15],a[252:255],v[120:123],a[12:15]
v_cvt_pk_bf16_f32 v84,v68,v69
v_cvt_pk_bf16_f32 v85,v70,v71
v_mfma_f32_16x16x32_bf16 a[60:63],a[252:255],v[124:127],a[60:63]
ds_read_b64_tr_b16 a[252:253],v6 offset:1024
ds_read_b64_tr_b16 a[254:255],v6 offset:7168
v_cvt_pk_bf16_f32 v86,v212,v213
v_cvt_pk_bf16_f32 v87,v214,v215
v_subrev_u32 v11,18432,v11
v_pk_mul_f32 v[72:73],v[72:73],v[150:151] op_sel_hi:[1,0]
v_pk_mul_f32 v[74:75],v[74:75],v[150:151] op_sel_hi:[1,0]
v_pk_mul_f32 v[216:217],v[216:217],v[146:147] op_sel_hi:[1,0]
v_pk_mul_f32 v[218:219],v[218:219],v[146:147] op_sel_hi:[1,0]
v_accvgpr_read_b32 v76,a60
v_accvgpr_read_b32 v77,a61
s_waitcnt lgkmcnt(2)
v_mfma_f32_16x16x32_bf16 v[176:179],a[240:243],v[112:115],v[176:179]
ds_write2st64_b64 v20,v[84:85],v[86:87] offset0:36 offset1:12
v_mfma_f32_16x16x32_bf16 v[224:227],a[240:243],v[116:119],v[224:227]
v_accvgpr_read_b32 v78,a62
v_accvgpr_read_b32 v79,a63
v_mfma_f32_16x16x32_bf16 a[16:19],a[240:243],v[120:123],a[16:19]
v_cvt_pk_bf16_f32 v88,v72,v73
v_cvt_pk_bf16_f32 v89,v74,v75
v_cvt_pk_bf16_f32 v90,v216,v217
v_cvt_pk_bf16_f32 v91,v218,v219
v_pk_mul_f32 v[76:77],v[76:77],v[150:151] op_sel_hi:[1,0]
v_pk_mul_f32 v[78:79],v[78:79],v[150:151] op_sel_hi:[1,0]
v_pk_mul_f32 v[220:221],v[220:221],v[146:147] op_sel_hi:[1,0]
v_pk_mul_f32 v[222:223],v[222:223],v[146:147] op_sel_hi:[1,0]
v_cvt_pk_bf16_f32 v92,v76,v77
v_cvt_pk_bf16_f32 v93,v78,v79
v_mfma_f32_16x16x32_bf16 a[64:67],a[240:243],v[124:127],a[64:67]
buffer_load_dwordx4 v7,s[4:7],s20 offen offset:128 lds
s_add_u32 m0,s22,26368
v_mfma_f32_16x16x32_bf16 v[180:183],a[244:247],v[112:115],v[180:183]
ds_read_b64_tr_b16 a[240:241],v3 offset:2048
ds_read_b64_tr_b16 a[242:243],v3 offset:8192
v_mfma_f32_16x16x32_bf16 v[228:231],a[244:247],v[116:119],v[228:231]
ds_write2st64_b64 v21,v[88:89],v[90:91] offset0:36 offset1:12
v_mfma_f32_16x16x32_bf16 a[20:23],a[244:247],v[120:123],a[20:23]
v_accvgpr_read_b32 v64,a64
v_accvgpr_read_b32 v65,a65
v_accvgpr_read_b32 v66,a66
v_accvgpr_read_b32 v67,a67
v_cvt_pk_bf16_f32 v94,v220,v221
v_pk_mul_f32 v[224:225],v[224:225],v[146:147] op_sel_hi:[1,0]
v_pk_mul_f32 v[226:227],v[226:227],v[146:147] op_sel_hi:[1,0]
v_pk_mul_f32 v[64:65],v[64:65],v[150:151] op_sel_hi:[1,0]
v_pk_mul_f32 v[66:67],v[66:67],v[150:151] op_sel_hi:[1,0]
v_cvt_pk_bf16_f32 v80,v64,v65
v_cvt_pk_bf16_f32 v81,v66,v67
v_mfma_f32_16x16x32_bf16 a[68:71],a[244:247],v[124:127],a[68:71]
ds_read_b64_tr_b16 a[244:245],v4 offset:2048
ds_read_b64_tr_b16 a[246:247],v4 offset:8192
v_mfma_f32_16x16x32_bf16 v[184:187],a[248:251],v[112:115],v[184:187]
v_cvt_pk_bf16_f32 v95,v222,v223
v_cvt_pk_bf16_f32 v82,v224,v225
v_mfma_f32_16x16x32_bf16 v[232:235],a[248:251],v[116:119],v[232:235]
ds_write2st64_b64 v22,v[92:93],v[94:95] offset0:36 offset1:12
v_mfma_f32_16x16x32_bf16 a[24:27],a[248:251],v[120:123],a[24:27]
v_accvgpr_read_b32 v68,a68
v_accvgpr_read_b32 v69,a69
v_accvgpr_read_b32 v70,a70
v_accvgpr_read_b32 v71,a71
v_cvt_pk_bf16_f32 v83,v226,v227
v_pk_mul_f32 v[228:229],v[228:229],v[146:147] op_sel_hi:[1,0]
v_pk_mul_f32 v[230:231],v[230:231],v[146:147] op_sel_hi:[1,0]
v_pk_mul_f32 v[68:69],v[68:69],v[150:151] op_sel_hi:[1,0]
v_pk_mul_f32 v[70:71],v[70:71],v[150:151] op_sel_hi:[1,0]
v_cvt_pk_bf16_f32 v84,v68,v69
v_cvt_pk_bf16_f32 v85,v70,v71
v_mfma_f32_16x16x32_bf16 a[72:75],a[248:251],v[124:127],a[72:75]
buffer_load_dwordx4 v7,s[4:7],s20 offen offset:256 lds
s_add_u32 s20,s20,12288
s_add_u32 m0,s23,0
s_waitcnt lgkmcnt(3)
v_mfma_f32_16x16x32_bf16 v[188:191],a[252:255],v[112:115],v[188:191]
ds_read_b64_tr_b16 a[248:249],v5 offset:2048
ds_read_b64_tr_b16 a[250:251],v5 offset:8192
v_mfma_f32_16x16x32_bf16 v[236:239],a[252:255],v[116:119],v[236:239]
ds_read_b128 v[152:155],v15 offset:18432
v_accvgpr_read_b32 v72,a72
v_mfma_f32_16x16x32_bf16 a[28:31],a[252:255],v[120:123],a[28:31]
ds_read_b128 v[156:159],v15 offset:21504
v_accvgpr_read_b32 v73,a73
v_accvgpr_read_b32 v74,a74
v_accvgpr_read_b32 v75,a75
v_cvt_pk_bf16_f32 v86,v228,v229
v_pk_mul_f32 v[232:233],v[232:233],v[146:147] op_sel_hi:[1,0]
v_pk_mul_f32 v[234:235],v[234:235],v[146:147] op_sel_hi:[1,0]
v_pk_mul_f32 v[72:73],v[72:73],v[150:151] op_sel_hi:[1,0]
v_pk_mul_f32 v[74:75],v[74:75],v[150:151] op_sel_hi:[1,0]
v_cvt_pk_bf16_f32 v88,v72,v73
v_cvt_pk_bf16_f32 v89,v74,v75
v_mfma_f32_16x16x32_bf16 a[76:79],a[252:255],v[124:127],a[76:79]
ds_read_b64_tr_b16 a[252:253],v6 offset:2048
ds_read_b64_tr_b16 a[254:255],v6 offset:8192
v_mfma_f32_16x16x32_bf16 v[192:195],a[240:243],v[112:115],v[192:195]
ds_write2st64_b64 v12,v[80:81],v[82:83] offset0:36 offset1:14
v_mfma_f32_16x16x32_bf16 v[240:243],a[240:243],v[116:119],v[240:243]
v_cvt_pk_bf16_f32 v87,v230,v231
v_cvt_pk_bf16_f32 v90,v232,v233
v_mfma_f32_16x16x32_bf16 a[32:35],a[240:243],v[120:123],a[32:35]
v_accvgpr_read_b32 v76,a76
v_accvgpr_read_b32 v77,a77
v_accvgpr_read_b32 v78,a78
v_accvgpr_read_b32 v79,a79
v_cvt_pk_bf16_f32 v91,v234,v235
v_pk_mul_f32 v[236:237],v[236:237],v[146:147] op_sel_hi:[1,0]
v_pk_mul_f32 v[238:239],v[238:239],v[146:147] op_sel_hi:[1,0]
v_pk_mul_f32 v[76:77],v[76:77],v[150:151] op_sel_hi:[1,0]
v_pk_mul_f32 v[78:79],v[78:79],v[150:151] op_sel_hi:[1,0]
v_cvt_pk_bf16_f32 v92,v76,v77
v_cvt_pk_bf16_f32 v93,v78,v79
v_mfma_f32_16x16x32_bf16 a[80:83],a[240:243],v[124:127],a[80:83]
s_waitcnt vmcnt(9)
ds_read_b128 a[144:147],v28 offset:12288
s_waitcnt lgkmcnt(4)
buffer_store_dwordx4 v[152:155],v10,s[16:19],s87 offen offset:0 nt
v_mfma_f32_16x16x32_bf16 v[196:199],a[244:247],v[112:115],v[196:199]
v_cvt_pk_bf16_f32 v94,v236,v237
v_cvt_pk_bf16_f32 v95,v238,v239
v_mfma_f32_16x16x32_bf16 v[244:247],a[244:247],v[116:119],v[244:247]
v_mfma_f32_16x16x32_bf16 a[36:39],a[244:247],v[120:123],a[36:39]
ds_read_b128 a[148:151],v29 offset:12288
v_accvgpr_read_b32 v64,a80
v_accvgpr_read_b32 v65,a81
v_accvgpr_read_b32 v66,a82
v_accvgpr_read_b32 v67,a83
s_waitcnt vmcnt(12)
s_waitcnt lgkmcnt(2)
s_barrier
ds_read_b128 a[152:155],v28 offset:13312
buffer_store_dwordx4 v[156:159],v10,s[16:19],s87 offen offset:3072 nt
v_pk_mul_f32 v[240:241],v[240:241],v[146:147] op_sel_hi:[1,0]
v_pk_mul_f32 v[242:243],v[242:243],v[146:147] op_sel_hi:[1,0]
v_pk_mul_f32 v[64:65],v[64:65],v[150:151] op_sel_hi:[1,0]
v_pk_mul_f32 v[66:67],v[66:67],v[150:151] op_sel_hi:[1,0]
v_cvt_pk_bf16_f32 v80,v64,v65
v_cvt_pk_bf16_f32 v81,v66,v67
v_mfma_f32_16x16x32_bf16 a[84:87],a[244:247],v[124:127],a[84:87]
v_accvgpr_read_b32 v64,a0
v_accvgpr_read_b32 v65,a1
v_mfma_f32_16x16x32_bf16 v[200:203],a[248:251],v[112:115],v[200:203]
ds_read_b128 a[156:159],v29 offset:13312
v_accvgpr_read_b32 v66,a2
v_mfma_f32_16x16x32_bf16 v[248:251],a[248:251],v[116:119],v[248:251]
ds_read_b128 a[160:163],v28 offset:14336
v_accvgpr_read_b32 v67,a3
v_mfma_f32_16x16x32_bf16 a[40:43],a[248:251],v[120:123],a[40:43]
buffer_load_dwordx4 v7,s[8:11],s21 offen offset:0 lds
s_add_u32 m0,s23,896
ds_read_b128 a[164:167],v29 offset:14336
v_accvgpr_read_b32 v68,a84
v_pk_mul_f32 v[244:245],v[244:245],v[146:147] op_sel_hi:[1,0]
v_pk_mul_f32 v[246:247],v[246:247],v[146:147] op_sel_hi:[1,0]
v_accvgpr_read_b32 v69,a85
v_pk_mul_f32 v[68:69],v[68:69],v[150:151] op_sel_hi:[1,0]
v_accvgpr_read_b32 v70,a86
v_accvgpr_read_b32 v71,a87
v_pk_mul_f32 v[70:71],v[70:71],v[150:151] op_sel_hi:[1,0]
v_cvt_pk_bf16_f32 v82,v240,v241
v_cvt_pk_bf16_f32 v83,v242,v243
v_mfma_f32_16x16x32_bf16 a[88:91],a[248:251],v[124:127],a[88:91]
ds_write2st64_b64 v20,v[84:85],v[86:87] offset0:36 offset1:14
v_mfma_f32_16x16x32_bf16 v[204:207],a[252:255],v[112:115],v[204:207]
v_cvt_pk_bf16_f32 v84,v68,v69
v_cvt_pk_bf16_f32 v85,v70,v71
v_mfma_f32_16x16x32_bf16 v[252:255],a[252:255],v[116:119],v[252:255]
v_accvgpr_read_b32 v68,a16
v_accvgpr_read_b32 v69,a17
v_mfma_f32_16x16x32_bf16 a[44:47],a[252:255],v[120:123],a[44:47]
ds_write2st64_b64 v21,v[88:89],v[90:91] offset0:36 offset1:14
v_pk_mul_f32 v[248:249],v[248:249],v[146:147] op_sel_hi:[1,0]
v_pk_mul_f32 v[250:251],v[250:251],v[146:147] op_sel_hi:[1,0]
v_accvgpr_read_b32 v72,a88
v_accvgpr_read_b32 v73,a89
v_pk_mul_f32 v[72:73],v[72:73],v[150:151] op_sel_hi:[1,0]
v_accvgpr_read_b32 v74,a90
v_accvgpr_read_b32 v75,a91
v_pk_mul_f32 v[74:75],v[74:75],v[150:151] op_sel_hi:[1,0]
v_accvgpr_read_b32 v70,a18
v_accvgpr_read_b32 v71,a19
v_mfma_f32_16x16x32_bf16 a[92:95],a[252:255],v[124:127],a[92:95]
ds_write2st64_b64 v22,v[92:93],v[94:95] offset0:36 offset1:14
v_mfma_f32_16x16x32_bf16 v[32:35],a[192:195],a[96:99],0
v_cvt_pk_bf16_f32 v88,v72,v73
v_cvt_pk_bf16_f32 v89,v74,v75
v_mfma_f32_16x16x32_bf16 v[32:35],a[196:199],a[100:103],v[32:35]
v_accvgpr_read_b32 v72,a4
v_accvgpr_read_b32 v73,a5
v_mfma_f32_16x16x32_bf16 v[32:35],a[200:203],a[104:107],v[32:35]
buffer_load_dwordx4 v7,s[8:11],s21 offen offset:128 lds
s_add_u32 m0,s23,1792
ds_read_b128 v[152:155],v15 offset:18432
v_accvgpr_read_b32 v76,a92
v_pk_mul_f32 v[252:253],v[252:253],v[146:147] op_sel_hi:[1,0]
v_pk_mul_f32 v[254:255],v[254:255],v[146:147] op_sel_hi:[1,0]
v_accvgpr_read_b32 v77,a93
v_pk_mul_f32 v[76:77],v[76:77],v[150:151] op_sel_hi:[1,0]
v_accvgpr_read_b32 v78,a94
v_accvgpr_read_b32 v79,a95
v_pk_mul_f32 v[78:79],v[78:79],v[150:151] op_sel_hi:[1,0]
v_cvt_pk_bf16_f32 v92,v76,v77
v_cvt_pk_bf16_f32 v93,v78,v79
v_mfma_f32_16x16x32_bf16 v[32:35],a[204:207],a[108:111],v[32:35]
ds_read_b128 v[156:159],v15 offset:21504
v_accvgpr_read_b32 v74,a6
v_mfma_f32_16x16x32_bf16 v[32:35],a[208:211],a[112:115],v[32:35]
ds_write2st64_b64 v12,v[80:81],v[82:83] offset0:36 offset1:16
v_mfma_f32_16x16x32_bf16 v[32:35],a[212:215],a[116:119],v[32:35]
v_accvgpr_read_b32 v75,a7
v_accvgpr_read_b32 v76,a20
v_accvgpr_read_b32 v77,a21
v_accvgpr_read_b32 v78,a22
v_accvgpr_read_b32 v79,a23
v_pk_mul_f32 v[64:65],v[64:65],v[148:149] op_sel_hi:[1,0]
v_pk_mul_f32 v[66:67],v[66:67],v[148:149] op_sel_hi:[1,0]
v_pk_mul_f32 v[68:69],v[68:69],v[148:149] op_sel_hi:[1,0]
v_pk_mul_f32 v[70:71],v[70:71],v[148:149] op_sel_hi:[1,0]
v_cvt_pk_bf16_f32 v80,v64,v65
v_cvt_pk_bf16_f32 v81,v66,v67
v_mfma_f32_16x16x32_bf16 v[36:39],a[216:219],a[96:99],0
buffer_load_dwordx4 v7,s[8:11],s21 offen offset:256 lds
s_add_u32 s21,s21,12288
s_mov_b32 s27,s42
v_mfma_f32_16x16x32_bf16 v[36:39],a[220:223],a[100:103],v[36:39]
s_mov_b32 s42,s41
v_cvt_pk_bf16_f32 v82,v68,v69
v_cvt_pk_bf16_f32 v83,v70,v71
v_mfma_f32_16x16x32_bf16 v[36:39],a[224:227],a[104:107],v[36:39]
s_add_u32 s69,s69,1
s_waitcnt lgkmcnt(2)
buffer_store_dwordx4 v[152:155],v10,s[16:19],s87 offen offset:128 nt
s_add_u32 s48,s48,325632
s_lshr_b32 s62,s39,s69
v_mfma_f32_16x16x32_bf16 v[36:39],a[228:231],a[108:111],v[36:39]
s_and_b32 s62,s62,1
v_accvgpr_read_b32 v64,a8
v_accvgpr_read_b32 v65,a9
v_accvgpr_read_b32 v66,a10
v_accvgpr_read_b32 v67,a11
v_accvgpr_read_b32 v68,a24
v_pk_mul_f32 v[72:73],v[72:73],v[148:149] op_sel_hi:[1,0]
v_pk_mul_f32 v[74:75],v[74:75],v[148:149] op_sel_hi:[1,0]
v_pk_mul_f32 v[76:77],v[76:77],v[148:149] op_sel_hi:[1,0]
v_pk_mul_f32 v[78:79],v[78:79],v[148:149] op_sel_hi:[1,0]
v_accvgpr_read_b32 v69,a25
v_accvgpr_read_b32 v70,a26
v_mfma_f32_16x16x32_bf16 v[36:39],a[232:235],a[112:115],v[36:39]
s_lshl_b32 s62,s62,1
s_waitcnt lgkmcnt(0)
buffer_store_dwordx4 v[156:159],v10,s[16:19],s87 offen offset:3200 nt
s_add_u32 s62,s62,s49
s_and_b32 s62,s62,3
v_mfma_f32_16x16x32_bf16 v[36:39],a[236:239],a[116:119],v[36:39]
s_add_u32 s63,s69,8
v_accvgpr_read_b32 v71,a27
v_cvt_pk_bf16_f32 v86,v244,v245
v_mfma_f32_16x16x32_bf16 v[40:43],a[192:195],a[120:123],0
s_lshr_b32 s63,s39,s63
v_cvt_pk_bf16_f32 v87,v246,v247
v_cvt_pk_bf16_f32 v90,v248,v249
v_mfma_f32_16x16x32_bf16 v[40:43],a[196:199],a[124:127],v[40:43]
s_and_b32 s63,s63,1
ds_write2st64_b64 v20,v[84:85],v[86:87] offset0:36 offset1:16
s_xor_b32 s62,s62,s63
s_mul_i32 s63,s3,3
s_lshl_b32 s64,s3,2
s_mov_b32 s40,1
v_pk_mul_f32 v[64:65],v[64:65],v[148:149] op_sel_hi:[1,0]
v_pk_mul_f32 v[66:67],v[66:67],v[148:149] op_sel_hi:[1,0]
v_pk_mul_f32 v[68:69],v[68:69],v[148:149] op_sel_hi:[1,0]
v_pk_mul_f32 v[70:71],v[70:71],v[148:149] op_sel_hi:[1,0]
v_cvt_pk_bf16_f32 v84,v72,v73
v_cvt_pk_bf16_f32 v85,v74,v75
v_mfma_f32_16x16x32_bf16 v[40:43],a[200:203],a[128:131],v[40:43]
s_add_u32 s65,s63,17
v_cvt_pk_bf16_f32 v86,v76,v77
v_cvt_pk_bf16_f32 v87,v78,v79
v_mfma_f32_16x16x32_bf16 v[40:43],a[204:207],a[132:135],v[40:43]
s_cmp_eq_u32 s3,0
v_accvgpr_read_b32 v72,a12
v_accvgpr_read_b32 v73,a13
v_mfma_f32_16x16x32_bf16 v[40:43],a[208:211],a[136:139],v[40:43]
s_cselect_b32 s65,16,s65
v_accvgpr_read_b32 v74,a14
v_accvgpr_read_b32 v75,a15
v_accvgpr_read_b32 v76,a28
v_accvgpr_read_b32 v77,a29
v_accvgpr_read_b32 v78,a30
v_pk_mul_f32 v[72:73],v[72:73],v[148:149] op_sel_hi:[1,0]
v_pk_mul_f32 v[74:75],v[74:75],v[148:149] op_sel_hi:[1,0]
v_pk_mul_f32 v[76:77],v[76:77],v[148:149] op_sel_hi:[1,0]
v_accvgpr_read_b32 v79,a31
v_pk_mul_f32 v[78:79],v[78:79],v[148:149] op_sel_hi:[1,0]
v_cvt_pk_bf16_f32 v91,v250,v251
v_cvt_pk_bf16_f32 v94,v252,v253
v_mfma_f32_16x16x32_bf16 v[40:43],a[212:215],a[140:143],v[40:43]
s_waitcnt vmcnt(10)
ds_read_b128 a[168:171],v28 offset:0
v_cvt_pk_bf16_f32 v95,v254,v255
v_mfma_f32_16x16x32_bf16 v[44:47],a[216:219],a[120:123],0
s_cselect_b32 s41,1,0
ds_read_b128 a[172:175],v29 offset:0
s_cmp_eq_u32 s62,1
v_mfma_f32_16x16x32_bf16 v[44:47],a[220:223],a[124:127],v[44:47]
s_cselect_b32 s64,s65,s64
ds_read_b128 a[176:179],v28 offset:1024
s_cselect_b32 s40,s41,s40
v_mfma_f32_16x16x32_bf16 v[44:47],a[224:227],a[128:131],v[44:47]
s_add_u32 s65,s63,29
ds_read_b128 a[180:183],v29 offset:1024
s_cmp_eq_u32 s62,2
ds_read_b128 a[184:187],v28 offset:2048
s_cselect_b32 s64,s65,s64
s_cselect_b32 s40,0,s40
v_pk_mul_f32 v[192:193],v[192:193],v[144:145] op_sel_hi:[1,0]
v_pk_mul_f32 v[194:195],v[194:195],v[144:145] op_sel_hi:[1,0]
s_add_u32 s65,s63,41
s_cmp_eq_u32 s62,3
ds_read_b128 a[188:191],v29 offset:2048
s_cselect_b32 s64,s65,s64
ds_write2st64_b64 v21,v[88:89],v[90:91] offset0:36 offset1:16
s_cselect_b32 s40,0,s40
s_mul_i32 s64,s64,6144
s_add_u32 s41,s48,s64
s_cmp_ge_u32 s69,8
v_cvt_pk_bf16_f32 v88,v64,v65
v_cvt_pk_bf16_f32 v89,v66,v67
v_accvgpr_read_b32 v64,a32
v_accvgpr_read_b32 v65,a33
v_pk_mul_f32 v[64:65],v[64:65],v[148:149] op_sel_hi:[1,0]
v_accvgpr_read_b32 v66,a34
v_accvgpr_read_b32 v67,a35
v_pk_mul_f32 v[66:67],v[66:67],v[148:149] op_sel_hi:[1,0]
v_cvt_pk_bf16_f32 v90,v68,v69
v_cvt_pk_bf16_f32 v91,v70,v71
v_mfma_f32_16x16x32_bf16 v[44:47],a[228:231],a[132:135],v[44:47]
s_cselect_b32 s41,166723584,s41
ds_write2st64_b64 v22,v[92:93],v[94:95] offset0:36 offset1:16
s_mov_b32 s28,s41
s_mov_b32 s29,s24
s_add_u32 s25,s22,12288
s_add_u32 s26,s22,24576
v_mfma_f32_16x16x32_bf16 v[44:47],a[232:235],a[136:139],v[44:47]
v_accvgpr_read_b32 v68,a36
v_accvgpr_read_b32 v69,a37
v_mfma_f32_16x16x32_bf16 v[44:47],a[236:239],a[140:143],v[44:47]
v_accvgpr_read_b32 v70,a38
v_accvgpr_read_b32 v71,a39
v_mfma_f32_16x16x32_bf16 v[48:51],a[192:195],a[144:147],0
ds_read_b128 v[152:155],v15 offset:18432
v_cvt_pk_bf16_f32 v92,v72,v73
v_cvt_pk_bf16_f32 v93,v74,v75
v_accvgpr_read_b32 v72,a40
v_accvgpr_read_b32 v73,a41
v_pk_mul_f32 v[68:69],v[68:69],v[148:149] op_sel_hi:[1,0]
v_pk_mul_f32 v[70:71],v[70:71],v[148:149] op_sel_hi:[1,0]
v_pk_mul_f32 v[196:197],v[196:197],v[144:145] op_sel_hi:[1,0]
v_pk_mul_f32 v[198:199],v[198:199],v[144:145] op_sel_hi:[1,0]
v_accvgpr_read_b32 v74,a42
v_accvgpr_read_b32 v75,a43
v_mfma_f32_16x16x32_bf16 v[48:51],a[196:199],a[148:151],v[48:51]
ds_read_b128 v[156:159],v15 offset:21504
v_cvt_pk_bf16_f32 v94,v76,v77
v_mfma_f32_16x16x32_bf16 v[48:51],a[200:203],a[152:155],v[48:51]
ds_write2st64_b64 v12,v[80:81],v[82:83] offset0:24 offset1:26
v_mfma_f32_16x16x32_bf16 v[48:51],a[204:207],a[156:159],v[48:51]
v_cvt_pk_bf16_f32 v95,v78,v79
v_accvgpr_read_b32 v76,a44
v_mfma_f32_16x16x32_bf16 v[48:51],a[208:211],a[160:163],v[48:51]
v_accvgpr_read_b32 v77,a45
v_accvgpr_read_b32 v78,a46
v_accvgpr_read_b32 v79,a47
v_cvt_pk_bf16_f32 v80,v64,v65
v_cvt_pk_bf16_f32 v81,v66,v67
v_pk_mul_f32 v[72:73],v[72:73],v[148:149] op_sel_hi:[1,0]
v_pk_mul_f32 v[74:75],v[74:75],v[148:149] op_sel_hi:[1,0]
v_pk_mul_f32 v[200:201],v[200:201],v[144:145] op_sel_hi:[1,0]
v_pk_mul_f32 v[202:203],v[202:203],v[144:145] op_sel_hi:[1,0]
v_cvt_pk_bf16_f32 v82,v192,v193
v_cvt_pk_bf16_f32 v83,v194,v195
v_mfma_f32_16x16x32_bf16 v[48:51],a[212:215],a[164:167],v[48:51]
ds_write2st64_b64 v20,v[84:85],v[86:87] offset0:24 offset1:26
v_mfma_f32_16x16x32_bf16 v[52:55],a[216:219],a[144:147],0
v_cvt_pk_bf16_f32 v84,v68,v69
v_cvt_pk_bf16_f32 v85,v70,v71
v_mfma_f32_16x16x32_bf16 v[52:55],a[220:223],a[148:151],v[52:55]
v_cvt_pk_bf16_f32 v86,v196,v197
v_cvt_pk_bf16_f32 v87,v198,v199
v_mfma_f32_16x16x32_bf16 v[52:55],a[224:227],a[152:155],v[52:55]
ds_write2st64_b64 v21,v[88:89],v[90:91] offset0:24 offset1:26
v_pk_mul_f32 v[76:77],v[76:77],v[148:149] op_sel_hi:[1,0]
v_pk_mul_f32 v[78:79],v[78:79],v[148:149] op_sel_hi:[1,0]
v_pk_mul_f32 v[204:205],v[204:205],v[144:145] op_sel_hi:[1,0]
v_pk_mul_f32 v[206:207],v[206:207],v[144:145] op_sel_hi:[1,0]
v_cvt_pk_bf16_f32 v88,v72,v73
v_cvt_pk_bf16_f32 v89,v74,v75
v_mfma_f32_16x16x32_bf16 v[52:55],a[228:231],a[156:159],v[52:55]
ds_write2st64_b64 v22,v[92:93],v[94:95] offset0:24 offset1:26
v_mfma_f32_16x16x32_bf16 v[52:55],a[232:235],a[160:163],v[52:55]
v_cvt_pk_bf16_f32 v90,v200,v201
v_cvt_pk_bf16_f32 v91,v202,v203
v_mfma_f32_16x16x32_bf16 v[52:55],a[236:239],a[164:167],v[52:55]
s_waitcnt lgkmcnt(2)
v_cvt_pk_bf16_f32 v92,v76,v77
v_cvt_pk_bf16_f32 v93,v78,v79
v_mfma_f32_16x16x32_bf16 v[56:59],a[192:195],a[168:171],0
ds_write2st64_b64 v12,v[80:81],v[82:83] offset0:28 offset1:4
v_pk_mul_f32 v[160:161],v[160:161],v[144:145] op_sel_hi:[1,0]
v_pk_mul_f32 v[162:163],v[162:163],v[144:145] op_sel_hi:[1,0]
v_pk_mul_f32 v[176:177],v[176:177],v[144:145] op_sel_hi:[1,0]
v_pk_mul_f32 v[178:179],v[178:179],v[144:145] op_sel_hi:[1,0]
v_cvt_pk_bf16_f32 v94,v204,v205
v_cvt_pk_bf16_f32 v95,v206,v207
v_mfma_f32_16x16x32_bf16 v[56:59],a[196:199],a[172:175],v[56:59]
ds_write2st64_b64 v20,v[84:85],v[86:87] offset0:28 offset1:4
v_mfma_f32_16x16x32_bf16 v[56:59],a[200:203],a[176:179],v[56:59]
v_cvt_pk_bf16_f32 v80,v160,v161
v_cvt_pk_bf16_f32 v81,v162,v163
v_mfma_f32_16x16x32_bf16 v[56:59],a[204:207],a[180:183],v[56:59]
v_cvt_pk_bf16_f32 v82,v176,v177
v_cvt_pk_bf16_f32 v83,v178,v179
ds_write2st64_b64 v21,v[88:89],v[90:91] offset0:28 offset1:4
v_pk_mul_f32 v[164:165],v[164:165],v[144:145] op_sel_hi:[1,0]
v_pk_mul_f32 v[166:167],v[166:167],v[144:145] op_sel_hi:[1,0]
v_pk_mul_f32 v[180:181],v[180:181],v[144:145] op_sel_hi:[1,0]
v_pk_mul_f32 v[182:183],v[182:183],v[144:145] op_sel_hi:[1,0]
v_cvt_pk_bf16_f32 v84,v164,v165
v_cvt_pk_bf16_f32 v85,v166,v167
v_mfma_f32_16x16x32_bf16 v[56:59],a[208:211],a[184:187],v[56:59]
ds_write2st64_b64 v22,v[92:93],v[94:95] offset0:28 offset1:4
v_mfma_f32_16x16x32_bf16 v[56:59],a[212:215],a[188:191],v[56:59]
v_cvt_pk_bf16_f32 v86,v180,v181
v_cvt_pk_bf16_f32 v87,v182,v183
v_mfma_f32_16x16x32_bf16 v[60:63],a[216:219],a[168:171],0
v_mfma_f32_16x16x32_bf16 v[60:63],a[220:223],a[172:175],v[60:63]
ds_write2st64_b64 v12,v[80:81],v[82:83] offset0:0 offset1:2
v_pk_mul_f32 v[168:169],v[168:169],v[144:145] op_sel_hi:[1,0]
v_pk_mul_f32 v[170:171],v[170:171],v[144:145] op_sel_hi:[1,0]
v_pk_mul_f32 v[184:185],v[184:185],v[144:145] op_sel_hi:[1,0]
v_pk_mul_f32 v[186:187],v[186:187],v[144:145] op_sel_hi:[1,0]
v_cvt_pk_bf16_f32 v88,v168,v169
v_cvt_pk_bf16_f32 v89,v170,v171
v_mfma_f32_16x16x32_bf16 v[60:63],a[224:227],a[176:179],v[60:63]
ds_write2st64_b64 v20,v[84:85],v[86:87] offset0:0 offset1:2
v_mfma_f32_16x16x32_bf16 v[60:63],a[228:231],a[180:183],v[60:63]
v_cvt_pk_bf16_f32 v90,v184,v185
v_cvt_pk_bf16_f32 v91,v186,v187
v_mfma_f32_16x16x32_bf16 v[60:63],a[232:235],a[184:187],v[60:63]
v_mfma_f32_16x16x32_bf16 v[60:63],a[236:239],a[188:191],v[60:63]
ds_write2st64_b64 v21,v[88:89],v[90:91] offset0:0 offset1:2
v_pk_mul_f32 v[172:173],v[172:173],v[144:145] op_sel_hi:[1,0]
v_pk_mul_f32 v[174:175],v[174:175],v[144:145] op_sel_hi:[1,0]
v_pk_mul_f32 v[188:189],v[188:189],v[144:145] op_sel_hi:[1,0]
v_pk_mul_f32 v[190:191],v[190:191],v[144:145] op_sel_hi:[1,0]
v_cvt_pk_bf16_f32 v92,v172,v173
v_cvt_pk_bf16_f32 v93,v174,v175
v_cvt_pk_bf16_f32 v94,v188,v189
v_cvt_pk_bf16_f32 v95,v190,v191
ds_write2st64_b64 v22,v[92:93],v[94:95] offset0:0 offset1:2
buffer_store_dwordx4 v[152:155],v10,s[16:19],s87 offen offset:256 nt
buffer_store_dwordx4 v[156:159],v10,s[16:19],s87 offen offset:3328 nt
ds_read_b128 a[192:195],v1 offset:12288
v_max3_f32 v144,v32,v33,v34
v_max3_f32 v146,v40,v41,v42
v_max3_f32 v144,v144,v35,v36
v_max3_f32 v146,v146,v43,v44
v_max3_f32 v144,v144,v37,v38
v_max3_f32 v146,v146,v45,v46
v_max_f32 v144,v144,v39
v_max_f32 v146,v146,v47
v_mov_b32 v145,v144
v_mov_b32 v147,v146
s_add_u32 m0,s23,12288
v_permlane32_swap_b32 v145,v144
v_permlane32_swap_b32 v147,v146
v_max_f32 v144,v144,v145
v_max_f32 v146,v146,v147
v_mov_b32 v145,v144
v_mov_b32 v147,v146
buffer_load_dwordx4 v7,s[8:11],s21 offen offset:0 lds
s_add_u32 m0,s23,13184
ds_read_b128 a[196:199],v2 offset:12288
v_permlane16_swap_b32 v145,v144
v_permlane16_swap_b32 v147,v146
v_max_f32 v144,v144,v145
v_max_f32 v146,v146,v147
v_mul_f32_e64 v16,-s36,v144
v_mul_f32_e64 v17,-s36,v146
v_max3_f32 v144,v48,v49,v50
s_waitcnt lgkmcnt(1)
v_mfma_f32_16x16x32_bf16 v[64:67],a[192:195],a[96:99],0
ds_read_b128 a[200:203],v1 offset:13312
v_max3_f32 v146,v56,v57,v58
v_max3_f32 v144,v144,v51,v52
v_max3_f32 v146,v146,v59,v60
v_max3_f32 v144,v144,v53,v54
v_max3_f32 v146,v146,v61,v62
v_max_f32 v144,v144,v55
v_max_f32 v146,v146,v63
v_mov_b32 v145,v144
v_mov_b32 v147,v146
v_fma_f32 v32,v32,s36,v16
v_permlane32_swap_b32 v145,v144
v_permlane32_swap_b32 v147,v146
v_max_f32 v144,v144,v145
v_max_f32 v146,v146,v147
v_mov_b32 v145,v144
v_mov_b32 v147,v146
v_fma_f32 v33,v33,s36,v16
v_permlane16_swap_b32 v145,v144
v_permlane16_swap_b32 v147,v146
s_waitcnt lgkmcnt(1)
v_mfma_f32_16x16x32_bf16 v[64:67],a[196:199],a[100:103],v[64:67]
buffer_load_dwordx4 v7,s[8:11],s21 offen offset:128 lds
s_add_u32 m0,s23,14080
ds_read_b128 a[204:207],v2 offset:13312
v_max_f32 v144,v144,v145
v_max_f32 v146,v146,v147
v_mul_f32_e64 v18,-s36,v144
v_mul_f32_e64 v19,-s36,v146
v_fma_f32 v34,v34,s36,v16
s_waitcnt lgkmcnt(1)
v_mfma_f32_16x16x32_bf16 v[64:67],a[200:203],a[104:107],v[64:67]
ds_read_b128 a[208:211],v1 offset:14336
v_fma_f32 v35,v35,s36,v16
v_fma_f32 v36,v36,s36,v16
v_fma_f32 v37,v37,s36,v16
v_fma_f32 v38,v38,s36,v16
v_fma_f32 v39,v39,s36,v16
v_fma_f32 v40,v40,s36,v17
v_fma_f32 v41,v41,s36,v17
v_fma_f32 v42,v42,s36,v17
v_fma_f32 v43,v43,s36,v17
v_fma_f32 v44,v44,s36,v17
v_fma_f32 v45,v45,s36,v17
v_fma_f32 v46,v46,s36,v17
v_fma_f32 v47,v47,s36,v17
v_fma_f32 v48,v48,s36,v18
v_fma_f32 v49,v49,s36,v18
v_fma_f32 v50,v50,s36,v18
v_fma_f32 v51,v51,s36,v18
v_fma_f32 v52,v52,s36,v18
v_fma_f32 v53,v53,s36,v18
v_fma_f32 v54,v54,s36,v18
v_fma_f32 v55,v55,s36,v18
v_fma_f32 v56,v56,s36,v19
v_fma_f32 v57,v57,s36,v19
v_fma_f32 v58,v58,s36,v19
v_fma_f32 v59,v59,s36,v19
v_fma_f32 v60,v60,s36,v19
s_waitcnt lgkmcnt(1)
v_mfma_f32_16x16x32_bf16 v[64:67],a[204:207],a[108:111],v[64:67]
ds_read_b128 a[212:215],v2 offset:14336
v_fma_f32 v61,v61,s36,v19
v_fma_f32 v62,v62,s36,v19
v_fma_f32 v63,v63,s36,v19
v_exp_f32 v32,v32
s_waitcnt lgkmcnt(1)
v_mfma_f32_16x16x32_bf16 v[64:67],a[208:211],a[112:115],v[64:67]
buffer_load_dwordx4 v7,s[8:11],s21 offen offset:256 lds
s_add_u32 s21,s21,12288
s_add_u32 m0,s22,0
ds_read_b128 a[216:219],v1 offset:18432
v_exp_f32 v33,v33
v_exp_f32 v34,v34
v_exp_f32 v35,v35
v_exp_f32 v36,v36
v_exp_f32 v37,v37
v_exp_f32 v38,v38
v_exp_f32 v39,v39
v_exp_f32 v40,v40
v_exp_f32 v41,v41
v_exp_f32 v42,v42
v_exp_f32 v43,v43
v_exp_f32 v44,v44
s_waitcnt lgkmcnt(1)
v_mfma_f32_16x16x32_bf16 v[64:67],a[212:215],a[116:119],v[64:67]
ds_read_b128 a[220:223],v2 offset:18432
v_exp_f32 v45,v45
v_mfma_f32_16x16x32_bf16 v[72:75],a[192:195],a[120:123],0
ds_read_b128 a[224:227],v1 offset:19456
v_exp_f32 v46,v46
v_mfma_f32_16x16x32_bf16 v[72:75],a[196:199],a[124:127],v[72:75]
ds_read_b128 a[228:231],v2 offset:19456
v_exp_f32 v47,v47
v_mfma_f32_16x16x32_bf16 v[72:75],a[200:203],a[128:131],v[72:75]
buffer_load_dwordx4 v7,s[4:7],s20 offen offset:0 lds
s_add_u32 m0,s22,896
v_mfma_f32_16x16x32_bf16 v[72:75],a[204:207],a[132:135],v[72:75]
ds_read_b128 a[232:235],v1 offset:20480
v_exp_f32 v48,v48
v_mfma_f32_16x16x32_bf16 v[72:75],a[208:211],a[136:139],v[72:75]
ds_read_b128 a[236:239],v2 offset:20480
v_exp_f32 v49,v49
v_mfma_f32_16x16x32_bf16 v[72:75],a[212:215],a[140:143],v[72:75]
v_exp_f32 v50,v50
v_mfma_f32_16x16x32_bf16 v[80:83],a[192:195],a[144:147],0
v_exp_f32 v51,v51
v_mfma_f32_16x16x32_bf16 v[80:83],a[196:199],a[148:151],v[80:83]
v_exp_f32 v52,v52
v_mfma_f32_16x16x32_bf16 v[80:83],a[200:203],a[152:155],v[80:83]
v_exp_f32 v53,v53
v_mfma_f32_16x16x32_bf16 v[80:83],a[204:207],a[156:159],v[80:83]
v_exp_f32 v54,v54
v_mfma_f32_16x16x32_bf16 v[80:83],a[208:211],a[160:163],v[80:83]
v_exp_f32 v55,v55
v_mfma_f32_16x16x32_bf16 v[80:83],a[212:215],a[164:167],v[80:83]
v_exp_f32 v56,v56
v_mfma_f32_16x16x32_bf16 v[88:91],a[192:195],a[168:171],0
v_exp_f32 v57,v57
v_mfma_f32_16x16x32_bf16 v[88:91],a[196:199],a[172:175],v[88:91]
v_exp_f32 v58,v58
v_mfma_f32_16x16x32_bf16 v[88:91],a[200:203],a[176:179],v[88:91]
buffer_load_dwordx4 v7,s[4:7],s20 offen offset:128 lds
s_add_u32 m0,s22,1792
v_mfma_f32_16x16x32_bf16 v[88:91],a[204:207],a[180:183],v[88:91]
v_exp_f32 v59,v59
v_mfma_f32_16x16x32_bf16 v[88:91],a[208:211],a[184:187],v[88:91]
v_exp_f32 v60,v60
v_mfma_f32_16x16x32_bf16 v[88:91],a[212:215],a[188:191],v[88:91]
s_waitcnt lgkmcnt(0)
v_exp_f32 v61,v61
v_mfma_f32_16x16x32_bf16 v[68:71],a[216:219],a[96:99],0
v_exp_f32 v62,v62
v_mfma_f32_16x16x32_bf16 v[68:71],a[220:223],a[100:103],v[68:71]
v_exp_f32 v63,v63
v_mfma_f32_16x16x32_bf16 v[68:71],a[224:227],a[104:107],v[68:71]
v_cvt_pk_bf16_f32 v96,v32,v33
v_cvt_pk_bf16_f32 v97,v34,v35
v_mfma_f32_16x16x32_bf16 v[68:71],a[228:231],a[108:111],v[68:71]
v_cvt_pk_bf16_f32 v98,v36,v37
v_cvt_pk_bf16_f32 v99,v38,v39
v_mfma_f32_16x16x32_bf16 v[68:71],a[232:235],a[112:115],v[68:71]
v_cvt_pk_bf16_f32 v100,v40,v41
v_cvt_pk_bf16_f32 v101,v42,v43
v_mfma_f32_16x16x32_bf16 v[128:131],v[24:27],v[96:99],0
v_cvt_pk_bf16_f32 v102,v44,v45
v_cvt_pk_bf16_f32 v103,v46,v47
v_mfma_f32_16x16x32_bf16 v[68:71],a[236:239],a[116:119],v[68:71]
v_cvt_pk_bf16_f32 v104,v48,v49
v_cvt_pk_bf16_f32 v105,v50,v51
v_mfma_f32_16x16x32_bf16 v[132:135],v[24:27],v[100:103],0
v_cvt_pk_bf16_f32 v106,v52,v53
v_cvt_pk_bf16_f32 v107,v54,v55
v_mfma_f32_16x16x32_bf16 v[76:79],a[216:219],a[120:123],0
buffer_load_dwordx4 v7,s[4:7],s20 offen offset:256 lds
s_add_u32 s20,s20,12288
v_mfma_f32_16x16x32_bf16 v[136:139],v[24:27],v[104:107],0
v_cvt_pk_bf16_f32 v108,v56,v57
v_cvt_pk_bf16_f32 v109,v58,v59
v_mfma_f32_16x16x32_bf16 v[76:79],a[220:223],a[124:127],v[76:79]
v_cvt_pk_bf16_f32 v110,v60,v61
v_cvt_pk_bf16_f32 v111,v62,v63
v_mfma_f32_16x16x32_bf16 v[76:79],a[224:227],a[128:131],v[76:79]
v_fma_f32 v64,v64,s36,v16
v_fma_f32 v65,v65,s36,v16
v_mfma_f32_16x16x32_bf16 v[140:143],v[24:27],v[108:111],0
v_fma_f32 v66,v66,s36,v16
v_fma_f32 v67,v67,s36,v16
v_mfma_f32_16x16x32_bf16 v[76:79],a[228:231],a[132:135],v[76:79]
v_fma_f32 v72,v72,s36,v17
v_fma_f32 v73,v73,s36,v17
v_mfma_f32_16x16x32_bf16 v[76:79],a[232:235],a[136:139],v[76:79]
v_fma_f32 v74,v74,s36,v17
v_fma_f32 v75,v75,s36,v17
v_mfma_f32_16x16x32_bf16 v[76:79],a[236:239],a[140:143],v[76:79]
v_exp_f32 v64,v64
v_mfma_f32_16x16x32_bf16 v[84:87],a[216:219],a[144:147],0
v_exp_f32 v65,v65
v_mfma_f32_16x16x32_bf16 v[84:87],a[220:223],a[148:151],v[84:87]
v_exp_f32 v66,v66
v_mfma_f32_16x16x32_bf16 v[84:87],a[224:227],a[152:155],v[84:87]
v_exp_f32 v67,v67
v_mfma_f32_16x16x32_bf16 v[84:87],a[228:231],a[156:159],v[84:87]
v_exp_f32 v72,v72
v_mfma_f32_16x16x32_bf16 v[84:87],a[232:235],a[160:163],v[84:87]
v_exp_f32 v73,v73
v_mfma_f32_16x16x32_bf16 v[84:87],a[236:239],a[164:167],v[84:87]
v_exp_f32 v74,v74
v_mfma_f32_16x16x32_bf16 v[92:95],a[216:219],a[168:171],0
v_exp_f32 v75,v75
v_mfma_f32_16x16x32_bf16 v[92:95],a[220:223],a[172:175],v[92:95]
v_cvt_pk_bf16_f32 v112,v64,v65
v_cvt_pk_bf16_f32 v113,v66,v67
v_mfma_f32_16x16x32_bf16 v[92:95],a[224:227],a[176:179],v[92:95]
v_cvt_pk_bf16_f32 v116,v72,v73
v_cvt_pk_bf16_f32 v117,v74,v75
v_mfma_f32_16x16x32_bf16 v[92:95],a[228:231],a[180:183],v[92:95]
v_mfma_f32_16x16x32_bf16 v[92:95],a[232:235],a[184:187],v[92:95]
v_mfma_f32_16x16x32_bf16 v[92:95],a[236:239],a[188:191],v[92:95]
s_waitcnt vmcnt(10)
s_barrier
ds_read_b64_tr_b16 a[240:241],v3 offset:0
ds_read_b64_tr_b16 a[242:243],v3 offset:6144
ds_read_b64_tr_b16 a[244:245],v4 offset:0
ds_read_b64_tr_b16 a[246:247],v4 offset:6144
ds_read_b64_tr_b16 a[248:249],v5 offset:0
ds_read_b64_tr_b16 a[250:251],v5 offset:6144
ds_read_b64_tr_b16 a[252:253],v6 offset:0
ds_read_b64_tr_b16 a[254:255],v6 offset:6144
s_waitcnt lgkmcnt(6)
v_mfma_f32_16x16x32_bf16 v[160:163],a[240:243],v[96:99],0
s_add_u32 m0,s23,24576
ds_read_b128 a[192:195],v1 offset:24576
v_fma_f32 v68,v68,s36,v16
v_mfma_f32_16x16x32_bf16 v[208:211],a[240:243],v[100:103],0
buffer_load_dwordx4 v7,s[8:11],s21 offen offset:0 lds
v_mfma_f32_16x16x32_bf16 a[0:3],a[240:243],v[104:107],0
s_add_u32 m0,s23,25472
ds_read_b128 a[196:199],v2 offset:24576
v_fma_f32 v69,v69,s36,v16
v_mfma_f32_16x16x32_bf16 a[48:51],a[240:243],v[108:111],0
s_waitcnt lgkmcnt(6)
ds_read_b64_tr_b16 a[240:241],v3 offset:1024
ds_read_b64_tr_b16 a[242:243],v3 offset:7168
v_mfma_f32_16x16x32_bf16 v[164:167],a[244:247],v[96:99],0
ds_read_b128 a[200:203],v1 offset:25600
v_fma_f32 v70,v70,s36,v16
v_mfma_f32_16x16x32_bf16 v[212:215],a[244:247],v[100:103],0
ds_read_b128 a[204:207],v2 offset:25600
v_fma_f32 v71,v71,s36,v16
v_mfma_f32_16x16x32_bf16 a[4:7],a[244:247],v[104:107],0
ds_read_b128 a[208:211],v1 offset:26624
v_fma_f32 v76,v76,s36,v17
v_mfma_f32_16x16x32_bf16 a[52:55],a[244:247],v[108:111],0
s_waitcnt lgkmcnt(7)
ds_read_b64_tr_b16 a[244:245],v4 offset:1024
ds_read_b64_tr_b16 a[246:247],v4 offset:7168
v_mfma_f32_16x16x32_bf16 v[168:171],a[248:251],v[96:99],0
ds_read_b128 a[212:215],v2 offset:26624
v_fma_f32 v77,v77,s36,v17
v_mfma_f32_16x16x32_bf16 v[216:219],a[248:251],v[100:103],0
buffer_load_dwordx4 v7,s[8:11],s21 offen offset:128 lds
v_mfma_f32_16x16x32_bf16 a[8:11],a[248:251],v[104:107],0
s_add_u32 m0,s23,26368
ds_read_b128 a[216:219],v1 offset:30720
v_fma_f32 v78,v78,s36,v17
v_mfma_f32_16x16x32_bf16 a[56:59],a[248:251],v[108:111],0
ds_read_b64_tr_b16 a[248:249],v5 offset:1024
ds_read_b64_tr_b16 a[250:251],v5 offset:7168
v_mfma_f32_16x16x32_bf16 v[172:175],a[252:255],v[96:99],0
ds_read_b128 a[220:223],v2 offset:30720
v_fma_f32 v79,v79,s36,v17
v_mfma_f32_16x16x32_bf16 v[220:223],a[252:255],v[100:103],0
ds_read_b128 a[224:227],v1 offset:31744
v_fma_f32 v80,v80,s36,v18
v_mfma_f32_16x16x32_bf16 a[12:15],a[252:255],v[104:107],0
ds_read_b128 a[228:231],v2 offset:31744
v_fma_f32 v81,v81,s36,v18
v_mfma_f32_16x16x32_bf16 a[60:63],a[252:255],v[108:111],0
s_waitcnt lgkmcnt(7)
ds_read_b64_tr_b16 a[252:253],v6 offset:1024
ds_read_b64_tr_b16 a[254:255],v6 offset:7168
v_mfma_f32_16x16x32_bf16 v[176:179],a[240:243],v[96:99],0
ds_read_b128 a[232:235],v1 offset:32768
v_fma_f32 v82,v82,s36,v18
v_mfma_f32_16x16x32_bf16 v[224:227],a[240:243],v[100:103],0
buffer_load_dwordx4 v7,s[8:11],s21 offen offset:256 lds
v_mfma_f32_16x16x32_bf16 a[16:19],a[240:243],v[104:107],0
s_add_u32 s21,s21,12288
ds_read_b128 a[236:239],v2 offset:32768
v_fma_f32 v83,v83,s36,v18
v_mfma_f32_16x16x32_bf16 a[64:67],a[240:243],v[108:111],0
s_add_u32 m0,s22,12288
ds_read_b64_tr_b16 a[240:241],v3 offset:2048
ds_read_b64_tr_b16 a[242:243],v3 offset:8192
v_mfma_f32_16x16x32_bf16 v[180:183],a[244:247],v[96:99],0
v_fma_f32 v84,v84,s36,v18
v_fma_f32 v85,v85,s36,v18
v_mfma_f32_16x16x32_bf16 v[228:231],a[244:247],v[100:103],0
v_fma_f32 v86,v86,s36,v18
v_fma_f32 v87,v87,s36,v18
v_mfma_f32_16x16x32_bf16 a[20:23],a[244:247],v[104:107],0
v_fma_f32 v88,v88,s36,v19
v_fma_f32 v89,v89,s36,v19
v_mfma_f32_16x16x32_bf16 a[68:71],a[244:247],v[108:111],0
s_waitcnt lgkmcnt(4)
ds_read_b64_tr_b16 a[244:245],v4 offset:2048
ds_read_b64_tr_b16 a[246:247],v4 offset:8192
v_mfma_f32_16x16x32_bf16 v[184:187],a[248:251],v[96:99],0
buffer_load_dwordx4 v7,s[4:7],s20 offen offset:0 lds
v_mfma_f32_16x16x32_bf16 v[232:235],a[248:251],v[100:103],0
s_add_u32 m0,s22,13184
v_fma_f32 v90,v90,s36,v19
v_fma_f32 v91,v91,s36,v19
v_mfma_f32_16x16x32_bf16 a[24:27],a[248:251],v[104:107],0
v_fma_f32 v92,v92,s36,v19
v_fma_f32 v93,v93,s36,v19
v_mfma_f32_16x16x32_bf16 a[72:75],a[248:251],v[108:111],0
ds_read_b64_tr_b16 a[248:249],v5 offset:2048
ds_read_b64_tr_b16 a[250:251],v5 offset:8192
v_mfma_f32_16x16x32_bf16 v[188:191],a[252:255],v[96:99],0
v_fma_f32 v94,v94,s36,v19
v_fma_f32 v95,v95,s36,v19
v_mfma_f32_16x16x32_bf16 v[236:239],a[252:255],v[100:103],0
v_exp_f32 v68,v68
v_mfma_f32_16x16x32_bf16 a[28:31],a[252:255],v[104:107],0
v_exp_f32 v69,v69
v_mfma_f32_16x16x32_bf16 a[76:79],a[252:255],v[108:111],0
s_waitcnt lgkmcnt(2)
ds_read_b64_tr_b16 a[252:253],v6 offset:2048
ds_read_b64_tr_b16 a[254:255],v6 offset:8192
v_mfma_f32_16x16x32_bf16 v[192:195],a[240:243],v[96:99],0
buffer_load_dwordx4 v7,s[4:7],s20 offen offset:128 lds
v_mfma_f32_16x16x32_bf16 v[240:243],a[240:243],v[100:103],0
s_add_u32 m0,s22,14080
v_exp_f32 v70,v70
v_mfma_f32_16x16x32_bf16 a[32:35],a[240:243],v[104:107],0
v_exp_f32 v71,v71
v_mfma_f32_16x16x32_bf16 a[80:83],a[240:243],v[108:111],0
v_exp_f32 v76,v76
v_mfma_f32_16x16x32_bf16 v[196:199],a[244:247],v[96:99],0
v_exp_f32 v77,v77
v_mfma_f32_16x16x32_bf16 v[244:247],a[244:247],v[100:103],0
v_exp_f32 v78,v78
v_mfma_f32_16x16x32_bf16 a[36:39],a[244:247],v[104:107],0
v_exp_f32 v79,v79
v_mfma_f32_16x16x32_bf16 a[84:87],a[244:247],v[108:111],0
s_waitcnt lgkmcnt(0)
v_exp_f32 v80,v80
v_mfma_f32_16x16x32_bf16 v[200:203],a[248:251],v[96:99],0
buffer_load_dwordx4 v7,s[4:7],s20 offen offset:256 lds
v_mfma_f32_16x16x32_bf16 v[248:251],a[248:251],v[100:103],0
s_add_u32 s20,s20,12288
v_exp_f32 v81,v81
v_mfma_f32_16x16x32_bf16 a[40:43],a[248:251],v[104:107],0
v_exp_f32 v82,v82
v_mfma_f32_16x16x32_bf16 a[88:91],a[248:251],v[108:111],0
v_exp_f32 v83,v83
v_mfma_f32_16x16x32_bf16 v[204:207],a[252:255],v[96:99],0
v_exp_f32 v84,v84
v_mfma_f32_16x16x32_bf16 v[252:255],a[252:255],v[100:103],0
v_exp_f32 v85,v85
v_mfma_f32_16x16x32_bf16 a[44:47],a[252:255],v[104:107],0
v_exp_f32 v86,v86
v_mfma_f32_16x16x32_bf16 a[92:95],a[252:255],v[108:111],0
v_exp_f32 v87,v87
v_mfma_f32_16x16x32_bf16 v[32:35],a[192:195],a[96:99],0
v_exp_f32 v88,v88
v_mfma_f32_16x16x32_bf16 v[32:35],a[196:199],a[100:103],v[32:35]
v_exp_f32 v89,v89
v_mfma_f32_16x16x32_bf16 v[32:35],a[200:203],a[104:107],v[32:35]
v_exp_f32 v90,v90
v_mfma_f32_16x16x32_bf16 v[32:35],a[204:207],a[108:111],v[32:35]
v_exp_f32 v91,v91
v_mfma_f32_16x16x32_bf16 v[32:35],a[208:211],a[112:115],v[32:35]
v_exp_f32 v92,v92
v_mfma_f32_16x16x32_bf16 v[32:35],a[212:215],a[116:119],v[32:35]
v_exp_f32 v93,v93
v_mfma_f32_16x16x32_bf16 v[40:43],a[192:195],a[120:123],0
v_exp_f32 v94,v94
v_mfma_f32_16x16x32_bf16 v[40:43],a[196:199],a[124:127],v[40:43]
v_exp_f32 v95,v95
v_mfma_f32_16x16x32_bf16 v[40:43],a[200:203],a[128:131],v[40:43]
v_cvt_pk_bf16_f32 v114,v68,v69
v_cvt_pk_bf16_f32 v115,v70,v71
v_mfma_f32_16x16x32_bf16 v[40:43],a[204:207],a[132:135],v[40:43]
v_cvt_pk_bf16_f32 v118,v76,v77
v_cvt_pk_bf16_f32 v119,v78,v79
v_mfma_f32_16x16x32_bf16 v[128:131],v[24:27],v[112:115],v[128:131]
v_cvt_pk_bf16_f32 v120,v80,v81
v_cvt_pk_bf16_f32 v121,v82,v83
v_mfma_f32_16x16x32_bf16 v[132:135],v[24:27],v[116:119],v[132:135]
v_cvt_pk_bf16_f32 v122,v84,v85
v_cvt_pk_bf16_f32 v123,v86,v87
v_mfma_f32_16x16x32_bf16 v[40:43],a[208:211],a[136:139],v[40:43]
v_cvt_pk_bf16_f32 v124,v88,v89
v_cvt_pk_bf16_f32 v125,v90,v91
v_mfma_f32_16x16x32_bf16 v[136:139],v[24:27],v[120:123],v[136:139]
v_cvt_pk_bf16_f32 v126,v92,v93
v_cvt_pk_bf16_f32 v127,v94,v95
v_mfma_f32_16x16x32_bf16 v[40:43],a[212:215],a[140:143],v[40:43]
v_fma_f32 v32,v32,s36,v16
v_fma_f32 v33,v33,s36,v16
v_mfma_f32_16x16x32_bf16 v[140:143],v[24:27],v[124:127],v[140:143]
v_fma_f32 v34,v34,s36,v16
v_fma_f32 v35,v35,s36,v16
v_mfma_f32_16x16x32_bf16 v[48:51],a[192:195],a[144:147],0
v_exp_f32 v32,v32
v_mfma_f32_16x16x32_bf16 v[48:51],a[196:199],a[148:151],v[48:51]
v_fma_f32 v40,v40,s36,v17
v_fma_f32 v41,v41,s36,v17
v_mfma_f32_16x16x32_bf16 v[48:51],a[200:203],a[152:155],v[48:51]
v_fma_f32 v42,v42,s36,v17
v_fma_f32 v43,v43,s36,v17
v_mfma_f32_16x16x32_bf16 v[48:51],a[204:207],a[156:159],v[48:51]
v_exp_f32 v33,v33
v_mfma_f32_16x16x32_bf16 v[48:51],a[208:211],a[160:163],v[48:51]
v_exp_f32 v34,v34
v_mfma_f32_16x16x32_bf16 v[48:51],a[212:215],a[164:167],v[48:51]
v_exp_f32 v35,v35
v_mfma_f32_16x16x32_bf16 v[56:59],a[192:195],a[168:171],0
v_exp_f32 v40,v40
v_mfma_f32_16x16x32_bf16 v[56:59],a[196:199],a[172:175],v[56:59]
v_exp_f32 v41,v41
v_mfma_f32_16x16x32_bf16 v[56:59],a[200:203],a[176:179],v[56:59]
v_exp_f32 v42,v42
v_mfma_f32_16x16x32_bf16 v[56:59],a[204:207],a[180:183],v[56:59]
v_exp_f32 v43,v43
v_mfma_f32_16x16x32_bf16 v[56:59],a[208:211],a[184:187],v[56:59]
v_cvt_pk_bf16_f32 v96,v32,v33
v_cvt_pk_bf16_f32 v97,v34,v35
v_mfma_f32_16x16x32_bf16 v[56:59],a[212:215],a[188:191],v[56:59]
v_cvt_pk_bf16_f32 v100,v40,v41
v_cvt_pk_bf16_f32 v101,v42,v43
v_mfma_f32_16x16x32_bf16 v[36:39],a[216:219],a[96:99],0
v_mfma_f32_16x16x32_bf16 v[36:39],a[220:223],a[100:103],v[36:39]
v_mfma_f32_16x16x32_bf16 v[36:39],a[224:227],a[104:107],v[36:39]
v_mfma_f32_16x16x32_bf16 v[36:39],a[228:231],a[108:111],v[36:39]
v_mfma_f32_16x16x32_bf16 v[36:39],a[232:235],a[112:115],v[36:39]
v_mfma_f32_16x16x32_bf16 v[36:39],a[236:239],a[116:119],v[36:39]
v_mfma_f32_16x16x32_bf16 v[44:47],a[216:219],a[120:123],0
v_mfma_f32_16x16x32_bf16 v[44:47],a[220:223],a[124:127],v[44:47]
v_mfma_f32_16x16x32_bf16 v[44:47],a[224:227],a[128:131],v[44:47]
v_mfma_f32_16x16x32_bf16 v[44:47],a[228:231],a[132:135],v[44:47]
v_mfma_f32_16x16x32_bf16 v[44:47],a[232:235],a[136:139],v[44:47]
s_waitcnt vmcnt(6)
s_barrier
v_mfma_f32_16x16x32_bf16 v[44:47],a[236:239],a[140:143],v[44:47]
v_mfma_f32_16x16x32_bf16 v[52:55],a[216:219],a[144:147],0
ds_read_b64_tr_b16 a[240:241],v3 offset:12288
ds_read_b64_tr_b16 a[242:243],v3 offset:18432
v_mfma_f32_16x16x32_bf16 v[52:55],a[220:223],a[148:151],v[52:55]
v_mfma_f32_16x16x32_bf16 v[52:55],a[224:227],a[152:155],v[52:55]
ds_read_b64_tr_b16 a[244:245],v4 offset:12288
ds_read_b64_tr_b16 a[246:247],v4 offset:18432
v_mfma_f32_16x16x32_bf16 v[52:55],a[228:231],a[156:159],v[52:55]
v_mfma_f32_16x16x32_bf16 v[52:55],a[232:235],a[160:163],v[52:55]
ds_read_b64_tr_b16 a[248:249],v5 offset:12288
ds_read_b64_tr_b16 a[250:251],v5 offset:18432
v_mfma_f32_16x16x32_bf16 v[52:55],a[236:239],a[164:167],v[52:55]
v_mfma_f32_16x16x32_bf16 v[60:63],a[216:219],a[168:171],0
ds_read_b64_tr_b16 a[252:253],v6 offset:12288
ds_read_b64_tr_b16 a[254:255],v6 offset:18432
v_mfma_f32_16x16x32_bf16 v[60:63],a[220:223],a[172:175],v[60:63]
v_mfma_f32_16x16x32_bf16 v[60:63],a[224:227],a[176:179],v[60:63]
v_mfma_f32_16x16x32_bf16 v[60:63],a[228:231],a[180:183],v[60:63]
v_mfma_f32_16x16x32_bf16 v[60:63],a[232:235],a[184:187],v[60:63]
v_mfma_f32_16x16x32_bf16 v[60:63],a[236:239],a[188:191],v[60:63]
s_waitcnt lgkmcnt(4)
v_mfma_f32_16x16x32_bf16 v[160:163],a[240:243],v[112:115],v[160:163]
s_add_u32 m0,s23,0
ds_read_b128 a[192:195],v1 offset:0
v_fma_f32 v36,v36,s36,v16
v_mfma_f32_16x16x32_bf16 v[208:211],a[240:243],v[116:119],v[208:211]
buffer_load_dwordx4 v7,s[8:11],s21 offen offset:0 lds
v_mfma_f32_16x16x32_bf16 a[0:3],a[240:243],v[120:123],a[0:3]
s_add_u32 m0,s23,896
ds_read_b128 a[196:199],v2 offset:0
v_fma_f32 v37,v37,s36,v16
v_mfma_f32_16x16x32_bf16 a[48:51],a[240:243],v[124:127],a[48:51]
ds_read_b64_tr_b16 a[240:241],v3 offset:13312
ds_read_b64_tr_b16 a[242:243],v3 offset:19456
v_mfma_f32_16x16x32_bf16 v[164:167],a[244:247],v[112:115],v[164:167]
ds_read_b128 a[200:203],v1 offset:1024
v_fma_f32 v38,v38,s36,v16
v_mfma_f32_16x16x32_bf16 v[212:215],a[244:247],v[116:119],v[212:215]
ds_read_b128 a[204:207],v2 offset:1024
v_fma_f32 v39,v39,s36,v16
v_mfma_f32_16x16x32_bf16 a[4:7],a[244:247],v[120:123],a[4:7]
ds_read_b128 a[208:211],v1 offset:2048
v_fma_f32 v44,v44,s36,v17
v_mfma_f32_16x16x32_bf16 a[52:55],a[244:247],v[124:127],a[52:55]
s_waitcnt lgkmcnt(7)
ds_read_b64_tr_b16 a[244:245],v4 offset:13312
ds_read_b64_tr_b16 a[246:247],v4 offset:19456
v_mfma_f32_16x16x32_bf16 v[168:171],a[248:251],v[112:115],v[168:171]
ds_read_b128 a[212:215],v2 offset:2048
v_fma_f32 v45,v45,s36,v17
v_mfma_f32_16x16x32_bf16 v[216:219],a[248:251],v[116:119],v[216:219]
buffer_load_dwordx4 v7,s[8:11],s21 offen offset:128 lds
v_mfma_f32_16x16x32_bf16 a[8:11],a[248:251],v[120:123],a[8:11]
s_add_u32 m0,s23,1792
ds_read_b128 a[216:219],v1 offset:6144
v_fma_f32 v46,v46,s36,v17
v_mfma_f32_16x16x32_bf16 a[56:59],a[248:251],v[124:127],a[56:59]
ds_read_b64_tr_b16 a[248:249],v5 offset:13312
ds_read_b64_tr_b16 a[250:251],v5 offset:19456
v_mfma_f32_16x16x32_bf16 v[172:175],a[252:255],v[112:115],v[172:175]
ds_read_b128 a[220:223],v2 offset:6144
v_fma_f32 v47,v47,s36,v17
v_mfma_f32_16x16x32_bf16 v[220:223],a[252:255],v[116:119],v[220:223]
ds_read_b128 a[224:227],v1 offset:7168
v_fma_f32 v48,v48,s36,v18
v_mfma_f32_16x16x32_bf16 a[12:15],a[252:255],v[120:123],a[12:15]
ds_read_b128 a[228:231],v2 offset:7168
v_fma_f32 v49,v49,s36,v18
v_mfma_f32_16x16x32_bf16 a[60:63],a[252:255],v[124:127],a[60:63]
s_waitcnt lgkmcnt(7)
ds_read_b64_tr_b16 a[252:253],v6 offset:13312
ds_read_b64_tr_b16 a[254:255],v6 offset:19456
v_mfma_f32_16x16x32_bf16 v[176:179],a[240:243],v[112:115],v[176:179]
ds_read_b128 a[232:235],v1 offset:8192
v_fma_f32 v50,v50,s36,v18
v_mfma_f32_16x16x32_bf16 v[224:227],a[240:243],v[116:119],v[224:227]
buffer_load_dwordx4 v7,s[8:11],s21 offen offset:256 lds
v_mfma_f32_16x16x32_bf16 a[16:19],a[240:243],v[120:123],a[16:19]
s_add_u32 s21,s21,12288
ds_read_b128 a[236:239],v2 offset:8192
v_fma_f32 v51,v51,s36,v18
v_mfma_f32_16x16x32_bf16 a[64:67],a[240:243],v[124:127],a[64:67]
s_add_u32 m0,s22,24576
ds_read_b64_tr_b16 a[240:241],v3 offset:14336
ds_read_b64_tr_b16 a[242:243],v3 offset:20480
v_mfma_f32_16x16x32_bf16 v[180:183],a[244:247],v[112:115],v[180:183]
v_fma_f32 v52,v52,s36,v18
v_fma_f32 v53,v53,s36,v18
v_mfma_f32_16x16x32_bf16 v[228:231],a[244:247],v[116:119],v[228:231]
v_fma_f32 v54,v54,s36,v18
v_fma_f32 v55,v55,s36,v18
v_mfma_f32_16x16x32_bf16 a[20:23],a[244:247],v[120:123],a[20:23]
v_fma_f32 v56,v56,s36,v19
v_fma_f32 v57,v57,s36,v19
v_mfma_f32_16x16x32_bf16 a[68:71],a[244:247],v[124:127],a[68:71]
s_waitcnt lgkmcnt(4)
ds_read_b64_tr_b16 a[244:245],v4 offset:14336
ds_read_b64_tr_b16 a[246:247],v4 offset:20480
v_mfma_f32_16x16x32_bf16 v[184:187],a[248:251],v[112:115],v[184:187]
buffer_load_dwordx4 v7,s[4:7],s20 offen offset:0 lds
v_mfma_f32_16x16x32_bf16 v[232:235],a[248:251],v[116:119],v[232:235]
s_add_u32 m0,s22,25472
v_fma_f32 v58,v58,s36,v19
v_fma_f32 v59,v59,s36,v19
v_mfma_f32_16x16x32_bf16 a[24:27],a[248:251],v[120:123],a[24:27]
v_fma_f32 v60,v60,s36,v19
v_fma_f32 v61,v61,s36,v19
v_mfma_f32_16x16x32_bf16 a[72:75],a[248:251],v[124:127],a[72:75]
ds_read_b64_tr_b16 a[248:249],v5 offset:14336
ds_read_b64_tr_b16 a[250:251],v5 offset:20480
v_mfma_f32_16x16x32_bf16 v[188:191],a[252:255],v[112:115],v[188:191]
v_fma_f32 v62,v62,s36,v19
v_fma_f32 v63,v63,s36,v19
v_mfma_f32_16x16x32_bf16 v[236:239],a[252:255],v[116:119],v[236:239]
v_exp_f32 v36,v36
v_mfma_f32_16x16x32_bf16 a[28:31],a[252:255],v[120:123],a[28:31]
v_exp_f32 v37,v37
v_mfma_f32_16x16x32_bf16 a[76:79],a[252:255],v[124:127],a[76:79]
s_waitcnt lgkmcnt(2)
ds_read_b64_tr_b16 a[252:253],v6 offset:14336
ds_read_b64_tr_b16 a[254:255],v6 offset:20480
v_mfma_f32_16x16x32_bf16 v[192:195],a[240:243],v[112:115],v[192:195]
buffer_load_dwordx4 v7,s[4:7],s20 offen offset:128 lds
v_mfma_f32_16x16x32_bf16 v[240:243],a[240:243],v[116:119],v[240:243]
s_add_u32 m0,s22,26368
v_exp_f32 v38,v38
v_mfma_f32_16x16x32_bf16 a[32:35],a[240:243],v[120:123],a[32:35]
v_exp_f32 v39,v39
v_mfma_f32_16x16x32_bf16 a[80:83],a[240:243],v[124:127],a[80:83]
v_exp_f32 v44,v44
v_mfma_f32_16x16x32_bf16 v[196:199],a[244:247],v[112:115],v[196:199]
v_exp_f32 v45,v45
v_mfma_f32_16x16x32_bf16 v[244:247],a[244:247],v[116:119],v[244:247]
v_exp_f32 v46,v46
v_mfma_f32_16x16x32_bf16 a[36:39],a[244:247],v[120:123],a[36:39]
v_exp_f32 v47,v47
v_mfma_f32_16x16x32_bf16 a[84:87],a[244:247],v[124:127],a[84:87]
s_waitcnt lgkmcnt(0)
v_exp_f32 v48,v48
v_mfma_f32_16x16x32_bf16 v[200:203],a[248:251],v[112:115],v[200:203]
buffer_load_dwordx4 v7,s[4:7],s20 offen offset:256 lds
v_mfma_f32_16x16x32_bf16 v[248:251],a[248:251],v[116:119],v[248:251]
s_add_u32 s20,s20,12288
v_exp_f32 v49,v49
v_mfma_f32_16x16x32_bf16 a[40:43],a[248:251],v[120:123],a[40:43]
v_exp_f32 v50,v50
v_mfma_f32_16x16x32_bf16 a[88:91],a[248:251],v[124:127],a[88:91]
v_exp_f32 v51,v51
v_mfma_f32_16x16x32_bf16 v[204:207],a[252:255],v[112:115],v[204:207]
v_exp_f32 v52,v52
v_mfma_f32_16x16x32_bf16 v[252:255],a[252:255],v[116:119],v[252:255]
v_exp_f32 v53,v53
v_mfma_f32_16x16x32_bf16 a[44:47],a[252:255],v[120:123],a[44:47]
v_exp_f32 v54,v54
v_mfma_f32_16x16x32_bf16 a[92:95],a[252:255],v[124:127],a[92:95]
v_exp_f32 v55,v55
v_mfma_f32_16x16x32_bf16 v[64:67],a[192:195],a[96:99],0
v_exp_f32 v56,v56
v_mfma_f32_16x16x32_bf16 v[64:67],a[196:199],a[100:103],v[64:67]
v_exp_f32 v57,v57
v_mfma_f32_16x16x32_bf16 v[64:67],a[200:203],a[104:107],v[64:67]
v_exp_f32 v58,v58
v_mfma_f32_16x16x32_bf16 v[64:67],a[204:207],a[108:111],v[64:67]
v_exp_f32 v59,v59
v_mfma_f32_16x16x32_bf16 v[64:67],a[208:211],a[112:115],v[64:67]
v_exp_f32 v60,v60
v_mfma_f32_16x16x32_bf16 v[64:67],a[212:215],a[116:119],v[64:67]
v_exp_f32 v61,v61
v_mfma_f32_16x16x32_bf16 v[72:75],a[192:195],a[120:123],0
v_exp_f32 v62,v62
v_mfma_f32_16x16x32_bf16 v[72:75],a[196:199],a[124:127],v[72:75]
v_exp_f32 v63,v63
v_mfma_f32_16x16x32_bf16 v[72:75],a[200:203],a[128:131],v[72:75]
v_cvt_pk_bf16_f32 v98,v36,v37
v_cvt_pk_bf16_f32 v99,v38,v39
v_mfma_f32_16x16x32_bf16 v[72:75],a[204:207],a[132:135],v[72:75]
v_cvt_pk_bf16_f32 v102,v44,v45
v_cvt_pk_bf16_f32 v103,v46,v47
v_mfma_f32_16x16x32_bf16 v[128:131],v[24:27],v[96:99],v[128:131]
v_cvt_pk_bf16_f32 v104,v48,v49
v_cvt_pk_bf16_f32 v105,v50,v51
v_mfma_f32_16x16x32_bf16 v[132:135],v[24:27],v[100:103],v[132:135]
v_cvt_pk_bf16_f32 v106,v52,v53
v_cvt_pk_bf16_f32 v107,v54,v55
v_mfma_f32_16x16x32_bf16 v[72:75],a[208:211],a[136:139],v[72:75]
v_cvt_pk_bf16_f32 v108,v56,v57
v_cvt_pk_bf16_f32 v109,v58,v59
v_mfma_f32_16x16x32_bf16 v[136:139],v[24:27],v[104:107],v[136:139]
v_cvt_pk_bf16_f32 v110,v60,v61
v_cvt_pk_bf16_f32 v111,v62,v63
v_mfma_f32_16x16x32_bf16 v[72:75],a[212:215],a[140:143],v[72:75]
v_fma_f32 v64,v64,s36,v16
v_fma_f32 v65,v65,s36,v16
v_mfma_f32_16x16x32_bf16 v[140:143],v[24:27],v[108:111],v[140:143]
v_fma_f32 v66,v66,s36,v16
v_fma_f32 v67,v67,s36,v16
v_mfma_f32_16x16x32_bf16 v[80:83],a[192:195],a[144:147],0
v_exp_f32 v64,v64
v_mfma_f32_16x16x32_bf16 v[80:83],a[196:199],a[148:151],v[80:83]
v_fma_f32 v72,v72,s36,v17
v_fma_f32 v73,v73,s36,v17
v_mfma_f32_16x16x32_bf16 v[80:83],a[200:203],a[152:155],v[80:83]
v_fma_f32 v74,v74,s36,v17
v_fma_f32 v75,v75,s36,v17
v_mfma_f32_16x16x32_bf16 v[80:83],a[204:207],a[156:159],v[80:83]
v_exp_f32 v65,v65
v_mfma_f32_16x16x32_bf16 v[80:83],a[208:211],a[160:163],v[80:83]
v_exp_f32 v66,v66
v_mfma_f32_16x16x32_bf16 v[80:83],a[212:215],a[164:167],v[80:83]
v_exp_f32 v67,v67
v_mfma_f32_16x16x32_bf16 v[88:91],a[192:195],a[168:171],0
v_exp_f32 v72,v72
v_mfma_f32_16x16x32_bf16 v[88:91],a[196:199],a[172:175],v[88:91]
v_exp_f32 v73,v73
v_mfma_f32_16x16x32_bf16 v[88:91],a[200:203],a[176:179],v[88:91]
v_exp_f32 v74,v74
v_mfma_f32_16x16x32_bf16 v[88:91],a[204:207],a[180:183],v[88:91]
v_exp_f32 v75,v75
v_mfma_f32_16x16x32_bf16 v[88:91],a[208:211],a[184:187],v[88:91]
v_cvt_pk_bf16_f32 v112,v64,v65
v_cvt_pk_bf16_f32 v113,v66,v67
v_mfma_f32_16x16x32_bf16 v[88:91],a[212:215],a[188:191],v[88:91]
v_cvt_pk_bf16_f32 v116,v72,v73
v_cvt_pk_bf16_f32 v117,v74,v75
v_mfma_f32_16x16x32_bf16 v[68:71],a[216:219],a[96:99],0
v_mfma_f32_16x16x32_bf16 v[68:71],a[220:223],a[100:103],v[68:71]
v_mfma_f32_16x16x32_bf16 v[68:71],a[224:227],a[104:107],v[68:71]
v_mfma_f32_16x16x32_bf16 v[68:71],a[228:231],a[108:111],v[68:71]
v_mfma_f32_16x16x32_bf16 v[68:71],a[232:235],a[112:115],v[68:71]
v_mfma_f32_16x16x32_bf16 v[68:71],a[236:239],a[116:119],v[68:71]
v_mfma_f32_16x16x32_bf16 v[76:79],a[216:219],a[120:123],0
v_mfma_f32_16x16x32_bf16 v[76:79],a[220:223],a[124:127],v[76:79]
v_mfma_f32_16x16x32_bf16 v[76:79],a[224:227],a[128:131],v[76:79]
v_mfma_f32_16x16x32_bf16 v[76:79],a[228:231],a[132:135],v[76:79]
v_mfma_f32_16x16x32_bf16 v[76:79],a[232:235],a[136:139],v[76:79]
s_waitcnt vmcnt(6)
s_barrier
v_mfma_f32_16x16x32_bf16 v[76:79],a[236:239],a[140:143],v[76:79]
v_mfma_f32_16x16x32_bf16 v[84:87],a[216:219],a[144:147],0
ds_read_b64_tr_b16 a[240:241],v3 offset:24576
ds_read_b64_tr_b16 a[242:243],v3 offset:30720
v_mfma_f32_16x16x32_bf16 v[84:87],a[220:223],a[148:151],v[84:87]
v_mfma_f32_16x16x32_bf16 v[84:87],a[224:227],a[152:155],v[84:87]
ds_read_b64_tr_b16 a[244:245],v4 offset:24576
ds_read_b64_tr_b16 a[246:247],v4 offset:30720
v_mfma_f32_16x16x32_bf16 v[84:87],a[228:231],a[156:159],v[84:87]
v_mfma_f32_16x16x32_bf16 v[84:87],a[232:235],a[160:163],v[84:87]
ds_read_b64_tr_b16 a[248:249],v5 offset:24576
ds_read_b64_tr_b16 a[250:251],v5 offset:30720
v_mfma_f32_16x16x32_bf16 v[84:87],a[236:239],a[164:167],v[84:87]
v_mfma_f32_16x16x32_bf16 v[92:95],a[216:219],a[168:171],0
ds_read_b64_tr_b16 a[252:253],v6 offset:24576
ds_read_b64_tr_b16 a[254:255],v6 offset:30720
v_mfma_f32_16x16x32_bf16 v[92:95],a[220:223],a[172:175],v[92:95]
v_mfma_f32_16x16x32_bf16 v[92:95],a[224:227],a[176:179],v[92:95]
v_mfma_f32_16x16x32_bf16 v[92:95],a[228:231],a[180:183],v[92:95]
v_mfma_f32_16x16x32_bf16 v[92:95],a[232:235],a[184:187],v[92:95]
v_mfma_f32_16x16x32_bf16 v[92:95],a[236:239],a[188:191],v[92:95]
s_mov_b32 s38,0
s_branch L_loop4
L_loop3:
s_bitcmp1_b32 s3,1
s_cbranch_scc1 L_loop3w1
.p2align 6
L_loop3w0:
s_waitcnt lgkmcnt(4)
v_mfma_f32_16x16x32_bf16 v[160:163],a[240:243],v[96:99],v[160:163]
s_add_u32 m0,s23,12288
ds_read_b128 a[192:195],v1 offset:12288
v_fma_f32 v68,v68,s36,v16
v_mfma_f32_16x16x32_bf16 v[208:211],a[240:243],v[100:103],v[208:211]
buffer_load_dwordx4 v7,s[8:11],s21 offen offset:0 lds
v_mfma_f32_16x16x32_bf16 a[0:3],a[240:243],v[104:107],a[0:3]
s_add_u32 m0,s23,13184
ds_read_b64_tr_b16 a[240:241],v3 offset:25600
ds_read_b64_tr_b16 a[242:243],v3 offset:31744
v_mfma_f32_16x16x32_bf16 v[164:167],a[244:247],v[96:99],v[164:167]
ds_read_b128 a[196:199],v2 offset:12288
v_fma_f32 v69,v69,s36,v16
v_mfma_f32_16x16x32_bf16 v[212:215],a[244:247],v[100:103],v[212:215]
ds_read_b128 a[200:203],v1 offset:13312
v_fma_f32 v70,v70,s36,v16
v_mfma_f32_16x16x32_bf16 a[4:7],a[244:247],v[104:107],a[4:7]
s_waitcnt lgkmcnt(5)
ds_read_b64_tr_b16 a[244:245],v4 offset:25600
ds_read_b64_tr_b16 a[246:247],v4 offset:31744
v_mfma_f32_16x16x32_bf16 v[168:171],a[248:251],v[96:99],v[168:171]
ds_read_b128 a[204:207],v2 offset:13312
v_fma_f32 v71,v71,s36,v16
v_mfma_f32_16x16x32_bf16 v[216:219],a[248:251],v[100:103],v[216:219]
buffer_load_dwordx4 v7,s[8:11],s21 offen offset:128 lds
v_mfma_f32_16x16x32_bf16 a[8:11],a[248:251],v[104:107],a[8:11]
s_add_u32 m0,s23,14080
ds_read_b64_tr_b16 a[248:249],v5 offset:25600
ds_read_b64_tr_b16 a[250:251],v5 offset:31744
v_mfma_f32_16x16x32_bf16 v[172:175],a[252:255],v[96:99],v[172:175]
ds_read_b128 a[208:211],v1 offset:14336
v_fma_f32 v76,v76,s36,v17
v_mfma_f32_16x16x32_bf16 v[220:223],a[252:255],v[100:103],v[220:223]
ds_read_b128 a[212:215],v2 offset:14336
v_fma_f32 v77,v77,s36,v17
v_mfma_f32_16x16x32_bf16 a[12:15],a[252:255],v[104:107],a[12:15]
s_waitcnt lgkmcnt(8)
ds_read_b64_tr_b16 a[252:253],v6 offset:25600
ds_read_b64_tr_b16 a[254:255],v6 offset:31744
v_mfma_f32_16x16x32_bf16 v[176:179],a[240:243],v[96:99],v[176:179]
buffer_load_dwordx4 v7,s[8:11],s21 offen offset:256 lds
v_mfma_f32_16x16x32_bf16 v[224:227],a[240:243],v[100:103],v[224:227]
s_add_u32 s21,s21,12288
ds_read_b128 a[216:219],v1 offset:18432
v_fma_f32 v78,v78,s36,v17
v_mfma_f32_16x16x32_bf16 a[16:19],a[240:243],v[104:107],a[16:19]
s_add_u32 m0,s22,0
ds_read_b64_tr_b16 a[240:241],v3 offset:26624
ds_read_b64_tr_b16 a[242:243],v3 offset:32768
s_waitcnt lgkmcnt(9)
v_mfma_f32_16x16x32_bf16 v[180:183],a[244:247],v[96:99],v[180:183]
ds_read_b128 a[220:223],v2 offset:18432
v_fma_f32 v79,v79,s36,v17
v_mfma_f32_16x16x32_bf16 v[228:231],a[244:247],v[100:103],v[228:231]
ds_read_b128 a[224:227],v1 offset:19456
v_fma_f32 v80,v80,s36,v18
v_mfma_f32_16x16x32_bf16 a[20:23],a[244:247],v[104:107],a[20:23]
s_waitcnt lgkmcnt(8)
ds_read_b64_tr_b16 a[244:245],v4 offset:26624
ds_read_b64_tr_b16 a[246:247],v4 offset:32768
v_mfma_f32_16x16x32_bf16 v[184:187],a[248:251],v[96:99],v[184:187]
buffer_load_dwordx4 v7,s[4:7],s20 offen offset:0 lds
v_mfma_f32_16x16x32_bf16 v[232:235],a[248:251],v[100:103],v[232:235]
s_add_u32 m0,s22,896
ds_read_b128 a[228:231],v2 offset:19456
v_fma_f32 v81,v81,s36,v18
v_mfma_f32_16x16x32_bf16 a[24:27],a[248:251],v[104:107],a[24:27]
s_waitcnt lgkmcnt(8)
ds_read_b64_tr_b16 a[248:249],v5 offset:26624
ds_read_b64_tr_b16 a[250:251],v5 offset:32768
v_mfma_f32_16x16x32_bf16 v[188:191],a[252:255],v[96:99],v[188:191]
ds_read_b128 a[232:235],v1 offset:20480
v_fma_f32 v82,v82,s36,v18
v_mfma_f32_16x16x32_bf16 v[236:239],a[252:255],v[100:103],v[236:239]
ds_read_b128 a[236:239],v2 offset:20480
v_fma_f32 v83,v83,s36,v18
v_mfma_f32_16x16x32_bf16 a[28:31],a[252:255],v[104:107],a[28:31]
s_waitcnt lgkmcnt(8)
ds_read_b64_tr_b16 a[252:253],v6 offset:26624
ds_read_b64_tr_b16 a[254:255],v6 offset:32768
v_mfma_f32_16x16x32_bf16 v[192:195],a[240:243],v[96:99],v[192:195]
buffer_load_dwordx4 v7,s[4:7],s20 offen offset:128 lds
v_mfma_f32_16x16x32_bf16 v[240:243],a[240:243],v[100:103],v[240:243]
s_add_u32 m0,s22,1792
ds_read_b128 v[152:155],v11 offset:0
v_fma_f32 v84,v84,s36,v18
v_mfma_f32_16x16x32_bf16 a[32:35],a[240:243],v[104:107],a[32:35]
s_waitcnt lgkmcnt(8)
v_fma_f32 v85,v85,s36,v18
v_fma_f32 v86,v86,s36,v18
v_mfma_f32_16x16x32_bf16 v[196:199],a[244:247],v[96:99],v[196:199]
v_fma_f32 v87,v87,s36,v18
v_mfma_f32_16x16x32_bf16 v[244:247],a[244:247],v[100:103],v[244:247]
v_exp_f32 v68,v68
v_mfma_f32_16x16x32_bf16 a[36:39],a[244:247],v[104:107],a[36:39]
s_waitcnt lgkmcnt(4)
v_exp_f32 v69,v69
v_mfma_f32_16x16x32_bf16 v[200:203],a[248:251],v[96:99],v[200:203]
buffer_load_dwordx4 v7,s[4:7],s20 offen offset:256 lds
v_mfma_f32_16x16x32_bf16 v[248:251],a[248:251],v[100:103],v[248:251]
s_add_u32 s20,s20,12288
v_exp_f32 v70,v70
v_mfma_f32_16x16x32_bf16 a[40:43],a[248:251],v[104:107],a[40:43]
s_waitcnt lgkmcnt(1)
v_exp_f32 v71,v71
v_mfma_f32_16x16x32_bf16 v[204:207],a[252:255],v[96:99],v[204:207]
v_exp_f32 v76,v76
v_mfma_f32_16x16x32_bf16 v[252:255],a[252:255],v[100:103],v[252:255]
v_exp_f32 v77,v77
v_mfma_f32_16x16x32_bf16 a[44:47],a[252:255],v[104:107],a[44:47]
v_exp_f32 v78,v78
v_mfma_f32_16x16x32_bf16 v[32:35],a[192:195],a[96:99],0
ds_read_b128 v[156:159],v11 offset:1024
v_cvt_pk_bf16_f32 v114,v68,v69
v_mfma_f32_16x16x32_bf16 v[32:35],a[196:199],a[100:103],v[32:35]
v_exp_f32 v79,v79
v_mfma_f32_16x16x32_bf16 v[32:35],a[200:203],a[104:107],v[32:35]
v_exp_f32 v80,v80
v_mfma_f32_16x16x32_bf16 v[32:35],a[204:207],a[108:111],v[32:35]
s_waitcnt lgkmcnt(1)
buffer_store_dwordx4 v[152:155],v10,s[16:19],s27 offen offset:0 nt
v_mfma_f32_16x16x32_bf16 v[32:35],a[208:211],a[112:115],v[32:35]
s_add_u32 m0,s29,0
v_exp_f32 v81,v81
v_mfma_f32_16x16x32_bf16 v[32:35],a[212:215],a[116:119],v[32:35]
v_exp_f32 v82,v82
v_mfma_f32_16x16x32_bf16 v[40:43],a[192:195],a[120:123],0
v_exp_f32 v83,v83
v_mfma_f32_16x16x32_bf16 v[40:43],a[196:199],a[124:127],v[40:43]
v_exp_f32 v84,v84
v_mfma_f32_16x16x32_bf16 v[40:43],a[200:203],a[128:131],v[40:43]
v_exp_f32 v85,v85
v_mfma_f32_16x16x32_bf16 v[40:43],a[204:207],a[132:135],v[40:43]
v_exp_f32 v86,v86
v_mfma_f32_16x16x32_bf16 v[40:43],a[208:211],a[136:139],v[40:43]
buffer_load_dwordx4 v8,s[12:15],s28 offen offset:0 nt lds
v_mfma_f32_16x16x32_bf16 v[40:43],a[212:215],a[140:143],v[40:43]
v_exp_f32 v87,v87
v_mfma_f32_16x16x32_bf16 v[48:51],a[192:195],a[144:147],0
v_cvt_pk_bf16_f32 v115,v70,v71
v_cvt_pk_bf16_f32 v118,v76,v77
v_mfma_f32_16x16x32_bf16 v[48:51],a[196:199],a[148:151],v[48:51]
v_cvt_pk_bf16_f32 v119,v78,v79
v_cvt_pk_bf16_f32 v120,v80,v81
v_mfma_f32_16x16x32_bf16 v[128:131],v[24:27],v[112:115],v[128:131]
v_cvt_pk_bf16_f32 v121,v82,v83
v_cvt_pk_bf16_f32 v122,v84,v85
v_mfma_f32_16x16x32_bf16 v[132:135],v[24:27],v[116:119],v[132:135]
v_cvt_pk_bf16_f32 v123,v86,v87
v_fma_f32 v32,v32,s36,v16
v_mfma_f32_16x16x32_bf16 v[48:51],a[200:203],a[152:155],v[48:51]
s_waitcnt lgkmcnt(0)
buffer_store_dwordx4 v[156:159],v10,s[16:19],s27 offen offset:128 nt
v_mfma_f32_16x16x32_bf16 v[136:139],v[24:27],v[120:123],v[136:139]
s_add_u32 m0,s29,896
v_fma_f32 v33,v33,s36,v16
v_fma_f32 v34,v34,s36,v16
v_mfma_f32_16x16x32_bf16 v[48:51],a[204:207],a[156:159],v[48:51]
v_fma_f32 v35,v35,s36,v16
v_fma_f32 v40,v40,s36,v17
v_mfma_f32_16x16x32_bf16 v[48:51],a[208:211],a[160:163],v[48:51]
v_fma_f32 v41,v41,s36,v17
v_fma_f32 v42,v42,s36,v17
v_mfma_f32_16x16x32_bf16 v[48:51],a[212:215],a[164:167],v[48:51]
v_fma_f32 v43,v43,s36,v17
v_mfma_f32_16x16x32_bf16 v[36:39],a[216:219],a[96:99],0
v_exp_f32 v32,v32
v_mfma_f32_16x16x32_bf16 v[36:39],a[220:223],a[100:103],v[36:39]
buffer_load_dwordx4 v8,s[12:15],s28 offen offset:128 nt lds
v_mfma_f32_16x16x32_bf16 v[36:39],a[224:227],a[104:107],v[36:39]
v_exp_f32 v33,v33
s_waitcnt vmcnt(10)
s_barrier
v_mfma_f32_16x16x32_bf16 v[36:39],a[228:231],a[108:111],v[36:39]
v_exp_f32 v34,v34
v_mfma_f32_16x16x32_bf16 v[36:39],a[232:235],a[112:115],v[36:39]
ds_read_b64_tr_b16 a[240:241],v3 offset:0
ds_read_b64_tr_b16 a[242:243],v3 offset:6144
v_mfma_f32_16x16x32_bf16 v[36:39],a[236:239],a[116:119],v[36:39]
v_exp_f32 v35,v35
v_mfma_f32_16x16x32_bf16 v[44:47],a[216:219],a[120:123],0
ds_read_b64_tr_b16 a[244:245],v4 offset:0
ds_read_b64_tr_b16 a[246:247],v4 offset:6144
v_mfma_f32_16x16x32_bf16 v[44:47],a[220:223],a[124:127],v[44:47]
ds_read_b64_tr_b16 a[248:249],v5 offset:0
ds_read_b64_tr_b16 a[250:251],v5 offset:6144
v_mfma_f32_16x16x32_bf16 v[44:47],a[224:227],a[128:131],v[44:47]
v_exp_f32 v40,v40
v_mfma_f32_16x16x32_bf16 v[44:47],a[228:231],a[132:135],v[44:47]
ds_read_b64_tr_b16 a[252:253],v6 offset:0
ds_read_b64_tr_b16 a[254:255],v6 offset:6144
v_mfma_f32_16x16x32_bf16 v[44:47],a[232:235],a[136:139],v[44:47]
v_exp_f32 v41,v41
v_mfma_f32_16x16x32_bf16 v[44:47],a[236:239],a[140:143],v[44:47]
v_exp_f32 v42,v42
v_mfma_f32_16x16x32_bf16 v[52:55],a[216:219],a[144:147],0
v_exp_f32 v43,v43
v_mfma_f32_16x16x32_bf16 v[52:55],a[220:223],a[148:151],v[52:55]
v_cvt_pk_bf16_f32 v96,v32,v33
v_cvt_pk_bf16_f32 v97,v34,v35
v_mfma_f32_16x16x32_bf16 v[52:55],a[224:227],a[152:155],v[52:55]
v_cvt_pk_bf16_f32 v100,v40,v41
v_cvt_pk_bf16_f32 v101,v42,v43
v_mfma_f32_16x16x32_bf16 v[52:55],a[228:231],a[156:159],v[52:55]
v_mfma_f32_16x16x32_bf16 v[52:55],a[232:235],a[160:163],v[52:55]
v_mfma_f32_16x16x32_bf16 v[52:55],a[236:239],a[164:167],v[52:55]
s_waitcnt lgkmcnt(2)
v_mfma_f32_16x16x32_bf16 v[160:163],a[240:243],v[112:115],v[160:163]
s_add_u32 m0,s23,24576
ds_read_b128 a[192:195],v1 offset:24576
v_fma_f32 v36,v36,s36,v16
v_mfma_f32_16x16x32_bf16 v[208:211],a[240:243],v[116:119],v[208:211]
buffer_load_dwordx4 v7,s[8:11],s21 offen offset:0 lds
v_mfma_f32_16x16x32_bf16 a[0:3],a[240:243],v[120:123],a[0:3]
s_add_u32 m0,s23,25472
ds_read_b64_tr_b16 a[240:241],v3 offset:1024
ds_read_b64_tr_b16 a[242:243],v3 offset:7168
v_mfma_f32_16x16x32_bf16 v[164:167],a[244:247],v[112:115],v[164:167]
ds_read_b128 a[196:199],v2 offset:24576
v_fma_f32 v37,v37,s36,v16
v_mfma_f32_16x16x32_bf16 v[212:215],a[244:247],v[116:119],v[212:215]
ds_read_b128 a[200:203],v1 offset:25600
v_fma_f32 v38,v38,s36,v16
v_mfma_f32_16x16x32_bf16 a[4:7],a[244:247],v[120:123],a[4:7]
ds_read_b64_tr_b16 a[244:245],v4 offset:1024
ds_read_b64_tr_b16 a[246:247],v4 offset:7168
v_mfma_f32_16x16x32_bf16 v[168:171],a[248:251],v[112:115],v[168:171]
ds_read_b128 a[204:207],v2 offset:25600
v_fma_f32 v39,v39,s36,v16
v_mfma_f32_16x16x32_bf16 v[216:219],a[248:251],v[116:119],v[216:219]
buffer_load_dwordx4 v7,s[8:11],s21 offen offset:128 lds
v_mfma_f32_16x16x32_bf16 a[8:11],a[248:251],v[120:123],a[8:11]
s_add_u32 m0,s23,26368
ds_read_b64_tr_b16 a[248:249],v5 offset:1024
ds_read_b64_tr_b16 a[250:251],v5 offset:7168
s_waitcnt lgkmcnt(9)
v_mfma_f32_16x16x32_bf16 v[172:175],a[252:255],v[112:115],v[172:175]
ds_read_b128 a[208:211],v1 offset:26624
v_fma_f32 v44,v44,s36,v17
v_mfma_f32_16x16x32_bf16 v[220:223],a[252:255],v[116:119],v[220:223]
ds_read_b128 a[212:215],v2 offset:26624
v_fma_f32 v45,v45,s36,v17
v_mfma_f32_16x16x32_bf16 a[12:15],a[252:255],v[120:123],a[12:15]
s_waitcnt lgkmcnt(8)
ds_read_b64_tr_b16 a[252:253],v6 offset:1024
ds_read_b64_tr_b16 a[254:255],v6 offset:7168
v_mfma_f32_16x16x32_bf16 v[176:179],a[240:243],v[112:115],v[176:179]
buffer_load_dwordx4 v7,s[8:11],s21 offen offset:256 lds
v_mfma_f32_16x16x32_bf16 v[224:227],a[240:243],v[116:119],v[224:227]
s_add_u32 s21,s21,12288
ds_read_b128 a[216:219],v1 offset:30720
v_fma_f32 v46,v46,s36,v17
v_mfma_f32_16x16x32_bf16 a[16:19],a[240:243],v[120:123],a[16:19]
s_add_u32 m0,s22,12288
ds_read_b64_tr_b16 a[240:241],v3 offset:2048
ds_read_b64_tr_b16 a[242:243],v3 offset:8192
s_waitcnt lgkmcnt(9)
v_mfma_f32_16x16x32_bf16 v[180:183],a[244:247],v[112:115],v[180:183]
ds_read_b128 a[220:223],v2 offset:30720
v_fma_f32 v47,v47,s36,v17
v_mfma_f32_16x16x32_bf16 v[228:231],a[244:247],v[116:119],v[228:231]
ds_read_b128 a[224:227],v1 offset:31744
v_fma_f32 v48,v48,s36,v18
v_mfma_f32_16x16x32_bf16 a[20:23],a[244:247],v[120:123],a[20:23]
s_waitcnt lgkmcnt(8)
ds_read_b64_tr_b16 a[244:245],v4 offset:2048
ds_read_b64_tr_b16 a[246:247],v4 offset:8192
v_mfma_f32_16x16x32_bf16 v[184:187],a[248:251],v[112:115],v[184:187]
buffer_load_dwordx4 v7,s[4:7],s20 offen offset:0 lds
v_mfma_f32_16x16x32_bf16 v[232:235],a[248:251],v[116:119],v[232:235]
s_add_u32 m0,s22,13184
ds_read_b128 a[228:231],v2 offset:31744
v_fma_f32 v49,v49,s36,v18
v_mfma_f32_16x16x32_bf16 a[24:27],a[248:251],v[120:123],a[24:27]
s_waitcnt lgkmcnt(8)
ds_read_b64_tr_b16 a[248:249],v5 offset:2048
ds_read_b64_tr_b16 a[250:251],v5 offset:8192
v_mfma_f32_16x16x32_bf16 v[188:191],a[252:255],v[112:115],v[188:191]
ds_read_b128 a[232:235],v1 offset:32768
v_fma_f32 v50,v50,s36,v18
v_mfma_f32_16x16x32_bf16 v[236:239],a[252:255],v[116:119],v[236:239]
ds_read_b128 a[236:239],v2 offset:32768
v_fma_f32 v51,v51,s36,v18
v_mfma_f32_16x16x32_bf16 a[28:31],a[252:255],v[120:123],a[28:31]
s_waitcnt lgkmcnt(8)
ds_read_b64_tr_b16 a[252:253],v6 offset:2048
ds_read_b64_tr_b16 a[254:255],v6 offset:8192
v_mfma_f32_16x16x32_bf16 v[192:195],a[240:243],v[112:115],v[192:195]
buffer_load_dwordx4 v7,s[4:7],s20 offen offset:128 lds
v_mfma_f32_16x16x32_bf16 v[240:243],a[240:243],v[116:119],v[240:243]
s_add_u32 m0,s22,14080
ds_read_b128 v[152:155],v11 offset:2048
v_fma_f32 v52,v52,s36,v18
v_mfma_f32_16x16x32_bf16 a[32:35],a[240:243],v[120:123],a[32:35]
s_waitcnt lgkmcnt(8)
v_fma_f32 v53,v53,s36,v18
v_fma_f32 v54,v54,s36,v18
v_mfma_f32_16x16x32_bf16 v[196:199],a[244:247],v[112:115],v[196:199]
v_fma_f32 v55,v55,s36,v18
v_mfma_f32_16x16x32_bf16 v[244:247],a[244:247],v[116:119],v[244:247]
v_exp_f32 v36,v36
v_mfma_f32_16x16x32_bf16 a[36:39],a[244:247],v[120:123],a[36:39]
s_waitcnt lgkmcnt(4)
v_exp_f32 v37,v37
v_mfma_f32_16x16x32_bf16 v[200:203],a[248:251],v[112:115],v[200:203]
buffer_load_dwordx4 v7,s[4:7],s20 offen offset:256 lds
v_mfma_f32_16x16x32_bf16 v[248:251],a[248:251],v[116:119],v[248:251]
s_add_u32 s20,s20,12288
v_exp_f32 v38,v38
v_mfma_f32_16x16x32_bf16 a[40:43],a[248:251],v[120:123],a[40:43]
s_waitcnt lgkmcnt(1)
v_exp_f32 v39,v39
v_mfma_f32_16x16x32_bf16 v[204:207],a[252:255],v[112:115],v[204:207]
v_exp_f32 v44,v44
v_mfma_f32_16x16x32_bf16 v[252:255],a[252:255],v[116:119],v[252:255]
v_exp_f32 v45,v45
v_mfma_f32_16x16x32_bf16 a[44:47],a[252:255],v[120:123],a[44:47]
v_exp_f32 v46,v46
v_mfma_f32_16x16x32_bf16 v[64:67],a[192:195],a[96:99],0
v_exp_f32 v47,v47
v_mfma_f32_16x16x32_bf16 v[64:67],a[196:199],a[100:103],v[64:67]
v_exp_f32 v48,v48
v_mfma_f32_16x16x32_bf16 v[64:67],a[200:203],a[104:107],v[64:67]
v_exp_f32 v49,v49
v_mfma_f32_16x16x32_bf16 v[64:67],a[204:207],a[108:111],v[64:67]
s_waitcnt lgkmcnt(0)
buffer_store_dwordx4 v[152:155],v10,s[16:19],s27 offen offset:256 nt
v_mfma_f32_16x16x32_bf16 v[64:67],a[208:211],a[112:115],v[64:67]
s_add_u32 m0,s29,1792
v_exp_f32 v50,v50
v_mfma_f32_16x16x32_bf16 v[64:67],a[212:215],a[116:119],v[64:67]
v_exp_f32 v51,v51
v_mfma_f32_16x16x32_bf16 v[72:75],a[192:195],a[120:123],0
v_exp_f32 v52,v52
v_mfma_f32_16x16x32_bf16 v[72:75],a[196:199],a[124:127],v[72:75]
v_exp_f32 v53,v53
v_mfma_f32_16x16x32_bf16 v[72:75],a[200:203],a[128:131],v[72:75]
v_exp_f32 v54,v54
v_mfma_f32_16x16x32_bf16 v[72:75],a[204:207],a[132:135],v[72:75]
v_exp_f32 v55,v55
v_mfma_f32_16x16x32_bf16 v[72:75],a[208:211],a[136:139],v[72:75]
v_cvt_pk_bf16_f32 v98,v36,v37
v_cvt_pk_bf16_f32 v99,v38,v39
v_mfma_f32_16x16x32_bf16 v[72:75],a[212:215],a[140:143],v[72:75]
v_cvt_pk_bf16_f32 v102,v44,v45
v_cvt_pk_bf16_f32 v103,v46,v47
v_mfma_f32_16x16x32_bf16 v[128:131],v[24:27],v[96:99],v[128:131]
v_cvt_pk_bf16_f32 v104,v48,v49
v_cvt_pk_bf16_f32 v105,v50,v51
v_mfma_f32_16x16x32_bf16 v[132:135],v[24:27],v[100:103],v[132:135]
v_cvt_pk_bf16_f32 v106,v52,v53
v_cvt_pk_bf16_f32 v107,v54,v55
v_mfma_f32_16x16x32_bf16 v[80:83],a[192:195],a[144:147],0
v_fma_f32 v64,v64,s36,v16
v_fma_f32 v65,v65,s36,v16
v_mfma_f32_16x16x32_bf16 v[136:139],v[24:27],v[104:107],v[136:139]
v_fma_f32 v66,v66,s36,v16
v_fma_f32 v67,v67,s36,v16
v_mfma_f32_16x16x32_bf16 v[80:83],a[196:199],a[148:151],v[80:83]
buffer_load_dwordx4 v8,s[12:15],s28 offen offset:256 nt lds
v_mfma_f32_16x16x32_bf16 v[80:83],a[200:203],a[152:155],v[80:83]
s_add_u32 s27,s27,3072
v_fma_f32 v72,v72,s36,v17
v_fma_f32 v73,v73,s36,v17
v_mfma_f32_16x16x32_bf16 v[80:83],a[204:207],a[156:159],v[80:83]
s_add_u32 s28,s28,3072
v_fma_f32 v74,v74,s36,v17
v_fma_f32 v75,v75,s36,v17
v_mfma_f32_16x16x32_bf16 v[80:83],a[208:211],a[160:163],v[80:83]
s_add_u32 s29,s29,3072
v_exp_f32 v64,v64
v_mfma_f32_16x16x32_bf16 v[80:83],a[212:215],a[164:167],v[80:83]
v_exp_f32 v65,v65
v_mfma_f32_16x16x32_bf16 v[68:71],a[216:219],a[96:99],0
v_exp_f32 v66,v66
v_mfma_f32_16x16x32_bf16 v[68:71],a[220:223],a[100:103],v[68:71]
v_exp_f32 v67,v67
v_mfma_f32_16x16x32_bf16 v[68:71],a[224:227],a[104:107],v[68:71]
v_exp_f32 v72,v72
v_mfma_f32_16x16x32_bf16 v[68:71],a[228:231],a[108:111],v[68:71]
s_waitcnt vmcnt(12)
s_barrier
v_mfma_f32_16x16x32_bf16 v[68:71],a[232:235],a[112:115],v[68:71]
v_exp_f32 v73,v73
v_mfma_f32_16x16x32_bf16 v[68:71],a[236:239],a[116:119],v[68:71]
ds_read_b64_tr_b16 a[240:241],v3 offset:12288
ds_read_b64_tr_b16 a[242:243],v3 offset:18432
v_mfma_f32_16x16x32_bf16 v[76:79],a[216:219],a[120:123],0
v_exp_f32 v74,v74
v_mfma_f32_16x16x32_bf16 v[76:79],a[220:223],a[124:127],v[76:79]
ds_read_b64_tr_b16 a[244:245],v4 offset:12288
ds_read_b64_tr_b16 a[246:247],v4 offset:18432
v_mfma_f32_16x16x32_bf16 v[76:79],a[224:227],a[128:131],v[76:79]
ds_read_b64_tr_b16 a[248:249],v5 offset:12288
ds_read_b64_tr_b16 a[250:251],v5 offset:18432
v_mfma_f32_16x16x32_bf16 v[76:79],a[228:231],a[132:135],v[76:79]
v_exp_f32 v75,v75
v_mfma_f32_16x16x32_bf16 v[76:79],a[232:235],a[136:139],v[76:79]
ds_read_b64_tr_b16 a[252:253],v6 offset:12288
ds_read_b64_tr_b16 a[254:255],v6 offset:18432
v_mfma_f32_16x16x32_bf16 v[76:79],a[236:239],a[140:143],v[76:79]
v_cvt_pk_bf16_f32 v112,v64,v65
v_cvt_pk_bf16_f32 v113,v66,v67
v_mfma_f32_16x16x32_bf16 v[84:87],a[216:219],a[144:147],0
v_cvt_pk_bf16_f32 v116,v72,v73
v_cvt_pk_bf16_f32 v117,v74,v75
v_mfma_f32_16x16x32_bf16 v[84:87],a[220:223],a[148:151],v[84:87]
v_mfma_f32_16x16x32_bf16 v[84:87],a[224:227],a[152:155],v[84:87]
v_mfma_f32_16x16x32_bf16 v[84:87],a[228:231],a[156:159],v[84:87]
v_mfma_f32_16x16x32_bf16 v[84:87],a[232:235],a[160:163],v[84:87]
v_mfma_f32_16x16x32_bf16 v[84:87],a[236:239],a[164:167],v[84:87]
s_waitcnt lgkmcnt(2)
v_mfma_f32_16x16x32_bf16 v[160:163],a[240:243],v[96:99],v[160:163]
s_add_u32 m0,s23,0
ds_read_b128 a[192:195],v1 offset:0
v_fma_f32 v68,v68,s36,v16
v_mfma_f32_16x16x32_bf16 v[208:211],a[240:243],v[100:103],v[208:211]
buffer_load_dwordx4 v7,s[8:11],s21 offen offset:0 lds
v_mfma_f32_16x16x32_bf16 a[0:3],a[240:243],v[104:107],a[0:3]
s_add_u32 m0,s23,896
ds_read_b64_tr_b16 a[240:241],v3 offset:13312
ds_read_b64_tr_b16 a[242:243],v3 offset:19456
v_mfma_f32_16x16x32_bf16 v[164:167],a[244:247],v[96:99],v[164:167]
ds_read_b128 a[196:199],v2 offset:0
v_fma_f32 v69,v69,s36,v16
v_mfma_f32_16x16x32_bf16 v[212:215],a[244:247],v[100:103],v[212:215]
ds_read_b128 a[200:203],v1 offset:1024
v_fma_f32 v70,v70,s36,v16
v_mfma_f32_16x16x32_bf16 a[4:7],a[244:247],v[104:107],a[4:7]
ds_read_b64_tr_b16 a[244:245],v4 offset:13312
ds_read_b64_tr_b16 a[246:247],v4 offset:19456
v_mfma_f32_16x16x32_bf16 v[168:171],a[248:251],v[96:99],v[168:171]
ds_read_b128 a[204:207],v2 offset:1024
v_fma_f32 v71,v71,s36,v16
v_mfma_f32_16x16x32_bf16 v[216:219],a[248:251],v[100:103],v[216:219]
buffer_load_dwordx4 v7,s[8:11],s21 offen offset:128 lds
v_mfma_f32_16x16x32_bf16 a[8:11],a[248:251],v[104:107],a[8:11]
s_add_u32 m0,s23,1792
ds_read_b64_tr_b16 a[248:249],v5 offset:13312
ds_read_b64_tr_b16 a[250:251],v5 offset:19456
s_waitcnt lgkmcnt(9)
v_mfma_f32_16x16x32_bf16 v[172:175],a[252:255],v[96:99],v[172:175]
ds_read_b128 a[208:211],v1 offset:2048
v_fma_f32 v76,v76,s36,v17
v_mfma_f32_16x16x32_bf16 v[220:223],a[252:255],v[100:103],v[220:223]
ds_read_b128 a[212:215],v2 offset:2048
v_fma_f32 v77,v77,s36,v17
v_mfma_f32_16x16x32_bf16 a[12:15],a[252:255],v[104:107],a[12:15]
s_waitcnt lgkmcnt(8)
ds_read_b64_tr_b16 a[252:253],v6 offset:13312
ds_read_b64_tr_b16 a[254:255],v6 offset:19456
v_mfma_f32_16x16x32_bf16 v[176:179],a[240:243],v[96:99],v[176:179]
buffer_load_dwordx4 v7,s[8:11],s21 offen offset:256 lds
v_mfma_f32_16x16x32_bf16 v[224:227],a[240:243],v[100:103],v[224:227]
s_add_u32 s21,s21,12288
ds_read_b128 a[216:219],v1 offset:6144
v_fma_f32 v78,v78,s36,v17
v_mfma_f32_16x16x32_bf16 a[16:19],a[240:243],v[104:107],a[16:19]
s_add_u32 m0,s22,24576
ds_read_b64_tr_b16 a[240:241],v3 offset:14336
ds_read_b64_tr_b16 a[242:243],v3 offset:20480
s_waitcnt lgkmcnt(9)
v_mfma_f32_16x16x32_bf16 v[180:183],a[244:247],v[96:99],v[180:183]
ds_read_b128 a[220:223],v2 offset:6144
v_fma_f32 v79,v79,s36,v17
v_mfma_f32_16x16x32_bf16 v[228:231],a[244:247],v[100:103],v[228:231]
ds_read_b128 a[224:227],v1 offset:7168
v_fma_f32 v80,v80,s36,v18
v_mfma_f32_16x16x32_bf16 a[20:23],a[244:247],v[104:107],a[20:23]
s_waitcnt lgkmcnt(8)
ds_read_b64_tr_b16 a[244:245],v4 offset:14336
ds_read_b64_tr_b16 a[246:247],v4 offset:20480
v_mfma_f32_16x16x32_bf16 v[184:187],a[248:251],v[96:99],v[184:187]
buffer_load_dwordx4 v7,s[4:7],s20 offen offset:0 lds
v_mfma_f32_16x16x32_bf16 v[232:235],a[248:251],v[100:103],v[232:235]
s_add_u32 m0,s22,25472
ds_read_b128 a[228:231],v2 offset:7168
v_fma_f32 v81,v81,s36,v18
v_mfma_f32_16x16x32_bf16 a[24:27],a[248:251],v[104:107],a[24:27]
s_waitcnt lgkmcnt(8)
ds_read_b64_tr_b16 a[248:249],v5 offset:14336
ds_read_b64_tr_b16 a[250:251],v5 offset:20480
v_mfma_f32_16x16x32_bf16 v[188:191],a[252:255],v[96:99],v[188:191]
ds_read_b128 a[232:235],v1 offset:8192
v_fma_f32 v82,v82,s36,v18
v_mfma_f32_16x16x32_bf16 v[236:239],a[252:255],v[100:103],v[236:239]
ds_read_b128 a[236:239],v2 offset:8192
v_fma_f32 v83,v83,s36,v18
v_mfma_f32_16x16x32_bf16 a[28:31],a[252:255],v[104:107],a[28:31]
s_waitcnt lgkmcnt(8)
ds_read_b64_tr_b16 a[252:253],v6 offset:14336
ds_read_b64_tr_b16 a[254:255],v6 offset:20480
v_mfma_f32_16x16x32_bf16 v[192:195],a[240:243],v[96:99],v[192:195]
buffer_load_dwordx4 v7,s[4:7],s20 offen offset:128 lds
v_mfma_f32_16x16x32_bf16 v[240:243],a[240:243],v[100:103],v[240:243]
s_add_u32 m0,s22,26368
ds_read_b128 v[156:159],v11 offset:3072
v_fma_f32 v84,v84,s36,v18
v_mfma_f32_16x16x32_bf16 a[32:35],a[240:243],v[104:107],a[32:35]
s_waitcnt lgkmcnt(8)
v_fma_f32 v85,v85,s36,v18
v_fma_f32 v86,v86,s36,v18
v_mfma_f32_16x16x32_bf16 v[196:199],a[244:247],v[96:99],v[196:199]
v_fma_f32 v87,v87,s36,v18
v_mfma_f32_16x16x32_bf16 v[244:247],a[244:247],v[100:103],v[244:247]
v_exp_f32 v68,v68
v_mfma_f32_16x16x32_bf16 a[36:39],a[244:247],v[104:107],a[36:39]
s_waitcnt lgkmcnt(4)
v_exp_f32 v69,v69
v_mfma_f32_16x16x32_bf16 v[200:203],a[248:251],v[96:99],v[200:203]
buffer_load_dwordx4 v7,s[4:7],s20 offen offset:256 lds
v_mfma_f32_16x16x32_bf16 v[248:251],a[248:251],v[100:103],v[248:251]
s_add_u32 s20,s20,12288
v_exp_f32 v70,v70
v_mfma_f32_16x16x32_bf16 a[40:43],a[248:251],v[104:107],a[40:43]
s_waitcnt lgkmcnt(1)
v_exp_f32 v71,v71
v_mfma_f32_16x16x32_bf16 v[204:207],a[252:255],v[96:99],v[204:207]
v_exp_f32 v76,v76
v_mfma_f32_16x16x32_bf16 v[252:255],a[252:255],v[100:103],v[252:255]
v_exp_f32 v77,v77
v_mfma_f32_16x16x32_bf16 a[44:47],a[252:255],v[104:107],a[44:47]
v_exp_f32 v78,v78
v_mfma_f32_16x16x32_bf16 v[32:35],a[192:195],a[96:99],0
ds_read_b128 v[152:155],v11 offset:4096
v_cvt_pk_bf16_f32 v114,v68,v69
v_mfma_f32_16x16x32_bf16 v[32:35],a[196:199],a[100:103],v[32:35]
v_exp_f32 v79,v79
v_mfma_f32_16x16x32_bf16 v[32:35],a[200:203],a[104:107],v[32:35]
v_exp_f32 v80,v80
v_mfma_f32_16x16x32_bf16 v[32:35],a[204:207],a[108:111],v[32:35]
s_waitcnt lgkmcnt(1)
buffer_store_dwordx4 v[156:159],v10,s[16:19],s27 offen offset:0 nt
v_mfma_f32_16x16x32_bf16 v[32:35],a[208:211],a[112:115],v[32:35]
s_add_u32 m0,s29,0
v_exp_f32 v81,v81
v_mfma_f32_16x16x32_bf16 v[32:35],a[212:215],a[116:119],v[32:35]
v_exp_f32 v82,v82
v_mfma_f32_16x16x32_bf16 v[40:43],a[192:195],a[120:123],0
v_exp_f32 v83,v83
v_mfma_f32_16x16x32_bf16 v[40:43],a[196:199],a[124:127],v[40:43]
v_exp_f32 v84,v84
v_mfma_f32_16x16x32_bf16 v[40:43],a[200:203],a[128:131],v[40:43]
v_exp_f32 v85,v85
v_mfma_f32_16x16x32_bf16 v[40:43],a[204:207],a[132:135],v[40:43]
v_exp_f32 v86,v86
v_mfma_f32_16x16x32_bf16 v[40:43],a[208:211],a[136:139],v[40:43]
buffer_load_dwordx4 v9,s[12:15],s28 offen offset:0 nt lds
v_mfma_f32_16x16x32_bf16 v[40:43],a[212:215],a[140:143],v[40:43]
v_exp_f32 v87,v87
v_mfma_f32_16x16x32_bf16 v[48:51],a[192:195],a[144:147],0
v_cvt_pk_bf16_f32 v115,v70,v71
v_cvt_pk_bf16_f32 v118,v76,v77
v_mfma_f32_16x16x32_bf16 v[48:51],a[196:199],a[148:151],v[48:51]
v_cvt_pk_bf16_f32 v119,v78,v79
v_cvt_pk_bf16_f32 v120,v80,v81
v_mfma_f32_16x16x32_bf16 v[128:131],v[24:27],v[112:115],v[128:131]
v_cvt_pk_bf16_f32 v121,v82,v83
v_cvt_pk_bf16_f32 v122,v84,v85
v_mfma_f32_16x16x32_bf16 v[132:135],v[24:27],v[116:119],v[132:135]
v_cvt_pk_bf16_f32 v123,v86,v87
v_fma_f32 v32,v32,s36,v16
v_mfma_f32_16x16x32_bf16 v[48:51],a[200:203],a[152:155],v[48:51]
s_waitcnt lgkmcnt(0)
buffer_store_dwordx4 v[152:155],v10,s[16:19],s27 offen offset:128 nt
v_mfma_f32_16x16x32_bf16 v[136:139],v[24:27],v[120:123],v[136:139]
s_add_u32 m0,s29,896
v_fma_f32 v33,v33,s36,v16
v_fma_f32 v34,v34,s36,v16
v_mfma_f32_16x16x32_bf16 v[48:51],a[204:207],a[156:159],v[48:51]
v_fma_f32 v35,v35,s36,v16
v_fma_f32 v40,v40,s36,v17
v_mfma_f32_16x16x32_bf16 v[48:51],a[208:211],a[160:163],v[48:51]
v_fma_f32 v41,v41,s36,v17
v_fma_f32 v42,v42,s36,v17
v_mfma_f32_16x16x32_bf16 v[48:51],a[212:215],a[164:167],v[48:51]
v_fma_f32 v43,v43,s36,v17
v_mfma_f32_16x16x32_bf16 v[36:39],a[216:219],a[96:99],0
v_exp_f32 v32,v32
v_mfma_f32_16x16x32_bf16 v[36:39],a[220:223],a[100:103],v[36:39]
buffer_load_dwordx4 v9,s[12:15],s28 offen offset:128 nt lds
v_mfma_f32_16x16x32_bf16 v[36:39],a[224:227],a[104:107],v[36:39]
v_exp_f32 v33,v33
s_waitcnt vmcnt(12)
s_barrier
v_mfma_f32_16x16x32_bf16 v[36:39],a[228:231],a[108:111],v[36:39]
v_exp_f32 v34,v34
v_mfma_f32_16x16x32_bf16 v[36:39],a[232:235],a[112:115],v[36:39]
ds_read_b64_tr_b16 a[240:241],v3 offset:24576
ds_read_b64_tr_b16 a[242:243],v3 offset:30720
v_mfma_f32_16x16x32_bf16 v[36:39],a[236:239],a[116:119],v[36:39]
v_exp_f32 v35,v35
v_mfma_f32_16x16x32_bf16 v[44:47],a[216:219],a[120:123],0
ds_read_b64_tr_b16 a[244:245],v4 offset:24576
ds_read_b64_tr_b16 a[246:247],v4 offset:30720
v_mfma_f32_16x16x32_bf16 v[44:47],a[220:223],a[124:127],v[44:47]
ds_read_b64_tr_b16 a[248:249],v5 offset:24576
ds_read_b64_tr_b16 a[250:251],v5 offset:30720
v_mfma_f32_16x16x32_bf16 v[44:47],a[224:227],a[128:131],v[44:47]
v_exp_f32 v40,v40
v_mfma_f32_16x16x32_bf16 v[44:47],a[228:231],a[132:135],v[44:47]
ds_read_b64_tr_b16 a[252:253],v6 offset:24576
ds_read_b64_tr_b16 a[254:255],v6 offset:30720
v_mfma_f32_16x16x32_bf16 v[44:47],a[232:235],a[136:139],v[44:47]
v_exp_f32 v41,v41
v_mfma_f32_16x16x32_bf16 v[44:47],a[236:239],a[140:143],v[44:47]
v_exp_f32 v42,v42
v_mfma_f32_16x16x32_bf16 v[52:55],a[216:219],a[144:147],0
v_exp_f32 v43,v43
v_mfma_f32_16x16x32_bf16 v[52:55],a[220:223],a[148:151],v[52:55]
v_cvt_pk_bf16_f32 v96,v32,v33
v_cvt_pk_bf16_f32 v97,v34,v35
v_mfma_f32_16x16x32_bf16 v[52:55],a[224:227],a[152:155],v[52:55]
v_cvt_pk_bf16_f32 v100,v40,v41
v_cvt_pk_bf16_f32 v101,v42,v43
v_mfma_f32_16x16x32_bf16 v[52:55],a[228:231],a[156:159],v[52:55]
v_mfma_f32_16x16x32_bf16 v[52:55],a[232:235],a[160:163],v[52:55]
v_mfma_f32_16x16x32_bf16 v[52:55],a[236:239],a[164:167],v[52:55]
s_waitcnt lgkmcnt(2)
v_mfma_f32_16x16x32_bf16 v[160:163],a[240:243],v[112:115],v[160:163]
s_add_u32 m0,s23,12288
ds_read_b128 a[192:195],v1 offset:12288
v_fma_f32 v36,v36,s36,v16
v_mfma_f32_16x16x32_bf16 v[208:211],a[240:243],v[116:119],v[208:211]
buffer_load_dwordx4 v7,s[8:11],s21 offen offset:0 lds
v_mfma_f32_16x16x32_bf16 a[0:3],a[240:243],v[120:123],a[0:3]
s_add_u32 m0,s23,13184
ds_read_b64_tr_b16 a[240:241],v3 offset:25600
ds_read_b64_tr_b16 a[242:243],v3 offset:31744
v_mfma_f32_16x16x32_bf16 v[164:167],a[244:247],v[112:115],v[164:167]
ds_read_b128 a[196:199],v2 offset:12288
v_fma_f32 v37,v37,s36,v16
v_mfma_f32_16x16x32_bf16 v[212:215],a[244:247],v[116:119],v[212:215]
ds_read_b128 a[200:203],v1 offset:13312
v_fma_f32 v38,v38,s36,v16
v_mfma_f32_16x16x32_bf16 a[4:7],a[244:247],v[120:123],a[4:7]
ds_read_b64_tr_b16 a[244:245],v4 offset:25600
ds_read_b64_tr_b16 a[246:247],v4 offset:31744
v_mfma_f32_16x16x32_bf16 v[168:171],a[248:251],v[112:115],v[168:171]
ds_read_b128 a[204:207],v2 offset:13312
v_fma_f32 v39,v39,s36,v16
v_mfma_f32_16x16x32_bf16 v[216:219],a[248:251],v[116:119],v[216:219]
buffer_load_dwordx4 v7,s[8:11],s21 offen offset:128 lds
v_mfma_f32_16x16x32_bf16 a[8:11],a[248:251],v[120:123],a[8:11]
s_add_u32 m0,s23,14080
ds_read_b64_tr_b16 a[248:249],v5 offset:25600
ds_read_b64_tr_b16 a[250:251],v5 offset:31744
s_waitcnt lgkmcnt(9)
v_mfma_f32_16x16x32_bf16 v[172:175],a[252:255],v[112:115],v[172:175]
ds_read_b128 a[208:211],v1 offset:14336
v_fma_f32 v44,v44,s36,v17
v_mfma_f32_16x16x32_bf16 v[220:223],a[252:255],v[116:119],v[220:223]
ds_read_b128 a[212:215],v2 offset:14336
v_fma_f32 v45,v45,s36,v17
v_mfma_f32_16x16x32_bf16 a[12:15],a[252:255],v[120:123],a[12:15]
s_waitcnt lgkmcnt(8)
ds_read_b64_tr_b16 a[252:253],v6 offset:25600
ds_read_b64_tr_b16 a[254:255],v6 offset:31744
v_mfma_f32_16x16x32_bf16 v[176:179],a[240:243],v[112:115],v[176:179]
buffer_load_dwordx4 v7,s[8:11],s21 offen offset:256 lds
v_mfma_f32_16x16x32_bf16 v[224:227],a[240:243],v[116:119],v[224:227]
s_add_u32 s21,s21,12288
ds_read_b128 a[216:219],v1 offset:18432
v_fma_f32 v46,v46,s36,v17
v_mfma_f32_16x16x32_bf16 a[16:19],a[240:243],v[120:123],a[16:19]
s_add_u32 m0,s22,0
ds_read_b64_tr_b16 a[240:241],v3 offset:26624
ds_read_b64_tr_b16 a[242:243],v3 offset:32768
s_waitcnt lgkmcnt(9)
v_mfma_f32_16x16x32_bf16 v[180:183],a[244:247],v[112:115],v[180:183]
ds_read_b128 a[220:223],v2 offset:18432
v_fma_f32 v47,v47,s36,v17
v_mfma_f32_16x16x32_bf16 v[228:231],a[244:247],v[116:119],v[228:231]
ds_read_b128 a[224:227],v1 offset:19456
v_fma_f32 v48,v48,s36,v18
v_mfma_f32_16x16x32_bf16 a[20:23],a[244:247],v[120:123],a[20:23]
s_waitcnt lgkmcnt(8)
ds_read_b64_tr_b16 a[244:245],v4 offset:26624
ds_read_b64_tr_b16 a[246:247],v4 offset:32768
v_mfma_f32_16x16x32_bf16 v[184:187],a[248:251],v[112:115],v[184:187]
buffer_load_dwordx4 v7,s[4:7],s20 offen offset:0 lds
v_mfma_f32_16x16x32_bf16 v[232:235],a[248:251],v[116:119],v[232:235]
s_add_u32 m0,s22,896
ds_read_b128 a[228:231],v2 offset:19456
v_fma_f32 v49,v49,s36,v18
v_mfma_f32_16x16x32_bf16 a[24:27],a[248:251],v[120:123],a[24:27]
s_waitcnt lgkmcnt(8)
ds_read_b64_tr_b16 a[248:249],v5 offset:26624
ds_read_b64_tr_b16 a[250:251],v5 offset:32768
v_mfma_f32_16x16x32_bf16 v[188:191],a[252:255],v[112:115],v[188:191]
ds_read_b128 a[232:235],v1 offset:20480
v_fma_f32 v50,v50,s36,v18
v_mfma_f32_16x16x32_bf16 v[236:239],a[252:255],v[116:119],v[236:239]
ds_read_b128 a[236:239],v2 offset:20480
v_fma_f32 v51,v51,s36,v18
v_mfma_f32_16x16x32_bf16 a[28:31],a[252:255],v[120:123],a[28:31]
s_waitcnt lgkmcnt(8)
ds_read_b64_tr_b16 a[252:253],v6 offset:26624
ds_read_b64_tr_b16 a[254:255],v6 offset:32768
v_mfma_f32_16x16x32_bf16 v[192:195],a[240:243],v[112:115],v[192:195]
buffer_load_dwordx4 v7,s[4:7],s20 offen offset:128 lds
v_mfma_f32_16x16x32_bf16 v[240:243],a[240:243],v[116:119],v[240:243]
s_add_u32 m0,s22,1792
ds_read_b128 v[156:159],v11 offset:5120
v_fma_f32 v52,v52,s36,v18
v_mfma_f32_16x16x32_bf16 a[32:35],a[240:243],v[120:123],a[32:35]
s_waitcnt lgkmcnt(8)
v_fma_f32 v53,v53,s36,v18
v_fma_f32 v54,v54,s36,v18
v_mfma_f32_16x16x32_bf16 v[196:199],a[244:247],v[112:115],v[196:199]
v_fma_f32 v55,v55,s36,v18
v_mfma_f32_16x16x32_bf16 v[244:247],a[244:247],v[116:119],v[244:247]
v_exp_f32 v36,v36
v_mfma_f32_16x16x32_bf16 a[36:39],a[244:247],v[120:123],a[36:39]
s_waitcnt lgkmcnt(4)
v_exp_f32 v37,v37
v_mfma_f32_16x16x32_bf16 v[200:203],a[248:251],v[112:115],v[200:203]
buffer_load_dwordx4 v7,s[4:7],s20 offen offset:256 lds
v_mfma_f32_16x16x32_bf16 v[248:251],a[248:251],v[116:119],v[248:251]
s_add_u32 s20,s20,12288
v_exp_f32 v38,v38
v_mfma_f32_16x16x32_bf16 a[40:43],a[248:251],v[120:123],a[40:43]
s_waitcnt lgkmcnt(1)
v_exp_f32 v39,v39
v_mfma_f32_16x16x32_bf16 v[204:207],a[252:255],v[112:115],v[204:207]
v_exp_f32 v44,v44
v_mfma_f32_16x16x32_bf16 v[252:255],a[252:255],v[116:119],v[252:255]
v_exp_f32 v45,v45
v_mfma_f32_16x16x32_bf16 a[44:47],a[252:255],v[120:123],a[44:47]
v_exp_f32 v46,v46
v_mfma_f32_16x16x32_bf16 v[64:67],a[192:195],a[96:99],0
v_exp_f32 v47,v47
v_mfma_f32_16x16x32_bf16 v[64:67],a[196:199],a[100:103],v[64:67]
v_exp_f32 v48,v48
v_mfma_f32_16x16x32_bf16 v[64:67],a[200:203],a[104:107],v[64:67]
v_exp_f32 v49,v49
v_mfma_f32_16x16x32_bf16 v[64:67],a[204:207],a[108:111],v[64:67]
s_waitcnt lgkmcnt(0)
buffer_store_dwordx4 v[156:159],v10,s[16:19],s27 offen offset:256 nt
v_mfma_f32_16x16x32_bf16 v[64:67],a[208:211],a[112:115],v[64:67]
s_add_u32 m0,s29,1792
v_exp_f32 v50,v50
v_mfma_f32_16x16x32_bf16 v[64:67],a[212:215],a[116:119],v[64:67]
v_exp_f32 v51,v51
v_mfma_f32_16x16x32_bf16 v[72:75],a[192:195],a[120:123],0
v_exp_f32 v52,v52
v_mfma_f32_16x16x32_bf16 v[72:75],a[196:199],a[124:127],v[72:75]
v_exp_f32 v53,v53
v_mfma_f32_16x16x32_bf16 v[72:75],a[200:203],a[128:131],v[72:75]
v_exp_f32 v54,v54
v_mfma_f32_16x16x32_bf16 v[72:75],a[204:207],a[132:135],v[72:75]
v_exp_f32 v55,v55
v_mfma_f32_16x16x32_bf16 v[72:75],a[208:211],a[136:139],v[72:75]
v_cvt_pk_bf16_f32 v98,v36,v37
v_cvt_pk_bf16_f32 v99,v38,v39
v_mfma_f32_16x16x32_bf16 v[72:75],a[212:215],a[140:143],v[72:75]
v_cvt_pk_bf16_f32 v102,v44,v45
v_cvt_pk_bf16_f32 v103,v46,v47
v_mfma_f32_16x16x32_bf16 v[128:131],v[24:27],v[96:99],v[128:131]
v_cvt_pk_bf16_f32 v104,v48,v49
v_cvt_pk_bf16_f32 v105,v50,v51
v_mfma_f32_16x16x32_bf16 v[132:135],v[24:27],v[100:103],v[132:135]
v_cvt_pk_bf16_f32 v106,v52,v53
v_cvt_pk_bf16_f32 v107,v54,v55
v_mfma_f32_16x16x32_bf16 v[80:83],a[192:195],a[144:147],0
v_fma_f32 v64,v64,s36,v16
v_fma_f32 v65,v65,s36,v16
v_mfma_f32_16x16x32_bf16 v[136:139],v[24:27],v[104:107],v[136:139]
v_fma_f32 v66,v66,s36,v16
v_fma_f32 v67,v67,s36,v16
v_mfma_f32_16x16x32_bf16 v[80:83],a[196:199],a[148:151],v[80:83]
buffer_load_dwordx4 v9,s[12:15],s28 offen offset:256 nt lds
v_mfma_f32_16x16x32_bf16 v[80:83],a[200:203],a[152:155],v[80:83]
s_add_u32 s27,s27,3072
v_fma_f32 v72,v72,s36,v17
v_fma_f32 v73,v73,s36,v17
v_mfma_f32_16x16x32_bf16 v[80:83],a[204:207],a[156:159],v[80:83]
s_add_u32 s28,s28,3072
v_fma_f32 v74,v74,s36,v17
v_fma_f32 v75,v75,s36,v17
v_mfma_f32_16x16x32_bf16 v[80:83],a[208:211],a[160:163],v[80:83]
s_add_u32 s29,s29,3072
v_exp_f32 v64,v64
v_mfma_f32_16x16x32_bf16 v[80:83],a[212:215],a[164:167],v[80:83]
v_exp_f32 v65,v65
v_mfma_f32_16x16x32_bf16 v[68:71],a[216:219],a[96:99],0
v_exp_f32 v66,v66
v_mfma_f32_16x16x32_bf16 v[68:71],a[220:223],a[100:103],v[68:71]
v_exp_f32 v67,v67
v_mfma_f32_16x16x32_bf16 v[68:71],a[224:227],a[104:107],v[68:71]
v_exp_f32 v72,v72
v_mfma_f32_16x16x32_bf16 v[68:71],a[228:231],a[108:111],v[68:71]
s_waitcnt vmcnt(12)
s_barrier
v_mfma_f32_16x16x32_bf16 v[68:71],a[232:235],a[112:115],v[68:71]
v_exp_f32 v73,v73
v_mfma_f32_16x16x32_bf16 v[68:71],a[236:239],a[116:119],v[68:71]
ds_read_b64_tr_b16 a[240:241],v3 offset:0
ds_read_b64_tr_b16 a[242:243],v3 offset:6144
v_mfma_f32_16x16x32_bf16 v[76:79],a[216:219],a[120:123],0
v_exp_f32 v74,v74
v_mfma_f32_16x16x32_bf16 v[76:79],a[220:223],a[124:127],v[76:79]
ds_read_b64_tr_b16 a[244:245],v4 offset:0
ds_read_b64_tr_b16 a[246:247],v4 offset:6144
v_mfma_f32_16x16x32_bf16 v[76:79],a[224:227],a[128:131],v[76:79]
ds_read_b64_tr_b16 a[248:249],v5 offset:0
ds_read_b64_tr_b16 a[250:251],v5 offset:6144
v_mfma_f32_16x16x32_bf16 v[76:79],a[228:231],a[132:135],v[76:79]
v_exp_f32 v75,v75
v_mfma_f32_16x16x32_bf16 v[76:79],a[232:235],a[136:139],v[76:79]
ds_read_b64_tr_b16 a[252:253],v6 offset:0
ds_read_b64_tr_b16 a[254:255],v6 offset:6144
v_mfma_f32_16x16x32_bf16 v[76:79],a[236:239],a[140:143],v[76:79]
v_cvt_pk_bf16_f32 v112,v64,v65
v_cvt_pk_bf16_f32 v113,v66,v67
v_mfma_f32_16x16x32_bf16 v[84:87],a[216:219],a[144:147],0
v_cvt_pk_bf16_f32 v116,v72,v73
v_cvt_pk_bf16_f32 v117,v74,v75
v_mfma_f32_16x16x32_bf16 v[84:87],a[220:223],a[148:151],v[84:87]
v_mfma_f32_16x16x32_bf16 v[84:87],a[224:227],a[152:155],v[84:87]
v_mfma_f32_16x16x32_bf16 v[84:87],a[228:231],a[156:159],v[84:87]
v_mfma_f32_16x16x32_bf16 v[84:87],a[232:235],a[160:163],v[84:87]
v_mfma_f32_16x16x32_bf16 v[84:87],a[236:239],a[164:167],v[84:87]
s_waitcnt lgkmcnt(2)
v_mfma_f32_16x16x32_bf16 v[160:163],a[240:243],v[96:99],v[160:163]
s_add_u32 m0,s23,24576
ds_read_b128 a[192:195],v1 offset:24576
v_fma_f32 v68,v68,s36,v16
v_mfma_f32_16x16x32_bf16 v[208:211],a[240:243],v[100:103],v[208:211]
buffer_load_dwordx4 v7,s[8:11],s21 offen offset:0 lds
v_mfma_f32_16x16x32_bf16 a[0:3],a[240:243],v[104:107],a[0:3]
s_add_u32 m0,s23,25472
ds_read_b64_tr_b16 a[240:241],v3 offset:1024
ds_read_b64_tr_b16 a[242:243],v3 offset:7168
v_mfma_f32_16x16x32_bf16 v[164:167],a[244:247],v[96:99],v[164:167]
ds_read_b128 a[196:199],v2 offset:24576
v_fma_f32 v69,v69,s36,v16
v_mfma_f32_16x16x32_bf16 v[212:215],a[244:247],v[100:103],v[212:215]
ds_read_b128 a[200:203],v1 offset:25600
v_fma_f32 v70,v70,s36,v16
v_mfma_f32_16x16x32_bf16 a[4:7],a[244:247],v[104:107],a[4:7]
ds_read_b64_tr_b16 a[244:245],v4 offset:1024
ds_read_b64_tr_b16 a[246:247],v4 offset:7168
v_mfma_f32_16x16x32_bf16 v[168:171],a[248:251],v[96:99],v[168:171]
ds_read_b128 a[204:207],v2 offset:25600
v_fma_f32 v71,v71,s36,v16
v_mfma_f32_16x16x32_bf16 v[216:219],a[248:251],v[100:103],v[216:219]
buffer_load_dwordx4 v7,s[8:11],s21 offen offset:128 lds
v_mfma_f32_16x16x32_bf16 a[8:11],a[248:251],v[104:107],a[8:11]
s_add_u32 m0,s23,26368
ds_read_b64_tr_b16 a[248:249],v5 offset:1024
ds_read_b64_tr_b16 a[250:251],v5 offset:7168
s_waitcnt lgkmcnt(9)
v_mfma_f32_16x16x32_bf16 v[172:175],a[252:255],v[96:99],v[172:175]
ds_read_b128 a[208:211],v1 offset:26624
v_fma_f32 v76,v76,s36,v17
v_mfma_f32_16x16x32_bf16 v[220:223],a[252:255],v[100:103],v[220:223]
ds_read_b128 a[212:215],v2 offset:26624
v_fma_f32 v77,v77,s36,v17
v_mfma_f32_16x16x32_bf16 a[12:15],a[252:255],v[104:107],a[12:15]
s_waitcnt lgkmcnt(8)
ds_read_b64_tr_b16 a[252:253],v6 offset:1024
ds_read_b64_tr_b16 a[254:255],v6 offset:7168
v_mfma_f32_16x16x32_bf16 v[176:179],a[240:243],v[96:99],v[176:179]
buffer_load_dwordx4 v7,s[8:11],s21 offen offset:256 lds
v_mfma_f32_16x16x32_bf16 v[224:227],a[240:243],v[100:103],v[224:227]
s_add_u32 s21,s21,12288
ds_read_b128 a[216:219],v1 offset:30720
v_fma_f32 v78,v78,s36,v17
v_mfma_f32_16x16x32_bf16 a[16:19],a[240:243],v[104:107],a[16:19]
s_add_u32 m0,s25,0
ds_read_b64_tr_b16 a[240:241],v3 offset:2048
ds_read_b64_tr_b16 a[242:243],v3 offset:8192
s_waitcnt lgkmcnt(9)
v_mfma_f32_16x16x32_bf16 v[180:183],a[244:247],v[96:99],v[180:183]
ds_read_b128 a[220:223],v2 offset:30720
v_fma_f32 v79,v79,s36,v17
v_mfma_f32_16x16x32_bf16 v[228:231],a[244:247],v[100:103],v[228:231]
ds_read_b128 a[224:227],v1 offset:31744
v_fma_f32 v80,v80,s36,v18
v_mfma_f32_16x16x32_bf16 a[20:23],a[244:247],v[104:107],a[20:23]
s_waitcnt lgkmcnt(8)
ds_read_b64_tr_b16 a[244:245],v4 offset:2048
ds_read_b64_tr_b16 a[246:247],v4 offset:8192
v_mfma_f32_16x16x32_bf16 v[184:187],a[248:251],v[96:99],v[184:187]
buffer_load_dwordx4 v7,s[4:7],s20 offen offset:0 lds
v_mfma_f32_16x16x32_bf16 v[232:235],a[248:251],v[100:103],v[232:235]
s_add_u32 m0,s25,896
ds_read_b128 a[228:231],v2 offset:31744
v_fma_f32 v81,v81,s36,v18
v_mfma_f32_16x16x32_bf16 a[24:27],a[248:251],v[104:107],a[24:27]
s_waitcnt lgkmcnt(8)
ds_read_b64_tr_b16 a[248:249],v5 offset:2048
ds_read_b64_tr_b16 a[250:251],v5 offset:8192
v_mfma_f32_16x16x32_bf16 v[188:191],a[252:255],v[96:99],v[188:191]
ds_read_b128 a[232:235],v1 offset:32768
v_fma_f32 v82,v82,s36,v18
v_mfma_f32_16x16x32_bf16 v[236:239],a[252:255],v[100:103],v[236:239]
ds_read_b128 a[236:239],v2 offset:32768
v_fma_f32 v83,v83,s36,v18
v_mfma_f32_16x16x32_bf16 a[28:31],a[252:255],v[104:107],a[28:31]
s_waitcnt lgkmcnt(8)
ds_read_b64_tr_b16 a[252:253],v6 offset:2048
ds_read_b64_tr_b16 a[254:255],v6 offset:8192
v_mfma_f32_16x16x32_bf16 v[192:195],a[240:243],v[96:99],v[192:195]
buffer_load_dwordx4 v7,s[4:7],s20 offen offset:128 lds
v_mfma_f32_16x16x32_bf16 v[240:243],a[240:243],v[100:103],v[240:243]
s_add_u32 m0,s25,1792
ds_read_b128 v[152:155],v11 offset:6144
v_fma_f32 v84,v84,s36,v18
v_mfma_f32_16x16x32_bf16 a[32:35],a[240:243],v[104:107],a[32:35]
s_waitcnt lgkmcnt(8)
v_fma_f32 v85,v85,s36,v18
v_fma_f32 v86,v86,s36,v18
v_mfma_f32_16x16x32_bf16 v[196:199],a[244:247],v[96:99],v[196:199]
v_fma_f32 v87,v87,s36,v18
v_mfma_f32_16x16x32_bf16 v[244:247],a[244:247],v[100:103],v[244:247]
v_exp_f32 v68,v68
v_mfma_f32_16x16x32_bf16 a[36:39],a[244:247],v[104:107],a[36:39]
s_waitcnt lgkmcnt(4)
v_exp_f32 v69,v69
v_mfma_f32_16x16x32_bf16 v[200:203],a[248:251],v[96:99],v[200:203]
buffer_load_dwordx4 v7,s[4:7],s20 offen offset:256 lds
v_mfma_f32_16x16x32_bf16 v[248:251],a[248:251],v[100:103],v[248:251]
s_add_u32 s20,s20,12288
v_exp_f32 v70,v70
v_mfma_f32_16x16x32_bf16 a[40:43],a[248:251],v[104:107],a[40:43]
s_waitcnt lgkmcnt(1)
v_exp_f32 v71,v71
v_mfma_f32_16x16x32_bf16 v[204:207],a[252:255],v[96:99],v[204:207]
v_exp_f32 v76,v76
v_mfma_f32_16x16x32_bf16 v[252:255],a[252:255],v[100:103],v[252:255]
v_exp_f32 v77,v77
v_mfma_f32_16x16x32_bf16 a[44:47],a[252:255],v[104:107],a[44:47]
v_exp_f32 v78,v78
v_mfma_f32_16x16x32_bf16 v[32:35],a[192:195],a[96:99],0
ds_read_b128 v[156:159],v11 offset:7168
v_cvt_pk_bf16_f32 v114,v68,v69
v_mfma_f32_16x16x32_bf16 v[32:35],a[196:199],a[100:103],v[32:35]
v_exp_f32 v79,v79
v_mfma_f32_16x16x32_bf16 v[32:35],a[200:203],a[104:107],v[32:35]
v_exp_f32 v80,v80
v_mfma_f32_16x16x32_bf16 v[32:35],a[204:207],a[108:111],v[32:35]
s_waitcnt lgkmcnt(1)
buffer_store_dwordx4 v[152:155],v10,s[16:19],s27 offen offset:0 nt
v_mfma_f32_16x16x32_bf16 v[32:35],a[208:211],a[112:115],v[32:35]
s_add_u32 m0,s29,0
v_exp_f32 v81,v81
v_mfma_f32_16x16x32_bf16 v[32:35],a[212:215],a[116:119],v[32:35]
v_exp_f32 v82,v82
v_mfma_f32_16x16x32_bf16 v[40:43],a[192:195],a[120:123],0
v_exp_f32 v83,v83
v_mfma_f32_16x16x32_bf16 v[40:43],a[196:199],a[124:127],v[40:43]
v_exp_f32 v84,v84
v_mfma_f32_16x16x32_bf16 v[40:43],a[200:203],a[128:131],v[40:43]
v_exp_f32 v85,v85
v_mfma_f32_16x16x32_bf16 v[40:43],a[204:207],a[132:135],v[40:43]
v_exp_f32 v86,v86
v_mfma_f32_16x16x32_bf16 v[40:43],a[208:211],a[136:139],v[40:43]
buffer_load_dwordx4 v8,s[12:15],s28 offen offset:0 nt lds
v_mfma_f32_16x16x32_bf16 v[40:43],a[212:215],a[140:143],v[40:43]
v_exp_f32 v87,v87
v_mfma_f32_16x16x32_bf16 v[48:51],a[192:195],a[144:147],0
v_cvt_pk_bf16_f32 v115,v70,v71
v_cvt_pk_bf16_f32 v118,v76,v77
v_mfma_f32_16x16x32_bf16 v[48:51],a[196:199],a[148:151],v[48:51]
v_cvt_pk_bf16_f32 v119,v78,v79
v_cvt_pk_bf16_f32 v120,v80,v81
v_mfma_f32_16x16x32_bf16 v[128:131],v[24:27],v[112:115],v[128:131]
v_cvt_pk_bf16_f32 v121,v82,v83
v_cvt_pk_bf16_f32 v122,v84,v85
v_mfma_f32_16x16x32_bf16 v[132:135],v[24:27],v[116:119],v[132:135]
v_cvt_pk_bf16_f32 v123,v86,v87
v_fma_f32 v32,v32,s36,v16
v_mfma_f32_16x16x32_bf16 v[48:51],a[200:203],a[152:155],v[48:51]
s_waitcnt lgkmcnt(0)
buffer_store_dwordx4 v[156:159],v10,s[16:19],s27 offen offset:128 nt
v_mfma_f32_16x16x32_bf16 v[136:139],v[24:27],v[120:123],v[136:139]
s_add_u32 m0,s29,896
v_fma_f32 v33,v33,s36,v16
v_fma_f32 v34,v34,s36,v16
v_mfma_f32_16x16x32_bf16 v[48:51],a[204:207],a[156:159],v[48:51]
v_fma_f32 v35,v35,s36,v16
v_fma_f32 v40,v40,s36,v17
v_mfma_f32_16x16x32_bf16 v[48:51],a[208:211],a[160:163],v[48:51]
v_fma_f32 v41,v41,s36,v17
v_fma_f32 v42,v42,s36,v17
v_mfma_f32_16x16x32_bf16 v[48:51],a[212:215],a[164:167],v[48:51]
v_fma_f32 v43,v43,s36,v17
v_mfma_f32_16x16x32_bf16 v[36:39],a[216:219],a[96:99],0
v_exp_f32 v32,v32
v_mfma_f32_16x16x32_bf16 v[36:39],a[220:223],a[100:103],v[36:39]
buffer_load_dwordx4 v8,s[12:15],s28 offen offset:128 nt lds
v_mfma_f32_16x16x32_bf16 v[36:39],a[224:227],a[104:107],v[36:39]
v_exp_f32 v33,v33
s_waitcnt vmcnt(12)
s_barrier
v_mfma_f32_16x16x32_bf16 v[36:39],a[228:231],a[108:111],v[36:39]
v_exp_f32 v34,v34
v_mfma_f32_16x16x32_bf16 v[36:39],a[232:235],a[112:115],v[36:39]
ds_read_b64_tr_b16 a[240:241],v3 offset:12288
ds_read_b64_tr_b16 a[242:243],v3 offset:18432
v_mfma_f32_16x16x32_bf16 v[36:39],a[236:239],a[116:119],v[36:39]
v_exp_f32 v35,v35
v_mfma_f32_16x16x32_bf16 v[44:47],a[216:219],a[120:123],0
ds_read_b64_tr_b16 a[244:245],v4 offset:12288
ds_read_b64_tr_b16 a[246:247],v4 offset:18432
v_mfma_f32_16x16x32_bf16 v[44:47],a[220:223],a[124:127],v[44:47]
ds_read_b64_tr_b16 a[248:249],v5 offset:12288
ds_read_b64_tr_b16 a[250:251],v5 offset:18432
v_mfma_f32_16x16x32_bf16 v[44:47],a[224:227],a[128:131],v[44:47]
v_exp_f32 v40,v40
v_mfma_f32_16x16x32_bf16 v[44:47],a[228:231],a[132:135],v[44:47]
ds_read_b64_tr_b16 a[252:253],v6 offset:12288
ds_read_b64_tr_b16 a[254:255],v6 offset:18432
v_mfma_f32_16x16x32_bf16 v[44:47],a[232:235],a[136:139],v[44:47]
v_exp_f32 v41,v41
v_mfma_f32_16x16x32_bf16 v[44:47],a[236:239],a[140:143],v[44:47]
v_exp_f32 v42,v42
v_mfma_f32_16x16x32_bf16 v[52:55],a[216:219],a[144:147],0
v_exp_f32 v43,v43
v_mfma_f32_16x16x32_bf16 v[52:55],a[220:223],a[148:151],v[52:55]
v_cvt_pk_bf16_f32 v96,v32,v33
v_cvt_pk_bf16_f32 v97,v34,v35
v_mfma_f32_16x16x32_bf16 v[52:55],a[224:227],a[152:155],v[52:55]
v_cvt_pk_bf16_f32 v100,v40,v41
v_cvt_pk_bf16_f32 v101,v42,v43
v_mfma_f32_16x16x32_bf16 v[52:55],a[228:231],a[156:159],v[52:55]
v_mfma_f32_16x16x32_bf16 v[52:55],a[232:235],a[160:163],v[52:55]
v_mfma_f32_16x16x32_bf16 v[52:55],a[236:239],a[164:167],v[52:55]
s_waitcnt lgkmcnt(2)
v_mfma_f32_16x16x32_bf16 v[160:163],a[240:243],v[112:115],v[160:163]
s_add_u32 m0,s23,0
ds_read_b128 a[192:195],v1 offset:0
v_fma_f32 v36,v36,s36,v16
v_mfma_f32_16x16x32_bf16 v[208:211],a[240:243],v[116:119],v[208:211]
buffer_load_dwordx4 v7,s[8:11],s21 offen offset:0 lds
v_mfma_f32_16x16x32_bf16 a[0:3],a[240:243],v[120:123],a[0:3]
s_add_u32 m0,s23,896
ds_read_b64_tr_b16 a[240:241],v3 offset:13312
ds_read_b64_tr_b16 a[242:243],v3 offset:19456
v_mfma_f32_16x16x32_bf16 v[164:167],a[244:247],v[112:115],v[164:167]
ds_read_b128 a[196:199],v2 offset:0
v_fma_f32 v37,v37,s36,v16
v_mfma_f32_16x16x32_bf16 v[212:215],a[244:247],v[116:119],v[212:215]
ds_read_b128 a[200:203],v1 offset:1024
v_fma_f32 v38,v38,s36,v16
v_mfma_f32_16x16x32_bf16 a[4:7],a[244:247],v[120:123],a[4:7]
ds_read_b64_tr_b16 a[244:245],v4 offset:13312
ds_read_b64_tr_b16 a[246:247],v4 offset:19456
v_mfma_f32_16x16x32_bf16 v[168:171],a[248:251],v[112:115],v[168:171]
ds_read_b128 a[204:207],v2 offset:1024
v_fma_f32 v39,v39,s36,v16
v_mfma_f32_16x16x32_bf16 v[216:219],a[248:251],v[116:119],v[216:219]
buffer_load_dwordx4 v7,s[8:11],s21 offen offset:128 lds
v_mfma_f32_16x16x32_bf16 a[8:11],a[248:251],v[120:123],a[8:11]
s_add_u32 m0,s23,1792
ds_read_b64_tr_b16 a[248:249],v5 offset:13312
ds_read_b64_tr_b16 a[250:251],v5 offset:19456
s_waitcnt lgkmcnt(9)
v_mfma_f32_16x16x32_bf16 v[172:175],a[252:255],v[112:115],v[172:175]
ds_read_b128 a[208:211],v1 offset:2048
v_fma_f32 v44,v44,s36,v17
v_mfma_f32_16x16x32_bf16 v[220:223],a[252:255],v[116:119],v[220:223]
ds_read_b128 a[212:215],v2 offset:2048
v_fma_f32 v45,v45,s36,v17
v_mfma_f32_16x16x32_bf16 a[12:15],a[252:255],v[120:123],a[12:15]
s_waitcnt lgkmcnt(8)
ds_read_b64_tr_b16 a[252:253],v6 offset:13312
ds_read_b64_tr_b16 a[254:255],v6 offset:19456
v_mfma_f32_16x16x32_bf16 v[176:179],a[240:243],v[112:115],v[176:179]
buffer_load_dwordx4 v7,s[8:11],s21 offen offset:256 lds
v_mfma_f32_16x16x32_bf16 v[224:227],a[240:243],v[116:119],v[224:227]
s_add_u32 s21,s21,12288
ds_read_b128 a[216:219],v1 offset:6144
v_fma_f32 v46,v46,s36,v17
v_mfma_f32_16x16x32_bf16 a[16:19],a[240:243],v[120:123],a[16:19]
s_add_u32 m0,s26,0
ds_read_b64_tr_b16 a[240:241],v3 offset:14336
ds_read_b64_tr_b16 a[242:243],v3 offset:20480
s_waitcnt lgkmcnt(9)
v_mfma_f32_16x16x32_bf16 v[180:183],a[244:247],v[112:115],v[180:183]
ds_read_b128 a[220:223],v2 offset:6144
v_fma_f32 v47,v47,s36,v17
v_mfma_f32_16x16x32_bf16 v[228:231],a[244:247],v[116:119],v[228:231]
ds_read_b128 a[224:227],v1 offset:7168
v_fma_f32 v48,v48,s36,v18
v_mfma_f32_16x16x32_bf16 a[20:23],a[244:247],v[120:123],a[20:23]
s_waitcnt lgkmcnt(8)
ds_read_b64_tr_b16 a[244:245],v4 offset:14336
ds_read_b64_tr_b16 a[246:247],v4 offset:20480
v_mfma_f32_16x16x32_bf16 v[184:187],a[248:251],v[112:115],v[184:187]
buffer_load_dwordx4 v7,s[4:7],s20 offen offset:0 lds
v_mfma_f32_16x16x32_bf16 v[232:235],a[248:251],v[116:119],v[232:235]
s_add_u32 m0,s26,896
ds_read_b128 a[228:231],v2 offset:7168
v_fma_f32 v49,v49,s36,v18
v_mfma_f32_16x16x32_bf16 a[24:27],a[248:251],v[120:123],a[24:27]
s_waitcnt lgkmcnt(8)
ds_read_b64_tr_b16 a[248:249],v5 offset:14336
ds_read_b64_tr_b16 a[250:251],v5 offset:20480
v_mfma_f32_16x16x32_bf16 v[188:191],a[252:255],v[112:115],v[188:191]
ds_read_b128 a[232:235],v1 offset:8192
v_fma_f32 v50,v50,s36,v18
v_mfma_f32_16x16x32_bf16 v[236:239],a[252:255],v[116:119],v[236:239]
ds_read_b128 a[236:239],v2 offset:8192
v_fma_f32 v51,v51,s36,v18
v_mfma_f32_16x16x32_bf16 a[28:31],a[252:255],v[120:123],a[28:31]
s_waitcnt lgkmcnt(8)
ds_read_b64_tr_b16 a[252:253],v6 offset:14336
ds_read_b64_tr_b16 a[254:255],v6 offset:20480
v_mfma_f32_16x16x32_bf16 v[192:195],a[240:243],v[112:115],v[192:195]
buffer_load_dwordx4 v7,s[4:7],s20 offen offset:128 lds
v_mfma_f32_16x16x32_bf16 v[240:243],a[240:243],v[116:119],v[240:243]
s_add_u32 m0,s26,1792
ds_read_b128 v[152:155],v11 offset:8192
v_fma_f32 v52,v52,s36,v18
v_mfma_f32_16x16x32_bf16 a[32:35],a[240:243],v[120:123],a[32:35]
s_waitcnt lgkmcnt(8)
v_fma_f32 v53,v53,s36,v18
v_fma_f32 v54,v54,s36,v18
v_mfma_f32_16x16x32_bf16 v[196:199],a[244:247],v[112:115],v[196:199]
v_fma_f32 v55,v55,s36,v18
v_add_u32 v11,9216,v11
v_mfma_f32_16x16x32_bf16 v[244:247],a[244:247],v[116:119],v[244:247]
v_exp_f32 v36,v36
v_mfma_f32_16x16x32_bf16 a[36:39],a[244:247],v[120:123],a[36:39]
s_waitcnt lgkmcnt(4)
v_exp_f32 v37,v37
v_mfma_f32_16x16x32_bf16 v[200:203],a[248:251],v[112:115],v[200:203]
buffer_load_dwordx4 v7,s[4:7],s20 offen offset:256 lds
v_mfma_f32_16x16x32_bf16 v[248:251],a[248:251],v[116:119],v[248:251]
s_add_u32 s20,s20,12288
v_exp_f32 v38,v38
v_mfma_f32_16x16x32_bf16 a[40:43],a[248:251],v[120:123],a[40:43]
s_waitcnt lgkmcnt(1)
v_exp_f32 v39,v39
v_mfma_f32_16x16x32_bf16 v[204:207],a[252:255],v[112:115],v[204:207]
v_exp_f32 v44,v44
v_mfma_f32_16x16x32_bf16 v[252:255],a[252:255],v[116:119],v[252:255]
v_exp_f32 v45,v45
v_mfma_f32_16x16x32_bf16 a[44:47],a[252:255],v[120:123],a[44:47]
v_exp_f32 v46,v46
v_mfma_f32_16x16x32_bf16 v[64:67],a[192:195],a[96:99],0
v_exp_f32 v47,v47
v_mfma_f32_16x16x32_bf16 v[64:67],a[196:199],a[100:103],v[64:67]
v_exp_f32 v48,v48
v_mfma_f32_16x16x32_bf16 v[64:67],a[200:203],a[104:107],v[64:67]
v_exp_f32 v49,v49
v_mfma_f32_16x16x32_bf16 v[64:67],a[204:207],a[108:111],v[64:67]
s_waitcnt lgkmcnt(0)
buffer_store_dwordx4 v[152:155],v10,s[16:19],s27 offen offset:256 nt
v_mfma_f32_16x16x32_bf16 v[64:67],a[208:211],a[112:115],v[64:67]
s_add_u32 m0,s29,1792
v_exp_f32 v50,v50
v_mfma_f32_16x16x32_bf16 v[64:67],a[212:215],a[116:119],v[64:67]
v_exp_f32 v51,v51
v_mfma_f32_16x16x32_bf16 v[72:75],a[192:195],a[120:123],0
v_exp_f32 v52,v52
v_mfma_f32_16x16x32_bf16 v[72:75],a[196:199],a[124:127],v[72:75]
v_exp_f32 v53,v53
v_mfma_f32_16x16x32_bf16 v[72:75],a[200:203],a[128:131],v[72:75]
v_exp_f32 v54,v54
v_mfma_f32_16x16x32_bf16 v[72:75],a[204:207],a[132:135],v[72:75]
v_exp_f32 v55,v55
v_mfma_f32_16x16x32_bf16 v[72:75],a[208:211],a[136:139],v[72:75]
v_cvt_pk_bf16_f32 v98,v36,v37
v_cvt_pk_bf16_f32 v99,v38,v39
v_mfma_f32_16x16x32_bf16 v[72:75],a[212:215],a[140:143],v[72:75]
v_cvt_pk_bf16_f32 v102,v44,v45
v_cvt_pk_bf16_f32 v103,v46,v47
v_mfma_f32_16x16x32_bf16 v[128:131],v[24:27],v[96:99],v[128:131]
v_cvt_pk_bf16_f32 v104,v48,v49
v_cvt_pk_bf16_f32 v105,v50,v51
v_mfma_f32_16x16x32_bf16 v[132:135],v[24:27],v[100:103],v[132:135]
v_cvt_pk_bf16_f32 v106,v52,v53
v_cvt_pk_bf16_f32 v107,v54,v55
v_mfma_f32_16x16x32_bf16 v[80:83],a[192:195],a[144:147],0
v_fma_f32 v64,v64,s36,v16
v_fma_f32 v65,v65,s36,v16
v_mfma_f32_16x16x32_bf16 v[136:139],v[24:27],v[104:107],v[136:139]
v_fma_f32 v66,v66,s36,v16
v_fma_f32 v67,v67,s36,v16
v_mfma_f32_16x16x32_bf16 v[80:83],a[196:199],a[148:151],v[80:83]
buffer_load_dwordx4 v8,s[12:15],s28 offen offset:256 nt lds
v_mfma_f32_16x16x32_bf16 v[80:83],a[200:203],a[152:155],v[80:83]
s_add_u32 s27,s27,3072
v_fma_f32 v72,v72,s36,v17
v_fma_f32 v73,v73,s36,v17
v_mfma_f32_16x16x32_bf16 v[80:83],a[204:207],a[156:159],v[80:83]
s_add_u32 s28,s28,3072
v_fma_f32 v74,v74,s36,v17
v_fma_f32 v75,v75,s36,v17
v_mfma_f32_16x16x32_bf16 v[80:83],a[208:211],a[160:163],v[80:83]
s_add_u32 s29,s29,3072
s_add_u32 s25,s24,18432
s_add_u32 s26,s22,12288
s_add_u32 s38,s38,1
s_cmp_lt_u32 s38,2
v_mfma_f32_16x16x32_bf16 v[80:83],a[212:215],a[164:167],v[80:83]
v_exp_f32 v64,v64
v_mfma_f32_16x16x32_bf16 v[68:71],a[216:219],a[96:99],0
v_exp_f32 v65,v65
v_mfma_f32_16x16x32_bf16 v[68:71],a[220:223],a[100:103],v[68:71]
v_exp_f32 v66,v66
v_mfma_f32_16x16x32_bf16 v[68:71],a[224:227],a[104:107],v[68:71]
v_exp_f32 v67,v67
s_waitcnt vmcnt(12)
s_barrier
v_mfma_f32_16x16x32_bf16 v[68:71],a[228:231],a[108:111],v[68:71]
v_exp_f32 v72,v72
v_mfma_f32_16x16x32_bf16 v[68:71],a[232:235],a[112:115],v[68:71]
ds_read_b64_tr_b16 a[240:241],v3 offset:24576
ds_read_b64_tr_b16 a[242:243],v3 offset:30720
v_mfma_f32_16x16x32_bf16 v[68:71],a[236:239],a[116:119],v[68:71]
v_exp_f32 v73,v73
v_mfma_f32_16x16x32_bf16 v[76:79],a[216:219],a[120:123],0
ds_read_b64_tr_b16 a[244:245],v4 offset:24576
ds_read_b64_tr_b16 a[246:247],v4 offset:30720
v_mfma_f32_16x16x32_bf16 v[76:79],a[220:223],a[124:127],v[76:79]
ds_read_b64_tr_b16 a[248:249],v5 offset:24576
ds_read_b64_tr_b16 a[250:251],v5 offset:30720
v_mfma_f32_16x16x32_bf16 v[76:79],a[224:227],a[128:131],v[76:79]
v_exp_f32 v74,v74
v_mfma_f32_16x16x32_bf16 v[76:79],a[228:231],a[132:135],v[76:79]
ds_read_b64_tr_b16 a[252:253],v6 offset:24576
ds_read_b64_tr_b16 a[254:255],v6 offset:30720
v_mfma_f32_16x16x32_bf16 v[76:79],a[232:235],a[136:139],v[76:79]
v_exp_f32 v75,v75
v_mfma_f32_16x16x32_bf16 v[76:79],a[236:239],a[140:143],v[76:79]
v_cvt_pk_bf16_f32 v112,v64,v65
v_cvt_pk_bf16_f32 v113,v66,v67
v_mfma_f32_16x16x32_bf16 v[84:87],a[216:219],a[144:147],0
v_cvt_pk_bf16_f32 v116,v72,v73
v_cvt_pk_bf16_f32 v117,v74,v75
v_mfma_f32_16x16x32_bf16 v[84:87],a[220:223],a[148:151],v[84:87]
v_xor_b32 v8,80,v8
v_xor_b32 v9,80,v9
v_mfma_f32_16x16x32_bf16 v[84:87],a[224:227],a[152:155],v[84:87]
v_mfma_f32_16x16x32_bf16 v[84:87],a[228:231],a[156:159],v[84:87]
v_mfma_f32_16x16x32_bf16 v[84:87],a[232:235],a[160:163],v[84:87]
v_mfma_f32_16x16x32_bf16 v[84:87],a[236:239],a[164:167],v[84:87]
s_cbranch_scc1 L_loop3w0
s_cmp_ge_u32 s69,8
s_cbranch_scc1 L_end3
s_cmp_eq_u32 s40,0
s_cbranch_scc1 L_tr33
s_branch L_tr34
.p2align 6
L_loop3w1:
s_waitcnt lgkmcnt(4)
v_mfma_f32_16x16x32_bf16 v[160:163],a[240:243],v[96:99],v[160:163]
s_add_u32 m0,s23,12288
ds_read_b128 a[192:195],v1 offset:12288
v_fma_f32 v78,v78,s36,v17
v_mfma_f32_16x16x32_bf16 v[208:211],a[240:243],v[100:103],v[208:211]
buffer_load_dwordx4 v7,s[8:11],s21 offen offset:0 lds
v_mfma_f32_16x16x32_bf16 a[0:3],a[240:243],v[104:107],a[0:3]
s_add_u32 m0,s23,13184
ds_read_b64_tr_b16 a[240:241],v3 offset:25600
ds_read_b64_tr_b16 a[242:243],v3 offset:31744
v_mfma_f32_16x16x32_bf16 v[164:167],a[244:247],v[96:99],v[164:167]
ds_read_b128 a[196:199],v2 offset:12288
v_fma_f32 v86,v86,s36,v18
v_mfma_f32_16x16x32_bf16 v[212:215],a[244:247],v[100:103],v[212:215]
ds_read_b128 a[200:203],v1 offset:13312
v_fma_f32 v85,v85,s36,v18
v_mfma_f32_16x16x32_bf16 a[4:7],a[244:247],v[104:107],a[4:7]
s_waitcnt lgkmcnt(5)
ds_read_b64_tr_b16 a[244:245],v4 offset:25600
ds_read_b64_tr_b16 a[246:247],v4 offset:31744
v_mfma_f32_16x16x32_bf16 v[168:171],a[248:251],v[96:99],v[168:171]
ds_read_b128 a[204:207],v2 offset:13312
v_fma_f32 v77,v77,s36,v17
v_mfma_f32_16x16x32_bf16 v[216:219],a[248:251],v[100:103],v[216:219]
buffer_load_dwordx4 v7,s[8:11],s21 offen offset:128 lds
v_mfma_f32_16x16x32_bf16 a[8:11],a[248:251],v[104:107],a[8:11]
s_add_u32 m0,s23,14080
ds_read_b64_tr_b16 a[248:249],v5 offset:25600
ds_read_b64_tr_b16 a[250:251],v5 offset:31744
v_mfma_f32_16x16x32_bf16 v[172:175],a[252:255],v[96:99],v[172:175]
ds_read_b128 a[208:211],v1 offset:14336
v_fma_f32 v83,v83,s36,v18
v_mfma_f32_16x16x32_bf16 v[220:223],a[252:255],v[100:103],v[220:223]
ds_read_b128 a[212:215],v2 offset:14336
v_fma_f32 v70,v70,s36,v16
v_mfma_f32_16x16x32_bf16 a[12:15],a[252:255],v[104:107],a[12:15]
s_waitcnt lgkmcnt(8)
ds_read_b64_tr_b16 a[252:253],v6 offset:25600
ds_read_b64_tr_b16 a[254:255],v6 offset:31744
v_mfma_f32_16x16x32_bf16 v[176:179],a[240:243],v[96:99],v[176:179]
buffer_load_dwordx4 v7,s[8:11],s21 offen offset:256 lds
v_mfma_f32_16x16x32_bf16 v[224:227],a[240:243],v[100:103],v[224:227]
s_add_u32 s21,s21,12288
ds_read_b128 a[216:219],v1 offset:18432
v_fma_f32 v76,v76,s36,v17
v_mfma_f32_16x16x32_bf16 a[16:19],a[240:243],v[104:107],a[16:19]
s_add_u32 m0,s22,0
ds_read_b64_tr_b16 a[242:243],v3 offset:32768
ds_read_b64_tr_b16 a[240:241],v3 offset:26624
s_waitcnt lgkmcnt(9)
v_mfma_f32_16x16x32_bf16 v[180:183],a[244:247],v[96:99],v[180:183]
ds_read_b128 a[220:223],v2 offset:18432
v_fma_f32 v82,v82,s36,v18
v_mfma_f32_16x16x32_bf16 v[228:231],a[244:247],v[100:103],v[228:231]
ds_read_b128 a[224:227],v1 offset:19456
v_fma_f32 v81,v81,s36,v18
v_mfma_f32_16x16x32_bf16 a[20:23],a[244:247],v[104:107],a[20:23]
s_waitcnt lgkmcnt(8)
ds_read_b64_tr_b16 a[246:247],v4 offset:32768
ds_read_b64_tr_b16 a[244:245],v4 offset:26624
v_mfma_f32_16x16x32_bf16 v[184:187],a[248:251],v[96:99],v[184:187]
buffer_load_dwordx4 v7,s[4:7],s20 offen offset:0 lds
v_mfma_f32_16x16x32_bf16 v[232:235],a[248:251],v[100:103],v[232:235]
s_add_u32 m0,s22,896
ds_read_b128 a[228:231],v2 offset:19456
v_fma_f32 v79,v79,s36,v17
v_mfma_f32_16x16x32_bf16 a[24:27],a[248:251],v[104:107],a[24:27]
s_waitcnt lgkmcnt(8)
ds_read_b64_tr_b16 a[248:249],v5 offset:26624
ds_read_b64_tr_b16 a[250:251],v5 offset:32768
v_mfma_f32_16x16x32_bf16 v[188:191],a[252:255],v[96:99],v[188:191]
ds_read_b128 a[232:235],v1 offset:20480
v_fma_f32 v71,v71,s36,v16
v_mfma_f32_16x16x32_bf16 v[236:239],a[252:255],v[100:103],v[236:239]
ds_read_b128 a[236:239],v2 offset:20480
v_fma_f32 v69,v69,s36,v16
v_mfma_f32_16x16x32_bf16 a[28:31],a[252:255],v[104:107],a[28:31]
s_waitcnt lgkmcnt(8)
ds_read_b64_tr_b16 a[254:255],v6 offset:32768
ds_read_b64_tr_b16 a[252:253],v6 offset:26624
v_mfma_f32_16x16x32_bf16 v[192:195],a[240:243],v[96:99],v[192:195]
buffer_load_dwordx4 v7,s[4:7],s20 offen offset:128 lds
v_mfma_f32_16x16x32_bf16 v[240:243],a[240:243],v[100:103],v[240:243]
s_add_u32 m0,s22,1792
ds_read_b128 v[156:159],v11 offset:0
v_fma_f32 v87,v87,s36,v18
v_mfma_f32_16x16x32_bf16 a[32:35],a[240:243],v[104:107],a[32:35]
s_waitcnt lgkmcnt(8)
v_exp_f32 v76,v76
v_mfma_f32_16x16x32_bf16 v[196:199],a[244:247],v[96:99],v[196:199]
v_exp_f32 v87,v87
v_mfma_f32_16x16x32_bf16 v[244:247],a[244:247],v[100:103],v[244:247]
v_exp_f32 v70,v70
v_mfma_f32_16x16x32_bf16 a[36:39],a[244:247],v[104:107],a[36:39]
s_waitcnt lgkmcnt(4)
v_exp_f32 v83,v83
v_mfma_f32_16x16x32_bf16 v[200:203],a[248:251],v[96:99],v[200:203]
buffer_load_dwordx4 v7,s[4:7],s20 offen offset:256 lds
v_mfma_f32_16x16x32_bf16 v[248:251],a[248:251],v[100:103],v[248:251]
s_add_u32 s20,s20,12288
v_exp_f32 v69,v69
v_mfma_f32_16x16x32_bf16 a[40:43],a[248:251],v[104:107],a[40:43]
s_waitcnt lgkmcnt(1)
v_exp_f32 v79,v79
v_mfma_f32_16x16x32_bf16 v[204:207],a[252:255],v[96:99],v[204:207]
v_exp_f32 v81,v81
v_mfma_f32_16x16x32_bf16 v[252:255],a[252:255],v[100:103],v[252:255]
v_exp_f32 v85,v85
v_mfma_f32_16x16x32_bf16 a[44:47],a[252:255],v[104:107],a[44:47]
v_exp_f32 v71,v71
v_mfma_f32_16x16x32_bf16 v[32:35],a[192:195],a[96:99],0
ds_read_b128 v[152:155],v11 offset:1024
v_fma_f32 v80,v80,s36,v18
v_mfma_f32_16x16x32_bf16 v[32:35],a[196:199],a[100:103],v[32:35]
v_exp_f32 v78,v78
v_mfma_f32_16x16x32_bf16 v[32:35],a[200:203],a[104:107],v[32:35]
v_exp_f32 v86,v86
v_mfma_f32_16x16x32_bf16 v[32:35],a[204:207],a[108:111],v[32:35]
s_waitcnt lgkmcnt(1)
buffer_store_dwordx4 v[156:159],v10,s[16:19],s27 offen offset:0 nt
v_mfma_f32_16x16x32_bf16 v[32:35],a[208:211],a[112:115],v[32:35]
s_add_u32 m0,s29,0
v_exp_f32 v77,v77
v_mfma_f32_16x16x32_bf16 v[32:35],a[212:215],a[116:119],v[32:35]
v_exp_f32 v82,v82
v_mfma_f32_16x16x32_bf16 v[40:43],a[192:195],a[120:123],0
v_exp_f32 v80,v80
v_mfma_f32_16x16x32_bf16 v[40:43],a[196:199],a[124:127],v[40:43]
v_cvt_pk_bf16_f32 v120,v80,v81
v_cvt_pk_bf16_f32 v123,v86,v87
v_mfma_f32_16x16x32_bf16 v[40:43],a[200:203],a[128:131],v[40:43]
v_fma_f32 v84,v84,s36,v18
v_fma_f32 v68,v68,s36,v16
v_mfma_f32_16x16x32_bf16 v[40:43],a[204:207],a[132:135],v[40:43]
v_exp_f32 v84,v84
v_mfma_f32_16x16x32_bf16 v[40:43],a[208:211],a[136:139],v[40:43]
buffer_load_dwordx4 v8,s[12:15],s28 offen offset:0 nt lds
v_mfma_f32_16x16x32_bf16 v[40:43],a[212:215],a[140:143],v[40:43]
v_exp_f32 v68,v68
v_mfma_f32_16x16x32_bf16 v[48:51],a[192:195],a[144:147],0
v_cvt_pk_bf16_f32 v121,v82,v83
v_cvt_pk_bf16_f32 v122,v84,v85
v_mfma_f32_16x16x32_bf16 v[48:51],a[196:199],a[148:151],v[48:51]
v_cvt_pk_bf16_f32 v115,v70,v71
v_fma_f32 v35,v35,s36,v16
v_mfma_f32_16x16x32_bf16 v[136:139],v[24:27],v[120:123],v[136:139]
v_exp_f32 v35,v35
v_mfma_f32_16x16x32_bf16 v[48:51],a[200:203],a[152:155],v[48:51]
v_fma_f32 v41,v41,s36,v17
v_fma_f32 v33,v33,s36,v16
v_mfma_f32_16x16x32_bf16 v[48:51],a[204:207],a[156:159],v[48:51]
s_waitcnt lgkmcnt(0)
buffer_store_dwordx4 v[152:155],v10,s[16:19],s27 offen offset:128 nt
v_mfma_f32_16x16x32_bf16 v[48:51],a[208:211],a[160:163],v[48:51]
s_add_u32 m0,s29,896
v_exp_f32 v41,v41
v_mfma_f32_16x16x32_bf16 v[48:51],a[212:215],a[164:167],v[48:51]
v_exp_f32 v33,v33
s_waitcnt vmcnt(9)
s_barrier
v_mfma_f32_16x16x32_bf16 v[36:39],a[216:219],a[96:99],0
v_cvt_pk_bf16_f32 v118,v76,v77
v_fma_f32 v34,v34,s36,v16
v_mfma_f32_16x16x32_bf16 v[36:39],a[220:223],a[100:103],v[36:39]
v_exp_f32 v34,v34
v_mfma_f32_16x16x32_bf16 v[36:39],a[224:227],a[104:107],v[36:39]
buffer_load_dwordx4 v8,s[12:15],s28 offen offset:128 nt lds
v_mfma_f32_16x16x32_bf16 v[36:39],a[228:231],a[108:111],v[36:39]
v_fma_f32 v42,v42,s36,v17
v_fma_f32 v40,v40,s36,v17
v_mfma_f32_16x16x32_bf16 v[36:39],a[232:235],a[112:115],v[36:39]
v_exp_f32 v40,v40
v_mfma_f32_16x16x32_bf16 v[36:39],a[236:239],a[116:119],v[36:39]
v_exp_f32 v42,v42
v_mfma_f32_16x16x32_bf16 v[44:47],a[216:219],a[120:123],0
ds_read_b64_tr_b16 a[240:241],v3 offset:0
ds_read_b64_tr_b16 a[242:243],v3 offset:6144
v_mfma_f32_16x16x32_bf16 v[44:47],a[220:223],a[124:127],v[44:47]
ds_read_b64_tr_b16 a[244:245],v4 offset:0
v_mfma_f32_16x16x32_bf16 v[44:47],a[224:227],a[128:131],v[44:47]
ds_read_b64_tr_b16 a[246:247],v4 offset:6144
v_cvt_pk_bf16_f32 v114,v68,v69
v_mfma_f32_16x16x32_bf16 v[44:47],a[228:231],a[132:135],v[44:47]
ds_read_b64_tr_b16 a[248:249],v5 offset:0
ds_read_b64_tr_b16 a[250:251],v5 offset:6144
v_mfma_f32_16x16x32_bf16 v[128:131],v[24:27],v[112:115],v[128:131]
ds_read_b64_tr_b16 a[252:253],v6 offset:0
v_mfma_f32_16x16x32_bf16 v[44:47],a[232:235],a[136:139],v[44:47]
ds_read_b64_tr_b16 a[254:255],v6 offset:6144
v_fma_f32 v32,v32,s36,v16
v_mfma_f32_16x16x32_bf16 v[44:47],a[236:239],a[140:143],v[44:47]
v_exp_f32 v32,v32
v_mfma_f32_16x16x32_bf16 v[52:55],a[216:219],a[144:147],0
v_cvt_pk_bf16_f32 v119,v78,v79
v_fma_f32 v43,v43,s36,v17
v_mfma_f32_16x16x32_bf16 v[52:55],a[220:223],a[148:151],v[52:55]
v_exp_f32 v43,v43
v_mfma_f32_16x16x32_bf16 v[132:135],v[24:27],v[116:119],v[132:135]
v_cvt_pk_bf16_f32 v101,v42,v43
v_cvt_pk_bf16_f32 v97,v34,v35
v_mfma_f32_16x16x32_bf16 v[52:55],a[224:227],a[152:155],v[52:55]
v_cvt_pk_bf16_f32 v100,v40,v41
v_cvt_pk_bf16_f32 v96,v32,v33
v_mfma_f32_16x16x32_bf16 v[52:55],a[228:231],a[156:159],v[52:55]
v_mfma_f32_16x16x32_bf16 v[52:55],a[232:235],a[160:163],v[52:55]
v_mfma_f32_16x16x32_bf16 v[52:55],a[236:239],a[164:167],v[52:55]
s_waitcnt lgkmcnt(1)
v_mfma_f32_16x16x32_bf16 v[160:163],a[240:243],v[112:115],v[160:163]
s_add_u32 m0,s23,24576
ds_read_b128 a[192:195],v1 offset:24576
v_fma_f32 v36,v36,s36,v16
v_mfma_f32_16x16x32_bf16 v[208:211],a[240:243],v[116:119],v[208:211]
buffer_load_dwordx4 v7,s[8:11],s21 offen offset:0 lds
v_mfma_f32_16x16x32_bf16 a[0:3],a[240:243],v[120:123],a[0:3]
s_add_u32 m0,s23,25472
ds_read_b64_tr_b16 a[240:241],v3 offset:1024
ds_read_b64_tr_b16 a[242:243],v3 offset:7168
v_mfma_f32_16x16x32_bf16 v[164:167],a[244:247],v[112:115],v[164:167]
ds_read_b128 a[196:199],v2 offset:24576
v_fma_f32 v37,v37,s36,v16
v_mfma_f32_16x16x32_bf16 v[212:215],a[244:247],v[116:119],v[212:215]
ds_read_b128 a[200:203],v1 offset:25600
v_fma_f32 v38,v38,s36,v16
v_mfma_f32_16x16x32_bf16 a[4:7],a[244:247],v[120:123],a[4:7]
ds_read_b64_tr_b16 a[244:245],v4 offset:1024
ds_read_b64_tr_b16 a[246:247],v4 offset:7168
v_mfma_f32_16x16x32_bf16 v[168:171],a[248:251],v[112:115],v[168:171]
ds_read_b128 a[204:207],v2 offset:25600
v_fma_f32 v39,v39,s36,v16
v_mfma_f32_16x16x32_bf16 v[216:219],a[248:251],v[116:119],v[216:219]
buffer_load_dwordx4 v7,s[8:11],s21 offen offset:128 lds
v_mfma_f32_16x16x32_bf16 a[8:11],a[248:251],v[120:123],a[8:11]
s_add_u32 m0,s23,26368
ds_read_b64_tr_b16 a[248:249],v5 offset:1024
ds_read_b64_tr_b16 a[250:251],v5 offset:7168
s_waitcnt lgkmcnt(9)
v_mfma_f32_16x16x32_bf16 v[172:175],a[252:255],v[112:115],v[172:175]
ds_read_b128 a[208:211],v1 offset:26624
v_fma_f32 v44,v44,s36,v17
v_mfma_f32_16x16x32_bf16 v[220:223],a[252:255],v[116:119],v[220:223]
ds_read_b128 a[212:215],v2 offset:26624
v_fma_f32 v45,v45,s36,v17
v_mfma_f32_16x16x32_bf16 a[12:15],a[252:255],v[120:123],a[12:15]
s_waitcnt lgkmcnt(8)
ds_read_b64_tr_b16 a[252:253],v6 offset:1024
ds_read_b64_tr_b16 a[254:255],v6 offset:7168
v_mfma_f32_16x16x32_bf16 v[176:179],a[240:243],v[112:115],v[176:179]
buffer_load_dwordx4 v7,s[8:11],s21 offen offset:256 lds
v_mfma_f32_16x16x32_bf16 v[224:227],a[240:243],v[116:119],v[224:227]
s_add_u32 s21,s21,12288
ds_read_b128 a[216:219],v1 offset:30720
v_fma_f32 v46,v46,s36,v17
v_mfma_f32_16x16x32_bf16 a[16:19],a[240:243],v[120:123],a[16:19]
s_add_u32 m0,s22,12288
ds_read_b64_tr_b16 a[240:241],v3 offset:2048
ds_read_b64_tr_b16 a[242:243],v3 offset:8192
s_waitcnt lgkmcnt(9)
v_mfma_f32_16x16x32_bf16 v[180:183],a[244:247],v[112:115],v[180:183]
ds_read_b128 a[220:223],v2 offset:30720
v_fma_f32 v47,v47,s36,v17
v_mfma_f32_16x16x32_bf16 v[228:231],a[244:247],v[116:119],v[228:231]
ds_read_b128 a[224:227],v1 offset:31744
v_fma_f32 v48,v48,s36,v18
v_mfma_f32_16x16x32_bf16 a[20:23],a[244:247],v[120:123],a[20:23]
s_waitcnt lgkmcnt(8)
ds_read_b64_tr_b16 a[244:245],v4 offset:2048
ds_read_b64_tr_b16 a[246:247],v4 offset:8192
v_mfma_f32_16x16x32_bf16 v[184:187],a[248:251],v[112:115],v[184:187]
buffer_load_dwordx4 v7,s[4:7],s20 offen offset:0 lds
v_mfma_f32_16x16x32_bf16 v[232:235],a[248:251],v[116:119],v[232:235]
s_add_u32 m0,s22,13184
ds_read_b128 a[228:231],v2 offset:31744
v_fma_f32 v49,v49,s36,v18
v_mfma_f32_16x16x32_bf16 a[24:27],a[248:251],v[120:123],a[24:27]
s_waitcnt lgkmcnt(8)
ds_read_b64_tr_b16 a[248:249],v5 offset:2048
ds_read_b64_tr_b16 a[250:251],v5 offset:8192
v_mfma_f32_16x16x32_bf16 v[188:191],a[252:255],v[112:115],v[188:191]
ds_read_b128 a[232:235],v1 offset:32768
v_fma_f32 v50,v50,s36,v18
v_mfma_f32_16x16x32_bf16 v[236:239],a[252:255],v[116:119],v[236:239]
ds_read_b128 a[236:239],v2 offset:32768
v_fma_f32 v51,v51,s36,v18
v_mfma_f32_16x16x32_bf16 a[28:31],a[252:255],v[120:123],a[28:31]
s_waitcnt lgkmcnt(8)
ds_read_b64_tr_b16 a[252:253],v6 offset:2048
ds_read_b64_tr_b16 a[254:255],v6 offset:8192
v_mfma_f32_16x16x32_bf16 v[192:195],a[240:243],v[112:115],v[192:195]
buffer_load_dwordx4 v7,s[4:7],s20 offen offset:128 lds
v_mfma_f32_16x16x32_bf16 v[240:243],a[240:243],v[116:119],v[240:243]
s_add_u32 m0,s22,14080
ds_read_b128 v[156:159],v11 offset:2048
v_fma_f32 v52,v52,s36,v18
v_mfma_f32_16x16x32_bf16 a[32:35],a[240:243],v[120:123],a[32:35]
s_waitcnt lgkmcnt(8)
v_fma_f32 v53,v53,s36,v18
v_fma_f32 v54,v54,s36,v18
v_mfma_f32_16x16x32_bf16 v[196:199],a[244:247],v[112:115],v[196:199]
v_fma_f32 v55,v55,s36,v18
v_mfma_f32_16x16x32_bf16 v[244:247],a[244:247],v[116:119],v[244:247]
v_exp_f32 v36,v36
v_mfma_f32_16x16x32_bf16 a[36:39],a[244:247],v[120:123],a[36:39]
s_waitcnt lgkmcnt(4)
v_exp_f32 v37,v37
v_mfma_f32_16x16x32_bf16 v[200:203],a[248:251],v[112:115],v[200:203]
buffer_load_dwordx4 v7,s[4:7],s20 offen offset:256 lds
v_mfma_f32_16x16x32_bf16 v[248:251],a[248:251],v[116:119],v[248:251]
s_add_u32 s20,s20,12288
v_exp_f32 v38,v38
v_mfma_f32_16x16x32_bf16 a[40:43],a[248:251],v[120:123],a[40:43]
s_waitcnt lgkmcnt(1)
v_exp_f32 v39,v39
v_mfma_f32_16x16x32_bf16 v[204:207],a[252:255],v[112:115],v[204:207]
v_exp_f32 v44,v44
v_mfma_f32_16x16x32_bf16 v[252:255],a[252:255],v[116:119],v[252:255]
v_exp_f32 v45,v45
v_mfma_f32_16x16x32_bf16 a[44:47],a[252:255],v[120:123],a[44:47]
v_exp_f32 v46,v46
v_mfma_f32_16x16x32_bf16 v[64:67],a[192:195],a[96:99],0
v_exp_f32 v47,v47
v_mfma_f32_16x16x32_bf16 v[64:67],a[196:199],a[100:103],v[64:67]
v_exp_f32 v48,v48
v_mfma_f32_16x16x32_bf16 v[64:67],a[200:203],a[104:107],v[64:67]
v_exp_f32 v49,v49
v_mfma_f32_16x16x32_bf16 v[64:67],a[204:207],a[108:111],v[64:67]
s_waitcnt lgkmcnt(0)
buffer_store_dwordx4 v[156:159],v10,s[16:19],s27 offen offset:256 nt
v_mfma_f32_16x16x32_bf16 v[64:67],a[208:211],a[112:115],v[64:67]
s_add_u32 m0,s29,1792
v_exp_f32 v50,v50
v_mfma_f32_16x16x32_bf16 v[64:67],a[212:215],a[116:119],v[64:67]
v_exp_f32 v51,v51
v_mfma_f32_16x16x32_bf16 v[72:75],a[192:195],a[120:123],0
v_exp_f32 v52,v52
v_mfma_f32_16x16x32_bf16 v[72:75],a[196:199],a[124:127],v[72:75]
v_exp_f32 v53,v53
v_mfma_f32_16x16x32_bf16 v[72:75],a[200:203],a[128:131],v[72:75]
v_exp_f32 v54,v54
v_mfma_f32_16x16x32_bf16 v[72:75],a[204:207],a[132:135],v[72:75]
v_exp_f32 v55,v55
v_mfma_f32_16x16x32_bf16 v[72:75],a[208:211],a[136:139],v[72:75]
v_cvt_pk_bf16_f32 v98,v36,v37
v_cvt_pk_bf16_f32 v99,v38,v39
v_mfma_f32_16x16x32_bf16 v[72:75],a[212:215],a[140:143],v[72:75]
v_cvt_pk_bf16_f32 v102,v44,v45
v_cvt_pk_bf16_f32 v103,v46,v47
v_mfma_f32_16x16x32_bf16 v[128:131],v[24:27],v[96:99],v[128:131]
v_cvt_pk_bf16_f32 v104,v48,v49
v_cvt_pk_bf16_f32 v105,v50,v51
v_mfma_f32_16x16x32_bf16 v[132:135],v[24:27],v[100:103],v[132:135]
v_cvt_pk_bf16_f32 v106,v52,v53
v_cvt_pk_bf16_f32 v107,v54,v55
v_mfma_f32_16x16x32_bf16 v[80:83],a[192:195],a[144:147],0
v_fma_f32 v64,v64,s36,v16
v_fma_f32 v65,v65,s36,v16
v_mfma_f32_16x16x32_bf16 v[136:139],v[24:27],v[104:107],v[136:139]
v_fma_f32 v66,v66,s36,v16
v_fma_f32 v67,v67,s36,v16
v_mfma_f32_16x16x32_bf16 v[80:83],a[196:199],a[148:151],v[80:83]
buffer_load_dwordx4 v8,s[12:15],s28 offen offset:256 nt lds
v_mfma_f32_16x16x32_bf16 v[80:83],a[200:203],a[152:155],v[80:83]
s_add_u32 s27,s27,3072
v_fma_f32 v72,v72,s36,v17
v_fma_f32 v73,v73,s36,v17
v_mfma_f32_16x16x32_bf16 v[80:83],a[204:207],a[156:159],v[80:83]
s_add_u32 s28,s28,3072
v_fma_f32 v74,v74,s36,v17
v_fma_f32 v75,v75,s36,v17
v_mfma_f32_16x16x32_bf16 v[80:83],a[208:211],a[160:163],v[80:83]
s_add_u32 s29,s29,3072
s_waitcnt vmcnt(12)
s_barrier
v_mfma_f32_16x16x32_bf16 v[80:83],a[212:215],a[164:167],v[80:83]
v_exp_f32 v64,v64
v_mfma_f32_16x16x32_bf16 v[68:71],a[216:219],a[96:99],0
v_exp_f32 v65,v65
v_mfma_f32_16x16x32_bf16 v[68:71],a[220:223],a[100:103],v[68:71]
v_exp_f32 v66,v66
v_mfma_f32_16x16x32_bf16 v[68:71],a[224:227],a[104:107],v[68:71]
v_exp_f32 v67,v67
v_mfma_f32_16x16x32_bf16 v[68:71],a[228:231],a[108:111],v[68:71]
v_exp_f32 v72,v72
v_mfma_f32_16x16x32_bf16 v[68:71],a[232:235],a[112:115],v[68:71]
v_exp_f32 v73,v73
v_mfma_f32_16x16x32_bf16 v[68:71],a[236:239],a[116:119],v[68:71]
ds_read_b64_tr_b16 a[240:241],v3 offset:12288
ds_read_b64_tr_b16 a[242:243],v3 offset:18432
v_mfma_f32_16x16x32_bf16 v[76:79],a[216:219],a[120:123],0
v_exp_f32 v74,v74
v_mfma_f32_16x16x32_bf16 v[76:79],a[220:223],a[124:127],v[76:79]
ds_read_b64_tr_b16 a[244:245],v4 offset:12288
ds_read_b64_tr_b16 a[246:247],v4 offset:18432
v_mfma_f32_16x16x32_bf16 v[76:79],a[224:227],a[128:131],v[76:79]
ds_read_b64_tr_b16 a[248:249],v5 offset:12288
ds_read_b64_tr_b16 a[250:251],v5 offset:18432
v_mfma_f32_16x16x32_bf16 v[76:79],a[228:231],a[132:135],v[76:79]
v_exp_f32 v75,v75
v_mfma_f32_16x16x32_bf16 v[76:79],a[232:235],a[136:139],v[76:79]
ds_read_b64_tr_b16 a[252:253],v6 offset:12288
ds_read_b64_tr_b16 a[254:255],v6 offset:18432
v_mfma_f32_16x16x32_bf16 v[76:79],a[236:239],a[140:143],v[76:79]
v_cvt_pk_bf16_f32 v112,v64,v65
v_cvt_pk_bf16_f32 v113,v66,v67
v_mfma_f32_16x16x32_bf16 v[84:87],a[216:219],a[144:147],0
v_cvt_pk_bf16_f32 v116,v72,v73
v_cvt_pk_bf16_f32 v117,v74,v75
v_mfma_f32_16x16x32_bf16 v[84:87],a[220:223],a[148:151],v[84:87]
v_mfma_f32_16x16x32_bf16 v[84:87],a[224:227],a[152:155],v[84:87]
v_mfma_f32_16x16x32_bf16 v[84:87],a[228:231],a[156:159],v[84:87]
v_mfma_f32_16x16x32_bf16 v[84:87],a[232:235],a[160:163],v[84:87]
v_mfma_f32_16x16x32_bf16 v[84:87],a[236:239],a[164:167],v[84:87]
s_waitcnt lgkmcnt(2)
v_mfma_f32_16x16x32_bf16 v[160:163],a[240:243],v[96:99],v[160:163]
s_add_u32 m0,s23,0
ds_read_b128 a[192:195],v1 offset:0
v_fma_f32 v78,v78,s36,v17
v_mfma_f32_16x16x32_bf16 v[208:211],a[240:243],v[100:103],v[208:211]
buffer_load_dwordx4 v7,s[8:11],s21 offen offset:0 lds
v_mfma_f32_16x16x32_bf16 a[0:3],a[240:243],v[104:107],a[0:3]
s_add_u32 m0,s23,896
ds_read_b64_tr_b16 a[240:241],v3 offset:13312
ds_read_b64_tr_b16 a[242:243],v3 offset:19456
v_mfma_f32_16x16x32_bf16 v[164:167],a[244:247],v[96:99],v[164:167]
ds_read_b128 a[196:199],v2 offset:0
v_fma_f32 v86,v86,s36,v18
v_mfma_f32_16x16x32_bf16 v[212:215],a[244:247],v[100:103],v[212:215]
ds_read_b128 a[200:203],v1 offset:1024
v_fma_f32 v85,v85,s36,v18
v_mfma_f32_16x16x32_bf16 a[4:7],a[244:247],v[104:107],a[4:7]
ds_read_b64_tr_b16 a[244:245],v4 offset:13312
ds_read_b64_tr_b16 a[246:247],v4 offset:19456
v_mfma_f32_16x16x32_bf16 v[168:171],a[248:251],v[96:99],v[168:171]
ds_read_b128 a[204:207],v2 offset:1024
v_fma_f32 v77,v77,s36,v17
v_mfma_f32_16x16x32_bf16 v[216:219],a[248:251],v[100:103],v[216:219]
buffer_load_dwordx4 v7,s[8:11],s21 offen offset:128 lds
v_mfma_f32_16x16x32_bf16 a[8:11],a[248:251],v[104:107],a[8:11]
s_add_u32 m0,s23,1792
ds_read_b64_tr_b16 a[248:249],v5 offset:13312
ds_read_b64_tr_b16 a[250:251],v5 offset:19456
s_waitcnt lgkmcnt(9)
v_mfma_f32_16x16x32_bf16 v[172:175],a[252:255],v[96:99],v[172:175]
ds_read_b128 a[208:211],v1 offset:2048
v_fma_f32 v83,v83,s36,v18
v_mfma_f32_16x16x32_bf16 v[220:223],a[252:255],v[100:103],v[220:223]
ds_read_b128 a[212:215],v2 offset:2048
v_fma_f32 v70,v70,s36,v16
v_mfma_f32_16x16x32_bf16 a[12:15],a[252:255],v[104:107],a[12:15]
s_waitcnt lgkmcnt(8)
ds_read_b64_tr_b16 a[252:253],v6 offset:13312
ds_read_b64_tr_b16 a[254:255],v6 offset:19456
v_mfma_f32_16x16x32_bf16 v[176:179],a[240:243],v[96:99],v[176:179]
buffer_load_dwordx4 v7,s[8:11],s21 offen offset:256 lds
v_mfma_f32_16x16x32_bf16 v[224:227],a[240:243],v[100:103],v[224:227]
s_add_u32 s21,s21,12288
ds_read_b128 a[216:219],v1 offset:6144
v_fma_f32 v76,v76,s36,v17
v_mfma_f32_16x16x32_bf16 a[16:19],a[240:243],v[104:107],a[16:19]
s_add_u32 m0,s22,24576
ds_read_b64_tr_b16 a[242:243],v3 offset:20480
ds_read_b64_tr_b16 a[240:241],v3 offset:14336
s_waitcnt lgkmcnt(9)
v_mfma_f32_16x16x32_bf16 v[180:183],a[244:247],v[96:99],v[180:183]
ds_read_b128 a[220:223],v2 offset:6144
v_fma_f32 v82,v82,s36,v18
v_mfma_f32_16x16x32_bf16 v[228:231],a[244:247],v[100:103],v[228:231]
ds_read_b128 a[224:227],v1 offset:7168
v_fma_f32 v81,v81,s36,v18
v_mfma_f32_16x16x32_bf16 a[20:23],a[244:247],v[104:107],a[20:23]
s_waitcnt lgkmcnt(8)
ds_read_b64_tr_b16 a[246:247],v4 offset:20480
ds_read_b64_tr_b16 a[244:245],v4 offset:14336
v_mfma_f32_16x16x32_bf16 v[184:187],a[248:251],v[96:99],v[184:187]
buffer_load_dwordx4 v7,s[4:7],s20 offen offset:0 lds
v_mfma_f32_16x16x32_bf16 v[232:235],a[248:251],v[100:103],v[232:235]
s_add_u32 m0,s22,25472
ds_read_b128 a[228:231],v2 offset:7168
v_fma_f32 v79,v79,s36,v17
v_mfma_f32_16x16x32_bf16 a[24:27],a[248:251],v[104:107],a[24:27]
s_waitcnt lgkmcnt(8)
ds_read_b64_tr_b16 a[248:249],v5 offset:14336
ds_read_b64_tr_b16 a[250:251],v5 offset:20480
v_mfma_f32_16x16x32_bf16 v[188:191],a[252:255],v[96:99],v[188:191]
ds_read_b128 a[232:235],v1 offset:8192
v_fma_f32 v71,v71,s36,v16
v_mfma_f32_16x16x32_bf16 v[236:239],a[252:255],v[100:103],v[236:239]
ds_read_b128 a[236:239],v2 offset:8192
v_fma_f32 v69,v69,s36,v16
v_mfma_f32_16x16x32_bf16 a[28:31],a[252:255],v[104:107],a[28:31]
s_waitcnt lgkmcnt(8)
ds_read_b64_tr_b16 a[254:255],v6 offset:20480
ds_read_b64_tr_b16 a[252:253],v6 offset:14336
v_mfma_f32_16x16x32_bf16 v[192:195],a[240:243],v[96:99],v[192:195]
buffer_load_dwordx4 v7,s[4:7],s20 offen offset:128 lds
v_mfma_f32_16x16x32_bf16 v[240:243],a[240:243],v[100:103],v[240:243]
s_add_u32 m0,s22,26368
ds_read_b128 v[152:155],v11 offset:3072
v_fma_f32 v87,v87,s36,v18
v_mfma_f32_16x16x32_bf16 a[32:35],a[240:243],v[104:107],a[32:35]
s_waitcnt lgkmcnt(8)
v_exp_f32 v76,v76
v_mfma_f32_16x16x32_bf16 v[196:199],a[244:247],v[96:99],v[196:199]
v_exp_f32 v87,v87
v_mfma_f32_16x16x32_bf16 v[244:247],a[244:247],v[100:103],v[244:247]
v_exp_f32 v70,v70
v_mfma_f32_16x16x32_bf16 a[36:39],a[244:247],v[104:107],a[36:39]
s_waitcnt lgkmcnt(4)
v_exp_f32 v83,v83
v_mfma_f32_16x16x32_bf16 v[200:203],a[248:251],v[96:99],v[200:203]
buffer_load_dwordx4 v7,s[4:7],s20 offen offset:256 lds
v_mfma_f32_16x16x32_bf16 v[248:251],a[248:251],v[100:103],v[248:251]
s_add_u32 s20,s20,12288
v_exp_f32 v69,v69
v_mfma_f32_16x16x32_bf16 a[40:43],a[248:251],v[104:107],a[40:43]
s_waitcnt lgkmcnt(1)
v_exp_f32 v79,v79
v_mfma_f32_16x16x32_bf16 v[204:207],a[252:255],v[96:99],v[204:207]
v_exp_f32 v81,v81
v_mfma_f32_16x16x32_bf16 v[252:255],a[252:255],v[100:103],v[252:255]
v_exp_f32 v85,v85
v_mfma_f32_16x16x32_bf16 a[44:47],a[252:255],v[104:107],a[44:47]
v_exp_f32 v71,v71
v_mfma_f32_16x16x32_bf16 v[32:35],a[192:195],a[96:99],0
ds_read_b128 v[156:159],v11 offset:4096
v_fma_f32 v80,v80,s36,v18
v_mfma_f32_16x16x32_bf16 v[32:35],a[196:199],a[100:103],v[32:35]
v_exp_f32 v78,v78
v_mfma_f32_16x16x32_bf16 v[32:35],a[200:203],a[104:107],v[32:35]
v_exp_f32 v86,v86
v_mfma_f32_16x16x32_bf16 v[32:35],a[204:207],a[108:111],v[32:35]
s_waitcnt lgkmcnt(1)
buffer_store_dwordx4 v[152:155],v10,s[16:19],s27 offen offset:0 nt
v_mfma_f32_16x16x32_bf16 v[32:35],a[208:211],a[112:115],v[32:35]
s_add_u32 m0,s29,0
v_exp_f32 v77,v77
v_mfma_f32_16x16x32_bf16 v[32:35],a[212:215],a[116:119],v[32:35]
v_exp_f32 v82,v82
v_mfma_f32_16x16x32_bf16 v[40:43],a[192:195],a[120:123],0
v_exp_f32 v80,v80
v_mfma_f32_16x16x32_bf16 v[40:43],a[196:199],a[124:127],v[40:43]
v_cvt_pk_bf16_f32 v120,v80,v81
v_cvt_pk_bf16_f32 v123,v86,v87
v_mfma_f32_16x16x32_bf16 v[40:43],a[200:203],a[128:131],v[40:43]
v_fma_f32 v84,v84,s36,v18
v_fma_f32 v68,v68,s36,v16
v_mfma_f32_16x16x32_bf16 v[40:43],a[204:207],a[132:135],v[40:43]
v_exp_f32 v84,v84
v_mfma_f32_16x16x32_bf16 v[40:43],a[208:211],a[136:139],v[40:43]
buffer_load_dwordx4 v9,s[12:15],s28 offen offset:0 nt lds
v_mfma_f32_16x16x32_bf16 v[40:43],a[212:215],a[140:143],v[40:43]
v_exp_f32 v68,v68
v_mfma_f32_16x16x32_bf16 v[48:51],a[192:195],a[144:147],0
v_cvt_pk_bf16_f32 v121,v82,v83
v_cvt_pk_bf16_f32 v122,v84,v85
v_mfma_f32_16x16x32_bf16 v[48:51],a[196:199],a[148:151],v[48:51]
v_cvt_pk_bf16_f32 v115,v70,v71
v_fma_f32 v35,v35,s36,v16
v_mfma_f32_16x16x32_bf16 v[136:139],v[24:27],v[120:123],v[136:139]
v_exp_f32 v35,v35
v_mfma_f32_16x16x32_bf16 v[48:51],a[200:203],a[152:155],v[48:51]
v_fma_f32 v41,v41,s36,v17
v_fma_f32 v33,v33,s36,v16
v_mfma_f32_16x16x32_bf16 v[48:51],a[204:207],a[156:159],v[48:51]
s_waitcnt lgkmcnt(0)
buffer_store_dwordx4 v[156:159],v10,s[16:19],s27 offen offset:128 nt
v_mfma_f32_16x16x32_bf16 v[48:51],a[208:211],a[160:163],v[48:51]
s_add_u32 m0,s29,896
v_exp_f32 v41,v41
v_mfma_f32_16x16x32_bf16 v[48:51],a[212:215],a[164:167],v[48:51]
v_exp_f32 v33,v33
s_waitcnt vmcnt(11)
s_barrier
v_mfma_f32_16x16x32_bf16 v[36:39],a[216:219],a[96:99],0
v_cvt_pk_bf16_f32 v118,v76,v77
v_fma_f32 v34,v34,s36,v16
v_mfma_f32_16x16x32_bf16 v[36:39],a[220:223],a[100:103],v[36:39]
v_exp_f32 v34,v34
v_mfma_f32_16x16x32_bf16 v[36:39],a[224:227],a[104:107],v[36:39]
buffer_load_dwordx4 v9,s[12:15],s28 offen offset:128 nt lds
v_mfma_f32_16x16x32_bf16 v[36:39],a[228:231],a[108:111],v[36:39]
v_fma_f32 v42,v42,s36,v17
v_fma_f32 v40,v40,s36,v17
v_mfma_f32_16x16x32_bf16 v[36:39],a[232:235],a[112:115],v[36:39]
v_exp_f32 v40,v40
v_mfma_f32_16x16x32_bf16 v[36:39],a[236:239],a[116:119],v[36:39]
v_exp_f32 v42,v42
v_mfma_f32_16x16x32_bf16 v[44:47],a[216:219],a[120:123],0
ds_read_b64_tr_b16 a[240:241],v3 offset:24576
ds_read_b64_tr_b16 a[242:243],v3 offset:30720
v_mfma_f32_16x16x32_bf16 v[44:47],a[220:223],a[124:127],v[44:47]
ds_read_b64_tr_b16 a[244:245],v4 offset:24576
v_mfma_f32_16x16x32_bf16 v[44:47],a[224:227],a[128:131],v[44:47]
ds_read_b64_tr_b16 a[246:247],v4 offset:30720
v_cvt_pk_bf16_f32 v114,v68,v69
v_mfma_f32_16x16x32_bf16 v[44:47],a[228:231],a[132:135],v[44:47]
ds_read_b64_tr_b16 a[248:249],v5 offset:24576
ds_read_b64_tr_b16 a[250:251],v5 offset:30720
v_mfma_f32_16x16x32_bf16 v[128:131],v[24:27],v[112:115],v[128:131]
ds_read_b64_tr_b16 a[252:253],v6 offset:24576
v_mfma_f32_16x16x32_bf16 v[44:47],a[232:235],a[136:139],v[44:47]
ds_read_b64_tr_b16 a[254:255],v6 offset:30720
v_fma_f32 v32,v32,s36,v16
v_mfma_f32_16x16x32_bf16 v[44:47],a[236:239],a[140:143],v[44:47]
v_exp_f32 v32,v32
v_mfma_f32_16x16x32_bf16 v[52:55],a[216:219],a[144:147],0
v_cvt_pk_bf16_f32 v119,v78,v79
v_fma_f32 v43,v43,s36,v17
v_mfma_f32_16x16x32_bf16 v[52:55],a[220:223],a[148:151],v[52:55]
v_exp_f32 v43,v43
v_mfma_f32_16x16x32_bf16 v[132:135],v[24:27],v[116:119],v[132:135]
v_cvt_pk_bf16_f32 v101,v42,v43
v_cvt_pk_bf16_f32 v97,v34,v35
v_mfma_f32_16x16x32_bf16 v[52:55],a[224:227],a[152:155],v[52:55]
v_cvt_pk_bf16_f32 v100,v40,v41
v_cvt_pk_bf16_f32 v96,v32,v33
v_mfma_f32_16x16x32_bf16 v[52:55],a[228:231],a[156:159],v[52:55]
v_mfma_f32_16x16x32_bf16 v[52:55],a[232:235],a[160:163],v[52:55]
v_mfma_f32_16x16x32_bf16 v[52:55],a[236:239],a[164:167],v[52:55]
s_waitcnt lgkmcnt(1)
v_mfma_f32_16x16x32_bf16 v[160:163],a[240:243],v[112:115],v[160:163]
s_add_u32 m0,s23,12288
ds_read_b128 a[192:195],v1 offset:12288
v_fma_f32 v36,v36,s36,v16
v_mfma_f32_16x16x32_bf16 v[208:211],a[240:243],v[116:119],v[208:211]
buffer_load_dwordx4 v7,s[8:11],s21 offen offset:0 lds
v_mfma_f32_16x16x32_bf16 a[0:3],a[240:243],v[120:123],a[0:3]
s_add_u32 m0,s23,13184
ds_read_b64_tr_b16 a[240:241],v3 offset:25600
ds_read_b64_tr_b16 a[242:243],v3 offset:31744
v_mfma_f32_16x16x32_bf16 v[164:167],a[244:247],v[112:115],v[164:167]
ds_read_b128 a[196:199],v2 offset:12288
v_fma_f32 v37,v37,s36,v16
v_mfma_f32_16x16x32_bf16 v[212:215],a[244:247],v[116:119],v[212:215]
ds_read_b128 a[200:203],v1 offset:13312
v_fma_f32 v38,v38,s36,v16
v_mfma_f32_16x16x32_bf16 a[4:7],a[244:247],v[120:123],a[4:7]
ds_read_b64_tr_b16 a[244:245],v4 offset:25600
ds_read_b64_tr_b16 a[246:247],v4 offset:31744
v_mfma_f32_16x16x32_bf16 v[168:171],a[248:251],v[112:115],v[168:171]
ds_read_b128 a[204:207],v2 offset:13312
v_fma_f32 v39,v39,s36,v16
v_mfma_f32_16x16x32_bf16 v[216:219],a[248:251],v[116:119],v[216:219]
buffer_load_dwordx4 v7,s[8:11],s21 offen offset:128 lds
v_mfma_f32_16x16x32_bf16 a[8:11],a[248:251],v[120:123],a[8:11]
s_add_u32 m0,s23,14080
ds_read_b64_tr_b16 a[248:249],v5 offset:25600
ds_read_b64_tr_b16 a[250:251],v5 offset:31744
s_waitcnt lgkmcnt(9)
v_mfma_f32_16x16x32_bf16 v[172:175],a[252:255],v[112:115],v[172:175]
ds_read_b128 a[208:211],v1 offset:14336
v_fma_f32 v44,v44,s36,v17
v_mfma_f32_16x16x32_bf16 v[220:223],a[252:255],v[116:119],v[220:223]
ds_read_b128 a[212:215],v2 offset:14336
v_fma_f32 v45,v45,s36,v17
v_mfma_f32_16x16x32_bf16 a[12:15],a[252:255],v[120:123],a[12:15]
s_waitcnt lgkmcnt(8)
ds_read_b64_tr_b16 a[252:253],v6 offset:25600
ds_read_b64_tr_b16 a[254:255],v6 offset:31744
v_mfma_f32_16x16x32_bf16 v[176:179],a[240:243],v[112:115],v[176:179]
buffer_load_dwordx4 v7,s[8:11],s21 offen offset:256 lds
v_mfma_f32_16x16x32_bf16 v[224:227],a[240:243],v[116:119],v[224:227]
s_add_u32 s21,s21,12288
ds_read_b128 a[216:219],v1 offset:18432
v_fma_f32 v46,v46,s36,v17
v_mfma_f32_16x16x32_bf16 a[16:19],a[240:243],v[120:123],a[16:19]
s_add_u32 m0,s22,0
ds_read_b64_tr_b16 a[240:241],v3 offset:26624
ds_read_b64_tr_b16 a[242:243],v3 offset:32768
s_waitcnt lgkmcnt(9)
v_mfma_f32_16x16x32_bf16 v[180:183],a[244:247],v[112:115],v[180:183]
ds_read_b128 a[220:223],v2 offset:18432
v_fma_f32 v47,v47,s36,v17
v_mfma_f32_16x16x32_bf16 v[228:231],a[244:247],v[116:119],v[228:231]
ds_read_b128 a[224:227],v1 offset:19456
v_fma_f32 v48,v48,s36,v18
v_mfma_f32_16x16x32_bf16 a[20:23],a[244:247],v[120:123],a[20:23]
s_waitcnt lgkmcnt(8)
ds_read_b64_tr_b16 a[244:245],v4 offset:26624
ds_read_b64_tr_b16 a[246:247],v4 offset:32768
v_mfma_f32_16x16x32_bf16 v[184:187],a[248:251],v[112:115],v[184:187]
buffer_load_dwordx4 v7,s[4:7],s20 offen offset:0 lds
v_mfma_f32_16x16x32_bf16 v[232:235],a[248:251],v[116:119],v[232:235]
s_add_u32 m0,s22,896
ds_read_b128 a[228:231],v2 offset:19456
v_fma_f32 v49,v49,s36,v18
v_mfma_f32_16x16x32_bf16 a[24:27],a[248:251],v[120:123],a[24:27]
s_waitcnt lgkmcnt(8)
ds_read_b64_tr_b16 a[248:249],v5 offset:26624
ds_read_b64_tr_b16 a[250:251],v5 offset:32768
v_mfma_f32_16x16x32_bf16 v[188:191],a[252:255],v[112:115],v[188:191]
ds_read_b128 a[232:235],v1 offset:20480
v_fma_f32 v50,v50,s36,v18
v_mfma_f32_16x16x32_bf16 v[236:239],a[252:255],v[116:119],v[236:239]
ds_read_b128 a[236:239],v2 offset:20480
v_fma_f32 v51,v51,s36,v18
v_mfma_f32_16x16x32_bf16 a[28:31],a[252:255],v[120:123],a[28:31]
s_waitcnt lgkmcnt(8)
ds_read_b64_tr_b16 a[252:253],v6 offset:26624
ds_read_b64_tr_b16 a[254:255],v6 offset:32768
v_mfma_f32_16x16x32_bf16 v[192:195],a[240:243],v[112:115],v[192:195]
buffer_load_dwordx4 v7,s[4:7],s20 offen offset:128 lds
v_mfma_f32_16x16x32_bf16 v[240:243],a[240:243],v[116:119],v[240:243]
s_add_u32 m0,s22,1792
ds_read_b128 v[152:155],v11 offset:5120
v_fma_f32 v52,v52,s36,v18
v_mfma_f32_16x16x32_bf16 a[32:35],a[240:243],v[120:123],a[32:35]
s_waitcnt lgkmcnt(8)
v_fma_f32 v53,v53,s36,v18
v_fma_f32 v54,v54,s36,v18
v_mfma_f32_16x16x32_bf16 v[196:199],a[244:247],v[112:115],v[196:199]
v_fma_f32 v55,v55,s36,v18
v_mfma_f32_16x16x32_bf16 v[244:247],a[244:247],v[116:119],v[244:247]
v_exp_f32 v36,v36
v_mfma_f32_16x16x32_bf16 a[36:39],a[244:247],v[120:123],a[36:39]
s_waitcnt lgkmcnt(4)
v_exp_f32 v37,v37
v_mfma_f32_16x16x32_bf16 v[200:203],a[248:251],v[112:115],v[200:203]
buffer_load_dwordx4 v7,s[4:7],s20 offen offset:256 lds
v_mfma_f32_16x16x32_bf16 v[248:251],a[248:251],v[116:119],v[248:251]
s_add_u32 s20,s20,12288
v_exp_f32 v38,v38
v_mfma_f32_16x16x32_bf16 a[40:43],a[248:251],v[120:123],a[40:43]
s_waitcnt lgkmcnt(1)
v_exp_f32 v39,v39
v_mfma_f32_16x16x32_bf16 v[204:207],a[252:255],v[112:115],v[204:207]
v_exp_f32 v44,v44
v_mfma_f32_16x16x32_bf16 v[252:255],a[252:255],v[116:119],v[252:255]
v_exp_f32 v45,v45
v_mfma_f32_16x16x32_bf16 a[44:47],a[252:255],v[120:123],a[44:47]
v_exp_f32 v46,v46
v_mfma_f32_16x16x32_bf16 v[64:67],a[192:195],a[96:99],0
v_exp_f32 v47,v47
v_mfma_f32_16x16x32_bf16 v[64:67],a[196:199],a[100:103],v[64:67]
v_exp_f32 v48,v48
v_mfma_f32_16x16x32_bf16 v[64:67],a[200:203],a[104:107],v[64:67]
v_exp_f32 v49,v49
v_mfma_f32_16x16x32_bf16 v[64:67],a[204:207],a[108:111],v[64:67]
s_waitcnt lgkmcnt(0)
buffer_store_dwordx4 v[152:155],v10,s[16:19],s27 offen offset:256 nt
v_mfma_f32_16x16x32_bf16 v[64:67],a[208:211],a[112:115],v[64:67]
s_add_u32 m0,s29,1792
v_exp_f32 v50,v50
v_mfma_f32_16x16x32_bf16 v[64:67],a[212:215],a[116:119],v[64:67]
v_exp_f32 v51,v51
v_mfma_f32_16x16x32_bf16 v[72:75],a[192:195],a[120:123],0
v_exp_f32 v52,v52
v_mfma_f32_16x16x32_bf16 v[72:75],a[196:199],a[124:127],v[72:75]
v_exp_f32 v53,v53
v_mfma_f32_16x16x32_bf16 v[72:75],a[200:203],a[128:131],v[72:75]
v_exp_f32 v54,v54
v_mfma_f32_16x16x32_bf16 v[72:75],a[204:207],a[132:135],v[72:75]
v_exp_f32 v55,v55
v_mfma_f32_16x16x32_bf16 v[72:75],a[208:211],a[136:139],v[72:75]
v_cvt_pk_bf16_f32 v98,v36,v37
v_cvt_pk_bf16_f32 v99,v38,v39
v_mfma_f32_16x16x32_bf16 v[72:75],a[212:215],a[140:143],v[72:75]
v_cvt_pk_bf16_f32 v102,v44,v45
v_cvt_pk_bf16_f32 v103,v46,v47
v_mfma_f32_16x16x32_bf16 v[128:131],v[24:27],v[96:99],v[128:131]
v_cvt_pk_bf16_f32 v104,v48,v49
v_cvt_pk_bf16_f32 v105,v50,v51
v_mfma_f32_16x16x32_bf16 v[132:135],v[24:27],v[100:103],v[132:135]
v_cvt_pk_bf16_f32 v106,v52,v53
v_cvt_pk_bf16_f32 v107,v54,v55
v_mfma_f32_16x16x32_bf16 v[80:83],a[192:195],a[144:147],0
v_fma_f32 v64,v64,s36,v16
v_fma_f32 v65,v65,s36,v16
v_mfma_f32_16x16x32_bf16 v[136:139],v[24:27],v[104:107],v[136:139]
v_fma_f32 v66,v66,s36,v16
v_fma_f32 v67,v67,s36,v16
v_mfma_f32_16x16x32_bf16 v[80:83],a[196:199],a[148:151],v[80:83]
buffer_load_dwordx4 v9,s[12:15],s28 offen offset:256 nt lds
v_mfma_f32_16x16x32_bf16 v[80:83],a[200:203],a[152:155],v[80:83]
s_add_u32 s27,s27,3072
v_fma_f32 v72,v72,s36,v17
v_fma_f32 v73,v73,s36,v17
v_mfma_f32_16x16x32_bf16 v[80:83],a[204:207],a[156:159],v[80:83]
s_add_u32 s28,s28,3072
v_fma_f32 v74,v74,s36,v17
v_fma_f32 v75,v75,s36,v17
v_mfma_f32_16x16x32_bf16 v[80:83],a[208:211],a[160:163],v[80:83]
s_add_u32 s29,s29,3072
s_waitcnt vmcnt(12)
s_barrier
v_mfma_f32_16x16x32_bf16 v[80:83],a[212:215],a[164:167],v[80:83]
v_exp_f32 v64,v64
v_mfma_f32_16x16x32_bf16 v[68:71],a[216:219],a[96:99],0
v_exp_f32 v65,v65
v_mfma_f32_16x16x32_bf16 v[68:71],a[220:223],a[100:103],v[68:71]
v_exp_f32 v66,v66
v_mfma_f32_16x16x32_bf16 v[68:71],a[224:227],a[104:107],v[68:71]
v_exp_f32 v67,v67
v_mfma_f32_16x16x32_bf16 v[68:71],a[228:231],a[108:111],v[68:71]
v_exp_f32 v72,v72
v_mfma_f32_16x16x32_bf16 v[68:71],a[232:235],a[112:115],v[68:71]
v_exp_f32 v73,v73
v_mfma_f32_16x16x32_bf16 v[68:71],a[236:239],a[116:119],v[68:71]
ds_read_b64_tr_b16 a[240:241],v3 offset:0
ds_read_b64_tr_b16 a[242:243],v3 offset:6144
v_mfma_f32_16x16x32_bf16 v[76:79],a[216:219],a[120:123],0
v_exp_f32 v74,v74
v_mfma_f32_16x16x32_bf16 v[76:79],a[220:223],a[124:127],v[76:79]
ds_read_b64_tr_b16 a[244:245],v4 offset:0
ds_read_b64_tr_b16 a[246:247],v4 offset:6144
v_mfma_f32_16x16x32_bf16 v[76:79],a[224:227],a[128:131],v[76:79]
ds_read_b64_tr_b16 a[248:249],v5 offset:0
ds_read_b64_tr_b16 a[250:251],v5 offset:6144
v_mfma_f32_16x16x32_bf16 v[76:79],a[228:231],a[132:135],v[76:79]
v_exp_f32 v75,v75
v_mfma_f32_16x16x32_bf16 v[76:79],a[232:235],a[136:139],v[76:79]
ds_read_b64_tr_b16 a[252:253],v6 offset:0
ds_read_b64_tr_b16 a[254:255],v6 offset:6144
v_mfma_f32_16x16x32_bf16 v[76:79],a[236:239],a[140:143],v[76:79]
v_cvt_pk_bf16_f32 v112,v64,v65
v_cvt_pk_bf16_f32 v113,v66,v67
v_mfma_f32_16x16x32_bf16 v[84:87],a[216:219],a[144:147],0
v_cvt_pk_bf16_f32 v116,v72,v73
v_cvt_pk_bf16_f32 v117,v74,v75
v_mfma_f32_16x16x32_bf16 v[84:87],a[220:223],a[148:151],v[84:87]
v_mfma_f32_16x16x32_bf16 v[84:87],a[224:227],a[152:155],v[84:87]
v_mfma_f32_16x16x32_bf16 v[84:87],a[228:231],a[156:159],v[84:87]
v_mfma_f32_16x16x32_bf16 v[84:87],a[232:235],a[160:163],v[84:87]
v_mfma_f32_16x16x32_bf16 v[84:87],a[236:239],a[164:167],v[84:87]
s_waitcnt lgkmcnt(2)
v_mfma_f32_16x16x32_bf16 v[160:163],a[240:243],v[96:99],v[160:163]
s_add_u32 m0,s23,24576
ds_read_b128 a[192:195],v1 offset:24576
v_fma_f32 v78,v78,s36,v17
v_mfma_f32_16x16x32_bf16 v[208:211],a[240:243],v[100:103],v[208:211]
buffer_load_dwordx4 v7,s[8:11],s21 offen offset:0 lds
v_mfma_f32_16x16x32_bf16 a[0:3],a[240:243],v[104:107],a[0:3]
s_add_u32 m0,s23,25472
ds_read_b64_tr_b16 a[240:241],v3 offset:1024
ds_read_b64_tr_b16 a[242:243],v3 offset:7168
v_mfma_f32_16x16x32_bf16 v[164:167],a[244:247],v[96:99],v[164:167]
ds_read_b128 a[196:199],v2 offset:24576
v_fma_f32 v86,v86,s36,v18
v_mfma_f32_16x16x32_bf16 v[212:215],a[244:247],v[100:103],v[212:215]
ds_read_b128 a[200:203],v1 offset:25600
v_fma_f32 v85,v85,s36,v18
v_mfma_f32_16x16x32_bf16 a[4:7],a[244:247],v[104:107],a[4:7]
ds_read_b64_tr_b16 a[244:245],v4 offset:1024
ds_read_b64_tr_b16 a[246:247],v4 offset:7168
v_mfma_f32_16x16x32_bf16 v[168:171],a[248:251],v[96:99],v[168:171]
ds_read_b128 a[204:207],v2 offset:25600
v_fma_f32 v77,v77,s36,v17
v_mfma_f32_16x16x32_bf16 v[216:219],a[248:251],v[100:103],v[216:219]
buffer_load_dwordx4 v7,s[8:11],s21 offen offset:128 lds
v_mfma_f32_16x16x32_bf16 a[8:11],a[248:251],v[104:107],a[8:11]
s_add_u32 m0,s23,26368
ds_read_b64_tr_b16 a[248:249],v5 offset:1024
ds_read_b64_tr_b16 a[250:251],v5 offset:7168
s_waitcnt lgkmcnt(9)
v_mfma_f32_16x16x32_bf16 v[172:175],a[252:255],v[96:99],v[172:175]
ds_read_b128 a[208:211],v1 offset:26624
v_fma_f32 v83,v83,s36,v18
v_mfma_f32_16x16x32_bf16 v[220:223],a[252:255],v[100:103],v[220:223]
ds_read_b128 a[212:215],v2 offset:26624
v_fma_f32 v70,v70,s36,v16
v_mfma_f32_16x16x32_bf16 a[12:15],a[252:255],v[104:107],a[12:15]
s_waitcnt lgkmcnt(8)
ds_read_b64_tr_b16 a[252:253],v6 offset:1024
ds_read_b64_tr_b16 a[254:255],v6 offset:7168
v_mfma_f32_16x16x32_bf16 v[176:179],a[240:243],v[96:99],v[176:179]
buffer_load_dwordx4 v7,s[8:11],s21 offen offset:256 lds
v_mfma_f32_16x16x32_bf16 v[224:227],a[240:243],v[100:103],v[224:227]
s_add_u32 s21,s21,12288
ds_read_b128 a[216:219],v1 offset:30720
v_fma_f32 v76,v76,s36,v17
v_mfma_f32_16x16x32_bf16 a[16:19],a[240:243],v[104:107],a[16:19]
s_add_u32 m0,s25,0
ds_read_b64_tr_b16 a[242:243],v3 offset:8192
ds_read_b64_tr_b16 a[240:241],v3 offset:2048
s_waitcnt lgkmcnt(9)
v_mfma_f32_16x16x32_bf16 v[180:183],a[244:247],v[96:99],v[180:183]
ds_read_b128 a[220:223],v2 offset:30720
v_fma_f32 v82,v82,s36,v18
v_mfma_f32_16x16x32_bf16 v[228:231],a[244:247],v[100:103],v[228:231]
ds_read_b128 a[224:227],v1 offset:31744
v_fma_f32 v81,v81,s36,v18
v_mfma_f32_16x16x32_bf16 a[20:23],a[244:247],v[104:107],a[20:23]
s_waitcnt lgkmcnt(8)
ds_read_b64_tr_b16 a[246:247],v4 offset:8192
ds_read_b64_tr_b16 a[244:245],v4 offset:2048
v_mfma_f32_16x16x32_bf16 v[184:187],a[248:251],v[96:99],v[184:187]
buffer_load_dwordx4 v7,s[4:7],s20 offen offset:0 lds
v_mfma_f32_16x16x32_bf16 v[232:235],a[248:251],v[100:103],v[232:235]
s_add_u32 m0,s25,896
ds_read_b128 a[228:231],v2 offset:31744
v_fma_f32 v79,v79,s36,v17
v_mfma_f32_16x16x32_bf16 a[24:27],a[248:251],v[104:107],a[24:27]
s_waitcnt lgkmcnt(8)
ds_read_b64_tr_b16 a[248:249],v5 offset:2048
ds_read_b64_tr_b16 a[250:251],v5 offset:8192
v_mfma_f32_16x16x32_bf16 v[188:191],a[252:255],v[96:99],v[188:191]
ds_read_b128 a[232:235],v1 offset:32768
v_fma_f32 v71,v71,s36,v16
v_mfma_f32_16x16x32_bf16 v[236:239],a[252:255],v[100:103],v[236:239]
ds_read_b128 a[236:239],v2 offset:32768
v_fma_f32 v69,v69,s36,v16
v_mfma_f32_16x16x32_bf16 a[28:31],a[252:255],v[104:107],a[28:31]
s_waitcnt lgkmcnt(8)
ds_read_b64_tr_b16 a[254:255],v6 offset:8192
ds_read_b64_tr_b16 a[252:253],v6 offset:2048
v_mfma_f32_16x16x32_bf16 v[192:195],a[240:243],v[96:99],v[192:195]
buffer_load_dwordx4 v7,s[4:7],s20 offen offset:128 lds
v_mfma_f32_16x16x32_bf16 v[240:243],a[240:243],v[100:103],v[240:243]
s_add_u32 m0,s25,1792
ds_read_b128 v[156:159],v11 offset:6144
v_fma_f32 v87,v87,s36,v18
v_mfma_f32_16x16x32_bf16 a[32:35],a[240:243],v[104:107],a[32:35]
s_waitcnt lgkmcnt(8)
v_exp_f32 v76,v76
v_mfma_f32_16x16x32_bf16 v[196:199],a[244:247],v[96:99],v[196:199]
v_exp_f32 v87,v87
v_mfma_f32_16x16x32_bf16 v[244:247],a[244:247],v[100:103],v[244:247]
v_exp_f32 v70,v70
v_mfma_f32_16x16x32_bf16 a[36:39],a[244:247],v[104:107],a[36:39]
s_waitcnt lgkmcnt(4)
v_exp_f32 v83,v83
v_mfma_f32_16x16x32_bf16 v[200:203],a[248:251],v[96:99],v[200:203]
buffer_load_dwordx4 v7,s[4:7],s20 offen offset:256 lds
v_mfma_f32_16x16x32_bf16 v[248:251],a[248:251],v[100:103],v[248:251]
s_add_u32 s20,s20,12288
v_exp_f32 v69,v69
v_mfma_f32_16x16x32_bf16 a[40:43],a[248:251],v[104:107],a[40:43]
s_waitcnt lgkmcnt(1)
v_exp_f32 v79,v79
v_mfma_f32_16x16x32_bf16 v[204:207],a[252:255],v[96:99],v[204:207]
v_exp_f32 v81,v81
v_mfma_f32_16x16x32_bf16 v[252:255],a[252:255],v[100:103],v[252:255]
v_exp_f32 v85,v85
v_mfma_f32_16x16x32_bf16 a[44:47],a[252:255],v[104:107],a[44:47]
v_exp_f32 v71,v71
v_mfma_f32_16x16x32_bf16 v[32:35],a[192:195],a[96:99],0
ds_read_b128 v[152:155],v11 offset:7168
v_fma_f32 v80,v80,s36,v18
v_mfma_f32_16x16x32_bf16 v[32:35],a[196:199],a[100:103],v[32:35]
v_exp_f32 v78,v78
v_mfma_f32_16x16x32_bf16 v[32:35],a[200:203],a[104:107],v[32:35]
v_exp_f32 v86,v86
v_mfma_f32_16x16x32_bf16 v[32:35],a[204:207],a[108:111],v[32:35]
s_waitcnt lgkmcnt(1)
buffer_store_dwordx4 v[156:159],v10,s[16:19],s27 offen offset:0 nt
v_mfma_f32_16x16x32_bf16 v[32:35],a[208:211],a[112:115],v[32:35]
s_add_u32 m0,s29,0
v_exp_f32 v77,v77
v_mfma_f32_16x16x32_bf16 v[32:35],a[212:215],a[116:119],v[32:35]
v_exp_f32 v82,v82
v_mfma_f32_16x16x32_bf16 v[40:43],a[192:195],a[120:123],0
v_exp_f32 v80,v80
v_mfma_f32_16x16x32_bf16 v[40:43],a[196:199],a[124:127],v[40:43]
v_cvt_pk_bf16_f32 v120,v80,v81
v_cvt_pk_bf16_f32 v123,v86,v87
v_mfma_f32_16x16x32_bf16 v[40:43],a[200:203],a[128:131],v[40:43]
v_fma_f32 v84,v84,s36,v18
v_fma_f32 v68,v68,s36,v16
v_mfma_f32_16x16x32_bf16 v[40:43],a[204:207],a[132:135],v[40:43]
v_exp_f32 v84,v84
v_mfma_f32_16x16x32_bf16 v[40:43],a[208:211],a[136:139],v[40:43]
buffer_load_dwordx4 v8,s[12:15],s28 offen offset:0 nt lds
v_mfma_f32_16x16x32_bf16 v[40:43],a[212:215],a[140:143],v[40:43]
v_exp_f32 v68,v68
v_mfma_f32_16x16x32_bf16 v[48:51],a[192:195],a[144:147],0
v_cvt_pk_bf16_f32 v121,v82,v83
v_cvt_pk_bf16_f32 v122,v84,v85
v_mfma_f32_16x16x32_bf16 v[48:51],a[196:199],a[148:151],v[48:51]
v_cvt_pk_bf16_f32 v115,v70,v71
v_fma_f32 v35,v35,s36,v16
v_mfma_f32_16x16x32_bf16 v[136:139],v[24:27],v[120:123],v[136:139]
v_exp_f32 v35,v35
v_mfma_f32_16x16x32_bf16 v[48:51],a[200:203],a[152:155],v[48:51]
v_fma_f32 v41,v41,s36,v17
v_fma_f32 v33,v33,s36,v16
v_mfma_f32_16x16x32_bf16 v[48:51],a[204:207],a[156:159],v[48:51]
s_waitcnt lgkmcnt(0)
buffer_store_dwordx4 v[152:155],v10,s[16:19],s27 offen offset:128 nt
v_mfma_f32_16x16x32_bf16 v[48:51],a[208:211],a[160:163],v[48:51]
s_add_u32 m0,s29,896
v_exp_f32 v41,v41
v_mfma_f32_16x16x32_bf16 v[48:51],a[212:215],a[164:167],v[48:51]
v_exp_f32 v33,v33
s_waitcnt vmcnt(11)
s_barrier
v_mfma_f32_16x16x32_bf16 v[36:39],a[216:219],a[96:99],0
v_cvt_pk_bf16_f32 v118,v76,v77
v_fma_f32 v34,v34,s36,v16
v_mfma_f32_16x16x32_bf16 v[36:39],a[220:223],a[100:103],v[36:39]
v_exp_f32 v34,v34
v_mfma_f32_16x16x32_bf16 v[36:39],a[224:227],a[104:107],v[36:39]
buffer_load_dwordx4 v8,s[12:15],s28 offen offset:128 nt lds
v_mfma_f32_16x16x32_bf16 v[36:39],a[228:231],a[108:111],v[36:39]
v_fma_f32 v42,v42,s36,v17
v_fma_f32 v40,v40,s36,v17
v_mfma_f32_16x16x32_bf16 v[36:39],a[232:235],a[112:115],v[36:39]
v_exp_f32 v40,v40
v_mfma_f32_16x16x32_bf16 v[36:39],a[236:239],a[116:119],v[36:39]
v_exp_f32 v42,v42
v_mfma_f32_16x16x32_bf16 v[44:47],a[216:219],a[120:123],0
ds_read_b64_tr_b16 a[240:241],v3 offset:12288
ds_read_b64_tr_b16 a[242:243],v3 offset:18432
v_mfma_f32_16x16x32_bf16 v[44:47],a[220:223],a[124:127],v[44:47]
ds_read_b64_tr_b16 a[244:245],v4 offset:12288
v_mfma_f32_16x16x32_bf16 v[44:47],a[224:227],a[128:131],v[44:47]
ds_read_b64_tr_b16 a[246:247],v4 offset:18432
v_cvt_pk_bf16_f32 v114,v68,v69
v_mfma_f32_16x16x32_bf16 v[44:47],a[228:231],a[132:135],v[44:47]
ds_read_b64_tr_b16 a[248:249],v5 offset:12288
ds_read_b64_tr_b16 a[250:251],v5 offset:18432
v_mfma_f32_16x16x32_bf16 v[128:131],v[24:27],v[112:115],v[128:131]
ds_read_b64_tr_b16 a[252:253],v6 offset:12288
v_mfma_f32_16x16x32_bf16 v[44:47],a[232:235],a[136:139],v[44:47]
ds_read_b64_tr_b16 a[254:255],v6 offset:18432
v_fma_f32 v32,v32,s36,v16
v_mfma_f32_16x16x32_bf16 v[44:47],a[236:239],a[140:143],v[44:47]
v_exp_f32 v32,v32
v_mfma_f32_16x16x32_bf16 v[52:55],a[216:219],a[144:147],0
v_cvt_pk_bf16_f32 v119,v78,v79
v_fma_f32 v43,v43,s36,v17
v_mfma_f32_16x16x32_bf16 v[52:55],a[220:223],a[148:151],v[52:55]
v_exp_f32 v43,v43
v_mfma_f32_16x16x32_bf16 v[132:135],v[24:27],v[116:119],v[132:135]
v_cvt_pk_bf16_f32 v101,v42,v43
v_cvt_pk_bf16_f32 v97,v34,v35
v_mfma_f32_16x16x32_bf16 v[52:55],a[224:227],a[152:155],v[52:55]
v_cvt_pk_bf16_f32 v100,v40,v41
v_cvt_pk_bf16_f32 v96,v32,v33
v_mfma_f32_16x16x32_bf16 v[52:55],a[228:231],a[156:159],v[52:55]
v_mfma_f32_16x16x32_bf16 v[52:55],a[232:235],a[160:163],v[52:55]
v_mfma_f32_16x16x32_bf16 v[52:55],a[236:239],a[164:167],v[52:55]
s_waitcnt lgkmcnt(1)
v_mfma_f32_16x16x32_bf16 v[160:163],a[240:243],v[112:115],v[160:163]
s_add_u32 m0,s23,0
ds_read_b128 a[192:195],v1 offset:0
v_fma_f32 v36,v36,s36,v16
v_mfma_f32_16x16x32_bf16 v[208:211],a[240:243],v[116:119],v[208:211]
buffer_load_dwordx4 v7,s[8:11],s21 offen offset:0 lds
v_mfma_f32_16x16x32_bf16 a[0:3],a[240:243],v[120:123],a[0:3]
s_add_u32 m0,s23,896
ds_read_b64_tr_b16 a[240:241],v3 offset:13312
ds_read_b64_tr_b16 a[242:243],v3 offset:19456
v_mfma_f32_16x16x32_bf16 v[164:167],a[244:247],v[112:115],v[164:167]
ds_read_b128 a[196:199],v2 offset:0
v_fma_f32 v37,v37,s36,v16
v_mfma_f32_16x16x32_bf16 v[212:215],a[244:247],v[116:119],v[212:215]
ds_read_b128 a[200:203],v1 offset:1024
v_fma_f32 v38,v38,s36,v16
v_mfma_f32_16x16x32_bf16 a[4:7],a[244:247],v[120:123],a[4:7]
ds_read_b64_tr_b16 a[244:245],v4 offset:13312
ds_read_b64_tr_b16 a[246:247],v4 offset:19456
v_mfma_f32_16x16x32_bf16 v[168:171],a[248:251],v[112:115],v[168:171]
ds_read_b128 a[204:207],v2 offset:1024
v_fma_f32 v39,v39,s36,v16
v_mfma_f32_16x16x32_bf16 v[216:219],a[248:251],v[116:119],v[216:219]
buffer_load_dwordx4 v7,s[8:11],s21 offen offset:128 lds
v_mfma_f32_16x16x32_bf16 a[8:11],a[248:251],v[120:123],a[8:11]
s_add_u32 m0,s23,1792
ds_read_b64_tr_b16 a[248:249],v5 offset:13312
ds_read_b64_tr_b16 a[250:251],v5 offset:19456
s_waitcnt lgkmcnt(9)
v_mfma_f32_16x16x32_bf16 v[172:175],a[252:255],v[112:115],v[172:175]
ds_read_b128 a[208:211],v1 offset:2048
v_fma_f32 v44,v44,s36,v17
v_mfma_f32_16x16x32_bf16 v[220:223],a[252:255],v[116:119],v[220:223]
ds_read_b128 a[212:215],v2 offset:2048
v_fma_f32 v45,v45,s36,v17
v_mfma_f32_16x16x32_bf16 a[12:15],a[252:255],v[120:123],a[12:15]
s_waitcnt lgkmcnt(8)
ds_read_b64_tr_b16 a[252:253],v6 offset:13312
ds_read_b64_tr_b16 a[254:255],v6 offset:19456
v_mfma_f32_16x16x32_bf16 v[176:179],a[240:243],v[112:115],v[176:179]
buffer_load_dwordx4 v7,s[8:11],s21 offen offset:256 lds
v_mfma_f32_16x16x32_bf16 v[224:227],a[240:243],v[116:119],v[224:227]
s_add_u32 s21,s21,12288
ds_read_b128 a[216:219],v1 offset:6144
v_fma_f32 v46,v46,s36,v17
v_mfma_f32_16x16x32_bf16 a[16:19],a[240:243],v[120:123],a[16:19]
s_add_u32 m0,s26,0
ds_read_b64_tr_b16 a[240:241],v3 offset:14336
ds_read_b64_tr_b16 a[242:243],v3 offset:20480
s_waitcnt lgkmcnt(9)
v_mfma_f32_16x16x32_bf16 v[180:183],a[244:247],v[112:115],v[180:183]
ds_read_b128 a[220:223],v2 offset:6144
v_fma_f32 v47,v47,s36,v17
v_mfma_f32_16x16x32_bf16 v[228:231],a[244:247],v[116:119],v[228:231]
ds_read_b128 a[224:227],v1 offset:7168
v_fma_f32 v48,v48,s36,v18
v_mfma_f32_16x16x32_bf16 a[20:23],a[244:247],v[120:123],a[20:23]
s_waitcnt lgkmcnt(8)
ds_read_b64_tr_b16 a[244:245],v4 offset:14336
ds_read_b64_tr_b16 a[246:247],v4 offset:20480
v_mfma_f32_16x16x32_bf16 v[184:187],a[248:251],v[112:115],v[184:187]
buffer_load_dwordx4 v7,s[4:7],s20 offen offset:0 lds
v_mfma_f32_16x16x32_bf16 v[232:235],a[248:251],v[116:119],v[232:235]
s_add_u32 m0,s26,896
ds_read_b128 a[228:231],v2 offset:7168
v_fma_f32 v49,v49,s36,v18
v_mfma_f32_16x16x32_bf16 a[24:27],a[248:251],v[120:123],a[24:27]
s_waitcnt lgkmcnt(8)
ds_read_b64_tr_b16 a[248:249],v5 offset:14336
ds_read_b64_tr_b16 a[250:251],v5 offset:20480
v_mfma_f32_16x16x32_bf16 v[188:191],a[252:255],v[112:115],v[188:191]
ds_read_b128 a[232:235],v1 offset:8192
v_fma_f32 v50,v50,s36,v18
v_mfma_f32_16x16x32_bf16 v[236:239],a[252:255],v[116:119],v[236:239]
ds_read_b128 a[236:239],v2 offset:8192
v_fma_f32 v51,v51,s36,v18
v_mfma_f32_16x16x32_bf16 a[28:31],a[252:255],v[120:123],a[28:31]
s_waitcnt lgkmcnt(8)
ds_read_b64_tr_b16 a[252:253],v6 offset:14336
ds_read_b64_tr_b16 a[254:255],v6 offset:20480
v_mfma_f32_16x16x32_bf16 v[192:195],a[240:243],v[112:115],v[192:195]
buffer_load_dwordx4 v7,s[4:7],s20 offen offset:128 lds
v_mfma_f32_16x16x32_bf16 v[240:243],a[240:243],v[116:119],v[240:243]
s_add_u32 m0,s26,1792
ds_read_b128 v[156:159],v11 offset:8192
v_fma_f32 v52,v52,s36,v18
v_mfma_f32_16x16x32_bf16 a[32:35],a[240:243],v[120:123],a[32:35]
s_waitcnt lgkmcnt(8)
v_fma_f32 v53,v53,s36,v18
v_fma_f32 v54,v54,s36,v18
v_mfma_f32_16x16x32_bf16 v[196:199],a[244:247],v[112:115],v[196:199]
v_fma_f32 v55,v55,s36,v18
v_add_u32 v11,9216,v11
v_mfma_f32_16x16x32_bf16 v[244:247],a[244:247],v[116:119],v[244:247]
v_exp_f32 v36,v36
v_mfma_f32_16x16x32_bf16 a[36:39],a[244:247],v[120:123],a[36:39]
s_waitcnt lgkmcnt(4)
v_exp_f32 v37,v37
v_mfma_f32_16x16x32_bf16 v[200:203],a[248:251],v[112:115],v[200:203]
buffer_load_dwordx4 v7,s[4:7],s20 offen offset:256 lds
v_mfma_f32_16x16x32_bf16 v[248:251],a[248:251],v[116:119],v[248:251]
s_add_u32 s20,s20,12288
v_exp_f32 v38,v38
v_mfma_f32_16x16x32_bf16 a[40:43],a[248:251],v[120:123],a[40:43]
s_waitcnt lgkmcnt(1)
v_exp_f32 v39,v39
v_mfma_f32_16x16x32_bf16 v[204:207],a[252:255],v[112:115],v[204:207]
v_exp_f32 v44,v44
v_mfma_f32_16x16x32_bf16 v[252:255],a[252:255],v[116:119],v[252:255]
v_exp_f32 v45,v45
v_mfma_f32_16x16x32_bf16 a[44:47],a[252:255],v[120:123],a[44:47]
v_exp_f32 v46,v46
v_mfma_f32_16x16x32_bf16 v[64:67],a[192:195],a[96:99],0
v_exp_f32 v47,v47
v_mfma_f32_16x16x32_bf16 v[64:67],a[196:199],a[100:103],v[64:67]
v_exp_f32 v48,v48
v_mfma_f32_16x16x32_bf16 v[64:67],a[200:203],a[104:107],v[64:67]
v_exp_f32 v49,v49
v_mfma_f32_16x16x32_bf16 v[64:67],a[204:207],a[108:111],v[64:67]
s_waitcnt lgkmcnt(0)
buffer_store_dwordx4 v[156:159],v10,s[16:19],s27 offen offset:256 nt
v_mfma_f32_16x16x32_bf16 v[64:67],a[208:211],a[112:115],v[64:67]
s_add_u32 m0,s29,1792
v_exp_f32 v50,v50
v_mfma_f32_16x16x32_bf16 v[64:67],a[212:215],a[116:119],v[64:67]
v_exp_f32 v51,v51
v_mfma_f32_16x16x32_bf16 v[72:75],a[192:195],a[120:123],0
v_exp_f32 v52,v52
v_mfma_f32_16x16x32_bf16 v[72:75],a[196:199],a[124:127],v[72:75]
v_exp_f32 v53,v53
v_mfma_f32_16x16x32_bf16 v[72:75],a[200:203],a[128:131],v[72:75]
v_exp_f32 v54,v54
v_mfma_f32_16x16x32_bf16 v[72:75],a[204:207],a[132:135],v[72:75]
v_exp_f32 v55,v55
v_mfma_f32_16x16x32_bf16 v[72:75],a[208:211],a[136:139],v[72:75]
v_cvt_pk_bf16_f32 v98,v36,v37
v_cvt_pk_bf16_f32 v99,v38,v39
v_mfma_f32_16x16x32_bf16 v[72:75],a[212:215],a[140:143],v[72:75]
v_cvt_pk_bf16_f32 v102,v44,v45
v_cvt_pk_bf16_f32 v103,v46,v47
v_mfma_f32_16x16x32_bf16 v[128:131],v[24:27],v[96:99],v[128:131]
v_cvt_pk_bf16_f32 v104,v48,v49
v_cvt_pk_bf16_f32 v105,v50,v51
v_mfma_f32_16x16x32_bf16 v[132:135],v[24:27],v[100:103],v[132:135]
v_cvt_pk_bf16_f32 v106,v52,v53
v_cvt_pk_bf16_f32 v107,v54,v55
v_mfma_f32_16x16x32_bf16 v[80:83],a[192:195],a[144:147],0
v_fma_f32 v64,v64,s36,v16
v_fma_f32 v65,v65,s36,v16
v_mfma_f32_16x16x32_bf16 v[136:139],v[24:27],v[104:107],v[136:139]
v_fma_f32 v66,v66,s36,v16
v_fma_f32 v67,v67,s36,v16
v_mfma_f32_16x16x32_bf16 v[80:83],a[196:199],a[148:151],v[80:83]
buffer_load_dwordx4 v8,s[12:15],s28 offen offset:256 nt lds
v_mfma_f32_16x16x32_bf16 v[80:83],a[200:203],a[152:155],v[80:83]
s_add_u32 s27,s27,3072
v_fma_f32 v72,v72,s36,v17
v_fma_f32 v73,v73,s36,v17
v_mfma_f32_16x16x32_bf16 v[80:83],a[204:207],a[156:159],v[80:83]
s_add_u32 s28,s28,3072
v_fma_f32 v74,v74,s36,v17
v_fma_f32 v75,v75,s36,v17
v_mfma_f32_16x16x32_bf16 v[80:83],a[208:211],a[160:163],v[80:83]
s_add_u32 s29,s29,3072
s_waitcnt vmcnt(12)
s_barrier
s_add_u32 s25,s24,18432
s_add_u32 s26,s22,12288
s_add_u32 s38,s38,1
s_cmp_lt_u32 s38,2
v_mfma_f32_16x16x32_bf16 v[80:83],a[212:215],a[164:167],v[80:83]
v_exp_f32 v64,v64
v_mfma_f32_16x16x32_bf16 v[68:71],a[216:219],a[96:99],0
v_exp_f32 v65,v65
v_mfma_f32_16x16x32_bf16 v[68:71],a[220:223],a[100:103],v[68:71]
v_exp_f32 v66,v66
v_mfma_f32_16x16x32_bf16 v[68:71],a[224:227],a[104:107],v[68:71]
v_exp_f32 v67,v67
v_mfma_f32_16x16x32_bf16 v[68:71],a[228:231],a[108:111],v[68:71]
v_exp_f32 v72,v72
v_mfma_f32_16x16x32_bf16 v[68:71],a[232:235],a[112:115],v[68:71]
ds_read_b64_tr_b16 a[240:241],v3 offset:24576
ds_read_b64_tr_b16 a[242:243],v3 offset:30720
v_mfma_f32_16x16x32_bf16 v[68:71],a[236:239],a[116:119],v[68:71]
v_exp_f32 v73,v73
v_mfma_f32_16x16x32_bf16 v[76:79],a[216:219],a[120:123],0
ds_read_b64_tr_b16 a[244:245],v4 offset:24576
ds_read_b64_tr_b16 a[246:247],v4 offset:30720
v_mfma_f32_16x16x32_bf16 v[76:79],a[220:223],a[124:127],v[76:79]
ds_read_b64_tr_b16 a[248:249],v5 offset:24576
ds_read_b64_tr_b16 a[250:251],v5 offset:30720
v_mfma_f32_16x16x32_bf16 v[76:79],a[224:227],a[128:131],v[76:79]
v_exp_f32 v74,v74
v_mfma_f32_16x16x32_bf16 v[76:79],a[228:231],a[132:135],v[76:79]
ds_read_b64_tr_b16 a[252:253],v6 offset:24576
ds_read_b64_tr_b16 a[254:255],v6 offset:30720
v_mfma_f32_16x16x32_bf16 v[76:79],a[232:235],a[136:139],v[76:79]
v_exp_f32 v75,v75
v_mfma_f32_16x16x32_bf16 v[76:79],a[236:239],a[140:143],v[76:79]
v_cvt_pk_bf16_f32 v112,v64,v65
v_cvt_pk_bf16_f32 v113,v66,v67
v_mfma_f32_16x16x32_bf16 v[84:87],a[216:219],a[144:147],0
v_cvt_pk_bf16_f32 v116,v72,v73
v_cvt_pk_bf16_f32 v117,v74,v75
v_mfma_f32_16x16x32_bf16 v[84:87],a[220:223],a[148:151],v[84:87]
v_xor_b32 v8,80,v8
v_xor_b32 v9,80,v9
v_mfma_f32_16x16x32_bf16 v[84:87],a[224:227],a[152:155],v[84:87]
v_mfma_f32_16x16x32_bf16 v[84:87],a[228:231],a[156:159],v[84:87]
v_mfma_f32_16x16x32_bf16 v[84:87],a[232:235],a[160:163],v[84:87]
v_mfma_f32_16x16x32_bf16 v[84:87],a[236:239],a[164:167],v[84:87]
s_cbranch_scc1 L_loop3w1
s_cmp_ge_u32 s69,8
s_cbranch_scc1 L_end3
s_cmp_eq_u32 s40,0
s_cbranch_scc1 L_tr33
s_branch L_tr34
L_tr34:
s_waitcnt vmcnt(36)
s_waitcnt lgkmcnt(4)
v_mfma_f32_16x16x32_bf16 v[160:163],a[240:243],v[96:99],v[160:163]
s_add_u32 m0,s24,0
ds_read_b128 a[96:99],v28 offset:0
v_fma_f32 v68,v68,s36,v16
v_mfma_f32_16x16x32_bf16 v[208:211],a[240:243],v[100:103],v[208:211]
ds_read_b128 a[100:103],v29 offset:0
v_fma_f32 v69,v69,s36,v16
v_mfma_f32_16x16x32_bf16 a[0:3],a[240:243],v[104:107],a[0:3]
ds_read_b128 a[104:107],v28 offset:1024
v_fma_f32 v70,v70,s36,v16
v_mfma_f32_16x16x32_bf16 v[164:167],a[244:247],v[96:99],v[164:167]
ds_read_b128 a[108:111],v29 offset:1024
v_fma_f32 v71,v71,s36,v16
v_mfma_f32_16x16x32_bf16 v[212:215],a[244:247],v[100:103],v[212:215]
ds_read_b128 a[112:115],v28 offset:2048
v_fma_f32 v76,v76,s36,v17
v_mfma_f32_16x16x32_bf16 a[4:7],a[244:247],v[104:107],a[4:7]
s_waitcnt lgkmcnt(5)
ds_read_b128 a[116:119],v29 offset:2048
v_fma_f32 v77,v77,s36,v17
v_mfma_f32_16x16x32_bf16 v[168:171],a[248:251],v[96:99],v[168:171]
ds_read_b64_tr_b16 a[240:241],v3 offset:25600
ds_read_b64_tr_b16 a[242:243],v3 offset:31744
v_mfma_f32_16x16x32_bf16 v[216:219],a[248:251],v[100:103],v[216:219]
ds_read_b64_tr_b16 a[244:245],v4 offset:25600
ds_read_b64_tr_b16 a[246:247],v4 offset:31744
v_mfma_f32_16x16x32_bf16 a[8:11],a[248:251],v[104:107],a[8:11]
ds_read_b64_tr_b16 a[248:249],v5 offset:25600
ds_read_b64_tr_b16 a[250:251],v5 offset:31744
v_mfma_f32_16x16x32_bf16 v[172:175],a[252:255],v[96:99],v[172:175]
ds_read_b128 a[192:195],v13 offset:0
v_fma_f32 v78,v78,s36,v17
v_mfma_f32_16x16x32_bf16 v[220:223],a[252:255],v[100:103],v[220:223]
ds_read_b128 a[196:199],v14 offset:0
v_fma_f32 v79,v79,s36,v17
v_mfma_f32_16x16x32_bf16 a[12:15],a[252:255],v[104:107],a[12:15]
ds_read_b64_tr_b16 a[252:253],v6 offset:25600
ds_read_b64_tr_b16 a[254:255],v6 offset:31744
ds_read_b128 a[200:203],v13 offset:1024
v_fma_f32 v80,v80,s36,v18
v_fma_f32 v81,v81,s36,v18
v_fma_f32 v82,v82,s36,v18
v_fma_f32 v83,v83,s36,v18
v_fma_f32 v84,v84,s36,v18
v_fma_f32 v85,v85,s36,v18
v_fma_f32 v86,v86,s36,v18
v_fma_f32 v87,v87,s36,v18
v_exp_f32 v68,v68
v_exp_f32 v69,v69
v_exp_f32 v70,v70
s_waitcnt lgkmcnt(9)
v_mfma_f32_16x16x32_bf16 v[176:179],a[240:243],v[96:99],v[176:179]
buffer_load_dwordx4 v8,s[12:15],s28 offen offset:0 nt lds
s_add_u32 m0,s24,896
v_mfma_f32_16x16x32_bf16 v[224:227],a[240:243],v[100:103],v[224:227]
ds_read_b128 a[204:207],v14 offset:1024
v_exp_f32 v71,v71
v_mfma_f32_16x16x32_bf16 a[16:19],a[240:243],v[104:107],a[16:19]
s_waitcnt lgkmcnt(4)
ds_read_b64_tr_b16 a[240:241],v3 offset:26624
ds_read_b64_tr_b16 a[242:243],v3 offset:32768
v_mfma_f32_16x16x32_bf16 v[180:183],a[244:247],v[96:99],v[180:183]
ds_read_b128 a[208:211],v13 offset:2048
v_exp_f32 v76,v76
v_mfma_f32_16x16x32_bf16 v[228:231],a[244:247],v[100:103],v[228:231]
ds_read_b128 a[212:215],v14 offset:2048
v_exp_f32 v77,v77
v_mfma_f32_16x16x32_bf16 a[20:23],a[244:247],v[104:107],a[20:23]
buffer_load_dwordx4 v8,s[12:15],s28 offen offset:128 nt lds
s_add_u32 m0,s24,1792
v_mfma_f32_16x16x32_bf16 v[184:187],a[248:251],v[96:99],v[184:187]
ds_read_b64_tr_b16 a[244:245],v4 offset:26624
ds_read_b64_tr_b16 a[246:247],v4 offset:32768
v_mfma_f32_16x16x32_bf16 v[232:235],a[248:251],v[100:103],v[232:235]
ds_read_b128 a[216:219],v13 offset:45056
v_exp_f32 v78,v78
v_mfma_f32_16x16x32_bf16 a[24:27],a[248:251],v[104:107],a[24:27]
s_waitcnt lgkmcnt(7)
ds_read_b64_tr_b16 a[248:249],v5 offset:26624
ds_read_b64_tr_b16 a[250:251],v5 offset:32768
v_mfma_f32_16x16x32_bf16 v[188:191],a[252:255],v[96:99],v[188:191]
ds_read_b128 a[220:223],v14 offset:45056
v_exp_f32 v79,v79
v_mfma_f32_16x16x32_bf16 v[236:239],a[252:255],v[100:103],v[236:239]
ds_read_b128 a[224:227],v13 offset:46080
v_exp_f32 v80,v80
v_mfma_f32_16x16x32_bf16 a[28:31],a[252:255],v[104:107],a[28:31]
s_waitcnt lgkmcnt(7)
ds_read_b64_tr_b16 a[252:253],v6 offset:26624
ds_read_b64_tr_b16 a[254:255],v6 offset:32768
v_mfma_f32_16x16x32_bf16 v[192:195],a[240:243],v[96:99],v[192:195]
ds_read_b128 a[228:231],v14 offset:46080
v_exp_f32 v81,v81
v_mfma_f32_16x16x32_bf16 v[240:243],a[240:243],v[100:103],v[240:243]
buffer_load_dwordx4 v8,s[12:15],s28 offen offset:256 nt lds
s_add_u32 s28,s28,3072
s_add_u32 m0,s24,3072
v_mfma_f32_16x16x32_bf16 a[32:35],a[240:243],v[104:107],a[32:35]
s_waitcnt lgkmcnt(7)
ds_read_b128 a[232:235],v13 offset:47104
v_exp_f32 v82,v82
v_mfma_f32_16x16x32_bf16 v[196:199],a[244:247],v[96:99],v[196:199]
ds_read_b128 a[236:239],v14 offset:47104
v_exp_f32 v83,v83
v_mfma_f32_16x16x32_bf16 v[244:247],a[244:247],v[100:103],v[244:247]
ds_read_b128 a[120:123],v28 offset:6144
v_exp_f32 v84,v84
v_mfma_f32_16x16x32_bf16 a[36:39],a[244:247],v[104:107],a[36:39]
s_waitcnt lgkmcnt(6)
ds_read_b128 a[124:127],v29 offset:6144
v_exp_f32 v85,v85
v_mfma_f32_16x16x32_bf16 v[200:203],a[248:251],v[96:99],v[200:203]
ds_read_b128 a[128:131],v28 offset:7168
v_exp_f32 v86,v86
v_mfma_f32_16x16x32_bf16 v[248:251],a[248:251],v[100:103],v[248:251]
ds_read_b128 a[132:135],v29 offset:7168
v_exp_f32 v87,v87
v_mfma_f32_16x16x32_bf16 a[40:43],a[248:251],v[104:107],a[40:43]
ds_read_b128 a[136:139],v28 offset:8192
buffer_load_dwordx4 v9,s[12:15],s28 offen offset:0 nt lds
s_add_u32 m0,s24,3968
s_waitcnt lgkmcnt(7)
v_mfma_f32_16x16x32_bf16 v[204:207],a[252:255],v[96:99],v[204:207]
ds_read_b128 a[140:143],v29 offset:8192
v_cvt_pk_bf16_f32 v114,v68,v69
v_mfma_f32_16x16x32_bf16 v[252:255],a[252:255],v[100:103],v[252:255]
v_cvt_pk_bf16_f32 v115,v70,v71
v_cvt_pk_bf16_f32 v118,v76,v77
v_mfma_f32_16x16x32_bf16 a[44:47],a[252:255],v[104:107],a[44:47]
v_cvt_pk_bf16_f32 v119,v78,v79
v_cvt_pk_bf16_f32 v120,v80,v81
v_mfma_f32_16x16x32_bf16 v[128:131],v[24:27],v[112:115],v[128:131]
v_cvt_pk_bf16_f32 v121,v82,v83
v_cvt_pk_bf16_f32 v122,v84,v85
v_mfma_f32_16x16x32_bf16 v[132:135],v[24:27],v[116:119],v[132:135]
v_cvt_pk_bf16_f32 v123,v86,v87
buffer_load_dwordx4 v9,s[12:15],s28 offen offset:128 nt lds
s_add_u32 m0,s24,4864
v_mfma_f32_16x16x32_bf16 v[136:139],v[24:27],v[120:123],v[136:139]
buffer_load_dwordx4 v9,s[12:15],s28 offen offset:256 nt lds
s_waitcnt vmcnt(11)
s_waitcnt lgkmcnt(2)
s_barrier
ds_read_b64_tr_b16 a[240:241],v3 offset:0
ds_read_b64_tr_b16 a[242:243],v3 offset:6144
ds_read_b64_tr_b16 a[244:245],v4 offset:0
s_add_u32 s28,s28,3072
ds_read_b64_tr_b16 a[246:247],v4 offset:6144
ds_read_b64_tr_b16 a[248:249],v5 offset:0
ds_read_b64_tr_b16 a[250:251],v5 offset:6144
ds_read_b64_tr_b16 a[252:253],v6 offset:0
ds_read_b64_tr_b16 a[254:255],v6 offset:6144
s_waitcnt lgkmcnt(6)
v_mfma_f32_16x16x32_bf16 v[160:163],a[240:243],v[112:115],v[160:163]
v_rcp_f32 v146,v132
v_mfma_f32_16x16x32_bf16 v[208:211],a[240:243],v[116:119],v[208:211]
v_rcp_f32 v148,v136
v_mfma_f32_16x16x32_bf16 a[0:3],a[240:243],v[120:123],a[0:3]
s_waitcnt lgkmcnt(4)
ds_read_b64_tr_b16 a[240:241],v3 offset:1024
ds_read_b64_tr_b16 a[242:243],v3 offset:7168
v_mfma_f32_16x16x32_bf16 v[164:167],a[244:247],v[112:115],v[164:167]
v_rcp_f32 v144,v128
v_mfma_f32_16x16x32_bf16 v[212:215],a[244:247],v[116:119],v[212:215]
v_max3_f32 v30,v128,v132,v136
v_cmp_nlt_f32 vcc,v30,v31
v_mfma_f32_16x16x32_bf16 a[4:7],a[244:247],v[120:123],a[4:7]
s_waitcnt lgkmcnt(4)
ds_read_b64_tr_b16 a[244:245],v4 offset:1024
ds_read_b64_tr_b16 a[246:247],v4 offset:7168
v_mfma_f32_16x16x32_bf16 v[168:171],a[248:251],v[112:115],v[168:171]
s_cmp_lg_u64 vcc,0
v_accvgpr_read_b32 v64,a0
v_accvgpr_read_b32 v65,a1
v_mfma_f32_16x16x32_bf16 v[216:219],a[248:251],v[116:119],v[216:219]
s_cselect_b32 s62,s32,0
v_accvgpr_read_b32 v66,a2
v_accvgpr_read_b32 v67,a3
v_mfma_f32_16x16x32_bf16 a[8:11],a[248:251],v[120:123],a[8:11]
s_or_b32 s31,s31,s62
ds_read_b64_tr_b16 a[248:249],v5 offset:1024
ds_read_b64_tr_b16 a[250:251],v5 offset:7168
s_waitcnt lgkmcnt(6)
v_mfma_f32_16x16x32_bf16 v[172:175],a[252:255],v[112:115],v[172:175]
s_lshl_b32 s32,s32,1
v_accvgpr_read_b32 v68,a4
v_accvgpr_read_b32 v69,a5
v_mfma_f32_16x16x32_bf16 v[220:223],a[252:255],v[116:119],v[220:223]
s_add_u32 m0,s22,24576
v_accvgpr_read_b32 v70,a6
v_accvgpr_read_b32 v71,a7
v_mfma_f32_16x16x32_bf16 a[12:15],a[252:255],v[120:123],a[12:15]
buffer_load_dwordx4 v7,s[4:7],s20 offen offset:0 lds
s_add_u32 m0,s22,25472
s_waitcnt lgkmcnt(4)
v_mfma_f32_16x16x32_bf16 v[176:179],a[240:243],v[112:115],v[176:179]
ds_read_b64_tr_b16 a[252:253],v6 offset:1024
ds_read_b64_tr_b16 a[254:255],v6 offset:7168
v_mfma_f32_16x16x32_bf16 v[224:227],a[240:243],v[116:119],v[224:227]
v_accvgpr_read_b32 v72,a8
v_accvgpr_read_b32 v73,a9
v_mfma_f32_16x16x32_bf16 a[16:19],a[240:243],v[120:123],a[16:19]
s_waitcnt lgkmcnt(4)
ds_read_b64_tr_b16 a[240:241],v3 offset:2048
ds_read_b64_tr_b16 a[242:243],v3 offset:8192
v_mfma_f32_16x16x32_bf16 v[180:183],a[244:247],v[112:115],v[180:183]
v_accvgpr_read_b32 v74,a10
v_accvgpr_read_b32 v75,a11
v_mfma_f32_16x16x32_bf16 v[228:231],a[244:247],v[116:119],v[228:231]
v_accvgpr_read_b32 v76,a12
v_accvgpr_read_b32 v77,a13
v_accvgpr_read_b32 v78,a14
v_accvgpr_read_b32 v79,a15
v_subrev_u32 v11,18432,v11
v_pk_mul_f32 v[208:209],v[208:209],v[146:147] op_sel_hi:[1,0]
v_pk_mul_f32 v[210:211],v[210:211],v[146:147] op_sel_hi:[1,0]
v_pk_mul_f32 v[224:225],v[224:225],v[146:147] op_sel_hi:[1,0]
v_pk_mul_f32 v[226:227],v[226:227],v[146:147] op_sel_hi:[1,0]
v_cvt_pk_bf16_f32 v80,v208,v209
v_cvt_pk_bf16_f32 v81,v210,v211
v_mfma_f32_16x16x32_bf16 a[20:23],a[244:247],v[120:123],a[20:23]
s_waitcnt lgkmcnt(4)
ds_read_b64_tr_b16 a[244:245],v4 offset:2048
ds_read_b64_tr_b16 a[246:247],v4 offset:8192
v_mfma_f32_16x16x32_bf16 v[184:187],a[248:251],v[112:115],v[184:187]
v_cvt_pk_bf16_f32 v82,v224,v225
v_cvt_pk_bf16_f32 v83,v226,v227
v_mfma_f32_16x16x32_bf16 v[232:235],a[248:251],v[116:119],v[232:235]
ds_write2st64_b64 v12,v[80:81],v[82:83] offset0:12 offset1:14
v_pk_mul_f32 v[212:213],v[212:213],v[146:147] op_sel_hi:[1,0]
v_pk_mul_f32 v[214:215],v[214:215],v[146:147] op_sel_hi:[1,0]
v_pk_mul_f32 v[228:229],v[228:229],v[146:147] op_sel_hi:[1,0]
v_pk_mul_f32 v[230:231],v[230:231],v[146:147] op_sel_hi:[1,0]
v_cvt_pk_bf16_f32 v84,v212,v213
v_cvt_pk_bf16_f32 v85,v214,v215
v_mfma_f32_16x16x32_bf16 a[24:27],a[248:251],v[120:123],a[24:27]
buffer_load_dwordx4 v7,s[4:7],s20 offen offset:128 lds
s_add_u32 m0,s22,26368
s_waitcnt lgkmcnt(3)
v_mfma_f32_16x16x32_bf16 v[188:191],a[252:255],v[112:115],v[188:191]
ds_read_b64_tr_b16 a[248:249],v5 offset:2048
ds_read_b64_tr_b16 a[250:251],v5 offset:8192
v_mfma_f32_16x16x32_bf16 v[236:239],a[252:255],v[116:119],v[236:239]
v_cvt_pk_bf16_f32 v86,v228,v229
v_cvt_pk_bf16_f32 v87,v230,v231
ds_write2st64_b64 v20,v[84:85],v[86:87] offset0:12 offset1:14
v_pk_mul_f32 v[216:217],v[216:217],v[146:147] op_sel_hi:[1,0]
v_pk_mul_f32 v[218:219],v[218:219],v[146:147] op_sel_hi:[1,0]
v_pk_mul_f32 v[232:233],v[232:233],v[146:147] op_sel_hi:[1,0]
v_pk_mul_f32 v[234:235],v[234:235],v[146:147] op_sel_hi:[1,0]
v_cvt_pk_bf16_f32 v88,v216,v217
v_cvt_pk_bf16_f32 v89,v218,v219
v_mfma_f32_16x16x32_bf16 a[28:31],a[252:255],v[120:123],a[28:31]
ds_read_b64_tr_b16 a[252:253],v6 offset:2048
ds_read_b64_tr_b16 a[254:255],v6 offset:8192
v_mfma_f32_16x16x32_bf16 v[192:195],a[240:243],v[112:115],v[192:195]
v_cvt_pk_bf16_f32 v90,v232,v233
v_cvt_pk_bf16_f32 v91,v234,v235
v_mfma_f32_16x16x32_bf16 v[240:243],a[240:243],v[116:119],v[240:243]
ds_write2st64_b64 v21,v[88:89],v[90:91] offset0:12 offset1:14
v_pk_mul_f32 v[220:221],v[220:221],v[146:147] op_sel_hi:[1,0]
v_pk_mul_f32 v[222:223],v[222:223],v[146:147] op_sel_hi:[1,0]
v_pk_mul_f32 v[236:237],v[236:237],v[146:147] op_sel_hi:[1,0]
v_pk_mul_f32 v[238:239],v[238:239],v[146:147] op_sel_hi:[1,0]
v_cvt_pk_bf16_f32 v92,v220,v221
v_cvt_pk_bf16_f32 v93,v222,v223
v_mfma_f32_16x16x32_bf16 a[32:35],a[240:243],v[120:123],a[32:35]
s_waitcnt lgkmcnt(3)
v_cvt_pk_bf16_f32 v94,v236,v237
v_cvt_pk_bf16_f32 v95,v238,v239
v_mfma_f32_16x16x32_bf16 v[196:199],a[244:247],v[112:115],v[196:199]
ds_write2st64_b64 v22,v[92:93],v[94:95] offset0:12 offset1:14
v_mfma_f32_16x16x32_bf16 v[244:247],a[244:247],v[116:119],v[244:247]
v_pk_mul_f32 v[240:241],v[240:241],v[146:147] op_sel_hi:[1,0]
v_pk_mul_f32 v[242:243],v[242:243],v[146:147] op_sel_hi:[1,0]
v_pk_mul_f32 v[64:65],v[64:65],v[148:149] op_sel_hi:[1,0]
v_pk_mul_f32 v[66:67],v[66:67],v[148:149] op_sel_hi:[1,0]
v_cvt_pk_bf16_f32 v82,v64,v65
v_cvt_pk_bf16_f32 v83,v66,v67
v_mfma_f32_16x16x32_bf16 a[36:39],a[244:247],v[120:123],a[36:39]
v_accvgpr_read_b32 v64,a16
v_accvgpr_read_b32 v65,a17
v_mfma_f32_16x16x32_bf16 v[200:203],a[248:251],v[112:115],v[200:203]
buffer_load_dwordx4 v7,s[4:7],s20 offen offset:256 lds
s_add_u32 s20,s20,12288
s_add_u32 m0,s23,0
v_mfma_f32_16x16x32_bf16 v[248:251],a[248:251],v[116:119],v[248:251]
v_accvgpr_read_b32 v66,a18
v_accvgpr_read_b32 v67,a19
v_cvt_pk_bf16_f32 v80,v240,v241
v_cvt_pk_bf16_f32 v81,v242,v243
v_pk_mul_f32 v[244:245],v[244:245],v[146:147] op_sel_hi:[1,0]
v_pk_mul_f32 v[246:247],v[246:247],v[146:147] op_sel_hi:[1,0]
v_pk_mul_f32 v[68:69],v[68:69],v[148:149] op_sel_hi:[1,0]
v_pk_mul_f32 v[70:71],v[70:71],v[148:149] op_sel_hi:[1,0]
v_cvt_pk_bf16_f32 v86,v68,v69
v_cvt_pk_bf16_f32 v87,v70,v71
v_mfma_f32_16x16x32_bf16 a[40:43],a[248:251],v[120:123],a[40:43]
s_waitcnt lgkmcnt(0)
v_accvgpr_read_b32 v68,a32
v_accvgpr_read_b32 v69,a33
v_mfma_f32_16x16x32_bf16 v[204:207],a[252:255],v[112:115],v[204:207]
v_accvgpr_read_b32 v70,a34
v_accvgpr_read_b32 v71,a35
v_mfma_f32_16x16x32_bf16 v[252:255],a[252:255],v[116:119],v[252:255]
v_cvt_pk_bf16_f32 v84,v244,v245
v_cvt_pk_bf16_f32 v85,v246,v247
v_pk_mul_f32 v[248:249],v[248:249],v[146:147] op_sel_hi:[1,0]
v_pk_mul_f32 v[250:251],v[250:251],v[146:147] op_sel_hi:[1,0]
v_pk_mul_f32 v[72:73],v[72:73],v[148:149] op_sel_hi:[1,0]
v_pk_mul_f32 v[74:75],v[74:75],v[148:149] op_sel_hi:[1,0]
v_cvt_pk_bf16_f32 v90,v72,v73
v_cvt_pk_bf16_f32 v91,v74,v75
v_mfma_f32_16x16x32_bf16 a[44:47],a[252:255],v[120:123],a[44:47]
v_accvgpr_read_b32 v72,a20
v_accvgpr_read_b32 v73,a21
v_mfma_f32_16x16x32_bf16 v[32:35],a[192:195],a[96:99],0
v_accvgpr_read_b32 v74,a22
v_accvgpr_read_b32 v75,a23
v_mfma_f32_16x16x32_bf16 v[32:35],a[196:199],a[100:103],v[32:35]
v_cvt_pk_bf16_f32 v88,v248,v249
v_cvt_pk_bf16_f32 v89,v250,v251
s_waitcnt vmcnt(9)
ds_read_b128 a[144:147],v28 offset:12288
v_pk_mul_f32 v[252:253],v[252:253],v[146:147] op_sel_hi:[1,0]
v_pk_mul_f32 v[254:255],v[254:255],v[146:147] op_sel_hi:[1,0]
v_pk_mul_f32 v[76:77],v[76:77],v[148:149] op_sel_hi:[1,0]
v_pk_mul_f32 v[78:79],v[78:79],v[148:149] op_sel_hi:[1,0]
v_cvt_pk_bf16_f32 v94,v76,v77
v_cvt_pk_bf16_f32 v95,v78,v79
v_mfma_f32_16x16x32_bf16 v[32:35],a[200:203],a[104:107],v[32:35]
ds_read_b128 a[148:151],v29 offset:12288
v_accvgpr_read_b32 v76,a36
v_mfma_f32_16x16x32_bf16 v[32:35],a[204:207],a[108:111],v[32:35]
ds_read_b128 a[152:155],v28 offset:13312
v_accvgpr_read_b32 v77,a37
v_accvgpr_read_b32 v78,a38
v_accvgpr_read_b32 v79,a39
v_cvt_pk_bf16_f32 v92,v252,v253
v_pk_mul_f32 v[64:65],v[64:65],v[148:149] op_sel_hi:[1,0]
v_pk_mul_f32 v[66:67],v[66:67],v[148:149] op_sel_hi:[1,0]
v_pk_mul_f32 v[68:69],v[68:69],v[148:149] op_sel_hi:[1,0]
v_pk_mul_f32 v[70:71],v[70:71],v[148:149] op_sel_hi:[1,0]
v_cvt_pk_bf16_f32 v93,v254,v255
s_waitcnt vmcnt(11)
s_barrier
v_mfma_f32_16x16x32_bf16 v[32:35],a[208:211],a[112:115],v[32:35]
ds_read_b128 a[156:159],v29 offset:13312
v_mfma_f32_16x16x32_bf16 v[32:35],a[212:215],a[116:119],v[32:35]
ds_read_b128 a[160:163],v28 offset:14336
v_mfma_f32_16x16x32_bf16 v[36:39],a[216:219],a[96:99],0
ds_read_b128 a[164:167],v29 offset:14336
v_mfma_f32_16x16x32_bf16 v[36:39],a[220:223],a[100:103],v[36:39]
ds_write2st64_b64 v12,v[80:81],v[82:83] offset0:16 offset1:24
v_pk_mul_f32 v[72:73],v[72:73],v[148:149] op_sel_hi:[1,0]
v_pk_mul_f32 v[74:75],v[74:75],v[148:149] op_sel_hi:[1,0]
v_pk_mul_f32 v[76:77],v[76:77],v[148:149] op_sel_hi:[1,0]
v_pk_mul_f32 v[78:79],v[78:79],v[148:149] op_sel_hi:[1,0]
v_cvt_pk_bf16_f32 v80,v64,v65
v_cvt_pk_bf16_f32 v81,v66,v67
v_mfma_f32_16x16x32_bf16 v[36:39],a[224:227],a[104:107],v[36:39]
buffer_load_dwordx4 v7,s[8:11],s21 offen offset:0 lds
s_add_u32 m0,s23,896
v_mfma_f32_16x16x32_bf16 v[36:39],a[228:231],a[108:111],v[36:39]
v_cvt_pk_bf16_f32 v82,v68,v69
v_cvt_pk_bf16_f32 v83,v70,v71
v_mfma_f32_16x16x32_bf16 v[36:39],a[232:235],a[112:115],v[36:39]
ds_write2st64_b64 v20,v[84:85],v[86:87] offset0:16 offset1:24
v_mfma_f32_16x16x32_bf16 v[36:39],a[236:239],a[116:119],v[36:39]
v_accvgpr_read_b32 v64,a24
v_accvgpr_read_b32 v65,a25
v_accvgpr_read_b32 v66,a26
v_accvgpr_read_b32 v67,a27
v_accvgpr_read_b32 v68,a40
v_pk_mul_f32 v[64:65],v[64:65],v[148:149] op_sel_hi:[1,0]
v_pk_mul_f32 v[66:67],v[66:67],v[148:149] op_sel_hi:[1,0]
v_accvgpr_read_b32 v69,a41
v_pk_mul_f32 v[68:69],v[68:69],v[148:149] op_sel_hi:[1,0]
v_accvgpr_read_b32 v70,a42
v_accvgpr_read_b32 v71,a43
v_pk_mul_f32 v[70:71],v[70:71],v[148:149] op_sel_hi:[1,0]
v_cvt_pk_bf16_f32 v84,v72,v73
v_cvt_pk_bf16_f32 v85,v74,v75
v_mfma_f32_16x16x32_bf16 v[40:43],a[192:195],a[120:123],0
ds_write2st64_b64 v21,v[88:89],v[90:91] offset0:16 offset1:24
v_mfma_f32_16x16x32_bf16 v[40:43],a[196:199],a[124:127],v[40:43]
v_cvt_pk_bf16_f32 v86,v76,v77
v_cvt_pk_bf16_f32 v87,v78,v79
v_mfma_f32_16x16x32_bf16 v[40:43],a[200:203],a[128:131],v[40:43]
v_accvgpr_read_b32 v72,a28
v_accvgpr_read_b32 v73,a29
v_mfma_f32_16x16x32_bf16 v[40:43],a[204:207],a[132:135],v[40:43]
buffer_load_dwordx4 v7,s[8:11],s21 offen offset:128 lds
s_add_u32 m0,s23,1792
v_accvgpr_read_b32 v74,a30
v_accvgpr_read_b32 v75,a31
v_pk_mul_f32 v[72:73],v[72:73],v[148:149] op_sel_hi:[1,0]
v_pk_mul_f32 v[74:75],v[74:75],v[148:149] op_sel_hi:[1,0]
v_accvgpr_read_b32 v76,a44
v_accvgpr_read_b32 v77,a45
v_pk_mul_f32 v[76:77],v[76:77],v[148:149] op_sel_hi:[1,0]
v_accvgpr_read_b32 v78,a46
v_accvgpr_read_b32 v79,a47
v_pk_mul_f32 v[78:79],v[78:79],v[148:149] op_sel_hi:[1,0]
v_cvt_pk_bf16_f32 v88,v64,v65
v_cvt_pk_bf16_f32 v89,v66,v67
v_mfma_f32_16x16x32_bf16 v[40:43],a[208:211],a[136:139],v[40:43]
ds_write2st64_b64 v22,v[92:93],v[94:95] offset0:16 offset1:24
v_mfma_f32_16x16x32_bf16 v[40:43],a[212:215],a[140:143],v[40:43]
v_cvt_pk_bf16_f32 v90,v68,v69
v_cvt_pk_bf16_f32 v91,v70,v71
v_mfma_f32_16x16x32_bf16 v[44:47],a[216:219],a[120:123],0
v_cvt_pk_bf16_f32 v92,v72,v73
v_cvt_pk_bf16_f32 v93,v74,v75
v_mfma_f32_16x16x32_bf16 v[44:47],a[220:223],a[124:127],v[44:47]
ds_write2st64_b64 v12,v[80:81],v[82:83] offset0:26 offset1:28
v_pk_mul_f32 v[160:161],v[160:161],v[144:145] op_sel_hi:[1,0]
v_pk_mul_f32 v[162:163],v[162:163],v[144:145] op_sel_hi:[1,0]
v_pk_mul_f32 v[176:177],v[176:177],v[144:145] op_sel_hi:[1,0]
v_pk_mul_f32 v[178:179],v[178:179],v[144:145] op_sel_hi:[1,0]
v_cvt_pk_bf16_f32 v94,v76,v77
v_cvt_pk_bf16_f32 v95,v78,v79
v_mfma_f32_16x16x32_bf16 v[44:47],a[224:227],a[128:131],v[44:47]
ds_write2st64_b64 v20,v[84:85],v[86:87] offset0:26 offset1:28
v_mfma_f32_16x16x32_bf16 v[44:47],a[228:231],a[132:135],v[44:47]
v_cvt_pk_bf16_f32 v80,v160,v161
v_cvt_pk_bf16_f32 v81,v162,v163
v_mfma_f32_16x16x32_bf16 v[44:47],a[232:235],a[136:139],v[44:47]
v_cvt_pk_bf16_f32 v82,v176,v177
v_cvt_pk_bf16_f32 v83,v178,v179
v_mfma_f32_16x16x32_bf16 v[44:47],a[236:239],a[140:143],v[44:47]
buffer_load_dwordx4 v7,s[8:11],s21 offen offset:256 lds
s_add_u32 s21,s21,12288
s_mov_b32 s27,s42
s_mov_b32 s42,s41
s_add_u32 s69,s69,1
v_pk_mul_f32 v[164:165],v[164:165],v[144:145] op_sel_hi:[1,0]
v_pk_mul_f32 v[166:167],v[166:167],v[144:145] op_sel_hi:[1,0]
v_pk_mul_f32 v[180:181],v[180:181],v[144:145] op_sel_hi:[1,0]
v_pk_mul_f32 v[182:183],v[182:183],v[144:145] op_sel_hi:[1,0]
v_cvt_pk_bf16_f32 v84,v164,v165
v_cvt_pk_bf16_f32 v85,v166,v167
s_waitcnt lgkmcnt(1)
v_mfma_f32_16x16x32_bf16 v[48:51],a[192:195],a[144:147],0
s_add_u32 s48,s48,325632
ds_write2st64_b64 v21,v[88:89],v[90:91] offset0:26 offset1:28
s_lshr_b32 s62,s39,s69
s_and_b32 s62,s62,1
s_lshl_b32 s62,s62,1
s_add_u32 s62,s62,s49
v_mfma_f32_16x16x32_bf16 v[48:51],a[196:199],a[148:151],v[48:51]
s_and_b32 s62,s62,3
v_cvt_pk_bf16_f32 v86,v180,v181
v_cvt_pk_bf16_f32 v87,v182,v183
v_mfma_f32_16x16x32_bf16 v[48:51],a[200:203],a[152:155],v[48:51]
s_add_u32 s63,s69,8
s_lshr_b32 s63,s39,s63
s_and_b32 s63,s63,1
v_mfma_f32_16x16x32_bf16 v[48:51],a[204:207],a[156:159],v[48:51]
s_xor_b32 s62,s62,s63
ds_write2st64_b64 v22,v[92:93],v[94:95] offset0:26 offset1:28
s_mul_i32 s63,s3,3
s_lshl_b32 s64,s3,2
s_mov_b32 s40,1
s_add_u32 s65,s63,17
v_pk_mul_f32 v[168:169],v[168:169],v[144:145] op_sel_hi:[1,0]
v_pk_mul_f32 v[170:171],v[170:171],v[144:145] op_sel_hi:[1,0]
v_pk_mul_f32 v[184:185],v[184:185],v[144:145] op_sel_hi:[1,0]
v_pk_mul_f32 v[186:187],v[186:187],v[144:145] op_sel_hi:[1,0]
v_cvt_pk_bf16_f32 v88,v168,v169
v_cvt_pk_bf16_f32 v89,v170,v171
v_mfma_f32_16x16x32_bf16 v[48:51],a[208:211],a[160:163],v[48:51]
s_cmp_eq_u32 s3,0
v_cvt_pk_bf16_f32 v90,v184,v185
v_cvt_pk_bf16_f32 v91,v186,v187
v_mfma_f32_16x16x32_bf16 v[48:51],a[212:215],a[164:167],v[48:51]
s_cselect_b32 s65,16,s65
s_cselect_b32 s41,1,0
s_cmp_eq_u32 s62,1
v_mfma_f32_16x16x32_bf16 v[52:55],a[216:219],a[144:147],0
s_cselect_b32 s64,s65,s64
s_cselect_b32 s40,s41,s40
s_add_u32 s65,s63,29
v_mfma_f32_16x16x32_bf16 v[52:55],a[220:223],a[148:151],v[52:55]
s_cmp_eq_u32 s62,2
s_cselect_b32 s64,s65,s64
s_cselect_b32 s40,0,s40
s_add_u32 s65,s63,41
s_cmp_eq_u32 s62,3
s_cselect_b32 s64,s65,s64
v_pk_mul_f32 v[172:173],v[172:173],v[144:145] op_sel_hi:[1,0]
v_pk_mul_f32 v[174:175],v[174:175],v[144:145] op_sel_hi:[1,0]
v_pk_mul_f32 v[188:189],v[188:189],v[144:145] op_sel_hi:[1,0]
v_pk_mul_f32 v[190:191],v[190:191],v[144:145] op_sel_hi:[1,0]
v_cvt_pk_bf16_f32 v92,v172,v173
v_cvt_pk_bf16_f32 v93,v174,v175
v_mfma_f32_16x16x32_bf16 v[52:55],a[224:227],a[152:155],v[52:55]
s_waitcnt vmcnt(6)
ds_read_b128 a[168:171],v28 offset:0
v_cvt_pk_bf16_f32 v94,v188,v189
v_mfma_f32_16x16x32_bf16 v[52:55],a[228:231],a[156:159],v[52:55]
s_cselect_b32 s40,0,s40
ds_read_b128 a[172:175],v29 offset:0
v_cvt_pk_bf16_f32 v95,v190,v191
v_mfma_f32_16x16x32_bf16 v[52:55],a[232:235],a[160:163],v[52:55]
s_mul_i32 s64,s64,6144
ds_read_b128 a[176:179],v28 offset:1024
s_add_u32 s41,s48,s64
v_mfma_f32_16x16x32_bf16 v[52:55],a[236:239],a[164:167],v[52:55]
s_cmp_ge_u32 s69,8
ds_read_b128 a[180:183],v29 offset:1024
s_cselect_b32 s41,166723584,s41
ds_read_b128 a[184:187],v28 offset:2048
s_mov_b32 s28,s41
s_mov_b32 s29,s24
v_pk_mul_f32 v[192:193],v[192:193],v[144:145] op_sel_hi:[1,0]
v_pk_mul_f32 v[194:195],v[194:195],v[144:145] op_sel_hi:[1,0]
s_add_u32 s25,s22,12288
s_add_u32 s26,s22,24576
ds_read_b128 a[188:191],v29 offset:2048
ds_write2st64_b64 v12,v[80:81],v[82:83] offset0:0 offset1:2
v_cvt_pk_bf16_f32 v80,v192,v193
v_cvt_pk_bf16_f32 v81,v194,v195
s_waitcnt lgkmcnt(6)
v_mfma_f32_16x16x32_bf16 v[56:59],a[192:195],a[168:171],0
s_waitcnt lgkmcnt(5)
ds_write2st64_b64 v20,v[84:85],v[86:87] offset0:0 offset1:2
v_mfma_f32_16x16x32_bf16 v[56:59],a[196:199],a[172:175],v[56:59]
s_waitcnt lgkmcnt(5)
v_mfma_f32_16x16x32_bf16 v[56:59],a[200:203],a[176:179],v[56:59]
s_waitcnt lgkmcnt(4)
v_mfma_f32_16x16x32_bf16 v[56:59],a[204:207],a[180:183],v[56:59]
ds_write2st64_b64 v21,v[88:89],v[90:91] offset0:0 offset1:2
v_pk_mul_f32 v[196:197],v[196:197],v[144:145] op_sel_hi:[1,0]
v_pk_mul_f32 v[198:199],v[198:199],v[144:145] op_sel_hi:[1,0]
v_cvt_pk_bf16_f32 v84,v196,v197
v_cvt_pk_bf16_f32 v85,v198,v199
s_waitcnt lgkmcnt(2)
v_mfma_f32_16x16x32_bf16 v[56:59],a[208:211],a[184:187],v[56:59]
v_mfma_f32_16x16x32_bf16 v[56:59],a[212:215],a[188:191],v[56:59]
ds_write2st64_b64 v22,v[92:93],v[94:95] offset0:0 offset1:2
v_mfma_f32_16x16x32_bf16 v[60:63],a[216:219],a[168:171],0
v_mfma_f32_16x16x32_bf16 v[60:63],a[220:223],a[172:175],v[60:63]
ds_write_b64 v12,v[80:81] offset:2048
v_pk_mul_f32 v[200:201],v[200:201],v[144:145] op_sel_hi:[1,0]
v_pk_mul_f32 v[202:203],v[202:203],v[144:145] op_sel_hi:[1,0]
v_cvt_pk_bf16_f32 v88,v200,v201
v_cvt_pk_bf16_f32 v89,v202,v203
v_mfma_f32_16x16x32_bf16 v[60:63],a[224:227],a[176:179],v[60:63]
ds_write_b64 v20,v[84:85] offset:2048
v_mfma_f32_16x16x32_bf16 v[60:63],a[228:231],a[180:183],v[60:63]
v_mfma_f32_16x16x32_bf16 v[60:63],a[232:235],a[184:187],v[60:63]
ds_write_b64 v21,v[88:89] offset:2048
v_mfma_f32_16x16x32_bf16 v[60:63],a[236:239],a[188:191],v[60:63]
v_pk_mul_f32 v[204:205],v[204:205],v[144:145] op_sel_hi:[1,0]
v_pk_mul_f32 v[206:207],v[206:207],v[144:145] op_sel_hi:[1,0]
v_cvt_pk_bf16_f32 v92,v204,v205
v_cvt_pk_bf16_f32 v93,v206,v207
ds_write_b64 v22,v[92:93] offset:2048
ds_read_b128 a[192:195],v1 offset:12288
v_max3_f32 v144,v32,v33,v34
v_max3_f32 v146,v40,v41,v42
v_max3_f32 v144,v144,v35,v36
v_max3_f32 v146,v146,v43,v44
v_max3_f32 v144,v144,v37,v38
v_max3_f32 v146,v146,v45,v46
v_max_f32 v144,v144,v39
v_max_f32 v146,v146,v47
v_mov_b32 v145,v144
v_mov_b32 v147,v146
s_add_u32 m0,s23,12288
v_permlane32_swap_b32 v145,v144
v_permlane32_swap_b32 v147,v146
v_max_f32 v144,v144,v145
v_max_f32 v146,v146,v147
v_mov_b32 v145,v144
v_mov_b32 v147,v146
buffer_load_dwordx4 v7,s[8:11],s21 offen offset:0 lds
s_add_u32 m0,s23,13184
ds_read_b128 a[196:199],v2 offset:12288
v_permlane16_swap_b32 v145,v144
v_permlane16_swap_b32 v147,v146
v_max_f32 v144,v144,v145
v_max_f32 v146,v146,v147
v_mul_f32_e64 v16,-s36,v144
v_mul_f32_e64 v17,-s36,v146
v_max3_f32 v144,v48,v49,v50
s_waitcnt lgkmcnt(1)
v_mfma_f32_16x16x32_bf16 v[64:67],a[192:195],a[96:99],0
ds_read_b128 a[200:203],v1 offset:13312
v_max3_f32 v146,v56,v57,v58
v_max3_f32 v144,v144,v51,v52
v_max3_f32 v146,v146,v59,v60
v_max3_f32 v144,v144,v53,v54
v_max3_f32 v146,v146,v61,v62
v_max_f32 v144,v144,v55
v_max_f32 v146,v146,v63
v_mov_b32 v145,v144
v_mov_b32 v147,v146
v_fma_f32 v32,v32,s36,v16
v_permlane32_swap_b32 v145,v144
v_permlane32_swap_b32 v147,v146
v_max_f32 v144,v144,v145
v_max_f32 v146,v146,v147
v_mov_b32 v145,v144
v_mov_b32 v147,v146
v_fma_f32 v33,v33,s36,v16
v_permlane16_swap_b32 v145,v144
v_permlane16_swap_b32 v147,v146
s_waitcnt lgkmcnt(1)
v_mfma_f32_16x16x32_bf16 v[64:67],a[196:199],a[100:103],v[64:67]
buffer_load_dwordx4 v7,s[8:11],s21 offen offset:128 lds
s_add_u32 m0,s23,14080
ds_read_b128 a[204:207],v2 offset:13312
v_max_f32 v144,v144,v145
v_max_f32 v146,v146,v147
v_mul_f32_e64 v18,-s36,v144
v_mul_f32_e64 v19,-s36,v146
v_fma_f32 v34,v34,s36,v16
s_waitcnt lgkmcnt(1)
v_mfma_f32_16x16x32_bf16 v[64:67],a[200:203],a[104:107],v[64:67]
ds_read_b128 a[208:211],v1 offset:14336
v_fma_f32 v35,v35,s36,v16
v_fma_f32 v36,v36,s36,v16
v_fma_f32 v37,v37,s36,v16
v_fma_f32 v38,v38,s36,v16
v_fma_f32 v39,v39,s36,v16
v_fma_f32 v40,v40,s36,v17
v_fma_f32 v41,v41,s36,v17
v_fma_f32 v42,v42,s36,v17
v_fma_f32 v43,v43,s36,v17
v_fma_f32 v44,v44,s36,v17
v_fma_f32 v45,v45,s36,v17
v_fma_f32 v46,v46,s36,v17
v_fma_f32 v47,v47,s36,v17
v_fma_f32 v48,v48,s36,v18
v_fma_f32 v49,v49,s36,v18
v_fma_f32 v50,v50,s36,v18
v_fma_f32 v51,v51,s36,v18
v_fma_f32 v52,v52,s36,v18
v_fma_f32 v53,v53,s36,v18
v_fma_f32 v54,v54,s36,v18
v_fma_f32 v55,v55,s36,v18
v_fma_f32 v56,v56,s36,v19
v_fma_f32 v57,v57,s36,v19
v_fma_f32 v58,v58,s36,v19
v_fma_f32 v59,v59,s36,v19
v_fma_f32 v60,v60,s36,v19
s_waitcnt lgkmcnt(1)
v_mfma_f32_16x16x32_bf16 v[64:67],a[204:207],a[108:111],v[64:67]
ds_read_b128 a[212:215],v2 offset:14336
v_fma_f32 v61,v61,s36,v19
v_fma_f32 v62,v62,s36,v19
v_fma_f32 v63,v63,s36,v19
v_exp_f32 v32,v32
s_waitcnt lgkmcnt(1)
v_mfma_f32_16x16x32_bf16 v[64:67],a[208:211],a[112:115],v[64:67]
buffer_load_dwordx4 v7,s[8:11],s21 offen offset:256 lds
s_add_u32 s21,s21,12288
s_add_u32 m0,s22,0
ds_read_b128 a[216:219],v1 offset:18432
v_exp_f32 v33,v33
v_exp_f32 v34,v34
v_exp_f32 v35,v35
v_exp_f32 v36,v36
v_exp_f32 v37,v37
v_exp_f32 v38,v38
v_exp_f32 v39,v39
v_exp_f32 v40,v40
v_exp_f32 v41,v41
v_exp_f32 v42,v42
v_exp_f32 v43,v43
v_exp_f32 v44,v44
s_waitcnt lgkmcnt(1)
v_mfma_f32_16x16x32_bf16 v[64:67],a[212:215],a[116:119],v[64:67]
ds_read_b128 a[220:223],v2 offset:18432
v_exp_f32 v45,v45
v_mfma_f32_16x16x32_bf16 v[72:75],a[192:195],a[120:123],0
ds_read_b128 a[224:227],v1 offset:19456
v_exp_f32 v46,v46
v_mfma_f32_16x16x32_bf16 v[72:75],a[196:199],a[124:127],v[72:75]
ds_read_b128 a[228:231],v2 offset:19456
v_exp_f32 v47,v47
v_mfma_f32_16x16x32_bf16 v[72:75],a[200:203],a[128:131],v[72:75]
buffer_load_dwordx4 v7,s[4:7],s20 offen offset:0 lds
s_add_u32 m0,s22,896
v_mfma_f32_16x16x32_bf16 v[72:75],a[204:207],a[132:135],v[72:75]
ds_read_b128 a[232:235],v1 offset:20480
v_exp_f32 v48,v48
v_mfma_f32_16x16x32_bf16 v[72:75],a[208:211],a[136:139],v[72:75]
ds_read_b128 a[236:239],v2 offset:20480
v_exp_f32 v49,v49
v_mfma_f32_16x16x32_bf16 v[72:75],a[212:215],a[140:143],v[72:75]
v_exp_f32 v50,v50
v_mfma_f32_16x16x32_bf16 v[80:83],a[192:195],a[144:147],0
v_exp_f32 v51,v51
v_mfma_f32_16x16x32_bf16 v[80:83],a[196:199],a[148:151],v[80:83]
v_exp_f32 v52,v52
v_mfma_f32_16x16x32_bf16 v[80:83],a[200:203],a[152:155],v[80:83]
v_exp_f32 v53,v53
v_mfma_f32_16x16x32_bf16 v[80:83],a[204:207],a[156:159],v[80:83]
v_exp_f32 v54,v54
v_mfma_f32_16x16x32_bf16 v[80:83],a[208:211],a[160:163],v[80:83]
v_exp_f32 v55,v55
v_mfma_f32_16x16x32_bf16 v[80:83],a[212:215],a[164:167],v[80:83]
v_exp_f32 v56,v56
v_mfma_f32_16x16x32_bf16 v[88:91],a[192:195],a[168:171],0
v_exp_f32 v57,v57
v_mfma_f32_16x16x32_bf16 v[88:91],a[196:199],a[172:175],v[88:91]
v_exp_f32 v58,v58
v_mfma_f32_16x16x32_bf16 v[88:91],a[200:203],a[176:179],v[88:91]
buffer_load_dwordx4 v7,s[4:7],s20 offen offset:128 lds
s_add_u32 m0,s22,1792
v_mfma_f32_16x16x32_bf16 v[88:91],a[204:207],a[180:183],v[88:91]
v_exp_f32 v59,v59
v_mfma_f32_16x16x32_bf16 v[88:91],a[208:211],a[184:187],v[88:91]
v_exp_f32 v60,v60
v_mfma_f32_16x16x32_bf16 v[88:91],a[212:215],a[188:191],v[88:91]
s_waitcnt lgkmcnt(0)
v_exp_f32 v61,v61
v_mfma_f32_16x16x32_bf16 v[68:71],a[216:219],a[96:99],0
v_exp_f32 v62,v62
v_mfma_f32_16x16x32_bf16 v[68:71],a[220:223],a[100:103],v[68:71]
v_exp_f32 v63,v63
v_mfma_f32_16x16x32_bf16 v[68:71],a[224:227],a[104:107],v[68:71]
v_cvt_pk_bf16_f32 v96,v32,v33
v_cvt_pk_bf16_f32 v97,v34,v35
v_mfma_f32_16x16x32_bf16 v[68:71],a[228:231],a[108:111],v[68:71]
v_cvt_pk_bf16_f32 v98,v36,v37
v_cvt_pk_bf16_f32 v99,v38,v39
v_mfma_f32_16x16x32_bf16 v[68:71],a[232:235],a[112:115],v[68:71]
v_cvt_pk_bf16_f32 v100,v40,v41
v_cvt_pk_bf16_f32 v101,v42,v43
v_mfma_f32_16x16x32_bf16 v[128:131],v[24:27],v[96:99],0
v_cvt_pk_bf16_f32 v102,v44,v45
v_cvt_pk_bf16_f32 v103,v46,v47
v_mfma_f32_16x16x32_bf16 v[68:71],a[236:239],a[116:119],v[68:71]
v_cvt_pk_bf16_f32 v104,v48,v49
v_cvt_pk_bf16_f32 v105,v50,v51
v_mfma_f32_16x16x32_bf16 v[132:135],v[24:27],v[100:103],0
v_cvt_pk_bf16_f32 v106,v52,v53
v_cvt_pk_bf16_f32 v107,v54,v55
v_mfma_f32_16x16x32_bf16 v[76:79],a[216:219],a[120:123],0
buffer_load_dwordx4 v7,s[4:7],s20 offen offset:256 lds
s_add_u32 s20,s20,12288
v_mfma_f32_16x16x32_bf16 v[136:139],v[24:27],v[104:107],0
v_cvt_pk_bf16_f32 v108,v56,v57
v_cvt_pk_bf16_f32 v109,v58,v59
v_mfma_f32_16x16x32_bf16 v[76:79],a[220:223],a[124:127],v[76:79]
v_cvt_pk_bf16_f32 v110,v60,v61
v_cvt_pk_bf16_f32 v111,v62,v63
v_mfma_f32_16x16x32_bf16 v[76:79],a[224:227],a[128:131],v[76:79]
v_fma_f32 v64,v64,s36,v16
v_fma_f32 v65,v65,s36,v16
v_mfma_f32_16x16x32_bf16 v[140:143],v[24:27],v[108:111],0
v_fma_f32 v66,v66,s36,v16
v_fma_f32 v67,v67,s36,v16
v_mfma_f32_16x16x32_bf16 v[76:79],a[228:231],a[132:135],v[76:79]
v_fma_f32 v72,v72,s36,v17
v_fma_f32 v73,v73,s36,v17
v_mfma_f32_16x16x32_bf16 v[76:79],a[232:235],a[136:139],v[76:79]
v_fma_f32 v74,v74,s36,v17
v_fma_f32 v75,v75,s36,v17
v_mfma_f32_16x16x32_bf16 v[76:79],a[236:239],a[140:143],v[76:79]
v_exp_f32 v64,v64
v_mfma_f32_16x16x32_bf16 v[84:87],a[216:219],a[144:147],0
v_exp_f32 v65,v65
v_mfma_f32_16x16x32_bf16 v[84:87],a[220:223],a[148:151],v[84:87]
v_exp_f32 v66,v66
v_mfma_f32_16x16x32_bf16 v[84:87],a[224:227],a[152:155],v[84:87]
v_exp_f32 v67,v67
v_mfma_f32_16x16x32_bf16 v[84:87],a[228:231],a[156:159],v[84:87]
v_exp_f32 v72,v72
v_mfma_f32_16x16x32_bf16 v[84:87],a[232:235],a[160:163],v[84:87]
v_exp_f32 v73,v73
v_mfma_f32_16x16x32_bf16 v[84:87],a[236:239],a[164:167],v[84:87]
v_exp_f32 v74,v74
v_mfma_f32_16x16x32_bf16 v[92:95],a[216:219],a[168:171],0
v_exp_f32 v75,v75
v_mfma_f32_16x16x32_bf16 v[92:95],a[220:223],a[172:175],v[92:95]
v_cvt_pk_bf16_f32 v112,v64,v65
v_cvt_pk_bf16_f32 v113,v66,v67
v_mfma_f32_16x16x32_bf16 v[92:95],a[224:227],a[176:179],v[92:95]
v_cvt_pk_bf16_f32 v116,v72,v73
v_cvt_pk_bf16_f32 v117,v74,v75
v_mfma_f32_16x16x32_bf16 v[92:95],a[228:231],a[180:183],v[92:95]
v_mfma_f32_16x16x32_bf16 v[92:95],a[232:235],a[184:187],v[92:95]
v_mfma_f32_16x16x32_bf16 v[92:95],a[236:239],a[188:191],v[92:95]
s_waitcnt vmcnt(6)
s_barrier
ds_read_b64_tr_b16 a[240:241],v3 offset:0
ds_read_b64_tr_b16 a[242:243],v3 offset:6144
ds_read_b64_tr_b16 a[244:245],v4 offset:0
ds_read_b64_tr_b16 a[246:247],v4 offset:6144
ds_read_b64_tr_b16 a[248:249],v5 offset:0
ds_read_b64_tr_b16 a[250:251],v5 offset:6144
ds_read_b64_tr_b16 a[252:253],v6 offset:0
ds_read_b64_tr_b16 a[254:255],v6 offset:6144
s_waitcnt lgkmcnt(6)
v_mfma_f32_16x16x32_bf16 v[160:163],a[240:243],v[96:99],0
s_add_u32 m0,s23,24576
ds_read_b128 a[192:195],v1 offset:24576
v_fma_f32 v68,v68,s36,v16
v_mfma_f32_16x16x32_bf16 v[208:211],a[240:243],v[100:103],0
buffer_load_dwordx4 v7,s[8:11],s21 offen offset:0 lds
v_mfma_f32_16x16x32_bf16 a[0:3],a[240:243],v[104:107],0
s_add_u32 m0,s23,25472
ds_read_b128 a[196:199],v2 offset:24576
v_fma_f32 v69,v69,s36,v16
v_mfma_f32_16x16x32_bf16 a[48:51],a[240:243],v[108:111],0
s_waitcnt lgkmcnt(6)
ds_read_b64_tr_b16 a[240:241],v3 offset:1024
ds_read_b64_tr_b16 a[242:243],v3 offset:7168
v_mfma_f32_16x16x32_bf16 v[164:167],a[244:247],v[96:99],0
ds_read_b128 a[200:203],v1 offset:25600
v_fma_f32 v70,v70,s36,v16
v_mfma_f32_16x16x32_bf16 v[212:215],a[244:247],v[100:103],0
ds_read_b128 a[204:207],v2 offset:25600
v_fma_f32 v71,v71,s36,v16
v_mfma_f32_16x16x32_bf16 a[4:7],a[244:247],v[104:107],0
ds_read_b128 a[208:211],v1 offset:26624
v_fma_f32 v76,v76,s36,v17
v_mfma_f32_16x16x32_bf16 a[52:55],a[244:247],v[108:111],0
s_waitcnt lgkmcnt(7)
ds_read_b64_tr_b16 a[244:245],v4 offset:1024
ds_read_b64_tr_b16 a[246:247],v4 offset:7168
v_mfma_f32_16x16x32_bf16 v[168:171],a[248:251],v[96:99],0
ds_read_b128 a[212:215],v2 offset:26624
v_fma_f32 v77,v77,s36,v17
v_mfma_f32_16x16x32_bf16 v[216:219],a[248:251],v[100:103],0
buffer_load_dwordx4 v7,s[8:11],s21 offen offset:128 lds
v_mfma_f32_16x16x32_bf16 a[8:11],a[248:251],v[104:107],0
s_add_u32 m0,s23,26368
ds_read_b128 a[216:219],v1 offset:30720
v_fma_f32 v78,v78,s36,v17
v_mfma_f32_16x16x32_bf16 a[56:59],a[248:251],v[108:111],0
ds_read_b64_tr_b16 a[248:249],v5 offset:1024
ds_read_b64_tr_b16 a[250:251],v5 offset:7168
v_mfma_f32_16x16x32_bf16 v[172:175],a[252:255],v[96:99],0
ds_read_b128 a[220:223],v2 offset:30720
v_fma_f32 v79,v79,s36,v17
v_mfma_f32_16x16x32_bf16 v[220:223],a[252:255],v[100:103],0
ds_read_b128 a[224:227],v1 offset:31744
v_fma_f32 v80,v80,s36,v18
v_mfma_f32_16x16x32_bf16 a[12:15],a[252:255],v[104:107],0
ds_read_b128 a[228:231],v2 offset:31744
v_fma_f32 v81,v81,s36,v18
v_mfma_f32_16x16x32_bf16 a[60:63],a[252:255],v[108:111],0
s_waitcnt lgkmcnt(7)
ds_read_b64_tr_b16 a[252:253],v6 offset:1024
ds_read_b64_tr_b16 a[254:255],v6 offset:7168
v_mfma_f32_16x16x32_bf16 v[176:179],a[240:243],v[96:99],0
ds_read_b128 a[232:235],v1 offset:32768
v_fma_f32 v82,v82,s36,v18
v_mfma_f32_16x16x32_bf16 v[224:227],a[240:243],v[100:103],0
buffer_load_dwordx4 v7,s[8:11],s21 offen offset:256 lds
v_mfma_f32_16x16x32_bf16 a[16:19],a[240:243],v[104:107],0
s_add_u32 s21,s21,12288
ds_read_b128 a[236:239],v2 offset:32768
v_fma_f32 v83,v83,s36,v18
v_mfma_f32_16x16x32_bf16 a[64:67],a[240:243],v[108:111],0
s_add_u32 m0,s22,12288
ds_read_b64_tr_b16 a[240:241],v3 offset:2048
ds_read_b64_tr_b16 a[242:243],v3 offset:8192
v_mfma_f32_16x16x32_bf16 v[180:183],a[244:247],v[96:99],0
v_fma_f32 v84,v84,s36,v18
v_fma_f32 v85,v85,s36,v18
v_mfma_f32_16x16x32_bf16 v[228:231],a[244:247],v[100:103],0
v_fma_f32 v86,v86,s36,v18
v_fma_f32 v87,v87,s36,v18
v_mfma_f32_16x16x32_bf16 a[20:23],a[244:247],v[104:107],0
v_fma_f32 v88,v88,s36,v19
v_fma_f32 v89,v89,s36,v19
v_mfma_f32_16x16x32_bf16 a[68:71],a[244:247],v[108:111],0
s_waitcnt lgkmcnt(4)
ds_read_b64_tr_b16 a[244:245],v4 offset:2048
ds_read_b64_tr_b16 a[246:247],v4 offset:8192
v_mfma_f32_16x16x32_bf16 v[184:187],a[248:251],v[96:99],0
buffer_load_dwordx4 v7,s[4:7],s20 offen offset:0 lds
v_mfma_f32_16x16x32_bf16 v[232:235],a[248:251],v[100:103],0
s_add_u32 m0,s22,13184
v_fma_f32 v90,v90,s36,v19
v_fma_f32 v91,v91,s36,v19
v_mfma_f32_16x16x32_bf16 a[24:27],a[248:251],v[104:107],0
v_fma_f32 v92,v92,s36,v19
v_fma_f32 v93,v93,s36,v19
v_mfma_f32_16x16x32_bf16 a[72:75],a[248:251],v[108:111],0
ds_read_b64_tr_b16 a[248:249],v5 offset:2048
ds_read_b64_tr_b16 a[250:251],v5 offset:8192
v_mfma_f32_16x16x32_bf16 v[188:191],a[252:255],v[96:99],0
v_fma_f32 v94,v94,s36,v19
v_fma_f32 v95,v95,s36,v19
v_mfma_f32_16x16x32_bf16 v[236:239],a[252:255],v[100:103],0
v_exp_f32 v68,v68
v_mfma_f32_16x16x32_bf16 a[28:31],a[252:255],v[104:107],0
v_exp_f32 v69,v69
v_mfma_f32_16x16x32_bf16 a[76:79],a[252:255],v[108:111],0
s_waitcnt lgkmcnt(2)
ds_read_b64_tr_b16 a[252:253],v6 offset:2048
ds_read_b64_tr_b16 a[254:255],v6 offset:8192
v_mfma_f32_16x16x32_bf16 v[192:195],a[240:243],v[96:99],0
buffer_load_dwordx4 v7,s[4:7],s20 offen offset:128 lds
v_mfma_f32_16x16x32_bf16 v[240:243],a[240:243],v[100:103],0
s_add_u32 m0,s22,14080
v_exp_f32 v70,v70
v_mfma_f32_16x16x32_bf16 a[32:35],a[240:243],v[104:107],0
v_exp_f32 v71,v71
v_mfma_f32_16x16x32_bf16 a[80:83],a[240:243],v[108:111],0
v_exp_f32 v76,v76
v_mfma_f32_16x16x32_bf16 v[196:199],a[244:247],v[96:99],0
v_exp_f32 v77,v77
v_mfma_f32_16x16x32_bf16 v[244:247],a[244:247],v[100:103],0
v_exp_f32 v78,v78
v_mfma_f32_16x16x32_bf16 a[36:39],a[244:247],v[104:107],0
v_exp_f32 v79,v79
v_mfma_f32_16x16x32_bf16 a[84:87],a[244:247],v[108:111],0
s_waitcnt lgkmcnt(0)
v_exp_f32 v80,v80
v_mfma_f32_16x16x32_bf16 v[200:203],a[248:251],v[96:99],0
buffer_load_dwordx4 v7,s[4:7],s20 offen offset:256 lds
v_mfma_f32_16x16x32_bf16 v[248:251],a[248:251],v[100:103],0
s_add_u32 s20,s20,12288
v_exp_f32 v81,v81
v_mfma_f32_16x16x32_bf16 a[40:43],a[248:251],v[104:107],0
v_exp_f32 v82,v82
v_mfma_f32_16x16x32_bf16 a[88:91],a[248:251],v[108:111],0
v_exp_f32 v83,v83
v_mfma_f32_16x16x32_bf16 v[204:207],a[252:255],v[96:99],0
v_exp_f32 v84,v84
v_mfma_f32_16x16x32_bf16 v[252:255],a[252:255],v[100:103],0
v_exp_f32 v85,v85
v_mfma_f32_16x16x32_bf16 a[44:47],a[252:255],v[104:107],0
v_exp_f32 v86,v86
v_mfma_f32_16x16x32_bf16 a[92:95],a[252:255],v[108:111],0
v_exp_f32 v87,v87
v_mfma_f32_16x16x32_bf16 v[32:35],a[192:195],a[96:99],0
v_exp_f32 v88,v88
v_mfma_f32_16x16x32_bf16 v[32:35],a[196:199],a[100:103],v[32:35]
v_exp_f32 v89,v89
v_mfma_f32_16x16x32_bf16 v[32:35],a[200:203],a[104:107],v[32:35]
v_exp_f32 v90,v90
v_mfma_f32_16x16x32_bf16 v[32:35],a[204:207],a[108:111],v[32:35]
v_exp_f32 v91,v91
v_mfma_f32_16x16x32_bf16 v[32:35],a[208:211],a[112:115],v[32:35]
v_exp_f32 v92,v92
v_mfma_f32_16x16x32_bf16 v[32:35],a[212:215],a[116:119],v[32:35]
v_exp_f32 v93,v93
v_mfma_f32_16x16x32_bf16 v[40:43],a[192:195],a[120:123],0
v_exp_f32 v94,v94
v_mfma_f32_16x16x32_bf16 v[40:43],a[196:199],a[124:127],v[40:43]
v_exp_f32 v95,v95
v_mfma_f32_16x16x32_bf16 v[40:43],a[200:203],a[128:131],v[40:43]
v_cvt_pk_bf16_f32 v114,v68,v69
v_cvt_pk_bf16_f32 v115,v70,v71
v_mfma_f32_16x16x32_bf16 v[40:43],a[204:207],a[132:135],v[40:43]
v_cvt_pk_bf16_f32 v118,v76,v77
v_cvt_pk_bf16_f32 v119,v78,v79
v_mfma_f32_16x16x32_bf16 v[128:131],v[24:27],v[112:115],v[128:131]
v_cvt_pk_bf16_f32 v120,v80,v81
v_cvt_pk_bf16_f32 v121,v82,v83
v_mfma_f32_16x16x32_bf16 v[132:135],v[24:27],v[116:119],v[132:135]
v_cvt_pk_bf16_f32 v122,v84,v85
v_cvt_pk_bf16_f32 v123,v86,v87
v_mfma_f32_16x16x32_bf16 v[40:43],a[208:211],a[136:139],v[40:43]
v_cvt_pk_bf16_f32 v124,v88,v89
v_cvt_pk_bf16_f32 v125,v90,v91
v_mfma_f32_16x16x32_bf16 v[136:139],v[24:27],v[120:123],v[136:139]
v_cvt_pk_bf16_f32 v126,v92,v93
v_cvt_pk_bf16_f32 v127,v94,v95
v_mfma_f32_16x16x32_bf16 v[40:43],a[212:215],a[140:143],v[40:43]
v_fma_f32 v32,v32,s36,v16
v_fma_f32 v33,v33,s36,v16
v_mfma_f32_16x16x32_bf16 v[140:143],v[24:27],v[124:127],v[140:143]
v_fma_f32 v34,v34,s36,v16
v_fma_f32 v35,v35,s36,v16
v_mfma_f32_16x16x32_bf16 v[48:51],a[192:195],a[144:147],0
v_exp_f32 v32,v32
v_mfma_f32_16x16x32_bf16 v[48:51],a[196:199],a[148:151],v[48:51]
v_fma_f32 v40,v40,s36,v17
v_fma_f32 v41,v41,s36,v17
v_mfma_f32_16x16x32_bf16 v[48:51],a[200:203],a[152:155],v[48:51]
v_fma_f32 v42,v42,s36,v17
v_fma_f32 v43,v43,s36,v17
v_mfma_f32_16x16x32_bf16 v[48:51],a[204:207],a[156:159],v[48:51]
v_exp_f32 v33,v33
v_mfma_f32_16x16x32_bf16 v[48:51],a[208:211],a[160:163],v[48:51]
v_exp_f32 v34,v34
v_mfma_f32_16x16x32_bf16 v[48:51],a[212:215],a[164:167],v[48:51]
v_exp_f32 v35,v35
v_mfma_f32_16x16x32_bf16 v[56:59],a[192:195],a[168:171],0
v_exp_f32 v40,v40
v_mfma_f32_16x16x32_bf16 v[56:59],a[196:199],a[172:175],v[56:59]
v_exp_f32 v41,v41
v_mfma_f32_16x16x32_bf16 v[56:59],a[200:203],a[176:179],v[56:59]
v_exp_f32 v42,v42
v_mfma_f32_16x16x32_bf16 v[56:59],a[204:207],a[180:183],v[56:59]
v_exp_f32 v43,v43
v_mfma_f32_16x16x32_bf16 v[56:59],a[208:211],a[184:187],v[56:59]
v_cvt_pk_bf16_f32 v96,v32,v33
v_cvt_pk_bf16_f32 v97,v34,v35
v_mfma_f32_16x16x32_bf16 v[56:59],a[212:215],a[188:191],v[56:59]
v_cvt_pk_bf16_f32 v100,v40,v41
v_cvt_pk_bf16_f32 v101,v42,v43
v_mfma_f32_16x16x32_bf16 v[36:39],a[216:219],a[96:99],0
v_mfma_f32_16x16x32_bf16 v[36:39],a[220:223],a[100:103],v[36:39]
v_mfma_f32_16x16x32_bf16 v[36:39],a[224:227],a[104:107],v[36:39]
v_mfma_f32_16x16x32_bf16 v[36:39],a[228:231],a[108:111],v[36:39]
v_mfma_f32_16x16x32_bf16 v[36:39],a[232:235],a[112:115],v[36:39]
v_mfma_f32_16x16x32_bf16 v[36:39],a[236:239],a[116:119],v[36:39]
v_mfma_f32_16x16x32_bf16 v[44:47],a[216:219],a[120:123],0
v_mfma_f32_16x16x32_bf16 v[44:47],a[220:223],a[124:127],v[44:47]
v_mfma_f32_16x16x32_bf16 v[44:47],a[224:227],a[128:131],v[44:47]
v_mfma_f32_16x16x32_bf16 v[44:47],a[228:231],a[132:135],v[44:47]
v_mfma_f32_16x16x32_bf16 v[44:47],a[232:235],a[136:139],v[44:47]
s_waitcnt vmcnt(6)
s_barrier
v_mfma_f32_16x16x32_bf16 v[44:47],a[236:239],a[140:143],v[44:47]
v_mfma_f32_16x16x32_bf16 v[52:55],a[216:219],a[144:147],0
ds_read_b64_tr_b16 a[240:241],v3 offset:12288
ds_read_b64_tr_b16 a[242:243],v3 offset:18432
v_mfma_f32_16x16x32_bf16 v[52:55],a[220:223],a[148:151],v[52:55]
v_mfma_f32_16x16x32_bf16 v[52:55],a[224:227],a[152:155],v[52:55]
ds_read_b64_tr_b16 a[244:245],v4 offset:12288
ds_read_b64_tr_b16 a[246:247],v4 offset:18432
v_mfma_f32_16x16x32_bf16 v[52:55],a[228:231],a[156:159],v[52:55]
v_mfma_f32_16x16x32_bf16 v[52:55],a[232:235],a[160:163],v[52:55]
ds_read_b64_tr_b16 a[248:249],v5 offset:12288
ds_read_b64_tr_b16 a[250:251],v5 offset:18432
v_mfma_f32_16x16x32_bf16 v[52:55],a[236:239],a[164:167],v[52:55]
v_mfma_f32_16x16x32_bf16 v[60:63],a[216:219],a[168:171],0
ds_read_b64_tr_b16 a[252:253],v6 offset:12288
ds_read_b64_tr_b16 a[254:255],v6 offset:18432
v_mfma_f32_16x16x32_bf16 v[60:63],a[220:223],a[172:175],v[60:63]
v_mfma_f32_16x16x32_bf16 v[60:63],a[224:227],a[176:179],v[60:63]
v_mfma_f32_16x16x32_bf16 v[60:63],a[228:231],a[180:183],v[60:63]
v_mfma_f32_16x16x32_bf16 v[60:63],a[232:235],a[184:187],v[60:63]
v_mfma_f32_16x16x32_bf16 v[60:63],a[236:239],a[188:191],v[60:63]
s_waitcnt lgkmcnt(4)
v_mfma_f32_16x16x32_bf16 v[160:163],a[240:243],v[112:115],v[160:163]
s_add_u32 m0,s23,0
ds_read_b128 a[192:195],v1 offset:0
v_fma_f32 v36,v36,s36,v16
v_mfma_f32_16x16x32_bf16 v[208:211],a[240:243],v[116:119],v[208:211]
buffer_load_dwordx4 v7,s[8:11],s21 offen offset:0 lds
v_mfma_f32_16x16x32_bf16 a[0:3],a[240:243],v[120:123],a[0:3]
s_add_u32 m0,s23,896
ds_read_b128 a[196:199],v2 offset:0
v_fma_f32 v37,v37,s36,v16
v_mfma_f32_16x16x32_bf16 a[48:51],a[240:243],v[124:127],a[48:51]
ds_read_b64_tr_b16 a[240:241],v3 offset:13312
ds_read_b64_tr_b16 a[242:243],v3 offset:19456
v_mfma_f32_16x16x32_bf16 v[164:167],a[244:247],v[112:115],v[164:167]
ds_read_b128 a[200:203],v1 offset:1024
v_fma_f32 v38,v38,s36,v16
v_mfma_f32_16x16x32_bf16 v[212:215],a[244:247],v[116:119],v[212:215]
ds_read_b128 a[204:207],v2 offset:1024
v_fma_f32 v39,v39,s36,v16
v_mfma_f32_16x16x32_bf16 a[4:7],a[244:247],v[120:123],a[4:7]
ds_read_b128 a[208:211],v1 offset:2048
v_fma_f32 v44,v44,s36,v17
v_mfma_f32_16x16x32_bf16 a[52:55],a[244:247],v[124:127],a[52:55]
s_waitcnt lgkmcnt(7)
ds_read_b64_tr_b16 a[244:245],v4 offset:13312
ds_read_b64_tr_b16 a[246:247],v4 offset:19456
v_mfma_f32_16x16x32_bf16 v[168:171],a[248:251],v[112:115],v[168:171]
ds_read_b128 a[212:215],v2 offset:2048
v_fma_f32 v45,v45,s36,v17
v_mfma_f32_16x16x32_bf16 v[216:219],a[248:251],v[116:119],v[216:219]
buffer_load_dwordx4 v7,s[8:11],s21 offen offset:128 lds
v_mfma_f32_16x16x32_bf16 a[8:11],a[248:251],v[120:123],a[8:11]
s_add_u32 m0,s23,1792
ds_read_b128 a[216:219],v1 offset:6144
v_fma_f32 v46,v46,s36,v17
v_mfma_f32_16x16x32_bf16 a[56:59],a[248:251],v[124:127],a[56:59]
ds_read_b64_tr_b16 a[248:249],v5 offset:13312
ds_read_b64_tr_b16 a[250:251],v5 offset:19456
v_mfma_f32_16x16x32_bf16 v[172:175],a[252:255],v[112:115],v[172:175]
ds_read_b128 a[220:223],v2 offset:6144
v_fma_f32 v47,v47,s36,v17
v_mfma_f32_16x16x32_bf16 v[220:223],a[252:255],v[116:119],v[220:223]
ds_read_b128 a[224:227],v1 offset:7168
v_fma_f32 v48,v48,s36,v18
v_mfma_f32_16x16x32_bf16 a[12:15],a[252:255],v[120:123],a[12:15]
ds_read_b128 a[228:231],v2 offset:7168
v_fma_f32 v49,v49,s36,v18
v_mfma_f32_16x16x32_bf16 a[60:63],a[252:255],v[124:127],a[60:63]
s_waitcnt lgkmcnt(7)
ds_read_b64_tr_b16 a[252:253],v6 offset:13312
ds_read_b64_tr_b16 a[254:255],v6 offset:19456
v_mfma_f32_16x16x32_bf16 v[176:179],a[240:243],v[112:115],v[176:179]
ds_read_b128 a[232:235],v1 offset:8192
v_fma_f32 v50,v50,s36,v18
v_mfma_f32_16x16x32_bf16 v[224:227],a[240:243],v[116:119],v[224:227]
buffer_load_dwordx4 v7,s[8:11],s21 offen offset:256 lds
v_mfma_f32_16x16x32_bf16 a[16:19],a[240:243],v[120:123],a[16:19]
s_add_u32 s21,s21,12288
ds_read_b128 a[236:239],v2 offset:8192
v_fma_f32 v51,v51,s36,v18
v_mfma_f32_16x16x32_bf16 a[64:67],a[240:243],v[124:127],a[64:67]
s_add_u32 m0,s22,24576
ds_read_b64_tr_b16 a[240:241],v3 offset:14336
ds_read_b64_tr_b16 a[242:243],v3 offset:20480
v_mfma_f32_16x16x32_bf16 v[180:183],a[244:247],v[112:115],v[180:183]
v_fma_f32 v52,v52,s36,v18
v_fma_f32 v53,v53,s36,v18
v_mfma_f32_16x16x32_bf16 v[228:231],a[244:247],v[116:119],v[228:231]
v_fma_f32 v54,v54,s36,v18
v_fma_f32 v55,v55,s36,v18
v_mfma_f32_16x16x32_bf16 a[20:23],a[244:247],v[120:123],a[20:23]
v_fma_f32 v56,v56,s36,v19
v_fma_f32 v57,v57,s36,v19
v_mfma_f32_16x16x32_bf16 a[68:71],a[244:247],v[124:127],a[68:71]
s_waitcnt lgkmcnt(4)
ds_read_b64_tr_b16 a[244:245],v4 offset:14336
ds_read_b64_tr_b16 a[246:247],v4 offset:20480
v_mfma_f32_16x16x32_bf16 v[184:187],a[248:251],v[112:115],v[184:187]
buffer_load_dwordx4 v7,s[4:7],s20 offen offset:0 lds
v_mfma_f32_16x16x32_bf16 v[232:235],a[248:251],v[116:119],v[232:235]
s_add_u32 m0,s22,25472
v_fma_f32 v58,v58,s36,v19
v_fma_f32 v59,v59,s36,v19
v_mfma_f32_16x16x32_bf16 a[24:27],a[248:251],v[120:123],a[24:27]
v_fma_f32 v60,v60,s36,v19
v_fma_f32 v61,v61,s36,v19
v_mfma_f32_16x16x32_bf16 a[72:75],a[248:251],v[124:127],a[72:75]
ds_read_b64_tr_b16 a[248:249],v5 offset:14336
ds_read_b64_tr_b16 a[250:251],v5 offset:20480
v_mfma_f32_16x16x32_bf16 v[188:191],a[252:255],v[112:115],v[188:191]
v_fma_f32 v62,v62,s36,v19
v_fma_f32 v63,v63,s36,v19
v_mfma_f32_16x16x32_bf16 v[236:239],a[252:255],v[116:119],v[236:239]
v_exp_f32 v36,v36
v_mfma_f32_16x16x32_bf16 a[28:31],a[252:255],v[120:123],a[28:31]
v_exp_f32 v37,v37
v_mfma_f32_16x16x32_bf16 a[76:79],a[252:255],v[124:127],a[76:79]
s_waitcnt lgkmcnt(2)
ds_read_b64_tr_b16 a[252:253],v6 offset:14336
ds_read_b64_tr_b16 a[254:255],v6 offset:20480
v_mfma_f32_16x16x32_bf16 v[192:195],a[240:243],v[112:115],v[192:195]
buffer_load_dwordx4 v7,s[4:7],s20 offen offset:128 lds
v_mfma_f32_16x16x32_bf16 v[240:243],a[240:243],v[116:119],v[240:243]
s_add_u32 m0,s22,26368
v_exp_f32 v38,v38
v_mfma_f32_16x16x32_bf16 a[32:35],a[240:243],v[120:123],a[32:35]
v_exp_f32 v39,v39
v_mfma_f32_16x16x32_bf16 a[80:83],a[240:243],v[124:127],a[80:83]
v_exp_f32 v44,v44
v_mfma_f32_16x16x32_bf16 v[196:199],a[244:247],v[112:115],v[196:199]
v_exp_f32 v45,v45
v_mfma_f32_16x16x32_bf16 v[244:247],a[244:247],v[116:119],v[244:247]
v_exp_f32 v46,v46
v_mfma_f32_16x16x32_bf16 a[36:39],a[244:247],v[120:123],a[36:39]
v_exp_f32 v47,v47
v_mfma_f32_16x16x32_bf16 a[84:87],a[244:247],v[124:127],a[84:87]
s_waitcnt lgkmcnt(0)
v_exp_f32 v48,v48
v_mfma_f32_16x16x32_bf16 v[200:203],a[248:251],v[112:115],v[200:203]
buffer_load_dwordx4 v7,s[4:7],s20 offen offset:256 lds
v_mfma_f32_16x16x32_bf16 v[248:251],a[248:251],v[116:119],v[248:251]
s_add_u32 s20,s20,12288
v_exp_f32 v49,v49
v_mfma_f32_16x16x32_bf16 a[40:43],a[248:251],v[120:123],a[40:43]
v_exp_f32 v50,v50
v_mfma_f32_16x16x32_bf16 a[88:91],a[248:251],v[124:127],a[88:91]
v_exp_f32 v51,v51
v_mfma_f32_16x16x32_bf16 v[204:207],a[252:255],v[112:115],v[204:207]
v_exp_f32 v52,v52
v_mfma_f32_16x16x32_bf16 v[252:255],a[252:255],v[116:119],v[252:255]
v_exp_f32 v53,v53
v_mfma_f32_16x16x32_bf16 a[44:47],a[252:255],v[120:123],a[44:47]
v_exp_f32 v54,v54
v_mfma_f32_16x16x32_bf16 a[92:95],a[252:255],v[124:127],a[92:95]
v_exp_f32 v55,v55
v_mfma_f32_16x16x32_bf16 v[64:67],a[192:195],a[96:99],0
v_exp_f32 v56,v56
v_mfma_f32_16x16x32_bf16 v[64:67],a[196:199],a[100:103],v[64:67]
v_exp_f32 v57,v57
v_mfma_f32_16x16x32_bf16 v[64:67],a[200:203],a[104:107],v[64:67]
v_exp_f32 v58,v58
v_mfma_f32_16x16x32_bf16 v[64:67],a[204:207],a[108:111],v[64:67]
v_exp_f32 v59,v59
v_mfma_f32_16x16x32_bf16 v[64:67],a[208:211],a[112:115],v[64:67]
v_exp_f32 v60,v60
v_mfma_f32_16x16x32_bf16 v[64:67],a[212:215],a[116:119],v[64:67]
v_exp_f32 v61,v61
v_mfma_f32_16x16x32_bf16 v[72:75],a[192:195],a[120:123],0
v_exp_f32 v62,v62
v_mfma_f32_16x16x32_bf16 v[72:75],a[196:199],a[124:127],v[72:75]
v_exp_f32 v63,v63
v_mfma_f32_16x16x32_bf16 v[72:75],a[200:203],a[128:131],v[72:75]
v_cvt_pk_bf16_f32 v98,v36,v37
v_cvt_pk_bf16_f32 v99,v38,v39
v_mfma_f32_16x16x32_bf16 v[72:75],a[204:207],a[132:135],v[72:75]
v_cvt_pk_bf16_f32 v102,v44,v45
v_cvt_pk_bf16_f32 v103,v46,v47
v_mfma_f32_16x16x32_bf16 v[128:131],v[24:27],v[96:99],v[128:131]
v_cvt_pk_bf16_f32 v104,v48,v49
v_cvt_pk_bf16_f32 v105,v50,v51
v_mfma_f32_16x16x32_bf16 v[132:135],v[24:27],v[100:103],v[132:135]
v_cvt_pk_bf16_f32 v106,v52,v53
v_cvt_pk_bf16_f32 v107,v54,v55
v_mfma_f32_16x16x32_bf16 v[72:75],a[208:211],a[136:139],v[72:75]
v_cvt_pk_bf16_f32 v108,v56,v57
v_cvt_pk_bf16_f32 v109,v58,v59
v_mfma_f32_16x16x32_bf16 v[136:139],v[24:27],v[104:107],v[136:139]
v_cvt_pk_bf16_f32 v110,v60,v61
v_cvt_pk_bf16_f32 v111,v62,v63
v_mfma_f32_16x16x32_bf16 v[72:75],a[212:215],a[140:143],v[72:75]
v_fma_f32 v64,v64,s36,v16
v_fma_f32 v65,v65,s36,v16
v_mfma_f32_16x16x32_bf16 v[140:143],v[24:27],v[108:111],v[140:143]
v_fma_f32 v66,v66,s36,v16
v_fma_f32 v67,v67,s36,v16
v_mfma_f32_16x16x32_bf16 v[80:83],a[192:195],a[144:147],0
v_exp_f32 v64,v64
v_mfma_f32_16x16x32_bf16 v[80:83],a[196:199],a[148:151],v[80:83]
v_fma_f32 v72,v72,s36,v17
v_fma_f32 v73,v73,s36,v17
v_mfma_f32_16x16x32_bf16 v[80:83],a[200:203],a[152:155],v[80:83]
v_fma_f32 v74,v74,s36,v17
v_fma_f32 v75,v75,s36,v17
v_mfma_f32_16x16x32_bf16 v[80:83],a[204:207],a[156:159],v[80:83]
v_exp_f32 v65,v65
v_mfma_f32_16x16x32_bf16 v[80:83],a[208:211],a[160:163],v[80:83]
v_exp_f32 v66,v66
v_mfma_f32_16x16x32_bf16 v[80:83],a[212:215],a[164:167],v[80:83]
v_exp_f32 v67,v67
v_mfma_f32_16x16x32_bf16 v[88:91],a[192:195],a[168:171],0
v_exp_f32 v72,v72
v_mfma_f32_16x16x32_bf16 v[88:91],a[196:199],a[172:175],v[88:91]
v_exp_f32 v73,v73
v_mfma_f32_16x16x32_bf16 v[88:91],a[200:203],a[176:179],v[88:91]
v_exp_f32 v74,v74
v_mfma_f32_16x16x32_bf16 v[88:91],a[204:207],a[180:183],v[88:91]
v_exp_f32 v75,v75
v_mfma_f32_16x16x32_bf16 v[88:91],a[208:211],a[184:187],v[88:91]
v_cvt_pk_bf16_f32 v112,v64,v65
v_cvt_pk_bf16_f32 v113,v66,v67
v_mfma_f32_16x16x32_bf16 v[88:91],a[212:215],a[188:191],v[88:91]
v_cvt_pk_bf16_f32 v116,v72,v73
v_cvt_pk_bf16_f32 v117,v74,v75
v_mfma_f32_16x16x32_bf16 v[68:71],a[216:219],a[96:99],0
v_mfma_f32_16x16x32_bf16 v[68:71],a[220:223],a[100:103],v[68:71]
v_mfma_f32_16x16x32_bf16 v[68:71],a[224:227],a[104:107],v[68:71]
v_mfma_f32_16x16x32_bf16 v[68:71],a[228:231],a[108:111],v[68:71]
v_mfma_f32_16x16x32_bf16 v[68:71],a[232:235],a[112:115],v[68:71]
v_mfma_f32_16x16x32_bf16 v[68:71],a[236:239],a[116:119],v[68:71]
v_mfma_f32_16x16x32_bf16 v[76:79],a[216:219],a[120:123],0
v_mfma_f32_16x16x32_bf16 v[76:79],a[220:223],a[124:127],v[76:79]
v_mfma_f32_16x16x32_bf16 v[76:79],a[224:227],a[128:131],v[76:79]
v_mfma_f32_16x16x32_bf16 v[76:79],a[228:231],a[132:135],v[76:79]
v_mfma_f32_16x16x32_bf16 v[76:79],a[232:235],a[136:139],v[76:79]
s_waitcnt vmcnt(6)
s_barrier
v_mfma_f32_16x16x32_bf16 v[76:79],a[236:239],a[140:143],v[76:79]
v_mfma_f32_16x16x32_bf16 v[84:87],a[216:219],a[144:147],0
ds_read_b64_tr_b16 a[240:241],v3 offset:24576
ds_read_b64_tr_b16 a[242:243],v3 offset:30720
v_mfma_f32_16x16x32_bf16 v[84:87],a[220:223],a[148:151],v[84:87]
v_mfma_f32_16x16x32_bf16 v[84:87],a[224:227],a[152:155],v[84:87]
ds_read_b64_tr_b16 a[244:245],v4 offset:24576
ds_read_b64_tr_b16 a[246:247],v4 offset:30720
v_mfma_f32_16x16x32_bf16 v[84:87],a[228:231],a[156:159],v[84:87]
v_mfma_f32_16x16x32_bf16 v[84:87],a[232:235],a[160:163],v[84:87]
ds_read_b64_tr_b16 a[248:249],v5 offset:24576
ds_read_b64_tr_b16 a[250:251],v5 offset:30720
v_mfma_f32_16x16x32_bf16 v[84:87],a[236:239],a[164:167],v[84:87]
v_mfma_f32_16x16x32_bf16 v[92:95],a[216:219],a[168:171],0
ds_read_b64_tr_b16 a[252:253],v6 offset:24576
ds_read_b64_tr_b16 a[254:255],v6 offset:30720
v_mfma_f32_16x16x32_bf16 v[92:95],a[220:223],a[172:175],v[92:95]
v_mfma_f32_16x16x32_bf16 v[92:95],a[224:227],a[176:179],v[92:95]
v_mfma_f32_16x16x32_bf16 v[92:95],a[228:231],a[180:183],v[92:95]
v_mfma_f32_16x16x32_bf16 v[92:95],a[232:235],a[184:187],v[92:95]
v_mfma_f32_16x16x32_bf16 v[92:95],a[236:239],a[188:191],v[92:95]
s_mov_b32 s38,0
s_branch L_loop4
L_tr33:
s_waitcnt vmcnt(36)
s_waitcnt lgkmcnt(4)
v_mfma_f32_16x16x32_bf16 v[160:163],a[240:243],v[96:99],v[160:163]
ds_read_b128 a[96:99],v28 offset:0
v_fma_f32 v68,v68,s36,v16
v_mfma_f32_16x16x32_bf16 v[208:211],a[240:243],v[100:103],v[208:211]
ds_read_b128 a[100:103],v29 offset:0
v_fma_f32 v69,v69,s36,v16
v_mfma_f32_16x16x32_bf16 a[0:3],a[240:243],v[104:107],a[0:3]
ds_read_b128 a[104:107],v28 offset:1024
v_fma_f32 v70,v70,s36,v16
v_mfma_f32_16x16x32_bf16 v[164:167],a[244:247],v[96:99],v[164:167]
ds_read_b128 a[108:111],v29 offset:1024
v_fma_f32 v71,v71,s36,v16
v_mfma_f32_16x16x32_bf16 v[212:215],a[244:247],v[100:103],v[212:215]
ds_read_b128 a[112:115],v28 offset:2048
v_fma_f32 v76,v76,s36,v17
v_mfma_f32_16x16x32_bf16 a[4:7],a[244:247],v[104:107],a[4:7]
s_waitcnt lgkmcnt(5)
ds_read_b128 a[116:119],v29 offset:2048
v_fma_f32 v77,v77,s36,v17
v_mfma_f32_16x16x32_bf16 v[168:171],a[248:251],v[96:99],v[168:171]
ds_read_b64_tr_b16 a[240:241],v3 offset:25600
ds_read_b64_tr_b16 a[242:243],v3 offset:31744
v_mfma_f32_16x16x32_bf16 v[216:219],a[248:251],v[100:103],v[216:219]
ds_read_b64_tr_b16 a[244:245],v4 offset:25600
ds_read_b64_tr_b16 a[246:247],v4 offset:31744
v_mfma_f32_16x16x32_bf16 a[8:11],a[248:251],v[104:107],a[8:11]
ds_read_b64_tr_b16 a[248:249],v5 offset:25600
ds_read_b64_tr_b16 a[250:251],v5 offset:31744
v_mfma_f32_16x16x32_bf16 v[172:175],a[252:255],v[96:99],v[172:175]
ds_read_b128 a[192:195],v13 offset:0
v_fma_f32 v78,v78,s36,v17
v_mfma_f32_16x16x32_bf16 v[220:223],a[252:255],v[100:103],v[220:223]
ds_read_b128 a[196:199],v14 offset:0
v_fma_f32 v79,v79,s36,v17
v_mfma_f32_16x16x32_bf16 a[12:15],a[252:255],v[104:107],a[12:15]
ds_read_b64_tr_b16 a[252:253],v6 offset:25600
ds_read_b64_tr_b16 a[254:255],v6 offset:31744
ds_read_b128 a[200:203],v13 offset:1024
v_fma_f32 v80,v80,s36,v18
v_fma_f32 v81,v81,s36,v18
v_fma_f32 v82,v82,s36,v18
v_fma_f32 v83,v83,s36,v18
v_fma_f32 v84,v84,s36,v18
v_fma_f32 v85,v85,s36,v18
v_fma_f32 v86,v86,s36,v18
v_fma_f32 v87,v87,s36,v18
v_exp_f32 v68,v68
v_exp_f32 v69,v69
v_exp_f32 v70,v70
s_waitcnt lgkmcnt(9)
v_mfma_f32_16x16x32_bf16 v[176:179],a[240:243],v[96:99],v[176:179]
ds_read_b128 a[204:207],v14 offset:1024
v_exp_f32 v71,v71
v_mfma_f32_16x16x32_bf16 v[224:227],a[240:243],v[100:103],v[224:227]
ds_read_b128 a[208:211],v13 offset:2048
v_exp_f32 v76,v76
v_mfma_f32_16x16x32_bf16 a[16:19],a[240:243],v[104:107],a[16:19]
s_waitcnt lgkmcnt(5)
ds_read_b64_tr_b16 a[240:241],v3 offset:26624
ds_read_b64_tr_b16 a[242:243],v3 offset:32768
v_mfma_f32_16x16x32_bf16 v[180:183],a[244:247],v[96:99],v[180:183]
ds_read_b128 a[212:215],v14 offset:2048
v_exp_f32 v77,v77
v_mfma_f32_16x16x32_bf16 v[228:231],a[244:247],v[100:103],v[228:231]
ds_read_b128 a[216:219],v13 offset:45056
v_exp_f32 v78,v78
v_mfma_f32_16x16x32_bf16 a[20:23],a[244:247],v[104:107],a[20:23]
ds_read_b64_tr_b16 a[244:245],v4 offset:26624
ds_read_b64_tr_b16 a[246:247],v4 offset:32768
v_mfma_f32_16x16x32_bf16 v[184:187],a[248:251],v[96:99],v[184:187]
ds_read_b128 a[220:223],v14 offset:45056
v_exp_f32 v79,v79
v_mfma_f32_16x16x32_bf16 v[232:235],a[248:251],v[100:103],v[232:235]
ds_read_b128 a[224:227],v13 offset:46080
v_exp_f32 v80,v80
v_mfma_f32_16x16x32_bf16 a[24:27],a[248:251],v[104:107],a[24:27]
s_waitcnt lgkmcnt(8)
ds_read_b64_tr_b16 a[248:249],v5 offset:26624
ds_read_b64_tr_b16 a[250:251],v5 offset:32768
v_mfma_f32_16x16x32_bf16 v[188:191],a[252:255],v[96:99],v[188:191]
ds_read_b128 a[228:231],v14 offset:46080
v_exp_f32 v81,v81
v_mfma_f32_16x16x32_bf16 v[236:239],a[252:255],v[100:103],v[236:239]
ds_read_b128 a[232:235],v13 offset:47104
v_exp_f32 v82,v82
v_mfma_f32_16x16x32_bf16 a[28:31],a[252:255],v[104:107],a[28:31]
s_waitcnt lgkmcnt(8)
ds_read_b64_tr_b16 a[252:253],v6 offset:26624
ds_read_b64_tr_b16 a[254:255],v6 offset:32768
v_mfma_f32_16x16x32_bf16 v[192:195],a[240:243],v[96:99],v[192:195]
ds_read_b128 a[236:239],v14 offset:47104
v_exp_f32 v83,v83
v_mfma_f32_16x16x32_bf16 v[240:243],a[240:243],v[100:103],v[240:243]
ds_read_b128 a[120:123],v28 offset:6144
v_exp_f32 v84,v84
v_mfma_f32_16x16x32_bf16 a[32:35],a[240:243],v[104:107],a[32:35]
s_waitcnt lgkmcnt(8)
ds_read_b128 a[124:127],v29 offset:6144
v_exp_f32 v85,v85
v_mfma_f32_16x16x32_bf16 v[196:199],a[244:247],v[96:99],v[196:199]
ds_read_b128 a[128:131],v28 offset:7168
v_exp_f32 v86,v86
v_mfma_f32_16x16x32_bf16 v[244:247],a[244:247],v[100:103],v[244:247]
ds_read_b128 a[132:135],v29 offset:7168
v_exp_f32 v87,v87
s_waitcnt vmcnt(5)
v_mfma_f32_16x16x32_bf16 a[36:39],a[244:247],v[104:107],a[36:39]
s_waitcnt lgkmcnt(7)
ds_read_b128 a[136:139],v28 offset:8192
v_cvt_pk_bf16_f32 v114,v68,v69
v_mfma_f32_16x16x32_bf16 v[200:203],a[248:251],v[96:99],v[200:203]
ds_read_b128 a[140:143],v29 offset:8192
v_cvt_pk_bf16_f32 v115,v70,v71
v_mfma_f32_16x16x32_bf16 v[248:251],a[248:251],v[100:103],v[248:251]
s_waitcnt lgkmcnt(6)
v_cvt_pk_bf16_f32 v118,v76,v77
v_cvt_pk_bf16_f32 v119,v78,v79
s_barrier
v_mfma_f32_16x16x32_bf16 v[128:131],v[24:27],v[112:115],v[128:131]
v_cvt_pk_bf16_f32 v120,v80,v81
v_cvt_pk_bf16_f32 v121,v82,v83
v_mfma_f32_16x16x32_bf16 v[132:135],v[24:27],v[116:119],v[132:135]
v_cvt_pk_bf16_f32 v122,v84,v85
v_cvt_pk_bf16_f32 v123,v86,v87
v_mfma_f32_16x16x32_bf16 a[40:43],a[248:251],v[104:107],a[40:43]
ds_read_b64_tr_b16 a[240:241],v3 offset:0
ds_read_b64_tr_b16 a[242:243],v3 offset:6144
v_mfma_f32_16x16x32_bf16 v[136:139],v[24:27],v[120:123],v[136:139]
ds_read_b64_tr_b16 a[244:245],v4 offset:0
ds_read_b64_tr_b16 a[246:247],v4 offset:6144
v_mfma_f32_16x16x32_bf16 v[204:207],a[252:255],v[96:99],v[204:207]
v_mfma_f32_16x16x32_bf16 v[252:255],a[252:255],v[100:103],v[252:255]
ds_read_b64_tr_b16 a[248:249],v5 offset:0
ds_read_b64_tr_b16 a[250:251],v5 offset:6144
v_mfma_f32_16x16x32_bf16 a[44:47],a[252:255],v[104:107],a[44:47]
s_waitcnt lgkmcnt(4)
ds_read_b64_tr_b16 a[252:253],v6 offset:0
ds_read_b64_tr_b16 a[254:255],v6 offset:6144
v_mfma_f32_16x16x32_bf16 v[160:163],a[240:243],v[112:115],v[160:163]
v_rcp_f32 v144,v128
v_mfma_f32_16x16x32_bf16 v[208:211],a[240:243],v[116:119],v[208:211]
v_rcp_f32 v146,v132
v_mfma_f32_16x16x32_bf16 a[0:3],a[240:243],v[120:123],a[0:3]
s_waitcnt lgkmcnt(4)
ds_read_b64_tr_b16 a[240:241],v3 offset:1024
ds_read_b64_tr_b16 a[242:243],v3 offset:7168
v_mfma_f32_16x16x32_bf16 v[164:167],a[244:247],v[112:115],v[164:167]
v_rcp_f32 v148,v136
v_mfma_f32_16x16x32_bf16 v[212:215],a[244:247],v[116:119],v[212:215]
v_max3_f32 v30,v128,v132,v136
v_cmp_nlt_f32 vcc,v30,v31
v_mfma_f32_16x16x32_bf16 a[4:7],a[244:247],v[120:123],a[4:7]
s_waitcnt lgkmcnt(4)
ds_read_b64_tr_b16 a[244:245],v4 offset:1024
ds_read_b64_tr_b16 a[246:247],v4 offset:7168
v_mfma_f32_16x16x32_bf16 v[168:171],a[248:251],v[112:115],v[168:171]
s_cmp_lg_u64 vcc,0
v_accvgpr_read_b32 v64,a0
v_accvgpr_read_b32 v65,a1
v_mfma_f32_16x16x32_bf16 v[216:219],a[248:251],v[116:119],v[216:219]
s_cselect_b32 s62,s32,0
v_accvgpr_read_b32 v66,a2
v_accvgpr_read_b32 v67,a3
v_accvgpr_read_b32 v72,a4
v_accvgpr_read_b32 v73,a5
v_accvgpr_read_b32 v74,a6
v_pk_mul_f32 v[160:161],v[160:161],v[144:145] op_sel_hi:[1,0]
v_pk_mul_f32 v[162:163],v[162:163],v[144:145] op_sel_hi:[1,0]
v_pk_mul_f32 v[208:209],v[208:209],v[146:147] op_sel_hi:[1,0]
v_pk_mul_f32 v[210:211],v[210:211],v[146:147] op_sel_hi:[1,0]
v_accvgpr_read_b32 v75,a7
v_cvt_pk_bf16_f32 v80,v160,v161
v_mfma_f32_16x16x32_bf16 a[8:11],a[248:251],v[120:123],a[8:11]
s_or_b32 s31,s31,s62
ds_read_b64_tr_b16 a[248:249],v5 offset:1024
ds_read_b64_tr_b16 a[250:251],v5 offset:7168
s_waitcnt lgkmcnt(4)
v_mfma_f32_16x16x32_bf16 v[172:175],a[252:255],v[112:115],v[172:175]
s_lshl_b32 s32,s32,1
v_cvt_pk_bf16_f32 v81,v162,v163
v_cvt_pk_bf16_f32 v82,v208,v209
v_mfma_f32_16x16x32_bf16 v[220:223],a[252:255],v[116:119],v[220:223]
s_add_u32 m0,s22,24576
v_cvt_pk_bf16_f32 v83,v210,v211
v_subrev_u32 v11,18432,v11
buffer_load_dwordx4 v7,s[4:7],s20 offen offset:0 lds
s_add_u32 m0,s22,25472
v_pk_mul_f32 v[164:165],v[164:165],v[144:145] op_sel_hi:[1,0]
v_pk_mul_f32 v[166:167],v[166:167],v[144:145] op_sel_hi:[1,0]
v_pk_mul_f32 v[212:213],v[212:213],v[146:147] op_sel_hi:[1,0]
v_pk_mul_f32 v[214:215],v[214:215],v[146:147] op_sel_hi:[1,0]
v_cvt_pk_bf16_f32 v84,v164,v165
v_cvt_pk_bf16_f32 v85,v166,v167
v_mfma_f32_16x16x32_bf16 a[12:15],a[252:255],v[120:123],a[12:15]
ds_read_b64_tr_b16 a[252:253],v6 offset:1024
ds_read_b64_tr_b16 a[254:255],v6 offset:7168
v_mfma_f32_16x16x32_bf16 v[176:179],a[240:243],v[112:115],v[176:179]
ds_write2st64_b64 v12,v[80:81],v[82:83] offset0:0 offset1:12
v_mfma_f32_16x16x32_bf16 v[224:227],a[240:243],v[116:119],v[224:227]
v_cvt_pk_bf16_f32 v86,v212,v213
v_cvt_pk_bf16_f32 v87,v214,v215
v_mfma_f32_16x16x32_bf16 a[16:19],a[240:243],v[120:123],a[16:19]
ds_read_b64_tr_b16 a[240:241],v3 offset:2048
ds_read_b64_tr_b16 a[242:243],v3 offset:8192
ds_write2st64_b64 v20,v[84:85],v[86:87] offset0:0 offset1:12
v_pk_mul_f32 v[168:169],v[168:169],v[144:145] op_sel_hi:[1,0]
v_pk_mul_f32 v[170:171],v[170:171],v[144:145] op_sel_hi:[1,0]
v_pk_mul_f32 v[216:217],v[216:217],v[146:147] op_sel_hi:[1,0]
v_pk_mul_f32 v[218:219],v[218:219],v[146:147] op_sel_hi:[1,0]
v_cvt_pk_bf16_f32 v88,v168,v169
v_accvgpr_read_b32 v68,a16
s_waitcnt lgkmcnt(6)
v_mfma_f32_16x16x32_bf16 v[180:183],a[244:247],v[112:115],v[180:183]
v_accvgpr_read_b32 v69,a17
v_accvgpr_read_b32 v70,a18
v_mfma_f32_16x16x32_bf16 v[228:231],a[244:247],v[116:119],v[228:231]
buffer_load_dwordx4 v7,s[4:7],s20 offen offset:128 lds
s_add_u32 m0,s22,26368
v_mfma_f32_16x16x32_bf16 a[20:23],a[244:247],v[120:123],a[20:23]
ds_read_b64_tr_b16 a[244:245],v4 offset:2048
ds_read_b64_tr_b16 a[246:247],v4 offset:8192
v_accvgpr_read_b32 v71,a19
v_cvt_pk_bf16_f32 v89,v170,v171
v_cvt_pk_bf16_f32 v90,v216,v217
v_pk_mul_f32 v[172:173],v[172:173],v[144:145] op_sel_hi:[1,0]
v_pk_mul_f32 v[174:175],v[174:175],v[144:145] op_sel_hi:[1,0]
v_pk_mul_f32 v[220:221],v[220:221],v[146:147] op_sel_hi:[1,0]
v_pk_mul_f32 v[222:223],v[222:223],v[146:147] op_sel_hi:[1,0]
v_accvgpr_read_b32 v76,a20
v_accvgpr_read_b32 v77,a21
v_mfma_f32_16x16x32_bf16 v[184:187],a[248:251],v[112:115],v[184:187]
v_accvgpr_read_b32 v78,a22
v_accvgpr_read_b32 v79,a23
v_mfma_f32_16x16x32_bf16 v[232:235],a[248:251],v[116:119],v[232:235]
v_cvt_pk_bf16_f32 v91,v218,v219
v_cvt_pk_bf16_f32 v92,v172,v173
v_mfma_f32_16x16x32_bf16 a[24:27],a[248:251],v[120:123],a[24:27]
ds_read_b64_tr_b16 a[248:249],v5 offset:2048
ds_read_b64_tr_b16 a[250:251],v5 offset:8192
ds_write2st64_b64 v21,v[88:89],v[90:91] offset0:0 offset1:12
v_pk_mul_f32 v[176:177],v[176:177],v[144:145] op_sel_hi:[1,0]
v_pk_mul_f32 v[178:179],v[178:179],v[144:145] op_sel_hi:[1,0]
v_pk_mul_f32 v[224:225],v[224:225],v[146:147] op_sel_hi:[1,0]
v_pk_mul_f32 v[226:227],v[226:227],v[146:147] op_sel_hi:[1,0]
v_cvt_pk_bf16_f32 v93,v174,v175
v_cvt_pk_bf16_f32 v94,v220,v221
s_waitcnt lgkmcnt(5)
v_mfma_f32_16x16x32_bf16 v[188:191],a[252:255],v[112:115],v[188:191]
v_cvt_pk_bf16_f32 v95,v222,v223
v_cvt_pk_bf16_f32 v80,v176,v177
v_mfma_f32_16x16x32_bf16 v[236:239],a[252:255],v[116:119],v[236:239]
ds_write2st64_b64 v22,v[92:93],v[94:95] offset0:0 offset1:12
v_mfma_f32_16x16x32_bf16 a[28:31],a[252:255],v[120:123],a[28:31]
v_cvt_pk_bf16_f32 v81,v178,v179
v_cvt_pk_bf16_f32 v82,v224,v225
v_mfma_f32_16x16x32_bf16 v[192:195],a[240:243],v[112:115],v[192:195]
v_cvt_pk_bf16_f32 v83,v226,v227
ds_read_b64_tr_b16 a[252:253],v6 offset:2048
ds_read_b64_tr_b16 a[254:255],v6 offset:8192
ds_write2st64_b64 v12,v[80:81],v[82:83] offset0:2 offset1:14
v_pk_mul_f32 v[180:181],v[180:181],v[144:145] op_sel_hi:[1,0]
v_pk_mul_f32 v[182:183],v[182:183],v[144:145] op_sel_hi:[1,0]
v_pk_mul_f32 v[228:229],v[228:229],v[146:147] op_sel_hi:[1,0]
v_pk_mul_f32 v[230:231],v[230:231],v[146:147] op_sel_hi:[1,0]
v_cvt_pk_bf16_f32 v84,v180,v181
v_cvt_pk_bf16_f32 v85,v182,v183
v_mfma_f32_16x16x32_bf16 v[240:243],a[240:243],v[116:119],v[240:243]
buffer_load_dwordx4 v7,s[4:7],s20 offen offset:256 lds
s_add_u32 s20,s20,12288
s_add_u32 m0,s23,0
v_mfma_f32_16x16x32_bf16 a[32:35],a[240:243],v[120:123],a[32:35]
s_waitcnt lgkmcnt(3)
v_cvt_pk_bf16_f32 v86,v228,v229
v_cvt_pk_bf16_f32 v87,v230,v231
v_mfma_f32_16x16x32_bf16 v[196:199],a[244:247],v[112:115],v[196:199]
ds_write2st64_b64 v20,v[84:85],v[86:87] offset0:2 offset1:14
v_pk_mul_f32 v[184:185],v[184:185],v[144:145] op_sel_hi:[1,0]
v_pk_mul_f32 v[186:187],v[186:187],v[144:145] op_sel_hi:[1,0]
v_pk_mul_f32 v[232:233],v[232:233],v[146:147] op_sel_hi:[1,0]
v_pk_mul_f32 v[234:235],v[234:235],v[146:147] op_sel_hi:[1,0]
v_cvt_pk_bf16_f32 v88,v184,v185
v_cvt_pk_bf16_f32 v89,v186,v187
v_mfma_f32_16x16x32_bf16 v[244:247],a[244:247],v[116:119],v[244:247]
v_cvt_pk_bf16_f32 v90,v232,v233
v_cvt_pk_bf16_f32 v91,v234,v235
v_mfma_f32_16x16x32_bf16 a[36:39],a[244:247],v[120:123],a[36:39]
ds_write2st64_b64 v21,v[88:89],v[90:91] offset0:2 offset1:14
v_mfma_f32_16x16x32_bf16 v[200:203],a[248:251],v[112:115],v[200:203]
v_mfma_f32_16x16x32_bf16 v[248:251],a[248:251],v[116:119],v[248:251]
v_pk_mul_f32 v[188:189],v[188:189],v[144:145] op_sel_hi:[1,0]
v_pk_mul_f32 v[190:191],v[190:191],v[144:145] op_sel_hi:[1,0]
v_pk_mul_f32 v[236:237],v[236:237],v[146:147] op_sel_hi:[1,0]
v_pk_mul_f32 v[238:239],v[238:239],v[146:147] op_sel_hi:[1,0]
v_cvt_pk_bf16_f32 v92,v188,v189
v_cvt_pk_bf16_f32 v93,v190,v191
v_mfma_f32_16x16x32_bf16 a[40:43],a[248:251],v[120:123],a[40:43]
s_waitcnt vmcnt(3)
ds_read_b128 a[144:147],v28 offset:12288
v_cvt_pk_bf16_f32 v94,v236,v237
s_waitcnt lgkmcnt(2)
v_mfma_f32_16x16x32_bf16 v[204:207],a[252:255],v[112:115],v[204:207]
ds_read_b128 a[148:151],v29 offset:12288
v_cvt_pk_bf16_f32 v95,v238,v239
v_mfma_f32_16x16x32_bf16 v[252:255],a[252:255],v[116:119],v[252:255]
ds_read_b128 a[152:155],v28 offset:13312
ds_read_b128 a[156:159],v29 offset:13312
v_pk_mul_f32 v[192:193],v[192:193],v[144:145] op_sel_hi:[1,0]
v_pk_mul_f32 v[194:195],v[194:195],v[144:145] op_sel_hi:[1,0]
v_pk_mul_f32 v[240:241],v[240:241],v[146:147] op_sel_hi:[1,0]
v_pk_mul_f32 v[242:243],v[242:243],v[146:147] op_sel_hi:[1,0]
v_cvt_pk_bf16_f32 v80,v192,v193
v_cvt_pk_bf16_f32 v81,v194,v195
v_mfma_f32_16x16x32_bf16 a[44:47],a[252:255],v[120:123],a[44:47]
ds_read_b128 a[160:163],v28 offset:14336
v_cvt_pk_bf16_f32 v82,v240,v241
v_mfma_f32_16x16x32_bf16 v[32:35],a[192:195],a[96:99],0
s_waitcnt vmcnt(5)
s_barrier
ds_read_b128 a[164:167],v29 offset:14336
v_mfma_f32_16x16x32_bf16 v[32:35],a[196:199],a[100:103],v[32:35]
ds_write2st64_b64 v22,v[92:93],v[94:95] offset0:2 offset1:14
v_pk_mul_f32 v[196:197],v[196:197],v[144:145] op_sel_hi:[1,0]
v_pk_mul_f32 v[198:199],v[198:199],v[144:145] op_sel_hi:[1,0]
v_pk_mul_f32 v[244:245],v[244:245],v[146:147] op_sel_hi:[1,0]
v_pk_mul_f32 v[246:247],v[246:247],v[146:147] op_sel_hi:[1,0]
v_cvt_pk_bf16_f32 v83,v242,v243
v_cvt_pk_bf16_f32 v84,v196,v197
v_mfma_f32_16x16x32_bf16 v[32:35],a[200:203],a[104:107],v[32:35]
ds_write2st64_b64 v12,v[80:81],v[82:83] offset0:4 offset1:16
v_mfma_f32_16x16x32_bf16 v[32:35],a[204:207],a[108:111],v[32:35]
v_cvt_pk_bf16_f32 v85,v198,v199
v_cvt_pk_bf16_f32 v86,v244,v245
v_mfma_f32_16x16x32_bf16 v[32:35],a[208:211],a[112:115],v[32:35]
v_cvt_pk_bf16_f32 v87,v246,v247
v_mfma_f32_16x16x32_bf16 v[32:35],a[212:215],a[116:119],v[32:35]
buffer_load_dwordx4 v7,s[8:11],s21 offen offset:0 lds
s_add_u32 m0,s23,896
v_pk_mul_f32 v[200:201],v[200:201],v[144:145] op_sel_hi:[1,0]
v_pk_mul_f32 v[202:203],v[202:203],v[144:145] op_sel_hi:[1,0]
v_pk_mul_f32 v[248:249],v[248:249],v[146:147] op_sel_hi:[1,0]
v_pk_mul_f32 v[250:251],v[250:251],v[146:147] op_sel_hi:[1,0]
v_cvt_pk_bf16_f32 v88,v200,v201
v_cvt_pk_bf16_f32 v89,v202,v203
v_mfma_f32_16x16x32_bf16 v[36:39],a[216:219],a[96:99],0
ds_write2st64_b64 v20,v[84:85],v[86:87] offset0:4 offset1:16
v_mfma_f32_16x16x32_bf16 v[36:39],a[220:223],a[100:103],v[36:39]
v_cvt_pk_bf16_f32 v90,v248,v249
v_cvt_pk_bf16_f32 v91,v250,v251
v_mfma_f32_16x16x32_bf16 v[36:39],a[224:227],a[104:107],v[36:39]
ds_write2st64_b64 v21,v[88:89],v[90:91] offset0:4 offset1:16
v_pk_mul_f32 v[204:205],v[204:205],v[144:145] op_sel_hi:[1,0]
v_pk_mul_f32 v[206:207],v[206:207],v[144:145] op_sel_hi:[1,0]
v_pk_mul_f32 v[252:253],v[252:253],v[146:147] op_sel_hi:[1,0]
v_pk_mul_f32 v[254:255],v[254:255],v[146:147] op_sel_hi:[1,0]
v_cvt_pk_bf16_f32 v92,v204,v205
v_cvt_pk_bf16_f32 v93,v206,v207
v_mfma_f32_16x16x32_bf16 v[36:39],a[228:231],a[108:111],v[36:39]
v_cvt_pk_bf16_f32 v94,v252,v253
v_cvt_pk_bf16_f32 v95,v254,v255
v_mfma_f32_16x16x32_bf16 v[36:39],a[232:235],a[112:115],v[36:39]
buffer_load_dwordx4 v7,s[8:11],s21 offen offset:128 lds
s_add_u32 m0,s23,1792
v_mfma_f32_16x16x32_bf16 v[36:39],a[236:239],a[116:119],v[36:39]
ds_write2st64_b64 v22,v[92:93],v[94:95] offset0:4 offset1:16
v_pk_mul_f32 v[64:65],v[64:65],v[148:149] op_sel_hi:[1,0]
v_pk_mul_f32 v[66:67],v[66:67],v[148:149] op_sel_hi:[1,0]
v_pk_mul_f32 v[68:69],v[68:69],v[148:149] op_sel_hi:[1,0]
v_pk_mul_f32 v[70:71],v[70:71],v[148:149] op_sel_hi:[1,0]
v_cvt_pk_bf16_f32 v80,v64,v65
v_cvt_pk_bf16_f32 v81,v66,v67
v_mfma_f32_16x16x32_bf16 v[40:43],a[192:195],a[120:123],0
v_cvt_pk_bf16_f32 v82,v68,v69
v_cvt_pk_bf16_f32 v83,v70,v71
v_mfma_f32_16x16x32_bf16 v[40:43],a[196:199],a[124:127],v[40:43]
ds_write2st64_b64 v12,v[80:81],v[82:83] offset0:24 offset1:26
v_mfma_f32_16x16x32_bf16 v[40:43],a[200:203],a[128:131],v[40:43]
v_accvgpr_read_b32 v64,a8
v_accvgpr_read_b32 v65,a9
v_mfma_f32_16x16x32_bf16 v[40:43],a[204:207],a[132:135],v[40:43]
v_accvgpr_read_b32 v66,a10
v_accvgpr_read_b32 v67,a11
v_accvgpr_read_b32 v68,a24
v_accvgpr_read_b32 v69,a25
v_accvgpr_read_b32 v70,a26
v_pk_mul_f32 v[72:73],v[72:73],v[148:149] op_sel_hi:[1,0]
v_pk_mul_f32 v[74:75],v[74:75],v[148:149] op_sel_hi:[1,0]
v_pk_mul_f32 v[76:77],v[76:77],v[148:149] op_sel_hi:[1,0]
v_pk_mul_f32 v[78:79],v[78:79],v[148:149] op_sel_hi:[1,0]
v_accvgpr_read_b32 v71,a27
v_cvt_pk_bf16_f32 v84,v72,v73
v_mfma_f32_16x16x32_bf16 v[40:43],a[208:211],a[136:139],v[40:43]
v_cvt_pk_bf16_f32 v85,v74,v75
v_cvt_pk_bf16_f32 v86,v76,v77
v_mfma_f32_16x16x32_bf16 v[40:43],a[212:215],a[140:143],v[40:43]
buffer_load_dwordx4 v7,s[8:11],s21 offen offset:256 lds
s_add_u32 s21,s21,12288
s_mov_b32 s27,s42
v_mfma_f32_16x16x32_bf16 v[44:47],a[216:219],a[120:123],0
s_mov_b32 s42,s41
v_cvt_pk_bf16_f32 v87,v78,v79
v_accvgpr_read_b32 v72,a12
v_accvgpr_read_b32 v73,a13
v_accvgpr_read_b32 v74,a14
v_accvgpr_read_b32 v75,a15
v_pk_mul_f32 v[64:65],v[64:65],v[148:149] op_sel_hi:[1,0]
v_pk_mul_f32 v[66:67],v[66:67],v[148:149] op_sel_hi:[1,0]
v_pk_mul_f32 v[68:69],v[68:69],v[148:149] op_sel_hi:[1,0]
v_pk_mul_f32 v[70:71],v[70:71],v[148:149] op_sel_hi:[1,0]
v_accvgpr_read_b32 v76,a28
v_accvgpr_read_b32 v77,a29
v_mfma_f32_16x16x32_bf16 v[44:47],a[220:223],a[124:127],v[44:47]
s_add_u32 s69,s69,1
ds_write2st64_b64 v20,v[84:85],v[86:87] offset0:24 offset1:26
s_add_u32 s48,s48,325632
s_lshr_b32 s62,s39,s69
s_and_b32 s62,s62,1
s_lshl_b32 s62,s62,1
v_mfma_f32_16x16x32_bf16 v[44:47],a[224:227],a[128:131],v[44:47]
s_add_u32 s62,s62,s49
v_accvgpr_read_b32 v78,a30
v_accvgpr_read_b32 v79,a31
v_mfma_f32_16x16x32_bf16 v[44:47],a[228:231],a[132:135],v[44:47]
s_and_b32 s62,s62,3
v_cvt_pk_bf16_f32 v88,v64,v65
v_cvt_pk_bf16_f32 v89,v66,v67
v_mfma_f32_16x16x32_bf16 v[44:47],a[232:235],a[136:139],v[44:47]
s_add_u32 s63,s69,8
v_accvgpr_read_b32 v64,a32
v_accvgpr_read_b32 v65,a33
v_accvgpr_read_b32 v66,a34
v_accvgpr_read_b32 v67,a35
v_cvt_pk_bf16_f32 v90,v68,v69
v_pk_mul_f32 v[72:73],v[72:73],v[148:149] op_sel_hi:[1,0]
v_pk_mul_f32 v[74:75],v[74:75],v[148:149] op_sel_hi:[1,0]
v_pk_mul_f32 v[76:77],v[76:77],v[148:149] op_sel_hi:[1,0]
v_pk_mul_f32 v[78:79],v[78:79],v[148:149] op_sel_hi:[1,0]
v_cvt_pk_bf16_f32 v91,v70,v71
v_accvgpr_read_b32 v68,a36
v_mfma_f32_16x16x32_bf16 v[44:47],a[236:239],a[140:143],v[44:47]
s_lshr_b32 s63,s39,s63
ds_write2st64_b64 v21,v[88:89],v[90:91] offset0:24 offset1:26
s_and_b32 s63,s63,1
s_xor_b32 s62,s62,s63
s_mul_i32 s63,s3,3
s_lshl_b32 s64,s3,2
s_waitcnt lgkmcnt(2)
v_mfma_f32_16x16x32_bf16 v[48:51],a[192:195],a[144:147],0
s_mov_b32 s40,1
v_accvgpr_read_b32 v69,a37
v_accvgpr_read_b32 v70,a38
v_mfma_f32_16x16x32_bf16 v[48:51],a[196:199],a[148:151],v[48:51]
s_add_u32 s65,s63,17
v_accvgpr_read_b32 v71,a39
v_cvt_pk_bf16_f32 v92,v72,v73
v_cvt_pk_bf16_f32 v93,v74,v75
v_accvgpr_read_b32 v72,a40
v_accvgpr_read_b32 v73,a41
v_pk_mul_f32 v[64:65],v[64:65],v[148:149] op_sel_hi:[1,0]
v_pk_mul_f32 v[66:67],v[66:67],v[148:149] op_sel_hi:[1,0]
v_accvgpr_read_b32 v74,a42
v_accvgpr_read_b32 v75,a43
v_mfma_f32_16x16x32_bf16 v[48:51],a[200:203],a[152:155],v[48:51]
s_cmp_eq_u32 s3,0
v_cvt_pk_bf16_f32 v94,v76,v77
v_cvt_pk_bf16_f32 v95,v78,v79
v_mfma_f32_16x16x32_bf16 v[48:51],a[204:207],a[156:159],v[48:51]
s_cselect_b32 s65,16,s65
ds_write2st64_b64 v22,v[92:93],v[94:95] offset0:24 offset1:26
s_cselect_b32 s41,1,0
s_cmp_eq_u32 s62,1
s_cselect_b32 s64,s65,s64
s_cselect_b32 s40,s41,s40
v_mfma_f32_16x16x32_bf16 v[48:51],a[208:211],a[160:163],v[48:51]
s_add_u32 s65,s63,29
v_cvt_pk_bf16_f32 v80,v64,v65
v_cvt_pk_bf16_f32 v81,v66,v67
v_accvgpr_read_b32 v76,a44
v_accvgpr_read_b32 v77,a45
v_accvgpr_read_b32 v78,a46
v_pk_mul_f32 v[68:69],v[68:69],v[148:149] op_sel_hi:[1,0]
v_pk_mul_f32 v[70:71],v[70:71],v[148:149] op_sel_hi:[1,0]
v_accvgpr_read_b32 v79,a47
v_cvt_pk_bf16_f32 v84,v68,v69
v_mfma_f32_16x16x32_bf16 v[48:51],a[212:215],a[164:167],v[48:51]
s_cmp_eq_u32 s62,2
ds_write_b64 v12,v[80:81] offset:14336
s_cselect_b32 s64,s65,s64
s_cselect_b32 s40,0,s40
v_mfma_f32_16x16x32_bf16 v[52:55],a[216:219],a[144:147],0
s_add_u32 s65,s63,41
v_cvt_pk_bf16_f32 v85,v70,v71
s_cmp_eq_u32 s62,3
v_mfma_f32_16x16x32_bf16 v[52:55],a[220:223],a[148:151],v[52:55]
s_cselect_b32 s64,s65,s64
ds_write_b64 v20,v[84:85] offset:14336
s_cselect_b32 s40,0,s40
s_mul_i32 s64,s64,6144
v_mfma_f32_16x16x32_bf16 v[52:55],a[224:227],a[152:155],v[52:55]
s_add_u32 s41,s48,s64
s_cmp_ge_u32 s69,8
s_cselect_b32 s41,166723584,s41
s_mov_b32 s28,s41
s_mov_b32 s29,s24
s_add_u32 s25,s22,12288
v_pk_mul_f32 v[72:73],v[72:73],v[148:149] op_sel_hi:[1,0]
v_pk_mul_f32 v[74:75],v[74:75],v[148:149] op_sel_hi:[1,0]
v_cvt_pk_bf16_f32 v88,v72,v73
v_cvt_pk_bf16_f32 v89,v74,v75
v_mfma_f32_16x16x32_bf16 v[52:55],a[228:231],a[156:159],v[52:55]
s_add_u32 s26,s22,24576
ds_write_b64 v21,v[88:89] offset:14336
v_mfma_f32_16x16x32_bf16 v[52:55],a[232:235],a[160:163],v[52:55]
v_mfma_f32_16x16x32_bf16 v[52:55],a[236:239],a[164:167],v[52:55]
v_pk_mul_f32 v[76:77],v[76:77],v[148:149] op_sel_hi:[1,0]
v_pk_mul_f32 v[78:79],v[78:79],v[148:149] op_sel_hi:[1,0]
v_cvt_pk_bf16_f32 v92,v76,v77
v_cvt_pk_bf16_f32 v93,v78,v79
ds_write_b64 v22,v[92:93] offset:14336
ds_read_b128 a[192:195],v1 offset:12288
v_max3_f32 v144,v32,v33,v34
v_max3_f32 v144,v144,v35,v36
v_max3_f32 v144,v144,v37,v38
v_max_f32 v144,v144,v39
v_mov_b32 v145,v144
v_max3_f32 v146,v40,v41,v42
v_max3_f32 v146,v146,v43,v44
v_permlane32_swap_b32 v145,v144
s_add_u32 m0,s23,12288
v_max_f32 v144,v144,v145
v_mov_b32 v145,v144
v_max3_f32 v146,v146,v45,v46
v_max_f32 v146,v146,v47
v_permlane16_swap_b32 v145,v144
v_max_f32 v144,v144,v145
v_mul_f32_e64 v16,-s36,v144
v_max3_f32 v144,v48,v49,v50
v_max3_f32 v144,v144,v51,v52
v_max3_f32 v144,v144,v53,v54
v_max_f32 v144,v144,v55
v_mov_b32 v147,v146
v_mov_b32 v145,v144
v_fma_f32 v32,v32,s36,v16
v_permlane32_swap_b32 v147,v146
v_permlane32_swap_b32 v145,v144
v_max_f32 v146,v146,v147
v_max_f32 v144,v144,v145
v_mov_b32 v147,v146
v_mov_b32 v145,v144
v_fma_f32 v33,v33,s36,v16
v_permlane16_swap_b32 v147,v146
s_waitcnt lgkmcnt(0)
v_mfma_f32_16x16x32_bf16 v[64:67],a[192:195],a[96:99],0
buffer_load_dwordx4 v7,s[8:11],s21 offen offset:0 lds
s_add_u32 m0,s23,13184
ds_read_b128 a[196:199],v2 offset:12288
v_permlane16_swap_b32 v145,v144
v_max_f32 v146,v146,v147
v_max_f32 v144,v144,v145
v_mul_f32_e64 v17,-s36,v146
v_mul_f32_e64 v18,-s36,v144
v_fma_f32 v34,v34,s36,v16
v_fma_f32 v35,v35,s36,v16
v_fma_f32 v36,v36,s36,v16
v_fma_f32 v37,v37,s36,v16
v_fma_f32 v38,v38,s36,v16
v_fma_f32 v39,v39,s36,v16
v_fma_f32 v40,v40,s36,v17
v_fma_f32 v41,v41,s36,v17
v_fma_f32 v42,v42,s36,v17
v_fma_f32 v43,v43,s36,v17
v_fma_f32 v44,v44,s36,v17
v_fma_f32 v45,v45,s36,v17
v_fma_f32 v46,v46,s36,v17
v_fma_f32 v47,v47,s36,v17
v_fma_f32 v48,v48,s36,v18
v_fma_f32 v49,v49,s36,v18
v_fma_f32 v50,v50,s36,v18
v_fma_f32 v51,v51,s36,v18
v_fma_f32 v52,v52,s36,v18
v_fma_f32 v53,v53,s36,v18
v_fma_f32 v54,v54,s36,v18
v_fma_f32 v55,v55,s36,v18
v_exp_f32 v32,v32
v_exp_f32 v33,v33
v_exp_f32 v34,v34
s_waitcnt lgkmcnt(0)
v_mfma_f32_16x16x32_bf16 v[64:67],a[196:199],a[100:103],v[64:67]
buffer_load_dwordx4 v7,s[8:11],s21 offen offset:128 lds
s_add_u32 m0,s23,14080
ds_read_b128 a[200:203],v1 offset:13312
buffer_load_dwordx4 v7,s[8:11],s21 offen offset:256 lds
s_add_u32 s21,s21,12288
s_add_u32 m0,s22,0
ds_read_b128 a[204:207],v2 offset:13312
v_exp_f32 v35,v35
v_exp_f32 v36,v36
v_exp_f32 v37,v37
v_exp_f32 v38,v38
v_exp_f32 v39,v39
v_exp_f32 v40,v40
v_exp_f32 v41,v41
v_exp_f32 v42,v42
v_exp_f32 v43,v43
v_exp_f32 v44,v44
v_exp_f32 v45,v45
v_exp_f32 v46,v46
v_exp_f32 v47,v47
v_exp_f32 v48,v48
v_exp_f32 v49,v49
s_waitcnt lgkmcnt(1)
v_mfma_f32_16x16x32_bf16 v[64:67],a[200:203],a[104:107],v[64:67]
buffer_load_dwordx4 v7,s[4:7],s20 offen offset:0 lds
s_add_u32 m0,s22,896
s_waitcnt lgkmcnt(0)
v_mfma_f32_16x16x32_bf16 v[64:67],a[204:207],a[108:111],v[64:67]
ds_read_b128 a[208:211],v1 offset:14336
v_exp_f32 v50,v50
v_exp_f32 v51,v51
v_exp_f32 v52,v52
v_exp_f32 v53,v53
v_exp_f32 v54,v54
v_exp_f32 v55,v55
v_cvt_pk_bf16_f32 v96,v32,v33
v_cvt_pk_bf16_f32 v97,v34,v35
v_cvt_pk_bf16_f32 v98,v36,v37
v_cvt_pk_bf16_f32 v99,v38,v39
v_cvt_pk_bf16_f32 v100,v40,v41
v_cvt_pk_bf16_f32 v101,v42,v43
v_mfma_f32_16x16x32_bf16 v[128:131],v[24:27],v[96:99],0
ds_read_b128 a[212:215],v2 offset:14336
v_cvt_pk_bf16_f32 v102,v44,v45
v_cvt_pk_bf16_f32 v103,v46,v47
v_cvt_pk_bf16_f32 v104,v48,v49
v_cvt_pk_bf16_f32 v105,v50,v51
v_mfma_f32_16x16x32_bf16 v[132:135],v[24:27],v[100:103],0
ds_read_b128 a[216:219],v1 offset:18432
v_cvt_pk_bf16_f32 v106,v52,v53
v_cvt_pk_bf16_f32 v107,v54,v55
buffer_load_dwordx4 v7,s[4:7],s20 offen offset:128 lds
s_add_u32 m0,s22,1792
v_mfma_f32_16x16x32_bf16 v[136:139],v[24:27],v[104:107],0
s_waitcnt lgkmcnt(2)
ds_read_b128 a[220:223],v2 offset:18432
v_mfma_f32_16x16x32_bf16 v[64:67],a[208:211],a[112:115],v[64:67]
ds_read_b128 a[224:227],v1 offset:19456
ds_read_b128 a[228:231],v2 offset:19456
ds_read_b128 a[232:235],v1 offset:20480
ds_read_b128 a[236:239],v2 offset:20480
s_waitcnt lgkmcnt(6)
v_mfma_f32_16x16x32_bf16 v[64:67],a[212:215],a[116:119],v[64:67]
v_mfma_f32_16x16x32_bf16 v[72:75],a[192:195],a[120:123],0
v_mfma_f32_16x16x32_bf16 v[72:75],a[196:199],a[124:127],v[72:75]
v_mfma_f32_16x16x32_bf16 v[72:75],a[200:203],a[128:131],v[72:75]
buffer_load_dwordx4 v7,s[4:7],s20 offen offset:256 lds
s_add_u32 s20,s20,12288
v_mfma_f32_16x16x32_bf16 v[72:75],a[204:207],a[132:135],v[72:75]
v_mfma_f32_16x16x32_bf16 v[72:75],a[208:211],a[136:139],v[72:75]
v_mfma_f32_16x16x32_bf16 v[72:75],a[212:215],a[140:143],v[72:75]
v_fma_f32 v64,v64,s36,v16
v_fma_f32 v65,v65,s36,v16
v_mfma_f32_16x16x32_bf16 v[80:83],a[192:195],a[144:147],0
v_fma_f32 v66,v66,s36,v16
v_fma_f32 v67,v67,s36,v16
v_mfma_f32_16x16x32_bf16 v[80:83],a[196:199],a[148:151],v[80:83]
v_exp_f32 v64,v64
v_mfma_f32_16x16x32_bf16 v[80:83],a[200:203],a[152:155],v[80:83]
v_fma_f32 v72,v72,s36,v17
v_fma_f32 v73,v73,s36,v17
v_mfma_f32_16x16x32_bf16 v[80:83],a[204:207],a[156:159],v[80:83]
v_fma_f32 v74,v74,s36,v17
v_fma_f32 v75,v75,s36,v17
v_mfma_f32_16x16x32_bf16 v[80:83],a[208:211],a[160:163],v[80:83]
v_exp_f32 v65,v65
v_mfma_f32_16x16x32_bf16 v[80:83],a[212:215],a[164:167],v[80:83]
s_waitcnt lgkmcnt(0)
v_exp_f32 v66,v66
v_mfma_f32_16x16x32_bf16 v[68:71],a[216:219],a[96:99],0
v_exp_f32 v67,v67
v_mfma_f32_16x16x32_bf16 v[68:71],a[220:223],a[100:103],v[68:71]
v_exp_f32 v72,v72
v_mfma_f32_16x16x32_bf16 v[68:71],a[224:227],a[104:107],v[68:71]
s_waitcnt vmcnt(6)
s_barrier
v_exp_f32 v73,v73
v_mfma_f32_16x16x32_bf16 v[68:71],a[228:231],a[108:111],v[68:71]
v_exp_f32 v74,v74
v_mfma_f32_16x16x32_bf16 v[68:71],a[232:235],a[112:115],v[68:71]
ds_read_b64_tr_b16 a[240:241],v3 offset:0
ds_read_b64_tr_b16 a[242:243],v3 offset:6144
v_mfma_f32_16x16x32_bf16 v[68:71],a[236:239],a[116:119],v[68:71]
ds_read_b64_tr_b16 a[244:245],v4 offset:0
ds_read_b64_tr_b16 a[246:247],v4 offset:6144
v_mfma_f32_16x16x32_bf16 v[76:79],a[216:219],a[120:123],0
v_exp_f32 v75,v75
v_mfma_f32_16x16x32_bf16 v[76:79],a[220:223],a[124:127],v[76:79]
ds_read_b64_tr_b16 a[248:249],v5 offset:0
ds_read_b64_tr_b16 a[250:251],v5 offset:6144
v_mfma_f32_16x16x32_bf16 v[76:79],a[224:227],a[128:131],v[76:79]
ds_read_b64_tr_b16 a[252:253],v6 offset:0
ds_read_b64_tr_b16 a[254:255],v6 offset:6144
v_mfma_f32_16x16x32_bf16 v[76:79],a[228:231],a[132:135],v[76:79]
v_cvt_pk_bf16_f32 v112,v64,v65
v_cvt_pk_bf16_f32 v113,v66,v67
v_mfma_f32_16x16x32_bf16 v[76:79],a[232:235],a[136:139],v[76:79]
v_cvt_pk_bf16_f32 v116,v72,v73
v_cvt_pk_bf16_f32 v117,v74,v75
v_mfma_f32_16x16x32_bf16 v[76:79],a[236:239],a[140:143],v[76:79]
v_mfma_f32_16x16x32_bf16 v[84:87],a[216:219],a[144:147],0
v_mfma_f32_16x16x32_bf16 v[84:87],a[220:223],a[148:151],v[84:87]
v_mfma_f32_16x16x32_bf16 v[84:87],a[224:227],a[152:155],v[84:87]
v_mfma_f32_16x16x32_bf16 v[84:87],a[228:231],a[156:159],v[84:87]
v_mfma_f32_16x16x32_bf16 v[84:87],a[232:235],a[160:163],v[84:87]
v_mfma_f32_16x16x32_bf16 v[84:87],a[236:239],a[164:167],v[84:87]
s_waitcnt lgkmcnt(0)
v_mfma_f32_16x16x32_bf16 v[160:163],a[240:243],v[96:99],0
s_add_u32 m0,s23,24576
ds_read_b128 a[192:195],v1 offset:24576
v_fma_f32 v68,v68,s36,v16
v_mfma_f32_16x16x32_bf16 v[208:211],a[240:243],v[100:103],0
buffer_load_dwordx4 v7,s[8:11],s21 offen offset:0 lds
v_mfma_f32_16x16x32_bf16 a[0:3],a[240:243],v[104:107],0
s_add_u32 m0,s23,25472
ds_read_b64_tr_b16 a[240:241],v3 offset:1024
ds_read_b64_tr_b16 a[242:243],v3 offset:7168
v_mfma_f32_16x16x32_bf16 v[164:167],a[244:247],v[96:99],0
ds_read_b128 a[196:199],v2 offset:24576
v_fma_f32 v69,v69,s36,v16
v_mfma_f32_16x16x32_bf16 v[212:215],a[244:247],v[100:103],0
ds_read_b128 a[200:203],v1 offset:25600
v_fma_f32 v70,v70,s36,v16
v_mfma_f32_16x16x32_bf16 a[4:7],a[244:247],v[104:107],0
ds_read_b64_tr_b16 a[244:245],v4 offset:1024
ds_read_b64_tr_b16 a[246:247],v4 offset:7168
v_mfma_f32_16x16x32_bf16 v[168:171],a[248:251],v[96:99],0
ds_read_b128 a[204:207],v2 offset:25600
v_fma_f32 v71,v71,s36,v16
v_mfma_f32_16x16x32_bf16 v[216:219],a[248:251],v[100:103],0
buffer_load_dwordx4 v7,s[8:11],s21 offen offset:128 lds
v_mfma_f32_16x16x32_bf16 a[8:11],a[248:251],v[104:107],0
s_add_u32 m0,s23,26368
ds_read_b64_tr_b16 a[248:249],v5 offset:1024
ds_read_b64_tr_b16 a[250:251],v5 offset:7168
v_mfma_f32_16x16x32_bf16 v[172:175],a[252:255],v[96:99],0
ds_read_b128 a[208:211],v1 offset:26624
v_fma_f32 v76,v76,s36,v17
v_mfma_f32_16x16x32_bf16 v[220:223],a[252:255],v[100:103],0
ds_read_b128 a[212:215],v2 offset:26624
v_fma_f32 v77,v77,s36,v17
v_mfma_f32_16x16x32_bf16 a[12:15],a[252:255],v[104:107],0
s_waitcnt lgkmcnt(8)
ds_read_b64_tr_b16 a[252:253],v6 offset:1024
ds_read_b64_tr_b16 a[254:255],v6 offset:7168
v_mfma_f32_16x16x32_bf16 v[176:179],a[240:243],v[96:99],0
buffer_load_dwordx4 v7,s[8:11],s21 offen offset:256 lds
v_mfma_f32_16x16x32_bf16 v[224:227],a[240:243],v[100:103],0
s_add_u32 s21,s21,12288
ds_read_b128 a[216:219],v1 offset:30720
v_fma_f32 v78,v78,s36,v17
v_mfma_f32_16x16x32_bf16 a[16:19],a[240:243],v[104:107],0
s_add_u32 m0,s22,12288
ds_read_b64_tr_b16 a[240:241],v3 offset:2048
ds_read_b64_tr_b16 a[242:243],v3 offset:8192
s_waitcnt lgkmcnt(9)
v_mfma_f32_16x16x32_bf16 v[180:183],a[244:247],v[96:99],0
ds_read_b128 a[220:223],v2 offset:30720
v_fma_f32 v79,v79,s36,v17
v_mfma_f32_16x16x32_bf16 v[228:231],a[244:247],v[100:103],0
ds_read_b128 a[224:227],v1 offset:31744
v_fma_f32 v80,v80,s36,v18
v_mfma_f32_16x16x32_bf16 a[20:23],a[244:247],v[104:107],0
s_waitcnt lgkmcnt(8)
ds_read_b64_tr_b16 a[244:245],v4 offset:2048
ds_read_b64_tr_b16 a[246:247],v4 offset:8192
v_mfma_f32_16x16x32_bf16 v[184:187],a[248:251],v[96:99],0
buffer_load_dwordx4 v7,s[4:7],s20 offen offset:0 lds
v_mfma_f32_16x16x32_bf16 v[232:235],a[248:251],v[100:103],0
s_add_u32 m0,s22,13184
ds_read_b128 a[228:231],v2 offset:31744
v_fma_f32 v81,v81,s36,v18
v_mfma_f32_16x16x32_bf16 a[24:27],a[248:251],v[104:107],0
s_waitcnt lgkmcnt(8)
ds_read_b64_tr_b16 a[248:249],v5 offset:2048
ds_read_b64_tr_b16 a[250:251],v5 offset:8192
v_mfma_f32_16x16x32_bf16 v[188:191],a[252:255],v[96:99],0
ds_read_b128 a[232:235],v1 offset:32768
v_fma_f32 v82,v82,s36,v18
v_mfma_f32_16x16x32_bf16 v[236:239],a[252:255],v[100:103],0
ds_read_b128 a[236:239],v2 offset:32768
v_fma_f32 v83,v83,s36,v18
v_mfma_f32_16x16x32_bf16 a[28:31],a[252:255],v[104:107],0
s_waitcnt lgkmcnt(8)
ds_read_b64_tr_b16 a[252:253],v6 offset:2048
ds_read_b64_tr_b16 a[254:255],v6 offset:8192
v_mfma_f32_16x16x32_bf16 v[192:195],a[240:243],v[96:99],0
buffer_load_dwordx4 v7,s[4:7],s20 offen offset:128 lds
v_mfma_f32_16x16x32_bf16 v[240:243],a[240:243],v[100:103],0
s_add_u32 m0,s22,14080
v_fma_f32 v84,v84,s36,v18
v_fma_f32 v85,v85,s36,v18
v_mfma_f32_16x16x32_bf16 a[32:35],a[240:243],v[104:107],0
s_waitcnt lgkmcnt(7)
v_fma_f32 v86,v86,s36,v18
v_fma_f32 v87,v87,s36,v18
v_mfma_f32_16x16x32_bf16 v[196:199],a[244:247],v[96:99],0
v_exp_f32 v68,v68
v_mfma_f32_16x16x32_bf16 v[244:247],a[244:247],v[100:103],0
v_exp_f32 v69,v69
v_mfma_f32_16x16x32_bf16 a[36:39],a[244:247],v[104:107],0
s_waitcnt lgkmcnt(3)
v_exp_f32 v70,v70
v_mfma_f32_16x16x32_bf16 v[200:203],a[248:251],v[96:99],0
buffer_load_dwordx4 v7,s[4:7],s20 offen offset:256 lds
v_mfma_f32_16x16x32_bf16 v[248:251],a[248:251],v[100:103],0
s_add_u32 s20,s20,12288
v_exp_f32 v71,v71
v_mfma_f32_16x16x32_bf16 a[40:43],a[248:251],v[104:107],0
s_waitcnt lgkmcnt(0)
v_exp_f32 v76,v76
v_mfma_f32_16x16x32_bf16 v[204:207],a[252:255],v[96:99],0
v_exp_f32 v77,v77
v_mfma_f32_16x16x32_bf16 v[252:255],a[252:255],v[100:103],0
v_exp_f32 v78,v78
v_mfma_f32_16x16x32_bf16 a[44:47],a[252:255],v[104:107],0
v_exp_f32 v79,v79
v_mfma_f32_16x16x32_bf16 v[32:35],a[192:195],a[96:99],0
v_exp_f32 v80,v80
v_mfma_f32_16x16x32_bf16 v[32:35],a[196:199],a[100:103],v[32:35]
v_exp_f32 v81,v81
v_mfma_f32_16x16x32_bf16 v[32:35],a[200:203],a[104:107],v[32:35]
v_exp_f32 v82,v82
v_mfma_f32_16x16x32_bf16 v[32:35],a[204:207],a[108:111],v[32:35]
v_exp_f32 v83,v83
v_mfma_f32_16x16x32_bf16 v[32:35],a[208:211],a[112:115],v[32:35]
v_exp_f32 v84,v84
v_mfma_f32_16x16x32_bf16 v[32:35],a[212:215],a[116:119],v[32:35]
v_exp_f32 v85,v85
v_mfma_f32_16x16x32_bf16 v[40:43],a[192:195],a[120:123],0
v_exp_f32 v86,v86
v_mfma_f32_16x16x32_bf16 v[40:43],a[196:199],a[124:127],v[40:43]
v_exp_f32 v87,v87
v_mfma_f32_16x16x32_bf16 v[40:43],a[200:203],a[128:131],v[40:43]
v_cvt_pk_bf16_f32 v114,v68,v69
v_cvt_pk_bf16_f32 v115,v70,v71
v_mfma_f32_16x16x32_bf16 v[40:43],a[204:207],a[132:135],v[40:43]
v_cvt_pk_bf16_f32 v118,v76,v77
v_cvt_pk_bf16_f32 v119,v78,v79
v_mfma_f32_16x16x32_bf16 v[128:131],v[24:27],v[112:115],v[128:131]
v_cvt_pk_bf16_f32 v120,v80,v81
v_cvt_pk_bf16_f32 v121,v82,v83
v_mfma_f32_16x16x32_bf16 v[132:135],v[24:27],v[116:119],v[132:135]
v_cvt_pk_bf16_f32 v122,v84,v85
v_cvt_pk_bf16_f32 v123,v86,v87
v_mfma_f32_16x16x32_bf16 v[40:43],a[208:211],a[136:139],v[40:43]
v_fma_f32 v32,v32,s36,v16
v_fma_f32 v33,v33,s36,v16
v_mfma_f32_16x16x32_bf16 v[136:139],v[24:27],v[120:123],v[136:139]
v_fma_f32 v34,v34,s36,v16
v_fma_f32 v35,v35,s36,v16
v_mfma_f32_16x16x32_bf16 v[40:43],a[212:215],a[140:143],v[40:43]
v_exp_f32 v32,v32
v_mfma_f32_16x16x32_bf16 v[48:51],a[192:195],a[144:147],0
v_exp_f32 v33,v33
v_mfma_f32_16x16x32_bf16 v[48:51],a[196:199],a[148:151],v[48:51]
v_exp_f32 v34,v34
v_mfma_f32_16x16x32_bf16 v[48:51],a[200:203],a[152:155],v[48:51]
v_exp_f32 v35,v35
v_mfma_f32_16x16x32_bf16 v[48:51],a[204:207],a[156:159],v[48:51]
v_fma_f32 v40,v40,s36,v17
v_fma_f32 v41,v41,s36,v17
v_mfma_f32_16x16x32_bf16 v[48:51],a[208:211],a[160:163],v[48:51]
v_fma_f32 v42,v42,s36,v17
v_fma_f32 v43,v43,s36,v17
v_mfma_f32_16x16x32_bf16 v[48:51],a[212:215],a[164:167],v[48:51]
v_exp_f32 v40,v40
v_mfma_f32_16x16x32_bf16 v[36:39],a[216:219],a[96:99],0
v_exp_f32 v41,v41
v_mfma_f32_16x16x32_bf16 v[36:39],a[220:223],a[100:103],v[36:39]
v_exp_f32 v42,v42
v_mfma_f32_16x16x32_bf16 v[36:39],a[224:227],a[104:107],v[36:39]
v_exp_f32 v43,v43
v_mfma_f32_16x16x32_bf16 v[36:39],a[228:231],a[108:111],v[36:39]
v_cvt_pk_bf16_f32 v96,v32,v33
v_cvt_pk_bf16_f32 v97,v34,v35
s_waitcnt vmcnt(6)
s_barrier
v_mfma_f32_16x16x32_bf16 v[36:39],a[232:235],a[112:115],v[36:39]
v_cvt_pk_bf16_f32 v100,v40,v41
v_cvt_pk_bf16_f32 v101,v42,v43
v_mfma_f32_16x16x32_bf16 v[36:39],a[236:239],a[116:119],v[36:39]
ds_read_b64_tr_b16 a[240:241],v3 offset:12288
ds_read_b64_tr_b16 a[242:243],v3 offset:18432
v_mfma_f32_16x16x32_bf16 v[44:47],a[216:219],a[120:123],0
v_mfma_f32_16x16x32_bf16 v[44:47],a[220:223],a[124:127],v[44:47]
ds_read_b64_tr_b16 a[244:245],v4 offset:12288
ds_read_b64_tr_b16 a[246:247],v4 offset:18432
v_mfma_f32_16x16x32_bf16 v[44:47],a[224:227],a[128:131],v[44:47]
ds_read_b64_tr_b16 a[248:249],v5 offset:12288
ds_read_b64_tr_b16 a[250:251],v5 offset:18432
v_mfma_f32_16x16x32_bf16 v[44:47],a[228:231],a[132:135],v[44:47]
v_mfma_f32_16x16x32_bf16 v[44:47],a[232:235],a[136:139],v[44:47]
ds_read_b64_tr_b16 a[252:253],v6 offset:12288
ds_read_b64_tr_b16 a[254:255],v6 offset:18432
v_mfma_f32_16x16x32_bf16 v[44:47],a[236:239],a[140:143],v[44:47]
v_mfma_f32_16x16x32_bf16 v[52:55],a[216:219],a[144:147],0
v_mfma_f32_16x16x32_bf16 v[52:55],a[220:223],a[148:151],v[52:55]
v_mfma_f32_16x16x32_bf16 v[52:55],a[224:227],a[152:155],v[52:55]
v_mfma_f32_16x16x32_bf16 v[52:55],a[228:231],a[156:159],v[52:55]
v_mfma_f32_16x16x32_bf16 v[52:55],a[232:235],a[160:163],v[52:55]
v_mfma_f32_16x16x32_bf16 v[52:55],a[236:239],a[164:167],v[52:55]
s_waitcnt lgkmcnt(2)
v_mfma_f32_16x16x32_bf16 v[160:163],a[240:243],v[112:115],v[160:163]
s_add_u32 m0,s23,0
ds_read_b128 a[192:195],v1 offset:0
v_fma_f32 v36,v36,s36,v16
v_mfma_f32_16x16x32_bf16 v[208:211],a[240:243],v[116:119],v[208:211]
buffer_load_dwordx4 v7,s[8:11],s21 offen offset:0 lds
v_mfma_f32_16x16x32_bf16 a[0:3],a[240:243],v[120:123],a[0:3]
s_add_u32 m0,s23,896
ds_read_b64_tr_b16 a[240:241],v3 offset:13312
ds_read_b64_tr_b16 a[242:243],v3 offset:19456
v_mfma_f32_16x16x32_bf16 v[164:167],a[244:247],v[112:115],v[164:167]
ds_read_b128 a[196:199],v2 offset:0
v_fma_f32 v37,v37,s36,v16
v_mfma_f32_16x16x32_bf16 v[212:215],a[244:247],v[116:119],v[212:215]
ds_read_b128 a[200:203],v1 offset:1024
v_fma_f32 v38,v38,s36,v16
v_mfma_f32_16x16x32_bf16 a[4:7],a[244:247],v[120:123],a[4:7]
ds_read_b64_tr_b16 a[244:245],v4 offset:13312
ds_read_b64_tr_b16 a[246:247],v4 offset:19456
v_mfma_f32_16x16x32_bf16 v[168:171],a[248:251],v[112:115],v[168:171]
ds_read_b128 a[204:207],v2 offset:1024
v_fma_f32 v39,v39,s36,v16
v_mfma_f32_16x16x32_bf16 v[216:219],a[248:251],v[116:119],v[216:219]
buffer_load_dwordx4 v7,s[8:11],s21 offen offset:128 lds
v_mfma_f32_16x16x32_bf16 a[8:11],a[248:251],v[120:123],a[8:11]
s_add_u32 m0,s23,1792
ds_read_b64_tr_b16 a[248:249],v5 offset:13312
ds_read_b64_tr_b16 a[250:251],v5 offset:19456
s_waitcnt lgkmcnt(9)
v_mfma_f32_16x16x32_bf16 v[172:175],a[252:255],v[112:115],v[172:175]
ds_read_b128 a[208:211],v1 offset:2048
v_fma_f32 v44,v44,s36,v17
v_mfma_f32_16x16x32_bf16 v[220:223],a[252:255],v[116:119],v[220:223]
ds_read_b128 a[212:215],v2 offset:2048
v_fma_f32 v45,v45,s36,v17
v_mfma_f32_16x16x32_bf16 a[12:15],a[252:255],v[120:123],a[12:15]
s_waitcnt lgkmcnt(8)
ds_read_b64_tr_b16 a[252:253],v6 offset:13312
ds_read_b64_tr_b16 a[254:255],v6 offset:19456
v_mfma_f32_16x16x32_bf16 v[176:179],a[240:243],v[112:115],v[176:179]
buffer_load_dwordx4 v7,s[8:11],s21 offen offset:256 lds
v_mfma_f32_16x16x32_bf16 v[224:227],a[240:243],v[116:119],v[224:227]
s_add_u32 s21,s21,12288
ds_read_b128 a[216:219],v1 offset:6144
v_fma_f32 v46,v46,s36,v17
v_mfma_f32_16x16x32_bf16 a[16:19],a[240:243],v[120:123],a[16:19]
s_add_u32 m0,s22,24576
ds_read_b64_tr_b16 a[240:241],v3 offset:14336
ds_read_b64_tr_b16 a[242:243],v3 offset:20480
s_waitcnt lgkmcnt(9)
v_mfma_f32_16x16x32_bf16 v[180:183],a[244:247],v[112:115],v[180:183]
ds_read_b128 a[220:223],v2 offset:6144
v_fma_f32 v47,v47,s36,v17
v_mfma_f32_16x16x32_bf16 v[228:231],a[244:247],v[116:119],v[228:231]
ds_read_b128 a[224:227],v1 offset:7168
v_fma_f32 v48,v48,s36,v18
v_mfma_f32_16x16x32_bf16 a[20:23],a[244:247],v[120:123],a[20:23]
s_waitcnt lgkmcnt(8)
ds_read_b64_tr_b16 a[244:245],v4 offset:14336
ds_read_b64_tr_b16 a[246:247],v4 offset:20480
v_mfma_f32_16x16x32_bf16 v[184:187],a[248:251],v[112:115],v[184:187]
buffer_load_dwordx4 v7,s[4:7],s20 offen offset:0 lds
v_mfma_f32_16x16x32_bf16 v[232:235],a[248:251],v[116:119],v[232:235]
s_add_u32 m0,s22,25472
ds_read_b128 a[228:231],v2 offset:7168
v_fma_f32 v49,v49,s36,v18
v_mfma_f32_16x16x32_bf16 a[24:27],a[248:251],v[120:123],a[24:27]
s_waitcnt lgkmcnt(8)
ds_read_b64_tr_b16 a[248:249],v5 offset:14336
ds_read_b64_tr_b16 a[250:251],v5 offset:20480
v_mfma_f32_16x16x32_bf16 v[188:191],a[252:255],v[112:115],v[188:191]
ds_read_b128 a[232:235],v1 offset:8192
v_fma_f32 v50,v50,s36,v18
v_mfma_f32_16x16x32_bf16 v[236:239],a[252:255],v[116:119],v[236:239]
ds_read_b128 a[236:239],v2 offset:8192
v_fma_f32 v51,v51,s36,v18
v_mfma_f32_16x16x32_bf16 a[28:31],a[252:255],v[120:123],a[28:31]
s_waitcnt lgkmcnt(8)
ds_read_b64_tr_b16 a[252:253],v6 offset:14336
ds_read_b64_tr_b16 a[254:255],v6 offset:20480
v_mfma_f32_16x16x32_bf16 v[192:195],a[240:243],v[112:115],v[192:195]
buffer_load_dwordx4 v7,s[4:7],s20 offen offset:128 lds
v_mfma_f32_16x16x32_bf16 v[240:243],a[240:243],v[116:119],v[240:243]
s_add_u32 m0,s22,26368
v_fma_f32 v52,v52,s36,v18
v_fma_f32 v53,v53,s36,v18
v_mfma_f32_16x16x32_bf16 a[32:35],a[240:243],v[120:123],a[32:35]
s_waitcnt lgkmcnt(7)
v_fma_f32 v54,v54,s36,v18
v_fma_f32 v55,v55,s36,v18
v_mfma_f32_16x16x32_bf16 v[196:199],a[244:247],v[112:115],v[196:199]
v_exp_f32 v36,v36
v_mfma_f32_16x16x32_bf16 v[244:247],a[244:247],v[116:119],v[244:247]
v_exp_f32 v37,v37
v_mfma_f32_16x16x32_bf16 a[36:39],a[244:247],v[120:123],a[36:39]
s_waitcnt lgkmcnt(3)
v_exp_f32 v38,v38
v_mfma_f32_16x16x32_bf16 v[200:203],a[248:251],v[112:115],v[200:203]
buffer_load_dwordx4 v7,s[4:7],s20 offen offset:256 lds
v_mfma_f32_16x16x32_bf16 v[248:251],a[248:251],v[116:119],v[248:251]
s_add_u32 s20,s20,12288
v_exp_f32 v39,v39
v_mfma_f32_16x16x32_bf16 a[40:43],a[248:251],v[120:123],a[40:43]
s_waitcnt lgkmcnt(0)
v_exp_f32 v44,v44
v_mfma_f32_16x16x32_bf16 v[204:207],a[252:255],v[112:115],v[204:207]
v_exp_f32 v45,v45
v_mfma_f32_16x16x32_bf16 v[252:255],a[252:255],v[116:119],v[252:255]
v_exp_f32 v46,v46
v_mfma_f32_16x16x32_bf16 a[44:47],a[252:255],v[120:123],a[44:47]
v_exp_f32 v47,v47
v_mfma_f32_16x16x32_bf16 v[64:67],a[192:195],a[96:99],0
v_exp_f32 v48,v48
v_mfma_f32_16x16x32_bf16 v[64:67],a[196:199],a[100:103],v[64:67]
v_exp_f32 v49,v49
v_mfma_f32_16x16x32_bf16 v[64:67],a[200:203],a[104:107],v[64:67]
v_exp_f32 v50,v50
v_mfma_f32_16x16x32_bf16 v[64:67],a[204:207],a[108:111],v[64:67]
v_exp_f32 v51,v51
v_mfma_f32_16x16x32_bf16 v[64:67],a[208:211],a[112:115],v[64:67]
v_exp_f32 v52,v52
v_mfma_f32_16x16x32_bf16 v[64:67],a[212:215],a[116:119],v[64:67]
v_exp_f32 v53,v53
v_mfma_f32_16x16x32_bf16 v[72:75],a[192:195],a[120:123],0
v_exp_f32 v54,v54
v_mfma_f32_16x16x32_bf16 v[72:75],a[196:199],a[124:127],v[72:75]
v_exp_f32 v55,v55
v_mfma_f32_16x16x32_bf16 v[72:75],a[200:203],a[128:131],v[72:75]
v_cvt_pk_bf16_f32 v98,v36,v37
v_cvt_pk_bf16_f32 v99,v38,v39
v_mfma_f32_16x16x32_bf16 v[72:75],a[204:207],a[132:135],v[72:75]
v_cvt_pk_bf16_f32 v102,v44,v45
v_cvt_pk_bf16_f32 v103,v46,v47
v_mfma_f32_16x16x32_bf16 v[128:131],v[24:27],v[96:99],v[128:131]
v_cvt_pk_bf16_f32 v104,v48,v49
v_cvt_pk_bf16_f32 v105,v50,v51
v_mfma_f32_16x16x32_bf16 v[132:135],v[24:27],v[100:103],v[132:135]
v_cvt_pk_bf16_f32 v106,v52,v53
v_cvt_pk_bf16_f32 v107,v54,v55
v_mfma_f32_16x16x32_bf16 v[72:75],a[208:211],a[136:139],v[72:75]
v_fma_f32 v64,v64,s36,v16
v_fma_f32 v65,v65,s36,v16
v_mfma_f32_16x16x32_bf16 v[136:139],v[24:27],v[104:107],v[136:139]
v_fma_f32 v66,v66,s36,v16
v_fma_f32 v67,v67,s36,v16
v_mfma_f32_16x16x32_bf16 v[72:75],a[212:215],a[140:143],v[72:75]
v_exp_f32 v64,v64
v_mfma_f32_16x16x32_bf16 v[80:83],a[192:195],a[144:147],0
v_exp_f32 v65,v65
v_mfma_f32_16x16x32_bf16 v[80:83],a[196:199],a[148:151],v[80:83]
v_exp_f32 v66,v66
v_mfma_f32_16x16x32_bf16 v[80:83],a[200:203],a[152:155],v[80:83]
v_exp_f32 v67,v67
v_mfma_f32_16x16x32_bf16 v[80:83],a[204:207],a[156:159],v[80:83]
v_fma_f32 v72,v72,s36,v17
v_fma_f32 v73,v73,s36,v17
v_mfma_f32_16x16x32_bf16 v[80:83],a[208:211],a[160:163],v[80:83]
v_fma_f32 v74,v74,s36,v17
v_fma_f32 v75,v75,s36,v17
v_mfma_f32_16x16x32_bf16 v[80:83],a[212:215],a[164:167],v[80:83]
v_exp_f32 v72,v72
v_mfma_f32_16x16x32_bf16 v[68:71],a[216:219],a[96:99],0
v_exp_f32 v73,v73
v_mfma_f32_16x16x32_bf16 v[68:71],a[220:223],a[100:103],v[68:71]
v_exp_f32 v74,v74
v_mfma_f32_16x16x32_bf16 v[68:71],a[224:227],a[104:107],v[68:71]
v_exp_f32 v75,v75
v_mfma_f32_16x16x32_bf16 v[68:71],a[228:231],a[108:111],v[68:71]
v_cvt_pk_bf16_f32 v112,v64,v65
v_cvt_pk_bf16_f32 v113,v66,v67
s_waitcnt vmcnt(6)
s_barrier
v_mfma_f32_16x16x32_bf16 v[68:71],a[232:235],a[112:115],v[68:71]
v_cvt_pk_bf16_f32 v116,v72,v73
v_cvt_pk_bf16_f32 v117,v74,v75
v_mfma_f32_16x16x32_bf16 v[68:71],a[236:239],a[116:119],v[68:71]
ds_read_b64_tr_b16 a[240:241],v3 offset:24576
ds_read_b64_tr_b16 a[242:243],v3 offset:30720
v_mfma_f32_16x16x32_bf16 v[76:79],a[216:219],a[120:123],0
v_mfma_f32_16x16x32_bf16 v[76:79],a[220:223],a[124:127],v[76:79]
ds_read_b64_tr_b16 a[244:245],v4 offset:24576
ds_read_b64_tr_b16 a[246:247],v4 offset:30720
v_mfma_f32_16x16x32_bf16 v[76:79],a[224:227],a[128:131],v[76:79]
ds_read_b64_tr_b16 a[248:249],v5 offset:24576
ds_read_b64_tr_b16 a[250:251],v5 offset:30720
v_mfma_f32_16x16x32_bf16 v[76:79],a[228:231],a[132:135],v[76:79]
v_mfma_f32_16x16x32_bf16 v[76:79],a[232:235],a[136:139],v[76:79]
ds_read_b64_tr_b16 a[252:253],v6 offset:24576
ds_read_b64_tr_b16 a[254:255],v6 offset:30720
v_mfma_f32_16x16x32_bf16 v[76:79],a[236:239],a[140:143],v[76:79]
v_mfma_f32_16x16x32_bf16 v[84:87],a[216:219],a[144:147],0
v_mfma_f32_16x16x32_bf16 v[84:87],a[220:223],a[148:151],v[84:87]
v_mfma_f32_16x16x32_bf16 v[84:87],a[224:227],a[152:155],v[84:87]
v_mfma_f32_16x16x32_bf16 v[84:87],a[228:231],a[156:159],v[84:87]
v_mfma_f32_16x16x32_bf16 v[84:87],a[232:235],a[160:163],v[84:87]
v_mfma_f32_16x16x32_bf16 v[84:87],a[236:239],a[164:167],v[84:87]
s_mov_b32 s38,0
s_branch L_loop3
L_end4:
s_waitcnt lgkmcnt(4)
v_mfma_f32_16x16x32_bf16 v[160:163],a[240:243],v[96:99],v[160:163]
v_fma_f32 v68,v68,s36,v16
v_fma_f32 v69,v69,s36,v16
v_mfma_f32_16x16x32_bf16 v[208:211],a[240:243],v[100:103],v[208:211]
v_fma_f32 v70,v70,s36,v16
v_fma_f32 v71,v71,s36,v16
v_mfma_f32_16x16x32_bf16 a[0:3],a[240:243],v[104:107],a[0:3]
v_fma_f32 v76,v76,s36,v17
v_fma_f32 v77,v77,s36,v17
v_mfma_f32_16x16x32_bf16 a[48:51],a[240:243],v[108:111],a[48:51]
ds_read_b64_tr_b16 a[240:241],v3 offset:25600
ds_read_b64_tr_b16 a[242:243],v3 offset:31744
v_mfma_f32_16x16x32_bf16 v[164:167],a[244:247],v[96:99],v[164:167]
v_fma_f32 v78,v78,s36,v17
v_fma_f32 v79,v79,s36,v17
v_mfma_f32_16x16x32_bf16 v[212:215],a[244:247],v[100:103],v[212:215]
v_fma_f32 v80,v80,s36,v18
v_fma_f32 v81,v81,s36,v18
v_mfma_f32_16x16x32_bf16 a[4:7],a[244:247],v[104:107],a[4:7]
v_fma_f32 v82,v82,s36,v18
v_fma_f32 v83,v83,s36,v18
v_mfma_f32_16x16x32_bf16 a[52:55],a[244:247],v[108:111],a[52:55]
s_waitcnt lgkmcnt(2)
ds_read_b64_tr_b16 a[244:245],v4 offset:25600
ds_read_b64_tr_b16 a[246:247],v4 offset:31744
v_mfma_f32_16x16x32_bf16 v[168:171],a[248:251],v[96:99],v[168:171]
v_fma_f32 v84,v84,s36,v18
v_fma_f32 v85,v85,s36,v18
v_mfma_f32_16x16x32_bf16 v[216:219],a[248:251],v[100:103],v[216:219]
v_fma_f32 v86,v86,s36,v18
v_fma_f32 v87,v87,s36,v18
v_mfma_f32_16x16x32_bf16 a[8:11],a[248:251],v[104:107],a[8:11]
v_fma_f32 v88,v88,s36,v19
v_fma_f32 v89,v89,s36,v19
v_mfma_f32_16x16x32_bf16 a[56:59],a[248:251],v[108:111],a[56:59]
ds_read_b64_tr_b16 a[248:249],v5 offset:25600
ds_read_b64_tr_b16 a[250:251],v5 offset:31744
v_mfma_f32_16x16x32_bf16 v[172:175],a[252:255],v[96:99],v[172:175]
v_fma_f32 v90,v90,s36,v19
v_fma_f32 v91,v91,s36,v19
v_mfma_f32_16x16x32_bf16 v[220:223],a[252:255],v[100:103],v[220:223]
v_fma_f32 v92,v92,s36,v19
v_fma_f32 v93,v93,s36,v19
v_mfma_f32_16x16x32_bf16 a[12:15],a[252:255],v[104:107],a[12:15]
v_fma_f32 v94,v94,s36,v19
v_fma_f32 v95,v95,s36,v19
v_mfma_f32_16x16x32_bf16 a[60:63],a[252:255],v[108:111],a[60:63]
s_waitcnt lgkmcnt(3)
ds_read_b64_tr_b16 a[252:253],v6 offset:25600
ds_read_b64_tr_b16 a[254:255],v6 offset:31744
v_mfma_f32_16x16x32_bf16 v[176:179],a[240:243],v[96:99],v[176:179]
v_exp_f32 v68,v68
v_mfma_f32_16x16x32_bf16 v[224:227],a[240:243],v[100:103],v[224:227]
v_exp_f32 v69,v69
v_mfma_f32_16x16x32_bf16 a[16:19],a[240:243],v[104:107],a[16:19]
v_exp_f32 v70,v70
v_mfma_f32_16x16x32_bf16 a[64:67],a[240:243],v[108:111],a[64:67]
s_waitcnt lgkmcnt(3)
ds_read_b64_tr_b16 a[240:241],v3 offset:26624
ds_read_b64_tr_b16 a[242:243],v3 offset:32768
v_mfma_f32_16x16x32_bf16 v[180:183],a[244:247],v[96:99],v[180:183]
v_exp_f32 v71,v71
v_mfma_f32_16x16x32_bf16 v[228:231],a[244:247],v[100:103],v[228:231]
v_exp_f32 v76,v76
v_mfma_f32_16x16x32_bf16 a[20:23],a[244:247],v[104:107],a[20:23]
v_exp_f32 v77,v77
v_mfma_f32_16x16x32_bf16 a[68:71],a[244:247],v[108:111],a[68:71]
s_waitcnt lgkmcnt(2)
ds_read_b64_tr_b16 a[244:245],v4 offset:26624
ds_read_b64_tr_b16 a[246:247],v4 offset:32768
v_mfma_f32_16x16x32_bf16 v[184:187],a[248:251],v[96:99],v[184:187]
v_exp_f32 v78,v78
v_mfma_f32_16x16x32_bf16 v[232:235],a[248:251],v[100:103],v[232:235]
v_exp_f32 v79,v79
v_mfma_f32_16x16x32_bf16 a[24:27],a[248:251],v[104:107],a[24:27]
v_exp_f32 v80,v80
v_mfma_f32_16x16x32_bf16 a[72:75],a[248:251],v[108:111],a[72:75]
ds_read_b64_tr_b16 a[248:249],v5 offset:26624
ds_read_b64_tr_b16 a[250:251],v5 offset:32768
v_mfma_f32_16x16x32_bf16 v[188:191],a[252:255],v[96:99],v[188:191]
v_exp_f32 v81,v81
v_mfma_f32_16x16x32_bf16 v[236:239],a[252:255],v[100:103],v[236:239]
v_exp_f32 v82,v82
v_mfma_f32_16x16x32_bf16 a[28:31],a[252:255],v[104:107],a[28:31]
v_exp_f32 v83,v83
v_mfma_f32_16x16x32_bf16 a[76:79],a[252:255],v[108:111],a[76:79]
s_waitcnt lgkmcnt(3)
ds_read_b64_tr_b16 a[252:253],v6 offset:26624
ds_read_b64_tr_b16 a[254:255],v6 offset:32768
v_mfma_f32_16x16x32_bf16 v[192:195],a[240:243],v[96:99],v[192:195]
v_exp_f32 v84,v84
v_mfma_f32_16x16x32_bf16 v[240:243],a[240:243],v[100:103],v[240:243]
v_exp_f32 v85,v85
v_mfma_f32_16x16x32_bf16 a[32:35],a[240:243],v[104:107],a[32:35]
v_exp_f32 v86,v86
v_mfma_f32_16x16x32_bf16 a[80:83],a[240:243],v[108:111],a[80:83]
s_waitcnt lgkmcnt(3)
v_exp_f32 v87,v87
v_mfma_f32_16x16x32_bf16 v[196:199],a[244:247],v[96:99],v[196:199]
v_exp_f32 v88,v88
v_mfma_f32_16x16x32_bf16 v[244:247],a[244:247],v[100:103],v[244:247]
v_exp_f32 v89,v89
v_mfma_f32_16x16x32_bf16 a[36:39],a[244:247],v[104:107],a[36:39]
v_exp_f32 v90,v90
v_mfma_f32_16x16x32_bf16 a[84:87],a[244:247],v[108:111],a[84:87]
s_waitcnt lgkmcnt(1)
v_exp_f32 v91,v91
v_mfma_f32_16x16x32_bf16 v[200:203],a[248:251],v[96:99],v[200:203]
v_exp_f32 v92,v92
v_mfma_f32_16x16x32_bf16 v[248:251],a[248:251],v[100:103],v[248:251]
v_exp_f32 v93,v93
v_mfma_f32_16x16x32_bf16 a[40:43],a[248:251],v[104:107],a[40:43]
v_exp_f32 v94,v94
v_mfma_f32_16x16x32_bf16 a[88:91],a[248:251],v[108:111],a[88:91]
s_waitcnt lgkmcnt(0)
v_exp_f32 v95,v95
v_mfma_f32_16x16x32_bf16 v[204:207],a[252:255],v[96:99],v[204:207]
v_cvt_pk_bf16_f32 v114,v68,v69
v_cvt_pk_bf16_f32 v115,v70,v71
v_mfma_f32_16x16x32_bf16 v[252:255],a[252:255],v[100:103],v[252:255]
v_cvt_pk_bf16_f32 v118,v76,v77
v_cvt_pk_bf16_f32 v119,v78,v79
v_mfma_f32_16x16x32_bf16 v[128:131],v[24:27],v[112:115],v[128:131]
v_cvt_pk_bf16_f32 v120,v80,v81
v_cvt_pk_bf16_f32 v121,v82,v83
v_mfma_f32_16x16x32_bf16 v[132:135],v[24:27],v[116:119],v[132:135]
v_cvt_pk_bf16_f32 v122,v84,v85
v_cvt_pk_bf16_f32 v123,v86,v87
s_waitcnt vmcnt(5)
s_barrier
v_mfma_f32_16x16x32_bf16 v[136:139],v[24:27],v[120:123],v[136:139]
v_cvt_pk_bf16_f32 v124,v88,v89
v_cvt_pk_bf16_f32 v125,v90,v91
v_mfma_f32_16x16x32_bf16 a[44:47],a[252:255],v[104:107],a[44:47]
v_cvt_pk_bf16_f32 v126,v92,v93
v_cvt_pk_bf16_f32 v127,v94,v95
v_mfma_f32_16x16x32_bf16 a[92:95],a[252:255],v[108:111],a[92:95]
ds_read_b64_tr_b16 a[240:241],v3 offset:0
v_mfma_f32_16x16x32_bf16 v[140:143],v[24:27],v[124:127],v[140:143]
ds_read_b64_tr_b16 a[242:243],v3 offset:6144
ds_read_b64_tr_b16 a[244:245],v4 offset:0
ds_read_b64_tr_b16 a[246:247],v4 offset:6144
ds_read_b64_tr_b16 a[248:249],v5 offset:0
ds_read_b64_tr_b16 a[250:251],v5 offset:6144
ds_read_b64_tr_b16 a[252:253],v6 offset:0
ds_read_b64_tr_b16 a[254:255],v6 offset:6144
s_waitcnt lgkmcnt(6)
v_mfma_f32_16x16x32_bf16 v[160:163],a[240:243],v[112:115],v[160:163]
s_waitcnt vmcnt(0)
v_rcp_f32 v144,v128
s_add_u32 s84,s42,0
v_mfma_f32_16x16x32_bf16 v[208:211],a[240:243],v[116:119],v[208:211]
s_add_u32 s85,s42,6144
v_rcp_f32 v150,v140
s_add_u32 s86,s42,12288
v_mfma_f32_16x16x32_bf16 a[0:3],a[240:243],v[120:123],a[0:3]
s_add_u32 s87,s42,18432
v_rcp_f32 v146,v132
v_mfma_f32_16x16x32_bf16 a[48:51],a[240:243],v[124:127],a[48:51]
s_waitcnt lgkmcnt(4)
ds_read_b64_tr_b16 a[240:241],v3 offset:1024
ds_read_b64_tr_b16 a[242:243],v3 offset:7168
v_mfma_f32_16x16x32_bf16 v[164:167],a[244:247],v[112:115],v[164:167]
v_rcp_f32 v148,v136
v_mfma_f32_16x16x32_bf16 v[212:215],a[244:247],v[116:119],v[212:215]
v_max3_f32 v30,v128,v132,v136
v_max_f32 v30,v30,v140
v_mfma_f32_16x16x32_bf16 a[4:7],a[244:247],v[120:123],a[4:7]
v_accvgpr_read_b32 v64,a48
v_accvgpr_read_b32 v65,a49
v_mfma_f32_16x16x32_bf16 a[52:55],a[244:247],v[124:127],a[52:55]
ds_read_b64_tr_b16 a[244:245],v4 offset:1024
ds_read_b64_tr_b16 a[246:247],v4 offset:7168
v_accvgpr_read_b32 v66,a50
v_accvgpr_read_b32 v67,a51
v_cmp_nlt_f32 vcc,v30,v31
v_pk_mul_f32 v[64:65],v[64:65],v[150:151] op_sel_hi:[1,0]
v_pk_mul_f32 v[160:161],v[160:161],v[144:145] op_sel_hi:[1,0]
v_pk_mul_f32 v[162:163],v[162:163],v[144:145] op_sel_hi:[1,0]
v_pk_mul_f32 v[66:67],v[66:67],v[150:151] op_sel_hi:[1,0]
v_accvgpr_read_b32 v68,a52
v_accvgpr_read_b32 v69,a53
s_waitcnt lgkmcnt(4)
v_mfma_f32_16x16x32_bf16 v[168:171],a[248:251],v[112:115],v[168:171]
s_cmp_lg_u64 vcc,0
v_accvgpr_read_b32 v70,a54
v_accvgpr_read_b32 v71,a55
v_mfma_f32_16x16x32_bf16 v[216:219],a[248:251],v[116:119],v[216:219]
s_cselect_b32 s62,s32,0
v_cvt_pk_bf16_f32 v80,v64,v65
v_cvt_pk_bf16_f32 v82,v160,v161
v_mfma_f32_16x16x32_bf16 a[8:11],a[248:251],v[120:123],a[8:11]
s_or_b32 s31,s31,s62
v_cvt_pk_bf16_f32 v83,v162,v163
v_cvt_pk_bf16_f32 v81,v66,v67
s_lshl_b32 s32,s32,1
ds_write2st64_b64 v12,v[80:81],v[82:83] offset0:36 offset1:0
v_pk_mul_f32 v[68:69],v[68:69],v[150:151] op_sel_hi:[1,0]
v_pk_mul_f32 v[70:71],v[70:71],v[150:151] op_sel_hi:[1,0]
v_pk_mul_f32 v[164:165],v[164:165],v[144:145] op_sel_hi:[1,0]
v_pk_mul_f32 v[166:167],v[166:167],v[144:145] op_sel_hi:[1,0]
v_cvt_pk_bf16_f32 v84,v68,v69
v_cvt_pk_bf16_f32 v85,v70,v71
v_mfma_f32_16x16x32_bf16 a[56:59],a[248:251],v[124:127],a[56:59]
ds_read_b64_tr_b16 a[248:249],v5 offset:1024
ds_read_b64_tr_b16 a[250:251],v5 offset:7168
v_mfma_f32_16x16x32_bf16 v[172:175],a[252:255],v[112:115],v[172:175]
v_cvt_pk_bf16_f32 v86,v164,v165
v_cvt_pk_bf16_f32 v87,v166,v167
v_mfma_f32_16x16x32_bf16 v[220:223],a[252:255],v[116:119],v[220:223]
ds_write2st64_b64 v20,v[84:85],v[86:87] offset0:36 offset1:0
v_mfma_f32_16x16x32_bf16 a[12:15],a[252:255],v[120:123],a[12:15]
v_accvgpr_read_b32 v72,a56
v_accvgpr_read_b32 v73,a57
v_accvgpr_read_b32 v74,a58
v_accvgpr_read_b32 v75,a59
v_pk_mul_f32 v[168:169],v[168:169],v[144:145] op_sel_hi:[1,0]
v_pk_mul_f32 v[170:171],v[170:171],v[144:145] op_sel_hi:[1,0]
v_pk_mul_f32 v[72:73],v[72:73],v[150:151] op_sel_hi:[1,0]
v_pk_mul_f32 v[74:75],v[74:75],v[150:151] op_sel_hi:[1,0]
v_cvt_pk_bf16_f32 v90,v168,v169
v_cvt_pk_bf16_f32 v91,v170,v171
v_mfma_f32_16x16x32_bf16 a[60:63],a[252:255],v[124:127],a[60:63]
s_waitcnt lgkmcnt(3)
ds_read_b64_tr_b16 a[252:253],v6 offset:1024
ds_read_b64_tr_b16 a[254:255],v6 offset:7168
v_mfma_f32_16x16x32_bf16 v[176:179],a[240:243],v[112:115],v[176:179]
v_cvt_pk_bf16_f32 v88,v72,v73
v_cvt_pk_bf16_f32 v89,v74,v75
v_mfma_f32_16x16x32_bf16 v[224:227],a[240:243],v[116:119],v[224:227]
ds_write2st64_b64 v21,v[88:89],v[90:91] offset0:36 offset1:0
v_mfma_f32_16x16x32_bf16 a[16:19],a[240:243],v[120:123],a[16:19]
v_accvgpr_read_b32 v76,a60
v_accvgpr_read_b32 v77,a61
v_accvgpr_read_b32 v78,a62
v_accvgpr_read_b32 v79,a63
v_pk_mul_f32 v[172:173],v[172:173],v[144:145] op_sel_hi:[1,0]
v_pk_mul_f32 v[174:175],v[174:175],v[144:145] op_sel_hi:[1,0]
v_pk_mul_f32 v[76:77],v[76:77],v[150:151] op_sel_hi:[1,0]
v_pk_mul_f32 v[78:79],v[78:79],v[150:151] op_sel_hi:[1,0]
v_cvt_pk_bf16_f32 v94,v172,v173
v_cvt_pk_bf16_f32 v95,v174,v175
v_mfma_f32_16x16x32_bf16 a[64:67],a[240:243],v[124:127],a[64:67]
ds_read_b64_tr_b16 a[240:241],v3 offset:2048
ds_read_b64_tr_b16 a[242:243],v3 offset:8192
v_cvt_pk_bf16_f32 v92,v76,v77
v_cvt_pk_bf16_f32 v93,v78,v79
v_pk_mul_f32 v[208:209],v[208:209],v[146:147] op_sel_hi:[1,0]
v_pk_mul_f32 v[210:211],v[210:211],v[146:147] op_sel_hi:[1,0]
v_pk_mul_f32 v[176:177],v[176:177],v[144:145] op_sel_hi:[1,0]
v_pk_mul_f32 v[178:179],v[178:179],v[144:145] op_sel_hi:[1,0]
v_cvt_pk_bf16_f32 v80,v208,v209
v_cvt_pk_bf16_f32 v81,v210,v211
v_mfma_f32_16x16x32_bf16 v[180:183],a[244:247],v[112:115],v[180:183]
ds_write2st64_b64 v22,v[92:93],v[94:95] offset0:36 offset1:0
v_mfma_f32_16x16x32_bf16 v[228:231],a[244:247],v[116:119],v[228:231]
v_cvt_pk_bf16_f32 v82,v176,v177
v_cvt_pk_bf16_f32 v83,v178,v179
v_mfma_f32_16x16x32_bf16 a[20:23],a[244:247],v[120:123],a[20:23]
v_accvgpr_read_b32 v64,a64
v_accvgpr_read_b32 v65,a65
v_mfma_f32_16x16x32_bf16 a[68:71],a[244:247],v[124:127],a[68:71]
ds_read_b64_tr_b16 a[244:245],v4 offset:2048
ds_read_b64_tr_b16 a[246:247],v4 offset:8192
ds_read_b128 v[152:155],v15 offset:18432
v_accvgpr_read_b32 v66,a66
v_accvgpr_read_b32 v67,a67
v_pk_mul_f32 v[212:213],v[212:213],v[146:147] op_sel_hi:[1,0]
v_pk_mul_f32 v[214:215],v[214:215],v[146:147] op_sel_hi:[1,0]
v_pk_mul_f32 v[180:181],v[180:181],v[144:145] op_sel_hi:[1,0]
v_pk_mul_f32 v[182:183],v[182:183],v[144:145] op_sel_hi:[1,0]
v_accvgpr_read_b32 v68,a68
v_accvgpr_read_b32 v69,a69
s_waitcnt lgkmcnt(4)
v_mfma_f32_16x16x32_bf16 v[184:187],a[248:251],v[112:115],v[184:187]
ds_read_b128 v[156:159],v15 offset:21504
v_accvgpr_read_b32 v70,a70
v_mfma_f32_16x16x32_bf16 v[232:235],a[248:251],v[116:119],v[232:235]
ds_read_b128 v[100:103],v15 offset:0
v_accvgpr_read_b32 v71,a71
v_mfma_f32_16x16x32_bf16 a[24:27],a[248:251],v[120:123],a[24:27]
ds_read_b128 v[104:107],v15 offset:3072
v_cvt_pk_bf16_f32 v84,v212,v213
v_mfma_f32_16x16x32_bf16 a[72:75],a[248:251],v[124:127],a[72:75]
ds_read_b64_tr_b16 a[248:249],v5 offset:2048
ds_read_b64_tr_b16 a[250:251],v5 offset:8192
ds_write2st64_b64 v12,v[80:81],v[82:83] offset0:12 offset1:2
v_pk_mul_f32 v[216:217],v[216:217],v[146:147] op_sel_hi:[1,0]
v_pk_mul_f32 v[218:219],v[218:219],v[146:147] op_sel_hi:[1,0]
v_pk_mul_f32 v[184:185],v[184:185],v[144:145] op_sel_hi:[1,0]
v_pk_mul_f32 v[186:187],v[186:187],v[144:145] op_sel_hi:[1,0]
v_cvt_pk_bf16_f32 v85,v214,v215
v_cvt_pk_bf16_f32 v86,v180,v181
v_mfma_f32_16x16x32_bf16 v[188:191],a[252:255],v[112:115],v[188:191]
s_waitcnt lgkmcnt(6)
buffer_store_dwordx4 v[152:155],v10,s[16:19],s87 offen offset:0 nt
v_mfma_f32_16x16x32_bf16 v[236:239],a[252:255],v[116:119],v[236:239]
v_cvt_pk_bf16_f32 v87,v182,v183
v_accvgpr_read_b32 v72,a72
v_mfma_f32_16x16x32_bf16 a[28:31],a[252:255],v[120:123],a[28:31]
v_accvgpr_read_b32 v73,a73
v_accvgpr_read_b32 v74,a74
v_mfma_f32_16x16x32_bf16 a[76:79],a[252:255],v[124:127],a[76:79]
ds_read_b64_tr_b16 a[252:253],v6 offset:2048
ds_read_b64_tr_b16 a[254:255],v6 offset:8192
ds_write2st64_b64 v20,v[84:85],v[86:87] offset0:12 offset1:2
v_pk_mul_f32 v[220:221],v[220:221],v[146:147] op_sel_hi:[1,0]
v_pk_mul_f32 v[222:223],v[222:223],v[146:147] op_sel_hi:[1,0]
v_pk_mul_f32 v[188:189],v[188:189],v[144:145] op_sel_hi:[1,0]
v_pk_mul_f32 v[190:191],v[190:191],v[144:145] op_sel_hi:[1,0]
v_pk_mul_f32 v[64:65],v[64:65],v[150:151] op_sel_hi:[1,0]
v_pk_mul_f32 v[66:67],v[66:67],v[150:151] op_sel_hi:[1,0]
v_pk_mul_f32 v[224:225],v[224:225],v[146:147] op_sel_hi:[1,0]
v_pk_mul_f32 v[226:227],v[226:227],v[146:147] op_sel_hi:[1,0]
v_pk_mul_f32 v[68:69],v[68:69],v[150:151] op_sel_hi:[1,0]
v_pk_mul_f32 v[70:71],v[70:71],v[150:151] op_sel_hi:[1,0]
v_pk_mul_f32 v[228:229],v[228:229],v[146:147] op_sel_hi:[1,0]
v_pk_mul_f32 v[230:231],v[230:231],v[146:147] op_sel_hi:[1,0]
v_pk_mul_f32 v[72:73],v[72:73],v[150:151] op_sel_hi:[1,0]
v_pk_mul_f32 v[232:233],v[232:233],v[146:147] op_sel_hi:[1,0]
v_pk_mul_f32 v[234:235],v[234:235],v[146:147] op_sel_hi:[1,0]
v_accvgpr_read_b32 v75,a75
v_pk_mul_f32 v[74:75],v[74:75],v[150:151] op_sel_hi:[1,0]
v_cvt_pk_bf16_f32 v88,v216,v217
v_cvt_pk_bf16_f32 v89,v218,v219
v_mfma_f32_16x16x32_bf16 v[192:195],a[240:243],v[112:115],v[192:195]
s_waitcnt lgkmcnt(3)
buffer_store_dwordx4 v[156:159],v10,s[16:19],s87 offen offset:3072 nt
v_mfma_f32_16x16x32_bf16 v[240:243],a[240:243],v[116:119],v[240:243]
v_cvt_pk_bf16_f32 v90,v184,v185
v_cvt_pk_bf16_f32 v91,v186,v187
v_mfma_f32_16x16x32_bf16 a[32:35],a[240:243],v[120:123],a[32:35]
v_cvt_pk_bf16_f32 v92,v220,v221
v_cvt_pk_bf16_f32 v93,v222,v223
v_cvt_pk_bf16_f32 v94,v188,v189
v_cvt_pk_bf16_f32 v95,v190,v191
v_accvgpr_read_b32 v76,a76
v_pk_mul_f32 v[236:237],v[236:237],v[146:147] op_sel_hi:[1,0]
v_pk_mul_f32 v[238:239],v[238:239],v[146:147] op_sel_hi:[1,0]
v_accvgpr_read_b32 v77,a77
v_pk_mul_f32 v[76:77],v[76:77],v[150:151] op_sel_hi:[1,0]
v_accvgpr_read_b32 v78,a78
v_accvgpr_read_b32 v79,a79
v_pk_mul_f32 v[78:79],v[78:79],v[150:151] op_sel_hi:[1,0]
v_cvt_pk_bf16_f32 v80,v64,v65
v_cvt_pk_bf16_f32 v81,v66,v67
v_mfma_f32_16x16x32_bf16 a[80:83],a[240:243],v[124:127],a[80:83]
ds_write2st64_b64 v21,v[88:89],v[90:91] offset0:12 offset1:2
v_mfma_f32_16x16x32_bf16 v[196:199],a[244:247],v[112:115],v[196:199]
v_cvt_pk_bf16_f32 v82,v224,v225
v_cvt_pk_bf16_f32 v83,v226,v227
v_mfma_f32_16x16x32_bf16 v[244:247],a[244:247],v[116:119],v[244:247]
v_cvt_pk_bf16_f32 v84,v68,v69
v_cvt_pk_bf16_f32 v85,v70,v71
v_mfma_f32_16x16x32_bf16 a[36:39],a[244:247],v[120:123],a[36:39]
ds_write2st64_b64 v22,v[92:93],v[94:95] offset0:12 offset1:2
v_pk_mul_f32 v[192:193],v[192:193],v[144:145] op_sel_hi:[1,0]
v_pk_mul_f32 v[194:195],v[194:195],v[144:145] op_sel_hi:[1,0]
v_accvgpr_read_b32 v64,a80
v_accvgpr_read_b32 v65,a81
v_pk_mul_f32 v[64:65],v[64:65],v[150:151] op_sel_hi:[1,0]
v_accvgpr_read_b32 v66,a82
v_accvgpr_read_b32 v67,a83
v_pk_mul_f32 v[66:67],v[66:67],v[150:151] op_sel_hi:[1,0]
v_cvt_pk_bf16_f32 v86,v228,v229
v_cvt_pk_bf16_f32 v87,v230,v231
v_mfma_f32_16x16x32_bf16 a[84:87],a[244:247],v[124:127],a[84:87]
ds_read_b128 v[152:155],v15 offset:6144
buffer_store_dwordx4 v[100:103],v10,s[16:19],s84 offen offset:0 nt
v_mfma_f32_16x16x32_bf16 v[200:203],a[248:251],v[112:115],v[200:203]
v_cvt_pk_bf16_f32 v88,v72,v73
v_cvt_pk_bf16_f32 v89,v74,v75
v_mfma_f32_16x16x32_bf16 v[248:251],a[248:251],v[116:119],v[248:251]
v_cvt_pk_bf16_f32 v90,v232,v233
v_cvt_pk_bf16_f32 v91,v234,v235
v_mfma_f32_16x16x32_bf16 a[40:43],a[248:251],v[120:123],a[40:43]
ds_read_b128 v[156:159],v15 offset:9216
v_cvt_pk_bf16_f32 v92,v76,v77
v_cvt_pk_bf16_f32 v93,v78,v79
v_cvt_pk_bf16_f32 v94,v236,v237
v_cvt_pk_bf16_f32 v95,v238,v239
v_pk_mul_f32 v[196:197],v[196:197],v[144:145] op_sel_hi:[1,0]
v_pk_mul_f32 v[198:199],v[198:199],v[144:145] op_sel_hi:[1,0]
v_accvgpr_read_b32 v68,a84
v_accvgpr_read_b32 v69,a85
v_pk_mul_f32 v[68:69],v[68:69],v[150:151] op_sel_hi:[1,0]
v_accvgpr_read_b32 v70,a86
v_accvgpr_read_b32 v71,a87
v_pk_mul_f32 v[70:71],v[70:71],v[150:151] op_sel_hi:[1,0]
ds_read_b128 v[100:103],v15 offset:1024
buffer_store_dwordx4 v[104:107],v10,s[16:19],s84 offen offset:3072 nt
v_mfma_f32_16x16x32_bf16 a[88:91],a[248:251],v[124:127],a[88:91]
s_waitcnt lgkmcnt(2)
v_mfma_f32_16x16x32_bf16 v[204:207],a[252:255],v[112:115],v[204:207]
v_mfma_f32_16x16x32_bf16 v[252:255],a[252:255],v[116:119],v[252:255]
ds_read_b128 v[104:107],v15 offset:4096
v_mfma_f32_16x16x32_bf16 a[44:47],a[252:255],v[120:123],a[44:47]
ds_write2st64_b64 v12,v[80:81],v[82:83] offset0:36 offset1:14
v_pk_mul_f32 v[200:201],v[200:201],v[144:145] op_sel_hi:[1,0]
v_pk_mul_f32 v[202:203],v[202:203],v[144:145] op_sel_hi:[1,0]
v_cvt_pk_bf16_f32 v80,v64,v65
v_accvgpr_read_b32 v72,a88
v_accvgpr_read_b32 v73,a89
v_pk_mul_f32 v[72:73],v[72:73],v[150:151] op_sel_hi:[1,0]
v_accvgpr_read_b32 v74,a90
v_accvgpr_read_b32 v75,a91
v_pk_mul_f32 v[74:75],v[74:75],v[150:151] op_sel_hi:[1,0]
v_cvt_pk_bf16_f32 v81,v66,v67
v_cvt_pk_bf16_f32 v82,v192,v193
v_mfma_f32_16x16x32_bf16 a[92:95],a[252:255],v[124:127],a[92:95]
ds_write2st64_b64 v20,v[84:85],v[86:87] offset0:36 offset1:14
v_pk_mul_f32 v[204:205],v[204:205],v[144:145] op_sel_hi:[1,0]
v_pk_mul_f32 v[206:207],v[206:207],v[144:145] op_sel_hi:[1,0]
v_pk_mul_f32 v[240:241],v[240:241],v[146:147] op_sel_hi:[1,0]
v_pk_mul_f32 v[242:243],v[242:243],v[146:147] op_sel_hi:[1,0]
v_pk_mul_f32 v[244:245],v[244:245],v[146:147] op_sel_hi:[1,0]
v_pk_mul_f32 v[246:247],v[246:247],v[146:147] op_sel_hi:[1,0]
v_pk_mul_f32 v[248:249],v[248:249],v[146:147] op_sel_hi:[1,0]
v_pk_mul_f32 v[250:251],v[250:251],v[146:147] op_sel_hi:[1,0]
v_pk_mul_f32 v[252:253],v[252:253],v[146:147] op_sel_hi:[1,0]
v_pk_mul_f32 v[254:255],v[254:255],v[146:147] op_sel_hi:[1,0]
v_cvt_pk_bf16_f32 v83,v194,v195
v_accvgpr_read_b32 v76,a92
v_accvgpr_read_b32 v77,a93
v_pk_mul_f32 v[76:77],v[76:77],v[150:151] op_sel_hi:[1,0]
v_accvgpr_read_b32 v78,a94
v_accvgpr_read_b32 v79,a95
v_pk_mul_f32 v[78:79],v[78:79],v[150:151] op_sel_hi:[1,0]
v_cvt_pk_bf16_f32 v84,v68,v69
v_cvt_pk_bf16_f32 v85,v70,v71
v_cvt_pk_bf16_f32 v86,v196,v197
v_cvt_pk_bf16_f32 v87,v198,v199
v_accvgpr_read_b32 v64,a0
v_accvgpr_read_b32 v65,a1
v_pk_mul_f32 v[64:65],v[64:65],v[148:149] op_sel_hi:[1,0]
v_accvgpr_read_b32 v66,a2
v_accvgpr_read_b32 v67,a3
v_pk_mul_f32 v[66:67],v[66:67],v[148:149] op_sel_hi:[1,0]
v_accvgpr_read_b32 v68,a4
v_accvgpr_read_b32 v69,a5
v_pk_mul_f32 v[68:69],v[68:69],v[148:149] op_sel_hi:[1,0]
v_accvgpr_read_b32 v70,a6
v_accvgpr_read_b32 v71,a7
v_pk_mul_f32 v[70:71],v[70:71],v[148:149] op_sel_hi:[1,0]
ds_write2st64_b64 v21,v[88:89],v[90:91] offset0:36 offset1:14
v_cvt_pk_bf16_f32 v88,v72,v73
v_cvt_pk_bf16_f32 v89,v74,v75
v_cvt_pk_bf16_f32 v90,v200,v201
v_cvt_pk_bf16_f32 v91,v202,v203
v_accvgpr_read_b32 v72,a8
v_accvgpr_read_b32 v73,a9
v_pk_mul_f32 v[72:73],v[72:73],v[148:149] op_sel_hi:[1,0]
v_accvgpr_read_b32 v74,a10
v_accvgpr_read_b32 v75,a11
v_pk_mul_f32 v[74:75],v[74:75],v[148:149] op_sel_hi:[1,0]
ds_write2st64_b64 v22,v[92:93],v[94:95] offset0:36 offset1:14
v_cvt_pk_bf16_f32 v92,v76,v77
v_cvt_pk_bf16_f32 v93,v78,v79
v_cvt_pk_bf16_f32 v94,v204,v205
v_cvt_pk_bf16_f32 v95,v206,v207
v_accvgpr_read_b32 v76,a12
v_accvgpr_read_b32 v77,a13
v_pk_mul_f32 v[76:77],v[76:77],v[148:149] op_sel_hi:[1,0]
v_accvgpr_read_b32 v78,a14
v_accvgpr_read_b32 v79,a15
v_pk_mul_f32 v[78:79],v[78:79],v[148:149] op_sel_hi:[1,0]
buffer_store_dwordx4 v[152:155],v10,s[16:19],s85 offen offset:0 nt
s_waitcnt lgkmcnt(1)
buffer_store_dwordx4 v[156:159],v10,s[16:19],s85 offen offset:3072 nt
ds_read_b128 v[152:155],v15 offset:18432
ds_read_b128 v[156:159],v15 offset:21504
buffer_store_dwordx4 v[100:103],v10,s[16:19],s84 offen offset:128 nt
buffer_store_dwordx4 v[104:107],v10,s[16:19],s84 offen offset:3200 nt
ds_read_b128 v[100:103],v15 offset:7168
ds_read_b128 v[104:107],v15 offset:10240
s_waitcnt lgkmcnt(3)
buffer_store_dwordx4 v[152:155],v10,s[16:19],s87 offen offset:128 nt
ds_write2st64_b64 v12,v[80:81],v[82:83] offset0:36 offset1:4
v_cvt_pk_bf16_f32 v80,v240,v241
v_cvt_pk_bf16_f32 v81,v242,v243
v_cvt_pk_bf16_f32 v82,v64,v65
v_cvt_pk_bf16_f32 v83,v66,v67
v_accvgpr_read_b32 v64,a16
v_accvgpr_read_b32 v65,a17
v_pk_mul_f32 v[64:65],v[64:65],v[148:149] op_sel_hi:[1,0]
v_accvgpr_read_b32 v66,a18
v_accvgpr_read_b32 v67,a19
v_pk_mul_f32 v[66:67],v[66:67],v[148:149] op_sel_hi:[1,0]
ds_write2st64_b64 v20,v[84:85],v[86:87] offset0:36 offset1:4
v_cvt_pk_bf16_f32 v84,v244,v245
v_cvt_pk_bf16_f32 v85,v246,v247
v_cvt_pk_bf16_f32 v86,v68,v69
v_cvt_pk_bf16_f32 v87,v70,v71
v_accvgpr_read_b32 v68,a32
v_accvgpr_read_b32 v69,a33
v_pk_mul_f32 v[68:69],v[68:69],v[148:149] op_sel_hi:[1,0]
v_accvgpr_read_b32 v70,a34
v_accvgpr_read_b32 v71,a35
v_pk_mul_f32 v[70:71],v[70:71],v[148:149] op_sel_hi:[1,0]
ds_write2st64_b64 v21,v[88:89],v[90:91] offset0:36 offset1:4
v_cvt_pk_bf16_f32 v88,v248,v249
v_cvt_pk_bf16_f32 v89,v250,v251
v_cvt_pk_bf16_f32 v90,v72,v73
v_cvt_pk_bf16_f32 v91,v74,v75
v_accvgpr_read_b32 v72,a20
v_accvgpr_read_b32 v73,a21
v_pk_mul_f32 v[72:73],v[72:73],v[148:149] op_sel_hi:[1,0]
v_accvgpr_read_b32 v74,a22
v_accvgpr_read_b32 v75,a23
v_pk_mul_f32 v[74:75],v[74:75],v[148:149] op_sel_hi:[1,0]
ds_write2st64_b64 v22,v[92:93],v[94:95] offset0:36 offset1:4
v_cvt_pk_bf16_f32 v92,v252,v253
v_cvt_pk_bf16_f32 v93,v254,v255
v_cvt_pk_bf16_f32 v94,v76,v77
v_cvt_pk_bf16_f32 v95,v78,v79
v_accvgpr_read_b32 v76,a36
v_accvgpr_read_b32 v77,a37
v_pk_mul_f32 v[76:77],v[76:77],v[148:149] op_sel_hi:[1,0]
v_accvgpr_read_b32 v78,a38
v_accvgpr_read_b32 v79,a39
v_pk_mul_f32 v[78:79],v[78:79],v[148:149] op_sel_hi:[1,0]
ds_read_b128 v[152:155],v15 offset:18432
s_waitcnt lgkmcnt(2)
buffer_store_dwordx4 v[156:159],v10,s[16:19],s87 offen offset:3200 nt
buffer_store_dwordx4 v[100:103],v10,s[16:19],s85 offen offset:128 nt
ds_read_b128 v[156:159],v15 offset:21504
ds_read_b128 v[100:103],v15 offset:2048
buffer_store_dwordx4 v[104:107],v10,s[16:19],s85 offen offset:3200 nt
s_waitcnt lgkmcnt(2)
buffer_store_dwordx4 v[152:155],v10,s[16:19],s87 offen offset:256 nt
ds_read_b128 v[104:107],v15 offset:5120
ds_write2st64_b64 v12,v[80:81],v[82:83] offset0:16 offset1:24
v_cvt_pk_bf16_f32 v80,v64,v65
v_cvt_pk_bf16_f32 v81,v66,v67
v_cvt_pk_bf16_f32 v82,v68,v69
v_cvt_pk_bf16_f32 v83,v70,v71
v_accvgpr_read_b32 v64,a24
v_accvgpr_read_b32 v65,a25
v_pk_mul_f32 v[64:65],v[64:65],v[148:149] op_sel_hi:[1,0]
v_accvgpr_read_b32 v66,a26
v_accvgpr_read_b32 v67,a27
v_pk_mul_f32 v[66:67],v[66:67],v[148:149] op_sel_hi:[1,0]
v_accvgpr_read_b32 v68,a40
v_accvgpr_read_b32 v69,a41
v_pk_mul_f32 v[68:69],v[68:69],v[148:149] op_sel_hi:[1,0]
v_accvgpr_read_b32 v70,a42
v_accvgpr_read_b32 v71,a43
v_pk_mul_f32 v[70:71],v[70:71],v[148:149] op_sel_hi:[1,0]
ds_write2st64_b64 v20,v[84:85],v[86:87] offset0:16 offset1:24
v_cvt_pk_bf16_f32 v84,v72,v73
v_cvt_pk_bf16_f32 v85,v74,v75
v_cvt_pk_bf16_f32 v86,v76,v77
v_cvt_pk_bf16_f32 v87,v78,v79
v_accvgpr_read_b32 v72,a28
v_accvgpr_read_b32 v73,a29
v_pk_mul_f32 v[72:73],v[72:73],v[148:149] op_sel_hi:[1,0]
v_accvgpr_read_b32 v74,a30
v_accvgpr_read_b32 v75,a31
v_pk_mul_f32 v[74:75],v[74:75],v[148:149] op_sel_hi:[1,0]
v_accvgpr_read_b32 v76,a44
v_accvgpr_read_b32 v77,a45
v_pk_mul_f32 v[76:77],v[76:77],v[148:149] op_sel_hi:[1,0]
v_accvgpr_read_b32 v78,a46
v_accvgpr_read_b32 v79,a47
v_pk_mul_f32 v[78:79],v[78:79],v[148:149] op_sel_hi:[1,0]
ds_write2st64_b64 v21,v[88:89],v[90:91] offset0:16 offset1:24
v_cvt_pk_bf16_f32 v88,v64,v65
v_cvt_pk_bf16_f32 v89,v66,v67
v_cvt_pk_bf16_f32 v90,v68,v69
v_cvt_pk_bf16_f32 v91,v70,v71
ds_write2st64_b64 v22,v[92:93],v[94:95] offset0:16 offset1:24
v_cvt_pk_bf16_f32 v92,v72,v73
v_cvt_pk_bf16_f32 v93,v74,v75
v_cvt_pk_bf16_f32 v94,v76,v77
v_cvt_pk_bf16_f32 v95,v78,v79
ds_read_b128 v[152:155],v15 offset:8192
s_waitcnt lgkmcnt(3)
buffer_store_dwordx4 v[156:159],v10,s[16:19],s87 offen offset:3328 nt
buffer_store_dwordx4 v[100:103],v10,s[16:19],s84 offen offset:256 nt
ds_read_b128 v[156:159],v15 offset:11264
ds_read_b128 v[100:103],v15 offset:12288
buffer_store_dwordx4 v[104:107],v10,s[16:19],s84 offen offset:3328 nt
s_waitcnt lgkmcnt(2)
buffer_store_dwordx4 v[152:155],v10,s[16:19],s85 offen offset:256 nt
ds_read_b128 v[104:107],v15 offset:15360
ds_write2st64_b64 v12,v[80:81],v[82:83] offset0:26 offset1:28
ds_write2st64_b64 v20,v[84:85],v[86:87] offset0:26 offset1:28
ds_write2st64_b64 v21,v[88:89],v[90:91] offset0:26 offset1:28
ds_write2st64_b64 v22,v[92:93],v[94:95] offset0:26 offset1:28
ds_read_b128 v[152:155],v15 offset:13312
s_waitcnt lgkmcnt(3)
buffer_store_dwordx4 v[156:159],v10,s[16:19],s85 offen offset:3328 nt
buffer_store_dwordx4 v[100:103],v10,s[16:19],s86 offen offset:0 nt
ds_read_b128 v[156:159],v15 offset:16384
ds_read_b128 v[100:103],v15 offset:14336
buffer_store_dwordx4 v[104:107],v10,s[16:19],s86 offen offset:3072 nt
s_waitcnt lgkmcnt(2)
buffer_store_dwordx4 v[152:155],v10,s[16:19],s86 offen offset:128 nt
ds_read_b128 v[104:107],v15 offset:17408
s_waitcnt lgkmcnt(2)
buffer_store_dwordx4 v[156:159],v10,s[16:19],s86 offen offset:3200 nt
s_waitcnt lgkmcnt(1)
buffer_store_dwordx4 v[100:103],v10,s[16:19],s86 offen offset:256 nt
s_waitcnt lgkmcnt(0)
buffer_store_dwordx4 v[104:107],v10,s[16:19],s86 offen offset:3328 nt
s_branch L_fin
L_end3:
s_waitcnt lgkmcnt(4)
v_mfma_f32_16x16x32_bf16 v[160:163],a[240:243],v[96:99],v[160:163]
v_fma_f32 v68,v68,s36,v16
v_fma_f32 v69,v69,s36,v16
v_mfma_f32_16x16x32_bf16 v[208:211],a[240:243],v[100:103],v[208:211]
v_fma_f32 v70,v70,s36,v16
v_fma_f32 v71,v71,s36,v16
v_mfma_f32_16x16x32_bf16 a[0:3],a[240:243],v[104:107],a[0:3]
ds_read_b64_tr_b16 a[240:241],v3 offset:25600
ds_read_b64_tr_b16 a[242:243],v3 offset:31744
v_mfma_f32_16x16x32_bf16 v[164:167],a[244:247],v[96:99],v[164:167]
v_fma_f32 v76,v76,s36,v17
v_fma_f32 v77,v77,s36,v17
v_mfma_f32_16x16x32_bf16 v[212:215],a[244:247],v[100:103],v[212:215]
v_fma_f32 v78,v78,s36,v17
v_fma_f32 v79,v79,s36,v17
v_mfma_f32_16x16x32_bf16 a[4:7],a[244:247],v[104:107],a[4:7]
s_waitcnt lgkmcnt(2)
ds_read_b64_tr_b16 a[244:245],v4 offset:25600
ds_read_b64_tr_b16 a[246:247],v4 offset:31744
v_mfma_f32_16x16x32_bf16 v[168:171],a[248:251],v[96:99],v[168:171]
v_fma_f32 v80,v80,s36,v18
v_fma_f32 v81,v81,s36,v18
v_mfma_f32_16x16x32_bf16 v[216:219],a[248:251],v[100:103],v[216:219]
v_fma_f32 v82,v82,s36,v18
v_fma_f32 v83,v83,s36,v18
v_mfma_f32_16x16x32_bf16 a[8:11],a[248:251],v[104:107],a[8:11]
ds_read_b64_tr_b16 a[248:249],v5 offset:25600
ds_read_b64_tr_b16 a[250:251],v5 offset:31744
v_mfma_f32_16x16x32_bf16 v[172:175],a[252:255],v[96:99],v[172:175]
v_fma_f32 v84,v84,s36,v18
v_fma_f32 v85,v85,s36,v18
v_mfma_f32_16x16x32_bf16 v[220:223],a[252:255],v[100:103],v[220:223]
v_fma_f32 v86,v86,s36,v18
v_fma_f32 v87,v87,s36,v18
v_mfma_f32_16x16x32_bf16 a[12:15],a[252:255],v[104:107],a[12:15]
s_waitcnt lgkmcnt(4)
ds_read_b64_tr_b16 a[252:253],v6 offset:25600
ds_read_b64_tr_b16 a[254:255],v6 offset:31744
v_mfma_f32_16x16x32_bf16 v[176:179],a[240:243],v[96:99],v[176:179]
v_exp_f32 v68,v68
v_mfma_f32_16x16x32_bf16 v[224:227],a[240:243],v[100:103],v[224:227]
v_exp_f32 v69,v69
v_mfma_f32_16x16x32_bf16 a[16:19],a[240:243],v[104:107],a[16:19]
s_waitcnt lgkmcnt(4)
ds_read_b64_tr_b16 a[240:241],v3 offset:26624
ds_read_b64_tr_b16 a[242:243],v3 offset:32768
v_mfma_f32_16x16x32_bf16 v[180:183],a[244:247],v[96:99],v[180:183]
v_exp_f32 v70,v70
v_mfma_f32_16x16x32_bf16 v[228:231],a[244:247],v[100:103],v[228:231]
v_exp_f32 v71,v71
v_mfma_f32_16x16x32_bf16 a[20:23],a[244:247],v[104:107],a[20:23]
s_waitcnt lgkmcnt(4)
ds_read_b64_tr_b16 a[244:245],v4 offset:26624
ds_read_b64_tr_b16 a[246:247],v4 offset:32768
v_mfma_f32_16x16x32_bf16 v[184:187],a[248:251],v[96:99],v[184:187]
v_exp_f32 v76,v76
v_mfma_f32_16x16x32_bf16 v[232:235],a[248:251],v[100:103],v[232:235]
v_exp_f32 v77,v77
v_mfma_f32_16x16x32_bf16 a[24:27],a[248:251],v[104:107],a[24:27]
s_waitcnt lgkmcnt(4)
ds_read_b64_tr_b16 a[248:249],v5 offset:26624
ds_read_b64_tr_b16 a[250:251],v5 offset:32768
v_mfma_f32_16x16x32_bf16 v[188:191],a[252:255],v[96:99],v[188:191]
v_exp_f32 v78,v78
v_mfma_f32_16x16x32_bf16 v[236:239],a[252:255],v[100:103],v[236:239]
v_exp_f32 v79,v79
v_mfma_f32_16x16x32_bf16 a[28:31],a[252:255],v[104:107],a[28:31]
s_waitcnt lgkmcnt(4)
ds_read_b64_tr_b16 a[252:253],v6 offset:26624
ds_read_b64_tr_b16 a[254:255],v6 offset:32768
v_mfma_f32_16x16x32_bf16 v[192:195],a[240:243],v[96:99],v[192:195]
v_exp_f32 v80,v80
v_mfma_f32_16x16x32_bf16 v[240:243],a[240:243],v[100:103],v[240:243]
v_exp_f32 v81,v81
v_mfma_f32_16x16x32_bf16 a[32:35],a[240:243],v[104:107],a[32:35]
s_waitcnt lgkmcnt(4)
v_exp_f32 v82,v82
v_mfma_f32_16x16x32_bf16 v[196:199],a[244:247],v[96:99],v[196:199]
v_exp_f32 v83,v83
v_mfma_f32_16x16x32_bf16 v[244:247],a[244:247],v[100:103],v[244:247]
v_exp_f32 v84,v84
v_mfma_f32_16x16x32_bf16 a[36:39],a[244:247],v[104:107],a[36:39]
s_waitcnt lgkmcnt(2)
v_exp_f32 v85,v85
v_mfma_f32_16x16x32_bf16 v[200:203],a[248:251],v[96:99],v[200:203]
v_exp_f32 v86,v86
v_mfma_f32_16x16x32_bf16 v[248:251],a[248:251],v[100:103],v[248:251]
v_exp_f32 v87,v87
v_mfma_f32_16x16x32_bf16 a[40:43],a[248:251],v[104:107],a[40:43]
s_waitcnt lgkmcnt(0)
v_cvt_pk_bf16_f32 v114,v68,v69
v_cvt_pk_bf16_f32 v115,v70,v71
v_mfma_f32_16x16x32_bf16 v[204:207],a[252:255],v[96:99],v[204:207]
v_cvt_pk_bf16_f32 v118,v76,v77
v_cvt_pk_bf16_f32 v119,v78,v79
v_mfma_f32_16x16x32_bf16 v[128:131],v[24:27],v[112:115],v[128:131]
v_cvt_pk_bf16_f32 v120,v80,v81
v_cvt_pk_bf16_f32 v121,v82,v83
v_mfma_f32_16x16x32_bf16 v[132:135],v[24:27],v[116:119],v[132:135]
v_cvt_pk_bf16_f32 v122,v84,v85
v_cvt_pk_bf16_f32 v123,v86,v87
s_waitcnt vmcnt(5)
s_barrier
v_mfma_f32_16x16x32_bf16 v[136:139],v[24:27],v[120:123],v[136:139]
v_mfma_f32_16x16x32_bf16 v[252:255],a[252:255],v[100:103],v[252:255]
v_mfma_f32_16x16x32_bf16 a[44:47],a[252:255],v[104:107],a[44:47]
ds_read_b64_tr_b16 a[240:241],v3 offset:0
ds_read_b64_tr_b16 a[242:243],v3 offset:6144
ds_read_b64_tr_b16 a[244:245],v4 offset:0
ds_read_b64_tr_b16 a[246:247],v4 offset:6144
ds_read_b64_tr_b16 a[248:249],v5 offset:0
ds_read_b64_tr_b16 a[250:251],v5 offset:6144
ds_read_b64_tr_b16 a[252:253],v6 offset:0
ds_read_b64_tr_b16 a[254:255],v6 offset:6144
s_waitcnt lgkmcnt(6)
v_mfma_f32_16x16x32_bf16 v[160:163],a[240:243],v[112:115],v[160:163]
s_waitcnt vmcnt(0)
v_rcp_f32 v144,v128
s_add_u32 s84,s42,0
v_mfma_f32_16x16x32_bf16 v[208:211],a[240:243],v[116:119],v[208:211]
s_add_u32 s85,s42,6144
v_rcp_f32 v146,v132
s_add_u32 s86,s42,12288
v_mfma_f32_16x16x32_bf16 a[0:3],a[240:243],v[120:123],a[0:3]
s_waitcnt lgkmcnt(4)
ds_read_b64_tr_b16 a[240:241],v3 offset:1024
ds_read_b64_tr_b16 a[242:243],v3 offset:7168
v_mfma_f32_16x16x32_bf16 v[164:167],a[244:247],v[112:115],v[164:167]
v_rcp_f32 v148,v136
v_mfma_f32_16x16x32_bf16 v[212:215],a[244:247],v[116:119],v[212:215]
v_max3_f32 v30,v128,v132,v136
v_cmp_nlt_f32 vcc,v30,v31
v_mfma_f32_16x16x32_bf16 a[4:7],a[244:247],v[120:123],a[4:7]
s_waitcnt lgkmcnt(4)
ds_read_b64_tr_b16 a[244:245],v4 offset:1024
ds_read_b64_tr_b16 a[246:247],v4 offset:7168
v_mfma_f32_16x16x32_bf16 v[168:171],a[248:251],v[112:115],v[168:171]
s_cmp_lg_u64 vcc,0
v_accvgpr_read_b32 v64,a0
v_accvgpr_read_b32 v65,a1
v_mfma_f32_16x16x32_bf16 v[216:219],a[248:251],v[116:119],v[216:219]
s_cselect_b32 s62,s32,0
v_accvgpr_read_b32 v66,a2
v_accvgpr_read_b32 v67,a3
v_accvgpr_read_b32 v72,a4
v_accvgpr_read_b32 v73,a5
v_accvgpr_read_b32 v74,a6
v_pk_mul_f32 v[160:161],v[160:161],v[144:145] op_sel_hi:[1,0]
v_pk_mul_f32 v[162:163],v[162:163],v[144:145] op_sel_hi:[1,0]
v_pk_mul_f32 v[208:209],v[208:209],v[146:147] op_sel_hi:[1,0]
v_pk_mul_f32 v[210:211],v[210:211],v[146:147] op_sel_hi:[1,0]
v_cvt_pk_bf16_f32 v80,v160,v161
v_cvt_pk_bf16_f32 v81,v162,v163
v_mfma_f32_16x16x32_bf16 a[8:11],a[248:251],v[120:123],a[8:11]
s_or_b32 s31,s31,s62
ds_read_b64_tr_b16 a[248:249],v5 offset:1024
ds_read_b64_tr_b16 a[250:251],v5 offset:7168
v_cvt_pk_bf16_f32 v82,v208,v209
v_cvt_pk_bf16_f32 v83,v210,v211
v_accvgpr_read_b32 v75,a7
v_pk_mul_f32 v[164:165],v[164:165],v[144:145] op_sel_hi:[1,0]
v_pk_mul_f32 v[166:167],v[166:167],v[144:145] op_sel_hi:[1,0]
v_pk_mul_f32 v[212:213],v[212:213],v[146:147] op_sel_hi:[1,0]
v_pk_mul_f32 v[214:215],v[214:215],v[146:147] op_sel_hi:[1,0]
v_cvt_pk_bf16_f32 v84,v164,v165
v_cvt_pk_bf16_f32 v85,v166,v167
s_waitcnt lgkmcnt(4)
v_mfma_f32_16x16x32_bf16 v[172:175],a[252:255],v[112:115],v[172:175]
s_lshl_b32 s32,s32,1
ds_write2st64_b64 v12,v[80:81],v[82:83] offset0:0 offset1:12
v_mfma_f32_16x16x32_bf16 v[220:223],a[252:255],v[116:119],v[220:223]
v_cvt_pk_bf16_f32 v86,v212,v213
v_cvt_pk_bf16_f32 v87,v214,v215
v_pk_mul_f32 v[168:169],v[168:169],v[144:145] op_sel_hi:[1,0]
v_pk_mul_f32 v[170:171],v[170:171],v[144:145] op_sel_hi:[1,0]
v_pk_mul_f32 v[216:217],v[216:217],v[146:147] op_sel_hi:[1,0]
v_pk_mul_f32 v[218:219],v[218:219],v[146:147] op_sel_hi:[1,0]
v_cvt_pk_bf16_f32 v88,v168,v169
v_cvt_pk_bf16_f32 v89,v170,v171
v_mfma_f32_16x16x32_bf16 a[12:15],a[252:255],v[120:123],a[12:15]
ds_read_b64_tr_b16 a[252:253],v6 offset:1024
ds_read_b64_tr_b16 a[254:255],v6 offset:7168
v_mfma_f32_16x16x32_bf16 v[176:179],a[240:243],v[112:115],v[176:179]
ds_write2st64_b64 v20,v[84:85],v[86:87] offset0:0 offset1:12
v_mfma_f32_16x16x32_bf16 v[224:227],a[240:243],v[116:119],v[224:227]
v_cvt_pk_bf16_f32 v90,v216,v217
v_cvt_pk_bf16_f32 v91,v218,v219
v_pk_mul_f32 v[172:173],v[172:173],v[144:145] op_sel_hi:[1,0]
v_pk_mul_f32 v[174:175],v[174:175],v[144:145] op_sel_hi:[1,0]
v_pk_mul_f32 v[220:221],v[220:221],v[146:147] op_sel_hi:[1,0]
v_pk_mul_f32 v[222:223],v[222:223],v[146:147] op_sel_hi:[1,0]
v_cvt_pk_bf16_f32 v92,v172,v173
v_cvt_pk_bf16_f32 v93,v174,v175
v_mfma_f32_16x16x32_bf16 a[16:19],a[240:243],v[120:123],a[16:19]
s_waitcnt lgkmcnt(3)
ds_read_b64_tr_b16 a[240:241],v3 offset:2048
ds_read_b64_tr_b16 a[242:243],v3 offset:8192
v_mfma_f32_16x16x32_bf16 v[180:183],a[244:247],v[112:115],v[180:183]
ds_write2st64_b64 v21,v[88:89],v[90:91] offset0:0 offset1:12
v_mfma_f32_16x16x32_bf16 v[228:231],a[244:247],v[116:119],v[228:231]
v_cvt_pk_bf16_f32 v94,v220,v221
v_cvt_pk_bf16_f32 v95,v222,v223
v_pk_mul_f32 v[176:177],v[176:177],v[144:145] op_sel_hi:[1,0]
v_pk_mul_f32 v[178:179],v[178:179],v[144:145] op_sel_hi:[1,0]
v_pk_mul_f32 v[224:225],v[224:225],v[146:147] op_sel_hi:[1,0]
v_pk_mul_f32 v[226:227],v[226:227],v[146:147] op_sel_hi:[1,0]
v_cvt_pk_bf16_f32 v80,v176,v177
v_cvt_pk_bf16_f32 v81,v178,v179
v_mfma_f32_16x16x32_bf16 a[20:23],a[244:247],v[120:123],a[20:23]
ds_read_b64_tr_b16 a[244:245],v4 offset:2048
ds_read_b64_tr_b16 a[246:247],v4 offset:8192
v_mfma_f32_16x16x32_bf16 v[184:187],a[248:251],v[112:115],v[184:187]
ds_write2st64_b64 v22,v[92:93],v[94:95] offset0:0 offset1:12
v_mfma_f32_16x16x32_bf16 v[232:235],a[248:251],v[116:119],v[232:235]
v_cvt_pk_bf16_f32 v82,v224,v225
v_cvt_pk_bf16_f32 v83,v226,v227
v_accvgpr_read_b32 v68,a16
v_accvgpr_read_b32 v69,a17
v_accvgpr_read_b32 v70,a18
v_pk_mul_f32 v[180:181],v[180:181],v[144:145] op_sel_hi:[1,0]
v_pk_mul_f32 v[182:183],v[182:183],v[144:145] op_sel_hi:[1,0]
v_pk_mul_f32 v[228:229],v[228:229],v[146:147] op_sel_hi:[1,0]
v_pk_mul_f32 v[230:231],v[230:231],v[146:147] op_sel_hi:[1,0]
v_cvt_pk_bf16_f32 v84,v180,v181
v_cvt_pk_bf16_f32 v85,v182,v183
v_mfma_f32_16x16x32_bf16 a[24:27],a[248:251],v[120:123],a[24:27]
s_waitcnt lgkmcnt(3)
ds_read_b64_tr_b16 a[248:249],v5 offset:2048
ds_read_b64_tr_b16 a[250:251],v5 offset:8192
v_mfma_f32_16x16x32_bf16 v[188:191],a[252:255],v[112:115],v[188:191]
ds_read_b128 v[152:155],v15 offset:0
v_cvt_pk_bf16_f32 v86,v228,v229
v_mfma_f32_16x16x32_bf16 v[236:239],a[252:255],v[116:119],v[236:239]
ds_read_b128 v[156:159],v15 offset:3072
v_cvt_pk_bf16_f32 v87,v230,v231
v_accvgpr_read_b32 v71,a19
v_accvgpr_read_b32 v76,a20
v_accvgpr_read_b32 v77,a21
v_pk_mul_f32 v[184:185],v[184:185],v[144:145] op_sel_hi:[1,0]
v_pk_mul_f32 v[186:187],v[186:187],v[144:145] op_sel_hi:[1,0]
v_pk_mul_f32 v[232:233],v[232:233],v[146:147] op_sel_hi:[1,0]
v_pk_mul_f32 v[234:235],v[234:235],v[146:147] op_sel_hi:[1,0]
v_cvt_pk_bf16_f32 v88,v184,v185
v_cvt_pk_bf16_f32 v89,v186,v187
v_mfma_f32_16x16x32_bf16 a[28:31],a[252:255],v[120:123],a[28:31]
ds_read_b64_tr_b16 a[252:253],v6 offset:2048
ds_read_b64_tr_b16 a[254:255],v6 offset:8192
v_mfma_f32_16x16x32_bf16 v[192:195],a[240:243],v[112:115],v[192:195]
ds_read_b128 v[100:103],v15 offset:6144
v_cvt_pk_bf16_f32 v90,v232,v233
v_mfma_f32_16x16x32_bf16 v[240:243],a[240:243],v[116:119],v[240:243]
ds_read_b128 v[104:107],v15 offset:9216
v_cvt_pk_bf16_f32 v91,v234,v235
v_accvgpr_read_b32 v78,a22
v_accvgpr_read_b32 v79,a23
v_pk_mul_f32 v[188:189],v[188:189],v[144:145] op_sel_hi:[1,0]
v_pk_mul_f32 v[190:191],v[190:191],v[144:145] op_sel_hi:[1,0]
v_pk_mul_f32 v[236:237],v[236:237],v[146:147] op_sel_hi:[1,0]
v_pk_mul_f32 v[238:239],v[238:239],v[146:147] op_sel_hi:[1,0]
v_cvt_pk_bf16_f32 v92,v188,v189
v_cvt_pk_bf16_f32 v93,v190,v191
v_mfma_f32_16x16x32_bf16 a[32:35],a[240:243],v[120:123],a[32:35]
s_waitcnt lgkmcnt(4)
ds_write2st64_b64 v12,v[80:81],v[82:83] offset0:2 offset1:14
v_mfma_f32_16x16x32_bf16 v[196:199],a[244:247],v[112:115],v[196:199]
v_cvt_pk_bf16_f32 v94,v236,v237
v_cvt_pk_bf16_f32 v95,v238,v239
v_mfma_f32_16x16x32_bf16 v[244:247],a[244:247],v[116:119],v[244:247]
ds_write2st64_b64 v20,v[84:85],v[86:87] offset0:2 offset1:14
v_pk_mul_f32 v[192:193],v[192:193],v[144:145] op_sel_hi:[1,0]
v_pk_mul_f32 v[194:195],v[194:195],v[144:145] op_sel_hi:[1,0]
v_pk_mul_f32 v[240:241],v[240:241],v[146:147] op_sel_hi:[1,0]
v_pk_mul_f32 v[242:243],v[242:243],v[146:147] op_sel_hi:[1,0]
v_cvt_pk_bf16_f32 v80,v192,v193
v_cvt_pk_bf16_f32 v81,v194,v195
v_mfma_f32_16x16x32_bf16 a[36:39],a[244:247],v[120:123],a[36:39]
ds_write2st64_b64 v21,v[88:89],v[90:91] offset0:2 offset1:14
v_mfma_f32_16x16x32_bf16 v[200:203],a[248:251],v[112:115],v[200:203]
v_cvt_pk_bf16_f32 v82,v240,v241
v_cvt_pk_bf16_f32 v83,v242,v243
v_mfma_f32_16x16x32_bf16 v[248:251],a[248:251],v[116:119],v[248:251]
ds_write2st64_b64 v22,v[92:93],v[94:95] offset0:2 offset1:14
v_pk_mul_f32 v[196:197],v[196:197],v[144:145] op_sel_hi:[1,0]
v_pk_mul_f32 v[198:199],v[198:199],v[144:145] op_sel_hi:[1,0]
v_pk_mul_f32 v[244:245],v[244:245],v[146:147] op_sel_hi:[1,0]
v_pk_mul_f32 v[246:247],v[246:247],v[146:147] op_sel_hi:[1,0]
v_cvt_pk_bf16_f32 v84,v196,v197
v_cvt_pk_bf16_f32 v85,v198,v199
v_mfma_f32_16x16x32_bf16 a[40:43],a[248:251],v[120:123],a[40:43]
buffer_store_dwordx4 v[152:155],v10,s[16:19],s84 offen offset:0 nt
s_waitcnt lgkmcnt(2)
v_mfma_f32_16x16x32_bf16 v[204:207],a[252:255],v[112:115],v[204:207]
v_cvt_pk_bf16_f32 v86,v244,v245
v_cvt_pk_bf16_f32 v87,v246,v247
v_mfma_f32_16x16x32_bf16 v[252:255],a[252:255],v[116:119],v[252:255]
ds_read_b128 v[152:155],v15 offset:1024
v_pk_mul_f32 v[200:201],v[200:201],v[144:145] op_sel_hi:[1,0]
v_pk_mul_f32 v[202:203],v[202:203],v[144:145] op_sel_hi:[1,0]
v_pk_mul_f32 v[248:249],v[248:249],v[146:147] op_sel_hi:[1,0]
v_pk_mul_f32 v[250:251],v[250:251],v[146:147] op_sel_hi:[1,0]
v_cvt_pk_bf16_f32 v88,v200,v201
v_cvt_pk_bf16_f32 v89,v202,v203
v_mfma_f32_16x16x32_bf16 a[44:47],a[252:255],v[120:123],a[44:47]
buffer_store_dwordx4 v[156:159],v10,s[16:19],s84 offen offset:3072 nt
v_cvt_pk_bf16_f32 v90,v248,v249
v_cvt_pk_bf16_f32 v91,v250,v251
v_pk_mul_f32 v[204:205],v[204:205],v[144:145] op_sel_hi:[1,0]
v_pk_mul_f32 v[206:207],v[206:207],v[144:145] op_sel_hi:[1,0]
v_pk_mul_f32 v[252:253],v[252:253],v[146:147] op_sel_hi:[1,0]
v_pk_mul_f32 v[254:255],v[254:255],v[146:147] op_sel_hi:[1,0]
v_pk_mul_f32 v[64:65],v[64:65],v[148:149] op_sel_hi:[1,0]
v_pk_mul_f32 v[66:67],v[66:67],v[148:149] op_sel_hi:[1,0]
v_pk_mul_f32 v[68:69],v[68:69],v[148:149] op_sel_hi:[1,0]
v_pk_mul_f32 v[70:71],v[70:71],v[148:149] op_sel_hi:[1,0]
v_pk_mul_f32 v[72:73],v[72:73],v[148:149] op_sel_hi:[1,0]
v_pk_mul_f32 v[74:75],v[74:75],v[148:149] op_sel_hi:[1,0]
v_pk_mul_f32 v[76:77],v[76:77],v[148:149] op_sel_hi:[1,0]
v_pk_mul_f32 v[78:79],v[78:79],v[148:149] op_sel_hi:[1,0]
v_cvt_pk_bf16_f32 v92,v204,v205
v_cvt_pk_bf16_f32 v93,v206,v207
v_cvt_pk_bf16_f32 v94,v252,v253
v_cvt_pk_bf16_f32 v95,v254,v255
ds_read_b128 v[156:159],v15 offset:4096
buffer_store_dwordx4 v[100:103],v10,s[16:19],s85 offen offset:0 nt
buffer_store_dwordx4 v[104:107],v10,s[16:19],s85 offen offset:3072 nt
ds_read_b128 v[100:103],v15 offset:7168
ds_read_b128 v[104:107],v15 offset:10240
s_waitcnt lgkmcnt(3)
buffer_store_dwordx4 v[152:155],v10,s[16:19],s84 offen offset:128 nt
ds_write2st64_b64 v12,v[80:81],v[82:83] offset0:4 offset1:16
v_cvt_pk_bf16_f32 v80,v64,v65
v_cvt_pk_bf16_f32 v81,v66,v67
v_cvt_pk_bf16_f32 v82,v68,v69
v_cvt_pk_bf16_f32 v83,v70,v71
v_accvgpr_read_b32 v64,a8
v_accvgpr_read_b32 v65,a9
v_pk_mul_f32 v[64:65],v[64:65],v[148:149] op_sel_hi:[1,0]
v_accvgpr_read_b32 v66,a10
v_accvgpr_read_b32 v67,a11
v_pk_mul_f32 v[66:67],v[66:67],v[148:149] op_sel_hi:[1,0]
v_accvgpr_read_b32 v68,a24
v_accvgpr_read_b32 v69,a25
v_pk_mul_f32 v[68:69],v[68:69],v[148:149] op_sel_hi:[1,0]
v_accvgpr_read_b32 v70,a26
v_accvgpr_read_b32 v71,a27
v_pk_mul_f32 v[70:71],v[70:71],v[148:149] op_sel_hi:[1,0]
ds_write2st64_b64 v20,v[84:85],v[86:87] offset0:4 offset1:16
v_cvt_pk_bf16_f32 v84,v72,v73
v_cvt_pk_bf16_f32 v85,v74,v75
v_cvt_pk_bf16_f32 v86,v76,v77
v_cvt_pk_bf16_f32 v87,v78,v79
v_accvgpr_read_b32 v72,a12
v_accvgpr_read_b32 v73,a13
v_pk_mul_f32 v[72:73],v[72:73],v[148:149] op_sel_hi:[1,0]
v_accvgpr_read_b32 v74,a14
v_accvgpr_read_b32 v75,a15
v_pk_mul_f32 v[74:75],v[74:75],v[148:149] op_sel_hi:[1,0]
v_accvgpr_read_b32 v76,a28
v_accvgpr_read_b32 v77,a29
v_pk_mul_f32 v[76:77],v[76:77],v[148:149] op_sel_hi:[1,0]
v_accvgpr_read_b32 v78,a30
v_accvgpr_read_b32 v79,a31
v_pk_mul_f32 v[78:79],v[78:79],v[148:149] op_sel_hi:[1,0]
ds_write2st64_b64 v21,v[88:89],v[90:91] offset0:4 offset1:16
v_cvt_pk_bf16_f32 v88,v64,v65
v_cvt_pk_bf16_f32 v89,v66,v67
v_cvt_pk_bf16_f32 v90,v68,v69
v_cvt_pk_bf16_f32 v91,v70,v71
v_accvgpr_read_b32 v64,a32
v_accvgpr_read_b32 v65,a33
v_pk_mul_f32 v[64:65],v[64:65],v[148:149] op_sel_hi:[1,0]
v_accvgpr_read_b32 v66,a34
v_accvgpr_read_b32 v67,a35
v_pk_mul_f32 v[66:67],v[66:67],v[148:149] op_sel_hi:[1,0]
v_accvgpr_read_b32 v68,a36
v_accvgpr_read_b32 v69,a37
v_pk_mul_f32 v[68:69],v[68:69],v[148:149] op_sel_hi:[1,0]
v_accvgpr_read_b32 v70,a38
v_accvgpr_read_b32 v71,a39
v_pk_mul_f32 v[70:71],v[70:71],v[148:149] op_sel_hi:[1,0]
ds_write2st64_b64 v22,v[92:93],v[94:95] offset0:4 offset1:16
v_cvt_pk_bf16_f32 v92,v72,v73
v_cvt_pk_bf16_f32 v93,v74,v75
v_cvt_pk_bf16_f32 v94,v76,v77
v_cvt_pk_bf16_f32 v95,v78,v79
v_accvgpr_read_b32 v72,a40
v_accvgpr_read_b32 v73,a41
v_pk_mul_f32 v[72:73],v[72:73],v[148:149] op_sel_hi:[1,0]
v_accvgpr_read_b32 v74,a42
v_accvgpr_read_b32 v75,a43
v_pk_mul_f32 v[74:75],v[74:75],v[148:149] op_sel_hi:[1,0]
v_accvgpr_read_b32 v76,a44
v_accvgpr_read_b32 v77,a45
v_pk_mul_f32 v[76:77],v[76:77],v[148:149] op_sel_hi:[1,0]
v_accvgpr_read_b32 v78,a46
v_accvgpr_read_b32 v79,a47
v_pk_mul_f32 v[78:79],v[78:79],v[148:149] op_sel_hi:[1,0]
ds_read_b128 v[152:155],v15 offset:2048
s_waitcnt lgkmcnt(2)
buffer_store_dwordx4 v[156:159],v10,s[16:19],s84 offen offset:3200 nt
buffer_store_dwordx4 v[100:103],v10,s[16:19],s85 offen offset:128 nt
ds_read_b128 v[156:159],v15 offset:5120
ds_read_b128 v[100:103],v15 offset:8192
buffer_store_dwordx4 v[104:107],v10,s[16:19],s85 offen offset:3200 nt
s_waitcnt lgkmcnt(2)
buffer_store_dwordx4 v[152:155],v10,s[16:19],s84 offen offset:256 nt
ds_read_b128 v[104:107],v15 offset:11264
ds_write2st64_b64 v12,v[80:81],v[82:83] offset0:24 offset1:26
v_cvt_pk_bf16_f32 v80,v64,v65
v_cvt_pk_bf16_f32 v81,v66,v67
ds_write2st64_b64 v20,v[84:85],v[86:87] offset0:24 offset1:26
v_cvt_pk_bf16_f32 v84,v68,v69
v_cvt_pk_bf16_f32 v85,v70,v71
ds_write2st64_b64 v21,v[88:89],v[90:91] offset0:24 offset1:26
v_cvt_pk_bf16_f32 v88,v72,v73
v_cvt_pk_bf16_f32 v89,v74,v75
ds_write2st64_b64 v22,v[92:93],v[94:95] offset0:24 offset1:26
v_cvt_pk_bf16_f32 v92,v76,v77
v_cvt_pk_bf16_f32 v93,v78,v79
ds_read_b128 v[152:155],v15 offset:12288
s_waitcnt lgkmcnt(3)
buffer_store_dwordx4 v[156:159],v10,s[16:19],s84 offen offset:3328 nt
buffer_store_dwordx4 v[100:103],v10,s[16:19],s85 offen offset:256 nt
ds_read_b128 v[156:159],v15 offset:15360
ds_read_b128 v[100:103],v15 offset:13312
buffer_store_dwordx4 v[104:107],v10,s[16:19],s85 offen offset:3328 nt
s_waitcnt lgkmcnt(2)
buffer_store_dwordx4 v[152:155],v10,s[16:19],s86 offen offset:0 nt
ds_read_b128 v[104:107],v15 offset:16384
ds_write_b64 v12,v[80:81] offset:14336
ds_write_b64 v20,v[84:85] offset:14336
ds_write_b64 v21,v[88:89] offset:14336
ds_write_b64 v22,v[92:93] offset:14336
ds_read_b128 v[152:155],v15 offset:14336
s_waitcnt lgkmcnt(6)
buffer_store_dwordx4 v[156:159],v10,s[16:19],s86 offen offset:3072 nt
buffer_store_dwordx4 v[100:103],v10,s[16:19],s86 offen offset:128 nt
ds_read_b128 v[156:159],v15 offset:17408
s_waitcnt lgkmcnt(2)
buffer_store_dwordx4 v[104:107],v10,s[16:19],s86 offen offset:3200 nt
s_waitcnt lgkmcnt(1)
buffer_store_dwordx4 v[152:155],v10,s[16:19],s86 offen offset:256 nt
s_waitcnt lgkmcnt(0)
buffer_store_dwordx4 v[156:159],v10,s[16:19],s86 offen offset:3328 nt
s_branch L_fin
L_fin:
s_waitcnt vmcnt(0)
L_stamped:
s_cmp_lg_u32 s31,0
s_cbranch_scc1 L_fix
L_done:
L_end:
s_endpgm
L_fix:
v_mov_b32 v144,v28
v_mov_b32 v145,v29
s_sub_u32 s62,s24,36864
v_add_u32 v146,s62,v3
v_add_u32 v147,s62,v4
v_add_u32 v148,s62,v5
v_add_u32 v149,s62,v6
v_and_b32 v21,15,v0
v_mul_u32_u24 v21,384,v21
v_lshrrev_b32 v22,4,v0
v_lshl_add_u32 v23,v22,3,v21
v_lshl_add_u32 v21,v22,4,v21
s_mov_b32 s6,100663296
s_mov_b32 s10,100663296
L_fix_pass:
s_ff1_i32_b32 s50,s31
s_bitset0_b32 s31,s50
s_mul_i32 s56,s50,325632
s_add_u32 s56,s56,s33
s_lshr_b32 s62,s39,s50
s_and_b32 s62,s62,1
s_lshl_b32 s62,s62,1
s_add_u32 s62,s62,s49
s_and_b32 s62,s62,3
s_add_u32 s63,s50,8
s_lshr_b32 s63,s39,s63
s_and_b32 s63,s63,1
s_xor_b32 s62,s62,s63
s_mul_i32 s63,s3,3
s_lshl_b32 s64,s3,2
s_mov_b32 s40,1
s_add_u32 s65,s63,17
s_cmp_eq_u32 s3,0
s_cselect_b32 s65,16,s65
s_cselect_b32 s54,1,0
s_cmp_eq_u32 s62,1
s_cselect_b32 s64,s65,s64
s_cselect_b32 s40,s54,s40
s_add_u32 s65,s63,29
s_cmp_eq_u32 s62,2
s_cselect_b32 s64,s65,s64
s_cselect_b32 s40,0,s40
s_add_u32 s65,s63,41
s_cmp_eq_u32 s62,3
s_cselect_b32 s64,s65,s64
s_cselect_b32 s40,0,s40
s_mul_i32 s64,s64,6144
s_add_u32 s54,s56,s64
s_add_u32 s55,s40,3
s_mov_b32 s51,0
L_fix_tile:
buffer_load_dwordx4 a[96:99],v21,s[12:15],s54 offen offset:0
buffer_load_dwordx4 a[100:103],v21,s[12:15],s54 offen offset:64
buffer_load_dwordx4 a[104:107],v21,s[12:15],s54 offen offset:128
buffer_load_dwordx4 a[108:111],v21,s[12:15],s54 offen offset:192
buffer_load_dwordx4 a[112:115],v21,s[12:15],s54 offen offset:256
buffer_load_dwordx4 a[116:119],v21,s[12:15],s54 offen offset:320
v_mov_b32 v20,0xff800000
s_mul_i32 s53,s50,196608
s_add_u32 s53,s53,s34
s_mov_b32 s52,0
L_fix_max:
s_mov_b32 s63,s53
s_add_u32 m0,s24,0
s_nop 0
buffer_load_dwordx4 v8,s[4:7],s63 offen offset:0 lds
s_add_u32 m0,s24,896
s_nop 0
buffer_load_dwordx4 v8,s[4:7],s63 offen offset:128 lds
s_add_u32 m0,s24,1792
s_nop 0
buffer_load_dwordx4 v8,s[4:7],s63 offen offset:256 lds
s_add_u32 s63,s63,3072
s_add_u32 m0,s24,3072
s_nop 0
buffer_load_dwordx4 v9,s[4:7],s63 offen offset:0 lds
s_add_u32 m0,s24,3968
s_nop 0
buffer_load_dwordx4 v9,s[4:7],s63 offen offset:128 lds
s_add_u32 m0,s24,4864
s_nop 0
buffer_load_dwordx4 v9,s[4:7],s63 offen offset:256 lds
s_add_u32 s63,s63,3072
s_add_u32 m0,s24,6144
s_nop 0
buffer_load_dwordx4 v8,s[4:7],s63 offen offset:0 lds
s_add_u32 m0,s24,7040
s_nop 0
buffer_load_dwordx4 v8,s[4:7],s63 offen offset:128 lds
s_add_u32 m0,s24,7936
s_nop 0
buffer_load_dwordx4 v8,s[4:7],s63 offen offset:256 lds
s_add_u32 s63,s63,3072
s_add_u32 m0,s24,9216
s_nop 0
buffer_load_dwordx4 v9,s[4:7],s63 offen offset:0 lds
s_add_u32 m0,s24,10112
s_nop 0
buffer_load_dwordx4 v9,s[4:7],s63 offen offset:128 lds
s_add_u32 m0,s24,11008
s_nop 0
buffer_load_dwordx4 v9,s[4:7],s63 offen offset:256 lds
s_add_u32 s63,s63,3072
s_waitcnt vmcnt(0)
ds_read_b128 a[192:195],v144 offset:0
ds_read_b128 a[196:199],v145 offset:0
ds_read_b128 a[200:203],v144 offset:1024
ds_read_b128 a[204:207],v145 offset:1024
ds_read_b128 a[208:211],v144 offset:2048
ds_read_b128 a[212:215],v145 offset:2048
ds_read_b128 a[216:219],v144 offset:6144
ds_read_b128 a[220:223],v145 offset:6144
ds_read_b128 a[224:227],v144 offset:7168
ds_read_b128 a[228:231],v145 offset:7168
ds_read_b128 a[232:235],v144 offset:8192
ds_read_b128 a[236:239],v145 offset:8192
s_waitcnt lgkmcnt(0)
v_mfma_f32_16x16x32_bf16 v[32:35],a[192:195],a[96:99],0
v_mfma_f32_16x16x32_bf16 v[32:35],a[196:199],a[100:103],v[32:35]
v_mfma_f32_16x16x32_bf16 v[32:35],a[200:203],a[104:107],v[32:35]
v_mfma_f32_16x16x32_bf16 v[32:35],a[204:207],a[108:111],v[32:35]
v_mfma_f32_16x16x32_bf16 v[32:35],a[208:211],a[112:115],v[32:35]
v_mfma_f32_16x16x32_bf16 v[32:35],a[212:215],a[116:119],v[32:35]
v_mfma_f32_16x16x32_bf16 v[36:39],a[216:219],a[96:99],0
v_mfma_f32_16x16x32_bf16 v[36:39],a[220:223],a[100:103],v[36:39]
v_mfma_f32_16x16x32_bf16 v[36:39],a[224:227],a[104:107],v[36:39]
v_mfma_f32_16x16x32_bf16 v[36:39],a[228:231],a[108:111],v[36:39]
v_mfma_f32_16x16x32_bf16 v[36:39],a[232:235],a[112:115],v[36:39]
v_mfma_f32_16x16x32_bf16 v[36:39],a[236:239],a[116:119],v[36:39]
s_nop 7
v_max3_f32 v20,v20,v32,v33
v_max3_f32 v20,v20,v34,v35
v_max3_f32 v20,v20,v36,v37
v_max3_f32 v20,v20,v38,v39
s_add_u32 s53,s53,12288
s_add_u32 s52,s52,1
s_cmp_lt_u32 s52,16
s_cbranch_scc1 L_fix_max
v_mov_b32 v30,v20
s_nop 1
v_permlane32_swap_b32 v30,v20
v_max_f32 v20,v20,v30
v_mov_b32 v30,v20
s_nop 1
v_permlane16_swap_b32 v30,v20
v_max_f32 v20,v20,v30
v_mul_f32_e64 v16,-s36,v20
v_mov_b32 v160,0
v_mov_b32 v161,0
v_mov_b32 v162,0
v_mov_b32 v163,0
v_mov_b32 v164,0
v_mov_b32 v165,0
v_mov_b32 v166,0
v_mov_b32 v167,0
v_mov_b32 v168,0
v_mov_b32 v169,0
v_mov_b32 v170,0
v_mov_b32 v171,0
v_mov_b32 v172,0
v_mov_b32 v173,0
v_mov_b32 v174,0
v_mov_b32 v175,0
v_mov_b32 v176,0
v_mov_b32 v177,0
v_mov_b32 v178,0
v_mov_b32 v179,0
v_mov_b32 v180,0
v_mov_b32 v181,0
v_mov_b32 v182,0
v_mov_b32 v183,0
v_mov_b32 v184,0
v_mov_b32 v185,0
v_mov_b32 v186,0
v_mov_b32 v187,0
v_mov_b32 v188,0
v_mov_b32 v189,0
v_mov_b32 v190,0
v_mov_b32 v191,0
v_mov_b32 v192,0
v_mov_b32 v193,0
v_mov_b32 v194,0
v_mov_b32 v195,0
v_mov_b32 v196,0
v_mov_b32 v197,0
v_mov_b32 v198,0
v_mov_b32 v199,0
v_mov_b32 v200,0
v_mov_b32 v201,0
v_mov_b32 v202,0
v_mov_b32 v203,0
v_mov_b32 v204,0
v_mov_b32 v205,0
v_mov_b32 v206,0
v_mov_b32 v207,0
v_mov_b32 v128,0
v_mov_b32 v129,0
v_mov_b32 v130,0
v_mov_b32 v131,0
s_mul_i32 s53,s50,196608
s_add_u32 s53,s53,s34
s_mov_b32 s52,0
L_fix_acc:
s_mov_b32 s63,s53
s_add_u32 m0,s24,0
s_nop 0
buffer_load_dwordx4 v8,s[4:7],s63 offen offset:0 lds
s_add_u32 m0,s24,896
s_nop 0
buffer_load_dwordx4 v8,s[4:7],s63 offen offset:128 lds
s_add_u32 m0,s24,1792
s_nop 0
buffer_load_dwordx4 v8,s[4:7],s63 offen offset:256 lds
s_add_u32 s63,s63,3072
s_add_u32 m0,s24,3072
s_nop 0
buffer_load_dwordx4 v9,s[4:7],s63 offen offset:0 lds
s_add_u32 m0,s24,3968
s_nop 0
buffer_load_dwordx4 v9,s[4:7],s63 offen offset:128 lds
s_add_u32 m0,s24,4864
s_nop 0
buffer_load_dwordx4 v9,s[4:7],s63 offen offset:256 lds
s_add_u32 s63,s63,3072
s_add_u32 m0,s24,6144
s_nop 0
buffer_load_dwordx4 v8,s[4:7],s63 offen offset:0 lds
s_add_u32 m0,s24,7040
s_nop 0
buffer_load_dwordx4 v8,s[4:7],s63 offen offset:128 lds
s_add_u32 m0,s24,7936
s_nop 0
buffer_load_dwordx4 v8,s[4:7],s63 offen offset:256 lds
s_add_u32 s63,s63,3072
s_add_u32 m0,s24,9216
s_nop 0
buffer_load_dwordx4 v9,s[4:7],s63 offen offset:0 lds
s_add_u32 m0,s24,10112
s_nop 0
buffer_load_dwordx4 v9,s[4:7],s63 offen offset:128 lds
s_add_u32 m0,s24,11008
s_nop 0
buffer_load_dwordx4 v9,s[4:7],s63 offen offset:256 lds
s_add_u32 s63,s63,3072
s_waitcnt vmcnt(0)
ds_read_b128 a[192:195],v144 offset:0
ds_read_b128 a[196:199],v145 offset:0
ds_read_b128 a[200:203],v144 offset:1024
ds_read_b128 a[204:207],v145 offset:1024
ds_read_b128 a[208:211],v144 offset:2048
ds_read_b128 a[212:215],v145 offset:2048
ds_read_b128 a[216:219],v144 offset:6144
ds_read_b128 a[220:223],v145 offset:6144
ds_read_b128 a[224:227],v144 offset:7168
ds_read_b128 a[228:231],v145 offset:7168
ds_read_b128 a[232:235],v144 offset:8192
ds_read_b128 a[236:239],v145 offset:8192
s_waitcnt lgkmcnt(0)
v_mfma_f32_16x16x32_bf16 v[32:35],a[192:195],a[96:99],0
v_mfma_f32_16x16x32_bf16 v[32:35],a[196:199],a[100:103],v[32:35]
v_mfma_f32_16x16x32_bf16 v[32:35],a[200:203],a[104:107],v[32:35]
v_mfma_f32_16x16x32_bf16 v[32:35],a[204:207],a[108:111],v[32:35]
v_mfma_f32_16x16x32_bf16 v[32:35],a[208:211],a[112:115],v[32:35]
v_mfma_f32_16x16x32_bf16 v[32:35],a[212:215],a[116:119],v[32:35]
v_mfma_f32_16x16x32_bf16 v[36:39],a[216:219],a[96:99],0
v_mfma_f32_16x16x32_bf16 v[36:39],a[220:223],a[100:103],v[36:39]
v_mfma_f32_16x16x32_bf16 v[36:39],a[224:227],a[104:107],v[36:39]
v_mfma_f32_16x16x32_bf16 v[36:39],a[228:231],a[108:111],v[36:39]
v_mfma_f32_16x16x32_bf16 v[36:39],a[232:235],a[112:115],v[36:39]
v_mfma_f32_16x16x32_bf16 v[36:39],a[236:239],a[116:119],v[36:39]
s_nop 7
v_fma_f32 v32,v32,s36,v16
v_exp_f32 v32,v32
v_fma_f32 v33,v33,s36,v16
v_exp_f32 v33,v33
s_nop 0
v_cvt_pk_bf16_f32 v96,v32,v33
v_fma_f32 v34,v34,s36,v16
v_exp_f32 v34,v34
v_fma_f32 v35,v35,s36,v16
v_exp_f32 v35,v35
s_nop 0
v_cvt_pk_bf16_f32 v97,v34,v35
v_fma_f32 v36,v36,s36,v16
v_exp_f32 v36,v36
v_fma_f32 v37,v37,s36,v16
v_exp_f32 v37,v37
s_nop 0
v_cvt_pk_bf16_f32 v98,v36,v37
v_fma_f32 v38,v38,s36,v16
v_exp_f32 v38,v38
v_fma_f32 v39,v39,s36,v16
v_exp_f32 v39,v39
s_nop 0
v_cvt_pk_bf16_f32 v99,v38,v39
s_nop 1
v_mfma_f32_16x16x32_bf16 v[128:131],v[24:27],v[96:99],v[128:131]
s_mov_b32 s63,s53
s_add_u32 m0,s24,0
s_nop 0
buffer_load_dwordx4 v8,s[8:11],s63 offen offset:0 lds
s_add_u32 m0,s24,896
s_nop 0
buffer_load_dwordx4 v8,s[8:11],s63 offen offset:128 lds
s_add_u32 m0,s24,1792
s_nop 0
buffer_load_dwordx4 v8,s[8:11],s63 offen offset:256 lds
s_add_u32 s63,s63,3072
s_add_u32 m0,s24,3072
s_nop 0
buffer_load_dwordx4 v9,s[8:11],s63 offen offset:0 lds
s_add_u32 m0,s24,3968
s_nop 0
buffer_load_dwordx4 v9,s[8:11],s63 offen offset:128 lds
s_add_u32 m0,s24,4864
s_nop 0
buffer_load_dwordx4 v9,s[8:11],s63 offen offset:256 lds
s_add_u32 s63,s63,3072
s_add_u32 m0,s24,6144
s_nop 0
buffer_load_dwordx4 v8,s[8:11],s63 offen offset:0 lds
s_add_u32 m0,s24,7040
s_nop 0
buffer_load_dwordx4 v8,s[8:11],s63 offen offset:128 lds
s_add_u32 m0,s24,7936
s_nop 0
buffer_load_dwordx4 v8,s[8:11],s63 offen offset:256 lds
s_add_u32 s63,s63,3072
s_add_u32 m0,s24,9216
s_nop 0
buffer_load_dwordx4 v9,s[8:11],s63 offen offset:0 lds
s_add_u32 m0,s24,10112
s_nop 0
buffer_load_dwordx4 v9,s[8:11],s63 offen offset:128 lds
s_add_u32 m0,s24,11008
s_nop 0
buffer_load_dwordx4 v9,s[8:11],s63 offen offset:256 lds
s_add_u32 s63,s63,3072
s_waitcnt vmcnt(0)
ds_read_b64_tr_b16 a[192:193],v146 offset:0
ds_read_b64_tr_b16 a[194:195],v146 offset:6144
ds_read_b64_tr_b16 a[196:197],v147 offset:0
ds_read_b64_tr_b16 a[198:199],v147 offset:6144
ds_read_b64_tr_b16 a[200:201],v148 offset:0
ds_read_b64_tr_b16 a[202:203],v148 offset:6144
ds_read_b64_tr_b16 a[204:205],v149 offset:0
ds_read_b64_tr_b16 a[206:207],v149 offset:6144
ds_read_b64_tr_b16 a[208:209],v146 offset:1024
ds_read_b64_tr_b16 a[210:211],v146 offset:7168
ds_read_b64_tr_b16 a[212:213],v147 offset:1024
ds_read_b64_tr_b16 a[214:215],v147 offset:7168
ds_read_b64_tr_b16 a[216:217],v148 offset:1024
ds_read_b64_tr_b16 a[218:219],v148 offset:7168
ds_read_b64_tr_b16 a[220:221],v149 offset:1024
ds_read_b64_tr_b16 a[222:223],v149 offset:7168
ds_read_b64_tr_b16 a[224:225],v146 offset:2048
ds_read_b64_tr_b16 a[226:227],v146 offset:8192
ds_read_b64_tr_b16 a[228:229],v147 offset:2048
ds_read_b64_tr_b16 a[230:231],v147 offset:8192
ds_read_b64_tr_b16 a[232:233],v148 offset:2048
ds_read_b64_tr_b16 a[234:235],v148 offset:8192
ds_read_b64_tr_b16 a[236:237],v149 offset:2048
ds_read_b64_tr_b16 a[238:239],v149 offset:8192
s_waitcnt lgkmcnt(0)
v_mfma_f32_16x16x32_bf16 v[160:163],a[192:195],v[96:99],v[160:163]
v_mfma_f32_16x16x32_bf16 v[164:167],a[196:199],v[96:99],v[164:167]
v_mfma_f32_16x16x32_bf16 v[168:171],a[200:203],v[96:99],v[168:171]
v_mfma_f32_16x16x32_bf16 v[172:175],a[204:207],v[96:99],v[172:175]
v_mfma_f32_16x16x32_bf16 v[176:179],a[208:211],v[96:99],v[176:179]
v_mfma_f32_16x16x32_bf16 v[180:183],a[212:215],v[96:99],v[180:183]
v_mfma_f32_16x16x32_bf16 v[184:187],a[216:219],v[96:99],v[184:187]
v_mfma_f32_16x16x32_bf16 v[188:191],a[220:223],v[96:99],v[188:191]
v_mfma_f32_16x16x32_bf16 v[192:195],a[224:227],v[96:99],v[192:195]
v_mfma_f32_16x16x32_bf16 v[196:199],a[228:231],v[96:99],v[196:199]
v_mfma_f32_16x16x32_bf16 v[200:203],a[232:235],v[96:99],v[200:203]
v_mfma_f32_16x16x32_bf16 v[204:207],a[236:239],v[96:99],v[204:207]
s_add_u32 s53,s53,12288
s_add_u32 s52,s52,1
s_cmp_lt_u32 s52,16
s_cbranch_scc1 L_fix_acc
s_nop 7
v_rcp_f32 v30,v128
s_nop 0
v_mul_f32 v160,v160,v30
v_mul_f32 v161,v161,v30
v_mul_f32 v162,v162,v30
v_mul_f32 v163,v163,v30
v_cvt_pk_bf16_f32 v160,v160,v161
v_cvt_pk_bf16_f32 v161,v162,v163
buffer_store_dwordx2 v[160:161],v23,s[16:19],s54 offen offset:0
v_mul_f32 v164,v164,v30
v_mul_f32 v165,v165,v30
v_mul_f32 v166,v166,v30
v_mul_f32 v167,v167,v30
v_cvt_pk_bf16_f32 v164,v164,v165
v_cvt_pk_bf16_f32 v165,v166,v167
buffer_store_dwordx2 v[164:165],v23,s[16:19],s54 offen offset:32
v_mul_f32 v168,v168,v30
v_mul_f32 v169,v169,v30
v_mul_f32 v170,v170,v30
v_mul_f32 v171,v171,v30
v_cvt_pk_bf16_f32 v168,v168,v169
v_cvt_pk_bf16_f32 v169,v170,v171
buffer_store_dwordx2 v[168:169],v23,s[16:19],s54 offen offset:64
v_mul_f32 v172,v172,v30
v_mul_f32 v173,v173,v30
v_mul_f32 v174,v174,v30
v_mul_f32 v175,v175,v30
v_cvt_pk_bf16_f32 v172,v172,v173
v_cvt_pk_bf16_f32 v173,v174,v175
buffer_store_dwordx2 v[172:173],v23,s[16:19],s54 offen offset:96
v_mul_f32 v176,v176,v30
v_mul_f32 v177,v177,v30
v_mul_f32 v178,v178,v30
v_mul_f32 v179,v179,v30
v_cvt_pk_bf16_f32 v176,v176,v177
v_cvt_pk_bf16_f32 v177,v178,v179
buffer_store_dwordx2 v[176:177],v23,s[16:19],s54 offen offset:128
v_mul_f32 v180,v180,v30
v_mul_f32 v181,v181,v30
v_mul_f32 v182,v182,v30
v_mul_f32 v183,v183,v30
v_cvt_pk_bf16_f32 v180,v180,v181
v_cvt_pk_bf16_f32 v181,v182,v183
buffer_store_dwordx2 v[180:181],v23,s[16:19],s54 offen offset:160
v_mul_f32 v184,v184,v30
v_mul_f32 v185,v185,v30
v_mul_f32 v186,v186,v30
v_mul_f32 v187,v187,v30
v_cvt_pk_bf16_f32 v184,v184,v185
v_cvt_pk_bf16_f32 v185,v186,v187
buffer_store_dwordx2 v[184:185],v23,s[16:19],s54 offen offset:192
v_mul_f32 v188,v188,v30
v_mul_f32 v189,v189,v30
v_mul_f32 v190,v190,v30
v_mul_f32 v191,v191,v30
v_cvt_pk_bf16_f32 v188,v188,v189
v_cvt_pk_bf16_f32 v189,v190,v191
buffer_store_dwordx2 v[188:189],v23,s[16:19],s54 offen offset:224
v_mul_f32 v192,v192,v30
v_mul_f32 v193,v193,v30
v_mul_f32 v194,v194,v30
v_mul_f32 v195,v195,v30
v_cvt_pk_bf16_f32 v192,v192,v193
v_cvt_pk_bf16_f32 v193,v194,v195
buffer_store_dwordx2 v[192:193],v23,s[16:19],s54 offen offset:256
v_mul_f32 v196,v196,v30
v_mul_f32 v197,v197,v30
v_mul_f32 v198,v198,v30
v_mul_f32 v199,v199,v30
v_cvt_pk_bf16_f32 v196,v196,v197
v_cvt_pk_bf16_f32 v197,v198,v199
buffer_store_dwordx2 v[196:197],v23,s[16:19],s54 offen offset:288
v_mul_f32 v200,v200,v30
v_mul_f32 v201,v201,v30
v_mul_f32 v202,v202,v30
v_mul_f32 v203,v203,v30
v_cvt_pk_bf16_f32 v200,v200,v201
v_cvt_pk_bf16_f32 v201,v202,v203
buffer_store_dwordx2 v[200:201],v23,s[16:19],s54 offen offset:320
v_mul_f32 v204,v204,v30
v_mul_f32 v205,v205,v30
v_mul_f32 v206,v206,v30
v_mul_f32 v207,v207,v30
v_cvt_pk_bf16_f32 v204,v204,v205
v_cvt_pk_bf16_f32 v205,v206,v207
buffer_store_dwordx2 v[204:205],v23,s[16:19],s54 offen offset:352
s_waitcnt vmcnt(0)
s_add_u32 s54,s54,6144
s_add_u32 s51,s51,1
s_cmp_lt_u32 s51,s55
s_cbranch_scc1 L_fix_tile
s_cmp_lg_u32 s31,0
s_cbranch_scc1 L_fix_pass
s_branch L_done
L_codeend:
.section .rodata,"a"
.p2align 6
.amdhsa_kernel standalone__gqa_softmax__near_ridge_kernel
  .amdhsa_next_free_vgpr 512
  .amdhsa_next_free_sgpr 102
  .amdhsa_accum_offset 256
  .amdhsa_group_segment_fixed_size 0
  .amdhsa_kernarg_size 48
  .amdhsa_user_sgpr_count 2
  .amdhsa_user_sgpr_kernarg_segment_ptr 1
  .amdhsa_system_sgpr_workgroup_id_x 1
.end_amdhsa_kernel
```

```asm
; @launch grid=(256,1,1) block=(256,1,1) lds=163840
.amdgcn_target "amdgcn-amd-amdhsa--gfx950"
.text
.globl standalone__gqa_softmax__near_ridge_kernel
.p2align 8
.type standalone__gqa_softmax__near_ridge_kernel,@function
standalone__gqa_softmax__near_ridge_kernel:
s_cmp_ge_u32 s2,256
s_cbranch_scc1 L_end
s_load_dwordx4 s[84:87],s[0:1],0
s_load_dwordx4 s[88:91],s[0:1],16
v_lshrrev_b32 v30,6,v0
v_and_b32 v0,63,v0
v_readfirstlane_b32 s3,v30
s_getpc_b64 s[92:93]
L_pc:
s_lshr_b32 s62,s2,3
s_mul_i32 s62,s62,3584
v_min_u32 v144,27,v0
v_lshlrev_b32 v144,7,v144
v_add_u32 v144,s62,v144
v_min_u32 v144,L_codeend-L_pc-4,v144
s_cmp_lg_u32 s3,0
s_cbranch_scc1 L_nopre
global_load_dword v128,v144,s[92:93]
L_nopre:
v_lshrrev_b32 v144,3,v0
v_and_b32 v146,7,v0
v_add_u32 v145,0,v144
v_mul_u32_u24 v145,43,v145
v_lshrrev_b32 v145,7,v145
v_and_b32 v145,6,v145
v_xor_b32 v145,v145,v146
v_lshlrev_b32 v145,4,v145
v_lshl_add_u32 v7,v144,7,v145
v_add_u32 v145,8,v144
v_mul_u32_u24 v145,43,v145
v_lshrrev_b32 v145,7,v145
v_and_b32 v145,6,v145
v_xor_b32 v145,v145,v146
v_lshlrev_b32 v145,4,v145
v_lshl_add_u32 v8,v144,7,v145
v_add_u32 v145,16,v144
v_mul_u32_u24 v145,43,v145
v_lshrrev_b32 v145,7,v145
v_and_b32 v145,6,v145
v_xor_b32 v145,v145,v146
v_lshlrev_b32 v145,4,v145
v_lshl_add_u32 v9,v144,7,v145
s_mov_b32 s37,0x5d800000
s_mov_b32 s36,0x3dd53b95
s_mov_b32 s31,0
s_mov_b32 s32,1
s_and_b32 s62,s2,7
s_lshr_b32 s63,s2,3
s_and_b32 s49,s63,3
s_lshr_b32 s43,s63,2
s_lshl_b32 s62,s62,3
s_add_u32 s62,s62,s43
s_lshl_b32 s64,s62,3
s_mul_i32 s34,s64,196608
s_mul_i32 s33,s64,325632
s_mov_b32 s48,s33
s_mul_i32 s22,s3,3072
s_add_u32 s23,s22,36864
s_mul_i32 s24,s3,22528
s_add_u32 s24,s24,73728
s_add_u32 s20,s34,s22
s_mov_b32 s21,s20
s_mov_b32 s69,0
s_mov_b32 s62,0xaac3d274
s_mov_b32 s63,0xac39aac3
s_cmp_ge_u32 s43,4
s_cselect_b32 s62,0xd4b2b2d4,s62
s_cselect_b32 s63,0xd274b4d1,s63
s_and_b32 s64,s43,3
s_lshl_b32 s64,s64,4
s_lshr_b64 s[62:63],s[62:63],s64
s_and_b32 s39,s62,0xffff
s_lshr_b32 s62,s39,s69
s_and_b32 s62,s62,1
s_lshl_b32 s62,s62,1
s_add_u32 s62,s62,s49
s_and_b32 s62,s62,3
s_add_u32 s63,s69,8
s_lshr_b32 s63,s39,s63
s_and_b32 s63,s63,1
s_xor_b32 s62,s62,s63
s_mul_i32 s63,s3,3
s_lshl_b32 s64,s3,2
s_mov_b32 s40,1
s_add_u32 s65,s63,17
s_cmp_eq_u32 s3,0
s_cselect_b32 s65,16,s65
s_cselect_b32 s41,1,0
s_cmp_eq_u32 s62,1
s_cselect_b32 s64,s65,s64
s_cselect_b32 s40,s41,s40
s_add_u32 s65,s63,29
s_cmp_eq_u32 s62,2
s_cselect_b32 s64,s65,s64
s_cselect_b32 s40,0,s40
s_add_u32 s65,s63,41
s_cmp_eq_u32 s62,3
s_cselect_b32 s64,s65,s64
s_cselect_b32 s40,0,s40
s_mul_i32 s64,s64,6144
s_add_u32 s41,s48,s64
s_waitcnt lgkmcnt(0)
s_mov_b32 s4,s86
s_and_b32 s5,s87,0xffff
s_mov_b32 s7,0x20000
s_mov_b32 s12,s84
s_and_b32 s13,s85,0xffff
s_mov_b32 s15,0x20000
s_mov_b32 s8,s88
s_and_b32 s9,s89,0xffff
s_mov_b32 s11,0x20000
s_mov_b32 s16,s90
s_and_b32 s17,s91,0xffff
s_mov_b32 s19,0x20000
s_add_u32 s6,s34,1572864
s_mov_b32 s10,s6
s_mov_b32 s14,166723584
s_mov_b32 s18,166723584
s_cmp_eq_u32 s40,0
s_cbranch_scc1 L_start3
L_start4:
s_add_u32 m0,s22,0
s_nop 0
buffer_load_dwordx4 v7,s[4:7],s20 offen offset:0 lds
buffer_load_dwordx4 v8,s[4:7],s20 offen offset:1024 lds
buffer_load_dwordx4 v9,s[4:7],s20 offen offset:2048 lds
s_add_u32 s20,s20,12288
s_mov_b32 s28,s41
s_add_u32 m0,s24,0
s_nop 0
buffer_load_dwordx4 v7,s[12:15],s28 offen offset:0 nt lds
buffer_load_dwordx4 v8,s[12:15],s28 offen offset:1024 nt lds
buffer_load_dwordx4 v9,s[12:15],s28 offen offset:2048 nt lds
s_add_u32 s28,s28,3072
s_add_u32 m0,s24,3072
s_nop 0
buffer_load_dwordx4 v7,s[12:15],s28 offen offset:0 nt lds
buffer_load_dwordx4 v8,s[12:15],s28 offen offset:1024 nt lds
buffer_load_dwordx4 v9,s[12:15],s28 offen offset:2048 nt lds
s_add_u32 s28,s28,3072
s_add_u32 m0,s24,6144
s_nop 0
buffer_load_dwordx4 v7,s[12:15],s28 offen offset:0 nt lds
buffer_load_dwordx4 v8,s[12:15],s28 offen offset:1024 nt lds
buffer_load_dwordx4 v9,s[12:15],s28 offen offset:2048 nt lds
s_add_u32 s28,s28,3072
s_add_u32 m0,s24,9216
s_nop 0
buffer_load_dwordx4 v7,s[12:15],s28 offen offset:0 nt lds
buffer_load_dwordx4 v8,s[12:15],s28 offen offset:1024 nt lds
buffer_load_dwordx4 v9,s[12:15],s28 offen offset:2048 nt lds
s_add_u32 s28,s28,3072
v_and_b32 v144,15,v0
v_lshrrev_b32 v145,4,v0
v_lshrrev_b32 v146,3,v144
v_mul_u32_u24 v1,384,v144
v_and_b32 v147,6,v144
v_xor_b32 v147,v147,v145
v_lshl_add_u32 v1,v147,4,v1
v_xor_b32 v2,64,v1
v_mul_u32_u24 v148,19456,v146
v_add_u32 v148,92160,v148
v_add_u32 v13,v148,v1
v_add_u32 v28,s24,v1
v_add_u32 v14,v148,v2
v_add_u32 v29,s24,v2
v_lshrrev_b32 v144,2,v0
v_mul_u32_u24 v3,384,v144
v_and_b32 v144,6,v144
v_bfe_u32 v147,v0,1,1
v_xor_b32 v144,v144,v147
v_lshl_add_u32 v3,v144,4,v3
v_and_b32 v147,1,v0
v_lshl_add_u32 v3,v147,3,v3
v_add_u32 v3,36864,v3
v_xor_b32 v4,32,v3
v_xor_b32 v5,64,v3
v_xor_b32 v6,96,v3
v_lshrrev_b32 v144,3,v0
v_and_b32 v145,7,v0
v_lshrrev_b32 v147,5,v0
v_xor_b32 v147,v147,v145
v_lshlrev_b32 v12,7,v145
v_lshl_add_u32 v12,v147,4,v12
v_bfe_u32 v146,v0,4,1
v_lshl_add_u32 v12,v146,3,v12
v_bfe_u32 v146,v0,3,1
v_mul_u32_u24 v146,3072,v146
v_add3_u32 v12,v12,v146,s24
v_xor_b32 v20,32,v12
v_xor_b32 v21,64,v12
v_xor_b32 v22,96,v12
v_xor_b32 v146,v145,v144
v_lshlrev_b32 v15,7,v144
v_lshl_add_u32 v15,v146,4,v15
v_add_u32 v15,s24,v15
v_add_u32 v146,0,v144
v_mul_u32_u24 v147,43,v146
v_lshrrev_b32 v147,7,v147
v_mul_u32_u24 v148,3,v147
v_sub_u32 v146,v146,v148
v_lshlrev_b32 v146,10,v146
v_lshl_add_u32 v146,v147,7,v146
v_xor_b32 v147,v147,v145
v_lshl_add_u32 v146,v147,4,v146
v_add_u32 v11,s24,v146
v_add_u32 v146,8,v144
v_mul_u32_u24 v147,43,v146
v_lshrrev_b32 v147,7,v147
v_mul_u32_u24 v148,3,v147
v_sub_u32 v146,v146,v148
v_lshlrev_b32 v146,10,v146
v_lshl_add_u32 v146,v147,7,v146
v_xor_b32 v147,v147,v145
v_lshl_add_u32 v146,v147,4,v146
v_add_u32 v23,s24,v146
v_add_u32 v146,16,v144
v_mul_u32_u24 v147,43,v146
v_lshrrev_b32 v147,7,v147
v_mul_u32_u24 v148,3,v147
v_sub_u32 v146,v146,v148
v_lshlrev_b32 v146,10,v146
v_lshl_add_u32 v146,v147,7,v146
v_xor_b32 v147,v147,v145
v_lshl_add_u32 v146,v147,4,v146
v_add_u32 v31,s24,v146
v_mul_u32_u24 v10,384,v144
v_lshl_add_u32 v10,v145,4,v10
v_mov_b32 v24,0x3f803f80
v_mov_b32 v25,0x3f803f80
v_mov_b32 v26,0x3f803f80
v_mov_b32 v27,0x3f803f80
v_lshlrev_b32 v0,4,v0
s_waitcnt vmcnt(12)
s_barrier
ds_read_b128 a[192:195],v1 offset:0
ds_read_b128 a[196:199],v2 offset:0
ds_read_b128 a[200:203],v1 offset:128
ds_read_b128 a[204:207],v2 offset:128
ds_read_b128 a[208:211],v1 offset:256
ds_read_b128 a[212:215],v2 offset:256
ds_read_b128 a[216:219],v1 offset:6144
ds_read_b128 a[220:223],v2 offset:6144
ds_read_b128 a[224:227],v1 offset:6272
ds_read_b128 a[228:231],v2 offset:6272
ds_read_b128 a[232:235],v1 offset:6400
ds_read_b128 a[236:239],v2 offset:6400
s_waitcnt vmcnt(6)
ds_read_b128 a[96:99],v28 offset:0
ds_read_b128 a[100:103],v29 offset:0
ds_read_b128 a[104:107],v28 offset:128
ds_read_b128 a[108:111],v29 offset:128
ds_read_b128 a[112:115],v28 offset:256
ds_read_b128 a[116:119],v29 offset:256
s_waitcnt lgkmcnt(5)
v_mfma_f32_16x16x32_bf16 v[32:35],a[192:195],a[96:99],0
s_lshl_b32 s64,s22,1
s_waitcnt lgkmcnt(4)
v_mfma_f32_16x16x32_bf16 v[32:35],a[196:199],a[100:103],v[32:35]
s_add_u32 s64,s64,49152
s_add_u32 m0,s24,12288
v_add_u32 v144,s64,v1
s_waitcnt lgkmcnt(3)
v_mfma_f32_16x16x32_bf16 v[32:35],a[200:203],a[104:107],v[32:35]
buffer_load_dwordx4 v7,s[12:15],s28 offen offset:0 nt lds
s_waitcnt lgkmcnt(2)
v_mfma_f32_16x16x32_bf16 v[32:35],a[204:207],a[108:111],v[32:35]
buffer_load_dwordx4 v8,s[12:15],s28 offen offset:1024 nt lds
s_waitcnt lgkmcnt(1)
v_mfma_f32_16x16x32_bf16 v[32:35],a[208:211],a[112:115],v[32:35]
buffer_load_dwordx4 v9,s[12:15],s28 offen offset:2048 nt lds
s_add_u32 s28,s28,3072
s_add_u32 m0,s24,15360
s_waitcnt lgkmcnt(0)
v_mfma_f32_16x16x32_bf16 v[32:35],a[212:215],a[116:119],v[32:35]
buffer_load_dwordx4 v7,s[12:15],s28 offen offset:0 nt lds
v_mfma_f32_16x16x32_bf16 v[36:39],a[216:219],a[96:99],0
buffer_load_dwordx4 v8,s[12:15],s28 offen offset:1024 nt lds
v_mfma_f32_16x16x32_bf16 v[36:39],a[220:223],a[100:103],v[36:39]
buffer_load_dwordx4 v9,s[12:15],s28 offen offset:2048 nt lds
s_add_u32 s28,s28,3072
s_lshl_b32 s65,s22,1
s_add_u32 m0,s65,49152
v_mfma_f32_16x16x32_bf16 v[36:39],a[224:227],a[104:107],v[36:39]
v_add_u32 v145,s64,v2
v_mfma_f32_16x16x32_bf16 v[36:39],a[228:231],a[108:111],v[36:39]
v_mfma_f32_16x16x32_bf16 v[36:39],a[232:235],a[112:115],v[36:39]
v_mfma_f32_16x16x32_bf16 v[36:39],a[236:239],a[116:119],v[36:39]
s_waitcnt vmcnt(6)
ds_read_b128 a[120:123],v28 offset:6144
ds_read_b128 a[124:127],v29 offset:6144
ds_read_b128 a[128:131],v28 offset:6272
ds_read_b128 a[132:135],v29 offset:6272
ds_read_b128 a[136:139],v28 offset:6400
ds_read_b128 a[140:143],v29 offset:6400
s_waitcnt lgkmcnt(5)
v_mfma_f32_16x16x32_bf16 v[40:43],a[192:195],a[120:123],0
buffer_load_dwordx4 v7,s[12:15],s28 offen offset:0 nt lds
s_waitcnt lgkmcnt(4)
v_mfma_f32_16x16x32_bf16 v[40:43],a[196:199],a[124:127],v[40:43]
buffer_load_dwordx4 v8,s[12:15],s28 offen offset:1024 nt lds
s_waitcnt lgkmcnt(3)
v_mfma_f32_16x16x32_bf16 v[40:43],a[200:203],a[128:131],v[40:43]
buffer_load_dwordx4 v9,s[12:15],s28 offen offset:2048 nt lds
s_add_u32 s28,s28,3072
s_add_u32 m0,s65,52224
s_waitcnt lgkmcnt(2)
v_mfma_f32_16x16x32_bf16 v[40:43],a[204:207],a[132:135],v[40:43]
buffer_load_dwordx4 v7,s[12:15],s28 offen offset:0 nt lds
s_waitcnt lgkmcnt(1)
v_mfma_f32_16x16x32_bf16 v[40:43],a[208:211],a[136:139],v[40:43]
buffer_load_dwordx4 v8,s[12:15],s28 offen offset:1024 nt lds
s_waitcnt lgkmcnt(0)
v_mfma_f32_16x16x32_bf16 v[40:43],a[212:215],a[140:143],v[40:43]
buffer_load_dwordx4 v9,s[12:15],s28 offen offset:2048 nt lds
s_add_u32 s28,s28,3072
s_add_u32 m0,s22,12288
v_mfma_f32_16x16x32_bf16 v[44:47],a[216:219],a[120:123],0
v_mfma_f32_16x16x32_bf16 v[44:47],a[220:223],a[124:127],v[44:47]
v_mfma_f32_16x16x32_bf16 v[44:47],a[224:227],a[128:131],v[44:47]
v_mfma_f32_16x16x32_bf16 v[44:47],a[228:231],a[132:135],v[44:47]
v_mfma_f32_16x16x32_bf16 v[44:47],a[232:235],a[136:139],v[44:47]
v_mfma_f32_16x16x32_bf16 v[44:47],a[236:239],a[140:143],v[44:47]
s_waitcnt vmcnt(6)
ds_read_b128 a[144:147],v28 offset:12288
ds_read_b128 a[148:151],v29 offset:12288
ds_read_b128 a[152:155],v28 offset:12416
ds_read_b128 a[156:159],v29 offset:12416
ds_read_b128 a[160:163],v28 offset:12544
ds_read_b128 a[164:167],v29 offset:12544
s_waitcnt lgkmcnt(5)
v_mfma_f32_16x16x32_bf16 v[48:51],a[192:195],a[144:147],0
buffer_load_dwordx4 v7,s[4:7],s20 offen offset:0 lds
s_waitcnt lgkmcnt(4)
v_mfma_f32_16x16x32_bf16 v[48:51],a[196:199],a[148:151],v[48:51]
buffer_load_dwordx4 v8,s[4:7],s20 offen offset:1024 lds
s_waitcnt lgkmcnt(3)
v_mfma_f32_16x16x32_bf16 v[48:51],a[200:203],a[152:155],v[48:51]
buffer_load_dwordx4 v9,s[4:7],s20 offen offset:2048 lds
s_add_u32 s20,s20,12288
s_add_u32 m0,s23,0
s_waitcnt lgkmcnt(2)
v_mfma_f32_16x16x32_bf16 v[48:51],a[204:207],a[156:159],v[48:51]
s_waitcnt lgkmcnt(1)
v_mfma_f32_16x16x32_bf16 v[48:51],a[208:211],a[160:163],v[48:51]
s_waitcnt lgkmcnt(0)
v_mfma_f32_16x16x32_bf16 v[48:51],a[212:215],a[164:167],v[48:51]
v_mfma_f32_16x16x32_bf16 v[52:55],a[216:219],a[144:147],0
v_mfma_f32_16x16x32_bf16 v[52:55],a[220:223],a[148:151],v[52:55]
v_mfma_f32_16x16x32_bf16 v[52:55],a[224:227],a[152:155],v[52:55]
v_mfma_f32_16x16x32_bf16 v[52:55],a[228:231],a[156:159],v[52:55]
v_mfma_f32_16x16x32_bf16 v[52:55],a[232:235],a[160:163],v[52:55]
v_mfma_f32_16x16x32_bf16 v[52:55],a[236:239],a[164:167],v[52:55]
s_waitcnt vmcnt(3)
ds_read_b128 a[168:171],v144 offset:0
ds_read_b128 a[172:175],v145 offset:0
ds_read_b128 a[176:179],v144 offset:128
ds_read_b128 a[180:183],v145 offset:128
ds_read_b128 a[184:187],v144 offset:256
ds_read_b128 a[188:191],v145 offset:256
s_waitcnt lgkmcnt(5)
v_mfma_f32_16x16x32_bf16 v[56:59],a[192:195],a[168:171],0
buffer_load_dwordx4 v7,s[8:11],s21 offen offset:0 lds
s_waitcnt lgkmcnt(4)
v_mfma_f32_16x16x32_bf16 v[56:59],a[196:199],a[172:175],v[56:59]
buffer_load_dwordx4 v8,s[8:11],s21 offen offset:1024 lds
s_waitcnt lgkmcnt(3)
v_mfma_f32_16x16x32_bf16 v[56:59],a[200:203],a[176:179],v[56:59]
buffer_load_dwordx4 v9,s[8:11],s21 offen offset:2048 lds
s_add_u32 s21,s21,12288
s_add_u32 m0,s22,24576
s_waitcnt lgkmcnt(2)
v_mfma_f32_16x16x32_bf16 v[56:59],a[204:207],a[180:183],v[56:59]
buffer_load_dwordx4 v7,s[4:7],s20 offen offset:0 lds
s_waitcnt lgkmcnt(1)
v_mfma_f32_16x16x32_bf16 v[56:59],a[208:211],a[184:187],v[56:59]
buffer_load_dwordx4 v8,s[4:7],s20 offen offset:1024 lds
s_waitcnt lgkmcnt(0)
v_mfma_f32_16x16x32_bf16 v[56:59],a[212:215],a[188:191],v[56:59]
buffer_load_dwordx4 v9,s[4:7],s20 offen offset:2048 lds
s_add_u32 s20,s20,12288
s_mov_b32 s27,166723584
v_mfma_f32_16x16x32_bf16 v[60:63],a[216:219],a[168:171],0
s_mov_b32 s42,s41
s_add_u32 s69,s69,1
s_add_u32 s48,s48,325632
v_mfma_f32_16x16x32_bf16 v[60:63],a[220:223],a[172:175],v[60:63]
s_lshr_b32 s62,s39,s69
s_and_b32 s62,s62,1
s_lshl_b32 s62,s62,1
v_mfma_f32_16x16x32_bf16 v[60:63],a[224:227],a[176:179],v[60:63]
s_add_u32 s62,s62,s49
s_and_b32 s62,s62,3
s_add_u32 s63,s69,8
v_mfma_f32_16x16x32_bf16 v[60:63],a[228:231],a[180:183],v[60:63]
s_lshr_b32 s63,s39,s63
s_and_b32 s63,s63,1
s_xor_b32 s62,s62,s63
v_mfma_f32_16x16x32_bf16 v[60:63],a[232:235],a[184:187],v[60:63]
s_mul_i32 s63,s3,3
s_lshl_b32 s64,s3,2
s_mov_b32 s40,1
v_mfma_f32_16x16x32_bf16 v[60:63],a[236:239],a[188:191],v[60:63]
s_waitcnt vmcnt(6)
s_barrier
s_add_u32 s65,s63,17
s_cmp_eq_u32 s3,0
s_cselect_b32 s65,16,s65
s_cselect_b32 s41,1,0
s_cmp_eq_u32 s62,1
s_cselect_b32 s64,s65,s64
s_cselect_b32 s40,s41,s40
s_add_u32 s65,s63,29
s_cmp_eq_u32 s62,2
s_cselect_b32 s64,s65,s64
s_cselect_b32 s40,0,s40
s_add_u32 s65,s63,41
s_cmp_eq_u32 s62,3
s_cselect_b32 s64,s65,s64
s_cselect_b32 s40,0,s40
s_mul_i32 s64,s64,6144
s_add_u32 s41,s48,s64
s_cmp_ge_u32 s69,8
s_cselect_b32 s41,166723584,s41
s_mov_b32 s28,s41
s_mov_b32 s29,s24
s_add_u32 s25,s22,12288
s_add_u32 s26,s22,24576
ds_read_b128 a[192:195],v1 offset:12288
v_max3_f32 v144,v32,v33,v34
v_max3_f32 v146,v40,v41,v42
v_max3_f32 v144,v144,v35,v36
v_max3_f32 v146,v146,v43,v44
v_max3_f32 v144,v144,v37,v38
v_max3_f32 v146,v146,v45,v46
v_max_f32 v144,v144,v39
v_max_f32 v146,v146,v47
v_mov_b32 v145,v144
v_mov_b32 v147,v146
s_add_u32 m0,s23,12288
v_permlane32_swap_b32 v145,v144
v_permlane32_swap_b32 v147,v146
v_max_f32 v144,v144,v145
v_max_f32 v146,v146,v147
v_mov_b32 v145,v144
v_mov_b32 v147,v146
buffer_load_dwordx4 v7,s[8:11],s21 offen offset:0 lds
ds_read_b128 a[196:199],v2 offset:12288
v_permlane16_swap_b32 v145,v144
v_permlane16_swap_b32 v147,v146
v_max_f32 v144,v144,v145
v_max_f32 v146,v146,v147
v_mul_f32_e64 v16,-s36,v144
v_mul_f32_e64 v17,-s36,v146
v_max3_f32 v144,v48,v49,v50
s_waitcnt lgkmcnt(1)
v_mfma_f32_16x16x32_bf16 v[64:67],a[192:195],a[96:99],0
ds_read_b128 a[200:203],v1 offset:12416
v_max3_f32 v146,v56,v57,v58
v_max3_f32 v144,v144,v51,v52
v_max3_f32 v146,v146,v59,v60
v_max3_f32 v144,v144,v53,v54
v_max3_f32 v146,v146,v61,v62
v_max_f32 v144,v144,v55
v_max_f32 v146,v146,v63
v_mov_b32 v145,v144
v_mov_b32 v147,v146
v_fma_f32 v32,v32,s36,v16
v_permlane32_swap_b32 v145,v144
v_permlane32_swap_b32 v147,v146
v_max_f32 v144,v144,v145
v_max_f32 v146,v146,v147
v_mov_b32 v145,v144
v_mov_b32 v147,v146
v_fma_f32 v33,v33,s36,v16
v_permlane16_swap_b32 v145,v144
v_permlane16_swap_b32 v147,v146
s_waitcnt lgkmcnt(1)
v_mfma_f32_16x16x32_bf16 v[64:67],a[196:199],a[100:103],v[64:67]
buffer_load_dwordx4 v8,s[8:11],s21 offen offset:1024 lds
ds_read_b128 a[204:207],v2 offset:12416
v_max_f32 v144,v144,v145
v_max_f32 v146,v146,v147
v_mul_f32_e64 v18,-s36,v144
v_mul_f32_e64 v19,-s36,v146
v_fma_f32 v34,v34,s36,v16
s_waitcnt lgkmcnt(1)
v_mfma_f32_16x16x32_bf16 v[64:67],a[200:203],a[104:107],v[64:67]
ds_read_b128 a[208:211],v1 offset:12544
v_fma_f32 v35,v35,s36,v16
v_fma_f32 v36,v36,s36,v16
v_fma_f32 v37,v37,s36,v16
v_fma_f32 v38,v38,s36,v16
v_fma_f32 v39,v39,s36,v16
v_fma_f32 v40,v40,s36,v17
v_fma_f32 v41,v41,s36,v17
v_fma_f32 v42,v42,s36,v17
v_fma_f32 v43,v43,s36,v17
v_fma_f32 v44,v44,s36,v17
v_fma_f32 v45,v45,s36,v17
v_fma_f32 v46,v46,s36,v17
v_fma_f32 v47,v47,s36,v17
v_fma_f32 v48,v48,s36,v18
v_fma_f32 v49,v49,s36,v18
v_fma_f32 v50,v50,s36,v18
v_fma_f32 v51,v51,s36,v18
v_fma_f32 v52,v52,s36,v18
v_fma_f32 v53,v53,s36,v18
v_fma_f32 v54,v54,s36,v18
v_fma_f32 v55,v55,s36,v18
v_fma_f32 v56,v56,s36,v19
v_fma_f32 v57,v57,s36,v19
v_fma_f32 v58,v58,s36,v19
v_fma_f32 v59,v59,s36,v19
v_fma_f32 v60,v60,s36,v19
s_waitcnt lgkmcnt(1)
v_mfma_f32_16x16x32_bf16 v[64:67],a[204:207],a[108:111],v[64:67]
ds_read_b128 a[212:215],v2 offset:12544
v_fma_f32 v61,v61,s36,v19
v_fma_f32 v62,v62,s36,v19
v_fma_f32 v63,v63,s36,v19
v_exp_f32 v32,v32
s_waitcnt lgkmcnt(1)
v_mfma_f32_16x16x32_bf16 v[64:67],a[208:211],a[112:115],v[64:67]
buffer_load_dwordx4 v9,s[8:11],s21 offen offset:2048 lds
s_add_u32 s21,s21,12288
s_add_u32 m0,s22,0
ds_read_b128 a[216:219],v1 offset:18432
v_exp_f32 v33,v33
v_exp_f32 v34,v34
v_exp_f32 v35,v35
v_exp_f32 v36,v36
v_exp_f32 v37,v37
v_exp_f32 v38,v38
v_exp_f32 v39,v39
v_exp_f32 v40,v40
v_exp_f32 v41,v41
v_exp_f32 v42,v42
v_exp_f32 v43,v43
v_exp_f32 v44,v44
s_waitcnt lgkmcnt(1)
v_mfma_f32_16x16x32_bf16 v[64:67],a[212:215],a[116:119],v[64:67]
ds_read_b128 a[220:223],v2 offset:18432
v_exp_f32 v45,v45
v_mfma_f32_16x16x32_bf16 v[72:75],a[192:195],a[120:123],0
ds_read_b128 a[224:227],v1 offset:18560
v_exp_f32 v46,v46
v_mfma_f32_16x16x32_bf16 v[72:75],a[196:199],a[124:127],v[72:75]
ds_read_b128 a[228:231],v2 offset:18560
v_exp_f32 v47,v47
v_mfma_f32_16x16x32_bf16 v[72:75],a[200:203],a[128:131],v[72:75]
buffer_load_dwordx4 v7,s[4:7],s20 offen offset:0 lds
v_mfma_f32_16x16x32_bf16 v[72:75],a[204:207],a[132:135],v[72:75]
ds_read_b128 a[232:235],v1 offset:18688
v_exp_f32 v48,v48
v_mfma_f32_16x16x32_bf16 v[72:75],a[208:211],a[136:139],v[72:75]
ds_read_b128 a[236:239],v2 offset:18688
v_exp_f32 v49,v49
v_mfma_f32_16x16x32_bf16 v[72:75],a[212:215],a[140:143],v[72:75]
v_exp_f32 v50,v50
v_mfma_f32_16x16x32_bf16 v[80:83],a[192:195],a[144:147],0
v_exp_f32 v51,v51
v_mfma_f32_16x16x32_bf16 v[80:83],a[196:199],a[148:151],v[80:83]
v_exp_f32 v52,v52
v_mfma_f32_16x16x32_bf16 v[80:83],a[200:203],a[152:155],v[80:83]
v_exp_f32 v53,v53
v_mfma_f32_16x16x32_bf16 v[80:83],a[204:207],a[156:159],v[80:83]
v_exp_f32 v54,v54
v_mfma_f32_16x16x32_bf16 v[80:83],a[208:211],a[160:163],v[80:83]
v_exp_f32 v55,v55
v_mfma_f32_16x16x32_bf16 v[80:83],a[212:215],a[164:167],v[80:83]
v_exp_f32 v56,v56
v_mfma_f32_16x16x32_bf16 v[88:91],a[192:195],a[168:171],0
v_exp_f32 v57,v57
v_mfma_f32_16x16x32_bf16 v[88:91],a[196:199],a[172:175],v[88:91]
v_exp_f32 v58,v58
v_mfma_f32_16x16x32_bf16 v[88:91],a[200:203],a[176:179],v[88:91]
buffer_load_dwordx4 v8,s[4:7],s20 offen offset:1024 lds
v_mfma_f32_16x16x32_bf16 v[88:91],a[204:207],a[180:183],v[88:91]
v_exp_f32 v59,v59
v_mfma_f32_16x16x32_bf16 v[88:91],a[208:211],a[184:187],v[88:91]
v_exp_f32 v60,v60
v_mfma_f32_16x16x32_bf16 v[88:91],a[212:215],a[188:191],v[88:91]
s_waitcnt lgkmcnt(0)
v_exp_f32 v61,v61
v_mfma_f32_16x16x32_bf16 v[68:71],a[216:219],a[96:99],0
v_exp_f32 v62,v62
v_mfma_f32_16x16x32_bf16 v[68:71],a[220:223],a[100:103],v[68:71]
v_exp_f32 v63,v63
v_mfma_f32_16x16x32_bf16 v[68:71],a[224:227],a[104:107],v[68:71]
v_cvt_pk_bf16_f32 v96,v32,v33
v_cvt_pk_bf16_f32 v97,v34,v35
v_mfma_f32_16x16x32_bf16 v[68:71],a[228:231],a[108:111],v[68:71]
v_cvt_pk_bf16_f32 v98,v36,v37
v_cvt_pk_bf16_f32 v99,v38,v39
v_mfma_f32_16x16x32_bf16 v[68:71],a[232:235],a[112:115],v[68:71]
v_cvt_pk_bf16_f32 v100,v40,v41
v_cvt_pk_bf16_f32 v101,v42,v43
v_mfma_f32_16x16x32_bf16 v[128:131],v[24:27],v[96:99],0
v_cvt_pk_bf16_f32 v102,v44,v45
v_cvt_pk_bf16_f32 v103,v46,v47
v_mfma_f32_16x16x32_bf16 v[68:71],a[236:239],a[116:119],v[68:71]
v_cvt_pk_bf16_f32 v104,v48,v49
v_cvt_pk_bf16_f32 v105,v50,v51
v_mfma_f32_16x16x32_bf16 v[132:135],v[24:27],v[100:103],0
v_cvt_pk_bf16_f32 v106,v52,v53
v_cvt_pk_bf16_f32 v107,v54,v55
v_mfma_f32_16x16x32_bf16 v[76:79],a[216:219],a[120:123],0
buffer_load_dwordx4 v9,s[4:7],s20 offen offset:2048 lds
s_add_u32 s20,s20,12288
v_mfma_f32_16x16x32_bf16 v[136:139],v[24:27],v[104:107],0
v_cvt_pk_bf16_f32 v108,v56,v57
v_cvt_pk_bf16_f32 v109,v58,v59
v_mfma_f32_16x16x32_bf16 v[76:79],a[220:223],a[124:127],v[76:79]
v_cvt_pk_bf16_f32 v110,v60,v61
v_cvt_pk_bf16_f32 v111,v62,v63
v_mfma_f32_16x16x32_bf16 v[76:79],a[224:227],a[128:131],v[76:79]
v_fma_f32 v64,v64,s36,v16
v_fma_f32 v65,v65,s36,v16
v_mfma_f32_16x16x32_bf16 v[140:143],v[24:27],v[108:111],0
v_fma_f32 v66,v66,s36,v16
v_fma_f32 v67,v67,s36,v16
v_mfma_f32_16x16x32_bf16 v[76:79],a[228:231],a[132:135],v[76:79]
v_fma_f32 v72,v72,s36,v17
v_fma_f32 v73,v73,s36,v17
v_mfma_f32_16x16x32_bf16 v[76:79],a[232:235],a[136:139],v[76:79]
v_fma_f32 v74,v74,s36,v17
v_fma_f32 v75,v75,s36,v17
v_mfma_f32_16x16x32_bf16 v[76:79],a[236:239],a[140:143],v[76:79]
v_exp_f32 v64,v64
v_mfma_f32_16x16x32_bf16 v[84:87],a[216:219],a[144:147],0
v_exp_f32 v65,v65
v_mfma_f32_16x16x32_bf16 v[84:87],a[220:223],a[148:151],v[84:87]
v_exp_f32 v66,v66
v_mfma_f32_16x16x32_bf16 v[84:87],a[224:227],a[152:155],v[84:87]
v_exp_f32 v67,v67
v_mfma_f32_16x16x32_bf16 v[84:87],a[228:231],a[156:159],v[84:87]
v_exp_f32 v72,v72
v_mfma_f32_16x16x32_bf16 v[84:87],a[232:235],a[160:163],v[84:87]
v_exp_f32 v73,v73
v_mfma_f32_16x16x32_bf16 v[84:87],a[236:239],a[164:167],v[84:87]
v_exp_f32 v74,v74
v_mfma_f32_16x16x32_bf16 v[92:95],a[216:219],a[168:171],0
v_exp_f32 v75,v75
v_mfma_f32_16x16x32_bf16 v[92:95],a[220:223],a[172:175],v[92:95]
v_cvt_pk_bf16_f32 v112,v64,v65
v_cvt_pk_bf16_f32 v113,v66,v67
v_mfma_f32_16x16x32_bf16 v[92:95],a[224:227],a[176:179],v[92:95]
v_cvt_pk_bf16_f32 v116,v72,v73
v_cvt_pk_bf16_f32 v117,v74,v75
v_mfma_f32_16x16x32_bf16 v[92:95],a[228:231],a[180:183],v[92:95]
v_mfma_f32_16x16x32_bf16 v[92:95],a[232:235],a[184:187],v[92:95]
v_mfma_f32_16x16x32_bf16 v[92:95],a[236:239],a[188:191],v[92:95]
s_waitcnt vmcnt(6)
s_barrier
ds_read_b64_tr_b16 a[240:241],v3 offset:0
ds_read_b64_tr_b16 a[242:243],v3 offset:6144
ds_read_b64_tr_b16 a[244:245],v4 offset:0
ds_read_b64_tr_b16 a[246:247],v4 offset:6144
ds_read_b64_tr_b16 a[248:249],v5 offset:0
ds_read_b64_tr_b16 a[250:251],v5 offset:6144
ds_read_b64_tr_b16 a[252:253],v6 offset:0
ds_read_b64_tr_b16 a[254:255],v6 offset:6144
s_waitcnt lgkmcnt(6)
v_mfma_f32_16x16x32_bf16 v[160:163],a[240:243],v[96:99],0
s_add_u32 m0,s23,24576
ds_read_b128 a[192:195],v1 offset:24576
v_fma_f32 v68,v68,s36,v16
v_mfma_f32_16x16x32_bf16 v[208:211],a[240:243],v[100:103],0
buffer_load_dwordx4 v7,s[8:11],s21 offen offset:0 lds
v_mfma_f32_16x16x32_bf16 a[0:3],a[240:243],v[104:107],0
ds_read_b128 a[196:199],v2 offset:24576
v_fma_f32 v69,v69,s36,v16
v_mfma_f32_16x16x32_bf16 a[48:51],a[240:243],v[108:111],0
s_waitcnt lgkmcnt(6)
ds_read_b64_tr_b16 a[240:241],v3 offset:128
ds_read_b64_tr_b16 a[242:243],v3 offset:6272
v_mfma_f32_16x16x32_bf16 v[164:167],a[244:247],v[96:99],0
ds_read_b128 a[200:203],v1 offset:24704
v_fma_f32 v70,v70,s36,v16
v_mfma_f32_16x16x32_bf16 v[212:215],a[244:247],v[100:103],0
ds_read_b128 a[204:207],v2 offset:24704
v_fma_f32 v71,v71,s36,v16
v_mfma_f32_16x16x32_bf16 a[4:7],a[244:247],v[104:107],0
ds_read_b128 a[208:211],v1 offset:24832
v_fma_f32 v76,v76,s36,v17
v_mfma_f32_16x16x32_bf16 a[52:55],a[244:247],v[108:111],0
s_waitcnt lgkmcnt(7)
ds_read_b64_tr_b16 a[244:245],v4 offset:128
ds_read_b64_tr_b16 a[246:247],v4 offset:6272
v_mfma_f32_16x16x32_bf16 v[168:171],a[248:251],v[96:99],0
ds_read_b128 a[212:215],v2 offset:24832
v_fma_f32 v77,v77,s36,v17
v_mfma_f32_16x16x32_bf16 v[216:219],a[248:251],v[100:103],0
buffer_load_dwordx4 v8,s[8:11],s21 offen offset:1024 lds
v_mfma_f32_16x16x32_bf16 a[8:11],a[248:251],v[104:107],0
ds_read_b128 a[216:219],v1 offset:30720
v_fma_f32 v78,v78,s36,v17
v_mfma_f32_16x16x32_bf16 a[56:59],a[248:251],v[108:111],0
ds_read_b64_tr_b16 a[248:249],v5 offset:128
ds_read_b64_tr_b16 a[250:251],v5 offset:6272
v_mfma_f32_16x16x32_bf16 v[172:175],a[252:255],v[96:99],0
ds_read_b128 a[220:223],v2 offset:30720
v_fma_f32 v79,v79,s36,v17
v_mfma_f32_16x16x32_bf16 v[220:223],a[252:255],v[100:103],0
ds_read_b128 a[224:227],v1 offset:30848
v_fma_f32 v80,v80,s36,v18
v_mfma_f32_16x16x32_bf16 a[12:15],a[252:255],v[104:107],0
ds_read_b128 a[228:231],v2 offset:30848
v_fma_f32 v81,v81,s36,v18
v_mfma_f32_16x16x32_bf16 a[60:63],a[252:255],v[108:111],0
s_waitcnt lgkmcnt(7)
ds_read_b64_tr_b16 a[252:253],v6 offset:128
ds_read_b64_tr_b16 a[254:255],v6 offset:6272
v_mfma_f32_16x16x32_bf16 v[176:179],a[240:243],v[96:99],0
ds_read_b128 a[232:235],v1 offset:30976
v_fma_f32 v82,v82,s36,v18
v_mfma_f32_16x16x32_bf16 v[224:227],a[240:243],v[100:103],0
buffer_load_dwordx4 v9,s[8:11],s21 offen offset:2048 lds
v_mfma_f32_16x16x32_bf16 a[16:19],a[240:243],v[104:107],0
s_add_u32 s21,s21,12288
ds_read_b128 a[236:239],v2 offset:30976
v_fma_f32 v83,v83,s36,v18
v_mfma_f32_16x16x32_bf16 a[64:67],a[240:243],v[108:111],0
s_add_u32 m0,s22,12288
ds_read_b64_tr_b16 a[240:241],v3 offset:256
ds_read_b64_tr_b16 a[242:243],v3 offset:6400
v_mfma_f32_16x16x32_bf16 v[180:183],a[244:247],v[96:99],0
v_fma_f32 v84,v84,s36,v18
v_fma_f32 v85,v85,s36,v18
v_mfma_f32_16x16x32_bf16 v[228:231],a[244:247],v[100:103],0
v_fma_f32 v86,v86,s36,v18
v_fma_f32 v87,v87,s36,v18
v_mfma_f32_16x16x32_bf16 a[20:23],a[244:247],v[104:107],0
v_fma_f32 v88,v88,s36,v19
v_fma_f32 v89,v89,s36,v19
v_mfma_f32_16x16x32_bf16 a[68:71],a[244:247],v[108:111],0
s_waitcnt lgkmcnt(4)
ds_read_b64_tr_b16 a[244:245],v4 offset:256
ds_read_b64_tr_b16 a[246:247],v4 offset:6400
v_mfma_f32_16x16x32_bf16 v[184:187],a[248:251],v[96:99],0
buffer_load_dwordx4 v7,s[4:7],s20 offen offset:0 lds
v_mfma_f32_16x16x32_bf16 v[232:235],a[248:251],v[100:103],0
v_fma_f32 v90,v90,s36,v19
v_fma_f32 v91,v91,s36,v19
v_mfma_f32_16x16x32_bf16 a[24:27],a[248:251],v[104:107],0
v_fma_f32 v92,v92,s36,v19
v_fma_f32 v93,v93,s36,v19
v_mfma_f32_16x16x32_bf16 a[72:75],a[248:251],v[108:111],0
ds_read_b64_tr_b16 a[248:249],v5 offset:256
ds_read_b64_tr_b16 a[250:251],v5 offset:6400
v_mfma_f32_16x16x32_bf16 v[188:191],a[252:255],v[96:99],0
v_fma_f32 v94,v94,s36,v19
v_fma_f32 v95,v95,s36,v19
v_mfma_f32_16x16x32_bf16 v[236:239],a[252:255],v[100:103],0
v_exp_f32 v68,v68
v_mfma_f32_16x16x32_bf16 a[28:31],a[252:255],v[104:107],0
v_exp_f32 v69,v69
v_mfma_f32_16x16x32_bf16 a[76:79],a[252:255],v[108:111],0
s_waitcnt lgkmcnt(2)
ds_read_b64_tr_b16 a[252:253],v6 offset:256
ds_read_b64_tr_b16 a[254:255],v6 offset:6400
v_mfma_f32_16x16x32_bf16 v[192:195],a[240:243],v[96:99],0
buffer_load_dwordx4 v8,s[4:7],s20 offen offset:1024 lds
v_mfma_f32_16x16x32_bf16 v[240:243],a[240:243],v[100:103],0
v_exp_f32 v70,v70
v_mfma_f32_16x16x32_bf16 a[32:35],a[240:243],v[104:107],0
v_exp_f32 v71,v71
v_mfma_f32_16x16x32_bf16 a[80:83],a[240:243],v[108:111],0
v_exp_f32 v76,v76
v_mfma_f32_16x16x32_bf16 v[196:199],a[244:247],v[96:99],0
v_exp_f32 v77,v77
v_mfma_f32_16x16x32_bf16 v[244:247],a[244:247],v[100:103],0
v_exp_f32 v78,v78
v_mfma_f32_16x16x32_bf16 a[36:39],a[244:247],v[104:107],0
v_exp_f32 v79,v79
v_mfma_f32_16x16x32_bf16 a[84:87],a[244:247],v[108:111],0
s_waitcnt lgkmcnt(0)
v_exp_f32 v80,v80
v_mfma_f32_16x16x32_bf16 v[200:203],a[248:251],v[96:99],0
buffer_load_dwordx4 v9,s[4:7],s20 offen offset:2048 lds
v_mfma_f32_16x16x32_bf16 v[248:251],a[248:251],v[100:103],0
s_add_u32 s20,s20,12288
v_exp_f32 v81,v81
v_mfma_f32_16x16x32_bf16 a[40:43],a[248:251],v[104:107],0
v_exp_f32 v82,v82
v_mfma_f32_16x16x32_bf16 a[88:91],a[248:251],v[108:111],0
v_exp_f32 v83,v83
v_mfma_f32_16x16x32_bf16 v[204:207],a[252:255],v[96:99],0
v_exp_f32 v84,v84
v_mfma_f32_16x16x32_bf16 v[252:255],a[252:255],v[100:103],0
v_exp_f32 v85,v85
v_mfma_f32_16x16x32_bf16 a[44:47],a[252:255],v[104:107],0
v_exp_f32 v86,v86
v_mfma_f32_16x16x32_bf16 a[92:95],a[252:255],v[108:111],0
v_exp_f32 v87,v87
v_mfma_f32_16x16x32_bf16 v[32:35],a[192:195],a[96:99],0
v_exp_f32 v88,v88
v_mfma_f32_16x16x32_bf16 v[32:35],a[196:199],a[100:103],v[32:35]
v_exp_f32 v89,v89
v_mfma_f32_16x16x32_bf16 v[32:35],a[200:203],a[104:107],v[32:35]
v_exp_f32 v90,v90
v_mfma_f32_16x16x32_bf16 v[32:35],a[204:207],a[108:111],v[32:35]
v_exp_f32 v91,v91
v_mfma_f32_16x16x32_bf16 v[32:35],a[208:211],a[112:115],v[32:35]
v_exp_f32 v92,v92
v_mfma_f32_16x16x32_bf16 v[32:35],a[212:215],a[116:119],v[32:35]
v_exp_f32 v93,v93
v_mfma_f32_16x16x32_bf16 v[40:43],a[192:195],a[120:123],0
v_exp_f32 v94,v94
v_mfma_f32_16x16x32_bf16 v[40:43],a[196:199],a[124:127],v[40:43]
v_exp_f32 v95,v95
v_mfma_f32_16x16x32_bf16 v[40:43],a[200:203],a[128:131],v[40:43]
v_cvt_pk_bf16_f32 v114,v68,v69
v_cvt_pk_bf16_f32 v115,v70,v71
v_mfma_f32_16x16x32_bf16 v[40:43],a[204:207],a[132:135],v[40:43]
v_cvt_pk_bf16_f32 v118,v76,v77
v_cvt_pk_bf16_f32 v119,v78,v79
v_mfma_f32_16x16x32_bf16 v[128:131],v[24:27],v[112:115],v[128:131]
v_cvt_pk_bf16_f32 v120,v80,v81
v_cvt_pk_bf16_f32 v121,v82,v83
v_mfma_f32_16x16x32_bf16 v[132:135],v[24:27],v[116:119],v[132:135]
v_cvt_pk_bf16_f32 v122,v84,v85
v_cvt_pk_bf16_f32 v123,v86,v87
v_mfma_f32_16x16x32_bf16 v[40:43],a[208:211],a[136:139],v[40:43]
v_cvt_pk_bf16_f32 v124,v88,v89
v_cvt_pk_bf16_f32 v125,v90,v91
v_mfma_f32_16x16x32_bf16 v[136:139],v[24:27],v[120:123],v[136:139]
v_cvt_pk_bf16_f32 v126,v92,v93
v_cvt_pk_bf16_f32 v127,v94,v95
v_mfma_f32_16x16x32_bf16 v[40:43],a[212:215],a[140:143],v[40:43]
v_fma_f32 v32,v32,s36,v16
v_fma_f32 v33,v33,s36,v16
v_mfma_f32_16x16x32_bf16 v[140:143],v[24:27],v[124:127],v[140:143]
v_fma_f32 v34,v34,s36,v16
v_fma_f32 v35,v35,s36,v16
v_mfma_f32_16x16x32_bf16 v[48:51],a[192:195],a[144:147],0
v_exp_f32 v32,v32
v_mfma_f32_16x16x32_bf16 v[48:51],a[196:199],a[148:151],v[48:51]
v_fma_f32 v40,v40,s36,v17
v_fma_f32 v41,v41,s36,v17
v_mfma_f32_16x16x32_bf16 v[48:51],a[200:203],a[152:155],v[48:51]
v_fma_f32 v42,v42,s36,v17
v_fma_f32 v43,v43,s36,v17
v_mfma_f32_16x16x32_bf16 v[48:51],a[204:207],a[156:159],v[48:51]
v_exp_f32 v33,v33
v_mfma_f32_16x16x32_bf16 v[48:51],a[208:211],a[160:163],v[48:51]
v_exp_f32 v34,v34
v_mfma_f32_16x16x32_bf16 v[48:51],a[212:215],a[164:167],v[48:51]
v_exp_f32 v35,v35
v_mfma_f32_16x16x32_bf16 v[56:59],a[192:195],a[168:171],0
v_exp_f32 v40,v40
v_mfma_f32_16x16x32_bf16 v[56:59],a[196:199],a[172:175],v[56:59]
v_exp_f32 v41,v41
v_mfma_f32_16x16x32_bf16 v[56:59],a[200:203],a[176:179],v[56:59]
v_exp_f32 v42,v42
v_mfma_f32_16x16x32_bf16 v[56:59],a[204:207],a[180:183],v[56:59]
v_exp_f32 v43,v43
v_mfma_f32_16x16x32_bf16 v[56:59],a[208:211],a[184:187],v[56:59]
v_cvt_pk_bf16_f32 v96,v32,v33
v_cvt_pk_bf16_f32 v97,v34,v35
v_mfma_f32_16x16x32_bf16 v[56:59],a[212:215],a[188:191],v[56:59]
v_cvt_pk_bf16_f32 v100,v40,v41
v_cvt_pk_bf16_f32 v101,v42,v43
v_mfma_f32_16x16x32_bf16 v[36:39],a[216:219],a[96:99],0
v_mfma_f32_16x16x32_bf16 v[36:39],a[220:223],a[100:103],v[36:39]
v_mfma_f32_16x16x32_bf16 v[36:39],a[224:227],a[104:107],v[36:39]
v_mfma_f32_16x16x32_bf16 v[36:39],a[228:231],a[108:111],v[36:39]
v_mfma_f32_16x16x32_bf16 v[36:39],a[232:235],a[112:115],v[36:39]
v_mfma_f32_16x16x32_bf16 v[36:39],a[236:239],a[116:119],v[36:39]
v_mfma_f32_16x16x32_bf16 v[44:47],a[216:219],a[120:123],0
v_mfma_f32_16x16x32_bf16 v[44:47],a[220:223],a[124:127],v[44:47]
v_mfma_f32_16x16x32_bf16 v[44:47],a[224:227],a[128:131],v[44:47]
v_mfma_f32_16x16x32_bf16 v[44:47],a[228:231],a[132:135],v[44:47]
v_mfma_f32_16x16x32_bf16 v[44:47],a[232:235],a[136:139],v[44:47]
s_waitcnt vmcnt(6)
s_barrier
v_mfma_f32_16x16x32_bf16 v[44:47],a[236:239],a[140:143],v[44:47]
v_mfma_f32_16x16x32_bf16 v[52:55],a[216:219],a[144:147],0
ds_read_b64_tr_b16 a[240:241],v3 offset:12288
ds_read_b64_tr_b16 a[242:243],v3 offset:18432
v_mfma_f32_16x16x32_bf16 v[52:55],a[220:223],a[148:151],v[52:55]
v_mfma_f32_16x16x32_bf16 v[52:55],a[224:227],a[152:155],v[52:55]
ds_read_b64_tr_b16 a[244:245],v4 offset:12288
ds_read_b64_tr_b16 a[246:247],v4 offset:18432
v_mfma_f32_16x16x32_bf16 v[52:55],a[228:231],a[156:159],v[52:55]
v_mfma_f32_16x16x32_bf16 v[52:55],a[232:235],a[160:163],v[52:55]
ds_read_b64_tr_b16 a[248:249],v5 offset:12288
ds_read_b64_tr_b16 a[250:251],v5 offset:18432
v_mfma_f32_16x16x32_bf16 v[52:55],a[236:239],a[164:167],v[52:55]
v_mfma_f32_16x16x32_bf16 v[60:63],a[216:219],a[168:171],0
ds_read_b64_tr_b16 a[252:253],v6 offset:12288
ds_read_b64_tr_b16 a[254:255],v6 offset:18432
v_mfma_f32_16x16x32_bf16 v[60:63],a[220:223],a[172:175],v[60:63]
v_mfma_f32_16x16x32_bf16 v[60:63],a[224:227],a[176:179],v[60:63]
v_mfma_f32_16x16x32_bf16 v[60:63],a[228:231],a[180:183],v[60:63]
v_mfma_f32_16x16x32_bf16 v[60:63],a[232:235],a[184:187],v[60:63]
v_mfma_f32_16x16x32_bf16 v[60:63],a[236:239],a[188:191],v[60:63]
s_waitcnt lgkmcnt(4)
v_mfma_f32_16x16x32_bf16 v[160:163],a[240:243],v[112:115],v[160:163]
s_add_u32 m0,s23,0
ds_read_b128 a[192:195],v1 offset:0
v_fma_f32 v36,v36,s36,v16
v_mfma_f32_16x16x32_bf16 v[208:211],a[240:243],v[116:119],v[208:211]
buffer_load_dwordx4 v7,s[8:11],s21 offen offset:0 lds
v_mfma_f32_16x16x32_bf16 a[0:3],a[240:243],v[120:123],a[0:3]
ds_read_b128 a[196:199],v2 offset:0
v_fma_f32 v37,v37,s36,v16
v_mfma_f32_16x16x32_bf16 a[48:51],a[240:243],v[124:127],a[48:51]
ds_read_b64_tr_b16 a[240:241],v3 offset:12416
ds_read_b64_tr_b16 a[242:243],v3 offset:18560
v_mfma_f32_16x16x32_bf16 v[164:167],a[244:247],v[112:115],v[164:167]
ds_read_b128 a[200:203],v1 offset:128
v_fma_f32 v38,v38,s36,v16
v_mfma_f32_16x16x32_bf16 v[212:215],a[244:247],v[116:119],v[212:215]
ds_read_b128 a[204:207],v2 offset:128
v_fma_f32 v39,v39,s36,v16
v_mfma_f32_16x16x32_bf16 a[4:7],a[244:247],v[120:123],a[4:7]
ds_read_b128 a[208:211],v1 offset:256
v_fma_f32 v44,v44,s36,v17
v_mfma_f32_16x16x32_bf16 a[52:55],a[244:247],v[124:127],a[52:55]
s_waitcnt lgkmcnt(7)
ds_read_b64_tr_b16 a[244:245],v4 offset:12416
ds_read_b64_tr_b16 a[246:247],v4 offset:18560
v_mfma_f32_16x16x32_bf16 v[168:171],a[248:251],v[112:115],v[168:171]
ds_read_b128 a[212:215],v2 offset:256
v_fma_f32 v45,v45,s36,v17
v_mfma_f32_16x16x32_bf16 v[216:219],a[248:251],v[116:119],v[216:219]
buffer_load_dwordx4 v8,s[8:11],s21 offen offset:1024 lds
v_mfma_f32_16x16x32_bf16 a[8:11],a[248:251],v[120:123],a[8:11]
ds_read_b128 a[216:219],v1 offset:6144
v_fma_f32 v46,v46,s36,v17
v_mfma_f32_16x16x32_bf16 a[56:59],a[248:251],v[124:127],a[56:59]
ds_read_b64_tr_b16 a[248:249],v5 offset:12416
ds_read_b64_tr_b16 a[250:251],v5 offset:18560
v_mfma_f32_16x16x32_bf16 v[172:175],a[252:255],v[112:115],v[172:175]
ds_read_b128 a[220:223],v2 offset:6144
v_fma_f32 v47,v47,s36,v17
v_mfma_f32_16x16x32_bf16 v[220:223],a[252:255],v[116:119],v[220:223]
ds_read_b128 a[224:227],v1 offset:6272
v_fma_f32 v48,v48,s36,v18
v_mfma_f32_16x16x32_bf16 a[12:15],a[252:255],v[120:123],a[12:15]
ds_read_b128 a[228:231],v2 offset:6272
v_fma_f32 v49,v49,s36,v18
v_mfma_f32_16x16x32_bf16 a[60:63],a[252:255],v[124:127],a[60:63]
s_waitcnt lgkmcnt(7)
ds_read_b64_tr_b16 a[252:253],v6 offset:12416
ds_read_b64_tr_b16 a[254:255],v6 offset:18560
v_mfma_f32_16x16x32_bf16 v[176:179],a[240:243],v[112:115],v[176:179]
ds_read_b128 a[232:235],v1 offset:6400
v_fma_f32 v50,v50,s36,v18
v_mfma_f32_16x16x32_bf16 v[224:227],a[240:243],v[116:119],v[224:227]
buffer_load_dwordx4 v9,s[8:11],s21 offen offset:2048 lds
v_mfma_f32_16x16x32_bf16 a[16:19],a[240:243],v[120:123],a[16:19]
s_add_u32 s21,s21,12288
ds_read_b128 a[236:239],v2 offset:6400
v_fma_f32 v51,v51,s36,v18
v_mfma_f32_16x16x32_bf16 a[64:67],a[240:243],v[124:127],a[64:67]
s_add_u32 m0,s22,24576
ds_read_b64_tr_b16 a[240:241],v3 offset:12544
ds_read_b64_tr_b16 a[242:243],v3 offset:18688
v_mfma_f32_16x16x32_bf16 v[180:183],a[244:247],v[112:115],v[180:183]
v_fma_f32 v52,v52,s36,v18
v_fma_f32 v53,v53,s36,v18
v_mfma_f32_16x16x32_bf16 v[228:231],a[244:247],v[116:119],v[228:231]
v_fma_f32 v54,v54,s36,v18
v_fma_f32 v55,v55,s36,v18
v_mfma_f32_16x16x32_bf16 a[20:23],a[244:247],v[120:123],a[20:23]
v_fma_f32 v56,v56,s36,v19
v_fma_f32 v57,v57,s36,v19
v_mfma_f32_16x16x32_bf16 a[68:71],a[244:247],v[124:127],a[68:71]
s_waitcnt lgkmcnt(4)
ds_read_b64_tr_b16 a[244:245],v4 offset:12544
ds_read_b64_tr_b16 a[246:247],v4 offset:18688
v_mfma_f32_16x16x32_bf16 v[184:187],a[248:251],v[112:115],v[184:187]
buffer_load_dwordx4 v7,s[4:7],s20 offen offset:0 lds
v_mfma_f32_16x16x32_bf16 v[232:235],a[248:251],v[116:119],v[232:235]
v_fma_f32 v58,v58,s36,v19
v_fma_f32 v59,v59,s36,v19
v_mfma_f32_16x16x32_bf16 a[24:27],a[248:251],v[120:123],a[24:27]
v_fma_f32 v60,v60,s36,v19
v_fma_f32 v61,v61,s36,v19
v_mfma_f32_16x16x32_bf16 a[72:75],a[248:251],v[124:127],a[72:75]
ds_read_b64_tr_b16 a[248:249],v5 offset:12544
ds_read_b64_tr_b16 a[250:251],v5 offset:18688
v_mfma_f32_16x16x32_bf16 v[188:191],a[252:255],v[112:115],v[188:191]
v_fma_f32 v62,v62,s36,v19
v_fma_f32 v63,v63,s36,v19
v_mfma_f32_16x16x32_bf16 v[236:239],a[252:255],v[116:119],v[236:239]
v_exp_f32 v36,v36
v_mfma_f32_16x16x32_bf16 a[28:31],a[252:255],v[120:123],a[28:31]
v_exp_f32 v37,v37
v_mfma_f32_16x16x32_bf16 a[76:79],a[252:255],v[124:127],a[76:79]
s_waitcnt lgkmcnt(2)
ds_read_b64_tr_b16 a[252:253],v6 offset:12544
ds_read_b64_tr_b16 a[254:255],v6 offset:18688
v_mfma_f32_16x16x32_bf16 v[192:195],a[240:243],v[112:115],v[192:195]
buffer_load_dwordx4 v8,s[4:7],s20 offen offset:1024 lds
v_mfma_f32_16x16x32_bf16 v[240:243],a[240:243],v[116:119],v[240:243]
v_exp_f32 v38,v38
v_mfma_f32_16x16x32_bf16 a[32:35],a[240:243],v[120:123],a[32:35]
v_exp_f32 v39,v39
v_mfma_f32_16x16x32_bf16 a[80:83],a[240:243],v[124:127],a[80:83]
v_exp_f32 v44,v44
v_mfma_f32_16x16x32_bf16 v[196:199],a[244:247],v[112:115],v[196:199]
v_exp_f32 v45,v45
v_mfma_f32_16x16x32_bf16 v[244:247],a[244:247],v[116:119],v[244:247]
v_exp_f32 v46,v46
v_mfma_f32_16x16x32_bf16 a[36:39],a[244:247],v[120:123],a[36:39]
v_exp_f32 v47,v47
v_mfma_f32_16x16x32_bf16 a[84:87],a[244:247],v[124:127],a[84:87]
s_waitcnt lgkmcnt(0)
v_exp_f32 v48,v48
v_mfma_f32_16x16x32_bf16 v[200:203],a[248:251],v[112:115],v[200:203]
buffer_load_dwordx4 v9,s[4:7],s20 offen offset:2048 lds
v_mfma_f32_16x16x32_bf16 v[248:251],a[248:251],v[116:119],v[248:251]
s_add_u32 s20,s20,12288
v_exp_f32 v49,v49
v_mfma_f32_16x16x32_bf16 a[40:43],a[248:251],v[120:123],a[40:43]
v_exp_f32 v50,v50
v_mfma_f32_16x16x32_bf16 a[88:91],a[248:251],v[124:127],a[88:91]
v_exp_f32 v51,v51
v_mfma_f32_16x16x32_bf16 v[204:207],a[252:255],v[112:115],v[204:207]
v_exp_f32 v52,v52
v_mfma_f32_16x16x32_bf16 v[252:255],a[252:255],v[116:119],v[252:255]
v_exp_f32 v53,v53
v_mfma_f32_16x16x32_bf16 a[44:47],a[252:255],v[120:123],a[44:47]
v_exp_f32 v54,v54
v_mfma_f32_16x16x32_bf16 a[92:95],a[252:255],v[124:127],a[92:95]
v_exp_f32 v55,v55
v_mfma_f32_16x16x32_bf16 v[64:67],a[192:195],a[96:99],0
v_exp_f32 v56,v56
v_mfma_f32_16x16x32_bf16 v[64:67],a[196:199],a[100:103],v[64:67]
v_exp_f32 v57,v57
v_mfma_f32_16x16x32_bf16 v[64:67],a[200:203],a[104:107],v[64:67]
v_exp_f32 v58,v58
v_mfma_f32_16x16x32_bf16 v[64:67],a[204:207],a[108:111],v[64:67]
v_exp_f32 v59,v59
v_mfma_f32_16x16x32_bf16 v[64:67],a[208:211],a[112:115],v[64:67]
v_exp_f32 v60,v60
v_mfma_f32_16x16x32_bf16 v[64:67],a[212:215],a[116:119],v[64:67]
v_exp_f32 v61,v61
v_mfma_f32_16x16x32_bf16 v[72:75],a[192:195],a[120:123],0
v_exp_f32 v62,v62
v_mfma_f32_16x16x32_bf16 v[72:75],a[196:199],a[124:127],v[72:75]
v_exp_f32 v63,v63
v_mfma_f32_16x16x32_bf16 v[72:75],a[200:203],a[128:131],v[72:75]
v_cvt_pk_bf16_f32 v98,v36,v37
v_cvt_pk_bf16_f32 v99,v38,v39
v_mfma_f32_16x16x32_bf16 v[72:75],a[204:207],a[132:135],v[72:75]
v_cvt_pk_bf16_f32 v102,v44,v45
v_cvt_pk_bf16_f32 v103,v46,v47
v_mfma_f32_16x16x32_bf16 v[128:131],v[24:27],v[96:99],v[128:131]
v_cvt_pk_bf16_f32 v104,v48,v49
v_cvt_pk_bf16_f32 v105,v50,v51
v_mfma_f32_16x16x32_bf16 v[132:135],v[24:27],v[100:103],v[132:135]
v_cvt_pk_bf16_f32 v106,v52,v53
v_cvt_pk_bf16_f32 v107,v54,v55
v_mfma_f32_16x16x32_bf16 v[72:75],a[208:211],a[136:139],v[72:75]
v_cvt_pk_bf16_f32 v108,v56,v57
v_cvt_pk_bf16_f32 v109,v58,v59
v_mfma_f32_16x16x32_bf16 v[136:139],v[24:27],v[104:107],v[136:139]
v_cvt_pk_bf16_f32 v110,v60,v61
v_cvt_pk_bf16_f32 v111,v62,v63
v_mfma_f32_16x16x32_bf16 v[72:75],a[212:215],a[140:143],v[72:75]
v_fma_f32 v64,v64,s36,v16
v_fma_f32 v65,v65,s36,v16
v_mfma_f32_16x16x32_bf16 v[140:143],v[24:27],v[108:111],v[140:143]
v_fma_f32 v66,v66,s36,v16
v_fma_f32 v67,v67,s36,v16
v_mfma_f32_16x16x32_bf16 v[80:83],a[192:195],a[144:147],0
v_exp_f32 v64,v64
v_mfma_f32_16x16x32_bf16 v[80:83],a[196:199],a[148:151],v[80:83]
v_fma_f32 v72,v72,s36,v17
v_fma_f32 v73,v73,s36,v17
v_mfma_f32_16x16x32_bf16 v[80:83],a[200:203],a[152:155],v[80:83]
v_fma_f32 v74,v74,s36,v17
v_fma_f32 v75,v75,s36,v17
v_mfma_f32_16x16x32_bf16 v[80:83],a[204:207],a[156:159],v[80:83]
v_exp_f32 v65,v65
v_mfma_f32_16x16x32_bf16 v[80:83],a[208:211],a[160:163],v[80:83]
v_exp_f32 v66,v66
v_mfma_f32_16x16x32_bf16 v[80:83],a[212:215],a[164:167],v[80:83]
v_exp_f32 v67,v67
v_mfma_f32_16x16x32_bf16 v[88:91],a[192:195],a[168:171],0
v_exp_f32 v72,v72
v_mfma_f32_16x16x32_bf16 v[88:91],a[196:199],a[172:175],v[88:91]
v_exp_f32 v73,v73
v_mfma_f32_16x16x32_bf16 v[88:91],a[200:203],a[176:179],v[88:91]
v_exp_f32 v74,v74
v_mfma_f32_16x16x32_bf16 v[88:91],a[204:207],a[180:183],v[88:91]
v_exp_f32 v75,v75
v_mfma_f32_16x16x32_bf16 v[88:91],a[208:211],a[184:187],v[88:91]
v_cvt_pk_bf16_f32 v112,v64,v65
v_cvt_pk_bf16_f32 v113,v66,v67
v_mfma_f32_16x16x32_bf16 v[88:91],a[212:215],a[188:191],v[88:91]
v_cvt_pk_bf16_f32 v116,v72,v73
v_cvt_pk_bf16_f32 v117,v74,v75
v_mfma_f32_16x16x32_bf16 v[68:71],a[216:219],a[96:99],0
v_mfma_f32_16x16x32_bf16 v[68:71],a[220:223],a[100:103],v[68:71]
v_mfma_f32_16x16x32_bf16 v[68:71],a[224:227],a[104:107],v[68:71]
v_mfma_f32_16x16x32_bf16 v[68:71],a[228:231],a[108:111],v[68:71]
v_mfma_f32_16x16x32_bf16 v[68:71],a[232:235],a[112:115],v[68:71]
v_mfma_f32_16x16x32_bf16 v[68:71],a[236:239],a[116:119],v[68:71]
v_mfma_f32_16x16x32_bf16 v[76:79],a[216:219],a[120:123],0
v_mfma_f32_16x16x32_bf16 v[76:79],a[220:223],a[124:127],v[76:79]
v_mfma_f32_16x16x32_bf16 v[76:79],a[224:227],a[128:131],v[76:79]
v_mfma_f32_16x16x32_bf16 v[76:79],a[228:231],a[132:135],v[76:79]
v_mfma_f32_16x16x32_bf16 v[76:79],a[232:235],a[136:139],v[76:79]
s_waitcnt vmcnt(6)
s_barrier
v_mfma_f32_16x16x32_bf16 v[76:79],a[236:239],a[140:143],v[76:79]
v_mfma_f32_16x16x32_bf16 v[84:87],a[216:219],a[144:147],0
ds_read_b64_tr_b16 a[240:241],v3 offset:24576
ds_read_b64_tr_b16 a[242:243],v3 offset:30720
v_mfma_f32_16x16x32_bf16 v[84:87],a[220:223],a[148:151],v[84:87]
v_mfma_f32_16x16x32_bf16 v[84:87],a[224:227],a[152:155],v[84:87]
ds_read_b64_tr_b16 a[244:245],v4 offset:24576
ds_read_b64_tr_b16 a[246:247],v4 offset:30720
v_mfma_f32_16x16x32_bf16 v[84:87],a[228:231],a[156:159],v[84:87]
v_mfma_f32_16x16x32_bf16 v[84:87],a[232:235],a[160:163],v[84:87]
ds_read_b64_tr_b16 a[248:249],v5 offset:24576
ds_read_b64_tr_b16 a[250:251],v5 offset:30720
v_mfma_f32_16x16x32_bf16 v[84:87],a[236:239],a[164:167],v[84:87]
v_mfma_f32_16x16x32_bf16 v[92:95],a[216:219],a[168:171],0
ds_read_b64_tr_b16 a[252:253],v6 offset:24576
ds_read_b64_tr_b16 a[254:255],v6 offset:30720
v_mfma_f32_16x16x32_bf16 v[92:95],a[220:223],a[172:175],v[92:95]
v_mfma_f32_16x16x32_bf16 v[92:95],a[224:227],a[176:179],v[92:95]
v_mfma_f32_16x16x32_bf16 v[92:95],a[228:231],a[180:183],v[92:95]
v_mfma_f32_16x16x32_bf16 v[92:95],a[232:235],a[184:187],v[92:95]
v_mfma_f32_16x16x32_bf16 v[92:95],a[236:239],a[188:191],v[92:95]
s_mov_b32 s38,0
s_branch L_loop4
L_start3:
s_add_u32 m0,s22,0
s_nop 0
buffer_load_dwordx4 v7,s[4:7],s20 offen offset:0 lds
buffer_load_dwordx4 v8,s[4:7],s20 offen offset:1024 lds
buffer_load_dwordx4 v9,s[4:7],s20 offen offset:2048 lds
s_add_u32 s20,s20,12288
s_mov_b32 s28,s41
s_add_u32 m0,s24,0
s_nop 0
buffer_load_dwordx4 v7,s[12:15],s28 offen offset:0 nt lds
buffer_load_dwordx4 v8,s[12:15],s28 offen offset:1024 nt lds
buffer_load_dwordx4 v9,s[12:15],s28 offen offset:2048 nt lds
s_add_u32 s28,s28,3072
s_add_u32 m0,s24,3072
s_nop 0
buffer_load_dwordx4 v7,s[12:15],s28 offen offset:0 nt lds
buffer_load_dwordx4 v8,s[12:15],s28 offen offset:1024 nt lds
buffer_load_dwordx4 v9,s[12:15],s28 offen offset:2048 nt lds
s_add_u32 s28,s28,3072
s_add_u32 m0,s24,6144
s_nop 0
buffer_load_dwordx4 v7,s[12:15],s28 offen offset:0 nt lds
buffer_load_dwordx4 v8,s[12:15],s28 offen offset:1024 nt lds
buffer_load_dwordx4 v9,s[12:15],s28 offen offset:2048 nt lds
s_add_u32 s28,s28,3072
s_add_u32 m0,s24,9216
s_nop 0
buffer_load_dwordx4 v7,s[12:15],s28 offen offset:0 nt lds
buffer_load_dwordx4 v8,s[12:15],s28 offen offset:1024 nt lds
buffer_load_dwordx4 v9,s[12:15],s28 offen offset:2048 nt lds
s_add_u32 s28,s28,3072
v_and_b32 v144,15,v0
v_lshrrev_b32 v145,4,v0
v_lshrrev_b32 v146,3,v144
v_mul_u32_u24 v1,384,v144
v_and_b32 v147,6,v144
v_xor_b32 v147,v147,v145
v_lshl_add_u32 v1,v147,4,v1
v_xor_b32 v2,64,v1
v_mul_u32_u24 v148,19456,v146
v_add_u32 v148,92160,v148
v_add_u32 v13,v148,v1
v_add_u32 v28,s24,v1
v_add_u32 v14,v148,v2
v_add_u32 v29,s24,v2
v_lshrrev_b32 v144,2,v0
v_mul_u32_u24 v3,384,v144
v_and_b32 v144,6,v144
v_bfe_u32 v147,v0,1,1
v_xor_b32 v144,v144,v147
v_lshl_add_u32 v3,v144,4,v3
v_and_b32 v147,1,v0
v_lshl_add_u32 v3,v147,3,v3
v_add_u32 v3,36864,v3
v_xor_b32 v4,32,v3
v_xor_b32 v5,64,v3
v_xor_b32 v6,96,v3
v_lshrrev_b32 v144,3,v0
v_and_b32 v145,7,v0
v_lshrrev_b32 v147,5,v0
v_xor_b32 v147,v147,v145
v_lshlrev_b32 v12,7,v145
v_lshl_add_u32 v12,v147,4,v12
v_bfe_u32 v146,v0,4,1
v_lshl_add_u32 v12,v146,3,v12
v_bfe_u32 v146,v0,3,1
v_mul_u32_u24 v146,3072,v146
v_add3_u32 v12,v12,v146,s24
v_xor_b32 v20,32,v12
v_xor_b32 v21,64,v12
v_xor_b32 v22,96,v12
v_xor_b32 v146,v145,v144
v_lshlrev_b32 v15,7,v144
v_lshl_add_u32 v15,v146,4,v15
v_add_u32 v15,s24,v15
v_add_u32 v146,0,v144
v_mul_u32_u24 v147,43,v146
v_lshrrev_b32 v147,7,v147
v_mul_u32_u24 v148,3,v147
v_sub_u32 v146,v146,v148
v_lshlrev_b32 v146,10,v146
v_lshl_add_u32 v146,v147,7,v146
v_xor_b32 v147,v147,v145
v_lshl_add_u32 v146,v147,4,v146
v_add_u32 v11,s24,v146
v_add_u32 v146,8,v144
v_mul_u32_u24 v147,43,v146
v_lshrrev_b32 v147,7,v147
v_mul_u32_u24 v148,3,v147
v_sub_u32 v146,v146,v148
v_lshlrev_b32 v146,10,v146
v_lshl_add_u32 v146,v147,7,v146
v_xor_b32 v147,v147,v145
v_lshl_add_u32 v146,v147,4,v146
v_add_u32 v23,s24,v146
v_add_u32 v146,16,v144
v_mul_u32_u24 v147,43,v146
v_lshrrev_b32 v147,7,v147
v_mul_u32_u24 v148,3,v147
v_sub_u32 v146,v146,v148
v_lshlrev_b32 v146,10,v146
v_lshl_add_u32 v146,v147,7,v146
v_xor_b32 v147,v147,v145
v_lshl_add_u32 v146,v147,4,v146
v_add_u32 v31,s24,v146
v_mul_u32_u24 v10,384,v144
v_lshl_add_u32 v10,v145,4,v10
v_mov_b32 v24,0x3f803f80
v_mov_b32 v25,0x3f803f80
v_mov_b32 v26,0x3f803f80
v_mov_b32 v27,0x3f803f80
v_lshlrev_b32 v0,4,v0
s_waitcnt vmcnt(12)
s_barrier
ds_read_b128 a[192:195],v1 offset:0
ds_read_b128 a[196:199],v2 offset:0
ds_read_b128 a[200:203],v1 offset:128
ds_read_b128 a[204:207],v2 offset:128
ds_read_b128 a[208:211],v1 offset:256
ds_read_b128 a[212:215],v2 offset:256
ds_read_b128 a[216:219],v1 offset:6144
ds_read_b128 a[220:223],v2 offset:6144
ds_read_b128 a[224:227],v1 offset:6272
ds_read_b128 a[228:231],v2 offset:6272
ds_read_b128 a[232:235],v1 offset:6400
ds_read_b128 a[236:239],v2 offset:6400
s_waitcnt vmcnt(6)
ds_read_b128 a[96:99],v28 offset:0
s_add_u32 m0,s24,12288
ds_read_b128 a[100:103],v29 offset:0
ds_read_b128 a[104:107],v28 offset:128
ds_read_b128 a[108:111],v29 offset:128
ds_read_b128 a[112:115],v28 offset:256
ds_read_b128 a[116:119],v29 offset:256
s_waitcnt lgkmcnt(5)
v_mfma_f32_16x16x32_bf16 v[32:35],a[192:195],a[96:99],0
buffer_load_dwordx4 v7,s[12:15],s28 offen offset:0 nt lds
s_waitcnt lgkmcnt(4)
v_mfma_f32_16x16x32_bf16 v[32:35],a[196:199],a[100:103],v[32:35]
buffer_load_dwordx4 v8,s[12:15],s28 offen offset:1024 nt lds
s_waitcnt lgkmcnt(3)
v_mfma_f32_16x16x32_bf16 v[32:35],a[200:203],a[104:107],v[32:35]
buffer_load_dwordx4 v9,s[12:15],s28 offen offset:2048 nt lds
s_add_u32 s28,s28,3072
s_add_u32 m0,s24,15360
s_waitcnt lgkmcnt(2)
v_mfma_f32_16x16x32_bf16 v[32:35],a[204:207],a[108:111],v[32:35]
buffer_load_dwordx4 v7,s[12:15],s28 offen offset:0 nt lds
s_waitcnt lgkmcnt(1)
v_mfma_f32_16x16x32_bf16 v[32:35],a[208:211],a[112:115],v[32:35]
buffer_load_dwordx4 v8,s[12:15],s28 offen offset:1024 nt lds
s_waitcnt lgkmcnt(0)
v_mfma_f32_16x16x32_bf16 v[32:35],a[212:215],a[116:119],v[32:35]
buffer_load_dwordx4 v9,s[12:15],s28 offen offset:2048 nt lds
s_add_u32 s28,s28,3072
s_add_u32 m0,s22,12288
v_mfma_f32_16x16x32_bf16 v[36:39],a[216:219],a[96:99],0
v_mfma_f32_16x16x32_bf16 v[36:39],a[220:223],a[100:103],v[36:39]
v_mfma_f32_16x16x32_bf16 v[36:39],a[224:227],a[104:107],v[36:39]
v_mfma_f32_16x16x32_bf16 v[36:39],a[228:231],a[108:111],v[36:39]
v_mfma_f32_16x16x32_bf16 v[36:39],a[232:235],a[112:115],v[36:39]
v_mfma_f32_16x16x32_bf16 v[36:39],a[236:239],a[116:119],v[36:39]
s_waitcnt vmcnt(6)
ds_read_b128 a[120:123],v28 offset:6144
ds_read_b128 a[124:127],v29 offset:6144
ds_read_b128 a[128:131],v28 offset:6272
ds_read_b128 a[132:135],v29 offset:6272
ds_read_b128 a[136:139],v28 offset:6400
ds_read_b128 a[140:143],v29 offset:6400
s_waitcnt lgkmcnt(5)
v_mfma_f32_16x16x32_bf16 v[40:43],a[192:195],a[120:123],0
buffer_load_dwordx4 v7,s[4:7],s20 offen offset:0 lds
s_waitcnt lgkmcnt(4)
v_mfma_f32_16x16x32_bf16 v[40:43],a[196:199],a[124:127],v[40:43]
buffer_load_dwordx4 v8,s[4:7],s20 offen offset:1024 lds
s_waitcnt lgkmcnt(3)
v_mfma_f32_16x16x32_bf16 v[40:43],a[200:203],a[128:131],v[40:43]
buffer_load_dwordx4 v9,s[4:7],s20 offen offset:2048 lds
s_add_u32 s20,s20,12288
s_add_u32 m0,s23,0
s_waitcnt lgkmcnt(2)
v_mfma_f32_16x16x32_bf16 v[40:43],a[204:207],a[132:135],v[40:43]
s_waitcnt lgkmcnt(1)
v_mfma_f32_16x16x32_bf16 v[40:43],a[208:211],a[136:139],v[40:43]
s_waitcnt lgkmcnt(0)
v_mfma_f32_16x16x32_bf16 v[40:43],a[212:215],a[140:143],v[40:43]
v_mfma_f32_16x16x32_bf16 v[44:47],a[216:219],a[120:123],0
v_mfma_f32_16x16x32_bf16 v[44:47],a[220:223],a[124:127],v[44:47]
v_mfma_f32_16x16x32_bf16 v[44:47],a[224:227],a[128:131],v[44:47]
v_mfma_f32_16x16x32_bf16 v[44:47],a[228:231],a[132:135],v[44:47]
v_mfma_f32_16x16x32_bf16 v[44:47],a[232:235],a[136:139],v[44:47]
v_mfma_f32_16x16x32_bf16 v[44:47],a[236:239],a[140:143],v[44:47]
s_waitcnt vmcnt(3)
ds_read_b128 a[144:147],v28 offset:12288
ds_read_b128 a[148:151],v29 offset:12288
ds_read_b128 a[152:155],v28 offset:12416
ds_read_b128 a[156:159],v29 offset:12416
ds_read_b128 a[160:163],v28 offset:12544
ds_read_b128 a[164:167],v29 offset:12544
s_waitcnt lgkmcnt(5)
v_mfma_f32_16x16x32_bf16 v[48:51],a[192:195],a[144:147],0
buffer_load_dwordx4 v7,s[8:11],s21 offen offset:0 lds
s_waitcnt lgkmcnt(4)
v_mfma_f32_16x16x32_bf16 v[48:51],a[196:199],a[148:151],v[48:51]
buffer_load_dwordx4 v8,s[8:11],s21 offen offset:1024 lds
s_waitcnt lgkmcnt(3)
v_mfma_f32_16x16x32_bf16 v[48:51],a[200:203],a[152:155],v[48:51]
buffer_load_dwordx4 v9,s[8:11],s21 offen offset:2048 lds
s_add_u32 s21,s21,12288
s_add_u32 m0,s22,24576
s_waitcnt lgkmcnt(2)
v_mfma_f32_16x16x32_bf16 v[48:51],a[204:207],a[156:159],v[48:51]
buffer_load_dwordx4 v7,s[4:7],s20 offen offset:0 lds
s_waitcnt lgkmcnt(1)
v_mfma_f32_16x16x32_bf16 v[48:51],a[208:211],a[160:163],v[48:51]
buffer_load_dwordx4 v8,s[4:7],s20 offen offset:1024 lds
s_waitcnt lgkmcnt(0)
v_mfma_f32_16x16x32_bf16 v[48:51],a[212:215],a[164:167],v[48:51]
buffer_load_dwordx4 v9,s[4:7],s20 offen offset:2048 lds
s_add_u32 s20,s20,12288
s_mov_b32 s27,166723584
v_mfma_f32_16x16x32_bf16 v[52:55],a[216:219],a[144:147],0
s_mov_b32 s42,s41
s_add_u32 s69,s69,1
s_add_u32 s48,s48,325632
v_mfma_f32_16x16x32_bf16 v[52:55],a[220:223],a[148:151],v[52:55]
s_lshr_b32 s62,s39,s69
s_and_b32 s62,s62,1
s_lshl_b32 s62,s62,1
v_mfma_f32_16x16x32_bf16 v[52:55],a[224:227],a[152:155],v[52:55]
s_add_u32 s62,s62,s49
s_and_b32 s62,s62,3
s_add_u32 s63,s69,8
v_mfma_f32_16x16x32_bf16 v[52:55],a[228:231],a[156:159],v[52:55]
s_lshr_b32 s63,s39,s63
s_and_b32 s63,s63,1
s_xor_b32 s62,s62,s63
v_mfma_f32_16x16x32_bf16 v[52:55],a[232:235],a[160:163],v[52:55]
s_mul_i32 s63,s3,3
s_lshl_b32 s64,s3,2
s_mov_b32 s40,1
v_mfma_f32_16x16x32_bf16 v[52:55],a[236:239],a[164:167],v[52:55]
s_waitcnt vmcnt(6)
s_barrier
s_add_u32 s65,s63,17
s_cmp_eq_u32 s3,0
s_cselect_b32 s65,16,s65
s_cselect_b32 s41,1,0
s_cmp_eq_u32 s62,1
s_cselect_b32 s64,s65,s64
s_cselect_b32 s40,s41,s40
s_add_u32 s65,s63,29
s_cmp_eq_u32 s62,2
s_cselect_b32 s64,s65,s64
s_cselect_b32 s40,0,s40
s_add_u32 s65,s63,41
s_cmp_eq_u32 s62,3
s_cselect_b32 s64,s65,s64
s_cselect_b32 s40,0,s40
s_mul_i32 s64,s64,6144
s_add_u32 s41,s48,s64
s_cmp_ge_u32 s69,8
s_cselect_b32 s41,166723584,s41
s_mov_b32 s28,s41
s_mov_b32 s29,s24
s_add_u32 s25,s22,12288
s_add_u32 s26,s22,24576
ds_read_b128 a[192:195],v1 offset:12288
v_max3_f32 v144,v32,v33,v34
v_max3_f32 v144,v144,v35,v36
v_max3_f32 v144,v144,v37,v38
v_max_f32 v144,v144,v39
v_mov_b32 v145,v144
v_max3_f32 v146,v40,v41,v42
v_max3_f32 v146,v146,v43,v44
v_permlane32_swap_b32 v145,v144
s_add_u32 m0,s23,12288
v_max_f32 v144,v144,v145
v_mov_b32 v145,v144
v_max3_f32 v146,v146,v45,v46
v_max_f32 v146,v146,v47
v_permlane16_swap_b32 v145,v144
v_max_f32 v144,v144,v145
v_mul_f32_e64 v16,-s36,v144
v_max3_f32 v144,v48,v49,v50
v_max3_f32 v144,v144,v51,v52
v_max3_f32 v144,v144,v53,v54
v_max_f32 v144,v144,v55
v_mov_b32 v147,v146
v_mov_b32 v145,v144
v_fma_f32 v32,v32,s36,v16
v_permlane32_swap_b32 v147,v146
v_permlane32_swap_b32 v145,v144
v_max_f32 v146,v146,v147
v_max_f32 v144,v144,v145
v_mov_b32 v147,v146
v_mov_b32 v145,v144
v_fma_f32 v33,v33,s36,v16
v_permlane16_swap_b32 v147,v146
s_waitcnt lgkmcnt(0)
v_mfma_f32_16x16x32_bf16 v[64:67],a[192:195],a[96:99],0
buffer_load_dwordx4 v7,s[8:11],s21 offen offset:0 lds
ds_read_b128 a[196:199],v2 offset:12288
v_permlane16_swap_b32 v145,v144
v_max_f32 v146,v146,v147
v_max_f32 v144,v144,v145
v_mul_f32_e64 v17,-s36,v146
v_mul_f32_e64 v18,-s36,v144
v_fma_f32 v34,v34,s36,v16
v_fma_f32 v35,v35,s36,v16
v_fma_f32 v36,v36,s36,v16
v_fma_f32 v37,v37,s36,v16
v_fma_f32 v38,v38,s36,v16
v_fma_f32 v39,v39,s36,v16
v_fma_f32 v40,v40,s36,v17
v_fma_f32 v41,v41,s36,v17
v_fma_f32 v42,v42,s36,v17
v_fma_f32 v43,v43,s36,v17
v_fma_f32 v44,v44,s36,v17
v_fma_f32 v45,v45,s36,v17
v_fma_f32 v46,v46,s36,v17
v_fma_f32 v47,v47,s36,v17
v_fma_f32 v48,v48,s36,v18
v_fma_f32 v49,v49,s36,v18
v_fma_f32 v50,v50,s36,v18
v_fma_f32 v51,v51,s36,v18
v_fma_f32 v52,v52,s36,v18
v_fma_f32 v53,v53,s36,v18
v_fma_f32 v54,v54,s36,v18
v_fma_f32 v55,v55,s36,v18
v_exp_f32 v32,v32
v_exp_f32 v33,v33
v_exp_f32 v34,v34
s_waitcnt lgkmcnt(0)
v_mfma_f32_16x16x32_bf16 v[64:67],a[196:199],a[100:103],v[64:67]
buffer_load_dwordx4 v8,s[8:11],s21 offen offset:1024 lds
buffer_load_dwordx4 v9,s[8:11],s21 offen offset:2048 lds
s_add_u32 s21,s21,12288
s_add_u32 m0,s22,0
ds_read_b128 a[200:203],v1 offset:12416
v_exp_f32 v35,v35
v_exp_f32 v36,v36
v_exp_f32 v37,v37
v_exp_f32 v38,v38
v_exp_f32 v39,v39
v_exp_f32 v40,v40
v_exp_f32 v41,v41
v_exp_f32 v42,v42
v_exp_f32 v43,v43
v_exp_f32 v44,v44
v_exp_f32 v45,v45
v_exp_f32 v46,v46
v_exp_f32 v47,v47
v_exp_f32 v48,v48
v_exp_f32 v49,v49
v_exp_f32 v50,v50
v_exp_f32 v51,v51
s_waitcnt lgkmcnt(0)
v_mfma_f32_16x16x32_bf16 v[64:67],a[200:203],a[104:107],v[64:67]
buffer_load_dwordx4 v7,s[4:7],s20 offen offset:0 lds
ds_read_b128 a[204:207],v2 offset:12416
v_exp_f32 v52,v52
v_exp_f32 v53,v53
v_exp_f32 v54,v54
v_exp_f32 v55,v55
v_cvt_pk_bf16_f32 v96,v32,v33
v_cvt_pk_bf16_f32 v97,v34,v35
v_cvt_pk_bf16_f32 v98,v36,v37
v_cvt_pk_bf16_f32 v99,v38,v39
v_cvt_pk_bf16_f32 v100,v40,v41
v_cvt_pk_bf16_f32 v101,v42,v43
v_mfma_f32_16x16x32_bf16 v[128:131],v[24:27],v[96:99],0
ds_read_b128 a[208:211],v1 offset:12544
v_cvt_pk_bf16_f32 v102,v44,v45
v_cvt_pk_bf16_f32 v103,v46,v47
v_cvt_pk_bf16_f32 v104,v48,v49
v_cvt_pk_bf16_f32 v105,v50,v51
v_mfma_f32_16x16x32_bf16 v[132:135],v[24:27],v[100:103],0
ds_read_b128 a[212:215],v2 offset:12544
v_cvt_pk_bf16_f32 v106,v52,v53
v_cvt_pk_bf16_f32 v107,v54,v55
ds_read_b128 a[216:219],v1 offset:18432
buffer_load_dwordx4 v8,s[4:7],s20 offen offset:1024 lds
v_mfma_f32_16x16x32_bf16 v[136:139],v[24:27],v[104:107],0
s_waitcnt lgkmcnt(3)
ds_read_b128 a[220:223],v2 offset:18432
v_mfma_f32_16x16x32_bf16 v[64:67],a[204:207],a[108:111],v[64:67]
ds_read_b128 a[224:227],v1 offset:18560
ds_read_b128 a[228:231],v2 offset:18560
ds_read_b128 a[232:235],v1 offset:18688
ds_read_b128 a[236:239],v2 offset:18688
s_waitcnt lgkmcnt(7)
v_mfma_f32_16x16x32_bf16 v[64:67],a[208:211],a[112:115],v[64:67]
s_waitcnt lgkmcnt(6)
v_mfma_f32_16x16x32_bf16 v[64:67],a[212:215],a[116:119],v[64:67]
v_mfma_f32_16x16x32_bf16 v[72:75],a[192:195],a[120:123],0
v_mfma_f32_16x16x32_bf16 v[72:75],a[196:199],a[124:127],v[72:75]
buffer_load_dwordx4 v9,s[4:7],s20 offen offset:2048 lds
s_add_u32 s20,s20,12288
v_mfma_f32_16x16x32_bf16 v[72:75],a[200:203],a[128:131],v[72:75]
v_mfma_f32_16x16x32_bf16 v[72:75],a[204:207],a[132:135],v[72:75]
v_mfma_f32_16x16x32_bf16 v[72:75],a[208:211],a[136:139],v[72:75]
v_mfma_f32_16x16x32_bf16 v[72:75],a[212:215],a[140:143],v[72:75]
v_fma_f32 v64,v64,s36,v16
v_fma_f32 v65,v65,s36,v16
v_mfma_f32_16x16x32_bf16 v[80:83],a[192:195],a[144:147],0
v_fma_f32 v66,v66,s36,v16
v_fma_f32 v67,v67,s36,v16
v_mfma_f32_16x16x32_bf16 v[80:83],a[196:199],a[148:151],v[80:83]
v_exp_f32 v64,v64
v_mfma_f32_16x16x32_bf16 v[80:83],a[200:203],a[152:155],v[80:83]
v_fma_f32 v72,v72,s36,v17
v_fma_f32 v73,v73,s36,v17
v_mfma_f32_16x16x32_bf16 v[80:83],a[204:207],a[156:159],v[80:83]
v_fma_f32 v74,v74,s36,v17
v_fma_f32 v75,v75,s36,v17
v_mfma_f32_16x16x32_bf16 v[80:83],a[208:211],a[160:163],v[80:83]
v_exp_f32 v65,v65
v_mfma_f32_16x16x32_bf16 v[80:83],a[212:215],a[164:167],v[80:83]
s_waitcnt lgkmcnt(0)
v_exp_f32 v66,v66
v_mfma_f32_16x16x32_bf16 v[68:71],a[216:219],a[96:99],0
v_exp_f32 v67,v67
v_mfma_f32_16x16x32_bf16 v[68:71],a[220:223],a[100:103],v[68:71]
s_waitcnt vmcnt(6)
s_barrier
v_exp_f32 v72,v72
v_mfma_f32_16x16x32_bf16 v[68:71],a[224:227],a[104:107],v[68:71]
v_exp_f32 v73,v73
v_mfma_f32_16x16x32_bf16 v[68:71],a[228:231],a[108:111],v[68:71]
ds_read_b64_tr_b16 a[240:241],v3 offset:0
ds_read_b64_tr_b16 a[242:243],v3 offset:6144
v_mfma_f32_16x16x32_bf16 v[68:71],a[232:235],a[112:115],v[68:71]
ds_read_b64_tr_b16 a[244:245],v4 offset:0
ds_read_b64_tr_b16 a[246:247],v4 offset:6144
v_mfma_f32_16x16x32_bf16 v[68:71],a[236:239],a[116:119],v[68:71]
v_exp_f32 v74,v74
v_mfma_f32_16x16x32_bf16 v[76:79],a[216:219],a[120:123],0
ds_read_b64_tr_b16 a[248:249],v5 offset:0
ds_read_b64_tr_b16 a[250:251],v5 offset:6144
v_mfma_f32_16x16x32_bf16 v[76:79],a[220:223],a[124:127],v[76:79]
ds_read_b64_tr_b16 a[252:253],v6 offset:0
ds_read_b64_tr_b16 a[254:255],v6 offset:6144
v_mfma_f32_16x16x32_bf16 v[76:79],a[224:227],a[128:131],v[76:79]
v_exp_f32 v75,v75
v_mfma_f32_16x16x32_bf16 v[76:79],a[228:231],a[132:135],v[76:79]
v_cvt_pk_bf16_f32 v112,v64,v65
v_cvt_pk_bf16_f32 v113,v66,v67
v_mfma_f32_16x16x32_bf16 v[76:79],a[232:235],a[136:139],v[76:79]
v_cvt_pk_bf16_f32 v116,v72,v73
v_cvt_pk_bf16_f32 v117,v74,v75
v_mfma_f32_16x16x32_bf16 v[76:79],a[236:239],a[140:143],v[76:79]
v_mfma_f32_16x16x32_bf16 v[84:87],a[216:219],a[144:147],0
v_mfma_f32_16x16x32_bf16 v[84:87],a[220:223],a[148:151],v[84:87]
v_mfma_f32_16x16x32_bf16 v[84:87],a[224:227],a[152:155],v[84:87]
v_mfma_f32_16x16x32_bf16 v[84:87],a[228:231],a[156:159],v[84:87]
v_mfma_f32_16x16x32_bf16 v[84:87],a[232:235],a[160:163],v[84:87]
v_mfma_f32_16x16x32_bf16 v[84:87],a[236:239],a[164:167],v[84:87]
s_waitcnt lgkmcnt(0)
v_mfma_f32_16x16x32_bf16 v[160:163],a[240:243],v[96:99],0
s_add_u32 m0,s23,24576
ds_read_b128 a[192:195],v1 offset:24576
v_fma_f32 v68,v68,s36,v16
v_mfma_f32_16x16x32_bf16 v[208:211],a[240:243],v[100:103],0
buffer_load_dwordx4 v7,s[8:11],s21 offen offset:0 lds
v_mfma_f32_16x16x32_bf16 a[0:3],a[240:243],v[104:107],0
ds_read_b64_tr_b16 a[240:241],v3 offset:128
ds_read_b64_tr_b16 a[242:243],v3 offset:6272
v_mfma_f32_16x16x32_bf16 v[164:167],a[244:247],v[96:99],0
ds_read_b128 a[196:199],v2 offset:24576
v_fma_f32 v69,v69,s36,v16
v_mfma_f32_16x16x32_bf16 v[212:215],a[244:247],v[100:103],0
ds_read_b128 a[200:203],v1 offset:24704
v_fma_f32 v70,v70,s36,v16
v_mfma_f32_16x16x32_bf16 a[4:7],a[244:247],v[104:107],0
ds_read_b64_tr_b16 a[244:245],v4 offset:128
ds_read_b64_tr_b16 a[246:247],v4 offset:6272
v_mfma_f32_16x16x32_bf16 v[168:171],a[248:251],v[96:99],0
ds_read_b128 a[204:207],v2 offset:24704
v_fma_f32 v71,v71,s36,v16
v_mfma_f32_16x16x32_bf16 v[216:219],a[248:251],v[100:103],0
buffer_load_dwordx4 v8,s[8:11],s21 offen offset:1024 lds
v_mfma_f32_16x16x32_bf16 a[8:11],a[248:251],v[104:107],0
ds_read_b64_tr_b16 a[248:249],v5 offset:128
ds_read_b64_tr_b16 a[250:251],v5 offset:6272
v_mfma_f32_16x16x32_bf16 v[172:175],a[252:255],v[96:99],0
ds_read_b128 a[208:211],v1 offset:24832
v_fma_f32 v76,v76,s36,v17
v_mfma_f32_16x16x32_bf16 v[220:223],a[252:255],v[100:103],0
ds_read_b128 a[212:215],v2 offset:24832
v_fma_f32 v77,v77,s36,v17
v_mfma_f32_16x16x32_bf16 a[12:15],a[252:255],v[104:107],0
s_waitcnt lgkmcnt(8)
ds_read_b64_tr_b16 a[252:253],v6 offset:128
ds_read_b64_tr_b16 a[254:255],v6 offset:6272
v_mfma_f32_16x16x32_bf16 v[176:179],a[240:243],v[96:99],0
buffer_load_dwordx4 v9,s[8:11],s21 offen offset:2048 lds
v_mfma_f32_16x16x32_bf16 v[224:227],a[240:243],v[100:103],0
s_add_u32 s21,s21,12288
ds_read_b128 a[216:219],v1 offset:30720
v_fma_f32 v78,v78,s36,v17
v_mfma_f32_16x16x32_bf16 a[16:19],a[240:243],v[104:107],0
s_add_u32 m0,s22,12288
ds_read_b64_tr_b16 a[240:241],v3 offset:256
ds_read_b64_tr_b16 a[242:243],v3 offset:6400
s_waitcnt lgkmcnt(9)
v_mfma_f32_16x16x32_bf16 v[180:183],a[244:247],v[96:99],0
ds_read_b128 a[220:223],v2 offset:30720
v_fma_f32 v79,v79,s36,v17
v_mfma_f32_16x16x32_bf16 v[228:231],a[244:247],v[100:103],0
ds_read_b128 a[224:227],v1 offset:30848
v_fma_f32 v80,v80,s36,v18
v_mfma_f32_16x16x32_bf16 a[20:23],a[244:247],v[104:107],0
s_waitcnt lgkmcnt(8)
ds_read_b64_tr_b16 a[244:245],v4 offset:256
ds_read_b64_tr_b16 a[246:247],v4 offset:6400
v_mfma_f32_16x16x32_bf16 v[184:187],a[248:251],v[96:99],0
buffer_load_dwordx4 v7,s[4:7],s20 offen offset:0 lds
v_mfma_f32_16x16x32_bf16 v[232:235],a[248:251],v[100:103],0
ds_read_b128 a[228:231],v2 offset:30848
v_fma_f32 v81,v81,s36,v18
v_mfma_f32_16x16x32_bf16 a[24:27],a[248:251],v[104:107],0
s_waitcnt lgkmcnt(8)
ds_read_b64_tr_b16 a[248:249],v5 offset:256
ds_read_b64_tr_b16 a[250:251],v5 offset:6400
v_mfma_f32_16x16x32_bf16 v[188:191],a[252:255],v[96:99],0
ds_read_b128 a[232:235],v1 offset:30976
v_fma_f32 v82,v82,s36,v18
v_mfma_f32_16x16x32_bf16 v[236:239],a[252:255],v[100:103],0
ds_read_b128 a[236:239],v2 offset:30976
v_fma_f32 v83,v83,s36,v18
v_mfma_f32_16x16x32_bf16 a[28:31],a[252:255],v[104:107],0
s_waitcnt lgkmcnt(8)
ds_read_b64_tr_b16 a[252:253],v6 offset:256
ds_read_b64_tr_b16 a[254:255],v6 offset:6400
v_mfma_f32_16x16x32_bf16 v[192:195],a[240:243],v[96:99],0
buffer_load_dwordx4 v8,s[4:7],s20 offen offset:1024 lds
v_mfma_f32_16x16x32_bf16 v[240:243],a[240:243],v[100:103],0
v_fma_f32 v84,v84,s36,v18
v_fma_f32 v85,v85,s36,v18
v_mfma_f32_16x16x32_bf16 a[32:35],a[240:243],v[104:107],0
s_waitcnt lgkmcnt(7)
v_fma_f32 v86,v86,s36,v18
v_fma_f32 v87,v87,s36,v18
v_mfma_f32_16x16x32_bf16 v[196:199],a[244:247],v[96:99],0
v_exp_f32 v68,v68
v_mfma_f32_16x16x32_bf16 v[244:247],a[244:247],v[100:103],0
v_exp_f32 v69,v69
v_mfma_f32_16x16x32_bf16 a[36:39],a[244:247],v[104:107],0
s_waitcnt lgkmcnt(3)
v_exp_f32 v70,v70
v_mfma_f32_16x16x32_bf16 v[200:203],a[248:251],v[96:99],0
buffer_load_dwordx4 v9,s[4:7],s20 offen offset:2048 lds
v_mfma_f32_16x16x32_bf16 v[248:251],a[248:251],v[100:103],0
s_add_u32 s20,s20,12288
v_exp_f32 v71,v71
v_mfma_f32_16x16x32_bf16 a[40:43],a[248:251],v[104:107],0
s_waitcnt lgkmcnt(0)
v_exp_f32 v76,v76
v_mfma_f32_16x16x32_bf16 v[204:207],a[252:255],v[96:99],0
v_exp_f32 v77,v77
v_mfma_f32_16x16x32_bf16 v[252:255],a[252:255],v[100:103],0
v_exp_f32 v78,v78
v_mfma_f32_16x16x32_bf16 a[44:47],a[252:255],v[104:107],0
v_exp_f32 v79,v79
v_mfma_f32_16x16x32_bf16 v[32:35],a[192:195],a[96:99],0
v_exp_f32 v80,v80
v_mfma_f32_16x16x32_bf16 v[32:35],a[196:199],a[100:103],v[32:35]
v_exp_f32 v81,v81
v_mfma_f32_16x16x32_bf16 v[32:35],a[200:203],a[104:107],v[32:35]
v_exp_f32 v82,v82
v_mfma_f32_16x16x32_bf16 v[32:35],a[204:207],a[108:111],v[32:35]
v_exp_f32 v83,v83
v_mfma_f32_16x16x32_bf16 v[32:35],a[208:211],a[112:115],v[32:35]
v_exp_f32 v84,v84
v_mfma_f32_16x16x32_bf16 v[32:35],a[212:215],a[116:119],v[32:35]
v_exp_f32 v85,v85
v_mfma_f32_16x16x32_bf16 v[40:43],a[192:195],a[120:123],0
v_exp_f32 v86,v86
v_mfma_f32_16x16x32_bf16 v[40:43],a[196:199],a[124:127],v[40:43]
v_exp_f32 v87,v87
v_mfma_f32_16x16x32_bf16 v[40:43],a[200:203],a[128:131],v[40:43]
v_cvt_pk_bf16_f32 v114,v68,v69
v_cvt_pk_bf16_f32 v115,v70,v71
v_mfma_f32_16x16x32_bf16 v[40:43],a[204:207],a[132:135],v[40:43]
v_cvt_pk_bf16_f32 v118,v76,v77
v_cvt_pk_bf16_f32 v119,v78,v79
v_mfma_f32_16x16x32_bf16 v[128:131],v[24:27],v[112:115],v[128:131]
v_cvt_pk_bf16_f32 v120,v80,v81
v_cvt_pk_bf16_f32 v121,v82,v83
v_mfma_f32_16x16x32_bf16 v[132:135],v[24:27],v[116:119],v[132:135]
v_cvt_pk_bf16_f32 v122,v84,v85
v_cvt_pk_bf16_f32 v123,v86,v87
v_mfma_f32_16x16x32_bf16 v[40:43],a[208:211],a[136:139],v[40:43]
v_fma_f32 v32,v32,s36,v16
v_fma_f32 v33,v33,s36,v16
v_mfma_f32_16x16x32_bf16 v[136:139],v[24:27],v[120:123],v[136:139]
v_fma_f32 v34,v34,s36,v16
v_fma_f32 v35,v35,s36,v16
v_mfma_f32_16x16x32_bf16 v[40:43],a[212:215],a[140:143],v[40:43]
v_exp_f32 v32,v32
v_mfma_f32_16x16x32_bf16 v[48:51],a[192:195],a[144:147],0
v_exp_f32 v33,v33
v_mfma_f32_16x16x32_bf16 v[48:51],a[196:199],a[148:151],v[48:51]
v_exp_f32 v34,v34
v_mfma_f32_16x16x32_bf16 v[48:51],a[200:203],a[152:155],v[48:51]
v_exp_f32 v35,v35
v_mfma_f32_16x16x32_bf16 v[48:51],a[204:207],a[156:159],v[48:51]
v_fma_f32 v40,v40,s36,v17
v_fma_f32 v41,v41,s36,v17
v_mfma_f32_16x16x32_bf16 v[48:51],a[208:211],a[160:163],v[48:51]
v_fma_f32 v42,v42,s36,v17
v_fma_f32 v43,v43,s36,v17
v_mfma_f32_16x16x32_bf16 v[48:51],a[212:215],a[164:167],v[48:51]
v_exp_f32 v40,v40
v_mfma_f32_16x16x32_bf16 v[36:39],a[216:219],a[96:99],0
v_exp_f32 v41,v41
v_mfma_f32_16x16x32_bf16 v[36:39],a[220:223],a[100:103],v[36:39]
v_exp_f32 v42,v42
v_mfma_f32_16x16x32_bf16 v[36:39],a[224:227],a[104:107],v[36:39]
v_exp_f32 v43,v43
v_mfma_f32_16x16x32_bf16 v[36:39],a[228:231],a[108:111],v[36:39]
v_cvt_pk_bf16_f32 v96,v32,v33
v_cvt_pk_bf16_f32 v97,v34,v35
s_waitcnt vmcnt(6)
s_barrier
v_mfma_f32_16x16x32_bf16 v[36:39],a[232:235],a[112:115],v[36:39]
v_cvt_pk_bf16_f32 v100,v40,v41
v_cvt_pk_bf16_f32 v101,v42,v43
v_mfma_f32_16x16x32_bf16 v[36:39],a[236:239],a[116:119],v[36:39]
ds_read_b64_tr_b16 a[240:241],v3 offset:12288
ds_read_b64_tr_b16 a[242:243],v3 offset:18432
v_mfma_f32_16x16x32_bf16 v[44:47],a[216:219],a[120:123],0
v_mfma_f32_16x16x32_bf16 v[44:47],a[220:223],a[124:127],v[44:47]
ds_read_b64_tr_b16 a[244:245],v4 offset:12288
ds_read_b64_tr_b16 a[246:247],v4 offset:18432
v_mfma_f32_16x16x32_bf16 v[44:47],a[224:227],a[128:131],v[44:47]
ds_read_b64_tr_b16 a[248:249],v5 offset:12288
ds_read_b64_tr_b16 a[250:251],v5 offset:18432
v_mfma_f32_16x16x32_bf16 v[44:47],a[228:231],a[132:135],v[44:47]
v_mfma_f32_16x16x32_bf16 v[44:47],a[232:235],a[136:139],v[44:47]
ds_read_b64_tr_b16 a[252:253],v6 offset:12288
ds_read_b64_tr_b16 a[254:255],v6 offset:18432
v_mfma_f32_16x16x32_bf16 v[44:47],a[236:239],a[140:143],v[44:47]
v_mfma_f32_16x16x32_bf16 v[52:55],a[216:219],a[144:147],0
v_mfma_f32_16x16x32_bf16 v[52:55],a[220:223],a[148:151],v[52:55]
v_mfma_f32_16x16x32_bf16 v[52:55],a[224:227],a[152:155],v[52:55]
v_mfma_f32_16x16x32_bf16 v[52:55],a[228:231],a[156:159],v[52:55]
v_mfma_f32_16x16x32_bf16 v[52:55],a[232:235],a[160:163],v[52:55]
v_mfma_f32_16x16x32_bf16 v[52:55],a[236:239],a[164:167],v[52:55]
s_waitcnt lgkmcnt(2)
v_mfma_f32_16x16x32_bf16 v[160:163],a[240:243],v[112:115],v[160:163]
s_add_u32 m0,s23,0
ds_read_b128 a[192:195],v1 offset:0
v_fma_f32 v36,v36,s36,v16
v_mfma_f32_16x16x32_bf16 v[208:211],a[240:243],v[116:119],v[208:211]
buffer_load_dwordx4 v7,s[8:11],s21 offen offset:0 lds
v_mfma_f32_16x16x32_bf16 a[0:3],a[240:243],v[120:123],a[0:3]
ds_read_b64_tr_b16 a[240:241],v3 offset:12416
ds_read_b64_tr_b16 a[242:243],v3 offset:18560
v_mfma_f32_16x16x32_bf16 v[164:167],a[244:247],v[112:115],v[164:167]
ds_read_b128 a[196:199],v2 offset:0
v_fma_f32 v37,v37,s36,v16
v_mfma_f32_16x16x32_bf16 v[212:215],a[244:247],v[116:119],v[212:215]
ds_read_b128 a[200:203],v1 offset:128
v_fma_f32 v38,v38,s36,v16
v_mfma_f32_16x16x32_bf16 a[4:7],a[244:247],v[120:123],a[4:7]
ds_read_b64_tr_b16 a[244:245],v4 offset:12416
ds_read_b64_tr_b16 a[246:247],v4 offset:18560
v_mfma_f32_16x16x32_bf16 v[168:171],a[248:251],v[112:115],v[168:171]
ds_read_b128 a[204:207],v2 offset:128
v_fma_f32 v39,v39,s36,v16
v_mfma_f32_16x16x32_bf16 v[216:219],a[248:251],v[116:119],v[216:219]
buffer_load_dwordx4 v8,s[8:11],s21 offen offset:1024 lds
v_mfma_f32_16x16x32_bf16 a[8:11],a[248:251],v[120:123],a[8:11]
s_waitcnt lgkmcnt(7)
ds_read_b64_tr_b16 a[248:249],v5 offset:12416
ds_read_b64_tr_b16 a[250:251],v5 offset:18560
v_mfma_f32_16x16x32_bf16 v[172:175],a[252:255],v[112:115],v[172:175]
ds_read_b128 a[208:211],v1 offset:256
v_fma_f32 v44,v44,s36,v17
v_mfma_f32_16x16x32_bf16 v[220:223],a[252:255],v[116:119],v[220:223]
ds_read_b128 a[212:215],v2 offset:256
v_fma_f32 v45,v45,s36,v17
v_mfma_f32_16x16x32_bf16 a[12:15],a[252:255],v[120:123],a[12:15]
s_waitcnt lgkmcnt(8)
ds_read_b64_tr_b16 a[252:253],v6 offset:12416
ds_read_b64_tr_b16 a[254:255],v6 offset:18560
v_mfma_f32_16x16x32_bf16 v[176:179],a[240:243],v[112:115],v[176:179]
buffer_load_dwordx4 v9,s[8:11],s21 offen offset:2048 lds
v_mfma_f32_16x16x32_bf16 v[224:227],a[240:243],v[116:119],v[224:227]
s_add_u32 s21,s21,12288
ds_read_b128 a[216:219],v1 offset:6144
v_fma_f32 v46,v46,s36,v17
v_mfma_f32_16x16x32_bf16 a[16:19],a[240:243],v[120:123],a[16:19]
s_add_u32 m0,s22,24576
ds_read_b64_tr_b16 a[240:241],v3 offset:12544
ds_read_b64_tr_b16 a[242:243],v3 offset:18688
s_waitcnt lgkmcnt(9)
v_mfma_f32_16x16x32_bf16 v[180:183],a[244:247],v[112:115],v[180:183]
ds_read_b128 a[220:223],v2 offset:6144
v_fma_f32 v47,v47,s36,v17
v_mfma_f32_16x16x32_bf16 v[228:231],a[244:247],v[116:119],v[228:231]
ds_read_b128 a[224:227],v1 offset:6272
v_fma_f32 v48,v48,s36,v18
v_mfma_f32_16x16x32_bf16 a[20:23],a[244:247],v[120:123],a[20:23]
s_waitcnt lgkmcnt(8)
ds_read_b64_tr_b16 a[244:245],v4 offset:12544
ds_read_b64_tr_b16 a[246:247],v4 offset:18688
v_mfma_f32_16x16x32_bf16 v[184:187],a[248:251],v[112:115],v[184:187]
buffer_load_dwordx4 v7,s[4:7],s20 offen offset:0 lds
v_mfma_f32_16x16x32_bf16 v[232:235],a[248:251],v[116:119],v[232:235]
ds_read_b128 a[228:231],v2 offset:6272
v_fma_f32 v49,v49,s36,v18
v_mfma_f32_16x16x32_bf16 a[24:27],a[248:251],v[120:123],a[24:27]
s_waitcnt lgkmcnt(8)
ds_read_b64_tr_b16 a[248:249],v5 offset:12544
ds_read_b64_tr_b16 a[250:251],v5 offset:18688
v_mfma_f32_16x16x32_bf16 v[188:191],a[252:255],v[112:115],v[188:191]
ds_read_b128 a[232:235],v1 offset:6400
v_fma_f32 v50,v50,s36,v18
v_mfma_f32_16x16x32_bf16 v[236:239],a[252:255],v[116:119],v[236:239]
ds_read_b128 a[236:239],v2 offset:6400
v_fma_f32 v51,v51,s36,v18
v_mfma_f32_16x16x32_bf16 a[28:31],a[252:255],v[120:123],a[28:31]
s_waitcnt lgkmcnt(8)
ds_read_b64_tr_b16 a[252:253],v6 offset:12544
ds_read_b64_tr_b16 a[254:255],v6 offset:18688
v_mfma_f32_16x16x32_bf16 v[192:195],a[240:243],v[112:115],v[192:195]
buffer_load_dwordx4 v8,s[4:7],s20 offen offset:1024 lds
v_mfma_f32_16x16x32_bf16 v[240:243],a[240:243],v[116:119],v[240:243]
v_fma_f32 v52,v52,s36,v18
v_fma_f32 v53,v53,s36,v18
v_mfma_f32_16x16x32_bf16 a[32:35],a[240:243],v[120:123],a[32:35]
s_waitcnt lgkmcnt(7)
v_fma_f32 v54,v54,s36,v18
v_fma_f32 v55,v55,s36,v18
v_mfma_f32_16x16x32_bf16 v[196:199],a[244:247],v[112:115],v[196:199]
v_exp_f32 v36,v36
v_mfma_f32_16x16x32_bf16 v[244:247],a[244:247],v[116:119],v[244:247]
v_exp_f32 v37,v37
v_mfma_f32_16x16x32_bf16 a[36:39],a[244:247],v[120:123],a[36:39]
s_waitcnt lgkmcnt(3)
v_exp_f32 v38,v38
v_mfma_f32_16x16x32_bf16 v[200:203],a[248:251],v[112:115],v[200:203]
buffer_load_dwordx4 v9,s[4:7],s20 offen offset:2048 lds
v_mfma_f32_16x16x32_bf16 v[248:251],a[248:251],v[116:119],v[248:251]
s_add_u32 s20,s20,12288
v_exp_f32 v39,v39
v_mfma_f32_16x16x32_bf16 a[40:43],a[248:251],v[120:123],a[40:43]
s_waitcnt lgkmcnt(0)
v_exp_f32 v44,v44
v_mfma_f32_16x16x32_bf16 v[204:207],a[252:255],v[112:115],v[204:207]
v_exp_f32 v45,v45
v_mfma_f32_16x16x32_bf16 v[252:255],a[252:255],v[116:119],v[252:255]
v_exp_f32 v46,v46
v_mfma_f32_16x16x32_bf16 a[44:47],a[252:255],v[120:123],a[44:47]
v_exp_f32 v47,v47
v_mfma_f32_16x16x32_bf16 v[64:67],a[192:195],a[96:99],0
v_exp_f32 v48,v48
v_mfma_f32_16x16x32_bf16 v[64:67],a[196:199],a[100:103],v[64:67]
v_exp_f32 v49,v49
v_mfma_f32_16x16x32_bf16 v[64:67],a[200:203],a[104:107],v[64:67]
v_exp_f32 v50,v50
v_mfma_f32_16x16x32_bf16 v[64:67],a[204:207],a[108:111],v[64:67]
v_exp_f32 v51,v51
v_mfma_f32_16x16x32_bf16 v[64:67],a[208:211],a[112:115],v[64:67]
v_exp_f32 v52,v52
v_mfma_f32_16x16x32_bf16 v[64:67],a[212:215],a[116:119],v[64:67]
v_exp_f32 v53,v53
v_mfma_f32_16x16x32_bf16 v[72:75],a[192:195],a[120:123],0
v_exp_f32 v54,v54
v_mfma_f32_16x16x32_bf16 v[72:75],a[196:199],a[124:127],v[72:75]
v_exp_f32 v55,v55
v_mfma_f32_16x16x32_bf16 v[72:75],a[200:203],a[128:131],v[72:75]
v_cvt_pk_bf16_f32 v98,v36,v37
v_cvt_pk_bf16_f32 v99,v38,v39
v_mfma_f32_16x16x32_bf16 v[72:75],a[204:207],a[132:135],v[72:75]
v_cvt_pk_bf16_f32 v102,v44,v45
v_cvt_pk_bf16_f32 v103,v46,v47
v_mfma_f32_16x16x32_bf16 v[128:131],v[24:27],v[96:99],v[128:131]
v_cvt_pk_bf16_f32 v104,v48,v49
v_cvt_pk_bf16_f32 v105,v50,v51
v_mfma_f32_16x16x32_bf16 v[132:135],v[24:27],v[100:103],v[132:135]
v_cvt_pk_bf16_f32 v106,v52,v53
v_cvt_pk_bf16_f32 v107,v54,v55
v_mfma_f32_16x16x32_bf16 v[72:75],a[208:211],a[136:139],v[72:75]
v_fma_f32 v64,v64,s36,v16
v_fma_f32 v65,v65,s36,v16
v_mfma_f32_16x16x32_bf16 v[136:139],v[24:27],v[104:107],v[136:139]
v_fma_f32 v66,v66,s36,v16
v_fma_f32 v67,v67,s36,v16
v_mfma_f32_16x16x32_bf16 v[72:75],a[212:215],a[140:143],v[72:75]
v_exp_f32 v64,v64
v_mfma_f32_16x16x32_bf16 v[80:83],a[192:195],a[144:147],0
v_exp_f32 v65,v65
v_mfma_f32_16x16x32_bf16 v[80:83],a[196:199],a[148:151],v[80:83]
v_exp_f32 v66,v66
v_mfma_f32_16x16x32_bf16 v[80:83],a[200:203],a[152:155],v[80:83]
v_exp_f32 v67,v67
v_mfma_f32_16x16x32_bf16 v[80:83],a[204:207],a[156:159],v[80:83]
v_fma_f32 v72,v72,s36,v17
v_fma_f32 v73,v73,s36,v17
v_mfma_f32_16x16x32_bf16 v[80:83],a[208:211],a[160:163],v[80:83]
v_fma_f32 v74,v74,s36,v17
v_fma_f32 v75,v75,s36,v17
v_mfma_f32_16x16x32_bf16 v[80:83],a[212:215],a[164:167],v[80:83]
v_exp_f32 v72,v72
v_mfma_f32_16x16x32_bf16 v[68:71],a[216:219],a[96:99],0
v_exp_f32 v73,v73
v_mfma_f32_16x16x32_bf16 v[68:71],a[220:223],a[100:103],v[68:71]
v_exp_f32 v74,v74
v_mfma_f32_16x16x32_bf16 v[68:71],a[224:227],a[104:107],v[68:71]
v_exp_f32 v75,v75
v_mfma_f32_16x16x32_bf16 v[68:71],a[228:231],a[108:111],v[68:71]
v_cvt_pk_bf16_f32 v112,v64,v65
v_cvt_pk_bf16_f32 v113,v66,v67
s_waitcnt vmcnt(6)
s_barrier
v_mfma_f32_16x16x32_bf16 v[68:71],a[232:235],a[112:115],v[68:71]
v_cvt_pk_bf16_f32 v116,v72,v73
v_cvt_pk_bf16_f32 v117,v74,v75
v_mfma_f32_16x16x32_bf16 v[68:71],a[236:239],a[116:119],v[68:71]
ds_read_b64_tr_b16 a[240:241],v3 offset:24576
ds_read_b64_tr_b16 a[242:243],v3 offset:30720
v_mfma_f32_16x16x32_bf16 v[76:79],a[216:219],a[120:123],0
v_mfma_f32_16x16x32_bf16 v[76:79],a[220:223],a[124:127],v[76:79]
ds_read_b64_tr_b16 a[244:245],v4 offset:24576
ds_read_b64_tr_b16 a[246:247],v4 offset:30720
v_mfma_f32_16x16x32_bf16 v[76:79],a[224:227],a[128:131],v[76:79]
ds_read_b64_tr_b16 a[248:249],v5 offset:24576
ds_read_b64_tr_b16 a[250:251],v5 offset:30720
v_mfma_f32_16x16x32_bf16 v[76:79],a[228:231],a[132:135],v[76:79]
v_mfma_f32_16x16x32_bf16 v[76:79],a[232:235],a[136:139],v[76:79]
ds_read_b64_tr_b16 a[252:253],v6 offset:24576
ds_read_b64_tr_b16 a[254:255],v6 offset:30720
v_mfma_f32_16x16x32_bf16 v[76:79],a[236:239],a[140:143],v[76:79]
v_mfma_f32_16x16x32_bf16 v[84:87],a[216:219],a[144:147],0
v_mfma_f32_16x16x32_bf16 v[84:87],a[220:223],a[148:151],v[84:87]
v_mfma_f32_16x16x32_bf16 v[84:87],a[224:227],a[152:155],v[84:87]
v_mfma_f32_16x16x32_bf16 v[84:87],a[228:231],a[156:159],v[84:87]
v_mfma_f32_16x16x32_bf16 v[84:87],a[232:235],a[160:163],v[84:87]
v_mfma_f32_16x16x32_bf16 v[84:87],a[236:239],a[164:167],v[84:87]
s_mov_b32 s38,0
s_branch L_loop3
L_loop4:
s_bitcmp1_b32 s3,1
s_cbranch_scc1 L_loop4w1
.p2align 6
L_loop4w0:
s_waitcnt lgkmcnt(4)
v_mfma_f32_16x16x32_bf16 v[160:163],a[240:243],v[96:99],v[160:163]
s_add_u32 m0,s23,12288
ds_read_b128 a[192:195],v1 offset:12288
v_fma_f32 v68,v68,s36,v16
v_mfma_f32_16x16x32_bf16 v[208:211],a[240:243],v[100:103],v[208:211]
buffer_load_dwordx4 v7,s[8:11],s21 offen offset:0 lds
v_mfma_f32_16x16x32_bf16 a[0:3],a[240:243],v[104:107],a[0:3]
ds_read_b128 a[196:199],v2 offset:12288
v_fma_f32 v69,v69,s36,v16
v_mfma_f32_16x16x32_bf16 a[48:51],a[240:243],v[108:111],a[48:51]
ds_read_b64_tr_b16 a[240:241],v3 offset:24704
ds_read_b64_tr_b16 a[242:243],v3 offset:30848
v_mfma_f32_16x16x32_bf16 v[164:167],a[244:247],v[96:99],v[164:167]
ds_read_b128 a[200:203],v1 offset:12416
v_fma_f32 v70,v70,s36,v16
v_mfma_f32_16x16x32_bf16 v[212:215],a[244:247],v[100:103],v[212:215]
ds_read_b128 a[204:207],v2 offset:12416
v_fma_f32 v71,v71,s36,v16
v_mfma_f32_16x16x32_bf16 a[4:7],a[244:247],v[104:107],a[4:7]
ds_read_b128 a[208:211],v1 offset:12544
v_fma_f32 v76,v76,s36,v17
v_mfma_f32_16x16x32_bf16 a[52:55],a[244:247],v[108:111],a[52:55]
s_waitcnt lgkmcnt(7)
ds_read_b64_tr_b16 a[244:245],v4 offset:24704
ds_read_b64_tr_b16 a[246:247],v4 offset:30848
v_mfma_f32_16x16x32_bf16 v[168:171],a[248:251],v[96:99],v[168:171]
ds_read_b128 a[212:215],v2 offset:12544
v_fma_f32 v77,v77,s36,v17
v_mfma_f32_16x16x32_bf16 v[216:219],a[248:251],v[100:103],v[216:219]
buffer_load_dwordx4 v8,s[8:11],s21 offen offset:1024 lds
v_mfma_f32_16x16x32_bf16 a[8:11],a[248:251],v[104:107],a[8:11]
ds_read_b128 a[216:219],v1 offset:18432
v_fma_f32 v78,v78,s36,v17
v_mfma_f32_16x16x32_bf16 a[56:59],a[248:251],v[108:111],a[56:59]
ds_read_b64_tr_b16 a[248:249],v5 offset:24704
ds_read_b64_tr_b16 a[250:251],v5 offset:30848
v_mfma_f32_16x16x32_bf16 v[172:175],a[252:255],v[96:99],v[172:175]
ds_read_b128 a[220:223],v2 offset:18432
v_fma_f32 v79,v79,s36,v17
v_mfma_f32_16x16x32_bf16 v[220:223],a[252:255],v[100:103],v[220:223]
ds_read_b128 a[224:227],v1 offset:18560
v_fma_f32 v80,v80,s36,v18
v_mfma_f32_16x16x32_bf16 a[12:15],a[252:255],v[104:107],a[12:15]
ds_read_b128 a[228:231],v2 offset:18560
v_fma_f32 v81,v81,s36,v18
v_mfma_f32_16x16x32_bf16 a[60:63],a[252:255],v[108:111],a[60:63]
s_waitcnt lgkmcnt(7)
ds_read_b64_tr_b16 a[252:253],v6 offset:24704
ds_read_b64_tr_b16 a[254:255],v6 offset:30848
v_mfma_f32_16x16x32_bf16 v[176:179],a[240:243],v[96:99],v[176:179]
ds_read_b128 a[232:235],v1 offset:18688
v_fma_f32 v82,v82,s36,v18
v_mfma_f32_16x16x32_bf16 v[224:227],a[240:243],v[100:103],v[224:227]
buffer_load_dwordx4 v9,s[8:11],s21 offen offset:2048 lds
v_mfma_f32_16x16x32_bf16 a[16:19],a[240:243],v[104:107],a[16:19]
s_add_u32 s21,s21,12288
ds_read_b128 a[236:239],v2 offset:18688
v_fma_f32 v83,v83,s36,v18
v_mfma_f32_16x16x32_bf16 a[64:67],a[240:243],v[108:111],a[64:67]
s_add_u32 m0,s22,0
ds_read_b64_tr_b16 a[240:241],v3 offset:24832
ds_read_b64_tr_b16 a[242:243],v3 offset:30976
v_mfma_f32_16x16x32_bf16 v[180:183],a[244:247],v[96:99],v[180:183]
v_fma_f32 v84,v84,s36,v18
v_fma_f32 v85,v85,s36,v18
v_mfma_f32_16x16x32_bf16 v[228:231],a[244:247],v[100:103],v[228:231]
v_fma_f32 v86,v86,s36,v18
v_fma_f32 v87,v87,s36,v18
v_mfma_f32_16x16x32_bf16 a[20:23],a[244:247],v[104:107],a[20:23]
v_fma_f32 v88,v88,s36,v19
v_fma_f32 v89,v89,s36,v19
v_mfma_f32_16x16x32_bf16 a[68:71],a[244:247],v[108:111],a[68:71]
s_waitcnt lgkmcnt(4)
ds_read_b64_tr_b16 a[244:245],v4 offset:24832
ds_read_b64_tr_b16 a[246:247],v4 offset:30976
v_mfma_f32_16x16x32_bf16 v[184:187],a[248:251],v[96:99],v[184:187]
buffer_load_dwordx4 v7,s[4:7],s20 offen offset:0 lds
v_mfma_f32_16x16x32_bf16 v[232:235],a[248:251],v[100:103],v[232:235]
v_fma_f32 v90,v90,s36,v19
v_fma_f32 v91,v91,s36,v19
v_mfma_f32_16x16x32_bf16 a[24:27],a[248:251],v[104:107],a[24:27]
v_fma_f32 v92,v92,s36,v19
v_fma_f32 v93,v93,s36,v19
v_mfma_f32_16x16x32_bf16 a[72:75],a[248:251],v[108:111],a[72:75]
ds_read_b64_tr_b16 a[248:249],v5 offset:24832
ds_read_b64_tr_b16 a[250:251],v5 offset:30976
v_mfma_f32_16x16x32_bf16 v[188:191],a[252:255],v[96:99],v[188:191]
v_fma_f32 v94,v94,s36,v19
v_fma_f32 v95,v95,s36,v19
v_mfma_f32_16x16x32_bf16 v[236:239],a[252:255],v[100:103],v[236:239]
v_exp_f32 v68,v68
v_mfma_f32_16x16x32_bf16 a[28:31],a[252:255],v[104:107],a[28:31]
v_exp_f32 v69,v69
v_mfma_f32_16x16x32_bf16 a[76:79],a[252:255],v[108:111],a[76:79]
s_waitcnt lgkmcnt(2)
ds_read_b64_tr_b16 a[252:253],v6 offset:24832
ds_read_b64_tr_b16 a[254:255],v6 offset:30976
v_mfma_f32_16x16x32_bf16 v[192:195],a[240:243],v[96:99],v[192:195]
buffer_load_dwordx4 v8,s[4:7],s20 offen offset:1024 lds
v_mfma_f32_16x16x32_bf16 v[240:243],a[240:243],v[100:103],v[240:243]
v_exp_f32 v70,v70
v_mfma_f32_16x16x32_bf16 a[32:35],a[240:243],v[104:107],a[32:35]
v_exp_f32 v71,v71
v_mfma_f32_16x16x32_bf16 a[80:83],a[240:243],v[108:111],a[80:83]
v_exp_f32 v76,v76
v_mfma_f32_16x16x32_bf16 v[196:199],a[244:247],v[96:99],v[196:199]
v_exp_f32 v77,v77
v_mfma_f32_16x16x32_bf16 v[244:247],a[244:247],v[100:103],v[244:247]
ds_read_b128 v[152:155],v11 offset:0
v_cvt_pk_bf16_f32 v114,v68,v69
v_mfma_f32_16x16x32_bf16 a[36:39],a[244:247],v[104:107],a[36:39]
v_exp_f32 v78,v78
v_mfma_f32_16x16x32_bf16 a[84:87],a[244:247],v[108:111],a[84:87]
s_waitcnt lgkmcnt(1)
v_exp_f32 v79,v79
v_mfma_f32_16x16x32_bf16 v[200:203],a[248:251],v[96:99],v[200:203]
buffer_load_dwordx4 v9,s[4:7],s20 offen offset:2048 lds
v_mfma_f32_16x16x32_bf16 v[248:251],a[248:251],v[100:103],v[248:251]
s_add_u32 s20,s20,12288
v_exp_f32 v80,v80
v_mfma_f32_16x16x32_bf16 a[40:43],a[248:251],v[104:107],a[40:43]
v_exp_f32 v81,v81
v_mfma_f32_16x16x32_bf16 a[88:91],a[248:251],v[108:111],a[88:91]
v_exp_f32 v82,v82
v_mfma_f32_16x16x32_bf16 v[204:207],a[252:255],v[96:99],v[204:207]
v_exp_f32 v83,v83
v_mfma_f32_16x16x32_bf16 v[252:255],a[252:255],v[100:103],v[252:255]
v_exp_f32 v84,v84
v_mfma_f32_16x16x32_bf16 a[44:47],a[252:255],v[104:107],a[44:47]
v_exp_f32 v85,v85
v_mfma_f32_16x16x32_bf16 a[92:95],a[252:255],v[108:111],a[92:95]
v_exp_f32 v86,v86
v_mfma_f32_16x16x32_bf16 v[32:35],a[192:195],a[96:99],0
ds_read_b128 v[156:159],v23 offset:0
v_mfma_f32_16x16x32_bf16 v[32:35],a[196:199],a[100:103],v[32:35]
v_exp_f32 v87,v87
v_mfma_f32_16x16x32_bf16 v[32:35],a[200:203],a[104:107],v[32:35]
v_exp_f32 v88,v88
v_mfma_f32_16x16x32_bf16 v[32:35],a[204:207],a[108:111],v[32:35]
v_exp_f32 v89,v89
v_mfma_f32_16x16x32_bf16 v[32:35],a[208:211],a[112:115],v[32:35]
v_exp_f32 v90,v90
v_mfma_f32_16x16x32_bf16 v[32:35],a[212:215],a[116:119],v[32:35]
s_waitcnt lgkmcnt(1)
buffer_store_dwordx4 v[152:155],v0,s[16:19],s27 offen offset:0 nt
v_mfma_f32_16x16x32_bf16 v[40:43],a[192:195],a[120:123],0
v_exp_f32 v91,v91
v_mfma_f32_16x16x32_bf16 v[40:43],a[196:199],a[124:127],v[40:43]
v_exp_f32 v92,v92
v_mfma_f32_16x16x32_bf16 v[40:43],a[200:203],a[128:131],v[40:43]
v_exp_f32 v93,v93
v_mfma_f32_16x16x32_bf16 v[40:43],a[204:207],a[132:135],v[40:43]
v_exp_f32 v94,v94
v_mfma_f32_16x16x32_bf16 v[40:43],a[208:211],a[136:139],v[40:43]
v_exp_f32 v95,v95
v_mfma_f32_16x16x32_bf16 v[40:43],a[212:215],a[140:143],v[40:43]
v_cvt_pk_bf16_f32 v115,v70,v71
v_cvt_pk_bf16_f32 v118,v76,v77
v_mfma_f32_16x16x32_bf16 v[48:51],a[192:195],a[144:147],0
ds_read_b128 v[152:155],v31 offset:0
v_cvt_pk_bf16_f32 v119,v78,v79
v_mfma_f32_16x16x32_bf16 v[128:131],v[24:27],v[112:115],v[128:131]
v_cvt_pk_bf16_f32 v120,v80,v81
v_cvt_pk_bf16_f32 v121,v82,v83
v_mfma_f32_16x16x32_bf16 v[132:135],v[24:27],v[116:119],v[132:135]
v_cvt_pk_bf16_f32 v122,v84,v85
v_cvt_pk_bf16_f32 v123,v86,v87
v_mfma_f32_16x16x32_bf16 v[48:51],a[196:199],a[148:151],v[48:51]
v_cvt_pk_bf16_f32 v124,v88,v89
v_cvt_pk_bf16_f32 v125,v90,v91
v_mfma_f32_16x16x32_bf16 v[136:139],v[24:27],v[120:123],v[136:139]
s_waitcnt lgkmcnt(1)
buffer_store_dwordx4 v[156:159],v0,s[16:19],s27 offen offset:1024 nt
v_mfma_f32_16x16x32_bf16 v[48:51],a[200:203],a[152:155],v[48:51]
v_cvt_pk_bf16_f32 v126,v92,v93
v_cvt_pk_bf16_f32 v127,v94,v95
v_mfma_f32_16x16x32_bf16 v[48:51],a[204:207],a[156:159],v[48:51]
v_fma_f32 v32,v32,s36,v16
v_fma_f32 v33,v33,s36,v16
v_mfma_f32_16x16x32_bf16 v[140:143],v[24:27],v[124:127],v[140:143]
v_fma_f32 v34,v34,s36,v16
v_fma_f32 v35,v35,s36,v16
v_mfma_f32_16x16x32_bf16 v[48:51],a[208:211],a[160:163],v[48:51]
v_fma_f32 v40,v40,s36,v17
v_fma_f32 v41,v41,s36,v17
v_mfma_f32_16x16x32_bf16 v[48:51],a[212:215],a[164:167],v[48:51]
v_fma_f32 v42,v42,s36,v17
v_fma_f32 v43,v43,s36,v17
v_mfma_f32_16x16x32_bf16 v[56:59],a[192:195],a[168:171],0
v_exp_f32 v32,v32
v_mfma_f32_16x16x32_bf16 v[56:59],a[196:199],a[172:175],v[56:59]
v_exp_f32 v33,v33
v_mfma_f32_16x16x32_bf16 v[56:59],a[200:203],a[176:179],v[56:59]
v_exp_f32 v34,v34
v_mfma_f32_16x16x32_bf16 v[56:59],a[204:207],a[180:183],v[56:59]
v_exp_f32 v35,v35
v_mfma_f32_16x16x32_bf16 v[56:59],a[208:211],a[184:187],v[56:59]
v_exp_f32 v40,v40
v_mfma_f32_16x16x32_bf16 v[56:59],a[212:215],a[188:191],v[56:59]
v_exp_f32 v41,v41
v_mfma_f32_16x16x32_bf16 v[36:39],a[216:219],a[96:99],0
s_waitcnt lgkmcnt(0)
buffer_store_dwordx4 v[152:155],v0,s[16:19],s27 offen offset:2048 nt
v_mfma_f32_16x16x32_bf16 v[36:39],a[220:223],a[100:103],v[36:39]
s_add_u32 s27,s27,3072
v_exp_f32 v42,v42
v_mfma_f32_16x16x32_bf16 v[36:39],a[224:227],a[104:107],v[36:39]
v_exp_f32 v43,v43
v_mfma_f32_16x16x32_bf16 v[36:39],a[228:231],a[108:111],v[36:39]
v_cvt_pk_bf16_f32 v96,v32,v33
v_cvt_pk_bf16_f32 v97,v34,v35
v_mfma_f32_16x16x32_bf16 v[36:39],a[232:235],a[112:115],v[36:39]
v_cvt_pk_bf16_f32 v100,v40,v41
v_cvt_pk_bf16_f32 v101,v42,v43
v_mfma_f32_16x16x32_bf16 v[36:39],a[236:239],a[116:119],v[36:39]
v_mfma_f32_16x16x32_bf16 v[44:47],a[216:219],a[120:123],0
v_mfma_f32_16x16x32_bf16 v[44:47],a[220:223],a[124:127],v[44:47]
v_mfma_f32_16x16x32_bf16 v[44:47],a[224:227],a[128:131],v[44:47]
v_mfma_f32_16x16x32_bf16 v[44:47],a[228:231],a[132:135],v[44:47]
s_waitcnt vmcnt(9)
s_barrier
v_mfma_f32_16x16x32_bf16 v[44:47],a[232:235],a[136:139],v[44:47]
v_mfma_f32_16x16x32_bf16 v[44:47],a[236:239],a[140:143],v[44:47]
ds_read_b64_tr_b16 a[240:241],v3 offset:0
ds_read_b64_tr_b16 a[242:243],v3 offset:6144
v_mfma_f32_16x16x32_bf16 v[52:55],a[216:219],a[144:147],0
v_mfma_f32_16x16x32_bf16 v[52:55],a[220:223],a[148:151],v[52:55]
ds_read_b64_tr_b16 a[244:245],v4 offset:0
ds_read_b64_tr_b16 a[246:247],v4 offset:6144
v_mfma_f32_16x16x32_bf16 v[52:55],a[224:227],a[152:155],v[52:55]
v_mfma_f32_16x16x32_bf16 v[52:55],a[228:231],a[156:159],v[52:55]
ds_read_b64_tr_b16 a[248:249],v5 offset:0
ds_read_b64_tr_b16 a[250:251],v5 offset:6144
v_mfma_f32_16x16x32_bf16 v[52:55],a[232:235],a[160:163],v[52:55]
v_mfma_f32_16x16x32_bf16 v[52:55],a[236:239],a[164:167],v[52:55]
ds_read_b64_tr_b16 a[252:253],v6 offset:0
ds_read_b64_tr_b16 a[254:255],v6 offset:6144
v_mfma_f32_16x16x32_bf16 v[60:63],a[216:219],a[168:171],0
v_mfma_f32_16x16x32_bf16 v[60:63],a[220:223],a[172:175],v[60:63]
v_mfma_f32_16x16x32_bf16 v[60:63],a[224:227],a[176:179],v[60:63]
v_mfma_f32_16x16x32_bf16 v[60:63],a[228:231],a[180:183],v[60:63]
v_mfma_f32_16x16x32_bf16 v[60:63],a[232:235],a[184:187],v[60:63]
v_mfma_f32_16x16x32_bf16 v[60:63],a[236:239],a[188:191],v[60:63]
s_waitcnt lgkmcnt(4)
v_mfma_f32_16x16x32_bf16 v[160:163],a[240:243],v[112:115],v[160:163]
s_add_u32 m0,s23,24576
ds_read_b128 a[192:195],v1 offset:24576
v_fma_f32 v36,v36,s36,v16
v_mfma_f32_16x16x32_bf16 v[208:211],a[240:243],v[116:119],v[208:211]
buffer_load_dwordx4 v7,s[8:11],s21 offen offset:0 lds
v_mfma_f32_16x16x32_bf16 a[0:3],a[240:243],v[120:123],a[0:3]
ds_read_b128 a[196:199],v2 offset:24576
v_fma_f32 v37,v37,s36,v16
v_mfma_f32_16x16x32_bf16 a[48:51],a[240:243],v[124:127],a[48:51]
ds_read_b64_tr_b16 a[240:241],v3 offset:128
ds_read_b64_tr_b16 a[242:243],v3 offset:6272
v_mfma_f32_16x16x32_bf16 v[164:167],a[244:247],v[112:115],v[164:167]
ds_read_b128 a[200:203],v1 offset:24704
v_fma_f32 v38,v38,s36,v16
v_mfma_f32_16x16x32_bf16 v[212:215],a[244:247],v[116:119],v[212:215]
ds_read_b128 a[204:207],v2 offset:24704
v_fma_f32 v39,v39,s36,v16
v_mfma_f32_16x16x32_bf16 a[4:7],a[244:247],v[120:123],a[4:7]
ds_read_b128 a[208:211],v1 offset:24832
v_fma_f32 v44,v44,s36,v17
v_mfma_f32_16x16x32_bf16 a[52:55],a[244:247],v[124:127],a[52:55]
s_waitcnt lgkmcnt(7)
ds_read_b64_tr_b16 a[244:245],v4 offset:128
ds_read_b64_tr_b16 a[246:247],v4 offset:6272
v_mfma_f32_16x16x32_bf16 v[168:171],a[248:251],v[112:115],v[168:171]
ds_read_b128 a[212:215],v2 offset:24832
v_fma_f32 v45,v45,s36,v17
v_mfma_f32_16x16x32_bf16 v[216:219],a[248:251],v[116:119],v[216:219]
buffer_load_dwordx4 v8,s[8:11],s21 offen offset:1024 lds
v_mfma_f32_16x16x32_bf16 a[8:11],a[248:251],v[120:123],a[8:11]
ds_read_b128 a[216:219],v1 offset:30720
v_fma_f32 v46,v46,s36,v17
v_mfma_f32_16x16x32_bf16 a[56:59],a[248:251],v[124:127],a[56:59]
ds_read_b64_tr_b16 a[248:249],v5 offset:128
ds_read_b64_tr_b16 a[250:251],v5 offset:6272
v_mfma_f32_16x16x32_bf16 v[172:175],a[252:255],v[112:115],v[172:175]
ds_read_b128 a[220:223],v2 offset:30720
v_fma_f32 v47,v47,s36,v17
v_mfma_f32_16x16x32_bf16 v[220:223],a[252:255],v[116:119],v[220:223]
ds_read_b128 a[224:227],v1 offset:30848
v_fma_f32 v48,v48,s36,v18
v_mfma_f32_16x16x32_bf16 a[12:15],a[252:255],v[120:123],a[12:15]
ds_read_b128 a[228:231],v2 offset:30848
v_fma_f32 v49,v49,s36,v18
v_mfma_f32_16x16x32_bf16 a[60:63],a[252:255],v[124:127],a[60:63]
s_waitcnt lgkmcnt(7)
ds_read_b64_tr_b16 a[252:253],v6 offset:128
ds_read_b64_tr_b16 a[254:255],v6 offset:6272
v_mfma_f32_16x16x32_bf16 v[176:179],a[240:243],v[112:115],v[176:179]
ds_read_b128 a[232:235],v1 offset:30976
v_fma_f32 v50,v50,s36,v18
v_mfma_f32_16x16x32_bf16 v[224:227],a[240:243],v[116:119],v[224:227]
buffer_load_dwordx4 v9,s[8:11],s21 offen offset:2048 lds
v_mfma_f32_16x16x32_bf16 a[16:19],a[240:243],v[120:123],a[16:19]
s_add_u32 s21,s21,12288
ds_read_b128 a[236:239],v2 offset:30976
v_fma_f32 v51,v51,s36,v18
v_mfma_f32_16x16x32_bf16 a[64:67],a[240:243],v[124:127],a[64:67]
s_add_u32 m0,s22,12288
ds_read_b64_tr_b16 a[240:241],v3 offset:256
ds_read_b64_tr_b16 a[242:243],v3 offset:6400
v_mfma_f32_16x16x32_bf16 v[180:183],a[244:247],v[112:115],v[180:183]
v_fma_f32 v52,v52,s36,v18
v_fma_f32 v53,v53,s36,v18
v_mfma_f32_16x16x32_bf16 v[228:231],a[244:247],v[116:119],v[228:231]
v_fma_f32 v54,v54,s36,v18
v_fma_f32 v55,v55,s36,v18
v_mfma_f32_16x16x32_bf16 a[20:23],a[244:247],v[120:123],a[20:23]
v_fma_f32 v56,v56,s36,v19
v_fma_f32 v57,v57,s36,v19
v_mfma_f32_16x16x32_bf16 a[68:71],a[244:247],v[124:127],a[68:71]
s_waitcnt lgkmcnt(4)
ds_read_b64_tr_b16 a[244:245],v4 offset:256
ds_read_b64_tr_b16 a[246:247],v4 offset:6400
v_mfma_f32_16x16x32_bf16 v[184:187],a[248:251],v[112:115],v[184:187]
buffer_load_dwordx4 v7,s[4:7],s20 offen offset:0 lds
v_mfma_f32_16x16x32_bf16 v[232:235],a[248:251],v[116:119],v[232:235]
v_fma_f32 v58,v58,s36,v19
v_fma_f32 v59,v59,s36,v19
v_mfma_f32_16x16x32_bf16 a[24:27],a[248:251],v[120:123],a[24:27]
v_fma_f32 v60,v60,s36,v19
v_fma_f32 v61,v61,s36,v19
v_mfma_f32_16x16x32_bf16 a[72:75],a[248:251],v[124:127],a[72:75]
ds_read_b64_tr_b16 a[248:249],v5 offset:256
ds_read_b64_tr_b16 a[250:251],v5 offset:6400
v_mfma_f32_16x16x32_bf16 v[188:191],a[252:255],v[112:115],v[188:191]
v_fma_f32 v62,v62,s36,v19
v_fma_f32 v63,v63,s36,v19
v_mfma_f32_16x16x32_bf16 v[236:239],a[252:255],v[116:119],v[236:239]
v_exp_f32 v36,v36
v_mfma_f32_16x16x32_bf16 a[28:31],a[252:255],v[120:123],a[28:31]
v_exp_f32 v37,v37
v_mfma_f32_16x16x32_bf16 a[76:79],a[252:255],v[124:127],a[76:79]
s_waitcnt lgkmcnt(2)
ds_read_b64_tr_b16 a[252:253],v6 offset:256
ds_read_b64_tr_b16 a[254:255],v6 offset:6400
v_mfma_f32_16x16x32_bf16 v[192:195],a[240:243],v[112:115],v[192:195]
buffer_load_dwordx4 v8,s[4:7],s20 offen offset:1024 lds
v_mfma_f32_16x16x32_bf16 v[240:243],a[240:243],v[116:119],v[240:243]
v_exp_f32 v38,v38
v_mfma_f32_16x16x32_bf16 a[32:35],a[240:243],v[120:123],a[32:35]
v_exp_f32 v39,v39
v_mfma_f32_16x16x32_bf16 a[80:83],a[240:243],v[124:127],a[80:83]
v_exp_f32 v44,v44
v_mfma_f32_16x16x32_bf16 v[196:199],a[244:247],v[112:115],v[196:199]
v_exp_f32 v45,v45
v_mfma_f32_16x16x32_bf16 v[244:247],a[244:247],v[116:119],v[244:247]
v_exp_f32 v46,v46
v_mfma_f32_16x16x32_bf16 a[36:39],a[244:247],v[120:123],a[36:39]
v_exp_f32 v47,v47
v_mfma_f32_16x16x32_bf16 a[84:87],a[244:247],v[124:127],a[84:87]
s_waitcnt lgkmcnt(0)
v_exp_f32 v48,v48
v_mfma_f32_16x16x32_bf16 v[200:203],a[248:251],v[112:115],v[200:203]
buffer_load_dwordx4 v9,s[4:7],s20 offen offset:2048 lds
v_mfma_f32_16x16x32_bf16 v[248:251],a[248:251],v[116:119],v[248:251]
s_add_u32 s20,s20,12288
v_exp_f32 v49,v49
v_mfma_f32_16x16x32_bf16 a[40:43],a[248:251],v[120:123],a[40:43]
s_add_u32 m0,s29,0
v_exp_f32 v50,v50
v_mfma_f32_16x16x32_bf16 a[88:91],a[248:251],v[124:127],a[88:91]
v_exp_f32 v51,v51
v_mfma_f32_16x16x32_bf16 v[204:207],a[252:255],v[112:115],v[204:207]
v_exp_f32 v52,v52
v_mfma_f32_16x16x32_bf16 v[252:255],a[252:255],v[116:119],v[252:255]
v_exp_f32 v53,v53
v_mfma_f32_16x16x32_bf16 a[44:47],a[252:255],v[120:123],a[44:47]
v_exp_f32 v54,v54
v_mfma_f32_16x16x32_bf16 a[92:95],a[252:255],v[124:127],a[92:95]
v_exp_f32 v55,v55
v_mfma_f32_16x16x32_bf16 v[64:67],a[192:195],a[96:99],0
v_exp_f32 v56,v56
v_mfma_f32_16x16x32_bf16 v[64:67],a[196:199],a[100:103],v[64:67]
v_exp_f32 v57,v57
v_mfma_f32_16x16x32_bf16 v[64:67],a[200:203],a[104:107],v[64:67]
v_exp_f32 v58,v58
v_mfma_f32_16x16x32_bf16 v[64:67],a[204:207],a[108:111],v[64:67]
v_exp_f32 v59,v59
v_mfma_f32_16x16x32_bf16 v[64:67],a[208:211],a[112:115],v[64:67]
v_exp_f32 v60,v60
v_mfma_f32_16x16x32_bf16 v[64:67],a[212:215],a[116:119],v[64:67]
buffer_load_dwordx4 v7,s[12:15],s28 offen offset:0 nt lds
v_mfma_f32_16x16x32_bf16 v[72:75],a[192:195],a[120:123],0
v_exp_f32 v61,v61
v_mfma_f32_16x16x32_bf16 v[72:75],a[196:199],a[124:127],v[72:75]
v_exp_f32 v62,v62
v_mfma_f32_16x16x32_bf16 v[72:75],a[200:203],a[128:131],v[72:75]
v_exp_f32 v63,v63
v_mfma_f32_16x16x32_bf16 v[72:75],a[204:207],a[132:135],v[72:75]
v_cvt_pk_bf16_f32 v98,v36,v37
v_cvt_pk_bf16_f32 v99,v38,v39
v_mfma_f32_16x16x32_bf16 v[72:75],a[208:211],a[136:139],v[72:75]
v_cvt_pk_bf16_f32 v102,v44,v45
v_cvt_pk_bf16_f32 v103,v46,v47
v_mfma_f32_16x16x32_bf16 v[128:131],v[24:27],v[96:99],v[128:131]
v_cvt_pk_bf16_f32 v104,v48,v49
v_cvt_pk_bf16_f32 v105,v50,v51
v_mfma_f32_16x16x32_bf16 v[132:135],v[24:27],v[100:103],v[132:135]
v_cvt_pk_bf16_f32 v106,v52,v53
v_cvt_pk_bf16_f32 v107,v54,v55
v_mfma_f32_16x16x32_bf16 v[72:75],a[212:215],a[140:143],v[72:75]
v_cvt_pk_bf16_f32 v108,v56,v57
v_cvt_pk_bf16_f32 v109,v58,v59
v_mfma_f32_16x16x32_bf16 v[136:139],v[24:27],v[104:107],v[136:139]
v_cvt_pk_bf16_f32 v110,v60,v61
v_cvt_pk_bf16_f32 v111,v62,v63
v_mfma_f32_16x16x32_bf16 v[80:83],a[192:195],a[144:147],0
v_fma_f32 v64,v64,s36,v16
v_fma_f32 v65,v65,s36,v16
v_mfma_f32_16x16x32_bf16 v[140:143],v[24:27],v[108:111],v[140:143]
buffer_load_dwordx4 v8,s[12:15],s28 offen offset:1024 nt lds
v_mfma_f32_16x16x32_bf16 v[80:83],a[196:199],a[148:151],v[80:83]
v_fma_f32 v66,v66,s36,v16
v_fma_f32 v67,v67,s36,v16
v_mfma_f32_16x16x32_bf16 v[80:83],a[200:203],a[152:155],v[80:83]
v_fma_f32 v72,v72,s36,v17
v_fma_f32 v73,v73,s36,v17
v_mfma_f32_16x16x32_bf16 v[80:83],a[204:207],a[156:159],v[80:83]
v_fma_f32 v74,v74,s36,v17
v_fma_f32 v75,v75,s36,v17
v_mfma_f32_16x16x32_bf16 v[80:83],a[208:211],a[160:163],v[80:83]
v_exp_f32 v64,v64
v_mfma_f32_16x16x32_bf16 v[80:83],a[212:215],a[164:167],v[80:83]
v_exp_f32 v65,v65
v_mfma_f32_16x16x32_bf16 v[88:91],a[192:195],a[168:171],0
v_exp_f32 v66,v66
v_mfma_f32_16x16x32_bf16 v[88:91],a[196:199],a[172:175],v[88:91]
v_exp_f32 v67,v67
v_mfma_f32_16x16x32_bf16 v[88:91],a[200:203],a[176:179],v[88:91]
v_exp_f32 v72,v72
v_mfma_f32_16x16x32_bf16 v[88:91],a[204:207],a[180:183],v[88:91]
v_exp_f32 v73,v73
v_mfma_f32_16x16x32_bf16 v[88:91],a[208:211],a[184:187],v[88:91]
v_exp_f32 v74,v74
v_mfma_f32_16x16x32_bf16 v[88:91],a[212:215],a[188:191],v[88:91]
v_exp_f32 v75,v75
v_mfma_f32_16x16x32_bf16 v[68:71],a[216:219],a[96:99],0
buffer_load_dwordx4 v9,s[12:15],s28 offen offset:2048 nt lds
v_mfma_f32_16x16x32_bf16 v[68:71],a[220:223],a[100:103],v[68:71]
s_add_u32 s28,s28,3072
v_cvt_pk_bf16_f32 v112,v64,v65
v_cvt_pk_bf16_f32 v113,v66,v67
v_mfma_f32_16x16x32_bf16 v[68:71],a[224:227],a[104:107],v[68:71]
s_add_u32 s29,s29,3072
v_cvt_pk_bf16_f32 v116,v72,v73
v_cvt_pk_bf16_f32 v117,v74,v75
v_mfma_f32_16x16x32_bf16 v[68:71],a[228:231],a[108:111],v[68:71]
v_mfma_f32_16x16x32_bf16 v[68:71],a[232:235],a[112:115],v[68:71]
v_mfma_f32_16x16x32_bf16 v[68:71],a[236:239],a[116:119],v[68:71]
v_mfma_f32_16x16x32_bf16 v[76:79],a[216:219],a[120:123],0
v_mfma_f32_16x16x32_bf16 v[76:79],a[220:223],a[124:127],v[76:79]
v_mfma_f32_16x16x32_bf16 v[76:79],a[224:227],a[128:131],v[76:79]
v_mfma_f32_16x16x32_bf16 v[76:79],a[228:231],a[132:135],v[76:79]
s_waitcnt vmcnt(12)
s_barrier
v_mfma_f32_16x16x32_bf16 v[76:79],a[232:235],a[136:139],v[76:79]
v_mfma_f32_16x16x32_bf16 v[76:79],a[236:239],a[140:143],v[76:79]
ds_read_b64_tr_b16 a[240:241],v3 offset:12288
ds_read_b64_tr_b16 a[242:243],v3 offset:18432
v_mfma_f32_16x16x32_bf16 v[84:87],a[216:219],a[144:147],0
v_mfma_f32_16x16x32_bf16 v[84:87],a[220:223],a[148:151],v[84:87]
ds_read_b64_tr_b16 a[244:245],v4 offset:12288
ds_read_b64_tr_b16 a[246:247],v4 offset:18432
v_mfma_f32_16x16x32_bf16 v[84:87],a[224:227],a[152:155],v[84:87]
v_mfma_f32_16x16x32_bf16 v[84:87],a[228:231],a[156:159],v[84:87]
ds_read_b64_tr_b16 a[248:249],v5 offset:12288
ds_read_b64_tr_b16 a[250:251],v5 offset:18432
v_mfma_f32_16x16x32_bf16 v[84:87],a[232:235],a[160:163],v[84:87]
v_mfma_f32_16x16x32_bf16 v[84:87],a[236:239],a[164:167],v[84:87]
ds_read_b64_tr_b16 a[252:253],v6 offset:12288
ds_read_b64_tr_b16 a[254:255],v6 offset:18432
v_mfma_f32_16x16x32_bf16 v[92:95],a[216:219],a[168:171],0
v_mfma_f32_16x16x32_bf16 v[92:95],a[220:223],a[172:175],v[92:95]
v_mfma_f32_16x16x32_bf16 v[92:95],a[224:227],a[176:179],v[92:95]
v_mfma_f32_16x16x32_bf16 v[92:95],a[228:231],a[180:183],v[92:95]
v_mfma_f32_16x16x32_bf16 v[92:95],a[232:235],a[184:187],v[92:95]
v_mfma_f32_16x16x32_bf16 v[92:95],a[236:239],a[188:191],v[92:95]
s_waitcnt lgkmcnt(4)
v_mfma_f32_16x16x32_bf16 v[160:163],a[240:243],v[96:99],v[160:163]
s_add_u32 m0,s23,0
ds_read_b128 a[192:195],v1 offset:0
v_fma_f32 v68,v68,s36,v16
v_mfma_f32_16x16x32_bf16 v[208:211],a[240:243],v[100:103],v[208:211]
buffer_load_dwordx4 v7,s[8:11],s21 offen offset:0 lds
v_mfma_f32_16x16x32_bf16 a[0:3],a[240:243],v[104:107],a[0:3]
ds_read_b128 a[196:199],v2 offset:0
v_fma_f32 v69,v69,s36,v16
v_mfma_f32_16x16x32_bf16 a[48:51],a[240:243],v[108:111],a[48:51]
ds_read_b64_tr_b16 a[240:241],v3 offset:12416
ds_read_b64_tr_b16 a[242:243],v3 offset:18560
v_mfma_f32_16x16x32_bf16 v[164:167],a[244:247],v[96:99],v[164:167]
ds_read_b128 a[200:203],v1 offset:128
v_fma_f32 v70,v70,s36,v16
v_mfma_f32_16x16x32_bf16 v[212:215],a[244:247],v[100:103],v[212:215]
ds_read_b128 a[204:207],v2 offset:128
v_fma_f32 v71,v71,s36,v16
v_mfma_f32_16x16x32_bf16 a[4:7],a[244:247],v[104:107],a[4:7]
ds_read_b128 a[208:211],v1 offset:256
v_fma_f32 v76,v76,s36,v17
v_mfma_f32_16x16x32_bf16 a[52:55],a[244:247],v[108:111],a[52:55]
s_waitcnt lgkmcnt(7)
ds_read_b64_tr_b16 a[244:245],v4 offset:12416
ds_read_b64_tr_b16 a[246:247],v4 offset:18560
v_mfma_f32_16x16x32_bf16 v[168:171],a[248:251],v[96:99],v[168:171]
ds_read_b128 a[212:215],v2 offset:256
v_fma_f32 v77,v77,s36,v17
v_mfma_f32_16x16x32_bf16 v[216:219],a[248:251],v[100:103],v[216:219]
buffer_load_dwordx4 v8,s[8:11],s21 offen offset:1024 lds
v_mfma_f32_16x16x32_bf16 a[8:11],a[248:251],v[104:107],a[8:11]
ds_read_b128 a[216:219],v1 offset:6144
v_fma_f32 v78,v78,s36,v17
v_mfma_f32_16x16x32_bf16 a[56:59],a[248:251],v[108:111],a[56:59]
ds_read_b64_tr_b16 a[248:249],v5 offset:12416
ds_read_b64_tr_b16 a[250:251],v5 offset:18560
v_mfma_f32_16x16x32_bf16 v[172:175],a[252:255],v[96:99],v[172:175]
ds_read_b128 a[220:223],v2 offset:6144
v_fma_f32 v79,v79,s36,v17
v_mfma_f32_16x16x32_bf16 v[220:223],a[252:255],v[100:103],v[220:223]
ds_read_b128 a[224:227],v1 offset:6272
v_fma_f32 v80,v80,s36,v18
v_mfma_f32_16x16x32_bf16 a[12:15],a[252:255],v[104:107],a[12:15]
ds_read_b128 a[228:231],v2 offset:6272
v_fma_f32 v81,v81,s36,v18
v_mfma_f32_16x16x32_bf16 a[60:63],a[252:255],v[108:111],a[60:63]
s_waitcnt lgkmcnt(7)
ds_read_b64_tr_b16 a[252:253],v6 offset:12416
ds_read_b64_tr_b16 a[254:255],v6 offset:18560
v_mfma_f32_16x16x32_bf16 v[176:179],a[240:243],v[96:99],v[176:179]
ds_read_b128 a[232:235],v1 offset:6400
v_fma_f32 v82,v82,s36,v18
v_mfma_f32_16x16x32_bf16 v[224:227],a[240:243],v[100:103],v[224:227]
buffer_load_dwordx4 v9,s[8:11],s21 offen offset:2048 lds
v_mfma_f32_16x16x32_bf16 a[16:19],a[240:243],v[104:107],a[16:19]
s_add_u32 s21,s21,12288
ds_read_b128 a[236:239],v2 offset:6400
v_fma_f32 v83,v83,s36,v18
v_mfma_f32_16x16x32_bf16 a[64:67],a[240:243],v[108:111],a[64:67]
s_add_u32 m0,s22,24576
ds_read_b64_tr_b16 a[240:241],v3 offset:12544
ds_read_b64_tr_b16 a[242:243],v3 offset:18688
v_mfma_f32_16x16x32_bf16 v[180:183],a[244:247],v[96:99],v[180:183]
v_fma_f32 v84,v84,s36,v18
v_fma_f32 v85,v85,s36,v18
v_mfma_f32_16x16x32_bf16 v[228:231],a[244:247],v[100:103],v[228:231]
v_fma_f32 v86,v86,s36,v18
v_fma_f32 v87,v87,s36,v18
v_mfma_f32_16x16x32_bf16 a[20:23],a[244:247],v[104:107],a[20:23]
v_fma_f32 v88,v88,s36,v19
v_fma_f32 v89,v89,s36,v19
v_mfma_f32_16x16x32_bf16 a[68:71],a[244:247],v[108:111],a[68:71]
s_waitcnt lgkmcnt(4)
ds_read_b64_tr_b16 a[244:245],v4 offset:12544
ds_read_b64_tr_b16 a[246:247],v4 offset:18688
v_mfma_f32_16x16x32_bf16 v[184:187],a[248:251],v[96:99],v[184:187]
buffer_load_dwordx4 v7,s[4:7],s20 offen offset:0 lds
v_mfma_f32_16x16x32_bf16 v[232:235],a[248:251],v[100:103],v[232:235]
v_fma_f32 v90,v90,s36,v19
v_fma_f32 v91,v91,s36,v19
v_mfma_f32_16x16x32_bf16 a[24:27],a[248:251],v[104:107],a[24:27]
v_fma_f32 v92,v92,s36,v19
v_fma_f32 v93,v93,s36,v19
v_mfma_f32_16x16x32_bf16 a[72:75],a[248:251],v[108:111],a[72:75]
ds_read_b64_tr_b16 a[248:249],v5 offset:12544
ds_read_b64_tr_b16 a[250:251],v5 offset:18688
v_mfma_f32_16x16x32_bf16 v[188:191],a[252:255],v[96:99],v[188:191]
v_fma_f32 v94,v94,s36,v19
v_fma_f32 v95,v95,s36,v19
v_mfma_f32_16x16x32_bf16 v[236:239],a[252:255],v[100:103],v[236:239]
v_exp_f32 v68,v68
v_mfma_f32_16x16x32_bf16 a[28:31],a[252:255],v[104:107],a[28:31]
v_exp_f32 v69,v69
v_mfma_f32_16x16x32_bf16 a[76:79],a[252:255],v[108:111],a[76:79]
s_waitcnt lgkmcnt(2)
ds_read_b64_tr_b16 a[252:253],v6 offset:12544
ds_read_b64_tr_b16 a[254:255],v6 offset:18688
v_mfma_f32_16x16x32_bf16 v[192:195],a[240:243],v[96:99],v[192:195]
buffer_load_dwordx4 v8,s[4:7],s20 offen offset:1024 lds
v_mfma_f32_16x16x32_bf16 v[240:243],a[240:243],v[100:103],v[240:243]
v_exp_f32 v70,v70
v_mfma_f32_16x16x32_bf16 a[32:35],a[240:243],v[104:107],a[32:35]
v_exp_f32 v71,v71
v_mfma_f32_16x16x32_bf16 a[80:83],a[240:243],v[108:111],a[80:83]
v_exp_f32 v76,v76
v_mfma_f32_16x16x32_bf16 v[196:199],a[244:247],v[96:99],v[196:199]
v_exp_f32 v77,v77
v_mfma_f32_16x16x32_bf16 v[244:247],a[244:247],v[100:103],v[244:247]
ds_read_b128 v[156:159],v11 offset:3072
v_cvt_pk_bf16_f32 v114,v68,v69
v_mfma_f32_16x16x32_bf16 a[36:39],a[244:247],v[104:107],a[36:39]
v_exp_f32 v78,v78
v_mfma_f32_16x16x32_bf16 a[84:87],a[244:247],v[108:111],a[84:87]
s_waitcnt lgkmcnt(1)
v_exp_f32 v79,v79
v_mfma_f32_16x16x32_bf16 v[200:203],a[248:251],v[96:99],v[200:203]
buffer_load_dwordx4 v9,s[4:7],s20 offen offset:2048 lds
v_mfma_f32_16x16x32_bf16 v[248:251],a[248:251],v[100:103],v[248:251]
s_add_u32 s20,s20,12288
v_exp_f32 v80,v80
v_mfma_f32_16x16x32_bf16 a[40:43],a[248:251],v[104:107],a[40:43]
v_exp_f32 v81,v81
v_mfma_f32_16x16x32_bf16 a[88:91],a[248:251],v[108:111],a[88:91]
v_exp_f32 v82,v82
v_mfma_f32_16x16x32_bf16 v[204:207],a[252:255],v[96:99],v[204:207]
v_exp_f32 v83,v83
v_mfma_f32_16x16x32_bf16 v[252:255],a[252:255],v[100:103],v[252:255]
v_exp_f32 v84,v84
v_mfma_f32_16x16x32_bf16 a[44:47],a[252:255],v[104:107],a[44:47]
v_exp_f32 v85,v85
v_mfma_f32_16x16x32_bf16 a[92:95],a[252:255],v[108:111],a[92:95]
v_exp_f32 v86,v86
v_mfma_f32_16x16x32_bf16 v[32:35],a[192:195],a[96:99],0
ds_read_b128 v[152:155],v23 offset:3072
v_mfma_f32_16x16x32_bf16 v[32:35],a[196:199],a[100:103],v[32:35]
v_exp_f32 v87,v87
v_mfma_f32_16x16x32_bf16 v[32:35],a[200:203],a[104:107],v[32:35]
v_exp_f32 v88,v88
v_mfma_f32_16x16x32_bf16 v[32:35],a[204:207],a[108:111],v[32:35]
v_exp_f32 v89,v89
v_mfma_f32_16x16x32_bf16 v[32:35],a[208:211],a[112:115],v[32:35]
v_exp_f32 v90,v90
v_mfma_f32_16x16x32_bf16 v[32:35],a[212:215],a[116:119],v[32:35]
s_waitcnt lgkmcnt(1)
buffer_store_dwordx4 v[156:159],v0,s[16:19],s27 offen offset:0 nt
v_mfma_f32_16x16x32_bf16 v[40:43],a[192:195],a[120:123],0
v_exp_f32 v91,v91
v_mfma_f32_16x16x32_bf16 v[40:43],a[196:199],a[124:127],v[40:43]
v_exp_f32 v92,v92
v_mfma_f32_16x16x32_bf16 v[40:43],a[200:203],a[128:131],v[40:43]
v_exp_f32 v93,v93
v_mfma_f32_16x16x32_bf16 v[40:43],a[204:207],a[132:135],v[40:43]
v_exp_f32 v94,v94
v_mfma_f32_16x16x32_bf16 v[40:43],a[208:211],a[136:139],v[40:43]
v_exp_f32 v95,v95
v_mfma_f32_16x16x32_bf16 v[40:43],a[212:215],a[140:143],v[40:43]
v_cvt_pk_bf16_f32 v115,v70,v71
v_cvt_pk_bf16_f32 v118,v76,v77
v_mfma_f32_16x16x32_bf16 v[48:51],a[192:195],a[144:147],0
ds_read_b128 v[156:159],v31 offset:3072
v_cvt_pk_bf16_f32 v119,v78,v79
v_mfma_f32_16x16x32_bf16 v[128:131],v[24:27],v[112:115],v[128:131]
v_cvt_pk_bf16_f32 v120,v80,v81
v_cvt_pk_bf16_f32 v121,v82,v83
v_mfma_f32_16x16x32_bf16 v[132:135],v[24:27],v[116:119],v[132:135]
v_cvt_pk_bf16_f32 v122,v84,v85
v_cvt_pk_bf16_f32 v123,v86,v87
v_mfma_f32_16x16x32_bf16 v[48:51],a[196:199],a[148:151],v[48:51]
v_cvt_pk_bf16_f32 v124,v88,v89
v_cvt_pk_bf16_f32 v125,v90,v91
v_mfma_f32_16x16x32_bf16 v[136:139],v[24:27],v[120:123],v[136:139]
s_waitcnt lgkmcnt(1)
buffer_store_dwordx4 v[152:155],v0,s[16:19],s27 offen offset:1024 nt
v_mfma_f32_16x16x32_bf16 v[48:51],a[200:203],a[152:155],v[48:51]
v_cvt_pk_bf16_f32 v126,v92,v93
v_cvt_pk_bf16_f32 v127,v94,v95
v_mfma_f32_16x16x32_bf16 v[48:51],a[204:207],a[156:159],v[48:51]
v_fma_f32 v32,v32,s36,v16
v_fma_f32 v33,v33,s36,v16
v_mfma_f32_16x16x32_bf16 v[140:143],v[24:27],v[124:127],v[140:143]
v_fma_f32 v34,v34,s36,v16
v_fma_f32 v35,v35,s36,v16
v_mfma_f32_16x16x32_bf16 v[48:51],a[208:211],a[160:163],v[48:51]
v_fma_f32 v40,v40,s36,v17
v_fma_f32 v41,v41,s36,v17
v_mfma_f32_16x16x32_bf16 v[48:51],a[212:215],a[164:167],v[48:51]
v_fma_f32 v42,v42,s36,v17
v_fma_f32 v43,v43,s36,v17
v_mfma_f32_16x16x32_bf16 v[56:59],a[192:195],a[168:171],0
v_exp_f32 v32,v32
v_mfma_f32_16x16x32_bf16 v[56:59],a[196:199],a[172:175],v[56:59]
v_exp_f32 v33,v33
v_mfma_f32_16x16x32_bf16 v[56:59],a[200:203],a[176:179],v[56:59]
v_exp_f32 v34,v34
v_mfma_f32_16x16x32_bf16 v[56:59],a[204:207],a[180:183],v[56:59]
v_exp_f32 v35,v35
v_mfma_f32_16x16x32_bf16 v[56:59],a[208:211],a[184:187],v[56:59]
v_exp_f32 v40,v40
v_mfma_f32_16x16x32_bf16 v[56:59],a[212:215],a[188:191],v[56:59]
v_exp_f32 v41,v41
v_mfma_f32_16x16x32_bf16 v[36:39],a[216:219],a[96:99],0
s_waitcnt lgkmcnt(0)
buffer_store_dwordx4 v[156:159],v0,s[16:19],s27 offen offset:2048 nt
v_mfma_f32_16x16x32_bf16 v[36:39],a[220:223],a[100:103],v[36:39]
s_add_u32 s27,s27,3072
v_exp_f32 v42,v42
v_mfma_f32_16x16x32_bf16 v[36:39],a[224:227],a[104:107],v[36:39]
v_exp_f32 v43,v43
v_mfma_f32_16x16x32_bf16 v[36:39],a[228:231],a[108:111],v[36:39]
v_cvt_pk_bf16_f32 v96,v32,v33
v_cvt_pk_bf16_f32 v97,v34,v35
v_mfma_f32_16x16x32_bf16 v[36:39],a[232:235],a[112:115],v[36:39]
v_cvt_pk_bf16_f32 v100,v40,v41
v_cvt_pk_bf16_f32 v101,v42,v43
v_mfma_f32_16x16x32_bf16 v[36:39],a[236:239],a[116:119],v[36:39]
v_mfma_f32_16x16x32_bf16 v[44:47],a[216:219],a[120:123],0
v_mfma_f32_16x16x32_bf16 v[44:47],a[220:223],a[124:127],v[44:47]
v_mfma_f32_16x16x32_bf16 v[44:47],a[224:227],a[128:131],v[44:47]
v_mfma_f32_16x16x32_bf16 v[44:47],a[228:231],a[132:135],v[44:47]
s_waitcnt vmcnt(12)
s_barrier
v_mfma_f32_16x16x32_bf16 v[44:47],a[232:235],a[136:139],v[44:47]
v_mfma_f32_16x16x32_bf16 v[44:47],a[236:239],a[140:143],v[44:47]
ds_read_b64_tr_b16 a[240:241],v3 offset:24576
ds_read_b64_tr_b16 a[242:243],v3 offset:30720
v_mfma_f32_16x16x32_bf16 v[52:55],a[216:219],a[144:147],0
v_mfma_f32_16x16x32_bf16 v[52:55],a[220:223],a[148:151],v[52:55]
ds_read_b64_tr_b16 a[244:245],v4 offset:24576
ds_read_b64_tr_b16 a[246:247],v4 offset:30720
v_mfma_f32_16x16x32_bf16 v[52:55],a[224:227],a[152:155],v[52:55]
v_mfma_f32_16x16x32_bf16 v[52:55],a[228:231],a[156:159],v[52:55]
ds_read_b64_tr_b16 a[248:249],v5 offset:24576
ds_read_b64_tr_b16 a[250:251],v5 offset:30720
v_mfma_f32_16x16x32_bf16 v[52:55],a[232:235],a[160:163],v[52:55]
v_mfma_f32_16x16x32_bf16 v[52:55],a[236:239],a[164:167],v[52:55]
ds_read_b64_tr_b16 a[252:253],v6 offset:24576
ds_read_b64_tr_b16 a[254:255],v6 offset:30720
v_mfma_f32_16x16x32_bf16 v[60:63],a[216:219],a[168:171],0
v_mfma_f32_16x16x32_bf16 v[60:63],a[220:223],a[172:175],v[60:63]
v_mfma_f32_16x16x32_bf16 v[60:63],a[224:227],a[176:179],v[60:63]
v_mfma_f32_16x16x32_bf16 v[60:63],a[228:231],a[180:183],v[60:63]
v_mfma_f32_16x16x32_bf16 v[60:63],a[232:235],a[184:187],v[60:63]
v_mfma_f32_16x16x32_bf16 v[60:63],a[236:239],a[188:191],v[60:63]
s_waitcnt lgkmcnt(4)
v_mfma_f32_16x16x32_bf16 v[160:163],a[240:243],v[112:115],v[160:163]
s_add_u32 m0,s23,12288
ds_read_b128 a[192:195],v1 offset:12288
v_fma_f32 v36,v36,s36,v16
v_mfma_f32_16x16x32_bf16 v[208:211],a[240:243],v[116:119],v[208:211]
buffer_load_dwordx4 v7,s[8:11],s21 offen offset:0 lds
v_mfma_f32_16x16x32_bf16 a[0:3],a[240:243],v[120:123],a[0:3]
ds_read_b128 a[196:199],v2 offset:12288
v_fma_f32 v37,v37,s36,v16
v_mfma_f32_16x16x32_bf16 a[48:51],a[240:243],v[124:127],a[48:51]
ds_read_b64_tr_b16 a[240:241],v3 offset:24704
ds_read_b64_tr_b16 a[242:243],v3 offset:30848
v_mfma_f32_16x16x32_bf16 v[164:167],a[244:247],v[112:115],v[164:167]
ds_read_b128 a[200:203],v1 offset:12416
v_fma_f32 v38,v38,s36,v16
v_mfma_f32_16x16x32_bf16 v[212:215],a[244:247],v[116:119],v[212:215]
ds_read_b128 a[204:207],v2 offset:12416
v_fma_f32 v39,v39,s36,v16
v_mfma_f32_16x16x32_bf16 a[4:7],a[244:247],v[120:123],a[4:7]
ds_read_b128 a[208:211],v1 offset:12544
v_fma_f32 v44,v44,s36,v17
v_mfma_f32_16x16x32_bf16 a[52:55],a[244:247],v[124:127],a[52:55]
s_waitcnt lgkmcnt(7)
ds_read_b64_tr_b16 a[244:245],v4 offset:24704
ds_read_b64_tr_b16 a[246:247],v4 offset:30848
v_mfma_f32_16x16x32_bf16 v[168:171],a[248:251],v[112:115],v[168:171]
ds_read_b128 a[212:215],v2 offset:12544
v_fma_f32 v45,v45,s36,v17
v_mfma_f32_16x16x32_bf16 v[216:219],a[248:251],v[116:119],v[216:219]
buffer_load_dwordx4 v8,s[8:11],s21 offen offset:1024 lds
v_mfma_f32_16x16x32_bf16 a[8:11],a[248:251],v[120:123],a[8:11]
ds_read_b128 a[216:219],v1 offset:18432
v_fma_f32 v46,v46,s36,v17
v_mfma_f32_16x16x32_bf16 a[56:59],a[248:251],v[124:127],a[56:59]
ds_read_b64_tr_b16 a[248:249],v5 offset:24704
ds_read_b64_tr_b16 a[250:251],v5 offset:30848
v_mfma_f32_16x16x32_bf16 v[172:175],a[252:255],v[112:115],v[172:175]
ds_read_b128 a[220:223],v2 offset:18432
v_fma_f32 v47,v47,s36,v17
v_mfma_f32_16x16x32_bf16 v[220:223],a[252:255],v[116:119],v[220:223]
ds_read_b128 a[224:227],v1 offset:18560
v_fma_f32 v48,v48,s36,v18
v_mfma_f32_16x16x32_bf16 a[12:15],a[252:255],v[120:123],a[12:15]
ds_read_b128 a[228:231],v2 offset:18560
v_fma_f32 v49,v49,s36,v18
v_mfma_f32_16x16x32_bf16 a[60:63],a[252:255],v[124:127],a[60:63]
s_waitcnt lgkmcnt(7)
ds_read_b64_tr_b16 a[252:253],v6 offset:24704
ds_read_b64_tr_b16 a[254:255],v6 offset:30848
v_mfma_f32_16x16x32_bf16 v[176:179],a[240:243],v[112:115],v[176:179]
ds_read_b128 a[232:235],v1 offset:18688
v_fma_f32 v50,v50,s36,v18
v_mfma_f32_16x16x32_bf16 v[224:227],a[240:243],v[116:119],v[224:227]
buffer_load_dwordx4 v9,s[8:11],s21 offen offset:2048 lds
v_mfma_f32_16x16x32_bf16 a[16:19],a[240:243],v[120:123],a[16:19]
s_add_u32 s21,s21,12288
ds_read_b128 a[236:239],v2 offset:18688
v_fma_f32 v51,v51,s36,v18
v_mfma_f32_16x16x32_bf16 a[64:67],a[240:243],v[124:127],a[64:67]
s_add_u32 m0,s22,0
ds_read_b64_tr_b16 a[240:241],v3 offset:24832
ds_read_b64_tr_b16 a[242:243],v3 offset:30976
v_mfma_f32_16x16x32_bf16 v[180:183],a[244:247],v[112:115],v[180:183]
v_fma_f32 v52,v52,s36,v18
v_fma_f32 v53,v53,s36,v18
v_mfma_f32_16x16x32_bf16 v[228:231],a[244:247],v[116:119],v[228:231]
v_fma_f32 v54,v54,s36,v18
v_fma_f32 v55,v55,s36,v18
v_mfma_f32_16x16x32_bf16 a[20:23],a[244:247],v[120:123],a[20:23]
v_fma_f32 v56,v56,s36,v19
v_fma_f32 v57,v57,s36,v19
v_mfma_f32_16x16x32_bf16 a[68:71],a[244:247],v[124:127],a[68:71]
s_waitcnt lgkmcnt(4)
ds_read_b64_tr_b16 a[244:245],v4 offset:24832
ds_read_b64_tr_b16 a[246:247],v4 offset:30976
v_mfma_f32_16x16x32_bf16 v[184:187],a[248:251],v[112:115],v[184:187]
buffer_load_dwordx4 v7,s[4:7],s20 offen offset:0 lds
v_mfma_f32_16x16x32_bf16 v[232:235],a[248:251],v[116:119],v[232:235]
v_fma_f32 v58,v58,s36,v19
v_fma_f32 v59,v59,s36,v19
v_mfma_f32_16x16x32_bf16 a[24:27],a[248:251],v[120:123],a[24:27]
v_fma_f32 v60,v60,s36,v19
v_fma_f32 v61,v61,s36,v19
v_mfma_f32_16x16x32_bf16 a[72:75],a[248:251],v[124:127],a[72:75]
ds_read_b64_tr_b16 a[248:249],v5 offset:24832
ds_read_b64_tr_b16 a[250:251],v5 offset:30976
v_mfma_f32_16x16x32_bf16 v[188:191],a[252:255],v[112:115],v[188:191]
v_fma_f32 v62,v62,s36,v19
v_fma_f32 v63,v63,s36,v19
v_mfma_f32_16x16x32_bf16 v[236:239],a[252:255],v[116:119],v[236:239]
v_exp_f32 v36,v36
v_mfma_f32_16x16x32_bf16 a[28:31],a[252:255],v[120:123],a[28:31]
v_exp_f32 v37,v37
v_mfma_f32_16x16x32_bf16 a[76:79],a[252:255],v[124:127],a[76:79]
s_waitcnt lgkmcnt(2)
ds_read_b64_tr_b16 a[252:253],v6 offset:24832
ds_read_b64_tr_b16 a[254:255],v6 offset:30976
v_mfma_f32_16x16x32_bf16 v[192:195],a[240:243],v[112:115],v[192:195]
buffer_load_dwordx4 v8,s[4:7],s20 offen offset:1024 lds
v_mfma_f32_16x16x32_bf16 v[240:243],a[240:243],v[116:119],v[240:243]
v_exp_f32 v38,v38
v_mfma_f32_16x16x32_bf16 a[32:35],a[240:243],v[120:123],a[32:35]
v_exp_f32 v39,v39
v_mfma_f32_16x16x32_bf16 a[80:83],a[240:243],v[124:127],a[80:83]
v_exp_f32 v44,v44
v_mfma_f32_16x16x32_bf16 v[196:199],a[244:247],v[112:115],v[196:199]
v_exp_f32 v45,v45
v_mfma_f32_16x16x32_bf16 v[244:247],a[244:247],v[116:119],v[244:247]
v_exp_f32 v46,v46
v_mfma_f32_16x16x32_bf16 a[36:39],a[244:247],v[120:123],a[36:39]
v_exp_f32 v47,v47
v_mfma_f32_16x16x32_bf16 a[84:87],a[244:247],v[124:127],a[84:87]
s_waitcnt lgkmcnt(0)
v_exp_f32 v48,v48
v_mfma_f32_16x16x32_bf16 v[200:203],a[248:251],v[112:115],v[200:203]
buffer_load_dwordx4 v9,s[4:7],s20 offen offset:2048 lds
v_mfma_f32_16x16x32_bf16 v[248:251],a[248:251],v[116:119],v[248:251]
s_add_u32 s20,s20,12288
v_exp_f32 v49,v49
v_mfma_f32_16x16x32_bf16 a[40:43],a[248:251],v[120:123],a[40:43]
s_add_u32 m0,s29,0
v_exp_f32 v50,v50
v_mfma_f32_16x16x32_bf16 a[88:91],a[248:251],v[124:127],a[88:91]
v_exp_f32 v51,v51
v_mfma_f32_16x16x32_bf16 v[204:207],a[252:255],v[112:115],v[204:207]
v_exp_f32 v52,v52
v_mfma_f32_16x16x32_bf16 v[252:255],a[252:255],v[116:119],v[252:255]
v_exp_f32 v53,v53
v_mfma_f32_16x16x32_bf16 a[44:47],a[252:255],v[120:123],a[44:47]
v_exp_f32 v54,v54
v_mfma_f32_16x16x32_bf16 a[92:95],a[252:255],v[124:127],a[92:95]
v_exp_f32 v55,v55
v_mfma_f32_16x16x32_bf16 v[64:67],a[192:195],a[96:99],0
v_exp_f32 v56,v56
v_mfma_f32_16x16x32_bf16 v[64:67],a[196:199],a[100:103],v[64:67]
v_exp_f32 v57,v57
v_mfma_f32_16x16x32_bf16 v[64:67],a[200:203],a[104:107],v[64:67]
v_exp_f32 v58,v58
v_mfma_f32_16x16x32_bf16 v[64:67],a[204:207],a[108:111],v[64:67]
v_exp_f32 v59,v59
v_mfma_f32_16x16x32_bf16 v[64:67],a[208:211],a[112:115],v[64:67]
v_exp_f32 v60,v60
v_mfma_f32_16x16x32_bf16 v[64:67],a[212:215],a[116:119],v[64:67]
buffer_load_dwordx4 v7,s[12:15],s28 offen offset:0 nt lds
v_mfma_f32_16x16x32_bf16 v[72:75],a[192:195],a[120:123],0
v_exp_f32 v61,v61
v_mfma_f32_16x16x32_bf16 v[72:75],a[196:199],a[124:127],v[72:75]
v_exp_f32 v62,v62
v_mfma_f32_16x16x32_bf16 v[72:75],a[200:203],a[128:131],v[72:75]
v_exp_f32 v63,v63
v_mfma_f32_16x16x32_bf16 v[72:75],a[204:207],a[132:135],v[72:75]
v_cvt_pk_bf16_f32 v98,v36,v37
v_cvt_pk_bf16_f32 v99,v38,v39
v_mfma_f32_16x16x32_bf16 v[72:75],a[208:211],a[136:139],v[72:75]
v_cvt_pk_bf16_f32 v102,v44,v45
v_cvt_pk_bf16_f32 v103,v46,v47
v_mfma_f32_16x16x32_bf16 v[128:131],v[24:27],v[96:99],v[128:131]
v_cvt_pk_bf16_f32 v104,v48,v49
v_cvt_pk_bf16_f32 v105,v50,v51
v_mfma_f32_16x16x32_bf16 v[132:135],v[24:27],v[100:103],v[132:135]
v_cvt_pk_bf16_f32 v106,v52,v53
v_cvt_pk_bf16_f32 v107,v54,v55
v_mfma_f32_16x16x32_bf16 v[72:75],a[212:215],a[140:143],v[72:75]
v_cvt_pk_bf16_f32 v108,v56,v57
v_cvt_pk_bf16_f32 v109,v58,v59
v_mfma_f32_16x16x32_bf16 v[136:139],v[24:27],v[104:107],v[136:139]
v_cvt_pk_bf16_f32 v110,v60,v61
v_cvt_pk_bf16_f32 v111,v62,v63
v_mfma_f32_16x16x32_bf16 v[80:83],a[192:195],a[144:147],0
v_fma_f32 v64,v64,s36,v16
v_fma_f32 v65,v65,s36,v16
v_mfma_f32_16x16x32_bf16 v[140:143],v[24:27],v[108:111],v[140:143]
buffer_load_dwordx4 v8,s[12:15],s28 offen offset:1024 nt lds
v_mfma_f32_16x16x32_bf16 v[80:83],a[196:199],a[148:151],v[80:83]
v_fma_f32 v66,v66,s36,v16
v_fma_f32 v67,v67,s36,v16
v_mfma_f32_16x16x32_bf16 v[80:83],a[200:203],a[152:155],v[80:83]
v_fma_f32 v72,v72,s36,v17
v_fma_f32 v73,v73,s36,v17
v_mfma_f32_16x16x32_bf16 v[80:83],a[204:207],a[156:159],v[80:83]
v_fma_f32 v74,v74,s36,v17
v_fma_f32 v75,v75,s36,v17
v_mfma_f32_16x16x32_bf16 v[80:83],a[208:211],a[160:163],v[80:83]
v_exp_f32 v64,v64
v_mfma_f32_16x16x32_bf16 v[80:83],a[212:215],a[164:167],v[80:83]
v_exp_f32 v65,v65
v_mfma_f32_16x16x32_bf16 v[88:91],a[192:195],a[168:171],0
v_exp_f32 v66,v66
v_mfma_f32_16x16x32_bf16 v[88:91],a[196:199],a[172:175],v[88:91]
v_exp_f32 v67,v67
v_mfma_f32_16x16x32_bf16 v[88:91],a[200:203],a[176:179],v[88:91]
v_exp_f32 v72,v72
v_mfma_f32_16x16x32_bf16 v[88:91],a[204:207],a[180:183],v[88:91]
v_exp_f32 v73,v73
v_mfma_f32_16x16x32_bf16 v[88:91],a[208:211],a[184:187],v[88:91]
v_exp_f32 v74,v74
v_mfma_f32_16x16x32_bf16 v[88:91],a[212:215],a[188:191],v[88:91]
v_exp_f32 v75,v75
v_mfma_f32_16x16x32_bf16 v[68:71],a[216:219],a[96:99],0
buffer_load_dwordx4 v9,s[12:15],s28 offen offset:2048 nt lds
v_mfma_f32_16x16x32_bf16 v[68:71],a[220:223],a[100:103],v[68:71]
s_add_u32 s28,s28,3072
v_cvt_pk_bf16_f32 v112,v64,v65
v_cvt_pk_bf16_f32 v113,v66,v67
v_mfma_f32_16x16x32_bf16 v[68:71],a[224:227],a[104:107],v[68:71]
s_add_u32 s29,s29,3072
v_cvt_pk_bf16_f32 v116,v72,v73
v_cvt_pk_bf16_f32 v117,v74,v75
v_mfma_f32_16x16x32_bf16 v[68:71],a[228:231],a[108:111],v[68:71]
v_mfma_f32_16x16x32_bf16 v[68:71],a[232:235],a[112:115],v[68:71]
v_mfma_f32_16x16x32_bf16 v[68:71],a[236:239],a[116:119],v[68:71]
v_mfma_f32_16x16x32_bf16 v[76:79],a[216:219],a[120:123],0
v_mfma_f32_16x16x32_bf16 v[76:79],a[220:223],a[124:127],v[76:79]
v_mfma_f32_16x16x32_bf16 v[76:79],a[224:227],a[128:131],v[76:79]
v_mfma_f32_16x16x32_bf16 v[76:79],a[228:231],a[132:135],v[76:79]
s_waitcnt vmcnt(12)
s_barrier
v_mfma_f32_16x16x32_bf16 v[76:79],a[232:235],a[136:139],v[76:79]
v_mfma_f32_16x16x32_bf16 v[76:79],a[236:239],a[140:143],v[76:79]
ds_read_b64_tr_b16 a[240:241],v3 offset:0
ds_read_b64_tr_b16 a[242:243],v3 offset:6144
v_mfma_f32_16x16x32_bf16 v[84:87],a[216:219],a[144:147],0
v_mfma_f32_16x16x32_bf16 v[84:87],a[220:223],a[148:151],v[84:87]
ds_read_b64_tr_b16 a[244:245],v4 offset:0
ds_read_b64_tr_b16 a[246:247],v4 offset:6144
v_mfma_f32_16x16x32_bf16 v[84:87],a[224:227],a[152:155],v[84:87]
v_mfma_f32_16x16x32_bf16 v[84:87],a[228:231],a[156:159],v[84:87]
ds_read_b64_tr_b16 a[248:249],v5 offset:0
ds_read_b64_tr_b16 a[250:251],v5 offset:6144
v_mfma_f32_16x16x32_bf16 v[84:87],a[232:235],a[160:163],v[84:87]
v_mfma_f32_16x16x32_bf16 v[84:87],a[236:239],a[164:167],v[84:87]
ds_read_b64_tr_b16 a[252:253],v6 offset:0
ds_read_b64_tr_b16 a[254:255],v6 offset:6144
v_mfma_f32_16x16x32_bf16 v[92:95],a[216:219],a[168:171],0
v_mfma_f32_16x16x32_bf16 v[92:95],a[220:223],a[172:175],v[92:95]
v_mfma_f32_16x16x32_bf16 v[92:95],a[224:227],a[176:179],v[92:95]
v_mfma_f32_16x16x32_bf16 v[92:95],a[228:231],a[180:183],v[92:95]
v_mfma_f32_16x16x32_bf16 v[92:95],a[232:235],a[184:187],v[92:95]
v_mfma_f32_16x16x32_bf16 v[92:95],a[236:239],a[188:191],v[92:95]
s_waitcnt lgkmcnt(4)
v_mfma_f32_16x16x32_bf16 v[160:163],a[240:243],v[96:99],v[160:163]
s_add_u32 m0,s23,24576
ds_read_b128 a[192:195],v1 offset:24576
v_fma_f32 v68,v68,s36,v16
v_mfma_f32_16x16x32_bf16 v[208:211],a[240:243],v[100:103],v[208:211]
buffer_load_dwordx4 v7,s[8:11],s21 offen offset:0 lds
v_mfma_f32_16x16x32_bf16 a[0:3],a[240:243],v[104:107],a[0:3]
ds_read_b128 a[196:199],v2 offset:24576
v_fma_f32 v69,v69,s36,v16
v_mfma_f32_16x16x32_bf16 a[48:51],a[240:243],v[108:111],a[48:51]
ds_read_b64_tr_b16 a[240:241],v3 offset:128
ds_read_b64_tr_b16 a[242:243],v3 offset:6272
v_mfma_f32_16x16x32_bf16 v[164:167],a[244:247],v[96:99],v[164:167]
ds_read_b128 a[200:203],v1 offset:24704
v_fma_f32 v70,v70,s36,v16
v_mfma_f32_16x16x32_bf16 v[212:215],a[244:247],v[100:103],v[212:215]
ds_read_b128 a[204:207],v2 offset:24704
v_fma_f32 v71,v71,s36,v16
v_mfma_f32_16x16x32_bf16 a[4:7],a[244:247],v[104:107],a[4:7]
ds_read_b128 a[208:211],v1 offset:24832
v_fma_f32 v76,v76,s36,v17
v_mfma_f32_16x16x32_bf16 a[52:55],a[244:247],v[108:111],a[52:55]
s_waitcnt lgkmcnt(7)
ds_read_b64_tr_b16 a[244:245],v4 offset:128
ds_read_b64_tr_b16 a[246:247],v4 offset:6272
v_mfma_f32_16x16x32_bf16 v[168:171],a[248:251],v[96:99],v[168:171]
ds_read_b128 a[212:215],v2 offset:24832
v_fma_f32 v77,v77,s36,v17
v_mfma_f32_16x16x32_bf16 v[216:219],a[248:251],v[100:103],v[216:219]
buffer_load_dwordx4 v8,s[8:11],s21 offen offset:1024 lds
v_mfma_f32_16x16x32_bf16 a[8:11],a[248:251],v[104:107],a[8:11]
ds_read_b128 a[216:219],v1 offset:30720
v_fma_f32 v78,v78,s36,v17
v_mfma_f32_16x16x32_bf16 a[56:59],a[248:251],v[108:111],a[56:59]
ds_read_b64_tr_b16 a[248:249],v5 offset:128
ds_read_b64_tr_b16 a[250:251],v5 offset:6272
v_mfma_f32_16x16x32_bf16 v[172:175],a[252:255],v[96:99],v[172:175]
ds_read_b128 a[220:223],v2 offset:30720
v_fma_f32 v79,v79,s36,v17
v_mfma_f32_16x16x32_bf16 v[220:223],a[252:255],v[100:103],v[220:223]
ds_read_b128 a[224:227],v1 offset:30848
v_fma_f32 v80,v80,s36,v18
v_mfma_f32_16x16x32_bf16 a[12:15],a[252:255],v[104:107],a[12:15]
ds_read_b128 a[228:231],v2 offset:30848
v_fma_f32 v81,v81,s36,v18
v_mfma_f32_16x16x32_bf16 a[60:63],a[252:255],v[108:111],a[60:63]
s_waitcnt lgkmcnt(7)
ds_read_b64_tr_b16 a[252:253],v6 offset:128
ds_read_b64_tr_b16 a[254:255],v6 offset:6272
v_mfma_f32_16x16x32_bf16 v[176:179],a[240:243],v[96:99],v[176:179]
ds_read_b128 a[232:235],v1 offset:30976
v_fma_f32 v82,v82,s36,v18
v_mfma_f32_16x16x32_bf16 v[224:227],a[240:243],v[100:103],v[224:227]
buffer_load_dwordx4 v9,s[8:11],s21 offen offset:2048 lds
v_mfma_f32_16x16x32_bf16 a[16:19],a[240:243],v[104:107],a[16:19]
s_add_u32 s21,s21,12288
ds_read_b128 a[236:239],v2 offset:30976
v_fma_f32 v83,v83,s36,v18
v_mfma_f32_16x16x32_bf16 a[64:67],a[240:243],v[108:111],a[64:67]
s_mov_b32 m0,s25
ds_read_b64_tr_b16 a[240:241],v3 offset:256
ds_read_b64_tr_b16 a[242:243],v3 offset:6400
v_mfma_f32_16x16x32_bf16 v[180:183],a[244:247],v[96:99],v[180:183]
v_fma_f32 v84,v84,s36,v18
v_fma_f32 v85,v85,s36,v18
v_mfma_f32_16x16x32_bf16 v[228:231],a[244:247],v[100:103],v[228:231]
v_fma_f32 v86,v86,s36,v18
v_fma_f32 v87,v87,s36,v18
v_mfma_f32_16x16x32_bf16 a[20:23],a[244:247],v[104:107],a[20:23]
v_fma_f32 v88,v88,s36,v19
v_fma_f32 v89,v89,s36,v19
v_mfma_f32_16x16x32_bf16 a[68:71],a[244:247],v[108:111],a[68:71]
s_waitcnt lgkmcnt(4)
ds_read_b64_tr_b16 a[244:245],v4 offset:256
ds_read_b64_tr_b16 a[246:247],v4 offset:6400
v_mfma_f32_16x16x32_bf16 v[184:187],a[248:251],v[96:99],v[184:187]
buffer_load_dwordx4 v7,s[4:7],s20 offen offset:0 lds
v_mfma_f32_16x16x32_bf16 v[232:235],a[248:251],v[100:103],v[232:235]
v_fma_f32 v90,v90,s36,v19
v_fma_f32 v91,v91,s36,v19
v_mfma_f32_16x16x32_bf16 a[24:27],a[248:251],v[104:107],a[24:27]
v_fma_f32 v92,v92,s36,v19
v_fma_f32 v93,v93,s36,v19
v_mfma_f32_16x16x32_bf16 a[72:75],a[248:251],v[108:111],a[72:75]
ds_read_b64_tr_b16 a[248:249],v5 offset:256
ds_read_b64_tr_b16 a[250:251],v5 offset:6400
v_mfma_f32_16x16x32_bf16 v[188:191],a[252:255],v[96:99],v[188:191]
v_fma_f32 v94,v94,s36,v19
v_fma_f32 v95,v95,s36,v19
v_mfma_f32_16x16x32_bf16 v[236:239],a[252:255],v[100:103],v[236:239]
v_exp_f32 v68,v68
v_mfma_f32_16x16x32_bf16 a[28:31],a[252:255],v[104:107],a[28:31]
v_exp_f32 v69,v69
v_mfma_f32_16x16x32_bf16 a[76:79],a[252:255],v[108:111],a[76:79]
s_waitcnt lgkmcnt(2)
ds_read_b64_tr_b16 a[252:253],v6 offset:256
ds_read_b64_tr_b16 a[254:255],v6 offset:6400
v_mfma_f32_16x16x32_bf16 v[192:195],a[240:243],v[96:99],v[192:195]
buffer_load_dwordx4 v8,s[4:7],s20 offen offset:1024 lds
v_mfma_f32_16x16x32_bf16 v[240:243],a[240:243],v[100:103],v[240:243]
v_exp_f32 v70,v70
v_mfma_f32_16x16x32_bf16 a[32:35],a[240:243],v[104:107],a[32:35]
v_exp_f32 v71,v71
v_mfma_f32_16x16x32_bf16 a[80:83],a[240:243],v[108:111],a[80:83]
v_exp_f32 v76,v76
v_mfma_f32_16x16x32_bf16 v[196:199],a[244:247],v[96:99],v[196:199]
v_exp_f32 v77,v77
v_mfma_f32_16x16x32_bf16 v[244:247],a[244:247],v[100:103],v[244:247]
ds_read_b128 v[152:155],v11 offset:6144
v_cvt_pk_bf16_f32 v114,v68,v69
v_mfma_f32_16x16x32_bf16 a[36:39],a[244:247],v[104:107],a[36:39]
v_exp_f32 v78,v78
v_mfma_f32_16x16x32_bf16 a[84:87],a[244:247],v[108:111],a[84:87]
s_waitcnt lgkmcnt(1)
v_exp_f32 v79,v79
v_mfma_f32_16x16x32_bf16 v[200:203],a[248:251],v[96:99],v[200:203]
buffer_load_dwordx4 v9,s[4:7],s20 offen offset:2048 lds
v_mfma_f32_16x16x32_bf16 v[248:251],a[248:251],v[100:103],v[248:251]
s_add_u32 s20,s20,12288
v_exp_f32 v80,v80
v_mfma_f32_16x16x32_bf16 a[40:43],a[248:251],v[104:107],a[40:43]
v_exp_f32 v81,v81
v_mfma_f32_16x16x32_bf16 a[88:91],a[248:251],v[108:111],a[88:91]
v_exp_f32 v82,v82
v_mfma_f32_16x16x32_bf16 v[204:207],a[252:255],v[96:99],v[204:207]
v_exp_f32 v83,v83
v_mfma_f32_16x16x32_bf16 v[252:255],a[252:255],v[100:103],v[252:255]
v_exp_f32 v84,v84
v_mfma_f32_16x16x32_bf16 a[44:47],a[252:255],v[104:107],a[44:47]
v_exp_f32 v85,v85
v_mfma_f32_16x16x32_bf16 a[92:95],a[252:255],v[108:111],a[92:95]
v_exp_f32 v86,v86
v_mfma_f32_16x16x32_bf16 v[32:35],a[192:195],a[96:99],0
ds_read_b128 v[156:159],v23 offset:6144
v_mfma_f32_16x16x32_bf16 v[32:35],a[196:199],a[100:103],v[32:35]
v_exp_f32 v87,v87
v_mfma_f32_16x16x32_bf16 v[32:35],a[200:203],a[104:107],v[32:35]
v_exp_f32 v88,v88
v_mfma_f32_16x16x32_bf16 v[32:35],a[204:207],a[108:111],v[32:35]
v_exp_f32 v89,v89
v_mfma_f32_16x16x32_bf16 v[32:35],a[208:211],a[112:115],v[32:35]
v_exp_f32 v90,v90
v_mfma_f32_16x16x32_bf16 v[32:35],a[212:215],a[116:119],v[32:35]
s_waitcnt lgkmcnt(1)
buffer_store_dwordx4 v[152:155],v0,s[16:19],s27 offen offset:0 nt
v_mfma_f32_16x16x32_bf16 v[40:43],a[192:195],a[120:123],0
v_exp_f32 v91,v91
v_mfma_f32_16x16x32_bf16 v[40:43],a[196:199],a[124:127],v[40:43]
v_exp_f32 v92,v92
v_mfma_f32_16x16x32_bf16 v[40:43],a[200:203],a[128:131],v[40:43]
v_exp_f32 v93,v93
v_mfma_f32_16x16x32_bf16 v[40:43],a[204:207],a[132:135],v[40:43]
v_exp_f32 v94,v94
v_mfma_f32_16x16x32_bf16 v[40:43],a[208:211],a[136:139],v[40:43]
v_exp_f32 v95,v95
v_mfma_f32_16x16x32_bf16 v[40:43],a[212:215],a[140:143],v[40:43]
v_cvt_pk_bf16_f32 v115,v70,v71
v_cvt_pk_bf16_f32 v118,v76,v77
v_mfma_f32_16x16x32_bf16 v[48:51],a[192:195],a[144:147],0
ds_read_b128 v[152:155],v31 offset:6144
v_cvt_pk_bf16_f32 v119,v78,v79
v_mfma_f32_16x16x32_bf16 v[128:131],v[24:27],v[112:115],v[128:131]
v_cvt_pk_bf16_f32 v120,v80,v81
v_cvt_pk_bf16_f32 v121,v82,v83
v_mfma_f32_16x16x32_bf16 v[132:135],v[24:27],v[116:119],v[132:135]
v_cvt_pk_bf16_f32 v122,v84,v85
v_cvt_pk_bf16_f32 v123,v86,v87
v_mfma_f32_16x16x32_bf16 v[48:51],a[196:199],a[148:151],v[48:51]
v_cvt_pk_bf16_f32 v124,v88,v89
v_cvt_pk_bf16_f32 v125,v90,v91
v_mfma_f32_16x16x32_bf16 v[136:139],v[24:27],v[120:123],v[136:139]
s_waitcnt lgkmcnt(1)
buffer_store_dwordx4 v[156:159],v0,s[16:19],s27 offen offset:1024 nt
v_mfma_f32_16x16x32_bf16 v[48:51],a[200:203],a[152:155],v[48:51]
v_cvt_pk_bf16_f32 v126,v92,v93
v_cvt_pk_bf16_f32 v127,v94,v95
v_mfma_f32_16x16x32_bf16 v[48:51],a[204:207],a[156:159],v[48:51]
v_fma_f32 v32,v32,s36,v16
v_fma_f32 v33,v33,s36,v16
v_mfma_f32_16x16x32_bf16 v[140:143],v[24:27],v[124:127],v[140:143]
v_fma_f32 v34,v34,s36,v16
v_fma_f32 v35,v35,s36,v16
v_mfma_f32_16x16x32_bf16 v[48:51],a[208:211],a[160:163],v[48:51]
v_fma_f32 v40,v40,s36,v17
v_fma_f32 v41,v41,s36,v17
v_mfma_f32_16x16x32_bf16 v[48:51],a[212:215],a[164:167],v[48:51]
v_fma_f32 v42,v42,s36,v17
v_fma_f32 v43,v43,s36,v17
v_mfma_f32_16x16x32_bf16 v[56:59],a[192:195],a[168:171],0
v_exp_f32 v32,v32
v_mfma_f32_16x16x32_bf16 v[56:59],a[196:199],a[172:175],v[56:59]
v_exp_f32 v33,v33
v_mfma_f32_16x16x32_bf16 v[56:59],a[200:203],a[176:179],v[56:59]
v_exp_f32 v34,v34
v_mfma_f32_16x16x32_bf16 v[56:59],a[204:207],a[180:183],v[56:59]
v_exp_f32 v35,v35
v_mfma_f32_16x16x32_bf16 v[56:59],a[208:211],a[184:187],v[56:59]
v_exp_f32 v40,v40
v_mfma_f32_16x16x32_bf16 v[56:59],a[212:215],a[188:191],v[56:59]
v_exp_f32 v41,v41
v_mfma_f32_16x16x32_bf16 v[36:39],a[216:219],a[96:99],0
s_waitcnt lgkmcnt(0)
buffer_store_dwordx4 v[152:155],v0,s[16:19],s27 offen offset:2048 nt
v_mfma_f32_16x16x32_bf16 v[36:39],a[220:223],a[100:103],v[36:39]
s_add_u32 s27,s27,3072
v_exp_f32 v42,v42
v_mfma_f32_16x16x32_bf16 v[36:39],a[224:227],a[104:107],v[36:39]
v_exp_f32 v43,v43
v_mfma_f32_16x16x32_bf16 v[36:39],a[228:231],a[108:111],v[36:39]
v_cvt_pk_bf16_f32 v96,v32,v33
v_cvt_pk_bf16_f32 v97,v34,v35
v_mfma_f32_16x16x32_bf16 v[36:39],a[232:235],a[112:115],v[36:39]
v_cvt_pk_bf16_f32 v100,v40,v41
v_cvt_pk_bf16_f32 v101,v42,v43
v_mfma_f32_16x16x32_bf16 v[36:39],a[236:239],a[116:119],v[36:39]
v_mfma_f32_16x16x32_bf16 v[44:47],a[216:219],a[120:123],0
v_mfma_f32_16x16x32_bf16 v[44:47],a[220:223],a[124:127],v[44:47]
v_mfma_f32_16x16x32_bf16 v[44:47],a[224:227],a[128:131],v[44:47]
v_mfma_f32_16x16x32_bf16 v[44:47],a[228:231],a[132:135],v[44:47]
s_waitcnt vmcnt(12)
s_barrier
v_mfma_f32_16x16x32_bf16 v[44:47],a[232:235],a[136:139],v[44:47]
v_mfma_f32_16x16x32_bf16 v[44:47],a[236:239],a[140:143],v[44:47]
ds_read_b64_tr_b16 a[240:241],v3 offset:12288
ds_read_b64_tr_b16 a[242:243],v3 offset:18432
v_mfma_f32_16x16x32_bf16 v[52:55],a[216:219],a[144:147],0
v_mfma_f32_16x16x32_bf16 v[52:55],a[220:223],a[148:151],v[52:55]
ds_read_b64_tr_b16 a[244:245],v4 offset:12288
ds_read_b64_tr_b16 a[246:247],v4 offset:18432
v_mfma_f32_16x16x32_bf16 v[52:55],a[224:227],a[152:155],v[52:55]
v_mfma_f32_16x16x32_bf16 v[52:55],a[228:231],a[156:159],v[52:55]
ds_read_b64_tr_b16 a[248:249],v5 offset:12288
ds_read_b64_tr_b16 a[250:251],v5 offset:18432
v_mfma_f32_16x16x32_bf16 v[52:55],a[232:235],a[160:163],v[52:55]
v_mfma_f32_16x16x32_bf16 v[52:55],a[236:239],a[164:167],v[52:55]
ds_read_b64_tr_b16 a[252:253],v6 offset:12288
ds_read_b64_tr_b16 a[254:255],v6 offset:18432
v_mfma_f32_16x16x32_bf16 v[60:63],a[216:219],a[168:171],0
v_mfma_f32_16x16x32_bf16 v[60:63],a[220:223],a[172:175],v[60:63]
v_mfma_f32_16x16x32_bf16 v[60:63],a[224:227],a[176:179],v[60:63]
v_mfma_f32_16x16x32_bf16 v[60:63],a[228:231],a[180:183],v[60:63]
v_mfma_f32_16x16x32_bf16 v[60:63],a[232:235],a[184:187],v[60:63]
v_mfma_f32_16x16x32_bf16 v[60:63],a[236:239],a[188:191],v[60:63]
s_waitcnt lgkmcnt(4)
v_mfma_f32_16x16x32_bf16 v[160:163],a[240:243],v[112:115],v[160:163]
s_add_u32 m0,s23,0
ds_read_b128 a[192:195],v1 offset:0
v_fma_f32 v36,v36,s36,v16
v_mfma_f32_16x16x32_bf16 v[208:211],a[240:243],v[116:119],v[208:211]
buffer_load_dwordx4 v7,s[8:11],s21 offen offset:0 lds
v_mfma_f32_16x16x32_bf16 a[0:3],a[240:243],v[120:123],a[0:3]
ds_read_b128 a[196:199],v2 offset:0
v_fma_f32 v37,v37,s36,v16
v_mfma_f32_16x16x32_bf16 a[48:51],a[240:243],v[124:127],a[48:51]
ds_read_b64_tr_b16 a[240:241],v3 offset:12416
ds_read_b64_tr_b16 a[242:243],v3 offset:18560
v_mfma_f32_16x16x32_bf16 v[164:167],a[244:247],v[112:115],v[164:167]
ds_read_b128 a[200:203],v1 offset:128
v_fma_f32 v38,v38,s36,v16
v_mfma_f32_16x16x32_bf16 v[212:215],a[244:247],v[116:119],v[212:215]
ds_read_b128 a[204:207],v2 offset:128
v_fma_f32 v39,v39,s36,v16
v_mfma_f32_16x16x32_bf16 a[4:7],a[244:247],v[120:123],a[4:7]
ds_read_b128 a[208:211],v1 offset:256
v_fma_f32 v44,v44,s36,v17
v_mfma_f32_16x16x32_bf16 a[52:55],a[244:247],v[124:127],a[52:55]
s_waitcnt lgkmcnt(7)
ds_read_b64_tr_b16 a[244:245],v4 offset:12416
ds_read_b64_tr_b16 a[246:247],v4 offset:18560
v_mfma_f32_16x16x32_bf16 v[168:171],a[248:251],v[112:115],v[168:171]
ds_read_b128 a[212:215],v2 offset:256
v_fma_f32 v45,v45,s36,v17
v_mfma_f32_16x16x32_bf16 v[216:219],a[248:251],v[116:119],v[216:219]
buffer_load_dwordx4 v8,s[8:11],s21 offen offset:1024 lds
v_mfma_f32_16x16x32_bf16 a[8:11],a[248:251],v[120:123],a[8:11]
ds_read_b128 a[216:219],v1 offset:6144
v_fma_f32 v46,v46,s36,v17
v_mfma_f32_16x16x32_bf16 a[56:59],a[248:251],v[124:127],a[56:59]
ds_read_b64_tr_b16 a[248:249],v5 offset:12416
ds_read_b64_tr_b16 a[250:251],v5 offset:18560
v_mfma_f32_16x16x32_bf16 v[172:175],a[252:255],v[112:115],v[172:175]
ds_read_b128 a[220:223],v2 offset:6144
v_fma_f32 v47,v47,s36,v17
v_mfma_f32_16x16x32_bf16 v[220:223],a[252:255],v[116:119],v[220:223]
ds_read_b128 a[224:227],v1 offset:6272
v_fma_f32 v48,v48,s36,v18
v_mfma_f32_16x16x32_bf16 a[12:15],a[252:255],v[120:123],a[12:15]
ds_read_b128 a[228:231],v2 offset:6272
v_fma_f32 v49,v49,s36,v18
v_mfma_f32_16x16x32_bf16 a[60:63],a[252:255],v[124:127],a[60:63]
s_waitcnt lgkmcnt(7)
ds_read_b64_tr_b16 a[252:253],v6 offset:12416
ds_read_b64_tr_b16 a[254:255],v6 offset:18560
v_mfma_f32_16x16x32_bf16 v[176:179],a[240:243],v[112:115],v[176:179]
ds_read_b128 a[232:235],v1 offset:6400
v_fma_f32 v50,v50,s36,v18
v_mfma_f32_16x16x32_bf16 v[224:227],a[240:243],v[116:119],v[224:227]
buffer_load_dwordx4 v9,s[8:11],s21 offen offset:2048 lds
v_mfma_f32_16x16x32_bf16 a[16:19],a[240:243],v[120:123],a[16:19]
s_add_u32 s21,s21,12288
ds_read_b128 a[236:239],v2 offset:6400
v_fma_f32 v51,v51,s36,v18
v_mfma_f32_16x16x32_bf16 a[64:67],a[240:243],v[124:127],a[64:67]
s_mov_b32 m0,s26
ds_read_b64_tr_b16 a[240:241],v3 offset:12544
ds_read_b64_tr_b16 a[242:243],v3 offset:18688
v_mfma_f32_16x16x32_bf16 v[180:183],a[244:247],v[112:115],v[180:183]
v_fma_f32 v52,v52,s36,v18
v_fma_f32 v53,v53,s36,v18
v_mfma_f32_16x16x32_bf16 v[228:231],a[244:247],v[116:119],v[228:231]
v_fma_f32 v54,v54,s36,v18
v_fma_f32 v55,v55,s36,v18
v_mfma_f32_16x16x32_bf16 a[20:23],a[244:247],v[120:123],a[20:23]
v_fma_f32 v56,v56,s36,v19
v_fma_f32 v57,v57,s36,v19
v_mfma_f32_16x16x32_bf16 a[68:71],a[244:247],v[124:127],a[68:71]
s_waitcnt lgkmcnt(4)
ds_read_b64_tr_b16 a[244:245],v4 offset:12544
ds_read_b64_tr_b16 a[246:247],v4 offset:18688
v_mfma_f32_16x16x32_bf16 v[184:187],a[248:251],v[112:115],v[184:187]
buffer_load_dwordx4 v7,s[4:7],s20 offen offset:0 lds
v_mfma_f32_16x16x32_bf16 v[232:235],a[248:251],v[116:119],v[232:235]
v_fma_f32 v58,v58,s36,v19
v_fma_f32 v59,v59,s36,v19
v_mfma_f32_16x16x32_bf16 a[24:27],a[248:251],v[120:123],a[24:27]
v_fma_f32 v60,v60,s36,v19
v_fma_f32 v61,v61,s36,v19
v_mfma_f32_16x16x32_bf16 a[72:75],a[248:251],v[124:127],a[72:75]
ds_read_b64_tr_b16 a[248:249],v5 offset:12544
ds_read_b64_tr_b16 a[250:251],v5 offset:18688
v_mfma_f32_16x16x32_bf16 v[188:191],a[252:255],v[112:115],v[188:191]
v_fma_f32 v62,v62,s36,v19
v_fma_f32 v63,v63,s36,v19
v_mfma_f32_16x16x32_bf16 v[236:239],a[252:255],v[116:119],v[236:239]
v_exp_f32 v36,v36
v_mfma_f32_16x16x32_bf16 a[28:31],a[252:255],v[120:123],a[28:31]
v_exp_f32 v37,v37
v_mfma_f32_16x16x32_bf16 a[76:79],a[252:255],v[124:127],a[76:79]
s_waitcnt lgkmcnt(2)
ds_read_b64_tr_b16 a[252:253],v6 offset:12544
ds_read_b64_tr_b16 a[254:255],v6 offset:18688
v_mfma_f32_16x16x32_bf16 v[192:195],a[240:243],v[112:115],v[192:195]
buffer_load_dwordx4 v8,s[4:7],s20 offen offset:1024 lds
v_mfma_f32_16x16x32_bf16 v[240:243],a[240:243],v[116:119],v[240:243]
v_exp_f32 v38,v38
v_mfma_f32_16x16x32_bf16 a[32:35],a[240:243],v[120:123],a[32:35]
v_exp_f32 v39,v39
v_mfma_f32_16x16x32_bf16 a[80:83],a[240:243],v[124:127],a[80:83]
v_exp_f32 v44,v44
v_mfma_f32_16x16x32_bf16 v[196:199],a[244:247],v[112:115],v[196:199]
v_exp_f32 v45,v45
v_mfma_f32_16x16x32_bf16 v[244:247],a[244:247],v[116:119],v[244:247]
v_exp_f32 v46,v46
v_mfma_f32_16x16x32_bf16 a[36:39],a[244:247],v[120:123],a[36:39]
v_exp_f32 v47,v47
v_mfma_f32_16x16x32_bf16 a[84:87],a[244:247],v[124:127],a[84:87]
s_waitcnt lgkmcnt(0)
v_exp_f32 v48,v48
v_mfma_f32_16x16x32_bf16 v[200:203],a[248:251],v[112:115],v[200:203]
buffer_load_dwordx4 v9,s[4:7],s20 offen offset:2048 lds
v_mfma_f32_16x16x32_bf16 v[248:251],a[248:251],v[116:119],v[248:251]
s_add_u32 s20,s20,12288
v_exp_f32 v49,v49
v_mfma_f32_16x16x32_bf16 a[40:43],a[248:251],v[120:123],a[40:43]
s_add_u32 m0,s29,0
v_exp_f32 v50,v50
v_mfma_f32_16x16x32_bf16 a[88:91],a[248:251],v[124:127],a[88:91]
v_exp_f32 v51,v51
v_mfma_f32_16x16x32_bf16 v[204:207],a[252:255],v[112:115],v[204:207]
v_exp_f32 v52,v52
v_mfma_f32_16x16x32_bf16 v[252:255],a[252:255],v[116:119],v[252:255]
v_exp_f32 v53,v53
v_mfma_f32_16x16x32_bf16 a[44:47],a[252:255],v[120:123],a[44:47]
v_exp_f32 v54,v54
v_mfma_f32_16x16x32_bf16 a[92:95],a[252:255],v[124:127],a[92:95]
v_exp_f32 v55,v55
v_mfma_f32_16x16x32_bf16 v[64:67],a[192:195],a[96:99],0
v_exp_f32 v56,v56
v_mfma_f32_16x16x32_bf16 v[64:67],a[196:199],a[100:103],v[64:67]
v_exp_f32 v57,v57
v_mfma_f32_16x16x32_bf16 v[64:67],a[200:203],a[104:107],v[64:67]
v_exp_f32 v58,v58
v_mfma_f32_16x16x32_bf16 v[64:67],a[204:207],a[108:111],v[64:67]
v_exp_f32 v59,v59
v_mfma_f32_16x16x32_bf16 v[64:67],a[208:211],a[112:115],v[64:67]
v_exp_f32 v60,v60
v_mfma_f32_16x16x32_bf16 v[64:67],a[212:215],a[116:119],v[64:67]
buffer_load_dwordx4 v7,s[12:15],s28 offen offset:0 nt lds
v_mfma_f32_16x16x32_bf16 v[72:75],a[192:195],a[120:123],0
v_exp_f32 v61,v61
v_mfma_f32_16x16x32_bf16 v[72:75],a[196:199],a[124:127],v[72:75]
v_exp_f32 v62,v62
v_mfma_f32_16x16x32_bf16 v[72:75],a[200:203],a[128:131],v[72:75]
v_exp_f32 v63,v63
v_mfma_f32_16x16x32_bf16 v[72:75],a[204:207],a[132:135],v[72:75]
v_cvt_pk_bf16_f32 v98,v36,v37
v_cvt_pk_bf16_f32 v99,v38,v39
v_mfma_f32_16x16x32_bf16 v[72:75],a[208:211],a[136:139],v[72:75]
v_cvt_pk_bf16_f32 v102,v44,v45
v_cvt_pk_bf16_f32 v103,v46,v47
v_mfma_f32_16x16x32_bf16 v[128:131],v[24:27],v[96:99],v[128:131]
v_cvt_pk_bf16_f32 v104,v48,v49
v_cvt_pk_bf16_f32 v105,v50,v51
v_mfma_f32_16x16x32_bf16 v[132:135],v[24:27],v[100:103],v[132:135]
v_cvt_pk_bf16_f32 v106,v52,v53
v_cvt_pk_bf16_f32 v107,v54,v55
v_mfma_f32_16x16x32_bf16 v[72:75],a[212:215],a[140:143],v[72:75]
v_cvt_pk_bf16_f32 v108,v56,v57
v_cvt_pk_bf16_f32 v109,v58,v59
v_mfma_f32_16x16x32_bf16 v[136:139],v[24:27],v[104:107],v[136:139]
v_cvt_pk_bf16_f32 v110,v60,v61
v_cvt_pk_bf16_f32 v111,v62,v63
v_mfma_f32_16x16x32_bf16 v[80:83],a[192:195],a[144:147],0
v_fma_f32 v64,v64,s36,v16
v_fma_f32 v65,v65,s36,v16
v_mfma_f32_16x16x32_bf16 v[140:143],v[24:27],v[108:111],v[140:143]
buffer_load_dwordx4 v8,s[12:15],s28 offen offset:1024 nt lds
v_mfma_f32_16x16x32_bf16 v[80:83],a[196:199],a[148:151],v[80:83]
v_fma_f32 v66,v66,s36,v16
v_fma_f32 v67,v67,s36,v16
v_mfma_f32_16x16x32_bf16 v[80:83],a[200:203],a[152:155],v[80:83]
v_fma_f32 v72,v72,s36,v17
v_fma_f32 v73,v73,s36,v17
v_mfma_f32_16x16x32_bf16 v[80:83],a[204:207],a[156:159],v[80:83]
v_fma_f32 v74,v74,s36,v17
v_fma_f32 v75,v75,s36,v17
v_mfma_f32_16x16x32_bf16 v[80:83],a[208:211],a[160:163],v[80:83]
v_exp_f32 v64,v64
v_mfma_f32_16x16x32_bf16 v[80:83],a[212:215],a[164:167],v[80:83]
v_exp_f32 v65,v65
v_mfma_f32_16x16x32_bf16 v[88:91],a[192:195],a[168:171],0
v_exp_f32 v66,v66
v_mfma_f32_16x16x32_bf16 v[88:91],a[196:199],a[172:175],v[88:91]
v_exp_f32 v67,v67
v_mfma_f32_16x16x32_bf16 v[88:91],a[200:203],a[176:179],v[88:91]
v_exp_f32 v72,v72
v_mfma_f32_16x16x32_bf16 v[88:91],a[204:207],a[180:183],v[88:91]
v_exp_f32 v73,v73
v_mfma_f32_16x16x32_bf16 v[88:91],a[208:211],a[184:187],v[88:91]
v_exp_f32 v74,v74
v_mfma_f32_16x16x32_bf16 v[88:91],a[212:215],a[188:191],v[88:91]
v_exp_f32 v75,v75
v_mfma_f32_16x16x32_bf16 v[68:71],a[216:219],a[96:99],0
buffer_load_dwordx4 v9,s[12:15],s28 offen offset:2048 nt lds
v_mfma_f32_16x16x32_bf16 v[68:71],a[220:223],a[100:103],v[68:71]
s_add_u32 s28,s28,3072
v_cvt_pk_bf16_f32 v112,v64,v65
v_cvt_pk_bf16_f32 v113,v66,v67
v_mfma_f32_16x16x32_bf16 v[68:71],a[224:227],a[104:107],v[68:71]
s_add_u32 s29,s29,3072
s_add_u32 s25,s24,18432
s_add_u32 s26,s22,12288
s_add_u32 s38,s38,1
s_cmp_lt_u32 s38,2
v_mfma_f32_16x16x32_bf16 v[68:71],a[228:231],a[108:111],v[68:71]
v_cvt_pk_bf16_f32 v116,v72,v73
v_cvt_pk_bf16_f32 v117,v74,v75
v_mfma_f32_16x16x32_bf16 v[68:71],a[232:235],a[112:115],v[68:71]
v_add_u32 v11,9216,v11
v_add_u32 v23,9216,v23
v_mfma_f32_16x16x32_bf16 v[68:71],a[236:239],a[116:119],v[68:71]
v_add_u32 v31,9216,v31
v_mfma_f32_16x16x32_bf16 v[76:79],a[216:219],a[120:123],0
v_mfma_f32_16x16x32_bf16 v[76:79],a[220:223],a[124:127],v[76:79]
v_mfma_f32_16x16x32_bf16 v[76:79],a[224:227],a[128:131],v[76:79]
s_waitcnt vmcnt(12)
s_barrier
v_mfma_f32_16x16x32_bf16 v[76:79],a[228:231],a[132:135],v[76:79]
v_mfma_f32_16x16x32_bf16 v[76:79],a[232:235],a[136:139],v[76:79]
ds_read_b64_tr_b16 a[240:241],v3 offset:24576
ds_read_b64_tr_b16 a[242:243],v3 offset:30720
v_mfma_f32_16x16x32_bf16 v[76:79],a[236:239],a[140:143],v[76:79]
v_mfma_f32_16x16x32_bf16 v[84:87],a[216:219],a[144:147],0
ds_read_b64_tr_b16 a[244:245],v4 offset:24576
ds_read_b64_tr_b16 a[246:247],v4 offset:30720
v_mfma_f32_16x16x32_bf16 v[84:87],a[220:223],a[148:151],v[84:87]
v_mfma_f32_16x16x32_bf16 v[84:87],a[224:227],a[152:155],v[84:87]
ds_read_b64_tr_b16 a[248:249],v5 offset:24576
ds_read_b64_tr_b16 a[250:251],v5 offset:30720
v_mfma_f32_16x16x32_bf16 v[84:87],a[228:231],a[156:159],v[84:87]
v_mfma_f32_16x16x32_bf16 v[84:87],a[232:235],a[160:163],v[84:87]
ds_read_b64_tr_b16 a[252:253],v6 offset:24576
ds_read_b64_tr_b16 a[254:255],v6 offset:30720
v_mfma_f32_16x16x32_bf16 v[84:87],a[236:239],a[164:167],v[84:87]
v_mfma_f32_16x16x32_bf16 v[92:95],a[216:219],a[168:171],0
v_mfma_f32_16x16x32_bf16 v[92:95],a[220:223],a[172:175],v[92:95]
v_mfma_f32_16x16x32_bf16 v[92:95],a[224:227],a[176:179],v[92:95]
v_mfma_f32_16x16x32_bf16 v[92:95],a[228:231],a[180:183],v[92:95]
v_mfma_f32_16x16x32_bf16 v[92:95],a[232:235],a[184:187],v[92:95]
v_mfma_f32_16x16x32_bf16 v[92:95],a[236:239],a[188:191],v[92:95]
s_cbranch_scc1 L_loop4w0
s_cmp_ge_u32 s69,8
s_cbranch_scc1 L_end4
s_cmp_eq_u32 s40,0
s_cbranch_scc1 L_tr43
s_branch L_tr44
.p2align 6
L_loop4w1:
s_waitcnt lgkmcnt(4)
v_mfma_f32_16x16x32_bf16 v[160:163],a[240:243],v[96:99],v[160:163]
s_add_u32 m0,s23,12288
ds_read_b128 a[192:195],v1 offset:12288
v_fma_f32 v86,v86,s36,v18
v_mfma_f32_16x16x32_bf16 v[208:211],a[240:243],v[100:103],v[208:211]
buffer_load_dwordx4 v7,s[8:11],s21 offen offset:0 lds
v_mfma_f32_16x16x32_bf16 a[0:3],a[240:243],v[104:107],a[0:3]
ds_read_b128 a[196:199],v2 offset:12288
v_fma_f32 v90,v90,s36,v19
v_mfma_f32_16x16x32_bf16 a[48:51],a[240:243],v[108:111],a[48:51]
ds_read_b64_tr_b16 a[240:241],v3 offset:24704
ds_read_b64_tr_b16 a[242:243],v3 offset:30848
v_mfma_f32_16x16x32_bf16 v[164:167],a[244:247],v[96:99],v[164:167]
ds_read_b128 a[200:203],v1 offset:12416
v_fma_f32 v93,v93,s36,v19
v_mfma_f32_16x16x32_bf16 v[212:215],a[244:247],v[100:103],v[212:215]
ds_read_b128 a[204:207],v2 offset:12416
v_fma_f32 v95,v95,s36,v19
v_mfma_f32_16x16x32_bf16 a[4:7],a[244:247],v[104:107],a[4:7]
ds_read_b128 a[208:211],v1 offset:12544
v_fma_f32 v78,v78,s36,v17
v_mfma_f32_16x16x32_bf16 a[52:55],a[244:247],v[108:111],a[52:55]
s_waitcnt lgkmcnt(7)
ds_read_b64_tr_b16 a[244:245],v4 offset:24704
ds_read_b64_tr_b16 a[246:247],v4 offset:30848
v_mfma_f32_16x16x32_bf16 v[168:171],a[248:251],v[96:99],v[168:171]
ds_read_b128 a[212:215],v2 offset:12544
v_fma_f32 v89,v89,s36,v19
v_mfma_f32_16x16x32_bf16 v[216:219],a[248:251],v[100:103],v[216:219]
buffer_load_dwordx4 v8,s[8:11],s21 offen offset:1024 lds
v_mfma_f32_16x16x32_bf16 a[8:11],a[248:251],v[104:107],a[8:11]
ds_read_b128 a[216:219],v1 offset:18432
v_fma_f32 v68,v68,s36,v16
v_mfma_f32_16x16x32_bf16 a[56:59],a[248:251],v[108:111],a[56:59]
ds_read_b64_tr_b16 a[250:251],v5 offset:30848
ds_read_b64_tr_b16 a[248:249],v5 offset:24704
v_mfma_f32_16x16x32_bf16 v[172:175],a[252:255],v[96:99],v[172:175]
ds_read_b128 a[220:223],v2 offset:18432
v_fma_f32 v92,v92,s36,v19
v_mfma_f32_16x16x32_bf16 v[220:223],a[252:255],v[100:103],v[220:223]
ds_read_b128 a[224:227],v1 offset:18560
v_fma_f32 v79,v79,s36,v17
v_mfma_f32_16x16x32_bf16 a[12:15],a[252:255],v[104:107],a[12:15]
ds_read_b128 a[228:231],v2 offset:18560
v_fma_f32 v91,v91,s36,v19
v_mfma_f32_16x16x32_bf16 a[60:63],a[252:255],v[108:111],a[60:63]
s_waitcnt lgkmcnt(7)
ds_read_b64_tr_b16 a[254:255],v6 offset:30848
ds_read_b64_tr_b16 a[252:253],v6 offset:24704
v_mfma_f32_16x16x32_bf16 v[176:179],a[240:243],v[96:99],v[176:179]
ds_read_b128 a[232:235],v1 offset:18688
v_fma_f32 v71,v71,s36,v16
v_mfma_f32_16x16x32_bf16 v[224:227],a[240:243],v[100:103],v[224:227]
buffer_load_dwordx4 v9,s[8:11],s21 offen offset:2048 lds
v_mfma_f32_16x16x32_bf16 a[16:19],a[240:243],v[104:107],a[16:19]
s_add_u32 s21,s21,12288
ds_read_b128 a[236:239],v2 offset:18688
v_fma_f32 v88,v88,s36,v19
v_mfma_f32_16x16x32_bf16 a[64:67],a[240:243],v[108:111],a[64:67]
s_add_u32 m0,s22,0
ds_read_b64_tr_b16 a[242:243],v3 offset:30976
ds_read_b64_tr_b16 a[240:241],v3 offset:24832
v_mfma_f32_16x16x32_bf16 v[180:183],a[244:247],v[96:99],v[180:183]
v_exp_f32 v90,v90
v_mfma_f32_16x16x32_bf16 v[228:231],a[244:247],v[100:103],v[228:231]
v_exp_f32 v79,v79
v_mfma_f32_16x16x32_bf16 a[20:23],a[244:247],v[104:107],a[20:23]
v_exp_f32 v86,v86
v_mfma_f32_16x16x32_bf16 a[68:71],a[244:247],v[108:111],a[68:71]
s_waitcnt lgkmcnt(4)
ds_read_b64_tr_b16 a[246:247],v4 offset:30976
ds_read_b64_tr_b16 a[244:245],v4 offset:24832
v_mfma_f32_16x16x32_bf16 v[184:187],a[248:251],v[96:99],v[184:187]
buffer_load_dwordx4 v7,s[4:7],s20 offen offset:0 lds
v_mfma_f32_16x16x32_bf16 v[232:235],a[248:251],v[100:103],v[232:235]
v_exp_f32 v91,v91
v_mfma_f32_16x16x32_bf16 a[24:27],a[248:251],v[104:107],a[24:27]
v_exp_f32 v92,v92
v_mfma_f32_16x16x32_bf16 a[72:75],a[248:251],v[108:111],a[72:75]
ds_read_b64_tr_b16 a[248:249],v5 offset:24832
ds_read_b64_tr_b16 a[250:251],v5 offset:30976
v_mfma_f32_16x16x32_bf16 v[188:191],a[252:255],v[96:99],v[188:191]
v_exp_f32 v89,v89
v_mfma_f32_16x16x32_bf16 v[236:239],a[252:255],v[100:103],v[236:239]
v_exp_f32 v95,v95
v_mfma_f32_16x16x32_bf16 a[28:31],a[252:255],v[104:107],a[28:31]
v_fma_f32 v82,v82,s36,v18
v_fma_f32 v83,v83,s36,v18
v_mfma_f32_16x16x32_bf16 a[76:79],a[252:255],v[108:111],a[76:79]
s_waitcnt lgkmcnt(2)
ds_read_b64_tr_b16 a[252:253],v6 offset:24832
ds_read_b64_tr_b16 a[254:255],v6 offset:30976
v_mfma_f32_16x16x32_bf16 v[192:195],a[240:243],v[96:99],v[192:195]
buffer_load_dwordx4 v8,s[4:7],s20 offen offset:1024 lds
v_mfma_f32_16x16x32_bf16 v[240:243],a[240:243],v[100:103],v[240:243]
v_exp_f32 v83,v83
v_mfma_f32_16x16x32_bf16 a[32:35],a[240:243],v[104:107],a[32:35]
v_fma_f32 v80,v80,s36,v18
v_fma_f32 v77,v77,s36,v17
v_mfma_f32_16x16x32_bf16 a[80:83],a[240:243],v[108:111],a[80:83]
v_exp_f32 v93,v93
v_mfma_f32_16x16x32_bf16 v[196:199],a[244:247],v[96:99],v[196:199]
v_fma_f32 v76,v76,s36,v17
v_fma_f32 v84,v84,s36,v18
v_mfma_f32_16x16x32_bf16 v[244:247],a[244:247],v[100:103],v[244:247]
ds_read_b128 v[156:159],v11 offset:0
v_fma_f32 v87,v87,s36,v18
v_mfma_f32_16x16x32_bf16 a[36:39],a[244:247],v[104:107],a[36:39]
v_exp_f32 v76,v76
v_mfma_f32_16x16x32_bf16 a[84:87],a[244:247],v[108:111],a[84:87]
s_waitcnt lgkmcnt(1)
v_exp_f32 v71,v71
v_mfma_f32_16x16x32_bf16 v[200:203],a[248:251],v[96:99],v[200:203]
buffer_load_dwordx4 v9,s[4:7],s20 offen offset:2048 lds
v_mfma_f32_16x16x32_bf16 v[248:251],a[248:251],v[100:103],v[248:251]
s_add_u32 s20,s20,12288
v_exp_f32 v82,v82
v_mfma_f32_16x16x32_bf16 a[40:43],a[248:251],v[104:107],a[40:43]
v_cvt_pk_bf16_f32 v121,v82,v83
v_fma_f32 v81,v81,s36,v18
v_mfma_f32_16x16x32_bf16 a[88:91],a[248:251],v[108:111],a[88:91]
v_exp_f32 v81,v81
v_mfma_f32_16x16x32_bf16 v[204:207],a[252:255],v[96:99],v[204:207]
v_exp_f32 v68,v68
v_mfma_f32_16x16x32_bf16 v[252:255],a[252:255],v[100:103],v[252:255]
v_exp_f32 v88,v88
v_mfma_f32_16x16x32_bf16 a[44:47],a[252:255],v[104:107],a[44:47]
v_fma_f32 v94,v94,s36,v19
v_fma_f32 v85,v85,s36,v18
v_mfma_f32_16x16x32_bf16 a[92:95],a[252:255],v[108:111],a[92:95]
v_exp_f32 v85,v85
v_mfma_f32_16x16x32_bf16 v[32:35],a[192:195],a[96:99],0
ds_read_b128 v[152:155],v23 offset:0
v_mfma_f32_16x16x32_bf16 v[32:35],a[196:199],a[100:103],v[32:35]
v_exp_f32 v94,v94
v_mfma_f32_16x16x32_bf16 v[32:35],a[200:203],a[104:107],v[32:35]
v_exp_f32 v87,v87
v_mfma_f32_16x16x32_bf16 v[32:35],a[204:207],a[108:111],v[32:35]
v_exp_f32 v80,v80
v_mfma_f32_16x16x32_bf16 v[32:35],a[208:211],a[112:115],v[32:35]
v_exp_f32 v77,v77
v_mfma_f32_16x16x32_bf16 v[32:35],a[212:215],a[116:119],v[32:35]
s_waitcnt lgkmcnt(1)
buffer_store_dwordx4 v[156:159],v0,s[16:19],s27 offen offset:0 nt
v_mfma_f32_16x16x32_bf16 v[40:43],a[192:195],a[120:123],0
v_exp_f32 v84,v84
v_mfma_f32_16x16x32_bf16 v[40:43],a[196:199],a[124:127],v[40:43]
v_exp_f32 v78,v78
v_mfma_f32_16x16x32_bf16 v[40:43],a[200:203],a[128:131],v[40:43]
v_fma_f32 v69,v69,s36,v16
v_cvt_pk_bf16_f32 v127,v94,v95
v_mfma_f32_16x16x32_bf16 v[40:43],a[204:207],a[132:135],v[40:43]
v_exp_f32 v69,v69
v_mfma_f32_16x16x32_bf16 v[40:43],a[208:211],a[136:139],v[40:43]
v_fma_f32 v35,v35,s36,v16
v_cvt_pk_bf16_f32 v120,v80,v81
v_mfma_f32_16x16x32_bf16 v[40:43],a[212:215],a[140:143],v[40:43]
v_exp_f32 v35,v35
v_mfma_f32_16x16x32_bf16 v[48:51],a[192:195],a[144:147],0
ds_read_b128 v[156:159],v31 offset:0
v_fma_f32 v70,v70,s36,v16
v_mfma_f32_16x16x32_bf16 v[48:51],a[196:199],a[148:151],v[48:51]
v_exp_f32 v70,v70
v_mfma_f32_16x16x32_bf16 v[48:51],a[200:203],a[152:155],v[48:51]
v_cvt_pk_bf16_f32 v115,v70,v71
v_fma_f32 v42,v42,s36,v17
v_mfma_f32_16x16x32_bf16 v[48:51],a[204:207],a[156:159],v[48:51]
v_fma_f32 v43,v43,s36,v17
v_fma_f32 v41,v41,s36,v17
v_mfma_f32_16x16x32_bf16 v[48:51],a[208:211],a[160:163],v[48:51]
s_waitcnt lgkmcnt(1)
buffer_store_dwordx4 v[152:155],v0,s[16:19],s27 offen offset:1024 nt
v_mfma_f32_16x16x32_bf16 v[48:51],a[212:215],a[164:167],v[48:51]
v_exp_f32 v41,v41
v_mfma_f32_16x16x32_bf16 v[56:59],a[192:195],a[168:171],0
v_fma_f32 v33,v33,s36,v16
v_cvt_pk_bf16_f32 v114,v68,v69
v_mfma_f32_16x16x32_bf16 v[56:59],a[196:199],a[172:175],v[56:59]
v_exp_f32 v33,v33
v_mfma_f32_16x16x32_bf16 v[128:131],v[24:27],v[112:115],v[128:131]
v_exp_f32 v42,v42
v_mfma_f32_16x16x32_bf16 v[56:59],a[200:203],a[176:179],v[56:59]
v_cvt_pk_bf16_f32 v118,v76,v77
v_cvt_pk_bf16_f32 v123,v86,v87
v_mfma_f32_16x16x32_bf16 v[56:59],a[204:207],a[180:183],v[56:59]
v_cvt_pk_bf16_f32 v126,v92,v93
v_cvt_pk_bf16_f32 v119,v78,v79
v_mfma_f32_16x16x32_bf16 v[56:59],a[208:211],a[184:187],v[56:59]
v_cvt_pk_bf16_f32 v122,v84,v85
v_fma_f32 v32,v32,s36,v16
v_mfma_f32_16x16x32_bf16 v[132:135],v[24:27],v[116:119],v[132:135]
v_exp_f32 v32,v32
v_mfma_f32_16x16x32_bf16 v[136:139],v[24:27],v[120:123],v[136:139]
v_cvt_pk_bf16_f32 v96,v32,v33
v_cvt_pk_bf16_f32 v124,v88,v89
v_mfma_f32_16x16x32_bf16 v[56:59],a[212:215],a[188:191],v[56:59]
v_fma_f32 v34,v34,s36,v16
v_cvt_pk_bf16_f32 v125,v90,v91
v_mfma_f32_16x16x32_bf16 v[36:39],a[216:219],a[96:99],0
v_exp_f32 v34,v34
v_mfma_f32_16x16x32_bf16 v[140:143],v[24:27],v[124:127],v[140:143]
s_waitcnt lgkmcnt(0)
buffer_store_dwordx4 v[156:159],v0,s[16:19],s27 offen offset:2048 nt
v_mfma_f32_16x16x32_bf16 v[36:39],a[220:223],a[100:103],v[36:39]
s_add_u32 s27,s27,3072
v_fma_f32 v40,v40,s36,v17
v_cvt_pk_bf16_f32 v97,v34,v35
v_mfma_f32_16x16x32_bf16 v[36:39],a[224:227],a[104:107],v[36:39]
v_exp_f32 v40,v40
v_mfma_f32_16x16x32_bf16 v[36:39],a[228:231],a[108:111],v[36:39]
v_exp_f32 v43,v43
s_waitcnt vmcnt(9)
s_barrier
v_mfma_f32_16x16x32_bf16 v[36:39],a[232:235],a[112:115],v[36:39]
v_cvt_pk_bf16_f32 v100,v40,v41
v_cvt_pk_bf16_f32 v101,v42,v43
v_mfma_f32_16x16x32_bf16 v[36:39],a[236:239],a[116:119],v[36:39]
v_mfma_f32_16x16x32_bf16 v[44:47],a[216:219],a[120:123],0
v_mfma_f32_16x16x32_bf16 v[44:47],a[220:223],a[124:127],v[44:47]
v_mfma_f32_16x16x32_bf16 v[44:47],a[224:227],a[128:131],v[44:47]
v_mfma_f32_16x16x32_bf16 v[44:47],a[228:231],a[132:135],v[44:47]
v_mfma_f32_16x16x32_bf16 v[44:47],a[232:235],a[136:139],v[44:47]
ds_read_b64_tr_b16 a[240:241],v3 offset:0
ds_read_b64_tr_b16 a[242:243],v3 offset:6144
v_mfma_f32_16x16x32_bf16 v[44:47],a[236:239],a[140:143],v[44:47]
v_mfma_f32_16x16x32_bf16 v[52:55],a[216:219],a[144:147],0
ds_read_b64_tr_b16 a[246:247],v4 offset:6144
ds_read_b64_tr_b16 a[244:245],v4 offset:0
v_mfma_f32_16x16x32_bf16 v[52:55],a[220:223],a[148:151],v[52:55]
v_mfma_f32_16x16x32_bf16 v[52:55],a[224:227],a[152:155],v[52:55]
ds_read_b64_tr_b16 a[250:251],v5 offset:6144
ds_read_b64_tr_b16 a[248:249],v5 offset:0
v_mfma_f32_16x16x32_bf16 v[52:55],a[228:231],a[156:159],v[52:55]
v_mfma_f32_16x16x32_bf16 v[52:55],a[232:235],a[160:163],v[52:55]
ds_read_b64_tr_b16 a[252:253],v6 offset:0
ds_read_b64_tr_b16 a[254:255],v6 offset:6144
v_mfma_f32_16x16x32_bf16 v[52:55],a[236:239],a[164:167],v[52:55]
v_mfma_f32_16x16x32_bf16 v[60:63],a[216:219],a[168:171],0
v_mfma_f32_16x16x32_bf16 v[60:63],a[220:223],a[172:175],v[60:63]
v_mfma_f32_16x16x32_bf16 v[60:63],a[224:227],a[176:179],v[60:63]
v_mfma_f32_16x16x32_bf16 v[60:63],a[228:231],a[180:183],v[60:63]
v_mfma_f32_16x16x32_bf16 v[60:63],a[232:235],a[184:187],v[60:63]
v_mfma_f32_16x16x32_bf16 v[60:63],a[236:239],a[188:191],v[60:63]
s_waitcnt lgkmcnt(2)
v_mfma_f32_16x16x32_bf16 v[160:163],a[240:243],v[112:115],v[160:163]
s_add_u32 m0,s23,24576
ds_read_b128 a[192:195],v1 offset:24576
v_fma_f32 v36,v36,s36,v16
v_mfma_f32_16x16x32_bf16 v[208:211],a[240:243],v[116:119],v[208:211]
buffer_load_dwordx4 v7,s[8:11],s21 offen offset:0 lds
v_mfma_f32_16x16x32_bf16 a[0:3],a[240:243],v[120:123],a[0:3]
ds_read_b128 a[196:199],v2 offset:24576
v_fma_f32 v37,v37,s36,v16
v_mfma_f32_16x16x32_bf16 a[48:51],a[240:243],v[124:127],a[48:51]
ds_read_b64_tr_b16 a[240:241],v3 offset:128
ds_read_b64_tr_b16 a[242:243],v3 offset:6272
v_mfma_f32_16x16x32_bf16 v[164:167],a[244:247],v[112:115],v[164:167]
ds_read_b128 a[200:203],v1 offset:24704
v_fma_f32 v38,v38,s36,v16
v_mfma_f32_16x16x32_bf16 v[212:215],a[244:247],v[116:119],v[212:215]
ds_read_b128 a[204:207],v2 offset:24704
v_fma_f32 v39,v39,s36,v16
v_mfma_f32_16x16x32_bf16 a[4:7],a[244:247],v[120:123],a[4:7]
ds_read_b128 a[208:211],v1 offset:24832
v_fma_f32 v44,v44,s36,v17
v_mfma_f32_16x16x32_bf16 a[52:55],a[244:247],v[124:127],a[52:55]
ds_read_b64_tr_b16 a[244:245],v4 offset:128
ds_read_b64_tr_b16 a[246:247],v4 offset:6272
v_mfma_f32_16x16x32_bf16 v[168:171],a[248:251],v[112:115],v[168:171]
ds_read_b128 a[212:215],v2 offset:24832
v_fma_f32 v45,v45,s36,v17
v_mfma_f32_16x16x32_bf16 v[216:219],a[248:251],v[116:119],v[216:219]
buffer_load_dwordx4 v8,s[8:11],s21 offen offset:1024 lds
v_mfma_f32_16x16x32_bf16 a[8:11],a[248:251],v[120:123],a[8:11]
ds_read_b128 a[216:219],v1 offset:30720
v_fma_f32 v46,v46,s36,v17
v_mfma_f32_16x16x32_bf16 a[56:59],a[248:251],v[124:127],a[56:59]
s_waitcnt lgkmcnt(8)
ds_read_b64_tr_b16 a[248:249],v5 offset:128
ds_read_b64_tr_b16 a[250:251],v5 offset:6272
v_mfma_f32_16x16x32_bf16 v[172:175],a[252:255],v[112:115],v[172:175]
ds_read_b128 a[220:223],v2 offset:30720
v_fma_f32 v47,v47,s36,v17
v_mfma_f32_16x16x32_bf16 v[220:223],a[252:255],v[116:119],v[220:223]
ds_read_b128 a[224:227],v1 offset:30848
v_fma_f32 v48,v48,s36,v18
v_mfma_f32_16x16x32_bf16 a[12:15],a[252:255],v[120:123],a[12:15]
ds_read_b128 a[228:231],v2 offset:30848
v_fma_f32 v49,v49,s36,v18
v_mfma_f32_16x16x32_bf16 a[60:63],a[252:255],v[124:127],a[60:63]
s_waitcnt lgkmcnt(7)
ds_read_b64_tr_b16 a[252:253],v6 offset:128
ds_read_b64_tr_b16 a[254:255],v6 offset:6272
v_mfma_f32_16x16x32_bf16 v[176:179],a[240:243],v[112:115],v[176:179]
ds_read_b128 a[232:235],v1 offset:30976
v_fma_f32 v50,v50,s36,v18
v_mfma_f32_16x16x32_bf16 v[224:227],a[240:243],v[116:119],v[224:227]
buffer_load_dwordx4 v9,s[8:11],s21 offen offset:2048 lds
v_mfma_f32_16x16x32_bf16 a[16:19],a[240:243],v[120:123],a[16:19]
s_add_u32 s21,s21,12288
ds_read_b128 a[236:239],v2 offset:30976
v_fma_f32 v51,v51,s36,v18
v_mfma_f32_16x16x32_bf16 a[64:67],a[240:243],v[124:127],a[64:67]
s_add_u32 m0,s22,12288
ds_read_b64_tr_b16 a[240:241],v3 offset:256
ds_read_b64_tr_b16 a[242:243],v3 offset:6400
v_mfma_f32_16x16x32_bf16 v[180:183],a[244:247],v[112:115],v[180:183]
v_fma_f32 v52,v52,s36,v18
v_fma_f32 v53,v53,s36,v18
v_mfma_f32_16x16x32_bf16 v[228:231],a[244:247],v[116:119],v[228:231]
v_fma_f32 v54,v54,s36,v18
v_fma_f32 v55,v55,s36,v18
v_mfma_f32_16x16x32_bf16 a[20:23],a[244:247],v[120:123],a[20:23]
v_fma_f32 v56,v56,s36,v19
v_fma_f32 v57,v57,s36,v19
v_mfma_f32_16x16x32_bf16 a[68:71],a[244:247],v[124:127],a[68:71]
s_waitcnt lgkmcnt(4)
ds_read_b64_tr_b16 a[244:245],v4 offset:256
ds_read_b64_tr_b16 a[246:247],v4 offset:6400
v_mfma_f32_16x16x32_bf16 v[184:187],a[248:251],v[112:115],v[184:187]
buffer_load_dwordx4 v7,s[4:7],s20 offen offset:0 lds
v_mfma_f32_16x16x32_bf16 v[232:235],a[248:251],v[116:119],v[232:235]
v_fma_f32 v58,v58,s36,v19
v_fma_f32 v59,v59,s36,v19
v_mfma_f32_16x16x32_bf16 a[24:27],a[248:251],v[120:123],a[24:27]
v_fma_f32 v60,v60,s36,v19
v_fma_f32 v61,v61,s36,v19
v_mfma_f32_16x16x32_bf16 a[72:75],a[248:251],v[124:127],a[72:75]
ds_read_b64_tr_b16 a[248:249],v5 offset:256
ds_read_b64_tr_b16 a[250:251],v5 offset:6400
v_mfma_f32_16x16x32_bf16 v[188:191],a[252:255],v[112:115],v[188:191]
v_fma_f32 v62,v62,s36,v19
v_fma_f32 v63,v63,s36,v19
v_mfma_f32_16x16x32_bf16 v[236:239],a[252:255],v[116:119],v[236:239]
v_exp_f32 v36,v36
v_mfma_f32_16x16x32_bf16 a[28:31],a[252:255],v[120:123],a[28:31]
v_exp_f32 v37,v37
v_mfma_f32_16x16x32_bf16 a[76:79],a[252:255],v[124:127],a[76:79]
s_waitcnt lgkmcnt(2)
ds_read_b64_tr_b16 a[252:253],v6 offset:256
ds_read_b64_tr_b16 a[254:255],v6 offset:6400
v_mfma_f32_16x16x32_bf16 v[192:195],a[240:243],v[112:115],v[192:195]
buffer_load_dwordx4 v8,s[4:7],s20 offen offset:1024 lds
v_mfma_f32_16x16x32_bf16 v[240:243],a[240:243],v[116:119],v[240:243]
v_exp_f32 v38,v38
v_mfma_f32_16x16x32_bf16 a[32:35],a[240:243],v[120:123],a[32:35]
v_exp_f32 v39,v39
v_mfma_f32_16x16x32_bf16 a[80:83],a[240:243],v[124:127],a[80:83]
v_exp_f32 v44,v44
v_mfma_f32_16x16x32_bf16 v[196:199],a[244:247],v[112:115],v[196:199]
v_exp_f32 v45,v45
v_mfma_f32_16x16x32_bf16 v[244:247],a[244:247],v[116:119],v[244:247]
v_exp_f32 v46,v46
v_mfma_f32_16x16x32_bf16 a[36:39],a[244:247],v[120:123],a[36:39]
v_exp_f32 v47,v47
v_mfma_f32_16x16x32_bf16 a[84:87],a[244:247],v[124:127],a[84:87]
s_waitcnt lgkmcnt(0)
v_exp_f32 v48,v48
v_mfma_f32_16x16x32_bf16 v[200:203],a[248:251],v[112:115],v[200:203]
buffer_load_dwordx4 v9,s[4:7],s20 offen offset:2048 lds
v_mfma_f32_16x16x32_bf16 v[248:251],a[248:251],v[116:119],v[248:251]
s_add_u32 s20,s20,12288
v_exp_f32 v49,v49
v_mfma_f32_16x16x32_bf16 a[40:43],a[248:251],v[120:123],a[40:43]
s_add_u32 m0,s29,0
v_exp_f32 v50,v50
v_mfma_f32_16x16x32_bf16 a[88:91],a[248:251],v[124:127],a[88:91]
v_exp_f32 v51,v51
v_mfma_f32_16x16x32_bf16 v[204:207],a[252:255],v[112:115],v[204:207]
v_exp_f32 v52,v52
v_mfma_f32_16x16x32_bf16 v[252:255],a[252:255],v[116:119],v[252:255]
v_exp_f32 v53,v53
v_mfma_f32_16x16x32_bf16 a[44:47],a[252:255],v[120:123],a[44:47]
v_exp_f32 v54,v54
v_mfma_f32_16x16x32_bf16 a[92:95],a[252:255],v[124:127],a[92:95]
v_exp_f32 v55,v55
v_mfma_f32_16x16x32_bf16 v[64:67],a[192:195],a[96:99],0
v_exp_f32 v56,v56
v_mfma_f32_16x16x32_bf16 v[64:67],a[196:199],a[100:103],v[64:67]
v_exp_f32 v57,v57
v_mfma_f32_16x16x32_bf16 v[64:67],a[200:203],a[104:107],v[64:67]
v_exp_f32 v58,v58
v_mfma_f32_16x16x32_bf16 v[64:67],a[204:207],a[108:111],v[64:67]
v_exp_f32 v59,v59
v_mfma_f32_16x16x32_bf16 v[64:67],a[208:211],a[112:115],v[64:67]
v_exp_f32 v60,v60
v_mfma_f32_16x16x32_bf16 v[64:67],a[212:215],a[116:119],v[64:67]
buffer_load_dwordx4 v7,s[12:15],s28 offen offset:0 nt lds
v_mfma_f32_16x16x32_bf16 v[72:75],a[192:195],a[120:123],0
v_exp_f32 v61,v61
v_mfma_f32_16x16x32_bf16 v[72:75],a[196:199],a[124:127],v[72:75]
v_exp_f32 v62,v62
v_mfma_f32_16x16x32_bf16 v[72:75],a[200:203],a[128:131],v[72:75]
v_exp_f32 v63,v63
v_mfma_f32_16x16x32_bf16 v[72:75],a[204:207],a[132:135],v[72:75]
v_cvt_pk_bf16_f32 v98,v36,v37
v_cvt_pk_bf16_f32 v99,v38,v39
v_mfma_f32_16x16x32_bf16 v[72:75],a[208:211],a[136:139],v[72:75]
v_cvt_pk_bf16_f32 v102,v44,v45
v_cvt_pk_bf16_f32 v103,v46,v47
v_mfma_f32_16x16x32_bf16 v[128:131],v[24:27],v[96:99],v[128:131]
v_cvt_pk_bf16_f32 v104,v48,v49
v_cvt_pk_bf16_f32 v105,v50,v51
v_mfma_f32_16x16x32_bf16 v[132:135],v[24:27],v[100:103],v[132:135]
v_cvt_pk_bf16_f32 v106,v52,v53
v_cvt_pk_bf16_f32 v107,v54,v55
v_mfma_f32_16x16x32_bf16 v[72:75],a[212:215],a[140:143],v[72:75]
v_cvt_pk_bf16_f32 v108,v56,v57
v_cvt_pk_bf16_f32 v109,v58,v59
v_mfma_f32_16x16x32_bf16 v[136:139],v[24:27],v[104:107],v[136:139]
v_cvt_pk_bf16_f32 v110,v60,v61
v_cvt_pk_bf16_f32 v111,v62,v63
v_mfma_f32_16x16x32_bf16 v[80:83],a[192:195],a[144:147],0
v_fma_f32 v64,v64,s36,v16
v_fma_f32 v65,v65,s36,v16
v_mfma_f32_16x16x32_bf16 v[140:143],v[24:27],v[108:111],v[140:143]
buffer_load_dwordx4 v8,s[12:15],s28 offen offset:1024 nt lds
v_mfma_f32_16x16x32_bf16 v[80:83],a[196:199],a[148:151],v[80:83]
v_fma_f32 v66,v66,s36,v16
v_fma_f32 v67,v67,s36,v16
v_mfma_f32_16x16x32_bf16 v[80:83],a[200:203],a[152:155],v[80:83]
v_fma_f32 v72,v72,s36,v17
v_fma_f32 v73,v73,s36,v17
v_mfma_f32_16x16x32_bf16 v[80:83],a[204:207],a[156:159],v[80:83]
v_fma_f32 v74,v74,s36,v17
v_fma_f32 v75,v75,s36,v17
v_mfma_f32_16x16x32_bf16 v[80:83],a[208:211],a[160:163],v[80:83]
v_exp_f32 v64,v64
v_mfma_f32_16x16x32_bf16 v[80:83],a[212:215],a[164:167],v[80:83]
v_exp_f32 v65,v65
v_mfma_f32_16x16x32_bf16 v[88:91],a[192:195],a[168:171],0
v_exp_f32 v66,v66
v_mfma_f32_16x16x32_bf16 v[88:91],a[196:199],a[172:175],v[88:91]
v_exp_f32 v67,v67
v_mfma_f32_16x16x32_bf16 v[88:91],a[200:203],a[176:179],v[88:91]
v_exp_f32 v72,v72
v_mfma_f32_16x16x32_bf16 v[88:91],a[204:207],a[180:183],v[88:91]
v_exp_f32 v73,v73
v_mfma_f32_16x16x32_bf16 v[88:91],a[208:211],a[184:187],v[88:91]
v_exp_f32 v74,v74
v_mfma_f32_16x16x32_bf16 v[88:91],a[212:215],a[188:191],v[88:91]
v_exp_f32 v75,v75
v_mfma_f32_16x16x32_bf16 v[68:71],a[216:219],a[96:99],0
buffer_load_dwordx4 v9,s[12:15],s28 offen offset:2048 nt lds
v_mfma_f32_16x16x32_bf16 v[68:71],a[220:223],a[100:103],v[68:71]
s_add_u32 s28,s28,3072
v_cvt_pk_bf16_f32 v112,v64,v65
v_cvt_pk_bf16_f32 v113,v66,v67
v_mfma_f32_16x16x32_bf16 v[68:71],a[224:227],a[104:107],v[68:71]
s_add_u32 s29,s29,3072
v_cvt_pk_bf16_f32 v116,v72,v73
v_cvt_pk_bf16_f32 v117,v74,v75
v_mfma_f32_16x16x32_bf16 v[68:71],a[228:231],a[108:111],v[68:71]
v_mfma_f32_16x16x32_bf16 v[68:71],a[232:235],a[112:115],v[68:71]
s_waitcnt vmcnt(12)
s_barrier
v_mfma_f32_16x16x32_bf16 v[68:71],a[236:239],a[116:119],v[68:71]
v_mfma_f32_16x16x32_bf16 v[76:79],a[216:219],a[120:123],0
v_mfma_f32_16x16x32_bf16 v[76:79],a[220:223],a[124:127],v[76:79]
v_mfma_f32_16x16x32_bf16 v[76:79],a[224:227],a[128:131],v[76:79]
v_mfma_f32_16x16x32_bf16 v[76:79],a[228:231],a[132:135],v[76:79]
v_mfma_f32_16x16x32_bf16 v[76:79],a[232:235],a[136:139],v[76:79]
v_mfma_f32_16x16x32_bf16 v[76:79],a[236:239],a[140:143],v[76:79]
ds_read_b64_tr_b16 a[240:241],v3 offset:12288
ds_read_b64_tr_b16 a[242:243],v3 offset:18432
v_mfma_f32_16x16x32_bf16 v[84:87],a[216:219],a[144:147],0
v_mfma_f32_16x16x32_bf16 v[84:87],a[220:223],a[148:151],v[84:87]
ds_read_b64_tr_b16 a[244:245],v4 offset:12288
ds_read_b64_tr_b16 a[246:247],v4 offset:18432
v_mfma_f32_16x16x32_bf16 v[84:87],a[224:227],a[152:155],v[84:87]
v_mfma_f32_16x16x32_bf16 v[84:87],a[228:231],a[156:159],v[84:87]
ds_read_b64_tr_b16 a[248:249],v5 offset:12288
ds_read_b64_tr_b16 a[250:251],v5 offset:18432
v_mfma_f32_16x16x32_bf16 v[84:87],a[232:235],a[160:163],v[84:87]
v_mfma_f32_16x16x32_bf16 v[84:87],a[236:239],a[164:167],v[84:87]
ds_read_b64_tr_b16 a[252:253],v6 offset:12288
ds_read_b64_tr_b16 a[254:255],v6 offset:18432
v_mfma_f32_16x16x32_bf16 v[92:95],a[216:219],a[168:171],0
v_mfma_f32_16x16x32_bf16 v[92:95],a[220:223],a[172:175],v[92:95]
v_mfma_f32_16x16x32_bf16 v[92:95],a[224:227],a[176:179],v[92:95]
v_mfma_f32_16x16x32_bf16 v[92:95],a[228:231],a[180:183],v[92:95]
v_mfma_f32_16x16x32_bf16 v[92:95],a[232:235],a[184:187],v[92:95]
v_mfma_f32_16x16x32_bf16 v[92:95],a[236:239],a[188:191],v[92:95]
s_waitcnt lgkmcnt(4)
v_mfma_f32_16x16x32_bf16 v[160:163],a[240:243],v[96:99],v[160:163]
s_add_u32 m0,s23,0
ds_read_b128 a[192:195],v1 offset:0
v_fma_f32 v86,v86,s36,v18
v_mfma_f32_16x16x32_bf16 v[208:211],a[240:243],v[100:103],v[208:211]
buffer_load_dwordx4 v7,s[8:11],s21 offen offset:0 lds
v_mfma_f32_16x16x32_bf16 a[0:3],a[240:243],v[104:107],a[0:3]
ds_read_b128 a[196:199],v2 offset:0
v_fma_f32 v90,v90,s36,v19
v_mfma_f32_16x16x32_bf16 a[48:51],a[240:243],v[108:111],a[48:51]
ds_read_b64_tr_b16 a[240:241],v3 offset:12416
ds_read_b64_tr_b16 a[242:243],v3 offset:18560
v_mfma_f32_16x16x32_bf16 v[164:167],a[244:247],v[96:99],v[164:167]
ds_read_b128 a[200:203],v1 offset:128
v_fma_f32 v93,v93,s36,v19
v_mfma_f32_16x16x32_bf16 v[212:215],a[244:247],v[100:103],v[212:215]
ds_read_b128 a[204:207],v2 offset:128
v_fma_f32 v95,v95,s36,v19
v_mfma_f32_16x16x32_bf16 a[4:7],a[244:247],v[104:107],a[4:7]
ds_read_b128 a[208:211],v1 offset:256
v_fma_f32 v78,v78,s36,v17
v_mfma_f32_16x16x32_bf16 a[52:55],a[244:247],v[108:111],a[52:55]
s_waitcnt lgkmcnt(7)
ds_read_b64_tr_b16 a[244:245],v4 offset:12416
ds_read_b64_tr_b16 a[246:247],v4 offset:18560
v_mfma_f32_16x16x32_bf16 v[168:171],a[248:251],v[96:99],v[168:171]
ds_read_b128 a[212:215],v2 offset:256
v_fma_f32 v89,v89,s36,v19
v_mfma_f32_16x16x32_bf16 v[216:219],a[248:251],v[100:103],v[216:219]
buffer_load_dwordx4 v8,s[8:11],s21 offen offset:1024 lds
v_mfma_f32_16x16x32_bf16 a[8:11],a[248:251],v[104:107],a[8:11]
ds_read_b128 a[216:219],v1 offset:6144
v_fma_f32 v68,v68,s36,v16
v_mfma_f32_16x16x32_bf16 a[56:59],a[248:251],v[108:111],a[56:59]
ds_read_b64_tr_b16 a[250:251],v5 offset:18560
ds_read_b64_tr_b16 a[248:249],v5 offset:12416
v_mfma_f32_16x16x32_bf16 v[172:175],a[252:255],v[96:99],v[172:175]
ds_read_b128 a[220:223],v2 offset:6144
v_fma_f32 v92,v92,s36,v19
v_mfma_f32_16x16x32_bf16 v[220:223],a[252:255],v[100:103],v[220:223]
ds_read_b128 a[224:227],v1 offset:6272
v_fma_f32 v79,v79,s36,v17
v_mfma_f32_16x16x32_bf16 a[12:15],a[252:255],v[104:107],a[12:15]
ds_read_b128 a[228:231],v2 offset:6272
v_fma_f32 v91,v91,s36,v19
v_mfma_f32_16x16x32_bf16 a[60:63],a[252:255],v[108:111],a[60:63]
s_waitcnt lgkmcnt(7)
ds_read_b64_tr_b16 a[254:255],v6 offset:18560
ds_read_b64_tr_b16 a[252:253],v6 offset:12416
v_mfma_f32_16x16x32_bf16 v[176:179],a[240:243],v[96:99],v[176:179]
ds_read_b128 a[232:235],v1 offset:6400
v_fma_f32 v71,v71,s36,v16
v_mfma_f32_16x16x32_bf16 v[224:227],a[240:243],v[100:103],v[224:227]
buffer_load_dwordx4 v9,s[8:11],s21 offen offset:2048 lds
v_mfma_f32_16x16x32_bf16 a[16:19],a[240:243],v[104:107],a[16:19]
s_add_u32 s21,s21,12288
ds_read_b128 a[236:239],v2 offset:6400
v_fma_f32 v88,v88,s36,v19
v_mfma_f32_16x16x32_bf16 a[64:67],a[240:243],v[108:111],a[64:67]
s_add_u32 m0,s22,24576
ds_read_b64_tr_b16 a[242:243],v3 offset:18688
ds_read_b64_tr_b16 a[240:241],v3 offset:12544
v_mfma_f32_16x16x32_bf16 v[180:183],a[244:247],v[96:99],v[180:183]
v_exp_f32 v90,v90
v_mfma_f32_16x16x32_bf16 v[228:231],a[244:247],v[100:103],v[228:231]
v_exp_f32 v79,v79
v_mfma_f32_16x16x32_bf16 a[20:23],a[244:247],v[104:107],a[20:23]
v_exp_f32 v86,v86
v_mfma_f32_16x16x32_bf16 a[68:71],a[244:247],v[108:111],a[68:71]
s_waitcnt lgkmcnt(4)
ds_read_b64_tr_b16 a[246:247],v4 offset:18688
ds_read_b64_tr_b16 a[244:245],v4 offset:12544
v_mfma_f32_16x16x32_bf16 v[184:187],a[248:251],v[96:99],v[184:187]
buffer_load_dwordx4 v7,s[4:7],s20 offen offset:0 lds
v_mfma_f32_16x16x32_bf16 v[232:235],a[248:251],v[100:103],v[232:235]
v_exp_f32 v91,v91
v_mfma_f32_16x16x32_bf16 a[24:27],a[248:251],v[104:107],a[24:27]
v_exp_f32 v92,v92
v_mfma_f32_16x16x32_bf16 a[72:75],a[248:251],v[108:111],a[72:75]
ds_read_b64_tr_b16 a[248:249],v5 offset:12544
ds_read_b64_tr_b16 a[250:251],v5 offset:18688
v_mfma_f32_16x16x32_bf16 v[188:191],a[252:255],v[96:99],v[188:191]
v_exp_f32 v89,v89
v_mfma_f32_16x16x32_bf16 v[236:239],a[252:255],v[100:103],v[236:239]
v_exp_f32 v95,v95
v_mfma_f32_16x16x32_bf16 a[28:31],a[252:255],v[104:107],a[28:31]
v_fma_f32 v82,v82,s36,v18
v_fma_f32 v83,v83,s36,v18
v_mfma_f32_16x16x32_bf16 a[76:79],a[252:255],v[108:111],a[76:79]
s_waitcnt lgkmcnt(2)
ds_read_b64_tr_b16 a[252:253],v6 offset:12544
ds_read_b64_tr_b16 a[254:255],v6 offset:18688
v_mfma_f32_16x16x32_bf16 v[192:195],a[240:243],v[96:99],v[192:195]
buffer_load_dwordx4 v8,s[4:7],s20 offen offset:1024 lds
v_mfma_f32_16x16x32_bf16 v[240:243],a[240:243],v[100:103],v[240:243]
v_exp_f32 v83,v83
v_mfma_f32_16x16x32_bf16 a[32:35],a[240:243],v[104:107],a[32:35]
v_fma_f32 v80,v80,s36,v18
v_fma_f32 v77,v77,s36,v17
v_mfma_f32_16x16x32_bf16 a[80:83],a[240:243],v[108:111],a[80:83]
v_exp_f32 v93,v93
v_mfma_f32_16x16x32_bf16 v[196:199],a[244:247],v[96:99],v[196:199]
v_fma_f32 v76,v76,s36,v17
v_fma_f32 v84,v84,s36,v18
v_mfma_f32_16x16x32_bf16 v[244:247],a[244:247],v[100:103],v[244:247]
ds_read_b128 v[152:155],v11 offset:3072
v_fma_f32 v87,v87,s36,v18
v_mfma_f32_16x16x32_bf16 a[36:39],a[244:247],v[104:107],a[36:39]
v_exp_f32 v76,v76
v_mfma_f32_16x16x32_bf16 a[84:87],a[244:247],v[108:111],a[84:87]
s_waitcnt lgkmcnt(1)
v_exp_f32 v71,v71
v_mfma_f32_16x16x32_bf16 v[200:203],a[248:251],v[96:99],v[200:203]
buffer_load_dwordx4 v9,s[4:7],s20 offen offset:2048 lds
v_mfma_f32_16x16x32_bf16 v[248:251],a[248:251],v[100:103],v[248:251]
s_add_u32 s20,s20,12288
v_exp_f32 v82,v82
v_mfma_f32_16x16x32_bf16 a[40:43],a[248:251],v[104:107],a[40:43]
v_cvt_pk_bf16_f32 v121,v82,v83
v_fma_f32 v81,v81,s36,v18
v_mfma_f32_16x16x32_bf16 a[88:91],a[248:251],v[108:111],a[88:91]
v_exp_f32 v81,v81
v_mfma_f32_16x16x32_bf16 v[204:207],a[252:255],v[96:99],v[204:207]
v_exp_f32 v68,v68
v_mfma_f32_16x16x32_bf16 v[252:255],a[252:255],v[100:103],v[252:255]
v_exp_f32 v88,v88
v_mfma_f32_16x16x32_bf16 a[44:47],a[252:255],v[104:107],a[44:47]
v_fma_f32 v94,v94,s36,v19
v_fma_f32 v85,v85,s36,v18
v_mfma_f32_16x16x32_bf16 a[92:95],a[252:255],v[108:111],a[92:95]
v_exp_f32 v85,v85
v_mfma_f32_16x16x32_bf16 v[32:35],a[192:195],a[96:99],0
ds_read_b128 v[156:159],v23 offset:3072
v_mfma_f32_16x16x32_bf16 v[32:35],a[196:199],a[100:103],v[32:35]
v_exp_f32 v94,v94
v_mfma_f32_16x16x32_bf16 v[32:35],a[200:203],a[104:107],v[32:35]
v_exp_f32 v87,v87
v_mfma_f32_16x16x32_bf16 v[32:35],a[204:207],a[108:111],v[32:35]
v_exp_f32 v80,v80
v_mfma_f32_16x16x32_bf16 v[32:35],a[208:211],a[112:115],v[32:35]
v_exp_f32 v77,v77
v_mfma_f32_16x16x32_bf16 v[32:35],a[212:215],a[116:119],v[32:35]
s_waitcnt lgkmcnt(1)
buffer_store_dwordx4 v[152:155],v0,s[16:19],s27 offen offset:0 nt
v_mfma_f32_16x16x32_bf16 v[40:43],a[192:195],a[120:123],0
v_exp_f32 v84,v84
v_mfma_f32_16x16x32_bf16 v[40:43],a[196:199],a[124:127],v[40:43]
v_exp_f32 v78,v78
v_mfma_f32_16x16x32_bf16 v[40:43],a[200:203],a[128:131],v[40:43]
v_fma_f32 v69,v69,s36,v16
v_cvt_pk_bf16_f32 v127,v94,v95
v_mfma_f32_16x16x32_bf16 v[40:43],a[204:207],a[132:135],v[40:43]
v_exp_f32 v69,v69
v_mfma_f32_16x16x32_bf16 v[40:43],a[208:211],a[136:139],v[40:43]
v_fma_f32 v35,v35,s36,v16
v_cvt_pk_bf16_f32 v120,v80,v81
v_mfma_f32_16x16x32_bf16 v[40:43],a[212:215],a[140:143],v[40:43]
v_exp_f32 v35,v35
v_mfma_f32_16x16x32_bf16 v[48:51],a[192:195],a[144:147],0
ds_read_b128 v[152:155],v31 offset:3072
v_fma_f32 v70,v70,s36,v16
v_mfma_f32_16x16x32_bf16 v[48:51],a[196:199],a[148:151],v[48:51]
v_exp_f32 v70,v70
v_mfma_f32_16x16x32_bf16 v[48:51],a[200:203],a[152:155],v[48:51]
v_cvt_pk_bf16_f32 v115,v70,v71
v_fma_f32 v42,v42,s36,v17
v_mfma_f32_16x16x32_bf16 v[48:51],a[204:207],a[156:159],v[48:51]
v_fma_f32 v43,v43,s36,v17
v_fma_f32 v41,v41,s36,v17
v_mfma_f32_16x16x32_bf16 v[48:51],a[208:211],a[160:163],v[48:51]
s_waitcnt lgkmcnt(1)
buffer_store_dwordx4 v[156:159],v0,s[16:19],s27 offen offset:1024 nt
v_mfma_f32_16x16x32_bf16 v[48:51],a[212:215],a[164:167],v[48:51]
v_exp_f32 v41,v41
v_mfma_f32_16x16x32_bf16 v[56:59],a[192:195],a[168:171],0
v_fma_f32 v33,v33,s36,v16
v_cvt_pk_bf16_f32 v114,v68,v69
v_mfma_f32_16x16x32_bf16 v[56:59],a[196:199],a[172:175],v[56:59]
v_exp_f32 v33,v33
v_mfma_f32_16x16x32_bf16 v[128:131],v[24:27],v[112:115],v[128:131]
v_exp_f32 v42,v42
v_mfma_f32_16x16x32_bf16 v[56:59],a[200:203],a[176:179],v[56:59]
v_cvt_pk_bf16_f32 v118,v76,v77
v_cvt_pk_bf16_f32 v123,v86,v87
v_mfma_f32_16x16x32_bf16 v[56:59],a[204:207],a[180:183],v[56:59]
v_cvt_pk_bf16_f32 v126,v92,v93
v_cvt_pk_bf16_f32 v119,v78,v79
v_mfma_f32_16x16x32_bf16 v[56:59],a[208:211],a[184:187],v[56:59]
v_cvt_pk_bf16_f32 v122,v84,v85
v_fma_f32 v32,v32,s36,v16
v_mfma_f32_16x16x32_bf16 v[132:135],v[24:27],v[116:119],v[132:135]
v_exp_f32 v32,v32
v_mfma_f32_16x16x32_bf16 v[136:139],v[24:27],v[120:123],v[136:139]
v_cvt_pk_bf16_f32 v96,v32,v33
v_cvt_pk_bf16_f32 v124,v88,v89
v_mfma_f32_16x16x32_bf16 v[56:59],a[212:215],a[188:191],v[56:59]
v_fma_f32 v34,v34,s36,v16
v_cvt_pk_bf16_f32 v125,v90,v91
v_mfma_f32_16x16x32_bf16 v[36:39],a[216:219],a[96:99],0
v_exp_f32 v34,v34
v_mfma_f32_16x16x32_bf16 v[140:143],v[24:27],v[124:127],v[140:143]
s_waitcnt lgkmcnt(0)
buffer_store_dwordx4 v[152:155],v0,s[16:19],s27 offen offset:2048 nt
v_mfma_f32_16x16x32_bf16 v[36:39],a[220:223],a[100:103],v[36:39]
s_add_u32 s27,s27,3072
v_fma_f32 v40,v40,s36,v17
v_cvt_pk_bf16_f32 v97,v34,v35
v_mfma_f32_16x16x32_bf16 v[36:39],a[224:227],a[104:107],v[36:39]
v_exp_f32 v40,v40
v_mfma_f32_16x16x32_bf16 v[36:39],a[228:231],a[108:111],v[36:39]
v_exp_f32 v43,v43
s_waitcnt vmcnt(12)
s_barrier
v_mfma_f32_16x16x32_bf16 v[36:39],a[232:235],a[112:115],v[36:39]
v_cvt_pk_bf16_f32 v100,v40,v41
v_cvt_pk_bf16_f32 v101,v42,v43
v_mfma_f32_16x16x32_bf16 v[36:39],a[236:239],a[116:119],v[36:39]
v_mfma_f32_16x16x32_bf16 v[44:47],a[216:219],a[120:123],0
v_mfma_f32_16x16x32_bf16 v[44:47],a[220:223],a[124:127],v[44:47]
v_mfma_f32_16x16x32_bf16 v[44:47],a[224:227],a[128:131],v[44:47]
v_mfma_f32_16x16x32_bf16 v[44:47],a[228:231],a[132:135],v[44:47]
v_mfma_f32_16x16x32_bf16 v[44:47],a[232:235],a[136:139],v[44:47]
ds_read_b64_tr_b16 a[240:241],v3 offset:24576
ds_read_b64_tr_b16 a[242:243],v3 offset:30720
v_mfma_f32_16x16x32_bf16 v[44:47],a[236:239],a[140:143],v[44:47]
v_mfma_f32_16x16x32_bf16 v[52:55],a[216:219],a[144:147],0
ds_read_b64_tr_b16 a[246:247],v4 offset:30720
ds_read_b64_tr_b16 a[244:245],v4 offset:24576
v_mfma_f32_16x16x32_bf16 v[52:55],a[220:223],a[148:151],v[52:55]
v_mfma_f32_16x16x32_bf16 v[52:55],a[224:227],a[152:155],v[52:55]
ds_read_b64_tr_b16 a[250:251],v5 offset:30720
ds_read_b64_tr_b16 a[248:249],v5 offset:24576
v_mfma_f32_16x16x32_bf16 v[52:55],a[228:231],a[156:159],v[52:55]
v_mfma_f32_16x16x32_bf16 v[52:55],a[232:235],a[160:163],v[52:55]
ds_read_b64_tr_b16 a[252:253],v6 offset:24576
ds_read_b64_tr_b16 a[254:255],v6 offset:30720
v_mfma_f32_16x16x32_bf16 v[52:55],a[236:239],a[164:167],v[52:55]
v_mfma_f32_16x16x32_bf16 v[60:63],a[216:219],a[168:171],0
v_mfma_f32_16x16x32_bf16 v[60:63],a[220:223],a[172:175],v[60:63]
v_mfma_f32_16x16x32_bf16 v[60:63],a[224:227],a[176:179],v[60:63]
v_mfma_f32_16x16x32_bf16 v[60:63],a[228:231],a[180:183],v[60:63]
v_mfma_f32_16x16x32_bf16 v[60:63],a[232:235],a[184:187],v[60:63]
v_mfma_f32_16x16x32_bf16 v[60:63],a[236:239],a[188:191],v[60:63]
s_waitcnt lgkmcnt(2)
v_mfma_f32_16x16x32_bf16 v[160:163],a[240:243],v[112:115],v[160:163]
s_add_u32 m0,s23,12288
ds_read_b128 a[192:195],v1 offset:12288
v_fma_f32 v36,v36,s36,v16
v_mfma_f32_16x16x32_bf16 v[208:211],a[240:243],v[116:119],v[208:211]
buffer_load_dwordx4 v7,s[8:11],s21 offen offset:0 lds
v_mfma_f32_16x16x32_bf16 a[0:3],a[240:243],v[120:123],a[0:3]
ds_read_b128 a[196:199],v2 offset:12288
v_fma_f32 v37,v37,s36,v16
v_mfma_f32_16x16x32_bf16 a[48:51],a[240:243],v[124:127],a[48:51]
ds_read_b64_tr_b16 a[240:241],v3 offset:24704
ds_read_b64_tr_b16 a[242:243],v3 offset:30848
v_mfma_f32_16x16x32_bf16 v[164:167],a[244:247],v[112:115],v[164:167]
ds_read_b128 a[200:203],v1 offset:12416
v_fma_f32 v38,v38,s36,v16
v_mfma_f32_16x16x32_bf16 v[212:215],a[244:247],v[116:119],v[212:215]
ds_read_b128 a[204:207],v2 offset:12416
v_fma_f32 v39,v39,s36,v16
v_mfma_f32_16x16x32_bf16 a[4:7],a[244:247],v[120:123],a[4:7]
ds_read_b128 a[208:211],v1 offset:12544
v_fma_f32 v44,v44,s36,v17
v_mfma_f32_16x16x32_bf16 a[52:55],a[244:247],v[124:127],a[52:55]
ds_read_b64_tr_b16 a[244:245],v4 offset:24704
ds_read_b64_tr_b16 a[246:247],v4 offset:30848
v_mfma_f32_16x16x32_bf16 v[168:171],a[248:251],v[112:115],v[168:171]
ds_read_b128 a[212:215],v2 offset:12544
v_fma_f32 v45,v45,s36,v17
v_mfma_f32_16x16x32_bf16 v[216:219],a[248:251],v[116:119],v[216:219]
buffer_load_dwordx4 v8,s[8:11],s21 offen offset:1024 lds
v_mfma_f32_16x16x32_bf16 a[8:11],a[248:251],v[120:123],a[8:11]
ds_read_b128 a[216:219],v1 offset:18432
v_fma_f32 v46,v46,s36,v17
v_mfma_f32_16x16x32_bf16 a[56:59],a[248:251],v[124:127],a[56:59]
s_waitcnt lgkmcnt(8)
ds_read_b64_tr_b16 a[248:249],v5 offset:24704
ds_read_b64_tr_b16 a[250:251],v5 offset:30848
v_mfma_f32_16x16x32_bf16 v[172:175],a[252:255],v[112:115],v[172:175]
ds_read_b128 a[220:223],v2 offset:18432
v_fma_f32 v47,v47,s36,v17
v_mfma_f32_16x16x32_bf16 v[220:223],a[252:255],v[116:119],v[220:223]
ds_read_b128 a[224:227],v1 offset:18560
v_fma_f32 v48,v48,s36,v18
v_mfma_f32_16x16x32_bf16 a[12:15],a[252:255],v[120:123],a[12:15]
ds_read_b128 a[228:231],v2 offset:18560
v_fma_f32 v49,v49,s36,v18
v_mfma_f32_16x16x32_bf16 a[60:63],a[252:255],v[124:127],a[60:63]
s_waitcnt lgkmcnt(7)
ds_read_b64_tr_b16 a[252:253],v6 offset:24704
ds_read_b64_tr_b16 a[254:255],v6 offset:30848
v_mfma_f32_16x16x32_bf16 v[176:179],a[240:243],v[112:115],v[176:179]
ds_read_b128 a[232:235],v1 offset:18688
v_fma_f32 v50,v50,s36,v18
v_mfma_f32_16x16x32_bf16 v[224:227],a[240:243],v[116:119],v[224:227]
buffer_load_dwordx4 v9,s[8:11],s21 offen offset:2048 lds
v_mfma_f32_16x16x32_bf16 a[16:19],a[240:243],v[120:123],a[16:19]
s_add_u32 s21,s21,12288
ds_read_b128 a[236:239],v2 offset:18688
v_fma_f32 v51,v51,s36,v18
v_mfma_f32_16x16x32_bf16 a[64:67],a[240:243],v[124:127],a[64:67]
s_add_u32 m0,s22,0
ds_read_b64_tr_b16 a[240:241],v3 offset:24832
ds_read_b64_tr_b16 a[242:243],v3 offset:30976
v_mfma_f32_16x16x32_bf16 v[180:183],a[244:247],v[112:115],v[180:183]
v_fma_f32 v52,v52,s36,v18
v_fma_f32 v53,v53,s36,v18
v_mfma_f32_16x16x32_bf16 v[228:231],a[244:247],v[116:119],v[228:231]
v_fma_f32 v54,v54,s36,v18
v_fma_f32 v55,v55,s36,v18
v_mfma_f32_16x16x32_bf16 a[20:23],a[244:247],v[120:123],a[20:23]
v_fma_f32 v56,v56,s36,v19
v_fma_f32 v57,v57,s36,v19
v_mfma_f32_16x16x32_bf16 a[68:71],a[244:247],v[124:127],a[68:71]
s_waitcnt lgkmcnt(4)
ds_read_b64_tr_b16 a[244:245],v4 offset:24832
ds_read_b64_tr_b16 a[246:247],v4 offset:30976
v_mfma_f32_16x16x32_bf16 v[184:187],a[248:251],v[112:115],v[184:187]
buffer_load_dwordx4 v7,s[4:7],s20 offen offset:0 lds
v_mfma_f32_16x16x32_bf16 v[232:235],a[248:251],v[116:119],v[232:235]
v_fma_f32 v58,v58,s36,v19
v_fma_f32 v59,v59,s36,v19
v_mfma_f32_16x16x32_bf16 a[24:27],a[248:251],v[120:123],a[24:27]
v_fma_f32 v60,v60,s36,v19
v_fma_f32 v61,v61,s36,v19
v_mfma_f32_16x16x32_bf16 a[72:75],a[248:251],v[124:127],a[72:75]
ds_read_b64_tr_b16 a[248:249],v5 offset:24832
ds_read_b64_tr_b16 a[250:251],v5 offset:30976
v_mfma_f32_16x16x32_bf16 v[188:191],a[252:255],v[112:115],v[188:191]
v_fma_f32 v62,v62,s36,v19
v_fma_f32 v63,v63,s36,v19
v_mfma_f32_16x16x32_bf16 v[236:239],a[252:255],v[116:119],v[236:239]
v_exp_f32 v36,v36
v_mfma_f32_16x16x32_bf16 a[28:31],a[252:255],v[120:123],a[28:31]
v_exp_f32 v37,v37
v_mfma_f32_16x16x32_bf16 a[76:79],a[252:255],v[124:127],a[76:79]
s_waitcnt lgkmcnt(2)
ds_read_b64_tr_b16 a[252:253],v6 offset:24832
ds_read_b64_tr_b16 a[254:255],v6 offset:30976
v_mfma_f32_16x16x32_bf16 v[192:195],a[240:243],v[112:115],v[192:195]
buffer_load_dwordx4 v8,s[4:7],s20 offen offset:1024 lds
v_mfma_f32_16x16x32_bf16 v[240:243],a[240:243],v[116:119],v[240:243]
v_exp_f32 v38,v38
v_mfma_f32_16x16x32_bf16 a[32:35],a[240:243],v[120:123],a[32:35]
v_exp_f32 v39,v39
v_mfma_f32_16x16x32_bf16 a[80:83],a[240:243],v[124:127],a[80:83]
v_exp_f32 v44,v44
v_mfma_f32_16x16x32_bf16 v[196:199],a[244:247],v[112:115],v[196:199]
v_exp_f32 v45,v45
v_mfma_f32_16x16x32_bf16 v[244:247],a[244:247],v[116:119],v[244:247]
v_exp_f32 v46,v46
v_mfma_f32_16x16x32_bf16 a[36:39],a[244:247],v[120:123],a[36:39]
v_exp_f32 v47,v47
v_mfma_f32_16x16x32_bf16 a[84:87],a[244:247],v[124:127],a[84:87]
s_waitcnt lgkmcnt(0)
v_exp_f32 v48,v48
v_mfma_f32_16x16x32_bf16 v[200:203],a[248:251],v[112:115],v[200:203]
buffer_load_dwordx4 v9,s[4:7],s20 offen offset:2048 lds
v_mfma_f32_16x16x32_bf16 v[248:251],a[248:251],v[116:119],v[248:251]
s_add_u32 s20,s20,12288
v_exp_f32 v49,v49
v_mfma_f32_16x16x32_bf16 a[40:43],a[248:251],v[120:123],a[40:43]
s_add_u32 m0,s29,0
v_exp_f32 v50,v50
v_mfma_f32_16x16x32_bf16 a[88:91],a[248:251],v[124:127],a[88:91]
v_exp_f32 v51,v51
v_mfma_f32_16x16x32_bf16 v[204:207],a[252:255],v[112:115],v[204:207]
v_exp_f32 v52,v52
v_mfma_f32_16x16x32_bf16 v[252:255],a[252:255],v[116:119],v[252:255]
v_exp_f32 v53,v53
v_mfma_f32_16x16x32_bf16 a[44:47],a[252:255],v[120:123],a[44:47]
v_exp_f32 v54,v54
v_mfma_f32_16x16x32_bf16 a[92:95],a[252:255],v[124:127],a[92:95]
v_exp_f32 v55,v55
v_mfma_f32_16x16x32_bf16 v[64:67],a[192:195],a[96:99],0
v_exp_f32 v56,v56
v_mfma_f32_16x16x32_bf16 v[64:67],a[196:199],a[100:103],v[64:67]
v_exp_f32 v57,v57
v_mfma_f32_16x16x32_bf16 v[64:67],a[200:203],a[104:107],v[64:67]
v_exp_f32 v58,v58
v_mfma_f32_16x16x32_bf16 v[64:67],a[204:207],a[108:111],v[64:67]
v_exp_f32 v59,v59
v_mfma_f32_16x16x32_bf16 v[64:67],a[208:211],a[112:115],v[64:67]
v_exp_f32 v60,v60
v_mfma_f32_16x16x32_bf16 v[64:67],a[212:215],a[116:119],v[64:67]
buffer_load_dwordx4 v7,s[12:15],s28 offen offset:0 nt lds
v_mfma_f32_16x16x32_bf16 v[72:75],a[192:195],a[120:123],0
v_exp_f32 v61,v61
v_mfma_f32_16x16x32_bf16 v[72:75],a[196:199],a[124:127],v[72:75]
v_exp_f32 v62,v62
v_mfma_f32_16x16x32_bf16 v[72:75],a[200:203],a[128:131],v[72:75]
v_exp_f32 v63,v63
v_mfma_f32_16x16x32_bf16 v[72:75],a[204:207],a[132:135],v[72:75]
v_cvt_pk_bf16_f32 v98,v36,v37
v_cvt_pk_bf16_f32 v99,v38,v39
v_mfma_f32_16x16x32_bf16 v[72:75],a[208:211],a[136:139],v[72:75]
v_cvt_pk_bf16_f32 v102,v44,v45
v_cvt_pk_bf16_f32 v103,v46,v47
v_mfma_f32_16x16x32_bf16 v[128:131],v[24:27],v[96:99],v[128:131]
v_cvt_pk_bf16_f32 v104,v48,v49
v_cvt_pk_bf16_f32 v105,v50,v51
v_mfma_f32_16x16x32_bf16 v[132:135],v[24:27],v[100:103],v[132:135]
v_cvt_pk_bf16_f32 v106,v52,v53
v_cvt_pk_bf16_f32 v107,v54,v55
v_mfma_f32_16x16x32_bf16 v[72:75],a[212:215],a[140:143],v[72:75]
v_cvt_pk_bf16_f32 v108,v56,v57
v_cvt_pk_bf16_f32 v109,v58,v59
v_mfma_f32_16x16x32_bf16 v[136:139],v[24:27],v[104:107],v[136:139]
v_cvt_pk_bf16_f32 v110,v60,v61
v_cvt_pk_bf16_f32 v111,v62,v63
v_mfma_f32_16x16x32_bf16 v[80:83],a[192:195],a[144:147],0
v_fma_f32 v64,v64,s36,v16
v_fma_f32 v65,v65,s36,v16
v_mfma_f32_16x16x32_bf16 v[140:143],v[24:27],v[108:111],v[140:143]
buffer_load_dwordx4 v8,s[12:15],s28 offen offset:1024 nt lds
v_mfma_f32_16x16x32_bf16 v[80:83],a[196:199],a[148:151],v[80:83]
v_fma_f32 v66,v66,s36,v16
v_fma_f32 v67,v67,s36,v16
v_mfma_f32_16x16x32_bf16 v[80:83],a[200:203],a[152:155],v[80:83]
v_fma_f32 v72,v72,s36,v17
v_fma_f32 v73,v73,s36,v17
v_mfma_f32_16x16x32_bf16 v[80:83],a[204:207],a[156:159],v[80:83]
v_fma_f32 v74,v74,s36,v17
v_fma_f32 v75,v75,s36,v17
v_mfma_f32_16x16x32_bf16 v[80:83],a[208:211],a[160:163],v[80:83]
v_exp_f32 v64,v64
v_mfma_f32_16x16x32_bf16 v[80:83],a[212:215],a[164:167],v[80:83]
v_exp_f32 v65,v65
v_mfma_f32_16x16x32_bf16 v[88:91],a[192:195],a[168:171],0
v_exp_f32 v66,v66
v_mfma_f32_16x16x32_bf16 v[88:91],a[196:199],a[172:175],v[88:91]
v_exp_f32 v67,v67
v_mfma_f32_16x16x32_bf16 v[88:91],a[200:203],a[176:179],v[88:91]
v_exp_f32 v72,v72
v_mfma_f32_16x16x32_bf16 v[88:91],a[204:207],a[180:183],v[88:91]
v_exp_f32 v73,v73
v_mfma_f32_16x16x32_bf16 v[88:91],a[208:211],a[184:187],v[88:91]
v_exp_f32 v74,v74
v_mfma_f32_16x16x32_bf16 v[88:91],a[212:215],a[188:191],v[88:91]
v_exp_f32 v75,v75
v_mfma_f32_16x16x32_bf16 v[68:71],a[216:219],a[96:99],0
buffer_load_dwordx4 v9,s[12:15],s28 offen offset:2048 nt lds
v_mfma_f32_16x16x32_bf16 v[68:71],a[220:223],a[100:103],v[68:71]
s_add_u32 s28,s28,3072
v_cvt_pk_bf16_f32 v112,v64,v65
v_cvt_pk_bf16_f32 v113,v66,v67
v_mfma_f32_16x16x32_bf16 v[68:71],a[224:227],a[104:107],v[68:71]
s_add_u32 s29,s29,3072
v_cvt_pk_bf16_f32 v116,v72,v73
v_cvt_pk_bf16_f32 v117,v74,v75
v_mfma_f32_16x16x32_bf16 v[68:71],a[228:231],a[108:111],v[68:71]
v_mfma_f32_16x16x32_bf16 v[68:71],a[232:235],a[112:115],v[68:71]
s_waitcnt vmcnt(12)
s_barrier
v_mfma_f32_16x16x32_bf16 v[68:71],a[236:239],a[116:119],v[68:71]
v_mfma_f32_16x16x32_bf16 v[76:79],a[216:219],a[120:123],0
v_mfma_f32_16x16x32_bf16 v[76:79],a[220:223],a[124:127],v[76:79]
v_mfma_f32_16x16x32_bf16 v[76:79],a[224:227],a[128:131],v[76:79]
v_mfma_f32_16x16x32_bf16 v[76:79],a[228:231],a[132:135],v[76:79]
v_mfma_f32_16x16x32_bf16 v[76:79],a[232:235],a[136:139],v[76:79]
v_mfma_f32_16x16x32_bf16 v[76:79],a[236:239],a[140:143],v[76:79]
ds_read_b64_tr_b16 a[240:241],v3 offset:0
ds_read_b64_tr_b16 a[242:243],v3 offset:6144
v_mfma_f32_16x16x32_bf16 v[84:87],a[216:219],a[144:147],0
v_mfma_f32_16x16x32_bf16 v[84:87],a[220:223],a[148:151],v[84:87]
ds_read_b64_tr_b16 a[244:245],v4 offset:0
ds_read_b64_tr_b16 a[246:247],v4 offset:6144
v_mfma_f32_16x16x32_bf16 v[84:87],a[224:227],a[152:155],v[84:87]
v_mfma_f32_16x16x32_bf16 v[84:87],a[228:231],a[156:159],v[84:87]
ds_read_b64_tr_b16 a[248:249],v5 offset:0
ds_read_b64_tr_b16 a[250:251],v5 offset:6144
v_mfma_f32_16x16x32_bf16 v[84:87],a[232:235],a[160:163],v[84:87]
v_mfma_f32_16x16x32_bf16 v[84:87],a[236:239],a[164:167],v[84:87]
ds_read_b64_tr_b16 a[252:253],v6 offset:0
ds_read_b64_tr_b16 a[254:255],v6 offset:6144
v_mfma_f32_16x16x32_bf16 v[92:95],a[216:219],a[168:171],0
v_mfma_f32_16x16x32_bf16 v[92:95],a[220:223],a[172:175],v[92:95]
v_mfma_f32_16x16x32_bf16 v[92:95],a[224:227],a[176:179],v[92:95]
v_mfma_f32_16x16x32_bf16 v[92:95],a[228:231],a[180:183],v[92:95]
v_mfma_f32_16x16x32_bf16 v[92:95],a[232:235],a[184:187],v[92:95]
v_mfma_f32_16x16x32_bf16 v[92:95],a[236:239],a[188:191],v[92:95]
s_waitcnt lgkmcnt(4)
v_mfma_f32_16x16x32_bf16 v[160:163],a[240:243],v[96:99],v[160:163]
s_add_u32 m0,s23,24576
ds_read_b128 a[192:195],v1 offset:24576
v_fma_f32 v86,v86,s36,v18
v_mfma_f32_16x16x32_bf16 v[208:211],a[240:243],v[100:103],v[208:211]
buffer_load_dwordx4 v7,s[8:11],s21 offen offset:0 lds
v_mfma_f32_16x16x32_bf16 a[0:3],a[240:243],v[104:107],a[0:3]
ds_read_b128 a[196:199],v2 offset:24576
v_fma_f32 v90,v90,s36,v19
v_mfma_f32_16x16x32_bf16 a[48:51],a[240:243],v[108:111],a[48:51]
ds_read_b64_tr_b16 a[240:241],v3 offset:128
ds_read_b64_tr_b16 a[242:243],v3 offset:6272
v_mfma_f32_16x16x32_bf16 v[164:167],a[244:247],v[96:99],v[164:167]
ds_read_b128 a[200:203],v1 offset:24704
v_fma_f32 v93,v93,s36,v19
v_mfma_f32_16x16x32_bf16 v[212:215],a[244:247],v[100:103],v[212:215]
ds_read_b128 a[204:207],v2 offset:24704
v_fma_f32 v95,v95,s36,v19
v_mfma_f32_16x16x32_bf16 a[4:7],a[244:247],v[104:107],a[4:7]
ds_read_b128 a[208:211],v1 offset:24832
v_fma_f32 v78,v78,s36,v17
v_mfma_f32_16x16x32_bf16 a[52:55],a[244:247],v[108:111],a[52:55]
s_waitcnt lgkmcnt(7)
ds_read_b64_tr_b16 a[244:245],v4 offset:128
ds_read_b64_tr_b16 a[246:247],v4 offset:6272
v_mfma_f32_16x16x32_bf16 v[168:171],a[248:251],v[96:99],v[168:171]
ds_read_b128 a[212:215],v2 offset:24832
v_fma_f32 v89,v89,s36,v19
v_mfma_f32_16x16x32_bf16 v[216:219],a[248:251],v[100:103],v[216:219]
buffer_load_dwordx4 v8,s[8:11],s21 offen offset:1024 lds
v_mfma_f32_16x16x32_bf16 a[8:11],a[248:251],v[104:107],a[8:11]
ds_read_b128 a[216:219],v1 offset:30720
v_fma_f32 v68,v68,s36,v16
v_mfma_f32_16x16x32_bf16 a[56:59],a[248:251],v[108:111],a[56:59]
ds_read_b64_tr_b16 a[250:251],v5 offset:6272
ds_read_b64_tr_b16 a[248:249],v5 offset:128
v_mfma_f32_16x16x32_bf16 v[172:175],a[252:255],v[96:99],v[172:175]
ds_read_b128 a[220:223],v2 offset:30720
v_fma_f32 v92,v92,s36,v19
v_mfma_f32_16x16x32_bf16 v[220:223],a[252:255],v[100:103],v[220:223]
ds_read_b128 a[224:227],v1 offset:30848
v_fma_f32 v79,v79,s36,v17
v_mfma_f32_16x16x32_bf16 a[12:15],a[252:255],v[104:107],a[12:15]
ds_read_b128 a[228:231],v2 offset:30848
v_fma_f32 v91,v91,s36,v19
v_mfma_f32_16x16x32_bf16 a[60:63],a[252:255],v[108:111],a[60:63]
s_waitcnt lgkmcnt(7)
ds_read_b64_tr_b16 a[254:255],v6 offset:6272
ds_read_b64_tr_b16 a[252:253],v6 offset:128
v_mfma_f32_16x16x32_bf16 v[176:179],a[240:243],v[96:99],v[176:179]
ds_read_b128 a[232:235],v1 offset:30976
v_fma_f32 v71,v71,s36,v16
v_mfma_f32_16x16x32_bf16 v[224:227],a[240:243],v[100:103],v[224:227]
buffer_load_dwordx4 v9,s[8:11],s21 offen offset:2048 lds
v_mfma_f32_16x16x32_bf16 a[16:19],a[240:243],v[104:107],a[16:19]
s_add_u32 s21,s21,12288
ds_read_b128 a[236:239],v2 offset:30976
v_fma_f32 v88,v88,s36,v19
v_mfma_f32_16x16x32_bf16 a[64:67],a[240:243],v[108:111],a[64:67]
s_mov_b32 m0,s25
ds_read_b64_tr_b16 a[242:243],v3 offset:6400
ds_read_b64_tr_b16 a[240:241],v3 offset:256
v_mfma_f32_16x16x32_bf16 v[180:183],a[244:247],v[96:99],v[180:183]
v_exp_f32 v90,v90
v_mfma_f32_16x16x32_bf16 v[228:231],a[244:247],v[100:103],v[228:231]
v_exp_f32 v79,v79
v_mfma_f32_16x16x32_bf16 a[20:23],a[244:247],v[104:107],a[20:23]
v_exp_f32 v86,v86
v_mfma_f32_16x16x32_bf16 a[68:71],a[244:247],v[108:111],a[68:71]
s_waitcnt lgkmcnt(4)
ds_read_b64_tr_b16 a[246:247],v4 offset:6400
ds_read_b64_tr_b16 a[244:245],v4 offset:256
v_mfma_f32_16x16x32_bf16 v[184:187],a[248:251],v[96:99],v[184:187]
buffer_load_dwordx4 v7,s[4:7],s20 offen offset:0 lds
v_mfma_f32_16x16x32_bf16 v[232:235],a[248:251],v[100:103],v[232:235]
v_exp_f32 v91,v91
v_mfma_f32_16x16x32_bf16 a[24:27],a[248:251],v[104:107],a[24:27]
v_exp_f32 v92,v92
v_mfma_f32_16x16x32_bf16 a[72:75],a[248:251],v[108:111],a[72:75]
ds_read_b64_tr_b16 a[248:249],v5 offset:256
ds_read_b64_tr_b16 a[250:251],v5 offset:6400
v_mfma_f32_16x16x32_bf16 v[188:191],a[252:255],v[96:99],v[188:191]
v_exp_f32 v89,v89
v_mfma_f32_16x16x32_bf16 v[236:239],a[252:255],v[100:103],v[236:239]
v_exp_f32 v95,v95
v_mfma_f32_16x16x32_bf16 a[28:31],a[252:255],v[104:107],a[28:31]
v_fma_f32 v82,v82,s36,v18
v_fma_f32 v83,v83,s36,v18
v_mfma_f32_16x16x32_bf16 a[76:79],a[252:255],v[108:111],a[76:79]
s_waitcnt lgkmcnt(2)
ds_read_b64_tr_b16 a[252:253],v6 offset:256
ds_read_b64_tr_b16 a[254:255],v6 offset:6400
v_mfma_f32_16x16x32_bf16 v[192:195],a[240:243],v[96:99],v[192:195]
buffer_load_dwordx4 v8,s[4:7],s20 offen offset:1024 lds
v_mfma_f32_16x16x32_bf16 v[240:243],a[240:243],v[100:103],v[240:243]
v_exp_f32 v83,v83
v_mfma_f32_16x16x32_bf16 a[32:35],a[240:243],v[104:107],a[32:35]
v_fma_f32 v80,v80,s36,v18
v_fma_f32 v77,v77,s36,v17
v_mfma_f32_16x16x32_bf16 a[80:83],a[240:243],v[108:111],a[80:83]
v_exp_f32 v93,v93
v_mfma_f32_16x16x32_bf16 v[196:199],a[244:247],v[96:99],v[196:199]
v_fma_f32 v76,v76,s36,v17
v_fma_f32 v84,v84,s36,v18
v_mfma_f32_16x16x32_bf16 v[244:247],a[244:247],v[100:103],v[244:247]
ds_read_b128 v[156:159],v11 offset:6144
v_fma_f32 v87,v87,s36,v18
v_mfma_f32_16x16x32_bf16 a[36:39],a[244:247],v[104:107],a[36:39]
v_exp_f32 v76,v76
v_mfma_f32_16x16x32_bf16 a[84:87],a[244:247],v[108:111],a[84:87]
s_waitcnt lgkmcnt(1)
v_exp_f32 v71,v71
v_mfma_f32_16x16x32_bf16 v[200:203],a[248:251],v[96:99],v[200:203]
buffer_load_dwordx4 v9,s[4:7],s20 offen offset:2048 lds
v_mfma_f32_16x16x32_bf16 v[248:251],a[248:251],v[100:103],v[248:251]
s_add_u32 s20,s20,12288
v_exp_f32 v82,v82
v_mfma_f32_16x16x32_bf16 a[40:43],a[248:251],v[104:107],a[40:43]
v_cvt_pk_bf16_f32 v121,v82,v83
v_fma_f32 v81,v81,s36,v18
v_mfma_f32_16x16x32_bf16 a[88:91],a[248:251],v[108:111],a[88:91]
v_exp_f32 v81,v81
v_mfma_f32_16x16x32_bf16 v[204:207],a[252:255],v[96:99],v[204:207]
v_exp_f32 v68,v68
v_mfma_f32_16x16x32_bf16 v[252:255],a[252:255],v[100:103],v[252:255]
v_exp_f32 v88,v88
v_mfma_f32_16x16x32_bf16 a[44:47],a[252:255],v[104:107],a[44:47]
v_fma_f32 v94,v94,s36,v19
v_fma_f32 v85,v85,s36,v18
v_mfma_f32_16x16x32_bf16 a[92:95],a[252:255],v[108:111],a[92:95]
v_exp_f32 v85,v85
v_mfma_f32_16x16x32_bf16 v[32:35],a[192:195],a[96:99],0
ds_read_b128 v[152:155],v23 offset:6144
v_mfma_f32_16x16x32_bf16 v[32:35],a[196:199],a[100:103],v[32:35]
v_exp_f32 v94,v94
v_mfma_f32_16x16x32_bf16 v[32:35],a[200:203],a[104:107],v[32:35]
v_exp_f32 v87,v87
v_mfma_f32_16x16x32_bf16 v[32:35],a[204:207],a[108:111],v[32:35]
v_exp_f32 v80,v80
v_mfma_f32_16x16x32_bf16 v[32:35],a[208:211],a[112:115],v[32:35]
v_exp_f32 v77,v77
v_mfma_f32_16x16x32_bf16 v[32:35],a[212:215],a[116:119],v[32:35]
s_waitcnt lgkmcnt(1)
buffer_store_dwordx4 v[156:159],v0,s[16:19],s27 offen offset:0 nt
v_mfma_f32_16x16x32_bf16 v[40:43],a[192:195],a[120:123],0
v_exp_f32 v84,v84
v_mfma_f32_16x16x32_bf16 v[40:43],a[196:199],a[124:127],v[40:43]
v_exp_f32 v78,v78
v_mfma_f32_16x16x32_bf16 v[40:43],a[200:203],a[128:131],v[40:43]
v_fma_f32 v69,v69,s36,v16
v_cvt_pk_bf16_f32 v127,v94,v95
v_mfma_f32_16x16x32_bf16 v[40:43],a[204:207],a[132:135],v[40:43]
v_exp_f32 v69,v69
v_mfma_f32_16x16x32_bf16 v[40:43],a[208:211],a[136:139],v[40:43]
v_fma_f32 v35,v35,s36,v16
v_cvt_pk_bf16_f32 v120,v80,v81
v_mfma_f32_16x16x32_bf16 v[40:43],a[212:215],a[140:143],v[40:43]
v_exp_f32 v35,v35
v_mfma_f32_16x16x32_bf16 v[48:51],a[192:195],a[144:147],0
ds_read_b128 v[156:159],v31 offset:6144
v_fma_f32 v70,v70,s36,v16
v_mfma_f32_16x16x32_bf16 v[48:51],a[196:199],a[148:151],v[48:51]
v_exp_f32 v70,v70
v_mfma_f32_16x16x32_bf16 v[48:51],a[200:203],a[152:155],v[48:51]
v_cvt_pk_bf16_f32 v115,v70,v71
v_fma_f32 v42,v42,s36,v17
v_mfma_f32_16x16x32_bf16 v[48:51],a[204:207],a[156:159],v[48:51]
v_fma_f32 v43,v43,s36,v17
v_fma_f32 v41,v41,s36,v17
v_mfma_f32_16x16x32_bf16 v[48:51],a[208:211],a[160:163],v[48:51]
s_waitcnt lgkmcnt(1)
buffer_store_dwordx4 v[152:155],v0,s[16:19],s27 offen offset:1024 nt
v_mfma_f32_16x16x32_bf16 v[48:51],a[212:215],a[164:167],v[48:51]
v_exp_f32 v41,v41
v_mfma_f32_16x16x32_bf16 v[56:59],a[192:195],a[168:171],0
v_fma_f32 v33,v33,s36,v16
v_cvt_pk_bf16_f32 v114,v68,v69
v_mfma_f32_16x16x32_bf16 v[56:59],a[196:199],a[172:175],v[56:59]
v_exp_f32 v33,v33
v_mfma_f32_16x16x32_bf16 v[128:131],v[24:27],v[112:115],v[128:131]
v_exp_f32 v42,v42
v_mfma_f32_16x16x32_bf16 v[56:59],a[200:203],a[176:179],v[56:59]
v_cvt_pk_bf16_f32 v118,v76,v77
v_cvt_pk_bf16_f32 v123,v86,v87
v_mfma_f32_16x16x32_bf16 v[56:59],a[204:207],a[180:183],v[56:59]
v_cvt_pk_bf16_f32 v126,v92,v93
v_cvt_pk_bf16_f32 v119,v78,v79
v_mfma_f32_16x16x32_bf16 v[56:59],a[208:211],a[184:187],v[56:59]
v_cvt_pk_bf16_f32 v122,v84,v85
v_fma_f32 v32,v32,s36,v16
v_mfma_f32_16x16x32_bf16 v[132:135],v[24:27],v[116:119],v[132:135]
v_exp_f32 v32,v32
v_mfma_f32_16x16x32_bf16 v[136:139],v[24:27],v[120:123],v[136:139]
v_cvt_pk_bf16_f32 v96,v32,v33
v_cvt_pk_bf16_f32 v124,v88,v89
v_mfma_f32_16x16x32_bf16 v[56:59],a[212:215],a[188:191],v[56:59]
v_fma_f32 v34,v34,s36,v16
v_cvt_pk_bf16_f32 v125,v90,v91
v_mfma_f32_16x16x32_bf16 v[36:39],a[216:219],a[96:99],0
v_exp_f32 v34,v34
v_mfma_f32_16x16x32_bf16 v[140:143],v[24:27],v[124:127],v[140:143]
s_waitcnt lgkmcnt(0)
buffer_store_dwordx4 v[156:159],v0,s[16:19],s27 offen offset:2048 nt
v_mfma_f32_16x16x32_bf16 v[36:39],a[220:223],a[100:103],v[36:39]
s_add_u32 s27,s27,3072
v_fma_f32 v40,v40,s36,v17
v_cvt_pk_bf16_f32 v97,v34,v35
v_mfma_f32_16x16x32_bf16 v[36:39],a[224:227],a[104:107],v[36:39]
v_exp_f32 v40,v40
v_mfma_f32_16x16x32_bf16 v[36:39],a[228:231],a[108:111],v[36:39]
v_exp_f32 v43,v43
s_waitcnt vmcnt(12)
s_barrier
v_mfma_f32_16x16x32_bf16 v[36:39],a[232:235],a[112:115],v[36:39]
v_cvt_pk_bf16_f32 v100,v40,v41
v_cvt_pk_bf16_f32 v101,v42,v43
v_mfma_f32_16x16x32_bf16 v[36:39],a[236:239],a[116:119],v[36:39]
v_mfma_f32_16x16x32_bf16 v[44:47],a[216:219],a[120:123],0
v_mfma_f32_16x16x32_bf16 v[44:47],a[220:223],a[124:127],v[44:47]
v_mfma_f32_16x16x32_bf16 v[44:47],a[224:227],a[128:131],v[44:47]
v_mfma_f32_16x16x32_bf16 v[44:47],a[228:231],a[132:135],v[44:47]
v_mfma_f32_16x16x32_bf16 v[44:47],a[232:235],a[136:139],v[44:47]
ds_read_b64_tr_b16 a[240:241],v3 offset:12288
ds_read_b64_tr_b16 a[242:243],v3 offset:18432
v_mfma_f32_16x16x32_bf16 v[44:47],a[236:239],a[140:143],v[44:47]
v_mfma_f32_16x16x32_bf16 v[52:55],a[216:219],a[144:147],0
ds_read_b64_tr_b16 a[246:247],v4 offset:18432
ds_read_b64_tr_b16 a[244:245],v4 offset:12288
v_mfma_f32_16x16x32_bf16 v[52:55],a[220:223],a[148:151],v[52:55]
v_mfma_f32_16x16x32_bf16 v[52:55],a[224:227],a[152:155],v[52:55]
ds_read_b64_tr_b16 a[250:251],v5 offset:18432
ds_read_b64_tr_b16 a[248:249],v5 offset:12288
v_mfma_f32_16x16x32_bf16 v[52:55],a[228:231],a[156:159],v[52:55]
v_mfma_f32_16x16x32_bf16 v[52:55],a[232:235],a[160:163],v[52:55]
ds_read_b64_tr_b16 a[252:253],v6 offset:12288
ds_read_b64_tr_b16 a[254:255],v6 offset:18432
v_mfma_f32_16x16x32_bf16 v[52:55],a[236:239],a[164:167],v[52:55]
v_mfma_f32_16x16x32_bf16 v[60:63],a[216:219],a[168:171],0
v_mfma_f32_16x16x32_bf16 v[60:63],a[220:223],a[172:175],v[60:63]
v_mfma_f32_16x16x32_bf16 v[60:63],a[224:227],a[176:179],v[60:63]
v_mfma_f32_16x16x32_bf16 v[60:63],a[228:231],a[180:183],v[60:63]
v_mfma_f32_16x16x32_bf16 v[60:63],a[232:235],a[184:187],v[60:63]
v_mfma_f32_16x16x32_bf16 v[60:63],a[236:239],a[188:191],v[60:63]
s_waitcnt lgkmcnt(2)
v_mfma_f32_16x16x32_bf16 v[160:163],a[240:243],v[112:115],v[160:163]
s_add_u32 m0,s23,0
ds_read_b128 a[192:195],v1 offset:0
v_fma_f32 v49,v49,s36,v18
v_mfma_f32_16x16x32_bf16 v[208:211],a[240:243],v[116:119],v[208:211]
buffer_load_dwordx4 v7,s[8:11],s21 offen offset:0 lds
v_mfma_f32_16x16x32_bf16 a[0:3],a[240:243],v[120:123],a[0:3]
ds_read_b128 a[196:199],v2 offset:0
v_fma_f32 v38,v38,s36,v16
v_mfma_f32_16x16x32_bf16 a[48:51],a[240:243],v[124:127],a[48:51]
ds_read_b64_tr_b16 a[240:241],v3 offset:12416
ds_read_b64_tr_b16 a[242:243],v3 offset:18560
v_mfma_f32_16x16x32_bf16 v[164:167],a[244:247],v[112:115],v[164:167]
ds_read_b128 a[200:203],v1 offset:128
v_fma_f32 v57,v57,s36,v19
v_mfma_f32_16x16x32_bf16 v[212:215],a[244:247],v[116:119],v[212:215]
ds_read_b128 a[204:207],v2 offset:128
v_fma_f32 v52,v52,s36,v18
v_mfma_f32_16x16x32_bf16 a[4:7],a[244:247],v[120:123],a[4:7]
ds_read_b128 a[208:211],v1 offset:256
v_fma_f32 v61,v61,s36,v19
v_mfma_f32_16x16x32_bf16 a[52:55],a[244:247],v[124:127],a[52:55]
ds_read_b64_tr_b16 a[244:245],v4 offset:12416
ds_read_b64_tr_b16 a[246:247],v4 offset:18560
v_mfma_f32_16x16x32_bf16 v[168:171],a[248:251],v[112:115],v[168:171]
ds_read_b128 a[212:215],v2 offset:256
v_fma_f32 v59,v59,s36,v19
v_mfma_f32_16x16x32_bf16 v[216:219],a[248:251],v[116:119],v[216:219]
buffer_load_dwordx4 v8,s[8:11],s21 offen offset:1024 lds
v_mfma_f32_16x16x32_bf16 a[8:11],a[248:251],v[120:123],a[8:11]
ds_read_b128 a[216:219],v1 offset:6144
v_fma_f32 v58,v58,s36,v19
v_mfma_f32_16x16x32_bf16 a[56:59],a[248:251],v[124:127],a[56:59]
s_waitcnt lgkmcnt(8)
ds_read_b64_tr_b16 a[248:249],v5 offset:12416
ds_read_b64_tr_b16 a[250:251],v5 offset:18560
v_mfma_f32_16x16x32_bf16 v[172:175],a[252:255],v[112:115],v[172:175]
ds_read_b128 a[220:223],v2 offset:6144
v_fma_f32 v37,v37,s36,v16
v_mfma_f32_16x16x32_bf16 v[220:223],a[252:255],v[116:119],v[220:223]
ds_read_b128 a[224:227],v1 offset:6272
v_fma_f32 v62,v62,s36,v19
v_mfma_f32_16x16x32_bf16 a[12:15],a[252:255],v[120:123],a[12:15]
ds_read_b128 a[228:231],v2 offset:6272
v_fma_f32 v45,v45,s36,v17
v_mfma_f32_16x16x32_bf16 a[60:63],a[252:255],v[124:127],a[60:63]
s_waitcnt lgkmcnt(7)
ds_read_b64_tr_b16 a[252:253],v6 offset:12416
ds_read_b64_tr_b16 a[254:255],v6 offset:18560
v_mfma_f32_16x16x32_bf16 v[176:179],a[240:243],v[112:115],v[176:179]
ds_read_b128 a[232:235],v1 offset:6400
v_fma_f32 v47,v47,s36,v17
v_mfma_f32_16x16x32_bf16 v[224:227],a[240:243],v[116:119],v[224:227]
buffer_load_dwordx4 v9,s[8:11],s21 offen offset:2048 lds
v_mfma_f32_16x16x32_bf16 a[16:19],a[240:243],v[120:123],a[16:19]
s_add_u32 s21,s21,12288
ds_read_b128 a[236:239],v2 offset:6400
v_fma_f32 v54,v54,s36,v18
v_mfma_f32_16x16x32_bf16 a[64:67],a[240:243],v[124:127],a[64:67]
s_mov_b32 m0,s26
ds_read_b64_tr_b16 a[242:243],v3 offset:18688
ds_read_b64_tr_b16 a[240:241],v3 offset:12544
v_mfma_f32_16x16x32_bf16 v[180:183],a[244:247],v[112:115],v[180:183]
v_exp_f32 v47,v47
v_mfma_f32_16x16x32_bf16 v[228:231],a[244:247],v[116:119],v[228:231]
v_exp_f32 v54,v54
v_mfma_f32_16x16x32_bf16 a[20:23],a[244:247],v[120:123],a[20:23]
v_exp_f32 v45,v45
v_mfma_f32_16x16x32_bf16 a[68:71],a[244:247],v[124:127],a[68:71]
s_waitcnt lgkmcnt(4)
ds_read_b64_tr_b16 a[244:245],v4 offset:12544
ds_read_b64_tr_b16 a[246:247],v4 offset:18688
v_mfma_f32_16x16x32_bf16 v[184:187],a[248:251],v[112:115],v[184:187]
buffer_load_dwordx4 v7,s[4:7],s20 offen offset:0 lds
v_mfma_f32_16x16x32_bf16 v[232:235],a[248:251],v[116:119],v[232:235]
v_exp_f32 v52,v52
v_mfma_f32_16x16x32_bf16 a[24:27],a[248:251],v[120:123],a[24:27]
v_exp_f32 v61,v61
v_mfma_f32_16x16x32_bf16 a[72:75],a[248:251],v[124:127],a[72:75]
ds_read_b64_tr_b16 a[250:251],v5 offset:18688
ds_read_b64_tr_b16 a[248:249],v5 offset:12544
v_mfma_f32_16x16x32_bf16 v[188:191],a[252:255],v[112:115],v[188:191]
v_exp_f32 v58,v58
v_mfma_f32_16x16x32_bf16 v[236:239],a[252:255],v[116:119],v[236:239]
v_exp_f32 v38,v38
v_mfma_f32_16x16x32_bf16 a[28:31],a[252:255],v[120:123],a[28:31]
v_exp_f32 v59,v59
v_mfma_f32_16x16x32_bf16 a[76:79],a[252:255],v[124:127],a[76:79]
s_waitcnt lgkmcnt(2)
ds_read_b64_tr_b16 a[254:255],v6 offset:18688
ds_read_b64_tr_b16 a[252:253],v6 offset:12544
v_mfma_f32_16x16x32_bf16 v[192:195],a[240:243],v[112:115],v[192:195]
buffer_load_dwordx4 v8,s[4:7],s20 offen offset:1024 lds
v_mfma_f32_16x16x32_bf16 v[240:243],a[240:243],v[116:119],v[240:243]
v_exp_f32 v49,v49
v_mfma_f32_16x16x32_bf16 a[32:35],a[240:243],v[120:123],a[32:35]
v_exp_f32 v57,v57
v_mfma_f32_16x16x32_bf16 a[80:83],a[240:243],v[124:127],a[80:83]
v_exp_f32 v37,v37
v_mfma_f32_16x16x32_bf16 v[196:199],a[244:247],v[112:115],v[196:199]
v_exp_f32 v62,v62
v_mfma_f32_16x16x32_bf16 v[244:247],a[244:247],v[116:119],v[244:247]
v_fma_f32 v56,v56,s36,v19
v_fma_f32 v53,v53,s36,v18
v_mfma_f32_16x16x32_bf16 a[36:39],a[244:247],v[120:123],a[36:39]
v_exp_f32 v56,v56
v_mfma_f32_16x16x32_bf16 a[84:87],a[244:247],v[124:127],a[84:87]
s_waitcnt lgkmcnt(0)
v_exp_f32 v53,v53
v_mfma_f32_16x16x32_bf16 v[200:203],a[248:251],v[112:115],v[200:203]
buffer_load_dwordx4 v9,s[4:7],s20 offen offset:2048 lds
v_mfma_f32_16x16x32_bf16 v[248:251],a[248:251],v[116:119],v[248:251]
s_add_u32 s20,s20,12288
v_fma_f32 v46,v46,s36,v17
v_fma_f32 v63,v63,s36,v19
v_mfma_f32_16x16x32_bf16 a[40:43],a[248:251],v[120:123],a[40:43]
s_add_u32 m0,s29,0
v_exp_f32 v63,v63
v_mfma_f32_16x16x32_bf16 a[88:91],a[248:251],v[124:127],a[88:91]
v_exp_f32 v46,v46
v_mfma_f32_16x16x32_bf16 v[204:207],a[252:255],v[112:115],v[204:207]
v_fma_f32 v48,v48,s36,v18
v_cvt_pk_bf16_f32 v108,v56,v57
v_mfma_f32_16x16x32_bf16 v[252:255],a[252:255],v[116:119],v[252:255]
v_exp_f32 v48,v48
v_mfma_f32_16x16x32_bf16 a[44:47],a[252:255],v[120:123],a[44:47]
v_fma_f32 v36,v36,s36,v16
v_cvt_pk_bf16_f32 v106,v52,v53
v_mfma_f32_16x16x32_bf16 a[92:95],a[252:255],v[124:127],a[92:95]
v_exp_f32 v36,v36
v_mfma_f32_16x16x32_bf16 v[64:67],a[192:195],a[96:99],0
v_fma_f32 v60,v60,s36,v19
v_fma_f32 v51,v51,s36,v18
v_mfma_f32_16x16x32_bf16 v[64:67],a[196:199],a[100:103],v[64:67]
v_exp_f32 v60,v60
v_mfma_f32_16x16x32_bf16 v[64:67],a[200:203],a[104:107],v[64:67]
v_exp_f32 v51,v51
v_mfma_f32_16x16x32_bf16 v[64:67],a[204:207],a[108:111],v[64:67]
v_cvt_pk_bf16_f32 v110,v60,v61
v_fma_f32 v44,v44,s36,v17
v_mfma_f32_16x16x32_bf16 v[64:67],a[208:211],a[112:115],v[64:67]
v_exp_f32 v44,v44
v_mfma_f32_16x16x32_bf16 v[64:67],a[212:215],a[116:119],v[64:67]
buffer_load_dwordx4 v7,s[12:15],s28 offen offset:0 nt lds
v_mfma_f32_16x16x32_bf16 v[72:75],a[192:195],a[120:123],0
v_fma_f32 v55,v55,s36,v18
v_cvt_pk_bf16_f32 v104,v48,v49
v_mfma_f32_16x16x32_bf16 v[72:75],a[196:199],a[124:127],v[72:75]
v_exp_f32 v55,v55
v_mfma_f32_16x16x32_bf16 v[72:75],a[200:203],a[128:131],v[72:75]
v_fma_f32 v39,v39,s36,v16
v_fma_f32 v50,v50,s36,v18
v_mfma_f32_16x16x32_bf16 v[72:75],a[204:207],a[132:135],v[72:75]
v_exp_f32 v39,v39
v_mfma_f32_16x16x32_bf16 v[72:75],a[208:211],a[136:139],v[72:75]
v_exp_f32 v50,v50
v_mfma_f32_16x16x32_bf16 v[72:75],a[212:215],a[140:143],v[72:75]
v_cvt_pk_bf16_f32 v99,v38,v39
v_cvt_pk_bf16_f32 v105,v50,v51
v_mfma_f32_16x16x32_bf16 v[80:83],a[192:195],a[144:147],0
v_cvt_pk_bf16_f32 v109,v58,v59
v_fma_f32 v64,v64,s36,v16
v_mfma_f32_16x16x32_bf16 v[80:83],a[196:199],a[148:151],v[80:83]
v_exp_f32 v64,v64
v_mfma_f32_16x16x32_bf16 v[80:83],a[200:203],a[152:155],v[80:83]
v_fma_f32 v73,v73,s36,v17
v_cvt_pk_bf16_f32 v107,v54,v55
v_mfma_f32_16x16x32_bf16 v[80:83],a[204:207],a[156:159],v[80:83]
v_exp_f32 v73,v73
v_mfma_f32_16x16x32_bf16 v[136:139],v[24:27],v[104:107],v[136:139]
buffer_load_dwordx4 v8,s[12:15],s28 offen offset:1024 nt lds
v_mfma_f32_16x16x32_bf16 v[80:83],a[208:211],a[160:163],v[80:83]
v_fma_f32 v72,v72,s36,v17
v_cvt_pk_bf16_f32 v102,v44,v45
v_mfma_f32_16x16x32_bf16 v[80:83],a[212:215],a[164:167],v[80:83]
v_exp_f32 v72,v72
v_mfma_f32_16x16x32_bf16 v[88:91],a[192:195],a[168:171],0
v_cvt_pk_bf16_f32 v111,v62,v63
v_fma_f32 v67,v67,s36,v16
v_mfma_f32_16x16x32_bf16 v[88:91],a[196:199],a[172:175],v[88:91]
v_exp_f32 v67,v67
v_mfma_f32_16x16x32_bf16 v[140:143],v[24:27],v[108:111],v[140:143]
v_fma_f32 v65,v65,s36,v16
v_fma_f32 v66,v66,s36,v16
v_mfma_f32_16x16x32_bf16 v[88:91],a[200:203],a[176:179],v[88:91]
v_exp_f32 v66,v66
v_mfma_f32_16x16x32_bf16 v[88:91],a[204:207],a[180:183],v[88:91]
v_exp_f32 v65,v65
v_mfma_f32_16x16x32_bf16 v[88:91],a[208:211],a[184:187],v[88:91]
v_cvt_pk_bf16_f32 v103,v46,v47
v_cvt_pk_bf16_f32 v98,v36,v37
v_mfma_f32_16x16x32_bf16 v[88:91],a[212:215],a[188:191],v[88:91]
v_add_u32 v31,9216,v31
v_fma_f32 v75,v75,s36,v17
v_mfma_f32_16x16x32_bf16 v[132:135],v[24:27],v[100:103],v[132:135]
v_exp_f32 v75,v75
v_mfma_f32_16x16x32_bf16 v[128:131],v[24:27],v[96:99],v[128:131]
v_cvt_pk_bf16_f32 v116,v72,v73
v_cvt_pk_bf16_f32 v113,v66,v67
v_mfma_f32_16x16x32_bf16 v[68:71],a[216:219],a[96:99],0
buffer_load_dwordx4 v9,s[12:15],s28 offen offset:2048 nt lds
v_mfma_f32_16x16x32_bf16 v[68:71],a[220:223],a[100:103],v[68:71]
s_add_u32 s28,s28,3072
v_fma_f32 v74,v74,s36,v17
v_add_u32 v23,9216,v23
v_mfma_f32_16x16x32_bf16 v[68:71],a[224:227],a[104:107],v[68:71]
s_add_u32 s29,s29,3072
s_add_u32 s25,s24,18432
s_add_u32 s26,s22,12288
s_add_u32 s38,s38,1
s_cmp_lt_u32 s38,2
v_mfma_f32_16x16x32_bf16 v[68:71],a[228:231],a[108:111],v[68:71]
v_exp_f32 v74,v74
s_waitcnt vmcnt(12)
s_barrier
v_mfma_f32_16x16x32_bf16 v[68:71],a[232:235],a[112:115],v[68:71]
v_add_u32 v11,9216,v11
v_cvt_pk_bf16_f32 v112,v64,v65
v_mfma_f32_16x16x32_bf16 v[68:71],a[236:239],a[116:119],v[68:71]
v_cvt_pk_bf16_f32 v117,v74,v75
v_mfma_f32_16x16x32_bf16 v[76:79],a[216:219],a[120:123],0
v_mfma_f32_16x16x32_bf16 v[76:79],a[220:223],a[124:127],v[76:79]
v_mfma_f32_16x16x32_bf16 v[76:79],a[224:227],a[128:131],v[76:79]
v_mfma_f32_16x16x32_bf16 v[76:79],a[228:231],a[132:135],v[76:79]
v_mfma_f32_16x16x32_bf16 v[76:79],a[232:235],a[136:139],v[76:79]
ds_read_b64_tr_b16 a[240:241],v3 offset:24576
ds_read_b64_tr_b16 a[242:243],v3 offset:30720
v_mfma_f32_16x16x32_bf16 v[76:79],a[236:239],a[140:143],v[76:79]
v_mfma_f32_16x16x32_bf16 v[84:87],a[216:219],a[144:147],0
ds_read_b64_tr_b16 a[246:247],v4 offset:30720
ds_read_b64_tr_b16 a[244:245],v4 offset:24576
v_mfma_f32_16x16x32_bf16 v[84:87],a[220:223],a[148:151],v[84:87]
v_mfma_f32_16x16x32_bf16 v[84:87],a[224:227],a[152:155],v[84:87]
ds_read_b64_tr_b16 a[250:251],v5 offset:30720
ds_read_b64_tr_b16 a[248:249],v5 offset:24576
v_mfma_f32_16x16x32_bf16 v[84:87],a[228:231],a[156:159],v[84:87]
v_mfma_f32_16x16x32_bf16 v[84:87],a[232:235],a[160:163],v[84:87]
ds_read_b64_tr_b16 a[254:255],v6 offset:30720
ds_read_b64_tr_b16 a[252:253],v6 offset:24576
v_mfma_f32_16x16x32_bf16 v[84:87],a[236:239],a[164:167],v[84:87]
v_mfma_f32_16x16x32_bf16 v[92:95],a[216:219],a[168:171],0
v_mfma_f32_16x16x32_bf16 v[92:95],a[220:223],a[172:175],v[92:95]
v_mfma_f32_16x16x32_bf16 v[92:95],a[224:227],a[176:179],v[92:95]
v_mfma_f32_16x16x32_bf16 v[92:95],a[228:231],a[180:183],v[92:95]
v_mfma_f32_16x16x32_bf16 v[92:95],a[232:235],a[184:187],v[92:95]
v_mfma_f32_16x16x32_bf16 v[92:95],a[236:239],a[188:191],v[92:95]
s_cbranch_scc1 L_loop4w1
s_cmp_ge_u32 s69,8
s_cbranch_scc1 L_end4
s_cmp_eq_u32 s40,0
s_cbranch_scc1 L_tr43
s_branch L_tr44
L_tr43:
s_waitcnt vmcnt(36)
s_waitcnt lgkmcnt(4)
v_mfma_f32_16x16x32_bf16 v[160:163],a[240:243],v[96:99],v[160:163]
ds_read_b128 a[96:99],v28 offset:0
v_fma_f32 v68,v68,s36,v16
v_mfma_f32_16x16x32_bf16 v[208:211],a[240:243],v[100:103],v[208:211]
ds_read_b128 a[100:103],v29 offset:0
v_fma_f32 v69,v69,s36,v16
v_mfma_f32_16x16x32_bf16 a[0:3],a[240:243],v[104:107],a[0:3]
ds_read_b128 a[104:107],v28 offset:128
v_fma_f32 v70,v70,s36,v16
v_mfma_f32_16x16x32_bf16 a[48:51],a[240:243],v[108:111],a[48:51]
ds_read_b128 a[108:111],v29 offset:128
v_fma_f32 v71,v71,s36,v16
v_mfma_f32_16x16x32_bf16 v[164:167],a[244:247],v[96:99],v[164:167]
ds_read_b128 a[112:115],v28 offset:256
v_fma_f32 v76,v76,s36,v17
v_mfma_f32_16x16x32_bf16 v[212:215],a[244:247],v[100:103],v[212:215]
ds_read_b128 a[116:119],v29 offset:256
v_fma_f32 v77,v77,s36,v17
v_mfma_f32_16x16x32_bf16 a[4:7],a[244:247],v[104:107],a[4:7]
ds_read_b64_tr_b16 a[240:241],v3 offset:24704
ds_read_b64_tr_b16 a[242:243],v3 offset:30848
v_mfma_f32_16x16x32_bf16 a[52:55],a[244:247],v[108:111],a[52:55]
s_waitcnt lgkmcnt(8)
ds_read_b64_tr_b16 a[244:245],v4 offset:24704
ds_read_b64_tr_b16 a[246:247],v4 offset:30848
v_mfma_f32_16x16x32_bf16 v[168:171],a[248:251],v[96:99],v[168:171]
ds_read_b128 a[192:195],v13 offset:0
v_fma_f32 v78,v78,s36,v17
v_mfma_f32_16x16x32_bf16 v[216:219],a[248:251],v[100:103],v[216:219]
ds_read_b128 a[196:199],v14 offset:0
v_fma_f32 v79,v79,s36,v17
v_mfma_f32_16x16x32_bf16 a[8:11],a[248:251],v[104:107],a[8:11]
ds_read_b128 a[200:203],v13 offset:128
v_fma_f32 v80,v80,s36,v18
v_mfma_f32_16x16x32_bf16 a[56:59],a[248:251],v[108:111],a[56:59]
ds_read_b64_tr_b16 a[248:249],v5 offset:24704
ds_read_b64_tr_b16 a[250:251],v5 offset:30848
v_mfma_f32_16x16x32_bf16 v[172:175],a[252:255],v[96:99],v[172:175]
ds_read_b128 a[204:207],v14 offset:128
v_fma_f32 v81,v81,s36,v18
v_mfma_f32_16x16x32_bf16 v[220:223],a[252:255],v[100:103],v[220:223]
ds_read_b128 a[208:211],v13 offset:256
v_fma_f32 v82,v82,s36,v18
v_mfma_f32_16x16x32_bf16 a[12:15],a[252:255],v[104:107],a[12:15]
ds_read_b128 a[212:215],v14 offset:256
v_fma_f32 v83,v83,s36,v18
v_mfma_f32_16x16x32_bf16 a[60:63],a[252:255],v[108:111],a[60:63]
s_waitcnt lgkmcnt(9)
ds_read_b64_tr_b16 a[252:253],v6 offset:24704
ds_read_b64_tr_b16 a[254:255],v6 offset:30848
v_mfma_f32_16x16x32_bf16 v[176:179],a[240:243],v[96:99],v[176:179]
ds_read_b128 a[216:219],v13 offset:45056
v_fma_f32 v84,v84,s36,v18
v_mfma_f32_16x16x32_bf16 v[224:227],a[240:243],v[100:103],v[224:227]
ds_read_b128 a[220:223],v14 offset:45056
v_fma_f32 v85,v85,s36,v18
v_mfma_f32_16x16x32_bf16 a[16:19],a[240:243],v[104:107],a[16:19]
ds_read_b128 a[224:227],v13 offset:45184
v_fma_f32 v86,v86,s36,v18
v_mfma_f32_16x16x32_bf16 a[64:67],a[240:243],v[108:111],a[64:67]
s_waitcnt lgkmcnt(9)
ds_read_b64_tr_b16 a[240:241],v3 offset:24832
ds_read_b64_tr_b16 a[242:243],v3 offset:30976
v_mfma_f32_16x16x32_bf16 v[180:183],a[244:247],v[96:99],v[180:183]
ds_read_b128 a[228:231],v14 offset:45184
v_fma_f32 v87,v87,s36,v18
v_mfma_f32_16x16x32_bf16 v[228:231],a[244:247],v[100:103],v[228:231]
ds_read_b128 a[232:235],v13 offset:45312
v_fma_f32 v88,v88,s36,v19
v_mfma_f32_16x16x32_bf16 a[20:23],a[244:247],v[104:107],a[20:23]
ds_read_b128 a[236:239],v14 offset:45312
v_fma_f32 v89,v89,s36,v19
v_mfma_f32_16x16x32_bf16 a[68:71],a[244:247],v[108:111],a[68:71]
s_waitcnt lgkmcnt(8)
ds_read_b64_tr_b16 a[244:245],v4 offset:24832
ds_read_b64_tr_b16 a[246:247],v4 offset:30976
v_mfma_f32_16x16x32_bf16 v[184:187],a[248:251],v[96:99],v[184:187]
ds_read_b128 a[120:123],v28 offset:6144
v_fma_f32 v90,v90,s36,v19
v_mfma_f32_16x16x32_bf16 v[232:235],a[248:251],v[100:103],v[232:235]
ds_read_b128 a[124:127],v29 offset:6144
v_fma_f32 v91,v91,s36,v19
v_mfma_f32_16x16x32_bf16 a[24:27],a[248:251],v[104:107],a[24:27]
ds_read_b128 a[128:131],v28 offset:6272
v_fma_f32 v92,v92,s36,v19
v_mfma_f32_16x16x32_bf16 a[72:75],a[248:251],v[108:111],a[72:75]
ds_read_b64_tr_b16 a[248:249],v5 offset:24832
ds_read_b64_tr_b16 a[250:251],v5 offset:30976
v_mfma_f32_16x16x32_bf16 v[188:191],a[252:255],v[96:99],v[188:191]
ds_read_b128 a[132:135],v29 offset:6272
v_fma_f32 v93,v93,s36,v19
v_mfma_f32_16x16x32_bf16 v[236:239],a[252:255],v[100:103],v[236:239]
ds_read_b128 a[136:139],v28 offset:6400
v_fma_f32 v94,v94,s36,v19
v_mfma_f32_16x16x32_bf16 a[28:31],a[252:255],v[104:107],a[28:31]
ds_read_b128 a[140:143],v29 offset:6400
v_fma_f32 v95,v95,s36,v19
v_mfma_f32_16x16x32_bf16 a[76:79],a[252:255],v[108:111],a[76:79]
s_waitcnt lgkmcnt(9)
ds_read_b64_tr_b16 a[252:253],v6 offset:24832
ds_read_b64_tr_b16 a[254:255],v6 offset:30976
v_mfma_f32_16x16x32_bf16 v[192:195],a[240:243],v[96:99],v[192:195]
v_exp_f32 v68,v68
v_mfma_f32_16x16x32_bf16 v[240:243],a[240:243],v[100:103],v[240:243]
v_exp_f32 v69,v69
v_mfma_f32_16x16x32_bf16 a[32:35],a[240:243],v[104:107],a[32:35]
v_exp_f32 v70,v70
v_mfma_f32_16x16x32_bf16 a[80:83],a[240:243],v[108:111],a[80:83]
s_waitcnt lgkmcnt(6)
v_exp_f32 v71,v71
v_mfma_f32_16x16x32_bf16 v[196:199],a[244:247],v[96:99],v[196:199]
v_exp_f32 v76,v76
v_mfma_f32_16x16x32_bf16 v[244:247],a[244:247],v[100:103],v[244:247]
v_exp_f32 v77,v77
v_mfma_f32_16x16x32_bf16 a[36:39],a[244:247],v[104:107],a[36:39]
v_exp_f32 v78,v78
v_mfma_f32_16x16x32_bf16 a[84:87],a[244:247],v[108:111],a[84:87]
s_waitcnt lgkmcnt(1)
v_exp_f32 v79,v79
v_mfma_f32_16x16x32_bf16 v[200:203],a[248:251],v[96:99],v[200:203]
v_exp_f32 v80,v80
v_mfma_f32_16x16x32_bf16 v[248:251],a[248:251],v[100:103],v[248:251]
v_exp_f32 v81,v81
v_mfma_f32_16x16x32_bf16 a[40:43],a[248:251],v[104:107],a[40:43]
v_exp_f32 v82,v82
v_mfma_f32_16x16x32_bf16 a[88:91],a[248:251],v[108:111],a[88:91]
s_waitcnt lgkmcnt(0)
v_exp_f32 v83,v83
v_mfma_f32_16x16x32_bf16 v[204:207],a[252:255],v[96:99],v[204:207]
v_exp_f32 v84,v84
v_mfma_f32_16x16x32_bf16 v[252:255],a[252:255],v[100:103],v[252:255]
v_exp_f32 v85,v85
v_mfma_f32_16x16x32_bf16 a[44:47],a[252:255],v[104:107],a[44:47]
v_exp_f32 v86,v86
v_mfma_f32_16x16x32_bf16 a[92:95],a[252:255],v[108:111],a[92:95]
v_exp_f32 v87,v87
s_waitcnt vmcnt(6)
s_barrier
v_exp_f32 v88,v88
v_exp_f32 v89,v89
v_exp_f32 v90,v90
v_exp_f32 v91,v91
v_exp_f32 v92,v92
v_exp_f32 v93,v93
v_exp_f32 v94,v94
v_exp_f32 v95,v95
v_cvt_pk_bf16_f32 v114,v68,v69
v_cvt_pk_bf16_f32 v115,v70,v71
v_cvt_pk_bf16_f32 v118,v76,v77
v_cvt_pk_bf16_f32 v119,v78,v79
v_mfma_f32_16x16x32_bf16 v[128:131],v[24:27],v[112:115],v[128:131]
v_cvt_pk_bf16_f32 v120,v80,v81
v_cvt_pk_bf16_f32 v121,v82,v83
v_mfma_f32_16x16x32_bf16 v[132:135],v[24:27],v[116:119],v[132:135]
ds_read_b64_tr_b16 a[240:241],v3 offset:0
ds_read_b64_tr_b16 a[242:243],v3 offset:6144
v_cvt_pk_bf16_f32 v122,v84,v85
v_cvt_pk_bf16_f32 v123,v86,v87
v_cvt_pk_bf16_f32 v124,v88,v89
v_cvt_pk_bf16_f32 v125,v90,v91
v_mfma_f32_16x16x32_bf16 v[136:139],v[24:27],v[120:123],v[136:139]
ds_read_b64_tr_b16 a[244:245],v4 offset:0
ds_read_b64_tr_b16 a[246:247],v4 offset:6144
v_cvt_pk_bf16_f32 v126,v92,v93
v_cvt_pk_bf16_f32 v127,v94,v95
ds_read_b64_tr_b16 a[248:249],v5 offset:0
ds_read_b64_tr_b16 a[250:251],v5 offset:6144
v_mfma_f32_16x16x32_bf16 v[140:143],v[24:27],v[124:127],v[140:143]
s_waitcnt lgkmcnt(4)
ds_read_b64_tr_b16 a[252:253],v6 offset:0
ds_read_b64_tr_b16 a[254:255],v6 offset:6144
v_mfma_f32_16x16x32_bf16 v[160:163],a[240:243],v[112:115],v[160:163]
s_add_u32 s87,s42,18432
v_rcp_f32 v144,v128
v_mfma_f32_16x16x32_bf16 v[208:211],a[240:243],v[116:119],v[208:211]
v_rcp_f32 v146,v132
v_mfma_f32_16x16x32_bf16 a[0:3],a[240:243],v[120:123],a[0:3]
v_rcp_f32 v150,v140
v_mfma_f32_16x16x32_bf16 a[48:51],a[240:243],v[124:127],a[48:51]
s_waitcnt lgkmcnt(4)
ds_read_b64_tr_b16 a[240:241],v3 offset:128
ds_read_b64_tr_b16 a[242:243],v3 offset:6272
v_mfma_f32_16x16x32_bf16 v[164:167],a[244:247],v[112:115],v[164:167]
v_rcp_f32 v148,v136
v_mfma_f32_16x16x32_bf16 v[212:215],a[244:247],v[116:119],v[212:215]
v_max3_f32 v30,v128,v132,v136
v_max_f32 v30,v30,v140
v_mfma_f32_16x16x32_bf16 a[4:7],a[244:247],v[120:123],a[4:7]
v_accvgpr_read_b32 v64,a48
v_accvgpr_read_b32 v65,a49
v_mfma_f32_16x16x32_bf16 a[52:55],a[244:247],v[124:127],a[52:55]
ds_read_b64_tr_b16 a[244:245],v4 offset:128
ds_read_b64_tr_b16 a[246:247],v4 offset:6272
v_accvgpr_read_b32 v66,a50
v_accvgpr_read_b32 v67,a51
v_cmp_ngt_f32 vcc,s37,v30
v_pk_mul_f32 v[64:65],v[64:65],v[150:151] op_sel_hi:[1,0]
v_pk_mul_f32 v[160:161],v[160:161],v[144:145] op_sel_hi:[1,0]
v_pk_mul_f32 v[162:163],v[162:163],v[144:145] op_sel_hi:[1,0]
v_pk_mul_f32 v[66:67],v[66:67],v[150:151] op_sel_hi:[1,0]
v_accvgpr_read_b32 v68,a52
v_accvgpr_read_b32 v69,a53
s_waitcnt lgkmcnt(4)
v_mfma_f32_16x16x32_bf16 v[168:171],a[248:251],v[112:115],v[168:171]
s_cmp_lg_u64 vcc,0
v_accvgpr_read_b32 v70,a54
v_accvgpr_read_b32 v71,a55
v_mfma_f32_16x16x32_bf16 v[216:219],a[248:251],v[116:119],v[216:219]
s_cselect_b32 s62,s32,0
v_cvt_pk_bf16_f32 v80,v64,v65
v_cvt_pk_bf16_f32 v81,v66,v67
v_mfma_f32_16x16x32_bf16 a[8:11],a[248:251],v[120:123],a[8:11]
s_or_b32 s31,s31,s62
v_cvt_pk_bf16_f32 v82,v160,v161
v_cvt_pk_bf16_f32 v83,v162,v163
v_subrev_u32 v11,18432,v11
v_subrev_u32 v23,18432,v23
v_subrev_u32 v31,18432,v31
v_pk_mul_f32 v[68:69],v[68:69],v[150:151] op_sel_hi:[1,0]
v_pk_mul_f32 v[70:71],v[70:71],v[150:151] op_sel_hi:[1,0]
v_pk_mul_f32 v[164:165],v[164:165],v[144:145] op_sel_hi:[1,0]
v_pk_mul_f32 v[166:167],v[166:167],v[144:145] op_sel_hi:[1,0]
v_cvt_pk_bf16_f32 v84,v68,v69
v_cvt_pk_bf16_f32 v85,v70,v71
v_mfma_f32_16x16x32_bf16 a[56:59],a[248:251],v[124:127],a[56:59]
s_lshl_b32 s32,s32,1
ds_read_b64_tr_b16 a[248:249],v5 offset:128
ds_read_b64_tr_b16 a[250:251],v5 offset:6272
v_mfma_f32_16x16x32_bf16 v[172:175],a[252:255],v[112:115],v[172:175]
s_add_u32 m0,s22,24576
ds_write2st64_b64 v12,v[80:81],v[82:83] offset0:36 offset1:0
v_mfma_f32_16x16x32_bf16 v[220:223],a[252:255],v[116:119],v[220:223]
v_cvt_pk_bf16_f32 v86,v164,v165
v_accvgpr_read_b32 v72,a56
v_mfma_f32_16x16x32_bf16 a[12:15],a[252:255],v[120:123],a[12:15]
v_accvgpr_read_b32 v73,a57
v_accvgpr_read_b32 v74,a58
v_accvgpr_read_b32 v75,a59
v_cvt_pk_bf16_f32 v87,v166,v167
v_pk_mul_f32 v[168:169],v[168:169],v[144:145] op_sel_hi:[1,0]
v_pk_mul_f32 v[170:171],v[170:171],v[144:145] op_sel_hi:[1,0]
v_pk_mul_f32 v[72:73],v[72:73],v[150:151] op_sel_hi:[1,0]
v_pk_mul_f32 v[74:75],v[74:75],v[150:151] op_sel_hi:[1,0]
v_cvt_pk_bf16_f32 v88,v72,v73
v_cvt_pk_bf16_f32 v89,v74,v75
v_mfma_f32_16x16x32_bf16 a[60:63],a[252:255],v[124:127],a[60:63]
buffer_load_dwordx4 v7,s[4:7],s20 offen offset:0 lds
s_waitcnt lgkmcnt(3)
v_mfma_f32_16x16x32_bf16 v[176:179],a[240:243],v[112:115],v[176:179]
ds_read_b64_tr_b16 a[252:253],v6 offset:128
ds_read_b64_tr_b16 a[254:255],v6 offset:6272
v_mfma_f32_16x16x32_bf16 v[224:227],a[240:243],v[116:119],v[224:227]
buffer_load_dwordx4 v8,s[4:7],s20 offen offset:1024 lds
v_mfma_f32_16x16x32_bf16 a[16:19],a[240:243],v[120:123],a[16:19]
v_cvt_pk_bf16_f32 v90,v168,v169
v_accvgpr_read_b32 v76,a60
v_accvgpr_read_b32 v77,a61
v_accvgpr_read_b32 v78,a62
v_accvgpr_read_b32 v79,a63
v_pk_mul_f32 v[172:173],v[172:173],v[144:145] op_sel_hi:[1,0]
v_pk_mul_f32 v[174:175],v[174:175],v[144:145] op_sel_hi:[1,0]
v_pk_mul_f32 v[76:77],v[76:77],v[150:151] op_sel_hi:[1,0]
v_pk_mul_f32 v[78:79],v[78:79],v[150:151] op_sel_hi:[1,0]
v_cvt_pk_bf16_f32 v92,v76,v77
v_cvt_pk_bf16_f32 v93,v78,v79
v_mfma_f32_16x16x32_bf16 a[64:67],a[240:243],v[124:127],a[64:67]
ds_read_b64_tr_b16 a[240:241],v3 offset:256
ds_read_b64_tr_b16 a[242:243],v3 offset:6400
v_mfma_f32_16x16x32_bf16 v[180:183],a[244:247],v[112:115],v[180:183]
ds_write2st64_b64 v20,v[84:85],v[86:87] offset0:36 offset1:0
v_pk_mul_f32 v[208:209],v[208:209],v[146:147] op_sel_hi:[1,0]
v_pk_mul_f32 v[210:211],v[210:211],v[146:147] op_sel_hi:[1,0]
v_pk_mul_f32 v[176:177],v[176:177],v[144:145] op_sel_hi:[1,0]
v_pk_mul_f32 v[178:179],v[178:179],v[144:145] op_sel_hi:[1,0]
v_accvgpr_read_b32 v64,a64
v_accvgpr_read_b32 v65,a65
v_mfma_f32_16x16x32_bf16 v[228:231],a[244:247],v[116:119],v[228:231]
v_accvgpr_read_b32 v66,a66
v_accvgpr_read_b32 v67,a67
v_mfma_f32_16x16x32_bf16 a[20:23],a[244:247],v[120:123],a[20:23]
v_cvt_pk_bf16_f32 v91,v170,v171
v_cvt_pk_bf16_f32 v94,v172,v173
v_mfma_f32_16x16x32_bf16 a[68:71],a[244:247],v[124:127],a[68:71]
s_waitcnt lgkmcnt(3)
ds_read_b64_tr_b16 a[244:245],v4 offset:256
ds_read_b64_tr_b16 a[246:247],v4 offset:6400
v_mfma_f32_16x16x32_bf16 v[184:187],a[248:251],v[112:115],v[184:187]
ds_write2st64_b64 v21,v[88:89],v[90:91] offset0:36 offset1:0
v_pk_mul_f32 v[212:213],v[212:213],v[146:147] op_sel_hi:[1,0]
v_pk_mul_f32 v[214:215],v[214:215],v[146:147] op_sel_hi:[1,0]
v_pk_mul_f32 v[180:181],v[180:181],v[144:145] op_sel_hi:[1,0]
v_pk_mul_f32 v[182:183],v[182:183],v[144:145] op_sel_hi:[1,0]
v_accvgpr_read_b32 v68,a68
v_accvgpr_read_b32 v69,a69
v_mfma_f32_16x16x32_bf16 v[232:235],a[248:251],v[116:119],v[232:235]
v_accvgpr_read_b32 v70,a70
v_accvgpr_read_b32 v71,a71
v_mfma_f32_16x16x32_bf16 a[24:27],a[248:251],v[120:123],a[24:27]
v_cvt_pk_bf16_f32 v95,v174,v175
v_cvt_pk_bf16_f32 v80,v208,v209
v_mfma_f32_16x16x32_bf16 a[72:75],a[248:251],v[124:127],a[72:75]
ds_read_b64_tr_b16 a[248:249],v5 offset:256
ds_read_b64_tr_b16 a[250:251],v5 offset:6400
ds_write2st64_b64 v22,v[92:93],v[94:95] offset0:36 offset1:0
v_pk_mul_f32 v[216:217],v[216:217],v[146:147] op_sel_hi:[1,0]
v_pk_mul_f32 v[218:219],v[218:219],v[146:147] op_sel_hi:[1,0]
v_pk_mul_f32 v[184:185],v[184:185],v[144:145] op_sel_hi:[1,0]
v_pk_mul_f32 v[186:187],v[186:187],v[144:145] op_sel_hi:[1,0]
v_cvt_pk_bf16_f32 v81,v210,v211
v_accvgpr_read_b32 v72,a72
v_mfma_f32_16x16x32_bf16 v[188:191],a[252:255],v[112:115],v[188:191]
buffer_load_dwordx4 v9,s[4:7],s20 offen offset:2048 lds
s_add_u32 s20,s20,12288
s_add_u32 m0,s23,0
v_mfma_f32_16x16x32_bf16 v[236:239],a[252:255],v[116:119],v[236:239]
ds_read_b128 v[152:155],v15 offset:18432
v_accvgpr_read_b32 v73,a73
v_mfma_f32_16x16x32_bf16 a[28:31],a[252:255],v[120:123],a[28:31]
ds_read_b128 v[156:159],v15 offset:21504
v_accvgpr_read_b32 v74,a74
v_mfma_f32_16x16x32_bf16 a[76:79],a[252:255],v[124:127],a[76:79]
ds_read_b64_tr_b16 a[252:253],v6 offset:256
ds_read_b64_tr_b16 a[254:255],v6 offset:6400
v_accvgpr_read_b32 v75,a75
v_cvt_pk_bf16_f32 v82,v176,v177
v_cvt_pk_bf16_f32 v83,v178,v179
v_pk_mul_f32 v[220:221],v[220:221],v[146:147] op_sel_hi:[1,0]
v_pk_mul_f32 v[222:223],v[222:223],v[146:147] op_sel_hi:[1,0]
v_pk_mul_f32 v[188:189],v[188:189],v[144:145] op_sel_hi:[1,0]
v_pk_mul_f32 v[190:191],v[190:191],v[144:145] op_sel_hi:[1,0]
v_accvgpr_read_b32 v76,a76
v_accvgpr_read_b32 v77,a77
s_waitcnt lgkmcnt(4)
v_mfma_f32_16x16x32_bf16 v[192:195],a[240:243],v[112:115],v[192:195]
ds_write2st64_b64 v12,v[80:81],v[82:83] offset0:12 offset1:2
v_mfma_f32_16x16x32_bf16 v[240:243],a[240:243],v[116:119],v[240:243]
v_accvgpr_read_b32 v78,a78
v_accvgpr_read_b32 v79,a79
v_cvt_pk_bf16_f32 v84,v212,v213
v_cvt_pk_bf16_f32 v85,v214,v215
v_cvt_pk_bf16_f32 v86,v180,v181
v_pk_mul_f32 v[64:65],v[64:65],v[150:151] op_sel_hi:[1,0]
v_pk_mul_f32 v[66:67],v[66:67],v[150:151] op_sel_hi:[1,0]
v_pk_mul_f32 v[224:225],v[224:225],v[146:147] op_sel_hi:[1,0]
v_pk_mul_f32 v[226:227],v[226:227],v[146:147] op_sel_hi:[1,0]
v_cvt_pk_bf16_f32 v80,v64,v65
v_cvt_pk_bf16_f32 v81,v66,v67
v_mfma_f32_16x16x32_bf16 a[32:35],a[240:243],v[120:123],a[32:35]
s_waitcnt vmcnt(3)
ds_read_b128 a[144:147],v28 offset:12288
s_waitcnt lgkmcnt(3)
buffer_store_dwordx4 v[152:155],v10,s[16:19],s87 offen offset:0 nt
v_mfma_f32_16x16x32_bf16 a[80:83],a[240:243],v[124:127],a[80:83]
v_cvt_pk_bf16_f32 v87,v182,v183
v_cvt_pk_bf16_f32 v88,v216,v217
v_mfma_f32_16x16x32_bf16 v[196:199],a[244:247],v[112:115],v[196:199]
v_cvt_pk_bf16_f32 v89,v218,v219
v_cvt_pk_bf16_f32 v90,v184,v185
v_mfma_f32_16x16x32_bf16 v[244:247],a[244:247],v[116:119],v[244:247]
ds_read_b128 a[148:151],v29 offset:12288
v_cvt_pk_bf16_f32 v91,v186,v187
v_accvgpr_read_b32 v64,a80
v_accvgpr_read_b32 v65,a81
v_accvgpr_read_b32 v66,a82
v_pk_mul_f32 v[68:69],v[68:69],v[150:151] op_sel_hi:[1,0]
s_waitcnt vmcnt(7)
s_waitcnt lgkmcnt(2)
s_barrier
ds_read_b128 a[152:155],v28 offset:12416
buffer_store_dwordx4 v[156:159],v10,s[16:19],s87 offen offset:3072 nt
v_pk_mul_f32 v[70:71],v[70:71],v[150:151] op_sel_hi:[1,0]
v_pk_mul_f32 v[228:229],v[228:229],v[146:147] op_sel_hi:[1,0]
v_pk_mul_f32 v[230:231],v[230:231],v[146:147] op_sel_hi:[1,0]
v_accvgpr_read_b32 v67,a83
v_cvt_pk_bf16_f32 v92,v220,v221
v_mfma_f32_16x16x32_bf16 a[36:39],a[244:247],v[120:123],a[36:39]
v_cvt_pk_bf16_f32 v93,v222,v223
v_cvt_pk_bf16_f32 v94,v188,v189
v_mfma_f32_16x16x32_bf16 a[84:87],a[244:247],v[124:127],a[84:87]
ds_read_b128 a[156:159],v29 offset:12416
v_cvt_pk_bf16_f32 v95,v190,v191
v_mfma_f32_16x16x32_bf16 v[200:203],a[248:251],v[112:115],v[200:203]
ds_read_b128 a[160:163],v28 offset:12544
v_cvt_pk_bf16_f32 v82,v224,v225
v_cvt_pk_bf16_f32 v83,v226,v227
buffer_load_dwordx4 v7,s[8:11],s21 offen offset:0 lds
ds_read_b128 a[164:167],v29 offset:12544
v_pk_mul_f32 v[72:73],v[72:73],v[150:151] op_sel_hi:[1,0]
v_pk_mul_f32 v[74:75],v[74:75],v[150:151] op_sel_hi:[1,0]
v_pk_mul_f32 v[232:233],v[232:233],v[146:147] op_sel_hi:[1,0]
v_pk_mul_f32 v[234:235],v[234:235],v[146:147] op_sel_hi:[1,0]
ds_write2st64_b64 v20,v[84:85],v[86:87] offset0:12 offset1:2
v_cvt_pk_bf16_f32 v84,v68,v69
v_mfma_f32_16x16x32_bf16 v[248:251],a[248:251],v[116:119],v[248:251]
v_cvt_pk_bf16_f32 v85,v70,v71
v_accvgpr_read_b32 v68,a84
v_mfma_f32_16x16x32_bf16 a[40:43],a[248:251],v[120:123],a[40:43]
v_accvgpr_read_b32 v69,a85
v_accvgpr_read_b32 v70,a86
v_mfma_f32_16x16x32_bf16 a[88:91],a[248:251],v[124:127],a[88:91]
ds_write2st64_b64 v21,v[88:89],v[90:91] offset0:12 offset1:2
v_pk_mul_f32 v[76:77],v[76:77],v[150:151] op_sel_hi:[1,0]
v_pk_mul_f32 v[78:79],v[78:79],v[150:151] op_sel_hi:[1,0]
v_pk_mul_f32 v[236:237],v[236:237],v[146:147] op_sel_hi:[1,0]
v_pk_mul_f32 v[238:239],v[238:239],v[146:147] op_sel_hi:[1,0]
v_accvgpr_read_b32 v71,a87
v_cvt_pk_bf16_f32 v88,v72,v73
v_mfma_f32_16x16x32_bf16 v[204:207],a[252:255],v[112:115],v[204:207]
ds_write2st64_b64 v22,v[92:93],v[94:95] offset0:12 offset1:2
v_mfma_f32_16x16x32_bf16 v[252:255],a[252:255],v[116:119],v[252:255]
v_cvt_pk_bf16_f32 v89,v74,v75
v_accvgpr_read_b32 v72,a88
v_mfma_f32_16x16x32_bf16 a[44:47],a[252:255],v[120:123],a[44:47]
v_accvgpr_read_b32 v73,a89
v_accvgpr_read_b32 v74,a90
v_mfma_f32_16x16x32_bf16 a[92:95],a[252:255],v[124:127],a[92:95]
buffer_load_dwordx4 v8,s[8:11],s21 offen offset:1024 lds
v_accvgpr_read_b32 v75,a91
v_cvt_pk_bf16_f32 v92,v76,v77
v_pk_mul_f32 v[64:65],v[64:65],v[150:151] op_sel_hi:[1,0]
v_pk_mul_f32 v[66:67],v[66:67],v[150:151] op_sel_hi:[1,0]
v_pk_mul_f32 v[192:193],v[192:193],v[144:145] op_sel_hi:[1,0]
v_pk_mul_f32 v[194:195],v[194:195],v[144:145] op_sel_hi:[1,0]
v_cvt_pk_bf16_f32 v93,v78,v79
v_accvgpr_read_b32 v76,a92
v_mfma_f32_16x16x32_bf16 v[32:35],a[192:195],a[96:99],0
ds_write2st64_b64 v12,v[80:81],v[82:83] offset0:36 offset1:14
v_mfma_f32_16x16x32_bf16 v[32:35],a[196:199],a[100:103],v[32:35]
v_accvgpr_read_b32 v77,a93
v_accvgpr_read_b32 v78,a94
v_mfma_f32_16x16x32_bf16 v[32:35],a[200:203],a[104:107],v[32:35]
v_accvgpr_read_b32 v79,a95
v_cvt_pk_bf16_f32 v80,v64,v65
v_cvt_pk_bf16_f32 v81,v66,v67
v_accvgpr_read_b32 v64,a0
v_accvgpr_read_b32 v65,a1
v_pk_mul_f32 v[68:69],v[68:69],v[150:151] op_sel_hi:[1,0]
v_pk_mul_f32 v[70:71],v[70:71],v[150:151] op_sel_hi:[1,0]
v_pk_mul_f32 v[196:197],v[196:197],v[144:145] op_sel_hi:[1,0]
v_pk_mul_f32 v[198:199],v[198:199],v[144:145] op_sel_hi:[1,0]
v_accvgpr_read_b32 v66,a2
v_accvgpr_read_b32 v67,a3
v_mfma_f32_16x16x32_bf16 v[32:35],a[204:207],a[108:111],v[32:35]
v_cvt_pk_bf16_f32 v86,v228,v229
v_cvt_pk_bf16_f32 v87,v230,v231
v_mfma_f32_16x16x32_bf16 v[32:35],a[208:211],a[112:115],v[32:35]
ds_write2st64_b64 v20,v[84:85],v[86:87] offset0:36 offset1:14
v_mfma_f32_16x16x32_bf16 v[32:35],a[212:215],a[116:119],v[32:35]
v_cvt_pk_bf16_f32 v84,v68,v69
v_cvt_pk_bf16_f32 v85,v70,v71
v_accvgpr_read_b32 v68,a4
v_accvgpr_read_b32 v69,a5
v_accvgpr_read_b32 v70,a6
v_pk_mul_f32 v[72:73],v[72:73],v[150:151] op_sel_hi:[1,0]
v_pk_mul_f32 v[74:75],v[74:75],v[150:151] op_sel_hi:[1,0]
v_pk_mul_f32 v[200:201],v[200:201],v[144:145] op_sel_hi:[1,0]
v_pk_mul_f32 v[202:203],v[202:203],v[144:145] op_sel_hi:[1,0]
v_accvgpr_read_b32 v71,a7
v_cvt_pk_bf16_f32 v90,v232,v233
v_mfma_f32_16x16x32_bf16 v[36:39],a[216:219],a[96:99],0
buffer_load_dwordx4 v9,s[8:11],s21 offen offset:2048 lds
s_add_u32 s21,s21,12288
s_mov_b32 s27,s42
v_mfma_f32_16x16x32_bf16 v[36:39],a[220:223],a[100:103],v[36:39]
s_mov_b32 s42,s41
v_cvt_pk_bf16_f32 v91,v234,v235
v_cvt_pk_bf16_f32 v94,v236,v237
v_mfma_f32_16x16x32_bf16 v[36:39],a[224:227],a[104:107],v[36:39]
s_add_u32 s69,s69,1
ds_write2st64_b64 v21,v[88:89],v[90:91] offset0:36 offset1:14
s_add_u32 s48,s48,325632
s_lshr_b32 s62,s39,s69
s_and_b32 s62,s62,1
s_lshl_b32 s62,s62,1
v_mfma_f32_16x16x32_bf16 v[36:39],a[228:231],a[108:111],v[36:39]
s_add_u32 s62,s62,s49
v_cvt_pk_bf16_f32 v95,v238,v239
v_cvt_pk_bf16_f32 v88,v72,v73
v_cvt_pk_bf16_f32 v89,v74,v75
v_accvgpr_read_b32 v72,a8
v_accvgpr_read_b32 v73,a9
v_pk_mul_f32 v[76:77],v[76:77],v[150:151] op_sel_hi:[1,0]
v_pk_mul_f32 v[78:79],v[78:79],v[150:151] op_sel_hi:[1,0]
v_pk_mul_f32 v[204:205],v[204:205],v[144:145] op_sel_hi:[1,0]
v_pk_mul_f32 v[206:207],v[206:207],v[144:145] op_sel_hi:[1,0]
v_accvgpr_read_b32 v74,a10
v_accvgpr_read_b32 v75,a11
v_mfma_f32_16x16x32_bf16 v[36:39],a[232:235],a[112:115],v[36:39]
s_and_b32 s62,s62,3
ds_write2st64_b64 v22,v[92:93],v[94:95] offset0:36 offset1:14
s_add_u32 s63,s69,8
s_lshr_b32 s63,s39,s63
s_and_b32 s63,s63,1
s_xor_b32 s62,s62,s63
v_mfma_f32_16x16x32_bf16 v[36:39],a[236:239],a[116:119],v[36:39]
s_mul_i32 s63,s3,3
v_cvt_pk_bf16_f32 v92,v76,v77
v_cvt_pk_bf16_f32 v93,v78,v79
v_mfma_f32_16x16x32_bf16 v[40:43],a[192:195],a[120:123],0
s_lshl_b32 s64,s3,2
v_accvgpr_read_b32 v76,a12
v_accvgpr_read_b32 v77,a13
v_accvgpr_read_b32 v78,a14
v_accvgpr_read_b32 v79,a15
v_cvt_pk_bf16_f32 v82,v192,v193
v_pk_mul_f32 v[240:241],v[240:241],v[146:147] op_sel_hi:[1,0]
v_pk_mul_f32 v[242:243],v[242:243],v[146:147] op_sel_hi:[1,0]
v_pk_mul_f32 v[64:65],v[64:65],v[148:149] op_sel_hi:[1,0]
v_pk_mul_f32 v[66:67],v[66:67],v[148:149] op_sel_hi:[1,0]
v_cvt_pk_bf16_f32 v83,v194,v195
v_cvt_pk_bf16_f32 v86,v196,v197
v_mfma_f32_16x16x32_bf16 v[40:43],a[196:199],a[124:127],v[40:43]
s_mov_b32 s40,1
ds_read_b128 v[152:155],v15 offset:18432
v_cvt_pk_bf16_f32 v87,v198,v199
v_mfma_f32_16x16x32_bf16 v[40:43],a[200:203],a[128:131],v[40:43]
s_add_u32 s65,s63,17
ds_read_b128 v[156:159],v15 offset:21504
v_cvt_pk_bf16_f32 v90,v200,v201
v_mfma_f32_16x16x32_bf16 v[40:43],a[204:207],a[132:135],v[40:43]
s_cmp_eq_u32 s3,0
ds_write2st64_b64 v12,v[80:81],v[82:83] offset0:36 offset1:4
s_cselect_b32 s65,16,s65
s_cselect_b32 s41,1,0
s_cmp_eq_u32 s62,1
s_cselect_b32 s64,s65,s64
v_pk_mul_f32 v[244:245],v[244:245],v[146:147] op_sel_hi:[1,0]
v_pk_mul_f32 v[246:247],v[246:247],v[146:147] op_sel_hi:[1,0]
v_pk_mul_f32 v[68:69],v[68:69],v[148:149] op_sel_hi:[1,0]
v_pk_mul_f32 v[70:71],v[70:71],v[148:149] op_sel_hi:[1,0]
v_cvt_pk_bf16_f32 v82,v64,v65
v_cvt_pk_bf16_f32 v83,v66,v67
v_mfma_f32_16x16x32_bf16 v[40:43],a[208:211],a[136:139],v[40:43]
s_cselect_b32 s40,s41,s40
ds_write2st64_b64 v20,v[84:85],v[86:87] offset0:36 offset1:4
s_add_u32 s65,s63,29
s_cmp_eq_u32 s62,2
s_cselect_b32 s64,s65,s64
s_cselect_b32 s40,0,s40
v_mfma_f32_16x16x32_bf16 v[40:43],a[212:215],a[140:143],v[40:43]
s_add_u32 s65,s63,41
v_cvt_pk_bf16_f32 v86,v68,v69
v_cvt_pk_bf16_f32 v87,v70,v71
v_mfma_f32_16x16x32_bf16 v[44:47],a[216:219],a[120:123],0
s_cmp_eq_u32 s62,3
v_accvgpr_read_b32 v64,a16
v_accvgpr_read_b32 v65,a17
v_accvgpr_read_b32 v66,a18
v_accvgpr_read_b32 v67,a19
v_accvgpr_read_b32 v68,a32
v_pk_mul_f32 v[248:249],v[248:249],v[146:147] op_sel_hi:[1,0]
v_pk_mul_f32 v[250:251],v[250:251],v[146:147] op_sel_hi:[1,0]
v_pk_mul_f32 v[72:73],v[72:73],v[148:149] op_sel_hi:[1,0]
v_pk_mul_f32 v[74:75],v[74:75],v[148:149] op_sel_hi:[1,0]
v_accvgpr_read_b32 v69,a33
v_accvgpr_read_b32 v70,a34
v_mfma_f32_16x16x32_bf16 v[44:47],a[220:223],a[124:127],v[44:47]
s_cselect_b32 s64,s65,s64
s_waitcnt lgkmcnt(1)
buffer_store_dwordx4 v[152:155],v10,s[16:19],s87 offen offset:128 nt
s_cselect_b32 s40,0,s40
s_mul_i32 s64,s64,6144
v_mfma_f32_16x16x32_bf16 v[44:47],a[224:227],a[128:131],v[44:47]
s_add_u32 s41,s48,s64
v_accvgpr_read_b32 v71,a35
v_cvt_pk_bf16_f32 v91,v202,v203
v_mfma_f32_16x16x32_bf16 v[44:47],a[228:231],a[132:135],v[44:47]
s_cmp_ge_u32 s69,8
v_cvt_pk_bf16_f32 v94,v204,v205
v_cvt_pk_bf16_f32 v95,v206,v207
v_mfma_f32_16x16x32_bf16 v[44:47],a[232:235],a[136:139],v[44:47]
s_cselect_b32 s41,166723584,s41
ds_write2st64_b64 v21,v[88:89],v[90:91] offset0:36 offset1:4
s_mov_b32 s28,s41
s_mov_b32 s29,s24
s_add_u32 s25,s22,12288
s_add_u32 s26,s22,24576
v_pk_mul_f32 v[252:253],v[252:253],v[146:147] op_sel_hi:[1,0]
v_pk_mul_f32 v[254:255],v[254:255],v[146:147] op_sel_hi:[1,0]
v_pk_mul_f32 v[76:77],v[76:77],v[148:149] op_sel_hi:[1,0]
v_pk_mul_f32 v[78:79],v[78:79],v[148:149] op_sel_hi:[1,0]
v_cvt_pk_bf16_f32 v90,v72,v73
v_cvt_pk_bf16_f32 v91,v74,v75
v_mfma_f32_16x16x32_bf16 v[44:47],a[236:239],a[140:143],v[44:47]
ds_write2st64_b64 v22,v[92:93],v[94:95] offset0:36 offset1:4
v_mfma_f32_16x16x32_bf16 v[48:51],a[192:195],a[144:147],0
v_cvt_pk_bf16_f32 v94,v76,v77
v_cvt_pk_bf16_f32 v95,v78,v79
v_mfma_f32_16x16x32_bf16 v[48:51],a[196:199],a[148:151],v[48:51]
v_accvgpr_read_b32 v72,a20
v_accvgpr_read_b32 v73,a21
v_accvgpr_read_b32 v74,a22
v_accvgpr_read_b32 v75,a23
v_accvgpr_read_b32 v76,a36
v_pk_mul_f32 v[64:65],v[64:65],v[148:149] op_sel_hi:[1,0]
v_pk_mul_f32 v[66:67],v[66:67],v[148:149] op_sel_hi:[1,0]
v_pk_mul_f32 v[68:69],v[68:69],v[148:149] op_sel_hi:[1,0]
v_pk_mul_f32 v[70:71],v[70:71],v[148:149] op_sel_hi:[1,0]
v_accvgpr_read_b32 v77,a37
v_accvgpr_read_b32 v78,a38
v_mfma_f32_16x16x32_bf16 v[48:51],a[200:203],a[152:155],v[48:51]
ds_read_b128 v[152:155],v15 offset:18432
buffer_store_dwordx4 v[156:159],v10,s[16:19],s87 offen offset:3200 nt
v_mfma_f32_16x16x32_bf16 v[48:51],a[204:207],a[156:159],v[48:51]
v_accvgpr_read_b32 v79,a39
v_cvt_pk_bf16_f32 v80,v240,v241
v_mfma_f32_16x16x32_bf16 v[48:51],a[208:211],a[160:163],v[48:51]
v_cvt_pk_bf16_f32 v81,v242,v243
v_cvt_pk_bf16_f32 v84,v244,v245
v_cvt_pk_bf16_f32 v85,v246,v247
v_cvt_pk_bf16_f32 v88,v248,v249
v_cvt_pk_bf16_f32 v89,v250,v251
v_pk_mul_f32 v[72:73],v[72:73],v[148:149] op_sel_hi:[1,0]
v_pk_mul_f32 v[74:75],v[74:75],v[148:149] op_sel_hi:[1,0]
v_pk_mul_f32 v[76:77],v[76:77],v[148:149] op_sel_hi:[1,0]
v_pk_mul_f32 v[78:79],v[78:79],v[148:149] op_sel_hi:[1,0]
v_cvt_pk_bf16_f32 v92,v252,v253
v_cvt_pk_bf16_f32 v93,v254,v255
v_mfma_f32_16x16x32_bf16 v[48:51],a[212:215],a[164:167],v[48:51]
ds_read_b128 v[156:159],v15 offset:21504
v_mfma_f32_16x16x32_bf16 v[52:55],a[216:219],a[144:147],0
ds_write2st64_b64 v12,v[80:81],v[82:83] offset0:16 offset1:24
v_mfma_f32_16x16x32_bf16 v[52:55],a[220:223],a[148:151],v[52:55]
v_cvt_pk_bf16_f32 v80,v64,v65
v_cvt_pk_bf16_f32 v81,v66,v67
v_mfma_f32_16x16x32_bf16 v[52:55],a[224:227],a[152:155],v[52:55]
v_cvt_pk_bf16_f32 v82,v68,v69
v_cvt_pk_bf16_f32 v83,v70,v71
v_accvgpr_read_b32 v64,a24
v_accvgpr_read_b32 v65,a25
v_accvgpr_read_b32 v66,a26
v_pk_mul_f32 v[64:65],v[64:65],v[148:149] op_sel_hi:[1,0]
v_accvgpr_read_b32 v67,a27
v_pk_mul_f32 v[66:67],v[66:67],v[148:149] op_sel_hi:[1,0]
v_accvgpr_read_b32 v68,a40
v_accvgpr_read_b32 v69,a41
v_pk_mul_f32 v[68:69],v[68:69],v[148:149] op_sel_hi:[1,0]
v_accvgpr_read_b32 v70,a42
v_accvgpr_read_b32 v71,a43
v_pk_mul_f32 v[70:71],v[70:71],v[148:149] op_sel_hi:[1,0]
ds_write2st64_b64 v20,v[84:85],v[86:87] offset0:16 offset1:24
v_cvt_pk_bf16_f32 v84,v72,v73
v_mfma_f32_16x16x32_bf16 v[52:55],a[228:231],a[156:159],v[52:55]
v_cvt_pk_bf16_f32 v85,v74,v75
v_cvt_pk_bf16_f32 v86,v76,v77
v_mfma_f32_16x16x32_bf16 v[52:55],a[232:235],a[160:163],v[52:55]
v_cvt_pk_bf16_f32 v87,v78,v79
v_accvgpr_read_b32 v72,a28
v_mfma_f32_16x16x32_bf16 v[52:55],a[236:239],a[164:167],v[52:55]
ds_write2st64_b64 v21,v[88:89],v[90:91] offset0:16 offset1:24
v_accvgpr_read_b32 v73,a29
v_pk_mul_f32 v[72:73],v[72:73],v[148:149] op_sel_hi:[1,0]
v_accvgpr_read_b32 v74,a30
v_accvgpr_read_b32 v75,a31
v_pk_mul_f32 v[74:75],v[74:75],v[148:149] op_sel_hi:[1,0]
v_accvgpr_read_b32 v76,a44
v_accvgpr_read_b32 v77,a45
v_pk_mul_f32 v[76:77],v[76:77],v[148:149] op_sel_hi:[1,0]
v_accvgpr_read_b32 v78,a46
v_accvgpr_read_b32 v79,a47
v_pk_mul_f32 v[78:79],v[78:79],v[148:149] op_sel_hi:[1,0]
v_cvt_pk_bf16_f32 v88,v64,v65
v_cvt_pk_bf16_f32 v89,v66,v67
v_cvt_pk_bf16_f32 v90,v68,v69
v_cvt_pk_bf16_f32 v91,v70,v71
ds_write2st64_b64 v22,v[92:93],v[94:95] offset0:16 offset1:24
v_cvt_pk_bf16_f32 v92,v72,v73
v_cvt_pk_bf16_f32 v93,v74,v75
v_cvt_pk_bf16_f32 v94,v76,v77
v_cvt_pk_bf16_f32 v95,v78,v79
ds_write2st64_b64 v12,v[80:81],v[82:83] offset0:26 offset1:28
ds_write2st64_b64 v20,v[84:85],v[86:87] offset0:26 offset1:28
ds_write2st64_b64 v21,v[88:89],v[90:91] offset0:26 offset1:28
ds_write2st64_b64 v22,v[92:93],v[94:95] offset0:26 offset1:28
s_waitcnt lgkmcnt(2)
buffer_store_dwordx4 v[152:155],v10,s[16:19],s87 offen offset:256 nt
buffer_store_dwordx4 v[156:159],v10,s[16:19],s87 offen offset:3328 nt
ds_read_b128 a[192:195],v1 offset:12288
v_max3_f32 v144,v32,v33,v34
v_max3_f32 v144,v144,v35,v36
v_max3_f32 v144,v144,v37,v38
v_max_f32 v144,v144,v39
v_mov_b32 v145,v144
v_max3_f32 v146,v40,v41,v42
v_max3_f32 v146,v146,v43,v44
v_permlane32_swap_b32 v145,v144
s_add_u32 m0,s23,12288
v_max_f32 v144,v144,v145
v_mov_b32 v145,v144
v_max3_f32 v146,v146,v45,v46
v_max_f32 v146,v146,v47
v_permlane16_swap_b32 v145,v144
v_max_f32 v144,v144,v145
v_mul_f32_e64 v16,-s36,v144
v_max3_f32 v144,v48,v49,v50
v_max3_f32 v144,v144,v51,v52
v_max3_f32 v144,v144,v53,v54
v_max_f32 v144,v144,v55
v_mov_b32 v147,v146
v_mov_b32 v145,v144
v_fma_f32 v32,v32,s36,v16
v_permlane32_swap_b32 v147,v146
v_permlane32_swap_b32 v145,v144
v_max_f32 v146,v146,v147
v_max_f32 v144,v144,v145
v_mov_b32 v147,v146
v_mov_b32 v145,v144
v_fma_f32 v33,v33,s36,v16
v_permlane16_swap_b32 v147,v146
s_waitcnt lgkmcnt(0)
v_mfma_f32_16x16x32_bf16 v[64:67],a[192:195],a[96:99],0
buffer_load_dwordx4 v7,s[8:11],s21 offen offset:0 lds
ds_read_b128 a[196:199],v2 offset:12288
v_permlane16_swap_b32 v145,v144
v_max_f32 v146,v146,v147
v_max_f32 v144,v144,v145
v_mul_f32_e64 v17,-s36,v146
v_mul_f32_e64 v18,-s36,v144
v_fma_f32 v34,v34,s36,v16
v_fma_f32 v35,v35,s36,v16
v_fma_f32 v36,v36,s36,v16
v_fma_f32 v37,v37,s36,v16
v_fma_f32 v38,v38,s36,v16
v_fma_f32 v39,v39,s36,v16
v_fma_f32 v40,v40,s36,v17
v_fma_f32 v41,v41,s36,v17
v_fma_f32 v42,v42,s36,v17
v_fma_f32 v43,v43,s36,v17
v_fma_f32 v44,v44,s36,v17
v_fma_f32 v45,v45,s36,v17
v_fma_f32 v46,v46,s36,v17
v_fma_f32 v47,v47,s36,v17
v_fma_f32 v48,v48,s36,v18
v_fma_f32 v49,v49,s36,v18
v_fma_f32 v50,v50,s36,v18
v_fma_f32 v51,v51,s36,v18
v_fma_f32 v52,v52,s36,v18
v_fma_f32 v53,v53,s36,v18
v_fma_f32 v54,v54,s36,v18
v_fma_f32 v55,v55,s36,v18
v_exp_f32 v32,v32
v_exp_f32 v33,v33
v_exp_f32 v34,v34
s_waitcnt lgkmcnt(0)
v_mfma_f32_16x16x32_bf16 v[64:67],a[196:199],a[100:103],v[64:67]
buffer_load_dwordx4 v8,s[8:11],s21 offen offset:1024 lds
buffer_load_dwordx4 v9,s[8:11],s21 offen offset:2048 lds
s_add_u32 s21,s21,12288
s_add_u32 m0,s22,0
ds_read_b128 a[200:203],v1 offset:12416
v_exp_f32 v35,v35
v_exp_f32 v36,v36
v_exp_f32 v37,v37
v_exp_f32 v38,v38
v_exp_f32 v39,v39
v_exp_f32 v40,v40
v_exp_f32 v41,v41
v_exp_f32 v42,v42
v_exp_f32 v43,v43
v_exp_f32 v44,v44
v_exp_f32 v45,v45
v_exp_f32 v46,v46
v_exp_f32 v47,v47
v_exp_f32 v48,v48
v_exp_f32 v49,v49
v_exp_f32 v50,v50
v_exp_f32 v51,v51
s_waitcnt lgkmcnt(0)
v_mfma_f32_16x16x32_bf16 v[64:67],a[200:203],a[104:107],v[64:67]
buffer_load_dwordx4 v7,s[4:7],s20 offen offset:0 lds
ds_read_b128 a[204:207],v2 offset:12416
v_exp_f32 v52,v52
v_exp_f32 v53,v53
v_exp_f32 v54,v54
v_exp_f32 v55,v55
v_cvt_pk_bf16_f32 v96,v32,v33
v_cvt_pk_bf16_f32 v97,v34,v35
v_cvt_pk_bf16_f32 v98,v36,v37
v_cvt_pk_bf16_f32 v99,v38,v39
v_cvt_pk_bf16_f32 v100,v40,v41
v_cvt_pk_bf16_f32 v101,v42,v43
v_mfma_f32_16x16x32_bf16 v[128:131],v[24:27],v[96:99],0
ds_read_b128 a[208:211],v1 offset:12544
v_cvt_pk_bf16_f32 v102,v44,v45
v_cvt_pk_bf16_f32 v103,v46,v47
v_cvt_pk_bf16_f32 v104,v48,v49
v_cvt_pk_bf16_f32 v105,v50,v51
v_mfma_f32_16x16x32_bf16 v[132:135],v[24:27],v[100:103],0
ds_read_b128 a[212:215],v2 offset:12544
v_cvt_pk_bf16_f32 v106,v52,v53
v_cvt_pk_bf16_f32 v107,v54,v55
ds_read_b128 a[216:219],v1 offset:18432
buffer_load_dwordx4 v8,s[4:7],s20 offen offset:1024 lds
v_mfma_f32_16x16x32_bf16 v[136:139],v[24:27],v[104:107],0
s_waitcnt lgkmcnt(3)
ds_read_b128 a[220:223],v2 offset:18432
v_mfma_f32_16x16x32_bf16 v[64:67],a[204:207],a[108:111],v[64:67]
ds_read_b128 a[224:227],v1 offset:18560
ds_read_b128 a[228:231],v2 offset:18560
ds_read_b128 a[232:235],v1 offset:18688
ds_read_b128 a[236:239],v2 offset:18688
s_waitcnt lgkmcnt(7)
v_mfma_f32_16x16x32_bf16 v[64:67],a[208:211],a[112:115],v[64:67]
s_waitcnt lgkmcnt(6)
v_mfma_f32_16x16x32_bf16 v[64:67],a[212:215],a[116:119],v[64:67]
v_mfma_f32_16x16x32_bf16 v[72:75],a[192:195],a[120:123],0
v_mfma_f32_16x16x32_bf16 v[72:75],a[196:199],a[124:127],v[72:75]
buffer_load_dwordx4 v9,s[4:7],s20 offen offset:2048 lds
s_add_u32 s20,s20,12288
v_mfma_f32_16x16x32_bf16 v[72:75],a[200:203],a[128:131],v[72:75]
v_mfma_f32_16x16x32_bf16 v[72:75],a[204:207],a[132:135],v[72:75]
v_mfma_f32_16x16x32_bf16 v[72:75],a[208:211],a[136:139],v[72:75]
v_mfma_f32_16x16x32_bf16 v[72:75],a[212:215],a[140:143],v[72:75]
v_fma_f32 v64,v64,s36,v16
v_fma_f32 v65,v65,s36,v16
v_mfma_f32_16x16x32_bf16 v[80:83],a[192:195],a[144:147],0
v_fma_f32 v66,v66,s36,v16
v_fma_f32 v67,v67,s36,v16
v_mfma_f32_16x16x32_bf16 v[80:83],a[196:199],a[148:151],v[80:83]
v_exp_f32 v64,v64
v_mfma_f32_16x16x32_bf16 v[80:83],a[200:203],a[152:155],v[80:83]
v_fma_f32 v72,v72,s36,v17
v_fma_f32 v73,v73,s36,v17
v_mfma_f32_16x16x32_bf16 v[80:83],a[204:207],a[156:159],v[80:83]
v_fma_f32 v74,v74,s36,v17
v_fma_f32 v75,v75,s36,v17
v_mfma_f32_16x16x32_bf16 v[80:83],a[208:211],a[160:163],v[80:83]
v_exp_f32 v65,v65
v_mfma_f32_16x16x32_bf16 v[80:83],a[212:215],a[164:167],v[80:83]
s_waitcnt lgkmcnt(0)
v_exp_f32 v66,v66
v_mfma_f32_16x16x32_bf16 v[68:71],a[216:219],a[96:99],0
v_exp_f32 v67,v67
v_mfma_f32_16x16x32_bf16 v[68:71],a[220:223],a[100:103],v[68:71]
s_waitcnt vmcnt(10)
s_barrier
v_exp_f32 v72,v72
v_mfma_f32_16x16x32_bf16 v[68:71],a[224:227],a[104:107],v[68:71]
v_exp_f32 v73,v73
v_mfma_f32_16x16x32_bf16 v[68:71],a[228:231],a[108:111],v[68:71]
ds_read_b64_tr_b16 a[240:241],v3 offset:0
ds_read_b64_tr_b16 a[242:243],v3 offset:6144
v_mfma_f32_16x16x32_bf16 v[68:71],a[232:235],a[112:115],v[68:71]
ds_read_b64_tr_b16 a[244:245],v4 offset:0
ds_read_b64_tr_b16 a[246:247],v4 offset:6144
v_mfma_f32_16x16x32_bf16 v[68:71],a[236:239],a[116:119],v[68:71]
v_exp_f32 v74,v74
v_mfma_f32_16x16x32_bf16 v[76:79],a[216:219],a[120:123],0
ds_read_b64_tr_b16 a[248:249],v5 offset:0
ds_read_b64_tr_b16 a[250:251],v5 offset:6144
v_mfma_f32_16x16x32_bf16 v[76:79],a[220:223],a[124:127],v[76:79]
ds_read_b64_tr_b16 a[252:253],v6 offset:0
ds_read_b64_tr_b16 a[254:255],v6 offset:6144
v_mfma_f32_16x16x32_bf16 v[76:79],a[224:227],a[128:131],v[76:79]
v_exp_f32 v75,v75
v_mfma_f32_16x16x32_bf16 v[76:79],a[228:231],a[132:135],v[76:79]
v_cvt_pk_bf16_f32 v112,v64,v65
v_cvt_pk_bf16_f32 v113,v66,v67
v_mfma_f32_16x16x32_bf16 v[76:79],a[232:235],a[136:139],v[76:79]
v_cvt_pk_bf16_f32 v116,v72,v73
v_cvt_pk_bf16_f32 v117,v74,v75
v_mfma_f32_16x16x32_bf16 v[76:79],a[236:239],a[140:143],v[76:79]
v_mfma_f32_16x16x32_bf16 v[84:87],a[216:219],a[144:147],0
v_mfma_f32_16x16x32_bf16 v[84:87],a[220:223],a[148:151],v[84:87]
v_mfma_f32_16x16x32_bf16 v[84:87],a[224:227],a[152:155],v[84:87]
v_mfma_f32_16x16x32_bf16 v[84:87],a[228:231],a[156:159],v[84:87]
v_mfma_f32_16x16x32_bf16 v[84:87],a[232:235],a[160:163],v[84:87]
v_mfma_f32_16x16x32_bf16 v[84:87],a[236:239],a[164:167],v[84:87]
s_waitcnt lgkmcnt(0)
v_mfma_f32_16x16x32_bf16 v[160:163],a[240:243],v[96:99],0
s_add_u32 m0,s23,24576
ds_read_b128 a[192:195],v1 offset:24576
v_fma_f32 v68,v68,s36,v16
v_mfma_f32_16x16x32_bf16 v[208:211],a[240:243],v[100:103],0
buffer_load_dwordx4 v7,s[8:11],s21 offen offset:0 lds
v_mfma_f32_16x16x32_bf16 a[0:3],a[240:243],v[104:107],0
ds_read_b64_tr_b16 a[240:241],v3 offset:128
ds_read_b64_tr_b16 a[242:243],v3 offset:6272
v_mfma_f32_16x16x32_bf16 v[164:167],a[244:247],v[96:99],0
ds_read_b128 a[196:199],v2 offset:24576
v_fma_f32 v69,v69,s36,v16
v_mfma_f32_16x16x32_bf16 v[212:215],a[244:247],v[100:103],0
ds_read_b128 a[200:203],v1 offset:24704
v_fma_f32 v70,v70,s36,v16
v_mfma_f32_16x16x32_bf16 a[4:7],a[244:247],v[104:107],0
ds_read_b64_tr_b16 a[244:245],v4 offset:128
ds_read_b64_tr_b16 a[246:247],v4 offset:6272
v_mfma_f32_16x16x32_bf16 v[168:171],a[248:251],v[96:99],0
ds_read_b128 a[204:207],v2 offset:24704
v_fma_f32 v71,v71,s36,v16
v_mfma_f32_16x16x32_bf16 v[216:219],a[248:251],v[100:103],0
buffer_load_dwordx4 v8,s[8:11],s21 offen offset:1024 lds
v_mfma_f32_16x16x32_bf16 a[8:11],a[248:251],v[104:107],0
ds_read_b64_tr_b16 a[248:249],v5 offset:128
ds_read_b64_tr_b16 a[250:251],v5 offset:6272
v_mfma_f32_16x16x32_bf16 v[172:175],a[252:255],v[96:99],0
ds_read_b128 a[208:211],v1 offset:24832
v_fma_f32 v76,v76,s36,v17
v_mfma_f32_16x16x32_bf16 v[220:223],a[252:255],v[100:103],0
ds_read_b128 a[212:215],v2 offset:24832
v_fma_f32 v77,v77,s36,v17
v_mfma_f32_16x16x32_bf16 a[12:15],a[252:255],v[104:107],0
s_waitcnt lgkmcnt(8)
ds_read_b64_tr_b16 a[252:253],v6 offset:128
ds_read_b64_tr_b16 a[254:255],v6 offset:6272
v_mfma_f32_16x16x32_bf16 v[176:179],a[240:243],v[96:99],0
buffer_load_dwordx4 v9,s[8:11],s21 offen offset:2048 lds
v_mfma_f32_16x16x32_bf16 v[224:227],a[240:243],v[100:103],0
s_add_u32 s21,s21,12288
ds_read_b128 a[216:219],v1 offset:30720
v_fma_f32 v78,v78,s36,v17
v_mfma_f32_16x16x32_bf16 a[16:19],a[240:243],v[104:107],0
s_add_u32 m0,s22,12288
ds_read_b64_tr_b16 a[240:241],v3 offset:256
ds_read_b64_tr_b16 a[242:243],v3 offset:6400
s_waitcnt lgkmcnt(9)
v_mfma_f32_16x16x32_bf16 v[180:183],a[244:247],v[96:99],0
ds_read_b128 a[220:223],v2 offset:30720
v_fma_f32 v79,v79,s36,v17
v_mfma_f32_16x16x32_bf16 v[228:231],a[244:247],v[100:103],0
ds_read_b128 a[224:227],v1 offset:30848
v_fma_f32 v80,v80,s36,v18
v_mfma_f32_16x16x32_bf16 a[20:23],a[244:247],v[104:107],0
s_waitcnt lgkmcnt(8)
ds_read_b64_tr_b16 a[244:245],v4 offset:256
ds_read_b64_tr_b16 a[246:247],v4 offset:6400
v_mfma_f32_16x16x32_bf16 v[184:187],a[248:251],v[96:99],0
buffer_load_dwordx4 v7,s[4:7],s20 offen offset:0 lds
v_mfma_f32_16x16x32_bf16 v[232:235],a[248:251],v[100:103],0
ds_read_b128 a[228:231],v2 offset:30848
v_fma_f32 v81,v81,s36,v18
v_mfma_f32_16x16x32_bf16 a[24:27],a[248:251],v[104:107],0
s_waitcnt lgkmcnt(8)
ds_read_b64_tr_b16 a[248:249],v5 offset:256
ds_read_b64_tr_b16 a[250:251],v5 offset:6400
v_mfma_f32_16x16x32_bf16 v[188:191],a[252:255],v[96:99],0
ds_read_b128 a[232:235],v1 offset:30976
v_fma_f32 v82,v82,s36,v18
v_mfma_f32_16x16x32_bf16 v[236:239],a[252:255],v[100:103],0
ds_read_b128 a[236:239],v2 offset:30976
v_fma_f32 v83,v83,s36,v18
v_mfma_f32_16x16x32_bf16 a[28:31],a[252:255],v[104:107],0
s_waitcnt lgkmcnt(8)
ds_read_b64_tr_b16 a[252:253],v6 offset:256
ds_read_b64_tr_b16 a[254:255],v6 offset:6400
v_mfma_f32_16x16x32_bf16 v[192:195],a[240:243],v[96:99],0
buffer_load_dwordx4 v8,s[4:7],s20 offen offset:1024 lds
v_mfma_f32_16x16x32_bf16 v[240:243],a[240:243],v[100:103],0
v_fma_f32 v84,v84,s36,v18
v_fma_f32 v85,v85,s36,v18
v_mfma_f32_16x16x32_bf16 a[32:35],a[240:243],v[104:107],0
s_waitcnt lgkmcnt(7)
v_fma_f32 v86,v86,s36,v18
v_fma_f32 v87,v87,s36,v18
v_mfma_f32_16x16x32_bf16 v[196:199],a[244:247],v[96:99],0
v_exp_f32 v68,v68
v_mfma_f32_16x16x32_bf16 v[244:247],a[244:247],v[100:103],0
v_exp_f32 v69,v69
v_mfma_f32_16x16x32_bf16 a[36:39],a[244:247],v[104:107],0
s_waitcnt lgkmcnt(3)
v_exp_f32 v70,v70
v_mfma_f32_16x16x32_bf16 v[200:203],a[248:251],v[96:99],0
buffer_load_dwordx4 v9,s[4:7],s20 offen offset:2048 lds
v_mfma_f32_16x16x32_bf16 v[248:251],a[248:251],v[100:103],0
s_add_u32 s20,s20,12288
v_exp_f32 v71,v71
v_mfma_f32_16x16x32_bf16 a[40:43],a[248:251],v[104:107],0
s_waitcnt lgkmcnt(0)
v_exp_f32 v76,v76
v_mfma_f32_16x16x32_bf16 v[204:207],a[252:255],v[96:99],0
v_exp_f32 v77,v77
v_mfma_f32_16x16x32_bf16 v[252:255],a[252:255],v[100:103],0
v_exp_f32 v78,v78
v_mfma_f32_16x16x32_bf16 a[44:47],a[252:255],v[104:107],0
v_exp_f32 v79,v79
v_mfma_f32_16x16x32_bf16 v[32:35],a[192:195],a[96:99],0
v_exp_f32 v80,v80
v_mfma_f32_16x16x32_bf16 v[32:35],a[196:199],a[100:103],v[32:35]
v_exp_f32 v81,v81
v_mfma_f32_16x16x32_bf16 v[32:35],a[200:203],a[104:107],v[32:35]
v_exp_f32 v82,v82
v_mfma_f32_16x16x32_bf16 v[32:35],a[204:207],a[108:111],v[32:35]
v_exp_f32 v83,v83
v_mfma_f32_16x16x32_bf16 v[32:35],a[208:211],a[112:115],v[32:35]
v_exp_f32 v84,v84
v_mfma_f32_16x16x32_bf16 v[32:35],a[212:215],a[116:119],v[32:35]
v_exp_f32 v85,v85
v_mfma_f32_16x16x32_bf16 v[40:43],a[192:195],a[120:123],0
v_exp_f32 v86,v86
v_mfma_f32_16x16x32_bf16 v[40:43],a[196:199],a[124:127],v[40:43]
v_exp_f32 v87,v87
v_mfma_f32_16x16x32_bf16 v[40:43],a[200:203],a[128:131],v[40:43]
v_cvt_pk_bf16_f32 v114,v68,v69
v_cvt_pk_bf16_f32 v115,v70,v71
v_mfma_f32_16x16x32_bf16 v[40:43],a[204:207],a[132:135],v[40:43]
v_cvt_pk_bf16_f32 v118,v76,v77
v_cvt_pk_bf16_f32 v119,v78,v79
v_mfma_f32_16x16x32_bf16 v[128:131],v[24:27],v[112:115],v[128:131]
v_cvt_pk_bf16_f32 v120,v80,v81
v_cvt_pk_bf16_f32 v121,v82,v83
v_mfma_f32_16x16x32_bf16 v[132:135],v[24:27],v[116:119],v[132:135]
v_cvt_pk_bf16_f32 v122,v84,v85
v_cvt_pk_bf16_f32 v123,v86,v87
v_mfma_f32_16x16x32_bf16 v[40:43],a[208:211],a[136:139],v[40:43]
v_fma_f32 v32,v32,s36,v16
v_fma_f32 v33,v33,s36,v16
v_mfma_f32_16x16x32_bf16 v[136:139],v[24:27],v[120:123],v[136:139]
v_fma_f32 v34,v34,s36,v16
v_fma_f32 v35,v35,s36,v16
v_mfma_f32_16x16x32_bf16 v[40:43],a[212:215],a[140:143],v[40:43]
v_exp_f32 v32,v32
v_mfma_f32_16x16x32_bf16 v[48:51],a[192:195],a[144:147],0
v_exp_f32 v33,v33
v_mfma_f32_16x16x32_bf16 v[48:51],a[196:199],a[148:151],v[48:51]
v_exp_f32 v34,v34
v_mfma_f32_16x16x32_bf16 v[48:51],a[200:203],a[152:155],v[48:51]
v_exp_f32 v35,v35
v_mfma_f32_16x16x32_bf16 v[48:51],a[204:207],a[156:159],v[48:51]
v_fma_f32 v40,v40,s36,v17
v_fma_f32 v41,v41,s36,v17
v_mfma_f32_16x16x32_bf16 v[48:51],a[208:211],a[160:163],v[48:51]
v_fma_f32 v42,v42,s36,v17
v_fma_f32 v43,v43,s36,v17
v_mfma_f32_16x16x32_bf16 v[48:51],a[212:215],a[164:167],v[48:51]
v_exp_f32 v40,v40
v_mfma_f32_16x16x32_bf16 v[36:39],a[216:219],a[96:99],0
v_exp_f32 v41,v41
v_mfma_f32_16x16x32_bf16 v[36:39],a[220:223],a[100:103],v[36:39]
v_exp_f32 v42,v42
v_mfma_f32_16x16x32_bf16 v[36:39],a[224:227],a[104:107],v[36:39]
v_exp_f32 v43,v43
v_mfma_f32_16x16x32_bf16 v[36:39],a[228:231],a[108:111],v[36:39]
v_cvt_pk_bf16_f32 v96,v32,v33
v_cvt_pk_bf16_f32 v97,v34,v35
s_waitcnt vmcnt(6)
s_barrier
v_mfma_f32_16x16x32_bf16 v[36:39],a[232:235],a[112:115],v[36:39]
v_cvt_pk_bf16_f32 v100,v40,v41
v_cvt_pk_bf16_f32 v101,v42,v43
v_mfma_f32_16x16x32_bf16 v[36:39],a[236:239],a[116:119],v[36:39]
ds_read_b64_tr_b16 a[240:241],v3 offset:12288
ds_read_b64_tr_b16 a[242:243],v3 offset:18432
v_mfma_f32_16x16x32_bf16 v[44:47],a[216:219],a[120:123],0
v_mfma_f32_16x16x32_bf16 v[44:47],a[220:223],a[124:127],v[44:47]
ds_read_b64_tr_b16 a[244:245],v4 offset:12288
ds_read_b64_tr_b16 a[246:247],v4 offset:18432
v_mfma_f32_16x16x32_bf16 v[44:47],a[224:227],a[128:131],v[44:47]
ds_read_b64_tr_b16 a[248:249],v5 offset:12288
ds_read_b64_tr_b16 a[250:251],v5 offset:18432
v_mfma_f32_16x16x32_bf16 v[44:47],a[228:231],a[132:135],v[44:47]
v_mfma_f32_16x16x32_bf16 v[44:47],a[232:235],a[136:139],v[44:47]
ds_read_b64_tr_b16 a[252:253],v6 offset:12288
ds_read_b64_tr_b16 a[254:255],v6 offset:18432
v_mfma_f32_16x16x32_bf16 v[44:47],a[236:239],a[140:143],v[44:47]
v_mfma_f32_16x16x32_bf16 v[52:55],a[216:219],a[144:147],0
v_mfma_f32_16x16x32_bf16 v[52:55],a[220:223],a[148:151],v[52:55]
v_mfma_f32_16x16x32_bf16 v[52:55],a[224:227],a[152:155],v[52:55]
v_mfma_f32_16x16x32_bf16 v[52:55],a[228:231],a[156:159],v[52:55]
v_mfma_f32_16x16x32_bf16 v[52:55],a[232:235],a[160:163],v[52:55]
v_mfma_f32_16x16x32_bf16 v[52:55],a[236:239],a[164:167],v[52:55]
s_waitcnt lgkmcnt(2)
v_mfma_f32_16x16x32_bf16 v[160:163],a[240:243],v[112:115],v[160:163]
s_add_u32 m0,s23,0
ds_read_b128 a[192:195],v1 offset:0
v_fma_f32 v36,v36,s36,v16
v_mfma_f32_16x16x32_bf16 v[208:211],a[240:243],v[116:119],v[208:211]
buffer_load_dwordx4 v7,s[8:11],s21 offen offset:0 lds
v_mfma_f32_16x16x32_bf16 a[0:3],a[240:243],v[120:123],a[0:3]
ds_read_b64_tr_b16 a[240:241],v3 offset:12416
ds_read_b64_tr_b16 a[242:243],v3 offset:18560
v_mfma_f32_16x16x32_bf16 v[164:167],a[244:247],v[112:115],v[164:167]
ds_read_b128 a[196:199],v2 offset:0
v_fma_f32 v37,v37,s36,v16
v_mfma_f32_16x16x32_bf16 v[212:215],a[244:247],v[116:119],v[212:215]
ds_read_b128 a[200:203],v1 offset:128
v_fma_f32 v38,v38,s36,v16
v_mfma_f32_16x16x32_bf16 a[4:7],a[244:247],v[120:123],a[4:7]
ds_read_b64_tr_b16 a[244:245],v4 offset:12416
ds_read_b64_tr_b16 a[246:247],v4 offset:18560
v_mfma_f32_16x16x32_bf16 v[168:171],a[248:251],v[112:115],v[168:171]
ds_read_b128 a[204:207],v2 offset:128
v_fma_f32 v39,v39,s36,v16
v_mfma_f32_16x16x32_bf16 v[216:219],a[248:251],v[116:119],v[216:219]
buffer_load_dwordx4 v8,s[8:11],s21 offen offset:1024 lds
v_mfma_f32_16x16x32_bf16 a[8:11],a[248:251],v[120:123],a[8:11]
s_waitcnt lgkmcnt(7)
ds_read_b64_tr_b16 a[248:249],v5 offset:12416
ds_read_b64_tr_b16 a[250:251],v5 offset:18560
v_mfma_f32_16x16x32_bf16 v[172:175],a[252:255],v[112:115],v[172:175]
ds_read_b128 a[208:211],v1 offset:256
v_fma_f32 v44,v44,s36,v17
v_mfma_f32_16x16x32_bf16 v[220:223],a[252:255],v[116:119],v[220:223]
ds_read_b128 a[212:215],v2 offset:256
v_fma_f32 v45,v45,s36,v17
v_mfma_f32_16x16x32_bf16 a[12:15],a[252:255],v[120:123],a[12:15]
s_waitcnt lgkmcnt(8)
ds_read_b64_tr_b16 a[252:253],v6 offset:12416
ds_read_b64_tr_b16 a[254:255],v6 offset:18560
v_mfma_f32_16x16x32_bf16 v[176:179],a[240:243],v[112:115],v[176:179]
buffer_load_dwordx4 v9,s[8:11],s21 offen offset:2048 lds
v_mfma_f32_16x16x32_bf16 v[224:227],a[240:243],v[116:119],v[224:227]
s_add_u32 s21,s21,12288
ds_read_b128 a[216:219],v1 offset:6144
v_fma_f32 v46,v46,s36,v17
v_mfma_f32_16x16x32_bf16 a[16:19],a[240:243],v[120:123],a[16:19]
s_add_u32 m0,s22,24576
ds_read_b64_tr_b16 a[240:241],v3 offset:12544
ds_read_b64_tr_b16 a[242:243],v3 offset:18688
s_waitcnt lgkmcnt(9)
v_mfma_f32_16x16x32_bf16 v[180:183],a[244:247],v[112:115],v[180:183]
ds_read_b128 a[220:223],v2 offset:6144
v_fma_f32 v47,v47,s36,v17
v_mfma_f32_16x16x32_bf16 v[228:231],a[244:247],v[116:119],v[228:231]
ds_read_b128 a[224:227],v1 offset:6272
v_fma_f32 v48,v48,s36,v18
v_mfma_f32_16x16x32_bf16 a[20:23],a[244:247],v[120:123],a[20:23]
s_waitcnt lgkmcnt(8)
ds_read_b64_tr_b16 a[244:245],v4 offset:12544
ds_read_b64_tr_b16 a[246:247],v4 offset:18688
v_mfma_f32_16x16x32_bf16 v[184:187],a[248:251],v[112:115],v[184:187]
buffer_load_dwordx4 v7,s[4:7],s20 offen offset:0 lds
v_mfma_f32_16x16x32_bf16 v[232:235],a[248:251],v[116:119],v[232:235]
ds_read_b128 a[228:231],v2 offset:6272
v_fma_f32 v49,v49,s36,v18
v_mfma_f32_16x16x32_bf16 a[24:27],a[248:251],v[120:123],a[24:27]
s_waitcnt lgkmcnt(8)
ds_read_b64_tr_b16 a[248:249],v5 offset:12544
ds_read_b64_tr_b16 a[250:251],v5 offset:18688
v_mfma_f32_16x16x32_bf16 v[188:191],a[252:255],v[112:115],v[188:191]
ds_read_b128 a[232:235],v1 offset:6400
v_fma_f32 v50,v50,s36,v18
v_mfma_f32_16x16x32_bf16 v[236:239],a[252:255],v[116:119],v[236:239]
ds_read_b128 a[236:239],v2 offset:6400
v_fma_f32 v51,v51,s36,v18
v_mfma_f32_16x16x32_bf16 a[28:31],a[252:255],v[120:123],a[28:31]
s_waitcnt lgkmcnt(8)
ds_read_b64_tr_b16 a[252:253],v6 offset:12544
ds_read_b64_tr_b16 a[254:255],v6 offset:18688
v_mfma_f32_16x16x32_bf16 v[192:195],a[240:243],v[112:115],v[192:195]
buffer_load_dwordx4 v8,s[4:7],s20 offen offset:1024 lds
v_mfma_f32_16x16x32_bf16 v[240:243],a[240:243],v[116:119],v[240:243]
v_fma_f32 v52,v52,s36,v18
v_fma_f32 v53,v53,s36,v18
v_mfma_f32_16x16x32_bf16 a[32:35],a[240:243],v[120:123],a[32:35]
s_waitcnt lgkmcnt(7)
v_fma_f32 v54,v54,s36,v18
v_fma_f32 v55,v55,s36,v18
v_mfma_f32_16x16x32_bf16 v[196:199],a[244:247],v[112:115],v[196:199]
v_exp_f32 v36,v36
v_mfma_f32_16x16x32_bf16 v[244:247],a[244:247],v[116:119],v[244:247]
v_exp_f32 v37,v37
v_mfma_f32_16x16x32_bf16 a[36:39],a[244:247],v[120:123],a[36:39]
s_waitcnt lgkmcnt(3)
v_exp_f32 v38,v38
v_mfma_f32_16x16x32_bf16 v[200:203],a[248:251],v[112:115],v[200:203]
buffer_load_dwordx4 v9,s[4:7],s20 offen offset:2048 lds
v_mfma_f32_16x16x32_bf16 v[248:251],a[248:251],v[116:119],v[248:251]
s_add_u32 s20,s20,12288
v_exp_f32 v39,v39
v_mfma_f32_16x16x32_bf16 a[40:43],a[248:251],v[120:123],a[40:43]
s_waitcnt lgkmcnt(0)
v_exp_f32 v44,v44
v_mfma_f32_16x16x32_bf16 v[204:207],a[252:255],v[112:115],v[204:207]
v_exp_f32 v45,v45
v_mfma_f32_16x16x32_bf16 v[252:255],a[252:255],v[116:119],v[252:255]
v_exp_f32 v46,v46
v_mfma_f32_16x16x32_bf16 a[44:47],a[252:255],v[120:123],a[44:47]
v_exp_f32 v47,v47
v_mfma_f32_16x16x32_bf16 v[64:67],a[192:195],a[96:99],0
v_exp_f32 v48,v48
v_mfma_f32_16x16x32_bf16 v[64:67],a[196:199],a[100:103],v[64:67]
v_exp_f32 v49,v49
v_mfma_f32_16x16x32_bf16 v[64:67],a[200:203],a[104:107],v[64:67]
v_exp_f32 v50,v50
v_mfma_f32_16x16x32_bf16 v[64:67],a[204:207],a[108:111],v[64:67]
v_exp_f32 v51,v51
v_mfma_f32_16x16x32_bf16 v[64:67],a[208:211],a[112:115],v[64:67]
v_exp_f32 v52,v52
v_mfma_f32_16x16x32_bf16 v[64:67],a[212:215],a[116:119],v[64:67]
v_exp_f32 v53,v53
v_mfma_f32_16x16x32_bf16 v[72:75],a[192:195],a[120:123],0
v_exp_f32 v54,v54
v_mfma_f32_16x16x32_bf16 v[72:75],a[196:199],a[124:127],v[72:75]
v_exp_f32 v55,v55
v_mfma_f32_16x16x32_bf16 v[72:75],a[200:203],a[128:131],v[72:75]
v_cvt_pk_bf16_f32 v98,v36,v37
v_cvt_pk_bf16_f32 v99,v38,v39
v_mfma_f32_16x16x32_bf16 v[72:75],a[204:207],a[132:135],v[72:75]
v_cvt_pk_bf16_f32 v102,v44,v45
v_cvt_pk_bf16_f32 v103,v46,v47
v_mfma_f32_16x16x32_bf16 v[128:131],v[24:27],v[96:99],v[128:131]
v_cvt_pk_bf16_f32 v104,v48,v49
v_cvt_pk_bf16_f32 v105,v50,v51
v_mfma_f32_16x16x32_bf16 v[132:135],v[24:27],v[100:103],v[132:135]
v_cvt_pk_bf16_f32 v106,v52,v53
v_cvt_pk_bf16_f32 v107,v54,v55
v_mfma_f32_16x16x32_bf16 v[72:75],a[208:211],a[136:139],v[72:75]
v_fma_f32 v64,v64,s36,v16
v_fma_f32 v65,v65,s36,v16
v_mfma_f32_16x16x32_bf16 v[136:139],v[24:27],v[104:107],v[136:139]
v_fma_f32 v66,v66,s36,v16
v_fma_f32 v67,v67,s36,v16
v_mfma_f32_16x16x32_bf16 v[72:75],a[212:215],a[140:143],v[72:75]
v_exp_f32 v64,v64
v_mfma_f32_16x16x32_bf16 v[80:83],a[192:195],a[144:147],0
v_exp_f32 v65,v65
v_mfma_f32_16x16x32_bf16 v[80:83],a[196:199],a[148:151],v[80:83]
v_exp_f32 v66,v66
v_mfma_f32_16x16x32_bf16 v[80:83],a[200:203],a[152:155],v[80:83]
v_exp_f32 v67,v67
v_mfma_f32_16x16x32_bf16 v[80:83],a[204:207],a[156:159],v[80:83]
v_fma_f32 v72,v72,s36,v17
v_fma_f32 v73,v73,s36,v17
v_mfma_f32_16x16x32_bf16 v[80:83],a[208:211],a[160:163],v[80:83]
v_fma_f32 v74,v74,s36,v17
v_fma_f32 v75,v75,s36,v17
v_mfma_f32_16x16x32_bf16 v[80:83],a[212:215],a[164:167],v[80:83]
v_exp_f32 v72,v72
v_mfma_f32_16x16x32_bf16 v[68:71],a[216:219],a[96:99],0
v_exp_f32 v73,v73
v_mfma_f32_16x16x32_bf16 v[68:71],a[220:223],a[100:103],v[68:71]
v_exp_f32 v74,v74
v_mfma_f32_16x16x32_bf16 v[68:71],a[224:227],a[104:107],v[68:71]
v_exp_f32 v75,v75
v_mfma_f32_16x16x32_bf16 v[68:71],a[228:231],a[108:111],v[68:71]
v_cvt_pk_bf16_f32 v112,v64,v65
v_cvt_pk_bf16_f32 v113,v66,v67
s_waitcnt vmcnt(6)
s_barrier
v_mfma_f32_16x16x32_bf16 v[68:71],a[232:235],a[112:115],v[68:71]
v_cvt_pk_bf16_f32 v116,v72,v73
v_cvt_pk_bf16_f32 v117,v74,v75
v_mfma_f32_16x16x32_bf16 v[68:71],a[236:239],a[116:119],v[68:71]
ds_read_b64_tr_b16 a[240:241],v3 offset:24576
ds_read_b64_tr_b16 a[242:243],v3 offset:30720
v_mfma_f32_16x16x32_bf16 v[76:79],a[216:219],a[120:123],0
v_mfma_f32_16x16x32_bf16 v[76:79],a[220:223],a[124:127],v[76:79]
ds_read_b64_tr_b16 a[244:245],v4 offset:24576
ds_read_b64_tr_b16 a[246:247],v4 offset:30720
v_mfma_f32_16x16x32_bf16 v[76:79],a[224:227],a[128:131],v[76:79]
ds_read_b64_tr_b16 a[248:249],v5 offset:24576
ds_read_b64_tr_b16 a[250:251],v5 offset:30720
v_mfma_f32_16x16x32_bf16 v[76:79],a[228:231],a[132:135],v[76:79]
v_mfma_f32_16x16x32_bf16 v[76:79],a[232:235],a[136:139],v[76:79]
ds_read_b64_tr_b16 a[252:253],v6 offset:24576
ds_read_b64_tr_b16 a[254:255],v6 offset:30720
v_mfma_f32_16x16x32_bf16 v[76:79],a[236:239],a[140:143],v[76:79]
v_mfma_f32_16x16x32_bf16 v[84:87],a[216:219],a[144:147],0
v_mfma_f32_16x16x32_bf16 v[84:87],a[220:223],a[148:151],v[84:87]
v_mfma_f32_16x16x32_bf16 v[84:87],a[224:227],a[152:155],v[84:87]
v_mfma_f32_16x16x32_bf16 v[84:87],a[228:231],a[156:159],v[84:87]
v_mfma_f32_16x16x32_bf16 v[84:87],a[232:235],a[160:163],v[84:87]
v_mfma_f32_16x16x32_bf16 v[84:87],a[236:239],a[164:167],v[84:87]
s_mov_b32 s38,0
s_branch L_loop3
L_tr44:
s_waitcnt vmcnt(36)
s_waitcnt lgkmcnt(4)
v_mfma_f32_16x16x32_bf16 v[160:163],a[240:243],v[96:99],v[160:163]
s_add_u32 m0,s24,0
ds_read_b128 a[96:99],v28 offset:0
v_fma_f32 v68,v68,s36,v16
v_mfma_f32_16x16x32_bf16 v[208:211],a[240:243],v[100:103],v[208:211]
ds_read_b128 a[100:103],v29 offset:0
v_fma_f32 v69,v69,s36,v16
v_mfma_f32_16x16x32_bf16 a[0:3],a[240:243],v[104:107],a[0:3]
ds_read_b128 a[104:107],v28 offset:128
v_fma_f32 v70,v70,s36,v16
v_mfma_f32_16x16x32_bf16 a[48:51],a[240:243],v[108:111],a[48:51]
ds_read_b128 a[108:111],v29 offset:128
v_fma_f32 v71,v71,s36,v16
v_mfma_f32_16x16x32_bf16 v[164:167],a[244:247],v[96:99],v[164:167]
ds_read_b128 a[112:115],v28 offset:256
v_fma_f32 v76,v76,s36,v17
v_mfma_f32_16x16x32_bf16 v[212:215],a[244:247],v[100:103],v[212:215]
ds_read_b128 a[116:119],v29 offset:256
v_fma_f32 v77,v77,s36,v17
v_mfma_f32_16x16x32_bf16 a[4:7],a[244:247],v[104:107],a[4:7]
ds_read_b64_tr_b16 a[240:241],v3 offset:24704
ds_read_b64_tr_b16 a[242:243],v3 offset:30848
v_mfma_f32_16x16x32_bf16 a[52:55],a[244:247],v[108:111],a[52:55]
s_waitcnt lgkmcnt(8)
ds_read_b64_tr_b16 a[244:245],v4 offset:24704
ds_read_b64_tr_b16 a[246:247],v4 offset:30848
v_mfma_f32_16x16x32_bf16 v[168:171],a[248:251],v[96:99],v[168:171]
ds_read_b128 a[192:195],v13 offset:0
v_fma_f32 v78,v78,s36,v17
v_mfma_f32_16x16x32_bf16 v[216:219],a[248:251],v[100:103],v[216:219]
ds_read_b128 a[196:199],v14 offset:0
v_fma_f32 v79,v79,s36,v17
v_mfma_f32_16x16x32_bf16 a[8:11],a[248:251],v[104:107],a[8:11]
ds_read_b128 a[200:203],v13 offset:128
v_fma_f32 v80,v80,s36,v18
v_mfma_f32_16x16x32_bf16 a[56:59],a[248:251],v[108:111],a[56:59]
ds_read_b64_tr_b16 a[248:249],v5 offset:24704
ds_read_b64_tr_b16 a[250:251],v5 offset:30848
v_mfma_f32_16x16x32_bf16 v[172:175],a[252:255],v[96:99],v[172:175]
ds_read_b128 a[204:207],v14 offset:128
v_fma_f32 v81,v81,s36,v18
v_mfma_f32_16x16x32_bf16 v[220:223],a[252:255],v[100:103],v[220:223]
ds_read_b128 a[208:211],v13 offset:256
v_fma_f32 v82,v82,s36,v18
v_mfma_f32_16x16x32_bf16 a[12:15],a[252:255],v[104:107],a[12:15]
s_waitcnt lgkmcnt(11)
buffer_load_dwordx4 v7,s[12:15],s28 offen offset:0 nt lds
v_mfma_f32_16x16x32_bf16 a[60:63],a[252:255],v[108:111],a[60:63]
s_waitcnt lgkmcnt(7)
ds_read_b64_tr_b16 a[252:253],v6 offset:24704
ds_read_b64_tr_b16 a[254:255],v6 offset:30848
v_mfma_f32_16x16x32_bf16 v[176:179],a[240:243],v[96:99],v[176:179]
ds_read_b128 a[212:215],v14 offset:256
v_fma_f32 v83,v83,s36,v18
v_mfma_f32_16x16x32_bf16 v[224:227],a[240:243],v[100:103],v[224:227]
ds_read_b128 a[216:219],v13 offset:45056
v_fma_f32 v84,v84,s36,v18
v_mfma_f32_16x16x32_bf16 a[16:19],a[240:243],v[104:107],a[16:19]
ds_read_b128 a[220:223],v14 offset:45056
v_fma_f32 v85,v85,s36,v18
v_mfma_f32_16x16x32_bf16 a[64:67],a[240:243],v[108:111],a[64:67]
ds_read_b64_tr_b16 a[240:241],v3 offset:24832
ds_read_b64_tr_b16 a[242:243],v3 offset:30976
v_mfma_f32_16x16x32_bf16 v[180:183],a[244:247],v[96:99],v[180:183]
ds_read_b128 a[224:227],v13 offset:45184
v_fma_f32 v86,v86,s36,v18
v_mfma_f32_16x16x32_bf16 v[228:231],a[244:247],v[100:103],v[228:231]
buffer_load_dwordx4 v8,s[12:15],s28 offen offset:1024 nt lds
v_mfma_f32_16x16x32_bf16 a[20:23],a[244:247],v[104:107],a[20:23]
ds_read_b128 a[228:231],v14 offset:45184
v_fma_f32 v87,v87,s36,v18
v_mfma_f32_16x16x32_bf16 a[68:71],a[244:247],v[108:111],a[68:71]
s_waitcnt lgkmcnt(7)
ds_read_b64_tr_b16 a[244:245],v4 offset:24832
ds_read_b64_tr_b16 a[246:247],v4 offset:30976
v_mfma_f32_16x16x32_bf16 v[184:187],a[248:251],v[96:99],v[184:187]
ds_read_b128 a[232:235],v13 offset:45312
v_fma_f32 v88,v88,s36,v19
v_mfma_f32_16x16x32_bf16 v[232:235],a[248:251],v[100:103],v[232:235]
ds_read_b128 a[236:239],v14 offset:45312
v_fma_f32 v89,v89,s36,v19
v_mfma_f32_16x16x32_bf16 a[24:27],a[248:251],v[104:107],a[24:27]
ds_read_b128 a[120:123],v28 offset:6144
v_fma_f32 v90,v90,s36,v19
v_mfma_f32_16x16x32_bf16 a[72:75],a[248:251],v[108:111],a[72:75]
ds_read_b64_tr_b16 a[248:249],v5 offset:24832
ds_read_b64_tr_b16 a[250:251],v5 offset:30976
v_mfma_f32_16x16x32_bf16 v[188:191],a[252:255],v[96:99],v[188:191]
ds_read_b128 a[124:127],v29 offset:6144
v_fma_f32 v91,v91,s36,v19
v_mfma_f32_16x16x32_bf16 v[236:239],a[252:255],v[100:103],v[236:239]
ds_read_b128 a[128:131],v28 offset:6272
v_fma_f32 v92,v92,s36,v19
v_mfma_f32_16x16x32_bf16 a[28:31],a[252:255],v[104:107],a[28:31]
buffer_load_dwordx4 v9,s[12:15],s28 offen offset:2048 nt lds
s_add_u32 s28,s28,3072
s_add_u32 m0,s24,3072
v_mfma_f32_16x16x32_bf16 a[76:79],a[252:255],v[108:111],a[76:79]
s_waitcnt lgkmcnt(7)
ds_read_b64_tr_b16 a[252:253],v6 offset:24832
ds_read_b64_tr_b16 a[254:255],v6 offset:30976
v_mfma_f32_16x16x32_bf16 v[192:195],a[240:243],v[96:99],v[192:195]
ds_read_b128 a[132:135],v29 offset:6272
v_fma_f32 v93,v93,s36,v19
v_mfma_f32_16x16x32_bf16 v[240:243],a[240:243],v[100:103],v[240:243]
ds_read_b128 a[136:139],v28 offset:6400
v_fma_f32 v94,v94,s36,v19
v_mfma_f32_16x16x32_bf16 a[32:35],a[240:243],v[104:107],a[32:35]
ds_read_b128 a[140:143],v29 offset:6400
v_fma_f32 v95,v95,s36,v19
v_mfma_f32_16x16x32_bf16 a[80:83],a[240:243],v[108:111],a[80:83]
v_exp_f32 v68,v68
v_mfma_f32_16x16x32_bf16 v[196:199],a[244:247],v[96:99],v[196:199]
v_exp_f32 v69,v69
v_mfma_f32_16x16x32_bf16 v[244:247],a[244:247],v[100:103],v[244:247]
v_exp_f32 v70,v70
v_mfma_f32_16x16x32_bf16 a[36:39],a[244:247],v[104:107],a[36:39]
v_exp_f32 v71,v71
v_mfma_f32_16x16x32_bf16 a[84:87],a[244:247],v[108:111],a[84:87]
s_waitcnt lgkmcnt(4)
v_exp_f32 v76,v76
v_mfma_f32_16x16x32_bf16 v[200:203],a[248:251],v[96:99],v[200:203]
buffer_load_dwordx4 v7,s[12:15],s28 offen offset:0 nt lds
v_mfma_f32_16x16x32_bf16 v[248:251],a[248:251],v[100:103],v[248:251]
v_exp_f32 v77,v77
v_mfma_f32_16x16x32_bf16 a[40:43],a[248:251],v[104:107],a[40:43]
v_exp_f32 v78,v78
v_mfma_f32_16x16x32_bf16 a[88:91],a[248:251],v[108:111],a[88:91]
s_waitcnt lgkmcnt(0)
v_exp_f32 v79,v79
v_mfma_f32_16x16x32_bf16 v[204:207],a[252:255],v[96:99],v[204:207]
v_exp_f32 v80,v80
v_mfma_f32_16x16x32_bf16 v[252:255],a[252:255],v[100:103],v[252:255]
v_exp_f32 v81,v81
v_mfma_f32_16x16x32_bf16 a[44:47],a[252:255],v[104:107],a[44:47]
v_exp_f32 v82,v82
v_mfma_f32_16x16x32_bf16 a[92:95],a[252:255],v[108:111],a[92:95]
v_exp_f32 v83,v83
v_exp_f32 v84,v84
v_exp_f32 v85,v85
v_exp_f32 v86,v86
v_exp_f32 v87,v87
v_exp_f32 v88,v88
v_exp_f32 v89,v89
v_exp_f32 v90,v90
v_exp_f32 v91,v91
v_exp_f32 v92,v92
v_exp_f32 v93,v93
v_exp_f32 v94,v94
v_exp_f32 v95,v95
v_cvt_pk_bf16_f32 v114,v68,v69
v_cvt_pk_bf16_f32 v115,v70,v71
v_cvt_pk_bf16_f32 v118,v76,v77
v_cvt_pk_bf16_f32 v119,v78,v79
v_mfma_f32_16x16x32_bf16 v[128:131],v[24:27],v[112:115],v[128:131]
buffer_load_dwordx4 v8,s[12:15],s28 offen offset:1024 nt lds
v_mfma_f32_16x16x32_bf16 v[132:135],v[24:27],v[116:119],v[132:135]
v_cvt_pk_bf16_f32 v120,v80,v81
v_cvt_pk_bf16_f32 v121,v82,v83
v_cvt_pk_bf16_f32 v122,v84,v85
v_cvt_pk_bf16_f32 v123,v86,v87
v_cvt_pk_bf16_f32 v124,v88,v89
v_cvt_pk_bf16_f32 v125,v90,v91
v_mfma_f32_16x16x32_bf16 v[136:139],v[24:27],v[120:123],v[136:139]
buffer_load_dwordx4 v9,s[12:15],s28 offen offset:2048 nt lds
s_waitcnt vmcnt(12)
s_barrier
ds_read_b64_tr_b16 a[240:241],v3 offset:0
ds_read_b64_tr_b16 a[242:243],v3 offset:6144
ds_read_b64_tr_b16 a[244:245],v4 offset:0
v_cvt_pk_bf16_f32 v126,v92,v93
v_cvt_pk_bf16_f32 v127,v94,v95
s_add_u32 s28,s28,3072
ds_read_b64_tr_b16 a[246:247],v4 offset:6144
v_mfma_f32_16x16x32_bf16 v[140:143],v[24:27],v[124:127],v[140:143]
ds_read_b64_tr_b16 a[248:249],v5 offset:0
ds_read_b64_tr_b16 a[250:251],v5 offset:6144
ds_read_b64_tr_b16 a[252:253],v6 offset:0
ds_read_b64_tr_b16 a[254:255],v6 offset:6144
s_waitcnt lgkmcnt(6)
v_mfma_f32_16x16x32_bf16 v[160:163],a[240:243],v[112:115],v[160:163]
s_add_u32 s87,s42,18432
v_rcp_f32 v146,v132
v_mfma_f32_16x16x32_bf16 v[208:211],a[240:243],v[116:119],v[208:211]
v_rcp_f32 v150,v140
v_mfma_f32_16x16x32_bf16 a[0:3],a[240:243],v[120:123],a[0:3]
v_rcp_f32 v148,v136
v_mfma_f32_16x16x32_bf16 a[48:51],a[240:243],v[124:127],a[48:51]
s_waitcnt lgkmcnt(4)
ds_read_b64_tr_b16 a[240:241],v3 offset:128
ds_read_b64_tr_b16 a[242:243],v3 offset:6272
v_mfma_f32_16x16x32_bf16 v[164:167],a[244:247],v[112:115],v[164:167]
v_rcp_f32 v144,v128
v_mfma_f32_16x16x32_bf16 v[212:215],a[244:247],v[116:119],v[212:215]
v_max3_f32 v30,v128,v132,v136
v_max_f32 v30,v30,v140
v_mfma_f32_16x16x32_bf16 a[4:7],a[244:247],v[120:123],a[4:7]
v_accvgpr_read_b32 v64,a48
v_accvgpr_read_b32 v65,a49
v_mfma_f32_16x16x32_bf16 a[52:55],a[244:247],v[124:127],a[52:55]
ds_read_b64_tr_b16 a[244:245],v4 offset:128
ds_read_b64_tr_b16 a[246:247],v4 offset:6272
v_accvgpr_read_b32 v66,a50
v_accvgpr_read_b32 v67,a51
v_cmp_ngt_f32 vcc,s37,v30
v_pk_mul_f32 v[64:65],v[64:65],v[150:151] op_sel_hi:[1,0]
v_pk_mul_f32 v[208:209],v[208:209],v[146:147] op_sel_hi:[1,0]
v_pk_mul_f32 v[210:211],v[210:211],v[146:147] op_sel_hi:[1,0]
v_pk_mul_f32 v[66:67],v[66:67],v[150:151] op_sel_hi:[1,0]
v_accvgpr_read_b32 v68,a52
v_accvgpr_read_b32 v69,a53
s_waitcnt lgkmcnt(4)
v_mfma_f32_16x16x32_bf16 v[168:171],a[248:251],v[112:115],v[168:171]
s_cmp_lg_u64 vcc,0
v_accvgpr_read_b32 v70,a54
v_accvgpr_read_b32 v71,a55
v_mfma_f32_16x16x32_bf16 v[216:219],a[248:251],v[116:119],v[216:219]
s_cselect_b32 s62,s32,0
v_cvt_pk_bf16_f32 v80,v64,v65
v_cvt_pk_bf16_f32 v81,v66,v67
v_mfma_f32_16x16x32_bf16 a[8:11],a[248:251],v[120:123],a[8:11]
s_or_b32 s31,s31,s62
v_cvt_pk_bf16_f32 v82,v208,v209
v_cvt_pk_bf16_f32 v83,v210,v211
v_mfma_f32_16x16x32_bf16 a[56:59],a[248:251],v[124:127],a[56:59]
s_lshl_b32 s32,s32,1
ds_read_b64_tr_b16 a[248:249],v5 offset:128
ds_read_b64_tr_b16 a[250:251],v5 offset:6272
ds_write2st64_b64 v12,v[80:81],v[82:83] offset0:36 offset1:12
s_add_u32 m0,s22,24576
v_pk_mul_f32 v[68:69],v[68:69],v[150:151] op_sel_hi:[1,0]
v_pk_mul_f32 v[70:71],v[70:71],v[150:151] op_sel_hi:[1,0]
v_pk_mul_f32 v[212:213],v[212:213],v[146:147] op_sel_hi:[1,0]
v_pk_mul_f32 v[214:215],v[214:215],v[146:147] op_sel_hi:[1,0]
v_accvgpr_read_b32 v72,a56
v_accvgpr_read_b32 v73,a57
v_mfma_f32_16x16x32_bf16 v[172:175],a[252:255],v[112:115],v[172:175]
buffer_load_dwordx4 v7,s[4:7],s20 offen offset:0 lds
v_mfma_f32_16x16x32_bf16 v[220:223],a[252:255],v[116:119],v[220:223]
v_accvgpr_read_b32 v74,a58
v_accvgpr_read_b32 v75,a59
v_mfma_f32_16x16x32_bf16 a[12:15],a[252:255],v[120:123],a[12:15]
v_cvt_pk_bf16_f32 v84,v68,v69
v_cvt_pk_bf16_f32 v85,v70,v71
v_mfma_f32_16x16x32_bf16 a[60:63],a[252:255],v[124:127],a[60:63]
ds_read_b64_tr_b16 a[252:253],v6 offset:128
ds_read_b64_tr_b16 a[254:255],v6 offset:6272
v_cvt_pk_bf16_f32 v86,v212,v213
v_cvt_pk_bf16_f32 v87,v214,v215
v_subrev_u32 v11,18432,v11
v_pk_mul_f32 v[72:73],v[72:73],v[150:151] op_sel_hi:[1,0]
v_pk_mul_f32 v[74:75],v[74:75],v[150:151] op_sel_hi:[1,0]
v_pk_mul_f32 v[216:217],v[216:217],v[146:147] op_sel_hi:[1,0]
v_pk_mul_f32 v[218:219],v[218:219],v[146:147] op_sel_hi:[1,0]
v_accvgpr_read_b32 v76,a60
v_accvgpr_read_b32 v77,a61
s_waitcnt lgkmcnt(2)
v_mfma_f32_16x16x32_bf16 v[176:179],a[240:243],v[112:115],v[176:179]
ds_write2st64_b64 v20,v[84:85],v[86:87] offset0:36 offset1:12
v_mfma_f32_16x16x32_bf16 v[224:227],a[240:243],v[116:119],v[224:227]
v_accvgpr_read_b32 v78,a62
v_accvgpr_read_b32 v79,a63
v_mfma_f32_16x16x32_bf16 a[16:19],a[240:243],v[120:123],a[16:19]
v_cvt_pk_bf16_f32 v88,v72,v73
v_cvt_pk_bf16_f32 v89,v74,v75
v_cvt_pk_bf16_f32 v90,v216,v217
v_cvt_pk_bf16_f32 v91,v218,v219
v_subrev_u32 v23,18432,v23
v_pk_mul_f32 v[76:77],v[76:77],v[150:151] op_sel_hi:[1,0]
v_pk_mul_f32 v[78:79],v[78:79],v[150:151] op_sel_hi:[1,0]
v_pk_mul_f32 v[220:221],v[220:221],v[146:147] op_sel_hi:[1,0]
v_pk_mul_f32 v[222:223],v[222:223],v[146:147] op_sel_hi:[1,0]
v_cvt_pk_bf16_f32 v92,v76,v77
v_cvt_pk_bf16_f32 v93,v78,v79
v_mfma_f32_16x16x32_bf16 a[64:67],a[240:243],v[124:127],a[64:67]
buffer_load_dwordx4 v8,s[4:7],s20 offen offset:1024 lds
v_mfma_f32_16x16x32_bf16 v[180:183],a[244:247],v[112:115],v[180:183]
ds_read_b64_tr_b16 a[240:241],v3 offset:256
ds_read_b64_tr_b16 a[242:243],v3 offset:6400
v_mfma_f32_16x16x32_bf16 v[228:231],a[244:247],v[116:119],v[228:231]
ds_write2st64_b64 v21,v[88:89],v[90:91] offset0:36 offset1:12
v_mfma_f32_16x16x32_bf16 a[20:23],a[244:247],v[120:123],a[20:23]
v_cvt_pk_bf16_f32 v94,v220,v221
v_accvgpr_read_b32 v64,a64
v_accvgpr_read_b32 v65,a65
v_accvgpr_read_b32 v66,a66
v_accvgpr_read_b32 v67,a67
v_pk_mul_f32 v[224:225],v[224:225],v[146:147] op_sel_hi:[1,0]
v_pk_mul_f32 v[226:227],v[226:227],v[146:147] op_sel_hi:[1,0]
v_pk_mul_f32 v[64:65],v[64:65],v[150:151] op_sel_hi:[1,0]
v_pk_mul_f32 v[66:67],v[66:67],v[150:151] op_sel_hi:[1,0]
v_cvt_pk_bf16_f32 v80,v64,v65
v_cvt_pk_bf16_f32 v81,v66,v67
v_mfma_f32_16x16x32_bf16 a[68:71],a[244:247],v[124:127],a[68:71]
ds_read_b64_tr_b16 a[244:245],v4 offset:256
ds_read_b64_tr_b16 a[246:247],v4 offset:6400
v_mfma_f32_16x16x32_bf16 v[184:187],a[248:251],v[112:115],v[184:187]
v_cvt_pk_bf16_f32 v95,v222,v223
v_cvt_pk_bf16_f32 v82,v224,v225
v_mfma_f32_16x16x32_bf16 v[232:235],a[248:251],v[116:119],v[232:235]
ds_write2st64_b64 v22,v[92:93],v[94:95] offset0:36 offset1:12
v_mfma_f32_16x16x32_bf16 a[24:27],a[248:251],v[120:123],a[24:27]
v_accvgpr_read_b32 v68,a68
v_accvgpr_read_b32 v69,a69
v_accvgpr_read_b32 v70,a70
v_accvgpr_read_b32 v71,a71
v_cvt_pk_bf16_f32 v83,v226,v227
v_pk_mul_f32 v[228:229],v[228:229],v[146:147] op_sel_hi:[1,0]
v_pk_mul_f32 v[230:231],v[230:231],v[146:147] op_sel_hi:[1,0]
v_pk_mul_f32 v[68:69],v[68:69],v[150:151] op_sel_hi:[1,0]
v_pk_mul_f32 v[70:71],v[70:71],v[150:151] op_sel_hi:[1,0]
v_cvt_pk_bf16_f32 v84,v68,v69
v_cvt_pk_bf16_f32 v85,v70,v71
v_mfma_f32_16x16x32_bf16 a[72:75],a[248:251],v[124:127],a[72:75]
buffer_load_dwordx4 v9,s[4:7],s20 offen offset:2048 lds
s_add_u32 s20,s20,12288
s_add_u32 m0,s23,0
s_waitcnt lgkmcnt(3)
v_mfma_f32_16x16x32_bf16 v[188:191],a[252:255],v[112:115],v[188:191]
ds_read_b64_tr_b16 a[248:249],v5 offset:256
ds_read_b64_tr_b16 a[250:251],v5 offset:6400
v_mfma_f32_16x16x32_bf16 v[236:239],a[252:255],v[116:119],v[236:239]
ds_read_b128 v[152:155],v15 offset:18432
v_accvgpr_read_b32 v72,a72
v_mfma_f32_16x16x32_bf16 a[28:31],a[252:255],v[120:123],a[28:31]
ds_read_b128 v[156:159],v15 offset:21504
v_accvgpr_read_b32 v73,a73
v_accvgpr_read_b32 v74,a74
v_accvgpr_read_b32 v75,a75
v_cvt_pk_bf16_f32 v86,v228,v229
v_pk_mul_f32 v[232:233],v[232:233],v[146:147] op_sel_hi:[1,0]
v_pk_mul_f32 v[234:235],v[234:235],v[146:147] op_sel_hi:[1,0]
v_pk_mul_f32 v[72:73],v[72:73],v[150:151] op_sel_hi:[1,0]
v_pk_mul_f32 v[74:75],v[74:75],v[150:151] op_sel_hi:[1,0]
v_cvt_pk_bf16_f32 v88,v72,v73
v_cvt_pk_bf16_f32 v89,v74,v75
v_mfma_f32_16x16x32_bf16 a[76:79],a[252:255],v[124:127],a[76:79]
ds_read_b64_tr_b16 a[252:253],v6 offset:256
ds_read_b64_tr_b16 a[254:255],v6 offset:6400
v_mfma_f32_16x16x32_bf16 v[192:195],a[240:243],v[112:115],v[192:195]
ds_write2st64_b64 v12,v[80:81],v[82:83] offset0:36 offset1:14
v_mfma_f32_16x16x32_bf16 v[240:243],a[240:243],v[116:119],v[240:243]
v_cvt_pk_bf16_f32 v87,v230,v231
v_cvt_pk_bf16_f32 v90,v232,v233
v_mfma_f32_16x16x32_bf16 a[32:35],a[240:243],v[120:123],a[32:35]
v_accvgpr_read_b32 v76,a76
v_accvgpr_read_b32 v77,a77
v_accvgpr_read_b32 v78,a78
v_accvgpr_read_b32 v79,a79
v_cvt_pk_bf16_f32 v91,v234,v235
v_pk_mul_f32 v[236:237],v[236:237],v[146:147] op_sel_hi:[1,0]
v_pk_mul_f32 v[238:239],v[238:239],v[146:147] op_sel_hi:[1,0]
v_pk_mul_f32 v[76:77],v[76:77],v[150:151] op_sel_hi:[1,0]
v_pk_mul_f32 v[78:79],v[78:79],v[150:151] op_sel_hi:[1,0]
v_cvt_pk_bf16_f32 v92,v76,v77
v_cvt_pk_bf16_f32 v93,v78,v79
v_mfma_f32_16x16x32_bf16 a[80:83],a[240:243],v[124:127],a[80:83]
s_waitcnt vmcnt(9)
ds_read_b128 a[144:147],v28 offset:12288
s_waitcnt lgkmcnt(4)
buffer_store_dwordx4 v[152:155],v10,s[16:19],s87 offen offset:0 nt
v_mfma_f32_16x16x32_bf16 v[196:199],a[244:247],v[112:115],v[196:199]
v_cvt_pk_bf16_f32 v94,v236,v237
v_cvt_pk_bf16_f32 v95,v238,v239
v_mfma_f32_16x16x32_bf16 v[244:247],a[244:247],v[116:119],v[244:247]
v_subrev_u32 v31,18432,v31
v_accvgpr_read_b32 v64,a80
v_mfma_f32_16x16x32_bf16 a[36:39],a[244:247],v[120:123],a[36:39]
ds_read_b128 a[148:151],v29 offset:12288
v_accvgpr_read_b32 v65,a81
v_accvgpr_read_b32 v66,a82
v_accvgpr_read_b32 v67,a83
v_pk_mul_f32 v[240:241],v[240:241],v[146:147] op_sel_hi:[1,0]
s_waitcnt vmcnt(13)
s_waitcnt lgkmcnt(2)
s_barrier
ds_read_b128 a[152:155],v28 offset:12416
buffer_store_dwordx4 v[156:159],v10,s[16:19],s87 offen offset:3072 nt
v_pk_mul_f32 v[242:243],v[242:243],v[146:147] op_sel_hi:[1,0]
v_pk_mul_f32 v[64:65],v[64:65],v[150:151] op_sel_hi:[1,0]
v_pk_mul_f32 v[66:67],v[66:67],v[150:151] op_sel_hi:[1,0]
v_cvt_pk_bf16_f32 v80,v64,v65
v_cvt_pk_bf16_f32 v81,v66,v67
v_mfma_f32_16x16x32_bf16 a[84:87],a[244:247],v[124:127],a[84:87]
v_accvgpr_read_b32 v64,a0
v_accvgpr_read_b32 v65,a1
v_mfma_f32_16x16x32_bf16 v[200:203],a[248:251],v[112:115],v[200:203]
ds_read_b128 a[156:159],v29 offset:12416
v_accvgpr_read_b32 v66,a2
v_mfma_f32_16x16x32_bf16 v[248:251],a[248:251],v[116:119],v[248:251]
ds_read_b128 a[160:163],v28 offset:12544
v_accvgpr_read_b32 v67,a3
v_mfma_f32_16x16x32_bf16 a[40:43],a[248:251],v[120:123],a[40:43]
buffer_load_dwordx4 v7,s[8:11],s21 offen offset:0 lds
ds_read_b128 a[164:167],v29 offset:12544
v_accvgpr_read_b32 v68,a84
v_pk_mul_f32 v[244:245],v[244:245],v[146:147] op_sel_hi:[1,0]
v_pk_mul_f32 v[246:247],v[246:247],v[146:147] op_sel_hi:[1,0]
v_accvgpr_read_b32 v69,a85
v_pk_mul_f32 v[68:69],v[68:69],v[150:151] op_sel_hi:[1,0]
v_accvgpr_read_b32 v70,a86
v_accvgpr_read_b32 v71,a87
v_pk_mul_f32 v[70:71],v[70:71],v[150:151] op_sel_hi:[1,0]
v_cvt_pk_bf16_f32 v82,v240,v241
v_cvt_pk_bf16_f32 v83,v242,v243
v_mfma_f32_16x16x32_bf16 a[88:91],a[248:251],v[124:127],a[88:91]
ds_write2st64_b64 v20,v[84:85],v[86:87] offset0:36 offset1:14
v_mfma_f32_16x16x32_bf16 v[204:207],a[252:255],v[112:115],v[204:207]
v_cvt_pk_bf16_f32 v84,v68,v69
v_cvt_pk_bf16_f32 v85,v70,v71
v_mfma_f32_16x16x32_bf16 v[252:255],a[252:255],v[116:119],v[252:255]
v_accvgpr_read_b32 v68,a16
v_accvgpr_read_b32 v69,a17
v_mfma_f32_16x16x32_bf16 a[44:47],a[252:255],v[120:123],a[44:47]
ds_write2st64_b64 v21,v[88:89],v[90:91] offset0:36 offset1:14
v_pk_mul_f32 v[248:249],v[248:249],v[146:147] op_sel_hi:[1,0]
v_pk_mul_f32 v[250:251],v[250:251],v[146:147] op_sel_hi:[1,0]
v_accvgpr_read_b32 v72,a88
v_accvgpr_read_b32 v73,a89
v_pk_mul_f32 v[72:73],v[72:73],v[150:151] op_sel_hi:[1,0]
v_accvgpr_read_b32 v74,a90
v_accvgpr_read_b32 v75,a91
v_pk_mul_f32 v[74:75],v[74:75],v[150:151] op_sel_hi:[1,0]
v_accvgpr_read_b32 v70,a18
v_accvgpr_read_b32 v71,a19
v_mfma_f32_16x16x32_bf16 a[92:95],a[252:255],v[124:127],a[92:95]
ds_write2st64_b64 v22,v[92:93],v[94:95] offset0:36 offset1:14
v_mfma_f32_16x16x32_bf16 v[32:35],a[192:195],a[96:99],0
v_cvt_pk_bf16_f32 v88,v72,v73
v_cvt_pk_bf16_f32 v89,v74,v75
v_mfma_f32_16x16x32_bf16 v[32:35],a[196:199],a[100:103],v[32:35]
v_accvgpr_read_b32 v72,a4
v_accvgpr_read_b32 v73,a5
v_mfma_f32_16x16x32_bf16 v[32:35],a[200:203],a[104:107],v[32:35]
buffer_load_dwordx4 v8,s[8:11],s21 offen offset:1024 lds
ds_read_b128 v[152:155],v15 offset:18432
v_accvgpr_read_b32 v76,a92
v_pk_mul_f32 v[252:253],v[252:253],v[146:147] op_sel_hi:[1,0]
v_pk_mul_f32 v[254:255],v[254:255],v[146:147] op_sel_hi:[1,0]
v_accvgpr_read_b32 v77,a93
v_pk_mul_f32 v[76:77],v[76:77],v[150:151] op_sel_hi:[1,0]
v_accvgpr_read_b32 v78,a94
v_accvgpr_read_b32 v79,a95
v_pk_mul_f32 v[78:79],v[78:79],v[150:151] op_sel_hi:[1,0]
v_cvt_pk_bf16_f32 v92,v76,v77
v_cvt_pk_bf16_f32 v93,v78,v79
v_mfma_f32_16x16x32_bf16 v[32:35],a[204:207],a[108:111],v[32:35]
ds_read_b128 v[156:159],v15 offset:21504
v_accvgpr_read_b32 v74,a6
v_mfma_f32_16x16x32_bf16 v[32:35],a[208:211],a[112:115],v[32:35]
ds_write2st64_b64 v12,v[80:81],v[82:83] offset0:36 offset1:16
v_mfma_f32_16x16x32_bf16 v[32:35],a[212:215],a[116:119],v[32:35]
v_accvgpr_read_b32 v75,a7
v_accvgpr_read_b32 v76,a20
v_accvgpr_read_b32 v77,a21
v_accvgpr_read_b32 v78,a22
v_accvgpr_read_b32 v79,a23
v_pk_mul_f32 v[64:65],v[64:65],v[148:149] op_sel_hi:[1,0]
v_pk_mul_f32 v[66:67],v[66:67],v[148:149] op_sel_hi:[1,0]
v_pk_mul_f32 v[68:69],v[68:69],v[148:149] op_sel_hi:[1,0]
v_pk_mul_f32 v[70:71],v[70:71],v[148:149] op_sel_hi:[1,0]
v_cvt_pk_bf16_f32 v80,v64,v65
v_cvt_pk_bf16_f32 v81,v66,v67
v_mfma_f32_16x16x32_bf16 v[36:39],a[216:219],a[96:99],0
buffer_load_dwordx4 v9,s[8:11],s21 offen offset:2048 lds
s_add_u32 s21,s21,12288
s_mov_b32 s27,s42
v_mfma_f32_16x16x32_bf16 v[36:39],a[220:223],a[100:103],v[36:39]
s_mov_b32 s42,s41
v_cvt_pk_bf16_f32 v82,v68,v69
v_cvt_pk_bf16_f32 v83,v70,v71
v_mfma_f32_16x16x32_bf16 v[36:39],a[224:227],a[104:107],v[36:39]
s_add_u32 s69,s69,1
s_waitcnt lgkmcnt(2)
buffer_store_dwordx4 v[152:155],v10,s[16:19],s87 offen offset:128 nt
s_add_u32 s48,s48,325632
s_lshr_b32 s62,s39,s69
v_mfma_f32_16x16x32_bf16 v[36:39],a[228:231],a[108:111],v[36:39]
s_and_b32 s62,s62,1
v_accvgpr_read_b32 v64,a8
v_accvgpr_read_b32 v65,a9
v_accvgpr_read_b32 v66,a10
v_accvgpr_read_b32 v67,a11
v_accvgpr_read_b32 v68,a24
v_pk_mul_f32 v[72:73],v[72:73],v[148:149] op_sel_hi:[1,0]
v_pk_mul_f32 v[74:75],v[74:75],v[148:149] op_sel_hi:[1,0]
v_pk_mul_f32 v[76:77],v[76:77],v[148:149] op_sel_hi:[1,0]
v_pk_mul_f32 v[78:79],v[78:79],v[148:149] op_sel_hi:[1,0]
v_accvgpr_read_b32 v69,a25
v_accvgpr_read_b32 v70,a26
v_mfma_f32_16x16x32_bf16 v[36:39],a[232:235],a[112:115],v[36:39]
s_lshl_b32 s62,s62,1
s_waitcnt lgkmcnt(0)
buffer_store_dwordx4 v[156:159],v10,s[16:19],s87 offen offset:3200 nt
s_add_u32 s62,s62,s49
s_and_b32 s62,s62,3
v_mfma_f32_16x16x32_bf16 v[36:39],a[236:239],a[116:119],v[36:39]
s_add_u32 s63,s69,8
v_accvgpr_read_b32 v71,a27
v_cvt_pk_bf16_f32 v86,v244,v245
v_mfma_f32_16x16x32_bf16 v[40:43],a[192:195],a[120:123],0
s_lshr_b32 s63,s39,s63
v_cvt_pk_bf16_f32 v87,v246,v247
v_cvt_pk_bf16_f32 v90,v248,v249
v_mfma_f32_16x16x32_bf16 v[40:43],a[196:199],a[124:127],v[40:43]
s_and_b32 s63,s63,1
ds_write2st64_b64 v20,v[84:85],v[86:87] offset0:36 offset1:16
s_xor_b32 s62,s62,s63
s_mul_i32 s63,s3,3
s_lshl_b32 s64,s3,2
s_mov_b32 s40,1
v_pk_mul_f32 v[64:65],v[64:65],v[148:149] op_sel_hi:[1,0]
v_pk_mul_f32 v[66:67],v[66:67],v[148:149] op_sel_hi:[1,0]
v_pk_mul_f32 v[68:69],v[68:69],v[148:149] op_sel_hi:[1,0]
v_pk_mul_f32 v[70:71],v[70:71],v[148:149] op_sel_hi:[1,0]
v_cvt_pk_bf16_f32 v84,v72,v73
v_cvt_pk_bf16_f32 v85,v74,v75
v_mfma_f32_16x16x32_bf16 v[40:43],a[200:203],a[128:131],v[40:43]
s_add_u32 s65,s63,17
v_cvt_pk_bf16_f32 v86,v76,v77
v_cvt_pk_bf16_f32 v87,v78,v79
v_mfma_f32_16x16x32_bf16 v[40:43],a[204:207],a[132:135],v[40:43]
s_cmp_eq_u32 s3,0
v_accvgpr_read_b32 v72,a12
v_accvgpr_read_b32 v73,a13
v_mfma_f32_16x16x32_bf16 v[40:43],a[208:211],a[136:139],v[40:43]
s_cselect_b32 s65,16,s65
v_accvgpr_read_b32 v74,a14
v_accvgpr_read_b32 v75,a15
v_accvgpr_read_b32 v76,a28
v_accvgpr_read_b32 v77,a29
v_accvgpr_read_b32 v78,a30
v_pk_mul_f32 v[72:73],v[72:73],v[148:149] op_sel_hi:[1,0]
v_pk_mul_f32 v[74:75],v[74:75],v[148:149] op_sel_hi:[1,0]
v_pk_mul_f32 v[76:77],v[76:77],v[148:149] op_sel_hi:[1,0]
v_accvgpr_read_b32 v79,a31
v_pk_mul_f32 v[78:79],v[78:79],v[148:149] op_sel_hi:[1,0]
v_cvt_pk_bf16_f32 v91,v250,v251
v_cvt_pk_bf16_f32 v94,v252,v253
v_mfma_f32_16x16x32_bf16 v[40:43],a[212:215],a[140:143],v[40:43]
s_waitcnt vmcnt(10)
ds_read_b128 a[168:171],v28 offset:0
v_cvt_pk_bf16_f32 v95,v254,v255
v_mfma_f32_16x16x32_bf16 v[44:47],a[216:219],a[120:123],0
s_cselect_b32 s41,1,0
ds_read_b128 a[172:175],v29 offset:0
s_cmp_eq_u32 s62,1
v_mfma_f32_16x16x32_bf16 v[44:47],a[220:223],a[124:127],v[44:47]
s_cselect_b32 s64,s65,s64
ds_read_b128 a[176:179],v28 offset:128
s_cselect_b32 s40,s41,s40
v_mfma_f32_16x16x32_bf16 v[44:47],a[224:227],a[128:131],v[44:47]
s_add_u32 s65,s63,29
ds_read_b128 a[180:183],v29 offset:128
s_cmp_eq_u32 s62,2
ds_read_b128 a[184:187],v28 offset:256
s_cselect_b32 s64,s65,s64
s_cselect_b32 s40,0,s40
v_pk_mul_f32 v[192:193],v[192:193],v[144:145] op_sel_hi:[1,0]
v_pk_mul_f32 v[194:195],v[194:195],v[144:145] op_sel_hi:[1,0]
s_add_u32 s65,s63,41
s_cmp_eq_u32 s62,3
ds_read_b128 a[188:191],v29 offset:256
s_cselect_b32 s64,s65,s64
ds_write2st64_b64 v21,v[88:89],v[90:91] offset0:36 offset1:16
s_cselect_b32 s40,0,s40
s_mul_i32 s64,s64,6144
s_add_u32 s41,s48,s64
s_cmp_ge_u32 s69,8
v_cvt_pk_bf16_f32 v88,v64,v65
v_cvt_pk_bf16_f32 v89,v66,v67
v_accvgpr_read_b32 v64,a32
v_accvgpr_read_b32 v65,a33
v_pk_mul_f32 v[64:65],v[64:65],v[148:149] op_sel_hi:[1,0]
v_accvgpr_read_b32 v66,a34
v_accvgpr_read_b32 v67,a35
v_pk_mul_f32 v[66:67],v[66:67],v[148:149] op_sel_hi:[1,0]
v_cvt_pk_bf16_f32 v90,v68,v69
v_cvt_pk_bf16_f32 v91,v70,v71
v_mfma_f32_16x16x32_bf16 v[44:47],a[228:231],a[132:135],v[44:47]
s_cselect_b32 s41,166723584,s41
ds_write2st64_b64 v22,v[92:93],v[94:95] offset0:36 offset1:16
s_mov_b32 s28,s41
s_mov_b32 s29,s24
s_add_u32 s25,s22,12288
s_add_u32 s26,s22,24576
v_mfma_f32_16x16x32_bf16 v[44:47],a[232:235],a[136:139],v[44:47]
v_accvgpr_read_b32 v68,a36
v_accvgpr_read_b32 v69,a37
v_mfma_f32_16x16x32_bf16 v[44:47],a[236:239],a[140:143],v[44:47]
v_accvgpr_read_b32 v70,a38
v_accvgpr_read_b32 v71,a39
v_mfma_f32_16x16x32_bf16 v[48:51],a[192:195],a[144:147],0
ds_read_b128 v[152:155],v15 offset:18432
v_cvt_pk_bf16_f32 v92,v72,v73
v_cvt_pk_bf16_f32 v93,v74,v75
v_accvgpr_read_b32 v72,a40
v_accvgpr_read_b32 v73,a41
v_pk_mul_f32 v[68:69],v[68:69],v[148:149] op_sel_hi:[1,0]
v_pk_mul_f32 v[70:71],v[70:71],v[148:149] op_sel_hi:[1,0]
v_pk_mul_f32 v[196:197],v[196:197],v[144:145] op_sel_hi:[1,0]
v_pk_mul_f32 v[198:199],v[198:199],v[144:145] op_sel_hi:[1,0]
v_accvgpr_read_b32 v74,a42
v_accvgpr_read_b32 v75,a43
v_mfma_f32_16x16x32_bf16 v[48:51],a[196:199],a[148:151],v[48:51]
ds_read_b128 v[156:159],v15 offset:21504
v_cvt_pk_bf16_f32 v94,v76,v77
v_mfma_f32_16x16x32_bf16 v[48:51],a[200:203],a[152:155],v[48:51]
ds_write2st64_b64 v12,v[80:81],v[82:83] offset0:24 offset1:26
v_mfma_f32_16x16x32_bf16 v[48:51],a[204:207],a[156:159],v[48:51]
v_cvt_pk_bf16_f32 v95,v78,v79
v_accvgpr_read_b32 v76,a44
v_mfma_f32_16x16x32_bf16 v[48:51],a[208:211],a[160:163],v[48:51]
v_accvgpr_read_b32 v77,a45
v_accvgpr_read_b32 v78,a46
v_accvgpr_read_b32 v79,a47
v_cvt_pk_bf16_f32 v80,v64,v65
v_cvt_pk_bf16_f32 v81,v66,v67
v_pk_mul_f32 v[72:73],v[72:73],v[148:149] op_sel_hi:[1,0]
v_pk_mul_f32 v[74:75],v[74:75],v[148:149] op_sel_hi:[1,0]
v_pk_mul_f32 v[200:201],v[200:201],v[144:145] op_sel_hi:[1,0]
v_pk_mul_f32 v[202:203],v[202:203],v[144:145] op_sel_hi:[1,0]
v_cvt_pk_bf16_f32 v82,v192,v193
v_cvt_pk_bf16_f32 v83,v194,v195
v_mfma_f32_16x16x32_bf16 v[48:51],a[212:215],a[164:167],v[48:51]
ds_write2st64_b64 v20,v[84:85],v[86:87] offset0:24 offset1:26
v_mfma_f32_16x16x32_bf16 v[52:55],a[216:219],a[144:147],0
v_cvt_pk_bf16_f32 v84,v68,v69
v_cvt_pk_bf16_f32 v85,v70,v71
v_mfma_f32_16x16x32_bf16 v[52:55],a[220:223],a[148:151],v[52:55]
v_cvt_pk_bf16_f32 v86,v196,v197
v_cvt_pk_bf16_f32 v87,v198,v199
v_mfma_f32_16x16x32_bf16 v[52:55],a[224:227],a[152:155],v[52:55]
ds_write2st64_b64 v21,v[88:89],v[90:91] offset0:24 offset1:26
v_pk_mul_f32 v[76:77],v[76:77],v[148:149] op_sel_hi:[1,0]
v_pk_mul_f32 v[78:79],v[78:79],v[148:149] op_sel_hi:[1,0]
v_pk_mul_f32 v[204:205],v[204:205],v[144:145] op_sel_hi:[1,0]
v_pk_mul_f32 v[206:207],v[206:207],v[144:145] op_sel_hi:[1,0]
v_cvt_pk_bf16_f32 v88,v72,v73
v_cvt_pk_bf16_f32 v89,v74,v75
v_mfma_f32_16x16x32_bf16 v[52:55],a[228:231],a[156:159],v[52:55]
ds_write2st64_b64 v22,v[92:93],v[94:95] offset0:24 offset1:26
v_mfma_f32_16x16x32_bf16 v[52:55],a[232:235],a[160:163],v[52:55]
v_cvt_pk_bf16_f32 v90,v200,v201
v_cvt_pk_bf16_f32 v91,v202,v203
v_mfma_f32_16x16x32_bf16 v[52:55],a[236:239],a[164:167],v[52:55]
s_waitcnt lgkmcnt(2)
v_cvt_pk_bf16_f32 v92,v76,v77
v_cvt_pk_bf16_f32 v93,v78,v79
v_mfma_f32_16x16x32_bf16 v[56:59],a[192:195],a[168:171],0
ds_write2st64_b64 v12,v[80:81],v[82:83] offset0:28 offset1:4
v_pk_mul_f32 v[160:161],v[160:161],v[144:145] op_sel_hi:[1,0]
v_pk_mul_f32 v[162:163],v[162:163],v[144:145] op_sel_hi:[1,0]
v_pk_mul_f32 v[176:177],v[176:177],v[144:145] op_sel_hi:[1,0]
v_pk_mul_f32 v[178:179],v[178:179],v[144:145] op_sel_hi:[1,0]
v_cvt_pk_bf16_f32 v94,v204,v205
v_cvt_pk_bf16_f32 v95,v206,v207
v_mfma_f32_16x16x32_bf16 v[56:59],a[196:199],a[172:175],v[56:59]
ds_write2st64_b64 v20,v[84:85],v[86:87] offset0:28 offset1:4
v_mfma_f32_16x16x32_bf16 v[56:59],a[200:203],a[176:179],v[56:59]
v_cvt_pk_bf16_f32 v80,v160,v161
v_cvt_pk_bf16_f32 v81,v162,v163
v_mfma_f32_16x16x32_bf16 v[56:59],a[204:207],a[180:183],v[56:59]
v_cvt_pk_bf16_f32 v82,v176,v177
v_cvt_pk_bf16_f32 v83,v178,v179
ds_write2st64_b64 v21,v[88:89],v[90:91] offset0:28 offset1:4
v_pk_mul_f32 v[164:165],v[164:165],v[144:145] op_sel_hi:[1,0]
v_pk_mul_f32 v[166:167],v[166:167],v[144:145] op_sel_hi:[1,0]
v_pk_mul_f32 v[180:181],v[180:181],v[144:145] op_sel_hi:[1,0]
v_pk_mul_f32 v[182:183],v[182:183],v[144:145] op_sel_hi:[1,0]
v_cvt_pk_bf16_f32 v84,v164,v165
v_cvt_pk_bf16_f32 v85,v166,v167
v_mfma_f32_16x16x32_bf16 v[56:59],a[208:211],a[184:187],v[56:59]
ds_write2st64_b64 v22,v[92:93],v[94:95] offset0:28 offset1:4
v_mfma_f32_16x16x32_bf16 v[56:59],a[212:215],a[188:191],v[56:59]
v_cvt_pk_bf16_f32 v86,v180,v181
v_cvt_pk_bf16_f32 v87,v182,v183
v_mfma_f32_16x16x32_bf16 v[60:63],a[216:219],a[168:171],0
v_mfma_f32_16x16x32_bf16 v[60:63],a[220:223],a[172:175],v[60:63]
ds_write2st64_b64 v12,v[80:81],v[82:83] offset0:0 offset1:2
v_pk_mul_f32 v[168:169],v[168:169],v[144:145] op_sel_hi:[1,0]
v_pk_mul_f32 v[170:171],v[170:171],v[144:145] op_sel_hi:[1,0]
v_pk_mul_f32 v[184:185],v[184:185],v[144:145] op_sel_hi:[1,0]
v_pk_mul_f32 v[186:187],v[186:187],v[144:145] op_sel_hi:[1,0]
v_cvt_pk_bf16_f32 v88,v168,v169
v_cvt_pk_bf16_f32 v89,v170,v171
v_mfma_f32_16x16x32_bf16 v[60:63],a[224:227],a[176:179],v[60:63]
ds_write2st64_b64 v20,v[84:85],v[86:87] offset0:0 offset1:2
v_mfma_f32_16x16x32_bf16 v[60:63],a[228:231],a[180:183],v[60:63]
v_cvt_pk_bf16_f32 v90,v184,v185
v_cvt_pk_bf16_f32 v91,v186,v187
v_mfma_f32_16x16x32_bf16 v[60:63],a[232:235],a[184:187],v[60:63]
v_mfma_f32_16x16x32_bf16 v[60:63],a[236:239],a[188:191],v[60:63]
ds_write2st64_b64 v21,v[88:89],v[90:91] offset0:0 offset1:2
v_pk_mul_f32 v[172:173],v[172:173],v[144:145] op_sel_hi:[1,0]
v_pk_mul_f32 v[174:175],v[174:175],v[144:145] op_sel_hi:[1,0]
v_pk_mul_f32 v[188:189],v[188:189],v[144:145] op_sel_hi:[1,0]
v_pk_mul_f32 v[190:191],v[190:191],v[144:145] op_sel_hi:[1,0]
v_cvt_pk_bf16_f32 v92,v172,v173
v_cvt_pk_bf16_f32 v93,v174,v175
v_cvt_pk_bf16_f32 v94,v188,v189
v_cvt_pk_bf16_f32 v95,v190,v191
ds_write2st64_b64 v22,v[92:93],v[94:95] offset0:0 offset1:2
buffer_store_dwordx4 v[152:155],v10,s[16:19],s87 offen offset:256 nt
buffer_store_dwordx4 v[156:159],v10,s[16:19],s87 offen offset:3328 nt
ds_read_b128 a[192:195],v1 offset:12288
v_max3_f32 v144,v32,v33,v34
v_max3_f32 v146,v40,v41,v42
v_max3_f32 v144,v144,v35,v36
v_max3_f32 v146,v146,v43,v44
v_max3_f32 v144,v144,v37,v38
v_max3_f32 v146,v146,v45,v46
v_max_f32 v144,v144,v39
v_max_f32 v146,v146,v47
v_mov_b32 v145,v144
v_mov_b32 v147,v146
s_add_u32 m0,s23,12288
v_permlane32_swap_b32 v145,v144
v_permlane32_swap_b32 v147,v146
v_max_f32 v144,v144,v145
v_max_f32 v146,v146,v147
v_mov_b32 v145,v144
v_mov_b32 v147,v146
buffer_load_dwordx4 v7,s[8:11],s21 offen offset:0 lds
ds_read_b128 a[196:199],v2 offset:12288
v_permlane16_swap_b32 v145,v144
v_permlane16_swap_b32 v147,v146
v_max_f32 v144,v144,v145
v_max_f32 v146,v146,v147
v_mul_f32_e64 v16,-s36,v144
v_mul_f32_e64 v17,-s36,v146
v_max3_f32 v144,v48,v49,v50
s_waitcnt lgkmcnt(1)
v_mfma_f32_16x16x32_bf16 v[64:67],a[192:195],a[96:99],0
ds_read_b128 a[200:203],v1 offset:12416
v_max3_f32 v146,v56,v57,v58
v_max3_f32 v144,v144,v51,v52
v_max3_f32 v146,v146,v59,v60
v_max3_f32 v144,v144,v53,v54
v_max3_f32 v146,v146,v61,v62
v_max_f32 v144,v144,v55
v_max_f32 v146,v146,v63
v_mov_b32 v145,v144
v_mov_b32 v147,v146
v_fma_f32 v32,v32,s36,v16
v_permlane32_swap_b32 v145,v144
v_permlane32_swap_b32 v147,v146
v_max_f32 v144,v144,v145
v_max_f32 v146,v146,v147
v_mov_b32 v145,v144
v_mov_b32 v147,v146
v_fma_f32 v33,v33,s36,v16
v_permlane16_swap_b32 v145,v144
v_permlane16_swap_b32 v147,v146
s_waitcnt lgkmcnt(1)
v_mfma_f32_16x16x32_bf16 v[64:67],a[196:199],a[100:103],v[64:67]
buffer_load_dwordx4 v8,s[8:11],s21 offen offset:1024 lds
ds_read_b128 a[204:207],v2 offset:12416
v_max_f32 v144,v144,v145
v_max_f32 v146,v146,v147
v_mul_f32_e64 v18,-s36,v144
v_mul_f32_e64 v19,-s36,v146
v_fma_f32 v34,v34,s36,v16
s_waitcnt lgkmcnt(1)
v_mfma_f32_16x16x32_bf16 v[64:67],a[200:203],a[104:107],v[64:67]
ds_read_b128 a[208:211],v1 offset:12544
v_fma_f32 v35,v35,s36,v16
v_fma_f32 v36,v36,s36,v16
v_fma_f32 v37,v37,s36,v16
v_fma_f32 v38,v38,s36,v16
v_fma_f32 v39,v39,s36,v16
v_fma_f32 v40,v40,s36,v17
v_fma_f32 v41,v41,s36,v17
v_fma_f32 v42,v42,s36,v17
v_fma_f32 v43,v43,s36,v17
v_fma_f32 v44,v44,s36,v17
v_fma_f32 v45,v45,s36,v17
v_fma_f32 v46,v46,s36,v17
v_fma_f32 v47,v47,s36,v17
v_fma_f32 v48,v48,s36,v18
v_fma_f32 v49,v49,s36,v18
v_fma_f32 v50,v50,s36,v18
v_fma_f32 v51,v51,s36,v18
v_fma_f32 v52,v52,s36,v18
v_fma_f32 v53,v53,s36,v18
v_fma_f32 v54,v54,s36,v18
v_fma_f32 v55,v55,s36,v18
v_fma_f32 v56,v56,s36,v19
v_fma_f32 v57,v57,s36,v19
v_fma_f32 v58,v58,s36,v19
v_fma_f32 v59,v59,s36,v19
v_fma_f32 v60,v60,s36,v19
s_waitcnt lgkmcnt(1)
v_mfma_f32_16x16x32_bf16 v[64:67],a[204:207],a[108:111],v[64:67]
ds_read_b128 a[212:215],v2 offset:12544
v_fma_f32 v61,v61,s36,v19
v_fma_f32 v62,v62,s36,v19
v_fma_f32 v63,v63,s36,v19
v_exp_f32 v32,v32
s_waitcnt lgkmcnt(1)
v_mfma_f32_16x16x32_bf16 v[64:67],a[208:211],a[112:115],v[64:67]
buffer_load_dwordx4 v9,s[8:11],s21 offen offset:2048 lds
s_add_u32 s21,s21,12288
s_add_u32 m0,s22,0
ds_read_b128 a[216:219],v1 offset:18432
v_exp_f32 v33,v33
v_exp_f32 v34,v34
v_exp_f32 v35,v35
v_exp_f32 v36,v36
v_exp_f32 v37,v37
v_exp_f32 v38,v38
v_exp_f32 v39,v39
v_exp_f32 v40,v40
v_exp_f32 v41,v41
v_exp_f32 v42,v42
v_exp_f32 v43,v43
v_exp_f32 v44,v44
s_waitcnt lgkmcnt(1)
v_mfma_f32_16x16x32_bf16 v[64:67],a[212:215],a[116:119],v[64:67]
ds_read_b128 a[220:223],v2 offset:18432
v_exp_f32 v45,v45
v_mfma_f32_16x16x32_bf16 v[72:75],a[192:195],a[120:123],0
ds_read_b128 a[224:227],v1 offset:18560
v_exp_f32 v46,v46
v_mfma_f32_16x16x32_bf16 v[72:75],a[196:199],a[124:127],v[72:75]
ds_read_b128 a[228:231],v2 offset:18560
v_exp_f32 v47,v47
v_mfma_f32_16x16x32_bf16 v[72:75],a[200:203],a[128:131],v[72:75]
buffer_load_dwordx4 v7,s[4:7],s20 offen offset:0 lds
v_mfma_f32_16x16x32_bf16 v[72:75],a[204:207],a[132:135],v[72:75]
ds_read_b128 a[232:235],v1 offset:18688
v_exp_f32 v48,v48
v_mfma_f32_16x16x32_bf16 v[72:75],a[208:211],a[136:139],v[72:75]
ds_read_b128 a[236:239],v2 offset:18688
v_exp_f32 v49,v49
v_mfma_f32_16x16x32_bf16 v[72:75],a[212:215],a[140:143],v[72:75]
v_exp_f32 v50,v50
v_mfma_f32_16x16x32_bf16 v[80:83],a[192:195],a[144:147],0
v_exp_f32 v51,v51
v_mfma_f32_16x16x32_bf16 v[80:83],a[196:199],a[148:151],v[80:83]
v_exp_f32 v52,v52
v_mfma_f32_16x16x32_bf16 v[80:83],a[200:203],a[152:155],v[80:83]
v_exp_f32 v53,v53
v_mfma_f32_16x16x32_bf16 v[80:83],a[204:207],a[156:159],v[80:83]
v_exp_f32 v54,v54
v_mfma_f32_16x16x32_bf16 v[80:83],a[208:211],a[160:163],v[80:83]
v_exp_f32 v55,v55
v_mfma_f32_16x16x32_bf16 v[80:83],a[212:215],a[164:167],v[80:83]
v_exp_f32 v56,v56
v_mfma_f32_16x16x32_bf16 v[88:91],a[192:195],a[168:171],0
v_exp_f32 v57,v57
v_mfma_f32_16x16x32_bf16 v[88:91],a[196:199],a[172:175],v[88:91]
v_exp_f32 v58,v58
v_mfma_f32_16x16x32_bf16 v[88:91],a[200:203],a[176:179],v[88:91]
buffer_load_dwordx4 v8,s[4:7],s20 offen offset:1024 lds
v_mfma_f32_16x16x32_bf16 v[88:91],a[204:207],a[180:183],v[88:91]
v_exp_f32 v59,v59
v_mfma_f32_16x16x32_bf16 v[88:91],a[208:211],a[184:187],v[88:91]
v_exp_f32 v60,v60
v_mfma_f32_16x16x32_bf16 v[88:91],a[212:215],a[188:191],v[88:91]
s_waitcnt lgkmcnt(0)
v_exp_f32 v61,v61
v_mfma_f32_16x16x32_bf16 v[68:71],a[216:219],a[96:99],0
v_exp_f32 v62,v62
v_mfma_f32_16x16x32_bf16 v[68:71],a[220:223],a[100:103],v[68:71]
v_exp_f32 v63,v63
v_mfma_f32_16x16x32_bf16 v[68:71],a[224:227],a[104:107],v[68:71]
v_cvt_pk_bf16_f32 v96,v32,v33
v_cvt_pk_bf16_f32 v97,v34,v35
v_mfma_f32_16x16x32_bf16 v[68:71],a[228:231],a[108:111],v[68:71]
v_cvt_pk_bf16_f32 v98,v36,v37
v_cvt_pk_bf16_f32 v99,v38,v39
v_mfma_f32_16x16x32_bf16 v[68:71],a[232:235],a[112:115],v[68:71]
v_cvt_pk_bf16_f32 v100,v40,v41
v_cvt_pk_bf16_f32 v101,v42,v43
v_mfma_f32_16x16x32_bf16 v[128:131],v[24:27],v[96:99],0
v_cvt_pk_bf16_f32 v102,v44,v45
v_cvt_pk_bf16_f32 v103,v46,v47
v_mfma_f32_16x16x32_bf16 v[68:71],a[236:239],a[116:119],v[68:71]
v_cvt_pk_bf16_f32 v104,v48,v49
v_cvt_pk_bf16_f32 v105,v50,v51
v_mfma_f32_16x16x32_bf16 v[132:135],v[24:27],v[100:103],0
v_cvt_pk_bf16_f32 v106,v52,v53
v_cvt_pk_bf16_f32 v107,v54,v55
v_mfma_f32_16x16x32_bf16 v[76:79],a[216:219],a[120:123],0
buffer_load_dwordx4 v9,s[4:7],s20 offen offset:2048 lds
s_add_u32 s20,s20,12288
v_mfma_f32_16x16x32_bf16 v[136:139],v[24:27],v[104:107],0
v_cvt_pk_bf16_f32 v108,v56,v57
v_cvt_pk_bf16_f32 v109,v58,v59
v_mfma_f32_16x16x32_bf16 v[76:79],a[220:223],a[124:127],v[76:79]
v_cvt_pk_bf16_f32 v110,v60,v61
v_cvt_pk_bf16_f32 v111,v62,v63
v_mfma_f32_16x16x32_bf16 v[76:79],a[224:227],a[128:131],v[76:79]
v_fma_f32 v64,v64,s36,v16
v_fma_f32 v65,v65,s36,v16
v_mfma_f32_16x16x32_bf16 v[140:143],v[24:27],v[108:111],0
v_fma_f32 v66,v66,s36,v16
v_fma_f32 v67,v67,s36,v16
v_mfma_f32_16x16x32_bf16 v[76:79],a[228:231],a[132:135],v[76:79]
v_fma_f32 v72,v72,s36,v17
v_fma_f32 v73,v73,s36,v17
v_mfma_f32_16x16x32_bf16 v[76:79],a[232:235],a[136:139],v[76:79]
v_fma_f32 v74,v74,s36,v17
v_fma_f32 v75,v75,s36,v17
v_mfma_f32_16x16x32_bf16 v[76:79],a[236:239],a[140:143],v[76:79]
v_exp_f32 v64,v64
v_mfma_f32_16x16x32_bf16 v[84:87],a[216:219],a[144:147],0
v_exp_f32 v65,v65
v_mfma_f32_16x16x32_bf16 v[84:87],a[220:223],a[148:151],v[84:87]
v_exp_f32 v66,v66
v_mfma_f32_16x16x32_bf16 v[84:87],a[224:227],a[152:155],v[84:87]
v_exp_f32 v67,v67
v_mfma_f32_16x16x32_bf16 v[84:87],a[228:231],a[156:159],v[84:87]
v_exp_f32 v72,v72
v_mfma_f32_16x16x32_bf16 v[84:87],a[232:235],a[160:163],v[84:87]
v_exp_f32 v73,v73
v_mfma_f32_16x16x32_bf16 v[84:87],a[236:239],a[164:167],v[84:87]
v_exp_f32 v74,v74
v_mfma_f32_16x16x32_bf16 v[92:95],a[216:219],a[168:171],0
v_exp_f32 v75,v75
v_mfma_f32_16x16x32_bf16 v[92:95],a[220:223],a[172:175],v[92:95]
v_cvt_pk_bf16_f32 v112,v64,v65
v_cvt_pk_bf16_f32 v113,v66,v67
v_mfma_f32_16x16x32_bf16 v[92:95],a[224:227],a[176:179],v[92:95]
v_cvt_pk_bf16_f32 v116,v72,v73
v_cvt_pk_bf16_f32 v117,v74,v75
v_mfma_f32_16x16x32_bf16 v[92:95],a[228:231],a[180:183],v[92:95]
v_mfma_f32_16x16x32_bf16 v[92:95],a[232:235],a[184:187],v[92:95]
v_mfma_f32_16x16x32_bf16 v[92:95],a[236:239],a[188:191],v[92:95]
s_waitcnt vmcnt(10)
s_barrier
ds_read_b64_tr_b16 a[240:241],v3 offset:0
ds_read_b64_tr_b16 a[242:243],v3 offset:6144
ds_read_b64_tr_b16 a[244:245],v4 offset:0
ds_read_b64_tr_b16 a[246:247],v4 offset:6144
ds_read_b64_tr_b16 a[248:249],v5 offset:0
ds_read_b64_tr_b16 a[250:251],v5 offset:6144
ds_read_b64_tr_b16 a[252:253],v6 offset:0
ds_read_b64_tr_b16 a[254:255],v6 offset:6144
s_waitcnt lgkmcnt(6)
v_mfma_f32_16x16x32_bf16 v[160:163],a[240:243],v[96:99],0
s_add_u32 m0,s23,24576
ds_read_b128 a[192:195],v1 offset:24576
v_fma_f32 v68,v68,s36,v16
v_mfma_f32_16x16x32_bf16 v[208:211],a[240:243],v[100:103],0
buffer_load_dwordx4 v7,s[8:11],s21 offen offset:0 lds
v_mfma_f32_16x16x32_bf16 a[0:3],a[240:243],v[104:107],0
ds_read_b128 a[196:199],v2 offset:24576
v_fma_f32 v69,v69,s36,v16
v_mfma_f32_16x16x32_bf16 a[48:51],a[240:243],v[108:111],0
s_waitcnt lgkmcnt(6)
ds_read_b64_tr_b16 a[240:241],v3 offset:128
ds_read_b64_tr_b16 a[242:243],v3 offset:6272
v_mfma_f32_16x16x32_bf16 v[164:167],a[244:247],v[96:99],0
ds_read_b128 a[200:203],v1 offset:24704
v_fma_f32 v70,v70,s36,v16
v_mfma_f32_16x16x32_bf16 v[212:215],a[244:247],v[100:103],0
ds_read_b128 a[204:207],v2 offset:24704
v_fma_f32 v71,v71,s36,v16
v_mfma_f32_16x16x32_bf16 a[4:7],a[244:247],v[104:107],0
ds_read_b128 a[208:211],v1 offset:24832
v_fma_f32 v76,v76,s36,v17
v_mfma_f32_16x16x32_bf16 a[52:55],a[244:247],v[108:111],0
s_waitcnt lgkmcnt(7)
ds_read_b64_tr_b16 a[244:245],v4 offset:128
ds_read_b64_tr_b16 a[246:247],v4 offset:6272
v_mfma_f32_16x16x32_bf16 v[168:171],a[248:251],v[96:99],0
ds_read_b128 a[212:215],v2 offset:24832
v_fma_f32 v77,v77,s36,v17
v_mfma_f32_16x16x32_bf16 v[216:219],a[248:251],v[100:103],0
buffer_load_dwordx4 v8,s[8:11],s21 offen offset:1024 lds
v_mfma_f32_16x16x32_bf16 a[8:11],a[248:251],v[104:107],0
ds_read_b128 a[216:219],v1 offset:30720
v_fma_f32 v78,v78,s36,v17
v_mfma_f32_16x16x32_bf16 a[56:59],a[248:251],v[108:111],0
ds_read_b64_tr_b16 a[248:249],v5 offset:128
ds_read_b64_tr_b16 a[250:251],v5 offset:6272
v_mfma_f32_16x16x32_bf16 v[172:175],a[252:255],v[96:99],0
ds_read_b128 a[220:223],v2 offset:30720
v_fma_f32 v79,v79,s36,v17
v_mfma_f32_16x16x32_bf16 v[220:223],a[252:255],v[100:103],0
ds_read_b128 a[224:227],v1 offset:30848
v_fma_f32 v80,v80,s36,v18
v_mfma_f32_16x16x32_bf16 a[12:15],a[252:255],v[104:107],0
ds_read_b128 a[228:231],v2 offset:30848
v_fma_f32 v81,v81,s36,v18
v_mfma_f32_16x16x32_bf16 a[60:63],a[252:255],v[108:111],0
s_waitcnt lgkmcnt(7)
ds_read_b64_tr_b16 a[252:253],v6 offset:128
ds_read_b64_tr_b16 a[254:255],v6 offset:6272
v_mfma_f32_16x16x32_bf16 v[176:179],a[240:243],v[96:99],0
ds_read_b128 a[232:235],v1 offset:30976
v_fma_f32 v82,v82,s36,v18
v_mfma_f32_16x16x32_bf16 v[224:227],a[240:243],v[100:103],0
buffer_load_dwordx4 v9,s[8:11],s21 offen offset:2048 lds
v_mfma_f32_16x16x32_bf16 a[16:19],a[240:243],v[104:107],0
s_add_u32 s21,s21,12288
ds_read_b128 a[236:239],v2 offset:30976
v_fma_f32 v83,v83,s36,v18
v_mfma_f32_16x16x32_bf16 a[64:67],a[240:243],v[108:111],0
s_add_u32 m0,s22,12288
ds_read_b64_tr_b16 a[240:241],v3 offset:256
ds_read_b64_tr_b16 a[242:243],v3 offset:6400
v_mfma_f32_16x16x32_bf16 v[180:183],a[244:247],v[96:99],0
v_fma_f32 v84,v84,s36,v18
v_fma_f32 v85,v85,s36,v18
v_mfma_f32_16x16x32_bf16 v[228:231],a[244:247],v[100:103],0
v_fma_f32 v86,v86,s36,v18
v_fma_f32 v87,v87,s36,v18
v_mfma_f32_16x16x32_bf16 a[20:23],a[244:247],v[104:107],0
v_fma_f32 v88,v88,s36,v19
v_fma_f32 v89,v89,s36,v19
v_mfma_f32_16x16x32_bf16 a[68:71],a[244:247],v[108:111],0
s_waitcnt lgkmcnt(4)
ds_read_b64_tr_b16 a[244:245],v4 offset:256
ds_read_b64_tr_b16 a[246:247],v4 offset:6400
v_mfma_f32_16x16x32_bf16 v[184:187],a[248:251],v[96:99],0
buffer_load_dwordx4 v7,s[4:7],s20 offen offset:0 lds
v_mfma_f32_16x16x32_bf16 v[232:235],a[248:251],v[100:103],0
v_fma_f32 v90,v90,s36,v19
v_fma_f32 v91,v91,s36,v19
v_mfma_f32_16x16x32_bf16 a[24:27],a[248:251],v[104:107],0
v_fma_f32 v92,v92,s36,v19
v_fma_f32 v93,v93,s36,v19
v_mfma_f32_16x16x32_bf16 a[72:75],a[248:251],v[108:111],0
ds_read_b64_tr_b16 a[248:249],v5 offset:256
ds_read_b64_tr_b16 a[250:251],v5 offset:6400
v_mfma_f32_16x16x32_bf16 v[188:191],a[252:255],v[96:99],0
v_fma_f32 v94,v94,s36,v19
v_fma_f32 v95,v95,s36,v19
v_mfma_f32_16x16x32_bf16 v[236:239],a[252:255],v[100:103],0
v_exp_f32 v68,v68
v_mfma_f32_16x16x32_bf16 a[28:31],a[252:255],v[104:107],0
v_exp_f32 v69,v69
v_mfma_f32_16x16x32_bf16 a[76:79],a[252:255],v[108:111],0
s_waitcnt lgkmcnt(2)
ds_read_b64_tr_b16 a[252:253],v6 offset:256
ds_read_b64_tr_b16 a[254:255],v6 offset:6400
v_mfma_f32_16x16x32_bf16 v[192:195],a[240:243],v[96:99],0
buffer_load_dwordx4 v8,s[4:7],s20 offen offset:1024 lds
v_mfma_f32_16x16x32_bf16 v[240:243],a[240:243],v[100:103],0
v_exp_f32 v70,v70
v_mfma_f32_16x16x32_bf16 a[32:35],a[240:243],v[104:107],0
v_exp_f32 v71,v71
v_mfma_f32_16x16x32_bf16 a[80:83],a[240:243],v[108:111],0
v_exp_f32 v76,v76
v_mfma_f32_16x16x32_bf16 v[196:199],a[244:247],v[96:99],0
v_exp_f32 v77,v77
v_mfma_f32_16x16x32_bf16 v[244:247],a[244:247],v[100:103],0
v_exp_f32 v78,v78
v_mfma_f32_16x16x32_bf16 a[36:39],a[244:247],v[104:107],0
v_exp_f32 v79,v79
v_mfma_f32_16x16x32_bf16 a[84:87],a[244:247],v[108:111],0
s_waitcnt lgkmcnt(0)
v_exp_f32 v80,v80
v_mfma_f32_16x16x32_bf16 v[200:203],a[248:251],v[96:99],0
buffer_load_dwordx4 v9,s[4:7],s20 offen offset:2048 lds
v_mfma_f32_16x16x32_bf16 v[248:251],a[248:251],v[100:103],0
s_add_u32 s20,s20,12288
v_exp_f32 v81,v81
v_mfma_f32_16x16x32_bf16 a[40:43],a[248:251],v[104:107],0
v_exp_f32 v82,v82
v_mfma_f32_16x16x32_bf16 a[88:91],a[248:251],v[108:111],0
v_exp_f32 v83,v83
v_mfma_f32_16x16x32_bf16 v[204:207],a[252:255],v[96:99],0
v_exp_f32 v84,v84
v_mfma_f32_16x16x32_bf16 v[252:255],a[252:255],v[100:103],0
v_exp_f32 v85,v85
v_mfma_f32_16x16x32_bf16 a[44:47],a[252:255],v[104:107],0
v_exp_f32 v86,v86
v_mfma_f32_16x16x32_bf16 a[92:95],a[252:255],v[108:111],0
v_exp_f32 v87,v87
v_mfma_f32_16x16x32_bf16 v[32:35],a[192:195],a[96:99],0
v_exp_f32 v88,v88
v_mfma_f32_16x16x32_bf16 v[32:35],a[196:199],a[100:103],v[32:35]
v_exp_f32 v89,v89
v_mfma_f32_16x16x32_bf16 v[32:35],a[200:203],a[104:107],v[32:35]
v_exp_f32 v90,v90
v_mfma_f32_16x16x32_bf16 v[32:35],a[204:207],a[108:111],v[32:35]
v_exp_f32 v91,v91
v_mfma_f32_16x16x32_bf16 v[32:35],a[208:211],a[112:115],v[32:35]
v_exp_f32 v92,v92
v_mfma_f32_16x16x32_bf16 v[32:35],a[212:215],a[116:119],v[32:35]
v_exp_f32 v93,v93
v_mfma_f32_16x16x32_bf16 v[40:43],a[192:195],a[120:123],0
v_exp_f32 v94,v94
v_mfma_f32_16x16x32_bf16 v[40:43],a[196:199],a[124:127],v[40:43]
v_exp_f32 v95,v95
v_mfma_f32_16x16x32_bf16 v[40:43],a[200:203],a[128:131],v[40:43]
v_cvt_pk_bf16_f32 v114,v68,v69
v_cvt_pk_bf16_f32 v115,v70,v71
v_mfma_f32_16x16x32_bf16 v[40:43],a[204:207],a[132:135],v[40:43]
v_cvt_pk_bf16_f32 v118,v76,v77
v_cvt_pk_bf16_f32 v119,v78,v79
v_mfma_f32_16x16x32_bf16 v[128:131],v[24:27],v[112:115],v[128:131]
v_cvt_pk_bf16_f32 v120,v80,v81
v_cvt_pk_bf16_f32 v121,v82,v83
v_mfma_f32_16x16x32_bf16 v[132:135],v[24:27],v[116:119],v[132:135]
v_cvt_pk_bf16_f32 v122,v84,v85
v_cvt_pk_bf16_f32 v123,v86,v87
v_mfma_f32_16x16x32_bf16 v[40:43],a[208:211],a[136:139],v[40:43]
v_cvt_pk_bf16_f32 v124,v88,v89
v_cvt_pk_bf16_f32 v125,v90,v91
v_mfma_f32_16x16x32_bf16 v[136:139],v[24:27],v[120:123],v[136:139]
v_cvt_pk_bf16_f32 v126,v92,v93
v_cvt_pk_bf16_f32 v127,v94,v95
v_mfma_f32_16x16x32_bf16 v[40:43],a[212:215],a[140:143],v[40:43]
v_fma_f32 v32,v32,s36,v16
v_fma_f32 v33,v33,s36,v16
v_mfma_f32_16x16x32_bf16 v[140:143],v[24:27],v[124:127],v[140:143]
v_fma_f32 v34,v34,s36,v16
v_fma_f32 v35,v35,s36,v16
v_mfma_f32_16x16x32_bf16 v[48:51],a[192:195],a[144:147],0
v_exp_f32 v32,v32
v_mfma_f32_16x16x32_bf16 v[48:51],a[196:199],a[148:151],v[48:51]
v_fma_f32 v40,v40,s36,v17
v_fma_f32 v41,v41,s36,v17
v_mfma_f32_16x16x32_bf16 v[48:51],a[200:203],a[152:155],v[48:51]
v_fma_f32 v42,v42,s36,v17
v_fma_f32 v43,v43,s36,v17
v_mfma_f32_16x16x32_bf16 v[48:51],a[204:207],a[156:159],v[48:51]
v_exp_f32 v33,v33
v_mfma_f32_16x16x32_bf16 v[48:51],a[208:211],a[160:163],v[48:51]
v_exp_f32 v34,v34
v_mfma_f32_16x16x32_bf16 v[48:51],a[212:215],a[164:167],v[48:51]
v_exp_f32 v35,v35
v_mfma_f32_16x16x32_bf16 v[56:59],a[192:195],a[168:171],0
v_exp_f32 v40,v40
v_mfma_f32_16x16x32_bf16 v[56:59],a[196:199],a[172:175],v[56:59]
v_exp_f32 v41,v41
v_mfma_f32_16x16x32_bf16 v[56:59],a[200:203],a[176:179],v[56:59]
v_exp_f32 v42,v42
v_mfma_f32_16x16x32_bf16 v[56:59],a[204:207],a[180:183],v[56:59]
v_exp_f32 v43,v43
v_mfma_f32_16x16x32_bf16 v[56:59],a[208:211],a[184:187],v[56:59]
v_cvt_pk_bf16_f32 v96,v32,v33
v_cvt_pk_bf16_f32 v97,v34,v35
v_mfma_f32_16x16x32_bf16 v[56:59],a[212:215],a[188:191],v[56:59]
v_cvt_pk_bf16_f32 v100,v40,v41
v_cvt_pk_bf16_f32 v101,v42,v43
v_mfma_f32_16x16x32_bf16 v[36:39],a[216:219],a[96:99],0
v_mfma_f32_16x16x32_bf16 v[36:39],a[220:223],a[100:103],v[36:39]
v_mfma_f32_16x16x32_bf16 v[36:39],a[224:227],a[104:107],v[36:39]
v_mfma_f32_16x16x32_bf16 v[36:39],a[228:231],a[108:111],v[36:39]
v_mfma_f32_16x16x32_bf16 v[36:39],a[232:235],a[112:115],v[36:39]
v_mfma_f32_16x16x32_bf16 v[36:39],a[236:239],a[116:119],v[36:39]
v_mfma_f32_16x16x32_bf16 v[44:47],a[216:219],a[120:123],0
v_mfma_f32_16x16x32_bf16 v[44:47],a[220:223],a[124:127],v[44:47]
v_mfma_f32_16x16x32_bf16 v[44:47],a[224:227],a[128:131],v[44:47]
v_mfma_f32_16x16x32_bf16 v[44:47],a[228:231],a[132:135],v[44:47]
v_mfma_f32_16x16x32_bf16 v[44:47],a[232:235],a[136:139],v[44:47]
s_waitcnt vmcnt(6)
s_barrier
v_mfma_f32_16x16x32_bf16 v[44:47],a[236:239],a[140:143],v[44:47]
v_mfma_f32_16x16x32_bf16 v[52:55],a[216:219],a[144:147],0
ds_read_b64_tr_b16 a[240:241],v3 offset:12288
ds_read_b64_tr_b16 a[242:243],v3 offset:18432
v_mfma_f32_16x16x32_bf16 v[52:55],a[220:223],a[148:151],v[52:55]
v_mfma_f32_16x16x32_bf16 v[52:55],a[224:227],a[152:155],v[52:55]
ds_read_b64_tr_b16 a[244:245],v4 offset:12288
ds_read_b64_tr_b16 a[246:247],v4 offset:18432
v_mfma_f32_16x16x32_bf16 v[52:55],a[228:231],a[156:159],v[52:55]
v_mfma_f32_16x16x32_bf16 v[52:55],a[232:235],a[160:163],v[52:55]
ds_read_b64_tr_b16 a[248:249],v5 offset:12288
ds_read_b64_tr_b16 a[250:251],v5 offset:18432
v_mfma_f32_16x16x32_bf16 v[52:55],a[236:239],a[164:167],v[52:55]
v_mfma_f32_16x16x32_bf16 v[60:63],a[216:219],a[168:171],0
ds_read_b64_tr_b16 a[252:253],v6 offset:12288
ds_read_b64_tr_b16 a[254:255],v6 offset:18432
v_mfma_f32_16x16x32_bf16 v[60:63],a[220:223],a[172:175],v[60:63]
v_mfma_f32_16x16x32_bf16 v[60:63],a[224:227],a[176:179],v[60:63]
v_mfma_f32_16x16x32_bf16 v[60:63],a[228:231],a[180:183],v[60:63]
v_mfma_f32_16x16x32_bf16 v[60:63],a[232:235],a[184:187],v[60:63]
v_mfma_f32_16x16x32_bf16 v[60:63],a[236:239],a[188:191],v[60:63]
s_waitcnt lgkmcnt(4)
v_mfma_f32_16x16x32_bf16 v[160:163],a[240:243],v[112:115],v[160:163]
s_add_u32 m0,s23,0
ds_read_b128 a[192:195],v1 offset:0
v_fma_f32 v36,v36,s36,v16
v_mfma_f32_16x16x32_bf16 v[208:211],a[240:243],v[116:119],v[208:211]
buffer_load_dwordx4 v7,s[8:11],s21 offen offset:0 lds
v_mfma_f32_16x16x32_bf16 a[0:3],a[240:243],v[120:123],a[0:3]
ds_read_b128 a[196:199],v2 offset:0
v_fma_f32 v37,v37,s36,v16
v_mfma_f32_16x16x32_bf16 a[48:51],a[240:243],v[124:127],a[48:51]
ds_read_b64_tr_b16 a[240:241],v3 offset:12416
ds_read_b64_tr_b16 a[242:243],v3 offset:18560
v_mfma_f32_16x16x32_bf16 v[164:167],a[244:247],v[112:115],v[164:167]
ds_read_b128 a[200:203],v1 offset:128
v_fma_f32 v38,v38,s36,v16
v_mfma_f32_16x16x32_bf16 v[212:215],a[244:247],v[116:119],v[212:215]
ds_read_b128 a[204:207],v2 offset:128
v_fma_f32 v39,v39,s36,v16
v_mfma_f32_16x16x32_bf16 a[4:7],a[244:247],v[120:123],a[4:7]
ds_read_b128 a[208:211],v1 offset:256
v_fma_f32 v44,v44,s36,v17
v_mfma_f32_16x16x32_bf16 a[52:55],a[244:247],v[124:127],a[52:55]
s_waitcnt lgkmcnt(7)
ds_read_b64_tr_b16 a[244:245],v4 offset:12416
ds_read_b64_tr_b16 a[246:247],v4 offset:18560
v_mfma_f32_16x16x32_bf16 v[168:171],a[248:251],v[112:115],v[168:171]
ds_read_b128 a[212:215],v2 offset:256
v_fma_f32 v45,v45,s36,v17
v_mfma_f32_16x16x32_bf16 v[216:219],a[248:251],v[116:119],v[216:219]
buffer_load_dwordx4 v8,s[8:11],s21 offen offset:1024 lds
v_mfma_f32_16x16x32_bf16 a[8:11],a[248:251],v[120:123],a[8:11]
ds_read_b128 a[216:219],v1 offset:6144
v_fma_f32 v46,v46,s36,v17
v_mfma_f32_16x16x32_bf16 a[56:59],a[248:251],v[124:127],a[56:59]
ds_read_b64_tr_b16 a[248:249],v5 offset:12416
ds_read_b64_tr_b16 a[250:251],v5 offset:18560
v_mfma_f32_16x16x32_bf16 v[172:175],a[252:255],v[112:115],v[172:175]
ds_read_b128 a[220:223],v2 offset:6144
v_fma_f32 v47,v47,s36,v17
v_mfma_f32_16x16x32_bf16 v[220:223],a[252:255],v[116:119],v[220:223]
ds_read_b128 a[224:227],v1 offset:6272
v_fma_f32 v48,v48,s36,v18
v_mfma_f32_16x16x32_bf16 a[12:15],a[252:255],v[120:123],a[12:15]
ds_read_b128 a[228:231],v2 offset:6272
v_fma_f32 v49,v49,s36,v18
v_mfma_f32_16x16x32_bf16 a[60:63],a[252:255],v[124:127],a[60:63]
s_waitcnt lgkmcnt(7)
ds_read_b64_tr_b16 a[252:253],v6 offset:12416
ds_read_b64_tr_b16 a[254:255],v6 offset:18560
v_mfma_f32_16x16x32_bf16 v[176:179],a[240:243],v[112:115],v[176:179]
ds_read_b128 a[232:235],v1 offset:6400
v_fma_f32 v50,v50,s36,v18
v_mfma_f32_16x16x32_bf16 v[224:227],a[240:243],v[116:119],v[224:227]
buffer_load_dwordx4 v9,s[8:11],s21 offen offset:2048 lds
v_mfma_f32_16x16x32_bf16 a[16:19],a[240:243],v[120:123],a[16:19]
s_add_u32 s21,s21,12288
ds_read_b128 a[236:239],v2 offset:6400
v_fma_f32 v51,v51,s36,v18
v_mfma_f32_16x16x32_bf16 a[64:67],a[240:243],v[124:127],a[64:67]
s_add_u32 m0,s22,24576
ds_read_b64_tr_b16 a[240:241],v3 offset:12544
ds_read_b64_tr_b16 a[242:243],v3 offset:18688
v_mfma_f32_16x16x32_bf16 v[180:183],a[244:247],v[112:115],v[180:183]
v_fma_f32 v52,v52,s36,v18
v_fma_f32 v53,v53,s36,v18
v_mfma_f32_16x16x32_bf16 v[228:231],a[244:247],v[116:119],v[228:231]
v_fma_f32 v54,v54,s36,v18
v_fma_f32 v55,v55,s36,v18
v_mfma_f32_16x16x32_bf16 a[20:23],a[244:247],v[120:123],a[20:23]
v_fma_f32 v56,v56,s36,v19
v_fma_f32 v57,v57,s36,v19
v_mfma_f32_16x16x32_bf16 a[68:71],a[244:247],v[124:127],a[68:71]
s_waitcnt lgkmcnt(4)
ds_read_b64_tr_b16 a[244:245],v4 offset:12544
ds_read_b64_tr_b16 a[246:247],v4 offset:18688
v_mfma_f32_16x16x32_bf16 v[184:187],a[248:251],v[112:115],v[184:187]
buffer_load_dwordx4 v7,s[4:7],s20 offen offset:0 lds
v_mfma_f32_16x16x32_bf16 v[232:235],a[248:251],v[116:119],v[232:235]
v_fma_f32 v58,v58,s36,v19
v_fma_f32 v59,v59,s36,v19
v_mfma_f32_16x16x32_bf16 a[24:27],a[248:251],v[120:123],a[24:27]
v_fma_f32 v60,v60,s36,v19
v_fma_f32 v61,v61,s36,v19
v_mfma_f32_16x16x32_bf16 a[72:75],a[248:251],v[124:127],a[72:75]
ds_read_b64_tr_b16 a[248:249],v5 offset:12544
ds_read_b64_tr_b16 a[250:251],v5 offset:18688
v_mfma_f32_16x16x32_bf16 v[188:191],a[252:255],v[112:115],v[188:191]
v_fma_f32 v62,v62,s36,v19
v_fma_f32 v63,v63,s36,v19
v_mfma_f32_16x16x32_bf16 v[236:239],a[252:255],v[116:119],v[236:239]
v_exp_f32 v36,v36
v_mfma_f32_16x16x32_bf16 a[28:31],a[252:255],v[120:123],a[28:31]
v_exp_f32 v37,v37
v_mfma_f32_16x16x32_bf16 a[76:79],a[252:255],v[124:127],a[76:79]
s_waitcnt lgkmcnt(2)
ds_read_b64_tr_b16 a[252:253],v6 offset:12544
ds_read_b64_tr_b16 a[254:255],v6 offset:18688
v_mfma_f32_16x16x32_bf16 v[192:195],a[240:243],v[112:115],v[192:195]
buffer_load_dwordx4 v8,s[4:7],s20 offen offset:1024 lds
v_mfma_f32_16x16x32_bf16 v[240:243],a[240:243],v[116:119],v[240:243]
v_exp_f32 v38,v38
v_mfma_f32_16x16x32_bf16 a[32:35],a[240:243],v[120:123],a[32:35]
v_exp_f32 v39,v39
v_mfma_f32_16x16x32_bf16 a[80:83],a[240:243],v[124:127],a[80:83]
v_exp_f32 v44,v44
v_mfma_f32_16x16x32_bf16 v[196:199],a[244:247],v[112:115],v[196:199]
v_exp_f32 v45,v45
v_mfma_f32_16x16x32_bf16 v[244:247],a[244:247],v[116:119],v[244:247]
v_exp_f32 v46,v46
v_mfma_f32_16x16x32_bf16 a[36:39],a[244:247],v[120:123],a[36:39]
v_exp_f32 v47,v47
v_mfma_f32_16x16x32_bf16 a[84:87],a[244:247],v[124:127],a[84:87]
s_waitcnt lgkmcnt(0)
v_exp_f32 v48,v48
v_mfma_f32_16x16x32_bf16 v[200:203],a[248:251],v[112:115],v[200:203]
buffer_load_dwordx4 v9,s[4:7],s20 offen offset:2048 lds
v_mfma_f32_16x16x32_bf16 v[248:251],a[248:251],v[116:119],v[248:251]
s_add_u32 s20,s20,12288
v_exp_f32 v49,v49
v_mfma_f32_16x16x32_bf16 a[40:43],a[248:251],v[120:123],a[40:43]
v_exp_f32 v50,v50
v_mfma_f32_16x16x32_bf16 a[88:91],a[248:251],v[124:127],a[88:91]
v_exp_f32 v51,v51
v_mfma_f32_16x16x32_bf16 v[204:207],a[252:255],v[112:115],v[204:207]
v_exp_f32 v52,v52
v_mfma_f32_16x16x32_bf16 v[252:255],a[252:255],v[116:119],v[252:255]
v_exp_f32 v53,v53
v_mfma_f32_16x16x32_bf16 a[44:47],a[252:255],v[120:123],a[44:47]
v_exp_f32 v54,v54
v_mfma_f32_16x16x32_bf16 a[92:95],a[252:255],v[124:127],a[92:95]
v_exp_f32 v55,v55
v_mfma_f32_16x16x32_bf16 v[64:67],a[192:195],a[96:99],0
v_exp_f32 v56,v56
v_mfma_f32_16x16x32_bf16 v[64:67],a[196:199],a[100:103],v[64:67]
v_exp_f32 v57,v57
v_mfma_f32_16x16x32_bf16 v[64:67],a[200:203],a[104:107],v[64:67]
v_exp_f32 v58,v58
v_mfma_f32_16x16x32_bf16 v[64:67],a[204:207],a[108:111],v[64:67]
v_exp_f32 v59,v59
v_mfma_f32_16x16x32_bf16 v[64:67],a[208:211],a[112:115],v[64:67]
v_exp_f32 v60,v60
v_mfma_f32_16x16x32_bf16 v[64:67],a[212:215],a[116:119],v[64:67]
v_exp_f32 v61,v61
v_mfma_f32_16x16x32_bf16 v[72:75],a[192:195],a[120:123],0
v_exp_f32 v62,v62
v_mfma_f32_16x16x32_bf16 v[72:75],a[196:199],a[124:127],v[72:75]
v_exp_f32 v63,v63
v_mfma_f32_16x16x32_bf16 v[72:75],a[200:203],a[128:131],v[72:75]
v_cvt_pk_bf16_f32 v98,v36,v37
v_cvt_pk_bf16_f32 v99,v38,v39
v_mfma_f32_16x16x32_bf16 v[72:75],a[204:207],a[132:135],v[72:75]
v_cvt_pk_bf16_f32 v102,v44,v45
v_cvt_pk_bf16_f32 v103,v46,v47
v_mfma_f32_16x16x32_bf16 v[128:131],v[24:27],v[96:99],v[128:131]
v_cvt_pk_bf16_f32 v104,v48,v49
v_cvt_pk_bf16_f32 v105,v50,v51
v_mfma_f32_16x16x32_bf16 v[132:135],v[24:27],v[100:103],v[132:135]
v_cvt_pk_bf16_f32 v106,v52,v53
v_cvt_pk_bf16_f32 v107,v54,v55
v_mfma_f32_16x16x32_bf16 v[72:75],a[208:211],a[136:139],v[72:75]
v_cvt_pk_bf16_f32 v108,v56,v57
v_cvt_pk_bf16_f32 v109,v58,v59
v_mfma_f32_16x16x32_bf16 v[136:139],v[24:27],v[104:107],v[136:139]
v_cvt_pk_bf16_f32 v110,v60,v61
v_cvt_pk_bf16_f32 v111,v62,v63
v_mfma_f32_16x16x32_bf16 v[72:75],a[212:215],a[140:143],v[72:75]
v_fma_f32 v64,v64,s36,v16
v_fma_f32 v65,v65,s36,v16
v_mfma_f32_16x16x32_bf16 v[140:143],v[24:27],v[108:111],v[140:143]
v_fma_f32 v66,v66,s36,v16
v_fma_f32 v67,v67,s36,v16
v_mfma_f32_16x16x32_bf16 v[80:83],a[192:195],a[144:147],0
v_exp_f32 v64,v64
v_mfma_f32_16x16x32_bf16 v[80:83],a[196:199],a[148:151],v[80:83]
v_fma_f32 v72,v72,s36,v17
v_fma_f32 v73,v73,s36,v17
v_mfma_f32_16x16x32_bf16 v[80:83],a[200:203],a[152:155],v[80:83]
v_fma_f32 v74,v74,s36,v17
v_fma_f32 v75,v75,s36,v17
v_mfma_f32_16x16x32_bf16 v[80:83],a[204:207],a[156:159],v[80:83]
v_exp_f32 v65,v65
v_mfma_f32_16x16x32_bf16 v[80:83],a[208:211],a[160:163],v[80:83]
v_exp_f32 v66,v66
v_mfma_f32_16x16x32_bf16 v[80:83],a[212:215],a[164:167],v[80:83]
v_exp_f32 v67,v67
v_mfma_f32_16x16x32_bf16 v[88:91],a[192:195],a[168:171],0
v_exp_f32 v72,v72
v_mfma_f32_16x16x32_bf16 v[88:91],a[196:199],a[172:175],v[88:91]
v_exp_f32 v73,v73
v_mfma_f32_16x16x32_bf16 v[88:91],a[200:203],a[176:179],v[88:91]
v_exp_f32 v74,v74
v_mfma_f32_16x16x32_bf16 v[88:91],a[204:207],a[180:183],v[88:91]
v_exp_f32 v75,v75
v_mfma_f32_16x16x32_bf16 v[88:91],a[208:211],a[184:187],v[88:91]
v_cvt_pk_bf16_f32 v112,v64,v65
v_cvt_pk_bf16_f32 v113,v66,v67
v_mfma_f32_16x16x32_bf16 v[88:91],a[212:215],a[188:191],v[88:91]
v_cvt_pk_bf16_f32 v116,v72,v73
v_cvt_pk_bf16_f32 v117,v74,v75
v_mfma_f32_16x16x32_bf16 v[68:71],a[216:219],a[96:99],0
v_mfma_f32_16x16x32_bf16 v[68:71],a[220:223],a[100:103],v[68:71]
v_mfma_f32_16x16x32_bf16 v[68:71],a[224:227],a[104:107],v[68:71]
v_mfma_f32_16x16x32_bf16 v[68:71],a[228:231],a[108:111],v[68:71]
v_mfma_f32_16x16x32_bf16 v[68:71],a[232:235],a[112:115],v[68:71]
v_mfma_f32_16x16x32_bf16 v[68:71],a[236:239],a[116:119],v[68:71]
v_mfma_f32_16x16x32_bf16 v[76:79],a[216:219],a[120:123],0
v_mfma_f32_16x16x32_bf16 v[76:79],a[220:223],a[124:127],v[76:79]
v_mfma_f32_16x16x32_bf16 v[76:79],a[224:227],a[128:131],v[76:79]
v_mfma_f32_16x16x32_bf16 v[76:79],a[228:231],a[132:135],v[76:79]
v_mfma_f32_16x16x32_bf16 v[76:79],a[232:235],a[136:139],v[76:79]
s_waitcnt vmcnt(6)
s_barrier
v_mfma_f32_16x16x32_bf16 v[76:79],a[236:239],a[140:143],v[76:79]
v_mfma_f32_16x16x32_bf16 v[84:87],a[216:219],a[144:147],0
ds_read_b64_tr_b16 a[240:241],v3 offset:24576
ds_read_b64_tr_b16 a[242:243],v3 offset:30720
v_mfma_f32_16x16x32_bf16 v[84:87],a[220:223],a[148:151],v[84:87]
v_mfma_f32_16x16x32_bf16 v[84:87],a[224:227],a[152:155],v[84:87]
ds_read_b64_tr_b16 a[244:245],v4 offset:24576
ds_read_b64_tr_b16 a[246:247],v4 offset:30720
v_mfma_f32_16x16x32_bf16 v[84:87],a[228:231],a[156:159],v[84:87]
v_mfma_f32_16x16x32_bf16 v[84:87],a[232:235],a[160:163],v[84:87]
ds_read_b64_tr_b16 a[248:249],v5 offset:24576
ds_read_b64_tr_b16 a[250:251],v5 offset:30720
v_mfma_f32_16x16x32_bf16 v[84:87],a[236:239],a[164:167],v[84:87]
v_mfma_f32_16x16x32_bf16 v[92:95],a[216:219],a[168:171],0
ds_read_b64_tr_b16 a[252:253],v6 offset:24576
ds_read_b64_tr_b16 a[254:255],v6 offset:30720
v_mfma_f32_16x16x32_bf16 v[92:95],a[220:223],a[172:175],v[92:95]
v_mfma_f32_16x16x32_bf16 v[92:95],a[224:227],a[176:179],v[92:95]
v_mfma_f32_16x16x32_bf16 v[92:95],a[228:231],a[180:183],v[92:95]
v_mfma_f32_16x16x32_bf16 v[92:95],a[232:235],a[184:187],v[92:95]
v_mfma_f32_16x16x32_bf16 v[92:95],a[236:239],a[188:191],v[92:95]
s_mov_b32 s38,0
s_branch L_loop4
L_loop3:
s_bitcmp1_b32 s3,1
s_cbranch_scc1 L_loop3w1
.p2align 6
L_loop3w0:
s_waitcnt lgkmcnt(4)
v_mfma_f32_16x16x32_bf16 v[160:163],a[240:243],v[96:99],v[160:163]
s_add_u32 m0,s23,12288
ds_read_b128 a[192:195],v1 offset:12288
v_fma_f32 v68,v68,s36,v16
v_mfma_f32_16x16x32_bf16 v[208:211],a[240:243],v[100:103],v[208:211]
buffer_load_dwordx4 v7,s[8:11],s21 offen offset:0 lds
v_mfma_f32_16x16x32_bf16 a[0:3],a[240:243],v[104:107],a[0:3]
ds_read_b64_tr_b16 a[240:241],v3 offset:24704
ds_read_b64_tr_b16 a[242:243],v3 offset:30848
v_mfma_f32_16x16x32_bf16 v[164:167],a[244:247],v[96:99],v[164:167]
ds_read_b128 a[196:199],v2 offset:12288
v_fma_f32 v69,v69,s36,v16
v_mfma_f32_16x16x32_bf16 v[212:215],a[244:247],v[100:103],v[212:215]
ds_read_b128 a[200:203],v1 offset:12416
v_fma_f32 v70,v70,s36,v16
v_mfma_f32_16x16x32_bf16 a[4:7],a[244:247],v[104:107],a[4:7]
s_waitcnt lgkmcnt(5)
ds_read_b64_tr_b16 a[244:245],v4 offset:24704
ds_read_b64_tr_b16 a[246:247],v4 offset:30848
v_mfma_f32_16x16x32_bf16 v[168:171],a[248:251],v[96:99],v[168:171]
ds_read_b128 a[204:207],v2 offset:12416
v_fma_f32 v71,v71,s36,v16
v_mfma_f32_16x16x32_bf16 v[216:219],a[248:251],v[100:103],v[216:219]
buffer_load_dwordx4 v8,s[8:11],s21 offen offset:1024 lds
v_mfma_f32_16x16x32_bf16 a[8:11],a[248:251],v[104:107],a[8:11]
ds_read_b64_tr_b16 a[248:249],v5 offset:24704
ds_read_b64_tr_b16 a[250:251],v5 offset:30848
v_mfma_f32_16x16x32_bf16 v[172:175],a[252:255],v[96:99],v[172:175]
ds_read_b128 a[208:211],v1 offset:12544
v_fma_f32 v76,v76,s36,v17
v_mfma_f32_16x16x32_bf16 v[220:223],a[252:255],v[100:103],v[220:223]
ds_read_b128 a[212:215],v2 offset:12544
v_fma_f32 v77,v77,s36,v17
v_mfma_f32_16x16x32_bf16 a[12:15],a[252:255],v[104:107],a[12:15]
s_waitcnt lgkmcnt(8)
ds_read_b64_tr_b16 a[252:253],v6 offset:24704
ds_read_b64_tr_b16 a[254:255],v6 offset:30848
v_mfma_f32_16x16x32_bf16 v[176:179],a[240:243],v[96:99],v[176:179]
buffer_load_dwordx4 v9,s[8:11],s21 offen offset:2048 lds
v_mfma_f32_16x16x32_bf16 v[224:227],a[240:243],v[100:103],v[224:227]
s_add_u32 s21,s21,12288
ds_read_b128 a[216:219],v1 offset:18432
v_fma_f32 v78,v78,s36,v17
v_mfma_f32_16x16x32_bf16 a[16:19],a[240:243],v[104:107],a[16:19]
s_add_u32 m0,s22,0
ds_read_b64_tr_b16 a[240:241],v3 offset:24832
ds_read_b64_tr_b16 a[242:243],v3 offset:30976
s_waitcnt lgkmcnt(9)
v_mfma_f32_16x16x32_bf16 v[180:183],a[244:247],v[96:99],v[180:183]
ds_read_b128 a[220:223],v2 offset:18432
v_fma_f32 v79,v79,s36,v17
v_mfma_f32_16x16x32_bf16 v[228:231],a[244:247],v[100:103],v[228:231]
ds_read_b128 a[224:227],v1 offset:18560
v_fma_f32 v80,v80,s36,v18
v_mfma_f32_16x16x32_bf16 a[20:23],a[244:247],v[104:107],a[20:23]
s_waitcnt lgkmcnt(8)
ds_read_b64_tr_b16 a[244:245],v4 offset:24832
ds_read_b64_tr_b16 a[246:247],v4 offset:30976
v_mfma_f32_16x16x32_bf16 v[184:187],a[248:251],v[96:99],v[184:187]
buffer_load_dwordx4 v7,s[4:7],s20 offen offset:0 lds
v_mfma_f32_16x16x32_bf16 v[232:235],a[248:251],v[100:103],v[232:235]
ds_read_b128 a[228:231],v2 offset:18560
v_fma_f32 v81,v81,s36,v18
v_mfma_f32_16x16x32_bf16 a[24:27],a[248:251],v[104:107],a[24:27]
s_waitcnt lgkmcnt(8)
ds_read_b64_tr_b16 a[248:249],v5 offset:24832
ds_read_b64_tr_b16 a[250:251],v5 offset:30976
v_mfma_f32_16x16x32_bf16 v[188:191],a[252:255],v[96:99],v[188:191]
ds_read_b128 a[232:235],v1 offset:18688
v_fma_f32 v82,v82,s36,v18
v_mfma_f32_16x16x32_bf16 v[236:239],a[252:255],v[100:103],v[236:239]
ds_read_b128 a[236:239],v2 offset:18688
v_fma_f32 v83,v83,s36,v18
v_mfma_f32_16x16x32_bf16 a[28:31],a[252:255],v[104:107],a[28:31]
s_waitcnt lgkmcnt(8)
ds_read_b64_tr_b16 a[252:253],v6 offset:24832
ds_read_b64_tr_b16 a[254:255],v6 offset:30976
v_mfma_f32_16x16x32_bf16 v[192:195],a[240:243],v[96:99],v[192:195]
buffer_load_dwordx4 v8,s[4:7],s20 offen offset:1024 lds
v_mfma_f32_16x16x32_bf16 v[240:243],a[240:243],v[100:103],v[240:243]
ds_read_b128 v[152:155],v11 offset:0
v_fma_f32 v84,v84,s36,v18
v_mfma_f32_16x16x32_bf16 a[32:35],a[240:243],v[104:107],a[32:35]
s_waitcnt lgkmcnt(8)
v_fma_f32 v85,v85,s36,v18
v_fma_f32 v86,v86,s36,v18
v_mfma_f32_16x16x32_bf16 v[196:199],a[244:247],v[96:99],v[196:199]
v_fma_f32 v87,v87,s36,v18
v_mfma_f32_16x16x32_bf16 v[244:247],a[244:247],v[100:103],v[244:247]
v_exp_f32 v68,v68
v_mfma_f32_16x16x32_bf16 a[36:39],a[244:247],v[104:107],a[36:39]
s_waitcnt lgkmcnt(4)
v_exp_f32 v69,v69
v_mfma_f32_16x16x32_bf16 v[200:203],a[248:251],v[96:99],v[200:203]
buffer_load_dwordx4 v9,s[4:7],s20 offen offset:2048 lds
v_mfma_f32_16x16x32_bf16 v[248:251],a[248:251],v[100:103],v[248:251]
s_add_u32 s20,s20,12288
v_exp_f32 v70,v70
v_mfma_f32_16x16x32_bf16 a[40:43],a[248:251],v[104:107],a[40:43]
s_waitcnt lgkmcnt(1)
ds_read_b128 v[156:159],v23 offset:0
v_cvt_pk_bf16_f32 v114,v68,v69
v_mfma_f32_16x16x32_bf16 v[204:207],a[252:255],v[96:99],v[204:207]
v_exp_f32 v71,v71
v_mfma_f32_16x16x32_bf16 v[252:255],a[252:255],v[100:103],v[252:255]
v_exp_f32 v76,v76
v_mfma_f32_16x16x32_bf16 a[44:47],a[252:255],v[104:107],a[44:47]
v_exp_f32 v77,v77
v_mfma_f32_16x16x32_bf16 v[32:35],a[192:195],a[96:99],0
v_exp_f32 v78,v78
v_mfma_f32_16x16x32_bf16 v[32:35],a[196:199],a[100:103],v[32:35]
v_exp_f32 v79,v79
v_mfma_f32_16x16x32_bf16 v[32:35],a[200:203],a[104:107],v[32:35]
v_exp_f32 v80,v80
v_mfma_f32_16x16x32_bf16 v[32:35],a[204:207],a[108:111],v[32:35]
s_waitcnt lgkmcnt(1)
buffer_store_dwordx4 v[152:155],v0,s[16:19],s27 offen offset:0 nt
v_mfma_f32_16x16x32_bf16 v[32:35],a[208:211],a[112:115],v[32:35]
v_exp_f32 v81,v81
v_mfma_f32_16x16x32_bf16 v[32:35],a[212:215],a[116:119],v[32:35]
v_exp_f32 v82,v82
v_mfma_f32_16x16x32_bf16 v[40:43],a[192:195],a[120:123],0
ds_read_b128 v[152:155],v31 offset:0
v_cvt_pk_bf16_f32 v115,v70,v71
v_mfma_f32_16x16x32_bf16 v[40:43],a[196:199],a[124:127],v[40:43]
v_exp_f32 v83,v83
v_mfma_f32_16x16x32_bf16 v[128:131],v[24:27],v[112:115],v[128:131]
v_exp_f32 v84,v84
v_mfma_f32_16x16x32_bf16 v[40:43],a[200:203],a[128:131],v[40:43]
v_exp_f32 v85,v85
v_mfma_f32_16x16x32_bf16 v[40:43],a[204:207],a[132:135],v[40:43]
v_exp_f32 v86,v86
v_mfma_f32_16x16x32_bf16 v[40:43],a[208:211],a[136:139],v[40:43]
v_exp_f32 v87,v87
v_mfma_f32_16x16x32_bf16 v[40:43],a[212:215],a[140:143],v[40:43]
s_waitcnt lgkmcnt(1)
buffer_store_dwordx4 v[156:159],v0,s[16:19],s27 offen offset:1024 nt
v_mfma_f32_16x16x32_bf16 v[48:51],a[192:195],a[144:147],0
v_cvt_pk_bf16_f32 v118,v76,v77
v_cvt_pk_bf16_f32 v119,v78,v79
v_mfma_f32_16x16x32_bf16 v[48:51],a[196:199],a[148:151],v[48:51]
v_cvt_pk_bf16_f32 v120,v80,v81
v_cvt_pk_bf16_f32 v121,v82,v83
v_mfma_f32_16x16x32_bf16 v[132:135],v[24:27],v[116:119],v[132:135]
v_cvt_pk_bf16_f32 v122,v84,v85
v_cvt_pk_bf16_f32 v123,v86,v87
v_mfma_f32_16x16x32_bf16 v[48:51],a[200:203],a[152:155],v[48:51]
v_fma_f32 v32,v32,s36,v16
v_fma_f32 v33,v33,s36,v16
v_mfma_f32_16x16x32_bf16 v[136:139],v[24:27],v[120:123],v[136:139]
v_fma_f32 v34,v34,s36,v16
v_fma_f32 v35,v35,s36,v16
v_mfma_f32_16x16x32_bf16 v[48:51],a[204:207],a[156:159],v[48:51]
v_fma_f32 v40,v40,s36,v17
v_fma_f32 v41,v41,s36,v17
v_mfma_f32_16x16x32_bf16 v[48:51],a[208:211],a[160:163],v[48:51]
v_fma_f32 v42,v42,s36,v17
v_fma_f32 v43,v43,s36,v17
v_mfma_f32_16x16x32_bf16 v[48:51],a[212:215],a[164:167],v[48:51]
s_waitcnt lgkmcnt(0)
buffer_store_dwordx4 v[152:155],v0,s[16:19],s27 offen offset:2048 nt
v_mfma_f32_16x16x32_bf16 v[36:39],a[216:219],a[96:99],0
s_add_u32 s27,s27,3072
v_exp_f32 v32,v32
v_mfma_f32_16x16x32_bf16 v[36:39],a[220:223],a[100:103],v[36:39]
v_exp_f32 v33,v33
v_mfma_f32_16x16x32_bf16 v[36:39],a[224:227],a[104:107],v[36:39]
v_exp_f32 v34,v34
s_waitcnt vmcnt(9)
s_barrier
v_mfma_f32_16x16x32_bf16 v[36:39],a[228:231],a[108:111],v[36:39]
v_exp_f32 v35,v35
v_mfma_f32_16x16x32_bf16 v[36:39],a[232:235],a[112:115],v[36:39]
ds_read_b64_tr_b16 a[240:241],v3 offset:0
ds_read_b64_tr_b16 a[242:243],v3 offset:6144
v_mfma_f32_16x16x32_bf16 v[36:39],a[236:239],a[116:119],v[36:39]
v_exp_f32 v40,v40
v_mfma_f32_16x16x32_bf16 v[44:47],a[216:219],a[120:123],0
ds_read_b64_tr_b16 a[244:245],v4 offset:0
ds_read_b64_tr_b16 a[246:247],v4 offset:6144
v_mfma_f32_16x16x32_bf16 v[44:47],a[220:223],a[124:127],v[44:47]
ds_read_b64_tr_b16 a[248:249],v5 offset:0
ds_read_b64_tr_b16 a[250:251],v5 offset:6144
v_mfma_f32_16x16x32_bf16 v[44:47],a[224:227],a[128:131],v[44:47]
v_exp_f32 v41,v41
v_mfma_f32_16x16x32_bf16 v[44:47],a[228:231],a[132:135],v[44:47]
ds_read_b64_tr_b16 a[252:253],v6 offset:0
ds_read_b64_tr_b16 a[254:255],v6 offset:6144
v_mfma_f32_16x16x32_bf16 v[44:47],a[232:235],a[136:139],v[44:47]
v_exp_f32 v42,v42
v_mfma_f32_16x16x32_bf16 v[44:47],a[236:239],a[140:143],v[44:47]
v_exp_f32 v43,v43
v_mfma_f32_16x16x32_bf16 v[52:55],a[216:219],a[144:147],0
v_cvt_pk_bf16_f32 v96,v32,v33
v_cvt_pk_bf16_f32 v97,v34,v35
v_mfma_f32_16x16x32_bf16 v[52:55],a[220:223],a[148:151],v[52:55]
v_cvt_pk_bf16_f32 v100,v40,v41
v_cvt_pk_bf16_f32 v101,v42,v43
v_mfma_f32_16x16x32_bf16 v[52:55],a[224:227],a[152:155],v[52:55]
v_mfma_f32_16x16x32_bf16 v[52:55],a[228:231],a[156:159],v[52:55]
v_mfma_f32_16x16x32_bf16 v[52:55],a[232:235],a[160:163],v[52:55]
v_mfma_f32_16x16x32_bf16 v[52:55],a[236:239],a[164:167],v[52:55]
s_waitcnt lgkmcnt(2)
v_mfma_f32_16x16x32_bf16 v[160:163],a[240:243],v[112:115],v[160:163]
s_add_u32 m0,s23,24576
ds_read_b128 a[192:195],v1 offset:24576
v_fma_f32 v36,v36,s36,v16
v_mfma_f32_16x16x32_bf16 v[208:211],a[240:243],v[116:119],v[208:211]
buffer_load_dwordx4 v7,s[8:11],s21 offen offset:0 lds
v_mfma_f32_16x16x32_bf16 a[0:3],a[240:243],v[120:123],a[0:3]
ds_read_b64_tr_b16 a[240:241],v3 offset:128
ds_read_b64_tr_b16 a[242:243],v3 offset:6272
v_mfma_f32_16x16x32_bf16 v[164:167],a[244:247],v[112:115],v[164:167]
ds_read_b128 a[196:199],v2 offset:24576
v_fma_f32 v37,v37,s36,v16
v_mfma_f32_16x16x32_bf16 v[212:215],a[244:247],v[116:119],v[212:215]
ds_read_b128 a[200:203],v1 offset:24704
v_fma_f32 v38,v38,s36,v16
v_mfma_f32_16x16x32_bf16 a[4:7],a[244:247],v[120:123],a[4:7]
ds_read_b64_tr_b16 a[244:245],v4 offset:128
ds_read_b64_tr_b16 a[246:247],v4 offset:6272
v_mfma_f32_16x16x32_bf16 v[168:171],a[248:251],v[112:115],v[168:171]
ds_read_b128 a[204:207],v2 offset:24704
v_fma_f32 v39,v39,s36,v16
v_mfma_f32_16x16x32_bf16 v[216:219],a[248:251],v[116:119],v[216:219]
buffer_load_dwordx4 v8,s[8:11],s21 offen offset:1024 lds
v_mfma_f32_16x16x32_bf16 a[8:11],a[248:251],v[120:123],a[8:11]
s_waitcnt lgkmcnt(7)
ds_read_b64_tr_b16 a[248:249],v5 offset:128
ds_read_b64_tr_b16 a[250:251],v5 offset:6272
v_mfma_f32_16x16x32_bf16 v[172:175],a[252:255],v[112:115],v[172:175]
ds_read_b128 a[208:211],v1 offset:24832
v_fma_f32 v44,v44,s36,v17
v_mfma_f32_16x16x32_bf16 v[220:223],a[252:255],v[116:119],v[220:223]
ds_read_b128 a[212:215],v2 offset:24832
v_fma_f32 v45,v45,s36,v17
v_mfma_f32_16x16x32_bf16 a[12:15],a[252:255],v[120:123],a[12:15]
s_waitcnt lgkmcnt(8)
ds_read_b64_tr_b16 a[252:253],v6 offset:128
ds_read_b64_tr_b16 a[254:255],v6 offset:6272
v_mfma_f32_16x16x32_bf16 v[176:179],a[240:243],v[112:115],v[176:179]
buffer_load_dwordx4 v9,s[8:11],s21 offen offset:2048 lds
v_mfma_f32_16x16x32_bf16 v[224:227],a[240:243],v[116:119],v[224:227]
s_add_u32 s21,s21,12288
ds_read_b128 a[216:219],v1 offset:30720
v_fma_f32 v46,v46,s36,v17
v_mfma_f32_16x16x32_bf16 a[16:19],a[240:243],v[120:123],a[16:19]
s_add_u32 m0,s22,12288
ds_read_b64_tr_b16 a[240:241],v3 offset:256
ds_read_b64_tr_b16 a[242:243],v3 offset:6400
s_waitcnt lgkmcnt(9)
v_mfma_f32_16x16x32_bf16 v[180:183],a[244:247],v[112:115],v[180:183]
ds_read_b128 a[220:223],v2 offset:30720
v_fma_f32 v47,v47,s36,v17
v_mfma_f32_16x16x32_bf16 v[228:231],a[244:247],v[116:119],v[228:231]
ds_read_b128 a[224:227],v1 offset:30848
v_fma_f32 v48,v48,s36,v18
v_mfma_f32_16x16x32_bf16 a[20:23],a[244:247],v[120:123],a[20:23]
s_waitcnt lgkmcnt(8)
ds_read_b64_tr_b16 a[244:245],v4 offset:256
ds_read_b64_tr_b16 a[246:247],v4 offset:6400
v_mfma_f32_16x16x32_bf16 v[184:187],a[248:251],v[112:115],v[184:187]
buffer_load_dwordx4 v7,s[4:7],s20 offen offset:0 lds
v_mfma_f32_16x16x32_bf16 v[232:235],a[248:251],v[116:119],v[232:235]
ds_read_b128 a[228:231],v2 offset:30848
v_fma_f32 v49,v49,s36,v18
v_mfma_f32_16x16x32_bf16 a[24:27],a[248:251],v[120:123],a[24:27]
s_waitcnt lgkmcnt(8)
ds_read_b64_tr_b16 a[248:249],v5 offset:256
ds_read_b64_tr_b16 a[250:251],v5 offset:6400
v_mfma_f32_16x16x32_bf16 v[188:191],a[252:255],v[112:115],v[188:191]
ds_read_b128 a[232:235],v1 offset:30976
v_fma_f32 v50,v50,s36,v18
v_mfma_f32_16x16x32_bf16 v[236:239],a[252:255],v[116:119],v[236:239]
ds_read_b128 a[236:239],v2 offset:30976
v_fma_f32 v51,v51,s36,v18
v_mfma_f32_16x16x32_bf16 a[28:31],a[252:255],v[120:123],a[28:31]
s_waitcnt lgkmcnt(8)
ds_read_b64_tr_b16 a[252:253],v6 offset:256
ds_read_b64_tr_b16 a[254:255],v6 offset:6400
v_mfma_f32_16x16x32_bf16 v[192:195],a[240:243],v[112:115],v[192:195]
buffer_load_dwordx4 v8,s[4:7],s20 offen offset:1024 lds
v_mfma_f32_16x16x32_bf16 v[240:243],a[240:243],v[116:119],v[240:243]
v_fma_f32 v52,v52,s36,v18
v_fma_f32 v53,v53,s36,v18
v_mfma_f32_16x16x32_bf16 a[32:35],a[240:243],v[120:123],a[32:35]
s_waitcnt lgkmcnt(7)
v_fma_f32 v54,v54,s36,v18
v_fma_f32 v55,v55,s36,v18
v_mfma_f32_16x16x32_bf16 v[196:199],a[244:247],v[112:115],v[196:199]
v_exp_f32 v36,v36
v_mfma_f32_16x16x32_bf16 v[244:247],a[244:247],v[116:119],v[244:247]
v_exp_f32 v37,v37
v_mfma_f32_16x16x32_bf16 a[36:39],a[244:247],v[120:123],a[36:39]
s_waitcnt lgkmcnt(3)
v_exp_f32 v38,v38
v_mfma_f32_16x16x32_bf16 v[200:203],a[248:251],v[112:115],v[200:203]
buffer_load_dwordx4 v9,s[4:7],s20 offen offset:2048 lds
v_mfma_f32_16x16x32_bf16 v[248:251],a[248:251],v[116:119],v[248:251]
s_add_u32 s20,s20,12288
v_exp_f32 v39,v39
v_mfma_f32_16x16x32_bf16 a[40:43],a[248:251],v[120:123],a[40:43]
s_add_u32 m0,s29,0
v_exp_f32 v44,v44
s_waitcnt lgkmcnt(0)
v_mfma_f32_16x16x32_bf16 v[204:207],a[252:255],v[112:115],v[204:207]
v_exp_f32 v45,v45
v_mfma_f32_16x16x32_bf16 v[252:255],a[252:255],v[116:119],v[252:255]
v_exp_f32 v46,v46
v_mfma_f32_16x16x32_bf16 a[44:47],a[252:255],v[120:123],a[44:47]
v_exp_f32 v47,v47
v_mfma_f32_16x16x32_bf16 v[64:67],a[192:195],a[96:99],0
v_exp_f32 v48,v48
v_mfma_f32_16x16x32_bf16 v[64:67],a[196:199],a[100:103],v[64:67]
v_exp_f32 v49,v49
v_mfma_f32_16x16x32_bf16 v[64:67],a[200:203],a[104:107],v[64:67]
v_exp_f32 v50,v50
v_mfma_f32_16x16x32_bf16 v[64:67],a[204:207],a[108:111],v[64:67]
buffer_load_dwordx4 v7,s[12:15],s28 offen offset:0 nt lds
v_mfma_f32_16x16x32_bf16 v[64:67],a[208:211],a[112:115],v[64:67]
v_exp_f32 v51,v51
v_mfma_f32_16x16x32_bf16 v[64:67],a[212:215],a[116:119],v[64:67]
v_exp_f32 v52,v52
v_mfma_f32_16x16x32_bf16 v[72:75],a[192:195],a[120:123],0
v_exp_f32 v53,v53
v_mfma_f32_16x16x32_bf16 v[72:75],a[196:199],a[124:127],v[72:75]
v_exp_f32 v54,v54
v_mfma_f32_16x16x32_bf16 v[72:75],a[200:203],a[128:131],v[72:75]
v_exp_f32 v55,v55
v_mfma_f32_16x16x32_bf16 v[72:75],a[204:207],a[132:135],v[72:75]
v_cvt_pk_bf16_f32 v98,v36,v37
v_cvt_pk_bf16_f32 v99,v38,v39
v_mfma_f32_16x16x32_bf16 v[72:75],a[208:211],a[136:139],v[72:75]
v_cvt_pk_bf16_f32 v102,v44,v45
v_cvt_pk_bf16_f32 v103,v46,v47
v_mfma_f32_16x16x32_bf16 v[128:131],v[24:27],v[96:99],v[128:131]
v_cvt_pk_bf16_f32 v104,v48,v49
v_cvt_pk_bf16_f32 v105,v50,v51
v_mfma_f32_16x16x32_bf16 v[132:135],v[24:27],v[100:103],v[132:135]
buffer_load_dwordx4 v8,s[12:15],s28 offen offset:1024 nt lds
v_mfma_f32_16x16x32_bf16 v[72:75],a[212:215],a[140:143],v[72:75]
v_cvt_pk_bf16_f32 v106,v52,v53
v_cvt_pk_bf16_f32 v107,v54,v55
v_mfma_f32_16x16x32_bf16 v[80:83],a[192:195],a[144:147],0
v_fma_f32 v64,v64,s36,v16
v_fma_f32 v65,v65,s36,v16
v_mfma_f32_16x16x32_bf16 v[136:139],v[24:27],v[104:107],v[136:139]
v_fma_f32 v66,v66,s36,v16
v_fma_f32 v67,v67,s36,v16
v_mfma_f32_16x16x32_bf16 v[80:83],a[196:199],a[148:151],v[80:83]
v_fma_f32 v72,v72,s36,v17
v_fma_f32 v73,v73,s36,v17
v_mfma_f32_16x16x32_bf16 v[80:83],a[200:203],a[152:155],v[80:83]
v_fma_f32 v74,v74,s36,v17
v_fma_f32 v75,v75,s36,v17
v_mfma_f32_16x16x32_bf16 v[80:83],a[204:207],a[156:159],v[80:83]
v_exp_f32 v64,v64
v_mfma_f32_16x16x32_bf16 v[80:83],a[208:211],a[160:163],v[80:83]
v_exp_f32 v65,v65
v_mfma_f32_16x16x32_bf16 v[80:83],a[212:215],a[164:167],v[80:83]
buffer_load_dwordx4 v9,s[12:15],s28 offen offset:2048 nt lds
v_mfma_f32_16x16x32_bf16 v[68:71],a[216:219],a[96:99],0
s_add_u32 s28,s28,3072
v_exp_f32 v66,v66
v_mfma_f32_16x16x32_bf16 v[68:71],a[220:223],a[100:103],v[68:71]
s_add_u32 s29,s29,3072
v_exp_f32 v67,v67
v_mfma_f32_16x16x32_bf16 v[68:71],a[224:227],a[104:107],v[68:71]
v_exp_f32 v72,v72
s_waitcnt vmcnt(12)
s_barrier
v_mfma_f32_16x16x32_bf16 v[68:71],a[228:231],a[108:111],v[68:71]
v_exp_f32 v73,v73
v_mfma_f32_16x16x32_bf16 v[68:71],a[232:235],a[112:115],v[68:71]
ds_read_b64_tr_b16 a[240:241],v3 offset:12288
ds_read_b64_tr_b16 a[242:243],v3 offset:18432
v_mfma_f32_16x16x32_bf16 v[68:71],a[236:239],a[116:119],v[68:71]
v_exp_f32 v74,v74
v_mfma_f32_16x16x32_bf16 v[76:79],a[216:219],a[120:123],0
ds_read_b64_tr_b16 a[244:245],v4 offset:12288
ds_read_b64_tr_b16 a[246:247],v4 offset:18432
v_mfma_f32_16x16x32_bf16 v[76:79],a[220:223],a[124:127],v[76:79]
ds_read_b64_tr_b16 a[248:249],v5 offset:12288
ds_read_b64_tr_b16 a[250:251],v5 offset:18432
v_mfma_f32_16x16x32_bf16 v[76:79],a[224:227],a[128:131],v[76:79]
v_exp_f32 v75,v75
v_mfma_f32_16x16x32_bf16 v[76:79],a[228:231],a[132:135],v[76:79]
ds_read_b64_tr_b16 a[252:253],v6 offset:12288
ds_read_b64_tr_b16 a[254:255],v6 offset:18432
v_mfma_f32_16x16x32_bf16 v[76:79],a[232:235],a[136:139],v[76:79]
v_cvt_pk_bf16_f32 v112,v64,v65
v_cvt_pk_bf16_f32 v113,v66,v67
v_mfma_f32_16x16x32_bf16 v[76:79],a[236:239],a[140:143],v[76:79]
v_cvt_pk_bf16_f32 v116,v72,v73
v_cvt_pk_bf16_f32 v117,v74,v75
v_mfma_f32_16x16x32_bf16 v[84:87],a[216:219],a[144:147],0
v_mfma_f32_16x16x32_bf16 v[84:87],a[220:223],a[148:151],v[84:87]
v_mfma_f32_16x16x32_bf16 v[84:87],a[224:227],a[152:155],v[84:87]
v_mfma_f32_16x16x32_bf16 v[84:87],a[228:231],a[156:159],v[84:87]
v_mfma_f32_16x16x32_bf16 v[84:87],a[232:235],a[160:163],v[84:87]
v_mfma_f32_16x16x32_bf16 v[84:87],a[236:239],a[164:167],v[84:87]
s_waitcnt lgkmcnt(2)
v_mfma_f32_16x16x32_bf16 v[160:163],a[240:243],v[96:99],v[160:163]
s_add_u32 m0,s23,0
ds_read_b128 a[192:195],v1 offset:0
v_fma_f32 v68,v68,s36,v16
v_mfma_f32_16x16x32_bf16 v[208:211],a[240:243],v[100:103],v[208:211]
buffer_load_dwordx4 v7,s[8:11],s21 offen offset:0 lds
v_mfma_f32_16x16x32_bf16 a[0:3],a[240:243],v[104:107],a[0:3]
ds_read_b64_tr_b16 a[240:241],v3 offset:12416
ds_read_b64_tr_b16 a[242:243],v3 offset:18560
v_mfma_f32_16x16x32_bf16 v[164:167],a[244:247],v[96:99],v[164:167]
ds_read_b128 a[196:199],v2 offset:0
v_fma_f32 v69,v69,s36,v16
v_mfma_f32_16x16x32_bf16 v[212:215],a[244:247],v[100:103],v[212:215]
ds_read_b128 a[200:203],v1 offset:128
v_fma_f32 v70,v70,s36,v16
v_mfma_f32_16x16x32_bf16 a[4:7],a[244:247],v[104:107],a[4:7]
ds_read_b64_tr_b16 a[244:245],v4 offset:12416
ds_read_b64_tr_b16 a[246:247],v4 offset:18560
v_mfma_f32_16x16x32_bf16 v[168:171],a[248:251],v[96:99],v[168:171]
ds_read_b128 a[204:207],v2 offset:128
v_fma_f32 v71,v71,s36,v16
v_mfma_f32_16x16x32_bf16 v[216:219],a[248:251],v[100:103],v[216:219]
buffer_load_dwordx4 v8,s[8:11],s21 offen offset:1024 lds
v_mfma_f32_16x16x32_bf16 a[8:11],a[248:251],v[104:107],a[8:11]
s_waitcnt lgkmcnt(7)
ds_read_b64_tr_b16 a[248:249],v5 offset:12416
ds_read_b64_tr_b16 a[250:251],v5 offset:18560
v_mfma_f32_16x16x32_bf16 v[172:175],a[252:255],v[96:99],v[172:175]
ds_read_b128 a[208:211],v1 offset:256
v_fma_f32 v76,v76,s36,v17
v_mfma_f32_16x16x32_bf16 v[220:223],a[252:255],v[100:103],v[220:223]
ds_read_b128 a[212:215],v2 offset:256
v_fma_f32 v77,v77,s36,v17
v_mfma_f32_16x16x32_bf16 a[12:15],a[252:255],v[104:107],a[12:15]
s_waitcnt lgkmcnt(8)
ds_read_b64_tr_b16 a[252:253],v6 offset:12416
ds_read_b64_tr_b16 a[254:255],v6 offset:18560
v_mfma_f32_16x16x32_bf16 v[176:179],a[240:243],v[96:99],v[176:179]
buffer_load_dwordx4 v9,s[8:11],s21 offen offset:2048 lds
v_mfma_f32_16x16x32_bf16 v[224:227],a[240:243],v[100:103],v[224:227]
s_add_u32 s21,s21,12288
ds_read_b128 a[216:219],v1 offset:6144
v_fma_f32 v78,v78,s36,v17
v_mfma_f32_16x16x32_bf16 a[16:19],a[240:243],v[104:107],a[16:19]
s_add_u32 m0,s22,24576
ds_read_b64_tr_b16 a[240:241],v3 offset:12544
ds_read_b64_tr_b16 a[242:243],v3 offset:18688
s_waitcnt lgkmcnt(9)
v_mfma_f32_16x16x32_bf16 v[180:183],a[244:247],v[96:99],v[180:183]
ds_read_b128 a[220:223],v2 offset:6144
v_fma_f32 v79,v79,s36,v17
v_mfma_f32_16x16x32_bf16 v[228:231],a[244:247],v[100:103],v[228:231]
ds_read_b128 a[224:227],v1 offset:6272
v_fma_f32 v80,v80,s36,v18
v_mfma_f32_16x16x32_bf16 a[20:23],a[244:247],v[104:107],a[20:23]
s_waitcnt lgkmcnt(8)
ds_read_b64_tr_b16 a[244:245],v4 offset:12544
ds_read_b64_tr_b16 a[246:247],v4 offset:18688
v_mfma_f32_16x16x32_bf16 v[184:187],a[248:251],v[96:99],v[184:187]
buffer_load_dwordx4 v7,s[4:7],s20 offen offset:0 lds
v_mfma_f32_16x16x32_bf16 v[232:235],a[248:251],v[100:103],v[232:235]
ds_read_b128 a[228:231],v2 offset:6272
v_fma_f32 v81,v81,s36,v18
v_mfma_f32_16x16x32_bf16 a[24:27],a[248:251],v[104:107],a[24:27]
s_waitcnt lgkmcnt(8)
ds_read_b64_tr_b16 a[248:249],v5 offset:12544
ds_read_b64_tr_b16 a[250:251],v5 offset:18688
v_mfma_f32_16x16x32_bf16 v[188:191],a[252:255],v[96:99],v[188:191]
ds_read_b128 a[232:235],v1 offset:6400
v_fma_f32 v82,v82,s36,v18
v_mfma_f32_16x16x32_bf16 v[236:239],a[252:255],v[100:103],v[236:239]
ds_read_b128 a[236:239],v2 offset:6400
v_fma_f32 v83,v83,s36,v18
v_mfma_f32_16x16x32_bf16 a[28:31],a[252:255],v[104:107],a[28:31]
s_waitcnt lgkmcnt(8)
ds_read_b64_tr_b16 a[252:253],v6 offset:12544
ds_read_b64_tr_b16 a[254:255],v6 offset:18688
v_mfma_f32_16x16x32_bf16 v[192:195],a[240:243],v[96:99],v[192:195]
buffer_load_dwordx4 v8,s[4:7],s20 offen offset:1024 lds
v_mfma_f32_16x16x32_bf16 v[240:243],a[240:243],v[100:103],v[240:243]
ds_read_b128 v[156:159],v11 offset:3072
v_fma_f32 v84,v84,s36,v18
v_mfma_f32_16x16x32_bf16 a[32:35],a[240:243],v[104:107],a[32:35]
s_waitcnt lgkmcnt(8)
v_fma_f32 v85,v85,s36,v18
v_fma_f32 v86,v86,s36,v18
v_mfma_f32_16x16x32_bf16 v[196:199],a[244:247],v[96:99],v[196:199]
v_fma_f32 v87,v87,s36,v18
v_mfma_f32_16x16x32_bf16 v[244:247],a[244:247],v[100:103],v[244:247]
v_exp_f32 v68,v68
v_mfma_f32_16x16x32_bf16 a[36:39],a[244:247],v[104:107],a[36:39]
s_waitcnt lgkmcnt(4)
v_exp_f32 v69,v69
v_mfma_f32_16x16x32_bf16 v[200:203],a[248:251],v[96:99],v[200:203]
buffer_load_dwordx4 v9,s[4:7],s20 offen offset:2048 lds
v_mfma_f32_16x16x32_bf16 v[248:251],a[248:251],v[100:103],v[248:251]
s_add_u32 s20,s20,12288
v_exp_f32 v70,v70
v_mfma_f32_16x16x32_bf16 a[40:43],a[248:251],v[104:107],a[40:43]
s_waitcnt lgkmcnt(1)
ds_read_b128 v[152:155],v23 offset:3072
v_cvt_pk_bf16_f32 v114,v68,v69
v_mfma_f32_16x16x32_bf16 v[204:207],a[252:255],v[96:99],v[204:207]
v_exp_f32 v71,v71
v_mfma_f32_16x16x32_bf16 v[252:255],a[252:255],v[100:103],v[252:255]
v_exp_f32 v76,v76
v_mfma_f32_16x16x32_bf16 a[44:47],a[252:255],v[104:107],a[44:47]
v_exp_f32 v77,v77
v_mfma_f32_16x16x32_bf16 v[32:35],a[192:195],a[96:99],0
v_exp_f32 v78,v78
v_mfma_f32_16x16x32_bf16 v[32:35],a[196:199],a[100:103],v[32:35]
v_exp_f32 v79,v79
v_mfma_f32_16x16x32_bf16 v[32:35],a[200:203],a[104:107],v[32:35]
v_exp_f32 v80,v80
v_mfma_f32_16x16x32_bf16 v[32:35],a[204:207],a[108:111],v[32:35]
s_waitcnt lgkmcnt(1)
buffer_store_dwordx4 v[156:159],v0,s[16:19],s27 offen offset:0 nt
v_mfma_f32_16x16x32_bf16 v[32:35],a[208:211],a[112:115],v[32:35]
v_exp_f32 v81,v81
v_mfma_f32_16x16x32_bf16 v[32:35],a[212:215],a[116:119],v[32:35]
v_exp_f32 v82,v82
v_mfma_f32_16x16x32_bf16 v[40:43],a[192:195],a[120:123],0
ds_read_b128 v[156:159],v31 offset:3072
v_cvt_pk_bf16_f32 v115,v70,v71
v_mfma_f32_16x16x32_bf16 v[40:43],a[196:199],a[124:127],v[40:43]
v_exp_f32 v83,v83
v_mfma_f32_16x16x32_bf16 v[128:131],v[24:27],v[112:115],v[128:131]
v_exp_f32 v84,v84
v_mfma_f32_16x16x32_bf16 v[40:43],a[200:203],a[128:131],v[40:43]
v_exp_f32 v85,v85
v_mfma_f32_16x16x32_bf16 v[40:43],a[204:207],a[132:135],v[40:43]
v_exp_f32 v86,v86
v_mfma_f32_16x16x32_bf16 v[40:43],a[208:211],a[136:139],v[40:43]
v_exp_f32 v87,v87
v_mfma_f32_16x16x32_bf16 v[40:43],a[212:215],a[140:143],v[40:43]
s_waitcnt lgkmcnt(1)
buffer_store_dwordx4 v[152:155],v0,s[16:19],s27 offen offset:1024 nt
v_mfma_f32_16x16x32_bf16 v[48:51],a[192:195],a[144:147],0
v_cvt_pk_bf16_f32 v118,v76,v77
v_cvt_pk_bf16_f32 v119,v78,v79
v_mfma_f32_16x16x32_bf16 v[48:51],a[196:199],a[148:151],v[48:51]
v_cvt_pk_bf16_f32 v120,v80,v81
v_cvt_pk_bf16_f32 v121,v82,v83
v_mfma_f32_16x16x32_bf16 v[132:135],v[24:27],v[116:119],v[132:135]
v_cvt_pk_bf16_f32 v122,v84,v85
v_cvt_pk_bf16_f32 v123,v86,v87
v_mfma_f32_16x16x32_bf16 v[48:51],a[200:203],a[152:155],v[48:51]
v_fma_f32 v32,v32,s36,v16
v_fma_f32 v33,v33,s36,v16
v_mfma_f32_16x16x32_bf16 v[136:139],v[24:27],v[120:123],v[136:139]
v_fma_f32 v34,v34,s36,v16
v_fma_f32 v35,v35,s36,v16
v_mfma_f32_16x16x32_bf16 v[48:51],a[204:207],a[156:159],v[48:51]
v_fma_f32 v40,v40,s36,v17
v_fma_f32 v41,v41,s36,v17
v_mfma_f32_16x16x32_bf16 v[48:51],a[208:211],a[160:163],v[48:51]
v_fma_f32 v42,v42,s36,v17
v_fma_f32 v43,v43,s36,v17
v_mfma_f32_16x16x32_bf16 v[48:51],a[212:215],a[164:167],v[48:51]
s_waitcnt lgkmcnt(0)
buffer_store_dwordx4 v[156:159],v0,s[16:19],s27 offen offset:2048 nt
v_mfma_f32_16x16x32_bf16 v[36:39],a[216:219],a[96:99],0
s_add_u32 s27,s27,3072
v_exp_f32 v32,v32
v_mfma_f32_16x16x32_bf16 v[36:39],a[220:223],a[100:103],v[36:39]
v_exp_f32 v33,v33
v_mfma_f32_16x16x32_bf16 v[36:39],a[224:227],a[104:107],v[36:39]
v_exp_f32 v34,v34
s_waitcnt vmcnt(12)
s_barrier
v_mfma_f32_16x16x32_bf16 v[36:39],a[228:231],a[108:111],v[36:39]
v_exp_f32 v35,v35
v_mfma_f32_16x16x32_bf16 v[36:39],a[232:235],a[112:115],v[36:39]
ds_read_b64_tr_b16 a[240:241],v3 offset:24576
ds_read_b64_tr_b16 a[242:243],v3 offset:30720
v_mfma_f32_16x16x32_bf16 v[36:39],a[236:239],a[116:119],v[36:39]
v_exp_f32 v40,v40
v_mfma_f32_16x16x32_bf16 v[44:47],a[216:219],a[120:123],0
ds_read_b64_tr_b16 a[244:245],v4 offset:24576
ds_read_b64_tr_b16 a[246:247],v4 offset:30720
v_mfma_f32_16x16x32_bf16 v[44:47],a[220:223],a[124:127],v[44:47]
ds_read_b64_tr_b16 a[248:249],v5 offset:24576
ds_read_b64_tr_b16 a[250:251],v5 offset:30720
v_mfma_f32_16x16x32_bf16 v[44:47],a[224:227],a[128:131],v[44:47]
v_exp_f32 v41,v41
v_mfma_f32_16x16x32_bf16 v[44:47],a[228:231],a[132:135],v[44:47]
ds_read_b64_tr_b16 a[252:253],v6 offset:24576
ds_read_b64_tr_b16 a[254:255],v6 offset:30720
v_mfma_f32_16x16x32_bf16 v[44:47],a[232:235],a[136:139],v[44:47]
v_exp_f32 v42,v42
v_mfma_f32_16x16x32_bf16 v[44:47],a[236:239],a[140:143],v[44:47]
v_exp_f32 v43,v43
v_mfma_f32_16x16x32_bf16 v[52:55],a[216:219],a[144:147],0
v_cvt_pk_bf16_f32 v96,v32,v33
v_cvt_pk_bf16_f32 v97,v34,v35
v_mfma_f32_16x16x32_bf16 v[52:55],a[220:223],a[148:151],v[52:55]
v_cvt_pk_bf16_f32 v100,v40,v41
v_cvt_pk_bf16_f32 v101,v42,v43
v_mfma_f32_16x16x32_bf16 v[52:55],a[224:227],a[152:155],v[52:55]
v_mfma_f32_16x16x32_bf16 v[52:55],a[228:231],a[156:159],v[52:55]
v_mfma_f32_16x16x32_bf16 v[52:55],a[232:235],a[160:163],v[52:55]
v_mfma_f32_16x16x32_bf16 v[52:55],a[236:239],a[164:167],v[52:55]
s_waitcnt lgkmcnt(2)
v_mfma_f32_16x16x32_bf16 v[160:163],a[240:243],v[112:115],v[160:163]
s_add_u32 m0,s23,12288
ds_read_b128 a[192:195],v1 offset:12288
v_fma_f32 v36,v36,s36,v16
v_mfma_f32_16x16x32_bf16 v[208:211],a[240:243],v[116:119],v[208:211]
buffer_load_dwordx4 v7,s[8:11],s21 offen offset:0 lds
v_mfma_f32_16x16x32_bf16 a[0:3],a[240:243],v[120:123],a[0:3]
ds_read_b64_tr_b16 a[240:241],v3 offset:24704
ds_read_b64_tr_b16 a[242:243],v3 offset:30848
v_mfma_f32_16x16x32_bf16 v[164:167],a[244:247],v[112:115],v[164:167]
ds_read_b128 a[196:199],v2 offset:12288
v_fma_f32 v37,v37,s36,v16
v_mfma_f32_16x16x32_bf16 v[212:215],a[244:247],v[116:119],v[212:215]
ds_read_b128 a[200:203],v1 offset:12416
v_fma_f32 v38,v38,s36,v16
v_mfma_f32_16x16x32_bf16 a[4:7],a[244:247],v[120:123],a[4:7]
ds_read_b64_tr_b16 a[244:245],v4 offset:24704
ds_read_b64_tr_b16 a[246:247],v4 offset:30848
v_mfma_f32_16x16x32_bf16 v[168:171],a[248:251],v[112:115],v[168:171]
ds_read_b128 a[204:207],v2 offset:12416
v_fma_f32 v39,v39,s36,v16
v_mfma_f32_16x16x32_bf16 v[216:219],a[248:251],v[116:119],v[216:219]
buffer_load_dwordx4 v8,s[8:11],s21 offen offset:1024 lds
v_mfma_f32_16x16x32_bf16 a[8:11],a[248:251],v[120:123],a[8:11]
s_waitcnt lgkmcnt(7)
ds_read_b64_tr_b16 a[248:249],v5 offset:24704
ds_read_b64_tr_b16 a[250:251],v5 offset:30848
v_mfma_f32_16x16x32_bf16 v[172:175],a[252:255],v[112:115],v[172:175]
ds_read_b128 a[208:211],v1 offset:12544
v_fma_f32 v44,v44,s36,v17
v_mfma_f32_16x16x32_bf16 v[220:223],a[252:255],v[116:119],v[220:223]
ds_read_b128 a[212:215],v2 offset:12544
v_fma_f32 v45,v45,s36,v17
v_mfma_f32_16x16x32_bf16 a[12:15],a[252:255],v[120:123],a[12:15]
s_waitcnt lgkmcnt(8)
ds_read_b64_tr_b16 a[252:253],v6 offset:24704
ds_read_b64_tr_b16 a[254:255],v6 offset:30848
v_mfma_f32_16x16x32_bf16 v[176:179],a[240:243],v[112:115],v[176:179]
buffer_load_dwordx4 v9,s[8:11],s21 offen offset:2048 lds
v_mfma_f32_16x16x32_bf16 v[224:227],a[240:243],v[116:119],v[224:227]
s_add_u32 s21,s21,12288
ds_read_b128 a[216:219],v1 offset:18432
v_fma_f32 v46,v46,s36,v17
v_mfma_f32_16x16x32_bf16 a[16:19],a[240:243],v[120:123],a[16:19]
s_add_u32 m0,s22,0
ds_read_b64_tr_b16 a[240:241],v3 offset:24832
ds_read_b64_tr_b16 a[242:243],v3 offset:30976
s_waitcnt lgkmcnt(9)
v_mfma_f32_16x16x32_bf16 v[180:183],a[244:247],v[112:115],v[180:183]
ds_read_b128 a[220:223],v2 offset:18432
v_fma_f32 v47,v47,s36,v17
v_mfma_f32_16x16x32_bf16 v[228:231],a[244:247],v[116:119],v[228:231]
ds_read_b128 a[224:227],v1 offset:18560
v_fma_f32 v48,v48,s36,v18
v_mfma_f32_16x16x32_bf16 a[20:23],a[244:247],v[120:123],a[20:23]
s_waitcnt lgkmcnt(8)
ds_read_b64_tr_b16 a[244:245],v4 offset:24832
ds_read_b64_tr_b16 a[246:247],v4 offset:30976
v_mfma_f32_16x16x32_bf16 v[184:187],a[248:251],v[112:115],v[184:187]
buffer_load_dwordx4 v7,s[4:7],s20 offen offset:0 lds
v_mfma_f32_16x16x32_bf16 v[232:235],a[248:251],v[116:119],v[232:235]
ds_read_b128 a[228:231],v2 offset:18560
v_fma_f32 v49,v49,s36,v18
v_mfma_f32_16x16x32_bf16 a[24:27],a[248:251],v[120:123],a[24:27]
s_waitcnt lgkmcnt(8)
ds_read_b64_tr_b16 a[248:249],v5 offset:24832
ds_read_b64_tr_b16 a[250:251],v5 offset:30976
v_mfma_f32_16x16x32_bf16 v[188:191],a[252:255],v[112:115],v[188:191]
ds_read_b128 a[232:235],v1 offset:18688
v_fma_f32 v50,v50,s36,v18
v_mfma_f32_16x16x32_bf16 v[236:239],a[252:255],v[116:119],v[236:239]
ds_read_b128 a[236:239],v2 offset:18688
v_fma_f32 v51,v51,s36,v18
v_mfma_f32_16x16x32_bf16 a[28:31],a[252:255],v[120:123],a[28:31]
s_waitcnt lgkmcnt(8)
ds_read_b64_tr_b16 a[252:253],v6 offset:24832
ds_read_b64_tr_b16 a[254:255],v6 offset:30976
v_mfma_f32_16x16x32_bf16 v[192:195],a[240:243],v[112:115],v[192:195]
buffer_load_dwordx4 v8,s[4:7],s20 offen offset:1024 lds
v_mfma_f32_16x16x32_bf16 v[240:243],a[240:243],v[116:119],v[240:243]
v_fma_f32 v52,v52,s36,v18
v_fma_f32 v53,v53,s36,v18
v_mfma_f32_16x16x32_bf16 a[32:35],a[240:243],v[120:123],a[32:35]
s_waitcnt lgkmcnt(7)
v_fma_f32 v54,v54,s36,v18
v_fma_f32 v55,v55,s36,v18
v_mfma_f32_16x16x32_bf16 v[196:199],a[244:247],v[112:115],v[196:199]
v_exp_f32 v36,v36
v_mfma_f32_16x16x32_bf16 v[244:247],a[244:247],v[116:119],v[244:247]
v_exp_f32 v37,v37
v_mfma_f32_16x16x32_bf16 a[36:39],a[244:247],v[120:123],a[36:39]
s_waitcnt lgkmcnt(3)
v_exp_f32 v38,v38
v_mfma_f32_16x16x32_bf16 v[200:203],a[248:251],v[112:115],v[200:203]
buffer_load_dwordx4 v9,s[4:7],s20 offen offset:2048 lds
v_mfma_f32_16x16x32_bf16 v[248:251],a[248:251],v[116:119],v[248:251]
s_add_u32 s20,s20,12288
v_exp_f32 v39,v39
v_mfma_f32_16x16x32_bf16 a[40:43],a[248:251],v[120:123],a[40:43]
s_add_u32 m0,s29,0
v_exp_f32 v44,v44
s_waitcnt lgkmcnt(0)
v_mfma_f32_16x16x32_bf16 v[204:207],a[252:255],v[112:115],v[204:207]
v_exp_f32 v45,v45
v_mfma_f32_16x16x32_bf16 v[252:255],a[252:255],v[116:119],v[252:255]
v_exp_f32 v46,v46
v_mfma_f32_16x16x32_bf16 a[44:47],a[252:255],v[120:123],a[44:47]
v_exp_f32 v47,v47
v_mfma_f32_16x16x32_bf16 v[64:67],a[192:195],a[96:99],0
v_exp_f32 v48,v48
v_mfma_f32_16x16x32_bf16 v[64:67],a[196:199],a[100:103],v[64:67]
v_exp_f32 v49,v49
v_mfma_f32_16x16x32_bf16 v[64:67],a[200:203],a[104:107],v[64:67]
v_exp_f32 v50,v50
v_mfma_f32_16x16x32_bf16 v[64:67],a[204:207],a[108:111],v[64:67]
buffer_load_dwordx4 v7,s[12:15],s28 offen offset:0 nt lds
v_mfma_f32_16x16x32_bf16 v[64:67],a[208:211],a[112:115],v[64:67]
v_exp_f32 v51,v51
v_mfma_f32_16x16x32_bf16 v[64:67],a[212:215],a[116:119],v[64:67]
v_exp_f32 v52,v52
v_mfma_f32_16x16x32_bf16 v[72:75],a[192:195],a[120:123],0
v_exp_f32 v53,v53
v_mfma_f32_16x16x32_bf16 v[72:75],a[196:199],a[124:127],v[72:75]
v_exp_f32 v54,v54
v_mfma_f32_16x16x32_bf16 v[72:75],a[200:203],a[128:131],v[72:75]
v_exp_f32 v55,v55
v_mfma_f32_16x16x32_bf16 v[72:75],a[204:207],a[132:135],v[72:75]
v_cvt_pk_bf16_f32 v98,v36,v37
v_cvt_pk_bf16_f32 v99,v38,v39
v_mfma_f32_16x16x32_bf16 v[72:75],a[208:211],a[136:139],v[72:75]
v_cvt_pk_bf16_f32 v102,v44,v45
v_cvt_pk_bf16_f32 v103,v46,v47
v_mfma_f32_16x16x32_bf16 v[128:131],v[24:27],v[96:99],v[128:131]
v_cvt_pk_bf16_f32 v104,v48,v49
v_cvt_pk_bf16_f32 v105,v50,v51
v_mfma_f32_16x16x32_bf16 v[132:135],v[24:27],v[100:103],v[132:135]
buffer_load_dwordx4 v8,s[12:15],s28 offen offset:1024 nt lds
v_mfma_f32_16x16x32_bf16 v[72:75],a[212:215],a[140:143],v[72:75]
v_cvt_pk_bf16_f32 v106,v52,v53
v_cvt_pk_bf16_f32 v107,v54,v55
v_mfma_f32_16x16x32_bf16 v[80:83],a[192:195],a[144:147],0
v_fma_f32 v64,v64,s36,v16
v_fma_f32 v65,v65,s36,v16
v_mfma_f32_16x16x32_bf16 v[136:139],v[24:27],v[104:107],v[136:139]
v_fma_f32 v66,v66,s36,v16
v_fma_f32 v67,v67,s36,v16
v_mfma_f32_16x16x32_bf16 v[80:83],a[196:199],a[148:151],v[80:83]
v_fma_f32 v72,v72,s36,v17
v_fma_f32 v73,v73,s36,v17
v_mfma_f32_16x16x32_bf16 v[80:83],a[200:203],a[152:155],v[80:83]
v_fma_f32 v74,v74,s36,v17
v_fma_f32 v75,v75,s36,v17
v_mfma_f32_16x16x32_bf16 v[80:83],a[204:207],a[156:159],v[80:83]
v_exp_f32 v64,v64
v_mfma_f32_16x16x32_bf16 v[80:83],a[208:211],a[160:163],v[80:83]
v_exp_f32 v65,v65
v_mfma_f32_16x16x32_bf16 v[80:83],a[212:215],a[164:167],v[80:83]
buffer_load_dwordx4 v9,s[12:15],s28 offen offset:2048 nt lds
v_mfma_f32_16x16x32_bf16 v[68:71],a[216:219],a[96:99],0
s_add_u32 s28,s28,3072
v_exp_f32 v66,v66
v_mfma_f32_16x16x32_bf16 v[68:71],a[220:223],a[100:103],v[68:71]
s_add_u32 s29,s29,3072
v_exp_f32 v67,v67
v_mfma_f32_16x16x32_bf16 v[68:71],a[224:227],a[104:107],v[68:71]
v_exp_f32 v72,v72
s_waitcnt vmcnt(12)
s_barrier
v_mfma_f32_16x16x32_bf16 v[68:71],a[228:231],a[108:111],v[68:71]
v_exp_f32 v73,v73
v_mfma_f32_16x16x32_bf16 v[68:71],a[232:235],a[112:115],v[68:71]
ds_read_b64_tr_b16 a[240:241],v3 offset:0
ds_read_b64_tr_b16 a[242:243],v3 offset:6144
v_mfma_f32_16x16x32_bf16 v[68:71],a[236:239],a[116:119],v[68:71]
v_exp_f32 v74,v74
v_mfma_f32_16x16x32_bf16 v[76:79],a[216:219],a[120:123],0
ds_read_b64_tr_b16 a[244:245],v4 offset:0
ds_read_b64_tr_b16 a[246:247],v4 offset:6144
v_mfma_f32_16x16x32_bf16 v[76:79],a[220:223],a[124:127],v[76:79]
ds_read_b64_tr_b16 a[248:249],v5 offset:0
ds_read_b64_tr_b16 a[250:251],v5 offset:6144
v_mfma_f32_16x16x32_bf16 v[76:79],a[224:227],a[128:131],v[76:79]
v_exp_f32 v75,v75
v_mfma_f32_16x16x32_bf16 v[76:79],a[228:231],a[132:135],v[76:79]
ds_read_b64_tr_b16 a[252:253],v6 offset:0
ds_read_b64_tr_b16 a[254:255],v6 offset:6144
v_mfma_f32_16x16x32_bf16 v[76:79],a[232:235],a[136:139],v[76:79]
v_cvt_pk_bf16_f32 v112,v64,v65
v_cvt_pk_bf16_f32 v113,v66,v67
v_mfma_f32_16x16x32_bf16 v[76:79],a[236:239],a[140:143],v[76:79]
v_cvt_pk_bf16_f32 v116,v72,v73
v_cvt_pk_bf16_f32 v117,v74,v75
v_mfma_f32_16x16x32_bf16 v[84:87],a[216:219],a[144:147],0
v_mfma_f32_16x16x32_bf16 v[84:87],a[220:223],a[148:151],v[84:87]
v_mfma_f32_16x16x32_bf16 v[84:87],a[224:227],a[152:155],v[84:87]
v_mfma_f32_16x16x32_bf16 v[84:87],a[228:231],a[156:159],v[84:87]
v_mfma_f32_16x16x32_bf16 v[84:87],a[232:235],a[160:163],v[84:87]
v_mfma_f32_16x16x32_bf16 v[84:87],a[236:239],a[164:167],v[84:87]
s_waitcnt lgkmcnt(2)
v_mfma_f32_16x16x32_bf16 v[160:163],a[240:243],v[96:99],v[160:163]
s_add_u32 m0,s23,24576
ds_read_b128 a[192:195],v1 offset:24576
v_fma_f32 v68,v68,s36,v16
v_mfma_f32_16x16x32_bf16 v[208:211],a[240:243],v[100:103],v[208:211]
buffer_load_dwordx4 v7,s[8:11],s21 offen offset:0 lds
v_mfma_f32_16x16x32_bf16 a[0:3],a[240:243],v[104:107],a[0:3]
ds_read_b64_tr_b16 a[240:241],v3 offset:128
ds_read_b64_tr_b16 a[242:243],v3 offset:6272
v_mfma_f32_16x16x32_bf16 v[164:167],a[244:247],v[96:99],v[164:167]
ds_read_b128 a[196:199],v2 offset:24576
v_fma_f32 v69,v69,s36,v16
v_mfma_f32_16x16x32_bf16 v[212:215],a[244:247],v[100:103],v[212:215]
ds_read_b128 a[200:203],v1 offset:24704
v_fma_f32 v70,v70,s36,v16
v_mfma_f32_16x16x32_bf16 a[4:7],a[244:247],v[104:107],a[4:7]
ds_read_b64_tr_b16 a[244:245],v4 offset:128
ds_read_b64_tr_b16 a[246:247],v4 offset:6272
v_mfma_f32_16x16x32_bf16 v[168:171],a[248:251],v[96:99],v[168:171]
ds_read_b128 a[204:207],v2 offset:24704
v_fma_f32 v71,v71,s36,v16
v_mfma_f32_16x16x32_bf16 v[216:219],a[248:251],v[100:103],v[216:219]
buffer_load_dwordx4 v8,s[8:11],s21 offen offset:1024 lds
v_mfma_f32_16x16x32_bf16 a[8:11],a[248:251],v[104:107],a[8:11]
s_waitcnt lgkmcnt(7)
ds_read_b64_tr_b16 a[248:249],v5 offset:128
ds_read_b64_tr_b16 a[250:251],v5 offset:6272
v_mfma_f32_16x16x32_bf16 v[172:175],a[252:255],v[96:99],v[172:175]
ds_read_b128 a[208:211],v1 offset:24832
v_fma_f32 v76,v76,s36,v17
v_mfma_f32_16x16x32_bf16 v[220:223],a[252:255],v[100:103],v[220:223]
ds_read_b128 a[212:215],v2 offset:24832
v_fma_f32 v77,v77,s36,v17
v_mfma_f32_16x16x32_bf16 a[12:15],a[252:255],v[104:107],a[12:15]
s_waitcnt lgkmcnt(8)
ds_read_b64_tr_b16 a[252:253],v6 offset:128
ds_read_b64_tr_b16 a[254:255],v6 offset:6272
v_mfma_f32_16x16x32_bf16 v[176:179],a[240:243],v[96:99],v[176:179]
buffer_load_dwordx4 v9,s[8:11],s21 offen offset:2048 lds
v_mfma_f32_16x16x32_bf16 v[224:227],a[240:243],v[100:103],v[224:227]
s_add_u32 s21,s21,12288
ds_read_b128 a[216:219],v1 offset:30720
v_fma_f32 v78,v78,s36,v17
v_mfma_f32_16x16x32_bf16 a[16:19],a[240:243],v[104:107],a[16:19]
s_mov_b32 m0,s25
ds_read_b64_tr_b16 a[240:241],v3 offset:256
ds_read_b64_tr_b16 a[242:243],v3 offset:6400
s_waitcnt lgkmcnt(9)
v_mfma_f32_16x16x32_bf16 v[180:183],a[244:247],v[96:99],v[180:183]
ds_read_b128 a[220:223],v2 offset:30720
v_fma_f32 v79,v79,s36,v17
v_mfma_f32_16x16x32_bf16 v[228:231],a[244:247],v[100:103],v[228:231]
ds_read_b128 a[224:227],v1 offset:30848
v_fma_f32 v80,v80,s36,v18
v_mfma_f32_16x16x32_bf16 a[20:23],a[244:247],v[104:107],a[20:23]
s_waitcnt lgkmcnt(8)
ds_read_b64_tr_b16 a[244:245],v4 offset:256
ds_read_b64_tr_b16 a[246:247],v4 offset:6400
v_mfma_f32_16x16x32_bf16 v[184:187],a[248:251],v[96:99],v[184:187]
buffer_load_dwordx4 v7,s[4:7],s20 offen offset:0 lds
v_mfma_f32_16x16x32_bf16 v[232:235],a[248:251],v[100:103],v[232:235]
ds_read_b128 a[228:231],v2 offset:30848
v_fma_f32 v81,v81,s36,v18
v_mfma_f32_16x16x32_bf16 a[24:27],a[248:251],v[104:107],a[24:27]
s_waitcnt lgkmcnt(8)
ds_read_b64_tr_b16 a[248:249],v5 offset:256
ds_read_b64_tr_b16 a[250:251],v5 offset:6400
v_mfma_f32_16x16x32_bf16 v[188:191],a[252:255],v[96:99],v[188:191]
ds_read_b128 a[232:235],v1 offset:30976
v_fma_f32 v82,v82,s36,v18
v_mfma_f32_16x16x32_bf16 v[236:239],a[252:255],v[100:103],v[236:239]
ds_read_b128 a[236:239],v2 offset:30976
v_fma_f32 v83,v83,s36,v18
v_mfma_f32_16x16x32_bf16 a[28:31],a[252:255],v[104:107],a[28:31]
s_waitcnt lgkmcnt(8)
ds_read_b64_tr_b16 a[252:253],v6 offset:256
ds_read_b64_tr_b16 a[254:255],v6 offset:6400
v_mfma_f32_16x16x32_bf16 v[192:195],a[240:243],v[96:99],v[192:195]
buffer_load_dwordx4 v8,s[4:7],s20 offen offset:1024 lds
v_mfma_f32_16x16x32_bf16 v[240:243],a[240:243],v[100:103],v[240:243]
ds_read_b128 v[152:155],v11 offset:6144
v_fma_f32 v84,v84,s36,v18
v_mfma_f32_16x16x32_bf16 a[32:35],a[240:243],v[104:107],a[32:35]
s_waitcnt lgkmcnt(8)
v_fma_f32 v85,v85,s36,v18
v_fma_f32 v86,v86,s36,v18
v_mfma_f32_16x16x32_bf16 v[196:199],a[244:247],v[96:99],v[196:199]
v_fma_f32 v87,v87,s36,v18
v_mfma_f32_16x16x32_bf16 v[244:247],a[244:247],v[100:103],v[244:247]
v_exp_f32 v68,v68
v_mfma_f32_16x16x32_bf16 a[36:39],a[244:247],v[104:107],a[36:39]
s_waitcnt lgkmcnt(4)
v_exp_f32 v69,v69
v_mfma_f32_16x16x32_bf16 v[200:203],a[248:251],v[96:99],v[200:203]
buffer_load_dwordx4 v9,s[4:7],s20 offen offset:2048 lds
v_mfma_f32_16x16x32_bf16 v[248:251],a[248:251],v[100:103],v[248:251]
s_add_u32 s20,s20,12288
v_exp_f32 v70,v70
v_mfma_f32_16x16x32_bf16 a[40:43],a[248:251],v[104:107],a[40:43]
s_waitcnt lgkmcnt(1)
ds_read_b128 v[156:159],v23 offset:6144
v_cvt_pk_bf16_f32 v114,v68,v69
v_mfma_f32_16x16x32_bf16 v[204:207],a[252:255],v[96:99],v[204:207]
v_exp_f32 v71,v71
v_mfma_f32_16x16x32_bf16 v[252:255],a[252:255],v[100:103],v[252:255]
v_exp_f32 v76,v76
v_mfma_f32_16x16x32_bf16 a[44:47],a[252:255],v[104:107],a[44:47]
v_exp_f32 v77,v77
v_mfma_f32_16x16x32_bf16 v[32:35],a[192:195],a[96:99],0
v_exp_f32 v78,v78
v_mfma_f32_16x16x32_bf16 v[32:35],a[196:199],a[100:103],v[32:35]
v_exp_f32 v79,v79
v_mfma_f32_16x16x32_bf16 v[32:35],a[200:203],a[104:107],v[32:35]
v_exp_f32 v80,v80
v_mfma_f32_16x16x32_bf16 v[32:35],a[204:207],a[108:111],v[32:35]
s_waitcnt lgkmcnt(1)
buffer_store_dwordx4 v[152:155],v0,s[16:19],s27 offen offset:0 nt
v_mfma_f32_16x16x32_bf16 v[32:35],a[208:211],a[112:115],v[32:35]
v_exp_f32 v81,v81
v_mfma_f32_16x16x32_bf16 v[32:35],a[212:215],a[116:119],v[32:35]
v_exp_f32 v82,v82
v_mfma_f32_16x16x32_bf16 v[40:43],a[192:195],a[120:123],0
ds_read_b128 v[152:155],v31 offset:6144
v_cvt_pk_bf16_f32 v115,v70,v71
v_mfma_f32_16x16x32_bf16 v[40:43],a[196:199],a[124:127],v[40:43]
v_exp_f32 v83,v83
v_mfma_f32_16x16x32_bf16 v[128:131],v[24:27],v[112:115],v[128:131]
v_exp_f32 v84,v84
v_mfma_f32_16x16x32_bf16 v[40:43],a[200:203],a[128:131],v[40:43]
v_exp_f32 v85,v85
v_mfma_f32_16x16x32_bf16 v[40:43],a[204:207],a[132:135],v[40:43]
v_exp_f32 v86,v86
v_mfma_f32_16x16x32_bf16 v[40:43],a[208:211],a[136:139],v[40:43]
v_exp_f32 v87,v87
v_mfma_f32_16x16x32_bf16 v[40:43],a[212:215],a[140:143],v[40:43]
s_waitcnt lgkmcnt(1)
buffer_store_dwordx4 v[156:159],v0,s[16:19],s27 offen offset:1024 nt
v_mfma_f32_16x16x32_bf16 v[48:51],a[192:195],a[144:147],0
v_cvt_pk_bf16_f32 v118,v76,v77
v_cvt_pk_bf16_f32 v119,v78,v79
v_mfma_f32_16x16x32_bf16 v[48:51],a[196:199],a[148:151],v[48:51]
v_cvt_pk_bf16_f32 v120,v80,v81
v_cvt_pk_bf16_f32 v121,v82,v83
v_mfma_f32_16x16x32_bf16 v[132:135],v[24:27],v[116:119],v[132:135]
v_cvt_pk_bf16_f32 v122,v84,v85
v_cvt_pk_bf16_f32 v123,v86,v87
v_mfma_f32_16x16x32_bf16 v[48:51],a[200:203],a[152:155],v[48:51]
v_fma_f32 v32,v32,s36,v16
v_fma_f32 v33,v33,s36,v16
v_mfma_f32_16x16x32_bf16 v[136:139],v[24:27],v[120:123],v[136:139]
v_fma_f32 v34,v34,s36,v16
v_fma_f32 v35,v35,s36,v16
v_mfma_f32_16x16x32_bf16 v[48:51],a[204:207],a[156:159],v[48:51]
v_fma_f32 v40,v40,s36,v17
v_fma_f32 v41,v41,s36,v17
v_mfma_f32_16x16x32_bf16 v[48:51],a[208:211],a[160:163],v[48:51]
v_fma_f32 v42,v42,s36,v17
v_fma_f32 v43,v43,s36,v17
v_mfma_f32_16x16x32_bf16 v[48:51],a[212:215],a[164:167],v[48:51]
s_waitcnt lgkmcnt(0)
buffer_store_dwordx4 v[152:155],v0,s[16:19],s27 offen offset:2048 nt
v_mfma_f32_16x16x32_bf16 v[36:39],a[216:219],a[96:99],0
s_add_u32 s27,s27,3072
v_exp_f32 v32,v32
v_mfma_f32_16x16x32_bf16 v[36:39],a[220:223],a[100:103],v[36:39]
v_exp_f32 v33,v33
v_mfma_f32_16x16x32_bf16 v[36:39],a[224:227],a[104:107],v[36:39]
v_exp_f32 v34,v34
s_waitcnt vmcnt(12)
s_barrier
v_mfma_f32_16x16x32_bf16 v[36:39],a[228:231],a[108:111],v[36:39]
v_exp_f32 v35,v35
v_mfma_f32_16x16x32_bf16 v[36:39],a[232:235],a[112:115],v[36:39]
ds_read_b64_tr_b16 a[240:241],v3 offset:12288
ds_read_b64_tr_b16 a[242:243],v3 offset:18432
v_mfma_f32_16x16x32_bf16 v[36:39],a[236:239],a[116:119],v[36:39]
v_exp_f32 v40,v40
v_mfma_f32_16x16x32_bf16 v[44:47],a[216:219],a[120:123],0
ds_read_b64_tr_b16 a[244:245],v4 offset:12288
ds_read_b64_tr_b16 a[246:247],v4 offset:18432
v_mfma_f32_16x16x32_bf16 v[44:47],a[220:223],a[124:127],v[44:47]
ds_read_b64_tr_b16 a[248:249],v5 offset:12288
ds_read_b64_tr_b16 a[250:251],v5 offset:18432
v_mfma_f32_16x16x32_bf16 v[44:47],a[224:227],a[128:131],v[44:47]
v_exp_f32 v41,v41
v_mfma_f32_16x16x32_bf16 v[44:47],a[228:231],a[132:135],v[44:47]
ds_read_b64_tr_b16 a[252:253],v6 offset:12288
ds_read_b64_tr_b16 a[254:255],v6 offset:18432
v_mfma_f32_16x16x32_bf16 v[44:47],a[232:235],a[136:139],v[44:47]
v_exp_f32 v42,v42
v_mfma_f32_16x16x32_bf16 v[44:47],a[236:239],a[140:143],v[44:47]
v_exp_f32 v43,v43
v_mfma_f32_16x16x32_bf16 v[52:55],a[216:219],a[144:147],0
v_cvt_pk_bf16_f32 v96,v32,v33
v_cvt_pk_bf16_f32 v97,v34,v35
v_mfma_f32_16x16x32_bf16 v[52:55],a[220:223],a[148:151],v[52:55]
v_cvt_pk_bf16_f32 v100,v40,v41
v_cvt_pk_bf16_f32 v101,v42,v43
v_mfma_f32_16x16x32_bf16 v[52:55],a[224:227],a[152:155],v[52:55]
v_mfma_f32_16x16x32_bf16 v[52:55],a[228:231],a[156:159],v[52:55]
v_mfma_f32_16x16x32_bf16 v[52:55],a[232:235],a[160:163],v[52:55]
v_mfma_f32_16x16x32_bf16 v[52:55],a[236:239],a[164:167],v[52:55]
s_waitcnt lgkmcnt(2)
v_mfma_f32_16x16x32_bf16 v[160:163],a[240:243],v[112:115],v[160:163]
s_add_u32 m0,s23,0
ds_read_b128 a[192:195],v1 offset:0
v_fma_f32 v36,v36,s36,v16
v_mfma_f32_16x16x32_bf16 v[208:211],a[240:243],v[116:119],v[208:211]
buffer_load_dwordx4 v7,s[8:11],s21 offen offset:0 lds
v_mfma_f32_16x16x32_bf16 a[0:3],a[240:243],v[120:123],a[0:3]
ds_read_b64_tr_b16 a[240:241],v3 offset:12416
ds_read_b64_tr_b16 a[242:243],v3 offset:18560
v_mfma_f32_16x16x32_bf16 v[164:167],a[244:247],v[112:115],v[164:167]
ds_read_b128 a[196:199],v2 offset:0
v_fma_f32 v37,v37,s36,v16
v_mfma_f32_16x16x32_bf16 v[212:215],a[244:247],v[116:119],v[212:215]
ds_read_b128 a[200:203],v1 offset:128
v_fma_f32 v38,v38,s36,v16
v_mfma_f32_16x16x32_bf16 a[4:7],a[244:247],v[120:123],a[4:7]
ds_read_b64_tr_b16 a[244:245],v4 offset:12416
ds_read_b64_tr_b16 a[246:247],v4 offset:18560
v_mfma_f32_16x16x32_bf16 v[168:171],a[248:251],v[112:115],v[168:171]
ds_read_b128 a[204:207],v2 offset:128
v_fma_f32 v39,v39,s36,v16
v_mfma_f32_16x16x32_bf16 v[216:219],a[248:251],v[116:119],v[216:219]
buffer_load_dwordx4 v8,s[8:11],s21 offen offset:1024 lds
v_mfma_f32_16x16x32_bf16 a[8:11],a[248:251],v[120:123],a[8:11]
s_waitcnt lgkmcnt(7)
ds_read_b64_tr_b16 a[248:249],v5 offset:12416
ds_read_b64_tr_b16 a[250:251],v5 offset:18560
v_mfma_f32_16x16x32_bf16 v[172:175],a[252:255],v[112:115],v[172:175]
ds_read_b128 a[208:211],v1 offset:256
v_fma_f32 v44,v44,s36,v17
v_mfma_f32_16x16x32_bf16 v[220:223],a[252:255],v[116:119],v[220:223]
ds_read_b128 a[212:215],v2 offset:256
v_fma_f32 v45,v45,s36,v17
v_mfma_f32_16x16x32_bf16 a[12:15],a[252:255],v[120:123],a[12:15]
s_waitcnt lgkmcnt(8)
ds_read_b64_tr_b16 a[252:253],v6 offset:12416
ds_read_b64_tr_b16 a[254:255],v6 offset:18560
v_mfma_f32_16x16x32_bf16 v[176:179],a[240:243],v[112:115],v[176:179]
buffer_load_dwordx4 v9,s[8:11],s21 offen offset:2048 lds
v_mfma_f32_16x16x32_bf16 v[224:227],a[240:243],v[116:119],v[224:227]
s_add_u32 s21,s21,12288
ds_read_b128 a[216:219],v1 offset:6144
v_fma_f32 v46,v46,s36,v17
v_mfma_f32_16x16x32_bf16 a[16:19],a[240:243],v[120:123],a[16:19]
s_mov_b32 m0,s26
ds_read_b64_tr_b16 a[240:241],v3 offset:12544
ds_read_b64_tr_b16 a[242:243],v3 offset:18688
s_waitcnt lgkmcnt(9)
v_mfma_f32_16x16x32_bf16 v[180:183],a[244:247],v[112:115],v[180:183]
ds_read_b128 a[220:223],v2 offset:6144
v_fma_f32 v47,v47,s36,v17
v_mfma_f32_16x16x32_bf16 v[228:231],a[244:247],v[116:119],v[228:231]
ds_read_b128 a[224:227],v1 offset:6272
v_fma_f32 v48,v48,s36,v18
v_mfma_f32_16x16x32_bf16 a[20:23],a[244:247],v[120:123],a[20:23]
s_waitcnt lgkmcnt(8)
ds_read_b64_tr_b16 a[244:245],v4 offset:12544
ds_read_b64_tr_b16 a[246:247],v4 offset:18688
v_mfma_f32_16x16x32_bf16 v[184:187],a[248:251],v[112:115],v[184:187]
buffer_load_dwordx4 v7,s[4:7],s20 offen offset:0 lds
v_mfma_f32_16x16x32_bf16 v[232:235],a[248:251],v[116:119],v[232:235]
ds_read_b128 a[228:231],v2 offset:6272
v_fma_f32 v49,v49,s36,v18
v_mfma_f32_16x16x32_bf16 a[24:27],a[248:251],v[120:123],a[24:27]
s_waitcnt lgkmcnt(8)
ds_read_b64_tr_b16 a[248:249],v5 offset:12544
ds_read_b64_tr_b16 a[250:251],v5 offset:18688
v_mfma_f32_16x16x32_bf16 v[188:191],a[252:255],v[112:115],v[188:191]
ds_read_b128 a[232:235],v1 offset:6400
v_fma_f32 v50,v50,s36,v18
v_mfma_f32_16x16x32_bf16 v[236:239],a[252:255],v[116:119],v[236:239]
ds_read_b128 a[236:239],v2 offset:6400
v_fma_f32 v51,v51,s36,v18
v_mfma_f32_16x16x32_bf16 a[28:31],a[252:255],v[120:123],a[28:31]
s_waitcnt lgkmcnt(8)
ds_read_b64_tr_b16 a[252:253],v6 offset:12544
ds_read_b64_tr_b16 a[254:255],v6 offset:18688
v_mfma_f32_16x16x32_bf16 v[192:195],a[240:243],v[112:115],v[192:195]
buffer_load_dwordx4 v8,s[4:7],s20 offen offset:1024 lds
v_mfma_f32_16x16x32_bf16 v[240:243],a[240:243],v[116:119],v[240:243]
v_fma_f32 v52,v52,s36,v18
v_fma_f32 v53,v53,s36,v18
v_mfma_f32_16x16x32_bf16 a[32:35],a[240:243],v[120:123],a[32:35]
s_waitcnt lgkmcnt(7)
v_fma_f32 v54,v54,s36,v18
v_fma_f32 v55,v55,s36,v18
v_mfma_f32_16x16x32_bf16 v[196:199],a[244:247],v[112:115],v[196:199]
v_exp_f32 v36,v36
v_mfma_f32_16x16x32_bf16 v[244:247],a[244:247],v[116:119],v[244:247]
v_exp_f32 v37,v37
v_mfma_f32_16x16x32_bf16 a[36:39],a[244:247],v[120:123],a[36:39]
s_waitcnt lgkmcnt(3)
v_exp_f32 v38,v38
v_mfma_f32_16x16x32_bf16 v[200:203],a[248:251],v[112:115],v[200:203]
buffer_load_dwordx4 v9,s[4:7],s20 offen offset:2048 lds
v_mfma_f32_16x16x32_bf16 v[248:251],a[248:251],v[116:119],v[248:251]
s_add_u32 s20,s20,12288
v_exp_f32 v39,v39
v_mfma_f32_16x16x32_bf16 a[40:43],a[248:251],v[120:123],a[40:43]
s_add_u32 m0,s29,0
v_exp_f32 v44,v44
s_waitcnt lgkmcnt(0)
v_mfma_f32_16x16x32_bf16 v[204:207],a[252:255],v[112:115],v[204:207]
v_exp_f32 v45,v45
v_mfma_f32_16x16x32_bf16 v[252:255],a[252:255],v[116:119],v[252:255]
v_exp_f32 v46,v46
v_mfma_f32_16x16x32_bf16 a[44:47],a[252:255],v[120:123],a[44:47]
v_exp_f32 v47,v47
v_mfma_f32_16x16x32_bf16 v[64:67],a[192:195],a[96:99],0
v_exp_f32 v48,v48
v_mfma_f32_16x16x32_bf16 v[64:67],a[196:199],a[100:103],v[64:67]
v_exp_f32 v49,v49
v_mfma_f32_16x16x32_bf16 v[64:67],a[200:203],a[104:107],v[64:67]
v_exp_f32 v50,v50
v_mfma_f32_16x16x32_bf16 v[64:67],a[204:207],a[108:111],v[64:67]
buffer_load_dwordx4 v7,s[12:15],s28 offen offset:0 nt lds
v_mfma_f32_16x16x32_bf16 v[64:67],a[208:211],a[112:115],v[64:67]
v_exp_f32 v51,v51
v_mfma_f32_16x16x32_bf16 v[64:67],a[212:215],a[116:119],v[64:67]
v_exp_f32 v52,v52
v_mfma_f32_16x16x32_bf16 v[72:75],a[192:195],a[120:123],0
v_exp_f32 v53,v53
v_mfma_f32_16x16x32_bf16 v[72:75],a[196:199],a[124:127],v[72:75]
v_exp_f32 v54,v54
v_mfma_f32_16x16x32_bf16 v[72:75],a[200:203],a[128:131],v[72:75]
v_exp_f32 v55,v55
v_mfma_f32_16x16x32_bf16 v[72:75],a[204:207],a[132:135],v[72:75]
v_cvt_pk_bf16_f32 v98,v36,v37
v_cvt_pk_bf16_f32 v99,v38,v39
v_mfma_f32_16x16x32_bf16 v[72:75],a[208:211],a[136:139],v[72:75]
v_cvt_pk_bf16_f32 v102,v44,v45
v_cvt_pk_bf16_f32 v103,v46,v47
v_mfma_f32_16x16x32_bf16 v[128:131],v[24:27],v[96:99],v[128:131]
v_cvt_pk_bf16_f32 v104,v48,v49
v_cvt_pk_bf16_f32 v105,v50,v51
v_mfma_f32_16x16x32_bf16 v[132:135],v[24:27],v[100:103],v[132:135]
buffer_load_dwordx4 v8,s[12:15],s28 offen offset:1024 nt lds
v_mfma_f32_16x16x32_bf16 v[72:75],a[212:215],a[140:143],v[72:75]
v_cvt_pk_bf16_f32 v106,v52,v53
v_cvt_pk_bf16_f32 v107,v54,v55
v_mfma_f32_16x16x32_bf16 v[80:83],a[192:195],a[144:147],0
v_fma_f32 v64,v64,s36,v16
v_fma_f32 v65,v65,s36,v16
v_mfma_f32_16x16x32_bf16 v[136:139],v[24:27],v[104:107],v[136:139]
v_fma_f32 v66,v66,s36,v16
v_fma_f32 v67,v67,s36,v16
v_mfma_f32_16x16x32_bf16 v[80:83],a[196:199],a[148:151],v[80:83]
v_fma_f32 v72,v72,s36,v17
v_fma_f32 v73,v73,s36,v17
v_mfma_f32_16x16x32_bf16 v[80:83],a[200:203],a[152:155],v[80:83]
v_fma_f32 v74,v74,s36,v17
v_fma_f32 v75,v75,s36,v17
v_mfma_f32_16x16x32_bf16 v[80:83],a[204:207],a[156:159],v[80:83]
v_exp_f32 v64,v64
v_mfma_f32_16x16x32_bf16 v[80:83],a[208:211],a[160:163],v[80:83]
v_exp_f32 v65,v65
v_mfma_f32_16x16x32_bf16 v[80:83],a[212:215],a[164:167],v[80:83]
buffer_load_dwordx4 v9,s[12:15],s28 offen offset:2048 nt lds
v_mfma_f32_16x16x32_bf16 v[68:71],a[216:219],a[96:99],0
s_add_u32 s28,s28,3072
v_exp_f32 v66,v66
v_mfma_f32_16x16x32_bf16 v[68:71],a[220:223],a[100:103],v[68:71]
s_add_u32 s29,s29,3072
s_add_u32 s25,s24,18432
s_add_u32 s26,s22,12288
s_add_u32 s38,s38,1
s_cmp_lt_u32 s38,2
v_mfma_f32_16x16x32_bf16 v[68:71],a[224:227],a[104:107],v[68:71]
v_exp_f32 v67,v67
s_waitcnt vmcnt(12)
s_barrier
v_mfma_f32_16x16x32_bf16 v[68:71],a[228:231],a[108:111],v[68:71]
v_exp_f32 v72,v72
v_mfma_f32_16x16x32_bf16 v[68:71],a[232:235],a[112:115],v[68:71]
ds_read_b64_tr_b16 a[240:241],v3 offset:24576
ds_read_b64_tr_b16 a[242:243],v3 offset:30720
v_mfma_f32_16x16x32_bf16 v[68:71],a[236:239],a[116:119],v[68:71]
v_exp_f32 v73,v73
v_mfma_f32_16x16x32_bf16 v[76:79],a[216:219],a[120:123],0
ds_read_b64_tr_b16 a[244:245],v4 offset:24576
ds_read_b64_tr_b16 a[246:247],v4 offset:30720
v_mfma_f32_16x16x32_bf16 v[76:79],a[220:223],a[124:127],v[76:79]
ds_read_b64_tr_b16 a[248:249],v5 offset:24576
ds_read_b64_tr_b16 a[250:251],v5 offset:30720
v_mfma_f32_16x16x32_bf16 v[76:79],a[224:227],a[128:131],v[76:79]
v_exp_f32 v74,v74
v_mfma_f32_16x16x32_bf16 v[76:79],a[228:231],a[132:135],v[76:79]
ds_read_b64_tr_b16 a[252:253],v6 offset:24576
ds_read_b64_tr_b16 a[254:255],v6 offset:30720
v_mfma_f32_16x16x32_bf16 v[76:79],a[232:235],a[136:139],v[76:79]
v_exp_f32 v75,v75
v_mfma_f32_16x16x32_bf16 v[76:79],a[236:239],a[140:143],v[76:79]
v_cvt_pk_bf16_f32 v112,v64,v65
v_cvt_pk_bf16_f32 v113,v66,v67
v_mfma_f32_16x16x32_bf16 v[84:87],a[216:219],a[144:147],0
v_cvt_pk_bf16_f32 v116,v72,v73
v_cvt_pk_bf16_f32 v117,v74,v75
v_mfma_f32_16x16x32_bf16 v[84:87],a[220:223],a[148:151],v[84:87]
v_add_u32 v11,9216,v11
v_add_u32 v23,9216,v23
v_mfma_f32_16x16x32_bf16 v[84:87],a[224:227],a[152:155],v[84:87]
v_add_u32 v31,9216,v31
v_mfma_f32_16x16x32_bf16 v[84:87],a[228:231],a[156:159],v[84:87]
v_mfma_f32_16x16x32_bf16 v[84:87],a[232:235],a[160:163],v[84:87]
v_mfma_f32_16x16x32_bf16 v[84:87],a[236:239],a[164:167],v[84:87]
s_cbranch_scc1 L_loop3w0
s_cmp_ge_u32 s69,8
s_cbranch_scc1 L_end3
s_cmp_eq_u32 s40,0
s_cbranch_scc1 L_tr33
s_branch L_tr34
.p2align 6
L_loop3w1:
s_waitcnt lgkmcnt(4)
v_mfma_f32_16x16x32_bf16 v[160:163],a[240:243],v[96:99],v[160:163]
s_add_u32 m0,s23,12288
ds_read_b128 a[192:195],v1 offset:12288
v_fma_f32 v68,v68,s36,v16
v_mfma_f32_16x16x32_bf16 v[208:211],a[240:243],v[100:103],v[208:211]
buffer_load_dwordx4 v7,s[8:11],s21 offen offset:0 lds
v_mfma_f32_16x16x32_bf16 a[0:3],a[240:243],v[104:107],a[0:3]
ds_read_b64_tr_b16 a[240:241],v3 offset:24704
ds_read_b64_tr_b16 a[242:243],v3 offset:30848
v_mfma_f32_16x16x32_bf16 v[164:167],a[244:247],v[96:99],v[164:167]
ds_read_b128 a[196:199],v2 offset:12288
v_fma_f32 v69,v69,s36,v16
v_mfma_f32_16x16x32_bf16 v[212:215],a[244:247],v[100:103],v[212:215]
ds_read_b128 a[200:203],v1 offset:12416
v_fma_f32 v70,v70,s36,v16
v_mfma_f32_16x16x32_bf16 a[4:7],a[244:247],v[104:107],a[4:7]
s_waitcnt lgkmcnt(5)
ds_read_b64_tr_b16 a[244:245],v4 offset:24704
ds_read_b64_tr_b16 a[246:247],v4 offset:30848
v_mfma_f32_16x16x32_bf16 v[168:171],a[248:251],v[96:99],v[168:171]
ds_read_b128 a[204:207],v2 offset:12416
v_fma_f32 v71,v71,s36,v16
v_mfma_f32_16x16x32_bf16 v[216:219],a[248:251],v[100:103],v[216:219]
buffer_load_dwordx4 v8,s[8:11],s21 offen offset:1024 lds
v_mfma_f32_16x16x32_bf16 a[8:11],a[248:251],v[104:107],a[8:11]
ds_read_b64_tr_b16 a[248:249],v5 offset:24704
ds_read_b64_tr_b16 a[250:251],v5 offset:30848
v_mfma_f32_16x16x32_bf16 v[172:175],a[252:255],v[96:99],v[172:175]
ds_read_b128 a[208:211],v1 offset:12544
v_fma_f32 v76,v76,s36,v17
v_mfma_f32_16x16x32_bf16 v[220:223],a[252:255],v[100:103],v[220:223]
ds_read_b128 a[212:215],v2 offset:12544
v_fma_f32 v77,v77,s36,v17
v_mfma_f32_16x16x32_bf16 a[12:15],a[252:255],v[104:107],a[12:15]
s_waitcnt lgkmcnt(8)
ds_read_b64_tr_b16 a[252:253],v6 offset:24704
ds_read_b64_tr_b16 a[254:255],v6 offset:30848
v_mfma_f32_16x16x32_bf16 v[176:179],a[240:243],v[96:99],v[176:179]
buffer_load_dwordx4 v9,s[8:11],s21 offen offset:2048 lds
v_mfma_f32_16x16x32_bf16 v[224:227],a[240:243],v[100:103],v[224:227]
s_add_u32 s21,s21,12288
ds_read_b128 a[216:219],v1 offset:18432
v_fma_f32 v78,v78,s36,v17
v_mfma_f32_16x16x32_bf16 a[16:19],a[240:243],v[104:107],a[16:19]
s_add_u32 m0,s22,0
ds_read_b64_tr_b16 a[240:241],v3 offset:24832
ds_read_b64_tr_b16 a[242:243],v3 offset:30976
s_waitcnt lgkmcnt(9)
v_mfma_f32_16x16x32_bf16 v[180:183],a[244:247],v[96:99],v[180:183]
ds_read_b128 a[220:223],v2 offset:18432
v_fma_f32 v79,v79,s36,v17
v_mfma_f32_16x16x32_bf16 v[228:231],a[244:247],v[100:103],v[228:231]
ds_read_b128 a[224:227],v1 offset:18560
v_fma_f32 v80,v80,s36,v18
v_mfma_f32_16x16x32_bf16 a[20:23],a[244:247],v[104:107],a[20:23]
s_waitcnt lgkmcnt(8)
ds_read_b64_tr_b16 a[244:245],v4 offset:24832
ds_read_b64_tr_b16 a[246:247],v4 offset:30976
v_mfma_f32_16x16x32_bf16 v[184:187],a[248:251],v[96:99],v[184:187]
buffer_load_dwordx4 v7,s[4:7],s20 offen offset:0 lds
v_mfma_f32_16x16x32_bf16 v[232:235],a[248:251],v[100:103],v[232:235]
ds_read_b128 a[228:231],v2 offset:18560
v_fma_f32 v81,v81,s36,v18
v_mfma_f32_16x16x32_bf16 a[24:27],a[248:251],v[104:107],a[24:27]
s_waitcnt lgkmcnt(8)
ds_read_b64_tr_b16 a[248:249],v5 offset:24832
ds_read_b64_tr_b16 a[250:251],v5 offset:30976
v_mfma_f32_16x16x32_bf16 v[188:191],a[252:255],v[96:99],v[188:191]
ds_read_b128 a[232:235],v1 offset:18688
v_fma_f32 v82,v82,s36,v18
v_mfma_f32_16x16x32_bf16 v[236:239],a[252:255],v[100:103],v[236:239]
ds_read_b128 a[236:239],v2 offset:18688
v_fma_f32 v83,v83,s36,v18
v_mfma_f32_16x16x32_bf16 a[28:31],a[252:255],v[104:107],a[28:31]
s_waitcnt lgkmcnt(8)
ds_read_b64_tr_b16 a[252:253],v6 offset:24832
ds_read_b64_tr_b16 a[254:255],v6 offset:30976
v_mfma_f32_16x16x32_bf16 v[192:195],a[240:243],v[96:99],v[192:195]
buffer_load_dwordx4 v8,s[4:7],s20 offen offset:1024 lds
v_mfma_f32_16x16x32_bf16 v[240:243],a[240:243],v[100:103],v[240:243]
ds_read_b128 v[156:159],v11 offset:0
v_fma_f32 v84,v84,s36,v18
v_mfma_f32_16x16x32_bf16 a[32:35],a[240:243],v[104:107],a[32:35]
s_waitcnt lgkmcnt(8)
v_fma_f32 v85,v85,s36,v18
v_fma_f32 v86,v86,s36,v18
v_mfma_f32_16x16x32_bf16 v[196:199],a[244:247],v[96:99],v[196:199]
v_fma_f32 v87,v87,s36,v18
v_mfma_f32_16x16x32_bf16 v[244:247],a[244:247],v[100:103],v[244:247]
v_exp_f32 v68,v68
v_mfma_f32_16x16x32_bf16 a[36:39],a[244:247],v[104:107],a[36:39]
s_waitcnt lgkmcnt(4)
v_exp_f32 v69,v69
v_mfma_f32_16x16x32_bf16 v[200:203],a[248:251],v[96:99],v[200:203]
buffer_load_dwordx4 v9,s[4:7],s20 offen offset:2048 lds
v_mfma_f32_16x16x32_bf16 v[248:251],a[248:251],v[100:103],v[248:251]
s_add_u32 s20,s20,12288
v_exp_f32 v70,v70
v_mfma_f32_16x16x32_bf16 a[40:43],a[248:251],v[104:107],a[40:43]
s_waitcnt lgkmcnt(1)
ds_read_b128 v[152:155],v23 offset:0
v_cvt_pk_bf16_f32 v114,v68,v69
v_mfma_f32_16x16x32_bf16 v[204:207],a[252:255],v[96:99],v[204:207]
v_exp_f32 v71,v71
v_mfma_f32_16x16x32_bf16 v[252:255],a[252:255],v[100:103],v[252:255]
v_exp_f32 v76,v76
v_mfma_f32_16x16x32_bf16 a[44:47],a[252:255],v[104:107],a[44:47]
v_exp_f32 v77,v77
v_mfma_f32_16x16x32_bf16 v[32:35],a[192:195],a[96:99],0
v_exp_f32 v78,v78
v_mfma_f32_16x16x32_bf16 v[32:35],a[196:199],a[100:103],v[32:35]
v_exp_f32 v79,v79
v_mfma_f32_16x16x32_bf16 v[32:35],a[200:203],a[104:107],v[32:35]
v_exp_f32 v80,v80
v_mfma_f32_16x16x32_bf16 v[32:35],a[204:207],a[108:111],v[32:35]
s_waitcnt lgkmcnt(1)
buffer_store_dwordx4 v[156:159],v0,s[16:19],s27 offen offset:0 nt
v_mfma_f32_16x16x32_bf16 v[32:35],a[208:211],a[112:115],v[32:35]
v_exp_f32 v81,v81
v_mfma_f32_16x16x32_bf16 v[32:35],a[212:215],a[116:119],v[32:35]
v_exp_f32 v82,v82
v_mfma_f32_16x16x32_bf16 v[40:43],a[192:195],a[120:123],0
ds_read_b128 v[156:159],v31 offset:0
v_cvt_pk_bf16_f32 v115,v70,v71
v_mfma_f32_16x16x32_bf16 v[40:43],a[196:199],a[124:127],v[40:43]
v_exp_f32 v83,v83
v_mfma_f32_16x16x32_bf16 v[128:131],v[24:27],v[112:115],v[128:131]
v_exp_f32 v84,v84
v_mfma_f32_16x16x32_bf16 v[40:43],a[200:203],a[128:131],v[40:43]
v_exp_f32 v85,v85
v_mfma_f32_16x16x32_bf16 v[40:43],a[204:207],a[132:135],v[40:43]
v_exp_f32 v86,v86
v_mfma_f32_16x16x32_bf16 v[40:43],a[208:211],a[136:139],v[40:43]
v_exp_f32 v87,v87
v_mfma_f32_16x16x32_bf16 v[40:43],a[212:215],a[140:143],v[40:43]
s_waitcnt lgkmcnt(1)
buffer_store_dwordx4 v[152:155],v0,s[16:19],s27 offen offset:1024 nt
v_mfma_f32_16x16x32_bf16 v[48:51],a[192:195],a[144:147],0
v_cvt_pk_bf16_f32 v118,v76,v77
v_cvt_pk_bf16_f32 v119,v78,v79
v_mfma_f32_16x16x32_bf16 v[48:51],a[196:199],a[148:151],v[48:51]
v_cvt_pk_bf16_f32 v120,v80,v81
v_cvt_pk_bf16_f32 v121,v82,v83
v_mfma_f32_16x16x32_bf16 v[132:135],v[24:27],v[116:119],v[132:135]
v_cvt_pk_bf16_f32 v122,v84,v85
v_cvt_pk_bf16_f32 v123,v86,v87
v_mfma_f32_16x16x32_bf16 v[48:51],a[200:203],a[152:155],v[48:51]
v_fma_f32 v32,v32,s36,v16
v_fma_f32 v33,v33,s36,v16
v_mfma_f32_16x16x32_bf16 v[136:139],v[24:27],v[120:123],v[136:139]
v_fma_f32 v34,v34,s36,v16
v_fma_f32 v35,v35,s36,v16
v_mfma_f32_16x16x32_bf16 v[48:51],a[204:207],a[156:159],v[48:51]
v_fma_f32 v40,v40,s36,v17
v_fma_f32 v41,v41,s36,v17
v_mfma_f32_16x16x32_bf16 v[48:51],a[208:211],a[160:163],v[48:51]
s_waitcnt vmcnt(8)
s_waitcnt lgkmcnt(0)
buffer_store_dwordx4 v[156:159],v0,s[16:19],s27 offen offset:2048 nt
s_barrier
v_mfma_f32_16x16x32_bf16 v[48:51],a[212:215],a[164:167],v[48:51]
s_add_u32 s27,s27,3072
v_fma_f32 v42,v42,s36,v17
v_fma_f32 v43,v43,s36,v17
v_mfma_f32_16x16x32_bf16 v[36:39],a[216:219],a[96:99],0
v_exp_f32 v32,v32
v_mfma_f32_16x16x32_bf16 v[36:39],a[220:223],a[100:103],v[36:39]
v_exp_f32 v33,v33
v_mfma_f32_16x16x32_bf16 v[36:39],a[224:227],a[104:107],v[36:39]
v_exp_f32 v34,v34
v_mfma_f32_16x16x32_bf16 v[36:39],a[228:231],a[108:111],v[36:39]
v_exp_f32 v35,v35
v_mfma_f32_16x16x32_bf16 v[36:39],a[232:235],a[112:115],v[36:39]
ds_read_b64_tr_b16 a[240:241],v3 offset:0
ds_read_b64_tr_b16 a[242:243],v3 offset:6144
v_mfma_f32_16x16x32_bf16 v[36:39],a[236:239],a[116:119],v[36:39]
v_exp_f32 v40,v40
v_mfma_f32_16x16x32_bf16 v[44:47],a[216:219],a[120:123],0
ds_read_b64_tr_b16 a[244:245],v4 offset:0
ds_read_b64_tr_b16 a[246:247],v4 offset:6144
v_mfma_f32_16x16x32_bf16 v[44:47],a[220:223],a[124:127],v[44:47]
ds_read_b64_tr_b16 a[248:249],v5 offset:0
ds_read_b64_tr_b16 a[250:251],v5 offset:6144
v_mfma_f32_16x16x32_bf16 v[44:47],a[224:227],a[128:131],v[44:47]
v_exp_f32 v41,v41
v_mfma_f32_16x16x32_bf16 v[44:47],a[228:231],a[132:135],v[44:47]
ds_read_b64_tr_b16 a[252:253],v6 offset:0
ds_read_b64_tr_b16 a[254:255],v6 offset:6144
v_mfma_f32_16x16x32_bf16 v[44:47],a[232:235],a[136:139],v[44:47]
v_exp_f32 v42,v42
v_mfma_f32_16x16x32_bf16 v[44:47],a[236:239],a[140:143],v[44:47]
v_exp_f32 v43,v43
v_mfma_f32_16x16x32_bf16 v[52:55],a[216:219],a[144:147],0
v_cvt_pk_bf16_f32 v96,v32,v33
v_cvt_pk_bf16_f32 v97,v34,v35
v_mfma_f32_16x16x32_bf16 v[52:55],a[220:223],a[148:151],v[52:55]
v_cvt_pk_bf16_f32 v100,v40,v41
v_cvt_pk_bf16_f32 v101,v42,v43
v_mfma_f32_16x16x32_bf16 v[52:55],a[224:227],a[152:155],v[52:55]
v_mfma_f32_16x16x32_bf16 v[52:55],a[228:231],a[156:159],v[52:55]
v_mfma_f32_16x16x32_bf16 v[52:55],a[232:235],a[160:163],v[52:55]
v_mfma_f32_16x16x32_bf16 v[52:55],a[236:239],a[164:167],v[52:55]
s_waitcnt lgkmcnt(2)
v_mfma_f32_16x16x32_bf16 v[160:163],a[240:243],v[112:115],v[160:163]
s_add_u32 m0,s23,24576
ds_read_b128 a[192:195],v1 offset:24576
v_fma_f32 v36,v36,s36,v16
v_mfma_f32_16x16x32_bf16 v[208:211],a[240:243],v[116:119],v[208:211]
buffer_load_dwordx4 v7,s[8:11],s21 offen offset:0 lds
v_mfma_f32_16x16x32_bf16 a[0:3],a[240:243],v[120:123],a[0:3]
ds_read_b64_tr_b16 a[240:241],v3 offset:128
ds_read_b64_tr_b16 a[242:243],v3 offset:6272
v_mfma_f32_16x16x32_bf16 v[164:167],a[244:247],v[112:115],v[164:167]
ds_read_b128 a[196:199],v2 offset:24576
v_fma_f32 v37,v37,s36,v16
v_mfma_f32_16x16x32_bf16 v[212:215],a[244:247],v[116:119],v[212:215]
ds_read_b128 a[200:203],v1 offset:24704
v_fma_f32 v38,v38,s36,v16
v_mfma_f32_16x16x32_bf16 a[4:7],a[244:247],v[120:123],a[4:7]
ds_read_b64_tr_b16 a[244:245],v4 offset:128
ds_read_b64_tr_b16 a[246:247],v4 offset:6272
v_mfma_f32_16x16x32_bf16 v[168:171],a[248:251],v[112:115],v[168:171]
ds_read_b128 a[204:207],v2 offset:24704
v_fma_f32 v39,v39,s36,v16
v_mfma_f32_16x16x32_bf16 v[216:219],a[248:251],v[116:119],v[216:219]
buffer_load_dwordx4 v8,s[8:11],s21 offen offset:1024 lds
v_mfma_f32_16x16x32_bf16 a[8:11],a[248:251],v[120:123],a[8:11]
s_waitcnt lgkmcnt(7)
ds_read_b64_tr_b16 a[248:249],v5 offset:128
ds_read_b64_tr_b16 a[250:251],v5 offset:6272
v_mfma_f32_16x16x32_bf16 v[172:175],a[252:255],v[112:115],v[172:175]
ds_read_b128 a[208:211],v1 offset:24832
v_fma_f32 v44,v44,s36,v17
v_mfma_f32_16x16x32_bf16 v[220:223],a[252:255],v[116:119],v[220:223]
ds_read_b128 a[212:215],v2 offset:24832
v_fma_f32 v45,v45,s36,v17
v_mfma_f32_16x16x32_bf16 a[12:15],a[252:255],v[120:123],a[12:15]
s_waitcnt lgkmcnt(8)
ds_read_b64_tr_b16 a[252:253],v6 offset:128
ds_read_b64_tr_b16 a[254:255],v6 offset:6272
v_mfma_f32_16x16x32_bf16 v[176:179],a[240:243],v[112:115],v[176:179]
buffer_load_dwordx4 v9,s[8:11],s21 offen offset:2048 lds
v_mfma_f32_16x16x32_bf16 v[224:227],a[240:243],v[116:119],v[224:227]
s_add_u32 s21,s21,12288
ds_read_b128 a[216:219],v1 offset:30720
v_fma_f32 v46,v46,s36,v17
v_mfma_f32_16x16x32_bf16 a[16:19],a[240:243],v[120:123],a[16:19]
s_add_u32 m0,s22,12288
ds_read_b64_tr_b16 a[240:241],v3 offset:256
ds_read_b64_tr_b16 a[242:243],v3 offset:6400
s_waitcnt lgkmcnt(9)
v_mfma_f32_16x16x32_bf16 v[180:183],a[244:247],v[112:115],v[180:183]
ds_read_b128 a[220:223],v2 offset:30720
v_fma_f32 v47,v47,s36,v17
v_mfma_f32_16x16x32_bf16 v[228:231],a[244:247],v[116:119],v[228:231]
ds_read_b128 a[224:227],v1 offset:30848
v_fma_f32 v48,v48,s36,v18
v_mfma_f32_16x16x32_bf16 a[20:23],a[244:247],v[120:123],a[20:23]
s_waitcnt lgkmcnt(8)
ds_read_b64_tr_b16 a[244:245],v4 offset:256
ds_read_b64_tr_b16 a[246:247],v4 offset:6400
v_mfma_f32_16x16x32_bf16 v[184:187],a[248:251],v[112:115],v[184:187]
buffer_load_dwordx4 v7,s[4:7],s20 offen offset:0 lds
v_mfma_f32_16x16x32_bf16 v[232:235],a[248:251],v[116:119],v[232:235]
ds_read_b128 a[228:231],v2 offset:30848
v_fma_f32 v49,v49,s36,v18
v_mfma_f32_16x16x32_bf16 a[24:27],a[248:251],v[120:123],a[24:27]
s_waitcnt lgkmcnt(8)
ds_read_b64_tr_b16 a[248:249],v5 offset:256
ds_read_b64_tr_b16 a[250:251],v5 offset:6400
v_mfma_f32_16x16x32_bf16 v[188:191],a[252:255],v[112:115],v[188:191]
ds_read_b128 a[232:235],v1 offset:30976
v_fma_f32 v50,v50,s36,v18
v_mfma_f32_16x16x32_bf16 v[236:239],a[252:255],v[116:119],v[236:239]
ds_read_b128 a[236:239],v2 offset:30976
v_fma_f32 v51,v51,s36,v18
v_mfma_f32_16x16x32_bf16 a[28:31],a[252:255],v[120:123],a[28:31]
s_waitcnt lgkmcnt(8)
ds_read_b64_tr_b16 a[252:253],v6 offset:256
ds_read_b64_tr_b16 a[254:255],v6 offset:6400
v_mfma_f32_16x16x32_bf16 v[192:195],a[240:243],v[112:115],v[192:195]
buffer_load_dwordx4 v8,s[4:7],s20 offen offset:1024 lds
v_mfma_f32_16x16x32_bf16 v[240:243],a[240:243],v[116:119],v[240:243]
v_fma_f32 v52,v52,s36,v18
v_fma_f32 v53,v53,s36,v18
v_mfma_f32_16x16x32_bf16 a[32:35],a[240:243],v[120:123],a[32:35]
s_waitcnt lgkmcnt(7)
v_fma_f32 v54,v54,s36,v18
v_fma_f32 v55,v55,s36,v18
v_mfma_f32_16x16x32_bf16 v[196:199],a[244:247],v[112:115],v[196:199]
v_exp_f32 v36,v36
v_mfma_f32_16x16x32_bf16 v[244:247],a[244:247],v[116:119],v[244:247]
v_exp_f32 v37,v37
v_mfma_f32_16x16x32_bf16 a[36:39],a[244:247],v[120:123],a[36:39]
s_waitcnt lgkmcnt(3)
v_exp_f32 v38,v38
v_mfma_f32_16x16x32_bf16 v[200:203],a[248:251],v[112:115],v[200:203]
buffer_load_dwordx4 v9,s[4:7],s20 offen offset:2048 lds
v_mfma_f32_16x16x32_bf16 v[248:251],a[248:251],v[116:119],v[248:251]
s_add_u32 s20,s20,12288
v_exp_f32 v39,v39
v_mfma_f32_16x16x32_bf16 a[40:43],a[248:251],v[120:123],a[40:43]
s_add_u32 m0,s29,0
v_exp_f32 v44,v44
s_waitcnt lgkmcnt(0)
v_mfma_f32_16x16x32_bf16 v[204:207],a[252:255],v[112:115],v[204:207]
v_exp_f32 v45,v45
v_mfma_f32_16x16x32_bf16 v[252:255],a[252:255],v[116:119],v[252:255]
v_exp_f32 v46,v46
v_mfma_f32_16x16x32_bf16 a[44:47],a[252:255],v[120:123],a[44:47]
v_exp_f32 v47,v47
v_mfma_f32_16x16x32_bf16 v[64:67],a[192:195],a[96:99],0
v_exp_f32 v48,v48
v_mfma_f32_16x16x32_bf16 v[64:67],a[196:199],a[100:103],v[64:67]
v_exp_f32 v49,v49
v_mfma_f32_16x16x32_bf16 v[64:67],a[200:203],a[104:107],v[64:67]
v_exp_f32 v50,v50
v_mfma_f32_16x16x32_bf16 v[64:67],a[204:207],a[108:111],v[64:67]
buffer_load_dwordx4 v7,s[12:15],s28 offen offset:0 nt lds
v_mfma_f32_16x16x32_bf16 v[64:67],a[208:211],a[112:115],v[64:67]
v_exp_f32 v51,v51
v_mfma_f32_16x16x32_bf16 v[64:67],a[212:215],a[116:119],v[64:67]
v_exp_f32 v52,v52
v_mfma_f32_16x16x32_bf16 v[72:75],a[192:195],a[120:123],0
v_exp_f32 v53,v53
v_mfma_f32_16x16x32_bf16 v[72:75],a[196:199],a[124:127],v[72:75]
v_exp_f32 v54,v54
v_mfma_f32_16x16x32_bf16 v[72:75],a[200:203],a[128:131],v[72:75]
v_exp_f32 v55,v55
v_mfma_f32_16x16x32_bf16 v[72:75],a[204:207],a[132:135],v[72:75]
v_cvt_pk_bf16_f32 v98,v36,v37
v_cvt_pk_bf16_f32 v99,v38,v39
v_mfma_f32_16x16x32_bf16 v[72:75],a[208:211],a[136:139],v[72:75]
v_cvt_pk_bf16_f32 v102,v44,v45
v_cvt_pk_bf16_f32 v103,v46,v47
v_mfma_f32_16x16x32_bf16 v[128:131],v[24:27],v[96:99],v[128:131]
v_cvt_pk_bf16_f32 v104,v48,v49
v_cvt_pk_bf16_f32 v105,v50,v51
v_mfma_f32_16x16x32_bf16 v[132:135],v[24:27],v[100:103],v[132:135]
buffer_load_dwordx4 v8,s[12:15],s28 offen offset:1024 nt lds
v_mfma_f32_16x16x32_bf16 v[72:75],a[212:215],a[140:143],v[72:75]
v_cvt_pk_bf16_f32 v106,v52,v53
v_cvt_pk_bf16_f32 v107,v54,v55
v_mfma_f32_16x16x32_bf16 v[80:83],a[192:195],a[144:147],0
v_fma_f32 v64,v64,s36,v16
v_fma_f32 v65,v65,s36,v16
v_mfma_f32_16x16x32_bf16 v[136:139],v[24:27],v[104:107],v[136:139]
v_fma_f32 v66,v66,s36,v16
v_fma_f32 v67,v67,s36,v16
v_mfma_f32_16x16x32_bf16 v[80:83],a[196:199],a[148:151],v[80:83]
v_fma_f32 v72,v72,s36,v17
v_fma_f32 v73,v73,s36,v17
v_mfma_f32_16x16x32_bf16 v[80:83],a[200:203],a[152:155],v[80:83]
v_fma_f32 v74,v74,s36,v17
v_fma_f32 v75,v75,s36,v17
v_mfma_f32_16x16x32_bf16 v[80:83],a[204:207],a[156:159],v[80:83]
v_exp_f32 v64,v64
v_mfma_f32_16x16x32_bf16 v[80:83],a[208:211],a[160:163],v[80:83]
s_waitcnt vmcnt(11)
buffer_load_dwordx4 v9,s[12:15],s28 offen offset:2048 nt lds
s_barrier
v_mfma_f32_16x16x32_bf16 v[80:83],a[212:215],a[164:167],v[80:83]
s_add_u32 s28,s28,3072
v_exp_f32 v65,v65
v_mfma_f32_16x16x32_bf16 v[68:71],a[216:219],a[96:99],0
s_add_u32 s29,s29,3072
v_exp_f32 v66,v66
v_mfma_f32_16x16x32_bf16 v[68:71],a[220:223],a[100:103],v[68:71]
v_exp_f32 v67,v67
v_mfma_f32_16x16x32_bf16 v[68:71],a[224:227],a[104:107],v[68:71]
v_exp_f32 v72,v72
v_mfma_f32_16x16x32_bf16 v[68:71],a[228:231],a[108:111],v[68:71]
v_exp_f32 v73,v73
v_mfma_f32_16x16x32_bf16 v[68:71],a[232:235],a[112:115],v[68:71]
ds_read_b64_tr_b16 a[240:241],v3 offset:12288
ds_read_b64_tr_b16 a[242:243],v3 offset:18432
v_mfma_f32_16x16x32_bf16 v[68:71],a[236:239],a[116:119],v[68:71]
v_exp_f32 v74,v74
v_mfma_f32_16x16x32_bf16 v[76:79],a[216:219],a[120:123],0
ds_read_b64_tr_b16 a[244:245],v4 offset:12288
ds_read_b64_tr_b16 a[246:247],v4 offset:18432
v_mfma_f32_16x16x32_bf16 v[76:79],a[220:223],a[124:127],v[76:79]
ds_read_b64_tr_b16 a[248:249],v5 offset:12288
ds_read_b64_tr_b16 a[250:251],v5 offset:18432
v_mfma_f32_16x16x32_bf16 v[76:79],a[224:227],a[128:131],v[76:79]
v_exp_f32 v75,v75
v_mfma_f32_16x16x32_bf16 v[76:79],a[228:231],a[132:135],v[76:79]
ds_read_b64_tr_b16 a[252:253],v6 offset:12288
ds_read_b64_tr_b16 a[254:255],v6 offset:18432
v_mfma_f32_16x16x32_bf16 v[76:79],a[232:235],a[136:139],v[76:79]
v_cvt_pk_bf16_f32 v112,v64,v65
v_cvt_pk_bf16_f32 v113,v66,v67
v_mfma_f32_16x16x32_bf16 v[76:79],a[236:239],a[140:143],v[76:79]
v_cvt_pk_bf16_f32 v116,v72,v73
v_cvt_pk_bf16_f32 v117,v74,v75
v_mfma_f32_16x16x32_bf16 v[84:87],a[216:219],a[144:147],0
v_mfma_f32_16x16x32_bf16 v[84:87],a[220:223],a[148:151],v[84:87]
v_mfma_f32_16x16x32_bf16 v[84:87],a[224:227],a[152:155],v[84:87]
v_mfma_f32_16x16x32_bf16 v[84:87],a[228:231],a[156:159],v[84:87]
v_mfma_f32_16x16x32_bf16 v[84:87],a[232:235],a[160:163],v[84:87]
v_mfma_f32_16x16x32_bf16 v[84:87],a[236:239],a[164:167],v[84:87]
s_waitcnt lgkmcnt(2)
v_mfma_f32_16x16x32_bf16 v[160:163],a[240:243],v[96:99],v[160:163]
s_add_u32 m0,s23,0
ds_read_b128 a[192:195],v1 offset:0
v_fma_f32 v68,v68,s36,v16
v_mfma_f32_16x16x32_bf16 v[208:211],a[240:243],v[100:103],v[208:211]
buffer_load_dwordx4 v7,s[8:11],s21 offen offset:0 lds
v_mfma_f32_16x16x32_bf16 a[0:3],a[240:243],v[104:107],a[0:3]
ds_read_b64_tr_b16 a[240:241],v3 offset:12416
ds_read_b64_tr_b16 a[242:243],v3 offset:18560
v_mfma_f32_16x16x32_bf16 v[164:167],a[244:247],v[96:99],v[164:167]
ds_read_b128 a[196:199],v2 offset:0
v_fma_f32 v69,v69,s36,v16
v_mfma_f32_16x16x32_bf16 v[212:215],a[244:247],v[100:103],v[212:215]
ds_read_b128 a[200:203],v1 offset:128
v_fma_f32 v70,v70,s36,v16
v_mfma_f32_16x16x32_bf16 a[4:7],a[244:247],v[104:107],a[4:7]
ds_read_b64_tr_b16 a[244:245],v4 offset:12416
ds_read_b64_tr_b16 a[246:247],v4 offset:18560
v_mfma_f32_16x16x32_bf16 v[168:171],a[248:251],v[96:99],v[168:171]
ds_read_b128 a[204:207],v2 offset:128
v_fma_f32 v71,v71,s36,v16
v_mfma_f32_16x16x32_bf16 v[216:219],a[248:251],v[100:103],v[216:219]
buffer_load_dwordx4 v8,s[8:11],s21 offen offset:1024 lds
v_mfma_f32_16x16x32_bf16 a[8:11],a[248:251],v[104:107],a[8:11]
s_waitcnt lgkmcnt(7)
ds_read_b64_tr_b16 a[248:249],v5 offset:12416
ds_read_b64_tr_b16 a[250:251],v5 offset:18560
v_mfma_f32_16x16x32_bf16 v[172:175],a[252:255],v[96:99],v[172:175]
ds_read_b128 a[208:211],v1 offset:256
v_fma_f32 v76,v76,s36,v17
v_mfma_f32_16x16x32_bf16 v[220:223],a[252:255],v[100:103],v[220:223]
ds_read_b128 a[212:215],v2 offset:256
v_fma_f32 v77,v77,s36,v17
v_mfma_f32_16x16x32_bf16 a[12:15],a[252:255],v[104:107],a[12:15]
s_waitcnt lgkmcnt(8)
ds_read_b64_tr_b16 a[252:253],v6 offset:12416
ds_read_b64_tr_b16 a[254:255],v6 offset:18560
v_mfma_f32_16x16x32_bf16 v[176:179],a[240:243],v[96:99],v[176:179]
buffer_load_dwordx4 v9,s[8:11],s21 offen offset:2048 lds
v_mfma_f32_16x16x32_bf16 v[224:227],a[240:243],v[100:103],v[224:227]
s_add_u32 s21,s21,12288
ds_read_b128 a[216:219],v1 offset:6144
v_fma_f32 v78,v78,s36,v17
v_mfma_f32_16x16x32_bf16 a[16:19],a[240:243],v[104:107],a[16:19]
s_add_u32 m0,s22,24576
ds_read_b64_tr_b16 a[240:241],v3 offset:12544
ds_read_b64_tr_b16 a[242:243],v3 offset:18688
s_waitcnt lgkmcnt(9)
v_mfma_f32_16x16x32_bf16 v[180:183],a[244:247],v[96:99],v[180:183]
ds_read_b128 a[220:223],v2 offset:6144
v_fma_f32 v79,v79,s36,v17
v_mfma_f32_16x16x32_bf16 v[228:231],a[244:247],v[100:103],v[228:231]
ds_read_b128 a[224:227],v1 offset:6272
v_fma_f32 v80,v80,s36,v18
v_mfma_f32_16x16x32_bf16 a[20:23],a[244:247],v[104:107],a[20:23]
s_waitcnt lgkmcnt(8)
ds_read_b64_tr_b16 a[244:245],v4 offset:12544
ds_read_b64_tr_b16 a[246:247],v4 offset:18688
v_mfma_f32_16x16x32_bf16 v[184:187],a[248:251],v[96:99],v[184:187]
buffer_load_dwordx4 v7,s[4:7],s20 offen offset:0 lds
v_mfma_f32_16x16x32_bf16 v[232:235],a[248:251],v[100:103],v[232:235]
ds_read_b128 a[228:231],v2 offset:6272
v_fma_f32 v81,v81,s36,v18
v_mfma_f32_16x16x32_bf16 a[24:27],a[248:251],v[104:107],a[24:27]
s_waitcnt lgkmcnt(8)
ds_read_b64_tr_b16 a[248:249],v5 offset:12544
ds_read_b64_tr_b16 a[250:251],v5 offset:18688
v_mfma_f32_16x16x32_bf16 v[188:191],a[252:255],v[96:99],v[188:191]
ds_read_b128 a[232:235],v1 offset:6400
v_fma_f32 v82,v82,s36,v18
v_mfma_f32_16x16x32_bf16 v[236:239],a[252:255],v[100:103],v[236:239]
ds_read_b128 a[236:239],v2 offset:6400
v_fma_f32 v83,v83,s36,v18
v_mfma_f32_16x16x32_bf16 a[28:31],a[252:255],v[104:107],a[28:31]
s_waitcnt lgkmcnt(8)
ds_read_b64_tr_b16 a[252:253],v6 offset:12544
ds_read_b64_tr_b16 a[254:255],v6 offset:18688
v_mfma_f32_16x16x32_bf16 v[192:195],a[240:243],v[96:99],v[192:195]
buffer_load_dwordx4 v8,s[4:7],s20 offen offset:1024 lds
v_mfma_f32_16x16x32_bf16 v[240:243],a[240:243],v[100:103],v[240:243]
ds_read_b128 v[152:155],v11 offset:3072
v_fma_f32 v84,v84,s36,v18
v_mfma_f32_16x16x32_bf16 a[32:35],a[240:243],v[104:107],a[32:35]
s_waitcnt lgkmcnt(8)
v_fma_f32 v85,v85,s36,v18
v_fma_f32 v86,v86,s36,v18
v_mfma_f32_16x16x32_bf16 v[196:199],a[244:247],v[96:99],v[196:199]
v_fma_f32 v87,v87,s36,v18
v_mfma_f32_16x16x32_bf16 v[244:247],a[244:247],v[100:103],v[244:247]
v_exp_f32 v68,v68
v_mfma_f32_16x16x32_bf16 a[36:39],a[244:247],v[104:107],a[36:39]
s_waitcnt lgkmcnt(4)
v_exp_f32 v69,v69
v_mfma_f32_16x16x32_bf16 v[200:203],a[248:251],v[96:99],v[200:203]
buffer_load_dwordx4 v9,s[4:7],s20 offen offset:2048 lds
v_mfma_f32_16x16x32_bf16 v[248:251],a[248:251],v[100:103],v[248:251]
s_add_u32 s20,s20,12288
v_exp_f32 v70,v70
v_mfma_f32_16x16x32_bf16 a[40:43],a[248:251],v[104:107],a[40:43]
s_waitcnt lgkmcnt(1)
ds_read_b128 v[156:159],v23 offset:3072
v_cvt_pk_bf16_f32 v114,v68,v69
v_mfma_f32_16x16x32_bf16 v[204:207],a[252:255],v[96:99],v[204:207]
v_exp_f32 v71,v71
v_mfma_f32_16x16x32_bf16 v[252:255],a[252:255],v[100:103],v[252:255]
v_exp_f32 v76,v76
v_mfma_f32_16x16x32_bf16 a[44:47],a[252:255],v[104:107],a[44:47]
v_exp_f32 v77,v77
v_mfma_f32_16x16x32_bf16 v[32:35],a[192:195],a[96:99],0
v_exp_f32 v78,v78
v_mfma_f32_16x16x32_bf16 v[32:35],a[196:199],a[100:103],v[32:35]
v_exp_f32 v79,v79
v_mfma_f32_16x16x32_bf16 v[32:35],a[200:203],a[104:107],v[32:35]
v_exp_f32 v80,v80
v_mfma_f32_16x16x32_bf16 v[32:35],a[204:207],a[108:111],v[32:35]
s_waitcnt lgkmcnt(1)
buffer_store_dwordx4 v[152:155],v0,s[16:19],s27 offen offset:0 nt
v_mfma_f32_16x16x32_bf16 v[32:35],a[208:211],a[112:115],v[32:35]
v_exp_f32 v81,v81
v_mfma_f32_16x16x32_bf16 v[32:35],a[212:215],a[116:119],v[32:35]
v_exp_f32 v82,v82
v_mfma_f32_16x16x32_bf16 v[40:43],a[192:195],a[120:123],0
ds_read_b128 v[152:155],v31 offset:3072
v_cvt_pk_bf16_f32 v115,v70,v71
v_mfma_f32_16x16x32_bf16 v[40:43],a[196:199],a[124:127],v[40:43]
v_exp_f32 v83,v83
v_mfma_f32_16x16x32_bf16 v[128:131],v[24:27],v[112:115],v[128:131]
v_exp_f32 v84,v84
v_mfma_f32_16x16x32_bf16 v[40:43],a[200:203],a[128:131],v[40:43]
v_exp_f32 v85,v85
v_mfma_f32_16x16x32_bf16 v[40:43],a[204:207],a[132:135],v[40:43]
v_exp_f32 v86,v86
v_mfma_f32_16x16x32_bf16 v[40:43],a[208:211],a[136:139],v[40:43]
v_exp_f32 v87,v87
v_mfma_f32_16x16x32_bf16 v[40:43],a[212:215],a[140:143],v[40:43]
s_waitcnt lgkmcnt(1)
buffer_store_dwordx4 v[156:159],v0,s[16:19],s27 offen offset:1024 nt
v_mfma_f32_16x16x32_bf16 v[48:51],a[192:195],a[144:147],0
v_cvt_pk_bf16_f32 v118,v76,v77
v_cvt_pk_bf16_f32 v119,v78,v79
v_mfma_f32_16x16x32_bf16 v[48:51],a[196:199],a[148:151],v[48:51]
v_cvt_pk_bf16_f32 v120,v80,v81
v_cvt_pk_bf16_f32 v121,v82,v83
v_mfma_f32_16x16x32_bf16 v[132:135],v[24:27],v[116:119],v[132:135]
v_cvt_pk_bf16_f32 v122,v84,v85
v_cvt_pk_bf16_f32 v123,v86,v87
v_mfma_f32_16x16x32_bf16 v[48:51],a[200:203],a[152:155],v[48:51]
v_fma_f32 v32,v32,s36,v16
v_fma_f32 v33,v33,s36,v16
v_mfma_f32_16x16x32_bf16 v[136:139],v[24:27],v[120:123],v[136:139]
v_fma_f32 v34,v34,s36,v16
v_fma_f32 v35,v35,s36,v16
v_mfma_f32_16x16x32_bf16 v[48:51],a[204:207],a[156:159],v[48:51]
v_fma_f32 v40,v40,s36,v17
v_fma_f32 v41,v41,s36,v17
v_mfma_f32_16x16x32_bf16 v[48:51],a[208:211],a[160:163],v[48:51]
s_waitcnt vmcnt(11)
s_waitcnt lgkmcnt(0)
buffer_store_dwordx4 v[152:155],v0,s[16:19],s27 offen offset:2048 nt
s_barrier
v_mfma_f32_16x16x32_bf16 v[48:51],a[212:215],a[164:167],v[48:51]
s_add_u32 s27,s27,3072
v_fma_f32 v42,v42,s36,v17
v_fma_f32 v43,v43,s36,v17
v_mfma_f32_16x16x32_bf16 v[36:39],a[216:219],a[96:99],0
v_exp_f32 v32,v32
v_mfma_f32_16x16x32_bf16 v[36:39],a[220:223],a[100:103],v[36:39]
v_exp_f32 v33,v33
v_mfma_f32_16x16x32_bf16 v[36:39],a[224:227],a[104:107],v[36:39]
v_exp_f32 v34,v34
v_mfma_f32_16x16x32_bf16 v[36:39],a[228:231],a[108:111],v[36:39]
v_exp_f32 v35,v35
v_mfma_f32_16x16x32_bf16 v[36:39],a[232:235],a[112:115],v[36:39]
ds_read_b64_tr_b16 a[240:241],v3 offset:24576
ds_read_b64_tr_b16 a[242:243],v3 offset:30720
v_mfma_f32_16x16x32_bf16 v[36:39],a[236:239],a[116:119],v[36:39]
v_exp_f32 v40,v40
v_mfma_f32_16x16x32_bf16 v[44:47],a[216:219],a[120:123],0
ds_read_b64_tr_b16 a[244:245],v4 offset:24576
ds_read_b64_tr_b16 a[246:247],v4 offset:30720
v_mfma_f32_16x16x32_bf16 v[44:47],a[220:223],a[124:127],v[44:47]
ds_read_b64_tr_b16 a[248:249],v5 offset:24576
ds_read_b64_tr_b16 a[250:251],v5 offset:30720
v_mfma_f32_16x16x32_bf16 v[44:47],a[224:227],a[128:131],v[44:47]
v_exp_f32 v41,v41
v_mfma_f32_16x16x32_bf16 v[44:47],a[228:231],a[132:135],v[44:47]
ds_read_b64_tr_b16 a[252:253],v6 offset:24576
ds_read_b64_tr_b16 a[254:255],v6 offset:30720
v_mfma_f32_16x16x32_bf16 v[44:47],a[232:235],a[136:139],v[44:47]
v_exp_f32 v42,v42
v_mfma_f32_16x16x32_bf16 v[44:47],a[236:239],a[140:143],v[44:47]
v_exp_f32 v43,v43
v_mfma_f32_16x16x32_bf16 v[52:55],a[216:219],a[144:147],0
v_cvt_pk_bf16_f32 v96,v32,v33
v_cvt_pk_bf16_f32 v97,v34,v35
v_mfma_f32_16x16x32_bf16 v[52:55],a[220:223],a[148:151],v[52:55]
v_cvt_pk_bf16_f32 v100,v40,v41
v_cvt_pk_bf16_f32 v101,v42,v43
v_mfma_f32_16x16x32_bf16 v[52:55],a[224:227],a[152:155],v[52:55]
v_mfma_f32_16x16x32_bf16 v[52:55],a[228:231],a[156:159],v[52:55]
v_mfma_f32_16x16x32_bf16 v[52:55],a[232:235],a[160:163],v[52:55]
v_mfma_f32_16x16x32_bf16 v[52:55],a[236:239],a[164:167],v[52:55]
s_waitcnt lgkmcnt(2)
v_mfma_f32_16x16x32_bf16 v[160:163],a[240:243],v[112:115],v[160:163]
s_add_u32 m0,s23,12288
ds_read_b128 a[192:195],v1 offset:12288
v_fma_f32 v36,v36,s36,v16
v_mfma_f32_16x16x32_bf16 v[208:211],a[240:243],v[116:119],v[208:211]
buffer_load_dwordx4 v7,s[8:11],s21 offen offset:0 lds
v_mfma_f32_16x16x32_bf16 a[0:3],a[240:243],v[120:123],a[0:3]
ds_read_b64_tr_b16 a[240:241],v3 offset:24704
ds_read_b64_tr_b16 a[242:243],v3 offset:30848
v_mfma_f32_16x16x32_bf16 v[164:167],a[244:247],v[112:115],v[164:167]
ds_read_b128 a[196:199],v2 offset:12288
v_fma_f32 v37,v37,s36,v16
v_mfma_f32_16x16x32_bf16 v[212:215],a[244:247],v[116:119],v[212:215]
ds_read_b128 a[200:203],v1 offset:12416
v_fma_f32 v38,v38,s36,v16
v_mfma_f32_16x16x32_bf16 a[4:7],a[244:247],v[120:123],a[4:7]
ds_read_b64_tr_b16 a[244:245],v4 offset:24704
ds_read_b64_tr_b16 a[246:247],v4 offset:30848
v_mfma_f32_16x16x32_bf16 v[168:171],a[248:251],v[112:115],v[168:171]
ds_read_b128 a[204:207],v2 offset:12416
v_fma_f32 v39,v39,s36,v16
v_mfma_f32_16x16x32_bf16 v[216:219],a[248:251],v[116:119],v[216:219]
buffer_load_dwordx4 v8,s[8:11],s21 offen offset:1024 lds
v_mfma_f32_16x16x32_bf16 a[8:11],a[248:251],v[120:123],a[8:11]
s_waitcnt lgkmcnt(7)
ds_read_b64_tr_b16 a[248:249],v5 offset:24704
ds_read_b64_tr_b16 a[250:251],v5 offset:30848
v_mfma_f32_16x16x32_bf16 v[172:175],a[252:255],v[112:115],v[172:175]
ds_read_b128 a[208:211],v1 offset:12544
v_fma_f32 v44,v44,s36,v17
v_mfma_f32_16x16x32_bf16 v[220:223],a[252:255],v[116:119],v[220:223]
ds_read_b128 a[212:215],v2 offset:12544
v_fma_f32 v45,v45,s36,v17
v_mfma_f32_16x16x32_bf16 a[12:15],a[252:255],v[120:123],a[12:15]
s_waitcnt lgkmcnt(8)
ds_read_b64_tr_b16 a[252:253],v6 offset:24704
ds_read_b64_tr_b16 a[254:255],v6 offset:30848
v_mfma_f32_16x16x32_bf16 v[176:179],a[240:243],v[112:115],v[176:179]
buffer_load_dwordx4 v9,s[8:11],s21 offen offset:2048 lds
v_mfma_f32_16x16x32_bf16 v[224:227],a[240:243],v[116:119],v[224:227]
s_add_u32 s21,s21,12288
ds_read_b128 a[216:219],v1 offset:18432
v_fma_f32 v46,v46,s36,v17
v_mfma_f32_16x16x32_bf16 a[16:19],a[240:243],v[120:123],a[16:19]
s_add_u32 m0,s22,0
ds_read_b64_tr_b16 a[240:241],v3 offset:24832
ds_read_b64_tr_b16 a[242:243],v3 offset:30976
s_waitcnt lgkmcnt(9)
v_mfma_f32_16x16x32_bf16 v[180:183],a[244:247],v[112:115],v[180:183]
ds_read_b128 a[220:223],v2 offset:18432
v_fma_f32 v47,v47,s36,v17
v_mfma_f32_16x16x32_bf16 v[228:231],a[244:247],v[116:119],v[228:231]
ds_read_b128 a[224:227],v1 offset:18560
v_fma_f32 v48,v48,s36,v18
v_mfma_f32_16x16x32_bf16 a[20:23],a[244:247],v[120:123],a[20:23]
s_waitcnt lgkmcnt(8)
ds_read_b64_tr_b16 a[244:245],v4 offset:24832
ds_read_b64_tr_b16 a[246:247],v4 offset:30976
v_mfma_f32_16x16x32_bf16 v[184:187],a[248:251],v[112:115],v[184:187]
buffer_load_dwordx4 v7,s[4:7],s20 offen offset:0 lds
v_mfma_f32_16x16x32_bf16 v[232:235],a[248:251],v[116:119],v[232:235]
ds_read_b128 a[228:231],v2 offset:18560
v_fma_f32 v49,v49,s36,v18
v_mfma_f32_16x16x32_bf16 a[24:27],a[248:251],v[120:123],a[24:27]
s_waitcnt lgkmcnt(8)
ds_read_b64_tr_b16 a[248:249],v5 offset:24832
ds_read_b64_tr_b16 a[250:251],v5 offset:30976
v_mfma_f32_16x16x32_bf16 v[188:191],a[252:255],v[112:115],v[188:191]
ds_read_b128 a[232:235],v1 offset:18688
v_fma_f32 v50,v50,s36,v18
v_mfma_f32_16x16x32_bf16 v[236:239],a[252:255],v[116:119],v[236:239]
ds_read_b128 a[236:239],v2 offset:18688
v_fma_f32 v51,v51,s36,v18
v_mfma_f32_16x16x32_bf16 a[28:31],a[252:255],v[120:123],a[28:31]
s_waitcnt lgkmcnt(8)
ds_read_b64_tr_b16 a[252:253],v6 offset:24832
ds_read_b64_tr_b16 a[254:255],v6 offset:30976
v_mfma_f32_16x16x32_bf16 v[192:195],a[240:243],v[112:115],v[192:195]
buffer_load_dwordx4 v8,s[4:7],s20 offen offset:1024 lds
v_mfma_f32_16x16x32_bf16 v[240:243],a[240:243],v[116:119],v[240:243]
v_fma_f32 v52,v52,s36,v18
v_fma_f32 v53,v53,s36,v18
v_mfma_f32_16x16x32_bf16 a[32:35],a[240:243],v[120:123],a[32:35]
s_waitcnt lgkmcnt(7)
v_fma_f32 v54,v54,s36,v18
v_fma_f32 v55,v55,s36,v18
v_mfma_f32_16x16x32_bf16 v[196:199],a[244:247],v[112:115],v[196:199]
v_exp_f32 v36,v36
v_mfma_f32_16x16x32_bf16 v[244:247],a[244:247],v[116:119],v[244:247]
v_exp_f32 v37,v37
v_mfma_f32_16x16x32_bf16 a[36:39],a[244:247],v[120:123],a[36:39]
s_waitcnt lgkmcnt(3)
v_exp_f32 v38,v38
v_mfma_f32_16x16x32_bf16 v[200:203],a[248:251],v[112:115],v[200:203]
buffer_load_dwordx4 v9,s[4:7],s20 offen offset:2048 lds
v_mfma_f32_16x16x32_bf16 v[248:251],a[248:251],v[116:119],v[248:251]
s_add_u32 s20,s20,12288
v_exp_f32 v39,v39
v_mfma_f32_16x16x32_bf16 a[40:43],a[248:251],v[120:123],a[40:43]
s_add_u32 m0,s29,0
v_exp_f32 v44,v44
s_waitcnt lgkmcnt(0)
v_mfma_f32_16x16x32_bf16 v[204:207],a[252:255],v[112:115],v[204:207]
v_exp_f32 v45,v45
v_mfma_f32_16x16x32_bf16 v[252:255],a[252:255],v[116:119],v[252:255]
v_exp_f32 v46,v46
v_mfma_f32_16x16x32_bf16 a[44:47],a[252:255],v[120:123],a[44:47]
v_exp_f32 v47,v47
v_mfma_f32_16x16x32_bf16 v[64:67],a[192:195],a[96:99],0
v_exp_f32 v48,v48
v_mfma_f32_16x16x32_bf16 v[64:67],a[196:199],a[100:103],v[64:67]
v_exp_f32 v49,v49
v_mfma_f32_16x16x32_bf16 v[64:67],a[200:203],a[104:107],v[64:67]
v_exp_f32 v50,v50
v_mfma_f32_16x16x32_bf16 v[64:67],a[204:207],a[108:111],v[64:67]
buffer_load_dwordx4 v7,s[12:15],s28 offen offset:0 nt lds
v_mfma_f32_16x16x32_bf16 v[64:67],a[208:211],a[112:115],v[64:67]
v_exp_f32 v51,v51
v_mfma_f32_16x16x32_bf16 v[64:67],a[212:215],a[116:119],v[64:67]
v_exp_f32 v52,v52
v_mfma_f32_16x16x32_bf16 v[72:75],a[192:195],a[120:123],0
v_exp_f32 v53,v53
v_mfma_f32_16x16x32_bf16 v[72:75],a[196:199],a[124:127],v[72:75]
v_exp_f32 v54,v54
v_mfma_f32_16x16x32_bf16 v[72:75],a[200:203],a[128:131],v[72:75]
v_exp_f32 v55,v55
v_mfma_f32_16x16x32_bf16 v[72:75],a[204:207],a[132:135],v[72:75]
v_cvt_pk_bf16_f32 v98,v36,v37
v_cvt_pk_bf16_f32 v99,v38,v39
v_mfma_f32_16x16x32_bf16 v[72:75],a[208:211],a[136:139],v[72:75]
v_cvt_pk_bf16_f32 v102,v44,v45
v_cvt_pk_bf16_f32 v103,v46,v47
v_mfma_f32_16x16x32_bf16 v[128:131],v[24:27],v[96:99],v[128:131]
v_cvt_pk_bf16_f32 v104,v48,v49
v_cvt_pk_bf16_f32 v105,v50,v51
v_mfma_f32_16x16x32_bf16 v[132:135],v[24:27],v[100:103],v[132:135]
buffer_load_dwordx4 v8,s[12:15],s28 offen offset:1024 nt lds
v_mfma_f32_16x16x32_bf16 v[72:75],a[212:215],a[140:143],v[72:75]
v_cvt_pk_bf16_f32 v106,v52,v53
v_cvt_pk_bf16_f32 v107,v54,v55
v_mfma_f32_16x16x32_bf16 v[80:83],a[192:195],a[144:147],0
v_fma_f32 v64,v64,s36,v16
v_fma_f32 v65,v65,s36,v16
v_mfma_f32_16x16x32_bf16 v[136:139],v[24:27],v[104:107],v[136:139]
v_fma_f32 v66,v66,s36,v16
v_fma_f32 v67,v67,s36,v16
v_mfma_f32_16x16x32_bf16 v[80:83],a[196:199],a[148:151],v[80:83]
v_fma_f32 v72,v72,s36,v17
v_fma_f32 v73,v73,s36,v17
v_mfma_f32_16x16x32_bf16 v[80:83],a[200:203],a[152:155],v[80:83]
v_fma_f32 v74,v74,s36,v17
v_fma_f32 v75,v75,s36,v17
v_mfma_f32_16x16x32_bf16 v[80:83],a[204:207],a[156:159],v[80:83]
v_exp_f32 v64,v64
v_mfma_f32_16x16x32_bf16 v[80:83],a[208:211],a[160:163],v[80:83]
s_waitcnt vmcnt(11)
buffer_load_dwordx4 v9,s[12:15],s28 offen offset:2048 nt lds
s_barrier
v_mfma_f32_16x16x32_bf16 v[80:83],a[212:215],a[164:167],v[80:83]
s_add_u32 s28,s28,3072
v_exp_f32 v65,v65
v_mfma_f32_16x16x32_bf16 v[68:71],a[216:219],a[96:99],0
s_add_u32 s29,s29,3072
v_exp_f32 v66,v66
v_mfma_f32_16x16x32_bf16 v[68:71],a[220:223],a[100:103],v[68:71]
v_exp_f32 v67,v67
v_mfma_f32_16x16x32_bf16 v[68:71],a[224:227],a[104:107],v[68:71]
v_exp_f32 v72,v72
v_mfma_f32_16x16x32_bf16 v[68:71],a[228:231],a[108:111],v[68:71]
v_exp_f32 v73,v73
v_mfma_f32_16x16x32_bf16 v[68:71],a[232:235],a[112:115],v[68:71]
ds_read_b64_tr_b16 a[240:241],v3 offset:0
ds_read_b64_tr_b16 a[242:243],v3 offset:6144
v_mfma_f32_16x16x32_bf16 v[68:71],a[236:239],a[116:119],v[68:71]
v_exp_f32 v74,v74
v_mfma_f32_16x16x32_bf16 v[76:79],a[216:219],a[120:123],0
ds_read_b64_tr_b16 a[244:245],v4 offset:0
ds_read_b64_tr_b16 a[246:247],v4 offset:6144
v_mfma_f32_16x16x32_bf16 v[76:79],a[220:223],a[124:127],v[76:79]
ds_read_b64_tr_b16 a[248:249],v5 offset:0
ds_read_b64_tr_b16 a[250:251],v5 offset:6144
v_mfma_f32_16x16x32_bf16 v[76:79],a[224:227],a[128:131],v[76:79]
v_exp_f32 v75,v75
v_mfma_f32_16x16x32_bf16 v[76:79],a[228:231],a[132:135],v[76:79]
ds_read_b64_tr_b16 a[252:253],v6 offset:0
ds_read_b64_tr_b16 a[254:255],v6 offset:6144
v_mfma_f32_16x16x32_bf16 v[76:79],a[232:235],a[136:139],v[76:79]
v_cvt_pk_bf16_f32 v112,v64,v65
v_cvt_pk_bf16_f32 v113,v66,v67
v_mfma_f32_16x16x32_bf16 v[76:79],a[236:239],a[140:143],v[76:79]
v_cvt_pk_bf16_f32 v116,v72,v73
v_cvt_pk_bf16_f32 v117,v74,v75
v_mfma_f32_16x16x32_bf16 v[84:87],a[216:219],a[144:147],0
v_mfma_f32_16x16x32_bf16 v[84:87],a[220:223],a[148:151],v[84:87]
v_mfma_f32_16x16x32_bf16 v[84:87],a[224:227],a[152:155],v[84:87]
v_mfma_f32_16x16x32_bf16 v[84:87],a[228:231],a[156:159],v[84:87]
v_mfma_f32_16x16x32_bf16 v[84:87],a[232:235],a[160:163],v[84:87]
v_mfma_f32_16x16x32_bf16 v[84:87],a[236:239],a[164:167],v[84:87]
s_waitcnt lgkmcnt(2)
v_mfma_f32_16x16x32_bf16 v[160:163],a[240:243],v[96:99],v[160:163]
s_add_u32 m0,s23,24576
ds_read_b128 a[192:195],v1 offset:24576
v_fma_f32 v68,v68,s36,v16
v_mfma_f32_16x16x32_bf16 v[208:211],a[240:243],v[100:103],v[208:211]
buffer_load_dwordx4 v7,s[8:11],s21 offen offset:0 lds
v_mfma_f32_16x16x32_bf16 a[0:3],a[240:243],v[104:107],a[0:3]
ds_read_b64_tr_b16 a[240:241],v3 offset:128
ds_read_b64_tr_b16 a[242:243],v3 offset:6272
v_mfma_f32_16x16x32_bf16 v[164:167],a[244:247],v[96:99],v[164:167]
ds_read_b128 a[196:199],v2 offset:24576
v_fma_f32 v69,v69,s36,v16
v_mfma_f32_16x16x32_bf16 v[212:215],a[244:247],v[100:103],v[212:215]
ds_read_b128 a[200:203],v1 offset:24704
v_fma_f32 v70,v70,s36,v16
v_mfma_f32_16x16x32_bf16 a[4:7],a[244:247],v[104:107],a[4:7]
ds_read_b64_tr_b16 a[244:245],v4 offset:128
ds_read_b64_tr_b16 a[246:247],v4 offset:6272
v_mfma_f32_16x16x32_bf16 v[168:171],a[248:251],v[96:99],v[168:171]
ds_read_b128 a[204:207],v2 offset:24704
v_fma_f32 v71,v71,s36,v16
v_mfma_f32_16x16x32_bf16 v[216:219],a[248:251],v[100:103],v[216:219]
buffer_load_dwordx4 v8,s[8:11],s21 offen offset:1024 lds
v_mfma_f32_16x16x32_bf16 a[8:11],a[248:251],v[104:107],a[8:11]
s_waitcnt lgkmcnt(7)
ds_read_b64_tr_b16 a[248:249],v5 offset:128
ds_read_b64_tr_b16 a[250:251],v5 offset:6272
v_mfma_f32_16x16x32_bf16 v[172:175],a[252:255],v[96:99],v[172:175]
ds_read_b128 a[208:211],v1 offset:24832
v_fma_f32 v76,v76,s36,v17
v_mfma_f32_16x16x32_bf16 v[220:223],a[252:255],v[100:103],v[220:223]
ds_read_b128 a[212:215],v2 offset:24832
v_fma_f32 v77,v77,s36,v17
v_mfma_f32_16x16x32_bf16 a[12:15],a[252:255],v[104:107],a[12:15]
s_waitcnt lgkmcnt(8)
ds_read_b64_tr_b16 a[252:253],v6 offset:128
ds_read_b64_tr_b16 a[254:255],v6 offset:6272
v_mfma_f32_16x16x32_bf16 v[176:179],a[240:243],v[96:99],v[176:179]
buffer_load_dwordx4 v9,s[8:11],s21 offen offset:2048 lds
v_mfma_f32_16x16x32_bf16 v[224:227],a[240:243],v[100:103],v[224:227]
s_add_u32 s21,s21,12288
ds_read_b128 a[216:219],v1 offset:30720
v_fma_f32 v78,v78,s36,v17
v_mfma_f32_16x16x32_bf16 a[16:19],a[240:243],v[104:107],a[16:19]
s_mov_b32 m0,s25
ds_read_b64_tr_b16 a[240:241],v3 offset:256
ds_read_b64_tr_b16 a[242:243],v3 offset:6400
s_waitcnt lgkmcnt(9)
v_mfma_f32_16x16x32_bf16 v[180:183],a[244:247],v[96:99],v[180:183]
ds_read_b128 a[220:223],v2 offset:30720
v_fma_f32 v79,v79,s36,v17
v_mfma_f32_16x16x32_bf16 v[228:231],a[244:247],v[100:103],v[228:231]
ds_read_b128 a[224:227],v1 offset:30848
v_fma_f32 v80,v80,s36,v18
v_mfma_f32_16x16x32_bf16 a[20:23],a[244:247],v[104:107],a[20:23]
s_waitcnt lgkmcnt(8)
ds_read_b64_tr_b16 a[244:245],v4 offset:256
ds_read_b64_tr_b16 a[246:247],v4 offset:6400
v_mfma_f32_16x16x32_bf16 v[184:187],a[248:251],v[96:99],v[184:187]
buffer_load_dwordx4 v7,s[4:7],s20 offen offset:0 lds
v_mfma_f32_16x16x32_bf16 v[232:235],a[248:251],v[100:103],v[232:235]
ds_read_b128 a[228:231],v2 offset:30848
v_fma_f32 v81,v81,s36,v18
v_mfma_f32_16x16x32_bf16 a[24:27],a[248:251],v[104:107],a[24:27]
s_waitcnt lgkmcnt(8)
ds_read_b64_tr_b16 a[248:249],v5 offset:256
ds_read_b64_tr_b16 a[250:251],v5 offset:6400
v_mfma_f32_16x16x32_bf16 v[188:191],a[252:255],v[96:99],v[188:191]
ds_read_b128 a[232:235],v1 offset:30976
v_fma_f32 v82,v82,s36,v18
v_mfma_f32_16x16x32_bf16 v[236:239],a[252:255],v[100:103],v[236:239]
ds_read_b128 a[236:239],v2 offset:30976
v_fma_f32 v83,v83,s36,v18
v_mfma_f32_16x16x32_bf16 a[28:31],a[252:255],v[104:107],a[28:31]
s_waitcnt lgkmcnt(8)
ds_read_b64_tr_b16 a[252:253],v6 offset:256
ds_read_b64_tr_b16 a[254:255],v6 offset:6400
v_mfma_f32_16x16x32_bf16 v[192:195],a[240:243],v[96:99],v[192:195]
buffer_load_dwordx4 v8,s[4:7],s20 offen offset:1024 lds
v_mfma_f32_16x16x32_bf16 v[240:243],a[240:243],v[100:103],v[240:243]
ds_read_b128 v[156:159],v11 offset:6144
v_fma_f32 v84,v84,s36,v18
v_mfma_f32_16x16x32_bf16 a[32:35],a[240:243],v[104:107],a[32:35]
s_waitcnt lgkmcnt(8)
v_fma_f32 v85,v85,s36,v18
v_fma_f32 v86,v86,s36,v18
v_mfma_f32_16x16x32_bf16 v[196:199],a[244:247],v[96:99],v[196:199]
v_fma_f32 v87,v87,s36,v18
v_mfma_f32_16x16x32_bf16 v[244:247],a[244:247],v[100:103],v[244:247]
v_exp_f32 v68,v68
v_mfma_f32_16x16x32_bf16 a[36:39],a[244:247],v[104:107],a[36:39]
s_waitcnt lgkmcnt(4)
v_exp_f32 v69,v69
v_mfma_f32_16x16x32_bf16 v[200:203],a[248:251],v[96:99],v[200:203]
buffer_load_dwordx4 v9,s[4:7],s20 offen offset:2048 lds
v_mfma_f32_16x16x32_bf16 v[248:251],a[248:251],v[100:103],v[248:251]
s_add_u32 s20,s20,12288
v_exp_f32 v70,v70
v_mfma_f32_16x16x32_bf16 a[40:43],a[248:251],v[104:107],a[40:43]
s_waitcnt lgkmcnt(1)
ds_read_b128 v[152:155],v23 offset:6144
v_cvt_pk_bf16_f32 v114,v68,v69
v_mfma_f32_16x16x32_bf16 v[204:207],a[252:255],v[96:99],v[204:207]
v_exp_f32 v71,v71
v_mfma_f32_16x16x32_bf16 v[252:255],a[252:255],v[100:103],v[252:255]
v_exp_f32 v76,v76
v_mfma_f32_16x16x32_bf16 a[44:47],a[252:255],v[104:107],a[44:47]
v_exp_f32 v77,v77
v_mfma_f32_16x16x32_bf16 v[32:35],a[192:195],a[96:99],0
v_exp_f32 v78,v78
v_mfma_f32_16x16x32_bf16 v[32:35],a[196:199],a[100:103],v[32:35]
v_exp_f32 v79,v79
v_mfma_f32_16x16x32_bf16 v[32:35],a[200:203],a[104:107],v[32:35]
v_exp_f32 v80,v80
v_mfma_f32_16x16x32_bf16 v[32:35],a[204:207],a[108:111],v[32:35]
s_waitcnt lgkmcnt(1)
buffer_store_dwordx4 v[156:159],v0,s[16:19],s27 offen offset:0 nt
v_mfma_f32_16x16x32_bf16 v[32:35],a[208:211],a[112:115],v[32:35]
v_exp_f32 v81,v81
v_mfma_f32_16x16x32_bf16 v[32:35],a[212:215],a[116:119],v[32:35]
v_exp_f32 v82,v82
v_mfma_f32_16x16x32_bf16 v[40:43],a[192:195],a[120:123],0
ds_read_b128 v[156:159],v31 offset:6144
v_cvt_pk_bf16_f32 v115,v70,v71
v_mfma_f32_16x16x32_bf16 v[40:43],a[196:199],a[124:127],v[40:43]
v_exp_f32 v83,v83
v_mfma_f32_16x16x32_bf16 v[128:131],v[24:27],v[112:115],v[128:131]
v_exp_f32 v84,v84
v_mfma_f32_16x16x32_bf16 v[40:43],a[200:203],a[128:131],v[40:43]
v_exp_f32 v85,v85
v_mfma_f32_16x16x32_bf16 v[40:43],a[204:207],a[132:135],v[40:43]
v_exp_f32 v86,v86
v_mfma_f32_16x16x32_bf16 v[40:43],a[208:211],a[136:139],v[40:43]
v_exp_f32 v87,v87
v_mfma_f32_16x16x32_bf16 v[40:43],a[212:215],a[140:143],v[40:43]
s_waitcnt lgkmcnt(1)
buffer_store_dwordx4 v[152:155],v0,s[16:19],s27 offen offset:1024 nt
v_mfma_f32_16x16x32_bf16 v[48:51],a[192:195],a[144:147],0
v_cvt_pk_bf16_f32 v118,v76,v77
v_cvt_pk_bf16_f32 v119,v78,v79
v_mfma_f32_16x16x32_bf16 v[48:51],a[196:199],a[148:151],v[48:51]
v_cvt_pk_bf16_f32 v120,v80,v81
v_cvt_pk_bf16_f32 v121,v82,v83
v_mfma_f32_16x16x32_bf16 v[132:135],v[24:27],v[116:119],v[132:135]
v_cvt_pk_bf16_f32 v122,v84,v85
v_cvt_pk_bf16_f32 v123,v86,v87
v_mfma_f32_16x16x32_bf16 v[48:51],a[200:203],a[152:155],v[48:51]
v_fma_f32 v32,v32,s36,v16
v_fma_f32 v33,v33,s36,v16
v_mfma_f32_16x16x32_bf16 v[136:139],v[24:27],v[120:123],v[136:139]
v_fma_f32 v34,v34,s36,v16
v_fma_f32 v35,v35,s36,v16
v_mfma_f32_16x16x32_bf16 v[48:51],a[204:207],a[156:159],v[48:51]
v_fma_f32 v40,v40,s36,v17
v_fma_f32 v41,v41,s36,v17
v_mfma_f32_16x16x32_bf16 v[48:51],a[208:211],a[160:163],v[48:51]
s_waitcnt vmcnt(11)
s_waitcnt lgkmcnt(0)
buffer_store_dwordx4 v[156:159],v0,s[16:19],s27 offen offset:2048 nt
s_barrier
v_mfma_f32_16x16x32_bf16 v[48:51],a[212:215],a[164:167],v[48:51]
s_add_u32 s27,s27,3072
v_fma_f32 v42,v42,s36,v17
v_fma_f32 v43,v43,s36,v17
v_mfma_f32_16x16x32_bf16 v[36:39],a[216:219],a[96:99],0
v_exp_f32 v32,v32
v_mfma_f32_16x16x32_bf16 v[36:39],a[220:223],a[100:103],v[36:39]
v_exp_f32 v33,v33
v_mfma_f32_16x16x32_bf16 v[36:39],a[224:227],a[104:107],v[36:39]
v_exp_f32 v34,v34
v_mfma_f32_16x16x32_bf16 v[36:39],a[228:231],a[108:111],v[36:39]
v_exp_f32 v35,v35
v_mfma_f32_16x16x32_bf16 v[36:39],a[232:235],a[112:115],v[36:39]
ds_read_b64_tr_b16 a[240:241],v3 offset:12288
ds_read_b64_tr_b16 a[242:243],v3 offset:18432
v_mfma_f32_16x16x32_bf16 v[36:39],a[236:239],a[116:119],v[36:39]
v_exp_f32 v40,v40
v_mfma_f32_16x16x32_bf16 v[44:47],a[216:219],a[120:123],0
ds_read_b64_tr_b16 a[244:245],v4 offset:12288
ds_read_b64_tr_b16 a[246:247],v4 offset:18432
v_mfma_f32_16x16x32_bf16 v[44:47],a[220:223],a[124:127],v[44:47]
ds_read_b64_tr_b16 a[248:249],v5 offset:12288
ds_read_b64_tr_b16 a[250:251],v5 offset:18432
v_mfma_f32_16x16x32_bf16 v[44:47],a[224:227],a[128:131],v[44:47]
v_exp_f32 v41,v41
v_mfma_f32_16x16x32_bf16 v[44:47],a[228:231],a[132:135],v[44:47]
ds_read_b64_tr_b16 a[252:253],v6 offset:12288
ds_read_b64_tr_b16 a[254:255],v6 offset:18432
v_mfma_f32_16x16x32_bf16 v[44:47],a[232:235],a[136:139],v[44:47]
v_exp_f32 v42,v42
v_mfma_f32_16x16x32_bf16 v[44:47],a[236:239],a[140:143],v[44:47]
v_exp_f32 v43,v43
v_mfma_f32_16x16x32_bf16 v[52:55],a[216:219],a[144:147],0
v_cvt_pk_bf16_f32 v96,v32,v33
v_cvt_pk_bf16_f32 v97,v34,v35
v_mfma_f32_16x16x32_bf16 v[52:55],a[220:223],a[148:151],v[52:55]
v_cvt_pk_bf16_f32 v100,v40,v41
v_cvt_pk_bf16_f32 v101,v42,v43
v_mfma_f32_16x16x32_bf16 v[52:55],a[224:227],a[152:155],v[52:55]
v_mfma_f32_16x16x32_bf16 v[52:55],a[228:231],a[156:159],v[52:55]
v_mfma_f32_16x16x32_bf16 v[52:55],a[232:235],a[160:163],v[52:55]
v_mfma_f32_16x16x32_bf16 v[52:55],a[236:239],a[164:167],v[52:55]
s_waitcnt lgkmcnt(2)
v_mfma_f32_16x16x32_bf16 v[160:163],a[240:243],v[112:115],v[160:163]
s_add_u32 m0,s23,0
ds_read_b128 a[192:195],v1 offset:0
v_fma_f32 v36,v36,s36,v16
v_mfma_f32_16x16x32_bf16 v[208:211],a[240:243],v[116:119],v[208:211]
buffer_load_dwordx4 v7,s[8:11],s21 offen offset:0 lds
v_mfma_f32_16x16x32_bf16 a[0:3],a[240:243],v[120:123],a[0:3]
ds_read_b64_tr_b16 a[240:241],v3 offset:12416
ds_read_b64_tr_b16 a[242:243],v3 offset:18560
v_mfma_f32_16x16x32_bf16 v[164:167],a[244:247],v[112:115],v[164:167]
ds_read_b128 a[196:199],v2 offset:0
v_fma_f32 v37,v37,s36,v16
v_mfma_f32_16x16x32_bf16 v[212:215],a[244:247],v[116:119],v[212:215]
ds_read_b128 a[200:203],v1 offset:128
v_fma_f32 v38,v38,s36,v16
v_mfma_f32_16x16x32_bf16 a[4:7],a[244:247],v[120:123],a[4:7]
ds_read_b64_tr_b16 a[244:245],v4 offset:12416
ds_read_b64_tr_b16 a[246:247],v4 offset:18560
v_mfma_f32_16x16x32_bf16 v[168:171],a[248:251],v[112:115],v[168:171]
ds_read_b128 a[204:207],v2 offset:128
v_fma_f32 v39,v39,s36,v16
v_mfma_f32_16x16x32_bf16 v[216:219],a[248:251],v[116:119],v[216:219]
buffer_load_dwordx4 v8,s[8:11],s21 offen offset:1024 lds
v_mfma_f32_16x16x32_bf16 a[8:11],a[248:251],v[120:123],a[8:11]
s_waitcnt lgkmcnt(7)
ds_read_b64_tr_b16 a[248:249],v5 offset:12416
ds_read_b64_tr_b16 a[250:251],v5 offset:18560
v_mfma_f32_16x16x32_bf16 v[172:175],a[252:255],v[112:115],v[172:175]
ds_read_b128 a[208:211],v1 offset:256
v_fma_f32 v44,v44,s36,v17
v_mfma_f32_16x16x32_bf16 v[220:223],a[252:255],v[116:119],v[220:223]
ds_read_b128 a[212:215],v2 offset:256
v_fma_f32 v45,v45,s36,v17
v_mfma_f32_16x16x32_bf16 a[12:15],a[252:255],v[120:123],a[12:15]
s_waitcnt lgkmcnt(8)
ds_read_b64_tr_b16 a[252:253],v6 offset:12416
ds_read_b64_tr_b16 a[254:255],v6 offset:18560
v_mfma_f32_16x16x32_bf16 v[176:179],a[240:243],v[112:115],v[176:179]
buffer_load_dwordx4 v9,s[8:11],s21 offen offset:2048 lds
v_mfma_f32_16x16x32_bf16 v[224:227],a[240:243],v[116:119],v[224:227]
s_add_u32 s21,s21,12288
ds_read_b128 a[216:219],v1 offset:6144
v_fma_f32 v46,v46,s36,v17
v_mfma_f32_16x16x32_bf16 a[16:19],a[240:243],v[120:123],a[16:19]
s_mov_b32 m0,s26
ds_read_b64_tr_b16 a[240:241],v3 offset:12544
ds_read_b64_tr_b16 a[242:243],v3 offset:18688
s_waitcnt lgkmcnt(9)
v_mfma_f32_16x16x32_bf16 v[180:183],a[244:247],v[112:115],v[180:183]
ds_read_b128 a[220:223],v2 offset:6144
v_fma_f32 v47,v47,s36,v17
v_mfma_f32_16x16x32_bf16 v[228:231],a[244:247],v[116:119],v[228:231]
ds_read_b128 a[224:227],v1 offset:6272
v_fma_f32 v48,v48,s36,v18
v_mfma_f32_16x16x32_bf16 a[20:23],a[244:247],v[120:123],a[20:23]
s_waitcnt lgkmcnt(8)
ds_read_b64_tr_b16 a[244:245],v4 offset:12544
ds_read_b64_tr_b16 a[246:247],v4 offset:18688
v_mfma_f32_16x16x32_bf16 v[184:187],a[248:251],v[112:115],v[184:187]
buffer_load_dwordx4 v7,s[4:7],s20 offen offset:0 lds
v_mfma_f32_16x16x32_bf16 v[232:235],a[248:251],v[116:119],v[232:235]
ds_read_b128 a[228:231],v2 offset:6272
v_fma_f32 v49,v49,s36,v18
v_mfma_f32_16x16x32_bf16 a[24:27],a[248:251],v[120:123],a[24:27]
s_waitcnt lgkmcnt(8)
ds_read_b64_tr_b16 a[248:249],v5 offset:12544
ds_read_b64_tr_b16 a[250:251],v5 offset:18688
v_mfma_f32_16x16x32_bf16 v[188:191],a[252:255],v[112:115],v[188:191]
ds_read_b128 a[232:235],v1 offset:6400
v_fma_f32 v50,v50,s36,v18
v_mfma_f32_16x16x32_bf16 v[236:239],a[252:255],v[116:119],v[236:239]
ds_read_b128 a[236:239],v2 offset:6400
v_fma_f32 v51,v51,s36,v18
v_mfma_f32_16x16x32_bf16 a[28:31],a[252:255],v[120:123],a[28:31]
s_waitcnt lgkmcnt(8)
ds_read_b64_tr_b16 a[252:253],v6 offset:12544
ds_read_b64_tr_b16 a[254:255],v6 offset:18688
v_mfma_f32_16x16x32_bf16 v[192:195],a[240:243],v[112:115],v[192:195]
buffer_load_dwordx4 v8,s[4:7],s20 offen offset:1024 lds
v_mfma_f32_16x16x32_bf16 v[240:243],a[240:243],v[116:119],v[240:243]
v_fma_f32 v52,v52,s36,v18
v_fma_f32 v53,v53,s36,v18
v_mfma_f32_16x16x32_bf16 a[32:35],a[240:243],v[120:123],a[32:35]
s_waitcnt lgkmcnt(7)
v_fma_f32 v54,v54,s36,v18
v_fma_f32 v55,v55,s36,v18
v_mfma_f32_16x16x32_bf16 v[196:199],a[244:247],v[112:115],v[196:199]
v_exp_f32 v36,v36
v_mfma_f32_16x16x32_bf16 v[244:247],a[244:247],v[116:119],v[244:247]
v_exp_f32 v37,v37
v_mfma_f32_16x16x32_bf16 a[36:39],a[244:247],v[120:123],a[36:39]
s_waitcnt lgkmcnt(3)
v_exp_f32 v38,v38
v_mfma_f32_16x16x32_bf16 v[200:203],a[248:251],v[112:115],v[200:203]
buffer_load_dwordx4 v9,s[4:7],s20 offen offset:2048 lds
v_mfma_f32_16x16x32_bf16 v[248:251],a[248:251],v[116:119],v[248:251]
s_add_u32 s20,s20,12288
v_exp_f32 v39,v39
v_mfma_f32_16x16x32_bf16 a[40:43],a[248:251],v[120:123],a[40:43]
s_add_u32 m0,s29,0
v_exp_f32 v44,v44
s_waitcnt lgkmcnt(0)
v_mfma_f32_16x16x32_bf16 v[204:207],a[252:255],v[112:115],v[204:207]
v_exp_f32 v45,v45
v_mfma_f32_16x16x32_bf16 v[252:255],a[252:255],v[116:119],v[252:255]
v_exp_f32 v46,v46
v_mfma_f32_16x16x32_bf16 a[44:47],a[252:255],v[120:123],a[44:47]
v_exp_f32 v47,v47
v_mfma_f32_16x16x32_bf16 v[64:67],a[192:195],a[96:99],0
v_exp_f32 v48,v48
v_mfma_f32_16x16x32_bf16 v[64:67],a[196:199],a[100:103],v[64:67]
v_exp_f32 v49,v49
v_mfma_f32_16x16x32_bf16 v[64:67],a[200:203],a[104:107],v[64:67]
v_exp_f32 v50,v50
v_mfma_f32_16x16x32_bf16 v[64:67],a[204:207],a[108:111],v[64:67]
buffer_load_dwordx4 v7,s[12:15],s28 offen offset:0 nt lds
v_mfma_f32_16x16x32_bf16 v[64:67],a[208:211],a[112:115],v[64:67]
v_exp_f32 v51,v51
v_mfma_f32_16x16x32_bf16 v[64:67],a[212:215],a[116:119],v[64:67]
v_exp_f32 v52,v52
v_mfma_f32_16x16x32_bf16 v[72:75],a[192:195],a[120:123],0
v_exp_f32 v53,v53
v_mfma_f32_16x16x32_bf16 v[72:75],a[196:199],a[124:127],v[72:75]
v_exp_f32 v54,v54
v_mfma_f32_16x16x32_bf16 v[72:75],a[200:203],a[128:131],v[72:75]
v_exp_f32 v55,v55
v_mfma_f32_16x16x32_bf16 v[72:75],a[204:207],a[132:135],v[72:75]
v_cvt_pk_bf16_f32 v98,v36,v37
v_cvt_pk_bf16_f32 v99,v38,v39
v_mfma_f32_16x16x32_bf16 v[72:75],a[208:211],a[136:139],v[72:75]
v_cvt_pk_bf16_f32 v102,v44,v45
v_cvt_pk_bf16_f32 v103,v46,v47
v_mfma_f32_16x16x32_bf16 v[128:131],v[24:27],v[96:99],v[128:131]
v_cvt_pk_bf16_f32 v104,v48,v49
v_cvt_pk_bf16_f32 v105,v50,v51
v_mfma_f32_16x16x32_bf16 v[132:135],v[24:27],v[100:103],v[132:135]
buffer_load_dwordx4 v8,s[12:15],s28 offen offset:1024 nt lds
v_mfma_f32_16x16x32_bf16 v[72:75],a[212:215],a[140:143],v[72:75]
v_cvt_pk_bf16_f32 v106,v52,v53
v_cvt_pk_bf16_f32 v107,v54,v55
v_mfma_f32_16x16x32_bf16 v[80:83],a[192:195],a[144:147],0
v_fma_f32 v64,v64,s36,v16
v_fma_f32 v65,v65,s36,v16
v_mfma_f32_16x16x32_bf16 v[136:139],v[24:27],v[104:107],v[136:139]
v_fma_f32 v66,v66,s36,v16
v_fma_f32 v67,v67,s36,v16
v_mfma_f32_16x16x32_bf16 v[80:83],a[196:199],a[148:151],v[80:83]
v_fma_f32 v72,v72,s36,v17
v_fma_f32 v73,v73,s36,v17
v_mfma_f32_16x16x32_bf16 v[80:83],a[200:203],a[152:155],v[80:83]
v_fma_f32 v74,v74,s36,v17
v_fma_f32 v75,v75,s36,v17
v_mfma_f32_16x16x32_bf16 v[80:83],a[204:207],a[156:159],v[80:83]
v_exp_f32 v64,v64
v_mfma_f32_16x16x32_bf16 v[80:83],a[208:211],a[160:163],v[80:83]
s_waitcnt vmcnt(11)
buffer_load_dwordx4 v9,s[12:15],s28 offen offset:2048 nt lds
s_barrier
v_mfma_f32_16x16x32_bf16 v[80:83],a[212:215],a[164:167],v[80:83]
s_add_u32 s28,s28,3072
v_exp_f32 v65,v65
v_mfma_f32_16x16x32_bf16 v[68:71],a[216:219],a[96:99],0
s_add_u32 s29,s29,3072
s_add_u32 s25,s24,18432
s_add_u32 s26,s22,12288
s_add_u32 s38,s38,1
s_cmp_lt_u32 s38,2
v_mfma_f32_16x16x32_bf16 v[68:71],a[220:223],a[100:103],v[68:71]
v_exp_f32 v66,v66
v_mfma_f32_16x16x32_bf16 v[68:71],a[224:227],a[104:107],v[68:71]
v_exp_f32 v67,v67
v_mfma_f32_16x16x32_bf16 v[68:71],a[228:231],a[108:111],v[68:71]
v_exp_f32 v72,v72
v_mfma_f32_16x16x32_bf16 v[68:71],a[232:235],a[112:115],v[68:71]
ds_read_b64_tr_b16 a[240:241],v3 offset:24576
ds_read_b64_tr_b16 a[242:243],v3 offset:30720
v_mfma_f32_16x16x32_bf16 v[68:71],a[236:239],a[116:119],v[68:71]
ds_read_b64_tr_b16 a[244:245],v4 offset:24576
ds_read_b64_tr_b16 a[246:247],v4 offset:30720
v_mfma_f32_16x16x32_bf16 v[76:79],a[216:219],a[120:123],0
v_exp_f32 v73,v73
v_mfma_f32_16x16x32_bf16 v[76:79],a[220:223],a[124:127],v[76:79]
ds_read_b64_tr_b16 a[248:249],v5 offset:24576
ds_read_b64_tr_b16 a[250:251],v5 offset:30720
v_mfma_f32_16x16x32_bf16 v[76:79],a[224:227],a[128:131],v[76:79]
ds_read_b64_tr_b16 a[252:253],v6 offset:24576
ds_read_b64_tr_b16 a[254:255],v6 offset:30720
v_mfma_f32_16x16x32_bf16 v[76:79],a[228:231],a[132:135],v[76:79]
v_exp_f32 v74,v74
v_mfma_f32_16x16x32_bf16 v[76:79],a[232:235],a[136:139],v[76:79]
v_exp_f32 v75,v75
v_mfma_f32_16x16x32_bf16 v[76:79],a[236:239],a[140:143],v[76:79]
v_cvt_pk_bf16_f32 v112,v64,v65
v_cvt_pk_bf16_f32 v113,v66,v67
v_mfma_f32_16x16x32_bf16 v[84:87],a[216:219],a[144:147],0
v_cvt_pk_bf16_f32 v116,v72,v73
v_cvt_pk_bf16_f32 v117,v74,v75
v_mfma_f32_16x16x32_bf16 v[84:87],a[220:223],a[148:151],v[84:87]
v_add_u32 v11,9216,v11
v_add_u32 v23,9216,v23
v_mfma_f32_16x16x32_bf16 v[84:87],a[224:227],a[152:155],v[84:87]
v_add_u32 v31,9216,v31
v_mfma_f32_16x16x32_bf16 v[84:87],a[228:231],a[156:159],v[84:87]
v_mfma_f32_16x16x32_bf16 v[84:87],a[232:235],a[160:163],v[84:87]
v_mfma_f32_16x16x32_bf16 v[84:87],a[236:239],a[164:167],v[84:87]
s_cbranch_scc1 L_loop3w1
s_cmp_ge_u32 s69,8
s_cbranch_scc1 L_end3
s_cmp_eq_u32 s40,0
s_cbranch_scc1 L_tr33
s_branch L_tr34
L_tr34:
s_waitcnt vmcnt(36)
s_waitcnt lgkmcnt(4)
v_mfma_f32_16x16x32_bf16 v[160:163],a[240:243],v[96:99],v[160:163]
s_add_u32 m0,s24,0
ds_read_b128 a[96:99],v28 offset:0
v_fma_f32 v68,v68,s36,v16
v_mfma_f32_16x16x32_bf16 v[208:211],a[240:243],v[100:103],v[208:211]
ds_read_b128 a[100:103],v29 offset:0
v_fma_f32 v69,v69,s36,v16
v_mfma_f32_16x16x32_bf16 a[0:3],a[240:243],v[104:107],a[0:3]
ds_read_b128 a[104:107],v28 offset:128
v_fma_f32 v70,v70,s36,v16
v_mfma_f32_16x16x32_bf16 v[164:167],a[244:247],v[96:99],v[164:167]
ds_read_b128 a[108:111],v29 offset:128
v_fma_f32 v71,v71,s36,v16
v_mfma_f32_16x16x32_bf16 v[212:215],a[244:247],v[100:103],v[212:215]
ds_read_b128 a[112:115],v28 offset:256
v_fma_f32 v76,v76,s36,v17
v_mfma_f32_16x16x32_bf16 a[4:7],a[244:247],v[104:107],a[4:7]
s_waitcnt lgkmcnt(5)
ds_read_b128 a[116:119],v29 offset:256
v_fma_f32 v77,v77,s36,v17
v_mfma_f32_16x16x32_bf16 v[168:171],a[248:251],v[96:99],v[168:171]
ds_read_b64_tr_b16 a[240:241],v3 offset:24704
ds_read_b64_tr_b16 a[242:243],v3 offset:30848
v_mfma_f32_16x16x32_bf16 v[216:219],a[248:251],v[100:103],v[216:219]
ds_read_b64_tr_b16 a[244:245],v4 offset:24704
ds_read_b64_tr_b16 a[246:247],v4 offset:30848
v_mfma_f32_16x16x32_bf16 a[8:11],a[248:251],v[104:107],a[8:11]
ds_read_b64_tr_b16 a[248:249],v5 offset:24704
ds_read_b64_tr_b16 a[250:251],v5 offset:30848
v_mfma_f32_16x16x32_bf16 v[172:175],a[252:255],v[96:99],v[172:175]
ds_read_b128 a[192:195],v13 offset:0
v_fma_f32 v78,v78,s36,v17
v_mfma_f32_16x16x32_bf16 v[220:223],a[252:255],v[100:103],v[220:223]
ds_read_b128 a[196:199],v14 offset:0
v_fma_f32 v79,v79,s36,v17
v_mfma_f32_16x16x32_bf16 a[12:15],a[252:255],v[104:107],a[12:15]
ds_read_b64_tr_b16 a[252:253],v6 offset:24704
ds_read_b64_tr_b16 a[254:255],v6 offset:30848
ds_read_b128 a[200:203],v13 offset:128
v_fma_f32 v80,v80,s36,v18
v_fma_f32 v81,v81,s36,v18
v_fma_f32 v82,v82,s36,v18
v_fma_f32 v83,v83,s36,v18
v_fma_f32 v84,v84,s36,v18
v_fma_f32 v85,v85,s36,v18
v_fma_f32 v86,v86,s36,v18
v_fma_f32 v87,v87,s36,v18
v_exp_f32 v68,v68
v_exp_f32 v69,v69
v_exp_f32 v70,v70
s_waitcnt lgkmcnt(9)
v_mfma_f32_16x16x32_bf16 v[176:179],a[240:243],v[96:99],v[176:179]
buffer_load_dwordx4 v7,s[12:15],s28 offen offset:0 nt lds
v_mfma_f32_16x16x32_bf16 v[224:227],a[240:243],v[100:103],v[224:227]
ds_read_b128 a[204:207],v14 offset:128
v_exp_f32 v71,v71
v_mfma_f32_16x16x32_bf16 a[16:19],a[240:243],v[104:107],a[16:19]
s_waitcnt lgkmcnt(4)
ds_read_b64_tr_b16 a[240:241],v3 offset:24832
ds_read_b64_tr_b16 a[242:243],v3 offset:30976
v_mfma_f32_16x16x32_bf16 v[180:183],a[244:247],v[96:99],v[180:183]
ds_read_b128 a[208:211],v13 offset:256
v_exp_f32 v76,v76
v_mfma_f32_16x16x32_bf16 v[228:231],a[244:247],v[100:103],v[228:231]
ds_read_b128 a[212:215],v14 offset:256
v_exp_f32 v77,v77
v_mfma_f32_16x16x32_bf16 a[20:23],a[244:247],v[104:107],a[20:23]
buffer_load_dwordx4 v8,s[12:15],s28 offen offset:1024 nt lds
v_mfma_f32_16x16x32_bf16 v[184:187],a[248:251],v[96:99],v[184:187]
ds_read_b64_tr_b16 a[244:245],v4 offset:24832
ds_read_b64_tr_b16 a[246:247],v4 offset:30976
v_mfma_f32_16x16x32_bf16 v[232:235],a[248:251],v[100:103],v[232:235]
ds_read_b128 a[216:219],v13 offset:45056
v_exp_f32 v78,v78
v_mfma_f32_16x16x32_bf16 a[24:27],a[248:251],v[104:107],a[24:27]
s_waitcnt lgkmcnt(7)
ds_read_b64_tr_b16 a[248:249],v5 offset:24832
ds_read_b64_tr_b16 a[250:251],v5 offset:30976
v_mfma_f32_16x16x32_bf16 v[188:191],a[252:255],v[96:99],v[188:191]
ds_read_b128 a[220:223],v14 offset:45056
v_exp_f32 v79,v79
v_mfma_f32_16x16x32_bf16 v[236:239],a[252:255],v[100:103],v[236:239]
ds_read_b128 a[224:227],v13 offset:45184
v_exp_f32 v80,v80
v_mfma_f32_16x16x32_bf16 a[28:31],a[252:255],v[104:107],a[28:31]
s_waitcnt lgkmcnt(7)
ds_read_b64_tr_b16 a[252:253],v6 offset:24832
ds_read_b64_tr_b16 a[254:255],v6 offset:30976
v_mfma_f32_16x16x32_bf16 v[192:195],a[240:243],v[96:99],v[192:195]
ds_read_b128 a[228:231],v14 offset:45184
v_exp_f32 v81,v81
v_mfma_f32_16x16x32_bf16 v[240:243],a[240:243],v[100:103],v[240:243]
buffer_load_dwordx4 v9,s[12:15],s28 offen offset:2048 nt lds
s_add_u32 s28,s28,3072
s_add_u32 m0,s24,3072
v_mfma_f32_16x16x32_bf16 a[32:35],a[240:243],v[104:107],a[32:35]
s_waitcnt lgkmcnt(7)
ds_read_b128 a[232:235],v13 offset:45312
v_exp_f32 v82,v82
v_mfma_f32_16x16x32_bf16 v[196:199],a[244:247],v[96:99],v[196:199]
ds_read_b128 a[236:239],v14 offset:45312
v_exp_f32 v83,v83
v_mfma_f32_16x16x32_bf16 v[244:247],a[244:247],v[100:103],v[244:247]
ds_read_b128 a[120:123],v28 offset:6144
v_exp_f32 v84,v84
v_mfma_f32_16x16x32_bf16 a[36:39],a[244:247],v[104:107],a[36:39]
s_waitcnt lgkmcnt(6)
ds_read_b128 a[124:127],v29 offset:6144
v_exp_f32 v85,v85
v_mfma_f32_16x16x32_bf16 v[200:203],a[248:251],v[96:99],v[200:203]
ds_read_b128 a[128:131],v28 offset:6272
v_exp_f32 v86,v86
v_mfma_f32_16x16x32_bf16 v[248:251],a[248:251],v[100:103],v[248:251]
ds_read_b128 a[132:135],v29 offset:6272
v_exp_f32 v87,v87
v_mfma_f32_16x16x32_bf16 a[40:43],a[248:251],v[104:107],a[40:43]
ds_read_b128 a[136:139],v28 offset:6400
buffer_load_dwordx4 v7,s[12:15],s28 offen offset:0 nt lds
s_waitcnt lgkmcnt(7)
v_mfma_f32_16x16x32_bf16 v[204:207],a[252:255],v[96:99],v[204:207]
ds_read_b128 a[140:143],v29 offset:6400
v_cvt_pk_bf16_f32 v114,v68,v69
v_mfma_f32_16x16x32_bf16 v[252:255],a[252:255],v[100:103],v[252:255]
v_cvt_pk_bf16_f32 v115,v70,v71
v_cvt_pk_bf16_f32 v118,v76,v77
v_mfma_f32_16x16x32_bf16 a[44:47],a[252:255],v[104:107],a[44:47]
v_cvt_pk_bf16_f32 v119,v78,v79
v_cvt_pk_bf16_f32 v120,v80,v81
v_mfma_f32_16x16x32_bf16 v[128:131],v[24:27],v[112:115],v[128:131]
v_cvt_pk_bf16_f32 v121,v82,v83
v_cvt_pk_bf16_f32 v122,v84,v85
v_mfma_f32_16x16x32_bf16 v[132:135],v[24:27],v[116:119],v[132:135]
v_cvt_pk_bf16_f32 v123,v86,v87
buffer_load_dwordx4 v8,s[12:15],s28 offen offset:1024 nt lds
buffer_load_dwordx4 v9,s[12:15],s28 offen offset:2048 nt lds
s_waitcnt vmcnt(12)
s_waitcnt lgkmcnt(3)
s_barrier
v_mfma_f32_16x16x32_bf16 v[136:139],v[24:27],v[120:123],v[136:139]
s_add_u32 s28,s28,3072
ds_read_b64_tr_b16 a[240:241],v3 offset:0
ds_read_b64_tr_b16 a[242:243],v3 offset:6144
ds_read_b64_tr_b16 a[244:245],v4 offset:0
ds_read_b64_tr_b16 a[246:247],v4 offset:6144
ds_read_b64_tr_b16 a[248:249],v5 offset:0
ds_read_b64_tr_b16 a[250:251],v5 offset:6144
ds_read_b64_tr_b16 a[252:253],v6 offset:0
ds_read_b64_tr_b16 a[254:255],v6 offset:6144
s_waitcnt lgkmcnt(6)
v_mfma_f32_16x16x32_bf16 v[160:163],a[240:243],v[112:115],v[160:163]
v_rcp_f32 v146,v132
v_mfma_f32_16x16x32_bf16 v[208:211],a[240:243],v[116:119],v[208:211]
v_rcp_f32 v148,v136
v_mfma_f32_16x16x32_bf16 a[0:3],a[240:243],v[120:123],a[0:3]
s_waitcnt lgkmcnt(4)
ds_read_b64_tr_b16 a[240:241],v3 offset:128
ds_read_b64_tr_b16 a[242:243],v3 offset:6272
v_mfma_f32_16x16x32_bf16 v[164:167],a[244:247],v[112:115],v[164:167]
v_rcp_f32 v144,v128
v_mfma_f32_16x16x32_bf16 v[212:215],a[244:247],v[116:119],v[212:215]
v_max3_f32 v30,v128,v132,v136
v_cmp_ngt_f32 vcc,s37,v30
v_mfma_f32_16x16x32_bf16 a[4:7],a[244:247],v[120:123],a[4:7]
s_waitcnt lgkmcnt(4)
ds_read_b64_tr_b16 a[244:245],v4 offset:128
ds_read_b64_tr_b16 a[246:247],v4 offset:6272
v_mfma_f32_16x16x32_bf16 v[168:171],a[248:251],v[112:115],v[168:171]
s_cmp_lg_u64 vcc,0
v_accvgpr_read_b32 v64,a0
v_accvgpr_read_b32 v65,a1
v_mfma_f32_16x16x32_bf16 v[216:219],a[248:251],v[116:119],v[216:219]
s_cselect_b32 s62,s32,0
v_accvgpr_read_b32 v66,a2
v_accvgpr_read_b32 v67,a3
v_mfma_f32_16x16x32_bf16 a[8:11],a[248:251],v[120:123],a[8:11]
s_or_b32 s31,s31,s62
ds_read_b64_tr_b16 a[248:249],v5 offset:128
ds_read_b64_tr_b16 a[250:251],v5 offset:6272
s_waitcnt lgkmcnt(6)
v_mfma_f32_16x16x32_bf16 v[172:175],a[252:255],v[112:115],v[172:175]
s_lshl_b32 s32,s32,1
v_accvgpr_read_b32 v68,a4
v_accvgpr_read_b32 v69,a5
v_mfma_f32_16x16x32_bf16 v[220:223],a[252:255],v[116:119],v[220:223]
s_add_u32 m0,s22,24576
v_accvgpr_read_b32 v70,a6
v_accvgpr_read_b32 v71,a7
v_mfma_f32_16x16x32_bf16 a[12:15],a[252:255],v[120:123],a[12:15]
buffer_load_dwordx4 v7,s[4:7],s20 offen offset:0 lds
s_waitcnt lgkmcnt(4)
v_mfma_f32_16x16x32_bf16 v[176:179],a[240:243],v[112:115],v[176:179]
ds_read_b64_tr_b16 a[252:253],v6 offset:128
ds_read_b64_tr_b16 a[254:255],v6 offset:6272
v_mfma_f32_16x16x32_bf16 v[224:227],a[240:243],v[116:119],v[224:227]
v_accvgpr_read_b32 v72,a8
v_accvgpr_read_b32 v73,a9
v_mfma_f32_16x16x32_bf16 a[16:19],a[240:243],v[120:123],a[16:19]
s_waitcnt lgkmcnt(4)
ds_read_b64_tr_b16 a[240:241],v3 offset:256
ds_read_b64_tr_b16 a[242:243],v3 offset:6400
v_mfma_f32_16x16x32_bf16 v[180:183],a[244:247],v[112:115],v[180:183]
v_accvgpr_read_b32 v74,a10
v_accvgpr_read_b32 v75,a11
v_mfma_f32_16x16x32_bf16 v[228:231],a[244:247],v[116:119],v[228:231]
v_accvgpr_read_b32 v76,a12
v_accvgpr_read_b32 v77,a13
v_accvgpr_read_b32 v78,a14
v_accvgpr_read_b32 v79,a15
v_subrev_u32 v11,18432,v11
v_pk_mul_f32 v[208:209],v[208:209],v[146:147] op_sel_hi:[1,0]
v_pk_mul_f32 v[210:211],v[210:211],v[146:147] op_sel_hi:[1,0]
v_pk_mul_f32 v[224:225],v[224:225],v[146:147] op_sel_hi:[1,0]
v_pk_mul_f32 v[226:227],v[226:227],v[146:147] op_sel_hi:[1,0]
v_cvt_pk_bf16_f32 v80,v208,v209
v_cvt_pk_bf16_f32 v81,v210,v211
v_mfma_f32_16x16x32_bf16 a[20:23],a[244:247],v[120:123],a[20:23]
s_waitcnt lgkmcnt(4)
ds_read_b64_tr_b16 a[244:245],v4 offset:256
ds_read_b64_tr_b16 a[246:247],v4 offset:6400
v_mfma_f32_16x16x32_bf16 v[184:187],a[248:251],v[112:115],v[184:187]
v_cvt_pk_bf16_f32 v82,v224,v225
v_cvt_pk_bf16_f32 v83,v226,v227
v_mfma_f32_16x16x32_bf16 v[232:235],a[248:251],v[116:119],v[232:235]
ds_write2st64_b64 v12,v[80:81],v[82:83] offset0:12 offset1:14
v_pk_mul_f32 v[212:213],v[212:213],v[146:147] op_sel_hi:[1,0]
v_pk_mul_f32 v[214:215],v[214:215],v[146:147] op_sel_hi:[1,0]
v_pk_mul_f32 v[228:229],v[228:229],v[146:147] op_sel_hi:[1,0]
v_pk_mul_f32 v[230:231],v[230:231],v[146:147] op_sel_hi:[1,0]
v_cvt_pk_bf16_f32 v84,v212,v213
v_cvt_pk_bf16_f32 v85,v214,v215
v_mfma_f32_16x16x32_bf16 a[24:27],a[248:251],v[120:123],a[24:27]
buffer_load_dwordx4 v8,s[4:7],s20 offen offset:1024 lds
s_waitcnt lgkmcnt(3)
v_mfma_f32_16x16x32_bf16 v[188:191],a[252:255],v[112:115],v[188:191]
ds_read_b64_tr_b16 a[248:249],v5 offset:256
ds_read_b64_tr_b16 a[250:251],v5 offset:6400
v_mfma_f32_16x16x32_bf16 v[236:239],a[252:255],v[116:119],v[236:239]
v_cvt_pk_bf16_f32 v86,v228,v229
v_cvt_pk_bf16_f32 v87,v230,v231
v_subrev_u32 v23,18432,v23
v_subrev_u32 v31,18432,v31
v_pk_mul_f32 v[216:217],v[216:217],v[146:147] op_sel_hi:[1,0]
v_pk_mul_f32 v[218:219],v[218:219],v[146:147] op_sel_hi:[1,0]
v_pk_mul_f32 v[232:233],v[232:233],v[146:147] op_sel_hi:[1,0]
v_pk_mul_f32 v[234:235],v[234:235],v[146:147] op_sel_hi:[1,0]
v_cvt_pk_bf16_f32 v88,v216,v217
v_cvt_pk_bf16_f32 v89,v218,v219
v_mfma_f32_16x16x32_bf16 a[28:31],a[252:255],v[120:123],a[28:31]
ds_read_b64_tr_b16 a[252:253],v6 offset:256
ds_read_b64_tr_b16 a[254:255],v6 offset:6400
v_mfma_f32_16x16x32_bf16 v[192:195],a[240:243],v[112:115],v[192:195]
ds_write2st64_b64 v20,v[84:85],v[86:87] offset0:12 offset1:14
v_mfma_f32_16x16x32_bf16 v[240:243],a[240:243],v[116:119],v[240:243]
v_cvt_pk_bf16_f32 v90,v232,v233
v_cvt_pk_bf16_f32 v91,v234,v235
v_pk_mul_f32 v[220:221],v[220:221],v[146:147] op_sel_hi:[1,0]
v_pk_mul_f32 v[222:223],v[222:223],v[146:147] op_sel_hi:[1,0]
v_pk_mul_f32 v[236:237],v[236:237],v[146:147] op_sel_hi:[1,0]
v_pk_mul_f32 v[238:239],v[238:239],v[146:147] op_sel_hi:[1,0]
v_cvt_pk_bf16_f32 v92,v220,v221
v_cvt_pk_bf16_f32 v93,v222,v223
v_mfma_f32_16x16x32_bf16 a[32:35],a[240:243],v[120:123],a[32:35]
s_waitcnt lgkmcnt(3)
ds_write2st64_b64 v21,v[88:89],v[90:91] offset0:12 offset1:14
v_mfma_f32_16x16x32_bf16 v[196:199],a[244:247],v[112:115],v[196:199]
v_cvt_pk_bf16_f32 v94,v236,v237
v_cvt_pk_bf16_f32 v95,v238,v239
v_mfma_f32_16x16x32_bf16 v[244:247],a[244:247],v[116:119],v[244:247]
ds_write2st64_b64 v22,v[92:93],v[94:95] offset0:12 offset1:14
v_pk_mul_f32 v[240:241],v[240:241],v[146:147] op_sel_hi:[1,0]
v_pk_mul_f32 v[242:243],v[242:243],v[146:147] op_sel_hi:[1,0]
v_pk_mul_f32 v[64:65],v[64:65],v[148:149] op_sel_hi:[1,0]
v_pk_mul_f32 v[66:67],v[66:67],v[148:149] op_sel_hi:[1,0]
v_cvt_pk_bf16_f32 v82,v64,v65
v_cvt_pk_bf16_f32 v83,v66,v67
v_mfma_f32_16x16x32_bf16 a[36:39],a[244:247],v[120:123],a[36:39]
v_accvgpr_read_b32 v64,a16
v_accvgpr_read_b32 v65,a17
v_mfma_f32_16x16x32_bf16 v[200:203],a[248:251],v[112:115],v[200:203]
buffer_load_dwordx4 v9,s[4:7],s20 offen offset:2048 lds
s_add_u32 s20,s20,12288
s_add_u32 m0,s23,0
v_mfma_f32_16x16x32_bf16 v[248:251],a[248:251],v[116:119],v[248:251]
v_accvgpr_read_b32 v66,a18
v_accvgpr_read_b32 v67,a19
v_cvt_pk_bf16_f32 v80,v240,v241
v_cvt_pk_bf16_f32 v81,v242,v243
v_pk_mul_f32 v[244:245],v[244:245],v[146:147] op_sel_hi:[1,0]
v_pk_mul_f32 v[246:247],v[246:247],v[146:147] op_sel_hi:[1,0]
v_pk_mul_f32 v[68:69],v[68:69],v[148:149] op_sel_hi:[1,0]
v_pk_mul_f32 v[70:71],v[70:71],v[148:149] op_sel_hi:[1,0]
v_cvt_pk_bf16_f32 v86,v68,v69
v_cvt_pk_bf16_f32 v87,v70,v71
v_mfma_f32_16x16x32_bf16 a[40:43],a[248:251],v[120:123],a[40:43]
s_waitcnt lgkmcnt(0)
v_accvgpr_read_b32 v68,a32
v_accvgpr_read_b32 v69,a33
v_mfma_f32_16x16x32_bf16 v[204:207],a[252:255],v[112:115],v[204:207]
v_accvgpr_read_b32 v70,a34
v_accvgpr_read_b32 v71,a35
v_mfma_f32_16x16x32_bf16 v[252:255],a[252:255],v[116:119],v[252:255]
v_cvt_pk_bf16_f32 v84,v244,v245
v_cvt_pk_bf16_f32 v85,v246,v247
v_pk_mul_f32 v[248:249],v[248:249],v[146:147] op_sel_hi:[1,0]
v_pk_mul_f32 v[250:251],v[250:251],v[146:147] op_sel_hi:[1,0]
v_pk_mul_f32 v[72:73],v[72:73],v[148:149] op_sel_hi:[1,0]
v_pk_mul_f32 v[74:75],v[74:75],v[148:149] op_sel_hi:[1,0]
v_cvt_pk_bf16_f32 v90,v72,v73
v_cvt_pk_bf16_f32 v91,v74,v75
v_mfma_f32_16x16x32_bf16 a[44:47],a[252:255],v[120:123],a[44:47]
v_accvgpr_read_b32 v72,a20
v_accvgpr_read_b32 v73,a21
v_mfma_f32_16x16x32_bf16 v[32:35],a[192:195],a[96:99],0
v_accvgpr_read_b32 v74,a22
v_accvgpr_read_b32 v75,a23
v_mfma_f32_16x16x32_bf16 v[32:35],a[196:199],a[100:103],v[32:35]
v_cvt_pk_bf16_f32 v88,v248,v249
v_cvt_pk_bf16_f32 v89,v250,v251
s_waitcnt vmcnt(9)
ds_read_b128 a[144:147],v28 offset:12288
v_pk_mul_f32 v[252:253],v[252:253],v[146:147] op_sel_hi:[1,0]
v_pk_mul_f32 v[254:255],v[254:255],v[146:147] op_sel_hi:[1,0]
v_pk_mul_f32 v[76:77],v[76:77],v[148:149] op_sel_hi:[1,0]
v_pk_mul_f32 v[78:79],v[78:79],v[148:149] op_sel_hi:[1,0]
v_cvt_pk_bf16_f32 v94,v76,v77
v_cvt_pk_bf16_f32 v95,v78,v79
v_mfma_f32_16x16x32_bf16 v[32:35],a[200:203],a[104:107],v[32:35]
ds_read_b128 a[148:151],v29 offset:12288
v_accvgpr_read_b32 v76,a36
v_mfma_f32_16x16x32_bf16 v[32:35],a[204:207],a[108:111],v[32:35]
ds_read_b128 a[152:155],v28 offset:12416
v_accvgpr_read_b32 v77,a37
v_accvgpr_read_b32 v78,a38
v_accvgpr_read_b32 v79,a39
v_cvt_pk_bf16_f32 v92,v252,v253
v_pk_mul_f32 v[64:65],v[64:65],v[148:149] op_sel_hi:[1,0]
v_pk_mul_f32 v[66:67],v[66:67],v[148:149] op_sel_hi:[1,0]
v_pk_mul_f32 v[68:69],v[68:69],v[148:149] op_sel_hi:[1,0]
v_pk_mul_f32 v[70:71],v[70:71],v[148:149] op_sel_hi:[1,0]
s_waitcnt vmcnt(12)
s_barrier
v_mfma_f32_16x16x32_bf16 v[32:35],a[208:211],a[112:115],v[32:35]
ds_read_b128 a[156:159],v29 offset:12416
v_cvt_pk_bf16_f32 v93,v254,v255
v_mfma_f32_16x16x32_bf16 v[32:35],a[212:215],a[116:119],v[32:35]
ds_read_b128 a[160:163],v28 offset:12544
v_mfma_f32_16x16x32_bf16 v[36:39],a[216:219],a[96:99],0
ds_read_b128 a[164:167],v29 offset:12544
v_mfma_f32_16x16x32_bf16 v[36:39],a[220:223],a[100:103],v[36:39]
ds_write2st64_b64 v12,v[80:81],v[82:83] offset0:16 offset1:24
v_pk_mul_f32 v[72:73],v[72:73],v[148:149] op_sel_hi:[1,0]
v_pk_mul_f32 v[74:75],v[74:75],v[148:149] op_sel_hi:[1,0]
v_pk_mul_f32 v[76:77],v[76:77],v[148:149] op_sel_hi:[1,0]
v_pk_mul_f32 v[78:79],v[78:79],v[148:149] op_sel_hi:[1,0]
v_cvt_pk_bf16_f32 v80,v64,v65
v_cvt_pk_bf16_f32 v81,v66,v67
v_mfma_f32_16x16x32_bf16 v[36:39],a[224:227],a[104:107],v[36:39]
buffer_load_dwordx4 v7,s[8:11],s21 offen offset:0 lds
v_mfma_f32_16x16x32_bf16 v[36:39],a[228:231],a[108:111],v[36:39]
v_cvt_pk_bf16_f32 v82,v68,v69
v_cvt_pk_bf16_f32 v83,v70,v71
v_mfma_f32_16x16x32_bf16 v[36:39],a[232:235],a[112:115],v[36:39]
ds_write2st64_b64 v20,v[84:85],v[86:87] offset0:16 offset1:24
v_mfma_f32_16x16x32_bf16 v[36:39],a[236:239],a[116:119],v[36:39]
v_accvgpr_read_b32 v64,a24
v_accvgpr_read_b32 v65,a25
v_accvgpr_read_b32 v66,a26
v_accvgpr_read_b32 v67,a27
v_accvgpr_read_b32 v68,a40
v_pk_mul_f32 v[64:65],v[64:65],v[148:149] op_sel_hi:[1,0]
v_pk_mul_f32 v[66:67],v[66:67],v[148:149] op_sel_hi:[1,0]
v_accvgpr_read_b32 v69,a41
v_pk_mul_f32 v[68:69],v[68:69],v[148:149] op_sel_hi:[1,0]
v_accvgpr_read_b32 v70,a42
v_accvgpr_read_b32 v71,a43
v_pk_mul_f32 v[70:71],v[70:71],v[148:149] op_sel_hi:[1,0]
v_cvt_pk_bf16_f32 v84,v72,v73
v_cvt_pk_bf16_f32 v85,v74,v75
v_mfma_f32_16x16x32_bf16 v[40:43],a[192:195],a[120:123],0
ds_write2st64_b64 v21,v[88:89],v[90:91] offset0:16 offset1:24
v_mfma_f32_16x16x32_bf16 v[40:43],a[196:199],a[124:127],v[40:43]
v_cvt_pk_bf16_f32 v86,v76,v77
v_cvt_pk_bf16_f32 v87,v78,v79
v_mfma_f32_16x16x32_bf16 v[40:43],a[200:203],a[128:131],v[40:43]
v_accvgpr_read_b32 v72,a28
v_accvgpr_read_b32 v73,a29
v_mfma_f32_16x16x32_bf16 v[40:43],a[204:207],a[132:135],v[40:43]
buffer_load_dwordx4 v8,s[8:11],s21 offen offset:1024 lds
v_accvgpr_read_b32 v74,a30
v_accvgpr_read_b32 v75,a31
v_pk_mul_f32 v[72:73],v[72:73],v[148:149] op_sel_hi:[1,0]
v_pk_mul_f32 v[74:75],v[74:75],v[148:149] op_sel_hi:[1,0]
v_accvgpr_read_b32 v76,a44
v_accvgpr_read_b32 v77,a45
v_pk_mul_f32 v[76:77],v[76:77],v[148:149] op_sel_hi:[1,0]
v_accvgpr_read_b32 v78,a46
v_accvgpr_read_b32 v79,a47
v_pk_mul_f32 v[78:79],v[78:79],v[148:149] op_sel_hi:[1,0]
v_cvt_pk_bf16_f32 v88,v64,v65
v_cvt_pk_bf16_f32 v89,v66,v67
v_mfma_f32_16x16x32_bf16 v[40:43],a[208:211],a[136:139],v[40:43]
ds_write2st64_b64 v22,v[92:93],v[94:95] offset0:16 offset1:24
v_mfma_f32_16x16x32_bf16 v[40:43],a[212:215],a[140:143],v[40:43]
v_cvt_pk_bf16_f32 v90,v68,v69
v_cvt_pk_bf16_f32 v91,v70,v71
v_mfma_f32_16x16x32_bf16 v[44:47],a[216:219],a[120:123],0
v_cvt_pk_bf16_f32 v92,v72,v73
v_cvt_pk_bf16_f32 v93,v74,v75
v_mfma_f32_16x16x32_bf16 v[44:47],a[220:223],a[124:127],v[44:47]
ds_write2st64_b64 v12,v[80:81],v[82:83] offset0:26 offset1:28
v_pk_mul_f32 v[160:161],v[160:161],v[144:145] op_sel_hi:[1,0]
v_pk_mul_f32 v[162:163],v[162:163],v[144:145] op_sel_hi:[1,0]
v_pk_mul_f32 v[176:177],v[176:177],v[144:145] op_sel_hi:[1,0]
v_pk_mul_f32 v[178:179],v[178:179],v[144:145] op_sel_hi:[1,0]
v_cvt_pk_bf16_f32 v94,v76,v77
v_cvt_pk_bf16_f32 v95,v78,v79
v_mfma_f32_16x16x32_bf16 v[44:47],a[224:227],a[128:131],v[44:47]
ds_write2st64_b64 v20,v[84:85],v[86:87] offset0:26 offset1:28
v_mfma_f32_16x16x32_bf16 v[44:47],a[228:231],a[132:135],v[44:47]
v_cvt_pk_bf16_f32 v80,v160,v161
v_cvt_pk_bf16_f32 v81,v162,v163
v_mfma_f32_16x16x32_bf16 v[44:47],a[232:235],a[136:139],v[44:47]
v_cvt_pk_bf16_f32 v82,v176,v177
v_cvt_pk_bf16_f32 v83,v178,v179
v_mfma_f32_16x16x32_bf16 v[44:47],a[236:239],a[140:143],v[44:47]
buffer_load_dwordx4 v9,s[8:11],s21 offen offset:2048 lds
s_add_u32 s21,s21,12288
s_mov_b32 s27,s42
s_mov_b32 s42,s41
s_add_u32 s69,s69,1
v_pk_mul_f32 v[164:165],v[164:165],v[144:145] op_sel_hi:[1,0]
v_pk_mul_f32 v[166:167],v[166:167],v[144:145] op_sel_hi:[1,0]
v_pk_mul_f32 v[180:181],v[180:181],v[144:145] op_sel_hi:[1,0]
v_pk_mul_f32 v[182:183],v[182:183],v[144:145] op_sel_hi:[1,0]
v_cvt_pk_bf16_f32 v84,v164,v165
v_cvt_pk_bf16_f32 v85,v166,v167
s_waitcnt lgkmcnt(1)
v_mfma_f32_16x16x32_bf16 v[48:51],a[192:195],a[144:147],0
s_add_u32 s48,s48,325632
ds_write2st64_b64 v21,v[88:89],v[90:91] offset0:26 offset1:28
s_lshr_b32 s62,s39,s69
s_and_b32 s62,s62,1
s_lshl_b32 s62,s62,1
s_add_u32 s62,s62,s49
v_mfma_f32_16x16x32_bf16 v[48:51],a[196:199],a[148:151],v[48:51]
s_and_b32 s62,s62,3
v_cvt_pk_bf16_f32 v86,v180,v181
v_cvt_pk_bf16_f32 v87,v182,v183
v_mfma_f32_16x16x32_bf16 v[48:51],a[200:203],a[152:155],v[48:51]
s_add_u32 s63,s69,8
s_lshr_b32 s63,s39,s63
s_and_b32 s63,s63,1
v_mfma_f32_16x16x32_bf16 v[48:51],a[204:207],a[156:159],v[48:51]
s_xor_b32 s62,s62,s63
ds_write2st64_b64 v22,v[92:93],v[94:95] offset0:26 offset1:28
s_mul_i32 s63,s3,3
s_lshl_b32 s64,s3,2
s_mov_b32 s40,1
s_add_u32 s65,s63,17
v_pk_mul_f32 v[168:169],v[168:169],v[144:145] op_sel_hi:[1,0]
v_pk_mul_f32 v[170:171],v[170:171],v[144:145] op_sel_hi:[1,0]
v_pk_mul_f32 v[184:185],v[184:185],v[144:145] op_sel_hi:[1,0]
v_pk_mul_f32 v[186:187],v[186:187],v[144:145] op_sel_hi:[1,0]
v_cvt_pk_bf16_f32 v88,v168,v169
v_cvt_pk_bf16_f32 v89,v170,v171
v_mfma_f32_16x16x32_bf16 v[48:51],a[208:211],a[160:163],v[48:51]
s_cmp_eq_u32 s3,0
v_cvt_pk_bf16_f32 v90,v184,v185
v_cvt_pk_bf16_f32 v91,v186,v187
v_mfma_f32_16x16x32_bf16 v[48:51],a[212:215],a[164:167],v[48:51]
s_cselect_b32 s65,16,s65
s_cselect_b32 s41,1,0
s_cmp_eq_u32 s62,1
v_mfma_f32_16x16x32_bf16 v[52:55],a[216:219],a[144:147],0
s_cselect_b32 s64,s65,s64
s_cselect_b32 s40,s41,s40
s_add_u32 s65,s63,29
v_mfma_f32_16x16x32_bf16 v[52:55],a[220:223],a[148:151],v[52:55]
s_cmp_eq_u32 s62,2
s_cselect_b32 s64,s65,s64
s_cselect_b32 s40,0,s40
s_add_u32 s65,s63,41
s_cmp_eq_u32 s62,3
s_cselect_b32 s64,s65,s64
v_pk_mul_f32 v[172:173],v[172:173],v[144:145] op_sel_hi:[1,0]
v_pk_mul_f32 v[174:175],v[174:175],v[144:145] op_sel_hi:[1,0]
v_pk_mul_f32 v[188:189],v[188:189],v[144:145] op_sel_hi:[1,0]
v_pk_mul_f32 v[190:191],v[190:191],v[144:145] op_sel_hi:[1,0]
v_cvt_pk_bf16_f32 v92,v172,v173
v_cvt_pk_bf16_f32 v93,v174,v175
v_mfma_f32_16x16x32_bf16 v[52:55],a[224:227],a[152:155],v[52:55]
s_waitcnt vmcnt(6)
ds_read_b128 a[168:171],v28 offset:0
v_cvt_pk_bf16_f32 v94,v188,v189
v_mfma_f32_16x16x32_bf16 v[52:55],a[228:231],a[156:159],v[52:55]
s_cselect_b32 s40,0,s40
ds_read_b128 a[172:175],v29 offset:0
v_cvt_pk_bf16_f32 v95,v190,v191
v_mfma_f32_16x16x32_bf16 v[52:55],a[232:235],a[160:163],v[52:55]
s_mul_i32 s64,s64,6144
ds_read_b128 a[176:179],v28 offset:128
s_add_u32 s41,s48,s64
v_mfma_f32_16x16x32_bf16 v[52:55],a[236:239],a[164:167],v[52:55]
s_cmp_ge_u32 s69,8
ds_read_b128 a[180:183],v29 offset:128
s_cselect_b32 s41,166723584,s41
ds_read_b128 a[184:187],v28 offset:256
s_mov_b32 s28,s41
s_mov_b32 s29,s24
v_pk_mul_f32 v[192:193],v[192:193],v[144:145] op_sel_hi:[1,0]
v_pk_mul_f32 v[194:195],v[194:195],v[144:145] op_sel_hi:[1,0]
s_add_u32 s25,s22,12288
s_add_u32 s26,s22,24576
ds_read_b128 a[188:191],v29 offset:256
ds_write2st64_b64 v12,v[80:81],v[82:83] offset0:0 offset1:2
v_cvt_pk_bf16_f32 v80,v192,v193
v_cvt_pk_bf16_f32 v81,v194,v195
s_waitcnt lgkmcnt(6)
v_mfma_f32_16x16x32_bf16 v[56:59],a[192:195],a[168:171],0
s_waitcnt lgkmcnt(5)
ds_write2st64_b64 v20,v[84:85],v[86:87] offset0:0 offset1:2
v_mfma_f32_16x16x32_bf16 v[56:59],a[196:199],a[172:175],v[56:59]
s_waitcnt lgkmcnt(5)
v_mfma_f32_16x16x32_bf16 v[56:59],a[200:203],a[176:179],v[56:59]
s_waitcnt lgkmcnt(4)
v_mfma_f32_16x16x32_bf16 v[56:59],a[204:207],a[180:183],v[56:59]
ds_write2st64_b64 v21,v[88:89],v[90:91] offset0:0 offset1:2
v_pk_mul_f32 v[196:197],v[196:197],v[144:145] op_sel_hi:[1,0]
v_pk_mul_f32 v[198:199],v[198:199],v[144:145] op_sel_hi:[1,0]
v_cvt_pk_bf16_f32 v84,v196,v197
v_cvt_pk_bf16_f32 v85,v198,v199
s_waitcnt lgkmcnt(2)
v_mfma_f32_16x16x32_bf16 v[56:59],a[208:211],a[184:187],v[56:59]
v_mfma_f32_16x16x32_bf16 v[56:59],a[212:215],a[188:191],v[56:59]
ds_write2st64_b64 v22,v[92:93],v[94:95] offset0:0 offset1:2
v_mfma_f32_16x16x32_bf16 v[60:63],a[216:219],a[168:171],0
v_mfma_f32_16x16x32_bf16 v[60:63],a[220:223],a[172:175],v[60:63]
ds_write_b64 v12,v[80:81] offset:2048
v_pk_mul_f32 v[200:201],v[200:201],v[144:145] op_sel_hi:[1,0]
v_pk_mul_f32 v[202:203],v[202:203],v[144:145] op_sel_hi:[1,0]
v_cvt_pk_bf16_f32 v88,v200,v201
v_cvt_pk_bf16_f32 v89,v202,v203
v_mfma_f32_16x16x32_bf16 v[60:63],a[224:227],a[176:179],v[60:63]
ds_write_b64 v20,v[84:85] offset:2048
v_mfma_f32_16x16x32_bf16 v[60:63],a[228:231],a[180:183],v[60:63]
v_mfma_f32_16x16x32_bf16 v[60:63],a[232:235],a[184:187],v[60:63]
ds_write_b64 v21,v[88:89] offset:2048
v_mfma_f32_16x16x32_bf16 v[60:63],a[236:239],a[188:191],v[60:63]
v_pk_mul_f32 v[204:205],v[204:205],v[144:145] op_sel_hi:[1,0]
v_pk_mul_f32 v[206:207],v[206:207],v[144:145] op_sel_hi:[1,0]
v_cvt_pk_bf16_f32 v92,v204,v205
v_cvt_pk_bf16_f32 v93,v206,v207
ds_write_b64 v22,v[92:93] offset:2048
ds_read_b128 a[192:195],v1 offset:12288
v_max3_f32 v144,v32,v33,v34
v_max3_f32 v146,v40,v41,v42
v_max3_f32 v144,v144,v35,v36
v_max3_f32 v146,v146,v43,v44
v_max3_f32 v144,v144,v37,v38
v_max3_f32 v146,v146,v45,v46
v_max_f32 v144,v144,v39
v_max_f32 v146,v146,v47
v_mov_b32 v145,v144
v_mov_b32 v147,v146
s_add_u32 m0,s23,12288
v_permlane32_swap_b32 v145,v144
v_permlane32_swap_b32 v147,v146
v_max_f32 v144,v144,v145
v_max_f32 v146,v146,v147
v_mov_b32 v145,v144
v_mov_b32 v147,v146
buffer_load_dwordx4 v7,s[8:11],s21 offen offset:0 lds
ds_read_b128 a[196:199],v2 offset:12288
v_permlane16_swap_b32 v145,v144
v_permlane16_swap_b32 v147,v146
v_max_f32 v144,v144,v145
v_max_f32 v146,v146,v147
v_mul_f32_e64 v16,-s36,v144
v_mul_f32_e64 v17,-s36,v146
v_max3_f32 v144,v48,v49,v50
s_waitcnt lgkmcnt(1)
v_mfma_f32_16x16x32_bf16 v[64:67],a[192:195],a[96:99],0
ds_read_b128 a[200:203],v1 offset:12416
v_max3_f32 v146,v56,v57,v58
v_max3_f32 v144,v144,v51,v52
v_max3_f32 v146,v146,v59,v60
v_max3_f32 v144,v144,v53,v54
v_max3_f32 v146,v146,v61,v62
v_max_f32 v144,v144,v55
v_max_f32 v146,v146,v63
v_mov_b32 v145,v144
v_mov_b32 v147,v146
v_fma_f32 v32,v32,s36,v16
v_permlane32_swap_b32 v145,v144
v_permlane32_swap_b32 v147,v146
v_max_f32 v144,v144,v145
v_max_f32 v146,v146,v147
v_mov_b32 v145,v144
v_mov_b32 v147,v146
v_fma_f32 v33,v33,s36,v16
v_permlane16_swap_b32 v145,v144
v_permlane16_swap_b32 v147,v146
s_waitcnt lgkmcnt(1)
v_mfma_f32_16x16x32_bf16 v[64:67],a[196:199],a[100:103],v[64:67]
buffer_load_dwordx4 v8,s[8:11],s21 offen offset:1024 lds
ds_read_b128 a[204:207],v2 offset:12416
v_max_f32 v144,v144,v145
v_max_f32 v146,v146,v147
v_mul_f32_e64 v18,-s36,v144
v_mul_f32_e64 v19,-s36,v146
v_fma_f32 v34,v34,s36,v16
s_waitcnt lgkmcnt(1)
v_mfma_f32_16x16x32_bf16 v[64:67],a[200:203],a[104:107],v[64:67]
ds_read_b128 a[208:211],v1 offset:12544
v_fma_f32 v35,v35,s36,v16
v_fma_f32 v36,v36,s36,v16
v_fma_f32 v37,v37,s36,v16
v_fma_f32 v38,v38,s36,v16
v_fma_f32 v39,v39,s36,v16
v_fma_f32 v40,v40,s36,v17
v_fma_f32 v41,v41,s36,v17
v_fma_f32 v42,v42,s36,v17
v_fma_f32 v43,v43,s36,v17
v_fma_f32 v44,v44,s36,v17
v_fma_f32 v45,v45,s36,v17
v_fma_f32 v46,v46,s36,v17
v_fma_f32 v47,v47,s36,v17
v_fma_f32 v48,v48,s36,v18
v_fma_f32 v49,v49,s36,v18
v_fma_f32 v50,v50,s36,v18
v_fma_f32 v51,v51,s36,v18
v_fma_f32 v52,v52,s36,v18
v_fma_f32 v53,v53,s36,v18
v_fma_f32 v54,v54,s36,v18
v_fma_f32 v55,v55,s36,v18
v_fma_f32 v56,v56,s36,v19
v_fma_f32 v57,v57,s36,v19
v_fma_f32 v58,v58,s36,v19
v_fma_f32 v59,v59,s36,v19
v_fma_f32 v60,v60,s36,v19
s_waitcnt lgkmcnt(1)
v_mfma_f32_16x16x32_bf16 v[64:67],a[204:207],a[108:111],v[64:67]
ds_read_b128 a[212:215],v2 offset:12544
v_fma_f32 v61,v61,s36,v19
v_fma_f32 v62,v62,s36,v19
v_fma_f32 v63,v63,s36,v19
v_exp_f32 v32,v32
s_waitcnt lgkmcnt(1)
v_mfma_f32_16x16x32_bf16 v[64:67],a[208:211],a[112:115],v[64:67]
buffer_load_dwordx4 v9,s[8:11],s21 offen offset:2048 lds
s_add_u32 s21,s21,12288
s_add_u32 m0,s22,0
ds_read_b128 a[216:219],v1 offset:18432
v_exp_f32 v33,v33
v_exp_f32 v34,v34
v_exp_f32 v35,v35
v_exp_f32 v36,v36
v_exp_f32 v37,v37
v_exp_f32 v38,v38
v_exp_f32 v39,v39
v_exp_f32 v40,v40
v_exp_f32 v41,v41
v_exp_f32 v42,v42
v_exp_f32 v43,v43
v_exp_f32 v44,v44
s_waitcnt lgkmcnt(1)
v_mfma_f32_16x16x32_bf16 v[64:67],a[212:215],a[116:119],v[64:67]
ds_read_b128 a[220:223],v2 offset:18432
v_exp_f32 v45,v45
v_mfma_f32_16x16x32_bf16 v[72:75],a[192:195],a[120:123],0
ds_read_b128 a[224:227],v1 offset:18560
v_exp_f32 v46,v46
v_mfma_f32_16x16x32_bf16 v[72:75],a[196:199],a[124:127],v[72:75]
ds_read_b128 a[228:231],v2 offset:18560
v_exp_f32 v47,v47
v_mfma_f32_16x16x32_bf16 v[72:75],a[200:203],a[128:131],v[72:75]
buffer_load_dwordx4 v7,s[4:7],s20 offen offset:0 lds
v_mfma_f32_16x16x32_bf16 v[72:75],a[204:207],a[132:135],v[72:75]
ds_read_b128 a[232:235],v1 offset:18688
v_exp_f32 v48,v48
v_mfma_f32_16x16x32_bf16 v[72:75],a[208:211],a[136:139],v[72:75]
ds_read_b128 a[236:239],v2 offset:18688
v_exp_f32 v49,v49
v_mfma_f32_16x16x32_bf16 v[72:75],a[212:215],a[140:143],v[72:75]
v_exp_f32 v50,v50
v_mfma_f32_16x16x32_bf16 v[80:83],a[192:195],a[144:147],0
v_exp_f32 v51,v51
v_mfma_f32_16x16x32_bf16 v[80:83],a[196:199],a[148:151],v[80:83]
v_exp_f32 v52,v52
v_mfma_f32_16x16x32_bf16 v[80:83],a[200:203],a[152:155],v[80:83]
v_exp_f32 v53,v53
v_mfma_f32_16x16x32_bf16 v[80:83],a[204:207],a[156:159],v[80:83]
v_exp_f32 v54,v54
v_mfma_f32_16x16x32_bf16 v[80:83],a[208:211],a[160:163],v[80:83]
v_exp_f32 v55,v55
v_mfma_f32_16x16x32_bf16 v[80:83],a[212:215],a[164:167],v[80:83]
v_exp_f32 v56,v56
v_mfma_f32_16x16x32_bf16 v[88:91],a[192:195],a[168:171],0
v_exp_f32 v57,v57
v_mfma_f32_16x16x32_bf16 v[88:91],a[196:199],a[172:175],v[88:91]
v_exp_f32 v58,v58
v_mfma_f32_16x16x32_bf16 v[88:91],a[200:203],a[176:179],v[88:91]
buffer_load_dwordx4 v8,s[4:7],s20 offen offset:1024 lds
v_mfma_f32_16x16x32_bf16 v[88:91],a[204:207],a[180:183],v[88:91]
v_exp_f32 v59,v59
v_mfma_f32_16x16x32_bf16 v[88:91],a[208:211],a[184:187],v[88:91]
v_exp_f32 v60,v60
v_mfma_f32_16x16x32_bf16 v[88:91],a[212:215],a[188:191],v[88:91]
s_waitcnt lgkmcnt(0)
v_exp_f32 v61,v61
v_mfma_f32_16x16x32_bf16 v[68:71],a[216:219],a[96:99],0
v_exp_f32 v62,v62
v_mfma_f32_16x16x32_bf16 v[68:71],a[220:223],a[100:103],v[68:71]
v_exp_f32 v63,v63
v_mfma_f32_16x16x32_bf16 v[68:71],a[224:227],a[104:107],v[68:71]
v_cvt_pk_bf16_f32 v96,v32,v33
v_cvt_pk_bf16_f32 v97,v34,v35
v_mfma_f32_16x16x32_bf16 v[68:71],a[228:231],a[108:111],v[68:71]
v_cvt_pk_bf16_f32 v98,v36,v37
v_cvt_pk_bf16_f32 v99,v38,v39
v_mfma_f32_16x16x32_bf16 v[68:71],a[232:235],a[112:115],v[68:71]
v_cvt_pk_bf16_f32 v100,v40,v41
v_cvt_pk_bf16_f32 v101,v42,v43
v_mfma_f32_16x16x32_bf16 v[128:131],v[24:27],v[96:99],0
v_cvt_pk_bf16_f32 v102,v44,v45
v_cvt_pk_bf16_f32 v103,v46,v47
v_mfma_f32_16x16x32_bf16 v[68:71],a[236:239],a[116:119],v[68:71]
v_cvt_pk_bf16_f32 v104,v48,v49
v_cvt_pk_bf16_f32 v105,v50,v51
v_mfma_f32_16x16x32_bf16 v[132:135],v[24:27],v[100:103],0
v_cvt_pk_bf16_f32 v106,v52,v53
v_cvt_pk_bf16_f32 v107,v54,v55
v_mfma_f32_16x16x32_bf16 v[76:79],a[216:219],a[120:123],0
buffer_load_dwordx4 v9,s[4:7],s20 offen offset:2048 lds
s_add_u32 s20,s20,12288
v_mfma_f32_16x16x32_bf16 v[136:139],v[24:27],v[104:107],0
v_cvt_pk_bf16_f32 v108,v56,v57
v_cvt_pk_bf16_f32 v109,v58,v59
v_mfma_f32_16x16x32_bf16 v[76:79],a[220:223],a[124:127],v[76:79]
v_cvt_pk_bf16_f32 v110,v60,v61
v_cvt_pk_bf16_f32 v111,v62,v63
v_mfma_f32_16x16x32_bf16 v[76:79],a[224:227],a[128:131],v[76:79]
v_fma_f32 v64,v64,s36,v16
v_fma_f32 v65,v65,s36,v16
v_mfma_f32_16x16x32_bf16 v[140:143],v[24:27],v[108:111],0
v_fma_f32 v66,v66,s36,v16
v_fma_f32 v67,v67,s36,v16
v_mfma_f32_16x16x32_bf16 v[76:79],a[228:231],a[132:135],v[76:79]
v_fma_f32 v72,v72,s36,v17
v_fma_f32 v73,v73,s36,v17
v_mfma_f32_16x16x32_bf16 v[76:79],a[232:235],a[136:139],v[76:79]
v_fma_f32 v74,v74,s36,v17
v_fma_f32 v75,v75,s36,v17
v_mfma_f32_16x16x32_bf16 v[76:79],a[236:239],a[140:143],v[76:79]
v_exp_f32 v64,v64
v_mfma_f32_16x16x32_bf16 v[84:87],a[216:219],a[144:147],0
v_exp_f32 v65,v65
v_mfma_f32_16x16x32_bf16 v[84:87],a[220:223],a[148:151],v[84:87]
v_exp_f32 v66,v66
v_mfma_f32_16x16x32_bf16 v[84:87],a[224:227],a[152:155],v[84:87]
v_exp_f32 v67,v67
v_mfma_f32_16x16x32_bf16 v[84:87],a[228:231],a[156:159],v[84:87]
v_exp_f32 v72,v72
v_mfma_f32_16x16x32_bf16 v[84:87],a[232:235],a[160:163],v[84:87]
v_exp_f32 v73,v73
v_mfma_f32_16x16x32_bf16 v[84:87],a[236:239],a[164:167],v[84:87]
v_exp_f32 v74,v74
v_mfma_f32_16x16x32_bf16 v[92:95],a[216:219],a[168:171],0
v_exp_f32 v75,v75
v_mfma_f32_16x16x32_bf16 v[92:95],a[220:223],a[172:175],v[92:95]
v_cvt_pk_bf16_f32 v112,v64,v65
v_cvt_pk_bf16_f32 v113,v66,v67
v_mfma_f32_16x16x32_bf16 v[92:95],a[224:227],a[176:179],v[92:95]
v_cvt_pk_bf16_f32 v116,v72,v73
v_cvt_pk_bf16_f32 v117,v74,v75
v_mfma_f32_16x16x32_bf16 v[92:95],a[228:231],a[180:183],v[92:95]
v_mfma_f32_16x16x32_bf16 v[92:95],a[232:235],a[184:187],v[92:95]
v_mfma_f32_16x16x32_bf16 v[92:95],a[236:239],a[188:191],v[92:95]
s_waitcnt vmcnt(6)
s_barrier
ds_read_b64_tr_b16 a[240:241],v3 offset:0
ds_read_b64_tr_b16 a[242:243],v3 offset:6144
ds_read_b64_tr_b16 a[244:245],v4 offset:0
ds_read_b64_tr_b16 a[246:247],v4 offset:6144
ds_read_b64_tr_b16 a[248:249],v5 offset:0
ds_read_b64_tr_b16 a[250:251],v5 offset:6144
ds_read_b64_tr_b16 a[252:253],v6 offset:0
ds_read_b64_tr_b16 a[254:255],v6 offset:6144
s_waitcnt lgkmcnt(6)
v_mfma_f32_16x16x32_bf16 v[160:163],a[240:243],v[96:99],0
s_add_u32 m0,s23,24576
ds_read_b128 a[192:195],v1 offset:24576
v_fma_f32 v68,v68,s36,v16
v_mfma_f32_16x16x32_bf16 v[208:211],a[240:243],v[100:103],0
buffer_load_dwordx4 v7,s[8:11],s21 offen offset:0 lds
v_mfma_f32_16x16x32_bf16 a[0:3],a[240:243],v[104:107],0
ds_read_b128 a[196:199],v2 offset:24576
v_fma_f32 v69,v69,s36,v16
v_mfma_f32_16x16x32_bf16 a[48:51],a[240:243],v[108:111],0
s_waitcnt lgkmcnt(6)
ds_read_b64_tr_b16 a[240:241],v3 offset:128
ds_read_b64_tr_b16 a[242:243],v3 offset:6272
v_mfma_f32_16x16x32_bf16 v[164:167],a[244:247],v[96:99],0
ds_read_b128 a[200:203],v1 offset:24704
v_fma_f32 v70,v70,s36,v16
v_mfma_f32_16x16x32_bf16 v[212:215],a[244:247],v[100:103],0
ds_read_b128 a[204:207],v2 offset:24704
v_fma_f32 v71,v71,s36,v16
v_mfma_f32_16x16x32_bf16 a[4:7],a[244:247],v[104:107],0
ds_read_b128 a[208:211],v1 offset:24832
v_fma_f32 v76,v76,s36,v17
v_mfma_f32_16x16x32_bf16 a[52:55],a[244:247],v[108:111],0
s_waitcnt lgkmcnt(7)
ds_read_b64_tr_b16 a[244:245],v4 offset:128
ds_read_b64_tr_b16 a[246:247],v4 offset:6272
v_mfma_f32_16x16x32_bf16 v[168:171],a[248:251],v[96:99],0
ds_read_b128 a[212:215],v2 offset:24832
v_fma_f32 v77,v77,s36,v17
v_mfma_f32_16x16x32_bf16 v[216:219],a[248:251],v[100:103],0
buffer_load_dwordx4 v8,s[8:11],s21 offen offset:1024 lds
v_mfma_f32_16x16x32_bf16 a[8:11],a[248:251],v[104:107],0
ds_read_b128 a[216:219],v1 offset:30720
v_fma_f32 v78,v78,s36,v17
v_mfma_f32_16x16x32_bf16 a[56:59],a[248:251],v[108:111],0
ds_read_b64_tr_b16 a[248:249],v5 offset:128
ds_read_b64_tr_b16 a[250:251],v5 offset:6272
v_mfma_f32_16x16x32_bf16 v[172:175],a[252:255],v[96:99],0
ds_read_b128 a[220:223],v2 offset:30720
v_fma_f32 v79,v79,s36,v17
v_mfma_f32_16x16x32_bf16 v[220:223],a[252:255],v[100:103],0
ds_read_b128 a[224:227],v1 offset:30848
v_fma_f32 v80,v80,s36,v18
v_mfma_f32_16x16x32_bf16 a[12:15],a[252:255],v[104:107],0
ds_read_b128 a[228:231],v2 offset:30848
v_fma_f32 v81,v81,s36,v18
v_mfma_f32_16x16x32_bf16 a[60:63],a[252:255],v[108:111],0
s_waitcnt lgkmcnt(7)
ds_read_b64_tr_b16 a[252:253],v6 offset:128
ds_read_b64_tr_b16 a[254:255],v6 offset:6272
v_mfma_f32_16x16x32_bf16 v[176:179],a[240:243],v[96:99],0
ds_read_b128 a[232:235],v1 offset:30976
v_fma_f32 v82,v82,s36,v18
v_mfma_f32_16x16x32_bf16 v[224:227],a[240:243],v[100:103],0
buffer_load_dwordx4 v9,s[8:11],s21 offen offset:2048 lds
v_mfma_f32_16x16x32_bf16 a[16:19],a[240:243],v[104:107],0
s_add_u32 s21,s21,12288
ds_read_b128 a[236:239],v2 offset:30976
v_fma_f32 v83,v83,s36,v18
v_mfma_f32_16x16x32_bf16 a[64:67],a[240:243],v[108:111],0
s_add_u32 m0,s22,12288
ds_read_b64_tr_b16 a[240:241],v3 offset:256
ds_read_b64_tr_b16 a[242:243],v3 offset:6400
v_mfma_f32_16x16x32_bf16 v[180:183],a[244:247],v[96:99],0
v_fma_f32 v84,v84,s36,v18
v_fma_f32 v85,v85,s36,v18
v_mfma_f32_16x16x32_bf16 v[228:231],a[244:247],v[100:103],0
v_fma_f32 v86,v86,s36,v18
v_fma_f32 v87,v87,s36,v18
v_mfma_f32_16x16x32_bf16 a[20:23],a[244:247],v[104:107],0
v_fma_f32 v88,v88,s36,v19
v_fma_f32 v89,v89,s36,v19
v_mfma_f32_16x16x32_bf16 a[68:71],a[244:247],v[108:111],0
s_waitcnt lgkmcnt(4)
ds_read_b64_tr_b16 a[244:245],v4 offset:256
ds_read_b64_tr_b16 a[246:247],v4 offset:6400
v_mfma_f32_16x16x32_bf16 v[184:187],a[248:251],v[96:99],0
buffer_load_dwordx4 v7,s[4:7],s20 offen offset:0 lds
v_mfma_f32_16x16x32_bf16 v[232:235],a[248:251],v[100:103],0
v_fma_f32 v90,v90,s36,v19
v_fma_f32 v91,v91,s36,v19
v_mfma_f32_16x16x32_bf16 a[24:27],a[248:251],v[104:107],0
v_fma_f32 v92,v92,s36,v19
v_fma_f32 v93,v93,s36,v19
v_mfma_f32_16x16x32_bf16 a[72:75],a[248:251],v[108:111],0
ds_read_b64_tr_b16 a[248:249],v5 offset:256
ds_read_b64_tr_b16 a[250:251],v5 offset:6400
v_mfma_f32_16x16x32_bf16 v[188:191],a[252:255],v[96:99],0
v_fma_f32 v94,v94,s36,v19
v_fma_f32 v95,v95,s36,v19
v_mfma_f32_16x16x32_bf16 v[236:239],a[252:255],v[100:103],0
v_exp_f32 v68,v68
v_mfma_f32_16x16x32_bf16 a[28:31],a[252:255],v[104:107],0
v_exp_f32 v69,v69
v_mfma_f32_16x16x32_bf16 a[76:79],a[252:255],v[108:111],0
s_waitcnt lgkmcnt(2)
ds_read_b64_tr_b16 a[252:253],v6 offset:256
ds_read_b64_tr_b16 a[254:255],v6 offset:6400
v_mfma_f32_16x16x32_bf16 v[192:195],a[240:243],v[96:99],0
buffer_load_dwordx4 v8,s[4:7],s20 offen offset:1024 lds
v_mfma_f32_16x16x32_bf16 v[240:243],a[240:243],v[100:103],0
v_exp_f32 v70,v70
v_mfma_f32_16x16x32_bf16 a[32:35],a[240:243],v[104:107],0
v_exp_f32 v71,v71
v_mfma_f32_16x16x32_bf16 a[80:83],a[240:243],v[108:111],0
v_exp_f32 v76,v76
v_mfma_f32_16x16x32_bf16 v[196:199],a[244:247],v[96:99],0
v_exp_f32 v77,v77
v_mfma_f32_16x16x32_bf16 v[244:247],a[244:247],v[100:103],0
v_exp_f32 v78,v78
v_mfma_f32_16x16x32_bf16 a[36:39],a[244:247],v[104:107],0
v_exp_f32 v79,v79
v_mfma_f32_16x16x32_bf16 a[84:87],a[244:247],v[108:111],0
s_waitcnt lgkmcnt(0)
v_exp_f32 v80,v80
v_mfma_f32_16x16x32_bf16 v[200:203],a[248:251],v[96:99],0
buffer_load_dwordx4 v9,s[4:7],s20 offen offset:2048 lds
v_mfma_f32_16x16x32_bf16 v[248:251],a[248:251],v[100:103],0
s_add_u32 s20,s20,12288
v_exp_f32 v81,v81
v_mfma_f32_16x16x32_bf16 a[40:43],a[248:251],v[104:107],0
v_exp_f32 v82,v82
v_mfma_f32_16x16x32_bf16 a[88:91],a[248:251],v[108:111],0
v_exp_f32 v83,v83
v_mfma_f32_16x16x32_bf16 v[204:207],a[252:255],v[96:99],0
v_exp_f32 v84,v84
v_mfma_f32_16x16x32_bf16 v[252:255],a[252:255],v[100:103],0
v_exp_f32 v85,v85
v_mfma_f32_16x16x32_bf16 a[44:47],a[252:255],v[104:107],0
v_exp_f32 v86,v86
v_mfma_f32_16x16x32_bf16 a[92:95],a[252:255],v[108:111],0
v_exp_f32 v87,v87
v_mfma_f32_16x16x32_bf16 v[32:35],a[192:195],a[96:99],0
v_exp_f32 v88,v88
v_mfma_f32_16x16x32_bf16 v[32:35],a[196:199],a[100:103],v[32:35]
v_exp_f32 v89,v89
v_mfma_f32_16x16x32_bf16 v[32:35],a[200:203],a[104:107],v[32:35]
v_exp_f32 v90,v90
v_mfma_f32_16x16x32_bf16 v[32:35],a[204:207],a[108:111],v[32:35]
v_exp_f32 v91,v91
v_mfma_f32_16x16x32_bf16 v[32:35],a[208:211],a[112:115],v[32:35]
v_exp_f32 v92,v92
v_mfma_f32_16x16x32_bf16 v[32:35],a[212:215],a[116:119],v[32:35]
v_exp_f32 v93,v93
v_mfma_f32_16x16x32_bf16 v[40:43],a[192:195],a[120:123],0
v_exp_f32 v94,v94
v_mfma_f32_16x16x32_bf16 v[40:43],a[196:199],a[124:127],v[40:43]
v_exp_f32 v95,v95
v_mfma_f32_16x16x32_bf16 v[40:43],a[200:203],a[128:131],v[40:43]
v_cvt_pk_bf16_f32 v114,v68,v69
v_cvt_pk_bf16_f32 v115,v70,v71
v_mfma_f32_16x16x32_bf16 v[40:43],a[204:207],a[132:135],v[40:43]
v_cvt_pk_bf16_f32 v118,v76,v77
v_cvt_pk_bf16_f32 v119,v78,v79
v_mfma_f32_16x16x32_bf16 v[128:131],v[24:27],v[112:115],v[128:131]
v_cvt_pk_bf16_f32 v120,v80,v81
v_cvt_pk_bf16_f32 v121,v82,v83
v_mfma_f32_16x16x32_bf16 v[132:135],v[24:27],v[116:119],v[132:135]
v_cvt_pk_bf16_f32 v122,v84,v85
v_cvt_pk_bf16_f32 v123,v86,v87
v_mfma_f32_16x16x32_bf16 v[40:43],a[208:211],a[136:139],v[40:43]
v_cvt_pk_bf16_f32 v124,v88,v89
v_cvt_pk_bf16_f32 v125,v90,v91
v_mfma_f32_16x16x32_bf16 v[136:139],v[24:27],v[120:123],v[136:139]
v_cvt_pk_bf16_f32 v126,v92,v93
v_cvt_pk_bf16_f32 v127,v94,v95
v_mfma_f32_16x16x32_bf16 v[40:43],a[212:215],a[140:143],v[40:43]
v_fma_f32 v32,v32,s36,v16
v_fma_f32 v33,v33,s36,v16
v_mfma_f32_16x16x32_bf16 v[140:143],v[24:27],v[124:127],v[140:143]
v_fma_f32 v34,v34,s36,v16
v_fma_f32 v35,v35,s36,v16
v_mfma_f32_16x16x32_bf16 v[48:51],a[192:195],a[144:147],0
v_exp_f32 v32,v32
v_mfma_f32_16x16x32_bf16 v[48:51],a[196:199],a[148:151],v[48:51]
v_fma_f32 v40,v40,s36,v17
v_fma_f32 v41,v41,s36,v17
v_mfma_f32_16x16x32_bf16 v[48:51],a[200:203],a[152:155],v[48:51]
v_fma_f32 v42,v42,s36,v17
v_fma_f32 v43,v43,s36,v17
v_mfma_f32_16x16x32_bf16 v[48:51],a[204:207],a[156:159],v[48:51]
v_exp_f32 v33,v33
v_mfma_f32_16x16x32_bf16 v[48:51],a[208:211],a[160:163],v[48:51]
v_exp_f32 v34,v34
v_mfma_f32_16x16x32_bf16 v[48:51],a[212:215],a[164:167],v[48:51]
v_exp_f32 v35,v35
v_mfma_f32_16x16x32_bf16 v[56:59],a[192:195],a[168:171],0
v_exp_f32 v40,v40
v_mfma_f32_16x16x32_bf16 v[56:59],a[196:199],a[172:175],v[56:59]
v_exp_f32 v41,v41
v_mfma_f32_16x16x32_bf16 v[56:59],a[200:203],a[176:179],v[56:59]
v_exp_f32 v42,v42
v_mfma_f32_16x16x32_bf16 v[56:59],a[204:207],a[180:183],v[56:59]
v_exp_f32 v43,v43
v_mfma_f32_16x16x32_bf16 v[56:59],a[208:211],a[184:187],v[56:59]
v_cvt_pk_bf16_f32 v96,v32,v33
v_cvt_pk_bf16_f32 v97,v34,v35
v_mfma_f32_16x16x32_bf16 v[56:59],a[212:215],a[188:191],v[56:59]
v_cvt_pk_bf16_f32 v100,v40,v41
v_cvt_pk_bf16_f32 v101,v42,v43
v_mfma_f32_16x16x32_bf16 v[36:39],a[216:219],a[96:99],0
v_mfma_f32_16x16x32_bf16 v[36:39],a[220:223],a[100:103],v[36:39]
v_mfma_f32_16x16x32_bf16 v[36:39],a[224:227],a[104:107],v[36:39]
v_mfma_f32_16x16x32_bf16 v[36:39],a[228:231],a[108:111],v[36:39]
v_mfma_f32_16x16x32_bf16 v[36:39],a[232:235],a[112:115],v[36:39]
v_mfma_f32_16x16x32_bf16 v[36:39],a[236:239],a[116:119],v[36:39]
v_mfma_f32_16x16x32_bf16 v[44:47],a[216:219],a[120:123],0
v_mfma_f32_16x16x32_bf16 v[44:47],a[220:223],a[124:127],v[44:47]
v_mfma_f32_16x16x32_bf16 v[44:47],a[224:227],a[128:131],v[44:47]
v_mfma_f32_16x16x32_bf16 v[44:47],a[228:231],a[132:135],v[44:47]
v_mfma_f32_16x16x32_bf16 v[44:47],a[232:235],a[136:139],v[44:47]
s_waitcnt vmcnt(6)
s_barrier
v_mfma_f32_16x16x32_bf16 v[44:47],a[236:239],a[140:143],v[44:47]
v_mfma_f32_16x16x32_bf16 v[52:55],a[216:219],a[144:147],0
ds_read_b64_tr_b16 a[240:241],v3 offset:12288
ds_read_b64_tr_b16 a[242:243],v3 offset:18432
v_mfma_f32_16x16x32_bf16 v[52:55],a[220:223],a[148:151],v[52:55]
v_mfma_f32_16x16x32_bf16 v[52:55],a[224:227],a[152:155],v[52:55]
ds_read_b64_tr_b16 a[244:245],v4 offset:12288
ds_read_b64_tr_b16 a[246:247],v4 offset:18432
v_mfma_f32_16x16x32_bf16 v[52:55],a[228:231],a[156:159],v[52:55]
v_mfma_f32_16x16x32_bf16 v[52:55],a[232:235],a[160:163],v[52:55]
ds_read_b64_tr_b16 a[248:249],v5 offset:12288
ds_read_b64_tr_b16 a[250:251],v5 offset:18432
v_mfma_f32_16x16x32_bf16 v[52:55],a[236:239],a[164:167],v[52:55]
v_mfma_f32_16x16x32_bf16 v[60:63],a[216:219],a[168:171],0
ds_read_b64_tr_b16 a[252:253],v6 offset:12288
ds_read_b64_tr_b16 a[254:255],v6 offset:18432
v_mfma_f32_16x16x32_bf16 v[60:63],a[220:223],a[172:175],v[60:63]
v_mfma_f32_16x16x32_bf16 v[60:63],a[224:227],a[176:179],v[60:63]
v_mfma_f32_16x16x32_bf16 v[60:63],a[228:231],a[180:183],v[60:63]
v_mfma_f32_16x16x32_bf16 v[60:63],a[232:235],a[184:187],v[60:63]
v_mfma_f32_16x16x32_bf16 v[60:63],a[236:239],a[188:191],v[60:63]
s_waitcnt lgkmcnt(4)
v_mfma_f32_16x16x32_bf16 v[160:163],a[240:243],v[112:115],v[160:163]
s_add_u32 m0,s23,0
ds_read_b128 a[192:195],v1 offset:0
v_fma_f32 v36,v36,s36,v16
v_mfma_f32_16x16x32_bf16 v[208:211],a[240:243],v[116:119],v[208:211]
buffer_load_dwordx4 v7,s[8:11],s21 offen offset:0 lds
v_mfma_f32_16x16x32_bf16 a[0:3],a[240:243],v[120:123],a[0:3]
ds_read_b128 a[196:199],v2 offset:0
v_fma_f32 v37,v37,s36,v16
v_mfma_f32_16x16x32_bf16 a[48:51],a[240:243],v[124:127],a[48:51]
ds_read_b64_tr_b16 a[240:241],v3 offset:12416
ds_read_b64_tr_b16 a[242:243],v3 offset:18560
v_mfma_f32_16x16x32_bf16 v[164:167],a[244:247],v[112:115],v[164:167]
ds_read_b128 a[200:203],v1 offset:128
v_fma_f32 v38,v38,s36,v16
v_mfma_f32_16x16x32_bf16 v[212:215],a[244:247],v[116:119],v[212:215]
ds_read_b128 a[204:207],v2 offset:128
v_fma_f32 v39,v39,s36,v16
v_mfma_f32_16x16x32_bf16 a[4:7],a[244:247],v[120:123],a[4:7]
ds_read_b128 a[208:211],v1 offset:256
v_fma_f32 v44,v44,s36,v17
v_mfma_f32_16x16x32_bf16 a[52:55],a[244:247],v[124:127],a[52:55]
s_waitcnt lgkmcnt(7)
ds_read_b64_tr_b16 a[244:245],v4 offset:12416
ds_read_b64_tr_b16 a[246:247],v4 offset:18560
v_mfma_f32_16x16x32_bf16 v[168:171],a[248:251],v[112:115],v[168:171]
ds_read_b128 a[212:215],v2 offset:256
v_fma_f32 v45,v45,s36,v17
v_mfma_f32_16x16x32_bf16 v[216:219],a[248:251],v[116:119],v[216:219]
buffer_load_dwordx4 v8,s[8:11],s21 offen offset:1024 lds
v_mfma_f32_16x16x32_bf16 a[8:11],a[248:251],v[120:123],a[8:11]
ds_read_b128 a[216:219],v1 offset:6144
v_fma_f32 v46,v46,s36,v17
v_mfma_f32_16x16x32_bf16 a[56:59],a[248:251],v[124:127],a[56:59]
ds_read_b64_tr_b16 a[248:249],v5 offset:12416
ds_read_b64_tr_b16 a[250:251],v5 offset:18560
v_mfma_f32_16x16x32_bf16 v[172:175],a[252:255],v[112:115],v[172:175]
ds_read_b128 a[220:223],v2 offset:6144
v_fma_f32 v47,v47,s36,v17
v_mfma_f32_16x16x32_bf16 v[220:223],a[252:255],v[116:119],v[220:223]
ds_read_b128 a[224:227],v1 offset:6272
v_fma_f32 v48,v48,s36,v18
v_mfma_f32_16x16x32_bf16 a[12:15],a[252:255],v[120:123],a[12:15]
ds_read_b128 a[228:231],v2 offset:6272
v_fma_f32 v49,v49,s36,v18
v_mfma_f32_16x16x32_bf16 a[60:63],a[252:255],v[124:127],a[60:63]
s_waitcnt lgkmcnt(7)
ds_read_b64_tr_b16 a[252:253],v6 offset:12416
ds_read_b64_tr_b16 a[254:255],v6 offset:18560
v_mfma_f32_16x16x32_bf16 v[176:179],a[240:243],v[112:115],v[176:179]
ds_read_b128 a[232:235],v1 offset:6400
v_fma_f32 v50,v50,s36,v18
v_mfma_f32_16x16x32_bf16 v[224:227],a[240:243],v[116:119],v[224:227]
buffer_load_dwordx4 v9,s[8:11],s21 offen offset:2048 lds
v_mfma_f32_16x16x32_bf16 a[16:19],a[240:243],v[120:123],a[16:19]
s_add_u32 s21,s21,12288
ds_read_b128 a[236:239],v2 offset:6400
v_fma_f32 v51,v51,s36,v18
v_mfma_f32_16x16x32_bf16 a[64:67],a[240:243],v[124:127],a[64:67]
s_add_u32 m0,s22,24576
ds_read_b64_tr_b16 a[240:241],v3 offset:12544
ds_read_b64_tr_b16 a[242:243],v3 offset:18688
v_mfma_f32_16x16x32_bf16 v[180:183],a[244:247],v[112:115],v[180:183]
v_fma_f32 v52,v52,s36,v18
v_fma_f32 v53,v53,s36,v18
v_mfma_f32_16x16x32_bf16 v[228:231],a[244:247],v[116:119],v[228:231]
v_fma_f32 v54,v54,s36,v18
v_fma_f32 v55,v55,s36,v18
v_mfma_f32_16x16x32_bf16 a[20:23],a[244:247],v[120:123],a[20:23]
v_fma_f32 v56,v56,s36,v19
v_fma_f32 v57,v57,s36,v19
v_mfma_f32_16x16x32_bf16 a[68:71],a[244:247],v[124:127],a[68:71]
s_waitcnt lgkmcnt(4)
ds_read_b64_tr_b16 a[244:245],v4 offset:12544
ds_read_b64_tr_b16 a[246:247],v4 offset:18688
v_mfma_f32_16x16x32_bf16 v[184:187],a[248:251],v[112:115],v[184:187]
buffer_load_dwordx4 v7,s[4:7],s20 offen offset:0 lds
v_mfma_f32_16x16x32_bf16 v[232:235],a[248:251],v[116:119],v[232:235]
v_fma_f32 v58,v58,s36,v19
v_fma_f32 v59,v59,s36,v19
v_mfma_f32_16x16x32_bf16 a[24:27],a[248:251],v[120:123],a[24:27]
v_fma_f32 v60,v60,s36,v19
v_fma_f32 v61,v61,s36,v19
v_mfma_f32_16x16x32_bf16 a[72:75],a[248:251],v[124:127],a[72:75]
ds_read_b64_tr_b16 a[248:249],v5 offset:12544
ds_read_b64_tr_b16 a[250:251],v5 offset:18688
v_mfma_f32_16x16x32_bf16 v[188:191],a[252:255],v[112:115],v[188:191]
v_fma_f32 v62,v62,s36,v19
v_fma_f32 v63,v63,s36,v19
v_mfma_f32_16x16x32_bf16 v[236:239],a[252:255],v[116:119],v[236:239]
v_exp_f32 v36,v36
v_mfma_f32_16x16x32_bf16 a[28:31],a[252:255],v[120:123],a[28:31]
v_exp_f32 v37,v37
v_mfma_f32_16x16x32_bf16 a[76:79],a[252:255],v[124:127],a[76:79]
s_waitcnt lgkmcnt(2)
ds_read_b64_tr_b16 a[252:253],v6 offset:12544
ds_read_b64_tr_b16 a[254:255],v6 offset:18688
v_mfma_f32_16x16x32_bf16 v[192:195],a[240:243],v[112:115],v[192:195]
buffer_load_dwordx4 v8,s[4:7],s20 offen offset:1024 lds
v_mfma_f32_16x16x32_bf16 v[240:243],a[240:243],v[116:119],v[240:243]
v_exp_f32 v38,v38
v_mfma_f32_16x16x32_bf16 a[32:35],a[240:243],v[120:123],a[32:35]
v_exp_f32 v39,v39
v_mfma_f32_16x16x32_bf16 a[80:83],a[240:243],v[124:127],a[80:83]
v_exp_f32 v44,v44
v_mfma_f32_16x16x32_bf16 v[196:199],a[244:247],v[112:115],v[196:199]
v_exp_f32 v45,v45
v_mfma_f32_16x16x32_bf16 v[244:247],a[244:247],v[116:119],v[244:247]
v_exp_f32 v46,v46
v_mfma_f32_16x16x32_bf16 a[36:39],a[244:247],v[120:123],a[36:39]
v_exp_f32 v47,v47
v_mfma_f32_16x16x32_bf16 a[84:87],a[244:247],v[124:127],a[84:87]
s_waitcnt lgkmcnt(0)
v_exp_f32 v48,v48
v_mfma_f32_16x16x32_bf16 v[200:203],a[248:251],v[112:115],v[200:203]
buffer_load_dwordx4 v9,s[4:7],s20 offen offset:2048 lds
v_mfma_f32_16x16x32_bf16 v[248:251],a[248:251],v[116:119],v[248:251]
s_add_u32 s20,s20,12288
v_exp_f32 v49,v49
v_mfma_f32_16x16x32_bf16 a[40:43],a[248:251],v[120:123],a[40:43]
v_exp_f32 v50,v50
v_mfma_f32_16x16x32_bf16 a[88:91],a[248:251],v[124:127],a[88:91]
v_exp_f32 v51,v51
v_mfma_f32_16x16x32_bf16 v[204:207],a[252:255],v[112:115],v[204:207]
v_exp_f32 v52,v52
v_mfma_f32_16x16x32_bf16 v[252:255],a[252:255],v[116:119],v[252:255]
v_exp_f32 v53,v53
v_mfma_f32_16x16x32_bf16 a[44:47],a[252:255],v[120:123],a[44:47]
v_exp_f32 v54,v54
v_mfma_f32_16x16x32_bf16 a[92:95],a[252:255],v[124:127],a[92:95]
v_exp_f32 v55,v55
v_mfma_f32_16x16x32_bf16 v[64:67],a[192:195],a[96:99],0
v_exp_f32 v56,v56
v_mfma_f32_16x16x32_bf16 v[64:67],a[196:199],a[100:103],v[64:67]
v_exp_f32 v57,v57
v_mfma_f32_16x16x32_bf16 v[64:67],a[200:203],a[104:107],v[64:67]
v_exp_f32 v58,v58
v_mfma_f32_16x16x32_bf16 v[64:67],a[204:207],a[108:111],v[64:67]
v_exp_f32 v59,v59
v_mfma_f32_16x16x32_bf16 v[64:67],a[208:211],a[112:115],v[64:67]
v_exp_f32 v60,v60
v_mfma_f32_16x16x32_bf16 v[64:67],a[212:215],a[116:119],v[64:67]
v_exp_f32 v61,v61
v_mfma_f32_16x16x32_bf16 v[72:75],a[192:195],a[120:123],0
v_exp_f32 v62,v62
v_mfma_f32_16x16x32_bf16 v[72:75],a[196:199],a[124:127],v[72:75]
v_exp_f32 v63,v63
v_mfma_f32_16x16x32_bf16 v[72:75],a[200:203],a[128:131],v[72:75]
v_cvt_pk_bf16_f32 v98,v36,v37
v_cvt_pk_bf16_f32 v99,v38,v39
v_mfma_f32_16x16x32_bf16 v[72:75],a[204:207],a[132:135],v[72:75]
v_cvt_pk_bf16_f32 v102,v44,v45
v_cvt_pk_bf16_f32 v103,v46,v47
v_mfma_f32_16x16x32_bf16 v[128:131],v[24:27],v[96:99],v[128:131]
v_cvt_pk_bf16_f32 v104,v48,v49
v_cvt_pk_bf16_f32 v105,v50,v51
v_mfma_f32_16x16x32_bf16 v[132:135],v[24:27],v[100:103],v[132:135]
v_cvt_pk_bf16_f32 v106,v52,v53
v_cvt_pk_bf16_f32 v107,v54,v55
v_mfma_f32_16x16x32_bf16 v[72:75],a[208:211],a[136:139],v[72:75]
v_cvt_pk_bf16_f32 v108,v56,v57
v_cvt_pk_bf16_f32 v109,v58,v59
v_mfma_f32_16x16x32_bf16 v[136:139],v[24:27],v[104:107],v[136:139]
v_cvt_pk_bf16_f32 v110,v60,v61
v_cvt_pk_bf16_f32 v111,v62,v63
v_mfma_f32_16x16x32_bf16 v[72:75],a[212:215],a[140:143],v[72:75]
v_fma_f32 v64,v64,s36,v16
v_fma_f32 v65,v65,s36,v16
v_mfma_f32_16x16x32_bf16 v[140:143],v[24:27],v[108:111],v[140:143]
v_fma_f32 v66,v66,s36,v16
v_fma_f32 v67,v67,s36,v16
v_mfma_f32_16x16x32_bf16 v[80:83],a[192:195],a[144:147],0
v_exp_f32 v64,v64
v_mfma_f32_16x16x32_bf16 v[80:83],a[196:199],a[148:151],v[80:83]
v_fma_f32 v72,v72,s36,v17
v_fma_f32 v73,v73,s36,v17
v_mfma_f32_16x16x32_bf16 v[80:83],a[200:203],a[152:155],v[80:83]
v_fma_f32 v74,v74,s36,v17
v_fma_f32 v75,v75,s36,v17
v_mfma_f32_16x16x32_bf16 v[80:83],a[204:207],a[156:159],v[80:83]
v_exp_f32 v65,v65
v_mfma_f32_16x16x32_bf16 v[80:83],a[208:211],a[160:163],v[80:83]
v_exp_f32 v66,v66
v_mfma_f32_16x16x32_bf16 v[80:83],a[212:215],a[164:167],v[80:83]
v_exp_f32 v67,v67
v_mfma_f32_16x16x32_bf16 v[88:91],a[192:195],a[168:171],0
v_exp_f32 v72,v72
v_mfma_f32_16x16x32_bf16 v[88:91],a[196:199],a[172:175],v[88:91]
v_exp_f32 v73,v73
v_mfma_f32_16x16x32_bf16 v[88:91],a[200:203],a[176:179],v[88:91]
v_exp_f32 v74,v74
v_mfma_f32_16x16x32_bf16 v[88:91],a[204:207],a[180:183],v[88:91]
v_exp_f32 v75,v75
v_mfma_f32_16x16x32_bf16 v[88:91],a[208:211],a[184:187],v[88:91]
v_cvt_pk_bf16_f32 v112,v64,v65
v_cvt_pk_bf16_f32 v113,v66,v67
v_mfma_f32_16x16x32_bf16 v[88:91],a[212:215],a[188:191],v[88:91]
v_cvt_pk_bf16_f32 v116,v72,v73
v_cvt_pk_bf16_f32 v117,v74,v75
v_mfma_f32_16x16x32_bf16 v[68:71],a[216:219],a[96:99],0
v_mfma_f32_16x16x32_bf16 v[68:71],a[220:223],a[100:103],v[68:71]
v_mfma_f32_16x16x32_bf16 v[68:71],a[224:227],a[104:107],v[68:71]
v_mfma_f32_16x16x32_bf16 v[68:71],a[228:231],a[108:111],v[68:71]
v_mfma_f32_16x16x32_bf16 v[68:71],a[232:235],a[112:115],v[68:71]
v_mfma_f32_16x16x32_bf16 v[68:71],a[236:239],a[116:119],v[68:71]
v_mfma_f32_16x16x32_bf16 v[76:79],a[216:219],a[120:123],0
v_mfma_f32_16x16x32_bf16 v[76:79],a[220:223],a[124:127],v[76:79]
v_mfma_f32_16x16x32_bf16 v[76:79],a[224:227],a[128:131],v[76:79]
v_mfma_f32_16x16x32_bf16 v[76:79],a[228:231],a[132:135],v[76:79]
v_mfma_f32_16x16x32_bf16 v[76:79],a[232:235],a[136:139],v[76:79]
s_waitcnt vmcnt(6)
s_barrier
v_mfma_f32_16x16x32_bf16 v[76:79],a[236:239],a[140:143],v[76:79]
v_mfma_f32_16x16x32_bf16 v[84:87],a[216:219],a[144:147],0
ds_read_b64_tr_b16 a[240:241],v3 offset:24576
ds_read_b64_tr_b16 a[242:243],v3 offset:30720
v_mfma_f32_16x16x32_bf16 v[84:87],a[220:223],a[148:151],v[84:87]
v_mfma_f32_16x16x32_bf16 v[84:87],a[224:227],a[152:155],v[84:87]
ds_read_b64_tr_b16 a[244:245],v4 offset:24576
ds_read_b64_tr_b16 a[246:247],v4 offset:30720
v_mfma_f32_16x16x32_bf16 v[84:87],a[228:231],a[156:159],v[84:87]
v_mfma_f32_16x16x32_bf16 v[84:87],a[232:235],a[160:163],v[84:87]
ds_read_b64_tr_b16 a[248:249],v5 offset:24576
ds_read_b64_tr_b16 a[250:251],v5 offset:30720
v_mfma_f32_16x16x32_bf16 v[84:87],a[236:239],a[164:167],v[84:87]
v_mfma_f32_16x16x32_bf16 v[92:95],a[216:219],a[168:171],0
ds_read_b64_tr_b16 a[252:253],v6 offset:24576
ds_read_b64_tr_b16 a[254:255],v6 offset:30720
v_mfma_f32_16x16x32_bf16 v[92:95],a[220:223],a[172:175],v[92:95]
v_mfma_f32_16x16x32_bf16 v[92:95],a[224:227],a[176:179],v[92:95]
v_mfma_f32_16x16x32_bf16 v[92:95],a[228:231],a[180:183],v[92:95]
v_mfma_f32_16x16x32_bf16 v[92:95],a[232:235],a[184:187],v[92:95]
v_mfma_f32_16x16x32_bf16 v[92:95],a[236:239],a[188:191],v[92:95]
s_mov_b32 s38,0
s_branch L_loop4
L_tr33:
s_waitcnt vmcnt(36)
s_waitcnt lgkmcnt(4)
v_mfma_f32_16x16x32_bf16 v[160:163],a[240:243],v[96:99],v[160:163]
ds_read_b128 a[96:99],v28 offset:0
v_fma_f32 v68,v68,s36,v16
v_mfma_f32_16x16x32_bf16 v[208:211],a[240:243],v[100:103],v[208:211]
ds_read_b128 a[100:103],v29 offset:0
v_fma_f32 v69,v69,s36,v16
v_mfma_f32_16x16x32_bf16 a[0:3],a[240:243],v[104:107],a[0:3]
ds_read_b128 a[104:107],v28 offset:128
v_fma_f32 v70,v70,s36,v16
v_mfma_f32_16x16x32_bf16 v[164:167],a[244:247],v[96:99],v[164:167]
ds_read_b128 a[108:111],v29 offset:128
v_fma_f32 v71,v71,s36,v16
v_mfma_f32_16x16x32_bf16 v[212:215],a[244:247],v[100:103],v[212:215]
ds_read_b128 a[112:115],v28 offset:256
v_fma_f32 v76,v76,s36,v17
v_mfma_f32_16x16x32_bf16 a[4:7],a[244:247],v[104:107],a[4:7]
s_waitcnt lgkmcnt(5)
ds_read_b128 a[116:119],v29 offset:256
v_fma_f32 v77,v77,s36,v17
v_mfma_f32_16x16x32_bf16 v[168:171],a[248:251],v[96:99],v[168:171]
ds_read_b64_tr_b16 a[240:241],v3 offset:24704
ds_read_b64_tr_b16 a[242:243],v3 offset:30848
v_mfma_f32_16x16x32_bf16 v[216:219],a[248:251],v[100:103],v[216:219]
ds_read_b64_tr_b16 a[244:245],v4 offset:24704
ds_read_b64_tr_b16 a[246:247],v4 offset:30848
v_mfma_f32_16x16x32_bf16 a[8:11],a[248:251],v[104:107],a[8:11]
ds_read_b64_tr_b16 a[248:249],v5 offset:24704
ds_read_b64_tr_b16 a[250:251],v5 offset:30848
v_mfma_f32_16x16x32_bf16 v[172:175],a[252:255],v[96:99],v[172:175]
ds_read_b128 a[192:195],v13 offset:0
v_fma_f32 v78,v78,s36,v17
v_mfma_f32_16x16x32_bf16 v[220:223],a[252:255],v[100:103],v[220:223]
ds_read_b128 a[196:199],v14 offset:0
v_fma_f32 v79,v79,s36,v17
v_mfma_f32_16x16x32_bf16 a[12:15],a[252:255],v[104:107],a[12:15]
ds_read_b64_tr_b16 a[252:253],v6 offset:24704
ds_read_b64_tr_b16 a[254:255],v6 offset:30848
ds_read_b128 a[200:203],v13 offset:128
v_fma_f32 v80,v80,s36,v18
v_fma_f32 v81,v81,s36,v18
v_fma_f32 v82,v82,s36,v18
v_fma_f32 v83,v83,s36,v18
v_fma_f32 v84,v84,s36,v18
v_fma_f32 v85,v85,s36,v18
v_fma_f32 v86,v86,s36,v18
v_fma_f32 v87,v87,s36,v18
v_exp_f32 v68,v68
v_exp_f32 v69,v69
v_exp_f32 v70,v70
s_waitcnt lgkmcnt(9)
v_mfma_f32_16x16x32_bf16 v[176:179],a[240:243],v[96:99],v[176:179]
ds_read_b128 a[204:207],v14 offset:128
v_exp_f32 v71,v71
v_mfma_f32_16x16x32_bf16 v[224:227],a[240:243],v[100:103],v[224:227]
ds_read_b128 a[208:211],v13 offset:256
v_exp_f32 v76,v76
v_mfma_f32_16x16x32_bf16 a[16:19],a[240:243],v[104:107],a[16:19]
s_waitcnt lgkmcnt(5)
ds_read_b64_tr_b16 a[240:241],v3 offset:24832
ds_read_b64_tr_b16 a[242:243],v3 offset:30976
v_mfma_f32_16x16x32_bf16 v[180:183],a[244:247],v[96:99],v[180:183]
ds_read_b128 a[212:215],v14 offset:256
v_exp_f32 v77,v77
v_mfma_f32_16x16x32_bf16 v[228:231],a[244:247],v[100:103],v[228:231]
ds_read_b128 a[216:219],v13 offset:45056
v_exp_f32 v78,v78
v_mfma_f32_16x16x32_bf16 a[20:23],a[244:247],v[104:107],a[20:23]
ds_read_b64_tr_b16 a[244:245],v4 offset:24832
ds_read_b64_tr_b16 a[246:247],v4 offset:30976
v_mfma_f32_16x16x32_bf16 v[184:187],a[248:251],v[96:99],v[184:187]
ds_read_b128 a[220:223],v14 offset:45056
v_exp_f32 v79,v79
v_mfma_f32_16x16x32_bf16 v[232:235],a[248:251],v[100:103],v[232:235]
ds_read_b128 a[224:227],v13 offset:45184
v_exp_f32 v80,v80
v_mfma_f32_16x16x32_bf16 a[24:27],a[248:251],v[104:107],a[24:27]
s_waitcnt lgkmcnt(8)
ds_read_b64_tr_b16 a[248:249],v5 offset:24832
ds_read_b64_tr_b16 a[250:251],v5 offset:30976
v_mfma_f32_16x16x32_bf16 v[188:191],a[252:255],v[96:99],v[188:191]
ds_read_b128 a[228:231],v14 offset:45184
v_exp_f32 v81,v81
v_mfma_f32_16x16x32_bf16 v[236:239],a[252:255],v[100:103],v[236:239]
ds_read_b128 a[232:235],v13 offset:45312
v_exp_f32 v82,v82
v_mfma_f32_16x16x32_bf16 a[28:31],a[252:255],v[104:107],a[28:31]
s_waitcnt lgkmcnt(8)
ds_read_b64_tr_b16 a[252:253],v6 offset:24832
ds_read_b64_tr_b16 a[254:255],v6 offset:30976
v_mfma_f32_16x16x32_bf16 v[192:195],a[240:243],v[96:99],v[192:195]
ds_read_b128 a[236:239],v14 offset:45312
v_exp_f32 v83,v83
v_mfma_f32_16x16x32_bf16 v[240:243],a[240:243],v[100:103],v[240:243]
ds_read_b128 a[120:123],v28 offset:6144
v_exp_f32 v84,v84
v_mfma_f32_16x16x32_bf16 a[32:35],a[240:243],v[104:107],a[32:35]
s_waitcnt lgkmcnt(8)
ds_read_b128 a[124:127],v29 offset:6144
v_exp_f32 v85,v85
v_mfma_f32_16x16x32_bf16 v[196:199],a[244:247],v[96:99],v[196:199]
ds_read_b128 a[128:131],v28 offset:6272
v_exp_f32 v86,v86
v_mfma_f32_16x16x32_bf16 v[244:247],a[244:247],v[100:103],v[244:247]
ds_read_b128 a[132:135],v29 offset:6272
v_exp_f32 v87,v87
s_waitcnt vmcnt(6)
v_mfma_f32_16x16x32_bf16 a[36:39],a[244:247],v[104:107],a[36:39]
s_waitcnt lgkmcnt(7)
ds_read_b128 a[136:139],v28 offset:6400
v_cvt_pk_bf16_f32 v114,v68,v69
v_mfma_f32_16x16x32_bf16 v[200:203],a[248:251],v[96:99],v[200:203]
ds_read_b128 a[140:143],v29 offset:6400
v_cvt_pk_bf16_f32 v115,v70,v71
v_mfma_f32_16x16x32_bf16 v[248:251],a[248:251],v[100:103],v[248:251]
s_waitcnt lgkmcnt(6)
v_cvt_pk_bf16_f32 v118,v76,v77
v_cvt_pk_bf16_f32 v119,v78,v79
s_barrier
v_mfma_f32_16x16x32_bf16 v[128:131],v[24:27],v[112:115],v[128:131]
v_cvt_pk_bf16_f32 v120,v80,v81
v_cvt_pk_bf16_f32 v121,v82,v83
v_mfma_f32_16x16x32_bf16 v[132:135],v[24:27],v[116:119],v[132:135]
v_cvt_pk_bf16_f32 v122,v84,v85
v_cvt_pk_bf16_f32 v123,v86,v87
v_mfma_f32_16x16x32_bf16 a[40:43],a[248:251],v[104:107],a[40:43]
ds_read_b64_tr_b16 a[240:241],v3 offset:0
ds_read_b64_tr_b16 a[242:243],v3 offset:6144
v_mfma_f32_16x16x32_bf16 v[136:139],v[24:27],v[120:123],v[136:139]
ds_read_b64_tr_b16 a[244:245],v4 offset:0
ds_read_b64_tr_b16 a[246:247],v4 offset:6144
v_mfma_f32_16x16x32_bf16 v[204:207],a[252:255],v[96:99],v[204:207]
v_mfma_f32_16x16x32_bf16 v[252:255],a[252:255],v[100:103],v[252:255]
ds_read_b64_tr_b16 a[248:249],v5 offset:0
ds_read_b64_tr_b16 a[250:251],v5 offset:6144
v_mfma_f32_16x16x32_bf16 a[44:47],a[252:255],v[104:107],a[44:47]
s_waitcnt lgkmcnt(4)
ds_read_b64_tr_b16 a[252:253],v6 offset:0
ds_read_b64_tr_b16 a[254:255],v6 offset:6144
v_mfma_f32_16x16x32_bf16 v[160:163],a[240:243],v[112:115],v[160:163]
v_rcp_f32 v144,v128
v_mfma_f32_16x16x32_bf16 v[208:211],a[240:243],v[116:119],v[208:211]
v_rcp_f32 v146,v132
v_mfma_f32_16x16x32_bf16 a[0:3],a[240:243],v[120:123],a[0:3]
s_waitcnt lgkmcnt(4)
ds_read_b64_tr_b16 a[240:241],v3 offset:128
ds_read_b64_tr_b16 a[242:243],v3 offset:6272
v_mfma_f32_16x16x32_bf16 v[164:167],a[244:247],v[112:115],v[164:167]
v_rcp_f32 v148,v136
v_mfma_f32_16x16x32_bf16 v[212:215],a[244:247],v[116:119],v[212:215]
v_max3_f32 v30,v128,v132,v136
v_cmp_ngt_f32 vcc,s37,v30
v_mfma_f32_16x16x32_bf16 a[4:7],a[244:247],v[120:123],a[4:7]
s_waitcnt lgkmcnt(4)
ds_read_b64_tr_b16 a[244:245],v4 offset:128
ds_read_b64_tr_b16 a[246:247],v4 offset:6272
v_mfma_f32_16x16x32_bf16 v[168:171],a[248:251],v[112:115],v[168:171]
s_cmp_lg_u64 vcc,0
v_accvgpr_read_b32 v64,a0
v_accvgpr_read_b32 v65,a1
v_mfma_f32_16x16x32_bf16 v[216:219],a[248:251],v[116:119],v[216:219]
s_cselect_b32 s62,s32,0
v_accvgpr_read_b32 v66,a2
v_accvgpr_read_b32 v67,a3
v_accvgpr_read_b32 v72,a4
v_accvgpr_read_b32 v73,a5
v_accvgpr_read_b32 v74,a6
v_pk_mul_f32 v[160:161],v[160:161],v[144:145] op_sel_hi:[1,0]
v_pk_mul_f32 v[162:163],v[162:163],v[144:145] op_sel_hi:[1,0]
v_pk_mul_f32 v[208:209],v[208:209],v[146:147] op_sel_hi:[1,0]
v_pk_mul_f32 v[210:211],v[210:211],v[146:147] op_sel_hi:[1,0]
v_accvgpr_read_b32 v75,a7
v_cvt_pk_bf16_f32 v80,v160,v161
v_mfma_f32_16x16x32_bf16 a[8:11],a[248:251],v[120:123],a[8:11]
s_or_b32 s31,s31,s62
ds_read_b64_tr_b16 a[248:249],v5 offset:128
ds_read_b64_tr_b16 a[250:251],v5 offset:6272
s_waitcnt lgkmcnt(4)
v_mfma_f32_16x16x32_bf16 v[172:175],a[252:255],v[112:115],v[172:175]
s_lshl_b32 s32,s32,1
v_cvt_pk_bf16_f32 v81,v162,v163
v_cvt_pk_bf16_f32 v82,v208,v209
v_mfma_f32_16x16x32_bf16 v[220:223],a[252:255],v[116:119],v[220:223]
s_add_u32 m0,s22,24576
v_cvt_pk_bf16_f32 v83,v210,v211
v_subrev_u32 v11,18432,v11
v_subrev_u32 v23,18432,v23
v_subrev_u32 v31,18432,v31
v_pk_mul_f32 v[164:165],v[164:165],v[144:145] op_sel_hi:[1,0]
v_pk_mul_f32 v[166:167],v[166:167],v[144:145] op_sel_hi:[1,0]
v_pk_mul_f32 v[212:213],v[212:213],v[146:147] op_sel_hi:[1,0]
v_pk_mul_f32 v[214:215],v[214:215],v[146:147] op_sel_hi:[1,0]
v_cvt_pk_bf16_f32 v84,v164,v165
v_cvt_pk_bf16_f32 v85,v166,v167
v_mfma_f32_16x16x32_bf16 a[12:15],a[252:255],v[120:123],a[12:15]
buffer_load_dwordx4 v7,s[4:7],s20 offen offset:0 lds
v_mfma_f32_16x16x32_bf16 v[176:179],a[240:243],v[112:115],v[176:179]
ds_read_b64_tr_b16 a[252:253],v6 offset:128
ds_read_b64_tr_b16 a[254:255],v6 offset:6272
v_mfma_f32_16x16x32_bf16 v[224:227],a[240:243],v[116:119],v[224:227]
ds_write2st64_b64 v12,v[80:81],v[82:83] offset0:0 offset1:12
v_mfma_f32_16x16x32_bf16 a[16:19],a[240:243],v[120:123],a[16:19]
v_cvt_pk_bf16_f32 v86,v212,v213
v_cvt_pk_bf16_f32 v87,v214,v215
v_pk_mul_f32 v[168:169],v[168:169],v[144:145] op_sel_hi:[1,0]
v_pk_mul_f32 v[170:171],v[170:171],v[144:145] op_sel_hi:[1,0]
v_pk_mul_f32 v[216:217],v[216:217],v[146:147] op_sel_hi:[1,0]
v_pk_mul_f32 v[218:219],v[218:219],v[146:147] op_sel_hi:[1,0]
v_cvt_pk_bf16_f32 v88,v168,v169
v_cvt_pk_bf16_f32 v89,v170,v171
s_waitcnt lgkmcnt(3)
v_mfma_f32_16x16x32_bf16 v[180:183],a[244:247],v[112:115],v[180:183]
ds_read_b64_tr_b16 a[240:241],v3 offset:256
ds_read_b64_tr_b16 a[242:243],v3 offset:6400
v_mfma_f32_16x16x32_bf16 v[228:231],a[244:247],v[116:119],v[228:231]
ds_write2st64_b64 v20,v[84:85],v[86:87] offset0:0 offset1:12
v_mfma_f32_16x16x32_bf16 a[20:23],a[244:247],v[120:123],a[20:23]
v_accvgpr_read_b32 v68,a16
v_accvgpr_read_b32 v69,a17
v_accvgpr_read_b32 v70,a18
v_accvgpr_read_b32 v71,a19
v_cvt_pk_bf16_f32 v90,v216,v217
v_pk_mul_f32 v[172:173],v[172:173],v[144:145] op_sel_hi:[1,0]
v_pk_mul_f32 v[174:175],v[174:175],v[144:145] op_sel_hi:[1,0]
v_pk_mul_f32 v[220:221],v[220:221],v[146:147] op_sel_hi:[1,0]
v_pk_mul_f32 v[222:223],v[222:223],v[146:147] op_sel_hi:[1,0]
v_accvgpr_read_b32 v76,a20
v_accvgpr_read_b32 v77,a21
v_mfma_f32_16x16x32_bf16 v[184:187],a[248:251],v[112:115],v[184:187]
buffer_load_dwordx4 v8,s[4:7],s20 offen offset:1024 lds
v_mfma_f32_16x16x32_bf16 v[232:235],a[248:251],v[116:119],v[232:235]
ds_read_b64_tr_b16 a[244:245],v4 offset:256
ds_read_b64_tr_b16 a[246:247],v4 offset:6400
v_mfma_f32_16x16x32_bf16 a[24:27],a[248:251],v[120:123],a[24:27]
ds_read_b64_tr_b16 a[248:249],v5 offset:256
ds_read_b64_tr_b16 a[250:251],v5 offset:6400
v_accvgpr_read_b32 v78,a22
v_accvgpr_read_b32 v79,a23
v_cvt_pk_bf16_f32 v91,v218,v219
v_pk_mul_f32 v[176:177],v[176:177],v[144:145] op_sel_hi:[1,0]
v_pk_mul_f32 v[178:179],v[178:179],v[144:145] op_sel_hi:[1,0]
v_pk_mul_f32 v[224:225],v[224:225],v[146:147] op_sel_hi:[1,0]
v_pk_mul_f32 v[226:227],v[226:227],v[146:147] op_sel_hi:[1,0]
v_cvt_pk_bf16_f32 v92,v172,v173
v_cvt_pk_bf16_f32 v93,v174,v175
s_waitcnt lgkmcnt(4)
v_mfma_f32_16x16x32_bf16 v[188:191],a[252:255],v[112:115],v[188:191]
ds_write2st64_b64 v21,v[88:89],v[90:91] offset0:0 offset1:12
v_mfma_f32_16x16x32_bf16 v[236:239],a[252:255],v[116:119],v[236:239]
v_cvt_pk_bf16_f32 v94,v220,v221
v_cvt_pk_bf16_f32 v95,v222,v223
v_mfma_f32_16x16x32_bf16 a[28:31],a[252:255],v[120:123],a[28:31]
v_cvt_pk_bf16_f32 v80,v176,v177
v_cvt_pk_bf16_f32 v81,v178,v179
v_mfma_f32_16x16x32_bf16 v[192:195],a[240:243],v[112:115],v[192:195]
ds_read_b64_tr_b16 a[252:253],v6 offset:256
ds_read_b64_tr_b16 a[254:255],v6 offset:6400
ds_write2st64_b64 v22,v[92:93],v[94:95] offset0:0 offset1:12
v_pk_mul_f32 v[180:181],v[180:181],v[144:145] op_sel_hi:[1,0]
v_pk_mul_f32 v[182:183],v[182:183],v[144:145] op_sel_hi:[1,0]
v_pk_mul_f32 v[228:229],v[228:229],v[146:147] op_sel_hi:[1,0]
v_pk_mul_f32 v[230:231],v[230:231],v[146:147] op_sel_hi:[1,0]
v_cvt_pk_bf16_f32 v82,v224,v225
v_cvt_pk_bf16_f32 v83,v226,v227
v_mfma_f32_16x16x32_bf16 v[240:243],a[240:243],v[116:119],v[240:243]
ds_write2st64_b64 v12,v[80:81],v[82:83] offset0:2 offset1:14
v_mfma_f32_16x16x32_bf16 a[32:35],a[240:243],v[120:123],a[32:35]
s_waitcnt lgkmcnt(4)
v_cvt_pk_bf16_f32 v84,v180,v181
v_cvt_pk_bf16_f32 v85,v182,v183
v_mfma_f32_16x16x32_bf16 v[196:199],a[244:247],v[112:115],v[196:199]
v_cvt_pk_bf16_f32 v86,v228,v229
v_cvt_pk_bf16_f32 v87,v230,v231
buffer_load_dwordx4 v9,s[4:7],s20 offen offset:2048 lds
s_add_u32 s20,s20,12288
s_add_u32 m0,s23,0
v_pk_mul_f32 v[184:185],v[184:185],v[144:145] op_sel_hi:[1,0]
v_pk_mul_f32 v[186:187],v[186:187],v[144:145] op_sel_hi:[1,0]
v_pk_mul_f32 v[232:233],v[232:233],v[146:147] op_sel_hi:[1,0]
v_pk_mul_f32 v[234:235],v[234:235],v[146:147] op_sel_hi:[1,0]
v_cvt_pk_bf16_f32 v88,v184,v185
v_cvt_pk_bf16_f32 v89,v186,v187
v_mfma_f32_16x16x32_bf16 v[244:247],a[244:247],v[116:119],v[244:247]
ds_write2st64_b64 v20,v[84:85],v[86:87] offset0:2 offset1:14
v_mfma_f32_16x16x32_bf16 a[36:39],a[244:247],v[120:123],a[36:39]
v_cvt_pk_bf16_f32 v90,v232,v233
v_cvt_pk_bf16_f32 v91,v234,v235
v_mfma_f32_16x16x32_bf16 v[200:203],a[248:251],v[112:115],v[200:203]
v_mfma_f32_16x16x32_bf16 v[248:251],a[248:251],v[116:119],v[248:251]
ds_write2st64_b64 v21,v[88:89],v[90:91] offset0:2 offset1:14
v_pk_mul_f32 v[188:189],v[188:189],v[144:145] op_sel_hi:[1,0]
v_pk_mul_f32 v[190:191],v[190:191],v[144:145] op_sel_hi:[1,0]
v_pk_mul_f32 v[236:237],v[236:237],v[146:147] op_sel_hi:[1,0]
v_pk_mul_f32 v[238:239],v[238:239],v[146:147] op_sel_hi:[1,0]
v_cvt_pk_bf16_f32 v92,v188,v189
v_cvt_pk_bf16_f32 v93,v190,v191
v_mfma_f32_16x16x32_bf16 a[40:43],a[248:251],v[120:123],a[40:43]
s_waitcnt lgkmcnt(2)
v_cvt_pk_bf16_f32 v94,v236,v237
v_cvt_pk_bf16_f32 v95,v238,v239
v_mfma_f32_16x16x32_bf16 v[204:207],a[252:255],v[112:115],v[204:207]
s_waitcnt vmcnt(3)
ds_read_b128 a[144:147],v28 offset:12288
v_mfma_f32_16x16x32_bf16 v[252:255],a[252:255],v[116:119],v[252:255]
ds_read_b128 a[148:151],v29 offset:12288
ds_read_b128 a[152:155],v28 offset:12416
v_pk_mul_f32 v[192:193],v[192:193],v[144:145] op_sel_hi:[1,0]
v_pk_mul_f32 v[194:195],v[194:195],v[144:145] op_sel_hi:[1,0]
v_pk_mul_f32 v[240:241],v[240:241],v[146:147] op_sel_hi:[1,0]
v_pk_mul_f32 v[242:243],v[242:243],v[146:147] op_sel_hi:[1,0]
v_cvt_pk_bf16_f32 v80,v192,v193
v_cvt_pk_bf16_f32 v81,v194,v195
v_mfma_f32_16x16x32_bf16 a[44:47],a[252:255],v[120:123],a[44:47]
ds_read_b128 a[156:159],v29 offset:12416
v_cvt_pk_bf16_f32 v82,v240,v241
v_mfma_f32_16x16x32_bf16 v[32:35],a[192:195],a[96:99],0
ds_read_b128 a[160:163],v28 offset:12544
v_cvt_pk_bf16_f32 v83,v242,v243
s_waitcnt vmcnt(6)
s_barrier
v_mfma_f32_16x16x32_bf16 v[32:35],a[196:199],a[100:103],v[32:35]
ds_read_b128 a[164:167],v29 offset:12544
ds_write2st64_b64 v22,v[92:93],v[94:95] offset0:2 offset1:14
v_pk_mul_f32 v[196:197],v[196:197],v[144:145] op_sel_hi:[1,0]
v_pk_mul_f32 v[198:199],v[198:199],v[144:145] op_sel_hi:[1,0]
v_pk_mul_f32 v[244:245],v[244:245],v[146:147] op_sel_hi:[1,0]
v_pk_mul_f32 v[246:247],v[246:247],v[146:147] op_sel_hi:[1,0]
v_cvt_pk_bf16_f32 v84,v196,v197
v_cvt_pk_bf16_f32 v85,v198,v199
v_mfma_f32_16x16x32_bf16 v[32:35],a[200:203],a[104:107],v[32:35]
ds_write2st64_b64 v12,v[80:81],v[82:83] offset0:4 offset1:16
v_mfma_f32_16x16x32_bf16 v[32:35],a[204:207],a[108:111],v[32:35]
v_cvt_pk_bf16_f32 v86,v244,v245
v_cvt_pk_bf16_f32 v87,v246,v247
v_mfma_f32_16x16x32_bf16 v[32:35],a[208:211],a[112:115],v[32:35]
v_mfma_f32_16x16x32_bf16 v[32:35],a[212:215],a[116:119],v[32:35]
buffer_load_dwordx4 v7,s[8:11],s21 offen offset:0 lds
v_pk_mul_f32 v[200:201],v[200:201],v[144:145] op_sel_hi:[1,0]
v_pk_mul_f32 v[202:203],v[202:203],v[144:145] op_sel_hi:[1,0]
v_pk_mul_f32 v[248:249],v[248:249],v[146:147] op_sel_hi:[1,0]
v_pk_mul_f32 v[250:251],v[250:251],v[146:147] op_sel_hi:[1,0]
v_cvt_pk_bf16_f32 v88,v200,v201
v_cvt_pk_bf16_f32 v89,v202,v203
v_mfma_f32_16x16x32_bf16 v[36:39],a[216:219],a[96:99],0
ds_write2st64_b64 v20,v[84:85],v[86:87] offset0:4 offset1:16
v_mfma_f32_16x16x32_bf16 v[36:39],a[220:223],a[100:103],v[36:39]
v_cvt_pk_bf16_f32 v90,v248,v249
v_cvt_pk_bf16_f32 v91,v250,v251
v_mfma_f32_16x16x32_bf16 v[36:39],a[224:227],a[104:107],v[36:39]
ds_write2st64_b64 v21,v[88:89],v[90:91] offset0:4 offset1:16
v_pk_mul_f32 v[204:205],v[204:205],v[144:145] op_sel_hi:[1,0]
v_pk_mul_f32 v[206:207],v[206:207],v[144:145] op_sel_hi:[1,0]
v_pk_mul_f32 v[252:253],v[252:253],v[146:147] op_sel_hi:[1,0]
v_pk_mul_f32 v[254:255],v[254:255],v[146:147] op_sel_hi:[1,0]
v_cvt_pk_bf16_f32 v92,v204,v205
v_cvt_pk_bf16_f32 v93,v206,v207
v_mfma_f32_16x16x32_bf16 v[36:39],a[228:231],a[108:111],v[36:39]
v_cvt_pk_bf16_f32 v94,v252,v253
v_cvt_pk_bf16_f32 v95,v254,v255
v_mfma_f32_16x16x32_bf16 v[36:39],a[232:235],a[112:115],v[36:39]
buffer_load_dwordx4 v8,s[8:11],s21 offen offset:1024 lds
v_mfma_f32_16x16x32_bf16 v[36:39],a[236:239],a[116:119],v[36:39]
ds_write2st64_b64 v22,v[92:93],v[94:95] offset0:4 offset1:16
v_pk_mul_f32 v[64:65],v[64:65],v[148:149] op_sel_hi:[1,0]
v_pk_mul_f32 v[66:67],v[66:67],v[148:149] op_sel_hi:[1,0]
v_pk_mul_f32 v[68:69],v[68:69],v[148:149] op_sel_hi:[1,0]
v_pk_mul_f32 v[70:71],v[70:71],v[148:149] op_sel_hi:[1,0]
v_cvt_pk_bf16_f32 v80,v64,v65
v_cvt_pk_bf16_f32 v81,v66,v67
v_mfma_f32_16x16x32_bf16 v[40:43],a[192:195],a[120:123],0
v_cvt_pk_bf16_f32 v82,v68,v69
v_cvt_pk_bf16_f32 v83,v70,v71
v_mfma_f32_16x16x32_bf16 v[40:43],a[196:199],a[124:127],v[40:43]
ds_write2st64_b64 v12,v[80:81],v[82:83] offset0:24 offset1:26
v_mfma_f32_16x16x32_bf16 v[40:43],a[200:203],a[128:131],v[40:43]
v_accvgpr_read_b32 v64,a8
v_accvgpr_read_b32 v65,a9
v_mfma_f32_16x16x32_bf16 v[40:43],a[204:207],a[132:135],v[40:43]
v_accvgpr_read_b32 v66,a10
v_accvgpr_read_b32 v67,a11
v_accvgpr_read_b32 v68,a24
v_accvgpr_read_b32 v69,a25
v_accvgpr_read_b32 v70,a26
v_pk_mul_f32 v[72:73],v[72:73],v[148:149] op_sel_hi:[1,0]
v_pk_mul_f32 v[74:75],v[74:75],v[148:149] op_sel_hi:[1,0]
v_pk_mul_f32 v[76:77],v[76:77],v[148:149] op_sel_hi:[1,0]
v_pk_mul_f32 v[78:79],v[78:79],v[148:149] op_sel_hi:[1,0]
v_accvgpr_read_b32 v71,a27
v_cvt_pk_bf16_f32 v84,v72,v73
v_mfma_f32_16x16x32_bf16 v[40:43],a[208:211],a[136:139],v[40:43]
buffer_load_dwordx4 v9,s[8:11],s21 offen offset:2048 lds
s_add_u32 s21,s21,12288
s_mov_b32 s27,s42
v_mfma_f32_16x16x32_bf16 v[40:43],a[212:215],a[140:143],v[40:43]
s_mov_b32 s42,s41
v_cvt_pk_bf16_f32 v85,v74,v75
v_cvt_pk_bf16_f32 v86,v76,v77
v_mfma_f32_16x16x32_bf16 v[44:47],a[216:219],a[120:123],0
s_add_u32 s69,s69,1
v_cvt_pk_bf16_f32 v87,v78,v79
v_accvgpr_read_b32 v72,a12
v_accvgpr_read_b32 v73,a13
v_accvgpr_read_b32 v74,a14
v_accvgpr_read_b32 v75,a15
v_pk_mul_f32 v[64:65],v[64:65],v[148:149] op_sel_hi:[1,0]
v_pk_mul_f32 v[66:67],v[66:67],v[148:149] op_sel_hi:[1,0]
v_pk_mul_f32 v[68:69],v[68:69],v[148:149] op_sel_hi:[1,0]
v_pk_mul_f32 v[70:71],v[70:71],v[148:149] op_sel_hi:[1,0]
v_accvgpr_read_b32 v76,a28
v_accvgpr_read_b32 v77,a29
v_mfma_f32_16x16x32_bf16 v[44:47],a[220:223],a[124:127],v[44:47]
s_add_u32 s48,s48,325632
ds_write2st64_b64 v20,v[84:85],v[86:87] offset0:24 offset1:26
s_lshr_b32 s62,s39,s69
s_and_b32 s62,s62,1
s_lshl_b32 s62,s62,1
s_add_u32 s62,s62,s49
v_mfma_f32_16x16x32_bf16 v[44:47],a[224:227],a[128:131],v[44:47]
s_and_b32 s62,s62,3
v_accvgpr_read_b32 v78,a30
v_accvgpr_read_b32 v79,a31
v_mfma_f32_16x16x32_bf16 v[44:47],a[228:231],a[132:135],v[44:47]
s_add_u32 s63,s69,8
v_cvt_pk_bf16_f32 v88,v64,v65
v_cvt_pk_bf16_f32 v89,v66,v67
v_mfma_f32_16x16x32_bf16 v[44:47],a[232:235],a[136:139],v[44:47]
s_lshr_b32 s63,s39,s63
v_accvgpr_read_b32 v64,a32
v_accvgpr_read_b32 v65,a33
v_accvgpr_read_b32 v66,a34
v_accvgpr_read_b32 v67,a35
v_cvt_pk_bf16_f32 v90,v68,v69
v_pk_mul_f32 v[72:73],v[72:73],v[148:149] op_sel_hi:[1,0]
v_pk_mul_f32 v[74:75],v[74:75],v[148:149] op_sel_hi:[1,0]
v_pk_mul_f32 v[76:77],v[76:77],v[148:149] op_sel_hi:[1,0]
v_pk_mul_f32 v[78:79],v[78:79],v[148:149] op_sel_hi:[1,0]
v_cvt_pk_bf16_f32 v91,v70,v71
v_accvgpr_read_b32 v68,a36
v_mfma_f32_16x16x32_bf16 v[44:47],a[236:239],a[140:143],v[44:47]
s_and_b32 s63,s63,1
ds_write2st64_b64 v21,v[88:89],v[90:91] offset0:24 offset1:26
s_xor_b32 s62,s62,s63
s_mul_i32 s63,s3,3
s_lshl_b32 s64,s3,2
s_mov_b32 s40,1
s_waitcnt lgkmcnt(2)
v_mfma_f32_16x16x32_bf16 v[48:51],a[192:195],a[144:147],0
s_add_u32 s65,s63,17
v_accvgpr_read_b32 v69,a37
v_accvgpr_read_b32 v70,a38
v_mfma_f32_16x16x32_bf16 v[48:51],a[196:199],a[148:151],v[48:51]
s_cmp_eq_u32 s3,0
v_accvgpr_read_b32 v71,a39
v_cvt_pk_bf16_f32 v92,v72,v73
v_cvt_pk_bf16_f32 v93,v74,v75
v_accvgpr_read_b32 v72,a40
v_accvgpr_read_b32 v73,a41
v_pk_mul_f32 v[64:65],v[64:65],v[148:149] op_sel_hi:[1,0]
v_pk_mul_f32 v[66:67],v[66:67],v[148:149] op_sel_hi:[1,0]
v_accvgpr_read_b32 v74,a42
v_accvgpr_read_b32 v75,a43
v_mfma_f32_16x16x32_bf16 v[48:51],a[200:203],a[152:155],v[48:51]
s_cselect_b32 s65,16,s65
v_cvt_pk_bf16_f32 v94,v76,v77
v_cvt_pk_bf16_f32 v95,v78,v79
v_mfma_f32_16x16x32_bf16 v[48:51],a[204:207],a[156:159],v[48:51]
s_cselect_b32 s41,1,0
ds_write2st64_b64 v22,v[92:93],v[94:95] offset0:24 offset1:26
s_cmp_eq_u32 s62,1
s_cselect_b32 s64,s65,s64
s_cselect_b32 s40,s41,s40
s_add_u32 s65,s63,29
v_mfma_f32_16x16x32_bf16 v[48:51],a[208:211],a[160:163],v[48:51]
s_cmp_eq_u32 s62,2
v_cvt_pk_bf16_f32 v80,v64,v65
v_cvt_pk_bf16_f32 v81,v66,v67
v_accvgpr_read_b32 v76,a44
v_accvgpr_read_b32 v77,a45
v_accvgpr_read_b32 v78,a46
v_pk_mul_f32 v[68:69],v[68:69],v[148:149] op_sel_hi:[1,0]
v_pk_mul_f32 v[70:71],v[70:71],v[148:149] op_sel_hi:[1,0]
v_accvgpr_read_b32 v79,a47
v_cvt_pk_bf16_f32 v84,v68,v69
v_mfma_f32_16x16x32_bf16 v[48:51],a[212:215],a[164:167],v[48:51]
s_cselect_b32 s64,s65,s64
ds_write_b64 v12,v[80:81] offset:14336
s_cselect_b32 s40,0,s40
s_add_u32 s65,s63,41
v_mfma_f32_16x16x32_bf16 v[52:55],a[216:219],a[144:147],0
s_cmp_eq_u32 s62,3
v_cvt_pk_bf16_f32 v85,v70,v71
s_cselect_b32 s64,s65,s64
v_mfma_f32_16x16x32_bf16 v[52:55],a[220:223],a[148:151],v[52:55]
s_cselect_b32 s40,0,s40
ds_write_b64 v20,v[84:85] offset:14336
s_mul_i32 s64,s64,6144
s_add_u32 s41,s48,s64
v_mfma_f32_16x16x32_bf16 v[52:55],a[224:227],a[152:155],v[52:55]
s_cmp_ge_u32 s69,8
s_cselect_b32 s41,166723584,s41
s_mov_b32 s28,s41
s_mov_b32 s29,s24
s_add_u32 s25,s22,12288
s_add_u32 s26,s22,24576
v_pk_mul_f32 v[72:73],v[72:73],v[148:149] op_sel_hi:[1,0]
v_pk_mul_f32 v[74:75],v[74:75],v[148:149] op_sel_hi:[1,0]
v_cvt_pk_bf16_f32 v88,v72,v73
v_cvt_pk_bf16_f32 v89,v74,v75
v_mfma_f32_16x16x32_bf16 v[52:55],a[228:231],a[156:159],v[52:55]
ds_write_b64 v21,v[88:89] offset:14336
v_mfma_f32_16x16x32_bf16 v[52:55],a[232:235],a[160:163],v[52:55]
v_mfma_f32_16x16x32_bf16 v[52:55],a[236:239],a[164:167],v[52:55]
v_pk_mul_f32 v[76:77],v[76:77],v[148:149] op_sel_hi:[1,0]
v_pk_mul_f32 v[78:79],v[78:79],v[148:149] op_sel_hi:[1,0]
v_cvt_pk_bf16_f32 v92,v76,v77
v_cvt_pk_bf16_f32 v93,v78,v79
ds_write_b64 v22,v[92:93] offset:14336
ds_read_b128 a[192:195],v1 offset:12288
v_max3_f32 v144,v32,v33,v34
v_max3_f32 v144,v144,v35,v36
v_max3_f32 v144,v144,v37,v38
v_max_f32 v144,v144,v39
v_mov_b32 v145,v144
v_max3_f32 v146,v40,v41,v42
v_max3_f32 v146,v146,v43,v44
v_permlane32_swap_b32 v145,v144
s_add_u32 m0,s23,12288
v_max_f32 v144,v144,v145
v_mov_b32 v145,v144
v_max3_f32 v146,v146,v45,v46
v_max_f32 v146,v146,v47
v_permlane16_swap_b32 v145,v144
v_max_f32 v144,v144,v145
v_mul_f32_e64 v16,-s36,v144
v_max3_f32 v144,v48,v49,v50
v_max3_f32 v144,v144,v51,v52
v_max3_f32 v144,v144,v53,v54
v_max_f32 v144,v144,v55
v_mov_b32 v147,v146
v_mov_b32 v145,v144
v_fma_f32 v32,v32,s36,v16
v_permlane32_swap_b32 v147,v146
v_permlane32_swap_b32 v145,v144
v_max_f32 v146,v146,v147
v_max_f32 v144,v144,v145
v_mov_b32 v147,v146
v_mov_b32 v145,v144
v_fma_f32 v33,v33,s36,v16
v_permlane16_swap_b32 v147,v146
s_waitcnt lgkmcnt(0)
v_mfma_f32_16x16x32_bf16 v[64:67],a[192:195],a[96:99],0
buffer_load_dwordx4 v7,s[8:11],s21 offen offset:0 lds
ds_read_b128 a[196:199],v2 offset:12288
v_permlane16_swap_b32 v145,v144
v_max_f32 v146,v146,v147
v_max_f32 v144,v144,v145
v_mul_f32_e64 v17,-s36,v146
v_mul_f32_e64 v18,-s36,v144
v_fma_f32 v34,v34,s36,v16
v_fma_f32 v35,v35,s36,v16
v_fma_f32 v36,v36,s36,v16
v_fma_f32 v37,v37,s36,v16
v_fma_f32 v38,v38,s36,v16
v_fma_f32 v39,v39,s36,v16
v_fma_f32 v40,v40,s36,v17
v_fma_f32 v41,v41,s36,v17
v_fma_f32 v42,v42,s36,v17
v_fma_f32 v43,v43,s36,v17
v_fma_f32 v44,v44,s36,v17
v_fma_f32 v45,v45,s36,v17
v_fma_f32 v46,v46,s36,v17
v_fma_f32 v47,v47,s36,v17
v_fma_f32 v48,v48,s36,v18
v_fma_f32 v49,v49,s36,v18
v_fma_f32 v50,v50,s36,v18
v_fma_f32 v51,v51,s36,v18
v_fma_f32 v52,v52,s36,v18
v_fma_f32 v53,v53,s36,v18
v_fma_f32 v54,v54,s36,v18
v_fma_f32 v55,v55,s36,v18
v_exp_f32 v32,v32
v_exp_f32 v33,v33
v_exp_f32 v34,v34
s_waitcnt lgkmcnt(0)
v_mfma_f32_16x16x32_bf16 v[64:67],a[196:199],a[100:103],v[64:67]
buffer_load_dwordx4 v8,s[8:11],s21 offen offset:1024 lds
buffer_load_dwordx4 v9,s[8:11],s21 offen offset:2048 lds
s_add_u32 s21,s21,12288
s_add_u32 m0,s22,0
ds_read_b128 a[200:203],v1 offset:12416
v_exp_f32 v35,v35
v_exp_f32 v36,v36
v_exp_f32 v37,v37
v_exp_f32 v38,v38
v_exp_f32 v39,v39
v_exp_f32 v40,v40
v_exp_f32 v41,v41
v_exp_f32 v42,v42
v_exp_f32 v43,v43
v_exp_f32 v44,v44
v_exp_f32 v45,v45
v_exp_f32 v46,v46
v_exp_f32 v47,v47
v_exp_f32 v48,v48
v_exp_f32 v49,v49
v_exp_f32 v50,v50
v_exp_f32 v51,v51
s_waitcnt lgkmcnt(0)
v_mfma_f32_16x16x32_bf16 v[64:67],a[200:203],a[104:107],v[64:67]
buffer_load_dwordx4 v7,s[4:7],s20 offen offset:0 lds
ds_read_b128 a[204:207],v2 offset:12416
v_exp_f32 v52,v52
v_exp_f32 v53,v53
v_exp_f32 v54,v54
v_exp_f32 v55,v55
v_cvt_pk_bf16_f32 v96,v32,v33
v_cvt_pk_bf16_f32 v97,v34,v35
v_cvt_pk_bf16_f32 v98,v36,v37
v_cvt_pk_bf16_f32 v99,v38,v39
v_cvt_pk_bf16_f32 v100,v40,v41
v_cvt_pk_bf16_f32 v101,v42,v43
v_mfma_f32_16x16x32_bf16 v[128:131],v[24:27],v[96:99],0
ds_read_b128 a[208:211],v1 offset:12544
v_cvt_pk_bf16_f32 v102,v44,v45
v_cvt_pk_bf16_f32 v103,v46,v47
v_cvt_pk_bf16_f32 v104,v48,v49
v_cvt_pk_bf16_f32 v105,v50,v51
v_mfma_f32_16x16x32_bf16 v[132:135],v[24:27],v[100:103],0
ds_read_b128 a[212:215],v2 offset:12544
v_cvt_pk_bf16_f32 v106,v52,v53
v_cvt_pk_bf16_f32 v107,v54,v55
ds_read_b128 a[216:219],v1 offset:18432
buffer_load_dwordx4 v8,s[4:7],s20 offen offset:1024 lds
v_mfma_f32_16x16x32_bf16 v[136:139],v[24:27],v[104:107],0
s_waitcnt lgkmcnt(3)
ds_read_b128 a[220:223],v2 offset:18432
v_mfma_f32_16x16x32_bf16 v[64:67],a[204:207],a[108:111],v[64:67]
ds_read_b128 a[224:227],v1 offset:18560
ds_read_b128 a[228:231],v2 offset:18560
ds_read_b128 a[232:235],v1 offset:18688
ds_read_b128 a[236:239],v2 offset:18688
s_waitcnt lgkmcnt(7)
v_mfma_f32_16x16x32_bf16 v[64:67],a[208:211],a[112:115],v[64:67]
s_waitcnt lgkmcnt(6)
v_mfma_f32_16x16x32_bf16 v[64:67],a[212:215],a[116:119],v[64:67]
v_mfma_f32_16x16x32_bf16 v[72:75],a[192:195],a[120:123],0
v_mfma_f32_16x16x32_bf16 v[72:75],a[196:199],a[124:127],v[72:75]
buffer_load_dwordx4 v9,s[4:7],s20 offen offset:2048 lds
s_add_u32 s20,s20,12288
v_mfma_f32_16x16x32_bf16 v[72:75],a[200:203],a[128:131],v[72:75]
v_mfma_f32_16x16x32_bf16 v[72:75],a[204:207],a[132:135],v[72:75]
v_mfma_f32_16x16x32_bf16 v[72:75],a[208:211],a[136:139],v[72:75]
v_mfma_f32_16x16x32_bf16 v[72:75],a[212:215],a[140:143],v[72:75]
v_fma_f32 v64,v64,s36,v16
v_fma_f32 v65,v65,s36,v16
v_mfma_f32_16x16x32_bf16 v[80:83],a[192:195],a[144:147],0
v_fma_f32 v66,v66,s36,v16
v_fma_f32 v67,v67,s36,v16
v_mfma_f32_16x16x32_bf16 v[80:83],a[196:199],a[148:151],v[80:83]
v_exp_f32 v64,v64
v_mfma_f32_16x16x32_bf16 v[80:83],a[200:203],a[152:155],v[80:83]
v_fma_f32 v72,v72,s36,v17
v_fma_f32 v73,v73,s36,v17
v_mfma_f32_16x16x32_bf16 v[80:83],a[204:207],a[156:159],v[80:83]
v_fma_f32 v74,v74,s36,v17
v_fma_f32 v75,v75,s36,v17
v_mfma_f32_16x16x32_bf16 v[80:83],a[208:211],a[160:163],v[80:83]
v_exp_f32 v65,v65
v_mfma_f32_16x16x32_bf16 v[80:83],a[212:215],a[164:167],v[80:83]
s_waitcnt lgkmcnt(0)
v_exp_f32 v66,v66
v_mfma_f32_16x16x32_bf16 v[68:71],a[216:219],a[96:99],0
v_exp_f32 v67,v67
v_mfma_f32_16x16x32_bf16 v[68:71],a[220:223],a[100:103],v[68:71]
s_waitcnt vmcnt(6)
s_barrier
v_exp_f32 v72,v72
v_mfma_f32_16x16x32_bf16 v[68:71],a[224:227],a[104:107],v[68:71]
v_exp_f32 v73,v73
v_mfma_f32_16x16x32_bf16 v[68:71],a[228:231],a[108:111],v[68:71]
ds_read_b64_tr_b16 a[240:241],v3 offset:0
ds_read_b64_tr_b16 a[242:243],v3 offset:6144
v_mfma_f32_16x16x32_bf16 v[68:71],a[232:235],a[112:115],v[68:71]
ds_read_b64_tr_b16 a[244:245],v4 offset:0
ds_read_b64_tr_b16 a[246:247],v4 offset:6144
v_mfma_f32_16x16x32_bf16 v[68:71],a[236:239],a[116:119],v[68:71]
v_exp_f32 v74,v74
v_mfma_f32_16x16x32_bf16 v[76:79],a[216:219],a[120:123],0
ds_read_b64_tr_b16 a[248:249],v5 offset:0
ds_read_b64_tr_b16 a[250:251],v5 offset:6144
v_mfma_f32_16x16x32_bf16 v[76:79],a[220:223],a[124:127],v[76:79]
ds_read_b64_tr_b16 a[252:253],v6 offset:0
ds_read_b64_tr_b16 a[254:255],v6 offset:6144
v_mfma_f32_16x16x32_bf16 v[76:79],a[224:227],a[128:131],v[76:79]
v_exp_f32 v75,v75
v_mfma_f32_16x16x32_bf16 v[76:79],a[228:231],a[132:135],v[76:79]
v_cvt_pk_bf16_f32 v112,v64,v65
v_cvt_pk_bf16_f32 v113,v66,v67
v_mfma_f32_16x16x32_bf16 v[76:79],a[232:235],a[136:139],v[76:79]
v_cvt_pk_bf16_f32 v116,v72,v73
v_cvt_pk_bf16_f32 v117,v74,v75
v_mfma_f32_16x16x32_bf16 v[76:79],a[236:239],a[140:143],v[76:79]
v_mfma_f32_16x16x32_bf16 v[84:87],a[216:219],a[144:147],0
v_mfma_f32_16x16x32_bf16 v[84:87],a[220:223],a[148:151],v[84:87]
v_mfma_f32_16x16x32_bf16 v[84:87],a[224:227],a[152:155],v[84:87]
v_mfma_f32_16x16x32_bf16 v[84:87],a[228:231],a[156:159],v[84:87]
v_mfma_f32_16x16x32_bf16 v[84:87],a[232:235],a[160:163],v[84:87]
v_mfma_f32_16x16x32_bf16 v[84:87],a[236:239],a[164:167],v[84:87]
s_waitcnt lgkmcnt(0)
v_mfma_f32_16x16x32_bf16 v[160:163],a[240:243],v[96:99],0
s_add_u32 m0,s23,24576
ds_read_b128 a[192:195],v1 offset:24576
v_fma_f32 v68,v68,s36,v16
v_mfma_f32_16x16x32_bf16 v[208:211],a[240:243],v[100:103],0
buffer_load_dwordx4 v7,s[8:11],s21 offen offset:0 lds
v_mfma_f32_16x16x32_bf16 a[0:3],a[240:243],v[104:107],0
ds_read_b64_tr_b16 a[240:241],v3 offset:128
ds_read_b64_tr_b16 a[242:243],v3 offset:6272
v_mfma_f32_16x16x32_bf16 v[164:167],a[244:247],v[96:99],0
ds_read_b128 a[196:199],v2 offset:24576
v_fma_f32 v69,v69,s36,v16
v_mfma_f32_16x16x32_bf16 v[212:215],a[244:247],v[100:103],0
ds_read_b128 a[200:203],v1 offset:24704
v_fma_f32 v70,v70,s36,v16
v_mfma_f32_16x16x32_bf16 a[4:7],a[244:247],v[104:107],0
ds_read_b64_tr_b16 a[244:245],v4 offset:128
ds_read_b64_tr_b16 a[246:247],v4 offset:6272
v_mfma_f32_16x16x32_bf16 v[168:171],a[248:251],v[96:99],0
ds_read_b128 a[204:207],v2 offset:24704
v_fma_f32 v71,v71,s36,v16
v_mfma_f32_16x16x32_bf16 v[216:219],a[248:251],v[100:103],0
buffer_load_dwordx4 v8,s[8:11],s21 offen offset:1024 lds
v_mfma_f32_16x16x32_bf16 a[8:11],a[248:251],v[104:107],0
ds_read_b64_tr_b16 a[248:249],v5 offset:128
ds_read_b64_tr_b16 a[250:251],v5 offset:6272
v_mfma_f32_16x16x32_bf16 v[172:175],a[252:255],v[96:99],0
ds_read_b128 a[208:211],v1 offset:24832
v_fma_f32 v76,v76,s36,v17
v_mfma_f32_16x16x32_bf16 v[220:223],a[252:255],v[100:103],0
ds_read_b128 a[212:215],v2 offset:24832
v_fma_f32 v77,v77,s36,v17
v_mfma_f32_16x16x32_bf16 a[12:15],a[252:255],v[104:107],0
s_waitcnt lgkmcnt(8)
ds_read_b64_tr_b16 a[252:253],v6 offset:128
ds_read_b64_tr_b16 a[254:255],v6 offset:6272
v_mfma_f32_16x16x32_bf16 v[176:179],a[240:243],v[96:99],0
buffer_load_dwordx4 v9,s[8:11],s21 offen offset:2048 lds
v_mfma_f32_16x16x32_bf16 v[224:227],a[240:243],v[100:103],0
s_add_u32 s21,s21,12288
ds_read_b128 a[216:219],v1 offset:30720
v_fma_f32 v78,v78,s36,v17
v_mfma_f32_16x16x32_bf16 a[16:19],a[240:243],v[104:107],0
s_add_u32 m0,s22,12288
ds_read_b64_tr_b16 a[240:241],v3 offset:256
ds_read_b64_tr_b16 a[242:243],v3 offset:6400
s_waitcnt lgkmcnt(9)
v_mfma_f32_16x16x32_bf16 v[180:183],a[244:247],v[96:99],0
ds_read_b128 a[220:223],v2 offset:30720
v_fma_f32 v79,v79,s36,v17
v_mfma_f32_16x16x32_bf16 v[228:231],a[244:247],v[100:103],0
ds_read_b128 a[224:227],v1 offset:30848
v_fma_f32 v80,v80,s36,v18
v_mfma_f32_16x16x32_bf16 a[20:23],a[244:247],v[104:107],0
s_waitcnt lgkmcnt(8)
ds_read_b64_tr_b16 a[244:245],v4 offset:256
ds_read_b64_tr_b16 a[246:247],v4 offset:6400
v_mfma_f32_16x16x32_bf16 v[184:187],a[248:251],v[96:99],0
buffer_load_dwordx4 v7,s[4:7],s20 offen offset:0 lds
v_mfma_f32_16x16x32_bf16 v[232:235],a[248:251],v[100:103],0
ds_read_b128 a[228:231],v2 offset:30848
v_fma_f32 v81,v81,s36,v18
v_mfma_f32_16x16x32_bf16 a[24:27],a[248:251],v[104:107],0
s_waitcnt lgkmcnt(8)
ds_read_b64_tr_b16 a[248:249],v5 offset:256
ds_read_b64_tr_b16 a[250:251],v5 offset:6400
v_mfma_f32_16x16x32_bf16 v[188:191],a[252:255],v[96:99],0
ds_read_b128 a[232:235],v1 offset:30976
v_fma_f32 v82,v82,s36,v18
v_mfma_f32_16x16x32_bf16 v[236:239],a[252:255],v[100:103],0
ds_read_b128 a[236:239],v2 offset:30976
v_fma_f32 v83,v83,s36,v18
v_mfma_f32_16x16x32_bf16 a[28:31],a[252:255],v[104:107],0
s_waitcnt lgkmcnt(8)
ds_read_b64_tr_b16 a[252:253],v6 offset:256
ds_read_b64_tr_b16 a[254:255],v6 offset:6400
v_mfma_f32_16x16x32_bf16 v[192:195],a[240:243],v[96:99],0
buffer_load_dwordx4 v8,s[4:7],s20 offen offset:1024 lds
v_mfma_f32_16x16x32_bf16 v[240:243],a[240:243],v[100:103],0
v_fma_f32 v84,v84,s36,v18
v_fma_f32 v85,v85,s36,v18
v_mfma_f32_16x16x32_bf16 a[32:35],a[240:243],v[104:107],0
s_waitcnt lgkmcnt(7)
v_fma_f32 v86,v86,s36,v18
v_fma_f32 v87,v87,s36,v18
v_mfma_f32_16x16x32_bf16 v[196:199],a[244:247],v[96:99],0
v_exp_f32 v68,v68
v_mfma_f32_16x16x32_bf16 v[244:247],a[244:247],v[100:103],0
v_exp_f32 v69,v69
v_mfma_f32_16x16x32_bf16 a[36:39],a[244:247],v[104:107],0
s_waitcnt lgkmcnt(3)
v_exp_f32 v70,v70
v_mfma_f32_16x16x32_bf16 v[200:203],a[248:251],v[96:99],0
buffer_load_dwordx4 v9,s[4:7],s20 offen offset:2048 lds
v_mfma_f32_16x16x32_bf16 v[248:251],a[248:251],v[100:103],0
s_add_u32 s20,s20,12288
v_exp_f32 v71,v71
v_mfma_f32_16x16x32_bf16 a[40:43],a[248:251],v[104:107],0
s_waitcnt lgkmcnt(0)
v_exp_f32 v76,v76
v_mfma_f32_16x16x32_bf16 v[204:207],a[252:255],v[96:99],0
v_exp_f32 v77,v77
v_mfma_f32_16x16x32_bf16 v[252:255],a[252:255],v[100:103],0
v_exp_f32 v78,v78
v_mfma_f32_16x16x32_bf16 a[44:47],a[252:255],v[104:107],0
v_exp_f32 v79,v79
v_mfma_f32_16x16x32_bf16 v[32:35],a[192:195],a[96:99],0
v_exp_f32 v80,v80
v_mfma_f32_16x16x32_bf16 v[32:35],a[196:199],a[100:103],v[32:35]
v_exp_f32 v81,v81
v_mfma_f32_16x16x32_bf16 v[32:35],a[200:203],a[104:107],v[32:35]
v_exp_f32 v82,v82
v_mfma_f32_16x16x32_bf16 v[32:35],a[204:207],a[108:111],v[32:35]
v_exp_f32 v83,v83
v_mfma_f32_16x16x32_bf16 v[32:35],a[208:211],a[112:115],v[32:35]
v_exp_f32 v84,v84
v_mfma_f32_16x16x32_bf16 v[32:35],a[212:215],a[116:119],v[32:35]
v_exp_f32 v85,v85
v_mfma_f32_16x16x32_bf16 v[40:43],a[192:195],a[120:123],0
v_exp_f32 v86,v86
v_mfma_f32_16x16x32_bf16 v[40:43],a[196:199],a[124:127],v[40:43]
v_exp_f32 v87,v87
v_mfma_f32_16x16x32_bf16 v[40:43],a[200:203],a[128:131],v[40:43]
v_cvt_pk_bf16_f32 v114,v68,v69
v_cvt_pk_bf16_f32 v115,v70,v71
v_mfma_f32_16x16x32_bf16 v[40:43],a[204:207],a[132:135],v[40:43]
v_cvt_pk_bf16_f32 v118,v76,v77
v_cvt_pk_bf16_f32 v119,v78,v79
v_mfma_f32_16x16x32_bf16 v[128:131],v[24:27],v[112:115],v[128:131]
v_cvt_pk_bf16_f32 v120,v80,v81
v_cvt_pk_bf16_f32 v121,v82,v83
v_mfma_f32_16x16x32_bf16 v[132:135],v[24:27],v[116:119],v[132:135]
v_cvt_pk_bf16_f32 v122,v84,v85
v_cvt_pk_bf16_f32 v123,v86,v87
v_mfma_f32_16x16x32_bf16 v[40:43],a[208:211],a[136:139],v[40:43]
v_fma_f32 v32,v32,s36,v16
v_fma_f32 v33,v33,s36,v16
v_mfma_f32_16x16x32_bf16 v[136:139],v[24:27],v[120:123],v[136:139]
v_fma_f32 v34,v34,s36,v16
v_fma_f32 v35,v35,s36,v16
v_mfma_f32_16x16x32_bf16 v[40:43],a[212:215],a[140:143],v[40:43]
v_exp_f32 v32,v32
v_mfma_f32_16x16x32_bf16 v[48:51],a[192:195],a[144:147],0
v_exp_f32 v33,v33
v_mfma_f32_16x16x32_bf16 v[48:51],a[196:199],a[148:151],v[48:51]
v_exp_f32 v34,v34
v_mfma_f32_16x16x32_bf16 v[48:51],a[200:203],a[152:155],v[48:51]
v_exp_f32 v35,v35
v_mfma_f32_16x16x32_bf16 v[48:51],a[204:207],a[156:159],v[48:51]
v_fma_f32 v40,v40,s36,v17
v_fma_f32 v41,v41,s36,v17
v_mfma_f32_16x16x32_bf16 v[48:51],a[208:211],a[160:163],v[48:51]
v_fma_f32 v42,v42,s36,v17
v_fma_f32 v43,v43,s36,v17
v_mfma_f32_16x16x32_bf16 v[48:51],a[212:215],a[164:167],v[48:51]
v_exp_f32 v40,v40
v_mfma_f32_16x16x32_bf16 v[36:39],a[216:219],a[96:99],0
v_exp_f32 v41,v41
v_mfma_f32_16x16x32_bf16 v[36:39],a[220:223],a[100:103],v[36:39]
v_exp_f32 v42,v42
v_mfma_f32_16x16x32_bf16 v[36:39],a[224:227],a[104:107],v[36:39]
v_exp_f32 v43,v43
v_mfma_f32_16x16x32_bf16 v[36:39],a[228:231],a[108:111],v[36:39]
v_cvt_pk_bf16_f32 v96,v32,v33
v_cvt_pk_bf16_f32 v97,v34,v35
s_waitcnt vmcnt(6)
s_barrier
v_mfma_f32_16x16x32_bf16 v[36:39],a[232:235],a[112:115],v[36:39]
v_cvt_pk_bf16_f32 v100,v40,v41
v_cvt_pk_bf16_f32 v101,v42,v43
v_mfma_f32_16x16x32_bf16 v[36:39],a[236:239],a[116:119],v[36:39]
ds_read_b64_tr_b16 a[240:241],v3 offset:12288
ds_read_b64_tr_b16 a[242:243],v3 offset:18432
v_mfma_f32_16x16x32_bf16 v[44:47],a[216:219],a[120:123],0
v_mfma_f32_16x16x32_bf16 v[44:47],a[220:223],a[124:127],v[44:47]
ds_read_b64_tr_b16 a[244:245],v4 offset:12288
ds_read_b64_tr_b16 a[246:247],v4 offset:18432
v_mfma_f32_16x16x32_bf16 v[44:47],a[224:227],a[128:131],v[44:47]
ds_read_b64_tr_b16 a[248:249],v5 offset:12288
ds_read_b64_tr_b16 a[250:251],v5 offset:18432
v_mfma_f32_16x16x32_bf16 v[44:47],a[228:231],a[132:135],v[44:47]
v_mfma_f32_16x16x32_bf16 v[44:47],a[232:235],a[136:139],v[44:47]
ds_read_b64_tr_b16 a[252:253],v6 offset:12288
ds_read_b64_tr_b16 a[254:255],v6 offset:18432
v_mfma_f32_16x16x32_bf16 v[44:47],a[236:239],a[140:143],v[44:47]
v_mfma_f32_16x16x32_bf16 v[52:55],a[216:219],a[144:147],0
v_mfma_f32_16x16x32_bf16 v[52:55],a[220:223],a[148:151],v[52:55]
v_mfma_f32_16x16x32_bf16 v[52:55],a[224:227],a[152:155],v[52:55]
v_mfma_f32_16x16x32_bf16 v[52:55],a[228:231],a[156:159],v[52:55]
v_mfma_f32_16x16x32_bf16 v[52:55],a[232:235],a[160:163],v[52:55]
v_mfma_f32_16x16x32_bf16 v[52:55],a[236:239],a[164:167],v[52:55]
s_waitcnt lgkmcnt(2)
v_mfma_f32_16x16x32_bf16 v[160:163],a[240:243],v[112:115],v[160:163]
s_add_u32 m0,s23,0
ds_read_b128 a[192:195],v1 offset:0
v_fma_f32 v36,v36,s36,v16
v_mfma_f32_16x16x32_bf16 v[208:211],a[240:243],v[116:119],v[208:211]
buffer_load_dwordx4 v7,s[8:11],s21 offen offset:0 lds
v_mfma_f32_16x16x32_bf16 a[0:3],a[240:243],v[120:123],a[0:3]
ds_read_b64_tr_b16 a[240:241],v3 offset:12416
ds_read_b64_tr_b16 a[242:243],v3 offset:18560
v_mfma_f32_16x16x32_bf16 v[164:167],a[244:247],v[112:115],v[164:167]
ds_read_b128 a[196:199],v2 offset:0
v_fma_f32 v37,v37,s36,v16
v_mfma_f32_16x16x32_bf16 v[212:215],a[244:247],v[116:119],v[212:215]
ds_read_b128 a[200:203],v1 offset:128
v_fma_f32 v38,v38,s36,v16
v_mfma_f32_16x16x32_bf16 a[4:7],a[244:247],v[120:123],a[4:7]
ds_read_b64_tr_b16 a[244:245],v4 offset:12416
ds_read_b64_tr_b16 a[246:247],v4 offset:18560
v_mfma_f32_16x16x32_bf16 v[168:171],a[248:251],v[112:115],v[168:171]
ds_read_b128 a[204:207],v2 offset:128
v_fma_f32 v39,v39,s36,v16
v_mfma_f32_16x16x32_bf16 v[216:219],a[248:251],v[116:119],v[216:219]
buffer_load_dwordx4 v8,s[8:11],s21 offen offset:1024 lds
v_mfma_f32_16x16x32_bf16 a[8:11],a[248:251],v[120:123],a[8:11]
s_waitcnt lgkmcnt(7)
ds_read_b64_tr_b16 a[248:249],v5 offset:12416
ds_read_b64_tr_b16 a[250:251],v5 offset:18560
v_mfma_f32_16x16x32_bf16 v[172:175],a[252:255],v[112:115],v[172:175]
ds_read_b128 a[208:211],v1 offset:256
v_fma_f32 v44,v44,s36,v17
v_mfma_f32_16x16x32_bf16 v[220:223],a[252:255],v[116:119],v[220:223]
ds_read_b128 a[212:215],v2 offset:256
v_fma_f32 v45,v45,s36,v17
v_mfma_f32_16x16x32_bf16 a[12:15],a[252:255],v[120:123],a[12:15]
s_waitcnt lgkmcnt(8)
ds_read_b64_tr_b16 a[252:253],v6 offset:12416
ds_read_b64_tr_b16 a[254:255],v6 offset:18560
v_mfma_f32_16x16x32_bf16 v[176:179],a[240:243],v[112:115],v[176:179]
buffer_load_dwordx4 v9,s[8:11],s21 offen offset:2048 lds
v_mfma_f32_16x16x32_bf16 v[224:227],a[240:243],v[116:119],v[224:227]
s_add_u32 s21,s21,12288
ds_read_b128 a[216:219],v1 offset:6144
v_fma_f32 v46,v46,s36,v17
v_mfma_f32_16x16x32_bf16 a[16:19],a[240:243],v[120:123],a[16:19]
s_add_u32 m0,s22,24576
ds_read_b64_tr_b16 a[240:241],v3 offset:12544
ds_read_b64_tr_b16 a[242:243],v3 offset:18688
s_waitcnt lgkmcnt(9)
v_mfma_f32_16x16x32_bf16 v[180:183],a[244:247],v[112:115],v[180:183]
ds_read_b128 a[220:223],v2 offset:6144
v_fma_f32 v47,v47,s36,v17
v_mfma_f32_16x16x32_bf16 v[228:231],a[244:247],v[116:119],v[228:231]
ds_read_b128 a[224:227],v1 offset:6272
v_fma_f32 v48,v48,s36,v18
v_mfma_f32_16x16x32_bf16 a[20:23],a[244:247],v[120:123],a[20:23]
s_waitcnt lgkmcnt(8)
ds_read_b64_tr_b16 a[244:245],v4 offset:12544
ds_read_b64_tr_b16 a[246:247],v4 offset:18688
v_mfma_f32_16x16x32_bf16 v[184:187],a[248:251],v[112:115],v[184:187]
buffer_load_dwordx4 v7,s[4:7],s20 offen offset:0 lds
v_mfma_f32_16x16x32_bf16 v[232:235],a[248:251],v[116:119],v[232:235]
ds_read_b128 a[228:231],v2 offset:6272
v_fma_f32 v49,v49,s36,v18
v_mfma_f32_16x16x32_bf16 a[24:27],a[248:251],v[120:123],a[24:27]
s_waitcnt lgkmcnt(8)
ds_read_b64_tr_b16 a[248:249],v5 offset:12544
ds_read_b64_tr_b16 a[250:251],v5 offset:18688
v_mfma_f32_16x16x32_bf16 v[188:191],a[252:255],v[112:115],v[188:191]
ds_read_b128 a[232:235],v1 offset:6400
v_fma_f32 v50,v50,s36,v18
v_mfma_f32_16x16x32_bf16 v[236:239],a[252:255],v[116:119],v[236:239]
ds_read_b128 a[236:239],v2 offset:6400
v_fma_f32 v51,v51,s36,v18
v_mfma_f32_16x16x32_bf16 a[28:31],a[252:255],v[120:123],a[28:31]
s_waitcnt lgkmcnt(8)
ds_read_b64_tr_b16 a[252:253],v6 offset:12544
ds_read_b64_tr_b16 a[254:255],v6 offset:18688
v_mfma_f32_16x16x32_bf16 v[192:195],a[240:243],v[112:115],v[192:195]
buffer_load_dwordx4 v8,s[4:7],s20 offen offset:1024 lds
v_mfma_f32_16x16x32_bf16 v[240:243],a[240:243],v[116:119],v[240:243]
v_fma_f32 v52,v52,s36,v18
v_fma_f32 v53,v53,s36,v18
v_mfma_f32_16x16x32_bf16 a[32:35],a[240:243],v[120:123],a[32:35]
s_waitcnt lgkmcnt(7)
v_fma_f32 v54,v54,s36,v18
v_fma_f32 v55,v55,s36,v18
v_mfma_f32_16x16x32_bf16 v[196:199],a[244:247],v[112:115],v[196:199]
v_exp_f32 v36,v36
v_mfma_f32_16x16x32_bf16 v[244:247],a[244:247],v[116:119],v[244:247]
v_exp_f32 v37,v37
v_mfma_f32_16x16x32_bf16 a[36:39],a[244:247],v[120:123],a[36:39]
s_waitcnt lgkmcnt(3)
v_exp_f32 v38,v38
v_mfma_f32_16x16x32_bf16 v[200:203],a[248:251],v[112:115],v[200:203]
buffer_load_dwordx4 v9,s[4:7],s20 offen offset:2048 lds
v_mfma_f32_16x16x32_bf16 v[248:251],a[248:251],v[116:119],v[248:251]
s_add_u32 s20,s20,12288
v_exp_f32 v39,v39
v_mfma_f32_16x16x32_bf16 a[40:43],a[248:251],v[120:123],a[40:43]
s_waitcnt lgkmcnt(0)
v_exp_f32 v44,v44
v_mfma_f32_16x16x32_bf16 v[204:207],a[252:255],v[112:115],v[204:207]
v_exp_f32 v45,v45
v_mfma_f32_16x16x32_bf16 v[252:255],a[252:255],v[116:119],v[252:255]
v_exp_f32 v46,v46
v_mfma_f32_16x16x32_bf16 a[44:47],a[252:255],v[120:123],a[44:47]
v_exp_f32 v47,v47
v_mfma_f32_16x16x32_bf16 v[64:67],a[192:195],a[96:99],0
v_exp_f32 v48,v48
v_mfma_f32_16x16x32_bf16 v[64:67],a[196:199],a[100:103],v[64:67]
v_exp_f32 v49,v49
v_mfma_f32_16x16x32_bf16 v[64:67],a[200:203],a[104:107],v[64:67]
v_exp_f32 v50,v50
v_mfma_f32_16x16x32_bf16 v[64:67],a[204:207],a[108:111],v[64:67]
v_exp_f32 v51,v51
v_mfma_f32_16x16x32_bf16 v[64:67],a[208:211],a[112:115],v[64:67]
v_exp_f32 v52,v52
v_mfma_f32_16x16x32_bf16 v[64:67],a[212:215],a[116:119],v[64:67]
v_exp_f32 v53,v53
v_mfma_f32_16x16x32_bf16 v[72:75],a[192:195],a[120:123],0
v_exp_f32 v54,v54
v_mfma_f32_16x16x32_bf16 v[72:75],a[196:199],a[124:127],v[72:75]
v_exp_f32 v55,v55
v_mfma_f32_16x16x32_bf16 v[72:75],a[200:203],a[128:131],v[72:75]
v_cvt_pk_bf16_f32 v98,v36,v37
v_cvt_pk_bf16_f32 v99,v38,v39
v_mfma_f32_16x16x32_bf16 v[72:75],a[204:207],a[132:135],v[72:75]
v_cvt_pk_bf16_f32 v102,v44,v45
v_cvt_pk_bf16_f32 v103,v46,v47
v_mfma_f32_16x16x32_bf16 v[128:131],v[24:27],v[96:99],v[128:131]
v_cvt_pk_bf16_f32 v104,v48,v49
v_cvt_pk_bf16_f32 v105,v50,v51
v_mfma_f32_16x16x32_bf16 v[132:135],v[24:27],v[100:103],v[132:135]
v_cvt_pk_bf16_f32 v106,v52,v53
v_cvt_pk_bf16_f32 v107,v54,v55
v_mfma_f32_16x16x32_bf16 v[72:75],a[208:211],a[136:139],v[72:75]
v_fma_f32 v64,v64,s36,v16
v_fma_f32 v65,v65,s36,v16
v_mfma_f32_16x16x32_bf16 v[136:139],v[24:27],v[104:107],v[136:139]
v_fma_f32 v66,v66,s36,v16
v_fma_f32 v67,v67,s36,v16
v_mfma_f32_16x16x32_bf16 v[72:75],a[212:215],a[140:143],v[72:75]
v_exp_f32 v64,v64
v_mfma_f32_16x16x32_bf16 v[80:83],a[192:195],a[144:147],0
v_exp_f32 v65,v65
v_mfma_f32_16x16x32_bf16 v[80:83],a[196:199],a[148:151],v[80:83]
v_exp_f32 v66,v66
v_mfma_f32_16x16x32_bf16 v[80:83],a[200:203],a[152:155],v[80:83]
v_exp_f32 v67,v67
v_mfma_f32_16x16x32_bf16 v[80:83],a[204:207],a[156:159],v[80:83]
v_fma_f32 v72,v72,s36,v17
v_fma_f32 v73,v73,s36,v17
v_mfma_f32_16x16x32_bf16 v[80:83],a[208:211],a[160:163],v[80:83]
v_fma_f32 v74,v74,s36,v17
v_fma_f32 v75,v75,s36,v17
v_mfma_f32_16x16x32_bf16 v[80:83],a[212:215],a[164:167],v[80:83]
v_exp_f32 v72,v72
v_mfma_f32_16x16x32_bf16 v[68:71],a[216:219],a[96:99],0
v_exp_f32 v73,v73
v_mfma_f32_16x16x32_bf16 v[68:71],a[220:223],a[100:103],v[68:71]
v_exp_f32 v74,v74
v_mfma_f32_16x16x32_bf16 v[68:71],a[224:227],a[104:107],v[68:71]
v_exp_f32 v75,v75
v_mfma_f32_16x16x32_bf16 v[68:71],a[228:231],a[108:111],v[68:71]
v_cvt_pk_bf16_f32 v112,v64,v65
v_cvt_pk_bf16_f32 v113,v66,v67
s_waitcnt vmcnt(6)
s_barrier
v_mfma_f32_16x16x32_bf16 v[68:71],a[232:235],a[112:115],v[68:71]
v_cvt_pk_bf16_f32 v116,v72,v73
v_cvt_pk_bf16_f32 v117,v74,v75
v_mfma_f32_16x16x32_bf16 v[68:71],a[236:239],a[116:119],v[68:71]
ds_read_b64_tr_b16 a[240:241],v3 offset:24576
ds_read_b64_tr_b16 a[242:243],v3 offset:30720
v_mfma_f32_16x16x32_bf16 v[76:79],a[216:219],a[120:123],0
v_mfma_f32_16x16x32_bf16 v[76:79],a[220:223],a[124:127],v[76:79]
ds_read_b64_tr_b16 a[244:245],v4 offset:24576
ds_read_b64_tr_b16 a[246:247],v4 offset:30720
v_mfma_f32_16x16x32_bf16 v[76:79],a[224:227],a[128:131],v[76:79]
ds_read_b64_tr_b16 a[248:249],v5 offset:24576
ds_read_b64_tr_b16 a[250:251],v5 offset:30720
v_mfma_f32_16x16x32_bf16 v[76:79],a[228:231],a[132:135],v[76:79]
v_mfma_f32_16x16x32_bf16 v[76:79],a[232:235],a[136:139],v[76:79]
ds_read_b64_tr_b16 a[252:253],v6 offset:24576
ds_read_b64_tr_b16 a[254:255],v6 offset:30720
v_mfma_f32_16x16x32_bf16 v[76:79],a[236:239],a[140:143],v[76:79]
v_mfma_f32_16x16x32_bf16 v[84:87],a[216:219],a[144:147],0
v_mfma_f32_16x16x32_bf16 v[84:87],a[220:223],a[148:151],v[84:87]
v_mfma_f32_16x16x32_bf16 v[84:87],a[224:227],a[152:155],v[84:87]
v_mfma_f32_16x16x32_bf16 v[84:87],a[228:231],a[156:159],v[84:87]
v_mfma_f32_16x16x32_bf16 v[84:87],a[232:235],a[160:163],v[84:87]
v_mfma_f32_16x16x32_bf16 v[84:87],a[236:239],a[164:167],v[84:87]
s_mov_b32 s38,0
s_branch L_loop3
L_end4:
s_waitcnt lgkmcnt(4)
v_mfma_f32_16x16x32_bf16 v[160:163],a[240:243],v[96:99],v[160:163]
v_fma_f32 v68,v68,s36,v16
v_fma_f32 v69,v69,s36,v16
v_mfma_f32_16x16x32_bf16 v[208:211],a[240:243],v[100:103],v[208:211]
v_fma_f32 v70,v70,s36,v16
v_fma_f32 v71,v71,s36,v16
v_mfma_f32_16x16x32_bf16 a[0:3],a[240:243],v[104:107],a[0:3]
v_fma_f32 v76,v76,s36,v17
v_fma_f32 v77,v77,s36,v17
v_mfma_f32_16x16x32_bf16 a[48:51],a[240:243],v[108:111],a[48:51]
ds_read_b64_tr_b16 a[240:241],v3 offset:24704
ds_read_b64_tr_b16 a[242:243],v3 offset:30848
v_mfma_f32_16x16x32_bf16 v[164:167],a[244:247],v[96:99],v[164:167]
v_fma_f32 v78,v78,s36,v17
v_fma_f32 v79,v79,s36,v17
v_mfma_f32_16x16x32_bf16 v[212:215],a[244:247],v[100:103],v[212:215]
v_fma_f32 v80,v80,s36,v18
v_fma_f32 v81,v81,s36,v18
v_mfma_f32_16x16x32_bf16 a[4:7],a[244:247],v[104:107],a[4:7]
v_fma_f32 v82,v82,s36,v18
v_fma_f32 v83,v83,s36,v18
v_mfma_f32_16x16x32_bf16 a[52:55],a[244:247],v[108:111],a[52:55]
s_waitcnt lgkmcnt(2)
ds_read_b64_tr_b16 a[244:245],v4 offset:24704
ds_read_b64_tr_b16 a[246:247],v4 offset:30848
v_mfma_f32_16x16x32_bf16 v[168:171],a[248:251],v[96:99],v[168:171]
v_fma_f32 v84,v84,s36,v18
v_fma_f32 v85,v85,s36,v18
v_mfma_f32_16x16x32_bf16 v[216:219],a[248:251],v[100:103],v[216:219]
v_fma_f32 v86,v86,s36,v18
v_fma_f32 v87,v87,s36,v18
v_mfma_f32_16x16x32_bf16 a[8:11],a[248:251],v[104:107],a[8:11]
v_fma_f32 v88,v88,s36,v19
v_fma_f32 v89,v89,s36,v19
v_mfma_f32_16x16x32_bf16 a[56:59],a[248:251],v[108:111],a[56:59]
ds_read_b64_tr_b16 a[248:249],v5 offset:24704
ds_read_b64_tr_b16 a[250:251],v5 offset:30848
v_mfma_f32_16x16x32_bf16 v[172:175],a[252:255],v[96:99],v[172:175]
v_fma_f32 v90,v90,s36,v19
v_fma_f32 v91,v91,s36,v19
v_mfma_f32_16x16x32_bf16 v[220:223],a[252:255],v[100:103],v[220:223]
v_fma_f32 v92,v92,s36,v19
v_fma_f32 v93,v93,s36,v19
v_mfma_f32_16x16x32_bf16 a[12:15],a[252:255],v[104:107],a[12:15]
v_fma_f32 v94,v94,s36,v19
v_fma_f32 v95,v95,s36,v19
v_mfma_f32_16x16x32_bf16 a[60:63],a[252:255],v[108:111],a[60:63]
s_waitcnt lgkmcnt(3)
ds_read_b64_tr_b16 a[252:253],v6 offset:24704
ds_read_b64_tr_b16 a[254:255],v6 offset:30848
v_mfma_f32_16x16x32_bf16 v[176:179],a[240:243],v[96:99],v[176:179]
v_exp_f32 v68,v68
v_mfma_f32_16x16x32_bf16 v[224:227],a[240:243],v[100:103],v[224:227]
v_exp_f32 v69,v69
v_mfma_f32_16x16x32_bf16 a[16:19],a[240:243],v[104:107],a[16:19]
v_exp_f32 v70,v70
v_mfma_f32_16x16x32_bf16 a[64:67],a[240:243],v[108:111],a[64:67]
s_waitcnt lgkmcnt(3)
ds_read_b64_tr_b16 a[240:241],v3 offset:24832
ds_read_b64_tr_b16 a[242:243],v3 offset:30976
v_mfma_f32_16x16x32_bf16 v[180:183],a[244:247],v[96:99],v[180:183]
v_exp_f32 v71,v71
v_mfma_f32_16x16x32_bf16 v[228:231],a[244:247],v[100:103],v[228:231]
v_exp_f32 v76,v76
v_mfma_f32_16x16x32_bf16 a[20:23],a[244:247],v[104:107],a[20:23]
v_exp_f32 v77,v77
v_mfma_f32_16x16x32_bf16 a[68:71],a[244:247],v[108:111],a[68:71]
s_waitcnt lgkmcnt(2)
ds_read_b64_tr_b16 a[244:245],v4 offset:24832
ds_read_b64_tr_b16 a[246:247],v4 offset:30976
v_mfma_f32_16x16x32_bf16 v[184:187],a[248:251],v[96:99],v[184:187]
v_exp_f32 v78,v78
v_mfma_f32_16x16x32_bf16 v[232:235],a[248:251],v[100:103],v[232:235]
v_exp_f32 v79,v79
v_mfma_f32_16x16x32_bf16 a[24:27],a[248:251],v[104:107],a[24:27]
v_exp_f32 v80,v80
v_mfma_f32_16x16x32_bf16 a[72:75],a[248:251],v[108:111],a[72:75]
ds_read_b64_tr_b16 a[248:249],v5 offset:24832
ds_read_b64_tr_b16 a[250:251],v5 offset:30976
v_mfma_f32_16x16x32_bf16 v[188:191],a[252:255],v[96:99],v[188:191]
v_exp_f32 v81,v81
v_mfma_f32_16x16x32_bf16 v[236:239],a[252:255],v[100:103],v[236:239]
v_exp_f32 v82,v82
v_mfma_f32_16x16x32_bf16 a[28:31],a[252:255],v[104:107],a[28:31]
v_exp_f32 v83,v83
v_mfma_f32_16x16x32_bf16 a[76:79],a[252:255],v[108:111],a[76:79]
s_waitcnt lgkmcnt(3)
ds_read_b64_tr_b16 a[252:253],v6 offset:24832
ds_read_b64_tr_b16 a[254:255],v6 offset:30976
v_mfma_f32_16x16x32_bf16 v[192:195],a[240:243],v[96:99],v[192:195]
v_exp_f32 v84,v84
v_mfma_f32_16x16x32_bf16 v[240:243],a[240:243],v[100:103],v[240:243]
v_exp_f32 v85,v85
v_mfma_f32_16x16x32_bf16 a[32:35],a[240:243],v[104:107],a[32:35]
v_exp_f32 v86,v86
v_mfma_f32_16x16x32_bf16 a[80:83],a[240:243],v[108:111],a[80:83]
s_waitcnt lgkmcnt(3)
v_exp_f32 v87,v87
v_mfma_f32_16x16x32_bf16 v[196:199],a[244:247],v[96:99],v[196:199]
v_exp_f32 v88,v88
v_mfma_f32_16x16x32_bf16 v[244:247],a[244:247],v[100:103],v[244:247]
v_exp_f32 v89,v89
v_mfma_f32_16x16x32_bf16 a[36:39],a[244:247],v[104:107],a[36:39]
v_exp_f32 v90,v90
v_mfma_f32_16x16x32_bf16 a[84:87],a[244:247],v[108:111],a[84:87]
s_waitcnt lgkmcnt(1)
v_exp_f32 v91,v91
v_mfma_f32_16x16x32_bf16 v[200:203],a[248:251],v[96:99],v[200:203]
v_exp_f32 v92,v92
v_mfma_f32_16x16x32_bf16 v[248:251],a[248:251],v[100:103],v[248:251]
v_exp_f32 v93,v93
v_mfma_f32_16x16x32_bf16 a[40:43],a[248:251],v[104:107],a[40:43]
v_exp_f32 v94,v94
v_mfma_f32_16x16x32_bf16 a[88:91],a[248:251],v[108:111],a[88:91]
s_waitcnt lgkmcnt(0)
v_exp_f32 v95,v95
v_mfma_f32_16x16x32_bf16 v[204:207],a[252:255],v[96:99],v[204:207]
v_cvt_pk_bf16_f32 v114,v68,v69
v_cvt_pk_bf16_f32 v115,v70,v71
v_mfma_f32_16x16x32_bf16 v[252:255],a[252:255],v[100:103],v[252:255]
v_cvt_pk_bf16_f32 v118,v76,v77
v_cvt_pk_bf16_f32 v119,v78,v79
v_mfma_f32_16x16x32_bf16 v[128:131],v[24:27],v[112:115],v[128:131]
v_cvt_pk_bf16_f32 v120,v80,v81
v_cvt_pk_bf16_f32 v121,v82,v83
v_mfma_f32_16x16x32_bf16 v[132:135],v[24:27],v[116:119],v[132:135]
v_cvt_pk_bf16_f32 v122,v84,v85
v_cvt_pk_bf16_f32 v123,v86,v87
s_waitcnt vmcnt(6)
s_barrier
v_mfma_f32_16x16x32_bf16 v[136:139],v[24:27],v[120:123],v[136:139]
v_cvt_pk_bf16_f32 v124,v88,v89
v_cvt_pk_bf16_f32 v125,v90,v91
v_mfma_f32_16x16x32_bf16 a[44:47],a[252:255],v[104:107],a[44:47]
v_cvt_pk_bf16_f32 v126,v92,v93
v_cvt_pk_bf16_f32 v127,v94,v95
v_mfma_f32_16x16x32_bf16 a[92:95],a[252:255],v[108:111],a[92:95]
ds_read_b64_tr_b16 a[240:241],v3 offset:0
v_mfma_f32_16x16x32_bf16 v[140:143],v[24:27],v[124:127],v[140:143]
ds_read_b64_tr_b16 a[242:243],v3 offset:6144
ds_read_b64_tr_b16 a[244:245],v4 offset:0
ds_read_b64_tr_b16 a[246:247],v4 offset:6144
ds_read_b64_tr_b16 a[248:249],v5 offset:0
ds_read_b64_tr_b16 a[250:251],v5 offset:6144
ds_read_b64_tr_b16 a[252:253],v6 offset:0
ds_read_b64_tr_b16 a[254:255],v6 offset:6144
s_waitcnt lgkmcnt(6)
v_mfma_f32_16x16x32_bf16 v[160:163],a[240:243],v[112:115],v[160:163]
s_waitcnt vmcnt(0)
v_rcp_f32 v144,v128
s_add_u32 s84,s42,0
v_mfma_f32_16x16x32_bf16 v[208:211],a[240:243],v[116:119],v[208:211]
s_add_u32 s85,s42,6144
v_rcp_f32 v150,v140
s_add_u32 s86,s42,12288
v_mfma_f32_16x16x32_bf16 a[0:3],a[240:243],v[120:123],a[0:3]
s_add_u32 s87,s42,18432
v_rcp_f32 v146,v132
v_mfma_f32_16x16x32_bf16 a[48:51],a[240:243],v[124:127],a[48:51]
s_waitcnt lgkmcnt(4)
ds_read_b64_tr_b16 a[240:241],v3 offset:128
ds_read_b64_tr_b16 a[242:243],v3 offset:6272
v_mfma_f32_16x16x32_bf16 v[164:167],a[244:247],v[112:115],v[164:167]
v_rcp_f32 v148,v136
v_mfma_f32_16x16x32_bf16 v[212:215],a[244:247],v[116:119],v[212:215]
v_max3_f32 v30,v128,v132,v136
v_max_f32 v30,v30,v140
v_mfma_f32_16x16x32_bf16 a[4:7],a[244:247],v[120:123],a[4:7]
v_accvgpr_read_b32 v64,a48
v_accvgpr_read_b32 v65,a49
v_mfma_f32_16x16x32_bf16 a[52:55],a[244:247],v[124:127],a[52:55]
ds_read_b64_tr_b16 a[244:245],v4 offset:128
ds_read_b64_tr_b16 a[246:247],v4 offset:6272
v_accvgpr_read_b32 v66,a50
v_accvgpr_read_b32 v67,a51
v_cmp_ngt_f32 vcc,s37,v30
v_pk_mul_f32 v[64:65],v[64:65],v[150:151] op_sel_hi:[1,0]
v_pk_mul_f32 v[160:161],v[160:161],v[144:145] op_sel_hi:[1,0]
v_pk_mul_f32 v[162:163],v[162:163],v[144:145] op_sel_hi:[1,0]
v_pk_mul_f32 v[66:67],v[66:67],v[150:151] op_sel_hi:[1,0]
v_accvgpr_read_b32 v68,a52
v_accvgpr_read_b32 v69,a53
s_waitcnt lgkmcnt(4)
v_mfma_f32_16x16x32_bf16 v[168:171],a[248:251],v[112:115],v[168:171]
s_cmp_lg_u64 vcc,0
v_accvgpr_read_b32 v70,a54
v_accvgpr_read_b32 v71,a55
v_mfma_f32_16x16x32_bf16 v[216:219],a[248:251],v[116:119],v[216:219]
s_cselect_b32 s62,s32,0
v_cvt_pk_bf16_f32 v80,v64,v65
v_cvt_pk_bf16_f32 v82,v160,v161
v_mfma_f32_16x16x32_bf16 a[8:11],a[248:251],v[120:123],a[8:11]
s_or_b32 s31,s31,s62
v_cvt_pk_bf16_f32 v83,v162,v163
v_cvt_pk_bf16_f32 v81,v66,v67
s_lshl_b32 s32,s32,1
ds_write2st64_b64 v12,v[80:81],v[82:83] offset0:36 offset1:0
v_pk_mul_f32 v[68:69],v[68:69],v[150:151] op_sel_hi:[1,0]
v_pk_mul_f32 v[70:71],v[70:71],v[150:151] op_sel_hi:[1,0]
v_pk_mul_f32 v[164:165],v[164:165],v[144:145] op_sel_hi:[1,0]
v_pk_mul_f32 v[166:167],v[166:167],v[144:145] op_sel_hi:[1,0]
v_cvt_pk_bf16_f32 v84,v68,v69
v_cvt_pk_bf16_f32 v85,v70,v71
v_mfma_f32_16x16x32_bf16 a[56:59],a[248:251],v[124:127],a[56:59]
ds_read_b64_tr_b16 a[248:249],v5 offset:128
ds_read_b64_tr_b16 a[250:251],v5 offset:6272
v_mfma_f32_16x16x32_bf16 v[172:175],a[252:255],v[112:115],v[172:175]
v_cvt_pk_bf16_f32 v86,v164,v165
v_cvt_pk_bf16_f32 v87,v166,v167
v_mfma_f32_16x16x32_bf16 v[220:223],a[252:255],v[116:119],v[220:223]
ds_write2st64_b64 v20,v[84:85],v[86:87] offset0:36 offset1:0
v_mfma_f32_16x16x32_bf16 a[12:15],a[252:255],v[120:123],a[12:15]
v_accvgpr_read_b32 v72,a56
v_accvgpr_read_b32 v73,a57
v_accvgpr_read_b32 v74,a58
v_accvgpr_read_b32 v75,a59
v_pk_mul_f32 v[168:169],v[168:169],v[144:145] op_sel_hi:[1,0]
v_pk_mul_f32 v[170:171],v[170:171],v[144:145] op_sel_hi:[1,0]
v_pk_mul_f32 v[72:73],v[72:73],v[150:151] op_sel_hi:[1,0]
v_pk_mul_f32 v[74:75],v[74:75],v[150:151] op_sel_hi:[1,0]
v_cvt_pk_bf16_f32 v90,v168,v169
v_cvt_pk_bf16_f32 v91,v170,v171
v_mfma_f32_16x16x32_bf16 a[60:63],a[252:255],v[124:127],a[60:63]
s_waitcnt lgkmcnt(3)
ds_read_b64_tr_b16 a[252:253],v6 offset:128
ds_read_b64_tr_b16 a[254:255],v6 offset:6272
v_mfma_f32_16x16x32_bf16 v[176:179],a[240:243],v[112:115],v[176:179]
v_cvt_pk_bf16_f32 v88,v72,v73
v_cvt_pk_bf16_f32 v89,v74,v75
v_mfma_f32_16x16x32_bf16 v[224:227],a[240:243],v[116:119],v[224:227]
ds_write2st64_b64 v21,v[88:89],v[90:91] offset0:36 offset1:0
v_mfma_f32_16x16x32_bf16 a[16:19],a[240:243],v[120:123],a[16:19]
v_accvgpr_read_b32 v76,a60
v_accvgpr_read_b32 v77,a61
v_accvgpr_read_b32 v78,a62
v_accvgpr_read_b32 v79,a63
v_pk_mul_f32 v[172:173],v[172:173],v[144:145] op_sel_hi:[1,0]
v_pk_mul_f32 v[174:175],v[174:175],v[144:145] op_sel_hi:[1,0]
v_pk_mul_f32 v[76:77],v[76:77],v[150:151] op_sel_hi:[1,0]
v_pk_mul_f32 v[78:79],v[78:79],v[150:151] op_sel_hi:[1,0]
v_cvt_pk_bf16_f32 v94,v172,v173
v_cvt_pk_bf16_f32 v95,v174,v175
v_mfma_f32_16x16x32_bf16 a[64:67],a[240:243],v[124:127],a[64:67]
ds_read_b64_tr_b16 a[240:241],v3 offset:256
ds_read_b64_tr_b16 a[242:243],v3 offset:6400
v_cvt_pk_bf16_f32 v92,v76,v77
v_cvt_pk_bf16_f32 v93,v78,v79
v_pk_mul_f32 v[208:209],v[208:209],v[146:147] op_sel_hi:[1,0]
v_pk_mul_f32 v[210:211],v[210:211],v[146:147] op_sel_hi:[1,0]
v_pk_mul_f32 v[176:177],v[176:177],v[144:145] op_sel_hi:[1,0]
v_pk_mul_f32 v[178:179],v[178:179],v[144:145] op_sel_hi:[1,0]
v_cvt_pk_bf16_f32 v80,v208,v209
v_cvt_pk_bf16_f32 v81,v210,v211
v_mfma_f32_16x16x32_bf16 v[180:183],a[244:247],v[112:115],v[180:183]
ds_write2st64_b64 v22,v[92:93],v[94:95] offset0:36 offset1:0
v_mfma_f32_16x16x32_bf16 v[228:231],a[244:247],v[116:119],v[228:231]
v_cvt_pk_bf16_f32 v82,v176,v177
v_cvt_pk_bf16_f32 v83,v178,v179
v_mfma_f32_16x16x32_bf16 a[20:23],a[244:247],v[120:123],a[20:23]
v_accvgpr_read_b32 v64,a64
v_accvgpr_read_b32 v65,a65
v_mfma_f32_16x16x32_bf16 a[68:71],a[244:247],v[124:127],a[68:71]
ds_read_b64_tr_b16 a[244:245],v4 offset:256
ds_read_b64_tr_b16 a[246:247],v4 offset:6400
ds_read_b128 v[152:155],v15 offset:18432
v_accvgpr_read_b32 v66,a66
v_accvgpr_read_b32 v67,a67
v_pk_mul_f32 v[212:213],v[212:213],v[146:147] op_sel_hi:[1,0]
v_pk_mul_f32 v[214:215],v[214:215],v[146:147] op_sel_hi:[1,0]
v_pk_mul_f32 v[180:181],v[180:181],v[144:145] op_sel_hi:[1,0]
v_pk_mul_f32 v[182:183],v[182:183],v[144:145] op_sel_hi:[1,0]
v_accvgpr_read_b32 v68,a68
v_accvgpr_read_b32 v69,a69
s_waitcnt lgkmcnt(4)
v_mfma_f32_16x16x32_bf16 v[184:187],a[248:251],v[112:115],v[184:187]
ds_read_b128 v[156:159],v15 offset:21504
v_accvgpr_read_b32 v70,a70
v_mfma_f32_16x16x32_bf16 v[232:235],a[248:251],v[116:119],v[232:235]
ds_read_b128 v[100:103],v15 offset:0
v_accvgpr_read_b32 v71,a71
v_mfma_f32_16x16x32_bf16 a[24:27],a[248:251],v[120:123],a[24:27]
ds_read_b128 v[104:107],v15 offset:3072
v_cvt_pk_bf16_f32 v84,v212,v213
v_mfma_f32_16x16x32_bf16 a[72:75],a[248:251],v[124:127],a[72:75]
ds_read_b64_tr_b16 a[248:249],v5 offset:256
ds_read_b64_tr_b16 a[250:251],v5 offset:6400
ds_write2st64_b64 v12,v[80:81],v[82:83] offset0:12 offset1:2
v_pk_mul_f32 v[216:217],v[216:217],v[146:147] op_sel_hi:[1,0]
v_pk_mul_f32 v[218:219],v[218:219],v[146:147] op_sel_hi:[1,0]
v_pk_mul_f32 v[184:185],v[184:185],v[144:145] op_sel_hi:[1,0]
v_pk_mul_f32 v[186:187],v[186:187],v[144:145] op_sel_hi:[1,0]
v_cvt_pk_bf16_f32 v85,v214,v215
v_cvt_pk_bf16_f32 v86,v180,v181
v_mfma_f32_16x16x32_bf16 v[188:191],a[252:255],v[112:115],v[188:191]
s_waitcnt lgkmcnt(6)
buffer_store_dwordx4 v[152:155],v10,s[16:19],s87 offen offset:0 nt
v_mfma_f32_16x16x32_bf16 v[236:239],a[252:255],v[116:119],v[236:239]
v_cvt_pk_bf16_f32 v87,v182,v183
v_accvgpr_read_b32 v72,a72
v_mfma_f32_16x16x32_bf16 a[28:31],a[252:255],v[120:123],a[28:31]
v_accvgpr_read_b32 v73,a73
v_accvgpr_read_b32 v74,a74
v_mfma_f32_16x16x32_bf16 a[76:79],a[252:255],v[124:127],a[76:79]
ds_read_b64_tr_b16 a[252:253],v6 offset:256
ds_read_b64_tr_b16 a[254:255],v6 offset:6400
ds_write2st64_b64 v20,v[84:85],v[86:87] offset0:12 offset1:2
v_pk_mul_f32 v[220:221],v[220:221],v[146:147] op_sel_hi:[1,0]
v_pk_mul_f32 v[222:223],v[222:223],v[146:147] op_sel_hi:[1,0]
v_pk_mul_f32 v[188:189],v[188:189],v[144:145] op_sel_hi:[1,0]
v_pk_mul_f32 v[190:191],v[190:191],v[144:145] op_sel_hi:[1,0]
v_pk_mul_f32 v[64:65],v[64:65],v[150:151] op_sel_hi:[1,0]
v_pk_mul_f32 v[66:67],v[66:67],v[150:151] op_sel_hi:[1,0]
v_pk_mul_f32 v[224:225],v[224:225],v[146:147] op_sel_hi:[1,0]
v_pk_mul_f32 v[226:227],v[226:227],v[146:147] op_sel_hi:[1,0]
v_pk_mul_f32 v[68:69],v[68:69],v[150:151] op_sel_hi:[1,0]
v_pk_mul_f32 v[70:71],v[70:71],v[150:151] op_sel_hi:[1,0]
v_pk_mul_f32 v[228:229],v[228:229],v[146:147] op_sel_hi:[1,0]
v_pk_mul_f32 v[230:231],v[230:231],v[146:147] op_sel_hi:[1,0]
v_pk_mul_f32 v[72:73],v[72:73],v[150:151] op_sel_hi:[1,0]
v_pk_mul_f32 v[232:233],v[232:233],v[146:147] op_sel_hi:[1,0]
v_pk_mul_f32 v[234:235],v[234:235],v[146:147] op_sel_hi:[1,0]
v_accvgpr_read_b32 v75,a75
v_pk_mul_f32 v[74:75],v[74:75],v[150:151] op_sel_hi:[1,0]
v_cvt_pk_bf16_f32 v88,v216,v217
v_cvt_pk_bf16_f32 v89,v218,v219
v_mfma_f32_16x16x32_bf16 v[192:195],a[240:243],v[112:115],v[192:195]
s_waitcnt lgkmcnt(3)
buffer_store_dwordx4 v[156:159],v10,s[16:19],s87 offen offset:3072 nt
v_mfma_f32_16x16x32_bf16 v[240:243],a[240:243],v[116:119],v[240:243]
v_cvt_pk_bf16_f32 v90,v184,v185
v_cvt_pk_bf16_f32 v91,v186,v187
v_mfma_f32_16x16x32_bf16 a[32:35],a[240:243],v[120:123],a[32:35]
v_cvt_pk_bf16_f32 v92,v220,v221
v_cvt_pk_bf16_f32 v93,v222,v223
v_cvt_pk_bf16_f32 v94,v188,v189
v_cvt_pk_bf16_f32 v95,v190,v191
v_accvgpr_read_b32 v76,a76
v_pk_mul_f32 v[236:237],v[236:237],v[146:147] op_sel_hi:[1,0]
v_pk_mul_f32 v[238:239],v[238:239],v[146:147] op_sel_hi:[1,0]
v_accvgpr_read_b32 v77,a77
v_pk_mul_f32 v[76:77],v[76:77],v[150:151] op_sel_hi:[1,0]
v_accvgpr_read_b32 v78,a78
v_accvgpr_read_b32 v79,a79
v_pk_mul_f32 v[78:79],v[78:79],v[150:151] op_sel_hi:[1,0]
v_cvt_pk_bf16_f32 v80,v64,v65
v_cvt_pk_bf16_f32 v81,v66,v67
v_mfma_f32_16x16x32_bf16 a[80:83],a[240:243],v[124:127],a[80:83]
ds_write2st64_b64 v21,v[88:89],v[90:91] offset0:12 offset1:2
v_mfma_f32_16x16x32_bf16 v[196:199],a[244:247],v[112:115],v[196:199]
v_cvt_pk_bf16_f32 v82,v224,v225
v_cvt_pk_bf16_f32 v83,v226,v227
v_mfma_f32_16x16x32_bf16 v[244:247],a[244:247],v[116:119],v[244:247]
v_cvt_pk_bf16_f32 v84,v68,v69
v_cvt_pk_bf16_f32 v85,v70,v71
v_mfma_f32_16x16x32_bf16 a[36:39],a[244:247],v[120:123],a[36:39]
ds_write2st64_b64 v22,v[92:93],v[94:95] offset0:12 offset1:2
v_pk_mul_f32 v[192:193],v[192:193],v[144:145] op_sel_hi:[1,0]
v_pk_mul_f32 v[194:195],v[194:195],v[144:145] op_sel_hi:[1,0]
v_accvgpr_read_b32 v64,a80
v_accvgpr_read_b32 v65,a81
v_pk_mul_f32 v[64:65],v[64:65],v[150:151] op_sel_hi:[1,0]
v_accvgpr_read_b32 v66,a82
v_accvgpr_read_b32 v67,a83
v_pk_mul_f32 v[66:67],v[66:67],v[150:151] op_sel_hi:[1,0]
v_cvt_pk_bf16_f32 v86,v228,v229
v_cvt_pk_bf16_f32 v87,v230,v231
v_mfma_f32_16x16x32_bf16 a[84:87],a[244:247],v[124:127],a[84:87]
ds_read_b128 v[152:155],v15 offset:6144
buffer_store_dwordx4 v[100:103],v10,s[16:19],s84 offen offset:0 nt
v_mfma_f32_16x16x32_bf16 v[200:203],a[248:251],v[112:115],v[200:203]
v_cvt_pk_bf16_f32 v88,v72,v73
v_cvt_pk_bf16_f32 v89,v74,v75
v_mfma_f32_16x16x32_bf16 v[248:251],a[248:251],v[116:119],v[248:251]
v_cvt_pk_bf16_f32 v90,v232,v233
v_cvt_pk_bf16_f32 v91,v234,v235
v_mfma_f32_16x16x32_bf16 a[40:43],a[248:251],v[120:123],a[40:43]
ds_read_b128 v[156:159],v15 offset:9216
v_cvt_pk_bf16_f32 v92,v76,v77
v_cvt_pk_bf16_f32 v93,v78,v79
v_cvt_pk_bf16_f32 v94,v236,v237
v_cvt_pk_bf16_f32 v95,v238,v239
v_pk_mul_f32 v[196:197],v[196:197],v[144:145] op_sel_hi:[1,0]
v_pk_mul_f32 v[198:199],v[198:199],v[144:145] op_sel_hi:[1,0]
v_accvgpr_read_b32 v68,a84
v_accvgpr_read_b32 v69,a85
v_pk_mul_f32 v[68:69],v[68:69],v[150:151] op_sel_hi:[1,0]
v_accvgpr_read_b32 v70,a86
v_accvgpr_read_b32 v71,a87
v_pk_mul_f32 v[70:71],v[70:71],v[150:151] op_sel_hi:[1,0]
ds_read_b128 v[100:103],v15 offset:1024
buffer_store_dwordx4 v[104:107],v10,s[16:19],s84 offen offset:3072 nt
v_mfma_f32_16x16x32_bf16 a[88:91],a[248:251],v[124:127],a[88:91]
s_waitcnt lgkmcnt(2)
v_mfma_f32_16x16x32_bf16 v[204:207],a[252:255],v[112:115],v[204:207]
v_mfma_f32_16x16x32_bf16 v[252:255],a[252:255],v[116:119],v[252:255]
ds_read_b128 v[104:107],v15 offset:4096
v_mfma_f32_16x16x32_bf16 a[44:47],a[252:255],v[120:123],a[44:47]
ds_write2st64_b64 v12,v[80:81],v[82:83] offset0:36 offset1:14
v_pk_mul_f32 v[200:201],v[200:201],v[144:145] op_sel_hi:[1,0]
v_pk_mul_f32 v[202:203],v[202:203],v[144:145] op_sel_hi:[1,0]
v_cvt_pk_bf16_f32 v80,v64,v65
v_accvgpr_read_b32 v72,a88
v_accvgpr_read_b32 v73,a89
v_pk_mul_f32 v[72:73],v[72:73],v[150:151] op_sel_hi:[1,0]
v_accvgpr_read_b32 v74,a90
v_accvgpr_read_b32 v75,a91
v_pk_mul_f32 v[74:75],v[74:75],v[150:151] op_sel_hi:[1,0]
v_cvt_pk_bf16_f32 v81,v66,v67
v_cvt_pk_bf16_f32 v82,v192,v193
v_mfma_f32_16x16x32_bf16 a[92:95],a[252:255],v[124:127],a[92:95]
ds_write2st64_b64 v20,v[84:85],v[86:87] offset0:36 offset1:14
v_pk_mul_f32 v[204:205],v[204:205],v[144:145] op_sel_hi:[1,0]
v_pk_mul_f32 v[206:207],v[206:207],v[144:145] op_sel_hi:[1,0]
v_pk_mul_f32 v[240:241],v[240:241],v[146:147] op_sel_hi:[1,0]
v_pk_mul_f32 v[242:243],v[242:243],v[146:147] op_sel_hi:[1,0]
v_pk_mul_f32 v[244:245],v[244:245],v[146:147] op_sel_hi:[1,0]
v_pk_mul_f32 v[246:247],v[246:247],v[146:147] op_sel_hi:[1,0]
v_pk_mul_f32 v[248:249],v[248:249],v[146:147] op_sel_hi:[1,0]
v_pk_mul_f32 v[250:251],v[250:251],v[146:147] op_sel_hi:[1,0]
v_pk_mul_f32 v[252:253],v[252:253],v[146:147] op_sel_hi:[1,0]
v_pk_mul_f32 v[254:255],v[254:255],v[146:147] op_sel_hi:[1,0]
v_cvt_pk_bf16_f32 v83,v194,v195
v_accvgpr_read_b32 v76,a92
v_accvgpr_read_b32 v77,a93
v_pk_mul_f32 v[76:77],v[76:77],v[150:151] op_sel_hi:[1,0]
v_accvgpr_read_b32 v78,a94
v_accvgpr_read_b32 v79,a95
v_pk_mul_f32 v[78:79],v[78:79],v[150:151] op_sel_hi:[1,0]
v_cvt_pk_bf16_f32 v84,v68,v69
v_cvt_pk_bf16_f32 v85,v70,v71
v_cvt_pk_bf16_f32 v86,v196,v197
v_cvt_pk_bf16_f32 v87,v198,v199
v_accvgpr_read_b32 v64,a0
v_accvgpr_read_b32 v65,a1
v_pk_mul_f32 v[64:65],v[64:65],v[148:149] op_sel_hi:[1,0]
v_accvgpr_read_b32 v66,a2
v_accvgpr_read_b32 v67,a3
v_pk_mul_f32 v[66:67],v[66:67],v[148:149] op_sel_hi:[1,0]
v_accvgpr_read_b32 v68,a4
v_accvgpr_read_b32 v69,a5
v_pk_mul_f32 v[68:69],v[68:69],v[148:149] op_sel_hi:[1,0]
v_accvgpr_read_b32 v70,a6
v_accvgpr_read_b32 v71,a7
v_pk_mul_f32 v[70:71],v[70:71],v[148:149] op_sel_hi:[1,0]
ds_write2st64_b64 v21,v[88:89],v[90:91] offset0:36 offset1:14
v_cvt_pk_bf16_f32 v88,v72,v73
v_cvt_pk_bf16_f32 v89,v74,v75
v_cvt_pk_bf16_f32 v90,v200,v201
v_cvt_pk_bf16_f32 v91,v202,v203
v_accvgpr_read_b32 v72,a8
v_accvgpr_read_b32 v73,a9
v_pk_mul_f32 v[72:73],v[72:73],v[148:149] op_sel_hi:[1,0]
v_accvgpr_read_b32 v74,a10
v_accvgpr_read_b32 v75,a11
v_pk_mul_f32 v[74:75],v[74:75],v[148:149] op_sel_hi:[1,0]
ds_write2st64_b64 v22,v[92:93],v[94:95] offset0:36 offset1:14
v_cvt_pk_bf16_f32 v92,v76,v77
v_cvt_pk_bf16_f32 v93,v78,v79
v_cvt_pk_bf16_f32 v94,v204,v205
v_cvt_pk_bf16_f32 v95,v206,v207
v_accvgpr_read_b32 v76,a12
v_accvgpr_read_b32 v77,a13
v_pk_mul_f32 v[76:77],v[76:77],v[148:149] op_sel_hi:[1,0]
v_accvgpr_read_b32 v78,a14
v_accvgpr_read_b32 v79,a15
v_pk_mul_f32 v[78:79],v[78:79],v[148:149] op_sel_hi:[1,0]
buffer_store_dwordx4 v[152:155],v10,s[16:19],s85 offen offset:0 nt
s_waitcnt lgkmcnt(1)
buffer_store_dwordx4 v[156:159],v10,s[16:19],s85 offen offset:3072 nt
ds_read_b128 v[152:155],v15 offset:18432
ds_read_b128 v[156:159],v15 offset:21504
buffer_store_dwordx4 v[100:103],v10,s[16:19],s84 offen offset:128 nt
buffer_store_dwordx4 v[104:107],v10,s[16:19],s84 offen offset:3200 nt
ds_read_b128 v[100:103],v15 offset:7168
ds_read_b128 v[104:107],v15 offset:10240
s_waitcnt lgkmcnt(3)
buffer_store_dwordx4 v[152:155],v10,s[16:19],s87 offen offset:128 nt
ds_write2st64_b64 v12,v[80:81],v[82:83] offset0:36 offset1:4
v_cvt_pk_bf16_f32 v80,v240,v241
v_cvt_pk_bf16_f32 v81,v242,v243
v_cvt_pk_bf16_f32 v82,v64,v65
v_cvt_pk_bf16_f32 v83,v66,v67
v_accvgpr_read_b32 v64,a16
v_accvgpr_read_b32 v65,a17
v_pk_mul_f32 v[64:65],v[64:65],v[148:149] op_sel_hi:[1,0]
v_accvgpr_read_b32 v66,a18
v_accvgpr_read_b32 v67,a19
v_pk_mul_f32 v[66:67],v[66:67],v[148:149] op_sel_hi:[1,0]
ds_write2st64_b64 v20,v[84:85],v[86:87] offset0:36 offset1:4
v_cvt_pk_bf16_f32 v84,v244,v245
v_cvt_pk_bf16_f32 v85,v246,v247
v_cvt_pk_bf16_f32 v86,v68,v69
v_cvt_pk_bf16_f32 v87,v70,v71
v_accvgpr_read_b32 v68,a32
v_accvgpr_read_b32 v69,a33
v_pk_mul_f32 v[68:69],v[68:69],v[148:149] op_sel_hi:[1,0]
v_accvgpr_read_b32 v70,a34
v_accvgpr_read_b32 v71,a35
v_pk_mul_f32 v[70:71],v[70:71],v[148:149] op_sel_hi:[1,0]
ds_write2st64_b64 v21,v[88:89],v[90:91] offset0:36 offset1:4
v_cvt_pk_bf16_f32 v88,v248,v249
v_cvt_pk_bf16_f32 v89,v250,v251
v_cvt_pk_bf16_f32 v90,v72,v73
v_cvt_pk_bf16_f32 v91,v74,v75
v_accvgpr_read_b32 v72,a20
v_accvgpr_read_b32 v73,a21
v_pk_mul_f32 v[72:73],v[72:73],v[148:149] op_sel_hi:[1,0]
v_accvgpr_read_b32 v74,a22
v_accvgpr_read_b32 v75,a23
v_pk_mul_f32 v[74:75],v[74:75],v[148:149] op_sel_hi:[1,0]
ds_write2st64_b64 v22,v[92:93],v[94:95] offset0:36 offset1:4
v_cvt_pk_bf16_f32 v92,v252,v253
v_cvt_pk_bf16_f32 v93,v254,v255
v_cvt_pk_bf16_f32 v94,v76,v77
v_cvt_pk_bf16_f32 v95,v78,v79
v_accvgpr_read_b32 v76,a36
v_accvgpr_read_b32 v77,a37
v_pk_mul_f32 v[76:77],v[76:77],v[148:149] op_sel_hi:[1,0]
v_accvgpr_read_b32 v78,a38
v_accvgpr_read_b32 v79,a39
v_pk_mul_f32 v[78:79],v[78:79],v[148:149] op_sel_hi:[1,0]
ds_read_b128 v[152:155],v15 offset:18432
s_waitcnt lgkmcnt(2)
buffer_store_dwordx4 v[156:159],v10,s[16:19],s87 offen offset:3200 nt
buffer_store_dwordx4 v[100:103],v10,s[16:19],s85 offen offset:128 nt
ds_read_b128 v[156:159],v15 offset:21504
ds_read_b128 v[100:103],v15 offset:2048
buffer_store_dwordx4 v[104:107],v10,s[16:19],s85 offen offset:3200 nt
s_waitcnt lgkmcnt(2)
buffer_store_dwordx4 v[152:155],v10,s[16:19],s87 offen offset:256 nt
ds_read_b128 v[104:107],v15 offset:5120
ds_write2st64_b64 v12,v[80:81],v[82:83] offset0:16 offset1:24
v_cvt_pk_bf16_f32 v80,v64,v65
v_cvt_pk_bf16_f32 v81,v66,v67
v_cvt_pk_bf16_f32 v82,v68,v69
v_cvt_pk_bf16_f32 v83,v70,v71
v_accvgpr_read_b32 v64,a24
v_accvgpr_read_b32 v65,a25
v_pk_mul_f32 v[64:65],v[64:65],v[148:149] op_sel_hi:[1,0]
v_accvgpr_read_b32 v66,a26
v_accvgpr_read_b32 v67,a27
v_pk_mul_f32 v[66:67],v[66:67],v[148:149] op_sel_hi:[1,0]
v_accvgpr_read_b32 v68,a40
v_accvgpr_read_b32 v69,a41
v_pk_mul_f32 v[68:69],v[68:69],v[148:149] op_sel_hi:[1,0]
v_accvgpr_read_b32 v70,a42
v_accvgpr_read_b32 v71,a43
v_pk_mul_f32 v[70:71],v[70:71],v[148:149] op_sel_hi:[1,0]
ds_write2st64_b64 v20,v[84:85],v[86:87] offset0:16 offset1:24
v_cvt_pk_bf16_f32 v84,v72,v73
v_cvt_pk_bf16_f32 v85,v74,v75
v_cvt_pk_bf16_f32 v86,v76,v77
v_cvt_pk_bf16_f32 v87,v78,v79
v_accvgpr_read_b32 v72,a28
v_accvgpr_read_b32 v73,a29
v_pk_mul_f32 v[72:73],v[72:73],v[148:149] op_sel_hi:[1,0]
v_accvgpr_read_b32 v74,a30
v_accvgpr_read_b32 v75,a31
v_pk_mul_f32 v[74:75],v[74:75],v[148:149] op_sel_hi:[1,0]
v_accvgpr_read_b32 v76,a44
v_accvgpr_read_b32 v77,a45
v_pk_mul_f32 v[76:77],v[76:77],v[148:149] op_sel_hi:[1,0]
v_accvgpr_read_b32 v78,a46
v_accvgpr_read_b32 v79,a47
v_pk_mul_f32 v[78:79],v[78:79],v[148:149] op_sel_hi:[1,0]
ds_write2st64_b64 v21,v[88:89],v[90:91] offset0:16 offset1:24
v_cvt_pk_bf16_f32 v88,v64,v65
v_cvt_pk_bf16_f32 v89,v66,v67
v_cvt_pk_bf16_f32 v90,v68,v69
v_cvt_pk_bf16_f32 v91,v70,v71
ds_write2st64_b64 v22,v[92:93],v[94:95] offset0:16 offset1:24
v_cvt_pk_bf16_f32 v92,v72,v73
v_cvt_pk_bf16_f32 v93,v74,v75
v_cvt_pk_bf16_f32 v94,v76,v77
v_cvt_pk_bf16_f32 v95,v78,v79
ds_read_b128 v[152:155],v15 offset:8192
s_waitcnt lgkmcnt(3)
buffer_store_dwordx4 v[156:159],v10,s[16:19],s87 offen offset:3328 nt
buffer_store_dwordx4 v[100:103],v10,s[16:19],s84 offen offset:256 nt
ds_read_b128 v[156:159],v15 offset:11264
ds_read_b128 v[100:103],v15 offset:12288
buffer_store_dwordx4 v[104:107],v10,s[16:19],s84 offen offset:3328 nt
s_waitcnt lgkmcnt(2)
buffer_store_dwordx4 v[152:155],v10,s[16:19],s85 offen offset:256 nt
ds_read_b128 v[104:107],v15 offset:15360
ds_write2st64_b64 v12,v[80:81],v[82:83] offset0:26 offset1:28
ds_write2st64_b64 v20,v[84:85],v[86:87] offset0:26 offset1:28
ds_write2st64_b64 v21,v[88:89],v[90:91] offset0:26 offset1:28
ds_write2st64_b64 v22,v[92:93],v[94:95] offset0:26 offset1:28
ds_read_b128 v[152:155],v15 offset:13312
s_waitcnt lgkmcnt(3)
buffer_store_dwordx4 v[156:159],v10,s[16:19],s85 offen offset:3328 nt
buffer_store_dwordx4 v[100:103],v10,s[16:19],s86 offen offset:0 nt
ds_read_b128 v[156:159],v15 offset:16384
ds_read_b128 v[100:103],v15 offset:14336
buffer_store_dwordx4 v[104:107],v10,s[16:19],s86 offen offset:3072 nt
s_waitcnt lgkmcnt(2)
buffer_store_dwordx4 v[152:155],v10,s[16:19],s86 offen offset:128 nt
ds_read_b128 v[104:107],v15 offset:17408
s_waitcnt lgkmcnt(2)
buffer_store_dwordx4 v[156:159],v10,s[16:19],s86 offen offset:3200 nt
s_waitcnt lgkmcnt(1)
buffer_store_dwordx4 v[100:103],v10,s[16:19],s86 offen offset:256 nt
s_waitcnt lgkmcnt(0)
buffer_store_dwordx4 v[104:107],v10,s[16:19],s86 offen offset:3328 nt
s_branch L_fin
L_end3:
s_waitcnt lgkmcnt(4)
v_mfma_f32_16x16x32_bf16 v[160:163],a[240:243],v[96:99],v[160:163]
v_fma_f32 v68,v68,s36,v16
v_fma_f32 v69,v69,s36,v16
v_mfma_f32_16x16x32_bf16 v[208:211],a[240:243],v[100:103],v[208:211]
v_fma_f32 v70,v70,s36,v16
v_fma_f32 v71,v71,s36,v16
v_mfma_f32_16x16x32_bf16 a[0:3],a[240:243],v[104:107],a[0:3]
ds_read_b64_tr_b16 a[240:241],v3 offset:24704
ds_read_b64_tr_b16 a[242:243],v3 offset:30848
v_mfma_f32_16x16x32_bf16 v[164:167],a[244:247],v[96:99],v[164:167]
v_fma_f32 v76,v76,s36,v17
v_fma_f32 v77,v77,s36,v17
v_mfma_f32_16x16x32_bf16 v[212:215],a[244:247],v[100:103],v[212:215]
v_fma_f32 v78,v78,s36,v17
v_fma_f32 v79,v79,s36,v17
v_mfma_f32_16x16x32_bf16 a[4:7],a[244:247],v[104:107],a[4:7]
s_waitcnt lgkmcnt(2)
ds_read_b64_tr_b16 a[244:245],v4 offset:24704
ds_read_b64_tr_b16 a[246:247],v4 offset:30848
v_mfma_f32_16x16x32_bf16 v[168:171],a[248:251],v[96:99],v[168:171]
v_fma_f32 v80,v80,s36,v18
v_fma_f32 v81,v81,s36,v18
v_mfma_f32_16x16x32_bf16 v[216:219],a[248:251],v[100:103],v[216:219]
v_fma_f32 v82,v82,s36,v18
v_fma_f32 v83,v83,s36,v18
v_mfma_f32_16x16x32_bf16 a[8:11],a[248:251],v[104:107],a[8:11]
ds_read_b64_tr_b16 a[248:249],v5 offset:24704
ds_read_b64_tr_b16 a[250:251],v5 offset:30848
v_mfma_f32_16x16x32_bf16 v[172:175],a[252:255],v[96:99],v[172:175]
v_fma_f32 v84,v84,s36,v18
v_fma_f32 v85,v85,s36,v18
v_mfma_f32_16x16x32_bf16 v[220:223],a[252:255],v[100:103],v[220:223]
v_fma_f32 v86,v86,s36,v18
v_fma_f32 v87,v87,s36,v18
v_mfma_f32_16x16x32_bf16 a[12:15],a[252:255],v[104:107],a[12:15]
s_waitcnt lgkmcnt(4)
ds_read_b64_tr_b16 a[252:253],v6 offset:24704
ds_read_b64_tr_b16 a[254:255],v6 offset:30848
v_mfma_f32_16x16x32_bf16 v[176:179],a[240:243],v[96:99],v[176:179]
v_exp_f32 v68,v68
v_mfma_f32_16x16x32_bf16 v[224:227],a[240:243],v[100:103],v[224:227]
v_exp_f32 v69,v69
v_mfma_f32_16x16x32_bf16 a[16:19],a[240:243],v[104:107],a[16:19]
s_waitcnt lgkmcnt(4)
ds_read_b64_tr_b16 a[240:241],v3 offset:24832
ds_read_b64_tr_b16 a[242:243],v3 offset:30976
v_mfma_f32_16x16x32_bf16 v[180:183],a[244:247],v[96:99],v[180:183]
v_exp_f32 v70,v70
v_mfma_f32_16x16x32_bf16 v[228:231],a[244:247],v[100:103],v[228:231]
v_exp_f32 v71,v71
v_mfma_f32_16x16x32_bf16 a[20:23],a[244:247],v[104:107],a[20:23]
s_waitcnt lgkmcnt(4)
ds_read_b64_tr_b16 a[244:245],v4 offset:24832
ds_read_b64_tr_b16 a[246:247],v4 offset:30976
v_mfma_f32_16x16x32_bf16 v[184:187],a[248:251],v[96:99],v[184:187]
v_exp_f32 v76,v76
v_mfma_f32_16x16x32_bf16 v[232:235],a[248:251],v[100:103],v[232:235]
v_exp_f32 v77,v77
v_mfma_f32_16x16x32_bf16 a[24:27],a[248:251],v[104:107],a[24:27]
s_waitcnt lgkmcnt(4)
ds_read_b64_tr_b16 a[248:249],v5 offset:24832
ds_read_b64_tr_b16 a[250:251],v5 offset:30976
v_mfma_f32_16x16x32_bf16 v[188:191],a[252:255],v[96:99],v[188:191]
v_exp_f32 v78,v78
v_mfma_f32_16x16x32_bf16 v[236:239],a[252:255],v[100:103],v[236:239]
v_exp_f32 v79,v79
v_mfma_f32_16x16x32_bf16 a[28:31],a[252:255],v[104:107],a[28:31]
s_waitcnt lgkmcnt(4)
ds_read_b64_tr_b16 a[252:253],v6 offset:24832
ds_read_b64_tr_b16 a[254:255],v6 offset:30976
v_mfma_f32_16x16x32_bf16 v[192:195],a[240:243],v[96:99],v[192:195]
v_exp_f32 v80,v80
v_mfma_f32_16x16x32_bf16 v[240:243],a[240:243],v[100:103],v[240:243]
v_exp_f32 v81,v81
v_mfma_f32_16x16x32_bf16 a[32:35],a[240:243],v[104:107],a[32:35]
s_waitcnt lgkmcnt(4)
v_exp_f32 v82,v82
v_mfma_f32_16x16x32_bf16 v[196:199],a[244:247],v[96:99],v[196:199]
v_exp_f32 v83,v83
v_mfma_f32_16x16x32_bf16 v[244:247],a[244:247],v[100:103],v[244:247]
v_exp_f32 v84,v84
v_mfma_f32_16x16x32_bf16 a[36:39],a[244:247],v[104:107],a[36:39]
s_waitcnt lgkmcnt(2)
v_exp_f32 v85,v85
v_mfma_f32_16x16x32_bf16 v[200:203],a[248:251],v[96:99],v[200:203]
v_exp_f32 v86,v86
v_mfma_f32_16x16x32_bf16 v[248:251],a[248:251],v[100:103],v[248:251]
v_exp_f32 v87,v87
v_mfma_f32_16x16x32_bf16 a[40:43],a[248:251],v[104:107],a[40:43]
s_waitcnt lgkmcnt(0)
v_cvt_pk_bf16_f32 v114,v68,v69
v_cvt_pk_bf16_f32 v115,v70,v71
v_mfma_f32_16x16x32_bf16 v[204:207],a[252:255],v[96:99],v[204:207]
v_cvt_pk_bf16_f32 v118,v76,v77
v_cvt_pk_bf16_f32 v119,v78,v79
v_mfma_f32_16x16x32_bf16 v[128:131],v[24:27],v[112:115],v[128:131]
v_cvt_pk_bf16_f32 v120,v80,v81
v_cvt_pk_bf16_f32 v121,v82,v83
v_mfma_f32_16x16x32_bf16 v[132:135],v[24:27],v[116:119],v[132:135]
v_cvt_pk_bf16_f32 v122,v84,v85
v_cvt_pk_bf16_f32 v123,v86,v87
s_waitcnt vmcnt(6)
s_barrier
v_mfma_f32_16x16x32_bf16 v[136:139],v[24:27],v[120:123],v[136:139]
v_mfma_f32_16x16x32_bf16 v[252:255],a[252:255],v[100:103],v[252:255]
v_mfma_f32_16x16x32_bf16 a[44:47],a[252:255],v[104:107],a[44:47]
ds_read_b64_tr_b16 a[240:241],v3 offset:0
ds_read_b64_tr_b16 a[242:243],v3 offset:6144
ds_read_b64_tr_b16 a[244:245],v4 offset:0
ds_read_b64_tr_b16 a[246:247],v4 offset:6144
ds_read_b64_tr_b16 a[248:249],v5 offset:0
ds_read_b64_tr_b16 a[250:251],v5 offset:6144
ds_read_b64_tr_b16 a[252:253],v6 offset:0
ds_read_b64_tr_b16 a[254:255],v6 offset:6144
s_waitcnt lgkmcnt(6)
v_mfma_f32_16x16x32_bf16 v[160:163],a[240:243],v[112:115],v[160:163]
s_waitcnt vmcnt(0)
v_rcp_f32 v144,v128
s_add_u32 s84,s42,0
v_mfma_f32_16x16x32_bf16 v[208:211],a[240:243],v[116:119],v[208:211]
s_add_u32 s85,s42,6144
v_rcp_f32 v146,v132
s_add_u32 s86,s42,12288
v_mfma_f32_16x16x32_bf16 a[0:3],a[240:243],v[120:123],a[0:3]
s_waitcnt lgkmcnt(4)
ds_read_b64_tr_b16 a[240:241],v3 offset:128
ds_read_b64_tr_b16 a[242:243],v3 offset:6272
v_mfma_f32_16x16x32_bf16 v[164:167],a[244:247],v[112:115],v[164:167]
v_rcp_f32 v148,v136
v_mfma_f32_16x16x32_bf16 v[212:215],a[244:247],v[116:119],v[212:215]
v_max3_f32 v30,v128,v132,v136
v_cmp_ngt_f32 vcc,s37,v30
v_mfma_f32_16x16x32_bf16 a[4:7],a[244:247],v[120:123],a[4:7]
s_waitcnt lgkmcnt(4)
ds_read_b64_tr_b16 a[244:245],v4 offset:128
ds_read_b64_tr_b16 a[246:247],v4 offset:6272
v_mfma_f32_16x16x32_bf16 v[168:171],a[248:251],v[112:115],v[168:171]
s_cmp_lg_u64 vcc,0
v_accvgpr_read_b32 v64,a0
v_accvgpr_read_b32 v65,a1
v_mfma_f32_16x16x32_bf16 v[216:219],a[248:251],v[116:119],v[216:219]
s_cselect_b32 s62,s32,0
v_accvgpr_read_b32 v66,a2
v_accvgpr_read_b32 v67,a3
v_accvgpr_read_b32 v72,a4
v_accvgpr_read_b32 v73,a5
v_accvgpr_read_b32 v74,a6
v_pk_mul_f32 v[160:161],v[160:161],v[144:145] op_sel_hi:[1,0]
v_pk_mul_f32 v[162:163],v[162:163],v[144:145] op_sel_hi:[1,0]
v_pk_mul_f32 v[208:209],v[208:209],v[146:147] op_sel_hi:[1,0]
v_pk_mul_f32 v[210:211],v[210:211],v[146:147] op_sel_hi:[1,0]
v_cvt_pk_bf16_f32 v80,v160,v161
v_cvt_pk_bf16_f32 v81,v162,v163
v_mfma_f32_16x16x32_bf16 a[8:11],a[248:251],v[120:123],a[8:11]
s_or_b32 s31,s31,s62
ds_read_b64_tr_b16 a[248:249],v5 offset:128
ds_read_b64_tr_b16 a[250:251],v5 offset:6272
v_cvt_pk_bf16_f32 v82,v208,v209
v_cvt_pk_bf16_f32 v83,v210,v211
v_accvgpr_read_b32 v75,a7
v_pk_mul_f32 v[164:165],v[164:165],v[144:145] op_sel_hi:[1,0]
v_pk_mul_f32 v[166:167],v[166:167],v[144:145] op_sel_hi:[1,0]
v_pk_mul_f32 v[212:213],v[212:213],v[146:147] op_sel_hi:[1,0]
v_pk_mul_f32 v[214:215],v[214:215],v[146:147] op_sel_hi:[1,0]
v_cvt_pk_bf16_f32 v84,v164,v165
v_cvt_pk_bf16_f32 v85,v166,v167
s_waitcnt lgkmcnt(4)
v_mfma_f32_16x16x32_bf16 v[172:175],a[252:255],v[112:115],v[172:175]
s_lshl_b32 s32,s32,1
ds_write2st64_b64 v12,v[80:81],v[82:83] offset0:0 offset1:12
v_mfma_f32_16x16x32_bf16 v[220:223],a[252:255],v[116:119],v[220:223]
v_cvt_pk_bf16_f32 v86,v212,v213
v_cvt_pk_bf16_f32 v87,v214,v215
v_pk_mul_f32 v[168:169],v[168:169],v[144:145] op_sel_hi:[1,0]
v_pk_mul_f32 v[170:171],v[170:171],v[144:145] op_sel_hi:[1,0]
v_pk_mul_f32 v[216:217],v[216:217],v[146:147] op_sel_hi:[1,0]
v_pk_mul_f32 v[218:219],v[218:219],v[146:147] op_sel_hi:[1,0]
v_cvt_pk_bf16_f32 v88,v168,v169
v_cvt_pk_bf16_f32 v89,v170,v171
v_mfma_f32_16x16x32_bf16 a[12:15],a[252:255],v[120:123],a[12:15]
ds_read_b64_tr_b16 a[252:253],v6 offset:128
ds_read_b64_tr_b16 a[254:255],v6 offset:6272
v_mfma_f32_16x16x32_bf16 v[176:179],a[240:243],v[112:115],v[176:179]
ds_write2st64_b64 v20,v[84:85],v[86:87] offset0:0 offset1:12
v_mfma_f32_16x16x32_bf16 v[224:227],a[240:243],v[116:119],v[224:227]
v_cvt_pk_bf16_f32 v90,v216,v217
v_cvt_pk_bf16_f32 v91,v218,v219
v_pk_mul_f32 v[172:173],v[172:173],v[144:145] op_sel_hi:[1,0]
v_pk_mul_f32 v[174:175],v[174:175],v[144:145] op_sel_hi:[1,0]
v_pk_mul_f32 v[220:221],v[220:221],v[146:147] op_sel_hi:[1,0]
v_pk_mul_f32 v[222:223],v[222:223],v[146:147] op_sel_hi:[1,0]
v_cvt_pk_bf16_f32 v92,v172,v173
v_cvt_pk_bf16_f32 v93,v174,v175
v_mfma_f32_16x16x32_bf16 a[16:19],a[240:243],v[120:123],a[16:19]
s_waitcnt lgkmcnt(3)
ds_read_b64_tr_b16 a[240:241],v3 offset:256
ds_read_b64_tr_b16 a[242:243],v3 offset:6400
v_mfma_f32_16x16x32_bf16 v[180:183],a[244:247],v[112:115],v[180:183]
ds_write2st64_b64 v21,v[88:89],v[90:91] offset0:0 offset1:12
v_mfma_f32_16x16x32_bf16 v[228:231],a[244:247],v[116:119],v[228:231]
v_cvt_pk_bf16_f32 v94,v220,v221
v_cvt_pk_bf16_f32 v95,v222,v223
v_pk_mul_f32 v[176:177],v[176:177],v[144:145] op_sel_hi:[1,0]
v_pk_mul_f32 v[178:179],v[178:179],v[144:145] op_sel_hi:[1,0]
v_pk_mul_f32 v[224:225],v[224:225],v[146:147] op_sel_hi:[1,0]
v_pk_mul_f32 v[226:227],v[226:227],v[146:147] op_sel_hi:[1,0]
v_cvt_pk_bf16_f32 v80,v176,v177
v_cvt_pk_bf16_f32 v81,v178,v179
v_mfma_f32_16x16x32_bf16 a[20:23],a[244:247],v[120:123],a[20:23]
ds_read_b64_tr_b16 a[244:245],v4 offset:256
ds_read_b64_tr_b16 a[246:247],v4 offset:6400
v_mfma_f32_16x16x32_bf16 v[184:187],a[248:251],v[112:115],v[184:187]
ds_write2st64_b64 v22,v[92:93],v[94:95] offset0:0 offset1:12
v_mfma_f32_16x16x32_bf16 v[232:235],a[248:251],v[116:119],v[232:235]
v_cvt_pk_bf16_f32 v82,v224,v225
v_cvt_pk_bf16_f32 v83,v226,v227
v_accvgpr_read_b32 v68,a16
v_accvgpr_read_b32 v69,a17
v_accvgpr_read_b32 v70,a18
v_pk_mul_f32 v[180:181],v[180:181],v[144:145] op_sel_hi:[1,0]
v_pk_mul_f32 v[182:183],v[182:183],v[144:145] op_sel_hi:[1,0]
v_pk_mul_f32 v[228:229],v[228:229],v[146:147] op_sel_hi:[1,0]
v_pk_mul_f32 v[230:231],v[230:231],v[146:147] op_sel_hi:[1,0]
v_cvt_pk_bf16_f32 v84,v180,v181
v_cvt_pk_bf16_f32 v85,v182,v183
v_mfma_f32_16x16x32_bf16 a[24:27],a[248:251],v[120:123],a[24:27]
s_waitcnt lgkmcnt(3)
ds_read_b64_tr_b16 a[248:249],v5 offset:256
ds_read_b64_tr_b16 a[250:251],v5 offset:6400
v_mfma_f32_16x16x32_bf16 v[188:191],a[252:255],v[112:115],v[188:191]
ds_read_b128 v[152:155],v15 offset:0
v_cvt_pk_bf16_f32 v86,v228,v229
v_mfma_f32_16x16x32_bf16 v[236:239],a[252:255],v[116:119],v[236:239]
ds_read_b128 v[156:159],v15 offset:3072
v_cvt_pk_bf16_f32 v87,v230,v231
v_accvgpr_read_b32 v71,a19
v_accvgpr_read_b32 v76,a20
v_accvgpr_read_b32 v77,a21
v_pk_mul_f32 v[184:185],v[184:185],v[144:145] op_sel_hi:[1,0]
v_pk_mul_f32 v[186:187],v[186:187],v[144:145] op_sel_hi:[1,0]
v_pk_mul_f32 v[232:233],v[232:233],v[146:147] op_sel_hi:[1,0]
v_pk_mul_f32 v[234:235],v[234:235],v[146:147] op_sel_hi:[1,0]
v_cvt_pk_bf16_f32 v88,v184,v185
v_cvt_pk_bf16_f32 v89,v186,v187
v_mfma_f32_16x16x32_bf16 a[28:31],a[252:255],v[120:123],a[28:31]
ds_read_b64_tr_b16 a[252:253],v6 offset:256
ds_read_b64_tr_b16 a[254:255],v6 offset:6400
v_mfma_f32_16x16x32_bf16 v[192:195],a[240:243],v[112:115],v[192:195]
ds_read_b128 v[100:103],v15 offset:6144
v_cvt_pk_bf16_f32 v90,v232,v233
v_mfma_f32_16x16x32_bf16 v[240:243],a[240:243],v[116:119],v[240:243]
ds_read_b128 v[104:107],v15 offset:9216
v_cvt_pk_bf16_f32 v91,v234,v235
v_accvgpr_read_b32 v78,a22
v_accvgpr_read_b32 v79,a23
v_pk_mul_f32 v[188:189],v[188:189],v[144:145] op_sel_hi:[1,0]
v_pk_mul_f32 v[190:191],v[190:191],v[144:145] op_sel_hi:[1,0]
v_pk_mul_f32 v[236:237],v[236:237],v[146:147] op_sel_hi:[1,0]
v_pk_mul_f32 v[238:239],v[238:239],v[146:147] op_sel_hi:[1,0]
v_cvt_pk_bf16_f32 v92,v188,v189
v_cvt_pk_bf16_f32 v93,v190,v191
v_mfma_f32_16x16x32_bf16 a[32:35],a[240:243],v[120:123],a[32:35]
s_waitcnt lgkmcnt(4)
ds_write2st64_b64 v12,v[80:81],v[82:83] offset0:2 offset1:14
v_mfma_f32_16x16x32_bf16 v[196:199],a[244:247],v[112:115],v[196:199]
v_cvt_pk_bf16_f32 v94,v236,v237
v_cvt_pk_bf16_f32 v95,v238,v239
v_mfma_f32_16x16x32_bf16 v[244:247],a[244:247],v[116:119],v[244:247]
ds_write2st64_b64 v20,v[84:85],v[86:87] offset0:2 offset1:14
v_pk_mul_f32 v[192:193],v[192:193],v[144:145] op_sel_hi:[1,0]
v_pk_mul_f32 v[194:195],v[194:195],v[144:145] op_sel_hi:[1,0]
v_pk_mul_f32 v[240:241],v[240:241],v[146:147] op_sel_hi:[1,0]
v_pk_mul_f32 v[242:243],v[242:243],v[146:147] op_sel_hi:[1,0]
v_cvt_pk_bf16_f32 v80,v192,v193
v_cvt_pk_bf16_f32 v81,v194,v195
v_mfma_f32_16x16x32_bf16 a[36:39],a[244:247],v[120:123],a[36:39]
ds_write2st64_b64 v21,v[88:89],v[90:91] offset0:2 offset1:14
v_mfma_f32_16x16x32_bf16 v[200:203],a[248:251],v[112:115],v[200:203]
v_cvt_pk_bf16_f32 v82,v240,v241
v_cvt_pk_bf16_f32 v83,v242,v243
v_mfma_f32_16x16x32_bf16 v[248:251],a[248:251],v[116:119],v[248:251]
ds_write2st64_b64 v22,v[92:93],v[94:95] offset0:2 offset1:14
v_pk_mul_f32 v[196:197],v[196:197],v[144:145] op_sel_hi:[1,0]
v_pk_mul_f32 v[198:199],v[198:199],v[144:145] op_sel_hi:[1,0]
v_pk_mul_f32 v[244:245],v[244:245],v[146:147] op_sel_hi:[1,0]
v_pk_mul_f32 v[246:247],v[246:247],v[146:147] op_sel_hi:[1,0]
v_cvt_pk_bf16_f32 v84,v196,v197
v_cvt_pk_bf16_f32 v85,v198,v199
v_mfma_f32_16x16x32_bf16 a[40:43],a[248:251],v[120:123],a[40:43]
buffer_store_dwordx4 v[152:155],v10,s[16:19],s84 offen offset:0 nt
s_waitcnt lgkmcnt(2)
v_mfma_f32_16x16x32_bf16 v[204:207],a[252:255],v[112:115],v[204:207]
v_cvt_pk_bf16_f32 v86,v244,v245
v_cvt_pk_bf16_f32 v87,v246,v247
v_mfma_f32_16x16x32_bf16 v[252:255],a[252:255],v[116:119],v[252:255]
ds_read_b128 v[152:155],v15 offset:1024
v_pk_mul_f32 v[200:201],v[200:201],v[144:145] op_sel_hi:[1,0]
v_pk_mul_f32 v[202:203],v[202:203],v[144:145] op_sel_hi:[1,0]
v_pk_mul_f32 v[248:249],v[248:249],v[146:147] op_sel_hi:[1,0]
v_pk_mul_f32 v[250:251],v[250:251],v[146:147] op_sel_hi:[1,0]
v_cvt_pk_bf16_f32 v88,v200,v201
v_cvt_pk_bf16_f32 v89,v202,v203
v_mfma_f32_16x16x32_bf16 a[44:47],a[252:255],v[120:123],a[44:47]
buffer_store_dwordx4 v[156:159],v10,s[16:19],s84 offen offset:3072 nt
v_cvt_pk_bf16_f32 v90,v248,v249
v_cvt_pk_bf16_f32 v91,v250,v251
v_pk_mul_f32 v[204:205],v[204:205],v[144:145] op_sel_hi:[1,0]
v_pk_mul_f32 v[206:207],v[206:207],v[144:145] op_sel_hi:[1,0]
v_pk_mul_f32 v[252:253],v[252:253],v[146:147] op_sel_hi:[1,0]
v_pk_mul_f32 v[254:255],v[254:255],v[146:147] op_sel_hi:[1,0]
v_pk_mul_f32 v[64:65],v[64:65],v[148:149] op_sel_hi:[1,0]
v_pk_mul_f32 v[66:67],v[66:67],v[148:149] op_sel_hi:[1,0]
v_pk_mul_f32 v[68:69],v[68:69],v[148:149] op_sel_hi:[1,0]
v_pk_mul_f32 v[70:71],v[70:71],v[148:149] op_sel_hi:[1,0]
v_pk_mul_f32 v[72:73],v[72:73],v[148:149] op_sel_hi:[1,0]
v_pk_mul_f32 v[74:75],v[74:75],v[148:149] op_sel_hi:[1,0]
v_pk_mul_f32 v[76:77],v[76:77],v[148:149] op_sel_hi:[1,0]
v_pk_mul_f32 v[78:79],v[78:79],v[148:149] op_sel_hi:[1,0]
v_cvt_pk_bf16_f32 v92,v204,v205
v_cvt_pk_bf16_f32 v93,v206,v207
v_cvt_pk_bf16_f32 v94,v252,v253
v_cvt_pk_bf16_f32 v95,v254,v255
ds_read_b128 v[156:159],v15 offset:4096
buffer_store_dwordx4 v[100:103],v10,s[16:19],s85 offen offset:0 nt
buffer_store_dwordx4 v[104:107],v10,s[16:19],s85 offen offset:3072 nt
ds_read_b128 v[100:103],v15 offset:7168
ds_read_b128 v[104:107],v15 offset:10240
s_waitcnt lgkmcnt(3)
buffer_store_dwordx4 v[152:155],v10,s[16:19],s84 offen offset:128 nt
ds_write2st64_b64 v12,v[80:81],v[82:83] offset0:4 offset1:16
v_cvt_pk_bf16_f32 v80,v64,v65
v_cvt_pk_bf16_f32 v81,v66,v67
v_cvt_pk_bf16_f32 v82,v68,v69
v_cvt_pk_bf16_f32 v83,v70,v71
v_accvgpr_read_b32 v64,a8
v_accvgpr_read_b32 v65,a9
v_pk_mul_f32 v[64:65],v[64:65],v[148:149] op_sel_hi:[1,0]
v_accvgpr_read_b32 v66,a10
v_accvgpr_read_b32 v67,a11
v_pk_mul_f32 v[66:67],v[66:67],v[148:149] op_sel_hi:[1,0]
v_accvgpr_read_b32 v68,a24
v_accvgpr_read_b32 v69,a25
v_pk_mul_f32 v[68:69],v[68:69],v[148:149] op_sel_hi:[1,0]
v_accvgpr_read_b32 v70,a26
v_accvgpr_read_b32 v71,a27
v_pk_mul_f32 v[70:71],v[70:71],v[148:149] op_sel_hi:[1,0]
ds_write2st64_b64 v20,v[84:85],v[86:87] offset0:4 offset1:16
v_cvt_pk_bf16_f32 v84,v72,v73
v_cvt_pk_bf16_f32 v85,v74,v75
v_cvt_pk_bf16_f32 v86,v76,v77
v_cvt_pk_bf16_f32 v87,v78,v79
v_accvgpr_read_b32 v72,a12
v_accvgpr_read_b32 v73,a13
v_pk_mul_f32 v[72:73],v[72:73],v[148:149] op_sel_hi:[1,0]
v_accvgpr_read_b32 v74,a14
v_accvgpr_read_b32 v75,a15
v_pk_mul_f32 v[74:75],v[74:75],v[148:149] op_sel_hi:[1,0]
v_accvgpr_read_b32 v76,a28
v_accvgpr_read_b32 v77,a29
v_pk_mul_f32 v[76:77],v[76:77],v[148:149] op_sel_hi:[1,0]
v_accvgpr_read_b32 v78,a30
v_accvgpr_read_b32 v79,a31
v_pk_mul_f32 v[78:79],v[78:79],v[148:149] op_sel_hi:[1,0]
ds_write2st64_b64 v21,v[88:89],v[90:91] offset0:4 offset1:16
v_cvt_pk_bf16_f32 v88,v64,v65
v_cvt_pk_bf16_f32 v89,v66,v67
v_cvt_pk_bf16_f32 v90,v68,v69
v_cvt_pk_bf16_f32 v91,v70,v71
v_accvgpr_read_b32 v64,a32
v_accvgpr_read_b32 v65,a33
v_pk_mul_f32 v[64:65],v[64:65],v[148:149] op_sel_hi:[1,0]
v_accvgpr_read_b32 v66,a34
v_accvgpr_read_b32 v67,a35
v_pk_mul_f32 v[66:67],v[66:67],v[148:149] op_sel_hi:[1,0]
v_accvgpr_read_b32 v68,a36
v_accvgpr_read_b32 v69,a37
v_pk_mul_f32 v[68:69],v[68:69],v[148:149] op_sel_hi:[1,0]
v_accvgpr_read_b32 v70,a38
v_accvgpr_read_b32 v71,a39
v_pk_mul_f32 v[70:71],v[70:71],v[148:149] op_sel_hi:[1,0]
ds_write2st64_b64 v22,v[92:93],v[94:95] offset0:4 offset1:16
v_cvt_pk_bf16_f32 v92,v72,v73
v_cvt_pk_bf16_f32 v93,v74,v75
v_cvt_pk_bf16_f32 v94,v76,v77
v_cvt_pk_bf16_f32 v95,v78,v79
v_accvgpr_read_b32 v72,a40
v_accvgpr_read_b32 v73,a41
v_pk_mul_f32 v[72:73],v[72:73],v[148:149] op_sel_hi:[1,0]
v_accvgpr_read_b32 v74,a42
v_accvgpr_read_b32 v75,a43
v_pk_mul_f32 v[74:75],v[74:75],v[148:149] op_sel_hi:[1,0]
v_accvgpr_read_b32 v76,a44
v_accvgpr_read_b32 v77,a45
v_pk_mul_f32 v[76:77],v[76:77],v[148:149] op_sel_hi:[1,0]
v_accvgpr_read_b32 v78,a46
v_accvgpr_read_b32 v79,a47
v_pk_mul_f32 v[78:79],v[78:79],v[148:149] op_sel_hi:[1,0]
ds_read_b128 v[152:155],v15 offset:2048
s_waitcnt lgkmcnt(2)
buffer_store_dwordx4 v[156:159],v10,s[16:19],s84 offen offset:3200 nt
buffer_store_dwordx4 v[100:103],v10,s[16:19],s85 offen offset:128 nt
ds_read_b128 v[156:159],v15 offset:5120
ds_read_b128 v[100:103],v15 offset:8192
buffer_store_dwordx4 v[104:107],v10,s[16:19],s85 offen offset:3200 nt
s_waitcnt lgkmcnt(2)
buffer_store_dwordx4 v[152:155],v10,s[16:19],s84 offen offset:256 nt
ds_read_b128 v[104:107],v15 offset:11264
ds_write2st64_b64 v12,v[80:81],v[82:83] offset0:24 offset1:26
v_cvt_pk_bf16_f32 v80,v64,v65
v_cvt_pk_bf16_f32 v81,v66,v67
ds_write2st64_b64 v20,v[84:85],v[86:87] offset0:24 offset1:26
v_cvt_pk_bf16_f32 v84,v68,v69
v_cvt_pk_bf16_f32 v85,v70,v71
ds_write2st64_b64 v21,v[88:89],v[90:91] offset0:24 offset1:26
v_cvt_pk_bf16_f32 v88,v72,v73
v_cvt_pk_bf16_f32 v89,v74,v75
ds_write2st64_b64 v22,v[92:93],v[94:95] offset0:24 offset1:26
v_cvt_pk_bf16_f32 v92,v76,v77
v_cvt_pk_bf16_f32 v93,v78,v79
ds_read_b128 v[152:155],v15 offset:12288
s_waitcnt lgkmcnt(3)
buffer_store_dwordx4 v[156:159],v10,s[16:19],s84 offen offset:3328 nt
buffer_store_dwordx4 v[100:103],v10,s[16:19],s85 offen offset:256 nt
ds_read_b128 v[156:159],v15 offset:15360
ds_read_b128 v[100:103],v15 offset:13312
buffer_store_dwordx4 v[104:107],v10,s[16:19],s85 offen offset:3328 nt
s_waitcnt lgkmcnt(2)
buffer_store_dwordx4 v[152:155],v10,s[16:19],s86 offen offset:0 nt
ds_read_b128 v[104:107],v15 offset:16384
ds_write_b64 v12,v[80:81] offset:14336
ds_write_b64 v20,v[84:85] offset:14336
ds_write_b64 v21,v[88:89] offset:14336
ds_write_b64 v22,v[92:93] offset:14336
ds_read_b128 v[152:155],v15 offset:14336
s_waitcnt lgkmcnt(6)
buffer_store_dwordx4 v[156:159],v10,s[16:19],s86 offen offset:3072 nt
buffer_store_dwordx4 v[100:103],v10,s[16:19],s86 offen offset:128 nt
ds_read_b128 v[156:159],v15 offset:17408
s_waitcnt lgkmcnt(2)
buffer_store_dwordx4 v[104:107],v10,s[16:19],s86 offen offset:3200 nt
s_waitcnt lgkmcnt(1)
buffer_store_dwordx4 v[152:155],v10,s[16:19],s86 offen offset:256 nt
s_waitcnt lgkmcnt(0)
buffer_store_dwordx4 v[156:159],v10,s[16:19],s86 offen offset:3328 nt
s_branch L_fin
L_fin:
s_waitcnt vmcnt(0)
L_stamped:
s_cmp_lg_u32 s31,0
s_cbranch_scc1 L_fix
L_done:
L_end:
s_endpgm
L_fix:
v_mov_b32 v144,v28
v_mov_b32 v145,v29
s_sub_u32 s62,s24,36864
v_add_u32 v146,s62,v3
v_add_u32 v147,s62,v4
v_add_u32 v148,s62,v5
v_add_u32 v149,s62,v6
v_bfe_u32 v21,v0,4,4
v_mul_u32_u24 v21,384,v21
v_lshrrev_b32 v22,8,v0
v_lshl_add_u32 v23,v22,3,v21
v_lshl_add_u32 v21,v22,4,v21
s_mov_b32 s6,100663296
s_mov_b32 s10,100663296
L_fix_pass:
s_ff1_i32_b32 s50,s31
s_bitset0_b32 s31,s50
s_mul_i32 s56,s50,325632
s_add_u32 s56,s56,s33
s_lshr_b32 s62,s39,s50
s_and_b32 s62,s62,1
s_lshl_b32 s62,s62,1
s_add_u32 s62,s62,s49
s_and_b32 s62,s62,3
s_add_u32 s63,s50,8
s_lshr_b32 s63,s39,s63
s_and_b32 s63,s63,1
s_xor_b32 s62,s62,s63
s_mul_i32 s63,s3,3
s_lshl_b32 s64,s3,2
s_mov_b32 s40,1
s_add_u32 s65,s63,17
s_cmp_eq_u32 s3,0
s_cselect_b32 s65,16,s65
s_cselect_b32 s54,1,0
s_cmp_eq_u32 s62,1
s_cselect_b32 s64,s65,s64
s_cselect_b32 s40,s54,s40
s_add_u32 s65,s63,29
s_cmp_eq_u32 s62,2
s_cselect_b32 s64,s65,s64
s_cselect_b32 s40,0,s40
s_add_u32 s65,s63,41
s_cmp_eq_u32 s62,3
s_cselect_b32 s64,s65,s64
s_cselect_b32 s40,0,s40
s_mul_i32 s64,s64,6144
s_add_u32 s54,s56,s64
s_add_u32 s55,s40,3
s_mov_b32 s51,0
L_fix_tile:
buffer_load_dwordx4 a[96:99],v21,s[12:15],s54 offen offset:0
buffer_load_dwordx4 a[100:103],v21,s[12:15],s54 offen offset:64
buffer_load_dwordx4 a[104:107],v21,s[12:15],s54 offen offset:128
buffer_load_dwordx4 a[108:111],v21,s[12:15],s54 offen offset:192
buffer_load_dwordx4 a[112:115],v21,s[12:15],s54 offen offset:256
buffer_load_dwordx4 a[116:119],v21,s[12:15],s54 offen offset:320
v_mov_b32 v20,0xff800000
s_mul_i32 s53,s50,196608
s_add_u32 s53,s53,s34
s_mov_b32 s52,0
L_fix_max:
s_mov_b32 s63,s53
s_add_u32 m0,s24,0
s_nop 0
buffer_load_dwordx4 v7,s[4:7],s63 offen offset:0 lds
buffer_load_dwordx4 v8,s[4:7],s63 offen offset:1024 lds
buffer_load_dwordx4 v9,s[4:7],s63 offen offset:2048 lds
s_add_u32 s63,s63,3072
s_add_u32 m0,s24,3072
s_nop 0
buffer_load_dwordx4 v7,s[4:7],s63 offen offset:0 lds
buffer_load_dwordx4 v8,s[4:7],s63 offen offset:1024 lds
buffer_load_dwordx4 v9,s[4:7],s63 offen offset:2048 lds
s_add_u32 s63,s63,3072
s_add_u32 m0,s24,6144
s_nop 0
buffer_load_dwordx4 v7,s[4:7],s63 offen offset:0 lds
buffer_load_dwordx4 v8,s[4:7],s63 offen offset:1024 lds
buffer_load_dwordx4 v9,s[4:7],s63 offen offset:2048 lds
s_add_u32 s63,s63,3072
s_add_u32 m0,s24,9216
s_nop 0
buffer_load_dwordx4 v7,s[4:7],s63 offen offset:0 lds
buffer_load_dwordx4 v8,s[4:7],s63 offen offset:1024 lds
buffer_load_dwordx4 v9,s[4:7],s63 offen offset:2048 lds
s_add_u32 s63,s63,3072
s_waitcnt vmcnt(0)
ds_read_b128 a[192:195],v144 offset:0
ds_read_b128 a[196:199],v145 offset:0
ds_read_b128 a[200:203],v144 offset:128
ds_read_b128 a[204:207],v145 offset:128
ds_read_b128 a[208:211],v144 offset:256
ds_read_b128 a[212:215],v145 offset:256
ds_read_b128 a[216:219],v144 offset:6144
ds_read_b128 a[220:223],v145 offset:6144
ds_read_b128 a[224:227],v144 offset:6272
ds_read_b128 a[228:231],v145 offset:6272
ds_read_b128 a[232:235],v144 offset:6400
ds_read_b128 a[236:239],v145 offset:6400
s_waitcnt lgkmcnt(0)
v_mfma_f32_16x16x32_bf16 v[32:35],a[192:195],a[96:99],0
v_mfma_f32_16x16x32_bf16 v[32:35],a[196:199],a[100:103],v[32:35]
v_mfma_f32_16x16x32_bf16 v[32:35],a[200:203],a[104:107],v[32:35]
v_mfma_f32_16x16x32_bf16 v[32:35],a[204:207],a[108:111],v[32:35]
v_mfma_f32_16x16x32_bf16 v[32:35],a[208:211],a[112:115],v[32:35]
v_mfma_f32_16x16x32_bf16 v[32:35],a[212:215],a[116:119],v[32:35]
v_mfma_f32_16x16x32_bf16 v[36:39],a[216:219],a[96:99],0
v_mfma_f32_16x16x32_bf16 v[36:39],a[220:223],a[100:103],v[36:39]
v_mfma_f32_16x16x32_bf16 v[36:39],a[224:227],a[104:107],v[36:39]
v_mfma_f32_16x16x32_bf16 v[36:39],a[228:231],a[108:111],v[36:39]
v_mfma_f32_16x16x32_bf16 v[36:39],a[232:235],a[112:115],v[36:39]
v_mfma_f32_16x16x32_bf16 v[36:39],a[236:239],a[116:119],v[36:39]
s_nop 7
v_max3_f32 v20,v20,v32,v33
v_max3_f32 v20,v20,v34,v35
v_max3_f32 v20,v20,v36,v37
v_max3_f32 v20,v20,v38,v39
s_add_u32 s53,s53,12288
s_add_u32 s52,s52,1
s_cmp_lt_u32 s52,16
s_cbranch_scc1 L_fix_max
v_mov_b32 v30,v20
s_nop 1
v_permlane32_swap_b32 v30,v20
v_max_f32 v20,v20,v30
v_mov_b32 v30,v20
s_nop 1
v_permlane16_swap_b32 v30,v20
v_max_f32 v20,v20,v30
v_mul_f32_e64 v16,-s36,v20
v_mov_b32 v160,0
v_mov_b32 v161,0
v_mov_b32 v162,0
v_mov_b32 v163,0
v_mov_b32 v164,0
v_mov_b32 v165,0
v_mov_b32 v166,0
v_mov_b32 v167,0
v_mov_b32 v168,0
v_mov_b32 v169,0
v_mov_b32 v170,0
v_mov_b32 v171,0
v_mov_b32 v172,0
v_mov_b32 v173,0
v_mov_b32 v174,0
v_mov_b32 v175,0
v_mov_b32 v176,0
v_mov_b32 v177,0
v_mov_b32 v178,0
v_mov_b32 v179,0
v_mov_b32 v180,0
v_mov_b32 v181,0
v_mov_b32 v182,0
v_mov_b32 v183,0
v_mov_b32 v184,0
v_mov_b32 v185,0
v_mov_b32 v186,0
v_mov_b32 v187,0
v_mov_b32 v188,0
v_mov_b32 v189,0
v_mov_b32 v190,0
v_mov_b32 v191,0
v_mov_b32 v192,0
v_mov_b32 v193,0
v_mov_b32 v194,0
v_mov_b32 v195,0
v_mov_b32 v196,0
v_mov_b32 v197,0
v_mov_b32 v198,0
v_mov_b32 v199,0
v_mov_b32 v200,0
v_mov_b32 v201,0
v_mov_b32 v202,0
v_mov_b32 v203,0
v_mov_b32 v204,0
v_mov_b32 v205,0
v_mov_b32 v206,0
v_mov_b32 v207,0
v_mov_b32 v128,0
v_mov_b32 v129,0
v_mov_b32 v130,0
v_mov_b32 v131,0
s_mul_i32 s53,s50,196608
s_add_u32 s53,s53,s34
s_mov_b32 s52,0
L_fix_acc:
s_mov_b32 s63,s53
s_add_u32 m0,s24,0
s_nop 0
buffer_load_dwordx4 v7,s[4:7],s63 offen offset:0 lds
buffer_load_dwordx4 v8,s[4:7],s63 offen offset:1024 lds
buffer_load_dwordx4 v9,s[4:7],s63 offen offset:2048 lds
s_add_u32 s63,s63,3072
s_add_u32 m0,s24,3072
s_nop 0
buffer_load_dwordx4 v7,s[4:7],s63 offen offset:0 lds
buffer_load_dwordx4 v8,s[4:7],s63 offen offset:1024 lds
buffer_load_dwordx4 v9,s[4:7],s63 offen offset:2048 lds
s_add_u32 s63,s63,3072
s_add_u32 m0,s24,6144
s_nop 0
buffer_load_dwordx4 v7,s[4:7],s63 offen offset:0 lds
buffer_load_dwordx4 v8,s[4:7],s63 offen offset:1024 lds
buffer_load_dwordx4 v9,s[4:7],s63 offen offset:2048 lds
s_add_u32 s63,s63,3072
s_add_u32 m0,s24,9216
s_nop 0
buffer_load_dwordx4 v7,s[4:7],s63 offen offset:0 lds
buffer_load_dwordx4 v8,s[4:7],s63 offen offset:1024 lds
buffer_load_dwordx4 v9,s[4:7],s63 offen offset:2048 lds
s_add_u32 s63,s63,3072
s_waitcnt vmcnt(0)
ds_read_b128 a[192:195],v144 offset:0
ds_read_b128 a[196:199],v145 offset:0
ds_read_b128 a[200:203],v144 offset:128
ds_read_b128 a[204:207],v145 offset:128
ds_read_b128 a[208:211],v144 offset:256
ds_read_b128 a[212:215],v145 offset:256
ds_read_b128 a[216:219],v144 offset:6144
ds_read_b128 a[220:223],v145 offset:6144
ds_read_b128 a[224:227],v144 offset:6272
ds_read_b128 a[228:231],v145 offset:6272
ds_read_b128 a[232:235],v144 offset:6400
ds_read_b128 a[236:239],v145 offset:6400
s_waitcnt lgkmcnt(0)
v_mfma_f32_16x16x32_bf16 v[32:35],a[192:195],a[96:99],0
v_mfma_f32_16x16x32_bf16 v[32:35],a[196:199],a[100:103],v[32:35]
v_mfma_f32_16x16x32_bf16 v[32:35],a[200:203],a[104:107],v[32:35]
v_mfma_f32_16x16x32_bf16 v[32:35],a[204:207],a[108:111],v[32:35]
v_mfma_f32_16x16x32_bf16 v[32:35],a[208:211],a[112:115],v[32:35]
v_mfma_f32_16x16x32_bf16 v[32:35],a[212:215],a[116:119],v[32:35]
v_mfma_f32_16x16x32_bf16 v[36:39],a[216:219],a[96:99],0
v_mfma_f32_16x16x32_bf16 v[36:39],a[220:223],a[100:103],v[36:39]
v_mfma_f32_16x16x32_bf16 v[36:39],a[224:227],a[104:107],v[36:39]
v_mfma_f32_16x16x32_bf16 v[36:39],a[228:231],a[108:111],v[36:39]
v_mfma_f32_16x16x32_bf16 v[36:39],a[232:235],a[112:115],v[36:39]
v_mfma_f32_16x16x32_bf16 v[36:39],a[236:239],a[116:119],v[36:39]
s_nop 7
v_fma_f32 v32,v32,s36,v16
v_exp_f32 v32,v32
v_fma_f32 v33,v33,s36,v16
v_exp_f32 v33,v33
s_nop 0
v_cvt_pk_bf16_f32 v96,v32,v33
v_fma_f32 v34,v34,s36,v16
v_exp_f32 v34,v34
v_fma_f32 v35,v35,s36,v16
v_exp_f32 v35,v35
s_nop 0
v_cvt_pk_bf16_f32 v97,v34,v35
v_fma_f32 v36,v36,s36,v16
v_exp_f32 v36,v36
v_fma_f32 v37,v37,s36,v16
v_exp_f32 v37,v37
s_nop 0
v_cvt_pk_bf16_f32 v98,v36,v37
v_fma_f32 v38,v38,s36,v16
v_exp_f32 v38,v38
v_fma_f32 v39,v39,s36,v16
v_exp_f32 v39,v39
s_nop 0
v_cvt_pk_bf16_f32 v99,v38,v39
s_nop 1
v_mfma_f32_16x16x32_bf16 v[128:131],v[24:27],v[96:99],v[128:131]
s_mov_b32 s63,s53
s_add_u32 m0,s24,0
s_nop 0
buffer_load_dwordx4 v7,s[8:11],s63 offen offset:0 lds
buffer_load_dwordx4 v8,s[8:11],s63 offen offset:1024 lds
buffer_load_dwordx4 v9,s[8:11],s63 offen offset:2048 lds
s_add_u32 s63,s63,3072
s_add_u32 m0,s24,3072
s_nop 0
buffer_load_dwordx4 v7,s[8:11],s63 offen offset:0 lds
buffer_load_dwordx4 v8,s[8:11],s63 offen offset:1024 lds
buffer_load_dwordx4 v9,s[8:11],s63 offen offset:2048 lds
s_add_u32 s63,s63,3072
s_add_u32 m0,s24,6144
s_nop 0
buffer_load_dwordx4 v7,s[8:11],s63 offen offset:0 lds
buffer_load_dwordx4 v8,s[8:11],s63 offen offset:1024 lds
buffer_load_dwordx4 v9,s[8:11],s63 offen offset:2048 lds
s_add_u32 s63,s63,3072
s_add_u32 m0,s24,9216
s_nop 0
buffer_load_dwordx4 v7,s[8:11],s63 offen offset:0 lds
buffer_load_dwordx4 v8,s[8:11],s63 offen offset:1024 lds
buffer_load_dwordx4 v9,s[8:11],s63 offen offset:2048 lds
s_add_u32 s63,s63,3072
s_waitcnt vmcnt(0)
ds_read_b64_tr_b16 a[192:193],v146 offset:0
ds_read_b64_tr_b16 a[194:195],v146 offset:6144
ds_read_b64_tr_b16 a[196:197],v147 offset:0
ds_read_b64_tr_b16 a[198:199],v147 offset:6144
ds_read_b64_tr_b16 a[200:201],v148 offset:0
ds_read_b64_tr_b16 a[202:203],v148 offset:6144
ds_read_b64_tr_b16 a[204:205],v149 offset:0
ds_read_b64_tr_b16 a[206:207],v149 offset:6144
ds_read_b64_tr_b16 a[208:209],v146 offset:128
ds_read_b64_tr_b16 a[210:211],v146 offset:6272
ds_read_b64_tr_b16 a[212:213],v147 offset:128
ds_read_b64_tr_b16 a[214:215],v147 offset:6272
ds_read_b64_tr_b16 a[216:217],v148 offset:128
ds_read_b64_tr_b16 a[218:219],v148 offset:6272
ds_read_b64_tr_b16 a[220:221],v149 offset:128
ds_read_b64_tr_b16 a[222:223],v149 offset:6272
ds_read_b64_tr_b16 a[224:225],v146 offset:256
ds_read_b64_tr_b16 a[226:227],v146 offset:6400
ds_read_b64_tr_b16 a[228:229],v147 offset:256
ds_read_b64_tr_b16 a[230:231],v147 offset:6400
ds_read_b64_tr_b16 a[232:233],v148 offset:256
ds_read_b64_tr_b16 a[234:235],v148 offset:6400
ds_read_b64_tr_b16 a[236:237],v149 offset:256
ds_read_b64_tr_b16 a[238:239],v149 offset:6400
s_waitcnt lgkmcnt(0)
v_mfma_f32_16x16x32_bf16 v[160:163],a[192:195],v[96:99],v[160:163]
v_mfma_f32_16x16x32_bf16 v[164:167],a[196:199],v[96:99],v[164:167]
v_mfma_f32_16x16x32_bf16 v[168:171],a[200:203],v[96:99],v[168:171]
v_mfma_f32_16x16x32_bf16 v[172:175],a[204:207],v[96:99],v[172:175]
v_mfma_f32_16x16x32_bf16 v[176:179],a[208:211],v[96:99],v[176:179]
v_mfma_f32_16x16x32_bf16 v[180:183],a[212:215],v[96:99],v[180:183]
v_mfma_f32_16x16x32_bf16 v[184:187],a[216:219],v[96:99],v[184:187]
v_mfma_f32_16x16x32_bf16 v[188:191],a[220:223],v[96:99],v[188:191]
v_mfma_f32_16x16x32_bf16 v[192:195],a[224:227],v[96:99],v[192:195]
v_mfma_f32_16x16x32_bf16 v[196:199],a[228:231],v[96:99],v[196:199]
v_mfma_f32_16x16x32_bf16 v[200:203],a[232:235],v[96:99],v[200:203]
v_mfma_f32_16x16x32_bf16 v[204:207],a[236:239],v[96:99],v[204:207]
s_add_u32 s53,s53,12288
s_add_u32 s52,s52,1
s_cmp_lt_u32 s52,16
s_cbranch_scc1 L_fix_acc
s_nop 7
v_rcp_f32 v30,v128
s_nop 0
v_mul_f32 v160,v160,v30
v_mul_f32 v161,v161,v30
v_mul_f32 v162,v162,v30
v_mul_f32 v163,v163,v30
v_cvt_pk_bf16_f32 v160,v160,v161
v_cvt_pk_bf16_f32 v161,v162,v163
buffer_store_dwordx2 v[160:161],v23,s[16:19],s54 offen offset:0
v_mul_f32 v164,v164,v30
v_mul_f32 v165,v165,v30
v_mul_f32 v166,v166,v30
v_mul_f32 v167,v167,v30
v_cvt_pk_bf16_f32 v164,v164,v165
v_cvt_pk_bf16_f32 v165,v166,v167
buffer_store_dwordx2 v[164:165],v23,s[16:19],s54 offen offset:32
v_mul_f32 v168,v168,v30
v_mul_f32 v169,v169,v30
v_mul_f32 v170,v170,v30
v_mul_f32 v171,v171,v30
v_cvt_pk_bf16_f32 v168,v168,v169
v_cvt_pk_bf16_f32 v169,v170,v171
buffer_store_dwordx2 v[168:169],v23,s[16:19],s54 offen offset:64
v_mul_f32 v172,v172,v30
v_mul_f32 v173,v173,v30
v_mul_f32 v174,v174,v30
v_mul_f32 v175,v175,v30
v_cvt_pk_bf16_f32 v172,v172,v173
v_cvt_pk_bf16_f32 v173,v174,v175
buffer_store_dwordx2 v[172:173],v23,s[16:19],s54 offen offset:96
v_mul_f32 v176,v176,v30
v_mul_f32 v177,v177,v30
v_mul_f32 v178,v178,v30
v_mul_f32 v179,v179,v30
v_cvt_pk_bf16_f32 v176,v176,v177
v_cvt_pk_bf16_f32 v177,v178,v179
buffer_store_dwordx2 v[176:177],v23,s[16:19],s54 offen offset:128
v_mul_f32 v180,v180,v30
v_mul_f32 v181,v181,v30
v_mul_f32 v182,v182,v30
v_mul_f32 v183,v183,v30
v_cvt_pk_bf16_f32 v180,v180,v181
v_cvt_pk_bf16_f32 v181,v182,v183
buffer_store_dwordx2 v[180:181],v23,s[16:19],s54 offen offset:160
v_mul_f32 v184,v184,v30
v_mul_f32 v185,v185,v30
v_mul_f32 v186,v186,v30
v_mul_f32 v187,v187,v30
v_cvt_pk_bf16_f32 v184,v184,v185
v_cvt_pk_bf16_f32 v185,v186,v187
buffer_store_dwordx2 v[184:185],v23,s[16:19],s54 offen offset:192
v_mul_f32 v188,v188,v30
v_mul_f32 v189,v189,v30
v_mul_f32 v190,v190,v30
v_mul_f32 v191,v191,v30
v_cvt_pk_bf16_f32 v188,v188,v189
v_cvt_pk_bf16_f32 v189,v190,v191
buffer_store_dwordx2 v[188:189],v23,s[16:19],s54 offen offset:224
v_mul_f32 v192,v192,v30
v_mul_f32 v193,v193,v30
v_mul_f32 v194,v194,v30
v_mul_f32 v195,v195,v30
v_cvt_pk_bf16_f32 v192,v192,v193
v_cvt_pk_bf16_f32 v193,v194,v195
buffer_store_dwordx2 v[192:193],v23,s[16:19],s54 offen offset:256
v_mul_f32 v196,v196,v30
v_mul_f32 v197,v197,v30
v_mul_f32 v198,v198,v30
v_mul_f32 v199,v199,v30
v_cvt_pk_bf16_f32 v196,v196,v197
v_cvt_pk_bf16_f32 v197,v198,v199
buffer_store_dwordx2 v[196:197],v23,s[16:19],s54 offen offset:288
v_mul_f32 v200,v200,v30
v_mul_f32 v201,v201,v30
v_mul_f32 v202,v202,v30
v_mul_f32 v203,v203,v30
v_cvt_pk_bf16_f32 v200,v200,v201
v_cvt_pk_bf16_f32 v201,v202,v203
buffer_store_dwordx2 v[200:201],v23,s[16:19],s54 offen offset:320
v_mul_f32 v204,v204,v30
v_mul_f32 v205,v205,v30
v_mul_f32 v206,v206,v30
v_mul_f32 v207,v207,v30
v_cvt_pk_bf16_f32 v204,v204,v205
v_cvt_pk_bf16_f32 v205,v206,v207
buffer_store_dwordx2 v[204:205],v23,s[16:19],s54 offen offset:352
s_waitcnt vmcnt(0)
s_add_u32 s54,s54,6144
s_add_u32 s51,s51,1
s_cmp_lt_u32 s51,s55
s_cbranch_scc1 L_fix_tile
s_cmp_lg_u32 s31,0
s_cbranch_scc1 L_fix_pass
s_branch L_done
L_codeend:
.section .rodata,"a"
.p2align 6
.amdhsa_kernel standalone__gqa_softmax__near_ridge_kernel
  .amdhsa_next_free_vgpr 512
  .amdhsa_next_free_sgpr 102
  .amdhsa_accum_offset 256
  .amdhsa_group_segment_fixed_size 0
  .amdhsa_kernarg_size 48
  .amdhsa_user_sgpr_count 2
  .amdhsa_user_sgpr_kernarg_segment_ptr 1
  .amdhsa_system_sgpr_workgroup_id_x 1
.end_amdhsa_kernel
```

```asm
; @launch grid=(256,1,1) block=(256,1,1) lds=163840
.amdgcn_target "amdgcn-amd-amdhsa--gfx950"
.text
.globl standalone__gqa_softmax__near_ridge_kernel
.p2align 8
.type standalone__gqa_softmax__near_ridge_kernel,@function
standalone__gqa_softmax__near_ridge_kernel:
s_cmp_ge_u32 s2,256
s_cbranch_scc1 L_end
s_load_dwordx4 s[84:87],s[0:1],0
s_load_dwordx4 s[88:91],s[0:1],16
v_lshrrev_b32 v30,6,v0
v_and_b32 v0,63,v0
v_readfirstlane_b32 s3,v30
s_getpc_b64 s[92:93]
L_pc:
s_lshr_b32 s62,s2,3
s_mul_i32 s62,s62,3584
v_min_u32 v144,27,v0
v_lshlrev_b32 v144,7,v144
v_add_u32 v144,s62,v144
v_min_u32 v144,L_codeend-L_pc-4,v144
s_cmp_lg_u32 s3,0
s_cbranch_scc1 L_nopre
global_load_dword v128,v144,s[92:93]
L_nopre:
v_lshrrev_b32 v144,3,v0
v_and_b32 v146,7,v0
v_add_u32 v145,0,v144
v_mul_u32_u24 v145,43,v145
v_lshrrev_b32 v145,7,v145
v_and_b32 v145,6,v145
v_xor_b32 v145,v145,v146
v_lshlrev_b32 v145,4,v145
v_lshl_add_u32 v7,v144,7,v145
v_add_u32 v145,8,v144
v_mul_u32_u24 v145,43,v145
v_lshrrev_b32 v145,7,v145
v_and_b32 v145,6,v145
v_xor_b32 v145,v145,v146
v_lshlrev_b32 v145,4,v145
v_lshl_add_u32 v8,v144,7,v145
v_add_u32 v145,16,v144
v_mul_u32_u24 v145,43,v145
v_lshrrev_b32 v145,7,v145
v_and_b32 v145,6,v145
v_xor_b32 v145,v145,v146
v_lshlrev_b32 v145,4,v145
v_lshl_add_u32 v9,v144,7,v145
s_mov_b32 s37,0x5d800000
s_mov_b32 s36,0x3dd53b95
s_mov_b32 s31,0
s_mov_b32 s32,1
s_and_b32 s62,s2,7
s_lshr_b32 s63,s2,3
s_and_b32 s49,s63,3
s_lshr_b32 s43,s63,2
s_lshl_b32 s62,s62,3
s_add_u32 s62,s62,s43
s_lshl_b32 s64,s62,3
s_mul_i32 s34,s64,196608
s_mul_i32 s33,s64,325632
s_mov_b32 s48,s33
s_and_b32 s63,s49,0
s_lshl_b32 s63,s63,1
s_xor_b32 s63,s63,s3
s_mul_i32 s22,s63,3072
s_mul_i32 s30,s63,22528
s_add_u32 s30,s30,92160
s_add_u32 s23,s22,36864
s_mul_i32 s24,s3,22528
s_add_u32 s24,s24,73728
s_add_u32 s20,s34,s22
s_add_u32 s21,s20,0
s_mov_b32 s69,0
s_mov_b32 s62,0xaac3d274
s_mov_b32 s63,0xac39aac3
s_cmp_ge_u32 s43,4
s_cselect_b32 s62,0xd4b2b2d4,s62
s_cselect_b32 s63,0xd274b4d1,s63
s_and_b32 s64,s43,3
s_lshl_b32 s64,s64,4
s_lshr_b64 s[62:63],s[62:63],s64
s_and_b32 s39,s62,0xffff
s_lshr_b32 s62,s39,s69
s_and_b32 s62,s62,1
s_lshl_b32 s62,s62,1
s_add_u32 s62,s62,s49
s_and_b32 s62,s62,3
s_add_u32 s63,s69,8
s_lshr_b32 s63,s39,s63
s_and_b32 s63,s63,1
s_xor_b32 s62,s62,s63
s_mul_i32 s63,s3,3
s_lshl_b32 s64,s3,2
s_mov_b32 s40,1
s_add_u32 s65,s63,17
s_cmp_eq_u32 s3,0
s_cselect_b32 s65,16,s65
s_cselect_b32 s41,1,0
s_cmp_eq_u32 s62,1
s_cselect_b32 s64,s65,s64
s_cselect_b32 s40,s41,s40
s_add_u32 s65,s63,29
s_cmp_eq_u32 s62,2
s_cselect_b32 s64,s65,s64
s_cselect_b32 s40,0,s40
s_add_u32 s65,s63,41
s_cmp_eq_u32 s62,3
s_cselect_b32 s64,s65,s64
s_cselect_b32 s40,0,s40
s_mul_i32 s64,s64,6144
s_add_u32 s41,s48,s64
s_waitcnt lgkmcnt(0)
s_mov_b32 s4,s86
s_and_b32 s5,s87,0xffff
s_mov_b32 s7,0x20000
s_mov_b32 s12,s84
s_and_b32 s13,s85,0xffff
s_mov_b32 s15,0x20000
s_mov_b32 s8,s88
s_and_b32 s9,s89,0xffff
s_mov_b32 s11,0x20000
s_mov_b32 s16,s90
s_and_b32 s17,s91,0xffff
s_mov_b32 s19,0x20000
s_add_u32 s6,s34,1572864
s_mov_b32 s10,s6
s_mov_b32 s14,166723584
s_mov_b32 s18,166723584
s_cmp_eq_u32 s40,0
s_cbranch_scc1 L_start3
L_start4:
s_add_u32 m0,s22,0
s_nop 0
buffer_load_dwordx4 v7,s[4:7],s20 offen offset:0 lds
buffer_load_dwordx4 v8,s[4:7],s20 offen offset:1024 lds
buffer_load_dwordx4 v9,s[4:7],s20 offen offset:2048 lds
s_add_u32 s20,s20,12288
s_mov_b32 s28,s41
s_add_u32 m0,s24,0
s_nop 0
buffer_load_dwordx4 v7,s[12:15],s28 offen offset:0 nt lds
buffer_load_dwordx4 v8,s[12:15],s28 offen offset:1024 nt lds
buffer_load_dwordx4 v9,s[12:15],s28 offen offset:2048 nt lds
s_add_u32 s28,s28,3072
s_add_u32 m0,s24,3072
s_nop 0
buffer_load_dwordx4 v7,s[12:15],s28 offen offset:0 nt lds
buffer_load_dwordx4 v8,s[12:15],s28 offen offset:1024 nt lds
buffer_load_dwordx4 v9,s[12:15],s28 offen offset:2048 nt lds
s_add_u32 s28,s28,3072
s_add_u32 m0,s24,6144
s_nop 0
buffer_load_dwordx4 v7,s[12:15],s28 offen offset:0 nt lds
buffer_load_dwordx4 v8,s[12:15],s28 offen offset:1024 nt lds
buffer_load_dwordx4 v9,s[12:15],s28 offen offset:2048 nt lds
s_add_u32 s28,s28,3072
s_add_u32 m0,s24,9216
s_nop 0
buffer_load_dwordx4 v7,s[12:15],s28 offen offset:0 nt lds
buffer_load_dwordx4 v8,s[12:15],s28 offen offset:1024 nt lds
buffer_load_dwordx4 v9,s[12:15],s28 offen offset:2048 nt lds
s_add_u32 s28,s28,3072
v_and_b32 v144,15,v0
v_lshrrev_b32 v145,4,v0
v_lshrrev_b32 v146,3,v144
v_mul_u32_u24 v1,384,v144
v_and_b32 v147,6,v144
v_xor_b32 v147,v147,v145
v_lshl_add_u32 v1,v147,4,v1
v_xor_b32 v2,64,v1
v_mul_u32_u24 v148,19456,v146
v_add_u32 v148,92160,v148
v_add_u32 v13,v148,v1
v_add_u32 v28,s24,v1
v_add_u32 v14,v148,v2
v_add_u32 v29,s24,v2
v_lshrrev_b32 v144,2,v0
v_mul_u32_u24 v3,384,v144
v_and_b32 v144,6,v144
v_bfe_u32 v147,v0,1,1
v_xor_b32 v144,v144,v147
v_lshl_add_u32 v3,v144,4,v3
v_and_b32 v147,1,v0
v_lshl_add_u32 v3,v147,3,v3
v_add_u32 v3,36864,v3
v_xor_b32 v4,32,v3
v_xor_b32 v5,64,v3
v_xor_b32 v6,96,v3
v_lshrrev_b32 v144,3,v0
v_and_b32 v145,7,v0
v_lshrrev_b32 v147,5,v0
v_xor_b32 v147,v147,v145
v_lshlrev_b32 v12,7,v145
v_lshl_add_u32 v12,v147,4,v12
v_bfe_u32 v146,v0,4,1
v_lshl_add_u32 v12,v146,3,v12
v_bfe_u32 v146,v0,3,1
v_mul_u32_u24 v146,3072,v146
v_add3_u32 v12,v12,v146,s24
v_xor_b32 v20,32,v12
v_xor_b32 v21,64,v12
v_xor_b32 v22,96,v12
v_xor_b32 v146,v145,v144
v_lshlrev_b32 v15,7,v144
v_lshl_add_u32 v15,v146,4,v15
v_add_u32 v15,s24,v15
v_add_u32 v146,0,v144
v_mul_u32_u24 v147,43,v146
v_lshrrev_b32 v147,7,v147
v_mul_u32_u24 v148,3,v147
v_sub_u32 v146,v146,v148
v_lshlrev_b32 v146,10,v146
v_lshl_add_u32 v146,v147,7,v146
v_xor_b32 v147,v147,v145
v_lshl_add_u32 v146,v147,4,v146
v_add_u32 v11,s24,v146
v_add_u32 v146,8,v144
v_mul_u32_u24 v147,43,v146
v_lshrrev_b32 v147,7,v147
v_mul_u32_u24 v148,3,v147
v_sub_u32 v146,v146,v148
v_lshlrev_b32 v146,10,v146
v_lshl_add_u32 v146,v147,7,v146
v_xor_b32 v147,v147,v145
v_lshl_add_u32 v146,v147,4,v146
v_add_u32 v23,s24,v146
v_add_u32 v146,16,v144
v_mul_u32_u24 v147,43,v146
v_lshrrev_b32 v147,7,v147
v_mul_u32_u24 v148,3,v147
v_sub_u32 v146,v146,v148
v_lshlrev_b32 v146,10,v146
v_lshl_add_u32 v146,v147,7,v146
v_xor_b32 v147,v147,v145
v_lshl_add_u32 v146,v147,4,v146
v_add_u32 v31,s24,v146
v_mul_u32_u24 v10,384,v144
v_lshl_add_u32 v10,v145,4,v10
v_mov_b32 v24,0x3f803f80
v_mov_b32 v25,0x3f803f80
v_mov_b32 v26,0x3f803f80
v_mov_b32 v27,0x3f803f80
v_lshlrev_b32 v0,4,v0
s_waitcnt vmcnt(12)
s_barrier
ds_read_b128 a[192:195],v1 offset:0
ds_read_b128 a[196:199],v2 offset:0
ds_read_b128 a[200:203],v1 offset:128
ds_read_b128 a[204:207],v2 offset:128
ds_read_b128 a[208:211],v1 offset:256
ds_read_b128 a[212:215],v2 offset:256
ds_read_b128 a[216:219],v1 offset:6144
ds_read_b128 a[220:223],v2 offset:6144
ds_read_b128 a[224:227],v1 offset:6272
ds_read_b128 a[228:231],v2 offset:6272
ds_read_b128 a[232:235],v1 offset:6400
ds_read_b128 a[236:239],v2 offset:6400
s_waitcnt vmcnt(6)
ds_read_b128 a[96:99],v28 offset:0
ds_read_b128 a[100:103],v29 offset:0
ds_read_b128 a[104:107],v28 offset:128
ds_read_b128 a[108:111],v29 offset:128
ds_read_b128 a[112:115],v28 offset:256
ds_read_b128 a[116:119],v29 offset:256
s_waitcnt lgkmcnt(5)
v_mfma_f32_16x16x32_bf16 v[32:35],a[192:195],a[96:99],0
s_lshl_b32 s64,s22,1
s_waitcnt lgkmcnt(4)
v_mfma_f32_16x16x32_bf16 v[32:35],a[196:199],a[100:103],v[32:35]
s_add_u32 s64,s64,49152
s_add_u32 m0,s24,12288
v_add_u32 v144,s64,v1
s_waitcnt lgkmcnt(3)
v_mfma_f32_16x16x32_bf16 v[32:35],a[200:203],a[104:107],v[32:35]
buffer_load_dwordx4 v7,s[12:15],s28 offen offset:0 nt lds
s_waitcnt lgkmcnt(2)
v_mfma_f32_16x16x32_bf16 v[32:35],a[204:207],a[108:111],v[32:35]
buffer_load_dwordx4 v8,s[12:15],s28 offen offset:1024 nt lds
s_waitcnt lgkmcnt(1)
v_mfma_f32_16x16x32_bf16 v[32:35],a[208:211],a[112:115],v[32:35]
buffer_load_dwordx4 v9,s[12:15],s28 offen offset:2048 nt lds
s_add_u32 s28,s28,3072
s_add_u32 m0,s24,15360
s_waitcnt lgkmcnt(0)
v_mfma_f32_16x16x32_bf16 v[32:35],a[212:215],a[116:119],v[32:35]
buffer_load_dwordx4 v7,s[12:15],s28 offen offset:0 nt lds
v_mfma_f32_16x16x32_bf16 v[36:39],a[216:219],a[96:99],0
buffer_load_dwordx4 v8,s[12:15],s28 offen offset:1024 nt lds
v_mfma_f32_16x16x32_bf16 v[36:39],a[220:223],a[100:103],v[36:39]
buffer_load_dwordx4 v9,s[12:15],s28 offen offset:2048 nt lds
s_add_u32 s28,s28,3072
s_lshl_b32 s65,s22,1
s_add_u32 m0,s65,49152
v_mfma_f32_16x16x32_bf16 v[36:39],a[224:227],a[104:107],v[36:39]
v_add_u32 v145,s64,v2
v_mfma_f32_16x16x32_bf16 v[36:39],a[228:231],a[108:111],v[36:39]
v_mfma_f32_16x16x32_bf16 v[36:39],a[232:235],a[112:115],v[36:39]
v_mfma_f32_16x16x32_bf16 v[36:39],a[236:239],a[116:119],v[36:39]
s_waitcnt vmcnt(6)
ds_read_b128 a[120:123],v28 offset:6144
ds_read_b128 a[124:127],v29 offset:6144
ds_read_b128 a[128:131],v28 offset:6272
ds_read_b128 a[132:135],v29 offset:6272
ds_read_b128 a[136:139],v28 offset:6400
ds_read_b128 a[140:143],v29 offset:6400
s_waitcnt lgkmcnt(5)
v_mfma_f32_16x16x32_bf16 v[40:43],a[192:195],a[120:123],0
buffer_load_dwordx4 v7,s[12:15],s28 offen offset:0 nt lds
s_waitcnt lgkmcnt(4)
v_mfma_f32_16x16x32_bf16 v[40:43],a[196:199],a[124:127],v[40:43]
buffer_load_dwordx4 v8,s[12:15],s28 offen offset:1024 nt lds
s_waitcnt lgkmcnt(3)
v_mfma_f32_16x16x32_bf16 v[40:43],a[200:203],a[128:131],v[40:43]
buffer_load_dwordx4 v9,s[12:15],s28 offen offset:2048 nt lds
s_add_u32 s28,s28,3072
s_add_u32 m0,s65,52224
s_waitcnt lgkmcnt(2)
v_mfma_f32_16x16x32_bf16 v[40:43],a[204:207],a[132:135],v[40:43]
buffer_load_dwordx4 v7,s[12:15],s28 offen offset:0 nt lds
s_waitcnt lgkmcnt(1)
v_mfma_f32_16x16x32_bf16 v[40:43],a[208:211],a[136:139],v[40:43]
buffer_load_dwordx4 v8,s[12:15],s28 offen offset:1024 nt lds
s_waitcnt lgkmcnt(0)
v_mfma_f32_16x16x32_bf16 v[40:43],a[212:215],a[140:143],v[40:43]
buffer_load_dwordx4 v9,s[12:15],s28 offen offset:2048 nt lds
s_add_u32 s28,s28,3072
s_add_u32 m0,s22,12288
v_mfma_f32_16x16x32_bf16 v[44:47],a[216:219],a[120:123],0
v_mfma_f32_16x16x32_bf16 v[44:47],a[220:223],a[124:127],v[44:47]
v_mfma_f32_16x16x32_bf16 v[44:47],a[224:227],a[128:131],v[44:47]
v_mfma_f32_16x16x32_bf16 v[44:47],a[228:231],a[132:135],v[44:47]
v_mfma_f32_16x16x32_bf16 v[44:47],a[232:235],a[136:139],v[44:47]
v_mfma_f32_16x16x32_bf16 v[44:47],a[236:239],a[140:143],v[44:47]
s_waitcnt vmcnt(6)
ds_read_b128 a[144:147],v28 offset:12288
ds_read_b128 a[148:151],v29 offset:12288
ds_read_b128 a[152:155],v28 offset:12416
ds_read_b128 a[156:159],v29 offset:12416
ds_read_b128 a[160:163],v28 offset:12544
ds_read_b128 a[164:167],v29 offset:12544
s_waitcnt lgkmcnt(5)
v_mfma_f32_16x16x32_bf16 v[48:51],a[192:195],a[144:147],0
buffer_load_dwordx4 v7,s[4:7],s20 offen offset:0 lds
s_waitcnt lgkmcnt(4)
v_mfma_f32_16x16x32_bf16 v[48:51],a[196:199],a[148:151],v[48:51]
buffer_load_dwordx4 v8,s[4:7],s20 offen offset:1024 lds
s_waitcnt lgkmcnt(3)
v_mfma_f32_16x16x32_bf16 v[48:51],a[200:203],a[152:155],v[48:51]
buffer_load_dwordx4 v9,s[4:7],s20 offen offset:2048 lds
s_add_u32 s20,s20,12288
s_add_u32 m0,s23,0
s_waitcnt lgkmcnt(2)
v_mfma_f32_16x16x32_bf16 v[48:51],a[204:207],a[156:159],v[48:51]
s_waitcnt lgkmcnt(1)
v_mfma_f32_16x16x32_bf16 v[48:51],a[208:211],a[160:163],v[48:51]
s_waitcnt lgkmcnt(0)
v_mfma_f32_16x16x32_bf16 v[48:51],a[212:215],a[164:167],v[48:51]
v_mfma_f32_16x16x32_bf16 v[52:55],a[216:219],a[144:147],0
v_mfma_f32_16x16x32_bf16 v[52:55],a[220:223],a[148:151],v[52:55]
v_mfma_f32_16x16x32_bf16 v[52:55],a[224:227],a[152:155],v[52:55]
v_mfma_f32_16x16x32_bf16 v[52:55],a[228:231],a[156:159],v[52:55]
v_mfma_f32_16x16x32_bf16 v[52:55],a[232:235],a[160:163],v[52:55]
v_mfma_f32_16x16x32_bf16 v[52:55],a[236:239],a[164:167],v[52:55]
s_waitcnt vmcnt(3)
ds_read_b128 a[168:171],v144 offset:0
ds_read_b128 a[172:175],v145 offset:0
ds_read_b128 a[176:179],v144 offset:128
ds_read_b128 a[180:183],v145 offset:128
ds_read_b128 a[184:187],v144 offset:256
ds_read_b128 a[188:191],v145 offset:256
s_waitcnt lgkmcnt(5)
v_mfma_f32_16x16x32_bf16 v[56:59],a[192:195],a[168:171],0
buffer_load_dwordx4 v7,s[8:11],s21 offen offset:0 lds
s_waitcnt lgkmcnt(4)
v_mfma_f32_16x16x32_bf16 v[56:59],a[196:199],a[172:175],v[56:59]
buffer_load_dwordx4 v8,s[8:11],s21 offen offset:1024 lds
s_waitcnt lgkmcnt(3)
v_mfma_f32_16x16x32_bf16 v[56:59],a[200:203],a[176:179],v[56:59]
buffer_load_dwordx4 v9,s[8:11],s21 offen offset:2048 lds
s_add_u32 s21,s21,12288
s_add_u32 m0,s22,24576
s_waitcnt lgkmcnt(2)
v_mfma_f32_16x16x32_bf16 v[56:59],a[204:207],a[180:183],v[56:59]
buffer_load_dwordx4 v7,s[4:7],s20 offen offset:0 lds
s_waitcnt lgkmcnt(1)
v_mfma_f32_16x16x32_bf16 v[56:59],a[208:211],a[184:187],v[56:59]
buffer_load_dwordx4 v8,s[4:7],s20 offen offset:1024 lds
s_waitcnt lgkmcnt(0)
v_mfma_f32_16x16x32_bf16 v[56:59],a[212:215],a[188:191],v[56:59]
buffer_load_dwordx4 v9,s[4:7],s20 offen offset:2048 lds
s_add_u32 s20,s20,12288
v_mfma_f32_16x16x32_bf16 v[60:63],a[216:219],a[168:171],0
s_mov_b32 s27,166723584
s_mov_b32 s42,s41
s_add_u32 s69,s69,1
v_mfma_f32_16x16x32_bf16 v[60:63],a[220:223],a[172:175],v[60:63]
s_add_u32 s48,s48,325632
s_lshr_b32 s62,s39,s69
s_and_b32 s62,s62,1
v_mfma_f32_16x16x32_bf16 v[60:63],a[224:227],a[176:179],v[60:63]
s_lshl_b32 s62,s62,1
s_add_u32 s62,s62,s49
s_and_b32 s62,s62,3
v_mfma_f32_16x16x32_bf16 v[60:63],a[228:231],a[180:183],v[60:63]
s_add_u32 s63,s69,8
s_lshr_b32 s63,s39,s63
s_and_b32 s63,s63,1
v_mfma_f32_16x16x32_bf16 v[60:63],a[232:235],a[184:187],v[60:63]
s_xor_b32 s62,s62,s63
s_mul_i32 s63,s3,3
s_lshl_b32 s64,s3,2
v_mfma_f32_16x16x32_bf16 v[60:63],a[236:239],a[188:191],v[60:63]
s_waitcnt vmcnt(6)
s_barrier
s_mov_b32 s40,1
s_add_u32 s65,s63,17
s_cmp_eq_u32 s3,0
s_cselect_b32 s65,16,s65
s_cselect_b32 s41,1,0
s_cmp_eq_u32 s62,1
s_cselect_b32 s64,s65,s64
s_cselect_b32 s40,s41,s40
s_add_u32 s65,s63,29
s_cmp_eq_u32 s62,2
s_cselect_b32 s64,s65,s64
s_cselect_b32 s40,0,s40
s_add_u32 s65,s63,41
s_cmp_eq_u32 s62,3
s_cselect_b32 s64,s65,s64
s_cselect_b32 s40,0,s40
s_mul_i32 s64,s64,6144
s_add_u32 s41,s48,s64
s_cmp_ge_u32 s69,8
s_cselect_b32 s41,166723584,s41
s_mov_b32 s28,s41
s_mov_b32 s29,s24
s_add_u32 s25,s22,12288
s_add_u32 s26,s22,24576
ds_read_b128 a[192:195],v1 offset:12288
v_max3_f32 v129,v32,v33,v34
v_max3_f32 v133,v40,v41,v42
v_max3_f32 v137,v48,v49,v50
v_max3_f32 v141,v56,v57,v58
v_max3_f32 v129,v129,v35,v36
v_max3_f32 v133,v133,v43,v44
v_max3_f32 v137,v137,v51,v52
v_max3_f32 v141,v141,v59,v60
v_max3_f32 v129,v129,v37,v38
v_max3_f32 v133,v133,v45,v46
v_max3_f32 v137,v137,v53,v54
v_max3_f32 v141,v141,v61,v62
v_max_f32 v129,v129,v39
v_max_f32 v133,v133,v47
v_max_f32 v137,v137,v55
v_max_f32 v141,v141,v63
v_mov_b32 v130,v129
v_mov_b32 v134,v133
v_mov_b32 v138,v137
v_mov_b32 v142,v141
v_permlane32_swap_b32 v130,v129
v_permlane32_swap_b32 v134,v133
v_permlane32_swap_b32 v138,v137
v_permlane32_swap_b32 v142,v141
v_max_f32 v129,v129,v130
v_max_f32 v133,v133,v134
v_max_f32 v137,v137,v138
v_max_f32 v141,v141,v142
v_mov_b32 v130,v129
v_mov_b32 v134,v133
s_waitcnt lgkmcnt(0)
v_mfma_f32_16x16x32_bf16 v[64:67],a[192:195],a[96:99],0
s_add_u32 m0,s23,12288
ds_read_b128 a[196:199],v2 offset:12288
buffer_load_dwordx4 v7,s[8:11],s21 offen offset:0 lds
ds_read_b128 a[200:203],v1 offset:12416
v_mov_b32 v138,v137
v_mov_b32 v142,v141
v_permlane16_swap_b32 v130,v129
v_permlane16_swap_b32 v134,v133
v_permlane16_swap_b32 v138,v137
v_permlane16_swap_b32 v142,v141
v_max_f32 v129,v129,v130
v_max_f32 v133,v133,v134
v_max_f32 v137,v137,v138
v_max_f32 v141,v141,v142
v_mul_f32_e64 v16,-s36,v129
v_mul_f32_e64 v17,-s36,v133
v_mul_f32_e64 v18,-s36,v137
v_mul_f32_e64 v19,-s36,v141
v_fma_f32 v32,v32,s36,v16
v_fma_f32 v33,v33,s36,v16
v_fma_f32 v34,v34,s36,v16
v_fma_f32 v35,v35,s36,v16
v_fma_f32 v36,v36,s36,v16
v_fma_f32 v37,v37,s36,v16
v_fma_f32 v38,v38,s36,v16
v_fma_f32 v39,v39,s36,v16
v_fma_f32 v40,v40,s36,v17
v_fma_f32 v41,v41,s36,v17
v_fma_f32 v42,v42,s36,v17
v_fma_f32 v43,v43,s36,v17
s_waitcnt lgkmcnt(1)
v_mfma_f32_16x16x32_bf16 v[64:67],a[196:199],a[100:103],v[64:67]
buffer_load_dwordx4 v8,s[8:11],s21 offen offset:1024 lds
s_waitcnt lgkmcnt(0)
v_mfma_f32_16x16x32_bf16 v[64:67],a[200:203],a[104:107],v[64:67]
ds_read_b128 a[204:207],v2 offset:12416
v_fma_f32 v44,v44,s36,v17
v_fma_f32 v45,v45,s36,v17
v_fma_f32 v46,v46,s36,v17
v_fma_f32 v47,v47,s36,v17
v_fma_f32 v48,v48,s36,v18
v_fma_f32 v49,v49,s36,v18
v_fma_f32 v50,v50,s36,v18
v_fma_f32 v51,v51,s36,v18
v_fma_f32 v52,v52,s36,v18
v_fma_f32 v53,v53,s36,v18
v_fma_f32 v54,v54,s36,v18
v_fma_f32 v55,v55,s36,v18
v_fma_f32 v56,v56,s36,v19
v_fma_f32 v57,v57,s36,v19
v_fma_f32 v58,v58,s36,v19
v_fma_f32 v59,v59,s36,v19
v_fma_f32 v60,v60,s36,v19
v_fma_f32 v61,v61,s36,v19
v_fma_f32 v62,v62,s36,v19
v_fma_f32 v63,v63,s36,v19
v_exp_f32 v32,v32
v_exp_f32 v33,v33
v_exp_f32 v34,v34
v_exp_f32 v35,v35
v_exp_f32 v36,v36
v_exp_f32 v37,v37
v_exp_f32 v38,v38
s_waitcnt lgkmcnt(0)
v_mfma_f32_16x16x32_bf16 v[64:67],a[204:207],a[108:111],v[64:67]
buffer_load_dwordx4 v9,s[8:11],s21 offen offset:2048 lds
ds_read_b128 a[208:211],v1 offset:12544
v_exp_f32 v39,v39
v_exp_f32 v40,v40
v_exp_f32 v41,v41
v_exp_f32 v42,v42
v_exp_f32 v43,v43
v_exp_f32 v44,v44
v_exp_f32 v45,v45
v_exp_f32 v46,v46
v_exp_f32 v47,v47
v_exp_f32 v48,v48
v_exp_f32 v49,v49
v_exp_f32 v50,v50
v_exp_f32 v51,v51
v_exp_f32 v52,v52
v_exp_f32 v53,v53
v_exp_f32 v54,v54
v_exp_f32 v55,v55
s_waitcnt lgkmcnt(0)
v_mfma_f32_16x16x32_bf16 v[64:67],a[208:211],a[112:115],v[64:67]
s_add_u32 s21,s21,12288
ds_read_b128 a[212:215],v2 offset:12544
v_exp_f32 v56,v56
v_exp_f32 v57,v57
v_exp_f32 v58,v58
v_exp_f32 v59,v59
v_exp_f32 v60,v60
v_exp_f32 v61,v61
v_exp_f32 v62,v62
v_exp_f32 v63,v63
v_cvt_pk_bf16_f32 v96,v32,v33
v_cvt_pk_bf16_f32 v97,v34,v35
v_cvt_pk_bf16_f32 v98,v36,v37
v_cvt_pk_bf16_f32 v99,v38,v39
v_cvt_pk_bf16_f32 v100,v40,v41
v_cvt_pk_bf16_f32 v101,v42,v43
v_mfma_f32_16x16x32_bf16 v[128:131],v[24:27],v[96:99],0
s_add_u32 m0,s22,0
ds_read_b128 a[216:219],v1 offset:18432
buffer_load_dwordx4 v7,s[4:7],s20 offen offset:0 lds
ds_read_b128 a[220:223],v2 offset:18432
v_cvt_pk_bf16_f32 v102,v44,v45
v_cvt_pk_bf16_f32 v103,v46,v47
v_cvt_pk_bf16_f32 v104,v48,v49
v_cvt_pk_bf16_f32 v105,v50,v51
v_mfma_f32_16x16x32_bf16 v[132:135],v[24:27],v[100:103],0
s_waitcnt lgkmcnt(2)
ds_read_b128 a[224:227],v1 offset:18560
v_cvt_pk_bf16_f32 v106,v52,v53
v_mfma_f32_16x16x32_bf16 v[64:67],a[212:215],a[116:119],v[64:67]
ds_read_b128 a[228:231],v2 offset:18560
v_cvt_pk_bf16_f32 v107,v54,v55
v_mfma_f32_16x16x32_bf16 v[72:75],a[192:195],a[120:123],0
ds_read_b128 a[232:235],v1 offset:18688
v_cvt_pk_bf16_f32 v108,v56,v57
v_mfma_f32_16x16x32_bf16 v[136:139],v[24:27],v[104:107],0
ds_read_b128 a[236:239],v2 offset:18688
buffer_load_dwordx4 v8,s[4:7],s20 offen offset:1024 lds
v_mfma_f32_16x16x32_bf16 v[72:75],a[196:199],a[124:127],v[72:75]
v_cvt_pk_bf16_f32 v109,v58,v59
v_cvt_pk_bf16_f32 v110,v60,v61
v_mfma_f32_16x16x32_bf16 v[72:75],a[200:203],a[128:131],v[72:75]
v_cvt_pk_bf16_f32 v111,v62,v63
v_fma_f32 v64,v64,s36,v16
v_mfma_f32_16x16x32_bf16 v[72:75],a[204:207],a[132:135],v[72:75]
v_fma_f32 v65,v65,s36,v16
v_fma_f32 v66,v66,s36,v16
v_mfma_f32_16x16x32_bf16 v[140:143],v[24:27],v[108:111],0
v_fma_f32 v67,v67,s36,v16
v_exp_f32 v64,v64
v_mfma_f32_16x16x32_bf16 v[72:75],a[208:211],a[136:139],v[72:75]
v_exp_f32 v65,v65
v_mfma_f32_16x16x32_bf16 v[72:75],a[212:215],a[140:143],v[72:75]
v_exp_f32 v66,v66
v_mfma_f32_16x16x32_bf16 v[80:83],a[192:195],a[144:147],0
v_exp_f32 v67,v67
v_mfma_f32_16x16x32_bf16 v[80:83],a[196:199],a[148:151],v[80:83]
v_cvt_pk_bf16_f32 v112,v64,v65
v_cvt_pk_bf16_f32 v113,v66,v67
v_mfma_f32_16x16x32_bf16 v[80:83],a[200:203],a[152:155],v[80:83]
v_mfma_f32_16x16x32_bf16 v[80:83],a[204:207],a[156:159],v[80:83]
v_fma_f32 v72,v72,s36,v17
v_fma_f32 v73,v73,s36,v17
v_mfma_f32_16x16x32_bf16 v[80:83],a[208:211],a[160:163],v[80:83]
v_fma_f32 v74,v74,s36,v17
v_fma_f32 v75,v75,s36,v17
v_mfma_f32_16x16x32_bf16 v[80:83],a[212:215],a[164:167],v[80:83]
v_exp_f32 v72,v72
v_mfma_f32_16x16x32_bf16 v[88:91],a[192:195],a[168:171],0
buffer_load_dwordx4 v9,s[4:7],s20 offen offset:2048 lds
v_mfma_f32_16x16x32_bf16 v[88:91],a[196:199],a[172:175],v[88:91]
s_add_u32 s20,s20,12288
v_exp_f32 v73,v73
v_mfma_f32_16x16x32_bf16 v[88:91],a[200:203],a[176:179],v[88:91]
v_exp_f32 v74,v74
v_mfma_f32_16x16x32_bf16 v[88:91],a[204:207],a[180:183],v[88:91]
v_exp_f32 v75,v75
v_mfma_f32_16x16x32_bf16 v[88:91],a[208:211],a[184:187],v[88:91]
v_cvt_pk_bf16_f32 v116,v72,v73
v_cvt_pk_bf16_f32 v117,v74,v75
v_mfma_f32_16x16x32_bf16 v[88:91],a[212:215],a[188:191],v[88:91]
s_waitcnt lgkmcnt(0)
v_mfma_f32_16x16x32_bf16 v[68:71],a[216:219],a[96:99],0
v_mfma_f32_16x16x32_bf16 v[68:71],a[220:223],a[100:103],v[68:71]
v_mfma_f32_16x16x32_bf16 v[68:71],a[224:227],a[104:107],v[68:71]
v_mfma_f32_16x16x32_bf16 v[68:71],a[228:231],a[108:111],v[68:71]
v_mfma_f32_16x16x32_bf16 v[68:71],a[232:235],a[112:115],v[68:71]
v_mfma_f32_16x16x32_bf16 v[68:71],a[236:239],a[116:119],v[68:71]
v_mfma_f32_16x16x32_bf16 v[76:79],a[216:219],a[120:123],0
v_mfma_f32_16x16x32_bf16 v[76:79],a[220:223],a[124:127],v[76:79]
v_mfma_f32_16x16x32_bf16 v[76:79],a[224:227],a[128:131],v[76:79]
v_mfma_f32_16x16x32_bf16 v[76:79],a[228:231],a[132:135],v[76:79]
v_mfma_f32_16x16x32_bf16 v[76:79],a[232:235],a[136:139],v[76:79]
v_mfma_f32_16x16x32_bf16 v[76:79],a[236:239],a[140:143],v[76:79]
v_mfma_f32_16x16x32_bf16 v[84:87],a[216:219],a[144:147],0
v_mfma_f32_16x16x32_bf16 v[84:87],a[220:223],a[148:151],v[84:87]
s_waitcnt vmcnt(6)
s_barrier
v_mfma_f32_16x16x32_bf16 v[84:87],a[224:227],a[152:155],v[84:87]
ds_read_b64_tr_b16 a[240:241],v3 offset:0
v_mfma_f32_16x16x32_bf16 v[84:87],a[228:231],a[156:159],v[84:87]
ds_read_b64_tr_b16 a[242:243],v3 offset:6144
v_mfma_f32_16x16x32_bf16 v[84:87],a[232:235],a[160:163],v[84:87]
ds_read_b64_tr_b16 a[244:245],v4 offset:0
v_mfma_f32_16x16x32_bf16 v[84:87],a[236:239],a[164:167],v[84:87]
ds_read_b64_tr_b16 a[246:247],v4 offset:6144
v_mfma_f32_16x16x32_bf16 v[92:95],a[216:219],a[168:171],0
ds_read_b64_tr_b16 a[248:249],v5 offset:0
v_mfma_f32_16x16x32_bf16 v[92:95],a[220:223],a[172:175],v[92:95]
ds_read_b64_tr_b16 a[250:251],v5 offset:6144
v_mfma_f32_16x16x32_bf16 v[92:95],a[224:227],a[176:179],v[92:95]
ds_read_b64_tr_b16 a[252:253],v6 offset:0
v_mfma_f32_16x16x32_bf16 v[92:95],a[228:231],a[180:183],v[92:95]
ds_read_b64_tr_b16 a[254:255],v6 offset:6144
v_mfma_f32_16x16x32_bf16 v[92:95],a[232:235],a[184:187],v[92:95]
v_mfma_f32_16x16x32_bf16 v[92:95],a[236:239],a[188:191],v[92:95]
s_waitcnt lgkmcnt(6)
v_mfma_f32_16x16x32_bf16 v[160:163],a[240:243],v[96:99],0
s_add_u32 m0,s23,24576
ds_read_b128 a[192:195],v1 offset:24576
v_fma_f32 v68,v68,s36,v16
v_mfma_f32_16x16x32_bf16 v[208:211],a[240:243],v[100:103],0
buffer_load_dwordx4 v7,s[8:11],s21 offen offset:0 lds
v_mfma_f32_16x16x32_bf16 a[0:3],a[240:243],v[104:107],0
ds_read_b128 a[196:199],v2 offset:24576
v_fma_f32 v69,v69,s36,v16
v_mfma_f32_16x16x32_bf16 a[48:51],a[240:243],v[108:111],0
s_waitcnt lgkmcnt(4)
ds_read_b64_tr_b16 a[240:241],v3 offset:128
ds_read_b64_tr_b16 a[242:243],v3 offset:6272
v_mfma_f32_16x16x32_bf16 v[164:167],a[244:247],v[96:99],0
ds_read_b128 a[200:203],v1 offset:24704
v_fma_f32 v70,v70,s36,v16
v_mfma_f32_16x16x32_bf16 v[212:215],a[244:247],v[100:103],0
ds_read_b128 a[204:207],v2 offset:24704
v_fma_f32 v71,v71,s36,v16
v_mfma_f32_16x16x32_bf16 a[4:7],a[244:247],v[104:107],0
ds_read_b128 a[208:211],v1 offset:24832
v_fma_f32 v76,v76,s36,v17
v_mfma_f32_16x16x32_bf16 a[52:55],a[244:247],v[108:111],0
ds_read_b64_tr_b16 a[244:245],v4 offset:128
ds_read_b64_tr_b16 a[246:247],v4 offset:6272
v_mfma_f32_16x16x32_bf16 v[168:171],a[248:251],v[96:99],0
ds_read_b128 a[212:215],v2 offset:24832
v_fma_f32 v77,v77,s36,v17
v_mfma_f32_16x16x32_bf16 v[216:219],a[248:251],v[100:103],0
buffer_load_dwordx4 v8,s[8:11],s21 offen offset:1024 lds
v_mfma_f32_16x16x32_bf16 a[8:11],a[248:251],v[104:107],0
ds_read_b128 a[216:219],v1 offset:30720
v_fma_f32 v78,v78,s36,v17
v_mfma_f32_16x16x32_bf16 a[56:59],a[248:251],v[108:111],0
s_waitcnt lgkmcnt(7)
ds_read_b64_tr_b16 a[248:249],v5 offset:128
ds_read_b64_tr_b16 a[250:251],v5 offset:6272
v_mfma_f32_16x16x32_bf16 v[172:175],a[252:255],v[96:99],0
ds_read_b128 a[220:223],v2 offset:30720
v_fma_f32 v79,v79,s36,v17
v_mfma_f32_16x16x32_bf16 v[220:223],a[252:255],v[100:103],0
ds_read_b128 a[224:227],v1 offset:30848
v_fma_f32 v80,v80,s36,v18
v_mfma_f32_16x16x32_bf16 a[12:15],a[252:255],v[104:107],0
ds_read_b128 a[228:231],v2 offset:30848
v_fma_f32 v81,v81,s36,v18
v_mfma_f32_16x16x32_bf16 a[60:63],a[252:255],v[108:111],0
ds_read_b64_tr_b16 a[252:253],v6 offset:128
ds_read_b64_tr_b16 a[254:255],v6 offset:6272
v_mfma_f32_16x16x32_bf16 v[176:179],a[240:243],v[96:99],0
ds_read_b128 a[232:235],v1 offset:30976
v_fma_f32 v82,v82,s36,v18
v_mfma_f32_16x16x32_bf16 v[224:227],a[240:243],v[100:103],0
buffer_load_dwordx4 v9,s[8:11],s21 offen offset:2048 lds
v_mfma_f32_16x16x32_bf16 a[16:19],a[240:243],v[104:107],0
s_add_u32 s21,s21,12288
ds_read_b128 a[236:239],v2 offset:30976
v_fma_f32 v83,v83,s36,v18
v_mfma_f32_16x16x32_bf16 a[64:67],a[240:243],v[108:111],0
s_add_u32 m0,s22,12288
ds_read_b64_tr_b16 a[240:241],v3 offset:256
ds_read_b64_tr_b16 a[242:243],v3 offset:6400
s_waitcnt lgkmcnt(9)
v_mfma_f32_16x16x32_bf16 v[180:183],a[244:247],v[96:99],0
v_fma_f32 v84,v84,s36,v18
v_fma_f32 v85,v85,s36,v18
v_mfma_f32_16x16x32_bf16 v[228:231],a[244:247],v[100:103],0
v_fma_f32 v86,v86,s36,v18
v_fma_f32 v87,v87,s36,v18
v_mfma_f32_16x16x32_bf16 a[20:23],a[244:247],v[104:107],0
v_fma_f32 v88,v88,s36,v19
v_fma_f32 v89,v89,s36,v19
v_mfma_f32_16x16x32_bf16 a[68:71],a[244:247],v[108:111],0
ds_read_b64_tr_b16 a[244:245],v4 offset:256
ds_read_b64_tr_b16 a[246:247],v4 offset:6400
v_mfma_f32_16x16x32_bf16 v[184:187],a[248:251],v[96:99],0
buffer_load_dwordx4 v7,s[4:7],s20 offen offset:0 lds
v_mfma_f32_16x16x32_bf16 v[232:235],a[248:251],v[100:103],0
v_fma_f32 v90,v90,s36,v19
v_fma_f32 v91,v91,s36,v19
v_mfma_f32_16x16x32_bf16 a[24:27],a[248:251],v[104:107],0
v_fma_f32 v92,v92,s36,v19
v_fma_f32 v93,v93,s36,v19
v_mfma_f32_16x16x32_bf16 a[72:75],a[248:251],v[108:111],0
s_waitcnt lgkmcnt(2)
ds_read_b64_tr_b16 a[248:249],v5 offset:256
ds_read_b64_tr_b16 a[250:251],v5 offset:6400
v_mfma_f32_16x16x32_bf16 v[188:191],a[252:255],v[96:99],0
v_fma_f32 v94,v94,s36,v19
v_fma_f32 v95,v95,s36,v19
v_mfma_f32_16x16x32_bf16 v[236:239],a[252:255],v[100:103],0
v_exp_f32 v68,v68
v_mfma_f32_16x16x32_bf16 a[28:31],a[252:255],v[104:107],0
v_exp_f32 v69,v69
v_mfma_f32_16x16x32_bf16 a[76:79],a[252:255],v[108:111],0
ds_read_b64_tr_b16 a[252:253],v6 offset:256
ds_read_b64_tr_b16 a[254:255],v6 offset:6400
v_mfma_f32_16x16x32_bf16 v[192:195],a[240:243],v[96:99],0
buffer_load_dwordx4 v8,s[4:7],s20 offen offset:1024 lds
v_mfma_f32_16x16x32_bf16 v[240:243],a[240:243],v[100:103],0
v_exp_f32 v70,v70
v_mfma_f32_16x16x32_bf16 a[32:35],a[240:243],v[104:107],0
v_exp_f32 v71,v71
v_mfma_f32_16x16x32_bf16 a[80:83],a[240:243],v[108:111],0
s_waitcnt lgkmcnt(2)
v_exp_f32 v76,v76
v_mfma_f32_16x16x32_bf16 v[196:199],a[244:247],v[96:99],0
v_exp_f32 v77,v77
v_mfma_f32_16x16x32_bf16 v[244:247],a[244:247],v[100:103],0
v_exp_f32 v78,v78
v_mfma_f32_16x16x32_bf16 a[36:39],a[244:247],v[104:107],0
v_exp_f32 v79,v79
v_mfma_f32_16x16x32_bf16 a[84:87],a[244:247],v[108:111],0
v_exp_f32 v80,v80
v_mfma_f32_16x16x32_bf16 v[200:203],a[248:251],v[96:99],0
buffer_load_dwordx4 v9,s[4:7],s20 offen offset:2048 lds
v_mfma_f32_16x16x32_bf16 v[248:251],a[248:251],v[100:103],0
s_add_u32 s20,s20,12288
v_exp_f32 v81,v81
v_mfma_f32_16x16x32_bf16 a[40:43],a[248:251],v[104:107],0
v_exp_f32 v82,v82
v_mfma_f32_16x16x32_bf16 a[88:91],a[248:251],v[108:111],0
s_waitcnt lgkmcnt(0)
v_exp_f32 v83,v83
v_mfma_f32_16x16x32_bf16 v[204:207],a[252:255],v[96:99],0
v_exp_f32 v84,v84
v_mfma_f32_16x16x32_bf16 v[252:255],a[252:255],v[100:103],0
v_exp_f32 v85,v85
v_mfma_f32_16x16x32_bf16 a[44:47],a[252:255],v[104:107],0
v_exp_f32 v86,v86
v_mfma_f32_16x16x32_bf16 a[92:95],a[252:255],v[108:111],0
v_exp_f32 v87,v87
v_mfma_f32_16x16x32_bf16 v[32:35],a[192:195],a[96:99],0
v_exp_f32 v88,v88
v_mfma_f32_16x16x32_bf16 v[32:35],a[196:199],a[100:103],v[32:35]
v_exp_f32 v89,v89
v_mfma_f32_16x16x32_bf16 v[32:35],a[200:203],a[104:107],v[32:35]
v_exp_f32 v90,v90
v_mfma_f32_16x16x32_bf16 v[32:35],a[204:207],a[108:111],v[32:35]
v_exp_f32 v91,v91
v_mfma_f32_16x16x32_bf16 v[32:35],a[208:211],a[112:115],v[32:35]
v_exp_f32 v92,v92
v_mfma_f32_16x16x32_bf16 v[32:35],a[212:215],a[116:119],v[32:35]
v_exp_f32 v93,v93
v_mfma_f32_16x16x32_bf16 v[40:43],a[192:195],a[120:123],0
v_exp_f32 v94,v94
v_mfma_f32_16x16x32_bf16 v[40:43],a[196:199],a[124:127],v[40:43]
v_exp_f32 v95,v95
v_mfma_f32_16x16x32_bf16 v[40:43],a[200:203],a[128:131],v[40:43]
v_cvt_pk_bf16_f32 v114,v68,v69
v_cvt_pk_bf16_f32 v115,v70,v71
v_mfma_f32_16x16x32_bf16 v[40:43],a[204:207],a[132:135],v[40:43]
v_cvt_pk_bf16_f32 v118,v76,v77
v_cvt_pk_bf16_f32 v119,v78,v79
v_mfma_f32_16x16x32_bf16 v[128:131],v[24:27],v[112:115],v[128:131]
v_cvt_pk_bf16_f32 v120,v80,v81
v_cvt_pk_bf16_f32 v121,v82,v83
v_mfma_f32_16x16x32_bf16 v[132:135],v[24:27],v[116:119],v[132:135]
v_cvt_pk_bf16_f32 v122,v84,v85
v_cvt_pk_bf16_f32 v123,v86,v87
v_mfma_f32_16x16x32_bf16 v[40:43],a[208:211],a[136:139],v[40:43]
v_cvt_pk_bf16_f32 v124,v88,v89
v_cvt_pk_bf16_f32 v125,v90,v91
v_mfma_f32_16x16x32_bf16 v[136:139],v[24:27],v[120:123],v[136:139]
v_cvt_pk_bf16_f32 v126,v92,v93
v_cvt_pk_bf16_f32 v127,v94,v95
v_mfma_f32_16x16x32_bf16 v[40:43],a[212:215],a[140:143],v[40:43]
v_fma_f32 v32,v32,s36,v16
v_fma_f32 v33,v33,s36,v16
v_mfma_f32_16x16x32_bf16 v[140:143],v[24:27],v[124:127],v[140:143]
v_fma_f32 v34,v34,s36,v16
v_fma_f32 v35,v35,s36,v16
v_mfma_f32_16x16x32_bf16 v[48:51],a[192:195],a[144:147],0
v_exp_f32 v32,v32
v_mfma_f32_16x16x32_bf16 v[48:51],a[196:199],a[148:151],v[48:51]
v_fma_f32 v40,v40,s36,v17
v_fma_f32 v41,v41,s36,v17
v_mfma_f32_16x16x32_bf16 v[48:51],a[200:203],a[152:155],v[48:51]
v_fma_f32 v42,v42,s36,v17
v_fma_f32 v43,v43,s36,v17
v_mfma_f32_16x16x32_bf16 v[48:51],a[204:207],a[156:159],v[48:51]
v_exp_f32 v33,v33
v_mfma_f32_16x16x32_bf16 v[48:51],a[208:211],a[160:163],v[48:51]
v_exp_f32 v34,v34
v_mfma_f32_16x16x32_bf16 v[48:51],a[212:215],a[164:167],v[48:51]
v_exp_f32 v35,v35
v_mfma_f32_16x16x32_bf16 v[56:59],a[192:195],a[168:171],0
v_exp_f32 v40,v40
v_mfma_f32_16x16x32_bf16 v[56:59],a[196:199],a[172:175],v[56:59]
v_exp_f32 v41,v41
v_mfma_f32_16x16x32_bf16 v[56:59],a[200:203],a[176:179],v[56:59]
v_exp_f32 v42,v42
v_mfma_f32_16x16x32_bf16 v[56:59],a[204:207],a[180:183],v[56:59]
v_exp_f32 v43,v43
v_mfma_f32_16x16x32_bf16 v[56:59],a[208:211],a[184:187],v[56:59]
v_cvt_pk_bf16_f32 v96,v32,v33
v_cvt_pk_bf16_f32 v97,v34,v35
v_mfma_f32_16x16x32_bf16 v[56:59],a[212:215],a[188:191],v[56:59]
v_cvt_pk_bf16_f32 v100,v40,v41
v_cvt_pk_bf16_f32 v101,v42,v43
v_mfma_f32_16x16x32_bf16 v[36:39],a[216:219],a[96:99],0
v_mfma_f32_16x16x32_bf16 v[36:39],a[220:223],a[100:103],v[36:39]
v_mfma_f32_16x16x32_bf16 v[36:39],a[224:227],a[104:107],v[36:39]
v_mfma_f32_16x16x32_bf16 v[36:39],a[228:231],a[108:111],v[36:39]
v_mfma_f32_16x16x32_bf16 v[36:39],a[232:235],a[112:115],v[36:39]
v_mfma_f32_16x16x32_bf16 v[36:39],a[236:239],a[116:119],v[36:39]
v_mfma_f32_16x16x32_bf16 v[44:47],a[216:219],a[120:123],0
v_mfma_f32_16x16x32_bf16 v[44:47],a[220:223],a[124:127],v[44:47]
v_mfma_f32_16x16x32_bf16 v[44:47],a[224:227],a[128:131],v[44:47]
v_mfma_f32_16x16x32_bf16 v[44:47],a[228:231],a[132:135],v[44:47]
v_mfma_f32_16x16x32_bf16 v[44:47],a[232:235],a[136:139],v[44:47]
s_waitcnt vmcnt(6)
s_barrier
v_mfma_f32_16x16x32_bf16 v[44:47],a[236:239],a[140:143],v[44:47]
ds_read_b64_tr_b16 a[240:241],v3 offset:12288
v_mfma_f32_16x16x32_bf16 v[52:55],a[216:219],a[144:147],0
ds_read_b64_tr_b16 a[242:243],v3 offset:18432
v_mfma_f32_16x16x32_bf16 v[52:55],a[220:223],a[148:151],v[52:55]
ds_read_b64_tr_b16 a[244:245],v4 offset:12288
v_mfma_f32_16x16x32_bf16 v[52:55],a[224:227],a[152:155],v[52:55]
ds_read_b64_tr_b16 a[246:247],v4 offset:18432
v_mfma_f32_16x16x32_bf16 v[52:55],a[228:231],a[156:159],v[52:55]
ds_read_b64_tr_b16 a[248:249],v5 offset:12288
v_mfma_f32_16x16x32_bf16 v[52:55],a[232:235],a[160:163],v[52:55]
ds_read_b64_tr_b16 a[250:251],v5 offset:18432
v_mfma_f32_16x16x32_bf16 v[52:55],a[236:239],a[164:167],v[52:55]
ds_read_b64_tr_b16 a[252:253],v6 offset:12288
v_mfma_f32_16x16x32_bf16 v[60:63],a[216:219],a[168:171],0
ds_read_b64_tr_b16 a[254:255],v6 offset:18432
v_mfma_f32_16x16x32_bf16 v[60:63],a[220:223],a[172:175],v[60:63]
v_mfma_f32_16x16x32_bf16 v[60:63],a[224:227],a[176:179],v[60:63]
v_mfma_f32_16x16x32_bf16 v[60:63],a[228:231],a[180:183],v[60:63]
v_mfma_f32_16x16x32_bf16 v[60:63],a[232:235],a[184:187],v[60:63]
v_mfma_f32_16x16x32_bf16 v[60:63],a[236:239],a[188:191],v[60:63]
s_waitcnt lgkmcnt(4)
v_mfma_f32_16x16x32_bf16 v[160:163],a[240:243],v[112:115],v[160:163]
s_add_u32 m0,s23,0
ds_read_b128 a[192:195],v1 offset:0
v_fma_f32 v36,v36,s36,v16
v_mfma_f32_16x16x32_bf16 v[208:211],a[240:243],v[116:119],v[208:211]
buffer_load_dwordx4 v7,s[8:11],s21 offen offset:0 lds
v_mfma_f32_16x16x32_bf16 a[0:3],a[240:243],v[120:123],a[0:3]
ds_read_b128 a[196:199],v2 offset:0
v_fma_f32 v37,v37,s36,v16
v_mfma_f32_16x16x32_bf16 a[48:51],a[240:243],v[124:127],a[48:51]
ds_read_b64_tr_b16 a[240:241],v3 offset:12416
ds_read_b64_tr_b16 a[242:243],v3 offset:18560
v_mfma_f32_16x16x32_bf16 v[164:167],a[244:247],v[112:115],v[164:167]
ds_read_b128 a[200:203],v1 offset:128
v_fma_f32 v38,v38,s36,v16
v_mfma_f32_16x16x32_bf16 v[212:215],a[244:247],v[116:119],v[212:215]
ds_read_b128 a[204:207],v2 offset:128
v_fma_f32 v39,v39,s36,v16
v_mfma_f32_16x16x32_bf16 a[4:7],a[244:247],v[120:123],a[4:7]
ds_read_b128 a[208:211],v1 offset:256
v_fma_f32 v44,v44,s36,v17
v_mfma_f32_16x16x32_bf16 a[52:55],a[244:247],v[124:127],a[52:55]
s_waitcnt lgkmcnt(7)
ds_read_b64_tr_b16 a[244:245],v4 offset:12416
ds_read_b64_tr_b16 a[246:247],v4 offset:18560
v_mfma_f32_16x16x32_bf16 v[168:171],a[248:251],v[112:115],v[168:171]
ds_read_b128 a[212:215],v2 offset:256
v_fma_f32 v45,v45,s36,v17
v_mfma_f32_16x16x32_bf16 v[216:219],a[248:251],v[116:119],v[216:219]
buffer_load_dwordx4 v8,s[8:11],s21 offen offset:1024 lds
v_mfma_f32_16x16x32_bf16 a[8:11],a[248:251],v[120:123],a[8:11]
ds_read_b128 a[216:219],v1 offset:6144
v_fma_f32 v46,v46,s36,v17
v_mfma_f32_16x16x32_bf16 a[56:59],a[248:251],v[124:127],a[56:59]
ds_read_b64_tr_b16 a[248:249],v5 offset:12416
ds_read_b64_tr_b16 a[250:251],v5 offset:18560
v_mfma_f32_16x16x32_bf16 v[172:175],a[252:255],v[112:115],v[172:175]
ds_read_b128 a[220:223],v2 offset:6144
v_fma_f32 v47,v47,s36,v17
v_mfma_f32_16x16x32_bf16 v[220:223],a[252:255],v[116:119],v[220:223]
ds_read_b128 a[224:227],v1 offset:6272
v_fma_f32 v48,v48,s36,v18
v_mfma_f32_16x16x32_bf16 a[12:15],a[252:255],v[120:123],a[12:15]
ds_read_b128 a[228:231],v2 offset:6272
v_fma_f32 v49,v49,s36,v18
v_mfma_f32_16x16x32_bf16 a[60:63],a[252:255],v[124:127],a[60:63]
s_waitcnt lgkmcnt(7)
ds_read_b64_tr_b16 a[252:253],v6 offset:12416
ds_read_b64_tr_b16 a[254:255],v6 offset:18560
v_mfma_f32_16x16x32_bf16 v[176:179],a[240:243],v[112:115],v[176:179]
ds_read_b128 a[232:235],v1 offset:6400
v_fma_f32 v50,v50,s36,v18
v_mfma_f32_16x16x32_bf16 v[224:227],a[240:243],v[116:119],v[224:227]
buffer_load_dwordx4 v9,s[8:11],s21 offen offset:2048 lds
v_mfma_f32_16x16x32_bf16 a[16:19],a[240:243],v[120:123],a[16:19]
s_add_u32 s21,s21,12288
ds_read_b128 a[236:239],v2 offset:6400
v_fma_f32 v51,v51,s36,v18
v_mfma_f32_16x16x32_bf16 a[64:67],a[240:243],v[124:127],a[64:67]
s_add_u32 m0,s22,24576
ds_read_b64_tr_b16 a[240:241],v3 offset:12544
ds_read_b64_tr_b16 a[242:243],v3 offset:18688
v_mfma_f32_16x16x32_bf16 v[180:183],a[244:247],v[112:115],v[180:183]
v_fma_f32 v52,v52,s36,v18
v_fma_f32 v53,v53,s36,v18
v_mfma_f32_16x16x32_bf16 v[228:231],a[244:247],v[116:119],v[228:231]
v_fma_f32 v54,v54,s36,v18
v_fma_f32 v55,v55,s36,v18
v_mfma_f32_16x16x32_bf16 a[20:23],a[244:247],v[120:123],a[20:23]
v_fma_f32 v56,v56,s36,v19
v_fma_f32 v57,v57,s36,v19
v_mfma_f32_16x16x32_bf16 a[68:71],a[244:247],v[124:127],a[68:71]
s_waitcnt lgkmcnt(4)
ds_read_b64_tr_b16 a[244:245],v4 offset:12544
ds_read_b64_tr_b16 a[246:247],v4 offset:18688
v_mfma_f32_16x16x32_bf16 v[184:187],a[248:251],v[112:115],v[184:187]
buffer_load_dwordx4 v7,s[4:7],s20 offen offset:0 lds
v_mfma_f32_16x16x32_bf16 v[232:235],a[248:251],v[116:119],v[232:235]
v_fma_f32 v58,v58,s36,v19
v_fma_f32 v59,v59,s36,v19
v_mfma_f32_16x16x32_bf16 a[24:27],a[248:251],v[120:123],a[24:27]
v_fma_f32 v60,v60,s36,v19
v_fma_f32 v61,v61,s36,v19
v_mfma_f32_16x16x32_bf16 a[72:75],a[248:251],v[124:127],a[72:75]
ds_read_b64_tr_b16 a[248:249],v5 offset:12544
ds_read_b64_tr_b16 a[250:251],v5 offset:18688
v_mfma_f32_16x16x32_bf16 v[188:191],a[252:255],v[112:115],v[188:191]
v_fma_f32 v62,v62,s36,v19
v_fma_f32 v63,v63,s36,v19
v_mfma_f32_16x16x32_bf16 v[236:239],a[252:255],v[116:119],v[236:239]
v_exp_f32 v36,v36
v_mfma_f32_16x16x32_bf16 a[28:31],a[252:255],v[120:123],a[28:31]
v_exp_f32 v37,v37
v_mfma_f32_16x16x32_bf16 a[76:79],a[252:255],v[124:127],a[76:79]
s_waitcnt lgkmcnt(2)
ds_read_b64_tr_b16 a[252:253],v6 offset:12544
ds_read_b64_tr_b16 a[254:255],v6 offset:18688
v_mfma_f32_16x16x32_bf16 v[192:195],a[240:243],v[112:115],v[192:195]
buffer_load_dwordx4 v8,s[4:7],s20 offen offset:1024 lds
v_mfma_f32_16x16x32_bf16 v[240:243],a[240:243],v[116:119],v[240:243]
v_exp_f32 v38,v38
v_mfma_f32_16x16x32_bf16 a[32:35],a[240:243],v[120:123],a[32:35]
v_exp_f32 v39,v39
v_mfma_f32_16x16x32_bf16 a[80:83],a[240:243],v[124:127],a[80:83]
v_exp_f32 v44,v44
v_mfma_f32_16x16x32_bf16 v[196:199],a[244:247],v[112:115],v[196:199]
v_exp_f32 v45,v45
v_mfma_f32_16x16x32_bf16 v[244:247],a[244:247],v[116:119],v[244:247]
v_exp_f32 v46,v46
v_mfma_f32_16x16x32_bf16 a[36:39],a[244:247],v[120:123],a[36:39]
v_exp_f32 v47,v47
v_mfma_f32_16x16x32_bf16 a[84:87],a[244:247],v[124:127],a[84:87]
s_waitcnt lgkmcnt(0)
v_exp_f32 v48,v48
v_mfma_f32_16x16x32_bf16 v[200:203],a[248:251],v[112:115],v[200:203]
buffer_load_dwordx4 v9,s[4:7],s20 offen offset:2048 lds
v_mfma_f32_16x16x32_bf16 v[248:251],a[248:251],v[116:119],v[248:251]
s_add_u32 s20,s20,12288
v_exp_f32 v49,v49
v_mfma_f32_16x16x32_bf16 a[40:43],a[248:251],v[120:123],a[40:43]
v_exp_f32 v50,v50
v_mfma_f32_16x16x32_bf16 a[88:91],a[248:251],v[124:127],a[88:91]
v_exp_f32 v51,v51
v_mfma_f32_16x16x32_bf16 v[204:207],a[252:255],v[112:115],v[204:207]
v_exp_f32 v52,v52
v_mfma_f32_16x16x32_bf16 v[252:255],a[252:255],v[116:119],v[252:255]
v_exp_f32 v53,v53
v_mfma_f32_16x16x32_bf16 a[44:47],a[252:255],v[120:123],a[44:47]
v_exp_f32 v54,v54
v_mfma_f32_16x16x32_bf16 a[92:95],a[252:255],v[124:127],a[92:95]
v_exp_f32 v55,v55
v_mfma_f32_16x16x32_bf16 v[64:67],a[192:195],a[96:99],0
v_exp_f32 v56,v56
v_mfma_f32_16x16x32_bf16 v[64:67],a[196:199],a[100:103],v[64:67]
v_exp_f32 v57,v57
v_mfma_f32_16x16x32_bf16 v[64:67],a[200:203],a[104:107],v[64:67]
v_exp_f32 v58,v58
v_mfma_f32_16x16x32_bf16 v[64:67],a[204:207],a[108:111],v[64:67]
v_exp_f32 v59,v59
v_mfma_f32_16x16x32_bf16 v[64:67],a[208:211],a[112:115],v[64:67]
v_exp_f32 v60,v60
v_mfma_f32_16x16x32_bf16 v[64:67],a[212:215],a[116:119],v[64:67]
v_exp_f32 v61,v61
v_mfma_f32_16x16x32_bf16 v[72:75],a[192:195],a[120:123],0
v_exp_f32 v62,v62
v_mfma_f32_16x16x32_bf16 v[72:75],a[196:199],a[124:127],v[72:75]
v_exp_f32 v63,v63
v_mfma_f32_16x16x32_bf16 v[72:75],a[200:203],a[128:131],v[72:75]
v_cvt_pk_bf16_f32 v98,v36,v37
v_cvt_pk_bf16_f32 v99,v38,v39
v_mfma_f32_16x16x32_bf16 v[72:75],a[204:207],a[132:135],v[72:75]
v_cvt_pk_bf16_f32 v102,v44,v45
v_cvt_pk_bf16_f32 v103,v46,v47
v_mfma_f32_16x16x32_bf16 v[128:131],v[24:27],v[96:99],v[128:131]
v_cvt_pk_bf16_f32 v104,v48,v49
v_cvt_pk_bf16_f32 v105,v50,v51
v_mfma_f32_16x16x32_bf16 v[132:135],v[24:27],v[100:103],v[132:135]
v_cvt_pk_bf16_f32 v106,v52,v53
v_cvt_pk_bf16_f32 v107,v54,v55
v_mfma_f32_16x16x32_bf16 v[72:75],a[208:211],a[136:139],v[72:75]
v_cvt_pk_bf16_f32 v108,v56,v57
v_cvt_pk_bf16_f32 v109,v58,v59
v_mfma_f32_16x16x32_bf16 v[136:139],v[24:27],v[104:107],v[136:139]
v_cvt_pk_bf16_f32 v110,v60,v61
v_cvt_pk_bf16_f32 v111,v62,v63
v_mfma_f32_16x16x32_bf16 v[72:75],a[212:215],a[140:143],v[72:75]
v_fma_f32 v64,v64,s36,v16
v_fma_f32 v65,v65,s36,v16
v_mfma_f32_16x16x32_bf16 v[140:143],v[24:27],v[108:111],v[140:143]
v_fma_f32 v66,v66,s36,v16
v_fma_f32 v67,v67,s36,v16
v_mfma_f32_16x16x32_bf16 v[80:83],a[192:195],a[144:147],0
v_exp_f32 v64,v64
v_mfma_f32_16x16x32_bf16 v[80:83],a[196:199],a[148:151],v[80:83]
v_fma_f32 v72,v72,s36,v17
v_fma_f32 v73,v73,s36,v17
v_mfma_f32_16x16x32_bf16 v[80:83],a[200:203],a[152:155],v[80:83]
v_fma_f32 v74,v74,s36,v17
v_fma_f32 v75,v75,s36,v17
v_mfma_f32_16x16x32_bf16 v[80:83],a[204:207],a[156:159],v[80:83]
v_exp_f32 v65,v65
v_mfma_f32_16x16x32_bf16 v[80:83],a[208:211],a[160:163],v[80:83]
v_exp_f32 v66,v66
v_mfma_f32_16x16x32_bf16 v[80:83],a[212:215],a[164:167],v[80:83]
v_exp_f32 v67,v67
v_mfma_f32_16x16x32_bf16 v[88:91],a[192:195],a[168:171],0
v_exp_f32 v72,v72
v_mfma_f32_16x16x32_bf16 v[88:91],a[196:199],a[172:175],v[88:91]
v_exp_f32 v73,v73
v_mfma_f32_16x16x32_bf16 v[88:91],a[200:203],a[176:179],v[88:91]
v_exp_f32 v74,v74
v_mfma_f32_16x16x32_bf16 v[88:91],a[204:207],a[180:183],v[88:91]
v_exp_f32 v75,v75
v_mfma_f32_16x16x32_bf16 v[88:91],a[208:211],a[184:187],v[88:91]
v_cvt_pk_bf16_f32 v112,v64,v65
v_cvt_pk_bf16_f32 v113,v66,v67
v_mfma_f32_16x16x32_bf16 v[88:91],a[212:215],a[188:191],v[88:91]
v_cvt_pk_bf16_f32 v116,v72,v73
v_cvt_pk_bf16_f32 v117,v74,v75
v_mfma_f32_16x16x32_bf16 v[68:71],a[216:219],a[96:99],0
v_mfma_f32_16x16x32_bf16 v[68:71],a[220:223],a[100:103],v[68:71]
v_mfma_f32_16x16x32_bf16 v[68:71],a[224:227],a[104:107],v[68:71]
v_mfma_f32_16x16x32_bf16 v[68:71],a[228:231],a[108:111],v[68:71]
v_mfma_f32_16x16x32_bf16 v[68:71],a[232:235],a[112:115],v[68:71]
v_mfma_f32_16x16x32_bf16 v[68:71],a[236:239],a[116:119],v[68:71]
v_mfma_f32_16x16x32_bf16 v[76:79],a[216:219],a[120:123],0
v_mfma_f32_16x16x32_bf16 v[76:79],a[220:223],a[124:127],v[76:79]
v_mfma_f32_16x16x32_bf16 v[76:79],a[224:227],a[128:131],v[76:79]
v_mfma_f32_16x16x32_bf16 v[76:79],a[228:231],a[132:135],v[76:79]
v_mfma_f32_16x16x32_bf16 v[76:79],a[232:235],a[136:139],v[76:79]
s_waitcnt vmcnt(6)
s_barrier
v_mfma_f32_16x16x32_bf16 v[76:79],a[236:239],a[140:143],v[76:79]
ds_read_b64_tr_b16 a[240:241],v3 offset:24576
v_mfma_f32_16x16x32_bf16 v[84:87],a[216:219],a[144:147],0
ds_read_b64_tr_b16 a[242:243],v3 offset:30720
v_mfma_f32_16x16x32_bf16 v[84:87],a[220:223],a[148:151],v[84:87]
ds_read_b64_tr_b16 a[244:245],v4 offset:24576
v_mfma_f32_16x16x32_bf16 v[84:87],a[224:227],a[152:155],v[84:87]
ds_read_b64_tr_b16 a[246:247],v4 offset:30720
v_mfma_f32_16x16x32_bf16 v[84:87],a[228:231],a[156:159],v[84:87]
ds_read_b64_tr_b16 a[248:249],v5 offset:24576
v_mfma_f32_16x16x32_bf16 v[84:87],a[232:235],a[160:163],v[84:87]
ds_read_b64_tr_b16 a[250:251],v5 offset:30720
v_mfma_f32_16x16x32_bf16 v[84:87],a[236:239],a[164:167],v[84:87]
ds_read_b64_tr_b16 a[252:253],v6 offset:24576
v_mfma_f32_16x16x32_bf16 v[92:95],a[216:219],a[168:171],0
ds_read_b64_tr_b16 a[254:255],v6 offset:30720
v_mfma_f32_16x16x32_bf16 v[92:95],a[220:223],a[172:175],v[92:95]
v_mfma_f32_16x16x32_bf16 v[92:95],a[224:227],a[176:179],v[92:95]
v_mfma_f32_16x16x32_bf16 v[92:95],a[228:231],a[180:183],v[92:95]
v_mfma_f32_16x16x32_bf16 v[92:95],a[232:235],a[184:187],v[92:95]
v_mfma_f32_16x16x32_bf16 v[92:95],a[236:239],a[188:191],v[92:95]
s_mov_b32 s38,0
s_branch L_loop4
L_start3:
s_add_u32 m0,s22,0
s_nop 0
buffer_load_dwordx4 v7,s[4:7],s20 offen offset:0 lds
buffer_load_dwordx4 v8,s[4:7],s20 offen offset:1024 lds
buffer_load_dwordx4 v9,s[4:7],s20 offen offset:2048 lds
s_add_u32 s20,s20,12288
s_mov_b32 s28,s41
s_add_u32 m0,s24,0
s_nop 0
buffer_load_dwordx4 v7,s[12:15],s28 offen offset:0 nt lds
buffer_load_dwordx4 v8,s[12:15],s28 offen offset:1024 nt lds
buffer_load_dwordx4 v9,s[12:15],s28 offen offset:2048 nt lds
s_add_u32 s28,s28,3072
s_add_u32 m0,s24,3072
s_nop 0
buffer_load_dwordx4 v7,s[12:15],s28 offen offset:0 nt lds
buffer_load_dwordx4 v8,s[12:15],s28 offen offset:1024 nt lds
buffer_load_dwordx4 v9,s[12:15],s28 offen offset:2048 nt lds
s_add_u32 s28,s28,3072
s_add_u32 m0,s24,6144
s_nop 0
buffer_load_dwordx4 v7,s[12:15],s28 offen offset:0 nt lds
buffer_load_dwordx4 v8,s[12:15],s28 offen offset:1024 nt lds
buffer_load_dwordx4 v9,s[12:15],s28 offen offset:2048 nt lds
s_add_u32 s28,s28,3072
s_add_u32 m0,s24,9216
s_nop 0
buffer_load_dwordx4 v7,s[12:15],s28 offen offset:0 nt lds
buffer_load_dwordx4 v8,s[12:15],s28 offen offset:1024 nt lds
buffer_load_dwordx4 v9,s[12:15],s28 offen offset:2048 nt lds
s_add_u32 s28,s28,3072
v_and_b32 v144,15,v0
v_lshrrev_b32 v145,4,v0
v_lshrrev_b32 v146,3,v144
v_mul_u32_u24 v1,384,v144
v_and_b32 v147,6,v144
v_xor_b32 v147,v147,v145
v_lshl_add_u32 v1,v147,4,v1
v_xor_b32 v2,64,v1
v_mul_u32_u24 v148,19456,v146
v_add_u32 v148,92160,v148
v_add_u32 v13,v148,v1
v_add_u32 v28,s24,v1
v_add_u32 v14,v148,v2
v_add_u32 v29,s24,v2
v_lshrrev_b32 v144,2,v0
v_mul_u32_u24 v3,384,v144
v_and_b32 v144,6,v144
v_bfe_u32 v147,v0,1,1
v_xor_b32 v144,v144,v147
v_lshl_add_u32 v3,v144,4,v3
v_and_b32 v147,1,v0
v_lshl_add_u32 v3,v147,3,v3
v_add_u32 v3,36864,v3
v_xor_b32 v4,32,v3
v_xor_b32 v5,64,v3
v_xor_b32 v6,96,v3
v_lshrrev_b32 v144,3,v0
v_and_b32 v145,7,v0
v_lshrrev_b32 v147,5,v0
v_xor_b32 v147,v147,v145
v_lshlrev_b32 v12,7,v145
v_lshl_add_u32 v12,v147,4,v12
v_bfe_u32 v146,v0,4,1
v_lshl_add_u32 v12,v146,3,v12
v_bfe_u32 v146,v0,3,1
v_mul_u32_u24 v146,3072,v146
v_add3_u32 v12,v12,v146,s24
v_xor_b32 v20,32,v12
v_xor_b32 v21,64,v12
v_xor_b32 v22,96,v12
v_xor_b32 v146,v145,v144
v_lshlrev_b32 v15,7,v144
v_lshl_add_u32 v15,v146,4,v15
v_add_u32 v15,s24,v15
v_add_u32 v146,0,v144
v_mul_u32_u24 v147,43,v146
v_lshrrev_b32 v147,7,v147
v_mul_u32_u24 v148,3,v147
v_sub_u32 v146,v146,v148
v_lshlrev_b32 v146,10,v146
v_lshl_add_u32 v146,v147,7,v146
v_xor_b32 v147,v147,v145
v_lshl_add_u32 v146,v147,4,v146
v_add_u32 v11,s24,v146
v_add_u32 v146,8,v144
v_mul_u32_u24 v147,43,v146
v_lshrrev_b32 v147,7,v147
v_mul_u32_u24 v148,3,v147
v_sub_u32 v146,v146,v148
v_lshlrev_b32 v146,10,v146
v_lshl_add_u32 v146,v147,7,v146
v_xor_b32 v147,v147,v145
v_lshl_add_u32 v146,v147,4,v146
v_add_u32 v23,s24,v146
v_add_u32 v146,16,v144
v_mul_u32_u24 v147,43,v146
v_lshrrev_b32 v147,7,v147
v_mul_u32_u24 v148,3,v147
v_sub_u32 v146,v146,v148
v_lshlrev_b32 v146,10,v146
v_lshl_add_u32 v146,v147,7,v146
v_xor_b32 v147,v147,v145
v_lshl_add_u32 v146,v147,4,v146
v_add_u32 v31,s24,v146
v_mul_u32_u24 v10,384,v144
v_lshl_add_u32 v10,v145,4,v10
v_mov_b32 v24,0x3f803f80
v_mov_b32 v25,0x3f803f80
v_mov_b32 v26,0x3f803f80
v_mov_b32 v27,0x3f803f80
v_lshlrev_b32 v0,4,v0
s_waitcnt vmcnt(12)
s_barrier
ds_read_b128 a[192:195],v1 offset:0
ds_read_b128 a[196:199],v2 offset:0
ds_read_b128 a[200:203],v1 offset:128
ds_read_b128 a[204:207],v2 offset:128
ds_read_b128 a[208:211],v1 offset:256
ds_read_b128 a[212:215],v2 offset:256
ds_read_b128 a[216:219],v1 offset:6144
ds_read_b128 a[220:223],v2 offset:6144
ds_read_b128 a[224:227],v1 offset:6272
ds_read_b128 a[228:231],v2 offset:6272
ds_read_b128 a[232:235],v1 offset:6400
ds_read_b128 a[236:239],v2 offset:6400
s_waitcnt vmcnt(6)
ds_read_b128 a[96:99],v28 offset:0
s_add_u32 m0,s24,12288
ds_read_b128 a[100:103],v29 offset:0
ds_read_b128 a[104:107],v28 offset:128
ds_read_b128 a[108:111],v29 offset:128
ds_read_b128 a[112:115],v28 offset:256
ds_read_b128 a[116:119],v29 offset:256
s_waitcnt lgkmcnt(5)
v_mfma_f32_16x16x32_bf16 v[32:35],a[192:195],a[96:99],0
buffer_load_dwordx4 v7,s[12:15],s28 offen offset:0 nt lds
s_waitcnt lgkmcnt(4)
v_mfma_f32_16x16x32_bf16 v[32:35],a[196:199],a[100:103],v[32:35]
buffer_load_dwordx4 v8,s[12:15],s28 offen offset:1024 nt lds
s_waitcnt lgkmcnt(3)
v_mfma_f32_16x16x32_bf16 v[32:35],a[200:203],a[104:107],v[32:35]
buffer_load_dwordx4 v9,s[12:15],s28 offen offset:2048 nt lds
s_add_u32 s28,s28,3072
s_add_u32 m0,s24,15360
s_waitcnt lgkmcnt(2)
v_mfma_f32_16x16x32_bf16 v[32:35],a[204:207],a[108:111],v[32:35]
buffer_load_dwordx4 v7,s[12:15],s28 offen offset:0 nt lds
s_waitcnt lgkmcnt(1)
v_mfma_f32_16x16x32_bf16 v[32:35],a[208:211],a[112:115],v[32:35]
buffer_load_dwordx4 v8,s[12:15],s28 offen offset:1024 nt lds
s_waitcnt lgkmcnt(0)
v_mfma_f32_16x16x32_bf16 v[32:35],a[212:215],a[116:119],v[32:35]
buffer_load_dwordx4 v9,s[12:15],s28 offen offset:2048 nt lds
s_add_u32 s28,s28,3072
s_add_u32 m0,s22,12288
v_mfma_f32_16x16x32_bf16 v[36:39],a[216:219],a[96:99],0
v_mfma_f32_16x16x32_bf16 v[36:39],a[220:223],a[100:103],v[36:39]
v_mfma_f32_16x16x32_bf16 v[36:39],a[224:227],a[104:107],v[36:39]
v_mfma_f32_16x16x32_bf16 v[36:39],a[228:231],a[108:111],v[36:39]
v_mfma_f32_16x16x32_bf16 v[36:39],a[232:235],a[112:115],v[36:39]
v_mfma_f32_16x16x32_bf16 v[36:39],a[236:239],a[116:119],v[36:39]
s_waitcnt vmcnt(6)
ds_read_b128 a[120:123],v28 offset:6144
ds_read_b128 a[124:127],v29 offset:6144
ds_read_b128 a[128:131],v28 offset:6272
ds_read_b128 a[132:135],v29 offset:6272
ds_read_b128 a[136:139],v28 offset:6400
ds_read_b128 a[140:143],v29 offset:6400
s_waitcnt lgkmcnt(5)
v_mfma_f32_16x16x32_bf16 v[40:43],a[192:195],a[120:123],0
buffer_load_dwordx4 v7,s[4:7],s20 offen offset:0 lds
s_waitcnt lgkmcnt(4)
v_mfma_f32_16x16x32_bf16 v[40:43],a[196:199],a[124:127],v[40:43]
buffer_load_dwordx4 v8,s[4:7],s20 offen offset:1024 lds
s_waitcnt lgkmcnt(3)
v_mfma_f32_16x16x32_bf16 v[40:43],a[200:203],a[128:131],v[40:43]
buffer_load_dwordx4 v9,s[4:7],s20 offen offset:2048 lds
s_add_u32 s20,s20,12288
s_add_u32 m0,s23,0
s_waitcnt lgkmcnt(2)
v_mfma_f32_16x16x32_bf16 v[40:43],a[204:207],a[132:135],v[40:43]
s_waitcnt lgkmcnt(1)
v_mfma_f32_16x16x32_bf16 v[40:43],a[208:211],a[136:139],v[40:43]
s_waitcnt lgkmcnt(0)
v_mfma_f32_16x16x32_bf16 v[40:43],a[212:215],a[140:143],v[40:43]
v_mfma_f32_16x16x32_bf16 v[44:47],a[216:219],a[120:123],0
v_mfma_f32_16x16x32_bf16 v[44:47],a[220:223],a[124:127],v[44:47]
v_mfma_f32_16x16x32_bf16 v[44:47],a[224:227],a[128:131],v[44:47]
v_mfma_f32_16x16x32_bf16 v[44:47],a[228:231],a[132:135],v[44:47]
v_mfma_f32_16x16x32_bf16 v[44:47],a[232:235],a[136:139],v[44:47]
v_mfma_f32_16x16x32_bf16 v[44:47],a[236:239],a[140:143],v[44:47]
s_waitcnt vmcnt(3)
ds_read_b128 a[144:147],v28 offset:12288
ds_read_b128 a[148:151],v29 offset:12288
ds_read_b128 a[152:155],v28 offset:12416
ds_read_b128 a[156:159],v29 offset:12416
ds_read_b128 a[160:163],v28 offset:12544
ds_read_b128 a[164:167],v29 offset:12544
s_waitcnt lgkmcnt(5)
v_mfma_f32_16x16x32_bf16 v[48:51],a[192:195],a[144:147],0
buffer_load_dwordx4 v7,s[8:11],s21 offen offset:0 lds
s_waitcnt lgkmcnt(4)
v_mfma_f32_16x16x32_bf16 v[48:51],a[196:199],a[148:151],v[48:51]
buffer_load_dwordx4 v8,s[8:11],s21 offen offset:1024 lds
s_waitcnt lgkmcnt(3)
v_mfma_f32_16x16x32_bf16 v[48:51],a[200:203],a[152:155],v[48:51]
buffer_load_dwordx4 v9,s[8:11],s21 offen offset:2048 lds
s_add_u32 s21,s21,12288
s_add_u32 m0,s22,24576
s_waitcnt lgkmcnt(2)
v_mfma_f32_16x16x32_bf16 v[48:51],a[204:207],a[156:159],v[48:51]
buffer_load_dwordx4 v7,s[4:7],s20 offen offset:0 lds
s_waitcnt lgkmcnt(1)
v_mfma_f32_16x16x32_bf16 v[48:51],a[208:211],a[160:163],v[48:51]
buffer_load_dwordx4 v8,s[4:7],s20 offen offset:1024 lds
s_waitcnt lgkmcnt(0)
v_mfma_f32_16x16x32_bf16 v[48:51],a[212:215],a[164:167],v[48:51]
buffer_load_dwordx4 v9,s[4:7],s20 offen offset:2048 lds
s_add_u32 s20,s20,12288
v_mfma_f32_16x16x32_bf16 v[52:55],a[216:219],a[144:147],0
s_mov_b32 s27,166723584
s_mov_b32 s42,s41
s_add_u32 s69,s69,1
v_mfma_f32_16x16x32_bf16 v[52:55],a[220:223],a[148:151],v[52:55]
s_add_u32 s48,s48,325632
s_lshr_b32 s62,s39,s69
s_and_b32 s62,s62,1
v_mfma_f32_16x16x32_bf16 v[52:55],a[224:227],a[152:155],v[52:55]
s_lshl_b32 s62,s62,1
s_add_u32 s62,s62,s49
s_and_b32 s62,s62,3
v_mfma_f32_16x16x32_bf16 v[52:55],a[228:231],a[156:159],v[52:55]
s_add_u32 s63,s69,8
s_lshr_b32 s63,s39,s63
s_and_b32 s63,s63,1
v_mfma_f32_16x16x32_bf16 v[52:55],a[232:235],a[160:163],v[52:55]
s_xor_b32 s62,s62,s63
s_mul_i32 s63,s3,3
s_lshl_b32 s64,s3,2
v_mfma_f32_16x16x32_bf16 v[52:55],a[236:239],a[164:167],v[52:55]
s_waitcnt vmcnt(6)
s_barrier
s_mov_b32 s40,1
s_add_u32 s65,s63,17
s_cmp_eq_u32 s3,0
s_cselect_b32 s65,16,s65
s_cselect_b32 s41,1,0
s_cmp_eq_u32 s62,1
s_cselect_b32 s64,s65,s64
s_cselect_b32 s40,s41,s40
s_add_u32 s65,s63,29
s_cmp_eq_u32 s62,2
s_cselect_b32 s64,s65,s64
s_cselect_b32 s40,0,s40
s_add_u32 s65,s63,41
s_cmp_eq_u32 s62,3
s_cselect_b32 s64,s65,s64
s_cselect_b32 s40,0,s40
s_mul_i32 s64,s64,6144
s_add_u32 s41,s48,s64
s_cmp_ge_u32 s69,8
s_cselect_b32 s41,166723584,s41
s_mov_b32 s28,s41
s_mov_b32 s29,s24
s_add_u32 s25,s22,12288
s_add_u32 s26,s22,24576
ds_read_b128 a[192:195],v1 offset:12288
v_max3_f32 v129,v32,v33,v34
v_max3_f32 v133,v40,v41,v42
v_max3_f32 v137,v48,v49,v50
v_max3_f32 v129,v129,v35,v36
v_max3_f32 v133,v133,v43,v44
v_max3_f32 v137,v137,v51,v52
v_max3_f32 v129,v129,v37,v38
v_max3_f32 v133,v133,v45,v46
v_max3_f32 v137,v137,v53,v54
v_max_f32 v129,v129,v39
v_max_f32 v133,v133,v47
v_max_f32 v137,v137,v55
v_mov_b32 v130,v129
v_mov_b32 v134,v133
v_mov_b32 v138,v137
v_permlane32_swap_b32 v130,v129
v_permlane32_swap_b32 v134,v133
v_permlane32_swap_b32 v138,v137
v_max_f32 v129,v129,v130
v_max_f32 v133,v133,v134
v_max_f32 v137,v137,v138
v_mov_b32 v130,v129
v_mov_b32 v134,v133
v_mov_b32 v138,v137
v_permlane16_swap_b32 v130,v129
v_permlane16_swap_b32 v134,v133
v_permlane16_swap_b32 v138,v137
v_max_f32 v129,v129,v130
s_waitcnt lgkmcnt(0)
v_mfma_f32_16x16x32_bf16 v[64:67],a[192:195],a[96:99],0
s_add_u32 m0,s23,12288
ds_read_b128 a[196:199],v2 offset:12288
buffer_load_dwordx4 v7,s[8:11],s21 offen offset:0 lds
ds_read_b128 a[200:203],v1 offset:12416
v_max_f32 v133,v133,v134
v_max_f32 v137,v137,v138
v_mul_f32_e64 v16,-s36,v129
v_mul_f32_e64 v17,-s36,v133
v_mul_f32_e64 v18,-s36,v137
v_fma_f32 v32,v32,s36,v16
v_fma_f32 v33,v33,s36,v16
v_fma_f32 v34,v34,s36,v16
v_fma_f32 v35,v35,s36,v16
v_fma_f32 v36,v36,s36,v16
v_fma_f32 v37,v37,s36,v16
v_fma_f32 v38,v38,s36,v16
v_fma_f32 v39,v39,s36,v16
v_fma_f32 v40,v40,s36,v17
v_fma_f32 v41,v41,s36,v17
v_fma_f32 v42,v42,s36,v17
v_fma_f32 v43,v43,s36,v17
v_fma_f32 v44,v44,s36,v17
v_fma_f32 v45,v45,s36,v17
v_fma_f32 v46,v46,s36,v17
v_fma_f32 v47,v47,s36,v17
v_fma_f32 v48,v48,s36,v18
v_fma_f32 v49,v49,s36,v18
v_fma_f32 v50,v50,s36,v18
v_fma_f32 v51,v51,s36,v18
v_fma_f32 v52,v52,s36,v18
v_fma_f32 v53,v53,s36,v18
v_fma_f32 v54,v54,s36,v18
v_fma_f32 v55,v55,s36,v18
v_exp_f32 v32,v32
s_waitcnt lgkmcnt(1)
v_mfma_f32_16x16x32_bf16 v[64:67],a[196:199],a[100:103],v[64:67]
buffer_load_dwordx4 v8,s[8:11],s21 offen offset:1024 lds
s_waitcnt lgkmcnt(0)
v_mfma_f32_16x16x32_bf16 v[64:67],a[200:203],a[104:107],v[64:67]
buffer_load_dwordx4 v9,s[8:11],s21 offen offset:2048 lds
ds_read_b128 a[204:207],v2 offset:12416
v_exp_f32 v33,v33
v_exp_f32 v34,v34
v_exp_f32 v35,v35
v_exp_f32 v36,v36
v_exp_f32 v37,v37
v_exp_f32 v38,v38
v_exp_f32 v39,v39
v_exp_f32 v40,v40
v_exp_f32 v41,v41
v_exp_f32 v42,v42
v_exp_f32 v43,v43
v_exp_f32 v44,v44
v_exp_f32 v45,v45
v_exp_f32 v46,v46
v_exp_f32 v47,v47
v_exp_f32 v48,v48
v_exp_f32 v49,v49
s_waitcnt lgkmcnt(0)
v_mfma_f32_16x16x32_bf16 v[64:67],a[204:207],a[108:111],v[64:67]
s_add_u32 s21,s21,12288
ds_read_b128 a[208:211],v1 offset:12544
v_exp_f32 v50,v50
v_exp_f32 v51,v51
v_exp_f32 v52,v52
v_exp_f32 v53,v53
v_exp_f32 v54,v54
v_exp_f32 v55,v55
v_cvt_pk_bf16_f32 v96,v32,v33
v_cvt_pk_bf16_f32 v97,v34,v35
v_cvt_pk_bf16_f32 v98,v36,v37
v_cvt_pk_bf16_f32 v99,v38,v39
v_cvt_pk_bf16_f32 v100,v40,v41
v_cvt_pk_bf16_f32 v101,v42,v43
v_mfma_f32_16x16x32_bf16 v[128:131],v[24:27],v[96:99],0
s_add_u32 m0,s22,0
ds_read_b128 a[212:215],v2 offset:12544
buffer_load_dwordx4 v7,s[4:7],s20 offen offset:0 lds
ds_read_b128 a[216:219],v1 offset:18432
v_cvt_pk_bf16_f32 v102,v44,v45
v_cvt_pk_bf16_f32 v103,v46,v47
v_cvt_pk_bf16_f32 v104,v48,v49
v_cvt_pk_bf16_f32 v105,v50,v51
v_mfma_f32_16x16x32_bf16 v[132:135],v[24:27],v[100:103],0
s_waitcnt lgkmcnt(2)
ds_read_b128 a[220:223],v2 offset:18432
v_cvt_pk_bf16_f32 v106,v52,v53
v_cvt_pk_bf16_f32 v107,v54,v55
v_mfma_f32_16x16x32_bf16 v[64:67],a[208:211],a[112:115],v[64:67]
buffer_load_dwordx4 v8,s[4:7],s20 offen offset:1024 lds
v_mfma_f32_16x16x32_bf16 v[136:139],v[24:27],v[104:107],0
ds_read_b128 a[224:227],v1 offset:18560
ds_read_b128 a[228:231],v2 offset:18560
ds_read_b128 a[232:235],v1 offset:18688
ds_read_b128 a[236:239],v2 offset:18688
s_waitcnt lgkmcnt(6)
v_mfma_f32_16x16x32_bf16 v[64:67],a[212:215],a[116:119],v[64:67]
v_mfma_f32_16x16x32_bf16 v[72:75],a[192:195],a[120:123],0
v_mfma_f32_16x16x32_bf16 v[72:75],a[196:199],a[124:127],v[72:75]
v_mfma_f32_16x16x32_bf16 v[72:75],a[200:203],a[128:131],v[72:75]
v_mfma_f32_16x16x32_bf16 v[72:75],a[204:207],a[132:135],v[72:75]
buffer_load_dwordx4 v9,s[4:7],s20 offen offset:2048 lds
v_mfma_f32_16x16x32_bf16 v[72:75],a[208:211],a[136:139],v[72:75]
s_add_u32 s20,s20,12288
v_mfma_f32_16x16x32_bf16 v[72:75],a[212:215],a[140:143],v[72:75]
v_fma_f32 v64,v64,s36,v16
v_fma_f32 v65,v65,s36,v16
v_mfma_f32_16x16x32_bf16 v[80:83],a[192:195],a[144:147],0
v_fma_f32 v66,v66,s36,v16
v_fma_f32 v67,v67,s36,v16
v_mfma_f32_16x16x32_bf16 v[80:83],a[196:199],a[148:151],v[80:83]
v_exp_f32 v64,v64
v_mfma_f32_16x16x32_bf16 v[80:83],a[200:203],a[152:155],v[80:83]
v_fma_f32 v72,v72,s36,v17
v_fma_f32 v73,v73,s36,v17
v_mfma_f32_16x16x32_bf16 v[80:83],a[204:207],a[156:159],v[80:83]
v_fma_f32 v74,v74,s36,v17
v_fma_f32 v75,v75,s36,v17
v_mfma_f32_16x16x32_bf16 v[80:83],a[208:211],a[160:163],v[80:83]
v_exp_f32 v65,v65
v_mfma_f32_16x16x32_bf16 v[80:83],a[212:215],a[164:167],v[80:83]
s_waitcnt lgkmcnt(0)
v_exp_f32 v66,v66
v_mfma_f32_16x16x32_bf16 v[68:71],a[216:219],a[96:99],0
v_exp_f32 v67,v67
v_mfma_f32_16x16x32_bf16 v[68:71],a[220:223],a[100:103],v[68:71]
v_exp_f32 v72,v72
v_mfma_f32_16x16x32_bf16 v[68:71],a[224:227],a[104:107],v[68:71]
v_exp_f32 v73,v73
s_waitcnt vmcnt(6)
s_barrier
v_mfma_f32_16x16x32_bf16 v[68:71],a[228:231],a[108:111],v[68:71]
ds_read_b64_tr_b16 a[240:241],v3 offset:0
ds_read_b64_tr_b16 a[242:243],v3 offset:6144
v_mfma_f32_16x16x32_bf16 v[68:71],a[232:235],a[112:115],v[68:71]
v_exp_f32 v74,v74
v_mfma_f32_16x16x32_bf16 v[68:71],a[236:239],a[116:119],v[68:71]
ds_read_b64_tr_b16 a[244:245],v4 offset:0
ds_read_b64_tr_b16 a[246:247],v4 offset:6144
v_mfma_f32_16x16x32_bf16 v[76:79],a[216:219],a[120:123],0
ds_read_b64_tr_b16 a[248:249],v5 offset:0
ds_read_b64_tr_b16 a[250:251],v5 offset:6144
v_mfma_f32_16x16x32_bf16 v[76:79],a[220:223],a[124:127],v[76:79]
v_exp_f32 v75,v75
v_mfma_f32_16x16x32_bf16 v[76:79],a[224:227],a[128:131],v[76:79]
ds_read_b64_tr_b16 a[252:253],v6 offset:0
ds_read_b64_tr_b16 a[254:255],v6 offset:6144
v_mfma_f32_16x16x32_bf16 v[76:79],a[228:231],a[132:135],v[76:79]
v_cvt_pk_bf16_f32 v112,v64,v65
v_cvt_pk_bf16_f32 v113,v66,v67
v_mfma_f32_16x16x32_bf16 v[76:79],a[232:235],a[136:139],v[76:79]
v_cvt_pk_bf16_f32 v116,v72,v73
v_cvt_pk_bf16_f32 v117,v74,v75
v_mfma_f32_16x16x32_bf16 v[76:79],a[236:239],a[140:143],v[76:79]
v_mfma_f32_16x16x32_bf16 v[84:87],a[216:219],a[144:147],0
v_mfma_f32_16x16x32_bf16 v[84:87],a[220:223],a[148:151],v[84:87]
v_mfma_f32_16x16x32_bf16 v[84:87],a[224:227],a[152:155],v[84:87]
v_mfma_f32_16x16x32_bf16 v[84:87],a[228:231],a[156:159],v[84:87]
v_mfma_f32_16x16x32_bf16 v[84:87],a[232:235],a[160:163],v[84:87]
v_mfma_f32_16x16x32_bf16 v[84:87],a[236:239],a[164:167],v[84:87]
s_waitcnt lgkmcnt(0)
v_mfma_f32_16x16x32_bf16 v[160:163],a[240:243],v[96:99],0
s_add_u32 m0,s23,24576
ds_read_b128 a[192:195],v1 offset:24576
v_fma_f32 v68,v68,s36,v16
v_mfma_f32_16x16x32_bf16 v[208:211],a[240:243],v[100:103],0
buffer_load_dwordx4 v7,s[8:11],s21 offen offset:0 lds
v_mfma_f32_16x16x32_bf16 a[0:3],a[240:243],v[104:107],0
ds_read_b64_tr_b16 a[240:241],v3 offset:128
ds_read_b64_tr_b16 a[242:243],v3 offset:6272
v_mfma_f32_16x16x32_bf16 v[164:167],a[244:247],v[96:99],0
ds_read_b128 a[196:199],v2 offset:24576
v_fma_f32 v69,v69,s36,v16
v_mfma_f32_16x16x32_bf16 v[212:215],a[244:247],v[100:103],0
ds_read_b128 a[200:203],v1 offset:24704
v_fma_f32 v70,v70,s36,v16
v_mfma_f32_16x16x32_bf16 a[4:7],a[244:247],v[104:107],0
ds_read_b64_tr_b16 a[244:245],v4 offset:128
ds_read_b64_tr_b16 a[246:247],v4 offset:6272
v_mfma_f32_16x16x32_bf16 v[168:171],a[248:251],v[96:99],0
ds_read_b128 a[204:207],v2 offset:24704
v_fma_f32 v71,v71,s36,v16
v_mfma_f32_16x16x32_bf16 v[216:219],a[248:251],v[100:103],0
buffer_load_dwordx4 v8,s[8:11],s21 offen offset:1024 lds
v_mfma_f32_16x16x32_bf16 a[8:11],a[248:251],v[104:107],0
ds_read_b64_tr_b16 a[248:249],v5 offset:128
ds_read_b64_tr_b16 a[250:251],v5 offset:6272
v_mfma_f32_16x16x32_bf16 v[172:175],a[252:255],v[96:99],0
ds_read_b128 a[208:211],v1 offset:24832
v_fma_f32 v76,v76,s36,v17
v_mfma_f32_16x16x32_bf16 v[220:223],a[252:255],v[100:103],0
ds_read_b128 a[212:215],v2 offset:24832
v_fma_f32 v77,v77,s36,v17
v_mfma_f32_16x16x32_bf16 a[12:15],a[252:255],v[104:107],0
s_waitcnt lgkmcnt(8)
ds_read_b64_tr_b16 a[252:253],v6 offset:128
ds_read_b64_tr_b16 a[254:255],v6 offset:6272
v_mfma_f32_16x16x32_bf16 v[176:179],a[240:243],v[96:99],0
buffer_load_dwordx4 v9,s[8:11],s21 offen offset:2048 lds
v_mfma_f32_16x16x32_bf16 v[224:227],a[240:243],v[100:103],0
s_add_u32 s21,s21,12288
ds_read_b128 a[216:219],v1 offset:30720
v_fma_f32 v78,v78,s36,v17
v_mfma_f32_16x16x32_bf16 a[16:19],a[240:243],v[104:107],0
s_add_u32 m0,s22,12288
ds_read_b64_tr_b16 a[240:241],v3 offset:256
ds_read_b64_tr_b16 a[242:243],v3 offset:6400
s_waitcnt lgkmcnt(9)
v_mfma_f32_16x16x32_bf16 v[180:183],a[244:247],v[96:99],0
ds_read_b128 a[220:223],v2 offset:30720
v_fma_f32 v79,v79,s36,v17
v_mfma_f32_16x16x32_bf16 v[228:231],a[244:247],v[100:103],0
ds_read_b128 a[224:227],v1 offset:30848
v_fma_f32 v80,v80,s36,v18
v_mfma_f32_16x16x32_bf16 a[20:23],a[244:247],v[104:107],0
s_waitcnt lgkmcnt(8)
ds_read_b64_tr_b16 a[244:245],v4 offset:256
ds_read_b64_tr_b16 a[246:247],v4 offset:6400
v_mfma_f32_16x16x32_bf16 v[184:187],a[248:251],v[96:99],0
buffer_load_dwordx4 v7,s[4:7],s20 offen offset:0 lds
v_mfma_f32_16x16x32_bf16 v[232:235],a[248:251],v[100:103],0
ds_read_b128 a[228:231],v2 offset:30848
v_fma_f32 v81,v81,s36,v18
v_mfma_f32_16x16x32_bf16 a[24:27],a[248:251],v[104:107],0
s_waitcnt lgkmcnt(8)
ds_read_b64_tr_b16 a[248:249],v5 offset:256
ds_read_b64_tr_b16 a[250:251],v5 offset:6400
v_mfma_f32_16x16x32_bf16 v[188:191],a[252:255],v[96:99],0
ds_read_b128 a[232:235],v1 offset:30976
v_fma_f32 v82,v82,s36,v18
v_mfma_f32_16x16x32_bf16 v[236:239],a[252:255],v[100:103],0
ds_read_b128 a[236:239],v2 offset:30976
v_fma_f32 v83,v83,s36,v18
v_mfma_f32_16x16x32_bf16 a[28:31],a[252:255],v[104:107],0
s_waitcnt lgkmcnt(8)
ds_read_b64_tr_b16 a[252:253],v6 offset:256
ds_read_b64_tr_b16 a[254:255],v6 offset:6400
v_mfma_f32_16x16x32_bf16 v[192:195],a[240:243],v[96:99],0
buffer_load_dwordx4 v8,s[4:7],s20 offen offset:1024 lds
v_mfma_f32_16x16x32_bf16 v[240:243],a[240:243],v[100:103],0
v_fma_f32 v84,v84,s36,v18
v_fma_f32 v85,v85,s36,v18
v_mfma_f32_16x16x32_bf16 a[32:35],a[240:243],v[104:107],0
s_waitcnt lgkmcnt(7)
v_fma_f32 v86,v86,s36,v18
v_fma_f32 v87,v87,s36,v18
v_mfma_f32_16x16x32_bf16 v[196:199],a[244:247],v[96:99],0
v_exp_f32 v68,v68
v_mfma_f32_16x16x32_bf16 v[244:247],a[244:247],v[100:103],0
v_exp_f32 v69,v69
v_mfma_f32_16x16x32_bf16 a[36:39],a[244:247],v[104:107],0
s_waitcnt lgkmcnt(3)
v_exp_f32 v70,v70
v_mfma_f32_16x16x32_bf16 v[200:203],a[248:251],v[96:99],0
buffer_load_dwordx4 v9,s[4:7],s20 offen offset:2048 lds
v_mfma_f32_16x16x32_bf16 v[248:251],a[248:251],v[100:103],0
s_add_u32 s20,s20,12288
v_exp_f32 v71,v71
v_mfma_f32_16x16x32_bf16 a[40:43],a[248:251],v[104:107],0
s_waitcnt lgkmcnt(0)
v_exp_f32 v76,v76
v_mfma_f32_16x16x32_bf16 v[204:207],a[252:255],v[96:99],0
v_exp_f32 v77,v77
v_mfma_f32_16x16x32_bf16 v[252:255],a[252:255],v[100:103],0
v_exp_f32 v78,v78
v_mfma_f32_16x16x32_bf16 a[44:47],a[252:255],v[104:107],0
v_exp_f32 v79,v79
v_mfma_f32_16x16x32_bf16 v[32:35],a[192:195],a[96:99],0
v_exp_f32 v80,v80
v_mfma_f32_16x16x32_bf16 v[32:35],a[196:199],a[100:103],v[32:35]
v_exp_f32 v81,v81
v_mfma_f32_16x16x32_bf16 v[32:35],a[200:203],a[104:107],v[32:35]
v_exp_f32 v82,v82
v_mfma_f32_16x16x32_bf16 v[32:35],a[204:207],a[108:111],v[32:35]
v_exp_f32 v83,v83
v_mfma_f32_16x16x32_bf16 v[32:35],a[208:211],a[112:115],v[32:35]
v_exp_f32 v84,v84
v_mfma_f32_16x16x32_bf16 v[32:35],a[212:215],a[116:119],v[32:35]
v_exp_f32 v85,v85
v_mfma_f32_16x16x32_bf16 v[40:43],a[192:195],a[120:123],0
v_exp_f32 v86,v86
v_mfma_f32_16x16x32_bf16 v[40:43],a[196:199],a[124:127],v[40:43]
v_exp_f32 v87,v87
v_mfma_f32_16x16x32_bf16 v[40:43],a[200:203],a[128:131],v[40:43]
v_cvt_pk_bf16_f32 v114,v68,v69
v_cvt_pk_bf16_f32 v115,v70,v71
v_mfma_f32_16x16x32_bf16 v[40:43],a[204:207],a[132:135],v[40:43]
v_cvt_pk_bf16_f32 v118,v76,v77
v_cvt_pk_bf16_f32 v119,v78,v79
v_mfma_f32_16x16x32_bf16 v[128:131],v[24:27],v[112:115],v[128:131]
v_cvt_pk_bf16_f32 v120,v80,v81
v_cvt_pk_bf16_f32 v121,v82,v83
v_mfma_f32_16x16x32_bf16 v[132:135],v[24:27],v[116:119],v[132:135]
v_cvt_pk_bf16_f32 v122,v84,v85
v_cvt_pk_bf16_f32 v123,v86,v87
v_mfma_f32_16x16x32_bf16 v[40:43],a[208:211],a[136:139],v[40:43]
v_fma_f32 v32,v32,s36,v16
v_fma_f32 v33,v33,s36,v16
v_mfma_f32_16x16x32_bf16 v[136:139],v[24:27],v[120:123],v[136:139]
v_fma_f32 v34,v34,s36,v16
v_fma_f32 v35,v35,s36,v16
v_mfma_f32_16x16x32_bf16 v[40:43],a[212:215],a[140:143],v[40:43]
v_exp_f32 v32,v32
v_mfma_f32_16x16x32_bf16 v[48:51],a[192:195],a[144:147],0
v_exp_f32 v33,v33
v_mfma_f32_16x16x32_bf16 v[48:51],a[196:199],a[148:151],v[48:51]
v_exp_f32 v34,v34
v_mfma_f32_16x16x32_bf16 v[48:51],a[200:203],a[152:155],v[48:51]
v_exp_f32 v35,v35
v_mfma_f32_16x16x32_bf16 v[48:51],a[204:207],a[156:159],v[48:51]
v_fma_f32 v40,v40,s36,v17
v_fma_f32 v41,v41,s36,v17
v_mfma_f32_16x16x32_bf16 v[48:51],a[208:211],a[160:163],v[48:51]
v_fma_f32 v42,v42,s36,v17
v_fma_f32 v43,v43,s36,v17
v_mfma_f32_16x16x32_bf16 v[48:51],a[212:215],a[164:167],v[48:51]
v_exp_f32 v40,v40
v_mfma_f32_16x16x32_bf16 v[36:39],a[216:219],a[96:99],0
v_exp_f32 v41,v41
v_mfma_f32_16x16x32_bf16 v[36:39],a[220:223],a[100:103],v[36:39]
v_exp_f32 v42,v42
v_mfma_f32_16x16x32_bf16 v[36:39],a[224:227],a[104:107],v[36:39]
v_exp_f32 v43,v43
v_mfma_f32_16x16x32_bf16 v[36:39],a[228:231],a[108:111],v[36:39]
v_cvt_pk_bf16_f32 v96,v32,v33
v_cvt_pk_bf16_f32 v97,v34,v35
s_waitcnt vmcnt(6)
v_mfma_f32_16x16x32_bf16 v[36:39],a[232:235],a[112:115],v[36:39]
s_barrier
v_mfma_f32_16x16x32_bf16 v[36:39],a[236:239],a[116:119],v[36:39]
ds_read_b64_tr_b16 a[240:241],v3 offset:12288
ds_read_b64_tr_b16 a[242:243],v3 offset:18432
v_mfma_f32_16x16x32_bf16 v[44:47],a[216:219],a[120:123],0
v_cvt_pk_bf16_f32 v100,v40,v41
v_cvt_pk_bf16_f32 v101,v42,v43
v_mfma_f32_16x16x32_bf16 v[44:47],a[220:223],a[124:127],v[44:47]
ds_read_b64_tr_b16 a[244:245],v4 offset:12288
ds_read_b64_tr_b16 a[246:247],v4 offset:18432
v_mfma_f32_16x16x32_bf16 v[44:47],a[224:227],a[128:131],v[44:47]
ds_read_b64_tr_b16 a[248:249],v5 offset:12288
ds_read_b64_tr_b16 a[250:251],v5 offset:18432
v_mfma_f32_16x16x32_bf16 v[44:47],a[228:231],a[132:135],v[44:47]
v_mfma_f32_16x16x32_bf16 v[44:47],a[232:235],a[136:139],v[44:47]
ds_read_b64_tr_b16 a[252:253],v6 offset:12288
ds_read_b64_tr_b16 a[254:255],v6 offset:18432
v_mfma_f32_16x16x32_bf16 v[44:47],a[236:239],a[140:143],v[44:47]
v_mfma_f32_16x16x32_bf16 v[52:55],a[216:219],a[144:147],0
v_mfma_f32_16x16x32_bf16 v[52:55],a[220:223],a[148:151],v[52:55]
v_mfma_f32_16x16x32_bf16 v[52:55],a[224:227],a[152:155],v[52:55]
v_mfma_f32_16x16x32_bf16 v[52:55],a[228:231],a[156:159],v[52:55]
v_mfma_f32_16x16x32_bf16 v[52:55],a[232:235],a[160:163],v[52:55]
v_mfma_f32_16x16x32_bf16 v[52:55],a[236:239],a[164:167],v[52:55]
s_waitcnt lgkmcnt(2)
v_mfma_f32_16x16x32_bf16 v[160:163],a[240:243],v[112:115],v[160:163]
s_add_u32 m0,s23,0
ds_read_b128 a[192:195],v1 offset:0
v_fma_f32 v36,v36,s36,v16
v_mfma_f32_16x16x32_bf16 v[208:211],a[240:243],v[116:119],v[208:211]
buffer_load_dwordx4 v7,s[8:11],s21 offen offset:0 lds
v_mfma_f32_16x16x32_bf16 a[0:3],a[240:243],v[120:123],a[0:3]
ds_read_b64_tr_b16 a[240:241],v3 offset:12416
ds_read_b64_tr_b16 a[242:243],v3 offset:18560
v_mfma_f32_16x16x32_bf16 v[164:167],a[244:247],v[112:115],v[164:167]
ds_read_b128 a[196:199],v2 offset:0
v_fma_f32 v37,v37,s36,v16
v_mfma_f32_16x16x32_bf16 v[212:215],a[244:247],v[116:119],v[212:215]
ds_read_b128 a[200:203],v1 offset:128
v_fma_f32 v38,v38,s36,v16
v_mfma_f32_16x16x32_bf16 a[4:7],a[244:247],v[120:123],a[4:7]
ds_read_b64_tr_b16 a[244:245],v4 offset:12416
ds_read_b64_tr_b16 a[246:247],v4 offset:18560
v_mfma_f32_16x16x32_bf16 v[168:171],a[248:251],v[112:115],v[168:171]
ds_read_b128 a[204:207],v2 offset:128
v_fma_f32 v39,v39,s36,v16
v_mfma_f32_16x16x32_bf16 v[216:219],a[248:251],v[116:119],v[216:219]
buffer_load_dwordx4 v8,s[8:11],s21 offen offset:1024 lds
v_mfma_f32_16x16x32_bf16 a[8:11],a[248:251],v[120:123],a[8:11]
s_waitcnt lgkmcnt(7)
ds_read_b64_tr_b16 a[248:249],v5 offset:12416
ds_read_b64_tr_b16 a[250:251],v5 offset:18560
v_mfma_f32_16x16x32_bf16 v[172:175],a[252:255],v[112:115],v[172:175]
ds_read_b128 a[208:211],v1 offset:256
v_fma_f32 v44,v44,s36,v17
v_mfma_f32_16x16x32_bf16 v[220:223],a[252:255],v[116:119],v[220:223]
ds_read_b128 a[212:215],v2 offset:256
v_fma_f32 v45,v45,s36,v17
v_mfma_f32_16x16x32_bf16 a[12:15],a[252:255],v[120:123],a[12:15]
s_waitcnt lgkmcnt(8)
ds_read_b64_tr_b16 a[252:253],v6 offset:12416
ds_read_b64_tr_b16 a[254:255],v6 offset:18560
v_mfma_f32_16x16x32_bf16 v[176:179],a[240:243],v[112:115],v[176:179]
buffer_load_dwordx4 v9,s[8:11],s21 offen offset:2048 lds
v_mfma_f32_16x16x32_bf16 v[224:227],a[240:243],v[116:119],v[224:227]
s_add_u32 s21,s21,12288
ds_read_b128 a[216:219],v1 offset:6144
v_fma_f32 v46,v46,s36,v17
v_mfma_f32_16x16x32_bf16 a[16:19],a[240:243],v[120:123],a[16:19]
s_add_u32 m0,s22,24576
ds_read_b64_tr_b16 a[240:241],v3 offset:12544
ds_read_b64_tr_b16 a[242:243],v3 offset:18688
s_waitcnt lgkmcnt(9)
v_mfma_f32_16x16x32_bf16 v[180:183],a[244:247],v[112:115],v[180:183]
ds_read_b128 a[220:223],v2 offset:6144
v_fma_f32 v47,v47,s36,v17
v_mfma_f32_16x16x32_bf16 v[228:231],a[244:247],v[116:119],v[228:231]
ds_read_b128 a[224:227],v1 offset:6272
v_fma_f32 v48,v48,s36,v18
v_mfma_f32_16x16x32_bf16 a[20:23],a[244:247],v[120:123],a[20:23]
s_waitcnt lgkmcnt(8)
ds_read_b64_tr_b16 a[244:245],v4 offset:12544
ds_read_b64_tr_b16 a[246:247],v4 offset:18688
v_mfma_f32_16x16x32_bf16 v[184:187],a[248:251],v[112:115],v[184:187]
buffer_load_dwordx4 v7,s[4:7],s20 offen offset:0 lds
v_mfma_f32_16x16x32_bf16 v[232:235],a[248:251],v[116:119],v[232:235]
ds_read_b128 a[228:231],v2 offset:6272
v_fma_f32 v49,v49,s36,v18
v_mfma_f32_16x16x32_bf16 a[24:27],a[248:251],v[120:123],a[24:27]
s_waitcnt lgkmcnt(8)
ds_read_b64_tr_b16 a[248:249],v5 offset:12544
ds_read_b64_tr_b16 a[250:251],v5 offset:18688
v_mfma_f32_16x16x32_bf16 v[188:191],a[252:255],v[112:115],v[188:191]
ds_read_b128 a[232:235],v1 offset:6400
v_fma_f32 v50,v50,s36,v18
v_mfma_f32_16x16x32_bf16 v[236:239],a[252:255],v[116:119],v[236:239]
ds_read_b128 a[236:239],v2 offset:6400
v_fma_f32 v51,v51,s36,v18
v_mfma_f32_16x16x32_bf16 a[28:31],a[252:255],v[120:123],a[28:31]
s_waitcnt lgkmcnt(8)
ds_read_b64_tr_b16 a[252:253],v6 offset:12544
ds_read_b64_tr_b16 a[254:255],v6 offset:18688
v_mfma_f32_16x16x32_bf16 v[192:195],a[240:243],v[112:115],v[192:195]
buffer_load_dwordx4 v8,s[4:7],s20 offen offset:1024 lds
v_mfma_f32_16x16x32_bf16 v[240:243],a[240:243],v[116:119],v[240:243]
v_fma_f32 v52,v52,s36,v18
v_fma_f32 v53,v53,s36,v18
v_mfma_f32_16x16x32_bf16 a[32:35],a[240:243],v[120:123],a[32:35]
s_waitcnt lgkmcnt(7)
v_fma_f32 v54,v54,s36,v18
v_fma_f32 v55,v55,s36,v18
v_mfma_f32_16x16x32_bf16 v[196:199],a[244:247],v[112:115],v[196:199]
v_exp_f32 v36,v36
v_mfma_f32_16x16x32_bf16 v[244:247],a[244:247],v[116:119],v[244:247]
v_exp_f32 v37,v37
v_mfma_f32_16x16x32_bf16 a[36:39],a[244:247],v[120:123],a[36:39]
s_waitcnt lgkmcnt(3)
v_exp_f32 v38,v38
v_mfma_f32_16x16x32_bf16 v[200:203],a[248:251],v[112:115],v[200:203]
buffer_load_dwordx4 v9,s[4:7],s20 offen offset:2048 lds
v_mfma_f32_16x16x32_bf16 v[248:251],a[248:251],v[116:119],v[248:251]
s_add_u32 s20,s20,12288
v_exp_f32 v39,v39
v_mfma_f32_16x16x32_bf16 a[40:43],a[248:251],v[120:123],a[40:43]
s_waitcnt lgkmcnt(0)
v_exp_f32 v44,v44
v_mfma_f32_16x16x32_bf16 v[204:207],a[252:255],v[112:115],v[204:207]
v_exp_f32 v45,v45
v_mfma_f32_16x16x32_bf16 v[252:255],a[252:255],v[116:119],v[252:255]
v_exp_f32 v46,v46
v_mfma_f32_16x16x32_bf16 a[44:47],a[252:255],v[120:123],a[44:47]
v_exp_f32 v47,v47
v_mfma_f32_16x16x32_bf16 v[64:67],a[192:195],a[96:99],0
v_exp_f32 v48,v48
v_mfma_f32_16x16x32_bf16 v[64:67],a[196:199],a[100:103],v[64:67]
v_exp_f32 v49,v49
v_mfma_f32_16x16x32_bf16 v[64:67],a[200:203],a[104:107],v[64:67]
v_exp_f32 v50,v50
v_mfma_f32_16x16x32_bf16 v[64:67],a[204:207],a[108:111],v[64:67]
v_exp_f32 v51,v51
v_mfma_f32_16x16x32_bf16 v[64:67],a[208:211],a[112:115],v[64:67]
v_exp_f32 v52,v52
v_mfma_f32_16x16x32_bf16 v[64:67],a[212:215],a[116:119],v[64:67]
v_exp_f32 v53,v53
v_mfma_f32_16x16x32_bf16 v[72:75],a[192:195],a[120:123],0
v_exp_f32 v54,v54
v_mfma_f32_16x16x32_bf16 v[72:75],a[196:199],a[124:127],v[72:75]
v_exp_f32 v55,v55
v_mfma_f32_16x16x32_bf16 v[72:75],a[200:203],a[128:131],v[72:75]
v_cvt_pk_bf16_f32 v98,v36,v37
v_cvt_pk_bf16_f32 v99,v38,v39
v_mfma_f32_16x16x32_bf16 v[72:75],a[204:207],a[132:135],v[72:75]
v_cvt_pk_bf16_f32 v102,v44,v45
v_cvt_pk_bf16_f32 v103,v46,v47
v_mfma_f32_16x16x32_bf16 v[128:131],v[24:27],v[96:99],v[128:131]
v_cvt_pk_bf16_f32 v104,v48,v49
v_cvt_pk_bf16_f32 v105,v50,v51
v_mfma_f32_16x16x32_bf16 v[132:135],v[24:27],v[100:103],v[132:135]
v_cvt_pk_bf16_f32 v106,v52,v53
v_cvt_pk_bf16_f32 v107,v54,v55
v_mfma_f32_16x16x32_bf16 v[72:75],a[208:211],a[136:139],v[72:75]
v_fma_f32 v64,v64,s36,v16
v_fma_f32 v65,v65,s36,v16
v_mfma_f32_16x16x32_bf16 v[136:139],v[24:27],v[104:107],v[136:139]
v_fma_f32 v66,v66,s36,v16
v_fma_f32 v67,v67,s36,v16
v_mfma_f32_16x16x32_bf16 v[72:75],a[212:215],a[140:143],v[72:75]
v_exp_f32 v64,v64
v_mfma_f32_16x16x32_bf16 v[80:83],a[192:195],a[144:147],0
v_exp_f32 v65,v65
v_mfma_f32_16x16x32_bf16 v[80:83],a[196:199],a[148:151],v[80:83]
v_exp_f32 v66,v66
v_mfma_f32_16x16x32_bf16 v[80:83],a[200:203],a[152:155],v[80:83]
v_exp_f32 v67,v67
v_mfma_f32_16x16x32_bf16 v[80:83],a[204:207],a[156:159],v[80:83]
v_fma_f32 v72,v72,s36,v17
v_fma_f32 v73,v73,s36,v17
v_mfma_f32_16x16x32_bf16 v[80:83],a[208:211],a[160:163],v[80:83]
v_fma_f32 v74,v74,s36,v17
v_fma_f32 v75,v75,s36,v17
v_mfma_f32_16x16x32_bf16 v[80:83],a[212:215],a[164:167],v[80:83]
v_exp_f32 v72,v72
v_mfma_f32_16x16x32_bf16 v[68:71],a[216:219],a[96:99],0
v_exp_f32 v73,v73
v_mfma_f32_16x16x32_bf16 v[68:71],a[220:223],a[100:103],v[68:71]
v_exp_f32 v74,v74
v_mfma_f32_16x16x32_bf16 v[68:71],a[224:227],a[104:107],v[68:71]
v_exp_f32 v75,v75
v_mfma_f32_16x16x32_bf16 v[68:71],a[228:231],a[108:111],v[68:71]
v_cvt_pk_bf16_f32 v112,v64,v65
v_cvt_pk_bf16_f32 v113,v66,v67
s_waitcnt vmcnt(6)
v_mfma_f32_16x16x32_bf16 v[68:71],a[232:235],a[112:115],v[68:71]
s_barrier
v_mfma_f32_16x16x32_bf16 v[68:71],a[236:239],a[116:119],v[68:71]
ds_read_b64_tr_b16 a[240:241],v3 offset:24576
ds_read_b64_tr_b16 a[242:243],v3 offset:30720
v_mfma_f32_16x16x32_bf16 v[76:79],a[216:219],a[120:123],0
v_cvt_pk_bf16_f32 v116,v72,v73
v_cvt_pk_bf16_f32 v117,v74,v75
v_mfma_f32_16x16x32_bf16 v[76:79],a[220:223],a[124:127],v[76:79]
ds_read_b64_tr_b16 a[244:245],v4 offset:24576
ds_read_b64_tr_b16 a[246:247],v4 offset:30720
v_mfma_f32_16x16x32_bf16 v[76:79],a[224:227],a[128:131],v[76:79]
ds_read_b64_tr_b16 a[248:249],v5 offset:24576
ds_read_b64_tr_b16 a[250:251],v5 offset:30720
v_mfma_f32_16x16x32_bf16 v[76:79],a[228:231],a[132:135],v[76:79]
v_mfma_f32_16x16x32_bf16 v[76:79],a[232:235],a[136:139],v[76:79]
ds_read_b64_tr_b16 a[252:253],v6 offset:24576
ds_read_b64_tr_b16 a[254:255],v6 offset:30720
v_mfma_f32_16x16x32_bf16 v[76:79],a[236:239],a[140:143],v[76:79]
v_mfma_f32_16x16x32_bf16 v[84:87],a[216:219],a[144:147],0
v_mfma_f32_16x16x32_bf16 v[84:87],a[220:223],a[148:151],v[84:87]
v_mfma_f32_16x16x32_bf16 v[84:87],a[224:227],a[152:155],v[84:87]
v_mfma_f32_16x16x32_bf16 v[84:87],a[228:231],a[156:159],v[84:87]
v_mfma_f32_16x16x32_bf16 v[84:87],a[232:235],a[160:163],v[84:87]
v_mfma_f32_16x16x32_bf16 v[84:87],a[236:239],a[164:167],v[84:87]
s_mov_b32 s38,0
s_branch L_loop3
L_loop4:
s_bitcmp1_b32 s3,1
s_cbranch_scc1 L_loop4w1
.p2align 6
L_loop4w0:
s_waitcnt lgkmcnt(4)
v_mfma_f32_16x16x32_bf16 v[160:163],a[240:243],v[96:99],v[160:163]
s_add_u32 m0,s23,12288
ds_read_b128 a[192:195],v1 offset:12288
v_fma_f32 v68,v68,s36,v16
v_mfma_f32_16x16x32_bf16 v[208:211],a[240:243],v[100:103],v[208:211]
buffer_load_dwordx4 v7,s[8:11],s21 offen offset:0 lds
v_mfma_f32_16x16x32_bf16 a[0:3],a[240:243],v[104:107],a[0:3]
ds_read_b128 a[196:199],v2 offset:12288
v_fma_f32 v69,v69,s36,v16
v_mfma_f32_16x16x32_bf16 a[48:51],a[240:243],v[108:111],a[48:51]
ds_read_b64_tr_b16 a[240:241],v3 offset:24704
ds_read_b64_tr_b16 a[242:243],v3 offset:30848
v_mfma_f32_16x16x32_bf16 v[164:167],a[244:247],v[96:99],v[164:167]
ds_read_b128 a[200:203],v1 offset:12416
v_fma_f32 v70,v70,s36,v16
v_mfma_f32_16x16x32_bf16 v[212:215],a[244:247],v[100:103],v[212:215]
ds_read_b128 a[204:207],v2 offset:12416
v_fma_f32 v71,v71,s36,v16
v_mfma_f32_16x16x32_bf16 a[4:7],a[244:247],v[104:107],a[4:7]
ds_read_b128 a[208:211],v1 offset:12544
v_fma_f32 v76,v76,s36,v17
v_mfma_f32_16x16x32_bf16 a[52:55],a[244:247],v[108:111],a[52:55]
s_waitcnt lgkmcnt(7)
ds_read_b64_tr_b16 a[244:245],v4 offset:24704
ds_read_b64_tr_b16 a[246:247],v4 offset:30848
v_mfma_f32_16x16x32_bf16 v[168:171],a[248:251],v[96:99],v[168:171]
ds_read_b128 a[212:215],v2 offset:12544
v_fma_f32 v77,v77,s36,v17
v_mfma_f32_16x16x32_bf16 v[216:219],a[248:251],v[100:103],v[216:219]
buffer_load_dwordx4 v8,s[8:11],s21 offen offset:1024 lds
v_mfma_f32_16x16x32_bf16 a[8:11],a[248:251],v[104:107],a[8:11]
ds_read_b128 a[216:219],v1 offset:18432
v_fma_f32 v78,v78,s36,v17
v_mfma_f32_16x16x32_bf16 a[56:59],a[248:251],v[108:111],a[56:59]
ds_read_b64_tr_b16 a[248:249],v5 offset:24704
ds_read_b64_tr_b16 a[250:251],v5 offset:30848
v_mfma_f32_16x16x32_bf16 v[172:175],a[252:255],v[96:99],v[172:175]
ds_read_b128 a[220:223],v2 offset:18432
v_fma_f32 v79,v79,s36,v17
v_mfma_f32_16x16x32_bf16 v[220:223],a[252:255],v[100:103],v[220:223]
ds_read_b128 a[224:227],v1 offset:18560
v_fma_f32 v80,v80,s36,v18
v_mfma_f32_16x16x32_bf16 a[12:15],a[252:255],v[104:107],a[12:15]
ds_read_b128 a[228:231],v2 offset:18560
v_fma_f32 v81,v81,s36,v18
v_mfma_f32_16x16x32_bf16 a[60:63],a[252:255],v[108:111],a[60:63]
s_waitcnt lgkmcnt(7)
ds_read_b64_tr_b16 a[252:253],v6 offset:24704
ds_read_b64_tr_b16 a[254:255],v6 offset:30848
v_mfma_f32_16x16x32_bf16 v[176:179],a[240:243],v[96:99],v[176:179]
ds_read_b128 a[232:235],v1 offset:18688
v_fma_f32 v82,v82,s36,v18
v_mfma_f32_16x16x32_bf16 v[224:227],a[240:243],v[100:103],v[224:227]
buffer_load_dwordx4 v9,s[8:11],s21 offen offset:2048 lds
v_mfma_f32_16x16x32_bf16 a[16:19],a[240:243],v[104:107],a[16:19]
s_add_u32 s21,s21,12288
ds_read_b128 a[236:239],v2 offset:18688
v_fma_f32 v83,v83,s36,v18
v_mfma_f32_16x16x32_bf16 a[64:67],a[240:243],v[108:111],a[64:67]
s_add_u32 m0,s22,0
ds_read_b64_tr_b16 a[240:241],v3 offset:24832
ds_read_b64_tr_b16 a[242:243],v3 offset:30976
v_mfma_f32_16x16x32_bf16 v[180:183],a[244:247],v[96:99],v[180:183]
v_fma_f32 v84,v84,s36,v18
v_fma_f32 v85,v85,s36,v18
v_mfma_f32_16x16x32_bf16 v[228:231],a[244:247],v[100:103],v[228:231]
v_fma_f32 v86,v86,s36,v18
v_fma_f32 v87,v87,s36,v18
v_mfma_f32_16x16x32_bf16 a[20:23],a[244:247],v[104:107],a[20:23]
v_fma_f32 v88,v88,s36,v19
v_fma_f32 v89,v89,s36,v19
v_mfma_f32_16x16x32_bf16 a[68:71],a[244:247],v[108:111],a[68:71]
s_waitcnt lgkmcnt(4)
ds_read_b64_tr_b16 a[244:245],v4 offset:24832
ds_read_b64_tr_b16 a[246:247],v4 offset:30976
v_mfma_f32_16x16x32_bf16 v[184:187],a[248:251],v[96:99],v[184:187]
buffer_load_dwordx4 v7,s[4:7],s20 offen offset:0 lds
v_mfma_f32_16x16x32_bf16 v[232:235],a[248:251],v[100:103],v[232:235]
v_fma_f32 v90,v90,s36,v19
v_fma_f32 v91,v91,s36,v19
v_mfma_f32_16x16x32_bf16 a[24:27],a[248:251],v[104:107],a[24:27]
v_fma_f32 v92,v92,s36,v19
v_fma_f32 v93,v93,s36,v19
v_mfma_f32_16x16x32_bf16 a[72:75],a[248:251],v[108:111],a[72:75]
ds_read_b64_tr_b16 a[248:249],v5 offset:24832
ds_read_b64_tr_b16 a[250:251],v5 offset:30976
v_mfma_f32_16x16x32_bf16 v[188:191],a[252:255],v[96:99],v[188:191]
v_fma_f32 v94,v94,s36,v19
v_fma_f32 v95,v95,s36,v19
v_mfma_f32_16x16x32_bf16 v[236:239],a[252:255],v[100:103],v[236:239]
v_exp_f32 v68,v68
v_mfma_f32_16x16x32_bf16 a[28:31],a[252:255],v[104:107],a[28:31]
v_exp_f32 v69,v69
v_mfma_f32_16x16x32_bf16 a[76:79],a[252:255],v[108:111],a[76:79]
s_waitcnt lgkmcnt(2)
ds_read_b64_tr_b16 a[252:253],v6 offset:24832
ds_read_b64_tr_b16 a[254:255],v6 offset:30976
v_mfma_f32_16x16x32_bf16 v[192:195],a[240:243],v[96:99],v[192:195]
buffer_load_dwordx4 v8,s[4:7],s20 offen offset:1024 lds
v_mfma_f32_16x16x32_bf16 v[240:243],a[240:243],v[100:103],v[240:243]
v_exp_f32 v70,v70
v_mfma_f32_16x16x32_bf16 a[32:35],a[240:243],v[104:107],a[32:35]
v_exp_f32 v71,v71
v_mfma_f32_16x16x32_bf16 a[80:83],a[240:243],v[108:111],a[80:83]
v_exp_f32 v76,v76
v_mfma_f32_16x16x32_bf16 v[196:199],a[244:247],v[96:99],v[196:199]
v_exp_f32 v77,v77
v_mfma_f32_16x16x32_bf16 v[244:247],a[244:247],v[100:103],v[244:247]
ds_read_b128 v[152:155],v11 offset:0
v_cvt_pk_bf16_f32 v114,v68,v69
v_mfma_f32_16x16x32_bf16 a[36:39],a[244:247],v[104:107],a[36:39]
v_exp_f32 v78,v78
v_mfma_f32_16x16x32_bf16 a[84:87],a[244:247],v[108:111],a[84:87]
s_waitcnt lgkmcnt(1)
v_exp_f32 v79,v79
v_mfma_f32_16x16x32_bf16 v[200:203],a[248:251],v[96:99],v[200:203]
buffer_load_dwordx4 v9,s[4:7],s20 offen offset:2048 lds
v_mfma_f32_16x16x32_bf16 v[248:251],a[248:251],v[100:103],v[248:251]
s_add_u32 s20,s20,12288
v_exp_f32 v80,v80
v_mfma_f32_16x16x32_bf16 a[40:43],a[248:251],v[104:107],a[40:43]
v_exp_f32 v81,v81
v_mfma_f32_16x16x32_bf16 a[88:91],a[248:251],v[108:111],a[88:91]
v_exp_f32 v82,v82
v_mfma_f32_16x16x32_bf16 v[204:207],a[252:255],v[96:99],v[204:207]
v_exp_f32 v83,v83
v_mfma_f32_16x16x32_bf16 v[252:255],a[252:255],v[100:103],v[252:255]
v_exp_f32 v84,v84
v_mfma_f32_16x16x32_bf16 a[44:47],a[252:255],v[104:107],a[44:47]
v_exp_f32 v85,v85
v_mfma_f32_16x16x32_bf16 a[92:95],a[252:255],v[108:111],a[92:95]
v_exp_f32 v86,v86
v_mfma_f32_16x16x32_bf16 v[32:35],a[192:195],a[96:99],0
ds_read_b128 v[156:159],v23 offset:0
v_mfma_f32_16x16x32_bf16 v[32:35],a[196:199],a[100:103],v[32:35]
v_exp_f32 v87,v87
v_mfma_f32_16x16x32_bf16 v[32:35],a[200:203],a[104:107],v[32:35]
v_exp_f32 v88,v88
v_mfma_f32_16x16x32_bf16 v[32:35],a[204:207],a[108:111],v[32:35]
v_exp_f32 v89,v89
v_mfma_f32_16x16x32_bf16 v[32:35],a[208:211],a[112:115],v[32:35]
v_exp_f32 v90,v90
v_mfma_f32_16x16x32_bf16 v[32:35],a[212:215],a[116:119],v[32:35]
s_waitcnt lgkmcnt(1)
buffer_store_dwordx4 v[152:155],v0,s[16:19],s27 offen offset:0 nt
v_exp_f32 v91,v91
v_cvt_pk_bf16_f32 v115,v70,v71
v_mfma_f32_16x16x32_bf16 v[40:43],a[192:195],a[120:123],0
v_exp_f32 v92,v92
v_mfma_f32_16x16x32_bf16 v[128:131],v[24:27],v[112:115],v[128:131]
v_exp_f32 v93,v93
v_mfma_f32_16x16x32_bf16 v[40:43],a[196:199],a[124:127],v[40:43]
v_exp_f32 v94,v94
v_mfma_f32_16x16x32_bf16 v[40:43],a[200:203],a[128:131],v[40:43]
v_exp_f32 v95,v95
v_mfma_f32_16x16x32_bf16 v[40:43],a[204:207],a[132:135],v[40:43]
v_cvt_pk_bf16_f32 v118,v76,v77
v_cvt_pk_bf16_f32 v119,v78,v79
v_mfma_f32_16x16x32_bf16 v[40:43],a[208:211],a[136:139],v[40:43]
ds_read_b128 v[152:155],v31 offset:0
v_mfma_f32_16x16x32_bf16 v[132:135],v[24:27],v[116:119],v[132:135]
v_cvt_pk_bf16_f32 v120,v80,v81
v_cvt_pk_bf16_f32 v121,v82,v83
v_mfma_f32_16x16x32_bf16 v[40:43],a[212:215],a[140:143],v[40:43]
v_cvt_pk_bf16_f32 v122,v84,v85
v_cvt_pk_bf16_f32 v123,v86,v87
v_mfma_f32_16x16x32_bf16 v[48:51],a[192:195],a[144:147],0
v_cvt_pk_bf16_f32 v124,v88,v89
v_cvt_pk_bf16_f32 v125,v90,v91
v_mfma_f32_16x16x32_bf16 v[136:139],v[24:27],v[120:123],v[136:139]
v_cvt_pk_bf16_f32 v126,v92,v93
v_cvt_pk_bf16_f32 v127,v94,v95
v_mfma_f32_16x16x32_bf16 v[48:51],a[196:199],a[148:151],v[48:51]
s_waitcnt lgkmcnt(1)
buffer_store_dwordx4 v[156:159],v0,s[16:19],s27 offen offset:1024 nt
v_fma_f32 v32,v32,s36,v16
v_fma_f32 v33,v33,s36,v16
v_fma_f32 v34,v34,s36,v16
v_mfma_f32_16x16x32_bf16 v[140:143],v[24:27],v[124:127],v[140:143]
v_fma_f32 v35,v35,s36,v16
v_fma_f32 v40,v40,s36,v17
v_mfma_f32_16x16x32_bf16 v[48:51],a[200:203],a[152:155],v[48:51]
v_fma_f32 v41,v41,s36,v17
v_fma_f32 v42,v42,s36,v17
v_mfma_f32_16x16x32_bf16 v[48:51],a[204:207],a[156:159],v[48:51]
v_fma_f32 v43,v43,s36,v17
v_mfma_f32_16x16x32_bf16 v[48:51],a[208:211],a[160:163],v[48:51]
v_exp_f32 v32,v32
v_mfma_f32_16x16x32_bf16 v[48:51],a[212:215],a[164:167],v[48:51]
v_exp_f32 v33,v33
v_mfma_f32_16x16x32_bf16 v[56:59],a[192:195],a[168:171],0
v_exp_f32 v34,v34
v_mfma_f32_16x16x32_bf16 v[56:59],a[196:199],a[172:175],v[56:59]
v_exp_f32 v35,v35
v_mfma_f32_16x16x32_bf16 v[56:59],a[200:203],a[176:179],v[56:59]
v_exp_f32 v40,v40
v_mfma_f32_16x16x32_bf16 v[56:59],a[204:207],a[180:183],v[56:59]
v_exp_f32 v41,v41
v_mfma_f32_16x16x32_bf16 v[56:59],a[208:211],a[184:187],v[56:59]
v_exp_f32 v42,v42
v_mfma_f32_16x16x32_bf16 v[56:59],a[212:215],a[188:191],v[56:59]
s_waitcnt lgkmcnt(0)
buffer_store_dwordx4 v[152:155],v0,s[16:19],s27 offen offset:2048 nt
v_exp_f32 v43,v43
v_cvt_pk_bf16_f32 v96,v32,v33
v_mfma_f32_16x16x32_bf16 v[36:39],a[216:219],a[96:99],0
s_add_u32 s27,s27,3072
v_cvt_pk_bf16_f32 v97,v34,v35
v_cvt_pk_bf16_f32 v100,v40,v41
v_mfma_f32_16x16x32_bf16 v[36:39],a[220:223],a[100:103],v[36:39]
v_cvt_pk_bf16_f32 v101,v42,v43
v_mfma_f32_16x16x32_bf16 v[36:39],a[224:227],a[104:107],v[36:39]
v_mfma_f32_16x16x32_bf16 v[36:39],a[228:231],a[108:111],v[36:39]
v_mfma_f32_16x16x32_bf16 v[36:39],a[232:235],a[112:115],v[36:39]
v_mfma_f32_16x16x32_bf16 v[36:39],a[236:239],a[116:119],v[36:39]
v_mfma_f32_16x16x32_bf16 v[44:47],a[216:219],a[120:123],0
v_mfma_f32_16x16x32_bf16 v[44:47],a[220:223],a[124:127],v[44:47]
s_waitcnt vmcnt(9)
v_mfma_f32_16x16x32_bf16 v[44:47],a[224:227],a[128:131],v[44:47]
s_barrier
v_mfma_f32_16x16x32_bf16 v[44:47],a[228:231],a[132:135],v[44:47]
ds_read_b64_tr_b16 a[240:241],v3 offset:0
ds_read_b64_tr_b16 a[242:243],v3 offset:6144
v_mfma_f32_16x16x32_bf16 v[44:47],a[232:235],a[136:139],v[44:47]
v_mfma_f32_16x16x32_bf16 v[44:47],a[236:239],a[140:143],v[44:47]
ds_read_b64_tr_b16 a[244:245],v4 offset:0
ds_read_b64_tr_b16 a[246:247],v4 offset:6144
v_mfma_f32_16x16x32_bf16 v[52:55],a[216:219],a[144:147],0
v_mfma_f32_16x16x32_bf16 v[52:55],a[220:223],a[148:151],v[52:55]
ds_read_b64_tr_b16 a[248:249],v5 offset:0
ds_read_b64_tr_b16 a[250:251],v5 offset:6144
v_mfma_f32_16x16x32_bf16 v[52:55],a[224:227],a[152:155],v[52:55]
v_mfma_f32_16x16x32_bf16 v[52:55],a[228:231],a[156:159],v[52:55]
ds_read_b64_tr_b16 a[252:253],v6 offset:0
ds_read_b64_tr_b16 a[254:255],v6 offset:6144
v_mfma_f32_16x16x32_bf16 v[52:55],a[232:235],a[160:163],v[52:55]
v_mfma_f32_16x16x32_bf16 v[52:55],a[236:239],a[164:167],v[52:55]
v_mfma_f32_16x16x32_bf16 v[60:63],a[216:219],a[168:171],0
v_mfma_f32_16x16x32_bf16 v[60:63],a[220:223],a[172:175],v[60:63]
v_mfma_f32_16x16x32_bf16 v[60:63],a[224:227],a[176:179],v[60:63]
v_mfma_f32_16x16x32_bf16 v[60:63],a[228:231],a[180:183],v[60:63]
v_mfma_f32_16x16x32_bf16 v[60:63],a[232:235],a[184:187],v[60:63]
v_mfma_f32_16x16x32_bf16 v[60:63],a[236:239],a[188:191],v[60:63]
s_waitcnt lgkmcnt(2)
v_mfma_f32_16x16x32_bf16 v[160:163],a[240:243],v[112:115],v[160:163]
s_add_u32 m0,s23,24576
ds_read_b128 a[192:195],v1 offset:24576
v_fma_f32 v55,v55,s36,v18
v_mfma_f32_16x16x32_bf16 v[208:211],a[240:243],v[116:119],v[208:211]
buffer_load_dwordx4 v7,s[8:11],s21 offen offset:0 lds
v_mfma_f32_16x16x32_bf16 a[0:3],a[240:243],v[120:123],a[0:3]
ds_read_b128 a[200:203],v1 offset:24704
v_fma_f32 v57,v57,s36,v19
v_mfma_f32_16x16x32_bf16 a[48:51],a[240:243],v[124:127],a[48:51]
ds_read_b64_tr_b16 a[240:241],v3 offset:128
ds_read_b64_tr_b16 a[242:243],v3 offset:6272
v_mfma_f32_16x16x32_bf16 v[164:167],a[244:247],v[112:115],v[164:167]
ds_read_b128 a[204:207],v2 offset:24704
v_fma_f32 v63,v63,s36,v19
v_mfma_f32_16x16x32_bf16 v[212:215],a[244:247],v[116:119],v[212:215]
ds_read_b128 a[196:199],v2 offset:24576
v_fma_f32 v36,v36,s36,v16
v_mfma_f32_16x16x32_bf16 a[4:7],a[244:247],v[120:123],a[4:7]
ds_read_b128 a[212:215],v2 offset:24832
v_fma_f32 v61,v61,s36,v19
v_mfma_f32_16x16x32_bf16 a[52:55],a[244:247],v[124:127],a[52:55]
ds_read_b64_tr_b16 a[246:247],v4 offset:6272
ds_read_b64_tr_b16 a[244:245],v4 offset:128
v_mfma_f32_16x16x32_bf16 v[168:171],a[248:251],v[112:115],v[168:171]
ds_read_b128 a[208:211],v1 offset:24832
v_fma_f32 v45,v45,s36,v17
v_mfma_f32_16x16x32_bf16 v[216:219],a[248:251],v[116:119],v[216:219]
buffer_load_dwordx4 v8,s[8:11],s21 offen offset:1024 lds
v_mfma_f32_16x16x32_bf16 a[8:11],a[248:251],v[120:123],a[8:11]
ds_read_b128 a[216:219],v1 offset:30720
v_fma_f32 v46,v46,s36,v17
v_mfma_f32_16x16x32_bf16 a[56:59],a[248:251],v[124:127],a[56:59]
s_waitcnt lgkmcnt(8)
ds_read_b64_tr_b16 a[250:251],v5 offset:6272
ds_read_b64_tr_b16 a[248:249],v5 offset:128
v_mfma_f32_16x16x32_bf16 v[172:175],a[252:255],v[112:115],v[172:175]
ds_read_b128 a[224:227],v1 offset:30848
v_fma_f32 v50,v50,s36,v18
v_mfma_f32_16x16x32_bf16 v[220:223],a[252:255],v[116:119],v[220:223]
ds_read_b128 a[220:223],v2 offset:30720
v_fma_f32 v37,v37,s36,v16
v_mfma_f32_16x16x32_bf16 a[12:15],a[252:255],v[120:123],a[12:15]
ds_read_b128 a[228:231],v2 offset:30848
v_fma_f32 v58,v58,s36,v19
v_mfma_f32_16x16x32_bf16 a[60:63],a[252:255],v[124:127],a[60:63]
s_waitcnt lgkmcnt(7)
ds_read_b64_tr_b16 a[252:253],v6 offset:128
ds_read_b64_tr_b16 a[254:255],v6 offset:6272
v_mfma_f32_16x16x32_bf16 v[176:179],a[240:243],v[112:115],v[176:179]
ds_read_b128 a[236:239],v2 offset:30976
v_fma_f32 v39,v39,s36,v16
v_mfma_f32_16x16x32_bf16 v[224:227],a[240:243],v[116:119],v[224:227]
buffer_load_dwordx4 v9,s[8:11],s21 offen offset:2048 lds
v_mfma_f32_16x16x32_bf16 a[16:19],a[240:243],v[120:123],a[16:19]
s_add_u32 s21,s21,12288
ds_read_b128 a[232:235],v1 offset:30976
v_fma_f32 v60,v60,s36,v19
v_mfma_f32_16x16x32_bf16 a[64:67],a[240:243],v[124:127],a[64:67]
s_add_u32 m0,s22,12288
ds_read_b64_tr_b16 a[240:241],v3 offset:256
ds_read_b64_tr_b16 a[242:243],v3 offset:6400
v_mfma_f32_16x16x32_bf16 v[180:183],a[244:247],v[112:115],v[180:183]
v_fma_f32 v54,v54,s36,v18
v_fma_f32 v59,v59,s36,v19
v_mfma_f32_16x16x32_bf16 v[228:231],a[244:247],v[116:119],v[228:231]
v_fma_f32 v56,v56,s36,v19
v_fma_f32 v52,v52,s36,v18
v_mfma_f32_16x16x32_bf16 a[20:23],a[244:247],v[120:123],a[20:23]
v_fma_f32 v44,v44,s36,v17
v_fma_f32 v38,v38,s36,v16
v_mfma_f32_16x16x32_bf16 a[68:71],a[244:247],v[124:127],a[68:71]
s_waitcnt lgkmcnt(4)
ds_read_b64_tr_b16 a[246:247],v4 offset:6400
ds_read_b64_tr_b16 a[244:245],v4 offset:256
v_mfma_f32_16x16x32_bf16 v[184:187],a[248:251],v[112:115],v[184:187]
buffer_load_dwordx4 v7,s[4:7],s20 offen offset:0 lds
v_mfma_f32_16x16x32_bf16 v[232:235],a[248:251],v[116:119],v[232:235]
v_fma_f32 v48,v48,s36,v18
v_fma_f32 v47,v47,s36,v17
v_mfma_f32_16x16x32_bf16 a[24:27],a[248:251],v[120:123],a[24:27]
v_fma_f32 v51,v51,s36,v18
v_fma_f32 v53,v53,s36,v18
v_mfma_f32_16x16x32_bf16 a[72:75],a[248:251],v[124:127],a[72:75]
ds_read_b64_tr_b16 a[250:251],v5 offset:6400
ds_read_b64_tr_b16 a[248:249],v5 offset:256
v_mfma_f32_16x16x32_bf16 v[188:191],a[252:255],v[112:115],v[188:191]
v_fma_f32 v62,v62,s36,v19
v_fma_f32 v49,v49,s36,v18
v_mfma_f32_16x16x32_bf16 v[236:239],a[252:255],v[116:119],v[236:239]
v_exp_f32 v49,v49
v_mfma_f32_16x16x32_bf16 a[28:31],a[252:255],v[120:123],a[28:31]
v_exp_f32 v55,v55
v_mfma_f32_16x16x32_bf16 a[76:79],a[252:255],v[124:127],a[76:79]
s_waitcnt lgkmcnt(2)
ds_read_b64_tr_b16 a[254:255],v6 offset:6400
ds_read_b64_tr_b16 a[252:253],v6 offset:256
v_mfma_f32_16x16x32_bf16 v[192:195],a[240:243],v[112:115],v[192:195]
buffer_load_dwordx4 v8,s[4:7],s20 offen offset:1024 lds
v_mfma_f32_16x16x32_bf16 v[240:243],a[240:243],v[116:119],v[240:243]
v_exp_f32 v36,v36
v_mfma_f32_16x16x32_bf16 a[32:35],a[240:243],v[120:123],a[32:35]
v_exp_f32 v54,v54
v_mfma_f32_16x16x32_bf16 a[80:83],a[240:243],v[124:127],a[80:83]
v_exp_f32 v53,v53
v_mfma_f32_16x16x32_bf16 v[196:199],a[244:247],v[112:115],v[196:199]
v_exp_f32 v51,v51
v_mfma_f32_16x16x32_bf16 v[244:247],a[244:247],v[116:119],v[244:247]
v_exp_f32 v57,v57
v_mfma_f32_16x16x32_bf16 a[36:39],a[244:247],v[120:123],a[36:39]
v_cvt_pk_bf16_f32 v107,v54,v55
v_mfma_f32_16x16x32_bf16 a[84:87],a[244:247],v[124:127],a[84:87]
s_waitcnt lgkmcnt(0)
v_exp_f32 v47,v47
v_mfma_f32_16x16x32_bf16 v[200:203],a[248:251],v[112:115],v[200:203]
buffer_load_dwordx4 v9,s[4:7],s20 offen offset:2048 lds
v_mfma_f32_16x16x32_bf16 v[248:251],a[248:251],v[116:119],v[248:251]
s_add_u32 s20,s20,12288
v_exp_f32 v56,v56
v_mfma_f32_16x16x32_bf16 a[40:43],a[248:251],v[120:123],a[40:43]
s_add_u32 m0,s29,0
v_cvt_pk_bf16_f32 v108,v56,v57
v_mfma_f32_16x16x32_bf16 a[88:91],a[248:251],v[124:127],a[88:91]
v_exp_f32 v38,v38
v_mfma_f32_16x16x32_bf16 v[204:207],a[252:255],v[112:115],v[204:207]
v_exp_f32 v61,v61
v_mfma_f32_16x16x32_bf16 v[252:255],a[252:255],v[116:119],v[252:255]
v_exp_f32 v46,v46
v_mfma_f32_16x16x32_bf16 a[44:47],a[252:255],v[120:123],a[44:47]
v_cvt_pk_bf16_f32 v103,v46,v47
v_mfma_f32_16x16x32_bf16 a[92:95],a[252:255],v[124:127],a[92:95]
v_exp_f32 v37,v37
v_mfma_f32_16x16x32_bf16 v[64:67],a[192:195],a[96:99],0
v_cvt_pk_bf16_f32 v98,v36,v37
v_mfma_f32_16x16x32_bf16 v[64:67],a[196:199],a[100:103],v[64:67]
v_exp_f32 v58,v58
v_mfma_f32_16x16x32_bf16 v[64:67],a[200:203],a[104:107],v[64:67]
v_exp_f32 v62,v62
v_mfma_f32_16x16x32_bf16 v[64:67],a[204:207],a[108:111],v[64:67]
v_exp_f32 v52,v52
v_mfma_f32_16x16x32_bf16 v[64:67],a[208:211],a[112:115],v[64:67]
v_cvt_pk_bf16_f32 v106,v52,v53
v_mfma_f32_16x16x32_bf16 v[64:67],a[212:215],a[116:119],v[64:67]
buffer_load_dwordx4 v7,s[12:15],s28 offen offset:0 nt lds
v_mfma_f32_16x16x32_bf16 v[72:75],a[192:195],a[120:123],0
v_exp_f32 v45,v45
v_mfma_f32_16x16x32_bf16 v[72:75],a[196:199],a[124:127],v[72:75]
v_exp_f32 v63,v63
v_mfma_f32_16x16x32_bf16 v[72:75],a[200:203],a[128:131],v[72:75]
v_cvt_pk_bf16_f32 v111,v62,v63
v_mfma_f32_16x16x32_bf16 v[72:75],a[204:207],a[132:135],v[72:75]
v_fma_f32 v66,v66,s36,v16
v_fma_f32 v64,v64,s36,v16
v_mfma_f32_16x16x32_bf16 v[72:75],a[208:211],a[136:139],v[72:75]
v_fma_f32 v65,v65,s36,v16
v_fma_f32 v67,v67,s36,v16
v_mfma_f32_16x16x32_bf16 v[72:75],a[212:215],a[140:143],v[72:75]
v_exp_f32 v65,v65
v_mfma_f32_16x16x32_bf16 v[80:83],a[192:195],a[144:147],0
v_exp_f32 v50,v50
v_mfma_f32_16x16x32_bf16 v[80:83],a[196:199],a[148:151],v[80:83]
v_cvt_pk_bf16_f32 v105,v50,v51
v_mfma_f32_16x16x32_bf16 v[80:83],a[200:203],a[152:155],v[80:83]
v_exp_f32 v48,v48
v_mfma_f32_16x16x32_bf16 v[80:83],a[204:207],a[156:159],v[80:83]
v_fma_f32 v73,v73,s36,v17
v_cvt_pk_bf16_f32 v104,v48,v49
v_mfma_f32_16x16x32_bf16 v[80:83],a[208:211],a[160:163],v[80:83]
buffer_load_dwordx4 v8,s[12:15],s28 offen offset:1024 nt lds
v_mfma_f32_16x16x32_bf16 v[136:139],v[24:27],v[104:107],v[136:139]
v_fma_f32 v72,v72,s36,v17
v_fma_f32 v75,v75,s36,v17
v_mfma_f32_16x16x32_bf16 v[80:83],a[212:215],a[164:167],v[80:83]
v_fma_f32 v74,v74,s36,v17
v_mfma_f32_16x16x32_bf16 v[88:91],a[192:195],a[168:171],0
v_exp_f32 v39,v39
v_mfma_f32_16x16x32_bf16 v[88:91],a[196:199],a[172:175],v[88:91]
v_cvt_pk_bf16_f32 v99,v38,v39
v_mfma_f32_16x16x32_bf16 v[88:91],a[200:203],a[176:179],v[88:91]
v_exp_f32 v67,v67
v_mfma_f32_16x16x32_bf16 v[128:131],v[24:27],v[96:99],v[128:131]
v_exp_f32 v72,v72
v_mfma_f32_16x16x32_bf16 v[88:91],a[204:207],a[180:183],v[88:91]
v_exp_f32 v44,v44
v_mfma_f32_16x16x32_bf16 v[88:91],a[208:211],a[184:187],v[88:91]
v_cvt_pk_bf16_f32 v102,v44,v45
v_mfma_f32_16x16x32_bf16 v[88:91],a[212:215],a[188:191],v[88:91]
v_exp_f32 v60,v60
v_mfma_f32_16x16x32_bf16 v[132:135],v[24:27],v[100:103],v[132:135]
v_cvt_pk_bf16_f32 v110,v60,v61
v_mfma_f32_16x16x32_bf16 v[68:71],a[216:219],a[96:99],0
v_exp_f32 v59,v59
v_mfma_f32_16x16x32_bf16 v[68:71],a[220:223],a[100:103],v[68:71]
buffer_load_dwordx4 v9,s[12:15],s28 offen offset:2048 nt lds
v_mfma_f32_16x16x32_bf16 v[68:71],a[224:227],a[104:107],v[68:71]
s_add_u32 s28,s28,3072
v_cvt_pk_bf16_f32 v109,v58,v59
v_mfma_f32_16x16x32_bf16 v[68:71],a[228:231],a[108:111],v[68:71]
s_add_u32 s29,s29,3072
v_exp_f32 v75,v75
v_mfma_f32_16x16x32_bf16 v[140:143],v[24:27],v[108:111],v[140:143]
v_exp_f32 v66,v66
v_mfma_f32_16x16x32_bf16 v[68:71],a[232:235],a[112:115],v[68:71]
v_cvt_pk_bf16_f32 v113,v66,v67
v_mfma_f32_16x16x32_bf16 v[68:71],a[236:239],a[116:119],v[68:71]
v_exp_f32 v64,v64
v_mfma_f32_16x16x32_bf16 v[76:79],a[216:219],a[120:123],0
v_cvt_pk_bf16_f32 v112,v64,v65
v_mfma_f32_16x16x32_bf16 v[76:79],a[220:223],a[124:127],v[76:79]
v_exp_f32 v73,v73
v_mfma_f32_16x16x32_bf16 v[76:79],a[224:227],a[128:131],v[76:79]
v_cvt_pk_bf16_f32 v116,v72,v73
s_waitcnt vmcnt(12)
v_mfma_f32_16x16x32_bf16 v[76:79],a[228:231],a[132:135],v[76:79]
s_barrier
v_mfma_f32_16x16x32_bf16 v[76:79],a[232:235],a[136:139],v[76:79]
ds_read_b64_tr_b16 a[240:241],v3 offset:12288
ds_read_b64_tr_b16 a[242:243],v3 offset:18432
v_mfma_f32_16x16x32_bf16 v[76:79],a[236:239],a[140:143],v[76:79]
v_exp_f32 v74,v74
v_mfma_f32_16x16x32_bf16 v[84:87],a[216:219],a[144:147],0
ds_read_b64_tr_b16 a[244:245],v4 offset:12288
ds_read_b64_tr_b16 a[246:247],v4 offset:18432
v_mfma_f32_16x16x32_bf16 v[84:87],a[220:223],a[148:151],v[84:87]
v_cvt_pk_bf16_f32 v117,v74,v75
v_mfma_f32_16x16x32_bf16 v[84:87],a[224:227],a[152:155],v[84:87]
ds_read_b64_tr_b16 a[250:251],v5 offset:18432
ds_read_b64_tr_b16 a[248:249],v5 offset:12288
v_mfma_f32_16x16x32_bf16 v[84:87],a[228:231],a[156:159],v[84:87]
v_mfma_f32_16x16x32_bf16 v[84:87],a[232:235],a[160:163],v[84:87]
ds_read_b64_tr_b16 a[252:253],v6 offset:12288
ds_read_b64_tr_b16 a[254:255],v6 offset:18432
v_mfma_f32_16x16x32_bf16 v[84:87],a[236:239],a[164:167],v[84:87]
v_mfma_f32_16x16x32_bf16 v[92:95],a[216:219],a[168:171],0
v_mfma_f32_16x16x32_bf16 v[92:95],a[220:223],a[172:175],v[92:95]
v_mfma_f32_16x16x32_bf16 v[92:95],a[224:227],a[176:179],v[92:95]
v_mfma_f32_16x16x32_bf16 v[92:95],a[228:231],a[180:183],v[92:95]
v_mfma_f32_16x16x32_bf16 v[92:95],a[232:235],a[184:187],v[92:95]
v_mfma_f32_16x16x32_bf16 v[92:95],a[236:239],a[188:191],v[92:95]
s_waitcnt lgkmcnt(2)
v_mfma_f32_16x16x32_bf16 v[160:163],a[240:243],v[96:99],v[160:163]
s_add_u32 m0,s23,0
ds_read_b128 a[192:195],v1 offset:0
v_fma_f32 v68,v68,s36,v16
v_mfma_f32_16x16x32_bf16 v[208:211],a[240:243],v[100:103],v[208:211]
buffer_load_dwordx4 v7,s[8:11],s21 offen offset:0 lds
v_mfma_f32_16x16x32_bf16 a[0:3],a[240:243],v[104:107],a[0:3]
ds_read_b128 a[196:199],v2 offset:0
v_fma_f32 v69,v69,s36,v16
v_mfma_f32_16x16x32_bf16 a[48:51],a[240:243],v[108:111],a[48:51]
ds_read_b64_tr_b16 a[240:241],v3 offset:12416
ds_read_b64_tr_b16 a[242:243],v3 offset:18560
v_mfma_f32_16x16x32_bf16 v[164:167],a[244:247],v[96:99],v[164:167]
ds_read_b128 a[200:203],v1 offset:128
v_fma_f32 v70,v70,s36,v16
v_mfma_f32_16x16x32_bf16 v[212:215],a[244:247],v[100:103],v[212:215]
ds_read_b128 a[204:207],v2 offset:128
v_fma_f32 v71,v71,s36,v16
v_mfma_f32_16x16x32_bf16 a[4:7],a[244:247],v[104:107],a[4:7]
ds_read_b128 a[208:211],v1 offset:256
v_fma_f32 v76,v76,s36,v17
v_mfma_f32_16x16x32_bf16 a[52:55],a[244:247],v[108:111],a[52:55]
ds_read_b64_tr_b16 a[244:245],v4 offset:12416
ds_read_b64_tr_b16 a[246:247],v4 offset:18560
v_mfma_f32_16x16x32_bf16 v[168:171],a[248:251],v[96:99],v[168:171]
ds_read_b128 a[212:215],v2 offset:256
v_fma_f32 v77,v77,s36,v17
v_mfma_f32_16x16x32_bf16 v[216:219],a[248:251],v[100:103],v[216:219]
buffer_load_dwordx4 v8,s[8:11],s21 offen offset:1024 lds
v_mfma_f32_16x16x32_bf16 a[8:11],a[248:251],v[104:107],a[8:11]
ds_read_b128 a[216:219],v1 offset:6144
v_fma_f32 v78,v78,s36,v17
v_mfma_f32_16x16x32_bf16 a[56:59],a[248:251],v[108:111],a[56:59]
s_waitcnt lgkmcnt(8)
ds_read_b64_tr_b16 a[248:249],v5 offset:12416
ds_read_b64_tr_b16 a[250:251],v5 offset:18560
v_mfma_f32_16x16x32_bf16 v[172:175],a[252:255],v[96:99],v[172:175]
ds_read_b128 a[220:223],v2 offset:6144
v_fma_f32 v79,v79,s36,v17
v_mfma_f32_16x16x32_bf16 v[220:223],a[252:255],v[100:103],v[220:223]
ds_read_b128 a[224:227],v1 offset:6272
v_fma_f32 v80,v80,s36,v18
v_mfma_f32_16x16x32_bf16 a[12:15],a[252:255],v[104:107],a[12:15]
ds_read_b128 a[228:231],v2 offset:6272
v_fma_f32 v81,v81,s36,v18
v_mfma_f32_16x16x32_bf16 a[60:63],a[252:255],v[108:111],a[60:63]
s_waitcnt lgkmcnt(7)
ds_read_b64_tr_b16 a[252:253],v6 offset:12416
ds_read_b64_tr_b16 a[254:255],v6 offset:18560
v_mfma_f32_16x16x32_bf16 v[176:179],a[240:243],v[96:99],v[176:179]
ds_read_b128 a[232:235],v1 offset:6400
v_fma_f32 v82,v82,s36,v18
v_mfma_f32_16x16x32_bf16 v[224:227],a[240:243],v[100:103],v[224:227]
buffer_load_dwordx4 v9,s[8:11],s21 offen offset:2048 lds
v_mfma_f32_16x16x32_bf16 a[16:19],a[240:243],v[104:107],a[16:19]
s_add_u32 s21,s21,12288
ds_read_b128 a[236:239],v2 offset:6400
v_fma_f32 v83,v83,s36,v18
v_mfma_f32_16x16x32_bf16 a[64:67],a[240:243],v[108:111],a[64:67]
s_add_u32 m0,s22,24576
ds_read_b64_tr_b16 a[240:241],v3 offset:12544
ds_read_b64_tr_b16 a[242:243],v3 offset:18688
v_mfma_f32_16x16x32_bf16 v[180:183],a[244:247],v[96:99],v[180:183]
v_fma_f32 v84,v84,s36,v18
v_fma_f32 v85,v85,s36,v18
v_mfma_f32_16x16x32_bf16 v[228:231],a[244:247],v[100:103],v[228:231]
v_fma_f32 v86,v86,s36,v18
v_fma_f32 v87,v87,s36,v18
v_mfma_f32_16x16x32_bf16 a[20:23],a[244:247],v[104:107],a[20:23]
v_fma_f32 v88,v88,s36,v19
v_fma_f32 v89,v89,s36,v19
v_mfma_f32_16x16x32_bf16 a[68:71],a[244:247],v[108:111],a[68:71]
s_waitcnt lgkmcnt(4)
ds_read_b64_tr_b16 a[244:245],v4 offset:12544
ds_read_b64_tr_b16 a[246:247],v4 offset:18688
v_mfma_f32_16x16x32_bf16 v[184:187],a[248:251],v[96:99],v[184:187]
buffer_load_dwordx4 v7,s[4:7],s20 offen offset:0 lds
v_mfma_f32_16x16x32_bf16 v[232:235],a[248:251],v[100:103],v[232:235]
v_fma_f32 v90,v90,s36,v19
v_fma_f32 v91,v91,s36,v19
v_mfma_f32_16x16x32_bf16 a[24:27],a[248:251],v[104:107],a[24:27]
v_fma_f32 v92,v92,s36,v19
v_fma_f32 v93,v93,s36,v19
v_mfma_f32_16x16x32_bf16 a[72:75],a[248:251],v[108:111],a[72:75]
ds_read_b64_tr_b16 a[248:249],v5 offset:12544
ds_read_b64_tr_b16 a[250:251],v5 offset:18688
v_mfma_f32_16x16x32_bf16 v[188:191],a[252:255],v[96:99],v[188:191]
v_fma_f32 v94,v94,s36,v19
v_fma_f32 v95,v95,s36,v19
v_mfma_f32_16x16x32_bf16 v[236:239],a[252:255],v[100:103],v[236:239]
v_exp_f32 v68,v68
v_mfma_f32_16x16x32_bf16 a[28:31],a[252:255],v[104:107],a[28:31]
v_exp_f32 v69,v69
v_mfma_f32_16x16x32_bf16 a[76:79],a[252:255],v[108:111],a[76:79]
s_waitcnt lgkmcnt(2)
ds_read_b64_tr_b16 a[252:253],v6 offset:12544
ds_read_b64_tr_b16 a[254:255],v6 offset:18688
v_mfma_f32_16x16x32_bf16 v[192:195],a[240:243],v[96:99],v[192:195]
buffer_load_dwordx4 v8,s[4:7],s20 offen offset:1024 lds
v_mfma_f32_16x16x32_bf16 v[240:243],a[240:243],v[100:103],v[240:243]
v_exp_f32 v70,v70
v_mfma_f32_16x16x32_bf16 a[32:35],a[240:243],v[104:107],a[32:35]
v_exp_f32 v71,v71
v_mfma_f32_16x16x32_bf16 a[80:83],a[240:243],v[108:111],a[80:83]
v_exp_f32 v76,v76
v_mfma_f32_16x16x32_bf16 v[196:199],a[244:247],v[96:99],v[196:199]
v_exp_f32 v77,v77
v_mfma_f32_16x16x32_bf16 v[244:247],a[244:247],v[100:103],v[244:247]
ds_read_b128 v[156:159],v11 offset:3072
v_cvt_pk_bf16_f32 v114,v68,v69
v_mfma_f32_16x16x32_bf16 a[36:39],a[244:247],v[104:107],a[36:39]
v_exp_f32 v78,v78
v_mfma_f32_16x16x32_bf16 a[84:87],a[244:247],v[108:111],a[84:87]
s_waitcnt lgkmcnt(1)
v_exp_f32 v79,v79
v_mfma_f32_16x16x32_bf16 v[200:203],a[248:251],v[96:99],v[200:203]
buffer_load_dwordx4 v9,s[4:7],s20 offen offset:2048 lds
v_mfma_f32_16x16x32_bf16 v[248:251],a[248:251],v[100:103],v[248:251]
s_add_u32 s20,s20,12288
v_exp_f32 v80,v80
v_mfma_f32_16x16x32_bf16 a[40:43],a[248:251],v[104:107],a[40:43]
v_exp_f32 v81,v81
v_mfma_f32_16x16x32_bf16 a[88:91],a[248:251],v[108:111],a[88:91]
v_exp_f32 v82,v82
v_mfma_f32_16x16x32_bf16 v[204:207],a[252:255],v[96:99],v[204:207]
v_exp_f32 v83,v83
v_mfma_f32_16x16x32_bf16 v[252:255],a[252:255],v[100:103],v[252:255]
v_exp_f32 v84,v84
v_mfma_f32_16x16x32_bf16 a[44:47],a[252:255],v[104:107],a[44:47]
v_exp_f32 v85,v85
v_mfma_f32_16x16x32_bf16 a[92:95],a[252:255],v[108:111],a[92:95]
v_exp_f32 v86,v86
v_mfma_f32_16x16x32_bf16 v[32:35],a[192:195],a[96:99],0
ds_read_b128 v[152:155],v23 offset:3072
v_mfma_f32_16x16x32_bf16 v[32:35],a[196:199],a[100:103],v[32:35]
v_exp_f32 v87,v87
v_mfma_f32_16x16x32_bf16 v[32:35],a[200:203],a[104:107],v[32:35]
v_exp_f32 v88,v88
v_mfma_f32_16x16x32_bf16 v[32:35],a[204:207],a[108:111],v[32:35]
v_exp_f32 v89,v89
v_mfma_f32_16x16x32_bf16 v[32:35],a[208:211],a[112:115],v[32:35]
v_exp_f32 v90,v90
v_mfma_f32_16x16x32_bf16 v[32:35],a[212:215],a[116:119],v[32:35]
s_waitcnt lgkmcnt(1)
buffer_store_dwordx4 v[156:159],v0,s[16:19],s27 offen offset:0 nt
v_exp_f32 v91,v91
v_cvt_pk_bf16_f32 v115,v70,v71
v_mfma_f32_16x16x32_bf16 v[40:43],a[192:195],a[120:123],0
v_exp_f32 v92,v92
v_mfma_f32_16x16x32_bf16 v[128:131],v[24:27],v[112:115],v[128:131]
v_exp_f32 v93,v93
v_mfma_f32_16x16x32_bf16 v[40:43],a[196:199],a[124:127],v[40:43]
v_exp_f32 v94,v94
v_mfma_f32_16x16x32_bf16 v[40:43],a[200:203],a[128:131],v[40:43]
v_exp_f32 v95,v95
v_mfma_f32_16x16x32_bf16 v[40:43],a[204:207],a[132:135],v[40:43]
v_cvt_pk_bf16_f32 v118,v76,v77
v_cvt_pk_bf16_f32 v119,v78,v79
v_mfma_f32_16x16x32_bf16 v[40:43],a[208:211],a[136:139],v[40:43]
ds_read_b128 v[156:159],v31 offset:3072
v_mfma_f32_16x16x32_bf16 v[132:135],v[24:27],v[116:119],v[132:135]
v_cvt_pk_bf16_f32 v120,v80,v81
v_cvt_pk_bf16_f32 v121,v82,v83
v_mfma_f32_16x16x32_bf16 v[40:43],a[212:215],a[140:143],v[40:43]
v_cvt_pk_bf16_f32 v122,v84,v85
v_cvt_pk_bf16_f32 v123,v86,v87
v_mfma_f32_16x16x32_bf16 v[48:51],a[192:195],a[144:147],0
v_cvt_pk_bf16_f32 v124,v88,v89
v_cvt_pk_bf16_f32 v125,v90,v91
v_mfma_f32_16x16x32_bf16 v[136:139],v[24:27],v[120:123],v[136:139]
v_cvt_pk_bf16_f32 v126,v92,v93
v_cvt_pk_bf16_f32 v127,v94,v95
v_mfma_f32_16x16x32_bf16 v[48:51],a[196:199],a[148:151],v[48:51]
s_waitcnt lgkmcnt(1)
buffer_store_dwordx4 v[152:155],v0,s[16:19],s27 offen offset:1024 nt
v_fma_f32 v32,v32,s36,v16
v_fma_f32 v33,v33,s36,v16
v_fma_f32 v34,v34,s36,v16
v_mfma_f32_16x16x32_bf16 v[140:143],v[24:27],v[124:127],v[140:143]
v_fma_f32 v35,v35,s36,v16
v_fma_f32 v40,v40,s36,v17
v_mfma_f32_16x16x32_bf16 v[48:51],a[200:203],a[152:155],v[48:51]
v_fma_f32 v41,v41,s36,v17
v_fma_f32 v42,v42,s36,v17
v_mfma_f32_16x16x32_bf16 v[48:51],a[204:207],a[156:159],v[48:51]
v_fma_f32 v43,v43,s36,v17
v_mfma_f32_16x16x32_bf16 v[48:51],a[208:211],a[160:163],v[48:51]
v_exp_f32 v32,v32
v_mfma_f32_16x16x32_bf16 v[48:51],a[212:215],a[164:167],v[48:51]
v_exp_f32 v33,v33
v_mfma_f32_16x16x32_bf16 v[56:59],a[192:195],a[168:171],0
v_exp_f32 v34,v34
v_mfma_f32_16x16x32_bf16 v[56:59],a[196:199],a[172:175],v[56:59]
v_exp_f32 v35,v35
v_mfma_f32_16x16x32_bf16 v[56:59],a[200:203],a[176:179],v[56:59]
v_exp_f32 v40,v40
v_mfma_f32_16x16x32_bf16 v[56:59],a[204:207],a[180:183],v[56:59]
v_exp_f32 v41,v41
v_mfma_f32_16x16x32_bf16 v[56:59],a[208:211],a[184:187],v[56:59]
v_exp_f32 v42,v42
v_mfma_f32_16x16x32_bf16 v[56:59],a[212:215],a[188:191],v[56:59]
s_waitcnt lgkmcnt(0)
buffer_store_dwordx4 v[156:159],v0,s[16:19],s27 offen offset:2048 nt
v_exp_f32 v43,v43
v_cvt_pk_bf16_f32 v96,v32,v33
v_mfma_f32_16x16x32_bf16 v[36:39],a[216:219],a[96:99],0
s_add_u32 s27,s27,3072
v_cvt_pk_bf16_f32 v97,v34,v35
v_cvt_pk_bf16_f32 v100,v40,v41
v_mfma_f32_16x16x32_bf16 v[36:39],a[220:223],a[100:103],v[36:39]
v_cvt_pk_bf16_f32 v101,v42,v43
v_mfma_f32_16x16x32_bf16 v[36:39],a[224:227],a[104:107],v[36:39]
v_mfma_f32_16x16x32_bf16 v[36:39],a[228:231],a[108:111],v[36:39]
v_mfma_f32_16x16x32_bf16 v[36:39],a[232:235],a[112:115],v[36:39]
v_mfma_f32_16x16x32_bf16 v[36:39],a[236:239],a[116:119],v[36:39]
v_mfma_f32_16x16x32_bf16 v[44:47],a[216:219],a[120:123],0
v_mfma_f32_16x16x32_bf16 v[44:47],a[220:223],a[124:127],v[44:47]
s_waitcnt vmcnt(12)
v_mfma_f32_16x16x32_bf16 v[44:47],a[224:227],a[128:131],v[44:47]
s_barrier
v_mfma_f32_16x16x32_bf16 v[44:47],a[228:231],a[132:135],v[44:47]
ds_read_b64_tr_b16 a[240:241],v3 offset:24576
ds_read_b64_tr_b16 a[242:243],v3 offset:30720
v_mfma_f32_16x16x32_bf16 v[44:47],a[232:235],a[136:139],v[44:47]
v_mfma_f32_16x16x32_bf16 v[44:47],a[236:239],a[140:143],v[44:47]
ds_read_b64_tr_b16 a[244:245],v4 offset:24576
ds_read_b64_tr_b16 a[246:247],v4 offset:30720
v_mfma_f32_16x16x32_bf16 v[52:55],a[216:219],a[144:147],0
v_mfma_f32_16x16x32_bf16 v[52:55],a[220:223],a[148:151],v[52:55]
ds_read_b64_tr_b16 a[248:249],v5 offset:24576
ds_read_b64_tr_b16 a[250:251],v5 offset:30720
v_mfma_f32_16x16x32_bf16 v[52:55],a[224:227],a[152:155],v[52:55]
v_mfma_f32_16x16x32_bf16 v[52:55],a[228:231],a[156:159],v[52:55]
ds_read_b64_tr_b16 a[252:253],v6 offset:24576
ds_read_b64_tr_b16 a[254:255],v6 offset:30720
v_mfma_f32_16x16x32_bf16 v[52:55],a[232:235],a[160:163],v[52:55]
v_mfma_f32_16x16x32_bf16 v[52:55],a[236:239],a[164:167],v[52:55]
v_mfma_f32_16x16x32_bf16 v[60:63],a[216:219],a[168:171],0
v_mfma_f32_16x16x32_bf16 v[60:63],a[220:223],a[172:175],v[60:63]
v_mfma_f32_16x16x32_bf16 v[60:63],a[224:227],a[176:179],v[60:63]
v_mfma_f32_16x16x32_bf16 v[60:63],a[228:231],a[180:183],v[60:63]
v_mfma_f32_16x16x32_bf16 v[60:63],a[232:235],a[184:187],v[60:63]
v_mfma_f32_16x16x32_bf16 v[60:63],a[236:239],a[188:191],v[60:63]
s_waitcnt lgkmcnt(2)
v_mfma_f32_16x16x32_bf16 v[160:163],a[240:243],v[112:115],v[160:163]
s_add_u32 m0,s23,12288
ds_read_b128 a[192:195],v1 offset:12288
v_fma_f32 v55,v55,s36,v18
v_mfma_f32_16x16x32_bf16 v[208:211],a[240:243],v[116:119],v[208:211]
buffer_load_dwordx4 v7,s[8:11],s21 offen offset:0 lds
v_mfma_f32_16x16x32_bf16 a[0:3],a[240:243],v[120:123],a[0:3]
ds_read_b128 a[200:203],v1 offset:12416
v_fma_f32 v57,v57,s36,v19
v_mfma_f32_16x16x32_bf16 a[48:51],a[240:243],v[124:127],a[48:51]
ds_read_b64_tr_b16 a[240:241],v3 offset:24704
ds_read_b64_tr_b16 a[242:243],v3 offset:30848
v_mfma_f32_16x16x32_bf16 v[164:167],a[244:247],v[112:115],v[164:167]
ds_read_b128 a[204:207],v2 offset:12416
v_fma_f32 v63,v63,s36,v19
v_mfma_f32_16x16x32_bf16 v[212:215],a[244:247],v[116:119],v[212:215]
ds_read_b128 a[196:199],v2 offset:12288
v_fma_f32 v36,v36,s36,v16
v_mfma_f32_16x16x32_bf16 a[4:7],a[244:247],v[120:123],a[4:7]
ds_read_b128 a[212:215],v2 offset:12544
v_fma_f32 v61,v61,s36,v19
v_mfma_f32_16x16x32_bf16 a[52:55],a[244:247],v[124:127],a[52:55]
ds_read_b64_tr_b16 a[246:247],v4 offset:30848
ds_read_b64_tr_b16 a[244:245],v4 offset:24704
v_mfma_f32_16x16x32_bf16 v[168:171],a[248:251],v[112:115],v[168:171]
ds_read_b128 a[208:211],v1 offset:12544
v_fma_f32 v45,v45,s36,v17
v_mfma_f32_16x16x32_bf16 v[216:219],a[248:251],v[116:119],v[216:219]
buffer_load_dwordx4 v8,s[8:11],s21 offen offset:1024 lds
v_mfma_f32_16x16x32_bf16 a[8:11],a[248:251],v[120:123],a[8:11]
ds_read_b128 a[216:219],v1 offset:18432
v_fma_f32 v46,v46,s36,v17
v_mfma_f32_16x16x32_bf16 a[56:59],a[248:251],v[124:127],a[56:59]
s_waitcnt lgkmcnt(8)
ds_read_b64_tr_b16 a[250:251],v5 offset:30848
ds_read_b64_tr_b16 a[248:249],v5 offset:24704
v_mfma_f32_16x16x32_bf16 v[172:175],a[252:255],v[112:115],v[172:175]
ds_read_b128 a[224:227],v1 offset:18560
v_fma_f32 v50,v50,s36,v18
v_mfma_f32_16x16x32_bf16 v[220:223],a[252:255],v[116:119],v[220:223]
ds_read_b128 a[220:223],v2 offset:18432
v_fma_f32 v37,v37,s36,v16
v_mfma_f32_16x16x32_bf16 a[12:15],a[252:255],v[120:123],a[12:15]
ds_read_b128 a[228:231],v2 offset:18560
v_fma_f32 v58,v58,s36,v19
v_mfma_f32_16x16x32_bf16 a[60:63],a[252:255],v[124:127],a[60:63]
s_waitcnt lgkmcnt(7)
ds_read_b64_tr_b16 a[252:253],v6 offset:24704
ds_read_b64_tr_b16 a[254:255],v6 offset:30848
v_mfma_f32_16x16x32_bf16 v[176:179],a[240:243],v[112:115],v[176:179]
ds_read_b128 a[236:239],v2 offset:18688
v_fma_f32 v39,v39,s36,v16
v_mfma_f32_16x16x32_bf16 v[224:227],a[240:243],v[116:119],v[224:227]
buffer_load_dwordx4 v9,s[8:11],s21 offen offset:2048 lds
v_mfma_f32_16x16x32_bf16 a[16:19],a[240:243],v[120:123],a[16:19]
s_add_u32 s21,s21,12288
ds_read_b128 a[232:235],v1 offset:18688
v_fma_f32 v60,v60,s36,v19
v_mfma_f32_16x16x32_bf16 a[64:67],a[240:243],v[124:127],a[64:67]
s_add_u32 m0,s22,0
ds_read_b64_tr_b16 a[240:241],v3 offset:24832
ds_read_b64_tr_b16 a[242:243],v3 offset:30976
v_mfma_f32_16x16x32_bf16 v[180:183],a[244:247],v[112:115],v[180:183]
v_fma_f32 v54,v54,s36,v18
v_fma_f32 v59,v59,s36,v19
v_mfma_f32_16x16x32_bf16 v[228:231],a[244:247],v[116:119],v[228:231]
v_fma_f32 v56,v56,s36,v19
v_fma_f32 v52,v52,s36,v18
v_mfma_f32_16x16x32_bf16 a[20:23],a[244:247],v[120:123],a[20:23]
v_fma_f32 v44,v44,s36,v17
v_fma_f32 v38,v38,s36,v16
v_mfma_f32_16x16x32_bf16 a[68:71],a[244:247],v[124:127],a[68:71]
s_waitcnt lgkmcnt(4)
ds_read_b64_tr_b16 a[246:247],v4 offset:30976
ds_read_b64_tr_b16 a[244:245],v4 offset:24832
v_mfma_f32_16x16x32_bf16 v[184:187],a[248:251],v[112:115],v[184:187]
buffer_load_dwordx4 v7,s[4:7],s20 offen offset:0 lds
v_mfma_f32_16x16x32_bf16 v[232:235],a[248:251],v[116:119],v[232:235]
v_fma_f32 v48,v48,s36,v18
v_fma_f32 v47,v47,s36,v17
v_mfma_f32_16x16x32_bf16 a[24:27],a[248:251],v[120:123],a[24:27]
v_fma_f32 v51,v51,s36,v18
v_fma_f32 v53,v53,s36,v18
v_mfma_f32_16x16x32_bf16 a[72:75],a[248:251],v[124:127],a[72:75]
ds_read_b64_tr_b16 a[250:251],v5 offset:30976
ds_read_b64_tr_b16 a[248:249],v5 offset:24832
v_mfma_f32_16x16x32_bf16 v[188:191],a[252:255],v[112:115],v[188:191]
v_fma_f32 v62,v62,s36,v19
v_fma_f32 v49,v49,s36,v18
v_mfma_f32_16x16x32_bf16 v[236:239],a[252:255],v[116:119],v[236:239]
v_exp_f32 v49,v49
v_mfma_f32_16x16x32_bf16 a[28:31],a[252:255],v[120:123],a[28:31]
v_exp_f32 v55,v55
v_mfma_f32_16x16x32_bf16 a[76:79],a[252:255],v[124:127],a[76:79]
s_waitcnt lgkmcnt(2)
ds_read_b64_tr_b16 a[254:255],v6 offset:30976
ds_read_b64_tr_b16 a[252:253],v6 offset:24832
v_mfma_f32_16x16x32_bf16 v[192:195],a[240:243],v[112:115],v[192:195]
buffer_load_dwordx4 v8,s[4:7],s20 offen offset:1024 lds
v_mfma_f32_16x16x32_bf16 v[240:243],a[240:243],v[116:119],v[240:243]
v_exp_f32 v36,v36
v_mfma_f32_16x16x32_bf16 a[32:35],a[240:243],v[120:123],a[32:35]
v_exp_f32 v54,v54
v_mfma_f32_16x16x32_bf16 a[80:83],a[240:243],v[124:127],a[80:83]
v_exp_f32 v53,v53
v_mfma_f32_16x16x32_bf16 v[196:199],a[244:247],v[112:115],v[196:199]
v_exp_f32 v51,v51
v_mfma_f32_16x16x32_bf16 v[244:247],a[244:247],v[116:119],v[244:247]
v_exp_f32 v57,v57
v_mfma_f32_16x16x32_bf16 a[36:39],a[244:247],v[120:123],a[36:39]
v_cvt_pk_bf16_f32 v107,v54,v55
v_mfma_f32_16x16x32_bf16 a[84:87],a[244:247],v[124:127],a[84:87]
s_waitcnt lgkmcnt(0)
v_exp_f32 v47,v47
v_mfma_f32_16x16x32_bf16 v[200:203],a[248:251],v[112:115],v[200:203]
buffer_load_dwordx4 v9,s[4:7],s20 offen offset:2048 lds
v_mfma_f32_16x16x32_bf16 v[248:251],a[248:251],v[116:119],v[248:251]
s_add_u32 s20,s20,12288
v_exp_f32 v56,v56
v_mfma_f32_16x16x32_bf16 a[40:43],a[248:251],v[120:123],a[40:43]
s_add_u32 m0,s29,0
v_cvt_pk_bf16_f32 v108,v56,v57
v_mfma_f32_16x16x32_bf16 a[88:91],a[248:251],v[124:127],a[88:91]
v_exp_f32 v38,v38
v_mfma_f32_16x16x32_bf16 v[204:207],a[252:255],v[112:115],v[204:207]
v_exp_f32 v61,v61
v_mfma_f32_16x16x32_bf16 v[252:255],a[252:255],v[116:119],v[252:255]
v_exp_f32 v46,v46
v_mfma_f32_16x16x32_bf16 a[44:47],a[252:255],v[120:123],a[44:47]
v_cvt_pk_bf16_f32 v103,v46,v47
v_mfma_f32_16x16x32_bf16 a[92:95],a[252:255],v[124:127],a[92:95]
v_exp_f32 v37,v37
v_mfma_f32_16x16x32_bf16 v[64:67],a[192:195],a[96:99],0
v_cvt_pk_bf16_f32 v98,v36,v37
v_mfma_f32_16x16x32_bf16 v[64:67],a[196:199],a[100:103],v[64:67]
v_exp_f32 v58,v58
v_mfma_f32_16x16x32_bf16 v[64:67],a[200:203],a[104:107],v[64:67]
v_exp_f32 v62,v62
v_mfma_f32_16x16x32_bf16 v[64:67],a[204:207],a[108:111],v[64:67]
v_exp_f32 v52,v52
v_mfma_f32_16x16x32_bf16 v[64:67],a[208:211],a[112:115],v[64:67]
v_cvt_pk_bf16_f32 v106,v52,v53
v_mfma_f32_16x16x32_bf16 v[64:67],a[212:215],a[116:119],v[64:67]
buffer_load_dwordx4 v7,s[12:15],s28 offen offset:0 nt lds
v_mfma_f32_16x16x32_bf16 v[72:75],a[192:195],a[120:123],0
v_exp_f32 v45,v45
v_mfma_f32_16x16x32_bf16 v[72:75],a[196:199],a[124:127],v[72:75]
v_exp_f32 v63,v63
v_mfma_f32_16x16x32_bf16 v[72:75],a[200:203],a[128:131],v[72:75]
v_cvt_pk_bf16_f32 v111,v62,v63
v_mfma_f32_16x16x32_bf16 v[72:75],a[204:207],a[132:135],v[72:75]
v_fma_f32 v66,v66,s36,v16
v_fma_f32 v64,v64,s36,v16
v_mfma_f32_16x16x32_bf16 v[72:75],a[208:211],a[136:139],v[72:75]
v_fma_f32 v65,v65,s36,v16
v_fma_f32 v67,v67,s36,v16
v_mfma_f32_16x16x32_bf16 v[72:75],a[212:215],a[140:143],v[72:75]
v_exp_f32 v65,v65
v_mfma_f32_16x16x32_bf16 v[80:83],a[192:195],a[144:147],0
v_exp_f32 v50,v50
v_mfma_f32_16x16x32_bf16 v[80:83],a[196:199],a[148:151],v[80:83]
v_cvt_pk_bf16_f32 v105,v50,v51
v_mfma_f32_16x16x32_bf16 v[80:83],a[200:203],a[152:155],v[80:83]
v_exp_f32 v48,v48
v_mfma_f32_16x16x32_bf16 v[80:83],a[204:207],a[156:159],v[80:83]
v_fma_f32 v73,v73,s36,v17
v_cvt_pk_bf16_f32 v104,v48,v49
v_mfma_f32_16x16x32_bf16 v[80:83],a[208:211],a[160:163],v[80:83]
buffer_load_dwordx4 v8,s[12:15],s28 offen offset:1024 nt lds
v_mfma_f32_16x16x32_bf16 v[136:139],v[24:27],v[104:107],v[136:139]
v_fma_f32 v72,v72,s36,v17
v_fma_f32 v75,v75,s36,v17
v_mfma_f32_16x16x32_bf16 v[80:83],a[212:215],a[164:167],v[80:83]
v_fma_f32 v74,v74,s36,v17
v_mfma_f32_16x16x32_bf16 v[88:91],a[192:195],a[168:171],0
v_exp_f32 v39,v39
v_mfma_f32_16x16x32_bf16 v[88:91],a[196:199],a[172:175],v[88:91]
v_cvt_pk_bf16_f32 v99,v38,v39
v_mfma_f32_16x16x32_bf16 v[88:91],a[200:203],a[176:179],v[88:91]
v_exp_f32 v67,v67
v_mfma_f32_16x16x32_bf16 v[128:131],v[24:27],v[96:99],v[128:131]
v_exp_f32 v72,v72
v_mfma_f32_16x16x32_bf16 v[88:91],a[204:207],a[180:183],v[88:91]
v_exp_f32 v44,v44
v_mfma_f32_16x16x32_bf16 v[88:91],a[208:211],a[184:187],v[88:91]
v_cvt_pk_bf16_f32 v102,v44,v45
v_mfma_f32_16x16x32_bf16 v[88:91],a[212:215],a[188:191],v[88:91]
v_exp_f32 v60,v60
v_mfma_f32_16x16x32_bf16 v[132:135],v[24:27],v[100:103],v[132:135]
v_cvt_pk_bf16_f32 v110,v60,v61
v_mfma_f32_16x16x32_bf16 v[68:71],a[216:219],a[96:99],0
v_exp_f32 v59,v59
v_mfma_f32_16x16x32_bf16 v[68:71],a[220:223],a[100:103],v[68:71]
buffer_load_dwordx4 v9,s[12:15],s28 offen offset:2048 nt lds
v_mfma_f32_16x16x32_bf16 v[68:71],a[224:227],a[104:107],v[68:71]
s_add_u32 s28,s28,3072
v_cvt_pk_bf16_f32 v109,v58,v59
v_mfma_f32_16x16x32_bf16 v[68:71],a[228:231],a[108:111],v[68:71]
s_add_u32 s29,s29,3072
v_exp_f32 v75,v75
v_mfma_f32_16x16x32_bf16 v[140:143],v[24:27],v[108:111],v[140:143]
v_exp_f32 v66,v66
v_mfma_f32_16x16x32_bf16 v[68:71],a[232:235],a[112:115],v[68:71]
v_cvt_pk_bf16_f32 v113,v66,v67
v_mfma_f32_16x16x32_bf16 v[68:71],a[236:239],a[116:119],v[68:71]
v_exp_f32 v64,v64
v_mfma_f32_16x16x32_bf16 v[76:79],a[216:219],a[120:123],0
v_cvt_pk_bf16_f32 v112,v64,v65
v_mfma_f32_16x16x32_bf16 v[76:79],a[220:223],a[124:127],v[76:79]
v_exp_f32 v73,v73
v_mfma_f32_16x16x32_bf16 v[76:79],a[224:227],a[128:131],v[76:79]
v_cvt_pk_bf16_f32 v116,v72,v73
s_waitcnt vmcnt(12)
v_mfma_f32_16x16x32_bf16 v[76:79],a[228:231],a[132:135],v[76:79]
s_barrier
v_mfma_f32_16x16x32_bf16 v[76:79],a[232:235],a[136:139],v[76:79]
ds_read_b64_tr_b16 a[240:241],v3 offset:0
ds_read_b64_tr_b16 a[242:243],v3 offset:6144
v_mfma_f32_16x16x32_bf16 v[76:79],a[236:239],a[140:143],v[76:79]
v_exp_f32 v74,v74
v_mfma_f32_16x16x32_bf16 v[84:87],a[216:219],a[144:147],0
ds_read_b64_tr_b16 a[244:245],v4 offset:0
ds_read_b64_tr_b16 a[246:247],v4 offset:6144
v_mfma_f32_16x16x32_bf16 v[84:87],a[220:223],a[148:151],v[84:87]
v_cvt_pk_bf16_f32 v117,v74,v75
v_mfma_f32_16x16x32_bf16 v[84:87],a[224:227],a[152:155],v[84:87]
ds_read_b64_tr_b16 a[250:251],v5 offset:6144
ds_read_b64_tr_b16 a[248:249],v5 offset:0
v_mfma_f32_16x16x32_bf16 v[84:87],a[228:231],a[156:159],v[84:87]
v_mfma_f32_16x16x32_bf16 v[84:87],a[232:235],a[160:163],v[84:87]
ds_read_b64_tr_b16 a[252:253],v6 offset:0
ds_read_b64_tr_b16 a[254:255],v6 offset:6144
v_mfma_f32_16x16x32_bf16 v[84:87],a[236:239],a[164:167],v[84:87]
v_mfma_f32_16x16x32_bf16 v[92:95],a[216:219],a[168:171],0
v_mfma_f32_16x16x32_bf16 v[92:95],a[220:223],a[172:175],v[92:95]
v_mfma_f32_16x16x32_bf16 v[92:95],a[224:227],a[176:179],v[92:95]
v_mfma_f32_16x16x32_bf16 v[92:95],a[228:231],a[180:183],v[92:95]
v_mfma_f32_16x16x32_bf16 v[92:95],a[232:235],a[184:187],v[92:95]
v_mfma_f32_16x16x32_bf16 v[92:95],a[236:239],a[188:191],v[92:95]
s_waitcnt lgkmcnt(2)
v_mfma_f32_16x16x32_bf16 v[160:163],a[240:243],v[96:99],v[160:163]
s_add_u32 m0,s23,24576
ds_read_b128 a[192:195],v1 offset:24576
v_fma_f32 v68,v68,s36,v16
v_mfma_f32_16x16x32_bf16 v[208:211],a[240:243],v[100:103],v[208:211]
buffer_load_dwordx4 v7,s[8:11],s21 offen offset:0 lds
v_mfma_f32_16x16x32_bf16 a[0:3],a[240:243],v[104:107],a[0:3]
ds_read_b128 a[196:199],v2 offset:24576
v_fma_f32 v69,v69,s36,v16
v_mfma_f32_16x16x32_bf16 a[48:51],a[240:243],v[108:111],a[48:51]
ds_read_b64_tr_b16 a[240:241],v3 offset:128
ds_read_b64_tr_b16 a[242:243],v3 offset:6272
v_mfma_f32_16x16x32_bf16 v[164:167],a[244:247],v[96:99],v[164:167]
ds_read_b128 a[200:203],v1 offset:24704
v_fma_f32 v70,v70,s36,v16
v_mfma_f32_16x16x32_bf16 v[212:215],a[244:247],v[100:103],v[212:215]
ds_read_b128 a[204:207],v2 offset:24704
v_fma_f32 v71,v71,s36,v16
v_mfma_f32_16x16x32_bf16 a[4:7],a[244:247],v[104:107],a[4:7]
ds_read_b128 a[208:211],v1 offset:24832
v_fma_f32 v76,v76,s36,v17
v_mfma_f32_16x16x32_bf16 a[52:55],a[244:247],v[108:111],a[52:55]
ds_read_b64_tr_b16 a[244:245],v4 offset:128
ds_read_b64_tr_b16 a[246:247],v4 offset:6272
v_mfma_f32_16x16x32_bf16 v[168:171],a[248:251],v[96:99],v[168:171]
ds_read_b128 a[212:215],v2 offset:24832
v_fma_f32 v77,v77,s36,v17
v_mfma_f32_16x16x32_bf16 v[216:219],a[248:251],v[100:103],v[216:219]
buffer_load_dwordx4 v8,s[8:11],s21 offen offset:1024 lds
v_mfma_f32_16x16x32_bf16 a[8:11],a[248:251],v[104:107],a[8:11]
ds_read_b128 a[216:219],v1 offset:30720
v_fma_f32 v78,v78,s36,v17
v_mfma_f32_16x16x32_bf16 a[56:59],a[248:251],v[108:111],a[56:59]
s_waitcnt lgkmcnt(8)
ds_read_b64_tr_b16 a[248:249],v5 offset:128
ds_read_b64_tr_b16 a[250:251],v5 offset:6272
v_mfma_f32_16x16x32_bf16 v[172:175],a[252:255],v[96:99],v[172:175]
ds_read_b128 a[220:223],v2 offset:30720
v_fma_f32 v79,v79,s36,v17
v_mfma_f32_16x16x32_bf16 v[220:223],a[252:255],v[100:103],v[220:223]
ds_read_b128 a[224:227],v1 offset:30848
v_fma_f32 v80,v80,s36,v18
v_mfma_f32_16x16x32_bf16 a[12:15],a[252:255],v[104:107],a[12:15]
ds_read_b128 a[228:231],v2 offset:30848
v_fma_f32 v81,v81,s36,v18
v_mfma_f32_16x16x32_bf16 a[60:63],a[252:255],v[108:111],a[60:63]
s_waitcnt lgkmcnt(7)
ds_read_b64_tr_b16 a[252:253],v6 offset:128
ds_read_b64_tr_b16 a[254:255],v6 offset:6272
v_mfma_f32_16x16x32_bf16 v[176:179],a[240:243],v[96:99],v[176:179]
ds_read_b128 a[232:235],v1 offset:30976
v_fma_f32 v82,v82,s36,v18
v_mfma_f32_16x16x32_bf16 v[224:227],a[240:243],v[100:103],v[224:227]
buffer_load_dwordx4 v9,s[8:11],s21 offen offset:2048 lds
v_mfma_f32_16x16x32_bf16 a[16:19],a[240:243],v[104:107],a[16:19]
s_add_u32 s21,s21,12288
ds_read_b128 a[236:239],v2 offset:30976
v_fma_f32 v83,v83,s36,v18
v_mfma_f32_16x16x32_bf16 a[64:67],a[240:243],v[108:111],a[64:67]
s_add_u32 m0,s25,0
ds_read_b64_tr_b16 a[240:241],v3 offset:256
ds_read_b64_tr_b16 a[242:243],v3 offset:6400
v_mfma_f32_16x16x32_bf16 v[180:183],a[244:247],v[96:99],v[180:183]
v_fma_f32 v84,v84,s36,v18
v_fma_f32 v85,v85,s36,v18
v_mfma_f32_16x16x32_bf16 v[228:231],a[244:247],v[100:103],v[228:231]
v_fma_f32 v86,v86,s36,v18
v_fma_f32 v87,v87,s36,v18
v_mfma_f32_16x16x32_bf16 a[20:23],a[244:247],v[104:107],a[20:23]
v_fma_f32 v88,v88,s36,v19
v_fma_f32 v89,v89,s36,v19
v_mfma_f32_16x16x32_bf16 a[68:71],a[244:247],v[108:111],a[68:71]
s_waitcnt lgkmcnt(4)
ds_read_b64_tr_b16 a[244:245],v4 offset:256
ds_read_b64_tr_b16 a[246:247],v4 offset:6400
v_mfma_f32_16x16x32_bf16 v[184:187],a[248:251],v[96:99],v[184:187]
buffer_load_dwordx4 v7,s[4:7],s20 offen offset:0 lds
v_mfma_f32_16x16x32_bf16 v[232:235],a[248:251],v[100:103],v[232:235]
v_fma_f32 v90,v90,s36,v19
v_fma_f32 v91,v91,s36,v19
v_mfma_f32_16x16x32_bf16 a[24:27],a[248:251],v[104:107],a[24:27]
v_fma_f32 v92,v92,s36,v19
v_fma_f32 v93,v93,s36,v19
v_mfma_f32_16x16x32_bf16 a[72:75],a[248:251],v[108:111],a[72:75]
ds_read_b64_tr_b16 a[248:249],v5 offset:256
ds_read_b64_tr_b16 a[250:251],v5 offset:6400
v_mfma_f32_16x16x32_bf16 v[188:191],a[252:255],v[96:99],v[188:191]
v_fma_f32 v94,v94,s36,v19
v_fma_f32 v95,v95,s36,v19
v_mfma_f32_16x16x32_bf16 v[236:239],a[252:255],v[100:103],v[236:239]
v_exp_f32 v68,v68
v_mfma_f32_16x16x32_bf16 a[28:31],a[252:255],v[104:107],a[28:31]
v_exp_f32 v69,v69
v_mfma_f32_16x16x32_bf16 a[76:79],a[252:255],v[108:111],a[76:79]
s_waitcnt lgkmcnt(2)
ds_read_b64_tr_b16 a[252:253],v6 offset:256
ds_read_b64_tr_b16 a[254:255],v6 offset:6400
v_mfma_f32_16x16x32_bf16 v[192:195],a[240:243],v[96:99],v[192:195]
buffer_load_dwordx4 v8,s[4:7],s20 offen offset:1024 lds
v_mfma_f32_16x16x32_bf16 v[240:243],a[240:243],v[100:103],v[240:243]
v_exp_f32 v70,v70
v_mfma_f32_16x16x32_bf16 a[32:35],a[240:243],v[104:107],a[32:35]
v_exp_f32 v71,v71
v_mfma_f32_16x16x32_bf16 a[80:83],a[240:243],v[108:111],a[80:83]
v_exp_f32 v76,v76
v_mfma_f32_16x16x32_bf16 v[196:199],a[244:247],v[96:99],v[196:199]
v_exp_f32 v77,v77
v_mfma_f32_16x16x32_bf16 v[244:247],a[244:247],v[100:103],v[244:247]
ds_read_b128 v[152:155],v11 offset:6144
v_cvt_pk_bf16_f32 v114,v68,v69
v_mfma_f32_16x16x32_bf16 a[36:39],a[244:247],v[104:107],a[36:39]
v_exp_f32 v78,v78
v_mfma_f32_16x16x32_bf16 a[84:87],a[244:247],v[108:111],a[84:87]
s_waitcnt lgkmcnt(1)
v_exp_f32 v79,v79
v_mfma_f32_16x16x32_bf16 v[200:203],a[248:251],v[96:99],v[200:203]
buffer_load_dwordx4 v9,s[4:7],s20 offen offset:2048 lds
v_mfma_f32_16x16x32_bf16 v[248:251],a[248:251],v[100:103],v[248:251]
s_add_u32 s20,s20,12288
v_exp_f32 v80,v80
v_mfma_f32_16x16x32_bf16 a[40:43],a[248:251],v[104:107],a[40:43]
v_exp_f32 v81,v81
v_mfma_f32_16x16x32_bf16 a[88:91],a[248:251],v[108:111],a[88:91]
v_exp_f32 v82,v82
v_mfma_f32_16x16x32_bf16 v[204:207],a[252:255],v[96:99],v[204:207]
v_exp_f32 v83,v83
v_mfma_f32_16x16x32_bf16 v[252:255],a[252:255],v[100:103],v[252:255]
v_exp_f32 v84,v84
v_mfma_f32_16x16x32_bf16 a[44:47],a[252:255],v[104:107],a[44:47]
v_exp_f32 v85,v85
v_mfma_f32_16x16x32_bf16 a[92:95],a[252:255],v[108:111],a[92:95]
v_exp_f32 v86,v86
v_mfma_f32_16x16x32_bf16 v[32:35],a[192:195],a[96:99],0
ds_read_b128 v[156:159],v23 offset:6144
v_mfma_f32_16x16x32_bf16 v[32:35],a[196:199],a[100:103],v[32:35]
v_exp_f32 v87,v87
v_mfma_f32_16x16x32_bf16 v[32:35],a[200:203],a[104:107],v[32:35]
v_exp_f32 v88,v88
v_mfma_f32_16x16x32_bf16 v[32:35],a[204:207],a[108:111],v[32:35]
v_exp_f32 v89,v89
v_mfma_f32_16x16x32_bf16 v[32:35],a[208:211],a[112:115],v[32:35]
v_exp_f32 v90,v90
v_mfma_f32_16x16x32_bf16 v[32:35],a[212:215],a[116:119],v[32:35]
s_waitcnt lgkmcnt(1)
buffer_store_dwordx4 v[152:155],v0,s[16:19],s27 offen offset:0 nt
v_exp_f32 v91,v91
v_cvt_pk_bf16_f32 v115,v70,v71
v_mfma_f32_16x16x32_bf16 v[40:43],a[192:195],a[120:123],0
v_exp_f32 v92,v92
v_mfma_f32_16x16x32_bf16 v[128:131],v[24:27],v[112:115],v[128:131]
v_exp_f32 v93,v93
v_mfma_f32_16x16x32_bf16 v[40:43],a[196:199],a[124:127],v[40:43]
v_exp_f32 v94,v94
v_mfma_f32_16x16x32_bf16 v[40:43],a[200:203],a[128:131],v[40:43]
v_exp_f32 v95,v95
v_mfma_f32_16x16x32_bf16 v[40:43],a[204:207],a[132:135],v[40:43]
v_cvt_pk_bf16_f32 v118,v76,v77
v_cvt_pk_bf16_f32 v119,v78,v79
v_mfma_f32_16x16x32_bf16 v[40:43],a[208:211],a[136:139],v[40:43]
ds_read_b128 v[152:155],v31 offset:6144
v_mfma_f32_16x16x32_bf16 v[132:135],v[24:27],v[116:119],v[132:135]
v_cvt_pk_bf16_f32 v120,v80,v81
v_cvt_pk_bf16_f32 v121,v82,v83
v_mfma_f32_16x16x32_bf16 v[40:43],a[212:215],a[140:143],v[40:43]
v_cvt_pk_bf16_f32 v122,v84,v85
v_cvt_pk_bf16_f32 v123,v86,v87
v_mfma_f32_16x16x32_bf16 v[48:51],a[192:195],a[144:147],0
v_cvt_pk_bf16_f32 v124,v88,v89
v_cvt_pk_bf16_f32 v125,v90,v91
v_mfma_f32_16x16x32_bf16 v[136:139],v[24:27],v[120:123],v[136:139]
v_cvt_pk_bf16_f32 v126,v92,v93
v_cvt_pk_bf16_f32 v127,v94,v95
v_mfma_f32_16x16x32_bf16 v[48:51],a[196:199],a[148:151],v[48:51]
s_waitcnt lgkmcnt(1)
buffer_store_dwordx4 v[156:159],v0,s[16:19],s27 offen offset:1024 nt
v_fma_f32 v32,v32,s36,v16
v_fma_f32 v33,v33,s36,v16
v_fma_f32 v34,v34,s36,v16
v_mfma_f32_16x16x32_bf16 v[140:143],v[24:27],v[124:127],v[140:143]
v_fma_f32 v35,v35,s36,v16
v_fma_f32 v40,v40,s36,v17
v_mfma_f32_16x16x32_bf16 v[48:51],a[200:203],a[152:155],v[48:51]
v_fma_f32 v41,v41,s36,v17
v_fma_f32 v42,v42,s36,v17
v_mfma_f32_16x16x32_bf16 v[48:51],a[204:207],a[156:159],v[48:51]
v_fma_f32 v43,v43,s36,v17
v_mfma_f32_16x16x32_bf16 v[48:51],a[208:211],a[160:163],v[48:51]
v_exp_f32 v32,v32
v_mfma_f32_16x16x32_bf16 v[48:51],a[212:215],a[164:167],v[48:51]
v_exp_f32 v33,v33
v_mfma_f32_16x16x32_bf16 v[56:59],a[192:195],a[168:171],0
v_exp_f32 v34,v34
v_mfma_f32_16x16x32_bf16 v[56:59],a[196:199],a[172:175],v[56:59]
v_exp_f32 v35,v35
v_mfma_f32_16x16x32_bf16 v[56:59],a[200:203],a[176:179],v[56:59]
v_exp_f32 v40,v40
v_mfma_f32_16x16x32_bf16 v[56:59],a[204:207],a[180:183],v[56:59]
v_exp_f32 v41,v41
v_mfma_f32_16x16x32_bf16 v[56:59],a[208:211],a[184:187],v[56:59]
v_exp_f32 v42,v42
v_mfma_f32_16x16x32_bf16 v[56:59],a[212:215],a[188:191],v[56:59]
s_waitcnt lgkmcnt(0)
buffer_store_dwordx4 v[152:155],v0,s[16:19],s27 offen offset:2048 nt
v_exp_f32 v43,v43
v_cvt_pk_bf16_f32 v96,v32,v33
v_mfma_f32_16x16x32_bf16 v[36:39],a[216:219],a[96:99],0
s_add_u32 s27,s27,3072
v_cvt_pk_bf16_f32 v97,v34,v35
v_cvt_pk_bf16_f32 v100,v40,v41
v_mfma_f32_16x16x32_bf16 v[36:39],a[220:223],a[100:103],v[36:39]
v_cvt_pk_bf16_f32 v101,v42,v43
v_mfma_f32_16x16x32_bf16 v[36:39],a[224:227],a[104:107],v[36:39]
v_mfma_f32_16x16x32_bf16 v[36:39],a[228:231],a[108:111],v[36:39]
v_mfma_f32_16x16x32_bf16 v[36:39],a[232:235],a[112:115],v[36:39]
v_mfma_f32_16x16x32_bf16 v[36:39],a[236:239],a[116:119],v[36:39]
v_mfma_f32_16x16x32_bf16 v[44:47],a[216:219],a[120:123],0
v_mfma_f32_16x16x32_bf16 v[44:47],a[220:223],a[124:127],v[44:47]
s_waitcnt vmcnt(12)
v_mfma_f32_16x16x32_bf16 v[44:47],a[224:227],a[128:131],v[44:47]
s_barrier
v_mfma_f32_16x16x32_bf16 v[44:47],a[228:231],a[132:135],v[44:47]
ds_read_b64_tr_b16 a[240:241],v3 offset:12288
ds_read_b64_tr_b16 a[242:243],v3 offset:18432
v_mfma_f32_16x16x32_bf16 v[44:47],a[232:235],a[136:139],v[44:47]
v_mfma_f32_16x16x32_bf16 v[44:47],a[236:239],a[140:143],v[44:47]
ds_read_b64_tr_b16 a[244:245],v4 offset:12288
ds_read_b64_tr_b16 a[246:247],v4 offset:18432
v_mfma_f32_16x16x32_bf16 v[52:55],a[216:219],a[144:147],0
v_mfma_f32_16x16x32_bf16 v[52:55],a[220:223],a[148:151],v[52:55]
ds_read_b64_tr_b16 a[248:249],v5 offset:12288
ds_read_b64_tr_b16 a[250:251],v5 offset:18432
v_mfma_f32_16x16x32_bf16 v[52:55],a[224:227],a[152:155],v[52:55]
v_mfma_f32_16x16x32_bf16 v[52:55],a[228:231],a[156:159],v[52:55]
ds_read_b64_tr_b16 a[252:253],v6 offset:12288
ds_read_b64_tr_b16 a[254:255],v6 offset:18432
v_mfma_f32_16x16x32_bf16 v[52:55],a[232:235],a[160:163],v[52:55]
v_mfma_f32_16x16x32_bf16 v[52:55],a[236:239],a[164:167],v[52:55]
v_mfma_f32_16x16x32_bf16 v[60:63],a[216:219],a[168:171],0
v_mfma_f32_16x16x32_bf16 v[60:63],a[220:223],a[172:175],v[60:63]
v_mfma_f32_16x16x32_bf16 v[60:63],a[224:227],a[176:179],v[60:63]
v_mfma_f32_16x16x32_bf16 v[60:63],a[228:231],a[180:183],v[60:63]
v_mfma_f32_16x16x32_bf16 v[60:63],a[232:235],a[184:187],v[60:63]
v_mfma_f32_16x16x32_bf16 v[60:63],a[236:239],a[188:191],v[60:63]
s_waitcnt lgkmcnt(2)
v_mfma_f32_16x16x32_bf16 v[160:163],a[240:243],v[112:115],v[160:163]
s_add_u32 m0,s23,0
ds_read_b128 a[192:195],v1 offset:0
v_fma_f32 v36,v36,s36,v16
v_mfma_f32_16x16x32_bf16 v[208:211],a[240:243],v[116:119],v[208:211]
buffer_load_dwordx4 v7,s[8:11],s21 offen offset:0 lds
v_mfma_f32_16x16x32_bf16 a[0:3],a[240:243],v[120:123],a[0:3]
ds_read_b128 a[196:199],v2 offset:0
v_fma_f32 v37,v37,s36,v16
v_mfma_f32_16x16x32_bf16 a[48:51],a[240:243],v[124:127],a[48:51]
ds_read_b64_tr_b16 a[240:241],v3 offset:12416
ds_read_b64_tr_b16 a[242:243],v3 offset:18560
v_mfma_f32_16x16x32_bf16 v[164:167],a[244:247],v[112:115],v[164:167]
ds_read_b128 a[200:203],v1 offset:128
v_fma_f32 v38,v38,s36,v16
v_mfma_f32_16x16x32_bf16 v[212:215],a[244:247],v[116:119],v[212:215]
ds_read_b128 a[204:207],v2 offset:128
v_fma_f32 v39,v39,s36,v16
v_mfma_f32_16x16x32_bf16 a[4:7],a[244:247],v[120:123],a[4:7]
ds_read_b128 a[208:211],v1 offset:256
v_fma_f32 v44,v44,s36,v17
v_mfma_f32_16x16x32_bf16 a[52:55],a[244:247],v[124:127],a[52:55]
ds_read_b64_tr_b16 a[244:245],v4 offset:12416
ds_read_b64_tr_b16 a[246:247],v4 offset:18560
v_mfma_f32_16x16x32_bf16 v[168:171],a[248:251],v[112:115],v[168:171]
ds_read_b128 a[212:215],v2 offset:256
v_fma_f32 v45,v45,s36,v17
v_mfma_f32_16x16x32_bf16 v[216:219],a[248:251],v[116:119],v[216:219]
buffer_load_dwordx4 v8,s[8:11],s21 offen offset:1024 lds
v_mfma_f32_16x16x32_bf16 a[8:11],a[248:251],v[120:123],a[8:11]
ds_read_b128 a[216:219],v1 offset:6144
v_fma_f32 v46,v46,s36,v17
v_mfma_f32_16x16x32_bf16 a[56:59],a[248:251],v[124:127],a[56:59]
s_waitcnt lgkmcnt(8)
ds_read_b64_tr_b16 a[248:249],v5 offset:12416
ds_read_b64_tr_b16 a[250:251],v5 offset:18560
v_mfma_f32_16x16x32_bf16 v[172:175],a[252:255],v[112:115],v[172:175]
ds_read_b128 a[220:223],v2 offset:6144
v_fma_f32 v47,v47,s36,v17
v_mfma_f32_16x16x32_bf16 v[220:223],a[252:255],v[116:119],v[220:223]
ds_read_b128 a[224:227],v1 offset:6272
v_fma_f32 v48,v48,s36,v18
v_mfma_f32_16x16x32_bf16 a[12:15],a[252:255],v[120:123],a[12:15]
ds_read_b128 a[228:231],v2 offset:6272
v_fma_f32 v49,v49,s36,v18
v_mfma_f32_16x16x32_bf16 a[60:63],a[252:255],v[124:127],a[60:63]
s_waitcnt lgkmcnt(7)
ds_read_b64_tr_b16 a[252:253],v6 offset:12416
ds_read_b64_tr_b16 a[254:255],v6 offset:18560
v_mfma_f32_16x16x32_bf16 v[176:179],a[240:243],v[112:115],v[176:179]
ds_read_b128 a[232:235],v1 offset:6400
v_fma_f32 v50,v50,s36,v18
v_mfma_f32_16x16x32_bf16 v[224:227],a[240:243],v[116:119],v[224:227]
buffer_load_dwordx4 v9,s[8:11],s21 offen offset:2048 lds
v_mfma_f32_16x16x32_bf16 a[16:19],a[240:243],v[120:123],a[16:19]
s_add_u32 s21,s21,12288
ds_read_b128 a[236:239],v2 offset:6400
v_fma_f32 v51,v51,s36,v18
v_mfma_f32_16x16x32_bf16 a[64:67],a[240:243],v[124:127],a[64:67]
s_add_u32 m0,s26,0
ds_read_b64_tr_b16 a[240:241],v3 offset:12544
ds_read_b64_tr_b16 a[242:243],v3 offset:18688
v_mfma_f32_16x16x32_bf16 v[180:183],a[244:247],v[112:115],v[180:183]
v_fma_f32 v52,v52,s36,v18
v_fma_f32 v53,v53,s36,v18
v_mfma_f32_16x16x32_bf16 v[228:231],a[244:247],v[116:119],v[228:231]
v_fma_f32 v54,v54,s36,v18
v_fma_f32 v55,v55,s36,v18
v_mfma_f32_16x16x32_bf16 a[20:23],a[244:247],v[120:123],a[20:23]
v_fma_f32 v56,v56,s36,v19
v_fma_f32 v57,v57,s36,v19
v_mfma_f32_16x16x32_bf16 a[68:71],a[244:247],v[124:127],a[68:71]
s_waitcnt lgkmcnt(4)
ds_read_b64_tr_b16 a[244:245],v4 offset:12544
ds_read_b64_tr_b16 a[246:247],v4 offset:18688
v_mfma_f32_16x16x32_bf16 v[184:187],a[248:251],v[112:115],v[184:187]
buffer_load_dwordx4 v7,s[4:7],s20 offen offset:0 lds
v_mfma_f32_16x16x32_bf16 v[232:235],a[248:251],v[116:119],v[232:235]
v_fma_f32 v58,v58,s36,v19
v_fma_f32 v59,v59,s36,v19
v_mfma_f32_16x16x32_bf16 a[24:27],a[248:251],v[120:123],a[24:27]
v_fma_f32 v60,v60,s36,v19
v_fma_f32 v61,v61,s36,v19
v_mfma_f32_16x16x32_bf16 a[72:75],a[248:251],v[124:127],a[72:75]
ds_read_b64_tr_b16 a[248:249],v5 offset:12544
ds_read_b64_tr_b16 a[250:251],v5 offset:18688
v_mfma_f32_16x16x32_bf16 v[188:191],a[252:255],v[112:115],v[188:191]
v_fma_f32 v62,v62,s36,v19
v_fma_f32 v63,v63,s36,v19
v_mfma_f32_16x16x32_bf16 v[236:239],a[252:255],v[116:119],v[236:239]
v_exp_f32 v36,v36
v_mfma_f32_16x16x32_bf16 a[28:31],a[252:255],v[120:123],a[28:31]
v_exp_f32 v37,v37
v_mfma_f32_16x16x32_bf16 a[76:79],a[252:255],v[124:127],a[76:79]
s_waitcnt lgkmcnt(2)
ds_read_b64_tr_b16 a[252:253],v6 offset:12544
ds_read_b64_tr_b16 a[254:255],v6 offset:18688
v_mfma_f32_16x16x32_bf16 v[192:195],a[240:243],v[112:115],v[192:195]
buffer_load_dwordx4 v8,s[4:7],s20 offen offset:1024 lds
v_mfma_f32_16x16x32_bf16 v[240:243],a[240:243],v[116:119],v[240:243]
v_exp_f32 v38,v38
v_mfma_f32_16x16x32_bf16 a[32:35],a[240:243],v[120:123],a[32:35]
v_exp_f32 v39,v39
v_mfma_f32_16x16x32_bf16 a[80:83],a[240:243],v[124:127],a[80:83]
v_exp_f32 v44,v44
v_mfma_f32_16x16x32_bf16 v[196:199],a[244:247],v[112:115],v[196:199]
v_exp_f32 v45,v45
v_mfma_f32_16x16x32_bf16 v[244:247],a[244:247],v[116:119],v[244:247]
v_exp_f32 v46,v46
v_mfma_f32_16x16x32_bf16 a[36:39],a[244:247],v[120:123],a[36:39]
v_exp_f32 v47,v47
v_mfma_f32_16x16x32_bf16 a[84:87],a[244:247],v[124:127],a[84:87]
s_waitcnt lgkmcnt(0)
v_exp_f32 v48,v48
v_mfma_f32_16x16x32_bf16 v[200:203],a[248:251],v[112:115],v[200:203]
buffer_load_dwordx4 v9,s[4:7],s20 offen offset:2048 lds
v_mfma_f32_16x16x32_bf16 v[248:251],a[248:251],v[116:119],v[248:251]
s_add_u32 s20,s20,12288
v_exp_f32 v49,v49
v_mfma_f32_16x16x32_bf16 a[40:43],a[248:251],v[120:123],a[40:43]
s_add_u32 m0,s29,0
v_exp_f32 v50,v50
v_mfma_f32_16x16x32_bf16 a[88:91],a[248:251],v[124:127],a[88:91]
v_exp_f32 v51,v51
v_mfma_f32_16x16x32_bf16 v[204:207],a[252:255],v[112:115],v[204:207]
v_exp_f32 v52,v52
v_mfma_f32_16x16x32_bf16 v[252:255],a[252:255],v[116:119],v[252:255]
v_exp_f32 v53,v53
v_mfma_f32_16x16x32_bf16 a[44:47],a[252:255],v[120:123],a[44:47]
v_exp_f32 v54,v54
v_mfma_f32_16x16x32_bf16 a[92:95],a[252:255],v[124:127],a[92:95]
v_exp_f32 v55,v55
v_mfma_f32_16x16x32_bf16 v[64:67],a[192:195],a[96:99],0
v_exp_f32 v56,v56
v_mfma_f32_16x16x32_bf16 v[64:67],a[196:199],a[100:103],v[64:67]
v_exp_f32 v57,v57
v_mfma_f32_16x16x32_bf16 v[64:67],a[200:203],a[104:107],v[64:67]
v_exp_f32 v58,v58
v_mfma_f32_16x16x32_bf16 v[64:67],a[204:207],a[108:111],v[64:67]
v_exp_f32 v59,v59
v_mfma_f32_16x16x32_bf16 v[64:67],a[208:211],a[112:115],v[64:67]
v_exp_f32 v60,v60
v_mfma_f32_16x16x32_bf16 v[64:67],a[212:215],a[116:119],v[64:67]
buffer_load_dwordx4 v7,s[12:15],s28 offen offset:0 nt lds
v_mfma_f32_16x16x32_bf16 v[72:75],a[192:195],a[120:123],0
v_exp_f32 v61,v61
v_mfma_f32_16x16x32_bf16 v[72:75],a[196:199],a[124:127],v[72:75]
v_exp_f32 v62,v62
v_mfma_f32_16x16x32_bf16 v[72:75],a[200:203],a[128:131],v[72:75]
v_exp_f32 v63,v63
v_mfma_f32_16x16x32_bf16 v[72:75],a[204:207],a[132:135],v[72:75]
v_cvt_pk_bf16_f32 v98,v36,v37
v_cvt_pk_bf16_f32 v99,v38,v39
v_mfma_f32_16x16x32_bf16 v[72:75],a[208:211],a[136:139],v[72:75]
v_cvt_pk_bf16_f32 v102,v44,v45
v_cvt_pk_bf16_f32 v103,v46,v47
v_mfma_f32_16x16x32_bf16 v[128:131],v[24:27],v[96:99],v[128:131]
v_cvt_pk_bf16_f32 v104,v48,v49
v_cvt_pk_bf16_f32 v105,v50,v51
v_mfma_f32_16x16x32_bf16 v[132:135],v[24:27],v[100:103],v[132:135]
v_cvt_pk_bf16_f32 v106,v52,v53
v_cvt_pk_bf16_f32 v107,v54,v55
v_mfma_f32_16x16x32_bf16 v[72:75],a[212:215],a[140:143],v[72:75]
v_cvt_pk_bf16_f32 v108,v56,v57
v_cvt_pk_bf16_f32 v109,v58,v59
v_mfma_f32_16x16x32_bf16 v[136:139],v[24:27],v[104:107],v[136:139]
v_cvt_pk_bf16_f32 v110,v60,v61
v_cvt_pk_bf16_f32 v111,v62,v63
v_mfma_f32_16x16x32_bf16 v[80:83],a[192:195],a[144:147],0
v_fma_f32 v64,v64,s36,v16
v_fma_f32 v65,v65,s36,v16
v_mfma_f32_16x16x32_bf16 v[140:143],v[24:27],v[108:111],v[140:143]
buffer_load_dwordx4 v8,s[12:15],s28 offen offset:1024 nt lds
v_mfma_f32_16x16x32_bf16 v[80:83],a[196:199],a[148:151],v[80:83]
v_fma_f32 v66,v66,s36,v16
v_fma_f32 v67,v67,s36,v16
v_mfma_f32_16x16x32_bf16 v[80:83],a[200:203],a[152:155],v[80:83]
v_fma_f32 v72,v72,s36,v17
v_fma_f32 v73,v73,s36,v17
v_mfma_f32_16x16x32_bf16 v[80:83],a[204:207],a[156:159],v[80:83]
v_fma_f32 v74,v74,s36,v17
v_fma_f32 v75,v75,s36,v17
v_mfma_f32_16x16x32_bf16 v[80:83],a[208:211],a[160:163],v[80:83]
v_exp_f32 v64,v64
v_mfma_f32_16x16x32_bf16 v[80:83],a[212:215],a[164:167],v[80:83]
v_exp_f32 v65,v65
v_mfma_f32_16x16x32_bf16 v[88:91],a[192:195],a[168:171],0
v_exp_f32 v66,v66
v_mfma_f32_16x16x32_bf16 v[88:91],a[196:199],a[172:175],v[88:91]
v_exp_f32 v67,v67
v_mfma_f32_16x16x32_bf16 v[88:91],a[200:203],a[176:179],v[88:91]
v_exp_f32 v72,v72
v_mfma_f32_16x16x32_bf16 v[88:91],a[204:207],a[180:183],v[88:91]
v_exp_f32 v73,v73
v_mfma_f32_16x16x32_bf16 v[88:91],a[208:211],a[184:187],v[88:91]
v_exp_f32 v74,v74
v_mfma_f32_16x16x32_bf16 v[88:91],a[212:215],a[188:191],v[88:91]
v_exp_f32 v75,v75
v_mfma_f32_16x16x32_bf16 v[68:71],a[216:219],a[96:99],0
buffer_load_dwordx4 v9,s[12:15],s28 offen offset:2048 nt lds
v_mfma_f32_16x16x32_bf16 v[68:71],a[220:223],a[100:103],v[68:71]
s_add_u32 s28,s28,3072
v_cvt_pk_bf16_f32 v112,v64,v65
v_cvt_pk_bf16_f32 v113,v66,v67
v_mfma_f32_16x16x32_bf16 v[68:71],a[224:227],a[104:107],v[68:71]
s_add_u32 s29,s29,3072
s_mov_b32 s25,s30
s_add_u32 s26,s22,12288
s_add_u32 s38,s38,1
s_cmp_lt_u32 s38,2
v_mfma_f32_16x16x32_bf16 v[68:71],a[228:231],a[108:111],v[68:71]
v_cvt_pk_bf16_f32 v116,v72,v73
v_cvt_pk_bf16_f32 v117,v74,v75
v_mfma_f32_16x16x32_bf16 v[68:71],a[232:235],a[112:115],v[68:71]
v_add_u32 v11,9216,v11
v_add_u32 v23,9216,v23
v_mfma_f32_16x16x32_bf16 v[68:71],a[236:239],a[116:119],v[68:71]
v_add_u32 v31,9216,v31
v_mfma_f32_16x16x32_bf16 v[76:79],a[216:219],a[120:123],0
v_mfma_f32_16x16x32_bf16 v[76:79],a[220:223],a[124:127],v[76:79]
v_mfma_f32_16x16x32_bf16 v[76:79],a[224:227],a[128:131],v[76:79]
s_waitcnt vmcnt(12)
v_mfma_f32_16x16x32_bf16 v[76:79],a[228:231],a[132:135],v[76:79]
s_barrier
v_mfma_f32_16x16x32_bf16 v[76:79],a[232:235],a[136:139],v[76:79]
ds_read_b64_tr_b16 a[240:241],v3 offset:24576
ds_read_b64_tr_b16 a[242:243],v3 offset:30720
v_mfma_f32_16x16x32_bf16 v[76:79],a[236:239],a[140:143],v[76:79]
v_mfma_f32_16x16x32_bf16 v[84:87],a[216:219],a[144:147],0
ds_read_b64_tr_b16 a[244:245],v4 offset:24576
ds_read_b64_tr_b16 a[246:247],v4 offset:30720
v_mfma_f32_16x16x32_bf16 v[84:87],a[220:223],a[148:151],v[84:87]
v_mfma_f32_16x16x32_bf16 v[84:87],a[224:227],a[152:155],v[84:87]
ds_read_b64_tr_b16 a[248:249],v5 offset:24576
ds_read_b64_tr_b16 a[250:251],v5 offset:30720
v_mfma_f32_16x16x32_bf16 v[84:87],a[228:231],a[156:159],v[84:87]
v_mfma_f32_16x16x32_bf16 v[84:87],a[232:235],a[160:163],v[84:87]
ds_read_b64_tr_b16 a[252:253],v6 offset:24576
ds_read_b64_tr_b16 a[254:255],v6 offset:30720
v_mfma_f32_16x16x32_bf16 v[84:87],a[236:239],a[164:167],v[84:87]
v_mfma_f32_16x16x32_bf16 v[92:95],a[216:219],a[168:171],0
v_mfma_f32_16x16x32_bf16 v[92:95],a[220:223],a[172:175],v[92:95]
v_mfma_f32_16x16x32_bf16 v[92:95],a[224:227],a[176:179],v[92:95]
v_mfma_f32_16x16x32_bf16 v[92:95],a[228:231],a[180:183],v[92:95]
v_mfma_f32_16x16x32_bf16 v[92:95],a[232:235],a[184:187],v[92:95]
v_mfma_f32_16x16x32_bf16 v[92:95],a[236:239],a[188:191],v[92:95]
s_cbranch_scc1 L_loop4w0
s_cmp_ge_u32 s69,8
s_cbranch_scc1 L_end4
s_cmp_eq_u32 s40,0
s_cbranch_scc1 L_tr43
s_branch L_tr44
.p2align 6
L_loop4w1:
s_waitcnt lgkmcnt(4)
v_mfma_f32_16x16x32_bf16 v[160:163],a[240:243],v[96:99],v[160:163]
s_add_u32 m0,s23,12288
ds_read_b128 a[192:195],v1 offset:12288
v_fma_f32 v68,v68,s36,v16
v_mfma_f32_16x16x32_bf16 v[208:211],a[240:243],v[100:103],v[208:211]
buffer_load_dwordx4 v7,s[8:11],s21 offen offset:0 lds
v_mfma_f32_16x16x32_bf16 a[0:3],a[240:243],v[104:107],a[0:3]
ds_read_b128 a[196:199],v2 offset:12288
v_fma_f32 v69,v69,s36,v16
v_mfma_f32_16x16x32_bf16 a[48:51],a[240:243],v[108:111],a[48:51]
ds_read_b64_tr_b16 a[240:241],v3 offset:24704
ds_read_b64_tr_b16 a[242:243],v3 offset:30848
v_mfma_f32_16x16x32_bf16 v[164:167],a[244:247],v[96:99],v[164:167]
ds_read_b128 a[200:203],v1 offset:12416
v_fma_f32 v70,v70,s36,v16
v_mfma_f32_16x16x32_bf16 v[212:215],a[244:247],v[100:103],v[212:215]
ds_read_b128 a[204:207],v2 offset:12416
v_fma_f32 v71,v71,s36,v16
v_mfma_f32_16x16x32_bf16 a[4:7],a[244:247],v[104:107],a[4:7]
ds_read_b128 a[208:211],v1 offset:12544
v_fma_f32 v76,v76,s36,v17
v_mfma_f32_16x16x32_bf16 a[52:55],a[244:247],v[108:111],a[52:55]
s_waitcnt lgkmcnt(7)
ds_read_b64_tr_b16 a[244:245],v4 offset:24704
ds_read_b64_tr_b16 a[246:247],v4 offset:30848
v_mfma_f32_16x16x32_bf16 v[168:171],a[248:251],v[96:99],v[168:171]
ds_read_b128 a[212:215],v2 offset:12544
v_fma_f32 v77,v77,s36,v17
v_mfma_f32_16x16x32_bf16 v[216:219],a[248:251],v[100:103],v[216:219]
buffer_load_dwordx4 v8,s[8:11],s21 offen offset:1024 lds
v_mfma_f32_16x16x32_bf16 a[8:11],a[248:251],v[104:107],a[8:11]
ds_read_b128 a[216:219],v1 offset:18432
v_fma_f32 v78,v78,s36,v17
v_mfma_f32_16x16x32_bf16 a[56:59],a[248:251],v[108:111],a[56:59]
ds_read_b64_tr_b16 a[248:249],v5 offset:24704
ds_read_b64_tr_b16 a[250:251],v5 offset:30848
v_mfma_f32_16x16x32_bf16 v[172:175],a[252:255],v[96:99],v[172:175]
ds_read_b128 a[220:223],v2 offset:18432
v_fma_f32 v79,v79,s36,v17
v_mfma_f32_16x16x32_bf16 v[220:223],a[252:255],v[100:103],v[220:223]
ds_read_b128 a[224:227],v1 offset:18560
v_fma_f32 v80,v80,s36,v18
v_mfma_f32_16x16x32_bf16 a[12:15],a[252:255],v[104:107],a[12:15]
ds_read_b128 a[228:231],v2 offset:18560
v_fma_f32 v81,v81,s36,v18
v_mfma_f32_16x16x32_bf16 a[60:63],a[252:255],v[108:111],a[60:63]
s_waitcnt lgkmcnt(7)
ds_read_b64_tr_b16 a[252:253],v6 offset:24704
ds_read_b64_tr_b16 a[254:255],v6 offset:30848
v_mfma_f32_16x16x32_bf16 v[176:179],a[240:243],v[96:99],v[176:179]
ds_read_b128 a[232:235],v1 offset:18688
v_fma_f32 v82,v82,s36,v18
v_mfma_f32_16x16x32_bf16 v[224:227],a[240:243],v[100:103],v[224:227]
buffer_load_dwordx4 v9,s[8:11],s21 offen offset:2048 lds
v_mfma_f32_16x16x32_bf16 a[16:19],a[240:243],v[104:107],a[16:19]
s_add_u32 s21,s21,12288
ds_read_b128 a[236:239],v2 offset:18688
v_fma_f32 v83,v83,s36,v18
v_mfma_f32_16x16x32_bf16 a[64:67],a[240:243],v[108:111],a[64:67]
s_add_u32 m0,s22,0
ds_read_b64_tr_b16 a[240:241],v3 offset:24832
ds_read_b64_tr_b16 a[242:243],v3 offset:30976
v_mfma_f32_16x16x32_bf16 v[180:183],a[244:247],v[96:99],v[180:183]
v_fma_f32 v84,v84,s36,v18
v_fma_f32 v85,v85,s36,v18
v_mfma_f32_16x16x32_bf16 v[228:231],a[244:247],v[100:103],v[228:231]
v_fma_f32 v86,v86,s36,v18
v_fma_f32 v87,v87,s36,v18
v_mfma_f32_16x16x32_bf16 a[20:23],a[244:247],v[104:107],a[20:23]
v_fma_f32 v88,v88,s36,v19
v_fma_f32 v89,v89,s36,v19
v_mfma_f32_16x16x32_bf16 a[68:71],a[244:247],v[108:111],a[68:71]
s_waitcnt lgkmcnt(4)
ds_read_b64_tr_b16 a[244:245],v4 offset:24832
ds_read_b64_tr_b16 a[246:247],v4 offset:30976
v_mfma_f32_16x16x32_bf16 v[184:187],a[248:251],v[96:99],v[184:187]
buffer_load_dwordx4 v7,s[4:7],s20 offen offset:0 lds
v_mfma_f32_16x16x32_bf16 v[232:235],a[248:251],v[100:103],v[232:235]
v_fma_f32 v90,v90,s36,v19
v_fma_f32 v91,v91,s36,v19
v_mfma_f32_16x16x32_bf16 a[24:27],a[248:251],v[104:107],a[24:27]
v_fma_f32 v92,v92,s36,v19
v_fma_f32 v93,v93,s36,v19
v_mfma_f32_16x16x32_bf16 a[72:75],a[248:251],v[108:111],a[72:75]
ds_read_b64_tr_b16 a[248:249],v5 offset:24832
ds_read_b64_tr_b16 a[250:251],v5 offset:30976
v_mfma_f32_16x16x32_bf16 v[188:191],a[252:255],v[96:99],v[188:191]
v_fma_f32 v94,v94,s36,v19
v_fma_f32 v95,v95,s36,v19
v_mfma_f32_16x16x32_bf16 v[236:239],a[252:255],v[100:103],v[236:239]
v_exp_f32 v68,v68
v_mfma_f32_16x16x32_bf16 a[28:31],a[252:255],v[104:107],a[28:31]
v_exp_f32 v69,v69
v_mfma_f32_16x16x32_bf16 a[76:79],a[252:255],v[108:111],a[76:79]
s_waitcnt lgkmcnt(2)
ds_read_b64_tr_b16 a[252:253],v6 offset:24832
ds_read_b64_tr_b16 a[254:255],v6 offset:30976
v_mfma_f32_16x16x32_bf16 v[192:195],a[240:243],v[96:99],v[192:195]
buffer_load_dwordx4 v8,s[4:7],s20 offen offset:1024 lds
v_mfma_f32_16x16x32_bf16 v[240:243],a[240:243],v[100:103],v[240:243]
v_exp_f32 v70,v70
v_mfma_f32_16x16x32_bf16 a[32:35],a[240:243],v[104:107],a[32:35]
v_exp_f32 v71,v71
v_mfma_f32_16x16x32_bf16 a[80:83],a[240:243],v[108:111],a[80:83]
v_exp_f32 v76,v76
v_mfma_f32_16x16x32_bf16 v[196:199],a[244:247],v[96:99],v[196:199]
v_exp_f32 v77,v77
v_mfma_f32_16x16x32_bf16 v[244:247],a[244:247],v[100:103],v[244:247]
ds_read_b128 v[156:159],v11 offset:0
v_cvt_pk_bf16_f32 v114,v68,v69
v_mfma_f32_16x16x32_bf16 a[36:39],a[244:247],v[104:107],a[36:39]
v_exp_f32 v78,v78
v_mfma_f32_16x16x32_bf16 a[84:87],a[244:247],v[108:111],a[84:87]
s_waitcnt lgkmcnt(1)
v_exp_f32 v79,v79
v_mfma_f32_16x16x32_bf16 v[200:203],a[248:251],v[96:99],v[200:203]
buffer_load_dwordx4 v9,s[4:7],s20 offen offset:2048 lds
v_mfma_f32_16x16x32_bf16 v[248:251],a[248:251],v[100:103],v[248:251]
s_add_u32 s20,s20,12288
v_exp_f32 v80,v80
v_mfma_f32_16x16x32_bf16 a[40:43],a[248:251],v[104:107],a[40:43]
v_exp_f32 v81,v81
v_mfma_f32_16x16x32_bf16 a[88:91],a[248:251],v[108:111],a[88:91]
v_exp_f32 v82,v82
v_mfma_f32_16x16x32_bf16 v[204:207],a[252:255],v[96:99],v[204:207]
v_exp_f32 v83,v83
v_mfma_f32_16x16x32_bf16 v[252:255],a[252:255],v[100:103],v[252:255]
v_exp_f32 v84,v84
v_mfma_f32_16x16x32_bf16 a[44:47],a[252:255],v[104:107],a[44:47]
v_exp_f32 v85,v85
v_mfma_f32_16x16x32_bf16 a[92:95],a[252:255],v[108:111],a[92:95]
v_exp_f32 v86,v86
v_mfma_f32_16x16x32_bf16 v[32:35],a[192:195],a[96:99],0
ds_read_b128 v[152:155],v23 offset:0
v_mfma_f32_16x16x32_bf16 v[32:35],a[196:199],a[100:103],v[32:35]
v_exp_f32 v87,v87
v_mfma_f32_16x16x32_bf16 v[32:35],a[200:203],a[104:107],v[32:35]
v_exp_f32 v88,v88
v_mfma_f32_16x16x32_bf16 v[32:35],a[204:207],a[108:111],v[32:35]
v_exp_f32 v89,v89
v_mfma_f32_16x16x32_bf16 v[32:35],a[208:211],a[112:115],v[32:35]
v_exp_f32 v90,v90
v_mfma_f32_16x16x32_bf16 v[32:35],a[212:215],a[116:119],v[32:35]
s_waitcnt lgkmcnt(1)
buffer_store_dwordx4 v[156:159],v0,s[16:19],s27 offen offset:0 nt
v_exp_f32 v91,v91
v_cvt_pk_bf16_f32 v115,v70,v71
v_mfma_f32_16x16x32_bf16 v[40:43],a[192:195],a[120:123],0
v_exp_f32 v92,v92
v_mfma_f32_16x16x32_bf16 v[128:131],v[24:27],v[112:115],v[128:131]
v_exp_f32 v93,v93
v_mfma_f32_16x16x32_bf16 v[40:43],a[196:199],a[124:127],v[40:43]
v_exp_f32 v94,v94
v_mfma_f32_16x16x32_bf16 v[40:43],a[200:203],a[128:131],v[40:43]
v_exp_f32 v95,v95
v_mfma_f32_16x16x32_bf16 v[40:43],a[204:207],a[132:135],v[40:43]
v_cvt_pk_bf16_f32 v118,v76,v77
v_cvt_pk_bf16_f32 v119,v78,v79
v_mfma_f32_16x16x32_bf16 v[40:43],a[208:211],a[136:139],v[40:43]
ds_read_b128 v[156:159],v31 offset:0
v_mfma_f32_16x16x32_bf16 v[132:135],v[24:27],v[116:119],v[132:135]
v_cvt_pk_bf16_f32 v120,v80,v81
v_cvt_pk_bf16_f32 v121,v82,v83
v_mfma_f32_16x16x32_bf16 v[40:43],a[212:215],a[140:143],v[40:43]
v_cvt_pk_bf16_f32 v122,v84,v85
v_cvt_pk_bf16_f32 v123,v86,v87
v_mfma_f32_16x16x32_bf16 v[48:51],a[192:195],a[144:147],0
v_cvt_pk_bf16_f32 v124,v88,v89
v_cvt_pk_bf16_f32 v125,v90,v91
v_mfma_f32_16x16x32_bf16 v[136:139],v[24:27],v[120:123],v[136:139]
v_cvt_pk_bf16_f32 v126,v92,v93
v_cvt_pk_bf16_f32 v127,v94,v95
v_mfma_f32_16x16x32_bf16 v[48:51],a[196:199],a[148:151],v[48:51]
s_waitcnt lgkmcnt(1)
buffer_store_dwordx4 v[152:155],v0,s[16:19],s27 offen offset:1024 nt
v_fma_f32 v32,v32,s36,v16
v_fma_f32 v33,v33,s36,v16
v_fma_f32 v34,v34,s36,v16
v_mfma_f32_16x16x32_bf16 v[140:143],v[24:27],v[124:127],v[140:143]
v_fma_f32 v35,v35,s36,v16
v_fma_f32 v40,v40,s36,v17
v_mfma_f32_16x16x32_bf16 v[48:51],a[200:203],a[152:155],v[48:51]
v_fma_f32 v41,v41,s36,v17
v_fma_f32 v42,v42,s36,v17
v_mfma_f32_16x16x32_bf16 v[48:51],a[204:207],a[156:159],v[48:51]
v_fma_f32 v43,v43,s36,v17
v_mfma_f32_16x16x32_bf16 v[48:51],a[208:211],a[160:163],v[48:51]
v_exp_f32 v32,v32
v_mfma_f32_16x16x32_bf16 v[48:51],a[212:215],a[164:167],v[48:51]
v_exp_f32 v33,v33
v_mfma_f32_16x16x32_bf16 v[56:59],a[192:195],a[168:171],0
v_exp_f32 v34,v34
v_mfma_f32_16x16x32_bf16 v[56:59],a[196:199],a[172:175],v[56:59]
v_exp_f32 v35,v35
v_mfma_f32_16x16x32_bf16 v[56:59],a[200:203],a[176:179],v[56:59]
v_exp_f32 v40,v40
v_mfma_f32_16x16x32_bf16 v[56:59],a[204:207],a[180:183],v[56:59]
v_exp_f32 v41,v41
v_mfma_f32_16x16x32_bf16 v[56:59],a[208:211],a[184:187],v[56:59]
v_exp_f32 v42,v42
v_mfma_f32_16x16x32_bf16 v[56:59],a[212:215],a[188:191],v[56:59]
s_waitcnt lgkmcnt(0)
buffer_store_dwordx4 v[156:159],v0,s[16:19],s27 offen offset:2048 nt
v_exp_f32 v43,v43
v_cvt_pk_bf16_f32 v96,v32,v33
v_mfma_f32_16x16x32_bf16 v[36:39],a[216:219],a[96:99],0
s_add_u32 s27,s27,3072
v_cvt_pk_bf16_f32 v97,v34,v35
v_cvt_pk_bf16_f32 v100,v40,v41
v_mfma_f32_16x16x32_bf16 v[36:39],a[220:223],a[100:103],v[36:39]
v_cvt_pk_bf16_f32 v101,v42,v43
v_mfma_f32_16x16x32_bf16 v[36:39],a[224:227],a[104:107],v[36:39]
s_waitcnt vmcnt(9)
v_mfma_f32_16x16x32_bf16 v[36:39],a[228:231],a[108:111],v[36:39]
s_barrier
v_mfma_f32_16x16x32_bf16 v[36:39],a[232:235],a[112:115],v[36:39]
v_mfma_f32_16x16x32_bf16 v[36:39],a[236:239],a[116:119],v[36:39]
v_mfma_f32_16x16x32_bf16 v[44:47],a[216:219],a[120:123],0
v_mfma_f32_16x16x32_bf16 v[44:47],a[220:223],a[124:127],v[44:47]
v_mfma_f32_16x16x32_bf16 v[44:47],a[224:227],a[128:131],v[44:47]
v_mfma_f32_16x16x32_bf16 v[44:47],a[228:231],a[132:135],v[44:47]
ds_read_b64_tr_b16 a[240:241],v3 offset:0
ds_read_b64_tr_b16 a[242:243],v3 offset:6144
v_mfma_f32_16x16x32_bf16 v[44:47],a[232:235],a[136:139],v[44:47]
v_mfma_f32_16x16x32_bf16 v[44:47],a[236:239],a[140:143],v[44:47]
ds_read_b64_tr_b16 a[244:245],v4 offset:0
ds_read_b64_tr_b16 a[246:247],v4 offset:6144
v_mfma_f32_16x16x32_bf16 v[52:55],a[216:219],a[144:147],0
v_mfma_f32_16x16x32_bf16 v[52:55],a[220:223],a[148:151],v[52:55]
ds_read_b64_tr_b16 a[248:249],v5 offset:0
ds_read_b64_tr_b16 a[250:251],v5 offset:6144
v_mfma_f32_16x16x32_bf16 v[52:55],a[224:227],a[152:155],v[52:55]
v_mfma_f32_16x16x32_bf16 v[52:55],a[228:231],a[156:159],v[52:55]
ds_read_b64_tr_b16 a[252:253],v6 offset:0
ds_read_b64_tr_b16 a[254:255],v6 offset:6144
v_mfma_f32_16x16x32_bf16 v[52:55],a[232:235],a[160:163],v[52:55]
v_mfma_f32_16x16x32_bf16 v[52:55],a[236:239],a[164:167],v[52:55]
v_mfma_f32_16x16x32_bf16 v[60:63],a[216:219],a[168:171],0
v_mfma_f32_16x16x32_bf16 v[60:63],a[220:223],a[172:175],v[60:63]
v_mfma_f32_16x16x32_bf16 v[60:63],a[224:227],a[176:179],v[60:63]
v_mfma_f32_16x16x32_bf16 v[60:63],a[228:231],a[180:183],v[60:63]
v_mfma_f32_16x16x32_bf16 v[60:63],a[232:235],a[184:187],v[60:63]
v_mfma_f32_16x16x32_bf16 v[60:63],a[236:239],a[188:191],v[60:63]
s_waitcnt lgkmcnt(2)
v_mfma_f32_16x16x32_bf16 v[160:163],a[240:243],v[112:115],v[160:163]
s_add_u32 m0,s23,24576
ds_read_b128 a[192:195],v1 offset:24576
v_fma_f32 v36,v36,s36,v16
v_mfma_f32_16x16x32_bf16 v[208:211],a[240:243],v[116:119],v[208:211]
buffer_load_dwordx4 v7,s[8:11],s21 offen offset:0 lds
v_mfma_f32_16x16x32_bf16 a[0:3],a[240:243],v[120:123],a[0:3]
ds_read_b128 a[196:199],v2 offset:24576
v_fma_f32 v37,v37,s36,v16
v_mfma_f32_16x16x32_bf16 a[48:51],a[240:243],v[124:127],a[48:51]
ds_read_b64_tr_b16 a[240:241],v3 offset:128
ds_read_b64_tr_b16 a[242:243],v3 offset:6272
v_mfma_f32_16x16x32_bf16 v[164:167],a[244:247],v[112:115],v[164:167]
ds_read_b128 a[200:203],v1 offset:24704
v_fma_f32 v38,v38,s36,v16
v_mfma_f32_16x16x32_bf16 v[212:215],a[244:247],v[116:119],v[212:215]
ds_read_b128 a[204:207],v2 offset:24704
v_fma_f32 v39,v39,s36,v16
v_mfma_f32_16x16x32_bf16 a[4:7],a[244:247],v[120:123],a[4:7]
ds_read_b128 a[208:211],v1 offset:24832
v_fma_f32 v44,v44,s36,v17
v_mfma_f32_16x16x32_bf16 a[52:55],a[244:247],v[124:127],a[52:55]
ds_read_b64_tr_b16 a[244:245],v4 offset:128
ds_read_b64_tr_b16 a[246:247],v4 offset:6272
v_mfma_f32_16x16x32_bf16 v[168:171],a[248:251],v[112:115],v[168:171]
ds_read_b128 a[212:215],v2 offset:24832
v_fma_f32 v45,v45,s36,v17
v_mfma_f32_16x16x32_bf16 v[216:219],a[248:251],v[116:119],v[216:219]
buffer_load_dwordx4 v8,s[8:11],s21 offen offset:1024 lds
v_mfma_f32_16x16x32_bf16 a[8:11],a[248:251],v[120:123],a[8:11]
ds_read_b128 a[216:219],v1 offset:30720
v_fma_f32 v46,v46,s36,v17
v_mfma_f32_16x16x32_bf16 a[56:59],a[248:251],v[124:127],a[56:59]
s_waitcnt lgkmcnt(8)
ds_read_b64_tr_b16 a[248:249],v5 offset:128
ds_read_b64_tr_b16 a[250:251],v5 offset:6272
v_mfma_f32_16x16x32_bf16 v[172:175],a[252:255],v[112:115],v[172:175]
ds_read_b128 a[220:223],v2 offset:30720
v_fma_f32 v47,v47,s36,v17
v_mfma_f32_16x16x32_bf16 v[220:223],a[252:255],v[116:119],v[220:223]
ds_read_b128 a[224:227],v1 offset:30848
v_fma_f32 v48,v48,s36,v18
v_mfma_f32_16x16x32_bf16 a[12:15],a[252:255],v[120:123],a[12:15]
ds_read_b128 a[228:231],v2 offset:30848
v_fma_f32 v49,v49,s36,v18
v_mfma_f32_16x16x32_bf16 a[60:63],a[252:255],v[124:127],a[60:63]
s_waitcnt lgkmcnt(7)
ds_read_b64_tr_b16 a[252:253],v6 offset:128
ds_read_b64_tr_b16 a[254:255],v6 offset:6272
v_mfma_f32_16x16x32_bf16 v[176:179],a[240:243],v[112:115],v[176:179]
ds_read_b128 a[232:235],v1 offset:30976
v_fma_f32 v50,v50,s36,v18
v_mfma_f32_16x16x32_bf16 v[224:227],a[240:243],v[116:119],v[224:227]
buffer_load_dwordx4 v9,s[8:11],s21 offen offset:2048 lds
v_mfma_f32_16x16x32_bf16 a[16:19],a[240:243],v[120:123],a[16:19]
s_add_u32 s21,s21,12288
ds_read_b128 a[236:239],v2 offset:30976
v_fma_f32 v51,v51,s36,v18
v_mfma_f32_16x16x32_bf16 a[64:67],a[240:243],v[124:127],a[64:67]
s_add_u32 m0,s22,12288
ds_read_b64_tr_b16 a[240:241],v3 offset:256
ds_read_b64_tr_b16 a[242:243],v3 offset:6400
v_mfma_f32_16x16x32_bf16 v[180:183],a[244:247],v[112:115],v[180:183]
v_fma_f32 v52,v52,s36,v18
v_fma_f32 v53,v53,s36,v18
v_mfma_f32_16x16x32_bf16 v[228:231],a[244:247],v[116:119],v[228:231]
v_fma_f32 v54,v54,s36,v18
v_fma_f32 v55,v55,s36,v18
v_mfma_f32_16x16x32_bf16 a[20:23],a[244:247],v[120:123],a[20:23]
v_fma_f32 v56,v56,s36,v19
v_fma_f32 v57,v57,s36,v19
v_mfma_f32_16x16x32_bf16 a[68:71],a[244:247],v[124:127],a[68:71]
s_waitcnt lgkmcnt(4)
ds_read_b64_tr_b16 a[244:245],v4 offset:256
ds_read_b64_tr_b16 a[246:247],v4 offset:6400
v_mfma_f32_16x16x32_bf16 v[184:187],a[248:251],v[112:115],v[184:187]
buffer_load_dwordx4 v7,s[4:7],s20 offen offset:0 lds
v_mfma_f32_16x16x32_bf16 v[232:235],a[248:251],v[116:119],v[232:235]
v_fma_f32 v58,v58,s36,v19
v_fma_f32 v59,v59,s36,v19
v_mfma_f32_16x16x32_bf16 a[24:27],a[248:251],v[120:123],a[24:27]
v_fma_f32 v60,v60,s36,v19
v_fma_f32 v61,v61,s36,v19
v_mfma_f32_16x16x32_bf16 a[72:75],a[248:251],v[124:127],a[72:75]
ds_read_b64_tr_b16 a[248:249],v5 offset:256
ds_read_b64_tr_b16 a[250:251],v5 offset:6400
v_mfma_f32_16x16x32_bf16 v[188:191],a[252:255],v[112:115],v[188:191]
v_fma_f32 v62,v62,s36,v19
v_fma_f32 v63,v63,s36,v19
v_mfma_f32_16x16x32_bf16 v[236:239],a[252:255],v[116:119],v[236:239]
v_exp_f32 v36,v36
v_mfma_f32_16x16x32_bf16 a[28:31],a[252:255],v[120:123],a[28:31]
v_exp_f32 v37,v37
v_mfma_f32_16x16x32_bf16 a[76:79],a[252:255],v[124:127],a[76:79]
s_waitcnt lgkmcnt(2)
ds_read_b64_tr_b16 a[252:253],v6 offset:256
ds_read_b64_tr_b16 a[254:255],v6 offset:6400
v_mfma_f32_16x16x32_bf16 v[192:195],a[240:243],v[112:115],v[192:195]
buffer_load_dwordx4 v8,s[4:7],s20 offen offset:1024 lds
v_mfma_f32_16x16x32_bf16 v[240:243],a[240:243],v[116:119],v[240:243]
v_exp_f32 v38,v38
v_mfma_f32_16x16x32_bf16 a[32:35],a[240:243],v[120:123],a[32:35]
v_exp_f32 v39,v39
v_mfma_f32_16x16x32_bf16 a[80:83],a[240:243],v[124:127],a[80:83]
v_exp_f32 v44,v44
v_mfma_f32_16x16x32_bf16 v[196:199],a[244:247],v[112:115],v[196:199]
v_exp_f32 v45,v45
v_mfma_f32_16x16x32_bf16 v[244:247],a[244:247],v[116:119],v[244:247]
v_exp_f32 v46,v46
v_mfma_f32_16x16x32_bf16 a[36:39],a[244:247],v[120:123],a[36:39]
v_exp_f32 v47,v47
v_mfma_f32_16x16x32_bf16 a[84:87],a[244:247],v[124:127],a[84:87]
s_waitcnt lgkmcnt(0)
v_exp_f32 v48,v48
v_mfma_f32_16x16x32_bf16 v[200:203],a[248:251],v[112:115],v[200:203]
buffer_load_dwordx4 v9,s[4:7],s20 offen offset:2048 lds
v_mfma_f32_16x16x32_bf16 v[248:251],a[248:251],v[116:119],v[248:251]
s_add_u32 s20,s20,12288
v_exp_f32 v49,v49
v_mfma_f32_16x16x32_bf16 a[40:43],a[248:251],v[120:123],a[40:43]
s_add_u32 m0,s29,0
v_exp_f32 v50,v50
v_mfma_f32_16x16x32_bf16 a[88:91],a[248:251],v[124:127],a[88:91]
v_exp_f32 v51,v51
v_mfma_f32_16x16x32_bf16 v[204:207],a[252:255],v[112:115],v[204:207]
v_exp_f32 v52,v52
v_mfma_f32_16x16x32_bf16 v[252:255],a[252:255],v[116:119],v[252:255]
v_exp_f32 v53,v53
v_mfma_f32_16x16x32_bf16 a[44:47],a[252:255],v[120:123],a[44:47]
v_exp_f32 v54,v54
v_mfma_f32_16x16x32_bf16 a[92:95],a[252:255],v[124:127],a[92:95]
v_exp_f32 v55,v55
v_mfma_f32_16x16x32_bf16 v[64:67],a[192:195],a[96:99],0
v_exp_f32 v56,v56
v_mfma_f32_16x16x32_bf16 v[64:67],a[196:199],a[100:103],v[64:67]
v_exp_f32 v57,v57
v_mfma_f32_16x16x32_bf16 v[64:67],a[200:203],a[104:107],v[64:67]
v_exp_f32 v58,v58
v_mfma_f32_16x16x32_bf16 v[64:67],a[204:207],a[108:111],v[64:67]
v_exp_f32 v59,v59
v_mfma_f32_16x16x32_bf16 v[64:67],a[208:211],a[112:115],v[64:67]
v_exp_f32 v60,v60
v_mfma_f32_16x16x32_bf16 v[64:67],a[212:215],a[116:119],v[64:67]
buffer_load_dwordx4 v7,s[12:15],s28 offen offset:0 nt lds
v_mfma_f32_16x16x32_bf16 v[72:75],a[192:195],a[120:123],0
v_exp_f32 v61,v61
v_mfma_f32_16x16x32_bf16 v[72:75],a[196:199],a[124:127],v[72:75]
v_exp_f32 v62,v62
v_mfma_f32_16x16x32_bf16 v[72:75],a[200:203],a[128:131],v[72:75]
v_exp_f32 v63,v63
v_mfma_f32_16x16x32_bf16 v[72:75],a[204:207],a[132:135],v[72:75]
v_cvt_pk_bf16_f32 v98,v36,v37
v_cvt_pk_bf16_f32 v99,v38,v39
v_mfma_f32_16x16x32_bf16 v[72:75],a[208:211],a[136:139],v[72:75]
v_cvt_pk_bf16_f32 v102,v44,v45
v_cvt_pk_bf16_f32 v103,v46,v47
v_mfma_f32_16x16x32_bf16 v[128:131],v[24:27],v[96:99],v[128:131]
v_cvt_pk_bf16_f32 v104,v48,v49
v_cvt_pk_bf16_f32 v105,v50,v51
v_mfma_f32_16x16x32_bf16 v[132:135],v[24:27],v[100:103],v[132:135]
v_cvt_pk_bf16_f32 v106,v52,v53
v_cvt_pk_bf16_f32 v107,v54,v55
v_mfma_f32_16x16x32_bf16 v[72:75],a[212:215],a[140:143],v[72:75]
v_cvt_pk_bf16_f32 v108,v56,v57
v_cvt_pk_bf16_f32 v109,v58,v59
v_mfma_f32_16x16x32_bf16 v[136:139],v[24:27],v[104:107],v[136:139]
v_cvt_pk_bf16_f32 v110,v60,v61
v_cvt_pk_bf16_f32 v111,v62,v63
v_mfma_f32_16x16x32_bf16 v[80:83],a[192:195],a[144:147],0
v_fma_f32 v64,v64,s36,v16
v_fma_f32 v65,v65,s36,v16
v_mfma_f32_16x16x32_bf16 v[140:143],v[24:27],v[108:111],v[140:143]
buffer_load_dwordx4 v8,s[12:15],s28 offen offset:1024 nt lds
v_mfma_f32_16x16x32_bf16 v[80:83],a[196:199],a[148:151],v[80:83]
v_fma_f32 v66,v66,s36,v16
v_fma_f32 v67,v67,s36,v16
v_mfma_f32_16x16x32_bf16 v[80:83],a[200:203],a[152:155],v[80:83]
v_fma_f32 v72,v72,s36,v17
v_fma_f32 v73,v73,s36,v17
v_mfma_f32_16x16x32_bf16 v[80:83],a[204:207],a[156:159],v[80:83]
v_fma_f32 v74,v74,s36,v17
v_fma_f32 v75,v75,s36,v17
v_mfma_f32_16x16x32_bf16 v[80:83],a[208:211],a[160:163],v[80:83]
v_exp_f32 v64,v64
v_mfma_f32_16x16x32_bf16 v[80:83],a[212:215],a[164:167],v[80:83]
v_exp_f32 v65,v65
v_mfma_f32_16x16x32_bf16 v[88:91],a[192:195],a[168:171],0
v_exp_f32 v66,v66
v_mfma_f32_16x16x32_bf16 v[88:91],a[196:199],a[172:175],v[88:91]
v_exp_f32 v67,v67
v_mfma_f32_16x16x32_bf16 v[88:91],a[200:203],a[176:179],v[88:91]
v_exp_f32 v72,v72
v_mfma_f32_16x16x32_bf16 v[88:91],a[204:207],a[180:183],v[88:91]
v_exp_f32 v73,v73
v_mfma_f32_16x16x32_bf16 v[88:91],a[208:211],a[184:187],v[88:91]
v_exp_f32 v74,v74
v_mfma_f32_16x16x32_bf16 v[88:91],a[212:215],a[188:191],v[88:91]
v_exp_f32 v75,v75
v_mfma_f32_16x16x32_bf16 v[68:71],a[216:219],a[96:99],0
buffer_load_dwordx4 v9,s[12:15],s28 offen offset:2048 nt lds
v_mfma_f32_16x16x32_bf16 v[68:71],a[220:223],a[100:103],v[68:71]
s_add_u32 s28,s28,3072
v_cvt_pk_bf16_f32 v112,v64,v65
v_cvt_pk_bf16_f32 v113,v66,v67
v_mfma_f32_16x16x32_bf16 v[68:71],a[224:227],a[104:107],v[68:71]
s_add_u32 s29,s29,3072
v_cvt_pk_bf16_f32 v116,v72,v73
v_cvt_pk_bf16_f32 v117,v74,v75
v_mfma_f32_16x16x32_bf16 v[68:71],a[228:231],a[108:111],v[68:71]
v_mfma_f32_16x16x32_bf16 v[68:71],a[232:235],a[112:115],v[68:71]
s_waitcnt vmcnt(12)
s_barrier
v_mfma_f32_16x16x32_bf16 v[68:71],a[236:239],a[116:119],v[68:71]
v_mfma_f32_16x16x32_bf16 v[76:79],a[216:219],a[120:123],0
v_mfma_f32_16x16x32_bf16 v[76:79],a[220:223],a[124:127],v[76:79]
v_mfma_f32_16x16x32_bf16 v[76:79],a[224:227],a[128:131],v[76:79]
v_mfma_f32_16x16x32_bf16 v[76:79],a[228:231],a[132:135],v[76:79]
v_mfma_f32_16x16x32_bf16 v[76:79],a[232:235],a[136:139],v[76:79]
ds_read_b64_tr_b16 a[240:241],v3 offset:12288
v_mfma_f32_16x16x32_bf16 v[76:79],a[236:239],a[140:143],v[76:79]
ds_read_b64_tr_b16 a[242:243],v3 offset:18432
v_mfma_f32_16x16x32_bf16 v[84:87],a[216:219],a[144:147],0
ds_read_b64_tr_b16 a[244:245],v4 offset:12288
v_mfma_f32_16x16x32_bf16 v[84:87],a[220:223],a[148:151],v[84:87]
ds_read_b64_tr_b16 a[246:247],v4 offset:18432
v_mfma_f32_16x16x32_bf16 v[84:87],a[224:227],a[152:155],v[84:87]
ds_read_b64_tr_b16 a[248:249],v5 offset:12288
v_mfma_f32_16x16x32_bf16 v[84:87],a[228:231],a[156:159],v[84:87]
ds_read_b64_tr_b16 a[250:251],v5 offset:18432
v_mfma_f32_16x16x32_bf16 v[84:87],a[232:235],a[160:163],v[84:87]
ds_read_b64_tr_b16 a[252:253],v6 offset:12288
v_mfma_f32_16x16x32_bf16 v[84:87],a[236:239],a[164:167],v[84:87]
ds_read_b64_tr_b16 a[254:255],v6 offset:18432
v_mfma_f32_16x16x32_bf16 v[92:95],a[216:219],a[168:171],0
v_mfma_f32_16x16x32_bf16 v[92:95],a[220:223],a[172:175],v[92:95]
v_mfma_f32_16x16x32_bf16 v[92:95],a[224:227],a[176:179],v[92:95]
v_mfma_f32_16x16x32_bf16 v[92:95],a[228:231],a[180:183],v[92:95]
v_mfma_f32_16x16x32_bf16 v[92:95],a[232:235],a[184:187],v[92:95]
v_mfma_f32_16x16x32_bf16 v[92:95],a[236:239],a[188:191],v[92:95]
s_waitcnt lgkmcnt(3)
v_mfma_f32_16x16x32_bf16 v[160:163],a[240:243],v[96:99],v[160:163]
s_add_u32 m0,s23,0
ds_read_b128 a[192:195],v1 offset:0
v_fma_f32 v68,v68,s36,v16
v_mfma_f32_16x16x32_bf16 v[208:211],a[240:243],v[100:103],v[208:211]
buffer_load_dwordx4 v7,s[8:11],s21 offen offset:0 lds
v_mfma_f32_16x16x32_bf16 a[0:3],a[240:243],v[104:107],a[0:3]
ds_read_b128 a[196:199],v2 offset:0
v_fma_f32 v69,v69,s36,v16
v_mfma_f32_16x16x32_bf16 a[48:51],a[240:243],v[108:111],a[48:51]
ds_read_b64_tr_b16 a[240:241],v3 offset:12416
ds_read_b64_tr_b16 a[242:243],v3 offset:18560
v_mfma_f32_16x16x32_bf16 v[164:167],a[244:247],v[96:99],v[164:167]
ds_read_b128 a[200:203],v1 offset:128
v_fma_f32 v70,v70,s36,v16
v_mfma_f32_16x16x32_bf16 v[212:215],a[244:247],v[100:103],v[212:215]
ds_read_b128 a[204:207],v2 offset:128
v_fma_f32 v71,v71,s36,v16
v_mfma_f32_16x16x32_bf16 a[4:7],a[244:247],v[104:107],a[4:7]
ds_read_b128 a[208:211],v1 offset:256
v_fma_f32 v76,v76,s36,v17
v_mfma_f32_16x16x32_bf16 a[52:55],a[244:247],v[108:111],a[52:55]
s_waitcnt lgkmcnt(7)
ds_read_b64_tr_b16 a[244:245],v4 offset:12416
ds_read_b64_tr_b16 a[246:247],v4 offset:18560
v_mfma_f32_16x16x32_bf16 v[168:171],a[248:251],v[96:99],v[168:171]
ds_read_b128 a[212:215],v2 offset:256
v_fma_f32 v77,v77,s36,v17
v_mfma_f32_16x16x32_bf16 v[216:219],a[248:251],v[100:103],v[216:219]
buffer_load_dwordx4 v8,s[8:11],s21 offen offset:1024 lds
v_mfma_f32_16x16x32_bf16 a[8:11],a[248:251],v[104:107],a[8:11]
ds_read_b128 a[216:219],v1 offset:6144
v_fma_f32 v78,v78,s36,v17
v_mfma_f32_16x16x32_bf16 a[56:59],a[248:251],v[108:111],a[56:59]
ds_read_b64_tr_b16 a[248:249],v5 offset:12416
ds_read_b64_tr_b16 a[250:251],v5 offset:18560
v_mfma_f32_16x16x32_bf16 v[172:175],a[252:255],v[96:99],v[172:175]
ds_read_b128 a[220:223],v2 offset:6144
v_fma_f32 v79,v79,s36,v17
v_mfma_f32_16x16x32_bf16 v[220:223],a[252:255],v[100:103],v[220:223]
ds_read_b128 a[224:227],v1 offset:6272
v_fma_f32 v80,v80,s36,v18
v_mfma_f32_16x16x32_bf16 a[12:15],a[252:255],v[104:107],a[12:15]
ds_read_b128 a[228:231],v2 offset:6272
v_fma_f32 v81,v81,s36,v18
v_mfma_f32_16x16x32_bf16 a[60:63],a[252:255],v[108:111],a[60:63]
s_waitcnt lgkmcnt(7)
ds_read_b64_tr_b16 a[252:253],v6 offset:12416
ds_read_b64_tr_b16 a[254:255],v6 offset:18560
v_mfma_f32_16x16x32_bf16 v[176:179],a[240:243],v[96:99],v[176:179]
ds_read_b128 a[232:235],v1 offset:6400
v_fma_f32 v82,v82,s36,v18
v_mfma_f32_16x16x32_bf16 v[224:227],a[240:243],v[100:103],v[224:227]
buffer_load_dwordx4 v9,s[8:11],s21 offen offset:2048 lds
v_mfma_f32_16x16x32_bf16 a[16:19],a[240:243],v[104:107],a[16:19]
s_add_u32 s21,s21,12288
ds_read_b128 a[236:239],v2 offset:6400
v_fma_f32 v83,v83,s36,v18
v_mfma_f32_16x16x32_bf16 a[64:67],a[240:243],v[108:111],a[64:67]
s_add_u32 m0,s22,24576
ds_read_b64_tr_b16 a[240:241],v3 offset:12544
ds_read_b64_tr_b16 a[242:243],v3 offset:18688
v_mfma_f32_16x16x32_bf16 v[180:183],a[244:247],v[96:99],v[180:183]
v_fma_f32 v84,v84,s36,v18
v_fma_f32 v85,v85,s36,v18
v_mfma_f32_16x16x32_bf16 v[228:231],a[244:247],v[100:103],v[228:231]
v_fma_f32 v86,v86,s36,v18
v_fma_f32 v87,v87,s36,v18
v_mfma_f32_16x16x32_bf16 a[20:23],a[244:247],v[104:107],a[20:23]
v_fma_f32 v88,v88,s36,v19
v_fma_f32 v89,v89,s36,v19
v_mfma_f32_16x16x32_bf16 a[68:71],a[244:247],v[108:111],a[68:71]
s_waitcnt lgkmcnt(4)
ds_read_b64_tr_b16 a[244:245],v4 offset:12544
ds_read_b64_tr_b16 a[246:247],v4 offset:18688
v_mfma_f32_16x16x32_bf16 v[184:187],a[248:251],v[96:99],v[184:187]
buffer_load_dwordx4 v7,s[4:7],s20 offen offset:0 lds
v_mfma_f32_16x16x32_bf16 v[232:235],a[248:251],v[100:103],v[232:235]
v_fma_f32 v90,v90,s36,v19
v_fma_f32 v91,v91,s36,v19
v_mfma_f32_16x16x32_bf16 a[24:27],a[248:251],v[104:107],a[24:27]
v_fma_f32 v92,v92,s36,v19
v_fma_f32 v93,v93,s36,v19
v_mfma_f32_16x16x32_bf16 a[72:75],a[248:251],v[108:111],a[72:75]
ds_read_b64_tr_b16 a[248:249],v5 offset:12544
ds_read_b64_tr_b16 a[250:251],v5 offset:18688
v_mfma_f32_16x16x32_bf16 v[188:191],a[252:255],v[96:99],v[188:191]
v_fma_f32 v94,v94,s36,v19
v_fma_f32 v95,v95,s36,v19
v_mfma_f32_16x16x32_bf16 v[236:239],a[252:255],v[100:103],v[236:239]
v_exp_f32 v68,v68
v_mfma_f32_16x16x32_bf16 a[28:31],a[252:255],v[104:107],a[28:31]
v_exp_f32 v69,v69
v_mfma_f32_16x16x32_bf16 a[76:79],a[252:255],v[108:111],a[76:79]
s_waitcnt lgkmcnt(2)
ds_read_b64_tr_b16 a[252:253],v6 offset:12544
ds_read_b64_tr_b16 a[254:255],v6 offset:18688
v_mfma_f32_16x16x32_bf16 v[192:195],a[240:243],v[96:99],v[192:195]
buffer_load_dwordx4 v8,s[4:7],s20 offen offset:1024 lds
v_mfma_f32_16x16x32_bf16 v[240:243],a[240:243],v[100:103],v[240:243]
v_exp_f32 v70,v70
v_mfma_f32_16x16x32_bf16 a[32:35],a[240:243],v[104:107],a[32:35]
v_exp_f32 v71,v71
v_mfma_f32_16x16x32_bf16 a[80:83],a[240:243],v[108:111],a[80:83]
v_exp_f32 v76,v76
v_mfma_f32_16x16x32_bf16 v[196:199],a[244:247],v[96:99],v[196:199]
v_exp_f32 v77,v77
v_mfma_f32_16x16x32_bf16 v[244:247],a[244:247],v[100:103],v[244:247]
ds_read_b128 v[152:155],v11 offset:3072
v_cvt_pk_bf16_f32 v114,v68,v69
v_mfma_f32_16x16x32_bf16 a[36:39],a[244:247],v[104:107],a[36:39]
v_exp_f32 v78,v78
v_mfma_f32_16x16x32_bf16 a[84:87],a[244:247],v[108:111],a[84:87]
s_waitcnt lgkmcnt(1)
v_exp_f32 v79,v79
v_mfma_f32_16x16x32_bf16 v[200:203],a[248:251],v[96:99],v[200:203]
buffer_load_dwordx4 v9,s[4:7],s20 offen offset:2048 lds
v_mfma_f32_16x16x32_bf16 v[248:251],a[248:251],v[100:103],v[248:251]
s_add_u32 s20,s20,12288
v_exp_f32 v80,v80
v_mfma_f32_16x16x32_bf16 a[40:43],a[248:251],v[104:107],a[40:43]
v_exp_f32 v81,v81
v_mfma_f32_16x16x32_bf16 a[88:91],a[248:251],v[108:111],a[88:91]
v_exp_f32 v82,v82
v_mfma_f32_16x16x32_bf16 v[204:207],a[252:255],v[96:99],v[204:207]
v_exp_f32 v83,v83
v_mfma_f32_16x16x32_bf16 v[252:255],a[252:255],v[100:103],v[252:255]
v_exp_f32 v84,v84
v_mfma_f32_16x16x32_bf16 a[44:47],a[252:255],v[104:107],a[44:47]
v_exp_f32 v85,v85
v_mfma_f32_16x16x32_bf16 a[92:95],a[252:255],v[108:111],a[92:95]
v_exp_f32 v86,v86
v_mfma_f32_16x16x32_bf16 v[32:35],a[192:195],a[96:99],0
ds_read_b128 v[156:159],v23 offset:3072
v_mfma_f32_16x16x32_bf16 v[32:35],a[196:199],a[100:103],v[32:35]
v_exp_f32 v87,v87
v_mfma_f32_16x16x32_bf16 v[32:35],a[200:203],a[104:107],v[32:35]
v_exp_f32 v88,v88
v_mfma_f32_16x16x32_bf16 v[32:35],a[204:207],a[108:111],v[32:35]
v_exp_f32 v89,v89
v_mfma_f32_16x16x32_bf16 v[32:35],a[208:211],a[112:115],v[32:35]
v_exp_f32 v90,v90
v_mfma_f32_16x16x32_bf16 v[32:35],a[212:215],a[116:119],v[32:35]
s_waitcnt lgkmcnt(1)
buffer_store_dwordx4 v[152:155],v0,s[16:19],s27 offen offset:0 nt
v_exp_f32 v91,v91
v_cvt_pk_bf16_f32 v115,v70,v71
v_mfma_f32_16x16x32_bf16 v[40:43],a[192:195],a[120:123],0
v_exp_f32 v92,v92
v_mfma_f32_16x16x32_bf16 v[128:131],v[24:27],v[112:115],v[128:131]
v_exp_f32 v93,v93
v_mfma_f32_16x16x32_bf16 v[40:43],a[196:199],a[124:127],v[40:43]
v_exp_f32 v94,v94
v_mfma_f32_16x16x32_bf16 v[40:43],a[200:203],a[128:131],v[40:43]
v_exp_f32 v95,v95
v_mfma_f32_16x16x32_bf16 v[40:43],a[204:207],a[132:135],v[40:43]
v_cvt_pk_bf16_f32 v118,v76,v77
v_cvt_pk_bf16_f32 v119,v78,v79
v_mfma_f32_16x16x32_bf16 v[40:43],a[208:211],a[136:139],v[40:43]
ds_read_b128 v[152:155],v31 offset:3072
v_mfma_f32_16x16x32_bf16 v[132:135],v[24:27],v[116:119],v[132:135]
v_cvt_pk_bf16_f32 v120,v80,v81
v_cvt_pk_bf16_f32 v121,v82,v83
v_mfma_f32_16x16x32_bf16 v[40:43],a[212:215],a[140:143],v[40:43]
v_cvt_pk_bf16_f32 v122,v84,v85
v_cvt_pk_bf16_f32 v123,v86,v87
v_mfma_f32_16x16x32_bf16 v[48:51],a[192:195],a[144:147],0
v_cvt_pk_bf16_f32 v124,v88,v89
v_cvt_pk_bf16_f32 v125,v90,v91
v_mfma_f32_16x16x32_bf16 v[136:139],v[24:27],v[120:123],v[136:139]
v_cvt_pk_bf16_f32 v126,v92,v93
v_cvt_pk_bf16_f32 v127,v94,v95
v_mfma_f32_16x16x32_bf16 v[48:51],a[196:199],a[148:151],v[48:51]
s_waitcnt lgkmcnt(1)
buffer_store_dwordx4 v[156:159],v0,s[16:19],s27 offen offset:1024 nt
v_fma_f32 v32,v32,s36,v16
v_fma_f32 v33,v33,s36,v16
v_fma_f32 v34,v34,s36,v16
v_mfma_f32_16x16x32_bf16 v[140:143],v[24:27],v[124:127],v[140:143]
v_fma_f32 v35,v35,s36,v16
v_fma_f32 v40,v40,s36,v17
v_mfma_f32_16x16x32_bf16 v[48:51],a[200:203],a[152:155],v[48:51]
v_fma_f32 v41,v41,s36,v17
v_fma_f32 v42,v42,s36,v17
v_mfma_f32_16x16x32_bf16 v[48:51],a[204:207],a[156:159],v[48:51]
v_fma_f32 v43,v43,s36,v17
v_mfma_f32_16x16x32_bf16 v[48:51],a[208:211],a[160:163],v[48:51]
v_exp_f32 v32,v32
v_mfma_f32_16x16x32_bf16 v[48:51],a[212:215],a[164:167],v[48:51]
v_exp_f32 v33,v33
v_mfma_f32_16x16x32_bf16 v[56:59],a[192:195],a[168:171],0
v_exp_f32 v34,v34
v_mfma_f32_16x16x32_bf16 v[56:59],a[196:199],a[172:175],v[56:59]
v_exp_f32 v35,v35
v_mfma_f32_16x16x32_bf16 v[56:59],a[200:203],a[176:179],v[56:59]
v_exp_f32 v40,v40
v_mfma_f32_16x16x32_bf16 v[56:59],a[204:207],a[180:183],v[56:59]
v_exp_f32 v41,v41
v_mfma_f32_16x16x32_bf16 v[56:59],a[208:211],a[184:187],v[56:59]
v_exp_f32 v42,v42
v_mfma_f32_16x16x32_bf16 v[56:59],a[212:215],a[188:191],v[56:59]
s_waitcnt lgkmcnt(0)
buffer_store_dwordx4 v[152:155],v0,s[16:19],s27 offen offset:2048 nt
v_exp_f32 v43,v43
v_cvt_pk_bf16_f32 v96,v32,v33
v_mfma_f32_16x16x32_bf16 v[36:39],a[216:219],a[96:99],0
s_add_u32 s27,s27,3072
v_cvt_pk_bf16_f32 v97,v34,v35
v_cvt_pk_bf16_f32 v100,v40,v41
v_mfma_f32_16x16x32_bf16 v[36:39],a[220:223],a[100:103],v[36:39]
v_cvt_pk_bf16_f32 v101,v42,v43
v_mfma_f32_16x16x32_bf16 v[36:39],a[224:227],a[104:107],v[36:39]
s_waitcnt vmcnt(12)
v_mfma_f32_16x16x32_bf16 v[36:39],a[228:231],a[108:111],v[36:39]
s_barrier
v_mfma_f32_16x16x32_bf16 v[36:39],a[232:235],a[112:115],v[36:39]
v_mfma_f32_16x16x32_bf16 v[36:39],a[236:239],a[116:119],v[36:39]
v_mfma_f32_16x16x32_bf16 v[44:47],a[216:219],a[120:123],0
v_mfma_f32_16x16x32_bf16 v[44:47],a[220:223],a[124:127],v[44:47]
v_mfma_f32_16x16x32_bf16 v[44:47],a[224:227],a[128:131],v[44:47]
v_mfma_f32_16x16x32_bf16 v[44:47],a[228:231],a[132:135],v[44:47]
ds_read_b64_tr_b16 a[240:241],v3 offset:24576
ds_read_b64_tr_b16 a[242:243],v3 offset:30720
v_mfma_f32_16x16x32_bf16 v[44:47],a[232:235],a[136:139],v[44:47]
v_mfma_f32_16x16x32_bf16 v[44:47],a[236:239],a[140:143],v[44:47]
ds_read_b64_tr_b16 a[244:245],v4 offset:24576
ds_read_b64_tr_b16 a[246:247],v4 offset:30720
v_mfma_f32_16x16x32_bf16 v[52:55],a[216:219],a[144:147],0
v_mfma_f32_16x16x32_bf16 v[52:55],a[220:223],a[148:151],v[52:55]
ds_read_b64_tr_b16 a[248:249],v5 offset:24576
ds_read_b64_tr_b16 a[250:251],v5 offset:30720
v_mfma_f32_16x16x32_bf16 v[52:55],a[224:227],a[152:155],v[52:55]
v_mfma_f32_16x16x32_bf16 v[52:55],a[228:231],a[156:159],v[52:55]
ds_read_b64_tr_b16 a[252:253],v6 offset:24576
ds_read_b64_tr_b16 a[254:255],v6 offset:30720
v_mfma_f32_16x16x32_bf16 v[52:55],a[232:235],a[160:163],v[52:55]
v_mfma_f32_16x16x32_bf16 v[52:55],a[236:239],a[164:167],v[52:55]
v_mfma_f32_16x16x32_bf16 v[60:63],a[216:219],a[168:171],0
v_mfma_f32_16x16x32_bf16 v[60:63],a[220:223],a[172:175],v[60:63]
v_mfma_f32_16x16x32_bf16 v[60:63],a[224:227],a[176:179],v[60:63]
v_mfma_f32_16x16x32_bf16 v[60:63],a[228:231],a[180:183],v[60:63]
v_mfma_f32_16x16x32_bf16 v[60:63],a[232:235],a[184:187],v[60:63]
v_mfma_f32_16x16x32_bf16 v[60:63],a[236:239],a[188:191],v[60:63]
s_waitcnt lgkmcnt(2)
v_mfma_f32_16x16x32_bf16 v[160:163],a[240:243],v[112:115],v[160:163]
s_add_u32 m0,s23,12288
ds_read_b128 a[192:195],v1 offset:12288
v_fma_f32 v36,v36,s36,v16
v_mfma_f32_16x16x32_bf16 v[208:211],a[240:243],v[116:119],v[208:211]
buffer_load_dwordx4 v7,s[8:11],s21 offen offset:0 lds
v_mfma_f32_16x16x32_bf16 a[0:3],a[240:243],v[120:123],a[0:3]
ds_read_b128 a[196:199],v2 offset:12288
v_fma_f32 v37,v37,s36,v16
v_mfma_f32_16x16x32_bf16 a[48:51],a[240:243],v[124:127],a[48:51]
ds_read_b64_tr_b16 a[240:241],v3 offset:24704
ds_read_b64_tr_b16 a[242:243],v3 offset:30848
v_mfma_f32_16x16x32_bf16 v[164:167],a[244:247],v[112:115],v[164:167]
ds_read_b128 a[200:203],v1 offset:12416
v_fma_f32 v38,v38,s36,v16
v_mfma_f32_16x16x32_bf16 v[212:215],a[244:247],v[116:119],v[212:215]
ds_read_b128 a[204:207],v2 offset:12416
v_fma_f32 v39,v39,s36,v16
v_mfma_f32_16x16x32_bf16 a[4:7],a[244:247],v[120:123],a[4:7]
ds_read_b128 a[208:211],v1 offset:12544
v_fma_f32 v44,v44,s36,v17
v_mfma_f32_16x16x32_bf16 a[52:55],a[244:247],v[124:127],a[52:55]
ds_read_b64_tr_b16 a[244:245],v4 offset:24704
ds_read_b64_tr_b16 a[246:247],v4 offset:30848
v_mfma_f32_16x16x32_bf16 v[168:171],a[248:251],v[112:115],v[168:171]
ds_read_b128 a[212:215],v2 offset:12544
v_fma_f32 v45,v45,s36,v17
v_mfma_f32_16x16x32_bf16 v[216:219],a[248:251],v[116:119],v[216:219]
buffer_load_dwordx4 v8,s[8:11],s21 offen offset:1024 lds
v_mfma_f32_16x16x32_bf16 a[8:11],a[248:251],v[120:123],a[8:11]
ds_read_b128 a[216:219],v1 offset:18432
v_fma_f32 v46,v46,s36,v17
v_mfma_f32_16x16x32_bf16 a[56:59],a[248:251],v[124:127],a[56:59]
s_waitcnt lgkmcnt(8)
ds_read_b64_tr_b16 a[248:249],v5 offset:24704
ds_read_b64_tr_b16 a[250:251],v5 offset:30848
v_mfma_f32_16x16x32_bf16 v[172:175],a[252:255],v[112:115],v[172:175]
ds_read_b128 a[220:223],v2 offset:18432
v_fma_f32 v47,v47,s36,v17
v_mfma_f32_16x16x32_bf16 v[220:223],a[252:255],v[116:119],v[220:223]
ds_read_b128 a[224:227],v1 offset:18560
v_fma_f32 v48,v48,s36,v18
v_mfma_f32_16x16x32_bf16 a[12:15],a[252:255],v[120:123],a[12:15]
ds_read_b128 a[228:231],v2 offset:18560
v_fma_f32 v49,v49,s36,v18
v_mfma_f32_16x16x32_bf16 a[60:63],a[252:255],v[124:127],a[60:63]
s_waitcnt lgkmcnt(7)
ds_read_b64_tr_b16 a[252:253],v6 offset:24704
ds_read_b64_tr_b16 a[254:255],v6 offset:30848
v_mfma_f32_16x16x32_bf16 v[176:179],a[240:243],v[112:115],v[176:179]
ds_read_b128 a[232:235],v1 offset:18688
v_fma_f32 v50,v50,s36,v18
v_mfma_f32_16x16x32_bf16 v[224:227],a[240:243],v[116:119],v[224:227]
buffer_load_dwordx4 v9,s[8:11],s21 offen offset:2048 lds
v_mfma_f32_16x16x32_bf16 a[16:19],a[240:243],v[120:123],a[16:19]
s_add_u32 s21,s21,12288
ds_read_b128 a[236:239],v2 offset:18688
v_fma_f32 v51,v51,s36,v18
v_mfma_f32_16x16x32_bf16 a[64:67],a[240:243],v[124:127],a[64:67]
s_add_u32 m0,s22,0
ds_read_b64_tr_b16 a[240:241],v3 offset:24832
ds_read_b64_tr_b16 a[242:243],v3 offset:30976
v_mfma_f32_16x16x32_bf16 v[180:183],a[244:247],v[112:115],v[180:183]
v_fma_f32 v52,v52,s36,v18
v_fma_f32 v53,v53,s36,v18
v_mfma_f32_16x16x32_bf16 v[228:231],a[244:247],v[116:119],v[228:231]
v_fma_f32 v54,v54,s36,v18
v_fma_f32 v55,v55,s36,v18
v_mfma_f32_16x16x32_bf16 a[20:23],a[244:247],v[120:123],a[20:23]
v_fma_f32 v56,v56,s36,v19
v_fma_f32 v57,v57,s36,v19
v_mfma_f32_16x16x32_bf16 a[68:71],a[244:247],v[124:127],a[68:71]
s_waitcnt lgkmcnt(4)
ds_read_b64_tr_b16 a[244:245],v4 offset:24832
ds_read_b64_tr_b16 a[246:247],v4 offset:30976
v_mfma_f32_16x16x32_bf16 v[184:187],a[248:251],v[112:115],v[184:187]
buffer_load_dwordx4 v7,s[4:7],s20 offen offset:0 lds
v_mfma_f32_16x16x32_bf16 v[232:235],a[248:251],v[116:119],v[232:235]
v_fma_f32 v58,v58,s36,v19
v_fma_f32 v59,v59,s36,v19
v_mfma_f32_16x16x32_bf16 a[24:27],a[248:251],v[120:123],a[24:27]
v_fma_f32 v60,v60,s36,v19
v_fma_f32 v61,v61,s36,v19
v_mfma_f32_16x16x32_bf16 a[72:75],a[248:251],v[124:127],a[72:75]
ds_read_b64_tr_b16 a[248:249],v5 offset:24832
ds_read_b64_tr_b16 a[250:251],v5 offset:30976
v_mfma_f32_16x16x32_bf16 v[188:191],a[252:255],v[112:115],v[188:191]
v_fma_f32 v62,v62,s36,v19
v_fma_f32 v63,v63,s36,v19
v_mfma_f32_16x16x32_bf16 v[236:239],a[252:255],v[116:119],v[236:239]
v_exp_f32 v36,v36
v_mfma_f32_16x16x32_bf16 a[28:31],a[252:255],v[120:123],a[28:31]
v_exp_f32 v37,v37
v_mfma_f32_16x16x32_bf16 a[76:79],a[252:255],v[124:127],a[76:79]
s_waitcnt lgkmcnt(2)
ds_read_b64_tr_b16 a[252:253],v6 offset:24832
ds_read_b64_tr_b16 a[254:255],v6 offset:30976
v_mfma_f32_16x16x32_bf16 v[192:195],a[240:243],v[112:115],v[192:195]
buffer_load_dwordx4 v8,s[4:7],s20 offen offset:1024 lds
v_mfma_f32_16x16x32_bf16 v[240:243],a[240:243],v[116:119],v[240:243]
v_exp_f32 v38,v38
v_mfma_f32_16x16x32_bf16 a[32:35],a[240:243],v[120:123],a[32:35]
v_exp_f32 v39,v39
v_mfma_f32_16x16x32_bf16 a[80:83],a[240:243],v[124:127],a[80:83]
v_exp_f32 v44,v44
v_mfma_f32_16x16x32_bf16 v[196:199],a[244:247],v[112:115],v[196:199]
v_exp_f32 v45,v45
v_mfma_f32_16x16x32_bf16 v[244:247],a[244:247],v[116:119],v[244:247]
v_exp_f32 v46,v46
v_mfma_f32_16x16x32_bf16 a[36:39],a[244:247],v[120:123],a[36:39]
v_exp_f32 v47,v47
v_mfma_f32_16x16x32_bf16 a[84:87],a[244:247],v[124:127],a[84:87]
s_waitcnt lgkmcnt(0)
v_exp_f32 v48,v48
v_mfma_f32_16x16x32_bf16 v[200:203],a[248:251],v[112:115],v[200:203]
buffer_load_dwordx4 v9,s[4:7],s20 offen offset:2048 lds
v_mfma_f32_16x16x32_bf16 v[248:251],a[248:251],v[116:119],v[248:251]
s_add_u32 s20,s20,12288
v_exp_f32 v49,v49
v_mfma_f32_16x16x32_bf16 a[40:43],a[248:251],v[120:123],a[40:43]
s_add_u32 m0,s29,0
v_exp_f32 v50,v50
v_mfma_f32_16x16x32_bf16 a[88:91],a[248:251],v[124:127],a[88:91]
v_exp_f32 v51,v51
v_mfma_f32_16x16x32_bf16 v[204:207],a[252:255],v[112:115],v[204:207]
v_exp_f32 v52,v52
v_mfma_f32_16x16x32_bf16 v[252:255],a[252:255],v[116:119],v[252:255]
v_exp_f32 v53,v53
v_mfma_f32_16x16x32_bf16 a[44:47],a[252:255],v[120:123],a[44:47]
v_exp_f32 v54,v54
v_mfma_f32_16x16x32_bf16 a[92:95],a[252:255],v[124:127],a[92:95]
v_exp_f32 v55,v55
v_mfma_f32_16x16x32_bf16 v[64:67],a[192:195],a[96:99],0
v_exp_f32 v56,v56
v_mfma_f32_16x16x32_bf16 v[64:67],a[196:199],a[100:103],v[64:67]
v_exp_f32 v57,v57
v_mfma_f32_16x16x32_bf16 v[64:67],a[200:203],a[104:107],v[64:67]
v_exp_f32 v58,v58
v_mfma_f32_16x16x32_bf16 v[64:67],a[204:207],a[108:111],v[64:67]
v_exp_f32 v59,v59
v_mfma_f32_16x16x32_bf16 v[64:67],a[208:211],a[112:115],v[64:67]
v_exp_f32 v60,v60
v_mfma_f32_16x16x32_bf16 v[64:67],a[212:215],a[116:119],v[64:67]
buffer_load_dwordx4 v7,s[12:15],s28 offen offset:0 nt lds
v_mfma_f32_16x16x32_bf16 v[72:75],a[192:195],a[120:123],0
v_exp_f32 v61,v61
v_mfma_f32_16x16x32_bf16 v[72:75],a[196:199],a[124:127],v[72:75]
v_exp_f32 v62,v62
v_mfma_f32_16x16x32_bf16 v[72:75],a[200:203],a[128:131],v[72:75]
v_exp_f32 v63,v63
v_mfma_f32_16x16x32_bf16 v[72:75],a[204:207],a[132:135],v[72:75]
v_cvt_pk_bf16_f32 v98,v36,v37
v_cvt_pk_bf16_f32 v99,v38,v39
v_mfma_f32_16x16x32_bf16 v[72:75],a[208:211],a[136:139],v[72:75]
v_cvt_pk_bf16_f32 v102,v44,v45
v_cvt_pk_bf16_f32 v103,v46,v47
v_mfma_f32_16x16x32_bf16 v[128:131],v[24:27],v[96:99],v[128:131]
v_cvt_pk_bf16_f32 v104,v48,v49
v_cvt_pk_bf16_f32 v105,v50,v51
v_mfma_f32_16x16x32_bf16 v[132:135],v[24:27],v[100:103],v[132:135]
v_cvt_pk_bf16_f32 v106,v52,v53
v_cvt_pk_bf16_f32 v107,v54,v55
v_mfma_f32_16x16x32_bf16 v[72:75],a[212:215],a[140:143],v[72:75]
v_cvt_pk_bf16_f32 v108,v56,v57
v_cvt_pk_bf16_f32 v109,v58,v59
v_mfma_f32_16x16x32_bf16 v[136:139],v[24:27],v[104:107],v[136:139]
v_cvt_pk_bf16_f32 v110,v60,v61
v_cvt_pk_bf16_f32 v111,v62,v63
v_mfma_f32_16x16x32_bf16 v[80:83],a[192:195],a[144:147],0
v_fma_f32 v64,v64,s36,v16
v_fma_f32 v65,v65,s36,v16
v_mfma_f32_16x16x32_bf16 v[140:143],v[24:27],v[108:111],v[140:143]
buffer_load_dwordx4 v8,s[12:15],s28 offen offset:1024 nt lds
v_mfma_f32_16x16x32_bf16 v[80:83],a[196:199],a[148:151],v[80:83]
v_fma_f32 v66,v66,s36,v16
v_fma_f32 v67,v67,s36,v16
v_mfma_f32_16x16x32_bf16 v[80:83],a[200:203],a[152:155],v[80:83]
v_fma_f32 v72,v72,s36,v17
v_fma_f32 v73,v73,s36,v17
v_mfma_f32_16x16x32_bf16 v[80:83],a[204:207],a[156:159],v[80:83]
v_fma_f32 v74,v74,s36,v17
v_fma_f32 v75,v75,s36,v17
v_mfma_f32_16x16x32_bf16 v[80:83],a[208:211],a[160:163],v[80:83]
v_exp_f32 v64,v64
v_mfma_f32_16x16x32_bf16 v[80:83],a[212:215],a[164:167],v[80:83]
v_exp_f32 v65,v65
v_mfma_f32_16x16x32_bf16 v[88:91],a[192:195],a[168:171],0
v_exp_f32 v66,v66
v_mfma_f32_16x16x32_bf16 v[88:91],a[196:199],a[172:175],v[88:91]
v_exp_f32 v67,v67
v_mfma_f32_16x16x32_bf16 v[88:91],a[200:203],a[176:179],v[88:91]
v_exp_f32 v72,v72
v_mfma_f32_16x16x32_bf16 v[88:91],a[204:207],a[180:183],v[88:91]
v_exp_f32 v73,v73
v_mfma_f32_16x16x32_bf16 v[88:91],a[208:211],a[184:187],v[88:91]
v_exp_f32 v74,v74
v_mfma_f32_16x16x32_bf16 v[88:91],a[212:215],a[188:191],v[88:91]
v_exp_f32 v75,v75
v_mfma_f32_16x16x32_bf16 v[68:71],a[216:219],a[96:99],0
buffer_load_dwordx4 v9,s[12:15],s28 offen offset:2048 nt lds
v_mfma_f32_16x16x32_bf16 v[68:71],a[220:223],a[100:103],v[68:71]
s_add_u32 s28,s28,3072
v_cvt_pk_bf16_f32 v112,v64,v65
v_cvt_pk_bf16_f32 v113,v66,v67
v_mfma_f32_16x16x32_bf16 v[68:71],a[224:227],a[104:107],v[68:71]
s_add_u32 s29,s29,3072
v_cvt_pk_bf16_f32 v116,v72,v73
v_cvt_pk_bf16_f32 v117,v74,v75
v_mfma_f32_16x16x32_bf16 v[68:71],a[228:231],a[108:111],v[68:71]
v_mfma_f32_16x16x32_bf16 v[68:71],a[232:235],a[112:115],v[68:71]
s_waitcnt vmcnt(12)
s_barrier
v_mfma_f32_16x16x32_bf16 v[68:71],a[236:239],a[116:119],v[68:71]
v_mfma_f32_16x16x32_bf16 v[76:79],a[216:219],a[120:123],0
v_mfma_f32_16x16x32_bf16 v[76:79],a[220:223],a[124:127],v[76:79]
v_mfma_f32_16x16x32_bf16 v[76:79],a[224:227],a[128:131],v[76:79]
v_mfma_f32_16x16x32_bf16 v[76:79],a[228:231],a[132:135],v[76:79]
v_mfma_f32_16x16x32_bf16 v[76:79],a[232:235],a[136:139],v[76:79]
ds_read_b64_tr_b16 a[240:241],v3 offset:0
v_mfma_f32_16x16x32_bf16 v[76:79],a[236:239],a[140:143],v[76:79]
ds_read_b64_tr_b16 a[242:243],v3 offset:6144
v_mfma_f32_16x16x32_bf16 v[84:87],a[216:219],a[144:147],0
ds_read_b64_tr_b16 a[244:245],v4 offset:0
v_mfma_f32_16x16x32_bf16 v[84:87],a[220:223],a[148:151],v[84:87]
ds_read_b64_tr_b16 a[246:247],v4 offset:6144
v_mfma_f32_16x16x32_bf16 v[84:87],a[224:227],a[152:155],v[84:87]
ds_read_b64_tr_b16 a[248:249],v5 offset:0
v_mfma_f32_16x16x32_bf16 v[84:87],a[228:231],a[156:159],v[84:87]
ds_read_b64_tr_b16 a[250:251],v5 offset:6144
v_mfma_f32_16x16x32_bf16 v[84:87],a[232:235],a[160:163],v[84:87]
ds_read_b64_tr_b16 a[252:253],v6 offset:0
v_mfma_f32_16x16x32_bf16 v[84:87],a[236:239],a[164:167],v[84:87]
ds_read_b64_tr_b16 a[254:255],v6 offset:6144
v_mfma_f32_16x16x32_bf16 v[92:95],a[216:219],a[168:171],0
v_mfma_f32_16x16x32_bf16 v[92:95],a[220:223],a[172:175],v[92:95]
v_mfma_f32_16x16x32_bf16 v[92:95],a[224:227],a[176:179],v[92:95]
v_mfma_f32_16x16x32_bf16 v[92:95],a[228:231],a[180:183],v[92:95]
v_mfma_f32_16x16x32_bf16 v[92:95],a[232:235],a[184:187],v[92:95]
v_mfma_f32_16x16x32_bf16 v[92:95],a[236:239],a[188:191],v[92:95]
s_waitcnt lgkmcnt(3)
v_mfma_f32_16x16x32_bf16 v[160:163],a[240:243],v[96:99],v[160:163]
s_add_u32 m0,s23,24576
ds_read_b128 a[192:195],v1 offset:24576
v_fma_f32 v68,v68,s36,v16
v_mfma_f32_16x16x32_bf16 v[208:211],a[240:243],v[100:103],v[208:211]
buffer_load_dwordx4 v7,s[8:11],s21 offen offset:0 lds
v_mfma_f32_16x16x32_bf16 a[0:3],a[240:243],v[104:107],a[0:3]
ds_read_b128 a[196:199],v2 offset:24576
v_fma_f32 v69,v69,s36,v16
v_mfma_f32_16x16x32_bf16 a[48:51],a[240:243],v[108:111],a[48:51]
ds_read_b64_tr_b16 a[240:241],v3 offset:128
ds_read_b64_tr_b16 a[242:243],v3 offset:6272
v_mfma_f32_16x16x32_bf16 v[164:167],a[244:247],v[96:99],v[164:167]
ds_read_b128 a[200:203],v1 offset:24704
v_fma_f32 v70,v70,s36,v16
v_mfma_f32_16x16x32_bf16 v[212:215],a[244:247],v[100:103],v[212:215]
ds_read_b128 a[204:207],v2 offset:24704
v_fma_f32 v71,v71,s36,v16
v_mfma_f32_16x16x32_bf16 a[4:7],a[244:247],v[104:107],a[4:7]
ds_read_b128 a[208:211],v1 offset:24832
v_fma_f32 v76,v76,s36,v17
v_mfma_f32_16x16x32_bf16 a[52:55],a[244:247],v[108:111],a[52:55]
s_waitcnt lgkmcnt(7)
ds_read_b64_tr_b16 a[244:245],v4 offset:128
ds_read_b64_tr_b16 a[246:247],v4 offset:6272
v_mfma_f32_16x16x32_bf16 v[168:171],a[248:251],v[96:99],v[168:171]
ds_read_b128 a[212:215],v2 offset:24832
v_fma_f32 v77,v77,s36,v17
v_mfma_f32_16x16x32_bf16 v[216:219],a[248:251],v[100:103],v[216:219]
buffer_load_dwordx4 v8,s[8:11],s21 offen offset:1024 lds
v_mfma_f32_16x16x32_bf16 a[8:11],a[248:251],v[104:107],a[8:11]
ds_read_b128 a[216:219],v1 offset:30720
v_fma_f32 v78,v78,s36,v17
v_mfma_f32_16x16x32_bf16 a[56:59],a[248:251],v[108:111],a[56:59]
ds_read_b64_tr_b16 a[248:249],v5 offset:128
ds_read_b64_tr_b16 a[250:251],v5 offset:6272
v_mfma_f32_16x16x32_bf16 v[172:175],a[252:255],v[96:99],v[172:175]
ds_read_b128 a[220:223],v2 offset:30720
v_fma_f32 v79,v79,s36,v17
v_mfma_f32_16x16x32_bf16 v[220:223],a[252:255],v[100:103],v[220:223]
ds_read_b128 a[224:227],v1 offset:30848
v_fma_f32 v80,v80,s36,v18
v_mfma_f32_16x16x32_bf16 a[12:15],a[252:255],v[104:107],a[12:15]
ds_read_b128 a[228:231],v2 offset:30848
v_fma_f32 v81,v81,s36,v18
v_mfma_f32_16x16x32_bf16 a[60:63],a[252:255],v[108:111],a[60:63]
s_waitcnt lgkmcnt(7)
ds_read_b64_tr_b16 a[252:253],v6 offset:128
ds_read_b64_tr_b16 a[254:255],v6 offset:6272
v_mfma_f32_16x16x32_bf16 v[176:179],a[240:243],v[96:99],v[176:179]
ds_read_b128 a[232:235],v1 offset:30976
v_fma_f32 v82,v82,s36,v18
v_mfma_f32_16x16x32_bf16 v[224:227],a[240:243],v[100:103],v[224:227]
buffer_load_dwordx4 v9,s[8:11],s21 offen offset:2048 lds
v_mfma_f32_16x16x32_bf16 a[16:19],a[240:243],v[104:107],a[16:19]
s_add_u32 s21,s21,12288
ds_read_b128 a[236:239],v2 offset:30976
v_fma_f32 v83,v83,s36,v18
v_mfma_f32_16x16x32_bf16 a[64:67],a[240:243],v[108:111],a[64:67]
s_add_u32 m0,s25,0
ds_read_b64_tr_b16 a[240:241],v3 offset:256
ds_read_b64_tr_b16 a[242:243],v3 offset:6400
v_mfma_f32_16x16x32_bf16 v[180:183],a[244:247],v[96:99],v[180:183]
v_fma_f32 v84,v84,s36,v18
v_fma_f32 v85,v85,s36,v18
v_mfma_f32_16x16x32_bf16 v[228:231],a[244:247],v[100:103],v[228:231]
v_fma_f32 v86,v86,s36,v18
v_fma_f32 v87,v87,s36,v18
v_mfma_f32_16x16x32_bf16 a[20:23],a[244:247],v[104:107],a[20:23]
v_fma_f32 v88,v88,s36,v19
v_fma_f32 v89,v89,s36,v19
v_mfma_f32_16x16x32_bf16 a[68:71],a[244:247],v[108:111],a[68:71]
s_waitcnt lgkmcnt(4)
ds_read_b64_tr_b16 a[244:245],v4 offset:256
ds_read_b64_tr_b16 a[246:247],v4 offset:6400
v_mfma_f32_16x16x32_bf16 v[184:187],a[248:251],v[96:99],v[184:187]
buffer_load_dwordx4 v7,s[4:7],s20 offen offset:0 lds
v_mfma_f32_16x16x32_bf16 v[232:235],a[248:251],v[100:103],v[232:235]
v_fma_f32 v90,v90,s36,v19
v_fma_f32 v91,v91,s36,v19
v_mfma_f32_16x16x32_bf16 a[24:27],a[248:251],v[104:107],a[24:27]
v_fma_f32 v92,v92,s36,v19
v_fma_f32 v93,v93,s36,v19
v_mfma_f32_16x16x32_bf16 a[72:75],a[248:251],v[108:111],a[72:75]
ds_read_b64_tr_b16 a[248:249],v5 offset:256
ds_read_b64_tr_b16 a[250:251],v5 offset:6400
v_mfma_f32_16x16x32_bf16 v[188:191],a[252:255],v[96:99],v[188:191]
v_fma_f32 v94,v94,s36,v19
v_fma_f32 v95,v95,s36,v19
v_mfma_f32_16x16x32_bf16 v[236:239],a[252:255],v[100:103],v[236:239]
v_exp_f32 v68,v68
v_mfma_f32_16x16x32_bf16 a[28:31],a[252:255],v[104:107],a[28:31]
v_exp_f32 v69,v69
v_mfma_f32_16x16x32_bf16 a[76:79],a[252:255],v[108:111],a[76:79]
s_waitcnt lgkmcnt(2)
ds_read_b64_tr_b16 a[252:253],v6 offset:256
ds_read_b64_tr_b16 a[254:255],v6 offset:6400
v_mfma_f32_16x16x32_bf16 v[192:195],a[240:243],v[96:99],v[192:195]
buffer_load_dwordx4 v8,s[4:7],s20 offen offset:1024 lds
v_mfma_f32_16x16x32_bf16 v[240:243],a[240:243],v[100:103],v[240:243]
v_exp_f32 v70,v70
v_mfma_f32_16x16x32_bf16 a[32:35],a[240:243],v[104:107],a[32:35]
v_exp_f32 v71,v71
v_mfma_f32_16x16x32_bf16 a[80:83],a[240:243],v[108:111],a[80:83]
v_exp_f32 v76,v76
v_mfma_f32_16x16x32_bf16 v[196:199],a[244:247],v[96:99],v[196:199]
v_exp_f32 v77,v77
v_mfma_f32_16x16x32_bf16 v[244:247],a[244:247],v[100:103],v[244:247]
ds_read_b128 v[156:159],v11 offset:6144
v_cvt_pk_bf16_f32 v114,v68,v69
v_mfma_f32_16x16x32_bf16 a[36:39],a[244:247],v[104:107],a[36:39]
v_exp_f32 v78,v78
v_mfma_f32_16x16x32_bf16 a[84:87],a[244:247],v[108:111],a[84:87]
s_waitcnt lgkmcnt(1)
v_exp_f32 v79,v79
v_mfma_f32_16x16x32_bf16 v[200:203],a[248:251],v[96:99],v[200:203]
buffer_load_dwordx4 v9,s[4:7],s20 offen offset:2048 lds
v_mfma_f32_16x16x32_bf16 v[248:251],a[248:251],v[100:103],v[248:251]
s_add_u32 s20,s20,12288
v_exp_f32 v80,v80
v_mfma_f32_16x16x32_bf16 a[40:43],a[248:251],v[104:107],a[40:43]
v_exp_f32 v81,v81
v_mfma_f32_16x16x32_bf16 a[88:91],a[248:251],v[108:111],a[88:91]
v_exp_f32 v82,v82
v_mfma_f32_16x16x32_bf16 v[204:207],a[252:255],v[96:99],v[204:207]
v_exp_f32 v83,v83
v_mfma_f32_16x16x32_bf16 v[252:255],a[252:255],v[100:103],v[252:255]
v_exp_f32 v84,v84
v_mfma_f32_16x16x32_bf16 a[44:47],a[252:255],v[104:107],a[44:47]
v_exp_f32 v85,v85
v_mfma_f32_16x16x32_bf16 a[92:95],a[252:255],v[108:111],a[92:95]
v_exp_f32 v86,v86
v_mfma_f32_16x16x32_bf16 v[32:35],a[192:195],a[96:99],0
ds_read_b128 v[152:155],v23 offset:6144
v_mfma_f32_16x16x32_bf16 v[32:35],a[196:199],a[100:103],v[32:35]
v_exp_f32 v87,v87
v_mfma_f32_16x16x32_bf16 v[32:35],a[200:203],a[104:107],v[32:35]
v_exp_f32 v88,v88
v_mfma_f32_16x16x32_bf16 v[32:35],a[204:207],a[108:111],v[32:35]
v_exp_f32 v89,v89
v_mfma_f32_16x16x32_bf16 v[32:35],a[208:211],a[112:115],v[32:35]
v_exp_f32 v90,v90
v_mfma_f32_16x16x32_bf16 v[32:35],a[212:215],a[116:119],v[32:35]
s_waitcnt lgkmcnt(1)
buffer_store_dwordx4 v[156:159],v0,s[16:19],s27 offen offset:0 nt
v_exp_f32 v91,v91
v_cvt_pk_bf16_f32 v115,v70,v71
v_mfma_f32_16x16x32_bf16 v[40:43],a[192:195],a[120:123],0
v_exp_f32 v92,v92
v_mfma_f32_16x16x32_bf16 v[128:131],v[24:27],v[112:115],v[128:131]
v_exp_f32 v93,v93
v_mfma_f32_16x16x32_bf16 v[40:43],a[196:199],a[124:127],v[40:43]
v_exp_f32 v94,v94
v_mfma_f32_16x16x32_bf16 v[40:43],a[200:203],a[128:131],v[40:43]
v_exp_f32 v95,v95
v_mfma_f32_16x16x32_bf16 v[40:43],a[204:207],a[132:135],v[40:43]
v_cvt_pk_bf16_f32 v118,v76,v77
v_cvt_pk_bf16_f32 v119,v78,v79
v_mfma_f32_16x16x32_bf16 v[40:43],a[208:211],a[136:139],v[40:43]
ds_read_b128 v[156:159],v31 offset:6144
v_mfma_f32_16x16x32_bf16 v[132:135],v[24:27],v[116:119],v[132:135]
v_cvt_pk_bf16_f32 v120,v80,v81
v_cvt_pk_bf16_f32 v121,v82,v83
v_mfma_f32_16x16x32_bf16 v[40:43],a[212:215],a[140:143],v[40:43]
v_cvt_pk_bf16_f32 v122,v84,v85
v_cvt_pk_bf16_f32 v123,v86,v87
v_mfma_f32_16x16x32_bf16 v[48:51],a[192:195],a[144:147],0
v_cvt_pk_bf16_f32 v124,v88,v89
v_cvt_pk_bf16_f32 v125,v90,v91
v_mfma_f32_16x16x32_bf16 v[136:139],v[24:27],v[120:123],v[136:139]
v_cvt_pk_bf16_f32 v126,v92,v93
v_cvt_pk_bf16_f32 v127,v94,v95
v_mfma_f32_16x16x32_bf16 v[48:51],a[196:199],a[148:151],v[48:51]
s_waitcnt lgkmcnt(1)
buffer_store_dwordx4 v[152:155],v0,s[16:19],s27 offen offset:1024 nt
v_fma_f32 v32,v32,s36,v16
v_fma_f32 v33,v33,s36,v16
v_fma_f32 v34,v34,s36,v16
v_mfma_f32_16x16x32_bf16 v[140:143],v[24:27],v[124:127],v[140:143]
v_fma_f32 v35,v35,s36,v16
v_fma_f32 v40,v40,s36,v17
v_mfma_f32_16x16x32_bf16 v[48:51],a[200:203],a[152:155],v[48:51]
v_fma_f32 v41,v41,s36,v17
v_fma_f32 v42,v42,s36,v17
v_mfma_f32_16x16x32_bf16 v[48:51],a[204:207],a[156:159],v[48:51]
v_fma_f32 v43,v43,s36,v17
v_mfma_f32_16x16x32_bf16 v[48:51],a[208:211],a[160:163],v[48:51]
v_exp_f32 v32,v32
v_mfma_f32_16x16x32_bf16 v[48:51],a[212:215],a[164:167],v[48:51]
v_exp_f32 v33,v33
v_mfma_f32_16x16x32_bf16 v[56:59],a[192:195],a[168:171],0
v_exp_f32 v34,v34
v_mfma_f32_16x16x32_bf16 v[56:59],a[196:199],a[172:175],v[56:59]
v_exp_f32 v35,v35
v_mfma_f32_16x16x32_bf16 v[56:59],a[200:203],a[176:179],v[56:59]
v_exp_f32 v40,v40
v_mfma_f32_16x16x32_bf16 v[56:59],a[204:207],a[180:183],v[56:59]
v_exp_f32 v41,v41
v_mfma_f32_16x16x32_bf16 v[56:59],a[208:211],a[184:187],v[56:59]
v_exp_f32 v42,v42
v_mfma_f32_16x16x32_bf16 v[56:59],a[212:215],a[188:191],v[56:59]
s_waitcnt lgkmcnt(0)
buffer_store_dwordx4 v[156:159],v0,s[16:19],s27 offen offset:2048 nt
v_exp_f32 v43,v43
v_cvt_pk_bf16_f32 v96,v32,v33
v_mfma_f32_16x16x32_bf16 v[36:39],a[216:219],a[96:99],0
s_add_u32 s27,s27,3072
v_cvt_pk_bf16_f32 v97,v34,v35
v_cvt_pk_bf16_f32 v100,v40,v41
v_mfma_f32_16x16x32_bf16 v[36:39],a[220:223],a[100:103],v[36:39]
v_cvt_pk_bf16_f32 v101,v42,v43
v_mfma_f32_16x16x32_bf16 v[36:39],a[224:227],a[104:107],v[36:39]
s_waitcnt vmcnt(12)
v_mfma_f32_16x16x32_bf16 v[36:39],a[228:231],a[108:111],v[36:39]
s_barrier
v_mfma_f32_16x16x32_bf16 v[36:39],a[232:235],a[112:115],v[36:39]
v_mfma_f32_16x16x32_bf16 v[36:39],a[236:239],a[116:119],v[36:39]
v_mfma_f32_16x16x32_bf16 v[44:47],a[216:219],a[120:123],0
v_mfma_f32_16x16x32_bf16 v[44:47],a[220:223],a[124:127],v[44:47]
v_mfma_f32_16x16x32_bf16 v[44:47],a[224:227],a[128:131],v[44:47]
v_mfma_f32_16x16x32_bf16 v[44:47],a[228:231],a[132:135],v[44:47]
ds_read_b64_tr_b16 a[240:241],v3 offset:12288
ds_read_b64_tr_b16 a[242:243],v3 offset:18432
v_mfma_f32_16x16x32_bf16 v[44:47],a[232:235],a[136:139],v[44:47]
v_mfma_f32_16x16x32_bf16 v[44:47],a[236:239],a[140:143],v[44:47]
ds_read_b64_tr_b16 a[244:245],v4 offset:12288
ds_read_b64_tr_b16 a[246:247],v4 offset:18432
v_mfma_f32_16x16x32_bf16 v[52:55],a[216:219],a[144:147],0
v_mfma_f32_16x16x32_bf16 v[52:55],a[220:223],a[148:151],v[52:55]
ds_read_b64_tr_b16 a[248:249],v5 offset:12288
ds_read_b64_tr_b16 a[250:251],v5 offset:18432
v_mfma_f32_16x16x32_bf16 v[52:55],a[224:227],a[152:155],v[52:55]
v_mfma_f32_16x16x32_bf16 v[52:55],a[228:231],a[156:159],v[52:55]
ds_read_b64_tr_b16 a[252:253],v6 offset:12288
ds_read_b64_tr_b16 a[254:255],v6 offset:18432
v_mfma_f32_16x16x32_bf16 v[52:55],a[232:235],a[160:163],v[52:55]
v_mfma_f32_16x16x32_bf16 v[52:55],a[236:239],a[164:167],v[52:55]
v_mfma_f32_16x16x32_bf16 v[60:63],a[216:219],a[168:171],0
v_mfma_f32_16x16x32_bf16 v[60:63],a[220:223],a[172:175],v[60:63]
v_mfma_f32_16x16x32_bf16 v[60:63],a[224:227],a[176:179],v[60:63]
v_mfma_f32_16x16x32_bf16 v[60:63],a[228:231],a[180:183],v[60:63]
v_mfma_f32_16x16x32_bf16 v[60:63],a[232:235],a[184:187],v[60:63]
v_mfma_f32_16x16x32_bf16 v[60:63],a[236:239],a[188:191],v[60:63]
s_waitcnt lgkmcnt(2)
v_mfma_f32_16x16x32_bf16 v[160:163],a[240:243],v[112:115],v[160:163]
s_add_u32 m0,s23,0
ds_read_b128 a[192:195],v1 offset:0
v_fma_f32 v55,v55,s36,v18
v_mfma_f32_16x16x32_bf16 v[208:211],a[240:243],v[116:119],v[208:211]
buffer_load_dwordx4 v7,s[8:11],s21 offen offset:0 lds
v_mfma_f32_16x16x32_bf16 a[0:3],a[240:243],v[120:123],a[0:3]
ds_read_b128 a[200:203],v1 offset:128
v_fma_f32 v57,v57,s36,v19
v_mfma_f32_16x16x32_bf16 a[48:51],a[240:243],v[124:127],a[48:51]
ds_read_b64_tr_b16 a[240:241],v3 offset:12416
ds_read_b64_tr_b16 a[242:243],v3 offset:18560
v_mfma_f32_16x16x32_bf16 v[164:167],a[244:247],v[112:115],v[164:167]
ds_read_b128 a[204:207],v2 offset:128
v_fma_f32 v63,v63,s36,v19
v_mfma_f32_16x16x32_bf16 v[212:215],a[244:247],v[116:119],v[212:215]
ds_read_b128 a[196:199],v2 offset:0
v_fma_f32 v36,v36,s36,v16
v_mfma_f32_16x16x32_bf16 a[4:7],a[244:247],v[120:123],a[4:7]
ds_read_b128 a[212:215],v2 offset:256
v_fma_f32 v61,v61,s36,v19
v_mfma_f32_16x16x32_bf16 a[52:55],a[244:247],v[124:127],a[52:55]
ds_read_b64_tr_b16 a[246:247],v4 offset:18560
ds_read_b64_tr_b16 a[244:245],v4 offset:12416
v_mfma_f32_16x16x32_bf16 v[168:171],a[248:251],v[112:115],v[168:171]
ds_read_b128 a[208:211],v1 offset:256
v_fma_f32 v45,v45,s36,v17
v_mfma_f32_16x16x32_bf16 v[216:219],a[248:251],v[116:119],v[216:219]
buffer_load_dwordx4 v8,s[8:11],s21 offen offset:1024 lds
v_mfma_f32_16x16x32_bf16 a[8:11],a[248:251],v[120:123],a[8:11]
ds_read_b128 a[216:219],v1 offset:6144
v_fma_f32 v46,v46,s36,v17
v_mfma_f32_16x16x32_bf16 a[56:59],a[248:251],v[124:127],a[56:59]
s_waitcnt lgkmcnt(8)
ds_read_b64_tr_b16 a[250:251],v5 offset:18560
ds_read_b64_tr_b16 a[248:249],v5 offset:12416
v_mfma_f32_16x16x32_bf16 v[172:175],a[252:255],v[112:115],v[172:175]
ds_read_b128 a[224:227],v1 offset:6272
v_fma_f32 v50,v50,s36,v18
v_mfma_f32_16x16x32_bf16 v[220:223],a[252:255],v[116:119],v[220:223]
ds_read_b128 a[220:223],v2 offset:6144
v_fma_f32 v37,v37,s36,v16
v_mfma_f32_16x16x32_bf16 a[12:15],a[252:255],v[120:123],a[12:15]
ds_read_b128 a[228:231],v2 offset:6272
v_fma_f32 v58,v58,s36,v19
v_mfma_f32_16x16x32_bf16 a[60:63],a[252:255],v[124:127],a[60:63]
s_waitcnt lgkmcnt(7)
ds_read_b64_tr_b16 a[252:253],v6 offset:12416
ds_read_b64_tr_b16 a[254:255],v6 offset:18560
v_mfma_f32_16x16x32_bf16 v[176:179],a[240:243],v[112:115],v[176:179]
ds_read_b128 a[236:239],v2 offset:6400
v_fma_f32 v39,v39,s36,v16
v_mfma_f32_16x16x32_bf16 v[224:227],a[240:243],v[116:119],v[224:227]
buffer_load_dwordx4 v9,s[8:11],s21 offen offset:2048 lds
v_mfma_f32_16x16x32_bf16 a[16:19],a[240:243],v[120:123],a[16:19]
s_add_u32 s21,s21,12288
ds_read_b128 a[232:235],v1 offset:6400
v_fma_f32 v60,v60,s36,v19
v_mfma_f32_16x16x32_bf16 a[64:67],a[240:243],v[124:127],a[64:67]
s_add_u32 m0,s26,0
ds_read_b64_tr_b16 a[240:241],v3 offset:12544
ds_read_b64_tr_b16 a[242:243],v3 offset:18688
v_mfma_f32_16x16x32_bf16 v[180:183],a[244:247],v[112:115],v[180:183]
v_fma_f32 v54,v54,s36,v18
v_fma_f32 v59,v59,s36,v19
v_mfma_f32_16x16x32_bf16 v[228:231],a[244:247],v[116:119],v[228:231]
v_fma_f32 v56,v56,s36,v19
v_fma_f32 v52,v52,s36,v18
v_mfma_f32_16x16x32_bf16 a[20:23],a[244:247],v[120:123],a[20:23]
v_fma_f32 v44,v44,s36,v17
v_fma_f32 v38,v38,s36,v16
v_mfma_f32_16x16x32_bf16 a[68:71],a[244:247],v[124:127],a[68:71]
s_waitcnt lgkmcnt(4)
ds_read_b64_tr_b16 a[246:247],v4 offset:18688
ds_read_b64_tr_b16 a[244:245],v4 offset:12544
v_mfma_f32_16x16x32_bf16 v[184:187],a[248:251],v[112:115],v[184:187]
buffer_load_dwordx4 v7,s[4:7],s20 offen offset:0 lds
v_mfma_f32_16x16x32_bf16 v[232:235],a[248:251],v[116:119],v[232:235]
v_fma_f32 v48,v48,s36,v18
v_fma_f32 v47,v47,s36,v17
v_mfma_f32_16x16x32_bf16 a[24:27],a[248:251],v[120:123],a[24:27]
v_fma_f32 v51,v51,s36,v18
v_fma_f32 v53,v53,s36,v18
v_mfma_f32_16x16x32_bf16 a[72:75],a[248:251],v[124:127],a[72:75]
ds_read_b64_tr_b16 a[250:251],v5 offset:18688
ds_read_b64_tr_b16 a[248:249],v5 offset:12544
v_mfma_f32_16x16x32_bf16 v[188:191],a[252:255],v[112:115],v[188:191]
v_fma_f32 v62,v62,s36,v19
v_add_u32 v31,9216,v31
v_mfma_f32_16x16x32_bf16 v[236:239],a[252:255],v[116:119],v[236:239]
v_exp_f32 v55,v55
v_mfma_f32_16x16x32_bf16 a[28:31],a[252:255],v[120:123],a[28:31]
v_fma_f32 v49,v49,s36,v18
v_add_u32 v11,9216,v11
v_mfma_f32_16x16x32_bf16 a[76:79],a[252:255],v[124:127],a[76:79]
s_waitcnt lgkmcnt(2)
ds_read_b64_tr_b16 a[254:255],v6 offset:18688
ds_read_b64_tr_b16 a[252:253],v6 offset:12544
v_mfma_f32_16x16x32_bf16 v[192:195],a[240:243],v[112:115],v[192:195]
buffer_load_dwordx4 v8,s[4:7],s20 offen offset:1024 lds
v_mfma_f32_16x16x32_bf16 v[240:243],a[240:243],v[116:119],v[240:243]
v_exp_f32 v49,v49
v_mfma_f32_16x16x32_bf16 a[32:35],a[240:243],v[120:123],a[32:35]
v_exp_f32 v36,v36
v_mfma_f32_16x16x32_bf16 a[80:83],a[240:243],v[124:127],a[80:83]
v_exp_f32 v54,v54
v_mfma_f32_16x16x32_bf16 v[196:199],a[244:247],v[112:115],v[196:199]
v_exp_f32 v53,v53
v_mfma_f32_16x16x32_bf16 v[244:247],a[244:247],v[116:119],v[244:247]
v_exp_f32 v51,v51
v_mfma_f32_16x16x32_bf16 a[36:39],a[244:247],v[120:123],a[36:39]
v_exp_f32 v57,v57
v_mfma_f32_16x16x32_bf16 a[84:87],a[244:247],v[124:127],a[84:87]
s_waitcnt lgkmcnt(0)
v_cvt_pk_bf16_f32 v107,v54,v55
v_add_u32 v23,9216,v23
v_mfma_f32_16x16x32_bf16 v[200:203],a[248:251],v[112:115],v[200:203]
buffer_load_dwordx4 v9,s[4:7],s20 offen offset:2048 lds
v_mfma_f32_16x16x32_bf16 v[248:251],a[248:251],v[116:119],v[248:251]
s_add_u32 s20,s20,12288
v_exp_f32 v47,v47
v_mfma_f32_16x16x32_bf16 a[40:43],a[248:251],v[120:123],a[40:43]
s_add_u32 m0,s29,0
v_exp_f32 v56,v56
v_mfma_f32_16x16x32_bf16 a[88:91],a[248:251],v[124:127],a[88:91]
v_cvt_pk_bf16_f32 v108,v56,v57
v_mfma_f32_16x16x32_bf16 v[204:207],a[252:255],v[112:115],v[204:207]
v_exp_f32 v38,v38
v_mfma_f32_16x16x32_bf16 v[252:255],a[252:255],v[116:119],v[252:255]
v_exp_f32 v61,v61
v_mfma_f32_16x16x32_bf16 a[44:47],a[252:255],v[120:123],a[44:47]
v_exp_f32 v46,v46
v_mfma_f32_16x16x32_bf16 a[92:95],a[252:255],v[124:127],a[92:95]
v_cvt_pk_bf16_f32 v103,v46,v47
v_mfma_f32_16x16x32_bf16 v[64:67],a[192:195],a[96:99],0
v_exp_f32 v37,v37
v_mfma_f32_16x16x32_bf16 v[64:67],a[196:199],a[100:103],v[64:67]
v_cvt_pk_bf16_f32 v98,v36,v37
v_mfma_f32_16x16x32_bf16 v[64:67],a[200:203],a[104:107],v[64:67]
v_exp_f32 v58,v58
v_mfma_f32_16x16x32_bf16 v[64:67],a[204:207],a[108:111],v[64:67]
v_exp_f32 v62,v62
v_mfma_f32_16x16x32_bf16 v[64:67],a[208:211],a[112:115],v[64:67]
v_exp_f32 v52,v52
v_mfma_f32_16x16x32_bf16 v[64:67],a[212:215],a[116:119],v[64:67]
buffer_load_dwordx4 v7,s[12:15],s28 offen offset:0 nt lds
v_mfma_f32_16x16x32_bf16 v[72:75],a[192:195],a[120:123],0
v_cvt_pk_bf16_f32 v106,v52,v53
v_mfma_f32_16x16x32_bf16 v[72:75],a[196:199],a[124:127],v[72:75]
v_exp_f32 v45,v45
v_mfma_f32_16x16x32_bf16 v[72:75],a[200:203],a[128:131],v[72:75]
v_exp_f32 v63,v63
v_mfma_f32_16x16x32_bf16 v[72:75],a[204:207],a[132:135],v[72:75]
v_fma_f32 v66,v66,s36,v16
v_fma_f32 v64,v64,s36,v16
v_mfma_f32_16x16x32_bf16 v[72:75],a[208:211],a[136:139],v[72:75]
v_fma_f32 v65,v65,s36,v16
v_fma_f32 v67,v67,s36,v16
v_mfma_f32_16x16x32_bf16 v[72:75],a[212:215],a[140:143],v[72:75]
v_cvt_pk_bf16_f32 v111,v62,v63
v_mfma_f32_16x16x32_bf16 v[80:83],a[192:195],a[144:147],0
v_exp_f32 v65,v65
v_mfma_f32_16x16x32_bf16 v[80:83],a[196:199],a[148:151],v[80:83]
v_exp_f32 v50,v50
v_mfma_f32_16x16x32_bf16 v[80:83],a[200:203],a[152:155],v[80:83]
v_cvt_pk_bf16_f32 v105,v50,v51
v_mfma_f32_16x16x32_bf16 v[80:83],a[204:207],a[156:159],v[80:83]
v_fma_f32 v73,v73,s36,v17
v_fma_f32 v72,v72,s36,v17
v_mfma_f32_16x16x32_bf16 v[80:83],a[208:211],a[160:163],v[80:83]
buffer_load_dwordx4 v8,s[12:15],s28 offen offset:1024 nt lds
v_mfma_f32_16x16x32_bf16 v[80:83],a[212:215],a[164:167],v[80:83]
v_fma_f32 v75,v75,s36,v17
v_fma_f32 v74,v74,s36,v17
v_mfma_f32_16x16x32_bf16 v[88:91],a[192:195],a[168:171],0
v_exp_f32 v48,v48
v_mfma_f32_16x16x32_bf16 v[88:91],a[196:199],a[172:175],v[88:91]
v_cvt_pk_bf16_f32 v104,v48,v49
v_mfma_f32_16x16x32_bf16 v[88:91],a[200:203],a[176:179],v[88:91]
v_exp_f32 v39,v39
v_mfma_f32_16x16x32_bf16 v[136:139],v[24:27],v[104:107],v[136:139]
v_cvt_pk_bf16_f32 v99,v38,v39
v_mfma_f32_16x16x32_bf16 v[88:91],a[204:207],a[180:183],v[88:91]
v_exp_f32 v67,v67
v_mfma_f32_16x16x32_bf16 v[128:131],v[24:27],v[96:99],v[128:131]
v_exp_f32 v72,v72
v_mfma_f32_16x16x32_bf16 v[88:91],a[208:211],a[184:187],v[88:91]
v_exp_f32 v44,v44
v_mfma_f32_16x16x32_bf16 v[88:91],a[212:215],a[188:191],v[88:91]
v_cvt_pk_bf16_f32 v102,v44,v45
v_mfma_f32_16x16x32_bf16 v[68:71],a[216:219],a[96:99],0
v_exp_f32 v60,v60
v_mfma_f32_16x16x32_bf16 v[132:135],v[24:27],v[100:103],v[132:135]
v_cvt_pk_bf16_f32 v110,v60,v61
v_mfma_f32_16x16x32_bf16 v[68:71],a[220:223],a[100:103],v[68:71]
buffer_load_dwordx4 v9,s[12:15],s28 offen offset:2048 nt lds
v_mfma_f32_16x16x32_bf16 v[68:71],a[224:227],a[104:107],v[68:71]
s_add_u32 s28,s28,3072
v_exp_f32 v59,v59
v_mfma_f32_16x16x32_bf16 v[68:71],a[228:231],a[108:111],v[68:71]
s_add_u32 s29,s29,3072
s_mov_b32 s25,s30
s_add_u32 s26,s22,12288
s_add_u32 s38,s38,1
s_cmp_lt_u32 s38,2
v_mfma_f32_16x16x32_bf16 v[68:71],a[232:235],a[112:115],v[68:71]
v_cvt_pk_bf16_f32 v109,v58,v59
s_waitcnt vmcnt(12)
v_mfma_f32_16x16x32_bf16 v[68:71],a[236:239],a[116:119],v[68:71]
s_barrier
v_mfma_f32_16x16x32_bf16 v[140:143],v[24:27],v[108:111],v[140:143]
v_exp_f32 v75,v75
v_mfma_f32_16x16x32_bf16 v[76:79],a[216:219],a[120:123],0
v_exp_f32 v66,v66
v_mfma_f32_16x16x32_bf16 v[76:79],a[220:223],a[124:127],v[76:79]
v_cvt_pk_bf16_f32 v113,v66,v67
v_mfma_f32_16x16x32_bf16 v[76:79],a[224:227],a[128:131],v[76:79]
v_exp_f32 v64,v64
v_mfma_f32_16x16x32_bf16 v[76:79],a[228:231],a[132:135],v[76:79]
v_cvt_pk_bf16_f32 v112,v64,v65
v_mfma_f32_16x16x32_bf16 v[76:79],a[232:235],a[136:139],v[76:79]
ds_read_b64_tr_b16 a[242:243],v3 offset:30720
ds_read_b64_tr_b16 a[240:241],v3 offset:24576
v_mfma_f32_16x16x32_bf16 v[76:79],a[236:239],a[140:143],v[76:79]
v_exp_f32 v73,v73
v_mfma_f32_16x16x32_bf16 v[84:87],a[216:219],a[144:147],0
ds_read_b64_tr_b16 a[246:247],v4 offset:30720
ds_read_b64_tr_b16 a[244:245],v4 offset:24576
v_mfma_f32_16x16x32_bf16 v[84:87],a[220:223],a[148:151],v[84:87]
v_cvt_pk_bf16_f32 v116,v72,v73
v_mfma_f32_16x16x32_bf16 v[84:87],a[224:227],a[152:155],v[84:87]
ds_read_b64_tr_b16 a[250:251],v5 offset:30720
ds_read_b64_tr_b16 a[248:249],v5 offset:24576
v_mfma_f32_16x16x32_bf16 v[84:87],a[228:231],a[156:159],v[84:87]
v_exp_f32 v74,v74
v_mfma_f32_16x16x32_bf16 v[84:87],a[232:235],a[160:163],v[84:87]
ds_read_b64_tr_b16 a[252:253],v6 offset:24576
ds_read_b64_tr_b16 a[254:255],v6 offset:30720
v_mfma_f32_16x16x32_bf16 v[84:87],a[236:239],a[164:167],v[84:87]
v_cvt_pk_bf16_f32 v117,v74,v75
v_mfma_f32_16x16x32_bf16 v[92:95],a[216:219],a[168:171],0
v_mfma_f32_16x16x32_bf16 v[92:95],a[220:223],a[172:175],v[92:95]
v_mfma_f32_16x16x32_bf16 v[92:95],a[224:227],a[176:179],v[92:95]
v_mfma_f32_16x16x32_bf16 v[92:95],a[228:231],a[180:183],v[92:95]
v_mfma_f32_16x16x32_bf16 v[92:95],a[232:235],a[184:187],v[92:95]
v_mfma_f32_16x16x32_bf16 v[92:95],a[236:239],a[188:191],v[92:95]
s_cbranch_scc1 L_loop4w1
s_cmp_ge_u32 s69,8
s_cbranch_scc1 L_end4
s_cmp_eq_u32 s40,0
s_cbranch_scc1 L_tr43
s_branch L_tr44
L_tr43:
s_waitcnt vmcnt(36)
s_waitcnt lgkmcnt(4)
v_mfma_f32_16x16x32_bf16 v[160:163],a[240:243],v[96:99],v[160:163]
ds_read_b128 a[96:99],v28 offset:0
v_fma_f32 v68,v68,s36,v16
v_mfma_f32_16x16x32_bf16 v[208:211],a[240:243],v[100:103],v[208:211]
ds_read_b128 a[100:103],v29 offset:0
v_fma_f32 v69,v69,s36,v16
v_mfma_f32_16x16x32_bf16 a[0:3],a[240:243],v[104:107],a[0:3]
ds_read_b128 a[104:107],v28 offset:128
v_fma_f32 v70,v70,s36,v16
v_mfma_f32_16x16x32_bf16 a[48:51],a[240:243],v[108:111],a[48:51]
ds_read_b128 a[108:111],v29 offset:128
v_fma_f32 v71,v71,s36,v16
v_mfma_f32_16x16x32_bf16 v[164:167],a[244:247],v[96:99],v[164:167]
ds_read_b128 a[112:115],v28 offset:256
v_fma_f32 v76,v76,s36,v17
v_mfma_f32_16x16x32_bf16 v[212:215],a[244:247],v[100:103],v[212:215]
ds_read_b128 a[116:119],v29 offset:256
v_fma_f32 v77,v77,s36,v17
v_mfma_f32_16x16x32_bf16 a[4:7],a[244:247],v[104:107],a[4:7]
ds_read_b64_tr_b16 a[240:241],v3 offset:24704
ds_read_b64_tr_b16 a[242:243],v3 offset:30848
v_mfma_f32_16x16x32_bf16 a[52:55],a[244:247],v[108:111],a[52:55]
s_waitcnt lgkmcnt(8)
ds_read_b64_tr_b16 a[244:245],v4 offset:24704
ds_read_b64_tr_b16 a[246:247],v4 offset:30848
v_mfma_f32_16x16x32_bf16 v[168:171],a[248:251],v[96:99],v[168:171]
ds_read_b128 a[192:195],v13 offset:0
v_fma_f32 v78,v78,s36,v17
v_mfma_f32_16x16x32_bf16 v[216:219],a[248:251],v[100:103],v[216:219]
ds_read_b128 a[196:199],v14 offset:0
v_fma_f32 v79,v79,s36,v17
v_mfma_f32_16x16x32_bf16 a[8:11],a[248:251],v[104:107],a[8:11]
ds_read_b128 a[200:203],v13 offset:128
v_fma_f32 v80,v80,s36,v18
v_mfma_f32_16x16x32_bf16 a[56:59],a[248:251],v[108:111],a[56:59]
ds_read_b64_tr_b16 a[248:249],v5 offset:24704
ds_read_b64_tr_b16 a[250:251],v5 offset:30848
v_mfma_f32_16x16x32_bf16 v[172:175],a[252:255],v[96:99],v[172:175]
ds_read_b128 a[204:207],v14 offset:128
v_fma_f32 v81,v81,s36,v18
v_mfma_f32_16x16x32_bf16 v[220:223],a[252:255],v[100:103],v[220:223]
ds_read_b128 a[208:211],v13 offset:256
v_fma_f32 v82,v82,s36,v18
v_mfma_f32_16x16x32_bf16 a[12:15],a[252:255],v[104:107],a[12:15]
ds_read_b128 a[212:215],v14 offset:256
v_fma_f32 v83,v83,s36,v18
v_mfma_f32_16x16x32_bf16 a[60:63],a[252:255],v[108:111],a[60:63]
s_waitcnt lgkmcnt(9)
ds_read_b64_tr_b16 a[252:253],v6 offset:24704
ds_read_b64_tr_b16 a[254:255],v6 offset:30848
v_mfma_f32_16x16x32_bf16 v[176:179],a[240:243],v[96:99],v[176:179]
ds_read_b128 a[216:219],v13 offset:45056
v_fma_f32 v84,v84,s36,v18
v_mfma_f32_16x16x32_bf16 v[224:227],a[240:243],v[100:103],v[224:227]
ds_read_b128 a[220:223],v14 offset:45056
v_fma_f32 v85,v85,s36,v18
v_mfma_f32_16x16x32_bf16 a[16:19],a[240:243],v[104:107],a[16:19]
ds_read_b128 a[224:227],v13 offset:45184
v_fma_f32 v86,v86,s36,v18
v_mfma_f32_16x16x32_bf16 a[64:67],a[240:243],v[108:111],a[64:67]
s_waitcnt lgkmcnt(9)
ds_read_b64_tr_b16 a[240:241],v3 offset:24832
ds_read_b64_tr_b16 a[242:243],v3 offset:30976
v_mfma_f32_16x16x32_bf16 v[180:183],a[244:247],v[96:99],v[180:183]
ds_read_b128 a[228:231],v14 offset:45184
v_fma_f32 v87,v87,s36,v18
v_mfma_f32_16x16x32_bf16 v[228:231],a[244:247],v[100:103],v[228:231]
ds_read_b128 a[232:235],v13 offset:45312
v_fma_f32 v88,v88,s36,v19
v_mfma_f32_16x16x32_bf16 a[20:23],a[244:247],v[104:107],a[20:23]
ds_read_b128 a[236:239],v14 offset:45312
v_fma_f32 v89,v89,s36,v19
v_mfma_f32_16x16x32_bf16 a[68:71],a[244:247],v[108:111],a[68:71]
s_waitcnt lgkmcnt(8)
ds_read_b64_tr_b16 a[244:245],v4 offset:24832
ds_read_b64_tr_b16 a[246:247],v4 offset:30976
v_mfma_f32_16x16x32_bf16 v[184:187],a[248:251],v[96:99],v[184:187]
ds_read_b128 a[120:123],v28 offset:6144
v_fma_f32 v90,v90,s36,v19
v_mfma_f32_16x16x32_bf16 v[232:235],a[248:251],v[100:103],v[232:235]
ds_read_b128 a[124:127],v29 offset:6144
v_fma_f32 v91,v91,s36,v19
v_mfma_f32_16x16x32_bf16 a[24:27],a[248:251],v[104:107],a[24:27]
ds_read_b128 a[128:131],v28 offset:6272
v_fma_f32 v92,v92,s36,v19
v_mfma_f32_16x16x32_bf16 a[72:75],a[248:251],v[108:111],a[72:75]
ds_read_b64_tr_b16 a[248:249],v5 offset:24832
ds_read_b64_tr_b16 a[250:251],v5 offset:30976
v_mfma_f32_16x16x32_bf16 v[188:191],a[252:255],v[96:99],v[188:191]
ds_read_b128 a[132:135],v29 offset:6272
v_fma_f32 v93,v93,s36,v19
v_mfma_f32_16x16x32_bf16 v[236:239],a[252:255],v[100:103],v[236:239]
ds_read_b128 a[136:139],v28 offset:6400
v_fma_f32 v94,v94,s36,v19
v_mfma_f32_16x16x32_bf16 a[28:31],a[252:255],v[104:107],a[28:31]
ds_read_b128 a[140:143],v29 offset:6400
v_fma_f32 v95,v95,s36,v19
v_mfma_f32_16x16x32_bf16 a[76:79],a[252:255],v[108:111],a[76:79]
s_waitcnt lgkmcnt(9)
ds_read_b64_tr_b16 a[252:253],v6 offset:24832
ds_read_b64_tr_b16 a[254:255],v6 offset:30976
v_mfma_f32_16x16x32_bf16 v[192:195],a[240:243],v[96:99],v[192:195]
v_exp_f32 v68,v68
v_mfma_f32_16x16x32_bf16 v[240:243],a[240:243],v[100:103],v[240:243]
v_exp_f32 v69,v69
v_mfma_f32_16x16x32_bf16 a[32:35],a[240:243],v[104:107],a[32:35]
v_exp_f32 v70,v70
v_mfma_f32_16x16x32_bf16 a[80:83],a[240:243],v[108:111],a[80:83]
s_waitcnt lgkmcnt(6)
v_exp_f32 v71,v71
v_mfma_f32_16x16x32_bf16 v[196:199],a[244:247],v[96:99],v[196:199]
v_exp_f32 v76,v76
v_mfma_f32_16x16x32_bf16 v[244:247],a[244:247],v[100:103],v[244:247]
v_exp_f32 v77,v77
v_mfma_f32_16x16x32_bf16 a[36:39],a[244:247],v[104:107],a[36:39]
v_exp_f32 v78,v78
v_mfma_f32_16x16x32_bf16 a[84:87],a[244:247],v[108:111],a[84:87]
s_waitcnt lgkmcnt(0)
v_exp_f32 v79,v79
v_mfma_f32_16x16x32_bf16 v[200:203],a[248:251],v[96:99],v[200:203]
v_exp_f32 v80,v80
v_mfma_f32_16x16x32_bf16 v[248:251],a[248:251],v[100:103],v[248:251]
v_exp_f32 v81,v81
v_mfma_f32_16x16x32_bf16 a[40:43],a[248:251],v[104:107],a[40:43]
v_exp_f32 v82,v82
v_mfma_f32_16x16x32_bf16 a[88:91],a[248:251],v[108:111],a[88:91]
v_exp_f32 v83,v83
v_mfma_f32_16x16x32_bf16 v[204:207],a[252:255],v[96:99],v[204:207]
v_exp_f32 v84,v84
v_mfma_f32_16x16x32_bf16 v[252:255],a[252:255],v[100:103],v[252:255]
v_exp_f32 v85,v85
v_mfma_f32_16x16x32_bf16 a[44:47],a[252:255],v[104:107],a[44:47]
v_exp_f32 v86,v86
v_mfma_f32_16x16x32_bf16 a[92:95],a[252:255],v[108:111],a[92:95]
v_exp_f32 v87,v87
s_waitcnt vmcnt(6)
s_barrier
v_exp_f32 v88,v88
v_exp_f32 v89,v89
v_exp_f32 v90,v90
v_exp_f32 v91,v91
v_exp_f32 v92,v92
v_exp_f32 v93,v93
v_exp_f32 v94,v94
v_exp_f32 v95,v95
v_cvt_pk_bf16_f32 v114,v68,v69
v_cvt_pk_bf16_f32 v115,v70,v71
v_cvt_pk_bf16_f32 v118,v76,v77
v_cvt_pk_bf16_f32 v119,v78,v79
v_mfma_f32_16x16x32_bf16 v[128:131],v[24:27],v[112:115],v[128:131]
ds_read_b64_tr_b16 a[240:241],v3 offset:0
ds_read_b64_tr_b16 a[242:243],v3 offset:6144
v_mfma_f32_16x16x32_bf16 v[132:135],v[24:27],v[116:119],v[132:135]
v_cvt_pk_bf16_f32 v120,v80,v81
v_cvt_pk_bf16_f32 v121,v82,v83
v_cvt_pk_bf16_f32 v122,v84,v85
v_cvt_pk_bf16_f32 v123,v86,v87
v_cvt_pk_bf16_f32 v124,v88,v89
v_cvt_pk_bf16_f32 v125,v90,v91
v_mfma_f32_16x16x32_bf16 v[136:139],v[24:27],v[120:123],v[136:139]
ds_read_b64_tr_b16 a[244:245],v4 offset:0
ds_read_b64_tr_b16 a[246:247],v4 offset:6144
ds_read_b64_tr_b16 a[248:249],v5 offset:0
v_cvt_pk_bf16_f32 v126,v92,v93
v_cvt_pk_bf16_f32 v127,v94,v95
ds_read_b64_tr_b16 a[250:251],v5 offset:6144
ds_read_b64_tr_b16 a[252:253],v6 offset:0
v_mfma_f32_16x16x32_bf16 v[140:143],v[24:27],v[124:127],v[140:143]
s_waitcnt lgkmcnt(5)
ds_read_b64_tr_b16 a[254:255],v6 offset:6144
v_mfma_f32_16x16x32_bf16 v[160:163],a[240:243],v[112:115],v[160:163]
s_add_u32 s87,s42,18432
v_rcp_f32 v144,v128
v_mfma_f32_16x16x32_bf16 v[208:211],a[240:243],v[116:119],v[208:211]
v_rcp_f32 v146,v132
v_mfma_f32_16x16x32_bf16 a[0:3],a[240:243],v[120:123],a[0:3]
v_rcp_f32 v148,v136
v_mfma_f32_16x16x32_bf16 a[48:51],a[240:243],v[124:127],a[48:51]
s_waitcnt lgkmcnt(4)
ds_read_b64_tr_b16 a[240:241],v3 offset:128
ds_read_b64_tr_b16 a[242:243],v3 offset:6272
v_mfma_f32_16x16x32_bf16 v[164:167],a[244:247],v[112:115],v[164:167]
v_rcp_f32 v150,v140
v_mfma_f32_16x16x32_bf16 v[212:215],a[244:247],v[116:119],v[212:215]
v_max3_f32 v30,v128,v132,v136
v_max_f32 v30,v30,v140
v_mfma_f32_16x16x32_bf16 a[4:7],a[244:247],v[120:123],a[4:7]
v_accvgpr_read_b32 v64,a48
v_accvgpr_read_b32 v65,a49
v_mfma_f32_16x16x32_bf16 a[52:55],a[244:247],v[124:127],a[52:55]
ds_read_b64_tr_b16 a[244:245],v4 offset:128
ds_read_b64_tr_b16 a[246:247],v4 offset:6272
v_accvgpr_read_b32 v66,a50
v_accvgpr_read_b32 v67,a51
v_cmp_ngt_f32 vcc,s37,v30
v_pk_mul_f32 v[64:65],v[64:65],v[150:151] op_sel_hi:[1,0]
v_pk_mul_f32 v[160:161],v[160:161],v[144:145] op_sel_hi:[1,0]
v_pk_mul_f32 v[162:163],v[162:163],v[144:145] op_sel_hi:[1,0]
v_pk_mul_f32 v[66:67],v[66:67],v[150:151] op_sel_hi:[1,0]
v_accvgpr_read_b32 v68,a52
v_accvgpr_read_b32 v69,a53
s_waitcnt lgkmcnt(4)
v_mfma_f32_16x16x32_bf16 v[168:171],a[248:251],v[112:115],v[168:171]
s_cmp_lg_u64 vcc,0
v_accvgpr_read_b32 v70,a54
v_accvgpr_read_b32 v71,a55
v_mfma_f32_16x16x32_bf16 v[216:219],a[248:251],v[116:119],v[216:219]
s_cselect_b32 s62,s32,0
v_cvt_pk_bf16_f32 v64,v64,v65
v_cvt_pk_bf16_f32 v160,v160,v161
v_mfma_f32_16x16x32_bf16 a[8:11],a[248:251],v[120:123],a[8:11]
s_or_b32 s31,s31,s62
v_cvt_pk_bf16_f32 v65,v66,v67
v_cvt_pk_bf16_f32 v161,v162,v163
v_mfma_f32_16x16x32_bf16 a[56:59],a[248:251],v[124:127],a[56:59]
s_lshl_b32 s32,s32,1
ds_read_b64_tr_b16 a[248:249],v5 offset:128
ds_read_b64_tr_b16 a[250:251],v5 offset:6272
ds_write2st64_b64 v12,v[64:65],v[160:161] offset0:36 offset1:0
v_pk_mul_f32 v[68:69],v[68:69],v[150:151] op_sel_hi:[1,0]
v_pk_mul_f32 v[70:71],v[70:71],v[150:151] op_sel_hi:[1,0]
v_pk_mul_f32 v[164:165],v[164:165],v[144:145] op_sel_hi:[1,0]
v_pk_mul_f32 v[166:167],v[166:167],v[144:145] op_sel_hi:[1,0]
v_accvgpr_read_b32 v72,a56
v_accvgpr_read_b32 v73,a57
v_mfma_f32_16x16x32_bf16 v[172:175],a[252:255],v[112:115],v[172:175]
s_add_u32 m0,s22,24576
v_accvgpr_read_b32 v74,a58
v_accvgpr_read_b32 v75,a59
v_mfma_f32_16x16x32_bf16 v[220:223],a[252:255],v[116:119],v[220:223]
buffer_load_dwordx4 v7,s[4:7],s20 offen offset:0 lds
v_mfma_f32_16x16x32_bf16 a[12:15],a[252:255],v[120:123],a[12:15]
v_cvt_pk_bf16_f32 v68,v68,v69
v_cvt_pk_bf16_f32 v164,v164,v165
v_mfma_f32_16x16x32_bf16 a[60:63],a[252:255],v[124:127],a[60:63]
ds_read_b64_tr_b16 a[252:253],v6 offset:128
ds_read_b64_tr_b16 a[254:255],v6 offset:6272
v_cvt_pk_bf16_f32 v69,v70,v71
v_cvt_pk_bf16_f32 v165,v166,v167
v_accvgpr_read_b32 v162,a6
v_pk_mul_f32 v[72:73],v[72:73],v[150:151] op_sel_hi:[1,0]
v_pk_mul_f32 v[74:75],v[74:75],v[150:151] op_sel_hi:[1,0]
v_pk_mul_f32 v[168:169],v[168:169],v[144:145] op_sel_hi:[1,0]
v_pk_mul_f32 v[170:171],v[170:171],v[144:145] op_sel_hi:[1,0]
v_accvgpr_read_b32 v76,a60
v_accvgpr_read_b32 v77,a61
s_waitcnt lgkmcnt(2)
v_mfma_f32_16x16x32_bf16 v[176:179],a[240:243],v[112:115],v[176:179]
ds_write2st64_b64 v20,v[68:69],v[164:165] offset0:36 offset1:0
v_mfma_f32_16x16x32_bf16 v[224:227],a[240:243],v[116:119],v[224:227]
v_accvgpr_read_b32 v78,a62
v_accvgpr_read_b32 v79,a63
v_mfma_f32_16x16x32_bf16 a[16:19],a[240:243],v[120:123],a[16:19]
buffer_load_dwordx4 v8,s[4:7],s20 offen offset:1024 lds
v_cvt_pk_bf16_f32 v72,v72,v73
v_cvt_pk_bf16_f32 v168,v168,v169
v_pk_mul_f32 v[76:77],v[76:77],v[150:151] op_sel_hi:[1,0]
v_pk_mul_f32 v[78:79],v[78:79],v[150:151] op_sel_hi:[1,0]
v_pk_mul_f32 v[172:173],v[172:173],v[144:145] op_sel_hi:[1,0]
v_pk_mul_f32 v[174:175],v[174:175],v[144:145] op_sel_hi:[1,0]
v_cvt_pk_bf16_f32 v73,v74,v75
v_cvt_pk_bf16_f32 v169,v170,v171
v_mfma_f32_16x16x32_bf16 a[64:67],a[240:243],v[124:127],a[64:67]
ds_read_b64_tr_b16 a[240:241],v3 offset:256
ds_read_b64_tr_b16 a[242:243],v3 offset:6400
v_mfma_f32_16x16x32_bf16 v[180:183],a[244:247],v[112:115],v[180:183]
ds_write2st64_b64 v21,v[72:73],v[168:169] offset0:36 offset1:0
v_mfma_f32_16x16x32_bf16 v[228:231],a[244:247],v[116:119],v[228:231]
v_cvt_pk_bf16_f32 v76,v76,v77
v_cvt_pk_bf16_f32 v172,v172,v173
v_mfma_f32_16x16x32_bf16 a[20:23],a[244:247],v[120:123],a[20:23]
v_accvgpr_read_b32 v80,a64
v_accvgpr_read_b32 v81,a65
v_accvgpr_read_b32 v82,a66
v_accvgpr_read_b32 v83,a67
v_cvt_pk_bf16_f32 v77,v78,v79
v_pk_mul_f32 v[208:209],v[208:209],v[146:147] op_sel_hi:[1,0]
v_pk_mul_f32 v[210:211],v[210:211],v[146:147] op_sel_hi:[1,0]
v_pk_mul_f32 v[176:177],v[176:177],v[144:145] op_sel_hi:[1,0]
v_pk_mul_f32 v[178:179],v[178:179],v[144:145] op_sel_hi:[1,0]
v_cvt_pk_bf16_f32 v173,v174,v175
v_cvt_pk_bf16_f32 v208,v208,v209
v_mfma_f32_16x16x32_bf16 a[68:71],a[244:247],v[124:127],a[68:71]
ds_read_b64_tr_b16 a[244:245],v4 offset:256
ds_read_b64_tr_b16 a[246:247],v4 offset:6400
v_mfma_f32_16x16x32_bf16 v[184:187],a[248:251],v[112:115],v[184:187]
ds_write2st64_b64 v22,v[76:77],v[172:173] offset0:36 offset1:0
v_mfma_f32_16x16x32_bf16 v[232:235],a[248:251],v[116:119],v[232:235]
v_cvt_pk_bf16_f32 v176,v176,v177
v_cvt_pk_bf16_f32 v209,v210,v211
v_mfma_f32_16x16x32_bf16 a[24:27],a[248:251],v[120:123],a[24:27]
ds_read_b128 v[152:155],v15 offset:18432
v_accvgpr_read_b32 v84,a68
v_accvgpr_read_b32 v85,a69
v_accvgpr_read_b32 v86,a70
v_accvgpr_read_b32 v87,a71
v_pk_mul_f32 v[212:213],v[212:213],v[146:147] op_sel_hi:[1,0]
v_pk_mul_f32 v[214:215],v[214:215],v[146:147] op_sel_hi:[1,0]
v_pk_mul_f32 v[180:181],v[180:181],v[144:145] op_sel_hi:[1,0]
v_pk_mul_f32 v[182:183],v[182:183],v[144:145] op_sel_hi:[1,0]
v_cvt_pk_bf16_f32 v177,v178,v179
v_cvt_pk_bf16_f32 v212,v212,v213
v_mfma_f32_16x16x32_bf16 a[72:75],a[248:251],v[124:127],a[72:75]
buffer_load_dwordx4 v9,s[4:7],s20 offen offset:2048 lds
s_waitcnt lgkmcnt(4)
v_mfma_f32_16x16x32_bf16 v[188:191],a[252:255],v[112:115],v[188:191]
s_add_u32 s20,s20,12288
ds_read_b64_tr_b16 a[248:249],v5 offset:256
ds_read_b64_tr_b16 a[250:251],v5 offset:6400
v_mfma_f32_16x16x32_bf16 v[236:239],a[252:255],v[116:119],v[236:239]
s_add_u32 m0,s23,0
ds_read_b128 v[156:159],v15 offset:21504
v_accvgpr_read_b32 v88,a72
v_mfma_f32_16x16x32_bf16 a[28:31],a[252:255],v[120:123],a[28:31]
ds_write2st64_b64 v12,v[208:209],v[176:177] offset0:12 offset1:2
v_pk_mul_f32 v[216:217],v[216:217],v[146:147] op_sel_hi:[1,0]
v_pk_mul_f32 v[218:219],v[218:219],v[146:147] op_sel_hi:[1,0]
v_pk_mul_f32 v[184:185],v[184:185],v[144:145] op_sel_hi:[1,0]
v_pk_mul_f32 v[186:187],v[186:187],v[144:145] op_sel_hi:[1,0]
v_accvgpr_read_b32 v89,a73
v_accvgpr_read_b32 v90,a74
v_mfma_f32_16x16x32_bf16 a[76:79],a[252:255],v[124:127],a[76:79]
ds_read_b64_tr_b16 a[252:253],v6 offset:256
ds_read_b64_tr_b16 a[254:255],v6 offset:6400
v_mfma_f32_16x16x32_bf16 v[192:195],a[240:243],v[112:115],v[192:195]
s_waitcnt lgkmcnt(6)
buffer_store_dwordx4 v[152:155],v10,s[16:19],s87 offen offset:0 nt
v_accvgpr_read_b32 v91,a75
v_cvt_pk_bf16_f32 v180,v180,v181
v_cvt_pk_bf16_f32 v213,v214,v215
v_mfma_f32_16x16x32_bf16 v[240:243],a[240:243],v[116:119],v[240:243]
v_accvgpr_read_b32 v92,a76
v_accvgpr_read_b32 v93,a77
v_mfma_f32_16x16x32_bf16 a[32:35],a[240:243],v[120:123],a[32:35]
v_accvgpr_read_b32 v94,a78
v_accvgpr_read_b32 v95,a79
v_cvt_pk_bf16_f32 v216,v216,v217
v_cvt_pk_bf16_f32 v184,v184,v185
v_cvt_pk_bf16_f32 v181,v182,v183
v_pk_mul_f32 v[220:221],v[220:221],v[146:147] op_sel_hi:[1,0]
v_pk_mul_f32 v[222:223],v[222:223],v[146:147] op_sel_hi:[1,0]
v_pk_mul_f32 v[188:189],v[188:189],v[144:145] op_sel_hi:[1,0]
v_pk_mul_f32 v[190:191],v[190:191],v[144:145] op_sel_hi:[1,0]
v_cvt_pk_bf16_f32 v217,v218,v219
v_cvt_pk_bf16_f32 v185,v186,v187
v_mfma_f32_16x16x32_bf16 a[80:83],a[240:243],v[124:127],a[80:83]
s_waitcnt vmcnt(4)
ds_read_b128 a[144:147],v28 offset:12288
s_waitcnt lgkmcnt(3)
buffer_store_dwordx4 v[156:159],v10,s[16:19],s87 offen offset:3072 nt
ds_read_b128 a[148:151],v29 offset:12288
v_cvt_pk_bf16_f32 v220,v220,v221
v_cvt_pk_bf16_f32 v188,v188,v189
v_mfma_f32_16x16x32_bf16 v[196:199],a[244:247],v[112:115],v[196:199]
ds_read_b128 a[152:155],v28 offset:12416
v_accvgpr_read_b32 v64,a80
v_mfma_f32_16x16x32_bf16 v[244:247],a[244:247],v[116:119],v[244:247]
ds_read_b128 a[156:159],v29 offset:12416
v_accvgpr_read_b32 v65,a81
v_mfma_f32_16x16x32_bf16 a[36:39],a[244:247],v[120:123],a[36:39]
ds_read_b128 a[160:163],v28 offset:12544
v_accvgpr_read_b32 v66,a82
v_accvgpr_read_b32 v67,a83
v_cvt_pk_bf16_f32 v221,v222,v223
s_waitcnt vmcnt(8)
s_waitcnt lgkmcnt(5)
s_barrier
ds_read_b128 a[164:167],v29 offset:12544
v_pk_mul_f32 v[80:81],v[80:81],v[150:151] op_sel_hi:[1,0]
v_pk_mul_f32 v[82:83],v[82:83],v[150:151] op_sel_hi:[1,0]
v_pk_mul_f32 v[224:225],v[224:225],v[146:147] op_sel_hi:[1,0]
v_pk_mul_f32 v[226:227],v[226:227],v[146:147] op_sel_hi:[1,0]
v_cvt_pk_bf16_f32 v189,v190,v191
v_cvt_pk_bf16_f32 v80,v80,v81
v_mfma_f32_16x16x32_bf16 a[84:87],a[244:247],v[124:127],a[84:87]
ds_write2st64_b64 v20,v[212:213],v[180:181] offset0:12 offset1:2
v_mfma_f32_16x16x32_bf16 v[200:203],a[248:251],v[112:115],v[200:203]
v_cvt_pk_bf16_f32 v224,v224,v225
v_cvt_pk_bf16_f32 v81,v82,v83
v_mfma_f32_16x16x32_bf16 v[248:251],a[248:251],v[116:119],v[248:251]
buffer_load_dwordx4 v7,s[8:11],s21 offen offset:0 lds
v_cvt_pk_bf16_f32 v225,v226,v227
v_accvgpr_read_b32 v82,a2
v_pk_mul_f32 v[84:85],v[84:85],v[150:151] op_sel_hi:[1,0]
v_pk_mul_f32 v[86:87],v[86:87],v[150:151] op_sel_hi:[1,0]
v_pk_mul_f32 v[228:229],v[228:229],v[146:147] op_sel_hi:[1,0]
v_pk_mul_f32 v[230:231],v[230:231],v[146:147] op_sel_hi:[1,0]
v_accvgpr_read_b32 v68,a84
v_accvgpr_read_b32 v69,a85
v_mfma_f32_16x16x32_bf16 a[40:43],a[248:251],v[120:123],a[40:43]
ds_write2st64_b64 v21,v[216:217],v[184:185] offset0:12 offset1:2
v_mfma_f32_16x16x32_bf16 a[88:91],a[248:251],v[124:127],a[88:91]
v_accvgpr_read_b32 v70,a86
v_accvgpr_read_b32 v71,a87
v_mfma_f32_16x16x32_bf16 v[204:207],a[252:255],v[112:115],v[204:207]
v_accvgpr_read_b32 v83,a3
v_accvgpr_read_b32 v163,a7
v_mfma_f32_16x16x32_bf16 v[252:255],a[252:255],v[116:119],v[252:255]
v_accvgpr_read_b32 v160,a4
v_accvgpr_read_b32 v161,a5
v_accvgpr_read_b32 v72,a88
v_accvgpr_read_b32 v73,a89
v_accvgpr_read_b32 v74,a90
v_pk_mul_f32 v[88:89],v[88:89],v[150:151] op_sel_hi:[1,0]
v_pk_mul_f32 v[90:91],v[90:91],v[150:151] op_sel_hi:[1,0]
v_pk_mul_f32 v[232:233],v[232:233],v[146:147] op_sel_hi:[1,0]
v_pk_mul_f32 v[234:235],v[234:235],v[146:147] op_sel_hi:[1,0]
v_accvgpr_read_b32 v75,a91
v_accvgpr_read_b32 v166,a10
v_mfma_f32_16x16x32_bf16 a[44:47],a[252:255],v[120:123],a[44:47]
ds_write2st64_b64 v22,v[220:221],v[188:189] offset0:12 offset1:2
v_mfma_f32_16x16x32_bf16 a[92:95],a[252:255],v[124:127],a[92:95]
v_accvgpr_read_b32 v167,a11
v_accvgpr_read_b32 v164,a8
v_mfma_f32_16x16x32_bf16 v[32:35],a[192:195],a[96:99],0
buffer_load_dwordx4 v8,s[8:11],s21 offen offset:1024 lds
v_mfma_f32_16x16x32_bf16 v[32:35],a[196:199],a[100:103],v[32:35]
v_accvgpr_read_b32 v165,a9
v_accvgpr_read_b32 v170,a14
v_accvgpr_read_b32 v171,a15
v_accvgpr_read_b32 v76,a92
v_accvgpr_read_b32 v77,a93
v_pk_mul_f32 v[92:93],v[92:93],v[150:151] op_sel_hi:[1,0]
v_pk_mul_f32 v[94:95],v[94:95],v[150:151] op_sel_hi:[1,0]
v_pk_mul_f32 v[236:237],v[236:237],v[146:147] op_sel_hi:[1,0]
v_pk_mul_f32 v[238:239],v[238:239],v[146:147] op_sel_hi:[1,0]
v_accvgpr_read_b32 v78,a94
v_accvgpr_read_b32 v79,a95
v_mfma_f32_16x16x32_bf16 v[32:35],a[200:203],a[104:107],v[32:35]
ds_write2st64_b64 v12,v[80:81],v[224:225] offset0:36 offset1:14
v_mfma_f32_16x16x32_bf16 v[32:35],a[204:207],a[108:111],v[32:35]
v_accvgpr_read_b32 v80,a0
v_accvgpr_read_b32 v81,a1
v_mfma_f32_16x16x32_bf16 v[32:35],a[208:211],a[112:115],v[32:35]
v_accvgpr_read_b32 v168,a12
v_accvgpr_read_b32 v169,a13
v_mfma_f32_16x16x32_bf16 v[32:35],a[212:215],a[116:119],v[32:35]
v_cvt_pk_bf16_f32 v84,v84,v85
v_cvt_pk_bf16_f32 v228,v228,v229
v_cvt_pk_bf16_f32 v88,v88,v89
v_cvt_pk_bf16_f32 v232,v232,v233
v_cvt_pk_bf16_f32 v85,v86,v87
v_pk_mul_f32 v[64:65],v[64:65],v[150:151] op_sel_hi:[1,0]
v_pk_mul_f32 v[66:67],v[66:67],v[150:151] op_sel_hi:[1,0]
v_pk_mul_f32 v[192:193],v[192:193],v[144:145] op_sel_hi:[1,0]
v_pk_mul_f32 v[194:195],v[194:195],v[144:145] op_sel_hi:[1,0]
v_cvt_pk_bf16_f32 v229,v230,v231
v_cvt_pk_bf16_f32 v92,v92,v93
v_mfma_f32_16x16x32_bf16 v[36:39],a[216:219],a[96:99],0
ds_write2st64_b64 v20,v[84:85],v[228:229] offset0:36 offset1:14
v_mfma_f32_16x16x32_bf16 v[36:39],a[220:223],a[100:103],v[36:39]
v_cvt_pk_bf16_f32 v236,v236,v237
v_cvt_pk_bf16_f32 v89,v90,v91
v_mfma_f32_16x16x32_bf16 v[36:39],a[224:227],a[104:107],v[36:39]
buffer_load_dwordx4 v9,s[8:11],s21 offen offset:2048 lds
v_mfma_f32_16x16x32_bf16 v[36:39],a[228:231],a[108:111],v[36:39]
s_add_u32 s21,s21,12288
v_cvt_pk_bf16_f32 v233,v234,v235
v_cvt_pk_bf16_f32 v93,v94,v95
v_cvt_pk_bf16_f32 v237,v238,v239
v_cvt_pk_bf16_f32 v64,v64,v65
v_cvt_pk_bf16_f32 v192,v192,v193
v_pk_mul_f32 v[68:69],v[68:69],v[150:151] op_sel_hi:[1,0]
v_pk_mul_f32 v[70:71],v[70:71],v[150:151] op_sel_hi:[1,0]
v_pk_mul_f32 v[196:197],v[196:197],v[144:145] op_sel_hi:[1,0]
v_pk_mul_f32 v[198:199],v[198:199],v[144:145] op_sel_hi:[1,0]
v_cvt_pk_bf16_f32 v65,v66,v67
v_cvt_pk_bf16_f32 v193,v194,v195
v_mfma_f32_16x16x32_bf16 v[36:39],a[232:235],a[112:115],v[36:39]
s_mov_b32 s27,s42
ds_write2st64_b64 v21,v[88:89],v[232:233] offset0:36 offset1:14
v_mfma_f32_16x16x32_bf16 v[36:39],a[236:239],a[116:119],v[36:39]
s_mov_b32 s42,s41
v_accvgpr_read_b32 v174,a18
v_accvgpr_read_b32 v175,a19
v_mfma_f32_16x16x32_bf16 v[40:43],a[192:195],a[120:123],0
s_add_u32 s69,s69,1
v_accvgpr_read_b32 v172,a16
v_accvgpr_read_b32 v173,a17
v_mfma_f32_16x16x32_bf16 v[40:43],a[196:199],a[124:127],v[40:43]
s_add_u32 s48,s48,325632
v_accvgpr_read_b32 v208,a32
v_accvgpr_read_b32 v209,a33
v_accvgpr_read_b32 v210,a34
v_accvgpr_read_b32 v211,a35
v_accvgpr_read_b32 v178,a22
v_pk_mul_f32 v[72:73],v[72:73],v[150:151] op_sel_hi:[1,0]
v_pk_mul_f32 v[74:75],v[74:75],v[150:151] op_sel_hi:[1,0]
v_pk_mul_f32 v[200:201],v[200:201],v[144:145] op_sel_hi:[1,0]
v_pk_mul_f32 v[202:203],v[202:203],v[144:145] op_sel_hi:[1,0]
v_accvgpr_read_b32 v179,a23
v_accvgpr_read_b32 v176,a20
v_mfma_f32_16x16x32_bf16 v[40:43],a[200:203],a[128:131],v[40:43]
s_lshr_b32 s62,s39,s69
ds_write2st64_b64 v22,v[92:93],v[236:237] offset0:36 offset1:14
v_mfma_f32_16x16x32_bf16 v[40:43],a[204:207],a[132:135],v[40:43]
s_and_b32 s62,s62,1
v_accvgpr_read_b32 v177,a21
v_accvgpr_read_b32 v214,a38
v_mfma_f32_16x16x32_bf16 v[40:43],a[208:211],a[136:139],v[40:43]
s_lshl_b32 s62,s62,1
ds_read_b128 v[152:155],v15 offset:18432
v_accvgpr_read_b32 v215,a39
v_accvgpr_read_b32 v212,a36
v_accvgpr_read_b32 v213,a37
v_cvt_pk_bf16_f32 v68,v68,v69
v_pk_mul_f32 v[76:77],v[76:77],v[150:151] op_sel_hi:[1,0]
v_pk_mul_f32 v[78:79],v[78:79],v[150:151] op_sel_hi:[1,0]
v_pk_mul_f32 v[204:205],v[204:205],v[144:145] op_sel_hi:[1,0]
v_pk_mul_f32 v[206:207],v[206:207],v[144:145] op_sel_hi:[1,0]
v_cvt_pk_bf16_f32 v196,v196,v197
v_cvt_pk_bf16_f32 v72,v72,v73
v_mfma_f32_16x16x32_bf16 v[40:43],a[212:215],a[140:143],v[40:43]
s_add_u32 s62,s62,s49
ds_read_b128 v[156:159],v15 offset:21504
v_cvt_pk_bf16_f32 v200,v200,v201
v_mfma_f32_16x16x32_bf16 v[44:47],a[216:219],a[120:123],0
s_and_b32 s62,s62,3
ds_write2st64_b64 v12,v[64:65],v[192:193] offset0:36 offset1:4
v_mfma_f32_16x16x32_bf16 v[44:47],a[220:223],a[124:127],v[44:47]
s_add_u32 s63,s69,8
v_cvt_pk_bf16_f32 v69,v70,v71
v_cvt_pk_bf16_f32 v197,v198,v199
v_mfma_f32_16x16x32_bf16 v[44:47],a[224:227],a[128:131],v[44:47]
s_lshr_b32 s63,s39,s63
v_cvt_pk_bf16_f32 v73,v74,v75
v_cvt_pk_bf16_f32 v201,v202,v203
v_accvgpr_read_b32 v182,a26
v_accvgpr_read_b32 v183,a27
v_accvgpr_read_b32 v180,a24
v_pk_mul_f32 v[240:241],v[240:241],v[146:147] op_sel_hi:[1,0]
v_pk_mul_f32 v[242:243],v[242:243],v[146:147] op_sel_hi:[1,0]
v_pk_mul_f32 v[80:81],v[80:81],v[148:149] op_sel_hi:[1,0]
v_pk_mul_f32 v[82:83],v[82:83],v[148:149] op_sel_hi:[1,0]
v_accvgpr_read_b32 v181,a25
v_accvgpr_read_b32 v218,a42
v_mfma_f32_16x16x32_bf16 v[44:47],a[228:231],a[132:135],v[44:47]
s_and_b32 s63,s63,1
ds_write2st64_b64 v20,v[68:69],v[196:197] offset0:36 offset1:4
v_mfma_f32_16x16x32_bf16 v[44:47],a[232:235],a[136:139],v[44:47]
s_xor_b32 s62,s62,s63
v_accvgpr_read_b32 v219,a43
v_accvgpr_read_b32 v216,a40
v_mfma_f32_16x16x32_bf16 v[44:47],a[236:239],a[140:143],v[44:47]
s_mul_i32 s63,s3,3
v_accvgpr_read_b32 v217,a41
v_cvt_pk_bf16_f32 v76,v76,v77
s_waitcnt lgkmcnt(1)
v_mfma_f32_16x16x32_bf16 v[48:51],a[192:195],a[144:147],0
s_lshl_b32 s64,s3,2
ds_read_b128 a[192:195],v1 offset:12288
buffer_store_dwordx4 v[152:155],v10,s[16:19],s87 offen offset:128 nt
v_cvt_pk_bf16_f32 v204,v204,v205
v_cvt_pk_bf16_f32 v77,v78,v79
v_pk_mul_f32 v[244:245],v[244:245],v[146:147] op_sel_hi:[1,0]
v_pk_mul_f32 v[246:247],v[246:247],v[146:147] op_sel_hi:[1,0]
v_pk_mul_f32 v[160:161],v[160:161],v[148:149] op_sel_hi:[1,0]
v_pk_mul_f32 v[162:163],v[162:163],v[148:149] op_sel_hi:[1,0]
v_cvt_pk_bf16_f32 v205,v206,v207
v_cvt_pk_bf16_f32 v240,v240,v241
v_mfma_f32_16x16x32_bf16 v[48:51],a[196:199],a[148:151],v[48:51]
s_mov_b32 s40,1
ds_read_b128 a[196:199],v2 offset:12288
v_cvt_pk_bf16_f32 v80,v80,v81
v_mfma_f32_16x16x32_bf16 v[48:51],a[200:203],a[152:155],v[48:51]
s_add_u32 s65,s63,17
ds_read_b128 a[200:203],v1 offset:12416
buffer_store_dwordx4 v[156:159],v10,s[16:19],s87 offen offset:3200 nt
v_accvgpr_read_b32 v186,a30
v_accvgpr_read_b32 v187,a31
v_accvgpr_read_b32 v184,a28
v_mfma_f32_16x16x32_bf16 v[48:51],a[204:207],a[156:159],v[48:51]
s_cmp_eq_u32 s3,0
ds_read_b128 a[204:207],v2 offset:12416
v_accvgpr_read_b32 v185,a29
v_mfma_f32_16x16x32_bf16 v[48:51],a[208:211],a[160:163],v[48:51]
s_cselect_b32 s65,16,s65
ds_read_b128 a[208:211],v1 offset:12544
v_accvgpr_read_b32 v222,a46
v_accvgpr_read_b32 v223,a47
v_accvgpr_read_b32 v220,a44
v_accvgpr_read_b32 v221,a45
v_pk_mul_f32 v[248:249],v[248:249],v[146:147] op_sel_hi:[1,0]
v_pk_mul_f32 v[250:251],v[250:251],v[146:147] op_sel_hi:[1,0]
v_pk_mul_f32 v[164:165],v[164:165],v[148:149] op_sel_hi:[1,0]
v_pk_mul_f32 v[166:167],v[166:167],v[148:149] op_sel_hi:[1,0]
v_cvt_pk_bf16_f32 v241,v242,v243
v_cvt_pk_bf16_f32 v81,v82,v83
v_mfma_f32_16x16x32_bf16 v[48:51],a[212:215],a[164:167],v[48:51]
s_cselect_b32 s41,1,0
ds_read_b128 a[212:215],v2 offset:12544
v_max3_f32 v129,v32,v33,v34
v_mfma_f32_16x16x32_bf16 v[52:55],a[216:219],a[144:147],0
s_cmp_eq_u32 s62,1
ds_read_b128 a[216:219],v1 offset:18432
v_max3_f32 v133,v40,v41,v42
v_mfma_f32_16x16x32_bf16 v[52:55],a[220:223],a[148:151],v[52:55]
s_cselect_b32 s64,s65,s64
ds_read_b128 a[220:223],v2 offset:18432
v_max3_f32 v137,v48,v49,v50
v_mfma_f32_16x16x32_bf16 v[52:55],a[224:227],a[152:155],v[52:55]
s_cselect_b32 s40,s41,s40
ds_read_b128 a[224:227],v1 offset:18560
v_max3_f32 v129,v129,v35,v36
v_max3_f32 v133,v133,v43,v44
v_max3_f32 v129,v129,v37,v38
v_max3_f32 v133,v133,v45,v46
v_pk_mul_f32 v[252:253],v[252:253],v[146:147] op_sel_hi:[1,0]
v_pk_mul_f32 v[254:255],v[254:255],v[146:147] op_sel_hi:[1,0]
v_pk_mul_f32 v[168:169],v[168:169],v[148:149] op_sel_hi:[1,0]
v_pk_mul_f32 v[170:171],v[170:171],v[148:149] op_sel_hi:[1,0]
v_max_f32 v129,v129,v39
v_max_f32 v133,v133,v47
v_mfma_f32_16x16x32_bf16 v[52:55],a[228:231],a[156:159],v[52:55]
s_add_u32 s65,s63,29
ds_read_b128 a[228:231],v2 offset:18560
v_mov_b32 v130,v129
v_mfma_f32_16x16x32_bf16 v[52:55],a[232:235],a[160:163],v[52:55]
s_cmp_eq_u32 s62,2
ds_read_b128 a[232:235],v1 offset:18688
v_mov_b32 v134,v133
v_mfma_f32_16x16x32_bf16 v[52:55],a[236:239],a[164:167],v[52:55]
s_cselect_b32 s64,s65,s64
ds_read_b128 a[236:239],v2 offset:18688
v_permlane32_swap_b32 v130,v129
s_waitcnt lgkmcnt(6)
v_mfma_f32_16x16x32_bf16 v[64:67],a[192:195],a[96:99],0
s_cselect_b32 s40,0,s40
ds_write2st64_b64 v21,v[72:73],v[200:201] offset0:36 offset1:4
v_pk_mul_f32 v[172:173],v[172:173],v[148:149] op_sel_hi:[1,0]
v_pk_mul_f32 v[174:175],v[174:175],v[148:149] op_sel_hi:[1,0]
v_pk_mul_f32 v[208:209],v[208:209],v[148:149] op_sel_hi:[1,0]
v_pk_mul_f32 v[210:211],v[210:211],v[148:149] op_sel_hi:[1,0]
v_max3_f32 v137,v137,v51,v52
v_max3_f32 v137,v137,v53,v54
v_mfma_f32_16x16x32_bf16 v[64:67],a[196:199],a[100:103],v[64:67]
s_add_u32 s65,s63,41
v_max_f32 v137,v137,v55
v_mov_b32 v138,v137
v_mfma_f32_16x16x32_bf16 v[64:67],a[200:203],a[104:107],v[64:67]
s_cmp_eq_u32 s62,3
v_permlane32_swap_b32 v134,v133
v_mfma_f32_16x16x32_bf16 v[64:67],a[204:207],a[108:111],v[64:67]
s_cselect_b32 s64,s65,s64
ds_write2st64_b64 v22,v[76:77],v[204:205] offset0:36 offset1:4
v_pk_mul_f32 v[176:177],v[176:177],v[148:149] op_sel_hi:[1,0]
v_pk_mul_f32 v[178:179],v[178:179],v[148:149] op_sel_hi:[1,0]
v_pk_mul_f32 v[212:213],v[212:213],v[148:149] op_sel_hi:[1,0]
v_pk_mul_f32 v[214:215],v[214:215],v[148:149] op_sel_hi:[1,0]
v_permlane32_swap_b32 v138,v137
v_max_f32 v129,v129,v130
v_mfma_f32_16x16x32_bf16 v[64:67],a[208:211],a[112:115],v[64:67]
s_cselect_b32 s40,0,s40
ds_read_b128 v[152:155],v15 offset:18432
v_max_f32 v133,v133,v134
v_mfma_f32_16x16x32_bf16 v[64:67],a[212:215],a[116:119],v[64:67]
s_mul_i32 s64,s64,6144
ds_read_b128 v[156:159],v15 offset:21504
v_max_f32 v137,v137,v138
v_mfma_f32_16x16x32_bf16 v[72:75],a[192:195],a[120:123],0
s_add_u32 s41,s48,s64
ds_write2st64_b64 v12,v[240:241],v[80:81] offset0:16 offset1:24
v_mfma_f32_16x16x32_bf16 v[72:75],a[196:199],a[124:127],v[72:75]
s_cmp_ge_u32 s69,8
v_mov_b32 v130,v129
v_mov_b32 v134,v133
v_mov_b32 v138,v137
v_permlane16_swap_b32 v130,v129
v_pk_mul_f32 v[180:181],v[180:181],v[148:149] op_sel_hi:[1,0]
v_pk_mul_f32 v[182:183],v[182:183],v[148:149] op_sel_hi:[1,0]
v_pk_mul_f32 v[216:217],v[216:217],v[148:149] op_sel_hi:[1,0]
v_pk_mul_f32 v[218:219],v[218:219],v[148:149] op_sel_hi:[1,0]
v_permlane16_swap_b32 v134,v133
v_permlane16_swap_b32 v138,v137
v_mfma_f32_16x16x32_bf16 v[72:75],a[200:203],a[128:131],v[72:75]
s_cselect_b32 s41,166723584,s41
v_max_f32 v129,v129,v130
v_max_f32 v133,v133,v134
v_mfma_f32_16x16x32_bf16 v[72:75],a[204:207],a[132:135],v[72:75]
s_mov_b32 s28,s41
v_max_f32 v137,v137,v138
v_mul_f32_e64 v16,-s36,v129
v_mfma_f32_16x16x32_bf16 v[72:75],a[208:211],a[136:139],v[72:75]
s_mov_b32 s29,s24
v_mul_f32_e64 v17,-s36,v133
v_mul_f32_e64 v18,-s36,v137
v_mfma_f32_16x16x32_bf16 v[72:75],a[212:215],a[140:143],v[72:75]
s_add_u32 s25,s22,12288
v_fma_f32 v32,v32,s36,v16
v_fma_f32 v33,v33,s36,v16
v_fma_f32 v34,v34,s36,v16
v_fma_f32 v35,v35,s36,v16
v_fma_f32 v36,v36,s36,v16
v_pk_mul_f32 v[184:185],v[184:185],v[148:149] op_sel_hi:[1,0]
v_pk_mul_f32 v[186:187],v[186:187],v[148:149] op_sel_hi:[1,0]
v_pk_mul_f32 v[220:221],v[220:221],v[148:149] op_sel_hi:[1,0]
v_pk_mul_f32 v[222:223],v[222:223],v[148:149] op_sel_hi:[1,0]
v_fma_f32 v37,v37,s36,v16
v_fma_f32 v38,v38,s36,v16
v_mfma_f32_16x16x32_bf16 v[80:83],a[192:195],a[144:147],0
s_add_u32 s26,s22,24576
v_fma_f32 v39,v39,s36,v16
v_fma_f32 v40,v40,s36,v17
v_mfma_f32_16x16x32_bf16 v[80:83],a[196:199],a[148:151],v[80:83]
s_add_u32 m0,s23,12288
v_fma_f32 v41,v41,s36,v17
v_fma_f32 v42,v42,s36,v17
v_mfma_f32_16x16x32_bf16 v[80:83],a[200:203],a[152:155],v[80:83]
s_waitcnt lgkmcnt(0)
buffer_store_dwordx4 v[152:155],v10,s[16:19],s87 offen offset:256 nt
v_fma_f32 v43,v43,s36,v17
v_fma_f32 v44,v44,s36,v17
v_fma_f32 v45,v45,s36,v17
v_mfma_f32_16x16x32_bf16 v[80:83],a[204:207],a[156:159],v[80:83]
v_fma_f32 v46,v46,s36,v17
v_fma_f32 v47,v47,s36,v17
v_mfma_f32_16x16x32_bf16 v[80:83],a[208:211],a[160:163],v[80:83]
v_fma_f32 v48,v48,s36,v18
v_fma_f32 v49,v49,s36,v18
v_mfma_f32_16x16x32_bf16 v[80:83],a[212:215],a[164:167],v[80:83]
buffer_load_dwordx4 v7,s[8:11],s21 offen offset:0 lds
v_mfma_f32_16x16x32_bf16 v[68:71],a[216:219],a[96:99],0
buffer_store_dwordx4 v[156:159],v10,s[16:19],s87 offen offset:3328 nt
v_fma_f32 v50,v50,s36,v18
v_fma_f32 v51,v51,s36,v18
v_fma_f32 v52,v52,s36,v18
v_mfma_f32_16x16x32_bf16 v[68:71],a[220:223],a[100:103],v[68:71]
v_fma_f32 v53,v53,s36,v18
v_fma_f32 v54,v54,s36,v18
v_mfma_f32_16x16x32_bf16 v[68:71],a[224:227],a[104:107],v[68:71]
v_fma_f32 v55,v55,s36,v18
v_exp_f32 v32,v32
v_mfma_f32_16x16x32_bf16 v[68:71],a[228:231],a[108:111],v[68:71]
v_exp_f32 v33,v33
v_mfma_f32_16x16x32_bf16 v[68:71],a[232:235],a[112:115],v[68:71]
v_exp_f32 v34,v34
v_mfma_f32_16x16x32_bf16 v[68:71],a[236:239],a[116:119],v[68:71]
buffer_load_dwordx4 v8,s[8:11],s21 offen offset:1024 lds
v_mfma_f32_16x16x32_bf16 v[76:79],a[216:219],a[120:123],0
v_exp_f32 v35,v35
v_mfma_f32_16x16x32_bf16 v[76:79],a[220:223],a[124:127],v[76:79]
v_exp_f32 v36,v36
v_mfma_f32_16x16x32_bf16 v[76:79],a[224:227],a[128:131],v[76:79]
v_exp_f32 v37,v37
v_mfma_f32_16x16x32_bf16 v[76:79],a[228:231],a[132:135],v[76:79]
v_exp_f32 v38,v38
v_mfma_f32_16x16x32_bf16 v[76:79],a[232:235],a[136:139],v[76:79]
v_exp_f32 v39,v39
v_mfma_f32_16x16x32_bf16 v[76:79],a[236:239],a[140:143],v[76:79]
v_exp_f32 v40,v40
v_mfma_f32_16x16x32_bf16 v[84:87],a[216:219],a[144:147],0
v_exp_f32 v41,v41
v_mfma_f32_16x16x32_bf16 v[84:87],a[220:223],a[148:151],v[84:87]
v_exp_f32 v42,v42
v_mfma_f32_16x16x32_bf16 v[84:87],a[224:227],a[152:155],v[84:87]
buffer_load_dwordx4 v9,s[8:11],s21 offen offset:2048 lds
v_mfma_f32_16x16x32_bf16 v[84:87],a[228:231],a[156:159],v[84:87]
s_add_u32 s21,s21,12288
v_exp_f32 v43,v43
v_mfma_f32_16x16x32_bf16 v[84:87],a[232:235],a[160:163],v[84:87]
s_add_u32 m0,s22,0
v_exp_f32 v44,v44
v_mfma_f32_16x16x32_bf16 v[84:87],a[236:239],a[164:167],v[84:87]
v_exp_f32 v45,v45
v_exp_f32 v46,v46
v_exp_f32 v47,v47
v_exp_f32 v48,v48
v_exp_f32 v49,v49
v_exp_f32 v50,v50
v_exp_f32 v51,v51
v_exp_f32 v52,v52
v_exp_f32 v53,v53
v_exp_f32 v54,v54
v_exp_f32 v55,v55
v_cvt_pk_bf16_f32 v244,v244,v245
v_cvt_pk_bf16_f32 v160,v160,v161
v_cvt_pk_bf16_f32 v248,v248,v249
v_cvt_pk_bf16_f32 v164,v164,v165
v_cvt_pk_bf16_f32 v245,v246,v247
v_cvt_pk_bf16_f32 v161,v162,v163
v_cvt_pk_bf16_f32 v252,v252,v253
v_cvt_pk_bf16_f32 v168,v168,v169
v_cvt_pk_bf16_f32 v96,v32,v33
v_cvt_pk_bf16_f32 v97,v34,v35
v_cvt_pk_bf16_f32 v98,v36,v37
v_cvt_pk_bf16_f32 v99,v38,v39
v_cvt_pk_bf16_f32 v100,v40,v41
v_cvt_pk_bf16_f32 v101,v42,v43
v_mfma_f32_16x16x32_bf16 v[128:131],v[24:27],v[96:99],0
buffer_load_dwordx4 v7,s[4:7],s20 offen offset:0 lds
ds_write2st64_b64 v20,v[244:245],v[160:161] offset0:16 offset1:24
v_cvt_pk_bf16_f32 v102,v44,v45
v_cvt_pk_bf16_f32 v103,v46,v47
v_cvt_pk_bf16_f32 v104,v48,v49
v_cvt_pk_bf16_f32 v105,v50,v51
v_mfma_f32_16x16x32_bf16 v[132:135],v[24:27],v[100:103],0
v_cvt_pk_bf16_f32 v106,v52,v53
v_cvt_pk_bf16_f32 v107,v54,v55
v_cvt_pk_bf16_f32 v249,v250,v251
v_cvt_pk_bf16_f32 v165,v166,v167
v_mfma_f32_16x16x32_bf16 v[136:139],v[24:27],v[104:107],0
v_cvt_pk_bf16_f32 v172,v172,v173
v_cvt_pk_bf16_f32 v208,v208,v209
v_cvt_pk_bf16_f32 v253,v254,v255
v_cvt_pk_bf16_f32 v169,v170,v171
v_cvt_pk_bf16_f32 v176,v176,v177
v_cvt_pk_bf16_f32 v212,v212,v213
v_fma_f32 v64,v64,s36,v16
v_fma_f32 v65,v65,s36,v16
v_fma_f32 v66,v66,s36,v16
v_fma_f32 v67,v67,s36,v16
v_fma_f32 v72,v72,s36,v17
v_fma_f32 v73,v73,s36,v17
v_fma_f32 v74,v74,s36,v17
v_fma_f32 v75,v75,s36,v17
v_cvt_pk_bf16_f32 v173,v174,v175
v_cvt_pk_bf16_f32 v209,v210,v211
v_cvt_pk_bf16_f32 v180,v180,v181
v_cvt_pk_bf16_f32 v216,v216,v217
v_cvt_pk_bf16_f32 v177,v178,v179
v_cvt_pk_bf16_f32 v213,v214,v215
v_exp_f32 v64,v64
v_exp_f32 v65,v65
v_exp_f32 v66,v66
v_exp_f32 v67,v67
v_exp_f32 v72,v72
v_exp_f32 v73,v73
v_exp_f32 v74,v74
v_exp_f32 v75,v75
v_cvt_pk_bf16_f32 v184,v184,v185
v_cvt_pk_bf16_f32 v220,v220,v221
v_cvt_pk_bf16_f32 v181,v182,v183
v_cvt_pk_bf16_f32 v217,v218,v219
v_cvt_pk_bf16_f32 v185,v186,v187
v_cvt_pk_bf16_f32 v221,v222,v223
v_subrev_u32 v11,18432,v11
v_subrev_u32 v23,18432,v23
v_subrev_u32 v31,18432,v31
v_cvt_pk_bf16_f32 v112,v64,v65
v_cvt_pk_bf16_f32 v113,v66,v67
v_cvt_pk_bf16_f32 v116,v72,v73
v_cvt_pk_bf16_f32 v117,v74,v75
buffer_load_dwordx4 v8,s[4:7],s20 offen offset:1024 lds
buffer_load_dwordx4 v9,s[4:7],s20 offen offset:2048 lds
ds_write2st64_b64 v21,v[248:249],v[164:165] offset0:16 offset1:24
s_add_u32 s20,s20,12288
ds_write2st64_b64 v22,v[252:253],v[168:169] offset0:16 offset1:24
s_waitcnt vmcnt(10)
s_barrier
ds_write2st64_b64 v12,v[172:173],v[208:209] offset0:26 offset1:28
ds_read_b64_tr_b16 a[240:241],v3 offset:0
ds_read_b64_tr_b16 a[242:243],v3 offset:6144
ds_read_b64_tr_b16 a[244:245],v4 offset:0
ds_read_b64_tr_b16 a[246:247],v4 offset:6144
ds_read_b64_tr_b16 a[248:249],v5 offset:0
ds_write2st64_b64 v20,v[176:177],v[212:213] offset0:26 offset1:28
ds_read_b64_tr_b16 a[250:251],v5 offset:6144
ds_read_b64_tr_b16 a[252:253],v6 offset:0
ds_read_b64_tr_b16 a[254:255],v6 offset:6144
ds_write2st64_b64 v21,v[180:181],v[216:217] offset0:26 offset1:28
ds_write2st64_b64 v22,v[184:185],v[220:221] offset0:26 offset1:28
s_waitcnt lgkmcnt(5)
v_mfma_f32_16x16x32_bf16 v[160:163],a[240:243],v[96:99],0
s_add_u32 m0,s23,24576
ds_read_b128 a[192:195],v1 offset:24576
v_fma_f32 v68,v68,s36,v16
v_mfma_f32_16x16x32_bf16 v[208:211],a[240:243],v[100:103],0
buffer_load_dwordx4 v7,s[8:11],s21 offen offset:0 lds
v_mfma_f32_16x16x32_bf16 a[0:3],a[240:243],v[104:107],0
ds_read_b64_tr_b16 a[240:241],v3 offset:128
ds_read_b64_tr_b16 a[242:243],v3 offset:6272
v_mfma_f32_16x16x32_bf16 v[164:167],a[244:247],v[96:99],0
ds_read_b128 a[196:199],v2 offset:24576
v_fma_f32 v69,v69,s36,v16
v_mfma_f32_16x16x32_bf16 v[212:215],a[244:247],v[100:103],0
ds_read_b128 a[200:203],v1 offset:24704
v_fma_f32 v70,v70,s36,v16
v_mfma_f32_16x16x32_bf16 a[4:7],a[244:247],v[104:107],0
s_waitcnt lgkmcnt(6)
ds_read_b64_tr_b16 a[244:245],v4 offset:128
ds_read_b64_tr_b16 a[246:247],v4 offset:6272
v_mfma_f32_16x16x32_bf16 v[168:171],a[248:251],v[96:99],0
ds_read_b128 a[204:207],v2 offset:24704
v_fma_f32 v71,v71,s36,v16
v_mfma_f32_16x16x32_bf16 v[216:219],a[248:251],v[100:103],0
buffer_load_dwordx4 v8,s[8:11],s21 offen offset:1024 lds
v_mfma_f32_16x16x32_bf16 a[8:11],a[248:251],v[104:107],0
ds_read_b64_tr_b16 a[248:249],v5 offset:128
ds_read_b64_tr_b16 a[250:251],v5 offset:6272
v_mfma_f32_16x16x32_bf16 v[172:175],a[252:255],v[96:99],0
ds_read_b128 a[208:211],v1 offset:24832
v_fma_f32 v76,v76,s36,v17
v_mfma_f32_16x16x32_bf16 v[220:223],a[252:255],v[100:103],0
ds_read_b128 a[212:215],v2 offset:24832
v_fma_f32 v77,v77,s36,v17
v_mfma_f32_16x16x32_bf16 a[12:15],a[252:255],v[104:107],0
s_waitcnt lgkmcnt(8)
ds_read_b64_tr_b16 a[252:253],v6 offset:128
ds_read_b64_tr_b16 a[254:255],v6 offset:6272
v_mfma_f32_16x16x32_bf16 v[176:179],a[240:243],v[96:99],0
buffer_load_dwordx4 v9,s[8:11],s21 offen offset:2048 lds
v_mfma_f32_16x16x32_bf16 v[224:227],a[240:243],v[100:103],0
s_add_u32 s21,s21,12288
ds_read_b128 a[216:219],v1 offset:30720
v_fma_f32 v78,v78,s36,v17
v_mfma_f32_16x16x32_bf16 a[16:19],a[240:243],v[104:107],0
s_add_u32 m0,s22,12288
ds_read_b64_tr_b16 a[240:241],v3 offset:256
ds_read_b64_tr_b16 a[242:243],v3 offset:6400
s_waitcnt lgkmcnt(9)
v_mfma_f32_16x16x32_bf16 v[180:183],a[244:247],v[96:99],0
ds_read_b128 a[220:223],v2 offset:30720
v_fma_f32 v79,v79,s36,v17
v_mfma_f32_16x16x32_bf16 v[228:231],a[244:247],v[100:103],0
ds_read_b128 a[224:227],v1 offset:30848
v_fma_f32 v80,v80,s36,v18
v_mfma_f32_16x16x32_bf16 a[20:23],a[244:247],v[104:107],0
s_waitcnt lgkmcnt(8)
ds_read_b64_tr_b16 a[244:245],v4 offset:256
ds_read_b64_tr_b16 a[246:247],v4 offset:6400
v_mfma_f32_16x16x32_bf16 v[184:187],a[248:251],v[96:99],0
buffer_load_dwordx4 v7,s[4:7],s20 offen offset:0 lds
v_mfma_f32_16x16x32_bf16 v[232:235],a[248:251],v[100:103],0
ds_read_b128 a[228:231],v2 offset:30848
v_fma_f32 v81,v81,s36,v18
v_mfma_f32_16x16x32_bf16 a[24:27],a[248:251],v[104:107],0
s_waitcnt lgkmcnt(8)
ds_read_b64_tr_b16 a[248:249],v5 offset:256
ds_read_b64_tr_b16 a[250:251],v5 offset:6400
v_mfma_f32_16x16x32_bf16 v[188:191],a[252:255],v[96:99],0
ds_read_b128 a[232:235],v1 offset:30976
v_fma_f32 v82,v82,s36,v18
v_mfma_f32_16x16x32_bf16 v[236:239],a[252:255],v[100:103],0
ds_read_b128 a[236:239],v2 offset:30976
v_fma_f32 v83,v83,s36,v18
v_mfma_f32_16x16x32_bf16 a[28:31],a[252:255],v[104:107],0
s_waitcnt lgkmcnt(8)
ds_read_b64_tr_b16 a[252:253],v6 offset:256
ds_read_b64_tr_b16 a[254:255],v6 offset:6400
v_mfma_f32_16x16x32_bf16 v[192:195],a[240:243],v[96:99],0
buffer_load_dwordx4 v8,s[4:7],s20 offen offset:1024 lds
v_mfma_f32_16x16x32_bf16 v[240:243],a[240:243],v[100:103],0
v_fma_f32 v84,v84,s36,v18
v_fma_f32 v85,v85,s36,v18
v_mfma_f32_16x16x32_bf16 a[32:35],a[240:243],v[104:107],0
s_waitcnt lgkmcnt(7)
v_fma_f32 v86,v86,s36,v18
v_fma_f32 v87,v87,s36,v18
v_mfma_f32_16x16x32_bf16 v[196:199],a[244:247],v[96:99],0
v_exp_f32 v68,v68
v_mfma_f32_16x16x32_bf16 v[244:247],a[244:247],v[100:103],0
v_exp_f32 v69,v69
v_mfma_f32_16x16x32_bf16 a[36:39],a[244:247],v[104:107],0
s_waitcnt lgkmcnt(3)
v_exp_f32 v70,v70
v_mfma_f32_16x16x32_bf16 v[200:203],a[248:251],v[96:99],0
buffer_load_dwordx4 v9,s[4:7],s20 offen offset:2048 lds
v_mfma_f32_16x16x32_bf16 v[248:251],a[248:251],v[100:103],0
s_add_u32 s20,s20,12288
v_exp_f32 v71,v71
v_mfma_f32_16x16x32_bf16 a[40:43],a[248:251],v[104:107],0
s_waitcnt lgkmcnt(0)
v_exp_f32 v76,v76
v_mfma_f32_16x16x32_bf16 v[204:207],a[252:255],v[96:99],0
v_exp_f32 v77,v77
v_mfma_f32_16x16x32_bf16 v[252:255],a[252:255],v[100:103],0
v_exp_f32 v78,v78
v_mfma_f32_16x16x32_bf16 a[44:47],a[252:255],v[104:107],0
v_exp_f32 v79,v79
v_mfma_f32_16x16x32_bf16 v[32:35],a[192:195],a[96:99],0
v_exp_f32 v80,v80
v_mfma_f32_16x16x32_bf16 v[32:35],a[196:199],a[100:103],v[32:35]
v_exp_f32 v81,v81
v_mfma_f32_16x16x32_bf16 v[32:35],a[200:203],a[104:107],v[32:35]
v_exp_f32 v82,v82
v_mfma_f32_16x16x32_bf16 v[32:35],a[204:207],a[108:111],v[32:35]
v_exp_f32 v83,v83
v_mfma_f32_16x16x32_bf16 v[32:35],a[208:211],a[112:115],v[32:35]
v_exp_f32 v84,v84
v_mfma_f32_16x16x32_bf16 v[32:35],a[212:215],a[116:119],v[32:35]
v_exp_f32 v85,v85
v_mfma_f32_16x16x32_bf16 v[40:43],a[192:195],a[120:123],0
v_exp_f32 v86,v86
v_mfma_f32_16x16x32_bf16 v[40:43],a[196:199],a[124:127],v[40:43]
v_exp_f32 v87,v87
v_mfma_f32_16x16x32_bf16 v[40:43],a[200:203],a[128:131],v[40:43]
v_cvt_pk_bf16_f32 v114,v68,v69
v_cvt_pk_bf16_f32 v115,v70,v71
v_mfma_f32_16x16x32_bf16 v[40:43],a[204:207],a[132:135],v[40:43]
v_cvt_pk_bf16_f32 v118,v76,v77
v_cvt_pk_bf16_f32 v119,v78,v79
v_mfma_f32_16x16x32_bf16 v[128:131],v[24:27],v[112:115],v[128:131]
v_cvt_pk_bf16_f32 v120,v80,v81
v_cvt_pk_bf16_f32 v121,v82,v83
v_mfma_f32_16x16x32_bf16 v[132:135],v[24:27],v[116:119],v[132:135]
v_cvt_pk_bf16_f32 v122,v84,v85
v_cvt_pk_bf16_f32 v123,v86,v87
v_mfma_f32_16x16x32_bf16 v[40:43],a[208:211],a[136:139],v[40:43]
v_fma_f32 v32,v32,s36,v16
v_fma_f32 v33,v33,s36,v16
v_mfma_f32_16x16x32_bf16 v[136:139],v[24:27],v[120:123],v[136:139]
v_fma_f32 v34,v34,s36,v16
v_fma_f32 v35,v35,s36,v16
v_mfma_f32_16x16x32_bf16 v[40:43],a[212:215],a[140:143],v[40:43]
v_exp_f32 v32,v32
v_mfma_f32_16x16x32_bf16 v[48:51],a[192:195],a[144:147],0
v_exp_f32 v33,v33
v_mfma_f32_16x16x32_bf16 v[48:51],a[196:199],a[148:151],v[48:51]
v_exp_f32 v34,v34
v_mfma_f32_16x16x32_bf16 v[48:51],a[200:203],a[152:155],v[48:51]
v_exp_f32 v35,v35
v_mfma_f32_16x16x32_bf16 v[48:51],a[204:207],a[156:159],v[48:51]
v_fma_f32 v40,v40,s36,v17
v_fma_f32 v41,v41,s36,v17
v_mfma_f32_16x16x32_bf16 v[48:51],a[208:211],a[160:163],v[48:51]
v_fma_f32 v42,v42,s36,v17
v_fma_f32 v43,v43,s36,v17
v_mfma_f32_16x16x32_bf16 v[48:51],a[212:215],a[164:167],v[48:51]
v_exp_f32 v40,v40
v_mfma_f32_16x16x32_bf16 v[36:39],a[216:219],a[96:99],0
v_exp_f32 v41,v41
v_mfma_f32_16x16x32_bf16 v[36:39],a[220:223],a[100:103],v[36:39]
v_exp_f32 v42,v42
v_mfma_f32_16x16x32_bf16 v[36:39],a[224:227],a[104:107],v[36:39]
v_exp_f32 v43,v43
v_mfma_f32_16x16x32_bf16 v[36:39],a[228:231],a[108:111],v[36:39]
v_cvt_pk_bf16_f32 v96,v32,v33
v_cvt_pk_bf16_f32 v97,v34,v35
s_waitcnt vmcnt(6)
v_mfma_f32_16x16x32_bf16 v[36:39],a[232:235],a[112:115],v[36:39]
s_barrier
v_mfma_f32_16x16x32_bf16 v[36:39],a[236:239],a[116:119],v[36:39]
ds_read_b64_tr_b16 a[240:241],v3 offset:12288
ds_read_b64_tr_b16 a[242:243],v3 offset:18432
v_mfma_f32_16x16x32_bf16 v[44:47],a[216:219],a[120:123],0
v_cvt_pk_bf16_f32 v100,v40,v41
v_cvt_pk_bf16_f32 v101,v42,v43
v_mfma_f32_16x16x32_bf16 v[44:47],a[220:223],a[124:127],v[44:47]
ds_read_b64_tr_b16 a[244:245],v4 offset:12288
ds_read_b64_tr_b16 a[246:247],v4 offset:18432
v_mfma_f32_16x16x32_bf16 v[44:47],a[224:227],a[128:131],v[44:47]
ds_read_b64_tr_b16 a[248:249],v5 offset:12288
ds_read_b64_tr_b16 a[250:251],v5 offset:18432
v_mfma_f32_16x16x32_bf16 v[44:47],a[228:231],a[132:135],v[44:47]
v_mfma_f32_16x16x32_bf16 v[44:47],a[232:235],a[136:139],v[44:47]
ds_read_b64_tr_b16 a[252:253],v6 offset:12288
ds_read_b64_tr_b16 a[254:255],v6 offset:18432
v_mfma_f32_16x16x32_bf16 v[44:47],a[236:239],a[140:143],v[44:47]
v_mfma_f32_16x16x32_bf16 v[52:55],a[216:219],a[144:147],0
v_mfma_f32_16x16x32_bf16 v[52:55],a[220:223],a[148:151],v[52:55]
v_mfma_f32_16x16x32_bf16 v[52:55],a[224:227],a[152:155],v[52:55]
v_mfma_f32_16x16x32_bf16 v[52:55],a[228:231],a[156:159],v[52:55]
v_mfma_f32_16x16x32_bf16 v[52:55],a[232:235],a[160:163],v[52:55]
v_mfma_f32_16x16x32_bf16 v[52:55],a[236:239],a[164:167],v[52:55]
s_waitcnt lgkmcnt(2)
v_mfma_f32_16x16x32_bf16 v[160:163],a[240:243],v[112:115],v[160:163]
s_add_u32 m0,s23,0
ds_read_b128 a[192:195],v1 offset:0
v_fma_f32 v36,v36,s36,v16
v_mfma_f32_16x16x32_bf16 v[208:211],a[240:243],v[116:119],v[208:211]
buffer_load_dwordx4 v7,s[8:11],s21 offen offset:0 lds
v_mfma_f32_16x16x32_bf16 a[0:3],a[240:243],v[120:123],a[0:3]
ds_read_b64_tr_b16 a[240:241],v3 offset:12416
ds_read_b64_tr_b16 a[242:243],v3 offset:18560
v_mfma_f32_16x16x32_bf16 v[164:167],a[244:247],v[112:115],v[164:167]
ds_read_b128 a[196:199],v2 offset:0
v_fma_f32 v37,v37,s36,v16
v_mfma_f32_16x16x32_bf16 v[212:215],a[244:247],v[116:119],v[212:215]
ds_read_b128 a[200:203],v1 offset:128
v_fma_f32 v38,v38,s36,v16
v_mfma_f32_16x16x32_bf16 a[4:7],a[244:247],v[120:123],a[4:7]
ds_read_b64_tr_b16 a[244:245],v4 offset:12416
ds_read_b64_tr_b16 a[246:247],v4 offset:18560
v_mfma_f32_16x16x32_bf16 v[168:171],a[248:251],v[112:115],v[168:171]
ds_read_b128 a[204:207],v2 offset:128
v_fma_f32 v39,v39,s36,v16
v_mfma_f32_16x16x32_bf16 v[216:219],a[248:251],v[116:119],v[216:219]
buffer_load_dwordx4 v8,s[8:11],s21 offen offset:1024 lds
v_mfma_f32_16x16x32_bf16 a[8:11],a[248:251],v[120:123],a[8:11]
s_waitcnt lgkmcnt(7)
ds_read_b64_tr_b16 a[248:249],v5 offset:12416
ds_read_b64_tr_b16 a[250:251],v5 offset:18560
v_mfma_f32_16x16x32_bf16 v[172:175],a[252:255],v[112:115],v[172:175]
ds_read_b128 a[208:211],v1 offset:256
v_fma_f32 v44,v44,s36,v17
v_mfma_f32_16x16x32_bf16 v[220:223],a[252:255],v[116:119],v[220:223]
ds_read_b128 a[212:215],v2 offset:256
v_fma_f32 v45,v45,s36,v17
v_mfma_f32_16x16x32_bf16 a[12:15],a[252:255],v[120:123],a[12:15]
s_waitcnt lgkmcnt(8)
ds_read_b64_tr_b16 a[252:253],v6 offset:12416
ds_read_b64_tr_b16 a[254:255],v6 offset:18560
v_mfma_f32_16x16x32_bf16 v[176:179],a[240:243],v[112:115],v[176:179]
buffer_load_dwordx4 v9,s[8:11],s21 offen offset:2048 lds
v_mfma_f32_16x16x32_bf16 v[224:227],a[240:243],v[116:119],v[224:227]
s_add_u32 s21,s21,12288
ds_read_b128 a[216:219],v1 offset:6144
v_fma_f32 v46,v46,s36,v17
v_mfma_f32_16x16x32_bf16 a[16:19],a[240:243],v[120:123],a[16:19]
s_add_u32 m0,s22,24576
ds_read_b64_tr_b16 a[240:241],v3 offset:12544
ds_read_b64_tr_b16 a[242:243],v3 offset:18688
s_waitcnt lgkmcnt(9)
v_mfma_f32_16x16x32_bf16 v[180:183],a[244:247],v[112:115],v[180:183]
ds_read_b128 a[220:223],v2 offset:6144
v_fma_f32 v47,v47,s36,v17
v_mfma_f32_16x16x32_bf16 v[228:231],a[244:247],v[116:119],v[228:231]
ds_read_b128 a[224:227],v1 offset:6272
v_fma_f32 v48,v48,s36,v18
v_mfma_f32_16x16x32_bf16 a[20:23],a[244:247],v[120:123],a[20:23]
s_waitcnt lgkmcnt(8)
ds_read_b64_tr_b16 a[244:245],v4 offset:12544
ds_read_b64_tr_b16 a[246:247],v4 offset:18688
v_mfma_f32_16x16x32_bf16 v[184:187],a[248:251],v[112:115],v[184:187]
buffer_load_dwordx4 v7,s[4:7],s20 offen offset:0 lds
v_mfma_f32_16x16x32_bf16 v[232:235],a[248:251],v[116:119],v[232:235]
ds_read_b128 a[228:231],v2 offset:6272
v_fma_f32 v49,v49,s36,v18
v_mfma_f32_16x16x32_bf16 a[24:27],a[248:251],v[120:123],a[24:27]
s_waitcnt lgkmcnt(8)
ds_read_b64_tr_b16 a[248:249],v5 offset:12544
ds_read_b64_tr_b16 a[250:251],v5 offset:18688
v_mfma_f32_16x16x32_bf16 v[188:191],a[252:255],v[112:115],v[188:191]
ds_read_b128 a[232:235],v1 offset:6400
v_fma_f32 v50,v50,s36,v18
v_mfma_f32_16x16x32_bf16 v[236:239],a[252:255],v[116:119],v[236:239]
ds_read_b128 a[236:239],v2 offset:6400
v_fma_f32 v51,v51,s36,v18
v_mfma_f32_16x16x32_bf16 a[28:31],a[252:255],v[120:123],a[28:31]
s_waitcnt lgkmcnt(8)
ds_read_b64_tr_b16 a[252:253],v6 offset:12544
ds_read_b64_tr_b16 a[254:255],v6 offset:18688
v_mfma_f32_16x16x32_bf16 v[192:195],a[240:243],v[112:115],v[192:195]
buffer_load_dwordx4 v8,s[4:7],s20 offen offset:1024 lds
v_mfma_f32_16x16x32_bf16 v[240:243],a[240:243],v[116:119],v[240:243]
v_fma_f32 v52,v52,s36,v18
v_fma_f32 v53,v53,s36,v18
v_mfma_f32_16x16x32_bf16 a[32:35],a[240:243],v[120:123],a[32:35]
s_waitcnt lgkmcnt(7)
v_fma_f32 v54,v54,s36,v18
v_fma_f32 v55,v55,s36,v18
v_mfma_f32_16x16x32_bf16 v[196:199],a[244:247],v[112:115],v[196:199]
v_exp_f32 v36,v36
v_mfma_f32_16x16x32_bf16 v[244:247],a[244:247],v[116:119],v[244:247]
v_exp_f32 v37,v37
v_mfma_f32_16x16x32_bf16 a[36:39],a[244:247],v[120:123],a[36:39]
s_waitcnt lgkmcnt(3)
v_exp_f32 v38,v38
v_mfma_f32_16x16x32_bf16 v[200:203],a[248:251],v[112:115],v[200:203]
buffer_load_dwordx4 v9,s[4:7],s20 offen offset:2048 lds
v_mfma_f32_16x16x32_bf16 v[248:251],a[248:251],v[116:119],v[248:251]
s_add_u32 s20,s20,12288
v_exp_f32 v39,v39
v_mfma_f32_16x16x32_bf16 a[40:43],a[248:251],v[120:123],a[40:43]
s_waitcnt lgkmcnt(0)
v_exp_f32 v44,v44
v_mfma_f32_16x16x32_bf16 v[204:207],a[252:255],v[112:115],v[204:207]
v_exp_f32 v45,v45
v_mfma_f32_16x16x32_bf16 v[252:255],a[252:255],v[116:119],v[252:255]
v_exp_f32 v46,v46
v_mfma_f32_16x16x32_bf16 a[44:47],a[252:255],v[120:123],a[44:47]
v_exp_f32 v47,v47
v_mfma_f32_16x16x32_bf16 v[64:67],a[192:195],a[96:99],0
v_exp_f32 v48,v48
v_mfma_f32_16x16x32_bf16 v[64:67],a[196:199],a[100:103],v[64:67]
v_exp_f32 v49,v49
v_mfma_f32_16x16x32_bf16 v[64:67],a[200:203],a[104:107],v[64:67]
v_exp_f32 v50,v50
v_mfma_f32_16x16x32_bf16 v[64:67],a[204:207],a[108:111],v[64:67]
v_exp_f32 v51,v51
v_mfma_f32_16x16x32_bf16 v[64:67],a[208:211],a[112:115],v[64:67]
v_exp_f32 v52,v52
v_mfma_f32_16x16x32_bf16 v[64:67],a[212:215],a[116:119],v[64:67]
v_exp_f32 v53,v53
v_mfma_f32_16x16x32_bf16 v[72:75],a[192:195],a[120:123],0
v_exp_f32 v54,v54
v_mfma_f32_16x16x32_bf16 v[72:75],a[196:199],a[124:127],v[72:75]
v_exp_f32 v55,v55
v_mfma_f32_16x16x32_bf16 v[72:75],a[200:203],a[128:131],v[72:75]
v_cvt_pk_bf16_f32 v98,v36,v37
v_cvt_pk_bf16_f32 v99,v38,v39
v_mfma_f32_16x16x32_bf16 v[72:75],a[204:207],a[132:135],v[72:75]
v_cvt_pk_bf16_f32 v102,v44,v45
v_cvt_pk_bf16_f32 v103,v46,v47
v_mfma_f32_16x16x32_bf16 v[128:131],v[24:27],v[96:99],v[128:131]
v_cvt_pk_bf16_f32 v104,v48,v49
v_cvt_pk_bf16_f32 v105,v50,v51
v_mfma_f32_16x16x32_bf16 v[132:135],v[24:27],v[100:103],v[132:135]
v_cvt_pk_bf16_f32 v106,v52,v53
v_cvt_pk_bf16_f32 v107,v54,v55
v_mfma_f32_16x16x32_bf16 v[72:75],a[208:211],a[136:139],v[72:75]
v_fma_f32 v64,v64,s36,v16
v_fma_f32 v65,v65,s36,v16
v_mfma_f32_16x16x32_bf16 v[136:139],v[24:27],v[104:107],v[136:139]
v_fma_f32 v66,v66,s36,v16
v_fma_f32 v67,v67,s36,v16
v_mfma_f32_16x16x32_bf16 v[72:75],a[212:215],a[140:143],v[72:75]
v_exp_f32 v64,v64
v_mfma_f32_16x16x32_bf16 v[80:83],a[192:195],a[144:147],0
v_exp_f32 v65,v65
v_mfma_f32_16x16x32_bf16 v[80:83],a[196:199],a[148:151],v[80:83]
v_exp_f32 v66,v66
v_mfma_f32_16x16x32_bf16 v[80:83],a[200:203],a[152:155],v[80:83]
v_exp_f32 v67,v67
v_mfma_f32_16x16x32_bf16 v[80:83],a[204:207],a[156:159],v[80:83]
v_fma_f32 v72,v72,s36,v17
v_fma_f32 v73,v73,s36,v17
v_mfma_f32_16x16x32_bf16 v[80:83],a[208:211],a[160:163],v[80:83]
v_fma_f32 v74,v74,s36,v17
v_fma_f32 v75,v75,s36,v17
v_mfma_f32_16x16x32_bf16 v[80:83],a[212:215],a[164:167],v[80:83]
v_exp_f32 v72,v72
v_mfma_f32_16x16x32_bf16 v[68:71],a[216:219],a[96:99],0
v_exp_f32 v73,v73
v_mfma_f32_16x16x32_bf16 v[68:71],a[220:223],a[100:103],v[68:71]
v_exp_f32 v74,v74
v_mfma_f32_16x16x32_bf16 v[68:71],a[224:227],a[104:107],v[68:71]
v_exp_f32 v75,v75
v_mfma_f32_16x16x32_bf16 v[68:71],a[228:231],a[108:111],v[68:71]
v_cvt_pk_bf16_f32 v112,v64,v65
v_cvt_pk_bf16_f32 v113,v66,v67
s_waitcnt vmcnt(6)
v_mfma_f32_16x16x32_bf16 v[68:71],a[232:235],a[112:115],v[68:71]
s_barrier
v_mfma_f32_16x16x32_bf16 v[68:71],a[236:239],a[116:119],v[68:71]
ds_read_b64_tr_b16 a[240:241],v3 offset:24576
ds_read_b64_tr_b16 a[242:243],v3 offset:30720
v_mfma_f32_16x16x32_bf16 v[76:79],a[216:219],a[120:123],0
v_cvt_pk_bf16_f32 v116,v72,v73
v_cvt_pk_bf16_f32 v117,v74,v75
v_mfma_f32_16x16x32_bf16 v[76:79],a[220:223],a[124:127],v[76:79]
ds_read_b64_tr_b16 a[244:245],v4 offset:24576
ds_read_b64_tr_b16 a[246:247],v4 offset:30720
v_mfma_f32_16x16x32_bf16 v[76:79],a[224:227],a[128:131],v[76:79]
ds_read_b64_tr_b16 a[248:249],v5 offset:24576
ds_read_b64_tr_b16 a[250:251],v5 offset:30720
v_mfma_f32_16x16x32_bf16 v[76:79],a[228:231],a[132:135],v[76:79]
v_mfma_f32_16x16x32_bf16 v[76:79],a[232:235],a[136:139],v[76:79]
ds_read_b64_tr_b16 a[252:253],v6 offset:24576
ds_read_b64_tr_b16 a[254:255],v6 offset:30720
v_mfma_f32_16x16x32_bf16 v[76:79],a[236:239],a[140:143],v[76:79]
v_mfma_f32_16x16x32_bf16 v[84:87],a[216:219],a[144:147],0
v_mfma_f32_16x16x32_bf16 v[84:87],a[220:223],a[148:151],v[84:87]
v_mfma_f32_16x16x32_bf16 v[84:87],a[224:227],a[152:155],v[84:87]
v_mfma_f32_16x16x32_bf16 v[84:87],a[228:231],a[156:159],v[84:87]
v_mfma_f32_16x16x32_bf16 v[84:87],a[232:235],a[160:163],v[84:87]
v_mfma_f32_16x16x32_bf16 v[84:87],a[236:239],a[164:167],v[84:87]
s_mov_b32 s38,0
s_branch L_loop3
L_tr44:
s_waitcnt vmcnt(36)
s_waitcnt lgkmcnt(4)
v_mfma_f32_16x16x32_bf16 v[160:163],a[240:243],v[96:99],v[160:163]
s_add_u32 m0,s24,0
ds_read_b128 a[96:99],v28 offset:0
v_fma_f32 v68,v68,s36,v16
v_mfma_f32_16x16x32_bf16 v[208:211],a[240:243],v[100:103],v[208:211]
ds_read_b128 a[100:103],v29 offset:0
v_fma_f32 v69,v69,s36,v16
v_mfma_f32_16x16x32_bf16 a[0:3],a[240:243],v[104:107],a[0:3]
ds_read_b128 a[104:107],v28 offset:128
v_fma_f32 v70,v70,s36,v16
v_mfma_f32_16x16x32_bf16 a[48:51],a[240:243],v[108:111],a[48:51]
ds_read_b128 a[108:111],v29 offset:128
v_fma_f32 v71,v71,s36,v16
v_mfma_f32_16x16x32_bf16 v[164:167],a[244:247],v[96:99],v[164:167]
ds_read_b128 a[112:115],v28 offset:256
v_fma_f32 v76,v76,s36,v17
v_mfma_f32_16x16x32_bf16 v[212:215],a[244:247],v[100:103],v[212:215]
ds_read_b128 a[116:119],v29 offset:256
v_fma_f32 v77,v77,s36,v17
v_mfma_f32_16x16x32_bf16 a[4:7],a[244:247],v[104:107],a[4:7]
ds_read_b64_tr_b16 a[240:241],v3 offset:24704
ds_read_b64_tr_b16 a[242:243],v3 offset:30848
v_mfma_f32_16x16x32_bf16 a[52:55],a[244:247],v[108:111],a[52:55]
s_waitcnt lgkmcnt(8)
ds_read_b64_tr_b16 a[244:245],v4 offset:24704
ds_read_b64_tr_b16 a[246:247],v4 offset:30848
v_mfma_f32_16x16x32_bf16 v[168:171],a[248:251],v[96:99],v[168:171]
ds_read_b128 a[192:195],v13 offset:0
v_fma_f32 v78,v78,s36,v17
v_mfma_f32_16x16x32_bf16 v[216:219],a[248:251],v[100:103],v[216:219]
ds_read_b128 a[196:199],v14 offset:0
v_fma_f32 v79,v79,s36,v17
v_mfma_f32_16x16x32_bf16 a[8:11],a[248:251],v[104:107],a[8:11]
ds_read_b128 a[200:203],v13 offset:128
v_fma_f32 v80,v80,s36,v18
v_mfma_f32_16x16x32_bf16 a[56:59],a[248:251],v[108:111],a[56:59]
ds_read_b64_tr_b16 a[248:249],v5 offset:24704
ds_read_b64_tr_b16 a[250:251],v5 offset:30848
v_mfma_f32_16x16x32_bf16 v[172:175],a[252:255],v[96:99],v[172:175]
ds_read_b128 a[204:207],v14 offset:128
v_fma_f32 v81,v81,s36,v18
v_mfma_f32_16x16x32_bf16 v[220:223],a[252:255],v[100:103],v[220:223]
ds_read_b128 a[208:211],v13 offset:256
v_fma_f32 v82,v82,s36,v18
v_mfma_f32_16x16x32_bf16 a[12:15],a[252:255],v[104:107],a[12:15]
s_waitcnt lgkmcnt(11)
buffer_load_dwordx4 v7,s[12:15],s28 offen offset:0 nt lds
v_mfma_f32_16x16x32_bf16 a[60:63],a[252:255],v[108:111],a[60:63]
s_waitcnt lgkmcnt(7)
ds_read_b64_tr_b16 a[252:253],v6 offset:24704
ds_read_b64_tr_b16 a[254:255],v6 offset:30848
v_mfma_f32_16x16x32_bf16 v[176:179],a[240:243],v[96:99],v[176:179]
ds_read_b128 a[212:215],v14 offset:256
v_fma_f32 v83,v83,s36,v18
v_mfma_f32_16x16x32_bf16 v[224:227],a[240:243],v[100:103],v[224:227]
ds_read_b128 a[216:219],v13 offset:45056
v_fma_f32 v84,v84,s36,v18
v_mfma_f32_16x16x32_bf16 a[16:19],a[240:243],v[104:107],a[16:19]
ds_read_b128 a[220:223],v14 offset:45056
v_fma_f32 v85,v85,s36,v18
v_mfma_f32_16x16x32_bf16 a[64:67],a[240:243],v[108:111],a[64:67]
ds_read_b64_tr_b16 a[240:241],v3 offset:24832
ds_read_b64_tr_b16 a[242:243],v3 offset:30976
v_mfma_f32_16x16x32_bf16 v[180:183],a[244:247],v[96:99],v[180:183]
ds_read_b128 a[224:227],v13 offset:45184
v_fma_f32 v86,v86,s36,v18
v_mfma_f32_16x16x32_bf16 v[228:231],a[244:247],v[100:103],v[228:231]
buffer_load_dwordx4 v8,s[12:15],s28 offen offset:1024 nt lds
v_mfma_f32_16x16x32_bf16 a[20:23],a[244:247],v[104:107],a[20:23]
ds_read_b128 a[228:231],v14 offset:45184
v_fma_f32 v87,v87,s36,v18
v_mfma_f32_16x16x32_bf16 a[68:71],a[244:247],v[108:111],a[68:71]
s_waitcnt lgkmcnt(7)
ds_read_b64_tr_b16 a[244:245],v4 offset:24832
ds_read_b64_tr_b16 a[246:247],v4 offset:30976
v_mfma_f32_16x16x32_bf16 v[184:187],a[248:251],v[96:99],v[184:187]
ds_read_b128 a[232:235],v13 offset:45312
v_fma_f32 v88,v88,s36,v19
v_mfma_f32_16x16x32_bf16 v[232:235],a[248:251],v[100:103],v[232:235]
ds_read_b128 a[236:239],v14 offset:45312
v_fma_f32 v89,v89,s36,v19
v_mfma_f32_16x16x32_bf16 a[24:27],a[248:251],v[104:107],a[24:27]
ds_read_b128 a[120:123],v28 offset:6144
v_fma_f32 v90,v90,s36,v19
v_mfma_f32_16x16x32_bf16 a[72:75],a[248:251],v[108:111],a[72:75]
ds_read_b64_tr_b16 a[248:249],v5 offset:24832
ds_read_b64_tr_b16 a[250:251],v5 offset:30976
v_mfma_f32_16x16x32_bf16 v[188:191],a[252:255],v[96:99],v[188:191]
ds_read_b128 a[124:127],v29 offset:6144
v_fma_f32 v91,v91,s36,v19
v_mfma_f32_16x16x32_bf16 v[236:239],a[252:255],v[100:103],v[236:239]
ds_read_b128 a[128:131],v28 offset:6272
v_fma_f32 v92,v92,s36,v19
v_mfma_f32_16x16x32_bf16 a[28:31],a[252:255],v[104:107],a[28:31]
buffer_load_dwordx4 v9,s[12:15],s28 offen offset:2048 nt lds
v_mfma_f32_16x16x32_bf16 a[76:79],a[252:255],v[108:111],a[76:79]
s_add_u32 s28,s28,3072
ds_read_b64_tr_b16 a[252:253],v6 offset:24832
ds_read_b64_tr_b16 a[254:255],v6 offset:30976
s_waitcnt lgkmcnt(9)
v_mfma_f32_16x16x32_bf16 v[192:195],a[240:243],v[96:99],v[192:195]
s_add_u32 m0,s24,3072
ds_read_b128 a[132:135],v29 offset:6272
v_fma_f32 v93,v93,s36,v19
v_mfma_f32_16x16x32_bf16 v[240:243],a[240:243],v[100:103],v[240:243]
ds_read_b128 a[136:139],v28 offset:6400
v_fma_f32 v94,v94,s36,v19
v_mfma_f32_16x16x32_bf16 a[32:35],a[240:243],v[104:107],a[32:35]
ds_read_b128 a[140:143],v29 offset:6400
v_fma_f32 v95,v95,s36,v19
v_mfma_f32_16x16x32_bf16 a[80:83],a[240:243],v[108:111],a[80:83]
v_exp_f32 v68,v68
v_mfma_f32_16x16x32_bf16 v[196:199],a[244:247],v[96:99],v[196:199]
v_exp_f32 v69,v69
v_mfma_f32_16x16x32_bf16 v[244:247],a[244:247],v[100:103],v[244:247]
v_exp_f32 v70,v70
v_mfma_f32_16x16x32_bf16 a[36:39],a[244:247],v[104:107],a[36:39]
v_exp_f32 v71,v71
v_mfma_f32_16x16x32_bf16 a[84:87],a[244:247],v[108:111],a[84:87]
s_waitcnt lgkmcnt(4)
v_exp_f32 v76,v76
v_mfma_f32_16x16x32_bf16 v[200:203],a[248:251],v[96:99],v[200:203]
buffer_load_dwordx4 v7,s[12:15],s28 offen offset:0 nt lds
v_mfma_f32_16x16x32_bf16 v[248:251],a[248:251],v[100:103],v[248:251]
v_exp_f32 v77,v77
v_mfma_f32_16x16x32_bf16 a[40:43],a[248:251],v[104:107],a[40:43]
v_exp_f32 v78,v78
v_mfma_f32_16x16x32_bf16 a[88:91],a[248:251],v[108:111],a[88:91]
s_waitcnt lgkmcnt(0)
v_exp_f32 v79,v79
v_mfma_f32_16x16x32_bf16 v[204:207],a[252:255],v[96:99],v[204:207]
v_exp_f32 v80,v80
v_mfma_f32_16x16x32_bf16 v[252:255],a[252:255],v[100:103],v[252:255]
v_exp_f32 v81,v81
v_mfma_f32_16x16x32_bf16 a[44:47],a[252:255],v[104:107],a[44:47]
v_exp_f32 v82,v82
v_mfma_f32_16x16x32_bf16 a[92:95],a[252:255],v[108:111],a[92:95]
v_exp_f32 v83,v83
v_exp_f32 v84,v84
v_exp_f32 v85,v85
v_exp_f32 v86,v86
v_exp_f32 v87,v87
v_exp_f32 v88,v88
v_exp_f32 v89,v89
v_exp_f32 v90,v90
v_exp_f32 v91,v91
v_exp_f32 v92,v92
v_exp_f32 v93,v93
v_exp_f32 v94,v94
v_exp_f32 v95,v95
v_cvt_pk_bf16_f32 v114,v68,v69
v_cvt_pk_bf16_f32 v115,v70,v71
v_cvt_pk_bf16_f32 v118,v76,v77
v_cvt_pk_bf16_f32 v119,v78,v79
v_mfma_f32_16x16x32_bf16 v[128:131],v[24:27],v[112:115],v[128:131]
buffer_load_dwordx4 v8,s[12:15],s28 offen offset:1024 nt lds
v_mfma_f32_16x16x32_bf16 v[132:135],v[24:27],v[116:119],v[132:135]
v_cvt_pk_bf16_f32 v120,v80,v81
v_cvt_pk_bf16_f32 v121,v82,v83
v_cvt_pk_bf16_f32 v122,v84,v85
v_cvt_pk_bf16_f32 v123,v86,v87
v_cvt_pk_bf16_f32 v124,v88,v89
v_cvt_pk_bf16_f32 v125,v90,v91
v_mfma_f32_16x16x32_bf16 v[136:139],v[24:27],v[120:123],v[136:139]
buffer_load_dwordx4 v9,s[12:15],s28 offen offset:2048 nt lds
s_waitcnt vmcnt(12)
s_barrier
ds_read_b64_tr_b16 a[240:241],v3 offset:0
ds_read_b64_tr_b16 a[242:243],v3 offset:6144
ds_read_b64_tr_b16 a[244:245],v4 offset:0
v_cvt_pk_bf16_f32 v126,v92,v93
v_cvt_pk_bf16_f32 v127,v94,v95
s_add_u32 s28,s28,3072
ds_read_b64_tr_b16 a[246:247],v4 offset:6144
v_mfma_f32_16x16x32_bf16 v[140:143],v[24:27],v[124:127],v[140:143]
ds_read_b64_tr_b16 a[248:249],v5 offset:0
ds_read_b64_tr_b16 a[250:251],v5 offset:6144
ds_read_b64_tr_b16 a[252:253],v6 offset:0
ds_read_b64_tr_b16 a[254:255],v6 offset:6144
s_waitcnt lgkmcnt(6)
v_mfma_f32_16x16x32_bf16 v[160:163],a[240:243],v[112:115],v[160:163]
s_add_u32 s87,s42,18432
v_rcp_f32 v146,v132
v_mfma_f32_16x16x32_bf16 v[208:211],a[240:243],v[116:119],v[208:211]
v_rcp_f32 v150,v140
v_mfma_f32_16x16x32_bf16 a[0:3],a[240:243],v[120:123],a[0:3]
v_rcp_f32 v148,v136
v_mfma_f32_16x16x32_bf16 a[48:51],a[240:243],v[124:127],a[48:51]
s_waitcnt lgkmcnt(4)
ds_read_b64_tr_b16 a[240:241],v3 offset:128
ds_read_b64_tr_b16 a[242:243],v3 offset:6272
v_mfma_f32_16x16x32_bf16 v[164:167],a[244:247],v[112:115],v[164:167]
v_max3_f32 v30,v128,v132,v136
v_max_f32 v30,v30,v140
v_mfma_f32_16x16x32_bf16 v[212:215],a[244:247],v[116:119],v[212:215]
v_cmp_ngt_f32 vcc,s37,v30
v_rcp_f32 v144,v128
v_mfma_f32_16x16x32_bf16 a[4:7],a[244:247],v[120:123],a[4:7]
v_accvgpr_read_b32 v64,a48
v_accvgpr_read_b32 v65,a49
v_mfma_f32_16x16x32_bf16 a[52:55],a[244:247],v[124:127],a[52:55]
s_cmp_lg_u64 vcc,0
ds_read_b64_tr_b16 a[244:245],v4 offset:128
ds_read_b64_tr_b16 a[246:247],v4 offset:6272
v_accvgpr_read_b32 v66,a50
v_accvgpr_read_b32 v67,a51
v_subrev_u32 v11,18432,v11
v_pk_mul_f32 v[64:65],v[64:65],v[150:151] op_sel_hi:[1,0]
v_pk_mul_f32 v[208:209],v[208:209],v[146:147] op_sel_hi:[1,0]
v_pk_mul_f32 v[210:211],v[210:211],v[146:147] op_sel_hi:[1,0]
v_pk_mul_f32 v[66:67],v[66:67],v[150:151] op_sel_hi:[1,0]
v_accvgpr_read_b32 v68,a52
v_accvgpr_read_b32 v69,a53
s_waitcnt lgkmcnt(4)
v_mfma_f32_16x16x32_bf16 v[168:171],a[248:251],v[112:115],v[168:171]
s_cselect_b32 s62,s32,0
v_accvgpr_read_b32 v70,a54
v_accvgpr_read_b32 v71,a55
v_mfma_f32_16x16x32_bf16 v[216:219],a[248:251],v[116:119],v[216:219]
s_or_b32 s31,s31,s62
v_cvt_pk_bf16_f32 v64,v64,v65
v_cvt_pk_bf16_f32 v208,v208,v209
v_mfma_f32_16x16x32_bf16 a[8:11],a[248:251],v[120:123],a[8:11]
s_lshl_b32 s32,s32,1
v_cvt_pk_bf16_f32 v65,v66,v67
v_cvt_pk_bf16_f32 v209,v210,v211
v_mfma_f32_16x16x32_bf16 a[56:59],a[248:251],v[124:127],a[56:59]
s_add_u32 m0,s22,24576
ds_read_b64_tr_b16 a[248:249],v5 offset:128
buffer_load_dwordx4 v7,s[4:7],s20 offen offset:0 lds
ds_read_b64_tr_b16 a[250:251],v5 offset:6272
ds_write2st64_b64 v12,v[64:65],v[208:209] offset0:36 offset1:12
v_pk_mul_f32 v[68:69],v[68:69],v[150:151] op_sel_hi:[1,0]
v_pk_mul_f32 v[70:71],v[70:71],v[150:151] op_sel_hi:[1,0]
v_pk_mul_f32 v[212:213],v[212:213],v[146:147] op_sel_hi:[1,0]
v_pk_mul_f32 v[214:215],v[214:215],v[146:147] op_sel_hi:[1,0]
v_accvgpr_read_b32 v72,a56
v_accvgpr_read_b32 v73,a57
v_mfma_f32_16x16x32_bf16 v[172:175],a[252:255],v[112:115],v[172:175]
v_accvgpr_read_b32 v74,a58
v_accvgpr_read_b32 v75,a59
v_mfma_f32_16x16x32_bf16 v[220:223],a[252:255],v[116:119],v[220:223]
v_cvt_pk_bf16_f32 v68,v68,v69
v_cvt_pk_bf16_f32 v212,v212,v213
v_mfma_f32_16x16x32_bf16 a[12:15],a[252:255],v[120:123],a[12:15]
v_cvt_pk_bf16_f32 v69,v70,v71
v_cvt_pk_bf16_f32 v213,v214,v215
v_mfma_f32_16x16x32_bf16 a[60:63],a[252:255],v[124:127],a[60:63]
s_waitcnt lgkmcnt(3)
ds_read_b64_tr_b16 a[252:253],v6 offset:128
ds_read_b64_tr_b16 a[254:255],v6 offset:6272
v_mfma_f32_16x16x32_bf16 v[176:179],a[240:243],v[112:115],v[176:179]
ds_write2st64_b64 v20,v[68:69],v[212:213] offset0:36 offset1:12
v_pk_mul_f32 v[72:73],v[72:73],v[150:151] op_sel_hi:[1,0]
v_pk_mul_f32 v[74:75],v[74:75],v[150:151] op_sel_hi:[1,0]
v_pk_mul_f32 v[216:217],v[216:217],v[146:147] op_sel_hi:[1,0]
v_pk_mul_f32 v[218:219],v[218:219],v[146:147] op_sel_hi:[1,0]
v_accvgpr_read_b32 v76,a60
v_accvgpr_read_b32 v77,a61
v_mfma_f32_16x16x32_bf16 v[224:227],a[240:243],v[116:119],v[224:227]
buffer_load_dwordx4 v8,s[4:7],s20 offen offset:1024 lds
v_mfma_f32_16x16x32_bf16 a[16:19],a[240:243],v[120:123],a[16:19]
v_accvgpr_read_b32 v78,a62
v_accvgpr_read_b32 v79,a63
v_mfma_f32_16x16x32_bf16 a[64:67],a[240:243],v[124:127],a[64:67]
ds_read_b64_tr_b16 a[240:241],v3 offset:256
ds_read_b64_tr_b16 a[242:243],v3 offset:6400
v_mfma_f32_16x16x32_bf16 v[180:183],a[244:247],v[112:115],v[180:183]
v_cvt_pk_bf16_f32 v72,v72,v73
v_cvt_pk_bf16_f32 v216,v216,v217
v_cvt_pk_bf16_f32 v73,v74,v75
v_cvt_pk_bf16_f32 v217,v218,v219
v_subrev_u32 v23,18432,v23
v_pk_mul_f32 v[76:77],v[76:77],v[150:151] op_sel_hi:[1,0]
v_pk_mul_f32 v[78:79],v[78:79],v[150:151] op_sel_hi:[1,0]
v_pk_mul_f32 v[220:221],v[220:221],v[146:147] op_sel_hi:[1,0]
v_pk_mul_f32 v[222:223],v[222:223],v[146:147] op_sel_hi:[1,0]
v_accvgpr_read_b32 v80,a64
v_accvgpr_read_b32 v81,a65
v_mfma_f32_16x16x32_bf16 v[228:231],a[244:247],v[116:119],v[228:231]
ds_write2st64_b64 v21,v[72:73],v[216:217] offset0:36 offset1:12
v_mfma_f32_16x16x32_bf16 a[20:23],a[244:247],v[120:123],a[20:23]
v_accvgpr_read_b32 v82,a66
v_accvgpr_read_b32 v83,a67
v_mfma_f32_16x16x32_bf16 a[68:71],a[244:247],v[124:127],a[68:71]
s_waitcnt lgkmcnt(3)
ds_read_b64_tr_b16 a[244:245],v4 offset:256
ds_read_b64_tr_b16 a[246:247],v4 offset:6400
v_mfma_f32_16x16x32_bf16 v[184:187],a[248:251],v[112:115],v[184:187]
v_cvt_pk_bf16_f32 v76,v76,v77
v_cvt_pk_bf16_f32 v220,v220,v221
v_cvt_pk_bf16_f32 v77,v78,v79
v_cvt_pk_bf16_f32 v221,v222,v223
v_subrev_u32 v31,18432,v31
v_pk_mul_f32 v[80:81],v[80:81],v[150:151] op_sel_hi:[1,0]
v_pk_mul_f32 v[82:83],v[82:83],v[150:151] op_sel_hi:[1,0]
v_pk_mul_f32 v[224:225],v[224:225],v[146:147] op_sel_hi:[1,0]
v_pk_mul_f32 v[226:227],v[226:227],v[146:147] op_sel_hi:[1,0]
v_accvgpr_read_b32 v84,a68
v_accvgpr_read_b32 v85,a69
v_mfma_f32_16x16x32_bf16 v[232:235],a[248:251],v[116:119],v[232:235]
ds_write2st64_b64 v22,v[76:77],v[220:221] offset0:36 offset1:12
v_mfma_f32_16x16x32_bf16 a[24:27],a[248:251],v[120:123],a[24:27]
v_accvgpr_read_b32 v86,a70
v_accvgpr_read_b32 v87,a71
v_mfma_f32_16x16x32_bf16 a[72:75],a[248:251],v[124:127],a[72:75]
ds_read_b64_tr_b16 a[248:249],v5 offset:256
ds_read_b64_tr_b16 a[250:251],v5 offset:6400
v_mfma_f32_16x16x32_bf16 v[188:191],a[252:255],v[112:115],v[188:191]
ds_read_b128 v[152:155],v15 offset:18432
v_cvt_pk_bf16_f32 v80,v80,v81
v_mfma_f32_16x16x32_bf16 v[236:239],a[252:255],v[116:119],v[236:239]
buffer_load_dwordx4 v9,s[4:7],s20 offen offset:2048 lds
ds_read_b128 v[156:159],v15 offset:21504
v_accvgpr_read_b32 v88,a72
v_pk_mul_f32 v[84:85],v[84:85],v[150:151] op_sel_hi:[1,0]
v_pk_mul_f32 v[86:87],v[86:87],v[150:151] op_sel_hi:[1,0]
v_pk_mul_f32 v[228:229],v[228:229],v[146:147] op_sel_hi:[1,0]
v_pk_mul_f32 v[230:231],v[230:231],v[146:147] op_sel_hi:[1,0]
v_accvgpr_read_b32 v89,a73
v_accvgpr_read_b32 v90,a74
v_mfma_f32_16x16x32_bf16 a[28:31],a[252:255],v[120:123],a[28:31]
s_add_u32 s20,s20,12288
v_accvgpr_read_b32 v91,a75
v_cvt_pk_bf16_f32 v224,v224,v225
v_mfma_f32_16x16x32_bf16 a[76:79],a[252:255],v[124:127],a[76:79]
s_add_u32 m0,s23,0
ds_read_b64_tr_b16 a[252:253],v6 offset:256
ds_read_b64_tr_b16 a[254:255],v6 offset:6400
s_waitcnt lgkmcnt(6)
v_mfma_f32_16x16x32_bf16 v[192:195],a[240:243],v[112:115],v[192:195]
v_cvt_pk_bf16_f32 v81,v82,v83
v_cvt_pk_bf16_f32 v84,v84,v85
v_mfma_f32_16x16x32_bf16 v[240:243],a[240:243],v[116:119],v[240:243]
v_cvt_pk_bf16_f32 v228,v228,v229
v_accvgpr_read_b32 v92,a76
v_accvgpr_read_b32 v93,a77
v_accvgpr_read_b32 v94,a78
v_accvgpr_read_b32 v95,a79
v_pk_mul_f32 v[88:89],v[88:89],v[150:151] op_sel_hi:[1,0]
v_pk_mul_f32 v[90:91],v[90:91],v[150:151] op_sel_hi:[1,0]
v_pk_mul_f32 v[232:233],v[232:233],v[146:147] op_sel_hi:[1,0]
v_pk_mul_f32 v[234:235],v[234:235],v[146:147] op_sel_hi:[1,0]
v_cvt_pk_bf16_f32 v225,v226,v227
v_cvt_pk_bf16_f32 v85,v86,v87
v_mfma_f32_16x16x32_bf16 a[32:35],a[240:243],v[120:123],a[32:35]
ds_write2st64_b64 v12,v[80:81],v[224:225] offset0:36 offset1:14
v_mfma_f32_16x16x32_bf16 a[80:83],a[240:243],v[124:127],a[80:83]
v_cvt_pk_bf16_f32 v229,v230,v231
v_accvgpr_read_b32 v82,a2
v_mfma_f32_16x16x32_bf16 v[196:199],a[244:247],v[112:115],v[196:199]
s_waitcnt lgkmcnt(3)
buffer_store_dwordx4 v[152:155],v10,s[16:19],s87 offen offset:0 nt
v_accvgpr_read_b32 v83,a3
v_accvgpr_read_b32 v86,a18
v_accvgpr_read_b32 v87,a19
v_mfma_f32_16x16x32_bf16 v[244:247],a[244:247],v[116:119],v[244:247]
s_waitcnt vmcnt(10)
ds_read_b128 a[144:147],v28 offset:12288
v_accvgpr_read_b32 v64,a80
v_accvgpr_read_b32 v65,a81
v_accvgpr_read_b32 v66,a82
v_accvgpr_read_b32 v67,a83
v_pk_mul_f32 v[92:93],v[92:93],v[150:151] op_sel_hi:[1,0]
v_pk_mul_f32 v[94:95],v[94:95],v[150:151] op_sel_hi:[1,0]
v_pk_mul_f32 v[236:237],v[236:237],v[146:147] op_sel_hi:[1,0]
v_pk_mul_f32 v[238:239],v[238:239],v[146:147] op_sel_hi:[1,0]
v_accvgpr_read_b32 v80,a0
v_accvgpr_read_b32 v81,a1
v_mfma_f32_16x16x32_bf16 a[36:39],a[244:247],v[120:123],a[36:39]
ds_read_b128 a[148:151],v29 offset:12288
buffer_store_dwordx4 v[156:159],v10,s[16:19],s87 offen offset:3072 nt
ds_read_b128 a[152:155],v28 offset:12416
v_cvt_pk_bf16_f32 v88,v88,v89
s_waitcnt vmcnt(14)
s_waitcnt lgkmcnt(3)
s_barrier
v_mfma_f32_16x16x32_bf16 a[84:87],a[244:247],v[124:127],a[84:87]
ds_read_b128 a[156:159],v29 offset:12416
v_cvt_pk_bf16_f32 v232,v232,v233
v_mfma_f32_16x16x32_bf16 v[200:203],a[248:251],v[112:115],v[200:203]
ds_read_b128 a[160:163],v28 offset:12544
v_cvt_pk_bf16_f32 v92,v92,v93
v_mfma_f32_16x16x32_bf16 v[248:251],a[248:251],v[116:119],v[248:251]
ds_read_b128 a[164:167],v29 offset:12544
v_cvt_pk_bf16_f32 v236,v236,v237
v_mfma_f32_16x16x32_bf16 a[40:43],a[248:251],v[120:123],a[40:43]
ds_write2st64_b64 v20,v[84:85],v[228:229] offset0:36 offset1:14
v_pk_mul_f32 v[64:65],v[64:65],v[150:151] op_sel_hi:[1,0]
v_pk_mul_f32 v[66:67],v[66:67],v[150:151] op_sel_hi:[1,0]
v_pk_mul_f32 v[240:241],v[240:241],v[146:147] op_sel_hi:[1,0]
v_pk_mul_f32 v[242:243],v[242:243],v[146:147] op_sel_hi:[1,0]
v_accvgpr_read_b32 v68,a84
v_accvgpr_read_b32 v69,a85
v_mfma_f32_16x16x32_bf16 a[88:91],a[248:251],v[124:127],a[88:91]
buffer_load_dwordx4 v7,s[8:11],s21 offen offset:0 lds
v_mfma_f32_16x16x32_bf16 v[204:207],a[252:255],v[112:115],v[204:207]
v_accvgpr_read_b32 v70,a86
v_accvgpr_read_b32 v71,a87
v_mfma_f32_16x16x32_bf16 v[252:255],a[252:255],v[116:119],v[252:255]
v_accvgpr_read_b32 v84,a16
v_accvgpr_read_b32 v85,a17
v_mfma_f32_16x16x32_bf16 a[44:47],a[252:255],v[120:123],a[44:47]
v_accvgpr_read_b32 v72,a88
v_accvgpr_read_b32 v73,a89
v_accvgpr_read_b32 v74,a90
v_accvgpr_read_b32 v75,a91
v_cvt_pk_bf16_f32 v89,v90,v91
v_pk_mul_f32 v[68:69],v[68:69],v[150:151] op_sel_hi:[1,0]
v_pk_mul_f32 v[70:71],v[70:71],v[150:151] op_sel_hi:[1,0]
v_pk_mul_f32 v[244:245],v[244:245],v[146:147] op_sel_hi:[1,0]
v_pk_mul_f32 v[246:247],v[246:247],v[146:147] op_sel_hi:[1,0]
v_cvt_pk_bf16_f32 v233,v234,v235
v_cvt_pk_bf16_f32 v93,v94,v95
v_mfma_f32_16x16x32_bf16 a[92:95],a[252:255],v[124:127],a[92:95]
ds_write2st64_b64 v21,v[88:89],v[232:233] offset0:36 offset1:14
v_mfma_f32_16x16x32_bf16 v[32:35],a[192:195],a[96:99],0
v_cvt_pk_bf16_f32 v237,v238,v239
v_accvgpr_read_b32 v90,a6
v_mfma_f32_16x16x32_bf16 v[32:35],a[196:199],a[100:103],v[32:35]
v_accvgpr_read_b32 v91,a7
v_accvgpr_read_b32 v94,a22
v_mfma_f32_16x16x32_bf16 v[32:35],a[200:203],a[104:107],v[32:35]
v_accvgpr_read_b32 v76,a92
v_accvgpr_read_b32 v77,a93
v_accvgpr_read_b32 v78,a94
v_accvgpr_read_b32 v79,a95
v_accvgpr_read_b32 v95,a23
v_pk_mul_f32 v[72:73],v[72:73],v[150:151] op_sel_hi:[1,0]
v_pk_mul_f32 v[74:75],v[74:75],v[150:151] op_sel_hi:[1,0]
v_pk_mul_f32 v[248:249],v[248:249],v[146:147] op_sel_hi:[1,0]
v_pk_mul_f32 v[250:251],v[250:251],v[146:147] op_sel_hi:[1,0]
v_accvgpr_read_b32 v88,a4
v_accvgpr_read_b32 v89,a5
v_mfma_f32_16x16x32_bf16 v[32:35],a[204:207],a[108:111],v[32:35]
buffer_load_dwordx4 v8,s[8:11],s21 offen offset:1024 lds
v_mfma_f32_16x16x32_bf16 v[32:35],a[208:211],a[112:115],v[32:35]
ds_write2st64_b64 v22,v[92:93],v[236:237] offset0:36 offset1:14
v_mfma_f32_16x16x32_bf16 v[32:35],a[212:215],a[116:119],v[32:35]
v_accvgpr_read_b32 v92,a20
v_accvgpr_read_b32 v93,a21
v_mfma_f32_16x16x32_bf16 v[36:39],a[216:219],a[96:99],0
ds_read_b128 v[152:155],v15 offset:18432
v_cvt_pk_bf16_f32 v64,v64,v65
v_mfma_f32_16x16x32_bf16 v[36:39],a[220:223],a[100:103],v[36:39]
ds_read_b128 v[156:159],v15 offset:21504
v_cvt_pk_bf16_f32 v240,v240,v241
v_cvt_pk_bf16_f32 v68,v68,v69
v_cvt_pk_bf16_f32 v244,v244,v245
v_cvt_pk_bf16_f32 v65,v66,v67
v_pk_mul_f32 v[76:77],v[76:77],v[150:151] op_sel_hi:[1,0]
v_pk_mul_f32 v[78:79],v[78:79],v[150:151] op_sel_hi:[1,0]
v_pk_mul_f32 v[252:253],v[252:253],v[146:147] op_sel_hi:[1,0]
v_pk_mul_f32 v[254:255],v[254:255],v[146:147] op_sel_hi:[1,0]
v_cvt_pk_bf16_f32 v241,v242,v243
v_cvt_pk_bf16_f32 v69,v70,v71
v_mfma_f32_16x16x32_bf16 v[36:39],a[224:227],a[104:107],v[36:39]
ds_write2st64_b64 v12,v[64:65],v[240:241] offset0:36 offset1:16
v_mfma_f32_16x16x32_bf16 v[36:39],a[228:231],a[108:111],v[36:39]
v_cvt_pk_bf16_f32 v245,v246,v247
v_accvgpr_read_b32 v66,a10
v_mfma_f32_16x16x32_bf16 v[36:39],a[232:235],a[112:115],v[36:39]
buffer_load_dwordx4 v9,s[8:11],s21 offen offset:2048 lds
v_mfma_f32_16x16x32_bf16 v[36:39],a[236:239],a[116:119],v[36:39]
s_add_u32 s21,s21,12288
v_accvgpr_read_b32 v67,a11
v_accvgpr_read_b32 v70,a26
v_accvgpr_read_b32 v71,a27
v_accvgpr_read_b32 v64,a8
v_accvgpr_read_b32 v65,a9
v_pk_mul_f32 v[80:81],v[80:81],v[148:149] op_sel_hi:[1,0]
v_pk_mul_f32 v[82:83],v[82:83],v[148:149] op_sel_hi:[1,0]
v_pk_mul_f32 v[84:85],v[84:85],v[148:149] op_sel_hi:[1,0]
v_pk_mul_f32 v[86:87],v[86:87],v[148:149] op_sel_hi:[1,0]
v_cvt_pk_bf16_f32 v72,v72,v73
v_cvt_pk_bf16_f32 v248,v248,v249
v_mfma_f32_16x16x32_bf16 v[40:43],a[192:195],a[120:123],0
s_mov_b32 s27,s42
ds_write2st64_b64 v20,v[68:69],v[244:245] offset0:36 offset1:16
v_mfma_f32_16x16x32_bf16 v[40:43],a[196:199],a[124:127],v[40:43]
s_mov_b32 s42,s41
v_accvgpr_read_b32 v68,a24
v_accvgpr_read_b32 v69,a25
v_mfma_f32_16x16x32_bf16 v[40:43],a[200:203],a[128:131],v[40:43]
s_add_u32 s69,s69,1
v_cvt_pk_bf16_f32 v76,v76,v77
v_cvt_pk_bf16_f32 v252,v252,v253
v_mfma_f32_16x16x32_bf16 v[40:43],a[204:207],a[132:135],v[40:43]
s_add_u32 s48,s48,325632
v_cvt_pk_bf16_f32 v73,v74,v75
v_cvt_pk_bf16_f32 v249,v250,v251
v_mfma_f32_16x16x32_bf16 v[40:43],a[208:211],a[136:139],v[40:43]
s_lshr_b32 s62,s39,s69
ds_write2st64_b64 v21,v[72:73],v[248:249] offset0:36 offset1:16
v_pk_mul_f32 v[88:89],v[88:89],v[148:149] op_sel_hi:[1,0]
v_pk_mul_f32 v[90:91],v[90:91],v[148:149] op_sel_hi:[1,0]
v_pk_mul_f32 v[92:93],v[92:93],v[148:149] op_sel_hi:[1,0]
v_pk_mul_f32 v[94:95],v[94:95],v[148:149] op_sel_hi:[1,0]
v_cvt_pk_bf16_f32 v77,v78,v79
v_cvt_pk_bf16_f32 v253,v254,v255
v_mfma_f32_16x16x32_bf16 v[40:43],a[212:215],a[140:143],v[40:43]
s_and_b32 s62,s62,1
v_accvgpr_read_b32 v74,a14
v_accvgpr_read_b32 v75,a15
v_mfma_f32_16x16x32_bf16 v[44:47],a[216:219],a[120:123],0
s_lshl_b32 s62,s62,1
v_accvgpr_read_b32 v72,a12
v_accvgpr_read_b32 v73,a13
v_mfma_f32_16x16x32_bf16 v[44:47],a[220:223],a[124:127],v[44:47]
s_add_u32 s62,s62,s49
ds_write2st64_b64 v22,v[76:77],v[252:253] offset0:36 offset1:16
v_mfma_f32_16x16x32_bf16 v[44:47],a[224:227],a[128:131],v[44:47]
s_and_b32 s62,s62,3
v_accvgpr_read_b32 v78,a30
v_accvgpr_read_b32 v79,a31
v_accvgpr_read_b32 v76,a28
v_accvgpr_read_b32 v77,a29
v_cvt_pk_bf16_f32 v80,v80,v81
v_pk_mul_f32 v[64:65],v[64:65],v[148:149] op_sel_hi:[1,0]
v_pk_mul_f32 v[66:67],v[66:67],v[148:149] op_sel_hi:[1,0]
v_pk_mul_f32 v[68:69],v[68:69],v[148:149] op_sel_hi:[1,0]
v_pk_mul_f32 v[70:71],v[70:71],v[148:149] op_sel_hi:[1,0]
v_cvt_pk_bf16_f32 v84,v84,v85
v_cvt_pk_bf16_f32 v81,v82,v83
v_mfma_f32_16x16x32_bf16 v[44:47],a[228:231],a[132:135],v[44:47]
s_waitcnt vmcnt(8)
ds_read_b128 a[168:171],v28 offset:0
s_waitcnt lgkmcnt(2)
buffer_store_dwordx4 v[152:155],v10,s[16:19],s87 offen offset:128 nt
ds_read_b128 a[172:175],v29 offset:0
v_cvt_pk_bf16_f32 v85,v86,v87
v_accvgpr_read_b32 v82,a34
v_mfma_f32_16x16x32_bf16 v[44:47],a[232:235],a[136:139],v[44:47]
s_add_u32 s63,s69,8
ds_read_b128 a[176:179],v28 offset:128
v_accvgpr_read_b32 v83,a35
v_mfma_f32_16x16x32_bf16 v[44:47],a[236:239],a[140:143],v[44:47]
s_lshr_b32 s63,s39,s63
ds_read_b128 a[180:183],v29 offset:128
v_accvgpr_read_b32 v86,a38
v_mfma_f32_16x16x32_bf16 v[48:51],a[192:195],a[144:147],0
s_and_b32 s63,s63,1
ds_read_b128 a[184:187],v28 offset:256
buffer_store_dwordx4 v[156:159],v10,s[16:19],s87 offen offset:3200 nt
ds_read_b128 a[188:191],v29 offset:256
v_accvgpr_read_b32 v87,a39
v_pk_mul_f32 v[72:73],v[72:73],v[148:149] op_sel_hi:[1,0]
v_pk_mul_f32 v[74:75],v[74:75],v[148:149] op_sel_hi:[1,0]
v_pk_mul_f32 v[76:77],v[76:77],v[148:149] op_sel_hi:[1,0]
v_pk_mul_f32 v[78:79],v[78:79],v[148:149] op_sel_hi:[1,0]
v_accvgpr_read_b32 v208,a40
v_accvgpr_read_b32 v209,a41
v_mfma_f32_16x16x32_bf16 v[48:51],a[196:199],a[148:151],v[48:51]
s_xor_b32 s62,s62,s63
ds_read_b128 v[152:155],v15 offset:18432
v_accvgpr_read_b32 v210,a42
v_mfma_f32_16x16x32_bf16 v[48:51],a[200:203],a[152:155],v[48:51]
s_mul_i32 s63,s3,3
ds_read_b128 v[156:159],v15 offset:21504
v_accvgpr_read_b32 v211,a43
v_mfma_f32_16x16x32_bf16 v[48:51],a[204:207],a[156:159],v[48:51]
s_lshl_b32 s64,s3,2
ds_write2st64_b64 v12,v[80:81],v[84:85] offset0:24 offset1:26
v_mfma_f32_16x16x32_bf16 v[48:51],a[208:211],a[160:163],v[48:51]
s_mov_b32 s40,1
v_accvgpr_read_b32 v80,a32
v_accvgpr_read_b32 v81,a33
v_mfma_f32_16x16x32_bf16 v[48:51],a[212:215],a[164:167],v[48:51]
s_add_u32 s65,s63,17
v_accvgpr_read_b32 v84,a36
v_accvgpr_read_b32 v85,a37
v_accvgpr_read_b32 v212,a44
v_accvgpr_read_b32 v213,a45
v_accvgpr_read_b32 v214,a46
v_pk_mul_f32 v[80:81],v[80:81],v[148:149] op_sel_hi:[1,0]
v_pk_mul_f32 v[82:83],v[82:83],v[148:149] op_sel_hi:[1,0]
v_pk_mul_f32 v[192:193],v[192:193],v[144:145] op_sel_hi:[1,0]
v_pk_mul_f32 v[194:195],v[194:195],v[144:145] op_sel_hi:[1,0]
v_accvgpr_read_b32 v215,a47
v_cvt_pk_bf16_f32 v88,v88,v89
v_mfma_f32_16x16x32_bf16 v[52:55],a[216:219],a[144:147],0
s_cmp_eq_u32 s3,0
v_cvt_pk_bf16_f32 v92,v92,v93
v_cvt_pk_bf16_f32 v64,v64,v65
v_mfma_f32_16x16x32_bf16 v[52:55],a[220:223],a[148:151],v[52:55]
s_cselect_b32 s65,16,s65
v_cvt_pk_bf16_f32 v68,v68,v69
v_cvt_pk_bf16_f32 v89,v90,v91
v_mfma_f32_16x16x32_bf16 v[52:55],a[224:227],a[152:155],v[52:55]
s_cselect_b32 s41,1,0
v_cvt_pk_bf16_f32 v93,v94,v95
v_cvt_pk_bf16_f32 v65,v66,v67
v_mfma_f32_16x16x32_bf16 v[52:55],a[228:231],a[156:159],v[52:55]
s_cmp_eq_u32 s62,1
ds_write2st64_b64 v20,v[88:89],v[92:93] offset0:24 offset1:26
v_pk_mul_f32 v[84:85],v[84:85],v[148:149] op_sel_hi:[1,0]
v_pk_mul_f32 v[86:87],v[86:87],v[148:149] op_sel_hi:[1,0]
v_pk_mul_f32 v[196:197],v[196:197],v[144:145] op_sel_hi:[1,0]
v_pk_mul_f32 v[198:199],v[198:199],v[144:145] op_sel_hi:[1,0]
v_cvt_pk_bf16_f32 v69,v70,v71
v_cvt_pk_bf16_f32 v72,v72,v73
v_mfma_f32_16x16x32_bf16 v[52:55],a[232:235],a[160:163],v[52:55]
s_cselect_b32 s64,s65,s64
v_cvt_pk_bf16_f32 v76,v76,v77
v_cvt_pk_bf16_f32 v73,v74,v75
v_mfma_f32_16x16x32_bf16 v[52:55],a[236:239],a[164:167],v[52:55]
s_cselect_b32 s40,s41,s40
v_cvt_pk_bf16_f32 v77,v78,v79
v_cvt_pk_bf16_f32 v80,v80,v81
s_waitcnt lgkmcnt(1)
v_mfma_f32_16x16x32_bf16 v[56:59],a[192:195],a[168:171],0
s_add_u32 s65,s63,29
ds_read_b128 a[192:195],v1 offset:12288
buffer_store_dwordx4 v[152:155],v10,s[16:19],s87 offen offset:256 nt
v_cvt_pk_bf16_f32 v192,v192,v193
v_cvt_pk_bf16_f32 v81,v82,v83
v_cvt_pk_bf16_f32 v193,v194,v195
v_mfma_f32_16x16x32_bf16 v[56:59],a[196:199],a[172:175],v[56:59]
s_cmp_eq_u32 s62,2
ds_read_b128 a[196:199],v2 offset:12288
v_cvt_pk_bf16_f32 v84,v84,v85
v_cvt_pk_bf16_f32 v196,v196,v197
v_cvt_pk_bf16_f32 v85,v86,v87
v_cvt_pk_bf16_f32 v197,v198,v199
v_pk_mul_f32 v[208:209],v[208:209],v[148:149] op_sel_hi:[1,0]
v_pk_mul_f32 v[210:211],v[210:211],v[148:149] op_sel_hi:[1,0]
v_pk_mul_f32 v[200:201],v[200:201],v[144:145] op_sel_hi:[1,0]
v_pk_mul_f32 v[202:203],v[202:203],v[144:145] op_sel_hi:[1,0]
v_max3_f32 v129,v32,v33,v34
v_max3_f32 v133,v40,v41,v42
v_mfma_f32_16x16x32_bf16 v[56:59],a[200:203],a[176:179],v[56:59]
s_cselect_b32 s64,s65,s64
ds_read_b128 a[200:203],v1 offset:12416
buffer_store_dwordx4 v[156:159],v10,s[16:19],s87 offen offset:3328 nt
v_max3_f32 v137,v48,v49,v50
v_max3_f32 v129,v129,v35,v36
v_max3_f32 v133,v133,v43,v44
v_mfma_f32_16x16x32_bf16 v[56:59],a[204:207],a[180:183],v[56:59]
s_cselect_b32 s40,0,s40
ds_read_b128 a[204:207],v2 offset:12416
v_max3_f32 v137,v137,v51,v52
v_mfma_f32_16x16x32_bf16 v[56:59],a[208:211],a[184:187],v[56:59]
s_add_u32 s65,s63,41
ds_read_b128 a[208:211],v1 offset:12544
v_max3_f32 v129,v129,v37,v38
v_mfma_f32_16x16x32_bf16 v[56:59],a[212:215],a[188:191],v[56:59]
s_cmp_eq_u32 s62,3
ds_read_b128 a[212:215],v2 offset:12544
v_max3_f32 v133,v133,v45,v46
v_mfma_f32_16x16x32_bf16 v[60:63],a[216:219],a[168:171],0
s_cselect_b32 s64,s65,s64
ds_read_b128 a[216:219],v1 offset:18432
v_max3_f32 v137,v137,v53,v54
v_max_f32 v129,v129,v39
v_max_f32 v133,v133,v47
v_max3_f32 v141,v56,v57,v58
v_pk_mul_f32 v[212:213],v[212:213],v[148:149] op_sel_hi:[1,0]
v_pk_mul_f32 v[214:215],v[214:215],v[148:149] op_sel_hi:[1,0]
v_pk_mul_f32 v[204:205],v[204:205],v[144:145] op_sel_hi:[1,0]
v_pk_mul_f32 v[206:207],v[206:207],v[144:145] op_sel_hi:[1,0]
v_max_f32 v137,v137,v55
v_mov_b32 v130,v129
v_mfma_f32_16x16x32_bf16 v[60:63],a[220:223],a[172:175],v[60:63]
s_cselect_b32 s40,0,s40
ds_read_b128 a[220:223],v2 offset:18432
v_mov_b32 v134,v133
v_mfma_f32_16x16x32_bf16 v[60:63],a[224:227],a[176:179],v[60:63]
s_mul_i32 s64,s64,6144
ds_read_b128 a[224:227],v1 offset:18560
v_mov_b32 v138,v137
v_mfma_f32_16x16x32_bf16 v[60:63],a[228:231],a[180:183],v[60:63]
s_add_u32 s41,s48,s64
ds_read_b128 a[228:231],v2 offset:18560
v_permlane32_swap_b32 v130,v129
v_mfma_f32_16x16x32_bf16 v[60:63],a[232:235],a[184:187],v[60:63]
s_cmp_ge_u32 s69,8
ds_read_b128 a[232:235],v1 offset:18688
v_permlane32_swap_b32 v134,v133
v_permlane32_swap_b32 v138,v137
v_pk_mul_f32 v[160:161],v[160:161],v[144:145] op_sel_hi:[1,0]
v_pk_mul_f32 v[162:163],v[162:163],v[144:145] op_sel_hi:[1,0]
v_pk_mul_f32 v[176:177],v[176:177],v[144:145] op_sel_hi:[1,0]
v_pk_mul_f32 v[178:179],v[178:179],v[144:145] op_sel_hi:[1,0]
v_max_f32 v129,v129,v130
v_max_f32 v133,v133,v134
v_mfma_f32_16x16x32_bf16 v[60:63],a[236:239],a[188:191],v[60:63]
s_cselect_b32 s41,166723584,s41
ds_read_b128 a[236:239],v2 offset:18688
v_max_f32 v137,v137,v138
v_mov_b32 v130,v129
v_mov_b32 v134,v133
v_mov_b32 v138,v137
v_permlane16_swap_b32 v130,v129
v_permlane16_swap_b32 v134,v133
v_max3_f32 v141,v141,v59,v60
v_max3_f32 v141,v141,v61,v62
v_max_f32 v141,v141,v63
v_mov_b32 v142,v141
v_permlane16_swap_b32 v138,v137
v_max_f32 v129,v129,v130
v_permlane32_swap_b32 v142,v141
v_max_f32 v141,v141,v142
v_mov_b32 v142,v141
v_max_f32 v133,v133,v134
v_max_f32 v137,v137,v138
v_permlane16_swap_b32 v142,v141
v_max_f32 v141,v141,v142
v_mul_f32_e64 v16,-s36,v129
v_mul_f32_e64 v17,-s36,v133
v_mul_f32_e64 v18,-s36,v137
v_mul_f32_e64 v19,-s36,v141
v_fma_f32 v32,v32,s36,v16
v_fma_f32 v33,v33,s36,v16
v_fma_f32 v34,v34,s36,v16
v_fma_f32 v35,v35,s36,v16
v_fma_f32 v36,v36,s36,v16
v_fma_f32 v37,v37,s36,v16
v_fma_f32 v38,v38,s36,v16
v_fma_f32 v39,v39,s36,v16
v_fma_f32 v40,v40,s36,v17
v_fma_f32 v41,v41,s36,v17
v_fma_f32 v42,v42,s36,v17
v_fma_f32 v43,v43,s36,v17
v_fma_f32 v44,v44,s36,v17
v_fma_f32 v45,v45,s36,v17
v_fma_f32 v46,v46,s36,v17
v_fma_f32 v47,v47,s36,v17
v_fma_f32 v48,v48,s36,v18
v_fma_f32 v49,v49,s36,v18
v_fma_f32 v50,v50,s36,v18
v_fma_f32 v51,v51,s36,v18
v_fma_f32 v52,v52,s36,v18
v_fma_f32 v53,v53,s36,v18
v_fma_f32 v54,v54,s36,v18
v_fma_f32 v55,v55,s36,v18
v_fma_f32 v56,v56,s36,v19
v_fma_f32 v57,v57,s36,v19
v_fma_f32 v58,v58,s36,v19
v_fma_f32 v59,v59,s36,v19
v_fma_f32 v60,v60,s36,v19
v_fma_f32 v61,v61,s36,v19
v_fma_f32 v62,v62,s36,v19
v_fma_f32 v63,v63,s36,v19
v_exp_f32 v32,v32
v_exp_f32 v33,v33
v_exp_f32 v34,v34
v_exp_f32 v35,v35
v_exp_f32 v36,v36
v_exp_f32 v37,v37
v_exp_f32 v38,v38
v_exp_f32 v39,v39
v_exp_f32 v40,v40
v_exp_f32 v41,v41
v_exp_f32 v42,v42
v_exp_f32 v43,v43
v_exp_f32 v44,v44
v_exp_f32 v45,v45
v_exp_f32 v46,v46
v_exp_f32 v47,v47
v_exp_f32 v48,v48
v_exp_f32 v49,v49
v_exp_f32 v50,v50
v_exp_f32 v51,v51
v_exp_f32 v52,v52
v_exp_f32 v53,v53
v_exp_f32 v54,v54
v_exp_f32 v55,v55
v_exp_f32 v56,v56
v_exp_f32 v57,v57
v_exp_f32 v58,v58
v_exp_f32 v59,v59
v_exp_f32 v60,v60
v_exp_f32 v61,v61
v_exp_f32 v62,v62
v_exp_f32 v63,v63
v_cvt_pk_bf16_f32 v208,v208,v209
v_cvt_pk_bf16_f32 v200,v200,v201
v_cvt_pk_bf16_f32 v212,v212,v213
v_cvt_pk_bf16_f32 v204,v204,v205
v_cvt_pk_bf16_f32 v96,v32,v33
v_cvt_pk_bf16_f32 v97,v34,v35
v_cvt_pk_bf16_f32 v98,v36,v37
v_cvt_pk_bf16_f32 v99,v38,v39
v_cvt_pk_bf16_f32 v100,v40,v41
v_cvt_pk_bf16_f32 v101,v42,v43
v_mfma_f32_16x16x32_bf16 v[128:131],v[24:27],v[96:99],0
s_mov_b32 s28,s41
ds_write2st64_b64 v21,v[64:65],v[68:69] offset0:24 offset1:26
s_waitcnt lgkmcnt(1)
v_mfma_f32_16x16x32_bf16 v[64:67],a[192:195],a[96:99],0
s_mov_b32 s29,s24
v_cvt_pk_bf16_f32 v102,v44,v45
v_cvt_pk_bf16_f32 v103,v46,v47
v_mfma_f32_16x16x32_bf16 v[64:67],a[196:199],a[100:103],v[64:67]
s_add_u32 s25,s22,12288
v_cvt_pk_bf16_f32 v104,v48,v49
v_cvt_pk_bf16_f32 v105,v50,v51
v_mfma_f32_16x16x32_bf16 v[132:135],v[24:27],v[100:103],0
s_add_u32 s26,s22,24576
v_cvt_pk_bf16_f32 v106,v52,v53
v_cvt_pk_bf16_f32 v107,v54,v55
v_mfma_f32_16x16x32_bf16 v[64:67],a[200:203],a[104:107],v[64:67]
s_add_u32 m0,s23,12288
ds_write2st64_b64 v22,v[72:73],v[76:77] offset0:24 offset1:26
v_mfma_f32_16x16x32_bf16 v[136:139],v[24:27],v[104:107],0
v_cvt_pk_bf16_f32 v108,v56,v57
v_cvt_pk_bf16_f32 v109,v58,v59
v_cvt_pk_bf16_f32 v110,v60,v61
v_cvt_pk_bf16_f32 v111,v62,v63
v_cvt_pk_bf16_f32 v209,v210,v211
v_pk_mul_f32 v[164:165],v[164:165],v[144:145] op_sel_hi:[1,0]
v_pk_mul_f32 v[166:167],v[166:167],v[144:145] op_sel_hi:[1,0]
v_pk_mul_f32 v[180:181],v[180:181],v[144:145] op_sel_hi:[1,0]
v_pk_mul_f32 v[182:183],v[182:183],v[144:145] op_sel_hi:[1,0]
v_cvt_pk_bf16_f32 v201,v202,v203
v_cvt_pk_bf16_f32 v160,v160,v161
v_mfma_f32_16x16x32_bf16 v[140:143],v[24:27],v[108:111],0
buffer_load_dwordx4 v7,s[8:11],s21 offen offset:0 lds
v_mfma_f32_16x16x32_bf16 v[64:67],a[204:207],a[108:111],v[64:67]
buffer_load_dwordx4 v8,s[8:11],s21 offen offset:1024 lds
v_mfma_f32_16x16x32_bf16 v[64:67],a[208:211],a[112:115],v[64:67]
buffer_load_dwordx4 v9,s[8:11],s21 offen offset:2048 lds
v_mfma_f32_16x16x32_bf16 v[64:67],a[212:215],a[116:119],v[64:67]
s_add_u32 s21,s21,12288
ds_write2st64_b64 v12,v[80:81],v[192:193] offset0:28 offset1:4
v_mfma_f32_16x16x32_bf16 v[72:75],a[192:195],a[120:123],0
s_add_u32 m0,s22,0
v_cvt_pk_bf16_f32 v176,v176,v177
v_cvt_pk_bf16_f32 v213,v214,v215
v_mfma_f32_16x16x32_bf16 v[72:75],a[196:199],a[124:127],v[72:75]
buffer_load_dwordx4 v7,s[4:7],s20 offen offset:0 lds
v_cvt_pk_bf16_f32 v205,v206,v207
v_cvt_pk_bf16_f32 v164,v164,v165
v_pk_mul_f32 v[168:169],v[168:169],v[144:145] op_sel_hi:[1,0]
v_pk_mul_f32 v[170:171],v[170:171],v[144:145] op_sel_hi:[1,0]
v_pk_mul_f32 v[184:185],v[184:185],v[144:145] op_sel_hi:[1,0]
v_pk_mul_f32 v[186:187],v[186:187],v[144:145] op_sel_hi:[1,0]
v_cvt_pk_bf16_f32 v180,v180,v181
v_cvt_pk_bf16_f32 v161,v162,v163
v_mfma_f32_16x16x32_bf16 v[72:75],a[200:203],a[128:131],v[72:75]
ds_write2st64_b64 v20,v[84:85],v[196:197] offset0:28 offset1:4
v_mfma_f32_16x16x32_bf16 v[72:75],a[204:207],a[132:135],v[72:75]
v_fma_f32 v64,v64,s36,v16
v_fma_f32 v65,v65,s36,v16
v_mfma_f32_16x16x32_bf16 v[72:75],a[208:211],a[136:139],v[72:75]
v_fma_f32 v66,v66,s36,v16
v_fma_f32 v67,v67,s36,v16
v_mfma_f32_16x16x32_bf16 v[72:75],a[212:215],a[140:143],v[72:75]
v_cvt_pk_bf16_f32 v177,v178,v179
v_cvt_pk_bf16_f32 v165,v166,v167
v_cvt_pk_bf16_f32 v168,v168,v169
v_cvt_pk_bf16_f32 v184,v184,v185
v_cvt_pk_bf16_f32 v181,v182,v183
v_pk_mul_f32 v[172:173],v[172:173],v[144:145] op_sel_hi:[1,0]
v_pk_mul_f32 v[174:175],v[174:175],v[144:145] op_sel_hi:[1,0]
v_pk_mul_f32 v[188:189],v[188:189],v[144:145] op_sel_hi:[1,0]
v_pk_mul_f32 v[190:191],v[190:191],v[144:145] op_sel_hi:[1,0]
v_fma_f32 v72,v72,s36,v17
v_fma_f32 v73,v73,s36,v17
v_mfma_f32_16x16x32_bf16 v[80:83],a[192:195],a[144:147],0
ds_write2st64_b64 v21,v[208:209],v[200:201] offset0:28 offset1:4
v_mfma_f32_16x16x32_bf16 v[80:83],a[196:199],a[148:151],v[80:83]
v_fma_f32 v74,v74,s36,v17
v_fma_f32 v75,v75,s36,v17
v_mfma_f32_16x16x32_bf16 v[80:83],a[200:203],a[152:155],v[80:83]
buffer_load_dwordx4 v8,s[4:7],s20 offen offset:1024 lds
v_mfma_f32_16x16x32_bf16 v[80:83],a[204:207],a[156:159],v[80:83]
v_exp_f32 v64,v64
v_mfma_f32_16x16x32_bf16 v[80:83],a[208:211],a[160:163],v[80:83]
ds_write2st64_b64 v22,v[212:213],v[204:205] offset0:28 offset1:4
v_mfma_f32_16x16x32_bf16 v[80:83],a[212:215],a[164:167],v[80:83]
v_exp_f32 v65,v65
v_mfma_f32_16x16x32_bf16 v[88:91],a[192:195],a[168:171],0
v_exp_f32 v66,v66
v_mfma_f32_16x16x32_bf16 v[88:91],a[196:199],a[172:175],v[88:91]
v_exp_f32 v67,v67
v_mfma_f32_16x16x32_bf16 v[88:91],a[200:203],a[176:179],v[88:91]
ds_write2st64_b64 v12,v[160:161],v[176:177] offset0:0 offset1:2
v_mfma_f32_16x16x32_bf16 v[88:91],a[204:207],a[180:183],v[88:91]
v_exp_f32 v72,v72
v_mfma_f32_16x16x32_bf16 v[88:91],a[208:211],a[184:187],v[88:91]
v_exp_f32 v73,v73
v_mfma_f32_16x16x32_bf16 v[88:91],a[212:215],a[188:191],v[88:91]
v_exp_f32 v74,v74
v_mfma_f32_16x16x32_bf16 v[68:71],a[216:219],a[96:99],0
buffer_load_dwordx4 v9,s[4:7],s20 offen offset:2048 lds
v_mfma_f32_16x16x32_bf16 v[68:71],a[220:223],a[100:103],v[68:71]
s_add_u32 s20,s20,12288
ds_write2st64_b64 v20,v[164:165],v[180:181] offset0:0 offset1:2
v_mfma_f32_16x16x32_bf16 v[68:71],a[224:227],a[104:107],v[68:71]
v_exp_f32 v75,v75
v_mfma_f32_16x16x32_bf16 v[68:71],a[228:231],a[108:111],v[68:71]
v_cvt_pk_bf16_f32 v169,v170,v171
v_cvt_pk_bf16_f32 v185,v186,v187
v_mfma_f32_16x16x32_bf16 v[68:71],a[232:235],a[112:115],v[68:71]
v_cvt_pk_bf16_f32 v172,v172,v173
v_cvt_pk_bf16_f32 v188,v188,v189
v_mfma_f32_16x16x32_bf16 v[68:71],a[236:239],a[116:119],v[68:71]
ds_write2st64_b64 v21,v[168:169],v[184:185] offset0:0 offset1:2
v_mfma_f32_16x16x32_bf16 v[76:79],a[216:219],a[120:123],0
v_cvt_pk_bf16_f32 v173,v174,v175
v_cvt_pk_bf16_f32 v189,v190,v191
v_mfma_f32_16x16x32_bf16 v[76:79],a[220:223],a[124:127],v[76:79]
v_cvt_pk_bf16_f32 v112,v64,v65
v_cvt_pk_bf16_f32 v113,v66,v67
v_mfma_f32_16x16x32_bf16 v[76:79],a[224:227],a[128:131],v[76:79]
v_cvt_pk_bf16_f32 v116,v72,v73
v_cvt_pk_bf16_f32 v117,v74,v75
v_mfma_f32_16x16x32_bf16 v[76:79],a[228:231],a[132:135],v[76:79]
ds_write2st64_b64 v22,v[172:173],v[188:189] offset0:0 offset1:2
v_mfma_f32_16x16x32_bf16 v[76:79],a[232:235],a[136:139],v[76:79]
v_mfma_f32_16x16x32_bf16 v[76:79],a[236:239],a[140:143],v[76:79]
v_mfma_f32_16x16x32_bf16 v[84:87],a[216:219],a[144:147],0
v_mfma_f32_16x16x32_bf16 v[84:87],a[220:223],a[148:151],v[84:87]
v_mfma_f32_16x16x32_bf16 v[84:87],a[224:227],a[152:155],v[84:87]
v_mfma_f32_16x16x32_bf16 v[84:87],a[228:231],a[156:159],v[84:87]
v_mfma_f32_16x16x32_bf16 v[84:87],a[232:235],a[160:163],v[84:87]
v_mfma_f32_16x16x32_bf16 v[84:87],a[236:239],a[164:167],v[84:87]
s_waitcnt vmcnt(10)
s_barrier
v_mfma_f32_16x16x32_bf16 v[92:95],a[216:219],a[168:171],0
ds_read_b64_tr_b16 a[240:241],v3 offset:0
v_mfma_f32_16x16x32_bf16 v[92:95],a[220:223],a[172:175],v[92:95]
ds_read_b64_tr_b16 a[242:243],v3 offset:6144
v_mfma_f32_16x16x32_bf16 v[92:95],a[224:227],a[176:179],v[92:95]
ds_read_b64_tr_b16 a[244:245],v4 offset:0
v_mfma_f32_16x16x32_bf16 v[92:95],a[228:231],a[180:183],v[92:95]
ds_read_b64_tr_b16 a[246:247],v4 offset:6144
v_mfma_f32_16x16x32_bf16 v[92:95],a[232:235],a[184:187],v[92:95]
ds_read_b64_tr_b16 a[248:249],v5 offset:0
v_mfma_f32_16x16x32_bf16 v[92:95],a[236:239],a[188:191],v[92:95]
s_waitcnt lgkmcnt(3)
ds_read_b64_tr_b16 a[250:251],v5 offset:6144
ds_read_b64_tr_b16 a[252:253],v6 offset:0
ds_read_b64_tr_b16 a[254:255],v6 offset:6144
v_mfma_f32_16x16x32_bf16 v[160:163],a[240:243],v[96:99],0
s_add_u32 m0,s23,24576
ds_read_b128 a[192:195],v1 offset:24576
v_fma_f32 v68,v68,s36,v16
v_mfma_f32_16x16x32_bf16 v[208:211],a[240:243],v[100:103],0
buffer_load_dwordx4 v7,s[8:11],s21 offen offset:0 lds
v_mfma_f32_16x16x32_bf16 a[0:3],a[240:243],v[104:107],0
ds_read_b128 a[196:199],v2 offset:24576
v_fma_f32 v69,v69,s36,v16
v_mfma_f32_16x16x32_bf16 a[48:51],a[240:243],v[108:111],0
s_waitcnt lgkmcnt(6)
ds_read_b64_tr_b16 a[240:241],v3 offset:128
ds_read_b64_tr_b16 a[242:243],v3 offset:6272
v_mfma_f32_16x16x32_bf16 v[164:167],a[244:247],v[96:99],0
ds_read_b128 a[200:203],v1 offset:24704
v_fma_f32 v70,v70,s36,v16
v_mfma_f32_16x16x32_bf16 v[212:215],a[244:247],v[100:103],0
ds_read_b128 a[204:207],v2 offset:24704
v_fma_f32 v71,v71,s36,v16
v_mfma_f32_16x16x32_bf16 a[4:7],a[244:247],v[104:107],0
ds_read_b128 a[208:211],v1 offset:24832
v_fma_f32 v76,v76,s36,v17
v_mfma_f32_16x16x32_bf16 a[52:55],a[244:247],v[108:111],0
s_waitcnt lgkmcnt(7)
ds_read_b64_tr_b16 a[244:245],v4 offset:128
ds_read_b64_tr_b16 a[246:247],v4 offset:6272
v_mfma_f32_16x16x32_bf16 v[168:171],a[248:251],v[96:99],0
ds_read_b128 a[212:215],v2 offset:24832
v_fma_f32 v77,v77,s36,v17
v_mfma_f32_16x16x32_bf16 v[216:219],a[248:251],v[100:103],0
buffer_load_dwordx4 v8,s[8:11],s21 offen offset:1024 lds
v_mfma_f32_16x16x32_bf16 a[8:11],a[248:251],v[104:107],0
ds_read_b128 a[216:219],v1 offset:30720
v_fma_f32 v78,v78,s36,v17
v_mfma_f32_16x16x32_bf16 a[56:59],a[248:251],v[108:111],0
ds_read_b64_tr_b16 a[248:249],v5 offset:128
ds_read_b64_tr_b16 a[250:251],v5 offset:6272
v_mfma_f32_16x16x32_bf16 v[172:175],a[252:255],v[96:99],0
ds_read_b128 a[220:223],v2 offset:30720
v_fma_f32 v79,v79,s36,v17
v_mfma_f32_16x16x32_bf16 v[220:223],a[252:255],v[100:103],0
ds_read_b128 a[224:227],v1 offset:30848
v_fma_f32 v80,v80,s36,v18
v_mfma_f32_16x16x32_bf16 a[12:15],a[252:255],v[104:107],0
ds_read_b128 a[228:231],v2 offset:30848
v_fma_f32 v81,v81,s36,v18
v_mfma_f32_16x16x32_bf16 a[60:63],a[252:255],v[108:111],0
s_waitcnt lgkmcnt(7)
ds_read_b64_tr_b16 a[252:253],v6 offset:128
ds_read_b64_tr_b16 a[254:255],v6 offset:6272
v_mfma_f32_16x16x32_bf16 v[176:179],a[240:243],v[96:99],0
ds_read_b128 a[232:235],v1 offset:30976
v_fma_f32 v82,v82,s36,v18
v_mfma_f32_16x16x32_bf16 v[224:227],a[240:243],v[100:103],0
buffer_load_dwordx4 v9,s[8:11],s21 offen offset:2048 lds
v_mfma_f32_16x16x32_bf16 a[16:19],a[240:243],v[104:107],0
s_add_u32 s21,s21,12288
ds_read_b128 a[236:239],v2 offset:30976
v_fma_f32 v83,v83,s36,v18
v_mfma_f32_16x16x32_bf16 a[64:67],a[240:243],v[108:111],0
s_add_u32 m0,s22,12288
ds_read_b64_tr_b16 a[240:241],v3 offset:256
ds_read_b64_tr_b16 a[242:243],v3 offset:6400
v_mfma_f32_16x16x32_bf16 v[180:183],a[244:247],v[96:99],0
v_fma_f32 v84,v84,s36,v18
v_fma_f32 v85,v85,s36,v18
v_mfma_f32_16x16x32_bf16 v[228:231],a[244:247],v[100:103],0
v_fma_f32 v86,v86,s36,v18
v_fma_f32 v87,v87,s36,v18
v_mfma_f32_16x16x32_bf16 a[20:23],a[244:247],v[104:107],0
v_fma_f32 v88,v88,s36,v19
v_fma_f32 v89,v89,s36,v19
v_mfma_f32_16x16x32_bf16 a[68:71],a[244:247],v[108:111],0
s_waitcnt lgkmcnt(4)
ds_read_b64_tr_b16 a[244:245],v4 offset:256
ds_read_b64_tr_b16 a[246:247],v4 offset:6400
v_mfma_f32_16x16x32_bf16 v[184:187],a[248:251],v[96:99],0
buffer_load_dwordx4 v7,s[4:7],s20 offen offset:0 lds
v_mfma_f32_16x16x32_bf16 v[232:235],a[248:251],v[100:103],0
v_fma_f32 v90,v90,s36,v19
v_fma_f32 v91,v91,s36,v19
v_mfma_f32_16x16x32_bf16 a[24:27],a[248:251],v[104:107],0
v_fma_f32 v92,v92,s36,v19
v_fma_f32 v93,v93,s36,v19
v_mfma_f32_16x16x32_bf16 a[72:75],a[248:251],v[108:111],0
ds_read_b64_tr_b16 a[248:249],v5 offset:256
ds_read_b64_tr_b16 a[250:251],v5 offset:6400
v_mfma_f32_16x16x32_bf16 v[188:191],a[252:255],v[96:99],0
v_fma_f32 v94,v94,s36,v19
v_fma_f32 v95,v95,s36,v19
v_mfma_f32_16x16x32_bf16 v[236:239],a[252:255],v[100:103],0
v_exp_f32 v68,v68
v_mfma_f32_16x16x32_bf16 a[28:31],a[252:255],v[104:107],0
v_exp_f32 v69,v69
v_mfma_f32_16x16x32_bf16 a[76:79],a[252:255],v[108:111],0
s_waitcnt lgkmcnt(2)
ds_read_b64_tr_b16 a[252:253],v6 offset:256
ds_read_b64_tr_b16 a[254:255],v6 offset:6400
v_mfma_f32_16x16x32_bf16 v[192:195],a[240:243],v[96:99],0
buffer_load_dwordx4 v8,s[4:7],s20 offen offset:1024 lds
v_mfma_f32_16x16x32_bf16 v[240:243],a[240:243],v[100:103],0
v_exp_f32 v70,v70
v_mfma_f32_16x16x32_bf16 a[32:35],a[240:243],v[104:107],0
v_exp_f32 v71,v71
v_mfma_f32_16x16x32_bf16 a[80:83],a[240:243],v[108:111],0
v_exp_f32 v76,v76
v_mfma_f32_16x16x32_bf16 v[196:199],a[244:247],v[96:99],0
v_exp_f32 v77,v77
v_mfma_f32_16x16x32_bf16 v[244:247],a[244:247],v[100:103],0
v_exp_f32 v78,v78
v_mfma_f32_16x16x32_bf16 a[36:39],a[244:247],v[104:107],0
v_exp_f32 v79,v79
v_mfma_f32_16x16x32_bf16 a[84:87],a[244:247],v[108:111],0
s_waitcnt lgkmcnt(0)
v_exp_f32 v80,v80
v_mfma_f32_16x16x32_bf16 v[200:203],a[248:251],v[96:99],0
buffer_load_dwordx4 v9,s[4:7],s20 offen offset:2048 lds
v_mfma_f32_16x16x32_bf16 v[248:251],a[248:251],v[100:103],0
s_add_u32 s20,s20,12288
v_exp_f32 v81,v81
v_mfma_f32_16x16x32_bf16 a[40:43],a[248:251],v[104:107],0
v_exp_f32 v82,v82
v_mfma_f32_16x16x32_bf16 a[88:91],a[248:251],v[108:111],0
v_exp_f32 v83,v83
v_mfma_f32_16x16x32_bf16 v[204:207],a[252:255],v[96:99],0
v_exp_f32 v84,v84
v_mfma_f32_16x16x32_bf16 v[252:255],a[252:255],v[100:103],0
v_exp_f32 v85,v85
v_mfma_f32_16x16x32_bf16 a[44:47],a[252:255],v[104:107],0
v_exp_f32 v86,v86
v_mfma_f32_16x16x32_bf16 a[92:95],a[252:255],v[108:111],0
v_exp_f32 v87,v87
v_mfma_f32_16x16x32_bf16 v[32:35],a[192:195],a[96:99],0
v_exp_f32 v88,v88
v_mfma_f32_16x16x32_bf16 v[32:35],a[196:199],a[100:103],v[32:35]
v_exp_f32 v89,v89
v_mfma_f32_16x16x32_bf16 v[32:35],a[200:203],a[104:107],v[32:35]
v_exp_f32 v90,v90
v_mfma_f32_16x16x32_bf16 v[32:35],a[204:207],a[108:111],v[32:35]
v_exp_f32 v91,v91
v_mfma_f32_16x16x32_bf16 v[32:35],a[208:211],a[112:115],v[32:35]
v_exp_f32 v92,v92
v_mfma_f32_16x16x32_bf16 v[32:35],a[212:215],a[116:119],v[32:35]
v_exp_f32 v93,v93
v_mfma_f32_16x16x32_bf16 v[40:43],a[192:195],a[120:123],0
v_exp_f32 v94,v94
v_mfma_f32_16x16x32_bf16 v[40:43],a[196:199],a[124:127],v[40:43]
v_exp_f32 v95,v95
v_mfma_f32_16x16x32_bf16 v[40:43],a[200:203],a[128:131],v[40:43]
v_cvt_pk_bf16_f32 v114,v68,v69
v_cvt_pk_bf16_f32 v115,v70,v71
v_mfma_f32_16x16x32_bf16 v[40:43],a[204:207],a[132:135],v[40:43]
v_cvt_pk_bf16_f32 v118,v76,v77
v_cvt_pk_bf16_f32 v119,v78,v79
v_mfma_f32_16x16x32_bf16 v[128:131],v[24:27],v[112:115],v[128:131]
v_cvt_pk_bf16_f32 v120,v80,v81
v_cvt_pk_bf16_f32 v121,v82,v83
v_mfma_f32_16x16x32_bf16 v[132:135],v[24:27],v[116:119],v[132:135]
v_cvt_pk_bf16_f32 v122,v84,v85
v_cvt_pk_bf16_f32 v123,v86,v87
v_mfma_f32_16x16x32_bf16 v[40:43],a[208:211],a[136:139],v[40:43]
v_cvt_pk_bf16_f32 v124,v88,v89
v_cvt_pk_bf16_f32 v125,v90,v91
v_mfma_f32_16x16x32_bf16 v[136:139],v[24:27],v[120:123],v[136:139]
v_cvt_pk_bf16_f32 v126,v92,v93
v_cvt_pk_bf16_f32 v127,v94,v95
v_mfma_f32_16x16x32_bf16 v[40:43],a[212:215],a[140:143],v[40:43]
v_fma_f32 v32,v32,s36,v16
v_fma_f32 v33,v33,s36,v16
v_mfma_f32_16x16x32_bf16 v[140:143],v[24:27],v[124:127],v[140:143]
v_fma_f32 v34,v34,s36,v16
v_fma_f32 v35,v35,s36,v16
v_mfma_f32_16x16x32_bf16 v[48:51],a[192:195],a[144:147],0
v_exp_f32 v32,v32
v_mfma_f32_16x16x32_bf16 v[48:51],a[196:199],a[148:151],v[48:51]
v_fma_f32 v40,v40,s36,v17
v_fma_f32 v41,v41,s36,v17
v_mfma_f32_16x16x32_bf16 v[48:51],a[200:203],a[152:155],v[48:51]
v_fma_f32 v42,v42,s36,v17
v_fma_f32 v43,v43,s36,v17
v_mfma_f32_16x16x32_bf16 v[48:51],a[204:207],a[156:159],v[48:51]
v_exp_f32 v33,v33
v_mfma_f32_16x16x32_bf16 v[48:51],a[208:211],a[160:163],v[48:51]
v_exp_f32 v34,v34
v_mfma_f32_16x16x32_bf16 v[48:51],a[212:215],a[164:167],v[48:51]
v_exp_f32 v35,v35
v_mfma_f32_16x16x32_bf16 v[56:59],a[192:195],a[168:171],0
v_exp_f32 v40,v40
v_mfma_f32_16x16x32_bf16 v[56:59],a[196:199],a[172:175],v[56:59]
v_exp_f32 v41,v41
v_mfma_f32_16x16x32_bf16 v[56:59],a[200:203],a[176:179],v[56:59]
v_exp_f32 v42,v42
v_mfma_f32_16x16x32_bf16 v[56:59],a[204:207],a[180:183],v[56:59]
v_exp_f32 v43,v43
v_mfma_f32_16x16x32_bf16 v[56:59],a[208:211],a[184:187],v[56:59]
v_cvt_pk_bf16_f32 v96,v32,v33
v_cvt_pk_bf16_f32 v97,v34,v35
v_mfma_f32_16x16x32_bf16 v[56:59],a[212:215],a[188:191],v[56:59]
v_cvt_pk_bf16_f32 v100,v40,v41
v_cvt_pk_bf16_f32 v101,v42,v43
v_mfma_f32_16x16x32_bf16 v[36:39],a[216:219],a[96:99],0
v_mfma_f32_16x16x32_bf16 v[36:39],a[220:223],a[100:103],v[36:39]
v_mfma_f32_16x16x32_bf16 v[36:39],a[224:227],a[104:107],v[36:39]
v_mfma_f32_16x16x32_bf16 v[36:39],a[228:231],a[108:111],v[36:39]
v_mfma_f32_16x16x32_bf16 v[36:39],a[232:235],a[112:115],v[36:39]
v_mfma_f32_16x16x32_bf16 v[36:39],a[236:239],a[116:119],v[36:39]
v_mfma_f32_16x16x32_bf16 v[44:47],a[216:219],a[120:123],0
v_mfma_f32_16x16x32_bf16 v[44:47],a[220:223],a[124:127],v[44:47]
v_mfma_f32_16x16x32_bf16 v[44:47],a[224:227],a[128:131],v[44:47]
v_mfma_f32_16x16x32_bf16 v[44:47],a[228:231],a[132:135],v[44:47]
v_mfma_f32_16x16x32_bf16 v[44:47],a[232:235],a[136:139],v[44:47]
s_waitcnt vmcnt(6)
s_barrier
v_mfma_f32_16x16x32_bf16 v[44:47],a[236:239],a[140:143],v[44:47]
ds_read_b64_tr_b16 a[240:241],v3 offset:12288
v_mfma_f32_16x16x32_bf16 v[52:55],a[216:219],a[144:147],0
ds_read_b64_tr_b16 a[242:243],v3 offset:18432
v_mfma_f32_16x16x32_bf16 v[52:55],a[220:223],a[148:151],v[52:55]
ds_read_b64_tr_b16 a[244:245],v4 offset:12288
v_mfma_f32_16x16x32_bf16 v[52:55],a[224:227],a[152:155],v[52:55]
ds_read_b64_tr_b16 a[246:247],v4 offset:18432
v_mfma_f32_16x16x32_bf16 v[52:55],a[228:231],a[156:159],v[52:55]
ds_read_b64_tr_b16 a[248:249],v5 offset:12288
v_mfma_f32_16x16x32_bf16 v[52:55],a[232:235],a[160:163],v[52:55]
ds_read_b64_tr_b16 a[250:251],v5 offset:18432
v_mfma_f32_16x16x32_bf16 v[52:55],a[236:239],a[164:167],v[52:55]
ds_read_b64_tr_b16 a[252:253],v6 offset:12288
v_mfma_f32_16x16x32_bf16 v[60:63],a[216:219],a[168:171],0
ds_read_b64_tr_b16 a[254:255],v6 offset:18432
v_mfma_f32_16x16x32_bf16 v[60:63],a[220:223],a[172:175],v[60:63]
v_mfma_f32_16x16x32_bf16 v[60:63],a[224:227],a[176:179],v[60:63]
v_mfma_f32_16x16x32_bf16 v[60:63],a[228:231],a[180:183],v[60:63]
v_mfma_f32_16x16x32_bf16 v[60:63],a[232:235],a[184:187],v[60:63]
v_mfma_f32_16x16x32_bf16 v[60:63],a[236:239],a[188:191],v[60:63]
s_waitcnt lgkmcnt(4)
v_mfma_f32_16x16x32_bf16 v[160:163],a[240:243],v[112:115],v[160:163]
s_add_u32 m0,s23,0
ds_read_b128 a[192:195],v1 offset:0
v_fma_f32 v36,v36,s36,v16
v_mfma_f32_16x16x32_bf16 v[208:211],a[240:243],v[116:119],v[208:211]
buffer_load_dwordx4 v7,s[8:11],s21 offen offset:0 lds
v_mfma_f32_16x16x32_bf16 a[0:3],a[240:243],v[120:123],a[0:3]
ds_read_b128 a[196:199],v2 offset:0
v_fma_f32 v37,v37,s36,v16
v_mfma_f32_16x16x32_bf16 a[48:51],a[240:243],v[124:127],a[48:51]
ds_read_b64_tr_b16 a[240:241],v3 offset:12416
ds_read_b64_tr_b16 a[242:243],v3 offset:18560
v_mfma_f32_16x16x32_bf16 v[164:167],a[244:247],v[112:115],v[164:167]
ds_read_b128 a[200:203],v1 offset:128
v_fma_f32 v38,v38,s36,v16
v_mfma_f32_16x16x32_bf16 v[212:215],a[244:247],v[116:119],v[212:215]
ds_read_b128 a[204:207],v2 offset:128
v_fma_f32 v39,v39,s36,v16
v_mfma_f32_16x16x32_bf16 a[4:7],a[244:247],v[120:123],a[4:7]
ds_read_b128 a[208:211],v1 offset:256
v_fma_f32 v44,v44,s36,v17
v_mfma_f32_16x16x32_bf16 a[52:55],a[244:247],v[124:127],a[52:55]
s_waitcnt lgkmcnt(7)
ds_read_b64_tr_b16 a[244:245],v4 offset:12416
ds_read_b64_tr_b16 a[246:247],v4 offset:18560
v_mfma_f32_16x16x32_bf16 v[168:171],a[248:251],v[112:115],v[168:171]
ds_read_b128 a[212:215],v2 offset:256
v_fma_f32 v45,v45,s36,v17
v_mfma_f32_16x16x32_bf16 v[216:219],a[248:251],v[116:119],v[216:219]
buffer_load_dwordx4 v8,s[8:11],s21 offen offset:1024 lds
v_mfma_f32_16x16x32_bf16 a[8:11],a[248:251],v[120:123],a[8:11]
ds_read_b128 a[216:219],v1 offset:6144
v_fma_f32 v46,v46,s36,v17
v_mfma_f32_16x16x32_bf16 a[56:59],a[248:251],v[124:127],a[56:59]
ds_read_b64_tr_b16 a[248:249],v5 offset:12416
ds_read_b64_tr_b16 a[250:251],v5 offset:18560
v_mfma_f32_16x16x32_bf16 v[172:175],a[252:255],v[112:115],v[172:175]
ds_read_b128 a[220:223],v2 offset:6144
v_fma_f32 v47,v47,s36,v17
v_mfma_f32_16x16x32_bf16 v[220:223],a[252:255],v[116:119],v[220:223]
ds_read_b128 a[224:227],v1 offset:6272
v_fma_f32 v48,v48,s36,v18
v_mfma_f32_16x16x32_bf16 a[12:15],a[252:255],v[120:123],a[12:15]
ds_read_b128 a[228:231],v2 offset:6272
v_fma_f32 v49,v49,s36,v18
v_mfma_f32_16x16x32_bf16 a[60:63],a[252:255],v[124:127],a[60:63]
s_waitcnt lgkmcnt(7)
ds_read_b64_tr_b16 a[252:253],v6 offset:12416
ds_read_b64_tr_b16 a[254:255],v6 offset:18560
v_mfma_f32_16x16x32_bf16 v[176:179],a[240:243],v[112:115],v[176:179]
ds_read_b128 a[232:235],v1 offset:6400
v_fma_f32 v50,v50,s36,v18
v_mfma_f32_16x16x32_bf16 v[224:227],a[240:243],v[116:119],v[224:227]
buffer_load_dwordx4 v9,s[8:11],s21 offen offset:2048 lds
v_mfma_f32_16x16x32_bf16 a[16:19],a[240:243],v[120:123],a[16:19]
s_add_u32 s21,s21,12288
ds_read_b128 a[236:239],v2 offset:6400
v_fma_f32 v51,v51,s36,v18
v_mfma_f32_16x16x32_bf16 a[64:67],a[240:243],v[124:127],a[64:67]
s_add_u32 m0,s22,24576
ds_read_b64_tr_b16 a[240:241],v3 offset:12544
ds_read_b64_tr_b16 a[242:243],v3 offset:18688
v_mfma_f32_16x16x32_bf16 v[180:183],a[244:247],v[112:115],v[180:183]
v_fma_f32 v52,v52,s36,v18
v_fma_f32 v53,v53,s36,v18
v_mfma_f32_16x16x32_bf16 v[228:231],a[244:247],v[116:119],v[228:231]
v_fma_f32 v54,v54,s36,v18
v_fma_f32 v55,v55,s36,v18
v_mfma_f32_16x16x32_bf16 a[20:23],a[244:247],v[120:123],a[20:23]
v_fma_f32 v56,v56,s36,v19
v_fma_f32 v57,v57,s36,v19
v_mfma_f32_16x16x32_bf16 a[68:71],a[244:247],v[124:127],a[68:71]
s_waitcnt lgkmcnt(4)
ds_read_b64_tr_b16 a[244:245],v4 offset:12544
ds_read_b64_tr_b16 a[246:247],v4 offset:18688
v_mfma_f32_16x16x32_bf16 v[184:187],a[248:251],v[112:115],v[184:187]
buffer_load_dwordx4 v7,s[4:7],s20 offen offset:0 lds
v_mfma_f32_16x16x32_bf16 v[232:235],a[248:251],v[116:119],v[232:235]
v_fma_f32 v58,v58,s36,v19
v_fma_f32 v59,v59,s36,v19
v_mfma_f32_16x16x32_bf16 a[24:27],a[248:251],v[120:123],a[24:27]
v_fma_f32 v60,v60,s36,v19
v_fma_f32 v61,v61,s36,v19
v_mfma_f32_16x16x32_bf16 a[72:75],a[248:251],v[124:127],a[72:75]
ds_read_b64_tr_b16 a[248:249],v5 offset:12544
ds_read_b64_tr_b16 a[250:251],v5 offset:18688
v_mfma_f32_16x16x32_bf16 v[188:191],a[252:255],v[112:115],v[188:191]
v_fma_f32 v62,v62,s36,v19
v_fma_f32 v63,v63,s36,v19
v_mfma_f32_16x16x32_bf16 v[236:239],a[252:255],v[116:119],v[236:239]
v_exp_f32 v36,v36
v_mfma_f32_16x16x32_bf16 a[28:31],a[252:255],v[120:123],a[28:31]
v_exp_f32 v37,v37
v_mfma_f32_16x16x32_bf16 a[76:79],a[252:255],v[124:127],a[76:79]
s_waitcnt lgkmcnt(2)
ds_read_b64_tr_b16 a[252:253],v6 offset:12544
ds_read_b64_tr_b16 a[254:255],v6 offset:18688
v_mfma_f32_16x16x32_bf16 v[192:195],a[240:243],v[112:115],v[192:195]
buffer_load_dwordx4 v8,s[4:7],s20 offen offset:1024 lds
v_mfma_f32_16x16x32_bf16 v[240:243],a[240:243],v[116:119],v[240:243]
v_exp_f32 v38,v38
v_mfma_f32_16x16x32_bf16 a[32:35],a[240:243],v[120:123],a[32:35]
v_exp_f32 v39,v39
v_mfma_f32_16x16x32_bf16 a[80:83],a[240:243],v[124:127],a[80:83]
v_exp_f32 v44,v44
v_mfma_f32_16x16x32_bf16 v[196:199],a[244:247],v[112:115],v[196:199]
v_exp_f32 v45,v45
v_mfma_f32_16x16x32_bf16 v[244:247],a[244:247],v[116:119],v[244:247]
v_exp_f32 v46,v46
v_mfma_f32_16x16x32_bf16 a[36:39],a[244:247],v[120:123],a[36:39]
v_exp_f32 v47,v47
v_mfma_f32_16x16x32_bf16 a[84:87],a[244:247],v[124:127],a[84:87]
s_waitcnt lgkmcnt(0)
v_exp_f32 v48,v48
v_mfma_f32_16x16x32_bf16 v[200:203],a[248:251],v[112:115],v[200:203]
buffer_load_dwordx4 v9,s[4:7],s20 offen offset:2048 lds
v_mfma_f32_16x16x32_bf16 v[248:251],a[248:251],v[116:119],v[248:251]
s_add_u32 s20,s20,12288
v_exp_f32 v49,v49
v_mfma_f32_16x16x32_bf16 a[40:43],a[248:251],v[120:123],a[40:43]
v_exp_f32 v50,v50
v_mfma_f32_16x16x32_bf16 a[88:91],a[248:251],v[124:127],a[88:91]
v_exp_f32 v51,v51
v_mfma_f32_16x16x32_bf16 v[204:207],a[252:255],v[112:115],v[204:207]
v_exp_f32 v52,v52
v_mfma_f32_16x16x32_bf16 v[252:255],a[252:255],v[116:119],v[252:255]
v_exp_f32 v53,v53
v_mfma_f32_16x16x32_bf16 a[44:47],a[252:255],v[120:123],a[44:47]
v_exp_f32 v54,v54
v_mfma_f32_16x16x32_bf16 a[92:95],a[252:255],v[124:127],a[92:95]
v_exp_f32 v55,v55
v_mfma_f32_16x16x32_bf16 v[64:67],a[192:195],a[96:99],0
v_exp_f32 v56,v56
v_mfma_f32_16x16x32_bf16 v[64:67],a[196:199],a[100:103],v[64:67]
v_exp_f32 v57,v57
v_mfma_f32_16x16x32_bf16 v[64:67],a[200:203],a[104:107],v[64:67]
v_exp_f32 v58,v58
v_mfma_f32_16x16x32_bf16 v[64:67],a[204:207],a[108:111],v[64:67]
v_exp_f32 v59,v59
v_mfma_f32_16x16x32_bf16 v[64:67],a[208:211],a[112:115],v[64:67]
v_exp_f32 v60,v60
v_mfma_f32_16x16x32_bf16 v[64:67],a[212:215],a[116:119],v[64:67]
v_exp_f32 v61,v61
v_mfma_f32_16x16x32_bf16 v[72:75],a[192:195],a[120:123],0
v_exp_f32 v62,v62
v_mfma_f32_16x16x32_bf16 v[72:75],a[196:199],a[124:127],v[72:75]
v_exp_f32 v63,v63
v_mfma_f32_16x16x32_bf16 v[72:75],a[200:203],a[128:131],v[72:75]
v_cvt_pk_bf16_f32 v98,v36,v37
v_cvt_pk_bf16_f32 v99,v38,v39
v_mfma_f32_16x16x32_bf16 v[72:75],a[204:207],a[132:135],v[72:75]
v_cvt_pk_bf16_f32 v102,v44,v45
v_cvt_pk_bf16_f32 v103,v46,v47
v_mfma_f32_16x16x32_bf16 v[128:131],v[24:27],v[96:99],v[128:131]
v_cvt_pk_bf16_f32 v104,v48,v49
v_cvt_pk_bf16_f32 v105,v50,v51
v_mfma_f32_16x16x32_bf16 v[132:135],v[24:27],v[100:103],v[132:135]
v_cvt_pk_bf16_f32 v106,v52,v53
v_cvt_pk_bf16_f32 v107,v54,v55
v_mfma_f32_16x16x32_bf16 v[72:75],a[208:211],a[136:139],v[72:75]
v_cvt_pk_bf16_f32 v108,v56,v57
v_cvt_pk_bf16_f32 v109,v58,v59
v_mfma_f32_16x16x32_bf16 v[136:139],v[24:27],v[104:107],v[136:139]
v_cvt_pk_bf16_f32 v110,v60,v61
v_cvt_pk_bf16_f32 v111,v62,v63
v_mfma_f32_16x16x32_bf16 v[72:75],a[212:215],a[140:143],v[72:75]
v_fma_f32 v64,v64,s36,v16
v_fma_f32 v65,v65,s36,v16
v_mfma_f32_16x16x32_bf16 v[140:143],v[24:27],v[108:111],v[140:143]
v_fma_f32 v66,v66,s36,v16
v_fma_f32 v67,v67,s36,v16
v_mfma_f32_16x16x32_bf16 v[80:83],a[192:195],a[144:147],0
v_exp_f32 v64,v64
v_mfma_f32_16x16x32_bf16 v[80:83],a[196:199],a[148:151],v[80:83]
v_fma_f32 v72,v72,s36,v17
v_fma_f32 v73,v73,s36,v17
v_mfma_f32_16x16x32_bf16 v[80:83],a[200:203],a[152:155],v[80:83]
v_fma_f32 v74,v74,s36,v17
v_fma_f32 v75,v75,s36,v17
v_mfma_f32_16x16x32_bf16 v[80:83],a[204:207],a[156:159],v[80:83]
v_exp_f32 v65,v65
v_mfma_f32_16x16x32_bf16 v[80:83],a[208:211],a[160:163],v[80:83]
v_exp_f32 v66,v66
v_mfma_f32_16x16x32_bf16 v[80:83],a[212:215],a[164:167],v[80:83]
v_exp_f32 v67,v67
v_mfma_f32_16x16x32_bf16 v[88:91],a[192:195],a[168:171],0
v_exp_f32 v72,v72
v_mfma_f32_16x16x32_bf16 v[88:91],a[196:199],a[172:175],v[88:91]
v_exp_f32 v73,v73
v_mfma_f32_16x16x32_bf16 v[88:91],a[200:203],a[176:179],v[88:91]
v_exp_f32 v74,v74
v_mfma_f32_16x16x32_bf16 v[88:91],a[204:207],a[180:183],v[88:91]
v_exp_f32 v75,v75
v_mfma_f32_16x16x32_bf16 v[88:91],a[208:211],a[184:187],v[88:91]
v_cvt_pk_bf16_f32 v112,v64,v65
v_cvt_pk_bf16_f32 v113,v66,v67
v_mfma_f32_16x16x32_bf16 v[88:91],a[212:215],a[188:191],v[88:91]
v_cvt_pk_bf16_f32 v116,v72,v73
v_cvt_pk_bf16_f32 v117,v74,v75
v_mfma_f32_16x16x32_bf16 v[68:71],a[216:219],a[96:99],0
v_mfma_f32_16x16x32_bf16 v[68:71],a[220:223],a[100:103],v[68:71]
v_mfma_f32_16x16x32_bf16 v[68:71],a[224:227],a[104:107],v[68:71]
v_mfma_f32_16x16x32_bf16 v[68:71],a[228:231],a[108:111],v[68:71]
v_mfma_f32_16x16x32_bf16 v[68:71],a[232:235],a[112:115],v[68:71]
v_mfma_f32_16x16x32_bf16 v[68:71],a[236:239],a[116:119],v[68:71]
v_mfma_f32_16x16x32_bf16 v[76:79],a[216:219],a[120:123],0
v_mfma_f32_16x16x32_bf16 v[76:79],a[220:223],a[124:127],v[76:79]
v_mfma_f32_16x16x32_bf16 v[76:79],a[224:227],a[128:131],v[76:79]
v_mfma_f32_16x16x32_bf16 v[76:79],a[228:231],a[132:135],v[76:79]
v_mfma_f32_16x16x32_bf16 v[76:79],a[232:235],a[136:139],v[76:79]
s_waitcnt vmcnt(6)
s_barrier
v_mfma_f32_16x16x32_bf16 v[76:79],a[236:239],a[140:143],v[76:79]
ds_read_b64_tr_b16 a[240:241],v3 offset:24576
v_mfma_f32_16x16x32_bf16 v[84:87],a[216:219],a[144:147],0
ds_read_b64_tr_b16 a[242:243],v3 offset:30720
v_mfma_f32_16x16x32_bf16 v[84:87],a[220:223],a[148:151],v[84:87]
ds_read_b64_tr_b16 a[244:245],v4 offset:24576
v_mfma_f32_16x16x32_bf16 v[84:87],a[224:227],a[152:155],v[84:87]
ds_read_b64_tr_b16 a[246:247],v4 offset:30720
v_mfma_f32_16x16x32_bf16 v[84:87],a[228:231],a[156:159],v[84:87]
ds_read_b64_tr_b16 a[248:249],v5 offset:24576
v_mfma_f32_16x16x32_bf16 v[84:87],a[232:235],a[160:163],v[84:87]
ds_read_b64_tr_b16 a[250:251],v5 offset:30720
v_mfma_f32_16x16x32_bf16 v[84:87],a[236:239],a[164:167],v[84:87]
ds_read_b64_tr_b16 a[252:253],v6 offset:24576
v_mfma_f32_16x16x32_bf16 v[92:95],a[216:219],a[168:171],0
ds_read_b64_tr_b16 a[254:255],v6 offset:30720
v_mfma_f32_16x16x32_bf16 v[92:95],a[220:223],a[172:175],v[92:95]
v_mfma_f32_16x16x32_bf16 v[92:95],a[224:227],a[176:179],v[92:95]
v_mfma_f32_16x16x32_bf16 v[92:95],a[228:231],a[180:183],v[92:95]
v_mfma_f32_16x16x32_bf16 v[92:95],a[232:235],a[184:187],v[92:95]
v_mfma_f32_16x16x32_bf16 v[92:95],a[236:239],a[188:191],v[92:95]
s_mov_b32 s38,0
s_branch L_loop4
L_loop3:
s_bitcmp1_b32 s3,1
s_cbranch_scc1 L_loop3w1
.p2align 6
L_loop3w0:
s_waitcnt lgkmcnt(4)
v_mfma_f32_16x16x32_bf16 v[160:163],a[240:243],v[96:99],v[160:163]
s_add_u32 m0,s23,12288
ds_read_b128 a[192:195],v1 offset:12288
v_fma_f32 v86,v86,s36,v18
v_mfma_f32_16x16x32_bf16 v[208:211],a[240:243],v[100:103],v[208:211]
buffer_load_dwordx4 v7,s[8:11],s21 offen offset:0 lds
v_mfma_f32_16x16x32_bf16 a[0:3],a[240:243],v[104:107],a[0:3]
ds_read_b64_tr_b16 a[242:243],v3 offset:30848
ds_read_b64_tr_b16 a[240:241],v3 offset:24704
v_mfma_f32_16x16x32_bf16 v[164:167],a[244:247],v[96:99],v[164:167]
ds_read_b128 a[196:199],v2 offset:12288
v_fma_f32 v69,v69,s36,v16
v_mfma_f32_16x16x32_bf16 v[212:215],a[244:247],v[100:103],v[212:215]
ds_read_b128 a[200:203],v1 offset:12416
v_fma_f32 v87,v87,s36,v18
v_mfma_f32_16x16x32_bf16 a[4:7],a[244:247],v[104:107],a[4:7]
s_waitcnt lgkmcnt(5)
ds_read_b64_tr_b16 a[244:245],v4 offset:24704
ds_read_b64_tr_b16 a[246:247],v4 offset:30848
v_mfma_f32_16x16x32_bf16 v[168:171],a[248:251],v[96:99],v[168:171]
ds_read_b128 a[212:215],v2 offset:12544
v_fma_f32 v76,v76,s36,v17
v_mfma_f32_16x16x32_bf16 v[216:219],a[248:251],v[100:103],v[216:219]
buffer_load_dwordx4 v8,s[8:11],s21 offen offset:1024 lds
v_mfma_f32_16x16x32_bf16 a[8:11],a[248:251],v[104:107],a[8:11]
ds_read_b64_tr_b16 a[248:249],v5 offset:24704
ds_read_b64_tr_b16 a[250:251],v5 offset:30848
v_mfma_f32_16x16x32_bf16 v[172:175],a[252:255],v[96:99],v[172:175]
ds_read_b128 a[204:207],v2 offset:12416
v_fma_f32 v68,v68,s36,v16
v_mfma_f32_16x16x32_bf16 v[220:223],a[252:255],v[100:103],v[220:223]
ds_read_b128 a[208:211],v1 offset:12544
v_fma_f32 v71,v71,s36,v16
v_mfma_f32_16x16x32_bf16 a[12:15],a[252:255],v[104:107],a[12:15]
s_waitcnt lgkmcnt(8)
ds_read_b64_tr_b16 a[254:255],v6 offset:30848
ds_read_b64_tr_b16 a[252:253],v6 offset:24704
v_mfma_f32_16x16x32_bf16 v[176:179],a[240:243],v[96:99],v[176:179]
buffer_load_dwordx4 v9,s[8:11],s21 offen offset:2048 lds
v_mfma_f32_16x16x32_bf16 v[224:227],a[240:243],v[100:103],v[224:227]
s_add_u32 s21,s21,12288
ds_read_b128 a[220:223],v2 offset:18432
v_fma_f32 v70,v70,s36,v16
v_mfma_f32_16x16x32_bf16 a[16:19],a[240:243],v[104:107],a[16:19]
s_add_u32 m0,s22,0
ds_read_b64_tr_b16 a[240:241],v3 offset:24832
ds_read_b64_tr_b16 a[242:243],v3 offset:30976
s_waitcnt lgkmcnt(9)
v_mfma_f32_16x16x32_bf16 v[180:183],a[244:247],v[96:99],v[180:183]
ds_read_b128 a[216:219],v1 offset:18432
v_fma_f32 v79,v79,s36,v17
v_mfma_f32_16x16x32_bf16 v[228:231],a[244:247],v[100:103],v[228:231]
ds_read_b128 a[224:227],v1 offset:18560
v_fma_f32 v78,v78,s36,v17
v_mfma_f32_16x16x32_bf16 a[20:23],a[244:247],v[104:107],a[20:23]
s_waitcnt lgkmcnt(8)
ds_read_b64_tr_b16 a[246:247],v4 offset:30976
ds_read_b64_tr_b16 a[244:245],v4 offset:24832
v_mfma_f32_16x16x32_bf16 v[184:187],a[248:251],v[96:99],v[184:187]
buffer_load_dwordx4 v7,s[4:7],s20 offen offset:0 lds
v_mfma_f32_16x16x32_bf16 v[232:235],a[248:251],v[100:103],v[232:235]
ds_read_b128 a[228:231],v2 offset:18560
v_fma_f32 v85,v85,s36,v18
v_mfma_f32_16x16x32_bf16 a[24:27],a[248:251],v[104:107],a[24:27]
s_waitcnt lgkmcnt(8)
ds_read_b64_tr_b16 a[248:249],v5 offset:24832
ds_read_b64_tr_b16 a[250:251],v5 offset:30976
v_mfma_f32_16x16x32_bf16 v[188:191],a[252:255],v[96:99],v[188:191]
ds_read_b128 a[232:235],v1 offset:18688
v_fma_f32 v82,v82,s36,v18
v_mfma_f32_16x16x32_bf16 v[236:239],a[252:255],v[100:103],v[236:239]
ds_read_b128 a[236:239],v2 offset:18688
v_fma_f32 v83,v83,s36,v18
v_mfma_f32_16x16x32_bf16 a[28:31],a[252:255],v[104:107],a[28:31]
s_waitcnt lgkmcnt(8)
ds_read_b64_tr_b16 a[254:255],v6 offset:30976
ds_read_b64_tr_b16 a[252:253],v6 offset:24832
v_mfma_f32_16x16x32_bf16 v[192:195],a[240:243],v[96:99],v[192:195]
buffer_load_dwordx4 v8,s[4:7],s20 offen offset:1024 lds
v_mfma_f32_16x16x32_bf16 v[240:243],a[240:243],v[100:103],v[240:243]
ds_read_b128 v[152:155],v11 offset:0
v_fma_f32 v81,v81,s36,v18
v_mfma_f32_16x16x32_bf16 a[32:35],a[240:243],v[104:107],a[32:35]
s_waitcnt lgkmcnt(8)
v_fma_f32 v84,v84,s36,v18
v_fma_f32 v77,v77,s36,v17
v_mfma_f32_16x16x32_bf16 v[196:199],a[244:247],v[96:99],v[196:199]
v_exp_f32 v86,v86
v_mfma_f32_16x16x32_bf16 v[244:247],a[244:247],v[100:103],v[244:247]
v_fma_f32 v80,v80,s36,v18
v_mfma_f32_16x16x32_bf16 a[36:39],a[244:247],v[104:107],a[36:39]
s_waitcnt lgkmcnt(4)
v_exp_f32 v80,v80
v_mfma_f32_16x16x32_bf16 v[200:203],a[248:251],v[96:99],v[200:203]
buffer_load_dwordx4 v9,s[4:7],s20 offen offset:2048 lds
v_mfma_f32_16x16x32_bf16 v[248:251],a[248:251],v[100:103],v[248:251]
s_add_u32 s20,s20,12288
v_exp_f32 v84,v84
v_mfma_f32_16x16x32_bf16 a[40:43],a[248:251],v[104:107],a[40:43]
s_waitcnt lgkmcnt(1)
ds_read_b128 v[156:159],v23 offset:0
v_mfma_f32_16x16x32_bf16 v[204:207],a[252:255],v[96:99],v[204:207]
v_exp_f32 v82,v82
v_mfma_f32_16x16x32_bf16 v[252:255],a[252:255],v[100:103],v[252:255]
v_exp_f32 v78,v78
v_mfma_f32_16x16x32_bf16 a[44:47],a[252:255],v[104:107],a[44:47]
v_exp_f32 v68,v68
v_mfma_f32_16x16x32_bf16 v[32:35],a[192:195],a[96:99],0
v_exp_f32 v85,v85
v_mfma_f32_16x16x32_bf16 v[32:35],a[196:199],a[100:103],v[32:35]
v_cvt_pk_bf16_f32 v122,v84,v85
v_mfma_f32_16x16x32_bf16 v[32:35],a[200:203],a[104:107],v[32:35]
v_exp_f32 v81,v81
v_mfma_f32_16x16x32_bf16 v[32:35],a[204:207],a[108:111],v[32:35]
s_waitcnt lgkmcnt(1)
buffer_store_dwordx4 v[152:155],v0,s[16:19],s27 offen offset:0 nt
v_cvt_pk_bf16_f32 v120,v80,v81
v_exp_f32 v76,v76
v_mfma_f32_16x16x32_bf16 v[32:35],a[208:211],a[112:115],v[32:35]
ds_read_b128 v[152:155],v31 offset:0
v_mfma_f32_16x16x32_bf16 v[32:35],a[212:215],a[116:119],v[32:35]
v_exp_f32 v71,v71
v_mfma_f32_16x16x32_bf16 v[40:43],a[192:195],a[120:123],0
v_exp_f32 v79,v79
v_mfma_f32_16x16x32_bf16 v[40:43],a[196:199],a[124:127],v[40:43]
v_cvt_pk_bf16_f32 v119,v78,v79
v_mfma_f32_16x16x32_bf16 v[40:43],a[200:203],a[128:131],v[40:43]
v_exp_f32 v70,v70
v_mfma_f32_16x16x32_bf16 v[40:43],a[204:207],a[132:135],v[40:43]
v_fma_f32 v32,v32,s36,v16
v_cvt_pk_bf16_f32 v115,v70,v71
v_mfma_f32_16x16x32_bf16 v[40:43],a[208:211],a[136:139],v[40:43]
v_fma_f32 v34,v34,s36,v16
v_fma_f32 v33,v33,s36,v16
v_mfma_f32_16x16x32_bf16 v[40:43],a[212:215],a[140:143],v[40:43]
s_waitcnt lgkmcnt(1)
buffer_store_dwordx4 v[156:159],v0,s[16:19],s27 offen offset:1024 nt
v_fma_f32 v35,v35,s36,v16
v_exp_f32 v35,v35
v_mfma_f32_16x16x32_bf16 v[48:51],a[192:195],a[144:147],0
v_exp_f32 v34,v34
v_mfma_f32_16x16x32_bf16 v[48:51],a[196:199],a[148:151],v[48:51]
v_cvt_pk_bf16_f32 v97,v34,v35
v_mfma_f32_16x16x32_bf16 v[48:51],a[200:203],a[152:155],v[48:51]
v_fma_f32 v41,v41,s36,v17
v_fma_f32 v40,v40,s36,v17
v_mfma_f32_16x16x32_bf16 v[48:51],a[204:207],a[156:159],v[48:51]
v_fma_f32 v42,v42,s36,v17
v_fma_f32 v43,v43,s36,v17
v_mfma_f32_16x16x32_bf16 v[48:51],a[208:211],a[160:163],v[48:51]
v_exp_f32 v41,v41
v_mfma_f32_16x16x32_bf16 v[48:51],a[212:215],a[164:167],v[48:51]
v_exp_f32 v77,v77
v_mfma_f32_16x16x32_bf16 v[36:39],a[216:219],a[96:99],0
v_cvt_pk_bf16_f32 v118,v76,v77
v_mfma_f32_16x16x32_bf16 v[36:39],a[220:223],a[100:103],v[36:39]
s_waitcnt lgkmcnt(0)
buffer_store_dwordx4 v[152:155],v0,s[16:19],s27 offen offset:2048 nt
v_exp_f32 v69,v69
v_mfma_f32_16x16x32_bf16 v[36:39],a[224:227],a[104:107],v[36:39]
s_add_u32 s27,s27,3072
v_cvt_pk_bf16_f32 v114,v68,v69
v_mfma_f32_16x16x32_bf16 v[132:135],v[24:27],v[116:119],v[132:135]
v_exp_f32 v87,v87
v_mfma_f32_16x16x32_bf16 v[128:131],v[24:27],v[112:115],v[128:131]
v_cvt_pk_bf16_f32 v123,v86,v87
s_waitcnt vmcnt(9)
v_mfma_f32_16x16x32_bf16 v[36:39],a[228:231],a[108:111],v[36:39]
s_barrier
v_mfma_f32_16x16x32_bf16 v[36:39],a[232:235],a[112:115],v[36:39]
ds_read_b64_tr_b16 a[240:241],v3 offset:0
ds_read_b64_tr_b16 a[242:243],v3 offset:6144
v_mfma_f32_16x16x32_bf16 v[36:39],a[236:239],a[116:119],v[36:39]
v_exp_f32 v83,v83
v_mfma_f32_16x16x32_bf16 v[44:47],a[216:219],a[120:123],0
ds_read_b64_tr_b16 a[244:245],v4 offset:0
ds_read_b64_tr_b16 a[246:247],v4 offset:6144
v_mfma_f32_16x16x32_bf16 v[44:47],a[220:223],a[124:127],v[44:47]
ds_read_b64_tr_b16 a[250:251],v5 offset:6144
ds_read_b64_tr_b16 a[248:249],v5 offset:0
v_mfma_f32_16x16x32_bf16 v[44:47],a[224:227],a[128:131],v[44:47]
v_cvt_pk_bf16_f32 v121,v82,v83
v_mfma_f32_16x16x32_bf16 v[44:47],a[228:231],a[132:135],v[44:47]
ds_read_b64_tr_b16 a[252:253],v6 offset:0
ds_read_b64_tr_b16 a[254:255],v6 offset:6144
v_mfma_f32_16x16x32_bf16 v[136:139],v[24:27],v[120:123],v[136:139]
v_exp_f32 v32,v32
v_mfma_f32_16x16x32_bf16 v[44:47],a[232:235],a[136:139],v[44:47]
v_exp_f32 v43,v43
v_mfma_f32_16x16x32_bf16 v[44:47],a[236:239],a[140:143],v[44:47]
v_exp_f32 v42,v42
v_mfma_f32_16x16x32_bf16 v[52:55],a[216:219],a[144:147],0
v_cvt_pk_bf16_f32 v101,v42,v43
v_mfma_f32_16x16x32_bf16 v[52:55],a[220:223],a[148:151],v[52:55]
v_exp_f32 v40,v40
v_mfma_f32_16x16x32_bf16 v[52:55],a[224:227],a[152:155],v[52:55]
v_cvt_pk_bf16_f32 v100,v40,v41
v_mfma_f32_16x16x32_bf16 v[52:55],a[228:231],a[156:159],v[52:55]
v_exp_f32 v33,v33
v_mfma_f32_16x16x32_bf16 v[52:55],a[232:235],a[160:163],v[52:55]
v_cvt_pk_bf16_f32 v96,v32,v33
v_mfma_f32_16x16x32_bf16 v[52:55],a[236:239],a[164:167],v[52:55]
s_waitcnt lgkmcnt(0)
v_mfma_f32_16x16x32_bf16 v[160:163],a[240:243],v[112:115],v[160:163]
s_add_u32 m0,s23,24576
ds_read_b128 a[192:195],v1 offset:24576
v_fma_f32 v36,v36,s36,v16
v_mfma_f32_16x16x32_bf16 v[208:211],a[240:243],v[116:119],v[208:211]
buffer_load_dwordx4 v7,s[8:11],s21 offen offset:0 lds
v_mfma_f32_16x16x32_bf16 a[0:3],a[240:243],v[120:123],a[0:3]
ds_read_b64_tr_b16 a[240:241],v3 offset:128
ds_read_b64_tr_b16 a[242:243],v3 offset:6272
v_mfma_f32_16x16x32_bf16 v[164:167],a[244:247],v[112:115],v[164:167]
ds_read_b128 a[196:199],v2 offset:24576
v_fma_f32 v37,v37,s36,v16
v_mfma_f32_16x16x32_bf16 v[212:215],a[244:247],v[116:119],v[212:215]
ds_read_b128 a[200:203],v1 offset:24704
v_fma_f32 v38,v38,s36,v16
v_mfma_f32_16x16x32_bf16 a[4:7],a[244:247],v[120:123],a[4:7]
ds_read_b64_tr_b16 a[244:245],v4 offset:128
ds_read_b64_tr_b16 a[246:247],v4 offset:6272
v_mfma_f32_16x16x32_bf16 v[168:171],a[248:251],v[112:115],v[168:171]
ds_read_b128 a[204:207],v2 offset:24704
v_fma_f32 v39,v39,s36,v16
v_mfma_f32_16x16x32_bf16 v[216:219],a[248:251],v[116:119],v[216:219]
buffer_load_dwordx4 v8,s[8:11],s21 offen offset:1024 lds
v_mfma_f32_16x16x32_bf16 a[8:11],a[248:251],v[120:123],a[8:11]
ds_read_b64_tr_b16 a[248:249],v5 offset:128
ds_read_b64_tr_b16 a[250:251],v5 offset:6272
v_mfma_f32_16x16x32_bf16 v[172:175],a[252:255],v[112:115],v[172:175]
ds_read_b128 a[208:211],v1 offset:24832
v_fma_f32 v44,v44,s36,v17
v_mfma_f32_16x16x32_bf16 v[220:223],a[252:255],v[116:119],v[220:223]
ds_read_b128 a[212:215],v2 offset:24832
v_fma_f32 v45,v45,s36,v17
v_mfma_f32_16x16x32_bf16 a[12:15],a[252:255],v[120:123],a[12:15]
s_waitcnt lgkmcnt(8)
ds_read_b64_tr_b16 a[252:253],v6 offset:128
ds_read_b64_tr_b16 a[254:255],v6 offset:6272
v_mfma_f32_16x16x32_bf16 v[176:179],a[240:243],v[112:115],v[176:179]
buffer_load_dwordx4 v9,s[8:11],s21 offen offset:2048 lds
v_mfma_f32_16x16x32_bf16 v[224:227],a[240:243],v[116:119],v[224:227]
s_add_u32 s21,s21,12288
ds_read_b128 a[216:219],v1 offset:30720
v_fma_f32 v46,v46,s36,v17
v_mfma_f32_16x16x32_bf16 a[16:19],a[240:243],v[120:123],a[16:19]
s_add_u32 m0,s22,12288
ds_read_b64_tr_b16 a[240:241],v3 offset:256
ds_read_b64_tr_b16 a[242:243],v3 offset:6400
s_waitcnt lgkmcnt(9)
v_mfma_f32_16x16x32_bf16 v[180:183],a[244:247],v[112:115],v[180:183]
ds_read_b128 a[220:223],v2 offset:30720
v_fma_f32 v47,v47,s36,v17
v_mfma_f32_16x16x32_bf16 v[228:231],a[244:247],v[116:119],v[228:231]
ds_read_b128 a[224:227],v1 offset:30848
v_fma_f32 v48,v48,s36,v18
v_mfma_f32_16x16x32_bf16 a[20:23],a[244:247],v[120:123],a[20:23]
s_waitcnt lgkmcnt(8)
ds_read_b64_tr_b16 a[244:245],v4 offset:256
ds_read_b64_tr_b16 a[246:247],v4 offset:6400
v_mfma_f32_16x16x32_bf16 v[184:187],a[248:251],v[112:115],v[184:187]
buffer_load_dwordx4 v7,s[4:7],s20 offen offset:0 lds
v_mfma_f32_16x16x32_bf16 v[232:235],a[248:251],v[116:119],v[232:235]
ds_read_b128 a[228:231],v2 offset:30848
v_fma_f32 v49,v49,s36,v18
v_mfma_f32_16x16x32_bf16 a[24:27],a[248:251],v[120:123],a[24:27]
s_waitcnt lgkmcnt(8)
ds_read_b64_tr_b16 a[248:249],v5 offset:256
ds_read_b64_tr_b16 a[250:251],v5 offset:6400
v_mfma_f32_16x16x32_bf16 v[188:191],a[252:255],v[112:115],v[188:191]
ds_read_b128 a[232:235],v1 offset:30976
v_fma_f32 v50,v50,s36,v18
v_mfma_f32_16x16x32_bf16 v[236:239],a[252:255],v[116:119],v[236:239]
ds_read_b128 a[236:239],v2 offset:30976
v_fma_f32 v51,v51,s36,v18
v_mfma_f32_16x16x32_bf16 a[28:31],a[252:255],v[120:123],a[28:31]
s_waitcnt lgkmcnt(8)
ds_read_b64_tr_b16 a[252:253],v6 offset:256
ds_read_b64_tr_b16 a[254:255],v6 offset:6400
v_mfma_f32_16x16x32_bf16 v[192:195],a[240:243],v[112:115],v[192:195]
buffer_load_dwordx4 v8,s[4:7],s20 offen offset:1024 lds
v_mfma_f32_16x16x32_bf16 v[240:243],a[240:243],v[116:119],v[240:243]
v_fma_f32 v52,v52,s36,v18
v_fma_f32 v53,v53,s36,v18
v_mfma_f32_16x16x32_bf16 a[32:35],a[240:243],v[120:123],a[32:35]
s_waitcnt lgkmcnt(7)
v_fma_f32 v54,v54,s36,v18
v_fma_f32 v55,v55,s36,v18
v_mfma_f32_16x16x32_bf16 v[196:199],a[244:247],v[112:115],v[196:199]
v_exp_f32 v36,v36
v_mfma_f32_16x16x32_bf16 v[244:247],a[244:247],v[116:119],v[244:247]
v_exp_f32 v37,v37
v_mfma_f32_16x16x32_bf16 a[36:39],a[244:247],v[120:123],a[36:39]
s_waitcnt lgkmcnt(3)
v_exp_f32 v38,v38
v_mfma_f32_16x16x32_bf16 v[200:203],a[248:251],v[112:115],v[200:203]
buffer_load_dwordx4 v9,s[4:7],s20 offen offset:2048 lds
v_mfma_f32_16x16x32_bf16 v[248:251],a[248:251],v[116:119],v[248:251]
s_add_u32 s20,s20,12288
v_exp_f32 v39,v39
v_mfma_f32_16x16x32_bf16 a[40:43],a[248:251],v[120:123],a[40:43]
s_add_u32 m0,s29,0
v_exp_f32 v44,v44
s_waitcnt lgkmcnt(0)
v_mfma_f32_16x16x32_bf16 v[204:207],a[252:255],v[112:115],v[204:207]
v_exp_f32 v45,v45
v_mfma_f32_16x16x32_bf16 v[252:255],a[252:255],v[116:119],v[252:255]
v_exp_f32 v46,v46
v_mfma_f32_16x16x32_bf16 a[44:47],a[252:255],v[120:123],a[44:47]
v_exp_f32 v47,v47
v_mfma_f32_16x16x32_bf16 v[64:67],a[192:195],a[96:99],0
v_exp_f32 v48,v48
v_mfma_f32_16x16x32_bf16 v[64:67],a[196:199],a[100:103],v[64:67]
v_exp_f32 v49,v49
v_mfma_f32_16x16x32_bf16 v[64:67],a[200:203],a[104:107],v[64:67]
v_exp_f32 v50,v50
v_mfma_f32_16x16x32_bf16 v[64:67],a[204:207],a[108:111],v[64:67]
buffer_load_dwordx4 v7,s[12:15],s28 offen offset:0 nt lds
v_mfma_f32_16x16x32_bf16 v[64:67],a[208:211],a[112:115],v[64:67]
v_exp_f32 v51,v51
v_mfma_f32_16x16x32_bf16 v[64:67],a[212:215],a[116:119],v[64:67]
v_exp_f32 v52,v52
v_mfma_f32_16x16x32_bf16 v[72:75],a[192:195],a[120:123],0
v_exp_f32 v53,v53
v_mfma_f32_16x16x32_bf16 v[72:75],a[196:199],a[124:127],v[72:75]
v_exp_f32 v54,v54
v_mfma_f32_16x16x32_bf16 v[72:75],a[200:203],a[128:131],v[72:75]
v_exp_f32 v55,v55
v_mfma_f32_16x16x32_bf16 v[72:75],a[204:207],a[132:135],v[72:75]
v_cvt_pk_bf16_f32 v98,v36,v37
v_cvt_pk_bf16_f32 v99,v38,v39
v_mfma_f32_16x16x32_bf16 v[72:75],a[208:211],a[136:139],v[72:75]
v_cvt_pk_bf16_f32 v102,v44,v45
v_cvt_pk_bf16_f32 v103,v46,v47
v_mfma_f32_16x16x32_bf16 v[128:131],v[24:27],v[96:99],v[128:131]
v_cvt_pk_bf16_f32 v104,v48,v49
v_cvt_pk_bf16_f32 v105,v50,v51
v_mfma_f32_16x16x32_bf16 v[132:135],v[24:27],v[100:103],v[132:135]
buffer_load_dwordx4 v8,s[12:15],s28 offen offset:1024 nt lds
v_mfma_f32_16x16x32_bf16 v[72:75],a[212:215],a[140:143],v[72:75]
v_cvt_pk_bf16_f32 v106,v52,v53
v_cvt_pk_bf16_f32 v107,v54,v55
v_mfma_f32_16x16x32_bf16 v[80:83],a[192:195],a[144:147],0
v_fma_f32 v64,v64,s36,v16
v_fma_f32 v65,v65,s36,v16
v_mfma_f32_16x16x32_bf16 v[136:139],v[24:27],v[104:107],v[136:139]
v_fma_f32 v66,v66,s36,v16
v_fma_f32 v67,v67,s36,v16
v_mfma_f32_16x16x32_bf16 v[80:83],a[196:199],a[148:151],v[80:83]
v_fma_f32 v72,v72,s36,v17
v_fma_f32 v73,v73,s36,v17
v_mfma_f32_16x16x32_bf16 v[80:83],a[200:203],a[152:155],v[80:83]
v_fma_f32 v74,v74,s36,v17
v_fma_f32 v75,v75,s36,v17
v_mfma_f32_16x16x32_bf16 v[80:83],a[204:207],a[156:159],v[80:83]
v_exp_f32 v64,v64
v_mfma_f32_16x16x32_bf16 v[80:83],a[208:211],a[160:163],v[80:83]
v_exp_f32 v65,v65
v_mfma_f32_16x16x32_bf16 v[80:83],a[212:215],a[164:167],v[80:83]
buffer_load_dwordx4 v9,s[12:15],s28 offen offset:2048 nt lds
v_mfma_f32_16x16x32_bf16 v[68:71],a[216:219],a[96:99],0
s_add_u32 s28,s28,3072
v_exp_f32 v66,v66
v_mfma_f32_16x16x32_bf16 v[68:71],a[220:223],a[100:103],v[68:71]
s_add_u32 s29,s29,3072
v_exp_f32 v67,v67
v_mfma_f32_16x16x32_bf16 v[68:71],a[224:227],a[104:107],v[68:71]
v_exp_f32 v72,v72
s_waitcnt vmcnt(12)
v_mfma_f32_16x16x32_bf16 v[68:71],a[228:231],a[108:111],v[68:71]
s_barrier
v_mfma_f32_16x16x32_bf16 v[68:71],a[232:235],a[112:115],v[68:71]
ds_read_b64_tr_b16 a[240:241],v3 offset:12288
ds_read_b64_tr_b16 a[242:243],v3 offset:18432
v_mfma_f32_16x16x32_bf16 v[68:71],a[236:239],a[116:119],v[68:71]
v_exp_f32 v73,v73
v_mfma_f32_16x16x32_bf16 v[76:79],a[216:219],a[120:123],0
ds_read_b64_tr_b16 a[244:245],v4 offset:12288
ds_read_b64_tr_b16 a[246:247],v4 offset:18432
v_mfma_f32_16x16x32_bf16 v[76:79],a[220:223],a[124:127],v[76:79]
ds_read_b64_tr_b16 a[248:249],v5 offset:12288
ds_read_b64_tr_b16 a[250:251],v5 offset:18432
v_mfma_f32_16x16x32_bf16 v[76:79],a[224:227],a[128:131],v[76:79]
v_exp_f32 v74,v74
v_mfma_f32_16x16x32_bf16 v[76:79],a[228:231],a[132:135],v[76:79]
ds_read_b64_tr_b16 a[252:253],v6 offset:12288
ds_read_b64_tr_b16 a[254:255],v6 offset:18432
v_mfma_f32_16x16x32_bf16 v[76:79],a[232:235],a[136:139],v[76:79]
v_exp_f32 v75,v75
v_mfma_f32_16x16x32_bf16 v[76:79],a[236:239],a[140:143],v[76:79]
v_cvt_pk_bf16_f32 v112,v64,v65
v_cvt_pk_bf16_f32 v113,v66,v67
v_mfma_f32_16x16x32_bf16 v[84:87],a[216:219],a[144:147],0
v_cvt_pk_bf16_f32 v116,v72,v73
v_cvt_pk_bf16_f32 v117,v74,v75
v_mfma_f32_16x16x32_bf16 v[84:87],a[220:223],a[148:151],v[84:87]
v_mfma_f32_16x16x32_bf16 v[84:87],a[224:227],a[152:155],v[84:87]
v_mfma_f32_16x16x32_bf16 v[84:87],a[228:231],a[156:159],v[84:87]
v_mfma_f32_16x16x32_bf16 v[84:87],a[232:235],a[160:163],v[84:87]
v_mfma_f32_16x16x32_bf16 v[84:87],a[236:239],a[164:167],v[84:87]
s_waitcnt lgkmcnt(2)
v_mfma_f32_16x16x32_bf16 v[160:163],a[240:243],v[96:99],v[160:163]
s_add_u32 m0,s23,0
ds_read_b128 a[192:195],v1 offset:0
v_fma_f32 v69,v69,s36,v16
v_mfma_f32_16x16x32_bf16 v[208:211],a[240:243],v[100:103],v[208:211]
buffer_load_dwordx4 v7,s[8:11],s21 offen offset:0 lds
v_mfma_f32_16x16x32_bf16 a[0:3],a[240:243],v[104:107],a[0:3]
ds_read_b64_tr_b16 a[242:243],v3 offset:18560
ds_read_b64_tr_b16 a[240:241],v3 offset:12416
v_mfma_f32_16x16x32_bf16 v[164:167],a[244:247],v[96:99],v[164:167]
ds_read_b128 a[196:199],v2 offset:0
v_fma_f32 v86,v86,s36,v18
v_mfma_f32_16x16x32_bf16 v[212:215],a[244:247],v[100:103],v[212:215]
ds_read_b128 a[200:203],v1 offset:128
v_fma_f32 v87,v87,s36,v18
v_mfma_f32_16x16x32_bf16 a[4:7],a[244:247],v[104:107],a[4:7]
ds_read_b64_tr_b16 a[244:245],v4 offset:12416
ds_read_b64_tr_b16 a[246:247],v4 offset:18560
v_mfma_f32_16x16x32_bf16 v[168:171],a[248:251],v[96:99],v[168:171]
ds_read_b128 a[212:215],v2 offset:256
v_fma_f32 v76,v76,s36,v17
v_mfma_f32_16x16x32_bf16 v[216:219],a[248:251],v[100:103],v[216:219]
buffer_load_dwordx4 v8,s[8:11],s21 offen offset:1024 lds
v_mfma_f32_16x16x32_bf16 a[8:11],a[248:251],v[104:107],a[8:11]
s_waitcnt lgkmcnt(7)
ds_read_b64_tr_b16 a[248:249],v5 offset:12416
ds_read_b64_tr_b16 a[250:251],v5 offset:18560
v_mfma_f32_16x16x32_bf16 v[172:175],a[252:255],v[96:99],v[172:175]
ds_read_b128 a[204:207],v2 offset:128
v_fma_f32 v68,v68,s36,v16
v_mfma_f32_16x16x32_bf16 v[220:223],a[252:255],v[100:103],v[220:223]
ds_read_b128 a[208:211],v1 offset:256
v_fma_f32 v71,v71,s36,v16
v_mfma_f32_16x16x32_bf16 a[12:15],a[252:255],v[104:107],a[12:15]
s_waitcnt lgkmcnt(8)
ds_read_b64_tr_b16 a[254:255],v6 offset:18560
ds_read_b64_tr_b16 a[252:253],v6 offset:12416
v_mfma_f32_16x16x32_bf16 v[176:179],a[240:243],v[96:99],v[176:179]
buffer_load_dwordx4 v9,s[8:11],s21 offen offset:2048 lds
v_mfma_f32_16x16x32_bf16 v[224:227],a[240:243],v[100:103],v[224:227]
s_add_u32 s21,s21,12288
ds_read_b128 a[220:223],v2 offset:6144
v_fma_f32 v70,v70,s36,v16
v_mfma_f32_16x16x32_bf16 a[16:19],a[240:243],v[104:107],a[16:19]
s_add_u32 m0,s22,24576
ds_read_b64_tr_b16 a[240:241],v3 offset:12544
ds_read_b64_tr_b16 a[242:243],v3 offset:18688
s_waitcnt lgkmcnt(9)
v_mfma_f32_16x16x32_bf16 v[180:183],a[244:247],v[96:99],v[180:183]
ds_read_b128 a[216:219],v1 offset:6144
v_fma_f32 v79,v79,s36,v17
v_mfma_f32_16x16x32_bf16 v[228:231],a[244:247],v[100:103],v[228:231]
ds_read_b128 a[224:227],v1 offset:6272
v_fma_f32 v78,v78,s36,v17
v_mfma_f32_16x16x32_bf16 a[20:23],a[244:247],v[104:107],a[20:23]
s_waitcnt lgkmcnt(8)
ds_read_b64_tr_b16 a[246:247],v4 offset:18688
ds_read_b64_tr_b16 a[244:245],v4 offset:12544
v_mfma_f32_16x16x32_bf16 v[184:187],a[248:251],v[96:99],v[184:187]
buffer_load_dwordx4 v7,s[4:7],s20 offen offset:0 lds
v_mfma_f32_16x16x32_bf16 v[232:235],a[248:251],v[100:103],v[232:235]
ds_read_b128 a[228:231],v2 offset:6272
v_fma_f32 v85,v85,s36,v18
v_mfma_f32_16x16x32_bf16 a[24:27],a[248:251],v[104:107],a[24:27]
s_waitcnt lgkmcnt(8)
ds_read_b64_tr_b16 a[248:249],v5 offset:12544
ds_read_b64_tr_b16 a[250:251],v5 offset:18688
v_mfma_f32_16x16x32_bf16 v[188:191],a[252:255],v[96:99],v[188:191]
ds_read_b128 a[232:235],v1 offset:6400
v_fma_f32 v82,v82,s36,v18
v_mfma_f32_16x16x32_bf16 v[236:239],a[252:255],v[100:103],v[236:239]
ds_read_b128 a[236:239],v2 offset:6400
v_fma_f32 v83,v83,s36,v18
v_mfma_f32_16x16x32_bf16 a[28:31],a[252:255],v[104:107],a[28:31]
s_waitcnt lgkmcnt(8)
ds_read_b64_tr_b16 a[254:255],v6 offset:18688
ds_read_b64_tr_b16 a[252:253],v6 offset:12544
v_mfma_f32_16x16x32_bf16 v[192:195],a[240:243],v[96:99],v[192:195]
buffer_load_dwordx4 v8,s[4:7],s20 offen offset:1024 lds
v_mfma_f32_16x16x32_bf16 v[240:243],a[240:243],v[100:103],v[240:243]
ds_read_b128 v[156:159],v11 offset:3072
v_fma_f32 v81,v81,s36,v18
v_mfma_f32_16x16x32_bf16 a[32:35],a[240:243],v[104:107],a[32:35]
s_waitcnt lgkmcnt(8)
v_fma_f32 v84,v84,s36,v18
v_fma_f32 v77,v77,s36,v17
v_mfma_f32_16x16x32_bf16 v[196:199],a[244:247],v[96:99],v[196:199]
v_exp_f32 v86,v86
v_mfma_f32_16x16x32_bf16 v[244:247],a[244:247],v[100:103],v[244:247]
v_fma_f32 v80,v80,s36,v18
v_mfma_f32_16x16x32_bf16 a[36:39],a[244:247],v[104:107],a[36:39]
s_waitcnt lgkmcnt(4)
v_exp_f32 v80,v80
v_mfma_f32_16x16x32_bf16 v[200:203],a[248:251],v[96:99],v[200:203]
buffer_load_dwordx4 v9,s[4:7],s20 offen offset:2048 lds
v_mfma_f32_16x16x32_bf16 v[248:251],a[248:251],v[100:103],v[248:251]
s_add_u32 s20,s20,12288
v_exp_f32 v84,v84
v_mfma_f32_16x16x32_bf16 a[40:43],a[248:251],v[104:107],a[40:43]
s_waitcnt lgkmcnt(1)
ds_read_b128 v[152:155],v23 offset:3072
v_mfma_f32_16x16x32_bf16 v[204:207],a[252:255],v[96:99],v[204:207]
v_exp_f32 v82,v82
v_mfma_f32_16x16x32_bf16 v[252:255],a[252:255],v[100:103],v[252:255]
v_exp_f32 v78,v78
v_mfma_f32_16x16x32_bf16 a[44:47],a[252:255],v[104:107],a[44:47]
v_exp_f32 v68,v68
v_mfma_f32_16x16x32_bf16 v[32:35],a[192:195],a[96:99],0
v_exp_f32 v85,v85
v_mfma_f32_16x16x32_bf16 v[32:35],a[196:199],a[100:103],v[32:35]
v_cvt_pk_bf16_f32 v122,v84,v85
v_mfma_f32_16x16x32_bf16 v[32:35],a[200:203],a[104:107],v[32:35]
v_exp_f32 v81,v81
v_mfma_f32_16x16x32_bf16 v[32:35],a[204:207],a[108:111],v[32:35]
s_waitcnt lgkmcnt(1)
buffer_store_dwordx4 v[156:159],v0,s[16:19],s27 offen offset:0 nt
v_cvt_pk_bf16_f32 v120,v80,v81
v_exp_f32 v76,v76
v_mfma_f32_16x16x32_bf16 v[32:35],a[208:211],a[112:115],v[32:35]
ds_read_b128 v[156:159],v31 offset:3072
v_mfma_f32_16x16x32_bf16 v[32:35],a[212:215],a[116:119],v[32:35]
v_exp_f32 v71,v71
v_mfma_f32_16x16x32_bf16 v[40:43],a[192:195],a[120:123],0
v_exp_f32 v79,v79
v_mfma_f32_16x16x32_bf16 v[40:43],a[196:199],a[124:127],v[40:43]
v_cvt_pk_bf16_f32 v119,v78,v79
v_mfma_f32_16x16x32_bf16 v[40:43],a[200:203],a[128:131],v[40:43]
v_exp_f32 v70,v70
v_mfma_f32_16x16x32_bf16 v[40:43],a[204:207],a[132:135],v[40:43]
v_fma_f32 v32,v32,s36,v16
v_cvt_pk_bf16_f32 v115,v70,v71
v_mfma_f32_16x16x32_bf16 v[40:43],a[208:211],a[136:139],v[40:43]
v_fma_f32 v34,v34,s36,v16
v_fma_f32 v33,v33,s36,v16
v_mfma_f32_16x16x32_bf16 v[40:43],a[212:215],a[140:143],v[40:43]
s_waitcnt lgkmcnt(1)
buffer_store_dwordx4 v[152:155],v0,s[16:19],s27 offen offset:1024 nt
v_fma_f32 v35,v35,s36,v16
v_exp_f32 v35,v35
v_mfma_f32_16x16x32_bf16 v[48:51],a[192:195],a[144:147],0
v_exp_f32 v34,v34
v_mfma_f32_16x16x32_bf16 v[48:51],a[196:199],a[148:151],v[48:51]
v_cvt_pk_bf16_f32 v97,v34,v35
v_mfma_f32_16x16x32_bf16 v[48:51],a[200:203],a[152:155],v[48:51]
v_fma_f32 v41,v41,s36,v17
v_fma_f32 v40,v40,s36,v17
v_mfma_f32_16x16x32_bf16 v[48:51],a[204:207],a[156:159],v[48:51]
v_fma_f32 v42,v42,s36,v17
v_fma_f32 v43,v43,s36,v17
v_mfma_f32_16x16x32_bf16 v[48:51],a[208:211],a[160:163],v[48:51]
v_exp_f32 v41,v41
v_mfma_f32_16x16x32_bf16 v[48:51],a[212:215],a[164:167],v[48:51]
v_exp_f32 v77,v77
v_mfma_f32_16x16x32_bf16 v[36:39],a[216:219],a[96:99],0
v_cvt_pk_bf16_f32 v118,v76,v77
v_mfma_f32_16x16x32_bf16 v[36:39],a[220:223],a[100:103],v[36:39]
s_waitcnt lgkmcnt(0)
buffer_store_dwordx4 v[156:159],v0,s[16:19],s27 offen offset:2048 nt
v_exp_f32 v69,v69
v_mfma_f32_16x16x32_bf16 v[36:39],a[224:227],a[104:107],v[36:39]
s_add_u32 s27,s27,3072
v_cvt_pk_bf16_f32 v114,v68,v69
v_mfma_f32_16x16x32_bf16 v[132:135],v[24:27],v[116:119],v[132:135]
v_exp_f32 v87,v87
v_mfma_f32_16x16x32_bf16 v[128:131],v[24:27],v[112:115],v[128:131]
v_cvt_pk_bf16_f32 v123,v86,v87
s_waitcnt vmcnt(12)
v_mfma_f32_16x16x32_bf16 v[36:39],a[228:231],a[108:111],v[36:39]
s_barrier
v_mfma_f32_16x16x32_bf16 v[36:39],a[232:235],a[112:115],v[36:39]
ds_read_b64_tr_b16 a[240:241],v3 offset:24576
ds_read_b64_tr_b16 a[242:243],v3 offset:30720
v_mfma_f32_16x16x32_bf16 v[36:39],a[236:239],a[116:119],v[36:39]
v_exp_f32 v83,v83
v_mfma_f32_16x16x32_bf16 v[44:47],a[216:219],a[120:123],0
ds_read_b64_tr_b16 a[244:245],v4 offset:24576
ds_read_b64_tr_b16 a[246:247],v4 offset:30720
v_mfma_f32_16x16x32_bf16 v[44:47],a[220:223],a[124:127],v[44:47]
ds_read_b64_tr_b16 a[250:251],v5 offset:30720
ds_read_b64_tr_b16 a[248:249],v5 offset:24576
v_mfma_f32_16x16x32_bf16 v[44:47],a[224:227],a[128:131],v[44:47]
v_cvt_pk_bf16_f32 v121,v82,v83
v_mfma_f32_16x16x32_bf16 v[44:47],a[228:231],a[132:135],v[44:47]
ds_read_b64_tr_b16 a[252:253],v6 offset:24576
ds_read_b64_tr_b16 a[254:255],v6 offset:30720
v_mfma_f32_16x16x32_bf16 v[136:139],v[24:27],v[120:123],v[136:139]
v_exp_f32 v32,v32
v_mfma_f32_16x16x32_bf16 v[44:47],a[232:235],a[136:139],v[44:47]
v_exp_f32 v43,v43
v_mfma_f32_16x16x32_bf16 v[44:47],a[236:239],a[140:143],v[44:47]
v_exp_f32 v42,v42
v_mfma_f32_16x16x32_bf16 v[52:55],a[216:219],a[144:147],0
v_cvt_pk_bf16_f32 v101,v42,v43
v_mfma_f32_16x16x32_bf16 v[52:55],a[220:223],a[148:151],v[52:55]
v_exp_f32 v40,v40
v_mfma_f32_16x16x32_bf16 v[52:55],a[224:227],a[152:155],v[52:55]
v_cvt_pk_bf16_f32 v100,v40,v41
v_mfma_f32_16x16x32_bf16 v[52:55],a[228:231],a[156:159],v[52:55]
v_exp_f32 v33,v33
v_mfma_f32_16x16x32_bf16 v[52:55],a[232:235],a[160:163],v[52:55]
v_cvt_pk_bf16_f32 v96,v32,v33
v_mfma_f32_16x16x32_bf16 v[52:55],a[236:239],a[164:167],v[52:55]
s_waitcnt lgkmcnt(0)
v_mfma_f32_16x16x32_bf16 v[160:163],a[240:243],v[112:115],v[160:163]
s_add_u32 m0,s23,12288
ds_read_b128 a[192:195],v1 offset:12288
v_fma_f32 v36,v36,s36,v16
v_mfma_f32_16x16x32_bf16 v[208:211],a[240:243],v[116:119],v[208:211]
buffer_load_dwordx4 v7,s[8:11],s21 offen offset:0 lds
v_mfma_f32_16x16x32_bf16 a[0:3],a[240:243],v[120:123],a[0:3]
ds_read_b64_tr_b16 a[240:241],v3 offset:24704
ds_read_b64_tr_b16 a[242:243],v3 offset:30848
v_mfma_f32_16x16x32_bf16 v[164:167],a[244:247],v[112:115],v[164:167]
ds_read_b128 a[196:199],v2 offset:12288
v_fma_f32 v37,v37,s36,v16
v_mfma_f32_16x16x32_bf16 v[212:215],a[244:247],v[116:119],v[212:215]
ds_read_b128 a[200:203],v1 offset:12416
v_fma_f32 v38,v38,s36,v16
v_mfma_f32_16x16x32_bf16 a[4:7],a[244:247],v[120:123],a[4:7]
ds_read_b64_tr_b16 a[244:245],v4 offset:24704
ds_read_b64_tr_b16 a[246:247],v4 offset:30848
v_mfma_f32_16x16x32_bf16 v[168:171],a[248:251],v[112:115],v[168:171]
ds_read_b128 a[204:207],v2 offset:12416
v_fma_f32 v39,v39,s36,v16
v_mfma_f32_16x16x32_bf16 v[216:219],a[248:251],v[116:119],v[216:219]
buffer_load_dwordx4 v8,s[8:11],s21 offen offset:1024 lds
v_mfma_f32_16x16x32_bf16 a[8:11],a[248:251],v[120:123],a[8:11]
ds_read_b64_tr_b16 a[248:249],v5 offset:24704
ds_read_b64_tr_b16 a[250:251],v5 offset:30848
v_mfma_f32_16x16x32_bf16 v[172:175],a[252:255],v[112:115],v[172:175]
ds_read_b128 a[208:211],v1 offset:12544
v_fma_f32 v44,v44,s36,v17
v_mfma_f32_16x16x32_bf16 v[220:223],a[252:255],v[116:119],v[220:223]
ds_read_b128 a[212:215],v2 offset:12544
v_fma_f32 v45,v45,s36,v17
v_mfma_f32_16x16x32_bf16 a[12:15],a[252:255],v[120:123],a[12:15]
s_waitcnt lgkmcnt(8)
ds_read_b64_tr_b16 a[252:253],v6 offset:24704
ds_read_b64_tr_b16 a[254:255],v6 offset:30848
v_mfma_f32_16x16x32_bf16 v[176:179],a[240:243],v[112:115],v[176:179]
buffer_load_dwordx4 v9,s[8:11],s21 offen offset:2048 lds
v_mfma_f32_16x16x32_bf16 v[224:227],a[240:243],v[116:119],v[224:227]
s_add_u32 s21,s21,12288
ds_read_b128 a[216:219],v1 offset:18432
v_fma_f32 v46,v46,s36,v17
v_mfma_f32_16x16x32_bf16 a[16:19],a[240:243],v[120:123],a[16:19]
s_add_u32 m0,s22,0
ds_read_b64_tr_b16 a[240:241],v3 offset:24832
ds_read_b64_tr_b16 a[242:243],v3 offset:30976
s_waitcnt lgkmcnt(9)
v_mfma_f32_16x16x32_bf16 v[180:183],a[244:247],v[112:115],v[180:183]
ds_read_b128 a[220:223],v2 offset:18432
v_fma_f32 v47,v47,s36,v17
v_mfma_f32_16x16x32_bf16 v[228:231],a[244:247],v[116:119],v[228:231]
ds_read_b128 a[224:227],v1 offset:18560
v_fma_f32 v48,v48,s36,v18
v_mfma_f32_16x16x32_bf16 a[20:23],a[244:247],v[120:123],a[20:23]
s_waitcnt lgkmcnt(8)
ds_read_b64_tr_b16 a[244:245],v4 offset:24832
ds_read_b64_tr_b16 a[246:247],v4 offset:30976
v_mfma_f32_16x16x32_bf16 v[184:187],a[248:251],v[112:115],v[184:187]
buffer_load_dwordx4 v7,s[4:7],s20 offen offset:0 lds
v_mfma_f32_16x16x32_bf16 v[232:235],a[248:251],v[116:119],v[232:235]
ds_read_b128 a[228:231],v2 offset:18560
v_fma_f32 v49,v49,s36,v18
v_mfma_f32_16x16x32_bf16 a[24:27],a[248:251],v[120:123],a[24:27]
s_waitcnt lgkmcnt(8)
ds_read_b64_tr_b16 a[248:249],v5 offset:24832
ds_read_b64_tr_b16 a[250:251],v5 offset:30976
v_mfma_f32_16x16x32_bf16 v[188:191],a[252:255],v[112:115],v[188:191]
ds_read_b128 a[232:235],v1 offset:18688
v_fma_f32 v50,v50,s36,v18
v_mfma_f32_16x16x32_bf16 v[236:239],a[252:255],v[116:119],v[236:239]
ds_read_b128 a[236:239],v2 offset:18688
v_fma_f32 v51,v51,s36,v18
v_mfma_f32_16x16x32_bf16 a[28:31],a[252:255],v[120:123],a[28:31]
s_waitcnt lgkmcnt(8)
ds_read_b64_tr_b16 a[252:253],v6 offset:24832
ds_read_b64_tr_b16 a[254:255],v6 offset:30976
v_mfma_f32_16x16x32_bf16 v[192:195],a[240:243],v[112:115],v[192:195]
buffer_load_dwordx4 v8,s[4:7],s20 offen offset:1024 lds
v_mfma_f32_16x16x32_bf16 v[240:243],a[240:243],v[116:119],v[240:243]
v_fma_f32 v52,v52,s36,v18
v_fma_f32 v53,v53,s36,v18
v_mfma_f32_16x16x32_bf16 a[32:35],a[240:243],v[120:123],a[32:35]
s_waitcnt lgkmcnt(7)
v_fma_f32 v54,v54,s36,v18
v_fma_f32 v55,v55,s36,v18
v_mfma_f32_16x16x32_bf16 v[196:199],a[244:247],v[112:115],v[196:199]
v_exp_f32 v36,v36
v_mfma_f32_16x16x32_bf16 v[244:247],a[244:247],v[116:119],v[244:247]
v_exp_f32 v37,v37
v_mfma_f32_16x16x32_bf16 a[36:39],a[244:247],v[120:123],a[36:39]
s_waitcnt lgkmcnt(3)
v_exp_f32 v38,v38
v_mfma_f32_16x16x32_bf16 v[200:203],a[248:251],v[112:115],v[200:203]
buffer_load_dwordx4 v9,s[4:7],s20 offen offset:2048 lds
v_mfma_f32_16x16x32_bf16 v[248:251],a[248:251],v[116:119],v[248:251]
s_add_u32 s20,s20,12288
v_exp_f32 v39,v39
v_mfma_f32_16x16x32_bf16 a[40:43],a[248:251],v[120:123],a[40:43]
s_add_u32 m0,s29,0
v_exp_f32 v44,v44
s_waitcnt lgkmcnt(0)
v_mfma_f32_16x16x32_bf16 v[204:207],a[252:255],v[112:115],v[204:207]
v_exp_f32 v45,v45
v_mfma_f32_16x16x32_bf16 v[252:255],a[252:255],v[116:119],v[252:255]
v_exp_f32 v46,v46
v_mfma_f32_16x16x32_bf16 a[44:47],a[252:255],v[120:123],a[44:47]
v_exp_f32 v47,v47
v_mfma_f32_16x16x32_bf16 v[64:67],a[192:195],a[96:99],0
v_exp_f32 v48,v48
v_mfma_f32_16x16x32_bf16 v[64:67],a[196:199],a[100:103],v[64:67]
v_exp_f32 v49,v49
v_mfma_f32_16x16x32_bf16 v[64:67],a[200:203],a[104:107],v[64:67]
v_exp_f32 v50,v50
v_mfma_f32_16x16x32_bf16 v[64:67],a[204:207],a[108:111],v[64:67]
buffer_load_dwordx4 v7,s[12:15],s28 offen offset:0 nt lds
v_mfma_f32_16x16x32_bf16 v[64:67],a[208:211],a[112:115],v[64:67]
v_exp_f32 v51,v51
v_mfma_f32_16x16x32_bf16 v[64:67],a[212:215],a[116:119],v[64:67]
v_exp_f32 v52,v52
v_mfma_f32_16x16x32_bf16 v[72:75],a[192:195],a[120:123],0
v_exp_f32 v53,v53
v_mfma_f32_16x16x32_bf16 v[72:75],a[196:199],a[124:127],v[72:75]
v_exp_f32 v54,v54
v_mfma_f32_16x16x32_bf16 v[72:75],a[200:203],a[128:131],v[72:75]
v_exp_f32 v55,v55
v_mfma_f32_16x16x32_bf16 v[72:75],a[204:207],a[132:135],v[72:75]
v_cvt_pk_bf16_f32 v98,v36,v37
v_cvt_pk_bf16_f32 v99,v38,v39
v_mfma_f32_16x16x32_bf16 v[72:75],a[208:211],a[136:139],v[72:75]
v_cvt_pk_bf16_f32 v102,v44,v45
v_cvt_pk_bf16_f32 v103,v46,v47
v_mfma_f32_16x16x32_bf16 v[128:131],v[24:27],v[96:99],v[128:131]
v_cvt_pk_bf16_f32 v104,v48,v49
v_cvt_pk_bf16_f32 v105,v50,v51
v_mfma_f32_16x16x32_bf16 v[132:135],v[24:27],v[100:103],v[132:135]
buffer_load_dwordx4 v8,s[12:15],s28 offen offset:1024 nt lds
v_mfma_f32_16x16x32_bf16 v[72:75],a[212:215],a[140:143],v[72:75]
v_cvt_pk_bf16_f32 v106,v52,v53
v_cvt_pk_bf16_f32 v107,v54,v55
v_mfma_f32_16x16x32_bf16 v[80:83],a[192:195],a[144:147],0
v_fma_f32 v64,v64,s36,v16
v_fma_f32 v65,v65,s36,v16
v_mfma_f32_16x16x32_bf16 v[136:139],v[24:27],v[104:107],v[136:139]
v_fma_f32 v66,v66,s36,v16
v_fma_f32 v67,v67,s36,v16
v_mfma_f32_16x16x32_bf16 v[80:83],a[196:199],a[148:151],v[80:83]
v_fma_f32 v72,v72,s36,v17
v_fma_f32 v73,v73,s36,v17
v_mfma_f32_16x16x32_bf16 v[80:83],a[200:203],a[152:155],v[80:83]
v_fma_f32 v74,v74,s36,v17
v_fma_f32 v75,v75,s36,v17
v_mfma_f32_16x16x32_bf16 v[80:83],a[204:207],a[156:159],v[80:83]
v_exp_f32 v64,v64
v_mfma_f32_16x16x32_bf16 v[80:83],a[208:211],a[160:163],v[80:83]
v_exp_f32 v65,v65
v_mfma_f32_16x16x32_bf16 v[80:83],a[212:215],a[164:167],v[80:83]
buffer_load_dwordx4 v9,s[12:15],s28 offen offset:2048 nt lds
v_mfma_f32_16x16x32_bf16 v[68:71],a[216:219],a[96:99],0
s_add_u32 s28,s28,3072
v_exp_f32 v66,v66
v_mfma_f32_16x16x32_bf16 v[68:71],a[220:223],a[100:103],v[68:71]
s_add_u32 s29,s29,3072
v_exp_f32 v67,v67
v_mfma_f32_16x16x32_bf16 v[68:71],a[224:227],a[104:107],v[68:71]
v_exp_f32 v72,v72
s_waitcnt vmcnt(12)
v_mfma_f32_16x16x32_bf16 v[68:71],a[228:231],a[108:111],v[68:71]
s_barrier
v_mfma_f32_16x16x32_bf16 v[68:71],a[232:235],a[112:115],v[68:71]
ds_read_b64_tr_b16 a[240:241],v3 offset:0
ds_read_b64_tr_b16 a[242:243],v3 offset:6144
v_mfma_f32_16x16x32_bf16 v[68:71],a[236:239],a[116:119],v[68:71]
v_exp_f32 v73,v73
v_mfma_f32_16x16x32_bf16 v[76:79],a[216:219],a[120:123],0
ds_read_b64_tr_b16 a[244:245],v4 offset:0
ds_read_b64_tr_b16 a[246:247],v4 offset:6144
v_mfma_f32_16x16x32_bf16 v[76:79],a[220:223],a[124:127],v[76:79]
ds_read_b64_tr_b16 a[248:249],v5 offset:0
ds_read_b64_tr_b16 a[250:251],v5 offset:6144
v_mfma_f32_16x16x32_bf16 v[76:79],a[224:227],a[128:131],v[76:79]
v_exp_f32 v74,v74
v_mfma_f32_16x16x32_bf16 v[76:79],a[228:231],a[132:135],v[76:79]
ds_read_b64_tr_b16 a[252:253],v6 offset:0
ds_read_b64_tr_b16 a[254:255],v6 offset:6144
v_mfma_f32_16x16x32_bf16 v[76:79],a[232:235],a[136:139],v[76:79]
v_exp_f32 v75,v75
v_mfma_f32_16x16x32_bf16 v[76:79],a[236:239],a[140:143],v[76:79]
v_cvt_pk_bf16_f32 v112,v64,v65
v_cvt_pk_bf16_f32 v113,v66,v67
v_mfma_f32_16x16x32_bf16 v[84:87],a[216:219],a[144:147],0
v_cvt_pk_bf16_f32 v116,v72,v73
v_cvt_pk_bf16_f32 v117,v74,v75
v_mfma_f32_16x16x32_bf16 v[84:87],a[220:223],a[148:151],v[84:87]
v_mfma_f32_16x16x32_bf16 v[84:87],a[224:227],a[152:155],v[84:87]
v_mfma_f32_16x16x32_bf16 v[84:87],a[228:231],a[156:159],v[84:87]
v_mfma_f32_16x16x32_bf16 v[84:87],a[232:235],a[160:163],v[84:87]
v_mfma_f32_16x16x32_bf16 v[84:87],a[236:239],a[164:167],v[84:87]
s_waitcnt lgkmcnt(2)
v_mfma_f32_16x16x32_bf16 v[160:163],a[240:243],v[96:99],v[160:163]
s_add_u32 m0,s23,24576
ds_read_b128 a[192:195],v1 offset:24576
v_fma_f32 v69,v69,s36,v16
v_mfma_f32_16x16x32_bf16 v[208:211],a[240:243],v[100:103],v[208:211]
buffer_load_dwordx4 v7,s[8:11],s21 offen offset:0 lds
v_mfma_f32_16x16x32_bf16 a[0:3],a[240:243],v[104:107],a[0:3]
ds_read_b64_tr_b16 a[242:243],v3 offset:6272
ds_read_b64_tr_b16 a[240:241],v3 offset:128
v_mfma_f32_16x16x32_bf16 v[164:167],a[244:247],v[96:99],v[164:167]
ds_read_b128 a[196:199],v2 offset:24576
v_fma_f32 v86,v86,s36,v18
v_mfma_f32_16x16x32_bf16 v[212:215],a[244:247],v[100:103],v[212:215]
ds_read_b128 a[200:203],v1 offset:24704
v_fma_f32 v87,v87,s36,v18
v_mfma_f32_16x16x32_bf16 a[4:7],a[244:247],v[104:107],a[4:7]
ds_read_b64_tr_b16 a[244:245],v4 offset:128
ds_read_b64_tr_b16 a[246:247],v4 offset:6272
v_mfma_f32_16x16x32_bf16 v[168:171],a[248:251],v[96:99],v[168:171]
ds_read_b128 a[212:215],v2 offset:24832
v_fma_f32 v76,v76,s36,v17
v_mfma_f32_16x16x32_bf16 v[216:219],a[248:251],v[100:103],v[216:219]
buffer_load_dwordx4 v8,s[8:11],s21 offen offset:1024 lds
v_mfma_f32_16x16x32_bf16 a[8:11],a[248:251],v[104:107],a[8:11]
s_waitcnt lgkmcnt(7)
ds_read_b64_tr_b16 a[248:249],v5 offset:128
ds_read_b64_tr_b16 a[250:251],v5 offset:6272
v_mfma_f32_16x16x32_bf16 v[172:175],a[252:255],v[96:99],v[172:175]
ds_read_b128 a[204:207],v2 offset:24704
v_fma_f32 v68,v68,s36,v16
v_mfma_f32_16x16x32_bf16 v[220:223],a[252:255],v[100:103],v[220:223]
ds_read_b128 a[208:211],v1 offset:24832
v_fma_f32 v71,v71,s36,v16
v_mfma_f32_16x16x32_bf16 a[12:15],a[252:255],v[104:107],a[12:15]
s_waitcnt lgkmcnt(8)
ds_read_b64_tr_b16 a[254:255],v6 offset:6272
ds_read_b64_tr_b16 a[252:253],v6 offset:128
v_mfma_f32_16x16x32_bf16 v[176:179],a[240:243],v[96:99],v[176:179]
buffer_load_dwordx4 v9,s[8:11],s21 offen offset:2048 lds
v_mfma_f32_16x16x32_bf16 v[224:227],a[240:243],v[100:103],v[224:227]
s_add_u32 s21,s21,12288
ds_read_b128 a[220:223],v2 offset:30720
v_fma_f32 v70,v70,s36,v16
v_mfma_f32_16x16x32_bf16 a[16:19],a[240:243],v[104:107],a[16:19]
s_add_u32 m0,s25,0
ds_read_b64_tr_b16 a[240:241],v3 offset:256
ds_read_b64_tr_b16 a[242:243],v3 offset:6400
s_waitcnt lgkmcnt(9)
v_mfma_f32_16x16x32_bf16 v[180:183],a[244:247],v[96:99],v[180:183]
ds_read_b128 a[216:219],v1 offset:30720
v_fma_f32 v79,v79,s36,v17
v_mfma_f32_16x16x32_bf16 v[228:231],a[244:247],v[100:103],v[228:231]
ds_read_b128 a[224:227],v1 offset:30848
v_fma_f32 v78,v78,s36,v17
v_mfma_f32_16x16x32_bf16 a[20:23],a[244:247],v[104:107],a[20:23]
s_waitcnt lgkmcnt(8)
ds_read_b64_tr_b16 a[246:247],v4 offset:6400
ds_read_b64_tr_b16 a[244:245],v4 offset:256
v_mfma_f32_16x16x32_bf16 v[184:187],a[248:251],v[96:99],v[184:187]
buffer_load_dwordx4 v7,s[4:7],s20 offen offset:0 lds
v_mfma_f32_16x16x32_bf16 v[232:235],a[248:251],v[100:103],v[232:235]
ds_read_b128 a[228:231],v2 offset:30848
v_fma_f32 v85,v85,s36,v18
v_mfma_f32_16x16x32_bf16 a[24:27],a[248:251],v[104:107],a[24:27]
s_waitcnt lgkmcnt(8)
ds_read_b64_tr_b16 a[248:249],v5 offset:256
ds_read_b64_tr_b16 a[250:251],v5 offset:6400
v_mfma_f32_16x16x32_bf16 v[188:191],a[252:255],v[96:99],v[188:191]
ds_read_b128 a[232:235],v1 offset:30976
v_fma_f32 v82,v82,s36,v18
v_mfma_f32_16x16x32_bf16 v[236:239],a[252:255],v[100:103],v[236:239]
ds_read_b128 a[236:239],v2 offset:30976
v_fma_f32 v83,v83,s36,v18
v_mfma_f32_16x16x32_bf16 a[28:31],a[252:255],v[104:107],a[28:31]
s_waitcnt lgkmcnt(8)
ds_read_b64_tr_b16 a[254:255],v6 offset:6400
ds_read_b64_tr_b16 a[252:253],v6 offset:256
v_mfma_f32_16x16x32_bf16 v[192:195],a[240:243],v[96:99],v[192:195]
buffer_load_dwordx4 v8,s[4:7],s20 offen offset:1024 lds
v_mfma_f32_16x16x32_bf16 v[240:243],a[240:243],v[100:103],v[240:243]
ds_read_b128 v[152:155],v11 offset:6144
v_fma_f32 v81,v81,s36,v18
v_mfma_f32_16x16x32_bf16 a[32:35],a[240:243],v[104:107],a[32:35]
s_waitcnt lgkmcnt(8)
v_fma_f32 v84,v84,s36,v18
v_fma_f32 v77,v77,s36,v17
v_mfma_f32_16x16x32_bf16 v[196:199],a[244:247],v[96:99],v[196:199]
v_exp_f32 v86,v86
v_mfma_f32_16x16x32_bf16 v[244:247],a[244:247],v[100:103],v[244:247]
v_fma_f32 v80,v80,s36,v18
v_mfma_f32_16x16x32_bf16 a[36:39],a[244:247],v[104:107],a[36:39]
s_waitcnt lgkmcnt(4)
v_exp_f32 v80,v80
v_mfma_f32_16x16x32_bf16 v[200:203],a[248:251],v[96:99],v[200:203]
buffer_load_dwordx4 v9,s[4:7],s20 offen offset:2048 lds
v_mfma_f32_16x16x32_bf16 v[248:251],a[248:251],v[100:103],v[248:251]
s_add_u32 s20,s20,12288
v_exp_f32 v84,v84
v_mfma_f32_16x16x32_bf16 a[40:43],a[248:251],v[104:107],a[40:43]
s_waitcnt lgkmcnt(1)
ds_read_b128 v[156:159],v23 offset:6144
v_mfma_f32_16x16x32_bf16 v[204:207],a[252:255],v[96:99],v[204:207]
v_exp_f32 v82,v82
v_mfma_f32_16x16x32_bf16 v[252:255],a[252:255],v[100:103],v[252:255]
v_exp_f32 v78,v78
v_mfma_f32_16x16x32_bf16 a[44:47],a[252:255],v[104:107],a[44:47]
v_exp_f32 v68,v68
v_mfma_f32_16x16x32_bf16 v[32:35],a[192:195],a[96:99],0
v_exp_f32 v85,v85
v_mfma_f32_16x16x32_bf16 v[32:35],a[196:199],a[100:103],v[32:35]
v_cvt_pk_bf16_f32 v122,v84,v85
v_mfma_f32_16x16x32_bf16 v[32:35],a[200:203],a[104:107],v[32:35]
v_exp_f32 v81,v81
v_mfma_f32_16x16x32_bf16 v[32:35],a[204:207],a[108:111],v[32:35]
s_waitcnt lgkmcnt(1)
buffer_store_dwordx4 v[152:155],v0,s[16:19],s27 offen offset:0 nt
v_cvt_pk_bf16_f32 v120,v80,v81
v_exp_f32 v76,v76
v_mfma_f32_16x16x32_bf16 v[32:35],a[208:211],a[112:115],v[32:35]
ds_read_b128 v[152:155],v31 offset:6144
v_mfma_f32_16x16x32_bf16 v[32:35],a[212:215],a[116:119],v[32:35]
v_exp_f32 v71,v71
v_mfma_f32_16x16x32_bf16 v[40:43],a[192:195],a[120:123],0
v_exp_f32 v79,v79
v_mfma_f32_16x16x32_bf16 v[40:43],a[196:199],a[124:127],v[40:43]
v_cvt_pk_bf16_f32 v119,v78,v79
v_mfma_f32_16x16x32_bf16 v[40:43],a[200:203],a[128:131],v[40:43]
v_exp_f32 v70,v70
v_mfma_f32_16x16x32_bf16 v[40:43],a[204:207],a[132:135],v[40:43]
v_fma_f32 v32,v32,s36,v16
v_cvt_pk_bf16_f32 v115,v70,v71
v_mfma_f32_16x16x32_bf16 v[40:43],a[208:211],a[136:139],v[40:43]
v_fma_f32 v34,v34,s36,v16
v_fma_f32 v33,v33,s36,v16
v_mfma_f32_16x16x32_bf16 v[40:43],a[212:215],a[140:143],v[40:43]
s_waitcnt lgkmcnt(1)
buffer_store_dwordx4 v[156:159],v0,s[16:19],s27 offen offset:1024 nt
v_fma_f32 v35,v35,s36,v16
v_exp_f32 v35,v35
v_mfma_f32_16x16x32_bf16 v[48:51],a[192:195],a[144:147],0
v_exp_f32 v34,v34
v_mfma_f32_16x16x32_bf16 v[48:51],a[196:199],a[148:151],v[48:51]
v_cvt_pk_bf16_f32 v97,v34,v35
v_mfma_f32_16x16x32_bf16 v[48:51],a[200:203],a[152:155],v[48:51]
v_fma_f32 v41,v41,s36,v17
v_fma_f32 v40,v40,s36,v17
v_mfma_f32_16x16x32_bf16 v[48:51],a[204:207],a[156:159],v[48:51]
v_fma_f32 v42,v42,s36,v17
v_fma_f32 v43,v43,s36,v17
v_mfma_f32_16x16x32_bf16 v[48:51],a[208:211],a[160:163],v[48:51]
v_exp_f32 v41,v41
v_mfma_f32_16x16x32_bf16 v[48:51],a[212:215],a[164:167],v[48:51]
v_exp_f32 v77,v77
v_mfma_f32_16x16x32_bf16 v[36:39],a[216:219],a[96:99],0
v_cvt_pk_bf16_f32 v118,v76,v77
v_mfma_f32_16x16x32_bf16 v[36:39],a[220:223],a[100:103],v[36:39]
s_waitcnt lgkmcnt(0)
buffer_store_dwordx4 v[152:155],v0,s[16:19],s27 offen offset:2048 nt
v_exp_f32 v69,v69
v_mfma_f32_16x16x32_bf16 v[36:39],a[224:227],a[104:107],v[36:39]
s_add_u32 s27,s27,3072
v_cvt_pk_bf16_f32 v114,v68,v69
v_mfma_f32_16x16x32_bf16 v[132:135],v[24:27],v[116:119],v[132:135]
v_exp_f32 v87,v87
v_mfma_f32_16x16x32_bf16 v[128:131],v[24:27],v[112:115],v[128:131]
v_cvt_pk_bf16_f32 v123,v86,v87
s_waitcnt vmcnt(12)
v_mfma_f32_16x16x32_bf16 v[36:39],a[228:231],a[108:111],v[36:39]
s_barrier
v_mfma_f32_16x16x32_bf16 v[36:39],a[232:235],a[112:115],v[36:39]
ds_read_b64_tr_b16 a[240:241],v3 offset:12288
ds_read_b64_tr_b16 a[242:243],v3 offset:18432
v_mfma_f32_16x16x32_bf16 v[36:39],a[236:239],a[116:119],v[36:39]
v_exp_f32 v83,v83
v_mfma_f32_16x16x32_bf16 v[44:47],a[216:219],a[120:123],0
ds_read_b64_tr_b16 a[244:245],v4 offset:12288
ds_read_b64_tr_b16 a[246:247],v4 offset:18432
v_mfma_f32_16x16x32_bf16 v[44:47],a[220:223],a[124:127],v[44:47]
ds_read_b64_tr_b16 a[250:251],v5 offset:18432
ds_read_b64_tr_b16 a[248:249],v5 offset:12288
v_mfma_f32_16x16x32_bf16 v[44:47],a[224:227],a[128:131],v[44:47]
v_cvt_pk_bf16_f32 v121,v82,v83
v_mfma_f32_16x16x32_bf16 v[44:47],a[228:231],a[132:135],v[44:47]
ds_read_b64_tr_b16 a[252:253],v6 offset:12288
ds_read_b64_tr_b16 a[254:255],v6 offset:18432
v_mfma_f32_16x16x32_bf16 v[136:139],v[24:27],v[120:123],v[136:139]
v_exp_f32 v32,v32
v_mfma_f32_16x16x32_bf16 v[44:47],a[232:235],a[136:139],v[44:47]
v_exp_f32 v43,v43
v_mfma_f32_16x16x32_bf16 v[44:47],a[236:239],a[140:143],v[44:47]
v_exp_f32 v42,v42
v_mfma_f32_16x16x32_bf16 v[52:55],a[216:219],a[144:147],0
v_cvt_pk_bf16_f32 v101,v42,v43
v_mfma_f32_16x16x32_bf16 v[52:55],a[220:223],a[148:151],v[52:55]
v_exp_f32 v40,v40
v_mfma_f32_16x16x32_bf16 v[52:55],a[224:227],a[152:155],v[52:55]
v_cvt_pk_bf16_f32 v100,v40,v41
v_mfma_f32_16x16x32_bf16 v[52:55],a[228:231],a[156:159],v[52:55]
v_exp_f32 v33,v33
v_mfma_f32_16x16x32_bf16 v[52:55],a[232:235],a[160:163],v[52:55]
v_cvt_pk_bf16_f32 v96,v32,v33
v_mfma_f32_16x16x32_bf16 v[52:55],a[236:239],a[164:167],v[52:55]
s_waitcnt lgkmcnt(0)
v_mfma_f32_16x16x32_bf16 v[160:163],a[240:243],v[112:115],v[160:163]
s_add_u32 m0,s23,0
ds_read_b128 a[192:195],v1 offset:0
v_fma_f32 v36,v36,s36,v16
v_mfma_f32_16x16x32_bf16 v[208:211],a[240:243],v[116:119],v[208:211]
buffer_load_dwordx4 v7,s[8:11],s21 offen offset:0 lds
v_mfma_f32_16x16x32_bf16 a[0:3],a[240:243],v[120:123],a[0:3]
ds_read_b64_tr_b16 a[240:241],v3 offset:12416
ds_read_b64_tr_b16 a[242:243],v3 offset:18560
v_mfma_f32_16x16x32_bf16 v[164:167],a[244:247],v[112:115],v[164:167]
ds_read_b128 a[196:199],v2 offset:0
v_fma_f32 v37,v37,s36,v16
v_mfma_f32_16x16x32_bf16 v[212:215],a[244:247],v[116:119],v[212:215]
ds_read_b128 a[200:203],v1 offset:128
v_fma_f32 v38,v38,s36,v16
v_mfma_f32_16x16x32_bf16 a[4:7],a[244:247],v[120:123],a[4:7]
ds_read_b64_tr_b16 a[244:245],v4 offset:12416
ds_read_b64_tr_b16 a[246:247],v4 offset:18560
v_mfma_f32_16x16x32_bf16 v[168:171],a[248:251],v[112:115],v[168:171]
ds_read_b128 a[204:207],v2 offset:128
v_fma_f32 v39,v39,s36,v16
v_mfma_f32_16x16x32_bf16 v[216:219],a[248:251],v[116:119],v[216:219]
buffer_load_dwordx4 v8,s[8:11],s21 offen offset:1024 lds
v_mfma_f32_16x16x32_bf16 a[8:11],a[248:251],v[120:123],a[8:11]
ds_read_b64_tr_b16 a[248:249],v5 offset:12416
ds_read_b64_tr_b16 a[250:251],v5 offset:18560
v_mfma_f32_16x16x32_bf16 v[172:175],a[252:255],v[112:115],v[172:175]
ds_read_b128 a[208:211],v1 offset:256
v_fma_f32 v44,v44,s36,v17
v_mfma_f32_16x16x32_bf16 v[220:223],a[252:255],v[116:119],v[220:223]
ds_read_b128 a[212:215],v2 offset:256
v_fma_f32 v45,v45,s36,v17
v_mfma_f32_16x16x32_bf16 a[12:15],a[252:255],v[120:123],a[12:15]
s_waitcnt lgkmcnt(8)
ds_read_b64_tr_b16 a[252:253],v6 offset:12416
ds_read_b64_tr_b16 a[254:255],v6 offset:18560
v_mfma_f32_16x16x32_bf16 v[176:179],a[240:243],v[112:115],v[176:179]
buffer_load_dwordx4 v9,s[8:11],s21 offen offset:2048 lds
v_mfma_f32_16x16x32_bf16 v[224:227],a[240:243],v[116:119],v[224:227]
s_add_u32 s21,s21,12288
ds_read_b128 a[216:219],v1 offset:6144
v_fma_f32 v46,v46,s36,v17
v_mfma_f32_16x16x32_bf16 a[16:19],a[240:243],v[120:123],a[16:19]
s_add_u32 m0,s26,0
ds_read_b64_tr_b16 a[240:241],v3 offset:12544
ds_read_b64_tr_b16 a[242:243],v3 offset:18688
s_waitcnt lgkmcnt(9)
v_mfma_f32_16x16x32_bf16 v[180:183],a[244:247],v[112:115],v[180:183]
ds_read_b128 a[220:223],v2 offset:6144
v_fma_f32 v47,v47,s36,v17
v_mfma_f32_16x16x32_bf16 v[228:231],a[244:247],v[116:119],v[228:231]
ds_read_b128 a[224:227],v1 offset:6272
v_fma_f32 v48,v48,s36,v18
v_mfma_f32_16x16x32_bf16 a[20:23],a[244:247],v[120:123],a[20:23]
s_waitcnt lgkmcnt(8)
ds_read_b64_tr_b16 a[244:245],v4 offset:12544
ds_read_b64_tr_b16 a[246:247],v4 offset:18688
v_mfma_f32_16x16x32_bf16 v[184:187],a[248:251],v[112:115],v[184:187]
buffer_load_dwordx4 v7,s[4:7],s20 offen offset:0 lds
v_mfma_f32_16x16x32_bf16 v[232:235],a[248:251],v[116:119],v[232:235]
ds_read_b128 a[228:231],v2 offset:6272
v_fma_f32 v49,v49,s36,v18
v_mfma_f32_16x16x32_bf16 a[24:27],a[248:251],v[120:123],a[24:27]
s_waitcnt lgkmcnt(8)
ds_read_b64_tr_b16 a[248:249],v5 offset:12544
ds_read_b64_tr_b16 a[250:251],v5 offset:18688
v_mfma_f32_16x16x32_bf16 v[188:191],a[252:255],v[112:115],v[188:191]
ds_read_b128 a[232:235],v1 offset:6400
v_fma_f32 v50,v50,s36,v18
v_mfma_f32_16x16x32_bf16 v[236:239],a[252:255],v[116:119],v[236:239]
ds_read_b128 a[236:239],v2 offset:6400
v_fma_f32 v51,v51,s36,v18
v_mfma_f32_16x16x32_bf16 a[28:31],a[252:255],v[120:123],a[28:31]
s_waitcnt lgkmcnt(8)
ds_read_b64_tr_b16 a[252:253],v6 offset:12544
ds_read_b64_tr_b16 a[254:255],v6 offset:18688
v_mfma_f32_16x16x32_bf16 v[192:195],a[240:243],v[112:115],v[192:195]
buffer_load_dwordx4 v8,s[4:7],s20 offen offset:1024 lds
v_mfma_f32_16x16x32_bf16 v[240:243],a[240:243],v[116:119],v[240:243]
v_fma_f32 v52,v52,s36,v18
v_fma_f32 v53,v53,s36,v18
v_mfma_f32_16x16x32_bf16 a[32:35],a[240:243],v[120:123],a[32:35]
s_waitcnt lgkmcnt(7)
v_fma_f32 v54,v54,s36,v18
v_fma_f32 v55,v55,s36,v18
v_mfma_f32_16x16x32_bf16 v[196:199],a[244:247],v[112:115],v[196:199]
v_exp_f32 v36,v36
v_mfma_f32_16x16x32_bf16 v[244:247],a[244:247],v[116:119],v[244:247]
v_exp_f32 v37,v37
v_mfma_f32_16x16x32_bf16 a[36:39],a[244:247],v[120:123],a[36:39]
s_waitcnt lgkmcnt(3)
v_exp_f32 v38,v38
v_mfma_f32_16x16x32_bf16 v[200:203],a[248:251],v[112:115],v[200:203]
buffer_load_dwordx4 v9,s[4:7],s20 offen offset:2048 lds
v_mfma_f32_16x16x32_bf16 v[248:251],a[248:251],v[116:119],v[248:251]
s_add_u32 s20,s20,12288
v_exp_f32 v39,v39
v_mfma_f32_16x16x32_bf16 a[40:43],a[248:251],v[120:123],a[40:43]
s_add_u32 m0,s29,0
v_exp_f32 v44,v44
s_waitcnt lgkmcnt(0)
v_mfma_f32_16x16x32_bf16 v[204:207],a[252:255],v[112:115],v[204:207]
v_exp_f32 v45,v45
v_mfma_f32_16x16x32_bf16 v[252:255],a[252:255],v[116:119],v[252:255]
v_exp_f32 v46,v46
v_mfma_f32_16x16x32_bf16 a[44:47],a[252:255],v[120:123],a[44:47]
v_exp_f32 v47,v47
v_mfma_f32_16x16x32_bf16 v[64:67],a[192:195],a[96:99],0
v_exp_f32 v48,v48
v_mfma_f32_16x16x32_bf16 v[64:67],a[196:199],a[100:103],v[64:67]
v_exp_f32 v49,v49
v_mfma_f32_16x16x32_bf16 v[64:67],a[200:203],a[104:107],v[64:67]
v_exp_f32 v50,v50
v_mfma_f32_16x16x32_bf16 v[64:67],a[204:207],a[108:111],v[64:67]
buffer_load_dwordx4 v7,s[12:15],s28 offen offset:0 nt lds
v_mfma_f32_16x16x32_bf16 v[64:67],a[208:211],a[112:115],v[64:67]
v_exp_f32 v51,v51
v_mfma_f32_16x16x32_bf16 v[64:67],a[212:215],a[116:119],v[64:67]
v_exp_f32 v52,v52
v_mfma_f32_16x16x32_bf16 v[72:75],a[192:195],a[120:123],0
v_exp_f32 v53,v53
v_mfma_f32_16x16x32_bf16 v[72:75],a[196:199],a[124:127],v[72:75]
v_exp_f32 v54,v54
v_mfma_f32_16x16x32_bf16 v[72:75],a[200:203],a[128:131],v[72:75]
v_exp_f32 v55,v55
v_mfma_f32_16x16x32_bf16 v[72:75],a[204:207],a[132:135],v[72:75]
v_cvt_pk_bf16_f32 v98,v36,v37
v_cvt_pk_bf16_f32 v99,v38,v39
v_mfma_f32_16x16x32_bf16 v[72:75],a[208:211],a[136:139],v[72:75]
v_cvt_pk_bf16_f32 v102,v44,v45
v_cvt_pk_bf16_f32 v103,v46,v47
v_mfma_f32_16x16x32_bf16 v[128:131],v[24:27],v[96:99],v[128:131]
v_cvt_pk_bf16_f32 v104,v48,v49
v_cvt_pk_bf16_f32 v105,v50,v51
v_mfma_f32_16x16x32_bf16 v[132:135],v[24:27],v[100:103],v[132:135]
buffer_load_dwordx4 v8,s[12:15],s28 offen offset:1024 nt lds
v_mfma_f32_16x16x32_bf16 v[72:75],a[212:215],a[140:143],v[72:75]
v_cvt_pk_bf16_f32 v106,v52,v53
v_cvt_pk_bf16_f32 v107,v54,v55
v_mfma_f32_16x16x32_bf16 v[80:83],a[192:195],a[144:147],0
v_fma_f32 v64,v64,s36,v16
v_fma_f32 v65,v65,s36,v16
v_mfma_f32_16x16x32_bf16 v[136:139],v[24:27],v[104:107],v[136:139]
v_fma_f32 v66,v66,s36,v16
v_fma_f32 v67,v67,s36,v16
v_mfma_f32_16x16x32_bf16 v[80:83],a[196:199],a[148:151],v[80:83]
v_fma_f32 v72,v72,s36,v17
v_fma_f32 v73,v73,s36,v17
v_mfma_f32_16x16x32_bf16 v[80:83],a[200:203],a[152:155],v[80:83]
v_fma_f32 v74,v74,s36,v17
v_fma_f32 v75,v75,s36,v17
v_mfma_f32_16x16x32_bf16 v[80:83],a[204:207],a[156:159],v[80:83]
v_exp_f32 v64,v64
v_mfma_f32_16x16x32_bf16 v[80:83],a[208:211],a[160:163],v[80:83]
v_exp_f32 v65,v65
v_mfma_f32_16x16x32_bf16 v[80:83],a[212:215],a[164:167],v[80:83]
buffer_load_dwordx4 v9,s[12:15],s28 offen offset:2048 nt lds
v_mfma_f32_16x16x32_bf16 v[68:71],a[216:219],a[96:99],0
s_add_u32 s28,s28,3072
v_exp_f32 v66,v66
v_mfma_f32_16x16x32_bf16 v[68:71],a[220:223],a[100:103],v[68:71]
s_add_u32 s29,s29,3072
s_mov_b32 s25,s30
s_add_u32 s26,s22,12288
s_add_u32 s38,s38,1
s_cmp_lt_u32 s38,2
v_mfma_f32_16x16x32_bf16 v[68:71],a[224:227],a[104:107],v[68:71]
v_exp_f32 v67,v67
s_waitcnt vmcnt(12)
v_mfma_f32_16x16x32_bf16 v[68:71],a[228:231],a[108:111],v[68:71]
s_barrier
v_mfma_f32_16x16x32_bf16 v[68:71],a[232:235],a[112:115],v[68:71]
ds_read_b64_tr_b16 a[240:241],v3 offset:24576
ds_read_b64_tr_b16 a[242:243],v3 offset:30720
v_mfma_f32_16x16x32_bf16 v[68:71],a[236:239],a[116:119],v[68:71]
v_exp_f32 v72,v72
v_mfma_f32_16x16x32_bf16 v[76:79],a[216:219],a[120:123],0
ds_read_b64_tr_b16 a[244:245],v4 offset:24576
ds_read_b64_tr_b16 a[246:247],v4 offset:30720
v_mfma_f32_16x16x32_bf16 v[76:79],a[220:223],a[124:127],v[76:79]
ds_read_b64_tr_b16 a[248:249],v5 offset:24576
ds_read_b64_tr_b16 a[250:251],v5 offset:30720
v_mfma_f32_16x16x32_bf16 v[76:79],a[224:227],a[128:131],v[76:79]
v_exp_f32 v73,v73
v_mfma_f32_16x16x32_bf16 v[76:79],a[228:231],a[132:135],v[76:79]
ds_read_b64_tr_b16 a[252:253],v6 offset:24576
ds_read_b64_tr_b16 a[254:255],v6 offset:30720
v_mfma_f32_16x16x32_bf16 v[76:79],a[232:235],a[136:139],v[76:79]
v_exp_f32 v74,v74
v_mfma_f32_16x16x32_bf16 v[76:79],a[236:239],a[140:143],v[76:79]
v_exp_f32 v75,v75
v_mfma_f32_16x16x32_bf16 v[84:87],a[216:219],a[144:147],0
v_cvt_pk_bf16_f32 v112,v64,v65
v_cvt_pk_bf16_f32 v113,v66,v67
v_mfma_f32_16x16x32_bf16 v[84:87],a[220:223],a[148:151],v[84:87]
v_cvt_pk_bf16_f32 v116,v72,v73
v_cvt_pk_bf16_f32 v117,v74,v75
v_mfma_f32_16x16x32_bf16 v[84:87],a[224:227],a[152:155],v[84:87]
v_add_u32 v11,9216,v11
v_add_u32 v23,9216,v23
v_mfma_f32_16x16x32_bf16 v[84:87],a[228:231],a[156:159],v[84:87]
v_add_u32 v31,9216,v31
v_mfma_f32_16x16x32_bf16 v[84:87],a[232:235],a[160:163],v[84:87]
v_mfma_f32_16x16x32_bf16 v[84:87],a[236:239],a[164:167],v[84:87]
s_cbranch_scc1 L_loop3w0
s_cmp_ge_u32 s69,8
s_cbranch_scc1 L_end3
s_cmp_eq_u32 s40,0
s_cbranch_scc1 L_tr33
s_branch L_tr34
.p2align 6
L_loop3w1:
s_waitcnt lgkmcnt(4)
v_mfma_f32_16x16x32_bf16 v[160:163],a[240:243],v[96:99],v[160:163]
s_add_u32 m0,s23,12288
ds_read_b128 a[192:195],v1 offset:12288
v_fma_f32 v80,v80,s36,v18
v_mfma_f32_16x16x32_bf16 v[208:211],a[240:243],v[100:103],v[208:211]
buffer_load_dwordx4 v7,s[8:11],s21 offen offset:0 lds
v_mfma_f32_16x16x32_bf16 a[0:3],a[240:243],v[104:107],a[0:3]
ds_read_b64_tr_b16 a[242:243],v3 offset:30848
ds_read_b64_tr_b16 a[240:241],v3 offset:24704
v_mfma_f32_16x16x32_bf16 v[164:167],a[244:247],v[96:99],v[164:167]
ds_read_b128 a[196:199],v2 offset:12288
v_fma_f32 v87,v87,s36,v18
v_mfma_f32_16x16x32_bf16 v[212:215],a[244:247],v[100:103],v[212:215]
ds_read_b128 a[200:203],v1 offset:12416
v_fma_f32 v79,v79,s36,v17
v_mfma_f32_16x16x32_bf16 a[4:7],a[244:247],v[104:107],a[4:7]
s_waitcnt lgkmcnt(5)
ds_read_b64_tr_b16 a[244:245],v4 offset:24704
ds_read_b64_tr_b16 a[246:247],v4 offset:30848
v_mfma_f32_16x16x32_bf16 v[168:171],a[248:251],v[96:99],v[168:171]
ds_read_b128 a[204:207],v2 offset:12416
v_fma_f32 v85,v85,s36,v18
v_mfma_f32_16x16x32_bf16 v[216:219],a[248:251],v[100:103],v[216:219]
buffer_load_dwordx4 v8,s[8:11],s21 offen offset:1024 lds
v_mfma_f32_16x16x32_bf16 a[8:11],a[248:251],v[104:107],a[8:11]
ds_read_b64_tr_b16 a[248:249],v5 offset:24704
ds_read_b64_tr_b16 a[250:251],v5 offset:30848
v_mfma_f32_16x16x32_bf16 v[172:175],a[252:255],v[96:99],v[172:175]
ds_read_b128 a[208:211],v1 offset:12544
v_fma_f32 v68,v68,s36,v16
v_mfma_f32_16x16x32_bf16 v[220:223],a[252:255],v[100:103],v[220:223]
ds_read_b128 a[212:215],v2 offset:12544
v_fma_f32 v76,v76,s36,v17
v_mfma_f32_16x16x32_bf16 a[12:15],a[252:255],v[104:107],a[12:15]
s_waitcnt lgkmcnt(8)
ds_read_b64_tr_b16 a[252:253],v6 offset:24704
ds_read_b64_tr_b16 a[254:255],v6 offset:30848
v_mfma_f32_16x16x32_bf16 v[176:179],a[240:243],v[96:99],v[176:179]
buffer_load_dwordx4 v9,s[8:11],s21 offen offset:2048 lds
v_mfma_f32_16x16x32_bf16 v[224:227],a[240:243],v[100:103],v[224:227]
s_add_u32 s21,s21,12288
ds_read_b128 a[216:219],v1 offset:18432
v_fma_f32 v78,v78,s36,v17
v_mfma_f32_16x16x32_bf16 a[16:19],a[240:243],v[104:107],a[16:19]
s_add_u32 m0,s22,0
ds_read_b64_tr_b16 a[240:241],v3 offset:24832
ds_read_b64_tr_b16 a[242:243],v3 offset:30976
s_waitcnt lgkmcnt(9)
v_mfma_f32_16x16x32_bf16 v[180:183],a[244:247],v[96:99],v[180:183]
ds_read_b128 a[220:223],v2 offset:18432
v_fma_f32 v84,v84,s36,v18
v_mfma_f32_16x16x32_bf16 v[228:231],a[244:247],v[100:103],v[228:231]
ds_read_b128 a[224:227],v1 offset:18560
v_fma_f32 v69,v69,s36,v16
v_mfma_f32_16x16x32_bf16 a[20:23],a[244:247],v[104:107],a[20:23]
s_waitcnt lgkmcnt(8)
ds_read_b64_tr_b16 a[246:247],v4 offset:30976
ds_read_b64_tr_b16 a[244:245],v4 offset:24832
v_mfma_f32_16x16x32_bf16 v[184:187],a[248:251],v[96:99],v[184:187]
buffer_load_dwordx4 v7,s[4:7],s20 offen offset:0 lds
v_mfma_f32_16x16x32_bf16 v[232:235],a[248:251],v[100:103],v[232:235]
ds_read_b128 a[228:231],v2 offset:18560
v_fma_f32 v83,v83,s36,v18
v_mfma_f32_16x16x32_bf16 a[24:27],a[248:251],v[104:107],a[24:27]
s_waitcnt lgkmcnt(8)
ds_read_b64_tr_b16 a[250:251],v5 offset:30976
ds_read_b64_tr_b16 a[248:249],v5 offset:24832
v_mfma_f32_16x16x32_bf16 v[188:191],a[252:255],v[96:99],v[188:191]
ds_read_b128 a[232:235],v1 offset:18688
v_fma_f32 v81,v81,s36,v18
v_mfma_f32_16x16x32_bf16 v[236:239],a[252:255],v[100:103],v[236:239]
ds_read_b128 a[236:239],v2 offset:18688
v_fma_f32 v77,v77,s36,v17
v_mfma_f32_16x16x32_bf16 a[28:31],a[252:255],v[104:107],a[28:31]
s_waitcnt lgkmcnt(8)
ds_read_b64_tr_b16 a[252:253],v6 offset:24832
ds_read_b64_tr_b16 a[254:255],v6 offset:30976
v_mfma_f32_16x16x32_bf16 v[192:195],a[240:243],v[96:99],v[192:195]
buffer_load_dwordx4 v8,s[4:7],s20 offen offset:1024 lds
v_mfma_f32_16x16x32_bf16 v[240:243],a[240:243],v[100:103],v[240:243]
ds_read_b128 v[156:159],v11 offset:0
v_fma_f32 v71,v71,s36,v16
v_mfma_f32_16x16x32_bf16 a[32:35],a[240:243],v[104:107],a[32:35]
s_waitcnt lgkmcnt(8)
v_exp_f32 v78,v78
v_mfma_f32_16x16x32_bf16 v[196:199],a[244:247],v[96:99],v[196:199]
v_exp_f32 v76,v76
v_mfma_f32_16x16x32_bf16 v[244:247],a[244:247],v[100:103],v[244:247]
v_exp_f32 v85,v85
v_mfma_f32_16x16x32_bf16 a[36:39],a[244:247],v[104:107],a[36:39]
s_waitcnt lgkmcnt(4)
v_exp_f32 v71,v71
v_mfma_f32_16x16x32_bf16 v[200:203],a[248:251],v[96:99],v[200:203]
buffer_load_dwordx4 v9,s[4:7],s20 offen offset:2048 lds
v_mfma_f32_16x16x32_bf16 v[248:251],a[248:251],v[100:103],v[248:251]
s_add_u32 s20,s20,12288
v_exp_f32 v81,v81
v_mfma_f32_16x16x32_bf16 a[40:43],a[248:251],v[104:107],a[40:43]
s_waitcnt lgkmcnt(1)
ds_read_b128 v[152:155],v23 offset:0
v_fma_f32 v82,v82,s36,v18
v_mfma_f32_16x16x32_bf16 v[204:207],a[252:255],v[96:99],v[204:207]
v_exp_f32 v83,v83
v_mfma_f32_16x16x32_bf16 v[252:255],a[252:255],v[100:103],v[252:255]
v_exp_f32 v87,v87
v_mfma_f32_16x16x32_bf16 a[44:47],a[252:255],v[104:107],a[44:47]
v_exp_f32 v77,v77
v_mfma_f32_16x16x32_bf16 v[32:35],a[192:195],a[96:99],0
v_exp_f32 v80,v80
v_mfma_f32_16x16x32_bf16 v[32:35],a[196:199],a[100:103],v[32:35]
v_exp_f32 v79,v79
v_mfma_f32_16x16x32_bf16 v[32:35],a[200:203],a[104:107],v[32:35]
v_exp_f32 v68,v68
v_mfma_f32_16x16x32_bf16 v[32:35],a[204:207],a[108:111],v[32:35]
s_waitcnt lgkmcnt(1)
buffer_store_dwordx4 v[156:159],v0,s[16:19],s27 offen offset:0 nt
v_exp_f32 v69,v69
v_fma_f32 v86,v86,s36,v18
v_mfma_f32_16x16x32_bf16 v[32:35],a[208:211],a[112:115],v[32:35]
ds_read_b128 v[156:159],v31 offset:0
v_cvt_pk_bf16_f32 v114,v68,v69
v_mfma_f32_16x16x32_bf16 v[32:35],a[212:215],a[116:119],v[32:35]
v_exp_f32 v86,v86
v_mfma_f32_16x16x32_bf16 v[40:43],a[192:195],a[120:123],0
v_exp_f32 v84,v84
v_mfma_f32_16x16x32_bf16 v[40:43],a[196:199],a[124:127],v[40:43]
v_exp_f32 v82,v82
v_mfma_f32_16x16x32_bf16 v[40:43],a[200:203],a[128:131],v[40:43]
v_cvt_pk_bf16_f32 v121,v82,v83
v_fma_f32 v70,v70,s36,v16
v_mfma_f32_16x16x32_bf16 v[40:43],a[204:207],a[132:135],v[40:43]
v_exp_f32 v70,v70
v_mfma_f32_16x16x32_bf16 v[40:43],a[208:211],a[136:139],v[40:43]
v_cvt_pk_bf16_f32 v122,v84,v85
v_cvt_pk_bf16_f32 v123,v86,v87
v_mfma_f32_16x16x32_bf16 v[40:43],a[212:215],a[140:143],v[40:43]
s_waitcnt lgkmcnt(1)
buffer_store_dwordx4 v[152:155],v0,s[16:19],s27 offen offset:1024 nt
v_cvt_pk_bf16_f32 v118,v76,v77
v_fma_f32 v35,v35,s36,v16
v_cvt_pk_bf16_f32 v119,v78,v79
v_mfma_f32_16x16x32_bf16 v[48:51],a[192:195],a[144:147],0
v_exp_f32 v35,v35
v_mfma_f32_16x16x32_bf16 v[132:135],v[24:27],v[116:119],v[132:135]
v_fma_f32 v33,v33,s36,v16
v_fma_f32 v41,v41,s36,v17
v_mfma_f32_16x16x32_bf16 v[48:51],a[196:199],a[148:151],v[48:51]
v_exp_f32 v41,v41
v_mfma_f32_16x16x32_bf16 v[48:51],a[200:203],a[152:155],v[48:51]
v_exp_f32 v33,v33
v_mfma_f32_16x16x32_bf16 v[48:51],a[204:207],a[156:159],v[48:51]
v_fma_f32 v43,v43,s36,v17
v_fma_f32 v40,v40,s36,v17
v_mfma_f32_16x16x32_bf16 v[48:51],a[208:211],a[160:163],v[48:51]
v_exp_f32 v40,v40
v_mfma_f32_16x16x32_bf16 v[48:51],a[212:215],a[164:167],v[48:51]
s_waitcnt vmcnt(8)
s_waitcnt lgkmcnt(0)
buffer_store_dwordx4 v[156:159],v0,s[16:19],s27 offen offset:2048 nt
v_exp_f32 v43,v43
v_fma_f32 v42,v42,s36,v17
v_mfma_f32_16x16x32_bf16 v[36:39],a[216:219],a[96:99],0
s_barrier
v_mfma_f32_16x16x32_bf16 v[36:39],a[220:223],a[100:103],v[36:39]
s_add_u32 s27,s27,3072
v_exp_f32 v42,v42
v_mfma_f32_16x16x32_bf16 v[36:39],a[224:227],a[104:107],v[36:39]
v_cvt_pk_bf16_f32 v115,v70,v71
v_fma_f32 v34,v34,s36,v16
v_mfma_f32_16x16x32_bf16 v[36:39],a[228:231],a[108:111],v[36:39]
v_exp_f32 v34,v34
v_mfma_f32_16x16x32_bf16 v[128:131],v[24:27],v[112:115],v[128:131]
ds_read_b64_tr_b16 a[242:243],v3 offset:6144
v_mfma_f32_16x16x32_bf16 v[36:39],a[232:235],a[112:115],v[36:39]
ds_read_b64_tr_b16 a[240:241],v3 offset:0
v_cvt_pk_bf16_f32 v120,v80,v81
v_mfma_f32_16x16x32_bf16 v[36:39],a[236:239],a[116:119],v[36:39]
ds_read_b64_tr_b16 a[244:245],v4 offset:0
ds_read_b64_tr_b16 a[246:247],v4 offset:6144
v_mfma_f32_16x16x32_bf16 v[136:139],v[24:27],v[120:123],v[136:139]
ds_read_b64_tr_b16 a[250:251],v5 offset:6144
v_mfma_f32_16x16x32_bf16 v[44:47],a[216:219],a[120:123],0
ds_read_b64_tr_b16 a[248:249],v5 offset:0
v_cvt_pk_bf16_f32 v100,v40,v41
v_mfma_f32_16x16x32_bf16 v[44:47],a[220:223],a[124:127],v[44:47]
ds_read_b64_tr_b16 a[254:255],v6 offset:6144
ds_read_b64_tr_b16 a[252:253],v6 offset:0
v_mfma_f32_16x16x32_bf16 v[44:47],a[224:227],a[128:131],v[44:47]
v_fma_f32 v32,v32,s36,v16
v_cvt_pk_bf16_f32 v101,v42,v43
v_mfma_f32_16x16x32_bf16 v[44:47],a[228:231],a[132:135],v[44:47]
v_exp_f32 v32,v32
v_mfma_f32_16x16x32_bf16 v[44:47],a[232:235],a[136:139],v[44:47]
v_cvt_pk_bf16_f32 v96,v32,v33
v_cvt_pk_bf16_f32 v97,v34,v35
v_mfma_f32_16x16x32_bf16 v[44:47],a[236:239],a[140:143],v[44:47]
v_mfma_f32_16x16x32_bf16 v[52:55],a[216:219],a[144:147],0
v_mfma_f32_16x16x32_bf16 v[52:55],a[220:223],a[148:151],v[52:55]
v_mfma_f32_16x16x32_bf16 v[52:55],a[224:227],a[152:155],v[52:55]
v_mfma_f32_16x16x32_bf16 v[52:55],a[228:231],a[156:159],v[52:55]
v_mfma_f32_16x16x32_bf16 v[52:55],a[232:235],a[160:163],v[52:55]
v_mfma_f32_16x16x32_bf16 v[52:55],a[236:239],a[164:167],v[52:55]
s_waitcnt lgkmcnt(0)
v_mfma_f32_16x16x32_bf16 v[160:163],a[240:243],v[112:115],v[160:163]
s_add_u32 m0,s23,24576
ds_read_b128 a[192:195],v1 offset:24576
v_fma_f32 v36,v36,s36,v16
v_mfma_f32_16x16x32_bf16 v[208:211],a[240:243],v[116:119],v[208:211]
buffer_load_dwordx4 v7,s[8:11],s21 offen offset:0 lds
v_mfma_f32_16x16x32_bf16 a[0:3],a[240:243],v[120:123],a[0:3]
ds_read_b64_tr_b16 a[240:241],v3 offset:128
ds_read_b64_tr_b16 a[242:243],v3 offset:6272
v_mfma_f32_16x16x32_bf16 v[164:167],a[244:247],v[112:115],v[164:167]
ds_read_b128 a[196:199],v2 offset:24576
v_fma_f32 v37,v37,s36,v16
v_mfma_f32_16x16x32_bf16 v[212:215],a[244:247],v[116:119],v[212:215]
ds_read_b128 a[200:203],v1 offset:24704
v_fma_f32 v38,v38,s36,v16
v_mfma_f32_16x16x32_bf16 a[4:7],a[244:247],v[120:123],a[4:7]
ds_read_b64_tr_b16 a[244:245],v4 offset:128
ds_read_b64_tr_b16 a[246:247],v4 offset:6272
v_mfma_f32_16x16x32_bf16 v[168:171],a[248:251],v[112:115],v[168:171]
ds_read_b128 a[204:207],v2 offset:24704
v_fma_f32 v39,v39,s36,v16
v_mfma_f32_16x16x32_bf16 v[216:219],a[248:251],v[116:119],v[216:219]
buffer_load_dwordx4 v8,s[8:11],s21 offen offset:1024 lds
v_mfma_f32_16x16x32_bf16 a[8:11],a[248:251],v[120:123],a[8:11]
ds_read_b64_tr_b16 a[248:249],v5 offset:128
ds_read_b64_tr_b16 a[250:251],v5 offset:6272
v_mfma_f32_16x16x32_bf16 v[172:175],a[252:255],v[112:115],v[172:175]
ds_read_b128 a[208:211],v1 offset:24832
v_fma_f32 v44,v44,s36,v17
v_mfma_f32_16x16x32_bf16 v[220:223],a[252:255],v[116:119],v[220:223]
ds_read_b128 a[212:215],v2 offset:24832
v_fma_f32 v45,v45,s36,v17
v_mfma_f32_16x16x32_bf16 a[12:15],a[252:255],v[120:123],a[12:15]
s_waitcnt lgkmcnt(8)
ds_read_b64_tr_b16 a[252:253],v6 offset:128
ds_read_b64_tr_b16 a[254:255],v6 offset:6272
v_mfma_f32_16x16x32_bf16 v[176:179],a[240:243],v[112:115],v[176:179]
buffer_load_dwordx4 v9,s[8:11],s21 offen offset:2048 lds
v_mfma_f32_16x16x32_bf16 v[224:227],a[240:243],v[116:119],v[224:227]
s_add_u32 s21,s21,12288
ds_read_b128 a[216:219],v1 offset:30720
v_fma_f32 v46,v46,s36,v17
v_mfma_f32_16x16x32_bf16 a[16:19],a[240:243],v[120:123],a[16:19]
s_add_u32 m0,s22,12288
ds_read_b64_tr_b16 a[240:241],v3 offset:256
ds_read_b64_tr_b16 a[242:243],v3 offset:6400
s_waitcnt lgkmcnt(9)
v_mfma_f32_16x16x32_bf16 v[180:183],a[244:247],v[112:115],v[180:183]
ds_read_b128 a[220:223],v2 offset:30720
v_fma_f32 v47,v47,s36,v17
v_mfma_f32_16x16x32_bf16 v[228:231],a[244:247],v[116:119],v[228:231]
ds_read_b128 a[224:227],v1 offset:30848
v_fma_f32 v48,v48,s36,v18
v_mfma_f32_16x16x32_bf16 a[20:23],a[244:247],v[120:123],a[20:23]
s_waitcnt lgkmcnt(8)
ds_read_b64_tr_b16 a[244:245],v4 offset:256
ds_read_b64_tr_b16 a[246:247],v4 offset:6400
v_mfma_f32_16x16x32_bf16 v[184:187],a[248:251],v[112:115],v[184:187]
buffer_load_dwordx4 v7,s[4:7],s20 offen offset:0 lds
v_mfma_f32_16x16x32_bf16 v[232:235],a[248:251],v[116:119],v[232:235]
ds_read_b128 a[228:231],v2 offset:30848
v_fma_f32 v49,v49,s36,v18
v_mfma_f32_16x16x32_bf16 a[24:27],a[248:251],v[120:123],a[24:27]
s_waitcnt lgkmcnt(8)
ds_read_b64_tr_b16 a[248:249],v5 offset:256
ds_read_b64_tr_b16 a[250:251],v5 offset:6400
v_mfma_f32_16x16x32_bf16 v[188:191],a[252:255],v[112:115],v[188:191]
ds_read_b128 a[232:235],v1 offset:30976
v_fma_f32 v50,v50,s36,v18
v_mfma_f32_16x16x32_bf16 v[236:239],a[252:255],v[116:119],v[236:239]
ds_read_b128 a[236:239],v2 offset:30976
v_fma_f32 v51,v51,s36,v18
v_mfma_f32_16x16x32_bf16 a[28:31],a[252:255],v[120:123],a[28:31]
s_waitcnt lgkmcnt(8)
ds_read_b64_tr_b16 a[252:253],v6 offset:256
ds_read_b64_tr_b16 a[254:255],v6 offset:6400
v_mfma_f32_16x16x32_bf16 v[192:195],a[240:243],v[112:115],v[192:195]
buffer_load_dwordx4 v8,s[4:7],s20 offen offset:1024 lds
v_mfma_f32_16x16x32_bf16 v[240:243],a[240:243],v[116:119],v[240:243]
v_fma_f32 v52,v52,s36,v18
v_fma_f32 v53,v53,s36,v18
v_mfma_f32_16x16x32_bf16 a[32:35],a[240:243],v[120:123],a[32:35]
s_waitcnt lgkmcnt(7)
v_fma_f32 v54,v54,s36,v18
v_fma_f32 v55,v55,s36,v18
v_mfma_f32_16x16x32_bf16 v[196:199],a[244:247],v[112:115],v[196:199]
v_exp_f32 v36,v36
v_mfma_f32_16x16x32_bf16 v[244:247],a[244:247],v[116:119],v[244:247]
v_exp_f32 v37,v37
v_mfma_f32_16x16x32_bf16 a[36:39],a[244:247],v[120:123],a[36:39]
s_waitcnt lgkmcnt(3)
v_exp_f32 v38,v38
v_mfma_f32_16x16x32_bf16 v[200:203],a[248:251],v[112:115],v[200:203]
buffer_load_dwordx4 v9,s[4:7],s20 offen offset:2048 lds
v_mfma_f32_16x16x32_bf16 v[248:251],a[248:251],v[116:119],v[248:251]
s_add_u32 s20,s20,12288
v_exp_f32 v39,v39
v_mfma_f32_16x16x32_bf16 a[40:43],a[248:251],v[120:123],a[40:43]
s_add_u32 m0,s29,0
v_exp_f32 v44,v44
s_waitcnt lgkmcnt(0)
v_mfma_f32_16x16x32_bf16 v[204:207],a[252:255],v[112:115],v[204:207]
v_exp_f32 v45,v45
v_mfma_f32_16x16x32_bf16 v[252:255],a[252:255],v[116:119],v[252:255]
v_exp_f32 v46,v46
v_mfma_f32_16x16x32_bf16 a[44:47],a[252:255],v[120:123],a[44:47]
v_exp_f32 v47,v47
v_mfma_f32_16x16x32_bf16 v[64:67],a[192:195],a[96:99],0
v_exp_f32 v48,v48
v_mfma_f32_16x16x32_bf16 v[64:67],a[196:199],a[100:103],v[64:67]
v_exp_f32 v49,v49
v_mfma_f32_16x16x32_bf16 v[64:67],a[200:203],a[104:107],v[64:67]
v_exp_f32 v50,v50
v_mfma_f32_16x16x32_bf16 v[64:67],a[204:207],a[108:111],v[64:67]
buffer_load_dwordx4 v7,s[12:15],s28 offen offset:0 nt lds
v_mfma_f32_16x16x32_bf16 v[64:67],a[208:211],a[112:115],v[64:67]
v_exp_f32 v51,v51
v_mfma_f32_16x16x32_bf16 v[64:67],a[212:215],a[116:119],v[64:67]
v_exp_f32 v52,v52
v_mfma_f32_16x16x32_bf16 v[72:75],a[192:195],a[120:123],0
v_exp_f32 v53,v53
v_mfma_f32_16x16x32_bf16 v[72:75],a[196:199],a[124:127],v[72:75]
v_exp_f32 v54,v54
v_mfma_f32_16x16x32_bf16 v[72:75],a[200:203],a[128:131],v[72:75]
v_exp_f32 v55,v55
v_mfma_f32_16x16x32_bf16 v[72:75],a[204:207],a[132:135],v[72:75]
v_cvt_pk_bf16_f32 v98,v36,v37
v_cvt_pk_bf16_f32 v99,v38,v39
v_mfma_f32_16x16x32_bf16 v[72:75],a[208:211],a[136:139],v[72:75]
v_cvt_pk_bf16_f32 v102,v44,v45
v_cvt_pk_bf16_f32 v103,v46,v47
v_mfma_f32_16x16x32_bf16 v[128:131],v[24:27],v[96:99],v[128:131]
v_cvt_pk_bf16_f32 v104,v48,v49
v_cvt_pk_bf16_f32 v105,v50,v51
v_mfma_f32_16x16x32_bf16 v[132:135],v[24:27],v[100:103],v[132:135]
buffer_load_dwordx4 v8,s[12:15],s28 offen offset:1024 nt lds
v_mfma_f32_16x16x32_bf16 v[72:75],a[212:215],a[140:143],v[72:75]
v_cvt_pk_bf16_f32 v106,v52,v53
v_cvt_pk_bf16_f32 v107,v54,v55
v_mfma_f32_16x16x32_bf16 v[80:83],a[192:195],a[144:147],0
v_fma_f32 v64,v64,s36,v16
v_fma_f32 v65,v65,s36,v16
v_mfma_f32_16x16x32_bf16 v[136:139],v[24:27],v[104:107],v[136:139]
v_fma_f32 v66,v66,s36,v16
v_fma_f32 v67,v67,s36,v16
v_mfma_f32_16x16x32_bf16 v[80:83],a[196:199],a[148:151],v[80:83]
v_fma_f32 v72,v72,s36,v17
v_fma_f32 v73,v73,s36,v17
v_mfma_f32_16x16x32_bf16 v[80:83],a[200:203],a[152:155],v[80:83]
v_fma_f32 v74,v74,s36,v17
v_fma_f32 v75,v75,s36,v17
v_mfma_f32_16x16x32_bf16 v[80:83],a[204:207],a[156:159],v[80:83]
v_exp_f32 v64,v64
v_mfma_f32_16x16x32_bf16 v[80:83],a[208:211],a[160:163],v[80:83]
s_waitcnt vmcnt(11)
buffer_load_dwordx4 v9,s[12:15],s28 offen offset:2048 nt lds
v_mfma_f32_16x16x32_bf16 v[80:83],a[212:215],a[164:167],v[80:83]
s_barrier
v_mfma_f32_16x16x32_bf16 v[68:71],a[216:219],a[96:99],0
s_add_u32 s28,s28,3072
v_exp_f32 v65,v65
v_mfma_f32_16x16x32_bf16 v[68:71],a[220:223],a[100:103],v[68:71]
s_add_u32 s29,s29,3072
v_exp_f32 v66,v66
v_mfma_f32_16x16x32_bf16 v[68:71],a[224:227],a[104:107],v[68:71]
v_exp_f32 v67,v67
v_mfma_f32_16x16x32_bf16 v[68:71],a[228:231],a[108:111],v[68:71]
v_exp_f32 v72,v72
v_mfma_f32_16x16x32_bf16 v[68:71],a[232:235],a[112:115],v[68:71]
ds_read_b64_tr_b16 a[240:241],v3 offset:12288
ds_read_b64_tr_b16 a[242:243],v3 offset:18432
v_mfma_f32_16x16x32_bf16 v[68:71],a[236:239],a[116:119],v[68:71]
ds_read_b64_tr_b16 a[244:245],v4 offset:12288
v_mfma_f32_16x16x32_bf16 v[76:79],a[216:219],a[120:123],0
ds_read_b64_tr_b16 a[246:247],v4 offset:18432
v_cvt_pk_bf16_f32 v112,v64,v65
v_mfma_f32_16x16x32_bf16 v[76:79],a[220:223],a[124:127],v[76:79]
ds_read_b64_tr_b16 a[248:249],v5 offset:12288
ds_read_b64_tr_b16 a[250:251],v5 offset:18432
v_mfma_f32_16x16x32_bf16 v[76:79],a[224:227],a[128:131],v[76:79]
ds_read_b64_tr_b16 a[252:253],v6 offset:12288
v_mfma_f32_16x16x32_bf16 v[76:79],a[228:231],a[132:135],v[76:79]
ds_read_b64_tr_b16 a[254:255],v6 offset:18432
v_cvt_pk_bf16_f32 v113,v66,v67
v_mfma_f32_16x16x32_bf16 v[76:79],a[232:235],a[136:139],v[76:79]
v_exp_f32 v73,v73
v_mfma_f32_16x16x32_bf16 v[76:79],a[236:239],a[140:143],v[76:79]
v_exp_f32 v74,v74
v_mfma_f32_16x16x32_bf16 v[84:87],a[216:219],a[144:147],0
v_exp_f32 v75,v75
v_mfma_f32_16x16x32_bf16 v[84:87],a[220:223],a[148:151],v[84:87]
v_cvt_pk_bf16_f32 v116,v72,v73
v_cvt_pk_bf16_f32 v117,v74,v75
v_mfma_f32_16x16x32_bf16 v[84:87],a[224:227],a[152:155],v[84:87]
v_mfma_f32_16x16x32_bf16 v[84:87],a[228:231],a[156:159],v[84:87]
v_mfma_f32_16x16x32_bf16 v[84:87],a[232:235],a[160:163],v[84:87]
v_mfma_f32_16x16x32_bf16 v[84:87],a[236:239],a[164:167],v[84:87]
s_waitcnt lgkmcnt(1)
v_mfma_f32_16x16x32_bf16 v[160:163],a[240:243],v[96:99],v[160:163]
s_add_u32 m0,s23,0
ds_read_b128 a[192:195],v1 offset:0
v_fma_f32 v80,v80,s36,v18
v_mfma_f32_16x16x32_bf16 v[208:211],a[240:243],v[100:103],v[208:211]
buffer_load_dwordx4 v7,s[8:11],s21 offen offset:0 lds
v_mfma_f32_16x16x32_bf16 a[0:3],a[240:243],v[104:107],a[0:3]
ds_read_b64_tr_b16 a[242:243],v3 offset:18560
ds_read_b64_tr_b16 a[240:241],v3 offset:12416
v_mfma_f32_16x16x32_bf16 v[164:167],a[244:247],v[96:99],v[164:167]
ds_read_b128 a[196:199],v2 offset:0
v_fma_f32 v87,v87,s36,v18
v_mfma_f32_16x16x32_bf16 v[212:215],a[244:247],v[100:103],v[212:215]
ds_read_b128 a[200:203],v1 offset:128
v_fma_f32 v79,v79,s36,v17
v_mfma_f32_16x16x32_bf16 a[4:7],a[244:247],v[104:107],a[4:7]
ds_read_b64_tr_b16 a[244:245],v4 offset:12416
ds_read_b64_tr_b16 a[246:247],v4 offset:18560
v_mfma_f32_16x16x32_bf16 v[168:171],a[248:251],v[96:99],v[168:171]
ds_read_b128 a[204:207],v2 offset:128
v_fma_f32 v85,v85,s36,v18
v_mfma_f32_16x16x32_bf16 v[216:219],a[248:251],v[100:103],v[216:219]
buffer_load_dwordx4 v8,s[8:11],s21 offen offset:1024 lds
v_mfma_f32_16x16x32_bf16 a[8:11],a[248:251],v[104:107],a[8:11]
s_waitcnt lgkmcnt(7)
ds_read_b64_tr_b16 a[248:249],v5 offset:12416
ds_read_b64_tr_b16 a[250:251],v5 offset:18560
v_mfma_f32_16x16x32_bf16 v[172:175],a[252:255],v[96:99],v[172:175]
ds_read_b128 a[208:211],v1 offset:256
v_fma_f32 v68,v68,s36,v16
v_mfma_f32_16x16x32_bf16 v[220:223],a[252:255],v[100:103],v[220:223]
ds_read_b128 a[212:215],v2 offset:256
v_fma_f32 v76,v76,s36,v17
v_mfma_f32_16x16x32_bf16 a[12:15],a[252:255],v[104:107],a[12:15]
s_waitcnt lgkmcnt(8)
ds_read_b64_tr_b16 a[252:253],v6 offset:12416
ds_read_b64_tr_b16 a[254:255],v6 offset:18560
v_mfma_f32_16x16x32_bf16 v[176:179],a[240:243],v[96:99],v[176:179]
buffer_load_dwordx4 v9,s[8:11],s21 offen offset:2048 lds
v_mfma_f32_16x16x32_bf16 v[224:227],a[240:243],v[100:103],v[224:227]
s_add_u32 s21,s21,12288
ds_read_b128 a[216:219],v1 offset:6144
v_fma_f32 v78,v78,s36,v17
v_mfma_f32_16x16x32_bf16 a[16:19],a[240:243],v[104:107],a[16:19]
s_add_u32 m0,s22,24576
ds_read_b64_tr_b16 a[240:241],v3 offset:12544
ds_read_b64_tr_b16 a[242:243],v3 offset:18688
s_waitcnt lgkmcnt(9)
v_mfma_f32_16x16x32_bf16 v[180:183],a[244:247],v[96:99],v[180:183]
ds_read_b128 a[220:223],v2 offset:6144
v_fma_f32 v84,v84,s36,v18
v_mfma_f32_16x16x32_bf16 v[228:231],a[244:247],v[100:103],v[228:231]
ds_read_b128 a[224:227],v1 offset:6272
v_fma_f32 v69,v69,s36,v16
v_mfma_f32_16x16x32_bf16 a[20:23],a[244:247],v[104:107],a[20:23]
s_waitcnt lgkmcnt(8)
ds_read_b64_tr_b16 a[246:247],v4 offset:18688
ds_read_b64_tr_b16 a[244:245],v4 offset:12544
v_mfma_f32_16x16x32_bf16 v[184:187],a[248:251],v[96:99],v[184:187]
buffer_load_dwordx4 v7,s[4:7],s20 offen offset:0 lds
v_mfma_f32_16x16x32_bf16 v[232:235],a[248:251],v[100:103],v[232:235]
ds_read_b128 a[228:231],v2 offset:6272
v_fma_f32 v83,v83,s36,v18
v_mfma_f32_16x16x32_bf16 a[24:27],a[248:251],v[104:107],a[24:27]
s_waitcnt lgkmcnt(8)
ds_read_b64_tr_b16 a[250:251],v5 offset:18688
ds_read_b64_tr_b16 a[248:249],v5 offset:12544
v_mfma_f32_16x16x32_bf16 v[188:191],a[252:255],v[96:99],v[188:191]
ds_read_b128 a[232:235],v1 offset:6400
v_fma_f32 v81,v81,s36,v18
v_mfma_f32_16x16x32_bf16 v[236:239],a[252:255],v[100:103],v[236:239]
ds_read_b128 a[236:239],v2 offset:6400
v_fma_f32 v77,v77,s36,v17
v_mfma_f32_16x16x32_bf16 a[28:31],a[252:255],v[104:107],a[28:31]
s_waitcnt lgkmcnt(8)
ds_read_b64_tr_b16 a[252:253],v6 offset:12544
ds_read_b64_tr_b16 a[254:255],v6 offset:18688
v_mfma_f32_16x16x32_bf16 v[192:195],a[240:243],v[96:99],v[192:195]
buffer_load_dwordx4 v8,s[4:7],s20 offen offset:1024 lds
v_mfma_f32_16x16x32_bf16 v[240:243],a[240:243],v[100:103],v[240:243]
ds_read_b128 v[152:155],v11 offset:3072
v_fma_f32 v71,v71,s36,v16
v_mfma_f32_16x16x32_bf16 a[32:35],a[240:243],v[104:107],a[32:35]
s_waitcnt lgkmcnt(8)
v_exp_f32 v78,v78
v_mfma_f32_16x16x32_bf16 v[196:199],a[244:247],v[96:99],v[196:199]
v_exp_f32 v76,v76
v_mfma_f32_16x16x32_bf16 v[244:247],a[244:247],v[100:103],v[244:247]
v_exp_f32 v85,v85
v_mfma_f32_16x16x32_bf16 a[36:39],a[244:247],v[104:107],a[36:39]
s_waitcnt lgkmcnt(4)
v_exp_f32 v71,v71
v_mfma_f32_16x16x32_bf16 v[200:203],a[248:251],v[96:99],v[200:203]
buffer_load_dwordx4 v9,s[4:7],s20 offen offset:2048 lds
v_mfma_f32_16x16x32_bf16 v[248:251],a[248:251],v[100:103],v[248:251]
s_add_u32 s20,s20,12288
v_exp_f32 v81,v81
v_mfma_f32_16x16x32_bf16 a[40:43],a[248:251],v[104:107],a[40:43]
s_waitcnt lgkmcnt(1)
ds_read_b128 v[156:159],v23 offset:3072
v_fma_f32 v82,v82,s36,v18
v_mfma_f32_16x16x32_bf16 v[204:207],a[252:255],v[96:99],v[204:207]
v_exp_f32 v83,v83
v_mfma_f32_16x16x32_bf16 v[252:255],a[252:255],v[100:103],v[252:255]
v_exp_f32 v87,v87
v_mfma_f32_16x16x32_bf16 a[44:47],a[252:255],v[104:107],a[44:47]
v_exp_f32 v77,v77
v_mfma_f32_16x16x32_bf16 v[32:35],a[192:195],a[96:99],0
v_exp_f32 v80,v80
v_mfma_f32_16x16x32_bf16 v[32:35],a[196:199],a[100:103],v[32:35]
v_exp_f32 v79,v79
v_mfma_f32_16x16x32_bf16 v[32:35],a[200:203],a[104:107],v[32:35]
v_exp_f32 v68,v68
v_mfma_f32_16x16x32_bf16 v[32:35],a[204:207],a[108:111],v[32:35]
s_waitcnt lgkmcnt(1)
buffer_store_dwordx4 v[152:155],v0,s[16:19],s27 offen offset:0 nt
v_exp_f32 v69,v69
v_fma_f32 v86,v86,s36,v18
v_mfma_f32_16x16x32_bf16 v[32:35],a[208:211],a[112:115],v[32:35]
ds_read_b128 v[152:155],v31 offset:3072
v_cvt_pk_bf16_f32 v114,v68,v69
v_mfma_f32_16x16x32_bf16 v[32:35],a[212:215],a[116:119],v[32:35]
v_exp_f32 v86,v86
v_mfma_f32_16x16x32_bf16 v[40:43],a[192:195],a[120:123],0
v_exp_f32 v84,v84
v_mfma_f32_16x16x32_bf16 v[40:43],a[196:199],a[124:127],v[40:43]
v_exp_f32 v82,v82
v_mfma_f32_16x16x32_bf16 v[40:43],a[200:203],a[128:131],v[40:43]
v_cvt_pk_bf16_f32 v121,v82,v83
v_fma_f32 v70,v70,s36,v16
v_mfma_f32_16x16x32_bf16 v[40:43],a[204:207],a[132:135],v[40:43]
v_exp_f32 v70,v70
v_mfma_f32_16x16x32_bf16 v[40:43],a[208:211],a[136:139],v[40:43]
v_cvt_pk_bf16_f32 v122,v84,v85
v_cvt_pk_bf16_f32 v123,v86,v87
v_mfma_f32_16x16x32_bf16 v[40:43],a[212:215],a[140:143],v[40:43]
s_waitcnt lgkmcnt(1)
buffer_store_dwordx4 v[156:159],v0,s[16:19],s27 offen offset:1024 nt
v_cvt_pk_bf16_f32 v118,v76,v77
v_fma_f32 v35,v35,s36,v16
v_cvt_pk_bf16_f32 v119,v78,v79
v_mfma_f32_16x16x32_bf16 v[48:51],a[192:195],a[144:147],0
v_exp_f32 v35,v35
v_mfma_f32_16x16x32_bf16 v[132:135],v[24:27],v[116:119],v[132:135]
v_fma_f32 v33,v33,s36,v16
v_fma_f32 v41,v41,s36,v17
v_mfma_f32_16x16x32_bf16 v[48:51],a[196:199],a[148:151],v[48:51]
v_exp_f32 v41,v41
v_mfma_f32_16x16x32_bf16 v[48:51],a[200:203],a[152:155],v[48:51]
v_exp_f32 v33,v33
v_mfma_f32_16x16x32_bf16 v[48:51],a[204:207],a[156:159],v[48:51]
v_fma_f32 v43,v43,s36,v17
v_fma_f32 v40,v40,s36,v17
v_mfma_f32_16x16x32_bf16 v[48:51],a[208:211],a[160:163],v[48:51]
v_exp_f32 v40,v40
v_mfma_f32_16x16x32_bf16 v[48:51],a[212:215],a[164:167],v[48:51]
s_waitcnt vmcnt(11)
s_waitcnt lgkmcnt(0)
buffer_store_dwordx4 v[152:155],v0,s[16:19],s27 offen offset:2048 nt
v_exp_f32 v43,v43
v_fma_f32 v42,v42,s36,v17
v_mfma_f32_16x16x32_bf16 v[36:39],a[216:219],a[96:99],0
s_barrier
v_mfma_f32_16x16x32_bf16 v[36:39],a[220:223],a[100:103],v[36:39]
s_add_u32 s27,s27,3072
v_exp_f32 v42,v42
v_mfma_f32_16x16x32_bf16 v[36:39],a[224:227],a[104:107],v[36:39]
v_cvt_pk_bf16_f32 v115,v70,v71
v_fma_f32 v34,v34,s36,v16
v_mfma_f32_16x16x32_bf16 v[36:39],a[228:231],a[108:111],v[36:39]
v_exp_f32 v34,v34
v_mfma_f32_16x16x32_bf16 v[128:131],v[24:27],v[112:115],v[128:131]
ds_read_b64_tr_b16 a[242:243],v3 offset:30720
v_mfma_f32_16x16x32_bf16 v[36:39],a[232:235],a[112:115],v[36:39]
ds_read_b64_tr_b16 a[240:241],v3 offset:24576
v_cvt_pk_bf16_f32 v120,v80,v81
v_mfma_f32_16x16x32_bf16 v[36:39],a[236:239],a[116:119],v[36:39]
ds_read_b64_tr_b16 a[244:245],v4 offset:24576
ds_read_b64_tr_b16 a[246:247],v4 offset:30720
v_mfma_f32_16x16x32_bf16 v[136:139],v[24:27],v[120:123],v[136:139]
ds_read_b64_tr_b16 a[250:251],v5 offset:30720
v_mfma_f32_16x16x32_bf16 v[44:47],a[216:219],a[120:123],0
ds_read_b64_tr_b16 a[248:249],v5 offset:24576
v_cvt_pk_bf16_f32 v100,v40,v41
v_mfma_f32_16x16x32_bf16 v[44:47],a[220:223],a[124:127],v[44:47]
ds_read_b64_tr_b16 a[254:255],v6 offset:30720
ds_read_b64_tr_b16 a[252:253],v6 offset:24576
v_mfma_f32_16x16x32_bf16 v[44:47],a[224:227],a[128:131],v[44:47]
v_fma_f32 v32,v32,s36,v16
v_cvt_pk_bf16_f32 v101,v42,v43
v_mfma_f32_16x16x32_bf16 v[44:47],a[228:231],a[132:135],v[44:47]
v_exp_f32 v32,v32
v_mfma_f32_16x16x32_bf16 v[44:47],a[232:235],a[136:139],v[44:47]
v_cvt_pk_bf16_f32 v96,v32,v33
v_cvt_pk_bf16_f32 v97,v34,v35
v_mfma_f32_16x16x32_bf16 v[44:47],a[236:239],a[140:143],v[44:47]
v_mfma_f32_16x16x32_bf16 v[52:55],a[216:219],a[144:147],0
v_mfma_f32_16x16x32_bf16 v[52:55],a[220:223],a[148:151],v[52:55]
v_mfma_f32_16x16x32_bf16 v[52:55],a[224:227],a[152:155],v[52:55]
v_mfma_f32_16x16x32_bf16 v[52:55],a[228:231],a[156:159],v[52:55]
v_mfma_f32_16x16x32_bf16 v[52:55],a[232:235],a[160:163],v[52:55]
v_mfma_f32_16x16x32_bf16 v[52:55],a[236:239],a[164:167],v[52:55]
s_waitcnt lgkmcnt(0)
v_mfma_f32_16x16x32_bf16 v[160:163],a[240:243],v[112:115],v[160:163]
s_add_u32 m0,s23,12288
ds_read_b128 a[192:195],v1 offset:12288
v_fma_f32 v36,v36,s36,v16
v_mfma_f32_16x16x32_bf16 v[208:211],a[240:243],v[116:119],v[208:211]
buffer_load_dwordx4 v7,s[8:11],s21 offen offset:0 lds
v_mfma_f32_16x16x32_bf16 a[0:3],a[240:243],v[120:123],a[0:3]
ds_read_b64_tr_b16 a[240:241],v3 offset:24704
ds_read_b64_tr_b16 a[242:243],v3 offset:30848
v_mfma_f32_16x16x32_bf16 v[164:167],a[244:247],v[112:115],v[164:167]
ds_read_b128 a[196:199],v2 offset:12288
v_fma_f32 v37,v37,s36,v16
v_mfma_f32_16x16x32_bf16 v[212:215],a[244:247],v[116:119],v[212:215]
ds_read_b128 a[200:203],v1 offset:12416
v_fma_f32 v38,v38,s36,v16
v_mfma_f32_16x16x32_bf16 a[4:7],a[244:247],v[120:123],a[4:7]
ds_read_b64_tr_b16 a[244:245],v4 offset:24704
ds_read_b64_tr_b16 a[246:247],v4 offset:30848
v_mfma_f32_16x16x32_bf16 v[168:171],a[248:251],v[112:115],v[168:171]
ds_read_b128 a[204:207],v2 offset:12416
v_fma_f32 v39,v39,s36,v16
v_mfma_f32_16x16x32_bf16 v[216:219],a[248:251],v[116:119],v[216:219]
buffer_load_dwordx4 v8,s[8:11],s21 offen offset:1024 lds
v_mfma_f32_16x16x32_bf16 a[8:11],a[248:251],v[120:123],a[8:11]
ds_read_b64_tr_b16 a[248:249],v5 offset:24704
ds_read_b64_tr_b16 a[250:251],v5 offset:30848
v_mfma_f32_16x16x32_bf16 v[172:175],a[252:255],v[112:115],v[172:175]
ds_read_b128 a[208:211],v1 offset:12544
v_fma_f32 v44,v44,s36,v17
v_mfma_f32_16x16x32_bf16 v[220:223],a[252:255],v[116:119],v[220:223]
ds_read_b128 a[212:215],v2 offset:12544
v_fma_f32 v45,v45,s36,v17
v_mfma_f32_16x16x32_bf16 a[12:15],a[252:255],v[120:123],a[12:15]
s_waitcnt lgkmcnt(8)
ds_read_b64_tr_b16 a[252:253],v6 offset:24704
ds_read_b64_tr_b16 a[254:255],v6 offset:30848
v_mfma_f32_16x16x32_bf16 v[176:179],a[240:243],v[112:115],v[176:179]
buffer_load_dwordx4 v9,s[8:11],s21 offen offset:2048 lds
v_mfma_f32_16x16x32_bf16 v[224:227],a[240:243],v[116:119],v[224:227]
s_add_u32 s21,s21,12288
ds_read_b128 a[216:219],v1 offset:18432
v_fma_f32 v46,v46,s36,v17
v_mfma_f32_16x16x32_bf16 a[16:19],a[240:243],v[120:123],a[16:19]
s_add_u32 m0,s22,0
ds_read_b64_tr_b16 a[240:241],v3 offset:24832
ds_read_b64_tr_b16 a[242:243],v3 offset:30976
s_waitcnt lgkmcnt(9)
v_mfma_f32_16x16x32_bf16 v[180:183],a[244:247],v[112:115],v[180:183]
ds_read_b128 a[220:223],v2 offset:18432
v_fma_f32 v47,v47,s36,v17
v_mfma_f32_16x16x32_bf16 v[228:231],a[244:247],v[116:119],v[228:231]
ds_read_b128 a[224:227],v1 offset:18560
v_fma_f32 v48,v48,s36,v18
v_mfma_f32_16x16x32_bf16 a[20:23],a[244:247],v[120:123],a[20:23]
s_waitcnt lgkmcnt(8)
ds_read_b64_tr_b16 a[244:245],v4 offset:24832
ds_read_b64_tr_b16 a[246:247],v4 offset:30976
v_mfma_f32_16x16x32_bf16 v[184:187],a[248:251],v[112:115],v[184:187]
buffer_load_dwordx4 v7,s[4:7],s20 offen offset:0 lds
v_mfma_f32_16x16x32_bf16 v[232:235],a[248:251],v[116:119],v[232:235]
ds_read_b128 a[228:231],v2 offset:18560
v_fma_f32 v49,v49,s36,v18
v_mfma_f32_16x16x32_bf16 a[24:27],a[248:251],v[120:123],a[24:27]
s_waitcnt lgkmcnt(8)
ds_read_b64_tr_b16 a[248:249],v5 offset:24832
ds_read_b64_tr_b16 a[250:251],v5 offset:30976
v_mfma_f32_16x16x32_bf16 v[188:191],a[252:255],v[112:115],v[188:191]
ds_read_b128 a[232:235],v1 offset:18688
v_fma_f32 v50,v50,s36,v18
v_mfma_f32_16x16x32_bf16 v[236:239],a[252:255],v[116:119],v[236:239]
ds_read_b128 a[236:239],v2 offset:18688
v_fma_f32 v51,v51,s36,v18
v_mfma_f32_16x16x32_bf16 a[28:31],a[252:255],v[120:123],a[28:31]
s_waitcnt lgkmcnt(8)
ds_read_b64_tr_b16 a[252:253],v6 offset:24832
ds_read_b64_tr_b16 a[254:255],v6 offset:30976
v_mfma_f32_16x16x32_bf16 v[192:195],a[240:243],v[112:115],v[192:195]
buffer_load_dwordx4 v8,s[4:7],s20 offen offset:1024 lds
v_mfma_f32_16x16x32_bf16 v[240:243],a[240:243],v[116:119],v[240:243]
v_fma_f32 v52,v52,s36,v18
v_fma_f32 v53,v53,s36,v18
v_mfma_f32_16x16x32_bf16 a[32:35],a[240:243],v[120:123],a[32:35]
s_waitcnt lgkmcnt(7)
v_fma_f32 v54,v54,s36,v18
v_fma_f32 v55,v55,s36,v18
v_mfma_f32_16x16x32_bf16 v[196:199],a[244:247],v[112:115],v[196:199]
v_exp_f32 v36,v36
v_mfma_f32_16x16x32_bf16 v[244:247],a[244:247],v[116:119],v[244:247]
v_exp_f32 v37,v37
v_mfma_f32_16x16x32_bf16 a[36:39],a[244:247],v[120:123],a[36:39]
s_waitcnt lgkmcnt(3)
v_exp_f32 v38,v38
v_mfma_f32_16x16x32_bf16 v[200:203],a[248:251],v[112:115],v[200:203]
buffer_load_dwordx4 v9,s[4:7],s20 offen offset:2048 lds
v_mfma_f32_16x16x32_bf16 v[248:251],a[248:251],v[116:119],v[248:251]
s_add_u32 s20,s20,12288
v_exp_f32 v39,v39
v_mfma_f32_16x16x32_bf16 a[40:43],a[248:251],v[120:123],a[40:43]
s_add_u32 m0,s29,0
v_exp_f32 v44,v44
s_waitcnt lgkmcnt(0)
v_mfma_f32_16x16x32_bf16 v[204:207],a[252:255],v[112:115],v[204:207]
v_exp_f32 v45,v45
v_mfma_f32_16x16x32_bf16 v[252:255],a[252:255],v[116:119],v[252:255]
v_exp_f32 v46,v46
v_mfma_f32_16x16x32_bf16 a[44:47],a[252:255],v[120:123],a[44:47]
v_exp_f32 v47,v47
v_mfma_f32_16x16x32_bf16 v[64:67],a[192:195],a[96:99],0
v_exp_f32 v48,v48
v_mfma_f32_16x16x32_bf16 v[64:67],a[196:199],a[100:103],v[64:67]
v_exp_f32 v49,v49
v_mfma_f32_16x16x32_bf16 v[64:67],a[200:203],a[104:107],v[64:67]
v_exp_f32 v50,v50
v_mfma_f32_16x16x32_bf16 v[64:67],a[204:207],a[108:111],v[64:67]
buffer_load_dwordx4 v7,s[12:15],s28 offen offset:0 nt lds
v_mfma_f32_16x16x32_bf16 v[64:67],a[208:211],a[112:115],v[64:67]
v_exp_f32 v51,v51
v_mfma_f32_16x16x32_bf16 v[64:67],a[212:215],a[116:119],v[64:67]
v_exp_f32 v52,v52
v_mfma_f32_16x16x32_bf16 v[72:75],a[192:195],a[120:123],0
v_exp_f32 v53,v53
v_mfma_f32_16x16x32_bf16 v[72:75],a[196:199],a[124:127],v[72:75]
v_exp_f32 v54,v54
v_mfma_f32_16x16x32_bf16 v[72:75],a[200:203],a[128:131],v[72:75]
v_exp_f32 v55,v55
v_mfma_f32_16x16x32_bf16 v[72:75],a[204:207],a[132:135],v[72:75]
v_cvt_pk_bf16_f32 v98,v36,v37
v_cvt_pk_bf16_f32 v99,v38,v39
v_mfma_f32_16x16x32_bf16 v[72:75],a[208:211],a[136:139],v[72:75]
v_cvt_pk_bf16_f32 v102,v44,v45
v_cvt_pk_bf16_f32 v103,v46,v47
v_mfma_f32_16x16x32_bf16 v[128:131],v[24:27],v[96:99],v[128:131]
v_cvt_pk_bf16_f32 v104,v48,v49
v_cvt_pk_bf16_f32 v105,v50,v51
v_mfma_f32_16x16x32_bf16 v[132:135],v[24:27],v[100:103],v[132:135]
buffer_load_dwordx4 v8,s[12:15],s28 offen offset:1024 nt lds
v_mfma_f32_16x16x32_bf16 v[72:75],a[212:215],a[140:143],v[72:75]
v_cvt_pk_bf16_f32 v106,v52,v53
v_cvt_pk_bf16_f32 v107,v54,v55
v_mfma_f32_16x16x32_bf16 v[80:83],a[192:195],a[144:147],0
v_fma_f32 v64,v64,s36,v16
v_fma_f32 v65,v65,s36,v16
v_mfma_f32_16x16x32_bf16 v[136:139],v[24:27],v[104:107],v[136:139]
v_fma_f32 v66,v66,s36,v16
v_fma_f32 v67,v67,s36,v16
v_mfma_f32_16x16x32_bf16 v[80:83],a[196:199],a[148:151],v[80:83]
v_fma_f32 v72,v72,s36,v17
v_fma_f32 v73,v73,s36,v17
v_mfma_f32_16x16x32_bf16 v[80:83],a[200:203],a[152:155],v[80:83]
v_fma_f32 v74,v74,s36,v17
v_fma_f32 v75,v75,s36,v17
v_mfma_f32_16x16x32_bf16 v[80:83],a[204:207],a[156:159],v[80:83]
v_exp_f32 v64,v64
v_mfma_f32_16x16x32_bf16 v[80:83],a[208:211],a[160:163],v[80:83]
s_waitcnt vmcnt(11)
buffer_load_dwordx4 v9,s[12:15],s28 offen offset:2048 nt lds
v_mfma_f32_16x16x32_bf16 v[80:83],a[212:215],a[164:167],v[80:83]
s_barrier
v_mfma_f32_16x16x32_bf16 v[68:71],a[216:219],a[96:99],0
s_add_u32 s28,s28,3072
v_exp_f32 v65,v65
v_mfma_f32_16x16x32_bf16 v[68:71],a[220:223],a[100:103],v[68:71]
s_add_u32 s29,s29,3072
v_exp_f32 v66,v66
v_mfma_f32_16x16x32_bf16 v[68:71],a[224:227],a[104:107],v[68:71]
v_exp_f32 v67,v67
v_mfma_f32_16x16x32_bf16 v[68:71],a[228:231],a[108:111],v[68:71]
v_exp_f32 v72,v72
v_mfma_f32_16x16x32_bf16 v[68:71],a[232:235],a[112:115],v[68:71]
ds_read_b64_tr_b16 a[240:241],v3 offset:0
ds_read_b64_tr_b16 a[242:243],v3 offset:6144
v_mfma_f32_16x16x32_bf16 v[68:71],a[236:239],a[116:119],v[68:71]
ds_read_b64_tr_b16 a[244:245],v4 offset:0
v_mfma_f32_16x16x32_bf16 v[76:79],a[216:219],a[120:123],0
ds_read_b64_tr_b16 a[246:247],v4 offset:6144
v_cvt_pk_bf16_f32 v112,v64,v65
v_mfma_f32_16x16x32_bf16 v[76:79],a[220:223],a[124:127],v[76:79]
ds_read_b64_tr_b16 a[248:249],v5 offset:0
ds_read_b64_tr_b16 a[250:251],v5 offset:6144
v_mfma_f32_16x16x32_bf16 v[76:79],a[224:227],a[128:131],v[76:79]
ds_read_b64_tr_b16 a[252:253],v6 offset:0
v_mfma_f32_16x16x32_bf16 v[76:79],a[228:231],a[132:135],v[76:79]
ds_read_b64_tr_b16 a[254:255],v6 offset:6144
v_cvt_pk_bf16_f32 v113,v66,v67
v_mfma_f32_16x16x32_bf16 v[76:79],a[232:235],a[136:139],v[76:79]
v_exp_f32 v73,v73
v_mfma_f32_16x16x32_bf16 v[76:79],a[236:239],a[140:143],v[76:79]
v_exp_f32 v74,v74
v_mfma_f32_16x16x32_bf16 v[84:87],a[216:219],a[144:147],0
v_exp_f32 v75,v75
v_mfma_f32_16x16x32_bf16 v[84:87],a[220:223],a[148:151],v[84:87]
v_cvt_pk_bf16_f32 v116,v72,v73
v_cvt_pk_bf16_f32 v117,v74,v75
v_mfma_f32_16x16x32_bf16 v[84:87],a[224:227],a[152:155],v[84:87]
v_mfma_f32_16x16x32_bf16 v[84:87],a[228:231],a[156:159],v[84:87]
v_mfma_f32_16x16x32_bf16 v[84:87],a[232:235],a[160:163],v[84:87]
v_mfma_f32_16x16x32_bf16 v[84:87],a[236:239],a[164:167],v[84:87]
s_waitcnt lgkmcnt(1)
v_mfma_f32_16x16x32_bf16 v[160:163],a[240:243],v[96:99],v[160:163]
s_add_u32 m0,s23,24576
ds_read_b128 a[192:195],v1 offset:24576
v_fma_f32 v80,v80,s36,v18
v_mfma_f32_16x16x32_bf16 v[208:211],a[240:243],v[100:103],v[208:211]
buffer_load_dwordx4 v7,s[8:11],s21 offen offset:0 lds
v_mfma_f32_16x16x32_bf16 a[0:3],a[240:243],v[104:107],a[0:3]
ds_read_b64_tr_b16 a[242:243],v3 offset:6272
ds_read_b64_tr_b16 a[240:241],v3 offset:128
v_mfma_f32_16x16x32_bf16 v[164:167],a[244:247],v[96:99],v[164:167]
ds_read_b128 a[196:199],v2 offset:24576
v_fma_f32 v87,v87,s36,v18
v_mfma_f32_16x16x32_bf16 v[212:215],a[244:247],v[100:103],v[212:215]
ds_read_b128 a[200:203],v1 offset:24704
v_fma_f32 v79,v79,s36,v17
v_mfma_f32_16x16x32_bf16 a[4:7],a[244:247],v[104:107],a[4:7]
ds_read_b64_tr_b16 a[244:245],v4 offset:128
ds_read_b64_tr_b16 a[246:247],v4 offset:6272
v_mfma_f32_16x16x32_bf16 v[168:171],a[248:251],v[96:99],v[168:171]
ds_read_b128 a[204:207],v2 offset:24704
v_fma_f32 v85,v85,s36,v18
v_mfma_f32_16x16x32_bf16 v[216:219],a[248:251],v[100:103],v[216:219]
buffer_load_dwordx4 v8,s[8:11],s21 offen offset:1024 lds
v_mfma_f32_16x16x32_bf16 a[8:11],a[248:251],v[104:107],a[8:11]
s_waitcnt lgkmcnt(7)
ds_read_b64_tr_b16 a[248:249],v5 offset:128
ds_read_b64_tr_b16 a[250:251],v5 offset:6272
v_mfma_f32_16x16x32_bf16 v[172:175],a[252:255],v[96:99],v[172:175]
ds_read_b128 a[208:211],v1 offset:24832
v_fma_f32 v68,v68,s36,v16
v_mfma_f32_16x16x32_bf16 v[220:223],a[252:255],v[100:103],v[220:223]
ds_read_b128 a[212:215],v2 offset:24832
v_fma_f32 v76,v76,s36,v17
v_mfma_f32_16x16x32_bf16 a[12:15],a[252:255],v[104:107],a[12:15]
s_waitcnt lgkmcnt(8)
ds_read_b64_tr_b16 a[252:253],v6 offset:128
ds_read_b64_tr_b16 a[254:255],v6 offset:6272
v_mfma_f32_16x16x32_bf16 v[176:179],a[240:243],v[96:99],v[176:179]
buffer_load_dwordx4 v9,s[8:11],s21 offen offset:2048 lds
v_mfma_f32_16x16x32_bf16 v[224:227],a[240:243],v[100:103],v[224:227]
s_add_u32 s21,s21,12288
ds_read_b128 a[216:219],v1 offset:30720
v_fma_f32 v78,v78,s36,v17
v_mfma_f32_16x16x32_bf16 a[16:19],a[240:243],v[104:107],a[16:19]
s_add_u32 m0,s25,0
ds_read_b64_tr_b16 a[240:241],v3 offset:256
ds_read_b64_tr_b16 a[242:243],v3 offset:6400
s_waitcnt lgkmcnt(9)
v_mfma_f32_16x16x32_bf16 v[180:183],a[244:247],v[96:99],v[180:183]
ds_read_b128 a[220:223],v2 offset:30720
v_fma_f32 v84,v84,s36,v18
v_mfma_f32_16x16x32_bf16 v[228:231],a[244:247],v[100:103],v[228:231]
ds_read_b128 a[224:227],v1 offset:30848
v_fma_f32 v69,v69,s36,v16
v_mfma_f32_16x16x32_bf16 a[20:23],a[244:247],v[104:107],a[20:23]
s_waitcnt lgkmcnt(8)
ds_read_b64_tr_b16 a[246:247],v4 offset:6400
ds_read_b64_tr_b16 a[244:245],v4 offset:256
v_mfma_f32_16x16x32_bf16 v[184:187],a[248:251],v[96:99],v[184:187]
buffer_load_dwordx4 v7,s[4:7],s20 offen offset:0 lds
v_mfma_f32_16x16x32_bf16 v[232:235],a[248:251],v[100:103],v[232:235]
ds_read_b128 a[228:231],v2 offset:30848
v_fma_f32 v83,v83,s36,v18
v_mfma_f32_16x16x32_bf16 a[24:27],a[248:251],v[104:107],a[24:27]
s_waitcnt lgkmcnt(8)
ds_read_b64_tr_b16 a[250:251],v5 offset:6400
ds_read_b64_tr_b16 a[248:249],v5 offset:256
v_mfma_f32_16x16x32_bf16 v[188:191],a[252:255],v[96:99],v[188:191]
ds_read_b128 a[232:235],v1 offset:30976
v_fma_f32 v81,v81,s36,v18
v_mfma_f32_16x16x32_bf16 v[236:239],a[252:255],v[100:103],v[236:239]
ds_read_b128 a[236:239],v2 offset:30976
v_fma_f32 v77,v77,s36,v17
v_mfma_f32_16x16x32_bf16 a[28:31],a[252:255],v[104:107],a[28:31]
s_waitcnt lgkmcnt(8)
ds_read_b64_tr_b16 a[252:253],v6 offset:256
ds_read_b64_tr_b16 a[254:255],v6 offset:6400
v_mfma_f32_16x16x32_bf16 v[192:195],a[240:243],v[96:99],v[192:195]
buffer_load_dwordx4 v8,s[4:7],s20 offen offset:1024 lds
v_mfma_f32_16x16x32_bf16 v[240:243],a[240:243],v[100:103],v[240:243]
ds_read_b128 v[156:159],v11 offset:6144
v_fma_f32 v71,v71,s36,v16
v_mfma_f32_16x16x32_bf16 a[32:35],a[240:243],v[104:107],a[32:35]
s_waitcnt lgkmcnt(8)
v_exp_f32 v78,v78
v_mfma_f32_16x16x32_bf16 v[196:199],a[244:247],v[96:99],v[196:199]
v_exp_f32 v76,v76
v_mfma_f32_16x16x32_bf16 v[244:247],a[244:247],v[100:103],v[244:247]
v_exp_f32 v85,v85
v_mfma_f32_16x16x32_bf16 a[36:39],a[244:247],v[104:107],a[36:39]
s_waitcnt lgkmcnt(4)
v_exp_f32 v71,v71
v_mfma_f32_16x16x32_bf16 v[200:203],a[248:251],v[96:99],v[200:203]
buffer_load_dwordx4 v9,s[4:7],s20 offen offset:2048 lds
v_mfma_f32_16x16x32_bf16 v[248:251],a[248:251],v[100:103],v[248:251]
s_add_u32 s20,s20,12288
v_exp_f32 v81,v81
v_mfma_f32_16x16x32_bf16 a[40:43],a[248:251],v[104:107],a[40:43]
s_waitcnt lgkmcnt(1)
ds_read_b128 v[152:155],v23 offset:6144
v_fma_f32 v82,v82,s36,v18
v_mfma_f32_16x16x32_bf16 v[204:207],a[252:255],v[96:99],v[204:207]
v_exp_f32 v83,v83
v_mfma_f32_16x16x32_bf16 v[252:255],a[252:255],v[100:103],v[252:255]
v_exp_f32 v87,v87
v_mfma_f32_16x16x32_bf16 a[44:47],a[252:255],v[104:107],a[44:47]
v_exp_f32 v77,v77
v_mfma_f32_16x16x32_bf16 v[32:35],a[192:195],a[96:99],0
v_exp_f32 v80,v80
v_mfma_f32_16x16x32_bf16 v[32:35],a[196:199],a[100:103],v[32:35]
v_exp_f32 v79,v79
v_mfma_f32_16x16x32_bf16 v[32:35],a[200:203],a[104:107],v[32:35]
v_exp_f32 v68,v68
v_mfma_f32_16x16x32_bf16 v[32:35],a[204:207],a[108:111],v[32:35]
s_waitcnt lgkmcnt(1)
buffer_store_dwordx4 v[156:159],v0,s[16:19],s27 offen offset:0 nt
v_exp_f32 v69,v69
v_fma_f32 v86,v86,s36,v18
v_mfma_f32_16x16x32_bf16 v[32:35],a[208:211],a[112:115],v[32:35]
ds_read_b128 v[156:159],v31 offset:6144
v_cvt_pk_bf16_f32 v114,v68,v69
v_mfma_f32_16x16x32_bf16 v[32:35],a[212:215],a[116:119],v[32:35]
v_exp_f32 v86,v86
v_mfma_f32_16x16x32_bf16 v[40:43],a[192:195],a[120:123],0
v_exp_f32 v84,v84
v_mfma_f32_16x16x32_bf16 v[40:43],a[196:199],a[124:127],v[40:43]
v_exp_f32 v82,v82
v_mfma_f32_16x16x32_bf16 v[40:43],a[200:203],a[128:131],v[40:43]
v_cvt_pk_bf16_f32 v121,v82,v83
v_fma_f32 v70,v70,s36,v16
v_mfma_f32_16x16x32_bf16 v[40:43],a[204:207],a[132:135],v[40:43]
v_exp_f32 v70,v70
v_mfma_f32_16x16x32_bf16 v[40:43],a[208:211],a[136:139],v[40:43]
v_cvt_pk_bf16_f32 v122,v84,v85
v_cvt_pk_bf16_f32 v123,v86,v87
v_mfma_f32_16x16x32_bf16 v[40:43],a[212:215],a[140:143],v[40:43]
s_waitcnt lgkmcnt(1)
buffer_store_dwordx4 v[152:155],v0,s[16:19],s27 offen offset:1024 nt
v_cvt_pk_bf16_f32 v118,v76,v77
v_fma_f32 v35,v35,s36,v16
v_cvt_pk_bf16_f32 v119,v78,v79
v_mfma_f32_16x16x32_bf16 v[48:51],a[192:195],a[144:147],0
v_exp_f32 v35,v35
v_mfma_f32_16x16x32_bf16 v[132:135],v[24:27],v[116:119],v[132:135]
v_fma_f32 v33,v33,s36,v16
v_fma_f32 v41,v41,s36,v17
v_mfma_f32_16x16x32_bf16 v[48:51],a[196:199],a[148:151],v[48:51]
v_exp_f32 v41,v41
v_mfma_f32_16x16x32_bf16 v[48:51],a[200:203],a[152:155],v[48:51]
v_exp_f32 v33,v33
v_mfma_f32_16x16x32_bf16 v[48:51],a[204:207],a[156:159],v[48:51]
v_fma_f32 v43,v43,s36,v17
v_fma_f32 v40,v40,s36,v17
v_mfma_f32_16x16x32_bf16 v[48:51],a[208:211],a[160:163],v[48:51]
v_exp_f32 v40,v40
v_mfma_f32_16x16x32_bf16 v[48:51],a[212:215],a[164:167],v[48:51]
s_waitcnt vmcnt(11)
s_waitcnt lgkmcnt(0)
buffer_store_dwordx4 v[156:159],v0,s[16:19],s27 offen offset:2048 nt
v_exp_f32 v43,v43
v_fma_f32 v42,v42,s36,v17
v_mfma_f32_16x16x32_bf16 v[36:39],a[216:219],a[96:99],0
s_barrier
v_mfma_f32_16x16x32_bf16 v[36:39],a[220:223],a[100:103],v[36:39]
s_add_u32 s27,s27,3072
v_exp_f32 v42,v42
v_mfma_f32_16x16x32_bf16 v[36:39],a[224:227],a[104:107],v[36:39]
v_cvt_pk_bf16_f32 v115,v70,v71
v_fma_f32 v34,v34,s36,v16
v_mfma_f32_16x16x32_bf16 v[36:39],a[228:231],a[108:111],v[36:39]
v_exp_f32 v34,v34
v_mfma_f32_16x16x32_bf16 v[128:131],v[24:27],v[112:115],v[128:131]
ds_read_b64_tr_b16 a[242:243],v3 offset:18432
v_mfma_f32_16x16x32_bf16 v[36:39],a[232:235],a[112:115],v[36:39]
ds_read_b64_tr_b16 a[240:241],v3 offset:12288
v_cvt_pk_bf16_f32 v120,v80,v81
v_mfma_f32_16x16x32_bf16 v[36:39],a[236:239],a[116:119],v[36:39]
ds_read_b64_tr_b16 a[244:245],v4 offset:12288
ds_read_b64_tr_b16 a[246:247],v4 offset:18432
v_mfma_f32_16x16x32_bf16 v[136:139],v[24:27],v[120:123],v[136:139]
ds_read_b64_tr_b16 a[250:251],v5 offset:18432
v_mfma_f32_16x16x32_bf16 v[44:47],a[216:219],a[120:123],0
ds_read_b64_tr_b16 a[248:249],v5 offset:12288
v_cvt_pk_bf16_f32 v100,v40,v41
v_mfma_f32_16x16x32_bf16 v[44:47],a[220:223],a[124:127],v[44:47]
ds_read_b64_tr_b16 a[254:255],v6 offset:18432
ds_read_b64_tr_b16 a[252:253],v6 offset:12288
v_mfma_f32_16x16x32_bf16 v[44:47],a[224:227],a[128:131],v[44:47]
v_fma_f32 v32,v32,s36,v16
v_cvt_pk_bf16_f32 v101,v42,v43
v_mfma_f32_16x16x32_bf16 v[44:47],a[228:231],a[132:135],v[44:47]
v_exp_f32 v32,v32
v_mfma_f32_16x16x32_bf16 v[44:47],a[232:235],a[136:139],v[44:47]
v_cvt_pk_bf16_f32 v96,v32,v33
v_cvt_pk_bf16_f32 v97,v34,v35
v_mfma_f32_16x16x32_bf16 v[44:47],a[236:239],a[140:143],v[44:47]
v_mfma_f32_16x16x32_bf16 v[52:55],a[216:219],a[144:147],0
v_mfma_f32_16x16x32_bf16 v[52:55],a[220:223],a[148:151],v[52:55]
v_mfma_f32_16x16x32_bf16 v[52:55],a[224:227],a[152:155],v[52:55]
v_mfma_f32_16x16x32_bf16 v[52:55],a[228:231],a[156:159],v[52:55]
v_mfma_f32_16x16x32_bf16 v[52:55],a[232:235],a[160:163],v[52:55]
v_mfma_f32_16x16x32_bf16 v[52:55],a[236:239],a[164:167],v[52:55]
s_waitcnt lgkmcnt(0)
v_mfma_f32_16x16x32_bf16 v[160:163],a[240:243],v[112:115],v[160:163]
s_add_u32 m0,s23,0
ds_read_b128 a[192:195],v1 offset:0
v_fma_f32 v36,v36,s36,v16
v_mfma_f32_16x16x32_bf16 v[208:211],a[240:243],v[116:119],v[208:211]
buffer_load_dwordx4 v7,s[8:11],s21 offen offset:0 lds
v_mfma_f32_16x16x32_bf16 a[0:3],a[240:243],v[120:123],a[0:3]
ds_read_b64_tr_b16 a[240:241],v3 offset:12416
ds_read_b64_tr_b16 a[242:243],v3 offset:18560
v_mfma_f32_16x16x32_bf16 v[164:167],a[244:247],v[112:115],v[164:167]
ds_read_b128 a[196:199],v2 offset:0
v_fma_f32 v37,v37,s36,v16
v_mfma_f32_16x16x32_bf16 v[212:215],a[244:247],v[116:119],v[212:215]
ds_read_b128 a[200:203],v1 offset:128
v_fma_f32 v38,v38,s36,v16
v_mfma_f32_16x16x32_bf16 a[4:7],a[244:247],v[120:123],a[4:7]
ds_read_b64_tr_b16 a[244:245],v4 offset:12416
ds_read_b64_tr_b16 a[246:247],v4 offset:18560
v_mfma_f32_16x16x32_bf16 v[168:171],a[248:251],v[112:115],v[168:171]
ds_read_b128 a[204:207],v2 offset:128
v_fma_f32 v39,v39,s36,v16
v_mfma_f32_16x16x32_bf16 v[216:219],a[248:251],v[116:119],v[216:219]
buffer_load_dwordx4 v8,s[8:11],s21 offen offset:1024 lds
v_mfma_f32_16x16x32_bf16 a[8:11],a[248:251],v[120:123],a[8:11]
ds_read_b64_tr_b16 a[248:249],v5 offset:12416
ds_read_b64_tr_b16 a[250:251],v5 offset:18560
v_mfma_f32_16x16x32_bf16 v[172:175],a[252:255],v[112:115],v[172:175]
ds_read_b128 a[208:211],v1 offset:256
v_fma_f32 v44,v44,s36,v17
v_mfma_f32_16x16x32_bf16 v[220:223],a[252:255],v[116:119],v[220:223]
ds_read_b128 a[212:215],v2 offset:256
v_fma_f32 v45,v45,s36,v17
v_mfma_f32_16x16x32_bf16 a[12:15],a[252:255],v[120:123],a[12:15]
s_waitcnt lgkmcnt(8)
ds_read_b64_tr_b16 a[252:253],v6 offset:12416
ds_read_b64_tr_b16 a[254:255],v6 offset:18560
v_mfma_f32_16x16x32_bf16 v[176:179],a[240:243],v[112:115],v[176:179]
buffer_load_dwordx4 v9,s[8:11],s21 offen offset:2048 lds
v_mfma_f32_16x16x32_bf16 v[224:227],a[240:243],v[116:119],v[224:227]
s_add_u32 s21,s21,12288
ds_read_b128 a[216:219],v1 offset:6144
v_fma_f32 v46,v46,s36,v17
v_mfma_f32_16x16x32_bf16 a[16:19],a[240:243],v[120:123],a[16:19]
s_add_u32 m0,s26,0
ds_read_b64_tr_b16 a[240:241],v3 offset:12544
ds_read_b64_tr_b16 a[242:243],v3 offset:18688
s_waitcnt lgkmcnt(9)
v_mfma_f32_16x16x32_bf16 v[180:183],a[244:247],v[112:115],v[180:183]
ds_read_b128 a[220:223],v2 offset:6144
v_fma_f32 v47,v47,s36,v17
v_mfma_f32_16x16x32_bf16 v[228:231],a[244:247],v[116:119],v[228:231]
ds_read_b128 a[224:227],v1 offset:6272
v_fma_f32 v48,v48,s36,v18
v_mfma_f32_16x16x32_bf16 a[20:23],a[244:247],v[120:123],a[20:23]
s_waitcnt lgkmcnt(8)
ds_read_b64_tr_b16 a[244:245],v4 offset:12544
ds_read_b64_tr_b16 a[246:247],v4 offset:18688
v_mfma_f32_16x16x32_bf16 v[184:187],a[248:251],v[112:115],v[184:187]
buffer_load_dwordx4 v7,s[4:7],s20 offen offset:0 lds
v_mfma_f32_16x16x32_bf16 v[232:235],a[248:251],v[116:119],v[232:235]
ds_read_b128 a[228:231],v2 offset:6272
v_fma_f32 v49,v49,s36,v18
v_mfma_f32_16x16x32_bf16 a[24:27],a[248:251],v[120:123],a[24:27]
s_waitcnt lgkmcnt(8)
ds_read_b64_tr_b16 a[248:249],v5 offset:12544
ds_read_b64_tr_b16 a[250:251],v5 offset:18688
v_mfma_f32_16x16x32_bf16 v[188:191],a[252:255],v[112:115],v[188:191]
ds_read_b128 a[232:235],v1 offset:6400
v_fma_f32 v50,v50,s36,v18
v_mfma_f32_16x16x32_bf16 v[236:239],a[252:255],v[116:119],v[236:239]
ds_read_b128 a[236:239],v2 offset:6400
v_fma_f32 v51,v51,s36,v18
v_mfma_f32_16x16x32_bf16 a[28:31],a[252:255],v[120:123],a[28:31]
s_waitcnt lgkmcnt(8)
ds_read_b64_tr_b16 a[252:253],v6 offset:12544
ds_read_b64_tr_b16 a[254:255],v6 offset:18688
v_mfma_f32_16x16x32_bf16 v[192:195],a[240:243],v[112:115],v[192:195]
buffer_load_dwordx4 v8,s[4:7],s20 offen offset:1024 lds
v_mfma_f32_16x16x32_bf16 v[240:243],a[240:243],v[116:119],v[240:243]
v_fma_f32 v52,v52,s36,v18
v_fma_f32 v53,v53,s36,v18
v_mfma_f32_16x16x32_bf16 a[32:35],a[240:243],v[120:123],a[32:35]
s_waitcnt lgkmcnt(7)
v_fma_f32 v54,v54,s36,v18
v_fma_f32 v55,v55,s36,v18
v_mfma_f32_16x16x32_bf16 v[196:199],a[244:247],v[112:115],v[196:199]
v_exp_f32 v36,v36
v_mfma_f32_16x16x32_bf16 v[244:247],a[244:247],v[116:119],v[244:247]
v_exp_f32 v37,v37
v_mfma_f32_16x16x32_bf16 a[36:39],a[244:247],v[120:123],a[36:39]
s_waitcnt lgkmcnt(3)
v_exp_f32 v38,v38
v_mfma_f32_16x16x32_bf16 v[200:203],a[248:251],v[112:115],v[200:203]
buffer_load_dwordx4 v9,s[4:7],s20 offen offset:2048 lds
v_mfma_f32_16x16x32_bf16 v[248:251],a[248:251],v[116:119],v[248:251]
s_add_u32 s20,s20,12288
v_exp_f32 v39,v39
v_mfma_f32_16x16x32_bf16 a[40:43],a[248:251],v[120:123],a[40:43]
s_add_u32 m0,s29,0
v_exp_f32 v44,v44
s_waitcnt lgkmcnt(0)
v_mfma_f32_16x16x32_bf16 v[204:207],a[252:255],v[112:115],v[204:207]
v_exp_f32 v45,v45
v_mfma_f32_16x16x32_bf16 v[252:255],a[252:255],v[116:119],v[252:255]
v_exp_f32 v46,v46
v_mfma_f32_16x16x32_bf16 a[44:47],a[252:255],v[120:123],a[44:47]
v_exp_f32 v47,v47
v_mfma_f32_16x16x32_bf16 v[64:67],a[192:195],a[96:99],0
v_exp_f32 v48,v48
v_mfma_f32_16x16x32_bf16 v[64:67],a[196:199],a[100:103],v[64:67]
v_exp_f32 v49,v49
v_mfma_f32_16x16x32_bf16 v[64:67],a[200:203],a[104:107],v[64:67]
v_exp_f32 v50,v50
v_mfma_f32_16x16x32_bf16 v[64:67],a[204:207],a[108:111],v[64:67]
buffer_load_dwordx4 v7,s[12:15],s28 offen offset:0 nt lds
v_mfma_f32_16x16x32_bf16 v[64:67],a[208:211],a[112:115],v[64:67]
v_exp_f32 v51,v51
v_mfma_f32_16x16x32_bf16 v[64:67],a[212:215],a[116:119],v[64:67]
v_exp_f32 v52,v52
v_mfma_f32_16x16x32_bf16 v[72:75],a[192:195],a[120:123],0
v_exp_f32 v53,v53
v_mfma_f32_16x16x32_bf16 v[72:75],a[196:199],a[124:127],v[72:75]
v_exp_f32 v54,v54
v_mfma_f32_16x16x32_bf16 v[72:75],a[200:203],a[128:131],v[72:75]
v_exp_f32 v55,v55
v_mfma_f32_16x16x32_bf16 v[72:75],a[204:207],a[132:135],v[72:75]
v_cvt_pk_bf16_f32 v98,v36,v37
v_cvt_pk_bf16_f32 v99,v38,v39
v_mfma_f32_16x16x32_bf16 v[72:75],a[208:211],a[136:139],v[72:75]
v_cvt_pk_bf16_f32 v102,v44,v45
v_cvt_pk_bf16_f32 v103,v46,v47
v_mfma_f32_16x16x32_bf16 v[128:131],v[24:27],v[96:99],v[128:131]
v_cvt_pk_bf16_f32 v104,v48,v49
v_cvt_pk_bf16_f32 v105,v50,v51
v_mfma_f32_16x16x32_bf16 v[132:135],v[24:27],v[100:103],v[132:135]
buffer_load_dwordx4 v8,s[12:15],s28 offen offset:1024 nt lds
v_mfma_f32_16x16x32_bf16 v[72:75],a[212:215],a[140:143],v[72:75]
v_cvt_pk_bf16_f32 v106,v52,v53
v_cvt_pk_bf16_f32 v107,v54,v55
v_mfma_f32_16x16x32_bf16 v[80:83],a[192:195],a[144:147],0
v_fma_f32 v64,v64,s36,v16
v_fma_f32 v65,v65,s36,v16
v_mfma_f32_16x16x32_bf16 v[136:139],v[24:27],v[104:107],v[136:139]
v_fma_f32 v66,v66,s36,v16
v_fma_f32 v67,v67,s36,v16
v_mfma_f32_16x16x32_bf16 v[80:83],a[196:199],a[148:151],v[80:83]
v_fma_f32 v72,v72,s36,v17
v_fma_f32 v73,v73,s36,v17
v_mfma_f32_16x16x32_bf16 v[80:83],a[200:203],a[152:155],v[80:83]
v_fma_f32 v74,v74,s36,v17
v_fma_f32 v75,v75,s36,v17
v_mfma_f32_16x16x32_bf16 v[80:83],a[204:207],a[156:159],v[80:83]
v_exp_f32 v64,v64
v_mfma_f32_16x16x32_bf16 v[80:83],a[208:211],a[160:163],v[80:83]
s_waitcnt vmcnt(11)
buffer_load_dwordx4 v9,s[12:15],s28 offen offset:2048 nt lds
v_mfma_f32_16x16x32_bf16 v[80:83],a[212:215],a[164:167],v[80:83]
s_barrier
v_mfma_f32_16x16x32_bf16 v[68:71],a[216:219],a[96:99],0
s_add_u32 s28,s28,3072
v_exp_f32 v65,v65
v_mfma_f32_16x16x32_bf16 v[68:71],a[220:223],a[100:103],v[68:71]
s_add_u32 s29,s29,3072
s_mov_b32 s25,s30
s_add_u32 s26,s22,12288
s_add_u32 s38,s38,1
s_cmp_lt_u32 s38,2
v_mfma_f32_16x16x32_bf16 v[68:71],a[224:227],a[104:107],v[68:71]
v_exp_f32 v66,v66
v_mfma_f32_16x16x32_bf16 v[68:71],a[228:231],a[108:111],v[68:71]
ds_read_b64_tr_b16 a[240:241],v3 offset:24576
v_mfma_f32_16x16x32_bf16 v[68:71],a[232:235],a[112:115],v[68:71]
ds_read_b64_tr_b16 a[242:243],v3 offset:30720
v_cvt_pk_bf16_f32 v112,v64,v65
v_mfma_f32_16x16x32_bf16 v[68:71],a[236:239],a[116:119],v[68:71]
ds_read_b64_tr_b16 a[244:245],v4 offset:24576
ds_read_b64_tr_b16 a[246:247],v4 offset:30720
v_mfma_f32_16x16x32_bf16 v[76:79],a[216:219],a[120:123],0
ds_read_b64_tr_b16 a[248:249],v5 offset:24576
v_mfma_f32_16x16x32_bf16 v[76:79],a[220:223],a[124:127],v[76:79]
ds_read_b64_tr_b16 a[250:251],v5 offset:30720
v_add_u32 v11,9216,v11
v_mfma_f32_16x16x32_bf16 v[76:79],a[224:227],a[128:131],v[76:79]
ds_read_b64_tr_b16 a[252:253],v6 offset:24576
ds_read_b64_tr_b16 a[254:255],v6 offset:30720
v_mfma_f32_16x16x32_bf16 v[76:79],a[228:231],a[132:135],v[76:79]
v_exp_f32 v67,v67
v_mfma_f32_16x16x32_bf16 v[76:79],a[232:235],a[136:139],v[76:79]
v_exp_f32 v72,v72
v_mfma_f32_16x16x32_bf16 v[76:79],a[236:239],a[140:143],v[76:79]
v_exp_f32 v73,v73
v_mfma_f32_16x16x32_bf16 v[84:87],a[216:219],a[144:147],0
v_exp_f32 v74,v74
v_mfma_f32_16x16x32_bf16 v[84:87],a[220:223],a[148:151],v[84:87]
v_exp_f32 v75,v75
v_mfma_f32_16x16x32_bf16 v[84:87],a[224:227],a[152:155],v[84:87]
v_cvt_pk_bf16_f32 v113,v66,v67
v_cvt_pk_bf16_f32 v116,v72,v73
v_mfma_f32_16x16x32_bf16 v[84:87],a[228:231],a[156:159],v[84:87]
v_cvt_pk_bf16_f32 v117,v74,v75
v_add_u32 v23,9216,v23
v_mfma_f32_16x16x32_bf16 v[84:87],a[232:235],a[160:163],v[84:87]
v_add_u32 v31,9216,v31
v_mfma_f32_16x16x32_bf16 v[84:87],a[236:239],a[164:167],v[84:87]
s_cbranch_scc1 L_loop3w1
s_cmp_ge_u32 s69,8
s_cbranch_scc1 L_end3
s_cmp_eq_u32 s40,0
s_cbranch_scc1 L_tr33
s_branch L_tr34
L_tr34:
s_waitcnt vmcnt(36)
s_waitcnt lgkmcnt(4)
v_mfma_f32_16x16x32_bf16 v[160:163],a[240:243],v[96:99],v[160:163]
s_add_u32 m0,s24,0
ds_read_b128 a[96:99],v28 offset:0
v_fma_f32 v68,v68,s36,v16
v_mfma_f32_16x16x32_bf16 v[208:211],a[240:243],v[100:103],v[208:211]
ds_read_b128 a[100:103],v29 offset:0
v_fma_f32 v69,v69,s36,v16
v_mfma_f32_16x16x32_bf16 a[0:3],a[240:243],v[104:107],a[0:3]
ds_read_b128 a[104:107],v28 offset:128
v_fma_f32 v70,v70,s36,v16
v_mfma_f32_16x16x32_bf16 v[164:167],a[244:247],v[96:99],v[164:167]
ds_read_b128 a[108:111],v29 offset:128
v_fma_f32 v71,v71,s36,v16
v_mfma_f32_16x16x32_bf16 v[212:215],a[244:247],v[100:103],v[212:215]
ds_read_b128 a[112:115],v28 offset:256
v_fma_f32 v76,v76,s36,v17
v_mfma_f32_16x16x32_bf16 a[4:7],a[244:247],v[104:107],a[4:7]
s_waitcnt lgkmcnt(5)
ds_read_b128 a[116:119],v29 offset:256
v_fma_f32 v77,v77,s36,v17
v_mfma_f32_16x16x32_bf16 v[168:171],a[248:251],v[96:99],v[168:171]
ds_read_b64_tr_b16 a[240:241],v3 offset:24704
ds_read_b64_tr_b16 a[242:243],v3 offset:30848
v_mfma_f32_16x16x32_bf16 v[216:219],a[248:251],v[100:103],v[216:219]
ds_read_b64_tr_b16 a[244:245],v4 offset:24704
ds_read_b64_tr_b16 a[246:247],v4 offset:30848
v_mfma_f32_16x16x32_bf16 a[8:11],a[248:251],v[104:107],a[8:11]
ds_read_b64_tr_b16 a[248:249],v5 offset:24704
ds_read_b64_tr_b16 a[250:251],v5 offset:30848
v_mfma_f32_16x16x32_bf16 v[172:175],a[252:255],v[96:99],v[172:175]
ds_read_b128 a[192:195],v13 offset:0
v_fma_f32 v78,v78,s36,v17
v_mfma_f32_16x16x32_bf16 v[220:223],a[252:255],v[100:103],v[220:223]
ds_read_b128 a[196:199],v14 offset:0
v_fma_f32 v79,v79,s36,v17
v_mfma_f32_16x16x32_bf16 a[12:15],a[252:255],v[104:107],a[12:15]
ds_read_b64_tr_b16 a[252:253],v6 offset:24704
ds_read_b64_tr_b16 a[254:255],v6 offset:30848
ds_read_b128 a[200:203],v13 offset:128
v_fma_f32 v80,v80,s36,v18
v_fma_f32 v81,v81,s36,v18
v_fma_f32 v82,v82,s36,v18
v_fma_f32 v83,v83,s36,v18
v_fma_f32 v84,v84,s36,v18
v_fma_f32 v85,v85,s36,v18
v_fma_f32 v86,v86,s36,v18
v_fma_f32 v87,v87,s36,v18
v_exp_f32 v68,v68
v_exp_f32 v69,v69
v_exp_f32 v70,v70
s_waitcnt lgkmcnt(9)
v_mfma_f32_16x16x32_bf16 v[176:179],a[240:243],v[96:99],v[176:179]
buffer_load_dwordx4 v7,s[12:15],s28 offen offset:0 nt lds
v_mfma_f32_16x16x32_bf16 v[224:227],a[240:243],v[100:103],v[224:227]
ds_read_b128 a[204:207],v14 offset:128
v_exp_f32 v71,v71
v_mfma_f32_16x16x32_bf16 a[16:19],a[240:243],v[104:107],a[16:19]
s_waitcnt lgkmcnt(4)
ds_read_b64_tr_b16 a[240:241],v3 offset:24832
ds_read_b64_tr_b16 a[242:243],v3 offset:30976
v_mfma_f32_16x16x32_bf16 v[180:183],a[244:247],v[96:99],v[180:183]
ds_read_b128 a[208:211],v13 offset:256
v_exp_f32 v76,v76
v_mfma_f32_16x16x32_bf16 v[228:231],a[244:247],v[100:103],v[228:231]
ds_read_b128 a[212:215],v14 offset:256
v_exp_f32 v77,v77
v_mfma_f32_16x16x32_bf16 a[20:23],a[244:247],v[104:107],a[20:23]
buffer_load_dwordx4 v8,s[12:15],s28 offen offset:1024 nt lds
v_mfma_f32_16x16x32_bf16 v[184:187],a[248:251],v[96:99],v[184:187]
ds_read_b64_tr_b16 a[244:245],v4 offset:24832
ds_read_b64_tr_b16 a[246:247],v4 offset:30976
v_mfma_f32_16x16x32_bf16 v[232:235],a[248:251],v[100:103],v[232:235]
ds_read_b128 a[216:219],v13 offset:45056
v_exp_f32 v78,v78
v_mfma_f32_16x16x32_bf16 a[24:27],a[248:251],v[104:107],a[24:27]
s_waitcnt lgkmcnt(7)
ds_read_b64_tr_b16 a[248:249],v5 offset:24832
ds_read_b64_tr_b16 a[250:251],v5 offset:30976
v_mfma_f32_16x16x32_bf16 v[188:191],a[252:255],v[96:99],v[188:191]
ds_read_b128 a[220:223],v14 offset:45056
v_exp_f32 v79,v79
v_mfma_f32_16x16x32_bf16 v[236:239],a[252:255],v[100:103],v[236:239]
ds_read_b128 a[224:227],v13 offset:45184
v_exp_f32 v80,v80
v_mfma_f32_16x16x32_bf16 a[28:31],a[252:255],v[104:107],a[28:31]
s_waitcnt lgkmcnt(7)
ds_read_b64_tr_b16 a[252:253],v6 offset:24832
ds_read_b64_tr_b16 a[254:255],v6 offset:30976
v_mfma_f32_16x16x32_bf16 v[192:195],a[240:243],v[96:99],v[192:195]
ds_read_b128 a[228:231],v14 offset:45184
v_exp_f32 v81,v81
v_mfma_f32_16x16x32_bf16 v[240:243],a[240:243],v[100:103],v[240:243]
buffer_load_dwordx4 v9,s[12:15],s28 offen offset:2048 nt lds
v_mfma_f32_16x16x32_bf16 a[32:35],a[240:243],v[104:107],a[32:35]
s_add_u32 s28,s28,3072
ds_read_b128 a[232:235],v13 offset:45312
v_exp_f32 v82,v82
s_waitcnt lgkmcnt(8)
v_mfma_f32_16x16x32_bf16 v[196:199],a[244:247],v[96:99],v[196:199]
s_add_u32 m0,s24,3072
ds_read_b128 a[236:239],v14 offset:45312
v_exp_f32 v83,v83
v_mfma_f32_16x16x32_bf16 v[244:247],a[244:247],v[100:103],v[244:247]
ds_read_b128 a[120:123],v28 offset:6144
v_exp_f32 v84,v84
v_mfma_f32_16x16x32_bf16 a[36:39],a[244:247],v[104:107],a[36:39]
s_waitcnt lgkmcnt(6)
ds_read_b128 a[124:127],v29 offset:6144
v_exp_f32 v85,v85
v_mfma_f32_16x16x32_bf16 v[200:203],a[248:251],v[96:99],v[200:203]
ds_read_b128 a[128:131],v28 offset:6272
v_exp_f32 v86,v86
v_mfma_f32_16x16x32_bf16 v[248:251],a[248:251],v[100:103],v[248:251]
ds_read_b128 a[132:135],v29 offset:6272
v_exp_f32 v87,v87
v_mfma_f32_16x16x32_bf16 a[40:43],a[248:251],v[104:107],a[40:43]
ds_read_b128 a[136:139],v28 offset:6400
buffer_load_dwordx4 v7,s[12:15],s28 offen offset:0 nt lds
s_waitcnt lgkmcnt(6)
v_mfma_f32_16x16x32_bf16 v[204:207],a[252:255],v[96:99],v[204:207]
ds_read_b128 a[140:143],v29 offset:6400
v_cvt_pk_bf16_f32 v114,v68,v69
v_mfma_f32_16x16x32_bf16 v[252:255],a[252:255],v[100:103],v[252:255]
v_cvt_pk_bf16_f32 v115,v70,v71
v_cvt_pk_bf16_f32 v118,v76,v77
v_mfma_f32_16x16x32_bf16 a[44:47],a[252:255],v[104:107],a[44:47]
v_cvt_pk_bf16_f32 v119,v78,v79
v_cvt_pk_bf16_f32 v120,v80,v81
v_mfma_f32_16x16x32_bf16 v[128:131],v[24:27],v[112:115],v[128:131]
v_cvt_pk_bf16_f32 v121,v82,v83
v_cvt_pk_bf16_f32 v122,v84,v85
v_mfma_f32_16x16x32_bf16 v[132:135],v[24:27],v[116:119],v[132:135]
v_cvt_pk_bf16_f32 v123,v86,v87
buffer_load_dwordx4 v8,s[12:15],s28 offen offset:1024 nt lds
buffer_load_dwordx4 v9,s[12:15],s28 offen offset:2048 nt lds
s_waitcnt vmcnt(12)
s_waitcnt lgkmcnt(2)
s_barrier
v_mfma_f32_16x16x32_bf16 v[136:139],v[24:27],v[120:123],v[136:139]
s_add_u32 s28,s28,3072
ds_read_b64_tr_b16 a[240:241],v3 offset:0
ds_read_b64_tr_b16 a[242:243],v3 offset:6144
ds_read_b64_tr_b16 a[244:245],v4 offset:0
ds_read_b64_tr_b16 a[246:247],v4 offset:6144
ds_read_b64_tr_b16 a[248:249],v5 offset:0
ds_read_b64_tr_b16 a[250:251],v5 offset:6144
ds_read_b64_tr_b16 a[252:253],v6 offset:0
ds_read_b64_tr_b16 a[254:255],v6 offset:6144
s_waitcnt lgkmcnt(6)
v_mfma_f32_16x16x32_bf16 v[160:163],a[240:243],v[112:115],v[160:163]
v_rcp_f32 v146,v132
v_mfma_f32_16x16x32_bf16 v[208:211],a[240:243],v[116:119],v[208:211]
v_rcp_f32 v148,v136
v_mfma_f32_16x16x32_bf16 a[0:3],a[240:243],v[120:123],a[0:3]
s_waitcnt lgkmcnt(4)
ds_read_b64_tr_b16 a[240:241],v3 offset:128
ds_read_b64_tr_b16 a[242:243],v3 offset:6272
v_mfma_f32_16x16x32_bf16 v[164:167],a[244:247],v[112:115],v[164:167]
v_max3_f32 v30,v128,v132,v136
v_cmp_ngt_f32 vcc,s37,v30
v_mfma_f32_16x16x32_bf16 v[212:215],a[244:247],v[116:119],v[212:215]
v_rcp_f32 v144,v128
v_mfma_f32_16x16x32_bf16 a[4:7],a[244:247],v[120:123],a[4:7]
s_waitcnt lgkmcnt(4)
ds_read_b64_tr_b16 a[244:245],v4 offset:128
ds_read_b64_tr_b16 a[246:247],v4 offset:6272
v_mfma_f32_16x16x32_bf16 v[168:171],a[248:251],v[112:115],v[168:171]
s_cmp_lg_u64 vcc,0
v_accvgpr_read_b32 v64,a0
v_accvgpr_read_b32 v65,a1
v_mfma_f32_16x16x32_bf16 v[216:219],a[248:251],v[116:119],v[216:219]
s_cselect_b32 s62,s32,0
v_accvgpr_read_b32 v66,a2
v_accvgpr_read_b32 v67,a3
v_mfma_f32_16x16x32_bf16 a[8:11],a[248:251],v[120:123],a[8:11]
s_or_b32 s31,s31,s62
ds_read_b64_tr_b16 a[248:249],v5 offset:128
ds_read_b64_tr_b16 a[250:251],v5 offset:6272
s_waitcnt lgkmcnt(6)
v_mfma_f32_16x16x32_bf16 v[172:175],a[252:255],v[112:115],v[172:175]
s_lshl_b32 s32,s32,1
v_accvgpr_read_b32 v68,a4
v_accvgpr_read_b32 v69,a5
v_mfma_f32_16x16x32_bf16 v[220:223],a[252:255],v[116:119],v[220:223]
s_add_u32 m0,s22,24576
v_accvgpr_read_b32 v70,a6
v_accvgpr_read_b32 v71,a7
v_mfma_f32_16x16x32_bf16 a[12:15],a[252:255],v[120:123],a[12:15]
buffer_load_dwordx4 v7,s[4:7],s20 offen offset:0 lds
s_waitcnt lgkmcnt(4)
v_mfma_f32_16x16x32_bf16 v[176:179],a[240:243],v[112:115],v[176:179]
ds_read_b64_tr_b16 a[252:253],v6 offset:128
ds_read_b64_tr_b16 a[254:255],v6 offset:6272
v_mfma_f32_16x16x32_bf16 v[224:227],a[240:243],v[116:119],v[224:227]
v_accvgpr_read_b32 v72,a8
v_accvgpr_read_b32 v73,a9
v_mfma_f32_16x16x32_bf16 a[16:19],a[240:243],v[120:123],a[16:19]
s_waitcnt lgkmcnt(4)
ds_read_b64_tr_b16 a[240:241],v3 offset:256
ds_read_b64_tr_b16 a[242:243],v3 offset:6400
v_mfma_f32_16x16x32_bf16 v[180:183],a[244:247],v[112:115],v[180:183]
v_accvgpr_read_b32 v74,a10
v_accvgpr_read_b32 v75,a11
v_mfma_f32_16x16x32_bf16 v[228:231],a[244:247],v[116:119],v[228:231]
v_accvgpr_read_b32 v76,a12
v_accvgpr_read_b32 v77,a13
v_accvgpr_read_b32 v78,a14
v_accvgpr_read_b32 v79,a15
v_accvgpr_read_b32 v80,a16
v_pk_mul_f32 v[208:209],v[208:209],v[146:147] op_sel_hi:[1,0]
v_pk_mul_f32 v[210:211],v[210:211],v[146:147] op_sel_hi:[1,0]
v_pk_mul_f32 v[224:225],v[224:225],v[146:147] op_sel_hi:[1,0]
v_pk_mul_f32 v[226:227],v[226:227],v[146:147] op_sel_hi:[1,0]
v_accvgpr_read_b32 v81,a17
v_accvgpr_read_b32 v82,a18
v_mfma_f32_16x16x32_bf16 a[20:23],a[244:247],v[120:123],a[20:23]
s_waitcnt lgkmcnt(4)
ds_read_b64_tr_b16 a[244:245],v4 offset:256
ds_read_b64_tr_b16 a[246:247],v4 offset:6400
v_mfma_f32_16x16x32_bf16 v[184:187],a[248:251],v[112:115],v[184:187]
v_accvgpr_read_b32 v83,a19
v_cvt_pk_bf16_f32 v208,v208,v209
v_mfma_f32_16x16x32_bf16 v[232:235],a[248:251],v[116:119],v[232:235]
v_cvt_pk_bf16_f32 v224,v224,v225
v_cvt_pk_bf16_f32 v209,v210,v211
v_accvgpr_read_b32 v88,a20
v_accvgpr_read_b32 v89,a21
v_accvgpr_read_b32 v90,a22
v_pk_mul_f32 v[212:213],v[212:213],v[146:147] op_sel_hi:[1,0]
v_pk_mul_f32 v[214:215],v[214:215],v[146:147] op_sel_hi:[1,0]
v_pk_mul_f32 v[228:229],v[228:229],v[146:147] op_sel_hi:[1,0]
v_pk_mul_f32 v[230:231],v[230:231],v[146:147] op_sel_hi:[1,0]
v_accvgpr_read_b32 v91,a23
v_cvt_pk_bf16_f32 v225,v226,v227
v_mfma_f32_16x16x32_bf16 a[24:27],a[248:251],v[120:123],a[24:27]
buffer_load_dwordx4 v8,s[4:7],s20 offen offset:1024 lds
s_waitcnt lgkmcnt(2)
v_mfma_f32_16x16x32_bf16 v[188:191],a[252:255],v[112:115],v[188:191]
ds_read_b64_tr_b16 a[248:249],v5 offset:256
ds_read_b64_tr_b16 a[250:251],v5 offset:6400
v_mfma_f32_16x16x32_bf16 v[236:239],a[252:255],v[116:119],v[236:239]
ds_write2st64_b64 v12,v[208:209],v[224:225] offset0:12 offset1:14
v_pk_mul_f32 v[216:217],v[216:217],v[146:147] op_sel_hi:[1,0]
v_pk_mul_f32 v[218:219],v[218:219],v[146:147] op_sel_hi:[1,0]
v_pk_mul_f32 v[232:233],v[232:233],v[146:147] op_sel_hi:[1,0]
v_pk_mul_f32 v[234:235],v[234:235],v[146:147] op_sel_hi:[1,0]
v_cvt_pk_bf16_f32 v212,v212,v213
v_cvt_pk_bf16_f32 v228,v228,v229
v_mfma_f32_16x16x32_bf16 a[28:31],a[252:255],v[120:123],a[28:31]
ds_read_b64_tr_b16 a[252:253],v6 offset:256
ds_read_b64_tr_b16 a[254:255],v6 offset:6400
v_mfma_f32_16x16x32_bf16 v[192:195],a[240:243],v[112:115],v[192:195]
v_cvt_pk_bf16_f32 v216,v216,v217
v_cvt_pk_bf16_f32 v232,v232,v233
v_mfma_f32_16x16x32_bf16 v[240:243],a[240:243],v[116:119],v[240:243]
v_cvt_pk_bf16_f32 v213,v214,v215
v_cvt_pk_bf16_f32 v229,v230,v231
v_cvt_pk_bf16_f32 v217,v218,v219
v_cvt_pk_bf16_f32 v233,v234,v235
v_subrev_u32 v11,18432,v11
v_pk_mul_f32 v[220:221],v[220:221],v[146:147] op_sel_hi:[1,0]
v_pk_mul_f32 v[222:223],v[222:223],v[146:147] op_sel_hi:[1,0]
v_pk_mul_f32 v[236:237],v[236:237],v[146:147] op_sel_hi:[1,0]
v_pk_mul_f32 v[238:239],v[238:239],v[146:147] op_sel_hi:[1,0]
v_cvt_pk_bf16_f32 v220,v220,v221
v_cvt_pk_bf16_f32 v236,v236,v237
v_mfma_f32_16x16x32_bf16 a[32:35],a[240:243],v[120:123],a[32:35]
s_waitcnt lgkmcnt(2)
ds_write2st64_b64 v20,v[212:213],v[228:229] offset0:12 offset1:14
v_mfma_f32_16x16x32_bf16 v[196:199],a[244:247],v[112:115],v[196:199]
v_cvt_pk_bf16_f32 v221,v222,v223
v_cvt_pk_bf16_f32 v237,v238,v239
v_mfma_f32_16x16x32_bf16 v[244:247],a[244:247],v[116:119],v[244:247]
v_subrev_u32 v23,18432,v23
v_subrev_u32 v31,18432,v31
v_pk_mul_f32 v[240:241],v[240:241],v[146:147] op_sel_hi:[1,0]
v_pk_mul_f32 v[242:243],v[242:243],v[146:147] op_sel_hi:[1,0]
v_pk_mul_f32 v[64:65],v[64:65],v[148:149] op_sel_hi:[1,0]
v_pk_mul_f32 v[66:67],v[66:67],v[148:149] op_sel_hi:[1,0]
v_accvgpr_read_b32 v84,a32
v_accvgpr_read_b32 v85,a33
v_mfma_f32_16x16x32_bf16 a[36:39],a[244:247],v[120:123],a[36:39]
ds_write2st64_b64 v21,v[216:217],v[232:233] offset0:12 offset1:14
v_mfma_f32_16x16x32_bf16 v[200:203],a[248:251],v[112:115],v[200:203]
v_accvgpr_read_b32 v86,a34
v_accvgpr_read_b32 v87,a35
v_mfma_f32_16x16x32_bf16 v[248:251],a[248:251],v[116:119],v[248:251]
buffer_load_dwordx4 v9,s[4:7],s20 offen offset:2048 lds
v_cvt_pk_bf16_f32 v240,v240,v241
v_cvt_pk_bf16_f32 v64,v64,v65
v_pk_mul_f32 v[244:245],v[244:245],v[146:147] op_sel_hi:[1,0]
v_pk_mul_f32 v[246:247],v[246:247],v[146:147] op_sel_hi:[1,0]
v_pk_mul_f32 v[68:69],v[68:69],v[148:149] op_sel_hi:[1,0]
v_pk_mul_f32 v[70:71],v[70:71],v[148:149] op_sel_hi:[1,0]
v_accvgpr_read_b32 v92,a36
v_accvgpr_read_b32 v93,a37
v_mfma_f32_16x16x32_bf16 a[40:43],a[248:251],v[120:123],a[40:43]
s_add_u32 s20,s20,12288
ds_write2st64_b64 v22,v[220:221],v[236:237] offset0:12 offset1:14
s_waitcnt lgkmcnt(2)
v_mfma_f32_16x16x32_bf16 v[204:207],a[252:255],v[112:115],v[204:207]
s_add_u32 m0,s23,0
v_accvgpr_read_b32 v94,a38
v_accvgpr_read_b32 v95,a39
v_mfma_f32_16x16x32_bf16 v[252:255],a[252:255],v[116:119],v[252:255]
v_cvt_pk_bf16_f32 v241,v242,v243
v_cvt_pk_bf16_f32 v65,v66,v67
v_mfma_f32_16x16x32_bf16 a[44:47],a[252:255],v[120:123],a[44:47]
v_cvt_pk_bf16_f32 v244,v244,v245
v_cvt_pk_bf16_f32 v68,v68,v69
v_cvt_pk_bf16_f32 v245,v246,v247
v_cvt_pk_bf16_f32 v69,v70,v71
v_accvgpr_read_b32 v66,a26
v_pk_mul_f32 v[248:249],v[248:249],v[146:147] op_sel_hi:[1,0]
v_pk_mul_f32 v[250:251],v[250:251],v[146:147] op_sel_hi:[1,0]
v_pk_mul_f32 v[72:73],v[72:73],v[148:149] op_sel_hi:[1,0]
v_pk_mul_f32 v[74:75],v[74:75],v[148:149] op_sel_hi:[1,0]
v_accvgpr_read_b32 v67,a27
v_accvgpr_read_b32 v70,a42
v_mfma_f32_16x16x32_bf16 v[32:35],a[192:195],a[96:99],0
v_accvgpr_read_b32 v71,a43
v_cvt_pk_bf16_f32 v248,v248,v249
v_mfma_f32_16x16x32_bf16 v[32:35],a[196:199],a[100:103],v[32:35]
v_cvt_pk_bf16_f32 v72,v72,v73
v_cvt_pk_bf16_f32 v249,v250,v251
v_mfma_f32_16x16x32_bf16 v[32:35],a[200:203],a[104:107],v[32:35]
s_waitcnt vmcnt(9)
ds_read_b128 a[144:147],v28 offset:12288
v_cvt_pk_bf16_f32 v73,v74,v75
v_mfma_f32_16x16x32_bf16 v[32:35],a[204:207],a[108:111],v[32:35]
ds_read_b128 a[148:151],v29 offset:12288
v_accvgpr_read_b32 v74,a30
v_accvgpr_read_b32 v75,a31
ds_read_b128 a[152:155],v28 offset:12416
v_pk_mul_f32 v[252:253],v[252:253],v[146:147] op_sel_hi:[1,0]
v_pk_mul_f32 v[254:255],v[254:255],v[146:147] op_sel_hi:[1,0]
v_pk_mul_f32 v[76:77],v[76:77],v[148:149] op_sel_hi:[1,0]
v_pk_mul_f32 v[78:79],v[78:79],v[148:149] op_sel_hi:[1,0]
v_cvt_pk_bf16_f32 v252,v252,v253
v_cvt_pk_bf16_f32 v76,v76,v77
v_mfma_f32_16x16x32_bf16 v[32:35],a[208:211],a[112:115],v[32:35]
ds_read_b128 a[156:159],v29 offset:12416
v_cvt_pk_bf16_f32 v253,v254,v255
v_mfma_f32_16x16x32_bf16 v[32:35],a[212:215],a[116:119],v[32:35]
ds_read_b128 a[160:163],v28 offset:12544
s_waitcnt vmcnt(12)
s_barrier
v_mfma_f32_16x16x32_bf16 v[36:39],a[216:219],a[96:99],0
ds_read_b128 a[164:167],v29 offset:12544
v_cvt_pk_bf16_f32 v77,v78,v79
v_mfma_f32_16x16x32_bf16 v[36:39],a[220:223],a[100:103],v[36:39]
ds_write2st64_b64 v12,v[240:241],v[64:65] offset0:16 offset1:24
v_mfma_f32_16x16x32_bf16 v[36:39],a[224:227],a[104:107],v[36:39]
v_accvgpr_read_b32 v64,a24
v_accvgpr_read_b32 v65,a25
v_accvgpr_read_b32 v78,a46
v_accvgpr_read_b32 v79,a47
v_max3_f32 v129,v32,v33,v34
v_pk_mul_f32 v[80:81],v[80:81],v[148:149] op_sel_hi:[1,0]
v_pk_mul_f32 v[82:83],v[82:83],v[148:149] op_sel_hi:[1,0]
v_pk_mul_f32 v[84:85],v[84:85],v[148:149] op_sel_hi:[1,0]
v_pk_mul_f32 v[86:87],v[86:87],v[148:149] op_sel_hi:[1,0]
v_cvt_pk_bf16_f32 v80,v80,v81
v_cvt_pk_bf16_f32 v84,v84,v85
v_mfma_f32_16x16x32_bf16 v[36:39],a[228:231],a[108:111],v[36:39]
buffer_load_dwordx4 v7,s[8:11],s21 offen offset:0 lds
v_mfma_f32_16x16x32_bf16 v[36:39],a[232:235],a[112:115],v[36:39]
ds_write2st64_b64 v20,v[244:245],v[68:69] offset0:16 offset1:24
v_mfma_f32_16x16x32_bf16 v[36:39],a[236:239],a[116:119],v[36:39]
v_accvgpr_read_b32 v68,a40
v_accvgpr_read_b32 v69,a41
v_mfma_f32_16x16x32_bf16 v[40:43],a[192:195],a[120:123],0
v_cvt_pk_bf16_f32 v81,v82,v83
v_cvt_pk_bf16_f32 v85,v86,v87
v_mfma_f32_16x16x32_bf16 v[40:43],a[196:199],a[124:127],v[40:43]
ds_write2st64_b64 v21,v[248:249],v[72:73] offset0:16 offset1:24
v_pk_mul_f32 v[88:89],v[88:89],v[148:149] op_sel_hi:[1,0]
v_pk_mul_f32 v[90:91],v[90:91],v[148:149] op_sel_hi:[1,0]
v_pk_mul_f32 v[92:93],v[92:93],v[148:149] op_sel_hi:[1,0]
v_pk_mul_f32 v[94:95],v[94:95],v[148:149] op_sel_hi:[1,0]
v_accvgpr_read_b32 v72,a28
v_accvgpr_read_b32 v73,a29
v_mfma_f32_16x16x32_bf16 v[40:43],a[200:203],a[128:131],v[40:43]
v_cvt_pk_bf16_f32 v88,v88,v89
v_cvt_pk_bf16_f32 v92,v92,v93
v_mfma_f32_16x16x32_bf16 v[40:43],a[204:207],a[132:135],v[40:43]
v_cvt_pk_bf16_f32 v89,v90,v91
v_cvt_pk_bf16_f32 v93,v94,v95
v_mfma_f32_16x16x32_bf16 v[40:43],a[208:211],a[136:139],v[40:43]
buffer_load_dwordx4 v8,s[8:11],s21 offen offset:1024 lds
v_mfma_f32_16x16x32_bf16 v[40:43],a[212:215],a[140:143],v[40:43]
ds_write2st64_b64 v22,v[252:253],v[76:77] offset0:16 offset1:24
v_pk_mul_f32 v[64:65],v[64:65],v[148:149] op_sel_hi:[1,0]
v_pk_mul_f32 v[66:67],v[66:67],v[148:149] op_sel_hi:[1,0]
v_pk_mul_f32 v[68:69],v[68:69],v[148:149] op_sel_hi:[1,0]
v_pk_mul_f32 v[70:71],v[70:71],v[148:149] op_sel_hi:[1,0]
v_accvgpr_read_b32 v76,a44
v_accvgpr_read_b32 v77,a45
v_mfma_f32_16x16x32_bf16 v[44:47],a[216:219],a[120:123],0
v_cvt_pk_bf16_f32 v64,v64,v65
v_cvt_pk_bf16_f32 v68,v68,v69
v_mfma_f32_16x16x32_bf16 v[44:47],a[220:223],a[124:127],v[44:47]
v_cvt_pk_bf16_f32 v65,v66,v67
v_cvt_pk_bf16_f32 v69,v70,v71
v_mfma_f32_16x16x32_bf16 v[44:47],a[224:227],a[128:131],v[44:47]
ds_write2st64_b64 v12,v[80:81],v[84:85] offset0:26 offset1:28
v_mfma_f32_16x16x32_bf16 v[44:47],a[228:231],a[132:135],v[44:47]
v_max3_f32 v133,v40,v41,v42
v_max3_f32 v129,v129,v35,v36
v_mfma_f32_16x16x32_bf16 v[44:47],a[232:235],a[136:139],v[44:47]
v_max3_f32 v129,v129,v37,v38
v_max_f32 v129,v129,v39
v_mov_b32 v130,v129
v_pk_mul_f32 v[72:73],v[72:73],v[148:149] op_sel_hi:[1,0]
v_pk_mul_f32 v[74:75],v[74:75],v[148:149] op_sel_hi:[1,0]
v_pk_mul_f32 v[76:77],v[76:77],v[148:149] op_sel_hi:[1,0]
v_pk_mul_f32 v[78:79],v[78:79],v[148:149] op_sel_hi:[1,0]
v_cvt_pk_bf16_f32 v72,v72,v73
v_cvt_pk_bf16_f32 v76,v76,v77
v_mfma_f32_16x16x32_bf16 v[44:47],a[236:239],a[140:143],v[44:47]
buffer_load_dwordx4 v9,s[8:11],s21 offen offset:2048 lds
s_waitcnt lgkmcnt(1)
v_mfma_f32_16x16x32_bf16 v[48:51],a[192:195],a[144:147],0
s_add_u32 s21,s21,12288
ds_write2st64_b64 v20,v[88:89],v[92:93] offset0:26 offset1:28
v_mfma_f32_16x16x32_bf16 v[48:51],a[196:199],a[148:151],v[48:51]
s_mov_b32 s27,s42
v_cvt_pk_bf16_f32 v73,v74,v75
v_cvt_pk_bf16_f32 v77,v78,v79
v_mfma_f32_16x16x32_bf16 v[48:51],a[200:203],a[152:155],v[48:51]
s_mov_b32 s42,s41
v_max3_f32 v133,v133,v43,v44
v_max3_f32 v133,v133,v45,v46
v_mfma_f32_16x16x32_bf16 v[48:51],a[204:207],a[156:159],v[48:51]
s_add_u32 s69,s69,1
v_max_f32 v133,v133,v47
v_mov_b32 v134,v133
v_permlane32_swap_b32 v130,v129
v_max_f32 v129,v129,v130
v_pk_mul_f32 v[160:161],v[160:161],v[144:145] op_sel_hi:[1,0]
v_pk_mul_f32 v[162:163],v[162:163],v[144:145] op_sel_hi:[1,0]
v_pk_mul_f32 v[176:177],v[176:177],v[144:145] op_sel_hi:[1,0]
v_pk_mul_f32 v[178:179],v[178:179],v[144:145] op_sel_hi:[1,0]
v_permlane32_swap_b32 v134,v133
v_max_f32 v133,v133,v134
v_mfma_f32_16x16x32_bf16 v[48:51],a[208:211],a[160:163],v[48:51]
s_add_u32 s48,s48,325632
ds_write2st64_b64 v21,v[64:65],v[68:69] offset0:26 offset1:28
v_mfma_f32_16x16x32_bf16 v[48:51],a[212:215],a[164:167],v[48:51]
s_lshr_b32 s62,s39,s69
v_mov_b32 v130,v129
v_mov_b32 v134,v133
v_mfma_f32_16x16x32_bf16 v[52:55],a[216:219],a[144:147],0
s_and_b32 s62,s62,1
v_permlane16_swap_b32 v130,v129
v_mfma_f32_16x16x32_bf16 v[52:55],a[220:223],a[148:151],v[52:55]
s_lshl_b32 s62,s62,1
v_max3_f32 v137,v48,v49,v50
v_permlane16_swap_b32 v134,v133
v_max_f32 v129,v129,v130
v_max_f32 v133,v133,v134
v_pk_mul_f32 v[164:165],v[164:165],v[144:145] op_sel_hi:[1,0]
v_pk_mul_f32 v[166:167],v[166:167],v[144:145] op_sel_hi:[1,0]
v_pk_mul_f32 v[180:181],v[180:181],v[144:145] op_sel_hi:[1,0]
v_pk_mul_f32 v[182:183],v[182:183],v[144:145] op_sel_hi:[1,0]
v_mul_f32_e64 v16,-s36,v129
v_mul_f32_e64 v17,-s36,v133
v_mfma_f32_16x16x32_bf16 v[52:55],a[224:227],a[152:155],v[52:55]
s_add_u32 s62,s62,s49
ds_write2st64_b64 v22,v[72:73],v[76:77] offset0:26 offset1:28
v_mfma_f32_16x16x32_bf16 v[52:55],a[228:231],a[156:159],v[52:55]
s_and_b32 s62,s62,3
v_fma_f32 v32,v32,s36,v16
v_fma_f32 v33,v33,s36,v16
v_mfma_f32_16x16x32_bf16 v[52:55],a[232:235],a[160:163],v[52:55]
s_add_u32 s63,s69,8
v_fma_f32 v34,v34,s36,v16
v_fma_f32 v35,v35,s36,v16
v_mfma_f32_16x16x32_bf16 v[52:55],a[236:239],a[164:167],v[52:55]
s_waitcnt vmcnt(6)
ds_read_b128 a[168:171],v28 offset:0
v_fma_f32 v36,v36,s36,v16
v_fma_f32 v37,v37,s36,v16
v_fma_f32 v38,v38,s36,v16
v_fma_f32 v39,v39,s36,v16
v_fma_f32 v40,v40,s36,v17
v_fma_f32 v41,v41,s36,v17
v_fma_f32 v42,v42,s36,v17
v_max3_f32 v137,v137,v51,v52
v_max3_f32 v137,v137,v53,v54
v_max_f32 v137,v137,v55
v_mov_b32 v138,v137
v_fma_f32 v43,v43,s36,v17
v_fma_f32 v44,v44,s36,v17
v_permlane32_swap_b32 v138,v137
v_max_f32 v137,v137,v138
v_mov_b32 v138,v137
v_fma_f32 v45,v45,s36,v17
v_fma_f32 v46,v46,s36,v17
v_permlane16_swap_b32 v138,v137
v_max_f32 v137,v137,v138
v_mul_f32_e64 v18,-s36,v137
v_fma_f32 v47,v47,s36,v17
v_fma_f32 v48,v48,s36,v18
v_fma_f32 v49,v49,s36,v18
v_fma_f32 v50,v50,s36,v18
v_fma_f32 v51,v51,s36,v18
v_fma_f32 v52,v52,s36,v18
v_fma_f32 v53,v53,s36,v18
v_fma_f32 v54,v54,s36,v18
v_fma_f32 v55,v55,s36,v18
v_cvt_pk_bf16_f32 v160,v160,v161
v_cvt_pk_bf16_f32 v176,v176,v177
s_waitcnt lgkmcnt(0)
v_mfma_f32_16x16x32_bf16 v[56:59],a[192:195],a[168:171],0
s_lshr_b32 s63,s39,s63
ds_read_b128 a[172:175],v29 offset:0
v_exp_f32 v32,v32
v_exp_f32 v33,v33
v_pk_mul_f32 v[168:169],v[168:169],v[144:145] op_sel_hi:[1,0]
v_pk_mul_f32 v[170:171],v[170:171],v[144:145] op_sel_hi:[1,0]
v_pk_mul_f32 v[184:185],v[184:185],v[144:145] op_sel_hi:[1,0]
v_pk_mul_f32 v[186:187],v[186:187],v[144:145] op_sel_hi:[1,0]
v_exp_f32 v34,v34
v_exp_f32 v35,v35
v_exp_f32 v36,v36
v_exp_f32 v37,v37
v_exp_f32 v38,v38
v_exp_f32 v39,v39
v_exp_f32 v40,v40
v_exp_f32 v41,v41
v_exp_f32 v42,v42
v_exp_f32 v43,v43
v_exp_f32 v44,v44
v_exp_f32 v45,v45
v_exp_f32 v46,v46
s_waitcnt lgkmcnt(0)
v_mfma_f32_16x16x32_bf16 v[56:59],a[196:199],a[172:175],v[56:59]
s_and_b32 s63,s63,1
ds_read_b128 a[176:179],v28 offset:128
v_exp_f32 v47,v47
v_exp_f32 v48,v48
v_exp_f32 v49,v49
v_exp_f32 v50,v50
v_exp_f32 v51,v51
v_exp_f32 v52,v52
v_exp_f32 v53,v53
v_exp_f32 v54,v54
v_exp_f32 v55,v55
v_cvt_pk_bf16_f32 v164,v164,v165
v_cvt_pk_bf16_f32 v180,v180,v181
v_cvt_pk_bf16_f32 v161,v162,v163
v_cvt_pk_bf16_f32 v177,v178,v179
v_cvt_pk_bf16_f32 v168,v168,v169
v_cvt_pk_bf16_f32 v184,v184,v185
v_cvt_pk_bf16_f32 v165,v166,v167
v_cvt_pk_bf16_f32 v181,v182,v183
v_cvt_pk_bf16_f32 v96,v32,v33
v_cvt_pk_bf16_f32 v97,v34,v35
v_cvt_pk_bf16_f32 v98,v36,v37
v_cvt_pk_bf16_f32 v99,v38,v39
v_cvt_pk_bf16_f32 v100,v40,v41
v_cvt_pk_bf16_f32 v101,v42,v43
v_mfma_f32_16x16x32_bf16 v[128:131],v[24:27],v[96:99],0
s_xor_b32 s62,s62,s63
ds_read_b128 a[180:183],v29 offset:128
v_cvt_pk_bf16_f32 v102,v44,v45
s_waitcnt lgkmcnt(1)
v_mfma_f32_16x16x32_bf16 v[56:59],a[200:203],a[176:179],v[56:59]
s_mul_i32 s63,s3,3
ds_read_b128 a[184:187],v28 offset:256
v_cvt_pk_bf16_f32 v103,v46,v47
v_cvt_pk_bf16_f32 v104,v48,v49
v_cvt_pk_bf16_f32 v105,v50,v51
v_mfma_f32_16x16x32_bf16 v[132:135],v[24:27],v[100:103],0
s_lshl_b32 s64,s3,2
ds_read_b128 a[188:191],v29 offset:256
v_cvt_pk_bf16_f32 v106,v52,v53
v_cvt_pk_bf16_f32 v107,v54,v55
v_cvt_pk_bf16_f32 v169,v170,v171
v_cvt_pk_bf16_f32 v185,v186,v187
v_mfma_f32_16x16x32_bf16 v[136:139],v[24:27],v[104:107],0
s_mov_b32 s40,1
ds_read_b128 a[192:195],v1 offset:12288
s_add_u32 s65,s63,17
ds_read_b128 a[196:199],v2 offset:12288
s_cmp_eq_u32 s3,0
s_cselect_b32 s65,16,s65
s_cselect_b32 s41,1,0
ds_read_b128 a[200:203],v1 offset:12416
s_cmp_eq_u32 s62,1
s_cselect_b32 s64,s65,s64
s_cselect_b32 s40,s41,s40
ds_write2st64_b64 v12,v[160:161],v[176:177] offset0:0 offset1:2
s_add_u32 s65,s63,29
s_cmp_eq_u32 s62,2
s_cselect_b32 s64,s65,s64
s_waitcnt lgkmcnt(6)
v_mfma_f32_16x16x32_bf16 v[56:59],a[204:207],a[180:183],v[56:59]
s_cselect_b32 s40,0,s40
ds_read_b128 a[204:207],v2 offset:12416
s_add_u32 s65,s63,41
s_waitcnt lgkmcnt(6)
v_mfma_f32_16x16x32_bf16 v[56:59],a[208:211],a[184:187],v[56:59]
s_cmp_eq_u32 s62,3
ds_read_b128 a[208:211],v1 offset:12544
s_cselect_b32 s64,s65,s64
s_cselect_b32 s40,0,s40
s_mul_i32 s64,s64,6144
ds_write2st64_b64 v20,v[164:165],v[180:181] offset0:0 offset1:2
v_pk_mul_f32 v[172:173],v[172:173],v[144:145] op_sel_hi:[1,0]
v_pk_mul_f32 v[174:175],v[174:175],v[144:145] op_sel_hi:[1,0]
v_pk_mul_f32 v[188:189],v[188:189],v[144:145] op_sel_hi:[1,0]
v_pk_mul_f32 v[190:191],v[190:191],v[144:145] op_sel_hi:[1,0]
v_cvt_pk_bf16_f32 v172,v172,v173
v_cvt_pk_bf16_f32 v188,v188,v189
s_waitcnt lgkmcnt(4)
v_mfma_f32_16x16x32_bf16 v[56:59],a[212:215],a[188:191],v[56:59]
s_add_u32 s41,s48,s64
ds_read_b128 a[212:215],v2 offset:12544
v_cvt_pk_bf16_f32 v173,v174,v175
v_mfma_f32_16x16x32_bf16 v[60:63],a[216:219],a[168:171],0
s_cmp_ge_u32 s69,8
ds_read_b128 a[216:219],v1 offset:18432
v_cvt_pk_bf16_f32 v189,v190,v191
v_mfma_f32_16x16x32_bf16 v[60:63],a[220:223],a[172:175],v[60:63]
s_cselect_b32 s41,166723584,s41
ds_read_b128 a[220:223],v2 offset:18432
v_max3_f32 v141,v56,v57,v58
v_mfma_f32_16x16x32_bf16 v[60:63],a[224:227],a[176:179],v[60:63]
s_mov_b32 s28,s41
ds_read_b128 a[224:227],v1 offset:18560
s_mov_b32 s29,s24
v_mfma_f32_16x16x32_bf16 v[60:63],a[228:231],a[180:183],v[60:63]
s_add_u32 s25,s22,12288
ds_read_b128 a[228:231],v2 offset:18560
s_add_u32 s26,s22,24576
ds_write2st64_b64 v21,v[168:169],v[184:185] offset0:0 offset1:2
v_pk_mul_f32 v[192:193],v[192:193],v[144:145] op_sel_hi:[1,0]
v_pk_mul_f32 v[194:195],v[194:195],v[144:145] op_sel_hi:[1,0]
v_cvt_pk_bf16_f32 v192,v192,v193
v_cvt_pk_bf16_f32 v193,v194,v195
v_mfma_f32_16x16x32_bf16 v[60:63],a[232:235],a[184:187],v[60:63]
s_add_u32 m0,s23,12288
ds_read_b128 a[232:235],v1 offset:18688
buffer_load_dwordx4 v7,s[8:11],s21 offen offset:0 lds
v_mfma_f32_16x16x32_bf16 v[60:63],a[236:239],a[188:191],v[60:63]
buffer_load_dwordx4 v8,s[8:11],s21 offen offset:1024 lds
v_mfma_f32_16x16x32_bf16 v[64:67],a[192:195],a[96:99],0
buffer_load_dwordx4 v9,s[8:11],s21 offen offset:2048 lds
v_mfma_f32_16x16x32_bf16 v[64:67],a[196:199],a[100:103],v[64:67]
s_add_u32 s21,s21,12288
ds_read_b128 a[236:239],v2 offset:18688
s_add_u32 m0,s22,0
v_mfma_f32_16x16x32_bf16 v[64:67],a[200:203],a[104:107],v[64:67]
buffer_load_dwordx4 v7,s[4:7],s20 offen offset:0 lds
ds_write2st64_b64 v22,v[172:173],v[188:189] offset0:0 offset1:2
v_pk_mul_f32 v[196:197],v[196:197],v[144:145] op_sel_hi:[1,0]
v_pk_mul_f32 v[198:199],v[198:199],v[144:145] op_sel_hi:[1,0]
v_max3_f32 v141,v141,v59,v60
v_max3_f32 v141,v141,v61,v62
s_waitcnt lgkmcnt(3)
v_mfma_f32_16x16x32_bf16 v[64:67],a[204:207],a[108:111],v[64:67]
v_max_f32 v141,v141,v63
v_mov_b32 v142,v141
v_mfma_f32_16x16x32_bf16 v[64:67],a[208:211],a[112:115],v[64:67]
v_cvt_pk_bf16_f32 v196,v196,v197
v_permlane32_swap_b32 v142,v141
v_mfma_f32_16x16x32_bf16 v[64:67],a[212:215],a[116:119],v[64:67]
ds_write_b64 v12,v[192:193] offset:2048
v_mfma_f32_16x16x32_bf16 v[72:75],a[192:195],a[120:123],0
v_max_f32 v141,v141,v142
v_mov_b32 v142,v141
v_cvt_pk_bf16_f32 v197,v198,v199
ds_write_b64 v20,v[196:197] offset:2048
v_pk_mul_f32 v[200:201],v[200:201],v[144:145] op_sel_hi:[1,0]
v_pk_mul_f32 v[202:203],v[202:203],v[144:145] op_sel_hi:[1,0]
v_permlane16_swap_b32 v142,v141
v_max_f32 v141,v141,v142
v_mfma_f32_16x16x32_bf16 v[72:75],a[196:199],a[124:127],v[72:75]
buffer_load_dwordx4 v8,s[4:7],s20 offen offset:1024 lds
v_mfma_f32_16x16x32_bf16 v[72:75],a[200:203],a[128:131],v[72:75]
v_mul_f32_e64 v19,-s36,v141
v_fma_f32 v56,v56,s36,v19
v_mfma_f32_16x16x32_bf16 v[72:75],a[204:207],a[132:135],v[72:75]
v_fma_f32 v57,v57,s36,v19
v_fma_f32 v58,v58,s36,v19
v_mfma_f32_16x16x32_bf16 v[72:75],a[208:211],a[136:139],v[72:75]
v_fma_f32 v59,v59,s36,v19
v_fma_f32 v60,v60,s36,v19
v_mfma_f32_16x16x32_bf16 v[72:75],a[212:215],a[140:143],v[72:75]
v_fma_f32 v61,v61,s36,v19
v_fma_f32 v62,v62,s36,v19
v_fma_f32 v63,v63,s36,v19
v_exp_f32 v56,v56
v_pk_mul_f32 v[204:205],v[204:205],v[144:145] op_sel_hi:[1,0]
v_pk_mul_f32 v[206:207],v[206:207],v[144:145] op_sel_hi:[1,0]
v_exp_f32 v57,v57
v_exp_f32 v58,v58
v_mfma_f32_16x16x32_bf16 v[80:83],a[192:195],a[144:147],0
v_exp_f32 v59,v59
v_mfma_f32_16x16x32_bf16 v[80:83],a[196:199],a[148:151],v[80:83]
v_exp_f32 v60,v60
v_mfma_f32_16x16x32_bf16 v[80:83],a[200:203],a[152:155],v[80:83]
v_exp_f32 v61,v61
v_mfma_f32_16x16x32_bf16 v[80:83],a[204:207],a[156:159],v[80:83]
v_exp_f32 v62,v62
v_mfma_f32_16x16x32_bf16 v[80:83],a[208:211],a[160:163],v[80:83]
buffer_load_dwordx4 v9,s[4:7],s20 offen offset:2048 lds
v_mfma_f32_16x16x32_bf16 v[80:83],a[212:215],a[164:167],v[80:83]
s_add_u32 s20,s20,12288
v_exp_f32 v63,v63
v_mfma_f32_16x16x32_bf16 v[88:91],a[192:195],a[168:171],0
v_cvt_pk_bf16_f32 v108,v56,v57
v_cvt_pk_bf16_f32 v109,v58,v59
v_mfma_f32_16x16x32_bf16 v[88:91],a[196:199],a[172:175],v[88:91]
v_cvt_pk_bf16_f32 v110,v60,v61
v_cvt_pk_bf16_f32 v111,v62,v63
v_mfma_f32_16x16x32_bf16 v[88:91],a[200:203],a[176:179],v[88:91]
v_fma_f32 v64,v64,s36,v16
v_fma_f32 v65,v65,s36,v16
v_mfma_f32_16x16x32_bf16 v[140:143],v[24:27],v[108:111],0
v_fma_f32 v66,v66,s36,v16
v_fma_f32 v67,v67,s36,v16
v_mfma_f32_16x16x32_bf16 v[88:91],a[204:207],a[180:183],v[88:91]
v_fma_f32 v72,v72,s36,v17
v_fma_f32 v73,v73,s36,v17
v_mfma_f32_16x16x32_bf16 v[88:91],a[208:211],a[184:187],v[88:91]
v_fma_f32 v74,v74,s36,v17
v_fma_f32 v75,v75,s36,v17
v_mfma_f32_16x16x32_bf16 v[88:91],a[212:215],a[188:191],v[88:91]
v_cvt_pk_bf16_f32 v200,v200,v201
v_exp_f32 v64,v64
v_mfma_f32_16x16x32_bf16 v[68:71],a[216:219],a[96:99],0
v_exp_f32 v65,v65
v_mfma_f32_16x16x32_bf16 v[68:71],a[220:223],a[100:103],v[68:71]
v_exp_f32 v66,v66
v_mfma_f32_16x16x32_bf16 v[68:71],a[224:227],a[104:107],v[68:71]
v_exp_f32 v67,v67
v_mfma_f32_16x16x32_bf16 v[68:71],a[228:231],a[108:111],v[68:71]
s_waitcnt lgkmcnt(0)
v_exp_f32 v72,v72
v_mfma_f32_16x16x32_bf16 v[68:71],a[232:235],a[112:115],v[68:71]
v_exp_f32 v73,v73
v_mfma_f32_16x16x32_bf16 v[68:71],a[236:239],a[116:119],v[68:71]
v_exp_f32 v74,v74
v_mfma_f32_16x16x32_bf16 v[76:79],a[216:219],a[120:123],0
v_exp_f32 v75,v75
v_mfma_f32_16x16x32_bf16 v[76:79],a[220:223],a[124:127],v[76:79]
v_cvt_pk_bf16_f32 v204,v204,v205
v_cvt_pk_bf16_f32 v201,v202,v203
v_mfma_f32_16x16x32_bf16 v[76:79],a[224:227],a[128:131],v[76:79]
ds_write_b64 v21,v[200:201] offset:2048
v_mfma_f32_16x16x32_bf16 v[76:79],a[228:231],a[132:135],v[76:79]
v_cvt_pk_bf16_f32 v205,v206,v207
v_cvt_pk_bf16_f32 v112,v64,v65
v_mfma_f32_16x16x32_bf16 v[76:79],a[232:235],a[136:139],v[76:79]
s_waitcnt vmcnt(6)
s_barrier
v_mfma_f32_16x16x32_bf16 v[76:79],a[236:239],a[140:143],v[76:79]
ds_write_b64 v22,v[204:205] offset:2048
v_mfma_f32_16x16x32_bf16 v[84:87],a[216:219],a[144:147],0
ds_read_b64_tr_b16 a[240:241],v3 offset:0
ds_read_b64_tr_b16 a[242:243],v3 offset:6144
v_mfma_f32_16x16x32_bf16 v[84:87],a[220:223],a[148:151],v[84:87]
ds_read_b64_tr_b16 a[244:245],v4 offset:0
ds_read_b64_tr_b16 a[246:247],v4 offset:6144
v_mfma_f32_16x16x32_bf16 v[84:87],a[224:227],a[152:155],v[84:87]
v_cvt_pk_bf16_f32 v113,v66,v67
v_cvt_pk_bf16_f32 v116,v72,v73
v_mfma_f32_16x16x32_bf16 v[84:87],a[228:231],a[156:159],v[84:87]
ds_read_b64_tr_b16 a[248:249],v5 offset:0
ds_read_b64_tr_b16 a[250:251],v5 offset:6144
v_mfma_f32_16x16x32_bf16 v[84:87],a[232:235],a[160:163],v[84:87]
v_cvt_pk_bf16_f32 v117,v74,v75
v_mfma_f32_16x16x32_bf16 v[84:87],a[236:239],a[164:167],v[84:87]
ds_read_b64_tr_b16 a[252:253],v6 offset:0
ds_read_b64_tr_b16 a[254:255],v6 offset:6144
v_mfma_f32_16x16x32_bf16 v[92:95],a[216:219],a[168:171],0
v_mfma_f32_16x16x32_bf16 v[92:95],a[220:223],a[172:175],v[92:95]
v_mfma_f32_16x16x32_bf16 v[92:95],a[224:227],a[176:179],v[92:95]
v_mfma_f32_16x16x32_bf16 v[92:95],a[228:231],a[180:183],v[92:95]
v_mfma_f32_16x16x32_bf16 v[92:95],a[232:235],a[184:187],v[92:95]
v_mfma_f32_16x16x32_bf16 v[92:95],a[236:239],a[188:191],v[92:95]
s_waitcnt lgkmcnt(4)
v_mfma_f32_16x16x32_bf16 v[160:163],a[240:243],v[96:99],0
s_add_u32 m0,s23,24576
ds_read_b128 a[192:195],v1 offset:24576
v_fma_f32 v68,v68,s36,v16
v_mfma_f32_16x16x32_bf16 v[208:211],a[240:243],v[100:103],0
buffer_load_dwordx4 v7,s[8:11],s21 offen offset:0 lds
v_mfma_f32_16x16x32_bf16 a[0:3],a[240:243],v[104:107],0
ds_read_b128 a[196:199],v2 offset:24576
v_fma_f32 v69,v69,s36,v16
v_mfma_f32_16x16x32_bf16 a[48:51],a[240:243],v[108:111],0
ds_read_b64_tr_b16 a[240:241],v3 offset:128
ds_read_b64_tr_b16 a[242:243],v3 offset:6272
v_mfma_f32_16x16x32_bf16 v[164:167],a[244:247],v[96:99],0
ds_read_b128 a[200:203],v1 offset:24704
v_fma_f32 v70,v70,s36,v16
v_mfma_f32_16x16x32_bf16 v[212:215],a[244:247],v[100:103],0
ds_read_b128 a[204:207],v2 offset:24704
v_fma_f32 v71,v71,s36,v16
v_mfma_f32_16x16x32_bf16 a[4:7],a[244:247],v[104:107],0
ds_read_b128 a[208:211],v1 offset:24832
v_fma_f32 v76,v76,s36,v17
v_mfma_f32_16x16x32_bf16 a[52:55],a[244:247],v[108:111],0
s_waitcnt lgkmcnt(7)
ds_read_b64_tr_b16 a[244:245],v4 offset:128
ds_read_b64_tr_b16 a[246:247],v4 offset:6272
v_mfma_f32_16x16x32_bf16 v[168:171],a[248:251],v[96:99],0
ds_read_b128 a[212:215],v2 offset:24832
v_fma_f32 v77,v77,s36,v17
v_mfma_f32_16x16x32_bf16 v[216:219],a[248:251],v[100:103],0
buffer_load_dwordx4 v8,s[8:11],s21 offen offset:1024 lds
v_mfma_f32_16x16x32_bf16 a[8:11],a[248:251],v[104:107],0
ds_read_b128 a[216:219],v1 offset:30720
v_fma_f32 v78,v78,s36,v17
v_mfma_f32_16x16x32_bf16 a[56:59],a[248:251],v[108:111],0
ds_read_b64_tr_b16 a[248:249],v5 offset:128
ds_read_b64_tr_b16 a[250:251],v5 offset:6272
v_mfma_f32_16x16x32_bf16 v[172:175],a[252:255],v[96:99],0
ds_read_b128 a[220:223],v2 offset:30720
v_fma_f32 v79,v79,s36,v17
v_mfma_f32_16x16x32_bf16 v[220:223],a[252:255],v[100:103],0
ds_read_b128 a[224:227],v1 offset:30848
v_fma_f32 v80,v80,s36,v18
v_mfma_f32_16x16x32_bf16 a[12:15],a[252:255],v[104:107],0
ds_read_b128 a[228:231],v2 offset:30848
v_fma_f32 v81,v81,s36,v18
v_mfma_f32_16x16x32_bf16 a[60:63],a[252:255],v[108:111],0
s_waitcnt lgkmcnt(7)
ds_read_b64_tr_b16 a[252:253],v6 offset:128
ds_read_b64_tr_b16 a[254:255],v6 offset:6272
v_mfma_f32_16x16x32_bf16 v[176:179],a[240:243],v[96:99],0
ds_read_b128 a[232:235],v1 offset:30976
v_fma_f32 v82,v82,s36,v18
v_mfma_f32_16x16x32_bf16 v[224:227],a[240:243],v[100:103],0
buffer_load_dwordx4 v9,s[8:11],s21 offen offset:2048 lds
v_mfma_f32_16x16x32_bf16 a[16:19],a[240:243],v[104:107],0
s_add_u32 s21,s21,12288
ds_read_b128 a[236:239],v2 offset:30976
v_fma_f32 v83,v83,s36,v18
v_mfma_f32_16x16x32_bf16 a[64:67],a[240:243],v[108:111],0
s_add_u32 m0,s22,12288
ds_read_b64_tr_b16 a[240:241],v3 offset:256
ds_read_b64_tr_b16 a[242:243],v3 offset:6400
v_mfma_f32_16x16x32_bf16 v[180:183],a[244:247],v[96:99],0
v_fma_f32 v84,v84,s36,v18
v_fma_f32 v85,v85,s36,v18
v_mfma_f32_16x16x32_bf16 v[228:231],a[244:247],v[100:103],0
v_fma_f32 v86,v86,s36,v18
v_fma_f32 v87,v87,s36,v18
v_mfma_f32_16x16x32_bf16 a[20:23],a[244:247],v[104:107],0
v_fma_f32 v88,v88,s36,v19
v_fma_f32 v89,v89,s36,v19
v_mfma_f32_16x16x32_bf16 a[68:71],a[244:247],v[108:111],0
s_waitcnt lgkmcnt(4)
ds_read_b64_tr_b16 a[244:245],v4 offset:256
ds_read_b64_tr_b16 a[246:247],v4 offset:6400
v_mfma_f32_16x16x32_bf16 v[184:187],a[248:251],v[96:99],0
buffer_load_dwordx4 v7,s[4:7],s20 offen offset:0 lds
v_mfma_f32_16x16x32_bf16 v[232:235],a[248:251],v[100:103],0
v_fma_f32 v90,v90,s36,v19
v_fma_f32 v91,v91,s36,v19
v_mfma_f32_16x16x32_bf16 a[24:27],a[248:251],v[104:107],0
v_fma_f32 v92,v92,s36,v19
v_fma_f32 v93,v93,s36,v19
v_mfma_f32_16x16x32_bf16 a[72:75],a[248:251],v[108:111],0
ds_read_b64_tr_b16 a[248:249],v5 offset:256
ds_read_b64_tr_b16 a[250:251],v5 offset:6400
v_mfma_f32_16x16x32_bf16 v[188:191],a[252:255],v[96:99],0
v_fma_f32 v94,v94,s36,v19
v_fma_f32 v95,v95,s36,v19
v_mfma_f32_16x16x32_bf16 v[236:239],a[252:255],v[100:103],0
v_exp_f32 v68,v68
v_mfma_f32_16x16x32_bf16 a[28:31],a[252:255],v[104:107],0
v_exp_f32 v69,v69
v_mfma_f32_16x16x32_bf16 a[76:79],a[252:255],v[108:111],0
s_waitcnt lgkmcnt(2)
ds_read_b64_tr_b16 a[252:253],v6 offset:256
ds_read_b64_tr_b16 a[254:255],v6 offset:6400
v_mfma_f32_16x16x32_bf16 v[192:195],a[240:243],v[96:99],0
buffer_load_dwordx4 v8,s[4:7],s20 offen offset:1024 lds
v_mfma_f32_16x16x32_bf16 v[240:243],a[240:243],v[100:103],0
v_exp_f32 v70,v70
v_mfma_f32_16x16x32_bf16 a[32:35],a[240:243],v[104:107],0
v_exp_f32 v71,v71
v_mfma_f32_16x16x32_bf16 a[80:83],a[240:243],v[108:111],0
v_exp_f32 v76,v76
v_mfma_f32_16x16x32_bf16 v[196:199],a[244:247],v[96:99],0
v_exp_f32 v77,v77
v_mfma_f32_16x16x32_bf16 v[244:247],a[244:247],v[100:103],0
v_exp_f32 v78,v78
v_mfma_f32_16x16x32_bf16 a[36:39],a[244:247],v[104:107],0
v_exp_f32 v79,v79
v_mfma_f32_16x16x32_bf16 a[84:87],a[244:247],v[108:111],0
s_waitcnt lgkmcnt(0)
v_exp_f32 v80,v80
v_mfma_f32_16x16x32_bf16 v[200:203],a[248:251],v[96:99],0
buffer_load_dwordx4 v9,s[4:7],s20 offen offset:2048 lds
v_mfma_f32_16x16x32_bf16 v[248:251],a[248:251],v[100:103],0
s_add_u32 s20,s20,12288
v_exp_f32 v81,v81
v_mfma_f32_16x16x32_bf16 a[40:43],a[248:251],v[104:107],0
v_exp_f32 v82,v82
v_mfma_f32_16x16x32_bf16 a[88:91],a[248:251],v[108:111],0
v_exp_f32 v83,v83
v_mfma_f32_16x16x32_bf16 v[204:207],a[252:255],v[96:99],0
v_exp_f32 v84,v84
v_mfma_f32_16x16x32_bf16 v[252:255],a[252:255],v[100:103],0
v_exp_f32 v85,v85
v_mfma_f32_16x16x32_bf16 a[44:47],a[252:255],v[104:107],0
v_exp_f32 v86,v86
v_mfma_f32_16x16x32_bf16 a[92:95],a[252:255],v[108:111],0
v_exp_f32 v87,v87
v_mfma_f32_16x16x32_bf16 v[32:35],a[192:195],a[96:99],0
v_exp_f32 v88,v88
v_mfma_f32_16x16x32_bf16 v[32:35],a[196:199],a[100:103],v[32:35]
v_exp_f32 v89,v89
v_mfma_f32_16x16x32_bf16 v[32:35],a[200:203],a[104:107],v[32:35]
v_exp_f32 v90,v90
v_mfma_f32_16x16x32_bf16 v[32:35],a[204:207],a[108:111],v[32:35]
v_exp_f32 v91,v91
v_mfma_f32_16x16x32_bf16 v[32:35],a[208:211],a[112:115],v[32:35]
v_exp_f32 v92,v92
v_mfma_f32_16x16x32_bf16 v[32:35],a[212:215],a[116:119],v[32:35]
v_exp_f32 v93,v93
v_mfma_f32_16x16x32_bf16 v[40:43],a[192:195],a[120:123],0
v_exp_f32 v94,v94
v_mfma_f32_16x16x32_bf16 v[40:43],a[196:199],a[124:127],v[40:43]
v_exp_f32 v95,v95
v_mfma_f32_16x16x32_bf16 v[40:43],a[200:203],a[128:131],v[40:43]
v_cvt_pk_bf16_f32 v114,v68,v69
v_cvt_pk_bf16_f32 v115,v70,v71
v_mfma_f32_16x16x32_bf16 v[40:43],a[204:207],a[132:135],v[40:43]
v_cvt_pk_bf16_f32 v118,v76,v77
v_cvt_pk_bf16_f32 v119,v78,v79
v_mfma_f32_16x16x32_bf16 v[128:131],v[24:27],v[112:115],v[128:131]
v_cvt_pk_bf16_f32 v120,v80,v81
v_cvt_pk_bf16_f32 v121,v82,v83
v_mfma_f32_16x16x32_bf16 v[132:135],v[24:27],v[116:119],v[132:135]
v_cvt_pk_bf16_f32 v122,v84,v85
v_cvt_pk_bf16_f32 v123,v86,v87
v_mfma_f32_16x16x32_bf16 v[40:43],a[208:211],a[136:139],v[40:43]
v_cvt_pk_bf16_f32 v124,v88,v89
v_cvt_pk_bf16_f32 v125,v90,v91
v_mfma_f32_16x16x32_bf16 v[136:139],v[24:27],v[120:123],v[136:139]
v_cvt_pk_bf16_f32 v126,v92,v93
v_cvt_pk_bf16_f32 v127,v94,v95
v_mfma_f32_16x16x32_bf16 v[40:43],a[212:215],a[140:143],v[40:43]
v_fma_f32 v32,v32,s36,v16
v_fma_f32 v33,v33,s36,v16
v_mfma_f32_16x16x32_bf16 v[140:143],v[24:27],v[124:127],v[140:143]
v_fma_f32 v34,v34,s36,v16
v_fma_f32 v35,v35,s36,v16
v_mfma_f32_16x16x32_bf16 v[48:51],a[192:195],a[144:147],0
v_exp_f32 v32,v32
v_mfma_f32_16x16x32_bf16 v[48:51],a[196:199],a[148:151],v[48:51]
v_fma_f32 v40,v40,s36,v17
v_fma_f32 v41,v41,s36,v17
v_mfma_f32_16x16x32_bf16 v[48:51],a[200:203],a[152:155],v[48:51]
v_fma_f32 v42,v42,s36,v17
v_fma_f32 v43,v43,s36,v17
v_mfma_f32_16x16x32_bf16 v[48:51],a[204:207],a[156:159],v[48:51]
v_exp_f32 v33,v33
v_mfma_f32_16x16x32_bf16 v[48:51],a[208:211],a[160:163],v[48:51]
v_exp_f32 v34,v34
v_mfma_f32_16x16x32_bf16 v[48:51],a[212:215],a[164:167],v[48:51]
v_exp_f32 v35,v35
v_mfma_f32_16x16x32_bf16 v[56:59],a[192:195],a[168:171],0
v_exp_f32 v40,v40
v_mfma_f32_16x16x32_bf16 v[56:59],a[196:199],a[172:175],v[56:59]
v_exp_f32 v41,v41
v_mfma_f32_16x16x32_bf16 v[56:59],a[200:203],a[176:179],v[56:59]
v_exp_f32 v42,v42
v_mfma_f32_16x16x32_bf16 v[56:59],a[204:207],a[180:183],v[56:59]
v_exp_f32 v43,v43
v_mfma_f32_16x16x32_bf16 v[56:59],a[208:211],a[184:187],v[56:59]
v_cvt_pk_bf16_f32 v96,v32,v33
v_cvt_pk_bf16_f32 v97,v34,v35
v_mfma_f32_16x16x32_bf16 v[56:59],a[212:215],a[188:191],v[56:59]
v_cvt_pk_bf16_f32 v100,v40,v41
v_cvt_pk_bf16_f32 v101,v42,v43
v_mfma_f32_16x16x32_bf16 v[36:39],a[216:219],a[96:99],0
v_mfma_f32_16x16x32_bf16 v[36:39],a[220:223],a[100:103],v[36:39]
v_mfma_f32_16x16x32_bf16 v[36:39],a[224:227],a[104:107],v[36:39]
v_mfma_f32_16x16x32_bf16 v[36:39],a[228:231],a[108:111],v[36:39]
v_mfma_f32_16x16x32_bf16 v[36:39],a[232:235],a[112:115],v[36:39]
v_mfma_f32_16x16x32_bf16 v[36:39],a[236:239],a[116:119],v[36:39]
v_mfma_f32_16x16x32_bf16 v[44:47],a[216:219],a[120:123],0
v_mfma_f32_16x16x32_bf16 v[44:47],a[220:223],a[124:127],v[44:47]
v_mfma_f32_16x16x32_bf16 v[44:47],a[224:227],a[128:131],v[44:47]
v_mfma_f32_16x16x32_bf16 v[44:47],a[228:231],a[132:135],v[44:47]
v_mfma_f32_16x16x32_bf16 v[44:47],a[232:235],a[136:139],v[44:47]
s_waitcnt vmcnt(6)
s_barrier
v_mfma_f32_16x16x32_bf16 v[44:47],a[236:239],a[140:143],v[44:47]
ds_read_b64_tr_b16 a[240:241],v3 offset:12288
v_mfma_f32_16x16x32_bf16 v[52:55],a[216:219],a[144:147],0
ds_read_b64_tr_b16 a[242:243],v3 offset:18432
v_mfma_f32_16x16x32_bf16 v[52:55],a[220:223],a[148:151],v[52:55]
ds_read_b64_tr_b16 a[244:245],v4 offset:12288
v_mfma_f32_16x16x32_bf16 v[52:55],a[224:227],a[152:155],v[52:55]
ds_read_b64_tr_b16 a[246:247],v4 offset:18432
v_mfma_f32_16x16x32_bf16 v[52:55],a[228:231],a[156:159],v[52:55]
ds_read_b64_tr_b16 a[248:249],v5 offset:12288
v_mfma_f32_16x16x32_bf16 v[52:55],a[232:235],a[160:163],v[52:55]
ds_read_b64_tr_b16 a[250:251],v5 offset:18432
v_mfma_f32_16x16x32_bf16 v[52:55],a[236:239],a[164:167],v[52:55]
ds_read_b64_tr_b16 a[252:253],v6 offset:12288
v_mfma_f32_16x16x32_bf16 v[60:63],a[216:219],a[168:171],0
ds_read_b64_tr_b16 a[254:255],v6 offset:18432
v_mfma_f32_16x16x32_bf16 v[60:63],a[220:223],a[172:175],v[60:63]
v_mfma_f32_16x16x32_bf16 v[60:63],a[224:227],a[176:179],v[60:63]
v_mfma_f32_16x16x32_bf16 v[60:63],a[228:231],a[180:183],v[60:63]
v_mfma_f32_16x16x32_bf16 v[60:63],a[232:235],a[184:187],v[60:63]
v_mfma_f32_16x16x32_bf16 v[60:63],a[236:239],a[188:191],v[60:63]
s_waitcnt lgkmcnt(4)
v_mfma_f32_16x16x32_bf16 v[160:163],a[240:243],v[112:115],v[160:163]
s_add_u32 m0,s23,0
ds_read_b128 a[192:195],v1 offset:0
v_fma_f32 v36,v36,s36,v16
v_mfma_f32_16x16x32_bf16 v[208:211],a[240:243],v[116:119],v[208:211]
buffer_load_dwordx4 v7,s[8:11],s21 offen offset:0 lds
v_mfma_f32_16x16x32_bf16 a[0:3],a[240:243],v[120:123],a[0:3]
ds_read_b128 a[196:199],v2 offset:0
v_fma_f32 v37,v37,s36,v16
v_mfma_f32_16x16x32_bf16 a[48:51],a[240:243],v[124:127],a[48:51]
ds_read_b64_tr_b16 a[240:241],v3 offset:12416
ds_read_b64_tr_b16 a[242:243],v3 offset:18560
v_mfma_f32_16x16x32_bf16 v[164:167],a[244:247],v[112:115],v[164:167]
ds_read_b128 a[200:203],v1 offset:128
v_fma_f32 v38,v38,s36,v16
v_mfma_f32_16x16x32_bf16 v[212:215],a[244:247],v[116:119],v[212:215]
ds_read_b128 a[204:207],v2 offset:128
v_fma_f32 v39,v39,s36,v16
v_mfma_f32_16x16x32_bf16 a[4:7],a[244:247],v[120:123],a[4:7]
ds_read_b128 a[208:211],v1 offset:256
v_fma_f32 v44,v44,s36,v17
v_mfma_f32_16x16x32_bf16 a[52:55],a[244:247],v[124:127],a[52:55]
s_waitcnt lgkmcnt(7)
ds_read_b64_tr_b16 a[244:245],v4 offset:12416
ds_read_b64_tr_b16 a[246:247],v4 offset:18560
v_mfma_f32_16x16x32_bf16 v[168:171],a[248:251],v[112:115],v[168:171]
ds_read_b128 a[212:215],v2 offset:256
v_fma_f32 v45,v45,s36,v17
v_mfma_f32_16x16x32_bf16 v[216:219],a[248:251],v[116:119],v[216:219]
buffer_load_dwordx4 v8,s[8:11],s21 offen offset:1024 lds
v_mfma_f32_16x16x32_bf16 a[8:11],a[248:251],v[120:123],a[8:11]
ds_read_b128 a[216:219],v1 offset:6144
v_fma_f32 v46,v46,s36,v17
v_mfma_f32_16x16x32_bf16 a[56:59],a[248:251],v[124:127],a[56:59]
ds_read_b64_tr_b16 a[248:249],v5 offset:12416
ds_read_b64_tr_b16 a[250:251],v5 offset:18560
v_mfma_f32_16x16x32_bf16 v[172:175],a[252:255],v[112:115],v[172:175]
ds_read_b128 a[220:223],v2 offset:6144
v_fma_f32 v47,v47,s36,v17
v_mfma_f32_16x16x32_bf16 v[220:223],a[252:255],v[116:119],v[220:223]
ds_read_b128 a[224:227],v1 offset:6272
v_fma_f32 v48,v48,s36,v18
v_mfma_f32_16x16x32_bf16 a[12:15],a[252:255],v[120:123],a[12:15]
ds_read_b128 a[228:231],v2 offset:6272
v_fma_f32 v49,v49,s36,v18
v_mfma_f32_16x16x32_bf16 a[60:63],a[252:255],v[124:127],a[60:63]
s_waitcnt lgkmcnt(7)
ds_read_b64_tr_b16 a[252:253],v6 offset:12416
ds_read_b64_tr_b16 a[254:255],v6 offset:18560
v_mfma_f32_16x16x32_bf16 v[176:179],a[240:243],v[112:115],v[176:179]
ds_read_b128 a[232:235],v1 offset:6400
v_fma_f32 v50,v50,s36,v18
v_mfma_f32_16x16x32_bf16 v[224:227],a[240:243],v[116:119],v[224:227]
buffer_load_dwordx4 v9,s[8:11],s21 offen offset:2048 lds
v_mfma_f32_16x16x32_bf16 a[16:19],a[240:243],v[120:123],a[16:19]
s_add_u32 s21,s21,12288
ds_read_b128 a[236:239],v2 offset:6400
v_fma_f32 v51,v51,s36,v18
v_mfma_f32_16x16x32_bf16 a[64:67],a[240:243],v[124:127],a[64:67]
s_add_u32 m0,s22,24576
ds_read_b64_tr_b16 a[240:241],v3 offset:12544
ds_read_b64_tr_b16 a[242:243],v3 offset:18688
v_mfma_f32_16x16x32_bf16 v[180:183],a[244:247],v[112:115],v[180:183]
v_fma_f32 v52,v52,s36,v18
v_fma_f32 v53,v53,s36,v18
v_mfma_f32_16x16x32_bf16 v[228:231],a[244:247],v[116:119],v[228:231]
v_fma_f32 v54,v54,s36,v18
v_fma_f32 v55,v55,s36,v18
v_mfma_f32_16x16x32_bf16 a[20:23],a[244:247],v[120:123],a[20:23]
v_fma_f32 v56,v56,s36,v19
v_fma_f32 v57,v57,s36,v19
v_mfma_f32_16x16x32_bf16 a[68:71],a[244:247],v[124:127],a[68:71]
s_waitcnt lgkmcnt(4)
ds_read_b64_tr_b16 a[244:245],v4 offset:12544
ds_read_b64_tr_b16 a[246:247],v4 offset:18688
v_mfma_f32_16x16x32_bf16 v[184:187],a[248:251],v[112:115],v[184:187]
buffer_load_dwordx4 v7,s[4:7],s20 offen offset:0 lds
v_mfma_f32_16x16x32_bf16 v[232:235],a[248:251],v[116:119],v[232:235]
v_fma_f32 v58,v58,s36,v19
v_fma_f32 v59,v59,s36,v19
v_mfma_f32_16x16x32_bf16 a[24:27],a[248:251],v[120:123],a[24:27]
v_fma_f32 v60,v60,s36,v19
v_fma_f32 v61,v61,s36,v19
v_mfma_f32_16x16x32_bf16 a[72:75],a[248:251],v[124:127],a[72:75]
ds_read_b64_tr_b16 a[248:249],v5 offset:12544
ds_read_b64_tr_b16 a[250:251],v5 offset:18688
v_mfma_f32_16x16x32_bf16 v[188:191],a[252:255],v[112:115],v[188:191]
v_fma_f32 v62,v62,s36,v19
v_fma_f32 v63,v63,s36,v19
v_mfma_f32_16x16x32_bf16 v[236:239],a[252:255],v[116:119],v[236:239]
v_exp_f32 v36,v36
v_mfma_f32_16x16x32_bf16 a[28:31],a[252:255],v[120:123],a[28:31]
v_exp_f32 v37,v37
v_mfma_f32_16x16x32_bf16 a[76:79],a[252:255],v[124:127],a[76:79]
s_waitcnt lgkmcnt(2)
ds_read_b64_tr_b16 a[252:253],v6 offset:12544
ds_read_b64_tr_b16 a[254:255],v6 offset:18688
v_mfma_f32_16x16x32_bf16 v[192:195],a[240:243],v[112:115],v[192:195]
buffer_load_dwordx4 v8,s[4:7],s20 offen offset:1024 lds
v_mfma_f32_16x16x32_bf16 v[240:243],a[240:243],v[116:119],v[240:243]
v_exp_f32 v38,v38
v_mfma_f32_16x16x32_bf16 a[32:35],a[240:243],v[120:123],a[32:35]
v_exp_f32 v39,v39
v_mfma_f32_16x16x32_bf16 a[80:83],a[240:243],v[124:127],a[80:83]
v_exp_f32 v44,v44
v_mfma_f32_16x16x32_bf16 v[196:199],a[244:247],v[112:115],v[196:199]
v_exp_f32 v45,v45
v_mfma_f32_16x16x32_bf16 v[244:247],a[244:247],v[116:119],v[244:247]
v_exp_f32 v46,v46
v_mfma_f32_16x16x32_bf16 a[36:39],a[244:247],v[120:123],a[36:39]
v_exp_f32 v47,v47
v_mfma_f32_16x16x32_bf16 a[84:87],a[244:247],v[124:127],a[84:87]
s_waitcnt lgkmcnt(0)
v_exp_f32 v48,v48
v_mfma_f32_16x16x32_bf16 v[200:203],a[248:251],v[112:115],v[200:203]
buffer_load_dwordx4 v9,s[4:7],s20 offen offset:2048 lds
v_mfma_f32_16x16x32_bf16 v[248:251],a[248:251],v[116:119],v[248:251]
s_add_u32 s20,s20,12288
v_exp_f32 v49,v49
v_mfma_f32_16x16x32_bf16 a[40:43],a[248:251],v[120:123],a[40:43]
v_exp_f32 v50,v50
v_mfma_f32_16x16x32_bf16 a[88:91],a[248:251],v[124:127],a[88:91]
v_exp_f32 v51,v51
v_mfma_f32_16x16x32_bf16 v[204:207],a[252:255],v[112:115],v[204:207]
v_exp_f32 v52,v52
v_mfma_f32_16x16x32_bf16 v[252:255],a[252:255],v[116:119],v[252:255]
v_exp_f32 v53,v53
v_mfma_f32_16x16x32_bf16 a[44:47],a[252:255],v[120:123],a[44:47]
v_exp_f32 v54,v54
v_mfma_f32_16x16x32_bf16 a[92:95],a[252:255],v[124:127],a[92:95]
v_exp_f32 v55,v55
v_mfma_f32_16x16x32_bf16 v[64:67],a[192:195],a[96:99],0
v_exp_f32 v56,v56
v_mfma_f32_16x16x32_bf16 v[64:67],a[196:199],a[100:103],v[64:67]
v_exp_f32 v57,v57
v_mfma_f32_16x16x32_bf16 v[64:67],a[200:203],a[104:107],v[64:67]
v_exp_f32 v58,v58
v_mfma_f32_16x16x32_bf16 v[64:67],a[204:207],a[108:111],v[64:67]
v_exp_f32 v59,v59
v_mfma_f32_16x16x32_bf16 v[64:67],a[208:211],a[112:115],v[64:67]
v_exp_f32 v60,v60
v_mfma_f32_16x16x32_bf16 v[64:67],a[212:215],a[116:119],v[64:67]
v_exp_f32 v61,v61
v_mfma_f32_16x16x32_bf16 v[72:75],a[192:195],a[120:123],0
v_exp_f32 v62,v62
v_mfma_f32_16x16x32_bf16 v[72:75],a[196:199],a[124:127],v[72:75]
v_exp_f32 v63,v63
v_mfma_f32_16x16x32_bf16 v[72:75],a[200:203],a[128:131],v[72:75]
v_cvt_pk_bf16_f32 v98,v36,v37
v_cvt_pk_bf16_f32 v99,v38,v39
v_mfma_f32_16x16x32_bf16 v[72:75],a[204:207],a[132:135],v[72:75]
v_cvt_pk_bf16_f32 v102,v44,v45
v_cvt_pk_bf16_f32 v103,v46,v47
v_mfma_f32_16x16x32_bf16 v[128:131],v[24:27],v[96:99],v[128:131]
v_cvt_pk_bf16_f32 v104,v48,v49
v_cvt_pk_bf16_f32 v105,v50,v51
v_mfma_f32_16x16x32_bf16 v[132:135],v[24:27],v[100:103],v[132:135]
v_cvt_pk_bf16_f32 v106,v52,v53
v_cvt_pk_bf16_f32 v107,v54,v55
v_mfma_f32_16x16x32_bf16 v[72:75],a[208:211],a[136:139],v[72:75]
v_cvt_pk_bf16_f32 v108,v56,v57
v_cvt_pk_bf16_f32 v109,v58,v59
v_mfma_f32_16x16x32_bf16 v[136:139],v[24:27],v[104:107],v[136:139]
v_cvt_pk_bf16_f32 v110,v60,v61
v_cvt_pk_bf16_f32 v111,v62,v63
v_mfma_f32_16x16x32_bf16 v[72:75],a[212:215],a[140:143],v[72:75]
v_fma_f32 v64,v64,s36,v16
v_fma_f32 v65,v65,s36,v16
v_mfma_f32_16x16x32_bf16 v[140:143],v[24:27],v[108:111],v[140:143]
v_fma_f32 v66,v66,s36,v16
v_fma_f32 v67,v67,s36,v16
v_mfma_f32_16x16x32_bf16 v[80:83],a[192:195],a[144:147],0
v_exp_f32 v64,v64
v_mfma_f32_16x16x32_bf16 v[80:83],a[196:199],a[148:151],v[80:83]
v_fma_f32 v72,v72,s36,v17
v_fma_f32 v73,v73,s36,v17
v_mfma_f32_16x16x32_bf16 v[80:83],a[200:203],a[152:155],v[80:83]
v_fma_f32 v74,v74,s36,v17
v_fma_f32 v75,v75,s36,v17
v_mfma_f32_16x16x32_bf16 v[80:83],a[204:207],a[156:159],v[80:83]
v_exp_f32 v65,v65
v_mfma_f32_16x16x32_bf16 v[80:83],a[208:211],a[160:163],v[80:83]
v_exp_f32 v66,v66
v_mfma_f32_16x16x32_bf16 v[80:83],a[212:215],a[164:167],v[80:83]
v_exp_f32 v67,v67
v_mfma_f32_16x16x32_bf16 v[88:91],a[192:195],a[168:171],0
v_exp_f32 v72,v72
v_mfma_f32_16x16x32_bf16 v[88:91],a[196:199],a[172:175],v[88:91]
v_exp_f32 v73,v73
v_mfma_f32_16x16x32_bf16 v[88:91],a[200:203],a[176:179],v[88:91]
v_exp_f32 v74,v74
v_mfma_f32_16x16x32_bf16 v[88:91],a[204:207],a[180:183],v[88:91]
v_exp_f32 v75,v75
v_mfma_f32_16x16x32_bf16 v[88:91],a[208:211],a[184:187],v[88:91]
v_cvt_pk_bf16_f32 v112,v64,v65
v_cvt_pk_bf16_f32 v113,v66,v67
v_mfma_f32_16x16x32_bf16 v[88:91],a[212:215],a[188:191],v[88:91]
v_cvt_pk_bf16_f32 v116,v72,v73
v_cvt_pk_bf16_f32 v117,v74,v75
v_mfma_f32_16x16x32_bf16 v[68:71],a[216:219],a[96:99],0
v_mfma_f32_16x16x32_bf16 v[68:71],a[220:223],a[100:103],v[68:71]
v_mfma_f32_16x16x32_bf16 v[68:71],a[224:227],a[104:107],v[68:71]
v_mfma_f32_16x16x32_bf16 v[68:71],a[228:231],a[108:111],v[68:71]
v_mfma_f32_16x16x32_bf16 v[68:71],a[232:235],a[112:115],v[68:71]
v_mfma_f32_16x16x32_bf16 v[68:71],a[236:239],a[116:119],v[68:71]
v_mfma_f32_16x16x32_bf16 v[76:79],a[216:219],a[120:123],0
v_mfma_f32_16x16x32_bf16 v[76:79],a[220:223],a[124:127],v[76:79]
v_mfma_f32_16x16x32_bf16 v[76:79],a[224:227],a[128:131],v[76:79]
v_mfma_f32_16x16x32_bf16 v[76:79],a[228:231],a[132:135],v[76:79]
v_mfma_f32_16x16x32_bf16 v[76:79],a[232:235],a[136:139],v[76:79]
s_waitcnt vmcnt(6)
s_barrier
v_mfma_f32_16x16x32_bf16 v[76:79],a[236:239],a[140:143],v[76:79]
ds_read_b64_tr_b16 a[240:241],v3 offset:24576
v_mfma_f32_16x16x32_bf16 v[84:87],a[216:219],a[144:147],0
ds_read_b64_tr_b16 a[242:243],v3 offset:30720
v_mfma_f32_16x16x32_bf16 v[84:87],a[220:223],a[148:151],v[84:87]
ds_read_b64_tr_b16 a[244:245],v4 offset:24576
v_mfma_f32_16x16x32_bf16 v[84:87],a[224:227],a[152:155],v[84:87]
ds_read_b64_tr_b16 a[246:247],v4 offset:30720
v_mfma_f32_16x16x32_bf16 v[84:87],a[228:231],a[156:159],v[84:87]
ds_read_b64_tr_b16 a[248:249],v5 offset:24576
v_mfma_f32_16x16x32_bf16 v[84:87],a[232:235],a[160:163],v[84:87]
ds_read_b64_tr_b16 a[250:251],v5 offset:30720
v_mfma_f32_16x16x32_bf16 v[84:87],a[236:239],a[164:167],v[84:87]
ds_read_b64_tr_b16 a[252:253],v6 offset:24576
v_mfma_f32_16x16x32_bf16 v[92:95],a[216:219],a[168:171],0
ds_read_b64_tr_b16 a[254:255],v6 offset:30720
v_mfma_f32_16x16x32_bf16 v[92:95],a[220:223],a[172:175],v[92:95]
v_mfma_f32_16x16x32_bf16 v[92:95],a[224:227],a[176:179],v[92:95]
v_mfma_f32_16x16x32_bf16 v[92:95],a[228:231],a[180:183],v[92:95]
v_mfma_f32_16x16x32_bf16 v[92:95],a[232:235],a[184:187],v[92:95]
v_mfma_f32_16x16x32_bf16 v[92:95],a[236:239],a[188:191],v[92:95]
s_mov_b32 s38,0
s_branch L_loop4
L_tr33:
s_waitcnt vmcnt(36)
s_waitcnt lgkmcnt(4)
v_mfma_f32_16x16x32_bf16 v[160:163],a[240:243],v[96:99],v[160:163]
ds_read_b128 a[96:99],v28 offset:0
v_fma_f32 v68,v68,s36,v16
v_mfma_f32_16x16x32_bf16 v[208:211],a[240:243],v[100:103],v[208:211]
ds_read_b128 a[100:103],v29 offset:0
v_fma_f32 v69,v69,s36,v16
v_mfma_f32_16x16x32_bf16 a[0:3],a[240:243],v[104:107],a[0:3]
ds_read_b128 a[104:107],v28 offset:128
v_fma_f32 v70,v70,s36,v16
v_mfma_f32_16x16x32_bf16 v[164:167],a[244:247],v[96:99],v[164:167]
ds_read_b128 a[108:111],v29 offset:128
v_fma_f32 v71,v71,s36,v16
v_mfma_f32_16x16x32_bf16 v[212:215],a[244:247],v[100:103],v[212:215]
ds_read_b128 a[112:115],v28 offset:256
v_fma_f32 v76,v76,s36,v17
v_mfma_f32_16x16x32_bf16 a[4:7],a[244:247],v[104:107],a[4:7]
s_waitcnt lgkmcnt(5)
ds_read_b128 a[116:119],v29 offset:256
v_fma_f32 v77,v77,s36,v17
v_mfma_f32_16x16x32_bf16 v[168:171],a[248:251],v[96:99],v[168:171]
ds_read_b64_tr_b16 a[240:241],v3 offset:24704
ds_read_b64_tr_b16 a[242:243],v3 offset:30848
v_mfma_f32_16x16x32_bf16 v[216:219],a[248:251],v[100:103],v[216:219]
ds_read_b64_tr_b16 a[244:245],v4 offset:24704
ds_read_b64_tr_b16 a[246:247],v4 offset:30848
v_mfma_f32_16x16x32_bf16 a[8:11],a[248:251],v[104:107],a[8:11]
ds_read_b64_tr_b16 a[248:249],v5 offset:24704
ds_read_b64_tr_b16 a[250:251],v5 offset:30848
v_mfma_f32_16x16x32_bf16 v[172:175],a[252:255],v[96:99],v[172:175]
ds_read_b128 a[192:195],v13 offset:0
v_fma_f32 v78,v78,s36,v17
v_mfma_f32_16x16x32_bf16 v[220:223],a[252:255],v[100:103],v[220:223]
ds_read_b128 a[196:199],v14 offset:0
v_fma_f32 v79,v79,s36,v17
v_mfma_f32_16x16x32_bf16 a[12:15],a[252:255],v[104:107],a[12:15]
ds_read_b64_tr_b16 a[252:253],v6 offset:24704
ds_read_b64_tr_b16 a[254:255],v6 offset:30848
ds_read_b128 a[200:203],v13 offset:128
v_fma_f32 v80,v80,s36,v18
v_fma_f32 v81,v81,s36,v18
v_fma_f32 v82,v82,s36,v18
v_fma_f32 v83,v83,s36,v18
v_fma_f32 v84,v84,s36,v18
v_fma_f32 v85,v85,s36,v18
v_fma_f32 v86,v86,s36,v18
v_fma_f32 v87,v87,s36,v18
v_exp_f32 v68,v68
v_exp_f32 v69,v69
v_exp_f32 v70,v70
s_waitcnt lgkmcnt(9)
v_mfma_f32_16x16x32_bf16 v[176:179],a[240:243],v[96:99],v[176:179]
ds_read_b128 a[204:207],v14 offset:128
v_exp_f32 v71,v71
v_mfma_f32_16x16x32_bf16 v[224:227],a[240:243],v[100:103],v[224:227]
ds_read_b128 a[208:211],v13 offset:256
v_exp_f32 v76,v76
v_mfma_f32_16x16x32_bf16 a[16:19],a[240:243],v[104:107],a[16:19]
s_waitcnt lgkmcnt(5)
ds_read_b64_tr_b16 a[240:241],v3 offset:24832
ds_read_b64_tr_b16 a[242:243],v3 offset:30976
v_mfma_f32_16x16x32_bf16 v[180:183],a[244:247],v[96:99],v[180:183]
ds_read_b128 a[212:215],v14 offset:256
v_exp_f32 v77,v77
v_mfma_f32_16x16x32_bf16 v[228:231],a[244:247],v[100:103],v[228:231]
ds_read_b128 a[216:219],v13 offset:45056
v_exp_f32 v78,v78
v_mfma_f32_16x16x32_bf16 a[20:23],a[244:247],v[104:107],a[20:23]
ds_read_b64_tr_b16 a[244:245],v4 offset:24832
ds_read_b64_tr_b16 a[246:247],v4 offset:30976
v_mfma_f32_16x16x32_bf16 v[184:187],a[248:251],v[96:99],v[184:187]
ds_read_b128 a[220:223],v14 offset:45056
v_exp_f32 v79,v79
v_mfma_f32_16x16x32_bf16 v[232:235],a[248:251],v[100:103],v[232:235]
ds_read_b128 a[224:227],v13 offset:45184
v_exp_f32 v80,v80
v_mfma_f32_16x16x32_bf16 a[24:27],a[248:251],v[104:107],a[24:27]
s_waitcnt lgkmcnt(8)
ds_read_b64_tr_b16 a[248:249],v5 offset:24832
ds_read_b64_tr_b16 a[250:251],v5 offset:30976
v_mfma_f32_16x16x32_bf16 v[188:191],a[252:255],v[96:99],v[188:191]
ds_read_b128 a[228:231],v14 offset:45184
v_exp_f32 v81,v81
v_mfma_f32_16x16x32_bf16 v[236:239],a[252:255],v[100:103],v[236:239]
ds_read_b128 a[232:235],v13 offset:45312
v_exp_f32 v82,v82
v_mfma_f32_16x16x32_bf16 a[28:31],a[252:255],v[104:107],a[28:31]
s_waitcnt lgkmcnt(8)
ds_read_b64_tr_b16 a[252:253],v6 offset:24832
ds_read_b64_tr_b16 a[254:255],v6 offset:30976
v_mfma_f32_16x16x32_bf16 v[192:195],a[240:243],v[96:99],v[192:195]
ds_read_b128 a[236:239],v14 offset:45312
v_exp_f32 v83,v83
v_mfma_f32_16x16x32_bf16 v[240:243],a[240:243],v[100:103],v[240:243]
ds_read_b128 a[120:123],v28 offset:6144
v_exp_f32 v84,v84
v_mfma_f32_16x16x32_bf16 a[32:35],a[240:243],v[104:107],a[32:35]
s_waitcnt lgkmcnt(8)
ds_read_b128 a[124:127],v29 offset:6144
v_exp_f32 v85,v85
v_mfma_f32_16x16x32_bf16 v[196:199],a[244:247],v[96:99],v[196:199]
ds_read_b128 a[128:131],v28 offset:6272
v_exp_f32 v86,v86
v_mfma_f32_16x16x32_bf16 v[244:247],a[244:247],v[100:103],v[244:247]
ds_read_b128 a[132:135],v29 offset:6272
v_exp_f32 v87,v87
s_waitcnt vmcnt(6)
v_mfma_f32_16x16x32_bf16 a[36:39],a[244:247],v[104:107],a[36:39]
s_waitcnt lgkmcnt(7)
ds_read_b128 a[136:139],v28 offset:6400
v_cvt_pk_bf16_f32 v114,v68,v69
v_mfma_f32_16x16x32_bf16 v[200:203],a[248:251],v[96:99],v[200:203]
ds_read_b128 a[140:143],v29 offset:6400
v_cvt_pk_bf16_f32 v115,v70,v71
v_mfma_f32_16x16x32_bf16 v[248:251],a[248:251],v[100:103],v[248:251]
s_waitcnt lgkmcnt(6)
v_cvt_pk_bf16_f32 v118,v76,v77
s_barrier
v_mfma_f32_16x16x32_bf16 v[128:131],v[24:27],v[112:115],v[128:131]
v_cvt_pk_bf16_f32 v119,v78,v79
v_cvt_pk_bf16_f32 v120,v80,v81
v_mfma_f32_16x16x32_bf16 a[40:43],a[248:251],v[104:107],a[40:43]
ds_read_b64_tr_b16 a[240:241],v3 offset:0
ds_read_b64_tr_b16 a[242:243],v3 offset:6144
v_mfma_f32_16x16x32_bf16 v[132:135],v[24:27],v[116:119],v[132:135]
v_cvt_pk_bf16_f32 v121,v82,v83
v_cvt_pk_bf16_f32 v122,v84,v85
v_mfma_f32_16x16x32_bf16 v[204:207],a[252:255],v[96:99],v[204:207]
ds_read_b64_tr_b16 a[244:245],v4 offset:0
ds_read_b64_tr_b16 a[246:247],v4 offset:6144
v_mfma_f32_16x16x32_bf16 v[252:255],a[252:255],v[100:103],v[252:255]
ds_read_b64_tr_b16 a[248:249],v5 offset:0
ds_read_b64_tr_b16 a[250:251],v5 offset:6144
v_mfma_f32_16x16x32_bf16 a[44:47],a[252:255],v[104:107],a[44:47]
v_cvt_pk_bf16_f32 v123,v86,v87
ds_read_b64_tr_b16 a[252:253],v6 offset:0
ds_read_b64_tr_b16 a[254:255],v6 offset:6144
v_mfma_f32_16x16x32_bf16 v[136:139],v[24:27],v[120:123],v[136:139]
s_waitcnt lgkmcnt(6)
v_mfma_f32_16x16x32_bf16 v[160:163],a[240:243],v[112:115],v[160:163]
v_rcp_f32 v144,v128
v_mfma_f32_16x16x32_bf16 v[208:211],a[240:243],v[116:119],v[208:211]
v_rcp_f32 v146,v132
v_mfma_f32_16x16x32_bf16 a[0:3],a[240:243],v[120:123],a[0:3]
s_waitcnt lgkmcnt(4)
ds_read_b64_tr_b16 a[240:241],v3 offset:128
ds_read_b64_tr_b16 a[242:243],v3 offset:6272
v_mfma_f32_16x16x32_bf16 v[164:167],a[244:247],v[112:115],v[164:167]
v_rcp_f32 v148,v136
v_mfma_f32_16x16x32_bf16 v[212:215],a[244:247],v[116:119],v[212:215]
v_max3_f32 v30,v128,v132,v136
v_cmp_ngt_f32 vcc,s37,v30
v_mfma_f32_16x16x32_bf16 a[4:7],a[244:247],v[120:123],a[4:7]
s_waitcnt lgkmcnt(4)
ds_read_b64_tr_b16 a[244:245],v4 offset:128
ds_read_b64_tr_b16 a[246:247],v4 offset:6272
v_mfma_f32_16x16x32_bf16 v[168:171],a[248:251],v[112:115],v[168:171]
s_cmp_lg_u64 vcc,0
v_accvgpr_read_b32 v64,a0
v_accvgpr_read_b32 v65,a1
v_mfma_f32_16x16x32_bf16 v[216:219],a[248:251],v[116:119],v[216:219]
s_cselect_b32 s62,s32,0
v_accvgpr_read_b32 v66,a2
v_accvgpr_read_b32 v67,a3
v_accvgpr_read_b32 v72,a4
v_accvgpr_read_b32 v73,a5
v_accvgpr_read_b32 v74,a6
v_pk_mul_f32 v[160:161],v[160:161],v[144:145] op_sel_hi:[1,0]
v_pk_mul_f32 v[162:163],v[162:163],v[144:145] op_sel_hi:[1,0]
v_pk_mul_f32 v[208:209],v[208:209],v[146:147] op_sel_hi:[1,0]
v_pk_mul_f32 v[210:211],v[210:211],v[146:147] op_sel_hi:[1,0]
v_accvgpr_read_b32 v75,a7
v_cvt_pk_bf16_f32 v160,v160,v161
v_mfma_f32_16x16x32_bf16 a[8:11],a[248:251],v[120:123],a[8:11]
s_or_b32 s31,s31,s62
ds_read_b64_tr_b16 a[248:249],v5 offset:128
ds_read_b64_tr_b16 a[250:251],v5 offset:6272
s_waitcnt lgkmcnt(4)
v_mfma_f32_16x16x32_bf16 v[172:175],a[252:255],v[112:115],v[172:175]
s_lshl_b32 s32,s32,1
v_cvt_pk_bf16_f32 v208,v208,v209
v_cvt_pk_bf16_f32 v161,v162,v163
v_mfma_f32_16x16x32_bf16 v[220:223],a[252:255],v[116:119],v[220:223]
s_add_u32 m0,s22,24576
v_cvt_pk_bf16_f32 v209,v210,v211
v_accvgpr_read_b32 v162,a10
v_mfma_f32_16x16x32_bf16 a[12:15],a[252:255],v[120:123],a[12:15]
buffer_load_dwordx4 v7,s[4:7],s20 offen offset:0 lds
ds_read_b64_tr_b16 a[252:253],v6 offset:128
ds_read_b64_tr_b16 a[254:255],v6 offset:6272
ds_write2st64_b64 v12,v[160:161],v[208:209] offset0:0 offset1:12
v_pk_mul_f32 v[164:165],v[164:165],v[144:145] op_sel_hi:[1,0]
v_pk_mul_f32 v[166:167],v[166:167],v[144:145] op_sel_hi:[1,0]
v_pk_mul_f32 v[212:213],v[212:213],v[146:147] op_sel_hi:[1,0]
v_pk_mul_f32 v[214:215],v[214:215],v[146:147] op_sel_hi:[1,0]
v_accvgpr_read_b32 v163,a11
v_accvgpr_read_b32 v160,a8
v_mfma_f32_16x16x32_bf16 v[176:179],a[240:243],v[112:115],v[176:179]
v_accvgpr_read_b32 v161,a9
v_cvt_pk_bf16_f32 v164,v164,v165
v_mfma_f32_16x16x32_bf16 v[224:227],a[240:243],v[116:119],v[224:227]
v_cvt_pk_bf16_f32 v212,v212,v213
v_cvt_pk_bf16_f32 v165,v166,v167
v_mfma_f32_16x16x32_bf16 a[16:19],a[240:243],v[120:123],a[16:19]
s_waitcnt lgkmcnt(3)
ds_read_b64_tr_b16 a[240:241],v3 offset:256
ds_read_b64_tr_b16 a[242:243],v3 offset:6400
v_mfma_f32_16x16x32_bf16 v[180:183],a[244:247],v[112:115],v[180:183]
v_cvt_pk_bf16_f32 v213,v214,v215
v_accvgpr_read_b32 v166,a14
v_accvgpr_read_b32 v167,a15
v_subrev_u32 v11,18432,v11
v_subrev_u32 v23,18432,v23
v_pk_mul_f32 v[168:169],v[168:169],v[144:145] op_sel_hi:[1,0]
v_pk_mul_f32 v[170:171],v[170:171],v[144:145] op_sel_hi:[1,0]
v_pk_mul_f32 v[216:217],v[216:217],v[146:147] op_sel_hi:[1,0]
v_pk_mul_f32 v[218:219],v[218:219],v[146:147] op_sel_hi:[1,0]
v_accvgpr_read_b32 v68,a16
v_accvgpr_read_b32 v69,a17
v_mfma_f32_16x16x32_bf16 v[228:231],a[244:247],v[116:119],v[228:231]
ds_write2st64_b64 v20,v[164:165],v[212:213] offset0:0 offset1:12
v_mfma_f32_16x16x32_bf16 a[20:23],a[244:247],v[120:123],a[20:23]
v_accvgpr_read_b32 v70,a18
v_accvgpr_read_b32 v71,a19
v_mfma_f32_16x16x32_bf16 v[184:187],a[248:251],v[112:115],v[184:187]
buffer_load_dwordx4 v8,s[4:7],s20 offen offset:1024 lds
v_mfma_f32_16x16x32_bf16 v[232:235],a[248:251],v[116:119],v[232:235]
ds_read_b64_tr_b16 a[244:245],v4 offset:256
ds_read_b64_tr_b16 a[246:247],v4 offset:6400
v_accvgpr_read_b32 v164,a12
v_accvgpr_read_b32 v76,a20
v_accvgpr_read_b32 v77,a21
v_pk_mul_f32 v[172:173],v[172:173],v[144:145] op_sel_hi:[1,0]
v_pk_mul_f32 v[174:175],v[174:175],v[144:145] op_sel_hi:[1,0]
v_pk_mul_f32 v[220:221],v[220:221],v[146:147] op_sel_hi:[1,0]
v_pk_mul_f32 v[222:223],v[222:223],v[146:147] op_sel_hi:[1,0]
v_accvgpr_read_b32 v78,a22
v_accvgpr_read_b32 v79,a23
v_mfma_f32_16x16x32_bf16 a[24:27],a[248:251],v[120:123],a[24:27]
s_waitcnt lgkmcnt(3)
ds_read_b64_tr_b16 a[248:249],v5 offset:256
ds_read_b64_tr_b16 a[250:251],v5 offset:6400
v_mfma_f32_16x16x32_bf16 v[188:191],a[252:255],v[112:115],v[188:191]
v_accvgpr_read_b32 v165,a13
v_cvt_pk_bf16_f32 v168,v168,v169
v_mfma_f32_16x16x32_bf16 v[236:239],a[252:255],v[116:119],v[236:239]
v_cvt_pk_bf16_f32 v216,v216,v217
v_cvt_pk_bf16_f32 v172,v172,v173
v_mfma_f32_16x16x32_bf16 a[28:31],a[252:255],v[120:123],a[28:31]
ds_read_b64_tr_b16 a[252:253],v6 offset:256
ds_read_b64_tr_b16 a[254:255],v6 offset:6400
v_accvgpr_read_b32 v208,a24
v_accvgpr_read_b32 v209,a25
v_accvgpr_read_b32 v210,a26
v_pk_mul_f32 v[176:177],v[176:177],v[144:145] op_sel_hi:[1,0]
v_pk_mul_f32 v[178:179],v[178:179],v[144:145] op_sel_hi:[1,0]
v_pk_mul_f32 v[224:225],v[224:225],v[146:147] op_sel_hi:[1,0]
v_pk_mul_f32 v[226:227],v[226:227],v[146:147] op_sel_hi:[1,0]
v_accvgpr_read_b32 v211,a27
v_accvgpr_read_b32 v212,a28
v_mfma_f32_16x16x32_bf16 v[192:195],a[240:243],v[112:115],v[192:195]
v_accvgpr_read_b32 v213,a29
v_accvgpr_read_b32 v214,a30
v_mfma_f32_16x16x32_bf16 v[240:243],a[240:243],v[116:119],v[240:243]
v_accvgpr_read_b32 v215,a31
v_cvt_pk_bf16_f32 v220,v220,v221
v_mfma_f32_16x16x32_bf16 a[32:35],a[240:243],v[120:123],a[32:35]
s_waitcnt lgkmcnt(2)
v_cvt_pk_bf16_f32 v169,v170,v171
v_cvt_pk_bf16_f32 v217,v218,v219
v_mfma_f32_16x16x32_bf16 v[196:199],a[244:247],v[112:115],v[196:199]
ds_write2st64_b64 v21,v[168:169],v[216:217] offset0:0 offset1:12
v_pk_mul_f32 v[180:181],v[180:181],v[144:145] op_sel_hi:[1,0]
v_pk_mul_f32 v[182:183],v[182:183],v[144:145] op_sel_hi:[1,0]
v_pk_mul_f32 v[228:229],v[228:229],v[146:147] op_sel_hi:[1,0]
v_pk_mul_f32 v[230:231],v[230:231],v[146:147] op_sel_hi:[1,0]
v_cvt_pk_bf16_f32 v173,v174,v175
v_cvt_pk_bf16_f32 v176,v176,v177
v_mfma_f32_16x16x32_bf16 v[244:247],a[244:247],v[116:119],v[244:247]
buffer_load_dwordx4 v9,s[4:7],s20 offen offset:2048 lds
v_mfma_f32_16x16x32_bf16 a[36:39],a[244:247],v[120:123],a[36:39]
s_add_u32 s20,s20,12288
v_cvt_pk_bf16_f32 v224,v224,v225
v_cvt_pk_bf16_f32 v221,v222,v223
v_mfma_f32_16x16x32_bf16 v[200:203],a[248:251],v[112:115],v[200:203]
s_add_u32 m0,s23,0
ds_write2st64_b64 v22,v[172:173],v[220:221] offset0:0 offset1:12
v_mfma_f32_16x16x32_bf16 v[248:251],a[248:251],v[116:119],v[248:251]
v_cvt_pk_bf16_f32 v180,v180,v181
v_cvt_pk_bf16_f32 v228,v228,v229
v_cvt_pk_bf16_f32 v177,v178,v179
v_cvt_pk_bf16_f32 v225,v226,v227
v_cvt_pk_bf16_f32 v181,v182,v183
v_pk_mul_f32 v[184:185],v[184:185],v[144:145] op_sel_hi:[1,0]
v_pk_mul_f32 v[186:187],v[186:187],v[144:145] op_sel_hi:[1,0]
v_pk_mul_f32 v[232:233],v[232:233],v[146:147] op_sel_hi:[1,0]
v_pk_mul_f32 v[234:235],v[234:235],v[146:147] op_sel_hi:[1,0]
v_cvt_pk_bf16_f32 v229,v230,v231
v_cvt_pk_bf16_f32 v184,v184,v185
v_mfma_f32_16x16x32_bf16 a[40:43],a[248:251],v[120:123],a[40:43]
s_waitcnt lgkmcnt(1)
ds_write2st64_b64 v12,v[176:177],v[224:225] offset0:2 offset1:14
v_mfma_f32_16x16x32_bf16 v[204:207],a[252:255],v[112:115],v[204:207]
v_cvt_pk_bf16_f32 v232,v232,v233
v_cvt_pk_bf16_f32 v185,v186,v187
v_mfma_f32_16x16x32_bf16 v[252:255],a[252:255],v[116:119],v[252:255]
v_cvt_pk_bf16_f32 v233,v234,v235
v_accvgpr_read_b32 v170,a34
v_mfma_f32_16x16x32_bf16 a[44:47],a[252:255],v[120:123],a[44:47]
v_accvgpr_read_b32 v171,a35
v_accvgpr_read_b32 v168,a32
v_accvgpr_read_b32 v169,a33
v_accvgpr_read_b32 v216,a36
v_accvgpr_read_b32 v217,a37
v_pk_mul_f32 v[188:189],v[188:189],v[144:145] op_sel_hi:[1,0]
v_pk_mul_f32 v[190:191],v[190:191],v[144:145] op_sel_hi:[1,0]
v_pk_mul_f32 v[236:237],v[236:237],v[146:147] op_sel_hi:[1,0]
v_pk_mul_f32 v[238:239],v[238:239],v[146:147] op_sel_hi:[1,0]
v_cvt_pk_bf16_f32 v188,v188,v189
v_cvt_pk_bf16_f32 v236,v236,v237
v_mfma_f32_16x16x32_bf16 v[32:35],a[192:195],a[96:99],0
s_waitcnt vmcnt(3)
ds_read_b128 a[144:147],v28 offset:12288
v_cvt_pk_bf16_f32 v189,v190,v191
v_mfma_f32_16x16x32_bf16 v[32:35],a[196:199],a[100:103],v[32:35]
ds_read_b128 a[148:151],v29 offset:12288
v_cvt_pk_bf16_f32 v237,v238,v239
v_mfma_f32_16x16x32_bf16 v[32:35],a[200:203],a[104:107],v[32:35]
ds_read_b128 a[152:155],v28 offset:12416
v_accvgpr_read_b32 v218,a38
v_mfma_f32_16x16x32_bf16 v[32:35],a[204:207],a[108:111],v[32:35]
ds_read_b128 a[156:159],v29 offset:12416
v_accvgpr_read_b32 v219,a39
v_accvgpr_read_b32 v172,a40
v_accvgpr_read_b32 v173,a41
s_waitcnt vmcnt(6)
s_barrier
ds_read_b128 a[160:163],v28 offset:12544
v_pk_mul_f32 v[192:193],v[192:193],v[144:145] op_sel_hi:[1,0]
v_pk_mul_f32 v[194:195],v[194:195],v[144:145] op_sel_hi:[1,0]
v_pk_mul_f32 v[240:241],v[240:241],v[146:147] op_sel_hi:[1,0]
v_pk_mul_f32 v[242:243],v[242:243],v[146:147] op_sel_hi:[1,0]
v_cvt_pk_bf16_f32 v192,v192,v193
v_cvt_pk_bf16_f32 v240,v240,v241
v_mfma_f32_16x16x32_bf16 v[32:35],a[208:211],a[112:115],v[32:35]
ds_read_b128 a[164:167],v29 offset:12544
v_cvt_pk_bf16_f32 v193,v194,v195
v_mfma_f32_16x16x32_bf16 v[32:35],a[212:215],a[116:119],v[32:35]
ds_write2st64_b64 v20,v[180:181],v[228:229] offset0:2 offset1:14
v_mfma_f32_16x16x32_bf16 v[36:39],a[216:219],a[96:99],0
v_cvt_pk_bf16_f32 v241,v242,v243
v_accvgpr_read_b32 v174,a42
v_mfma_f32_16x16x32_bf16 v[36:39],a[220:223],a[100:103],v[36:39]
buffer_load_dwordx4 v7,s[8:11],s21 offen offset:0 lds
v_accvgpr_read_b32 v175,a43
v_accvgpr_read_b32 v220,a44
v_pk_mul_f32 v[196:197],v[196:197],v[144:145] op_sel_hi:[1,0]
v_pk_mul_f32 v[198:199],v[198:199],v[144:145] op_sel_hi:[1,0]
v_pk_mul_f32 v[244:245],v[244:245],v[146:147] op_sel_hi:[1,0]
v_pk_mul_f32 v[246:247],v[246:247],v[146:147] op_sel_hi:[1,0]
v_cvt_pk_bf16_f32 v196,v196,v197
v_cvt_pk_bf16_f32 v244,v244,v245
v_mfma_f32_16x16x32_bf16 v[36:39],a[224:227],a[104:107],v[36:39]
ds_write2st64_b64 v21,v[184:185],v[232:233] offset0:2 offset1:14
v_mfma_f32_16x16x32_bf16 v[36:39],a[228:231],a[108:111],v[36:39]
v_cvt_pk_bf16_f32 v197,v198,v199
v_cvt_pk_bf16_f32 v245,v246,v247
v_mfma_f32_16x16x32_bf16 v[36:39],a[232:235],a[112:115],v[36:39]
v_accvgpr_read_b32 v221,a45
v_accvgpr_read_b32 v222,a46
v_mfma_f32_16x16x32_bf16 v[36:39],a[236:239],a[116:119],v[36:39]
v_accvgpr_read_b32 v223,a47
v_max3_f32 v129,v32,v33,v34
v_subrev_u32 v31,18432,v31
ds_write2st64_b64 v22,v[188:189],v[236:237] offset0:2 offset1:14
v_pk_mul_f32 v[200:201],v[200:201],v[144:145] op_sel_hi:[1,0]
v_pk_mul_f32 v[202:203],v[202:203],v[144:145] op_sel_hi:[1,0]
v_pk_mul_f32 v[248:249],v[248:249],v[146:147] op_sel_hi:[1,0]
v_pk_mul_f32 v[250:251],v[250:251],v[146:147] op_sel_hi:[1,0]
v_cvt_pk_bf16_f32 v200,v200,v201
v_cvt_pk_bf16_f32 v248,v248,v249
v_mfma_f32_16x16x32_bf16 v[40:43],a[192:195],a[120:123],0
buffer_load_dwordx4 v8,s[8:11],s21 offen offset:1024 lds
v_mfma_f32_16x16x32_bf16 v[40:43],a[196:199],a[124:127],v[40:43]
ds_write2st64_b64 v12,v[192:193],v[240:241] offset0:4 offset1:16
v_mfma_f32_16x16x32_bf16 v[40:43],a[200:203],a[128:131],v[40:43]
v_cvt_pk_bf16_f32 v201,v202,v203
v_cvt_pk_bf16_f32 v249,v250,v251
v_mfma_f32_16x16x32_bf16 v[40:43],a[204:207],a[132:135],v[40:43]
v_max3_f32 v129,v129,v35,v36
v_max3_f32 v129,v129,v37,v38
v_max_f32 v129,v129,v39
v_mov_b32 v130,v129
v_pk_mul_f32 v[204:205],v[204:205],v[144:145] op_sel_hi:[1,0]
v_pk_mul_f32 v[206:207],v[206:207],v[144:145] op_sel_hi:[1,0]
v_pk_mul_f32 v[252:253],v[252:253],v[146:147] op_sel_hi:[1,0]
v_pk_mul_f32 v[254:255],v[254:255],v[146:147] op_sel_hi:[1,0]
v_cvt_pk_bf16_f32 v204,v204,v205
v_cvt_pk_bf16_f32 v252,v252,v253
v_mfma_f32_16x16x32_bf16 v[40:43],a[208:211],a[136:139],v[40:43]
ds_write2st64_b64 v20,v[196:197],v[244:245] offset0:4 offset1:16
v_mfma_f32_16x16x32_bf16 v[40:43],a[212:215],a[140:143],v[40:43]
v_cvt_pk_bf16_f32 v205,v206,v207
v_cvt_pk_bf16_f32 v253,v254,v255
v_mfma_f32_16x16x32_bf16 v[44:47],a[216:219],a[120:123],0
v_permlane32_swap_b32 v130,v129
v_mfma_f32_16x16x32_bf16 v[44:47],a[220:223],a[124:127],v[44:47]
v_max_f32 v129,v129,v130
v_mov_b32 v130,v129
ds_write2st64_b64 v21,v[200:201],v[248:249] offset0:4 offset1:16
v_pk_mul_f32 v[64:65],v[64:65],v[148:149] op_sel_hi:[1,0]
v_pk_mul_f32 v[66:67],v[66:67],v[148:149] op_sel_hi:[1,0]
v_pk_mul_f32 v[68:69],v[68:69],v[148:149] op_sel_hi:[1,0]
v_pk_mul_f32 v[70:71],v[70:71],v[148:149] op_sel_hi:[1,0]
v_cvt_pk_bf16_f32 v64,v64,v65
v_cvt_pk_bf16_f32 v68,v68,v69
v_mfma_f32_16x16x32_bf16 v[44:47],a[224:227],a[128:131],v[44:47]
buffer_load_dwordx4 v9,s[8:11],s21 offen offset:2048 lds
v_mfma_f32_16x16x32_bf16 v[44:47],a[228:231],a[132:135],v[44:47]
s_add_u32 s21,s21,12288
ds_write2st64_b64 v22,v[204:205],v[252:253] offset0:4 offset1:16
v_mfma_f32_16x16x32_bf16 v[44:47],a[232:235],a[136:139],v[44:47]
s_mov_b32 s27,s42
v_cvt_pk_bf16_f32 v65,v66,v67
v_cvt_pk_bf16_f32 v69,v70,v71
v_mfma_f32_16x16x32_bf16 v[44:47],a[236:239],a[140:143],v[44:47]
s_mov_b32 s42,s41
v_max3_f32 v133,v40,v41,v42
v_permlane16_swap_b32 v130,v129
v_max_f32 v129,v129,v130
v_mul_f32_e64 v16,-s36,v129
v_pk_mul_f32 v[72:73],v[72:73],v[148:149] op_sel_hi:[1,0]
v_pk_mul_f32 v[74:75],v[74:75],v[148:149] op_sel_hi:[1,0]
v_pk_mul_f32 v[76:77],v[76:77],v[148:149] op_sel_hi:[1,0]
v_pk_mul_f32 v[78:79],v[78:79],v[148:149] op_sel_hi:[1,0]
v_cvt_pk_bf16_f32 v72,v72,v73
v_cvt_pk_bf16_f32 v76,v76,v77
s_waitcnt lgkmcnt(1)
v_mfma_f32_16x16x32_bf16 v[48:51],a[192:195],a[144:147],0
s_add_u32 s69,s69,1
ds_read_b128 a[192:195],v1 offset:12288
v_cvt_pk_bf16_f32 v73,v74,v75
v_mfma_f32_16x16x32_bf16 v[48:51],a[196:199],a[148:151],v[48:51]
s_add_u32 s48,s48,325632
ds_read_b128 a[196:199],v2 offset:12288
v_cvt_pk_bf16_f32 v77,v78,v79
v_mfma_f32_16x16x32_bf16 v[48:51],a[200:203],a[152:155],v[48:51]
s_lshr_b32 s62,s39,s69
ds_read_b128 a[200:203],v1 offset:12416
v_max3_f32 v133,v133,v43,v44
v_mfma_f32_16x16x32_bf16 v[48:51],a[204:207],a[156:159],v[48:51]
s_and_b32 s62,s62,1
ds_read_b128 a[204:207],v2 offset:12416
v_max3_f32 v133,v133,v45,v46
v_max_f32 v133,v133,v47
v_mov_b32 v134,v133
v_fma_f32 v32,v32,s36,v16
v_pk_mul_f32 v[160:161],v[160:161],v[148:149] op_sel_hi:[1,0]
v_pk_mul_f32 v[162:163],v[162:163],v[148:149] op_sel_hi:[1,0]
v_pk_mul_f32 v[208:209],v[208:209],v[148:149] op_sel_hi:[1,0]
v_pk_mul_f32 v[210:211],v[210:211],v[148:149] op_sel_hi:[1,0]
v_permlane32_swap_b32 v134,v133
v_max_f32 v133,v133,v134
v_mfma_f32_16x16x32_bf16 v[48:51],a[208:211],a[160:163],v[48:51]
s_lshl_b32 s62,s62,1
ds_read_b128 a[208:211],v1 offset:12544
v_mov_b32 v134,v133
v_mfma_f32_16x16x32_bf16 v[48:51],a[212:215],a[164:167],v[48:51]
s_add_u32 s62,s62,s49
ds_read_b128 a[212:215],v2 offset:12544
v_permlane16_swap_b32 v134,v133
v_mfma_f32_16x16x32_bf16 v[52:55],a[216:219],a[144:147],0
s_and_b32 s62,s62,3
ds_read_b128 a[216:219],v1 offset:18432
v_max_f32 v133,v133,v134
v_mfma_f32_16x16x32_bf16 v[52:55],a[220:223],a[148:151],v[52:55]
s_add_u32 s63,s69,8
ds_read_b128 a[220:223],v2 offset:18432
v_max3_f32 v137,v48,v49,v50
v_mul_f32_e64 v17,-s36,v133
v_fma_f32 v33,v33,s36,v16
v_fma_f32 v34,v34,s36,v16
v_pk_mul_f32 v[164:165],v[164:165],v[148:149] op_sel_hi:[1,0]
v_pk_mul_f32 v[166:167],v[166:167],v[148:149] op_sel_hi:[1,0]
v_pk_mul_f32 v[212:213],v[212:213],v[148:149] op_sel_hi:[1,0]
v_pk_mul_f32 v[214:215],v[214:215],v[148:149] op_sel_hi:[1,0]
v_fma_f32 v35,v35,s36,v16
v_fma_f32 v36,v36,s36,v16
v_mfma_f32_16x16x32_bf16 v[52:55],a[224:227],a[152:155],v[52:55]
s_lshr_b32 s63,s39,s63
ds_read_b128 a[224:227],v1 offset:18560
v_fma_f32 v37,v37,s36,v16
v_mfma_f32_16x16x32_bf16 v[52:55],a[228:231],a[156:159],v[52:55]
s_and_b32 s63,s63,1
ds_read_b128 a[228:231],v2 offset:18560
v_fma_f32 v38,v38,s36,v16
v_mfma_f32_16x16x32_bf16 v[52:55],a[232:235],a[160:163],v[52:55]
s_xor_b32 s62,s62,s63
ds_read_b128 a[232:235],v1 offset:18688
v_fma_f32 v39,v39,s36,v16
v_mfma_f32_16x16x32_bf16 v[52:55],a[236:239],a[164:167],v[52:55]
s_mul_i32 s63,s3,3
ds_read_b128 a[236:239],v2 offset:18688
v_fma_f32 v40,v40,s36,v17
v_fma_f32 v41,v41,s36,v17
v_fma_f32 v42,v42,s36,v17
v_fma_f32 v43,v43,s36,v17
v_pk_mul_f32 v[168:169],v[168:169],v[148:149] op_sel_hi:[1,0]
v_pk_mul_f32 v[170:171],v[170:171],v[148:149] op_sel_hi:[1,0]
v_fma_f32 v44,v44,s36,v17
v_max3_f32 v137,v137,v51,v52
v_max3_f32 v137,v137,v53,v54
v_max_f32 v137,v137,v55
v_mov_b32 v138,v137
v_fma_f32 v45,v45,s36,v17
v_fma_f32 v46,v46,s36,v17
v_permlane32_swap_b32 v138,v137
v_max_f32 v137,v137,v138
v_mov_b32 v138,v137
v_fma_f32 v47,v47,s36,v17
v_exp_f32 v32,v32
v_permlane16_swap_b32 v138,v137
v_max_f32 v137,v137,v138
v_mul_f32_e64 v18,-s36,v137
v_fma_f32 v48,v48,s36,v18
v_fma_f32 v49,v49,s36,v18
v_fma_f32 v50,v50,s36,v18
v_fma_f32 v51,v51,s36,v18
v_fma_f32 v52,v52,s36,v18
v_fma_f32 v53,v53,s36,v18
v_fma_f32 v54,v54,s36,v18
v_fma_f32 v55,v55,s36,v18
v_exp_f32 v33,v33
v_exp_f32 v34,v34
v_exp_f32 v35,v35
v_exp_f32 v36,v36
v_exp_f32 v37,v37
v_exp_f32 v38,v38
v_exp_f32 v39,v39
v_exp_f32 v40,v40
v_exp_f32 v41,v41
v_exp_f32 v42,v42
v_exp_f32 v43,v43
v_exp_f32 v44,v44
v_exp_f32 v45,v45
v_exp_f32 v46,v46
v_exp_f32 v47,v47
v_exp_f32 v48,v48
v_exp_f32 v49,v49
v_exp_f32 v50,v50
v_exp_f32 v51,v51
v_exp_f32 v52,v52
v_exp_f32 v53,v53
v_exp_f32 v54,v54
v_exp_f32 v55,v55
v_cvt_pk_bf16_f32 v160,v160,v161
v_cvt_pk_bf16_f32 v208,v208,v209
v_cvt_pk_bf16_f32 v164,v164,v165
v_cvt_pk_bf16_f32 v212,v212,v213
v_cvt_pk_bf16_f32 v96,v32,v33
v_cvt_pk_bf16_f32 v97,v34,v35
v_cvt_pk_bf16_f32 v98,v36,v37
v_cvt_pk_bf16_f32 v99,v38,v39
v_cvt_pk_bf16_f32 v100,v40,v41
v_cvt_pk_bf16_f32 v101,v42,v43
v_mfma_f32_16x16x32_bf16 v[128:131],v[24:27],v[96:99],0
s_lshl_b32 s64,s3,2
ds_write2st64_b64 v12,v[64:65],v[68:69] offset0:24 offset1:26
s_waitcnt lgkmcnt(1)
v_mfma_f32_16x16x32_bf16 v[64:67],a[192:195],a[96:99],0
s_mov_b32 s40,1
v_cvt_pk_bf16_f32 v102,v44,v45
v_cvt_pk_bf16_f32 v103,v46,v47
v_mfma_f32_16x16x32_bf16 v[64:67],a[196:199],a[100:103],v[64:67]
s_add_u32 s65,s63,17
v_cvt_pk_bf16_f32 v104,v48,v49
v_cvt_pk_bf16_f32 v105,v50,v51
v_mfma_f32_16x16x32_bf16 v[132:135],v[24:27],v[100:103],0
s_cmp_eq_u32 s3,0
v_cvt_pk_bf16_f32 v106,v52,v53
v_cvt_pk_bf16_f32 v107,v54,v55
v_mfma_f32_16x16x32_bf16 v[64:67],a[200:203],a[104:107],v[64:67]
s_cselect_b32 s65,16,s65
ds_write2st64_b64 v20,v[72:73],v[76:77] offset0:24 offset1:26
v_mfma_f32_16x16x32_bf16 v[136:139],v[24:27],v[104:107],0
s_cselect_b32 s41,1,0
v_cvt_pk_bf16_f32 v161,v162,v163
v_cvt_pk_bf16_f32 v209,v210,v211
v_mfma_f32_16x16x32_bf16 v[64:67],a[204:207],a[108:111],v[64:67]
s_cmp_eq_u32 s62,1
v_cvt_pk_bf16_f32 v168,v168,v169
v_cvt_pk_bf16_f32 v165,v166,v167
v_cvt_pk_bf16_f32 v213,v214,v215
v_cvt_pk_bf16_f32 v169,v170,v171
s_cselect_b32 s64,s65,s64
v_pk_mul_f32 v[216:217],v[216:217],v[148:149] op_sel_hi:[1,0]
v_pk_mul_f32 v[218:219],v[218:219],v[148:149] op_sel_hi:[1,0]
v_cvt_pk_bf16_f32 v216,v216,v217
v_cvt_pk_bf16_f32 v217,v218,v219
v_mfma_f32_16x16x32_bf16 v[64:67],a[208:211],a[112:115],v[64:67]
s_cselect_b32 s40,s41,s40
ds_write2st64_b64 v21,v[160:161],v[208:209] offset0:24 offset1:26
v_mfma_f32_16x16x32_bf16 v[64:67],a[212:215],a[116:119],v[64:67]
s_add_u32 s65,s63,29
s_cmp_eq_u32 s62,2
s_cselect_b32 s64,s65,s64
v_mfma_f32_16x16x32_bf16 v[72:75],a[192:195],a[120:123],0
s_cselect_b32 s40,0,s40
s_add_u32 s65,s63,41
s_cmp_eq_u32 s62,3
v_mfma_f32_16x16x32_bf16 v[72:75],a[196:199],a[124:127],v[72:75]
s_cselect_b32 s64,s65,s64
v_fma_f32 v64,v64,s36,v16
v_fma_f32 v65,v65,s36,v16
v_fma_f32 v66,v66,s36,v16
v_fma_f32 v67,v67,s36,v16
v_exp_f32 v64,v64
v_pk_mul_f32 v[172:173],v[172:173],v[148:149] op_sel_hi:[1,0]
v_pk_mul_f32 v[174:175],v[174:175],v[148:149] op_sel_hi:[1,0]
v_exp_f32 v65,v65
v_exp_f32 v66,v66
v_mfma_f32_16x16x32_bf16 v[72:75],a[200:203],a[128:131],v[72:75]
s_cselect_b32 s40,0,s40
ds_write2st64_b64 v22,v[164:165],v[212:213] offset0:24 offset1:26
v_mfma_f32_16x16x32_bf16 v[72:75],a[204:207],a[132:135],v[72:75]
s_mul_i32 s64,s64,6144
v_exp_f32 v67,v67
v_mfma_f32_16x16x32_bf16 v[72:75],a[208:211],a[136:139],v[72:75]
s_add_u32 s41,s48,s64
v_cvt_pk_bf16_f32 v172,v172,v173
v_cvt_pk_bf16_f32 v173,v174,v175
v_mfma_f32_16x16x32_bf16 v[72:75],a[212:215],a[140:143],v[72:75]
s_cmp_ge_u32 s69,8
v_cvt_pk_bf16_f32 v112,v64,v65
v_cvt_pk_bf16_f32 v113,v66,v67
s_cselect_b32 s41,166723584,s41
s_mov_b32 s28,s41
ds_write_b64 v12,v[168:169] offset:14336
v_pk_mul_f32 v[220:221],v[220:221],v[148:149] op_sel_hi:[1,0]
v_pk_mul_f32 v[222:223],v[222:223],v[148:149] op_sel_hi:[1,0]
v_fma_f32 v72,v72,s36,v17
v_fma_f32 v73,v73,s36,v17
v_mfma_f32_16x16x32_bf16 v[80:83],a[192:195],a[144:147],0
s_mov_b32 s29,s24
ds_write_b64 v20,v[216:217] offset:14336
v_mfma_f32_16x16x32_bf16 v[80:83],a[196:199],a[148:151],v[80:83]
s_add_u32 s25,s22,12288
v_fma_f32 v74,v74,s36,v17
v_fma_f32 v75,v75,s36,v17
v_mfma_f32_16x16x32_bf16 v[80:83],a[200:203],a[152:155],v[80:83]
s_add_u32 s26,s22,24576
ds_write_b64 v21,v[172:173] offset:14336
v_mfma_f32_16x16x32_bf16 v[80:83],a[204:207],a[156:159],v[80:83]
s_add_u32 m0,s23,12288
v_exp_f32 v72,v72
v_mfma_f32_16x16x32_bf16 v[80:83],a[208:211],a[160:163],v[80:83]
buffer_load_dwordx4 v7,s[8:11],s21 offen offset:0 lds
v_mfma_f32_16x16x32_bf16 v[80:83],a[212:215],a[164:167],v[80:83]
buffer_load_dwordx4 v8,s[8:11],s21 offen offset:1024 lds
v_mfma_f32_16x16x32_bf16 v[68:71],a[216:219],a[96:99],0
buffer_load_dwordx4 v9,s[8:11],s21 offen offset:2048 lds
v_mfma_f32_16x16x32_bf16 v[68:71],a[220:223],a[100:103],v[68:71]
s_add_u32 s21,s21,12288
v_exp_f32 v73,v73
v_mfma_f32_16x16x32_bf16 v[68:71],a[224:227],a[104:107],v[68:71]
s_add_u32 m0,s22,0
v_exp_f32 v74,v74
v_mfma_f32_16x16x32_bf16 v[68:71],a[228:231],a[108:111],v[68:71]
buffer_load_dwordx4 v7,s[4:7],s20 offen offset:0 lds
v_mfma_f32_16x16x32_bf16 v[68:71],a[232:235],a[112:115],v[68:71]
buffer_load_dwordx4 v8,s[4:7],s20 offen offset:1024 lds
v_mfma_f32_16x16x32_bf16 v[68:71],a[236:239],a[116:119],v[68:71]
buffer_load_dwordx4 v9,s[4:7],s20 offen offset:2048 lds
v_mfma_f32_16x16x32_bf16 v[76:79],a[216:219],a[120:123],0
s_add_u32 s20,s20,12288
v_exp_f32 v75,v75
v_mfma_f32_16x16x32_bf16 v[76:79],a[220:223],a[124:127],v[76:79]
v_cvt_pk_bf16_f32 v220,v220,v221
v_cvt_pk_bf16_f32 v221,v222,v223
v_mfma_f32_16x16x32_bf16 v[76:79],a[224:227],a[128:131],v[76:79]
ds_write_b64 v22,v[220:221] offset:14336
v_mfma_f32_16x16x32_bf16 v[76:79],a[228:231],a[132:135],v[76:79]
v_cvt_pk_bf16_f32 v116,v72,v73
v_cvt_pk_bf16_f32 v117,v74,v75
v_mfma_f32_16x16x32_bf16 v[76:79],a[232:235],a[136:139],v[76:79]
s_waitcnt vmcnt(6)
s_barrier
v_mfma_f32_16x16x32_bf16 v[76:79],a[236:239],a[140:143],v[76:79]
ds_read_b64_tr_b16 a[240:241],v3 offset:0
v_mfma_f32_16x16x32_bf16 v[84:87],a[216:219],a[144:147],0
ds_read_b64_tr_b16 a[242:243],v3 offset:6144
v_mfma_f32_16x16x32_bf16 v[84:87],a[220:223],a[148:151],v[84:87]
ds_read_b64_tr_b16 a[244:245],v4 offset:0
ds_read_b64_tr_b16 a[246:247],v4 offset:6144
v_mfma_f32_16x16x32_bf16 v[84:87],a[224:227],a[152:155],v[84:87]
ds_read_b64_tr_b16 a[248:249],v5 offset:0
v_mfma_f32_16x16x32_bf16 v[84:87],a[228:231],a[156:159],v[84:87]
ds_read_b64_tr_b16 a[250:251],v5 offset:6144
v_mfma_f32_16x16x32_bf16 v[84:87],a[232:235],a[160:163],v[84:87]
ds_read_b64_tr_b16 a[252:253],v6 offset:0
ds_read_b64_tr_b16 a[254:255],v6 offset:6144
v_mfma_f32_16x16x32_bf16 v[84:87],a[236:239],a[164:167],v[84:87]
s_waitcnt lgkmcnt(6)
v_mfma_f32_16x16x32_bf16 v[160:163],a[240:243],v[96:99],0
s_add_u32 m0,s23,24576
ds_read_b128 a[192:195],v1 offset:24576
v_fma_f32 v68,v68,s36,v16
v_mfma_f32_16x16x32_bf16 v[208:211],a[240:243],v[100:103],0
buffer_load_dwordx4 v7,s[8:11],s21 offen offset:0 lds
v_mfma_f32_16x16x32_bf16 a[0:3],a[240:243],v[104:107],0
s_waitcnt lgkmcnt(5)
ds_read_b64_tr_b16 a[240:241],v3 offset:128
ds_read_b64_tr_b16 a[242:243],v3 offset:6272
v_mfma_f32_16x16x32_bf16 v[164:167],a[244:247],v[96:99],0
ds_read_b128 a[196:199],v2 offset:24576
v_fma_f32 v69,v69,s36,v16
v_mfma_f32_16x16x32_bf16 v[212:215],a[244:247],v[100:103],0
ds_read_b128 a[200:203],v1 offset:24704
v_fma_f32 v70,v70,s36,v16
v_mfma_f32_16x16x32_bf16 a[4:7],a[244:247],v[104:107],0
s_waitcnt lgkmcnt(7)
ds_read_b64_tr_b16 a[244:245],v4 offset:128
ds_read_b64_tr_b16 a[246:247],v4 offset:6272
v_mfma_f32_16x16x32_bf16 v[168:171],a[248:251],v[96:99],0
ds_read_b128 a[204:207],v2 offset:24704
v_fma_f32 v71,v71,s36,v16
v_mfma_f32_16x16x32_bf16 v[216:219],a[248:251],v[100:103],0
buffer_load_dwordx4 v8,s[8:11],s21 offen offset:1024 lds
v_mfma_f32_16x16x32_bf16 a[8:11],a[248:251],v[104:107],0
s_waitcnt lgkmcnt(7)
ds_read_b64_tr_b16 a[248:249],v5 offset:128
ds_read_b64_tr_b16 a[250:251],v5 offset:6272
v_mfma_f32_16x16x32_bf16 v[172:175],a[252:255],v[96:99],0
ds_read_b128 a[208:211],v1 offset:24832
v_fma_f32 v76,v76,s36,v17
v_mfma_f32_16x16x32_bf16 v[220:223],a[252:255],v[100:103],0
ds_read_b128 a[212:215],v2 offset:24832
v_fma_f32 v77,v77,s36,v17
v_mfma_f32_16x16x32_bf16 a[12:15],a[252:255],v[104:107],0
s_waitcnt lgkmcnt(8)
ds_read_b64_tr_b16 a[252:253],v6 offset:128
ds_read_b64_tr_b16 a[254:255],v6 offset:6272
v_mfma_f32_16x16x32_bf16 v[176:179],a[240:243],v[96:99],0
buffer_load_dwordx4 v9,s[8:11],s21 offen offset:2048 lds
v_mfma_f32_16x16x32_bf16 v[224:227],a[240:243],v[100:103],0
s_add_u32 s21,s21,12288
ds_read_b128 a[216:219],v1 offset:30720
v_fma_f32 v78,v78,s36,v17
v_mfma_f32_16x16x32_bf16 a[16:19],a[240:243],v[104:107],0
s_add_u32 m0,s22,12288
ds_read_b64_tr_b16 a[240:241],v3 offset:256
ds_read_b64_tr_b16 a[242:243],v3 offset:6400
s_waitcnt lgkmcnt(9)
v_mfma_f32_16x16x32_bf16 v[180:183],a[244:247],v[96:99],0
ds_read_b128 a[220:223],v2 offset:30720
v_fma_f32 v79,v79,s36,v17
v_mfma_f32_16x16x32_bf16 v[228:231],a[244:247],v[100:103],0
ds_read_b128 a[224:227],v1 offset:30848
v_fma_f32 v80,v80,s36,v18
v_mfma_f32_16x16x32_bf16 a[20:23],a[244:247],v[104:107],0
s_waitcnt lgkmcnt(8)
ds_read_b64_tr_b16 a[244:245],v4 offset:256
ds_read_b64_tr_b16 a[246:247],v4 offset:6400
v_mfma_f32_16x16x32_bf16 v[184:187],a[248:251],v[96:99],0
buffer_load_dwordx4 v7,s[4:7],s20 offen offset:0 lds
v_mfma_f32_16x16x32_bf16 v[232:235],a[248:251],v[100:103],0
ds_read_b128 a[228:231],v2 offset:30848
v_fma_f32 v81,v81,s36,v18
v_mfma_f32_16x16x32_bf16 a[24:27],a[248:251],v[104:107],0
s_waitcnt lgkmcnt(8)
ds_read_b64_tr_b16 a[248:249],v5 offset:256
ds_read_b64_tr_b16 a[250:251],v5 offset:6400
v_mfma_f32_16x16x32_bf16 v[188:191],a[252:255],v[96:99],0
ds_read_b128 a[232:235],v1 offset:30976
v_fma_f32 v82,v82,s36,v18
v_mfma_f32_16x16x32_bf16 v[236:239],a[252:255],v[100:103],0
ds_read_b128 a[236:239],v2 offset:30976
v_fma_f32 v83,v83,s36,v18
v_mfma_f32_16x16x32_bf16 a[28:31],a[252:255],v[104:107],0
s_waitcnt lgkmcnt(8)
ds_read_b64_tr_b16 a[252:253],v6 offset:256
ds_read_b64_tr_b16 a[254:255],v6 offset:6400
v_mfma_f32_16x16x32_bf16 v[192:195],a[240:243],v[96:99],0
buffer_load_dwordx4 v8,s[4:7],s20 offen offset:1024 lds
v_mfma_f32_16x16x32_bf16 v[240:243],a[240:243],v[100:103],0
v_fma_f32 v84,v84,s36,v18
v_fma_f32 v85,v85,s36,v18
v_mfma_f32_16x16x32_bf16 a[32:35],a[240:243],v[104:107],0
s_waitcnt lgkmcnt(7)
v_fma_f32 v86,v86,s36,v18
v_fma_f32 v87,v87,s36,v18
v_mfma_f32_16x16x32_bf16 v[196:199],a[244:247],v[96:99],0
v_exp_f32 v68,v68
v_mfma_f32_16x16x32_bf16 v[244:247],a[244:247],v[100:103],0
v_exp_f32 v69,v69
v_mfma_f32_16x16x32_bf16 a[36:39],a[244:247],v[104:107],0
s_waitcnt lgkmcnt(3)
v_exp_f32 v70,v70
v_mfma_f32_16x16x32_bf16 v[200:203],a[248:251],v[96:99],0
buffer_load_dwordx4 v9,s[4:7],s20 offen offset:2048 lds
v_mfma_f32_16x16x32_bf16 v[248:251],a[248:251],v[100:103],0
s_add_u32 s20,s20,12288
v_exp_f32 v71,v71
v_mfma_f32_16x16x32_bf16 a[40:43],a[248:251],v[104:107],0
s_waitcnt lgkmcnt(0)
v_exp_f32 v76,v76
v_mfma_f32_16x16x32_bf16 v[204:207],a[252:255],v[96:99],0
v_exp_f32 v77,v77
v_mfma_f32_16x16x32_bf16 v[252:255],a[252:255],v[100:103],0
v_exp_f32 v78,v78
v_mfma_f32_16x16x32_bf16 a[44:47],a[252:255],v[104:107],0
v_exp_f32 v79,v79
v_mfma_f32_16x16x32_bf16 v[32:35],a[192:195],a[96:99],0
v_exp_f32 v80,v80
v_mfma_f32_16x16x32_bf16 v[32:35],a[196:199],a[100:103],v[32:35]
v_exp_f32 v81,v81
v_mfma_f32_16x16x32_bf16 v[32:35],a[200:203],a[104:107],v[32:35]
v_exp_f32 v82,v82
v_mfma_f32_16x16x32_bf16 v[32:35],a[204:207],a[108:111],v[32:35]
v_exp_f32 v83,v83
v_mfma_f32_16x16x32_bf16 v[32:35],a[208:211],a[112:115],v[32:35]
v_exp_f32 v84,v84
v_mfma_f32_16x16x32_bf16 v[32:35],a[212:215],a[116:119],v[32:35]
v_exp_f32 v85,v85
v_mfma_f32_16x16x32_bf16 v[40:43],a[192:195],a[120:123],0
v_exp_f32 v86,v86
v_mfma_f32_16x16x32_bf16 v[40:43],a[196:199],a[124:127],v[40:43]
v_exp_f32 v87,v87
v_mfma_f32_16x16x32_bf16 v[40:43],a[200:203],a[128:131],v[40:43]
v_cvt_pk_bf16_f32 v114,v68,v69
v_cvt_pk_bf16_f32 v115,v70,v71
v_mfma_f32_16x16x32_bf16 v[40:43],a[204:207],a[132:135],v[40:43]
v_cvt_pk_bf16_f32 v118,v76,v77
v_cvt_pk_bf16_f32 v119,v78,v79
v_mfma_f32_16x16x32_bf16 v[128:131],v[24:27],v[112:115],v[128:131]
v_cvt_pk_bf16_f32 v120,v80,v81
v_cvt_pk_bf16_f32 v121,v82,v83
v_mfma_f32_16x16x32_bf16 v[132:135],v[24:27],v[116:119],v[132:135]
v_cvt_pk_bf16_f32 v122,v84,v85
v_cvt_pk_bf16_f32 v123,v86,v87
v_mfma_f32_16x16x32_bf16 v[40:43],a[208:211],a[136:139],v[40:43]
v_fma_f32 v32,v32,s36,v16
v_fma_f32 v33,v33,s36,v16
v_mfma_f32_16x16x32_bf16 v[136:139],v[24:27],v[120:123],v[136:139]
v_fma_f32 v34,v34,s36,v16
v_fma_f32 v35,v35,s36,v16
v_mfma_f32_16x16x32_bf16 v[40:43],a[212:215],a[140:143],v[40:43]
v_exp_f32 v32,v32
v_mfma_f32_16x16x32_bf16 v[48:51],a[192:195],a[144:147],0
v_exp_f32 v33,v33
v_mfma_f32_16x16x32_bf16 v[48:51],a[196:199],a[148:151],v[48:51]
v_exp_f32 v34,v34
v_mfma_f32_16x16x32_bf16 v[48:51],a[200:203],a[152:155],v[48:51]
v_exp_f32 v35,v35
v_mfma_f32_16x16x32_bf16 v[48:51],a[204:207],a[156:159],v[48:51]
v_fma_f32 v40,v40,s36,v17
v_fma_f32 v41,v41,s36,v17
v_mfma_f32_16x16x32_bf16 v[48:51],a[208:211],a[160:163],v[48:51]
v_fma_f32 v42,v42,s36,v17
v_fma_f32 v43,v43,s36,v17
v_mfma_f32_16x16x32_bf16 v[48:51],a[212:215],a[164:167],v[48:51]
v_exp_f32 v40,v40
v_mfma_f32_16x16x32_bf16 v[36:39],a[216:219],a[96:99],0
v_exp_f32 v41,v41
v_mfma_f32_16x16x32_bf16 v[36:39],a[220:223],a[100:103],v[36:39]
v_exp_f32 v42,v42
v_mfma_f32_16x16x32_bf16 v[36:39],a[224:227],a[104:107],v[36:39]
v_exp_f32 v43,v43
v_mfma_f32_16x16x32_bf16 v[36:39],a[228:231],a[108:111],v[36:39]
v_cvt_pk_bf16_f32 v96,v32,v33
v_cvt_pk_bf16_f32 v97,v34,v35
s_waitcnt vmcnt(6)
v_mfma_f32_16x16x32_bf16 v[36:39],a[232:235],a[112:115],v[36:39]
s_barrier
v_mfma_f32_16x16x32_bf16 v[36:39],a[236:239],a[116:119],v[36:39]
ds_read_b64_tr_b16 a[240:241],v3 offset:12288
ds_read_b64_tr_b16 a[242:243],v3 offset:18432
v_mfma_f32_16x16x32_bf16 v[44:47],a[216:219],a[120:123],0
v_cvt_pk_bf16_f32 v100,v40,v41
v_cvt_pk_bf16_f32 v101,v42,v43
v_mfma_f32_16x16x32_bf16 v[44:47],a[220:223],a[124:127],v[44:47]
ds_read_b64_tr_b16 a[244:245],v4 offset:12288
ds_read_b64_tr_b16 a[246:247],v4 offset:18432
v_mfma_f32_16x16x32_bf16 v[44:47],a[224:227],a[128:131],v[44:47]
ds_read_b64_tr_b16 a[248:249],v5 offset:12288
ds_read_b64_tr_b16 a[250:251],v5 offset:18432
v_mfma_f32_16x16x32_bf16 v[44:47],a[228:231],a[132:135],v[44:47]
v_mfma_f32_16x16x32_bf16 v[44:47],a[232:235],a[136:139],v[44:47]
ds_read_b64_tr_b16 a[252:253],v6 offset:12288
ds_read_b64_tr_b16 a[254:255],v6 offset:18432
v_mfma_f32_16x16x32_bf16 v[44:47],a[236:239],a[140:143],v[44:47]
v_mfma_f32_16x16x32_bf16 v[52:55],a[216:219],a[144:147],0
v_mfma_f32_16x16x32_bf16 v[52:55],a[220:223],a[148:151],v[52:55]
v_mfma_f32_16x16x32_bf16 v[52:55],a[224:227],a[152:155],v[52:55]
v_mfma_f32_16x16x32_bf16 v[52:55],a[228:231],a[156:159],v[52:55]
v_mfma_f32_16x16x32_bf16 v[52:55],a[232:235],a[160:163],v[52:55]
v_mfma_f32_16x16x32_bf16 v[52:55],a[236:239],a[164:167],v[52:55]
s_waitcnt lgkmcnt(2)
v_mfma_f32_16x16x32_bf16 v[160:163],a[240:243],v[112:115],v[160:163]
s_add_u32 m0,s23,0
ds_read_b128 a[192:195],v1 offset:0
v_fma_f32 v36,v36,s36,v16
v_mfma_f32_16x16x32_bf16 v[208:211],a[240:243],v[116:119],v[208:211]
buffer_load_dwordx4 v7,s[8:11],s21 offen offset:0 lds
v_mfma_f32_16x16x32_bf16 a[0:3],a[240:243],v[120:123],a[0:3]
ds_read_b64_tr_b16 a[240:241],v3 offset:12416
ds_read_b64_tr_b16 a[242:243],v3 offset:18560
v_mfma_f32_16x16x32_bf16 v[164:167],a[244:247],v[112:115],v[164:167]
ds_read_b128 a[196:199],v2 offset:0
v_fma_f32 v37,v37,s36,v16
v_mfma_f32_16x16x32_bf16 v[212:215],a[244:247],v[116:119],v[212:215]
ds_read_b128 a[200:203],v1 offset:128
v_fma_f32 v38,v38,s36,v16
v_mfma_f32_16x16x32_bf16 a[4:7],a[244:247],v[120:123],a[4:7]
ds_read_b64_tr_b16 a[244:245],v4 offset:12416
ds_read_b64_tr_b16 a[246:247],v4 offset:18560
v_mfma_f32_16x16x32_bf16 v[168:171],a[248:251],v[112:115],v[168:171]
ds_read_b128 a[204:207],v2 offset:128
v_fma_f32 v39,v39,s36,v16
v_mfma_f32_16x16x32_bf16 v[216:219],a[248:251],v[116:119],v[216:219]
buffer_load_dwordx4 v8,s[8:11],s21 offen offset:1024 lds
v_mfma_f32_16x16x32_bf16 a[8:11],a[248:251],v[120:123],a[8:11]
s_waitcnt lgkmcnt(7)
ds_read_b64_tr_b16 a[248:249],v5 offset:12416
ds_read_b64_tr_b16 a[250:251],v5 offset:18560
v_mfma_f32_16x16x32_bf16 v[172:175],a[252:255],v[112:115],v[172:175]
ds_read_b128 a[208:211],v1 offset:256
v_fma_f32 v44,v44,s36,v17
v_mfma_f32_16x16x32_bf16 v[220:223],a[252:255],v[116:119],v[220:223]
ds_read_b128 a[212:215],v2 offset:256
v_fma_f32 v45,v45,s36,v17
v_mfma_f32_16x16x32_bf16 a[12:15],a[252:255],v[120:123],a[12:15]
s_waitcnt lgkmcnt(8)
ds_read_b64_tr_b16 a[252:253],v6 offset:12416
ds_read_b64_tr_b16 a[254:255],v6 offset:18560
v_mfma_f32_16x16x32_bf16 v[176:179],a[240:243],v[112:115],v[176:179]
buffer_load_dwordx4 v9,s[8:11],s21 offen offset:2048 lds
v_mfma_f32_16x16x32_bf16 v[224:227],a[240:243],v[116:119],v[224:227]
s_add_u32 s21,s21,12288
ds_read_b128 a[216:219],v1 offset:6144
v_fma_f32 v46,v46,s36,v17
v_mfma_f32_16x16x32_bf16 a[16:19],a[240:243],v[120:123],a[16:19]
s_add_u32 m0,s22,24576
ds_read_b64_tr_b16 a[240:241],v3 offset:12544
ds_read_b64_tr_b16 a[242:243],v3 offset:18688
s_waitcnt lgkmcnt(9)
v_mfma_f32_16x16x32_bf16 v[180:183],a[244:247],v[112:115],v[180:183]
ds_read_b128 a[220:223],v2 offset:6144
v_fma_f32 v47,v47,s36,v17
v_mfma_f32_16x16x32_bf16 v[228:231],a[244:247],v[116:119],v[228:231]
ds_read_b128 a[224:227],v1 offset:6272
v_fma_f32 v48,v48,s36,v18
v_mfma_f32_16x16x32_bf16 a[20:23],a[244:247],v[120:123],a[20:23]
s_waitcnt lgkmcnt(8)
ds_read_b64_tr_b16 a[244:245],v4 offset:12544
ds_read_b64_tr_b16 a[246:247],v4 offset:18688
v_mfma_f32_16x16x32_bf16 v[184:187],a[248:251],v[112:115],v[184:187]
buffer_load_dwordx4 v7,s[4:7],s20 offen offset:0 lds
v_mfma_f32_16x16x32_bf16 v[232:235],a[248:251],v[116:119],v[232:235]
ds_read_b128 a[228:231],v2 offset:6272
v_fma_f32 v49,v49,s36,v18
v_mfma_f32_16x16x32_bf16 a[24:27],a[248:251],v[120:123],a[24:27]
s_waitcnt lgkmcnt(8)
ds_read_b64_tr_b16 a[248:249],v5 offset:12544
ds_read_b64_tr_b16 a[250:251],v5 offset:18688
v_mfma_f32_16x16x32_bf16 v[188:191],a[252:255],v[112:115],v[188:191]
ds_read_b128 a[232:235],v1 offset:6400
v_fma_f32 v50,v50,s36,v18
v_mfma_f32_16x16x32_bf16 v[236:239],a[252:255],v[116:119],v[236:239]
ds_read_b128 a[236:239],v2 offset:6400
v_fma_f32 v51,v51,s36,v18
v_mfma_f32_16x16x32_bf16 a[28:31],a[252:255],v[120:123],a[28:31]
s_waitcnt lgkmcnt(8)
ds_read_b64_tr_b16 a[252:253],v6 offset:12544
ds_read_b64_tr_b16 a[254:255],v6 offset:18688
v_mfma_f32_16x16x32_bf16 v[192:195],a[240:243],v[112:115],v[192:195]
buffer_load_dwordx4 v8,s[4:7],s20 offen offset:1024 lds
v_mfma_f32_16x16x32_bf16 v[240:243],a[240:243],v[116:119],v[240:243]
v_fma_f32 v52,v52,s36,v18
v_fma_f32 v53,v53,s36,v18
v_mfma_f32_16x16x32_bf16 a[32:35],a[240:243],v[120:123],a[32:35]
s_waitcnt lgkmcnt(7)
v_fma_f32 v54,v54,s36,v18
v_fma_f32 v55,v55,s36,v18
v_mfma_f32_16x16x32_bf16 v[196:199],a[244:247],v[112:115],v[196:199]
v_exp_f32 v36,v36
v_mfma_f32_16x16x32_bf16 v[244:247],a[244:247],v[116:119],v[244:247]
v_exp_f32 v37,v37
v_mfma_f32_16x16x32_bf16 a[36:39],a[244:247],v[120:123],a[36:39]
s_waitcnt lgkmcnt(3)
v_exp_f32 v38,v38
v_mfma_f32_16x16x32_bf16 v[200:203],a[248:251],v[112:115],v[200:203]
buffer_load_dwordx4 v9,s[4:7],s20 offen offset:2048 lds
v_mfma_f32_16x16x32_bf16 v[248:251],a[248:251],v[116:119],v[248:251]
s_add_u32 s20,s20,12288
v_exp_f32 v39,v39
v_mfma_f32_16x16x32_bf16 a[40:43],a[248:251],v[120:123],a[40:43]
s_waitcnt lgkmcnt(0)
v_exp_f32 v44,v44
v_mfma_f32_16x16x32_bf16 v[204:207],a[252:255],v[112:115],v[204:207]
v_exp_f32 v45,v45
v_mfma_f32_16x16x32_bf16 v[252:255],a[252:255],v[116:119],v[252:255]
v_exp_f32 v46,v46
v_mfma_f32_16x16x32_bf16 a[44:47],a[252:255],v[120:123],a[44:47]
v_exp_f32 v47,v47
v_mfma_f32_16x16x32_bf16 v[64:67],a[192:195],a[96:99],0
v_exp_f32 v48,v48
v_mfma_f32_16x16x32_bf16 v[64:67],a[196:199],a[100:103],v[64:67]
v_exp_f32 v49,v49
v_mfma_f32_16x16x32_bf16 v[64:67],a[200:203],a[104:107],v[64:67]
v_exp_f32 v50,v50
v_mfma_f32_16x16x32_bf16 v[64:67],a[204:207],a[108:111],v[64:67]
v_exp_f32 v51,v51
v_mfma_f32_16x16x32_bf16 v[64:67],a[208:211],a[112:115],v[64:67]
v_exp_f32 v52,v52
v_mfma_f32_16x16x32_bf16 v[64:67],a[212:215],a[116:119],v[64:67]
v_exp_f32 v53,v53
v_mfma_f32_16x16x32_bf16 v[72:75],a[192:195],a[120:123],0
v_exp_f32 v54,v54
v_mfma_f32_16x16x32_bf16 v[72:75],a[196:199],a[124:127],v[72:75]
v_exp_f32 v55,v55
v_mfma_f32_16x16x32_bf16 v[72:75],a[200:203],a[128:131],v[72:75]
v_cvt_pk_bf16_f32 v98,v36,v37
v_cvt_pk_bf16_f32 v99,v38,v39
v_mfma_f32_16x16x32_bf16 v[72:75],a[204:207],a[132:135],v[72:75]
v_cvt_pk_bf16_f32 v102,v44,v45
v_cvt_pk_bf16_f32 v103,v46,v47
v_mfma_f32_16x16x32_bf16 v[128:131],v[24:27],v[96:99],v[128:131]
v_cvt_pk_bf16_f32 v104,v48,v49
v_cvt_pk_bf16_f32 v105,v50,v51
v_mfma_f32_16x16x32_bf16 v[132:135],v[24:27],v[100:103],v[132:135]
v_cvt_pk_bf16_f32 v106,v52,v53
v_cvt_pk_bf16_f32 v107,v54,v55
v_mfma_f32_16x16x32_bf16 v[72:75],a[208:211],a[136:139],v[72:75]
v_fma_f32 v64,v64,s36,v16
v_fma_f32 v65,v65,s36,v16
v_mfma_f32_16x16x32_bf16 v[136:139],v[24:27],v[104:107],v[136:139]
v_fma_f32 v66,v66,s36,v16
v_fma_f32 v67,v67,s36,v16
v_mfma_f32_16x16x32_bf16 v[72:75],a[212:215],a[140:143],v[72:75]
v_exp_f32 v64,v64
v_mfma_f32_16x16x32_bf16 v[80:83],a[192:195],a[144:147],0
v_exp_f32 v65,v65
v_mfma_f32_16x16x32_bf16 v[80:83],a[196:199],a[148:151],v[80:83]
v_exp_f32 v66,v66
v_mfma_f32_16x16x32_bf16 v[80:83],a[200:203],a[152:155],v[80:83]
v_exp_f32 v67,v67
v_mfma_f32_16x16x32_bf16 v[80:83],a[204:207],a[156:159],v[80:83]
v_fma_f32 v72,v72,s36,v17
v_fma_f32 v73,v73,s36,v17
v_mfma_f32_16x16x32_bf16 v[80:83],a[208:211],a[160:163],v[80:83]
v_fma_f32 v74,v74,s36,v17
v_fma_f32 v75,v75,s36,v17
v_mfma_f32_16x16x32_bf16 v[80:83],a[212:215],a[164:167],v[80:83]
v_exp_f32 v72,v72
v_mfma_f32_16x16x32_bf16 v[68:71],a[216:219],a[96:99],0
v_exp_f32 v73,v73
v_mfma_f32_16x16x32_bf16 v[68:71],a[220:223],a[100:103],v[68:71]
v_exp_f32 v74,v74
v_mfma_f32_16x16x32_bf16 v[68:71],a[224:227],a[104:107],v[68:71]
v_exp_f32 v75,v75
v_mfma_f32_16x16x32_bf16 v[68:71],a[228:231],a[108:111],v[68:71]
v_cvt_pk_bf16_f32 v112,v64,v65
v_cvt_pk_bf16_f32 v113,v66,v67
s_waitcnt vmcnt(6)
v_mfma_f32_16x16x32_bf16 v[68:71],a[232:235],a[112:115],v[68:71]
s_barrier
v_mfma_f32_16x16x32_bf16 v[68:71],a[236:239],a[116:119],v[68:71]
ds_read_b64_tr_b16 a[240:241],v3 offset:24576
ds_read_b64_tr_b16 a[242:243],v3 offset:30720
v_mfma_f32_16x16x32_bf16 v[76:79],a[216:219],a[120:123],0
v_cvt_pk_bf16_f32 v116,v72,v73
v_cvt_pk_bf16_f32 v117,v74,v75
v_mfma_f32_16x16x32_bf16 v[76:79],a[220:223],a[124:127],v[76:79]
ds_read_b64_tr_b16 a[244:245],v4 offset:24576
ds_read_b64_tr_b16 a[246:247],v4 offset:30720
v_mfma_f32_16x16x32_bf16 v[76:79],a[224:227],a[128:131],v[76:79]
ds_read_b64_tr_b16 a[248:249],v5 offset:24576
ds_read_b64_tr_b16 a[250:251],v5 offset:30720
v_mfma_f32_16x16x32_bf16 v[76:79],a[228:231],a[132:135],v[76:79]
v_mfma_f32_16x16x32_bf16 v[76:79],a[232:235],a[136:139],v[76:79]
ds_read_b64_tr_b16 a[252:253],v6 offset:24576
ds_read_b64_tr_b16 a[254:255],v6 offset:30720
v_mfma_f32_16x16x32_bf16 v[76:79],a[236:239],a[140:143],v[76:79]
v_mfma_f32_16x16x32_bf16 v[84:87],a[216:219],a[144:147],0
v_mfma_f32_16x16x32_bf16 v[84:87],a[220:223],a[148:151],v[84:87]
v_mfma_f32_16x16x32_bf16 v[84:87],a[224:227],a[152:155],v[84:87]
v_mfma_f32_16x16x32_bf16 v[84:87],a[228:231],a[156:159],v[84:87]
v_mfma_f32_16x16x32_bf16 v[84:87],a[232:235],a[160:163],v[84:87]
v_mfma_f32_16x16x32_bf16 v[84:87],a[236:239],a[164:167],v[84:87]
s_mov_b32 s38,0
s_branch L_loop3
L_end4:
s_waitcnt lgkmcnt(4)
v_mfma_f32_16x16x32_bf16 v[160:163],a[240:243],v[96:99],v[160:163]
v_fma_f32 v68,v68,s36,v16
v_fma_f32 v69,v69,s36,v16
v_mfma_f32_16x16x32_bf16 v[208:211],a[240:243],v[100:103],v[208:211]
v_fma_f32 v70,v70,s36,v16
v_fma_f32 v71,v71,s36,v16
v_mfma_f32_16x16x32_bf16 a[0:3],a[240:243],v[104:107],a[0:3]
v_fma_f32 v76,v76,s36,v17
v_fma_f32 v77,v77,s36,v17
v_mfma_f32_16x16x32_bf16 a[48:51],a[240:243],v[108:111],a[48:51]
ds_read_b64_tr_b16 a[240:241],v3 offset:24704
ds_read_b64_tr_b16 a[242:243],v3 offset:30848
v_mfma_f32_16x16x32_bf16 v[164:167],a[244:247],v[96:99],v[164:167]
v_fma_f32 v78,v78,s36,v17
v_fma_f32 v79,v79,s36,v17
v_mfma_f32_16x16x32_bf16 v[212:215],a[244:247],v[100:103],v[212:215]
v_fma_f32 v80,v80,s36,v18
v_fma_f32 v81,v81,s36,v18
v_mfma_f32_16x16x32_bf16 a[4:7],a[244:247],v[104:107],a[4:7]
v_fma_f32 v82,v82,s36,v18
v_fma_f32 v83,v83,s36,v18
v_mfma_f32_16x16x32_bf16 a[52:55],a[244:247],v[108:111],a[52:55]
s_waitcnt lgkmcnt(2)
ds_read_b64_tr_b16 a[244:245],v4 offset:24704
ds_read_b64_tr_b16 a[246:247],v4 offset:30848
v_mfma_f32_16x16x32_bf16 v[168:171],a[248:251],v[96:99],v[168:171]
v_fma_f32 v84,v84,s36,v18
v_fma_f32 v85,v85,s36,v18
v_mfma_f32_16x16x32_bf16 v[216:219],a[248:251],v[100:103],v[216:219]
v_fma_f32 v86,v86,s36,v18
v_fma_f32 v87,v87,s36,v18
v_mfma_f32_16x16x32_bf16 a[8:11],a[248:251],v[104:107],a[8:11]
v_fma_f32 v88,v88,s36,v19
v_fma_f32 v89,v89,s36,v19
v_mfma_f32_16x16x32_bf16 a[56:59],a[248:251],v[108:111],a[56:59]
ds_read_b64_tr_b16 a[248:249],v5 offset:24704
ds_read_b64_tr_b16 a[250:251],v5 offset:30848
v_mfma_f32_16x16x32_bf16 v[172:175],a[252:255],v[96:99],v[172:175]
v_fma_f32 v90,v90,s36,v19
v_fma_f32 v91,v91,s36,v19
v_mfma_f32_16x16x32_bf16 v[220:223],a[252:255],v[100:103],v[220:223]
v_fma_f32 v92,v92,s36,v19
v_fma_f32 v93,v93,s36,v19
v_mfma_f32_16x16x32_bf16 a[12:15],a[252:255],v[104:107],a[12:15]
v_fma_f32 v94,v94,s36,v19
v_fma_f32 v95,v95,s36,v19
v_mfma_f32_16x16x32_bf16 a[60:63],a[252:255],v[108:111],a[60:63]
s_waitcnt lgkmcnt(3)
ds_read_b64_tr_b16 a[252:253],v6 offset:24704
ds_read_b64_tr_b16 a[254:255],v6 offset:30848
v_mfma_f32_16x16x32_bf16 v[176:179],a[240:243],v[96:99],v[176:179]
v_exp_f32 v68,v68
v_mfma_f32_16x16x32_bf16 v[224:227],a[240:243],v[100:103],v[224:227]
v_exp_f32 v69,v69
v_mfma_f32_16x16x32_bf16 a[16:19],a[240:243],v[104:107],a[16:19]
v_exp_f32 v70,v70
v_mfma_f32_16x16x32_bf16 a[64:67],a[240:243],v[108:111],a[64:67]
s_waitcnt lgkmcnt(3)
ds_read_b64_tr_b16 a[240:241],v3 offset:24832
ds_read_b64_tr_b16 a[242:243],v3 offset:30976
v_mfma_f32_16x16x32_bf16 v[180:183],a[244:247],v[96:99],v[180:183]
v_exp_f32 v71,v71
v_mfma_f32_16x16x32_bf16 v[228:231],a[244:247],v[100:103],v[228:231]
v_exp_f32 v76,v76
v_mfma_f32_16x16x32_bf16 a[20:23],a[244:247],v[104:107],a[20:23]
v_exp_f32 v77,v77
v_mfma_f32_16x16x32_bf16 a[68:71],a[244:247],v[108:111],a[68:71]
s_waitcnt lgkmcnt(2)
ds_read_b64_tr_b16 a[244:245],v4 offset:24832
ds_read_b64_tr_b16 a[246:247],v4 offset:30976
v_mfma_f32_16x16x32_bf16 v[184:187],a[248:251],v[96:99],v[184:187]
v_exp_f32 v78,v78
v_mfma_f32_16x16x32_bf16 v[232:235],a[248:251],v[100:103],v[232:235]
v_exp_f32 v79,v79
v_mfma_f32_16x16x32_bf16 a[24:27],a[248:251],v[104:107],a[24:27]
v_exp_f32 v80,v80
v_mfma_f32_16x16x32_bf16 a[72:75],a[248:251],v[108:111],a[72:75]
ds_read_b64_tr_b16 a[248:249],v5 offset:24832
ds_read_b64_tr_b16 a[250:251],v5 offset:30976
v_mfma_f32_16x16x32_bf16 v[188:191],a[252:255],v[96:99],v[188:191]
v_exp_f32 v81,v81
v_mfma_f32_16x16x32_bf16 v[236:239],a[252:255],v[100:103],v[236:239]
v_exp_f32 v82,v82
v_mfma_f32_16x16x32_bf16 a[28:31],a[252:255],v[104:107],a[28:31]
v_exp_f32 v83,v83
v_mfma_f32_16x16x32_bf16 a[76:79],a[252:255],v[108:111],a[76:79]
s_waitcnt lgkmcnt(3)
ds_read_b64_tr_b16 a[252:253],v6 offset:24832
ds_read_b64_tr_b16 a[254:255],v6 offset:30976
v_mfma_f32_16x16x32_bf16 v[192:195],a[240:243],v[96:99],v[192:195]
v_exp_f32 v84,v84
v_mfma_f32_16x16x32_bf16 v[240:243],a[240:243],v[100:103],v[240:243]
v_exp_f32 v85,v85
v_mfma_f32_16x16x32_bf16 a[32:35],a[240:243],v[104:107],a[32:35]
v_exp_f32 v86,v86
v_mfma_f32_16x16x32_bf16 a[80:83],a[240:243],v[108:111],a[80:83]
s_waitcnt lgkmcnt(3)
v_exp_f32 v87,v87
v_mfma_f32_16x16x32_bf16 v[196:199],a[244:247],v[96:99],v[196:199]
v_exp_f32 v88,v88
v_mfma_f32_16x16x32_bf16 v[244:247],a[244:247],v[100:103],v[244:247]
v_exp_f32 v89,v89
v_mfma_f32_16x16x32_bf16 a[36:39],a[244:247],v[104:107],a[36:39]
v_exp_f32 v90,v90
v_mfma_f32_16x16x32_bf16 a[84:87],a[244:247],v[108:111],a[84:87]
s_waitcnt lgkmcnt(0)
v_exp_f32 v91,v91
v_mfma_f32_16x16x32_bf16 v[200:203],a[248:251],v[96:99],v[200:203]
v_exp_f32 v92,v92
v_mfma_f32_16x16x32_bf16 v[248:251],a[248:251],v[100:103],v[248:251]
v_exp_f32 v93,v93
v_mfma_f32_16x16x32_bf16 a[40:43],a[248:251],v[104:107],a[40:43]
v_exp_f32 v94,v94
v_mfma_f32_16x16x32_bf16 a[88:91],a[248:251],v[108:111],a[88:91]
v_exp_f32 v95,v95
v_mfma_f32_16x16x32_bf16 v[204:207],a[252:255],v[96:99],v[204:207]
v_cvt_pk_bf16_f32 v114,v68,v69
v_cvt_pk_bf16_f32 v115,v70,v71
v_mfma_f32_16x16x32_bf16 v[252:255],a[252:255],v[100:103],v[252:255]
v_cvt_pk_bf16_f32 v118,v76,v77
v_cvt_pk_bf16_f32 v119,v78,v79
v_mfma_f32_16x16x32_bf16 v[128:131],v[24:27],v[112:115],v[128:131]
v_cvt_pk_bf16_f32 v120,v80,v81
v_cvt_pk_bf16_f32 v121,v82,v83
v_mfma_f32_16x16x32_bf16 v[132:135],v[24:27],v[116:119],v[132:135]
v_cvt_pk_bf16_f32 v122,v84,v85
v_cvt_pk_bf16_f32 v123,v86,v87
s_waitcnt vmcnt(6)
s_barrier
v_mfma_f32_16x16x32_bf16 v[136:139],v[24:27],v[120:123],v[136:139]
v_cvt_pk_bf16_f32 v124,v88,v89
v_cvt_pk_bf16_f32 v125,v90,v91
v_mfma_f32_16x16x32_bf16 a[44:47],a[252:255],v[104:107],a[44:47]
v_cvt_pk_bf16_f32 v126,v92,v93
v_cvt_pk_bf16_f32 v127,v94,v95
v_mfma_f32_16x16x32_bf16 a[92:95],a[252:255],v[108:111],a[92:95]
ds_read_b64_tr_b16 a[240:241],v3 offset:0
v_mfma_f32_16x16x32_bf16 v[140:143],v[24:27],v[124:127],v[140:143]
ds_read_b64_tr_b16 a[242:243],v3 offset:6144
ds_read_b64_tr_b16 a[244:245],v4 offset:0
ds_read_b64_tr_b16 a[246:247],v4 offset:6144
ds_read_b64_tr_b16 a[248:249],v5 offset:0
ds_read_b64_tr_b16 a[250:251],v5 offset:6144
ds_read_b64_tr_b16 a[252:253],v6 offset:0
ds_read_b64_tr_b16 a[254:255],v6 offset:6144
s_waitcnt lgkmcnt(6)
v_mfma_f32_16x16x32_bf16 v[160:163],a[240:243],v[112:115],v[160:163]
s_waitcnt vmcnt(0)
v_rcp_f32 v144,v128
v_mfma_f32_16x16x32_bf16 v[208:211],a[240:243],v[116:119],v[208:211]
s_add_u32 s84,s42,0
v_rcp_f32 v150,v140
v_mfma_f32_16x16x32_bf16 a[0:3],a[240:243],v[120:123],a[0:3]
s_add_u32 s85,s42,6144
v_rcp_f32 v146,v132
v_mfma_f32_16x16x32_bf16 a[48:51],a[240:243],v[124:127],a[48:51]
s_add_u32 s86,s42,12288
ds_read_b64_tr_b16 a[240:241],v3 offset:128
ds_read_b64_tr_b16 a[242:243],v3 offset:6272
s_waitcnt lgkmcnt(6)
v_mfma_f32_16x16x32_bf16 v[164:167],a[244:247],v[112:115],v[164:167]
s_add_u32 s87,s42,18432
v_rcp_f32 v148,v136
v_mfma_f32_16x16x32_bf16 v[212:215],a[244:247],v[116:119],v[212:215]
v_max3_f32 v30,v128,v132,v136
v_accvgpr_read_b32 v64,a48
v_mfma_f32_16x16x32_bf16 a[4:7],a[244:247],v[120:123],a[4:7]
v_accvgpr_read_b32 v65,a49
v_accvgpr_read_b32 v66,a50
v_mfma_f32_16x16x32_bf16 a[52:55],a[244:247],v[124:127],a[52:55]
ds_read_b64_tr_b16 a[244:245],v4 offset:128
ds_read_b64_tr_b16 a[246:247],v4 offset:6272
v_accvgpr_read_b32 v67,a51
v_max_f32 v30,v30,v140
v_cmp_ngt_f32 vcc,s37,v30
v_pk_mul_f32 v[64:65],v[64:65],v[150:151] op_sel_hi:[1,0]
v_pk_mul_f32 v[160:161],v[160:161],v[144:145] op_sel_hi:[1,0]
v_pk_mul_f32 v[162:163],v[162:163],v[144:145] op_sel_hi:[1,0]
v_pk_mul_f32 v[66:67],v[66:67],v[150:151] op_sel_hi:[1,0]
v_accvgpr_read_b32 v68,a52
v_accvgpr_read_b32 v69,a53
s_waitcnt lgkmcnt(4)
v_mfma_f32_16x16x32_bf16 v[168:171],a[248:251],v[112:115],v[168:171]
s_cmp_lg_u64 vcc,0
v_accvgpr_read_b32 v70,a54
v_accvgpr_read_b32 v71,a55
v_mfma_f32_16x16x32_bf16 v[216:219],a[248:251],v[116:119],v[216:219]
s_cselect_b32 s62,s32,0
v_cvt_pk_bf16_f32 v64,v64,v65
v_cvt_pk_bf16_f32 v160,v160,v161
v_mfma_f32_16x16x32_bf16 a[8:11],a[248:251],v[120:123],a[8:11]
s_or_b32 s31,s31,s62
v_cvt_pk_bf16_f32 v65,v66,v67
v_cvt_pk_bf16_f32 v161,v162,v163
s_lshl_b32 s32,s32,1
ds_write2st64_b64 v12,v[64:65],v[160:161] offset0:36 offset1:0
v_pk_mul_f32 v[68:69],v[68:69],v[150:151] op_sel_hi:[1,0]
v_pk_mul_f32 v[70:71],v[70:71],v[150:151] op_sel_hi:[1,0]
v_pk_mul_f32 v[164:165],v[164:165],v[144:145] op_sel_hi:[1,0]
v_pk_mul_f32 v[166:167],v[166:167],v[144:145] op_sel_hi:[1,0]
v_cvt_pk_bf16_f32 v68,v68,v69
v_cvt_pk_bf16_f32 v164,v164,v165
v_mfma_f32_16x16x32_bf16 a[56:59],a[248:251],v[124:127],a[56:59]
ds_read_b64_tr_b16 a[248:249],v5 offset:128
ds_read_b64_tr_b16 a[250:251],v5 offset:6272
v_mfma_f32_16x16x32_bf16 v[172:175],a[252:255],v[112:115],v[172:175]
v_cvt_pk_bf16_f32 v69,v70,v71
v_cvt_pk_bf16_f32 v165,v166,v167
v_mfma_f32_16x16x32_bf16 v[220:223],a[252:255],v[116:119],v[220:223]
ds_write2st64_b64 v20,v[68:69],v[164:165] offset0:36 offset1:0
v_mfma_f32_16x16x32_bf16 a[12:15],a[252:255],v[120:123],a[12:15]
v_accvgpr_read_b32 v72,a56
v_accvgpr_read_b32 v73,a57
v_accvgpr_read_b32 v74,a58
v_accvgpr_read_b32 v75,a59
v_pk_mul_f32 v[168:169],v[168:169],v[144:145] op_sel_hi:[1,0]
v_pk_mul_f32 v[170:171],v[170:171],v[144:145] op_sel_hi:[1,0]
v_pk_mul_f32 v[72:73],v[72:73],v[150:151] op_sel_hi:[1,0]
v_pk_mul_f32 v[74:75],v[74:75],v[150:151] op_sel_hi:[1,0]
v_cvt_pk_bf16_f32 v168,v168,v169
v_cvt_pk_bf16_f32 v72,v72,v73
v_mfma_f32_16x16x32_bf16 a[60:63],a[252:255],v[124:127],a[60:63]
s_waitcnt lgkmcnt(3)
ds_read_b64_tr_b16 a[252:253],v6 offset:128
ds_read_b64_tr_b16 a[254:255],v6 offset:6272
v_mfma_f32_16x16x32_bf16 v[176:179],a[240:243],v[112:115],v[176:179]
v_cvt_pk_bf16_f32 v169,v170,v171
v_cvt_pk_bf16_f32 v73,v74,v75
v_mfma_f32_16x16x32_bf16 v[224:227],a[240:243],v[116:119],v[224:227]
ds_write2st64_b64 v21,v[72:73],v[168:169] offset0:36 offset1:0
v_mfma_f32_16x16x32_bf16 a[16:19],a[240:243],v[120:123],a[16:19]
v_accvgpr_read_b32 v76,a60
v_accvgpr_read_b32 v77,a61
v_accvgpr_read_b32 v78,a62
v_accvgpr_read_b32 v79,a63
v_pk_mul_f32 v[172:173],v[172:173],v[144:145] op_sel_hi:[1,0]
v_pk_mul_f32 v[174:175],v[174:175],v[144:145] op_sel_hi:[1,0]
v_pk_mul_f32 v[76:77],v[76:77],v[150:151] op_sel_hi:[1,0]
v_pk_mul_f32 v[78:79],v[78:79],v[150:151] op_sel_hi:[1,0]
v_cvt_pk_bf16_f32 v172,v172,v173
v_cvt_pk_bf16_f32 v76,v76,v77
v_mfma_f32_16x16x32_bf16 a[64:67],a[240:243],v[124:127],a[64:67]
ds_read_b64_tr_b16 a[240:241],v3 offset:256
ds_read_b64_tr_b16 a[242:243],v3 offset:6400
v_cvt_pk_bf16_f32 v173,v174,v175
v_cvt_pk_bf16_f32 v77,v78,v79
v_pk_mul_f32 v[208:209],v[208:209],v[146:147] op_sel_hi:[1,0]
v_pk_mul_f32 v[210:211],v[210:211],v[146:147] op_sel_hi:[1,0]
v_pk_mul_f32 v[176:177],v[176:177],v[144:145] op_sel_hi:[1,0]
v_pk_mul_f32 v[178:179],v[178:179],v[144:145] op_sel_hi:[1,0]
v_cvt_pk_bf16_f32 v208,v208,v209
v_cvt_pk_bf16_f32 v176,v176,v177
v_mfma_f32_16x16x32_bf16 v[180:183],a[244:247],v[112:115],v[180:183]
ds_write2st64_b64 v22,v[76:77],v[172:173] offset0:36 offset1:0
v_mfma_f32_16x16x32_bf16 v[228:231],a[244:247],v[116:119],v[228:231]
v_accvgpr_read_b32 v80,a64
v_accvgpr_read_b32 v81,a65
v_mfma_f32_16x16x32_bf16 a[20:23],a[244:247],v[120:123],a[20:23]
ds_read_b128 v[152:155],v15 offset:18432
v_accvgpr_read_b32 v82,a66
v_mfma_f32_16x16x32_bf16 a[68:71],a[244:247],v[124:127],a[68:71]
ds_read_b64_tr_b16 a[244:245],v4 offset:256
ds_read_b64_tr_b16 a[246:247],v4 offset:6400
ds_read_b128 v[156:159],v15 offset:21504
v_accvgpr_read_b32 v83,a67
v_cvt_pk_bf16_f32 v209,v210,v211
v_pk_mul_f32 v[212:213],v[212:213],v[146:147] op_sel_hi:[1,0]
v_pk_mul_f32 v[214:215],v[214:215],v[146:147] op_sel_hi:[1,0]
v_pk_mul_f32 v[180:181],v[180:181],v[144:145] op_sel_hi:[1,0]
v_pk_mul_f32 v[182:183],v[182:183],v[144:145] op_sel_hi:[1,0]
v_cvt_pk_bf16_f32 v177,v178,v179
v_accvgpr_read_b32 v84,a68
s_waitcnt lgkmcnt(5)
v_mfma_f32_16x16x32_bf16 v[184:187],a[248:251],v[112:115],v[184:187]
ds_read_b128 v[100:103],v15 offset:0
v_accvgpr_read_b32 v85,a69
v_mfma_f32_16x16x32_bf16 v[232:235],a[248:251],v[116:119],v[232:235]
ds_read_b128 v[104:107],v15 offset:3072
v_accvgpr_read_b32 v86,a70
v_mfma_f32_16x16x32_bf16 a[24:27],a[248:251],v[120:123],a[24:27]
ds_write2st64_b64 v12,v[208:209],v[176:177] offset0:12 offset1:2
v_mfma_f32_16x16x32_bf16 a[72:75],a[248:251],v[124:127],a[72:75]
v_accvgpr_read_b32 v87,a71
v_cvt_pk_bf16_f32 v212,v212,v213
v_cvt_pk_bf16_f32 v180,v180,v181
v_cvt_pk_bf16_f32 v213,v214,v215
v_cvt_pk_bf16_f32 v181,v182,v183
v_pk_mul_f32 v[216:217],v[216:217],v[146:147] op_sel_hi:[1,0]
v_pk_mul_f32 v[218:219],v[218:219],v[146:147] op_sel_hi:[1,0]
v_pk_mul_f32 v[184:185],v[184:185],v[144:145] op_sel_hi:[1,0]
v_pk_mul_f32 v[186:187],v[186:187],v[144:145] op_sel_hi:[1,0]
v_accvgpr_read_b32 v88,a72
v_accvgpr_read_b32 v89,a73
v_mfma_f32_16x16x32_bf16 v[188:191],a[252:255],v[112:115],v[188:191]
ds_read_b64_tr_b16 a[248:249],v5 offset:256
ds_read_b64_tr_b16 a[250:251],v5 offset:6400
v_mfma_f32_16x16x32_bf16 v[236:239],a[252:255],v[116:119],v[236:239]
ds_write2st64_b64 v20,v[212:213],v[180:181] offset0:12 offset1:2
v_mfma_f32_16x16x32_bf16 a[28:31],a[252:255],v[120:123],a[28:31]
v_accvgpr_read_b32 v90,a74
v_accvgpr_read_b32 v91,a75
v_mfma_f32_16x16x32_bf16 a[76:79],a[252:255],v[124:127],a[76:79]
s_waitcnt lgkmcnt(3)
ds_read_b64_tr_b16 a[252:253],v6 offset:256
ds_read_b64_tr_b16 a[254:255],v6 offset:6400
buffer_store_dwordx4 v[152:155],v10,s[16:19],s87 offen offset:0 nt
v_cvt_pk_bf16_f32 v216,v216,v217
v_pk_mul_f32 v[220:221],v[220:221],v[146:147] op_sel_hi:[1,0]
v_pk_mul_f32 v[222:223],v[222:223],v[146:147] op_sel_hi:[1,0]
v_pk_mul_f32 v[188:189],v[188:189],v[144:145] op_sel_hi:[1,0]
v_pk_mul_f32 v[190:191],v[190:191],v[144:145] op_sel_hi:[1,0]
v_pk_mul_f32 v[80:81],v[80:81],v[150:151] op_sel_hi:[1,0]
v_pk_mul_f32 v[82:83],v[82:83],v[150:151] op_sel_hi:[1,0]
v_pk_mul_f32 v[224:225],v[224:225],v[146:147] op_sel_hi:[1,0]
v_pk_mul_f32 v[226:227],v[226:227],v[146:147] op_sel_hi:[1,0]
v_pk_mul_f32 v[84:85],v[84:85],v[150:151] op_sel_hi:[1,0]
v_pk_mul_f32 v[86:87],v[86:87],v[150:151] op_sel_hi:[1,0]
v_pk_mul_f32 v[228:229],v[228:229],v[146:147] op_sel_hi:[1,0]
v_pk_mul_f32 v[230:231],v[230:231],v[146:147] op_sel_hi:[1,0]
v_pk_mul_f32 v[88:89],v[88:89],v[150:151] op_sel_hi:[1,0]
v_pk_mul_f32 v[90:91],v[90:91],v[150:151] op_sel_hi:[1,0]
v_pk_mul_f32 v[232:233],v[232:233],v[146:147] op_sel_hi:[1,0]
v_pk_mul_f32 v[234:235],v[234:235],v[146:147] op_sel_hi:[1,0]
v_cvt_pk_bf16_f32 v184,v184,v185
v_cvt_pk_bf16_f32 v217,v218,v219
v_mfma_f32_16x16x32_bf16 v[192:195],a[240:243],v[112:115],v[192:195]
buffer_store_dwordx4 v[156:159],v10,s[16:19],s87 offen offset:3072 nt
v_cvt_pk_bf16_f32 v220,v220,v221
v_cvt_pk_bf16_f32 v188,v188,v189
v_cvt_pk_bf16_f32 v185,v186,v187
v_mfma_f32_16x16x32_bf16 v[240:243],a[240:243],v[116:119],v[240:243]
v_cvt_pk_bf16_f32 v221,v222,v223
v_cvt_pk_bf16_f32 v189,v190,v191
v_mfma_f32_16x16x32_bf16 a[32:35],a[240:243],v[120:123],a[32:35]
v_accvgpr_read_b32 v92,a76
v_accvgpr_read_b32 v93,a77
v_accvgpr_read_b32 v94,a78
v_accvgpr_read_b32 v95,a79
v_cvt_pk_bf16_f32 v80,v80,v81
v_pk_mul_f32 v[236:237],v[236:237],v[146:147] op_sel_hi:[1,0]
v_pk_mul_f32 v[238:239],v[238:239],v[146:147] op_sel_hi:[1,0]
v_pk_mul_f32 v[92:93],v[92:93],v[150:151] op_sel_hi:[1,0]
v_pk_mul_f32 v[94:95],v[94:95],v[150:151] op_sel_hi:[1,0]
v_cvt_pk_bf16_f32 v224,v224,v225
v_cvt_pk_bf16_f32 v84,v84,v85
v_mfma_f32_16x16x32_bf16 a[80:83],a[240:243],v[124:127],a[80:83]
ds_write2st64_b64 v21,v[216:217],v[184:185] offset0:12 offset1:2
v_mfma_f32_16x16x32_bf16 v[196:199],a[244:247],v[112:115],v[196:199]
v_cvt_pk_bf16_f32 v228,v228,v229
v_cvt_pk_bf16_f32 v81,v82,v83
v_mfma_f32_16x16x32_bf16 v[244:247],a[244:247],v[116:119],v[244:247]
buffer_store_dwordx4 v[100:103],v10,s[16:19],s84 offen offset:0 nt
v_cvt_pk_bf16_f32 v225,v226,v227
v_cvt_pk_bf16_f32 v88,v88,v89
v_accvgpr_read_b32 v64,a80
v_mfma_f32_16x16x32_bf16 a[36:39],a[244:247],v[120:123],a[36:39]
v_accvgpr_read_b32 v65,a81
v_accvgpr_read_b32 v66,a82
v_accvgpr_read_b32 v67,a83
v_cvt_pk_bf16_f32 v232,v232,v233
v_cvt_pk_bf16_f32 v85,v86,v87
v_pk_mul_f32 v[192:193],v[192:193],v[144:145] op_sel_hi:[1,0]
v_pk_mul_f32 v[194:195],v[194:195],v[144:145] op_sel_hi:[1,0]
v_pk_mul_f32 v[64:65],v[64:65],v[150:151] op_sel_hi:[1,0]
v_pk_mul_f32 v[66:67],v[66:67],v[150:151] op_sel_hi:[1,0]
v_cvt_pk_bf16_f32 v229,v230,v231
v_cvt_pk_bf16_f32 v236,v236,v237
v_mfma_f32_16x16x32_bf16 a[84:87],a[244:247],v[124:127],a[84:87]
s_waitcnt lgkmcnt(0)
ds_write2st64_b64 v22,v[220:221],v[188:189] offset0:12 offset1:2
v_mfma_f32_16x16x32_bf16 v[200:203],a[248:251],v[112:115],v[200:203]
v_cvt_pk_bf16_f32 v92,v92,v93
v_cvt_pk_bf16_f32 v89,v90,v91
v_mfma_f32_16x16x32_bf16 v[248:251],a[248:251],v[116:119],v[248:251]
ds_read_b128 v[152:155],v15 offset:6144
buffer_store_dwordx4 v[104:107],v10,s[16:19],s84 offen offset:3072 nt
ds_read_b128 v[156:159],v15 offset:9216
v_cvt_pk_bf16_f32 v233,v234,v235
v_cvt_pk_bf16_f32 v237,v238,v239
v_mfma_f32_16x16x32_bf16 a[40:43],a[248:251],v[120:123],a[40:43]
ds_read_b128 v[100:103],v15 offset:1024
v_cvt_pk_bf16_f32 v93,v94,v95
v_accvgpr_read_b32 v68,a84
v_accvgpr_read_b32 v69,a85
v_accvgpr_read_b32 v70,a86
v_pk_mul_f32 v[196:197],v[196:197],v[144:145] op_sel_hi:[1,0]
v_pk_mul_f32 v[198:199],v[198:199],v[144:145] op_sel_hi:[1,0]
v_pk_mul_f32 v[68:69],v[68:69],v[150:151] op_sel_hi:[1,0]
v_accvgpr_read_b32 v71,a87
v_pk_mul_f32 v[70:71],v[70:71],v[150:151] op_sel_hi:[1,0]
v_cvt_pk_bf16_f32 v192,v192,v193
v_cvt_pk_bf16_f32 v64,v64,v65
v_mfma_f32_16x16x32_bf16 a[88:91],a[248:251],v[124:127],a[88:91]
ds_read_b128 v[104:107],v15 offset:4096
v_cvt_pk_bf16_f32 v196,v196,v197
v_mfma_f32_16x16x32_bf16 v[204:207],a[252:255],v[112:115],v[204:207]
ds_write2st64_b64 v12,v[80:81],v[224:225] offset0:36 offset1:14
v_mfma_f32_16x16x32_bf16 v[252:255],a[252:255],v[116:119],v[252:255]
v_cvt_pk_bf16_f32 v68,v68,v69
v_cvt_pk_bf16_f32 v193,v194,v195
v_mfma_f32_16x16x32_bf16 a[44:47],a[252:255],v[120:123],a[44:47]
s_waitcnt lgkmcnt(4)
buffer_store_dwordx4 v[152:155],v10,s[16:19],s85 offen offset:0 nt
v_accvgpr_read_b32 v72,a88
v_accvgpr_read_b32 v73,a89
v_accvgpr_read_b32 v74,a90
v_pk_mul_f32 v[200:201],v[200:201],v[144:145] op_sel_hi:[1,0]
v_pk_mul_f32 v[202:203],v[202:203],v[144:145] op_sel_hi:[1,0]
v_pk_mul_f32 v[72:73],v[72:73],v[150:151] op_sel_hi:[1,0]
v_accvgpr_read_b32 v75,a91
v_pk_mul_f32 v[74:75],v[74:75],v[150:151] op_sel_hi:[1,0]
v_cvt_pk_bf16_f32 v65,v66,v67
v_cvt_pk_bf16_f32 v197,v198,v199
v_mfma_f32_16x16x32_bf16 a[92:95],a[252:255],v[124:127],a[92:95]
ds_write2st64_b64 v20,v[84:85],v[228:229] offset0:36 offset1:14
v_pk_mul_f32 v[204:205],v[204:205],v[144:145] op_sel_hi:[1,0]
v_pk_mul_f32 v[206:207],v[206:207],v[144:145] op_sel_hi:[1,0]
v_pk_mul_f32 v[240:241],v[240:241],v[146:147] op_sel_hi:[1,0]
v_pk_mul_f32 v[242:243],v[242:243],v[146:147] op_sel_hi:[1,0]
v_pk_mul_f32 v[244:245],v[244:245],v[146:147] op_sel_hi:[1,0]
v_pk_mul_f32 v[246:247],v[246:247],v[146:147] op_sel_hi:[1,0]
v_pk_mul_f32 v[248:249],v[248:249],v[146:147] op_sel_hi:[1,0]
v_pk_mul_f32 v[250:251],v[250:251],v[146:147] op_sel_hi:[1,0]
v_pk_mul_f32 v[252:253],v[252:253],v[146:147] op_sel_hi:[1,0]
v_pk_mul_f32 v[254:255],v[254:255],v[146:147] op_sel_hi:[1,0]
v_accvgpr_read_b32 v76,a92
v_accvgpr_read_b32 v77,a93
v_pk_mul_f32 v[76:77],v[76:77],v[150:151] op_sel_hi:[1,0]
v_cvt_pk_bf16_f32 v69,v70,v71
v_cvt_pk_bf16_f32 v200,v200,v201
v_cvt_pk_bf16_f32 v72,v72,v73
v_accvgpr_read_b32 v78,a94
v_accvgpr_read_b32 v79,a95
v_pk_mul_f32 v[78:79],v[78:79],v[150:151] op_sel_hi:[1,0]
v_cvt_pk_bf16_f32 v204,v204,v205
v_cvt_pk_bf16_f32 v76,v76,v77
v_cvt_pk_bf16_f32 v201,v202,v203
v_cvt_pk_bf16_f32 v73,v74,v75
v_cvt_pk_bf16_f32 v205,v206,v207
v_cvt_pk_bf16_f32 v77,v78,v79
v_accvgpr_read_b32 v80,a0
v_accvgpr_read_b32 v81,a1
v_pk_mul_f32 v[80:81],v[80:81],v[148:149] op_sel_hi:[1,0]
v_accvgpr_read_b32 v82,a2
v_accvgpr_read_b32 v83,a3
v_pk_mul_f32 v[82:83],v[82:83],v[148:149] op_sel_hi:[1,0]
v_accvgpr_read_b32 v84,a4
v_accvgpr_read_b32 v85,a5
v_pk_mul_f32 v[84:85],v[84:85],v[148:149] op_sel_hi:[1,0]
v_accvgpr_read_b32 v86,a6
v_accvgpr_read_b32 v87,a7
v_pk_mul_f32 v[86:87],v[86:87],v[148:149] op_sel_hi:[1,0]
v_cvt_pk_bf16_f32 v240,v240,v241
v_cvt_pk_bf16_f32 v80,v80,v81
v_accvgpr_read_b32 v90,a10
v_accvgpr_read_b32 v91,a11
v_pk_mul_f32 v[90:91],v[90:91],v[148:149] op_sel_hi:[1,0]
v_cvt_pk_bf16_f32 v244,v244,v245
v_cvt_pk_bf16_f32 v84,v84,v85
v_cvt_pk_bf16_f32 v241,v242,v243
v_cvt_pk_bf16_f32 v81,v82,v83
v_accvgpr_read_b32 v94,a14
v_accvgpr_read_b32 v95,a15
v_pk_mul_f32 v[94:95],v[94:95],v[148:149] op_sel_hi:[1,0]
v_cvt_pk_bf16_f32 v248,v248,v249
v_cvt_pk_bf16_f32 v245,v246,v247
v_cvt_pk_bf16_f32 v85,v86,v87
v_cvt_pk_bf16_f32 v252,v252,v253
v_cvt_pk_bf16_f32 v249,v250,v251
v_cvt_pk_bf16_f32 v253,v254,v255
v_accvgpr_read_b32 v66,a18
v_accvgpr_read_b32 v67,a19
v_pk_mul_f32 v[66:67],v[66:67],v[148:149] op_sel_hi:[1,0]
v_accvgpr_read_b32 v70,a34
v_accvgpr_read_b32 v71,a35
v_pk_mul_f32 v[70:71],v[70:71],v[148:149] op_sel_hi:[1,0]
v_accvgpr_read_b32 v74,a22
v_accvgpr_read_b32 v75,a23
v_pk_mul_f32 v[74:75],v[74:75],v[148:149] op_sel_hi:[1,0]
v_accvgpr_read_b32 v78,a38
v_accvgpr_read_b32 v79,a39
v_pk_mul_f32 v[78:79],v[78:79],v[148:149] op_sel_hi:[1,0]
v_accvgpr_read_b32 v82,a26
v_accvgpr_read_b32 v83,a27
v_pk_mul_f32 v[82:83],v[82:83],v[148:149] op_sel_hi:[1,0]
v_accvgpr_read_b32 v86,a42
v_accvgpr_read_b32 v87,a43
v_pk_mul_f32 v[86:87],v[86:87],v[148:149] op_sel_hi:[1,0]
ds_write2st64_b64 v21,v[88:89],v[232:233] offset0:36 offset1:14
v_accvgpr_read_b32 v88,a8
v_accvgpr_read_b32 v89,a9
v_pk_mul_f32 v[88:89],v[88:89],v[148:149] op_sel_hi:[1,0]
s_waitcnt lgkmcnt(1)
buffer_store_dwordx4 v[156:159],v10,s[16:19],s85 offen offset:3072 nt
v_cvt_pk_bf16_f32 v88,v88,v89
v_cvt_pk_bf16_f32 v89,v90,v91
v_accvgpr_read_b32 v90,a30
v_accvgpr_read_b32 v91,a31
v_pk_mul_f32 v[90:91],v[90:91],v[148:149] op_sel_hi:[1,0]
ds_write2st64_b64 v22,v[92:93],v[236:237] offset0:36 offset1:14
v_accvgpr_read_b32 v92,a12
v_accvgpr_read_b32 v93,a13
v_pk_mul_f32 v[92:93],v[92:93],v[148:149] op_sel_hi:[1,0]
ds_read_b128 v[152:155],v15 offset:18432
buffer_store_dwordx4 v[100:103],v10,s[16:19],s84 offen offset:128 nt
ds_read_b128 v[156:159],v15 offset:21504
v_cvt_pk_bf16_f32 v92,v92,v93
v_cvt_pk_bf16_f32 v93,v94,v95
v_accvgpr_read_b32 v94,a46
v_accvgpr_read_b32 v95,a47
v_pk_mul_f32 v[94:95],v[94:95],v[148:149] op_sel_hi:[1,0]
ds_read_b128 v[100:103],v15 offset:7168
buffer_store_dwordx4 v[104:107],v10,s[16:19],s84 offen offset:3200 nt
s_waitcnt lgkmcnt(2)
buffer_store_dwordx4 v[152:155],v10,s[16:19],s87 offen offset:128 nt
ds_read_b128 v[104:107],v15 offset:10240
ds_write2st64_b64 v12,v[64:65],v[192:193] offset0:36 offset1:4
v_accvgpr_read_b32 v64,a16
v_accvgpr_read_b32 v65,a17
v_pk_mul_f32 v[64:65],v[64:65],v[148:149] op_sel_hi:[1,0]
s_waitcnt lgkmcnt(2)
buffer_store_dwordx4 v[156:159],v10,s[16:19],s87 offen offset:3200 nt
v_cvt_pk_bf16_f32 v64,v64,v65
v_cvt_pk_bf16_f32 v65,v66,v67
ds_write2st64_b64 v20,v[68:69],v[196:197] offset0:36 offset1:4
v_accvgpr_read_b32 v68,a32
v_accvgpr_read_b32 v69,a33
v_pk_mul_f32 v[68:69],v[68:69],v[148:149] op_sel_hi:[1,0]
buffer_store_dwordx4 v[100:103],v10,s[16:19],s85 offen offset:128 nt
v_cvt_pk_bf16_f32 v68,v68,v69
v_cvt_pk_bf16_f32 v69,v70,v71
ds_write2st64_b64 v21,v[72:73],v[200:201] offset0:36 offset1:4
v_accvgpr_read_b32 v72,a20
v_accvgpr_read_b32 v73,a21
v_pk_mul_f32 v[72:73],v[72:73],v[148:149] op_sel_hi:[1,0]
s_waitcnt lgkmcnt(2)
buffer_store_dwordx4 v[104:107],v10,s[16:19],s85 offen offset:3200 nt
v_cvt_pk_bf16_f32 v72,v72,v73
v_cvt_pk_bf16_f32 v73,v74,v75
ds_write2st64_b64 v22,v[76:77],v[204:205] offset0:36 offset1:4
v_accvgpr_read_b32 v76,a36
v_accvgpr_read_b32 v77,a37
v_pk_mul_f32 v[76:77],v[76:77],v[148:149] op_sel_hi:[1,0]
ds_read_b128 v[152:155],v15 offset:18432
v_cvt_pk_bf16_f32 v76,v76,v77
v_cvt_pk_bf16_f32 v77,v78,v79
ds_read_b128 v[156:159],v15 offset:21504
ds_read_b128 v[100:103],v15 offset:2048
ds_read_b128 v[104:107],v15 offset:5120
ds_write2st64_b64 v12,v[240:241],v[80:81] offset0:16 offset1:24
v_accvgpr_read_b32 v80,a24
v_accvgpr_read_b32 v81,a25
v_pk_mul_f32 v[80:81],v[80:81],v[148:149] op_sel_hi:[1,0]
ds_write2st64_b64 v20,v[244:245],v[84:85] offset0:16 offset1:24
v_accvgpr_read_b32 v84,a40
v_accvgpr_read_b32 v85,a41
v_pk_mul_f32 v[84:85],v[84:85],v[148:149] op_sel_hi:[1,0]
v_cvt_pk_bf16_f32 v80,v80,v81
v_cvt_pk_bf16_f32 v84,v84,v85
v_cvt_pk_bf16_f32 v81,v82,v83
v_cvt_pk_bf16_f32 v85,v86,v87
s_waitcnt lgkmcnt(4)
buffer_store_dwordx4 v[152:155],v10,s[16:19],s87 offen offset:256 nt
ds_write2st64_b64 v21,v[248:249],v[88:89] offset0:16 offset1:24
v_accvgpr_read_b32 v88,a28
v_accvgpr_read_b32 v89,a29
v_pk_mul_f32 v[88:89],v[88:89],v[148:149] op_sel_hi:[1,0]
buffer_store_dwordx4 v[156:159],v10,s[16:19],s87 offen offset:3328 nt
v_cvt_pk_bf16_f32 v88,v88,v89
v_cvt_pk_bf16_f32 v89,v90,v91
ds_write2st64_b64 v22,v[252:253],v[92:93] offset0:16 offset1:24
v_accvgpr_read_b32 v92,a44
v_accvgpr_read_b32 v93,a45
v_pk_mul_f32 v[92:93],v[92:93],v[148:149] op_sel_hi:[1,0]
ds_read_b128 v[152:155],v15 offset:8192
s_waitcnt lgkmcnt(3)
buffer_store_dwordx4 v[100:103],v10,s[16:19],s84 offen offset:256 nt
ds_read_b128 v[156:159],v15 offset:11264
v_cvt_pk_bf16_f32 v92,v92,v93
v_cvt_pk_bf16_f32 v93,v94,v95
ds_read_b128 v[100:103],v15 offset:12288
buffer_store_dwordx4 v[104:107],v10,s[16:19],s84 offen offset:3328 nt
s_waitcnt lgkmcnt(2)
buffer_store_dwordx4 v[152:155],v10,s[16:19],s85 offen offset:256 nt
ds_read_b128 v[104:107],v15 offset:15360
ds_write2st64_b64 v12,v[64:65],v[68:69] offset0:26 offset1:28
s_waitcnt lgkmcnt(2)
buffer_store_dwordx4 v[156:159],v10,s[16:19],s85 offen offset:3328 nt
ds_write2st64_b64 v20,v[72:73],v[76:77] offset0:26 offset1:28
buffer_store_dwordx4 v[100:103],v10,s[16:19],s86 offen offset:0 nt
ds_write2st64_b64 v21,v[80:81],v[84:85] offset0:26 offset1:28
s_waitcnt lgkmcnt(2)
buffer_store_dwordx4 v[104:107],v10,s[16:19],s86 offen offset:3072 nt
ds_write2st64_b64 v22,v[88:89],v[92:93] offset0:26 offset1:28
ds_read_b128 v[152:155],v15 offset:13312
ds_read_b128 v[156:159],v15 offset:16384
ds_read_b128 v[100:103],v15 offset:14336
ds_read_b128 v[104:107],v15 offset:17408
s_waitcnt lgkmcnt(3)
buffer_store_dwordx4 v[152:155],v10,s[16:19],s86 offen offset:128 nt
s_waitcnt lgkmcnt(2)
buffer_store_dwordx4 v[156:159],v10,s[16:19],s86 offen offset:3200 nt
s_waitcnt lgkmcnt(1)
buffer_store_dwordx4 v[100:103],v10,s[16:19],s86 offen offset:256 nt
s_waitcnt lgkmcnt(0)
buffer_store_dwordx4 v[104:107],v10,s[16:19],s86 offen offset:3328 nt
s_branch L_fin
L_end3:
s_waitcnt lgkmcnt(4)
v_mfma_f32_16x16x32_bf16 v[160:163],a[240:243],v[96:99],v[160:163]
v_fma_f32 v68,v68,s36,v16
v_fma_f32 v69,v69,s36,v16
v_mfma_f32_16x16x32_bf16 v[208:211],a[240:243],v[100:103],v[208:211]
v_fma_f32 v70,v70,s36,v16
v_fma_f32 v71,v71,s36,v16
v_mfma_f32_16x16x32_bf16 a[0:3],a[240:243],v[104:107],a[0:3]
ds_read_b64_tr_b16 a[240:241],v3 offset:24704
ds_read_b64_tr_b16 a[242:243],v3 offset:30848
v_mfma_f32_16x16x32_bf16 v[164:167],a[244:247],v[96:99],v[164:167]
v_fma_f32 v76,v76,s36,v17
v_fma_f32 v77,v77,s36,v17
v_mfma_f32_16x16x32_bf16 v[212:215],a[244:247],v[100:103],v[212:215]
v_fma_f32 v78,v78,s36,v17
v_fma_f32 v79,v79,s36,v17
v_mfma_f32_16x16x32_bf16 a[4:7],a[244:247],v[104:107],a[4:7]
s_waitcnt lgkmcnt(2)
ds_read_b64_tr_b16 a[244:245],v4 offset:24704
ds_read_b64_tr_b16 a[246:247],v4 offset:30848
v_mfma_f32_16x16x32_bf16 v[168:171],a[248:251],v[96:99],v[168:171]
v_fma_f32 v80,v80,s36,v18
v_fma_f32 v81,v81,s36,v18
v_mfma_f32_16x16x32_bf16 v[216:219],a[248:251],v[100:103],v[216:219]
v_fma_f32 v82,v82,s36,v18
v_fma_f32 v83,v83,s36,v18
v_mfma_f32_16x16x32_bf16 a[8:11],a[248:251],v[104:107],a[8:11]
ds_read_b64_tr_b16 a[248:249],v5 offset:24704
ds_read_b64_tr_b16 a[250:251],v5 offset:30848
v_mfma_f32_16x16x32_bf16 v[172:175],a[252:255],v[96:99],v[172:175]
v_fma_f32 v84,v84,s36,v18
v_fma_f32 v85,v85,s36,v18
v_mfma_f32_16x16x32_bf16 v[220:223],a[252:255],v[100:103],v[220:223]
v_fma_f32 v86,v86,s36,v18
v_fma_f32 v87,v87,s36,v18
v_mfma_f32_16x16x32_bf16 a[12:15],a[252:255],v[104:107],a[12:15]
s_waitcnt lgkmcnt(4)
ds_read_b64_tr_b16 a[252:253],v6 offset:24704
ds_read_b64_tr_b16 a[254:255],v6 offset:30848
v_mfma_f32_16x16x32_bf16 v[176:179],a[240:243],v[96:99],v[176:179]
v_exp_f32 v68,v68
v_mfma_f32_16x16x32_bf16 v[224:227],a[240:243],v[100:103],v[224:227]
v_exp_f32 v69,v69
v_mfma_f32_16x16x32_bf16 a[16:19],a[240:243],v[104:107],a[16:19]
s_waitcnt lgkmcnt(4)
ds_read_b64_tr_b16 a[240:241],v3 offset:24832
ds_read_b64_tr_b16 a[242:243],v3 offset:30976
v_mfma_f32_16x16x32_bf16 v[180:183],a[244:247],v[96:99],v[180:183]
v_exp_f32 v70,v70
v_mfma_f32_16x16x32_bf16 v[228:231],a[244:247],v[100:103],v[228:231]
v_exp_f32 v71,v71
v_mfma_f32_16x16x32_bf16 a[20:23],a[244:247],v[104:107],a[20:23]
s_waitcnt lgkmcnt(4)
ds_read_b64_tr_b16 a[244:245],v4 offset:24832
ds_read_b64_tr_b16 a[246:247],v4 offset:30976
v_mfma_f32_16x16x32_bf16 v[184:187],a[248:251],v[96:99],v[184:187]
v_exp_f32 v76,v76
v_mfma_f32_16x16x32_bf16 v[232:235],a[248:251],v[100:103],v[232:235]
v_exp_f32 v77,v77
v_mfma_f32_16x16x32_bf16 a[24:27],a[248:251],v[104:107],a[24:27]
s_waitcnt lgkmcnt(4)
ds_read_b64_tr_b16 a[248:249],v5 offset:24832
ds_read_b64_tr_b16 a[250:251],v5 offset:30976
v_mfma_f32_16x16x32_bf16 v[188:191],a[252:255],v[96:99],v[188:191]
v_exp_f32 v78,v78
v_mfma_f32_16x16x32_bf16 v[236:239],a[252:255],v[100:103],v[236:239]
v_exp_f32 v79,v79
v_mfma_f32_16x16x32_bf16 a[28:31],a[252:255],v[104:107],a[28:31]
s_waitcnt lgkmcnt(4)
ds_read_b64_tr_b16 a[252:253],v6 offset:24832
ds_read_b64_tr_b16 a[254:255],v6 offset:30976
v_mfma_f32_16x16x32_bf16 v[192:195],a[240:243],v[96:99],v[192:195]
v_exp_f32 v80,v80
v_mfma_f32_16x16x32_bf16 v[240:243],a[240:243],v[100:103],v[240:243]
v_exp_f32 v81,v81
v_mfma_f32_16x16x32_bf16 a[32:35],a[240:243],v[104:107],a[32:35]
s_waitcnt lgkmcnt(4)
v_exp_f32 v82,v82
v_mfma_f32_16x16x32_bf16 v[196:199],a[244:247],v[96:99],v[196:199]
v_exp_f32 v83,v83
v_mfma_f32_16x16x32_bf16 v[244:247],a[244:247],v[100:103],v[244:247]
v_exp_f32 v84,v84
v_mfma_f32_16x16x32_bf16 a[36:39],a[244:247],v[104:107],a[36:39]
s_waitcnt lgkmcnt(2)
v_exp_f32 v85,v85
v_mfma_f32_16x16x32_bf16 v[200:203],a[248:251],v[96:99],v[200:203]
v_exp_f32 v86,v86
v_mfma_f32_16x16x32_bf16 v[248:251],a[248:251],v[100:103],v[248:251]
v_exp_f32 v87,v87
v_mfma_f32_16x16x32_bf16 a[40:43],a[248:251],v[104:107],a[40:43]
s_waitcnt lgkmcnt(0)
v_cvt_pk_bf16_f32 v114,v68,v69
v_cvt_pk_bf16_f32 v115,v70,v71
v_mfma_f32_16x16x32_bf16 v[204:207],a[252:255],v[96:99],v[204:207]
v_cvt_pk_bf16_f32 v118,v76,v77
v_cvt_pk_bf16_f32 v119,v78,v79
v_mfma_f32_16x16x32_bf16 v[128:131],v[24:27],v[112:115],v[128:131]
v_cvt_pk_bf16_f32 v120,v80,v81
v_cvt_pk_bf16_f32 v121,v82,v83
v_mfma_f32_16x16x32_bf16 v[132:135],v[24:27],v[116:119],v[132:135]
v_cvt_pk_bf16_f32 v122,v84,v85
v_cvt_pk_bf16_f32 v123,v86,v87
s_waitcnt vmcnt(6)
s_barrier
v_mfma_f32_16x16x32_bf16 v[136:139],v[24:27],v[120:123],v[136:139]
v_mfma_f32_16x16x32_bf16 v[252:255],a[252:255],v[100:103],v[252:255]
v_mfma_f32_16x16x32_bf16 a[44:47],a[252:255],v[104:107],a[44:47]
ds_read_b64_tr_b16 a[240:241],v3 offset:0
ds_read_b64_tr_b16 a[242:243],v3 offset:6144
ds_read_b64_tr_b16 a[244:245],v4 offset:0
ds_read_b64_tr_b16 a[246:247],v4 offset:6144
ds_read_b64_tr_b16 a[248:249],v5 offset:0
ds_read_b64_tr_b16 a[250:251],v5 offset:6144
ds_read_b64_tr_b16 a[252:253],v6 offset:0
ds_read_b64_tr_b16 a[254:255],v6 offset:6144
s_waitcnt lgkmcnt(6)
v_mfma_f32_16x16x32_bf16 v[160:163],a[240:243],v[112:115],v[160:163]
s_waitcnt vmcnt(0)
v_rcp_f32 v144,v128
v_mfma_f32_16x16x32_bf16 v[208:211],a[240:243],v[116:119],v[208:211]
s_add_u32 s84,s42,0
v_rcp_f32 v146,v132
v_mfma_f32_16x16x32_bf16 a[0:3],a[240:243],v[120:123],a[0:3]
s_add_u32 s85,s42,6144
ds_read_b64_tr_b16 a[240:241],v3 offset:128
ds_read_b64_tr_b16 a[242:243],v3 offset:6272
s_waitcnt lgkmcnt(6)
v_mfma_f32_16x16x32_bf16 v[164:167],a[244:247],v[112:115],v[164:167]
s_add_u32 s86,s42,12288
v_rcp_f32 v148,v136
v_mfma_f32_16x16x32_bf16 v[212:215],a[244:247],v[116:119],v[212:215]
v_max3_f32 v30,v128,v132,v136
v_accvgpr_read_b32 v64,a0
v_mfma_f32_16x16x32_bf16 a[4:7],a[244:247],v[120:123],a[4:7]
s_waitcnt lgkmcnt(4)
ds_read_b64_tr_b16 a[244:245],v4 offset:128
ds_read_b64_tr_b16 a[246:247],v4 offset:6272
v_mfma_f32_16x16x32_bf16 v[168:171],a[248:251],v[112:115],v[168:171]
v_accvgpr_read_b32 v65,a1
v_accvgpr_read_b32 v66,a2
v_mfma_f32_16x16x32_bf16 v[216:219],a[248:251],v[116:119],v[216:219]
v_accvgpr_read_b32 v67,a3
v_cmp_ngt_f32 vcc,s37,v30
v_accvgpr_read_b32 v72,a4
v_accvgpr_read_b32 v73,a5
v_accvgpr_read_b32 v74,a6
v_pk_mul_f32 v[160:161],v[160:161],v[144:145] op_sel_hi:[1,0]
v_pk_mul_f32 v[162:163],v[162:163],v[144:145] op_sel_hi:[1,0]
v_pk_mul_f32 v[208:209],v[208:209],v[146:147] op_sel_hi:[1,0]
v_pk_mul_f32 v[210:211],v[210:211],v[146:147] op_sel_hi:[1,0]
v_cvt_pk_bf16_f32 v160,v160,v161
v_cvt_pk_bf16_f32 v208,v208,v209
v_mfma_f32_16x16x32_bf16 a[8:11],a[248:251],v[120:123],a[8:11]
s_cmp_lg_u64 vcc,0
ds_read_b64_tr_b16 a[248:249],v5 offset:128
ds_read_b64_tr_b16 a[250:251],v5 offset:6272
v_cvt_pk_bf16_f32 v161,v162,v163
v_cvt_pk_bf16_f32 v209,v210,v211
v_accvgpr_read_b32 v75,a7
v_pk_mul_f32 v[164:165],v[164:165],v[144:145] op_sel_hi:[1,0]
v_pk_mul_f32 v[166:167],v[166:167],v[144:145] op_sel_hi:[1,0]
v_pk_mul_f32 v[212:213],v[212:213],v[146:147] op_sel_hi:[1,0]
v_pk_mul_f32 v[214:215],v[214:215],v[146:147] op_sel_hi:[1,0]
v_cvt_pk_bf16_f32 v164,v164,v165
v_cvt_pk_bf16_f32 v212,v212,v213
s_waitcnt lgkmcnt(4)
v_mfma_f32_16x16x32_bf16 v[172:175],a[252:255],v[112:115],v[172:175]
s_cselect_b32 s62,s32,0
ds_write2st64_b64 v12,v[160:161],v[208:209] offset0:0 offset1:12
v_mfma_f32_16x16x32_bf16 v[220:223],a[252:255],v[116:119],v[220:223]
s_or_b32 s31,s31,s62
v_cvt_pk_bf16_f32 v165,v166,v167
v_cvt_pk_bf16_f32 v213,v214,v215
v_accvgpr_read_b32 v80,a8
v_accvgpr_read_b32 v81,a9
v_accvgpr_read_b32 v82,a10
v_pk_mul_f32 v[168:169],v[168:169],v[144:145] op_sel_hi:[1,0]
v_pk_mul_f32 v[170:171],v[170:171],v[144:145] op_sel_hi:[1,0]
v_pk_mul_f32 v[216:217],v[216:217],v[146:147] op_sel_hi:[1,0]
v_pk_mul_f32 v[218:219],v[218:219],v[146:147] op_sel_hi:[1,0]
v_cvt_pk_bf16_f32 v168,v168,v169
v_cvt_pk_bf16_f32 v216,v216,v217
v_mfma_f32_16x16x32_bf16 a[12:15],a[252:255],v[120:123],a[12:15]
s_lshl_b32 s32,s32,1
ds_read_b64_tr_b16 a[252:253],v6 offset:128
ds_read_b64_tr_b16 a[254:255],v6 offset:6272
v_mfma_f32_16x16x32_bf16 v[176:179],a[240:243],v[112:115],v[176:179]
ds_write2st64_b64 v20,v[164:165],v[212:213] offset0:0 offset1:12
v_mfma_f32_16x16x32_bf16 v[224:227],a[240:243],v[116:119],v[224:227]
v_cvt_pk_bf16_f32 v169,v170,v171
v_cvt_pk_bf16_f32 v217,v218,v219
v_accvgpr_read_b32 v83,a11
v_accvgpr_read_b32 v88,a12
v_accvgpr_read_b32 v89,a13
v_pk_mul_f32 v[172:173],v[172:173],v[144:145] op_sel_hi:[1,0]
v_pk_mul_f32 v[174:175],v[174:175],v[144:145] op_sel_hi:[1,0]
v_pk_mul_f32 v[220:221],v[220:221],v[146:147] op_sel_hi:[1,0]
v_pk_mul_f32 v[222:223],v[222:223],v[146:147] op_sel_hi:[1,0]
v_cvt_pk_bf16_f32 v172,v172,v173
v_cvt_pk_bf16_f32 v220,v220,v221
v_mfma_f32_16x16x32_bf16 a[16:19],a[240:243],v[120:123],a[16:19]
s_waitcnt lgkmcnt(3)
ds_read_b64_tr_b16 a[240:241],v3 offset:256
ds_read_b64_tr_b16 a[242:243],v3 offset:6400
v_mfma_f32_16x16x32_bf16 v[180:183],a[244:247],v[112:115],v[180:183]
ds_write2st64_b64 v21,v[168:169],v[216:217] offset0:0 offset1:12
v_mfma_f32_16x16x32_bf16 v[228:231],a[244:247],v[116:119],v[228:231]
v_cvt_pk_bf16_f32 v173,v174,v175
v_cvt_pk_bf16_f32 v221,v222,v223
v_accvgpr_read_b32 v90,a14
v_accvgpr_read_b32 v68,a16
v_accvgpr_read_b32 v69,a17
v_pk_mul_f32 v[176:177],v[176:177],v[144:145] op_sel_hi:[1,0]
v_pk_mul_f32 v[178:179],v[178:179],v[144:145] op_sel_hi:[1,0]
v_pk_mul_f32 v[224:225],v[224:225],v[146:147] op_sel_hi:[1,0]
v_pk_mul_f32 v[226:227],v[226:227],v[146:147] op_sel_hi:[1,0]
v_cvt_pk_bf16_f32 v176,v176,v177
v_cvt_pk_bf16_f32 v224,v224,v225
v_mfma_f32_16x16x32_bf16 a[20:23],a[244:247],v[120:123],a[20:23]
ds_read_b64_tr_b16 a[244:245],v4 offset:256
ds_read_b64_tr_b16 a[246:247],v4 offset:6400
v_mfma_f32_16x16x32_bf16 v[184:187],a[248:251],v[112:115],v[184:187]
ds_write2st64_b64 v22,v[172:173],v[220:221] offset0:0 offset1:12
v_mfma_f32_16x16x32_bf16 v[232:235],a[248:251],v[116:119],v[232:235]
v_cvt_pk_bf16_f32 v177,v178,v179
v_cvt_pk_bf16_f32 v225,v226,v227
v_accvgpr_read_b32 v70,a18
v_accvgpr_read_b32 v71,a19
v_accvgpr_read_b32 v76,a20
v_pk_mul_f32 v[180:181],v[180:181],v[144:145] op_sel_hi:[1,0]
v_pk_mul_f32 v[182:183],v[182:183],v[144:145] op_sel_hi:[1,0]
v_pk_mul_f32 v[228:229],v[228:229],v[146:147] op_sel_hi:[1,0]
v_pk_mul_f32 v[230:231],v[230:231],v[146:147] op_sel_hi:[1,0]
v_cvt_pk_bf16_f32 v180,v180,v181
v_cvt_pk_bf16_f32 v228,v228,v229
v_mfma_f32_16x16x32_bf16 a[24:27],a[248:251],v[120:123],a[24:27]
s_waitcnt lgkmcnt(3)
ds_read_b64_tr_b16 a[248:249],v5 offset:256
ds_read_b64_tr_b16 a[250:251],v5 offset:6400
v_mfma_f32_16x16x32_bf16 v[188:191],a[252:255],v[112:115],v[188:191]
ds_read_b128 v[152:155],v15 offset:0
v_cvt_pk_bf16_f32 v181,v182,v183
v_mfma_f32_16x16x32_bf16 v[236:239],a[252:255],v[116:119],v[236:239]
ds_read_b128 v[156:159],v15 offset:3072
v_cvt_pk_bf16_f32 v229,v230,v231
v_accvgpr_read_b32 v77,a21
v_accvgpr_read_b32 v78,a22
v_accvgpr_read_b32 v79,a23
v_pk_mul_f32 v[184:185],v[184:185],v[144:145] op_sel_hi:[1,0]
v_pk_mul_f32 v[186:187],v[186:187],v[144:145] op_sel_hi:[1,0]
v_pk_mul_f32 v[232:233],v[232:233],v[146:147] op_sel_hi:[1,0]
v_pk_mul_f32 v[234:235],v[234:235],v[146:147] op_sel_hi:[1,0]
v_cvt_pk_bf16_f32 v184,v184,v185
v_cvt_pk_bf16_f32 v232,v232,v233
v_mfma_f32_16x16x32_bf16 a[28:31],a[252:255],v[120:123],a[28:31]
ds_read_b64_tr_b16 a[252:253],v6 offset:256
ds_read_b64_tr_b16 a[254:255],v6 offset:6400
v_mfma_f32_16x16x32_bf16 v[192:195],a[240:243],v[112:115],v[192:195]
ds_read_b128 v[100:103],v15 offset:6144
v_cvt_pk_bf16_f32 v185,v186,v187
v_mfma_f32_16x16x32_bf16 v[240:243],a[240:243],v[116:119],v[240:243]
ds_read_b128 v[104:107],v15 offset:9216
v_cvt_pk_bf16_f32 v233,v234,v235
v_accvgpr_read_b32 v84,a24
v_accvgpr_read_b32 v85,a25
v_accvgpr_read_b32 v86,a26
v_pk_mul_f32 v[188:189],v[188:189],v[144:145] op_sel_hi:[1,0]
v_pk_mul_f32 v[190:191],v[190:191],v[144:145] op_sel_hi:[1,0]
v_pk_mul_f32 v[236:237],v[236:237],v[146:147] op_sel_hi:[1,0]
v_pk_mul_f32 v[238:239],v[238:239],v[146:147] op_sel_hi:[1,0]
v_cvt_pk_bf16_f32 v188,v188,v189
v_cvt_pk_bf16_f32 v236,v236,v237
v_mfma_f32_16x16x32_bf16 a[32:35],a[240:243],v[120:123],a[32:35]
s_waitcnt lgkmcnt(4)
ds_write2st64_b64 v12,v[176:177],v[224:225] offset0:2 offset1:14
v_mfma_f32_16x16x32_bf16 v[196:199],a[244:247],v[112:115],v[196:199]
v_cvt_pk_bf16_f32 v189,v190,v191
v_cvt_pk_bf16_f32 v237,v238,v239
v_mfma_f32_16x16x32_bf16 v[244:247],a[244:247],v[116:119],v[244:247]
buffer_store_dwordx4 v[152:155],v10,s[16:19],s84 offen offset:0 nt
v_accvgpr_read_b32 v87,a27
v_accvgpr_read_b32 v92,a28
v_accvgpr_read_b32 v93,a29
v_pk_mul_f32 v[192:193],v[192:193],v[144:145] op_sel_hi:[1,0]
v_pk_mul_f32 v[194:195],v[194:195],v[144:145] op_sel_hi:[1,0]
v_pk_mul_f32 v[240:241],v[240:241],v[146:147] op_sel_hi:[1,0]
v_pk_mul_f32 v[242:243],v[242:243],v[146:147] op_sel_hi:[1,0]
v_cvt_pk_bf16_f32 v192,v192,v193
v_cvt_pk_bf16_f32 v240,v240,v241
v_mfma_f32_16x16x32_bf16 a[36:39],a[244:247],v[120:123],a[36:39]
ds_write2st64_b64 v20,v[180:181],v[228:229] offset0:2 offset1:14
v_mfma_f32_16x16x32_bf16 v[200:203],a[248:251],v[112:115],v[200:203]
v_cvt_pk_bf16_f32 v193,v194,v195
v_cvt_pk_bf16_f32 v241,v242,v243
v_mfma_f32_16x16x32_bf16 v[248:251],a[248:251],v[116:119],v[248:251]
buffer_store_dwordx4 v[156:159],v10,s[16:19],s84 offen offset:3072 nt
v_accvgpr_read_b32 v91,a15
v_accvgpr_read_b32 v94,a30
v_accvgpr_read_b32 v95,a31
v_pk_mul_f32 v[196:197],v[196:197],v[144:145] op_sel_hi:[1,0]
v_pk_mul_f32 v[198:199],v[198:199],v[144:145] op_sel_hi:[1,0]
v_pk_mul_f32 v[244:245],v[244:245],v[146:147] op_sel_hi:[1,0]
v_pk_mul_f32 v[246:247],v[246:247],v[146:147] op_sel_hi:[1,0]
v_cvt_pk_bf16_f32 v196,v196,v197
v_cvt_pk_bf16_f32 v244,v244,v245
v_mfma_f32_16x16x32_bf16 a[40:43],a[248:251],v[120:123],a[40:43]
s_waitcnt lgkmcnt(1)
ds_write2st64_b64 v21,v[184:185],v[232:233] offset0:2 offset1:14
v_mfma_f32_16x16x32_bf16 v[204:207],a[252:255],v[112:115],v[204:207]
v_cvt_pk_bf16_f32 v197,v198,v199
v_cvt_pk_bf16_f32 v245,v246,v247
v_mfma_f32_16x16x32_bf16 v[252:255],a[252:255],v[116:119],v[252:255]
buffer_store_dwordx4 v[100:103],v10,s[16:19],s85 offen offset:0 nt
v_pk_mul_f32 v[200:201],v[200:201],v[144:145] op_sel_hi:[1,0]
v_pk_mul_f32 v[202:203],v[202:203],v[144:145] op_sel_hi:[1,0]
v_pk_mul_f32 v[248:249],v[248:249],v[146:147] op_sel_hi:[1,0]
v_pk_mul_f32 v[250:251],v[250:251],v[146:147] op_sel_hi:[1,0]
v_cvt_pk_bf16_f32 v200,v200,v201
v_cvt_pk_bf16_f32 v248,v248,v249
v_mfma_f32_16x16x32_bf16 a[44:47],a[252:255],v[120:123],a[44:47]
ds_write2st64_b64 v22,v[188:189],v[236:237] offset0:2 offset1:14
v_pk_mul_f32 v[204:205],v[204:205],v[144:145] op_sel_hi:[1,0]
v_pk_mul_f32 v[252:253],v[252:253],v[146:147] op_sel_hi:[1,0]
v_pk_mul_f32 v[206:207],v[206:207],v[144:145] op_sel_hi:[1,0]
v_pk_mul_f32 v[254:255],v[254:255],v[146:147] op_sel_hi:[1,0]
v_pk_mul_f32 v[64:65],v[64:65],v[148:149] op_sel_hi:[1,0]
v_pk_mul_f32 v[68:69],v[68:69],v[148:149] op_sel_hi:[1,0]
v_pk_mul_f32 v[66:67],v[66:67],v[148:149] op_sel_hi:[1,0]
v_pk_mul_f32 v[70:71],v[70:71],v[148:149] op_sel_hi:[1,0]
v_pk_mul_f32 v[72:73],v[72:73],v[148:149] op_sel_hi:[1,0]
v_pk_mul_f32 v[76:77],v[76:77],v[148:149] op_sel_hi:[1,0]
v_pk_mul_f32 v[74:75],v[74:75],v[148:149] op_sel_hi:[1,0]
v_pk_mul_f32 v[78:79],v[78:79],v[148:149] op_sel_hi:[1,0]
v_pk_mul_f32 v[80:81],v[80:81],v[148:149] op_sel_hi:[1,0]
v_pk_mul_f32 v[84:85],v[84:85],v[148:149] op_sel_hi:[1,0]
v_pk_mul_f32 v[82:83],v[82:83],v[148:149] op_sel_hi:[1,0]
v_pk_mul_f32 v[86:87],v[86:87],v[148:149] op_sel_hi:[1,0]
v_pk_mul_f32 v[88:89],v[88:89],v[148:149] op_sel_hi:[1,0]
v_pk_mul_f32 v[92:93],v[92:93],v[148:149] op_sel_hi:[1,0]
v_pk_mul_f32 v[90:91],v[90:91],v[148:149] op_sel_hi:[1,0]
v_pk_mul_f32 v[94:95],v[94:95],v[148:149] op_sel_hi:[1,0]
v_cvt_pk_bf16_f32 v201,v202,v203
v_cvt_pk_bf16_f32 v249,v250,v251
v_cvt_pk_bf16_f32 v204,v204,v205
v_cvt_pk_bf16_f32 v252,v252,v253
v_cvt_pk_bf16_f32 v205,v206,v207
v_cvt_pk_bf16_f32 v253,v254,v255
v_cvt_pk_bf16_f32 v64,v64,v65
v_cvt_pk_bf16_f32 v68,v68,v69
v_cvt_pk_bf16_f32 v72,v72,v73
v_cvt_pk_bf16_f32 v76,v76,v77
v_cvt_pk_bf16_f32 v65,v66,v67
v_cvt_pk_bf16_f32 v69,v70,v71
v_cvt_pk_bf16_f32 v80,v80,v81
v_cvt_pk_bf16_f32 v84,v84,v85
v_cvt_pk_bf16_f32 v73,v74,v75
v_cvt_pk_bf16_f32 v77,v78,v79
v_cvt_pk_bf16_f32 v88,v88,v89
v_cvt_pk_bf16_f32 v92,v92,v93
v_cvt_pk_bf16_f32 v81,v82,v83
v_cvt_pk_bf16_f32 v85,v86,v87
v_cvt_pk_bf16_f32 v89,v90,v91
v_cvt_pk_bf16_f32 v93,v94,v95
v_accvgpr_read_b32 v66,a34
v_accvgpr_read_b32 v67,a35
v_pk_mul_f32 v[66:67],v[66:67],v[148:149] op_sel_hi:[1,0]
v_accvgpr_read_b32 v70,a38
v_accvgpr_read_b32 v71,a39
v_pk_mul_f32 v[70:71],v[70:71],v[148:149] op_sel_hi:[1,0]
v_accvgpr_read_b32 v74,a42
v_accvgpr_read_b32 v75,a43
v_pk_mul_f32 v[74:75],v[74:75],v[148:149] op_sel_hi:[1,0]
v_accvgpr_read_b32 v78,a46
v_accvgpr_read_b32 v79,a47
v_pk_mul_f32 v[78:79],v[78:79],v[148:149] op_sel_hi:[1,0]
ds_read_b128 v[152:155],v15 offset:1024
buffer_store_dwordx4 v[104:107],v10,s[16:19],s85 offen offset:3072 nt
ds_read_b128 v[156:159],v15 offset:4096
ds_read_b128 v[100:103],v15 offset:7168
ds_read_b128 v[104:107],v15 offset:10240
ds_write2st64_b64 v12,v[192:193],v[240:241] offset0:4 offset1:16
ds_write2st64_b64 v20,v[196:197],v[244:245] offset0:4 offset1:16
s_waitcnt lgkmcnt(2)
buffer_store_dwordx4 v[152:155],v10,s[16:19],s84 offen offset:128 nt
ds_write2st64_b64 v21,v[200:201],v[248:249] offset0:4 offset1:16
buffer_store_dwordx4 v[156:159],v10,s[16:19],s84 offen offset:3200 nt
ds_write2st64_b64 v22,v[204:205],v[252:253] offset0:4 offset1:16
ds_read_b128 v[152:155],v15 offset:2048
buffer_store_dwordx4 v[100:103],v10,s[16:19],s85 offen offset:128 nt
ds_read_b128 v[156:159],v15 offset:5120
ds_read_b128 v[100:103],v15 offset:8192
buffer_store_dwordx4 v[104:107],v10,s[16:19],s85 offen offset:3200 nt
s_waitcnt lgkmcnt(2)
buffer_store_dwordx4 v[152:155],v10,s[16:19],s84 offen offset:256 nt
ds_read_b128 v[104:107],v15 offset:11264
ds_write2st64_b64 v12,v[64:65],v[68:69] offset0:24 offset1:26
v_accvgpr_read_b32 v64,a32
v_accvgpr_read_b32 v65,a33
v_pk_mul_f32 v[64:65],v[64:65],v[148:149] op_sel_hi:[1,0]
v_accvgpr_read_b32 v68,a36
v_accvgpr_read_b32 v69,a37
v_pk_mul_f32 v[68:69],v[68:69],v[148:149] op_sel_hi:[1,0]
v_cvt_pk_bf16_f32 v64,v64,v65
v_cvt_pk_bf16_f32 v68,v68,v69
v_cvt_pk_bf16_f32 v65,v66,v67
v_cvt_pk_bf16_f32 v69,v70,v71
s_waitcnt lgkmcnt(2)
buffer_store_dwordx4 v[156:159],v10,s[16:19],s84 offen offset:3328 nt
ds_write2st64_b64 v20,v[72:73],v[76:77] offset0:24 offset1:26
v_accvgpr_read_b32 v72,a40
v_accvgpr_read_b32 v73,a41
v_pk_mul_f32 v[72:73],v[72:73],v[148:149] op_sel_hi:[1,0]
v_accvgpr_read_b32 v76,a44
v_accvgpr_read_b32 v77,a45
v_pk_mul_f32 v[76:77],v[76:77],v[148:149] op_sel_hi:[1,0]
v_cvt_pk_bf16_f32 v72,v72,v73
v_cvt_pk_bf16_f32 v76,v76,v77
v_cvt_pk_bf16_f32 v73,v74,v75
v_cvt_pk_bf16_f32 v77,v78,v79
buffer_store_dwordx4 v[100:103],v10,s[16:19],s85 offen offset:256 nt
ds_write2st64_b64 v21,v[80:81],v[84:85] offset0:24 offset1:26
s_waitcnt lgkmcnt(1)
buffer_store_dwordx4 v[104:107],v10,s[16:19],s85 offen offset:3328 nt
ds_write2st64_b64 v22,v[88:89],v[92:93] offset0:24 offset1:26
ds_read_b128 v[152:155],v15 offset:12288
ds_read_b128 v[156:159],v15 offset:15360
ds_read_b128 v[100:103],v15 offset:13312
ds_read_b128 v[104:107],v15 offset:16384
ds_write_b64 v12,v[64:65] offset:14336
ds_write_b64 v20,v[68:69] offset:14336
ds_write_b64 v21,v[72:73] offset:14336
s_waitcnt lgkmcnt(6)
buffer_store_dwordx4 v[152:155],v10,s[16:19],s86 offen offset:0 nt
ds_write_b64 v22,v[76:77] offset:14336
ds_read_b128 v[152:155],v15 offset:14336
s_waitcnt lgkmcnt(4)
buffer_store_dwordx4 v[156:159],v10,s[16:19],s86 offen offset:3072 nt
buffer_store_dwordx4 v[100:103],v10,s[16:19],s86 offen offset:128 nt
ds_read_b128 v[156:159],v15 offset:17408
buffer_store_dwordx4 v[104:107],v10,s[16:19],s86 offen offset:3200 nt
s_waitcnt lgkmcnt(1)
buffer_store_dwordx4 v[152:155],v10,s[16:19],s86 offen offset:256 nt
s_waitcnt lgkmcnt(0)
buffer_store_dwordx4 v[156:159],v10,s[16:19],s86 offen offset:3328 nt
s_branch L_fin
L_fin:
s_waitcnt vmcnt(0)
L_stamped:
s_cmp_lg_u32 s31,0
s_cbranch_scc1 L_fix
L_done:
L_end:
s_endpgm
L_fix:
v_mov_b32 v144,v28
v_mov_b32 v145,v29
s_sub_u32 s62,s24,36864
v_add_u32 v146,s62,v3
v_add_u32 v147,s62,v4
v_add_u32 v148,s62,v5
v_add_u32 v149,s62,v6
v_bfe_u32 v21,v0,4,4
v_mul_u32_u24 v21,384,v21
v_lshrrev_b32 v22,8,v0
v_lshl_add_u32 v23,v22,3,v21
v_lshl_add_u32 v21,v22,4,v21
s_mov_b32 s6,100663296
s_mov_b32 s10,100663296
L_fix_pass:
s_ff1_i32_b32 s50,s31
s_bitset0_b32 s31,s50
s_mul_i32 s56,s50,325632
s_add_u32 s56,s56,s33
s_lshr_b32 s62,s39,s50
s_and_b32 s62,s62,1
s_lshl_b32 s62,s62,1
s_add_u32 s62,s62,s49
s_and_b32 s62,s62,3
s_add_u32 s63,s50,8
s_lshr_b32 s63,s39,s63
s_and_b32 s63,s63,1
s_xor_b32 s62,s62,s63
s_mul_i32 s63,s3,3
s_lshl_b32 s64,s3,2
s_mov_b32 s40,1
s_add_u32 s65,s63,17
s_cmp_eq_u32 s3,0
s_cselect_b32 s65,16,s65
s_cselect_b32 s54,1,0
s_cmp_eq_u32 s62,1
s_cselect_b32 s64,s65,s64
s_cselect_b32 s40,s54,s40
s_add_u32 s65,s63,29
s_cmp_eq_u32 s62,2
s_cselect_b32 s64,s65,s64
s_cselect_b32 s40,0,s40
s_add_u32 s65,s63,41
s_cmp_eq_u32 s62,3
s_cselect_b32 s64,s65,s64
s_cselect_b32 s40,0,s40
s_mul_i32 s64,s64,6144
s_add_u32 s54,s56,s64
s_add_u32 s55,s40,3
s_mov_b32 s51,0
L_fix_tile:
buffer_load_dwordx4 a[96:99],v21,s[12:15],s54 offen offset:0
buffer_load_dwordx4 a[100:103],v21,s[12:15],s54 offen offset:64
buffer_load_dwordx4 a[104:107],v21,s[12:15],s54 offen offset:128
buffer_load_dwordx4 a[108:111],v21,s[12:15],s54 offen offset:192
buffer_load_dwordx4 a[112:115],v21,s[12:15],s54 offen offset:256
buffer_load_dwordx4 a[116:119],v21,s[12:15],s54 offen offset:320
v_mov_b32 v20,0xff800000
s_mul_i32 s53,s50,196608
s_add_u32 s53,s53,s34
s_mov_b32 s52,0
L_fix_max:
s_mov_b32 s63,s53
s_add_u32 m0,s24,0
s_nop 0
buffer_load_dwordx4 v7,s[4:7],s63 offen offset:0 lds
buffer_load_dwordx4 v8,s[4:7],s63 offen offset:1024 lds
buffer_load_dwordx4 v9,s[4:7],s63 offen offset:2048 lds
s_add_u32 s63,s63,3072
s_add_u32 m0,s24,3072
s_nop 0
buffer_load_dwordx4 v7,s[4:7],s63 offen offset:0 lds
buffer_load_dwordx4 v8,s[4:7],s63 offen offset:1024 lds
buffer_load_dwordx4 v9,s[4:7],s63 offen offset:2048 lds
s_add_u32 s63,s63,3072
s_add_u32 m0,s24,6144
s_nop 0
buffer_load_dwordx4 v7,s[4:7],s63 offen offset:0 lds
buffer_load_dwordx4 v8,s[4:7],s63 offen offset:1024 lds
buffer_load_dwordx4 v9,s[4:7],s63 offen offset:2048 lds
s_add_u32 s63,s63,3072
s_add_u32 m0,s24,9216
s_nop 0
buffer_load_dwordx4 v7,s[4:7],s63 offen offset:0 lds
buffer_load_dwordx4 v8,s[4:7],s63 offen offset:1024 lds
buffer_load_dwordx4 v9,s[4:7],s63 offen offset:2048 lds
s_add_u32 s63,s63,3072
s_waitcnt vmcnt(0)
ds_read_b128 a[192:195],v144 offset:0
ds_read_b128 a[196:199],v145 offset:0
ds_read_b128 a[200:203],v144 offset:128
ds_read_b128 a[204:207],v145 offset:128
ds_read_b128 a[208:211],v144 offset:256
ds_read_b128 a[212:215],v145 offset:256
ds_read_b128 a[216:219],v144 offset:6144
ds_read_b128 a[220:223],v145 offset:6144
ds_read_b128 a[224:227],v144 offset:6272
ds_read_b128 a[228:231],v145 offset:6272
ds_read_b128 a[232:235],v144 offset:6400
ds_read_b128 a[236:239],v145 offset:6400
s_waitcnt lgkmcnt(0)
v_mfma_f32_16x16x32_bf16 v[32:35],a[192:195],a[96:99],0
v_mfma_f32_16x16x32_bf16 v[32:35],a[196:199],a[100:103],v[32:35]
v_mfma_f32_16x16x32_bf16 v[32:35],a[200:203],a[104:107],v[32:35]
v_mfma_f32_16x16x32_bf16 v[32:35],a[204:207],a[108:111],v[32:35]
v_mfma_f32_16x16x32_bf16 v[32:35],a[208:211],a[112:115],v[32:35]
v_mfma_f32_16x16x32_bf16 v[32:35],a[212:215],a[116:119],v[32:35]
v_mfma_f32_16x16x32_bf16 v[36:39],a[216:219],a[96:99],0
v_mfma_f32_16x16x32_bf16 v[36:39],a[220:223],a[100:103],v[36:39]
v_mfma_f32_16x16x32_bf16 v[36:39],a[224:227],a[104:107],v[36:39]
v_mfma_f32_16x16x32_bf16 v[36:39],a[228:231],a[108:111],v[36:39]
v_mfma_f32_16x16x32_bf16 v[36:39],a[232:235],a[112:115],v[36:39]
v_mfma_f32_16x16x32_bf16 v[36:39],a[236:239],a[116:119],v[36:39]
s_nop 7
v_max3_f32 v20,v20,v32,v33
v_max3_f32 v20,v20,v34,v35
v_max3_f32 v20,v20,v36,v37
v_max3_f32 v20,v20,v38,v39
s_add_u32 s53,s53,12288
s_add_u32 s52,s52,1
s_cmp_lt_u32 s52,16
s_cbranch_scc1 L_fix_max
v_mov_b32 v30,v20
s_nop 1
v_permlane32_swap_b32 v30,v20
v_max_f32 v20,v20,v30
v_mov_b32 v30,v20
s_nop 1
v_permlane16_swap_b32 v30,v20
v_max_f32 v20,v20,v30
v_mul_f32_e64 v16,-s36,v20
v_mov_b32 v160,0
v_mov_b32 v161,0
v_mov_b32 v162,0
v_mov_b32 v163,0
v_mov_b32 v164,0
v_mov_b32 v165,0
v_mov_b32 v166,0
v_mov_b32 v167,0
v_mov_b32 v168,0
v_mov_b32 v169,0
v_mov_b32 v170,0
v_mov_b32 v171,0
v_mov_b32 v172,0
v_mov_b32 v173,0
v_mov_b32 v174,0
v_mov_b32 v175,0
v_mov_b32 v176,0
v_mov_b32 v177,0
v_mov_b32 v178,0
v_mov_b32 v179,0
v_mov_b32 v180,0
v_mov_b32 v181,0
v_mov_b32 v182,0
v_mov_b32 v183,0
v_mov_b32 v184,0
v_mov_b32 v185,0
v_mov_b32 v186,0
v_mov_b32 v187,0
v_mov_b32 v188,0
v_mov_b32 v189,0
v_mov_b32 v190,0
v_mov_b32 v191,0
v_mov_b32 v192,0
v_mov_b32 v193,0
v_mov_b32 v194,0
v_mov_b32 v195,0
v_mov_b32 v196,0
v_mov_b32 v197,0
v_mov_b32 v198,0
v_mov_b32 v199,0
v_mov_b32 v200,0
v_mov_b32 v201,0
v_mov_b32 v202,0
v_mov_b32 v203,0
v_mov_b32 v204,0
v_mov_b32 v205,0
v_mov_b32 v206,0
v_mov_b32 v207,0
v_mov_b32 v128,0
v_mov_b32 v129,0
v_mov_b32 v130,0
v_mov_b32 v131,0
s_mul_i32 s53,s50,196608
s_add_u32 s53,s53,s34
s_mov_b32 s52,0
L_fix_acc:
s_mov_b32 s63,s53
s_add_u32 m0,s24,0
s_nop 0
buffer_load_dwordx4 v7,s[4:7],s63 offen offset:0 lds
buffer_load_dwordx4 v8,s[4:7],s63 offen offset:1024 lds
buffer_load_dwordx4 v9,s[4:7],s63 offen offset:2048 lds
s_add_u32 s63,s63,3072
s_add_u32 m0,s24,3072
s_nop 0
buffer_load_dwordx4 v7,s[4:7],s63 offen offset:0 lds
buffer_load_dwordx4 v8,s[4:7],s63 offen offset:1024 lds
buffer_load_dwordx4 v9,s[4:7],s63 offen offset:2048 lds
s_add_u32 s63,s63,3072
s_add_u32 m0,s24,6144
s_nop 0
buffer_load_dwordx4 v7,s[4:7],s63 offen offset:0 lds
buffer_load_dwordx4 v8,s[4:7],s63 offen offset:1024 lds
buffer_load_dwordx4 v9,s[4:7],s63 offen offset:2048 lds
s_add_u32 s63,s63,3072
s_add_u32 m0,s24,9216
s_nop 0
buffer_load_dwordx4 v7,s[4:7],s63 offen offset:0 lds
buffer_load_dwordx4 v8,s[4:7],s63 offen offset:1024 lds
buffer_load_dwordx4 v9,s[4:7],s63 offen offset:2048 lds
s_add_u32 s63,s63,3072
s_waitcnt vmcnt(0)
ds_read_b128 a[192:195],v144 offset:0
ds_read_b128 a[196:199],v145 offset:0
ds_read_b128 a[200:203],v144 offset:128
ds_read_b128 a[204:207],v145 offset:128
ds_read_b128 a[208:211],v144 offset:256
ds_read_b128 a[212:215],v145 offset:256
ds_read_b128 a[216:219],v144 offset:6144
ds_read_b128 a[220:223],v145 offset:6144
ds_read_b128 a[224:227],v144 offset:6272
ds_read_b128 a[228:231],v145 offset:6272
ds_read_b128 a[232:235],v144 offset:6400
ds_read_b128 a[236:239],v145 offset:6400
s_waitcnt lgkmcnt(0)
v_mfma_f32_16x16x32_bf16 v[32:35],a[192:195],a[96:99],0
v_mfma_f32_16x16x32_bf16 v[32:35],a[196:199],a[100:103],v[32:35]
v_mfma_f32_16x16x32_bf16 v[32:35],a[200:203],a[104:107],v[32:35]
v_mfma_f32_16x16x32_bf16 v[32:35],a[204:207],a[108:111],v[32:35]
v_mfma_f32_16x16x32_bf16 v[32:35],a[208:211],a[112:115],v[32:35]
v_mfma_f32_16x16x32_bf16 v[32:35],a[212:215],a[116:119],v[32:35]
v_mfma_f32_16x16x32_bf16 v[36:39],a[216:219],a[96:99],0
v_mfma_f32_16x16x32_bf16 v[36:39],a[220:223],a[100:103],v[36:39]
v_mfma_f32_16x16x32_bf16 v[36:39],a[224:227],a[104:107],v[36:39]
v_mfma_f32_16x16x32_bf16 v[36:39],a[228:231],a[108:111],v[36:39]
v_mfma_f32_16x16x32_bf16 v[36:39],a[232:235],a[112:115],v[36:39]
v_mfma_f32_16x16x32_bf16 v[36:39],a[236:239],a[116:119],v[36:39]
s_nop 7
v_fma_f32 v32,v32,s36,v16
v_exp_f32 v32,v32
v_fma_f32 v33,v33,s36,v16
v_exp_f32 v33,v33
s_nop 0
v_cvt_pk_bf16_f32 v96,v32,v33
v_fma_f32 v34,v34,s36,v16
v_exp_f32 v34,v34
v_fma_f32 v35,v35,s36,v16
v_exp_f32 v35,v35
s_nop 0
v_cvt_pk_bf16_f32 v97,v34,v35
v_fma_f32 v36,v36,s36,v16
v_exp_f32 v36,v36
v_fma_f32 v37,v37,s36,v16
v_exp_f32 v37,v37
s_nop 0
v_cvt_pk_bf16_f32 v98,v36,v37
v_fma_f32 v38,v38,s36,v16
v_exp_f32 v38,v38
v_fma_f32 v39,v39,s36,v16
v_exp_f32 v39,v39
s_nop 0
v_cvt_pk_bf16_f32 v99,v38,v39
s_nop 1
v_mfma_f32_16x16x32_bf16 v[128:131],v[24:27],v[96:99],v[128:131]
s_mov_b32 s63,s53
s_add_u32 m0,s24,0
s_nop 0
buffer_load_dwordx4 v7,s[8:11],s63 offen offset:0 lds
buffer_load_dwordx4 v8,s[8:11],s63 offen offset:1024 lds
buffer_load_dwordx4 v9,s[8:11],s63 offen offset:2048 lds
s_add_u32 s63,s63,3072
s_add_u32 m0,s24,3072
s_nop 0
buffer_load_dwordx4 v7,s[8:11],s63 offen offset:0 lds
buffer_load_dwordx4 v8,s[8:11],s63 offen offset:1024 lds
buffer_load_dwordx4 v9,s[8:11],s63 offen offset:2048 lds
s_add_u32 s63,s63,3072
s_add_u32 m0,s24,6144
s_nop 0
buffer_load_dwordx4 v7,s[8:11],s63 offen offset:0 lds
buffer_load_dwordx4 v8,s[8:11],s63 offen offset:1024 lds
buffer_load_dwordx4 v9,s[8:11],s63 offen offset:2048 lds
s_add_u32 s63,s63,3072
s_add_u32 m0,s24,9216
s_nop 0
buffer_load_dwordx4 v7,s[8:11],s63 offen offset:0 lds
buffer_load_dwordx4 v8,s[8:11],s63 offen offset:1024 lds
buffer_load_dwordx4 v9,s[8:11],s63 offen offset:2048 lds
s_add_u32 s63,s63,3072
s_waitcnt vmcnt(0)
ds_read_b64_tr_b16 a[192:193],v146 offset:0
ds_read_b64_tr_b16 a[194:195],v146 offset:6144
ds_read_b64_tr_b16 a[196:197],v147 offset:0
ds_read_b64_tr_b16 a[198:199],v147 offset:6144
ds_read_b64_tr_b16 a[200:201],v148 offset:0
ds_read_b64_tr_b16 a[202:203],v148 offset:6144
ds_read_b64_tr_b16 a[204:205],v149 offset:0
ds_read_b64_tr_b16 a[206:207],v149 offset:6144
ds_read_b64_tr_b16 a[208:209],v146 offset:128
ds_read_b64_tr_b16 a[210:211],v146 offset:6272
ds_read_b64_tr_b16 a[212:213],v147 offset:128
ds_read_b64_tr_b16 a[214:215],v147 offset:6272
ds_read_b64_tr_b16 a[216:217],v148 offset:128
ds_read_b64_tr_b16 a[218:219],v148 offset:6272
ds_read_b64_tr_b16 a[220:221],v149 offset:128
ds_read_b64_tr_b16 a[222:223],v149 offset:6272
ds_read_b64_tr_b16 a[224:225],v146 offset:256
ds_read_b64_tr_b16 a[226:227],v146 offset:6400
ds_read_b64_tr_b16 a[228:229],v147 offset:256
ds_read_b64_tr_b16 a[230:231],v147 offset:6400
ds_read_b64_tr_b16 a[232:233],v148 offset:256
ds_read_b64_tr_b16 a[234:235],v148 offset:6400
ds_read_b64_tr_b16 a[236:237],v149 offset:256
ds_read_b64_tr_b16 a[238:239],v149 offset:6400
s_waitcnt lgkmcnt(0)
v_mfma_f32_16x16x32_bf16 v[160:163],a[192:195],v[96:99],v[160:163]
v_mfma_f32_16x16x32_bf16 v[164:167],a[196:199],v[96:99],v[164:167]
v_mfma_f32_16x16x32_bf16 v[168:171],a[200:203],v[96:99],v[168:171]
v_mfma_f32_16x16x32_bf16 v[172:175],a[204:207],v[96:99],v[172:175]
v_mfma_f32_16x16x32_bf16 v[176:179],a[208:211],v[96:99],v[176:179]
v_mfma_f32_16x16x32_bf16 v[180:183],a[212:215],v[96:99],v[180:183]
v_mfma_f32_16x16x32_bf16 v[184:187],a[216:219],v[96:99],v[184:187]
v_mfma_f32_16x16x32_bf16 v[188:191],a[220:223],v[96:99],v[188:191]
v_mfma_f32_16x16x32_bf16 v[192:195],a[224:227],v[96:99],v[192:195]
v_mfma_f32_16x16x32_bf16 v[196:199],a[228:231],v[96:99],v[196:199]
v_mfma_f32_16x16x32_bf16 v[200:203],a[232:235],v[96:99],v[200:203]
v_mfma_f32_16x16x32_bf16 v[204:207],a[236:239],v[96:99],v[204:207]
s_add_u32 s53,s53,12288
s_add_u32 s52,s52,1
s_cmp_lt_u32 s52,16
s_cbranch_scc1 L_fix_acc
s_nop 7
v_rcp_f32 v30,v128
s_nop 0
v_mul_f32 v160,v160,v30
v_mul_f32 v161,v161,v30
v_mul_f32 v162,v162,v30
v_mul_f32 v163,v163,v30
v_cvt_pk_bf16_f32 v160,v160,v161
v_cvt_pk_bf16_f32 v161,v162,v163
buffer_store_dwordx2 v[160:161],v23,s[16:19],s54 offen offset:0
v_mul_f32 v164,v164,v30
v_mul_f32 v165,v165,v30
v_mul_f32 v166,v166,v30
v_mul_f32 v167,v167,v30
v_cvt_pk_bf16_f32 v164,v164,v165
v_cvt_pk_bf16_f32 v165,v166,v167
buffer_store_dwordx2 v[164:165],v23,s[16:19],s54 offen offset:32
v_mul_f32 v168,v168,v30
v_mul_f32 v169,v169,v30
v_mul_f32 v170,v170,v30
v_mul_f32 v171,v171,v30
v_cvt_pk_bf16_f32 v168,v168,v169
v_cvt_pk_bf16_f32 v169,v170,v171
buffer_store_dwordx2 v[168:169],v23,s[16:19],s54 offen offset:64
v_mul_f32 v172,v172,v30
v_mul_f32 v173,v173,v30
v_mul_f32 v174,v174,v30
v_mul_f32 v175,v175,v30
v_cvt_pk_bf16_f32 v172,v172,v173
v_cvt_pk_bf16_f32 v173,v174,v175
buffer_store_dwordx2 v[172:173],v23,s[16:19],s54 offen offset:96
v_mul_f32 v176,v176,v30
v_mul_f32 v177,v177,v30
v_mul_f32 v178,v178,v30
v_mul_f32 v179,v179,v30
v_cvt_pk_bf16_f32 v176,v176,v177
v_cvt_pk_bf16_f32 v177,v178,v179
buffer_store_dwordx2 v[176:177],v23,s[16:19],s54 offen offset:128
v_mul_f32 v180,v180,v30
v_mul_f32 v181,v181,v30
v_mul_f32 v182,v182,v30
v_mul_f32 v183,v183,v30
v_cvt_pk_bf16_f32 v180,v180,v181
v_cvt_pk_bf16_f32 v181,v182,v183
buffer_store_dwordx2 v[180:181],v23,s[16:19],s54 offen offset:160
v_mul_f32 v184,v184,v30
v_mul_f32 v185,v185,v30
v_mul_f32 v186,v186,v30
v_mul_f32 v187,v187,v30
v_cvt_pk_bf16_f32 v184,v184,v185
v_cvt_pk_bf16_f32 v185,v186,v187
buffer_store_dwordx2 v[184:185],v23,s[16:19],s54 offen offset:192
v_mul_f32 v188,v188,v30
v_mul_f32 v189,v189,v30
v_mul_f32 v190,v190,v30
v_mul_f32 v191,v191,v30
v_cvt_pk_bf16_f32 v188,v188,v189
v_cvt_pk_bf16_f32 v189,v190,v191
buffer_store_dwordx2 v[188:189],v23,s[16:19],s54 offen offset:224
v_mul_f32 v192,v192,v30
v_mul_f32 v193,v193,v30
v_mul_f32 v194,v194,v30
v_mul_f32 v195,v195,v30
v_cvt_pk_bf16_f32 v192,v192,v193
v_cvt_pk_bf16_f32 v193,v194,v195
buffer_store_dwordx2 v[192:193],v23,s[16:19],s54 offen offset:256
v_mul_f32 v196,v196,v30
v_mul_f32 v197,v197,v30
v_mul_f32 v198,v198,v30
v_mul_f32 v199,v199,v30
v_cvt_pk_bf16_f32 v196,v196,v197
v_cvt_pk_bf16_f32 v197,v198,v199
buffer_store_dwordx2 v[196:197],v23,s[16:19],s54 offen offset:288
v_mul_f32 v200,v200,v30
v_mul_f32 v201,v201,v30
v_mul_f32 v202,v202,v30
v_mul_f32 v203,v203,v30
v_cvt_pk_bf16_f32 v200,v200,v201
v_cvt_pk_bf16_f32 v201,v202,v203
buffer_store_dwordx2 v[200:201],v23,s[16:19],s54 offen offset:320
v_mul_f32 v204,v204,v30
v_mul_f32 v205,v205,v30
v_mul_f32 v206,v206,v30
v_mul_f32 v207,v207,v30
v_cvt_pk_bf16_f32 v204,v204,v205
v_cvt_pk_bf16_f32 v205,v206,v207
buffer_store_dwordx2 v[204:205],v23,s[16:19],s54 offen offset:352
s_waitcnt vmcnt(0)
s_add_u32 s54,s54,6144
s_add_u32 s51,s51,1
s_cmp_lt_u32 s51,s55
s_cbranch_scc1 L_fix_tile
s_cmp_lg_u32 s31,0
s_cbranch_scc1 L_fix_pass
s_branch L_done
L_codeend:
.section .rodata,"a"
.p2align 6
.amdhsa_kernel standalone__gqa_softmax__near_ridge_kernel
  .amdhsa_next_free_vgpr 512
  .amdhsa_next_free_sgpr 102
  .amdhsa_accum_offset 256
  .amdhsa_group_segment_fixed_size 0
  .amdhsa_kernarg_size 48
  .amdhsa_user_sgpr_count 2
  .amdhsa_user_sgpr_kernarg_segment_ptr 1
  .amdhsa_system_sgpr_workgroup_id_x 1
.end_amdhsa_kernel
```

```asm
; @launch grid=(256,1,1) block=(256,1,1) lds=163840
.amdgcn_target "amdgcn-amd-amdhsa--gfx950"
.text
.globl standalone__gqa_softmax__near_ridge_kernel
.p2align 8
.type standalone__gqa_softmax__near_ridge_kernel,@function
standalone__gqa_softmax__near_ridge_kernel:
s_cmp_ge_u32 s2,256
s_cbranch_scc1 L_end
s_load_dwordx4 s[84:87],s[0:1],0
s_load_dwordx4 s[88:91],s[0:1],16
v_lshrrev_b32 v152,6,v0
v_and_b32 v156,63,v0
v_readfirstlane_b32 s3,v152
s_lshr_b32 s34,s2,3
s_getpc_b64 s[92:93]
L_pc:
s_mul_i32 s62,s34,4096
v_min_u32 v152,31,v156
v_lshlrev_b32 v152,7,v152
v_add_u32 v152,s62,v152
v_min_u32 v152,L_codeend-L_pc-4,v152
s_cmp_lg_u32 s3,0
s_cbranch_scc1 L_nopre
global_load_dword v52,v152,s[92:93]
L_nopre:
v_lshrrev_b32 v152,3,v156
v_and_b32 v154,7,v156
v_add_u32 v153,0,v152
v_mul_u32_u24 v153,43,v153
v_lshrrev_b32 v153,7,v153
v_and_b32 v153,6,v153
v_xor_b32 v153,v153,v154
v_lshlrev_b32 v153,4,v153
v_lshl_add_u32 v6,v152,7,v153
v_add_u32 v153,8,v152
v_mul_u32_u24 v153,43,v153
v_lshrrev_b32 v153,7,v153
v_and_b32 v153,6,v153
v_xor_b32 v153,v153,v154
v_lshlrev_b32 v153,4,v153
v_lshl_add_u32 v7,v152,7,v153
v_add_u32 v153,16,v152
v_mul_u32_u24 v153,43,v153
v_lshrrev_b32 v153,7,v153
v_and_b32 v153,6,v153
v_xor_b32 v153,v153,v154
v_lshlrev_b32 v153,4,v153
v_lshl_add_u32 v8,v152,7,v153
s_mov_b32 s37,0x5d800000
s_mov_b32 s36,0x3dd53b95
s_mov_b32 s31,0
s_mov_b32 s32,1
s_and_b32 s62,s2,7
s_lshl_b32 s33,s62,6
s_mul_i32 s22,s3,3072
s_add_u32 s23,s22,36864
s_mul_i32 s24,s3,22528
s_add_u32 s24,s24,73728
s_mov_b32 s69,0
s_lshl_b32 s62,s69,5
s_add_u32 s62,s62,s34
s_mul_i32 s63,s62,171
s_lshr_b32 s63,s63,9
s_mul_i32 s64,s63,3
s_sub_u32 s62,s62,s64
s_add_u32 s63,s63,s33
s_mul_i32 s30,s63,196608
s_mul_i32 s41,s63,325632
s_lshl_b32 s63,s3,2
s_add_u32 s64,s63,21
s_cmp_eq_u32 s3,0
s_cselect_b32 s64,20,s64
s_cselect_b32 s40,1,0
s_add_u32 s65,s63,37
s_cmp_eq_u32 s62,2
s_cselect_b32 s64,s65,s64
s_cselect_b32 s40,0,s40
s_add_u32 s65,s63,s3
s_cmp_eq_u32 s62,0
s_cselect_b32 s64,s65,s64
s_cselect_b32 s40,1,s40
s_mul_i32 s64,s64,6144
s_add_u32 s41,s41,s64
s_add_u32 s20,s30,s22
s_mov_b32 s21,s20
s_waitcnt lgkmcnt(0)
s_mov_b32 s4,s86
s_and_b32 s5,s87,0xffff
s_mov_b32 s6,100663296
s_mov_b32 s7,0x20000
s_mov_b32 s12,s84
s_and_b32 s13,s85,0xffff
s_mov_b32 s14,166723584
s_mov_b32 s15,0x20000
s_mov_b32 s8,s88
s_and_b32 s9,s89,0xffff
s_mov_b32 s10,100663296
s_mov_b32 s11,0x20000
s_mov_b32 s16,s90
s_and_b32 s17,s91,0xffff
s_mov_b32 s18,166723584
s_mov_b32 s19,0x20000
s_cmp_eq_u32 s40,0
s_cbranch_scc1 L_start4
L_start5:
s_add_u32 m0,s22,0
s_nop 0
buffer_load_dwordx4 v6,s[4:7],s20 offen offset:0 lds
buffer_load_dwordx4 v7,s[4:7],s20 offen offset:1024 lds
buffer_load_dwordx4 v8,s[4:7],s20 offen offset:2048 lds
s_add_u32 s20,s20,12288
s_mov_b32 s28,s41
s_add_u32 m0,s24,0
s_nop 0
buffer_load_dwordx4 v6,s[12:15],s28 offen offset:0 nt lds
buffer_load_dwordx4 v7,s[12:15],s28 offen offset:1024 nt lds
buffer_load_dwordx4 v8,s[12:15],s28 offen offset:2048 nt lds
s_add_u32 s28,s28,3072
s_add_u32 m0,s24,3072
s_nop 0
buffer_load_dwordx4 v6,s[12:15],s28 offen offset:0 nt lds
buffer_load_dwordx4 v7,s[12:15],s28 offen offset:1024 nt lds
buffer_load_dwordx4 v8,s[12:15],s28 offen offset:2048 nt lds
s_add_u32 s28,s28,3072
s_add_u32 m0,s24,6144
s_nop 0
buffer_load_dwordx4 v6,s[12:15],s28 offen offset:0 nt lds
buffer_load_dwordx4 v7,s[12:15],s28 offen offset:1024 nt lds
buffer_load_dwordx4 v8,s[12:15],s28 offen offset:2048 nt lds
s_add_u32 s28,s28,3072
s_add_u32 m0,s24,9216
s_nop 0
buffer_load_dwordx4 v6,s[12:15],s28 offen offset:0 nt lds
buffer_load_dwordx4 v7,s[12:15],s28 offen offset:1024 nt lds
buffer_load_dwordx4 v8,s[12:15],s28 offen offset:2048 nt lds
s_add_u32 s28,s28,3072
v_and_b32 v152,15,v156
v_lshrrev_b32 v153,4,v156
v_mul_u32_u24 v0,384,v152
v_and_b32 v155,6,v152
v_xor_b32 v155,v155,v153
v_lshl_add_u32 v0,v155,4,v0
v_xor_b32 v1,64,v0
v_add_u32 v11,s24,v0
v_add_u32 v12,s24,v1
v_lshrrev_b32 v152,2,v156
v_mul_u32_u24 v2,384,v152
v_and_b32 v152,6,v152
v_bfe_u32 v155,v156,1,1
v_xor_b32 v152,v152,v155
v_lshl_add_u32 v2,v152,4,v2
v_and_b32 v155,1,v156
v_lshl_add_u32 v2,v155,3,v2
v_add_u32 v2,36864,v2
v_xor_b32 v3,32,v2
v_xor_b32 v4,64,v2
v_xor_b32 v5,96,v2
v_lshrrev_b32 v152,3,v156
v_and_b32 v153,7,v156
v_xor_b32 v155,v153,v152
v_lshl_add_u32 v10,v152,7,s24
v_lshl_add_u32 v10,v155,4,v10
v_mul_u32_u24 v9,384,v152
v_lshl_add_u32 v9,v153,4,v9
v_mov_b32 v48,0x3f803f80
v_mov_b32 v49,0x3f803f80
v_mov_b32 v50,0x3f803f80
v_mov_b32 v51,0x3f803f80
s_waitcnt vmcnt(12)
s_barrier
s_waitcnt vmcnt(6)
ds_read_b128 a[144:147],v11 offset:0
ds_read_b128 v[112:115],v0 offset:0
ds_read_b128 a[148:151],v12 offset:0
ds_read_b128 a[152:155],v11 offset:128
ds_read_b128 a[156:159],v12 offset:128
ds_read_b128 a[160:163],v11 offset:256
ds_read_b128 a[164:167],v12 offset:256
s_add_u32 m0,s24,12288
ds_read_b128 v[116:119],v1 offset:0
ds_read_b128 v[120:123],v0 offset:128
ds_read_b128 v[124:127],v1 offset:128
s_waitcnt lgkmcnt(8)
v_mfma_f32_16x16x32_bf16 v[72:75],v[112:115],a[144:147],0
buffer_load_dwordx4 v6,s[12:15],s28 offen offset:0 nt lds
ds_read_b128 v[128:131],v0 offset:256
ds_read_b128 v[132:135],v1 offset:256
ds_read_b128 v[136:139],v0 offset:6144
ds_read_b128 v[140:143],v1 offset:6144
ds_read_b128 v[112:115],v0 offset:6272
s_waitcnt lgkmcnt(7)
v_mfma_f32_16x16x32_bf16 v[72:75],v[116:119],a[148:151],v[72:75]
buffer_load_dwordx4 v7,s[12:15],s28 offen offset:1024 nt lds
s_waitcnt lgkmcnt(6)
v_mfma_f32_16x16x32_bf16 v[72:75],v[120:123],a[152:155],v[72:75]
buffer_load_dwordx4 v8,s[12:15],s28 offen offset:2048 nt lds
s_add_u32 s28,s28,3072
s_add_u32 m0,s24,15360
s_waitcnt lgkmcnt(5)
v_mfma_f32_16x16x32_bf16 v[72:75],v[124:127],a[156:159],v[72:75]
buffer_load_dwordx4 v6,s[12:15],s28 offen offset:0 nt lds
s_waitcnt lgkmcnt(4)
v_mfma_f32_16x16x32_bf16 v[72:75],v[128:131],a[160:163],v[72:75]
buffer_load_dwordx4 v7,s[12:15],s28 offen offset:1024 nt lds
s_waitcnt lgkmcnt(3)
v_mfma_f32_16x16x32_bf16 v[72:75],v[132:135],a[164:167],v[72:75]
buffer_load_dwordx4 v8,s[12:15],s28 offen offset:2048 nt lds
s_add_u32 s28,s28,3072
s_add_u32 m0,s24,0
s_waitcnt lgkmcnt(0)
v_mfma_f32_16x16x32_bf16 v[76:79],v[136:139],a[144:147],0
ds_read_b128 v[116:119],v1 offset:6272
v_mfma_f32_16x16x32_bf16 v[76:79],v[140:143],a[148:151],v[76:79]
ds_read_b128 v[120:123],v0 offset:6400
v_mfma_f32_16x16x32_bf16 v[76:79],v[112:115],a[152:155],v[76:79]
ds_read_b128 v[124:127],v1 offset:6400
ds_read_b128 v[128:131],v0 offset:0
ds_read_b128 v[132:135],v1 offset:0
ds_read_b128 v[136:139],v0 offset:128
ds_read_b128 v[140:143],v1 offset:128
ds_read_b128 v[112:115],v0 offset:256
s_waitcnt lgkmcnt(7)
v_mfma_f32_16x16x32_bf16 v[76:79],v[116:119],a[156:159],v[76:79]
s_waitcnt lgkmcnt(6)
ds_read_b128 v[116:119],v1 offset:256
v_mfma_f32_16x16x32_bf16 v[76:79],v[120:123],a[160:163],v[76:79]
s_waitcnt lgkmcnt(6)
ds_read_b128 v[120:123],v0 offset:6144
v_mfma_f32_16x16x32_bf16 v[76:79],v[124:127],a[164:167],v[76:79]
s_waitcnt vmcnt(6)
ds_read_b128 a[168:171],v11 offset:6144
ds_read_b128 a[172:175],v12 offset:6144
ds_read_b128 a[176:179],v11 offset:6272
ds_read_b128 a[180:183],v12 offset:6272
ds_read_b128 a[184:187],v11 offset:6400
ds_read_b128 a[188:191],v12 offset:6400
ds_read_b128 v[124:127],v1 offset:6144
s_waitcnt lgkmcnt(6)
v_mfma_f32_16x16x32_bf16 v[80:83],v[128:131],a[168:171],0
buffer_load_dwordx4 v6,s[12:15],s28 offen offset:0 nt lds
s_waitcnt lgkmcnt(5)
v_mfma_f32_16x16x32_bf16 v[80:83],v[132:135],a[172:175],v[80:83]
buffer_load_dwordx4 v7,s[12:15],s28 offen offset:1024 nt lds
s_waitcnt lgkmcnt(4)
v_mfma_f32_16x16x32_bf16 v[80:83],v[136:139],a[176:179],v[80:83]
buffer_load_dwordx4 v8,s[12:15],s28 offen offset:2048 nt lds
s_add_u32 s28,s28,3072
s_add_u32 m0,s24,3072
s_waitcnt lgkmcnt(3)
v_mfma_f32_16x16x32_bf16 v[80:83],v[140:143],a[180:183],v[80:83]
buffer_load_dwordx4 v6,s[12:15],s28 offen offset:0 nt lds
s_waitcnt lgkmcnt(2)
v_mfma_f32_16x16x32_bf16 v[80:83],v[112:115],a[184:187],v[80:83]
buffer_load_dwordx4 v7,s[12:15],s28 offen offset:1024 nt lds
s_waitcnt lgkmcnt(1)
v_mfma_f32_16x16x32_bf16 v[80:83],v[116:119],a[188:191],v[80:83]
buffer_load_dwordx4 v8,s[12:15],s28 offen offset:2048 nt lds
s_add_u32 s28,s28,3072
s_add_u32 m0,s24,6144
v_mfma_f32_16x16x32_bf16 v[84:87],v[120:123],a[168:171],0
s_waitcnt lgkmcnt(0)
ds_read_b128 v[128:131],v0 offset:6272
v_mfma_f32_16x16x32_bf16 v[84:87],v[124:127],a[172:175],v[84:87]
ds_read_b128 v[132:135],v1 offset:6272
ds_read_b128 v[136:139],v0 offset:6400
ds_read_b128 v[140:143],v1 offset:6400
ds_read_b128 v[112:115],v0 offset:0
ds_read_b128 v[116:119],v1 offset:0
ds_read_b128 v[120:123],v0 offset:128
ds_read_b128 v[124:127],v1 offset:128
s_waitcnt lgkmcnt(7)
v_mfma_f32_16x16x32_bf16 v[84:87],v[128:131],a[176:179],v[84:87]
s_waitcnt lgkmcnt(6)
ds_read_b128 v[128:131],v0 offset:256
v_mfma_f32_16x16x32_bf16 v[84:87],v[132:135],a[180:183],v[84:87]
s_waitcnt lgkmcnt(6)
ds_read_b128 v[132:135],v1 offset:256
v_mfma_f32_16x16x32_bf16 v[84:87],v[136:139],a[184:187],v[84:87]
s_waitcnt lgkmcnt(6)
ds_read_b128 v[136:139],v0 offset:6144
v_mfma_f32_16x16x32_bf16 v[84:87],v[140:143],a[188:191],v[84:87]
s_waitcnt vmcnt(6)
ds_read_b128 a[192:195],v11 offset:12288
ds_read_b128 a[196:199],v12 offset:12288
ds_read_b128 a[200:203],v11 offset:12416
ds_read_b128 a[204:207],v12 offset:12416
ds_read_b128 a[208:211],v11 offset:12544
ds_read_b128 a[212:215],v12 offset:12544
ds_read_b128 v[140:143],v1 offset:6144
s_waitcnt lgkmcnt(6)
v_mfma_f32_16x16x32_bf16 v[88:91],v[112:115],a[192:195],0
buffer_load_dwordx4 v6,s[12:15],s28 offen offset:0 nt lds
s_waitcnt lgkmcnt(5)
v_mfma_f32_16x16x32_bf16 v[88:91],v[116:119],a[196:199],v[88:91]
buffer_load_dwordx4 v7,s[12:15],s28 offen offset:1024 nt lds
s_waitcnt lgkmcnt(4)
v_mfma_f32_16x16x32_bf16 v[88:91],v[120:123],a[200:203],v[88:91]
buffer_load_dwordx4 v8,s[12:15],s28 offen offset:2048 nt lds
s_add_u32 s28,s28,3072
s_add_u32 m0,s24,9216
s_waitcnt lgkmcnt(3)
v_mfma_f32_16x16x32_bf16 v[88:91],v[124:127],a[204:207],v[88:91]
buffer_load_dwordx4 v6,s[12:15],s28 offen offset:0 nt lds
s_waitcnt lgkmcnt(2)
v_mfma_f32_16x16x32_bf16 v[88:91],v[128:131],a[208:211],v[88:91]
buffer_load_dwordx4 v7,s[12:15],s28 offen offset:1024 nt lds
s_waitcnt lgkmcnt(1)
v_mfma_f32_16x16x32_bf16 v[88:91],v[132:135],a[212:215],v[88:91]
buffer_load_dwordx4 v8,s[12:15],s28 offen offset:2048 nt lds
s_add_u32 s28,s28,3072
s_add_u32 m0,s22,12288
v_mfma_f32_16x16x32_bf16 v[92:95],v[136:139],a[192:195],0
s_waitcnt lgkmcnt(0)
ds_read_b128 v[112:115],v0 offset:6272
v_mfma_f32_16x16x32_bf16 v[92:95],v[140:143],a[196:199],v[92:95]
ds_read_b128 v[116:119],v1 offset:6272
ds_read_b128 v[120:123],v0 offset:6400
ds_read_b128 v[124:127],v1 offset:6400
ds_read_b128 v[128:131],v0 offset:0
ds_read_b128 v[132:135],v1 offset:0
ds_read_b128 v[136:139],v0 offset:128
ds_read_b128 v[140:143],v1 offset:128
s_waitcnt lgkmcnt(7)
v_mfma_f32_16x16x32_bf16 v[92:95],v[112:115],a[200:203],v[92:95]
s_waitcnt lgkmcnt(6)
ds_read_b128 v[112:115],v0 offset:256
v_mfma_f32_16x16x32_bf16 v[92:95],v[116:119],a[204:207],v[92:95]
s_waitcnt lgkmcnt(6)
ds_read_b128 v[116:119],v1 offset:256
v_mfma_f32_16x16x32_bf16 v[92:95],v[120:123],a[208:211],v[92:95]
s_waitcnt lgkmcnt(6)
ds_read_b128 v[120:123],v0 offset:6144
v_mfma_f32_16x16x32_bf16 v[92:95],v[124:127],a[212:215],v[92:95]
s_waitcnt vmcnt(6)
ds_read_b128 a[216:219],v11 offset:0
ds_read_b128 a[220:223],v12 offset:0
ds_read_b128 a[224:227],v11 offset:128
ds_read_b128 a[228:231],v12 offset:128
ds_read_b128 a[232:235],v11 offset:256
ds_read_b128 a[236:239],v12 offset:256
ds_read_b128 v[124:127],v1 offset:6144
s_waitcnt lgkmcnt(6)
v_mfma_f32_16x16x32_bf16 v[96:99],v[128:131],a[216:219],0
buffer_load_dwordx4 v6,s[4:7],s20 offen offset:0 lds
s_waitcnt lgkmcnt(5)
v_mfma_f32_16x16x32_bf16 v[96:99],v[132:135],a[220:223],v[96:99]
buffer_load_dwordx4 v7,s[4:7],s20 offen offset:1024 lds
s_waitcnt lgkmcnt(4)
v_mfma_f32_16x16x32_bf16 v[96:99],v[136:139],a[224:227],v[96:99]
buffer_load_dwordx4 v8,s[4:7],s20 offen offset:2048 lds
s_add_u32 s20,s20,12288
s_add_u32 m0,s23,0
s_waitcnt lgkmcnt(3)
v_mfma_f32_16x16x32_bf16 v[96:99],v[140:143],a[228:231],v[96:99]
s_waitcnt lgkmcnt(2)
ds_read_b128 v[128:131],v0 offset:6272
v_mfma_f32_16x16x32_bf16 v[96:99],v[112:115],a[232:235],v[96:99]
s_waitcnt lgkmcnt(2)
ds_read_b128 v[132:135],v1 offset:6272
v_mfma_f32_16x16x32_bf16 v[96:99],v[116:119],a[236:239],v[96:99]
ds_read_b128 v[136:139],v0 offset:6400
v_mfma_f32_16x16x32_bf16 v[100:103],v[120:123],a[216:219],0
s_waitcnt lgkmcnt(3)
ds_read_b128 v[140:143],v1 offset:6400
v_mfma_f32_16x16x32_bf16 v[100:103],v[124:127],a[220:223],v[100:103]
ds_read_b128 v[112:115],v0 offset:0
ds_read_b128 v[116:119],v1 offset:0
ds_read_b128 v[120:123],v0 offset:128
ds_read_b128 v[124:127],v1 offset:128
s_waitcnt lgkmcnt(7)
v_mfma_f32_16x16x32_bf16 v[100:103],v[128:131],a[224:227],v[100:103]
s_waitcnt lgkmcnt(6)
ds_read_b128 v[128:131],v0 offset:256
v_mfma_f32_16x16x32_bf16 v[100:103],v[132:135],a[228:231],v[100:103]
s_waitcnt lgkmcnt(6)
ds_read_b128 v[132:135],v1 offset:256
v_mfma_f32_16x16x32_bf16 v[100:103],v[136:139],a[232:235],v[100:103]
s_waitcnt lgkmcnt(6)
ds_read_b128 v[136:139],v0 offset:6144
v_mfma_f32_16x16x32_bf16 v[100:103],v[140:143],a[236:239],v[100:103]
s_waitcnt vmcnt(3)
ds_read_b128 a[240:243],v11 offset:6144
ds_read_b128 a[244:247],v12 offset:6144
ds_read_b128 a[248:251],v11 offset:6272
ds_read_b128 a[252:255],v12 offset:6272
ds_read_b128 v[144:147],v11 offset:6400
ds_read_b128 v[148:151],v12 offset:6400
ds_read_b128 v[140:143],v1 offset:6144
s_waitcnt lgkmcnt(6)
v_mfma_f32_16x16x32_bf16 v[104:107],v[112:115],a[240:243],0
buffer_load_dwordx4 v6,s[8:11],s21 offen offset:0 lds
s_waitcnt lgkmcnt(5)
v_mfma_f32_16x16x32_bf16 v[104:107],v[116:119],a[244:247],v[104:107]
buffer_load_dwordx4 v7,s[8:11],s21 offen offset:1024 lds
s_waitcnt lgkmcnt(4)
v_mfma_f32_16x16x32_bf16 v[104:107],v[120:123],a[248:251],v[104:107]
buffer_load_dwordx4 v8,s[8:11],s21 offen offset:2048 lds
s_add_u32 s21,s21,12288
s_waitcnt lgkmcnt(3)
v_mfma_f32_16x16x32_bf16 v[104:107],v[124:127],a[252:255],v[104:107]
s_mov_b32 s27,166723584
ds_read_b128 v[112:115],v0 offset:6272
s_mov_b32 s42,s41
s_waitcnt lgkmcnt(3)
v_mfma_f32_16x16x32_bf16 v[104:107],v[128:131],v[144:147],v[104:107]
s_add_u32 s69,s69,1
ds_read_b128 v[116:119],v1 offset:6272
s_lshl_b32 s62,s69,5
s_waitcnt lgkmcnt(3)
v_mfma_f32_16x16x32_bf16 v[104:107],v[132:135],v[148:151],v[104:107]
s_add_u32 s62,s62,s34
ds_read_b128 v[120:123],v0 offset:6400
s_mul_i32 s63,s62,171
v_mfma_f32_16x16x32_bf16 v[108:111],v[136:139],a[240:243],0
s_lshr_b32 s63,s63,9
ds_read_b128 v[124:127],v1 offset:6400
s_mul_i32 s64,s63,3
s_waitcnt lgkmcnt(4)
v_mfma_f32_16x16x32_bf16 v[108:111],v[140:143],a[244:247],v[108:111]
s_sub_u32 s62,s62,s64
s_add_u32 s63,s63,s33
s_mul_i32 s30,s63,196608
s_mul_i32 s41,s63,325632
s_lshl_b32 s63,s3,2
s_add_u32 s64,s63,21
s_cmp_eq_u32 s3,0
s_cselect_b32 s64,20,s64
s_cselect_b32 s40,1,0
s_add_u32 s65,s63,37
s_cmp_eq_u32 s62,2
s_cselect_b32 s64,s65,s64
s_cselect_b32 s40,0,s40
s_add_u32 s65,s63,s3
s_cmp_eq_u32 s62,0
s_cselect_b32 s64,s65,s64
s_cselect_b32 s40,1,s40
s_mul_i32 s64,s64,6144
s_add_u32 s41,s41,s64
s_cmp_ge_u32 s69,6
s_waitcnt lgkmcnt(3)
v_mfma_f32_16x16x32_bf16 v[108:111],v[112:115],a[248:251],v[108:111]
s_cselect_b32 s41,166723584,s41
s_cselect_b32 s30,100663296,s30
s_add_u32 s25,s30,s22
s_waitcnt lgkmcnt(2)
v_mfma_f32_16x16x32_bf16 v[108:111],v[116:119],a[252:255],v[108:111]
s_add_u32 s26,s25,12288
s_mov_b32 s28,s41
s_mov_b32 s29,s24
s_waitcnt lgkmcnt(1)
v_mfma_f32_16x16x32_bf16 v[108:111],v[120:123],v[144:147],v[108:111]
s_waitcnt lgkmcnt(0)
v_mfma_f32_16x16x32_bf16 v[108:111],v[124:127],v[148:151],v[108:111]
s_waitcnt vmcnt(3)
s_barrier
ds_read_b128 v[128:131],v0 offset:12288
ds_read_b128 v[132:135],v1 offset:12288
v_max3_f32 v20,v72,v73,v74
ds_read_b128 v[136:139],v0 offset:12416
v_max3_f32 v20,v20,v75,v76
ds_read_b128 v[140:143],v1 offset:12416
v_max3_f32 v20,v20,v77,v78
ds_read_b128 v[112:115],v0 offset:12544
v_max_f32 v20,v20,v79
ds_read_b128 v[116:119],v1 offset:12544
v_max3_f32 v26,v80,v81,v82
ds_read_b128 v[120:123],v0 offset:18432
v_mov_b32 v21,v20
ds_read_b128 v[124:127],v1 offset:18432
v_max3_f32 v26,v26,v83,v84
v_permlane32_swap_b32 v21,v20
v_max3_f32 v26,v26,v85,v86
v_max_f32 v20,v20,v21
v_max_f32 v26,v26,v87
v_mov_b32 v21,v20
v_max3_f32 v32,v88,v89,v90
v_mov_b32 v27,v26
v_permlane16_swap_b32 v21,v20
v_max3_f32 v32,v32,v91,v92
v_permlane32_swap_b32 v27,v26
v_max_f32 v20,v20,v21
v_max3_f32 v32,v32,v93,v94
v_max_f32 v26,v26,v27
v_mul_f32_e64 v13,-s36,v20
v_max_f32 v32,v32,v95
v_mov_b32 v27,v26
v_fma_f32 v72,v72,s36,v13
v_fma_f32 v73,v73,s36,v13
v_fma_f32 v74,v74,s36,v13
v_fma_f32 v75,v75,s36,v13
v_max3_f32 v38,v96,v97,v98
v_mov_b32 v33,v32
v_permlane16_swap_b32 v27,v26
v_exp_f32 v72,v72
v_exp_f32 v73,v73
v_exp_f32 v74,v74
v_exp_f32 v75,v75
v_max3_f32 v38,v38,v99,v100
v_permlane32_swap_b32 v33,v32
v_max_f32 v26,v26,v27
v_max3_f32 v38,v38,v101,v102
v_max_f32 v32,v32,v33
v_mul_f32_e64 v14,-s36,v26
v_cvt_pk_bf16_f32 v18,v72,v73
v_cvt_pk_bf16_f32 v19,v74,v75
s_waitcnt lgkmcnt(0)
v_mfma_f32_16x16x32_bf16 v[72:75],v[128:131],a[144:147],0
s_add_u32 m0,s22,24576
v_max_f32 v38,v38,v103
buffer_load_dwordx4 v6,s[4:7],s20 offen offset:0 lds
buffer_load_dwordx4 v7,s[4:7],s20 offen offset:1024 lds
buffer_load_dwordx4 v8,s[4:7],s20 offen offset:2048 lds
v_mov_b32 v33,v32
v_fma_f32 v80,v80,s36,v14
v_fma_f32 v81,v81,s36,v14
v_fma_f32 v82,v82,s36,v14
v_fma_f32 v83,v83,s36,v14
v_max3_f32 v44,v104,v105,v106
v_mov_b32 v39,v38
v_permlane16_swap_b32 v33,v32
v_exp_f32 v80,v80
v_exp_f32 v81,v81
v_exp_f32 v82,v82
v_exp_f32 v83,v83
v_max3_f32 v44,v44,v107,v108
v_permlane32_swap_b32 v39,v38
v_max_f32 v32,v32,v33
v_max3_f32 v44,v44,v109,v110
v_max_f32 v38,v38,v39
v_mul_f32_e64 v15,-s36,v32
v_cvt_pk_bf16_f32 v24,v80,v81
v_cvt_pk_bf16_f32 v25,v82,v83
v_mfma_f32_16x16x32_bf16 v[80:83],v[128:131],a[168:171],0
s_add_u32 s20,s20,12288
v_max_f32 v44,v44,v111
v_mov_b32 v39,v38
v_fma_f32 v88,v88,s36,v15
v_fma_f32 v89,v89,s36,v15
v_fma_f32 v90,v90,s36,v15
v_fma_f32 v91,v91,s36,v15
v_mov_b32 v45,v44
v_permlane16_swap_b32 v39,v38
v_exp_f32 v88,v88
v_exp_f32 v89,v89
v_exp_f32 v90,v90
v_exp_f32 v91,v91
v_permlane32_swap_b32 v45,v44
v_max_f32 v38,v38,v39
v_max_f32 v44,v44,v45
v_mul_f32_e64 v16,-s36,v38
v_cvt_pk_bf16_f32 v30,v88,v89
v_cvt_pk_bf16_f32 v31,v90,v91
v_mfma_f32_16x16x32_bf16 v[88:91],v[128:131],a[192:195],0
s_add_u32 m0,s23,12288
v_mov_b32 v45,v44
buffer_load_dwordx4 v6,s[8:11],s21 offen offset:0 lds
buffer_load_dwordx4 v7,s[8:11],s21 offen offset:1024 lds
v_fma_f32 v96,v96,s36,v16
v_fma_f32 v97,v97,s36,v16
v_fma_f32 v98,v98,s36,v16
v_fma_f32 v99,v99,s36,v16
v_permlane16_swap_b32 v45,v44
v_exp_f32 v96,v96
v_exp_f32 v97,v97
v_exp_f32 v98,v98
v_exp_f32 v99,v99
v_max_f32 v44,v44,v45
v_mul_f32_e64 v17,-s36,v44
v_cvt_pk_bf16_f32 v36,v96,v97
v_cvt_pk_bf16_f32 v37,v98,v99
v_mfma_f32_16x16x32_bf16 v[96:99],v[128:131],a[216:219],0
v_fma_f32 v104,v104,s36,v17
v_fma_f32 v105,v105,s36,v17
v_fma_f32 v106,v106,s36,v17
v_fma_f32 v107,v107,s36,v17
buffer_load_dwordx4 v8,s[8:11],s21 offen offset:2048 lds
v_exp_f32 v104,v104
v_exp_f32 v105,v105
v_exp_f32 v106,v106
v_exp_f32 v107,v107
v_cvt_pk_bf16_f32 v42,v104,v105
v_cvt_pk_bf16_f32 v43,v106,v107
v_mfma_f32_16x16x32_bf16 v[104:107],v[128:131],a[240:243],0
s_add_u32 s21,s21,12288
ds_read_b128 v[128:131],v0 offset:18560
v_fma_f32 v76,v76,s36,v13
v_mfma_f32_16x16x32_bf16 v[72:75],v[132:135],a[148:151],v[72:75]
s_add_u32 m0,s23,24576
v_fma_f32 v77,v77,s36,v13
v_fma_f32 v78,v78,s36,v13
v_mfma_f32_16x16x32_bf16 v[80:83],v[132:135],a[172:175],v[80:83]
v_fma_f32 v79,v79,s36,v13
v_exp_f32 v76,v76
v_mfma_f32_16x16x32_bf16 v[88:91],v[132:135],a[196:199],v[88:91]
v_exp_f32 v77,v77
v_mfma_f32_16x16x32_bf16 v[96:99],v[132:135],a[220:223],v[96:99]
v_exp_f32 v78,v78
v_mfma_f32_16x16x32_bf16 v[104:107],v[132:135],a[244:247],v[104:107]
buffer_load_dwordx4 v6,s[8:11],s21 offen offset:0 lds
v_mfma_f32_16x16x32_bf16 v[72:75],v[136:139],a[152:155],v[72:75]
ds_read_b128 v[132:135],v1 offset:18560
v_exp_f32 v79,v79
v_mfma_f32_16x16x32_bf16 v[80:83],v[136:139],a[176:179],v[80:83]
v_fma_f32 v84,v84,s36,v14
v_fma_f32 v85,v85,s36,v14
v_mfma_f32_16x16x32_bf16 v[88:91],v[136:139],a[200:203],v[88:91]
v_fma_f32 v86,v86,s36,v14
v_fma_f32 v87,v87,s36,v14
v_mfma_f32_16x16x32_bf16 v[96:99],v[136:139],a[224:227],v[96:99]
v_cvt_pk_bf16_f32 v20,v76,v77
v_cvt_pk_bf16_f32 v21,v78,v79
v_mfma_f32_16x16x32_bf16 v[104:107],v[136:139],a[248:251],v[104:107]
ds_read_b128 v[136:139],v0 offset:18688
v_exp_f32 v84,v84
v_mfma_f32_16x16x32_bf16 v[52:55],v[48:51],v[18:21],0
v_exp_f32 v85,v85
v_mfma_f32_16x16x32_bf16 v[72:75],v[140:143],a[156:159],v[72:75]
buffer_load_dwordx4 v7,s[8:11],s21 offen offset:1024 lds
v_mfma_f32_16x16x32_bf16 v[80:83],v[140:143],a[180:183],v[80:83]
v_exp_f32 v86,v86
v_mfma_f32_16x16x32_bf16 v[88:91],v[140:143],a[204:207],v[88:91]
v_exp_f32 v87,v87
v_mfma_f32_16x16x32_bf16 v[96:99],v[140:143],a[228:231],v[96:99]
v_fma_f32 v92,v92,s36,v15
v_fma_f32 v93,v93,s36,v15
v_mfma_f32_16x16x32_bf16 v[104:107],v[140:143],a[252:255],v[104:107]
ds_read_b128 v[140:143],v1 offset:18688
v_fma_f32 v94,v94,s36,v15
v_mfma_f32_16x16x32_bf16 v[72:75],v[112:115],a[160:163],v[72:75]
v_fma_f32 v95,v95,s36,v15
v_cvt_pk_bf16_f32 v26,v84,v85
v_mfma_f32_16x16x32_bf16 v[80:83],v[112:115],a[184:187],v[80:83]
v_cvt_pk_bf16_f32 v27,v86,v87
v_exp_f32 v92,v92
v_mfma_f32_16x16x32_bf16 v[88:91],v[112:115],a[208:211],v[88:91]
v_exp_f32 v93,v93
v_mfma_f32_16x16x32_bf16 v[56:59],v[48:51],v[24:27],0
buffer_load_dwordx4 v8,s[8:11],s21 offen offset:2048 lds
v_mfma_f32_16x16x32_bf16 v[96:99],v[112:115],a[232:235],v[96:99]
s_add_u32 s21,s21,12288
v_exp_f32 v94,v94
v_mfma_f32_16x16x32_bf16 v[104:107],v[112:115],v[144:147],v[104:107]
s_add_u32 m0,s22,0
v_exp_f32 v95,v95
v_mfma_f32_16x16x32_bf16 v[72:75],v[116:119],a[164:167],v[72:75]
v_fma_f32 v100,v100,s36,v16
v_fma_f32 v101,v101,s36,v16
v_mfma_f32_16x16x32_bf16 v[80:83],v[116:119],a[188:191],v[80:83]
v_fma_f32 v102,v102,s36,v16
v_fma_f32 v103,v103,s36,v16
v_mfma_f32_16x16x32_bf16 v[88:91],v[116:119],a[212:215],v[88:91]
v_cvt_pk_bf16_f32 v32,v92,v93
v_cvt_pk_bf16_f32 v33,v94,v95
v_mfma_f32_16x16x32_bf16 v[96:99],v[116:119],a[236:239],v[96:99]
v_exp_f32 v100,v100
v_mfma_f32_16x16x32_bf16 v[60:63],v[48:51],v[30:33],0
v_exp_f32 v101,v101
v_mfma_f32_16x16x32_bf16 v[104:107],v[116:119],v[148:151],v[104:107]
v_exp_f32 v102,v102
v_mfma_f32_16x16x32_bf16 v[76:79],v[120:123],a[144:147],0
v_exp_f32 v103,v103
v_mfma_f32_16x16x32_bf16 v[84:87],v[120:123],a[168:171],0
v_fma_f32 v108,v108,s36,v17
v_fma_f32 v109,v109,s36,v17
v_mfma_f32_16x16x32_bf16 v[92:95],v[120:123],a[192:195],0
v_fma_f32 v110,v110,s36,v17
v_fma_f32 v111,v111,s36,v17
v_cvt_pk_bf16_f32 v38,v100,v101
v_cvt_pk_bf16_f32 v39,v102,v103
v_mfma_f32_16x16x32_bf16 v[100:103],v[120:123],a[216:219],0
v_exp_f32 v108,v108
v_mfma_f32_16x16x32_bf16 v[64:67],v[48:51],v[36:39],0
v_exp_f32 v109,v109
v_exp_f32 v110,v110
v_exp_f32 v111,v111
v_cvt_pk_bf16_f32 v44,v108,v109
v_cvt_pk_bf16_f32 v45,v110,v111
v_mfma_f32_16x16x32_bf16 v[108:111],v[120:123],a[240:243],0
v_fma_f32 v72,v72,s36,v13
v_fma_f32 v73,v73,s36,v13
v_mfma_f32_16x16x32_bf16 v[68:71],v[48:51],v[42:45],0
v_fma_f32 v74,v74,s36,v13
v_fma_f32 v75,v75,s36,v13
v_mfma_f32_16x16x32_bf16 v[76:79],v[124:127],a[148:151],v[76:79]
v_fma_f32 v80,v80,s36,v14
v_fma_f32 v81,v81,s36,v14
v_mfma_f32_16x16x32_bf16 v[84:87],v[124:127],a[172:175],v[84:87]
v_fma_f32 v82,v82,s36,v14
v_fma_f32 v83,v83,s36,v14
v_mfma_f32_16x16x32_bf16 v[92:95],v[124:127],a[196:199],v[92:95]
v_fma_f32 v88,v88,s36,v15
v_fma_f32 v89,v89,s36,v15
v_mfma_f32_16x16x32_bf16 v[100:103],v[124:127],a[220:223],v[100:103]
v_exp_f32 v72,v72
v_mfma_f32_16x16x32_bf16 v[108:111],v[124:127],a[244:247],v[108:111]
s_waitcnt lgkmcnt(0)
v_exp_f32 v73,v73
v_mfma_f32_16x16x32_bf16 v[76:79],v[128:131],a[152:155],v[76:79]
v_exp_f32 v74,v74
v_mfma_f32_16x16x32_bf16 v[84:87],v[128:131],a[176:179],v[84:87]
v_exp_f32 v75,v75
v_mfma_f32_16x16x32_bf16 v[92:95],v[128:131],a[200:203],v[92:95]
v_exp_f32 v80,v80
v_mfma_f32_16x16x32_bf16 v[100:103],v[128:131],a[224:227],v[100:103]
v_exp_f32 v81,v81
v_mfma_f32_16x16x32_bf16 v[108:111],v[128:131],a[248:251],v[108:111]
s_waitcnt vmcnt(9)
s_barrier
v_mfma_f32_16x16x32_bf16 v[76:79],v[132:135],a[156:159],v[76:79]
v_exp_f32 v82,v82
v_mfma_f32_16x16x32_bf16 v[84:87],v[132:135],a[180:183],v[84:87]
buffer_load_dwordx4 v6,s[4:7],s20 offen offset:0 lds
v_mfma_f32_16x16x32_bf16 v[92:95],v[132:135],a[204:207],v[92:95]
v_exp_f32 v83,v83
v_mfma_f32_16x16x32_bf16 v[100:103],v[132:135],a[228:231],v[100:103]
v_exp_f32 v88,v88
v_mfma_f32_16x16x32_bf16 v[108:111],v[132:135],a[252:255],v[108:111]
v_exp_f32 v89,v89
v_mfma_f32_16x16x32_bf16 v[76:79],v[136:139],a[160:163],v[76:79]
v_cvt_pk_bf16_f32 v22,v72,v73
v_cvt_pk_bf16_f32 v23,v74,v75
v_mfma_f32_16x16x32_bf16 v[84:87],v[136:139],a[184:187],v[84:87]
buffer_load_dwordx4 v7,s[4:7],s20 offen offset:1024 lds
v_mfma_f32_16x16x32_bf16 v[92:95],v[136:139],a[208:211],v[92:95]
v_cvt_pk_bf16_f32 v28,v80,v81
v_cvt_pk_bf16_f32 v29,v82,v83
v_mfma_f32_16x16x32_bf16 v[100:103],v[136:139],a[232:235],v[100:103]
v_cvt_pk_bf16_f32 v34,v88,v89
v_mfma_f32_16x16x32_bf16 v[108:111],v[136:139],v[144:147],v[108:111]
v_mfma_f32_16x16x32_bf16 v[76:79],v[140:143],a[164:167],v[76:79]
ds_read_b64_tr_b16 v[112:113],v2 offset:0
ds_read_b64_tr_b16 v[114:115],v2 offset:6144
v_mfma_f32_16x16x32_bf16 v[84:87],v[140:143],a[188:191],v[84:87]
v_mfma_f32_16x16x32_bf16 v[92:95],v[140:143],a[212:215],v[92:95]
buffer_load_dwordx4 v8,s[4:7],s20 offen offset:2048 lds
v_mfma_f32_16x16x32_bf16 v[100:103],v[140:143],a[236:239],v[100:103]
s_add_u32 s20,s20,12288
ds_read_b64_tr_b16 v[116:117],v3 offset:0
ds_read_b64_tr_b16 v[118:119],v3 offset:6144
v_mfma_f32_16x16x32_bf16 v[108:111],v[140:143],v[148:151],v[108:111]
ds_read_b64_tr_b16 v[120:121],v4 offset:0
ds_read_b64_tr_b16 v[122:123],v4 offset:6144
ds_read_b64_tr_b16 v[124:125],v5 offset:0
ds_read_b64_tr_b16 v[126:127],v5 offset:6144
s_waitcnt lgkmcnt(6)
v_mfma_f32_16x16x32_bf16 v[160:163],v[112:115],v[18:21],0
s_add_u32 m0,s23,0
ds_read_b64_tr_b16 v[128:129],v2 offset:128
ds_read_b64_tr_b16 v[130:131],v2 offset:6272
v_mfma_f32_16x16x32_bf16 v[208:211],v[112:115],v[24:27],0
ds_read_b64_tr_b16 v[132:133],v3 offset:128
ds_read_b64_tr_b16 v[134:135],v3 offset:6272
v_mfma_f32_16x16x32_bf16 a[0:3],v[112:115],v[30:33],0
ds_read_b64_tr_b16 v[136:137],v4 offset:128
ds_read_b64_tr_b16 v[138:139],v4 offset:6272
v_mfma_f32_16x16x32_bf16 a[48:51],v[112:115],v[36:39],0
ds_read_b64_tr_b16 v[140:141],v5 offset:128
ds_read_b64_tr_b16 v[142:143],v5 offset:6272
v_mfma_f32_16x16x32_bf16 a[96:99],v[112:115],v[42:45],0
s_waitcnt lgkmcnt(12)
ds_read_b64_tr_b16 v[112:113],v2 offset:256
ds_read_b64_tr_b16 v[114:115],v2 offset:6400
v_mfma_f32_16x16x32_bf16 v[164:167],v[116:119],v[18:21],0
v_fma_f32 v90,v90,s36,v15
v_fma_f32 v91,v91,s36,v15
v_mfma_f32_16x16x32_bf16 v[212:215],v[116:119],v[24:27],0
v_exp_f32 v90,v90
v_mfma_f32_16x16x32_bf16 a[4:7],v[116:119],v[30:33],0
v_exp_f32 v91,v91
v_mfma_f32_16x16x32_bf16 a[52:55],v[116:119],v[36:39],0
v_cvt_pk_bf16_f32 v35,v90,v91
v_fma_f32 v96,v96,s36,v16
v_mfma_f32_16x16x32_bf16 a[100:103],v[116:119],v[42:45],0
s_waitcnt lgkmcnt(7)
ds_read_b64_tr_b16 v[116:117],v3 offset:256
ds_read_b64_tr_b16 v[118:119],v3 offset:6400
v_mfma_f32_16x16x32_bf16 v[168:171],v[120:123],v[18:21],0
v_fma_f32 v97,v97,s36,v16
v_fma_f32 v98,v98,s36,v16
v_mfma_f32_16x16x32_bf16 v[216:219],v[120:123],v[24:27],0
v_fma_f32 v99,v99,s36,v16
v_fma_f32 v104,v104,s36,v17
v_mfma_f32_16x16x32_bf16 a[8:11],v[120:123],v[30:33],0
v_exp_f32 v96,v96
v_mfma_f32_16x16x32_bf16 a[56:59],v[120:123],v[36:39],0
v_exp_f32 v97,v97
v_mfma_f32_16x16x32_bf16 a[104:107],v[120:123],v[42:45],0
ds_read_b64_tr_b16 v[120:121],v4 offset:256
ds_read_b64_tr_b16 v[122:123],v4 offset:6400
v_mfma_f32_16x16x32_bf16 v[172:175],v[124:127],v[18:21],0
v_exp_f32 v98,v98
v_mfma_f32_16x16x32_bf16 v[220:223],v[124:127],v[24:27],0
v_exp_f32 v99,v99
v_mfma_f32_16x16x32_bf16 a[12:15],v[124:127],v[30:33],0
v_cvt_pk_bf16_f32 v40,v96,v97
v_cvt_pk_bf16_f32 v41,v98,v99
v_mfma_f32_16x16x32_bf16 a[60:63],v[124:127],v[36:39],0
v_fma_f32 v105,v105,s36,v17
v_fma_f32 v106,v106,s36,v17
v_mfma_f32_16x16x32_bf16 a[108:111],v[124:127],v[42:45],0
ds_read_b64_tr_b16 v[124:125],v5 offset:256
ds_read_b64_tr_b16 v[126:127],v5 offset:6400
v_mfma_f32_16x16x32_bf16 v[176:179],v[128:131],v[18:21],0
v_fma_f32 v107,v107,s36,v17
v_fma_f32 v76,v76,s36,v13
v_mfma_f32_16x16x32_bf16 v[224:227],v[128:131],v[24:27],0
v_exp_f32 v104,v104
v_mfma_f32_16x16x32_bf16 a[16:19],v[128:131],v[30:33],0
v_exp_f32 v105,v105
v_mfma_f32_16x16x32_bf16 a[64:67],v[128:131],v[36:39],0
v_exp_f32 v106,v106
v_mfma_f32_16x16x32_bf16 a[112:115],v[128:131],v[42:45],0
s_waitcnt lgkmcnt(2)
v_exp_f32 v107,v107
v_mfma_f32_16x16x32_bf16 v[180:183],v[132:135],v[18:21],0
v_cvt_pk_bf16_f32 v46,v104,v105
v_cvt_pk_bf16_f32 v47,v106,v107
v_mfma_f32_16x16x32_bf16 v[228:231],v[132:135],v[24:27],0
v_fma_f32 v77,v77,s36,v13
v_fma_f32 v78,v78,s36,v13
v_mfma_f32_16x16x32_bf16 a[20:23],v[132:135],v[30:33],0
v_fma_f32 v79,v79,s36,v13
v_fma_f32 v84,v84,s36,v14
v_mfma_f32_16x16x32_bf16 a[68:71],v[132:135],v[36:39],0
v_exp_f32 v76,v76
v_mfma_f32_16x16x32_bf16 a[116:119],v[132:135],v[42:45],0
v_exp_f32 v77,v77
v_mfma_f32_16x16x32_bf16 v[184:187],v[136:139],v[18:21],0
v_exp_f32 v78,v78
v_mfma_f32_16x16x32_bf16 v[232:235],v[136:139],v[24:27],0
v_exp_f32 v79,v79
v_mfma_f32_16x16x32_bf16 a[24:27],v[136:139],v[30:33],0
v_fma_f32 v85,v85,s36,v14
v_fma_f32 v86,v86,s36,v14
v_mfma_f32_16x16x32_bf16 a[72:75],v[136:139],v[36:39],0
v_fma_f32 v87,v87,s36,v14
v_fma_f32 v92,v92,s36,v15
v_mfma_f32_16x16x32_bf16 a[120:123],v[136:139],v[42:45],0
v_exp_f32 v84,v84
v_mfma_f32_16x16x32_bf16 v[188:191],v[140:143],v[18:21],0
v_exp_f32 v85,v85
v_mfma_f32_16x16x32_bf16 v[236:239],v[140:143],v[24:27],0
v_exp_f32 v86,v86
v_mfma_f32_16x16x32_bf16 a[28:31],v[140:143],v[30:33],0
v_exp_f32 v87,v87
v_mfma_f32_16x16x32_bf16 a[76:79],v[140:143],v[36:39],0
v_fma_f32 v93,v93,s36,v15
v_fma_f32 v94,v94,s36,v15
v_mfma_f32_16x16x32_bf16 a[124:127],v[140:143],v[42:45],0
v_fma_f32 v95,v95,s36,v15
v_fma_f32 v100,v100,s36,v16
v_mfma_f32_16x16x32_bf16 v[192:195],v[112:115],v[18:21],0
v_exp_f32 v92,v92
v_mfma_f32_16x16x32_bf16 v[240:243],v[112:115],v[24:27],0
v_exp_f32 v93,v93
s_waitcnt vmcnt(6) lgkmcnt(0)
v_mfma_f32_16x16x32_bf16 a[32:35],v[112:115],v[30:33],0
s_barrier
v_mfma_f32_16x16x32_bf16 a[80:83],v[112:115],v[36:39],0
ds_read_b128 v[128:131],v0 offset:24576
v_fma_f32 v101,v101,s36,v16
v_mfma_f32_16x16x32_bf16 a[128:131],v[112:115],v[42:45],0
ds_read_b128 v[132:135],v1 offset:24576
v_fma_f32 v102,v102,s36,v16
v_mfma_f32_16x16x32_bf16 v[196:199],v[116:119],v[18:21],0
ds_read_b128 v[136:139],v0 offset:24704
v_fma_f32 v103,v103,s36,v16
v_mfma_f32_16x16x32_bf16 v[244:247],v[116:119],v[24:27],0
ds_read_b128 v[140:143],v1 offset:24704
v_fma_f32 v108,v108,s36,v17
v_mfma_f32_16x16x32_bf16 a[36:39],v[116:119],v[30:33],0
ds_read_b128 v[112:115],v0 offset:24832
v_fma_f32 v109,v109,s36,v17
v_mfma_f32_16x16x32_bf16 a[84:87],v[116:119],v[36:39],0
buffer_load_dwordx4 v6,s[8:11],s21 offen offset:0 lds
v_mfma_f32_16x16x32_bf16 a[132:135],v[116:119],v[42:45],0
ds_read_b128 v[116:119],v1 offset:24832
v_fma_f32 v110,v110,s36,v17
v_mfma_f32_16x16x32_bf16 v[200:203],v[120:123],v[18:21],0
v_exp_f32 v94,v94
v_mfma_f32_16x16x32_bf16 v[248:251],v[120:123],v[24:27],0
v_exp_f32 v95,v95
v_mfma_f32_16x16x32_bf16 a[40:43],v[120:123],v[30:33],0
v_exp_f32 v100,v100
v_mfma_f32_16x16x32_bf16 a[88:91],v[120:123],v[36:39],0
v_exp_f32 v101,v101
v_mfma_f32_16x16x32_bf16 a[136:139],v[120:123],v[42:45],0
ds_read_b128 v[120:123],v0 offset:30720
v_fma_f32 v111,v111,s36,v17
v_mfma_f32_16x16x32_bf16 v[204:207],v[124:127],v[18:21],0
v_cvt_pk_bf16_f32 v20,v76,v77
v_cvt_pk_bf16_f32 v21,v78,v79
v_mfma_f32_16x16x32_bf16 v[252:255],v[124:127],v[24:27],0
v_cvt_pk_bf16_f32 v26,v84,v85
v_cvt_pk_bf16_f32 v27,v86,v87
v_mfma_f32_16x16x32_bf16 v[52:55],v[48:51],v[20:23],v[52:55]
v_exp_f32 v102,v102
v_mfma_f32_16x16x32_bf16 v[56:59],v[48:51],v[26:29],v[56:59]
v_exp_f32 v103,v103
v_mfma_f32_16x16x32_bf16 a[44:47],v[124:127],v[30:33],0
v_cvt_pk_bf16_f32 v32,v92,v93
v_cvt_pk_bf16_f32 v33,v94,v95
v_mfma_f32_16x16x32_bf16 a[92:95],v[124:127],v[36:39],0
buffer_load_dwordx4 v7,s[8:11],s21 offen offset:1024 lds
v_mfma_f32_16x16x32_bf16 v[60:63],v[48:51],v[32:35],v[60:63]
v_cvt_pk_bf16_f32 v38,v100,v101
v_cvt_pk_bf16_f32 v39,v102,v103
v_mfma_f32_16x16x32_bf16 a[140:143],v[124:127],v[42:45],0
ds_read_b128 v[124:127],v1 offset:30720
v_mfma_f32_16x16x32_bf16 v[64:67],v[48:51],v[38:41],v[64:67]
s_waitcnt lgkmcnt(1)
v_exp_f32 v108,v108
v_mfma_f32_16x16x32_bf16 v[72:75],v[128:131],a[144:147],0
v_exp_f32 v109,v109
v_mfma_f32_16x16x32_bf16 v[80:83],v[128:131],a[168:171],0
v_exp_f32 v110,v110
v_mfma_f32_16x16x32_bf16 v[88:91],v[128:131],a[192:195],0
v_exp_f32 v111,v111
v_mfma_f32_16x16x32_bf16 v[96:99],v[128:131],a[216:219],0
v_cvt_pk_bf16_f32 v44,v108,v109
v_cvt_pk_bf16_f32 v45,v110,v111
v_mfma_f32_16x16x32_bf16 v[104:107],v[128:131],a[240:243],0
ds_read_b128 v[128:131],v0 offset:30848
v_mfma_f32_16x16x32_bf16 v[68:71],v[48:51],v[44:47],v[68:71]
v_mfma_f32_16x16x32_bf16 v[72:75],v[132:135],a[148:151],v[72:75]
v_mfma_f32_16x16x32_bf16 v[80:83],v[132:135],a[172:175],v[80:83]
buffer_load_dwordx4 v8,s[8:11],s21 offen offset:2048 lds
v_mfma_f32_16x16x32_bf16 v[88:91],v[132:135],a[196:199],v[88:91]
s_add_u32 s21,s21,12288
v_mfma_f32_16x16x32_bf16 v[96:99],v[132:135],a[220:223],v[96:99]
s_add_u32 m0,s22,12288
v_mfma_f32_16x16x32_bf16 v[104:107],v[132:135],a[244:247],v[104:107]
ds_read_b128 v[132:135],v1 offset:30848
v_mfma_f32_16x16x32_bf16 v[72:75],v[136:139],a[152:155],v[72:75]
v_mfma_f32_16x16x32_bf16 v[80:83],v[136:139],a[176:179],v[80:83]
v_mfma_f32_16x16x32_bf16 v[88:91],v[136:139],a[200:203],v[88:91]
v_mfma_f32_16x16x32_bf16 v[96:99],v[136:139],a[224:227],v[96:99]
v_mfma_f32_16x16x32_bf16 v[104:107],v[136:139],a[248:251],v[104:107]
ds_read_b128 v[136:139],v0 offset:30976
v_mfma_f32_16x16x32_bf16 v[72:75],v[140:143],a[156:159],v[72:75]
v_mfma_f32_16x16x32_bf16 v[80:83],v[140:143],a[180:183],v[80:83]
v_mfma_f32_16x16x32_bf16 v[88:91],v[140:143],a[204:207],v[88:91]
buffer_load_dwordx4 v6,s[4:7],s20 offen offset:0 lds
v_mfma_f32_16x16x32_bf16 v[96:99],v[140:143],a[228:231],v[96:99]
v_mfma_f32_16x16x32_bf16 v[104:107],v[140:143],a[252:255],v[104:107]
ds_read_b128 v[140:143],v1 offset:30976
v_mfma_f32_16x16x32_bf16 v[72:75],v[112:115],a[160:163],v[72:75]
v_mfma_f32_16x16x32_bf16 v[80:83],v[112:115],a[184:187],v[80:83]
v_mfma_f32_16x16x32_bf16 v[88:91],v[112:115],a[208:211],v[88:91]
v_mfma_f32_16x16x32_bf16 v[96:99],v[112:115],a[232:235],v[96:99]
v_mfma_f32_16x16x32_bf16 v[104:107],v[112:115],v[144:147],v[104:107]
v_mfma_f32_16x16x32_bf16 v[72:75],v[116:119],a[164:167],v[72:75]
v_mfma_f32_16x16x32_bf16 v[80:83],v[116:119],a[188:191],v[80:83]
v_mfma_f32_16x16x32_bf16 v[88:91],v[116:119],a[212:215],v[88:91]
v_mfma_f32_16x16x32_bf16 v[96:99],v[116:119],a[236:239],v[96:99]
v_mfma_f32_16x16x32_bf16 v[104:107],v[116:119],v[148:151],v[104:107]
buffer_load_dwordx4 v7,s[4:7],s20 offen offset:1024 lds
v_mfma_f32_16x16x32_bf16 v[76:79],v[120:123],a[144:147],0
v_mfma_f32_16x16x32_bf16 v[84:87],v[120:123],a[168:171],0
v_mfma_f32_16x16x32_bf16 v[92:95],v[120:123],a[192:195],0
v_fma_f32 v72,v72,s36,v13
v_fma_f32 v73,v73,s36,v13
v_mfma_f32_16x16x32_bf16 v[100:103],v[120:123],a[216:219],0
v_fma_f32 v74,v74,s36,v13
v_fma_f32 v75,v75,s36,v13
v_mfma_f32_16x16x32_bf16 v[108:111],v[120:123],a[240:243],0
s_waitcnt lgkmcnt(0)
v_fma_f32 v80,v80,s36,v14
v_fma_f32 v81,v81,s36,v14
v_mfma_f32_16x16x32_bf16 v[76:79],v[124:127],a[148:151],v[76:79]
v_fma_f32 v82,v82,s36,v14
v_fma_f32 v83,v83,s36,v14
v_mfma_f32_16x16x32_bf16 v[84:87],v[124:127],a[172:175],v[84:87]
v_fma_f32 v88,v88,s36,v15
v_fma_f32 v89,v89,s36,v15
v_mfma_f32_16x16x32_bf16 v[92:95],v[124:127],a[196:199],v[92:95]
v_exp_f32 v72,v72
v_mfma_f32_16x16x32_bf16 v[100:103],v[124:127],a[220:223],v[100:103]
v_exp_f32 v73,v73
v_mfma_f32_16x16x32_bf16 v[108:111],v[124:127],a[244:247],v[108:111]
v_exp_f32 v74,v74
v_mfma_f32_16x16x32_bf16 v[76:79],v[128:131],a[152:155],v[76:79]
buffer_load_dwordx4 v8,s[4:7],s20 offen offset:2048 lds
v_mfma_f32_16x16x32_bf16 v[84:87],v[128:131],a[176:179],v[84:87]
s_add_u32 s20,s20,12288
v_exp_f32 v75,v75
v_mfma_f32_16x16x32_bf16 v[92:95],v[128:131],a[200:203],v[92:95]
v_exp_f32 v80,v80
v_mfma_f32_16x16x32_bf16 v[100:103],v[128:131],a[224:227],v[100:103]
v_exp_f32 v81,v81
v_mfma_f32_16x16x32_bf16 v[108:111],v[128:131],a[248:251],v[108:111]
v_exp_f32 v82,v82
v_mfma_f32_16x16x32_bf16 v[76:79],v[132:135],a[156:159],v[76:79]
ds_read_b64_tr_b16 v[112:113],v2 offset:18432
v_mfma_f32_16x16x32_bf16 v[84:87],v[132:135],a[180:183],v[84:87]
ds_read_b64_tr_b16 v[114:115],v2 offset:12288
v_cvt_pk_bf16_f32 v18,v72,v73
v_mfma_f32_16x16x32_bf16 v[92:95],v[132:135],a[204:207],v[92:95]
v_exp_f32 v83,v83
v_mfma_f32_16x16x32_bf16 v[100:103],v[132:135],a[228:231],v[100:103]
ds_read_b64_tr_b16 v[116:117],v3 offset:18432
ds_read_b64_tr_b16 v[118:119],v3 offset:12288
v_mfma_f32_16x16x32_bf16 v[108:111],v[132:135],a[252:255],v[108:111]
v_exp_f32 v88,v88
v_mfma_f32_16x16x32_bf16 v[76:79],v[136:139],a[160:163],v[76:79]
ds_read_b64_tr_b16 v[120:121],v4 offset:18432
v_mfma_f32_16x16x32_bf16 v[84:87],v[136:139],a[184:187],v[84:87]
ds_read_b64_tr_b16 v[122:123],v4 offset:12288
v_cvt_pk_bf16_f32 v19,v74,v75
v_mfma_f32_16x16x32_bf16 v[92:95],v[136:139],a[208:211],v[92:95]
v_exp_f32 v89,v89
v_mfma_f32_16x16x32_bf16 v[100:103],v[136:139],a[232:235],v[100:103]
ds_read_b64_tr_b16 v[124:125],v5 offset:18432
ds_read_b64_tr_b16 v[126:127],v5 offset:12288
v_mfma_f32_16x16x32_bf16 v[108:111],v[136:139],v[144:147],v[108:111]
v_cvt_pk_bf16_f32 v24,v80,v81
v_cvt_pk_bf16_f32 v25,v82,v83
v_mfma_f32_16x16x32_bf16 v[76:79],v[140:143],a[164:167],v[76:79]
v_cvt_pk_bf16_f32 v30,v88,v89
v_mfma_f32_16x16x32_bf16 v[84:87],v[140:143],a[188:191],v[84:87]
v_mfma_f32_16x16x32_bf16 v[92:95],v[140:143],a[212:215],v[92:95]
v_mfma_f32_16x16x32_bf16 v[100:103],v[140:143],a[236:239],v[100:103]
v_mfma_f32_16x16x32_bf16 v[108:111],v[140:143],v[148:151],v[108:111]
s_waitcnt lgkmcnt(3)
v_mfma_f32_16x16x32_bf16 v[160:163],v[112:115],v[20:23],v[160:163]
s_add_u32 m0,s23,12288
ds_read_b64_tr_b16 v[128:129],v2 offset:18560
ds_read_b64_tr_b16 v[130:131],v2 offset:12416
v_mfma_f32_16x16x32_bf16 v[208:211],v[112:115],v[26:29],v[208:211]
ds_read_b64_tr_b16 v[132:133],v3 offset:18560
ds_read_b64_tr_b16 v[134:135],v3 offset:12416
v_mfma_f32_16x16x32_bf16 a[0:3],v[112:115],v[32:35],a[0:3]
ds_read_b64_tr_b16 v[136:137],v4 offset:18560
ds_read_b64_tr_b16 v[138:139],v4 offset:12416
v_mfma_f32_16x16x32_bf16 a[48:51],v[112:115],v[38:41],a[48:51]
ds_read_b64_tr_b16 v[140:141],v5 offset:18560
ds_read_b64_tr_b16 v[142:143],v5 offset:12416
v_mfma_f32_16x16x32_bf16 a[96:99],v[112:115],v[44:47],a[96:99]
ds_read_b64_tr_b16 v[112:113],v2 offset:18688
ds_read_b64_tr_b16 v[114:115],v2 offset:12544
v_mfma_f32_16x16x32_bf16 v[164:167],v[116:119],v[20:23],v[164:167]
v_fma_f32 v90,v90,s36,v15
v_fma_f32 v91,v91,s36,v15
v_mfma_f32_16x16x32_bf16 v[212:215],v[116:119],v[26:29],v[212:215]
v_exp_f32 v90,v90
v_mfma_f32_16x16x32_bf16 a[4:7],v[116:119],v[32:35],a[4:7]
v_exp_f32 v91,v91
v_mfma_f32_16x16x32_bf16 a[52:55],v[116:119],v[38:41],a[52:55]
v_cvt_pk_bf16_f32 v31,v90,v91
v_fma_f32 v96,v96,s36,v16
v_mfma_f32_16x16x32_bf16 a[100:103],v[116:119],v[44:47],a[100:103]
s_waitcnt lgkmcnt(8)
ds_read_b64_tr_b16 v[116:117],v3 offset:18688
ds_read_b64_tr_b16 v[118:119],v3 offset:12544
v_mfma_f32_16x16x32_bf16 v[168:171],v[120:123],v[20:23],v[168:171]
v_fma_f32 v97,v97,s36,v16
v_fma_f32 v98,v98,s36,v16
v_mfma_f32_16x16x32_bf16 v[216:219],v[120:123],v[26:29],v[216:219]
v_fma_f32 v99,v99,s36,v16
v_fma_f32 v104,v104,s36,v17
v_mfma_f32_16x16x32_bf16 a[8:11],v[120:123],v[32:35],a[8:11]
v_exp_f32 v96,v96
v_mfma_f32_16x16x32_bf16 a[56:59],v[120:123],v[38:41],a[56:59]
v_exp_f32 v97,v97
v_mfma_f32_16x16x32_bf16 a[104:107],v[120:123],v[44:47],a[104:107]
ds_read_b64_tr_b16 v[120:121],v4 offset:18688
ds_read_b64_tr_b16 v[122:123],v4 offset:12544
v_mfma_f32_16x16x32_bf16 v[172:175],v[124:127],v[20:23],v[172:175]
v_exp_f32 v98,v98
v_mfma_f32_16x16x32_bf16 v[220:223],v[124:127],v[26:29],v[220:223]
v_exp_f32 v99,v99
v_mfma_f32_16x16x32_bf16 a[12:15],v[124:127],v[32:35],a[12:15]
v_cvt_pk_bf16_f32 v36,v96,v97
v_cvt_pk_bf16_f32 v37,v98,v99
v_mfma_f32_16x16x32_bf16 a[60:63],v[124:127],v[38:41],a[60:63]
v_fma_f32 v105,v105,s36,v17
v_fma_f32 v106,v106,s36,v17
v_mfma_f32_16x16x32_bf16 a[108:111],v[124:127],v[44:47],a[108:111]
ds_read_b64_tr_b16 v[124:125],v5 offset:18688
ds_read_b64_tr_b16 v[126:127],v5 offset:12544
v_mfma_f32_16x16x32_bf16 v[176:179],v[128:131],v[20:23],v[176:179]
v_fma_f32 v107,v107,s36,v17
v_fma_f32 v76,v76,s36,v13
v_mfma_f32_16x16x32_bf16 v[224:227],v[128:131],v[26:29],v[224:227]
v_exp_f32 v104,v104
v_mfma_f32_16x16x32_bf16 a[16:19],v[128:131],v[32:35],a[16:19]
v_exp_f32 v105,v105
v_mfma_f32_16x16x32_bf16 a[64:67],v[128:131],v[38:41],a[64:67]
v_exp_f32 v106,v106
v_mfma_f32_16x16x32_bf16 a[112:115],v[128:131],v[44:47],a[112:115]
s_waitcnt lgkmcnt(2)
v_exp_f32 v107,v107
v_mfma_f32_16x16x32_bf16 v[180:183],v[132:135],v[20:23],v[180:183]
v_cvt_pk_bf16_f32 v42,v104,v105
v_cvt_pk_bf16_f32 v43,v106,v107
v_mfma_f32_16x16x32_bf16 v[228:231],v[132:135],v[26:29],v[228:231]
v_fma_f32 v77,v77,s36,v13
v_fma_f32 v78,v78,s36,v13
v_mfma_f32_16x16x32_bf16 a[20:23],v[132:135],v[32:35],a[20:23]
v_fma_f32 v79,v79,s36,v13
v_fma_f32 v84,v84,s36,v14
v_mfma_f32_16x16x32_bf16 a[68:71],v[132:135],v[38:41],a[68:71]
v_exp_f32 v76,v76
v_mfma_f32_16x16x32_bf16 a[116:119],v[132:135],v[44:47],a[116:119]
v_exp_f32 v77,v77
v_mfma_f32_16x16x32_bf16 v[184:187],v[136:139],v[20:23],v[184:187]
v_exp_f32 v78,v78
v_mfma_f32_16x16x32_bf16 v[232:235],v[136:139],v[26:29],v[232:235]
v_exp_f32 v79,v79
v_mfma_f32_16x16x32_bf16 a[24:27],v[136:139],v[32:35],a[24:27]
v_fma_f32 v85,v85,s36,v14
v_fma_f32 v86,v86,s36,v14
v_mfma_f32_16x16x32_bf16 a[72:75],v[136:139],v[38:41],a[72:75]
v_fma_f32 v87,v87,s36,v14
v_fma_f32 v92,v92,s36,v15
v_mfma_f32_16x16x32_bf16 a[120:123],v[136:139],v[44:47],a[120:123]
v_exp_f32 v84,v84
v_mfma_f32_16x16x32_bf16 v[188:191],v[140:143],v[20:23],v[188:191]
v_exp_f32 v85,v85
v_mfma_f32_16x16x32_bf16 v[236:239],v[140:143],v[26:29],v[236:239]
v_exp_f32 v86,v86
v_mfma_f32_16x16x32_bf16 a[28:31],v[140:143],v[32:35],a[28:31]
v_exp_f32 v87,v87
v_mfma_f32_16x16x32_bf16 a[76:79],v[140:143],v[38:41],a[76:79]
v_fma_f32 v93,v93,s36,v15
v_fma_f32 v94,v94,s36,v15
v_mfma_f32_16x16x32_bf16 a[124:127],v[140:143],v[44:47],a[124:127]
v_fma_f32 v95,v95,s36,v15
v_fma_f32 v100,v100,s36,v16
v_mfma_f32_16x16x32_bf16 v[192:195],v[112:115],v[20:23],v[192:195]
v_exp_f32 v92,v92
v_mfma_f32_16x16x32_bf16 v[240:243],v[112:115],v[26:29],v[240:243]
v_exp_f32 v93,v93
s_waitcnt vmcnt(6) lgkmcnt(0)
v_mfma_f32_16x16x32_bf16 a[32:35],v[112:115],v[32:35],a[32:35]
s_barrier
v_mfma_f32_16x16x32_bf16 a[80:83],v[112:115],v[38:41],a[80:83]
ds_read_b128 v[128:131],v0 offset:0
v_fma_f32 v101,v101,s36,v16
v_mfma_f32_16x16x32_bf16 a[128:131],v[112:115],v[44:47],a[128:131]
ds_read_b128 v[132:135],v1 offset:0
v_fma_f32 v102,v102,s36,v16
v_mfma_f32_16x16x32_bf16 v[196:199],v[116:119],v[20:23],v[196:199]
ds_read_b128 v[136:139],v0 offset:128
v_fma_f32 v103,v103,s36,v16
v_mfma_f32_16x16x32_bf16 v[244:247],v[116:119],v[26:29],v[244:247]
ds_read_b128 v[140:143],v1 offset:128
v_fma_f32 v108,v108,s36,v17
v_mfma_f32_16x16x32_bf16 a[36:39],v[116:119],v[32:35],a[36:39]
ds_read_b128 v[112:115],v0 offset:256
v_fma_f32 v109,v109,s36,v17
v_mfma_f32_16x16x32_bf16 a[84:87],v[116:119],v[38:41],a[84:87]
buffer_load_dwordx4 v6,s[8:11],s21 offen offset:0 lds
v_mfma_f32_16x16x32_bf16 a[132:135],v[116:119],v[44:47],a[132:135]
ds_read_b128 v[116:119],v1 offset:256
v_fma_f32 v110,v110,s36,v17
v_mfma_f32_16x16x32_bf16 v[200:203],v[120:123],v[20:23],v[200:203]
v_exp_f32 v94,v94
v_mfma_f32_16x16x32_bf16 v[248:251],v[120:123],v[26:29],v[248:251]
v_exp_f32 v95,v95
v_mfma_f32_16x16x32_bf16 a[40:43],v[120:123],v[32:35],a[40:43]
v_exp_f32 v100,v100
v_mfma_f32_16x16x32_bf16 a[88:91],v[120:123],v[38:41],a[88:91]
v_exp_f32 v101,v101
v_mfma_f32_16x16x32_bf16 a[136:139],v[120:123],v[44:47],a[136:139]
ds_read_b128 v[120:123],v0 offset:6144
v_fma_f32 v111,v111,s36,v17
v_mfma_f32_16x16x32_bf16 v[204:207],v[124:127],v[20:23],v[204:207]
v_cvt_pk_bf16_f32 v20,v76,v77
v_cvt_pk_bf16_f32 v21,v78,v79
v_mfma_f32_16x16x32_bf16 v[252:255],v[124:127],v[26:29],v[252:255]
v_cvt_pk_bf16_f32 v26,v84,v85
v_cvt_pk_bf16_f32 v27,v86,v87
v_mfma_f32_16x16x32_bf16 v[52:55],v[48:51],v[18:21],v[52:55]
v_exp_f32 v102,v102
v_mfma_f32_16x16x32_bf16 v[56:59],v[48:51],v[24:27],v[56:59]
v_exp_f32 v103,v103
v_mfma_f32_16x16x32_bf16 a[44:47],v[124:127],v[32:35],a[44:47]
v_cvt_pk_bf16_f32 v32,v92,v93
v_cvt_pk_bf16_f32 v33,v94,v95
v_mfma_f32_16x16x32_bf16 a[92:95],v[124:127],v[38:41],a[92:95]
buffer_load_dwordx4 v7,s[8:11],s21 offen offset:1024 lds
v_mfma_f32_16x16x32_bf16 v[60:63],v[48:51],v[30:33],v[60:63]
v_cvt_pk_bf16_f32 v38,v100,v101
v_cvt_pk_bf16_f32 v39,v102,v103
v_mfma_f32_16x16x32_bf16 a[140:143],v[124:127],v[44:47],a[140:143]
ds_read_b128 v[124:127],v1 offset:6144
v_mfma_f32_16x16x32_bf16 v[64:67],v[48:51],v[36:39],v[64:67]
s_waitcnt lgkmcnt(1)
v_exp_f32 v108,v108
v_mfma_f32_16x16x32_bf16 v[72:75],v[128:131],a[144:147],0
v_exp_f32 v109,v109
v_mfma_f32_16x16x32_bf16 v[80:83],v[128:131],a[168:171],0
v_exp_f32 v110,v110
v_mfma_f32_16x16x32_bf16 v[88:91],v[128:131],a[192:195],0
v_exp_f32 v111,v111
v_mfma_f32_16x16x32_bf16 v[96:99],v[128:131],a[216:219],0
v_cvt_pk_bf16_f32 v44,v108,v109
v_cvt_pk_bf16_f32 v45,v110,v111
v_mfma_f32_16x16x32_bf16 v[104:107],v[128:131],a[240:243],0
ds_read_b128 v[128:131],v0 offset:6272
v_mfma_f32_16x16x32_bf16 v[68:71],v[48:51],v[42:45],v[68:71]
v_mfma_f32_16x16x32_bf16 v[72:75],v[132:135],a[148:151],v[72:75]
v_mfma_f32_16x16x32_bf16 v[80:83],v[132:135],a[172:175],v[80:83]
buffer_load_dwordx4 v8,s[8:11],s21 offen offset:2048 lds
v_mfma_f32_16x16x32_bf16 v[88:91],v[132:135],a[196:199],v[88:91]
s_add_u32 s21,s21,12288
v_mfma_f32_16x16x32_bf16 v[96:99],v[132:135],a[220:223],v[96:99]
s_add_u32 m0,s22,24576
v_mfma_f32_16x16x32_bf16 v[104:107],v[132:135],a[244:247],v[104:107]
ds_read_b128 v[132:135],v1 offset:6272
v_mfma_f32_16x16x32_bf16 v[72:75],v[136:139],a[152:155],v[72:75]
v_mfma_f32_16x16x32_bf16 v[80:83],v[136:139],a[176:179],v[80:83]
v_mfma_f32_16x16x32_bf16 v[88:91],v[136:139],a[200:203],v[88:91]
v_mfma_f32_16x16x32_bf16 v[96:99],v[136:139],a[224:227],v[96:99]
v_mfma_f32_16x16x32_bf16 v[104:107],v[136:139],a[248:251],v[104:107]
ds_read_b128 v[136:139],v0 offset:6400
v_mfma_f32_16x16x32_bf16 v[72:75],v[140:143],a[156:159],v[72:75]
v_mfma_f32_16x16x32_bf16 v[80:83],v[140:143],a[180:183],v[80:83]
v_mfma_f32_16x16x32_bf16 v[88:91],v[140:143],a[204:207],v[88:91]
buffer_load_dwordx4 v6,s[4:7],s20 offen offset:0 lds
v_mfma_f32_16x16x32_bf16 v[96:99],v[140:143],a[228:231],v[96:99]
v_mfma_f32_16x16x32_bf16 v[104:107],v[140:143],a[252:255],v[104:107]
ds_read_b128 v[140:143],v1 offset:6400
v_mfma_f32_16x16x32_bf16 v[72:75],v[112:115],a[160:163],v[72:75]
v_mfma_f32_16x16x32_bf16 v[80:83],v[112:115],a[184:187],v[80:83]
v_mfma_f32_16x16x32_bf16 v[88:91],v[112:115],a[208:211],v[88:91]
v_mfma_f32_16x16x32_bf16 v[96:99],v[112:115],a[232:235],v[96:99]
v_mfma_f32_16x16x32_bf16 v[104:107],v[112:115],v[144:147],v[104:107]
v_mfma_f32_16x16x32_bf16 v[72:75],v[116:119],a[164:167],v[72:75]
v_mfma_f32_16x16x32_bf16 v[80:83],v[116:119],a[188:191],v[80:83]
v_mfma_f32_16x16x32_bf16 v[88:91],v[116:119],a[212:215],v[88:91]
v_mfma_f32_16x16x32_bf16 v[96:99],v[116:119],a[236:239],v[96:99]
v_mfma_f32_16x16x32_bf16 v[104:107],v[116:119],v[148:151],v[104:107]
buffer_load_dwordx4 v7,s[4:7],s20 offen offset:1024 lds
v_mfma_f32_16x16x32_bf16 v[76:79],v[120:123],a[144:147],0
v_mfma_f32_16x16x32_bf16 v[84:87],v[120:123],a[168:171],0
v_mfma_f32_16x16x32_bf16 v[92:95],v[120:123],a[192:195],0
v_fma_f32 v72,v72,s36,v13
v_fma_f32 v73,v73,s36,v13
v_mfma_f32_16x16x32_bf16 v[100:103],v[120:123],a[216:219],0
v_fma_f32 v74,v74,s36,v13
v_fma_f32 v75,v75,s36,v13
v_mfma_f32_16x16x32_bf16 v[108:111],v[120:123],a[240:243],0
s_waitcnt lgkmcnt(0)
v_fma_f32 v80,v80,s36,v14
v_fma_f32 v81,v81,s36,v14
v_mfma_f32_16x16x32_bf16 v[76:79],v[124:127],a[148:151],v[76:79]
v_fma_f32 v82,v82,s36,v14
v_fma_f32 v83,v83,s36,v14
v_mfma_f32_16x16x32_bf16 v[84:87],v[124:127],a[172:175],v[84:87]
v_fma_f32 v88,v88,s36,v15
v_fma_f32 v89,v89,s36,v15
v_mfma_f32_16x16x32_bf16 v[92:95],v[124:127],a[196:199],v[92:95]
v_exp_f32 v72,v72
v_mfma_f32_16x16x32_bf16 v[100:103],v[124:127],a[220:223],v[100:103]
v_exp_f32 v73,v73
v_mfma_f32_16x16x32_bf16 v[108:111],v[124:127],a[244:247],v[108:111]
v_exp_f32 v74,v74
v_mfma_f32_16x16x32_bf16 v[76:79],v[128:131],a[152:155],v[76:79]
buffer_load_dwordx4 v8,s[4:7],s20 offen offset:2048 lds
v_mfma_f32_16x16x32_bf16 v[84:87],v[128:131],a[176:179],v[84:87]
s_add_u32 s20,s20,12288
v_exp_f32 v75,v75
v_mfma_f32_16x16x32_bf16 v[92:95],v[128:131],a[200:203],v[92:95]
v_exp_f32 v80,v80
v_mfma_f32_16x16x32_bf16 v[100:103],v[128:131],a[224:227],v[100:103]
v_exp_f32 v81,v81
v_mfma_f32_16x16x32_bf16 v[108:111],v[128:131],a[248:251],v[108:111]
v_exp_f32 v82,v82
v_mfma_f32_16x16x32_bf16 v[76:79],v[132:135],a[156:159],v[76:79]
ds_read_b64_tr_b16 v[112:113],v2 offset:24576
v_mfma_f32_16x16x32_bf16 v[84:87],v[132:135],a[180:183],v[84:87]
ds_read_b64_tr_b16 v[114:115],v2 offset:30720
v_cvt_pk_bf16_f32 v22,v72,v73
v_mfma_f32_16x16x32_bf16 v[92:95],v[132:135],a[204:207],v[92:95]
v_exp_f32 v83,v83
v_mfma_f32_16x16x32_bf16 v[100:103],v[132:135],a[228:231],v[100:103]
ds_read_b64_tr_b16 v[116:117],v3 offset:24576
ds_read_b64_tr_b16 v[118:119],v3 offset:30720
v_mfma_f32_16x16x32_bf16 v[108:111],v[132:135],a[252:255],v[108:111]
v_exp_f32 v88,v88
v_mfma_f32_16x16x32_bf16 v[76:79],v[136:139],a[160:163],v[76:79]
ds_read_b64_tr_b16 v[120:121],v4 offset:24576
v_mfma_f32_16x16x32_bf16 v[84:87],v[136:139],a[184:187],v[84:87]
ds_read_b64_tr_b16 v[122:123],v4 offset:30720
v_cvt_pk_bf16_f32 v23,v74,v75
v_mfma_f32_16x16x32_bf16 v[92:95],v[136:139],a[208:211],v[92:95]
v_exp_f32 v89,v89
v_mfma_f32_16x16x32_bf16 v[100:103],v[136:139],a[232:235],v[100:103]
ds_read_b64_tr_b16 v[124:125],v5 offset:24576
ds_read_b64_tr_b16 v[126:127],v5 offset:30720
v_mfma_f32_16x16x32_bf16 v[108:111],v[136:139],v[144:147],v[108:111]
v_cvt_pk_bf16_f32 v28,v80,v81
v_cvt_pk_bf16_f32 v29,v82,v83
v_mfma_f32_16x16x32_bf16 v[76:79],v[140:143],a[164:167],v[76:79]
v_cvt_pk_bf16_f32 v34,v88,v89
v_mfma_f32_16x16x32_bf16 v[84:87],v[140:143],a[188:191],v[84:87]
v_mfma_f32_16x16x32_bf16 v[92:95],v[140:143],a[212:215],v[92:95]
v_mfma_f32_16x16x32_bf16 v[100:103],v[140:143],a[236:239],v[100:103]
v_mfma_f32_16x16x32_bf16 v[108:111],v[140:143],v[148:151],v[108:111]
s_mov_b32 s38,0
s_branch L_loop5
L_start4:
s_add_u32 m0,s22,0
s_nop 0
buffer_load_dwordx4 v6,s[4:7],s20 offen offset:0 lds
buffer_load_dwordx4 v7,s[4:7],s20 offen offset:1024 lds
buffer_load_dwordx4 v8,s[4:7],s20 offen offset:2048 lds
s_add_u32 s20,s20,12288
s_mov_b32 s28,s41
s_add_u32 m0,s24,0
s_nop 0
buffer_load_dwordx4 v6,s[12:15],s28 offen offset:0 nt lds
buffer_load_dwordx4 v7,s[12:15],s28 offen offset:1024 nt lds
buffer_load_dwordx4 v8,s[12:15],s28 offen offset:2048 nt lds
s_add_u32 s28,s28,3072
s_add_u32 m0,s24,3072
s_nop 0
buffer_load_dwordx4 v6,s[12:15],s28 offen offset:0 nt lds
buffer_load_dwordx4 v7,s[12:15],s28 offen offset:1024 nt lds
buffer_load_dwordx4 v8,s[12:15],s28 offen offset:2048 nt lds
s_add_u32 s28,s28,3072
s_add_u32 m0,s24,6144
s_nop 0
buffer_load_dwordx4 v6,s[12:15],s28 offen offset:0 nt lds
buffer_load_dwordx4 v7,s[12:15],s28 offen offset:1024 nt lds
buffer_load_dwordx4 v8,s[12:15],s28 offen offset:2048 nt lds
s_add_u32 s28,s28,3072
s_add_u32 m0,s24,9216
s_nop 0
buffer_load_dwordx4 v6,s[12:15],s28 offen offset:0 nt lds
buffer_load_dwordx4 v7,s[12:15],s28 offen offset:1024 nt lds
buffer_load_dwordx4 v8,s[12:15],s28 offen offset:2048 nt lds
s_add_u32 s28,s28,3072
v_and_b32 v152,15,v156
v_lshrrev_b32 v153,4,v156
v_mul_u32_u24 v0,384,v152
v_and_b32 v155,6,v152
v_xor_b32 v155,v155,v153
v_lshl_add_u32 v0,v155,4,v0
v_xor_b32 v1,64,v0
v_add_u32 v11,s24,v0
v_add_u32 v12,s24,v1
v_lshrrev_b32 v152,2,v156
v_mul_u32_u24 v2,384,v152
v_and_b32 v152,6,v152
v_bfe_u32 v155,v156,1,1
v_xor_b32 v152,v152,v155
v_lshl_add_u32 v2,v152,4,v2
v_and_b32 v155,1,v156
v_lshl_add_u32 v2,v155,3,v2
v_add_u32 v2,36864,v2
v_xor_b32 v3,32,v2
v_xor_b32 v4,64,v2
v_xor_b32 v5,96,v2
v_lshrrev_b32 v152,3,v156
v_and_b32 v153,7,v156
v_xor_b32 v155,v153,v152
v_lshl_add_u32 v10,v152,7,s24
v_lshl_add_u32 v10,v155,4,v10
v_mul_u32_u24 v9,384,v152
v_lshl_add_u32 v9,v153,4,v9
v_mov_b32 v48,0x3f803f80
v_mov_b32 v49,0x3f803f80
v_mov_b32 v50,0x3f803f80
v_mov_b32 v51,0x3f803f80
s_waitcnt vmcnt(12)
s_barrier
s_waitcnt vmcnt(6)
ds_read_b128 a[144:147],v11 offset:0
ds_read_b128 v[112:115],v0 offset:0
ds_read_b128 a[148:151],v12 offset:0
ds_read_b128 a[152:155],v11 offset:128
ds_read_b128 a[156:159],v12 offset:128
ds_read_b128 a[160:163],v11 offset:256
ds_read_b128 a[164:167],v12 offset:256
s_add_u32 m0,s24,12288
ds_read_b128 v[116:119],v1 offset:0
ds_read_b128 v[120:123],v0 offset:128
ds_read_b128 v[124:127],v1 offset:128
s_waitcnt lgkmcnt(8)
v_mfma_f32_16x16x32_bf16 v[72:75],v[112:115],a[144:147],0
buffer_load_dwordx4 v6,s[12:15],s28 offen offset:0 nt lds
ds_read_b128 v[128:131],v0 offset:256
ds_read_b128 v[132:135],v1 offset:256
ds_read_b128 v[136:139],v0 offset:6144
ds_read_b128 v[140:143],v1 offset:6144
ds_read_b128 v[112:115],v0 offset:6272
s_waitcnt lgkmcnt(7)
v_mfma_f32_16x16x32_bf16 v[72:75],v[116:119],a[148:151],v[72:75]
buffer_load_dwordx4 v7,s[12:15],s28 offen offset:1024 nt lds
s_waitcnt lgkmcnt(6)
v_mfma_f32_16x16x32_bf16 v[72:75],v[120:123],a[152:155],v[72:75]
buffer_load_dwordx4 v8,s[12:15],s28 offen offset:2048 nt lds
s_add_u32 s28,s28,3072
s_add_u32 m0,s24,15360
s_waitcnt lgkmcnt(5)
v_mfma_f32_16x16x32_bf16 v[72:75],v[124:127],a[156:159],v[72:75]
buffer_load_dwordx4 v6,s[12:15],s28 offen offset:0 nt lds
s_waitcnt lgkmcnt(4)
v_mfma_f32_16x16x32_bf16 v[72:75],v[128:131],a[160:163],v[72:75]
buffer_load_dwordx4 v7,s[12:15],s28 offen offset:1024 nt lds
s_waitcnt lgkmcnt(3)
v_mfma_f32_16x16x32_bf16 v[72:75],v[132:135],a[164:167],v[72:75]
buffer_load_dwordx4 v8,s[12:15],s28 offen offset:2048 nt lds
s_add_u32 s28,s28,3072
s_add_u32 m0,s24,0
s_waitcnt lgkmcnt(0)
v_mfma_f32_16x16x32_bf16 v[76:79],v[136:139],a[144:147],0
ds_read_b128 v[116:119],v1 offset:6272
v_mfma_f32_16x16x32_bf16 v[76:79],v[140:143],a[148:151],v[76:79]
ds_read_b128 v[120:123],v0 offset:6400
v_mfma_f32_16x16x32_bf16 v[76:79],v[112:115],a[152:155],v[76:79]
ds_read_b128 v[124:127],v1 offset:6400
ds_read_b128 v[128:131],v0 offset:0
ds_read_b128 v[132:135],v1 offset:0
ds_read_b128 v[136:139],v0 offset:128
ds_read_b128 v[140:143],v1 offset:128
ds_read_b128 v[112:115],v0 offset:256
s_waitcnt lgkmcnt(7)
v_mfma_f32_16x16x32_bf16 v[76:79],v[116:119],a[156:159],v[76:79]
s_waitcnt lgkmcnt(6)
ds_read_b128 v[116:119],v1 offset:256
v_mfma_f32_16x16x32_bf16 v[76:79],v[120:123],a[160:163],v[76:79]
s_waitcnt lgkmcnt(6)
ds_read_b128 v[120:123],v0 offset:6144
v_mfma_f32_16x16x32_bf16 v[76:79],v[124:127],a[164:167],v[76:79]
s_waitcnt vmcnt(6)
ds_read_b128 a[168:171],v11 offset:6144
ds_read_b128 a[172:175],v12 offset:6144
ds_read_b128 a[176:179],v11 offset:6272
ds_read_b128 a[180:183],v12 offset:6272
ds_read_b128 a[184:187],v11 offset:6400
ds_read_b128 a[188:191],v12 offset:6400
ds_read_b128 v[124:127],v1 offset:6144
s_waitcnt lgkmcnt(6)
v_mfma_f32_16x16x32_bf16 v[80:83],v[128:131],a[168:171],0
buffer_load_dwordx4 v6,s[12:15],s28 offen offset:0 nt lds
s_waitcnt lgkmcnt(5)
v_mfma_f32_16x16x32_bf16 v[80:83],v[132:135],a[172:175],v[80:83]
buffer_load_dwordx4 v7,s[12:15],s28 offen offset:1024 nt lds
s_waitcnt lgkmcnt(4)
v_mfma_f32_16x16x32_bf16 v[80:83],v[136:139],a[176:179],v[80:83]
buffer_load_dwordx4 v8,s[12:15],s28 offen offset:2048 nt lds
s_add_u32 s28,s28,3072
s_add_u32 m0,s24,3072
s_waitcnt lgkmcnt(3)
v_mfma_f32_16x16x32_bf16 v[80:83],v[140:143],a[180:183],v[80:83]
buffer_load_dwordx4 v6,s[12:15],s28 offen offset:0 nt lds
s_waitcnt lgkmcnt(2)
v_mfma_f32_16x16x32_bf16 v[80:83],v[112:115],a[184:187],v[80:83]
buffer_load_dwordx4 v7,s[12:15],s28 offen offset:1024 nt lds
s_waitcnt lgkmcnt(1)
v_mfma_f32_16x16x32_bf16 v[80:83],v[116:119],a[188:191],v[80:83]
buffer_load_dwordx4 v8,s[12:15],s28 offen offset:2048 nt lds
s_add_u32 s28,s28,3072
s_add_u32 m0,s22,12288
v_mfma_f32_16x16x32_bf16 v[84:87],v[120:123],a[168:171],0
s_waitcnt lgkmcnt(0)
ds_read_b128 v[128:131],v0 offset:6272
v_mfma_f32_16x16x32_bf16 v[84:87],v[124:127],a[172:175],v[84:87]
ds_read_b128 v[132:135],v1 offset:6272
ds_read_b128 v[136:139],v0 offset:6400
ds_read_b128 v[140:143],v1 offset:6400
ds_read_b128 v[112:115],v0 offset:0
ds_read_b128 v[116:119],v1 offset:0
ds_read_b128 v[120:123],v0 offset:128
ds_read_b128 v[124:127],v1 offset:128
s_waitcnt lgkmcnt(7)
v_mfma_f32_16x16x32_bf16 v[84:87],v[128:131],a[176:179],v[84:87]
s_waitcnt lgkmcnt(6)
ds_read_b128 v[128:131],v0 offset:256
v_mfma_f32_16x16x32_bf16 v[84:87],v[132:135],a[180:183],v[84:87]
s_waitcnt lgkmcnt(6)
ds_read_b128 v[132:135],v1 offset:256
v_mfma_f32_16x16x32_bf16 v[84:87],v[136:139],a[184:187],v[84:87]
s_waitcnt lgkmcnt(6)
ds_read_b128 v[136:139],v0 offset:6144
v_mfma_f32_16x16x32_bf16 v[84:87],v[140:143],a[188:191],v[84:87]
s_waitcnt vmcnt(6)
ds_read_b128 a[192:195],v11 offset:12288
ds_read_b128 a[196:199],v12 offset:12288
ds_read_b128 a[200:203],v11 offset:12416
ds_read_b128 a[204:207],v12 offset:12416
ds_read_b128 a[208:211],v11 offset:12544
ds_read_b128 a[212:215],v12 offset:12544
ds_read_b128 v[140:143],v1 offset:6144
s_waitcnt lgkmcnt(6)
v_mfma_f32_16x16x32_bf16 v[88:91],v[112:115],a[192:195],0
buffer_load_dwordx4 v6,s[4:7],s20 offen offset:0 lds
s_waitcnt lgkmcnt(5)
v_mfma_f32_16x16x32_bf16 v[88:91],v[116:119],a[196:199],v[88:91]
buffer_load_dwordx4 v7,s[4:7],s20 offen offset:1024 lds
s_waitcnt lgkmcnt(4)
v_mfma_f32_16x16x32_bf16 v[88:91],v[120:123],a[200:203],v[88:91]
buffer_load_dwordx4 v8,s[4:7],s20 offen offset:2048 lds
s_add_u32 s20,s20,12288
s_add_u32 m0,s23,0
s_waitcnt lgkmcnt(3)
v_mfma_f32_16x16x32_bf16 v[88:91],v[124:127],a[204:207],v[88:91]
s_waitcnt lgkmcnt(2)
ds_read_b128 v[112:115],v0 offset:6272
v_mfma_f32_16x16x32_bf16 v[88:91],v[128:131],a[208:211],v[88:91]
s_waitcnt lgkmcnt(2)
ds_read_b128 v[116:119],v1 offset:6272
v_mfma_f32_16x16x32_bf16 v[88:91],v[132:135],a[212:215],v[88:91]
ds_read_b128 v[120:123],v0 offset:6400
v_mfma_f32_16x16x32_bf16 v[92:95],v[136:139],a[192:195],0
s_waitcnt lgkmcnt(3)
ds_read_b128 v[124:127],v1 offset:6400
v_mfma_f32_16x16x32_bf16 v[92:95],v[140:143],a[196:199],v[92:95]
ds_read_b128 v[128:131],v0 offset:0
ds_read_b128 v[132:135],v1 offset:0
ds_read_b128 v[136:139],v0 offset:128
ds_read_b128 v[140:143],v1 offset:128
s_waitcnt lgkmcnt(7)
v_mfma_f32_16x16x32_bf16 v[92:95],v[112:115],a[200:203],v[92:95]
s_waitcnt lgkmcnt(6)
ds_read_b128 v[112:115],v0 offset:256
v_mfma_f32_16x16x32_bf16 v[92:95],v[116:119],a[204:207],v[92:95]
s_waitcnt lgkmcnt(6)
ds_read_b128 v[116:119],v1 offset:256
v_mfma_f32_16x16x32_bf16 v[92:95],v[120:123],a[208:211],v[92:95]
s_waitcnt lgkmcnt(6)
ds_read_b128 v[120:123],v0 offset:6144
v_mfma_f32_16x16x32_bf16 v[92:95],v[124:127],a[212:215],v[92:95]
s_waitcnt vmcnt(3)
ds_read_b128 a[216:219],v11 offset:0
ds_read_b128 a[220:223],v12 offset:0
ds_read_b128 a[224:227],v11 offset:128
ds_read_b128 a[228:231],v12 offset:128
ds_read_b128 a[232:235],v11 offset:256
ds_read_b128 a[236:239],v12 offset:256
ds_read_b128 v[124:127],v1 offset:6144
s_waitcnt lgkmcnt(6)
v_mfma_f32_16x16x32_bf16 v[96:99],v[128:131],a[216:219],0
buffer_load_dwordx4 v6,s[8:11],s21 offen offset:0 lds
s_waitcnt lgkmcnt(5)
v_mfma_f32_16x16x32_bf16 v[96:99],v[132:135],a[220:223],v[96:99]
buffer_load_dwordx4 v7,s[8:11],s21 offen offset:1024 lds
s_waitcnt lgkmcnt(4)
v_mfma_f32_16x16x32_bf16 v[96:99],v[136:139],a[224:227],v[96:99]
buffer_load_dwordx4 v8,s[8:11],s21 offen offset:2048 lds
s_add_u32 s21,s21,12288
s_waitcnt lgkmcnt(3)
v_mfma_f32_16x16x32_bf16 v[96:99],v[140:143],a[228:231],v[96:99]
s_mov_b32 s27,166723584
ds_read_b128 v[128:131],v0 offset:6272
s_mov_b32 s42,s41
s_waitcnt lgkmcnt(3)
v_mfma_f32_16x16x32_bf16 v[96:99],v[112:115],a[232:235],v[96:99]
s_add_u32 s69,s69,1
ds_read_b128 v[132:135],v1 offset:6272
s_lshl_b32 s62,s69,5
s_waitcnt lgkmcnt(3)
v_mfma_f32_16x16x32_bf16 v[96:99],v[116:119],a[236:239],v[96:99]
s_add_u32 s62,s62,s34
ds_read_b128 v[136:139],v0 offset:6400
s_mul_i32 s63,s62,171
v_mfma_f32_16x16x32_bf16 v[100:103],v[120:123],a[216:219],0
s_lshr_b32 s63,s63,9
ds_read_b128 v[140:143],v1 offset:6400
s_mul_i32 s64,s63,3
s_waitcnt lgkmcnt(4)
v_mfma_f32_16x16x32_bf16 v[100:103],v[124:127],a[220:223],v[100:103]
s_sub_u32 s62,s62,s64
s_add_u32 s63,s63,s33
s_mul_i32 s30,s63,196608
s_mul_i32 s41,s63,325632
s_lshl_b32 s63,s3,2
s_add_u32 s64,s63,21
s_cmp_eq_u32 s3,0
s_cselect_b32 s64,20,s64
s_cselect_b32 s40,1,0
s_add_u32 s65,s63,37
s_cmp_eq_u32 s62,2
s_cselect_b32 s64,s65,s64
s_cselect_b32 s40,0,s40
s_add_u32 s65,s63,s3
s_cmp_eq_u32 s62,0
s_cselect_b32 s64,s65,s64
s_cselect_b32 s40,1,s40
s_mul_i32 s64,s64,6144
s_add_u32 s41,s41,s64
s_cmp_ge_u32 s69,6
s_waitcnt lgkmcnt(3)
v_mfma_f32_16x16x32_bf16 v[100:103],v[128:131],a[224:227],v[100:103]
s_cselect_b32 s41,166723584,s41
s_cselect_b32 s30,100663296,s30
s_add_u32 s25,s30,s22
s_waitcnt lgkmcnt(2)
v_mfma_f32_16x16x32_bf16 v[100:103],v[132:135],a[228:231],v[100:103]
s_add_u32 s26,s25,12288
s_mov_b32 s28,s41
s_mov_b32 s29,s24
s_waitcnt lgkmcnt(1)
v_mfma_f32_16x16x32_bf16 v[100:103],v[136:139],a[232:235],v[100:103]
s_waitcnt lgkmcnt(0)
v_mfma_f32_16x16x32_bf16 v[100:103],v[140:143],a[236:239],v[100:103]
s_waitcnt vmcnt(3)
s_barrier
ds_read_b128 v[128:131],v0 offset:12288
ds_read_b128 v[132:135],v1 offset:12288
v_max3_f32 v20,v72,v73,v74
ds_read_b128 v[136:139],v0 offset:12416
v_max3_f32 v20,v20,v75,v76
ds_read_b128 v[140:143],v1 offset:12416
v_max3_f32 v20,v20,v77,v78
ds_read_b128 v[112:115],v0 offset:12544
v_max_f32 v20,v20,v79
ds_read_b128 v[116:119],v1 offset:12544
v_max3_f32 v26,v80,v81,v82
ds_read_b128 v[120:123],v0 offset:18432
v_mov_b32 v21,v20
ds_read_b128 v[124:127],v1 offset:18432
v_max3_f32 v26,v26,v83,v84
v_permlane32_swap_b32 v21,v20
v_max3_f32 v26,v26,v85,v86
v_max_f32 v20,v20,v21
v_max_f32 v26,v26,v87
v_mov_b32 v21,v20
v_max3_f32 v32,v88,v89,v90
v_mov_b32 v27,v26
v_permlane16_swap_b32 v21,v20
v_max3_f32 v32,v32,v91,v92
v_permlane32_swap_b32 v27,v26
v_max_f32 v20,v20,v21
v_max3_f32 v32,v32,v93,v94
v_max_f32 v26,v26,v27
v_mul_f32_e64 v13,-s36,v20
v_max_f32 v32,v32,v95
v_mov_b32 v27,v26
v_fma_f32 v72,v72,s36,v13
v_fma_f32 v73,v73,s36,v13
v_fma_f32 v74,v74,s36,v13
v_fma_f32 v75,v75,s36,v13
v_max3_f32 v38,v96,v97,v98
v_mov_b32 v33,v32
v_permlane16_swap_b32 v27,v26
v_exp_f32 v72,v72
v_exp_f32 v73,v73
v_exp_f32 v74,v74
v_exp_f32 v75,v75
v_max3_f32 v38,v38,v99,v100
v_permlane32_swap_b32 v33,v32
v_max_f32 v26,v26,v27
v_max3_f32 v38,v38,v101,v102
v_max_f32 v32,v32,v33
v_mul_f32_e64 v14,-s36,v26
v_cvt_pk_bf16_f32 v18,v72,v73
v_cvt_pk_bf16_f32 v19,v74,v75
s_waitcnt lgkmcnt(0)
v_mfma_f32_16x16x32_bf16 v[72:75],v[128:131],a[144:147],0
s_add_u32 m0,s22,24576
v_max_f32 v38,v38,v103
buffer_load_dwordx4 v6,s[4:7],s20 offen offset:0 lds
buffer_load_dwordx4 v7,s[4:7],s20 offen offset:1024 lds
buffer_load_dwordx4 v8,s[4:7],s20 offen offset:2048 lds
v_mov_b32 v33,v32
v_fma_f32 v80,v80,s36,v14
v_fma_f32 v81,v81,s36,v14
v_fma_f32 v82,v82,s36,v14
v_fma_f32 v83,v83,s36,v14
v_mov_b32 v39,v38
v_permlane16_swap_b32 v33,v32
v_exp_f32 v80,v80
v_exp_f32 v81,v81
v_exp_f32 v82,v82
v_exp_f32 v83,v83
v_permlane32_swap_b32 v39,v38
v_max_f32 v32,v32,v33
v_max_f32 v38,v38,v39
v_mul_f32_e64 v15,-s36,v32
v_cvt_pk_bf16_f32 v24,v80,v81
v_cvt_pk_bf16_f32 v25,v82,v83
v_mfma_f32_16x16x32_bf16 v[80:83],v[128:131],a[168:171],0
s_add_u32 s20,s20,12288
v_mov_b32 v39,v38
v_fma_f32 v88,v88,s36,v15
v_fma_f32 v89,v89,s36,v15
v_fma_f32 v90,v90,s36,v15
v_fma_f32 v91,v91,s36,v15
v_permlane16_swap_b32 v39,v38
v_exp_f32 v88,v88
v_exp_f32 v89,v89
v_exp_f32 v90,v90
v_exp_f32 v91,v91
v_max_f32 v38,v38,v39
v_mul_f32_e64 v16,-s36,v38
v_cvt_pk_bf16_f32 v30,v88,v89
v_cvt_pk_bf16_f32 v31,v90,v91
v_mfma_f32_16x16x32_bf16 v[88:91],v[128:131],a[192:195],0
s_add_u32 m0,s23,12288
v_fma_f32 v96,v96,s36,v16
buffer_load_dwordx4 v6,s[8:11],s21 offen offset:0 lds
v_fma_f32 v97,v97,s36,v16
v_fma_f32 v98,v98,s36,v16
buffer_load_dwordx4 v7,s[8:11],s21 offen offset:1024 lds
v_fma_f32 v99,v99,s36,v16
v_exp_f32 v96,v96
v_exp_f32 v97,v97
v_exp_f32 v98,v98
v_exp_f32 v99,v99
v_cvt_pk_bf16_f32 v36,v96,v97
v_cvt_pk_bf16_f32 v37,v98,v99
v_mfma_f32_16x16x32_bf16 v[96:99],v[128:131],a[216:219],0
ds_read_b128 v[128:131],v0 offset:18560
v_fma_f32 v76,v76,s36,v13
v_mfma_f32_16x16x32_bf16 v[72:75],v[132:135],a[148:151],v[72:75]
v_fma_f32 v77,v77,s36,v13
v_fma_f32 v78,v78,s36,v13
v_mfma_f32_16x16x32_bf16 v[80:83],v[132:135],a[172:175],v[80:83]
v_fma_f32 v79,v79,s36,v13
v_exp_f32 v76,v76
v_mfma_f32_16x16x32_bf16 v[88:91],v[132:135],a[196:199],v[88:91]
v_exp_f32 v77,v77
v_mfma_f32_16x16x32_bf16 v[96:99],v[132:135],a[220:223],v[96:99]
buffer_load_dwordx4 v8,s[8:11],s21 offen offset:2048 lds
v_mfma_f32_16x16x32_bf16 v[72:75],v[136:139],a[152:155],v[72:75]
s_add_u32 s21,s21,12288
ds_read_b128 v[132:135],v1 offset:18560
v_exp_f32 v78,v78
v_mfma_f32_16x16x32_bf16 v[80:83],v[136:139],a[176:179],v[80:83]
s_add_u32 m0,s23,24576
v_exp_f32 v79,v79
v_mfma_f32_16x16x32_bf16 v[88:91],v[136:139],a[200:203],v[88:91]
v_fma_f32 v84,v84,s36,v14
v_fma_f32 v85,v85,s36,v14
v_mfma_f32_16x16x32_bf16 v[96:99],v[136:139],a[224:227],v[96:99]
ds_read_b128 v[136:139],v0 offset:18688
v_fma_f32 v86,v86,s36,v14
v_mfma_f32_16x16x32_bf16 v[72:75],v[140:143],a[156:159],v[72:75]
v_fma_f32 v87,v87,s36,v14
v_cvt_pk_bf16_f32 v20,v76,v77
v_mfma_f32_16x16x32_bf16 v[80:83],v[140:143],a[180:183],v[80:83]
v_cvt_pk_bf16_f32 v21,v78,v79
v_exp_f32 v84,v84
v_mfma_f32_16x16x32_bf16 v[88:91],v[140:143],a[204:207],v[88:91]
v_exp_f32 v85,v85
v_mfma_f32_16x16x32_bf16 v[52:55],v[48:51],v[18:21],0
buffer_load_dwordx4 v6,s[8:11],s21 offen offset:0 lds
v_mfma_f32_16x16x32_bf16 v[96:99],v[140:143],a[228:231],v[96:99]
ds_read_b128 v[140:143],v1 offset:18688
v_exp_f32 v86,v86
v_mfma_f32_16x16x32_bf16 v[72:75],v[112:115],a[160:163],v[72:75]
v_exp_f32 v87,v87
v_mfma_f32_16x16x32_bf16 v[80:83],v[112:115],a[184:187],v[80:83]
v_fma_f32 v92,v92,s36,v15
v_fma_f32 v93,v93,s36,v15
v_mfma_f32_16x16x32_bf16 v[88:91],v[112:115],a[208:211],v[88:91]
v_fma_f32 v94,v94,s36,v15
v_fma_f32 v95,v95,s36,v15
v_mfma_f32_16x16x32_bf16 v[96:99],v[112:115],a[232:235],v[96:99]
v_cvt_pk_bf16_f32 v26,v84,v85
v_cvt_pk_bf16_f32 v27,v86,v87
v_mfma_f32_16x16x32_bf16 v[72:75],v[116:119],a[164:167],v[72:75]
v_exp_f32 v92,v92
v_mfma_f32_16x16x32_bf16 v[56:59],v[48:51],v[24:27],0
v_exp_f32 v93,v93
v_mfma_f32_16x16x32_bf16 v[80:83],v[116:119],a[188:191],v[80:83]
buffer_load_dwordx4 v7,s[8:11],s21 offen offset:1024 lds
v_mfma_f32_16x16x32_bf16 v[88:91],v[116:119],a[212:215],v[88:91]
v_exp_f32 v94,v94
v_mfma_f32_16x16x32_bf16 v[96:99],v[116:119],a[236:239],v[96:99]
v_exp_f32 v95,v95
v_mfma_f32_16x16x32_bf16 v[76:79],v[120:123],a[144:147],0
v_fma_f32 v100,v100,s36,v16
v_fma_f32 v101,v101,s36,v16
v_mfma_f32_16x16x32_bf16 v[84:87],v[120:123],a[168:171],0
v_fma_f32 v102,v102,s36,v16
v_fma_f32 v103,v103,s36,v16
v_cvt_pk_bf16_f32 v32,v92,v93
v_cvt_pk_bf16_f32 v33,v94,v95
v_mfma_f32_16x16x32_bf16 v[92:95],v[120:123],a[192:195],0
v_exp_f32 v100,v100
v_mfma_f32_16x16x32_bf16 v[60:63],v[48:51],v[30:33],0
v_exp_f32 v101,v101
buffer_load_dwordx4 v8,s[8:11],s21 offen offset:2048 lds
v_exp_f32 v102,v102
v_exp_f32 v103,v103
v_cvt_pk_bf16_f32 v38,v100,v101
v_cvt_pk_bf16_f32 v39,v102,v103
v_mfma_f32_16x16x32_bf16 v[100:103],v[120:123],a[216:219],0
s_add_u32 s21,s21,12288
v_fma_f32 v72,v72,s36,v13
v_fma_f32 v73,v73,s36,v13
s_waitcnt vmcnt(9)
s_barrier
v_mfma_f32_16x16x32_bf16 v[64:67],v[48:51],v[36:39],0
s_add_u32 m0,s22,0
v_fma_f32 v74,v74,s36,v13
v_fma_f32 v75,v75,s36,v13
v_mfma_f32_16x16x32_bf16 v[76:79],v[124:127],a[148:151],v[76:79]
buffer_load_dwordx4 v6,s[4:7],s20 offen offset:0 lds
v_mfma_f32_16x16x32_bf16 v[84:87],v[124:127],a[172:175],v[84:87]
v_fma_f32 v80,v80,s36,v14
v_fma_f32 v81,v81,s36,v14
v_mfma_f32_16x16x32_bf16 v[92:95],v[124:127],a[196:199],v[92:95]
v_exp_f32 v72,v72
v_mfma_f32_16x16x32_bf16 v[100:103],v[124:127],a[220:223],v[100:103]
s_waitcnt lgkmcnt(0)
v_exp_f32 v73,v73
v_mfma_f32_16x16x32_bf16 v[76:79],v[128:131],a[152:155],v[76:79]
v_exp_f32 v74,v74
v_mfma_f32_16x16x32_bf16 v[84:87],v[128:131],a[176:179],v[84:87]
buffer_load_dwordx4 v7,s[4:7],s20 offen offset:1024 lds
v_mfma_f32_16x16x32_bf16 v[92:95],v[128:131],a[200:203],v[92:95]
v_exp_f32 v75,v75
v_mfma_f32_16x16x32_bf16 v[100:103],v[128:131],a[224:227],v[100:103]
v_exp_f32 v80,v80
v_mfma_f32_16x16x32_bf16 v[76:79],v[132:135],a[156:159],v[76:79]
v_exp_f32 v81,v81
v_mfma_f32_16x16x32_bf16 v[84:87],v[132:135],a[180:183],v[84:87]
ds_read_b64_tr_b16 v[112:113],v2 offset:0
ds_read_b64_tr_b16 v[114:115],v2 offset:6144
v_mfma_f32_16x16x32_bf16 v[92:95],v[132:135],a[204:207],v[92:95]
v_cvt_pk_bf16_f32 v22,v72,v73
v_cvt_pk_bf16_f32 v23,v74,v75
v_mfma_f32_16x16x32_bf16 v[100:103],v[132:135],a[228:231],v[100:103]
buffer_load_dwordx4 v8,s[4:7],s20 offen offset:2048 lds
v_mfma_f32_16x16x32_bf16 v[76:79],v[136:139],a[160:163],v[76:79]
s_add_u32 s20,s20,12288
ds_read_b64_tr_b16 v[116:117],v3 offset:0
ds_read_b64_tr_b16 v[118:119],v3 offset:6144
v_mfma_f32_16x16x32_bf16 v[84:87],v[136:139],a[184:187],v[84:87]
ds_read_b64_tr_b16 v[120:121],v4 offset:0
ds_read_b64_tr_b16 v[122:123],v4 offset:6144
v_mfma_f32_16x16x32_bf16 v[92:95],v[136:139],a[208:211],v[92:95]
v_cvt_pk_bf16_f32 v28,v80,v81
v_mfma_f32_16x16x32_bf16 v[100:103],v[136:139],a[232:235],v[100:103]
ds_read_b64_tr_b16 v[124:125],v5 offset:0
ds_read_b64_tr_b16 v[126:127],v5 offset:6144
v_mfma_f32_16x16x32_bf16 v[76:79],v[140:143],a[164:167],v[76:79]
v_mfma_f32_16x16x32_bf16 v[84:87],v[140:143],a[188:191],v[84:87]
v_mfma_f32_16x16x32_bf16 v[92:95],v[140:143],a[212:215],v[92:95]
v_mfma_f32_16x16x32_bf16 v[100:103],v[140:143],a[236:239],v[100:103]
s_waitcnt lgkmcnt(6)
v_mfma_f32_16x16x32_bf16 v[160:163],v[112:115],v[18:21],0
s_add_u32 m0,s23,0
ds_read_b64_tr_b16 v[128:129],v2 offset:128
ds_read_b64_tr_b16 v[130:131],v2 offset:6272
v_mfma_f32_16x16x32_bf16 v[208:211],v[112:115],v[24:27],0
ds_read_b64_tr_b16 v[132:133],v3 offset:128
ds_read_b64_tr_b16 v[134:135],v3 offset:6272
v_mfma_f32_16x16x32_bf16 a[0:3],v[112:115],v[30:33],0
ds_read_b64_tr_b16 v[136:137],v4 offset:128
ds_read_b64_tr_b16 v[138:139],v4 offset:6272
v_mfma_f32_16x16x32_bf16 a[48:51],v[112:115],v[36:39],0
s_waitcnt lgkmcnt(8)
ds_read_b64_tr_b16 v[140:141],v5 offset:128
ds_read_b64_tr_b16 v[142:143],v5 offset:6272
v_mfma_f32_16x16x32_bf16 v[164:167],v[116:119],v[18:21],0
ds_read_b64_tr_b16 v[112:113],v2 offset:256
ds_read_b64_tr_b16 v[114:115],v2 offset:6400
v_mfma_f32_16x16x32_bf16 v[212:215],v[116:119],v[24:27],0
v_fma_f32 v82,v82,s36,v14
v_fma_f32 v83,v83,s36,v14
v_mfma_f32_16x16x32_bf16 a[4:7],v[116:119],v[30:33],0
v_exp_f32 v82,v82
v_mfma_f32_16x16x32_bf16 a[52:55],v[116:119],v[36:39],0
ds_read_b64_tr_b16 v[116:117],v3 offset:256
ds_read_b64_tr_b16 v[118:119],v3 offset:6400
v_mfma_f32_16x16x32_bf16 v[168:171],v[120:123],v[18:21],0
v_exp_f32 v83,v83
v_mfma_f32_16x16x32_bf16 v[216:219],v[120:123],v[24:27],0
v_cvt_pk_bf16_f32 v29,v82,v83
v_fma_f32 v88,v88,s36,v15
v_mfma_f32_16x16x32_bf16 a[8:11],v[120:123],v[30:33],0
v_fma_f32 v89,v89,s36,v15
v_fma_f32 v90,v90,s36,v15
v_mfma_f32_16x16x32_bf16 a[56:59],v[120:123],v[36:39],0
s_waitcnt lgkmcnt(5)
ds_read_b64_tr_b16 v[120:121],v4 offset:256
ds_read_b64_tr_b16 v[122:123],v4 offset:6400
v_mfma_f32_16x16x32_bf16 v[172:175],v[124:127],v[18:21],0
v_fma_f32 v91,v91,s36,v15
v_fma_f32 v96,v96,s36,v16
v_mfma_f32_16x16x32_bf16 v[220:223],v[124:127],v[24:27],0
v_exp_f32 v88,v88
v_mfma_f32_16x16x32_bf16 a[12:15],v[124:127],v[30:33],0
v_exp_f32 v89,v89
v_mfma_f32_16x16x32_bf16 a[60:63],v[124:127],v[36:39],0
ds_read_b64_tr_b16 v[124:125],v5 offset:256
ds_read_b64_tr_b16 v[126:127],v5 offset:6400
v_mfma_f32_16x16x32_bf16 v[176:179],v[128:131],v[18:21],0
v_exp_f32 v90,v90
v_mfma_f32_16x16x32_bf16 v[224:227],v[128:131],v[24:27],0
v_exp_f32 v91,v91
v_mfma_f32_16x16x32_bf16 a[16:19],v[128:131],v[30:33],0
v_cvt_pk_bf16_f32 v34,v88,v89
v_cvt_pk_bf16_f32 v35,v90,v91
v_mfma_f32_16x16x32_bf16 a[64:67],v[128:131],v[36:39],0
v_fma_f32 v97,v97,s36,v16
v_fma_f32 v98,v98,s36,v16
v_mfma_f32_16x16x32_bf16 v[180:183],v[132:135],v[18:21],0
v_fma_f32 v99,v99,s36,v16
v_fma_f32 v76,v76,s36,v13
v_mfma_f32_16x16x32_bf16 v[228:231],v[132:135],v[24:27],0
v_exp_f32 v96,v96
v_mfma_f32_16x16x32_bf16 a[20:23],v[132:135],v[30:33],0
v_exp_f32 v97,v97
v_mfma_f32_16x16x32_bf16 a[68:71],v[132:135],v[36:39],0
v_exp_f32 v98,v98
v_mfma_f32_16x16x32_bf16 v[184:187],v[136:139],v[18:21],0
v_exp_f32 v99,v99
v_mfma_f32_16x16x32_bf16 v[232:235],v[136:139],v[24:27],0
v_cvt_pk_bf16_f32 v40,v96,v97
v_cvt_pk_bf16_f32 v41,v98,v99
v_mfma_f32_16x16x32_bf16 a[24:27],v[136:139],v[30:33],0
v_fma_f32 v77,v77,s36,v13
v_fma_f32 v78,v78,s36,v13
v_mfma_f32_16x16x32_bf16 a[72:75],v[136:139],v[36:39],0
s_waitcnt lgkmcnt(0)
v_fma_f32 v79,v79,s36,v13
v_fma_f32 v84,v84,s36,v14
v_mfma_f32_16x16x32_bf16 v[188:191],v[140:143],v[18:21],0
v_exp_f32 v76,v76
v_mfma_f32_16x16x32_bf16 v[236:239],v[140:143],v[24:27],0
v_exp_f32 v77,v77
v_mfma_f32_16x16x32_bf16 a[28:31],v[140:143],v[30:33],0
v_exp_f32 v78,v78
v_mfma_f32_16x16x32_bf16 a[76:79],v[140:143],v[36:39],0
v_exp_f32 v79,v79
v_mfma_f32_16x16x32_bf16 v[192:195],v[112:115],v[18:21],0
v_fma_f32 v85,v85,s36,v14
v_fma_f32 v86,v86,s36,v14
s_waitcnt vmcnt(6)
v_mfma_f32_16x16x32_bf16 v[240:243],v[112:115],v[24:27],0
s_barrier
v_mfma_f32_16x16x32_bf16 a[32:35],v[112:115],v[30:33],0
ds_read_b128 v[128:131],v0 offset:24576
v_fma_f32 v87,v87,s36,v14
v_mfma_f32_16x16x32_bf16 a[80:83],v[112:115],v[36:39],0
ds_read_b128 v[132:135],v1 offset:24576
v_fma_f32 v92,v92,s36,v15
v_mfma_f32_16x16x32_bf16 v[196:199],v[116:119],v[18:21],0
ds_read_b128 v[136:139],v0 offset:24704
v_fma_f32 v93,v93,s36,v15
v_mfma_f32_16x16x32_bf16 v[244:247],v[116:119],v[24:27],0
ds_read_b128 v[140:143],v1 offset:24704
v_fma_f32 v94,v94,s36,v15
v_mfma_f32_16x16x32_bf16 a[36:39],v[116:119],v[30:33],0
ds_read_b128 v[112:115],v0 offset:24832
v_fma_f32 v95,v95,s36,v15
v_mfma_f32_16x16x32_bf16 a[84:87],v[116:119],v[36:39],0
buffer_load_dwordx4 v6,s[8:11],s21 offen offset:0 lds
v_mfma_f32_16x16x32_bf16 v[200:203],v[120:123],v[18:21],0
ds_read_b128 v[116:119],v1 offset:24832
v_fma_f32 v100,v100,s36,v16
v_mfma_f32_16x16x32_bf16 v[248:251],v[120:123],v[24:27],0
v_exp_f32 v84,v84
v_mfma_f32_16x16x32_bf16 a[40:43],v[120:123],v[30:33],0
v_exp_f32 v85,v85
v_mfma_f32_16x16x32_bf16 a[88:91],v[120:123],v[36:39],0
ds_read_b128 v[120:123],v0 offset:30720
v_fma_f32 v101,v101,s36,v16
v_mfma_f32_16x16x32_bf16 v[204:207],v[124:127],v[18:21],0
v_cvt_pk_bf16_f32 v20,v76,v77
v_cvt_pk_bf16_f32 v21,v78,v79
v_mfma_f32_16x16x32_bf16 v[252:255],v[124:127],v[24:27],0
v_exp_f32 v86,v86
v_mfma_f32_16x16x32_bf16 v[52:55],v[48:51],v[20:23],v[52:55]
v_exp_f32 v87,v87
v_mfma_f32_16x16x32_bf16 a[44:47],v[124:127],v[30:33],0
v_cvt_pk_bf16_f32 v26,v84,v85
v_cvt_pk_bf16_f32 v27,v86,v87
v_mfma_f32_16x16x32_bf16 a[92:95],v[124:127],v[36:39],0
buffer_load_dwordx4 v7,s[8:11],s21 offen offset:1024 lds
v_mfma_f32_16x16x32_bf16 v[56:59],v[48:51],v[26:29],v[56:59]
s_waitcnt lgkmcnt(1)
ds_read_b128 v[124:127],v1 offset:30720
v_fma_f32 v102,v102,s36,v16
v_mfma_f32_16x16x32_bf16 v[72:75],v[128:131],a[144:147],0
v_exp_f32 v92,v92
v_mfma_f32_16x16x32_bf16 v[80:83],v[128:131],a[168:171],0
v_exp_f32 v93,v93
v_mfma_f32_16x16x32_bf16 v[88:91],v[128:131],a[192:195],0
v_exp_f32 v94,v94
v_mfma_f32_16x16x32_bf16 v[96:99],v[128:131],a[216:219],0
ds_read_b128 v[128:131],v0 offset:30848
v_fma_f32 v103,v103,s36,v16
v_mfma_f32_16x16x32_bf16 v[72:75],v[132:135],a[148:151],v[72:75]
v_exp_f32 v95,v95
v_mfma_f32_16x16x32_bf16 v[80:83],v[132:135],a[172:175],v[80:83]
v_cvt_pk_bf16_f32 v32,v92,v93
v_cvt_pk_bf16_f32 v33,v94,v95
v_mfma_f32_16x16x32_bf16 v[88:91],v[132:135],a[196:199],v[88:91]
v_exp_f32 v100,v100
v_mfma_f32_16x16x32_bf16 v[60:63],v[48:51],v[32:35],v[60:63]
buffer_load_dwordx4 v8,s[8:11],s21 offen offset:2048 lds
v_mfma_f32_16x16x32_bf16 v[96:99],v[132:135],a[220:223],v[96:99]
s_add_u32 s21,s21,12288
v_exp_f32 v101,v101
v_mfma_f32_16x16x32_bf16 v[72:75],v[136:139],a[152:155],v[72:75]
s_add_u32 m0,s22,12288
v_exp_f32 v102,v102
v_mfma_f32_16x16x32_bf16 v[80:83],v[136:139],a[176:179],v[80:83]
v_exp_f32 v103,v103
v_mfma_f32_16x16x32_bf16 v[88:91],v[136:139],a[200:203],v[88:91]
v_cvt_pk_bf16_f32 v38,v100,v101
v_cvt_pk_bf16_f32 v39,v102,v103
v_mfma_f32_16x16x32_bf16 v[96:99],v[136:139],a[224:227],v[96:99]
ds_read_b128 v[132:135],v1 offset:30848
v_mfma_f32_16x16x32_bf16 v[64:67],v[48:51],v[38:41],v[64:67]
ds_read_b128 v[136:139],v0 offset:30976
v_mfma_f32_16x16x32_bf16 v[72:75],v[140:143],a[156:159],v[72:75]
v_mfma_f32_16x16x32_bf16 v[80:83],v[140:143],a[180:183],v[80:83]
v_mfma_f32_16x16x32_bf16 v[88:91],v[140:143],a[204:207],v[88:91]
buffer_load_dwordx4 v6,s[4:7],s20 offen offset:0 lds
v_mfma_f32_16x16x32_bf16 v[96:99],v[140:143],a[228:231],v[96:99]
ds_read_b128 v[140:143],v1 offset:30976
v_mfma_f32_16x16x32_bf16 v[72:75],v[112:115],a[160:163],v[72:75]
v_mfma_f32_16x16x32_bf16 v[80:83],v[112:115],a[184:187],v[80:83]
v_mfma_f32_16x16x32_bf16 v[88:91],v[112:115],a[208:211],v[88:91]
v_mfma_f32_16x16x32_bf16 v[96:99],v[112:115],a[232:235],v[96:99]
v_mfma_f32_16x16x32_bf16 v[72:75],v[116:119],a[164:167],v[72:75]
v_mfma_f32_16x16x32_bf16 v[80:83],v[116:119],a[188:191],v[80:83]
v_mfma_f32_16x16x32_bf16 v[88:91],v[116:119],a[212:215],v[88:91]
v_mfma_f32_16x16x32_bf16 v[96:99],v[116:119],a[236:239],v[96:99]
buffer_load_dwordx4 v7,s[4:7],s20 offen offset:1024 lds
s_waitcnt lgkmcnt(0)
v_mfma_f32_16x16x32_bf16 v[76:79],v[120:123],a[144:147],0
v_mfma_f32_16x16x32_bf16 v[84:87],v[120:123],a[168:171],0
v_mfma_f32_16x16x32_bf16 v[92:95],v[120:123],a[192:195],0
v_mfma_f32_16x16x32_bf16 v[100:103],v[120:123],a[216:219],0
v_fma_f32 v72,v72,s36,v13
v_fma_f32 v73,v73,s36,v13
v_mfma_f32_16x16x32_bf16 v[76:79],v[124:127],a[148:151],v[76:79]
v_fma_f32 v74,v74,s36,v13
v_fma_f32 v75,v75,s36,v13
v_mfma_f32_16x16x32_bf16 v[84:87],v[124:127],a[172:175],v[84:87]
v_fma_f32 v80,v80,s36,v14
v_fma_f32 v81,v81,s36,v14
v_mfma_f32_16x16x32_bf16 v[92:95],v[124:127],a[196:199],v[92:95]
v_exp_f32 v72,v72
v_mfma_f32_16x16x32_bf16 v[100:103],v[124:127],a[220:223],v[100:103]
v_exp_f32 v73,v73
v_mfma_f32_16x16x32_bf16 v[76:79],v[128:131],a[152:155],v[76:79]
buffer_load_dwordx4 v8,s[4:7],s20 offen offset:2048 lds
v_mfma_f32_16x16x32_bf16 v[84:87],v[128:131],a[176:179],v[84:87]
s_add_u32 s20,s20,12288
ds_read_b64_tr_b16 v[112:113],v2 offset:18432
v_mfma_f32_16x16x32_bf16 v[92:95],v[128:131],a[200:203],v[92:95]
ds_read_b64_tr_b16 v[114:115],v2 offset:12288
v_cvt_pk_bf16_f32 v18,v72,v73
v_mfma_f32_16x16x32_bf16 v[100:103],v[128:131],a[224:227],v[100:103]
ds_read_b64_tr_b16 v[116:117],v3 offset:18432
v_mfma_f32_16x16x32_bf16 v[76:79],v[132:135],a[156:159],v[76:79]
ds_read_b64_tr_b16 v[118:119],v3 offset:12288
v_mfma_f32_16x16x32_bf16 v[84:87],v[132:135],a[180:183],v[84:87]
ds_read_b64_tr_b16 v[120:121],v4 offset:18432
v_mfma_f32_16x16x32_bf16 v[92:95],v[132:135],a[204:207],v[92:95]
ds_read_b64_tr_b16 v[122:123],v4 offset:12288
v_mfma_f32_16x16x32_bf16 v[100:103],v[132:135],a[228:231],v[100:103]
ds_read_b64_tr_b16 v[124:125],v5 offset:18432
v_mfma_f32_16x16x32_bf16 v[76:79],v[136:139],a[160:163],v[76:79]
ds_read_b64_tr_b16 v[126:127],v5 offset:12288
v_mfma_f32_16x16x32_bf16 v[84:87],v[136:139],a[184:187],v[84:87]
v_exp_f32 v74,v74
v_mfma_f32_16x16x32_bf16 v[92:95],v[136:139],a[208:211],v[92:95]
v_exp_f32 v75,v75
v_mfma_f32_16x16x32_bf16 v[100:103],v[136:139],a[232:235],v[100:103]
v_exp_f32 v80,v80
v_mfma_f32_16x16x32_bf16 v[76:79],v[140:143],a[164:167],v[76:79]
v_exp_f32 v81,v81
v_mfma_f32_16x16x32_bf16 v[84:87],v[140:143],a[188:191],v[84:87]
v_cvt_pk_bf16_f32 v19,v74,v75
v_cvt_pk_bf16_f32 v24,v80,v81
v_mfma_f32_16x16x32_bf16 v[92:95],v[140:143],a[212:215],v[92:95]
v_mfma_f32_16x16x32_bf16 v[100:103],v[140:143],a[236:239],v[100:103]
s_waitcnt lgkmcnt(2)
v_mfma_f32_16x16x32_bf16 v[160:163],v[112:115],v[20:23],v[160:163]
s_add_u32 m0,s23,12288
ds_read_b64_tr_b16 v[128:129],v2 offset:18560
ds_read_b64_tr_b16 v[130:131],v2 offset:12416
v_mfma_f32_16x16x32_bf16 v[208:211],v[112:115],v[26:29],v[208:211]
ds_read_b64_tr_b16 v[132:133],v3 offset:18560
ds_read_b64_tr_b16 v[134:135],v3 offset:12416
v_mfma_f32_16x16x32_bf16 a[0:3],v[112:115],v[32:35],a[0:3]
ds_read_b64_tr_b16 v[136:137],v4 offset:18560
ds_read_b64_tr_b16 v[138:139],v4 offset:12416
v_mfma_f32_16x16x32_bf16 a[48:51],v[112:115],v[38:41],a[48:51]
ds_read_b64_tr_b16 v[140:141],v5 offset:18560
ds_read_b64_tr_b16 v[142:143],v5 offset:12416
v_mfma_f32_16x16x32_bf16 v[164:167],v[116:119],v[20:23],v[164:167]
ds_read_b64_tr_b16 v[112:113],v2 offset:18688
ds_read_b64_tr_b16 v[114:115],v2 offset:12544
v_mfma_f32_16x16x32_bf16 v[212:215],v[116:119],v[26:29],v[212:215]
v_fma_f32 v82,v82,s36,v14
v_fma_f32 v83,v83,s36,v14
v_mfma_f32_16x16x32_bf16 a[4:7],v[116:119],v[32:35],a[4:7]
v_exp_f32 v82,v82
v_mfma_f32_16x16x32_bf16 a[52:55],v[116:119],v[38:41],a[52:55]
ds_read_b64_tr_b16 v[116:117],v3 offset:18688
ds_read_b64_tr_b16 v[118:119],v3 offset:12544
v_mfma_f32_16x16x32_bf16 v[168:171],v[120:123],v[20:23],v[168:171]
v_exp_f32 v83,v83
v_mfma_f32_16x16x32_bf16 v[216:219],v[120:123],v[26:29],v[216:219]
v_cvt_pk_bf16_f32 v25,v82,v83
v_fma_f32 v88,v88,s36,v15
v_mfma_f32_16x16x32_bf16 a[8:11],v[120:123],v[32:35],a[8:11]
v_fma_f32 v89,v89,s36,v15
v_fma_f32 v90,v90,s36,v15
v_mfma_f32_16x16x32_bf16 a[56:59],v[120:123],v[38:41],a[56:59]
s_waitcnt lgkmcnt(6)
ds_read_b64_tr_b16 v[120:121],v4 offset:18688
ds_read_b64_tr_b16 v[122:123],v4 offset:12544
v_mfma_f32_16x16x32_bf16 v[172:175],v[124:127],v[20:23],v[172:175]
v_fma_f32 v91,v91,s36,v15
v_fma_f32 v96,v96,s36,v16
v_mfma_f32_16x16x32_bf16 v[220:223],v[124:127],v[26:29],v[220:223]
v_exp_f32 v88,v88
v_mfma_f32_16x16x32_bf16 a[12:15],v[124:127],v[32:35],a[12:15]
v_exp_f32 v89,v89
v_mfma_f32_16x16x32_bf16 a[60:63],v[124:127],v[38:41],a[60:63]
ds_read_b64_tr_b16 v[124:125],v5 offset:18688
ds_read_b64_tr_b16 v[126:127],v5 offset:12544
v_mfma_f32_16x16x32_bf16 v[176:179],v[128:131],v[20:23],v[176:179]
v_exp_f32 v90,v90
v_mfma_f32_16x16x32_bf16 v[224:227],v[128:131],v[26:29],v[224:227]
v_exp_f32 v91,v91
v_mfma_f32_16x16x32_bf16 a[16:19],v[128:131],v[32:35],a[16:19]
v_cvt_pk_bf16_f32 v30,v88,v89
v_cvt_pk_bf16_f32 v31,v90,v91
v_mfma_f32_16x16x32_bf16 a[64:67],v[128:131],v[38:41],a[64:67]
v_fma_f32 v97,v97,s36,v16
v_fma_f32 v98,v98,s36,v16
v_mfma_f32_16x16x32_bf16 v[180:183],v[132:135],v[20:23],v[180:183]
v_fma_f32 v99,v99,s36,v16
v_fma_f32 v76,v76,s36,v13
v_mfma_f32_16x16x32_bf16 v[228:231],v[132:135],v[26:29],v[228:231]
v_exp_f32 v96,v96
v_mfma_f32_16x16x32_bf16 a[20:23],v[132:135],v[32:35],a[20:23]
v_exp_f32 v97,v97
v_mfma_f32_16x16x32_bf16 a[68:71],v[132:135],v[38:41],a[68:71]
v_exp_f32 v98,v98
v_mfma_f32_16x16x32_bf16 v[184:187],v[136:139],v[20:23],v[184:187]
v_exp_f32 v99,v99
v_mfma_f32_16x16x32_bf16 v[232:235],v[136:139],v[26:29],v[232:235]
v_cvt_pk_bf16_f32 v36,v96,v97
v_cvt_pk_bf16_f32 v37,v98,v99
v_mfma_f32_16x16x32_bf16 a[24:27],v[136:139],v[32:35],a[24:27]
v_fma_f32 v77,v77,s36,v13
v_fma_f32 v78,v78,s36,v13
v_mfma_f32_16x16x32_bf16 a[72:75],v[136:139],v[38:41],a[72:75]
s_waitcnt lgkmcnt(0)
v_fma_f32 v79,v79,s36,v13
v_fma_f32 v84,v84,s36,v14
v_mfma_f32_16x16x32_bf16 v[188:191],v[140:143],v[20:23],v[188:191]
v_exp_f32 v76,v76
v_mfma_f32_16x16x32_bf16 v[236:239],v[140:143],v[26:29],v[236:239]
v_exp_f32 v77,v77
v_mfma_f32_16x16x32_bf16 a[28:31],v[140:143],v[32:35],a[28:31]
v_exp_f32 v78,v78
v_mfma_f32_16x16x32_bf16 a[76:79],v[140:143],v[38:41],a[76:79]
v_exp_f32 v79,v79
v_mfma_f32_16x16x32_bf16 v[192:195],v[112:115],v[20:23],v[192:195]
v_fma_f32 v85,v85,s36,v14
v_fma_f32 v86,v86,s36,v14
s_waitcnt vmcnt(6)
v_mfma_f32_16x16x32_bf16 v[240:243],v[112:115],v[26:29],v[240:243]
s_barrier
v_mfma_f32_16x16x32_bf16 a[32:35],v[112:115],v[32:35],a[32:35]
ds_read_b128 v[128:131],v0 offset:0
v_fma_f32 v87,v87,s36,v14
v_mfma_f32_16x16x32_bf16 a[80:83],v[112:115],v[38:41],a[80:83]
ds_read_b128 v[132:135],v1 offset:0
v_fma_f32 v92,v92,s36,v15
v_mfma_f32_16x16x32_bf16 v[196:199],v[116:119],v[20:23],v[196:199]
ds_read_b128 v[136:139],v0 offset:128
v_fma_f32 v93,v93,s36,v15
v_mfma_f32_16x16x32_bf16 v[244:247],v[116:119],v[26:29],v[244:247]
ds_read_b128 v[140:143],v1 offset:128
v_fma_f32 v94,v94,s36,v15
v_mfma_f32_16x16x32_bf16 a[36:39],v[116:119],v[32:35],a[36:39]
ds_read_b128 v[112:115],v0 offset:256
v_fma_f32 v95,v95,s36,v15
v_mfma_f32_16x16x32_bf16 a[84:87],v[116:119],v[38:41],a[84:87]
buffer_load_dwordx4 v6,s[8:11],s21 offen offset:0 lds
v_mfma_f32_16x16x32_bf16 v[200:203],v[120:123],v[20:23],v[200:203]
ds_read_b128 v[116:119],v1 offset:256
v_fma_f32 v100,v100,s36,v16
v_mfma_f32_16x16x32_bf16 v[248:251],v[120:123],v[26:29],v[248:251]
v_exp_f32 v84,v84
v_mfma_f32_16x16x32_bf16 a[40:43],v[120:123],v[32:35],a[40:43]
v_exp_f32 v85,v85
v_mfma_f32_16x16x32_bf16 a[88:91],v[120:123],v[38:41],a[88:91]
ds_read_b128 v[120:123],v0 offset:6144
v_fma_f32 v101,v101,s36,v16
v_mfma_f32_16x16x32_bf16 v[204:207],v[124:127],v[20:23],v[204:207]
v_cvt_pk_bf16_f32 v20,v76,v77
v_cvt_pk_bf16_f32 v21,v78,v79
v_mfma_f32_16x16x32_bf16 v[252:255],v[124:127],v[26:29],v[252:255]
v_exp_f32 v86,v86
v_mfma_f32_16x16x32_bf16 v[52:55],v[48:51],v[18:21],v[52:55]
v_exp_f32 v87,v87
v_mfma_f32_16x16x32_bf16 a[44:47],v[124:127],v[32:35],a[44:47]
v_cvt_pk_bf16_f32 v26,v84,v85
v_cvt_pk_bf16_f32 v27,v86,v87
v_mfma_f32_16x16x32_bf16 a[92:95],v[124:127],v[38:41],a[92:95]
buffer_load_dwordx4 v7,s[8:11],s21 offen offset:1024 lds
v_mfma_f32_16x16x32_bf16 v[56:59],v[48:51],v[24:27],v[56:59]
s_waitcnt lgkmcnt(1)
ds_read_b128 v[124:127],v1 offset:6144
v_fma_f32 v102,v102,s36,v16
v_mfma_f32_16x16x32_bf16 v[72:75],v[128:131],a[144:147],0
v_exp_f32 v92,v92
v_mfma_f32_16x16x32_bf16 v[80:83],v[128:131],a[168:171],0
v_exp_f32 v93,v93
v_mfma_f32_16x16x32_bf16 v[88:91],v[128:131],a[192:195],0
v_exp_f32 v94,v94
v_mfma_f32_16x16x32_bf16 v[96:99],v[128:131],a[216:219],0
ds_read_b128 v[128:131],v0 offset:6272
v_fma_f32 v103,v103,s36,v16
v_mfma_f32_16x16x32_bf16 v[72:75],v[132:135],a[148:151],v[72:75]
v_exp_f32 v95,v95
v_mfma_f32_16x16x32_bf16 v[80:83],v[132:135],a[172:175],v[80:83]
v_cvt_pk_bf16_f32 v32,v92,v93
v_cvt_pk_bf16_f32 v33,v94,v95
v_mfma_f32_16x16x32_bf16 v[88:91],v[132:135],a[196:199],v[88:91]
v_exp_f32 v100,v100
v_mfma_f32_16x16x32_bf16 v[60:63],v[48:51],v[30:33],v[60:63]
buffer_load_dwordx4 v8,s[8:11],s21 offen offset:2048 lds
v_mfma_f32_16x16x32_bf16 v[96:99],v[132:135],a[220:223],v[96:99]
s_add_u32 s21,s21,12288
v_exp_f32 v101,v101
v_mfma_f32_16x16x32_bf16 v[72:75],v[136:139],a[152:155],v[72:75]
s_add_u32 m0,s22,24576
v_exp_f32 v102,v102
v_mfma_f32_16x16x32_bf16 v[80:83],v[136:139],a[176:179],v[80:83]
v_exp_f32 v103,v103
v_mfma_f32_16x16x32_bf16 v[88:91],v[136:139],a[200:203],v[88:91]
v_cvt_pk_bf16_f32 v38,v100,v101
v_cvt_pk_bf16_f32 v39,v102,v103
v_mfma_f32_16x16x32_bf16 v[96:99],v[136:139],a[224:227],v[96:99]
ds_read_b128 v[132:135],v1 offset:6272
v_mfma_f32_16x16x32_bf16 v[64:67],v[48:51],v[36:39],v[64:67]
ds_read_b128 v[136:139],v0 offset:6400
v_mfma_f32_16x16x32_bf16 v[72:75],v[140:143],a[156:159],v[72:75]
v_mfma_f32_16x16x32_bf16 v[80:83],v[140:143],a[180:183],v[80:83]
v_mfma_f32_16x16x32_bf16 v[88:91],v[140:143],a[204:207],v[88:91]
buffer_load_dwordx4 v6,s[4:7],s20 offen offset:0 lds
v_mfma_f32_16x16x32_bf16 v[96:99],v[140:143],a[228:231],v[96:99]
ds_read_b128 v[140:143],v1 offset:6400
v_mfma_f32_16x16x32_bf16 v[72:75],v[112:115],a[160:163],v[72:75]
v_mfma_f32_16x16x32_bf16 v[80:83],v[112:115],a[184:187],v[80:83]
v_mfma_f32_16x16x32_bf16 v[88:91],v[112:115],a[208:211],v[88:91]
v_mfma_f32_16x16x32_bf16 v[96:99],v[112:115],a[232:235],v[96:99]
v_mfma_f32_16x16x32_bf16 v[72:75],v[116:119],a[164:167],v[72:75]
v_mfma_f32_16x16x32_bf16 v[80:83],v[116:119],a[188:191],v[80:83]
v_mfma_f32_16x16x32_bf16 v[88:91],v[116:119],a[212:215],v[88:91]
v_mfma_f32_16x16x32_bf16 v[96:99],v[116:119],a[236:239],v[96:99]
buffer_load_dwordx4 v7,s[4:7],s20 offen offset:1024 lds
s_waitcnt lgkmcnt(0)
v_mfma_f32_16x16x32_bf16 v[76:79],v[120:123],a[144:147],0
v_mfma_f32_16x16x32_bf16 v[84:87],v[120:123],a[168:171],0
v_mfma_f32_16x16x32_bf16 v[92:95],v[120:123],a[192:195],0
v_mfma_f32_16x16x32_bf16 v[100:103],v[120:123],a[216:219],0
v_fma_f32 v72,v72,s36,v13
v_fma_f32 v73,v73,s36,v13
v_mfma_f32_16x16x32_bf16 v[76:79],v[124:127],a[148:151],v[76:79]
v_fma_f32 v74,v74,s36,v13
v_fma_f32 v75,v75,s36,v13
v_mfma_f32_16x16x32_bf16 v[84:87],v[124:127],a[172:175],v[84:87]
v_fma_f32 v80,v80,s36,v14
v_fma_f32 v81,v81,s36,v14
v_mfma_f32_16x16x32_bf16 v[92:95],v[124:127],a[196:199],v[92:95]
v_exp_f32 v72,v72
v_mfma_f32_16x16x32_bf16 v[100:103],v[124:127],a[220:223],v[100:103]
v_exp_f32 v73,v73
v_mfma_f32_16x16x32_bf16 v[76:79],v[128:131],a[152:155],v[76:79]
buffer_load_dwordx4 v8,s[4:7],s20 offen offset:2048 lds
v_mfma_f32_16x16x32_bf16 v[84:87],v[128:131],a[176:179],v[84:87]
s_add_u32 s20,s20,12288
ds_read_b64_tr_b16 v[112:113],v2 offset:24576
v_mfma_f32_16x16x32_bf16 v[92:95],v[128:131],a[200:203],v[92:95]
ds_read_b64_tr_b16 v[114:115],v2 offset:30720
v_cvt_pk_bf16_f32 v22,v72,v73
v_mfma_f32_16x16x32_bf16 v[100:103],v[128:131],a[224:227],v[100:103]
ds_read_b64_tr_b16 v[116:117],v3 offset:24576
v_mfma_f32_16x16x32_bf16 v[76:79],v[132:135],a[156:159],v[76:79]
ds_read_b64_tr_b16 v[118:119],v3 offset:30720
v_mfma_f32_16x16x32_bf16 v[84:87],v[132:135],a[180:183],v[84:87]
ds_read_b64_tr_b16 v[120:121],v4 offset:24576
v_mfma_f32_16x16x32_bf16 v[92:95],v[132:135],a[204:207],v[92:95]
ds_read_b64_tr_b16 v[122:123],v4 offset:30720
v_mfma_f32_16x16x32_bf16 v[100:103],v[132:135],a[228:231],v[100:103]
ds_read_b64_tr_b16 v[124:125],v5 offset:24576
v_mfma_f32_16x16x32_bf16 v[76:79],v[136:139],a[160:163],v[76:79]
ds_read_b64_tr_b16 v[126:127],v5 offset:30720
v_mfma_f32_16x16x32_bf16 v[84:87],v[136:139],a[184:187],v[84:87]
v_exp_f32 v74,v74
v_mfma_f32_16x16x32_bf16 v[92:95],v[136:139],a[208:211],v[92:95]
v_exp_f32 v75,v75
v_mfma_f32_16x16x32_bf16 v[100:103],v[136:139],a[232:235],v[100:103]
v_exp_f32 v80,v80
v_mfma_f32_16x16x32_bf16 v[76:79],v[140:143],a[164:167],v[76:79]
v_exp_f32 v81,v81
v_mfma_f32_16x16x32_bf16 v[84:87],v[140:143],a[188:191],v[84:87]
v_cvt_pk_bf16_f32 v23,v74,v75
v_cvt_pk_bf16_f32 v28,v80,v81
v_mfma_f32_16x16x32_bf16 v[92:95],v[140:143],a[212:215],v[92:95]
v_mfma_f32_16x16x32_bf16 v[100:103],v[140:143],a[236:239],v[100:103]
s_mov_b32 s38,0
s_branch L_loop4
L_loop5:
.p2align 6
L_loop5w0:
s_waitcnt lgkmcnt(4)
v_mfma_f32_16x16x32_bf16 v[160:163],v[112:115],v[18:21],v[160:163]
s_add_u32 m0,s23,24576
ds_read_b64_tr_b16 v[128:129],v2 offset:24704
ds_read_b64_tr_b16 v[130:131],v2 offset:30848
v_mfma_f32_16x16x32_bf16 v[208:211],v[112:115],v[24:27],v[208:211]
ds_read_b64_tr_b16 v[132:133],v3 offset:24704
ds_read_b64_tr_b16 v[134:135],v3 offset:30848
v_mfma_f32_16x16x32_bf16 a[0:3],v[112:115],v[30:33],a[0:3]
ds_read_b64_tr_b16 v[136:137],v4 offset:24704
ds_read_b64_tr_b16 v[138:139],v4 offset:30848
v_mfma_f32_16x16x32_bf16 a[48:51],v[112:115],v[36:39],a[48:51]
ds_read_b64_tr_b16 v[140:141],v5 offset:24704
ds_read_b64_tr_b16 v[142:143],v5 offset:30848
v_mfma_f32_16x16x32_bf16 a[96:99],v[112:115],v[42:45],a[96:99]
ds_read_b64_tr_b16 v[112:113],v2 offset:24832
ds_read_b64_tr_b16 v[114:115],v2 offset:30976
v_mfma_f32_16x16x32_bf16 v[164:167],v[116:119],v[18:21],v[164:167]
v_fma_f32 v90,v90,s36,v15
v_fma_f32 v91,v91,s36,v15
v_mfma_f32_16x16x32_bf16 v[212:215],v[116:119],v[24:27],v[212:215]
v_exp_f32 v90,v90
v_mfma_f32_16x16x32_bf16 a[4:7],v[116:119],v[30:33],a[4:7]
v_exp_f32 v91,v91
v_mfma_f32_16x16x32_bf16 a[52:55],v[116:119],v[36:39],a[52:55]
v_cvt_pk_bf16_f32 v35,v90,v91
v_fma_f32 v96,v96,s36,v16
v_mfma_f32_16x16x32_bf16 a[100:103],v[116:119],v[42:45],a[100:103]
s_waitcnt lgkmcnt(8)
ds_read_b64_tr_b16 v[116:117],v3 offset:24832
ds_read_b64_tr_b16 v[118:119],v3 offset:30976
v_mfma_f32_16x16x32_bf16 v[168:171],v[120:123],v[18:21],v[168:171]
v_fma_f32 v97,v97,s36,v16
v_fma_f32 v98,v98,s36,v16
v_mfma_f32_16x16x32_bf16 v[216:219],v[120:123],v[24:27],v[216:219]
v_fma_f32 v99,v99,s36,v16
v_fma_f32 v104,v104,s36,v17
v_mfma_f32_16x16x32_bf16 a[8:11],v[120:123],v[30:33],a[8:11]
v_exp_f32 v96,v96
v_mfma_f32_16x16x32_bf16 a[56:59],v[120:123],v[36:39],a[56:59]
v_exp_f32 v97,v97
v_mfma_f32_16x16x32_bf16 a[104:107],v[120:123],v[42:45],a[104:107]
ds_read_b64_tr_b16 v[120:121],v4 offset:24832
ds_read_b64_tr_b16 v[122:123],v4 offset:30976
v_mfma_f32_16x16x32_bf16 v[172:175],v[124:127],v[18:21],v[172:175]
v_exp_f32 v98,v98
v_mfma_f32_16x16x32_bf16 v[220:223],v[124:127],v[24:27],v[220:223]
v_exp_f32 v99,v99
v_mfma_f32_16x16x32_bf16 a[12:15],v[124:127],v[30:33],a[12:15]
v_cvt_pk_bf16_f32 v40,v96,v97
v_cvt_pk_bf16_f32 v41,v98,v99
v_mfma_f32_16x16x32_bf16 a[60:63],v[124:127],v[36:39],a[60:63]
v_fma_f32 v105,v105,s36,v17
v_fma_f32 v106,v106,s36,v17
v_mfma_f32_16x16x32_bf16 a[108:111],v[124:127],v[42:45],a[108:111]
ds_read_b64_tr_b16 v[124:125],v5 offset:24832
ds_read_b64_tr_b16 v[126:127],v5 offset:30976
v_mfma_f32_16x16x32_bf16 v[176:179],v[128:131],v[18:21],v[176:179]
v_fma_f32 v107,v107,s36,v17
v_fma_f32 v76,v76,s36,v13
v_mfma_f32_16x16x32_bf16 v[224:227],v[128:131],v[24:27],v[224:227]
v_exp_f32 v104,v104
v_mfma_f32_16x16x32_bf16 a[16:19],v[128:131],v[30:33],a[16:19]
v_exp_f32 v105,v105
v_mfma_f32_16x16x32_bf16 a[64:67],v[128:131],v[36:39],a[64:67]
v_exp_f32 v106,v106
v_mfma_f32_16x16x32_bf16 a[112:115],v[128:131],v[42:45],a[112:115]
s_waitcnt lgkmcnt(2)
v_exp_f32 v107,v107
v_mfma_f32_16x16x32_bf16 v[180:183],v[132:135],v[18:21],v[180:183]
v_cvt_pk_bf16_f32 v46,v104,v105
v_cvt_pk_bf16_f32 v47,v106,v107
v_mfma_f32_16x16x32_bf16 v[228:231],v[132:135],v[24:27],v[228:231]
v_fma_f32 v77,v77,s36,v13
v_fma_f32 v78,v78,s36,v13
v_mfma_f32_16x16x32_bf16 a[20:23],v[132:135],v[30:33],a[20:23]
v_fma_f32 v79,v79,s36,v13
v_fma_f32 v84,v84,s36,v14
v_mfma_f32_16x16x32_bf16 a[68:71],v[132:135],v[36:39],a[68:71]
v_exp_f32 v76,v76
v_mfma_f32_16x16x32_bf16 a[116:119],v[132:135],v[42:45],a[116:119]
v_exp_f32 v77,v77
v_mfma_f32_16x16x32_bf16 v[184:187],v[136:139],v[18:21],v[184:187]
v_exp_f32 v78,v78
v_mfma_f32_16x16x32_bf16 v[232:235],v[136:139],v[24:27],v[232:235]
v_exp_f32 v79,v79
v_mfma_f32_16x16x32_bf16 a[24:27],v[136:139],v[30:33],a[24:27]
v_fma_f32 v85,v85,s36,v14
v_fma_f32 v86,v86,s36,v14
v_mfma_f32_16x16x32_bf16 a[72:75],v[136:139],v[36:39],a[72:75]
v_fma_f32 v87,v87,s36,v14
v_fma_f32 v92,v92,s36,v15
v_mfma_f32_16x16x32_bf16 a[120:123],v[136:139],v[42:45],a[120:123]
v_exp_f32 v84,v84
v_mfma_f32_16x16x32_bf16 v[188:191],v[140:143],v[18:21],v[188:191]
v_exp_f32 v85,v85
v_mfma_f32_16x16x32_bf16 v[236:239],v[140:143],v[24:27],v[236:239]
v_exp_f32 v86,v86
v_mfma_f32_16x16x32_bf16 a[28:31],v[140:143],v[30:33],a[28:31]
v_exp_f32 v87,v87
v_mfma_f32_16x16x32_bf16 a[76:79],v[140:143],v[36:39],a[76:79]
v_fma_f32 v93,v93,s36,v15
v_fma_f32 v94,v94,s36,v15
v_mfma_f32_16x16x32_bf16 a[124:127],v[140:143],v[42:45],a[124:127]
v_fma_f32 v95,v95,s36,v15
v_fma_f32 v100,v100,s36,v16
v_mfma_f32_16x16x32_bf16 v[192:195],v[112:115],v[18:21],v[192:195]
v_exp_f32 v92,v92
v_mfma_f32_16x16x32_bf16 v[240:243],v[112:115],v[24:27],v[240:243]
v_exp_f32 v93,v93
s_waitcnt vmcnt(6) lgkmcnt(0)
v_mfma_f32_16x16x32_bf16 a[32:35],v[112:115],v[30:33],a[32:35]
s_barrier
v_mfma_f32_16x16x32_bf16 a[80:83],v[112:115],v[36:39],a[80:83]
ds_read_b128 v[128:131],v0 offset:12288
v_fma_f32 v101,v101,s36,v16
v_mfma_f32_16x16x32_bf16 a[128:131],v[112:115],v[42:45],a[128:131]
ds_read_b128 v[132:135],v1 offset:12288
v_fma_f32 v102,v102,s36,v16
v_mfma_f32_16x16x32_bf16 v[196:199],v[116:119],v[18:21],v[196:199]
ds_read_b128 v[136:139],v0 offset:12416
v_fma_f32 v103,v103,s36,v16
v_mfma_f32_16x16x32_bf16 v[244:247],v[116:119],v[24:27],v[244:247]
ds_read_b128 v[140:143],v1 offset:12416
v_fma_f32 v108,v108,s36,v17
v_mfma_f32_16x16x32_bf16 a[36:39],v[116:119],v[30:33],a[36:39]
ds_read_b128 v[152:155],v10 offset:0
v_fma_f32 v109,v109,s36,v17
v_mfma_f32_16x16x32_bf16 a[84:87],v[116:119],v[36:39],a[84:87]
buffer_load_dwordx4 v6,s[8:11],s21 offen offset:0 lds
v_mfma_f32_16x16x32_bf16 a[132:135],v[116:119],v[42:45],a[132:135]
ds_read_b128 v[112:115],v0 offset:12544
v_fma_f32 v110,v110,s36,v17
v_mfma_f32_16x16x32_bf16 v[200:203],v[120:123],v[18:21],v[200:203]
ds_read_b128 v[116:119],v1 offset:12544
v_fma_f32 v111,v111,s36,v17
v_mfma_f32_16x16x32_bf16 v[248:251],v[120:123],v[24:27],v[248:251]
v_exp_f32 v94,v94
v_mfma_f32_16x16x32_bf16 a[40:43],v[120:123],v[30:33],a[40:43]
v_exp_f32 v95,v95
v_mfma_f32_16x16x32_bf16 a[88:91],v[120:123],v[36:39],a[88:91]
v_exp_f32 v100,v100
v_mfma_f32_16x16x32_bf16 a[136:139],v[120:123],v[42:45],a[136:139]
ds_read_b128 v[120:123],v0 offset:18432
v_mfma_f32_16x16x32_bf16 v[204:207],v[124:127],v[18:21],v[204:207]
v_cvt_pk_bf16_f32 v20,v76,v77
v_cvt_pk_bf16_f32 v21,v78,v79
v_mfma_f32_16x16x32_bf16 v[252:255],v[124:127],v[24:27],v[252:255]
v_cvt_pk_bf16_f32 v26,v84,v85
v_cvt_pk_bf16_f32 v27,v86,v87
v_mfma_f32_16x16x32_bf16 v[52:55],v[48:51],v[20:23],v[52:55]
v_exp_f32 v101,v101
v_mfma_f32_16x16x32_bf16 v[56:59],v[48:51],v[26:29],v[56:59]
v_exp_f32 v102,v102
v_mfma_f32_16x16x32_bf16 a[44:47],v[124:127],v[30:33],a[44:47]
v_cvt_pk_bf16_f32 v32,v92,v93
v_cvt_pk_bf16_f32 v33,v94,v95
v_mfma_f32_16x16x32_bf16 a[92:95],v[124:127],v[36:39],a[92:95]
s_waitcnt lgkmcnt(1)
buffer_store_dwordx4 v[152:155],v9,s[16:19],s27 offen offset:0 nt
buffer_load_dwordx4 v7,s[8:11],s21 offen offset:1024 lds
v_mfma_f32_16x16x32_bf16 v[60:63],v[48:51],v[32:35],v[60:63]
v_exp_f32 v103,v103
v_mfma_f32_16x16x32_bf16 a[140:143],v[124:127],v[42:45],a[140:143]
ds_read_b128 v[124:127],v1 offset:18432
v_cvt_pk_bf16_f32 v38,v100,v101
v_mfma_f32_16x16x32_bf16 v[72:75],v[128:131],a[144:147],0
v_cvt_pk_bf16_f32 v39,v102,v103
v_mfma_f32_16x16x32_bf16 v[80:83],v[128:131],a[168:171],0
v_exp_f32 v108,v108
v_mfma_f32_16x16x32_bf16 v[64:67],v[48:51],v[38:41],v[64:67]
v_exp_f32 v109,v109
v_mfma_f32_16x16x32_bf16 v[88:91],v[128:131],a[192:195],0
ds_read_b128 v[156:159],v10 offset:1024
v_cvt_pk_bf16_f32 v44,v108,v109
v_mfma_f32_16x16x32_bf16 v[96:99],v[128:131],a[216:219],0
v_exp_f32 v110,v110
v_mfma_f32_16x16x32_bf16 v[104:107],v[128:131],a[240:243],0
ds_read_b128 v[128:131],v0 offset:18560
v_mfma_f32_16x16x32_bf16 v[72:75],v[132:135],a[148:151],v[72:75]
v_exp_f32 v111,v111
v_mfma_f32_16x16x32_bf16 v[80:83],v[132:135],a[172:175],v[80:83]
buffer_load_dwordx4 v8,s[8:11],s21 offen offset:2048 lds
v_mfma_f32_16x16x32_bf16 v[88:91],v[132:135],a[196:199],v[88:91]
s_add_u32 s21,s21,12288
v_cvt_pk_bf16_f32 v45,v110,v111
v_mfma_f32_16x16x32_bf16 v[96:99],v[132:135],a[220:223],v[96:99]
s_add_u32 m0,s22,0
v_mfma_f32_16x16x32_bf16 v[68:71],v[48:51],v[44:47],v[68:71]
v_mfma_f32_16x16x32_bf16 v[104:107],v[132:135],a[244:247],v[104:107]
ds_read_b128 v[132:135],v1 offset:18560
v_mfma_f32_16x16x32_bf16 v[72:75],v[136:139],a[152:155],v[72:75]
v_mfma_f32_16x16x32_bf16 v[80:83],v[136:139],a[176:179],v[80:83]
v_mfma_f32_16x16x32_bf16 v[88:91],v[136:139],a[200:203],v[88:91]
v_mfma_f32_16x16x32_bf16 v[96:99],v[136:139],a[224:227],v[96:99]
v_mfma_f32_16x16x32_bf16 v[104:107],v[136:139],a[248:251],v[104:107]
ds_read_b128 v[136:139],v0 offset:18688
v_mfma_f32_16x16x32_bf16 v[72:75],v[140:143],a[156:159],v[72:75]
v_mfma_f32_16x16x32_bf16 v[80:83],v[140:143],a[180:183],v[80:83]
v_mfma_f32_16x16x32_bf16 v[88:91],v[140:143],a[204:207],v[88:91]
s_waitcnt lgkmcnt(2)
buffer_store_dwordx4 v[156:159],v9,s[16:19],s27 offen offset:128 nt
buffer_load_dwordx4 v6,s[4:7],s20 offen offset:0 lds
v_mfma_f32_16x16x32_bf16 v[96:99],v[140:143],a[228:231],v[96:99]
v_mfma_f32_16x16x32_bf16 v[104:107],v[140:143],a[252:255],v[104:107]
ds_read_b128 v[140:143],v1 offset:18688
v_mfma_f32_16x16x32_bf16 v[72:75],v[112:115],a[160:163],v[72:75]
v_mfma_f32_16x16x32_bf16 v[80:83],v[112:115],a[184:187],v[80:83]
v_mfma_f32_16x16x32_bf16 v[88:91],v[112:115],a[208:211],v[88:91]
v_mfma_f32_16x16x32_bf16 v[96:99],v[112:115],a[232:235],v[96:99]
ds_read_b128 v[152:155],v10 offset:2048
v_mfma_f32_16x16x32_bf16 v[104:107],v[112:115],v[144:147],v[104:107]
v_mfma_f32_16x16x32_bf16 v[72:75],v[116:119],a[164:167],v[72:75]
v_mfma_f32_16x16x32_bf16 v[80:83],v[116:119],a[188:191],v[80:83]
v_mfma_f32_16x16x32_bf16 v[88:91],v[116:119],a[212:215],v[88:91]
buffer_load_dwordx4 v7,s[4:7],s20 offen offset:1024 lds
v_mfma_f32_16x16x32_bf16 v[96:99],v[116:119],a[236:239],v[96:99]
v_mfma_f32_16x16x32_bf16 v[104:107],v[116:119],v[148:151],v[104:107]
v_mfma_f32_16x16x32_bf16 v[76:79],v[120:123],a[144:147],0
v_mfma_f32_16x16x32_bf16 v[84:87],v[120:123],a[168:171],0
v_mfma_f32_16x16x32_bf16 v[92:95],v[120:123],a[192:195],0
v_fma_f32 v72,v72,s36,v13
v_fma_f32 v73,v73,s36,v13
v_mfma_f32_16x16x32_bf16 v[100:103],v[120:123],a[216:219],0
v_fma_f32 v74,v74,s36,v13
v_fma_f32 v75,v75,s36,v13
v_mfma_f32_16x16x32_bf16 v[108:111],v[120:123],a[240:243],0
v_fma_f32 v80,v80,s36,v14
v_fma_f32 v81,v81,s36,v14
v_mfma_f32_16x16x32_bf16 v[76:79],v[124:127],a[148:151],v[76:79]
v_fma_f32 v82,v82,s36,v14
v_fma_f32 v83,v83,s36,v14
v_mfma_f32_16x16x32_bf16 v[84:87],v[124:127],a[172:175],v[84:87]
v_fma_f32 v88,v88,s36,v15
v_fma_f32 v89,v89,s36,v15
v_mfma_f32_16x16x32_bf16 v[92:95],v[124:127],a[196:199],v[92:95]
v_exp_f32 v72,v72
v_mfma_f32_16x16x32_bf16 v[100:103],v[124:127],a[220:223],v[100:103]
v_exp_f32 v73,v73
v_mfma_f32_16x16x32_bf16 v[108:111],v[124:127],a[244:247],v[108:111]
s_waitcnt lgkmcnt(0)
buffer_store_dwordx4 v[152:155],v9,s[16:19],s27 offen offset:256 nt
buffer_load_dwordx4 v8,s[4:7],s20 offen offset:2048 lds
v_mfma_f32_16x16x32_bf16 v[76:79],v[128:131],a[152:155],v[76:79]
s_add_u32 s20,s20,12288
v_exp_f32 v74,v74
v_mfma_f32_16x16x32_bf16 v[84:87],v[128:131],a[176:179],v[84:87]
s_add_u32 s27,s27,3072
v_exp_f32 v75,v75
v_mfma_f32_16x16x32_bf16 v[92:95],v[128:131],a[200:203],v[92:95]
v_exp_f32 v80,v80
v_mfma_f32_16x16x32_bf16 v[100:103],v[128:131],a[224:227],v[100:103]
v_exp_f32 v81,v81
v_mfma_f32_16x16x32_bf16 v[108:111],v[128:131],a[248:251],v[108:111]
ds_read_b64_tr_b16 v[112:113],v2 offset:6144
ds_read_b64_tr_b16 v[114:115],v2 offset:0
v_mfma_f32_16x16x32_bf16 v[76:79],v[132:135],a[156:159],v[76:79]
v_exp_f32 v82,v82
v_mfma_f32_16x16x32_bf16 v[84:87],v[132:135],a[180:183],v[84:87]
ds_read_b64_tr_b16 v[116:117],v3 offset:6144
ds_read_b64_tr_b16 v[118:119],v3 offset:0
v_mfma_f32_16x16x32_bf16 v[92:95],v[132:135],a[204:207],v[92:95]
v_exp_f32 v83,v83
v_mfma_f32_16x16x32_bf16 v[100:103],v[132:135],a[228:231],v[100:103]
v_exp_f32 v88,v88
v_mfma_f32_16x16x32_bf16 v[108:111],v[132:135],a[252:255],v[108:111]
ds_read_b64_tr_b16 v[120:121],v4 offset:6144
ds_read_b64_tr_b16 v[122:123],v4 offset:0
v_mfma_f32_16x16x32_bf16 v[76:79],v[136:139],a[160:163],v[76:79]
v_exp_f32 v89,v89
v_mfma_f32_16x16x32_bf16 v[84:87],v[136:139],a[184:187],v[84:87]
ds_read_b64_tr_b16 v[124:125],v5 offset:6144
ds_read_b64_tr_b16 v[126:127],v5 offset:0
v_mfma_f32_16x16x32_bf16 v[92:95],v[136:139],a[208:211],v[92:95]
v_cvt_pk_bf16_f32 v18,v72,v73
v_cvt_pk_bf16_f32 v19,v74,v75
v_mfma_f32_16x16x32_bf16 v[100:103],v[136:139],a[232:235],v[100:103]
v_cvt_pk_bf16_f32 v24,v80,v81
v_cvt_pk_bf16_f32 v25,v82,v83
v_mfma_f32_16x16x32_bf16 v[108:111],v[136:139],v[144:147],v[108:111]
v_cvt_pk_bf16_f32 v30,v88,v89
v_mfma_f32_16x16x32_bf16 v[76:79],v[140:143],a[164:167],v[76:79]
v_mfma_f32_16x16x32_bf16 v[84:87],v[140:143],a[188:191],v[84:87]
v_mfma_f32_16x16x32_bf16 v[92:95],v[140:143],a[212:215],v[92:95]
v_mfma_f32_16x16x32_bf16 v[100:103],v[140:143],a[236:239],v[100:103]
v_mfma_f32_16x16x32_bf16 v[108:111],v[140:143],v[148:151],v[108:111]
s_waitcnt lgkmcnt(2)
v_mfma_f32_16x16x32_bf16 v[160:163],v[112:115],v[20:23],v[160:163]
s_add_u32 m0,s29,0
ds_read_b64_tr_b16 v[128:129],v2 offset:6272
ds_read_b64_tr_b16 v[130:131],v2 offset:128
v_mfma_f32_16x16x32_bf16 v[208:211],v[112:115],v[26:29],v[208:211]
ds_read_b64_tr_b16 v[132:133],v3 offset:6272
ds_read_b64_tr_b16 v[134:135],v3 offset:128
v_mfma_f32_16x16x32_bf16 a[0:3],v[112:115],v[32:35],a[0:3]
ds_read_b64_tr_b16 v[136:137],v4 offset:6272
ds_read_b64_tr_b16 v[138:139],v4 offset:128
v_mfma_f32_16x16x32_bf16 a[48:51],v[112:115],v[38:41],a[48:51]
ds_read_b64_tr_b16 v[140:141],v5 offset:6272
ds_read_b64_tr_b16 v[142:143],v5 offset:128
v_mfma_f32_16x16x32_bf16 a[96:99],v[112:115],v[44:47],a[96:99]
ds_read_b64_tr_b16 v[112:113],v2 offset:6400
ds_read_b64_tr_b16 v[114:115],v2 offset:256
v_mfma_f32_16x16x32_bf16 v[164:167],v[116:119],v[20:23],v[164:167]
v_fma_f32 v90,v90,s36,v15
v_fma_f32 v91,v91,s36,v15
v_mfma_f32_16x16x32_bf16 v[212:215],v[116:119],v[26:29],v[212:215]
v_exp_f32 v90,v90
v_mfma_f32_16x16x32_bf16 a[4:7],v[116:119],v[32:35],a[4:7]
buffer_load_dwordx4 v6,s[12:15],s28 offen offset:0 nt lds
v_mfma_f32_16x16x32_bf16 a[52:55],v[116:119],v[38:41],a[52:55]
v_exp_f32 v91,v91
v_mfma_f32_16x16x32_bf16 a[100:103],v[116:119],v[44:47],a[100:103]
ds_read_b64_tr_b16 v[116:117],v3 offset:6400
ds_read_b64_tr_b16 v[118:119],v3 offset:256
v_mfma_f32_16x16x32_bf16 v[168:171],v[120:123],v[20:23],v[168:171]
v_cvt_pk_bf16_f32 v31,v90,v91
v_fma_f32 v96,v96,s36,v16
v_mfma_f32_16x16x32_bf16 v[216:219],v[120:123],v[26:29],v[216:219]
v_fma_f32 v97,v97,s36,v16
v_fma_f32 v98,v98,s36,v16
v_mfma_f32_16x16x32_bf16 a[8:11],v[120:123],v[32:35],a[8:11]
v_fma_f32 v99,v99,s36,v16
v_fma_f32 v104,v104,s36,v17
v_mfma_f32_16x16x32_bf16 a[56:59],v[120:123],v[38:41],a[56:59]
v_exp_f32 v96,v96
v_mfma_f32_16x16x32_bf16 a[104:107],v[120:123],v[44:47],a[104:107]
s_waitcnt lgkmcnt(2)
ds_read_b64_tr_b16 v[120:121],v4 offset:6400
ds_read_b64_tr_b16 v[122:123],v4 offset:256
v_mfma_f32_16x16x32_bf16 v[172:175],v[124:127],v[20:23],v[172:175]
v_exp_f32 v97,v97
v_mfma_f32_16x16x32_bf16 v[220:223],v[124:127],v[26:29],v[220:223]
v_exp_f32 v98,v98
v_mfma_f32_16x16x32_bf16 a[12:15],v[124:127],v[32:35],a[12:15]
buffer_load_dwordx4 v7,s[12:15],s28 offen offset:1024 nt lds
v_mfma_f32_16x16x32_bf16 a[60:63],v[124:127],v[38:41],a[60:63]
v_exp_f32 v99,v99
v_mfma_f32_16x16x32_bf16 a[108:111],v[124:127],v[44:47],a[108:111]
ds_read_b64_tr_b16 v[124:125],v5 offset:6400
ds_read_b64_tr_b16 v[126:127],v5 offset:256
v_mfma_f32_16x16x32_bf16 v[176:179],v[128:131],v[20:23],v[176:179]
v_cvt_pk_bf16_f32 v36,v96,v97
v_cvt_pk_bf16_f32 v37,v98,v99
v_mfma_f32_16x16x32_bf16 v[224:227],v[128:131],v[26:29],v[224:227]
v_fma_f32 v105,v105,s36,v17
v_fma_f32 v106,v106,s36,v17
v_mfma_f32_16x16x32_bf16 a[16:19],v[128:131],v[32:35],a[16:19]
v_fma_f32 v107,v107,s36,v17
v_fma_f32 v76,v76,s36,v13
v_mfma_f32_16x16x32_bf16 a[64:67],v[128:131],v[38:41],a[64:67]
v_exp_f32 v104,v104
v_mfma_f32_16x16x32_bf16 a[112:115],v[128:131],v[44:47],a[112:115]
v_exp_f32 v105,v105
v_mfma_f32_16x16x32_bf16 v[180:183],v[132:135],v[20:23],v[180:183]
v_exp_f32 v106,v106
v_mfma_f32_16x16x32_bf16 v[228:231],v[132:135],v[26:29],v[228:231]
v_exp_f32 v107,v107
v_mfma_f32_16x16x32_bf16 a[20:23],v[132:135],v[32:35],a[20:23]
buffer_load_dwordx4 v8,s[12:15],s28 offen offset:2048 nt lds
v_mfma_f32_16x16x32_bf16 a[68:71],v[132:135],v[38:41],a[68:71]
s_add_u32 s28,s28,3072
v_cvt_pk_bf16_f32 v42,v104,v105
v_cvt_pk_bf16_f32 v43,v106,v107
v_mfma_f32_16x16x32_bf16 a[116:119],v[132:135],v[44:47],a[116:119]
s_add_u32 s29,s29,3072
v_fma_f32 v77,v77,s36,v13
v_fma_f32 v78,v78,s36,v13
v_mfma_f32_16x16x32_bf16 v[184:187],v[136:139],v[20:23],v[184:187]
s_add_u32 m0,s23,0
v_fma_f32 v79,v79,s36,v13
v_fma_f32 v84,v84,s36,v14
v_mfma_f32_16x16x32_bf16 v[232:235],v[136:139],v[26:29],v[232:235]
v_exp_f32 v76,v76
v_mfma_f32_16x16x32_bf16 a[24:27],v[136:139],v[32:35],a[24:27]
v_exp_f32 v77,v77
v_mfma_f32_16x16x32_bf16 a[72:75],v[136:139],v[38:41],a[72:75]
v_exp_f32 v78,v78
v_mfma_f32_16x16x32_bf16 a[120:123],v[136:139],v[44:47],a[120:123]
v_exp_f32 v79,v79
v_mfma_f32_16x16x32_bf16 v[188:191],v[140:143],v[20:23],v[188:191]
v_fma_f32 v85,v85,s36,v14
v_fma_f32 v86,v86,s36,v14
v_mfma_f32_16x16x32_bf16 v[236:239],v[140:143],v[26:29],v[236:239]
v_fma_f32 v87,v87,s36,v14
v_fma_f32 v92,v92,s36,v15
v_mfma_f32_16x16x32_bf16 a[28:31],v[140:143],v[32:35],a[28:31]
v_exp_f32 v84,v84
v_mfma_f32_16x16x32_bf16 a[76:79],v[140:143],v[38:41],a[76:79]
v_exp_f32 v85,v85
v_mfma_f32_16x16x32_bf16 a[124:127],v[140:143],v[44:47],a[124:127]
v_exp_f32 v86,v86
v_mfma_f32_16x16x32_bf16 v[192:195],v[112:115],v[20:23],v[192:195]
v_exp_f32 v87,v87
s_waitcnt vmcnt(12) lgkmcnt(0)
v_mfma_f32_16x16x32_bf16 v[240:243],v[112:115],v[26:29],v[240:243]
s_barrier
v_mfma_f32_16x16x32_bf16 a[32:35],v[112:115],v[32:35],a[32:35]
ds_read_b128 v[128:131],v0 offset:24576
v_fma_f32 v93,v93,s36,v15
v_mfma_f32_16x16x32_bf16 a[80:83],v[112:115],v[38:41],a[80:83]
ds_read_b128 v[132:135],v1 offset:24576
v_fma_f32 v94,v94,s36,v15
v_mfma_f32_16x16x32_bf16 a[128:131],v[112:115],v[44:47],a[128:131]
ds_read_b128 v[136:139],v0 offset:24704
v_fma_f32 v95,v95,s36,v15
v_mfma_f32_16x16x32_bf16 v[196:199],v[116:119],v[20:23],v[196:199]
ds_read_b128 v[140:143],v1 offset:24704
v_fma_f32 v100,v100,s36,v16
v_mfma_f32_16x16x32_bf16 v[244:247],v[116:119],v[26:29],v[244:247]
ds_read_b128 v[112:115],v0 offset:24832
v_fma_f32 v101,v101,s36,v16
v_mfma_f32_16x16x32_bf16 a[36:39],v[116:119],v[32:35],a[36:39]
buffer_load_dwordx4 v6,s[8:11],s21 offen offset:0 lds
v_mfma_f32_16x16x32_bf16 a[84:87],v[116:119],v[38:41],a[84:87]
v_exp_f32 v92,v92
v_mfma_f32_16x16x32_bf16 a[132:135],v[116:119],v[44:47],a[132:135]
ds_read_b128 v[116:119],v1 offset:24832
v_fma_f32 v102,v102,s36,v16
v_mfma_f32_16x16x32_bf16 v[200:203],v[120:123],v[20:23],v[200:203]
v_exp_f32 v93,v93
v_mfma_f32_16x16x32_bf16 v[248:251],v[120:123],v[26:29],v[248:251]
v_exp_f32 v94,v94
v_mfma_f32_16x16x32_bf16 a[40:43],v[120:123],v[32:35],a[40:43]
v_exp_f32 v95,v95
v_mfma_f32_16x16x32_bf16 a[88:91],v[120:123],v[38:41],a[88:91]
v_fma_f32 v103,v103,s36,v16
v_fma_f32 v108,v108,s36,v17
v_mfma_f32_16x16x32_bf16 a[136:139],v[120:123],v[44:47],a[136:139]
ds_read_b128 v[120:123],v0 offset:30720
v_fma_f32 v109,v109,s36,v17
v_mfma_f32_16x16x32_bf16 v[204:207],v[124:127],v[20:23],v[204:207]
v_cvt_pk_bf16_f32 v20,v76,v77
v_cvt_pk_bf16_f32 v21,v78,v79
v_mfma_f32_16x16x32_bf16 v[252:255],v[124:127],v[26:29],v[252:255]
v_cvt_pk_bf16_f32 v26,v84,v85
v_cvt_pk_bf16_f32 v27,v86,v87
v_mfma_f32_16x16x32_bf16 v[52:55],v[48:51],v[18:21],v[52:55]
v_exp_f32 v100,v100
v_mfma_f32_16x16x32_bf16 v[56:59],v[48:51],v[24:27],v[56:59]
v_exp_f32 v101,v101
v_mfma_f32_16x16x32_bf16 a[44:47],v[124:127],v[32:35],a[44:47]
buffer_load_dwordx4 v7,s[8:11],s21 offen offset:1024 lds
v_mfma_f32_16x16x32_bf16 a[92:95],v[124:127],v[38:41],a[92:95]
v_cvt_pk_bf16_f32 v32,v92,v93
v_cvt_pk_bf16_f32 v33,v94,v95
v_mfma_f32_16x16x32_bf16 a[140:143],v[124:127],v[44:47],a[140:143]
ds_read_b128 v[124:127],v1 offset:30720
v_fma_f32 v110,v110,s36,v17
v_mfma_f32_16x16x32_bf16 v[60:63],v[48:51],v[30:33],v[60:63]
s_waitcnt lgkmcnt(1)
v_exp_f32 v102,v102
v_mfma_f32_16x16x32_bf16 v[72:75],v[128:131],a[144:147],0
v_exp_f32 v103,v103
v_mfma_f32_16x16x32_bf16 v[80:83],v[128:131],a[168:171],0
v_fma_f32 v111,v111,s36,v17
v_cvt_pk_bf16_f32 v38,v100,v101
v_mfma_f32_16x16x32_bf16 v[88:91],v[128:131],a[192:195],0
v_cvt_pk_bf16_f32 v39,v102,v103
v_mfma_f32_16x16x32_bf16 v[96:99],v[128:131],a[216:219],0
v_exp_f32 v108,v108
v_mfma_f32_16x16x32_bf16 v[64:67],v[48:51],v[36:39],v[64:67]
v_exp_f32 v109,v109
v_mfma_f32_16x16x32_bf16 v[104:107],v[128:131],a[240:243],0
ds_read_b128 v[128:131],v0 offset:30848
v_cvt_pk_bf16_f32 v44,v108,v109
v_mfma_f32_16x16x32_bf16 v[72:75],v[132:135],a[148:151],v[72:75]
v_exp_f32 v110,v110
v_mfma_f32_16x16x32_bf16 v[80:83],v[132:135],a[172:175],v[80:83]
buffer_load_dwordx4 v8,s[8:11],s21 offen offset:2048 lds
v_mfma_f32_16x16x32_bf16 v[88:91],v[132:135],a[196:199],v[88:91]
s_add_u32 s21,s21,12288
v_exp_f32 v111,v111
v_mfma_f32_16x16x32_bf16 v[96:99],v[132:135],a[220:223],v[96:99]
s_add_u32 m0,s22,12288
v_cvt_pk_bf16_f32 v45,v110,v111
v_mfma_f32_16x16x32_bf16 v[104:107],v[132:135],a[244:247],v[104:107]
ds_read_b128 v[132:135],v1 offset:30848
v_mfma_f32_16x16x32_bf16 v[68:71],v[48:51],v[42:45],v[68:71]
v_mfma_f32_16x16x32_bf16 v[72:75],v[136:139],a[152:155],v[72:75]
v_mfma_f32_16x16x32_bf16 v[80:83],v[136:139],a[176:179],v[80:83]
v_mfma_f32_16x16x32_bf16 v[88:91],v[136:139],a[200:203],v[88:91]
v_mfma_f32_16x16x32_bf16 v[96:99],v[136:139],a[224:227],v[96:99]
v_mfma_f32_16x16x32_bf16 v[104:107],v[136:139],a[248:251],v[104:107]
ds_read_b128 v[136:139],v0 offset:30976
v_mfma_f32_16x16x32_bf16 v[72:75],v[140:143],a[156:159],v[72:75]
v_mfma_f32_16x16x32_bf16 v[80:83],v[140:143],a[180:183],v[80:83]
buffer_load_dwordx4 v6,s[4:7],s20 offen offset:0 lds
v_mfma_f32_16x16x32_bf16 v[88:91],v[140:143],a[204:207],v[88:91]
v_mfma_f32_16x16x32_bf16 v[96:99],v[140:143],a[228:231],v[96:99]
v_mfma_f32_16x16x32_bf16 v[104:107],v[140:143],a[252:255],v[104:107]
ds_read_b128 v[140:143],v1 offset:30976
v_mfma_f32_16x16x32_bf16 v[72:75],v[112:115],a[160:163],v[72:75]
v_mfma_f32_16x16x32_bf16 v[80:83],v[112:115],a[184:187],v[80:83]
v_mfma_f32_16x16x32_bf16 v[88:91],v[112:115],a[208:211],v[88:91]
v_mfma_f32_16x16x32_bf16 v[96:99],v[112:115],a[232:235],v[96:99]
v_mfma_f32_16x16x32_bf16 v[104:107],v[112:115],v[144:147],v[104:107]
v_mfma_f32_16x16x32_bf16 v[72:75],v[116:119],a[164:167],v[72:75]
v_mfma_f32_16x16x32_bf16 v[80:83],v[116:119],a[188:191],v[80:83]
v_mfma_f32_16x16x32_bf16 v[88:91],v[116:119],a[212:215],v[88:91]
v_mfma_f32_16x16x32_bf16 v[96:99],v[116:119],a[236:239],v[96:99]
buffer_load_dwordx4 v7,s[4:7],s20 offen offset:1024 lds
v_mfma_f32_16x16x32_bf16 v[104:107],v[116:119],v[148:151],v[104:107]
v_mfma_f32_16x16x32_bf16 v[76:79],v[120:123],a[144:147],0
v_mfma_f32_16x16x32_bf16 v[84:87],v[120:123],a[168:171],0
v_mfma_f32_16x16x32_bf16 v[92:95],v[120:123],a[192:195],0
v_fma_f32 v72,v72,s36,v13
v_fma_f32 v73,v73,s36,v13
v_mfma_f32_16x16x32_bf16 v[100:103],v[120:123],a[216:219],0
v_fma_f32 v74,v74,s36,v13
v_fma_f32 v75,v75,s36,v13
v_mfma_f32_16x16x32_bf16 v[108:111],v[120:123],a[240:243],0
s_waitcnt lgkmcnt(0)
v_fma_f32 v80,v80,s36,v14
v_fma_f32 v81,v81,s36,v14
v_mfma_f32_16x16x32_bf16 v[76:79],v[124:127],a[148:151],v[76:79]
v_fma_f32 v82,v82,s36,v14
v_fma_f32 v83,v83,s36,v14
v_mfma_f32_16x16x32_bf16 v[84:87],v[124:127],a[172:175],v[84:87]
v_fma_f32 v88,v88,s36,v15
v_fma_f32 v89,v89,s36,v15
v_mfma_f32_16x16x32_bf16 v[92:95],v[124:127],a[196:199],v[92:95]
v_exp_f32 v72,v72
v_mfma_f32_16x16x32_bf16 v[100:103],v[124:127],a[220:223],v[100:103]
v_exp_f32 v73,v73
v_mfma_f32_16x16x32_bf16 v[108:111],v[124:127],a[244:247],v[108:111]
buffer_load_dwordx4 v8,s[4:7],s20 offen offset:2048 lds
v_mfma_f32_16x16x32_bf16 v[76:79],v[128:131],a[152:155],v[76:79]
s_add_u32 s20,s20,12288
v_exp_f32 v74,v74
v_mfma_f32_16x16x32_bf16 v[84:87],v[128:131],a[176:179],v[84:87]
v_exp_f32 v75,v75
v_mfma_f32_16x16x32_bf16 v[92:95],v[128:131],a[200:203],v[92:95]
v_exp_f32 v80,v80
v_mfma_f32_16x16x32_bf16 v[100:103],v[128:131],a[224:227],v[100:103]
v_exp_f32 v81,v81
v_mfma_f32_16x16x32_bf16 v[108:111],v[128:131],a[248:251],v[108:111]
ds_read_b64_tr_b16 v[112:113],v2 offset:12288
v_mfma_f32_16x16x32_bf16 v[76:79],v[132:135],a[156:159],v[76:79]
ds_read_b64_tr_b16 v[114:115],v2 offset:18432
v_cvt_pk_bf16_f32 v22,v72,v73
v_mfma_f32_16x16x32_bf16 v[84:87],v[132:135],a[180:183],v[84:87]
v_exp_f32 v82,v82
v_mfma_f32_16x16x32_bf16 v[92:95],v[132:135],a[204:207],v[92:95]
ds_read_b64_tr_b16 v[116:117],v3 offset:12288
ds_read_b64_tr_b16 v[118:119],v3 offset:18432
v_mfma_f32_16x16x32_bf16 v[100:103],v[132:135],a[228:231],v[100:103]
v_exp_f32 v83,v83
v_mfma_f32_16x16x32_bf16 v[108:111],v[132:135],a[252:255],v[108:111]
ds_read_b64_tr_b16 v[120:121],v4 offset:12288
v_mfma_f32_16x16x32_bf16 v[76:79],v[136:139],a[160:163],v[76:79]
ds_read_b64_tr_b16 v[122:123],v4 offset:18432
v_cvt_pk_bf16_f32 v23,v74,v75
v_mfma_f32_16x16x32_bf16 v[84:87],v[136:139],a[184:187],v[84:87]
v_exp_f32 v88,v88
v_mfma_f32_16x16x32_bf16 v[92:95],v[136:139],a[208:211],v[92:95]
ds_read_b64_tr_b16 v[124:125],v5 offset:12288
ds_read_b64_tr_b16 v[126:127],v5 offset:18432
v_mfma_f32_16x16x32_bf16 v[100:103],v[136:139],a[232:235],v[100:103]
v_exp_f32 v89,v89
v_mfma_f32_16x16x32_bf16 v[108:111],v[136:139],v[144:147],v[108:111]
v_cvt_pk_bf16_f32 v28,v80,v81
v_cvt_pk_bf16_f32 v29,v82,v83
v_mfma_f32_16x16x32_bf16 v[76:79],v[140:143],a[164:167],v[76:79]
v_cvt_pk_bf16_f32 v34,v88,v89
v_mfma_f32_16x16x32_bf16 v[84:87],v[140:143],a[188:191],v[84:87]
v_mfma_f32_16x16x32_bf16 v[92:95],v[140:143],a[212:215],v[92:95]
v_mfma_f32_16x16x32_bf16 v[100:103],v[140:143],a[236:239],v[100:103]
v_mfma_f32_16x16x32_bf16 v[108:111],v[140:143],v[148:151],v[108:111]
s_waitcnt lgkmcnt(2)
v_mfma_f32_16x16x32_bf16 v[160:163],v[112:115],v[18:21],v[160:163]
s_add_u32 m0,s23,12288
ds_read_b64_tr_b16 v[128:129],v2 offset:12416
ds_read_b64_tr_b16 v[130:131],v2 offset:18560
v_mfma_f32_16x16x32_bf16 v[208:211],v[112:115],v[24:27],v[208:211]
ds_read_b64_tr_b16 v[132:133],v3 offset:12416
ds_read_b64_tr_b16 v[134:135],v3 offset:18560
v_mfma_f32_16x16x32_bf16 a[0:3],v[112:115],v[30:33],a[0:3]
ds_read_b64_tr_b16 v[136:137],v4 offset:12416
ds_read_b64_tr_b16 v[138:139],v4 offset:18560
v_mfma_f32_16x16x32_bf16 a[48:51],v[112:115],v[36:39],a[48:51]
ds_read_b64_tr_b16 v[140:141],v5 offset:12416
ds_read_b64_tr_b16 v[142:143],v5 offset:18560
v_mfma_f32_16x16x32_bf16 a[96:99],v[112:115],v[42:45],a[96:99]
ds_read_b64_tr_b16 v[112:113],v2 offset:12544
ds_read_b64_tr_b16 v[114:115],v2 offset:18688
v_mfma_f32_16x16x32_bf16 v[164:167],v[116:119],v[18:21],v[164:167]
v_fma_f32 v90,v90,s36,v15
v_fma_f32 v91,v91,s36,v15
v_mfma_f32_16x16x32_bf16 v[212:215],v[116:119],v[24:27],v[212:215]
v_exp_f32 v90,v90
v_mfma_f32_16x16x32_bf16 a[4:7],v[116:119],v[30:33],a[4:7]
v_exp_f32 v91,v91
v_mfma_f32_16x16x32_bf16 a[52:55],v[116:119],v[36:39],a[52:55]
v_cvt_pk_bf16_f32 v35,v90,v91
v_fma_f32 v96,v96,s36,v16
v_mfma_f32_16x16x32_bf16 a[100:103],v[116:119],v[42:45],a[100:103]
ds_read_b64_tr_b16 v[116:117],v3 offset:12544
ds_read_b64_tr_b16 v[118:119],v3 offset:18688
v_mfma_f32_16x16x32_bf16 v[168:171],v[120:123],v[18:21],v[168:171]
v_fma_f32 v97,v97,s36,v16
v_fma_f32 v98,v98,s36,v16
v_mfma_f32_16x16x32_bf16 v[216:219],v[120:123],v[24:27],v[216:219]
v_fma_f32 v99,v99,s36,v16
v_fma_f32 v104,v104,s36,v17
v_mfma_f32_16x16x32_bf16 a[8:11],v[120:123],v[30:33],a[8:11]
v_exp_f32 v96,v96
v_mfma_f32_16x16x32_bf16 a[56:59],v[120:123],v[36:39],a[56:59]
v_exp_f32 v97,v97
v_mfma_f32_16x16x32_bf16 a[104:107],v[120:123],v[42:45],a[104:107]
s_waitcnt lgkmcnt(2)
ds_read_b64_tr_b16 v[120:121],v4 offset:12544
ds_read_b64_tr_b16 v[122:123],v4 offset:18688
v_mfma_f32_16x16x32_bf16 v[172:175],v[124:127],v[18:21],v[172:175]
v_exp_f32 v98,v98
v_mfma_f32_16x16x32_bf16 v[220:223],v[124:127],v[24:27],v[220:223]
v_exp_f32 v99,v99
v_mfma_f32_16x16x32_bf16 a[12:15],v[124:127],v[30:33],a[12:15]
v_cvt_pk_bf16_f32 v40,v96,v97
v_cvt_pk_bf16_f32 v41,v98,v99
v_mfma_f32_16x16x32_bf16 a[60:63],v[124:127],v[36:39],a[60:63]
v_fma_f32 v105,v105,s36,v17
v_fma_f32 v106,v106,s36,v17
v_mfma_f32_16x16x32_bf16 a[108:111],v[124:127],v[42:45],a[108:111]
ds_read_b64_tr_b16 v[124:125],v5 offset:12544
ds_read_b64_tr_b16 v[126:127],v5 offset:18688
v_mfma_f32_16x16x32_bf16 v[176:179],v[128:131],v[18:21],v[176:179]
v_fma_f32 v107,v107,s36,v17
v_fma_f32 v76,v76,s36,v13
v_mfma_f32_16x16x32_bf16 v[224:227],v[128:131],v[24:27],v[224:227]
v_exp_f32 v104,v104
v_mfma_f32_16x16x32_bf16 a[16:19],v[128:131],v[30:33],a[16:19]
v_exp_f32 v105,v105
v_mfma_f32_16x16x32_bf16 a[64:67],v[128:131],v[36:39],a[64:67]
v_exp_f32 v106,v106
v_mfma_f32_16x16x32_bf16 a[112:115],v[128:131],v[42:45],a[112:115]
v_exp_f32 v107,v107
v_mfma_f32_16x16x32_bf16 v[180:183],v[132:135],v[18:21],v[180:183]
v_cvt_pk_bf16_f32 v46,v104,v105
v_cvt_pk_bf16_f32 v47,v106,v107
v_mfma_f32_16x16x32_bf16 v[228:231],v[132:135],v[24:27],v[228:231]
v_fma_f32 v77,v77,s36,v13
v_fma_f32 v78,v78,s36,v13
v_mfma_f32_16x16x32_bf16 a[20:23],v[132:135],v[30:33],a[20:23]
v_fma_f32 v79,v79,s36,v13
v_fma_f32 v84,v84,s36,v14
v_mfma_f32_16x16x32_bf16 a[68:71],v[132:135],v[36:39],a[68:71]
v_exp_f32 v76,v76
v_mfma_f32_16x16x32_bf16 a[116:119],v[132:135],v[42:45],a[116:119]
v_exp_f32 v77,v77
v_mfma_f32_16x16x32_bf16 v[184:187],v[136:139],v[18:21],v[184:187]
v_exp_f32 v78,v78
v_mfma_f32_16x16x32_bf16 v[232:235],v[136:139],v[24:27],v[232:235]
v_exp_f32 v79,v79
v_mfma_f32_16x16x32_bf16 a[24:27],v[136:139],v[30:33],a[24:27]
v_fma_f32 v85,v85,s36,v14
v_fma_f32 v86,v86,s36,v14
v_mfma_f32_16x16x32_bf16 a[72:75],v[136:139],v[36:39],a[72:75]
v_fma_f32 v87,v87,s36,v14
v_fma_f32 v92,v92,s36,v15
v_mfma_f32_16x16x32_bf16 a[120:123],v[136:139],v[42:45],a[120:123]
v_exp_f32 v84,v84
v_mfma_f32_16x16x32_bf16 v[188:191],v[140:143],v[18:21],v[188:191]
v_exp_f32 v85,v85
v_mfma_f32_16x16x32_bf16 v[236:239],v[140:143],v[24:27],v[236:239]
v_exp_f32 v86,v86
v_mfma_f32_16x16x32_bf16 a[28:31],v[140:143],v[30:33],a[28:31]
v_exp_f32 v87,v87
v_mfma_f32_16x16x32_bf16 a[76:79],v[140:143],v[36:39],a[76:79]
v_fma_f32 v93,v93,s36,v15
v_fma_f32 v94,v94,s36,v15
v_mfma_f32_16x16x32_bf16 a[124:127],v[140:143],v[42:45],a[124:127]
v_fma_f32 v95,v95,s36,v15
v_fma_f32 v100,v100,s36,v16
v_mfma_f32_16x16x32_bf16 v[192:195],v[112:115],v[18:21],v[192:195]
v_exp_f32 v92,v92
v_mfma_f32_16x16x32_bf16 v[240:243],v[112:115],v[24:27],v[240:243]
v_exp_f32 v93,v93
s_waitcnt vmcnt(9) lgkmcnt(0)
v_mfma_f32_16x16x32_bf16 a[32:35],v[112:115],v[30:33],a[32:35]
s_barrier
v_mfma_f32_16x16x32_bf16 a[80:83],v[112:115],v[36:39],a[80:83]
ds_read_b128 v[128:131],v0 offset:0
v_fma_f32 v101,v101,s36,v16
v_mfma_f32_16x16x32_bf16 a[128:131],v[112:115],v[42:45],a[128:131]
ds_read_b128 v[132:135],v1 offset:0
v_fma_f32 v102,v102,s36,v16
v_mfma_f32_16x16x32_bf16 v[196:199],v[116:119],v[18:21],v[196:199]
ds_read_b128 v[136:139],v0 offset:128
v_fma_f32 v103,v103,s36,v16
v_mfma_f32_16x16x32_bf16 v[244:247],v[116:119],v[24:27],v[244:247]
ds_read_b128 v[140:143],v1 offset:128
v_fma_f32 v108,v108,s36,v17
v_mfma_f32_16x16x32_bf16 a[36:39],v[116:119],v[30:33],a[36:39]
ds_read_b128 v[156:159],v10 offset:3072
v_fma_f32 v109,v109,s36,v17
v_mfma_f32_16x16x32_bf16 a[84:87],v[116:119],v[36:39],a[84:87]
buffer_load_dwordx4 v6,s[8:11],s21 offen offset:0 lds
v_mfma_f32_16x16x32_bf16 a[132:135],v[116:119],v[42:45],a[132:135]
ds_read_b128 v[112:115],v0 offset:256
v_fma_f32 v110,v110,s36,v17
v_mfma_f32_16x16x32_bf16 v[200:203],v[120:123],v[18:21],v[200:203]
ds_read_b128 v[116:119],v1 offset:256
v_fma_f32 v111,v111,s36,v17
v_mfma_f32_16x16x32_bf16 v[248:251],v[120:123],v[24:27],v[248:251]
v_exp_f32 v94,v94
v_mfma_f32_16x16x32_bf16 a[40:43],v[120:123],v[30:33],a[40:43]
v_exp_f32 v95,v95
v_mfma_f32_16x16x32_bf16 a[88:91],v[120:123],v[36:39],a[88:91]
v_exp_f32 v100,v100
v_mfma_f32_16x16x32_bf16 a[136:139],v[120:123],v[42:45],a[136:139]
ds_read_b128 v[120:123],v0 offset:6144
v_mfma_f32_16x16x32_bf16 v[204:207],v[124:127],v[18:21],v[204:207]
v_cvt_pk_bf16_f32 v20,v76,v77
v_cvt_pk_bf16_f32 v21,v78,v79
v_mfma_f32_16x16x32_bf16 v[252:255],v[124:127],v[24:27],v[252:255]
v_cvt_pk_bf16_f32 v26,v84,v85
v_cvt_pk_bf16_f32 v27,v86,v87
v_mfma_f32_16x16x32_bf16 v[52:55],v[48:51],v[20:23],v[52:55]
v_exp_f32 v101,v101
v_mfma_f32_16x16x32_bf16 v[56:59],v[48:51],v[26:29],v[56:59]
v_exp_f32 v102,v102
v_mfma_f32_16x16x32_bf16 a[44:47],v[124:127],v[30:33],a[44:47]
v_cvt_pk_bf16_f32 v32,v92,v93
v_cvt_pk_bf16_f32 v33,v94,v95
v_mfma_f32_16x16x32_bf16 a[92:95],v[124:127],v[36:39],a[92:95]
s_waitcnt lgkmcnt(1)
buffer_store_dwordx4 v[156:159],v9,s[16:19],s27 offen offset:0 nt
buffer_load_dwordx4 v7,s[8:11],s21 offen offset:1024 lds
v_mfma_f32_16x16x32_bf16 v[60:63],v[48:51],v[32:35],v[60:63]
v_exp_f32 v103,v103
v_mfma_f32_16x16x32_bf16 a[140:143],v[124:127],v[42:45],a[140:143]
ds_read_b128 v[124:127],v1 offset:6144
v_cvt_pk_bf16_f32 v38,v100,v101
v_mfma_f32_16x16x32_bf16 v[72:75],v[128:131],a[144:147],0
v_cvt_pk_bf16_f32 v39,v102,v103
v_mfma_f32_16x16x32_bf16 v[80:83],v[128:131],a[168:171],0
v_exp_f32 v108,v108
v_mfma_f32_16x16x32_bf16 v[64:67],v[48:51],v[38:41],v[64:67]
v_exp_f32 v109,v109
v_mfma_f32_16x16x32_bf16 v[88:91],v[128:131],a[192:195],0
ds_read_b128 v[152:155],v10 offset:4096
v_cvt_pk_bf16_f32 v44,v108,v109
v_mfma_f32_16x16x32_bf16 v[96:99],v[128:131],a[216:219],0
v_exp_f32 v110,v110
v_mfma_f32_16x16x32_bf16 v[104:107],v[128:131],a[240:243],0
ds_read_b128 v[128:131],v0 offset:6272
v_mfma_f32_16x16x32_bf16 v[72:75],v[132:135],a[148:151],v[72:75]
v_exp_f32 v111,v111
v_mfma_f32_16x16x32_bf16 v[80:83],v[132:135],a[172:175],v[80:83]
buffer_load_dwordx4 v8,s[8:11],s21 offen offset:2048 lds
v_mfma_f32_16x16x32_bf16 v[88:91],v[132:135],a[196:199],v[88:91]
s_add_u32 s21,s21,12288
v_cvt_pk_bf16_f32 v45,v110,v111
v_mfma_f32_16x16x32_bf16 v[96:99],v[132:135],a[220:223],v[96:99]
s_add_u32 m0,s22,24576
v_mfma_f32_16x16x32_bf16 v[68:71],v[48:51],v[44:47],v[68:71]
v_mfma_f32_16x16x32_bf16 v[104:107],v[132:135],a[244:247],v[104:107]
ds_read_b128 v[132:135],v1 offset:6272
v_mfma_f32_16x16x32_bf16 v[72:75],v[136:139],a[152:155],v[72:75]
v_mfma_f32_16x16x32_bf16 v[80:83],v[136:139],a[176:179],v[80:83]
v_mfma_f32_16x16x32_bf16 v[88:91],v[136:139],a[200:203],v[88:91]
v_mfma_f32_16x16x32_bf16 v[96:99],v[136:139],a[224:227],v[96:99]
v_mfma_f32_16x16x32_bf16 v[104:107],v[136:139],a[248:251],v[104:107]
ds_read_b128 v[136:139],v0 offset:6400
v_mfma_f32_16x16x32_bf16 v[72:75],v[140:143],a[156:159],v[72:75]
v_mfma_f32_16x16x32_bf16 v[80:83],v[140:143],a[180:183],v[80:83]
v_mfma_f32_16x16x32_bf16 v[88:91],v[140:143],a[204:207],v[88:91]
s_waitcnt lgkmcnt(2)
buffer_store_dwordx4 v[152:155],v9,s[16:19],s27 offen offset:128 nt
buffer_load_dwordx4 v6,s[4:7],s20 offen offset:0 lds
v_mfma_f32_16x16x32_bf16 v[96:99],v[140:143],a[228:231],v[96:99]
v_mfma_f32_16x16x32_bf16 v[104:107],v[140:143],a[252:255],v[104:107]
ds_read_b128 v[140:143],v1 offset:6400
v_mfma_f32_16x16x32_bf16 v[72:75],v[112:115],a[160:163],v[72:75]
v_mfma_f32_16x16x32_bf16 v[80:83],v[112:115],a[184:187],v[80:83]
v_mfma_f32_16x16x32_bf16 v[88:91],v[112:115],a[208:211],v[88:91]
v_mfma_f32_16x16x32_bf16 v[96:99],v[112:115],a[232:235],v[96:99]
ds_read_b128 v[156:159],v10 offset:5120
v_mfma_f32_16x16x32_bf16 v[104:107],v[112:115],v[144:147],v[104:107]
v_mfma_f32_16x16x32_bf16 v[72:75],v[116:119],a[164:167],v[72:75]
v_mfma_f32_16x16x32_bf16 v[80:83],v[116:119],a[188:191],v[80:83]
v_mfma_f32_16x16x32_bf16 v[88:91],v[116:119],a[212:215],v[88:91]
buffer_load_dwordx4 v7,s[4:7],s20 offen offset:1024 lds
v_mfma_f32_16x16x32_bf16 v[96:99],v[116:119],a[236:239],v[96:99]
v_mfma_f32_16x16x32_bf16 v[104:107],v[116:119],v[148:151],v[104:107]
v_mfma_f32_16x16x32_bf16 v[76:79],v[120:123],a[144:147],0
v_mfma_f32_16x16x32_bf16 v[84:87],v[120:123],a[168:171],0
v_mfma_f32_16x16x32_bf16 v[92:95],v[120:123],a[192:195],0
v_fma_f32 v72,v72,s36,v13
v_fma_f32 v73,v73,s36,v13
v_mfma_f32_16x16x32_bf16 v[100:103],v[120:123],a[216:219],0
v_fma_f32 v74,v74,s36,v13
v_fma_f32 v75,v75,s36,v13
v_mfma_f32_16x16x32_bf16 v[108:111],v[120:123],a[240:243],0
v_fma_f32 v80,v80,s36,v14
v_fma_f32 v81,v81,s36,v14
v_mfma_f32_16x16x32_bf16 v[76:79],v[124:127],a[148:151],v[76:79]
v_fma_f32 v82,v82,s36,v14
v_fma_f32 v83,v83,s36,v14
v_mfma_f32_16x16x32_bf16 v[84:87],v[124:127],a[172:175],v[84:87]
v_fma_f32 v88,v88,s36,v15
v_fma_f32 v89,v89,s36,v15
v_mfma_f32_16x16x32_bf16 v[92:95],v[124:127],a[196:199],v[92:95]
v_exp_f32 v72,v72
v_mfma_f32_16x16x32_bf16 v[100:103],v[124:127],a[220:223],v[100:103]
v_exp_f32 v73,v73
v_mfma_f32_16x16x32_bf16 v[108:111],v[124:127],a[244:247],v[108:111]
s_waitcnt lgkmcnt(0)
buffer_store_dwordx4 v[156:159],v9,s[16:19],s27 offen offset:256 nt
buffer_load_dwordx4 v8,s[4:7],s20 offen offset:2048 lds
v_mfma_f32_16x16x32_bf16 v[76:79],v[128:131],a[152:155],v[76:79]
s_add_u32 s20,s20,12288
v_exp_f32 v74,v74
v_mfma_f32_16x16x32_bf16 v[84:87],v[128:131],a[176:179],v[84:87]
s_add_u32 s27,s27,3072
v_exp_f32 v75,v75
v_mfma_f32_16x16x32_bf16 v[92:95],v[128:131],a[200:203],v[92:95]
v_exp_f32 v80,v80
v_mfma_f32_16x16x32_bf16 v[100:103],v[128:131],a[224:227],v[100:103]
v_exp_f32 v81,v81
v_mfma_f32_16x16x32_bf16 v[108:111],v[128:131],a[248:251],v[108:111]
ds_read_b64_tr_b16 v[112:113],v2 offset:30720
ds_read_b64_tr_b16 v[114:115],v2 offset:24576
v_mfma_f32_16x16x32_bf16 v[76:79],v[132:135],a[156:159],v[76:79]
v_exp_f32 v82,v82
v_mfma_f32_16x16x32_bf16 v[84:87],v[132:135],a[180:183],v[84:87]
ds_read_b64_tr_b16 v[116:117],v3 offset:30720
ds_read_b64_tr_b16 v[118:119],v3 offset:24576
v_mfma_f32_16x16x32_bf16 v[92:95],v[132:135],a[204:207],v[92:95]
v_exp_f32 v83,v83
v_mfma_f32_16x16x32_bf16 v[100:103],v[132:135],a[228:231],v[100:103]
v_exp_f32 v88,v88
v_mfma_f32_16x16x32_bf16 v[108:111],v[132:135],a[252:255],v[108:111]
ds_read_b64_tr_b16 v[120:121],v4 offset:30720
ds_read_b64_tr_b16 v[122:123],v4 offset:24576
v_mfma_f32_16x16x32_bf16 v[76:79],v[136:139],a[160:163],v[76:79]
v_exp_f32 v89,v89
v_mfma_f32_16x16x32_bf16 v[84:87],v[136:139],a[184:187],v[84:87]
ds_read_b64_tr_b16 v[124:125],v5 offset:30720
ds_read_b64_tr_b16 v[126:127],v5 offset:24576
v_mfma_f32_16x16x32_bf16 v[92:95],v[136:139],a[208:211],v[92:95]
v_cvt_pk_bf16_f32 v18,v72,v73
v_cvt_pk_bf16_f32 v19,v74,v75
v_mfma_f32_16x16x32_bf16 v[100:103],v[136:139],a[232:235],v[100:103]
v_cvt_pk_bf16_f32 v24,v80,v81
v_cvt_pk_bf16_f32 v25,v82,v83
v_mfma_f32_16x16x32_bf16 v[108:111],v[136:139],v[144:147],v[108:111]
v_cvt_pk_bf16_f32 v30,v88,v89
v_mfma_f32_16x16x32_bf16 v[76:79],v[140:143],a[164:167],v[76:79]
v_mfma_f32_16x16x32_bf16 v[84:87],v[140:143],a[188:191],v[84:87]
v_mfma_f32_16x16x32_bf16 v[92:95],v[140:143],a[212:215],v[92:95]
v_mfma_f32_16x16x32_bf16 v[100:103],v[140:143],a[236:239],v[100:103]
v_mfma_f32_16x16x32_bf16 v[108:111],v[140:143],v[148:151],v[108:111]
s_waitcnt lgkmcnt(2)
v_mfma_f32_16x16x32_bf16 v[160:163],v[112:115],v[20:23],v[160:163]
s_add_u32 m0,s29,0
ds_read_b64_tr_b16 v[128:129],v2 offset:30848
ds_read_b64_tr_b16 v[130:131],v2 offset:24704
v_mfma_f32_16x16x32_bf16 v[208:211],v[112:115],v[26:29],v[208:211]
ds_read_b64_tr_b16 v[132:133],v3 offset:30848
ds_read_b64_tr_b16 v[134:135],v3 offset:24704
v_mfma_f32_16x16x32_bf16 a[0:3],v[112:115],v[32:35],a[0:3]
ds_read_b64_tr_b16 v[136:137],v4 offset:30848
ds_read_b64_tr_b16 v[138:139],v4 offset:24704
v_mfma_f32_16x16x32_bf16 a[48:51],v[112:115],v[38:41],a[48:51]
ds_read_b64_tr_b16 v[140:141],v5 offset:30848
ds_read_b64_tr_b16 v[142:143],v5 offset:24704
v_mfma_f32_16x16x32_bf16 a[96:99],v[112:115],v[44:47],a[96:99]
ds_read_b64_tr_b16 v[112:113],v2 offset:30976
ds_read_b64_tr_b16 v[114:115],v2 offset:24832
v_mfma_f32_16x16x32_bf16 v[164:167],v[116:119],v[20:23],v[164:167]
v_fma_f32 v90,v90,s36,v15
v_fma_f32 v91,v91,s36,v15
v_mfma_f32_16x16x32_bf16 v[212:215],v[116:119],v[26:29],v[212:215]
v_exp_f32 v90,v90
v_mfma_f32_16x16x32_bf16 a[4:7],v[116:119],v[32:35],a[4:7]
buffer_load_dwordx4 v6,s[12:15],s28 offen offset:0 nt lds
v_mfma_f32_16x16x32_bf16 a[52:55],v[116:119],v[38:41],a[52:55]
v_exp_f32 v91,v91
v_mfma_f32_16x16x32_bf16 a[100:103],v[116:119],v[44:47],a[100:103]
ds_read_b64_tr_b16 v[116:117],v3 offset:30976
ds_read_b64_tr_b16 v[118:119],v3 offset:24832
v_mfma_f32_16x16x32_bf16 v[168:171],v[120:123],v[20:23],v[168:171]
v_cvt_pk_bf16_f32 v31,v90,v91
v_fma_f32 v96,v96,s36,v16
v_mfma_f32_16x16x32_bf16 v[216:219],v[120:123],v[26:29],v[216:219]
v_fma_f32 v97,v97,s36,v16
v_fma_f32 v98,v98,s36,v16
v_mfma_f32_16x16x32_bf16 a[8:11],v[120:123],v[32:35],a[8:11]
v_fma_f32 v99,v99,s36,v16
v_fma_f32 v104,v104,s36,v17
v_mfma_f32_16x16x32_bf16 a[56:59],v[120:123],v[38:41],a[56:59]
v_exp_f32 v96,v96
v_mfma_f32_16x16x32_bf16 a[104:107],v[120:123],v[44:47],a[104:107]
s_waitcnt lgkmcnt(2)
ds_read_b64_tr_b16 v[120:121],v4 offset:30976
ds_read_b64_tr_b16 v[122:123],v4 offset:24832
v_mfma_f32_16x16x32_bf16 v[172:175],v[124:127],v[20:23],v[172:175]
v_exp_f32 v97,v97
v_mfma_f32_16x16x32_bf16 v[220:223],v[124:127],v[26:29],v[220:223]
v_exp_f32 v98,v98
v_mfma_f32_16x16x32_bf16 a[12:15],v[124:127],v[32:35],a[12:15]
buffer_load_dwordx4 v7,s[12:15],s28 offen offset:1024 nt lds
v_mfma_f32_16x16x32_bf16 a[60:63],v[124:127],v[38:41],a[60:63]
v_exp_f32 v99,v99
v_mfma_f32_16x16x32_bf16 a[108:111],v[124:127],v[44:47],a[108:111]
ds_read_b64_tr_b16 v[124:125],v5 offset:30976
ds_read_b64_tr_b16 v[126:127],v5 offset:24832
v_mfma_f32_16x16x32_bf16 v[176:179],v[128:131],v[20:23],v[176:179]
v_cvt_pk_bf16_f32 v36,v96,v97
v_cvt_pk_bf16_f32 v37,v98,v99
v_mfma_f32_16x16x32_bf16 v[224:227],v[128:131],v[26:29],v[224:227]
v_fma_f32 v105,v105,s36,v17
v_fma_f32 v106,v106,s36,v17
v_mfma_f32_16x16x32_bf16 a[16:19],v[128:131],v[32:35],a[16:19]
v_fma_f32 v107,v107,s36,v17
v_fma_f32 v76,v76,s36,v13
v_mfma_f32_16x16x32_bf16 a[64:67],v[128:131],v[38:41],a[64:67]
v_exp_f32 v104,v104
v_mfma_f32_16x16x32_bf16 a[112:115],v[128:131],v[44:47],a[112:115]
v_exp_f32 v105,v105
v_mfma_f32_16x16x32_bf16 v[180:183],v[132:135],v[20:23],v[180:183]
v_exp_f32 v106,v106
v_mfma_f32_16x16x32_bf16 v[228:231],v[132:135],v[26:29],v[228:231]
v_exp_f32 v107,v107
v_mfma_f32_16x16x32_bf16 a[20:23],v[132:135],v[32:35],a[20:23]
buffer_load_dwordx4 v8,s[12:15],s28 offen offset:2048 nt lds
v_mfma_f32_16x16x32_bf16 a[68:71],v[132:135],v[38:41],a[68:71]
s_add_u32 s28,s28,3072
v_cvt_pk_bf16_f32 v42,v104,v105
v_cvt_pk_bf16_f32 v43,v106,v107
v_mfma_f32_16x16x32_bf16 a[116:119],v[132:135],v[44:47],a[116:119]
s_add_u32 s29,s29,3072
v_fma_f32 v77,v77,s36,v13
v_fma_f32 v78,v78,s36,v13
v_mfma_f32_16x16x32_bf16 v[184:187],v[136:139],v[20:23],v[184:187]
s_add_u32 m0,s23,24576
v_fma_f32 v79,v79,s36,v13
v_fma_f32 v84,v84,s36,v14
v_mfma_f32_16x16x32_bf16 v[232:235],v[136:139],v[26:29],v[232:235]
v_exp_f32 v76,v76
v_mfma_f32_16x16x32_bf16 a[24:27],v[136:139],v[32:35],a[24:27]
v_exp_f32 v77,v77
v_mfma_f32_16x16x32_bf16 a[72:75],v[136:139],v[38:41],a[72:75]
v_exp_f32 v78,v78
v_mfma_f32_16x16x32_bf16 a[120:123],v[136:139],v[44:47],a[120:123]
v_exp_f32 v79,v79
v_mfma_f32_16x16x32_bf16 v[188:191],v[140:143],v[20:23],v[188:191]
v_fma_f32 v85,v85,s36,v14
v_fma_f32 v86,v86,s36,v14
v_mfma_f32_16x16x32_bf16 v[236:239],v[140:143],v[26:29],v[236:239]
v_fma_f32 v87,v87,s36,v14
v_fma_f32 v92,v92,s36,v15
v_mfma_f32_16x16x32_bf16 a[28:31],v[140:143],v[32:35],a[28:31]
v_exp_f32 v84,v84
v_mfma_f32_16x16x32_bf16 a[76:79],v[140:143],v[38:41],a[76:79]
v_exp_f32 v85,v85
v_mfma_f32_16x16x32_bf16 a[124:127],v[140:143],v[44:47],a[124:127]
v_exp_f32 v86,v86
v_mfma_f32_16x16x32_bf16 v[192:195],v[112:115],v[20:23],v[192:195]
v_exp_f32 v87,v87
s_waitcnt vmcnt(12) lgkmcnt(0)
v_mfma_f32_16x16x32_bf16 v[240:243],v[112:115],v[26:29],v[240:243]
s_barrier
v_mfma_f32_16x16x32_bf16 a[32:35],v[112:115],v[32:35],a[32:35]
ds_read_b128 v[128:131],v0 offset:12288
v_fma_f32 v93,v93,s36,v15
v_mfma_f32_16x16x32_bf16 a[80:83],v[112:115],v[38:41],a[80:83]
ds_read_b128 v[132:135],v1 offset:12288
v_fma_f32 v94,v94,s36,v15
v_mfma_f32_16x16x32_bf16 a[128:131],v[112:115],v[44:47],a[128:131]
ds_read_b128 v[136:139],v0 offset:12416
v_fma_f32 v95,v95,s36,v15
v_mfma_f32_16x16x32_bf16 v[196:199],v[116:119],v[20:23],v[196:199]
ds_read_b128 v[140:143],v1 offset:12416
v_fma_f32 v100,v100,s36,v16
v_mfma_f32_16x16x32_bf16 v[244:247],v[116:119],v[26:29],v[244:247]
ds_read_b128 v[112:115],v0 offset:12544
v_fma_f32 v101,v101,s36,v16
v_mfma_f32_16x16x32_bf16 a[36:39],v[116:119],v[32:35],a[36:39]
buffer_load_dwordx4 v6,s[8:11],s21 offen offset:0 lds
v_mfma_f32_16x16x32_bf16 a[84:87],v[116:119],v[38:41],a[84:87]
v_exp_f32 v92,v92
v_mfma_f32_16x16x32_bf16 a[132:135],v[116:119],v[44:47],a[132:135]
ds_read_b128 v[116:119],v1 offset:12544
v_fma_f32 v102,v102,s36,v16
v_mfma_f32_16x16x32_bf16 v[200:203],v[120:123],v[20:23],v[200:203]
v_exp_f32 v93,v93
v_mfma_f32_16x16x32_bf16 v[248:251],v[120:123],v[26:29],v[248:251]
v_exp_f32 v94,v94
v_mfma_f32_16x16x32_bf16 a[40:43],v[120:123],v[32:35],a[40:43]
v_exp_f32 v95,v95
v_mfma_f32_16x16x32_bf16 a[88:91],v[120:123],v[38:41],a[88:91]
v_fma_f32 v103,v103,s36,v16
v_fma_f32 v108,v108,s36,v17
v_mfma_f32_16x16x32_bf16 a[136:139],v[120:123],v[44:47],a[136:139]
ds_read_b128 v[120:123],v0 offset:18432
v_fma_f32 v109,v109,s36,v17
v_mfma_f32_16x16x32_bf16 v[204:207],v[124:127],v[20:23],v[204:207]
v_cvt_pk_bf16_f32 v20,v76,v77
v_cvt_pk_bf16_f32 v21,v78,v79
v_mfma_f32_16x16x32_bf16 v[252:255],v[124:127],v[26:29],v[252:255]
v_cvt_pk_bf16_f32 v26,v84,v85
v_cvt_pk_bf16_f32 v27,v86,v87
v_mfma_f32_16x16x32_bf16 v[52:55],v[48:51],v[18:21],v[52:55]
v_exp_f32 v100,v100
v_mfma_f32_16x16x32_bf16 v[56:59],v[48:51],v[24:27],v[56:59]
v_exp_f32 v101,v101
v_mfma_f32_16x16x32_bf16 a[44:47],v[124:127],v[32:35],a[44:47]
buffer_load_dwordx4 v7,s[8:11],s21 offen offset:1024 lds
v_mfma_f32_16x16x32_bf16 a[92:95],v[124:127],v[38:41],a[92:95]
v_cvt_pk_bf16_f32 v32,v92,v93
v_cvt_pk_bf16_f32 v33,v94,v95
v_mfma_f32_16x16x32_bf16 a[140:143],v[124:127],v[44:47],a[140:143]
ds_read_b128 v[124:127],v1 offset:18432
v_fma_f32 v110,v110,s36,v17
v_mfma_f32_16x16x32_bf16 v[60:63],v[48:51],v[30:33],v[60:63]
s_waitcnt lgkmcnt(1)
v_exp_f32 v102,v102
v_mfma_f32_16x16x32_bf16 v[72:75],v[128:131],a[144:147],0
v_exp_f32 v103,v103
v_mfma_f32_16x16x32_bf16 v[80:83],v[128:131],a[168:171],0
v_fma_f32 v111,v111,s36,v17
v_cvt_pk_bf16_f32 v38,v100,v101
v_mfma_f32_16x16x32_bf16 v[88:91],v[128:131],a[192:195],0
v_cvt_pk_bf16_f32 v39,v102,v103
v_mfma_f32_16x16x32_bf16 v[96:99],v[128:131],a[216:219],0
v_exp_f32 v108,v108
v_mfma_f32_16x16x32_bf16 v[64:67],v[48:51],v[36:39],v[64:67]
v_exp_f32 v109,v109
v_mfma_f32_16x16x32_bf16 v[104:107],v[128:131],a[240:243],0
ds_read_b128 v[128:131],v0 offset:18560
v_cvt_pk_bf16_f32 v44,v108,v109
v_mfma_f32_16x16x32_bf16 v[72:75],v[132:135],a[148:151],v[72:75]
v_exp_f32 v110,v110
v_mfma_f32_16x16x32_bf16 v[80:83],v[132:135],a[172:175],v[80:83]
buffer_load_dwordx4 v8,s[8:11],s21 offen offset:2048 lds
v_mfma_f32_16x16x32_bf16 v[88:91],v[132:135],a[196:199],v[88:91]
s_add_u32 s21,s21,12288
v_exp_f32 v111,v111
v_mfma_f32_16x16x32_bf16 v[96:99],v[132:135],a[220:223],v[96:99]
s_add_u32 m0,s22,0
v_cvt_pk_bf16_f32 v45,v110,v111
v_mfma_f32_16x16x32_bf16 v[104:107],v[132:135],a[244:247],v[104:107]
ds_read_b128 v[132:135],v1 offset:18560
v_mfma_f32_16x16x32_bf16 v[68:71],v[48:51],v[42:45],v[68:71]
v_mfma_f32_16x16x32_bf16 v[72:75],v[136:139],a[152:155],v[72:75]
v_mfma_f32_16x16x32_bf16 v[80:83],v[136:139],a[176:179],v[80:83]
v_mfma_f32_16x16x32_bf16 v[88:91],v[136:139],a[200:203],v[88:91]
v_mfma_f32_16x16x32_bf16 v[96:99],v[136:139],a[224:227],v[96:99]
v_mfma_f32_16x16x32_bf16 v[104:107],v[136:139],a[248:251],v[104:107]
ds_read_b128 v[136:139],v0 offset:18688
v_mfma_f32_16x16x32_bf16 v[72:75],v[140:143],a[156:159],v[72:75]
v_mfma_f32_16x16x32_bf16 v[80:83],v[140:143],a[180:183],v[80:83]
buffer_load_dwordx4 v6,s[4:7],s20 offen offset:0 lds
v_mfma_f32_16x16x32_bf16 v[88:91],v[140:143],a[204:207],v[88:91]
v_mfma_f32_16x16x32_bf16 v[96:99],v[140:143],a[228:231],v[96:99]
v_mfma_f32_16x16x32_bf16 v[104:107],v[140:143],a[252:255],v[104:107]
ds_read_b128 v[140:143],v1 offset:18688
v_mfma_f32_16x16x32_bf16 v[72:75],v[112:115],a[160:163],v[72:75]
v_mfma_f32_16x16x32_bf16 v[80:83],v[112:115],a[184:187],v[80:83]
v_mfma_f32_16x16x32_bf16 v[88:91],v[112:115],a[208:211],v[88:91]
v_mfma_f32_16x16x32_bf16 v[96:99],v[112:115],a[232:235],v[96:99]
v_mfma_f32_16x16x32_bf16 v[104:107],v[112:115],v[144:147],v[104:107]
v_mfma_f32_16x16x32_bf16 v[72:75],v[116:119],a[164:167],v[72:75]
v_mfma_f32_16x16x32_bf16 v[80:83],v[116:119],a[188:191],v[80:83]
v_mfma_f32_16x16x32_bf16 v[88:91],v[116:119],a[212:215],v[88:91]
v_mfma_f32_16x16x32_bf16 v[96:99],v[116:119],a[236:239],v[96:99]
buffer_load_dwordx4 v7,s[4:7],s20 offen offset:1024 lds
v_mfma_f32_16x16x32_bf16 v[104:107],v[116:119],v[148:151],v[104:107]
v_mfma_f32_16x16x32_bf16 v[76:79],v[120:123],a[144:147],0
v_mfma_f32_16x16x32_bf16 v[84:87],v[120:123],a[168:171],0
v_mfma_f32_16x16x32_bf16 v[92:95],v[120:123],a[192:195],0
v_fma_f32 v72,v72,s36,v13
v_fma_f32 v73,v73,s36,v13
v_mfma_f32_16x16x32_bf16 v[100:103],v[120:123],a[216:219],0
v_fma_f32 v74,v74,s36,v13
v_fma_f32 v75,v75,s36,v13
v_mfma_f32_16x16x32_bf16 v[108:111],v[120:123],a[240:243],0
s_waitcnt lgkmcnt(0)
v_fma_f32 v80,v80,s36,v14
v_fma_f32 v81,v81,s36,v14
v_mfma_f32_16x16x32_bf16 v[76:79],v[124:127],a[148:151],v[76:79]
v_fma_f32 v82,v82,s36,v14
v_fma_f32 v83,v83,s36,v14
v_mfma_f32_16x16x32_bf16 v[84:87],v[124:127],a[172:175],v[84:87]
v_fma_f32 v88,v88,s36,v15
v_fma_f32 v89,v89,s36,v15
v_mfma_f32_16x16x32_bf16 v[92:95],v[124:127],a[196:199],v[92:95]
v_exp_f32 v72,v72
v_mfma_f32_16x16x32_bf16 v[100:103],v[124:127],a[220:223],v[100:103]
v_exp_f32 v73,v73
v_mfma_f32_16x16x32_bf16 v[108:111],v[124:127],a[244:247],v[108:111]
buffer_load_dwordx4 v8,s[4:7],s20 offen offset:2048 lds
v_mfma_f32_16x16x32_bf16 v[76:79],v[128:131],a[152:155],v[76:79]
s_add_u32 s20,s20,12288
v_exp_f32 v74,v74
v_mfma_f32_16x16x32_bf16 v[84:87],v[128:131],a[176:179],v[84:87]
v_exp_f32 v75,v75
v_mfma_f32_16x16x32_bf16 v[92:95],v[128:131],a[200:203],v[92:95]
v_exp_f32 v80,v80
v_mfma_f32_16x16x32_bf16 v[100:103],v[128:131],a[224:227],v[100:103]
v_exp_f32 v81,v81
v_mfma_f32_16x16x32_bf16 v[108:111],v[128:131],a[248:251],v[108:111]
ds_read_b64_tr_b16 v[112:113],v2 offset:0
v_mfma_f32_16x16x32_bf16 v[76:79],v[132:135],a[156:159],v[76:79]
ds_read_b64_tr_b16 v[114:115],v2 offset:6144
v_cvt_pk_bf16_f32 v22,v72,v73
v_mfma_f32_16x16x32_bf16 v[84:87],v[132:135],a[180:183],v[84:87]
v_exp_f32 v82,v82
v_mfma_f32_16x16x32_bf16 v[92:95],v[132:135],a[204:207],v[92:95]
ds_read_b64_tr_b16 v[116:117],v3 offset:0
ds_read_b64_tr_b16 v[118:119],v3 offset:6144
v_mfma_f32_16x16x32_bf16 v[100:103],v[132:135],a[228:231],v[100:103]
v_exp_f32 v83,v83
v_mfma_f32_16x16x32_bf16 v[108:111],v[132:135],a[252:255],v[108:111]
ds_read_b64_tr_b16 v[120:121],v4 offset:0
v_mfma_f32_16x16x32_bf16 v[76:79],v[136:139],a[160:163],v[76:79]
ds_read_b64_tr_b16 v[122:123],v4 offset:6144
v_cvt_pk_bf16_f32 v23,v74,v75
v_mfma_f32_16x16x32_bf16 v[84:87],v[136:139],a[184:187],v[84:87]
v_exp_f32 v88,v88
v_mfma_f32_16x16x32_bf16 v[92:95],v[136:139],a[208:211],v[92:95]
ds_read_b64_tr_b16 v[124:125],v5 offset:0
ds_read_b64_tr_b16 v[126:127],v5 offset:6144
v_mfma_f32_16x16x32_bf16 v[100:103],v[136:139],a[232:235],v[100:103]
v_exp_f32 v89,v89
v_mfma_f32_16x16x32_bf16 v[108:111],v[136:139],v[144:147],v[108:111]
v_cvt_pk_bf16_f32 v28,v80,v81
v_cvt_pk_bf16_f32 v29,v82,v83
v_mfma_f32_16x16x32_bf16 v[76:79],v[140:143],a[164:167],v[76:79]
v_cvt_pk_bf16_f32 v34,v88,v89
v_mfma_f32_16x16x32_bf16 v[84:87],v[140:143],a[188:191],v[84:87]
v_mfma_f32_16x16x32_bf16 v[92:95],v[140:143],a[212:215],v[92:95]
v_mfma_f32_16x16x32_bf16 v[100:103],v[140:143],a[236:239],v[100:103]
v_mfma_f32_16x16x32_bf16 v[108:111],v[140:143],v[148:151],v[108:111]
s_waitcnt lgkmcnt(2)
v_mfma_f32_16x16x32_bf16 v[160:163],v[112:115],v[18:21],v[160:163]
s_add_u32 m0,s23,0
ds_read_b64_tr_b16 v[128:129],v2 offset:128
ds_read_b64_tr_b16 v[130:131],v2 offset:6272
v_mfma_f32_16x16x32_bf16 v[208:211],v[112:115],v[24:27],v[208:211]
ds_read_b64_tr_b16 v[132:133],v3 offset:128
ds_read_b64_tr_b16 v[134:135],v3 offset:6272
v_mfma_f32_16x16x32_bf16 a[0:3],v[112:115],v[30:33],a[0:3]
ds_read_b64_tr_b16 v[136:137],v4 offset:128
ds_read_b64_tr_b16 v[138:139],v4 offset:6272
v_mfma_f32_16x16x32_bf16 a[48:51],v[112:115],v[36:39],a[48:51]
ds_read_b64_tr_b16 v[140:141],v5 offset:128
ds_read_b64_tr_b16 v[142:143],v5 offset:6272
v_mfma_f32_16x16x32_bf16 a[96:99],v[112:115],v[42:45],a[96:99]
ds_read_b64_tr_b16 v[112:113],v2 offset:256
ds_read_b64_tr_b16 v[114:115],v2 offset:6400
v_mfma_f32_16x16x32_bf16 v[164:167],v[116:119],v[18:21],v[164:167]
v_fma_f32 v90,v90,s36,v15
v_fma_f32 v91,v91,s36,v15
v_mfma_f32_16x16x32_bf16 v[212:215],v[116:119],v[24:27],v[212:215]
v_exp_f32 v90,v90
v_mfma_f32_16x16x32_bf16 a[4:7],v[116:119],v[30:33],a[4:7]
v_exp_f32 v91,v91
v_mfma_f32_16x16x32_bf16 a[52:55],v[116:119],v[36:39],a[52:55]
v_cvt_pk_bf16_f32 v35,v90,v91
v_fma_f32 v96,v96,s36,v16
v_mfma_f32_16x16x32_bf16 a[100:103],v[116:119],v[42:45],a[100:103]
ds_read_b64_tr_b16 v[116:117],v3 offset:256
ds_read_b64_tr_b16 v[118:119],v3 offset:6400
v_mfma_f32_16x16x32_bf16 v[168:171],v[120:123],v[18:21],v[168:171]
v_fma_f32 v97,v97,s36,v16
v_fma_f32 v98,v98,s36,v16
v_mfma_f32_16x16x32_bf16 v[216:219],v[120:123],v[24:27],v[216:219]
v_fma_f32 v99,v99,s36,v16
v_fma_f32 v104,v104,s36,v17
v_mfma_f32_16x16x32_bf16 a[8:11],v[120:123],v[30:33],a[8:11]
v_exp_f32 v96,v96
v_mfma_f32_16x16x32_bf16 a[56:59],v[120:123],v[36:39],a[56:59]
v_exp_f32 v97,v97
v_mfma_f32_16x16x32_bf16 a[104:107],v[120:123],v[42:45],a[104:107]
s_waitcnt lgkmcnt(2)
ds_read_b64_tr_b16 v[120:121],v4 offset:256
ds_read_b64_tr_b16 v[122:123],v4 offset:6400
v_mfma_f32_16x16x32_bf16 v[172:175],v[124:127],v[18:21],v[172:175]
v_exp_f32 v98,v98
v_mfma_f32_16x16x32_bf16 v[220:223],v[124:127],v[24:27],v[220:223]
v_exp_f32 v99,v99
v_mfma_f32_16x16x32_bf16 a[12:15],v[124:127],v[30:33],a[12:15]
v_cvt_pk_bf16_f32 v40,v96,v97
v_cvt_pk_bf16_f32 v41,v98,v99
v_mfma_f32_16x16x32_bf16 a[60:63],v[124:127],v[36:39],a[60:63]
v_fma_f32 v105,v105,s36,v17
v_fma_f32 v106,v106,s36,v17
v_mfma_f32_16x16x32_bf16 a[108:111],v[124:127],v[42:45],a[108:111]
ds_read_b64_tr_b16 v[124:125],v5 offset:256
ds_read_b64_tr_b16 v[126:127],v5 offset:6400
v_mfma_f32_16x16x32_bf16 v[176:179],v[128:131],v[18:21],v[176:179]
v_fma_f32 v107,v107,s36,v17
v_fma_f32 v76,v76,s36,v13
v_mfma_f32_16x16x32_bf16 v[224:227],v[128:131],v[24:27],v[224:227]
v_exp_f32 v104,v104
v_mfma_f32_16x16x32_bf16 a[16:19],v[128:131],v[30:33],a[16:19]
v_exp_f32 v105,v105
v_mfma_f32_16x16x32_bf16 a[64:67],v[128:131],v[36:39],a[64:67]
v_exp_f32 v106,v106
v_mfma_f32_16x16x32_bf16 a[112:115],v[128:131],v[42:45],a[112:115]
v_exp_f32 v107,v107
v_mfma_f32_16x16x32_bf16 v[180:183],v[132:135],v[18:21],v[180:183]
v_cvt_pk_bf16_f32 v46,v104,v105
v_cvt_pk_bf16_f32 v47,v106,v107
v_mfma_f32_16x16x32_bf16 v[228:231],v[132:135],v[24:27],v[228:231]
v_fma_f32 v77,v77,s36,v13
v_fma_f32 v78,v78,s36,v13
v_mfma_f32_16x16x32_bf16 a[20:23],v[132:135],v[30:33],a[20:23]
v_fma_f32 v79,v79,s36,v13
v_fma_f32 v84,v84,s36,v14
v_mfma_f32_16x16x32_bf16 a[68:71],v[132:135],v[36:39],a[68:71]
v_exp_f32 v76,v76
v_mfma_f32_16x16x32_bf16 a[116:119],v[132:135],v[42:45],a[116:119]
v_exp_f32 v77,v77
v_mfma_f32_16x16x32_bf16 v[184:187],v[136:139],v[18:21],v[184:187]
v_exp_f32 v78,v78
v_mfma_f32_16x16x32_bf16 v[232:235],v[136:139],v[24:27],v[232:235]
v_exp_f32 v79,v79
v_mfma_f32_16x16x32_bf16 a[24:27],v[136:139],v[30:33],a[24:27]
v_fma_f32 v85,v85,s36,v14
v_fma_f32 v86,v86,s36,v14
v_mfma_f32_16x16x32_bf16 a[72:75],v[136:139],v[36:39],a[72:75]
v_fma_f32 v87,v87,s36,v14
v_fma_f32 v92,v92,s36,v15
v_mfma_f32_16x16x32_bf16 a[120:123],v[136:139],v[42:45],a[120:123]
v_exp_f32 v84,v84
v_mfma_f32_16x16x32_bf16 v[188:191],v[140:143],v[18:21],v[188:191]
v_exp_f32 v85,v85
v_mfma_f32_16x16x32_bf16 v[236:239],v[140:143],v[24:27],v[236:239]
v_exp_f32 v86,v86
v_mfma_f32_16x16x32_bf16 a[28:31],v[140:143],v[30:33],a[28:31]
v_exp_f32 v87,v87
v_mfma_f32_16x16x32_bf16 a[76:79],v[140:143],v[36:39],a[76:79]
v_fma_f32 v93,v93,s36,v15
v_fma_f32 v94,v94,s36,v15
v_mfma_f32_16x16x32_bf16 a[124:127],v[140:143],v[42:45],a[124:127]
v_fma_f32 v95,v95,s36,v15
v_fma_f32 v100,v100,s36,v16
v_mfma_f32_16x16x32_bf16 v[192:195],v[112:115],v[18:21],v[192:195]
v_exp_f32 v92,v92
v_mfma_f32_16x16x32_bf16 v[240:243],v[112:115],v[24:27],v[240:243]
v_exp_f32 v93,v93
s_waitcnt vmcnt(9) lgkmcnt(0)
v_mfma_f32_16x16x32_bf16 a[32:35],v[112:115],v[30:33],a[32:35]
s_barrier
v_mfma_f32_16x16x32_bf16 a[80:83],v[112:115],v[36:39],a[80:83]
ds_read_b128 v[128:131],v0 offset:24576
v_fma_f32 v101,v101,s36,v16
v_mfma_f32_16x16x32_bf16 a[128:131],v[112:115],v[42:45],a[128:131]
ds_read_b128 v[132:135],v1 offset:24576
v_fma_f32 v102,v102,s36,v16
v_mfma_f32_16x16x32_bf16 v[196:199],v[116:119],v[18:21],v[196:199]
ds_read_b128 v[136:139],v0 offset:24704
v_fma_f32 v103,v103,s36,v16
v_mfma_f32_16x16x32_bf16 v[244:247],v[116:119],v[24:27],v[244:247]
ds_read_b128 v[140:143],v1 offset:24704
v_fma_f32 v108,v108,s36,v17
v_mfma_f32_16x16x32_bf16 a[36:39],v[116:119],v[30:33],a[36:39]
ds_read_b128 v[152:155],v10 offset:6144
v_fma_f32 v109,v109,s36,v17
v_mfma_f32_16x16x32_bf16 a[84:87],v[116:119],v[36:39],a[84:87]
buffer_load_dwordx4 v6,s[8:11],s21 offen offset:0 lds
v_mfma_f32_16x16x32_bf16 a[132:135],v[116:119],v[42:45],a[132:135]
ds_read_b128 v[112:115],v0 offset:24832
v_fma_f32 v110,v110,s36,v17
v_mfma_f32_16x16x32_bf16 v[200:203],v[120:123],v[18:21],v[200:203]
ds_read_b128 v[116:119],v1 offset:24832
v_fma_f32 v111,v111,s36,v17
v_mfma_f32_16x16x32_bf16 v[248:251],v[120:123],v[24:27],v[248:251]
v_exp_f32 v94,v94
v_mfma_f32_16x16x32_bf16 a[40:43],v[120:123],v[30:33],a[40:43]
v_exp_f32 v95,v95
v_mfma_f32_16x16x32_bf16 a[88:91],v[120:123],v[36:39],a[88:91]
v_exp_f32 v100,v100
v_mfma_f32_16x16x32_bf16 a[136:139],v[120:123],v[42:45],a[136:139]
ds_read_b128 v[120:123],v0 offset:30720
v_mfma_f32_16x16x32_bf16 v[204:207],v[124:127],v[18:21],v[204:207]
v_cvt_pk_bf16_f32 v20,v76,v77
v_cvt_pk_bf16_f32 v21,v78,v79
v_mfma_f32_16x16x32_bf16 v[252:255],v[124:127],v[24:27],v[252:255]
v_cvt_pk_bf16_f32 v26,v84,v85
v_cvt_pk_bf16_f32 v27,v86,v87
v_mfma_f32_16x16x32_bf16 v[52:55],v[48:51],v[20:23],v[52:55]
v_exp_f32 v101,v101
v_mfma_f32_16x16x32_bf16 v[56:59],v[48:51],v[26:29],v[56:59]
v_exp_f32 v102,v102
v_mfma_f32_16x16x32_bf16 a[44:47],v[124:127],v[30:33],a[44:47]
v_cvt_pk_bf16_f32 v32,v92,v93
v_cvt_pk_bf16_f32 v33,v94,v95
v_mfma_f32_16x16x32_bf16 a[92:95],v[124:127],v[36:39],a[92:95]
s_waitcnt lgkmcnt(1)
buffer_store_dwordx4 v[152:155],v9,s[16:19],s27 offen offset:0 nt
buffer_load_dwordx4 v7,s[8:11],s21 offen offset:1024 lds
v_mfma_f32_16x16x32_bf16 v[60:63],v[48:51],v[32:35],v[60:63]
v_exp_f32 v103,v103
v_mfma_f32_16x16x32_bf16 a[140:143],v[124:127],v[42:45],a[140:143]
ds_read_b128 v[124:127],v1 offset:30720
v_cvt_pk_bf16_f32 v38,v100,v101
v_mfma_f32_16x16x32_bf16 v[72:75],v[128:131],a[144:147],0
v_cvt_pk_bf16_f32 v39,v102,v103
v_mfma_f32_16x16x32_bf16 v[80:83],v[128:131],a[168:171],0
v_exp_f32 v108,v108
v_mfma_f32_16x16x32_bf16 v[64:67],v[48:51],v[38:41],v[64:67]
v_exp_f32 v109,v109
v_mfma_f32_16x16x32_bf16 v[88:91],v[128:131],a[192:195],0
ds_read_b128 v[156:159],v10 offset:7168
v_cvt_pk_bf16_f32 v44,v108,v109
v_mfma_f32_16x16x32_bf16 v[96:99],v[128:131],a[216:219],0
v_exp_f32 v110,v110
v_mfma_f32_16x16x32_bf16 v[104:107],v[128:131],a[240:243],0
ds_read_b128 v[128:131],v0 offset:30848
v_mfma_f32_16x16x32_bf16 v[72:75],v[132:135],a[148:151],v[72:75]
v_exp_f32 v111,v111
v_mfma_f32_16x16x32_bf16 v[80:83],v[132:135],a[172:175],v[80:83]
buffer_load_dwordx4 v8,s[8:11],s21 offen offset:2048 lds
v_mfma_f32_16x16x32_bf16 v[88:91],v[132:135],a[196:199],v[88:91]
s_add_u32 s21,s21,12288
v_cvt_pk_bf16_f32 v45,v110,v111
v_mfma_f32_16x16x32_bf16 v[96:99],v[132:135],a[220:223],v[96:99]
s_cmp_eq_u32 s38,1
v_mfma_f32_16x16x32_bf16 v[68:71],v[48:51],v[44:47],v[68:71]
s_cselect_b32 s20,s26,s20
v_mfma_f32_16x16x32_bf16 v[104:107],v[132:135],a[244:247],v[104:107]
s_add_u32 m0,s22,12288
ds_read_b128 v[132:135],v1 offset:30848
v_mfma_f32_16x16x32_bf16 v[72:75],v[136:139],a[152:155],v[72:75]
v_mfma_f32_16x16x32_bf16 v[80:83],v[136:139],a[176:179],v[80:83]
v_mfma_f32_16x16x32_bf16 v[88:91],v[136:139],a[200:203],v[88:91]
v_mfma_f32_16x16x32_bf16 v[96:99],v[136:139],a[224:227],v[96:99]
v_mfma_f32_16x16x32_bf16 v[104:107],v[136:139],a[248:251],v[104:107]
ds_read_b128 v[136:139],v0 offset:30976
v_mfma_f32_16x16x32_bf16 v[72:75],v[140:143],a[156:159],v[72:75]
v_mfma_f32_16x16x32_bf16 v[80:83],v[140:143],a[180:183],v[80:83]
v_mfma_f32_16x16x32_bf16 v[88:91],v[140:143],a[204:207],v[88:91]
s_waitcnt lgkmcnt(2)
buffer_store_dwordx4 v[156:159],v9,s[16:19],s27 offen offset:128 nt
buffer_load_dwordx4 v6,s[4:7],s20 offen offset:0 lds
v_mfma_f32_16x16x32_bf16 v[96:99],v[140:143],a[228:231],v[96:99]
v_mfma_f32_16x16x32_bf16 v[104:107],v[140:143],a[252:255],v[104:107]
ds_read_b128 v[140:143],v1 offset:30976
v_mfma_f32_16x16x32_bf16 v[72:75],v[112:115],a[160:163],v[72:75]
v_mfma_f32_16x16x32_bf16 v[80:83],v[112:115],a[184:187],v[80:83]
v_mfma_f32_16x16x32_bf16 v[88:91],v[112:115],a[208:211],v[88:91]
v_mfma_f32_16x16x32_bf16 v[96:99],v[112:115],a[232:235],v[96:99]
ds_read_b128 v[152:155],v10 offset:8192
v_mfma_f32_16x16x32_bf16 v[104:107],v[112:115],v[144:147],v[104:107]
v_mfma_f32_16x16x32_bf16 v[72:75],v[116:119],a[164:167],v[72:75]
v_mfma_f32_16x16x32_bf16 v[80:83],v[116:119],a[188:191],v[80:83]
v_mfma_f32_16x16x32_bf16 v[88:91],v[116:119],a[212:215],v[88:91]
buffer_load_dwordx4 v7,s[4:7],s20 offen offset:1024 lds
v_mfma_f32_16x16x32_bf16 v[96:99],v[116:119],a[236:239],v[96:99]
v_mfma_f32_16x16x32_bf16 v[104:107],v[116:119],v[148:151],v[104:107]
v_mfma_f32_16x16x32_bf16 v[76:79],v[120:123],a[144:147],0
v_mfma_f32_16x16x32_bf16 v[84:87],v[120:123],a[168:171],0
v_mfma_f32_16x16x32_bf16 v[92:95],v[120:123],a[192:195],0
v_fma_f32 v72,v72,s36,v13
v_fma_f32 v73,v73,s36,v13
v_mfma_f32_16x16x32_bf16 v[100:103],v[120:123],a[216:219],0
v_fma_f32 v74,v74,s36,v13
v_fma_f32 v75,v75,s36,v13
v_mfma_f32_16x16x32_bf16 v[108:111],v[120:123],a[240:243],0
v_fma_f32 v80,v80,s36,v14
v_fma_f32 v81,v81,s36,v14
v_mfma_f32_16x16x32_bf16 v[76:79],v[124:127],a[148:151],v[76:79]
v_fma_f32 v82,v82,s36,v14
v_fma_f32 v83,v83,s36,v14
v_mfma_f32_16x16x32_bf16 v[84:87],v[124:127],a[172:175],v[84:87]
v_fma_f32 v88,v88,s36,v15
v_fma_f32 v89,v89,s36,v15
v_mfma_f32_16x16x32_bf16 v[92:95],v[124:127],a[196:199],v[92:95]
v_exp_f32 v72,v72
v_mfma_f32_16x16x32_bf16 v[100:103],v[124:127],a[220:223],v[100:103]
v_exp_f32 v73,v73
v_mfma_f32_16x16x32_bf16 v[108:111],v[124:127],a[244:247],v[108:111]
s_waitcnt lgkmcnt(0)
buffer_store_dwordx4 v[152:155],v9,s[16:19],s27 offen offset:256 nt
buffer_load_dwordx4 v8,s[4:7],s20 offen offset:2048 lds
v_mfma_f32_16x16x32_bf16 v[76:79],v[128:131],a[152:155],v[76:79]
s_add_u32 s20,s20,12288
v_exp_f32 v74,v74
v_mfma_f32_16x16x32_bf16 v[84:87],v[128:131],a[176:179],v[84:87]
s_add_u32 s27,s27,3072
v_exp_f32 v75,v75
v_mfma_f32_16x16x32_bf16 v[92:95],v[128:131],a[200:203],v[92:95]
v_exp_f32 v80,v80
v_mfma_f32_16x16x32_bf16 v[100:103],v[128:131],a[224:227],v[100:103]
v_exp_f32 v81,v81
v_mfma_f32_16x16x32_bf16 v[108:111],v[128:131],a[248:251],v[108:111]
ds_read_b64_tr_b16 v[112:113],v2 offset:18432
ds_read_b64_tr_b16 v[114:115],v2 offset:12288
v_mfma_f32_16x16x32_bf16 v[76:79],v[132:135],a[156:159],v[76:79]
v_exp_f32 v82,v82
v_mfma_f32_16x16x32_bf16 v[84:87],v[132:135],a[180:183],v[84:87]
ds_read_b64_tr_b16 v[116:117],v3 offset:18432
ds_read_b64_tr_b16 v[118:119],v3 offset:12288
v_mfma_f32_16x16x32_bf16 v[92:95],v[132:135],a[204:207],v[92:95]
v_exp_f32 v83,v83
v_mfma_f32_16x16x32_bf16 v[100:103],v[132:135],a[228:231],v[100:103]
v_exp_f32 v88,v88
v_mfma_f32_16x16x32_bf16 v[108:111],v[132:135],a[252:255],v[108:111]
ds_read_b64_tr_b16 v[120:121],v4 offset:18432
ds_read_b64_tr_b16 v[122:123],v4 offset:12288
v_mfma_f32_16x16x32_bf16 v[76:79],v[136:139],a[160:163],v[76:79]
v_exp_f32 v89,v89
v_mfma_f32_16x16x32_bf16 v[84:87],v[136:139],a[184:187],v[84:87]
ds_read_b64_tr_b16 v[124:125],v5 offset:18432
ds_read_b64_tr_b16 v[126:127],v5 offset:12288
v_mfma_f32_16x16x32_bf16 v[92:95],v[136:139],a[208:211],v[92:95]
v_cvt_pk_bf16_f32 v18,v72,v73
v_cvt_pk_bf16_f32 v19,v74,v75
v_mfma_f32_16x16x32_bf16 v[100:103],v[136:139],a[232:235],v[100:103]
v_cvt_pk_bf16_f32 v24,v80,v81
v_cvt_pk_bf16_f32 v25,v82,v83
v_mfma_f32_16x16x32_bf16 v[108:111],v[136:139],v[144:147],v[108:111]
v_cvt_pk_bf16_f32 v30,v88,v89
v_mfma_f32_16x16x32_bf16 v[76:79],v[140:143],a[164:167],v[76:79]
v_mfma_f32_16x16x32_bf16 v[84:87],v[140:143],a[188:191],v[84:87]
v_mfma_f32_16x16x32_bf16 v[92:95],v[140:143],a[212:215],v[92:95]
v_mfma_f32_16x16x32_bf16 v[100:103],v[140:143],a[236:239],v[100:103]
v_mfma_f32_16x16x32_bf16 v[108:111],v[140:143],v[148:151],v[108:111]
s_waitcnt lgkmcnt(2)
v_mfma_f32_16x16x32_bf16 v[160:163],v[112:115],v[20:23],v[160:163]
s_add_u32 m0,s29,0
ds_read_b64_tr_b16 v[128:129],v2 offset:18560
ds_read_b64_tr_b16 v[130:131],v2 offset:12416
v_mfma_f32_16x16x32_bf16 v[208:211],v[112:115],v[26:29],v[208:211]
ds_read_b64_tr_b16 v[132:133],v3 offset:18560
ds_read_b64_tr_b16 v[134:135],v3 offset:12416
v_mfma_f32_16x16x32_bf16 a[0:3],v[112:115],v[32:35],a[0:3]
ds_read_b64_tr_b16 v[136:137],v4 offset:18560
ds_read_b64_tr_b16 v[138:139],v4 offset:12416
v_mfma_f32_16x16x32_bf16 a[48:51],v[112:115],v[38:41],a[48:51]
ds_read_b64_tr_b16 v[140:141],v5 offset:18560
ds_read_b64_tr_b16 v[142:143],v5 offset:12416
v_mfma_f32_16x16x32_bf16 a[96:99],v[112:115],v[44:47],a[96:99]
ds_read_b64_tr_b16 v[112:113],v2 offset:18688
ds_read_b64_tr_b16 v[114:115],v2 offset:12544
v_mfma_f32_16x16x32_bf16 v[164:167],v[116:119],v[20:23],v[164:167]
v_fma_f32 v90,v90,s36,v15
v_fma_f32 v91,v91,s36,v15
v_mfma_f32_16x16x32_bf16 v[212:215],v[116:119],v[26:29],v[212:215]
v_exp_f32 v90,v90
v_mfma_f32_16x16x32_bf16 a[4:7],v[116:119],v[32:35],a[4:7]
buffer_load_dwordx4 v6,s[12:15],s28 offen offset:0 nt lds
v_mfma_f32_16x16x32_bf16 a[52:55],v[116:119],v[38:41],a[52:55]
v_exp_f32 v91,v91
v_mfma_f32_16x16x32_bf16 a[100:103],v[116:119],v[44:47],a[100:103]
ds_read_b64_tr_b16 v[116:117],v3 offset:18688
ds_read_b64_tr_b16 v[118:119],v3 offset:12544
v_mfma_f32_16x16x32_bf16 v[168:171],v[120:123],v[20:23],v[168:171]
v_cvt_pk_bf16_f32 v31,v90,v91
v_fma_f32 v96,v96,s36,v16
v_mfma_f32_16x16x32_bf16 v[216:219],v[120:123],v[26:29],v[216:219]
v_fma_f32 v97,v97,s36,v16
v_fma_f32 v98,v98,s36,v16
v_mfma_f32_16x16x32_bf16 a[8:11],v[120:123],v[32:35],a[8:11]
v_fma_f32 v99,v99,s36,v16
v_fma_f32 v104,v104,s36,v17
v_mfma_f32_16x16x32_bf16 a[56:59],v[120:123],v[38:41],a[56:59]
v_exp_f32 v96,v96
v_mfma_f32_16x16x32_bf16 a[104:107],v[120:123],v[44:47],a[104:107]
s_waitcnt lgkmcnt(2)
ds_read_b64_tr_b16 v[120:121],v4 offset:18688
ds_read_b64_tr_b16 v[122:123],v4 offset:12544
v_mfma_f32_16x16x32_bf16 v[172:175],v[124:127],v[20:23],v[172:175]
v_exp_f32 v97,v97
v_mfma_f32_16x16x32_bf16 v[220:223],v[124:127],v[26:29],v[220:223]
v_exp_f32 v98,v98
v_mfma_f32_16x16x32_bf16 a[12:15],v[124:127],v[32:35],a[12:15]
buffer_load_dwordx4 v7,s[12:15],s28 offen offset:1024 nt lds
v_mfma_f32_16x16x32_bf16 a[60:63],v[124:127],v[38:41],a[60:63]
v_exp_f32 v99,v99
v_mfma_f32_16x16x32_bf16 a[108:111],v[124:127],v[44:47],a[108:111]
ds_read_b64_tr_b16 v[124:125],v5 offset:18688
ds_read_b64_tr_b16 v[126:127],v5 offset:12544
v_mfma_f32_16x16x32_bf16 v[176:179],v[128:131],v[20:23],v[176:179]
v_cvt_pk_bf16_f32 v36,v96,v97
v_cvt_pk_bf16_f32 v37,v98,v99
v_mfma_f32_16x16x32_bf16 v[224:227],v[128:131],v[26:29],v[224:227]
v_fma_f32 v105,v105,s36,v17
v_fma_f32 v106,v106,s36,v17
v_mfma_f32_16x16x32_bf16 a[16:19],v[128:131],v[32:35],a[16:19]
v_fma_f32 v107,v107,s36,v17
v_fma_f32 v76,v76,s36,v13
v_mfma_f32_16x16x32_bf16 a[64:67],v[128:131],v[38:41],a[64:67]
v_exp_f32 v104,v104
v_mfma_f32_16x16x32_bf16 a[112:115],v[128:131],v[44:47],a[112:115]
v_exp_f32 v105,v105
v_mfma_f32_16x16x32_bf16 v[180:183],v[132:135],v[20:23],v[180:183]
v_exp_f32 v106,v106
v_mfma_f32_16x16x32_bf16 v[228:231],v[132:135],v[26:29],v[228:231]
v_exp_f32 v107,v107
v_mfma_f32_16x16x32_bf16 a[20:23],v[132:135],v[32:35],a[20:23]
buffer_load_dwordx4 v8,s[12:15],s28 offen offset:2048 nt lds
v_mfma_f32_16x16x32_bf16 a[68:71],v[132:135],v[38:41],a[68:71]
s_add_u32 s28,s28,3072
v_cvt_pk_bf16_f32 v42,v104,v105
v_cvt_pk_bf16_f32 v43,v106,v107
v_mfma_f32_16x16x32_bf16 a[116:119],v[132:135],v[44:47],a[116:119]
s_add_u32 s29,s29,3072
v_fma_f32 v77,v77,s36,v13
v_fma_f32 v78,v78,s36,v13
v_mfma_f32_16x16x32_bf16 v[184:187],v[136:139],v[20:23],v[184:187]
s_cmp_eq_u32 s38,1
v_fma_f32 v79,v79,s36,v13
v_fma_f32 v84,v84,s36,v14
v_mfma_f32_16x16x32_bf16 v[232:235],v[136:139],v[26:29],v[232:235]
s_cselect_b32 s21,s26,s21
v_exp_f32 v76,v76
v_mfma_f32_16x16x32_bf16 a[24:27],v[136:139],v[32:35],a[24:27]
s_add_u32 m0,s23,12288
v_exp_f32 v77,v77
v_mfma_f32_16x16x32_bf16 a[72:75],v[136:139],v[38:41],a[72:75]
v_exp_f32 v78,v78
v_mfma_f32_16x16x32_bf16 a[120:123],v[136:139],v[44:47],a[120:123]
v_exp_f32 v79,v79
v_mfma_f32_16x16x32_bf16 v[188:191],v[140:143],v[20:23],v[188:191]
v_fma_f32 v85,v85,s36,v14
v_fma_f32 v86,v86,s36,v14
v_mfma_f32_16x16x32_bf16 v[236:239],v[140:143],v[26:29],v[236:239]
v_fma_f32 v87,v87,s36,v14
v_fma_f32 v92,v92,s36,v15
v_mfma_f32_16x16x32_bf16 a[28:31],v[140:143],v[32:35],a[28:31]
v_exp_f32 v84,v84
v_mfma_f32_16x16x32_bf16 a[76:79],v[140:143],v[38:41],a[76:79]
v_exp_f32 v85,v85
v_mfma_f32_16x16x32_bf16 a[124:127],v[140:143],v[44:47],a[124:127]
v_exp_f32 v86,v86
v_mfma_f32_16x16x32_bf16 v[192:195],v[112:115],v[20:23],v[192:195]
v_exp_f32 v87,v87
s_waitcnt vmcnt(12) lgkmcnt(0)
v_mfma_f32_16x16x32_bf16 v[240:243],v[112:115],v[26:29],v[240:243]
s_barrier
v_mfma_f32_16x16x32_bf16 a[32:35],v[112:115],v[32:35],a[32:35]
ds_read_b128 v[128:131],v0 offset:0
v_fma_f32 v93,v93,s36,v15
v_mfma_f32_16x16x32_bf16 a[80:83],v[112:115],v[38:41],a[80:83]
ds_read_b128 v[132:135],v1 offset:0
v_fma_f32 v94,v94,s36,v15
v_mfma_f32_16x16x32_bf16 a[128:131],v[112:115],v[44:47],a[128:131]
ds_read_b128 v[136:139],v0 offset:128
v_fma_f32 v95,v95,s36,v15
v_mfma_f32_16x16x32_bf16 v[196:199],v[116:119],v[20:23],v[196:199]
ds_read_b128 v[140:143],v1 offset:128
v_fma_f32 v100,v100,s36,v16
v_mfma_f32_16x16x32_bf16 v[244:247],v[116:119],v[26:29],v[244:247]
ds_read_b128 v[112:115],v0 offset:256
v_fma_f32 v101,v101,s36,v16
v_mfma_f32_16x16x32_bf16 a[36:39],v[116:119],v[32:35],a[36:39]
buffer_load_dwordx4 v6,s[8:11],s21 offen offset:0 lds
v_mfma_f32_16x16x32_bf16 a[84:87],v[116:119],v[38:41],a[84:87]
v_exp_f32 v92,v92
v_mfma_f32_16x16x32_bf16 a[132:135],v[116:119],v[44:47],a[132:135]
ds_read_b128 v[116:119],v1 offset:256
v_fma_f32 v102,v102,s36,v16
v_mfma_f32_16x16x32_bf16 v[200:203],v[120:123],v[20:23],v[200:203]
v_exp_f32 v93,v93
v_mfma_f32_16x16x32_bf16 v[248:251],v[120:123],v[26:29],v[248:251]
v_exp_f32 v94,v94
v_mfma_f32_16x16x32_bf16 a[40:43],v[120:123],v[32:35],a[40:43]
v_exp_f32 v95,v95
v_mfma_f32_16x16x32_bf16 a[88:91],v[120:123],v[38:41],a[88:91]
v_fma_f32 v103,v103,s36,v16
v_fma_f32 v108,v108,s36,v17
v_mfma_f32_16x16x32_bf16 a[136:139],v[120:123],v[44:47],a[136:139]
ds_read_b128 v[120:123],v0 offset:6144
v_fma_f32 v109,v109,s36,v17
v_mfma_f32_16x16x32_bf16 v[204:207],v[124:127],v[20:23],v[204:207]
v_cvt_pk_bf16_f32 v20,v76,v77
v_cvt_pk_bf16_f32 v21,v78,v79
v_mfma_f32_16x16x32_bf16 v[252:255],v[124:127],v[26:29],v[252:255]
v_cvt_pk_bf16_f32 v26,v84,v85
v_cvt_pk_bf16_f32 v27,v86,v87
v_mfma_f32_16x16x32_bf16 v[52:55],v[48:51],v[18:21],v[52:55]
v_exp_f32 v100,v100
v_mfma_f32_16x16x32_bf16 v[56:59],v[48:51],v[24:27],v[56:59]
v_exp_f32 v101,v101
v_mfma_f32_16x16x32_bf16 a[44:47],v[124:127],v[32:35],a[44:47]
buffer_load_dwordx4 v7,s[8:11],s21 offen offset:1024 lds
v_mfma_f32_16x16x32_bf16 a[92:95],v[124:127],v[38:41],a[92:95]
v_cvt_pk_bf16_f32 v32,v92,v93
v_cvt_pk_bf16_f32 v33,v94,v95
v_mfma_f32_16x16x32_bf16 a[140:143],v[124:127],v[44:47],a[140:143]
ds_read_b128 v[124:127],v1 offset:6144
v_fma_f32 v110,v110,s36,v17
v_mfma_f32_16x16x32_bf16 v[60:63],v[48:51],v[30:33],v[60:63]
s_waitcnt lgkmcnt(1)
v_exp_f32 v102,v102
v_mfma_f32_16x16x32_bf16 v[72:75],v[128:131],a[144:147],0
v_exp_f32 v103,v103
v_mfma_f32_16x16x32_bf16 v[80:83],v[128:131],a[168:171],0
v_fma_f32 v111,v111,s36,v17
v_cvt_pk_bf16_f32 v38,v100,v101
v_mfma_f32_16x16x32_bf16 v[88:91],v[128:131],a[192:195],0
v_cvt_pk_bf16_f32 v39,v102,v103
v_add_u32 v10,9216,v10
v_mfma_f32_16x16x32_bf16 v[96:99],v[128:131],a[216:219],0
v_exp_f32 v108,v108
v_mfma_f32_16x16x32_bf16 v[64:67],v[48:51],v[36:39],v[64:67]
v_exp_f32 v109,v109
v_mfma_f32_16x16x32_bf16 v[104:107],v[128:131],a[240:243],0
ds_read_b128 v[128:131],v0 offset:6272
v_cvt_pk_bf16_f32 v44,v108,v109
v_mfma_f32_16x16x32_bf16 v[72:75],v[132:135],a[148:151],v[72:75]
v_exp_f32 v110,v110
v_mfma_f32_16x16x32_bf16 v[80:83],v[132:135],a[172:175],v[80:83]
buffer_load_dwordx4 v8,s[8:11],s21 offen offset:2048 lds
v_mfma_f32_16x16x32_bf16 v[88:91],v[132:135],a[196:199],v[88:91]
s_add_u32 s21,s21,12288
v_exp_f32 v111,v111
v_mfma_f32_16x16x32_bf16 v[96:99],v[132:135],a[220:223],v[96:99]
s_add_u32 m0,s22,24576
v_cvt_pk_bf16_f32 v45,v110,v111
v_mfma_f32_16x16x32_bf16 v[104:107],v[132:135],a[244:247],v[104:107]
ds_read_b128 v[132:135],v1 offset:6272
v_mfma_f32_16x16x32_bf16 v[68:71],v[48:51],v[42:45],v[68:71]
v_mfma_f32_16x16x32_bf16 v[72:75],v[136:139],a[152:155],v[72:75]
v_mfma_f32_16x16x32_bf16 v[80:83],v[136:139],a[176:179],v[80:83]
v_mfma_f32_16x16x32_bf16 v[88:91],v[136:139],a[200:203],v[88:91]
v_mfma_f32_16x16x32_bf16 v[96:99],v[136:139],a[224:227],v[96:99]
v_mfma_f32_16x16x32_bf16 v[104:107],v[136:139],a[248:251],v[104:107]
ds_read_b128 v[136:139],v0 offset:6400
v_mfma_f32_16x16x32_bf16 v[72:75],v[140:143],a[156:159],v[72:75]
v_mfma_f32_16x16x32_bf16 v[80:83],v[140:143],a[180:183],v[80:83]
buffer_load_dwordx4 v6,s[4:7],s20 offen offset:0 lds
v_mfma_f32_16x16x32_bf16 v[88:91],v[140:143],a[204:207],v[88:91]
v_mfma_f32_16x16x32_bf16 v[96:99],v[140:143],a[228:231],v[96:99]
v_mfma_f32_16x16x32_bf16 v[104:107],v[140:143],a[252:255],v[104:107]
ds_read_b128 v[140:143],v1 offset:6400
v_mfma_f32_16x16x32_bf16 v[72:75],v[112:115],a[160:163],v[72:75]
v_mfma_f32_16x16x32_bf16 v[80:83],v[112:115],a[184:187],v[80:83]
v_mfma_f32_16x16x32_bf16 v[88:91],v[112:115],a[208:211],v[88:91]
v_mfma_f32_16x16x32_bf16 v[96:99],v[112:115],a[232:235],v[96:99]
v_mfma_f32_16x16x32_bf16 v[104:107],v[112:115],v[144:147],v[104:107]
v_mfma_f32_16x16x32_bf16 v[72:75],v[116:119],a[164:167],v[72:75]
v_mfma_f32_16x16x32_bf16 v[80:83],v[116:119],a[188:191],v[80:83]
v_mfma_f32_16x16x32_bf16 v[88:91],v[116:119],a[212:215],v[88:91]
v_mfma_f32_16x16x32_bf16 v[96:99],v[116:119],a[236:239],v[96:99]
buffer_load_dwordx4 v7,s[4:7],s20 offen offset:1024 lds
v_mfma_f32_16x16x32_bf16 v[104:107],v[116:119],v[148:151],v[104:107]
v_mfma_f32_16x16x32_bf16 v[76:79],v[120:123],a[144:147],0
v_mfma_f32_16x16x32_bf16 v[84:87],v[120:123],a[168:171],0
v_mfma_f32_16x16x32_bf16 v[92:95],v[120:123],a[192:195],0
v_fma_f32 v72,v72,s36,v13
v_fma_f32 v73,v73,s36,v13
v_mfma_f32_16x16x32_bf16 v[100:103],v[120:123],a[216:219],0
v_fma_f32 v74,v74,s36,v13
v_fma_f32 v75,v75,s36,v13
v_mfma_f32_16x16x32_bf16 v[108:111],v[120:123],a[240:243],0
s_waitcnt lgkmcnt(0)
v_fma_f32 v80,v80,s36,v14
v_fma_f32 v81,v81,s36,v14
v_mfma_f32_16x16x32_bf16 v[76:79],v[124:127],a[148:151],v[76:79]
v_fma_f32 v82,v82,s36,v14
v_fma_f32 v83,v83,s36,v14
v_mfma_f32_16x16x32_bf16 v[84:87],v[124:127],a[172:175],v[84:87]
v_fma_f32 v88,v88,s36,v15
v_fma_f32 v89,v89,s36,v15
v_mfma_f32_16x16x32_bf16 v[92:95],v[124:127],a[196:199],v[92:95]
v_exp_f32 v72,v72
v_mfma_f32_16x16x32_bf16 v[100:103],v[124:127],a[220:223],v[100:103]
v_exp_f32 v73,v73
v_mfma_f32_16x16x32_bf16 v[108:111],v[124:127],a[244:247],v[108:111]
buffer_load_dwordx4 v8,s[4:7],s20 offen offset:2048 lds
v_mfma_f32_16x16x32_bf16 v[76:79],v[128:131],a[152:155],v[76:79]
s_add_u32 s20,s20,12288
s_add_u32 s38,s38,1
s_cmp_lt_u32 s38,2
v_mfma_f32_16x16x32_bf16 v[84:87],v[128:131],a[176:179],v[84:87]
v_exp_f32 v74,v74
v_mfma_f32_16x16x32_bf16 v[92:95],v[128:131],a[200:203],v[92:95]
v_exp_f32 v75,v75
v_mfma_f32_16x16x32_bf16 v[100:103],v[128:131],a[224:227],v[100:103]
v_exp_f32 v80,v80
v_mfma_f32_16x16x32_bf16 v[108:111],v[128:131],a[248:251],v[108:111]
ds_read_b64_tr_b16 v[112:113],v2 offset:24576
v_mfma_f32_16x16x32_bf16 v[76:79],v[132:135],a[156:159],v[76:79]
ds_read_b64_tr_b16 v[114:115],v2 offset:30720
v_cvt_pk_bf16_f32 v22,v72,v73
v_mfma_f32_16x16x32_bf16 v[84:87],v[132:135],a[180:183],v[84:87]
v_exp_f32 v81,v81
v_mfma_f32_16x16x32_bf16 v[92:95],v[132:135],a[204:207],v[92:95]
ds_read_b64_tr_b16 v[116:117],v3 offset:24576
ds_read_b64_tr_b16 v[118:119],v3 offset:30720
v_mfma_f32_16x16x32_bf16 v[100:103],v[132:135],a[228:231],v[100:103]
v_exp_f32 v82,v82
v_mfma_f32_16x16x32_bf16 v[108:111],v[132:135],a[252:255],v[108:111]
ds_read_b64_tr_b16 v[120:121],v4 offset:24576
v_mfma_f32_16x16x32_bf16 v[76:79],v[136:139],a[160:163],v[76:79]
ds_read_b64_tr_b16 v[122:123],v4 offset:30720
v_cvt_pk_bf16_f32 v23,v74,v75
v_mfma_f32_16x16x32_bf16 v[84:87],v[136:139],a[184:187],v[84:87]
v_exp_f32 v83,v83
v_mfma_f32_16x16x32_bf16 v[92:95],v[136:139],a[208:211],v[92:95]
ds_read_b64_tr_b16 v[124:125],v5 offset:24576
ds_read_b64_tr_b16 v[126:127],v5 offset:30720
v_mfma_f32_16x16x32_bf16 v[100:103],v[136:139],a[232:235],v[100:103]
v_exp_f32 v88,v88
v_mfma_f32_16x16x32_bf16 v[108:111],v[136:139],v[144:147],v[108:111]
v_exp_f32 v89,v89
v_mfma_f32_16x16x32_bf16 v[76:79],v[140:143],a[164:167],v[76:79]
v_cvt_pk_bf16_f32 v28,v80,v81
v_cvt_pk_bf16_f32 v29,v82,v83
v_mfma_f32_16x16x32_bf16 v[84:87],v[140:143],a[188:191],v[84:87]
v_cvt_pk_bf16_f32 v34,v88,v89
v_mfma_f32_16x16x32_bf16 v[92:95],v[140:143],a[212:215],v[92:95]
v_mfma_f32_16x16x32_bf16 v[100:103],v[140:143],a[236:239],v[100:103]
v_mfma_f32_16x16x32_bf16 v[108:111],v[140:143],v[148:151],v[108:111]
s_cbranch_scc1 L_loop5w0
s_cmp_ge_u32 s69,6
s_cbranch_scc1 L_end5
s_cmp_eq_u32 s40,0
s_cbranch_scc1 L_tr54
s_branch L_tr55
L_tr54:
s_waitcnt vmcnt(42)
s_waitcnt lgkmcnt(4)
v_mfma_f32_16x16x32_bf16 v[160:163],v[112:115],v[18:21],v[160:163]
s_add_u32 m0,s24,0
ds_read_b128 a[144:147],v11 offset:0
v_fma_f32 v90,v90,s36,v15
v_mfma_f32_16x16x32_bf16 v[208:211],v[112:115],v[24:27],v[208:211]
ds_read_b128 a[148:151],v12 offset:0
v_fma_f32 v91,v91,s36,v15
v_mfma_f32_16x16x32_bf16 a[0:3],v[112:115],v[30:33],a[0:3]
ds_read_b128 a[152:155],v11 offset:128
v_fma_f32 v96,v96,s36,v16
v_mfma_f32_16x16x32_bf16 a[48:51],v[112:115],v[36:39],a[48:51]
ds_read_b128 a[156:159],v12 offset:128
v_fma_f32 v97,v97,s36,v16
v_mfma_f32_16x16x32_bf16 a[96:99],v[112:115],v[42:45],a[96:99]
ds_read_b128 a[160:163],v11 offset:256
v_fma_f32 v98,v98,s36,v16
v_mfma_f32_16x16x32_bf16 v[164:167],v[116:119],v[18:21],v[164:167]
ds_read_b128 a[164:167],v12 offset:256
ds_read_b64_tr_b16 v[128:129],v2 offset:24704
ds_read_b64_tr_b16 v[130:131],v2 offset:30848
ds_read_b64_tr_b16 v[132:133],v3 offset:24704
ds_read_b64_tr_b16 v[134:135],v3 offset:30848
ds_read_b64_tr_b16 v[136:137],v4 offset:24704
ds_read_b64_tr_b16 v[138:139],v4 offset:30848
ds_read_b64_tr_b16 v[140:141],v5 offset:24704
ds_read_b64_tr_b16 v[142:143],v5 offset:30848
ds_read_b64_tr_b16 v[112:113],v2 offset:24832
ds_read_b64_tr_b16 v[114:115],v2 offset:30976
ds_read_b128 a[168:171],v11 offset:6144
v_mfma_f32_16x16x32_bf16 v[212:215],v[116:119],v[24:27],v[212:215]
v_fma_f32 v99,v99,s36,v16
ds_read_b128 a[172:175],v12 offset:6144
ds_read_b128 a[176:179],v11 offset:6272
v_mfma_f32_16x16x32_bf16 a[4:7],v[116:119],v[30:33],a[4:7]
v_fma_f32 v104,v104,s36,v17
ds_read_b128 a[180:183],v12 offset:6272
ds_read_b128 a[184:187],v11 offset:6400
v_mfma_f32_16x16x32_bf16 a[52:55],v[116:119],v[36:39],a[52:55]
s_waitcnt lgkmcnt(15)
buffer_load_dwordx4 v6,s[12:15],s28 offen offset:0 nt lds
v_mfma_f32_16x16x32_bf16 a[100:103],v[116:119],v[42:45],a[100:103]
ds_read_b64_tr_b16 v[116:117],v3 offset:24832
ds_read_b64_tr_b16 v[118:119],v3 offset:30976
v_mfma_f32_16x16x32_bf16 v[168:171],v[120:123],v[18:21],v[168:171]
ds_read_b128 a[188:191],v12 offset:6400
v_fma_f32 v105,v105,s36,v17
v_mfma_f32_16x16x32_bf16 v[216:219],v[120:123],v[24:27],v[216:219]
v_fma_f32 v106,v106,s36,v17
v_fma_f32 v107,v107,s36,v17
v_mfma_f32_16x16x32_bf16 a[8:11],v[120:123],v[30:33],a[8:11]
v_fma_f32 v76,v76,s36,v13
v_fma_f32 v77,v77,s36,v13
v_mfma_f32_16x16x32_bf16 a[56:59],v[120:123],v[36:39],a[56:59]
buffer_load_dwordx4 v7,s[12:15],s28 offen offset:1024 nt lds
v_mfma_f32_16x16x32_bf16 a[104:107],v[120:123],v[42:45],a[104:107]
ds_read_b64_tr_b16 v[120:121],v4 offset:24832
ds_read_b64_tr_b16 v[122:123],v4 offset:30976
v_mfma_f32_16x16x32_bf16 v[172:175],v[124:127],v[18:21],v[172:175]
v_fma_f32 v78,v78,s36,v13
v_fma_f32 v79,v79,s36,v13
v_mfma_f32_16x16x32_bf16 v[220:223],v[124:127],v[24:27],v[220:223]
v_fma_f32 v84,v84,s36,v14
v_fma_f32 v85,v85,s36,v14
v_mfma_f32_16x16x32_bf16 a[12:15],v[124:127],v[30:33],a[12:15]
v_fma_f32 v86,v86,s36,v14
v_fma_f32 v87,v87,s36,v14
v_mfma_f32_16x16x32_bf16 a[60:63],v[124:127],v[36:39],a[60:63]
v_fma_f32 v92,v92,s36,v15
v_fma_f32 v93,v93,s36,v15
v_mfma_f32_16x16x32_bf16 a[108:111],v[124:127],v[42:45],a[108:111]
s_waitcnt lgkmcnt(2)
ds_read_b64_tr_b16 v[124:125],v5 offset:24832
ds_read_b64_tr_b16 v[126:127],v5 offset:30976
v_mfma_f32_16x16x32_bf16 v[176:179],v[128:131],v[18:21],v[176:179]
v_fma_f32 v94,v94,s36,v15
v_fma_f32 v95,v95,s36,v15
v_mfma_f32_16x16x32_bf16 v[224:227],v[128:131],v[24:27],v[224:227]
buffer_load_dwordx4 v8,s[12:15],s28 offen offset:2048 nt lds
v_mfma_f32_16x16x32_bf16 a[16:19],v[128:131],v[30:33],a[16:19]
s_add_u32 s28,s28,3072
v_fma_f32 v100,v100,s36,v16
v_fma_f32 v101,v101,s36,v16
v_mfma_f32_16x16x32_bf16 a[64:67],v[128:131],v[36:39],a[64:67]
s_add_u32 m0,s24,3072
v_fma_f32 v102,v102,s36,v16
v_fma_f32 v103,v103,s36,v16
v_mfma_f32_16x16x32_bf16 a[112:115],v[128:131],v[42:45],a[112:115]
v_fma_f32 v108,v108,s36,v17
v_fma_f32 v109,v109,s36,v17
v_mfma_f32_16x16x32_bf16 v[180:183],v[132:135],v[18:21],v[180:183]
v_fma_f32 v110,v110,s36,v17
v_fma_f32 v111,v111,s36,v17
v_mfma_f32_16x16x32_bf16 v[228:231],v[132:135],v[24:27],v[228:231]
v_exp_f32 v90,v90
v_mfma_f32_16x16x32_bf16 a[20:23],v[132:135],v[30:33],a[20:23]
v_exp_f32 v91,v91
v_mfma_f32_16x16x32_bf16 a[68:71],v[132:135],v[36:39],a[68:71]
v_exp_f32 v96,v96
v_mfma_f32_16x16x32_bf16 a[116:119],v[132:135],v[42:45],a[116:119]
buffer_load_dwordx4 v6,s[12:15],s28 offen offset:0 nt lds
v_mfma_f32_16x16x32_bf16 v[184:187],v[136:139],v[18:21],v[184:187]
v_exp_f32 v97,v97
v_mfma_f32_16x16x32_bf16 v[232:235],v[136:139],v[24:27],v[232:235]
v_exp_f32 v98,v98
v_mfma_f32_16x16x32_bf16 a[24:27],v[136:139],v[30:33],a[24:27]
v_exp_f32 v99,v99
v_mfma_f32_16x16x32_bf16 a[72:75],v[136:139],v[36:39],a[72:75]
v_exp_f32 v104,v104
v_mfma_f32_16x16x32_bf16 a[120:123],v[136:139],v[42:45],a[120:123]
v_exp_f32 v105,v105
v_mfma_f32_16x16x32_bf16 v[188:191],v[140:143],v[18:21],v[188:191]
v_exp_f32 v106,v106
v_mfma_f32_16x16x32_bf16 v[236:239],v[140:143],v[24:27],v[236:239]
buffer_load_dwordx4 v7,s[12:15],s28 offen offset:1024 nt lds
v_mfma_f32_16x16x32_bf16 a[28:31],v[140:143],v[30:33],a[28:31]
v_exp_f32 v107,v107
v_mfma_f32_16x16x32_bf16 a[76:79],v[140:143],v[36:39],a[76:79]
v_exp_f32 v76,v76
v_mfma_f32_16x16x32_bf16 a[124:127],v[140:143],v[42:45],a[124:127]
v_exp_f32 v77,v77
v_mfma_f32_16x16x32_bf16 v[192:195],v[112:115],v[18:21],v[192:195]
v_exp_f32 v78,v78
v_mfma_f32_16x16x32_bf16 v[240:243],v[112:115],v[24:27],v[240:243]
v_exp_f32 v79,v79
v_mfma_f32_16x16x32_bf16 a[32:35],v[112:115],v[30:33],a[32:35]
v_exp_f32 v84,v84
v_mfma_f32_16x16x32_bf16 a[80:83],v[112:115],v[36:39],a[80:83]
v_exp_f32 v85,v85
v_mfma_f32_16x16x32_bf16 a[128:131],v[112:115],v[42:45],a[128:131]
buffer_load_dwordx4 v8,s[12:15],s28 offen offset:2048 nt lds
s_waitcnt vmcnt(20) lgkmcnt(0)
s_barrier
v_mfma_f32_16x16x32_bf16 v[196:199],v[116:119],v[18:21],v[196:199]
s_add_u32 s28,s28,3072
v_exp_f32 v86,v86
v_mfma_f32_16x16x32_bf16 v[244:247],v[116:119],v[24:27],v[244:247]
s_add_u32 m0,s22,0
v_exp_f32 v87,v87
v_mfma_f32_16x16x32_bf16 a[36:39],v[116:119],v[30:33],a[36:39]
buffer_load_dwordx4 v6,s[4:7],s25 offen offset:0 lds
v_mfma_f32_16x16x32_bf16 a[84:87],v[116:119],v[36:39],a[84:87]
buffer_load_dwordx4 v7,s[4:7],s25 offen offset:1024 lds
v_mfma_f32_16x16x32_bf16 a[132:135],v[116:119],v[42:45],a[132:135]
buffer_load_dwordx4 v8,s[4:7],s25 offen offset:2048 lds
v_mfma_f32_16x16x32_bf16 v[200:203],v[120:123],v[18:21],v[200:203]
v_exp_f32 v92,v92
v_mfma_f32_16x16x32_bf16 v[248:251],v[120:123],v[24:27],v[248:251]
v_exp_f32 v93,v93
v_mfma_f32_16x16x32_bf16 a[40:43],v[120:123],v[30:33],a[40:43]
v_exp_f32 v94,v94
v_mfma_f32_16x16x32_bf16 a[88:91],v[120:123],v[36:39],a[88:91]
v_exp_f32 v95,v95
v_mfma_f32_16x16x32_bf16 a[136:139],v[120:123],v[42:45],a[136:139]
ds_read_b64_tr_b16 v[128:129],v2 offset:6144
ds_read_b64_tr_b16 v[130:131],v2 offset:0
v_mfma_f32_16x16x32_bf16 v[204:207],v[124:127],v[18:21],v[204:207]
v_exp_f32 v100,v100
v_mfma_f32_16x16x32_bf16 v[252:255],v[124:127],v[24:27],v[252:255]
v_exp_f32 v101,v101
v_mfma_f32_16x16x32_bf16 a[44:47],v[124:127],v[30:33],a[44:47]
ds_read_b64_tr_b16 v[132:133],v3 offset:6144
ds_read_b64_tr_b16 v[134:135],v3 offset:0
v_mfma_f32_16x16x32_bf16 a[92:95],v[124:127],v[36:39],a[92:95]
v_exp_f32 v102,v102
v_mfma_f32_16x16x32_bf16 a[140:143],v[124:127],v[42:45],a[140:143]
ds_read_b64_tr_b16 v[136:137],v4 offset:6144
ds_read_b64_tr_b16 v[138:139],v4 offset:0
v_exp_f32 v103,v103
v_exp_f32 v108,v108
v_exp_f32 v109,v109
ds_read_b64_tr_b16 v[140:141],v5 offset:6144
ds_read_b64_tr_b16 v[142:143],v5 offset:0
v_exp_f32 v110,v110
v_exp_f32 v111,v111
v_cvt_pk_bf16_f32 v35,v90,v91
v_cvt_pk_bf16_f32 v40,v96,v97
v_cvt_pk_bf16_f32 v41,v98,v99
v_cvt_pk_bf16_f32 v46,v104,v105
v_cvt_pk_bf16_f32 v47,v106,v107
v_cvt_pk_bf16_f32 v20,v76,v77
v_cvt_pk_bf16_f32 v21,v78,v79
v_cvt_pk_bf16_f32 v26,v84,v85
v_cvt_pk_bf16_f32 v27,v86,v87
v_mfma_f32_16x16x32_bf16 v[52:55],v[48:51],v[20:23],v[52:55]
v_cvt_pk_bf16_f32 v32,v92,v93
v_cvt_pk_bf16_f32 v33,v94,v95
v_mfma_f32_16x16x32_bf16 v[56:59],v[48:51],v[26:29],v[56:59]
v_cvt_pk_bf16_f32 v38,v100,v101
v_cvt_pk_bf16_f32 v39,v102,v103
v_mfma_f32_16x16x32_bf16 v[60:63],v[48:51],v[32:35],v[60:63]
v_cvt_pk_bf16_f32 v44,v108,v109
v_cvt_pk_bf16_f32 v45,v110,v111
v_mfma_f32_16x16x32_bf16 v[64:67],v[48:51],v[38:41],v[64:67]
v_subrev_u32 v10,18432,v10
v_mfma_f32_16x16x32_bf16 v[68:71],v[48:51],v[44:47],v[68:71]
s_waitcnt lgkmcnt(1)
v_mfma_f32_16x16x32_bf16 v[160:163],v[128:131],v[20:23],v[160:163]
s_add_u32 s87,s42,18432
ds_read_b64_tr_b16 v[112:113],v2 offset:6272
ds_read_b64_tr_b16 v[114:115],v2 offset:128
v_mfma_f32_16x16x32_bf16 v[208:211],v[128:131],v[26:29],v[208:211]
s_add_u32 s66,s42,24576
ds_read_b64_tr_b16 v[116:117],v3 offset:6272
ds_read_b64_tr_b16 v[118:119],v3 offset:128
v_mfma_f32_16x16x32_bf16 a[0:3],v[128:131],v[32:35],a[0:3]
ds_read_b64_tr_b16 v[120:121],v4 offset:6272
ds_read_b64_tr_b16 v[122:123],v4 offset:128
v_mfma_f32_16x16x32_bf16 a[48:51],v[128:131],v[38:41],a[48:51]
ds_read_b64_tr_b16 v[124:125],v5 offset:6272
ds_read_b64_tr_b16 v[126:127],v5 offset:128
v_mfma_f32_16x16x32_bf16 a[96:99],v[128:131],v[44:47],a[96:99]
ds_read_b64_tr_b16 v[128:129],v2 offset:6400
ds_read_b64_tr_b16 v[130:131],v2 offset:256
v_mfma_f32_16x16x32_bf16 v[164:167],v[132:135],v[20:23],v[164:167]
v_mbcnt_lo_u32_b32 v57,-1,0
v_mbcnt_hi_u32_b32 v57,-1,v57
v_mfma_f32_16x16x32_bf16 v[212:215],v[132:135],v[26:29],v[212:215]
v_and_b32 v61,7,v57
v_lshrrev_b32 v53,5,v57
v_mfma_f32_16x16x32_bf16 a[4:7],v[132:135],v[32:35],a[4:7]
v_xor_b32 v61,v61,v53
v_and_b32 v53,15,v57
v_lshl_add_u32 v53,v53,7,s24
v_lshl_add_u32 v53,v61,4,v53
v_bfe_u32 v61,v57,4,1
v_lshl_add_u32 v36,v61,3,v53
v_xor_b32 v37,32,v36
v_xor_b32 v42,64,v36
v_xor_b32 v43,96,v36
v_bfe_u32 v53,v57,3,1
v_lshlrev_b32 v53,11,v53
v_rcp_f32 v66,v64
v_rcp_f32 v70,v68
v_accvgpr_read_b32 v72,a48
v_accvgpr_read_b32 v73,a49
v_pk_mul_f32 v[72:73],v[72:73],v[66:67] op_sel_hi:[1,0]
v_accvgpr_read_b32 v74,a50
v_accvgpr_read_b32 v75,a51
v_pk_mul_f32 v[74:75],v[74:75],v[66:67] op_sel_hi:[1,0]
v_accvgpr_read_b32 v76,a96
v_accvgpr_read_b32 v77,a97
v_pk_mul_f32 v[76:77],v[76:77],v[70:71] op_sel_hi:[1,0]
v_accvgpr_read_b32 v78,a98
v_accvgpr_read_b32 v79,a99
v_pk_mul_f32 v[78:79],v[78:79],v[70:71] op_sel_hi:[1,0]
v_cvt_pk_bf16_f32 v72,v72,v73
v_cvt_pk_bf16_f32 v76,v76,v77
v_mfma_f32_16x16x32_bf16 a[52:55],v[132:135],v[38:41],a[52:55]
v_cvt_pk_bf16_f32 v73,v74,v75
v_cvt_pk_bf16_f32 v77,v78,v79
v_mfma_f32_16x16x32_bf16 a[100:103],v[132:135],v[44:47],a[100:103]
ds_read_b64_tr_b16 v[132:133],v3 offset:6400
ds_read_b64_tr_b16 v[134:135],v3 offset:256
v_mfma_f32_16x16x32_bf16 v[168:171],v[136:139],v[20:23],v[168:171]
ds_write2st64_b64 v36,v[72:73],v[76:77] offset0:36 offset1:40
v_mfma_f32_16x16x32_bf16 v[216:219],v[136:139],v[26:29],v[216:219]
v_accvgpr_read_b32 v80,a52
v_accvgpr_read_b32 v81,a53
v_mfma_f32_16x16x32_bf16 a[8:11],v[136:139],v[32:35],a[8:11]
v_accvgpr_read_b32 v82,a54
v_accvgpr_read_b32 v83,a55
v_accvgpr_read_b32 v84,a100
v_accvgpr_read_b32 v85,a101
v_accvgpr_read_b32 v86,a102
v_pk_mul_f32 v[80:81],v[80:81],v[66:67] op_sel_hi:[1,0]
v_pk_mul_f32 v[82:83],v[82:83],v[66:67] op_sel_hi:[1,0]
v_pk_mul_f32 v[84:85],v[84:85],v[70:71] op_sel_hi:[1,0]
v_accvgpr_read_b32 v87,a103
v_pk_mul_f32 v[86:87],v[86:87],v[70:71] op_sel_hi:[1,0]
v_cvt_pk_bf16_f32 v80,v80,v81
v_cvt_pk_bf16_f32 v84,v84,v85
v_mfma_f32_16x16x32_bf16 a[56:59],v[136:139],v[38:41],a[56:59]
v_cvt_pk_bf16_f32 v81,v82,v83
v_cvt_pk_bf16_f32 v85,v86,v87
v_mfma_f32_16x16x32_bf16 a[104:107],v[136:139],v[44:47],a[104:107]
s_waitcnt lgkmcnt(2)
ds_read_b64_tr_b16 v[136:137],v4 offset:6400
ds_read_b64_tr_b16 v[138:139],v4 offset:256
v_mfma_f32_16x16x32_bf16 v[172:175],v[140:143],v[20:23],v[172:175]
ds_write2st64_b64 v37,v[80:81],v[84:85] offset0:36 offset1:40
v_mfma_f32_16x16x32_bf16 v[220:223],v[140:143],v[26:29],v[220:223]
v_accvgpr_read_b32 v88,a56
v_accvgpr_read_b32 v89,a57
v_mfma_f32_16x16x32_bf16 a[12:15],v[140:143],v[32:35],a[12:15]
v_accvgpr_read_b32 v90,a58
v_accvgpr_read_b32 v91,a59
v_accvgpr_read_b32 v92,a104
v_accvgpr_read_b32 v93,a105
v_accvgpr_read_b32 v94,a106
v_pk_mul_f32 v[88:89],v[88:89],v[66:67] op_sel_hi:[1,0]
v_pk_mul_f32 v[90:91],v[90:91],v[66:67] op_sel_hi:[1,0]
v_pk_mul_f32 v[92:93],v[92:93],v[70:71] op_sel_hi:[1,0]
v_accvgpr_read_b32 v95,a107
v_pk_mul_f32 v[94:95],v[94:95],v[70:71] op_sel_hi:[1,0]
v_cvt_pk_bf16_f32 v88,v88,v89
v_cvt_pk_bf16_f32 v92,v92,v93
v_mfma_f32_16x16x32_bf16 a[60:63],v[140:143],v[38:41],a[60:63]
v_cvt_pk_bf16_f32 v89,v90,v91
v_cvt_pk_bf16_f32 v93,v94,v95
v_mfma_f32_16x16x32_bf16 a[108:111],v[140:143],v[44:47],a[108:111]
ds_read_b64_tr_b16 v[140:141],v5 offset:6400
ds_read_b64_tr_b16 v[142:143],v5 offset:256
v_mfma_f32_16x16x32_bf16 v[176:179],v[112:115],v[20:23],v[176:179]
ds_write2st64_b64 v42,v[88:89],v[92:93] offset0:36 offset1:40
v_mfma_f32_16x16x32_bf16 v[224:227],v[112:115],v[26:29],v[224:227]
v_accvgpr_read_b32 v96,a60
v_accvgpr_read_b32 v97,a61
v_mfma_f32_16x16x32_bf16 a[16:19],v[112:115],v[32:35],a[16:19]
v_accvgpr_read_b32 v98,a62
v_accvgpr_read_b32 v99,a63
v_accvgpr_read_b32 v100,a108
v_accvgpr_read_b32 v101,a109
v_accvgpr_read_b32 v102,a110
v_pk_mul_f32 v[96:97],v[96:97],v[66:67] op_sel_hi:[1,0]
v_pk_mul_f32 v[98:99],v[98:99],v[66:67] op_sel_hi:[1,0]
v_pk_mul_f32 v[100:101],v[100:101],v[70:71] op_sel_hi:[1,0]
v_accvgpr_read_b32 v103,a111
v_pk_mul_f32 v[102:103],v[102:103],v[70:71] op_sel_hi:[1,0]
v_cvt_pk_bf16_f32 v96,v96,v97
v_cvt_pk_bf16_f32 v100,v100,v101
v_mfma_f32_16x16x32_bf16 a[64:67],v[112:115],v[38:41],a[64:67]
v_max3_f32 v152,v52,v56,v60
v_cvt_pk_bf16_f32 v97,v98,v99
v_mfma_f32_16x16x32_bf16 a[112:115],v[112:115],v[44:47],a[112:115]
v_cvt_pk_bf16_f32 v101,v102,v103
v_max3_f32 v152,v152,v64,v68
v_mfma_f32_16x16x32_bf16 v[180:183],v[116:119],v[20:23],v[180:183]
ds_write2st64_b64 v43,v[96:97],v[100:101] offset0:36 offset1:40
v_mfma_f32_16x16x32_bf16 v[228:231],v[116:119],v[26:29],v[228:231]
v_accvgpr_read_b32 v72,a64
v_accvgpr_read_b32 v73,a65
v_mfma_f32_16x16x32_bf16 a[20:23],v[116:119],v[32:35],a[20:23]
v_accvgpr_read_b32 v74,a66
v_accvgpr_read_b32 v75,a67
v_accvgpr_read_b32 v76,a112
v_accvgpr_read_b32 v77,a113
v_accvgpr_read_b32 v78,a114
v_pk_mul_f32 v[72:73],v[72:73],v[66:67] op_sel_hi:[1,0]
v_pk_mul_f32 v[74:75],v[74:75],v[66:67] op_sel_hi:[1,0]
v_pk_mul_f32 v[76:77],v[76:77],v[70:71] op_sel_hi:[1,0]
v_accvgpr_read_b32 v79,a115
v_pk_mul_f32 v[78:79],v[78:79],v[70:71] op_sel_hi:[1,0]
v_cmp_ngt_f32 vcc,s37,v152
v_cvt_pk_bf16_f32 v72,v72,v73
v_mfma_f32_16x16x32_bf16 a[68:71],v[116:119],v[38:41],a[68:71]
ds_read_b128 v[152:155],v10 offset:18432
v_cvt_pk_bf16_f32 v76,v76,v77
v_mfma_f32_16x16x32_bf16 a[116:119],v[116:119],v[44:47],a[116:119]
s_cmp_lg_u64 vcc,0
ds_read_b128 v[156:159],v10 offset:19456
v_cvt_pk_bf16_f32 v73,v74,v75
v_mfma_f32_16x16x32_bf16 v[184:187],v[120:123],v[20:23],v[184:187]
s_cselect_b32 s62,s32,0
ds_read_b128 v[104:107],v10 offset:20480
v_accvgpr_read_b32 v80,a68
v_mfma_f32_16x16x32_bf16 v[232:235],v[120:123],v[26:29],v[232:235]
s_or_b32 s31,s31,s62
ds_read_b128 v[108:111],v10 offset:21504
v_accvgpr_read_b32 v81,a69
v_mfma_f32_16x16x32_bf16 a[24:27],v[120:123],v[32:35],a[24:27]
s_lshl_b32 s32,s32,1
v_accvgpr_read_b32 v82,a70
v_accvgpr_read_b32 v83,a71
v_accvgpr_read_b32 v84,a116
v_accvgpr_read_b32 v85,a117
v_accvgpr_read_b32 v86,a118
v_pk_mul_f32 v[80:81],v[80:81],v[66:67] op_sel_hi:[1,0]
v_pk_mul_f32 v[82:83],v[82:83],v[66:67] op_sel_hi:[1,0]
v_pk_mul_f32 v[84:85],v[84:85],v[70:71] op_sel_hi:[1,0]
v_accvgpr_read_b32 v87,a119
v_pk_mul_f32 v[86:87],v[86:87],v[70:71] op_sel_hi:[1,0]
v_cvt_pk_bf16_f32 v77,v78,v79
v_cvt_pk_bf16_f32 v80,v80,v81
v_mfma_f32_16x16x32_bf16 a[72:75],v[120:123],v[38:41],a[72:75]
s_add_u32 m0,s23,0
ds_write2st64_b64 v36,v[72:73],v[76:77] offset0:36 offset1:40
v_mfma_f32_16x16x32_bf16 a[120:123],v[120:123],v[44:47],a[120:123]
s_waitcnt vmcnt(15)
v_cvt_pk_bf16_f32 v84,v84,v85
v_cvt_pk_bf16_f32 v81,v82,v83
v_mfma_f32_16x16x32_bf16 v[188:191],v[124:127],v[20:23],v[188:191]
s_waitcnt lgkmcnt(3)
ds_read_b128 a[192:195],v11 offset:12288
buffer_store_dwordx4 v[152:155],v9,s[16:19],s87 offen offset:0 nt
ds_read_b128 a[196:199],v12 offset:12288
v_accvgpr_read_b32 v88,a72
v_accvgpr_read_b32 v89,a73
v_mfma_f32_16x16x32_bf16 v[236:239],v[124:127],v[26:29],v[236:239]
ds_read_b128 a[200:203],v11 offset:12416
v_accvgpr_read_b32 v90,a74
v_mfma_f32_16x16x32_bf16 a[28:31],v[124:127],v[32:35],a[28:31]
ds_read_b128 a[204:207],v12 offset:12416
ds_read_b128 a[208:211],v11 offset:12544
buffer_store_dwordx4 v[156:159],v9,s[16:19],s87 offen offset:3072 nt
ds_read_b128 a[212:215],v12 offset:12544
v_pk_mul_f32 v[88:89],v[88:89],v[66:67] op_sel_hi:[1,0]
v_accvgpr_read_b32 v91,a75
v_pk_mul_f32 v[90:91],v[90:91],v[66:67] op_sel_hi:[1,0]
v_accvgpr_read_b32 v92,a120
v_accvgpr_read_b32 v93,a121
v_pk_mul_f32 v[92:93],v[92:93],v[70:71] op_sel_hi:[1,0]
v_accvgpr_read_b32 v94,a122
v_accvgpr_read_b32 v95,a123
v_pk_mul_f32 v[94:95],v[94:95],v[70:71] op_sel_hi:[1,0]
v_cvt_pk_bf16_f32 v85,v86,v87
v_cvt_pk_bf16_f32 v88,v88,v89
v_mfma_f32_16x16x32_bf16 a[76:79],v[124:127],v[38:41],a[76:79]
ds_write2st64_b64 v37,v[80:81],v[84:85] offset0:36 offset1:40
v_mfma_f32_16x16x32_bf16 a[124:127],v[124:127],v[44:47],a[124:127]
v_cvt_pk_bf16_f32 v92,v92,v93
v_cvt_pk_bf16_f32 v89,v90,v91
v_mfma_f32_16x16x32_bf16 v[192:195],v[128:131],v[20:23],v[192:195]
s_waitcnt lgkmcnt(4)
buffer_store_dwordx4 v[104:107],v9,s[16:19],s66 offen offset:0 nt
v_cvt_pk_bf16_f32 v93,v94,v95
v_rcp_f32 v58,v56
v_mfma_f32_16x16x32_bf16 v[240:243],v[128:131],v[26:29],v[240:243]
v_accvgpr_read_b32 v96,a76
v_accvgpr_read_b32 v97,a77
v_mfma_f32_16x16x32_bf16 a[32:35],v[128:131],v[32:35],a[32:35]
v_accvgpr_read_b32 v98,a78
ds_write2st64_b64 v42,v[88:89],v[92:93] offset0:36 offset1:40
v_pk_mul_f32 v[96:97],v[96:97],v[66:67] op_sel_hi:[1,0]
v_accvgpr_read_b32 v99,a79
v_pk_mul_f32 v[98:99],v[98:99],v[66:67] op_sel_hi:[1,0]
buffer_store_dwordx4 v[108:111],v9,s[16:19],s66 offen offset:3072 nt
v_accvgpr_read_b32 v100,a124
v_accvgpr_read_b32 v101,a125
v_pk_mul_f32 v[100:101],v[100:101],v[70:71] op_sel_hi:[1,0]
v_accvgpr_read_b32 v102,a126
v_accvgpr_read_b32 v103,a127
v_pk_mul_f32 v[102:103],v[102:103],v[70:71] op_sel_hi:[1,0]
v_cvt_pk_bf16_f32 v96,v96,v97
v_cvt_pk_bf16_f32 v100,v100,v101
v_mfma_f32_16x16x32_bf16 a[80:83],v[128:131],v[38:41],a[80:83]
v_cvt_pk_bf16_f32 v97,v98,v99
v_cvt_pk_bf16_f32 v101,v102,v103
v_mfma_f32_16x16x32_bf16 a[128:131],v[128:131],v[44:47],a[128:131]
ds_write2st64_b64 v43,v[96:97],v[100:101] offset0:36 offset1:40
v_mfma_f32_16x16x32_bf16 v[196:199],v[132:135],v[20:23],v[196:199]
v_rcp_f32 v62,v60
s_waitcnt vmcnt(4)
s_barrier
v_mfma_f32_16x16x32_bf16 v[244:247],v[132:135],v[26:29],v[244:247]
ds_read_b128 v[76:79],v10 offset:18432
v_accvgpr_read_b32 v72,a80
v_mfma_f32_16x16x32_bf16 a[36:39],v[132:135],v[32:35],a[36:39]
ds_read_b128 v[152:155],v10 offset:19456
ds_read_b128 v[156:159],v10 offset:20480
v_accvgpr_read_b32 v73,a81
ds_read_b128 v[84:87],v10 offset:21504
v_pk_mul_f32 v[72:73],v[72:73],v[66:67] op_sel_hi:[1,0]
ds_read_b128 v[112:115],v0 offset:0
buffer_load_dwordx4 v6,s[8:11],s25 offen offset:0 lds
ds_read_b128 v[116:119],v1 offset:0
ds_read_b128 v[120:123],v0 offset:128
v_accvgpr_read_b32 v74,a82
ds_read_b128 v[124:127],v1 offset:128
v_accvgpr_read_b32 v75,a83
ds_read_b128 v[128:131],v0 offset:256
v_pk_mul_f32 v[74:75],v[74:75],v[66:67] op_sel_hi:[1,0]
v_accvgpr_read_b32 v80,a128
s_waitcnt lgkmcnt(8)
buffer_store_dwordx4 v[76:79],v9,s[16:19],s87 offen offset:128 nt
v_accvgpr_read_b32 v81,a129
v_pk_mul_f32 v[80:81],v[80:81],v[70:71] op_sel_hi:[1,0]
v_accvgpr_read_b32 v82,a130
v_accvgpr_read_b32 v83,a131
v_pk_mul_f32 v[82:83],v[82:83],v[70:71] op_sel_hi:[1,0]
v_cvt_pk_bf16_f32 v72,v72,v73
v_cvt_pk_bf16_f32 v80,v80,v81
v_mfma_f32_16x16x32_bf16 a[84:87],v[132:135],v[38:41],a[84:87]
v_cvt_pk_bf16_f32 v73,v74,v75
v_cvt_pk_bf16_f32 v81,v82,v83
v_mfma_f32_16x16x32_bf16 a[132:135],v[132:135],v[44:47],a[132:135]
ds_write2st64_b64 v36,v[72:73],v[80:81] offset0:36 offset1:40
v_mfma_f32_16x16x32_bf16 v[200:203],v[136:139],v[20:23],v[200:203]
v_add_u32 v36,v36,v53
v_rcp_f32 v54,v52
v_mfma_f32_16x16x32_bf16 v[248:251],v[136:139],v[26:29],v[248:251]
buffer_load_dwordx4 v7,s[8:11],s25 offen offset:1024 lds
v_mfma_f32_16x16x32_bf16 a[40:43],v[136:139],v[32:35],a[40:43]
s_waitcnt lgkmcnt(1)
buffer_store_dwordx4 v[152:155],v9,s[16:19],s87 offen offset:3200 nt
ds_read_b128 v[132:135],v1 offset:256
v_accvgpr_read_b32 v104,a84
v_accvgpr_read_b32 v105,a85
v_pk_mul_f32 v[104:105],v[104:105],v[66:67] op_sel_hi:[1,0]
v_accvgpr_read_b32 v106,a86
v_accvgpr_read_b32 v107,a87
v_pk_mul_f32 v[106:107],v[106:107],v[66:67] op_sel_hi:[1,0]
v_accvgpr_read_b32 v108,a132
v_accvgpr_read_b32 v109,a133
v_pk_mul_f32 v[108:109],v[108:109],v[70:71] op_sel_hi:[1,0]
v_accvgpr_read_b32 v110,a134
buffer_store_dwordx4 v[156:159],v9,s[16:19],s66 offen offset:128 nt
buffer_load_dwordx4 v8,s[8:11],s25 offen offset:2048 lds
v_accvgpr_read_b32 v111,a135
v_pk_mul_f32 v[110:111],v[110:111],v[70:71] op_sel_hi:[1,0]
v_cvt_pk_bf16_f32 v104,v104,v105
v_cvt_pk_bf16_f32 v108,v108,v109
v_mfma_f32_16x16x32_bf16 a[88:91],v[136:139],v[38:41],a[88:91]
s_add_u32 m0,s23,24576
v_cvt_pk_bf16_f32 v105,v106,v107
v_cvt_pk_bf16_f32 v109,v110,v111
v_mfma_f32_16x16x32_bf16 a[136:139],v[136:139],v[44:47],a[136:139]
ds_write2st64_b64 v37,v[104:105],v[108:109] offset0:36 offset1:40
v_mfma_f32_16x16x32_bf16 v[204:207],v[140:143],v[20:23],v[204:207]
v_add_u32 v37,v37,v53
v_accvgpr_read_b32 v110,a2
v_mfma_f32_16x16x32_bf16 v[252:255],v[140:143],v[26:29],v[252:255]
buffer_store_dwordx4 v[84:87],v9,s[16:19],s66 offen offset:3200 nt
ds_read_b128 v[136:139],v0 offset:6144
v_accvgpr_read_b32 v92,a88
v_accvgpr_read_b32 v93,a89
v_mfma_f32_16x16x32_bf16 a[44:47],v[140:143],v[32:35],a[44:47]
v_accvgpr_read_b32 v94,a90
v_accvgpr_read_b32 v95,a91
v_accvgpr_read_b32 v96,a136
v_accvgpr_read_b32 v97,a137
buffer_load_dwordx4 v6,s[8:11],s21 offen offset:0 lds
v_pk_mul_f32 v[92:93],v[92:93],v[66:67] op_sel_hi:[1,0]
v_pk_mul_f32 v[94:95],v[94:95],v[66:67] op_sel_hi:[1,0]
v_pk_mul_f32 v[96:97],v[96:97],v[70:71] op_sel_hi:[1,0]
v_accvgpr_read_b32 v98,a138
v_accvgpr_read_b32 v99,a139
v_pk_mul_f32 v[98:99],v[98:99],v[70:71] op_sel_hi:[1,0]
v_cvt_pk_bf16_f32 v92,v92,v93
v_cvt_pk_bf16_f32 v96,v96,v97
v_mfma_f32_16x16x32_bf16 a[92:95],v[140:143],v[38:41],a[92:95]
s_waitcnt vmcnt(15)
ds_read_b128 a[216:219],v11 offset:0
v_cvt_pk_bf16_f32 v93,v94,v95
v_mfma_f32_16x16x32_bf16 a[140:143],v[140:143],v[44:47],a[140:143]
ds_read_b128 a[220:223],v12 offset:0
v_cvt_pk_bf16_f32 v97,v98,v99
v_mfma_f32_16x16x32_bf16 v[72:75],v[112:115],a[144:147],0
ds_read_b128 a[224:227],v11 offset:128
v_accvgpr_read_b32 v111,a3
v_mfma_f32_16x16x32_bf16 v[80:83],v[112:115],a[168:171],0
ds_read_b128 a[228:231],v12 offset:128
v_accvgpr_read_b32 v108,a0
v_mfma_f32_16x16x32_bf16 v[88:91],v[112:115],a[192:195],0
ds_read_b128 a[232:235],v11 offset:256
ds_read_b128 a[236:239],v12 offset:256
v_accvgpr_read_b32 v109,a1
ds_write2st64_b64 v42,v[92:93],v[96:97] offset0:36 offset1:40
v_pk_mul_f32 v[208:209],v[208:209],v[58:59] op_sel_hi:[1,0]
v_pk_mul_f32 v[210:211],v[210:211],v[58:59] op_sel_hi:[1,0]
v_pk_mul_f32 v[224:225],v[224:225],v[58:59] op_sel_hi:[1,0]
ds_read_b128 v[140:143],v1 offset:6144
ds_read_b128 v[112:115],v0 offset:6272
buffer_load_dwordx4 v7,s[8:11],s21 offen offset:1024 lds
v_pk_mul_f32 v[226:227],v[226:227],v[58:59] op_sel_hi:[1,0]
v_pk_mul_f32 v[212:213],v[212:213],v[58:59] op_sel_hi:[1,0]
v_pk_mul_f32 v[214:215],v[214:215],v[58:59] op_sel_hi:[1,0]
v_pk_mul_f32 v[228:229],v[228:229],v[58:59] op_sel_hi:[1,0]
v_pk_mul_f32 v[230:231],v[230:231],v[58:59] op_sel_hi:[1,0]
v_pk_mul_f32 v[216:217],v[216:217],v[58:59] op_sel_hi:[1,0]
v_pk_mul_f32 v[218:219],v[218:219],v[58:59] op_sel_hi:[1,0]
v_pk_mul_f32 v[232:233],v[232:233],v[58:59] op_sel_hi:[1,0]
v_pk_mul_f32 v[234:235],v[234:235],v[58:59] op_sel_hi:[1,0]
v_pk_mul_f32 v[220:221],v[220:221],v[58:59] op_sel_hi:[1,0]
v_pk_mul_f32 v[222:223],v[222:223],v[58:59] op_sel_hi:[1,0]
v_pk_mul_f32 v[236:237],v[236:237],v[58:59] op_sel_hi:[1,0]
v_pk_mul_f32 v[238:239],v[238:239],v[58:59] op_sel_hi:[1,0]
v_pk_mul_f32 v[240:241],v[240:241],v[58:59] op_sel_hi:[1,0]
v_pk_mul_f32 v[242:243],v[242:243],v[58:59] op_sel_hi:[1,0]
v_pk_mul_f32 v[110:111],v[110:111],v[62:63] op_sel_hi:[1,0]
v_pk_mul_f32 v[244:245],v[244:245],v[58:59] op_sel_hi:[1,0]
v_pk_mul_f32 v[246:247],v[246:247],v[58:59] op_sel_hi:[1,0]
v_pk_mul_f32 v[108:109],v[108:109],v[62:63] op_sel_hi:[1,0]
v_add_u32 v42,v42,v53
v_accvgpr_read_b32 v100,a92
v_accvgpr_read_b32 v101,a93
v_pk_mul_f32 v[100:101],v[100:101],v[66:67] op_sel_hi:[1,0]
v_accvgpr_read_b32 v102,a94
v_accvgpr_read_b32 v103,a95
v_pk_mul_f32 v[102:103],v[102:103],v[66:67] op_sel_hi:[1,0]
v_accvgpr_read_b32 v94,a6
v_accvgpr_read_b32 v95,a7
v_pk_mul_f32 v[94:95],v[94:95],v[62:63] op_sel_hi:[1,0]
v_accvgpr_read_b32 v76,a140
v_accvgpr_read_b32 v77,a141
v_pk_mul_f32 v[76:77],v[76:77],v[70:71] op_sel_hi:[1,0]
v_accvgpr_read_b32 v78,a142
v_accvgpr_read_b32 v79,a143
v_pk_mul_f32 v[78:79],v[78:79],v[70:71] op_sel_hi:[1,0]
v_accvgpr_read_b32 v92,a4
v_accvgpr_read_b32 v93,a5
v_pk_mul_f32 v[92:93],v[92:93],v[62:63] op_sel_hi:[1,0]
v_cvt_pk_bf16_f32 v100,v100,v101
v_cvt_pk_bf16_f32 v76,v76,v77
v_mfma_f32_16x16x32_bf16 v[72:75],v[116:119],a[148:151],v[72:75]
v_cvt_pk_bf16_f32 v101,v102,v103
v_cvt_pk_bf16_f32 v77,v78,v79
v_mfma_f32_16x16x32_bf16 v[80:83],v[116:119],a[172:175],v[80:83]
buffer_load_dwordx4 v8,s[8:11],s21 offen offset:2048 lds
v_mfma_f32_16x16x32_bf16 v[88:91],v[116:119],a[196:199],v[88:91]
s_add_u32 s21,s21,12288
ds_write2st64_b64 v43,v[100:101],v[76:77] offset0:36 offset1:40
v_pk_mul_f32 v[248:249],v[248:249],v[58:59] op_sel_hi:[1,0]
v_pk_mul_f32 v[250:251],v[250:251],v[58:59] op_sel_hi:[1,0]
v_add_u32 v43,v43,v53
ds_read_b128 v[152:155],v10 offset:18432
ds_read_b128 v[156:159],v10 offset:19456
v_accvgpr_read_b32 v98,a10
ds_read_b128 v[84:87],v10 offset:20480
v_accvgpr_read_b32 v99,a11
ds_read_b128 v[104:107],v10 offset:21504
v_pk_mul_f32 v[98:99],v[98:99],v[62:63] op_sel_hi:[1,0]
ds_read_b128 v[116:119],v1 offset:6272
v_accvgpr_read_b32 v96,a8
v_accvgpr_read_b32 v97,a9
v_pk_mul_f32 v[96:97],v[96:97],v[62:63] op_sel_hi:[1,0]
v_accvgpr_read_b32 v78,a14
v_accvgpr_read_b32 v79,a15
v_mfma_f32_16x16x32_bf16 v[72:75],v[120:123],a[152:155],v[72:75]
s_mov_b32 s27,s42
v_accvgpr_read_b32 v76,a12
v_accvgpr_read_b32 v77,a13
v_mfma_f32_16x16x32_bf16 v[80:83],v[120:123],a[176:179],v[80:83]
s_mov_b32 s42,s41
v_cvt_pk_bf16_f32 v208,v208,v209
v_cvt_pk_bf16_f32 v224,v224,v225
v_mfma_f32_16x16x32_bf16 v[88:91],v[120:123],a[200:203],v[88:91]
s_add_u32 s69,s69,1
ds_read_b128 v[120:123],v0 offset:6400
v_cvt_pk_bf16_f32 v209,v210,v211
v_cvt_pk_bf16_f32 v225,v226,v227
ds_write2st64_b64 v36,v[208:209],v[224:225] offset0:12 offset1:14
v_pk_mul_f32 v[252:253],v[252:253],v[58:59] op_sel_hi:[1,0]
v_pk_mul_f32 v[254:255],v[254:255],v[58:59] op_sel_hi:[1,0]
v_pk_mul_f32 v[76:77],v[76:77],v[62:63] op_sel_hi:[1,0]
s_waitcnt lgkmcnt(3)
buffer_store_dwordx4 v[152:155],v9,s[16:19],s87 offen offset:256 nt
v_pk_mul_f32 v[78:79],v[78:79],v[62:63] op_sel_hi:[1,0]
v_accvgpr_read_b32 v102,a18
v_accvgpr_read_b32 v103,a19
v_mfma_f32_16x16x32_bf16 v[72:75],v[124:127],a[156:159],v[72:75]
s_lshl_b32 s62,s69,5
v_accvgpr_read_b32 v100,a16
v_accvgpr_read_b32 v101,a17
v_mfma_f32_16x16x32_bf16 v[80:83],v[124:127],a[180:183],v[80:83]
s_add_u32 s62,s62,s34
v_accvgpr_read_b32 v210,a34
v_accvgpr_read_b32 v211,a35
v_mfma_f32_16x16x32_bf16 v[88:91],v[124:127],a[204:207],v[88:91]
s_mul_i32 s63,s62,171
ds_read_b128 v[124:127],v1 offset:6400
buffer_store_dwordx4 v[156:159],v9,s[16:19],s87 offen offset:3328 nt
v_accvgpr_read_b32 v208,a32
v_accvgpr_read_b32 v209,a33
v_accvgpr_read_b32 v226,a22
v_mfma_f32_16x16x32_bf16 v[72:75],v[128:131],a[160:163],v[72:75]
s_lshr_b32 s63,s63,9
v_accvgpr_read_b32 v227,a23
v_accvgpr_read_b32 v224,a20
v_accvgpr_read_b32 v225,a21
v_cvt_pk_bf16_f32 v212,v212,v213
v_cvt_pk_bf16_f32 v228,v228,v229
v_pk_mul_f32 v[100:101],v[100:101],v[62:63] op_sel_hi:[1,0]
buffer_store_dwordx4 v[84:87],v9,s[16:19],s66 offen offset:256 nt
v_pk_mul_f32 v[102:103],v[102:103],v[62:63] op_sel_hi:[1,0]
v_pk_mul_f32 v[208:209],v[208:209],v[62:63] op_sel_hi:[1,0]
v_pk_mul_f32 v[210:211],v[210:211],v[62:63] op_sel_hi:[1,0]
v_cvt_pk_bf16_f32 v216,v216,v217
v_cvt_pk_bf16_f32 v232,v232,v233
v_mfma_f32_16x16x32_bf16 v[80:83],v[128:131],a[184:187],v[80:83]
s_mul_i32 s64,s63,3
v_cvt_pk_bf16_f32 v213,v214,v215
v_cvt_pk_bf16_f32 v229,v230,v231
v_mfma_f32_16x16x32_bf16 v[88:91],v[128:131],a[208:211],v[88:91]
s_sub_u32 s62,s62,s64
ds_write2st64_b64 v37,v[212:213],v[228:229] offset0:12 offset1:14
v_mfma_f32_16x16x32_bf16 v[72:75],v[132:135],a[164:167],v[72:75]
s_add_u32 s63,s63,s33
v_cvt_pk_bf16_f32 v220,v220,v221
buffer_store_dwordx4 v[104:107],v9,s[16:19],s66 offen offset:3328 nt
ds_read_b128 v[128:131],v0 offset:0
v_pk_mul_f32 v[224:225],v[224:225],v[62:63] op_sel_hi:[1,0]
v_pk_mul_f32 v[226:227],v[226:227],v[62:63] op_sel_hi:[1,0]
v_accvgpr_read_b32 v104,a36
v_accvgpr_read_b32 v105,a37
v_pk_mul_f32 v[104:105],v[104:105],v[62:63] op_sel_hi:[1,0]
v_accvgpr_read_b32 v106,a38
v_accvgpr_read_b32 v107,a39
v_pk_mul_f32 v[106:107],v[106:107],v[62:63] op_sel_hi:[1,0]
v_cvt_pk_bf16_f32 v236,v236,v237
v_cvt_pk_bf16_f32 v217,v218,v219
v_mfma_f32_16x16x32_bf16 v[80:83],v[132:135],a[188:191],v[80:83]
s_mul_i32 s30,s63,196608
v_cvt_pk_bf16_f32 v233,v234,v235
v_cvt_pk_bf16_f32 v240,v240,v241
v_mfma_f32_16x16x32_bf16 v[88:91],v[132:135],a[212:215],v[88:91]
s_mul_i32 s41,s63,325632
ds_write2st64_b64 v42,v[216:217],v[232:233] offset0:12 offset1:14
v_cvt_pk_bf16_f32 v108,v108,v109
v_cvt_pk_bf16_f32 v221,v222,v223
v_cvt_pk_bf16_f32 v237,v238,v239
ds_read_b128 v[132:135],v1 offset:0
v_cvt_pk_bf16_f32 v244,v244,v245
v_cvt_pk_bf16_f32 v92,v92,v93
v_cvt_pk_bf16_f32 v241,v242,v243
v_cvt_pk_bf16_f32 v109,v110,v111
v_cvt_pk_bf16_f32 v248,v248,v249
ds_write2st64_b64 v43,v[220:221],v[236:237] offset0:12 offset1:14
v_cvt_pk_bf16_f32 v96,v96,v97
v_cvt_pk_bf16_f32 v245,v246,v247
v_cvt_pk_bf16_f32 v93,v94,v95
v_cvt_pk_bf16_f32 v252,v252,v253
v_cvt_pk_bf16_f32 v76,v76,v77
v_cvt_pk_bf16_f32 v249,v250,v251
v_cvt_pk_bf16_f32 v97,v98,v99
v_cvt_pk_bf16_f32 v253,v254,v255
v_cvt_pk_bf16_f32 v77,v78,v79
v_accvgpr_read_b32 v214,a26
v_accvgpr_read_b32 v215,a27
ds_write2st64_b64 v36,v[240:241],v[108:109] offset0:16 offset1:24
v_accvgpr_read_b32 v230,a42
v_accvgpr_read_b32 v231,a43
v_accvgpr_read_b32 v212,a24
v_accvgpr_read_b32 v213,a25
v_accvgpr_read_b32 v228,a40
v_accvgpr_read_b32 v229,a41
v_accvgpr_read_b32 v218,a30
v_accvgpr_read_b32 v219,a31
v_accvgpr_read_b32 v234,a46
v_accvgpr_read_b32 v235,a47
v_accvgpr_read_b32 v216,a28
ds_write2st64_b64 v37,v[244:245],v[92:93] offset0:16 offset1:24
v_accvgpr_read_b32 v217,a29
v_accvgpr_read_b32 v232,a44
v_accvgpr_read_b32 v233,a45
v_cvt_pk_bf16_f32 v100,v100,v101
v_cvt_pk_bf16_f32 v208,v208,v209
v_cvt_pk_bf16_f32 v101,v102,v103
v_cvt_pk_bf16_f32 v209,v210,v211
v_max3_f32 v20,v72,v73,v74
v_max3_f32 v26,v80,v81,v82
v_max3_f32 v32,v88,v89,v90
v_cvt_pk_bf16_f32 v224,v224,v225
ds_write2st64_b64 v42,v[248:249],v[96:97] offset0:16 offset1:24
v_cvt_pk_bf16_f32 v104,v104,v105
v_cvt_pk_bf16_f32 v225,v226,v227
v_cvt_pk_bf16_f32 v105,v106,v107
s_lshl_b32 s63,s3,2
s_add_u32 s64,s63,21
s_cmp_eq_u32 s3,0
s_cselect_b32 s64,20,s64
s_cselect_b32 s40,1,0
s_add_u32 s65,s63,37
s_cmp_eq_u32 s62,2
s_cselect_b32 s64,s65,s64
ds_write2st64_b64 v43,v[252:253],v[76:77] offset0:16 offset1:24
v_mfma_f32_16x16x32_bf16 v[76:79],v[136:139],a[144:147],0
s_cselect_b32 s40,0,s40
s_add_u32 s65,s63,s3
s_cmp_eq_u32 s62,0
s_cselect_b32 s64,s65,s64
s_cselect_b32 s40,1,s40
s_mul_i32 s64,s64,6144
v_pk_mul_f32 v[212:213],v[212:213],v[62:63] op_sel_hi:[1,0]
v_pk_mul_f32 v[214:215],v[214:215],v[62:63] op_sel_hi:[1,0]
v_pk_mul_f32 v[228:229],v[228:229],v[62:63] op_sel_hi:[1,0]
v_pk_mul_f32 v[230:231],v[230:231],v[62:63] op_sel_hi:[1,0]
v_cvt_pk_bf16_f32 v212,v212,v213
v_cvt_pk_bf16_f32 v228,v228,v229
v_mfma_f32_16x16x32_bf16 v[84:87],v[136:139],a[168:171],0
s_add_u32 s41,s41,s64
ds_write2st64_b64 v36,v[100:101],v[208:209] offset0:26 offset1:28
v_mfma_f32_16x16x32_bf16 v[92:95],v[136:139],a[192:195],0
s_cmp_ge_u32 s69,6
v_cvt_pk_bf16_f32 v213,v214,v215
v_cvt_pk_bf16_f32 v229,v230,v231
v_mfma_f32_16x16x32_bf16 v[76:79],v[140:143],a[148:151],v[76:79]
s_cselect_b32 s41,166723584,s41
ds_read_b128 v[136:139],v0 offset:128
s_cselect_b32 s30,100663296,s30
s_add_u32 s25,s30,s22
s_add_u32 s26,s25,12288
s_add_u32 m0,s22,0
ds_write2st64_b64 v37,v[224:225],v[104:105] offset0:26 offset1:28
v_pk_mul_f32 v[216:217],v[216:217],v[62:63] op_sel_hi:[1,0]
v_pk_mul_f32 v[218:219],v[218:219],v[62:63] op_sel_hi:[1,0]
v_pk_mul_f32 v[232:233],v[232:233],v[62:63] op_sel_hi:[1,0]
v_pk_mul_f32 v[234:235],v[234:235],v[62:63] op_sel_hi:[1,0]
v_cvt_pk_bf16_f32 v216,v216,v217
v_cvt_pk_bf16_f32 v232,v232,v233
v_mfma_f32_16x16x32_bf16 v[84:87],v[140:143],a[172:175],v[84:87]
s_mov_b32 s28,s41
v_cvt_pk_bf16_f32 v217,v218,v219
v_cvt_pk_bf16_f32 v233,v234,v235
v_mfma_f32_16x16x32_bf16 v[92:95],v[140:143],a[196:199],v[92:95]
s_mov_b32 s29,s24
ds_read_b128 v[140:143],v1 offset:128
v_mfma_f32_16x16x32_bf16 v[76:79],v[112:115],a[152:155],v[76:79]
ds_write2st64_b64 v42,v[212:213],v[228:229] offset0:26 offset1:28
v_pk_mul_f32 v[160:161],v[160:161],v[54:55] op_sel_hi:[1,0]
v_pk_mul_f32 v[162:163],v[162:163],v[54:55] op_sel_hi:[1,0]
v_pk_mul_f32 v[176:177],v[176:177],v[54:55] op_sel_hi:[1,0]
v_pk_mul_f32 v[178:179],v[178:179],v[54:55] op_sel_hi:[1,0]
v_cvt_pk_bf16_f32 v160,v160,v161
v_cvt_pk_bf16_f32 v176,v176,v177
v_mfma_f32_16x16x32_bf16 v[84:87],v[112:115],a[176:179],v[84:87]
v_cvt_pk_bf16_f32 v161,v162,v163
v_cvt_pk_bf16_f32 v177,v178,v179
v_mfma_f32_16x16x32_bf16 v[92:95],v[112:115],a[200:203],v[92:95]
s_waitcnt lgkmcnt(2)
ds_read_b128 v[112:115],v0 offset:256
v_mfma_f32_16x16x32_bf16 v[76:79],v[116:119],a[156:159],v[76:79]
ds_write2st64_b64 v43,v[216:217],v[232:233] offset0:26 offset1:28
v_mfma_f32_16x16x32_bf16 v[84:87],v[116:119],a[180:183],v[84:87]
v_pk_mul_f32 v[164:165],v[164:165],v[54:55] op_sel_hi:[1,0]
v_pk_mul_f32 v[166:167],v[166:167],v[54:55] op_sel_hi:[1,0]
v_pk_mul_f32 v[180:181],v[180:181],v[54:55] op_sel_hi:[1,0]
v_pk_mul_f32 v[182:183],v[182:183],v[54:55] op_sel_hi:[1,0]
v_cvt_pk_bf16_f32 v164,v164,v165
v_cvt_pk_bf16_f32 v180,v180,v181
v_mfma_f32_16x16x32_bf16 v[92:95],v[116:119],a[204:207],v[92:95]
ds_write2st64_b64 v36,v[160:161],v[176:177] offset0:0 offset1:2
v_mfma_f32_16x16x32_bf16 v[76:79],v[120:123],a[160:163],v[76:79]
v_cvt_pk_bf16_f32 v165,v166,v167
v_cvt_pk_bf16_f32 v181,v182,v183
v_mfma_f32_16x16x32_bf16 v[84:87],v[120:123],a[184:187],v[84:87]
ds_read_b128 v[116:119],v1 offset:256
v_pk_mul_f32 v[168:169],v[168:169],v[54:55] op_sel_hi:[1,0]
ds_write2st64_b64 v37,v[164:165],v[180:181] offset0:0 offset1:2
v_pk_mul_f32 v[170:171],v[170:171],v[54:55] op_sel_hi:[1,0]
v_pk_mul_f32 v[184:185],v[184:185],v[54:55] op_sel_hi:[1,0]
v_pk_mul_f32 v[186:187],v[186:187],v[54:55] op_sel_hi:[1,0]
v_cvt_pk_bf16_f32 v168,v168,v169
v_cvt_pk_bf16_f32 v184,v184,v185
v_mfma_f32_16x16x32_bf16 v[92:95],v[120:123],a[208:211],v[92:95]
ds_read_b128 v[120:123],v0 offset:6144
v_cvt_pk_bf16_f32 v169,v170,v171
v_mfma_f32_16x16x32_bf16 v[76:79],v[124:127],a[164:167],v[76:79]
v_cvt_pk_bf16_f32 v185,v186,v187
v_mfma_f32_16x16x32_bf16 v[84:87],v[124:127],a[188:191],v[84:87]
ds_write2st64_b64 v42,v[168:169],v[184:185] offset0:0 offset1:2
v_pk_mul_f32 v[172:173],v[172:173],v[54:55] op_sel_hi:[1,0]
v_pk_mul_f32 v[174:175],v[174:175],v[54:55] op_sel_hi:[1,0]
v_pk_mul_f32 v[188:189],v[188:189],v[54:55] op_sel_hi:[1,0]
v_pk_mul_f32 v[190:191],v[190:191],v[54:55] op_sel_hi:[1,0]
v_cvt_pk_bf16_f32 v172,v172,v173
v_max3_f32 v20,v20,v75,v76
v_mfma_f32_16x16x32_bf16 v[92:95],v[124:127],a[212:215],v[92:95]
ds_read_b128 v[124:127],v1 offset:6144
v_max3_f32 v20,v20,v77,v78
v_mfma_f32_16x16x32_bf16 v[96:99],v[128:131],a[216:219],0
ds_read_b128 v[128:131],v0 offset:6272
v_max_f32 v20,v20,v79
v_mfma_f32_16x16x32_bf16 v[96:99],v[132:135],a[220:223],v[96:99]
ds_read_b128 v[132:135],v1 offset:6272
v_mov_b32 v21,v20
v_max3_f32 v26,v26,v83,v84
v_max3_f32 v26,v26,v85,v86
v_permlane32_swap_b32 v21,v20
v_pk_mul_f32 v[192:193],v[192:193],v[54:55] op_sel_hi:[1,0]
v_pk_mul_f32 v[194:195],v[194:195],v[54:55] op_sel_hi:[1,0]
v_max_f32 v20,v20,v21
v_max_f32 v26,v26,v87
v_mfma_f32_16x16x32_bf16 v[96:99],v[136:139],a[224:227],v[96:99]
s_waitcnt lgkmcnt(3)
ds_read_b128 v[136:139],v0 offset:6400
v_mov_b32 v21,v20
v_mfma_f32_16x16x32_bf16 v[96:99],v[140:143],a[228:231],v[96:99]
ds_read_b128 v[140:143],v1 offset:6400
v_mov_b32 v27,v26
v_mfma_f32_16x16x32_bf16 v[96:99],v[112:115],a[232:235],v[96:99]
ds_read_b128 v[112:115],v0 offset:12544
v_permlane16_swap_b32 v21,v20
v_mfma_f32_16x16x32_bf16 v[96:99],v[116:119],a[236:239],v[96:99]
ds_read_b128 v[116:119],v1 offset:12544
v_max3_f32 v32,v32,v91,v92
v_permlane32_swap_b32 v27,v26
v_max_f32 v20,v20,v21
v_pk_mul_f32 v[196:197],v[196:197],v[54:55] op_sel_hi:[1,0]
v_pk_mul_f32 v[198:199],v[198:199],v[54:55] op_sel_hi:[1,0]
v_max3_f32 v32,v32,v93,v94
v_max_f32 v26,v26,v27
v_mfma_f32_16x16x32_bf16 v[100:103],v[120:123],a[216:219],0
s_waitcnt lgkmcnt(4)
ds_read_b128 v[120:123],v0 offset:18432
v_mul_f32_e64 v13,-s36,v20
v_mfma_f32_16x16x32_bf16 v[100:103],v[124:127],a[220:223],v[100:103]
ds_read_b128 v[124:127],v1 offset:18432
v_max_f32 v32,v32,v95
v_mfma_f32_16x16x32_bf16 v[100:103],v[128:131],a[224:227],v[100:103]
ds_read_b128 v[128:131],v0 offset:12288
v_mov_b32 v27,v26
v_fma_f32 v72,v72,s36,v13
v_fma_f32 v73,v73,s36,v13
v_fma_f32 v74,v74,s36,v13
v_pk_mul_f32 v[200:201],v[200:201],v[54:55] op_sel_hi:[1,0]
v_pk_mul_f32 v[202:203],v[202:203],v[54:55] op_sel_hi:[1,0]
v_fma_f32 v75,v75,s36,v13
v_max3_f32 v38,v96,v97,v98
v_mfma_f32_16x16x32_bf16 v[100:103],v[132:135],a[228:231],v[100:103]
s_waitcnt lgkmcnt(4)
ds_read_b128 v[132:135],v1 offset:12288
v_mov_b32 v33,v32
v_mfma_f32_16x16x32_bf16 v[100:103],v[136:139],a[232:235],v[100:103]
ds_read_b128 v[136:139],v0 offset:12416
v_permlane16_swap_b32 v27,v26
v_mfma_f32_16x16x32_bf16 v[100:103],v[140:143],a[236:239],v[100:103]
ds_read_b128 v[140:143],v1 offset:12416
v_exp_f32 v72,v72
v_exp_f32 v73,v73
v_pk_mul_f32 v[204:205],v[204:205],v[54:55] op_sel_hi:[1,0]
v_pk_mul_f32 v[206:207],v[206:207],v[54:55] op_sel_hi:[1,0]
v_exp_f32 v74,v74
v_exp_f32 v75,v75
v_permlane32_swap_b32 v33,v32
v_max_f32 v26,v26,v27
v_max3_f32 v38,v38,v99,v100
v_max_f32 v32,v32,v33
v_mul_f32_e64 v14,-s36,v26
v_max3_f32 v38,v38,v101,v102
v_cvt_pk_bf16_f32 v18,v72,v73
v_cvt_pk_bf16_f32 v19,v74,v75
s_waitcnt lgkmcnt(3)
v_mfma_f32_16x16x32_bf16 v[72:75],v[128:131],a[144:147],0
v_mov_b32 v33,v32
v_fma_f32 v80,v80,s36,v14
v_fma_f32 v81,v81,s36,v14
v_fma_f32 v82,v82,s36,v14
v_fma_f32 v83,v83,s36,v14
v_max_f32 v38,v38,v103
v_permlane16_swap_b32 v33,v32
v_exp_f32 v80,v80
v_exp_f32 v81,v81
v_exp_f32 v82,v82
v_exp_f32 v83,v83
v_mov_b32 v39,v38
v_max_f32 v32,v32,v33
v_mul_f32_e64 v15,-s36,v32
v_permlane32_swap_b32 v39,v38
v_max_f32 v38,v38,v39
v_cvt_pk_bf16_f32 v24,v80,v81
v_cvt_pk_bf16_f32 v25,v82,v83
v_mfma_f32_16x16x32_bf16 v[80:83],v[128:131],a[168:171],0
v_fma_f32 v88,v88,s36,v15
v_fma_f32 v89,v89,s36,v15
v_fma_f32 v90,v90,s36,v15
v_fma_f32 v91,v91,s36,v15
v_mov_b32 v39,v38
v_exp_f32 v88,v88
v_exp_f32 v89,v89
v_exp_f32 v90,v90
v_exp_f32 v91,v91
v_permlane16_swap_b32 v39,v38
v_max_f32 v38,v38,v39
v_cvt_pk_bf16_f32 v188,v188,v189
v_mul_f32_e64 v16,-s36,v38
v_cvt_pk_bf16_f32 v173,v174,v175
v_cvt_pk_bf16_f32 v192,v192,v193
v_cvt_pk_bf16_f32 v30,v88,v89
v_cvt_pk_bf16_f32 v31,v90,v91
v_mfma_f32_16x16x32_bf16 v[88:91],v[128:131],a[192:195],0
v_cvt_pk_bf16_f32 v189,v190,v191
ds_write2st64_b64 v43,v[172:173],v[188:189] offset0:0 offset1:2
v_fma_f32 v96,v96,s36,v16
v_fma_f32 v97,v97,s36,v16
v_fma_f32 v98,v98,s36,v16
v_fma_f32 v99,v99,s36,v16
v_cvt_pk_bf16_f32 v196,v196,v197
v_cvt_pk_bf16_f32 v193,v194,v195
v_exp_f32 v96,v96
v_exp_f32 v97,v97
v_exp_f32 v98,v98
ds_write_b64 v36,v[192:193] offset:2048
v_exp_f32 v99,v99
v_cvt_pk_bf16_f32 v197,v198,v199
v_cvt_pk_bf16_f32 v36,v96,v97
ds_write_b64 v37,v[196:197] offset:2048
v_cvt_pk_bf16_f32 v37,v98,v99
v_mfma_f32_16x16x32_bf16 v[96:99],v[128:131],a[216:219],0
s_waitcnt lgkmcnt(2)
ds_read_b128 v[128:131],v0 offset:18560
v_fma_f32 v76,v76,s36,v13
v_mfma_f32_16x16x32_bf16 v[72:75],v[132:135],a[148:151],v[72:75]
v_fma_f32 v77,v77,s36,v13
v_fma_f32 v78,v78,s36,v13
v_mfma_f32_16x16x32_bf16 v[80:83],v[132:135],a[172:175],v[80:83]
v_fma_f32 v79,v79,s36,v13
v_exp_f32 v76,v76
v_mfma_f32_16x16x32_bf16 v[88:91],v[132:135],a[196:199],v[88:91]
v_exp_f32 v77,v77
v_mfma_f32_16x16x32_bf16 v[96:99],v[132:135],a[220:223],v[96:99]
ds_read_b128 v[132:135],v1 offset:18560
v_exp_f32 v78,v78
v_mfma_f32_16x16x32_bf16 v[72:75],v[136:139],a[152:155],v[72:75]
v_exp_f32 v79,v79
v_mfma_f32_16x16x32_bf16 v[80:83],v[136:139],a[176:179],v[80:83]
v_fma_f32 v84,v84,s36,v14
v_fma_f32 v85,v85,s36,v14
v_mfma_f32_16x16x32_bf16 v[88:91],v[136:139],a[200:203],v[88:91]
v_fma_f32 v86,v86,s36,v14
s_waitcnt vmcnt(8)
s_barrier
v_mfma_f32_16x16x32_bf16 v[96:99],v[136:139],a[224:227],v[96:99]
ds_read_b128 v[136:139],v0 offset:18688
buffer_load_dwordx4 v6,s[4:7],s20 offen offset:0 lds
v_mfma_f32_16x16x32_bf16 v[72:75],v[140:143],a[156:159],v[72:75]
v_fma_f32 v87,v87,s36,v14
v_cvt_pk_bf16_f32 v20,v76,v77
v_mfma_f32_16x16x32_bf16 v[80:83],v[140:143],a[180:183],v[80:83]
v_cvt_pk_bf16_f32 v21,v78,v79
v_exp_f32 v84,v84
v_mfma_f32_16x16x32_bf16 v[88:91],v[140:143],a[204:207],v[88:91]
v_exp_f32 v85,v85
v_mfma_f32_16x16x32_bf16 v[52:55],v[48:51],v[18:21],0
v_exp_f32 v86,v86
v_mfma_f32_16x16x32_bf16 v[96:99],v[140:143],a[228:231],v[96:99]
ds_read_b128 v[140:143],v1 offset:18688
v_exp_f32 v87,v87
v_mfma_f32_16x16x32_bf16 v[72:75],v[112:115],a[160:163],v[72:75]
buffer_load_dwordx4 v7,s[4:7],s20 offen offset:1024 lds
v_mfma_f32_16x16x32_bf16 v[80:83],v[112:115],a[184:187],v[80:83]
v_fma_f32 v92,v92,s36,v15
v_fma_f32 v93,v93,s36,v15
v_mfma_f32_16x16x32_bf16 v[88:91],v[112:115],a[208:211],v[88:91]
v_fma_f32 v94,v94,s36,v15
v_fma_f32 v95,v95,s36,v15
v_mfma_f32_16x16x32_bf16 v[96:99],v[112:115],a[232:235],v[96:99]
ds_read_b64_tr_b16 v[112:113],v2 offset:0
ds_read_b64_tr_b16 v[114:115],v2 offset:6144
v_mfma_f32_16x16x32_bf16 v[72:75],v[116:119],a[164:167],v[72:75]
v_cvt_pk_bf16_f32 v26,v84,v85
v_cvt_pk_bf16_f32 v27,v86,v87
v_mfma_f32_16x16x32_bf16 v[80:83],v[116:119],a[188:191],v[80:83]
buffer_load_dwordx4 v8,s[4:7],s20 offen offset:2048 lds
v_mfma_f32_16x16x32_bf16 v[56:59],v[48:51],v[24:27],0
s_add_u32 s20,s20,12288
v_exp_f32 v92,v92
v_mfma_f32_16x16x32_bf16 v[88:91],v[116:119],a[212:215],v[88:91]
v_exp_f32 v93,v93
v_mfma_f32_16x16x32_bf16 v[96:99],v[116:119],a[236:239],v[96:99]
ds_read_b64_tr_b16 v[116:117],v3 offset:0
ds_read_b64_tr_b16 v[118:119],v3 offset:6144
v_mfma_f32_16x16x32_bf16 v[76:79],v[120:123],a[144:147],0
v_exp_f32 v94,v94
v_mfma_f32_16x16x32_bf16 v[84:87],v[120:123],a[168:171],0
v_exp_f32 v95,v95
v_fma_f32 v100,v100,s36,v16
v_fma_f32 v101,v101,s36,v16
v_fma_f32 v102,v102,s36,v16
v_fma_f32 v103,v103,s36,v16
v_cvt_pk_bf16_f32 v32,v92,v93
v_cvt_pk_bf16_f32 v33,v94,v95
v_mfma_f32_16x16x32_bf16 v[92:95],v[120:123],a[192:195],0
v_exp_f32 v100,v100
v_mfma_f32_16x16x32_bf16 v[60:63],v[48:51],v[30:33],0
v_exp_f32 v101,v101
v_exp_f32 v102,v102
v_exp_f32 v103,v103
v_cvt_pk_bf16_f32 v38,v100,v101
v_cvt_pk_bf16_f32 v39,v102,v103
v_mfma_f32_16x16x32_bf16 v[100:103],v[120:123],a[216:219],0
ds_read_b64_tr_b16 v[120:121],v4 offset:0
ds_read_b64_tr_b16 v[122:123],v4 offset:6144
v_mfma_f32_16x16x32_bf16 v[64:67],v[48:51],v[36:39],0
v_fma_f32 v72,v72,s36,v13
v_fma_f32 v73,v73,s36,v13
v_mfma_f32_16x16x32_bf16 v[76:79],v[124:127],a[148:151],v[76:79]
v_fma_f32 v74,v74,s36,v13
v_fma_f32 v75,v75,s36,v13
v_mfma_f32_16x16x32_bf16 v[84:87],v[124:127],a[172:175],v[84:87]
v_fma_f32 v80,v80,s36,v14
v_fma_f32 v81,v81,s36,v14
v_mfma_f32_16x16x32_bf16 v[92:95],v[124:127],a[196:199],v[92:95]
v_cvt_pk_bf16_f32 v200,v200,v201
v_exp_f32 v72,v72
v_mfma_f32_16x16x32_bf16 v[100:103],v[124:127],a[220:223],v[100:103]
s_waitcnt lgkmcnt(2)
ds_read_b64_tr_b16 v[124:125],v5 offset:0
ds_read_b64_tr_b16 v[126:127],v5 offset:6144
v_mfma_f32_16x16x32_bf16 v[76:79],v[128:131],a[152:155],v[76:79]
v_exp_f32 v73,v73
v_mfma_f32_16x16x32_bf16 v[84:87],v[128:131],a[176:179],v[84:87]
v_exp_f32 v74,v74
v_mfma_f32_16x16x32_bf16 v[92:95],v[128:131],a[200:203],v[92:95]
v_exp_f32 v75,v75
v_mfma_f32_16x16x32_bf16 v[100:103],v[128:131],a[224:227],v[100:103]
v_exp_f32 v80,v80
v_mfma_f32_16x16x32_bf16 v[76:79],v[132:135],a[156:159],v[76:79]
v_exp_f32 v81,v81
v_mfma_f32_16x16x32_bf16 v[84:87],v[132:135],a[180:183],v[84:87]
v_cvt_pk_bf16_f32 v204,v204,v205
v_cvt_pk_bf16_f32 v201,v202,v203
v_mfma_f32_16x16x32_bf16 v[92:95],v[132:135],a[204:207],v[92:95]
ds_write_b64 v42,v[200:201] offset:2048
v_mfma_f32_16x16x32_bf16 v[100:103],v[132:135],a[228:231],v[100:103]
v_cvt_pk_bf16_f32 v205,v206,v207
v_cvt_pk_bf16_f32 v22,v72,v73
v_mfma_f32_16x16x32_bf16 v[76:79],v[136:139],a[160:163],v[76:79]
ds_write_b64 v43,v[204:205] offset:2048
v_mfma_f32_16x16x32_bf16 v[84:87],v[136:139],a[184:187],v[84:87]
v_cvt_pk_bf16_f32 v23,v74,v75
v_cvt_pk_bf16_f32 v28,v80,v81
v_mfma_f32_16x16x32_bf16 v[92:95],v[136:139],a[208:211],v[92:95]
v_mfma_f32_16x16x32_bf16 v[100:103],v[136:139],a[232:235],v[100:103]
v_mfma_f32_16x16x32_bf16 v[76:79],v[140:143],a[164:167],v[76:79]
v_mfma_f32_16x16x32_bf16 v[84:87],v[140:143],a[188:191],v[84:87]
v_mfma_f32_16x16x32_bf16 v[92:95],v[140:143],a[212:215],v[92:95]
v_mfma_f32_16x16x32_bf16 v[100:103],v[140:143],a[236:239],v[100:103]
v_mfma_f32_16x16x32_bf16 v[160:163],v[112:115],v[18:21],0
s_add_u32 m0,s23,0
ds_read_b64_tr_b16 v[128:129],v2 offset:128
ds_read_b64_tr_b16 v[130:131],v2 offset:6272
v_mfma_f32_16x16x32_bf16 v[208:211],v[112:115],v[24:27],0
ds_read_b64_tr_b16 v[132:133],v3 offset:128
ds_read_b64_tr_b16 v[134:135],v3 offset:6272
v_mfma_f32_16x16x32_bf16 a[0:3],v[112:115],v[30:33],0
ds_read_b64_tr_b16 v[136:137],v4 offset:128
ds_read_b64_tr_b16 v[138:139],v4 offset:6272
v_mfma_f32_16x16x32_bf16 a[48:51],v[112:115],v[36:39],0
ds_read_b64_tr_b16 v[140:141],v5 offset:128
ds_read_b64_tr_b16 v[142:143],v5 offset:6272
v_mfma_f32_16x16x32_bf16 v[164:167],v[116:119],v[18:21],0
ds_read_b64_tr_b16 v[112:113],v2 offset:256
ds_read_b64_tr_b16 v[114:115],v2 offset:6400
v_mfma_f32_16x16x32_bf16 v[212:215],v[116:119],v[24:27],0
v_fma_f32 v82,v82,s36,v14
v_fma_f32 v83,v83,s36,v14
v_mfma_f32_16x16x32_bf16 a[4:7],v[116:119],v[30:33],0
v_exp_f32 v82,v82
v_mfma_f32_16x16x32_bf16 a[52:55],v[116:119],v[36:39],0
s_waitcnt lgkmcnt(10)
ds_read_b64_tr_b16 v[116:117],v3 offset:256
ds_read_b64_tr_b16 v[118:119],v3 offset:6400
v_mfma_f32_16x16x32_bf16 v[168:171],v[120:123],v[18:21],0
v_exp_f32 v83,v83
v_mfma_f32_16x16x32_bf16 v[216:219],v[120:123],v[24:27],0
v_cvt_pk_bf16_f32 v29,v82,v83
v_fma_f32 v88,v88,s36,v15
v_mfma_f32_16x16x32_bf16 a[8:11],v[120:123],v[30:33],0
v_fma_f32 v89,v89,s36,v15
v_fma_f32 v90,v90,s36,v15
v_mfma_f32_16x16x32_bf16 a[56:59],v[120:123],v[36:39],0
ds_read_b64_tr_b16 v[120:121],v4 offset:256
ds_read_b64_tr_b16 v[122:123],v4 offset:6400
v_mfma_f32_16x16x32_bf16 v[172:175],v[124:127],v[18:21],0
v_fma_f32 v91,v91,s36,v15
v_fma_f32 v96,v96,s36,v16
v_mfma_f32_16x16x32_bf16 v[220:223],v[124:127],v[24:27],0
v_exp_f32 v88,v88
v_mfma_f32_16x16x32_bf16 a[12:15],v[124:127],v[30:33],0
v_exp_f32 v89,v89
v_mfma_f32_16x16x32_bf16 a[60:63],v[124:127],v[36:39],0
s_waitcnt lgkmcnt(3)
ds_read_b64_tr_b16 v[124:125],v5 offset:256
ds_read_b64_tr_b16 v[126:127],v5 offset:6400
v_mfma_f32_16x16x32_bf16 v[176:179],v[128:131],v[18:21],0
v_exp_f32 v90,v90
v_mfma_f32_16x16x32_bf16 v[224:227],v[128:131],v[24:27],0
v_exp_f32 v91,v91
v_mfma_f32_16x16x32_bf16 a[16:19],v[128:131],v[30:33],0
v_cvt_pk_bf16_f32 v34,v88,v89
v_cvt_pk_bf16_f32 v35,v90,v91
v_mfma_f32_16x16x32_bf16 a[64:67],v[128:131],v[36:39],0
v_fma_f32 v97,v97,s36,v16
v_fma_f32 v98,v98,s36,v16
v_mfma_f32_16x16x32_bf16 v[180:183],v[132:135],v[18:21],0
v_fma_f32 v99,v99,s36,v16
v_fma_f32 v76,v76,s36,v13
v_mfma_f32_16x16x32_bf16 v[228:231],v[132:135],v[24:27],0
v_exp_f32 v96,v96
v_mfma_f32_16x16x32_bf16 a[20:23],v[132:135],v[30:33],0
v_exp_f32 v97,v97
v_mfma_f32_16x16x32_bf16 a[68:71],v[132:135],v[36:39],0
v_exp_f32 v98,v98
v_mfma_f32_16x16x32_bf16 v[184:187],v[136:139],v[18:21],0
v_exp_f32 v99,v99
v_mfma_f32_16x16x32_bf16 v[232:235],v[136:139],v[24:27],0
v_cvt_pk_bf16_f32 v40,v96,v97
v_cvt_pk_bf16_f32 v41,v98,v99
v_mfma_f32_16x16x32_bf16 a[24:27],v[136:139],v[30:33],0
v_fma_f32 v77,v77,s36,v13
v_fma_f32 v78,v78,s36,v13
v_mfma_f32_16x16x32_bf16 a[72:75],v[136:139],v[36:39],0
v_fma_f32 v79,v79,s36,v13
v_fma_f32 v84,v84,s36,v14
v_mfma_f32_16x16x32_bf16 v[188:191],v[140:143],v[18:21],0
v_exp_f32 v76,v76
v_mfma_f32_16x16x32_bf16 v[236:239],v[140:143],v[24:27],0
v_exp_f32 v77,v77
v_mfma_f32_16x16x32_bf16 a[28:31],v[140:143],v[30:33],0
v_exp_f32 v78,v78
v_mfma_f32_16x16x32_bf16 a[76:79],v[140:143],v[36:39],0
v_exp_f32 v79,v79
v_mfma_f32_16x16x32_bf16 v[192:195],v[112:115],v[18:21],0
v_fma_f32 v85,v85,s36,v14
v_fma_f32 v86,v86,s36,v14
s_waitcnt vmcnt(30) lgkmcnt(0)
v_mfma_f32_16x16x32_bf16 v[240:243],v[112:115],v[24:27],0
s_barrier
v_mfma_f32_16x16x32_bf16 a[32:35],v[112:115],v[30:33],0
ds_read_b128 v[128:131],v0 offset:24576
v_fma_f32 v87,v87,s36,v14
v_mfma_f32_16x16x32_bf16 a[80:83],v[112:115],v[36:39],0
ds_read_b128 v[132:135],v1 offset:24576
v_fma_f32 v92,v92,s36,v15
v_mfma_f32_16x16x32_bf16 v[196:199],v[116:119],v[18:21],0
ds_read_b128 v[136:139],v0 offset:24704
v_fma_f32 v93,v93,s36,v15
v_mfma_f32_16x16x32_bf16 v[244:247],v[116:119],v[24:27],0
ds_read_b128 v[140:143],v1 offset:24704
v_fma_f32 v94,v94,s36,v15
v_mfma_f32_16x16x32_bf16 a[36:39],v[116:119],v[30:33],0
ds_read_b128 v[112:115],v0 offset:24832
v_fma_f32 v95,v95,s36,v15
v_mfma_f32_16x16x32_bf16 a[84:87],v[116:119],v[36:39],0
buffer_load_dwordx4 v6,s[8:11],s21 offen offset:0 lds
v_mfma_f32_16x16x32_bf16 v[200:203],v[120:123],v[18:21],0
ds_read_b128 v[116:119],v1 offset:24832
v_fma_f32 v100,v100,s36,v16
v_mfma_f32_16x16x32_bf16 v[248:251],v[120:123],v[24:27],0
v_exp_f32 v84,v84
v_mfma_f32_16x16x32_bf16 a[40:43],v[120:123],v[30:33],0
v_exp_f32 v85,v85
v_mfma_f32_16x16x32_bf16 a[88:91],v[120:123],v[36:39],0
ds_read_b128 v[120:123],v0 offset:30720
v_fma_f32 v101,v101,s36,v16
v_mfma_f32_16x16x32_bf16 v[204:207],v[124:127],v[18:21],0
v_cvt_pk_bf16_f32 v20,v76,v77
v_cvt_pk_bf16_f32 v21,v78,v79
v_mfma_f32_16x16x32_bf16 v[252:255],v[124:127],v[24:27],0
v_exp_f32 v86,v86
v_mfma_f32_16x16x32_bf16 v[52:55],v[48:51],v[20:23],v[52:55]
v_exp_f32 v87,v87
v_mfma_f32_16x16x32_bf16 a[44:47],v[124:127],v[30:33],0
v_cvt_pk_bf16_f32 v26,v84,v85
v_cvt_pk_bf16_f32 v27,v86,v87
v_mfma_f32_16x16x32_bf16 a[92:95],v[124:127],v[36:39],0
buffer_load_dwordx4 v7,s[8:11],s21 offen offset:1024 lds
v_mfma_f32_16x16x32_bf16 v[56:59],v[48:51],v[26:29],v[56:59]
s_waitcnt lgkmcnt(1)
ds_read_b128 v[124:127],v1 offset:30720
v_fma_f32 v102,v102,s36,v16
v_mfma_f32_16x16x32_bf16 v[72:75],v[128:131],a[144:147],0
v_exp_f32 v92,v92
v_mfma_f32_16x16x32_bf16 v[80:83],v[128:131],a[168:171],0
v_exp_f32 v93,v93
v_mfma_f32_16x16x32_bf16 v[88:91],v[128:131],a[192:195],0
v_exp_f32 v94,v94
v_mfma_f32_16x16x32_bf16 v[96:99],v[128:131],a[216:219],0
ds_read_b128 v[128:131],v0 offset:30848
v_fma_f32 v103,v103,s36,v16
v_mfma_f32_16x16x32_bf16 v[72:75],v[132:135],a[148:151],v[72:75]
v_exp_f32 v95,v95
v_mfma_f32_16x16x32_bf16 v[80:83],v[132:135],a[172:175],v[80:83]
v_cvt_pk_bf16_f32 v32,v92,v93
v_cvt_pk_bf16_f32 v33,v94,v95
v_mfma_f32_16x16x32_bf16 v[88:91],v[132:135],a[196:199],v[88:91]
v_exp_f32 v100,v100
v_mfma_f32_16x16x32_bf16 v[60:63],v[48:51],v[32:35],v[60:63]
buffer_load_dwordx4 v8,s[8:11],s21 offen offset:2048 lds
v_mfma_f32_16x16x32_bf16 v[96:99],v[132:135],a[220:223],v[96:99]
s_add_u32 s21,s21,12288
v_exp_f32 v101,v101
v_mfma_f32_16x16x32_bf16 v[72:75],v[136:139],a[152:155],v[72:75]
s_add_u32 m0,s22,12288
v_exp_f32 v102,v102
v_mfma_f32_16x16x32_bf16 v[80:83],v[136:139],a[176:179],v[80:83]
v_exp_f32 v103,v103
v_mfma_f32_16x16x32_bf16 v[88:91],v[136:139],a[200:203],v[88:91]
v_cvt_pk_bf16_f32 v38,v100,v101
v_cvt_pk_bf16_f32 v39,v102,v103
v_mfma_f32_16x16x32_bf16 v[96:99],v[136:139],a[224:227],v[96:99]
ds_read_b128 v[132:135],v1 offset:30848
v_mfma_f32_16x16x32_bf16 v[64:67],v[48:51],v[38:41],v[64:67]
ds_read_b128 v[136:139],v0 offset:30976
v_mfma_f32_16x16x32_bf16 v[72:75],v[140:143],a[156:159],v[72:75]
v_mfma_f32_16x16x32_bf16 v[80:83],v[140:143],a[180:183],v[80:83]
v_mfma_f32_16x16x32_bf16 v[88:91],v[140:143],a[204:207],v[88:91]
buffer_load_dwordx4 v6,s[4:7],s20 offen offset:0 lds
v_mfma_f32_16x16x32_bf16 v[96:99],v[140:143],a[228:231],v[96:99]
ds_read_b128 v[140:143],v1 offset:30976
v_mfma_f32_16x16x32_bf16 v[72:75],v[112:115],a[160:163],v[72:75]
v_mfma_f32_16x16x32_bf16 v[80:83],v[112:115],a[184:187],v[80:83]
v_mfma_f32_16x16x32_bf16 v[88:91],v[112:115],a[208:211],v[88:91]
v_mfma_f32_16x16x32_bf16 v[96:99],v[112:115],a[232:235],v[96:99]
v_mfma_f32_16x16x32_bf16 v[72:75],v[116:119],a[164:167],v[72:75]
v_mfma_f32_16x16x32_bf16 v[80:83],v[116:119],a[188:191],v[80:83]
v_mfma_f32_16x16x32_bf16 v[88:91],v[116:119],a[212:215],v[88:91]
v_mfma_f32_16x16x32_bf16 v[96:99],v[116:119],a[236:239],v[96:99]
buffer_load_dwordx4 v7,s[4:7],s20 offen offset:1024 lds
s_waitcnt lgkmcnt(0)
v_mfma_f32_16x16x32_bf16 v[76:79],v[120:123],a[144:147],0
v_mfma_f32_16x16x32_bf16 v[84:87],v[120:123],a[168:171],0
v_mfma_f32_16x16x32_bf16 v[92:95],v[120:123],a[192:195],0
v_mfma_f32_16x16x32_bf16 v[100:103],v[120:123],a[216:219],0
v_fma_f32 v72,v72,s36,v13
v_fma_f32 v73,v73,s36,v13
v_mfma_f32_16x16x32_bf16 v[76:79],v[124:127],a[148:151],v[76:79]
v_fma_f32 v74,v74,s36,v13
v_fma_f32 v75,v75,s36,v13
v_mfma_f32_16x16x32_bf16 v[84:87],v[124:127],a[172:175],v[84:87]
v_fma_f32 v80,v80,s36,v14
v_fma_f32 v81,v81,s36,v14
v_mfma_f32_16x16x32_bf16 v[92:95],v[124:127],a[196:199],v[92:95]
v_exp_f32 v72,v72
v_mfma_f32_16x16x32_bf16 v[100:103],v[124:127],a[220:223],v[100:103]
v_exp_f32 v73,v73
v_mfma_f32_16x16x32_bf16 v[76:79],v[128:131],a[152:155],v[76:79]
buffer_load_dwordx4 v8,s[4:7],s20 offen offset:2048 lds
v_mfma_f32_16x16x32_bf16 v[84:87],v[128:131],a[176:179],v[84:87]
s_add_u32 s20,s20,12288
ds_read_b64_tr_b16 v[112:113],v2 offset:18432
v_mfma_f32_16x16x32_bf16 v[92:95],v[128:131],a[200:203],v[92:95]
ds_read_b64_tr_b16 v[114:115],v2 offset:12288
v_cvt_pk_bf16_f32 v18,v72,v73
v_mfma_f32_16x16x32_bf16 v[100:103],v[128:131],a[224:227],v[100:103]
ds_read_b64_tr_b16 v[116:117],v3 offset:18432
v_mfma_f32_16x16x32_bf16 v[76:79],v[132:135],a[156:159],v[76:79]
ds_read_b64_tr_b16 v[118:119],v3 offset:12288
v_mfma_f32_16x16x32_bf16 v[84:87],v[132:135],a[180:183],v[84:87]
ds_read_b64_tr_b16 v[120:121],v4 offset:18432
v_mfma_f32_16x16x32_bf16 v[92:95],v[132:135],a[204:207],v[92:95]
ds_read_b64_tr_b16 v[122:123],v4 offset:12288
v_mfma_f32_16x16x32_bf16 v[100:103],v[132:135],a[228:231],v[100:103]
ds_read_b64_tr_b16 v[124:125],v5 offset:18432
v_mfma_f32_16x16x32_bf16 v[76:79],v[136:139],a[160:163],v[76:79]
ds_read_b64_tr_b16 v[126:127],v5 offset:12288
v_mfma_f32_16x16x32_bf16 v[84:87],v[136:139],a[184:187],v[84:87]
v_exp_f32 v74,v74
v_mfma_f32_16x16x32_bf16 v[92:95],v[136:139],a[208:211],v[92:95]
v_exp_f32 v75,v75
v_mfma_f32_16x16x32_bf16 v[100:103],v[136:139],a[232:235],v[100:103]
v_exp_f32 v80,v80
v_mfma_f32_16x16x32_bf16 v[76:79],v[140:143],a[164:167],v[76:79]
v_exp_f32 v81,v81
v_mfma_f32_16x16x32_bf16 v[84:87],v[140:143],a[188:191],v[84:87]
v_cvt_pk_bf16_f32 v19,v74,v75
v_cvt_pk_bf16_f32 v24,v80,v81
v_mfma_f32_16x16x32_bf16 v[92:95],v[140:143],a[212:215],v[92:95]
v_mfma_f32_16x16x32_bf16 v[100:103],v[140:143],a[236:239],v[100:103]
s_waitcnt lgkmcnt(2)
v_mfma_f32_16x16x32_bf16 v[160:163],v[112:115],v[20:23],v[160:163]
s_add_u32 m0,s23,12288
ds_read_b64_tr_b16 v[128:129],v2 offset:18560
ds_read_b64_tr_b16 v[130:131],v2 offset:12416
v_mfma_f32_16x16x32_bf16 v[208:211],v[112:115],v[26:29],v[208:211]
ds_read_b64_tr_b16 v[132:133],v3 offset:18560
ds_read_b64_tr_b16 v[134:135],v3 offset:12416
v_mfma_f32_16x16x32_bf16 a[0:3],v[112:115],v[32:35],a[0:3]
ds_read_b64_tr_b16 v[136:137],v4 offset:18560
ds_read_b64_tr_b16 v[138:139],v4 offset:12416
v_mfma_f32_16x16x32_bf16 a[48:51],v[112:115],v[38:41],a[48:51]
ds_read_b64_tr_b16 v[140:141],v5 offset:18560
ds_read_b64_tr_b16 v[142:143],v5 offset:12416
v_mfma_f32_16x16x32_bf16 v[164:167],v[116:119],v[20:23],v[164:167]
ds_read_b64_tr_b16 v[112:113],v2 offset:18688
ds_read_b64_tr_b16 v[114:115],v2 offset:12544
v_mfma_f32_16x16x32_bf16 v[212:215],v[116:119],v[26:29],v[212:215]
v_fma_f32 v82,v82,s36,v14
v_fma_f32 v83,v83,s36,v14
v_mfma_f32_16x16x32_bf16 a[4:7],v[116:119],v[32:35],a[4:7]
v_exp_f32 v82,v82
v_mfma_f32_16x16x32_bf16 a[52:55],v[116:119],v[38:41],a[52:55]
ds_read_b64_tr_b16 v[116:117],v3 offset:18688
ds_read_b64_tr_b16 v[118:119],v3 offset:12544
v_mfma_f32_16x16x32_bf16 v[168:171],v[120:123],v[20:23],v[168:171]
v_exp_f32 v83,v83
v_mfma_f32_16x16x32_bf16 v[216:219],v[120:123],v[26:29],v[216:219]
v_cvt_pk_bf16_f32 v25,v82,v83
v_fma_f32 v88,v88,s36,v15
v_mfma_f32_16x16x32_bf16 a[8:11],v[120:123],v[32:35],a[8:11]
v_fma_f32 v89,v89,s36,v15
v_fma_f32 v90,v90,s36,v15
v_mfma_f32_16x16x32_bf16 a[56:59],v[120:123],v[38:41],a[56:59]
s_waitcnt lgkmcnt(6)
ds_read_b64_tr_b16 v[120:121],v4 offset:18688
ds_read_b64_tr_b16 v[122:123],v4 offset:12544
v_mfma_f32_16x16x32_bf16 v[172:175],v[124:127],v[20:23],v[172:175]
v_fma_f32 v91,v91,s36,v15
v_fma_f32 v96,v96,s36,v16
v_mfma_f32_16x16x32_bf16 v[220:223],v[124:127],v[26:29],v[220:223]
v_exp_f32 v88,v88
v_mfma_f32_16x16x32_bf16 a[12:15],v[124:127],v[32:35],a[12:15]
v_exp_f32 v89,v89
v_mfma_f32_16x16x32_bf16 a[60:63],v[124:127],v[38:41],a[60:63]
ds_read_b64_tr_b16 v[124:125],v5 offset:18688
ds_read_b64_tr_b16 v[126:127],v5 offset:12544
v_mfma_f32_16x16x32_bf16 v[176:179],v[128:131],v[20:23],v[176:179]
v_exp_f32 v90,v90
v_mfma_f32_16x16x32_bf16 v[224:227],v[128:131],v[26:29],v[224:227]
v_exp_f32 v91,v91
v_mfma_f32_16x16x32_bf16 a[16:19],v[128:131],v[32:35],a[16:19]
v_cvt_pk_bf16_f32 v30,v88,v89
v_cvt_pk_bf16_f32 v31,v90,v91
v_mfma_f32_16x16x32_bf16 a[64:67],v[128:131],v[38:41],a[64:67]
v_fma_f32 v97,v97,s36,v16
v_fma_f32 v98,v98,s36,v16
v_mfma_f32_16x16x32_bf16 v[180:183],v[132:135],v[20:23],v[180:183]
v_fma_f32 v99,v99,s36,v16
v_fma_f32 v76,v76,s36,v13
v_mfma_f32_16x16x32_bf16 v[228:231],v[132:135],v[26:29],v[228:231]
v_exp_f32 v96,v96
v_mfma_f32_16x16x32_bf16 a[20:23],v[132:135],v[32:35],a[20:23]
v_exp_f32 v97,v97
v_mfma_f32_16x16x32_bf16 a[68:71],v[132:135],v[38:41],a[68:71]
v_exp_f32 v98,v98
v_mfma_f32_16x16x32_bf16 v[184:187],v[136:139],v[20:23],v[184:187]
v_exp_f32 v99,v99
v_mfma_f32_16x16x32_bf16 v[232:235],v[136:139],v[26:29],v[232:235]
v_cvt_pk_bf16_f32 v36,v96,v97
v_cvt_pk_bf16_f32 v37,v98,v99
v_mfma_f32_16x16x32_bf16 a[24:27],v[136:139],v[32:35],a[24:27]
v_fma_f32 v77,v77,s36,v13
v_fma_f32 v78,v78,s36,v13
v_mfma_f32_16x16x32_bf16 a[72:75],v[136:139],v[38:41],a[72:75]
s_waitcnt lgkmcnt(0)
v_fma_f32 v79,v79,s36,v13
v_fma_f32 v84,v84,s36,v14
v_mfma_f32_16x16x32_bf16 v[188:191],v[140:143],v[20:23],v[188:191]
v_exp_f32 v76,v76
v_mfma_f32_16x16x32_bf16 v[236:239],v[140:143],v[26:29],v[236:239]
v_exp_f32 v77,v77
v_mfma_f32_16x16x32_bf16 a[28:31],v[140:143],v[32:35],a[28:31]
v_exp_f32 v78,v78
v_mfma_f32_16x16x32_bf16 a[76:79],v[140:143],v[38:41],a[76:79]
v_exp_f32 v79,v79
v_mfma_f32_16x16x32_bf16 v[192:195],v[112:115],v[20:23],v[192:195]
v_fma_f32 v85,v85,s36,v14
v_fma_f32 v86,v86,s36,v14
s_waitcnt vmcnt(6)
v_mfma_f32_16x16x32_bf16 v[240:243],v[112:115],v[26:29],v[240:243]
s_barrier
v_mfma_f32_16x16x32_bf16 a[32:35],v[112:115],v[32:35],a[32:35]
ds_read_b128 v[128:131],v0 offset:0
v_fma_f32 v87,v87,s36,v14
v_mfma_f32_16x16x32_bf16 a[80:83],v[112:115],v[38:41],a[80:83]
ds_read_b128 v[132:135],v1 offset:0
v_fma_f32 v92,v92,s36,v15
v_mfma_f32_16x16x32_bf16 v[196:199],v[116:119],v[20:23],v[196:199]
ds_read_b128 v[136:139],v0 offset:128
v_fma_f32 v93,v93,s36,v15
v_mfma_f32_16x16x32_bf16 v[244:247],v[116:119],v[26:29],v[244:247]
ds_read_b128 v[140:143],v1 offset:128
v_fma_f32 v94,v94,s36,v15
v_mfma_f32_16x16x32_bf16 a[36:39],v[116:119],v[32:35],a[36:39]
ds_read_b128 v[112:115],v0 offset:256
v_fma_f32 v95,v95,s36,v15
v_mfma_f32_16x16x32_bf16 a[84:87],v[116:119],v[38:41],a[84:87]
buffer_load_dwordx4 v6,s[8:11],s21 offen offset:0 lds
v_mfma_f32_16x16x32_bf16 v[200:203],v[120:123],v[20:23],v[200:203]
ds_read_b128 v[116:119],v1 offset:256
v_fma_f32 v100,v100,s36,v16
v_mfma_f32_16x16x32_bf16 v[248:251],v[120:123],v[26:29],v[248:251]
v_exp_f32 v84,v84
v_mfma_f32_16x16x32_bf16 a[40:43],v[120:123],v[32:35],a[40:43]
v_exp_f32 v85,v85
v_mfma_f32_16x16x32_bf16 a[88:91],v[120:123],v[38:41],a[88:91]
ds_read_b128 v[120:123],v0 offset:6144
v_fma_f32 v101,v101,s36,v16
v_mfma_f32_16x16x32_bf16 v[204:207],v[124:127],v[20:23],v[204:207]
v_cvt_pk_bf16_f32 v20,v76,v77
v_cvt_pk_bf16_f32 v21,v78,v79
v_mfma_f32_16x16x32_bf16 v[252:255],v[124:127],v[26:29],v[252:255]
v_exp_f32 v86,v86
v_mfma_f32_16x16x32_bf16 v[52:55],v[48:51],v[18:21],v[52:55]
v_exp_f32 v87,v87
v_mfma_f32_16x16x32_bf16 a[44:47],v[124:127],v[32:35],a[44:47]
v_cvt_pk_bf16_f32 v26,v84,v85
v_cvt_pk_bf16_f32 v27,v86,v87
v_mfma_f32_16x16x32_bf16 a[92:95],v[124:127],v[38:41],a[92:95]
buffer_load_dwordx4 v7,s[8:11],s21 offen offset:1024 lds
v_mfma_f32_16x16x32_bf16 v[56:59],v[48:51],v[24:27],v[56:59]
s_waitcnt lgkmcnt(1)
ds_read_b128 v[124:127],v1 offset:6144
v_fma_f32 v102,v102,s36,v16
v_mfma_f32_16x16x32_bf16 v[72:75],v[128:131],a[144:147],0
v_exp_f32 v92,v92
v_mfma_f32_16x16x32_bf16 v[80:83],v[128:131],a[168:171],0
v_exp_f32 v93,v93
v_mfma_f32_16x16x32_bf16 v[88:91],v[128:131],a[192:195],0
v_exp_f32 v94,v94
v_mfma_f32_16x16x32_bf16 v[96:99],v[128:131],a[216:219],0
ds_read_b128 v[128:131],v0 offset:6272
v_fma_f32 v103,v103,s36,v16
v_mfma_f32_16x16x32_bf16 v[72:75],v[132:135],a[148:151],v[72:75]
v_exp_f32 v95,v95
v_mfma_f32_16x16x32_bf16 v[80:83],v[132:135],a[172:175],v[80:83]
v_cvt_pk_bf16_f32 v32,v92,v93
v_cvt_pk_bf16_f32 v33,v94,v95
v_mfma_f32_16x16x32_bf16 v[88:91],v[132:135],a[196:199],v[88:91]
v_exp_f32 v100,v100
v_mfma_f32_16x16x32_bf16 v[60:63],v[48:51],v[30:33],v[60:63]
buffer_load_dwordx4 v8,s[8:11],s21 offen offset:2048 lds
v_mfma_f32_16x16x32_bf16 v[96:99],v[132:135],a[220:223],v[96:99]
s_add_u32 s21,s21,12288
v_exp_f32 v101,v101
v_mfma_f32_16x16x32_bf16 v[72:75],v[136:139],a[152:155],v[72:75]
s_add_u32 m0,s22,24576
v_exp_f32 v102,v102
v_mfma_f32_16x16x32_bf16 v[80:83],v[136:139],a[176:179],v[80:83]
v_exp_f32 v103,v103
v_mfma_f32_16x16x32_bf16 v[88:91],v[136:139],a[200:203],v[88:91]
v_cvt_pk_bf16_f32 v38,v100,v101
v_cvt_pk_bf16_f32 v39,v102,v103
v_mfma_f32_16x16x32_bf16 v[96:99],v[136:139],a[224:227],v[96:99]
ds_read_b128 v[132:135],v1 offset:6272
v_mfma_f32_16x16x32_bf16 v[64:67],v[48:51],v[36:39],v[64:67]
ds_read_b128 v[136:139],v0 offset:6400
v_mfma_f32_16x16x32_bf16 v[72:75],v[140:143],a[156:159],v[72:75]
v_mfma_f32_16x16x32_bf16 v[80:83],v[140:143],a[180:183],v[80:83]
v_mfma_f32_16x16x32_bf16 v[88:91],v[140:143],a[204:207],v[88:91]
buffer_load_dwordx4 v6,s[4:7],s20 offen offset:0 lds
v_mfma_f32_16x16x32_bf16 v[96:99],v[140:143],a[228:231],v[96:99]
ds_read_b128 v[140:143],v1 offset:6400
v_mfma_f32_16x16x32_bf16 v[72:75],v[112:115],a[160:163],v[72:75]
v_mfma_f32_16x16x32_bf16 v[80:83],v[112:115],a[184:187],v[80:83]
v_mfma_f32_16x16x32_bf16 v[88:91],v[112:115],a[208:211],v[88:91]
v_mfma_f32_16x16x32_bf16 v[96:99],v[112:115],a[232:235],v[96:99]
v_mfma_f32_16x16x32_bf16 v[72:75],v[116:119],a[164:167],v[72:75]
v_mfma_f32_16x16x32_bf16 v[80:83],v[116:119],a[188:191],v[80:83]
v_mfma_f32_16x16x32_bf16 v[88:91],v[116:119],a[212:215],v[88:91]
v_mfma_f32_16x16x32_bf16 v[96:99],v[116:119],a[236:239],v[96:99]
buffer_load_dwordx4 v7,s[4:7],s20 offen offset:1024 lds
s_waitcnt lgkmcnt(0)
v_mfma_f32_16x16x32_bf16 v[76:79],v[120:123],a[144:147],0
v_mfma_f32_16x16x32_bf16 v[84:87],v[120:123],a[168:171],0
v_mfma_f32_16x16x32_bf16 v[92:95],v[120:123],a[192:195],0
v_mfma_f32_16x16x32_bf16 v[100:103],v[120:123],a[216:219],0
v_fma_f32 v72,v72,s36,v13
v_fma_f32 v73,v73,s36,v13
v_mfma_f32_16x16x32_bf16 v[76:79],v[124:127],a[148:151],v[76:79]
v_fma_f32 v74,v74,s36,v13
v_fma_f32 v75,v75,s36,v13
v_mfma_f32_16x16x32_bf16 v[84:87],v[124:127],a[172:175],v[84:87]
v_fma_f32 v80,v80,s36,v14
v_fma_f32 v81,v81,s36,v14
v_mfma_f32_16x16x32_bf16 v[92:95],v[124:127],a[196:199],v[92:95]
v_exp_f32 v72,v72
v_mfma_f32_16x16x32_bf16 v[100:103],v[124:127],a[220:223],v[100:103]
v_exp_f32 v73,v73
v_mfma_f32_16x16x32_bf16 v[76:79],v[128:131],a[152:155],v[76:79]
buffer_load_dwordx4 v8,s[4:7],s20 offen offset:2048 lds
v_mfma_f32_16x16x32_bf16 v[84:87],v[128:131],a[176:179],v[84:87]
s_add_u32 s20,s20,12288
ds_read_b64_tr_b16 v[112:113],v2 offset:24576
v_mfma_f32_16x16x32_bf16 v[92:95],v[128:131],a[200:203],v[92:95]
ds_read_b64_tr_b16 v[114:115],v2 offset:30720
v_cvt_pk_bf16_f32 v22,v72,v73
v_mfma_f32_16x16x32_bf16 v[100:103],v[128:131],a[224:227],v[100:103]
ds_read_b64_tr_b16 v[116:117],v3 offset:24576
v_mfma_f32_16x16x32_bf16 v[76:79],v[132:135],a[156:159],v[76:79]
ds_read_b64_tr_b16 v[118:119],v3 offset:30720
v_mfma_f32_16x16x32_bf16 v[84:87],v[132:135],a[180:183],v[84:87]
ds_read_b64_tr_b16 v[120:121],v4 offset:24576
v_mfma_f32_16x16x32_bf16 v[92:95],v[132:135],a[204:207],v[92:95]
ds_read_b64_tr_b16 v[122:123],v4 offset:30720
v_mfma_f32_16x16x32_bf16 v[100:103],v[132:135],a[228:231],v[100:103]
ds_read_b64_tr_b16 v[124:125],v5 offset:24576
v_mfma_f32_16x16x32_bf16 v[76:79],v[136:139],a[160:163],v[76:79]
ds_read_b64_tr_b16 v[126:127],v5 offset:30720
v_mfma_f32_16x16x32_bf16 v[84:87],v[136:139],a[184:187],v[84:87]
v_exp_f32 v74,v74
v_mfma_f32_16x16x32_bf16 v[92:95],v[136:139],a[208:211],v[92:95]
v_exp_f32 v75,v75
v_mfma_f32_16x16x32_bf16 v[100:103],v[136:139],a[232:235],v[100:103]
v_exp_f32 v80,v80
v_mfma_f32_16x16x32_bf16 v[76:79],v[140:143],a[164:167],v[76:79]
v_exp_f32 v81,v81
v_mfma_f32_16x16x32_bf16 v[84:87],v[140:143],a[188:191],v[84:87]
v_cvt_pk_bf16_f32 v23,v74,v75
v_cvt_pk_bf16_f32 v28,v80,v81
v_mfma_f32_16x16x32_bf16 v[92:95],v[140:143],a[212:215],v[92:95]
v_mfma_f32_16x16x32_bf16 v[100:103],v[140:143],a[236:239],v[100:103]
s_mov_b32 s38,0
s_branch L_loop4
L_tr55:
s_waitcnt vmcnt(42)
s_waitcnt lgkmcnt(4)
v_mfma_f32_16x16x32_bf16 v[160:163],v[112:115],v[18:21],v[160:163]
s_add_u32 m0,s24,0
ds_read_b128 a[144:147],v11 offset:0
v_fma_f32 v90,v90,s36,v15
v_mfma_f32_16x16x32_bf16 v[208:211],v[112:115],v[24:27],v[208:211]
ds_read_b128 a[148:151],v12 offset:0
v_fma_f32 v91,v91,s36,v15
v_mfma_f32_16x16x32_bf16 a[0:3],v[112:115],v[30:33],a[0:3]
ds_read_b128 a[152:155],v11 offset:128
v_fma_f32 v96,v96,s36,v16
v_mfma_f32_16x16x32_bf16 a[48:51],v[112:115],v[36:39],a[48:51]
ds_read_b128 a[156:159],v12 offset:128
v_fma_f32 v97,v97,s36,v16
v_mfma_f32_16x16x32_bf16 a[96:99],v[112:115],v[42:45],a[96:99]
ds_read_b128 a[160:163],v11 offset:256
v_fma_f32 v98,v98,s36,v16
v_mfma_f32_16x16x32_bf16 v[164:167],v[116:119],v[18:21],v[164:167]
ds_read_b128 a[164:167],v12 offset:256
ds_read_b64_tr_b16 v[128:129],v2 offset:24704
ds_read_b64_tr_b16 v[130:131],v2 offset:30848
ds_read_b64_tr_b16 v[132:133],v3 offset:24704
ds_read_b64_tr_b16 v[134:135],v3 offset:30848
ds_read_b64_tr_b16 v[136:137],v4 offset:24704
ds_read_b64_tr_b16 v[138:139],v4 offset:30848
ds_read_b64_tr_b16 v[140:141],v5 offset:24704
ds_read_b64_tr_b16 v[142:143],v5 offset:30848
ds_read_b64_tr_b16 v[112:113],v2 offset:24832
ds_read_b64_tr_b16 v[114:115],v2 offset:30976
ds_read_b128 a[168:171],v11 offset:6144
v_mfma_f32_16x16x32_bf16 v[212:215],v[116:119],v[24:27],v[212:215]
v_fma_f32 v99,v99,s36,v16
ds_read_b128 a[172:175],v12 offset:6144
ds_read_b128 a[176:179],v11 offset:6272
v_mfma_f32_16x16x32_bf16 a[4:7],v[116:119],v[30:33],a[4:7]
v_fma_f32 v104,v104,s36,v17
ds_read_b128 a[180:183],v12 offset:6272
ds_read_b128 a[184:187],v11 offset:6400
v_mfma_f32_16x16x32_bf16 a[52:55],v[116:119],v[36:39],a[52:55]
s_waitcnt lgkmcnt(15)
buffer_load_dwordx4 v6,s[12:15],s28 offen offset:0 nt lds
v_mfma_f32_16x16x32_bf16 a[100:103],v[116:119],v[42:45],a[100:103]
ds_read_b64_tr_b16 v[116:117],v3 offset:24832
ds_read_b64_tr_b16 v[118:119],v3 offset:30976
v_mfma_f32_16x16x32_bf16 v[168:171],v[120:123],v[18:21],v[168:171]
ds_read_b128 a[188:191],v12 offset:6400
v_fma_f32 v105,v105,s36,v17
v_mfma_f32_16x16x32_bf16 v[216:219],v[120:123],v[24:27],v[216:219]
v_fma_f32 v106,v106,s36,v17
v_fma_f32 v107,v107,s36,v17
v_mfma_f32_16x16x32_bf16 a[8:11],v[120:123],v[30:33],a[8:11]
v_fma_f32 v76,v76,s36,v13
v_fma_f32 v77,v77,s36,v13
v_mfma_f32_16x16x32_bf16 a[56:59],v[120:123],v[36:39],a[56:59]
buffer_load_dwordx4 v7,s[12:15],s28 offen offset:1024 nt lds
v_mfma_f32_16x16x32_bf16 a[104:107],v[120:123],v[42:45],a[104:107]
ds_read_b64_tr_b16 v[120:121],v4 offset:24832
ds_read_b64_tr_b16 v[122:123],v4 offset:30976
v_mfma_f32_16x16x32_bf16 v[172:175],v[124:127],v[18:21],v[172:175]
v_fma_f32 v78,v78,s36,v13
v_fma_f32 v79,v79,s36,v13
v_mfma_f32_16x16x32_bf16 v[220:223],v[124:127],v[24:27],v[220:223]
v_fma_f32 v84,v84,s36,v14
v_fma_f32 v85,v85,s36,v14
v_mfma_f32_16x16x32_bf16 a[12:15],v[124:127],v[30:33],a[12:15]
v_fma_f32 v86,v86,s36,v14
v_fma_f32 v87,v87,s36,v14
v_mfma_f32_16x16x32_bf16 a[60:63],v[124:127],v[36:39],a[60:63]
v_fma_f32 v92,v92,s36,v15
v_fma_f32 v93,v93,s36,v15
v_mfma_f32_16x16x32_bf16 a[108:111],v[124:127],v[42:45],a[108:111]
s_waitcnt lgkmcnt(2)
ds_read_b64_tr_b16 v[124:125],v5 offset:24832
ds_read_b64_tr_b16 v[126:127],v5 offset:30976
v_mfma_f32_16x16x32_bf16 v[176:179],v[128:131],v[18:21],v[176:179]
v_fma_f32 v94,v94,s36,v15
v_fma_f32 v95,v95,s36,v15
v_mfma_f32_16x16x32_bf16 v[224:227],v[128:131],v[24:27],v[224:227]
buffer_load_dwordx4 v8,s[12:15],s28 offen offset:2048 nt lds
v_mfma_f32_16x16x32_bf16 a[16:19],v[128:131],v[30:33],a[16:19]
s_add_u32 s28,s28,3072
v_fma_f32 v100,v100,s36,v16
v_fma_f32 v101,v101,s36,v16
v_mfma_f32_16x16x32_bf16 a[64:67],v[128:131],v[36:39],a[64:67]
s_add_u32 m0,s24,3072
v_fma_f32 v102,v102,s36,v16
v_fma_f32 v103,v103,s36,v16
v_mfma_f32_16x16x32_bf16 a[112:115],v[128:131],v[42:45],a[112:115]
v_fma_f32 v108,v108,s36,v17
v_fma_f32 v109,v109,s36,v17
v_mfma_f32_16x16x32_bf16 v[180:183],v[132:135],v[18:21],v[180:183]
v_fma_f32 v110,v110,s36,v17
v_fma_f32 v111,v111,s36,v17
v_mfma_f32_16x16x32_bf16 v[228:231],v[132:135],v[24:27],v[228:231]
v_exp_f32 v90,v90
v_mfma_f32_16x16x32_bf16 a[20:23],v[132:135],v[30:33],a[20:23]
v_exp_f32 v91,v91
v_mfma_f32_16x16x32_bf16 a[68:71],v[132:135],v[36:39],a[68:71]
v_exp_f32 v96,v96
v_mfma_f32_16x16x32_bf16 a[116:119],v[132:135],v[42:45],a[116:119]
buffer_load_dwordx4 v6,s[12:15],s28 offen offset:0 nt lds
v_mfma_f32_16x16x32_bf16 v[184:187],v[136:139],v[18:21],v[184:187]
v_exp_f32 v97,v97
v_mfma_f32_16x16x32_bf16 v[232:235],v[136:139],v[24:27],v[232:235]
v_exp_f32 v98,v98
v_mfma_f32_16x16x32_bf16 a[24:27],v[136:139],v[30:33],a[24:27]
v_exp_f32 v99,v99
v_mfma_f32_16x16x32_bf16 a[72:75],v[136:139],v[36:39],a[72:75]
v_exp_f32 v104,v104
v_mfma_f32_16x16x32_bf16 a[120:123],v[136:139],v[42:45],a[120:123]
v_exp_f32 v105,v105
v_mfma_f32_16x16x32_bf16 v[188:191],v[140:143],v[18:21],v[188:191]
v_exp_f32 v106,v106
v_mfma_f32_16x16x32_bf16 v[236:239],v[140:143],v[24:27],v[236:239]
buffer_load_dwordx4 v7,s[12:15],s28 offen offset:1024 nt lds
v_mfma_f32_16x16x32_bf16 a[28:31],v[140:143],v[30:33],a[28:31]
v_exp_f32 v107,v107
v_mfma_f32_16x16x32_bf16 a[76:79],v[140:143],v[36:39],a[76:79]
v_exp_f32 v76,v76
v_mfma_f32_16x16x32_bf16 a[124:127],v[140:143],v[42:45],a[124:127]
v_exp_f32 v77,v77
v_mfma_f32_16x16x32_bf16 v[192:195],v[112:115],v[18:21],v[192:195]
v_exp_f32 v78,v78
v_mfma_f32_16x16x32_bf16 v[240:243],v[112:115],v[24:27],v[240:243]
v_exp_f32 v79,v79
v_mfma_f32_16x16x32_bf16 a[32:35],v[112:115],v[30:33],a[32:35]
v_exp_f32 v84,v84
v_mfma_f32_16x16x32_bf16 a[80:83],v[112:115],v[36:39],a[80:83]
v_exp_f32 v85,v85
v_mfma_f32_16x16x32_bf16 a[128:131],v[112:115],v[42:45],a[128:131]
buffer_load_dwordx4 v8,s[12:15],s28 offen offset:2048 nt lds
s_waitcnt vmcnt(20) lgkmcnt(0)
s_barrier
v_mfma_f32_16x16x32_bf16 v[196:199],v[116:119],v[18:21],v[196:199]
s_add_u32 s28,s28,3072
v_exp_f32 v86,v86
v_mfma_f32_16x16x32_bf16 v[244:247],v[116:119],v[24:27],v[244:247]
s_add_u32 m0,s22,0
v_exp_f32 v87,v87
v_mfma_f32_16x16x32_bf16 a[36:39],v[116:119],v[30:33],a[36:39]
buffer_load_dwordx4 v6,s[4:7],s25 offen offset:0 lds
v_mfma_f32_16x16x32_bf16 a[84:87],v[116:119],v[36:39],a[84:87]
buffer_load_dwordx4 v7,s[4:7],s25 offen offset:1024 lds
v_mfma_f32_16x16x32_bf16 a[132:135],v[116:119],v[42:45],a[132:135]
buffer_load_dwordx4 v8,s[4:7],s25 offen offset:2048 lds
v_mfma_f32_16x16x32_bf16 v[200:203],v[120:123],v[18:21],v[200:203]
v_exp_f32 v92,v92
v_mfma_f32_16x16x32_bf16 v[248:251],v[120:123],v[24:27],v[248:251]
v_exp_f32 v93,v93
v_mfma_f32_16x16x32_bf16 a[40:43],v[120:123],v[30:33],a[40:43]
v_exp_f32 v94,v94
v_mfma_f32_16x16x32_bf16 a[88:91],v[120:123],v[36:39],a[88:91]
v_exp_f32 v95,v95
v_mfma_f32_16x16x32_bf16 a[136:139],v[120:123],v[42:45],a[136:139]
ds_read_b64_tr_b16 v[128:129],v2 offset:6144
ds_read_b64_tr_b16 v[130:131],v2 offset:0
v_mfma_f32_16x16x32_bf16 v[204:207],v[124:127],v[18:21],v[204:207]
v_exp_f32 v100,v100
v_mfma_f32_16x16x32_bf16 v[252:255],v[124:127],v[24:27],v[252:255]
v_exp_f32 v101,v101
v_mfma_f32_16x16x32_bf16 a[44:47],v[124:127],v[30:33],a[44:47]
ds_read_b64_tr_b16 v[132:133],v3 offset:6144
ds_read_b64_tr_b16 v[134:135],v3 offset:0
v_mfma_f32_16x16x32_bf16 a[92:95],v[124:127],v[36:39],a[92:95]
v_exp_f32 v102,v102
v_mfma_f32_16x16x32_bf16 a[140:143],v[124:127],v[42:45],a[140:143]
ds_read_b64_tr_b16 v[136:137],v4 offset:6144
ds_read_b64_tr_b16 v[138:139],v4 offset:0
v_exp_f32 v103,v103
v_exp_f32 v108,v108
v_exp_f32 v109,v109
ds_read_b64_tr_b16 v[140:141],v5 offset:6144
ds_read_b64_tr_b16 v[142:143],v5 offset:0
v_exp_f32 v110,v110
v_exp_f32 v111,v111
v_cvt_pk_bf16_f32 v35,v90,v91
v_cvt_pk_bf16_f32 v40,v96,v97
v_cvt_pk_bf16_f32 v41,v98,v99
v_cvt_pk_bf16_f32 v46,v104,v105
v_cvt_pk_bf16_f32 v47,v106,v107
v_cvt_pk_bf16_f32 v20,v76,v77
v_cvt_pk_bf16_f32 v21,v78,v79
v_cvt_pk_bf16_f32 v26,v84,v85
v_cvt_pk_bf16_f32 v27,v86,v87
v_mfma_f32_16x16x32_bf16 v[52:55],v[48:51],v[20:23],v[52:55]
v_cvt_pk_bf16_f32 v32,v92,v93
v_cvt_pk_bf16_f32 v33,v94,v95
v_mfma_f32_16x16x32_bf16 v[56:59],v[48:51],v[26:29],v[56:59]
v_cvt_pk_bf16_f32 v38,v100,v101
v_cvt_pk_bf16_f32 v39,v102,v103
v_mfma_f32_16x16x32_bf16 v[60:63],v[48:51],v[32:35],v[60:63]
v_cvt_pk_bf16_f32 v44,v108,v109
v_cvt_pk_bf16_f32 v45,v110,v111
v_mfma_f32_16x16x32_bf16 v[64:67],v[48:51],v[38:41],v[64:67]
v_subrev_u32 v10,18432,v10
v_mfma_f32_16x16x32_bf16 v[68:71],v[48:51],v[44:47],v[68:71]
s_waitcnt lgkmcnt(1)
v_mfma_f32_16x16x32_bf16 v[160:163],v[128:131],v[20:23],v[160:163]
s_add_u32 s87,s42,18432
ds_read_b64_tr_b16 v[112:113],v2 offset:6272
ds_read_b64_tr_b16 v[114:115],v2 offset:128
v_mfma_f32_16x16x32_bf16 v[208:211],v[128:131],v[26:29],v[208:211]
s_add_u32 s66,s42,24576
ds_read_b64_tr_b16 v[116:117],v3 offset:6272
ds_read_b64_tr_b16 v[118:119],v3 offset:128
v_mfma_f32_16x16x32_bf16 a[0:3],v[128:131],v[32:35],a[0:3]
ds_read_b64_tr_b16 v[120:121],v4 offset:6272
ds_read_b64_tr_b16 v[122:123],v4 offset:128
v_mfma_f32_16x16x32_bf16 a[48:51],v[128:131],v[38:41],a[48:51]
ds_read_b64_tr_b16 v[124:125],v5 offset:6272
ds_read_b64_tr_b16 v[126:127],v5 offset:128
v_mfma_f32_16x16x32_bf16 a[96:99],v[128:131],v[44:47],a[96:99]
ds_read_b64_tr_b16 v[128:129],v2 offset:6400
ds_read_b64_tr_b16 v[130:131],v2 offset:256
v_mfma_f32_16x16x32_bf16 v[164:167],v[132:135],v[20:23],v[164:167]
v_mbcnt_lo_u32_b32 v57,-1,0
v_mbcnt_hi_u32_b32 v57,-1,v57
v_mfma_f32_16x16x32_bf16 v[212:215],v[132:135],v[26:29],v[212:215]
v_and_b32 v61,7,v57
v_lshrrev_b32 v53,5,v57
v_mfma_f32_16x16x32_bf16 a[4:7],v[132:135],v[32:35],a[4:7]
v_xor_b32 v61,v61,v53
v_and_b32 v53,15,v57
v_lshl_add_u32 v53,v53,7,s24
v_lshl_add_u32 v53,v61,4,v53
v_bfe_u32 v61,v57,4,1
v_lshl_add_u32 v36,v61,3,v53
v_xor_b32 v37,32,v36
v_xor_b32 v42,64,v36
v_xor_b32 v43,96,v36
v_bfe_u32 v53,v57,3,1
v_lshlrev_b32 v53,11,v53
v_rcp_f32 v66,v64
v_rcp_f32 v70,v68
v_accvgpr_read_b32 v72,a48
v_accvgpr_read_b32 v73,a49
v_pk_mul_f32 v[72:73],v[72:73],v[66:67] op_sel_hi:[1,0]
v_accvgpr_read_b32 v74,a50
v_accvgpr_read_b32 v75,a51
v_pk_mul_f32 v[74:75],v[74:75],v[66:67] op_sel_hi:[1,0]
v_accvgpr_read_b32 v76,a96
v_accvgpr_read_b32 v77,a97
v_pk_mul_f32 v[76:77],v[76:77],v[70:71] op_sel_hi:[1,0]
v_accvgpr_read_b32 v78,a98
v_accvgpr_read_b32 v79,a99
v_pk_mul_f32 v[78:79],v[78:79],v[70:71] op_sel_hi:[1,0]
v_cvt_pk_bf16_f32 v72,v72,v73
v_cvt_pk_bf16_f32 v76,v76,v77
v_mfma_f32_16x16x32_bf16 a[52:55],v[132:135],v[38:41],a[52:55]
v_cvt_pk_bf16_f32 v73,v74,v75
v_cvt_pk_bf16_f32 v77,v78,v79
v_mfma_f32_16x16x32_bf16 a[100:103],v[132:135],v[44:47],a[100:103]
ds_read_b64_tr_b16 v[132:133],v3 offset:6400
ds_read_b64_tr_b16 v[134:135],v3 offset:256
v_mfma_f32_16x16x32_bf16 v[168:171],v[136:139],v[20:23],v[168:171]
ds_write2st64_b64 v36,v[72:73],v[76:77] offset0:36 offset1:40
v_mfma_f32_16x16x32_bf16 v[216:219],v[136:139],v[26:29],v[216:219]
v_accvgpr_read_b32 v80,a52
v_accvgpr_read_b32 v81,a53
v_mfma_f32_16x16x32_bf16 a[8:11],v[136:139],v[32:35],a[8:11]
v_accvgpr_read_b32 v82,a54
v_accvgpr_read_b32 v83,a55
v_accvgpr_read_b32 v84,a100
v_accvgpr_read_b32 v85,a101
v_accvgpr_read_b32 v86,a102
v_pk_mul_f32 v[80:81],v[80:81],v[66:67] op_sel_hi:[1,0]
v_pk_mul_f32 v[82:83],v[82:83],v[66:67] op_sel_hi:[1,0]
v_pk_mul_f32 v[84:85],v[84:85],v[70:71] op_sel_hi:[1,0]
v_accvgpr_read_b32 v87,a103
v_pk_mul_f32 v[86:87],v[86:87],v[70:71] op_sel_hi:[1,0]
v_cvt_pk_bf16_f32 v80,v80,v81
v_cvt_pk_bf16_f32 v84,v84,v85
v_mfma_f32_16x16x32_bf16 a[56:59],v[136:139],v[38:41],a[56:59]
v_cvt_pk_bf16_f32 v81,v82,v83
v_cvt_pk_bf16_f32 v85,v86,v87
v_mfma_f32_16x16x32_bf16 a[104:107],v[136:139],v[44:47],a[104:107]
s_waitcnt lgkmcnt(2)
ds_read_b64_tr_b16 v[136:137],v4 offset:6400
ds_read_b64_tr_b16 v[138:139],v4 offset:256
v_mfma_f32_16x16x32_bf16 v[172:175],v[140:143],v[20:23],v[172:175]
ds_write2st64_b64 v37,v[80:81],v[84:85] offset0:36 offset1:40
v_mfma_f32_16x16x32_bf16 v[220:223],v[140:143],v[26:29],v[220:223]
v_accvgpr_read_b32 v88,a56
v_accvgpr_read_b32 v89,a57
v_mfma_f32_16x16x32_bf16 a[12:15],v[140:143],v[32:35],a[12:15]
v_accvgpr_read_b32 v90,a58
v_accvgpr_read_b32 v91,a59
v_accvgpr_read_b32 v92,a104
v_accvgpr_read_b32 v93,a105
v_accvgpr_read_b32 v94,a106
v_pk_mul_f32 v[88:89],v[88:89],v[66:67] op_sel_hi:[1,0]
v_pk_mul_f32 v[90:91],v[90:91],v[66:67] op_sel_hi:[1,0]
v_pk_mul_f32 v[92:93],v[92:93],v[70:71] op_sel_hi:[1,0]
v_accvgpr_read_b32 v95,a107
v_pk_mul_f32 v[94:95],v[94:95],v[70:71] op_sel_hi:[1,0]
v_cvt_pk_bf16_f32 v88,v88,v89
v_cvt_pk_bf16_f32 v92,v92,v93
v_mfma_f32_16x16x32_bf16 a[60:63],v[140:143],v[38:41],a[60:63]
v_cvt_pk_bf16_f32 v89,v90,v91
v_cvt_pk_bf16_f32 v93,v94,v95
v_mfma_f32_16x16x32_bf16 a[108:111],v[140:143],v[44:47],a[108:111]
ds_read_b64_tr_b16 v[140:141],v5 offset:6400
ds_read_b64_tr_b16 v[142:143],v5 offset:256
v_mfma_f32_16x16x32_bf16 v[176:179],v[112:115],v[20:23],v[176:179]
ds_write2st64_b64 v42,v[88:89],v[92:93] offset0:36 offset1:40
v_mfma_f32_16x16x32_bf16 v[224:227],v[112:115],v[26:29],v[224:227]
v_accvgpr_read_b32 v96,a60
v_accvgpr_read_b32 v97,a61
v_mfma_f32_16x16x32_bf16 a[16:19],v[112:115],v[32:35],a[16:19]
v_accvgpr_read_b32 v98,a62
v_accvgpr_read_b32 v99,a63
v_accvgpr_read_b32 v100,a108
v_accvgpr_read_b32 v101,a109
v_accvgpr_read_b32 v102,a110
v_pk_mul_f32 v[96:97],v[96:97],v[66:67] op_sel_hi:[1,0]
v_pk_mul_f32 v[98:99],v[98:99],v[66:67] op_sel_hi:[1,0]
v_pk_mul_f32 v[100:101],v[100:101],v[70:71] op_sel_hi:[1,0]
v_accvgpr_read_b32 v103,a111
v_pk_mul_f32 v[102:103],v[102:103],v[70:71] op_sel_hi:[1,0]
v_cvt_pk_bf16_f32 v96,v96,v97
v_cvt_pk_bf16_f32 v100,v100,v101
v_mfma_f32_16x16x32_bf16 a[64:67],v[112:115],v[38:41],a[64:67]
v_max3_f32 v152,v52,v56,v60
v_cvt_pk_bf16_f32 v97,v98,v99
v_mfma_f32_16x16x32_bf16 a[112:115],v[112:115],v[44:47],a[112:115]
v_cvt_pk_bf16_f32 v101,v102,v103
v_max3_f32 v152,v152,v64,v68
v_mfma_f32_16x16x32_bf16 v[180:183],v[116:119],v[20:23],v[180:183]
ds_write2st64_b64 v43,v[96:97],v[100:101] offset0:36 offset1:40
v_mfma_f32_16x16x32_bf16 v[228:231],v[116:119],v[26:29],v[228:231]
v_accvgpr_read_b32 v72,a64
v_accvgpr_read_b32 v73,a65
v_mfma_f32_16x16x32_bf16 a[20:23],v[116:119],v[32:35],a[20:23]
v_accvgpr_read_b32 v74,a66
v_accvgpr_read_b32 v75,a67
v_accvgpr_read_b32 v76,a112
v_accvgpr_read_b32 v77,a113
v_accvgpr_read_b32 v78,a114
v_pk_mul_f32 v[72:73],v[72:73],v[66:67] op_sel_hi:[1,0]
v_pk_mul_f32 v[74:75],v[74:75],v[66:67] op_sel_hi:[1,0]
v_pk_mul_f32 v[76:77],v[76:77],v[70:71] op_sel_hi:[1,0]
v_accvgpr_read_b32 v79,a115
v_pk_mul_f32 v[78:79],v[78:79],v[70:71] op_sel_hi:[1,0]
v_cmp_ngt_f32 vcc,s37,v152
v_cvt_pk_bf16_f32 v72,v72,v73
v_mfma_f32_16x16x32_bf16 a[68:71],v[116:119],v[38:41],a[68:71]
ds_read_b128 v[152:155],v10 offset:18432
v_cvt_pk_bf16_f32 v76,v76,v77
v_mfma_f32_16x16x32_bf16 a[116:119],v[116:119],v[44:47],a[116:119]
s_cmp_lg_u64 vcc,0
ds_read_b128 v[156:159],v10 offset:19456
v_cvt_pk_bf16_f32 v73,v74,v75
v_mfma_f32_16x16x32_bf16 v[184:187],v[120:123],v[20:23],v[184:187]
s_cselect_b32 s62,s32,0
ds_read_b128 v[104:107],v10 offset:20480
v_accvgpr_read_b32 v80,a68
v_mfma_f32_16x16x32_bf16 v[232:235],v[120:123],v[26:29],v[232:235]
s_or_b32 s31,s31,s62
ds_read_b128 v[108:111],v10 offset:21504
v_accvgpr_read_b32 v81,a69
v_mfma_f32_16x16x32_bf16 a[24:27],v[120:123],v[32:35],a[24:27]
s_lshl_b32 s32,s32,1
v_accvgpr_read_b32 v82,a70
v_accvgpr_read_b32 v83,a71
v_accvgpr_read_b32 v84,a116
v_accvgpr_read_b32 v85,a117
v_accvgpr_read_b32 v86,a118
v_pk_mul_f32 v[80:81],v[80:81],v[66:67] op_sel_hi:[1,0]
v_pk_mul_f32 v[82:83],v[82:83],v[66:67] op_sel_hi:[1,0]
v_pk_mul_f32 v[84:85],v[84:85],v[70:71] op_sel_hi:[1,0]
v_accvgpr_read_b32 v87,a119
v_pk_mul_f32 v[86:87],v[86:87],v[70:71] op_sel_hi:[1,0]
v_cvt_pk_bf16_f32 v77,v78,v79
v_cvt_pk_bf16_f32 v80,v80,v81
v_mfma_f32_16x16x32_bf16 a[72:75],v[120:123],v[38:41],a[72:75]
s_add_u32 m0,s24,6144
ds_write2st64_b64 v36,v[72:73],v[76:77] offset0:36 offset1:40
v_mfma_f32_16x16x32_bf16 a[120:123],v[120:123],v[44:47],a[120:123]
v_cvt_pk_bf16_f32 v84,v84,v85
v_cvt_pk_bf16_f32 v81,v82,v83
v_mfma_f32_16x16x32_bf16 v[188:191],v[124:127],v[20:23],v[188:191]
buffer_load_dwordx4 v6,s[12:15],s28 offen offset:0 nt lds
v_mfma_f32_16x16x32_bf16 v[236:239],v[124:127],v[26:29],v[236:239]
buffer_load_dwordx4 v7,s[12:15],s28 offen offset:1024 nt lds
v_mfma_f32_16x16x32_bf16 a[28:31],v[124:127],v[32:35],a[28:31]
buffer_load_dwordx4 v8,s[12:15],s28 offen offset:2048 nt lds
s_waitcnt lgkmcnt(1)
buffer_store_dwordx4 v[152:155],v9,s[16:19],s87 offen offset:0 nt
v_accvgpr_read_b32 v88,a72
v_accvgpr_read_b32 v89,a73
v_pk_mul_f32 v[88:89],v[88:89],v[66:67] op_sel_hi:[1,0]
v_accvgpr_read_b32 v90,a74
v_accvgpr_read_b32 v91,a75
v_pk_mul_f32 v[90:91],v[90:91],v[66:67] op_sel_hi:[1,0]
v_accvgpr_read_b32 v92,a120
v_accvgpr_read_b32 v93,a121
v_pk_mul_f32 v[92:93],v[92:93],v[70:71] op_sel_hi:[1,0]
v_accvgpr_read_b32 v94,a122
v_accvgpr_read_b32 v95,a123
buffer_store_dwordx4 v[156:159],v9,s[16:19],s87 offen offset:3072 nt
v_pk_mul_f32 v[94:95],v[94:95],v[70:71] op_sel_hi:[1,0]
v_cvt_pk_bf16_f32 v85,v86,v87
v_cvt_pk_bf16_f32 v88,v88,v89
v_mfma_f32_16x16x32_bf16 a[76:79],v[124:127],v[38:41],a[76:79]
s_add_u32 s28,s28,3072
v_cvt_pk_bf16_f32 v92,v92,v93
v_cvt_pk_bf16_f32 v89,v90,v91
v_mfma_f32_16x16x32_bf16 a[124:127],v[124:127],v[44:47],a[124:127]
s_add_u32 m0,s24,9216
v_cvt_pk_bf16_f32 v93,v94,v95
v_rcp_f32 v62,v60
v_mfma_f32_16x16x32_bf16 v[192:195],v[128:131],v[20:23],v[192:195]
buffer_load_dwordx4 v6,s[12:15],s28 offen offset:0 nt lds
v_mfma_f32_16x16x32_bf16 v[240:243],v[128:131],v[26:29],v[240:243]
buffer_load_dwordx4 v7,s[12:15],s28 offen offset:1024 nt lds
v_mfma_f32_16x16x32_bf16 a[32:35],v[128:131],v[32:35],a[32:35]
buffer_load_dwordx4 v8,s[12:15],s28 offen offset:2048 nt lds
ds_write2st64_b64 v37,v[80:81],v[84:85] offset0:36 offset1:40
v_accvgpr_read_b32 v96,a76
v_accvgpr_read_b32 v97,a77
v_pk_mul_f32 v[96:97],v[96:97],v[66:67] op_sel_hi:[1,0]
buffer_store_dwordx4 v[104:107],v9,s[16:19],s66 offen offset:0 nt
v_accvgpr_read_b32 v98,a78
v_accvgpr_read_b32 v99,a79
v_pk_mul_f32 v[98:99],v[98:99],v[66:67] op_sel_hi:[1,0]
v_accvgpr_read_b32 v100,a124
v_accvgpr_read_b32 v101,a125
v_pk_mul_f32 v[100:101],v[100:101],v[70:71] op_sel_hi:[1,0]
v_accvgpr_read_b32 v102,a126
v_accvgpr_read_b32 v103,a127
v_pk_mul_f32 v[102:103],v[102:103],v[70:71] op_sel_hi:[1,0]
v_cvt_pk_bf16_f32 v96,v96,v97
v_cvt_pk_bf16_f32 v100,v100,v101
v_mfma_f32_16x16x32_bf16 a[80:83],v[128:131],v[38:41],a[80:83]
s_waitcnt vmcnt(24)
ds_read_b128 a[192:195],v11 offset:12288
buffer_store_dwordx4 v[108:111],v9,s[16:19],s66 offen offset:3072 nt
ds_read_b128 a[196:199],v12 offset:12288
v_cvt_pk_bf16_f32 v97,v98,v99
v_cvt_pk_bf16_f32 v101,v102,v103
v_mfma_f32_16x16x32_bf16 a[128:131],v[128:131],v[44:47],a[128:131]
s_add_u32 s28,s28,3072
ds_read_b128 a[200:203],v11 offset:12416
s_waitcnt vmcnt(10)
s_barrier
v_mfma_f32_16x16x32_bf16 v[196:199],v[132:135],v[20:23],v[196:199]
s_add_u32 m0,s23,0
ds_read_b128 a[204:207],v12 offset:12416
ds_write2st64_b64 v42,v[88:89],v[92:93] offset0:36 offset1:40
v_mfma_f32_16x16x32_bf16 v[244:247],v[132:135],v[26:29],v[244:247]
v_accvgpr_read_b32 v72,a80
ds_read_b128 a[208:211],v11 offset:12544
ds_read_b128 a[212:215],v12 offset:12544
v_mfma_f32_16x16x32_bf16 a[36:39],v[132:135],v[32:35],a[36:39]
v_accvgpr_read_b32 v73,a81
buffer_load_dwordx4 v6,s[8:11],s25 offen offset:0 lds
ds_write2st64_b64 v43,v[96:97],v[100:101] offset0:36 offset1:40
v_pk_mul_f32 v[72:73],v[72:73],v[66:67] op_sel_hi:[1,0]
v_accvgpr_read_b32 v74,a82
v_accvgpr_read_b32 v75,a83
ds_read_b128 v[76:79],v10 offset:18432
ds_read_b128 v[152:155],v10 offset:19456
v_pk_mul_f32 v[74:75],v[74:75],v[66:67] op_sel_hi:[1,0]
ds_read_b128 v[156:159],v10 offset:20480
v_accvgpr_read_b32 v80,a128
ds_read_b128 v[84:87],v10 offset:21504
v_accvgpr_read_b32 v81,a129
ds_read_b128 v[112:115],v0 offset:0
v_pk_mul_f32 v[80:81],v[80:81],v[70:71] op_sel_hi:[1,0]
ds_read_b128 v[116:119],v1 offset:0
buffer_load_dwordx4 v7,s[8:11],s25 offen offset:1024 lds
ds_read_b128 v[120:123],v0 offset:128
v_accvgpr_read_b32 v82,a130
ds_read_b128 v[124:127],v1 offset:128
v_accvgpr_read_b32 v83,a131
ds_read_b128 v[128:131],v0 offset:256
v_pk_mul_f32 v[82:83],v[82:83],v[70:71] op_sel_hi:[1,0]
v_cvt_pk_bf16_f32 v72,v72,v73
v_cvt_pk_bf16_f32 v80,v80,v81
v_mfma_f32_16x16x32_bf16 a[84:87],v[132:135],v[38:41],a[84:87]
s_waitcnt lgkmcnt(8)
buffer_store_dwordx4 v[76:79],v9,s[16:19],s87 offen offset:128 nt
v_cvt_pk_bf16_f32 v73,v74,v75
v_cvt_pk_bf16_f32 v81,v82,v83
v_rcp_f32 v54,v52
v_mfma_f32_16x16x32_bf16 a[132:135],v[132:135],v[44:47],a[132:135]
ds_read_b128 v[132:135],v1 offset:256
v_rcp_f32 v58,v56
v_mfma_f32_16x16x32_bf16 v[200:203],v[136:139],v[20:23],v[200:203]
ds_write2st64_b64 v36,v[72:73],v[80:81] offset0:36 offset1:40
v_mfma_f32_16x16x32_bf16 v[248:251],v[136:139],v[26:29],v[248:251]
v_add_u32 v36,v36,v53
v_accvgpr_read_b32 v104,a84
v_mfma_f32_16x16x32_bf16 a[40:43],v[136:139],v[32:35],a[40:43]
buffer_load_dwordx4 v8,s[8:11],s25 offen offset:2048 lds
s_waitcnt lgkmcnt(3)
buffer_store_dwordx4 v[152:155],v9,s[16:19],s87 offen offset:3200 nt
v_accvgpr_read_b32 v105,a85
v_pk_mul_f32 v[104:105],v[104:105],v[66:67] op_sel_hi:[1,0]
v_accvgpr_read_b32 v106,a86
v_accvgpr_read_b32 v107,a87
v_pk_mul_f32 v[106:107],v[106:107],v[66:67] op_sel_hi:[1,0]
v_accvgpr_read_b32 v108,a132
v_accvgpr_read_b32 v109,a133
v_pk_mul_f32 v[108:109],v[108:109],v[70:71] op_sel_hi:[1,0]
v_accvgpr_read_b32 v110,a134
v_accvgpr_read_b32 v111,a135
v_pk_mul_f32 v[110:111],v[110:111],v[70:71] op_sel_hi:[1,0]
v_cvt_pk_bf16_f32 v104,v104,v105
v_cvt_pk_bf16_f32 v108,v108,v109
v_mfma_f32_16x16x32_bf16 a[88:91],v[136:139],v[38:41],a[88:91]
s_add_u32 m0,s23,24576
v_cvt_pk_bf16_f32 v105,v106,v107
v_cvt_pk_bf16_f32 v109,v110,v111
v_mfma_f32_16x16x32_bf16 a[136:139],v[136:139],v[44:47],a[136:139]
ds_write2st64_b64 v37,v[104:105],v[108:109] offset0:36 offset1:40
v_mfma_f32_16x16x32_bf16 v[204:207],v[140:143],v[20:23],v[204:207]
s_waitcnt vmcnt(18)
v_add_u32 v37,v37,v53
v_accvgpr_read_b32 v92,a88
v_mfma_f32_16x16x32_bf16 v[252:255],v[140:143],v[26:29],v[252:255]
buffer_load_dwordx4 v6,s[8:11],s21 offen offset:0 lds
v_mfma_f32_16x16x32_bf16 a[44:47],v[140:143],v[32:35],a[44:47]
ds_read_b128 a[216:219],v11 offset:0
ds_read_b128 a[220:223],v12 offset:0
buffer_store_dwordx4 v[156:159],v9,s[16:19],s66 offen offset:128 nt
ds_read_b128 a[224:227],v11 offset:128
v_accvgpr_read_b32 v93,a89
ds_read_b128 a[228:231],v12 offset:128
v_pk_mul_f32 v[92:93],v[92:93],v[66:67] op_sel_hi:[1,0]
ds_read_b128 a[232:235],v11 offset:256
v_accvgpr_read_b32 v94,a90
ds_read_b128 a[236:239],v12 offset:256
buffer_store_dwordx4 v[84:87],v9,s[16:19],s66 offen offset:3200 nt
ds_read_b128 v[136:139],v0 offset:6144
v_accvgpr_read_b32 v95,a91
v_pk_mul_f32 v[94:95],v[94:95],v[66:67] op_sel_hi:[1,0]
v_accvgpr_read_b32 v96,a136
v_accvgpr_read_b32 v97,a137
v_pk_mul_f32 v[96:97],v[96:97],v[70:71] op_sel_hi:[1,0]
v_accvgpr_read_b32 v98,a138
v_accvgpr_read_b32 v99,a139
v_pk_mul_f32 v[98:99],v[98:99],v[70:71] op_sel_hi:[1,0]
v_cvt_pk_bf16_f32 v92,v92,v93
v_cvt_pk_bf16_f32 v96,v96,v97
v_mfma_f32_16x16x32_bf16 a[92:95],v[140:143],v[38:41],a[92:95]
buffer_load_dwordx4 v7,s[8:11],s21 offen offset:1024 lds
v_mfma_f32_16x16x32_bf16 a[140:143],v[140:143],v[44:47],a[140:143]
ds_read_b128 v[140:143],v1 offset:6144
v_cvt_pk_bf16_f32 v93,v94,v95
v_mfma_f32_16x16x32_bf16 v[72:75],v[112:115],a[144:147],0
v_cvt_pk_bf16_f32 v97,v98,v99
v_accvgpr_read_b32 v108,a0
v_mfma_f32_16x16x32_bf16 v[80:83],v[112:115],a[168:171],0
ds_write2st64_b64 v42,v[92:93],v[96:97] offset0:36 offset1:40
v_mfma_f32_16x16x32_bf16 v[88:91],v[112:115],a[192:195],0
v_add_u32 v42,v42,v53
ds_read_b128 v[112:115],v0 offset:6272
v_accvgpr_read_b32 v100,a92
v_accvgpr_read_b32 v101,a93
v_pk_mul_f32 v[100:101],v[100:101],v[66:67] op_sel_hi:[1,0]
v_accvgpr_read_b32 v76,a140
v_accvgpr_read_b32 v77,a141
v_pk_mul_f32 v[76:77],v[76:77],v[70:71] op_sel_hi:[1,0]
v_accvgpr_read_b32 v102,a94
v_accvgpr_read_b32 v103,a95
v_pk_mul_f32 v[102:103],v[102:103],v[66:67] op_sel_hi:[1,0]
v_accvgpr_read_b32 v78,a142
v_accvgpr_read_b32 v79,a143
v_pk_mul_f32 v[78:79],v[78:79],v[70:71] op_sel_hi:[1,0]
v_cvt_pk_bf16_f32 v100,v100,v101
v_cvt_pk_bf16_f32 v76,v76,v77
v_cvt_pk_bf16_f32 v101,v102,v103
v_cvt_pk_bf16_f32 v77,v78,v79
ds_write2st64_b64 v43,v[100:101],v[76:77] offset0:36 offset1:40
v_add_u32 v43,v43,v53
v_accvgpr_read_b32 v109,a1
v_pk_mul_f32 v[108:109],v[108:109],v[62:63] op_sel_hi:[1,0]
buffer_load_dwordx4 v8,s[8:11],s21 offen offset:2048 lds
ds_read_b128 v[152:155],v10 offset:18432
ds_read_b128 v[156:159],v10 offset:19456
v_accvgpr_read_b32 v92,a16
ds_read_b128 v[84:87],v10 offset:20480
v_accvgpr_read_b32 v93,a17
ds_read_b128 v[104:107],v10 offset:21504
v_pk_mul_f32 v[92:93],v[92:93],v[62:63] op_sel_hi:[1,0]
v_accvgpr_read_b32 v110,a2
v_accvgpr_read_b32 v111,a3
v_pk_mul_f32 v[110:111],v[110:111],v[62:63] op_sel_hi:[1,0]
v_accvgpr_read_b32 v94,a18
v_accvgpr_read_b32 v95,a19
v_pk_mul_f32 v[94:95],v[94:95],v[62:63] op_sel_hi:[1,0]
v_accvgpr_read_b32 v96,a4
v_accvgpr_read_b32 v97,a5
v_pk_mul_f32 v[96:97],v[96:97],v[62:63] op_sel_hi:[1,0]
v_accvgpr_read_b32 v76,a20
v_accvgpr_read_b32 v77,a21
v_pk_mul_f32 v[76:77],v[76:77],v[62:63] op_sel_hi:[1,0]
v_accvgpr_read_b32 v98,a6
v_accvgpr_read_b32 v99,a7
v_pk_mul_f32 v[98:99],v[98:99],v[62:63] op_sel_hi:[1,0]
v_accvgpr_read_b32 v78,a22
v_accvgpr_read_b32 v79,a23
v_pk_mul_f32 v[78:79],v[78:79],v[62:63] op_sel_hi:[1,0]
v_cvt_pk_bf16_f32 v108,v108,v109
v_cvt_pk_bf16_f32 v92,v92,v93
v_cvt_pk_bf16_f32 v96,v96,v97
s_waitcnt lgkmcnt(3)
buffer_store_dwordx4 v[152:155],v9,s[16:19],s87 offen offset:256 nt
v_cvt_pk_bf16_f32 v76,v76,v77
v_cvt_pk_bf16_f32 v109,v110,v111
v_cvt_pk_bf16_f32 v93,v94,v95
v_cvt_pk_bf16_f32 v97,v98,v99
v_cvt_pk_bf16_f32 v77,v78,v79
v_accvgpr_read_b32 v102,a10
v_accvgpr_read_b32 v103,a11
v_pk_mul_f32 v[102:103],v[102:103],v[62:63] op_sel_hi:[1,0]
v_accvgpr_read_b32 v100,a8
ds_write2st64_b64 v36,v[108:109],v[92:93] offset0:24 offset1:26
v_accvgpr_read_b32 v101,a9
v_pk_mul_f32 v[100:101],v[100:101],v[62:63] op_sel_hi:[1,0]
v_accvgpr_read_b32 v110,a14
s_waitcnt lgkmcnt(1)
buffer_store_dwordx4 v[156:159],v9,s[16:19],s87 offen offset:3328 nt
v_accvgpr_read_b32 v111,a15
v_pk_mul_f32 v[110:111],v[110:111],v[62:63] op_sel_hi:[1,0]
v_accvgpr_read_b32 v94,a26
v_accvgpr_read_b32 v95,a27
v_pk_mul_f32 v[94:95],v[94:95],v[62:63] op_sel_hi:[1,0]
v_accvgpr_read_b32 v78,a30
v_accvgpr_read_b32 v79,a31
v_pk_mul_f32 v[78:79],v[78:79],v[62:63] op_sel_hi:[1,0]
v_accvgpr_read_b32 v92,a24
ds_write2st64_b64 v37,v[96:97],v[76:77] offset0:24 offset1:26
v_accvgpr_read_b32 v93,a25
v_pk_mul_f32 v[92:93],v[92:93],v[62:63] op_sel_hi:[1,0]
v_accvgpr_read_b32 v108,a12
buffer_store_dwordx4 v[84:87],v9,s[16:19],s66 offen offset:256 nt
v_accvgpr_read_b32 v109,a13
v_pk_mul_f32 v[108:109],v[108:109],v[62:63] op_sel_hi:[1,0]
v_accvgpr_read_b32 v76,a28
v_accvgpr_read_b32 v77,a29
v_pk_mul_f32 v[76:77],v[76:77],v[62:63] op_sel_hi:[1,0]
v_accvgpr_read_b32 v84,a32
v_accvgpr_read_b32 v85,a33
v_mfma_f32_16x16x32_bf16 v[72:75],v[116:119],a[148:151],v[72:75]
s_waitcnt vmcnt(15)
ds_read_b128 a[240:243],v11 offset:6144
v_accvgpr_read_b32 v86,a34
v_mfma_f32_16x16x32_bf16 v[80:83],v[116:119],a[172:175],v[80:83]
s_add_u32 s21,s21,12288
ds_read_b128 a[244:247],v12 offset:6144
buffer_store_dwordx4 v[104:107],v9,s[16:19],s66 offen offset:3328 nt
ds_read_b128 a[248:251],v11 offset:6272
v_accvgpr_read_b32 v87,a35
v_accvgpr_read_b32 v98,a38
v_mfma_f32_16x16x32_bf16 v[88:91],v[116:119],a[196:199],v[88:91]
s_mov_b32 s27,s42
ds_read_b128 a[252:255],v12 offset:6272
ds_read_b128 v[144:147],v11 offset:6400
v_accvgpr_read_b32 v99,a39
ds_read_b128 v[148:151],v12 offset:6400
v_pk_mul_f32 v[84:85],v[84:85],v[62:63] op_sel_hi:[1,0]
ds_read_b128 v[116:119],v1 offset:6272
v_pk_mul_f32 v[86:87],v[86:87],v[62:63] op_sel_hi:[1,0]
v_pk_mul_f32 v[160:161],v[160:161],v[54:55] op_sel_hi:[1,0]
v_pk_mul_f32 v[162:163],v[162:163],v[54:55] op_sel_hi:[1,0]
v_accvgpr_read_b32 v96,a36
v_accvgpr_read_b32 v97,a37
v_mfma_f32_16x16x32_bf16 v[72:75],v[120:123],a[152:155],v[72:75]
s_mov_b32 s42,s41
v_accvgpr_read_b32 v104,a40
v_accvgpr_read_b32 v105,a41
v_mfma_f32_16x16x32_bf16 v[80:83],v[120:123],a[176:179],v[80:83]
s_add_u32 s69,s69,1
v_accvgpr_read_b32 v106,a42
v_accvgpr_read_b32 v107,a43
v_mfma_f32_16x16x32_bf16 v[88:91],v[120:123],a[200:203],v[88:91]
s_lshl_b32 s62,s69,5
ds_read_b128 v[120:123],v0 offset:6400
v_cvt_pk_bf16_f32 v100,v100,v101
v_cvt_pk_bf16_f32 v92,v92,v93
v_cvt_pk_bf16_f32 v101,v102,v103
v_cvt_pk_bf16_f32 v93,v94,v95
ds_write2st64_b64 v42,v[100:101],v[92:93] offset0:24 offset1:26
v_pk_mul_f32 v[96:97],v[96:97],v[62:63] op_sel_hi:[1,0]
v_pk_mul_f32 v[98:99],v[98:99],v[62:63] op_sel_hi:[1,0]
v_pk_mul_f32 v[164:165],v[164:165],v[54:55] op_sel_hi:[1,0]
v_pk_mul_f32 v[166:167],v[166:167],v[54:55] op_sel_hi:[1,0]
v_accvgpr_read_b32 v102,a46
v_accvgpr_read_b32 v103,a47
v_mfma_f32_16x16x32_bf16 v[72:75],v[124:127],a[156:159],v[72:75]
s_add_u32 s62,s62,s34
v_accvgpr_read_b32 v100,a44
v_accvgpr_read_b32 v101,a45
v_mfma_f32_16x16x32_bf16 v[80:83],v[124:127],a[180:183],v[80:83]
s_mul_i32 s63,s62,171
v_cvt_pk_bf16_f32 v108,v108,v109
v_cvt_pk_bf16_f32 v76,v76,v77
v_mfma_f32_16x16x32_bf16 v[88:91],v[124:127],a[204:207],v[88:91]
s_lshr_b32 s63,s63,9
ds_read_b128 v[124:127],v1 offset:6400
v_cvt_pk_bf16_f32 v109,v110,v111
v_mfma_f32_16x16x32_bf16 v[72:75],v[128:131],a[160:163],v[72:75]
s_mul_i32 s64,s63,3
v_cvt_pk_bf16_f32 v77,v78,v79
ds_write2st64_b64 v43,v[108:109],v[76:77] offset0:24 offset1:26
v_pk_mul_f32 v[104:105],v[104:105],v[62:63] op_sel_hi:[1,0]
v_pk_mul_f32 v[106:107],v[106:107],v[62:63] op_sel_hi:[1,0]
v_pk_mul_f32 v[168:169],v[168:169],v[54:55] op_sel_hi:[1,0]
v_pk_mul_f32 v[170:171],v[170:171],v[54:55] op_sel_hi:[1,0]
v_cvt_pk_bf16_f32 v84,v84,v85
v_cvt_pk_bf16_f32 v160,v160,v161
v_mfma_f32_16x16x32_bf16 v[80:83],v[128:131],a[184:187],v[80:83]
s_sub_u32 s62,s62,s64
v_cvt_pk_bf16_f32 v85,v86,v87
v_cvt_pk_bf16_f32 v161,v162,v163
v_mfma_f32_16x16x32_bf16 v[88:91],v[128:131],a[208:211],v[88:91]
s_add_u32 s63,s63,s33
ds_read_b128 v[128:131],v0 offset:0
v_cvt_pk_bf16_f32 v96,v96,v97
v_mfma_f32_16x16x32_bf16 v[72:75],v[132:135],a[164:167],v[72:75]
s_mul_i32 s30,s63,196608
ds_write2st64_b64 v36,v[84:85],v[160:161] offset0:28 offset1:0
v_mfma_f32_16x16x32_bf16 v[80:83],v[132:135],a[188:191],v[80:83]
s_mul_i32 s41,s63,325632
v_cvt_pk_bf16_f32 v164,v164,v165
v_cvt_pk_bf16_f32 v97,v98,v99
v_cvt_pk_bf16_f32 v165,v166,v167
v_cvt_pk_bf16_f32 v104,v104,v105
v_cvt_pk_bf16_f32 v168,v168,v169
v_pk_mul_f32 v[100:101],v[100:101],v[62:63] op_sel_hi:[1,0]
v_pk_mul_f32 v[102:103],v[102:103],v[62:63] op_sel_hi:[1,0]
v_pk_mul_f32 v[172:173],v[172:173],v[54:55] op_sel_hi:[1,0]
v_pk_mul_f32 v[174:175],v[174:175],v[54:55] op_sel_hi:[1,0]
v_cvt_pk_bf16_f32 v105,v106,v107
v_cvt_pk_bf16_f32 v169,v170,v171
v_mfma_f32_16x16x32_bf16 v[88:91],v[132:135],a[212:215],v[88:91]
s_lshl_b32 s63,s3,2
ds_write2st64_b64 v37,v[96:97],v[164:165] offset0:28 offset1:0
v_mfma_f32_16x16x32_bf16 v[76:79],v[136:139],a[144:147],0
s_add_u32 s64,s63,21
v_cvt_pk_bf16_f32 v100,v100,v101
v_cvt_pk_bf16_f32 v172,v172,v173
v_mfma_f32_16x16x32_bf16 v[84:87],v[136:139],a[168:171],0
s_cmp_eq_u32 s3,0
ds_read_b128 v[132:135],v1 offset:0
v_cvt_pk_bf16_f32 v101,v102,v103
v_cvt_pk_bf16_f32 v173,v174,v175
v_max3_f32 v20,v72,v73,v74
v_max3_f32 v26,v80,v81,v82
ds_write2st64_b64 v42,v[104:105],v[168:169] offset0:28 offset1:0
v_pk_mul_f32 v[176:177],v[176:177],v[54:55] op_sel_hi:[1,0]
v_pk_mul_f32 v[178:179],v[178:179],v[54:55] op_sel_hi:[1,0]
v_pk_mul_f32 v[192:193],v[192:193],v[54:55] op_sel_hi:[1,0]
v_pk_mul_f32 v[194:195],v[194:195],v[54:55] op_sel_hi:[1,0]
v_max3_f32 v32,v88,v89,v90
v_cvt_pk_bf16_f32 v176,v176,v177
v_mfma_f32_16x16x32_bf16 v[92:95],v[136:139],a[192:195],0
s_cselect_b32 s64,20,s64
ds_read_b128 v[136:139],v0 offset:128
v_cvt_pk_bf16_f32 v192,v192,v193
v_mfma_f32_16x16x32_bf16 v[76:79],v[140:143],a[148:151],v[76:79]
s_cselect_b32 s40,1,0
v_cvt_pk_bf16_f32 v177,v178,v179
v_cvt_pk_bf16_f32 v193,v194,v195
v_mfma_f32_16x16x32_bf16 v[84:87],v[140:143],a[172:175],v[84:87]
s_add_u32 s65,s63,37
ds_write2st64_b64 v43,v[100:101],v[172:173] offset0:28 offset1:0
v_mfma_f32_16x16x32_bf16 v[92:95],v[140:143],a[196:199],v[92:95]
s_cmp_eq_u32 s62,2
s_cselect_b32 s64,s65,s64
ds_read_b128 v[140:143],v1 offset:128
s_cselect_b32 s40,0,s40
v_pk_mul_f32 v[180:181],v[180:181],v[54:55] op_sel_hi:[1,0]
v_pk_mul_f32 v[182:183],v[182:183],v[54:55] op_sel_hi:[1,0]
v_pk_mul_f32 v[196:197],v[196:197],v[54:55] op_sel_hi:[1,0]
v_pk_mul_f32 v[198:199],v[198:199],v[54:55] op_sel_hi:[1,0]
v_cvt_pk_bf16_f32 v180,v180,v181
v_cvt_pk_bf16_f32 v196,v196,v197
v_mfma_f32_16x16x32_bf16 v[76:79],v[112:115],a[152:155],v[76:79]
s_add_u32 s65,s63,s3
ds_write2st64_b64 v36,v[176:177],v[192:193] offset0:2 offset1:4
v_mfma_f32_16x16x32_bf16 v[84:87],v[112:115],a[176:179],v[84:87]
s_cmp_eq_u32 s62,0
v_cvt_pk_bf16_f32 v181,v182,v183
v_cvt_pk_bf16_f32 v197,v198,v199
v_mfma_f32_16x16x32_bf16 v[92:95],v[112:115],a[200:203],v[92:95]
s_cselect_b32 s64,s65,s64
ds_read_b128 v[112:115],v0 offset:256
s_cselect_b32 s40,1,s40
s_mul_i32 s64,s64,6144
s_add_u32 s41,s41,s64
s_cmp_ge_u32 s69,6
ds_write2st64_b64 v37,v[180:181],v[196:197] offset0:2 offset1:4
v_pk_mul_f32 v[184:185],v[184:185],v[54:55] op_sel_hi:[1,0]
v_pk_mul_f32 v[186:187],v[186:187],v[54:55] op_sel_hi:[1,0]
v_pk_mul_f32 v[200:201],v[200:201],v[54:55] op_sel_hi:[1,0]
v_pk_mul_f32 v[202:203],v[202:203],v[54:55] op_sel_hi:[1,0]
v_cvt_pk_bf16_f32 v184,v184,v185
v_cvt_pk_bf16_f32 v200,v200,v201
s_waitcnt lgkmcnt(3)
v_mfma_f32_16x16x32_bf16 v[76:79],v[116:119],a[156:159],v[76:79]
s_cselect_b32 s41,166723584,s41
v_cvt_pk_bf16_f32 v185,v186,v187
v_cvt_pk_bf16_f32 v201,v202,v203
v_mfma_f32_16x16x32_bf16 v[84:87],v[116:119],a[180:183],v[84:87]
s_cselect_b32 s30,100663296,s30
s_add_u32 s25,s30,s22
ds_write2st64_b64 v42,v[184:185],v[200:201] offset0:2 offset1:4
v_mfma_f32_16x16x32_bf16 v[92:95],v[116:119],a[204:207],v[92:95]
s_add_u32 s26,s25,12288
s_add_u32 m0,s22,0
s_mov_b32 s28,s41
v_mfma_f32_16x16x32_bf16 v[76:79],v[120:123],a[160:163],v[76:79]
s_mov_b32 s29,s24
ds_read_b128 v[116:119],v1 offset:256
v_pk_mul_f32 v[188:189],v[188:189],v[54:55] op_sel_hi:[1,0]
v_pk_mul_f32 v[190:191],v[190:191],v[54:55] op_sel_hi:[1,0]
v_pk_mul_f32 v[204:205],v[204:205],v[54:55] op_sel_hi:[1,0]
v_pk_mul_f32 v[206:207],v[206:207],v[54:55] op_sel_hi:[1,0]
v_cvt_pk_bf16_f32 v188,v188,v189
v_cvt_pk_bf16_f32 v204,v204,v205
v_mfma_f32_16x16x32_bf16 v[84:87],v[120:123],a[184:187],v[84:87]
v_cvt_pk_bf16_f32 v189,v190,v191
v_cvt_pk_bf16_f32 v205,v206,v207
v_mfma_f32_16x16x32_bf16 v[92:95],v[120:123],a[208:211],v[92:95]
ds_write2st64_b64 v43,v[188:189],v[204:205] offset0:2 offset1:4
v_mfma_f32_16x16x32_bf16 v[76:79],v[124:127],a[164:167],v[76:79]
v_mfma_f32_16x16x32_bf16 v[84:87],v[124:127],a[188:191],v[84:87]
ds_read_b128 v[120:123],v0 offset:6144
v_pk_mul_f32 v[208:209],v[208:209],v[58:59] op_sel_hi:[1,0]
v_pk_mul_f32 v[210:211],v[210:211],v[58:59] op_sel_hi:[1,0]
v_pk_mul_f32 v[224:225],v[224:225],v[58:59] op_sel_hi:[1,0]
v_pk_mul_f32 v[226:227],v[226:227],v[58:59] op_sel_hi:[1,0]
v_cvt_pk_bf16_f32 v208,v208,v209
v_cvt_pk_bf16_f32 v224,v224,v225
v_mfma_f32_16x16x32_bf16 v[92:95],v[124:127],a[212:215],v[92:95]
ds_read_b128 v[124:127],v1 offset:6144
v_max3_f32 v20,v20,v75,v76
v_mfma_f32_16x16x32_bf16 v[96:99],v[128:131],a[216:219],0
v_max3_f32 v20,v20,v77,v78
v_max_f32 v20,v20,v79
v_mfma_f32_16x16x32_bf16 v[104:107],v[128:131],a[240:243],0
ds_read_b128 v[128:131],v0 offset:6272
v_mov_b32 v21,v20
v_max3_f32 v26,v26,v83,v84
v_max3_f32 v26,v26,v85,v86
v_permlane32_swap_b32 v21,v20
v_pk_mul_f32 v[212:213],v[212:213],v[58:59] op_sel_hi:[1,0]
v_pk_mul_f32 v[214:215],v[214:215],v[58:59] op_sel_hi:[1,0]
v_pk_mul_f32 v[228:229],v[228:229],v[58:59] op_sel_hi:[1,0]
v_pk_mul_f32 v[230:231],v[230:231],v[58:59] op_sel_hi:[1,0]
v_max_f32 v20,v20,v21
v_max_f32 v26,v26,v87
v_mfma_f32_16x16x32_bf16 v[96:99],v[132:135],a[220:223],v[96:99]
v_mov_b32 v21,v20
v_mov_b32 v27,v26
v_mfma_f32_16x16x32_bf16 v[104:107],v[132:135],a[244:247],v[104:107]
ds_read_b128 v[132:135],v1 offset:6272
v_permlane16_swap_b32 v21,v20
v_mfma_f32_16x16x32_bf16 v[96:99],v[136:139],a[224:227],v[96:99]
v_max3_f32 v32,v32,v91,v92
v_permlane32_swap_b32 v27,v26
v_mfma_f32_16x16x32_bf16 v[104:107],v[136:139],a[248:251],v[104:107]
ds_read_b128 v[136:139],v0 offset:6400
v_max_f32 v20,v20,v21
v_max3_f32 v32,v32,v93,v94
v_max_f32 v26,v26,v27
v_mul_f32_e64 v13,-s36,v20
v_pk_mul_f32 v[216:217],v[216:217],v[58:59] op_sel_hi:[1,0]
v_pk_mul_f32 v[218:219],v[218:219],v[58:59] op_sel_hi:[1,0]
v_pk_mul_f32 v[232:233],v[232:233],v[58:59] op_sel_hi:[1,0]
v_pk_mul_f32 v[234:235],v[234:235],v[58:59] op_sel_hi:[1,0]
v_max_f32 v32,v32,v95
v_mov_b32 v27,v26
v_mfma_f32_16x16x32_bf16 v[96:99],v[140:143],a[228:231],v[96:99]
v_fma_f32 v72,v72,s36,v13
v_fma_f32 v73,v73,s36,v13
v_mfma_f32_16x16x32_bf16 v[104:107],v[140:143],a[252:255],v[104:107]
s_waitcnt lgkmcnt(2)
ds_read_b128 v[140:143],v1 offset:6400
v_fma_f32 v74,v74,s36,v13
v_mfma_f32_16x16x32_bf16 v[96:99],v[112:115],a[232:235],v[96:99]
v_fma_f32 v75,v75,s36,v13
v_mov_b32 v33,v32
v_mfma_f32_16x16x32_bf16 v[104:107],v[112:115],v[144:147],v[104:107]
ds_read_b128 v[112:115],v0 offset:12544
v_permlane16_swap_b32 v27,v26
v_exp_f32 v72,v72
v_pk_mul_f32 v[220:221],v[220:221],v[58:59] op_sel_hi:[1,0]
v_pk_mul_f32 v[222:223],v[222:223],v[58:59] op_sel_hi:[1,0]
v_pk_mul_f32 v[236:237],v[236:237],v[58:59] op_sel_hi:[1,0]
v_pk_mul_f32 v[238:239],v[238:239],v[58:59] op_sel_hi:[1,0]
v_exp_f32 v73,v73
v_exp_f32 v74,v74
v_mfma_f32_16x16x32_bf16 v[96:99],v[116:119],a[236:239],v[96:99]
v_exp_f32 v75,v75
v_mfma_f32_16x16x32_bf16 v[104:107],v[116:119],v[148:151],v[104:107]
ds_read_b128 v[116:119],v1 offset:12544
v_permlane32_swap_b32 v33,v32
v_mfma_f32_16x16x32_bf16 v[100:103],v[120:123],a[216:219],0
v_max_f32 v26,v26,v27
v_max_f32 v32,v32,v33
v_mul_f32_e64 v14,-s36,v26
v_max3_f32 v38,v96,v97,v98
v_cvt_pk_bf16_f32 v18,v72,v73
v_pk_mul_f32 v[240:241],v[240:241],v[58:59] op_sel_hi:[1,0]
v_pk_mul_f32 v[242:243],v[242:243],v[58:59] op_sel_hi:[1,0]
v_cvt_pk_bf16_f32 v19,v74,v75
v_mov_b32 v33,v32
v_mfma_f32_16x16x32_bf16 v[108:111],v[120:123],a[240:243],0
ds_read_b128 v[120:123],v0 offset:18432
v_fma_f32 v80,v80,s36,v14
v_mfma_f32_16x16x32_bf16 v[100:103],v[124:127],a[220:223],v[100:103]
v_fma_f32 v81,v81,s36,v14
v_fma_f32 v82,v82,s36,v14
v_mfma_f32_16x16x32_bf16 v[108:111],v[124:127],a[244:247],v[108:111]
ds_read_b128 v[124:127],v1 offset:18432
v_fma_f32 v83,v83,s36,v14
v_mfma_f32_16x16x32_bf16 v[100:103],v[128:131],a[224:227],v[100:103]
v_max3_f32 v44,v104,v105,v106
v_permlane16_swap_b32 v33,v32
v_exp_f32 v80,v80
v_pk_mul_f32 v[244:245],v[244:245],v[58:59] op_sel_hi:[1,0]
v_pk_mul_f32 v[246:247],v[246:247],v[58:59] op_sel_hi:[1,0]
v_exp_f32 v81,v81
v_exp_f32 v82,v82
v_mfma_f32_16x16x32_bf16 v[108:111],v[128:131],a[248:251],v[108:111]
s_waitcnt lgkmcnt(2)
ds_read_b128 v[128:131],v0 offset:12288
v_exp_f32 v83,v83
v_mfma_f32_16x16x32_bf16 v[100:103],v[132:135],a[228:231],v[100:103]
v_max_f32 v32,v32,v33
v_mul_f32_e64 v15,-s36,v32
v_mfma_f32_16x16x32_bf16 v[108:111],v[132:135],a[252:255],v[108:111]
ds_read_b128 v[132:135],v1 offset:12288
v_cvt_pk_bf16_f32 v24,v80,v81
v_cvt_pk_bf16_f32 v25,v82,v83
v_fma_f32 v88,v88,s36,v15
v_fma_f32 v89,v89,s36,v15
v_pk_mul_f32 v[248:249],v[248:249],v[58:59] op_sel_hi:[1,0]
v_pk_mul_f32 v[250:251],v[250:251],v[58:59] op_sel_hi:[1,0]
v_fma_f32 v90,v90,s36,v15
v_fma_f32 v91,v91,s36,v15
v_mfma_f32_16x16x32_bf16 v[100:103],v[136:139],a[232:235],v[100:103]
v_cvt_pk_bf16_f32 v209,v210,v211
v_cvt_pk_bf16_f32 v225,v226,v227
v_mfma_f32_16x16x32_bf16 v[108:111],v[136:139],v[144:147],v[108:111]
ds_read_b128 v[136:139],v0 offset:12416
v_cvt_pk_bf16_f32 v212,v212,v213
v_mfma_f32_16x16x32_bf16 v[100:103],v[140:143],a[236:239],v[100:103]
ds_write2st64_b64 v36,v[208:209],v[224:225] offset0:12 offset1:14
v_mfma_f32_16x16x32_bf16 v[108:111],v[140:143],v[148:151],v[108:111]
v_cvt_pk_bf16_f32 v228,v228,v229
ds_read_b128 v[140:143],v1 offset:12416
v_exp_f32 v88,v88
v_pk_mul_f32 v[252:253],v[252:253],v[58:59] op_sel_hi:[1,0]
v_pk_mul_f32 v[254:255],v[254:255],v[58:59] op_sel_hi:[1,0]
v_exp_f32 v89,v89
v_max3_f32 v38,v38,v99,v100
s_waitcnt lgkmcnt(3)
v_mfma_f32_16x16x32_bf16 v[72:75],v[128:131],a[144:147],0
v_max3_f32 v38,v38,v101,v102
v_max_f32 v38,v38,v103
v_mfma_f32_16x16x32_bf16 v[80:83],v[128:131],a[168:171],0
v_mov_b32 v39,v38
v_max3_f32 v44,v44,v107,v108
v_max3_f32 v44,v44,v109,v110
v_permlane32_swap_b32 v39,v38
v_max_f32 v38,v38,v39
v_max_f32 v44,v44,v111
v_mov_b32 v39,v38
v_exp_f32 v90,v90
v_exp_f32 v91,v91
v_mov_b32 v45,v44
v_permlane16_swap_b32 v39,v38
v_cvt_pk_bf16_f32 v216,v216,v217
v_cvt_pk_bf16_f32 v232,v232,v233
v_cvt_pk_bf16_f32 v213,v214,v215
v_cvt_pk_bf16_f32 v229,v230,v231
ds_write2st64_b64 v37,v[212:213],v[228:229] offset0:12 offset1:14
v_permlane32_swap_b32 v45,v44
v_max_f32 v38,v38,v39
v_cvt_pk_bf16_f32 v220,v220,v221
v_cvt_pk_bf16_f32 v236,v236,v237
v_cvt_pk_bf16_f32 v217,v218,v219
v_cvt_pk_bf16_f32 v233,v234,v235
v_max_f32 v44,v44,v45
v_mul_f32_e64 v16,-s36,v38
v_cvt_pk_bf16_f32 v240,v240,v241
v_cvt_pk_bf16_f32 v30,v88,v89
ds_write2st64_b64 v42,v[216:217],v[232:233] offset0:12 offset1:14
v_cvt_pk_bf16_f32 v31,v90,v91
v_mfma_f32_16x16x32_bf16 v[88:91],v[128:131],a[192:195],0
v_cvt_pk_bf16_f32 v221,v222,v223
v_cvt_pk_bf16_f32 v237,v238,v239
v_mov_b32 v45,v44
v_fma_f32 v96,v96,s36,v16
v_fma_f32 v97,v97,s36,v16
v_fma_f32 v98,v98,s36,v16
v_fma_f32 v99,v99,s36,v16
v_cvt_pk_bf16_f32 v244,v244,v245
ds_write2st64_b64 v43,v[220:221],v[236:237] offset0:12 offset1:14
v_cvt_pk_bf16_f32 v241,v242,v243
v_permlane16_swap_b32 v45,v44
v_exp_f32 v96,v96
v_exp_f32 v97,v97
v_exp_f32 v98,v98
v_exp_f32 v99,v99
ds_write_b64 v36,v[240:241] offset:8192
v_cvt_pk_bf16_f32 v245,v246,v247
v_max_f32 v44,v44,v45
v_mul_f32_e64 v17,-s36,v44
v_cvt_pk_bf16_f32 v248,v248,v249
ds_write_b64 v37,v[244:245] offset:8192
v_cvt_pk_bf16_f32 v36,v96,v97
v_fma_f32 v104,v104,s36,v17
v_fma_f32 v105,v105,s36,v17
v_fma_f32 v106,v106,s36,v17
v_fma_f32 v107,v107,s36,v17
v_cvt_pk_bf16_f32 v37,v98,v99
v_mfma_f32_16x16x32_bf16 v[96:99],v[128:131],a[216:219],0
v_cvt_pk_bf16_f32 v252,v252,v253
v_cvt_pk_bf16_f32 v249,v250,v251
ds_write_b64 v42,v[248:249] offset:8192
v_exp_f32 v104,v104
v_exp_f32 v105,v105
v_exp_f32 v106,v106
v_exp_f32 v107,v107
v_cvt_pk_bf16_f32 v253,v254,v255
ds_write_b64 v43,v[252:253] offset:8192
v_cvt_pk_bf16_f32 v42,v104,v105
v_cvt_pk_bf16_f32 v43,v106,v107
v_mfma_f32_16x16x32_bf16 v[104:107],v[128:131],a[240:243],0
ds_read_b128 v[128:131],v0 offset:18560
v_fma_f32 v76,v76,s36,v13
v_mfma_f32_16x16x32_bf16 v[72:75],v[132:135],a[148:151],v[72:75]
v_fma_f32 v77,v77,s36,v13
v_fma_f32 v78,v78,s36,v13
v_mfma_f32_16x16x32_bf16 v[80:83],v[132:135],a[172:175],v[80:83]
v_fma_f32 v79,v79,s36,v13
v_exp_f32 v76,v76
v_mfma_f32_16x16x32_bf16 v[88:91],v[132:135],a[196:199],v[88:91]
v_exp_f32 v77,v77
v_mfma_f32_16x16x32_bf16 v[96:99],v[132:135],a[220:223],v[96:99]
v_exp_f32 v78,v78
v_mfma_f32_16x16x32_bf16 v[104:107],v[132:135],a[244:247],v[104:107]
s_waitcnt lgkmcnt(2)
ds_read_b128 v[132:135],v1 offset:18560
v_exp_f32 v79,v79
v_mfma_f32_16x16x32_bf16 v[72:75],v[136:139],a[152:155],v[72:75]
v_fma_f32 v84,v84,s36,v14
v_fma_f32 v85,v85,s36,v14
v_mfma_f32_16x16x32_bf16 v[80:83],v[136:139],a[176:179],v[80:83]
v_fma_f32 v86,v86,s36,v14
v_fma_f32 v87,v87,s36,v14
v_mfma_f32_16x16x32_bf16 v[88:91],v[136:139],a[200:203],v[88:91]
s_waitcnt vmcnt(10)
s_barrier
v_mfma_f32_16x16x32_bf16 v[96:99],v[136:139],a[224:227],v[96:99]
v_cvt_pk_bf16_f32 v20,v76,v77
v_cvt_pk_bf16_f32 v21,v78,v79
v_mfma_f32_16x16x32_bf16 v[104:107],v[136:139],a[248:251],v[104:107]
buffer_load_dwordx4 v6,s[4:7],s20 offen offset:0 lds
v_mfma_f32_16x16x32_bf16 v[52:55],v[48:51],v[18:21],0
ds_read_b128 v[136:139],v0 offset:18688
v_exp_f32 v84,v84
v_mfma_f32_16x16x32_bf16 v[72:75],v[140:143],a[156:159],v[72:75]
v_exp_f32 v85,v85
v_mfma_f32_16x16x32_bf16 v[80:83],v[140:143],a[180:183],v[80:83]
v_exp_f32 v86,v86
v_mfma_f32_16x16x32_bf16 v[88:91],v[140:143],a[204:207],v[88:91]
v_exp_f32 v87,v87
v_mfma_f32_16x16x32_bf16 v[96:99],v[140:143],a[228:231],v[96:99]
buffer_load_dwordx4 v7,s[4:7],s20 offen offset:1024 lds
v_mfma_f32_16x16x32_bf16 v[104:107],v[140:143],a[252:255],v[104:107]
ds_read_b128 v[140:143],v1 offset:18688
v_fma_f32 v92,v92,s36,v15
v_mfma_f32_16x16x32_bf16 v[72:75],v[112:115],a[160:163],v[72:75]
v_fma_f32 v93,v93,s36,v15
v_fma_f32 v94,v94,s36,v15
v_mfma_f32_16x16x32_bf16 v[80:83],v[112:115],a[184:187],v[80:83]
v_fma_f32 v95,v95,s36,v15
v_cvt_pk_bf16_f32 v26,v84,v85
v_mfma_f32_16x16x32_bf16 v[88:91],v[112:115],a[208:211],v[88:91]
v_cvt_pk_bf16_f32 v27,v86,v87
v_exp_f32 v92,v92
v_mfma_f32_16x16x32_bf16 v[96:99],v[112:115],a[232:235],v[96:99]
v_exp_f32 v93,v93
v_mfma_f32_16x16x32_bf16 v[56:59],v[48:51],v[24:27],0
buffer_load_dwordx4 v8,s[4:7],s20 offen offset:2048 lds
v_mfma_f32_16x16x32_bf16 v[104:107],v[112:115],v[144:147],v[104:107]
s_add_u32 s20,s20,12288
ds_read_b64_tr_b16 v[112:113],v2 offset:0
ds_read_b64_tr_b16 v[114:115],v2 offset:6144
v_mfma_f32_16x16x32_bf16 v[72:75],v[116:119],a[164:167],v[72:75]
v_exp_f32 v94,v94
v_mfma_f32_16x16x32_bf16 v[80:83],v[116:119],a[188:191],v[80:83]
v_exp_f32 v95,v95
v_mfma_f32_16x16x32_bf16 v[88:91],v[116:119],a[212:215],v[88:91]
v_fma_f32 v100,v100,s36,v16
v_fma_f32 v101,v101,s36,v16
v_mfma_f32_16x16x32_bf16 v[96:99],v[116:119],a[236:239],v[96:99]
v_fma_f32 v102,v102,s36,v16
v_fma_f32 v103,v103,s36,v16
v_mfma_f32_16x16x32_bf16 v[104:107],v[116:119],v[148:151],v[104:107]
ds_read_b64_tr_b16 v[116:117],v3 offset:0
ds_read_b64_tr_b16 v[118:119],v3 offset:6144
v_mfma_f32_16x16x32_bf16 v[76:79],v[120:123],a[144:147],0
v_cvt_pk_bf16_f32 v32,v92,v93
v_cvt_pk_bf16_f32 v33,v94,v95
v_mfma_f32_16x16x32_bf16 v[84:87],v[120:123],a[168:171],0
v_exp_f32 v100,v100
v_mfma_f32_16x16x32_bf16 v[60:63],v[48:51],v[30:33],0
v_exp_f32 v101,v101
v_mfma_f32_16x16x32_bf16 v[92:95],v[120:123],a[192:195],0
v_exp_f32 v102,v102
v_exp_f32 v103,v103
v_fma_f32 v108,v108,s36,v17
v_fma_f32 v109,v109,s36,v17
v_fma_f32 v110,v110,s36,v17
v_fma_f32 v111,v111,s36,v17
v_cvt_pk_bf16_f32 v38,v100,v101
v_cvt_pk_bf16_f32 v39,v102,v103
v_mfma_f32_16x16x32_bf16 v[100:103],v[120:123],a[216:219],0
v_exp_f32 v108,v108
v_mfma_f32_16x16x32_bf16 v[64:67],v[48:51],v[36:39],0
v_exp_f32 v109,v109
v_exp_f32 v110,v110
v_exp_f32 v111,v111
v_cvt_pk_bf16_f32 v44,v108,v109
v_cvt_pk_bf16_f32 v45,v110,v111
v_mfma_f32_16x16x32_bf16 v[108:111],v[120:123],a[240:243],0
ds_read_b64_tr_b16 v[120:121],v4 offset:0
ds_read_b64_tr_b16 v[122:123],v4 offset:6144
v_mfma_f32_16x16x32_bf16 v[68:71],v[48:51],v[42:45],0
v_fma_f32 v72,v72,s36,v13
v_fma_f32 v73,v73,s36,v13
v_mfma_f32_16x16x32_bf16 v[76:79],v[124:127],a[148:151],v[76:79]
v_fma_f32 v74,v74,s36,v13
v_fma_f32 v75,v75,s36,v13
v_mfma_f32_16x16x32_bf16 v[84:87],v[124:127],a[172:175],v[84:87]
v_fma_f32 v80,v80,s36,v14
v_fma_f32 v81,v81,s36,v14
v_mfma_f32_16x16x32_bf16 v[92:95],v[124:127],a[196:199],v[92:95]
v_fma_f32 v82,v82,s36,v14
v_fma_f32 v83,v83,s36,v14
v_mfma_f32_16x16x32_bf16 v[100:103],v[124:127],a[220:223],v[100:103]
v_fma_f32 v88,v88,s36,v15
v_fma_f32 v89,v89,s36,v15
v_mfma_f32_16x16x32_bf16 v[108:111],v[124:127],a[244:247],v[108:111]
s_waitcnt lgkmcnt(2)
ds_read_b64_tr_b16 v[124:125],v5 offset:0
ds_read_b64_tr_b16 v[126:127],v5 offset:6144
v_mfma_f32_16x16x32_bf16 v[76:79],v[128:131],a[152:155],v[76:79]
v_exp_f32 v72,v72
v_mfma_f32_16x16x32_bf16 v[84:87],v[128:131],a[176:179],v[84:87]
v_exp_f32 v73,v73
v_mfma_f32_16x16x32_bf16 v[92:95],v[128:131],a[200:203],v[92:95]
v_exp_f32 v74,v74
v_mfma_f32_16x16x32_bf16 v[100:103],v[128:131],a[224:227],v[100:103]
v_exp_f32 v75,v75
v_mfma_f32_16x16x32_bf16 v[108:111],v[128:131],a[248:251],v[108:111]
v_exp_f32 v80,v80
v_mfma_f32_16x16x32_bf16 v[76:79],v[132:135],a[156:159],v[76:79]
v_exp_f32 v81,v81
v_mfma_f32_16x16x32_bf16 v[84:87],v[132:135],a[180:183],v[84:87]
v_exp_f32 v82,v82
v_mfma_f32_16x16x32_bf16 v[92:95],v[132:135],a[204:207],v[92:95]
v_exp_f32 v83,v83
v_mfma_f32_16x16x32_bf16 v[100:103],v[132:135],a[228:231],v[100:103]
v_exp_f32 v88,v88
v_mfma_f32_16x16x32_bf16 v[108:111],v[132:135],a[252:255],v[108:111]
v_exp_f32 v89,v89
v_mfma_f32_16x16x32_bf16 v[76:79],v[136:139],a[160:163],v[76:79]
v_cvt_pk_bf16_f32 v22,v72,v73
v_cvt_pk_bf16_f32 v23,v74,v75
v_mfma_f32_16x16x32_bf16 v[84:87],v[136:139],a[184:187],v[84:87]
v_cvt_pk_bf16_f32 v28,v80,v81
v_cvt_pk_bf16_f32 v29,v82,v83
v_mfma_f32_16x16x32_bf16 v[92:95],v[136:139],a[208:211],v[92:95]
v_cvt_pk_bf16_f32 v34,v88,v89
v_mfma_f32_16x16x32_bf16 v[100:103],v[136:139],a[232:235],v[100:103]
v_mfma_f32_16x16x32_bf16 v[108:111],v[136:139],v[144:147],v[108:111]
v_mfma_f32_16x16x32_bf16 v[76:79],v[140:143],a[164:167],v[76:79]
v_mfma_f32_16x16x32_bf16 v[84:87],v[140:143],a[188:191],v[84:87]
v_mfma_f32_16x16x32_bf16 v[92:95],v[140:143],a[212:215],v[92:95]
v_mfma_f32_16x16x32_bf16 v[100:103],v[140:143],a[236:239],v[100:103]
v_mfma_f32_16x16x32_bf16 v[108:111],v[140:143],v[148:151],v[108:111]
v_mfma_f32_16x16x32_bf16 v[160:163],v[112:115],v[18:21],0
s_add_u32 m0,s23,0
ds_read_b64_tr_b16 v[128:129],v2 offset:128
ds_read_b64_tr_b16 v[130:131],v2 offset:6272
v_mfma_f32_16x16x32_bf16 v[208:211],v[112:115],v[24:27],0
ds_read_b64_tr_b16 v[132:133],v3 offset:128
ds_read_b64_tr_b16 v[134:135],v3 offset:6272
v_mfma_f32_16x16x32_bf16 a[0:3],v[112:115],v[30:33],0
ds_read_b64_tr_b16 v[136:137],v4 offset:128
ds_read_b64_tr_b16 v[138:139],v4 offset:6272
v_mfma_f32_16x16x32_bf16 a[48:51],v[112:115],v[36:39],0
ds_read_b64_tr_b16 v[140:141],v5 offset:128
ds_read_b64_tr_b16 v[142:143],v5 offset:6272
v_mfma_f32_16x16x32_bf16 a[96:99],v[112:115],v[42:45],0
ds_read_b64_tr_b16 v[112:113],v2 offset:256
ds_read_b64_tr_b16 v[114:115],v2 offset:6400
v_mfma_f32_16x16x32_bf16 v[164:167],v[116:119],v[18:21],0
v_fma_f32 v90,v90,s36,v15
v_fma_f32 v91,v91,s36,v15
v_mfma_f32_16x16x32_bf16 v[212:215],v[116:119],v[24:27],0
v_exp_f32 v90,v90
v_mfma_f32_16x16x32_bf16 a[4:7],v[116:119],v[30:33],0
v_exp_f32 v91,v91
v_mfma_f32_16x16x32_bf16 a[52:55],v[116:119],v[36:39],0
v_cvt_pk_bf16_f32 v35,v90,v91
v_fma_f32 v96,v96,s36,v16
v_mfma_f32_16x16x32_bf16 a[100:103],v[116:119],v[42:45],0
s_waitcnt lgkmcnt(8)
ds_read_b64_tr_b16 v[116:117],v3 offset:256
ds_read_b64_tr_b16 v[118:119],v3 offset:6400
v_mfma_f32_16x16x32_bf16 v[168:171],v[120:123],v[18:21],0
v_fma_f32 v97,v97,s36,v16
v_fma_f32 v98,v98,s36,v16
v_mfma_f32_16x16x32_bf16 v[216:219],v[120:123],v[24:27],0
v_fma_f32 v99,v99,s36,v16
v_fma_f32 v104,v104,s36,v17
v_mfma_f32_16x16x32_bf16 a[8:11],v[120:123],v[30:33],0
v_exp_f32 v96,v96
v_mfma_f32_16x16x32_bf16 a[56:59],v[120:123],v[36:39],0
v_exp_f32 v97,v97
v_mfma_f32_16x16x32_bf16 a[104:107],v[120:123],v[42:45],0
ds_read_b64_tr_b16 v[120:121],v4 offset:256
ds_read_b64_tr_b16 v[122:123],v4 offset:6400
v_mfma_f32_16x16x32_bf16 v[172:175],v[124:127],v[18:21],0
v_exp_f32 v98,v98
v_mfma_f32_16x16x32_bf16 v[220:223],v[124:127],v[24:27],0
v_exp_f32 v99,v99
v_mfma_f32_16x16x32_bf16 a[12:15],v[124:127],v[30:33],0
v_cvt_pk_bf16_f32 v40,v96,v97
v_cvt_pk_bf16_f32 v41,v98,v99
v_mfma_f32_16x16x32_bf16 a[60:63],v[124:127],v[36:39],0
v_fma_f32 v105,v105,s36,v17
v_fma_f32 v106,v106,s36,v17
v_mfma_f32_16x16x32_bf16 a[108:111],v[124:127],v[42:45],0
ds_read_b64_tr_b16 v[124:125],v5 offset:256
ds_read_b64_tr_b16 v[126:127],v5 offset:6400
v_mfma_f32_16x16x32_bf16 v[176:179],v[128:131],v[18:21],0
v_fma_f32 v107,v107,s36,v17
v_fma_f32 v76,v76,s36,v13
v_mfma_f32_16x16x32_bf16 v[224:227],v[128:131],v[24:27],0
v_exp_f32 v104,v104
v_mfma_f32_16x16x32_bf16 a[16:19],v[128:131],v[30:33],0
v_exp_f32 v105,v105
v_mfma_f32_16x16x32_bf16 a[64:67],v[128:131],v[36:39],0
v_exp_f32 v106,v106
v_mfma_f32_16x16x32_bf16 a[112:115],v[128:131],v[42:45],0
s_waitcnt lgkmcnt(2)
v_exp_f32 v107,v107
v_mfma_f32_16x16x32_bf16 v[180:183],v[132:135],v[18:21],0
v_cvt_pk_bf16_f32 v46,v104,v105
v_cvt_pk_bf16_f32 v47,v106,v107
v_mfma_f32_16x16x32_bf16 v[228:231],v[132:135],v[24:27],0
v_fma_f32 v77,v77,s36,v13
v_fma_f32 v78,v78,s36,v13
v_mfma_f32_16x16x32_bf16 a[20:23],v[132:135],v[30:33],0
v_fma_f32 v79,v79,s36,v13
v_fma_f32 v84,v84,s36,v14
v_mfma_f32_16x16x32_bf16 a[68:71],v[132:135],v[36:39],0
v_exp_f32 v76,v76
v_mfma_f32_16x16x32_bf16 a[116:119],v[132:135],v[42:45],0
v_exp_f32 v77,v77
v_mfma_f32_16x16x32_bf16 v[184:187],v[136:139],v[18:21],0
v_exp_f32 v78,v78
v_mfma_f32_16x16x32_bf16 v[232:235],v[136:139],v[24:27],0
v_exp_f32 v79,v79
v_mfma_f32_16x16x32_bf16 a[24:27],v[136:139],v[30:33],0
v_fma_f32 v85,v85,s36,v14
v_fma_f32 v86,v86,s36,v14
v_mfma_f32_16x16x32_bf16 a[72:75],v[136:139],v[36:39],0
v_fma_f32 v87,v87,s36,v14
v_fma_f32 v92,v92,s36,v15
v_mfma_f32_16x16x32_bf16 a[120:123],v[136:139],v[42:45],0
v_exp_f32 v84,v84
v_mfma_f32_16x16x32_bf16 v[188:191],v[140:143],v[18:21],0
v_exp_f32 v85,v85
v_mfma_f32_16x16x32_bf16 v[236:239],v[140:143],v[24:27],0
v_exp_f32 v86,v86
v_mfma_f32_16x16x32_bf16 a[28:31],v[140:143],v[30:33],0
v_exp_f32 v87,v87
v_mfma_f32_16x16x32_bf16 a[76:79],v[140:143],v[36:39],0
v_fma_f32 v93,v93,s36,v15
v_fma_f32 v94,v94,s36,v15
v_mfma_f32_16x16x32_bf16 a[124:127],v[140:143],v[42:45],0
v_fma_f32 v95,v95,s36,v15
v_fma_f32 v100,v100,s36,v16
v_mfma_f32_16x16x32_bf16 v[192:195],v[112:115],v[18:21],0
v_exp_f32 v92,v92
v_mfma_f32_16x16x32_bf16 v[240:243],v[112:115],v[24:27],0
v_exp_f32 v93,v93
s_waitcnt vmcnt(36) lgkmcnt(0)
v_mfma_f32_16x16x32_bf16 a[32:35],v[112:115],v[30:33],0
s_barrier
v_mfma_f32_16x16x32_bf16 a[80:83],v[112:115],v[36:39],0
ds_read_b128 v[128:131],v0 offset:24576
v_fma_f32 v101,v101,s36,v16
v_mfma_f32_16x16x32_bf16 a[128:131],v[112:115],v[42:45],0
ds_read_b128 v[132:135],v1 offset:24576
v_fma_f32 v102,v102,s36,v16
v_mfma_f32_16x16x32_bf16 v[196:199],v[116:119],v[18:21],0
ds_read_b128 v[136:139],v0 offset:24704
v_fma_f32 v103,v103,s36,v16
v_mfma_f32_16x16x32_bf16 v[244:247],v[116:119],v[24:27],0
ds_read_b128 v[140:143],v1 offset:24704
v_fma_f32 v108,v108,s36,v17
v_mfma_f32_16x16x32_bf16 a[36:39],v[116:119],v[30:33],0
ds_read_b128 v[112:115],v0 offset:24832
v_fma_f32 v109,v109,s36,v17
v_mfma_f32_16x16x32_bf16 a[84:87],v[116:119],v[36:39],0
buffer_load_dwordx4 v6,s[8:11],s21 offen offset:0 lds
v_mfma_f32_16x16x32_bf16 a[132:135],v[116:119],v[42:45],0
ds_read_b128 v[116:119],v1 offset:24832
v_fma_f32 v110,v110,s36,v17
v_mfma_f32_16x16x32_bf16 v[200:203],v[120:123],v[18:21],0
v_exp_f32 v94,v94
v_mfma_f32_16x16x32_bf16 v[248:251],v[120:123],v[24:27],0
v_exp_f32 v95,v95
v_mfma_f32_16x16x32_bf16 a[40:43],v[120:123],v[30:33],0
v_exp_f32 v100,v100
v_mfma_f32_16x16x32_bf16 a[88:91],v[120:123],v[36:39],0
v_exp_f32 v101,v101
v_mfma_f32_16x16x32_bf16 a[136:139],v[120:123],v[42:45],0
ds_read_b128 v[120:123],v0 offset:30720
v_fma_f32 v111,v111,s36,v17
v_mfma_f32_16x16x32_bf16 v[204:207],v[124:127],v[18:21],0
v_cvt_pk_bf16_f32 v20,v76,v77
v_cvt_pk_bf16_f32 v21,v78,v79
v_mfma_f32_16x16x32_bf16 v[252:255],v[124:127],v[24:27],0
v_cvt_pk_bf16_f32 v26,v84,v85
v_cvt_pk_bf16_f32 v27,v86,v87
v_mfma_f32_16x16x32_bf16 v[52:55],v[48:51],v[20:23],v[52:55]
v_exp_f32 v102,v102
v_mfma_f32_16x16x32_bf16 v[56:59],v[48:51],v[26:29],v[56:59]
v_exp_f32 v103,v103
v_mfma_f32_16x16x32_bf16 a[44:47],v[124:127],v[30:33],0
v_cvt_pk_bf16_f32 v32,v92,v93
v_cvt_pk_bf16_f32 v33,v94,v95
v_mfma_f32_16x16x32_bf16 a[92:95],v[124:127],v[36:39],0
buffer_load_dwordx4 v7,s[8:11],s21 offen offset:1024 lds
v_mfma_f32_16x16x32_bf16 v[60:63],v[48:51],v[32:35],v[60:63]
v_cvt_pk_bf16_f32 v38,v100,v101
v_cvt_pk_bf16_f32 v39,v102,v103
v_mfma_f32_16x16x32_bf16 a[140:143],v[124:127],v[42:45],0
ds_read_b128 v[124:127],v1 offset:30720
v_mfma_f32_16x16x32_bf16 v[64:67],v[48:51],v[38:41],v[64:67]
s_waitcnt lgkmcnt(1)
v_exp_f32 v108,v108
v_mfma_f32_16x16x32_bf16 v[72:75],v[128:131],a[144:147],0
v_exp_f32 v109,v109
v_mfma_f32_16x16x32_bf16 v[80:83],v[128:131],a[168:171],0
v_exp_f32 v110,v110
v_mfma_f32_16x16x32_bf16 v[88:91],v[128:131],a[192:195],0
v_exp_f32 v111,v111
v_mfma_f32_16x16x32_bf16 v[96:99],v[128:131],a[216:219],0
v_cvt_pk_bf16_f32 v44,v108,v109
v_cvt_pk_bf16_f32 v45,v110,v111
v_mfma_f32_16x16x32_bf16 v[104:107],v[128:131],a[240:243],0
ds_read_b128 v[128:131],v0 offset:30848
v_mfma_f32_16x16x32_bf16 v[68:71],v[48:51],v[44:47],v[68:71]
v_mfma_f32_16x16x32_bf16 v[72:75],v[132:135],a[148:151],v[72:75]
v_mfma_f32_16x16x32_bf16 v[80:83],v[132:135],a[172:175],v[80:83]
buffer_load_dwordx4 v8,s[8:11],s21 offen offset:2048 lds
v_mfma_f32_16x16x32_bf16 v[88:91],v[132:135],a[196:199],v[88:91]
s_add_u32 s21,s21,12288
v_mfma_f32_16x16x32_bf16 v[96:99],v[132:135],a[220:223],v[96:99]
s_add_u32 m0,s22,12288
v_mfma_f32_16x16x32_bf16 v[104:107],v[132:135],a[244:247],v[104:107]
ds_read_b128 v[132:135],v1 offset:30848
v_mfma_f32_16x16x32_bf16 v[72:75],v[136:139],a[152:155],v[72:75]
v_mfma_f32_16x16x32_bf16 v[80:83],v[136:139],a[176:179],v[80:83]
v_mfma_f32_16x16x32_bf16 v[88:91],v[136:139],a[200:203],v[88:91]
v_mfma_f32_16x16x32_bf16 v[96:99],v[136:139],a[224:227],v[96:99]
v_mfma_f32_16x16x32_bf16 v[104:107],v[136:139],a[248:251],v[104:107]
ds_read_b128 v[136:139],v0 offset:30976
v_mfma_f32_16x16x32_bf16 v[72:75],v[140:143],a[156:159],v[72:75]
v_mfma_f32_16x16x32_bf16 v[80:83],v[140:143],a[180:183],v[80:83]
v_mfma_f32_16x16x32_bf16 v[88:91],v[140:143],a[204:207],v[88:91]
buffer_load_dwordx4 v6,s[4:7],s20 offen offset:0 lds
v_mfma_f32_16x16x32_bf16 v[96:99],v[140:143],a[228:231],v[96:99]
v_mfma_f32_16x16x32_bf16 v[104:107],v[140:143],a[252:255],v[104:107]
ds_read_b128 v[140:143],v1 offset:30976
v_mfma_f32_16x16x32_bf16 v[72:75],v[112:115],a[160:163],v[72:75]
v_mfma_f32_16x16x32_bf16 v[80:83],v[112:115],a[184:187],v[80:83]
v_mfma_f32_16x16x32_bf16 v[88:91],v[112:115],a[208:211],v[88:91]
v_mfma_f32_16x16x32_bf16 v[96:99],v[112:115],a[232:235],v[96:99]
v_mfma_f32_16x16x32_bf16 v[104:107],v[112:115],v[144:147],v[104:107]
v_mfma_f32_16x16x32_bf16 v[72:75],v[116:119],a[164:167],v[72:75]
v_mfma_f32_16x16x32_bf16 v[80:83],v[116:119],a[188:191],v[80:83]
v_mfma_f32_16x16x32_bf16 v[88:91],v[116:119],a[212:215],v[88:91]
v_mfma_f32_16x16x32_bf16 v[96:99],v[116:119],a[236:239],v[96:99]
v_mfma_f32_16x16x32_bf16 v[104:107],v[116:119],v[148:151],v[104:107]
buffer_load_dwordx4 v7,s[4:7],s20 offen offset:1024 lds
v_mfma_f32_16x16x32_bf16 v[76:79],v[120:123],a[144:147],0
v_mfma_f32_16x16x32_bf16 v[84:87],v[120:123],a[168:171],0
v_mfma_f32_16x16x32_bf16 v[92:95],v[120:123],a[192:195],0
v_fma_f32 v72,v72,s36,v13
v_fma_f32 v73,v73,s36,v13
v_mfma_f32_16x16x32_bf16 v[100:103],v[120:123],a[216:219],0
v_fma_f32 v74,v74,s36,v13
v_fma_f32 v75,v75,s36,v13
v_mfma_f32_16x16x32_bf16 v[108:111],v[120:123],a[240:243],0
s_waitcnt lgkmcnt(0)
v_fma_f32 v80,v80,s36,v14
v_fma_f32 v81,v81,s36,v14
v_mfma_f32_16x16x32_bf16 v[76:79],v[124:127],a[148:151],v[76:79]
v_fma_f32 v82,v82,s36,v14
v_fma_f32 v83,v83,s36,v14
v_mfma_f32_16x16x32_bf16 v[84:87],v[124:127],a[172:175],v[84:87]
v_fma_f32 v88,v88,s36,v15
v_fma_f32 v89,v89,s36,v15
v_mfma_f32_16x16x32_bf16 v[92:95],v[124:127],a[196:199],v[92:95]
v_exp_f32 v72,v72
v_mfma_f32_16x16x32_bf16 v[100:103],v[124:127],a[220:223],v[100:103]
v_exp_f32 v73,v73
v_mfma_f32_16x16x32_bf16 v[108:111],v[124:127],a[244:247],v[108:111]
v_exp_f32 v74,v74
v_mfma_f32_16x16x32_bf16 v[76:79],v[128:131],a[152:155],v[76:79]
buffer_load_dwordx4 v8,s[4:7],s20 offen offset:2048 lds
v_mfma_f32_16x16x32_bf16 v[84:87],v[128:131],a[176:179],v[84:87]
s_add_u32 s20,s20,12288
v_exp_f32 v75,v75
v_mfma_f32_16x16x32_bf16 v[92:95],v[128:131],a[200:203],v[92:95]
v_exp_f32 v80,v80
v_mfma_f32_16x16x32_bf16 v[100:103],v[128:131],a[224:227],v[100:103]
v_exp_f32 v81,v81
v_mfma_f32_16x16x32_bf16 v[108:111],v[128:131],a[248:251],v[108:111]
v_exp_f32 v82,v82
v_mfma_f32_16x16x32_bf16 v[76:79],v[132:135],a[156:159],v[76:79]
ds_read_b64_tr_b16 v[112:113],v2 offset:18432
v_mfma_f32_16x16x32_bf16 v[84:87],v[132:135],a[180:183],v[84:87]
ds_read_b64_tr_b16 v[114:115],v2 offset:12288
v_cvt_pk_bf16_f32 v18,v72,v73
v_mfma_f32_16x16x32_bf16 v[92:95],v[132:135],a[204:207],v[92:95]
v_exp_f32 v83,v83
v_mfma_f32_16x16x32_bf16 v[100:103],v[132:135],a[228:231],v[100:103]
ds_read_b64_tr_b16 v[116:117],v3 offset:18432
ds_read_b64_tr_b16 v[118:119],v3 offset:12288
v_mfma_f32_16x16x32_bf16 v[108:111],v[132:135],a[252:255],v[108:111]
v_exp_f32 v88,v88
v_mfma_f32_16x16x32_bf16 v[76:79],v[136:139],a[160:163],v[76:79]
ds_read_b64_tr_b16 v[120:121],v4 offset:18432
v_mfma_f32_16x16x32_bf16 v[84:87],v[136:139],a[184:187],v[84:87]
ds_read_b64_tr_b16 v[122:123],v4 offset:12288
v_cvt_pk_bf16_f32 v19,v74,v75
v_mfma_f32_16x16x32_bf16 v[92:95],v[136:139],a[208:211],v[92:95]
v_exp_f32 v89,v89
v_mfma_f32_16x16x32_bf16 v[100:103],v[136:139],a[232:235],v[100:103]
ds_read_b64_tr_b16 v[124:125],v5 offset:18432
ds_read_b64_tr_b16 v[126:127],v5 offset:12288
v_mfma_f32_16x16x32_bf16 v[108:111],v[136:139],v[144:147],v[108:111]
v_cvt_pk_bf16_f32 v24,v80,v81
v_cvt_pk_bf16_f32 v25,v82,v83
v_mfma_f32_16x16x32_bf16 v[76:79],v[140:143],a[164:167],v[76:79]
v_cvt_pk_bf16_f32 v30,v88,v89
v_mfma_f32_16x16x32_bf16 v[84:87],v[140:143],a[188:191],v[84:87]
v_mfma_f32_16x16x32_bf16 v[92:95],v[140:143],a[212:215],v[92:95]
v_mfma_f32_16x16x32_bf16 v[100:103],v[140:143],a[236:239],v[100:103]
v_mfma_f32_16x16x32_bf16 v[108:111],v[140:143],v[148:151],v[108:111]
s_waitcnt lgkmcnt(3)
v_mfma_f32_16x16x32_bf16 v[160:163],v[112:115],v[20:23],v[160:163]
s_add_u32 m0,s23,12288
ds_read_b64_tr_b16 v[128:129],v2 offset:18560
ds_read_b64_tr_b16 v[130:131],v2 offset:12416
v_mfma_f32_16x16x32_bf16 v[208:211],v[112:115],v[26:29],v[208:211]
ds_read_b64_tr_b16 v[132:133],v3 offset:18560
ds_read_b64_tr_b16 v[134:135],v3 offset:12416
v_mfma_f32_16x16x32_bf16 a[0:3],v[112:115],v[32:35],a[0:3]
ds_read_b64_tr_b16 v[136:137],v4 offset:18560
ds_read_b64_tr_b16 v[138:139],v4 offset:12416
v_mfma_f32_16x16x32_bf16 a[48:51],v[112:115],v[38:41],a[48:51]
ds_read_b64_tr_b16 v[140:141],v5 offset:18560
ds_read_b64_tr_b16 v[142:143],v5 offset:12416
v_mfma_f32_16x16x32_bf16 a[96:99],v[112:115],v[44:47],a[96:99]
ds_read_b64_tr_b16 v[112:113],v2 offset:18688
ds_read_b64_tr_b16 v[114:115],v2 offset:12544
v_mfma_f32_16x16x32_bf16 v[164:167],v[116:119],v[20:23],v[164:167]
v_fma_f32 v90,v90,s36,v15
v_fma_f32 v91,v91,s36,v15
v_mfma_f32_16x16x32_bf16 v[212:215],v[116:119],v[26:29],v[212:215]
v_exp_f32 v90,v90
v_mfma_f32_16x16x32_bf16 a[4:7],v[116:119],v[32:35],a[4:7]
v_exp_f32 v91,v91
v_mfma_f32_16x16x32_bf16 a[52:55],v[116:119],v[38:41],a[52:55]
v_cvt_pk_bf16_f32 v31,v90,v91
v_fma_f32 v96,v96,s36,v16
v_mfma_f32_16x16x32_bf16 a[100:103],v[116:119],v[44:47],a[100:103]
s_waitcnt lgkmcnt(8)
ds_read_b64_tr_b16 v[116:117],v3 offset:18688
ds_read_b64_tr_b16 v[118:119],v3 offset:12544
v_mfma_f32_16x16x32_bf16 v[168:171],v[120:123],v[20:23],v[168:171]
v_fma_f32 v97,v97,s36,v16
v_fma_f32 v98,v98,s36,v16
v_mfma_f32_16x16x32_bf16 v[216:219],v[120:123],v[26:29],v[216:219]
v_fma_f32 v99,v99,s36,v16
v_fma_f32 v104,v104,s36,v17
v_mfma_f32_16x16x32_bf16 a[8:11],v[120:123],v[32:35],a[8:11]
v_exp_f32 v96,v96
v_mfma_f32_16x16x32_bf16 a[56:59],v[120:123],v[38:41],a[56:59]
v_exp_f32 v97,v97
v_mfma_f32_16x16x32_bf16 a[104:107],v[120:123],v[44:47],a[104:107]
ds_read_b64_tr_b16 v[120:121],v4 offset:18688
ds_read_b64_tr_b16 v[122:123],v4 offset:12544
v_mfma_f32_16x16x32_bf16 v[172:175],v[124:127],v[20:23],v[172:175]
v_exp_f32 v98,v98
v_mfma_f32_16x16x32_bf16 v[220:223],v[124:127],v[26:29],v[220:223]
v_exp_f32 v99,v99
v_mfma_f32_16x16x32_bf16 a[12:15],v[124:127],v[32:35],a[12:15]
v_cvt_pk_bf16_f32 v36,v96,v97
v_cvt_pk_bf16_f32 v37,v98,v99
v_mfma_f32_16x16x32_bf16 a[60:63],v[124:127],v[38:41],a[60:63]
v_fma_f32 v105,v105,s36,v17
v_fma_f32 v106,v106,s36,v17
v_mfma_f32_16x16x32_bf16 a[108:111],v[124:127],v[44:47],a[108:111]
ds_read_b64_tr_b16 v[124:125],v5 offset:18688
ds_read_b64_tr_b16 v[126:127],v5 offset:12544
v_mfma_f32_16x16x32_bf16 v[176:179],v[128:131],v[20:23],v[176:179]
v_fma_f32 v107,v107,s36,v17
v_fma_f32 v76,v76,s36,v13
v_mfma_f32_16x16x32_bf16 v[224:227],v[128:131],v[26:29],v[224:227]
v_exp_f32 v104,v104
v_mfma_f32_16x16x32_bf16 a[16:19],v[128:131],v[32:35],a[16:19]
v_exp_f32 v105,v105
v_mfma_f32_16x16x32_bf16 a[64:67],v[128:131],v[38:41],a[64:67]
v_exp_f32 v106,v106
v_mfma_f32_16x16x32_bf16 a[112:115],v[128:131],v[44:47],a[112:115]
s_waitcnt lgkmcnt(2)
v_exp_f32 v107,v107
v_mfma_f32_16x16x32_bf16 v[180:183],v[132:135],v[20:23],v[180:183]
v_cvt_pk_bf16_f32 v42,v104,v105
v_cvt_pk_bf16_f32 v43,v106,v107
v_mfma_f32_16x16x32_bf16 v[228:231],v[132:135],v[26:29],v[228:231]
v_fma_f32 v77,v77,s36,v13
v_fma_f32 v78,v78,s36,v13
v_mfma_f32_16x16x32_bf16 a[20:23],v[132:135],v[32:35],a[20:23]
v_fma_f32 v79,v79,s36,v13
v_fma_f32 v84,v84,s36,v14
v_mfma_f32_16x16x32_bf16 a[68:71],v[132:135],v[38:41],a[68:71]
v_exp_f32 v76,v76
v_mfma_f32_16x16x32_bf16 a[116:119],v[132:135],v[44:47],a[116:119]
v_exp_f32 v77,v77
v_mfma_f32_16x16x32_bf16 v[184:187],v[136:139],v[20:23],v[184:187]
v_exp_f32 v78,v78
v_mfma_f32_16x16x32_bf16 v[232:235],v[136:139],v[26:29],v[232:235]
v_exp_f32 v79,v79
v_mfma_f32_16x16x32_bf16 a[24:27],v[136:139],v[32:35],a[24:27]
v_fma_f32 v85,v85,s36,v14
v_fma_f32 v86,v86,s36,v14
v_mfma_f32_16x16x32_bf16 a[72:75],v[136:139],v[38:41],a[72:75]
v_fma_f32 v87,v87,s36,v14
v_fma_f32 v92,v92,s36,v15
v_mfma_f32_16x16x32_bf16 a[120:123],v[136:139],v[44:47],a[120:123]
v_exp_f32 v84,v84
v_mfma_f32_16x16x32_bf16 v[188:191],v[140:143],v[20:23],v[188:191]
v_exp_f32 v85,v85
v_mfma_f32_16x16x32_bf16 v[236:239],v[140:143],v[26:29],v[236:239]
v_exp_f32 v86,v86
v_mfma_f32_16x16x32_bf16 a[28:31],v[140:143],v[32:35],a[28:31]
v_exp_f32 v87,v87
v_mfma_f32_16x16x32_bf16 a[76:79],v[140:143],v[38:41],a[76:79]
v_fma_f32 v93,v93,s36,v15
v_fma_f32 v94,v94,s36,v15
v_mfma_f32_16x16x32_bf16 a[124:127],v[140:143],v[44:47],a[124:127]
v_fma_f32 v95,v95,s36,v15
v_fma_f32 v100,v100,s36,v16
v_mfma_f32_16x16x32_bf16 v[192:195],v[112:115],v[20:23],v[192:195]
v_exp_f32 v92,v92
v_mfma_f32_16x16x32_bf16 v[240:243],v[112:115],v[26:29],v[240:243]
v_exp_f32 v93,v93
s_waitcnt vmcnt(6) lgkmcnt(0)
v_mfma_f32_16x16x32_bf16 a[32:35],v[112:115],v[32:35],a[32:35]
s_barrier
v_mfma_f32_16x16x32_bf16 a[80:83],v[112:115],v[38:41],a[80:83]
ds_read_b128 v[128:131],v0 offset:0
v_fma_f32 v101,v101,s36,v16
v_mfma_f32_16x16x32_bf16 a[128:131],v[112:115],v[44:47],a[128:131]
ds_read_b128 v[132:135],v1 offset:0
v_fma_f32 v102,v102,s36,v16
v_mfma_f32_16x16x32_bf16 v[196:199],v[116:119],v[20:23],v[196:199]
ds_read_b128 v[136:139],v0 offset:128
v_fma_f32 v103,v103,s36,v16
v_mfma_f32_16x16x32_bf16 v[244:247],v[116:119],v[26:29],v[244:247]
ds_read_b128 v[140:143],v1 offset:128
v_fma_f32 v108,v108,s36,v17
v_mfma_f32_16x16x32_bf16 a[36:39],v[116:119],v[32:35],a[36:39]
ds_read_b128 v[112:115],v0 offset:256
v_fma_f32 v109,v109,s36,v17
v_mfma_f32_16x16x32_bf16 a[84:87],v[116:119],v[38:41],a[84:87]
buffer_load_dwordx4 v6,s[8:11],s21 offen offset:0 lds
v_mfma_f32_16x16x32_bf16 a[132:135],v[116:119],v[44:47],a[132:135]
ds_read_b128 v[116:119],v1 offset:256
v_fma_f32 v110,v110,s36,v17
v_mfma_f32_16x16x32_bf16 v[200:203],v[120:123],v[20:23],v[200:203]
v_exp_f32 v94,v94
v_mfma_f32_16x16x32_bf16 v[248:251],v[120:123],v[26:29],v[248:251]
v_exp_f32 v95,v95
v_mfma_f32_16x16x32_bf16 a[40:43],v[120:123],v[32:35],a[40:43]
v_exp_f32 v100,v100
v_mfma_f32_16x16x32_bf16 a[88:91],v[120:123],v[38:41],a[88:91]
v_exp_f32 v101,v101
v_mfma_f32_16x16x32_bf16 a[136:139],v[120:123],v[44:47],a[136:139]
ds_read_b128 v[120:123],v0 offset:6144
v_fma_f32 v111,v111,s36,v17
v_mfma_f32_16x16x32_bf16 v[204:207],v[124:127],v[20:23],v[204:207]
v_cvt_pk_bf16_f32 v20,v76,v77
v_cvt_pk_bf16_f32 v21,v78,v79
v_mfma_f32_16x16x32_bf16 v[252:255],v[124:127],v[26:29],v[252:255]
v_cvt_pk_bf16_f32 v26,v84,v85
v_cvt_pk_bf16_f32 v27,v86,v87
v_mfma_f32_16x16x32_bf16 v[52:55],v[48:51],v[18:21],v[52:55]
v_exp_f32 v102,v102
v_mfma_f32_16x16x32_bf16 v[56:59],v[48:51],v[24:27],v[56:59]
v_exp_f32 v103,v103
v_mfma_f32_16x16x32_bf16 a[44:47],v[124:127],v[32:35],a[44:47]
v_cvt_pk_bf16_f32 v32,v92,v93
v_cvt_pk_bf16_f32 v33,v94,v95
v_mfma_f32_16x16x32_bf16 a[92:95],v[124:127],v[38:41],a[92:95]
buffer_load_dwordx4 v7,s[8:11],s21 offen offset:1024 lds
v_mfma_f32_16x16x32_bf16 v[60:63],v[48:51],v[30:33],v[60:63]
v_cvt_pk_bf16_f32 v38,v100,v101
v_cvt_pk_bf16_f32 v39,v102,v103
v_mfma_f32_16x16x32_bf16 a[140:143],v[124:127],v[44:47],a[140:143]
ds_read_b128 v[124:127],v1 offset:6144
v_mfma_f32_16x16x32_bf16 v[64:67],v[48:51],v[36:39],v[64:67]
s_waitcnt lgkmcnt(1)
v_exp_f32 v108,v108
v_mfma_f32_16x16x32_bf16 v[72:75],v[128:131],a[144:147],0
v_exp_f32 v109,v109
v_mfma_f32_16x16x32_bf16 v[80:83],v[128:131],a[168:171],0
v_exp_f32 v110,v110
v_mfma_f32_16x16x32_bf16 v[88:91],v[128:131],a[192:195],0
v_exp_f32 v111,v111
v_mfma_f32_16x16x32_bf16 v[96:99],v[128:131],a[216:219],0
v_cvt_pk_bf16_f32 v44,v108,v109
v_cvt_pk_bf16_f32 v45,v110,v111
v_mfma_f32_16x16x32_bf16 v[104:107],v[128:131],a[240:243],0
ds_read_b128 v[128:131],v0 offset:6272
v_mfma_f32_16x16x32_bf16 v[68:71],v[48:51],v[42:45],v[68:71]
v_mfma_f32_16x16x32_bf16 v[72:75],v[132:135],a[148:151],v[72:75]
v_mfma_f32_16x16x32_bf16 v[80:83],v[132:135],a[172:175],v[80:83]
buffer_load_dwordx4 v8,s[8:11],s21 offen offset:2048 lds
v_mfma_f32_16x16x32_bf16 v[88:91],v[132:135],a[196:199],v[88:91]
s_add_u32 s21,s21,12288
v_mfma_f32_16x16x32_bf16 v[96:99],v[132:135],a[220:223],v[96:99]
s_add_u32 m0,s22,24576
v_mfma_f32_16x16x32_bf16 v[104:107],v[132:135],a[244:247],v[104:107]
ds_read_b128 v[132:135],v1 offset:6272
v_mfma_f32_16x16x32_bf16 v[72:75],v[136:139],a[152:155],v[72:75]
v_mfma_f32_16x16x32_bf16 v[80:83],v[136:139],a[176:179],v[80:83]
v_mfma_f32_16x16x32_bf16 v[88:91],v[136:139],a[200:203],v[88:91]
v_mfma_f32_16x16x32_bf16 v[96:99],v[136:139],a[224:227],v[96:99]
v_mfma_f32_16x16x32_bf16 v[104:107],v[136:139],a[248:251],v[104:107]
ds_read_b128 v[136:139],v0 offset:6400
v_mfma_f32_16x16x32_bf16 v[72:75],v[140:143],a[156:159],v[72:75]
v_mfma_f32_16x16x32_bf16 v[80:83],v[140:143],a[180:183],v[80:83]
v_mfma_f32_16x16x32_bf16 v[88:91],v[140:143],a[204:207],v[88:91]
buffer_load_dwordx4 v6,s[4:7],s20 offen offset:0 lds
v_mfma_f32_16x16x32_bf16 v[96:99],v[140:143],a[228:231],v[96:99]
v_mfma_f32_16x16x32_bf16 v[104:107],v[140:143],a[252:255],v[104:107]
ds_read_b128 v[140:143],v1 offset:6400
v_mfma_f32_16x16x32_bf16 v[72:75],v[112:115],a[160:163],v[72:75]
v_mfma_f32_16x16x32_bf16 v[80:83],v[112:115],a[184:187],v[80:83]
v_mfma_f32_16x16x32_bf16 v[88:91],v[112:115],a[208:211],v[88:91]
v_mfma_f32_16x16x32_bf16 v[96:99],v[112:115],a[232:235],v[96:99]
v_mfma_f32_16x16x32_bf16 v[104:107],v[112:115],v[144:147],v[104:107]
v_mfma_f32_16x16x32_bf16 v[72:75],v[116:119],a[164:167],v[72:75]
v_mfma_f32_16x16x32_bf16 v[80:83],v[116:119],a[188:191],v[80:83]
v_mfma_f32_16x16x32_bf16 v[88:91],v[116:119],a[212:215],v[88:91]
v_mfma_f32_16x16x32_bf16 v[96:99],v[116:119],a[236:239],v[96:99]
v_mfma_f32_16x16x32_bf16 v[104:107],v[116:119],v[148:151],v[104:107]
buffer_load_dwordx4 v7,s[4:7],s20 offen offset:1024 lds
v_mfma_f32_16x16x32_bf16 v[76:79],v[120:123],a[144:147],0
v_mfma_f32_16x16x32_bf16 v[84:87],v[120:123],a[168:171],0
v_mfma_f32_16x16x32_bf16 v[92:95],v[120:123],a[192:195],0
v_fma_f32 v72,v72,s36,v13
v_fma_f32 v73,v73,s36,v13
v_mfma_f32_16x16x32_bf16 v[100:103],v[120:123],a[216:219],0
v_fma_f32 v74,v74,s36,v13
v_fma_f32 v75,v75,s36,v13
v_mfma_f32_16x16x32_bf16 v[108:111],v[120:123],a[240:243],0
s_waitcnt lgkmcnt(0)
v_fma_f32 v80,v80,s36,v14
v_fma_f32 v81,v81,s36,v14
v_mfma_f32_16x16x32_bf16 v[76:79],v[124:127],a[148:151],v[76:79]
v_fma_f32 v82,v82,s36,v14
v_fma_f32 v83,v83,s36,v14
v_mfma_f32_16x16x32_bf16 v[84:87],v[124:127],a[172:175],v[84:87]
v_fma_f32 v88,v88,s36,v15
v_fma_f32 v89,v89,s36,v15
v_mfma_f32_16x16x32_bf16 v[92:95],v[124:127],a[196:199],v[92:95]
v_exp_f32 v72,v72
v_mfma_f32_16x16x32_bf16 v[100:103],v[124:127],a[220:223],v[100:103]
v_exp_f32 v73,v73
v_mfma_f32_16x16x32_bf16 v[108:111],v[124:127],a[244:247],v[108:111]
v_exp_f32 v74,v74
v_mfma_f32_16x16x32_bf16 v[76:79],v[128:131],a[152:155],v[76:79]
buffer_load_dwordx4 v8,s[4:7],s20 offen offset:2048 lds
v_mfma_f32_16x16x32_bf16 v[84:87],v[128:131],a[176:179],v[84:87]
s_add_u32 s20,s20,12288
v_exp_f32 v75,v75
v_mfma_f32_16x16x32_bf16 v[92:95],v[128:131],a[200:203],v[92:95]
v_exp_f32 v80,v80
v_mfma_f32_16x16x32_bf16 v[100:103],v[128:131],a[224:227],v[100:103]
v_exp_f32 v81,v81
v_mfma_f32_16x16x32_bf16 v[108:111],v[128:131],a[248:251],v[108:111]
v_exp_f32 v82,v82
v_mfma_f32_16x16x32_bf16 v[76:79],v[132:135],a[156:159],v[76:79]
ds_read_b64_tr_b16 v[112:113],v2 offset:24576
v_mfma_f32_16x16x32_bf16 v[84:87],v[132:135],a[180:183],v[84:87]
ds_read_b64_tr_b16 v[114:115],v2 offset:30720
v_cvt_pk_bf16_f32 v22,v72,v73
v_mfma_f32_16x16x32_bf16 v[92:95],v[132:135],a[204:207],v[92:95]
v_exp_f32 v83,v83
v_mfma_f32_16x16x32_bf16 v[100:103],v[132:135],a[228:231],v[100:103]
ds_read_b64_tr_b16 v[116:117],v3 offset:24576
ds_read_b64_tr_b16 v[118:119],v3 offset:30720
v_mfma_f32_16x16x32_bf16 v[108:111],v[132:135],a[252:255],v[108:111]
v_exp_f32 v88,v88
v_mfma_f32_16x16x32_bf16 v[76:79],v[136:139],a[160:163],v[76:79]
ds_read_b64_tr_b16 v[120:121],v4 offset:24576
v_mfma_f32_16x16x32_bf16 v[84:87],v[136:139],a[184:187],v[84:87]
ds_read_b64_tr_b16 v[122:123],v4 offset:30720
v_cvt_pk_bf16_f32 v23,v74,v75
v_mfma_f32_16x16x32_bf16 v[92:95],v[136:139],a[208:211],v[92:95]
v_exp_f32 v89,v89
v_mfma_f32_16x16x32_bf16 v[100:103],v[136:139],a[232:235],v[100:103]
ds_read_b64_tr_b16 v[124:125],v5 offset:24576
ds_read_b64_tr_b16 v[126:127],v5 offset:30720
v_mfma_f32_16x16x32_bf16 v[108:111],v[136:139],v[144:147],v[108:111]
v_cvt_pk_bf16_f32 v28,v80,v81
v_cvt_pk_bf16_f32 v29,v82,v83
v_mfma_f32_16x16x32_bf16 v[76:79],v[140:143],a[164:167],v[76:79]
v_cvt_pk_bf16_f32 v34,v88,v89
v_mfma_f32_16x16x32_bf16 v[84:87],v[140:143],a[188:191],v[84:87]
v_mfma_f32_16x16x32_bf16 v[92:95],v[140:143],a[212:215],v[92:95]
v_mfma_f32_16x16x32_bf16 v[100:103],v[140:143],a[236:239],v[100:103]
v_mfma_f32_16x16x32_bf16 v[108:111],v[140:143],v[148:151],v[108:111]
s_mov_b32 s38,0
s_branch L_loop5
L_loop4:
.p2align 6
L_loop4w0:
s_waitcnt lgkmcnt(4)
v_mfma_f32_16x16x32_bf16 v[160:163],v[112:115],v[18:21],v[160:163]
s_add_u32 m0,s23,24576
ds_read_b64_tr_b16 v[128:129],v2 offset:24704
ds_read_b64_tr_b16 v[130:131],v2 offset:30848
v_mfma_f32_16x16x32_bf16 v[208:211],v[112:115],v[24:27],v[208:211]
ds_read_b64_tr_b16 v[132:133],v3 offset:24704
ds_read_b64_tr_b16 v[134:135],v3 offset:30848
v_mfma_f32_16x16x32_bf16 a[0:3],v[112:115],v[30:33],a[0:3]
ds_read_b64_tr_b16 v[136:137],v4 offset:24704
ds_read_b64_tr_b16 v[138:139],v4 offset:30848
v_mfma_f32_16x16x32_bf16 a[48:51],v[112:115],v[36:39],a[48:51]
ds_read_b64_tr_b16 v[140:141],v5 offset:24704
ds_read_b64_tr_b16 v[142:143],v5 offset:30848
v_mfma_f32_16x16x32_bf16 v[164:167],v[116:119],v[18:21],v[164:167]
ds_read_b64_tr_b16 v[112:113],v2 offset:24832
ds_read_b64_tr_b16 v[114:115],v2 offset:30976
v_mfma_f32_16x16x32_bf16 v[212:215],v[116:119],v[24:27],v[212:215]
v_fma_f32 v82,v82,s36,v14
v_fma_f32 v83,v83,s36,v14
v_mfma_f32_16x16x32_bf16 a[4:7],v[116:119],v[30:33],a[4:7]
v_exp_f32 v82,v82
v_mfma_f32_16x16x32_bf16 a[52:55],v[116:119],v[36:39],a[52:55]
s_waitcnt lgkmcnt(10)
ds_read_b64_tr_b16 v[116:117],v3 offset:24832
ds_read_b64_tr_b16 v[118:119],v3 offset:30976
v_mfma_f32_16x16x32_bf16 v[168:171],v[120:123],v[18:21],v[168:171]
v_exp_f32 v83,v83
v_mfma_f32_16x16x32_bf16 v[216:219],v[120:123],v[24:27],v[216:219]
v_cvt_pk_bf16_f32 v29,v82,v83
v_fma_f32 v88,v88,s36,v15
v_mfma_f32_16x16x32_bf16 a[8:11],v[120:123],v[30:33],a[8:11]
v_fma_f32 v89,v89,s36,v15
v_fma_f32 v90,v90,s36,v15
v_mfma_f32_16x16x32_bf16 a[56:59],v[120:123],v[36:39],a[56:59]
ds_read_b64_tr_b16 v[120:121],v4 offset:24832
ds_read_b64_tr_b16 v[122:123],v4 offset:30976
v_mfma_f32_16x16x32_bf16 v[172:175],v[124:127],v[18:21],v[172:175]
v_fma_f32 v91,v91,s36,v15
v_fma_f32 v96,v96,s36,v16
v_mfma_f32_16x16x32_bf16 v[220:223],v[124:127],v[24:27],v[220:223]
v_exp_f32 v88,v88
v_mfma_f32_16x16x32_bf16 a[12:15],v[124:127],v[30:33],a[12:15]
v_exp_f32 v89,v89
v_mfma_f32_16x16x32_bf16 a[60:63],v[124:127],v[36:39],a[60:63]
s_waitcnt lgkmcnt(3)
ds_read_b64_tr_b16 v[124:125],v5 offset:24832
ds_read_b64_tr_b16 v[126:127],v5 offset:30976
v_mfma_f32_16x16x32_bf16 v[176:179],v[128:131],v[18:21],v[176:179]
v_exp_f32 v90,v90
v_mfma_f32_16x16x32_bf16 v[224:227],v[128:131],v[24:27],v[224:227]
v_exp_f32 v91,v91
v_mfma_f32_16x16x32_bf16 a[16:19],v[128:131],v[30:33],a[16:19]
v_cvt_pk_bf16_f32 v34,v88,v89
v_cvt_pk_bf16_f32 v35,v90,v91
v_mfma_f32_16x16x32_bf16 a[64:67],v[128:131],v[36:39],a[64:67]
v_fma_f32 v97,v97,s36,v16
v_fma_f32 v98,v98,s36,v16
v_mfma_f32_16x16x32_bf16 v[180:183],v[132:135],v[18:21],v[180:183]
v_fma_f32 v99,v99,s36,v16
v_fma_f32 v76,v76,s36,v13
v_mfma_f32_16x16x32_bf16 v[228:231],v[132:135],v[24:27],v[228:231]
v_exp_f32 v96,v96
v_mfma_f32_16x16x32_bf16 a[20:23],v[132:135],v[30:33],a[20:23]
v_exp_f32 v97,v97
v_mfma_f32_16x16x32_bf16 a[68:71],v[132:135],v[36:39],a[68:71]
v_exp_f32 v98,v98
v_mfma_f32_16x16x32_bf16 v[184:187],v[136:139],v[18:21],v[184:187]
v_exp_f32 v99,v99
v_mfma_f32_16x16x32_bf16 v[232:235],v[136:139],v[24:27],v[232:235]
v_cvt_pk_bf16_f32 v40,v96,v97
v_cvt_pk_bf16_f32 v41,v98,v99
v_mfma_f32_16x16x32_bf16 a[24:27],v[136:139],v[30:33],a[24:27]
v_fma_f32 v77,v77,s36,v13
v_fma_f32 v78,v78,s36,v13
v_mfma_f32_16x16x32_bf16 a[72:75],v[136:139],v[36:39],a[72:75]
v_fma_f32 v79,v79,s36,v13
v_fma_f32 v84,v84,s36,v14
v_mfma_f32_16x16x32_bf16 v[188:191],v[140:143],v[18:21],v[188:191]
v_exp_f32 v76,v76
v_mfma_f32_16x16x32_bf16 v[236:239],v[140:143],v[24:27],v[236:239]
v_exp_f32 v77,v77
v_mfma_f32_16x16x32_bf16 a[28:31],v[140:143],v[30:33],a[28:31]
v_exp_f32 v78,v78
v_mfma_f32_16x16x32_bf16 a[76:79],v[140:143],v[36:39],a[76:79]
v_exp_f32 v79,v79
v_mfma_f32_16x16x32_bf16 v[192:195],v[112:115],v[18:21],v[192:195]
v_fma_f32 v85,v85,s36,v14
v_fma_f32 v86,v86,s36,v14
s_waitcnt vmcnt(6) lgkmcnt(0)
v_mfma_f32_16x16x32_bf16 v[240:243],v[112:115],v[24:27],v[240:243]
s_barrier
v_mfma_f32_16x16x32_bf16 a[32:35],v[112:115],v[30:33],a[32:35]
ds_read_b128 v[128:131],v0 offset:12288
v_fma_f32 v87,v87,s36,v14
v_mfma_f32_16x16x32_bf16 a[80:83],v[112:115],v[36:39],a[80:83]
ds_read_b128 v[132:135],v1 offset:12288
v_fma_f32 v92,v92,s36,v15
v_mfma_f32_16x16x32_bf16 v[196:199],v[116:119],v[18:21],v[196:199]
ds_read_b128 v[136:139],v0 offset:12416
v_fma_f32 v93,v93,s36,v15
v_mfma_f32_16x16x32_bf16 v[244:247],v[116:119],v[24:27],v[244:247]
ds_read_b128 v[140:143],v1 offset:12416
v_fma_f32 v94,v94,s36,v15
v_mfma_f32_16x16x32_bf16 a[36:39],v[116:119],v[30:33],a[36:39]
ds_read_b128 v[156:159],v10 offset:0
v_fma_f32 v95,v95,s36,v15
v_mfma_f32_16x16x32_bf16 a[84:87],v[116:119],v[36:39],a[84:87]
buffer_load_dwordx4 v6,s[8:11],s21 offen offset:0 lds
v_mfma_f32_16x16x32_bf16 v[200:203],v[120:123],v[18:21],v[200:203]
ds_read_b128 v[112:115],v0 offset:12544
v_fma_f32 v100,v100,s36,v16
v_mfma_f32_16x16x32_bf16 v[248:251],v[120:123],v[24:27],v[248:251]
ds_read_b128 v[116:119],v1 offset:12544
v_fma_f32 v101,v101,s36,v16
v_mfma_f32_16x16x32_bf16 a[40:43],v[120:123],v[30:33],a[40:43]
v_exp_f32 v84,v84
v_mfma_f32_16x16x32_bf16 a[88:91],v[120:123],v[36:39],a[88:91]
ds_read_b128 v[120:123],v0 offset:18432
v_fma_f32 v102,v102,s36,v16
v_mfma_f32_16x16x32_bf16 v[204:207],v[124:127],v[18:21],v[204:207]
v_cvt_pk_bf16_f32 v20,v76,v77
v_cvt_pk_bf16_f32 v21,v78,v79
v_mfma_f32_16x16x32_bf16 v[252:255],v[124:127],v[24:27],v[252:255]
v_exp_f32 v85,v85
v_mfma_f32_16x16x32_bf16 v[52:55],v[48:51],v[20:23],v[52:55]
v_exp_f32 v86,v86
v_mfma_f32_16x16x32_bf16 a[44:47],v[124:127],v[30:33],a[44:47]
v_exp_f32 v87,v87
v_mfma_f32_16x16x32_bf16 a[92:95],v[124:127],v[36:39],a[92:95]
s_waitcnt lgkmcnt(3)
buffer_store_dwordx4 v[156:159],v9,s[16:19],s27 offen offset:0 nt
buffer_load_dwordx4 v7,s[8:11],s21 offen offset:1024 lds
v_mfma_f32_16x16x32_bf16 v[72:75],v[128:131],a[144:147],0
ds_read_b128 v[152:155],v10 offset:1024
v_mfma_f32_16x16x32_bf16 v[80:83],v[128:131],a[168:171],0
ds_read_b128 v[124:127],v1 offset:18432
v_cvt_pk_bf16_f32 v26,v84,v85
v_mfma_f32_16x16x32_bf16 v[88:91],v[128:131],a[192:195],0
v_cvt_pk_bf16_f32 v27,v86,v87
v_fma_f32 v103,v103,s36,v16
v_mfma_f32_16x16x32_bf16 v[96:99],v[128:131],a[216:219],0
ds_read_b128 v[128:131],v0 offset:18560
v_mfma_f32_16x16x32_bf16 v[56:59],v[48:51],v[26:29],v[56:59]
v_exp_f32 v92,v92
v_mfma_f32_16x16x32_bf16 v[72:75],v[132:135],a[148:151],v[72:75]
v_exp_f32 v93,v93
v_mfma_f32_16x16x32_bf16 v[80:83],v[132:135],a[172:175],v[80:83]
v_exp_f32 v94,v94
v_mfma_f32_16x16x32_bf16 v[88:91],v[132:135],a[196:199],v[88:91]
buffer_load_dwordx4 v8,s[8:11],s21 offen offset:2048 lds
v_mfma_f32_16x16x32_bf16 v[96:99],v[132:135],a[220:223],v[96:99]
s_add_u32 s21,s21,12288
v_exp_f32 v95,v95
v_mfma_f32_16x16x32_bf16 v[72:75],v[136:139],a[152:155],v[72:75]
s_add_u32 m0,s22,0
v_cvt_pk_bf16_f32 v32,v92,v93
v_cvt_pk_bf16_f32 v33,v94,v95
v_mfma_f32_16x16x32_bf16 v[80:83],v[136:139],a[176:179],v[80:83]
v_exp_f32 v100,v100
v_mfma_f32_16x16x32_bf16 v[60:63],v[48:51],v[32:35],v[60:63]
v_exp_f32 v101,v101
v_mfma_f32_16x16x32_bf16 v[88:91],v[136:139],a[200:203],v[88:91]
v_exp_f32 v102,v102
v_mfma_f32_16x16x32_bf16 v[96:99],v[136:139],a[224:227],v[96:99]
v_exp_f32 v103,v103
v_mfma_f32_16x16x32_bf16 v[72:75],v[140:143],a[156:159],v[72:75]
v_cvt_pk_bf16_f32 v38,v100,v101
v_cvt_pk_bf16_f32 v39,v102,v103
v_mfma_f32_16x16x32_bf16 v[80:83],v[140:143],a[180:183],v[80:83]
ds_read_b128 v[132:135],v1 offset:18560
v_mfma_f32_16x16x32_bf16 v[64:67],v[48:51],v[38:41],v[64:67]
s_waitcnt lgkmcnt(1)
buffer_store_dwordx4 v[152:155],v9,s[16:19],s27 offen offset:128 nt
buffer_load_dwordx4 v6,s[4:7],s20 offen offset:0 lds
v_mfma_f32_16x16x32_bf16 v[88:91],v[140:143],a[204:207],v[88:91]
ds_read_b128 v[156:159],v10 offset:2048
v_mfma_f32_16x16x32_bf16 v[96:99],v[140:143],a[228:231],v[96:99]
ds_read_b128 v[136:139],v0 offset:18688
v_mfma_f32_16x16x32_bf16 v[72:75],v[112:115],a[160:163],v[72:75]
ds_read_b128 v[140:143],v1 offset:18688
v_mfma_f32_16x16x32_bf16 v[80:83],v[112:115],a[184:187],v[80:83]
v_mfma_f32_16x16x32_bf16 v[88:91],v[112:115],a[208:211],v[88:91]
v_mfma_f32_16x16x32_bf16 v[96:99],v[112:115],a[232:235],v[96:99]
v_mfma_f32_16x16x32_bf16 v[72:75],v[116:119],a[164:167],v[72:75]
v_mfma_f32_16x16x32_bf16 v[80:83],v[116:119],a[188:191],v[80:83]
buffer_load_dwordx4 v7,s[4:7],s20 offen offset:1024 lds
v_mfma_f32_16x16x32_bf16 v[88:91],v[116:119],a[212:215],v[88:91]
v_mfma_f32_16x16x32_bf16 v[96:99],v[116:119],a[236:239],v[96:99]
v_mfma_f32_16x16x32_bf16 v[76:79],v[120:123],a[144:147],0
v_mfma_f32_16x16x32_bf16 v[84:87],v[120:123],a[168:171],0
v_mfma_f32_16x16x32_bf16 v[92:95],v[120:123],a[192:195],0
v_mfma_f32_16x16x32_bf16 v[100:103],v[120:123],a[216:219],0
v_fma_f32 v72,v72,s36,v13
v_fma_f32 v73,v73,s36,v13
v_mfma_f32_16x16x32_bf16 v[76:79],v[124:127],a[148:151],v[76:79]
v_fma_f32 v74,v74,s36,v13
v_fma_f32 v75,v75,s36,v13
v_mfma_f32_16x16x32_bf16 v[84:87],v[124:127],a[172:175],v[84:87]
v_fma_f32 v80,v80,s36,v14
v_fma_f32 v81,v81,s36,v14
v_mfma_f32_16x16x32_bf16 v[92:95],v[124:127],a[196:199],v[92:95]
s_waitcnt lgkmcnt(0)
buffer_store_dwordx4 v[156:159],v9,s[16:19],s27 offen offset:256 nt
buffer_load_dwordx4 v8,s[4:7],s20 offen offset:2048 lds
v_mfma_f32_16x16x32_bf16 v[100:103],v[124:127],a[220:223],v[100:103]
s_add_u32 s20,s20,12288
ds_read_b64_tr_b16 v[112:113],v2 offset:6144
v_mfma_f32_16x16x32_bf16 v[76:79],v[128:131],a[152:155],v[76:79]
s_add_u32 s27,s27,3072
ds_read_b64_tr_b16 v[114:115],v2 offset:0
v_mfma_f32_16x16x32_bf16 v[84:87],v[128:131],a[176:179],v[84:87]
ds_read_b64_tr_b16 v[116:117],v3 offset:6144
v_mfma_f32_16x16x32_bf16 v[92:95],v[128:131],a[200:203],v[92:95]
ds_read_b64_tr_b16 v[118:119],v3 offset:0
v_mfma_f32_16x16x32_bf16 v[100:103],v[128:131],a[224:227],v[100:103]
ds_read_b64_tr_b16 v[120:121],v4 offset:6144
v_mfma_f32_16x16x32_bf16 v[76:79],v[132:135],a[156:159],v[76:79]
ds_read_b64_tr_b16 v[122:123],v4 offset:0
v_mfma_f32_16x16x32_bf16 v[84:87],v[132:135],a[180:183],v[84:87]
ds_read_b64_tr_b16 v[124:125],v5 offset:6144
v_mfma_f32_16x16x32_bf16 v[92:95],v[132:135],a[204:207],v[92:95]
ds_read_b64_tr_b16 v[126:127],v5 offset:0
v_mfma_f32_16x16x32_bf16 v[100:103],v[132:135],a[228:231],v[100:103]
v_exp_f32 v72,v72
v_mfma_f32_16x16x32_bf16 v[76:79],v[136:139],a[160:163],v[76:79]
v_exp_f32 v73,v73
v_mfma_f32_16x16x32_bf16 v[84:87],v[136:139],a[184:187],v[84:87]
v_exp_f32 v74,v74
v_mfma_f32_16x16x32_bf16 v[92:95],v[136:139],a[208:211],v[92:95]
v_exp_f32 v75,v75
v_mfma_f32_16x16x32_bf16 v[100:103],v[136:139],a[232:235],v[100:103]
v_exp_f32 v80,v80
v_mfma_f32_16x16x32_bf16 v[76:79],v[140:143],a[164:167],v[76:79]
v_exp_f32 v81,v81
v_mfma_f32_16x16x32_bf16 v[84:87],v[140:143],a[188:191],v[84:87]
v_cvt_pk_bf16_f32 v18,v72,v73
v_cvt_pk_bf16_f32 v19,v74,v75
v_mfma_f32_16x16x32_bf16 v[92:95],v[140:143],a[212:215],v[92:95]
v_cvt_pk_bf16_f32 v24,v80,v81
v_mfma_f32_16x16x32_bf16 v[100:103],v[140:143],a[236:239],v[100:103]
s_waitcnt lgkmcnt(0)
v_mfma_f32_16x16x32_bf16 v[160:163],v[112:115],v[20:23],v[160:163]
s_add_u32 m0,s29,0
ds_read_b64_tr_b16 v[128:129],v2 offset:6272
ds_read_b64_tr_b16 v[130:131],v2 offset:128
v_mfma_f32_16x16x32_bf16 v[208:211],v[112:115],v[26:29],v[208:211]
ds_read_b64_tr_b16 v[132:133],v3 offset:6272
ds_read_b64_tr_b16 v[134:135],v3 offset:128
v_mfma_f32_16x16x32_bf16 a[0:3],v[112:115],v[32:35],a[0:3]
ds_read_b64_tr_b16 v[136:137],v4 offset:6272
ds_read_b64_tr_b16 v[138:139],v4 offset:128
v_mfma_f32_16x16x32_bf16 a[48:51],v[112:115],v[38:41],a[48:51]
ds_read_b64_tr_b16 v[140:141],v5 offset:6272
ds_read_b64_tr_b16 v[142:143],v5 offset:128
v_mfma_f32_16x16x32_bf16 v[164:167],v[116:119],v[20:23],v[164:167]
ds_read_b64_tr_b16 v[112:113],v2 offset:6400
ds_read_b64_tr_b16 v[114:115],v2 offset:256
v_mfma_f32_16x16x32_bf16 v[212:215],v[116:119],v[26:29],v[212:215]
v_fma_f32 v82,v82,s36,v14
v_fma_f32 v83,v83,s36,v14
v_mfma_f32_16x16x32_bf16 a[4:7],v[116:119],v[32:35],a[4:7]
buffer_load_dwordx4 v6,s[12:15],s28 offen offset:0 nt lds
v_mfma_f32_16x16x32_bf16 a[52:55],v[116:119],v[38:41],a[52:55]
ds_read_b64_tr_b16 v[116:117],v3 offset:6400
ds_read_b64_tr_b16 v[118:119],v3 offset:256
v_mfma_f32_16x16x32_bf16 v[168:171],v[120:123],v[20:23],v[168:171]
v_exp_f32 v82,v82
v_mfma_f32_16x16x32_bf16 v[216:219],v[120:123],v[26:29],v[216:219]
v_exp_f32 v83,v83
v_mfma_f32_16x16x32_bf16 a[8:11],v[120:123],v[32:35],a[8:11]
v_cvt_pk_bf16_f32 v25,v82,v83
v_fma_f32 v88,v88,s36,v15
v_mfma_f32_16x16x32_bf16 a[56:59],v[120:123],v[38:41],a[56:59]
ds_read_b64_tr_b16 v[120:121],v4 offset:6400
ds_read_b64_tr_b16 v[122:123],v4 offset:256
v_mfma_f32_16x16x32_bf16 v[172:175],v[124:127],v[20:23],v[172:175]
v_fma_f32 v89,v89,s36,v15
v_fma_f32 v90,v90,s36,v15
v_mfma_f32_16x16x32_bf16 v[220:223],v[124:127],v[26:29],v[220:223]
buffer_load_dwordx4 v7,s[12:15],s28 offen offset:1024 nt lds
v_mfma_f32_16x16x32_bf16 a[12:15],v[124:127],v[32:35],a[12:15]
v_fma_f32 v91,v91,s36,v15
v_fma_f32 v96,v96,s36,v16
v_mfma_f32_16x16x32_bf16 a[60:63],v[124:127],v[38:41],a[60:63]
s_waitcnt lgkmcnt(3)
ds_read_b64_tr_b16 v[124:125],v5 offset:6400
ds_read_b64_tr_b16 v[126:127],v5 offset:256
v_mfma_f32_16x16x32_bf16 v[176:179],v[128:131],v[20:23],v[176:179]
v_exp_f32 v88,v88
v_mfma_f32_16x16x32_bf16 v[224:227],v[128:131],v[26:29],v[224:227]
v_exp_f32 v89,v89
v_mfma_f32_16x16x32_bf16 a[16:19],v[128:131],v[32:35],a[16:19]
v_exp_f32 v90,v90
v_mfma_f32_16x16x32_bf16 a[64:67],v[128:131],v[38:41],a[64:67]
v_exp_f32 v91,v91
v_mfma_f32_16x16x32_bf16 v[180:183],v[132:135],v[20:23],v[180:183]
v_cvt_pk_bf16_f32 v30,v88,v89
v_cvt_pk_bf16_f32 v31,v90,v91
v_mfma_f32_16x16x32_bf16 v[228:231],v[132:135],v[26:29],v[228:231]
buffer_load_dwordx4 v8,s[12:15],s28 offen offset:2048 nt lds
v_mfma_f32_16x16x32_bf16 a[20:23],v[132:135],v[32:35],a[20:23]
s_add_u32 s28,s28,3072
v_fma_f32 v97,v97,s36,v16
v_fma_f32 v98,v98,s36,v16
v_mfma_f32_16x16x32_bf16 a[68:71],v[132:135],v[38:41],a[68:71]
s_add_u32 s29,s29,3072
v_fma_f32 v99,v99,s36,v16
v_fma_f32 v76,v76,s36,v13
v_mfma_f32_16x16x32_bf16 v[184:187],v[136:139],v[20:23],v[184:187]
s_add_u32 m0,s23,0
v_exp_f32 v96,v96
v_mfma_f32_16x16x32_bf16 v[232:235],v[136:139],v[26:29],v[232:235]
v_exp_f32 v97,v97
v_mfma_f32_16x16x32_bf16 a[24:27],v[136:139],v[32:35],a[24:27]
v_exp_f32 v98,v98
v_mfma_f32_16x16x32_bf16 a[72:75],v[136:139],v[38:41],a[72:75]
v_exp_f32 v99,v99
v_mfma_f32_16x16x32_bf16 v[188:191],v[140:143],v[20:23],v[188:191]
v_cvt_pk_bf16_f32 v36,v96,v97
v_cvt_pk_bf16_f32 v37,v98,v99
v_mfma_f32_16x16x32_bf16 v[236:239],v[140:143],v[26:29],v[236:239]
v_fma_f32 v77,v77,s36,v13
v_fma_f32 v78,v78,s36,v13
v_mfma_f32_16x16x32_bf16 a[28:31],v[140:143],v[32:35],a[28:31]
v_fma_f32 v79,v79,s36,v13
v_fma_f32 v84,v84,s36,v14
v_mfma_f32_16x16x32_bf16 a[76:79],v[140:143],v[38:41],a[76:79]
v_exp_f32 v76,v76
s_waitcnt vmcnt(12) lgkmcnt(0)
v_mfma_f32_16x16x32_bf16 v[192:195],v[112:115],v[20:23],v[192:195]
s_barrier
v_mfma_f32_16x16x32_bf16 v[240:243],v[112:115],v[26:29],v[240:243]
ds_read_b128 v[128:131],v0 offset:24576
v_fma_f32 v85,v85,s36,v14
v_mfma_f32_16x16x32_bf16 a[32:35],v[112:115],v[32:35],a[32:35]
ds_read_b128 v[132:135],v1 offset:24576
v_fma_f32 v86,v86,s36,v14
v_mfma_f32_16x16x32_bf16 a[80:83],v[112:115],v[38:41],a[80:83]
ds_read_b128 v[136:139],v0 offset:24704
v_fma_f32 v87,v87,s36,v14
v_mfma_f32_16x16x32_bf16 v[196:199],v[116:119],v[20:23],v[196:199]
ds_read_b128 v[140:143],v1 offset:24704
v_fma_f32 v92,v92,s36,v15
v_mfma_f32_16x16x32_bf16 v[244:247],v[116:119],v[26:29],v[244:247]
ds_read_b128 v[112:115],v0 offset:24832
v_fma_f32 v93,v93,s36,v15
v_mfma_f32_16x16x32_bf16 a[36:39],v[116:119],v[32:35],a[36:39]
buffer_load_dwordx4 v6,s[8:11],s21 offen offset:0 lds
v_mfma_f32_16x16x32_bf16 a[84:87],v[116:119],v[38:41],a[84:87]
ds_read_b128 v[116:119],v1 offset:24832
v_fma_f32 v94,v94,s36,v15
v_mfma_f32_16x16x32_bf16 v[200:203],v[120:123],v[20:23],v[200:203]
v_exp_f32 v77,v77
v_mfma_f32_16x16x32_bf16 v[248:251],v[120:123],v[26:29],v[248:251]
v_exp_f32 v78,v78
v_mfma_f32_16x16x32_bf16 a[40:43],v[120:123],v[32:35],a[40:43]
v_exp_f32 v79,v79
v_mfma_f32_16x16x32_bf16 a[88:91],v[120:123],v[38:41],a[88:91]
ds_read_b128 v[120:123],v0 offset:30720
v_fma_f32 v95,v95,s36,v15
v_mfma_f32_16x16x32_bf16 v[204:207],v[124:127],v[20:23],v[204:207]
v_cvt_pk_bf16_f32 v20,v76,v77
v_cvt_pk_bf16_f32 v21,v78,v79
v_mfma_f32_16x16x32_bf16 v[252:255],v[124:127],v[26:29],v[252:255]
v_exp_f32 v84,v84
v_mfma_f32_16x16x32_bf16 v[52:55],v[48:51],v[18:21],v[52:55]
v_exp_f32 v85,v85
v_mfma_f32_16x16x32_bf16 a[44:47],v[124:127],v[32:35],a[44:47]
buffer_load_dwordx4 v7,s[8:11],s21 offen offset:1024 lds
v_mfma_f32_16x16x32_bf16 a[92:95],v[124:127],v[38:41],a[92:95]
s_waitcnt lgkmcnt(1)
ds_read_b128 v[124:127],v1 offset:30720
v_cvt_pk_bf16_f32 v26,v84,v85
v_mfma_f32_16x16x32_bf16 v[72:75],v[128:131],a[144:147],0
v_exp_f32 v86,v86
v_mfma_f32_16x16x32_bf16 v[80:83],v[128:131],a[168:171],0
v_exp_f32 v87,v87
v_mfma_f32_16x16x32_bf16 v[88:91],v[128:131],a[192:195],0
v_cvt_pk_bf16_f32 v27,v86,v87
v_fma_f32 v100,v100,s36,v16
v_mfma_f32_16x16x32_bf16 v[96:99],v[128:131],a[216:219],0
ds_read_b128 v[128:131],v0 offset:30848
v_fma_f32 v101,v101,s36,v16
v_mfma_f32_16x16x32_bf16 v[56:59],v[48:51],v[24:27],v[56:59]
v_exp_f32 v92,v92
v_mfma_f32_16x16x32_bf16 v[72:75],v[132:135],a[148:151],v[72:75]
v_exp_f32 v93,v93
v_mfma_f32_16x16x32_bf16 v[80:83],v[132:135],a[172:175],v[80:83]
v_exp_f32 v94,v94
v_mfma_f32_16x16x32_bf16 v[88:91],v[132:135],a[196:199],v[88:91]
buffer_load_dwordx4 v8,s[8:11],s21 offen offset:2048 lds
v_mfma_f32_16x16x32_bf16 v[96:99],v[132:135],a[220:223],v[96:99]
s_add_u32 s21,s21,12288
v_exp_f32 v95,v95
v_mfma_f32_16x16x32_bf16 v[72:75],v[136:139],a[152:155],v[72:75]
s_add_u32 m0,s22,12288
v_fma_f32 v102,v102,s36,v16
v_fma_f32 v103,v103,s36,v16
v_mfma_f32_16x16x32_bf16 v[80:83],v[136:139],a[176:179],v[80:83]
v_cvt_pk_bf16_f32 v32,v92,v93
v_cvt_pk_bf16_f32 v33,v94,v95
v_mfma_f32_16x16x32_bf16 v[88:91],v[136:139],a[200:203],v[88:91]
v_exp_f32 v100,v100
v_mfma_f32_16x16x32_bf16 v[60:63],v[48:51],v[30:33],v[60:63]
v_exp_f32 v101,v101
v_mfma_f32_16x16x32_bf16 v[96:99],v[136:139],a[224:227],v[96:99]
v_exp_f32 v102,v102
v_mfma_f32_16x16x32_bf16 v[72:75],v[140:143],a[156:159],v[72:75]
v_exp_f32 v103,v103
v_mfma_f32_16x16x32_bf16 v[80:83],v[140:143],a[180:183],v[80:83]
v_cvt_pk_bf16_f32 v38,v100,v101
v_cvt_pk_bf16_f32 v39,v102,v103
v_mfma_f32_16x16x32_bf16 v[88:91],v[140:143],a[204:207],v[88:91]
buffer_load_dwordx4 v6,s[4:7],s20 offen offset:0 lds
v_mfma_f32_16x16x32_bf16 v[64:67],v[48:51],v[36:39],v[64:67]
ds_read_b128 v[132:135],v1 offset:30848
v_mfma_f32_16x16x32_bf16 v[96:99],v[140:143],a[228:231],v[96:99]
ds_read_b128 v[136:139],v0 offset:30976
v_mfma_f32_16x16x32_bf16 v[72:75],v[112:115],a[160:163],v[72:75]
ds_read_b128 v[140:143],v1 offset:30976
v_mfma_f32_16x16x32_bf16 v[80:83],v[112:115],a[184:187],v[80:83]
v_mfma_f32_16x16x32_bf16 v[88:91],v[112:115],a[208:211],v[88:91]
v_mfma_f32_16x16x32_bf16 v[96:99],v[112:115],a[232:235],v[96:99]
v_mfma_f32_16x16x32_bf16 v[72:75],v[116:119],a[164:167],v[72:75]
v_mfma_f32_16x16x32_bf16 v[80:83],v[116:119],a[188:191],v[80:83]
v_mfma_f32_16x16x32_bf16 v[88:91],v[116:119],a[212:215],v[88:91]
buffer_load_dwordx4 v7,s[4:7],s20 offen offset:1024 lds
v_mfma_f32_16x16x32_bf16 v[96:99],v[116:119],a[236:239],v[96:99]
s_waitcnt lgkmcnt(1)
v_mfma_f32_16x16x32_bf16 v[76:79],v[120:123],a[144:147],0
v_mfma_f32_16x16x32_bf16 v[84:87],v[120:123],a[168:171],0
v_mfma_f32_16x16x32_bf16 v[92:95],v[120:123],a[192:195],0
v_mfma_f32_16x16x32_bf16 v[100:103],v[120:123],a[216:219],0
v_fma_f32 v72,v72,s36,v13
v_fma_f32 v73,v73,s36,v13
v_mfma_f32_16x16x32_bf16 v[76:79],v[124:127],a[148:151],v[76:79]
v_fma_f32 v74,v74,s36,v13
v_fma_f32 v75,v75,s36,v13
v_mfma_f32_16x16x32_bf16 v[84:87],v[124:127],a[172:175],v[84:87]
v_fma_f32 v80,v80,s36,v14
v_fma_f32 v81,v81,s36,v14
v_mfma_f32_16x16x32_bf16 v[92:95],v[124:127],a[196:199],v[92:95]
v_exp_f32 v72,v72
v_mfma_f32_16x16x32_bf16 v[100:103],v[124:127],a[220:223],v[100:103]
buffer_load_dwordx4 v8,s[4:7],s20 offen offset:2048 lds
v_mfma_f32_16x16x32_bf16 v[76:79],v[128:131],a[152:155],v[76:79]
s_add_u32 s20,s20,12288
ds_read_b64_tr_b16 v[112:113],v2 offset:12288
v_mfma_f32_16x16x32_bf16 v[84:87],v[128:131],a[176:179],v[84:87]
ds_read_b64_tr_b16 v[114:115],v2 offset:18432
v_mfma_f32_16x16x32_bf16 v[92:95],v[128:131],a[200:203],v[92:95]
ds_read_b64_tr_b16 v[116:117],v3 offset:12288
v_mfma_f32_16x16x32_bf16 v[100:103],v[128:131],a[224:227],v[100:103]
ds_read_b64_tr_b16 v[118:119],v3 offset:18432
v_mfma_f32_16x16x32_bf16 v[76:79],v[132:135],a[156:159],v[76:79]
ds_read_b64_tr_b16 v[120:121],v4 offset:12288
v_mfma_f32_16x16x32_bf16 v[84:87],v[132:135],a[180:183],v[84:87]
ds_read_b64_tr_b16 v[122:123],v4 offset:18432
v_mfma_f32_16x16x32_bf16 v[92:95],v[132:135],a[204:207],v[92:95]
ds_read_b64_tr_b16 v[124:125],v5 offset:12288
v_mfma_f32_16x16x32_bf16 v[100:103],v[132:135],a[228:231],v[100:103]
ds_read_b64_tr_b16 v[126:127],v5 offset:18432
v_mfma_f32_16x16x32_bf16 v[76:79],v[136:139],a[160:163],v[76:79]
v_exp_f32 v73,v73
v_mfma_f32_16x16x32_bf16 v[84:87],v[136:139],a[184:187],v[84:87]
v_exp_f32 v74,v74
v_mfma_f32_16x16x32_bf16 v[92:95],v[136:139],a[208:211],v[92:95]
v_exp_f32 v75,v75
v_mfma_f32_16x16x32_bf16 v[100:103],v[136:139],a[232:235],v[100:103]
s_waitcnt lgkmcnt(5)
v_exp_f32 v80,v80
v_mfma_f32_16x16x32_bf16 v[76:79],v[140:143],a[164:167],v[76:79]
v_exp_f32 v81,v81
v_mfma_f32_16x16x32_bf16 v[84:87],v[140:143],a[188:191],v[84:87]
v_cvt_pk_bf16_f32 v22,v72,v73
v_cvt_pk_bf16_f32 v23,v74,v75
v_mfma_f32_16x16x32_bf16 v[92:95],v[140:143],a[212:215],v[92:95]
v_cvt_pk_bf16_f32 v28,v80,v81
v_mfma_f32_16x16x32_bf16 v[100:103],v[140:143],a[236:239],v[100:103]
v_mfma_f32_16x16x32_bf16 v[160:163],v[112:115],v[18:21],v[160:163]
s_add_u32 m0,s23,12288
ds_read_b64_tr_b16 v[128:129],v2 offset:12416
ds_read_b64_tr_b16 v[130:131],v2 offset:18560
v_mfma_f32_16x16x32_bf16 v[208:211],v[112:115],v[24:27],v[208:211]
ds_read_b64_tr_b16 v[132:133],v3 offset:12416
ds_read_b64_tr_b16 v[134:135],v3 offset:18560
v_mfma_f32_16x16x32_bf16 a[0:3],v[112:115],v[30:33],a[0:3]
ds_read_b64_tr_b16 v[136:137],v4 offset:12416
ds_read_b64_tr_b16 v[138:139],v4 offset:18560
v_mfma_f32_16x16x32_bf16 a[48:51],v[112:115],v[36:39],a[48:51]
s_waitcnt lgkmcnt(6)
ds_read_b64_tr_b16 v[140:141],v5 offset:12416
ds_read_b64_tr_b16 v[142:143],v5 offset:18560
v_mfma_f32_16x16x32_bf16 v[164:167],v[116:119],v[18:21],v[164:167]
ds_read_b64_tr_b16 v[112:113],v2 offset:12544
ds_read_b64_tr_b16 v[114:115],v2 offset:18688
v_mfma_f32_16x16x32_bf16 v[212:215],v[116:119],v[24:27],v[212:215]
v_fma_f32 v82,v82,s36,v14
v_fma_f32 v83,v83,s36,v14
v_mfma_f32_16x16x32_bf16 a[4:7],v[116:119],v[30:33],a[4:7]
v_exp_f32 v82,v82
v_mfma_f32_16x16x32_bf16 a[52:55],v[116:119],v[36:39],a[52:55]
ds_read_b64_tr_b16 v[116:117],v3 offset:12544
ds_read_b64_tr_b16 v[118:119],v3 offset:18688
v_mfma_f32_16x16x32_bf16 v[168:171],v[120:123],v[18:21],v[168:171]
v_exp_f32 v83,v83
v_mfma_f32_16x16x32_bf16 v[216:219],v[120:123],v[24:27],v[216:219]
v_cvt_pk_bf16_f32 v29,v82,v83
v_fma_f32 v88,v88,s36,v15
v_mfma_f32_16x16x32_bf16 a[8:11],v[120:123],v[30:33],a[8:11]
v_fma_f32 v89,v89,s36,v15
v_fma_f32 v90,v90,s36,v15
v_mfma_f32_16x16x32_bf16 a[56:59],v[120:123],v[36:39],a[56:59]
ds_read_b64_tr_b16 v[120:121],v4 offset:12544
ds_read_b64_tr_b16 v[122:123],v4 offset:18688
v_mfma_f32_16x16x32_bf16 v[172:175],v[124:127],v[18:21],v[172:175]
v_fma_f32 v91,v91,s36,v15
v_fma_f32 v96,v96,s36,v16
v_mfma_f32_16x16x32_bf16 v[220:223],v[124:127],v[24:27],v[220:223]
v_exp_f32 v88,v88
v_mfma_f32_16x16x32_bf16 a[12:15],v[124:127],v[30:33],a[12:15]
v_exp_f32 v89,v89
v_mfma_f32_16x16x32_bf16 a[60:63],v[124:127],v[36:39],a[60:63]
s_waitcnt lgkmcnt(4)
ds_read_b64_tr_b16 v[124:125],v5 offset:12544
ds_read_b64_tr_b16 v[126:127],v5 offset:18688
v_mfma_f32_16x16x32_bf16 v[176:179],v[128:131],v[18:21],v[176:179]
v_exp_f32 v90,v90
v_mfma_f32_16x16x32_bf16 v[224:227],v[128:131],v[24:27],v[224:227]
v_exp_f32 v91,v91
v_mfma_f32_16x16x32_bf16 a[16:19],v[128:131],v[30:33],a[16:19]
v_cvt_pk_bf16_f32 v34,v88,v89
v_cvt_pk_bf16_f32 v35,v90,v91
v_mfma_f32_16x16x32_bf16 a[64:67],v[128:131],v[36:39],a[64:67]
v_fma_f32 v97,v97,s36,v16
v_fma_f32 v98,v98,s36,v16
v_mfma_f32_16x16x32_bf16 v[180:183],v[132:135],v[18:21],v[180:183]
v_fma_f32 v99,v99,s36,v16
v_fma_f32 v76,v76,s36,v13
v_mfma_f32_16x16x32_bf16 v[228:231],v[132:135],v[24:27],v[228:231]
v_exp_f32 v96,v96
v_mfma_f32_16x16x32_bf16 a[20:23],v[132:135],v[30:33],a[20:23]
v_exp_f32 v97,v97
v_mfma_f32_16x16x32_bf16 a[68:71],v[132:135],v[36:39],a[68:71]
v_exp_f32 v98,v98
v_mfma_f32_16x16x32_bf16 v[184:187],v[136:139],v[18:21],v[184:187]
v_exp_f32 v99,v99
v_mfma_f32_16x16x32_bf16 v[232:235],v[136:139],v[24:27],v[232:235]
v_cvt_pk_bf16_f32 v40,v96,v97
v_cvt_pk_bf16_f32 v41,v98,v99
v_mfma_f32_16x16x32_bf16 a[24:27],v[136:139],v[30:33],a[24:27]
v_fma_f32 v77,v77,s36,v13
v_fma_f32 v78,v78,s36,v13
v_mfma_f32_16x16x32_bf16 a[72:75],v[136:139],v[36:39],a[72:75]
v_fma_f32 v79,v79,s36,v13
v_fma_f32 v84,v84,s36,v14
v_mfma_f32_16x16x32_bf16 v[188:191],v[140:143],v[18:21],v[188:191]
v_exp_f32 v76,v76
v_mfma_f32_16x16x32_bf16 v[236:239],v[140:143],v[24:27],v[236:239]
v_exp_f32 v77,v77
v_mfma_f32_16x16x32_bf16 a[28:31],v[140:143],v[30:33],a[28:31]
v_exp_f32 v78,v78
v_mfma_f32_16x16x32_bf16 a[76:79],v[140:143],v[36:39],a[76:79]
v_exp_f32 v79,v79
v_mfma_f32_16x16x32_bf16 v[192:195],v[112:115],v[18:21],v[192:195]
v_fma_f32 v85,v85,s36,v14
v_fma_f32 v86,v86,s36,v14
s_waitcnt vmcnt(9) lgkmcnt(0)
v_mfma_f32_16x16x32_bf16 v[240:243],v[112:115],v[24:27],v[240:243]
s_barrier
v_mfma_f32_16x16x32_bf16 a[32:35],v[112:115],v[30:33],a[32:35]
ds_read_b128 v[128:131],v0 offset:0
v_fma_f32 v87,v87,s36,v14
v_mfma_f32_16x16x32_bf16 a[80:83],v[112:115],v[36:39],a[80:83]
ds_read_b128 v[132:135],v1 offset:0
v_fma_f32 v92,v92,s36,v15
v_mfma_f32_16x16x32_bf16 v[196:199],v[116:119],v[18:21],v[196:199]
ds_read_b128 v[136:139],v0 offset:128
v_fma_f32 v93,v93,s36,v15
v_mfma_f32_16x16x32_bf16 v[244:247],v[116:119],v[24:27],v[244:247]
ds_read_b128 v[140:143],v1 offset:128
v_fma_f32 v94,v94,s36,v15
v_mfma_f32_16x16x32_bf16 a[36:39],v[116:119],v[30:33],a[36:39]
ds_read_b128 v[152:155],v10 offset:3072
v_fma_f32 v95,v95,s36,v15
v_mfma_f32_16x16x32_bf16 a[84:87],v[116:119],v[36:39],a[84:87]
buffer_load_dwordx4 v6,s[8:11],s21 offen offset:0 lds
v_mfma_f32_16x16x32_bf16 v[200:203],v[120:123],v[18:21],v[200:203]
ds_read_b128 v[112:115],v0 offset:256
v_fma_f32 v100,v100,s36,v16
v_mfma_f32_16x16x32_bf16 v[248:251],v[120:123],v[24:27],v[248:251]
ds_read_b128 v[116:119],v1 offset:256
v_fma_f32 v101,v101,s36,v16
v_mfma_f32_16x16x32_bf16 a[40:43],v[120:123],v[30:33],a[40:43]
v_exp_f32 v84,v84
v_mfma_f32_16x16x32_bf16 a[88:91],v[120:123],v[36:39],a[88:91]
ds_read_b128 v[120:123],v0 offset:6144
v_fma_f32 v102,v102,s36,v16
v_mfma_f32_16x16x32_bf16 v[204:207],v[124:127],v[18:21],v[204:207]
v_cvt_pk_bf16_f32 v20,v76,v77
v_cvt_pk_bf16_f32 v21,v78,v79
v_mfma_f32_16x16x32_bf16 v[252:255],v[124:127],v[24:27],v[252:255]
v_exp_f32 v85,v85
v_mfma_f32_16x16x32_bf16 v[52:55],v[48:51],v[20:23],v[52:55]
v_exp_f32 v86,v86
v_mfma_f32_16x16x32_bf16 a[44:47],v[124:127],v[30:33],a[44:47]
v_exp_f32 v87,v87
v_mfma_f32_16x16x32_bf16 a[92:95],v[124:127],v[36:39],a[92:95]
s_waitcnt lgkmcnt(3)
buffer_store_dwordx4 v[152:155],v9,s[16:19],s27 offen offset:0 nt
buffer_load_dwordx4 v7,s[8:11],s21 offen offset:1024 lds
v_mfma_f32_16x16x32_bf16 v[72:75],v[128:131],a[144:147],0
ds_read_b128 v[156:159],v10 offset:4096
v_mfma_f32_16x16x32_bf16 v[80:83],v[128:131],a[168:171],0
ds_read_b128 v[124:127],v1 offset:6144
v_cvt_pk_bf16_f32 v26,v84,v85
v_mfma_f32_16x16x32_bf16 v[88:91],v[128:131],a[192:195],0
v_cvt_pk_bf16_f32 v27,v86,v87
v_fma_f32 v103,v103,s36,v16
v_mfma_f32_16x16x32_bf16 v[96:99],v[128:131],a[216:219],0
ds_read_b128 v[128:131],v0 offset:6272
v_mfma_f32_16x16x32_bf16 v[56:59],v[48:51],v[26:29],v[56:59]
v_exp_f32 v92,v92
v_mfma_f32_16x16x32_bf16 v[72:75],v[132:135],a[148:151],v[72:75]
v_exp_f32 v93,v93
v_mfma_f32_16x16x32_bf16 v[80:83],v[132:135],a[172:175],v[80:83]
v_exp_f32 v94,v94
v_mfma_f32_16x16x32_bf16 v[88:91],v[132:135],a[196:199],v[88:91]
buffer_load_dwordx4 v8,s[8:11],s21 offen offset:2048 lds
v_mfma_f32_16x16x32_bf16 v[96:99],v[132:135],a[220:223],v[96:99]
s_add_u32 s21,s21,12288
v_exp_f32 v95,v95
v_mfma_f32_16x16x32_bf16 v[72:75],v[136:139],a[152:155],v[72:75]
s_add_u32 m0,s22,24576
v_cvt_pk_bf16_f32 v32,v92,v93
v_cvt_pk_bf16_f32 v33,v94,v95
v_mfma_f32_16x16x32_bf16 v[80:83],v[136:139],a[176:179],v[80:83]
v_exp_f32 v100,v100
v_mfma_f32_16x16x32_bf16 v[60:63],v[48:51],v[32:35],v[60:63]
v_exp_f32 v101,v101
v_mfma_f32_16x16x32_bf16 v[88:91],v[136:139],a[200:203],v[88:91]
v_exp_f32 v102,v102
v_mfma_f32_16x16x32_bf16 v[96:99],v[136:139],a[224:227],v[96:99]
v_exp_f32 v103,v103
v_mfma_f32_16x16x32_bf16 v[72:75],v[140:143],a[156:159],v[72:75]
v_cvt_pk_bf16_f32 v38,v100,v101
v_cvt_pk_bf16_f32 v39,v102,v103
v_mfma_f32_16x16x32_bf16 v[80:83],v[140:143],a[180:183],v[80:83]
ds_read_b128 v[132:135],v1 offset:6272
v_mfma_f32_16x16x32_bf16 v[64:67],v[48:51],v[38:41],v[64:67]
s_waitcnt lgkmcnt(1)
buffer_store_dwordx4 v[156:159],v9,s[16:19],s27 offen offset:128 nt
buffer_load_dwordx4 v6,s[4:7],s20 offen offset:0 lds
v_mfma_f32_16x16x32_bf16 v[88:91],v[140:143],a[204:207],v[88:91]
ds_read_b128 v[152:155],v10 offset:5120
v_mfma_f32_16x16x32_bf16 v[96:99],v[140:143],a[228:231],v[96:99]
ds_read_b128 v[136:139],v0 offset:6400
v_mfma_f32_16x16x32_bf16 v[72:75],v[112:115],a[160:163],v[72:75]
ds_read_b128 v[140:143],v1 offset:6400
v_mfma_f32_16x16x32_bf16 v[80:83],v[112:115],a[184:187],v[80:83]
v_mfma_f32_16x16x32_bf16 v[88:91],v[112:115],a[208:211],v[88:91]
v_mfma_f32_16x16x32_bf16 v[96:99],v[112:115],a[232:235],v[96:99]
v_mfma_f32_16x16x32_bf16 v[72:75],v[116:119],a[164:167],v[72:75]
v_mfma_f32_16x16x32_bf16 v[80:83],v[116:119],a[188:191],v[80:83]
buffer_load_dwordx4 v7,s[4:7],s20 offen offset:1024 lds
v_mfma_f32_16x16x32_bf16 v[88:91],v[116:119],a[212:215],v[88:91]
v_mfma_f32_16x16x32_bf16 v[96:99],v[116:119],a[236:239],v[96:99]
v_mfma_f32_16x16x32_bf16 v[76:79],v[120:123],a[144:147],0
v_mfma_f32_16x16x32_bf16 v[84:87],v[120:123],a[168:171],0
v_mfma_f32_16x16x32_bf16 v[92:95],v[120:123],a[192:195],0
v_mfma_f32_16x16x32_bf16 v[100:103],v[120:123],a[216:219],0
v_fma_f32 v72,v72,s36,v13
v_fma_f32 v73,v73,s36,v13
v_mfma_f32_16x16x32_bf16 v[76:79],v[124:127],a[148:151],v[76:79]
v_fma_f32 v74,v74,s36,v13
v_fma_f32 v75,v75,s36,v13
v_mfma_f32_16x16x32_bf16 v[84:87],v[124:127],a[172:175],v[84:87]
v_fma_f32 v80,v80,s36,v14
v_fma_f32 v81,v81,s36,v14
v_mfma_f32_16x16x32_bf16 v[92:95],v[124:127],a[196:199],v[92:95]
s_waitcnt lgkmcnt(0)
buffer_store_dwordx4 v[152:155],v9,s[16:19],s27 offen offset:256 nt
buffer_load_dwordx4 v8,s[4:7],s20 offen offset:2048 lds
v_mfma_f32_16x16x32_bf16 v[100:103],v[124:127],a[220:223],v[100:103]
s_add_u32 s20,s20,12288
ds_read_b64_tr_b16 v[112:113],v2 offset:30720
v_mfma_f32_16x16x32_bf16 v[76:79],v[128:131],a[152:155],v[76:79]
s_add_u32 s27,s27,3072
ds_read_b64_tr_b16 v[114:115],v2 offset:24576
v_mfma_f32_16x16x32_bf16 v[84:87],v[128:131],a[176:179],v[84:87]
ds_read_b64_tr_b16 v[116:117],v3 offset:30720
v_mfma_f32_16x16x32_bf16 v[92:95],v[128:131],a[200:203],v[92:95]
ds_read_b64_tr_b16 v[118:119],v3 offset:24576
v_mfma_f32_16x16x32_bf16 v[100:103],v[128:131],a[224:227],v[100:103]
ds_read_b64_tr_b16 v[120:121],v4 offset:30720
v_mfma_f32_16x16x32_bf16 v[76:79],v[132:135],a[156:159],v[76:79]
ds_read_b64_tr_b16 v[122:123],v4 offset:24576
v_mfma_f32_16x16x32_bf16 v[84:87],v[132:135],a[180:183],v[84:87]
ds_read_b64_tr_b16 v[124:125],v5 offset:30720
v_mfma_f32_16x16x32_bf16 v[92:95],v[132:135],a[204:207],v[92:95]
ds_read_b64_tr_b16 v[126:127],v5 offset:24576
v_mfma_f32_16x16x32_bf16 v[100:103],v[132:135],a[228:231],v[100:103]
v_exp_f32 v72,v72
v_mfma_f32_16x16x32_bf16 v[76:79],v[136:139],a[160:163],v[76:79]
v_exp_f32 v73,v73
v_mfma_f32_16x16x32_bf16 v[84:87],v[136:139],a[184:187],v[84:87]
v_exp_f32 v74,v74
v_mfma_f32_16x16x32_bf16 v[92:95],v[136:139],a[208:211],v[92:95]
v_exp_f32 v75,v75
v_mfma_f32_16x16x32_bf16 v[100:103],v[136:139],a[232:235],v[100:103]
v_exp_f32 v80,v80
v_mfma_f32_16x16x32_bf16 v[76:79],v[140:143],a[164:167],v[76:79]
v_exp_f32 v81,v81
v_mfma_f32_16x16x32_bf16 v[84:87],v[140:143],a[188:191],v[84:87]
v_cvt_pk_bf16_f32 v18,v72,v73
v_cvt_pk_bf16_f32 v19,v74,v75
v_mfma_f32_16x16x32_bf16 v[92:95],v[140:143],a[212:215],v[92:95]
v_cvt_pk_bf16_f32 v24,v80,v81
v_mfma_f32_16x16x32_bf16 v[100:103],v[140:143],a[236:239],v[100:103]
s_waitcnt lgkmcnt(0)
v_mfma_f32_16x16x32_bf16 v[160:163],v[112:115],v[20:23],v[160:163]
s_add_u32 m0,s29,0
ds_read_b64_tr_b16 v[128:129],v2 offset:30848
ds_read_b64_tr_b16 v[130:131],v2 offset:24704
v_mfma_f32_16x16x32_bf16 v[208:211],v[112:115],v[26:29],v[208:211]
ds_read_b64_tr_b16 v[132:133],v3 offset:30848
ds_read_b64_tr_b16 v[134:135],v3 offset:24704
v_mfma_f32_16x16x32_bf16 a[0:3],v[112:115],v[32:35],a[0:3]
ds_read_b64_tr_b16 v[136:137],v4 offset:30848
ds_read_b64_tr_b16 v[138:139],v4 offset:24704
v_mfma_f32_16x16x32_bf16 a[48:51],v[112:115],v[38:41],a[48:51]
ds_read_b64_tr_b16 v[140:141],v5 offset:30848
ds_read_b64_tr_b16 v[142:143],v5 offset:24704
v_mfma_f32_16x16x32_bf16 v[164:167],v[116:119],v[20:23],v[164:167]
ds_read_b64_tr_b16 v[112:113],v2 offset:30976
ds_read_b64_tr_b16 v[114:115],v2 offset:24832
v_mfma_f32_16x16x32_bf16 v[212:215],v[116:119],v[26:29],v[212:215]
v_fma_f32 v82,v82,s36,v14
v_fma_f32 v83,v83,s36,v14
v_mfma_f32_16x16x32_bf16 a[4:7],v[116:119],v[32:35],a[4:7]
buffer_load_dwordx4 v6,s[12:15],s28 offen offset:0 nt lds
v_mfma_f32_16x16x32_bf16 a[52:55],v[116:119],v[38:41],a[52:55]
ds_read_b64_tr_b16 v[116:117],v3 offset:30976
ds_read_b64_tr_b16 v[118:119],v3 offset:24832
v_mfma_f32_16x16x32_bf16 v[168:171],v[120:123],v[20:23],v[168:171]
v_exp_f32 v82,v82
v_mfma_f32_16x16x32_bf16 v[216:219],v[120:123],v[26:29],v[216:219]
v_exp_f32 v83,v83
v_mfma_f32_16x16x32_bf16 a[8:11],v[120:123],v[32:35],a[8:11]
v_cvt_pk_bf16_f32 v25,v82,v83
v_fma_f32 v88,v88,s36,v15
v_mfma_f32_16x16x32_bf16 a[56:59],v[120:123],v[38:41],a[56:59]
ds_read_b64_tr_b16 v[120:121],v4 offset:30976
ds_read_b64_tr_b16 v[122:123],v4 offset:24832
v_mfma_f32_16x16x32_bf16 v[172:175],v[124:127],v[20:23],v[172:175]
v_fma_f32 v89,v89,s36,v15
v_fma_f32 v90,v90,s36,v15
v_mfma_f32_16x16x32_bf16 v[220:223],v[124:127],v[26:29],v[220:223]
buffer_load_dwordx4 v7,s[12:15],s28 offen offset:1024 nt lds
v_mfma_f32_16x16x32_bf16 a[12:15],v[124:127],v[32:35],a[12:15]
v_fma_f32 v91,v91,s36,v15
v_fma_f32 v96,v96,s36,v16
v_mfma_f32_16x16x32_bf16 a[60:63],v[124:127],v[38:41],a[60:63]
s_waitcnt lgkmcnt(3)
ds_read_b64_tr_b16 v[124:125],v5 offset:30976
ds_read_b64_tr_b16 v[126:127],v5 offset:24832
v_mfma_f32_16x16x32_bf16 v[176:179],v[128:131],v[20:23],v[176:179]
v_exp_f32 v88,v88
v_mfma_f32_16x16x32_bf16 v[224:227],v[128:131],v[26:29],v[224:227]
v_exp_f32 v89,v89
v_mfma_f32_16x16x32_bf16 a[16:19],v[128:131],v[32:35],a[16:19]
v_exp_f32 v90,v90
v_mfma_f32_16x16x32_bf16 a[64:67],v[128:131],v[38:41],a[64:67]
v_exp_f32 v91,v91
v_mfma_f32_16x16x32_bf16 v[180:183],v[132:135],v[20:23],v[180:183]
v_cvt_pk_bf16_f32 v30,v88,v89
v_cvt_pk_bf16_f32 v31,v90,v91
v_mfma_f32_16x16x32_bf16 v[228:231],v[132:135],v[26:29],v[228:231]
buffer_load_dwordx4 v8,s[12:15],s28 offen offset:2048 nt lds
v_mfma_f32_16x16x32_bf16 a[20:23],v[132:135],v[32:35],a[20:23]
s_add_u32 s28,s28,3072
v_fma_f32 v97,v97,s36,v16
v_fma_f32 v98,v98,s36,v16
v_mfma_f32_16x16x32_bf16 a[68:71],v[132:135],v[38:41],a[68:71]
s_add_u32 s29,s29,3072
v_fma_f32 v99,v99,s36,v16
v_fma_f32 v76,v76,s36,v13
v_mfma_f32_16x16x32_bf16 v[184:187],v[136:139],v[20:23],v[184:187]
s_add_u32 m0,s23,24576
v_exp_f32 v96,v96
v_mfma_f32_16x16x32_bf16 v[232:235],v[136:139],v[26:29],v[232:235]
v_exp_f32 v97,v97
v_mfma_f32_16x16x32_bf16 a[24:27],v[136:139],v[32:35],a[24:27]
v_exp_f32 v98,v98
v_mfma_f32_16x16x32_bf16 a[72:75],v[136:139],v[38:41],a[72:75]
v_exp_f32 v99,v99
v_mfma_f32_16x16x32_bf16 v[188:191],v[140:143],v[20:23],v[188:191]
v_cvt_pk_bf16_f32 v36,v96,v97
v_cvt_pk_bf16_f32 v37,v98,v99
v_mfma_f32_16x16x32_bf16 v[236:239],v[140:143],v[26:29],v[236:239]
v_fma_f32 v77,v77,s36,v13
v_fma_f32 v78,v78,s36,v13
v_mfma_f32_16x16x32_bf16 a[28:31],v[140:143],v[32:35],a[28:31]
v_fma_f32 v79,v79,s36,v13
v_fma_f32 v84,v84,s36,v14
v_mfma_f32_16x16x32_bf16 a[76:79],v[140:143],v[38:41],a[76:79]
v_exp_f32 v76,v76
s_waitcnt vmcnt(12) lgkmcnt(0)
v_mfma_f32_16x16x32_bf16 v[192:195],v[112:115],v[20:23],v[192:195]
s_barrier
v_mfma_f32_16x16x32_bf16 v[240:243],v[112:115],v[26:29],v[240:243]
ds_read_b128 v[128:131],v0 offset:12288
v_fma_f32 v85,v85,s36,v14
v_mfma_f32_16x16x32_bf16 a[32:35],v[112:115],v[32:35],a[32:35]
ds_read_b128 v[132:135],v1 offset:12288
v_fma_f32 v86,v86,s36,v14
v_mfma_f32_16x16x32_bf16 a[80:83],v[112:115],v[38:41],a[80:83]
ds_read_b128 v[136:139],v0 offset:12416
v_fma_f32 v87,v87,s36,v14
v_mfma_f32_16x16x32_bf16 v[196:199],v[116:119],v[20:23],v[196:199]
ds_read_b128 v[140:143],v1 offset:12416
v_fma_f32 v92,v92,s36,v15
v_mfma_f32_16x16x32_bf16 v[244:247],v[116:119],v[26:29],v[244:247]
ds_read_b128 v[112:115],v0 offset:12544
v_fma_f32 v93,v93,s36,v15
v_mfma_f32_16x16x32_bf16 a[36:39],v[116:119],v[32:35],a[36:39]
buffer_load_dwordx4 v6,s[8:11],s21 offen offset:0 lds
v_mfma_f32_16x16x32_bf16 a[84:87],v[116:119],v[38:41],a[84:87]
ds_read_b128 v[116:119],v1 offset:12544
v_fma_f32 v94,v94,s36,v15
v_mfma_f32_16x16x32_bf16 v[200:203],v[120:123],v[20:23],v[200:203]
v_exp_f32 v77,v77
v_mfma_f32_16x16x32_bf16 v[248:251],v[120:123],v[26:29],v[248:251]
v_exp_f32 v78,v78
v_mfma_f32_16x16x32_bf16 a[40:43],v[120:123],v[32:35],a[40:43]
v_exp_f32 v79,v79
v_mfma_f32_16x16x32_bf16 a[88:91],v[120:123],v[38:41],a[88:91]
ds_read_b128 v[120:123],v0 offset:18432
v_fma_f32 v95,v95,s36,v15
v_mfma_f32_16x16x32_bf16 v[204:207],v[124:127],v[20:23],v[204:207]
v_cvt_pk_bf16_f32 v20,v76,v77
v_cvt_pk_bf16_f32 v21,v78,v79
v_mfma_f32_16x16x32_bf16 v[252:255],v[124:127],v[26:29],v[252:255]
v_exp_f32 v84,v84
v_mfma_f32_16x16x32_bf16 v[52:55],v[48:51],v[18:21],v[52:55]
v_exp_f32 v85,v85
v_mfma_f32_16x16x32_bf16 a[44:47],v[124:127],v[32:35],a[44:47]
buffer_load_dwordx4 v7,s[8:11],s21 offen offset:1024 lds
v_mfma_f32_16x16x32_bf16 a[92:95],v[124:127],v[38:41],a[92:95]
s_waitcnt lgkmcnt(1)
ds_read_b128 v[124:127],v1 offset:18432
v_cvt_pk_bf16_f32 v26,v84,v85
v_mfma_f32_16x16x32_bf16 v[72:75],v[128:131],a[144:147],0
v_exp_f32 v86,v86
v_mfma_f32_16x16x32_bf16 v[80:83],v[128:131],a[168:171],0
v_exp_f32 v87,v87
v_mfma_f32_16x16x32_bf16 v[88:91],v[128:131],a[192:195],0
v_cvt_pk_bf16_f32 v27,v86,v87
v_fma_f32 v100,v100,s36,v16
v_mfma_f32_16x16x32_bf16 v[96:99],v[128:131],a[216:219],0
ds_read_b128 v[128:131],v0 offset:18560
v_fma_f32 v101,v101,s36,v16
v_mfma_f32_16x16x32_bf16 v[56:59],v[48:51],v[24:27],v[56:59]
v_exp_f32 v92,v92
v_mfma_f32_16x16x32_bf16 v[72:75],v[132:135],a[148:151],v[72:75]
v_exp_f32 v93,v93
v_mfma_f32_16x16x32_bf16 v[80:83],v[132:135],a[172:175],v[80:83]
v_exp_f32 v94,v94
v_mfma_f32_16x16x32_bf16 v[88:91],v[132:135],a[196:199],v[88:91]
buffer_load_dwordx4 v8,s[8:11],s21 offen offset:2048 lds
v_mfma_f32_16x16x32_bf16 v[96:99],v[132:135],a[220:223],v[96:99]
s_add_u32 s21,s21,12288
v_exp_f32 v95,v95
v_mfma_f32_16x16x32_bf16 v[72:75],v[136:139],a[152:155],v[72:75]
s_add_u32 m0,s22,0
v_fma_f32 v102,v102,s36,v16
v_fma_f32 v103,v103,s36,v16
v_mfma_f32_16x16x32_bf16 v[80:83],v[136:139],a[176:179],v[80:83]
v_cvt_pk_bf16_f32 v32,v92,v93
v_cvt_pk_bf16_f32 v33,v94,v95
v_mfma_f32_16x16x32_bf16 v[88:91],v[136:139],a[200:203],v[88:91]
v_exp_f32 v100,v100
v_mfma_f32_16x16x32_bf16 v[60:63],v[48:51],v[30:33],v[60:63]
v_exp_f32 v101,v101
v_mfma_f32_16x16x32_bf16 v[96:99],v[136:139],a[224:227],v[96:99]
v_exp_f32 v102,v102
v_mfma_f32_16x16x32_bf16 v[72:75],v[140:143],a[156:159],v[72:75]
v_exp_f32 v103,v103
v_mfma_f32_16x16x32_bf16 v[80:83],v[140:143],a[180:183],v[80:83]
v_cvt_pk_bf16_f32 v38,v100,v101
v_cvt_pk_bf16_f32 v39,v102,v103
v_mfma_f32_16x16x32_bf16 v[88:91],v[140:143],a[204:207],v[88:91]
buffer_load_dwordx4 v6,s[4:7],s20 offen offset:0 lds
v_mfma_f32_16x16x32_bf16 v[64:67],v[48:51],v[36:39],v[64:67]
ds_read_b128 v[132:135],v1 offset:18560
v_mfma_f32_16x16x32_bf16 v[96:99],v[140:143],a[228:231],v[96:99]
ds_read_b128 v[136:139],v0 offset:18688
v_mfma_f32_16x16x32_bf16 v[72:75],v[112:115],a[160:163],v[72:75]
ds_read_b128 v[140:143],v1 offset:18688
v_mfma_f32_16x16x32_bf16 v[80:83],v[112:115],a[184:187],v[80:83]
v_mfma_f32_16x16x32_bf16 v[88:91],v[112:115],a[208:211],v[88:91]
v_mfma_f32_16x16x32_bf16 v[96:99],v[112:115],a[232:235],v[96:99]
v_mfma_f32_16x16x32_bf16 v[72:75],v[116:119],a[164:167],v[72:75]
v_mfma_f32_16x16x32_bf16 v[80:83],v[116:119],a[188:191],v[80:83]
v_mfma_f32_16x16x32_bf16 v[88:91],v[116:119],a[212:215],v[88:91]
buffer_load_dwordx4 v7,s[4:7],s20 offen offset:1024 lds
v_mfma_f32_16x16x32_bf16 v[96:99],v[116:119],a[236:239],v[96:99]
s_waitcnt lgkmcnt(1)
v_mfma_f32_16x16x32_bf16 v[76:79],v[120:123],a[144:147],0
v_mfma_f32_16x16x32_bf16 v[84:87],v[120:123],a[168:171],0
v_mfma_f32_16x16x32_bf16 v[92:95],v[120:123],a[192:195],0
v_mfma_f32_16x16x32_bf16 v[100:103],v[120:123],a[216:219],0
v_fma_f32 v72,v72,s36,v13
v_fma_f32 v73,v73,s36,v13
v_mfma_f32_16x16x32_bf16 v[76:79],v[124:127],a[148:151],v[76:79]
v_fma_f32 v74,v74,s36,v13
v_fma_f32 v75,v75,s36,v13
v_mfma_f32_16x16x32_bf16 v[84:87],v[124:127],a[172:175],v[84:87]
v_fma_f32 v80,v80,s36,v14
v_fma_f32 v81,v81,s36,v14
v_mfma_f32_16x16x32_bf16 v[92:95],v[124:127],a[196:199],v[92:95]
v_exp_f32 v72,v72
v_mfma_f32_16x16x32_bf16 v[100:103],v[124:127],a[220:223],v[100:103]
buffer_load_dwordx4 v8,s[4:7],s20 offen offset:2048 lds
v_mfma_f32_16x16x32_bf16 v[76:79],v[128:131],a[152:155],v[76:79]
s_add_u32 s20,s20,12288
ds_read_b64_tr_b16 v[112:113],v2 offset:0
v_mfma_f32_16x16x32_bf16 v[84:87],v[128:131],a[176:179],v[84:87]
ds_read_b64_tr_b16 v[114:115],v2 offset:6144
v_mfma_f32_16x16x32_bf16 v[92:95],v[128:131],a[200:203],v[92:95]
ds_read_b64_tr_b16 v[116:117],v3 offset:0
v_mfma_f32_16x16x32_bf16 v[100:103],v[128:131],a[224:227],v[100:103]
ds_read_b64_tr_b16 v[118:119],v3 offset:6144
v_mfma_f32_16x16x32_bf16 v[76:79],v[132:135],a[156:159],v[76:79]
ds_read_b64_tr_b16 v[120:121],v4 offset:0
v_mfma_f32_16x16x32_bf16 v[84:87],v[132:135],a[180:183],v[84:87]
ds_read_b64_tr_b16 v[122:123],v4 offset:6144
v_mfma_f32_16x16x32_bf16 v[92:95],v[132:135],a[204:207],v[92:95]
ds_read_b64_tr_b16 v[124:125],v5 offset:0
v_mfma_f32_16x16x32_bf16 v[100:103],v[132:135],a[228:231],v[100:103]
ds_read_b64_tr_b16 v[126:127],v5 offset:6144
v_mfma_f32_16x16x32_bf16 v[76:79],v[136:139],a[160:163],v[76:79]
v_exp_f32 v73,v73
v_mfma_f32_16x16x32_bf16 v[84:87],v[136:139],a[184:187],v[84:87]
v_exp_f32 v74,v74
v_mfma_f32_16x16x32_bf16 v[92:95],v[136:139],a[208:211],v[92:95]
v_exp_f32 v75,v75
v_mfma_f32_16x16x32_bf16 v[100:103],v[136:139],a[232:235],v[100:103]
s_waitcnt lgkmcnt(5)
v_exp_f32 v80,v80
v_mfma_f32_16x16x32_bf16 v[76:79],v[140:143],a[164:167],v[76:79]
v_exp_f32 v81,v81
v_mfma_f32_16x16x32_bf16 v[84:87],v[140:143],a[188:191],v[84:87]
v_cvt_pk_bf16_f32 v22,v72,v73
v_cvt_pk_bf16_f32 v23,v74,v75
v_mfma_f32_16x16x32_bf16 v[92:95],v[140:143],a[212:215],v[92:95]
v_cvt_pk_bf16_f32 v28,v80,v81
v_mfma_f32_16x16x32_bf16 v[100:103],v[140:143],a[236:239],v[100:103]
v_mfma_f32_16x16x32_bf16 v[160:163],v[112:115],v[18:21],v[160:163]
s_add_u32 m0,s23,0
ds_read_b64_tr_b16 v[128:129],v2 offset:128
ds_read_b64_tr_b16 v[130:131],v2 offset:6272
v_mfma_f32_16x16x32_bf16 v[208:211],v[112:115],v[24:27],v[208:211]
ds_read_b64_tr_b16 v[132:133],v3 offset:128
ds_read_b64_tr_b16 v[134:135],v3 offset:6272
v_mfma_f32_16x16x32_bf16 a[0:3],v[112:115],v[30:33],a[0:3]
ds_read_b64_tr_b16 v[136:137],v4 offset:128
ds_read_b64_tr_b16 v[138:139],v4 offset:6272
v_mfma_f32_16x16x32_bf16 a[48:51],v[112:115],v[36:39],a[48:51]
s_waitcnt lgkmcnt(6)
ds_read_b64_tr_b16 v[140:141],v5 offset:128
ds_read_b64_tr_b16 v[142:143],v5 offset:6272
v_mfma_f32_16x16x32_bf16 v[164:167],v[116:119],v[18:21],v[164:167]
ds_read_b64_tr_b16 v[112:113],v2 offset:256
ds_read_b64_tr_b16 v[114:115],v2 offset:6400
v_mfma_f32_16x16x32_bf16 v[212:215],v[116:119],v[24:27],v[212:215]
v_fma_f32 v82,v82,s36,v14
v_fma_f32 v83,v83,s36,v14
v_mfma_f32_16x16x32_bf16 a[4:7],v[116:119],v[30:33],a[4:7]
v_exp_f32 v82,v82
v_mfma_f32_16x16x32_bf16 a[52:55],v[116:119],v[36:39],a[52:55]
ds_read_b64_tr_b16 v[116:117],v3 offset:256
ds_read_b64_tr_b16 v[118:119],v3 offset:6400
v_mfma_f32_16x16x32_bf16 v[168:171],v[120:123],v[18:21],v[168:171]
v_exp_f32 v83,v83
v_mfma_f32_16x16x32_bf16 v[216:219],v[120:123],v[24:27],v[216:219]
v_cvt_pk_bf16_f32 v29,v82,v83
v_fma_f32 v88,v88,s36,v15
v_mfma_f32_16x16x32_bf16 a[8:11],v[120:123],v[30:33],a[8:11]
v_fma_f32 v89,v89,s36,v15
v_fma_f32 v90,v90,s36,v15
v_mfma_f32_16x16x32_bf16 a[56:59],v[120:123],v[36:39],a[56:59]
ds_read_b64_tr_b16 v[120:121],v4 offset:256
ds_read_b64_tr_b16 v[122:123],v4 offset:6400
v_mfma_f32_16x16x32_bf16 v[172:175],v[124:127],v[18:21],v[172:175]
v_fma_f32 v91,v91,s36,v15
v_fma_f32 v96,v96,s36,v16
v_mfma_f32_16x16x32_bf16 v[220:223],v[124:127],v[24:27],v[220:223]
v_exp_f32 v88,v88
v_mfma_f32_16x16x32_bf16 a[12:15],v[124:127],v[30:33],a[12:15]
v_exp_f32 v89,v89
v_mfma_f32_16x16x32_bf16 a[60:63],v[124:127],v[36:39],a[60:63]
s_waitcnt lgkmcnt(4)
ds_read_b64_tr_b16 v[124:125],v5 offset:256
ds_read_b64_tr_b16 v[126:127],v5 offset:6400
v_mfma_f32_16x16x32_bf16 v[176:179],v[128:131],v[18:21],v[176:179]
v_exp_f32 v90,v90
v_mfma_f32_16x16x32_bf16 v[224:227],v[128:131],v[24:27],v[224:227]
v_exp_f32 v91,v91
v_mfma_f32_16x16x32_bf16 a[16:19],v[128:131],v[30:33],a[16:19]
v_cvt_pk_bf16_f32 v34,v88,v89
v_cvt_pk_bf16_f32 v35,v90,v91
v_mfma_f32_16x16x32_bf16 a[64:67],v[128:131],v[36:39],a[64:67]
v_fma_f32 v97,v97,s36,v16
v_fma_f32 v98,v98,s36,v16
v_mfma_f32_16x16x32_bf16 v[180:183],v[132:135],v[18:21],v[180:183]
v_fma_f32 v99,v99,s36,v16
v_fma_f32 v76,v76,s36,v13
v_mfma_f32_16x16x32_bf16 v[228:231],v[132:135],v[24:27],v[228:231]
v_exp_f32 v96,v96
v_mfma_f32_16x16x32_bf16 a[20:23],v[132:135],v[30:33],a[20:23]
v_exp_f32 v97,v97
v_mfma_f32_16x16x32_bf16 a[68:71],v[132:135],v[36:39],a[68:71]
v_exp_f32 v98,v98
v_mfma_f32_16x16x32_bf16 v[184:187],v[136:139],v[18:21],v[184:187]
v_exp_f32 v99,v99
v_mfma_f32_16x16x32_bf16 v[232:235],v[136:139],v[24:27],v[232:235]
v_cvt_pk_bf16_f32 v40,v96,v97
v_cvt_pk_bf16_f32 v41,v98,v99
v_mfma_f32_16x16x32_bf16 a[24:27],v[136:139],v[30:33],a[24:27]
v_fma_f32 v77,v77,s36,v13
v_fma_f32 v78,v78,s36,v13
v_mfma_f32_16x16x32_bf16 a[72:75],v[136:139],v[36:39],a[72:75]
v_fma_f32 v79,v79,s36,v13
v_fma_f32 v84,v84,s36,v14
v_mfma_f32_16x16x32_bf16 v[188:191],v[140:143],v[18:21],v[188:191]
v_exp_f32 v76,v76
v_mfma_f32_16x16x32_bf16 v[236:239],v[140:143],v[24:27],v[236:239]
v_exp_f32 v77,v77
v_mfma_f32_16x16x32_bf16 a[28:31],v[140:143],v[30:33],a[28:31]
v_exp_f32 v78,v78
v_mfma_f32_16x16x32_bf16 a[76:79],v[140:143],v[36:39],a[76:79]
v_exp_f32 v79,v79
v_mfma_f32_16x16x32_bf16 v[192:195],v[112:115],v[18:21],v[192:195]
v_fma_f32 v85,v85,s36,v14
v_fma_f32 v86,v86,s36,v14
s_waitcnt vmcnt(9) lgkmcnt(0)
v_mfma_f32_16x16x32_bf16 v[240:243],v[112:115],v[24:27],v[240:243]
s_barrier
v_mfma_f32_16x16x32_bf16 a[32:35],v[112:115],v[30:33],a[32:35]
ds_read_b128 v[128:131],v0 offset:24576
v_fma_f32 v87,v87,s36,v14
v_mfma_f32_16x16x32_bf16 a[80:83],v[112:115],v[36:39],a[80:83]
ds_read_b128 v[132:135],v1 offset:24576
v_fma_f32 v92,v92,s36,v15
v_mfma_f32_16x16x32_bf16 v[196:199],v[116:119],v[18:21],v[196:199]
ds_read_b128 v[136:139],v0 offset:24704
v_fma_f32 v93,v93,s36,v15
v_mfma_f32_16x16x32_bf16 v[244:247],v[116:119],v[24:27],v[244:247]
ds_read_b128 v[140:143],v1 offset:24704
v_fma_f32 v94,v94,s36,v15
v_mfma_f32_16x16x32_bf16 a[36:39],v[116:119],v[30:33],a[36:39]
ds_read_b128 v[156:159],v10 offset:6144
v_fma_f32 v95,v95,s36,v15
v_mfma_f32_16x16x32_bf16 a[84:87],v[116:119],v[36:39],a[84:87]
buffer_load_dwordx4 v6,s[8:11],s21 offen offset:0 lds
v_mfma_f32_16x16x32_bf16 v[200:203],v[120:123],v[18:21],v[200:203]
ds_read_b128 v[112:115],v0 offset:24832
v_fma_f32 v100,v100,s36,v16
v_mfma_f32_16x16x32_bf16 v[248:251],v[120:123],v[24:27],v[248:251]
ds_read_b128 v[116:119],v1 offset:24832
v_fma_f32 v101,v101,s36,v16
v_mfma_f32_16x16x32_bf16 a[40:43],v[120:123],v[30:33],a[40:43]
v_exp_f32 v84,v84
v_mfma_f32_16x16x32_bf16 a[88:91],v[120:123],v[36:39],a[88:91]
ds_read_b128 v[120:123],v0 offset:30720
v_fma_f32 v102,v102,s36,v16
v_mfma_f32_16x16x32_bf16 v[204:207],v[124:127],v[18:21],v[204:207]
v_cvt_pk_bf16_f32 v20,v76,v77
v_cvt_pk_bf16_f32 v21,v78,v79
v_mfma_f32_16x16x32_bf16 v[252:255],v[124:127],v[24:27],v[252:255]
v_exp_f32 v85,v85
v_mfma_f32_16x16x32_bf16 v[52:55],v[48:51],v[20:23],v[52:55]
v_exp_f32 v86,v86
v_mfma_f32_16x16x32_bf16 a[44:47],v[124:127],v[30:33],a[44:47]
v_exp_f32 v87,v87
v_mfma_f32_16x16x32_bf16 a[92:95],v[124:127],v[36:39],a[92:95]
s_waitcnt lgkmcnt(3)
buffer_store_dwordx4 v[156:159],v9,s[16:19],s27 offen offset:0 nt
buffer_load_dwordx4 v7,s[8:11],s21 offen offset:1024 lds
v_mfma_f32_16x16x32_bf16 v[72:75],v[128:131],a[144:147],0
ds_read_b128 v[152:155],v10 offset:7168
v_mfma_f32_16x16x32_bf16 v[80:83],v[128:131],a[168:171],0
ds_read_b128 v[124:127],v1 offset:30720
v_cvt_pk_bf16_f32 v26,v84,v85
v_mfma_f32_16x16x32_bf16 v[88:91],v[128:131],a[192:195],0
v_cvt_pk_bf16_f32 v27,v86,v87
v_fma_f32 v103,v103,s36,v16
v_mfma_f32_16x16x32_bf16 v[96:99],v[128:131],a[216:219],0
ds_read_b128 v[128:131],v0 offset:30848
v_mfma_f32_16x16x32_bf16 v[56:59],v[48:51],v[26:29],v[56:59]
v_exp_f32 v92,v92
v_mfma_f32_16x16x32_bf16 v[72:75],v[132:135],a[148:151],v[72:75]
v_exp_f32 v93,v93
v_mfma_f32_16x16x32_bf16 v[80:83],v[132:135],a[172:175],v[80:83]
v_exp_f32 v94,v94
v_mfma_f32_16x16x32_bf16 v[88:91],v[132:135],a[196:199],v[88:91]
buffer_load_dwordx4 v8,s[8:11],s21 offen offset:2048 lds
v_mfma_f32_16x16x32_bf16 v[96:99],v[132:135],a[220:223],v[96:99]
s_add_u32 s21,s21,12288
v_exp_f32 v95,v95
v_mfma_f32_16x16x32_bf16 v[72:75],v[136:139],a[152:155],v[72:75]
s_cmp_eq_u32 s38,1
v_cvt_pk_bf16_f32 v32,v92,v93
v_cvt_pk_bf16_f32 v33,v94,v95
v_mfma_f32_16x16x32_bf16 v[80:83],v[136:139],a[176:179],v[80:83]
s_cselect_b32 s20,s26,s20
v_exp_f32 v100,v100
v_mfma_f32_16x16x32_bf16 v[60:63],v[48:51],v[32:35],v[60:63]
s_add_u32 m0,s22,12288
v_exp_f32 v101,v101
v_mfma_f32_16x16x32_bf16 v[88:91],v[136:139],a[200:203],v[88:91]
v_exp_f32 v102,v102
v_mfma_f32_16x16x32_bf16 v[96:99],v[136:139],a[224:227],v[96:99]
v_exp_f32 v103,v103
v_mfma_f32_16x16x32_bf16 v[72:75],v[140:143],a[156:159],v[72:75]
v_cvt_pk_bf16_f32 v38,v100,v101
v_cvt_pk_bf16_f32 v39,v102,v103
v_mfma_f32_16x16x32_bf16 v[80:83],v[140:143],a[180:183],v[80:83]
ds_read_b128 v[132:135],v1 offset:30848
v_mfma_f32_16x16x32_bf16 v[64:67],v[48:51],v[38:41],v[64:67]
s_waitcnt lgkmcnt(1)
buffer_store_dwordx4 v[152:155],v9,s[16:19],s27 offen offset:128 nt
buffer_load_dwordx4 v6,s[4:7],s20 offen offset:0 lds
v_mfma_f32_16x16x32_bf16 v[88:91],v[140:143],a[204:207],v[88:91]
ds_read_b128 v[156:159],v10 offset:8192
v_mfma_f32_16x16x32_bf16 v[96:99],v[140:143],a[228:231],v[96:99]
ds_read_b128 v[136:139],v0 offset:30976
v_mfma_f32_16x16x32_bf16 v[72:75],v[112:115],a[160:163],v[72:75]
ds_read_b128 v[140:143],v1 offset:30976
v_mfma_f32_16x16x32_bf16 v[80:83],v[112:115],a[184:187],v[80:83]
v_mfma_f32_16x16x32_bf16 v[88:91],v[112:115],a[208:211],v[88:91]
v_mfma_f32_16x16x32_bf16 v[96:99],v[112:115],a[232:235],v[96:99]
v_mfma_f32_16x16x32_bf16 v[72:75],v[116:119],a[164:167],v[72:75]
v_mfma_f32_16x16x32_bf16 v[80:83],v[116:119],a[188:191],v[80:83]
buffer_load_dwordx4 v7,s[4:7],s20 offen offset:1024 lds
v_mfma_f32_16x16x32_bf16 v[88:91],v[116:119],a[212:215],v[88:91]
v_mfma_f32_16x16x32_bf16 v[96:99],v[116:119],a[236:239],v[96:99]
v_mfma_f32_16x16x32_bf16 v[76:79],v[120:123],a[144:147],0
v_mfma_f32_16x16x32_bf16 v[84:87],v[120:123],a[168:171],0
v_mfma_f32_16x16x32_bf16 v[92:95],v[120:123],a[192:195],0
v_mfma_f32_16x16x32_bf16 v[100:103],v[120:123],a[216:219],0
v_fma_f32 v72,v72,s36,v13
v_fma_f32 v73,v73,s36,v13
v_mfma_f32_16x16x32_bf16 v[76:79],v[124:127],a[148:151],v[76:79]
v_fma_f32 v74,v74,s36,v13
v_fma_f32 v75,v75,s36,v13
v_mfma_f32_16x16x32_bf16 v[84:87],v[124:127],a[172:175],v[84:87]
v_fma_f32 v80,v80,s36,v14
v_fma_f32 v81,v81,s36,v14
v_mfma_f32_16x16x32_bf16 v[92:95],v[124:127],a[196:199],v[92:95]
s_waitcnt lgkmcnt(0)
buffer_store_dwordx4 v[156:159],v9,s[16:19],s27 offen offset:256 nt
buffer_load_dwordx4 v8,s[4:7],s20 offen offset:2048 lds
v_mfma_f32_16x16x32_bf16 v[100:103],v[124:127],a[220:223],v[100:103]
s_add_u32 s20,s20,12288
ds_read_b64_tr_b16 v[112:113],v2 offset:18432
v_mfma_f32_16x16x32_bf16 v[76:79],v[128:131],a[152:155],v[76:79]
s_add_u32 s27,s27,3072
ds_read_b64_tr_b16 v[114:115],v2 offset:12288
v_mfma_f32_16x16x32_bf16 v[84:87],v[128:131],a[176:179],v[84:87]
ds_read_b64_tr_b16 v[116:117],v3 offset:18432
v_mfma_f32_16x16x32_bf16 v[92:95],v[128:131],a[200:203],v[92:95]
ds_read_b64_tr_b16 v[118:119],v3 offset:12288
v_mfma_f32_16x16x32_bf16 v[100:103],v[128:131],a[224:227],v[100:103]
ds_read_b64_tr_b16 v[120:121],v4 offset:18432
v_mfma_f32_16x16x32_bf16 v[76:79],v[132:135],a[156:159],v[76:79]
ds_read_b64_tr_b16 v[122:123],v4 offset:12288
v_mfma_f32_16x16x32_bf16 v[84:87],v[132:135],a[180:183],v[84:87]
ds_read_b64_tr_b16 v[124:125],v5 offset:18432
v_mfma_f32_16x16x32_bf16 v[92:95],v[132:135],a[204:207],v[92:95]
ds_read_b64_tr_b16 v[126:127],v5 offset:12288
v_mfma_f32_16x16x32_bf16 v[100:103],v[132:135],a[228:231],v[100:103]
v_exp_f32 v72,v72
v_mfma_f32_16x16x32_bf16 v[76:79],v[136:139],a[160:163],v[76:79]
v_exp_f32 v73,v73
v_mfma_f32_16x16x32_bf16 v[84:87],v[136:139],a[184:187],v[84:87]
v_exp_f32 v74,v74
v_mfma_f32_16x16x32_bf16 v[92:95],v[136:139],a[208:211],v[92:95]
v_exp_f32 v75,v75
v_mfma_f32_16x16x32_bf16 v[100:103],v[136:139],a[232:235],v[100:103]
v_exp_f32 v80,v80
v_mfma_f32_16x16x32_bf16 v[76:79],v[140:143],a[164:167],v[76:79]
v_exp_f32 v81,v81
v_mfma_f32_16x16x32_bf16 v[84:87],v[140:143],a[188:191],v[84:87]
v_cvt_pk_bf16_f32 v18,v72,v73
v_cvt_pk_bf16_f32 v19,v74,v75
v_mfma_f32_16x16x32_bf16 v[92:95],v[140:143],a[212:215],v[92:95]
v_cvt_pk_bf16_f32 v24,v80,v81
v_mfma_f32_16x16x32_bf16 v[100:103],v[140:143],a[236:239],v[100:103]
s_waitcnt lgkmcnt(0)
v_mfma_f32_16x16x32_bf16 v[160:163],v[112:115],v[20:23],v[160:163]
s_add_u32 m0,s29,0
ds_read_b64_tr_b16 v[128:129],v2 offset:18560
ds_read_b64_tr_b16 v[130:131],v2 offset:12416
v_mfma_f32_16x16x32_bf16 v[208:211],v[112:115],v[26:29],v[208:211]
ds_read_b64_tr_b16 v[132:133],v3 offset:18560
ds_read_b64_tr_b16 v[134:135],v3 offset:12416
v_mfma_f32_16x16x32_bf16 a[0:3],v[112:115],v[32:35],a[0:3]
ds_read_b64_tr_b16 v[136:137],v4 offset:18560
ds_read_b64_tr_b16 v[138:139],v4 offset:12416
v_mfma_f32_16x16x32_bf16 a[48:51],v[112:115],v[38:41],a[48:51]
ds_read_b64_tr_b16 v[140:141],v5 offset:18560
ds_read_b64_tr_b16 v[142:143],v5 offset:12416
v_mfma_f32_16x16x32_bf16 v[164:167],v[116:119],v[20:23],v[164:167]
ds_read_b64_tr_b16 v[112:113],v2 offset:18688
ds_read_b64_tr_b16 v[114:115],v2 offset:12544
v_mfma_f32_16x16x32_bf16 v[212:215],v[116:119],v[26:29],v[212:215]
v_fma_f32 v82,v82,s36,v14
v_fma_f32 v83,v83,s36,v14
v_mfma_f32_16x16x32_bf16 a[4:7],v[116:119],v[32:35],a[4:7]
buffer_load_dwordx4 v6,s[12:15],s28 offen offset:0 nt lds
v_mfma_f32_16x16x32_bf16 a[52:55],v[116:119],v[38:41],a[52:55]
ds_read_b64_tr_b16 v[116:117],v3 offset:18688
ds_read_b64_tr_b16 v[118:119],v3 offset:12544
v_mfma_f32_16x16x32_bf16 v[168:171],v[120:123],v[20:23],v[168:171]
v_exp_f32 v82,v82
v_mfma_f32_16x16x32_bf16 v[216:219],v[120:123],v[26:29],v[216:219]
v_exp_f32 v83,v83
v_mfma_f32_16x16x32_bf16 a[8:11],v[120:123],v[32:35],a[8:11]
v_cvt_pk_bf16_f32 v25,v82,v83
v_fma_f32 v88,v88,s36,v15
v_mfma_f32_16x16x32_bf16 a[56:59],v[120:123],v[38:41],a[56:59]
ds_read_b64_tr_b16 v[120:121],v4 offset:18688
ds_read_b64_tr_b16 v[122:123],v4 offset:12544
v_mfma_f32_16x16x32_bf16 v[172:175],v[124:127],v[20:23],v[172:175]
v_fma_f32 v89,v89,s36,v15
v_fma_f32 v90,v90,s36,v15
v_mfma_f32_16x16x32_bf16 v[220:223],v[124:127],v[26:29],v[220:223]
buffer_load_dwordx4 v7,s[12:15],s28 offen offset:1024 nt lds
v_mfma_f32_16x16x32_bf16 a[12:15],v[124:127],v[32:35],a[12:15]
v_fma_f32 v91,v91,s36,v15
v_fma_f32 v96,v96,s36,v16
v_mfma_f32_16x16x32_bf16 a[60:63],v[124:127],v[38:41],a[60:63]
s_waitcnt lgkmcnt(3)
ds_read_b64_tr_b16 v[124:125],v5 offset:18688
ds_read_b64_tr_b16 v[126:127],v5 offset:12544
v_mfma_f32_16x16x32_bf16 v[176:179],v[128:131],v[20:23],v[176:179]
v_exp_f32 v88,v88
v_mfma_f32_16x16x32_bf16 v[224:227],v[128:131],v[26:29],v[224:227]
v_exp_f32 v89,v89
v_mfma_f32_16x16x32_bf16 a[16:19],v[128:131],v[32:35],a[16:19]
v_exp_f32 v90,v90
v_mfma_f32_16x16x32_bf16 a[64:67],v[128:131],v[38:41],a[64:67]
v_exp_f32 v91,v91
v_mfma_f32_16x16x32_bf16 v[180:183],v[132:135],v[20:23],v[180:183]
v_cvt_pk_bf16_f32 v30,v88,v89
v_cvt_pk_bf16_f32 v31,v90,v91
v_mfma_f32_16x16x32_bf16 v[228:231],v[132:135],v[26:29],v[228:231]
buffer_load_dwordx4 v8,s[12:15],s28 offen offset:2048 nt lds
v_mfma_f32_16x16x32_bf16 a[20:23],v[132:135],v[32:35],a[20:23]
s_add_u32 s28,s28,3072
v_fma_f32 v97,v97,s36,v16
v_fma_f32 v98,v98,s36,v16
v_mfma_f32_16x16x32_bf16 a[68:71],v[132:135],v[38:41],a[68:71]
s_add_u32 s29,s29,3072
v_fma_f32 v99,v99,s36,v16
v_fma_f32 v76,v76,s36,v13
v_mfma_f32_16x16x32_bf16 v[184:187],v[136:139],v[20:23],v[184:187]
s_cmp_eq_u32 s38,1
v_exp_f32 v96,v96
v_mfma_f32_16x16x32_bf16 v[232:235],v[136:139],v[26:29],v[232:235]
s_cselect_b32 s21,s26,s21
v_exp_f32 v97,v97
v_mfma_f32_16x16x32_bf16 a[24:27],v[136:139],v[32:35],a[24:27]
s_add_u32 m0,s23,12288
v_exp_f32 v98,v98
v_mfma_f32_16x16x32_bf16 a[72:75],v[136:139],v[38:41],a[72:75]
v_exp_f32 v99,v99
v_mfma_f32_16x16x32_bf16 v[188:191],v[140:143],v[20:23],v[188:191]
v_cvt_pk_bf16_f32 v36,v96,v97
v_cvt_pk_bf16_f32 v37,v98,v99
v_mfma_f32_16x16x32_bf16 v[236:239],v[140:143],v[26:29],v[236:239]
v_fma_f32 v77,v77,s36,v13
v_fma_f32 v78,v78,s36,v13
v_mfma_f32_16x16x32_bf16 a[28:31],v[140:143],v[32:35],a[28:31]
v_fma_f32 v79,v79,s36,v13
v_fma_f32 v84,v84,s36,v14
v_mfma_f32_16x16x32_bf16 a[76:79],v[140:143],v[38:41],a[76:79]
v_exp_f32 v76,v76
s_waitcnt vmcnt(12) lgkmcnt(0)
v_mfma_f32_16x16x32_bf16 v[192:195],v[112:115],v[20:23],v[192:195]
s_barrier
v_mfma_f32_16x16x32_bf16 v[240:243],v[112:115],v[26:29],v[240:243]
ds_read_b128 v[128:131],v0 offset:0
v_fma_f32 v85,v85,s36,v14
v_mfma_f32_16x16x32_bf16 a[32:35],v[112:115],v[32:35],a[32:35]
ds_read_b128 v[132:135],v1 offset:0
v_fma_f32 v86,v86,s36,v14
v_mfma_f32_16x16x32_bf16 a[80:83],v[112:115],v[38:41],a[80:83]
ds_read_b128 v[136:139],v0 offset:128
v_fma_f32 v87,v87,s36,v14
v_mfma_f32_16x16x32_bf16 v[196:199],v[116:119],v[20:23],v[196:199]
ds_read_b128 v[140:143],v1 offset:128
v_fma_f32 v92,v92,s36,v15
v_mfma_f32_16x16x32_bf16 v[244:247],v[116:119],v[26:29],v[244:247]
ds_read_b128 v[112:115],v0 offset:256
v_fma_f32 v93,v93,s36,v15
v_mfma_f32_16x16x32_bf16 a[36:39],v[116:119],v[32:35],a[36:39]
buffer_load_dwordx4 v6,s[8:11],s21 offen offset:0 lds
v_mfma_f32_16x16x32_bf16 a[84:87],v[116:119],v[38:41],a[84:87]
ds_read_b128 v[116:119],v1 offset:256
v_fma_f32 v94,v94,s36,v15
v_mfma_f32_16x16x32_bf16 v[200:203],v[120:123],v[20:23],v[200:203]
v_exp_f32 v77,v77
v_mfma_f32_16x16x32_bf16 v[248:251],v[120:123],v[26:29],v[248:251]
v_exp_f32 v78,v78
v_mfma_f32_16x16x32_bf16 a[40:43],v[120:123],v[32:35],a[40:43]
v_exp_f32 v79,v79
v_mfma_f32_16x16x32_bf16 a[88:91],v[120:123],v[38:41],a[88:91]
ds_read_b128 v[120:123],v0 offset:6144
v_fma_f32 v95,v95,s36,v15
v_mfma_f32_16x16x32_bf16 v[204:207],v[124:127],v[20:23],v[204:207]
v_cvt_pk_bf16_f32 v20,v76,v77
v_cvt_pk_bf16_f32 v21,v78,v79
v_mfma_f32_16x16x32_bf16 v[252:255],v[124:127],v[26:29],v[252:255]
v_exp_f32 v84,v84
v_mfma_f32_16x16x32_bf16 v[52:55],v[48:51],v[18:21],v[52:55]
v_exp_f32 v85,v85
v_mfma_f32_16x16x32_bf16 a[44:47],v[124:127],v[32:35],a[44:47]
buffer_load_dwordx4 v7,s[8:11],s21 offen offset:1024 lds
v_mfma_f32_16x16x32_bf16 a[92:95],v[124:127],v[38:41],a[92:95]
s_waitcnt lgkmcnt(1)
ds_read_b128 v[124:127],v1 offset:6144
v_cvt_pk_bf16_f32 v26,v84,v85
v_mfma_f32_16x16x32_bf16 v[72:75],v[128:131],a[144:147],0
v_exp_f32 v86,v86
v_mfma_f32_16x16x32_bf16 v[80:83],v[128:131],a[168:171],0
v_exp_f32 v87,v87
v_mfma_f32_16x16x32_bf16 v[88:91],v[128:131],a[192:195],0
v_cvt_pk_bf16_f32 v27,v86,v87
v_fma_f32 v100,v100,s36,v16
v_mfma_f32_16x16x32_bf16 v[96:99],v[128:131],a[216:219],0
ds_read_b128 v[128:131],v0 offset:6272
v_fma_f32 v101,v101,s36,v16
v_mfma_f32_16x16x32_bf16 v[56:59],v[48:51],v[24:27],v[56:59]
v_exp_f32 v92,v92
v_mfma_f32_16x16x32_bf16 v[72:75],v[132:135],a[148:151],v[72:75]
v_exp_f32 v93,v93
v_mfma_f32_16x16x32_bf16 v[80:83],v[132:135],a[172:175],v[80:83]
v_exp_f32 v94,v94
v_mfma_f32_16x16x32_bf16 v[88:91],v[132:135],a[196:199],v[88:91]
buffer_load_dwordx4 v8,s[8:11],s21 offen offset:2048 lds
v_mfma_f32_16x16x32_bf16 v[96:99],v[132:135],a[220:223],v[96:99]
s_add_u32 s21,s21,12288
v_exp_f32 v95,v95
v_mfma_f32_16x16x32_bf16 v[72:75],v[136:139],a[152:155],v[72:75]
s_add_u32 m0,s22,24576
v_fma_f32 v102,v102,s36,v16
v_fma_f32 v103,v103,s36,v16
v_mfma_f32_16x16x32_bf16 v[80:83],v[136:139],a[176:179],v[80:83]
v_cvt_pk_bf16_f32 v32,v92,v93
v_cvt_pk_bf16_f32 v33,v94,v95
v_mfma_f32_16x16x32_bf16 v[88:91],v[136:139],a[200:203],v[88:91]
v_exp_f32 v100,v100
v_mfma_f32_16x16x32_bf16 v[60:63],v[48:51],v[30:33],v[60:63]
v_exp_f32 v101,v101
v_mfma_f32_16x16x32_bf16 v[96:99],v[136:139],a[224:227],v[96:99]
v_exp_f32 v102,v102
v_mfma_f32_16x16x32_bf16 v[72:75],v[140:143],a[156:159],v[72:75]
v_exp_f32 v103,v103
v_mfma_f32_16x16x32_bf16 v[80:83],v[140:143],a[180:183],v[80:83]
v_cvt_pk_bf16_f32 v38,v100,v101
v_cvt_pk_bf16_f32 v39,v102,v103
v_mfma_f32_16x16x32_bf16 v[88:91],v[140:143],a[204:207],v[88:91]
buffer_load_dwordx4 v6,s[4:7],s20 offen offset:0 lds
v_mfma_f32_16x16x32_bf16 v[64:67],v[48:51],v[36:39],v[64:67]
ds_read_b128 v[132:135],v1 offset:6272
v_add_u32 v10,9216,v10
v_mfma_f32_16x16x32_bf16 v[96:99],v[140:143],a[228:231],v[96:99]
ds_read_b128 v[136:139],v0 offset:6400
v_mfma_f32_16x16x32_bf16 v[72:75],v[112:115],a[160:163],v[72:75]
ds_read_b128 v[140:143],v1 offset:6400
v_mfma_f32_16x16x32_bf16 v[80:83],v[112:115],a[184:187],v[80:83]
v_mfma_f32_16x16x32_bf16 v[88:91],v[112:115],a[208:211],v[88:91]
v_mfma_f32_16x16x32_bf16 v[96:99],v[112:115],a[232:235],v[96:99]
v_mfma_f32_16x16x32_bf16 v[72:75],v[116:119],a[164:167],v[72:75]
v_mfma_f32_16x16x32_bf16 v[80:83],v[116:119],a[188:191],v[80:83]
v_mfma_f32_16x16x32_bf16 v[88:91],v[116:119],a[212:215],v[88:91]
buffer_load_dwordx4 v7,s[4:7],s20 offen offset:1024 lds
v_mfma_f32_16x16x32_bf16 v[96:99],v[116:119],a[236:239],v[96:99]
s_waitcnt lgkmcnt(1)
v_mfma_f32_16x16x32_bf16 v[76:79],v[120:123],a[144:147],0
v_mfma_f32_16x16x32_bf16 v[84:87],v[120:123],a[168:171],0
v_mfma_f32_16x16x32_bf16 v[92:95],v[120:123],a[192:195],0
v_mfma_f32_16x16x32_bf16 v[100:103],v[120:123],a[216:219],0
v_fma_f32 v72,v72,s36,v13
v_fma_f32 v73,v73,s36,v13
v_mfma_f32_16x16x32_bf16 v[76:79],v[124:127],a[148:151],v[76:79]
v_fma_f32 v74,v74,s36,v13
v_fma_f32 v75,v75,s36,v13
v_mfma_f32_16x16x32_bf16 v[84:87],v[124:127],a[172:175],v[84:87]
v_fma_f32 v80,v80,s36,v14
v_fma_f32 v81,v81,s36,v14
v_mfma_f32_16x16x32_bf16 v[92:95],v[124:127],a[196:199],v[92:95]
v_exp_f32 v72,v72
v_mfma_f32_16x16x32_bf16 v[100:103],v[124:127],a[220:223],v[100:103]
buffer_load_dwordx4 v8,s[4:7],s20 offen offset:2048 lds
v_mfma_f32_16x16x32_bf16 v[76:79],v[128:131],a[152:155],v[76:79]
s_add_u32 s20,s20,12288
s_add_u32 s38,s38,1
s_cmp_lt_u32 s38,2
v_mfma_f32_16x16x32_bf16 v[84:87],v[128:131],a[176:179],v[84:87]
ds_read_b64_tr_b16 v[112:113],v2 offset:24576
ds_read_b64_tr_b16 v[114:115],v2 offset:30720
v_mfma_f32_16x16x32_bf16 v[92:95],v[128:131],a[200:203],v[92:95]
ds_read_b64_tr_b16 v[116:117],v3 offset:24576
v_mfma_f32_16x16x32_bf16 v[100:103],v[128:131],a[224:227],v[100:103]
ds_read_b64_tr_b16 v[118:119],v3 offset:30720
v_mfma_f32_16x16x32_bf16 v[76:79],v[132:135],a[156:159],v[76:79]
ds_read_b64_tr_b16 v[120:121],v4 offset:24576
v_mfma_f32_16x16x32_bf16 v[84:87],v[132:135],a[180:183],v[84:87]
ds_read_b64_tr_b16 v[122:123],v4 offset:30720
v_mfma_f32_16x16x32_bf16 v[92:95],v[132:135],a[204:207],v[92:95]
ds_read_b64_tr_b16 v[124:125],v5 offset:24576
v_mfma_f32_16x16x32_bf16 v[100:103],v[132:135],a[228:231],v[100:103]
ds_read_b64_tr_b16 v[126:127],v5 offset:30720
v_mfma_f32_16x16x32_bf16 v[76:79],v[136:139],a[160:163],v[76:79]
v_exp_f32 v73,v73
v_mfma_f32_16x16x32_bf16 v[84:87],v[136:139],a[184:187],v[84:87]
v_exp_f32 v74,v74
v_mfma_f32_16x16x32_bf16 v[92:95],v[136:139],a[208:211],v[92:95]
v_exp_f32 v75,v75
v_mfma_f32_16x16x32_bf16 v[100:103],v[136:139],a[232:235],v[100:103]
s_waitcnt lgkmcnt(5)
v_exp_f32 v80,v80
v_mfma_f32_16x16x32_bf16 v[76:79],v[140:143],a[164:167],v[76:79]
v_exp_f32 v81,v81
v_mfma_f32_16x16x32_bf16 v[84:87],v[140:143],a[188:191],v[84:87]
v_cvt_pk_bf16_f32 v22,v72,v73
v_cvt_pk_bf16_f32 v23,v74,v75
v_mfma_f32_16x16x32_bf16 v[92:95],v[140:143],a[212:215],v[92:95]
v_cvt_pk_bf16_f32 v28,v80,v81
v_mfma_f32_16x16x32_bf16 v[100:103],v[140:143],a[236:239],v[100:103]
s_cbranch_scc1 L_loop4w0
s_cmp_ge_u32 s69,6
s_cbranch_scc1 L_end4
s_cmp_eq_u32 s40,0
s_cbranch_scc1 L_tr44
s_branch L_tr45
L_tr45:
s_waitcnt vmcnt(42)
s_waitcnt lgkmcnt(4)
v_mfma_f32_16x16x32_bf16 v[160:163],v[112:115],v[18:21],v[160:163]
s_add_u32 m0,s24,0
ds_read_b128 a[144:147],v11 offset:0
v_fma_f32 v82,v82,s36,v14
v_mfma_f32_16x16x32_bf16 v[208:211],v[112:115],v[24:27],v[208:211]
ds_read_b128 a[148:151],v12 offset:0
v_fma_f32 v83,v83,s36,v14
v_mfma_f32_16x16x32_bf16 a[0:3],v[112:115],v[30:33],a[0:3]
ds_read_b128 a[152:155],v11 offset:128
v_fma_f32 v88,v88,s36,v15
v_mfma_f32_16x16x32_bf16 a[48:51],v[112:115],v[36:39],a[48:51]
ds_read_b128 a[156:159],v12 offset:128
v_fma_f32 v89,v89,s36,v15
v_mfma_f32_16x16x32_bf16 v[164:167],v[116:119],v[18:21],v[164:167]
ds_read_b128 a[160:163],v11 offset:256
v_fma_f32 v90,v90,s36,v15
v_mfma_f32_16x16x32_bf16 v[212:215],v[116:119],v[24:27],v[212:215]
ds_read_b128 a[164:167],v12 offset:256
ds_read_b64_tr_b16 v[128:129],v2 offset:24704
ds_read_b64_tr_b16 v[130:131],v2 offset:30848
ds_read_b64_tr_b16 v[132:133],v3 offset:24704
ds_read_b64_tr_b16 v[134:135],v3 offset:30848
ds_read_b64_tr_b16 v[136:137],v4 offset:24704
ds_read_b64_tr_b16 v[138:139],v4 offset:30848
ds_read_b64_tr_b16 v[140:141],v5 offset:24704
ds_read_b64_tr_b16 v[142:143],v5 offset:30848
ds_read_b64_tr_b16 v[112:113],v2 offset:24832
ds_read_b64_tr_b16 v[114:115],v2 offset:30976
ds_read_b128 a[168:171],v11 offset:6144
v_mfma_f32_16x16x32_bf16 a[4:7],v[116:119],v[30:33],a[4:7]
v_fma_f32 v91,v91,s36,v15
ds_read_b128 a[172:175],v12 offset:6144
ds_read_b128 a[176:179],v11 offset:6272
v_mfma_f32_16x16x32_bf16 a[52:55],v[116:119],v[36:39],a[52:55]
s_waitcnt lgkmcnt(13)
v_fma_f32 v96,v96,s36,v16
ds_read_b128 a[180:183],v12 offset:6272
ds_read_b128 a[184:187],v11 offset:6400
v_mfma_f32_16x16x32_bf16 v[168:171],v[120:123],v[18:21],v[168:171]
buffer_load_dwordx4 v6,s[12:15],s28 offen offset:0 nt lds
v_mfma_f32_16x16x32_bf16 v[216:219],v[120:123],v[24:27],v[216:219]
ds_read_b64_tr_b16 v[116:117],v3 offset:24832
ds_read_b64_tr_b16 v[118:119],v3 offset:30976
v_mfma_f32_16x16x32_bf16 a[8:11],v[120:123],v[30:33],a[8:11]
ds_read_b128 a[188:191],v12 offset:6400
v_fma_f32 v97,v97,s36,v16
v_mfma_f32_16x16x32_bf16 a[56:59],v[120:123],v[36:39],a[56:59]
ds_read_b64_tr_b16 v[120:121],v4 offset:24832
ds_read_b64_tr_b16 v[122:123],v4 offset:30976
v_mfma_f32_16x16x32_bf16 v[172:175],v[124:127],v[18:21],v[172:175]
v_fma_f32 v98,v98,s36,v16
v_fma_f32 v99,v99,s36,v16
v_mfma_f32_16x16x32_bf16 v[220:223],v[124:127],v[24:27],v[220:223]
buffer_load_dwordx4 v7,s[12:15],s28 offen offset:1024 nt lds
v_mfma_f32_16x16x32_bf16 a[12:15],v[124:127],v[30:33],a[12:15]
v_fma_f32 v76,v76,s36,v13
v_fma_f32 v77,v77,s36,v13
v_mfma_f32_16x16x32_bf16 a[60:63],v[124:127],v[36:39],a[60:63]
s_waitcnt lgkmcnt(5)
ds_read_b64_tr_b16 v[124:125],v5 offset:24832
ds_read_b64_tr_b16 v[126:127],v5 offset:30976
v_mfma_f32_16x16x32_bf16 v[176:179],v[128:131],v[18:21],v[176:179]
v_fma_f32 v78,v78,s36,v13
v_fma_f32 v79,v79,s36,v13
v_mfma_f32_16x16x32_bf16 v[224:227],v[128:131],v[24:27],v[224:227]
v_fma_f32 v84,v84,s36,v14
v_fma_f32 v85,v85,s36,v14
v_mfma_f32_16x16x32_bf16 a[16:19],v[128:131],v[30:33],a[16:19]
v_fma_f32 v86,v86,s36,v14
v_fma_f32 v87,v87,s36,v14
v_mfma_f32_16x16x32_bf16 a[64:67],v[128:131],v[36:39],a[64:67]
v_fma_f32 v92,v92,s36,v15
v_fma_f32 v93,v93,s36,v15
v_mfma_f32_16x16x32_bf16 v[180:183],v[132:135],v[18:21],v[180:183]
v_fma_f32 v94,v94,s36,v15
v_fma_f32 v95,v95,s36,v15
v_mfma_f32_16x16x32_bf16 v[228:231],v[132:135],v[24:27],v[228:231]
buffer_load_dwordx4 v8,s[12:15],s28 offen offset:2048 nt lds
v_mfma_f32_16x16x32_bf16 a[20:23],v[132:135],v[30:33],a[20:23]
s_add_u32 s28,s28,3072
v_fma_f32 v100,v100,s36,v16
v_fma_f32 v101,v101,s36,v16
v_mfma_f32_16x16x32_bf16 a[68:71],v[132:135],v[36:39],a[68:71]
s_add_u32 m0,s24,3072
v_fma_f32 v102,v102,s36,v16
v_fma_f32 v103,v103,s36,v16
v_mfma_f32_16x16x32_bf16 v[184:187],v[136:139],v[18:21],v[184:187]
v_exp_f32 v82,v82
v_mfma_f32_16x16x32_bf16 v[232:235],v[136:139],v[24:27],v[232:235]
v_exp_f32 v83,v83
v_mfma_f32_16x16x32_bf16 a[24:27],v[136:139],v[30:33],a[24:27]
v_exp_f32 v88,v88
v_mfma_f32_16x16x32_bf16 a[72:75],v[136:139],v[36:39],a[72:75]
v_exp_f32 v89,v89
v_mfma_f32_16x16x32_bf16 v[188:191],v[140:143],v[18:21],v[188:191]
v_exp_f32 v90,v90
v_mfma_f32_16x16x32_bf16 v[236:239],v[140:143],v[24:27],v[236:239]
buffer_load_dwordx4 v6,s[12:15],s28 offen offset:0 nt lds
v_mfma_f32_16x16x32_bf16 a[28:31],v[140:143],v[30:33],a[28:31]
v_exp_f32 v91,v91
v_mfma_f32_16x16x32_bf16 a[76:79],v[140:143],v[36:39],a[76:79]
v_exp_f32 v96,v96
v_mfma_f32_16x16x32_bf16 v[192:195],v[112:115],v[18:21],v[192:195]
v_exp_f32 v97,v97
v_mfma_f32_16x16x32_bf16 v[240:243],v[112:115],v[24:27],v[240:243]
v_exp_f32 v98,v98
v_mfma_f32_16x16x32_bf16 a[32:35],v[112:115],v[30:33],a[32:35]
v_exp_f32 v99,v99
v_mfma_f32_16x16x32_bf16 a[80:83],v[112:115],v[36:39],a[80:83]
s_waitcnt lgkmcnt(0)
v_exp_f32 v76,v76
v_mfma_f32_16x16x32_bf16 v[196:199],v[116:119],v[18:21],v[196:199]
buffer_load_dwordx4 v7,s[12:15],s28 offen offset:1024 nt lds
v_mfma_f32_16x16x32_bf16 v[244:247],v[116:119],v[24:27],v[244:247]
v_exp_f32 v77,v77
v_mfma_f32_16x16x32_bf16 a[36:39],v[116:119],v[30:33],a[36:39]
v_exp_f32 v78,v78
v_mfma_f32_16x16x32_bf16 a[84:87],v[116:119],v[36:39],a[84:87]
v_exp_f32 v79,v79
v_mfma_f32_16x16x32_bf16 v[200:203],v[120:123],v[18:21],v[200:203]
v_exp_f32 v84,v84
v_mfma_f32_16x16x32_bf16 v[248:251],v[120:123],v[24:27],v[248:251]
v_exp_f32 v85,v85
v_mfma_f32_16x16x32_bf16 a[40:43],v[120:123],v[30:33],a[40:43]
v_exp_f32 v86,v86
v_mfma_f32_16x16x32_bf16 a[88:91],v[120:123],v[36:39],a[88:91]
v_exp_f32 v87,v87
v_mfma_f32_16x16x32_bf16 v[204:207],v[124:127],v[18:21],v[204:207]
buffer_load_dwordx4 v8,s[12:15],s28 offen offset:2048 nt lds
s_waitcnt vmcnt(20)
s_barrier
v_mfma_f32_16x16x32_bf16 v[252:255],v[124:127],v[24:27],v[252:255]
s_add_u32 s28,s28,3072
ds_read_b64_tr_b16 v[128:129],v2 offset:6144
ds_read_b64_tr_b16 v[130:131],v2 offset:0
v_mfma_f32_16x16x32_bf16 a[44:47],v[124:127],v[30:33],a[44:47]
s_add_u32 m0,s22,0
ds_read_b64_tr_b16 v[132:133],v3 offset:6144
buffer_load_dwordx4 v6,s[4:7],s25 offen offset:0 lds
v_mfma_f32_16x16x32_bf16 a[92:95],v[124:127],v[36:39],a[92:95]
buffer_load_dwordx4 v7,s[4:7],s25 offen offset:1024 lds
buffer_load_dwordx4 v8,s[4:7],s25 offen offset:2048 lds
ds_read_b64_tr_b16 v[134:135],v3 offset:0
ds_read_b64_tr_b16 v[136:137],v4 offset:6144
ds_read_b64_tr_b16 v[138:139],v4 offset:0
ds_read_b64_tr_b16 v[140:141],v5 offset:6144
ds_read_b64_tr_b16 v[142:143],v5 offset:0
v_exp_f32 v92,v92
v_exp_f32 v93,v93
v_exp_f32 v94,v94
v_exp_f32 v95,v95
v_exp_f32 v100,v100
v_exp_f32 v101,v101
v_exp_f32 v102,v102
v_exp_f32 v103,v103
v_cvt_pk_bf16_f32 v29,v82,v83
v_cvt_pk_bf16_f32 v34,v88,v89
v_cvt_pk_bf16_f32 v35,v90,v91
v_cvt_pk_bf16_f32 v40,v96,v97
v_cvt_pk_bf16_f32 v41,v98,v99
v_cvt_pk_bf16_f32 v20,v76,v77
v_cvt_pk_bf16_f32 v21,v78,v79
v_cvt_pk_bf16_f32 v26,v84,v85
v_cvt_pk_bf16_f32 v27,v86,v87
v_mfma_f32_16x16x32_bf16 v[52:55],v[48:51],v[20:23],v[52:55]
v_cvt_pk_bf16_f32 v32,v92,v93
v_cvt_pk_bf16_f32 v33,v94,v95
v_mfma_f32_16x16x32_bf16 v[56:59],v[48:51],v[26:29],v[56:59]
v_cvt_pk_bf16_f32 v38,v100,v101
v_cvt_pk_bf16_f32 v39,v102,v103
v_mfma_f32_16x16x32_bf16 v[60:63],v[48:51],v[32:35],v[60:63]
v_subrev_u32 v10,18432,v10
v_mfma_f32_16x16x32_bf16 v[64:67],v[48:51],v[38:41],v[64:67]
s_waitcnt lgkmcnt(0)
v_mfma_f32_16x16x32_bf16 v[160:163],v[128:131],v[20:23],v[160:163]
s_add_u32 s87,s42,18432
ds_read_b64_tr_b16 v[112:113],v2 offset:6272
ds_read_b64_tr_b16 v[114:115],v2 offset:128
v_mfma_f32_16x16x32_bf16 v[208:211],v[128:131],v[26:29],v[208:211]
ds_read_b64_tr_b16 v[116:117],v3 offset:6272
ds_read_b64_tr_b16 v[118:119],v3 offset:128
v_mfma_f32_16x16x32_bf16 a[0:3],v[128:131],v[32:35],a[0:3]
ds_read_b64_tr_b16 v[120:121],v4 offset:6272
ds_read_b64_tr_b16 v[122:123],v4 offset:128
v_mfma_f32_16x16x32_bf16 a[48:51],v[128:131],v[38:41],a[48:51]
ds_read_b64_tr_b16 v[124:125],v5 offset:6272
ds_read_b64_tr_b16 v[126:127],v5 offset:128
v_mfma_f32_16x16x32_bf16 v[164:167],v[132:135],v[20:23],v[164:167]
ds_read_b64_tr_b16 v[128:129],v2 offset:6400
ds_read_b64_tr_b16 v[130:131],v2 offset:256
v_mfma_f32_16x16x32_bf16 v[212:215],v[132:135],v[26:29],v[212:215]
v_mbcnt_lo_u32_b32 v57,-1,0
v_mbcnt_hi_u32_b32 v57,-1,v57
v_mfma_f32_16x16x32_bf16 a[4:7],v[132:135],v[32:35],a[4:7]
v_and_b32 v61,7,v57
v_lshrrev_b32 v53,5,v57
v_mfma_f32_16x16x32_bf16 a[52:55],v[132:135],v[38:41],a[52:55]
ds_read_b64_tr_b16 v[132:133],v3 offset:6400
ds_read_b64_tr_b16 v[134:135],v3 offset:256
v_mfma_f32_16x16x32_bf16 v[168:171],v[136:139],v[20:23],v[168:171]
v_xor_b32 v61,v61,v53
v_and_b32 v53,15,v57
v_mfma_f32_16x16x32_bf16 v[216:219],v[136:139],v[26:29],v[216:219]
v_lshl_add_u32 v53,v53,7,s24
v_lshl_add_u32 v53,v61,4,v53
v_mfma_f32_16x16x32_bf16 a[8:11],v[136:139],v[32:35],a[8:11]
v_bfe_u32 v61,v57,4,1
v_lshl_add_u32 v36,v61,3,v53
v_mfma_f32_16x16x32_bf16 a[56:59],v[136:139],v[38:41],a[56:59]
ds_read_b64_tr_b16 v[136:137],v4 offset:6400
ds_read_b64_tr_b16 v[138:139],v4 offset:256
v_mfma_f32_16x16x32_bf16 v[172:175],v[140:143],v[20:23],v[172:175]
v_xor_b32 v37,32,v36
v_xor_b32 v42,64,v36
v_mfma_f32_16x16x32_bf16 v[220:223],v[140:143],v[26:29],v[220:223]
v_xor_b32 v43,96,v36
v_bfe_u32 v53,v57,3,1
v_mfma_f32_16x16x32_bf16 a[12:15],v[140:143],v[32:35],a[12:15]
v_lshlrev_b32 v53,11,v53
v_rcp_f32 v66,v64
v_mfma_f32_16x16x32_bf16 a[60:63],v[140:143],v[38:41],a[60:63]
s_waitcnt lgkmcnt(3)
ds_read_b64_tr_b16 v[140:141],v5 offset:6400
ds_read_b64_tr_b16 v[142:143],v5 offset:256
v_mfma_f32_16x16x32_bf16 v[176:179],v[112:115],v[20:23],v[176:179]
v_accvgpr_read_b32 v72,a48
v_accvgpr_read_b32 v73,a49
v_mfma_f32_16x16x32_bf16 v[224:227],v[112:115],v[26:29],v[224:227]
v_accvgpr_read_b32 v74,a50
v_accvgpr_read_b32 v75,a51
v_mfma_f32_16x16x32_bf16 a[16:19],v[112:115],v[32:35],a[16:19]
v_accvgpr_read_b32 v80,a52
v_accvgpr_read_b32 v81,a53
v_mfma_f32_16x16x32_bf16 a[64:67],v[112:115],v[38:41],a[64:67]
v_accvgpr_read_b32 v82,a54
v_accvgpr_read_b32 v83,a55
v_mfma_f32_16x16x32_bf16 v[180:183],v[116:119],v[20:23],v[180:183]
v_accvgpr_read_b32 v88,a56
v_accvgpr_read_b32 v89,a57
v_mfma_f32_16x16x32_bf16 v[228:231],v[116:119],v[26:29],v[228:231]
v_accvgpr_read_b32 v90,a58
v_accvgpr_read_b32 v91,a59
v_mfma_f32_16x16x32_bf16 a[20:23],v[116:119],v[32:35],a[20:23]
v_accvgpr_read_b32 v76,a64
v_accvgpr_read_b32 v77,a65
v_accvgpr_read_b32 v78,a66
v_accvgpr_read_b32 v79,a67
v_max3_f32 v152,v52,v56,v60
v_pk_mul_f32 v[72:73],v[72:73],v[66:67] op_sel_hi:[1,0]
v_pk_mul_f32 v[74:75],v[74:75],v[66:67] op_sel_hi:[1,0]
v_pk_mul_f32 v[76:77],v[76:77],v[66:67] op_sel_hi:[1,0]
v_pk_mul_f32 v[78:79],v[78:79],v[66:67] op_sel_hi:[1,0]
v_accvgpr_read_b32 v96,a60
v_accvgpr_read_b32 v97,a61
v_mfma_f32_16x16x32_bf16 a[68:71],v[116:119],v[38:41],a[68:71]
v_accvgpr_read_b32 v98,a62
v_accvgpr_read_b32 v99,a63
v_mfma_f32_16x16x32_bf16 v[184:187],v[120:123],v[20:23],v[184:187]
v_max_f32 v152,v152,v64
v_cmp_ngt_f32 vcc,s37,v152
v_mfma_f32_16x16x32_bf16 v[232:235],v[120:123],v[26:29],v[232:235]
v_cvt_pk_bf16_f32 v72,v72,v73
v_cvt_pk_bf16_f32 v76,v76,v77
v_mfma_f32_16x16x32_bf16 a[24:27],v[120:123],v[32:35],a[24:27]
s_cmp_lg_u64 vcc,0
v_accvgpr_read_b32 v84,a68
v_accvgpr_read_b32 v85,a69
v_accvgpr_read_b32 v86,a70
v_accvgpr_read_b32 v87,a71
v_cvt_pk_bf16_f32 v73,v74,v75
v_pk_mul_f32 v[80:81],v[80:81],v[66:67] op_sel_hi:[1,0]
v_pk_mul_f32 v[82:83],v[82:83],v[66:67] op_sel_hi:[1,0]
v_pk_mul_f32 v[84:85],v[84:85],v[66:67] op_sel_hi:[1,0]
v_pk_mul_f32 v[86:87],v[86:87],v[66:67] op_sel_hi:[1,0]
v_cvt_pk_bf16_f32 v77,v78,v79
v_cvt_pk_bf16_f32 v80,v80,v81
v_mfma_f32_16x16x32_bf16 a[72:75],v[120:123],v[38:41],a[72:75]
s_cselect_b32 s62,s32,0
ds_write2st64_b64 v36,v[72:73],v[76:77] offset0:36 offset1:40
v_mfma_f32_16x16x32_bf16 v[188:191],v[124:127],v[20:23],v[188:191]
s_or_b32 s31,s31,s62
v_cvt_pk_bf16_f32 v84,v84,v85
v_cvt_pk_bf16_f32 v81,v82,v83
v_mfma_f32_16x16x32_bf16 v[236:239],v[124:127],v[26:29],v[236:239]
s_lshl_b32 s32,s32,1
v_accvgpr_read_b32 v92,a72
v_accvgpr_read_b32 v93,a73
v_mfma_f32_16x16x32_bf16 a[28:31],v[124:127],v[32:35],a[28:31]
s_add_u32 m0,s24,6144
v_accvgpr_read_b32 v94,a74
buffer_load_dwordx4 v6,s[12:15],s28 offen offset:0 nt lds
buffer_load_dwordx4 v7,s[12:15],s28 offen offset:1024 nt lds
buffer_load_dwordx4 v8,s[12:15],s28 offen offset:2048 nt lds
v_pk_mul_f32 v[88:89],v[88:89],v[66:67] op_sel_hi:[1,0]
v_pk_mul_f32 v[90:91],v[90:91],v[66:67] op_sel_hi:[1,0]
v_pk_mul_f32 v[92:93],v[92:93],v[66:67] op_sel_hi:[1,0]
v_accvgpr_read_b32 v95,a75
v_pk_mul_f32 v[94:95],v[94:95],v[66:67] op_sel_hi:[1,0]
v_cvt_pk_bf16_f32 v85,v86,v87
v_cvt_pk_bf16_f32 v88,v88,v89
v_mfma_f32_16x16x32_bf16 a[76:79],v[124:127],v[38:41],a[76:79]
s_add_u32 s28,s28,3072
ds_write2st64_b64 v37,v[80:81],v[84:85] offset0:36 offset1:40
v_mfma_f32_16x16x32_bf16 v[192:195],v[128:131],v[20:23],v[192:195]
s_add_u32 m0,s24,9216
v_cvt_pk_bf16_f32 v92,v92,v93
v_cvt_pk_bf16_f32 v89,v90,v91
v_mfma_f32_16x16x32_bf16 v[240:243],v[128:131],v[26:29],v[240:243]
buffer_load_dwordx4 v6,s[12:15],s28 offen offset:0 nt lds
v_mfma_f32_16x16x32_bf16 a[32:35],v[128:131],v[32:35],a[32:35]
buffer_load_dwordx4 v7,s[12:15],s28 offen offset:1024 nt lds
buffer_load_dwordx4 v8,s[12:15],s28 offen offset:2048 nt lds
v_pk_mul_f32 v[96:97],v[96:97],v[66:67] op_sel_hi:[1,0]
v_pk_mul_f32 v[98:99],v[98:99],v[66:67] op_sel_hi:[1,0]
v_accvgpr_read_b32 v100,a76
v_accvgpr_read_b32 v101,a77
v_pk_mul_f32 v[100:101],v[100:101],v[66:67] op_sel_hi:[1,0]
v_accvgpr_read_b32 v102,a78
v_accvgpr_read_b32 v103,a79
v_pk_mul_f32 v[102:103],v[102:103],v[66:67] op_sel_hi:[1,0]
v_cvt_pk_bf16_f32 v93,v94,v95
v_cvt_pk_bf16_f32 v96,v96,v97
v_mfma_f32_16x16x32_bf16 a[80:83],v[128:131],v[38:41],a[80:83]
s_add_u32 s28,s28,3072
ds_write2st64_b64 v42,v[88:89],v[92:93] offset0:36 offset1:40
s_waitcnt lgkmcnt(1)
v_mfma_f32_16x16x32_bf16 v[196:199],v[132:135],v[20:23],v[196:199]
s_add_u32 m0,s23,0
v_cvt_pk_bf16_f32 v100,v100,v101
v_cvt_pk_bf16_f32 v97,v98,v99
v_mfma_f32_16x16x32_bf16 v[244:247],v[132:135],v[26:29],v[244:247]
v_cvt_pk_bf16_f32 v101,v102,v103
v_accvgpr_read_b32 v72,a80
v_mfma_f32_16x16x32_bf16 a[36:39],v[132:135],v[32:35],a[36:39]
v_accvgpr_read_b32 v73,a81
ds_write2st64_b64 v43,v[96:97],v[100:101] offset0:36 offset1:40
v_pk_mul_f32 v[72:73],v[72:73],v[66:67] op_sel_hi:[1,0]
v_accvgpr_read_b32 v74,a82
v_accvgpr_read_b32 v75,a83
ds_read_b128 v[152:155],v10 offset:18432
ds_read_b128 v[156:159],v10 offset:19456
v_pk_mul_f32 v[74:75],v[74:75],v[66:67] op_sel_hi:[1,0]
v_cvt_pk_bf16_f32 v72,v72,v73
v_cvt_pk_bf16_f32 v73,v74,v75
v_mfma_f32_16x16x32_bf16 a[84:87],v[132:135],v[38:41],a[84:87]
s_waitcnt vmcnt(21)
ds_read_b128 a[192:195],v11 offset:12288
v_rcp_f32 v62,v60
v_mfma_f32_16x16x32_bf16 v[200:203],v[136:139],v[20:23],v[200:203]
ds_read_b128 a[196:199],v12 offset:12288
v_rcp_f32 v54,v52
v_mfma_f32_16x16x32_bf16 v[248:251],v[136:139],v[26:29],v[248:251]
ds_read_b128 a[200:203],v11 offset:12416
v_accvgpr_read_b32 v76,a84
v_mfma_f32_16x16x32_bf16 a[40:43],v[136:139],v[32:35],a[40:43]
ds_read_b128 a[204:207],v12 offset:12416
ds_read_b128 a[208:211],v11 offset:12544
v_accvgpr_read_b32 v77,a85
ds_read_b128 a[212:215],v12 offset:12544
v_pk_mul_f32 v[76:77],v[76:77],v[66:67] op_sel_hi:[1,0]
ds_read_b128 v[104:107],v10 offset:20480
s_waitcnt lgkmcnt(8)
buffer_store_dwordx4 v[152:155],v9,s[16:19],s87 offen offset:0 nt
ds_read_b128 v[108:111],v10 offset:21504
v_accvgpr_read_b32 v78,a86
v_accvgpr_read_b32 v79,a87
v_pk_mul_f32 v[78:79],v[78:79],v[66:67] op_sel_hi:[1,0]
v_cvt_pk_bf16_f32 v76,v76,v77
v_cvt_pk_bf16_f32 v77,v78,v79
v_mfma_f32_16x16x32_bf16 a[88:91],v[136:139],v[38:41],a[88:91]
v_accvgpr_read_b32 v78,a2
v_accvgpr_read_b32 v79,a3
v_mfma_f32_16x16x32_bf16 v[204:207],v[140:143],v[20:23],v[204:207]
ds_write_b64 v36,v[72:73] offset:18432
v_mfma_f32_16x16x32_bf16 v[252:255],v[140:143],v[26:29],v[252:255]
s_waitcnt lgkmcnt(7)
buffer_store_dwordx4 v[156:159],v9,s[16:19],s87 offen offset:3072 nt
v_add_u32 v36,v36,v53
v_rcp_f32 v58,v56
v_mfma_f32_16x16x32_bf16 a[44:47],v[140:143],v[32:35],a[44:47]
v_accvgpr_read_b32 v84,a88
v_accvgpr_read_b32 v85,a89
v_accvgpr_read_b32 v86,a90
v_accvgpr_read_b32 v87,a91
ds_write_b64 v37,v[76:77] offset:18432
s_waitcnt lgkmcnt(2)
buffer_store_dwordx4 v[104:107],v9,s[16:19],s87 offen offset:128 nt
v_pk_mul_f32 v[84:85],v[84:85],v[66:67] op_sel_hi:[1,0]
v_pk_mul_f32 v[86:87],v[86:87],v[66:67] op_sel_hi:[1,0]
v_add_u32 v37,v37,v53
v_cvt_pk_bf16_f32 v84,v84,v85
v_mfma_f32_16x16x32_bf16 a[92:95],v[140:143],v[38:41],a[92:95]
v_cvt_pk_bf16_f32 v85,v86,v87
v_accvgpr_read_b32 v76,a0
v_accvgpr_read_b32 v77,a1
ds_write_b64 v42,v[84:85] offset:18432
buffer_store_dwordx4 v[108:111],v9,s[16:19],s87 offen offset:3200 nt
v_add_u32 v42,v42,v53
v_accvgpr_read_b32 v104,a16
v_accvgpr_read_b32 v105,a17
v_accvgpr_read_b32 v92,a92
v_accvgpr_read_b32 v93,a93
v_accvgpr_read_b32 v94,a94
s_waitcnt vmcnt(10)
s_barrier
ds_read_b128 v[112:115],v0 offset:0
ds_read_b128 v[116:119],v1 offset:0
v_accvgpr_read_b32 v95,a95
ds_read_b128 v[120:123],v0 offset:128
v_accvgpr_read_b32 v106,a18
ds_read_b128 v[124:127],v1 offset:128
v_accvgpr_read_b32 v107,a19
ds_read_b128 v[128:131],v0 offset:256
v_accvgpr_read_b32 v84,a20
ds_read_b128 v[132:135],v1 offset:256
buffer_load_dwordx4 v6,s[8:11],s25 offen offset:0 lds
ds_read_b128 v[136:139],v0 offset:6144
ds_read_b128 v[140:143],v1 offset:6144
v_accvgpr_read_b32 v85,a21
v_accvgpr_read_b32 v108,a4
v_accvgpr_read_b32 v109,a5
v_accvgpr_read_b32 v86,a22
v_accvgpr_read_b32 v87,a23
v_accvgpr_read_b32 v110,a6
v_accvgpr_read_b32 v111,a7
s_waitcnt lgkmcnt(7)
v_mfma_f32_16x16x32_bf16 v[72:75],v[112:115],a[144:147],0
v_mfma_f32_16x16x32_bf16 v[80:83],v[112:115],a[168:171],0
v_mfma_f32_16x16x32_bf16 v[88:91],v[112:115],a[192:195],0
ds_read_b128 v[112:115],v0 offset:6272
v_pk_mul_f32 v[92:93],v[92:93],v[66:67] op_sel_hi:[1,0]
v_pk_mul_f32 v[94:95],v[94:95],v[66:67] op_sel_hi:[1,0]
buffer_load_dwordx4 v7,s[8:11],s25 offen offset:1024 lds
v_pk_mul_f32 v[76:77],v[76:77],v[62:63] op_sel_hi:[1,0]
v_pk_mul_f32 v[104:105],v[104:105],v[62:63] op_sel_hi:[1,0]
v_pk_mul_f32 v[78:79],v[78:79],v[62:63] op_sel_hi:[1,0]
v_pk_mul_f32 v[106:107],v[106:107],v[62:63] op_sel_hi:[1,0]
v_pk_mul_f32 v[108:109],v[108:109],v[62:63] op_sel_hi:[1,0]
v_pk_mul_f32 v[84:85],v[84:85],v[62:63] op_sel_hi:[1,0]
v_pk_mul_f32 v[110:111],v[110:111],v[62:63] op_sel_hi:[1,0]
v_pk_mul_f32 v[86:87],v[86:87],v[62:63] op_sel_hi:[1,0]
v_cvt_pk_bf16_f32 v92,v92,v93
v_cvt_pk_bf16_f32 v93,v94,v95
ds_write_b64 v43,v[92:93] offset:18432
ds_read_b128 v[96:99],v10 offset:18432
ds_read_b128 v[100:103],v10 offset:19456
v_add_u32 v43,v43,v53
v_cvt_pk_bf16_f32 v76,v76,v77
v_cvt_pk_bf16_f32 v104,v104,v105
v_cvt_pk_bf16_f32 v108,v108,v109
v_cvt_pk_bf16_f32 v84,v84,v85
v_cvt_pk_bf16_f32 v77,v78,v79
v_cvt_pk_bf16_f32 v105,v106,v107
ds_write2st64_b64 v36,v[76:77],v[104:105] offset0:24 offset1:26
v_cvt_pk_bf16_f32 v109,v110,v111
v_cvt_pk_bf16_f32 v85,v86,v87
v_accvgpr_read_b32 v94,a10
buffer_load_dwordx4 v8,s[8:11],s25 offen offset:2048 lds
v_accvgpr_read_b32 v95,a11
v_pk_mul_f32 v[94:95],v[94:95],v[62:63] op_sel_hi:[1,0]
v_accvgpr_read_b32 v92,a8
ds_write2st64_b64 v37,v[108:109],v[84:85] offset0:24 offset1:26
v_accvgpr_read_b32 v93,a9
v_pk_mul_f32 v[92:93],v[92:93],v[62:63] op_sel_hi:[1,0]
v_accvgpr_read_b32 v78,a26
s_waitcnt lgkmcnt(2)
buffer_store_dwordx4 v[96:99],v9,s[16:19],s87 offen offset:256 nt
v_accvgpr_read_b32 v79,a27
v_pk_mul_f32 v[78:79],v[78:79],v[62:63] op_sel_hi:[1,0]
v_accvgpr_read_b32 v106,a14
v_accvgpr_read_b32 v107,a15
v_pk_mul_f32 v[106:107],v[106:107],v[62:63] op_sel_hi:[1,0]
v_accvgpr_read_b32 v76,a24
v_accvgpr_read_b32 v77,a25
v_pk_mul_f32 v[76:77],v[76:77],v[62:63] op_sel_hi:[1,0]
v_accvgpr_read_b32 v104,a12
v_accvgpr_read_b32 v105,a13
v_pk_mul_f32 v[104:105],v[104:105],v[62:63] op_sel_hi:[1,0]
buffer_store_dwordx4 v[100:103],v9,s[16:19],s87 offen offset:3328 nt
v_accvgpr_read_b32 v86,a30
v_accvgpr_read_b32 v87,a31
v_pk_mul_f32 v[86:87],v[86:87],v[62:63] op_sel_hi:[1,0]
v_accvgpr_read_b32 v84,a28
v_accvgpr_read_b32 v85,a29
v_pk_mul_f32 v[84:85],v[84:85],v[62:63] op_sel_hi:[1,0]
v_accvgpr_read_b32 v96,a32
v_accvgpr_read_b32 v97,a33
v_mfma_f32_16x16x32_bf16 v[72:75],v[116:119],a[148:151],v[72:75]
s_waitcnt vmcnt(18)
ds_read_b128 a[216:219],v11 offset:0
ds_read_b128 a[220:223],v12 offset:0
v_accvgpr_read_b32 v98,a34
ds_read_b128 a[224:227],v11 offset:128
v_pk_mul_f32 v[96:97],v[96:97],v[62:63] op_sel_hi:[1,0]
ds_read_b128 a[228:231],v12 offset:128
v_pk_mul_f32 v[160:161],v[160:161],v[54:55] op_sel_hi:[1,0]
ds_read_b128 a[232:235],v11 offset:256
v_pk_mul_f32 v[162:163],v[162:163],v[54:55] op_sel_hi:[1,0]
ds_read_b128 a[236:239],v12 offset:256
v_accvgpr_read_b32 v99,a35
v_pk_mul_f32 v[98:99],v[98:99],v[62:63] op_sel_hi:[1,0]
v_accvgpr_read_b32 v100,a36
v_accvgpr_read_b32 v101,a37
v_mfma_f32_16x16x32_bf16 v[80:83],v[116:119],a[172:175],v[80:83]
s_add_u32 m0,s23,24576
v_accvgpr_read_b32 v102,a38
v_accvgpr_read_b32 v103,a39
v_mfma_f32_16x16x32_bf16 v[88:91],v[116:119],a[196:199],v[88:91]
buffer_load_dwordx4 v6,s[8:11],s21 offen offset:0 lds
v_mfma_f32_16x16x32_bf16 v[72:75],v[120:123],a[152:155],v[72:75]
buffer_load_dwordx4 v7,s[8:11],s21 offen offset:1024 lds
v_mfma_f32_16x16x32_bf16 v[80:83],v[120:123],a[176:179],v[80:83]
ds_read_b128 v[116:119],v1 offset:6272
v_accvgpr_read_b32 v110,a42
v_accvgpr_read_b32 v111,a43
v_accvgpr_read_b32 v108,a40
v_accvgpr_read_b32 v109,a41
v_pk_mul_f32 v[100:101],v[100:101],v[62:63] op_sel_hi:[1,0]
v_pk_mul_f32 v[102:103],v[102:103],v[62:63] op_sel_hi:[1,0]
v_pk_mul_f32 v[164:165],v[164:165],v[54:55] op_sel_hi:[1,0]
v_pk_mul_f32 v[166:167],v[166:167],v[54:55] op_sel_hi:[1,0]
v_cvt_pk_bf16_f32 v92,v92,v93
v_cvt_pk_bf16_f32 v76,v76,v77
v_mfma_f32_16x16x32_bf16 v[88:91],v[120:123],a[200:203],v[88:91]
ds_read_b128 v[120:123],v0 offset:6400
v_cvt_pk_bf16_f32 v104,v104,v105
v_mfma_f32_16x16x32_bf16 v[72:75],v[124:127],a[156:159],v[72:75]
v_cvt_pk_bf16_f32 v84,v84,v85
v_cvt_pk_bf16_f32 v93,v94,v95
v_mfma_f32_16x16x32_bf16 v[80:83],v[124:127],a[180:183],v[80:83]
v_cvt_pk_bf16_f32 v77,v78,v79
v_cvt_pk_bf16_f32 v105,v106,v107
v_mfma_f32_16x16x32_bf16 v[88:91],v[124:127],a[204:207],v[88:91]
ds_write2st64_b64 v42,v[92:93],v[76:77] offset0:24 offset1:26
v_pk_mul_f32 v[108:109],v[108:109],v[62:63] op_sel_hi:[1,0]
v_pk_mul_f32 v[110:111],v[110:111],v[62:63] op_sel_hi:[1,0]
v_pk_mul_f32 v[168:169],v[168:169],v[54:55] op_sel_hi:[1,0]
ds_read_b128 v[124:127],v1 offset:6400
v_pk_mul_f32 v[170:171],v[170:171],v[54:55] op_sel_hi:[1,0]
v_cvt_pk_bf16_f32 v85,v86,v87
v_accvgpr_read_b32 v106,a46
v_mfma_f32_16x16x32_bf16 v[72:75],v[128:131],a[160:163],v[72:75]
buffer_load_dwordx4 v8,s[8:11],s21 offen offset:2048 lds
v_mfma_f32_16x16x32_bf16 v[80:83],v[128:131],a[184:187],v[80:83]
s_add_u32 s21,s21,12288
ds_write2st64_b64 v43,v[104:105],v[84:85] offset0:24 offset1:26
v_mfma_f32_16x16x32_bf16 v[88:91],v[128:131],a[208:211],v[88:91]
s_mov_b32 s27,s42
v_accvgpr_read_b32 v107,a47
v_accvgpr_read_b32 v104,a44
v_mfma_f32_16x16x32_bf16 v[72:75],v[132:135],a[164:167],v[72:75]
s_mov_b32 s42,s41
ds_read_b128 v[128:131],v0 offset:0
v_accvgpr_read_b32 v105,a45
v_cvt_pk_bf16_f32 v96,v96,v97
v_cvt_pk_bf16_f32 v160,v160,v161
v_cvt_pk_bf16_f32 v97,v98,v99
v_pk_mul_f32 v[106:107],v[106:107],v[62:63] op_sel_hi:[1,0]
v_pk_mul_f32 v[172:173],v[172:173],v[54:55] op_sel_hi:[1,0]
v_pk_mul_f32 v[174:175],v[174:175],v[54:55] op_sel_hi:[1,0]
v_pk_mul_f32 v[104:105],v[104:105],v[62:63] op_sel_hi:[1,0]
v_cvt_pk_bf16_f32 v161,v162,v163
v_cvt_pk_bf16_f32 v100,v100,v101
v_mfma_f32_16x16x32_bf16 v[80:83],v[132:135],a[188:191],v[80:83]
s_waitcnt vmcnt(12)
ds_read_b128 a[240:243],v11 offset:6144
v_cvt_pk_bf16_f32 v164,v164,v165
v_mfma_f32_16x16x32_bf16 v[88:91],v[132:135],a[212:215],v[88:91]
s_add_u32 s69,s69,1
ds_read_b128 a[244:247],v12 offset:6144
v_cvt_pk_bf16_f32 v108,v108,v109
v_mfma_f32_16x16x32_bf16 v[76:79],v[136:139],a[144:147],0
s_lshl_b32 s62,s69,5
ds_read_b128 a[248:251],v11 offset:6272
ds_read_b128 a[252:255],v12 offset:6272
v_cvt_pk_bf16_f32 v168,v168,v169
ds_read_b128 v[144:147],v11 offset:6400
v_pk_mul_f32 v[176:177],v[176:177],v[54:55] op_sel_hi:[1,0]
ds_read_b128 v[148:151],v12 offset:6400
v_pk_mul_f32 v[178:179],v[178:179],v[54:55] op_sel_hi:[1,0]
ds_write2st64_b64 v36,v[96:97],v[160:161] offset0:28 offset1:0
v_pk_mul_f32 v[192:193],v[192:193],v[54:55] op_sel_hi:[1,0]
v_pk_mul_f32 v[194:195],v[194:195],v[54:55] op_sel_hi:[1,0]
v_cvt_pk_bf16_f32 v101,v102,v103
ds_read_b128 v[132:135],v1 offset:0
v_mfma_f32_16x16x32_bf16 v[84:87],v[136:139],a[168:171],0
s_add_u32 s62,s62,s34
v_cvt_pk_bf16_f32 v165,v166,v167
v_cvt_pk_bf16_f32 v172,v172,v173
v_mfma_f32_16x16x32_bf16 v[92:95],v[136:139],a[192:195],0
s_mul_i32 s63,s62,171
ds_read_b128 v[136:139],v0 offset:128
v_cvt_pk_bf16_f32 v104,v104,v105
v_mfma_f32_16x16x32_bf16 v[76:79],v[140:143],a[148:151],v[76:79]
s_lshr_b32 s63,s63,9
ds_write2st64_b64 v37,v[100:101],v[164:165] offset0:28 offset1:0
v_mfma_f32_16x16x32_bf16 v[84:87],v[140:143],a[172:175],v[84:87]
s_mul_i32 s64,s63,3
v_cvt_pk_bf16_f32 v109,v110,v111
v_cvt_pk_bf16_f32 v169,v170,v171
v_cvt_pk_bf16_f32 v173,v174,v175
v_cvt_pk_bf16_f32 v105,v106,v107
v_max3_f32 v20,v72,v73,v74
v_pk_mul_f32 v[180:181],v[180:181],v[54:55] op_sel_hi:[1,0]
v_pk_mul_f32 v[182:183],v[182:183],v[54:55] op_sel_hi:[1,0]
v_pk_mul_f32 v[196:197],v[196:197],v[54:55] op_sel_hi:[1,0]
v_pk_mul_f32 v[198:199],v[198:199],v[54:55] op_sel_hi:[1,0]
v_max3_f32 v26,v80,v81,v82
v_max3_f32 v32,v88,v89,v90
v_mfma_f32_16x16x32_bf16 v[92:95],v[140:143],a[196:199],v[92:95]
s_sub_u32 s62,s62,s64
ds_write2st64_b64 v42,v[108:109],v[168:169] offset0:28 offset1:0
v_mfma_f32_16x16x32_bf16 v[76:79],v[112:115],a[152:155],v[76:79]
s_add_u32 s63,s63,s33
v_cvt_pk_bf16_f32 v176,v176,v177
v_cvt_pk_bf16_f32 v192,v192,v193
v_mfma_f32_16x16x32_bf16 v[84:87],v[112:115],a[176:179],v[84:87]
s_mul_i32 s30,s63,196608
ds_read_b128 v[140:143],v1 offset:128
v_cvt_pk_bf16_f32 v180,v180,v181
v_mfma_f32_16x16x32_bf16 v[92:95],v[112:115],a[200:203],v[92:95]
s_mul_i32 s41,s63,325632
ds_read_b128 v[112:115],v0 offset:256
ds_write2st64_b64 v43,v[104:105],v[172:173] offset0:28 offset1:0
v_pk_mul_f32 v[184:185],v[184:185],v[54:55] op_sel_hi:[1,0]
v_pk_mul_f32 v[186:187],v[186:187],v[54:55] op_sel_hi:[1,0]
v_pk_mul_f32 v[200:201],v[200:201],v[54:55] op_sel_hi:[1,0]
v_pk_mul_f32 v[202:203],v[202:203],v[54:55] op_sel_hi:[1,0]
v_cvt_pk_bf16_f32 v196,v196,v197
v_cvt_pk_bf16_f32 v177,v178,v179
s_waitcnt lgkmcnt(4)
v_mfma_f32_16x16x32_bf16 v[76:79],v[116:119],a[156:159],v[76:79]
s_lshl_b32 s63,s3,2
v_cvt_pk_bf16_f32 v193,v194,v195
v_cvt_pk_bf16_f32 v181,v182,v183
v_mfma_f32_16x16x32_bf16 v[84:87],v[116:119],a[180:183],v[84:87]
s_add_u32 s64,s63,21
v_cvt_pk_bf16_f32 v184,v184,v185
v_cvt_pk_bf16_f32 v200,v200,v201
v_mfma_f32_16x16x32_bf16 v[92:95],v[116:119],a[204:207],v[92:95]
s_cmp_eq_u32 s3,0
ds_write2st64_b64 v36,v[176:177],v[192:193] offset0:2 offset1:4
v_pk_mul_f32 v[188:189],v[188:189],v[54:55] op_sel_hi:[1,0]
v_pk_mul_f32 v[190:191],v[190:191],v[54:55] op_sel_hi:[1,0]
v_pk_mul_f32 v[204:205],v[204:205],v[54:55] op_sel_hi:[1,0]
ds_read_b128 v[116:119],v1 offset:256
v_pk_mul_f32 v[206:207],v[206:207],v[54:55] op_sel_hi:[1,0]
v_cvt_pk_bf16_f32 v197,v198,v199
v_cvt_pk_bf16_f32 v185,v186,v187
v_mfma_f32_16x16x32_bf16 v[76:79],v[120:123],a[160:163],v[76:79]
s_cselect_b32 s64,20,s64
v_cvt_pk_bf16_f32 v201,v202,v203
v_cvt_pk_bf16_f32 v188,v188,v189
v_mfma_f32_16x16x32_bf16 v[84:87],v[120:123],a[184:187],v[84:87]
s_cselect_b32 s40,1,0
ds_write2st64_b64 v37,v[180:181],v[196:197] offset0:2 offset1:4
v_mfma_f32_16x16x32_bf16 v[92:95],v[120:123],a[208:211],v[92:95]
s_add_u32 s65,s63,37
v_cvt_pk_bf16_f32 v204,v204,v205
v_cvt_pk_bf16_f32 v189,v190,v191
v_mfma_f32_16x16x32_bf16 v[76:79],v[124:127],a[164:167],v[76:79]
s_cmp_eq_u32 s62,2
ds_read_b128 v[120:123],v0 offset:6144
v_cvt_pk_bf16_f32 v205,v206,v207
s_cselect_b32 s64,s65,s64
s_cselect_b32 s40,0,s40
s_add_u32 s65,s63,s3
ds_write2st64_b64 v42,v[184:185],v[200:201] offset0:2 offset1:4
v_pk_mul_f32 v[208:209],v[208:209],v[58:59] op_sel_hi:[1,0]
v_pk_mul_f32 v[210:211],v[210:211],v[58:59] op_sel_hi:[1,0]
v_pk_mul_f32 v[224:225],v[224:225],v[58:59] op_sel_hi:[1,0]
v_pk_mul_f32 v[226:227],v[226:227],v[58:59] op_sel_hi:[1,0]
v_max3_f32 v20,v20,v75,v76
v_max3_f32 v20,v20,v77,v78
v_mfma_f32_16x16x32_bf16 v[84:87],v[124:127],a[188:191],v[84:87]
s_cmp_eq_u32 s62,0
v_max_f32 v20,v20,v79
v_mov_b32 v21,v20
v_mfma_f32_16x16x32_bf16 v[92:95],v[124:127],a[212:215],v[92:95]
s_cselect_b32 s64,s65,s64
ds_read_b128 v[124:127],v1 offset:6144
v_permlane32_swap_b32 v21,v20
v_mfma_f32_16x16x32_bf16 v[96:99],v[128:131],a[216:219],0
s_cselect_b32 s40,1,s40
ds_write2st64_b64 v43,v[188:189],v[204:205] offset0:2 offset1:4
v_mfma_f32_16x16x32_bf16 v[104:107],v[128:131],a[240:243],0
s_mul_i32 s64,s64,6144
v_max3_f32 v26,v26,v83,v84
ds_read_b128 v[128:131],v0 offset:6272
v_max_f32 v20,v20,v21
v_pk_mul_f32 v[212:213],v[212:213],v[58:59] op_sel_hi:[1,0]
v_pk_mul_f32 v[214:215],v[214:215],v[58:59] op_sel_hi:[1,0]
v_pk_mul_f32 v[228:229],v[228:229],v[58:59] op_sel_hi:[1,0]
v_pk_mul_f32 v[230:231],v[230:231],v[58:59] op_sel_hi:[1,0]
v_max3_f32 v26,v26,v85,v86
v_mov_b32 v21,v20
v_mfma_f32_16x16x32_bf16 v[96:99],v[132:135],a[220:223],v[96:99]
s_add_u32 s41,s41,s64
v_max_f32 v26,v26,v87
v_permlane16_swap_b32 v21,v20
v_mfma_f32_16x16x32_bf16 v[104:107],v[132:135],a[244:247],v[104:107]
s_cmp_ge_u32 s69,6
ds_read_b128 v[132:135],v1 offset:6272
v_mov_b32 v27,v26
v_mfma_f32_16x16x32_bf16 v[96:99],v[136:139],a[224:227],v[96:99]
s_cselect_b32 s41,166723584,s41
v_max3_f32 v32,v32,v91,v92
v_max_f32 v20,v20,v21
v_permlane32_swap_b32 v27,v26
v_max3_f32 v32,v32,v93,v94
v_pk_mul_f32 v[216:217],v[216:217],v[58:59] op_sel_hi:[1,0]
v_pk_mul_f32 v[218:219],v[218:219],v[58:59] op_sel_hi:[1,0]
v_pk_mul_f32 v[232:233],v[232:233],v[58:59] op_sel_hi:[1,0]
v_pk_mul_f32 v[234:235],v[234:235],v[58:59] op_sel_hi:[1,0]
v_mul_f32_e64 v13,-s36,v20
v_max_f32 v26,v26,v27
v_mfma_f32_16x16x32_bf16 v[104:107],v[136:139],a[248:251],v[104:107]
s_cselect_b32 s30,100663296,s30
ds_read_b128 v[136:139],v0 offset:6400
v_max_f32 v32,v32,v95
s_waitcnt lgkmcnt(3)
v_mfma_f32_16x16x32_bf16 v[96:99],v[140:143],a[228:231],v[96:99]
s_add_u32 s25,s30,s22
v_fma_f32 v72,v72,s36,v13
v_fma_f32 v73,v73,s36,v13
v_mfma_f32_16x16x32_bf16 v[104:107],v[140:143],a[252:255],v[104:107]
s_add_u32 s26,s25,12288
ds_read_b128 v[140:143],v1 offset:6400
v_fma_f32 v74,v74,s36,v13
v_mfma_f32_16x16x32_bf16 v[96:99],v[112:115],a[232:235],v[96:99]
s_add_u32 m0,s22,0
v_fma_f32 v75,v75,s36,v13
v_mov_b32 v27,v26
v_mov_b32 v33,v32
v_exp_f32 v72,v72
v_pk_mul_f32 v[220:221],v[220:221],v[58:59] op_sel_hi:[1,0]
v_pk_mul_f32 v[222:223],v[222:223],v[58:59] op_sel_hi:[1,0]
v_pk_mul_f32 v[236:237],v[236:237],v[58:59] op_sel_hi:[1,0]
v_pk_mul_f32 v[238:239],v[238:239],v[58:59] op_sel_hi:[1,0]
v_exp_f32 v73,v73
v_exp_f32 v74,v74
v_mfma_f32_16x16x32_bf16 v[104:107],v[112:115],v[144:147],v[104:107]
s_mov_b32 s28,s41
ds_read_b128 v[112:115],v0 offset:12544
v_exp_f32 v75,v75
v_mfma_f32_16x16x32_bf16 v[96:99],v[116:119],a[236:239],v[96:99]
s_mov_b32 s29,s24
v_permlane16_swap_b32 v27,v26
v_mfma_f32_16x16x32_bf16 v[104:107],v[116:119],v[148:151],v[104:107]
ds_read_b128 v[116:119],v1 offset:12544
v_permlane32_swap_b32 v33,v32
v_mfma_f32_16x16x32_bf16 v[100:103],v[120:123],a[216:219],0
v_max_f32 v26,v26,v27
v_max_f32 v32,v32,v33
v_max3_f32 v38,v96,v97,v98
v_mul_f32_e64 v14,-s36,v26
v_cvt_pk_bf16_f32 v18,v72,v73
v_pk_mul_f32 v[240:241],v[240:241],v[58:59] op_sel_hi:[1,0]
v_pk_mul_f32 v[242:243],v[242:243],v[58:59] op_sel_hi:[1,0]
v_cvt_pk_bf16_f32 v19,v74,v75
v_mov_b32 v33,v32
v_mfma_f32_16x16x32_bf16 v[108:111],v[120:123],a[240:243],0
ds_read_b128 v[120:123],v0 offset:18432
v_fma_f32 v80,v80,s36,v14
v_mfma_f32_16x16x32_bf16 v[100:103],v[124:127],a[220:223],v[100:103]
v_fma_f32 v81,v81,s36,v14
v_fma_f32 v82,v82,s36,v14
v_mfma_f32_16x16x32_bf16 v[108:111],v[124:127],a[244:247],v[108:111]
s_waitcnt lgkmcnt(2)
ds_read_b128 v[124:127],v1 offset:18432
v_fma_f32 v83,v83,s36,v14
v_mfma_f32_16x16x32_bf16 v[100:103],v[128:131],a[224:227],v[100:103]
v_max3_f32 v44,v104,v105,v106
v_permlane16_swap_b32 v33,v32
v_exp_f32 v80,v80
v_pk_mul_f32 v[244:245],v[244:245],v[58:59] op_sel_hi:[1,0]
v_pk_mul_f32 v[246:247],v[246:247],v[58:59] op_sel_hi:[1,0]
v_exp_f32 v81,v81
v_exp_f32 v82,v82
v_mfma_f32_16x16x32_bf16 v[108:111],v[128:131],a[248:251],v[108:111]
ds_read_b128 v[128:131],v0 offset:12288
v_exp_f32 v83,v83
v_mfma_f32_16x16x32_bf16 v[100:103],v[132:135],a[228:231],v[100:103]
v_max_f32 v32,v32,v33
v_mul_f32_e64 v15,-s36,v32
v_mfma_f32_16x16x32_bf16 v[108:111],v[132:135],a[252:255],v[108:111]
ds_read_b128 v[132:135],v1 offset:12288
v_cvt_pk_bf16_f32 v208,v208,v209
v_cvt_pk_bf16_f32 v224,v224,v225
v_cvt_pk_bf16_f32 v24,v80,v81
v_cvt_pk_bf16_f32 v25,v82,v83
v_pk_mul_f32 v[248:249],v[248:249],v[58:59] op_sel_hi:[1,0]
v_pk_mul_f32 v[250:251],v[250:251],v[58:59] op_sel_hi:[1,0]
v_fma_f32 v88,v88,s36,v15
v_fma_f32 v89,v89,s36,v15
v_mfma_f32_16x16x32_bf16 v[100:103],v[136:139],a[232:235],v[100:103]
v_fma_f32 v90,v90,s36,v15
v_fma_f32 v91,v91,s36,v15
v_mfma_f32_16x16x32_bf16 v[108:111],v[136:139],v[144:147],v[108:111]
ds_read_b128 v[136:139],v0 offset:12416
v_cvt_pk_bf16_f32 v212,v212,v213
v_mfma_f32_16x16x32_bf16 v[100:103],v[140:143],a[236:239],v[100:103]
v_cvt_pk_bf16_f32 v228,v228,v229
v_cvt_pk_bf16_f32 v209,v210,v211
v_mfma_f32_16x16x32_bf16 v[108:111],v[140:143],v[148:151],v[108:111]
ds_read_b128 v[140:143],v1 offset:12416
v_cvt_pk_bf16_f32 v225,v226,v227
ds_write2st64_b64 v36,v[208:209],v[224:225] offset0:12 offset1:14
v_pk_mul_f32 v[252:253],v[252:253],v[58:59] op_sel_hi:[1,0]
v_pk_mul_f32 v[254:255],v[254:255],v[58:59] op_sel_hi:[1,0]
v_max3_f32 v38,v38,v99,v100
v_max3_f32 v38,v38,v101,v102
s_waitcnt lgkmcnt(3)
v_mfma_f32_16x16x32_bf16 v[72:75],v[128:131],a[144:147],0
v_max_f32 v38,v38,v103
v_mov_b32 v39,v38
v_mfma_f32_16x16x32_bf16 v[80:83],v[128:131],a[168:171],0
v_max3_f32 v44,v44,v107,v108
v_permlane32_swap_b32 v39,v38
v_max3_f32 v44,v44,v109,v110
v_max_f32 v38,v38,v39
v_max_f32 v44,v44,v111
v_mov_b32 v39,v38
v_exp_f32 v88,v88
v_exp_f32 v89,v89
v_exp_f32 v90,v90
v_exp_f32 v91,v91
v_mov_b32 v45,v44
v_permlane16_swap_b32 v39,v38
v_cvt_pk_bf16_f32 v216,v216,v217
v_cvt_pk_bf16_f32 v232,v232,v233
v_cvt_pk_bf16_f32 v213,v214,v215
v_cvt_pk_bf16_f32 v229,v230,v231
ds_write2st64_b64 v37,v[212:213],v[228:229] offset0:12 offset1:14
v_permlane32_swap_b32 v45,v44
v_max_f32 v38,v38,v39
v_cvt_pk_bf16_f32 v220,v220,v221
v_cvt_pk_bf16_f32 v236,v236,v237
v_cvt_pk_bf16_f32 v217,v218,v219
v_cvt_pk_bf16_f32 v233,v234,v235
v_max_f32 v44,v44,v45
v_mul_f32_e64 v16,-s36,v38
v_cvt_pk_bf16_f32 v240,v240,v241
v_cvt_pk_bf16_f32 v30,v88,v89
ds_write2st64_b64 v42,v[216:217],v[232:233] offset0:12 offset1:14
v_cvt_pk_bf16_f32 v31,v90,v91
v_mfma_f32_16x16x32_bf16 v[88:91],v[128:131],a[192:195],0
v_cvt_pk_bf16_f32 v221,v222,v223
v_cvt_pk_bf16_f32 v237,v238,v239
v_mov_b32 v45,v44
v_fma_f32 v96,v96,s36,v16
v_fma_f32 v97,v97,s36,v16
v_fma_f32 v98,v98,s36,v16
v_fma_f32 v99,v99,s36,v16
v_cvt_pk_bf16_f32 v244,v244,v245
ds_write2st64_b64 v43,v[220:221],v[236:237] offset0:12 offset1:14
v_cvt_pk_bf16_f32 v241,v242,v243
v_permlane16_swap_b32 v45,v44
v_exp_f32 v96,v96
v_exp_f32 v97,v97
v_exp_f32 v98,v98
v_exp_f32 v99,v99
ds_write_b64 v36,v[240:241] offset:8192
v_cvt_pk_bf16_f32 v245,v246,v247
v_max_f32 v44,v44,v45
v_mul_f32_e64 v17,-s36,v44
v_cvt_pk_bf16_f32 v248,v248,v249
ds_write_b64 v37,v[244:245] offset:8192
v_cvt_pk_bf16_f32 v36,v96,v97
v_fma_f32 v104,v104,s36,v17
v_fma_f32 v105,v105,s36,v17
v_fma_f32 v106,v106,s36,v17
v_fma_f32 v107,v107,s36,v17
v_cvt_pk_bf16_f32 v37,v98,v99
v_mfma_f32_16x16x32_bf16 v[96:99],v[128:131],a[216:219],0
v_cvt_pk_bf16_f32 v252,v252,v253
v_cvt_pk_bf16_f32 v249,v250,v251
ds_write_b64 v42,v[248:249] offset:8192
v_exp_f32 v104,v104
v_exp_f32 v105,v105
v_exp_f32 v106,v106
v_exp_f32 v107,v107
v_cvt_pk_bf16_f32 v253,v254,v255
ds_write_b64 v43,v[252:253] offset:8192
v_cvt_pk_bf16_f32 v42,v104,v105
v_cvt_pk_bf16_f32 v43,v106,v107
v_mfma_f32_16x16x32_bf16 v[104:107],v[128:131],a[240:243],0
ds_read_b128 v[128:131],v0 offset:18560
v_fma_f32 v76,v76,s36,v13
v_mfma_f32_16x16x32_bf16 v[72:75],v[132:135],a[148:151],v[72:75]
v_fma_f32 v77,v77,s36,v13
v_fma_f32 v78,v78,s36,v13
v_mfma_f32_16x16x32_bf16 v[80:83],v[132:135],a[172:175],v[80:83]
v_fma_f32 v79,v79,s36,v13
v_exp_f32 v76,v76
v_mfma_f32_16x16x32_bf16 v[88:91],v[132:135],a[196:199],v[88:91]
v_exp_f32 v77,v77
v_mfma_f32_16x16x32_bf16 v[96:99],v[132:135],a[220:223],v[96:99]
v_exp_f32 v78,v78
v_mfma_f32_16x16x32_bf16 v[104:107],v[132:135],a[244:247],v[104:107]
ds_read_b128 v[132:135],v1 offset:18560
v_exp_f32 v79,v79
s_waitcnt vmcnt(5)
s_barrier
s_waitcnt lgkmcnt(2)
v_mfma_f32_16x16x32_bf16 v[72:75],v[136:139],a[152:155],v[72:75]
v_fma_f32 v84,v84,s36,v14
v_fma_f32 v85,v85,s36,v14
v_mfma_f32_16x16x32_bf16 v[80:83],v[136:139],a[176:179],v[80:83]
buffer_load_dwordx4 v6,s[4:7],s20 offen offset:0 lds
v_mfma_f32_16x16x32_bf16 v[88:91],v[136:139],a[200:203],v[88:91]
v_fma_f32 v86,v86,s36,v14
v_fma_f32 v87,v87,s36,v14
v_mfma_f32_16x16x32_bf16 v[96:99],v[136:139],a[224:227],v[96:99]
v_cvt_pk_bf16_f32 v20,v76,v77
v_cvt_pk_bf16_f32 v21,v78,v79
v_mfma_f32_16x16x32_bf16 v[104:107],v[136:139],a[248:251],v[104:107]
ds_read_b128 v[136:139],v0 offset:18688
v_exp_f32 v84,v84
v_mfma_f32_16x16x32_bf16 v[52:55],v[48:51],v[18:21],0
v_exp_f32 v85,v85
v_mfma_f32_16x16x32_bf16 v[72:75],v[140:143],a[156:159],v[72:75]
buffer_load_dwordx4 v7,s[4:7],s20 offen offset:1024 lds
v_mfma_f32_16x16x32_bf16 v[80:83],v[140:143],a[180:183],v[80:83]
v_exp_f32 v86,v86
v_mfma_f32_16x16x32_bf16 v[88:91],v[140:143],a[204:207],v[88:91]
v_exp_f32 v87,v87
v_mfma_f32_16x16x32_bf16 v[96:99],v[140:143],a[228:231],v[96:99]
v_fma_f32 v92,v92,s36,v15
v_fma_f32 v93,v93,s36,v15
v_mfma_f32_16x16x32_bf16 v[104:107],v[140:143],a[252:255],v[104:107]
ds_read_b128 v[140:143],v1 offset:18688
v_fma_f32 v94,v94,s36,v15
v_mfma_f32_16x16x32_bf16 v[72:75],v[112:115],a[160:163],v[72:75]
v_fma_f32 v95,v95,s36,v15
v_cvt_pk_bf16_f32 v26,v84,v85
v_mfma_f32_16x16x32_bf16 v[80:83],v[112:115],a[184:187],v[80:83]
buffer_load_dwordx4 v8,s[4:7],s20 offen offset:2048 lds
v_mfma_f32_16x16x32_bf16 v[88:91],v[112:115],a[208:211],v[88:91]
s_add_u32 s20,s20,12288
v_cvt_pk_bf16_f32 v27,v86,v87
v_exp_f32 v92,v92
v_mfma_f32_16x16x32_bf16 v[96:99],v[112:115],a[232:235],v[96:99]
v_exp_f32 v93,v93
v_mfma_f32_16x16x32_bf16 v[56:59],v[48:51],v[24:27],0
v_exp_f32 v94,v94
v_mfma_f32_16x16x32_bf16 v[104:107],v[112:115],v[144:147],v[104:107]
ds_read_b64_tr_b16 v[112:113],v2 offset:0
ds_read_b64_tr_b16 v[114:115],v2 offset:6144
v_mfma_f32_16x16x32_bf16 v[72:75],v[116:119],a[164:167],v[72:75]
v_exp_f32 v95,v95
v_mfma_f32_16x16x32_bf16 v[80:83],v[116:119],a[188:191],v[80:83]
v_fma_f32 v100,v100,s36,v16
v_fma_f32 v101,v101,s36,v16
v_mfma_f32_16x16x32_bf16 v[88:91],v[116:119],a[212:215],v[88:91]
v_fma_f32 v102,v102,s36,v16
v_fma_f32 v103,v103,s36,v16
v_mfma_f32_16x16x32_bf16 v[96:99],v[116:119],a[236:239],v[96:99]
v_cvt_pk_bf16_f32 v32,v92,v93
v_cvt_pk_bf16_f32 v33,v94,v95
v_mfma_f32_16x16x32_bf16 v[104:107],v[116:119],v[148:151],v[104:107]
ds_read_b64_tr_b16 v[116:117],v3 offset:0
ds_read_b64_tr_b16 v[118:119],v3 offset:6144
v_mfma_f32_16x16x32_bf16 v[60:63],v[48:51],v[30:33],0
v_exp_f32 v100,v100
v_mfma_f32_16x16x32_bf16 v[76:79],v[120:123],a[144:147],0
v_exp_f32 v101,v101
v_mfma_f32_16x16x32_bf16 v[84:87],v[120:123],a[168:171],0
v_exp_f32 v102,v102
v_mfma_f32_16x16x32_bf16 v[92:95],v[120:123],a[192:195],0
v_exp_f32 v103,v103
v_fma_f32 v108,v108,s36,v17
v_fma_f32 v109,v109,s36,v17
v_fma_f32 v110,v110,s36,v17
v_fma_f32 v111,v111,s36,v17
v_cvt_pk_bf16_f32 v38,v100,v101
v_cvt_pk_bf16_f32 v39,v102,v103
v_mfma_f32_16x16x32_bf16 v[100:103],v[120:123],a[216:219],0
v_exp_f32 v108,v108
v_mfma_f32_16x16x32_bf16 v[64:67],v[48:51],v[36:39],0
v_exp_f32 v109,v109
v_exp_f32 v110,v110
v_exp_f32 v111,v111
v_cvt_pk_bf16_f32 v44,v108,v109
v_cvt_pk_bf16_f32 v45,v110,v111
v_mfma_f32_16x16x32_bf16 v[108:111],v[120:123],a[240:243],0
ds_read_b64_tr_b16 v[120:121],v4 offset:0
ds_read_b64_tr_b16 v[122:123],v4 offset:6144
v_mfma_f32_16x16x32_bf16 v[68:71],v[48:51],v[42:45],0
v_fma_f32 v72,v72,s36,v13
v_fma_f32 v73,v73,s36,v13
v_mfma_f32_16x16x32_bf16 v[76:79],v[124:127],a[148:151],v[76:79]
v_fma_f32 v74,v74,s36,v13
v_fma_f32 v75,v75,s36,v13
v_mfma_f32_16x16x32_bf16 v[84:87],v[124:127],a[172:175],v[84:87]
v_fma_f32 v80,v80,s36,v14
v_fma_f32 v81,v81,s36,v14
v_mfma_f32_16x16x32_bf16 v[92:95],v[124:127],a[196:199],v[92:95]
v_fma_f32 v82,v82,s36,v14
v_fma_f32 v83,v83,s36,v14
v_mfma_f32_16x16x32_bf16 v[100:103],v[124:127],a[220:223],v[100:103]
v_fma_f32 v88,v88,s36,v15
v_fma_f32 v89,v89,s36,v15
v_mfma_f32_16x16x32_bf16 v[108:111],v[124:127],a[244:247],v[108:111]
s_waitcnt lgkmcnt(2)
ds_read_b64_tr_b16 v[124:125],v5 offset:0
ds_read_b64_tr_b16 v[126:127],v5 offset:6144
v_mfma_f32_16x16x32_bf16 v[76:79],v[128:131],a[152:155],v[76:79]
v_exp_f32 v72,v72
v_mfma_f32_16x16x32_bf16 v[84:87],v[128:131],a[176:179],v[84:87]
v_exp_f32 v73,v73
v_mfma_f32_16x16x32_bf16 v[92:95],v[128:131],a[200:203],v[92:95]
v_exp_f32 v74,v74
v_mfma_f32_16x16x32_bf16 v[100:103],v[128:131],a[224:227],v[100:103]
v_exp_f32 v75,v75
v_mfma_f32_16x16x32_bf16 v[108:111],v[128:131],a[248:251],v[108:111]
v_exp_f32 v80,v80
v_mfma_f32_16x16x32_bf16 v[76:79],v[132:135],a[156:159],v[76:79]
v_exp_f32 v81,v81
v_mfma_f32_16x16x32_bf16 v[84:87],v[132:135],a[180:183],v[84:87]
v_exp_f32 v82,v82
v_mfma_f32_16x16x32_bf16 v[92:95],v[132:135],a[204:207],v[92:95]
v_exp_f32 v83,v83
v_mfma_f32_16x16x32_bf16 v[100:103],v[132:135],a[228:231],v[100:103]
v_exp_f32 v88,v88
v_mfma_f32_16x16x32_bf16 v[108:111],v[132:135],a[252:255],v[108:111]
v_exp_f32 v89,v89
v_mfma_f32_16x16x32_bf16 v[76:79],v[136:139],a[160:163],v[76:79]
v_cvt_pk_bf16_f32 v22,v72,v73
v_cvt_pk_bf16_f32 v23,v74,v75
v_mfma_f32_16x16x32_bf16 v[84:87],v[136:139],a[184:187],v[84:87]
v_cvt_pk_bf16_f32 v28,v80,v81
v_cvt_pk_bf16_f32 v29,v82,v83
v_mfma_f32_16x16x32_bf16 v[92:95],v[136:139],a[208:211],v[92:95]
v_cvt_pk_bf16_f32 v34,v88,v89
v_mfma_f32_16x16x32_bf16 v[100:103],v[136:139],a[232:235],v[100:103]
v_mfma_f32_16x16x32_bf16 v[108:111],v[136:139],v[144:147],v[108:111]
v_mfma_f32_16x16x32_bf16 v[76:79],v[140:143],a[164:167],v[76:79]
v_mfma_f32_16x16x32_bf16 v[84:87],v[140:143],a[188:191],v[84:87]
v_mfma_f32_16x16x32_bf16 v[92:95],v[140:143],a[212:215],v[92:95]
v_mfma_f32_16x16x32_bf16 v[100:103],v[140:143],a[236:239],v[100:103]
v_mfma_f32_16x16x32_bf16 v[108:111],v[140:143],v[148:151],v[108:111]
v_mfma_f32_16x16x32_bf16 v[160:163],v[112:115],v[18:21],0
s_add_u32 m0,s23,0
ds_read_b64_tr_b16 v[128:129],v2 offset:128
ds_read_b64_tr_b16 v[130:131],v2 offset:6272
v_mfma_f32_16x16x32_bf16 v[208:211],v[112:115],v[24:27],0
ds_read_b64_tr_b16 v[132:133],v3 offset:128
ds_read_b64_tr_b16 v[134:135],v3 offset:6272
v_mfma_f32_16x16x32_bf16 a[0:3],v[112:115],v[30:33],0
ds_read_b64_tr_b16 v[136:137],v4 offset:128
ds_read_b64_tr_b16 v[138:139],v4 offset:6272
v_mfma_f32_16x16x32_bf16 a[48:51],v[112:115],v[36:39],0
ds_read_b64_tr_b16 v[140:141],v5 offset:128
ds_read_b64_tr_b16 v[142:143],v5 offset:6272
v_mfma_f32_16x16x32_bf16 a[96:99],v[112:115],v[42:45],0
ds_read_b64_tr_b16 v[112:113],v2 offset:256
ds_read_b64_tr_b16 v[114:115],v2 offset:6400
v_mfma_f32_16x16x32_bf16 v[164:167],v[116:119],v[18:21],0
v_fma_f32 v90,v90,s36,v15
v_fma_f32 v91,v91,s36,v15
v_mfma_f32_16x16x32_bf16 v[212:215],v[116:119],v[24:27],0
v_exp_f32 v90,v90
v_mfma_f32_16x16x32_bf16 a[4:7],v[116:119],v[30:33],0
v_exp_f32 v91,v91
v_mfma_f32_16x16x32_bf16 a[52:55],v[116:119],v[36:39],0
v_cvt_pk_bf16_f32 v35,v90,v91
v_fma_f32 v96,v96,s36,v16
v_mfma_f32_16x16x32_bf16 a[100:103],v[116:119],v[42:45],0
s_waitcnt lgkmcnt(8)
ds_read_b64_tr_b16 v[116:117],v3 offset:256
ds_read_b64_tr_b16 v[118:119],v3 offset:6400
v_mfma_f32_16x16x32_bf16 v[168:171],v[120:123],v[18:21],0
v_fma_f32 v97,v97,s36,v16
v_fma_f32 v98,v98,s36,v16
v_mfma_f32_16x16x32_bf16 v[216:219],v[120:123],v[24:27],0
v_fma_f32 v99,v99,s36,v16
v_fma_f32 v104,v104,s36,v17
v_mfma_f32_16x16x32_bf16 a[8:11],v[120:123],v[30:33],0
v_exp_f32 v96,v96
v_mfma_f32_16x16x32_bf16 a[56:59],v[120:123],v[36:39],0
v_exp_f32 v97,v97
v_mfma_f32_16x16x32_bf16 a[104:107],v[120:123],v[42:45],0
ds_read_b64_tr_b16 v[120:121],v4 offset:256
ds_read_b64_tr_b16 v[122:123],v4 offset:6400
v_mfma_f32_16x16x32_bf16 v[172:175],v[124:127],v[18:21],0
v_exp_f32 v98,v98
v_mfma_f32_16x16x32_bf16 v[220:223],v[124:127],v[24:27],0
v_exp_f32 v99,v99
v_mfma_f32_16x16x32_bf16 a[12:15],v[124:127],v[30:33],0
v_cvt_pk_bf16_f32 v40,v96,v97
v_cvt_pk_bf16_f32 v41,v98,v99
v_mfma_f32_16x16x32_bf16 a[60:63],v[124:127],v[36:39],0
v_fma_f32 v105,v105,s36,v17
v_fma_f32 v106,v106,s36,v17
v_mfma_f32_16x16x32_bf16 a[108:111],v[124:127],v[42:45],0
ds_read_b64_tr_b16 v[124:125],v5 offset:256
ds_read_b64_tr_b16 v[126:127],v5 offset:6400
v_mfma_f32_16x16x32_bf16 v[176:179],v[128:131],v[18:21],0
v_fma_f32 v107,v107,s36,v17
v_fma_f32 v76,v76,s36,v13
v_mfma_f32_16x16x32_bf16 v[224:227],v[128:131],v[24:27],0
v_exp_f32 v104,v104
v_mfma_f32_16x16x32_bf16 a[16:19],v[128:131],v[30:33],0
v_exp_f32 v105,v105
v_mfma_f32_16x16x32_bf16 a[64:67],v[128:131],v[36:39],0
v_exp_f32 v106,v106
v_mfma_f32_16x16x32_bf16 a[112:115],v[128:131],v[42:45],0
s_waitcnt lgkmcnt(2)
v_exp_f32 v107,v107
v_mfma_f32_16x16x32_bf16 v[180:183],v[132:135],v[18:21],0
v_cvt_pk_bf16_f32 v46,v104,v105
v_cvt_pk_bf16_f32 v47,v106,v107
v_mfma_f32_16x16x32_bf16 v[228:231],v[132:135],v[24:27],0
v_fma_f32 v77,v77,s36,v13
v_fma_f32 v78,v78,s36,v13
v_mfma_f32_16x16x32_bf16 a[20:23],v[132:135],v[30:33],0
v_fma_f32 v79,v79,s36,v13
v_fma_f32 v84,v84,s36,v14
v_mfma_f32_16x16x32_bf16 a[68:71],v[132:135],v[36:39],0
v_exp_f32 v76,v76
v_mfma_f32_16x16x32_bf16 a[116:119],v[132:135],v[42:45],0
v_exp_f32 v77,v77
v_mfma_f32_16x16x32_bf16 v[184:187],v[136:139],v[18:21],0
v_exp_f32 v78,v78
v_mfma_f32_16x16x32_bf16 v[232:235],v[136:139],v[24:27],0
v_exp_f32 v79,v79
v_mfma_f32_16x16x32_bf16 a[24:27],v[136:139],v[30:33],0
v_fma_f32 v85,v85,s36,v14
v_fma_f32 v86,v86,s36,v14
v_mfma_f32_16x16x32_bf16 a[72:75],v[136:139],v[36:39],0
v_fma_f32 v87,v87,s36,v14
v_fma_f32 v92,v92,s36,v15
v_mfma_f32_16x16x32_bf16 a[120:123],v[136:139],v[42:45],0
v_exp_f32 v84,v84
v_mfma_f32_16x16x32_bf16 v[188:191],v[140:143],v[18:21],0
v_exp_f32 v85,v85
v_mfma_f32_16x16x32_bf16 v[236:239],v[140:143],v[24:27],0
v_exp_f32 v86,v86
v_mfma_f32_16x16x32_bf16 a[28:31],v[140:143],v[30:33],0
v_exp_f32 v87,v87
v_mfma_f32_16x16x32_bf16 a[76:79],v[140:143],v[36:39],0
v_fma_f32 v93,v93,s36,v15
v_fma_f32 v94,v94,s36,v15
v_mfma_f32_16x16x32_bf16 a[124:127],v[140:143],v[42:45],0
v_fma_f32 v95,v95,s36,v15
v_fma_f32 v100,v100,s36,v16
v_mfma_f32_16x16x32_bf16 v[192:195],v[112:115],v[18:21],0
v_exp_f32 v92,v92
v_mfma_f32_16x16x32_bf16 v[240:243],v[112:115],v[24:27],0
v_exp_f32 v93,v93
s_waitcnt vmcnt(30) lgkmcnt(0)
v_mfma_f32_16x16x32_bf16 a[32:35],v[112:115],v[30:33],0
s_barrier
v_mfma_f32_16x16x32_bf16 a[80:83],v[112:115],v[36:39],0
ds_read_b128 v[128:131],v0 offset:24576
v_fma_f32 v101,v101,s36,v16
v_mfma_f32_16x16x32_bf16 a[128:131],v[112:115],v[42:45],0
ds_read_b128 v[132:135],v1 offset:24576
v_fma_f32 v102,v102,s36,v16
v_mfma_f32_16x16x32_bf16 v[196:199],v[116:119],v[18:21],0
ds_read_b128 v[136:139],v0 offset:24704
v_fma_f32 v103,v103,s36,v16
v_mfma_f32_16x16x32_bf16 v[244:247],v[116:119],v[24:27],0
ds_read_b128 v[140:143],v1 offset:24704
v_fma_f32 v108,v108,s36,v17
v_mfma_f32_16x16x32_bf16 a[36:39],v[116:119],v[30:33],0
ds_read_b128 v[112:115],v0 offset:24832
v_fma_f32 v109,v109,s36,v17
v_mfma_f32_16x16x32_bf16 a[84:87],v[116:119],v[36:39],0
buffer_load_dwordx4 v6,s[8:11],s21 offen offset:0 lds
v_mfma_f32_16x16x32_bf16 a[132:135],v[116:119],v[42:45],0
ds_read_b128 v[116:119],v1 offset:24832
v_fma_f32 v110,v110,s36,v17
v_mfma_f32_16x16x32_bf16 v[200:203],v[120:123],v[18:21],0
v_exp_f32 v94,v94
v_mfma_f32_16x16x32_bf16 v[248:251],v[120:123],v[24:27],0
v_exp_f32 v95,v95
v_mfma_f32_16x16x32_bf16 a[40:43],v[120:123],v[30:33],0
v_exp_f32 v100,v100
v_mfma_f32_16x16x32_bf16 a[88:91],v[120:123],v[36:39],0
v_exp_f32 v101,v101
v_mfma_f32_16x16x32_bf16 a[136:139],v[120:123],v[42:45],0
ds_read_b128 v[120:123],v0 offset:30720
v_fma_f32 v111,v111,s36,v17
v_mfma_f32_16x16x32_bf16 v[204:207],v[124:127],v[18:21],0
v_cvt_pk_bf16_f32 v20,v76,v77
v_cvt_pk_bf16_f32 v21,v78,v79
v_mfma_f32_16x16x32_bf16 v[252:255],v[124:127],v[24:27],0
v_cvt_pk_bf16_f32 v26,v84,v85
v_cvt_pk_bf16_f32 v27,v86,v87
v_mfma_f32_16x16x32_bf16 v[52:55],v[48:51],v[20:23],v[52:55]
v_exp_f32 v102,v102
v_mfma_f32_16x16x32_bf16 v[56:59],v[48:51],v[26:29],v[56:59]
v_exp_f32 v103,v103
v_mfma_f32_16x16x32_bf16 a[44:47],v[124:127],v[30:33],0
v_cvt_pk_bf16_f32 v32,v92,v93
v_cvt_pk_bf16_f32 v33,v94,v95
v_mfma_f32_16x16x32_bf16 a[92:95],v[124:127],v[36:39],0
buffer_load_dwordx4 v7,s[8:11],s21 offen offset:1024 lds
v_mfma_f32_16x16x32_bf16 v[60:63],v[48:51],v[32:35],v[60:63]
v_cvt_pk_bf16_f32 v38,v100,v101
v_cvt_pk_bf16_f32 v39,v102,v103
v_mfma_f32_16x16x32_bf16 a[140:143],v[124:127],v[42:45],0
ds_read_b128 v[124:127],v1 offset:30720
v_mfma_f32_16x16x32_bf16 v[64:67],v[48:51],v[38:41],v[64:67]
s_waitcnt lgkmcnt(1)
v_exp_f32 v108,v108
v_mfma_f32_16x16x32_bf16 v[72:75],v[128:131],a[144:147],0
v_exp_f32 v109,v109
v_mfma_f32_16x16x32_bf16 v[80:83],v[128:131],a[168:171],0
v_exp_f32 v110,v110
v_mfma_f32_16x16x32_bf16 v[88:91],v[128:131],a[192:195],0
v_exp_f32 v111,v111
v_mfma_f32_16x16x32_bf16 v[96:99],v[128:131],a[216:219],0
v_cvt_pk_bf16_f32 v44,v108,v109
v_cvt_pk_bf16_f32 v45,v110,v111
v_mfma_f32_16x16x32_bf16 v[104:107],v[128:131],a[240:243],0
ds_read_b128 v[128:131],v0 offset:30848
v_mfma_f32_16x16x32_bf16 v[68:71],v[48:51],v[44:47],v[68:71]
v_mfma_f32_16x16x32_bf16 v[72:75],v[132:135],a[148:151],v[72:75]
v_mfma_f32_16x16x32_bf16 v[80:83],v[132:135],a[172:175],v[80:83]
buffer_load_dwordx4 v8,s[8:11],s21 offen offset:2048 lds
v_mfma_f32_16x16x32_bf16 v[88:91],v[132:135],a[196:199],v[88:91]
s_add_u32 s21,s21,12288
v_mfma_f32_16x16x32_bf16 v[96:99],v[132:135],a[220:223],v[96:99]
s_add_u32 m0,s22,12288
v_mfma_f32_16x16x32_bf16 v[104:107],v[132:135],a[244:247],v[104:107]
ds_read_b128 v[132:135],v1 offset:30848
v_mfma_f32_16x16x32_bf16 v[72:75],v[136:139],a[152:155],v[72:75]
v_mfma_f32_16x16x32_bf16 v[80:83],v[136:139],a[176:179],v[80:83]
v_mfma_f32_16x16x32_bf16 v[88:91],v[136:139],a[200:203],v[88:91]
v_mfma_f32_16x16x32_bf16 v[96:99],v[136:139],a[224:227],v[96:99]
v_mfma_f32_16x16x32_bf16 v[104:107],v[136:139],a[248:251],v[104:107]
ds_read_b128 v[136:139],v0 offset:30976
v_mfma_f32_16x16x32_bf16 v[72:75],v[140:143],a[156:159],v[72:75]
v_mfma_f32_16x16x32_bf16 v[80:83],v[140:143],a[180:183],v[80:83]
v_mfma_f32_16x16x32_bf16 v[88:91],v[140:143],a[204:207],v[88:91]
buffer_load_dwordx4 v6,s[4:7],s20 offen offset:0 lds
v_mfma_f32_16x16x32_bf16 v[96:99],v[140:143],a[228:231],v[96:99]
v_mfma_f32_16x16x32_bf16 v[104:107],v[140:143],a[252:255],v[104:107]
ds_read_b128 v[140:143],v1 offset:30976
v_mfma_f32_16x16x32_bf16 v[72:75],v[112:115],a[160:163],v[72:75]
v_mfma_f32_16x16x32_bf16 v[80:83],v[112:115],a[184:187],v[80:83]
v_mfma_f32_16x16x32_bf16 v[88:91],v[112:115],a[208:211],v[88:91]
v_mfma_f32_16x16x32_bf16 v[96:99],v[112:115],a[232:235],v[96:99]
v_mfma_f32_16x16x32_bf16 v[104:107],v[112:115],v[144:147],v[104:107]
v_mfma_f32_16x16x32_bf16 v[72:75],v[116:119],a[164:167],v[72:75]
v_mfma_f32_16x16x32_bf16 v[80:83],v[116:119],a[188:191],v[80:83]
v_mfma_f32_16x16x32_bf16 v[88:91],v[116:119],a[212:215],v[88:91]
v_mfma_f32_16x16x32_bf16 v[96:99],v[116:119],a[236:239],v[96:99]
v_mfma_f32_16x16x32_bf16 v[104:107],v[116:119],v[148:151],v[104:107]
buffer_load_dwordx4 v7,s[4:7],s20 offen offset:1024 lds
v_mfma_f32_16x16x32_bf16 v[76:79],v[120:123],a[144:147],0
v_mfma_f32_16x16x32_bf16 v[84:87],v[120:123],a[168:171],0
v_mfma_f32_16x16x32_bf16 v[92:95],v[120:123],a[192:195],0
v_fma_f32 v72,v72,s36,v13
v_fma_f32 v73,v73,s36,v13
v_mfma_f32_16x16x32_bf16 v[100:103],v[120:123],a[216:219],0
v_fma_f32 v74,v74,s36,v13
v_fma_f32 v75,v75,s36,v13
v_mfma_f32_16x16x32_bf16 v[108:111],v[120:123],a[240:243],0
s_waitcnt lgkmcnt(0)
v_fma_f32 v80,v80,s36,v14
v_fma_f32 v81,v81,s36,v14
v_mfma_f32_16x16x32_bf16 v[76:79],v[124:127],a[148:151],v[76:79]
v_fma_f32 v82,v82,s36,v14
v_fma_f32 v83,v83,s36,v14
v_mfma_f32_16x16x32_bf16 v[84:87],v[124:127],a[172:175],v[84:87]
v_fma_f32 v88,v88,s36,v15
v_fma_f32 v89,v89,s36,v15
v_mfma_f32_16x16x32_bf16 v[92:95],v[124:127],a[196:199],v[92:95]
v_exp_f32 v72,v72
v_mfma_f32_16x16x32_bf16 v[100:103],v[124:127],a[220:223],v[100:103]
v_exp_f32 v73,v73
v_mfma_f32_16x16x32_bf16 v[108:111],v[124:127],a[244:247],v[108:111]
v_exp_f32 v74,v74
v_mfma_f32_16x16x32_bf16 v[76:79],v[128:131],a[152:155],v[76:79]
buffer_load_dwordx4 v8,s[4:7],s20 offen offset:2048 lds
v_mfma_f32_16x16x32_bf16 v[84:87],v[128:131],a[176:179],v[84:87]
s_add_u32 s20,s20,12288
v_exp_f32 v75,v75
v_mfma_f32_16x16x32_bf16 v[92:95],v[128:131],a[200:203],v[92:95]
v_exp_f32 v80,v80
v_mfma_f32_16x16x32_bf16 v[100:103],v[128:131],a[224:227],v[100:103]
v_exp_f32 v81,v81
v_mfma_f32_16x16x32_bf16 v[108:111],v[128:131],a[248:251],v[108:111]
v_exp_f32 v82,v82
v_mfma_f32_16x16x32_bf16 v[76:79],v[132:135],a[156:159],v[76:79]
ds_read_b64_tr_b16 v[112:113],v2 offset:18432
v_mfma_f32_16x16x32_bf16 v[84:87],v[132:135],a[180:183],v[84:87]
ds_read_b64_tr_b16 v[114:115],v2 offset:12288
v_cvt_pk_bf16_f32 v18,v72,v73
v_mfma_f32_16x16x32_bf16 v[92:95],v[132:135],a[204:207],v[92:95]
v_exp_f32 v83,v83
v_mfma_f32_16x16x32_bf16 v[100:103],v[132:135],a[228:231],v[100:103]
ds_read_b64_tr_b16 v[116:117],v3 offset:18432
ds_read_b64_tr_b16 v[118:119],v3 offset:12288
v_mfma_f32_16x16x32_bf16 v[108:111],v[132:135],a[252:255],v[108:111]
v_exp_f32 v88,v88
v_mfma_f32_16x16x32_bf16 v[76:79],v[136:139],a[160:163],v[76:79]
ds_read_b64_tr_b16 v[120:121],v4 offset:18432
v_mfma_f32_16x16x32_bf16 v[84:87],v[136:139],a[184:187],v[84:87]
ds_read_b64_tr_b16 v[122:123],v4 offset:12288
v_cvt_pk_bf16_f32 v19,v74,v75
v_mfma_f32_16x16x32_bf16 v[92:95],v[136:139],a[208:211],v[92:95]
v_exp_f32 v89,v89
v_mfma_f32_16x16x32_bf16 v[100:103],v[136:139],a[232:235],v[100:103]
ds_read_b64_tr_b16 v[124:125],v5 offset:18432
ds_read_b64_tr_b16 v[126:127],v5 offset:12288
v_mfma_f32_16x16x32_bf16 v[108:111],v[136:139],v[144:147],v[108:111]
v_cvt_pk_bf16_f32 v24,v80,v81
v_cvt_pk_bf16_f32 v25,v82,v83
v_mfma_f32_16x16x32_bf16 v[76:79],v[140:143],a[164:167],v[76:79]
v_cvt_pk_bf16_f32 v30,v88,v89
v_mfma_f32_16x16x32_bf16 v[84:87],v[140:143],a[188:191],v[84:87]
v_mfma_f32_16x16x32_bf16 v[92:95],v[140:143],a[212:215],v[92:95]
v_mfma_f32_16x16x32_bf16 v[100:103],v[140:143],a[236:239],v[100:103]
v_mfma_f32_16x16x32_bf16 v[108:111],v[140:143],v[148:151],v[108:111]
s_waitcnt lgkmcnt(3)
v_mfma_f32_16x16x32_bf16 v[160:163],v[112:115],v[20:23],v[160:163]
s_add_u32 m0,s23,12288
ds_read_b64_tr_b16 v[128:129],v2 offset:18560
ds_read_b64_tr_b16 v[130:131],v2 offset:12416
v_mfma_f32_16x16x32_bf16 v[208:211],v[112:115],v[26:29],v[208:211]
ds_read_b64_tr_b16 v[132:133],v3 offset:18560
ds_read_b64_tr_b16 v[134:135],v3 offset:12416
v_mfma_f32_16x16x32_bf16 a[0:3],v[112:115],v[32:35],a[0:3]
ds_read_b64_tr_b16 v[136:137],v4 offset:18560
ds_read_b64_tr_b16 v[138:139],v4 offset:12416
v_mfma_f32_16x16x32_bf16 a[48:51],v[112:115],v[38:41],a[48:51]
ds_read_b64_tr_b16 v[140:141],v5 offset:18560
ds_read_b64_tr_b16 v[142:143],v5 offset:12416
v_mfma_f32_16x16x32_bf16 a[96:99],v[112:115],v[44:47],a[96:99]
ds_read_b64_tr_b16 v[112:113],v2 offset:18688
ds_read_b64_tr_b16 v[114:115],v2 offset:12544
v_mfma_f32_16x16x32_bf16 v[164:167],v[116:119],v[20:23],v[164:167]
v_fma_f32 v90,v90,s36,v15
v_fma_f32 v91,v91,s36,v15
v_mfma_f32_16x16x32_bf16 v[212:215],v[116:119],v[26:29],v[212:215]
v_exp_f32 v90,v90
v_mfma_f32_16x16x32_bf16 a[4:7],v[116:119],v[32:35],a[4:7]
v_exp_f32 v91,v91
v_mfma_f32_16x16x32_bf16 a[52:55],v[116:119],v[38:41],a[52:55]
v_cvt_pk_bf16_f32 v31,v90,v91
v_fma_f32 v96,v96,s36,v16
v_mfma_f32_16x16x32_bf16 a[100:103],v[116:119],v[44:47],a[100:103]
s_waitcnt lgkmcnt(8)
ds_read_b64_tr_b16 v[116:117],v3 offset:18688
ds_read_b64_tr_b16 v[118:119],v3 offset:12544
v_mfma_f32_16x16x32_bf16 v[168:171],v[120:123],v[20:23],v[168:171]
v_fma_f32 v97,v97,s36,v16
v_fma_f32 v98,v98,s36,v16
v_mfma_f32_16x16x32_bf16 v[216:219],v[120:123],v[26:29],v[216:219]
v_fma_f32 v99,v99,s36,v16
v_fma_f32 v104,v104,s36,v17
v_mfma_f32_16x16x32_bf16 a[8:11],v[120:123],v[32:35],a[8:11]
v_exp_f32 v96,v96
v_mfma_f32_16x16x32_bf16 a[56:59],v[120:123],v[38:41],a[56:59]
v_exp_f32 v97,v97
v_mfma_f32_16x16x32_bf16 a[104:107],v[120:123],v[44:47],a[104:107]
ds_read_b64_tr_b16 v[120:121],v4 offset:18688
ds_read_b64_tr_b16 v[122:123],v4 offset:12544
v_mfma_f32_16x16x32_bf16 v[172:175],v[124:127],v[20:23],v[172:175]
v_exp_f32 v98,v98
v_mfma_f32_16x16x32_bf16 v[220:223],v[124:127],v[26:29],v[220:223]
v_exp_f32 v99,v99
v_mfma_f32_16x16x32_bf16 a[12:15],v[124:127],v[32:35],a[12:15]
v_cvt_pk_bf16_f32 v36,v96,v97
v_cvt_pk_bf16_f32 v37,v98,v99
v_mfma_f32_16x16x32_bf16 a[60:63],v[124:127],v[38:41],a[60:63]
v_fma_f32 v105,v105,s36,v17
v_fma_f32 v106,v106,s36,v17
v_mfma_f32_16x16x32_bf16 a[108:111],v[124:127],v[44:47],a[108:111]
ds_read_b64_tr_b16 v[124:125],v5 offset:18688
ds_read_b64_tr_b16 v[126:127],v5 offset:12544
v_mfma_f32_16x16x32_bf16 v[176:179],v[128:131],v[20:23],v[176:179]
v_fma_f32 v107,v107,s36,v17
v_fma_f32 v76,v76,s36,v13
v_mfma_f32_16x16x32_bf16 v[224:227],v[128:131],v[26:29],v[224:227]
v_exp_f32 v104,v104
v_mfma_f32_16x16x32_bf16 a[16:19],v[128:131],v[32:35],a[16:19]
v_exp_f32 v105,v105
v_mfma_f32_16x16x32_bf16 a[64:67],v[128:131],v[38:41],a[64:67]
v_exp_f32 v106,v106
v_mfma_f32_16x16x32_bf16 a[112:115],v[128:131],v[44:47],a[112:115]
s_waitcnt lgkmcnt(2)
v_exp_f32 v107,v107
v_mfma_f32_16x16x32_bf16 v[180:183],v[132:135],v[20:23],v[180:183]
v_cvt_pk_bf16_f32 v42,v104,v105
v_cvt_pk_bf16_f32 v43,v106,v107
v_mfma_f32_16x16x32_bf16 v[228:231],v[132:135],v[26:29],v[228:231]
v_fma_f32 v77,v77,s36,v13
v_fma_f32 v78,v78,s36,v13
v_mfma_f32_16x16x32_bf16 a[20:23],v[132:135],v[32:35],a[20:23]
v_fma_f32 v79,v79,s36,v13
v_fma_f32 v84,v84,s36,v14
v_mfma_f32_16x16x32_bf16 a[68:71],v[132:135],v[38:41],a[68:71]
v_exp_f32 v76,v76
v_mfma_f32_16x16x32_bf16 a[116:119],v[132:135],v[44:47],a[116:119]
v_exp_f32 v77,v77
v_mfma_f32_16x16x32_bf16 v[184:187],v[136:139],v[20:23],v[184:187]
v_exp_f32 v78,v78
v_mfma_f32_16x16x32_bf16 v[232:235],v[136:139],v[26:29],v[232:235]
v_exp_f32 v79,v79
v_mfma_f32_16x16x32_bf16 a[24:27],v[136:139],v[32:35],a[24:27]
v_fma_f32 v85,v85,s36,v14
v_fma_f32 v86,v86,s36,v14
v_mfma_f32_16x16x32_bf16 a[72:75],v[136:139],v[38:41],a[72:75]
v_fma_f32 v87,v87,s36,v14
v_fma_f32 v92,v92,s36,v15
v_mfma_f32_16x16x32_bf16 a[120:123],v[136:139],v[44:47],a[120:123]
v_exp_f32 v84,v84
v_mfma_f32_16x16x32_bf16 v[188:191],v[140:143],v[20:23],v[188:191]
v_exp_f32 v85,v85
v_mfma_f32_16x16x32_bf16 v[236:239],v[140:143],v[26:29],v[236:239]
v_exp_f32 v86,v86
v_mfma_f32_16x16x32_bf16 a[28:31],v[140:143],v[32:35],a[28:31]
v_exp_f32 v87,v87
v_mfma_f32_16x16x32_bf16 a[76:79],v[140:143],v[38:41],a[76:79]
v_fma_f32 v93,v93,s36,v15
v_fma_f32 v94,v94,s36,v15
v_mfma_f32_16x16x32_bf16 a[124:127],v[140:143],v[44:47],a[124:127]
v_fma_f32 v95,v95,s36,v15
v_fma_f32 v100,v100,s36,v16
v_mfma_f32_16x16x32_bf16 v[192:195],v[112:115],v[20:23],v[192:195]
v_exp_f32 v92,v92
v_mfma_f32_16x16x32_bf16 v[240:243],v[112:115],v[26:29],v[240:243]
v_exp_f32 v93,v93
s_waitcnt vmcnt(6) lgkmcnt(0)
v_mfma_f32_16x16x32_bf16 a[32:35],v[112:115],v[32:35],a[32:35]
s_barrier
v_mfma_f32_16x16x32_bf16 a[80:83],v[112:115],v[38:41],a[80:83]
ds_read_b128 v[128:131],v0 offset:0
v_fma_f32 v101,v101,s36,v16
v_mfma_f32_16x16x32_bf16 a[128:131],v[112:115],v[44:47],a[128:131]
ds_read_b128 v[132:135],v1 offset:0
v_fma_f32 v102,v102,s36,v16
v_mfma_f32_16x16x32_bf16 v[196:199],v[116:119],v[20:23],v[196:199]
ds_read_b128 v[136:139],v0 offset:128
v_fma_f32 v103,v103,s36,v16
v_mfma_f32_16x16x32_bf16 v[244:247],v[116:119],v[26:29],v[244:247]
ds_read_b128 v[140:143],v1 offset:128
v_fma_f32 v108,v108,s36,v17
v_mfma_f32_16x16x32_bf16 a[36:39],v[116:119],v[32:35],a[36:39]
ds_read_b128 v[112:115],v0 offset:256
v_fma_f32 v109,v109,s36,v17
v_mfma_f32_16x16x32_bf16 a[84:87],v[116:119],v[38:41],a[84:87]
buffer_load_dwordx4 v6,s[8:11],s21 offen offset:0 lds
v_mfma_f32_16x16x32_bf16 a[132:135],v[116:119],v[44:47],a[132:135]
ds_read_b128 v[116:119],v1 offset:256
v_fma_f32 v110,v110,s36,v17
v_mfma_f32_16x16x32_bf16 v[200:203],v[120:123],v[20:23],v[200:203]
v_exp_f32 v94,v94
v_mfma_f32_16x16x32_bf16 v[248:251],v[120:123],v[26:29],v[248:251]
v_exp_f32 v95,v95
v_mfma_f32_16x16x32_bf16 a[40:43],v[120:123],v[32:35],a[40:43]
v_exp_f32 v100,v100
v_mfma_f32_16x16x32_bf16 a[88:91],v[120:123],v[38:41],a[88:91]
v_exp_f32 v101,v101
v_mfma_f32_16x16x32_bf16 a[136:139],v[120:123],v[44:47],a[136:139]
ds_read_b128 v[120:123],v0 offset:6144
v_fma_f32 v111,v111,s36,v17
v_mfma_f32_16x16x32_bf16 v[204:207],v[124:127],v[20:23],v[204:207]
v_cvt_pk_bf16_f32 v20,v76,v77
v_cvt_pk_bf16_f32 v21,v78,v79
v_mfma_f32_16x16x32_bf16 v[252:255],v[124:127],v[26:29],v[252:255]
v_cvt_pk_bf16_f32 v26,v84,v85
v_cvt_pk_bf16_f32 v27,v86,v87
v_mfma_f32_16x16x32_bf16 v[52:55],v[48:51],v[18:21],v[52:55]
v_exp_f32 v102,v102
v_mfma_f32_16x16x32_bf16 v[56:59],v[48:51],v[24:27],v[56:59]
v_exp_f32 v103,v103
v_mfma_f32_16x16x32_bf16 a[44:47],v[124:127],v[32:35],a[44:47]
v_cvt_pk_bf16_f32 v32,v92,v93
v_cvt_pk_bf16_f32 v33,v94,v95
v_mfma_f32_16x16x32_bf16 a[92:95],v[124:127],v[38:41],a[92:95]
buffer_load_dwordx4 v7,s[8:11],s21 offen offset:1024 lds
v_mfma_f32_16x16x32_bf16 v[60:63],v[48:51],v[30:33],v[60:63]
v_cvt_pk_bf16_f32 v38,v100,v101
v_cvt_pk_bf16_f32 v39,v102,v103
v_mfma_f32_16x16x32_bf16 a[140:143],v[124:127],v[44:47],a[140:143]
ds_read_b128 v[124:127],v1 offset:6144
v_mfma_f32_16x16x32_bf16 v[64:67],v[48:51],v[36:39],v[64:67]
s_waitcnt lgkmcnt(1)
v_exp_f32 v108,v108
v_mfma_f32_16x16x32_bf16 v[72:75],v[128:131],a[144:147],0
v_exp_f32 v109,v109
v_mfma_f32_16x16x32_bf16 v[80:83],v[128:131],a[168:171],0
v_exp_f32 v110,v110
v_mfma_f32_16x16x32_bf16 v[88:91],v[128:131],a[192:195],0
v_exp_f32 v111,v111
v_mfma_f32_16x16x32_bf16 v[96:99],v[128:131],a[216:219],0
v_cvt_pk_bf16_f32 v44,v108,v109
v_cvt_pk_bf16_f32 v45,v110,v111
v_mfma_f32_16x16x32_bf16 v[104:107],v[128:131],a[240:243],0
ds_read_b128 v[128:131],v0 offset:6272
v_mfma_f32_16x16x32_bf16 v[68:71],v[48:51],v[42:45],v[68:71]
v_mfma_f32_16x16x32_bf16 v[72:75],v[132:135],a[148:151],v[72:75]
v_mfma_f32_16x16x32_bf16 v[80:83],v[132:135],a[172:175],v[80:83]
buffer_load_dwordx4 v8,s[8:11],s21 offen offset:2048 lds
v_mfma_f32_16x16x32_bf16 v[88:91],v[132:135],a[196:199],v[88:91]
s_add_u32 s21,s21,12288
v_mfma_f32_16x16x32_bf16 v[96:99],v[132:135],a[220:223],v[96:99]
s_add_u32 m0,s22,24576
v_mfma_f32_16x16x32_bf16 v[104:107],v[132:135],a[244:247],v[104:107]
ds_read_b128 v[132:135],v1 offset:6272
v_mfma_f32_16x16x32_bf16 v[72:75],v[136:139],a[152:155],v[72:75]
v_mfma_f32_16x16x32_bf16 v[80:83],v[136:139],a[176:179],v[80:83]
v_mfma_f32_16x16x32_bf16 v[88:91],v[136:139],a[200:203],v[88:91]
v_mfma_f32_16x16x32_bf16 v[96:99],v[136:139],a[224:227],v[96:99]
v_mfma_f32_16x16x32_bf16 v[104:107],v[136:139],a[248:251],v[104:107]
ds_read_b128 v[136:139],v0 offset:6400
v_mfma_f32_16x16x32_bf16 v[72:75],v[140:143],a[156:159],v[72:75]
v_mfma_f32_16x16x32_bf16 v[80:83],v[140:143],a[180:183],v[80:83]
v_mfma_f32_16x16x32_bf16 v[88:91],v[140:143],a[204:207],v[88:91]
buffer_load_dwordx4 v6,s[4:7],s20 offen offset:0 lds
v_mfma_f32_16x16x32_bf16 v[96:99],v[140:143],a[228:231],v[96:99]
v_mfma_f32_16x16x32_bf16 v[104:107],v[140:143],a[252:255],v[104:107]
ds_read_b128 v[140:143],v1 offset:6400
v_mfma_f32_16x16x32_bf16 v[72:75],v[112:115],a[160:163],v[72:75]
v_mfma_f32_16x16x32_bf16 v[80:83],v[112:115],a[184:187],v[80:83]
v_mfma_f32_16x16x32_bf16 v[88:91],v[112:115],a[208:211],v[88:91]
v_mfma_f32_16x16x32_bf16 v[96:99],v[112:115],a[232:235],v[96:99]
v_mfma_f32_16x16x32_bf16 v[104:107],v[112:115],v[144:147],v[104:107]
v_mfma_f32_16x16x32_bf16 v[72:75],v[116:119],a[164:167],v[72:75]
v_mfma_f32_16x16x32_bf16 v[80:83],v[116:119],a[188:191],v[80:83]
v_mfma_f32_16x16x32_bf16 v[88:91],v[116:119],a[212:215],v[88:91]
v_mfma_f32_16x16x32_bf16 v[96:99],v[116:119],a[236:239],v[96:99]
v_mfma_f32_16x16x32_bf16 v[104:107],v[116:119],v[148:151],v[104:107]
buffer_load_dwordx4 v7,s[4:7],s20 offen offset:1024 lds
v_mfma_f32_16x16x32_bf16 v[76:79],v[120:123],a[144:147],0
v_mfma_f32_16x16x32_bf16 v[84:87],v[120:123],a[168:171],0
v_mfma_f32_16x16x32_bf16 v[92:95],v[120:123],a[192:195],0
v_fma_f32 v72,v72,s36,v13
v_fma_f32 v73,v73,s36,v13
v_mfma_f32_16x16x32_bf16 v[100:103],v[120:123],a[216:219],0
v_fma_f32 v74,v74,s36,v13
v_fma_f32 v75,v75,s36,v13
v_mfma_f32_16x16x32_bf16 v[108:111],v[120:123],a[240:243],0
s_waitcnt lgkmcnt(0)
v_fma_f32 v80,v80,s36,v14
v_fma_f32 v81,v81,s36,v14
v_mfma_f32_16x16x32_bf16 v[76:79],v[124:127],a[148:151],v[76:79]
v_fma_f32 v82,v82,s36,v14
v_fma_f32 v83,v83,s36,v14
v_mfma_f32_16x16x32_bf16 v[84:87],v[124:127],a[172:175],v[84:87]
v_fma_f32 v88,v88,s36,v15
v_fma_f32 v89,v89,s36,v15
v_mfma_f32_16x16x32_bf16 v[92:95],v[124:127],a[196:199],v[92:95]
v_exp_f32 v72,v72
v_mfma_f32_16x16x32_bf16 v[100:103],v[124:127],a[220:223],v[100:103]
v_exp_f32 v73,v73
v_mfma_f32_16x16x32_bf16 v[108:111],v[124:127],a[244:247],v[108:111]
v_exp_f32 v74,v74
v_mfma_f32_16x16x32_bf16 v[76:79],v[128:131],a[152:155],v[76:79]
buffer_load_dwordx4 v8,s[4:7],s20 offen offset:2048 lds
v_mfma_f32_16x16x32_bf16 v[84:87],v[128:131],a[176:179],v[84:87]
s_add_u32 s20,s20,12288
v_exp_f32 v75,v75
v_mfma_f32_16x16x32_bf16 v[92:95],v[128:131],a[200:203],v[92:95]
v_exp_f32 v80,v80
v_mfma_f32_16x16x32_bf16 v[100:103],v[128:131],a[224:227],v[100:103]
v_exp_f32 v81,v81
v_mfma_f32_16x16x32_bf16 v[108:111],v[128:131],a[248:251],v[108:111]
v_exp_f32 v82,v82
v_mfma_f32_16x16x32_bf16 v[76:79],v[132:135],a[156:159],v[76:79]
ds_read_b64_tr_b16 v[112:113],v2 offset:24576
v_mfma_f32_16x16x32_bf16 v[84:87],v[132:135],a[180:183],v[84:87]
ds_read_b64_tr_b16 v[114:115],v2 offset:30720
v_cvt_pk_bf16_f32 v22,v72,v73
v_mfma_f32_16x16x32_bf16 v[92:95],v[132:135],a[204:207],v[92:95]
v_exp_f32 v83,v83
v_mfma_f32_16x16x32_bf16 v[100:103],v[132:135],a[228:231],v[100:103]
ds_read_b64_tr_b16 v[116:117],v3 offset:24576
ds_read_b64_tr_b16 v[118:119],v3 offset:30720
v_mfma_f32_16x16x32_bf16 v[108:111],v[132:135],a[252:255],v[108:111]
v_exp_f32 v88,v88
v_mfma_f32_16x16x32_bf16 v[76:79],v[136:139],a[160:163],v[76:79]
ds_read_b64_tr_b16 v[120:121],v4 offset:24576
v_mfma_f32_16x16x32_bf16 v[84:87],v[136:139],a[184:187],v[84:87]
ds_read_b64_tr_b16 v[122:123],v4 offset:30720
v_cvt_pk_bf16_f32 v23,v74,v75
v_mfma_f32_16x16x32_bf16 v[92:95],v[136:139],a[208:211],v[92:95]
v_exp_f32 v89,v89
v_mfma_f32_16x16x32_bf16 v[100:103],v[136:139],a[232:235],v[100:103]
ds_read_b64_tr_b16 v[124:125],v5 offset:24576
ds_read_b64_tr_b16 v[126:127],v5 offset:30720
v_mfma_f32_16x16x32_bf16 v[108:111],v[136:139],v[144:147],v[108:111]
v_cvt_pk_bf16_f32 v28,v80,v81
v_cvt_pk_bf16_f32 v29,v82,v83
v_mfma_f32_16x16x32_bf16 v[76:79],v[140:143],a[164:167],v[76:79]
v_cvt_pk_bf16_f32 v34,v88,v89
v_mfma_f32_16x16x32_bf16 v[84:87],v[140:143],a[188:191],v[84:87]
v_mfma_f32_16x16x32_bf16 v[92:95],v[140:143],a[212:215],v[92:95]
v_mfma_f32_16x16x32_bf16 v[100:103],v[140:143],a[236:239],v[100:103]
v_mfma_f32_16x16x32_bf16 v[108:111],v[140:143],v[148:151],v[108:111]
s_mov_b32 s38,0
s_branch L_loop5
L_tr44:
s_waitcnt vmcnt(42)
s_waitcnt lgkmcnt(4)
v_mfma_f32_16x16x32_bf16 v[160:163],v[112:115],v[18:21],v[160:163]
s_add_u32 m0,s24,0
ds_read_b128 a[144:147],v11 offset:0
v_fma_f32 v82,v82,s36,v14
v_mfma_f32_16x16x32_bf16 v[208:211],v[112:115],v[24:27],v[208:211]
ds_read_b128 a[148:151],v12 offset:0
v_fma_f32 v83,v83,s36,v14
v_mfma_f32_16x16x32_bf16 a[0:3],v[112:115],v[30:33],a[0:3]
ds_read_b128 a[152:155],v11 offset:128
v_fma_f32 v88,v88,s36,v15
v_mfma_f32_16x16x32_bf16 a[48:51],v[112:115],v[36:39],a[48:51]
ds_read_b128 a[156:159],v12 offset:128
v_fma_f32 v89,v89,s36,v15
v_mfma_f32_16x16x32_bf16 v[164:167],v[116:119],v[18:21],v[164:167]
ds_read_b128 a[160:163],v11 offset:256
v_fma_f32 v90,v90,s36,v15
v_mfma_f32_16x16x32_bf16 v[212:215],v[116:119],v[24:27],v[212:215]
ds_read_b128 a[164:167],v12 offset:256
ds_read_b64_tr_b16 v[128:129],v2 offset:24704
ds_read_b64_tr_b16 v[130:131],v2 offset:30848
ds_read_b64_tr_b16 v[132:133],v3 offset:24704
ds_read_b64_tr_b16 v[134:135],v3 offset:30848
ds_read_b64_tr_b16 v[136:137],v4 offset:24704
ds_read_b64_tr_b16 v[138:139],v4 offset:30848
ds_read_b64_tr_b16 v[140:141],v5 offset:24704
ds_read_b64_tr_b16 v[142:143],v5 offset:30848
ds_read_b64_tr_b16 v[112:113],v2 offset:24832
ds_read_b64_tr_b16 v[114:115],v2 offset:30976
ds_read_b128 a[168:171],v11 offset:6144
v_mfma_f32_16x16x32_bf16 a[4:7],v[116:119],v[30:33],a[4:7]
v_fma_f32 v91,v91,s36,v15
ds_read_b128 a[172:175],v12 offset:6144
ds_read_b128 a[176:179],v11 offset:6272
v_mfma_f32_16x16x32_bf16 a[52:55],v[116:119],v[36:39],a[52:55]
s_waitcnt lgkmcnt(13)
v_fma_f32 v96,v96,s36,v16
ds_read_b128 a[180:183],v12 offset:6272
ds_read_b128 a[184:187],v11 offset:6400
v_mfma_f32_16x16x32_bf16 v[168:171],v[120:123],v[18:21],v[168:171]
buffer_load_dwordx4 v6,s[12:15],s28 offen offset:0 nt lds
v_mfma_f32_16x16x32_bf16 v[216:219],v[120:123],v[24:27],v[216:219]
ds_read_b64_tr_b16 v[116:117],v3 offset:24832
ds_read_b64_tr_b16 v[118:119],v3 offset:30976
v_mfma_f32_16x16x32_bf16 a[8:11],v[120:123],v[30:33],a[8:11]
ds_read_b128 a[188:191],v12 offset:6400
v_fma_f32 v97,v97,s36,v16
v_mfma_f32_16x16x32_bf16 a[56:59],v[120:123],v[36:39],a[56:59]
ds_read_b64_tr_b16 v[120:121],v4 offset:24832
ds_read_b64_tr_b16 v[122:123],v4 offset:30976
v_mfma_f32_16x16x32_bf16 v[172:175],v[124:127],v[18:21],v[172:175]
v_fma_f32 v98,v98,s36,v16
v_fma_f32 v99,v99,s36,v16
v_mfma_f32_16x16x32_bf16 v[220:223],v[124:127],v[24:27],v[220:223]
buffer_load_dwordx4 v7,s[12:15],s28 offen offset:1024 nt lds
v_mfma_f32_16x16x32_bf16 a[12:15],v[124:127],v[30:33],a[12:15]
v_fma_f32 v76,v76,s36,v13
v_fma_f32 v77,v77,s36,v13
v_mfma_f32_16x16x32_bf16 a[60:63],v[124:127],v[36:39],a[60:63]
s_waitcnt lgkmcnt(5)
ds_read_b64_tr_b16 v[124:125],v5 offset:24832
ds_read_b64_tr_b16 v[126:127],v5 offset:30976
v_mfma_f32_16x16x32_bf16 v[176:179],v[128:131],v[18:21],v[176:179]
v_fma_f32 v78,v78,s36,v13
v_fma_f32 v79,v79,s36,v13
v_mfma_f32_16x16x32_bf16 v[224:227],v[128:131],v[24:27],v[224:227]
v_fma_f32 v84,v84,s36,v14
v_fma_f32 v85,v85,s36,v14
v_mfma_f32_16x16x32_bf16 a[16:19],v[128:131],v[30:33],a[16:19]
v_fma_f32 v86,v86,s36,v14
v_fma_f32 v87,v87,s36,v14
v_mfma_f32_16x16x32_bf16 a[64:67],v[128:131],v[36:39],a[64:67]
v_fma_f32 v92,v92,s36,v15
v_fma_f32 v93,v93,s36,v15
v_mfma_f32_16x16x32_bf16 v[180:183],v[132:135],v[18:21],v[180:183]
v_fma_f32 v94,v94,s36,v15
v_fma_f32 v95,v95,s36,v15
v_mfma_f32_16x16x32_bf16 v[228:231],v[132:135],v[24:27],v[228:231]
buffer_load_dwordx4 v8,s[12:15],s28 offen offset:2048 nt lds
v_mfma_f32_16x16x32_bf16 a[20:23],v[132:135],v[30:33],a[20:23]
s_add_u32 s28,s28,3072
v_fma_f32 v100,v100,s36,v16
v_fma_f32 v101,v101,s36,v16
v_mfma_f32_16x16x32_bf16 a[68:71],v[132:135],v[36:39],a[68:71]
s_add_u32 m0,s24,3072
v_fma_f32 v102,v102,s36,v16
v_fma_f32 v103,v103,s36,v16
v_mfma_f32_16x16x32_bf16 v[184:187],v[136:139],v[18:21],v[184:187]
v_exp_f32 v82,v82
v_mfma_f32_16x16x32_bf16 v[232:235],v[136:139],v[24:27],v[232:235]
v_exp_f32 v83,v83
v_mfma_f32_16x16x32_bf16 a[24:27],v[136:139],v[30:33],a[24:27]
v_exp_f32 v88,v88
v_mfma_f32_16x16x32_bf16 a[72:75],v[136:139],v[36:39],a[72:75]
v_exp_f32 v89,v89
v_mfma_f32_16x16x32_bf16 v[188:191],v[140:143],v[18:21],v[188:191]
v_exp_f32 v90,v90
v_mfma_f32_16x16x32_bf16 v[236:239],v[140:143],v[24:27],v[236:239]
buffer_load_dwordx4 v6,s[12:15],s28 offen offset:0 nt lds
v_mfma_f32_16x16x32_bf16 a[28:31],v[140:143],v[30:33],a[28:31]
v_exp_f32 v91,v91
v_mfma_f32_16x16x32_bf16 a[76:79],v[140:143],v[36:39],a[76:79]
v_exp_f32 v96,v96
v_mfma_f32_16x16x32_bf16 v[192:195],v[112:115],v[18:21],v[192:195]
v_exp_f32 v97,v97
v_mfma_f32_16x16x32_bf16 v[240:243],v[112:115],v[24:27],v[240:243]
v_exp_f32 v98,v98
v_mfma_f32_16x16x32_bf16 a[32:35],v[112:115],v[30:33],a[32:35]
v_exp_f32 v99,v99
v_mfma_f32_16x16x32_bf16 a[80:83],v[112:115],v[36:39],a[80:83]
s_waitcnt lgkmcnt(0)
v_exp_f32 v76,v76
v_mfma_f32_16x16x32_bf16 v[196:199],v[116:119],v[18:21],v[196:199]
buffer_load_dwordx4 v7,s[12:15],s28 offen offset:1024 nt lds
v_mfma_f32_16x16x32_bf16 v[244:247],v[116:119],v[24:27],v[244:247]
v_exp_f32 v77,v77
v_mfma_f32_16x16x32_bf16 a[36:39],v[116:119],v[30:33],a[36:39]
v_exp_f32 v78,v78
v_mfma_f32_16x16x32_bf16 a[84:87],v[116:119],v[36:39],a[84:87]
v_exp_f32 v79,v79
v_mfma_f32_16x16x32_bf16 v[200:203],v[120:123],v[18:21],v[200:203]
v_exp_f32 v84,v84
v_mfma_f32_16x16x32_bf16 v[248:251],v[120:123],v[24:27],v[248:251]
v_exp_f32 v85,v85
v_mfma_f32_16x16x32_bf16 a[40:43],v[120:123],v[30:33],a[40:43]
v_exp_f32 v86,v86
v_mfma_f32_16x16x32_bf16 a[88:91],v[120:123],v[36:39],a[88:91]
v_exp_f32 v87,v87
v_mfma_f32_16x16x32_bf16 v[204:207],v[124:127],v[18:21],v[204:207]
buffer_load_dwordx4 v8,s[12:15],s28 offen offset:2048 nt lds
s_waitcnt vmcnt(20)
s_barrier
v_mfma_f32_16x16x32_bf16 v[252:255],v[124:127],v[24:27],v[252:255]
s_add_u32 s28,s28,3072
ds_read_b64_tr_b16 v[128:129],v2 offset:6144
ds_read_b64_tr_b16 v[130:131],v2 offset:0
v_mfma_f32_16x16x32_bf16 a[44:47],v[124:127],v[30:33],a[44:47]
s_add_u32 m0,s22,0
ds_read_b64_tr_b16 v[132:133],v3 offset:6144
buffer_load_dwordx4 v6,s[4:7],s25 offen offset:0 lds
v_mfma_f32_16x16x32_bf16 a[92:95],v[124:127],v[36:39],a[92:95]
buffer_load_dwordx4 v7,s[4:7],s25 offen offset:1024 lds
buffer_load_dwordx4 v8,s[4:7],s25 offen offset:2048 lds
ds_read_b64_tr_b16 v[134:135],v3 offset:0
ds_read_b64_tr_b16 v[136:137],v4 offset:6144
ds_read_b64_tr_b16 v[138:139],v4 offset:0
ds_read_b64_tr_b16 v[140:141],v5 offset:6144
ds_read_b64_tr_b16 v[142:143],v5 offset:0
v_exp_f32 v92,v92
v_exp_f32 v93,v93
v_exp_f32 v94,v94
v_exp_f32 v95,v95
v_exp_f32 v100,v100
v_exp_f32 v101,v101
v_exp_f32 v102,v102
v_exp_f32 v103,v103
v_cvt_pk_bf16_f32 v29,v82,v83
v_cvt_pk_bf16_f32 v34,v88,v89
v_cvt_pk_bf16_f32 v35,v90,v91
v_cvt_pk_bf16_f32 v40,v96,v97
v_cvt_pk_bf16_f32 v41,v98,v99
v_cvt_pk_bf16_f32 v20,v76,v77
v_cvt_pk_bf16_f32 v21,v78,v79
v_cvt_pk_bf16_f32 v26,v84,v85
v_cvt_pk_bf16_f32 v27,v86,v87
v_mfma_f32_16x16x32_bf16 v[52:55],v[48:51],v[20:23],v[52:55]
v_cvt_pk_bf16_f32 v32,v92,v93
v_cvt_pk_bf16_f32 v33,v94,v95
v_mfma_f32_16x16x32_bf16 v[56:59],v[48:51],v[26:29],v[56:59]
v_cvt_pk_bf16_f32 v38,v100,v101
v_cvt_pk_bf16_f32 v39,v102,v103
v_mfma_f32_16x16x32_bf16 v[60:63],v[48:51],v[32:35],v[60:63]
v_subrev_u32 v10,18432,v10
v_mfma_f32_16x16x32_bf16 v[64:67],v[48:51],v[38:41],v[64:67]
s_waitcnt lgkmcnt(0)
v_mfma_f32_16x16x32_bf16 v[160:163],v[128:131],v[20:23],v[160:163]
s_add_u32 s87,s42,18432
ds_read_b64_tr_b16 v[112:113],v2 offset:6272
ds_read_b64_tr_b16 v[114:115],v2 offset:128
v_mfma_f32_16x16x32_bf16 v[208:211],v[128:131],v[26:29],v[208:211]
ds_read_b64_tr_b16 v[116:117],v3 offset:6272
ds_read_b64_tr_b16 v[118:119],v3 offset:128
v_mfma_f32_16x16x32_bf16 a[0:3],v[128:131],v[32:35],a[0:3]
ds_read_b64_tr_b16 v[120:121],v4 offset:6272
ds_read_b64_tr_b16 v[122:123],v4 offset:128
v_mfma_f32_16x16x32_bf16 a[48:51],v[128:131],v[38:41],a[48:51]
ds_read_b64_tr_b16 v[124:125],v5 offset:6272
ds_read_b64_tr_b16 v[126:127],v5 offset:128
v_mfma_f32_16x16x32_bf16 v[164:167],v[132:135],v[20:23],v[164:167]
ds_read_b64_tr_b16 v[128:129],v2 offset:6400
ds_read_b64_tr_b16 v[130:131],v2 offset:256
v_mfma_f32_16x16x32_bf16 v[212:215],v[132:135],v[26:29],v[212:215]
v_mbcnt_lo_u32_b32 v57,-1,0
v_mbcnt_hi_u32_b32 v57,-1,v57
v_mfma_f32_16x16x32_bf16 a[4:7],v[132:135],v[32:35],a[4:7]
v_and_b32 v61,7,v57
v_lshrrev_b32 v53,5,v57
v_mfma_f32_16x16x32_bf16 a[52:55],v[132:135],v[38:41],a[52:55]
ds_read_b64_tr_b16 v[132:133],v3 offset:6400
ds_read_b64_tr_b16 v[134:135],v3 offset:256
v_mfma_f32_16x16x32_bf16 v[168:171],v[136:139],v[20:23],v[168:171]
v_xor_b32 v61,v61,v53
v_and_b32 v53,15,v57
v_mfma_f32_16x16x32_bf16 v[216:219],v[136:139],v[26:29],v[216:219]
v_lshl_add_u32 v53,v53,7,s24
v_lshl_add_u32 v53,v61,4,v53
v_mfma_f32_16x16x32_bf16 a[8:11],v[136:139],v[32:35],a[8:11]
v_bfe_u32 v61,v57,4,1
v_lshl_add_u32 v36,v61,3,v53
v_mfma_f32_16x16x32_bf16 a[56:59],v[136:139],v[38:41],a[56:59]
ds_read_b64_tr_b16 v[136:137],v4 offset:6400
ds_read_b64_tr_b16 v[138:139],v4 offset:256
v_mfma_f32_16x16x32_bf16 v[172:175],v[140:143],v[20:23],v[172:175]
v_xor_b32 v37,32,v36
v_xor_b32 v42,64,v36
v_mfma_f32_16x16x32_bf16 v[220:223],v[140:143],v[26:29],v[220:223]
v_xor_b32 v43,96,v36
v_bfe_u32 v53,v57,3,1
v_mfma_f32_16x16x32_bf16 a[12:15],v[140:143],v[32:35],a[12:15]
v_lshlrev_b32 v53,11,v53
v_rcp_f32 v66,v64
v_mfma_f32_16x16x32_bf16 a[60:63],v[140:143],v[38:41],a[60:63]
s_waitcnt lgkmcnt(3)
ds_read_b64_tr_b16 v[140:141],v5 offset:6400
ds_read_b64_tr_b16 v[142:143],v5 offset:256
v_mfma_f32_16x16x32_bf16 v[176:179],v[112:115],v[20:23],v[176:179]
v_accvgpr_read_b32 v72,a48
v_accvgpr_read_b32 v73,a49
v_mfma_f32_16x16x32_bf16 v[224:227],v[112:115],v[26:29],v[224:227]
v_accvgpr_read_b32 v74,a50
v_accvgpr_read_b32 v75,a51
v_mfma_f32_16x16x32_bf16 a[16:19],v[112:115],v[32:35],a[16:19]
v_accvgpr_read_b32 v80,a52
v_accvgpr_read_b32 v81,a53
v_mfma_f32_16x16x32_bf16 a[64:67],v[112:115],v[38:41],a[64:67]
v_accvgpr_read_b32 v82,a54
v_accvgpr_read_b32 v83,a55
v_mfma_f32_16x16x32_bf16 v[180:183],v[116:119],v[20:23],v[180:183]
v_accvgpr_read_b32 v88,a56
v_accvgpr_read_b32 v89,a57
v_mfma_f32_16x16x32_bf16 v[228:231],v[116:119],v[26:29],v[228:231]
v_accvgpr_read_b32 v90,a58
v_accvgpr_read_b32 v91,a59
v_mfma_f32_16x16x32_bf16 a[20:23],v[116:119],v[32:35],a[20:23]
v_accvgpr_read_b32 v76,a64
v_accvgpr_read_b32 v77,a65
v_accvgpr_read_b32 v78,a66
v_accvgpr_read_b32 v79,a67
v_accvgpr_read_b32 v96,a60
v_pk_mul_f32 v[72:73],v[72:73],v[66:67] op_sel_hi:[1,0]
v_pk_mul_f32 v[74:75],v[74:75],v[66:67] op_sel_hi:[1,0]
v_pk_mul_f32 v[76:77],v[76:77],v[66:67] op_sel_hi:[1,0]
v_pk_mul_f32 v[78:79],v[78:79],v[66:67] op_sel_hi:[1,0]
v_accvgpr_read_b32 v97,a61
v_accvgpr_read_b32 v98,a62
v_mfma_f32_16x16x32_bf16 a[68:71],v[116:119],v[38:41],a[68:71]
v_accvgpr_read_b32 v99,a63
v_cvt_pk_bf16_f32 v72,v72,v73
v_mfma_f32_16x16x32_bf16 v[184:187],v[120:123],v[20:23],v[184:187]
v_cvt_pk_bf16_f32 v76,v76,v77
v_cvt_pk_bf16_f32 v73,v74,v75
v_mfma_f32_16x16x32_bf16 v[232:235],v[120:123],v[26:29],v[232:235]
v_cvt_pk_bf16_f32 v77,v78,v79
v_max3_f32 v152,v52,v56,v60
v_mfma_f32_16x16x32_bf16 a[24:27],v[120:123],v[32:35],a[24:27]
ds_write2st64_b64 v36,v[72:73],v[76:77] offset0:36 offset1:40
v_pk_mul_f32 v[80:81],v[80:81],v[66:67] op_sel_hi:[1,0]
v_pk_mul_f32 v[82:83],v[82:83],v[66:67] op_sel_hi:[1,0]
v_accvgpr_read_b32 v84,a68
v_accvgpr_read_b32 v85,a69
v_pk_mul_f32 v[84:85],v[84:85],v[66:67] op_sel_hi:[1,0]
v_accvgpr_read_b32 v86,a70
v_accvgpr_read_b32 v87,a71
v_pk_mul_f32 v[86:87],v[86:87],v[66:67] op_sel_hi:[1,0]
v_cvt_pk_bf16_f32 v80,v80,v81
v_cvt_pk_bf16_f32 v84,v84,v85
v_mfma_f32_16x16x32_bf16 a[72:75],v[120:123],v[38:41],a[72:75]
v_cvt_pk_bf16_f32 v81,v82,v83
v_cvt_pk_bf16_f32 v85,v86,v87
v_mfma_f32_16x16x32_bf16 v[188:191],v[124:127],v[20:23],v[188:191]
ds_write2st64_b64 v37,v[80:81],v[84:85] offset0:36 offset1:40
v_mfma_f32_16x16x32_bf16 v[236:239],v[124:127],v[26:29],v[236:239]
v_max_f32 v152,v152,v64
v_cmp_ngt_f32 vcc,s37,v152
v_mfma_f32_16x16x32_bf16 a[28:31],v[124:127],v[32:35],a[28:31]
v_accvgpr_read_b32 v92,a72
v_accvgpr_read_b32 v93,a73
v_accvgpr_read_b32 v94,a74
v_accvgpr_read_b32 v95,a75
v_rcp_f32 v58,v56
v_pk_mul_f32 v[88:89],v[88:89],v[66:67] op_sel_hi:[1,0]
v_pk_mul_f32 v[90:91],v[90:91],v[66:67] op_sel_hi:[1,0]
v_pk_mul_f32 v[92:93],v[92:93],v[66:67] op_sel_hi:[1,0]
v_pk_mul_f32 v[94:95],v[94:95],v[66:67] op_sel_hi:[1,0]
v_cvt_pk_bf16_f32 v88,v88,v89
v_cvt_pk_bf16_f32 v92,v92,v93
v_mfma_f32_16x16x32_bf16 a[76:79],v[124:127],v[38:41],a[76:79]
s_cmp_lg_u64 vcc,0
v_cvt_pk_bf16_f32 v89,v90,v91
v_cvt_pk_bf16_f32 v93,v94,v95
v_mfma_f32_16x16x32_bf16 v[192:195],v[128:131],v[20:23],v[192:195]
s_cselect_b32 s62,s32,0
ds_write2st64_b64 v42,v[88:89],v[92:93] offset0:36 offset1:40
v_mfma_f32_16x16x32_bf16 v[240:243],v[128:131],v[26:29],v[240:243]
s_or_b32 s31,s31,s62
v_accvgpr_read_b32 v100,a76
v_accvgpr_read_b32 v101,a77
v_mfma_f32_16x16x32_bf16 a[32:35],v[128:131],v[32:35],a[32:35]
s_lshl_b32 s32,s32,1
v_accvgpr_read_b32 v102,a78
v_accvgpr_read_b32 v103,a79
v_rcp_f32 v62,v60
v_rcp_f32 v54,v52
v_pk_mul_f32 v[96:97],v[96:97],v[66:67] op_sel_hi:[1,0]
v_pk_mul_f32 v[98:99],v[98:99],v[66:67] op_sel_hi:[1,0]
v_pk_mul_f32 v[100:101],v[100:101],v[66:67] op_sel_hi:[1,0]
v_pk_mul_f32 v[102:103],v[102:103],v[66:67] op_sel_hi:[1,0]
v_cvt_pk_bf16_f32 v96,v96,v97
v_cvt_pk_bf16_f32 v100,v100,v101
v_mfma_f32_16x16x32_bf16 a[80:83],v[128:131],v[38:41],a[80:83]
s_add_u32 m0,s23,0
v_cvt_pk_bf16_f32 v97,v98,v99
v_cvt_pk_bf16_f32 v101,v102,v103
s_waitcnt lgkmcnt(1)
v_mfma_f32_16x16x32_bf16 v[196:199],v[132:135],v[20:23],v[196:199]
ds_write2st64_b64 v43,v[96:97],v[100:101] offset0:36 offset1:40
v_mfma_f32_16x16x32_bf16 v[244:247],v[132:135],v[26:29],v[244:247]
v_mfma_f32_16x16x32_bf16 a[36:39],v[132:135],v[32:35],a[36:39]
ds_read_b128 v[152:155],v10 offset:18432
ds_read_b128 v[156:159],v10 offset:19456
v_accvgpr_read_b32 v72,a80
ds_read_b128 v[104:107],v10 offset:20480
v_accvgpr_read_b32 v73,a81
ds_read_b128 v[108:111],v10 offset:21504
v_pk_mul_f32 v[72:73],v[72:73],v[66:67] op_sel_hi:[1,0]
v_accvgpr_read_b32 v74,a82
v_accvgpr_read_b32 v75,a83
v_pk_mul_f32 v[74:75],v[74:75],v[66:67] op_sel_hi:[1,0]
v_cvt_pk_bf16_f32 v72,v72,v73
v_cvt_pk_bf16_f32 v73,v74,v75
v_mfma_f32_16x16x32_bf16 a[84:87],v[132:135],v[38:41],a[84:87]
ds_write_b64 v36,v[72:73] offset:18432
v_mfma_f32_16x16x32_bf16 v[200:203],v[136:139],v[20:23],v[200:203]
s_waitcnt vmcnt(15)
ds_read_b128 a[192:195],v11 offset:12288
v_add_u32 v36,v36,v53
v_mfma_f32_16x16x32_bf16 v[248:251],v[136:139],v[26:29],v[248:251]
ds_read_b128 a[196:199],v12 offset:12288
v_mfma_f32_16x16x32_bf16 a[40:43],v[136:139],v[32:35],a[40:43]
s_waitcnt lgkmcnt(6)
ds_read_b128 a[200:203],v11 offset:12416
ds_read_b128 a[204:207],v12 offset:12416
buffer_store_dwordx4 v[152:155],v9,s[16:19],s87 offen offset:0 nt
ds_read_b128 a[208:211],v11 offset:12544
v_accvgpr_read_b32 v76,a84
ds_read_b128 a[212:215],v12 offset:12544
v_accvgpr_read_b32 v77,a85
v_pk_mul_f32 v[76:77],v[76:77],v[66:67] op_sel_hi:[1,0]
v_accvgpr_read_b32 v78,a86
v_accvgpr_read_b32 v79,a87
v_pk_mul_f32 v[78:79],v[78:79],v[66:67] op_sel_hi:[1,0]
v_cvt_pk_bf16_f32 v76,v76,v77
v_cvt_pk_bf16_f32 v77,v78,v79
v_mfma_f32_16x16x32_bf16 a[88:91],v[136:139],v[38:41],a[88:91]
ds_write_b64 v37,v[76:77] offset:18432
v_mfma_f32_16x16x32_bf16 v[204:207],v[140:143],v[20:23],v[204:207]
s_waitcnt lgkmcnt(7)
buffer_store_dwordx4 v[156:159],v9,s[16:19],s87 offen offset:3072 nt
v_add_u32 v37,v37,v53
v_accvgpr_read_b32 v78,a2
v_accvgpr_read_b32 v79,a3
v_mfma_f32_16x16x32_bf16 v[252:255],v[140:143],v[26:29],v[252:255]
v_accvgpr_read_b32 v76,a0
v_accvgpr_read_b32 v84,a88
v_mfma_f32_16x16x32_bf16 a[44:47],v[140:143],v[32:35],a[44:47]
v_accvgpr_read_b32 v85,a89
v_accvgpr_read_b32 v86,a90
buffer_store_dwordx4 v[104:107],v9,s[16:19],s87 offen offset:128 nt
v_pk_mul_f32 v[84:85],v[84:85],v[66:67] op_sel_hi:[1,0]
v_accvgpr_read_b32 v87,a91
v_pk_mul_f32 v[86:87],v[86:87],v[66:67] op_sel_hi:[1,0]
v_accvgpr_read_b32 v77,a1
v_accvgpr_read_b32 v104,a4
v_mfma_f32_16x16x32_bf16 a[92:95],v[140:143],v[38:41],a[92:95]
v_accvgpr_read_b32 v105,a5
v_accvgpr_read_b32 v106,a6
v_accvgpr_read_b32 v107,a7
v_cvt_pk_bf16_f32 v84,v84,v85
buffer_store_dwordx4 v[108:111],v9,s[16:19],s87 offen offset:3200 nt
v_cvt_pk_bf16_f32 v85,v86,v87
v_accvgpr_read_b32 v86,a14
v_accvgpr_read_b32 v108,a8
v_accvgpr_read_b32 v92,a92
v_accvgpr_read_b32 v93,a93
v_accvgpr_read_b32 v94,a94
v_accvgpr_read_b32 v95,a95
v_accvgpr_read_b32 v109,a9
v_accvgpr_read_b32 v110,a10
ds_write_b64 v42,v[84:85] offset:18432
v_add_u32 v42,v42,v53
v_accvgpr_read_b32 v111,a11
v_accvgpr_read_b32 v87,a15
v_accvgpr_read_b32 v84,a12
v_accvgpr_read_b32 v85,a13
s_waitcnt vmcnt(4)
s_barrier
ds_read_b128 v[112:115],v0 offset:0
ds_read_b128 v[116:119],v1 offset:0
ds_read_b128 v[120:123],v0 offset:128
ds_read_b128 v[124:127],v1 offset:128
ds_read_b128 v[128:131],v0 offset:256
ds_read_b128 v[132:135],v1 offset:256
buffer_load_dwordx4 v6,s[8:11],s25 offen offset:0 lds
ds_read_b128 v[136:139],v0 offset:6144
ds_read_b128 v[140:143],v1 offset:6144
s_waitcnt lgkmcnt(7)
v_mfma_f32_16x16x32_bf16 v[72:75],v[112:115],a[144:147],0
v_mfma_f32_16x16x32_bf16 v[80:83],v[112:115],a[168:171],0
v_mfma_f32_16x16x32_bf16 v[88:91],v[112:115],a[192:195],0
ds_read_b128 v[112:115],v0 offset:6272
v_pk_mul_f32 v[92:93],v[92:93],v[66:67] op_sel_hi:[1,0]
v_pk_mul_f32 v[94:95],v[94:95],v[66:67] op_sel_hi:[1,0]
buffer_load_dwordx4 v7,s[8:11],s25 offen offset:1024 lds
v_pk_mul_f32 v[208:209],v[208:209],v[58:59] op_sel_hi:[1,0]
v_pk_mul_f32 v[210:211],v[210:211],v[58:59] op_sel_hi:[1,0]
v_pk_mul_f32 v[224:225],v[224:225],v[58:59] op_sel_hi:[1,0]
v_pk_mul_f32 v[226:227],v[226:227],v[58:59] op_sel_hi:[1,0]
v_pk_mul_f32 v[212:213],v[212:213],v[58:59] op_sel_hi:[1,0]
v_pk_mul_f32 v[214:215],v[214:215],v[58:59] op_sel_hi:[1,0]
v_pk_mul_f32 v[228:229],v[228:229],v[58:59] op_sel_hi:[1,0]
v_pk_mul_f32 v[230:231],v[230:231],v[58:59] op_sel_hi:[1,0]
v_pk_mul_f32 v[216:217],v[216:217],v[58:59] op_sel_hi:[1,0]
v_pk_mul_f32 v[218:219],v[218:219],v[58:59] op_sel_hi:[1,0]
v_pk_mul_f32 v[232:233],v[232:233],v[58:59] op_sel_hi:[1,0]
v_pk_mul_f32 v[234:235],v[234:235],v[58:59] op_sel_hi:[1,0]
v_pk_mul_f32 v[220:221],v[220:221],v[58:59] op_sel_hi:[1,0]
v_pk_mul_f32 v[222:223],v[222:223],v[58:59] op_sel_hi:[1,0]
v_pk_mul_f32 v[236:237],v[236:237],v[58:59] op_sel_hi:[1,0]
v_pk_mul_f32 v[238:239],v[238:239],v[58:59] op_sel_hi:[1,0]
v_pk_mul_f32 v[240:241],v[240:241],v[58:59] op_sel_hi:[1,0]
v_pk_mul_f32 v[242:243],v[242:243],v[58:59] op_sel_hi:[1,0]
v_pk_mul_f32 v[76:77],v[76:77],v[62:63] op_sel_hi:[1,0]
v_pk_mul_f32 v[78:79],v[78:79],v[62:63] op_sel_hi:[1,0]
v_pk_mul_f32 v[244:245],v[244:245],v[58:59] op_sel_hi:[1,0]
v_pk_mul_f32 v[246:247],v[246:247],v[58:59] op_sel_hi:[1,0]
v_pk_mul_f32 v[104:105],v[104:105],v[62:63] op_sel_hi:[1,0]
v_pk_mul_f32 v[106:107],v[106:107],v[62:63] op_sel_hi:[1,0]
v_cvt_pk_bf16_f32 v92,v92,v93
v_cvt_pk_bf16_f32 v93,v94,v95
s_waitcnt lgkmcnt(0)
v_mfma_f32_16x16x32_bf16 v[72:75],v[116:119],a[148:151],v[72:75]
ds_write_b64 v43,v[92:93] offset:18432
v_mfma_f32_16x16x32_bf16 v[80:83],v[116:119],a[172:175],v[80:83]
buffer_load_dwordx4 v8,s[8:11],s25 offen offset:2048 lds
v_mfma_f32_16x16x32_bf16 v[88:91],v[116:119],a[196:199],v[88:91]
s_add_u32 m0,s23,24576
ds_read_b128 v[96:99],v10 offset:18432
ds_read_b128 v[100:103],v10 offset:19456
v_add_u32 v43,v43,v53
ds_read_b128 v[116:119],v1 offset:6272
v_pk_mul_f32 v[248:249],v[248:249],v[58:59] op_sel_hi:[1,0]
v_pk_mul_f32 v[250:251],v[250:251],v[58:59] op_sel_hi:[1,0]
v_pk_mul_f32 v[108:109],v[108:109],v[62:63] op_sel_hi:[1,0]
v_pk_mul_f32 v[110:111],v[110:111],v[62:63] op_sel_hi:[1,0]
v_cvt_pk_bf16_f32 v208,v208,v209
v_cvt_pk_bf16_f32 v224,v224,v225
v_mfma_f32_16x16x32_bf16 v[72:75],v[120:123],a[152:155],v[72:75]
v_cvt_pk_bf16_f32 v209,v210,v211
v_cvt_pk_bf16_f32 v225,v226,v227
v_mfma_f32_16x16x32_bf16 v[80:83],v[120:123],a[176:179],v[80:83]
ds_write2st64_b64 v36,v[208:209],v[224:225] offset0:12 offset1:14
v_mfma_f32_16x16x32_bf16 v[88:91],v[120:123],a[200:203],v[88:91]
s_waitcnt vmcnt(10)
v_accvgpr_read_b32 v94,a18
buffer_load_dwordx4 v6,s[8:11],s21 offen offset:0 lds
ds_read_b128 a[216:219],v11 offset:0
ds_read_b128 a[220:223],v12 offset:0
s_waitcnt lgkmcnt(5)
buffer_store_dwordx4 v[96:99],v9,s[16:19],s87 offen offset:256 nt
ds_read_b128 a[224:227],v11 offset:128
v_pk_mul_f32 v[252:253],v[252:253],v[58:59] op_sel_hi:[1,0]
ds_read_b128 a[228:231],v12 offset:128
v_pk_mul_f32 v[254:255],v[254:255],v[58:59] op_sel_hi:[1,0]
ds_read_b128 a[232:235],v11 offset:256
v_pk_mul_f32 v[84:85],v[84:85],v[62:63] op_sel_hi:[1,0]
ds_read_b128 a[236:239],v12 offset:256
s_waitcnt lgkmcnt(7)
buffer_store_dwordx4 v[100:103],v9,s[16:19],s87 offen offset:3328 nt
ds_read_b128 v[120:123],v0 offset:6400
v_pk_mul_f32 v[86:87],v[86:87],v[62:63] op_sel_hi:[1,0]
v_accvgpr_read_b32 v95,a19
v_accvgpr_read_b32 v92,a16
v_mfma_f32_16x16x32_bf16 v[72:75],v[124:127],a[156:159],v[72:75]
v_accvgpr_read_b32 v93,a17
v_accvgpr_read_b32 v210,a34
v_mfma_f32_16x16x32_bf16 v[80:83],v[124:127],a[180:183],v[80:83]
v_accvgpr_read_b32 v211,a35
v_accvgpr_read_b32 v208,a32
v_mfma_f32_16x16x32_bf16 v[88:91],v[124:127],a[204:207],v[88:91]
ds_read_b128 v[124:127],v1 offset:6400
v_accvgpr_read_b32 v209,a33
v_accvgpr_read_b32 v226,a22
v_accvgpr_read_b32 v227,a23
v_accvgpr_read_b32 v224,a20
buffer_load_dwordx4 v7,s[8:11],s21 offen offset:1024 lds
v_pk_mul_f32 v[92:93],v[92:93],v[62:63] op_sel_hi:[1,0]
v_pk_mul_f32 v[94:95],v[94:95],v[62:63] op_sel_hi:[1,0]
v_pk_mul_f32 v[210:211],v[210:211],v[62:63] op_sel_hi:[1,0]
v_pk_mul_f32 v[208:209],v[208:209],v[62:63] op_sel_hi:[1,0]
v_accvgpr_read_b32 v225,a21
v_accvgpr_read_b32 v96,a36
v_mfma_f32_16x16x32_bf16 v[72:75],v[128:131],a[160:163],v[72:75]
v_accvgpr_read_b32 v97,a37
v_accvgpr_read_b32 v98,a38
v_mfma_f32_16x16x32_bf16 v[80:83],v[128:131],a[184:187],v[80:83]
v_accvgpr_read_b32 v99,a39
v_cvt_pk_bf16_f32 v212,v212,v213
v_mfma_f32_16x16x32_bf16 v[88:91],v[128:131],a[208:211],v[88:91]
ds_read_b128 v[128:131],v0 offset:0
v_cvt_pk_bf16_f32 v228,v228,v229
v_cvt_pk_bf16_f32 v216,v216,v217
v_cvt_pk_bf16_f32 v232,v232,v233
v_cvt_pk_bf16_f32 v213,v214,v215
v_pk_mul_f32 v[224:225],v[224:225],v[62:63] op_sel_hi:[1,0]
v_pk_mul_f32 v[226:227],v[226:227],v[62:63] op_sel_hi:[1,0]
v_pk_mul_f32 v[96:97],v[96:97],v[62:63] op_sel_hi:[1,0]
v_pk_mul_f32 v[98:99],v[98:99],v[62:63] op_sel_hi:[1,0]
v_cvt_pk_bf16_f32 v229,v230,v231
v_cvt_pk_bf16_f32 v220,v220,v221
v_mfma_f32_16x16x32_bf16 v[72:75],v[132:135],a[164:167],v[72:75]
ds_write2st64_b64 v37,v[212:213],v[228:229] offset0:12 offset1:14
v_mfma_f32_16x16x32_bf16 v[80:83],v[132:135],a[188:191],v[80:83]
v_cvt_pk_bf16_f32 v236,v236,v237
v_cvt_pk_bf16_f32 v217,v218,v219
v_mfma_f32_16x16x32_bf16 v[88:91],v[132:135],a[212:215],v[88:91]
ds_read_b128 v[132:135],v1 offset:0
v_cvt_pk_bf16_f32 v233,v234,v235
v_cvt_pk_bf16_f32 v240,v240,v241
v_cvt_pk_bf16_f32 v76,v76,v77
v_cvt_pk_bf16_f32 v221,v222,v223
buffer_load_dwordx4 v8,s[8:11],s21 offen offset:2048 lds
ds_write2st64_b64 v42,v[216:217],v[232:233] offset0:12 offset1:14
v_cvt_pk_bf16_f32 v237,v238,v239
v_cvt_pk_bf16_f32 v241,v242,v243
v_cvt_pk_bf16_f32 v77,v78,v79
v_cvt_pk_bf16_f32 v244,v244,v245
v_cvt_pk_bf16_f32 v104,v104,v105
v_cvt_pk_bf16_f32 v248,v248,v249
v_cvt_pk_bf16_f32 v108,v108,v109
v_cvt_pk_bf16_f32 v245,v246,v247
v_cvt_pk_bf16_f32 v105,v106,v107
v_cvt_pk_bf16_f32 v252,v252,v253
v_cvt_pk_bf16_f32 v84,v84,v85
ds_write2st64_b64 v43,v[220:221],v[236:237] offset0:12 offset1:14
v_cvt_pk_bf16_f32 v249,v250,v251
v_cvt_pk_bf16_f32 v109,v110,v111
v_accvgpr_read_b32 v100,a24
v_accvgpr_read_b32 v101,a25
v_accvgpr_read_b32 v102,a26
v_accvgpr_read_b32 v103,a27
v_accvgpr_read_b32 v214,a42
v_accvgpr_read_b32 v215,a43
v_accvgpr_read_b32 v212,a40
v_accvgpr_read_b32 v213,a41
v_cvt_pk_bf16_f32 v253,v254,v255
ds_write2st64_b64 v36,v[240:241],v[76:77] offset0:16 offset1:24
v_mfma_f32_16x16x32_bf16 v[76:79],v[136:139],a[144:147],0
s_add_u32 s21,s21,12288
v_cvt_pk_bf16_f32 v85,v86,v87
v_cvt_pk_bf16_f32 v92,v92,v93
v_cvt_pk_bf16_f32 v208,v208,v209
v_cvt_pk_bf16_f32 v93,v94,v95
v_cvt_pk_bf16_f32 v209,v210,v211
v_pk_mul_f32 v[100:101],v[100:101],v[62:63] op_sel_hi:[1,0]
v_pk_mul_f32 v[102:103],v[102:103],v[62:63] op_sel_hi:[1,0]
v_pk_mul_f32 v[212:213],v[212:213],v[62:63] op_sel_hi:[1,0]
v_pk_mul_f32 v[214:215],v[214:215],v[62:63] op_sel_hi:[1,0]
ds_write2st64_b64 v37,v[244:245],v[104:105] offset0:16 offset1:24
v_accvgpr_read_b32 v230,a30
v_accvgpr_read_b32 v231,a31
v_accvgpr_read_b32 v228,a28
v_accvgpr_read_b32 v229,a29
v_accvgpr_read_b32 v218,a46
v_accvgpr_read_b32 v219,a47
v_accvgpr_read_b32 v216,a44
v_accvgpr_read_b32 v217,a45
v_cvt_pk_bf16_f32 v224,v224,v225
v_cvt_pk_bf16_f32 v96,v96,v97
v_cvt_pk_bf16_f32 v225,v226,v227
ds_write2st64_b64 v42,v[248:249],v[108:109] offset0:16 offset1:24
v_cvt_pk_bf16_f32 v97,v98,v99
v_cvt_pk_bf16_f32 v100,v100,v101
v_cvt_pk_bf16_f32 v212,v212,v213
v_cvt_pk_bf16_f32 v101,v102,v103
v_cvt_pk_bf16_f32 v213,v214,v215
v_max3_f32 v20,v72,v73,v74
v_max3_f32 v26,v80,v81,v82
v_max3_f32 v32,v88,v89,v90
s_mov_b32 s27,s42
s_mov_b32 s42,s41
s_add_u32 s69,s69,1
ds_write2st64_b64 v43,v[252:253],v[84:85] offset0:16 offset1:24
v_mfma_f32_16x16x32_bf16 v[84:87],v[136:139],a[168:171],0
s_lshl_b32 s62,s69,5
s_add_u32 s62,s62,s34
s_mul_i32 s63,s62,171
s_lshr_b32 s63,s63,9
s_mul_i32 s64,s63,3
s_sub_u32 s62,s62,s64
s_add_u32 s63,s63,s33
s_mul_i32 s30,s63,196608
s_mul_i32 s41,s63,325632
s_lshl_b32 s63,s3,2
ds_write2st64_b64 v36,v[92:93],v[208:209] offset0:26 offset1:28
v_mfma_f32_16x16x32_bf16 v[92:95],v[136:139],a[192:195],0
s_add_u32 s64,s63,21
s_cmp_eq_u32 s3,0
s_cselect_b32 s64,20,s64
v_mfma_f32_16x16x32_bf16 v[76:79],v[140:143],a[148:151],v[76:79]
s_cselect_b32 s40,1,0
ds_read_b128 v[136:139],v0 offset:128
s_add_u32 s65,s63,37
s_cmp_eq_u32 s62,2
s_cselect_b32 s64,s65,s64
s_cselect_b32 s40,0,s40
ds_write2st64_b64 v37,v[224:225],v[96:97] offset0:26 offset1:28
v_pk_mul_f32 v[228:229],v[228:229],v[62:63] op_sel_hi:[1,0]
v_pk_mul_f32 v[230:231],v[230:231],v[62:63] op_sel_hi:[1,0]
v_pk_mul_f32 v[216:217],v[216:217],v[62:63] op_sel_hi:[1,0]
v_pk_mul_f32 v[218:219],v[218:219],v[62:63] op_sel_hi:[1,0]
v_cvt_pk_bf16_f32 v228,v228,v229
v_cvt_pk_bf16_f32 v216,v216,v217
v_mfma_f32_16x16x32_bf16 v[84:87],v[140:143],a[172:175],v[84:87]
s_add_u32 s65,s63,s3
v_cvt_pk_bf16_f32 v229,v230,v231
v_cvt_pk_bf16_f32 v217,v218,v219
v_mfma_f32_16x16x32_bf16 v[92:95],v[140:143],a[196:199],v[92:95]
s_cmp_eq_u32 s62,0
ds_read_b128 v[140:143],v1 offset:128
s_cselect_b32 s64,s65,s64
v_mfma_f32_16x16x32_bf16 v[76:79],v[112:115],a[152:155],v[76:79]
s_cselect_b32 s40,1,s40
ds_write2st64_b64 v42,v[100:101],v[212:213] offset0:26 offset1:28
v_pk_mul_f32 v[160:161],v[160:161],v[54:55] op_sel_hi:[1,0]
v_pk_mul_f32 v[162:163],v[162:163],v[54:55] op_sel_hi:[1,0]
v_pk_mul_f32 v[176:177],v[176:177],v[54:55] op_sel_hi:[1,0]
v_pk_mul_f32 v[178:179],v[178:179],v[54:55] op_sel_hi:[1,0]
v_cvt_pk_bf16_f32 v160,v160,v161
v_cvt_pk_bf16_f32 v176,v176,v177
v_mfma_f32_16x16x32_bf16 v[84:87],v[112:115],a[176:179],v[84:87]
s_mul_i32 s64,s64,6144
v_cvt_pk_bf16_f32 v161,v162,v163
v_cvt_pk_bf16_f32 v177,v178,v179
v_mfma_f32_16x16x32_bf16 v[92:95],v[112:115],a[200:203],v[92:95]
s_add_u32 s41,s41,s64
ds_read_b128 v[112:115],v0 offset:256
s_cmp_ge_u32 s69,6
v_mfma_f32_16x16x32_bf16 v[76:79],v[116:119],a[156:159],v[76:79]
s_cselect_b32 s41,166723584,s41
ds_write2st64_b64 v43,v[228:229],v[216:217] offset0:26 offset1:28
v_pk_mul_f32 v[164:165],v[164:165],v[54:55] op_sel_hi:[1,0]
v_pk_mul_f32 v[166:167],v[166:167],v[54:55] op_sel_hi:[1,0]
v_pk_mul_f32 v[180:181],v[180:181],v[54:55] op_sel_hi:[1,0]
v_pk_mul_f32 v[182:183],v[182:183],v[54:55] op_sel_hi:[1,0]
v_cvt_pk_bf16_f32 v164,v164,v165
v_cvt_pk_bf16_f32 v180,v180,v181
v_mfma_f32_16x16x32_bf16 v[84:87],v[116:119],a[180:183],v[84:87]
s_cselect_b32 s30,100663296,s30
v_cvt_pk_bf16_f32 v165,v166,v167
v_cvt_pk_bf16_f32 v181,v182,v183
v_mfma_f32_16x16x32_bf16 v[92:95],v[116:119],a[204:207],v[92:95]
s_add_u32 s25,s30,s22
ds_read_b128 v[116:119],v1 offset:256
s_add_u32 s26,s25,12288
s_waitcnt lgkmcnt(3)
v_mfma_f32_16x16x32_bf16 v[76:79],v[120:123],a[160:163],v[76:79]
s_add_u32 m0,s22,0
ds_write2st64_b64 v36,v[160:161],v[176:177] offset0:0 offset1:2
v_mfma_f32_16x16x32_bf16 v[84:87],v[120:123],a[184:187],v[84:87]
s_mov_b32 s28,s41
s_mov_b32 s29,s24
v_pk_mul_f32 v[168:169],v[168:169],v[54:55] op_sel_hi:[1,0]
v_pk_mul_f32 v[170:171],v[170:171],v[54:55] op_sel_hi:[1,0]
v_pk_mul_f32 v[184:185],v[184:185],v[54:55] op_sel_hi:[1,0]
v_pk_mul_f32 v[186:187],v[186:187],v[54:55] op_sel_hi:[1,0]
v_cvt_pk_bf16_f32 v168,v168,v169
v_cvt_pk_bf16_f32 v184,v184,v185
v_mfma_f32_16x16x32_bf16 v[92:95],v[120:123],a[208:211],v[92:95]
ds_write2st64_b64 v37,v[164:165],v[180:181] offset0:0 offset1:2
v_mfma_f32_16x16x32_bf16 v[76:79],v[124:127],a[164:167],v[76:79]
v_cvt_pk_bf16_f32 v169,v170,v171
v_cvt_pk_bf16_f32 v185,v186,v187
v_mfma_f32_16x16x32_bf16 v[84:87],v[124:127],a[188:191],v[84:87]
ds_read_b128 v[120:123],v0 offset:6144
v_pk_mul_f32 v[172:173],v[172:173],v[54:55] op_sel_hi:[1,0]
ds_write2st64_b64 v42,v[168:169],v[184:185] offset0:0 offset1:2
v_pk_mul_f32 v[174:175],v[174:175],v[54:55] op_sel_hi:[1,0]
v_pk_mul_f32 v[188:189],v[188:189],v[54:55] op_sel_hi:[1,0]
v_pk_mul_f32 v[190:191],v[190:191],v[54:55] op_sel_hi:[1,0]
v_max3_f32 v20,v20,v75,v76
v_max3_f32 v20,v20,v77,v78
v_mfma_f32_16x16x32_bf16 v[92:95],v[124:127],a[212:215],v[92:95]
ds_read_b128 v[124:127],v1 offset:6144
v_max_f32 v20,v20,v79
v_mfma_f32_16x16x32_bf16 v[96:99],v[128:131],a[216:219],0
ds_read_b128 v[128:131],v0 offset:6272
v_mov_b32 v21,v20
v_mfma_f32_16x16x32_bf16 v[96:99],v[132:135],a[220:223],v[96:99]
ds_read_b128 v[132:135],v1 offset:6272
v_max3_f32 v26,v26,v83,v84
v_permlane32_swap_b32 v21,v20
v_max3_f32 v26,v26,v85,v86
v_pk_mul_f32 v[192:193],v[192:193],v[54:55] op_sel_hi:[1,0]
v_pk_mul_f32 v[194:195],v[194:195],v[54:55] op_sel_hi:[1,0]
v_max_f32 v20,v20,v21
v_max_f32 v26,v26,v87
v_mfma_f32_16x16x32_bf16 v[96:99],v[136:139],a[224:227],v[96:99]
ds_read_b128 v[136:139],v0 offset:6400
v_mov_b32 v21,v20
v_mfma_f32_16x16x32_bf16 v[96:99],v[140:143],a[228:231],v[96:99]
s_waitcnt lgkmcnt(4)
ds_read_b128 v[140:143],v1 offset:6400
v_mov_b32 v27,v26
v_mfma_f32_16x16x32_bf16 v[96:99],v[112:115],a[232:235],v[96:99]
ds_read_b128 v[112:115],v0 offset:12544
v_permlane16_swap_b32 v21,v20
v_max3_f32 v32,v32,v91,v92
v_permlane32_swap_b32 v27,v26
v_pk_mul_f32 v[196:197],v[196:197],v[54:55] op_sel_hi:[1,0]
v_pk_mul_f32 v[198:199],v[198:199],v[54:55] op_sel_hi:[1,0]
v_max_f32 v20,v20,v21
v_max3_f32 v32,v32,v93,v94
v_mfma_f32_16x16x32_bf16 v[96:99],v[116:119],a[236:239],v[96:99]
ds_read_b128 v[116:119],v1 offset:12544
v_max_f32 v26,v26,v27
v_mfma_f32_16x16x32_bf16 v[100:103],v[120:123],a[216:219],0
s_waitcnt lgkmcnt(4)
ds_read_b128 v[120:123],v0 offset:18432
v_mul_f32_e64 v13,-s36,v20
v_mfma_f32_16x16x32_bf16 v[100:103],v[124:127],a[220:223],v[100:103]
ds_read_b128 v[124:127],v1 offset:18432
v_max_f32 v32,v32,v95
v_mfma_f32_16x16x32_bf16 v[100:103],v[128:131],a[224:227],v[100:103]
ds_read_b128 v[128:131],v0 offset:12288
v_mov_b32 v27,v26
v_fma_f32 v72,v72,s36,v13
v_fma_f32 v73,v73,s36,v13
v_fma_f32 v74,v74,s36,v13
v_pk_mul_f32 v[200:201],v[200:201],v[54:55] op_sel_hi:[1,0]
v_pk_mul_f32 v[202:203],v[202:203],v[54:55] op_sel_hi:[1,0]
v_fma_f32 v75,v75,s36,v13
v_max3_f32 v38,v96,v97,v98
v_mfma_f32_16x16x32_bf16 v[100:103],v[132:135],a[228:231],v[100:103]
s_waitcnt lgkmcnt(4)
ds_read_b128 v[132:135],v1 offset:12288
v_mov_b32 v33,v32
v_mfma_f32_16x16x32_bf16 v[100:103],v[136:139],a[232:235],v[100:103]
ds_read_b128 v[136:139],v0 offset:12416
v_permlane16_swap_b32 v27,v26
v_mfma_f32_16x16x32_bf16 v[100:103],v[140:143],a[236:239],v[100:103]
ds_read_b128 v[140:143],v1 offset:12416
v_exp_f32 v72,v72
v_exp_f32 v73,v73
v_pk_mul_f32 v[204:205],v[204:205],v[54:55] op_sel_hi:[1,0]
v_pk_mul_f32 v[206:207],v[206:207],v[54:55] op_sel_hi:[1,0]
v_exp_f32 v74,v74
v_exp_f32 v75,v75
v_permlane32_swap_b32 v33,v32
v_max_f32 v26,v26,v27
v_max3_f32 v38,v38,v99,v100
v_max_f32 v32,v32,v33
v_mul_f32_e64 v14,-s36,v26
v_max3_f32 v38,v38,v101,v102
v_cvt_pk_bf16_f32 v18,v72,v73
v_cvt_pk_bf16_f32 v19,v74,v75
s_waitcnt lgkmcnt(3)
v_mfma_f32_16x16x32_bf16 v[72:75],v[128:131],a[144:147],0
v_mov_b32 v33,v32
v_fma_f32 v80,v80,s36,v14
v_fma_f32 v81,v81,s36,v14
v_fma_f32 v82,v82,s36,v14
v_fma_f32 v83,v83,s36,v14
v_max_f32 v38,v38,v103
v_permlane16_swap_b32 v33,v32
v_exp_f32 v80,v80
v_exp_f32 v81,v81
v_exp_f32 v82,v82
v_exp_f32 v83,v83
v_mov_b32 v39,v38
v_max_f32 v32,v32,v33
v_mul_f32_e64 v15,-s36,v32
v_permlane32_swap_b32 v39,v38
v_max_f32 v38,v38,v39
v_cvt_pk_bf16_f32 v24,v80,v81
v_cvt_pk_bf16_f32 v25,v82,v83
v_mfma_f32_16x16x32_bf16 v[80:83],v[128:131],a[168:171],0
v_fma_f32 v88,v88,s36,v15
v_fma_f32 v89,v89,s36,v15
v_fma_f32 v90,v90,s36,v15
v_fma_f32 v91,v91,s36,v15
v_mov_b32 v39,v38
v_exp_f32 v88,v88
v_exp_f32 v89,v89
v_exp_f32 v90,v90
v_exp_f32 v91,v91
v_permlane16_swap_b32 v39,v38
v_max_f32 v38,v38,v39
v_cvt_pk_bf16_f32 v172,v172,v173
v_cvt_pk_bf16_f32 v188,v188,v189
v_mul_f32_e64 v16,-s36,v38
v_cvt_pk_bf16_f32 v192,v192,v193
v_cvt_pk_bf16_f32 v30,v88,v89
v_cvt_pk_bf16_f32 v31,v90,v91
v_mfma_f32_16x16x32_bf16 v[88:91],v[128:131],a[192:195],0
v_cvt_pk_bf16_f32 v173,v174,v175
v_cvt_pk_bf16_f32 v189,v190,v191
ds_write2st64_b64 v43,v[172:173],v[188:189] offset0:0 offset1:2
v_fma_f32 v96,v96,s36,v16
v_fma_f32 v97,v97,s36,v16
v_fma_f32 v98,v98,s36,v16
v_fma_f32 v99,v99,s36,v16
v_cvt_pk_bf16_f32 v196,v196,v197
v_cvt_pk_bf16_f32 v193,v194,v195
v_exp_f32 v96,v96
v_exp_f32 v97,v97
v_exp_f32 v98,v98
ds_write_b64 v36,v[192:193] offset:2048
v_exp_f32 v99,v99
s_waitcnt vmcnt(5)
s_barrier
buffer_load_dwordx4 v6,s[4:7],s20 offen offset:0 lds
v_cvt_pk_bf16_f32 v197,v198,v199
ds_write_b64 v37,v[196:197] offset:2048
v_cvt_pk_bf16_f32 v36,v96,v97
v_cvt_pk_bf16_f32 v37,v98,v99
v_mfma_f32_16x16x32_bf16 v[96:99],v[128:131],a[216:219],0
s_waitcnt lgkmcnt(2)
ds_read_b128 v[128:131],v0 offset:18560
v_fma_f32 v76,v76,s36,v13
v_mfma_f32_16x16x32_bf16 v[72:75],v[132:135],a[148:151],v[72:75]
v_fma_f32 v77,v77,s36,v13
v_fma_f32 v78,v78,s36,v13
v_mfma_f32_16x16x32_bf16 v[80:83],v[132:135],a[172:175],v[80:83]
v_fma_f32 v79,v79,s36,v13
v_exp_f32 v76,v76
v_mfma_f32_16x16x32_bf16 v[88:91],v[132:135],a[196:199],v[88:91]
buffer_load_dwordx4 v7,s[4:7],s20 offen offset:1024 lds
v_mfma_f32_16x16x32_bf16 v[96:99],v[132:135],a[220:223],v[96:99]
ds_read_b128 v[132:135],v1 offset:18560
v_exp_f32 v77,v77
v_mfma_f32_16x16x32_bf16 v[72:75],v[136:139],a[152:155],v[72:75]
v_exp_f32 v78,v78
v_mfma_f32_16x16x32_bf16 v[80:83],v[136:139],a[176:179],v[80:83]
v_exp_f32 v79,v79
v_mfma_f32_16x16x32_bf16 v[88:91],v[136:139],a[200:203],v[88:91]
v_fma_f32 v84,v84,s36,v14
v_fma_f32 v85,v85,s36,v14
v_mfma_f32_16x16x32_bf16 v[96:99],v[136:139],a[224:227],v[96:99]
buffer_load_dwordx4 v8,s[4:7],s20 offen offset:2048 lds
v_mfma_f32_16x16x32_bf16 v[72:75],v[140:143],a[156:159],v[72:75]
s_add_u32 s20,s20,12288
ds_read_b128 v[136:139],v0 offset:18688
v_fma_f32 v86,v86,s36,v14
v_mfma_f32_16x16x32_bf16 v[80:83],v[140:143],a[180:183],v[80:83]
v_fma_f32 v87,v87,s36,v14
v_cvt_pk_bf16_f32 v20,v76,v77
v_mfma_f32_16x16x32_bf16 v[88:91],v[140:143],a[204:207],v[88:91]
v_cvt_pk_bf16_f32 v21,v78,v79
v_exp_f32 v84,v84
v_mfma_f32_16x16x32_bf16 v[96:99],v[140:143],a[228:231],v[96:99]
ds_read_b128 v[140:143],v1 offset:18688
v_exp_f32 v85,v85
v_mfma_f32_16x16x32_bf16 v[52:55],v[48:51],v[18:21],0
v_exp_f32 v86,v86
v_mfma_f32_16x16x32_bf16 v[72:75],v[112:115],a[160:163],v[72:75]
v_exp_f32 v87,v87
v_mfma_f32_16x16x32_bf16 v[80:83],v[112:115],a[184:187],v[80:83]
v_fma_f32 v92,v92,s36,v15
v_fma_f32 v93,v93,s36,v15
v_mfma_f32_16x16x32_bf16 v[88:91],v[112:115],a[208:211],v[88:91]
v_fma_f32 v94,v94,s36,v15
v_fma_f32 v95,v95,s36,v15
v_mfma_f32_16x16x32_bf16 v[96:99],v[112:115],a[232:235],v[96:99]
ds_read_b64_tr_b16 v[112:113],v2 offset:0
ds_read_b64_tr_b16 v[114:115],v2 offset:6144
v_mfma_f32_16x16x32_bf16 v[72:75],v[116:119],a[164:167],v[72:75]
v_cvt_pk_bf16_f32 v26,v84,v85
v_cvt_pk_bf16_f32 v27,v86,v87
v_mfma_f32_16x16x32_bf16 v[80:83],v[116:119],a[188:191],v[80:83]
v_exp_f32 v92,v92
v_mfma_f32_16x16x32_bf16 v[56:59],v[48:51],v[24:27],0
v_exp_f32 v93,v93
v_mfma_f32_16x16x32_bf16 v[88:91],v[116:119],a[212:215],v[88:91]
v_exp_f32 v94,v94
v_mfma_f32_16x16x32_bf16 v[96:99],v[116:119],a[236:239],v[96:99]
ds_read_b64_tr_b16 v[116:117],v3 offset:0
ds_read_b64_tr_b16 v[118:119],v3 offset:6144
v_mfma_f32_16x16x32_bf16 v[76:79],v[120:123],a[144:147],0
v_exp_f32 v95,v95
v_mfma_f32_16x16x32_bf16 v[84:87],v[120:123],a[168:171],0
v_fma_f32 v100,v100,s36,v16
v_fma_f32 v101,v101,s36,v16
v_fma_f32 v102,v102,s36,v16
v_fma_f32 v103,v103,s36,v16
v_cvt_pk_bf16_f32 v32,v92,v93
v_cvt_pk_bf16_f32 v33,v94,v95
v_mfma_f32_16x16x32_bf16 v[92:95],v[120:123],a[192:195],0
v_exp_f32 v100,v100
v_mfma_f32_16x16x32_bf16 v[60:63],v[48:51],v[30:33],0
v_exp_f32 v101,v101
v_exp_f32 v102,v102
v_exp_f32 v103,v103
v_cvt_pk_bf16_f32 v38,v100,v101
v_cvt_pk_bf16_f32 v39,v102,v103
v_mfma_f32_16x16x32_bf16 v[100:103],v[120:123],a[216:219],0
ds_read_b64_tr_b16 v[120:121],v4 offset:0
ds_read_b64_tr_b16 v[122:123],v4 offset:6144
v_mfma_f32_16x16x32_bf16 v[64:67],v[48:51],v[36:39],0
v_fma_f32 v72,v72,s36,v13
v_fma_f32 v73,v73,s36,v13
v_mfma_f32_16x16x32_bf16 v[76:79],v[124:127],a[148:151],v[76:79]
v_fma_f32 v74,v74,s36,v13
v_fma_f32 v75,v75,s36,v13
v_mfma_f32_16x16x32_bf16 v[84:87],v[124:127],a[172:175],v[84:87]
v_fma_f32 v80,v80,s36,v14
v_fma_f32 v81,v81,s36,v14
v_mfma_f32_16x16x32_bf16 v[92:95],v[124:127],a[196:199],v[92:95]
v_cvt_pk_bf16_f32 v200,v200,v201
v_exp_f32 v72,v72
v_mfma_f32_16x16x32_bf16 v[100:103],v[124:127],a[220:223],v[100:103]
s_waitcnt lgkmcnt(2)
ds_read_b64_tr_b16 v[124:125],v5 offset:0
ds_read_b64_tr_b16 v[126:127],v5 offset:6144
v_mfma_f32_16x16x32_bf16 v[76:79],v[128:131],a[152:155],v[76:79]
v_exp_f32 v73,v73
v_mfma_f32_16x16x32_bf16 v[84:87],v[128:131],a[176:179],v[84:87]
v_exp_f32 v74,v74
v_mfma_f32_16x16x32_bf16 v[92:95],v[128:131],a[200:203],v[92:95]
v_exp_f32 v75,v75
v_mfma_f32_16x16x32_bf16 v[100:103],v[128:131],a[224:227],v[100:103]
v_exp_f32 v80,v80
v_mfma_f32_16x16x32_bf16 v[76:79],v[132:135],a[156:159],v[76:79]
v_exp_f32 v81,v81
v_mfma_f32_16x16x32_bf16 v[84:87],v[132:135],a[180:183],v[84:87]
v_cvt_pk_bf16_f32 v204,v204,v205
v_cvt_pk_bf16_f32 v201,v202,v203
v_mfma_f32_16x16x32_bf16 v[92:95],v[132:135],a[204:207],v[92:95]
ds_write_b64 v42,v[200:201] offset:2048
v_mfma_f32_16x16x32_bf16 v[100:103],v[132:135],a[228:231],v[100:103]
v_cvt_pk_bf16_f32 v205,v206,v207
v_cvt_pk_bf16_f32 v22,v72,v73
v_mfma_f32_16x16x32_bf16 v[76:79],v[136:139],a[160:163],v[76:79]
ds_write_b64 v43,v[204:205] offset:2048
v_mfma_f32_16x16x32_bf16 v[84:87],v[136:139],a[184:187],v[84:87]
v_cvt_pk_bf16_f32 v23,v74,v75
v_cvt_pk_bf16_f32 v28,v80,v81
v_mfma_f32_16x16x32_bf16 v[92:95],v[136:139],a[208:211],v[92:95]
v_mfma_f32_16x16x32_bf16 v[100:103],v[136:139],a[232:235],v[100:103]
v_mfma_f32_16x16x32_bf16 v[76:79],v[140:143],a[164:167],v[76:79]
v_mfma_f32_16x16x32_bf16 v[84:87],v[140:143],a[188:191],v[84:87]
v_mfma_f32_16x16x32_bf16 v[92:95],v[140:143],a[212:215],v[92:95]
v_mfma_f32_16x16x32_bf16 v[100:103],v[140:143],a[236:239],v[100:103]
v_mfma_f32_16x16x32_bf16 v[160:163],v[112:115],v[18:21],0
s_add_u32 m0,s23,0
ds_read_b64_tr_b16 v[128:129],v2 offset:128
ds_read_b64_tr_b16 v[130:131],v2 offset:6272
v_mfma_f32_16x16x32_bf16 v[208:211],v[112:115],v[24:27],0
ds_read_b64_tr_b16 v[132:133],v3 offset:128
ds_read_b64_tr_b16 v[134:135],v3 offset:6272
v_mfma_f32_16x16x32_bf16 a[0:3],v[112:115],v[30:33],0
ds_read_b64_tr_b16 v[136:137],v4 offset:128
ds_read_b64_tr_b16 v[138:139],v4 offset:6272
v_mfma_f32_16x16x32_bf16 a[48:51],v[112:115],v[36:39],0
ds_read_b64_tr_b16 v[140:141],v5 offset:128
ds_read_b64_tr_b16 v[142:143],v5 offset:6272
v_mfma_f32_16x16x32_bf16 v[164:167],v[116:119],v[18:21],0
ds_read_b64_tr_b16 v[112:113],v2 offset:256
ds_read_b64_tr_b16 v[114:115],v2 offset:6400
v_mfma_f32_16x16x32_bf16 v[212:215],v[116:119],v[24:27],0
v_fma_f32 v82,v82,s36,v14
v_fma_f32 v83,v83,s36,v14
v_mfma_f32_16x16x32_bf16 a[4:7],v[116:119],v[30:33],0
v_exp_f32 v82,v82
v_mfma_f32_16x16x32_bf16 a[52:55],v[116:119],v[36:39],0
s_waitcnt lgkmcnt(10)
ds_read_b64_tr_b16 v[116:117],v3 offset:256
ds_read_b64_tr_b16 v[118:119],v3 offset:6400
v_mfma_f32_16x16x32_bf16 v[168:171],v[120:123],v[18:21],0
v_exp_f32 v83,v83
v_mfma_f32_16x16x32_bf16 v[216:219],v[120:123],v[24:27],0
v_cvt_pk_bf16_f32 v29,v82,v83
v_fma_f32 v88,v88,s36,v15
v_mfma_f32_16x16x32_bf16 a[8:11],v[120:123],v[30:33],0
v_fma_f32 v89,v89,s36,v15
v_fma_f32 v90,v90,s36,v15
v_mfma_f32_16x16x32_bf16 a[56:59],v[120:123],v[36:39],0
ds_read_b64_tr_b16 v[120:121],v4 offset:256
ds_read_b64_tr_b16 v[122:123],v4 offset:6400
v_mfma_f32_16x16x32_bf16 v[172:175],v[124:127],v[18:21],0
v_fma_f32 v91,v91,s36,v15
v_fma_f32 v96,v96,s36,v16
v_mfma_f32_16x16x32_bf16 v[220:223],v[124:127],v[24:27],0
v_exp_f32 v88,v88
v_mfma_f32_16x16x32_bf16 a[12:15],v[124:127],v[30:33],0
v_exp_f32 v89,v89
v_mfma_f32_16x16x32_bf16 a[60:63],v[124:127],v[36:39],0
s_waitcnt lgkmcnt(3)
ds_read_b64_tr_b16 v[124:125],v5 offset:256
ds_read_b64_tr_b16 v[126:127],v5 offset:6400
v_mfma_f32_16x16x32_bf16 v[176:179],v[128:131],v[18:21],0
v_exp_f32 v90,v90
v_mfma_f32_16x16x32_bf16 v[224:227],v[128:131],v[24:27],0
v_exp_f32 v91,v91
v_mfma_f32_16x16x32_bf16 a[16:19],v[128:131],v[30:33],0
v_cvt_pk_bf16_f32 v34,v88,v89
v_cvt_pk_bf16_f32 v35,v90,v91
v_mfma_f32_16x16x32_bf16 a[64:67],v[128:131],v[36:39],0
v_fma_f32 v97,v97,s36,v16
v_fma_f32 v98,v98,s36,v16
v_mfma_f32_16x16x32_bf16 v[180:183],v[132:135],v[18:21],0
v_fma_f32 v99,v99,s36,v16
v_fma_f32 v76,v76,s36,v13
v_mfma_f32_16x16x32_bf16 v[228:231],v[132:135],v[24:27],0
v_exp_f32 v96,v96
v_mfma_f32_16x16x32_bf16 a[20:23],v[132:135],v[30:33],0
v_exp_f32 v97,v97
v_mfma_f32_16x16x32_bf16 a[68:71],v[132:135],v[36:39],0
v_exp_f32 v98,v98
v_mfma_f32_16x16x32_bf16 v[184:187],v[136:139],v[18:21],0
v_exp_f32 v99,v99
v_mfma_f32_16x16x32_bf16 v[232:235],v[136:139],v[24:27],0
v_cvt_pk_bf16_f32 v40,v96,v97
v_cvt_pk_bf16_f32 v41,v98,v99
v_mfma_f32_16x16x32_bf16 a[24:27],v[136:139],v[30:33],0
v_fma_f32 v77,v77,s36,v13
v_fma_f32 v78,v78,s36,v13
v_mfma_f32_16x16x32_bf16 a[72:75],v[136:139],v[36:39],0
v_fma_f32 v79,v79,s36,v13
v_fma_f32 v84,v84,s36,v14
v_mfma_f32_16x16x32_bf16 v[188:191],v[140:143],v[18:21],0
v_exp_f32 v76,v76
v_mfma_f32_16x16x32_bf16 v[236:239],v[140:143],v[24:27],0
v_exp_f32 v77,v77
v_mfma_f32_16x16x32_bf16 a[28:31],v[140:143],v[30:33],0
v_exp_f32 v78,v78
v_mfma_f32_16x16x32_bf16 a[76:79],v[140:143],v[36:39],0
v_exp_f32 v79,v79
v_mfma_f32_16x16x32_bf16 v[192:195],v[112:115],v[18:21],0
v_fma_f32 v85,v85,s36,v14
v_fma_f32 v86,v86,s36,v14
s_waitcnt vmcnt(24) lgkmcnt(0)
v_mfma_f32_16x16x32_bf16 v[240:243],v[112:115],v[24:27],0
s_barrier
v_mfma_f32_16x16x32_bf16 a[32:35],v[112:115],v[30:33],0
ds_read_b128 v[128:131],v0 offset:24576
v_fma_f32 v87,v87,s36,v14
v_mfma_f32_16x16x32_bf16 a[80:83],v[112:115],v[36:39],0
ds_read_b128 v[132:135],v1 offset:24576
v_fma_f32 v92,v92,s36,v15
v_mfma_f32_16x16x32_bf16 v[196:199],v[116:119],v[18:21],0
ds_read_b128 v[136:139],v0 offset:24704
v_fma_f32 v93,v93,s36,v15
v_mfma_f32_16x16x32_bf16 v[244:247],v[116:119],v[24:27],0
ds_read_b128 v[140:143],v1 offset:24704
v_fma_f32 v94,v94,s36,v15
v_mfma_f32_16x16x32_bf16 a[36:39],v[116:119],v[30:33],0
ds_read_b128 v[112:115],v0 offset:24832
v_fma_f32 v95,v95,s36,v15
v_mfma_f32_16x16x32_bf16 a[84:87],v[116:119],v[36:39],0
buffer_load_dwordx4 v6,s[8:11],s21 offen offset:0 lds
v_mfma_f32_16x16x32_bf16 v[200:203],v[120:123],v[18:21],0
ds_read_b128 v[116:119],v1 offset:24832
v_fma_f32 v100,v100,s36,v16
v_mfma_f32_16x16x32_bf16 v[248:251],v[120:123],v[24:27],0
v_exp_f32 v84,v84
v_mfma_f32_16x16x32_bf16 a[40:43],v[120:123],v[30:33],0
v_exp_f32 v85,v85
v_mfma_f32_16x16x32_bf16 a[88:91],v[120:123],v[36:39],0
ds_read_b128 v[120:123],v0 offset:30720
v_fma_f32 v101,v101,s36,v16
v_mfma_f32_16x16x32_bf16 v[204:207],v[124:127],v[18:21],0
v_cvt_pk_bf16_f32 v20,v76,v77
v_cvt_pk_bf16_f32 v21,v78,v79
v_mfma_f32_16x16x32_bf16 v[252:255],v[124:127],v[24:27],0
v_exp_f32 v86,v86
v_mfma_f32_16x16x32_bf16 v[52:55],v[48:51],v[20:23],v[52:55]
v_exp_f32 v87,v87
v_mfma_f32_16x16x32_bf16 a[44:47],v[124:127],v[30:33],0
v_cvt_pk_bf16_f32 v26,v84,v85
v_cvt_pk_bf16_f32 v27,v86,v87
v_mfma_f32_16x16x32_bf16 a[92:95],v[124:127],v[36:39],0
buffer_load_dwordx4 v7,s[8:11],s21 offen offset:1024 lds
v_mfma_f32_16x16x32_bf16 v[56:59],v[48:51],v[26:29],v[56:59]
s_waitcnt lgkmcnt(1)
ds_read_b128 v[124:127],v1 offset:30720
v_fma_f32 v102,v102,s36,v16
v_mfma_f32_16x16x32_bf16 v[72:75],v[128:131],a[144:147],0
v_exp_f32 v92,v92
v_mfma_f32_16x16x32_bf16 v[80:83],v[128:131],a[168:171],0
v_exp_f32 v93,v93
v_mfma_f32_16x16x32_bf16 v[88:91],v[128:131],a[192:195],0
v_exp_f32 v94,v94
v_mfma_f32_16x16x32_bf16 v[96:99],v[128:131],a[216:219],0
ds_read_b128 v[128:131],v0 offset:30848
v_fma_f32 v103,v103,s36,v16
v_mfma_f32_16x16x32_bf16 v[72:75],v[132:135],a[148:151],v[72:75]
v_exp_f32 v95,v95
v_mfma_f32_16x16x32_bf16 v[80:83],v[132:135],a[172:175],v[80:83]
v_cvt_pk_bf16_f32 v32,v92,v93
v_cvt_pk_bf16_f32 v33,v94,v95
v_mfma_f32_16x16x32_bf16 v[88:91],v[132:135],a[196:199],v[88:91]
v_exp_f32 v100,v100
v_mfma_f32_16x16x32_bf16 v[60:63],v[48:51],v[32:35],v[60:63]
buffer_load_dwordx4 v8,s[8:11],s21 offen offset:2048 lds
v_mfma_f32_16x16x32_bf16 v[96:99],v[132:135],a[220:223],v[96:99]
s_add_u32 s21,s21,12288
v_exp_f32 v101,v101
v_mfma_f32_16x16x32_bf16 v[72:75],v[136:139],a[152:155],v[72:75]
s_add_u32 m0,s22,12288
v_exp_f32 v102,v102
v_mfma_f32_16x16x32_bf16 v[80:83],v[136:139],a[176:179],v[80:83]
v_exp_f32 v103,v103
v_mfma_f32_16x16x32_bf16 v[88:91],v[136:139],a[200:203],v[88:91]
v_cvt_pk_bf16_f32 v38,v100,v101
v_cvt_pk_bf16_f32 v39,v102,v103
v_mfma_f32_16x16x32_bf16 v[96:99],v[136:139],a[224:227],v[96:99]
ds_read_b128 v[132:135],v1 offset:30848
v_mfma_f32_16x16x32_bf16 v[64:67],v[48:51],v[38:41],v[64:67]
ds_read_b128 v[136:139],v0 offset:30976
v_mfma_f32_16x16x32_bf16 v[72:75],v[140:143],a[156:159],v[72:75]
v_mfma_f32_16x16x32_bf16 v[80:83],v[140:143],a[180:183],v[80:83]
v_mfma_f32_16x16x32_bf16 v[88:91],v[140:143],a[204:207],v[88:91]
buffer_load_dwordx4 v6,s[4:7],s20 offen offset:0 lds
v_mfma_f32_16x16x32_bf16 v[96:99],v[140:143],a[228:231],v[96:99]
ds_read_b128 v[140:143],v1 offset:30976
v_mfma_f32_16x16x32_bf16 v[72:75],v[112:115],a[160:163],v[72:75]
v_mfma_f32_16x16x32_bf16 v[80:83],v[112:115],a[184:187],v[80:83]
v_mfma_f32_16x16x32_bf16 v[88:91],v[112:115],a[208:211],v[88:91]
v_mfma_f32_16x16x32_bf16 v[96:99],v[112:115],a[232:235],v[96:99]
v_mfma_f32_16x16x32_bf16 v[72:75],v[116:119],a[164:167],v[72:75]
v_mfma_f32_16x16x32_bf16 v[80:83],v[116:119],a[188:191],v[80:83]
v_mfma_f32_16x16x32_bf16 v[88:91],v[116:119],a[212:215],v[88:91]
v_mfma_f32_16x16x32_bf16 v[96:99],v[116:119],a[236:239],v[96:99]
buffer_load_dwordx4 v7,s[4:7],s20 offen offset:1024 lds
s_waitcnt lgkmcnt(0)
v_mfma_f32_16x16x32_bf16 v[76:79],v[120:123],a[144:147],0
v_mfma_f32_16x16x32_bf16 v[84:87],v[120:123],a[168:171],0
v_mfma_f32_16x16x32_bf16 v[92:95],v[120:123],a[192:195],0
v_mfma_f32_16x16x32_bf16 v[100:103],v[120:123],a[216:219],0
v_fma_f32 v72,v72,s36,v13
v_fma_f32 v73,v73,s36,v13
v_mfma_f32_16x16x32_bf16 v[76:79],v[124:127],a[148:151],v[76:79]
v_fma_f32 v74,v74,s36,v13
v_fma_f32 v75,v75,s36,v13
v_mfma_f32_16x16x32_bf16 v[84:87],v[124:127],a[172:175],v[84:87]
v_fma_f32 v80,v80,s36,v14
v_fma_f32 v81,v81,s36,v14
v_mfma_f32_16x16x32_bf16 v[92:95],v[124:127],a[196:199],v[92:95]
v_exp_f32 v72,v72
v_mfma_f32_16x16x32_bf16 v[100:103],v[124:127],a[220:223],v[100:103]
v_exp_f32 v73,v73
v_mfma_f32_16x16x32_bf16 v[76:79],v[128:131],a[152:155],v[76:79]
buffer_load_dwordx4 v8,s[4:7],s20 offen offset:2048 lds
v_mfma_f32_16x16x32_bf16 v[84:87],v[128:131],a[176:179],v[84:87]
s_add_u32 s20,s20,12288
ds_read_b64_tr_b16 v[112:113],v2 offset:18432
v_mfma_f32_16x16x32_bf16 v[92:95],v[128:131],a[200:203],v[92:95]
ds_read_b64_tr_b16 v[114:115],v2 offset:12288
v_cvt_pk_bf16_f32 v18,v72,v73
v_mfma_f32_16x16x32_bf16 v[100:103],v[128:131],a[224:227],v[100:103]
ds_read_b64_tr_b16 v[116:117],v3 offset:18432
v_mfma_f32_16x16x32_bf16 v[76:79],v[132:135],a[156:159],v[76:79]
ds_read_b64_tr_b16 v[118:119],v3 offset:12288
v_mfma_f32_16x16x32_bf16 v[84:87],v[132:135],a[180:183],v[84:87]
ds_read_b64_tr_b16 v[120:121],v4 offset:18432
v_mfma_f32_16x16x32_bf16 v[92:95],v[132:135],a[204:207],v[92:95]
ds_read_b64_tr_b16 v[122:123],v4 offset:12288
v_mfma_f32_16x16x32_bf16 v[100:103],v[132:135],a[228:231],v[100:103]
ds_read_b64_tr_b16 v[124:125],v5 offset:18432
v_mfma_f32_16x16x32_bf16 v[76:79],v[136:139],a[160:163],v[76:79]
ds_read_b64_tr_b16 v[126:127],v5 offset:12288
v_mfma_f32_16x16x32_bf16 v[84:87],v[136:139],a[184:187],v[84:87]
v_exp_f32 v74,v74
v_mfma_f32_16x16x32_bf16 v[92:95],v[136:139],a[208:211],v[92:95]
v_exp_f32 v75,v75
v_mfma_f32_16x16x32_bf16 v[100:103],v[136:139],a[232:235],v[100:103]
v_exp_f32 v80,v80
v_mfma_f32_16x16x32_bf16 v[76:79],v[140:143],a[164:167],v[76:79]
v_exp_f32 v81,v81
v_mfma_f32_16x16x32_bf16 v[84:87],v[140:143],a[188:191],v[84:87]
v_cvt_pk_bf16_f32 v19,v74,v75
v_cvt_pk_bf16_f32 v24,v80,v81
v_mfma_f32_16x16x32_bf16 v[92:95],v[140:143],a[212:215],v[92:95]
v_mfma_f32_16x16x32_bf16 v[100:103],v[140:143],a[236:239],v[100:103]
s_waitcnt lgkmcnt(2)
v_mfma_f32_16x16x32_bf16 v[160:163],v[112:115],v[20:23],v[160:163]
s_add_u32 m0,s23,12288
ds_read_b64_tr_b16 v[128:129],v2 offset:18560
ds_read_b64_tr_b16 v[130:131],v2 offset:12416
v_mfma_f32_16x16x32_bf16 v[208:211],v[112:115],v[26:29],v[208:211]
ds_read_b64_tr_b16 v[132:133],v3 offset:18560
ds_read_b64_tr_b16 v[134:135],v3 offset:12416
v_mfma_f32_16x16x32_bf16 a[0:3],v[112:115],v[32:35],a[0:3]
ds_read_b64_tr_b16 v[136:137],v4 offset:18560
ds_read_b64_tr_b16 v[138:139],v4 offset:12416
v_mfma_f32_16x16x32_bf16 a[48:51],v[112:115],v[38:41],a[48:51]
ds_read_b64_tr_b16 v[140:141],v5 offset:18560
ds_read_b64_tr_b16 v[142:143],v5 offset:12416
v_mfma_f32_16x16x32_bf16 v[164:167],v[116:119],v[20:23],v[164:167]
ds_read_b64_tr_b16 v[112:113],v2 offset:18688
ds_read_b64_tr_b16 v[114:115],v2 offset:12544
v_mfma_f32_16x16x32_bf16 v[212:215],v[116:119],v[26:29],v[212:215]
v_fma_f32 v82,v82,s36,v14
v_fma_f32 v83,v83,s36,v14
v_mfma_f32_16x16x32_bf16 a[4:7],v[116:119],v[32:35],a[4:7]
v_exp_f32 v82,v82
v_mfma_f32_16x16x32_bf16 a[52:55],v[116:119],v[38:41],a[52:55]
ds_read_b64_tr_b16 v[116:117],v3 offset:18688
ds_read_b64_tr_b16 v[118:119],v3 offset:12544
v_mfma_f32_16x16x32_bf16 v[168:171],v[120:123],v[20:23],v[168:171]
v_exp_f32 v83,v83
v_mfma_f32_16x16x32_bf16 v[216:219],v[120:123],v[26:29],v[216:219]
v_cvt_pk_bf16_f32 v25,v82,v83
v_fma_f32 v88,v88,s36,v15
v_mfma_f32_16x16x32_bf16 a[8:11],v[120:123],v[32:35],a[8:11]
v_fma_f32 v89,v89,s36,v15
v_fma_f32 v90,v90,s36,v15
v_mfma_f32_16x16x32_bf16 a[56:59],v[120:123],v[38:41],a[56:59]
s_waitcnt lgkmcnt(6)
ds_read_b64_tr_b16 v[120:121],v4 offset:18688
ds_read_b64_tr_b16 v[122:123],v4 offset:12544
v_mfma_f32_16x16x32_bf16 v[172:175],v[124:127],v[20:23],v[172:175]
v_fma_f32 v91,v91,s36,v15
v_fma_f32 v96,v96,s36,v16
v_mfma_f32_16x16x32_bf16 v[220:223],v[124:127],v[26:29],v[220:223]
v_exp_f32 v88,v88
v_mfma_f32_16x16x32_bf16 a[12:15],v[124:127],v[32:35],a[12:15]
v_exp_f32 v89,v89
v_mfma_f32_16x16x32_bf16 a[60:63],v[124:127],v[38:41],a[60:63]
ds_read_b64_tr_b16 v[124:125],v5 offset:18688
ds_read_b64_tr_b16 v[126:127],v5 offset:12544
v_mfma_f32_16x16x32_bf16 v[176:179],v[128:131],v[20:23],v[176:179]
v_exp_f32 v90,v90
v_mfma_f32_16x16x32_bf16 v[224:227],v[128:131],v[26:29],v[224:227]
v_exp_f32 v91,v91
v_mfma_f32_16x16x32_bf16 a[16:19],v[128:131],v[32:35],a[16:19]
v_cvt_pk_bf16_f32 v30,v88,v89
v_cvt_pk_bf16_f32 v31,v90,v91
v_mfma_f32_16x16x32_bf16 a[64:67],v[128:131],v[38:41],a[64:67]
v_fma_f32 v97,v97,s36,v16
v_fma_f32 v98,v98,s36,v16
v_mfma_f32_16x16x32_bf16 v[180:183],v[132:135],v[20:23],v[180:183]
v_fma_f32 v99,v99,s36,v16
v_fma_f32 v76,v76,s36,v13
v_mfma_f32_16x16x32_bf16 v[228:231],v[132:135],v[26:29],v[228:231]
v_exp_f32 v96,v96
v_mfma_f32_16x16x32_bf16 a[20:23],v[132:135],v[32:35],a[20:23]
v_exp_f32 v97,v97
v_mfma_f32_16x16x32_bf16 a[68:71],v[132:135],v[38:41],a[68:71]
v_exp_f32 v98,v98
v_mfma_f32_16x16x32_bf16 v[184:187],v[136:139],v[20:23],v[184:187]
v_exp_f32 v99,v99
v_mfma_f32_16x16x32_bf16 v[232:235],v[136:139],v[26:29],v[232:235]
v_cvt_pk_bf16_f32 v36,v96,v97
v_cvt_pk_bf16_f32 v37,v98,v99
v_mfma_f32_16x16x32_bf16 a[24:27],v[136:139],v[32:35],a[24:27]
v_fma_f32 v77,v77,s36,v13
v_fma_f32 v78,v78,s36,v13
v_mfma_f32_16x16x32_bf16 a[72:75],v[136:139],v[38:41],a[72:75]
s_waitcnt lgkmcnt(0)
v_fma_f32 v79,v79,s36,v13
v_fma_f32 v84,v84,s36,v14
v_mfma_f32_16x16x32_bf16 v[188:191],v[140:143],v[20:23],v[188:191]
v_exp_f32 v76,v76
v_mfma_f32_16x16x32_bf16 v[236:239],v[140:143],v[26:29],v[236:239]
v_exp_f32 v77,v77
v_mfma_f32_16x16x32_bf16 a[28:31],v[140:143],v[32:35],a[28:31]
v_exp_f32 v78,v78
v_mfma_f32_16x16x32_bf16 a[76:79],v[140:143],v[38:41],a[76:79]
v_exp_f32 v79,v79
v_mfma_f32_16x16x32_bf16 v[192:195],v[112:115],v[20:23],v[192:195]
v_fma_f32 v85,v85,s36,v14
v_fma_f32 v86,v86,s36,v14
s_waitcnt vmcnt(6)
v_mfma_f32_16x16x32_bf16 v[240:243],v[112:115],v[26:29],v[240:243]
s_barrier
v_mfma_f32_16x16x32_bf16 a[32:35],v[112:115],v[32:35],a[32:35]
ds_read_b128 v[128:131],v0 offset:0
v_fma_f32 v87,v87,s36,v14
v_mfma_f32_16x16x32_bf16 a[80:83],v[112:115],v[38:41],a[80:83]
ds_read_b128 v[132:135],v1 offset:0
v_fma_f32 v92,v92,s36,v15
v_mfma_f32_16x16x32_bf16 v[196:199],v[116:119],v[20:23],v[196:199]
ds_read_b128 v[136:139],v0 offset:128
v_fma_f32 v93,v93,s36,v15
v_mfma_f32_16x16x32_bf16 v[244:247],v[116:119],v[26:29],v[244:247]
ds_read_b128 v[140:143],v1 offset:128
v_fma_f32 v94,v94,s36,v15
v_mfma_f32_16x16x32_bf16 a[36:39],v[116:119],v[32:35],a[36:39]
ds_read_b128 v[112:115],v0 offset:256
v_fma_f32 v95,v95,s36,v15
v_mfma_f32_16x16x32_bf16 a[84:87],v[116:119],v[38:41],a[84:87]
buffer_load_dwordx4 v6,s[8:11],s21 offen offset:0 lds
v_mfma_f32_16x16x32_bf16 v[200:203],v[120:123],v[20:23],v[200:203]
ds_read_b128 v[116:119],v1 offset:256
v_fma_f32 v100,v100,s36,v16
v_mfma_f32_16x16x32_bf16 v[248:251],v[120:123],v[26:29],v[248:251]
v_exp_f32 v84,v84
v_mfma_f32_16x16x32_bf16 a[40:43],v[120:123],v[32:35],a[40:43]
v_exp_f32 v85,v85
v_mfma_f32_16x16x32_bf16 a[88:91],v[120:123],v[38:41],a[88:91]
ds_read_b128 v[120:123],v0 offset:6144
v_fma_f32 v101,v101,s36,v16
v_mfma_f32_16x16x32_bf16 v[204:207],v[124:127],v[20:23],v[204:207]
v_cvt_pk_bf16_f32 v20,v76,v77
v_cvt_pk_bf16_f32 v21,v78,v79
v_mfma_f32_16x16x32_bf16 v[252:255],v[124:127],v[26:29],v[252:255]
v_exp_f32 v86,v86
v_mfma_f32_16x16x32_bf16 v[52:55],v[48:51],v[18:21],v[52:55]
v_exp_f32 v87,v87
v_mfma_f32_16x16x32_bf16 a[44:47],v[124:127],v[32:35],a[44:47]
v_cvt_pk_bf16_f32 v26,v84,v85
v_cvt_pk_bf16_f32 v27,v86,v87
v_mfma_f32_16x16x32_bf16 a[92:95],v[124:127],v[38:41],a[92:95]
buffer_load_dwordx4 v7,s[8:11],s21 offen offset:1024 lds
v_mfma_f32_16x16x32_bf16 v[56:59],v[48:51],v[24:27],v[56:59]
s_waitcnt lgkmcnt(1)
ds_read_b128 v[124:127],v1 offset:6144
v_fma_f32 v102,v102,s36,v16
v_mfma_f32_16x16x32_bf16 v[72:75],v[128:131],a[144:147],0
v_exp_f32 v92,v92
v_mfma_f32_16x16x32_bf16 v[80:83],v[128:131],a[168:171],0
v_exp_f32 v93,v93
v_mfma_f32_16x16x32_bf16 v[88:91],v[128:131],a[192:195],0
v_exp_f32 v94,v94
v_mfma_f32_16x16x32_bf16 v[96:99],v[128:131],a[216:219],0
ds_read_b128 v[128:131],v0 offset:6272
v_fma_f32 v103,v103,s36,v16
v_mfma_f32_16x16x32_bf16 v[72:75],v[132:135],a[148:151],v[72:75]
v_exp_f32 v95,v95
v_mfma_f32_16x16x32_bf16 v[80:83],v[132:135],a[172:175],v[80:83]
v_cvt_pk_bf16_f32 v32,v92,v93
v_cvt_pk_bf16_f32 v33,v94,v95
v_mfma_f32_16x16x32_bf16 v[88:91],v[132:135],a[196:199],v[88:91]
v_exp_f32 v100,v100
v_mfma_f32_16x16x32_bf16 v[60:63],v[48:51],v[30:33],v[60:63]
buffer_load_dwordx4 v8,s[8:11],s21 offen offset:2048 lds
v_mfma_f32_16x16x32_bf16 v[96:99],v[132:135],a[220:223],v[96:99]
s_add_u32 s21,s21,12288
v_exp_f32 v101,v101
v_mfma_f32_16x16x32_bf16 v[72:75],v[136:139],a[152:155],v[72:75]
s_add_u32 m0,s22,24576
v_exp_f32 v102,v102
v_mfma_f32_16x16x32_bf16 v[80:83],v[136:139],a[176:179],v[80:83]
v_exp_f32 v103,v103
v_mfma_f32_16x16x32_bf16 v[88:91],v[136:139],a[200:203],v[88:91]
v_cvt_pk_bf16_f32 v38,v100,v101
v_cvt_pk_bf16_f32 v39,v102,v103
v_mfma_f32_16x16x32_bf16 v[96:99],v[136:139],a[224:227],v[96:99]
ds_read_b128 v[132:135],v1 offset:6272
v_mfma_f32_16x16x32_bf16 v[64:67],v[48:51],v[36:39],v[64:67]
ds_read_b128 v[136:139],v0 offset:6400
v_mfma_f32_16x16x32_bf16 v[72:75],v[140:143],a[156:159],v[72:75]
v_mfma_f32_16x16x32_bf16 v[80:83],v[140:143],a[180:183],v[80:83]
v_mfma_f32_16x16x32_bf16 v[88:91],v[140:143],a[204:207],v[88:91]
buffer_load_dwordx4 v6,s[4:7],s20 offen offset:0 lds
v_mfma_f32_16x16x32_bf16 v[96:99],v[140:143],a[228:231],v[96:99]
ds_read_b128 v[140:143],v1 offset:6400
v_mfma_f32_16x16x32_bf16 v[72:75],v[112:115],a[160:163],v[72:75]
v_mfma_f32_16x16x32_bf16 v[80:83],v[112:115],a[184:187],v[80:83]
v_mfma_f32_16x16x32_bf16 v[88:91],v[112:115],a[208:211],v[88:91]
v_mfma_f32_16x16x32_bf16 v[96:99],v[112:115],a[232:235],v[96:99]
v_mfma_f32_16x16x32_bf16 v[72:75],v[116:119],a[164:167],v[72:75]
v_mfma_f32_16x16x32_bf16 v[80:83],v[116:119],a[188:191],v[80:83]
v_mfma_f32_16x16x32_bf16 v[88:91],v[116:119],a[212:215],v[88:91]
v_mfma_f32_16x16x32_bf16 v[96:99],v[116:119],a[236:239],v[96:99]
buffer_load_dwordx4 v7,s[4:7],s20 offen offset:1024 lds
s_waitcnt lgkmcnt(0)
v_mfma_f32_16x16x32_bf16 v[76:79],v[120:123],a[144:147],0
v_mfma_f32_16x16x32_bf16 v[84:87],v[120:123],a[168:171],0
v_mfma_f32_16x16x32_bf16 v[92:95],v[120:123],a[192:195],0
v_mfma_f32_16x16x32_bf16 v[100:103],v[120:123],a[216:219],0
v_fma_f32 v72,v72,s36,v13
v_fma_f32 v73,v73,s36,v13
v_mfma_f32_16x16x32_bf16 v[76:79],v[124:127],a[148:151],v[76:79]
v_fma_f32 v74,v74,s36,v13
v_fma_f32 v75,v75,s36,v13
v_mfma_f32_16x16x32_bf16 v[84:87],v[124:127],a[172:175],v[84:87]
v_fma_f32 v80,v80,s36,v14
v_fma_f32 v81,v81,s36,v14
v_mfma_f32_16x16x32_bf16 v[92:95],v[124:127],a[196:199],v[92:95]
v_exp_f32 v72,v72
v_mfma_f32_16x16x32_bf16 v[100:103],v[124:127],a[220:223],v[100:103]
v_exp_f32 v73,v73
v_mfma_f32_16x16x32_bf16 v[76:79],v[128:131],a[152:155],v[76:79]
buffer_load_dwordx4 v8,s[4:7],s20 offen offset:2048 lds
v_mfma_f32_16x16x32_bf16 v[84:87],v[128:131],a[176:179],v[84:87]
s_add_u32 s20,s20,12288
ds_read_b64_tr_b16 v[112:113],v2 offset:24576
v_mfma_f32_16x16x32_bf16 v[92:95],v[128:131],a[200:203],v[92:95]
ds_read_b64_tr_b16 v[114:115],v2 offset:30720
v_cvt_pk_bf16_f32 v22,v72,v73
v_mfma_f32_16x16x32_bf16 v[100:103],v[128:131],a[224:227],v[100:103]
ds_read_b64_tr_b16 v[116:117],v3 offset:24576
v_mfma_f32_16x16x32_bf16 v[76:79],v[132:135],a[156:159],v[76:79]
ds_read_b64_tr_b16 v[118:119],v3 offset:30720
v_mfma_f32_16x16x32_bf16 v[84:87],v[132:135],a[180:183],v[84:87]
ds_read_b64_tr_b16 v[120:121],v4 offset:24576
v_mfma_f32_16x16x32_bf16 v[92:95],v[132:135],a[204:207],v[92:95]
ds_read_b64_tr_b16 v[122:123],v4 offset:30720
v_mfma_f32_16x16x32_bf16 v[100:103],v[132:135],a[228:231],v[100:103]
ds_read_b64_tr_b16 v[124:125],v5 offset:24576
v_mfma_f32_16x16x32_bf16 v[76:79],v[136:139],a[160:163],v[76:79]
ds_read_b64_tr_b16 v[126:127],v5 offset:30720
v_mfma_f32_16x16x32_bf16 v[84:87],v[136:139],a[184:187],v[84:87]
v_exp_f32 v74,v74
v_mfma_f32_16x16x32_bf16 v[92:95],v[136:139],a[208:211],v[92:95]
v_exp_f32 v75,v75
v_mfma_f32_16x16x32_bf16 v[100:103],v[136:139],a[232:235],v[100:103]
v_exp_f32 v80,v80
v_mfma_f32_16x16x32_bf16 v[76:79],v[140:143],a[164:167],v[76:79]
v_exp_f32 v81,v81
v_mfma_f32_16x16x32_bf16 v[84:87],v[140:143],a[188:191],v[84:87]
v_cvt_pk_bf16_f32 v23,v74,v75
v_cvt_pk_bf16_f32 v28,v80,v81
v_mfma_f32_16x16x32_bf16 v[92:95],v[140:143],a[212:215],v[92:95]
v_mfma_f32_16x16x32_bf16 v[100:103],v[140:143],a[236:239],v[100:103]
s_mov_b32 s38,0
s_branch L_loop4
L_end5:
s_waitcnt lgkmcnt(4)
v_mfma_f32_16x16x32_bf16 v[160:163],v[112:115],v[18:21],v[160:163]
ds_read_b64_tr_b16 v[128:129],v2 offset:24704
ds_read_b64_tr_b16 v[130:131],v2 offset:30848
v_mfma_f32_16x16x32_bf16 v[208:211],v[112:115],v[24:27],v[208:211]
ds_read_b64_tr_b16 v[132:133],v3 offset:24704
ds_read_b64_tr_b16 v[134:135],v3 offset:30848
v_mfma_f32_16x16x32_bf16 a[0:3],v[112:115],v[30:33],a[0:3]
ds_read_b64_tr_b16 v[136:137],v4 offset:24704
ds_read_b64_tr_b16 v[138:139],v4 offset:30848
v_mfma_f32_16x16x32_bf16 a[48:51],v[112:115],v[36:39],a[48:51]
ds_read_b64_tr_b16 v[140:141],v5 offset:24704
ds_read_b64_tr_b16 v[142:143],v5 offset:30848
v_mfma_f32_16x16x32_bf16 a[96:99],v[112:115],v[42:45],a[96:99]
ds_read_b64_tr_b16 v[112:113],v2 offset:24832
ds_read_b64_tr_b16 v[114:115],v2 offset:30976
v_mfma_f32_16x16x32_bf16 v[164:167],v[116:119],v[18:21],v[164:167]
v_fma_f32 v90,v90,s36,v15
v_fma_f32 v91,v91,s36,v15
v_mfma_f32_16x16x32_bf16 v[212:215],v[116:119],v[24:27],v[212:215]
v_fma_f32 v96,v96,s36,v16
v_fma_f32 v97,v97,s36,v16
v_mfma_f32_16x16x32_bf16 a[4:7],v[116:119],v[30:33],a[4:7]
v_fma_f32 v98,v98,s36,v16
v_fma_f32 v99,v99,s36,v16
v_mfma_f32_16x16x32_bf16 a[52:55],v[116:119],v[36:39],a[52:55]
v_fma_f32 v104,v104,s36,v17
v_fma_f32 v105,v105,s36,v17
v_mfma_f32_16x16x32_bf16 a[100:103],v[116:119],v[42:45],a[100:103]
s_waitcnt lgkmcnt(8)
ds_read_b64_tr_b16 v[116:117],v3 offset:24832
ds_read_b64_tr_b16 v[118:119],v3 offset:30976
v_mfma_f32_16x16x32_bf16 v[168:171],v[120:123],v[18:21],v[168:171]
v_fma_f32 v106,v106,s36,v17
v_fma_f32 v107,v107,s36,v17
v_mfma_f32_16x16x32_bf16 v[216:219],v[120:123],v[24:27],v[216:219]
v_fma_f32 v76,v76,s36,v13
v_fma_f32 v77,v77,s36,v13
v_mfma_f32_16x16x32_bf16 a[8:11],v[120:123],v[30:33],a[8:11]
v_fma_f32 v78,v78,s36,v13
v_fma_f32 v79,v79,s36,v13
v_mfma_f32_16x16x32_bf16 a[56:59],v[120:123],v[36:39],a[56:59]
v_fma_f32 v84,v84,s36,v14
v_fma_f32 v85,v85,s36,v14
v_mfma_f32_16x16x32_bf16 a[104:107],v[120:123],v[42:45],a[104:107]
ds_read_b64_tr_b16 v[120:121],v4 offset:24832
ds_read_b64_tr_b16 v[122:123],v4 offset:30976
v_mfma_f32_16x16x32_bf16 v[172:175],v[124:127],v[18:21],v[172:175]
v_fma_f32 v86,v86,s36,v14
v_fma_f32 v87,v87,s36,v14
v_mfma_f32_16x16x32_bf16 v[220:223],v[124:127],v[24:27],v[220:223]
v_fma_f32 v92,v92,s36,v15
v_fma_f32 v93,v93,s36,v15
v_mfma_f32_16x16x32_bf16 a[12:15],v[124:127],v[30:33],a[12:15]
v_fma_f32 v94,v94,s36,v15
v_fma_f32 v95,v95,s36,v15
v_mfma_f32_16x16x32_bf16 a[60:63],v[124:127],v[36:39],a[60:63]
v_fma_f32 v100,v100,s36,v16
v_fma_f32 v101,v101,s36,v16
v_mfma_f32_16x16x32_bf16 a[108:111],v[124:127],v[42:45],a[108:111]
ds_read_b64_tr_b16 v[124:125],v5 offset:24832
ds_read_b64_tr_b16 v[126:127],v5 offset:30976
v_mfma_f32_16x16x32_bf16 v[176:179],v[128:131],v[18:21],v[176:179]
v_fma_f32 v102,v102,s36,v16
v_fma_f32 v103,v103,s36,v16
v_mfma_f32_16x16x32_bf16 v[224:227],v[128:131],v[24:27],v[224:227]
v_fma_f32 v108,v108,s36,v17
v_fma_f32 v109,v109,s36,v17
v_mfma_f32_16x16x32_bf16 a[16:19],v[128:131],v[30:33],a[16:19]
v_fma_f32 v110,v110,s36,v17
v_fma_f32 v111,v111,s36,v17
v_mfma_f32_16x16x32_bf16 a[64:67],v[128:131],v[36:39],a[64:67]
v_exp_f32 v90,v90
v_mfma_f32_16x16x32_bf16 a[112:115],v[128:131],v[42:45],a[112:115]
s_waitcnt lgkmcnt(2)
v_exp_f32 v91,v91
v_mfma_f32_16x16x32_bf16 v[180:183],v[132:135],v[18:21],v[180:183]
v_exp_f32 v96,v96
v_mfma_f32_16x16x32_bf16 v[228:231],v[132:135],v[24:27],v[228:231]
v_exp_f32 v97,v97
v_mfma_f32_16x16x32_bf16 a[20:23],v[132:135],v[30:33],a[20:23]
v_exp_f32 v98,v98
v_mfma_f32_16x16x32_bf16 a[68:71],v[132:135],v[36:39],a[68:71]
v_exp_f32 v99,v99
v_mfma_f32_16x16x32_bf16 a[116:119],v[132:135],v[42:45],a[116:119]
v_exp_f32 v104,v104
v_mfma_f32_16x16x32_bf16 v[184:187],v[136:139],v[18:21],v[184:187]
v_exp_f32 v105,v105
v_mfma_f32_16x16x32_bf16 v[232:235],v[136:139],v[24:27],v[232:235]
v_exp_f32 v106,v106
v_mfma_f32_16x16x32_bf16 a[24:27],v[136:139],v[30:33],a[24:27]
v_exp_f32 v107,v107
v_mfma_f32_16x16x32_bf16 a[72:75],v[136:139],v[36:39],a[72:75]
v_exp_f32 v76,v76
v_mfma_f32_16x16x32_bf16 a[120:123],v[136:139],v[42:45],a[120:123]
v_exp_f32 v77,v77
v_mfma_f32_16x16x32_bf16 v[188:191],v[140:143],v[18:21],v[188:191]
v_exp_f32 v78,v78
v_mfma_f32_16x16x32_bf16 v[236:239],v[140:143],v[24:27],v[236:239]
v_exp_f32 v79,v79
v_mfma_f32_16x16x32_bf16 a[28:31],v[140:143],v[30:33],a[28:31]
v_exp_f32 v84,v84
v_mfma_f32_16x16x32_bf16 a[76:79],v[140:143],v[36:39],a[76:79]
v_exp_f32 v85,v85
v_mfma_f32_16x16x32_bf16 a[124:127],v[140:143],v[42:45],a[124:127]
v_exp_f32 v86,v86
v_mfma_f32_16x16x32_bf16 v[192:195],v[112:115],v[18:21],v[192:195]
v_exp_f32 v87,v87
v_mfma_f32_16x16x32_bf16 v[240:243],v[112:115],v[24:27],v[240:243]
v_exp_f32 v92,v92
v_mfma_f32_16x16x32_bf16 a[32:35],v[112:115],v[30:33],a[32:35]
v_exp_f32 v93,v93
v_mfma_f32_16x16x32_bf16 a[80:83],v[112:115],v[36:39],a[80:83]
v_exp_f32 v94,v94
v_mfma_f32_16x16x32_bf16 a[128:131],v[112:115],v[42:45],a[128:131]
v_exp_f32 v95,v95
v_mfma_f32_16x16x32_bf16 v[196:199],v[116:119],v[18:21],v[196:199]
v_exp_f32 v100,v100
v_mfma_f32_16x16x32_bf16 v[244:247],v[116:119],v[24:27],v[244:247]
v_exp_f32 v101,v101
v_mfma_f32_16x16x32_bf16 a[36:39],v[116:119],v[30:33],a[36:39]
v_exp_f32 v102,v102
v_mfma_f32_16x16x32_bf16 a[84:87],v[116:119],v[36:39],a[84:87]
v_exp_f32 v103,v103
v_mfma_f32_16x16x32_bf16 a[132:135],v[116:119],v[42:45],a[132:135]
v_exp_f32 v108,v108
s_waitcnt vmcnt(14) lgkmcnt(0)
s_barrier
v_mfma_f32_16x16x32_bf16 v[200:203],v[120:123],v[18:21],v[200:203]
v_exp_f32 v109,v109
v_mfma_f32_16x16x32_bf16 v[248:251],v[120:123],v[24:27],v[248:251]
v_exp_f32 v110,v110
v_mfma_f32_16x16x32_bf16 a[40:43],v[120:123],v[30:33],a[40:43]
v_exp_f32 v111,v111
v_mfma_f32_16x16x32_bf16 a[88:91],v[120:123],v[36:39],a[88:91]
v_cvt_pk_bf16_f32 v35,v90,v91
v_cvt_pk_bf16_f32 v40,v96,v97
v_mfma_f32_16x16x32_bf16 a[136:139],v[120:123],v[42:45],a[136:139]
v_cvt_pk_bf16_f32 v41,v98,v99
v_cvt_pk_bf16_f32 v46,v104,v105
v_mfma_f32_16x16x32_bf16 v[204:207],v[124:127],v[18:21],v[204:207]
v_cvt_pk_bf16_f32 v47,v106,v107
v_cvt_pk_bf16_f32 v20,v76,v77
v_mfma_f32_16x16x32_bf16 v[252:255],v[124:127],v[24:27],v[252:255]
v_cvt_pk_bf16_f32 v21,v78,v79
v_cvt_pk_bf16_f32 v26,v84,v85
v_mfma_f32_16x16x32_bf16 a[44:47],v[124:127],v[30:33],a[44:47]
v_cvt_pk_bf16_f32 v27,v86,v87
v_cvt_pk_bf16_f32 v32,v92,v93
v_mfma_f32_16x16x32_bf16 v[52:55],v[48:51],v[20:23],v[52:55]
v_cvt_pk_bf16_f32 v33,v94,v95
v_subrev_u32 v10,18432,v10
v_mfma_f32_16x16x32_bf16 v[56:59],v[48:51],v[26:29],v[56:59]
v_mfma_f32_16x16x32_bf16 v[60:63],v[48:51],v[32:35],v[60:63]
v_mfma_f32_16x16x32_bf16 a[92:95],v[124:127],v[36:39],a[92:95]
v_cvt_pk_bf16_f32 v38,v100,v101
v_cvt_pk_bf16_f32 v39,v102,v103
v_mfma_f32_16x16x32_bf16 a[140:143],v[124:127],v[42:45],a[140:143]
v_cvt_pk_bf16_f32 v44,v108,v109
v_cvt_pk_bf16_f32 v45,v110,v111
v_mfma_f32_16x16x32_bf16 v[64:67],v[48:51],v[38:41],v[64:67]
ds_read_b64_tr_b16 v[128:129],v2 offset:6144
v_mfma_f32_16x16x32_bf16 v[68:71],v[48:51],v[44:47],v[68:71]
ds_read_b64_tr_b16 v[130:131],v2 offset:0
ds_read_b64_tr_b16 v[132:133],v3 offset:6144
ds_read_b64_tr_b16 v[134:135],v3 offset:0
ds_read_b64_tr_b16 v[136:137],v4 offset:6144
ds_read_b64_tr_b16 v[138:139],v4 offset:0
ds_read_b64_tr_b16 v[140:141],v5 offset:6144
ds_read_b64_tr_b16 v[142:143],v5 offset:0
s_waitcnt lgkmcnt(6)
v_mfma_f32_16x16x32_bf16 v[160:163],v[128:131],v[20:23],v[160:163]
s_waitcnt vmcnt(6)
ds_read_b64_tr_b16 v[112:113],v2 offset:6272
ds_read_b64_tr_b16 v[114:115],v2 offset:128
v_mfma_f32_16x16x32_bf16 v[208:211],v[128:131],v[26:29],v[208:211]
s_add_u32 s84,s42,0
ds_read_b64_tr_b16 v[116:117],v3 offset:6272
ds_read_b64_tr_b16 v[118:119],v3 offset:128
v_mfma_f32_16x16x32_bf16 a[0:3],v[128:131],v[32:35],a[0:3]
s_add_u32 s85,s42,6144
ds_read_b64_tr_b16 v[120:121],v4 offset:6272
ds_read_b64_tr_b16 v[122:123],v4 offset:128
v_mfma_f32_16x16x32_bf16 a[48:51],v[128:131],v[38:41],a[48:51]
s_add_u32 s86,s42,12288
ds_read_b64_tr_b16 v[124:125],v5 offset:6272
ds_read_b64_tr_b16 v[126:127],v5 offset:128
v_mfma_f32_16x16x32_bf16 a[96:99],v[128:131],v[44:47],a[96:99]
s_add_u32 s87,s42,18432
ds_read_b64_tr_b16 v[128:129],v2 offset:6400
ds_read_b64_tr_b16 v[130:131],v2 offset:256
s_waitcnt lgkmcnt(14)
v_mfma_f32_16x16x32_bf16 v[164:167],v[132:135],v[20:23],v[164:167]
s_add_u32 s66,s42,24576
v_mbcnt_lo_u32_b32 v57,-1,0
v_mbcnt_hi_u32_b32 v57,-1,v57
v_mfma_f32_16x16x32_bf16 v[212:215],v[132:135],v[26:29],v[212:215]
v_and_b32 v61,7,v57
v_lshrrev_b32 v53,5,v57
v_mfma_f32_16x16x32_bf16 a[4:7],v[132:135],v[32:35],a[4:7]
v_xor_b32 v61,v61,v53
v_and_b32 v53,15,v57
v_lshl_add_u32 v53,v53,7,s24
v_lshl_add_u32 v53,v61,4,v53
v_bfe_u32 v61,v57,4,1
v_lshl_add_u32 v36,v61,3,v53
v_xor_b32 v37,32,v36
v_xor_b32 v42,64,v36
v_xor_b32 v43,96,v36
v_bfe_u32 v53,v57,3,1
v_lshlrev_b32 v53,11,v53
v_rcp_f32 v66,v64
v_rcp_f32 v70,v68
v_accvgpr_read_b32 v72,a48
v_accvgpr_read_b32 v73,a49
v_pk_mul_f32 v[72:73],v[72:73],v[66:67] op_sel_hi:[1,0]
v_accvgpr_read_b32 v74,a50
v_accvgpr_read_b32 v75,a51
v_pk_mul_f32 v[74:75],v[74:75],v[66:67] op_sel_hi:[1,0]
v_accvgpr_read_b32 v76,a96
v_accvgpr_read_b32 v77,a97
v_pk_mul_f32 v[76:77],v[76:77],v[70:71] op_sel_hi:[1,0]
v_accvgpr_read_b32 v78,a98
v_accvgpr_read_b32 v79,a99
v_pk_mul_f32 v[78:79],v[78:79],v[70:71] op_sel_hi:[1,0]
v_cvt_pk_bf16_f32 v72,v72,v73
v_cvt_pk_bf16_f32 v76,v76,v77
v_mfma_f32_16x16x32_bf16 a[52:55],v[132:135],v[38:41],a[52:55]
v_cvt_pk_bf16_f32 v73,v74,v75
v_cvt_pk_bf16_f32 v77,v78,v79
v_mfma_f32_16x16x32_bf16 a[100:103],v[132:135],v[44:47],a[100:103]
s_waitcnt lgkmcnt(0)
ds_read_b64_tr_b16 v[132:133],v3 offset:6400
ds_read_b64_tr_b16 v[134:135],v3 offset:256
v_mfma_f32_16x16x32_bf16 v[168:171],v[136:139],v[20:23],v[168:171]
ds_write2st64_b64 v36,v[72:73],v[76:77] offset0:36 offset1:40
v_mfma_f32_16x16x32_bf16 v[216:219],v[136:139],v[26:29],v[216:219]
v_accvgpr_read_b32 v80,a52
v_accvgpr_read_b32 v81,a53
v_mfma_f32_16x16x32_bf16 a[8:11],v[136:139],v[32:35],a[8:11]
v_accvgpr_read_b32 v82,a54
v_accvgpr_read_b32 v83,a55
v_accvgpr_read_b32 v84,a100
v_accvgpr_read_b32 v85,a101
v_accvgpr_read_b32 v86,a102
v_pk_mul_f32 v[80:81],v[80:81],v[66:67] op_sel_hi:[1,0]
v_pk_mul_f32 v[82:83],v[82:83],v[66:67] op_sel_hi:[1,0]
v_pk_mul_f32 v[84:85],v[84:85],v[70:71] op_sel_hi:[1,0]
v_accvgpr_read_b32 v87,a103
v_pk_mul_f32 v[86:87],v[86:87],v[70:71] op_sel_hi:[1,0]
v_cvt_pk_bf16_f32 v80,v80,v81
v_cvt_pk_bf16_f32 v84,v84,v85
v_mfma_f32_16x16x32_bf16 a[56:59],v[136:139],v[38:41],a[56:59]
v_cvt_pk_bf16_f32 v81,v82,v83
v_cvt_pk_bf16_f32 v85,v86,v87
v_mfma_f32_16x16x32_bf16 a[104:107],v[136:139],v[44:47],a[104:107]
ds_read_b64_tr_b16 v[136:137],v4 offset:6400
ds_read_b64_tr_b16 v[138:139],v4 offset:256
v_mfma_f32_16x16x32_bf16 v[172:175],v[140:143],v[20:23],v[172:175]
ds_write2st64_b64 v37,v[80:81],v[84:85] offset0:36 offset1:40
v_mfma_f32_16x16x32_bf16 v[220:223],v[140:143],v[26:29],v[220:223]
v_accvgpr_read_b32 v88,a56
v_accvgpr_read_b32 v89,a57
v_mfma_f32_16x16x32_bf16 a[12:15],v[140:143],v[32:35],a[12:15]
v_accvgpr_read_b32 v90,a58
v_accvgpr_read_b32 v91,a59
v_accvgpr_read_b32 v92,a104
v_accvgpr_read_b32 v93,a105
v_accvgpr_read_b32 v94,a106
v_pk_mul_f32 v[88:89],v[88:89],v[66:67] op_sel_hi:[1,0]
v_pk_mul_f32 v[90:91],v[90:91],v[66:67] op_sel_hi:[1,0]
v_pk_mul_f32 v[92:93],v[92:93],v[70:71] op_sel_hi:[1,0]
v_accvgpr_read_b32 v95,a107
v_pk_mul_f32 v[94:95],v[94:95],v[70:71] op_sel_hi:[1,0]
v_cvt_pk_bf16_f32 v88,v88,v89
v_cvt_pk_bf16_f32 v92,v92,v93
v_mfma_f32_16x16x32_bf16 a[60:63],v[140:143],v[38:41],a[60:63]
v_cvt_pk_bf16_f32 v89,v90,v91
v_cvt_pk_bf16_f32 v93,v94,v95
v_mfma_f32_16x16x32_bf16 a[108:111],v[140:143],v[44:47],a[108:111]
ds_read_b64_tr_b16 v[140:141],v5 offset:6400
ds_read_b64_tr_b16 v[142:143],v5 offset:256
v_mfma_f32_16x16x32_bf16 v[176:179],v[112:115],v[20:23],v[176:179]
ds_write2st64_b64 v42,v[88:89],v[92:93] offset0:36 offset1:40
v_mfma_f32_16x16x32_bf16 v[224:227],v[112:115],v[26:29],v[224:227]
v_accvgpr_read_b32 v96,a60
v_accvgpr_read_b32 v97,a61
v_mfma_f32_16x16x32_bf16 a[16:19],v[112:115],v[32:35],a[16:19]
v_accvgpr_read_b32 v98,a62
v_accvgpr_read_b32 v99,a63
v_accvgpr_read_b32 v100,a108
v_accvgpr_read_b32 v101,a109
v_accvgpr_read_b32 v102,a110
v_pk_mul_f32 v[96:97],v[96:97],v[66:67] op_sel_hi:[1,0]
v_pk_mul_f32 v[98:99],v[98:99],v[66:67] op_sel_hi:[1,0]
v_pk_mul_f32 v[100:101],v[100:101],v[70:71] op_sel_hi:[1,0]
v_accvgpr_read_b32 v103,a111
v_pk_mul_f32 v[102:103],v[102:103],v[70:71] op_sel_hi:[1,0]
v_cvt_pk_bf16_f32 v96,v96,v97
v_cvt_pk_bf16_f32 v100,v100,v101
v_mfma_f32_16x16x32_bf16 a[64:67],v[112:115],v[38:41],a[64:67]
v_max3_f32 v152,v52,v56,v60
v_cvt_pk_bf16_f32 v97,v98,v99
v_mfma_f32_16x16x32_bf16 a[112:115],v[112:115],v[44:47],a[112:115]
v_cvt_pk_bf16_f32 v101,v102,v103
v_max3_f32 v152,v152,v64,v68
v_mfma_f32_16x16x32_bf16 v[180:183],v[116:119],v[20:23],v[180:183]
ds_write2st64_b64 v43,v[96:97],v[100:101] offset0:36 offset1:40
v_mfma_f32_16x16x32_bf16 v[228:231],v[116:119],v[26:29],v[228:231]
v_accvgpr_read_b32 v72,a64
v_accvgpr_read_b32 v73,a65
v_mfma_f32_16x16x32_bf16 a[20:23],v[116:119],v[32:35],a[20:23]
v_accvgpr_read_b32 v74,a66
v_accvgpr_read_b32 v75,a67
v_accvgpr_read_b32 v76,a112
v_accvgpr_read_b32 v77,a113
v_accvgpr_read_b32 v78,a114
v_pk_mul_f32 v[72:73],v[72:73],v[66:67] op_sel_hi:[1,0]
v_pk_mul_f32 v[74:75],v[74:75],v[66:67] op_sel_hi:[1,0]
v_pk_mul_f32 v[76:77],v[76:77],v[70:71] op_sel_hi:[1,0]
v_accvgpr_read_b32 v79,a115
v_pk_mul_f32 v[78:79],v[78:79],v[70:71] op_sel_hi:[1,0]
v_cmp_ngt_f32 vcc,s37,v152
v_cvt_pk_bf16_f32 v72,v72,v73
v_mfma_f32_16x16x32_bf16 a[68:71],v[116:119],v[38:41],a[68:71]
ds_read_b128 v[152:155],v10 offset:18432
v_cvt_pk_bf16_f32 v76,v76,v77
v_mfma_f32_16x16x32_bf16 a[116:119],v[116:119],v[44:47],a[116:119]
s_cmp_lg_u64 vcc,0
ds_read_b128 v[156:159],v10 offset:19456
v_cvt_pk_bf16_f32 v73,v74,v75
v_mfma_f32_16x16x32_bf16 v[184:187],v[120:123],v[20:23],v[184:187]
s_cselect_b32 s62,s32,0
ds_read_b128 v[104:107],v10 offset:20480
v_accvgpr_read_b32 v80,a68
v_mfma_f32_16x16x32_bf16 v[232:235],v[120:123],v[26:29],v[232:235]
s_or_b32 s31,s31,s62
ds_read_b128 v[108:111],v10 offset:21504
v_accvgpr_read_b32 v81,a69
v_mfma_f32_16x16x32_bf16 a[24:27],v[120:123],v[32:35],a[24:27]
s_lshl_b32 s32,s32,1
v_accvgpr_read_b32 v82,a70
v_accvgpr_read_b32 v83,a71
v_accvgpr_read_b32 v84,a116
v_accvgpr_read_b32 v85,a117
v_accvgpr_read_b32 v86,a118
v_pk_mul_f32 v[80:81],v[80:81],v[66:67] op_sel_hi:[1,0]
v_pk_mul_f32 v[82:83],v[82:83],v[66:67] op_sel_hi:[1,0]
v_pk_mul_f32 v[84:85],v[84:85],v[70:71] op_sel_hi:[1,0]
v_accvgpr_read_b32 v87,a119
v_pk_mul_f32 v[86:87],v[86:87],v[70:71] op_sel_hi:[1,0]
v_cvt_pk_bf16_f32 v77,v78,v79
v_cvt_pk_bf16_f32 v80,v80,v81
v_mfma_f32_16x16x32_bf16 a[72:75],v[120:123],v[38:41],a[72:75]
ds_write2st64_b64 v36,v[72:73],v[76:77] offset0:36 offset1:40
v_mfma_f32_16x16x32_bf16 a[120:123],v[120:123],v[44:47],a[120:123]
v_cvt_pk_bf16_f32 v84,v84,v85
v_cvt_pk_bf16_f32 v81,v82,v83
v_mfma_f32_16x16x32_bf16 v[188:191],v[124:127],v[20:23],v[188:191]
s_waitcnt lgkmcnt(3)
buffer_store_dwordx4 v[152:155],v9,s[16:19],s87 offen offset:0 nt
v_cvt_pk_bf16_f32 v85,v86,v87
v_rcp_f32 v58,v56
v_mfma_f32_16x16x32_bf16 v[236:239],v[124:127],v[26:29],v[236:239]
v_accvgpr_read_b32 v88,a72
v_accvgpr_read_b32 v89,a73
v_mfma_f32_16x16x32_bf16 a[28:31],v[124:127],v[32:35],a[28:31]
v_accvgpr_read_b32 v90,a74
ds_write2st64_b64 v37,v[80:81],v[84:85] offset0:36 offset1:40
v_pk_mul_f32 v[88:89],v[88:89],v[66:67] op_sel_hi:[1,0]
v_accvgpr_read_b32 v91,a75
v_pk_mul_f32 v[90:91],v[90:91],v[66:67] op_sel_hi:[1,0]
buffer_store_dwordx4 v[156:159],v9,s[16:19],s87 offen offset:3072 nt
v_accvgpr_read_b32 v92,a120
v_accvgpr_read_b32 v93,a121
v_pk_mul_f32 v[92:93],v[92:93],v[70:71] op_sel_hi:[1,0]
v_accvgpr_read_b32 v94,a122
v_accvgpr_read_b32 v95,a123
v_pk_mul_f32 v[94:95],v[94:95],v[70:71] op_sel_hi:[1,0]
v_cvt_pk_bf16_f32 v88,v88,v89
v_cvt_pk_bf16_f32 v92,v92,v93
v_mfma_f32_16x16x32_bf16 a[76:79],v[124:127],v[38:41],a[76:79]
v_cvt_pk_bf16_f32 v89,v90,v91
v_cvt_pk_bf16_f32 v93,v94,v95
v_mfma_f32_16x16x32_bf16 a[124:127],v[124:127],v[44:47],a[124:127]
ds_write2st64_b64 v42,v[88:89],v[92:93] offset0:36 offset1:40
v_mfma_f32_16x16x32_bf16 v[192:195],v[128:131],v[20:23],v[192:195]
v_rcp_f32 v62,v60
v_mfma_f32_16x16x32_bf16 v[240:243],v[128:131],v[26:29],v[240:243]
s_waitcnt lgkmcnt(1)
buffer_store_dwordx4 v[104:107],v9,s[16:19],s66 offen offset:0 nt
v_accvgpr_read_b32 v96,a76
v_accvgpr_read_b32 v97,a77
v_accvgpr_read_b32 v98,a78
v_mfma_f32_16x16x32_bf16 a[32:35],v[128:131],v[32:35],a[32:35]
v_accvgpr_read_b32 v99,a79
v_accvgpr_read_b32 v100,a124
v_accvgpr_read_b32 v101,a125
v_accvgpr_read_b32 v102,a126
v_accvgpr_read_b32 v103,a127
v_pk_mul_f32 v[96:97],v[96:97],v[66:67] op_sel_hi:[1,0]
buffer_store_dwordx4 v[108:111],v9,s[16:19],s66 offen offset:3072 nt
v_pk_mul_f32 v[98:99],v[98:99],v[66:67] op_sel_hi:[1,0]
v_pk_mul_f32 v[100:101],v[100:101],v[70:71] op_sel_hi:[1,0]
v_pk_mul_f32 v[102:103],v[102:103],v[70:71] op_sel_hi:[1,0]
v_cvt_pk_bf16_f32 v96,v96,v97
v_cvt_pk_bf16_f32 v100,v100,v101
v_mfma_f32_16x16x32_bf16 a[80:83],v[128:131],v[38:41],a[80:83]
v_cvt_pk_bf16_f32 v97,v98,v99
v_cvt_pk_bf16_f32 v101,v102,v103
v_mfma_f32_16x16x32_bf16 a[128:131],v[128:131],v[44:47],a[128:131]
ds_write2st64_b64 v43,v[96:97],v[100:101] offset0:36 offset1:40
v_mfma_f32_16x16x32_bf16 v[196:199],v[132:135],v[20:23],v[196:199]
v_rcp_f32 v54,v52
v_mfma_f32_16x16x32_bf16 v[244:247],v[132:135],v[26:29],v[244:247]
ds_read_b128 v[72:75],v10 offset:18432
v_accvgpr_read_b32 v80,a80
v_mfma_f32_16x16x32_bf16 a[36:39],v[132:135],v[32:35],a[36:39]
ds_read_b128 v[76:79],v10 offset:19456
ds_read_b128 v[152:155],v10 offset:20480
v_accvgpr_read_b32 v81,a81
ds_read_b128 v[156:159],v10 offset:21504
v_pk_mul_f32 v[80:81],v[80:81],v[66:67] op_sel_hi:[1,0]
v_accvgpr_read_b32 v82,a82
v_accvgpr_read_b32 v83,a83
v_pk_mul_f32 v[82:83],v[82:83],v[66:67] op_sel_hi:[1,0]
v_accvgpr_read_b32 v84,a128
v_accvgpr_read_b32 v85,a129
v_pk_mul_f32 v[84:85],v[84:85],v[70:71] op_sel_hi:[1,0]
v_accvgpr_read_b32 v86,a130
v_accvgpr_read_b32 v87,a131
v_pk_mul_f32 v[86:87],v[86:87],v[70:71] op_sel_hi:[1,0]
v_cvt_pk_bf16_f32 v80,v80,v81
v_cvt_pk_bf16_f32 v84,v84,v85
v_mfma_f32_16x16x32_bf16 a[84:87],v[132:135],v[38:41],a[84:87]
v_cvt_pk_bf16_f32 v81,v82,v83
v_cvt_pk_bf16_f32 v85,v86,v87
v_mfma_f32_16x16x32_bf16 a[132:135],v[132:135],v[44:47],a[132:135]
ds_write2st64_b64 v36,v[80:81],v[84:85] offset0:36 offset1:40
v_mfma_f32_16x16x32_bf16 v[200:203],v[136:139],v[20:23],v[200:203]
v_add_u32 v36,v36,v53
v_mfma_f32_16x16x32_bf16 v[248:251],v[136:139],v[26:29],v[248:251]
s_waitcnt lgkmcnt(3)
buffer_store_dwordx4 v[72:75],v9,s[16:19],s87 offen offset:128 nt
v_accvgpr_read_b32 v104,a84
v_accvgpr_read_b32 v105,a85
v_accvgpr_read_b32 v106,a86
v_mfma_f32_16x16x32_bf16 a[40:43],v[136:139],v[32:35],a[40:43]
v_accvgpr_read_b32 v107,a87
v_accvgpr_read_b32 v108,a132
v_accvgpr_read_b32 v109,a133
v_accvgpr_read_b32 v110,a134
v_accvgpr_read_b32 v111,a135
v_pk_mul_f32 v[104:105],v[104:105],v[66:67] op_sel_hi:[1,0]
buffer_store_dwordx4 v[76:79],v9,s[16:19],s87 offen offset:3200 nt
v_pk_mul_f32 v[106:107],v[106:107],v[66:67] op_sel_hi:[1,0]
v_pk_mul_f32 v[108:109],v[108:109],v[70:71] op_sel_hi:[1,0]
v_pk_mul_f32 v[110:111],v[110:111],v[70:71] op_sel_hi:[1,0]
v_cvt_pk_bf16_f32 v104,v104,v105
v_cvt_pk_bf16_f32 v108,v108,v109
v_mfma_f32_16x16x32_bf16 a[88:91],v[136:139],v[38:41],a[88:91]
v_cvt_pk_bf16_f32 v105,v106,v107
v_cvt_pk_bf16_f32 v109,v110,v111
v_mfma_f32_16x16x32_bf16 a[136:139],v[136:139],v[44:47],a[136:139]
ds_write2st64_b64 v37,v[104:105],v[108:109] offset0:36 offset1:40
v_mfma_f32_16x16x32_bf16 v[204:207],v[140:143],v[20:23],v[204:207]
v_add_u32 v37,v37,v53
v_mfma_f32_16x16x32_bf16 v[252:255],v[140:143],v[26:29],v[252:255]
s_waitcnt lgkmcnt(1)
buffer_store_dwordx4 v[152:155],v9,s[16:19],s66 offen offset:128 nt
v_accvgpr_read_b32 v88,a88
v_accvgpr_read_b32 v89,a89
v_accvgpr_read_b32 v90,a90
v_mfma_f32_16x16x32_bf16 a[44:47],v[140:143],v[32:35],a[44:47]
v_accvgpr_read_b32 v91,a91
v_accvgpr_read_b32 v92,a136
v_accvgpr_read_b32 v93,a137
v_accvgpr_read_b32 v94,a138
v_accvgpr_read_b32 v95,a139
v_pk_mul_f32 v[88:89],v[88:89],v[66:67] op_sel_hi:[1,0]
buffer_store_dwordx4 v[156:159],v9,s[16:19],s66 offen offset:3200 nt
v_pk_mul_f32 v[90:91],v[90:91],v[66:67] op_sel_hi:[1,0]
v_pk_mul_f32 v[92:93],v[92:93],v[70:71] op_sel_hi:[1,0]
v_pk_mul_f32 v[94:95],v[94:95],v[70:71] op_sel_hi:[1,0]
v_cvt_pk_bf16_f32 v88,v88,v89
v_cvt_pk_bf16_f32 v92,v92,v93
v_mfma_f32_16x16x32_bf16 a[92:95],v[140:143],v[38:41],a[92:95]
v_cvt_pk_bf16_f32 v89,v90,v91
v_cvt_pk_bf16_f32 v93,v94,v95
v_mfma_f32_16x16x32_bf16 a[140:143],v[140:143],v[44:47],a[140:143]
ds_write2st64_b64 v42,v[88:89],v[92:93] offset0:36 offset1:40
v_pk_mul_f32 v[208:209],v[208:209],v[58:59] op_sel_hi:[1,0]
v_pk_mul_f32 v[224:225],v[224:225],v[58:59] op_sel_hi:[1,0]
v_pk_mul_f32 v[210:211],v[210:211],v[58:59] op_sel_hi:[1,0]
v_pk_mul_f32 v[226:227],v[226:227],v[58:59] op_sel_hi:[1,0]
v_pk_mul_f32 v[212:213],v[212:213],v[58:59] op_sel_hi:[1,0]
v_pk_mul_f32 v[228:229],v[228:229],v[58:59] op_sel_hi:[1,0]
v_pk_mul_f32 v[214:215],v[214:215],v[58:59] op_sel_hi:[1,0]
v_pk_mul_f32 v[230:231],v[230:231],v[58:59] op_sel_hi:[1,0]
v_pk_mul_f32 v[216:217],v[216:217],v[58:59] op_sel_hi:[1,0]
v_pk_mul_f32 v[232:233],v[232:233],v[58:59] op_sel_hi:[1,0]
v_pk_mul_f32 v[218:219],v[218:219],v[58:59] op_sel_hi:[1,0]
v_pk_mul_f32 v[234:235],v[234:235],v[58:59] op_sel_hi:[1,0]
v_pk_mul_f32 v[220:221],v[220:221],v[58:59] op_sel_hi:[1,0]
v_pk_mul_f32 v[236:237],v[236:237],v[58:59] op_sel_hi:[1,0]
v_pk_mul_f32 v[222:223],v[222:223],v[58:59] op_sel_hi:[1,0]
v_pk_mul_f32 v[238:239],v[238:239],v[58:59] op_sel_hi:[1,0]
v_pk_mul_f32 v[240:241],v[240:241],v[58:59] op_sel_hi:[1,0]
v_pk_mul_f32 v[242:243],v[242:243],v[58:59] op_sel_hi:[1,0]
v_pk_mul_f32 v[244:245],v[244:245],v[58:59] op_sel_hi:[1,0]
v_pk_mul_f32 v[246:247],v[246:247],v[58:59] op_sel_hi:[1,0]
v_pk_mul_f32 v[248:249],v[248:249],v[58:59] op_sel_hi:[1,0]
v_pk_mul_f32 v[250:251],v[250:251],v[58:59] op_sel_hi:[1,0]
v_pk_mul_f32 v[252:253],v[252:253],v[58:59] op_sel_hi:[1,0]
v_pk_mul_f32 v[254:255],v[254:255],v[58:59] op_sel_hi:[1,0]
v_pk_mul_f32 v[160:161],v[160:161],v[54:55] op_sel_hi:[1,0]
v_pk_mul_f32 v[176:177],v[176:177],v[54:55] op_sel_hi:[1,0]
v_pk_mul_f32 v[162:163],v[162:163],v[54:55] op_sel_hi:[1,0]
v_pk_mul_f32 v[178:179],v[178:179],v[54:55] op_sel_hi:[1,0]
v_pk_mul_f32 v[164:165],v[164:165],v[54:55] op_sel_hi:[1,0]
v_pk_mul_f32 v[180:181],v[180:181],v[54:55] op_sel_hi:[1,0]
v_pk_mul_f32 v[166:167],v[166:167],v[54:55] op_sel_hi:[1,0]
v_pk_mul_f32 v[182:183],v[182:183],v[54:55] op_sel_hi:[1,0]
v_pk_mul_f32 v[168:169],v[168:169],v[54:55] op_sel_hi:[1,0]
v_pk_mul_f32 v[184:185],v[184:185],v[54:55] op_sel_hi:[1,0]
v_pk_mul_f32 v[170:171],v[170:171],v[54:55] op_sel_hi:[1,0]
v_pk_mul_f32 v[186:187],v[186:187],v[54:55] op_sel_hi:[1,0]
v_pk_mul_f32 v[172:173],v[172:173],v[54:55] op_sel_hi:[1,0]
v_pk_mul_f32 v[188:189],v[188:189],v[54:55] op_sel_hi:[1,0]
v_pk_mul_f32 v[174:175],v[174:175],v[54:55] op_sel_hi:[1,0]
v_pk_mul_f32 v[190:191],v[190:191],v[54:55] op_sel_hi:[1,0]
v_pk_mul_f32 v[192:193],v[192:193],v[54:55] op_sel_hi:[1,0]
v_pk_mul_f32 v[194:195],v[194:195],v[54:55] op_sel_hi:[1,0]
v_pk_mul_f32 v[196:197],v[196:197],v[54:55] op_sel_hi:[1,0]
v_pk_mul_f32 v[198:199],v[198:199],v[54:55] op_sel_hi:[1,0]
v_pk_mul_f32 v[200:201],v[200:201],v[54:55] op_sel_hi:[1,0]
v_pk_mul_f32 v[202:203],v[202:203],v[54:55] op_sel_hi:[1,0]
v_pk_mul_f32 v[204:205],v[204:205],v[54:55] op_sel_hi:[1,0]
v_pk_mul_f32 v[206:207],v[206:207],v[54:55] op_sel_hi:[1,0]
v_add_u32 v42,v42,v53
v_accvgpr_read_b32 v96,a92
v_accvgpr_read_b32 v97,a93
v_pk_mul_f32 v[96:97],v[96:97],v[66:67] op_sel_hi:[1,0]
v_accvgpr_read_b32 v100,a140
v_accvgpr_read_b32 v101,a141
v_pk_mul_f32 v[100:101],v[100:101],v[70:71] op_sel_hi:[1,0]
v_accvgpr_read_b32 v98,a94
v_accvgpr_read_b32 v99,a95
v_pk_mul_f32 v[98:99],v[98:99],v[66:67] op_sel_hi:[1,0]
v_accvgpr_read_b32 v102,a142
v_accvgpr_read_b32 v103,a143
v_pk_mul_f32 v[102:103],v[102:103],v[70:71] op_sel_hi:[1,0]
v_cvt_pk_bf16_f32 v96,v96,v97
v_cvt_pk_bf16_f32 v100,v100,v101
v_cvt_pk_bf16_f32 v97,v98,v99
v_cvt_pk_bf16_f32 v101,v102,v103
ds_write2st64_b64 v43,v[96:97],v[100:101] offset0:36 offset1:40
v_add_u32 v43,v43,v53
v_cvt_pk_bf16_f32 v208,v208,v209
v_cvt_pk_bf16_f32 v224,v224,v225
ds_read_b128 v[80:83],v10 offset:18432
ds_read_b128 v[84:87],v10 offset:19456
v_cvt_pk_bf16_f32 v212,v212,v213
ds_read_b128 v[152:155],v10 offset:20480
v_cvt_pk_bf16_f32 v228,v228,v229
ds_read_b128 v[156:159],v10 offset:21504
v_cvt_pk_bf16_f32 v209,v210,v211
v_cvt_pk_bf16_f32 v225,v226,v227
ds_write2st64_b64 v36,v[208:209],v[224:225] offset0:12 offset1:14
v_cvt_pk_bf16_f32 v216,v216,v217
v_cvt_pk_bf16_f32 v232,v232,v233
v_cvt_pk_bf16_f32 v213,v214,v215
v_cvt_pk_bf16_f32 v229,v230,v231
v_cvt_pk_bf16_f32 v220,v220,v221
v_cvt_pk_bf16_f32 v236,v236,v237
v_cvt_pk_bf16_f32 v217,v218,v219
v_cvt_pk_bf16_f32 v233,v234,v235
v_cvt_pk_bf16_f32 v221,v222,v223
v_cvt_pk_bf16_f32 v237,v238,v239
v_accvgpr_read_b32 v88,a0
ds_write2st64_b64 v37,v[212:213],v[228:229] offset0:12 offset1:14
v_accvgpr_read_b32 v89,a1
v_pk_mul_f32 v[88:89],v[88:89],v[62:63] op_sel_hi:[1,0]
v_accvgpr_read_b32 v90,a2
s_waitcnt lgkmcnt(3)
buffer_store_dwordx4 v[80:83],v9,s[16:19],s87 offen offset:256 nt
v_accvgpr_read_b32 v91,a3
v_pk_mul_f32 v[90:91],v[90:91],v[62:63] op_sel_hi:[1,0]
v_accvgpr_read_b32 v92,a4
v_accvgpr_read_b32 v93,a5
v_pk_mul_f32 v[92:93],v[92:93],v[62:63] op_sel_hi:[1,0]
v_accvgpr_read_b32 v94,a6
v_accvgpr_read_b32 v95,a7
v_pk_mul_f32 v[94:95],v[94:95],v[62:63] op_sel_hi:[1,0]
v_cvt_pk_bf16_f32 v240,v240,v241
ds_write2st64_b64 v42,v[216:217],v[232:233] offset0:12 offset1:14
v_accvgpr_read_b32 v96,a8
v_accvgpr_read_b32 v97,a9
v_pk_mul_f32 v[96:97],v[96:97],v[62:63] op_sel_hi:[1,0]
buffer_store_dwordx4 v[84:87],v9,s[16:19],s87 offen offset:3328 nt
v_cvt_pk_bf16_f32 v88,v88,v89
v_cvt_pk_bf16_f32 v244,v244,v245
v_accvgpr_read_b32 v98,a10
v_accvgpr_read_b32 v99,a11
v_pk_mul_f32 v[98:99],v[98:99],v[62:63] op_sel_hi:[1,0]
v_accvgpr_read_b32 v100,a12
v_accvgpr_read_b32 v101,a13
v_pk_mul_f32 v[100:101],v[100:101],v[62:63] op_sel_hi:[1,0]
v_cvt_pk_bf16_f32 v92,v92,v93
ds_write2st64_b64 v43,v[220:221],v[236:237] offset0:12 offset1:14
v_cvt_pk_bf16_f32 v241,v242,v243
v_cvt_pk_bf16_f32 v89,v90,v91
v_cvt_pk_bf16_f32 v248,v248,v249
ds_read_b128 v[72:75],v10 offset:6144
ds_read_b128 v[76:79],v10 offset:9216
buffer_store_dwordx4 v[152:155],v9,s[16:19],s66 offen offset:256 nt
ds_read_b128 v[104:107],v10 offset:7168
v_accvgpr_read_b32 v102,a14
ds_read_b128 v[108:111],v10 offset:10240
v_accvgpr_read_b32 v103,a15
v_pk_mul_f32 v[102:103],v[102:103],v[62:63] op_sel_hi:[1,0]
v_cvt_pk_bf16_f32 v96,v96,v97
ds_write2st64_b64 v36,v[240:241],v[88:89] offset0:16 offset1:24
v_cvt_pk_bf16_f32 v245,v246,v247
v_cvt_pk_bf16_f32 v93,v94,v95
v_cvt_pk_bf16_f32 v252,v252,v253
s_waitcnt lgkmcnt(5)
buffer_store_dwordx4 v[156:159],v9,s[16:19],s66 offen offset:3328 nt
v_cvt_pk_bf16_f32 v100,v100,v101
v_cvt_pk_bf16_f32 v249,v250,v251
v_cvt_pk_bf16_f32 v97,v98,v99
v_cvt_pk_bf16_f32 v253,v254,v255
v_cvt_pk_bf16_f32 v101,v102,v103
v_accvgpr_read_b32 v80,a16
v_accvgpr_read_b32 v81,a17
v_pk_mul_f32 v[80:81],v[80:81],v[62:63] op_sel_hi:[1,0]
v_accvgpr_read_b32 v84,a32
ds_write2st64_b64 v37,v[244:245],v[92:93] offset0:16 offset1:24
v_accvgpr_read_b32 v85,a33
v_pk_mul_f32 v[84:85],v[84:85],v[62:63] op_sel_hi:[1,0]
v_accvgpr_read_b32 v212,a20
s_waitcnt lgkmcnt(2)
buffer_store_dwordx4 v[72:75],v9,s[16:19],s85 offen offset:0 nt
v_accvgpr_read_b32 v213,a21
v_pk_mul_f32 v[212:213],v[212:213],v[62:63] op_sel_hi:[1,0]
v_accvgpr_read_b32 v228,a36
v_accvgpr_read_b32 v229,a37
v_pk_mul_f32 v[228:229],v[228:229],v[62:63] op_sel_hi:[1,0]
v_accvgpr_read_b32 v82,a18
v_accvgpr_read_b32 v83,a19
v_pk_mul_f32 v[82:83],v[82:83],v[62:63] op_sel_hi:[1,0]
v_accvgpr_read_b32 v86,a34
ds_write2st64_b64 v42,v[248:249],v[96:97] offset0:16 offset1:24
v_accvgpr_read_b32 v87,a35
v_pk_mul_f32 v[86:87],v[86:87],v[62:63] op_sel_hi:[1,0]
v_accvgpr_read_b32 v214,a22
buffer_store_dwordx4 v[76:79],v9,s[16:19],s85 offen offset:3072 nt
v_accvgpr_read_b32 v215,a23
v_pk_mul_f32 v[214:215],v[214:215],v[62:63] op_sel_hi:[1,0]
v_accvgpr_read_b32 v230,a38
v_accvgpr_read_b32 v231,a39
v_pk_mul_f32 v[230:231],v[230:231],v[62:63] op_sel_hi:[1,0]
v_accvgpr_read_b32 v216,a24
v_accvgpr_read_b32 v217,a25
v_pk_mul_f32 v[216:217],v[216:217],v[62:63] op_sel_hi:[1,0]
v_accvgpr_read_b32 v232,a40
ds_write2st64_b64 v43,v[252:253],v[100:101] offset0:16 offset1:24
v_accvgpr_read_b32 v233,a41
v_pk_mul_f32 v[232:233],v[232:233],v[62:63] op_sel_hi:[1,0]
v_cvt_pk_bf16_f32 v80,v80,v81
ds_read_b128 v[208:211],v10 offset:8192
ds_read_b128 v[224:227],v10 offset:11264
buffer_store_dwordx4 v[104:107],v9,s[16:19],s85 offen offset:128 nt
ds_read_b128 v[152:155],v10 offset:12288
v_cvt_pk_bf16_f32 v84,v84,v85
ds_read_b128 v[156:159],v10 offset:15360
v_accvgpr_read_b32 v218,a26
v_accvgpr_read_b32 v219,a27
v_pk_mul_f32 v[218:219],v[218:219],v[62:63] op_sel_hi:[1,0]
v_accvgpr_read_b32 v234,a42
v_accvgpr_read_b32 v235,a43
buffer_store_dwordx4 v[108:111],v9,s[16:19],s85 offen offset:3200 nt
v_pk_mul_f32 v[234:235],v[234:235],v[62:63] op_sel_hi:[1,0]
v_accvgpr_read_b32 v220,a28
v_accvgpr_read_b32 v221,a29
v_pk_mul_f32 v[220:221],v[220:221],v[62:63] op_sel_hi:[1,0]
v_accvgpr_read_b32 v236,a44
v_accvgpr_read_b32 v237,a45
v_pk_mul_f32 v[236:237],v[236:237],v[62:63] op_sel_hi:[1,0]
v_cvt_pk_bf16_f32 v212,v212,v213
v_cvt_pk_bf16_f32 v228,v228,v229
v_cvt_pk_bf16_f32 v81,v82,v83
v_cvt_pk_bf16_f32 v85,v86,v87
ds_write2st64_b64 v36,v[80:81],v[84:85] offset0:26 offset1:28
v_accvgpr_read_b32 v222,a30
v_accvgpr_read_b32 v223,a31
v_pk_mul_f32 v[222:223],v[222:223],v[62:63] op_sel_hi:[1,0]
s_waitcnt lgkmcnt(2)
buffer_store_dwordx4 v[208:211],v9,s[16:19],s85 offen offset:256 nt
v_accvgpr_read_b32 v238,a46
v_accvgpr_read_b32 v239,a47
v_pk_mul_f32 v[238:239],v[238:239],v[62:63] op_sel_hi:[1,0]
v_cvt_pk_bf16_f32 v216,v216,v217
v_cvt_pk_bf16_f32 v232,v232,v233
v_cvt_pk_bf16_f32 v213,v214,v215
v_cvt_pk_bf16_f32 v229,v230,v231
v_cvt_pk_bf16_f32 v220,v220,v221
v_cvt_pk_bf16_f32 v236,v236,v237
ds_write2st64_b64 v37,v[212:213],v[228:229] offset0:26 offset1:28
v_cvt_pk_bf16_f32 v217,v218,v219
v_cvt_pk_bf16_f32 v233,v234,v235
v_cvt_pk_bf16_f32 v221,v222,v223
buffer_store_dwordx4 v[224:227],v9,s[16:19],s85 offen offset:3328 nt
v_cvt_pk_bf16_f32 v237,v238,v239
v_cvt_pk_bf16_f32 v160,v160,v161
v_cvt_pk_bf16_f32 v176,v176,v177
v_cvt_pk_bf16_f32 v164,v164,v165
v_cvt_pk_bf16_f32 v180,v180,v181
v_cvt_pk_bf16_f32 v161,v162,v163
v_cvt_pk_bf16_f32 v177,v178,v179
v_cvt_pk_bf16_f32 v168,v168,v169
v_cvt_pk_bf16_f32 v184,v184,v185
ds_write2st64_b64 v42,v[216:217],v[232:233] offset0:26 offset1:28
v_cvt_pk_bf16_f32 v165,v166,v167
v_cvt_pk_bf16_f32 v181,v182,v183
v_cvt_pk_bf16_f32 v172,v172,v173
buffer_store_dwordx4 v[152:155],v9,s[16:19],s86 offen offset:0 nt
v_cvt_pk_bf16_f32 v188,v188,v189
v_cvt_pk_bf16_f32 v169,v170,v171
v_cvt_pk_bf16_f32 v185,v186,v187
v_cvt_pk_bf16_f32 v173,v174,v175
v_cvt_pk_bf16_f32 v189,v190,v191
v_cvt_pk_bf16_f32 v192,v192,v193
v_cvt_pk_bf16_f32 v196,v196,v197
v_cvt_pk_bf16_f32 v193,v194,v195
v_cvt_pk_bf16_f32 v200,v200,v201
ds_write2st64_b64 v43,v[220:221],v[236:237] offset0:26 offset1:28
v_cvt_pk_bf16_f32 v197,v198,v199
v_cvt_pk_bf16_f32 v204,v204,v205
v_cvt_pk_bf16_f32 v201,v202,v203
ds_read_b128 v[88:91],v10 offset:13312
ds_read_b128 v[240:243],v10 offset:16384
s_waitcnt lgkmcnt(3)
buffer_store_dwordx4 v[156:159],v9,s[16:19],s86 offen offset:3072 nt
ds_read_b128 v[72:75],v10 offset:14336
v_cvt_pk_bf16_f32 v205,v206,v207
ds_read_b128 v[76:79],v10 offset:17408
ds_write2st64_b64 v36,v[160:161],v[176:177] offset0:0 offset1:2
ds_write2st64_b64 v37,v[164:165],v[180:181] offset0:0 offset1:2
s_waitcnt lgkmcnt(2)
buffer_store_dwordx4 v[88:91],v9,s[16:19],s86 offen offset:128 nt
ds_write2st64_b64 v42,v[168:169],v[184:185] offset0:0 offset1:2
buffer_store_dwordx4 v[240:243],v9,s[16:19],s86 offen offset:3200 nt
ds_write2st64_b64 v43,v[172:173],v[188:189] offset0:0 offset1:2
ds_read_b128 v[92:95],v10 offset:0
ds_read_b128 v[104:107],v10 offset:3072
buffer_store_dwordx4 v[72:75],v9,s[16:19],s86 offen offset:256 nt
ds_read_b128 v[108:111],v10 offset:1024
ds_read_b128 v[244:247],v10 offset:4096
ds_write_b64 v36,v[192:193] offset:2048
buffer_store_dwordx4 v[76:79],v9,s[16:19],s86 offen offset:3328 nt
ds_write_b64 v37,v[196:197] offset:2048
s_waitcnt lgkmcnt(4)
buffer_store_dwordx4 v[92:95],v9,s[16:19],s84 offen offset:0 nt
ds_write_b64 v42,v[200:201] offset:2048
buffer_store_dwordx4 v[104:107],v9,s[16:19],s84 offen offset:3072 nt
ds_write_b64 v43,v[204:205] offset:2048
ds_read_b128 v[96:99],v10 offset:2048
ds_read_b128 v[248:251],v10 offset:5120
s_waitcnt lgkmcnt(4)
buffer_store_dwordx4 v[108:111],v9,s[16:19],s84 offen offset:128 nt
buffer_store_dwordx4 v[244:247],v9,s[16:19],s84 offen offset:3200 nt
s_waitcnt lgkmcnt(1)
buffer_store_dwordx4 v[96:99],v9,s[16:19],s84 offen offset:256 nt
s_waitcnt lgkmcnt(0)
buffer_store_dwordx4 v[248:251],v9,s[16:19],s84 offen offset:3328 nt
s_branch L_fin
L_end4:
s_waitcnt lgkmcnt(4)
v_mfma_f32_16x16x32_bf16 v[160:163],v[112:115],v[18:21],v[160:163]
ds_read_b64_tr_b16 v[128:129],v2 offset:24704
ds_read_b64_tr_b16 v[130:131],v2 offset:30848
v_mfma_f32_16x16x32_bf16 v[208:211],v[112:115],v[24:27],v[208:211]
ds_read_b64_tr_b16 v[132:133],v3 offset:24704
ds_read_b64_tr_b16 v[134:135],v3 offset:30848
v_mfma_f32_16x16x32_bf16 a[0:3],v[112:115],v[30:33],a[0:3]
ds_read_b64_tr_b16 v[136:137],v4 offset:24704
ds_read_b64_tr_b16 v[138:139],v4 offset:30848
v_mfma_f32_16x16x32_bf16 a[48:51],v[112:115],v[36:39],a[48:51]
ds_read_b64_tr_b16 v[140:141],v5 offset:24704
ds_read_b64_tr_b16 v[142:143],v5 offset:30848
v_mfma_f32_16x16x32_bf16 v[164:167],v[116:119],v[18:21],v[164:167]
ds_read_b64_tr_b16 v[112:113],v2 offset:24832
ds_read_b64_tr_b16 v[114:115],v2 offset:30976
v_mfma_f32_16x16x32_bf16 v[212:215],v[116:119],v[24:27],v[212:215]
v_fma_f32 v82,v82,s36,v14
v_fma_f32 v83,v83,s36,v14
v_mfma_f32_16x16x32_bf16 a[4:7],v[116:119],v[30:33],a[4:7]
v_fma_f32 v88,v88,s36,v15
v_fma_f32 v89,v89,s36,v15
v_mfma_f32_16x16x32_bf16 a[52:55],v[116:119],v[36:39],a[52:55]
s_waitcnt lgkmcnt(10)
ds_read_b64_tr_b16 v[116:117],v3 offset:24832
ds_read_b64_tr_b16 v[118:119],v3 offset:30976
v_mfma_f32_16x16x32_bf16 v[168:171],v[120:123],v[18:21],v[168:171]
v_fma_f32 v90,v90,s36,v15
v_fma_f32 v91,v91,s36,v15
v_mfma_f32_16x16x32_bf16 v[216:219],v[120:123],v[24:27],v[216:219]
v_fma_f32 v96,v96,s36,v16
v_fma_f32 v97,v97,s36,v16
v_mfma_f32_16x16x32_bf16 a[8:11],v[120:123],v[30:33],a[8:11]
v_fma_f32 v98,v98,s36,v16
v_fma_f32 v99,v99,s36,v16
v_mfma_f32_16x16x32_bf16 a[56:59],v[120:123],v[36:39],a[56:59]
ds_read_b64_tr_b16 v[120:121],v4 offset:24832
ds_read_b64_tr_b16 v[122:123],v4 offset:30976
v_mfma_f32_16x16x32_bf16 v[172:175],v[124:127],v[18:21],v[172:175]
v_fma_f32 v76,v76,s36,v13
v_fma_f32 v77,v77,s36,v13
v_mfma_f32_16x16x32_bf16 v[220:223],v[124:127],v[24:27],v[220:223]
v_fma_f32 v78,v78,s36,v13
v_fma_f32 v79,v79,s36,v13
v_mfma_f32_16x16x32_bf16 a[12:15],v[124:127],v[30:33],a[12:15]
v_fma_f32 v84,v84,s36,v14
v_fma_f32 v85,v85,s36,v14
v_mfma_f32_16x16x32_bf16 a[60:63],v[124:127],v[36:39],a[60:63]
s_waitcnt lgkmcnt(3)
ds_read_b64_tr_b16 v[124:125],v5 offset:24832
ds_read_b64_tr_b16 v[126:127],v5 offset:30976
v_mfma_f32_16x16x32_bf16 v[176:179],v[128:131],v[18:21],v[176:179]
v_fma_f32 v86,v86,s36,v14
v_fma_f32 v87,v87,s36,v14
v_mfma_f32_16x16x32_bf16 v[224:227],v[128:131],v[24:27],v[224:227]
v_fma_f32 v92,v92,s36,v15
v_fma_f32 v93,v93,s36,v15
v_mfma_f32_16x16x32_bf16 a[16:19],v[128:131],v[30:33],a[16:19]
v_fma_f32 v94,v94,s36,v15
v_fma_f32 v95,v95,s36,v15
v_mfma_f32_16x16x32_bf16 a[64:67],v[128:131],v[36:39],a[64:67]
v_fma_f32 v100,v100,s36,v16
v_fma_f32 v101,v101,s36,v16
v_mfma_f32_16x16x32_bf16 v[180:183],v[132:135],v[18:21],v[180:183]
v_fma_f32 v102,v102,s36,v16
v_fma_f32 v103,v103,s36,v16
v_mfma_f32_16x16x32_bf16 v[228:231],v[132:135],v[24:27],v[228:231]
v_exp_f32 v82,v82
v_mfma_f32_16x16x32_bf16 a[20:23],v[132:135],v[30:33],a[20:23]
v_exp_f32 v83,v83
v_mfma_f32_16x16x32_bf16 a[68:71],v[132:135],v[36:39],a[68:71]
v_exp_f32 v88,v88
v_mfma_f32_16x16x32_bf16 v[184:187],v[136:139],v[18:21],v[184:187]
v_exp_f32 v89,v89
v_mfma_f32_16x16x32_bf16 v[232:235],v[136:139],v[24:27],v[232:235]
v_exp_f32 v90,v90
v_mfma_f32_16x16x32_bf16 a[24:27],v[136:139],v[30:33],a[24:27]
v_exp_f32 v91,v91
v_mfma_f32_16x16x32_bf16 a[72:75],v[136:139],v[36:39],a[72:75]
v_exp_f32 v96,v96
v_mfma_f32_16x16x32_bf16 v[188:191],v[140:143],v[18:21],v[188:191]
v_exp_f32 v97,v97
v_mfma_f32_16x16x32_bf16 v[236:239],v[140:143],v[24:27],v[236:239]
v_exp_f32 v98,v98
v_mfma_f32_16x16x32_bf16 a[28:31],v[140:143],v[30:33],a[28:31]
v_exp_f32 v99,v99
v_mfma_f32_16x16x32_bf16 a[76:79],v[140:143],v[36:39],a[76:79]
v_exp_f32 v76,v76
v_mfma_f32_16x16x32_bf16 v[192:195],v[112:115],v[18:21],v[192:195]
v_exp_f32 v77,v77
v_mfma_f32_16x16x32_bf16 v[240:243],v[112:115],v[24:27],v[240:243]
v_exp_f32 v78,v78
v_mfma_f32_16x16x32_bf16 a[32:35],v[112:115],v[30:33],a[32:35]
v_exp_f32 v79,v79
v_mfma_f32_16x16x32_bf16 a[80:83],v[112:115],v[36:39],a[80:83]
s_waitcnt lgkmcnt(0)
v_exp_f32 v84,v84
v_mfma_f32_16x16x32_bf16 v[196:199],v[116:119],v[18:21],v[196:199]
v_exp_f32 v85,v85
v_mfma_f32_16x16x32_bf16 v[244:247],v[116:119],v[24:27],v[244:247]
v_exp_f32 v86,v86
v_mfma_f32_16x16x32_bf16 a[36:39],v[116:119],v[30:33],a[36:39]
v_exp_f32 v87,v87
v_mfma_f32_16x16x32_bf16 a[84:87],v[116:119],v[36:39],a[84:87]
v_exp_f32 v92,v92
s_waitcnt vmcnt(14)
s_barrier
v_mfma_f32_16x16x32_bf16 v[200:203],v[120:123],v[18:21],v[200:203]
v_exp_f32 v93,v93
v_mfma_f32_16x16x32_bf16 v[248:251],v[120:123],v[24:27],v[248:251]
v_exp_f32 v94,v94
v_mfma_f32_16x16x32_bf16 a[40:43],v[120:123],v[30:33],a[40:43]
v_exp_f32 v95,v95
v_mfma_f32_16x16x32_bf16 a[88:91],v[120:123],v[36:39],a[88:91]
v_exp_f32 v100,v100
v_mfma_f32_16x16x32_bf16 v[204:207],v[124:127],v[18:21],v[204:207]
v_exp_f32 v101,v101
v_mfma_f32_16x16x32_bf16 v[252:255],v[124:127],v[24:27],v[252:255]
v_exp_f32 v102,v102
v_mfma_f32_16x16x32_bf16 a[44:47],v[124:127],v[30:33],a[44:47]
v_exp_f32 v103,v103
v_mfma_f32_16x16x32_bf16 a[92:95],v[124:127],v[36:39],a[92:95]
v_cvt_pk_bf16_f32 v29,v82,v83
v_cvt_pk_bf16_f32 v34,v88,v89
v_cvt_pk_bf16_f32 v35,v90,v91
v_cvt_pk_bf16_f32 v40,v96,v97
v_cvt_pk_bf16_f32 v41,v98,v99
v_cvt_pk_bf16_f32 v20,v76,v77
v_cvt_pk_bf16_f32 v21,v78,v79
v_cvt_pk_bf16_f32 v26,v84,v85
v_cvt_pk_bf16_f32 v27,v86,v87
v_mfma_f32_16x16x32_bf16 v[52:55],v[48:51],v[20:23],v[52:55]
v_cvt_pk_bf16_f32 v32,v92,v93
v_cvt_pk_bf16_f32 v33,v94,v95
v_mfma_f32_16x16x32_bf16 v[56:59],v[48:51],v[26:29],v[56:59]
ds_read_b64_tr_b16 v[128:129],v2 offset:6144
ds_read_b64_tr_b16 v[130:131],v2 offset:0
v_mfma_f32_16x16x32_bf16 v[60:63],v[48:51],v[32:35],v[60:63]
v_cvt_pk_bf16_f32 v38,v100,v101
v_cvt_pk_bf16_f32 v39,v102,v103
v_subrev_u32 v10,18432,v10
ds_read_b64_tr_b16 v[132:133],v3 offset:6144
v_mfma_f32_16x16x32_bf16 v[64:67],v[48:51],v[38:41],v[64:67]
ds_read_b64_tr_b16 v[134:135],v3 offset:0
ds_read_b64_tr_b16 v[136:137],v4 offset:6144
ds_read_b64_tr_b16 v[138:139],v4 offset:0
ds_read_b64_tr_b16 v[140:141],v5 offset:6144
ds_read_b64_tr_b16 v[142:143],v5 offset:0
s_waitcnt lgkmcnt(6)
v_mfma_f32_16x16x32_bf16 v[160:163],v[128:131],v[20:23],v[160:163]
s_waitcnt vmcnt(6)
ds_read_b64_tr_b16 v[112:113],v2 offset:6272
ds_read_b64_tr_b16 v[114:115],v2 offset:128
v_mfma_f32_16x16x32_bf16 v[208:211],v[128:131],v[26:29],v[208:211]
s_add_u32 s84,s42,0
ds_read_b64_tr_b16 v[116:117],v3 offset:6272
ds_read_b64_tr_b16 v[118:119],v3 offset:128
v_mfma_f32_16x16x32_bf16 a[0:3],v[128:131],v[32:35],a[0:3]
s_add_u32 s85,s42,6144
ds_read_b64_tr_b16 v[120:121],v4 offset:6272
ds_read_b64_tr_b16 v[122:123],v4 offset:128
v_mfma_f32_16x16x32_bf16 a[48:51],v[128:131],v[38:41],a[48:51]
s_add_u32 s86,s42,12288
ds_read_b64_tr_b16 v[124:125],v5 offset:6272
ds_read_b64_tr_b16 v[126:127],v5 offset:128
s_waitcnt lgkmcnt(12)
v_mfma_f32_16x16x32_bf16 v[164:167],v[132:135],v[20:23],v[164:167]
s_add_u32 s87,s42,18432
ds_read_b64_tr_b16 v[128:129],v2 offset:6400
ds_read_b64_tr_b16 v[130:131],v2 offset:256
v_mfma_f32_16x16x32_bf16 v[212:215],v[132:135],v[26:29],v[212:215]
v_mbcnt_lo_u32_b32 v57,-1,0
v_mbcnt_hi_u32_b32 v57,-1,v57
v_mfma_f32_16x16x32_bf16 a[4:7],v[132:135],v[32:35],a[4:7]
v_and_b32 v61,7,v57
v_lshrrev_b32 v53,5,v57
v_mfma_f32_16x16x32_bf16 a[52:55],v[132:135],v[38:41],a[52:55]
s_waitcnt lgkmcnt(10)
ds_read_b64_tr_b16 v[132:133],v3 offset:6400
ds_read_b64_tr_b16 v[134:135],v3 offset:256
v_mfma_f32_16x16x32_bf16 v[168:171],v[136:139],v[20:23],v[168:171]
v_xor_b32 v61,v61,v53
v_and_b32 v53,15,v57
v_mfma_f32_16x16x32_bf16 v[216:219],v[136:139],v[26:29],v[216:219]
v_lshl_add_u32 v53,v53,7,s24
v_lshl_add_u32 v53,v61,4,v53
v_mfma_f32_16x16x32_bf16 a[8:11],v[136:139],v[32:35],a[8:11]
v_bfe_u32 v61,v57,4,1
v_lshl_add_u32 v36,v61,3,v53
v_mfma_f32_16x16x32_bf16 a[56:59],v[136:139],v[38:41],a[56:59]
ds_read_b64_tr_b16 v[136:137],v4 offset:6400
ds_read_b64_tr_b16 v[138:139],v4 offset:256
v_mfma_f32_16x16x32_bf16 v[172:175],v[140:143],v[20:23],v[172:175]
v_xor_b32 v37,32,v36
v_xor_b32 v42,64,v36
v_mfma_f32_16x16x32_bf16 v[220:223],v[140:143],v[26:29],v[220:223]
v_xor_b32 v43,96,v36
v_bfe_u32 v53,v57,3,1
v_mfma_f32_16x16x32_bf16 a[12:15],v[140:143],v[32:35],a[12:15]
v_lshlrev_b32 v53,11,v53
v_rcp_f32 v66,v64
v_mfma_f32_16x16x32_bf16 a[60:63],v[140:143],v[38:41],a[60:63]
s_waitcnt lgkmcnt(2)
ds_read_b64_tr_b16 v[140:141],v5 offset:6400
ds_read_b64_tr_b16 v[142:143],v5 offset:256
v_mfma_f32_16x16x32_bf16 v[176:179],v[112:115],v[20:23],v[176:179]
v_accvgpr_read_b32 v72,a48
v_accvgpr_read_b32 v73,a49
v_mfma_f32_16x16x32_bf16 v[224:227],v[112:115],v[26:29],v[224:227]
v_accvgpr_read_b32 v74,a50
v_accvgpr_read_b32 v75,a51
v_mfma_f32_16x16x32_bf16 a[16:19],v[112:115],v[32:35],a[16:19]
v_accvgpr_read_b32 v80,a52
v_accvgpr_read_b32 v81,a53
v_mfma_f32_16x16x32_bf16 a[64:67],v[112:115],v[38:41],a[64:67]
v_accvgpr_read_b32 v82,a54
v_accvgpr_read_b32 v83,a55
v_mfma_f32_16x16x32_bf16 v[180:183],v[116:119],v[20:23],v[180:183]
v_accvgpr_read_b32 v88,a56
v_accvgpr_read_b32 v89,a57
v_mfma_f32_16x16x32_bf16 v[228:231],v[116:119],v[26:29],v[228:231]
v_accvgpr_read_b32 v90,a58
v_accvgpr_read_b32 v91,a59
v_mfma_f32_16x16x32_bf16 a[20:23],v[116:119],v[32:35],a[20:23]
v_accvgpr_read_b32 v76,a64
v_accvgpr_read_b32 v77,a65
v_accvgpr_read_b32 v78,a66
v_accvgpr_read_b32 v79,a67
v_accvgpr_read_b32 v96,a60
v_pk_mul_f32 v[72:73],v[72:73],v[66:67] op_sel_hi:[1,0]
v_pk_mul_f32 v[74:75],v[74:75],v[66:67] op_sel_hi:[1,0]
v_pk_mul_f32 v[76:77],v[76:77],v[66:67] op_sel_hi:[1,0]
v_pk_mul_f32 v[78:79],v[78:79],v[66:67] op_sel_hi:[1,0]
v_accvgpr_read_b32 v97,a61
v_accvgpr_read_b32 v98,a62
v_mfma_f32_16x16x32_bf16 a[68:71],v[116:119],v[38:41],a[68:71]
v_accvgpr_read_b32 v99,a63
v_cvt_pk_bf16_f32 v72,v72,v73
v_mfma_f32_16x16x32_bf16 v[184:187],v[120:123],v[20:23],v[184:187]
v_cvt_pk_bf16_f32 v76,v76,v77
v_cvt_pk_bf16_f32 v73,v74,v75
v_mfma_f32_16x16x32_bf16 v[232:235],v[120:123],v[26:29],v[232:235]
v_cvt_pk_bf16_f32 v77,v78,v79
v_max3_f32 v152,v52,v56,v60
v_mfma_f32_16x16x32_bf16 a[24:27],v[120:123],v[32:35],a[24:27]
ds_write2st64_b64 v36,v[72:73],v[76:77] offset0:36 offset1:40
v_pk_mul_f32 v[80:81],v[80:81],v[66:67] op_sel_hi:[1,0]
v_pk_mul_f32 v[82:83],v[82:83],v[66:67] op_sel_hi:[1,0]
v_accvgpr_read_b32 v84,a68
v_accvgpr_read_b32 v85,a69
v_pk_mul_f32 v[84:85],v[84:85],v[66:67] op_sel_hi:[1,0]
v_accvgpr_read_b32 v86,a70
v_accvgpr_read_b32 v87,a71
v_pk_mul_f32 v[86:87],v[86:87],v[66:67] op_sel_hi:[1,0]
v_cvt_pk_bf16_f32 v80,v80,v81
v_cvt_pk_bf16_f32 v84,v84,v85
v_mfma_f32_16x16x32_bf16 a[72:75],v[120:123],v[38:41],a[72:75]
v_cvt_pk_bf16_f32 v81,v82,v83
v_cvt_pk_bf16_f32 v85,v86,v87
v_mfma_f32_16x16x32_bf16 v[188:191],v[124:127],v[20:23],v[188:191]
ds_write2st64_b64 v37,v[80:81],v[84:85] offset0:36 offset1:40
v_mfma_f32_16x16x32_bf16 v[236:239],v[124:127],v[26:29],v[236:239]
v_max_f32 v152,v152,v64
v_cmp_ngt_f32 vcc,s37,v152
v_mfma_f32_16x16x32_bf16 a[28:31],v[124:127],v[32:35],a[28:31]
v_accvgpr_read_b32 v92,a72
v_accvgpr_read_b32 v93,a73
v_accvgpr_read_b32 v94,a74
v_accvgpr_read_b32 v95,a75
v_rcp_f32 v58,v56
v_pk_mul_f32 v[88:89],v[88:89],v[66:67] op_sel_hi:[1,0]
v_pk_mul_f32 v[90:91],v[90:91],v[66:67] op_sel_hi:[1,0]
v_pk_mul_f32 v[92:93],v[92:93],v[66:67] op_sel_hi:[1,0]
v_pk_mul_f32 v[94:95],v[94:95],v[66:67] op_sel_hi:[1,0]
v_cvt_pk_bf16_f32 v88,v88,v89
v_cvt_pk_bf16_f32 v92,v92,v93
v_mfma_f32_16x16x32_bf16 a[76:79],v[124:127],v[38:41],a[76:79]
s_cmp_lg_u64 vcc,0
v_cvt_pk_bf16_f32 v89,v90,v91
v_cvt_pk_bf16_f32 v93,v94,v95
v_mfma_f32_16x16x32_bf16 v[192:195],v[128:131],v[20:23],v[192:195]
s_cselect_b32 s62,s32,0
ds_write2st64_b64 v42,v[88:89],v[92:93] offset0:36 offset1:40
v_mfma_f32_16x16x32_bf16 v[240:243],v[128:131],v[26:29],v[240:243]
s_or_b32 s31,s31,s62
v_accvgpr_read_b32 v100,a76
v_accvgpr_read_b32 v101,a77
v_mfma_f32_16x16x32_bf16 a[32:35],v[128:131],v[32:35],a[32:35]
s_lshl_b32 s32,s32,1
v_accvgpr_read_b32 v102,a78
v_accvgpr_read_b32 v103,a79
v_rcp_f32 v62,v60
v_rcp_f32 v54,v52
v_pk_mul_f32 v[96:97],v[96:97],v[66:67] op_sel_hi:[1,0]
v_pk_mul_f32 v[98:99],v[98:99],v[66:67] op_sel_hi:[1,0]
v_pk_mul_f32 v[100:101],v[100:101],v[66:67] op_sel_hi:[1,0]
v_pk_mul_f32 v[102:103],v[102:103],v[66:67] op_sel_hi:[1,0]
v_cvt_pk_bf16_f32 v96,v96,v97
v_cvt_pk_bf16_f32 v100,v100,v101
v_mfma_f32_16x16x32_bf16 a[80:83],v[128:131],v[38:41],a[80:83]
v_cvt_pk_bf16_f32 v97,v98,v99
v_cvt_pk_bf16_f32 v101,v102,v103
v_mfma_f32_16x16x32_bf16 v[196:199],v[132:135],v[20:23],v[196:199]
ds_write2st64_b64 v43,v[96:97],v[100:101] offset0:36 offset1:40
v_mfma_f32_16x16x32_bf16 v[244:247],v[132:135],v[26:29],v[244:247]
v_mfma_f32_16x16x32_bf16 a[36:39],v[132:135],v[32:35],a[36:39]
ds_read_b128 v[152:155],v10 offset:18432
ds_read_b128 v[156:159],v10 offset:19456
v_accvgpr_read_b32 v72,a80
ds_read_b128 v[104:107],v10 offset:20480
v_accvgpr_read_b32 v73,a81
ds_read_b128 v[108:111],v10 offset:21504
v_pk_mul_f32 v[72:73],v[72:73],v[66:67] op_sel_hi:[1,0]
v_accvgpr_read_b32 v74,a82
v_accvgpr_read_b32 v75,a83
v_pk_mul_f32 v[74:75],v[74:75],v[66:67] op_sel_hi:[1,0]
v_cvt_pk_bf16_f32 v72,v72,v73
v_cvt_pk_bf16_f32 v73,v74,v75
v_mfma_f32_16x16x32_bf16 a[84:87],v[132:135],v[38:41],a[84:87]
s_waitcnt lgkmcnt(5)
ds_write_b64 v36,v[72:73] offset:18432
v_mfma_f32_16x16x32_bf16 v[200:203],v[136:139],v[20:23],v[200:203]
v_add_u32 v36,v36,v53
v_mfma_f32_16x16x32_bf16 v[248:251],v[136:139],v[26:29],v[248:251]
v_mfma_f32_16x16x32_bf16 a[40:43],v[136:139],v[32:35],a[40:43]
s_waitcnt lgkmcnt(4)
buffer_store_dwordx4 v[152:155],v9,s[16:19],s87 offen offset:0 nt
s_waitcnt lgkmcnt(1)
buffer_store_dwordx4 v[156:159],v9,s[16:19],s87 offen offset:3072 nt
buffer_store_dwordx4 v[104:107],v9,s[16:19],s87 offen offset:128 nt
v_accvgpr_read_b32 v76,a84
v_accvgpr_read_b32 v77,a85
v_pk_mul_f32 v[76:77],v[76:77],v[66:67] op_sel_hi:[1,0]
v_accvgpr_read_b32 v78,a86
v_accvgpr_read_b32 v79,a87
v_pk_mul_f32 v[78:79],v[78:79],v[66:67] op_sel_hi:[1,0]
v_cvt_pk_bf16_f32 v76,v76,v77
v_cvt_pk_bf16_f32 v77,v78,v79
v_mfma_f32_16x16x32_bf16 a[88:91],v[136:139],v[38:41],a[88:91]
v_accvgpr_read_b32 v104,a4
v_accvgpr_read_b32 v105,a5
v_mfma_f32_16x16x32_bf16 v[204:207],v[140:143],v[20:23],v[204:207]
ds_write_b64 v37,v[76:77] offset:18432
v_mfma_f32_16x16x32_bf16 v[252:255],v[140:143],v[26:29],v[252:255]
buffer_store_dwordx4 v[108:111],v9,s[16:19],s87 offen offset:3200 nt
v_add_u32 v37,v37,v53
v_accvgpr_read_b32 v76,a0
v_accvgpr_read_b32 v80,a88
v_mfma_f32_16x16x32_bf16 a[44:47],v[140:143],v[32:35],a[44:47]
v_accvgpr_read_b32 v81,a89
v_accvgpr_read_b32 v82,a90
v_accvgpr_read_b32 v83,a91
v_accvgpr_read_b32 v77,a1
v_accvgpr_read_b32 v78,a2
v_pk_mul_f32 v[80:81],v[80:81],v[66:67] op_sel_hi:[1,0]
v_pk_mul_f32 v[82:83],v[82:83],v[66:67] op_sel_hi:[1,0]
v_cvt_pk_bf16_f32 v80,v80,v81
v_cvt_pk_bf16_f32 v81,v82,v83
v_mfma_f32_16x16x32_bf16 a[92:95],v[140:143],v[38:41],a[92:95]
ds_write_b64 v42,v[80:81] offset:18432
v_add_u32 v42,v42,v53
v_accvgpr_read_b32 v79,a3
v_pk_mul_f32 v[208:209],v[208:209],v[58:59] op_sel_hi:[1,0]
v_pk_mul_f32 v[224:225],v[224:225],v[58:59] op_sel_hi:[1,0]
v_pk_mul_f32 v[210:211],v[210:211],v[58:59] op_sel_hi:[1,0]
v_pk_mul_f32 v[226:227],v[226:227],v[58:59] op_sel_hi:[1,0]
v_pk_mul_f32 v[212:213],v[212:213],v[58:59] op_sel_hi:[1,0]
v_pk_mul_f32 v[228:229],v[228:229],v[58:59] op_sel_hi:[1,0]
v_pk_mul_f32 v[214:215],v[214:215],v[58:59] op_sel_hi:[1,0]
v_pk_mul_f32 v[230:231],v[230:231],v[58:59] op_sel_hi:[1,0]
v_pk_mul_f32 v[216:217],v[216:217],v[58:59] op_sel_hi:[1,0]
v_pk_mul_f32 v[232:233],v[232:233],v[58:59] op_sel_hi:[1,0]
v_pk_mul_f32 v[218:219],v[218:219],v[58:59] op_sel_hi:[1,0]
v_pk_mul_f32 v[234:235],v[234:235],v[58:59] op_sel_hi:[1,0]
v_pk_mul_f32 v[220:221],v[220:221],v[58:59] op_sel_hi:[1,0]
v_pk_mul_f32 v[236:237],v[236:237],v[58:59] op_sel_hi:[1,0]
v_pk_mul_f32 v[222:223],v[222:223],v[58:59] op_sel_hi:[1,0]
v_pk_mul_f32 v[238:239],v[238:239],v[58:59] op_sel_hi:[1,0]
v_pk_mul_f32 v[240:241],v[240:241],v[58:59] op_sel_hi:[1,0]
v_pk_mul_f32 v[76:77],v[76:77],v[62:63] op_sel_hi:[1,0]
v_pk_mul_f32 v[242:243],v[242:243],v[58:59] op_sel_hi:[1,0]
v_pk_mul_f32 v[244:245],v[244:245],v[58:59] op_sel_hi:[1,0]
v_pk_mul_f32 v[104:105],v[104:105],v[62:63] op_sel_hi:[1,0]
v_pk_mul_f32 v[78:79],v[78:79],v[62:63] op_sel_hi:[1,0]
v_pk_mul_f32 v[246:247],v[246:247],v[58:59] op_sel_hi:[1,0]
v_pk_mul_f32 v[248:249],v[248:249],v[58:59] op_sel_hi:[1,0]
v_pk_mul_f32 v[250:251],v[250:251],v[58:59] op_sel_hi:[1,0]
v_pk_mul_f32 v[252:253],v[252:253],v[58:59] op_sel_hi:[1,0]
v_pk_mul_f32 v[254:255],v[254:255],v[58:59] op_sel_hi:[1,0]
v_pk_mul_f32 v[160:161],v[160:161],v[54:55] op_sel_hi:[1,0]
v_pk_mul_f32 v[176:177],v[176:177],v[54:55] op_sel_hi:[1,0]
v_pk_mul_f32 v[162:163],v[162:163],v[54:55] op_sel_hi:[1,0]
v_pk_mul_f32 v[178:179],v[178:179],v[54:55] op_sel_hi:[1,0]
v_pk_mul_f32 v[164:165],v[164:165],v[54:55] op_sel_hi:[1,0]
v_pk_mul_f32 v[180:181],v[180:181],v[54:55] op_sel_hi:[1,0]
v_pk_mul_f32 v[166:167],v[166:167],v[54:55] op_sel_hi:[1,0]
v_pk_mul_f32 v[182:183],v[182:183],v[54:55] op_sel_hi:[1,0]
v_pk_mul_f32 v[168:169],v[168:169],v[54:55] op_sel_hi:[1,0]
v_pk_mul_f32 v[184:185],v[184:185],v[54:55] op_sel_hi:[1,0]
v_pk_mul_f32 v[170:171],v[170:171],v[54:55] op_sel_hi:[1,0]
v_pk_mul_f32 v[186:187],v[186:187],v[54:55] op_sel_hi:[1,0]
v_pk_mul_f32 v[172:173],v[172:173],v[54:55] op_sel_hi:[1,0]
v_pk_mul_f32 v[188:189],v[188:189],v[54:55] op_sel_hi:[1,0]
v_pk_mul_f32 v[174:175],v[174:175],v[54:55] op_sel_hi:[1,0]
v_pk_mul_f32 v[190:191],v[190:191],v[54:55] op_sel_hi:[1,0]
v_pk_mul_f32 v[192:193],v[192:193],v[54:55] op_sel_hi:[1,0]
v_pk_mul_f32 v[194:195],v[194:195],v[54:55] op_sel_hi:[1,0]
v_pk_mul_f32 v[196:197],v[196:197],v[54:55] op_sel_hi:[1,0]
v_pk_mul_f32 v[198:199],v[198:199],v[54:55] op_sel_hi:[1,0]
v_pk_mul_f32 v[200:201],v[200:201],v[54:55] op_sel_hi:[1,0]
v_pk_mul_f32 v[202:203],v[202:203],v[54:55] op_sel_hi:[1,0]
v_pk_mul_f32 v[204:205],v[204:205],v[54:55] op_sel_hi:[1,0]
v_pk_mul_f32 v[206:207],v[206:207],v[54:55] op_sel_hi:[1,0]
v_accvgpr_read_b32 v84,a92
v_accvgpr_read_b32 v85,a93
v_pk_mul_f32 v[84:85],v[84:85],v[66:67] op_sel_hi:[1,0]
v_accvgpr_read_b32 v86,a94
v_accvgpr_read_b32 v87,a95
v_pk_mul_f32 v[86:87],v[86:87],v[66:67] op_sel_hi:[1,0]
v_cvt_pk_bf16_f32 v84,v84,v85
v_cvt_pk_bf16_f32 v85,v86,v87
ds_write_b64 v43,v[84:85] offset:18432
ds_read_b128 v[88:91],v10 offset:18432
ds_read_b128 v[92:95],v10 offset:19456
v_add_u32 v43,v43,v53
v_cvt_pk_bf16_f32 v208,v208,v209
v_cvt_pk_bf16_f32 v224,v224,v225
v_cvt_pk_bf16_f32 v212,v212,v213
v_cvt_pk_bf16_f32 v228,v228,v229
v_cvt_pk_bf16_f32 v209,v210,v211
v_cvt_pk_bf16_f32 v225,v226,v227
ds_write2st64_b64 v36,v[208:209],v[224:225] offset0:12 offset1:14
v_cvt_pk_bf16_f32 v216,v216,v217
v_cvt_pk_bf16_f32 v232,v232,v233
v_cvt_pk_bf16_f32 v213,v214,v215
v_cvt_pk_bf16_f32 v229,v230,v231
v_cvt_pk_bf16_f32 v220,v220,v221
v_cvt_pk_bf16_f32 v236,v236,v237
v_cvt_pk_bf16_f32 v217,v218,v219
v_cvt_pk_bf16_f32 v233,v234,v235
v_cvt_pk_bf16_f32 v221,v222,v223
v_cvt_pk_bf16_f32 v237,v238,v239
v_accvgpr_read_b32 v106,a6
ds_write2st64_b64 v37,v[212:213],v[228:229] offset0:12 offset1:14
v_accvgpr_read_b32 v107,a7
v_pk_mul_f32 v[106:107],v[106:107],v[62:63] op_sel_hi:[1,0]
v_accvgpr_read_b32 v108,a8
s_waitcnt lgkmcnt(2)
buffer_store_dwordx4 v[88:91],v9,s[16:19],s87 offen offset:256 nt
v_accvgpr_read_b32 v109,a9
v_pk_mul_f32 v[108:109],v[108:109],v[62:63] op_sel_hi:[1,0]
v_cvt_pk_bf16_f32 v240,v240,v241
v_cvt_pk_bf16_f32 v76,v76,v77
v_accvgpr_read_b32 v110,a10
v_accvgpr_read_b32 v111,a11
v_pk_mul_f32 v[110:111],v[110:111],v[62:63] op_sel_hi:[1,0]
v_accvgpr_read_b32 v80,a12
v_accvgpr_read_b32 v81,a13
ds_write2st64_b64 v42,v[216:217],v[232:233] offset0:12 offset1:14
v_pk_mul_f32 v[80:81],v[80:81],v[62:63] op_sel_hi:[1,0]
v_cvt_pk_bf16_f32 v244,v244,v245
v_cvt_pk_bf16_f32 v104,v104,v105
buffer_store_dwordx4 v[92:95],v9,s[16:19],s87 offen offset:3328 nt
v_cvt_pk_bf16_f32 v241,v242,v243
v_cvt_pk_bf16_f32 v77,v78,v79
v_accvgpr_read_b32 v82,a14
v_accvgpr_read_b32 v83,a15
v_pk_mul_f32 v[82:83],v[82:83],v[62:63] op_sel_hi:[1,0]
v_cvt_pk_bf16_f32 v248,v248,v249
v_cvt_pk_bf16_f32 v108,v108,v109
v_cvt_pk_bf16_f32 v245,v246,v247
v_cvt_pk_bf16_f32 v105,v106,v107
ds_write2st64_b64 v43,v[220:221],v[236:237] offset0:12 offset1:14
v_cvt_pk_bf16_f32 v252,v252,v253
v_cvt_pk_bf16_f32 v80,v80,v81
v_cvt_pk_bf16_f32 v249,v250,v251
ds_read_b128 v[96:99],v10 offset:6144
ds_read_b128 v[100:103],v10 offset:9216
v_cvt_pk_bf16_f32 v109,v110,v111
ds_read_b128 v[72:75],v10 offset:7168
v_cvt_pk_bf16_f32 v253,v254,v255
ds_read_b128 v[152:155],v10 offset:10240
v_cvt_pk_bf16_f32 v81,v82,v83
ds_write2st64_b64 v36,v[240:241],v[76:77] offset0:16 offset1:24
v_accvgpr_read_b32 v88,a16
v_accvgpr_read_b32 v89,a17
v_pk_mul_f32 v[88:89],v[88:89],v[62:63] op_sel_hi:[1,0]
v_accvgpr_read_b32 v92,a32
v_accvgpr_read_b32 v93,a33
v_pk_mul_f32 v[92:93],v[92:93],v[62:63] op_sel_hi:[1,0]
v_accvgpr_read_b32 v212,a20
v_accvgpr_read_b32 v213,a21
v_pk_mul_f32 v[212:213],v[212:213],v[62:63] op_sel_hi:[1,0]
v_accvgpr_read_b32 v228,a36
v_accvgpr_read_b32 v229,a37
ds_write2st64_b64 v37,v[244:245],v[104:105] offset0:16 offset1:24
v_pk_mul_f32 v[228:229],v[228:229],v[62:63] op_sel_hi:[1,0]
v_accvgpr_read_b32 v90,a18
v_accvgpr_read_b32 v91,a19
s_waitcnt lgkmcnt(3)
buffer_store_dwordx4 v[96:99],v9,s[16:19],s85 offen offset:0 nt
v_pk_mul_f32 v[90:91],v[90:91],v[62:63] op_sel_hi:[1,0]
v_accvgpr_read_b32 v94,a34
v_accvgpr_read_b32 v95,a35
v_pk_mul_f32 v[94:95],v[94:95],v[62:63] op_sel_hi:[1,0]
v_accvgpr_read_b32 v214,a22
v_accvgpr_read_b32 v215,a23
v_pk_mul_f32 v[214:215],v[214:215],v[62:63] op_sel_hi:[1,0]
v_accvgpr_read_b32 v230,a38
v_accvgpr_read_b32 v231,a39
ds_write2st64_b64 v42,v[248:249],v[108:109] offset0:16 offset1:24
v_pk_mul_f32 v[230:231],v[230:231],v[62:63] op_sel_hi:[1,0]
v_accvgpr_read_b32 v216,a24
v_accvgpr_read_b32 v217,a25
buffer_store_dwordx4 v[100:103],v9,s[16:19],s85 offen offset:3072 nt
v_pk_mul_f32 v[216:217],v[216:217],v[62:63] op_sel_hi:[1,0]
v_accvgpr_read_b32 v232,a40
v_accvgpr_read_b32 v233,a41
v_pk_mul_f32 v[232:233],v[232:233],v[62:63] op_sel_hi:[1,0]
v_cvt_pk_bf16_f32 v88,v88,v89
v_cvt_pk_bf16_f32 v92,v92,v93
v_accvgpr_read_b32 v218,a26
v_accvgpr_read_b32 v219,a27
v_pk_mul_f32 v[218:219],v[218:219],v[62:63] op_sel_hi:[1,0]
ds_write2st64_b64 v43,v[252:253],v[80:81] offset0:16 offset1:24
v_accvgpr_read_b32 v234,a42
v_accvgpr_read_b32 v235,a43
v_pk_mul_f32 v[234:235],v[234:235],v[62:63] op_sel_hi:[1,0]
ds_read_b128 v[156:159],v10 offset:8192
ds_read_b128 v[84:87],v10 offset:11264
buffer_store_dwordx4 v[72:75],v9,s[16:19],s85 offen offset:128 nt
ds_read_b128 v[208:211],v10 offset:12288
v_accvgpr_read_b32 v220,a28
ds_read_b128 v[224:227],v10 offset:15360
v_accvgpr_read_b32 v221,a29
v_pk_mul_f32 v[220:221],v[220:221],v[62:63] op_sel_hi:[1,0]
v_accvgpr_read_b32 v236,a44
v_accvgpr_read_b32 v237,a45
v_pk_mul_f32 v[236:237],v[236:237],v[62:63] op_sel_hi:[1,0]
s_waitcnt lgkmcnt(5)
buffer_store_dwordx4 v[152:155],v9,s[16:19],s85 offen offset:3200 nt
v_cvt_pk_bf16_f32 v212,v212,v213
v_cvt_pk_bf16_f32 v228,v228,v229
v_cvt_pk_bf16_f32 v89,v90,v91
v_cvt_pk_bf16_f32 v93,v94,v95
v_accvgpr_read_b32 v222,a30
v_accvgpr_read_b32 v223,a31
v_pk_mul_f32 v[222:223],v[222:223],v[62:63] op_sel_hi:[1,0]
v_accvgpr_read_b32 v238,a46
v_accvgpr_read_b32 v239,a47
ds_write2st64_b64 v36,v[88:89],v[92:93] offset0:26 offset1:28
v_pk_mul_f32 v[238:239],v[238:239],v[62:63] op_sel_hi:[1,0]
v_cvt_pk_bf16_f32 v216,v216,v217
v_cvt_pk_bf16_f32 v232,v232,v233
s_waitcnt lgkmcnt(2)
buffer_store_dwordx4 v[156:159],v9,s[16:19],s85 offen offset:256 nt
v_cvt_pk_bf16_f32 v213,v214,v215
v_cvt_pk_bf16_f32 v229,v230,v231
v_cvt_pk_bf16_f32 v220,v220,v221
v_cvt_pk_bf16_f32 v236,v236,v237
v_cvt_pk_bf16_f32 v217,v218,v219
v_cvt_pk_bf16_f32 v233,v234,v235
v_cvt_pk_bf16_f32 v221,v222,v223
v_cvt_pk_bf16_f32 v237,v238,v239
v_cvt_pk_bf16_f32 v160,v160,v161
ds_write2st64_b64 v37,v[212:213],v[228:229] offset0:26 offset1:28
v_cvt_pk_bf16_f32 v176,v176,v177
v_cvt_pk_bf16_f32 v164,v164,v165
v_cvt_pk_bf16_f32 v180,v180,v181
buffer_store_dwordx4 v[84:87],v9,s[16:19],s85 offen offset:3328 nt
v_cvt_pk_bf16_f32 v161,v162,v163
v_cvt_pk_bf16_f32 v177,v178,v179
v_cvt_pk_bf16_f32 v168,v168,v169
v_cvt_pk_bf16_f32 v184,v184,v185
v_cvt_pk_bf16_f32 v165,v166,v167
v_cvt_pk_bf16_f32 v181,v182,v183
v_cvt_pk_bf16_f32 v172,v172,v173
v_cvt_pk_bf16_f32 v188,v188,v189
v_cvt_pk_bf16_f32 v169,v170,v171
ds_write2st64_b64 v42,v[216:217],v[232:233] offset0:26 offset1:28
v_cvt_pk_bf16_f32 v185,v186,v187
v_cvt_pk_bf16_f32 v173,v174,v175
v_cvt_pk_bf16_f32 v189,v190,v191
buffer_store_dwordx4 v[208:211],v9,s[16:19],s86 offen offset:0 nt
v_cvt_pk_bf16_f32 v192,v192,v193
v_cvt_pk_bf16_f32 v196,v196,v197
v_cvt_pk_bf16_f32 v193,v194,v195
v_cvt_pk_bf16_f32 v200,v200,v201
v_cvt_pk_bf16_f32 v197,v198,v199
v_cvt_pk_bf16_f32 v204,v204,v205
v_cvt_pk_bf16_f32 v201,v202,v203
v_cvt_pk_bf16_f32 v205,v206,v207
ds_write2st64_b64 v43,v[220:221],v[236:237] offset0:26 offset1:28
ds_read_b128 v[76:79],v10 offset:13312
ds_read_b128 v[240:243],v10 offset:16384
s_waitcnt lgkmcnt(3)
buffer_store_dwordx4 v[224:227],v9,s[16:19],s86 offen offset:3072 nt
ds_read_b128 v[152:155],v10 offset:14336
ds_read_b128 v[72:75],v10 offset:17408
ds_write2st64_b64 v36,v[160:161],v[176:177] offset0:0 offset1:2
ds_write2st64_b64 v37,v[164:165],v[180:181] offset0:0 offset1:2
s_waitcnt lgkmcnt(2)
buffer_store_dwordx4 v[76:79],v9,s[16:19],s86 offen offset:128 nt
ds_write2st64_b64 v42,v[168:169],v[184:185] offset0:0 offset1:2
buffer_store_dwordx4 v[240:243],v9,s[16:19],s86 offen offset:3200 nt
ds_write2st64_b64 v43,v[172:173],v[188:189] offset0:0 offset1:2
ds_read_b128 v[96:99],v10 offset:0
ds_read_b128 v[100:103],v10 offset:3072
buffer_store_dwordx4 v[152:155],v9,s[16:19],s86 offen offset:256 nt
ds_read_b128 v[104:107],v10 offset:1024
ds_read_b128 v[244:247],v10 offset:4096
ds_write_b64 v36,v[192:193] offset:2048
buffer_store_dwordx4 v[72:75],v9,s[16:19],s86 offen offset:3328 nt
ds_write_b64 v37,v[196:197] offset:2048
s_waitcnt lgkmcnt(4)
buffer_store_dwordx4 v[96:99],v9,s[16:19],s84 offen offset:0 nt
ds_write_b64 v42,v[200:201] offset:2048
buffer_store_dwordx4 v[100:103],v9,s[16:19],s84 offen offset:3072 nt
ds_write_b64 v43,v[204:205] offset:2048
ds_read_b128 v[108:111],v10 offset:2048
ds_read_b128 v[248:251],v10 offset:5120
s_waitcnt lgkmcnt(4)
buffer_store_dwordx4 v[104:107],v9,s[16:19],s84 offen offset:128 nt
buffer_store_dwordx4 v[244:247],v9,s[16:19],s84 offen offset:3200 nt
s_waitcnt lgkmcnt(1)
buffer_store_dwordx4 v[108:111],v9,s[16:19],s84 offen offset:256 nt
s_waitcnt lgkmcnt(0)
buffer_store_dwordx4 v[248:251],v9,s[16:19],s84 offen offset:3328 nt
s_branch L_fin
L_fin:
s_waitcnt vmcnt(0)
L_stamped:
s_cmp_lg_u32 s31,0
s_cbranch_scc1 L_fix
L_done:
L_end:
s_endpgm
L_fix:
s_sub_u32 s62,s24,36864
v_add_u32 v112,s62,v2
v_add_u32 v113,s62,v3
v_add_u32 v114,s62,v4
v_add_u32 v115,s62,v5
v_mbcnt_lo_u32_b32 v156,-1,0
v_mbcnt_hi_u32_b32 v156,-1,v156
v_and_b32 v153,15,v156
v_mul_u32_u24 v153,384,v153
v_lshrrev_b32 v154,4,v156
v_lshl_add_u32 v155,v154,3,v153
v_lshl_add_u32 v153,v154,4,v153
L_fix_pass:
s_ff1_i32_b32 s50,s31
s_bitset0_b32 s31,s50
s_lshl_b32 s62,s50,5
s_add_u32 s62,s62,s34
s_mul_i32 s63,s62,171
s_lshr_b32 s63,s63,9
s_mul_i32 s64,s63,3
s_sub_u32 s62,s62,s64
s_add_u32 s63,s63,s33
s_mul_i32 s30,s63,196608
s_mul_i32 s41,s63,325632
s_lshl_b32 s63,s3,2
s_add_u32 s64,s63,21
s_cmp_eq_u32 s3,0
s_cselect_b32 s64,20,s64
s_cselect_b32 s40,1,0
s_add_u32 s65,s63,37
s_cmp_eq_u32 s62,2
s_cselect_b32 s64,s65,s64
s_cselect_b32 s40,0,s40
s_add_u32 s65,s63,s3
s_cmp_eq_u32 s62,0
s_cselect_b32 s64,s65,s64
s_cselect_b32 s40,1,s40
s_mul_i32 s64,s64,6144
s_add_u32 s41,s41,s64
s_add_u32 s55,s40,4
s_mov_b32 s51,0
L_fix_tile:
buffer_load_dwordx4 a[144:147],v153,s[12:15],s41 offen offset:0
buffer_load_dwordx4 a[148:151],v153,s[12:15],s41 offen offset:64
buffer_load_dwordx4 a[152:155],v153,s[12:15],s41 offen offset:128
buffer_load_dwordx4 a[156:159],v153,s[12:15],s41 offen offset:192
buffer_load_dwordx4 a[160:163],v153,s[12:15],s41 offen offset:256
buffer_load_dwordx4 a[164:167],v153,s[12:15],s41 offen offset:320
v_mov_b32 v152,0xff800000
s_mov_b32 s53,s30
s_mov_b32 s52,0
L_fix_max:
s_mov_b32 s63,s53
s_add_u32 m0,s24,0
s_nop 0
buffer_load_dwordx4 v6,s[4:7],s63 offen offset:0 lds
buffer_load_dwordx4 v7,s[4:7],s63 offen offset:1024 lds
buffer_load_dwordx4 v8,s[4:7],s63 offen offset:2048 lds
s_add_u32 s63,s63,3072
s_add_u32 m0,s24,3072
s_nop 0
buffer_load_dwordx4 v6,s[4:7],s63 offen offset:0 lds
buffer_load_dwordx4 v7,s[4:7],s63 offen offset:1024 lds
buffer_load_dwordx4 v8,s[4:7],s63 offen offset:2048 lds
s_add_u32 s63,s63,3072
s_add_u32 m0,s24,6144
s_nop 0
buffer_load_dwordx4 v6,s[4:7],s63 offen offset:0 lds
buffer_load_dwordx4 v7,s[4:7],s63 offen offset:1024 lds
buffer_load_dwordx4 v8,s[4:7],s63 offen offset:2048 lds
s_add_u32 s63,s63,3072
s_add_u32 m0,s24,9216
s_nop 0
buffer_load_dwordx4 v6,s[4:7],s63 offen offset:0 lds
buffer_load_dwordx4 v7,s[4:7],s63 offen offset:1024 lds
buffer_load_dwordx4 v8,s[4:7],s63 offen offset:2048 lds
s_add_u32 s63,s63,3072
s_waitcnt vmcnt(0)
ds_read_b128 a[0:3],v11 offset:0
ds_read_b128 a[4:7],v12 offset:0
ds_read_b128 a[8:11],v11 offset:128
ds_read_b128 a[12:15],v12 offset:128
ds_read_b128 a[16:19],v11 offset:256
ds_read_b128 a[20:23],v12 offset:256
ds_read_b128 a[24:27],v11 offset:6144
ds_read_b128 a[28:31],v12 offset:6144
ds_read_b128 a[32:35],v11 offset:6272
ds_read_b128 a[36:39],v12 offset:6272
ds_read_b128 a[40:43],v11 offset:6400
ds_read_b128 a[44:47],v12 offset:6400
s_waitcnt lgkmcnt(0)
v_mfma_f32_16x16x32_bf16 v[72:75],a[0:3],a[144:147],0
v_mfma_f32_16x16x32_bf16 v[72:75],a[4:7],a[148:151],v[72:75]
v_mfma_f32_16x16x32_bf16 v[72:75],a[8:11],a[152:155],v[72:75]
v_mfma_f32_16x16x32_bf16 v[72:75],a[12:15],a[156:159],v[72:75]
v_mfma_f32_16x16x32_bf16 v[72:75],a[16:19],a[160:163],v[72:75]
v_mfma_f32_16x16x32_bf16 v[72:75],a[20:23],a[164:167],v[72:75]
v_mfma_f32_16x16x32_bf16 v[76:79],a[24:27],a[144:147],0
v_mfma_f32_16x16x32_bf16 v[76:79],a[28:31],a[148:151],v[76:79]
v_mfma_f32_16x16x32_bf16 v[76:79],a[32:35],a[152:155],v[76:79]
v_mfma_f32_16x16x32_bf16 v[76:79],a[36:39],a[156:159],v[76:79]
v_mfma_f32_16x16x32_bf16 v[76:79],a[40:43],a[160:163],v[76:79]
v_mfma_f32_16x16x32_bf16 v[76:79],a[44:47],a[164:167],v[76:79]
s_nop 7
v_max3_f32 v152,v152,v72,v73
v_max3_f32 v152,v152,v74,v75
v_max3_f32 v152,v152,v76,v77
v_max3_f32 v152,v152,v78,v79
s_add_u32 s53,s53,12288
s_add_u32 s52,s52,1
s_cmp_lt_u32 s52,16
s_cbranch_scc1 L_fix_max
v_mov_b32 v156,v152
s_nop 1
v_permlane32_swap_b32 v156,v152
v_max_f32 v152,v152,v156
v_mov_b32 v156,v152
s_nop 1
v_permlane16_swap_b32 v156,v152
v_max_f32 v152,v152,v156
v_mul_f32_e64 v13,-s36,v152
v_mov_b32 v160,0
v_mov_b32 v161,0
v_mov_b32 v162,0
v_mov_b32 v163,0
v_mov_b32 v164,0
v_mov_b32 v165,0
v_mov_b32 v166,0
v_mov_b32 v167,0
v_mov_b32 v168,0
v_mov_b32 v169,0
v_mov_b32 v170,0
v_mov_b32 v171,0
v_mov_b32 v172,0
v_mov_b32 v173,0
v_mov_b32 v174,0
v_mov_b32 v175,0
v_mov_b32 v176,0
v_mov_b32 v177,0
v_mov_b32 v178,0
v_mov_b32 v179,0
v_mov_b32 v180,0
v_mov_b32 v181,0
v_mov_b32 v182,0
v_mov_b32 v183,0
v_mov_b32 v184,0
v_mov_b32 v185,0
v_mov_b32 v186,0
v_mov_b32 v187,0
v_mov_b32 v188,0
v_mov_b32 v189,0
v_mov_b32 v190,0
v_mov_b32 v191,0
v_mov_b32 v192,0
v_mov_b32 v193,0
v_mov_b32 v194,0
v_mov_b32 v195,0
v_mov_b32 v196,0
v_mov_b32 v197,0
v_mov_b32 v198,0
v_mov_b32 v199,0
v_mov_b32 v200,0
v_mov_b32 v201,0
v_mov_b32 v202,0
v_mov_b32 v203,0
v_mov_b32 v204,0
v_mov_b32 v205,0
v_mov_b32 v206,0
v_mov_b32 v207,0
v_mov_b32 v52,0
v_mov_b32 v53,0
v_mov_b32 v54,0
v_mov_b32 v55,0
s_mov_b32 s53,s30
s_mov_b32 s52,0
L_fix_acc:
s_mov_b32 s63,s53
s_add_u32 m0,s24,0
s_nop 0
buffer_load_dwordx4 v6,s[4:7],s63 offen offset:0 lds
buffer_load_dwordx4 v7,s[4:7],s63 offen offset:1024 lds
buffer_load_dwordx4 v8,s[4:7],s63 offen offset:2048 lds
s_add_u32 s63,s63,3072
s_add_u32 m0,s24,3072
s_nop 0
buffer_load_dwordx4 v6,s[4:7],s63 offen offset:0 lds
buffer_load_dwordx4 v7,s[4:7],s63 offen offset:1024 lds
buffer_load_dwordx4 v8,s[4:7],s63 offen offset:2048 lds
s_add_u32 s63,s63,3072
s_add_u32 m0,s24,6144
s_nop 0
buffer_load_dwordx4 v6,s[4:7],s63 offen offset:0 lds
buffer_load_dwordx4 v7,s[4:7],s63 offen offset:1024 lds
buffer_load_dwordx4 v8,s[4:7],s63 offen offset:2048 lds
s_add_u32 s63,s63,3072
s_add_u32 m0,s24,9216
s_nop 0
buffer_load_dwordx4 v6,s[4:7],s63 offen offset:0 lds
buffer_load_dwordx4 v7,s[4:7],s63 offen offset:1024 lds
buffer_load_dwordx4 v8,s[4:7],s63 offen offset:2048 lds
s_add_u32 s63,s63,3072
s_waitcnt vmcnt(0)
ds_read_b128 a[0:3],v11 offset:0
ds_read_b128 a[4:7],v12 offset:0
ds_read_b128 a[8:11],v11 offset:128
ds_read_b128 a[12:15],v12 offset:128
ds_read_b128 a[16:19],v11 offset:256
ds_read_b128 a[20:23],v12 offset:256
ds_read_b128 a[24:27],v11 offset:6144
ds_read_b128 a[28:31],v12 offset:6144
ds_read_b128 a[32:35],v11 offset:6272
ds_read_b128 a[36:39],v12 offset:6272
ds_read_b128 a[40:43],v11 offset:6400
ds_read_b128 a[44:47],v12 offset:6400
s_waitcnt lgkmcnt(0)
v_mfma_f32_16x16x32_bf16 v[72:75],a[0:3],a[144:147],0
v_mfma_f32_16x16x32_bf16 v[72:75],a[4:7],a[148:151],v[72:75]
v_mfma_f32_16x16x32_bf16 v[72:75],a[8:11],a[152:155],v[72:75]
v_mfma_f32_16x16x32_bf16 v[72:75],a[12:15],a[156:159],v[72:75]
v_mfma_f32_16x16x32_bf16 v[72:75],a[16:19],a[160:163],v[72:75]
v_mfma_f32_16x16x32_bf16 v[72:75],a[20:23],a[164:167],v[72:75]
v_mfma_f32_16x16x32_bf16 v[76:79],a[24:27],a[144:147],0
v_mfma_f32_16x16x32_bf16 v[76:79],a[28:31],a[148:151],v[76:79]
v_mfma_f32_16x16x32_bf16 v[76:79],a[32:35],a[152:155],v[76:79]
v_mfma_f32_16x16x32_bf16 v[76:79],a[36:39],a[156:159],v[76:79]
v_mfma_f32_16x16x32_bf16 v[76:79],a[40:43],a[160:163],v[76:79]
v_mfma_f32_16x16x32_bf16 v[76:79],a[44:47],a[164:167],v[76:79]
s_nop 7
v_fma_f32 v72,v72,s36,v13
v_fma_f32 v73,v73,s36,v13
v_exp_f32 v72,v72
v_exp_f32 v73,v73
s_nop 0
v_cvt_pk_bf16_f32 v18,v72,v73
v_fma_f32 v74,v74,s36,v13
v_fma_f32 v75,v75,s36,v13
v_exp_f32 v74,v74
v_exp_f32 v75,v75
s_nop 0
v_cvt_pk_bf16_f32 v19,v74,v75
v_fma_f32 v76,v76,s36,v13
v_fma_f32 v77,v77,s36,v13
v_exp_f32 v76,v76
v_exp_f32 v77,v77
s_nop 0
v_cvt_pk_bf16_f32 v20,v76,v77
v_fma_f32 v78,v78,s36,v13
v_fma_f32 v79,v79,s36,v13
v_exp_f32 v78,v78
v_exp_f32 v79,v79
s_nop 0
v_cvt_pk_bf16_f32 v21,v78,v79
s_nop 1
v_mfma_f32_16x16x32_bf16 v[52:55],v[48:51],v[18:21],v[52:55]
s_mov_b32 s63,s53
s_add_u32 m0,s24,0
s_nop 0
buffer_load_dwordx4 v6,s[8:11],s63 offen offset:0 lds
buffer_load_dwordx4 v7,s[8:11],s63 offen offset:1024 lds
buffer_load_dwordx4 v8,s[8:11],s63 offen offset:2048 lds
s_add_u32 s63,s63,3072
s_add_u32 m0,s24,3072
s_nop 0
buffer_load_dwordx4 v6,s[8:11],s63 offen offset:0 lds
buffer_load_dwordx4 v7,s[8:11],s63 offen offset:1024 lds
buffer_load_dwordx4 v8,s[8:11],s63 offen offset:2048 lds
s_add_u32 s63,s63,3072
s_add_u32 m0,s24,6144
s_nop 0
buffer_load_dwordx4 v6,s[8:11],s63 offen offset:0 lds
buffer_load_dwordx4 v7,s[8:11],s63 offen offset:1024 lds
buffer_load_dwordx4 v8,s[8:11],s63 offen offset:2048 lds
s_add_u32 s63,s63,3072
s_add_u32 m0,s24,9216
s_nop 0
buffer_load_dwordx4 v6,s[8:11],s63 offen offset:0 lds
buffer_load_dwordx4 v7,s[8:11],s63 offen offset:1024 lds
buffer_load_dwordx4 v8,s[8:11],s63 offen offset:2048 lds
s_add_u32 s63,s63,3072
s_waitcnt vmcnt(0)
ds_read_b64_tr_b16 a[0:1],v112 offset:0
ds_read_b64_tr_b16 a[2:3],v112 offset:6144
ds_read_b64_tr_b16 a[4:5],v113 offset:0
ds_read_b64_tr_b16 a[6:7],v113 offset:6144
ds_read_b64_tr_b16 a[8:9],v114 offset:0
ds_read_b64_tr_b16 a[10:11],v114 offset:6144
ds_read_b64_tr_b16 a[12:13],v115 offset:0
ds_read_b64_tr_b16 a[14:15],v115 offset:6144
ds_read_b64_tr_b16 a[16:17],v112 offset:128
ds_read_b64_tr_b16 a[18:19],v112 offset:6272
ds_read_b64_tr_b16 a[20:21],v113 offset:128
ds_read_b64_tr_b16 a[22:23],v113 offset:6272
ds_read_b64_tr_b16 a[24:25],v114 offset:128
ds_read_b64_tr_b16 a[26:27],v114 offset:6272
ds_read_b64_tr_b16 a[28:29],v115 offset:128
ds_read_b64_tr_b16 a[30:31],v115 offset:6272
ds_read_b64_tr_b16 a[32:33],v112 offset:256
ds_read_b64_tr_b16 a[34:35],v112 offset:6400
ds_read_b64_tr_b16 a[36:37],v113 offset:256
ds_read_b64_tr_b16 a[38:39],v113 offset:6400
ds_read_b64_tr_b16 a[40:41],v114 offset:256
ds_read_b64_tr_b16 a[42:43],v114 offset:6400
ds_read_b64_tr_b16 a[44:45],v115 offset:256
ds_read_b64_tr_b16 a[46:47],v115 offset:6400
s_waitcnt lgkmcnt(0)
v_mfma_f32_16x16x32_bf16 v[160:163],a[0:3],v[18:21],v[160:163]
v_mfma_f32_16x16x32_bf16 v[164:167],a[4:7],v[18:21],v[164:167]
v_mfma_f32_16x16x32_bf16 v[168:171],a[8:11],v[18:21],v[168:171]
v_mfma_f32_16x16x32_bf16 v[172:175],a[12:15],v[18:21],v[172:175]
v_mfma_f32_16x16x32_bf16 v[176:179],a[16:19],v[18:21],v[176:179]
v_mfma_f32_16x16x32_bf16 v[180:183],a[20:23],v[18:21],v[180:183]
v_mfma_f32_16x16x32_bf16 v[184:187],a[24:27],v[18:21],v[184:187]
v_mfma_f32_16x16x32_bf16 v[188:191],a[28:31],v[18:21],v[188:191]
v_mfma_f32_16x16x32_bf16 v[192:195],a[32:35],v[18:21],v[192:195]
v_mfma_f32_16x16x32_bf16 v[196:199],a[36:39],v[18:21],v[196:199]
v_mfma_f32_16x16x32_bf16 v[200:203],a[40:43],v[18:21],v[200:203]
v_mfma_f32_16x16x32_bf16 v[204:207],a[44:47],v[18:21],v[204:207]
s_add_u32 s53,s53,12288
s_add_u32 s52,s52,1
s_cmp_lt_u32 s52,16
s_cbranch_scc1 L_fix_acc
s_nop 7
v_rcp_f32 v156,v52
s_nop 0
v_mul_f32 v160,v160,v156
v_mul_f32 v161,v161,v156
v_mul_f32 v162,v162,v156
v_mul_f32 v163,v163,v156
v_cvt_pk_bf16_f32 v160,v160,v161
v_cvt_pk_bf16_f32 v161,v162,v163
buffer_store_dwordx2 v[160:161],v155,s[16:19],s41 offen offset:0
v_mul_f32 v164,v164,v156
v_mul_f32 v165,v165,v156
v_mul_f32 v166,v166,v156
v_mul_f32 v167,v167,v156
v_cvt_pk_bf16_f32 v164,v164,v165
v_cvt_pk_bf16_f32 v165,v166,v167
buffer_store_dwordx2 v[164:165],v155,s[16:19],s41 offen offset:32
v_mul_f32 v168,v168,v156
v_mul_f32 v169,v169,v156
v_mul_f32 v170,v170,v156
v_mul_f32 v171,v171,v156
v_cvt_pk_bf16_f32 v168,v168,v169
v_cvt_pk_bf16_f32 v169,v170,v171
buffer_store_dwordx2 v[168:169],v155,s[16:19],s41 offen offset:64
v_mul_f32 v172,v172,v156
v_mul_f32 v173,v173,v156
v_mul_f32 v174,v174,v156
v_mul_f32 v175,v175,v156
v_cvt_pk_bf16_f32 v172,v172,v173
v_cvt_pk_bf16_f32 v173,v174,v175
buffer_store_dwordx2 v[172:173],v155,s[16:19],s41 offen offset:96
v_mul_f32 v176,v176,v156
v_mul_f32 v177,v177,v156
v_mul_f32 v178,v178,v156
v_mul_f32 v179,v179,v156
v_cvt_pk_bf16_f32 v176,v176,v177
v_cvt_pk_bf16_f32 v177,v178,v179
buffer_store_dwordx2 v[176:177],v155,s[16:19],s41 offen offset:128
v_mul_f32 v180,v180,v156
v_mul_f32 v181,v181,v156
v_mul_f32 v182,v182,v156
v_mul_f32 v183,v183,v156
v_cvt_pk_bf16_f32 v180,v180,v181
v_cvt_pk_bf16_f32 v181,v182,v183
buffer_store_dwordx2 v[180:181],v155,s[16:19],s41 offen offset:160
v_mul_f32 v184,v184,v156
v_mul_f32 v185,v185,v156
v_mul_f32 v186,v186,v156
v_mul_f32 v187,v187,v156
v_cvt_pk_bf16_f32 v184,v184,v185
v_cvt_pk_bf16_f32 v185,v186,v187
buffer_store_dwordx2 v[184:185],v155,s[16:19],s41 offen offset:192
v_mul_f32 v188,v188,v156
v_mul_f32 v189,v189,v156
v_mul_f32 v190,v190,v156
v_mul_f32 v191,v191,v156
v_cvt_pk_bf16_f32 v188,v188,v189
v_cvt_pk_bf16_f32 v189,v190,v191
buffer_store_dwordx2 v[188:189],v155,s[16:19],s41 offen offset:224
v_mul_f32 v192,v192,v156
v_mul_f32 v193,v193,v156
v_mul_f32 v194,v194,v156
v_mul_f32 v195,v195,v156
v_cvt_pk_bf16_f32 v192,v192,v193
v_cvt_pk_bf16_f32 v193,v194,v195
buffer_store_dwordx2 v[192:193],v155,s[16:19],s41 offen offset:256
v_mul_f32 v196,v196,v156
v_mul_f32 v197,v197,v156
v_mul_f32 v198,v198,v156
v_mul_f32 v199,v199,v156
v_cvt_pk_bf16_f32 v196,v196,v197
v_cvt_pk_bf16_f32 v197,v198,v199
buffer_store_dwordx2 v[196:197],v155,s[16:19],s41 offen offset:288
v_mul_f32 v200,v200,v156
v_mul_f32 v201,v201,v156
v_mul_f32 v202,v202,v156
v_mul_f32 v203,v203,v156
v_cvt_pk_bf16_f32 v200,v200,v201
v_cvt_pk_bf16_f32 v201,v202,v203
buffer_store_dwordx2 v[200:201],v155,s[16:19],s41 offen offset:320
v_mul_f32 v204,v204,v156
v_mul_f32 v205,v205,v156
v_mul_f32 v206,v206,v156
v_mul_f32 v207,v207,v156
v_cvt_pk_bf16_f32 v204,v204,v205
v_cvt_pk_bf16_f32 v205,v206,v207
buffer_store_dwordx2 v[204:205],v155,s[16:19],s41 offen offset:352
s_waitcnt vmcnt(0)
s_add_u32 s41,s41,6144
s_add_u32 s51,s51,1
s_cmp_lt_u32 s51,s55
s_cbranch_scc1 L_fix_tile
s_cmp_lg_u32 s31,0
s_cbranch_scc1 L_fix_pass
s_branch L_done
L_codeend:
.section .rodata,"a"
.p2align 6
.amdhsa_kernel standalone__gqa_softmax__near_ridge_kernel
  .amdhsa_next_free_vgpr 512
  .amdhsa_next_free_sgpr 102
  .amdhsa_accum_offset 256
  .amdhsa_group_segment_fixed_size 0
  .amdhsa_kernarg_size 48
  .amdhsa_user_sgpr_count 2
  .amdhsa_user_sgpr_kernarg_segment_ptr 1
  .amdhsa_system_sgpr_workgroup_id_x 1
.end_amdhsa_kernel
```

```asm
; @launch grid=(256,1,1) block=(256,1,1) lds=163840
.amdgcn_target "amdgcn-amd-amdhsa--gfx950"
.text
.globl standalone__gqa_softmax__near_ridge_kernel
.p2align 8
.type standalone__gqa_softmax__near_ridge_kernel,@function
standalone__gqa_softmax__near_ridge_kernel:
s_cmp_ge_u32 s2,256
s_cbranch_scc1 L_end
s_load_dwordx4 s[84:87],s[0:1],0
s_load_dwordx4 s[88:91],s[0:1],16
v_lshrrev_b32 v156,6,v0
v_and_b32 v19,63,v0
v_readfirstlane_b32 s3,v156
s_lshr_b32 s34,s2,3
s_getpc_b64 s[92:93]
L_pc:
s_mul_i32 s62,s34,4096
v_min_u32 v156,31,v19
v_lshlrev_b32 v156,7,v156
v_add_u32 v156,s62,v156
v_min_u32 v156,L_codeend-L_pc-4,v156
s_cmp_lg_u32 s3,0
s_cbranch_scc1 L_nopre
global_load_dword v60,v156,s[92:93]
L_nopre:
v_lshrrev_b32 v156,3,v19
v_and_b32 v158,7,v19
v_add_u32 v157,0,v156
v_mul_u32_u24 v157,43,v157
v_lshrrev_b32 v157,7,v157
v_and_b32 v157,6,v157
v_xor_b32 v157,v157,v158
v_lshlrev_b32 v157,4,v157
v_lshl_add_u32 v6,v156,7,v157
v_add_u32 v157,8,v156
v_mul_u32_u24 v157,43,v157
v_lshrrev_b32 v157,7,v157
v_and_b32 v157,6,v157
v_xor_b32 v157,v157,v158
v_lshlrev_b32 v157,4,v157
v_lshl_add_u32 v7,v156,7,v157
v_add_u32 v157,16,v156
v_mul_u32_u24 v157,43,v157
v_lshrrev_b32 v157,7,v157
v_and_b32 v157,6,v157
v_xor_b32 v157,v157,v158
v_lshlrev_b32 v157,4,v157
v_lshl_add_u32 v8,v156,7,v157
s_mov_b32 s37,0x5d800000
s_mov_b32 s36,0x3dd53b95
s_mov_b32 s31,0
s_mov_b32 s32,1
s_and_b32 s62,s2,7
s_lshl_b32 s33,s62,6
s_mul_i32 s22,s3,3072
s_add_u32 s23,s22,36864
s_mul_i32 s24,s3,22528
s_add_u32 s24,s24,73728
s_mov_b32 s69,0
s_lshl_b32 s62,s69,5
s_add_u32 s62,s62,s34
s_mul_i32 s63,s62,171
s_lshr_b32 s63,s63,9
s_mul_i32 s64,s63,3
s_sub_u32 s62,s62,s64
s_add_u32 s63,s63,s33
s_mul_i32 s30,s63,196608
s_mul_i32 s41,s63,325632
s_lshl_b32 s63,s3,2
s_add_u32 s64,s63,21
s_cmp_eq_u32 s3,0
s_cselect_b32 s64,20,s64
s_cselect_b32 s40,1,0
s_add_u32 s65,s63,37
s_cmp_eq_u32 s62,2
s_cselect_b32 s64,s65,s64
s_cselect_b32 s40,0,s40
s_add_u32 s65,s63,s3
s_cmp_eq_u32 s62,0
s_cselect_b32 s64,s65,s64
s_cselect_b32 s40,1,s40
s_mul_i32 s64,s64,6144
s_add_u32 s41,s41,s64
s_add_u32 s20,s30,s22
s_mov_b32 s21,s20
s_waitcnt lgkmcnt(0)
s_mov_b32 s4,s86
s_and_b32 s5,s87,0xffff
s_mov_b32 s6,100663296
s_mov_b32 s7,0x20000
s_mov_b32 s12,s84
s_and_b32 s13,s85,0xffff
s_mov_b32 s14,166723584
s_mov_b32 s15,0x20000
s_mov_b32 s8,s88
s_and_b32 s9,s89,0xffff
s_mov_b32 s10,100663296
s_mov_b32 s11,0x20000
s_mov_b32 s16,s90
s_and_b32 s17,s91,0xffff
s_mov_b32 s18,166723584
s_mov_b32 s19,0x20000
s_mov_b32 s28,s41
s_add_u32 m0,s22,0
s_nop 0
buffer_load_dwordx4 v6,s[4:7],s20 offen offset:0 lds
buffer_load_dwordx4 v7,s[4:7],s20 offen offset:1024 lds
buffer_load_dwordx4 v8,s[4:7],s20 offen offset:2048 lds
s_add_u32 s20,s20,12288
s_add_u32 m0,s24,0
s_nop 0
buffer_load_dwordx4 v6,s[12:15],s28 offen offset:0 nt lds
buffer_load_dwordx4 v7,s[12:15],s28 offen offset:1024 nt lds
buffer_load_dwordx4 v8,s[12:15],s28 offen offset:2048 nt lds
s_add_u32 s28,s28,3072
s_add_u32 m0,s24,3072
s_nop 0
buffer_load_dwordx4 v6,s[12:15],s28 offen offset:0 nt lds
buffer_load_dwordx4 v7,s[12:15],s28 offen offset:1024 nt lds
buffer_load_dwordx4 v8,s[12:15],s28 offen offset:2048 nt lds
s_add_u32 s28,s28,3072
s_add_u32 m0,s22,12288
s_nop 0
buffer_load_dwordx4 v6,s[4:7],s20 offen offset:0 lds
buffer_load_dwordx4 v7,s[4:7],s20 offen offset:1024 lds
buffer_load_dwordx4 v8,s[4:7],s20 offen offset:2048 lds
s_add_u32 s20,s20,12288
s_add_u32 m0,s24,6144
s_nop 0
buffer_load_dwordx4 v6,s[12:15],s28 offen offset:0 nt lds
buffer_load_dwordx4 v7,s[12:15],s28 offen offset:1024 nt lds
buffer_load_dwordx4 v8,s[12:15],s28 offen offset:2048 nt lds
s_add_u32 s28,s28,3072
s_add_u32 m0,s24,9216
s_nop 0
buffer_load_dwordx4 v6,s[12:15],s28 offen offset:0 nt lds
buffer_load_dwordx4 v7,s[12:15],s28 offen offset:1024 nt lds
buffer_load_dwordx4 v8,s[12:15],s28 offen offset:2048 nt lds
s_add_u32 s28,s28,3072
v_and_b32 v156,15,v19
v_lshrrev_b32 v157,4,v19
v_mul_u32_u24 v0,384,v156
v_and_b32 v159,6,v156
v_xor_b32 v159,v159,v157
v_lshl_add_u32 v0,v159,4,v0
v_xor_b32 v1,64,v0
v_add_u32 v11,s24,v0
v_add_u32 v12,s24,v1
v_lshrrev_b32 v156,2,v19
v_mul_u32_u24 v2,384,v156
v_and_b32 v156,6,v156
v_bfe_u32 v159,v19,1,1
v_xor_b32 v156,v156,v159
v_lshl_add_u32 v2,v156,4,v2
v_and_b32 v159,1,v19
v_lshl_add_u32 v2,v159,3,v2
v_add_u32 v2,36864,v2
v_xor_b32 v3,32,v2
v_xor_b32 v4,64,v2
v_xor_b32 v5,96,v2
v_lshrrev_b32 v156,3,v19
v_and_b32 v157,7,v19
v_xor_b32 v159,v157,v156
v_lshl_add_u32 v10,v156,7,s24
v_lshl_add_u32 v10,v159,4,v10
v_mul_u32_u24 v9,384,v156
v_lshl_add_u32 v9,v157,4,v9
v_lshrrev_b32 v156,4,v19
v_xor_b32 v156,v156,v19
v_bfe_u32 v156,v156,1,1
v_subrev_u32 v156,1,v156
v_and_b32 v152,0x3f803f80,v156
v_and_b32 v153,0x3f803f80,v156
v_and_b32 v154,0x3f803f80,v156
v_and_b32 v155,0x3f803f80,v156
v_and_b32 v156,1,v19
v_mul_u32_u24 v156,0xaaaa,v156
v_add_u32 v18,0x4444,v156
s_waitcnt vmcnt(6)
s_barrier
s_cmp_eq_u32 s40,0
s_cbranch_scc1 L_start4
L_start5:
s_add_u32 m0,s24,12288
s_waitcnt vmcnt(9)
ds_read_b128 a[144:147],v11 offset:0
ds_read_b128 a[148:151],v12 offset:0
buffer_load_dwordx4 v6,s[12:15],s28 offen offset:0 nt lds
ds_read_b128 a[152:155],v11 offset:128
buffer_load_dwordx4 v7,s[12:15],s28 offen offset:1024 nt lds
ds_read_b128 a[156:159],v12 offset:128
buffer_load_dwordx4 v8,s[12:15],s28 offen offset:2048 nt lds
s_add_u32 s28,s28,3072
s_add_u32 m0,s24,15360
ds_read_b128 a[160:163],v11 offset:256
ds_read_b128 a[164:167],v12 offset:256
buffer_load_dwordx4 v6,s[12:15],s28 offen offset:0 nt lds
buffer_load_dwordx4 v7,s[12:15],s28 offen offset:1024 nt lds
buffer_load_dwordx4 v8,s[12:15],s28 offen offset:2048 nt lds
s_add_u32 s28,s28,3072
s_add_u32 m0,s24,0
ds_read_b128 v[112:115],v0 offset:0
ds_read_b128 v[116:119],v1 offset:0
v_mov_b32 v60,0
ds_read_b128 v[120:123],v0 offset:128
v_mov_b32 v61,0
ds_read_b128 v[124:127],v1 offset:128
v_mov_b32 v62,0
ds_read_b128 v[128:131],v0 offset:256
v_mov_b32 v63,0
ds_read_b128 v[132:135],v1 offset:256
v_mov_b32 v64,0
ds_read_b128 v[136:139],v0 offset:6144
v_mov_b32 v65,0
ds_read_b128 v[140:143],v1 offset:6144
v_mov_b32 v66,0
v_mov_b32 v67,0
v_mov_b32 v68,0
v_mov_b32 v69,0
v_mov_b32 v70,0
v_mov_b32 v71,0
s_waitcnt lgkmcnt(7)
v_mfma_f32_16x16x32_bf16 v[72:75],v[112:115],a[144:147],0
s_waitcnt lgkmcnt(6)
ds_read_b128 v[112:115],v0 offset:6272
v_mfma_f32_16x16x32_bf16 v[72:75],v[116:119],a[148:151],v[72:75]
s_waitcnt lgkmcnt(6)
ds_read_b128 v[116:119],v1 offset:6272
v_mfma_f32_16x16x32_bf16 v[72:75],v[120:123],a[152:155],v[72:75]
s_waitcnt lgkmcnt(6)
ds_read_b128 v[120:123],v0 offset:6400
v_mfma_f32_16x16x32_bf16 v[72:75],v[124:127],a[156:159],v[72:75]
s_waitcnt lgkmcnt(6)
ds_read_b128 v[124:127],v1 offset:6400
v_mfma_f32_16x16x32_bf16 v[72:75],v[128:131],a[160:163],v[72:75]
s_waitcnt lgkmcnt(6)
ds_read_b128 v[128:131],v0 offset:0
v_mfma_f32_16x16x32_bf16 v[72:75],v[132:135],a[164:167],v[72:75]
s_waitcnt lgkmcnt(6)
ds_read_b128 v[132:135],v1 offset:0
v_mfma_f32_16x16x32_bf16 v[76:79],v[136:139],a[144:147],0
s_waitcnt lgkmcnt(6)
ds_read_b128 v[136:139],v0 offset:128
v_mfma_f32_16x16x32_bf16 v[76:79],v[140:143],a[148:151],v[76:79]
s_waitcnt lgkmcnt(6)
ds_read_b128 v[140:143],v1 offset:128
v_mfma_f32_16x16x32_bf16 v[76:79],v[112:115],a[152:155],v[76:79]
s_waitcnt lgkmcnt(6)
ds_read_b128 v[112:115],v0 offset:256
v_mfma_f32_16x16x32_bf16 v[76:79],v[116:119],a[156:159],v[76:79]
s_waitcnt lgkmcnt(6)
ds_read_b128 v[116:119],v1 offset:256
v_max3_f32 v40,v72,v73,v74
v_mfma_f32_16x16x32_bf16 v[76:79],v[120:123],a[160:163],v[76:79]
s_waitcnt lgkmcnt(6)
ds_read_b128 v[120:123],v0 offset:6144
v_mfma_f32_16x16x32_bf16 v[76:79],v[124:127],a[164:167],v[76:79]
s_waitcnt vmcnt(6)
ds_read_b128 a[168:171],v11 offset:6144
ds_read_b128 a[172:175],v12 offset:6144
buffer_load_dwordx4 v6,s[12:15],s28 offen offset:0 nt lds
ds_read_b128 a[176:179],v11 offset:6272
buffer_load_dwordx4 v7,s[12:15],s28 offen offset:1024 nt lds
ds_read_b128 a[180:183],v12 offset:6272
buffer_load_dwordx4 v8,s[12:15],s28 offen offset:2048 nt lds
s_add_u32 s28,s28,3072
s_add_u32 m0,s24,3072
ds_read_b128 a[184:187],v11 offset:6400
ds_read_b128 a[188:191],v12 offset:6400
buffer_load_dwordx4 v6,s[12:15],s28 offen offset:0 nt lds
buffer_load_dwordx4 v7,s[12:15],s28 offen offset:1024 nt lds
buffer_load_dwordx4 v8,s[12:15],s28 offen offset:2048 nt lds
s_add_u32 s28,s28,3072
s_add_u32 m0,s24,6144
ds_read_b128 v[124:127],v1 offset:6144
v_max3_f32 v40,v40,v75,v76
v_max3_f32 v40,v40,v77,v78
v_max_f32 v40,v40,v79
v_mov_b32 v41,v40
s_waitcnt lgkmcnt(6)
v_mfma_f32_16x16x32_bf16 v[80:83],v[128:131],a[168:171],0
s_waitcnt lgkmcnt(5)
ds_read_b128 v[128:131],v0 offset:6272
v_permlane32_swap_b32 v41,v40
v_mfma_f32_16x16x32_bf16 v[80:83],v[132:135],a[172:175],v[80:83]
s_waitcnt lgkmcnt(4)
ds_read_b128 v[132:135],v1 offset:6272
v_max_f32 v40,v40,v41
v_mfma_f32_16x16x32_bf16 v[80:83],v[136:139],a[176:179],v[80:83]
ds_read_b128 v[136:139],v0 offset:6400
v_mov_b32 v41,v40
v_mfma_f32_16x16x32_bf16 v[80:83],v[140:143],a[180:183],v[80:83]
s_waitcnt lgkmcnt(4)
ds_read_b128 v[140:143],v1 offset:6400
v_permlane16_swap_b32 v41,v40
v_mfma_f32_16x16x32_bf16 v[80:83],v[112:115],a[184:187],v[80:83]
ds_read_b128 v[112:115],v0 offset:12288
v_max_f32 v40,v40,v41
v_mfma_f32_16x16x32_bf16 v[80:83],v[116:119],a[188:191],v[80:83]
ds_read_b128 v[116:119],v1 offset:12288
v_mul_f32_e64 v13,-s36,v40
v_mfma_f32_16x16x32_bf16 v[84:87],v[120:123],a[168:171],0
s_waitcnt lgkmcnt(6)
ds_read_b128 v[120:123],v0 offset:12416
v_fma_f32 v72,v72,s36,v13
v_mfma_f32_16x16x32_bf16 v[84:87],v[124:127],a[172:175],v[84:87]
ds_read_b128 v[124:127],v1 offset:12416
v_fma_f32 v73,v73,s36,v13
v_fma_f32 v74,v74,s36,v13
v_fma_f32 v75,v75,s36,v13
v_exp_f32 v72,v72
s_waitcnt lgkmcnt(7)
v_mfma_f32_16x16x32_bf16 v[84:87],v[128:131],a[176:179],v[84:87]
s_waitcnt lgkmcnt(5)
ds_read_b128 v[128:131],v0 offset:12544
v_exp_f32 v73,v73
v_mfma_f32_16x16x32_bf16 v[84:87],v[132:135],a[180:183],v[84:87]
ds_read_b128 v[132:135],v1 offset:12544
v_exp_f32 v74,v74
v_mfma_f32_16x16x32_bf16 v[84:87],v[136:139],a[184:187],v[84:87]
s_waitcnt lgkmcnt(5)
ds_read_b128 v[136:139],v0 offset:18432
v_exp_f32 v75,v75
v_mfma_f32_16x16x32_bf16 v[84:87],v[140:143],a[188:191],v[84:87]
ds_read_b128 v[140:143],v1 offset:18432
v_cvt_pk_bf16_f32 v20,v72,v73
v_cvt_pk_bf16_f32 v21,v74,v75
v_mfma_f32_16x16x32_bf16 v[72:75],v[112:115],a[144:147],0
s_waitcnt lgkmcnt(5)
ds_read_b128 v[112:115],v0 offset:18560
v_fma_f32 v76,v76,s36,v13
v_mfma_f32_16x16x32_bf16 v[72:75],v[116:119],a[148:151],v[72:75]
ds_read_b128 v[116:119],v1 offset:18560
v_fma_f32 v77,v77,s36,v13
v_mfma_f32_16x16x32_bf16 v[72:75],v[120:123],a[152:155],v[72:75]
s_waitcnt lgkmcnt(6)
ds_read_b128 v[120:123],v0 offset:18688
v_fma_f32 v78,v78,s36,v13
v_mfma_f32_16x16x32_bf16 v[72:75],v[124:127],a[156:159],v[72:75]
s_waitcnt lgkmcnt(6)
ds_read_b128 v[124:127],v1 offset:18688
v_fma_f32 v79,v79,s36,v13
v_exp_f32 v76,v76
v_mfma_f32_16x16x32_bf16 v[72:75],v[128:131],a[160:163],v[72:75]
s_waitcnt lgkmcnt(5)
ds_read_b128 v[128:131],v0 offset:0
v_exp_f32 v77,v77
v_mfma_f32_16x16x32_bf16 v[72:75],v[132:135],a[164:167],v[72:75]
ds_read_b128 v[132:135],v1 offset:0
v_exp_f32 v78,v78
v_exp_f32 v79,v79
v_cvt_pk_bf16_f32 v22,v76,v77
v_cvt_pk_bf16_f32 v23,v78,v79
v_mfma_f32_16x16x32_bf16 v[76:79],v[136:139],a[144:147],0
s_waitcnt lgkmcnt(5)
ds_read_b128 v[136:139],v0 offset:128
v_max3_f32 v44,v80,v81,v82
v_mfma_f32_16x16x32_bf16 v[76:79],v[140:143],a[148:151],v[76:79]
ds_read_b128 v[140:143],v1 offset:128
v_max3_f32 v44,v44,v83,v84
v_mfma_f32_16x16x32_bf16 v[76:79],v[112:115],a[152:155],v[76:79]
s_waitcnt lgkmcnt(5)
ds_read_b128 v[112:115],v0 offset:256
v_max3_f32 v44,v44,v85,v86
v_mfma_f32_16x16x32_bf16 v[76:79],v[116:119],a[156:159],v[76:79]
ds_read_b128 v[116:119],v1 offset:256
v_max_f32 v44,v44,v87
v_mfma_f32_16x16x32_bf16 v[76:79],v[120:123],a[160:163],v[76:79]
s_waitcnt lgkmcnt(5)
ds_read_b128 v[120:123],v0 offset:6144
v_mov_b32 v45,v44
v_mfma_f32_16x16x32_bf16 v[76:79],v[124:127],a[164:167],v[76:79]
s_waitcnt vmcnt(6)
ds_read_b128 a[192:195],v11 offset:12288
ds_read_b128 a[196:199],v12 offset:12288
buffer_load_dwordx4 v6,s[12:15],s28 offen offset:0 nt lds
ds_read_b128 a[200:203],v11 offset:12416
buffer_load_dwordx4 v7,s[12:15],s28 offen offset:1024 nt lds
ds_read_b128 a[204:207],v12 offset:12416
buffer_load_dwordx4 v8,s[12:15],s28 offen offset:2048 nt lds
s_add_u32 s28,s28,3072
s_add_u32 m0,s24,9216
ds_read_b128 a[208:211],v11 offset:12544
ds_read_b128 a[212:215],v12 offset:12544
buffer_load_dwordx4 v6,s[12:15],s28 offen offset:0 nt lds
buffer_load_dwordx4 v7,s[12:15],s28 offen offset:1024 nt lds
buffer_load_dwordx4 v8,s[12:15],s28 offen offset:2048 nt lds
s_add_u32 s28,s28,3072
s_add_u32 m0,s23,0
ds_read_b128 v[124:127],v1 offset:6144
v_permlane32_swap_b32 v45,v44
v_max_f32 v44,v44,v45
v_mov_b32 v45,v44
s_waitcnt lgkmcnt(6)
v_mfma_f32_16x16x32_bf16 v[88:91],v[128:131],a[192:195],0
s_waitcnt lgkmcnt(5)
ds_read_b128 v[128:131],v0 offset:6272
v_permlane16_swap_b32 v45,v44
v_mfma_f32_16x16x32_bf16 v[88:91],v[132:135],a[196:199],v[88:91]
s_waitcnt lgkmcnt(4)
ds_read_b128 v[132:135],v1 offset:6272
v_max_f32 v44,v44,v45
v_mfma_f32_16x16x32_bf16 v[88:91],v[136:139],a[200:203],v[88:91]
ds_read_b128 v[136:139],v0 offset:6400
v_mul_f32_e64 v14,-s36,v44
v_mfma_f32_16x16x32_bf16 v[88:91],v[140:143],a[204:207],v[88:91]
s_waitcnt lgkmcnt(4)
ds_read_b128 v[140:143],v1 offset:6400
v_fma_f32 v80,v80,s36,v14
v_mfma_f32_16x16x32_bf16 v[88:91],v[112:115],a[208:211],v[88:91]
ds_read_b128 v[112:115],v0 offset:12288
v_fma_f32 v81,v81,s36,v14
v_mfma_f32_16x16x32_bf16 v[88:91],v[116:119],a[212:215],v[88:91]
ds_read_b128 v[116:119],v1 offset:12288
v_fma_f32 v82,v82,s36,v14
v_mfma_f32_16x16x32_bf16 v[92:95],v[120:123],a[192:195],0
s_waitcnt lgkmcnt(6)
ds_read_b128 v[120:123],v0 offset:12416
v_fma_f32 v83,v83,s36,v14
v_exp_f32 v80,v80
v_mfma_f32_16x16x32_bf16 v[92:95],v[124:127],a[196:199],v[92:95]
s_waitcnt lgkmcnt(6)
ds_read_b128 v[124:127],v1 offset:12416
v_exp_f32 v81,v81
v_exp_f32 v82,v82
v_mfma_f32_16x16x32_bf16 v[92:95],v[128:131],a[200:203],v[92:95]
s_waitcnt lgkmcnt(5)
ds_read_b128 v[128:131],v0 offset:12544
v_exp_f32 v83,v83
v_mfma_f32_16x16x32_bf16 v[92:95],v[132:135],a[204:207],v[92:95]
ds_read_b128 v[132:135],v1 offset:12544
v_cvt_pk_bf16_f32 v24,v80,v81
v_mfma_f32_16x16x32_bf16 v[92:95],v[136:139],a[208:211],v[92:95]
s_waitcnt lgkmcnt(5)
ds_read_b128 v[136:139],v0 offset:18432
v_cvt_pk_bf16_f32 v25,v82,v83
v_mfma_f32_16x16x32_bf16 v[92:95],v[140:143],a[212:215],v[92:95]
ds_read_b128 v[140:143],v1 offset:18432
v_fma_f32 v84,v84,s36,v14
v_mfma_f32_16x16x32_bf16 v[80:83],v[112:115],a[168:171],0
s_waitcnt lgkmcnt(5)
ds_read_b128 v[112:115],v0 offset:18560
v_fma_f32 v85,v85,s36,v14
v_mfma_f32_16x16x32_bf16 v[80:83],v[116:119],a[172:175],v[80:83]
ds_read_b128 v[116:119],v1 offset:18560
v_fma_f32 v86,v86,s36,v14
v_mfma_f32_16x16x32_bf16 v[80:83],v[120:123],a[176:179],v[80:83]
s_waitcnt lgkmcnt(6)
ds_read_b128 v[120:123],v0 offset:18688
v_fma_f32 v87,v87,s36,v14
v_exp_f32 v84,v84
v_mfma_f32_16x16x32_bf16 v[80:83],v[124:127],a[180:183],v[80:83]
s_waitcnt lgkmcnt(6)
ds_read_b128 v[124:127],v1 offset:18688
v_exp_f32 v85,v85
v_exp_f32 v86,v86
v_mfma_f32_16x16x32_bf16 v[80:83],v[128:131],a[184:187],v[80:83]
s_waitcnt lgkmcnt(5)
ds_read_b128 v[128:131],v0 offset:0
v_exp_f32 v87,v87
v_mfma_f32_16x16x32_bf16 v[80:83],v[132:135],a[188:191],v[80:83]
ds_read_b128 v[132:135],v1 offset:0
v_cvt_pk_bf16_f32 v26,v84,v85
v_cvt_pk_bf16_f32 v27,v86,v87
v_mfma_f32_16x16x32_bf16 v[84:87],v[136:139],a[168:171],0
ds_read_b128 v[136:139],v0 offset:128
v_max3_f32 v48,v88,v89,v90
v_smfmac_f32_16x16x64_bf16 v[60:63],v[152:155],v[20:27],v18
s_waitcnt lgkmcnt(5)
v_max3_f32 v48,v48,v91,v92
v_mfma_f32_16x16x32_bf16 v[84:87],v[140:143],a[172:175],v[84:87]
ds_read_b128 v[140:143],v1 offset:128
v_max3_f32 v48,v48,v93,v94
v_mfma_f32_16x16x32_bf16 v[84:87],v[112:115],a[176:179],v[84:87]
ds_read_b128 v[112:115],v0 offset:256
v_max_f32 v48,v48,v95
v_mfma_f32_16x16x32_bf16 v[84:87],v[116:119],a[180:183],v[84:87]
s_waitcnt lgkmcnt(5)
ds_read_b128 v[116:119],v1 offset:256
v_mov_b32 v49,v48
v_mfma_f32_16x16x32_bf16 v[84:87],v[120:123],a[184:187],v[84:87]
ds_read_b128 v[120:123],v0 offset:6144
v_permlane32_swap_b32 v49,v48
v_mfma_f32_16x16x32_bf16 v[84:87],v[124:127],a[188:191],v[84:87]
s_waitcnt vmcnt(6)
ds_read_b128 a[216:219],v11 offset:0
ds_read_b128 a[220:223],v12 offset:0
buffer_load_dwordx4 v6,s[8:11],s21 offen offset:0 lds
ds_read_b128 a[224:227],v11 offset:128
buffer_load_dwordx4 v7,s[8:11],s21 offen offset:1024 lds
ds_read_b128 a[228:231],v12 offset:128
buffer_load_dwordx4 v8,s[8:11],s21 offen offset:2048 lds
s_add_u32 s21,s21,12288
s_add_u32 m0,s22,24576
ds_read_b128 a[232:235],v11 offset:256
ds_read_b128 a[236:239],v12 offset:256
buffer_load_dwordx4 v6,s[4:7],s20 offen offset:0 lds
buffer_load_dwordx4 v7,s[4:7],s20 offen offset:1024 lds
buffer_load_dwordx4 v8,s[4:7],s20 offen offset:2048 lds
s_add_u32 s20,s20,12288
s_add_u32 m0,s23,12288
ds_read_b128 v[124:127],v1 offset:6144
v_max_f32 v48,v48,v49
v_mov_b32 v49,v48
v_fma_f32 v72,v72,s36,v13
v_fma_f32 v73,v73,s36,v13
s_waitcnt lgkmcnt(6)
v_mfma_f32_16x16x32_bf16 v[96:99],v[128:131],a[216:219],0
s_waitcnt lgkmcnt(5)
ds_read_b128 v[128:131],v0 offset:6272
v_permlane16_swap_b32 v49,v48
v_mfma_f32_16x16x32_bf16 v[96:99],v[132:135],a[220:223],v[96:99]
s_waitcnt lgkmcnt(4)
ds_read_b128 v[132:135],v1 offset:6272
v_max_f32 v48,v48,v49
v_mfma_f32_16x16x32_bf16 v[96:99],v[136:139],a[224:227],v[96:99]
ds_read_b128 v[136:139],v0 offset:6400
v_mul_f32_e64 v15,-s36,v48
v_mfma_f32_16x16x32_bf16 v[96:99],v[140:143],a[228:231],v[96:99]
s_waitcnt lgkmcnt(4)
ds_read_b128 v[140:143],v1 offset:6400
v_fma_f32 v88,v88,s36,v15
v_mfma_f32_16x16x32_bf16 v[96:99],v[112:115],a[232:235],v[96:99]
ds_read_b128 v[112:115],v0 offset:12288
v_fma_f32 v89,v89,s36,v15
v_mfma_f32_16x16x32_bf16 v[96:99],v[116:119],a[236:239],v[96:99]
ds_read_b128 v[116:119],v1 offset:12288
v_fma_f32 v90,v90,s36,v15
v_mfma_f32_16x16x32_bf16 v[100:103],v[120:123],a[216:219],0
s_waitcnt lgkmcnt(6)
ds_read_b128 v[120:123],v0 offset:12416
v_fma_f32 v91,v91,s36,v15
v_exp_f32 v88,v88
v_mfma_f32_16x16x32_bf16 v[100:103],v[124:127],a[220:223],v[100:103]
s_waitcnt lgkmcnt(6)
ds_read_b128 v[124:127],v1 offset:12416
v_exp_f32 v89,v89
v_exp_f32 v90,v90
v_mfma_f32_16x16x32_bf16 v[100:103],v[128:131],a[224:227],v[100:103]
s_waitcnt lgkmcnt(5)
ds_read_b128 v[128:131],v0 offset:12544
v_exp_f32 v91,v91
v_mfma_f32_16x16x32_bf16 v[100:103],v[132:135],a[228:231],v[100:103]
ds_read_b128 v[132:135],v1 offset:12544
v_cvt_pk_bf16_f32 v28,v88,v89
v_mfma_f32_16x16x32_bf16 v[100:103],v[136:139],a[232:235],v[100:103]
s_waitcnt lgkmcnt(5)
ds_read_b128 v[136:139],v0 offset:18432
v_cvt_pk_bf16_f32 v29,v90,v91
v_mfma_f32_16x16x32_bf16 v[100:103],v[140:143],a[236:239],v[100:103]
ds_read_b128 v[140:143],v1 offset:18432
v_fma_f32 v92,v92,s36,v15
v_mfma_f32_16x16x32_bf16 v[88:91],v[112:115],a[192:195],0
s_waitcnt lgkmcnt(5)
ds_read_b128 v[112:115],v0 offset:18560
v_fma_f32 v93,v93,s36,v15
v_mfma_f32_16x16x32_bf16 v[88:91],v[116:119],a[196:199],v[88:91]
ds_read_b128 v[116:119],v1 offset:18560
v_fma_f32 v94,v94,s36,v15
v_mfma_f32_16x16x32_bf16 v[88:91],v[120:123],a[200:203],v[88:91]
s_waitcnt lgkmcnt(6)
ds_read_b128 v[120:123],v0 offset:18688
v_fma_f32 v95,v95,s36,v15
v_exp_f32 v92,v92
v_mfma_f32_16x16x32_bf16 v[88:91],v[124:127],a[204:207],v[88:91]
s_waitcnt lgkmcnt(6)
ds_read_b128 v[124:127],v1 offset:18688
v_exp_f32 v93,v93
v_exp_f32 v94,v94
v_mfma_f32_16x16x32_bf16 v[88:91],v[128:131],a[208:211],v[88:91]
s_waitcnt lgkmcnt(5)
ds_read_b128 v[128:131],v0 offset:0
v_exp_f32 v95,v95
v_mfma_f32_16x16x32_bf16 v[88:91],v[132:135],a[212:215],v[88:91]
ds_read_b128 v[132:135],v1 offset:0
v_cvt_pk_bf16_f32 v30,v92,v93
v_cvt_pk_bf16_f32 v31,v94,v95
v_mfma_f32_16x16x32_bf16 v[92:95],v[136:139],a[192:195],0
s_waitcnt lgkmcnt(5)
ds_read_b128 v[136:139],v0 offset:128
v_max3_f32 v52,v96,v97,v98
v_mfma_f32_16x16x32_bf16 v[92:95],v[140:143],a[196:199],v[92:95]
ds_read_b128 v[140:143],v1 offset:128
v_max3_f32 v52,v52,v99,v100
v_mfma_f32_16x16x32_bf16 v[92:95],v[112:115],a[200:203],v[92:95]
s_waitcnt lgkmcnt(5)
ds_read_b128 v[112:115],v0 offset:256
v_max3_f32 v52,v52,v101,v102
v_mfma_f32_16x16x32_bf16 v[92:95],v[116:119],a[204:207],v[92:95]
ds_read_b128 v[116:119],v1 offset:256
v_max_f32 v52,v52,v103
v_mfma_f32_16x16x32_bf16 v[92:95],v[120:123],a[208:211],v[92:95]
s_waitcnt lgkmcnt(6)
ds_read_b128 v[120:123],v0 offset:6144
v_mov_b32 v53,v52
v_mfma_f32_16x16x32_bf16 v[92:95],v[124:127],a[212:215],v[92:95]
s_waitcnt vmcnt(6)
ds_read_b128 a[240:243],v11 offset:6144
ds_read_b128 a[244:247],v12 offset:6144
buffer_load_dwordx4 v6,s[8:11],s21 offen offset:0 lds
ds_read_b128 a[248:251],v11 offset:6272
buffer_load_dwordx4 v7,s[8:11],s21 offen offset:1024 lds
ds_read_b128 a[252:255],v12 offset:6272
buffer_load_dwordx4 v8,s[8:11],s21 offen offset:2048 lds
s_add_u32 s21,s21,12288
s_add_u32 m0,s23,24576
ds_read_b128 v[144:147],v11 offset:6400
ds_read_b128 v[148:151],v12 offset:6400
buffer_load_dwordx4 v6,s[8:11],s21 offen offset:0 lds
buffer_load_dwordx4 v7,s[8:11],s21 offen offset:1024 lds
buffer_load_dwordx4 v8,s[8:11],s21 offen offset:2048 lds
s_add_u32 s21,s21,12288
ds_read_b128 v[124:127],v1 offset:6144
v_permlane32_swap_b32 v53,v52
v_max_f32 v52,v52,v53
v_mov_b32 v53,v52
v_fma_f32 v74,v74,s36,v13
s_waitcnt lgkmcnt(6)
v_mfma_f32_16x16x32_bf16 v[104:107],v[128:131],a[240:243],0
s_mov_b32 s27,166723584
ds_read_b128 v[128:131],v0 offset:6272
v_permlane16_swap_b32 v53,v52
s_waitcnt lgkmcnt(6)
v_mfma_f32_16x16x32_bf16 v[104:107],v[132:135],a[244:247],v[104:107]
s_mov_b32 s42,s41
ds_read_b128 v[132:135],v1 offset:6272
v_max_f32 v52,v52,v53
s_waitcnt lgkmcnt(5)
v_mfma_f32_16x16x32_bf16 v[104:107],v[136:139],a[248:251],v[104:107]
s_add_u32 s69,s69,1
ds_read_b128 v[136:139],v0 offset:6400
v_mul_f32_e64 v16,-s36,v52
v_mfma_f32_16x16x32_bf16 v[104:107],v[140:143],a[252:255],v[104:107]
s_lshl_b32 s62,s69,5
ds_read_b128 v[140:143],v1 offset:6400
v_fma_f32 v96,v96,s36,v16
s_waitcnt lgkmcnt(5)
v_mfma_f32_16x16x32_bf16 v[104:107],v[112:115],v[144:147],v[104:107]
s_add_u32 s62,s62,s34
ds_read_b128 v[112:115],v0 offset:12288
v_fma_f32 v97,v97,s36,v16
v_mfma_f32_16x16x32_bf16 v[104:107],v[116:119],v[148:151],v[104:107]
s_mul_i32 s63,s62,171
ds_read_b128 v[116:119],v1 offset:12288
v_fma_f32 v98,v98,s36,v16
v_mfma_f32_16x16x32_bf16 v[108:111],v[120:123],a[240:243],0
s_lshr_b32 s63,s63,9
ds_read_b128 v[120:123],v0 offset:12416
v_fma_f32 v99,v99,s36,v16
s_waitcnt lgkmcnt(7)
v_mfma_f32_16x16x32_bf16 v[108:111],v[124:127],a[244:247],v[108:111]
s_mul_i32 s64,s63,3
ds_read_b128 v[124:127],v1 offset:12416
v_exp_f32 v96,v96
v_exp_f32 v97,v97
v_exp_f32 v98,v98
s_waitcnt lgkmcnt(7)
v_mfma_f32_16x16x32_bf16 v[108:111],v[128:131],a[248:251],v[108:111]
s_sub_u32 s62,s62,s64
ds_read_b128 v[128:131],v0 offset:12544
v_exp_f32 v99,v99
s_waitcnt lgkmcnt(6)
v_mfma_f32_16x16x32_bf16 v[108:111],v[132:135],a[252:255],v[108:111]
s_add_u32 s63,s63,s33
ds_read_b128 v[132:135],v1 offset:12544
v_cvt_pk_bf16_f32 v32,v96,v97
v_mfma_f32_16x16x32_bf16 v[108:111],v[136:139],v[144:147],v[108:111]
s_mul_i32 s30,s63,196608
ds_read_b128 v[136:139],v0 offset:18432
v_cvt_pk_bf16_f32 v33,v98,v99
s_waitcnt lgkmcnt(6)
v_mfma_f32_16x16x32_bf16 v[108:111],v[140:143],v[148:151],v[108:111]
s_waitcnt vmcnt(9)
s_barrier
v_mfma_f32_16x16x32_bf16 v[96:99],v[112:115],a[216:219],0
s_mul_i32 s41,s63,325632
ds_read_b128 v[140:143],v1 offset:18432
v_fma_f32 v100,v100,s36,v16
s_waitcnt lgkmcnt(5)
v_mfma_f32_16x16x32_bf16 v[96:99],v[116:119],a[220:223],v[96:99]
s_lshl_b32 s63,s3,2
ds_read_b128 v[112:115],v0 offset:18560
v_fma_f32 v101,v101,s36,v16
v_mfma_f32_16x16x32_bf16 v[96:99],v[120:123],a[224:227],v[96:99]
s_add_u32 s64,s63,21
ds_read_b128 v[116:119],v1 offset:18560
v_fma_f32 v102,v102,s36,v16
s_waitcnt lgkmcnt(6)
v_mfma_f32_16x16x32_bf16 v[96:99],v[124:127],a[228:231],v[96:99]
s_cmp_eq_u32 s3,0
ds_read_b128 v[120:123],v0 offset:18688
v_fma_f32 v103,v103,s36,v16
v_exp_f32 v100,v100
s_waitcnt lgkmcnt(6)
v_mfma_f32_16x16x32_bf16 v[96:99],v[128:131],a[232:235],v[96:99]
s_cselect_b32 s64,20,s64
ds_read_b128 v[124:127],v1 offset:18688
v_exp_f32 v101,v101
s_waitcnt lgkmcnt(5)
v_mfma_f32_16x16x32_bf16 v[96:99],v[132:135],a[236:239],v[96:99]
s_cselect_b32 s40,1,0
ds_read_b128 v[128:131],v0 offset:12288
ds_read_b128 v[132:135],v1 offset:12288
v_exp_f32 v102,v102
v_exp_f32 v103,v103
v_cvt_pk_bf16_f32 v34,v100,v101
v_cvt_pk_bf16_f32 v35,v102,v103
v_mfma_f32_16x16x32_bf16 v[100:103],v[136:139],a[216:219],0
s_add_u32 s65,s63,37
ds_read_b128 v[136:139],v0 offset:12416
v_max3_f32 v56,v104,v105,v106
v_smfmac_f32_16x16x64_bf16 v[64:67],v[152:155],v[28:35],v18
s_cmp_eq_u32 s62,2
s_cselect_b32 s64,s65,s64
v_max3_f32 v56,v56,v107,v108
s_waitcnt lgkmcnt(6)
v_mfma_f32_16x16x32_bf16 v[100:103],v[140:143],a[220:223],v[100:103]
s_cselect_b32 s40,0,s40
ds_read_b128 v[140:143],v1 offset:12416
v_max3_f32 v56,v56,v109,v110
v_mfma_f32_16x16x32_bf16 v[100:103],v[112:115],a[224:227],v[100:103]
s_add_u32 s65,s63,s3
ds_read_b128 v[112:115],v0 offset:12544
v_max_f32 v56,v56,v111
s_waitcnt lgkmcnt(6)
v_mfma_f32_16x16x32_bf16 v[100:103],v[116:119],a[228:231],v[100:103]
s_cmp_eq_u32 s62,0
ds_read_b128 v[116:119],v1 offset:12544
v_mov_b32 v57,v56
v_mfma_f32_16x16x32_bf16 v[100:103],v[120:123],a[232:235],v[100:103]
s_cselect_b32 s64,s65,s64
ds_read_b128 v[120:123],v0 offset:18432
v_permlane32_swap_b32 v57,v56
s_waitcnt lgkmcnt(6)
v_mfma_f32_16x16x32_bf16 v[100:103],v[124:127],a[236:239],v[100:103]
s_cselect_b32 s40,1,s40
ds_read_b128 v[124:127],v1 offset:18432
v_max_f32 v56,v56,v57
v_mov_b32 v57,v56
v_fma_f32 v75,v75,s36,v13
v_fma_f32 v80,v80,s36,v14
v_permlane16_swap_b32 v57,v56
v_max_f32 v56,v56,v57
v_mul_f32_e64 v17,-s36,v56
v_fma_f32 v104,v104,s36,v17
v_fma_f32 v105,v105,s36,v17
v_fma_f32 v106,v106,s36,v17
v_fma_f32 v107,v107,s36,v17
v_exp_f32 v104,v104
v_exp_f32 v105,v105
v_exp_f32 v106,v106
v_exp_f32 v107,v107
v_cvt_pk_bf16_f32 v36,v104,v105
v_cvt_pk_bf16_f32 v37,v106,v107
v_mfma_f32_16x16x32_bf16 v[104:107],v[128:131],a[240:243],0
s_mul_i32 s64,s64,6144
ds_read_b128 v[128:131],v0 offset:18560
v_fma_f32 v108,v108,s36,v17
s_waitcnt lgkmcnt(3)
v_mfma_f32_16x16x32_bf16 v[104:107],v[132:135],a[244:247],v[104:107]
s_add_u32 s41,s41,s64
ds_read_b128 v[132:135],v1 offset:18560
v_fma_f32 v109,v109,s36,v17
v_mfma_f32_16x16x32_bf16 v[104:107],v[136:139],a[248:251],v[104:107]
s_cmp_ge_u32 s69,6
ds_read_b128 v[136:139],v0 offset:18688
v_fma_f32 v110,v110,s36,v17
v_mfma_f32_16x16x32_bf16 v[104:107],v[140:143],a[252:255],v[104:107]
s_cselect_b32 s41,166723584,s41
ds_read_b128 v[140:143],v1 offset:18688
v_fma_f32 v111,v111,s36,v17
v_mfma_f32_16x16x32_bf16 v[104:107],v[112:115],v[144:147],v[104:107]
s_cselect_b32 s30,100663296,s30
ds_read_b64_tr_b16 v[112:113],v2 offset:0
ds_read_b64_tr_b16 v[114:115],v2 offset:6144
v_mfma_f32_16x16x32_bf16 v[104:107],v[116:119],v[148:151],v[104:107]
s_add_u32 s25,s30,s22
ds_read_b64_tr_b16 v[116:117],v3 offset:0
ds_read_b64_tr_b16 v[118:119],v3 offset:6144
v_exp_f32 v108,v108
v_exp_f32 v109,v109
v_exp_f32 v110,v110
v_exp_f32 v111,v111
v_cvt_pk_bf16_f32 v38,v108,v109
v_cvt_pk_bf16_f32 v39,v110,v111
s_waitcnt lgkmcnt(8)
v_mfma_f32_16x16x32_bf16 v[108:111],v[120:123],a[240:243],0
s_add_u32 s26,s25,12288
ds_read_b64_tr_b16 v[120:121],v4 offset:0
ds_read_b64_tr_b16 v[122:123],v4 offset:6144
v_smfmac_f32_16x16x64_bf16 v[68:71],v[152:155],v[32:39],v18
s_mov_b32 s28,s41
s_mov_b32 s29,s24
v_fma_f32 v81,v81,s36,v14
v_mfma_f32_16x16x32_bf16 v[108:111],v[124:127],a[244:247],v[108:111]
s_add_u32 m0,s22,0
ds_read_b64_tr_b16 v[124:125],v5 offset:0
buffer_load_dwordx4 v6,s[4:7],s20 offen offset:0 lds
s_waitcnt lgkmcnt(7)
v_mfma_f32_16x16x32_bf16 v[108:111],v[128:131],a[248:251],v[108:111]
buffer_load_dwordx4 v7,s[4:7],s20 offen offset:1024 lds
v_mfma_f32_16x16x32_bf16 v[108:111],v[132:135],a[252:255],v[108:111]
buffer_load_dwordx4 v8,s[4:7],s20 offen offset:2048 lds
v_mfma_f32_16x16x32_bf16 v[108:111],v[136:139],v[144:147],v[108:111]
s_add_u32 s20,s20,12288
ds_read_b64_tr_b16 v[126:127],v5 offset:6144
v_fma_f32 v82,v82,s36,v14
v_mfma_f32_16x16x32_bf16 v[108:111],v[140:143],v[148:151],v[108:111]
v_fma_f32 v83,v83,s36,v14
v_fma_f32 v88,v88,s36,v15
v_fma_f32 v89,v89,s36,v15
v_exp_f32 v72,v72
v_exp_f32 v73,v73
v_exp_f32 v74,v74
v_exp_f32 v75,v75
v_exp_f32 v80,v80
v_exp_f32 v81,v81
v_exp_f32 v82,v82
v_exp_f32 v83,v83
v_exp_f32 v88,v88
v_exp_f32 v89,v89
v_cvt_pk_bf16_f32 v40,v72,v73
v_cvt_pk_bf16_f32 v41,v74,v75
v_cvt_pk_bf16_f32 v44,v80,v81
v_cvt_pk_bf16_f32 v45,v82,v83
v_cvt_pk_bf16_f32 v48,v88,v89
s_waitcnt lgkmcnt(1)
v_mfma_f32_16x16x32_bf16 v[160:163],v[112:115],v[20:23],0
s_add_u32 m0,s23,0
ds_read_b64_tr_b16 v[128:129],v2 offset:128
ds_read_b64_tr_b16 v[130:131],v2 offset:6272
v_mfma_f32_16x16x32_bf16 v[208:211],v[112:115],v[24:27],0
ds_read_b64_tr_b16 v[132:133],v3 offset:128
ds_read_b64_tr_b16 v[134:135],v3 offset:6272
v_mfma_f32_16x16x32_bf16 a[0:3],v[112:115],v[28:31],0
ds_read_b64_tr_b16 v[136:137],v4 offset:128
ds_read_b64_tr_b16 v[138:139],v4 offset:6272
v_mfma_f32_16x16x32_bf16 a[48:51],v[112:115],v[32:35],0
ds_read_b64_tr_b16 v[140:141],v5 offset:128
ds_read_b64_tr_b16 v[142:143],v5 offset:6272
v_mfma_f32_16x16x32_bf16 a[96:99],v[112:115],v[36:39],0
ds_read_b64_tr_b16 v[112:113],v2 offset:256
ds_read_b64_tr_b16 v[114:115],v2 offset:6400
v_mfma_f32_16x16x32_bf16 v[164:167],v[116:119],v[20:23],0
v_fma_f32 v90,v90,s36,v15
v_fma_f32 v91,v91,s36,v15
v_mfma_f32_16x16x32_bf16 v[212:215],v[116:119],v[24:27],0
v_exp_f32 v90,v90
v_mfma_f32_16x16x32_bf16 a[4:7],v[116:119],v[28:31],0
v_exp_f32 v91,v91
v_mfma_f32_16x16x32_bf16 a[52:55],v[116:119],v[32:35],0
v_cvt_pk_bf16_f32 v49,v90,v91
v_fma_f32 v96,v96,s36,v16
v_mfma_f32_16x16x32_bf16 a[100:103],v[116:119],v[36:39],0
ds_read_b64_tr_b16 v[116:117],v3 offset:256
ds_read_b64_tr_b16 v[118:119],v3 offset:6400
v_mfma_f32_16x16x32_bf16 v[168:171],v[120:123],v[20:23],0
v_fma_f32 v97,v97,s36,v16
v_fma_f32 v98,v98,s36,v16
v_mfma_f32_16x16x32_bf16 v[216:219],v[120:123],v[24:27],0
v_fma_f32 v99,v99,s36,v16
v_fma_f32 v104,v104,s36,v17
v_mfma_f32_16x16x32_bf16 a[8:11],v[120:123],v[28:31],0
v_exp_f32 v96,v96
v_mfma_f32_16x16x32_bf16 a[56:59],v[120:123],v[32:35],0
v_exp_f32 v97,v97
v_mfma_f32_16x16x32_bf16 a[104:107],v[120:123],v[36:39],0
s_waitcnt lgkmcnt(2)
ds_read_b64_tr_b16 v[120:121],v4 offset:256
ds_read_b64_tr_b16 v[122:123],v4 offset:6400
v_mfma_f32_16x16x32_bf16 v[172:175],v[124:127],v[20:23],0
v_exp_f32 v98,v98
v_mfma_f32_16x16x32_bf16 v[220:223],v[124:127],v[24:27],0
v_exp_f32 v99,v99
v_mfma_f32_16x16x32_bf16 a[12:15],v[124:127],v[28:31],0
v_cvt_pk_bf16_f32 v52,v96,v97
v_cvt_pk_bf16_f32 v53,v98,v99
v_mfma_f32_16x16x32_bf16 a[60:63],v[124:127],v[32:35],0
v_fma_f32 v105,v105,s36,v17
v_fma_f32 v106,v106,s36,v17
v_mfma_f32_16x16x32_bf16 a[108:111],v[124:127],v[36:39],0
ds_read_b64_tr_b16 v[124:125],v5 offset:256
ds_read_b64_tr_b16 v[126:127],v5 offset:6400
v_mfma_f32_16x16x32_bf16 v[176:179],v[128:131],v[20:23],0
v_fma_f32 v107,v107,s36,v17
v_fma_f32 v76,v76,s36,v13
v_mfma_f32_16x16x32_bf16 v[224:227],v[128:131],v[24:27],0
v_exp_f32 v104,v104
v_mfma_f32_16x16x32_bf16 a[16:19],v[128:131],v[28:31],0
v_exp_f32 v105,v105
v_mfma_f32_16x16x32_bf16 a[64:67],v[128:131],v[32:35],0
v_exp_f32 v106,v106
v_mfma_f32_16x16x32_bf16 a[112:115],v[128:131],v[36:39],0
v_exp_f32 v107,v107
v_mfma_f32_16x16x32_bf16 v[180:183],v[132:135],v[20:23],0
v_cvt_pk_bf16_f32 v56,v104,v105
v_cvt_pk_bf16_f32 v57,v106,v107
v_mfma_f32_16x16x32_bf16 v[228:231],v[132:135],v[24:27],0
v_fma_f32 v77,v77,s36,v13
v_fma_f32 v78,v78,s36,v13
v_mfma_f32_16x16x32_bf16 a[20:23],v[132:135],v[28:31],0
v_fma_f32 v79,v79,s36,v13
v_fma_f32 v84,v84,s36,v14
v_mfma_f32_16x16x32_bf16 a[68:71],v[132:135],v[32:35],0
v_exp_f32 v76,v76
v_mfma_f32_16x16x32_bf16 a[116:119],v[132:135],v[36:39],0
v_exp_f32 v77,v77
v_mfma_f32_16x16x32_bf16 v[184:187],v[136:139],v[20:23],0
v_exp_f32 v78,v78
v_mfma_f32_16x16x32_bf16 v[232:235],v[136:139],v[24:27],0
v_exp_f32 v79,v79
v_mfma_f32_16x16x32_bf16 a[24:27],v[136:139],v[28:31],0
v_cvt_pk_bf16_f32 v42,v76,v77
v_cvt_pk_bf16_f32 v43,v78,v79
v_mfma_f32_16x16x32_bf16 a[72:75],v[136:139],v[32:35],0
v_fma_f32 v85,v85,s36,v14
v_fma_f32 v86,v86,s36,v14
v_mfma_f32_16x16x32_bf16 a[120:123],v[136:139],v[36:39],0
v_fma_f32 v87,v87,s36,v14
v_fma_f32 v92,v92,s36,v15
v_mfma_f32_16x16x32_bf16 v[188:191],v[140:143],v[20:23],0
v_exp_f32 v84,v84
v_mfma_f32_16x16x32_bf16 v[236:239],v[140:143],v[24:27],0
v_exp_f32 v85,v85
v_mfma_f32_16x16x32_bf16 a[28:31],v[140:143],v[28:31],0
v_exp_f32 v86,v86
v_mfma_f32_16x16x32_bf16 a[76:79],v[140:143],v[32:35],0
v_exp_f32 v87,v87
v_mfma_f32_16x16x32_bf16 a[124:127],v[140:143],v[36:39],0
v_cvt_pk_bf16_f32 v46,v84,v85
v_cvt_pk_bf16_f32 v47,v86,v87
v_mfma_f32_16x16x32_bf16 v[192:195],v[112:115],v[20:23],0
v_fma_f32 v93,v93,s36,v15
v_fma_f32 v94,v94,s36,v15
v_smfmac_f32_16x16x64_bf16 v[60:63],v[152:155],v[40:47],v18
v_fma_f32 v95,v95,s36,v15
s_waitcnt vmcnt(6) lgkmcnt(0)
v_mfma_f32_16x16x32_bf16 v[240:243],v[112:115],v[24:27],0
s_barrier
v_mfma_f32_16x16x32_bf16 a[32:35],v[112:115],v[28:31],0
ds_read_b128 v[128:131],v0 offset:24576
v_fma_f32 v100,v100,s36,v16
v_mfma_f32_16x16x32_bf16 a[80:83],v[112:115],v[32:35],0
ds_read_b128 v[132:135],v1 offset:24576
v_fma_f32 v101,v101,s36,v16
v_mfma_f32_16x16x32_bf16 a[128:131],v[112:115],v[36:39],0
ds_read_b128 v[136:139],v0 offset:24704
v_fma_f32 v102,v102,s36,v16
v_mfma_f32_16x16x32_bf16 v[196:199],v[116:119],v[20:23],0
ds_read_b128 v[140:143],v1 offset:24704
v_fma_f32 v103,v103,s36,v16
v_mfma_f32_16x16x32_bf16 v[244:247],v[116:119],v[24:27],0
ds_read_b128 v[112:115],v0 offset:24832
v_fma_f32 v108,v108,s36,v17
v_mfma_f32_16x16x32_bf16 a[36:39],v[116:119],v[28:31],0
buffer_load_dwordx4 v6,s[8:11],s21 offen offset:0 lds
v_mfma_f32_16x16x32_bf16 a[84:87],v[116:119],v[32:35],0
v_exp_f32 v92,v92
v_mfma_f32_16x16x32_bf16 a[132:135],v[116:119],v[36:39],0
ds_read_b128 v[116:119],v1 offset:24832
v_fma_f32 v109,v109,s36,v17
v_mfma_f32_16x16x32_bf16 v[200:203],v[120:123],v[20:23],0
v_exp_f32 v93,v93
v_mfma_f32_16x16x32_bf16 v[248:251],v[120:123],v[24:27],0
v_exp_f32 v94,v94
v_mfma_f32_16x16x32_bf16 a[40:43],v[120:123],v[28:31],0
v_exp_f32 v95,v95
v_mfma_f32_16x16x32_bf16 a[88:91],v[120:123],v[32:35],0
v_cvt_pk_bf16_f32 v50,v92,v93
v_cvt_pk_bf16_f32 v51,v94,v95
v_mfma_f32_16x16x32_bf16 a[136:139],v[120:123],v[36:39],0
ds_read_b128 v[120:123],v0 offset:30720
v_fma_f32 v110,v110,s36,v17
v_mfma_f32_16x16x32_bf16 v[204:207],v[124:127],v[20:23],0
v_exp_f32 v100,v100
v_mfma_f32_16x16x32_bf16 v[252:255],v[124:127],v[24:27],0
v_exp_f32 v101,v101
v_mfma_f32_16x16x32_bf16 a[44:47],v[124:127],v[28:31],0
v_exp_f32 v102,v102
v_mfma_f32_16x16x32_bf16 a[92:95],v[124:127],v[32:35],0
v_exp_f32 v103,v103
v_mfma_f32_16x16x32_bf16 a[140:143],v[124:127],v[36:39],0
buffer_load_dwordx4 v7,s[8:11],s21 offen offset:1024 lds
s_waitcnt lgkmcnt(1)
v_mfma_f32_16x16x32_bf16 v[72:75],v[128:131],a[144:147],0
ds_read_b128 v[124:127],v1 offset:30720
v_cvt_pk_bf16_f32 v54,v100,v101
v_mfma_f32_16x16x32_bf16 v[80:83],v[128:131],a[168:171],0
v_cvt_pk_bf16_f32 v55,v102,v103
v_fma_f32 v111,v111,s36,v17
v_mfma_f32_16x16x32_bf16 v[88:91],v[128:131],a[192:195],0
v_exp_f32 v108,v108
v_smfmac_f32_16x16x64_bf16 v[64:67],v[152:155],v[48:55],v18
v_mfma_f32_16x16x32_bf16 v[96:99],v[128:131],a[216:219],0
v_exp_f32 v109,v109
v_mfma_f32_16x16x32_bf16 v[104:107],v[128:131],a[240:243],0
ds_read_b128 v[128:131],v0 offset:30848
v_cvt_pk_bf16_f32 v58,v108,v109
v_mfma_f32_16x16x32_bf16 v[72:75],v[132:135],a[148:151],v[72:75]
v_exp_f32 v110,v110
v_mfma_f32_16x16x32_bf16 v[80:83],v[132:135],a[172:175],v[80:83]
v_exp_f32 v111,v111
v_mfma_f32_16x16x32_bf16 v[88:91],v[132:135],a[196:199],v[88:91]
v_cvt_pk_bf16_f32 v59,v110,v111
v_mfma_f32_16x16x32_bf16 v[96:99],v[132:135],a[220:223],v[96:99]
v_mfma_f32_16x16x32_bf16 v[104:107],v[132:135],a[244:247],v[104:107]
buffer_load_dwordx4 v8,s[8:11],s21 offen offset:2048 lds
v_smfmac_f32_16x16x64_bf16 v[68:71],v[152:155],v[52:59],v18
s_add_u32 s21,s21,12288
ds_read_b128 v[132:135],v1 offset:30848
v_mfma_f32_16x16x32_bf16 v[72:75],v[136:139],a[152:155],v[72:75]
s_add_u32 m0,s22,12288
v_mfma_f32_16x16x32_bf16 v[80:83],v[136:139],a[176:179],v[80:83]
v_mfma_f32_16x16x32_bf16 v[88:91],v[136:139],a[200:203],v[88:91]
v_mfma_f32_16x16x32_bf16 v[96:99],v[136:139],a[224:227],v[96:99]
v_mfma_f32_16x16x32_bf16 v[104:107],v[136:139],a[248:251],v[104:107]
ds_read_b128 v[136:139],v0 offset:30976
v_mfma_f32_16x16x32_bf16 v[72:75],v[140:143],a[156:159],v[72:75]
v_mfma_f32_16x16x32_bf16 v[80:83],v[140:143],a[180:183],v[80:83]
v_mfma_f32_16x16x32_bf16 v[88:91],v[140:143],a[204:207],v[88:91]
v_mfma_f32_16x16x32_bf16 v[96:99],v[140:143],a[228:231],v[96:99]
v_mfma_f32_16x16x32_bf16 v[104:107],v[140:143],a[252:255],v[104:107]
buffer_load_dwordx4 v6,s[4:7],s20 offen offset:0 lds
v_mfma_f32_16x16x32_bf16 v[72:75],v[112:115],a[160:163],v[72:75]
ds_read_b128 v[140:143],v1 offset:30976
v_mfma_f32_16x16x32_bf16 v[80:83],v[112:115],a[184:187],v[80:83]
v_mfma_f32_16x16x32_bf16 v[88:91],v[112:115],a[208:211],v[88:91]
v_mfma_f32_16x16x32_bf16 v[96:99],v[112:115],a[232:235],v[96:99]
v_mfma_f32_16x16x32_bf16 v[104:107],v[112:115],v[144:147],v[104:107]
v_mfma_f32_16x16x32_bf16 v[72:75],v[116:119],a[164:167],v[72:75]
v_mfma_f32_16x16x32_bf16 v[80:83],v[116:119],a[188:191],v[80:83]
v_mfma_f32_16x16x32_bf16 v[88:91],v[116:119],a[212:215],v[88:91]
v_mfma_f32_16x16x32_bf16 v[96:99],v[116:119],a[236:239],v[96:99]
v_mfma_f32_16x16x32_bf16 v[104:107],v[116:119],v[148:151],v[104:107]
s_waitcnt lgkmcnt(0)
v_mfma_f32_16x16x32_bf16 v[76:79],v[120:123],a[144:147],0
v_mfma_f32_16x16x32_bf16 v[84:87],v[120:123],a[168:171],0
buffer_load_dwordx4 v7,s[4:7],s20 offen offset:1024 lds
v_mfma_f32_16x16x32_bf16 v[92:95],v[120:123],a[192:195],0
v_fma_f32 v72,v72,s36,v13
v_fma_f32 v73,v73,s36,v13
v_mfma_f32_16x16x32_bf16 v[100:103],v[120:123],a[216:219],0
v_fma_f32 v74,v74,s36,v13
v_fma_f32 v75,v75,s36,v13
v_mfma_f32_16x16x32_bf16 v[108:111],v[120:123],a[240:243],0
v_fma_f32 v80,v80,s36,v14
v_fma_f32 v81,v81,s36,v14
v_mfma_f32_16x16x32_bf16 v[76:79],v[124:127],a[148:151],v[76:79]
v_fma_f32 v82,v82,s36,v14
v_fma_f32 v83,v83,s36,v14
v_mfma_f32_16x16x32_bf16 v[84:87],v[124:127],a[172:175],v[84:87]
v_fma_f32 v88,v88,s36,v15
v_fma_f32 v89,v89,s36,v15
v_mfma_f32_16x16x32_bf16 v[92:95],v[124:127],a[196:199],v[92:95]
v_exp_f32 v72,v72
v_mfma_f32_16x16x32_bf16 v[100:103],v[124:127],a[220:223],v[100:103]
v_exp_f32 v73,v73
v_mfma_f32_16x16x32_bf16 v[108:111],v[124:127],a[244:247],v[108:111]
v_exp_f32 v74,v74
v_mfma_f32_16x16x32_bf16 v[76:79],v[128:131],a[152:155],v[76:79]
v_exp_f32 v75,v75
v_mfma_f32_16x16x32_bf16 v[84:87],v[128:131],a[176:179],v[84:87]
v_exp_f32 v80,v80
v_mfma_f32_16x16x32_bf16 v[92:95],v[128:131],a[200:203],v[92:95]
buffer_load_dwordx4 v8,s[4:7],s20 offen offset:2048 lds
v_mfma_f32_16x16x32_bf16 v[100:103],v[128:131],a[224:227],v[100:103]
s_add_u32 s20,s20,12288
v_exp_f32 v81,v81
v_mfma_f32_16x16x32_bf16 v[108:111],v[128:131],a[248:251],v[108:111]
v_exp_f32 v82,v82
v_mfma_f32_16x16x32_bf16 v[76:79],v[132:135],a[156:159],v[76:79]
v_exp_f32 v83,v83
v_mfma_f32_16x16x32_bf16 v[84:87],v[132:135],a[180:183],v[84:87]
v_exp_f32 v88,v88
v_mfma_f32_16x16x32_bf16 v[92:95],v[132:135],a[204:207],v[92:95]
ds_read_b64_tr_b16 v[112:113],v2 offset:12288
v_mfma_f32_16x16x32_bf16 v[100:103],v[132:135],a[228:231],v[100:103]
ds_read_b64_tr_b16 v[114:115],v2 offset:18432
v_cvt_pk_bf16_f32 v20,v72,v73
v_mfma_f32_16x16x32_bf16 v[108:111],v[132:135],a[252:255],v[108:111]
v_exp_f32 v89,v89
v_mfma_f32_16x16x32_bf16 v[76:79],v[136:139],a[160:163],v[76:79]
ds_read_b64_tr_b16 v[116:117],v3 offset:12288
ds_read_b64_tr_b16 v[118:119],v3 offset:18432
v_mfma_f32_16x16x32_bf16 v[84:87],v[136:139],a[184:187],v[84:87]
v_cvt_pk_bf16_f32 v21,v74,v75
v_cvt_pk_bf16_f32 v24,v80,v81
v_mfma_f32_16x16x32_bf16 v[92:95],v[136:139],a[208:211],v[92:95]
ds_read_b64_tr_b16 v[120:121],v4 offset:12288
v_mfma_f32_16x16x32_bf16 v[100:103],v[136:139],a[232:235],v[100:103]
ds_read_b64_tr_b16 v[122:123],v4 offset:18432
v_cvt_pk_bf16_f32 v25,v82,v83
v_mfma_f32_16x16x32_bf16 v[108:111],v[136:139],v[144:147],v[108:111]
v_cvt_pk_bf16_f32 v28,v88,v89
v_mfma_f32_16x16x32_bf16 v[76:79],v[140:143],a[164:167],v[76:79]
ds_read_b64_tr_b16 v[124:125],v5 offset:12288
ds_read_b64_tr_b16 v[126:127],v5 offset:18432
v_mfma_f32_16x16x32_bf16 v[84:87],v[140:143],a[188:191],v[84:87]
v_mfma_f32_16x16x32_bf16 v[92:95],v[140:143],a[212:215],v[92:95]
v_mfma_f32_16x16x32_bf16 v[100:103],v[140:143],a[236:239],v[100:103]
v_mfma_f32_16x16x32_bf16 v[108:111],v[140:143],v[148:151],v[108:111]
s_waitcnt lgkmcnt(4)
v_mfma_f32_16x16x32_bf16 v[160:163],v[112:115],v[40:43],v[160:163]
s_add_u32 m0,s23,12288
ds_read_b64_tr_b16 v[128:129],v2 offset:12416
ds_read_b64_tr_b16 v[130:131],v2 offset:18560
v_mfma_f32_16x16x32_bf16 v[208:211],v[112:115],v[44:47],v[208:211]
ds_read_b64_tr_b16 v[132:133],v3 offset:12416
ds_read_b64_tr_b16 v[134:135],v3 offset:18560
v_mfma_f32_16x16x32_bf16 a[0:3],v[112:115],v[48:51],a[0:3]
ds_read_b64_tr_b16 v[136:137],v4 offset:12416
ds_read_b64_tr_b16 v[138:139],v4 offset:18560
v_mfma_f32_16x16x32_bf16 a[48:51],v[112:115],v[52:55],a[48:51]
ds_read_b64_tr_b16 v[140:141],v5 offset:12416
ds_read_b64_tr_b16 v[142:143],v5 offset:18560
v_mfma_f32_16x16x32_bf16 a[96:99],v[112:115],v[56:59],a[96:99]
ds_read_b64_tr_b16 v[112:113],v2 offset:12544
ds_read_b64_tr_b16 v[114:115],v2 offset:18688
v_mfma_f32_16x16x32_bf16 v[164:167],v[116:119],v[40:43],v[164:167]
v_fma_f32 v90,v90,s36,v15
v_fma_f32 v91,v91,s36,v15
v_mfma_f32_16x16x32_bf16 v[212:215],v[116:119],v[44:47],v[212:215]
v_exp_f32 v90,v90
v_mfma_f32_16x16x32_bf16 a[4:7],v[116:119],v[48:51],a[4:7]
v_exp_f32 v91,v91
v_mfma_f32_16x16x32_bf16 a[52:55],v[116:119],v[52:55],a[52:55]
v_cvt_pk_bf16_f32 v29,v90,v91
v_fma_f32 v96,v96,s36,v16
v_mfma_f32_16x16x32_bf16 a[100:103],v[116:119],v[56:59],a[100:103]
s_waitcnt lgkmcnt(8)
ds_read_b64_tr_b16 v[116:117],v3 offset:12544
ds_read_b64_tr_b16 v[118:119],v3 offset:18688
v_mfma_f32_16x16x32_bf16 v[168:171],v[120:123],v[40:43],v[168:171]
v_fma_f32 v97,v97,s36,v16
v_fma_f32 v98,v98,s36,v16
v_mfma_f32_16x16x32_bf16 v[216:219],v[120:123],v[44:47],v[216:219]
v_fma_f32 v99,v99,s36,v16
v_fma_f32 v104,v104,s36,v17
v_mfma_f32_16x16x32_bf16 a[8:11],v[120:123],v[48:51],a[8:11]
v_exp_f32 v96,v96
v_mfma_f32_16x16x32_bf16 a[56:59],v[120:123],v[52:55],a[56:59]
v_exp_f32 v97,v97
v_mfma_f32_16x16x32_bf16 a[104:107],v[120:123],v[56:59],a[104:107]
ds_read_b64_tr_b16 v[120:121],v4 offset:12544
ds_read_b64_tr_b16 v[122:123],v4 offset:18688
v_mfma_f32_16x16x32_bf16 v[172:175],v[124:127],v[40:43],v[172:175]
v_exp_f32 v98,v98
v_mfma_f32_16x16x32_bf16 v[220:223],v[124:127],v[44:47],v[220:223]
v_exp_f32 v99,v99
v_mfma_f32_16x16x32_bf16 a[12:15],v[124:127],v[48:51],a[12:15]
v_cvt_pk_bf16_f32 v32,v96,v97
v_cvt_pk_bf16_f32 v33,v98,v99
v_mfma_f32_16x16x32_bf16 a[60:63],v[124:127],v[52:55],a[60:63]
v_fma_f32 v105,v105,s36,v17
v_fma_f32 v106,v106,s36,v17
v_mfma_f32_16x16x32_bf16 a[108:111],v[124:127],v[56:59],a[108:111]
ds_read_b64_tr_b16 v[124:125],v5 offset:12544
ds_read_b64_tr_b16 v[126:127],v5 offset:18688
v_mfma_f32_16x16x32_bf16 v[176:179],v[128:131],v[40:43],v[176:179]
v_fma_f32 v107,v107,s36,v17
v_fma_f32 v76,v76,s36,v13
v_mfma_f32_16x16x32_bf16 v[224:227],v[128:131],v[44:47],v[224:227]
v_exp_f32 v104,v104
v_mfma_f32_16x16x32_bf16 a[16:19],v[128:131],v[48:51],a[16:19]
v_exp_f32 v105,v105
v_mfma_f32_16x16x32_bf16 a[64:67],v[128:131],v[52:55],a[64:67]
v_exp_f32 v106,v106
v_mfma_f32_16x16x32_bf16 a[112:115],v[128:131],v[56:59],a[112:115]
s_waitcnt lgkmcnt(2)
v_exp_f32 v107,v107
v_mfma_f32_16x16x32_bf16 v[180:183],v[132:135],v[40:43],v[180:183]
v_cvt_pk_bf16_f32 v36,v104,v105
v_cvt_pk_bf16_f32 v37,v106,v107
v_mfma_f32_16x16x32_bf16 v[228:231],v[132:135],v[44:47],v[228:231]
v_fma_f32 v77,v77,s36,v13
v_fma_f32 v78,v78,s36,v13
v_mfma_f32_16x16x32_bf16 a[20:23],v[132:135],v[48:51],a[20:23]
v_fma_f32 v79,v79,s36,v13
v_fma_f32 v84,v84,s36,v14
v_mfma_f32_16x16x32_bf16 a[68:71],v[132:135],v[52:55],a[68:71]
v_exp_f32 v76,v76
v_mfma_f32_16x16x32_bf16 a[116:119],v[132:135],v[56:59],a[116:119]
v_exp_f32 v77,v77
v_mfma_f32_16x16x32_bf16 v[184:187],v[136:139],v[40:43],v[184:187]
v_exp_f32 v78,v78
v_mfma_f32_16x16x32_bf16 v[232:235],v[136:139],v[44:47],v[232:235]
v_exp_f32 v79,v79
v_mfma_f32_16x16x32_bf16 a[24:27],v[136:139],v[48:51],a[24:27]
v_cvt_pk_bf16_f32 v22,v76,v77
v_cvt_pk_bf16_f32 v23,v78,v79
v_mfma_f32_16x16x32_bf16 a[72:75],v[136:139],v[52:55],a[72:75]
v_fma_f32 v85,v85,s36,v14
v_fma_f32 v86,v86,s36,v14
v_mfma_f32_16x16x32_bf16 a[120:123],v[136:139],v[56:59],a[120:123]
v_fma_f32 v87,v87,s36,v14
v_fma_f32 v92,v92,s36,v15
v_mfma_f32_16x16x32_bf16 v[188:191],v[140:143],v[40:43],v[188:191]
v_exp_f32 v84,v84
v_mfma_f32_16x16x32_bf16 v[236:239],v[140:143],v[44:47],v[236:239]
v_exp_f32 v85,v85
v_mfma_f32_16x16x32_bf16 a[28:31],v[140:143],v[48:51],a[28:31]
v_exp_f32 v86,v86
v_mfma_f32_16x16x32_bf16 a[76:79],v[140:143],v[52:55],a[76:79]
v_exp_f32 v87,v87
v_mfma_f32_16x16x32_bf16 a[124:127],v[140:143],v[56:59],a[124:127]
v_cvt_pk_bf16_f32 v26,v84,v85
v_cvt_pk_bf16_f32 v27,v86,v87
v_mfma_f32_16x16x32_bf16 v[192:195],v[112:115],v[40:43],v[192:195]
v_fma_f32 v93,v93,s36,v15
v_fma_f32 v94,v94,s36,v15
v_smfmac_f32_16x16x64_bf16 v[60:63],v[152:155],v[20:27],v18
v_fma_f32 v95,v95,s36,v15
s_waitcnt vmcnt(6) lgkmcnt(0)
v_mfma_f32_16x16x32_bf16 v[240:243],v[112:115],v[44:47],v[240:243]
s_barrier
v_mfma_f32_16x16x32_bf16 a[32:35],v[112:115],v[48:51],a[32:35]
ds_read_b128 v[128:131],v0 offset:0
v_fma_f32 v100,v100,s36,v16
v_mfma_f32_16x16x32_bf16 a[80:83],v[112:115],v[52:55],a[80:83]
ds_read_b128 v[132:135],v1 offset:0
v_fma_f32 v101,v101,s36,v16
v_mfma_f32_16x16x32_bf16 a[128:131],v[112:115],v[56:59],a[128:131]
ds_read_b128 v[136:139],v0 offset:128
v_fma_f32 v102,v102,s36,v16
v_mfma_f32_16x16x32_bf16 v[196:199],v[116:119],v[40:43],v[196:199]
ds_read_b128 v[140:143],v1 offset:128
v_fma_f32 v103,v103,s36,v16
v_mfma_f32_16x16x32_bf16 v[244:247],v[116:119],v[44:47],v[244:247]
ds_read_b128 v[112:115],v0 offset:256
v_fma_f32 v108,v108,s36,v17
v_mfma_f32_16x16x32_bf16 a[36:39],v[116:119],v[48:51],a[36:39]
buffer_load_dwordx4 v6,s[8:11],s21 offen offset:0 lds
v_mfma_f32_16x16x32_bf16 a[84:87],v[116:119],v[52:55],a[84:87]
v_exp_f32 v92,v92
v_mfma_f32_16x16x32_bf16 a[132:135],v[116:119],v[56:59],a[132:135]
ds_read_b128 v[116:119],v1 offset:256
v_fma_f32 v109,v109,s36,v17
v_mfma_f32_16x16x32_bf16 v[200:203],v[120:123],v[40:43],v[200:203]
v_exp_f32 v93,v93
v_mfma_f32_16x16x32_bf16 v[248:251],v[120:123],v[44:47],v[248:251]
v_exp_f32 v94,v94
v_mfma_f32_16x16x32_bf16 a[40:43],v[120:123],v[48:51],a[40:43]
v_exp_f32 v95,v95
v_mfma_f32_16x16x32_bf16 a[88:91],v[120:123],v[52:55],a[88:91]
v_cvt_pk_bf16_f32 v30,v92,v93
v_cvt_pk_bf16_f32 v31,v94,v95
v_mfma_f32_16x16x32_bf16 a[136:139],v[120:123],v[56:59],a[136:139]
ds_read_b128 v[120:123],v0 offset:6144
v_fma_f32 v110,v110,s36,v17
v_mfma_f32_16x16x32_bf16 v[204:207],v[124:127],v[40:43],v[204:207]
v_exp_f32 v100,v100
v_mfma_f32_16x16x32_bf16 v[252:255],v[124:127],v[44:47],v[252:255]
v_exp_f32 v101,v101
v_mfma_f32_16x16x32_bf16 a[44:47],v[124:127],v[48:51],a[44:47]
v_exp_f32 v102,v102
v_mfma_f32_16x16x32_bf16 a[92:95],v[124:127],v[52:55],a[92:95]
v_exp_f32 v103,v103
v_mfma_f32_16x16x32_bf16 a[140:143],v[124:127],v[56:59],a[140:143]
buffer_load_dwordx4 v7,s[8:11],s21 offen offset:1024 lds
s_waitcnt lgkmcnt(1)
v_mfma_f32_16x16x32_bf16 v[72:75],v[128:131],a[144:147],0
ds_read_b128 v[124:127],v1 offset:6144
v_cvt_pk_bf16_f32 v34,v100,v101
v_mfma_f32_16x16x32_bf16 v[80:83],v[128:131],a[168:171],0
v_cvt_pk_bf16_f32 v35,v102,v103
v_fma_f32 v111,v111,s36,v17
v_mfma_f32_16x16x32_bf16 v[88:91],v[128:131],a[192:195],0
v_exp_f32 v108,v108
v_smfmac_f32_16x16x64_bf16 v[64:67],v[152:155],v[28:35],v18
v_mfma_f32_16x16x32_bf16 v[96:99],v[128:131],a[216:219],0
v_exp_f32 v109,v109
v_mfma_f32_16x16x32_bf16 v[104:107],v[128:131],a[240:243],0
ds_read_b128 v[128:131],v0 offset:6272
v_cvt_pk_bf16_f32 v38,v108,v109
v_mfma_f32_16x16x32_bf16 v[72:75],v[132:135],a[148:151],v[72:75]
v_exp_f32 v110,v110
v_mfma_f32_16x16x32_bf16 v[80:83],v[132:135],a[172:175],v[80:83]
v_exp_f32 v111,v111
v_mfma_f32_16x16x32_bf16 v[88:91],v[132:135],a[196:199],v[88:91]
v_cvt_pk_bf16_f32 v39,v110,v111
v_mfma_f32_16x16x32_bf16 v[96:99],v[132:135],a[220:223],v[96:99]
v_mfma_f32_16x16x32_bf16 v[104:107],v[132:135],a[244:247],v[104:107]
buffer_load_dwordx4 v8,s[8:11],s21 offen offset:2048 lds
v_smfmac_f32_16x16x64_bf16 v[68:71],v[152:155],v[32:39],v18
s_add_u32 s21,s21,12288
ds_read_b128 v[132:135],v1 offset:6272
v_mfma_f32_16x16x32_bf16 v[72:75],v[136:139],a[152:155],v[72:75]
s_add_u32 m0,s22,24576
v_mfma_f32_16x16x32_bf16 v[80:83],v[136:139],a[176:179],v[80:83]
v_mfma_f32_16x16x32_bf16 v[88:91],v[136:139],a[200:203],v[88:91]
v_mfma_f32_16x16x32_bf16 v[96:99],v[136:139],a[224:227],v[96:99]
v_mfma_f32_16x16x32_bf16 v[104:107],v[136:139],a[248:251],v[104:107]
ds_read_b128 v[136:139],v0 offset:6400
v_mfma_f32_16x16x32_bf16 v[72:75],v[140:143],a[156:159],v[72:75]
v_mfma_f32_16x16x32_bf16 v[80:83],v[140:143],a[180:183],v[80:83]
v_mfma_f32_16x16x32_bf16 v[88:91],v[140:143],a[204:207],v[88:91]
v_mfma_f32_16x16x32_bf16 v[96:99],v[140:143],a[228:231],v[96:99]
v_mfma_f32_16x16x32_bf16 v[104:107],v[140:143],a[252:255],v[104:107]
buffer_load_dwordx4 v6,s[4:7],s20 offen offset:0 lds
v_mfma_f32_16x16x32_bf16 v[72:75],v[112:115],a[160:163],v[72:75]
ds_read_b128 v[140:143],v1 offset:6400
v_mfma_f32_16x16x32_bf16 v[80:83],v[112:115],a[184:187],v[80:83]
v_mfma_f32_16x16x32_bf16 v[88:91],v[112:115],a[208:211],v[88:91]
v_mfma_f32_16x16x32_bf16 v[96:99],v[112:115],a[232:235],v[96:99]
v_mfma_f32_16x16x32_bf16 v[104:107],v[112:115],v[144:147],v[104:107]
v_mfma_f32_16x16x32_bf16 v[72:75],v[116:119],a[164:167],v[72:75]
v_mfma_f32_16x16x32_bf16 v[80:83],v[116:119],a[188:191],v[80:83]
v_mfma_f32_16x16x32_bf16 v[88:91],v[116:119],a[212:215],v[88:91]
v_mfma_f32_16x16x32_bf16 v[96:99],v[116:119],a[236:239],v[96:99]
v_mfma_f32_16x16x32_bf16 v[104:107],v[116:119],v[148:151],v[104:107]
s_waitcnt lgkmcnt(0)
v_mfma_f32_16x16x32_bf16 v[76:79],v[120:123],a[144:147],0
v_mfma_f32_16x16x32_bf16 v[84:87],v[120:123],a[168:171],0
buffer_load_dwordx4 v7,s[4:7],s20 offen offset:1024 lds
v_mfma_f32_16x16x32_bf16 v[92:95],v[120:123],a[192:195],0
v_fma_f32 v72,v72,s36,v13
v_fma_f32 v73,v73,s36,v13
v_mfma_f32_16x16x32_bf16 v[100:103],v[120:123],a[216:219],0
v_fma_f32 v74,v74,s36,v13
v_fma_f32 v75,v75,s36,v13
v_mfma_f32_16x16x32_bf16 v[108:111],v[120:123],a[240:243],0
v_fma_f32 v80,v80,s36,v14
v_fma_f32 v81,v81,s36,v14
v_mfma_f32_16x16x32_bf16 v[76:79],v[124:127],a[148:151],v[76:79]
v_fma_f32 v82,v82,s36,v14
v_fma_f32 v83,v83,s36,v14
v_mfma_f32_16x16x32_bf16 v[84:87],v[124:127],a[172:175],v[84:87]
v_fma_f32 v88,v88,s36,v15
v_fma_f32 v89,v89,s36,v15
v_mfma_f32_16x16x32_bf16 v[92:95],v[124:127],a[196:199],v[92:95]
v_exp_f32 v72,v72
v_mfma_f32_16x16x32_bf16 v[100:103],v[124:127],a[220:223],v[100:103]
v_exp_f32 v73,v73
v_mfma_f32_16x16x32_bf16 v[108:111],v[124:127],a[244:247],v[108:111]
v_exp_f32 v74,v74
v_mfma_f32_16x16x32_bf16 v[76:79],v[128:131],a[152:155],v[76:79]
v_exp_f32 v75,v75
v_mfma_f32_16x16x32_bf16 v[84:87],v[128:131],a[176:179],v[84:87]
v_exp_f32 v80,v80
v_mfma_f32_16x16x32_bf16 v[92:95],v[128:131],a[200:203],v[92:95]
buffer_load_dwordx4 v8,s[4:7],s20 offen offset:2048 lds
v_mfma_f32_16x16x32_bf16 v[100:103],v[128:131],a[224:227],v[100:103]
s_add_u32 s20,s20,12288
v_exp_f32 v81,v81
v_mfma_f32_16x16x32_bf16 v[108:111],v[128:131],a[248:251],v[108:111]
v_exp_f32 v82,v82
v_mfma_f32_16x16x32_bf16 v[76:79],v[132:135],a[156:159],v[76:79]
v_exp_f32 v83,v83
v_mfma_f32_16x16x32_bf16 v[84:87],v[132:135],a[180:183],v[84:87]
v_exp_f32 v88,v88
v_mfma_f32_16x16x32_bf16 v[92:95],v[132:135],a[204:207],v[92:95]
ds_read_b64_tr_b16 v[112:113],v2 offset:24576
v_mfma_f32_16x16x32_bf16 v[100:103],v[132:135],a[228:231],v[100:103]
ds_read_b64_tr_b16 v[114:115],v2 offset:30720
v_cvt_pk_bf16_f32 v40,v72,v73
v_mfma_f32_16x16x32_bf16 v[108:111],v[132:135],a[252:255],v[108:111]
v_exp_f32 v89,v89
v_mfma_f32_16x16x32_bf16 v[76:79],v[136:139],a[160:163],v[76:79]
ds_read_b64_tr_b16 v[116:117],v3 offset:24576
ds_read_b64_tr_b16 v[118:119],v3 offset:30720
v_mfma_f32_16x16x32_bf16 v[84:87],v[136:139],a[184:187],v[84:87]
v_cvt_pk_bf16_f32 v41,v74,v75
v_cvt_pk_bf16_f32 v44,v80,v81
v_mfma_f32_16x16x32_bf16 v[92:95],v[136:139],a[208:211],v[92:95]
ds_read_b64_tr_b16 v[120:121],v4 offset:24576
v_mfma_f32_16x16x32_bf16 v[100:103],v[136:139],a[232:235],v[100:103]
ds_read_b64_tr_b16 v[122:123],v4 offset:30720
v_cvt_pk_bf16_f32 v45,v82,v83
v_mfma_f32_16x16x32_bf16 v[108:111],v[136:139],v[144:147],v[108:111]
v_cvt_pk_bf16_f32 v48,v88,v89
v_mfma_f32_16x16x32_bf16 v[76:79],v[140:143],a[164:167],v[76:79]
ds_read_b64_tr_b16 v[124:125],v5 offset:24576
ds_read_b64_tr_b16 v[126:127],v5 offset:30720
v_mfma_f32_16x16x32_bf16 v[84:87],v[140:143],a[188:191],v[84:87]
v_mfma_f32_16x16x32_bf16 v[92:95],v[140:143],a[212:215],v[92:95]
v_mfma_f32_16x16x32_bf16 v[100:103],v[140:143],a[236:239],v[100:103]
v_mfma_f32_16x16x32_bf16 v[108:111],v[140:143],v[148:151],v[108:111]
s_mov_b32 s38,0
s_branch L_loop5
L_start4:
s_add_u32 m0,s24,12288
s_waitcnt vmcnt(9)
ds_read_b128 a[144:147],v11 offset:0
ds_read_b128 a[148:151],v12 offset:0
buffer_load_dwordx4 v6,s[12:15],s28 offen offset:0 nt lds
ds_read_b128 a[152:155],v11 offset:128
buffer_load_dwordx4 v7,s[12:15],s28 offen offset:1024 nt lds
ds_read_b128 a[156:159],v12 offset:128
buffer_load_dwordx4 v8,s[12:15],s28 offen offset:2048 nt lds
s_add_u32 s28,s28,3072
s_add_u32 m0,s24,15360
ds_read_b128 a[160:163],v11 offset:256
ds_read_b128 a[164:167],v12 offset:256
buffer_load_dwordx4 v6,s[12:15],s28 offen offset:0 nt lds
buffer_load_dwordx4 v7,s[12:15],s28 offen offset:1024 nt lds
buffer_load_dwordx4 v8,s[12:15],s28 offen offset:2048 nt lds
s_add_u32 s28,s28,3072
s_add_u32 m0,s24,0
ds_read_b128 v[112:115],v0 offset:0
ds_read_b128 v[116:119],v1 offset:0
v_mov_b32 v60,0
ds_read_b128 v[120:123],v0 offset:128
v_mov_b32 v61,0
ds_read_b128 v[124:127],v1 offset:128
v_mov_b32 v62,0
ds_read_b128 v[128:131],v0 offset:256
v_mov_b32 v63,0
ds_read_b128 v[132:135],v1 offset:256
v_mov_b32 v64,0
ds_read_b128 v[136:139],v0 offset:6144
v_mov_b32 v65,0
ds_read_b128 v[140:143],v1 offset:6144
v_mov_b32 v66,0
v_mov_b32 v67,0
s_waitcnt lgkmcnt(7)
v_mfma_f32_16x16x32_bf16 v[72:75],v[112:115],a[144:147],0
s_waitcnt lgkmcnt(6)
ds_read_b128 v[112:115],v0 offset:6272
v_mfma_f32_16x16x32_bf16 v[72:75],v[116:119],a[148:151],v[72:75]
s_waitcnt lgkmcnt(6)
ds_read_b128 v[116:119],v1 offset:6272
v_mfma_f32_16x16x32_bf16 v[72:75],v[120:123],a[152:155],v[72:75]
s_waitcnt lgkmcnt(6)
ds_read_b128 v[120:123],v0 offset:6400
v_mfma_f32_16x16x32_bf16 v[72:75],v[124:127],a[156:159],v[72:75]
s_waitcnt lgkmcnt(6)
ds_read_b128 v[124:127],v1 offset:6400
v_mfma_f32_16x16x32_bf16 v[72:75],v[128:131],a[160:163],v[72:75]
s_waitcnt lgkmcnt(6)
ds_read_b128 v[128:131],v0 offset:0
v_mfma_f32_16x16x32_bf16 v[72:75],v[132:135],a[164:167],v[72:75]
s_waitcnt lgkmcnt(6)
ds_read_b128 v[132:135],v1 offset:0
v_mfma_f32_16x16x32_bf16 v[76:79],v[136:139],a[144:147],0
s_waitcnt lgkmcnt(6)
ds_read_b128 v[136:139],v0 offset:128
v_mfma_f32_16x16x32_bf16 v[76:79],v[140:143],a[148:151],v[76:79]
s_waitcnt lgkmcnt(6)
ds_read_b128 v[140:143],v1 offset:128
v_mfma_f32_16x16x32_bf16 v[76:79],v[112:115],a[152:155],v[76:79]
s_waitcnt lgkmcnt(6)
ds_read_b128 v[112:115],v0 offset:256
v_mfma_f32_16x16x32_bf16 v[76:79],v[116:119],a[156:159],v[76:79]
s_waitcnt lgkmcnt(6)
ds_read_b128 v[116:119],v1 offset:256
v_max3_f32 v40,v72,v73,v74
v_mfma_f32_16x16x32_bf16 v[76:79],v[120:123],a[160:163],v[76:79]
s_waitcnt lgkmcnt(6)
ds_read_b128 v[120:123],v0 offset:6144
v_mfma_f32_16x16x32_bf16 v[76:79],v[124:127],a[164:167],v[76:79]
s_waitcnt vmcnt(6)
ds_read_b128 a[168:171],v11 offset:6144
ds_read_b128 a[172:175],v12 offset:6144
buffer_load_dwordx4 v6,s[12:15],s28 offen offset:0 nt lds
ds_read_b128 a[176:179],v11 offset:6272
buffer_load_dwordx4 v7,s[12:15],s28 offen offset:1024 nt lds
ds_read_b128 a[180:183],v12 offset:6272
buffer_load_dwordx4 v8,s[12:15],s28 offen offset:2048 nt lds
s_add_u32 s28,s28,3072
s_add_u32 m0,s24,3072
ds_read_b128 a[184:187],v11 offset:6400
ds_read_b128 a[188:191],v12 offset:6400
buffer_load_dwordx4 v6,s[12:15],s28 offen offset:0 nt lds
buffer_load_dwordx4 v7,s[12:15],s28 offen offset:1024 nt lds
buffer_load_dwordx4 v8,s[12:15],s28 offen offset:2048 nt lds
s_add_u32 s28,s28,3072
s_add_u32 m0,s23,0
ds_read_b128 v[124:127],v1 offset:6144
v_max3_f32 v40,v40,v75,v76
v_max3_f32 v40,v40,v77,v78
v_max_f32 v40,v40,v79
v_mov_b32 v41,v40
s_waitcnt lgkmcnt(6)
v_mfma_f32_16x16x32_bf16 v[80:83],v[128:131],a[168:171],0
s_waitcnt lgkmcnt(5)
ds_read_b128 v[128:131],v0 offset:6272
v_permlane32_swap_b32 v41,v40
v_mfma_f32_16x16x32_bf16 v[80:83],v[132:135],a[172:175],v[80:83]
s_waitcnt lgkmcnt(4)
ds_read_b128 v[132:135],v1 offset:6272
v_max_f32 v40,v40,v41
v_mfma_f32_16x16x32_bf16 v[80:83],v[136:139],a[176:179],v[80:83]
ds_read_b128 v[136:139],v0 offset:6400
v_mov_b32 v41,v40
v_mfma_f32_16x16x32_bf16 v[80:83],v[140:143],a[180:183],v[80:83]
s_waitcnt lgkmcnt(4)
ds_read_b128 v[140:143],v1 offset:6400
v_permlane16_swap_b32 v41,v40
v_mfma_f32_16x16x32_bf16 v[80:83],v[112:115],a[184:187],v[80:83]
ds_read_b128 v[112:115],v0 offset:12288
v_max_f32 v40,v40,v41
v_mfma_f32_16x16x32_bf16 v[80:83],v[116:119],a[188:191],v[80:83]
ds_read_b128 v[116:119],v1 offset:12288
v_mul_f32_e64 v13,-s36,v40
v_mfma_f32_16x16x32_bf16 v[84:87],v[120:123],a[168:171],0
s_waitcnt lgkmcnt(6)
ds_read_b128 v[120:123],v0 offset:12416
v_fma_f32 v72,v72,s36,v13
v_mfma_f32_16x16x32_bf16 v[84:87],v[124:127],a[172:175],v[84:87]
ds_read_b128 v[124:127],v1 offset:12416
v_fma_f32 v73,v73,s36,v13
v_fma_f32 v74,v74,s36,v13
v_fma_f32 v75,v75,s36,v13
v_exp_f32 v72,v72
s_waitcnt lgkmcnt(7)
v_mfma_f32_16x16x32_bf16 v[84:87],v[128:131],a[176:179],v[84:87]
s_waitcnt lgkmcnt(5)
ds_read_b128 v[128:131],v0 offset:12544
v_exp_f32 v73,v73
v_mfma_f32_16x16x32_bf16 v[84:87],v[132:135],a[180:183],v[84:87]
ds_read_b128 v[132:135],v1 offset:12544
v_exp_f32 v74,v74
v_mfma_f32_16x16x32_bf16 v[84:87],v[136:139],a[184:187],v[84:87]
s_waitcnt lgkmcnt(5)
ds_read_b128 v[136:139],v0 offset:18432
v_exp_f32 v75,v75
v_mfma_f32_16x16x32_bf16 v[84:87],v[140:143],a[188:191],v[84:87]
ds_read_b128 v[140:143],v1 offset:18432
v_cvt_pk_bf16_f32 v20,v72,v73
v_cvt_pk_bf16_f32 v21,v74,v75
v_mfma_f32_16x16x32_bf16 v[72:75],v[112:115],a[144:147],0
s_waitcnt lgkmcnt(5)
ds_read_b128 v[112:115],v0 offset:18560
v_fma_f32 v76,v76,s36,v13
v_mfma_f32_16x16x32_bf16 v[72:75],v[116:119],a[148:151],v[72:75]
ds_read_b128 v[116:119],v1 offset:18560
v_fma_f32 v77,v77,s36,v13
v_mfma_f32_16x16x32_bf16 v[72:75],v[120:123],a[152:155],v[72:75]
s_waitcnt lgkmcnt(6)
ds_read_b128 v[120:123],v0 offset:18688
v_fma_f32 v78,v78,s36,v13
v_mfma_f32_16x16x32_bf16 v[72:75],v[124:127],a[156:159],v[72:75]
s_waitcnt lgkmcnt(6)
ds_read_b128 v[124:127],v1 offset:18688
v_fma_f32 v79,v79,s36,v13
v_exp_f32 v76,v76
v_mfma_f32_16x16x32_bf16 v[72:75],v[128:131],a[160:163],v[72:75]
s_waitcnt lgkmcnt(5)
ds_read_b128 v[128:131],v0 offset:0
v_exp_f32 v77,v77
v_mfma_f32_16x16x32_bf16 v[72:75],v[132:135],a[164:167],v[72:75]
ds_read_b128 v[132:135],v1 offset:0
v_exp_f32 v78,v78
v_exp_f32 v79,v79
v_cvt_pk_bf16_f32 v22,v76,v77
v_cvt_pk_bf16_f32 v23,v78,v79
v_mfma_f32_16x16x32_bf16 v[76:79],v[136:139],a[144:147],0
s_waitcnt lgkmcnt(5)
ds_read_b128 v[136:139],v0 offset:128
v_max3_f32 v44,v80,v81,v82
v_mfma_f32_16x16x32_bf16 v[76:79],v[140:143],a[148:151],v[76:79]
ds_read_b128 v[140:143],v1 offset:128
v_max3_f32 v44,v44,v83,v84
v_mfma_f32_16x16x32_bf16 v[76:79],v[112:115],a[152:155],v[76:79]
s_waitcnt lgkmcnt(5)
ds_read_b128 v[112:115],v0 offset:256
v_max3_f32 v44,v44,v85,v86
v_mfma_f32_16x16x32_bf16 v[76:79],v[116:119],a[156:159],v[76:79]
ds_read_b128 v[116:119],v1 offset:256
v_max_f32 v44,v44,v87
v_mfma_f32_16x16x32_bf16 v[76:79],v[120:123],a[160:163],v[76:79]
s_waitcnt lgkmcnt(5)
ds_read_b128 v[120:123],v0 offset:6144
v_mov_b32 v45,v44
v_mfma_f32_16x16x32_bf16 v[76:79],v[124:127],a[164:167],v[76:79]
s_waitcnt vmcnt(6)
ds_read_b128 a[192:195],v11 offset:12288
ds_read_b128 a[196:199],v12 offset:12288
buffer_load_dwordx4 v6,s[8:11],s21 offen offset:0 lds
ds_read_b128 a[200:203],v11 offset:12416
buffer_load_dwordx4 v7,s[8:11],s21 offen offset:1024 lds
ds_read_b128 a[204:207],v12 offset:12416
buffer_load_dwordx4 v8,s[8:11],s21 offen offset:2048 lds
s_add_u32 s21,s21,12288
s_add_u32 m0,s22,24576
ds_read_b128 a[208:211],v11 offset:12544
ds_read_b128 a[212:215],v12 offset:12544
buffer_load_dwordx4 v6,s[4:7],s20 offen offset:0 lds
buffer_load_dwordx4 v7,s[4:7],s20 offen offset:1024 lds
buffer_load_dwordx4 v8,s[4:7],s20 offen offset:2048 lds
s_add_u32 s20,s20,12288
s_add_u32 m0,s23,12288
ds_read_b128 v[124:127],v1 offset:6144
v_permlane32_swap_b32 v45,v44
v_max_f32 v44,v44,v45
v_mov_b32 v45,v44
s_waitcnt lgkmcnt(6)
v_mfma_f32_16x16x32_bf16 v[88:91],v[128:131],a[192:195],0
s_waitcnt lgkmcnt(5)
ds_read_b128 v[128:131],v0 offset:6272
v_permlane16_swap_b32 v45,v44
v_mfma_f32_16x16x32_bf16 v[88:91],v[132:135],a[196:199],v[88:91]
s_waitcnt lgkmcnt(4)
ds_read_b128 v[132:135],v1 offset:6272
v_max_f32 v44,v44,v45
v_mfma_f32_16x16x32_bf16 v[88:91],v[136:139],a[200:203],v[88:91]
ds_read_b128 v[136:139],v0 offset:6400
v_mul_f32_e64 v14,-s36,v44
v_mfma_f32_16x16x32_bf16 v[88:91],v[140:143],a[204:207],v[88:91]
s_waitcnt lgkmcnt(4)
ds_read_b128 v[140:143],v1 offset:6400
v_fma_f32 v80,v80,s36,v14
v_mfma_f32_16x16x32_bf16 v[88:91],v[112:115],a[208:211],v[88:91]
ds_read_b128 v[112:115],v0 offset:12288
v_fma_f32 v81,v81,s36,v14
v_mfma_f32_16x16x32_bf16 v[88:91],v[116:119],a[212:215],v[88:91]
ds_read_b128 v[116:119],v1 offset:12288
v_fma_f32 v82,v82,s36,v14
v_mfma_f32_16x16x32_bf16 v[92:95],v[120:123],a[192:195],0
s_waitcnt lgkmcnt(6)
ds_read_b128 v[120:123],v0 offset:12416
v_fma_f32 v83,v83,s36,v14
v_exp_f32 v80,v80
v_mfma_f32_16x16x32_bf16 v[92:95],v[124:127],a[196:199],v[92:95]
s_waitcnt lgkmcnt(6)
ds_read_b128 v[124:127],v1 offset:12416
v_exp_f32 v81,v81
v_exp_f32 v82,v82
v_mfma_f32_16x16x32_bf16 v[92:95],v[128:131],a[200:203],v[92:95]
s_waitcnt lgkmcnt(5)
ds_read_b128 v[128:131],v0 offset:12544
v_exp_f32 v83,v83
v_mfma_f32_16x16x32_bf16 v[92:95],v[132:135],a[204:207],v[92:95]
ds_read_b128 v[132:135],v1 offset:12544
v_cvt_pk_bf16_f32 v24,v80,v81
v_mfma_f32_16x16x32_bf16 v[92:95],v[136:139],a[208:211],v[92:95]
s_waitcnt lgkmcnt(5)
ds_read_b128 v[136:139],v0 offset:18432
v_cvt_pk_bf16_f32 v25,v82,v83
v_mfma_f32_16x16x32_bf16 v[92:95],v[140:143],a[212:215],v[92:95]
ds_read_b128 v[140:143],v1 offset:18432
v_fma_f32 v84,v84,s36,v14
v_mfma_f32_16x16x32_bf16 v[80:83],v[112:115],a[168:171],0
s_waitcnt lgkmcnt(5)
ds_read_b128 v[112:115],v0 offset:18560
v_fma_f32 v85,v85,s36,v14
v_mfma_f32_16x16x32_bf16 v[80:83],v[116:119],a[172:175],v[80:83]
ds_read_b128 v[116:119],v1 offset:18560
v_fma_f32 v86,v86,s36,v14
v_mfma_f32_16x16x32_bf16 v[80:83],v[120:123],a[176:179],v[80:83]
s_waitcnt lgkmcnt(6)
ds_read_b128 v[120:123],v0 offset:18688
v_fma_f32 v87,v87,s36,v14
v_exp_f32 v84,v84
v_mfma_f32_16x16x32_bf16 v[80:83],v[124:127],a[180:183],v[80:83]
s_waitcnt lgkmcnt(6)
ds_read_b128 v[124:127],v1 offset:18688
v_exp_f32 v85,v85
v_exp_f32 v86,v86
v_mfma_f32_16x16x32_bf16 v[80:83],v[128:131],a[184:187],v[80:83]
s_waitcnt lgkmcnt(5)
ds_read_b128 v[128:131],v0 offset:0
v_exp_f32 v87,v87
v_mfma_f32_16x16x32_bf16 v[80:83],v[132:135],a[188:191],v[80:83]
ds_read_b128 v[132:135],v1 offset:0
v_cvt_pk_bf16_f32 v26,v84,v85
v_cvt_pk_bf16_f32 v27,v86,v87
v_mfma_f32_16x16x32_bf16 v[84:87],v[136:139],a[168:171],0
ds_read_b128 v[136:139],v0 offset:128
v_max3_f32 v48,v88,v89,v90
v_smfmac_f32_16x16x64_bf16 v[60:63],v[152:155],v[20:27],v18
s_waitcnt lgkmcnt(5)
v_max3_f32 v48,v48,v91,v92
v_mfma_f32_16x16x32_bf16 v[84:87],v[140:143],a[172:175],v[84:87]
ds_read_b128 v[140:143],v1 offset:128
v_max3_f32 v48,v48,v93,v94
v_mfma_f32_16x16x32_bf16 v[84:87],v[112:115],a[176:179],v[84:87]
ds_read_b128 v[112:115],v0 offset:256
v_max_f32 v48,v48,v95
v_mfma_f32_16x16x32_bf16 v[84:87],v[116:119],a[180:183],v[84:87]
s_waitcnt lgkmcnt(5)
ds_read_b128 v[116:119],v1 offset:256
v_mov_b32 v49,v48
v_mfma_f32_16x16x32_bf16 v[84:87],v[120:123],a[184:187],v[84:87]
ds_read_b128 v[120:123],v0 offset:6144
v_permlane32_swap_b32 v49,v48
v_mfma_f32_16x16x32_bf16 v[84:87],v[124:127],a[188:191],v[84:87]
s_waitcnt vmcnt(6)
ds_read_b128 a[216:219],v11 offset:0
ds_read_b128 a[220:223],v12 offset:0
buffer_load_dwordx4 v6,s[8:11],s21 offen offset:0 lds
ds_read_b128 a[224:227],v11 offset:128
buffer_load_dwordx4 v7,s[8:11],s21 offen offset:1024 lds
ds_read_b128 a[228:231],v12 offset:128
buffer_load_dwordx4 v8,s[8:11],s21 offen offset:2048 lds
s_add_u32 s21,s21,12288
s_add_u32 m0,s23,24576
ds_read_b128 a[232:235],v11 offset:256
ds_read_b128 a[236:239],v12 offset:256
buffer_load_dwordx4 v6,s[8:11],s21 offen offset:0 lds
buffer_load_dwordx4 v7,s[8:11],s21 offen offset:1024 lds
buffer_load_dwordx4 v8,s[8:11],s21 offen offset:2048 lds
s_add_u32 s21,s21,12288
ds_read_b128 v[124:127],v1 offset:6144
v_max_f32 v48,v48,v49
v_mov_b32 v49,v48
v_fma_f32 v72,v72,s36,v13
v_fma_f32 v73,v73,s36,v13
v_permlane16_swap_b32 v49,v48
s_waitcnt lgkmcnt(6)
v_mfma_f32_16x16x32_bf16 v[96:99],v[128:131],a[216:219],0
s_mov_b32 s27,166723584
ds_read_b128 v[128:131],v0 offset:6272
v_max_f32 v48,v48,v49
s_waitcnt lgkmcnt(6)
v_mfma_f32_16x16x32_bf16 v[96:99],v[132:135],a[220:223],v[96:99]
s_mov_b32 s42,s41
ds_read_b128 v[132:135],v1 offset:6272
v_mul_f32_e64 v15,-s36,v48
s_waitcnt lgkmcnt(5)
v_mfma_f32_16x16x32_bf16 v[96:99],v[136:139],a[224:227],v[96:99]
s_add_u32 s69,s69,1
ds_read_b128 v[136:139],v0 offset:6400
v_fma_f32 v88,v88,s36,v15
v_mfma_f32_16x16x32_bf16 v[96:99],v[140:143],a[228:231],v[96:99]
s_lshl_b32 s62,s69,5
ds_read_b128 v[140:143],v1 offset:6400
v_fma_f32 v89,v89,s36,v15
s_waitcnt lgkmcnt(5)
v_mfma_f32_16x16x32_bf16 v[96:99],v[112:115],a[232:235],v[96:99]
s_add_u32 s62,s62,s34
ds_read_b128 v[112:115],v0 offset:12288
v_fma_f32 v90,v90,s36,v15
v_mfma_f32_16x16x32_bf16 v[96:99],v[116:119],a[236:239],v[96:99]
s_mul_i32 s63,s62,171
ds_read_b128 v[116:119],v1 offset:12288
v_fma_f32 v91,v91,s36,v15
v_mfma_f32_16x16x32_bf16 v[100:103],v[120:123],a[216:219],0
s_lshr_b32 s63,s63,9
ds_read_b128 v[120:123],v0 offset:12416
v_exp_f32 v88,v88
s_waitcnt lgkmcnt(7)
v_mfma_f32_16x16x32_bf16 v[100:103],v[124:127],a[220:223],v[100:103]
s_mul_i32 s64,s63,3
ds_read_b128 v[124:127],v1 offset:12416
v_exp_f32 v89,v89
v_exp_f32 v90,v90
v_exp_f32 v91,v91
s_waitcnt lgkmcnt(6)
v_mfma_f32_16x16x32_bf16 v[100:103],v[128:131],a[224:227],v[100:103]
s_sub_u32 s62,s62,s64
ds_read_b128 v[128:131],v0 offset:12544
v_cvt_pk_bf16_f32 v28,v88,v89
v_mfma_f32_16x16x32_bf16 v[100:103],v[132:135],a[228:231],v[100:103]
s_add_u32 s63,s63,s33
ds_read_b128 v[132:135],v1 offset:12544
v_cvt_pk_bf16_f32 v29,v90,v91
s_waitcnt lgkmcnt(6)
v_mfma_f32_16x16x32_bf16 v[100:103],v[136:139],a[232:235],v[100:103]
s_mul_i32 s30,s63,196608
ds_read_b128 v[136:139],v0 offset:18432
v_fma_f32 v92,v92,s36,v15
v_mfma_f32_16x16x32_bf16 v[100:103],v[140:143],a[236:239],v[100:103]
s_waitcnt vmcnt(9)
s_barrier
s_waitcnt lgkmcnt(5)
v_mfma_f32_16x16x32_bf16 v[88:91],v[112:115],a[192:195],0
s_mul_i32 s41,s63,325632
ds_read_b128 v[140:143],v1 offset:18432
v_fma_f32 v93,v93,s36,v15
v_mfma_f32_16x16x32_bf16 v[88:91],v[116:119],a[196:199],v[88:91]
s_lshl_b32 s63,s3,2
ds_read_b128 v[112:115],v0 offset:18560
v_fma_f32 v94,v94,s36,v15
s_waitcnt lgkmcnt(5)
v_mfma_f32_16x16x32_bf16 v[88:91],v[120:123],a[200:203],v[88:91]
s_add_u32 s64,s63,21
ds_read_b128 v[116:119],v1 offset:18560
v_fma_f32 v95,v95,s36,v15
v_mfma_f32_16x16x32_bf16 v[88:91],v[124:127],a[204:207],v[88:91]
s_cmp_eq_u32 s3,0
ds_read_b128 v[120:123],v0 offset:18688
v_exp_f32 v92,v92
v_exp_f32 v93,v93
s_waitcnt lgkmcnt(6)
v_mfma_f32_16x16x32_bf16 v[88:91],v[128:131],a[208:211],v[88:91]
s_cselect_b32 s64,20,s64
ds_read_b128 v[124:127],v1 offset:18688
v_exp_f32 v94,v94
s_waitcnt lgkmcnt(5)
v_mfma_f32_16x16x32_bf16 v[88:91],v[132:135],a[212:215],v[88:91]
s_cselect_b32 s40,1,0
ds_read_b128 v[128:131],v0 offset:12288
ds_read_b128 v[132:135],v1 offset:12288
v_exp_f32 v95,v95
v_cvt_pk_bf16_f32 v30,v92,v93
v_cvt_pk_bf16_f32 v31,v94,v95
v_mfma_f32_16x16x32_bf16 v[92:95],v[136:139],a[192:195],0
s_add_u32 s65,s63,37
ds_read_b128 v[136:139],v0 offset:12416
v_max3_f32 v52,v96,v97,v98
s_waitcnt lgkmcnt(7)
v_mfma_f32_16x16x32_bf16 v[92:95],v[140:143],a[196:199],v[92:95]
s_cmp_eq_u32 s62,2
ds_read_b128 v[140:143],v1 offset:12416
v_max3_f32 v52,v52,v99,v100
s_waitcnt lgkmcnt(7)
v_mfma_f32_16x16x32_bf16 v[92:95],v[112:115],a[200:203],v[92:95]
s_cselect_b32 s64,s65,s64
ds_read_b128 v[112:115],v0 offset:12544
v_max3_f32 v52,v52,v101,v102
s_waitcnt lgkmcnt(7)
v_mfma_f32_16x16x32_bf16 v[92:95],v[116:119],a[204:207],v[92:95]
s_cselect_b32 s40,0,s40
ds_read_b128 v[116:119],v1 offset:12544
v_max_f32 v52,v52,v103
s_waitcnt lgkmcnt(7)
v_mfma_f32_16x16x32_bf16 v[92:95],v[120:123],a[208:211],v[92:95]
s_add_u32 s65,s63,s3
ds_read_b128 v[120:123],v0 offset:18432
v_mov_b32 v53,v52
v_fma_f32 v74,v74,s36,v13
v_fma_f32 v75,v75,s36,v13
v_permlane32_swap_b32 v53,v52
s_waitcnt lgkmcnt(7)
v_mfma_f32_16x16x32_bf16 v[92:95],v[124:127],a[212:215],v[92:95]
s_cmp_eq_u32 s62,0
ds_read_b128 v[124:127],v1 offset:18432
v_max_f32 v52,v52,v53
v_mov_b32 v53,v52
v_fma_f32 v80,v80,s36,v14
v_fma_f32 v81,v81,s36,v14
v_permlane16_swap_b32 v53,v52
v_max_f32 v52,v52,v53
v_mul_f32_e64 v16,-s36,v52
v_fma_f32 v96,v96,s36,v16
v_fma_f32 v97,v97,s36,v16
v_fma_f32 v98,v98,s36,v16
v_fma_f32 v99,v99,s36,v16
v_exp_f32 v96,v96
v_exp_f32 v97,v97
v_exp_f32 v98,v98
v_exp_f32 v99,v99
v_cvt_pk_bf16_f32 v32,v96,v97
v_cvt_pk_bf16_f32 v33,v98,v99
s_waitcnt lgkmcnt(2)
v_mfma_f32_16x16x32_bf16 v[96:99],v[128:131],a[216:219],0
s_cselect_b32 s64,s65,s64
ds_read_b128 v[128:131],v0 offset:18560
v_fma_f32 v100,v100,s36,v16
v_mfma_f32_16x16x32_bf16 v[96:99],v[132:135],a[220:223],v[96:99]
s_cselect_b32 s40,1,s40
ds_read_b128 v[132:135],v1 offset:18560
v_fma_f32 v101,v101,s36,v16
v_mfma_f32_16x16x32_bf16 v[96:99],v[136:139],a[224:227],v[96:99]
s_mul_i32 s64,s64,6144
ds_read_b128 v[136:139],v0 offset:18688
v_fma_f32 v102,v102,s36,v16
v_mfma_f32_16x16x32_bf16 v[96:99],v[140:143],a[228:231],v[96:99]
s_add_u32 s41,s41,s64
ds_read_b128 v[140:143],v1 offset:18688
v_fma_f32 v103,v103,s36,v16
v_mfma_f32_16x16x32_bf16 v[96:99],v[112:115],a[232:235],v[96:99]
s_cmp_ge_u32 s69,6
ds_read_b64_tr_b16 v[112:113],v2 offset:0
ds_read_b64_tr_b16 v[114:115],v2 offset:6144
v_mfma_f32_16x16x32_bf16 v[96:99],v[116:119],a[236:239],v[96:99]
s_cselect_b32 s41,166723584,s41
ds_read_b64_tr_b16 v[116:117],v3 offset:0
ds_read_b64_tr_b16 v[118:119],v3 offset:6144
v_exp_f32 v100,v100
v_exp_f32 v101,v101
v_exp_f32 v102,v102
v_exp_f32 v103,v103
v_cvt_pk_bf16_f32 v34,v100,v101
v_cvt_pk_bf16_f32 v35,v102,v103
s_waitcnt lgkmcnt(8)
v_mfma_f32_16x16x32_bf16 v[100:103],v[120:123],a[216:219],0
s_cselect_b32 s30,100663296,s30
ds_read_b64_tr_b16 v[120:121],v4 offset:0
ds_read_b64_tr_b16 v[122:123],v4 offset:6144
v_smfmac_f32_16x16x64_bf16 v[64:67],v[152:155],v[28:35],v18
s_add_u32 s25,s30,s22
s_add_u32 s26,s25,12288
v_exp_f32 v72,v72
v_mfma_f32_16x16x32_bf16 v[100:103],v[124:127],a[220:223],v[100:103]
s_mov_b32 s28,s41
ds_read_b64_tr_b16 v[124:125],v5 offset:0
ds_read_b64_tr_b16 v[126:127],v5 offset:6144
s_waitcnt lgkmcnt(9)
v_mfma_f32_16x16x32_bf16 v[100:103],v[128:131],a[224:227],v[100:103]
s_mov_b32 s29,s24
v_exp_f32 v73,v73
v_mfma_f32_16x16x32_bf16 v[100:103],v[132:135],a[228:231],v[100:103]
s_add_u32 m0,s22,0
v_exp_f32 v74,v74
v_mfma_f32_16x16x32_bf16 v[100:103],v[136:139],a[232:235],v[100:103]
buffer_load_dwordx4 v6,s[4:7],s20 offen offset:0 lds
s_waitcnt lgkmcnt(4)
v_mfma_f32_16x16x32_bf16 v[100:103],v[140:143],a[236:239],v[100:103]
buffer_load_dwordx4 v7,s[4:7],s20 offen offset:1024 lds
buffer_load_dwordx4 v8,s[4:7],s20 offen offset:2048 lds
v_exp_f32 v75,v75
v_exp_f32 v80,v80
v_exp_f32 v81,v81
v_cvt_pk_bf16_f32 v40,v72,v73
v_cvt_pk_bf16_f32 v41,v74,v75
v_cvt_pk_bf16_f32 v44,v80,v81
s_add_u32 s20,s20,12288
v_mfma_f32_16x16x32_bf16 v[160:163],v[112:115],v[20:23],0
s_add_u32 m0,s23,0
ds_read_b64_tr_b16 v[128:129],v2 offset:128
ds_read_b64_tr_b16 v[130:131],v2 offset:6272
v_mfma_f32_16x16x32_bf16 v[208:211],v[112:115],v[24:27],0
ds_read_b64_tr_b16 v[132:133],v3 offset:128
ds_read_b64_tr_b16 v[134:135],v3 offset:6272
v_mfma_f32_16x16x32_bf16 a[0:3],v[112:115],v[28:31],0
ds_read_b64_tr_b16 v[136:137],v4 offset:128
ds_read_b64_tr_b16 v[138:139],v4 offset:6272
v_mfma_f32_16x16x32_bf16 a[48:51],v[112:115],v[32:35],0
ds_read_b64_tr_b16 v[140:141],v5 offset:128
ds_read_b64_tr_b16 v[142:143],v5 offset:6272
v_mfma_f32_16x16x32_bf16 v[164:167],v[116:119],v[20:23],0
ds_read_b64_tr_b16 v[112:113],v2 offset:256
ds_read_b64_tr_b16 v[114:115],v2 offset:6400
v_mfma_f32_16x16x32_bf16 v[212:215],v[116:119],v[24:27],0
v_fma_f32 v82,v82,s36,v14
v_fma_f32 v83,v83,s36,v14
v_mfma_f32_16x16x32_bf16 a[4:7],v[116:119],v[28:31],0
v_exp_f32 v82,v82
v_mfma_f32_16x16x32_bf16 a[52:55],v[116:119],v[32:35],0
s_waitcnt lgkmcnt(10)
ds_read_b64_tr_b16 v[116:117],v3 offset:256
ds_read_b64_tr_b16 v[118:119],v3 offset:6400
v_mfma_f32_16x16x32_bf16 v[168:171],v[120:123],v[20:23],0
v_exp_f32 v83,v83
v_mfma_f32_16x16x32_bf16 v[216:219],v[120:123],v[24:27],0
v_cvt_pk_bf16_f32 v45,v82,v83
v_fma_f32 v88,v88,s36,v15
v_mfma_f32_16x16x32_bf16 a[8:11],v[120:123],v[28:31],0
v_fma_f32 v89,v89,s36,v15
v_fma_f32 v90,v90,s36,v15
v_mfma_f32_16x16x32_bf16 a[56:59],v[120:123],v[32:35],0
ds_read_b64_tr_b16 v[120:121],v4 offset:256
ds_read_b64_tr_b16 v[122:123],v4 offset:6400
v_mfma_f32_16x16x32_bf16 v[172:175],v[124:127],v[20:23],0
v_fma_f32 v91,v91,s36,v15
v_fma_f32 v96,v96,s36,v16
v_mfma_f32_16x16x32_bf16 v[220:223],v[124:127],v[24:27],0
v_exp_f32 v88,v88
v_mfma_f32_16x16x32_bf16 a[12:15],v[124:127],v[28:31],0
v_exp_f32 v89,v89
v_mfma_f32_16x16x32_bf16 a[60:63],v[124:127],v[32:35],0
s_waitcnt lgkmcnt(3)
ds_read_b64_tr_b16 v[124:125],v5 offset:256
ds_read_b64_tr_b16 v[126:127],v5 offset:6400
v_mfma_f32_16x16x32_bf16 v[176:179],v[128:131],v[20:23],0
v_exp_f32 v90,v90
v_mfma_f32_16x16x32_bf16 v[224:227],v[128:131],v[24:27],0
v_exp_f32 v91,v91
v_mfma_f32_16x16x32_bf16 a[16:19],v[128:131],v[28:31],0
v_cvt_pk_bf16_f32 v48,v88,v89
v_cvt_pk_bf16_f32 v49,v90,v91
v_mfma_f32_16x16x32_bf16 a[64:67],v[128:131],v[32:35],0
v_fma_f32 v97,v97,s36,v16
v_fma_f32 v98,v98,s36,v16
v_mfma_f32_16x16x32_bf16 v[180:183],v[132:135],v[20:23],0
v_fma_f32 v99,v99,s36,v16
v_fma_f32 v76,v76,s36,v13
v_mfma_f32_16x16x32_bf16 v[228:231],v[132:135],v[24:27],0
v_exp_f32 v96,v96
v_mfma_f32_16x16x32_bf16 a[20:23],v[132:135],v[28:31],0
v_exp_f32 v97,v97
v_mfma_f32_16x16x32_bf16 a[68:71],v[132:135],v[32:35],0
v_exp_f32 v98,v98
v_mfma_f32_16x16x32_bf16 v[184:187],v[136:139],v[20:23],0
v_exp_f32 v99,v99
v_mfma_f32_16x16x32_bf16 v[232:235],v[136:139],v[24:27],0
v_cvt_pk_bf16_f32 v52,v96,v97
v_cvt_pk_bf16_f32 v53,v98,v99
v_mfma_f32_16x16x32_bf16 a[24:27],v[136:139],v[28:31],0
v_fma_f32 v77,v77,s36,v13
v_fma_f32 v78,v78,s36,v13
v_mfma_f32_16x16x32_bf16 a[72:75],v[136:139],v[32:35],0
v_fma_f32 v79,v79,s36,v13
v_fma_f32 v84,v84,s36,v14
v_mfma_f32_16x16x32_bf16 v[188:191],v[140:143],v[20:23],0
v_exp_f32 v76,v76
v_mfma_f32_16x16x32_bf16 v[236:239],v[140:143],v[24:27],0
v_exp_f32 v77,v77
v_mfma_f32_16x16x32_bf16 a[28:31],v[140:143],v[28:31],0
v_exp_f32 v78,v78
v_mfma_f32_16x16x32_bf16 a[76:79],v[140:143],v[32:35],0
v_exp_f32 v79,v79
v_mfma_f32_16x16x32_bf16 v[192:195],v[112:115],v[20:23],0
v_cvt_pk_bf16_f32 v42,v76,v77
v_cvt_pk_bf16_f32 v43,v78,v79
s_waitcnt vmcnt(6) lgkmcnt(0)
v_mfma_f32_16x16x32_bf16 v[240:243],v[112:115],v[24:27],0
s_barrier
v_mfma_f32_16x16x32_bf16 a[32:35],v[112:115],v[28:31],0
ds_read_b128 v[128:131],v0 offset:24576
v_fma_f32 v85,v85,s36,v14
v_mfma_f32_16x16x32_bf16 a[80:83],v[112:115],v[32:35],0
ds_read_b128 v[132:135],v1 offset:24576
v_fma_f32 v86,v86,s36,v14
v_mfma_f32_16x16x32_bf16 v[196:199],v[116:119],v[20:23],0
ds_read_b128 v[136:139],v0 offset:24704
v_fma_f32 v87,v87,s36,v14
v_mfma_f32_16x16x32_bf16 v[244:247],v[116:119],v[24:27],0
ds_read_b128 v[140:143],v1 offset:24704
v_fma_f32 v92,v92,s36,v15
v_mfma_f32_16x16x32_bf16 a[36:39],v[116:119],v[28:31],0
ds_read_b128 v[112:115],v0 offset:24832
v_fma_f32 v93,v93,s36,v15
v_mfma_f32_16x16x32_bf16 a[84:87],v[116:119],v[32:35],0
buffer_load_dwordx4 v6,s[8:11],s21 offen offset:0 lds
v_mfma_f32_16x16x32_bf16 v[200:203],v[120:123],v[20:23],0
ds_read_b128 v[116:119],v1 offset:24832
v_fma_f32 v94,v94,s36,v15
v_mfma_f32_16x16x32_bf16 v[248:251],v[120:123],v[24:27],0
v_exp_f32 v84,v84
v_mfma_f32_16x16x32_bf16 a[40:43],v[120:123],v[28:31],0
v_exp_f32 v85,v85
v_mfma_f32_16x16x32_bf16 a[88:91],v[120:123],v[32:35],0
ds_read_b128 v[120:123],v0 offset:30720
v_cvt_pk_bf16_f32 v46,v84,v85
v_mfma_f32_16x16x32_bf16 v[204:207],v[124:127],v[20:23],0
v_exp_f32 v86,v86
v_mfma_f32_16x16x32_bf16 v[252:255],v[124:127],v[24:27],0
v_exp_f32 v87,v87
v_mfma_f32_16x16x32_bf16 a[44:47],v[124:127],v[28:31],0
v_cvt_pk_bf16_f32 v47,v86,v87
v_fma_f32 v95,v95,s36,v15
v_mfma_f32_16x16x32_bf16 a[92:95],v[124:127],v[32:35],0
ds_read_b128 v[124:127],v1 offset:30720
v_fma_f32 v100,v100,s36,v16
v_smfmac_f32_16x16x64_bf16 v[60:63],v[152:155],v[40:47],v18
buffer_load_dwordx4 v7,s[8:11],s21 offen offset:1024 lds
s_waitcnt lgkmcnt(2)
v_mfma_f32_16x16x32_bf16 v[72:75],v[128:131],a[144:147],0
v_exp_f32 v92,v92
v_mfma_f32_16x16x32_bf16 v[80:83],v[128:131],a[168:171],0
v_exp_f32 v93,v93
v_mfma_f32_16x16x32_bf16 v[88:91],v[128:131],a[192:195],0
v_exp_f32 v94,v94
v_mfma_f32_16x16x32_bf16 v[96:99],v[128:131],a[216:219],0
ds_read_b128 v[128:131],v0 offset:30848
v_cvt_pk_bf16_f32 v50,v92,v93
v_mfma_f32_16x16x32_bf16 v[72:75],v[132:135],a[148:151],v[72:75]
v_exp_f32 v95,v95
v_mfma_f32_16x16x32_bf16 v[80:83],v[132:135],a[172:175],v[80:83]
v_cvt_pk_bf16_f32 v51,v94,v95
v_fma_f32 v101,v101,s36,v16
v_mfma_f32_16x16x32_bf16 v[88:91],v[132:135],a[196:199],v[88:91]
v_fma_f32 v102,v102,s36,v16
v_fma_f32 v103,v103,s36,v16
v_mfma_f32_16x16x32_bf16 v[96:99],v[132:135],a[220:223],v[96:99]
v_exp_f32 v100,v100
v_mfma_f32_16x16x32_bf16 v[72:75],v[136:139],a[152:155],v[72:75]
buffer_load_dwordx4 v8,s[8:11],s21 offen offset:2048 lds
v_mfma_f32_16x16x32_bf16 v[80:83],v[136:139],a[176:179],v[80:83]
s_add_u32 s21,s21,12288
v_exp_f32 v101,v101
v_mfma_f32_16x16x32_bf16 v[88:91],v[136:139],a[200:203],v[88:91]
s_add_u32 m0,s22,12288
v_exp_f32 v102,v102
v_mfma_f32_16x16x32_bf16 v[96:99],v[136:139],a[224:227],v[96:99]
v_exp_f32 v103,v103
v_mfma_f32_16x16x32_bf16 v[72:75],v[140:143],a[156:159],v[72:75]
v_cvt_pk_bf16_f32 v54,v100,v101
v_cvt_pk_bf16_f32 v55,v102,v103
v_mfma_f32_16x16x32_bf16 v[80:83],v[140:143],a[180:183],v[80:83]
ds_read_b128 v[132:135],v1 offset:30848
v_smfmac_f32_16x16x64_bf16 v[64:67],v[152:155],v[48:55],v18
ds_read_b128 v[136:139],v0 offset:30976
v_mfma_f32_16x16x32_bf16 v[88:91],v[140:143],a[204:207],v[88:91]
v_mfma_f32_16x16x32_bf16 v[96:99],v[140:143],a[228:231],v[96:99]
ds_read_b128 v[140:143],v1 offset:30976
v_mfma_f32_16x16x32_bf16 v[72:75],v[112:115],a[160:163],v[72:75]
buffer_load_dwordx4 v6,s[4:7],s20 offen offset:0 lds
v_mfma_f32_16x16x32_bf16 v[80:83],v[112:115],a[184:187],v[80:83]
v_mfma_f32_16x16x32_bf16 v[88:91],v[112:115],a[208:211],v[88:91]
v_mfma_f32_16x16x32_bf16 v[96:99],v[112:115],a[232:235],v[96:99]
v_mfma_f32_16x16x32_bf16 v[72:75],v[116:119],a[164:167],v[72:75]
v_mfma_f32_16x16x32_bf16 v[80:83],v[116:119],a[188:191],v[80:83]
v_mfma_f32_16x16x32_bf16 v[88:91],v[116:119],a[212:215],v[88:91]
v_mfma_f32_16x16x32_bf16 v[96:99],v[116:119],a[236:239],v[96:99]
s_waitcnt lgkmcnt(0)
v_mfma_f32_16x16x32_bf16 v[76:79],v[120:123],a[144:147],0
buffer_load_dwordx4 v7,s[4:7],s20 offen offset:1024 lds
v_mfma_f32_16x16x32_bf16 v[84:87],v[120:123],a[168:171],0
v_mfma_f32_16x16x32_bf16 v[92:95],v[120:123],a[192:195],0
v_mfma_f32_16x16x32_bf16 v[100:103],v[120:123],a[216:219],0
v_fma_f32 v72,v72,s36,v13
v_fma_f32 v73,v73,s36,v13
v_mfma_f32_16x16x32_bf16 v[76:79],v[124:127],a[148:151],v[76:79]
v_fma_f32 v74,v74,s36,v13
v_fma_f32 v75,v75,s36,v13
v_mfma_f32_16x16x32_bf16 v[84:87],v[124:127],a[172:175],v[84:87]
v_fma_f32 v80,v80,s36,v14
v_fma_f32 v81,v81,s36,v14
v_mfma_f32_16x16x32_bf16 v[92:95],v[124:127],a[196:199],v[92:95]
v_exp_f32 v72,v72
v_mfma_f32_16x16x32_bf16 v[100:103],v[124:127],a[220:223],v[100:103]
v_exp_f32 v73,v73
v_mfma_f32_16x16x32_bf16 v[76:79],v[128:131],a[152:155],v[76:79]
v_exp_f32 v74,v74
v_mfma_f32_16x16x32_bf16 v[84:87],v[128:131],a[176:179],v[84:87]
buffer_load_dwordx4 v8,s[4:7],s20 offen offset:2048 lds
v_mfma_f32_16x16x32_bf16 v[92:95],v[128:131],a[200:203],v[92:95]
s_add_u32 s20,s20,12288
v_exp_f32 v75,v75
v_mfma_f32_16x16x32_bf16 v[100:103],v[128:131],a[224:227],v[100:103]
ds_read_b64_tr_b16 v[112:113],v2 offset:12288
ds_read_b64_tr_b16 v[114:115],v2 offset:18432
v_mfma_f32_16x16x32_bf16 v[76:79],v[132:135],a[156:159],v[76:79]
v_exp_f32 v80,v80
v_mfma_f32_16x16x32_bf16 v[84:87],v[132:135],a[180:183],v[84:87]
ds_read_b64_tr_b16 v[116:117],v3 offset:12288
ds_read_b64_tr_b16 v[118:119],v3 offset:18432
v_mfma_f32_16x16x32_bf16 v[92:95],v[132:135],a[204:207],v[92:95]
v_exp_f32 v81,v81
v_mfma_f32_16x16x32_bf16 v[100:103],v[132:135],a[228:231],v[100:103]
ds_read_b64_tr_b16 v[120:121],v4 offset:12288
ds_read_b64_tr_b16 v[122:123],v4 offset:18432
v_mfma_f32_16x16x32_bf16 v[76:79],v[136:139],a[160:163],v[76:79]
v_cvt_pk_bf16_f32 v20,v72,v73
v_cvt_pk_bf16_f32 v21,v74,v75
v_mfma_f32_16x16x32_bf16 v[84:87],v[136:139],a[184:187],v[84:87]
ds_read_b64_tr_b16 v[124:125],v5 offset:12288
ds_read_b64_tr_b16 v[126:127],v5 offset:18432
v_mfma_f32_16x16x32_bf16 v[92:95],v[136:139],a[208:211],v[92:95]
v_cvt_pk_bf16_f32 v24,v80,v81
v_mfma_f32_16x16x32_bf16 v[100:103],v[136:139],a[232:235],v[100:103]
v_mfma_f32_16x16x32_bf16 v[76:79],v[140:143],a[164:167],v[76:79]
v_mfma_f32_16x16x32_bf16 v[84:87],v[140:143],a[188:191],v[84:87]
v_mfma_f32_16x16x32_bf16 v[92:95],v[140:143],a[212:215],v[92:95]
v_mfma_f32_16x16x32_bf16 v[100:103],v[140:143],a[236:239],v[100:103]
s_waitcnt lgkmcnt(4)
v_mfma_f32_16x16x32_bf16 v[160:163],v[112:115],v[40:43],v[160:163]
s_add_u32 m0,s23,12288
ds_read_b64_tr_b16 v[128:129],v2 offset:12416
ds_read_b64_tr_b16 v[130:131],v2 offset:18560
v_mfma_f32_16x16x32_bf16 v[208:211],v[112:115],v[44:47],v[208:211]
ds_read_b64_tr_b16 v[132:133],v3 offset:12416
ds_read_b64_tr_b16 v[134:135],v3 offset:18560
v_mfma_f32_16x16x32_bf16 a[0:3],v[112:115],v[48:51],a[0:3]
ds_read_b64_tr_b16 v[136:137],v4 offset:12416
ds_read_b64_tr_b16 v[138:139],v4 offset:18560
v_mfma_f32_16x16x32_bf16 a[48:51],v[112:115],v[52:55],a[48:51]
ds_read_b64_tr_b16 v[140:141],v5 offset:12416
ds_read_b64_tr_b16 v[142:143],v5 offset:18560
v_mfma_f32_16x16x32_bf16 v[164:167],v[116:119],v[40:43],v[164:167]
ds_read_b64_tr_b16 v[112:113],v2 offset:12544
ds_read_b64_tr_b16 v[114:115],v2 offset:18688
v_mfma_f32_16x16x32_bf16 v[212:215],v[116:119],v[44:47],v[212:215]
v_fma_f32 v82,v82,s36,v14
v_fma_f32 v83,v83,s36,v14
v_mfma_f32_16x16x32_bf16 a[4:7],v[116:119],v[48:51],a[4:7]
v_exp_f32 v82,v82
v_mfma_f32_16x16x32_bf16 a[52:55],v[116:119],v[52:55],a[52:55]
s_waitcnt lgkmcnt(10)
ds_read_b64_tr_b16 v[116:117],v3 offset:12544
ds_read_b64_tr_b16 v[118:119],v3 offset:18688
v_mfma_f32_16x16x32_bf16 v[168:171],v[120:123],v[40:43],v[168:171]
v_exp_f32 v83,v83
v_mfma_f32_16x16x32_bf16 v[216:219],v[120:123],v[44:47],v[216:219]
v_cvt_pk_bf16_f32 v25,v82,v83
v_fma_f32 v88,v88,s36,v15
v_mfma_f32_16x16x32_bf16 a[8:11],v[120:123],v[48:51],a[8:11]
v_fma_f32 v89,v89,s36,v15
v_fma_f32 v90,v90,s36,v15
v_mfma_f32_16x16x32_bf16 a[56:59],v[120:123],v[52:55],a[56:59]
ds_read_b64_tr_b16 v[120:121],v4 offset:12544
ds_read_b64_tr_b16 v[122:123],v4 offset:18688
v_mfma_f32_16x16x32_bf16 v[172:175],v[124:127],v[40:43],v[172:175]
v_fma_f32 v91,v91,s36,v15
v_fma_f32 v96,v96,s36,v16
v_mfma_f32_16x16x32_bf16 v[220:223],v[124:127],v[44:47],v[220:223]
v_exp_f32 v88,v88
v_mfma_f32_16x16x32_bf16 a[12:15],v[124:127],v[48:51],a[12:15]
v_exp_f32 v89,v89
v_mfma_f32_16x16x32_bf16 a[60:63],v[124:127],v[52:55],a[60:63]
s_waitcnt lgkmcnt(3)
ds_read_b64_tr_b16 v[124:125],v5 offset:12544
ds_read_b64_tr_b16 v[126:127],v5 offset:18688
v_mfma_f32_16x16x32_bf16 v[176:179],v[128:131],v[40:43],v[176:179]
v_exp_f32 v90,v90
v_mfma_f32_16x16x32_bf16 v[224:227],v[128:131],v[44:47],v[224:227]
v_exp_f32 v91,v91
v_mfma_f32_16x16x32_bf16 a[16:19],v[128:131],v[48:51],a[16:19]
v_cvt_pk_bf16_f32 v28,v88,v89
v_cvt_pk_bf16_f32 v29,v90,v91
v_mfma_f32_16x16x32_bf16 a[64:67],v[128:131],v[52:55],a[64:67]
v_fma_f32 v97,v97,s36,v16
v_fma_f32 v98,v98,s36,v16
v_mfma_f32_16x16x32_bf16 v[180:183],v[132:135],v[40:43],v[180:183]
v_fma_f32 v99,v99,s36,v16
v_fma_f32 v76,v76,s36,v13
v_mfma_f32_16x16x32_bf16 v[228:231],v[132:135],v[44:47],v[228:231]
v_exp_f32 v96,v96
v_mfma_f32_16x16x32_bf16 a[20:23],v[132:135],v[48:51],a[20:23]
v_exp_f32 v97,v97
v_mfma_f32_16x16x32_bf16 a[68:71],v[132:135],v[52:55],a[68:71]
v_exp_f32 v98,v98
v_mfma_f32_16x16x32_bf16 v[184:187],v[136:139],v[40:43],v[184:187]
v_exp_f32 v99,v99
v_mfma_f32_16x16x32_bf16 v[232:235],v[136:139],v[44:47],v[232:235]
v_cvt_pk_bf16_f32 v32,v96,v97
v_cvt_pk_bf16_f32 v33,v98,v99
v_mfma_f32_16x16x32_bf16 a[24:27],v[136:139],v[48:51],a[24:27]
v_fma_f32 v77,v77,s36,v13
v_fma_f32 v78,v78,s36,v13
v_mfma_f32_16x16x32_bf16 a[72:75],v[136:139],v[52:55],a[72:75]
v_fma_f32 v79,v79,s36,v13
v_fma_f32 v84,v84,s36,v14
v_mfma_f32_16x16x32_bf16 v[188:191],v[140:143],v[40:43],v[188:191]
v_exp_f32 v76,v76
v_mfma_f32_16x16x32_bf16 v[236:239],v[140:143],v[44:47],v[236:239]
v_exp_f32 v77,v77
v_mfma_f32_16x16x32_bf16 a[28:31],v[140:143],v[48:51],a[28:31]
v_exp_f32 v78,v78
v_mfma_f32_16x16x32_bf16 a[76:79],v[140:143],v[52:55],a[76:79]
v_exp_f32 v79,v79
v_mfma_f32_16x16x32_bf16 v[192:195],v[112:115],v[40:43],v[192:195]
v_cvt_pk_bf16_f32 v22,v76,v77
v_cvt_pk_bf16_f32 v23,v78,v79
s_waitcnt vmcnt(6) lgkmcnt(0)
v_mfma_f32_16x16x32_bf16 v[240:243],v[112:115],v[44:47],v[240:243]
s_barrier
v_mfma_f32_16x16x32_bf16 a[32:35],v[112:115],v[48:51],a[32:35]
ds_read_b128 v[128:131],v0 offset:0
v_fma_f32 v85,v85,s36,v14
v_mfma_f32_16x16x32_bf16 a[80:83],v[112:115],v[52:55],a[80:83]
ds_read_b128 v[132:135],v1 offset:0
v_fma_f32 v86,v86,s36,v14
v_mfma_f32_16x16x32_bf16 v[196:199],v[116:119],v[40:43],v[196:199]
ds_read_b128 v[136:139],v0 offset:128
v_fma_f32 v87,v87,s36,v14
v_mfma_f32_16x16x32_bf16 v[244:247],v[116:119],v[44:47],v[244:247]
ds_read_b128 v[140:143],v1 offset:128
v_fma_f32 v92,v92,s36,v15
v_mfma_f32_16x16x32_bf16 a[36:39],v[116:119],v[48:51],a[36:39]
ds_read_b128 v[112:115],v0 offset:256
v_fma_f32 v93,v93,s36,v15
v_mfma_f32_16x16x32_bf16 a[84:87],v[116:119],v[52:55],a[84:87]
buffer_load_dwordx4 v6,s[8:11],s21 offen offset:0 lds
v_mfma_f32_16x16x32_bf16 v[200:203],v[120:123],v[40:43],v[200:203]
ds_read_b128 v[116:119],v1 offset:256
v_fma_f32 v94,v94,s36,v15
v_mfma_f32_16x16x32_bf16 v[248:251],v[120:123],v[44:47],v[248:251]
v_exp_f32 v84,v84
v_mfma_f32_16x16x32_bf16 a[40:43],v[120:123],v[48:51],a[40:43]
v_exp_f32 v85,v85
v_mfma_f32_16x16x32_bf16 a[88:91],v[120:123],v[52:55],a[88:91]
ds_read_b128 v[120:123],v0 offset:6144
v_cvt_pk_bf16_f32 v26,v84,v85
v_mfma_f32_16x16x32_bf16 v[204:207],v[124:127],v[40:43],v[204:207]
v_exp_f32 v86,v86
v_mfma_f32_16x16x32_bf16 v[252:255],v[124:127],v[44:47],v[252:255]
v_exp_f32 v87,v87
v_mfma_f32_16x16x32_bf16 a[44:47],v[124:127],v[48:51],a[44:47]
v_cvt_pk_bf16_f32 v27,v86,v87
v_fma_f32 v95,v95,s36,v15
v_mfma_f32_16x16x32_bf16 a[92:95],v[124:127],v[52:55],a[92:95]
ds_read_b128 v[124:127],v1 offset:6144
v_fma_f32 v100,v100,s36,v16
v_smfmac_f32_16x16x64_bf16 v[60:63],v[152:155],v[20:27],v18
buffer_load_dwordx4 v7,s[8:11],s21 offen offset:1024 lds
s_waitcnt lgkmcnt(2)
v_mfma_f32_16x16x32_bf16 v[72:75],v[128:131],a[144:147],0
v_exp_f32 v92,v92
v_mfma_f32_16x16x32_bf16 v[80:83],v[128:131],a[168:171],0
v_exp_f32 v93,v93
v_mfma_f32_16x16x32_bf16 v[88:91],v[128:131],a[192:195],0
v_exp_f32 v94,v94
v_mfma_f32_16x16x32_bf16 v[96:99],v[128:131],a[216:219],0
ds_read_b128 v[128:131],v0 offset:6272
v_cvt_pk_bf16_f32 v30,v92,v93
v_mfma_f32_16x16x32_bf16 v[72:75],v[132:135],a[148:151],v[72:75]
v_exp_f32 v95,v95
v_mfma_f32_16x16x32_bf16 v[80:83],v[132:135],a[172:175],v[80:83]
v_cvt_pk_bf16_f32 v31,v94,v95
v_fma_f32 v101,v101,s36,v16
v_mfma_f32_16x16x32_bf16 v[88:91],v[132:135],a[196:199],v[88:91]
v_fma_f32 v102,v102,s36,v16
v_fma_f32 v103,v103,s36,v16
v_mfma_f32_16x16x32_bf16 v[96:99],v[132:135],a[220:223],v[96:99]
v_exp_f32 v100,v100
v_mfma_f32_16x16x32_bf16 v[72:75],v[136:139],a[152:155],v[72:75]
buffer_load_dwordx4 v8,s[8:11],s21 offen offset:2048 lds
v_mfma_f32_16x16x32_bf16 v[80:83],v[136:139],a[176:179],v[80:83]
s_add_u32 s21,s21,12288
v_exp_f32 v101,v101
v_mfma_f32_16x16x32_bf16 v[88:91],v[136:139],a[200:203],v[88:91]
s_add_u32 m0,s22,24576
v_exp_f32 v102,v102
v_mfma_f32_16x16x32_bf16 v[96:99],v[136:139],a[224:227],v[96:99]
v_exp_f32 v103,v103
v_mfma_f32_16x16x32_bf16 v[72:75],v[140:143],a[156:159],v[72:75]
v_cvt_pk_bf16_f32 v34,v100,v101
v_cvt_pk_bf16_f32 v35,v102,v103
v_mfma_f32_16x16x32_bf16 v[80:83],v[140:143],a[180:183],v[80:83]
ds_read_b128 v[132:135],v1 offset:6272
v_smfmac_f32_16x16x64_bf16 v[64:67],v[152:155],v[28:35],v18
ds_read_b128 v[136:139],v0 offset:6400
v_mfma_f32_16x16x32_bf16 v[88:91],v[140:143],a[204:207],v[88:91]
v_mfma_f32_16x16x32_bf16 v[96:99],v[140:143],a[228:231],v[96:99]
ds_read_b128 v[140:143],v1 offset:6400
v_mfma_f32_16x16x32_bf16 v[72:75],v[112:115],a[160:163],v[72:75]
buffer_load_dwordx4 v6,s[4:7],s20 offen offset:0 lds
v_mfma_f32_16x16x32_bf16 v[80:83],v[112:115],a[184:187],v[80:83]
v_mfma_f32_16x16x32_bf16 v[88:91],v[112:115],a[208:211],v[88:91]
v_mfma_f32_16x16x32_bf16 v[96:99],v[112:115],a[232:235],v[96:99]
v_mfma_f32_16x16x32_bf16 v[72:75],v[116:119],a[164:167],v[72:75]
v_mfma_f32_16x16x32_bf16 v[80:83],v[116:119],a[188:191],v[80:83]
v_mfma_f32_16x16x32_bf16 v[88:91],v[116:119],a[212:215],v[88:91]
v_mfma_f32_16x16x32_bf16 v[96:99],v[116:119],a[236:239],v[96:99]
s_waitcnt lgkmcnt(0)
v_mfma_f32_16x16x32_bf16 v[76:79],v[120:123],a[144:147],0
buffer_load_dwordx4 v7,s[4:7],s20 offen offset:1024 lds
v_mfma_f32_16x16x32_bf16 v[84:87],v[120:123],a[168:171],0
v_mfma_f32_16x16x32_bf16 v[92:95],v[120:123],a[192:195],0
v_mfma_f32_16x16x32_bf16 v[100:103],v[120:123],a[216:219],0
v_fma_f32 v72,v72,s36,v13
v_fma_f32 v73,v73,s36,v13
v_mfma_f32_16x16x32_bf16 v[76:79],v[124:127],a[148:151],v[76:79]
v_fma_f32 v74,v74,s36,v13
v_fma_f32 v75,v75,s36,v13
v_mfma_f32_16x16x32_bf16 v[84:87],v[124:127],a[172:175],v[84:87]
v_fma_f32 v80,v80,s36,v14
v_fma_f32 v81,v81,s36,v14
v_mfma_f32_16x16x32_bf16 v[92:95],v[124:127],a[196:199],v[92:95]
v_exp_f32 v72,v72
v_mfma_f32_16x16x32_bf16 v[100:103],v[124:127],a[220:223],v[100:103]
v_exp_f32 v73,v73
v_mfma_f32_16x16x32_bf16 v[76:79],v[128:131],a[152:155],v[76:79]
v_exp_f32 v74,v74
v_mfma_f32_16x16x32_bf16 v[84:87],v[128:131],a[176:179],v[84:87]
buffer_load_dwordx4 v8,s[4:7],s20 offen offset:2048 lds
v_mfma_f32_16x16x32_bf16 v[92:95],v[128:131],a[200:203],v[92:95]
s_add_u32 s20,s20,12288
v_exp_f32 v75,v75
v_mfma_f32_16x16x32_bf16 v[100:103],v[128:131],a[224:227],v[100:103]
ds_read_b64_tr_b16 v[112:113],v2 offset:24576
ds_read_b64_tr_b16 v[114:115],v2 offset:30720
v_mfma_f32_16x16x32_bf16 v[76:79],v[132:135],a[156:159],v[76:79]
v_exp_f32 v80,v80
v_mfma_f32_16x16x32_bf16 v[84:87],v[132:135],a[180:183],v[84:87]
ds_read_b64_tr_b16 v[116:117],v3 offset:24576
ds_read_b64_tr_b16 v[118:119],v3 offset:30720
v_mfma_f32_16x16x32_bf16 v[92:95],v[132:135],a[204:207],v[92:95]
v_exp_f32 v81,v81
v_mfma_f32_16x16x32_bf16 v[100:103],v[132:135],a[228:231],v[100:103]
ds_read_b64_tr_b16 v[120:121],v4 offset:24576
ds_read_b64_tr_b16 v[122:123],v4 offset:30720
v_mfma_f32_16x16x32_bf16 v[76:79],v[136:139],a[160:163],v[76:79]
v_cvt_pk_bf16_f32 v40,v72,v73
v_cvt_pk_bf16_f32 v41,v74,v75
v_mfma_f32_16x16x32_bf16 v[84:87],v[136:139],a[184:187],v[84:87]
ds_read_b64_tr_b16 v[124:125],v5 offset:24576
ds_read_b64_tr_b16 v[126:127],v5 offset:30720
v_mfma_f32_16x16x32_bf16 v[92:95],v[136:139],a[208:211],v[92:95]
v_cvt_pk_bf16_f32 v44,v80,v81
v_mfma_f32_16x16x32_bf16 v[100:103],v[136:139],a[232:235],v[100:103]
v_mfma_f32_16x16x32_bf16 v[76:79],v[140:143],a[164:167],v[76:79]
v_mfma_f32_16x16x32_bf16 v[84:87],v[140:143],a[188:191],v[84:87]
v_mfma_f32_16x16x32_bf16 v[92:95],v[140:143],a[212:215],v[92:95]
v_mfma_f32_16x16x32_bf16 v[100:103],v[140:143],a[236:239],v[100:103]
s_mov_b32 s38,0
s_branch L_loop4
L_loop5:
.p2align 6
L_loop5w0:
s_waitcnt lgkmcnt(4)
v_mfma_f32_16x16x32_bf16 v[160:163],v[112:115],v[20:23],v[160:163]
s_add_u32 m0,s23,24576
ds_read_b64_tr_b16 v[128:129],v2 offset:24704
ds_read_b64_tr_b16 v[130:131],v2 offset:30848
v_mfma_f32_16x16x32_bf16 v[208:211],v[112:115],v[24:27],v[208:211]
ds_read_b64_tr_b16 v[132:133],v3 offset:24704
ds_read_b64_tr_b16 v[134:135],v3 offset:30848
v_mfma_f32_16x16x32_bf16 a[0:3],v[112:115],v[28:31],a[0:3]
ds_read_b64_tr_b16 v[136:137],v4 offset:24704
ds_read_b64_tr_b16 v[138:139],v4 offset:30848
v_mfma_f32_16x16x32_bf16 a[48:51],v[112:115],v[32:35],a[48:51]
ds_read_b64_tr_b16 v[140:141],v5 offset:24704
ds_read_b64_tr_b16 v[142:143],v5 offset:30848
v_mfma_f32_16x16x32_bf16 a[96:99],v[112:115],v[36:39],a[96:99]
ds_read_b64_tr_b16 v[112:113],v2 offset:24832
ds_read_b64_tr_b16 v[114:115],v2 offset:30976
v_mfma_f32_16x16x32_bf16 v[164:167],v[116:119],v[20:23],v[164:167]
v_fma_f32 v90,v90,s36,v15
v_fma_f32 v91,v91,s36,v15
v_mfma_f32_16x16x32_bf16 v[212:215],v[116:119],v[24:27],v[212:215]
v_exp_f32 v90,v90
v_mfma_f32_16x16x32_bf16 a[4:7],v[116:119],v[28:31],a[4:7]
v_exp_f32 v91,v91
v_mfma_f32_16x16x32_bf16 a[52:55],v[116:119],v[32:35],a[52:55]
v_cvt_pk_bf16_f32 v49,v90,v91
v_fma_f32 v96,v96,s36,v16
v_mfma_f32_16x16x32_bf16 a[100:103],v[116:119],v[36:39],a[100:103]
s_waitcnt lgkmcnt(8)
ds_read_b64_tr_b16 v[116:117],v3 offset:24832
ds_read_b64_tr_b16 v[118:119],v3 offset:30976
v_mfma_f32_16x16x32_bf16 v[168:171],v[120:123],v[20:23],v[168:171]
v_fma_f32 v97,v97,s36,v16
v_fma_f32 v98,v98,s36,v16
v_mfma_f32_16x16x32_bf16 v[216:219],v[120:123],v[24:27],v[216:219]
v_fma_f32 v99,v99,s36,v16
v_fma_f32 v104,v104,s36,v17
v_mfma_f32_16x16x32_bf16 a[8:11],v[120:123],v[28:31],a[8:11]
v_exp_f32 v96,v96
v_mfma_f32_16x16x32_bf16 a[56:59],v[120:123],v[32:35],a[56:59]
v_exp_f32 v97,v97
v_mfma_f32_16x16x32_bf16 a[104:107],v[120:123],v[36:39],a[104:107]
ds_read_b64_tr_b16 v[120:121],v4 offset:24832
ds_read_b64_tr_b16 v[122:123],v4 offset:30976
v_mfma_f32_16x16x32_bf16 v[172:175],v[124:127],v[20:23],v[172:175]
v_exp_f32 v98,v98
v_mfma_f32_16x16x32_bf16 v[220:223],v[124:127],v[24:27],v[220:223]
v_exp_f32 v99,v99
v_mfma_f32_16x16x32_bf16 a[12:15],v[124:127],v[28:31],a[12:15]
v_cvt_pk_bf16_f32 v52,v96,v97
v_cvt_pk_bf16_f32 v53,v98,v99
v_mfma_f32_16x16x32_bf16 a[60:63],v[124:127],v[32:35],a[60:63]
v_fma_f32 v105,v105,s36,v17
v_fma_f32 v106,v106,s36,v17
v_mfma_f32_16x16x32_bf16 a[108:111],v[124:127],v[36:39],a[108:111]
ds_read_b64_tr_b16 v[124:125],v5 offset:24832
ds_read_b64_tr_b16 v[126:127],v5 offset:30976
v_mfma_f32_16x16x32_bf16 v[176:179],v[128:131],v[20:23],v[176:179]
v_fma_f32 v107,v107,s36,v17
v_fma_f32 v76,v76,s36,v13
v_mfma_f32_16x16x32_bf16 v[224:227],v[128:131],v[24:27],v[224:227]
v_exp_f32 v104,v104
v_mfma_f32_16x16x32_bf16 a[16:19],v[128:131],v[28:31],a[16:19]
v_exp_f32 v105,v105
v_mfma_f32_16x16x32_bf16 a[64:67],v[128:131],v[32:35],a[64:67]
v_exp_f32 v106,v106
v_mfma_f32_16x16x32_bf16 a[112:115],v[128:131],v[36:39],a[112:115]
s_waitcnt lgkmcnt(2)
v_exp_f32 v107,v107
v_mfma_f32_16x16x32_bf16 v[180:183],v[132:135],v[20:23],v[180:183]
v_cvt_pk_bf16_f32 v56,v104,v105
v_cvt_pk_bf16_f32 v57,v106,v107
v_mfma_f32_16x16x32_bf16 v[228:231],v[132:135],v[24:27],v[228:231]
v_fma_f32 v77,v77,s36,v13
v_fma_f32 v78,v78,s36,v13
v_mfma_f32_16x16x32_bf16 a[20:23],v[132:135],v[28:31],a[20:23]
v_fma_f32 v79,v79,s36,v13
v_fma_f32 v84,v84,s36,v14
v_mfma_f32_16x16x32_bf16 a[68:71],v[132:135],v[32:35],a[68:71]
v_exp_f32 v76,v76
v_mfma_f32_16x16x32_bf16 a[116:119],v[132:135],v[36:39],a[116:119]
v_exp_f32 v77,v77
v_mfma_f32_16x16x32_bf16 v[184:187],v[136:139],v[20:23],v[184:187]
v_exp_f32 v78,v78
v_mfma_f32_16x16x32_bf16 v[232:235],v[136:139],v[24:27],v[232:235]
v_exp_f32 v79,v79
v_mfma_f32_16x16x32_bf16 a[24:27],v[136:139],v[28:31],a[24:27]
v_cvt_pk_bf16_f32 v42,v76,v77
v_cvt_pk_bf16_f32 v43,v78,v79
v_mfma_f32_16x16x32_bf16 a[72:75],v[136:139],v[32:35],a[72:75]
v_fma_f32 v85,v85,s36,v14
v_fma_f32 v86,v86,s36,v14
v_mfma_f32_16x16x32_bf16 a[120:123],v[136:139],v[36:39],a[120:123]
v_fma_f32 v87,v87,s36,v14
v_fma_f32 v92,v92,s36,v15
v_mfma_f32_16x16x32_bf16 v[188:191],v[140:143],v[20:23],v[188:191]
v_exp_f32 v84,v84
v_mfma_f32_16x16x32_bf16 v[236:239],v[140:143],v[24:27],v[236:239]
v_exp_f32 v85,v85
v_mfma_f32_16x16x32_bf16 a[28:31],v[140:143],v[28:31],a[28:31]
v_exp_f32 v86,v86
v_mfma_f32_16x16x32_bf16 a[76:79],v[140:143],v[32:35],a[76:79]
v_exp_f32 v87,v87
v_mfma_f32_16x16x32_bf16 a[124:127],v[140:143],v[36:39],a[124:127]
v_cvt_pk_bf16_f32 v46,v84,v85
v_cvt_pk_bf16_f32 v47,v86,v87
v_mfma_f32_16x16x32_bf16 v[192:195],v[112:115],v[20:23],v[192:195]
v_fma_f32 v93,v93,s36,v15
v_fma_f32 v94,v94,s36,v15
v_smfmac_f32_16x16x64_bf16 v[60:63],v[152:155],v[40:47],v18
v_fma_f32 v95,v95,s36,v15
s_waitcnt vmcnt(6) lgkmcnt(0)
v_mfma_f32_16x16x32_bf16 v[240:243],v[112:115],v[24:27],v[240:243]
s_barrier
v_mfma_f32_16x16x32_bf16 a[32:35],v[112:115],v[28:31],a[32:35]
ds_read_b128 v[128:131],v0 offset:12288
v_fma_f32 v100,v100,s36,v16
v_mfma_f32_16x16x32_bf16 a[80:83],v[112:115],v[32:35],a[80:83]
ds_read_b128 v[132:135],v1 offset:12288
v_fma_f32 v101,v101,s36,v16
v_mfma_f32_16x16x32_bf16 a[128:131],v[112:115],v[36:39],a[128:131]
ds_read_b128 v[136:139],v0 offset:12416
v_fma_f32 v102,v102,s36,v16
v_mfma_f32_16x16x32_bf16 v[196:199],v[116:119],v[20:23],v[196:199]
ds_read_b128 v[140:143],v1 offset:12416
v_fma_f32 v103,v103,s36,v16
v_mfma_f32_16x16x32_bf16 v[244:247],v[116:119],v[24:27],v[244:247]
ds_read_b128 v[156:159],v10 offset:0
v_fma_f32 v108,v108,s36,v17
v_mfma_f32_16x16x32_bf16 a[36:39],v[116:119],v[28:31],a[36:39]
buffer_load_dwordx4 v6,s[8:11],s21 offen offset:0 lds
v_mfma_f32_16x16x32_bf16 a[84:87],v[116:119],v[32:35],a[84:87]
ds_read_b128 v[112:115],v0 offset:12544
v_fma_f32 v109,v109,s36,v17
v_mfma_f32_16x16x32_bf16 a[132:135],v[116:119],v[36:39],a[132:135]
ds_read_b128 v[116:119],v1 offset:12544
v_fma_f32 v110,v110,s36,v17
v_mfma_f32_16x16x32_bf16 v[200:203],v[120:123],v[20:23],v[200:203]
v_exp_f32 v92,v92
v_mfma_f32_16x16x32_bf16 v[248:251],v[120:123],v[24:27],v[248:251]
v_exp_f32 v93,v93
v_mfma_f32_16x16x32_bf16 a[40:43],v[120:123],v[28:31],a[40:43]
v_exp_f32 v94,v94
v_mfma_f32_16x16x32_bf16 a[88:91],v[120:123],v[32:35],a[88:91]
v_exp_f32 v95,v95
v_mfma_f32_16x16x32_bf16 a[136:139],v[120:123],v[36:39],a[136:139]
ds_read_b128 v[120:123],v0 offset:18432
v_cvt_pk_bf16_f32 v50,v92,v93
v_mfma_f32_16x16x32_bf16 v[204:207],v[124:127],v[20:23],v[204:207]
v_cvt_pk_bf16_f32 v51,v94,v95
v_fma_f32 v111,v111,s36,v17
v_mfma_f32_16x16x32_bf16 v[252:255],v[124:127],v[24:27],v[252:255]
v_exp_f32 v100,v100
v_mfma_f32_16x16x32_bf16 a[44:47],v[124:127],v[28:31],a[44:47]
v_exp_f32 v101,v101
v_mfma_f32_16x16x32_bf16 a[92:95],v[124:127],v[32:35],a[92:95]
v_exp_f32 v102,v102
v_mfma_f32_16x16x32_bf16 a[140:143],v[124:127],v[36:39],a[140:143]
s_waitcnt lgkmcnt(1)
buffer_store_dwordx4 v[156:159],v9,s[16:19],s27 offen offset:0 nt
buffer_load_dwordx4 v7,s[8:11],s21 offen offset:1024 lds
v_mfma_f32_16x16x32_bf16 v[72:75],v[128:131],a[144:147],0
ds_read_b128 v[124:127],v1 offset:18432
v_cvt_pk_bf16_f32 v54,v100,v101
v_mfma_f32_16x16x32_bf16 v[80:83],v[128:131],a[168:171],0
v_exp_f32 v103,v103
v_mfma_f32_16x16x32_bf16 v[88:91],v[128:131],a[192:195],0
v_cvt_pk_bf16_f32 v55,v102,v103
v_mfma_f32_16x16x32_bf16 v[96:99],v[128:131],a[216:219],0
v_exp_f32 v108,v108
v_smfmac_f32_16x16x64_bf16 v[64:67],v[152:155],v[48:55],v18
v_mfma_f32_16x16x32_bf16 v[104:107],v[128:131],a[240:243],0
ds_read_b128 v[156:159],v10 offset:1024
v_mfma_f32_16x16x32_bf16 v[72:75],v[132:135],a[148:151],v[72:75]
ds_read_b128 v[128:131],v0 offset:18560
v_mfma_f32_16x16x32_bf16 v[80:83],v[132:135],a[172:175],v[80:83]
v_exp_f32 v109,v109
v_mfma_f32_16x16x32_bf16 v[88:91],v[132:135],a[196:199],v[88:91]
v_exp_f32 v110,v110
v_mfma_f32_16x16x32_bf16 v[96:99],v[132:135],a[220:223],v[96:99]
buffer_load_dwordx4 v8,s[8:11],s21 offen offset:2048 lds
v_mfma_f32_16x16x32_bf16 v[104:107],v[132:135],a[244:247],v[104:107]
s_add_u32 s21,s21,12288
v_exp_f32 v111,v111
v_mfma_f32_16x16x32_bf16 v[72:75],v[136:139],a[152:155],v[72:75]
s_add_u32 m0,s22,0
v_cvt_pk_bf16_f32 v58,v108,v109
v_cvt_pk_bf16_f32 v59,v110,v111
v_mfma_f32_16x16x32_bf16 v[80:83],v[136:139],a[176:179],v[80:83]
ds_read_b128 v[132:135],v1 offset:18560
v_smfmac_f32_16x16x64_bf16 v[68:71],v[152:155],v[52:59],v18
v_mfma_f32_16x16x32_bf16 v[88:91],v[136:139],a[200:203],v[88:91]
v_mfma_f32_16x16x32_bf16 v[96:99],v[136:139],a[224:227],v[96:99]
v_mfma_f32_16x16x32_bf16 v[104:107],v[136:139],a[248:251],v[104:107]
ds_read_b128 v[136:139],v0 offset:18688
v_mfma_f32_16x16x32_bf16 v[72:75],v[140:143],a[156:159],v[72:75]
v_mfma_f32_16x16x32_bf16 v[80:83],v[140:143],a[180:183],v[80:83]
v_mfma_f32_16x16x32_bf16 v[88:91],v[140:143],a[204:207],v[88:91]
v_mfma_f32_16x16x32_bf16 v[96:99],v[140:143],a[228:231],v[96:99]
v_mfma_f32_16x16x32_bf16 v[104:107],v[140:143],a[252:255],v[104:107]
s_waitcnt lgkmcnt(1)
buffer_store_dwordx4 v[156:159],v9,s[16:19],s27 offen offset:128 nt
buffer_load_dwordx4 v6,s[4:7],s20 offen offset:0 lds
v_mfma_f32_16x16x32_bf16 v[72:75],v[112:115],a[160:163],v[72:75]
ds_read_b128 v[140:143],v1 offset:18688
v_mfma_f32_16x16x32_bf16 v[80:83],v[112:115],a[184:187],v[80:83]
v_mfma_f32_16x16x32_bf16 v[88:91],v[112:115],a[208:211],v[88:91]
v_mfma_f32_16x16x32_bf16 v[96:99],v[112:115],a[232:235],v[96:99]
v_mfma_f32_16x16x32_bf16 v[104:107],v[112:115],v[144:147],v[104:107]
v_mfma_f32_16x16x32_bf16 v[72:75],v[116:119],a[164:167],v[72:75]
ds_read_b128 v[156:159],v10 offset:2048
v_mfma_f32_16x16x32_bf16 v[80:83],v[116:119],a[188:191],v[80:83]
v_mfma_f32_16x16x32_bf16 v[88:91],v[116:119],a[212:215],v[88:91]
v_mfma_f32_16x16x32_bf16 v[96:99],v[116:119],a[236:239],v[96:99]
v_mfma_f32_16x16x32_bf16 v[104:107],v[116:119],v[148:151],v[104:107]
buffer_load_dwordx4 v7,s[4:7],s20 offen offset:1024 lds
v_mfma_f32_16x16x32_bf16 v[76:79],v[120:123],a[144:147],0
v_mfma_f32_16x16x32_bf16 v[84:87],v[120:123],a[168:171],0
v_fma_f32 v72,v72,s36,v13
v_fma_f32 v73,v73,s36,v13
v_mfma_f32_16x16x32_bf16 v[92:95],v[120:123],a[192:195],0
v_fma_f32 v74,v74,s36,v13
v_fma_f32 v75,v75,s36,v13
v_mfma_f32_16x16x32_bf16 v[100:103],v[120:123],a[216:219],0
v_fma_f32 v80,v80,s36,v14
v_fma_f32 v81,v81,s36,v14
v_mfma_f32_16x16x32_bf16 v[108:111],v[120:123],a[240:243],0
v_fma_f32 v82,v82,s36,v14
v_fma_f32 v83,v83,s36,v14
v_mfma_f32_16x16x32_bf16 v[76:79],v[124:127],a[148:151],v[76:79]
v_fma_f32 v88,v88,s36,v15
v_fma_f32 v89,v89,s36,v15
v_mfma_f32_16x16x32_bf16 v[84:87],v[124:127],a[172:175],v[84:87]
v_exp_f32 v72,v72
v_mfma_f32_16x16x32_bf16 v[92:95],v[124:127],a[196:199],v[92:95]
v_exp_f32 v73,v73
v_mfma_f32_16x16x32_bf16 v[100:103],v[124:127],a[220:223],v[100:103]
v_exp_f32 v74,v74
v_mfma_f32_16x16x32_bf16 v[108:111],v[124:127],a[244:247],v[108:111]
v_exp_f32 v75,v75
v_mfma_f32_16x16x32_bf16 v[76:79],v[128:131],a[152:155],v[76:79]
v_exp_f32 v80,v80
v_mfma_f32_16x16x32_bf16 v[84:87],v[128:131],a[176:179],v[84:87]
s_waitcnt lgkmcnt(0)
buffer_store_dwordx4 v[156:159],v9,s[16:19],s27 offen offset:256 nt
buffer_load_dwordx4 v8,s[4:7],s20 offen offset:2048 lds
v_mfma_f32_16x16x32_bf16 v[92:95],v[128:131],a[200:203],v[92:95]
s_add_u32 s20,s20,12288
v_exp_f32 v81,v81
v_mfma_f32_16x16x32_bf16 v[100:103],v[128:131],a[224:227],v[100:103]
s_add_u32 s27,s27,3072
v_exp_f32 v82,v82
v_mfma_f32_16x16x32_bf16 v[108:111],v[128:131],a[248:251],v[108:111]
v_exp_f32 v83,v83
v_mfma_f32_16x16x32_bf16 v[76:79],v[132:135],a[156:159],v[76:79]
v_exp_f32 v88,v88
v_mfma_f32_16x16x32_bf16 v[84:87],v[132:135],a[180:183],v[84:87]
ds_read_b64_tr_b16 v[112:113],v2 offset:0
ds_read_b64_tr_b16 v[114:115],v2 offset:6144
v_mfma_f32_16x16x32_bf16 v[92:95],v[132:135],a[204:207],v[92:95]
v_exp_f32 v89,v89
v_mfma_f32_16x16x32_bf16 v[100:103],v[132:135],a[228:231],v[100:103]
ds_read_b64_tr_b16 v[116:117],v3 offset:0
ds_read_b64_tr_b16 v[118:119],v3 offset:6144
v_mfma_f32_16x16x32_bf16 v[108:111],v[132:135],a[252:255],v[108:111]
v_cvt_pk_bf16_f32 v20,v72,v73
v_cvt_pk_bf16_f32 v21,v74,v75
v_mfma_f32_16x16x32_bf16 v[76:79],v[136:139],a[160:163],v[76:79]
v_cvt_pk_bf16_f32 v24,v80,v81
v_cvt_pk_bf16_f32 v25,v82,v83
v_mfma_f32_16x16x32_bf16 v[84:87],v[136:139],a[184:187],v[84:87]
ds_read_b64_tr_b16 v[120:121],v4 offset:0
ds_read_b64_tr_b16 v[122:123],v4 offset:6144
v_mfma_f32_16x16x32_bf16 v[92:95],v[136:139],a[208:211],v[92:95]
v_cvt_pk_bf16_f32 v28,v88,v89
v_mfma_f32_16x16x32_bf16 v[100:103],v[136:139],a[232:235],v[100:103]
ds_read_b64_tr_b16 v[124:125],v5 offset:0
ds_read_b64_tr_b16 v[126:127],v5 offset:6144
v_mfma_f32_16x16x32_bf16 v[108:111],v[136:139],v[144:147],v[108:111]
v_mfma_f32_16x16x32_bf16 v[76:79],v[140:143],a[164:167],v[76:79]
v_mfma_f32_16x16x32_bf16 v[84:87],v[140:143],a[188:191],v[84:87]
v_mfma_f32_16x16x32_bf16 v[92:95],v[140:143],a[212:215],v[92:95]
v_mfma_f32_16x16x32_bf16 v[100:103],v[140:143],a[236:239],v[100:103]
v_mfma_f32_16x16x32_bf16 v[108:111],v[140:143],v[148:151],v[108:111]
s_waitcnt lgkmcnt(4)
v_mfma_f32_16x16x32_bf16 v[160:163],v[112:115],v[40:43],v[160:163]
s_add_u32 m0,s29,0
ds_read_b64_tr_b16 v[128:129],v2 offset:128
ds_read_b64_tr_b16 v[130:131],v2 offset:6272
v_mfma_f32_16x16x32_bf16 v[208:211],v[112:115],v[44:47],v[208:211]
ds_read_b64_tr_b16 v[132:133],v3 offset:128
ds_read_b64_tr_b16 v[134:135],v3 offset:6272
v_mfma_f32_16x16x32_bf16 a[0:3],v[112:115],v[48:51],a[0:3]
ds_read_b64_tr_b16 v[136:137],v4 offset:128
ds_read_b64_tr_b16 v[138:139],v4 offset:6272
v_mfma_f32_16x16x32_bf16 a[48:51],v[112:115],v[52:55],a[48:51]
ds_read_b64_tr_b16 v[140:141],v5 offset:128
ds_read_b64_tr_b16 v[142:143],v5 offset:6272
v_mfma_f32_16x16x32_bf16 a[96:99],v[112:115],v[56:59],a[96:99]
ds_read_b64_tr_b16 v[112:113],v2 offset:256
ds_read_b64_tr_b16 v[114:115],v2 offset:6400
v_mfma_f32_16x16x32_bf16 v[164:167],v[116:119],v[40:43],v[164:167]
v_fma_f32 v90,v90,s36,v15
v_fma_f32 v91,v91,s36,v15
v_mfma_f32_16x16x32_bf16 v[212:215],v[116:119],v[44:47],v[212:215]
v_exp_f32 v90,v90
v_mfma_f32_16x16x32_bf16 a[4:7],v[116:119],v[48:51],a[4:7]
buffer_load_dwordx4 v6,s[12:15],s28 offen offset:0 nt lds
v_mfma_f32_16x16x32_bf16 a[52:55],v[116:119],v[52:55],a[52:55]
v_exp_f32 v91,v91
v_mfma_f32_16x16x32_bf16 a[100:103],v[116:119],v[56:59],a[100:103]
s_waitcnt lgkmcnt(7)
ds_read_b64_tr_b16 v[116:117],v3 offset:256
ds_read_b64_tr_b16 v[118:119],v3 offset:6400
v_mfma_f32_16x16x32_bf16 v[168:171],v[120:123],v[40:43],v[168:171]
v_cvt_pk_bf16_f32 v29,v90,v91
v_fma_f32 v96,v96,s36,v16
v_mfma_f32_16x16x32_bf16 v[216:219],v[120:123],v[44:47],v[216:219]
v_fma_f32 v97,v97,s36,v16
v_fma_f32 v98,v98,s36,v16
v_mfma_f32_16x16x32_bf16 a[8:11],v[120:123],v[48:51],a[8:11]
v_fma_f32 v99,v99,s36,v16
v_fma_f32 v104,v104,s36,v17
v_mfma_f32_16x16x32_bf16 a[56:59],v[120:123],v[52:55],a[56:59]
v_exp_f32 v96,v96
v_mfma_f32_16x16x32_bf16 a[104:107],v[120:123],v[56:59],a[104:107]
ds_read_b64_tr_b16 v[120:121],v4 offset:256
ds_read_b64_tr_b16 v[122:123],v4 offset:6400
v_mfma_f32_16x16x32_bf16 v[172:175],v[124:127],v[40:43],v[172:175]
v_exp_f32 v97,v97
v_mfma_f32_16x16x32_bf16 v[220:223],v[124:127],v[44:47],v[220:223]
v_exp_f32 v98,v98
v_mfma_f32_16x16x32_bf16 a[12:15],v[124:127],v[48:51],a[12:15]
buffer_load_dwordx4 v7,s[12:15],s28 offen offset:1024 nt lds
v_mfma_f32_16x16x32_bf16 a[60:63],v[124:127],v[52:55],a[60:63]
v_exp_f32 v99,v99
v_mfma_f32_16x16x32_bf16 a[108:111],v[124:127],v[56:59],a[108:111]
ds_read_b64_tr_b16 v[124:125],v5 offset:256
ds_read_b64_tr_b16 v[126:127],v5 offset:6400
v_mfma_f32_16x16x32_bf16 v[176:179],v[128:131],v[40:43],v[176:179]
v_cvt_pk_bf16_f32 v32,v96,v97
v_cvt_pk_bf16_f32 v33,v98,v99
v_mfma_f32_16x16x32_bf16 v[224:227],v[128:131],v[44:47],v[224:227]
v_fma_f32 v105,v105,s36,v17
v_fma_f32 v106,v106,s36,v17
v_mfma_f32_16x16x32_bf16 a[16:19],v[128:131],v[48:51],a[16:19]
v_fma_f32 v107,v107,s36,v17
v_fma_f32 v76,v76,s36,v13
v_mfma_f32_16x16x32_bf16 a[64:67],v[128:131],v[52:55],a[64:67]
v_exp_f32 v104,v104
v_mfma_f32_16x16x32_bf16 a[112:115],v[128:131],v[56:59],a[112:115]
s_waitcnt lgkmcnt(2)
v_exp_f32 v105,v105
v_mfma_f32_16x16x32_bf16 v[180:183],v[132:135],v[40:43],v[180:183]
v_exp_f32 v106,v106
v_mfma_f32_16x16x32_bf16 v[228:231],v[132:135],v[44:47],v[228:231]
v_exp_f32 v107,v107
v_mfma_f32_16x16x32_bf16 a[20:23],v[132:135],v[48:51],a[20:23]
buffer_load_dwordx4 v8,s[12:15],s28 offen offset:2048 nt lds
v_mfma_f32_16x16x32_bf16 a[68:71],v[132:135],v[52:55],a[68:71]
s_add_u32 s28,s28,3072
v_cvt_pk_bf16_f32 v36,v104,v105
v_cvt_pk_bf16_f32 v37,v106,v107
v_mfma_f32_16x16x32_bf16 a[116:119],v[132:135],v[56:59],a[116:119]
s_add_u32 s29,s29,3072
v_fma_f32 v77,v77,s36,v13
v_fma_f32 v78,v78,s36,v13
v_mfma_f32_16x16x32_bf16 v[184:187],v[136:139],v[40:43],v[184:187]
s_add_u32 m0,s23,0
v_fma_f32 v79,v79,s36,v13
v_fma_f32 v84,v84,s36,v14
v_mfma_f32_16x16x32_bf16 v[232:235],v[136:139],v[44:47],v[232:235]
v_exp_f32 v76,v76
v_mfma_f32_16x16x32_bf16 a[24:27],v[136:139],v[48:51],a[24:27]
v_exp_f32 v77,v77
v_mfma_f32_16x16x32_bf16 a[72:75],v[136:139],v[52:55],a[72:75]
v_exp_f32 v78,v78
v_mfma_f32_16x16x32_bf16 a[120:123],v[136:139],v[56:59],a[120:123]
v_exp_f32 v79,v79
v_mfma_f32_16x16x32_bf16 v[188:191],v[140:143],v[40:43],v[188:191]
v_cvt_pk_bf16_f32 v22,v76,v77
v_cvt_pk_bf16_f32 v23,v78,v79
v_mfma_f32_16x16x32_bf16 v[236:239],v[140:143],v[44:47],v[236:239]
v_fma_f32 v85,v85,s36,v14
v_fma_f32 v86,v86,s36,v14
v_mfma_f32_16x16x32_bf16 a[28:31],v[140:143],v[48:51],a[28:31]
v_fma_f32 v87,v87,s36,v14
v_fma_f32 v92,v92,s36,v15
v_mfma_f32_16x16x32_bf16 a[76:79],v[140:143],v[52:55],a[76:79]
v_exp_f32 v84,v84
v_mfma_f32_16x16x32_bf16 a[124:127],v[140:143],v[56:59],a[124:127]
v_exp_f32 v85,v85
v_mfma_f32_16x16x32_bf16 v[192:195],v[112:115],v[40:43],v[192:195]
v_exp_f32 v86,v86
s_waitcnt vmcnt(12) lgkmcnt(0)
v_mfma_f32_16x16x32_bf16 v[240:243],v[112:115],v[44:47],v[240:243]
s_barrier
v_mfma_f32_16x16x32_bf16 a[32:35],v[112:115],v[48:51],a[32:35]
ds_read_b128 v[128:131],v0 offset:24576
v_cvt_pk_bf16_f32 v26,v84,v85
v_mfma_f32_16x16x32_bf16 a[80:83],v[112:115],v[52:55],a[80:83]
ds_read_b128 v[132:135],v1 offset:24576
v_fma_f32 v93,v93,s36,v15
v_mfma_f32_16x16x32_bf16 a[128:131],v[112:115],v[56:59],a[128:131]
ds_read_b128 v[136:139],v0 offset:24704
v_fma_f32 v94,v94,s36,v15
v_mfma_f32_16x16x32_bf16 v[196:199],v[116:119],v[40:43],v[196:199]
ds_read_b128 v[140:143],v1 offset:24704
v_fma_f32 v95,v95,s36,v15
v_mfma_f32_16x16x32_bf16 v[244:247],v[116:119],v[44:47],v[244:247]
ds_read_b128 v[112:115],v0 offset:24832
v_fma_f32 v100,v100,s36,v16
v_mfma_f32_16x16x32_bf16 a[36:39],v[116:119],v[48:51],a[36:39]
buffer_load_dwordx4 v6,s[8:11],s21 offen offset:0 lds
v_mfma_f32_16x16x32_bf16 a[84:87],v[116:119],v[52:55],a[84:87]
v_exp_f32 v87,v87
v_mfma_f32_16x16x32_bf16 a[132:135],v[116:119],v[56:59],a[132:135]
ds_read_b128 v[116:119],v1 offset:24832
v_cvt_pk_bf16_f32 v27,v86,v87
v_mfma_f32_16x16x32_bf16 v[200:203],v[120:123],v[40:43],v[200:203]
v_exp_f32 v92,v92
v_smfmac_f32_16x16x64_bf16 v[60:63],v[152:155],v[20:27],v18
v_fma_f32 v101,v101,s36,v16
v_mfma_f32_16x16x32_bf16 v[248:251],v[120:123],v[44:47],v[248:251]
v_exp_f32 v93,v93
v_mfma_f32_16x16x32_bf16 a[40:43],v[120:123],v[48:51],a[40:43]
v_exp_f32 v94,v94
v_mfma_f32_16x16x32_bf16 a[88:91],v[120:123],v[52:55],a[88:91]
v_exp_f32 v95,v95
v_mfma_f32_16x16x32_bf16 a[136:139],v[120:123],v[56:59],a[136:139]
ds_read_b128 v[120:123],v0 offset:30720
v_cvt_pk_bf16_f32 v30,v92,v93
v_mfma_f32_16x16x32_bf16 v[204:207],v[124:127],v[40:43],v[204:207]
v_cvt_pk_bf16_f32 v31,v94,v95
v_fma_f32 v102,v102,s36,v16
v_mfma_f32_16x16x32_bf16 v[252:255],v[124:127],v[44:47],v[252:255]
v_fma_f32 v103,v103,s36,v16
v_fma_f32 v108,v108,s36,v17
v_mfma_f32_16x16x32_bf16 a[44:47],v[124:127],v[48:51],a[44:47]
v_exp_f32 v100,v100
v_mfma_f32_16x16x32_bf16 a[92:95],v[124:127],v[52:55],a[92:95]
buffer_load_dwordx4 v7,s[8:11],s21 offen offset:1024 lds
v_mfma_f32_16x16x32_bf16 a[140:143],v[124:127],v[56:59],a[140:143]
s_waitcnt lgkmcnt(1)
ds_read_b128 v[124:127],v1 offset:30720
v_fma_f32 v109,v109,s36,v17
v_mfma_f32_16x16x32_bf16 v[72:75],v[128:131],a[144:147],0
v_exp_f32 v101,v101
v_mfma_f32_16x16x32_bf16 v[80:83],v[128:131],a[168:171],0
v_exp_f32 v102,v102
v_mfma_f32_16x16x32_bf16 v[88:91],v[128:131],a[192:195],0
v_exp_f32 v103,v103
v_mfma_f32_16x16x32_bf16 v[96:99],v[128:131],a[216:219],0
v_cvt_pk_bf16_f32 v34,v100,v101
v_cvt_pk_bf16_f32 v35,v102,v103
v_mfma_f32_16x16x32_bf16 v[104:107],v[128:131],a[240:243],0
ds_read_b128 v[128:131],v0 offset:30848
v_fma_f32 v110,v110,s36,v17
v_smfmac_f32_16x16x64_bf16 v[64:67],v[152:155],v[28:35],v18
v_fma_f32 v111,v111,s36,v17
v_mfma_f32_16x16x32_bf16 v[72:75],v[132:135],a[148:151],v[72:75]
v_exp_f32 v108,v108
v_mfma_f32_16x16x32_bf16 v[80:83],v[132:135],a[172:175],v[80:83]
v_exp_f32 v109,v109
v_mfma_f32_16x16x32_bf16 v[88:91],v[132:135],a[196:199],v[88:91]
v_exp_f32 v110,v110
v_mfma_f32_16x16x32_bf16 v[96:99],v[132:135],a[220:223],v[96:99]
buffer_load_dwordx4 v8,s[8:11],s21 offen offset:2048 lds
v_mfma_f32_16x16x32_bf16 v[104:107],v[132:135],a[244:247],v[104:107]
s_add_u32 s21,s21,12288
v_exp_f32 v111,v111
v_mfma_f32_16x16x32_bf16 v[72:75],v[136:139],a[152:155],v[72:75]
s_add_u32 m0,s22,12288
v_cvt_pk_bf16_f32 v38,v108,v109
v_cvt_pk_bf16_f32 v39,v110,v111
v_mfma_f32_16x16x32_bf16 v[80:83],v[136:139],a[176:179],v[80:83]
ds_read_b128 v[132:135],v1 offset:30848
v_smfmac_f32_16x16x64_bf16 v[68:71],v[152:155],v[32:39],v18
v_mfma_f32_16x16x32_bf16 v[88:91],v[136:139],a[200:203],v[88:91]
v_mfma_f32_16x16x32_bf16 v[96:99],v[136:139],a[224:227],v[96:99]
v_mfma_f32_16x16x32_bf16 v[104:107],v[136:139],a[248:251],v[104:107]
ds_read_b128 v[136:139],v0 offset:30976
v_mfma_f32_16x16x32_bf16 v[72:75],v[140:143],a[156:159],v[72:75]
v_mfma_f32_16x16x32_bf16 v[80:83],v[140:143],a[180:183],v[80:83]
v_mfma_f32_16x16x32_bf16 v[88:91],v[140:143],a[204:207],v[88:91]
v_mfma_f32_16x16x32_bf16 v[96:99],v[140:143],a[228:231],v[96:99]
buffer_load_dwordx4 v6,s[4:7],s20 offen offset:0 lds
v_mfma_f32_16x16x32_bf16 v[104:107],v[140:143],a[252:255],v[104:107]
ds_read_b128 v[140:143],v1 offset:30976
v_mfma_f32_16x16x32_bf16 v[72:75],v[112:115],a[160:163],v[72:75]
v_mfma_f32_16x16x32_bf16 v[80:83],v[112:115],a[184:187],v[80:83]
v_mfma_f32_16x16x32_bf16 v[88:91],v[112:115],a[208:211],v[88:91]
v_mfma_f32_16x16x32_bf16 v[96:99],v[112:115],a[232:235],v[96:99]
v_mfma_f32_16x16x32_bf16 v[104:107],v[112:115],v[144:147],v[104:107]
v_mfma_f32_16x16x32_bf16 v[72:75],v[116:119],a[164:167],v[72:75]
v_mfma_f32_16x16x32_bf16 v[80:83],v[116:119],a[188:191],v[80:83]
v_mfma_f32_16x16x32_bf16 v[88:91],v[116:119],a[212:215],v[88:91]
v_mfma_f32_16x16x32_bf16 v[96:99],v[116:119],a[236:239],v[96:99]
v_mfma_f32_16x16x32_bf16 v[104:107],v[116:119],v[148:151],v[104:107]
s_waitcnt lgkmcnt(0)
v_mfma_f32_16x16x32_bf16 v[76:79],v[120:123],a[144:147],0
buffer_load_dwordx4 v7,s[4:7],s20 offen offset:1024 lds
v_mfma_f32_16x16x32_bf16 v[84:87],v[120:123],a[168:171],0
v_mfma_f32_16x16x32_bf16 v[92:95],v[120:123],a[192:195],0
v_fma_f32 v72,v72,s36,v13
v_fma_f32 v73,v73,s36,v13
v_mfma_f32_16x16x32_bf16 v[100:103],v[120:123],a[216:219],0
v_fma_f32 v74,v74,s36,v13
v_fma_f32 v75,v75,s36,v13
v_mfma_f32_16x16x32_bf16 v[108:111],v[120:123],a[240:243],0
v_fma_f32 v80,v80,s36,v14
v_fma_f32 v81,v81,s36,v14
v_mfma_f32_16x16x32_bf16 v[76:79],v[124:127],a[148:151],v[76:79]
v_fma_f32 v82,v82,s36,v14
v_fma_f32 v83,v83,s36,v14
v_mfma_f32_16x16x32_bf16 v[84:87],v[124:127],a[172:175],v[84:87]
v_fma_f32 v88,v88,s36,v15
v_fma_f32 v89,v89,s36,v15
v_mfma_f32_16x16x32_bf16 v[92:95],v[124:127],a[196:199],v[92:95]
v_exp_f32 v72,v72
v_mfma_f32_16x16x32_bf16 v[100:103],v[124:127],a[220:223],v[100:103]
v_exp_f32 v73,v73
v_mfma_f32_16x16x32_bf16 v[108:111],v[124:127],a[244:247],v[108:111]
v_exp_f32 v74,v74
v_mfma_f32_16x16x32_bf16 v[76:79],v[128:131],a[152:155],v[76:79]
v_exp_f32 v75,v75
v_mfma_f32_16x16x32_bf16 v[84:87],v[128:131],a[176:179],v[84:87]
buffer_load_dwordx4 v8,s[4:7],s20 offen offset:2048 lds
v_mfma_f32_16x16x32_bf16 v[92:95],v[128:131],a[200:203],v[92:95]
s_add_u32 s20,s20,12288
v_exp_f32 v80,v80
v_mfma_f32_16x16x32_bf16 v[100:103],v[128:131],a[224:227],v[100:103]
v_exp_f32 v81,v81
v_mfma_f32_16x16x32_bf16 v[108:111],v[128:131],a[248:251],v[108:111]
v_exp_f32 v82,v82
v_mfma_f32_16x16x32_bf16 v[76:79],v[132:135],a[156:159],v[76:79]
v_exp_f32 v83,v83
v_mfma_f32_16x16x32_bf16 v[84:87],v[132:135],a[180:183],v[84:87]
ds_read_b64_tr_b16 v[112:113],v2 offset:12288
v_mfma_f32_16x16x32_bf16 v[92:95],v[132:135],a[204:207],v[92:95]
ds_read_b64_tr_b16 v[114:115],v2 offset:18432
v_cvt_pk_bf16_f32 v40,v72,v73
v_mfma_f32_16x16x32_bf16 v[100:103],v[132:135],a[228:231],v[100:103]
v_exp_f32 v88,v88
v_mfma_f32_16x16x32_bf16 v[108:111],v[132:135],a[252:255],v[108:111]
ds_read_b64_tr_b16 v[116:117],v3 offset:12288
ds_read_b64_tr_b16 v[118:119],v3 offset:18432
v_mfma_f32_16x16x32_bf16 v[76:79],v[136:139],a[160:163],v[76:79]
v_exp_f32 v89,v89
v_mfma_f32_16x16x32_bf16 v[84:87],v[136:139],a[184:187],v[84:87]
ds_read_b64_tr_b16 v[120:121],v4 offset:12288
v_mfma_f32_16x16x32_bf16 v[92:95],v[136:139],a[208:211],v[92:95]
ds_read_b64_tr_b16 v[122:123],v4 offset:18432
v_cvt_pk_bf16_f32 v41,v74,v75
v_mfma_f32_16x16x32_bf16 v[100:103],v[136:139],a[232:235],v[100:103]
v_cvt_pk_bf16_f32 v44,v80,v81
v_cvt_pk_bf16_f32 v45,v82,v83
v_mfma_f32_16x16x32_bf16 v[108:111],v[136:139],v[144:147],v[108:111]
ds_read_b64_tr_b16 v[124:125],v5 offset:12288
ds_read_b64_tr_b16 v[126:127],v5 offset:18432
v_mfma_f32_16x16x32_bf16 v[76:79],v[140:143],a[164:167],v[76:79]
v_cvt_pk_bf16_f32 v48,v88,v89
v_mfma_f32_16x16x32_bf16 v[84:87],v[140:143],a[188:191],v[84:87]
v_mfma_f32_16x16x32_bf16 v[92:95],v[140:143],a[212:215],v[92:95]
v_mfma_f32_16x16x32_bf16 v[100:103],v[140:143],a[236:239],v[100:103]
v_mfma_f32_16x16x32_bf16 v[108:111],v[140:143],v[148:151],v[108:111]
s_waitcnt lgkmcnt(4)
v_mfma_f32_16x16x32_bf16 v[160:163],v[112:115],v[20:23],v[160:163]
s_add_u32 m0,s23,12288
ds_read_b64_tr_b16 v[128:129],v2 offset:12416
ds_read_b64_tr_b16 v[130:131],v2 offset:18560
v_mfma_f32_16x16x32_bf16 v[208:211],v[112:115],v[24:27],v[208:211]
ds_read_b64_tr_b16 v[132:133],v3 offset:12416
ds_read_b64_tr_b16 v[134:135],v3 offset:18560
v_mfma_f32_16x16x32_bf16 a[0:3],v[112:115],v[28:31],a[0:3]
ds_read_b64_tr_b16 v[136:137],v4 offset:12416
ds_read_b64_tr_b16 v[138:139],v4 offset:18560
v_mfma_f32_16x16x32_bf16 a[48:51],v[112:115],v[32:35],a[48:51]
ds_read_b64_tr_b16 v[140:141],v5 offset:12416
ds_read_b64_tr_b16 v[142:143],v5 offset:18560
v_mfma_f32_16x16x32_bf16 a[96:99],v[112:115],v[36:39],a[96:99]
ds_read_b64_tr_b16 v[112:113],v2 offset:12544
ds_read_b64_tr_b16 v[114:115],v2 offset:18688
v_mfma_f32_16x16x32_bf16 v[164:167],v[116:119],v[20:23],v[164:167]
v_fma_f32 v90,v90,s36,v15
v_fma_f32 v91,v91,s36,v15
v_mfma_f32_16x16x32_bf16 v[212:215],v[116:119],v[24:27],v[212:215]
v_exp_f32 v90,v90
v_mfma_f32_16x16x32_bf16 a[4:7],v[116:119],v[28:31],a[4:7]
v_exp_f32 v91,v91
v_mfma_f32_16x16x32_bf16 a[52:55],v[116:119],v[32:35],a[52:55]
v_cvt_pk_bf16_f32 v49,v90,v91
v_fma_f32 v96,v96,s36,v16
v_mfma_f32_16x16x32_bf16 a[100:103],v[116:119],v[36:39],a[100:103]
s_waitcnt lgkmcnt(8)
ds_read_b64_tr_b16 v[116:117],v3 offset:12544
ds_read_b64_tr_b16 v[118:119],v3 offset:18688
v_mfma_f32_16x16x32_bf16 v[168:171],v[120:123],v[20:23],v[168:171]
v_fma_f32 v97,v97,s36,v16
v_fma_f32 v98,v98,s36,v16
v_mfma_f32_16x16x32_bf16 v[216:219],v[120:123],v[24:27],v[216:219]
v_fma_f32 v99,v99,s36,v16
v_fma_f32 v104,v104,s36,v17
v_mfma_f32_16x16x32_bf16 a[8:11],v[120:123],v[28:31],a[8:11]
v_exp_f32 v96,v96
v_mfma_f32_16x16x32_bf16 a[56:59],v[120:123],v[32:35],a[56:59]
v_exp_f32 v97,v97
v_mfma_f32_16x16x32_bf16 a[104:107],v[120:123],v[36:39],a[104:107]
ds_read_b64_tr_b16 v[120:121],v4 offset:12544
ds_read_b64_tr_b16 v[122:123],v4 offset:18688
v_mfma_f32_16x16x32_bf16 v[172:175],v[124:127],v[20:23],v[172:175]
v_exp_f32 v98,v98
v_mfma_f32_16x16x32_bf16 v[220:223],v[124:127],v[24:27],v[220:223]
v_exp_f32 v99,v99
v_mfma_f32_16x16x32_bf16 a[12:15],v[124:127],v[28:31],a[12:15]
v_cvt_pk_bf16_f32 v52,v96,v97
v_cvt_pk_bf16_f32 v53,v98,v99
v_mfma_f32_16x16x32_bf16 a[60:63],v[124:127],v[32:35],a[60:63]
v_fma_f32 v105,v105,s36,v17
v_fma_f32 v106,v106,s36,v17
v_mfma_f32_16x16x32_bf16 a[108:111],v[124:127],v[36:39],a[108:111]
ds_read_b64_tr_b16 v[124:125],v5 offset:12544
ds_read_b64_tr_b16 v[126:127],v5 offset:18688
v_mfma_f32_16x16x32_bf16 v[176:179],v[128:131],v[20:23],v[176:179]
v_fma_f32 v107,v107,s36,v17
v_fma_f32 v76,v76,s36,v13
v_mfma_f32_16x16x32_bf16 v[224:227],v[128:131],v[24:27],v[224:227]
v_exp_f32 v104,v104
v_mfma_f32_16x16x32_bf16 a[16:19],v[128:131],v[28:31],a[16:19]
v_exp_f32 v105,v105
v_mfma_f32_16x16x32_bf16 a[64:67],v[128:131],v[32:35],a[64:67]
v_exp_f32 v106,v106
v_mfma_f32_16x16x32_bf16 a[112:115],v[128:131],v[36:39],a[112:115]
s_waitcnt lgkmcnt(2)
v_exp_f32 v107,v107
v_mfma_f32_16x16x32_bf16 v[180:183],v[132:135],v[20:23],v[180:183]
v_cvt_pk_bf16_f32 v56,v104,v105
v_cvt_pk_bf16_f32 v57,v106,v107
v_mfma_f32_16x16x32_bf16 v[228:231],v[132:135],v[24:27],v[228:231]
v_fma_f32 v77,v77,s36,v13
v_fma_f32 v78,v78,s36,v13
v_mfma_f32_16x16x32_bf16 a[20:23],v[132:135],v[28:31],a[20:23]
v_fma_f32 v79,v79,s36,v13
v_fma_f32 v84,v84,s36,v14
v_mfma_f32_16x16x32_bf16 a[68:71],v[132:135],v[32:35],a[68:71]
v_exp_f32 v76,v76
v_mfma_f32_16x16x32_bf16 a[116:119],v[132:135],v[36:39],a[116:119]
v_exp_f32 v77,v77
v_mfma_f32_16x16x32_bf16 v[184:187],v[136:139],v[20:23],v[184:187]
v_exp_f32 v78,v78
v_mfma_f32_16x16x32_bf16 v[232:235],v[136:139],v[24:27],v[232:235]
v_exp_f32 v79,v79
v_mfma_f32_16x16x32_bf16 a[24:27],v[136:139],v[28:31],a[24:27]
v_cvt_pk_bf16_f32 v42,v76,v77
v_cvt_pk_bf16_f32 v43,v78,v79
v_mfma_f32_16x16x32_bf16 a[72:75],v[136:139],v[32:35],a[72:75]
v_fma_f32 v85,v85,s36,v14
v_fma_f32 v86,v86,s36,v14
v_mfma_f32_16x16x32_bf16 a[120:123],v[136:139],v[36:39],a[120:123]
v_fma_f32 v87,v87,s36,v14
v_fma_f32 v92,v92,s36,v15
v_mfma_f32_16x16x32_bf16 v[188:191],v[140:143],v[20:23],v[188:191]
v_exp_f32 v84,v84
v_mfma_f32_16x16x32_bf16 v[236:239],v[140:143],v[24:27],v[236:239]
v_exp_f32 v85,v85
v_mfma_f32_16x16x32_bf16 a[28:31],v[140:143],v[28:31],a[28:31]
v_exp_f32 v86,v86
v_mfma_f32_16x16x32_bf16 a[76:79],v[140:143],v[32:35],a[76:79]
v_exp_f32 v87,v87
v_mfma_f32_16x16x32_bf16 a[124:127],v[140:143],v[36:39],a[124:127]
v_cvt_pk_bf16_f32 v46,v84,v85
v_cvt_pk_bf16_f32 v47,v86,v87
v_mfma_f32_16x16x32_bf16 v[192:195],v[112:115],v[20:23],v[192:195]
v_fma_f32 v93,v93,s36,v15
v_fma_f32 v94,v94,s36,v15
v_smfmac_f32_16x16x64_bf16 v[60:63],v[152:155],v[40:47],v18
v_fma_f32 v95,v95,s36,v15
s_waitcnt vmcnt(9) lgkmcnt(0)
v_mfma_f32_16x16x32_bf16 v[240:243],v[112:115],v[24:27],v[240:243]
s_barrier
v_mfma_f32_16x16x32_bf16 a[32:35],v[112:115],v[28:31],a[32:35]
ds_read_b128 v[128:131],v0 offset:0
v_fma_f32 v100,v100,s36,v16
v_mfma_f32_16x16x32_bf16 a[80:83],v[112:115],v[32:35],a[80:83]
ds_read_b128 v[132:135],v1 offset:0
v_fma_f32 v101,v101,s36,v16
v_mfma_f32_16x16x32_bf16 a[128:131],v[112:115],v[36:39],a[128:131]
ds_read_b128 v[136:139],v0 offset:128
v_fma_f32 v102,v102,s36,v16
v_mfma_f32_16x16x32_bf16 v[196:199],v[116:119],v[20:23],v[196:199]
ds_read_b128 v[140:143],v1 offset:128
v_fma_f32 v103,v103,s36,v16
v_mfma_f32_16x16x32_bf16 v[244:247],v[116:119],v[24:27],v[244:247]
ds_read_b128 v[156:159],v10 offset:3072
v_fma_f32 v108,v108,s36,v17
v_mfma_f32_16x16x32_bf16 a[36:39],v[116:119],v[28:31],a[36:39]
buffer_load_dwordx4 v6,s[8:11],s21 offen offset:0 lds
v_mfma_f32_16x16x32_bf16 a[84:87],v[116:119],v[32:35],a[84:87]
ds_read_b128 v[112:115],v0 offset:256
v_fma_f32 v109,v109,s36,v17
v_mfma_f32_16x16x32_bf16 a[132:135],v[116:119],v[36:39],a[132:135]
ds_read_b128 v[116:119],v1 offset:256
v_fma_f32 v110,v110,s36,v17
v_mfma_f32_16x16x32_bf16 v[200:203],v[120:123],v[20:23],v[200:203]
v_exp_f32 v92,v92
v_mfma_f32_16x16x32_bf16 v[248:251],v[120:123],v[24:27],v[248:251]
v_exp_f32 v93,v93
v_mfma_f32_16x16x32_bf16 a[40:43],v[120:123],v[28:31],a[40:43]
v_exp_f32 v94,v94
v_mfma_f32_16x16x32_bf16 a[88:91],v[120:123],v[32:35],a[88:91]
v_exp_f32 v95,v95
v_mfma_f32_16x16x32_bf16 a[136:139],v[120:123],v[36:39],a[136:139]
ds_read_b128 v[120:123],v0 offset:6144
v_cvt_pk_bf16_f32 v50,v92,v93
v_mfma_f32_16x16x32_bf16 v[204:207],v[124:127],v[20:23],v[204:207]
v_cvt_pk_bf16_f32 v51,v94,v95
v_fma_f32 v111,v111,s36,v17
v_mfma_f32_16x16x32_bf16 v[252:255],v[124:127],v[24:27],v[252:255]
v_exp_f32 v100,v100
v_mfma_f32_16x16x32_bf16 a[44:47],v[124:127],v[28:31],a[44:47]
v_exp_f32 v101,v101
v_mfma_f32_16x16x32_bf16 a[92:95],v[124:127],v[32:35],a[92:95]
v_exp_f32 v102,v102
v_mfma_f32_16x16x32_bf16 a[140:143],v[124:127],v[36:39],a[140:143]
s_waitcnt lgkmcnt(1)
buffer_store_dwordx4 v[156:159],v9,s[16:19],s27 offen offset:0 nt
buffer_load_dwordx4 v7,s[8:11],s21 offen offset:1024 lds
v_mfma_f32_16x16x32_bf16 v[72:75],v[128:131],a[144:147],0
ds_read_b128 v[124:127],v1 offset:6144
v_cvt_pk_bf16_f32 v54,v100,v101
v_mfma_f32_16x16x32_bf16 v[80:83],v[128:131],a[168:171],0
v_exp_f32 v103,v103
v_mfma_f32_16x16x32_bf16 v[88:91],v[128:131],a[192:195],0
v_cvt_pk_bf16_f32 v55,v102,v103
v_mfma_f32_16x16x32_bf16 v[96:99],v[128:131],a[216:219],0
v_exp_f32 v108,v108
v_smfmac_f32_16x16x64_bf16 v[64:67],v[152:155],v[48:55],v18
v_mfma_f32_16x16x32_bf16 v[104:107],v[128:131],a[240:243],0
ds_read_b128 v[156:159],v10 offset:4096
v_mfma_f32_16x16x32_bf16 v[72:75],v[132:135],a[148:151],v[72:75]
ds_read_b128 v[128:131],v0 offset:6272
v_mfma_f32_16x16x32_bf16 v[80:83],v[132:135],a[172:175],v[80:83]
v_exp_f32 v109,v109
v_mfma_f32_16x16x32_bf16 v[88:91],v[132:135],a[196:199],v[88:91]
v_exp_f32 v110,v110
v_mfma_f32_16x16x32_bf16 v[96:99],v[132:135],a[220:223],v[96:99]
buffer_load_dwordx4 v8,s[8:11],s21 offen offset:2048 lds
v_mfma_f32_16x16x32_bf16 v[104:107],v[132:135],a[244:247],v[104:107]
s_add_u32 s21,s21,12288
v_exp_f32 v111,v111
v_mfma_f32_16x16x32_bf16 v[72:75],v[136:139],a[152:155],v[72:75]
s_add_u32 m0,s22,24576
v_cvt_pk_bf16_f32 v58,v108,v109
v_cvt_pk_bf16_f32 v59,v110,v111
v_mfma_f32_16x16x32_bf16 v[80:83],v[136:139],a[176:179],v[80:83]
ds_read_b128 v[132:135],v1 offset:6272
v_smfmac_f32_16x16x64_bf16 v[68:71],v[152:155],v[52:59],v18
v_mfma_f32_16x16x32_bf16 v[88:91],v[136:139],a[200:203],v[88:91]
v_mfma_f32_16x16x32_bf16 v[96:99],v[136:139],a[224:227],v[96:99]
v_mfma_f32_16x16x32_bf16 v[104:107],v[136:139],a[248:251],v[104:107]
ds_read_b128 v[136:139],v0 offset:6400
v_mfma_f32_16x16x32_bf16 v[72:75],v[140:143],a[156:159],v[72:75]
v_mfma_f32_16x16x32_bf16 v[80:83],v[140:143],a[180:183],v[80:83]
v_mfma_f32_16x16x32_bf16 v[88:91],v[140:143],a[204:207],v[88:91]
v_mfma_f32_16x16x32_bf16 v[96:99],v[140:143],a[228:231],v[96:99]
v_mfma_f32_16x16x32_bf16 v[104:107],v[140:143],a[252:255],v[104:107]
s_waitcnt lgkmcnt(1)
buffer_store_dwordx4 v[156:159],v9,s[16:19],s27 offen offset:128 nt
buffer_load_dwordx4 v6,s[4:7],s20 offen offset:0 lds
v_mfma_f32_16x16x32_bf16 v[72:75],v[112:115],a[160:163],v[72:75]
ds_read_b128 v[140:143],v1 offset:6400
v_mfma_f32_16x16x32_bf16 v[80:83],v[112:115],a[184:187],v[80:83]
v_mfma_f32_16x16x32_bf16 v[88:91],v[112:115],a[208:211],v[88:91]
v_mfma_f32_16x16x32_bf16 v[96:99],v[112:115],a[232:235],v[96:99]
v_mfma_f32_16x16x32_bf16 v[104:107],v[112:115],v[144:147],v[104:107]
v_mfma_f32_16x16x32_bf16 v[72:75],v[116:119],a[164:167],v[72:75]
ds_read_b128 v[156:159],v10 offset:5120
v_mfma_f32_16x16x32_bf16 v[80:83],v[116:119],a[188:191],v[80:83]
v_mfma_f32_16x16x32_bf16 v[88:91],v[116:119],a[212:215],v[88:91]
v_mfma_f32_16x16x32_bf16 v[96:99],v[116:119],a[236:239],v[96:99]
v_mfma_f32_16x16x32_bf16 v[104:107],v[116:119],v[148:151],v[104:107]
buffer_load_dwordx4 v7,s[4:7],s20 offen offset:1024 lds
v_mfma_f32_16x16x32_bf16 v[76:79],v[120:123],a[144:147],0
v_mfma_f32_16x16x32_bf16 v[84:87],v[120:123],a[168:171],0
v_fma_f32 v72,v72,s36,v13
v_fma_f32 v73,v73,s36,v13
v_mfma_f32_16x16x32_bf16 v[92:95],v[120:123],a[192:195],0
v_fma_f32 v74,v74,s36,v13
v_fma_f32 v75,v75,s36,v13
v_mfma_f32_16x16x32_bf16 v[100:103],v[120:123],a[216:219],0
v_fma_f32 v80,v80,s36,v14
v_fma_f32 v81,v81,s36,v14
v_mfma_f32_16x16x32_bf16 v[108:111],v[120:123],a[240:243],0
v_fma_f32 v82,v82,s36,v14
v_fma_f32 v83,v83,s36,v14
v_mfma_f32_16x16x32_bf16 v[76:79],v[124:127],a[148:151],v[76:79]
v_fma_f32 v88,v88,s36,v15
v_fma_f32 v89,v89,s36,v15
v_mfma_f32_16x16x32_bf16 v[84:87],v[124:127],a[172:175],v[84:87]
v_exp_f32 v72,v72
v_mfma_f32_16x16x32_bf16 v[92:95],v[124:127],a[196:199],v[92:95]
v_exp_f32 v73,v73
v_mfma_f32_16x16x32_bf16 v[100:103],v[124:127],a[220:223],v[100:103]
v_exp_f32 v74,v74
v_mfma_f32_16x16x32_bf16 v[108:111],v[124:127],a[244:247],v[108:111]
v_exp_f32 v75,v75
v_mfma_f32_16x16x32_bf16 v[76:79],v[128:131],a[152:155],v[76:79]
v_exp_f32 v80,v80
v_mfma_f32_16x16x32_bf16 v[84:87],v[128:131],a[176:179],v[84:87]
s_waitcnt lgkmcnt(0)
buffer_store_dwordx4 v[156:159],v9,s[16:19],s27 offen offset:256 nt
buffer_load_dwordx4 v8,s[4:7],s20 offen offset:2048 lds
v_mfma_f32_16x16x32_bf16 v[92:95],v[128:131],a[200:203],v[92:95]
s_add_u32 s20,s20,12288
v_exp_f32 v81,v81
v_mfma_f32_16x16x32_bf16 v[100:103],v[128:131],a[224:227],v[100:103]
s_add_u32 s27,s27,3072
v_exp_f32 v82,v82
v_mfma_f32_16x16x32_bf16 v[108:111],v[128:131],a[248:251],v[108:111]
v_exp_f32 v83,v83
v_mfma_f32_16x16x32_bf16 v[76:79],v[132:135],a[156:159],v[76:79]
v_exp_f32 v88,v88
v_mfma_f32_16x16x32_bf16 v[84:87],v[132:135],a[180:183],v[84:87]
ds_read_b64_tr_b16 v[112:113],v2 offset:24576
ds_read_b64_tr_b16 v[114:115],v2 offset:30720
v_mfma_f32_16x16x32_bf16 v[92:95],v[132:135],a[204:207],v[92:95]
v_exp_f32 v89,v89
v_mfma_f32_16x16x32_bf16 v[100:103],v[132:135],a[228:231],v[100:103]
ds_read_b64_tr_b16 v[116:117],v3 offset:24576
ds_read_b64_tr_b16 v[118:119],v3 offset:30720
v_mfma_f32_16x16x32_bf16 v[108:111],v[132:135],a[252:255],v[108:111]
v_cvt_pk_bf16_f32 v20,v72,v73
v_cvt_pk_bf16_f32 v21,v74,v75
v_mfma_f32_16x16x32_bf16 v[76:79],v[136:139],a[160:163],v[76:79]
v_cvt_pk_bf16_f32 v24,v80,v81
v_cvt_pk_bf16_f32 v25,v82,v83
v_mfma_f32_16x16x32_bf16 v[84:87],v[136:139],a[184:187],v[84:87]
ds_read_b64_tr_b16 v[120:121],v4 offset:24576
ds_read_b64_tr_b16 v[122:123],v4 offset:30720
v_mfma_f32_16x16x32_bf16 v[92:95],v[136:139],a[208:211],v[92:95]
v_cvt_pk_bf16_f32 v28,v88,v89
v_mfma_f32_16x16x32_bf16 v[100:103],v[136:139],a[232:235],v[100:103]
ds_read_b64_tr_b16 v[124:125],v5 offset:24576
ds_read_b64_tr_b16 v[126:127],v5 offset:30720
v_mfma_f32_16x16x32_bf16 v[108:111],v[136:139],v[144:147],v[108:111]
v_mfma_f32_16x16x32_bf16 v[76:79],v[140:143],a[164:167],v[76:79]
v_mfma_f32_16x16x32_bf16 v[84:87],v[140:143],a[188:191],v[84:87]
v_mfma_f32_16x16x32_bf16 v[92:95],v[140:143],a[212:215],v[92:95]
v_mfma_f32_16x16x32_bf16 v[100:103],v[140:143],a[236:239],v[100:103]
v_mfma_f32_16x16x32_bf16 v[108:111],v[140:143],v[148:151],v[108:111]
s_waitcnt lgkmcnt(4)
v_mfma_f32_16x16x32_bf16 v[160:163],v[112:115],v[40:43],v[160:163]
s_add_u32 m0,s29,0
ds_read_b64_tr_b16 v[128:129],v2 offset:24704
ds_read_b64_tr_b16 v[130:131],v2 offset:30848
v_mfma_f32_16x16x32_bf16 v[208:211],v[112:115],v[44:47],v[208:211]
ds_read_b64_tr_b16 v[132:133],v3 offset:24704
ds_read_b64_tr_b16 v[134:135],v3 offset:30848
v_mfma_f32_16x16x32_bf16 a[0:3],v[112:115],v[48:51],a[0:3]
ds_read_b64_tr_b16 v[136:137],v4 offset:24704
ds_read_b64_tr_b16 v[138:139],v4 offset:30848
v_mfma_f32_16x16x32_bf16 a[48:51],v[112:115],v[52:55],a[48:51]
ds_read_b64_tr_b16 v[140:141],v5 offset:24704
ds_read_b64_tr_b16 v[142:143],v5 offset:30848
v_mfma_f32_16x16x32_bf16 a[96:99],v[112:115],v[56:59],a[96:99]
ds_read_b64_tr_b16 v[112:113],v2 offset:24832
ds_read_b64_tr_b16 v[114:115],v2 offset:30976
v_mfma_f32_16x16x32_bf16 v[164:167],v[116:119],v[40:43],v[164:167]
v_fma_f32 v90,v90,s36,v15
v_fma_f32 v91,v91,s36,v15
v_mfma_f32_16x16x32_bf16 v[212:215],v[116:119],v[44:47],v[212:215]
v_exp_f32 v90,v90
v_mfma_f32_16x16x32_bf16 a[4:7],v[116:119],v[48:51],a[4:7]
buffer_load_dwordx4 v6,s[12:15],s28 offen offset:0 nt lds
v_mfma_f32_16x16x32_bf16 a[52:55],v[116:119],v[52:55],a[52:55]
v_exp_f32 v91,v91
v_mfma_f32_16x16x32_bf16 a[100:103],v[116:119],v[56:59],a[100:103]
s_waitcnt lgkmcnt(7)
ds_read_b64_tr_b16 v[116:117],v3 offset:24832
ds_read_b64_tr_b16 v[118:119],v3 offset:30976
v_mfma_f32_16x16x32_bf16 v[168:171],v[120:123],v[40:43],v[168:171]
v_cvt_pk_bf16_f32 v29,v90,v91
v_fma_f32 v96,v96,s36,v16
v_mfma_f32_16x16x32_bf16 v[216:219],v[120:123],v[44:47],v[216:219]
v_fma_f32 v97,v97,s36,v16
v_fma_f32 v98,v98,s36,v16
v_mfma_f32_16x16x32_bf16 a[8:11],v[120:123],v[48:51],a[8:11]
v_fma_f32 v99,v99,s36,v16
v_fma_f32 v104,v104,s36,v17
v_mfma_f32_16x16x32_bf16 a[56:59],v[120:123],v[52:55],a[56:59]
v_exp_f32 v96,v96
v_mfma_f32_16x16x32_bf16 a[104:107],v[120:123],v[56:59],a[104:107]
ds_read_b64_tr_b16 v[120:121],v4 offset:24832
ds_read_b64_tr_b16 v[122:123],v4 offset:30976
v_mfma_f32_16x16x32_bf16 v[172:175],v[124:127],v[40:43],v[172:175]
v_exp_f32 v97,v97
v_mfma_f32_16x16x32_bf16 v[220:223],v[124:127],v[44:47],v[220:223]
v_exp_f32 v98,v98
v_mfma_f32_16x16x32_bf16 a[12:15],v[124:127],v[48:51],a[12:15]
buffer_load_dwordx4 v7,s[12:15],s28 offen offset:1024 nt lds
v_mfma_f32_16x16x32_bf16 a[60:63],v[124:127],v[52:55],a[60:63]
v_exp_f32 v99,v99
v_mfma_f32_16x16x32_bf16 a[108:111],v[124:127],v[56:59],a[108:111]
ds_read_b64_tr_b16 v[124:125],v5 offset:24832
ds_read_b64_tr_b16 v[126:127],v5 offset:30976
v_mfma_f32_16x16x32_bf16 v[176:179],v[128:131],v[40:43],v[176:179]
v_cvt_pk_bf16_f32 v32,v96,v97
v_cvt_pk_bf16_f32 v33,v98,v99
v_mfma_f32_16x16x32_bf16 v[224:227],v[128:131],v[44:47],v[224:227]
v_fma_f32 v105,v105,s36,v17
v_fma_f32 v106,v106,s36,v17
v_mfma_f32_16x16x32_bf16 a[16:19],v[128:131],v[48:51],a[16:19]
v_fma_f32 v107,v107,s36,v17
v_fma_f32 v76,v76,s36,v13
v_mfma_f32_16x16x32_bf16 a[64:67],v[128:131],v[52:55],a[64:67]
v_exp_f32 v104,v104
v_mfma_f32_16x16x32_bf16 a[112:115],v[128:131],v[56:59],a[112:115]
s_waitcnt lgkmcnt(2)
v_exp_f32 v105,v105
v_mfma_f32_16x16x32_bf16 v[180:183],v[132:135],v[40:43],v[180:183]
v_exp_f32 v106,v106
v_mfma_f32_16x16x32_bf16 v[228:231],v[132:135],v[44:47],v[228:231]
v_exp_f32 v107,v107
v_mfma_f32_16x16x32_bf16 a[20:23],v[132:135],v[48:51],a[20:23]
buffer_load_dwordx4 v8,s[12:15],s28 offen offset:2048 nt lds
v_mfma_f32_16x16x32_bf16 a[68:71],v[132:135],v[52:55],a[68:71]
s_add_u32 s28,s28,3072
v_cvt_pk_bf16_f32 v36,v104,v105
v_cvt_pk_bf16_f32 v37,v106,v107
v_mfma_f32_16x16x32_bf16 a[116:119],v[132:135],v[56:59],a[116:119]
s_add_u32 s29,s29,3072
v_fma_f32 v77,v77,s36,v13
v_fma_f32 v78,v78,s36,v13
v_mfma_f32_16x16x32_bf16 v[184:187],v[136:139],v[40:43],v[184:187]
s_add_u32 m0,s23,24576
v_fma_f32 v79,v79,s36,v13
v_fma_f32 v84,v84,s36,v14
v_mfma_f32_16x16x32_bf16 v[232:235],v[136:139],v[44:47],v[232:235]
v_exp_f32 v76,v76
v_mfma_f32_16x16x32_bf16 a[24:27],v[136:139],v[48:51],a[24:27]
v_exp_f32 v77,v77
v_mfma_f32_16x16x32_bf16 a[72:75],v[136:139],v[52:55],a[72:75]
v_exp_f32 v78,v78
v_mfma_f32_16x16x32_bf16 a[120:123],v[136:139],v[56:59],a[120:123]
v_exp_f32 v79,v79
v_mfma_f32_16x16x32_bf16 v[188:191],v[140:143],v[40:43],v[188:191]
v_cvt_pk_bf16_f32 v22,v76,v77
v_cvt_pk_bf16_f32 v23,v78,v79
v_mfma_f32_16x16x32_bf16 v[236:239],v[140:143],v[44:47],v[236:239]
v_fma_f32 v85,v85,s36,v14
v_fma_f32 v86,v86,s36,v14
v_mfma_f32_16x16x32_bf16 a[28:31],v[140:143],v[48:51],a[28:31]
v_fma_f32 v87,v87,s36,v14
v_fma_f32 v92,v92,s36,v15
v_mfma_f32_16x16x32_bf16 a[76:79],v[140:143],v[52:55],a[76:79]
v_exp_f32 v84,v84
v_mfma_f32_16x16x32_bf16 a[124:127],v[140:143],v[56:59],a[124:127]
v_exp_f32 v85,v85
v_mfma_f32_16x16x32_bf16 v[192:195],v[112:115],v[40:43],v[192:195]
v_exp_f32 v86,v86
s_waitcnt vmcnt(12) lgkmcnt(0)
v_mfma_f32_16x16x32_bf16 v[240:243],v[112:115],v[44:47],v[240:243]
s_barrier
v_mfma_f32_16x16x32_bf16 a[32:35],v[112:115],v[48:51],a[32:35]
ds_read_b128 v[128:131],v0 offset:12288
v_cvt_pk_bf16_f32 v26,v84,v85
v_mfma_f32_16x16x32_bf16 a[80:83],v[112:115],v[52:55],a[80:83]
ds_read_b128 v[132:135],v1 offset:12288
v_fma_f32 v93,v93,s36,v15
v_mfma_f32_16x16x32_bf16 a[128:131],v[112:115],v[56:59],a[128:131]
ds_read_b128 v[136:139],v0 offset:12416
v_fma_f32 v94,v94,s36,v15
v_mfma_f32_16x16x32_bf16 v[196:199],v[116:119],v[40:43],v[196:199]
ds_read_b128 v[140:143],v1 offset:12416
v_fma_f32 v95,v95,s36,v15
v_mfma_f32_16x16x32_bf16 v[244:247],v[116:119],v[44:47],v[244:247]
ds_read_b128 v[112:115],v0 offset:12544
v_fma_f32 v100,v100,s36,v16
v_mfma_f32_16x16x32_bf16 a[36:39],v[116:119],v[48:51],a[36:39]
buffer_load_dwordx4 v6,s[8:11],s21 offen offset:0 lds
v_mfma_f32_16x16x32_bf16 a[84:87],v[116:119],v[52:55],a[84:87]
v_exp_f32 v87,v87
v_mfma_f32_16x16x32_bf16 a[132:135],v[116:119],v[56:59],a[132:135]
ds_read_b128 v[116:119],v1 offset:12544
v_cvt_pk_bf16_f32 v27,v86,v87
v_mfma_f32_16x16x32_bf16 v[200:203],v[120:123],v[40:43],v[200:203]
v_exp_f32 v92,v92
v_smfmac_f32_16x16x64_bf16 v[60:63],v[152:155],v[20:27],v18
v_fma_f32 v101,v101,s36,v16
v_mfma_f32_16x16x32_bf16 v[248:251],v[120:123],v[44:47],v[248:251]
v_exp_f32 v93,v93
v_mfma_f32_16x16x32_bf16 a[40:43],v[120:123],v[48:51],a[40:43]
v_exp_f32 v94,v94
v_mfma_f32_16x16x32_bf16 a[88:91],v[120:123],v[52:55],a[88:91]
v_exp_f32 v95,v95
v_mfma_f32_16x16x32_bf16 a[136:139],v[120:123],v[56:59],a[136:139]
ds_read_b128 v[120:123],v0 offset:18432
v_cvt_pk_bf16_f32 v30,v92,v93
v_mfma_f32_16x16x32_bf16 v[204:207],v[124:127],v[40:43],v[204:207]
v_cvt_pk_bf16_f32 v31,v94,v95
v_fma_f32 v102,v102,s36,v16
v_mfma_f32_16x16x32_bf16 v[252:255],v[124:127],v[44:47],v[252:255]
v_fma_f32 v103,v103,s36,v16
v_fma_f32 v108,v108,s36,v17
v_mfma_f32_16x16x32_bf16 a[44:47],v[124:127],v[48:51],a[44:47]
v_exp_f32 v100,v100
v_mfma_f32_16x16x32_bf16 a[92:95],v[124:127],v[52:55],a[92:95]
buffer_load_dwordx4 v7,s[8:11],s21 offen offset:1024 lds
v_mfma_f32_16x16x32_bf16 a[140:143],v[124:127],v[56:59],a[140:143]
s_waitcnt lgkmcnt(1)
ds_read_b128 v[124:127],v1 offset:18432
v_fma_f32 v109,v109,s36,v17
v_mfma_f32_16x16x32_bf16 v[72:75],v[128:131],a[144:147],0
v_exp_f32 v101,v101
v_mfma_f32_16x16x32_bf16 v[80:83],v[128:131],a[168:171],0
v_exp_f32 v102,v102
v_mfma_f32_16x16x32_bf16 v[88:91],v[128:131],a[192:195],0
v_exp_f32 v103,v103
v_mfma_f32_16x16x32_bf16 v[96:99],v[128:131],a[216:219],0
v_cvt_pk_bf16_f32 v34,v100,v101
v_cvt_pk_bf16_f32 v35,v102,v103
v_mfma_f32_16x16x32_bf16 v[104:107],v[128:131],a[240:243],0
ds_read_b128 v[128:131],v0 offset:18560
v_fma_f32 v110,v110,s36,v17
v_smfmac_f32_16x16x64_bf16 v[64:67],v[152:155],v[28:35],v18
v_fma_f32 v111,v111,s36,v17
v_mfma_f32_16x16x32_bf16 v[72:75],v[132:135],a[148:151],v[72:75]
v_exp_f32 v108,v108
v_mfma_f32_16x16x32_bf16 v[80:83],v[132:135],a[172:175],v[80:83]
v_exp_f32 v109,v109
v_mfma_f32_16x16x32_bf16 v[88:91],v[132:135],a[196:199],v[88:91]
v_exp_f32 v110,v110
v_mfma_f32_16x16x32_bf16 v[96:99],v[132:135],a[220:223],v[96:99]
buffer_load_dwordx4 v8,s[8:11],s21 offen offset:2048 lds
v_mfma_f32_16x16x32_bf16 v[104:107],v[132:135],a[244:247],v[104:107]
s_add_u32 s21,s21,12288
v_exp_f32 v111,v111
v_mfma_f32_16x16x32_bf16 v[72:75],v[136:139],a[152:155],v[72:75]
s_add_u32 m0,s22,0
v_cvt_pk_bf16_f32 v38,v108,v109
v_cvt_pk_bf16_f32 v39,v110,v111
v_mfma_f32_16x16x32_bf16 v[80:83],v[136:139],a[176:179],v[80:83]
ds_read_b128 v[132:135],v1 offset:18560
v_smfmac_f32_16x16x64_bf16 v[68:71],v[152:155],v[32:39],v18
v_mfma_f32_16x16x32_bf16 v[88:91],v[136:139],a[200:203],v[88:91]
v_mfma_f32_16x16x32_bf16 v[96:99],v[136:139],a[224:227],v[96:99]
v_mfma_f32_16x16x32_bf16 v[104:107],v[136:139],a[248:251],v[104:107]
ds_read_b128 v[136:139],v0 offset:18688
v_mfma_f32_16x16x32_bf16 v[72:75],v[140:143],a[156:159],v[72:75]
v_mfma_f32_16x16x32_bf16 v[80:83],v[140:143],a[180:183],v[80:83]
v_mfma_f32_16x16x32_bf16 v[88:91],v[140:143],a[204:207],v[88:91]
v_mfma_f32_16x16x32_bf16 v[96:99],v[140:143],a[228:231],v[96:99]
buffer_load_dwordx4 v6,s[4:7],s20 offen offset:0 lds
v_mfma_f32_16x16x32_bf16 v[104:107],v[140:143],a[252:255],v[104:107]
ds_read_b128 v[140:143],v1 offset:18688
v_mfma_f32_16x16x32_bf16 v[72:75],v[112:115],a[160:163],v[72:75]
v_mfma_f32_16x16x32_bf16 v[80:83],v[112:115],a[184:187],v[80:83]
v_mfma_f32_16x16x32_bf16 v[88:91],v[112:115],a[208:211],v[88:91]
v_mfma_f32_16x16x32_bf16 v[96:99],v[112:115],a[232:235],v[96:99]
v_mfma_f32_16x16x32_bf16 v[104:107],v[112:115],v[144:147],v[104:107]
v_mfma_f32_16x16x32_bf16 v[72:75],v[116:119],a[164:167],v[72:75]
v_mfma_f32_16x16x32_bf16 v[80:83],v[116:119],a[188:191],v[80:83]
v_mfma_f32_16x16x32_bf16 v[88:91],v[116:119],a[212:215],v[88:91]
v_mfma_f32_16x16x32_bf16 v[96:99],v[116:119],a[236:239],v[96:99]
v_mfma_f32_16x16x32_bf16 v[104:107],v[116:119],v[148:151],v[104:107]
s_waitcnt lgkmcnt(0)
v_mfma_f32_16x16x32_bf16 v[76:79],v[120:123],a[144:147],0
buffer_load_dwordx4 v7,s[4:7],s20 offen offset:1024 lds
v_mfma_f32_16x16x32_bf16 v[84:87],v[120:123],a[168:171],0
v_mfma_f32_16x16x32_bf16 v[92:95],v[120:123],a[192:195],0
v_fma_f32 v72,v72,s36,v13
v_fma_f32 v73,v73,s36,v13
v_mfma_f32_16x16x32_bf16 v[100:103],v[120:123],a[216:219],0
v_fma_f32 v74,v74,s36,v13
v_fma_f32 v75,v75,s36,v13
v_mfma_f32_16x16x32_bf16 v[108:111],v[120:123],a[240:243],0
v_fma_f32 v80,v80,s36,v14
v_fma_f32 v81,v81,s36,v14
v_mfma_f32_16x16x32_bf16 v[76:79],v[124:127],a[148:151],v[76:79]
v_fma_f32 v82,v82,s36,v14
v_fma_f32 v83,v83,s36,v14
v_mfma_f32_16x16x32_bf16 v[84:87],v[124:127],a[172:175],v[84:87]
v_fma_f32 v88,v88,s36,v15
v_fma_f32 v89,v89,s36,v15
v_mfma_f32_16x16x32_bf16 v[92:95],v[124:127],a[196:199],v[92:95]
v_exp_f32 v72,v72
v_mfma_f32_16x16x32_bf16 v[100:103],v[124:127],a[220:223],v[100:103]
v_exp_f32 v73,v73
v_mfma_f32_16x16x32_bf16 v[108:111],v[124:127],a[244:247],v[108:111]
v_exp_f32 v74,v74
v_mfma_f32_16x16x32_bf16 v[76:79],v[128:131],a[152:155],v[76:79]
v_exp_f32 v75,v75
v_mfma_f32_16x16x32_bf16 v[84:87],v[128:131],a[176:179],v[84:87]
buffer_load_dwordx4 v8,s[4:7],s20 offen offset:2048 lds
v_mfma_f32_16x16x32_bf16 v[92:95],v[128:131],a[200:203],v[92:95]
s_add_u32 s20,s20,12288
v_exp_f32 v80,v80
v_mfma_f32_16x16x32_bf16 v[100:103],v[128:131],a[224:227],v[100:103]
v_exp_f32 v81,v81
v_mfma_f32_16x16x32_bf16 v[108:111],v[128:131],a[248:251],v[108:111]
v_exp_f32 v82,v82
v_mfma_f32_16x16x32_bf16 v[76:79],v[132:135],a[156:159],v[76:79]
v_exp_f32 v83,v83
v_mfma_f32_16x16x32_bf16 v[84:87],v[132:135],a[180:183],v[84:87]
ds_read_b64_tr_b16 v[112:113],v2 offset:0
v_mfma_f32_16x16x32_bf16 v[92:95],v[132:135],a[204:207],v[92:95]
ds_read_b64_tr_b16 v[114:115],v2 offset:6144
v_cvt_pk_bf16_f32 v40,v72,v73
v_mfma_f32_16x16x32_bf16 v[100:103],v[132:135],a[228:231],v[100:103]
v_exp_f32 v88,v88
v_mfma_f32_16x16x32_bf16 v[108:111],v[132:135],a[252:255],v[108:111]
ds_read_b64_tr_b16 v[116:117],v3 offset:0
ds_read_b64_tr_b16 v[118:119],v3 offset:6144
v_mfma_f32_16x16x32_bf16 v[76:79],v[136:139],a[160:163],v[76:79]
v_exp_f32 v89,v89
v_mfma_f32_16x16x32_bf16 v[84:87],v[136:139],a[184:187],v[84:87]
ds_read_b64_tr_b16 v[120:121],v4 offset:0
v_mfma_f32_16x16x32_bf16 v[92:95],v[136:139],a[208:211],v[92:95]
ds_read_b64_tr_b16 v[122:123],v4 offset:6144
v_cvt_pk_bf16_f32 v41,v74,v75
v_mfma_f32_16x16x32_bf16 v[100:103],v[136:139],a[232:235],v[100:103]
v_cvt_pk_bf16_f32 v44,v80,v81
v_cvt_pk_bf16_f32 v45,v82,v83
v_mfma_f32_16x16x32_bf16 v[108:111],v[136:139],v[144:147],v[108:111]
ds_read_b64_tr_b16 v[124:125],v5 offset:0
ds_read_b64_tr_b16 v[126:127],v5 offset:6144
v_mfma_f32_16x16x32_bf16 v[76:79],v[140:143],a[164:167],v[76:79]
v_cvt_pk_bf16_f32 v48,v88,v89
v_mfma_f32_16x16x32_bf16 v[84:87],v[140:143],a[188:191],v[84:87]
v_mfma_f32_16x16x32_bf16 v[92:95],v[140:143],a[212:215],v[92:95]
v_mfma_f32_16x16x32_bf16 v[100:103],v[140:143],a[236:239],v[100:103]
v_mfma_f32_16x16x32_bf16 v[108:111],v[140:143],v[148:151],v[108:111]
s_waitcnt lgkmcnt(4)
v_mfma_f32_16x16x32_bf16 v[160:163],v[112:115],v[20:23],v[160:163]
s_add_u32 m0,s23,0
ds_read_b64_tr_b16 v[128:129],v2 offset:128
ds_read_b64_tr_b16 v[130:131],v2 offset:6272
v_mfma_f32_16x16x32_bf16 v[208:211],v[112:115],v[24:27],v[208:211]
ds_read_b64_tr_b16 v[132:133],v3 offset:128
ds_read_b64_tr_b16 v[134:135],v3 offset:6272
v_mfma_f32_16x16x32_bf16 a[0:3],v[112:115],v[28:31],a[0:3]
ds_read_b64_tr_b16 v[136:137],v4 offset:128
ds_read_b64_tr_b16 v[138:139],v4 offset:6272
v_mfma_f32_16x16x32_bf16 a[48:51],v[112:115],v[32:35],a[48:51]
ds_read_b64_tr_b16 v[140:141],v5 offset:128
ds_read_b64_tr_b16 v[142:143],v5 offset:6272
v_mfma_f32_16x16x32_bf16 a[96:99],v[112:115],v[36:39],a[96:99]
ds_read_b64_tr_b16 v[112:113],v2 offset:256
ds_read_b64_tr_b16 v[114:115],v2 offset:6400
v_mfma_f32_16x16x32_bf16 v[164:167],v[116:119],v[20:23],v[164:167]
v_fma_f32 v90,v90,s36,v15
v_fma_f32 v91,v91,s36,v15
v_mfma_f32_16x16x32_bf16 v[212:215],v[116:119],v[24:27],v[212:215]
v_exp_f32 v90,v90
v_mfma_f32_16x16x32_bf16 a[4:7],v[116:119],v[28:31],a[4:7]
v_exp_f32 v91,v91
v_mfma_f32_16x16x32_bf16 a[52:55],v[116:119],v[32:35],a[52:55]
v_cvt_pk_bf16_f32 v49,v90,v91
v_fma_f32 v96,v96,s36,v16
v_mfma_f32_16x16x32_bf16 a[100:103],v[116:119],v[36:39],a[100:103]
s_waitcnt lgkmcnt(8)
ds_read_b64_tr_b16 v[116:117],v3 offset:256
ds_read_b64_tr_b16 v[118:119],v3 offset:6400
v_mfma_f32_16x16x32_bf16 v[168:171],v[120:123],v[20:23],v[168:171]
v_fma_f32 v97,v97,s36,v16
v_fma_f32 v98,v98,s36,v16
v_mfma_f32_16x16x32_bf16 v[216:219],v[120:123],v[24:27],v[216:219]
v_fma_f32 v99,v99,s36,v16
v_fma_f32 v104,v104,s36,v17
v_mfma_f32_16x16x32_bf16 a[8:11],v[120:123],v[28:31],a[8:11]
v_exp_f32 v96,v96
v_mfma_f32_16x16x32_bf16 a[56:59],v[120:123],v[32:35],a[56:59]
v_exp_f32 v97,v97
v_mfma_f32_16x16x32_bf16 a[104:107],v[120:123],v[36:39],a[104:107]
ds_read_b64_tr_b16 v[120:121],v4 offset:256
ds_read_b64_tr_b16 v[122:123],v4 offset:6400
v_mfma_f32_16x16x32_bf16 v[172:175],v[124:127],v[20:23],v[172:175]
v_exp_f32 v98,v98
v_mfma_f32_16x16x32_bf16 v[220:223],v[124:127],v[24:27],v[220:223]
v_exp_f32 v99,v99
v_mfma_f32_16x16x32_bf16 a[12:15],v[124:127],v[28:31],a[12:15]
v_cvt_pk_bf16_f32 v52,v96,v97
v_cvt_pk_bf16_f32 v53,v98,v99
v_mfma_f32_16x16x32_bf16 a[60:63],v[124:127],v[32:35],a[60:63]
v_fma_f32 v105,v105,s36,v17
v_fma_f32 v106,v106,s36,v17
v_mfma_f32_16x16x32_bf16 a[108:111],v[124:127],v[36:39],a[108:111]
ds_read_b64_tr_b16 v[124:125],v5 offset:256
ds_read_b64_tr_b16 v[126:127],v5 offset:6400
v_mfma_f32_16x16x32_bf16 v[176:179],v[128:131],v[20:23],v[176:179]
v_fma_f32 v107,v107,s36,v17
v_fma_f32 v76,v76,s36,v13
v_mfma_f32_16x16x32_bf16 v[224:227],v[128:131],v[24:27],v[224:227]
v_exp_f32 v104,v104
v_mfma_f32_16x16x32_bf16 a[16:19],v[128:131],v[28:31],a[16:19]
v_exp_f32 v105,v105
v_mfma_f32_16x16x32_bf16 a[64:67],v[128:131],v[32:35],a[64:67]
v_exp_f32 v106,v106
v_mfma_f32_16x16x32_bf16 a[112:115],v[128:131],v[36:39],a[112:115]
s_waitcnt lgkmcnt(2)
v_exp_f32 v107,v107
v_mfma_f32_16x16x32_bf16 v[180:183],v[132:135],v[20:23],v[180:183]
v_cvt_pk_bf16_f32 v56,v104,v105
v_cvt_pk_bf16_f32 v57,v106,v107
v_mfma_f32_16x16x32_bf16 v[228:231],v[132:135],v[24:27],v[228:231]
v_fma_f32 v77,v77,s36,v13
v_fma_f32 v78,v78,s36,v13
v_mfma_f32_16x16x32_bf16 a[20:23],v[132:135],v[28:31],a[20:23]
v_fma_f32 v79,v79,s36,v13
v_fma_f32 v84,v84,s36,v14
v_mfma_f32_16x16x32_bf16 a[68:71],v[132:135],v[32:35],a[68:71]
v_exp_f32 v76,v76
v_mfma_f32_16x16x32_bf16 a[116:119],v[132:135],v[36:39],a[116:119]
v_exp_f32 v77,v77
v_mfma_f32_16x16x32_bf16 v[184:187],v[136:139],v[20:23],v[184:187]
v_exp_f32 v78,v78
v_mfma_f32_16x16x32_bf16 v[232:235],v[136:139],v[24:27],v[232:235]
v_exp_f32 v79,v79
v_mfma_f32_16x16x32_bf16 a[24:27],v[136:139],v[28:31],a[24:27]
v_cvt_pk_bf16_f32 v42,v76,v77
v_cvt_pk_bf16_f32 v43,v78,v79
v_mfma_f32_16x16x32_bf16 a[72:75],v[136:139],v[32:35],a[72:75]
v_fma_f32 v85,v85,s36,v14
v_fma_f32 v86,v86,s36,v14
v_mfma_f32_16x16x32_bf16 a[120:123],v[136:139],v[36:39],a[120:123]
v_fma_f32 v87,v87,s36,v14
v_fma_f32 v92,v92,s36,v15
v_mfma_f32_16x16x32_bf16 v[188:191],v[140:143],v[20:23],v[188:191]
v_exp_f32 v84,v84
v_mfma_f32_16x16x32_bf16 v[236:239],v[140:143],v[24:27],v[236:239]
v_exp_f32 v85,v85
v_mfma_f32_16x16x32_bf16 a[28:31],v[140:143],v[28:31],a[28:31]
v_exp_f32 v86,v86
v_mfma_f32_16x16x32_bf16 a[76:79],v[140:143],v[32:35],a[76:79]
v_exp_f32 v87,v87
v_mfma_f32_16x16x32_bf16 a[124:127],v[140:143],v[36:39],a[124:127]
v_cvt_pk_bf16_f32 v46,v84,v85
v_cvt_pk_bf16_f32 v47,v86,v87
v_mfma_f32_16x16x32_bf16 v[192:195],v[112:115],v[20:23],v[192:195]
v_fma_f32 v93,v93,s36,v15
v_fma_f32 v94,v94,s36,v15
v_smfmac_f32_16x16x64_bf16 v[60:63],v[152:155],v[40:47],v18
v_fma_f32 v95,v95,s36,v15
s_waitcnt vmcnt(9) lgkmcnt(0)
v_mfma_f32_16x16x32_bf16 v[240:243],v[112:115],v[24:27],v[240:243]
s_barrier
v_mfma_f32_16x16x32_bf16 a[32:35],v[112:115],v[28:31],a[32:35]
ds_read_b128 v[128:131],v0 offset:24576
v_fma_f32 v100,v100,s36,v16
v_mfma_f32_16x16x32_bf16 a[80:83],v[112:115],v[32:35],a[80:83]
ds_read_b128 v[132:135],v1 offset:24576
v_fma_f32 v101,v101,s36,v16
v_mfma_f32_16x16x32_bf16 a[128:131],v[112:115],v[36:39],a[128:131]
ds_read_b128 v[136:139],v0 offset:24704
v_fma_f32 v102,v102,s36,v16
v_mfma_f32_16x16x32_bf16 v[196:199],v[116:119],v[20:23],v[196:199]
ds_read_b128 v[140:143],v1 offset:24704
v_fma_f32 v103,v103,s36,v16
v_mfma_f32_16x16x32_bf16 v[244:247],v[116:119],v[24:27],v[244:247]
ds_read_b128 v[156:159],v10 offset:6144
v_fma_f32 v108,v108,s36,v17
v_mfma_f32_16x16x32_bf16 a[36:39],v[116:119],v[28:31],a[36:39]
buffer_load_dwordx4 v6,s[8:11],s21 offen offset:0 lds
v_mfma_f32_16x16x32_bf16 a[84:87],v[116:119],v[32:35],a[84:87]
ds_read_b128 v[112:115],v0 offset:24832
v_fma_f32 v109,v109,s36,v17
v_mfma_f32_16x16x32_bf16 a[132:135],v[116:119],v[36:39],a[132:135]
ds_read_b128 v[116:119],v1 offset:24832
v_fma_f32 v110,v110,s36,v17
v_mfma_f32_16x16x32_bf16 v[200:203],v[120:123],v[20:23],v[200:203]
v_exp_f32 v92,v92
v_mfma_f32_16x16x32_bf16 v[248:251],v[120:123],v[24:27],v[248:251]
v_exp_f32 v93,v93
v_mfma_f32_16x16x32_bf16 a[40:43],v[120:123],v[28:31],a[40:43]
v_exp_f32 v94,v94
v_mfma_f32_16x16x32_bf16 a[88:91],v[120:123],v[32:35],a[88:91]
v_exp_f32 v95,v95
v_mfma_f32_16x16x32_bf16 a[136:139],v[120:123],v[36:39],a[136:139]
ds_read_b128 v[120:123],v0 offset:30720
v_cvt_pk_bf16_f32 v50,v92,v93
v_mfma_f32_16x16x32_bf16 v[204:207],v[124:127],v[20:23],v[204:207]
v_cvt_pk_bf16_f32 v51,v94,v95
v_fma_f32 v111,v111,s36,v17
v_mfma_f32_16x16x32_bf16 v[252:255],v[124:127],v[24:27],v[252:255]
v_exp_f32 v100,v100
v_mfma_f32_16x16x32_bf16 a[44:47],v[124:127],v[28:31],a[44:47]
v_exp_f32 v101,v101
v_mfma_f32_16x16x32_bf16 a[92:95],v[124:127],v[32:35],a[92:95]
v_exp_f32 v102,v102
v_mfma_f32_16x16x32_bf16 a[140:143],v[124:127],v[36:39],a[140:143]
s_waitcnt lgkmcnt(1)
buffer_store_dwordx4 v[156:159],v9,s[16:19],s27 offen offset:0 nt
buffer_load_dwordx4 v7,s[8:11],s21 offen offset:1024 lds
v_mfma_f32_16x16x32_bf16 v[72:75],v[128:131],a[144:147],0
ds_read_b128 v[124:127],v1 offset:30720
v_cvt_pk_bf16_f32 v54,v100,v101
v_mfma_f32_16x16x32_bf16 v[80:83],v[128:131],a[168:171],0
v_exp_f32 v103,v103
v_mfma_f32_16x16x32_bf16 v[88:91],v[128:131],a[192:195],0
v_cvt_pk_bf16_f32 v55,v102,v103
v_mfma_f32_16x16x32_bf16 v[96:99],v[128:131],a[216:219],0
v_exp_f32 v108,v108
v_smfmac_f32_16x16x64_bf16 v[64:67],v[152:155],v[48:55],v18
v_mfma_f32_16x16x32_bf16 v[104:107],v[128:131],a[240:243],0
ds_read_b128 v[156:159],v10 offset:7168
v_mfma_f32_16x16x32_bf16 v[72:75],v[132:135],a[148:151],v[72:75]
ds_read_b128 v[128:131],v0 offset:30848
v_mfma_f32_16x16x32_bf16 v[80:83],v[132:135],a[172:175],v[80:83]
v_exp_f32 v109,v109
v_mfma_f32_16x16x32_bf16 v[88:91],v[132:135],a[196:199],v[88:91]
v_exp_f32 v110,v110
v_mfma_f32_16x16x32_bf16 v[96:99],v[132:135],a[220:223],v[96:99]
buffer_load_dwordx4 v8,s[8:11],s21 offen offset:2048 lds
v_mfma_f32_16x16x32_bf16 v[104:107],v[132:135],a[244:247],v[104:107]
s_add_u32 s21,s21,12288
v_exp_f32 v111,v111
v_mfma_f32_16x16x32_bf16 v[72:75],v[136:139],a[152:155],v[72:75]
s_cmp_eq_u32 s38,1
v_cvt_pk_bf16_f32 v58,v108,v109
v_cvt_pk_bf16_f32 v59,v110,v111
v_mfma_f32_16x16x32_bf16 v[80:83],v[136:139],a[176:179],v[80:83]
s_cselect_b32 s20,s26,s20
ds_read_b128 v[132:135],v1 offset:30848
v_smfmac_f32_16x16x64_bf16 v[68:71],v[152:155],v[52:59],v18
s_add_u32 m0,s22,12288
v_mfma_f32_16x16x32_bf16 v[88:91],v[136:139],a[200:203],v[88:91]
v_mfma_f32_16x16x32_bf16 v[96:99],v[136:139],a[224:227],v[96:99]
v_mfma_f32_16x16x32_bf16 v[104:107],v[136:139],a[248:251],v[104:107]
ds_read_b128 v[136:139],v0 offset:30976
v_mfma_f32_16x16x32_bf16 v[72:75],v[140:143],a[156:159],v[72:75]
v_mfma_f32_16x16x32_bf16 v[80:83],v[140:143],a[180:183],v[80:83]
v_mfma_f32_16x16x32_bf16 v[88:91],v[140:143],a[204:207],v[88:91]
v_mfma_f32_16x16x32_bf16 v[96:99],v[140:143],a[228:231],v[96:99]
v_mfma_f32_16x16x32_bf16 v[104:107],v[140:143],a[252:255],v[104:107]
s_waitcnt lgkmcnt(1)
buffer_store_dwordx4 v[156:159],v9,s[16:19],s27 offen offset:128 nt
buffer_load_dwordx4 v6,s[4:7],s20 offen offset:0 lds
v_mfma_f32_16x16x32_bf16 v[72:75],v[112:115],a[160:163],v[72:75]
ds_read_b128 v[140:143],v1 offset:30976
v_mfma_f32_16x16x32_bf16 v[80:83],v[112:115],a[184:187],v[80:83]
v_mfma_f32_16x16x32_bf16 v[88:91],v[112:115],a[208:211],v[88:91]
v_mfma_f32_16x16x32_bf16 v[96:99],v[112:115],a[232:235],v[96:99]
v_mfma_f32_16x16x32_bf16 v[104:107],v[112:115],v[144:147],v[104:107]
v_mfma_f32_16x16x32_bf16 v[72:75],v[116:119],a[164:167],v[72:75]
ds_read_b128 v[156:159],v10 offset:8192
v_mfma_f32_16x16x32_bf16 v[80:83],v[116:119],a[188:191],v[80:83]
v_mfma_f32_16x16x32_bf16 v[88:91],v[116:119],a[212:215],v[88:91]
v_mfma_f32_16x16x32_bf16 v[96:99],v[116:119],a[236:239],v[96:99]
v_mfma_f32_16x16x32_bf16 v[104:107],v[116:119],v[148:151],v[104:107]
buffer_load_dwordx4 v7,s[4:7],s20 offen offset:1024 lds
v_mfma_f32_16x16x32_bf16 v[76:79],v[120:123],a[144:147],0
v_mfma_f32_16x16x32_bf16 v[84:87],v[120:123],a[168:171],0
v_fma_f32 v72,v72,s36,v13
v_fma_f32 v73,v73,s36,v13
v_mfma_f32_16x16x32_bf16 v[92:95],v[120:123],a[192:195],0
v_fma_f32 v74,v74,s36,v13
v_fma_f32 v75,v75,s36,v13
v_mfma_f32_16x16x32_bf16 v[100:103],v[120:123],a[216:219],0
v_fma_f32 v80,v80,s36,v14
v_fma_f32 v81,v81,s36,v14
v_mfma_f32_16x16x32_bf16 v[108:111],v[120:123],a[240:243],0
v_fma_f32 v82,v82,s36,v14
v_fma_f32 v83,v83,s36,v14
v_mfma_f32_16x16x32_bf16 v[76:79],v[124:127],a[148:151],v[76:79]
v_fma_f32 v88,v88,s36,v15
v_fma_f32 v89,v89,s36,v15
v_mfma_f32_16x16x32_bf16 v[84:87],v[124:127],a[172:175],v[84:87]
v_exp_f32 v72,v72
v_mfma_f32_16x16x32_bf16 v[92:95],v[124:127],a[196:199],v[92:95]
v_exp_f32 v73,v73
v_mfma_f32_16x16x32_bf16 v[100:103],v[124:127],a[220:223],v[100:103]
v_exp_f32 v74,v74
v_mfma_f32_16x16x32_bf16 v[108:111],v[124:127],a[244:247],v[108:111]
v_exp_f32 v75,v75
v_mfma_f32_16x16x32_bf16 v[76:79],v[128:131],a[152:155],v[76:79]
v_exp_f32 v80,v80
v_mfma_f32_16x16x32_bf16 v[84:87],v[128:131],a[176:179],v[84:87]
s_waitcnt lgkmcnt(0)
buffer_store_dwordx4 v[156:159],v9,s[16:19],s27 offen offset:256 nt
buffer_load_dwordx4 v8,s[4:7],s20 offen offset:2048 lds
v_mfma_f32_16x16x32_bf16 v[92:95],v[128:131],a[200:203],v[92:95]
s_add_u32 s20,s20,12288
v_exp_f32 v81,v81
v_mfma_f32_16x16x32_bf16 v[100:103],v[128:131],a[224:227],v[100:103]
s_add_u32 s27,s27,3072
v_exp_f32 v82,v82
v_mfma_f32_16x16x32_bf16 v[108:111],v[128:131],a[248:251],v[108:111]
v_exp_f32 v83,v83
v_mfma_f32_16x16x32_bf16 v[76:79],v[132:135],a[156:159],v[76:79]
v_exp_f32 v88,v88
v_mfma_f32_16x16x32_bf16 v[84:87],v[132:135],a[180:183],v[84:87]
ds_read_b64_tr_b16 v[112:113],v2 offset:12288
ds_read_b64_tr_b16 v[114:115],v2 offset:18432
v_mfma_f32_16x16x32_bf16 v[92:95],v[132:135],a[204:207],v[92:95]
v_exp_f32 v89,v89
v_mfma_f32_16x16x32_bf16 v[100:103],v[132:135],a[228:231],v[100:103]
ds_read_b64_tr_b16 v[116:117],v3 offset:12288
ds_read_b64_tr_b16 v[118:119],v3 offset:18432
v_mfma_f32_16x16x32_bf16 v[108:111],v[132:135],a[252:255],v[108:111]
v_cvt_pk_bf16_f32 v20,v72,v73
v_cvt_pk_bf16_f32 v21,v74,v75
v_mfma_f32_16x16x32_bf16 v[76:79],v[136:139],a[160:163],v[76:79]
v_cvt_pk_bf16_f32 v24,v80,v81
v_cvt_pk_bf16_f32 v25,v82,v83
v_mfma_f32_16x16x32_bf16 v[84:87],v[136:139],a[184:187],v[84:87]
ds_read_b64_tr_b16 v[120:121],v4 offset:12288
ds_read_b64_tr_b16 v[122:123],v4 offset:18432
v_mfma_f32_16x16x32_bf16 v[92:95],v[136:139],a[208:211],v[92:95]
v_cvt_pk_bf16_f32 v28,v88,v89
v_mfma_f32_16x16x32_bf16 v[100:103],v[136:139],a[232:235],v[100:103]
ds_read_b64_tr_b16 v[124:125],v5 offset:12288
ds_read_b64_tr_b16 v[126:127],v5 offset:18432
v_mfma_f32_16x16x32_bf16 v[108:111],v[136:139],v[144:147],v[108:111]
v_mfma_f32_16x16x32_bf16 v[76:79],v[140:143],a[164:167],v[76:79]
v_mfma_f32_16x16x32_bf16 v[84:87],v[140:143],a[188:191],v[84:87]
v_mfma_f32_16x16x32_bf16 v[92:95],v[140:143],a[212:215],v[92:95]
v_mfma_f32_16x16x32_bf16 v[100:103],v[140:143],a[236:239],v[100:103]
v_mfma_f32_16x16x32_bf16 v[108:111],v[140:143],v[148:151],v[108:111]
s_waitcnt lgkmcnt(4)
v_mfma_f32_16x16x32_bf16 v[160:163],v[112:115],v[40:43],v[160:163]
s_add_u32 m0,s29,0
ds_read_b64_tr_b16 v[128:129],v2 offset:12416
ds_read_b64_tr_b16 v[130:131],v2 offset:18560
v_mfma_f32_16x16x32_bf16 v[208:211],v[112:115],v[44:47],v[208:211]
ds_read_b64_tr_b16 v[132:133],v3 offset:12416
ds_read_b64_tr_b16 v[134:135],v3 offset:18560
v_mfma_f32_16x16x32_bf16 a[0:3],v[112:115],v[48:51],a[0:3]
ds_read_b64_tr_b16 v[136:137],v4 offset:12416
ds_read_b64_tr_b16 v[138:139],v4 offset:18560
v_mfma_f32_16x16x32_bf16 a[48:51],v[112:115],v[52:55],a[48:51]
ds_read_b64_tr_b16 v[140:141],v5 offset:12416
ds_read_b64_tr_b16 v[142:143],v5 offset:18560
v_mfma_f32_16x16x32_bf16 a[96:99],v[112:115],v[56:59],a[96:99]
ds_read_b64_tr_b16 v[112:113],v2 offset:12544
ds_read_b64_tr_b16 v[114:115],v2 offset:18688
v_mfma_f32_16x16x32_bf16 v[164:167],v[116:119],v[40:43],v[164:167]
v_fma_f32 v90,v90,s36,v15
v_fma_f32 v91,v91,s36,v15
v_mfma_f32_16x16x32_bf16 v[212:215],v[116:119],v[44:47],v[212:215]
v_exp_f32 v90,v90
v_mfma_f32_16x16x32_bf16 a[4:7],v[116:119],v[48:51],a[4:7]
buffer_load_dwordx4 v6,s[12:15],s28 offen offset:0 nt lds
v_mfma_f32_16x16x32_bf16 a[52:55],v[116:119],v[52:55],a[52:55]
v_exp_f32 v91,v91
v_mfma_f32_16x16x32_bf16 a[100:103],v[116:119],v[56:59],a[100:103]
s_waitcnt lgkmcnt(7)
ds_read_b64_tr_b16 v[116:117],v3 offset:12544
ds_read_b64_tr_b16 v[118:119],v3 offset:18688
v_mfma_f32_16x16x32_bf16 v[168:171],v[120:123],v[40:43],v[168:171]
v_cvt_pk_bf16_f32 v29,v90,v91
v_fma_f32 v96,v96,s36,v16
v_mfma_f32_16x16x32_bf16 v[216:219],v[120:123],v[44:47],v[216:219]
v_fma_f32 v97,v97,s36,v16
v_fma_f32 v98,v98,s36,v16
v_mfma_f32_16x16x32_bf16 a[8:11],v[120:123],v[48:51],a[8:11]
v_fma_f32 v99,v99,s36,v16
v_fma_f32 v104,v104,s36,v17
v_mfma_f32_16x16x32_bf16 a[56:59],v[120:123],v[52:55],a[56:59]
v_exp_f32 v96,v96
v_mfma_f32_16x16x32_bf16 a[104:107],v[120:123],v[56:59],a[104:107]
ds_read_b64_tr_b16 v[120:121],v4 offset:12544
ds_read_b64_tr_b16 v[122:123],v4 offset:18688
v_mfma_f32_16x16x32_bf16 v[172:175],v[124:127],v[40:43],v[172:175]
v_exp_f32 v97,v97
v_mfma_f32_16x16x32_bf16 v[220:223],v[124:127],v[44:47],v[220:223]
v_exp_f32 v98,v98
v_mfma_f32_16x16x32_bf16 a[12:15],v[124:127],v[48:51],a[12:15]
buffer_load_dwordx4 v7,s[12:15],s28 offen offset:1024 nt lds
v_mfma_f32_16x16x32_bf16 a[60:63],v[124:127],v[52:55],a[60:63]
v_exp_f32 v99,v99
v_mfma_f32_16x16x32_bf16 a[108:111],v[124:127],v[56:59],a[108:111]
ds_read_b64_tr_b16 v[124:125],v5 offset:12544
ds_read_b64_tr_b16 v[126:127],v5 offset:18688
v_mfma_f32_16x16x32_bf16 v[176:179],v[128:131],v[40:43],v[176:179]
v_cvt_pk_bf16_f32 v32,v96,v97
v_cvt_pk_bf16_f32 v33,v98,v99
v_mfma_f32_16x16x32_bf16 v[224:227],v[128:131],v[44:47],v[224:227]
v_fma_f32 v105,v105,s36,v17
v_fma_f32 v106,v106,s36,v17
v_mfma_f32_16x16x32_bf16 a[16:19],v[128:131],v[48:51],a[16:19]
v_fma_f32 v107,v107,s36,v17
v_fma_f32 v76,v76,s36,v13
v_mfma_f32_16x16x32_bf16 a[64:67],v[128:131],v[52:55],a[64:67]
v_exp_f32 v104,v104
v_mfma_f32_16x16x32_bf16 a[112:115],v[128:131],v[56:59],a[112:115]
s_waitcnt lgkmcnt(2)
v_exp_f32 v105,v105
v_mfma_f32_16x16x32_bf16 v[180:183],v[132:135],v[40:43],v[180:183]
v_exp_f32 v106,v106
v_mfma_f32_16x16x32_bf16 v[228:231],v[132:135],v[44:47],v[228:231]
v_exp_f32 v107,v107
v_mfma_f32_16x16x32_bf16 a[20:23],v[132:135],v[48:51],a[20:23]
buffer_load_dwordx4 v8,s[12:15],s28 offen offset:2048 nt lds
v_mfma_f32_16x16x32_bf16 a[68:71],v[132:135],v[52:55],a[68:71]
s_add_u32 s28,s28,3072
v_cvt_pk_bf16_f32 v36,v104,v105
v_cvt_pk_bf16_f32 v37,v106,v107
v_mfma_f32_16x16x32_bf16 a[116:119],v[132:135],v[56:59],a[116:119]
s_add_u32 s29,s29,3072
v_fma_f32 v77,v77,s36,v13
v_fma_f32 v78,v78,s36,v13
v_mfma_f32_16x16x32_bf16 v[184:187],v[136:139],v[40:43],v[184:187]
s_cmp_eq_u32 s38,1
v_fma_f32 v79,v79,s36,v13
v_fma_f32 v84,v84,s36,v14
v_mfma_f32_16x16x32_bf16 v[232:235],v[136:139],v[44:47],v[232:235]
s_cselect_b32 s21,s26,s21
v_exp_f32 v76,v76
v_mfma_f32_16x16x32_bf16 a[24:27],v[136:139],v[48:51],a[24:27]
s_add_u32 m0,s23,12288
v_exp_f32 v77,v77
v_mfma_f32_16x16x32_bf16 a[72:75],v[136:139],v[52:55],a[72:75]
v_exp_f32 v78,v78
v_mfma_f32_16x16x32_bf16 a[120:123],v[136:139],v[56:59],a[120:123]
v_exp_f32 v79,v79
v_mfma_f32_16x16x32_bf16 v[188:191],v[140:143],v[40:43],v[188:191]
v_cvt_pk_bf16_f32 v22,v76,v77
v_cvt_pk_bf16_f32 v23,v78,v79
v_mfma_f32_16x16x32_bf16 v[236:239],v[140:143],v[44:47],v[236:239]
v_fma_f32 v85,v85,s36,v14
v_fma_f32 v86,v86,s36,v14
v_mfma_f32_16x16x32_bf16 a[28:31],v[140:143],v[48:51],a[28:31]
v_fma_f32 v87,v87,s36,v14
v_fma_f32 v92,v92,s36,v15
v_mfma_f32_16x16x32_bf16 a[76:79],v[140:143],v[52:55],a[76:79]
v_exp_f32 v84,v84
v_mfma_f32_16x16x32_bf16 a[124:127],v[140:143],v[56:59],a[124:127]
v_exp_f32 v85,v85
v_mfma_f32_16x16x32_bf16 v[192:195],v[112:115],v[40:43],v[192:195]
v_exp_f32 v86,v86
s_waitcnt vmcnt(12) lgkmcnt(0)
v_mfma_f32_16x16x32_bf16 v[240:243],v[112:115],v[44:47],v[240:243]
s_barrier
v_mfma_f32_16x16x32_bf16 a[32:35],v[112:115],v[48:51],a[32:35]
ds_read_b128 v[128:131],v0 offset:0
v_cvt_pk_bf16_f32 v26,v84,v85
v_mfma_f32_16x16x32_bf16 a[80:83],v[112:115],v[52:55],a[80:83]
ds_read_b128 v[132:135],v1 offset:0
v_fma_f32 v93,v93,s36,v15
v_mfma_f32_16x16x32_bf16 a[128:131],v[112:115],v[56:59],a[128:131]
ds_read_b128 v[136:139],v0 offset:128
v_fma_f32 v94,v94,s36,v15
v_mfma_f32_16x16x32_bf16 v[196:199],v[116:119],v[40:43],v[196:199]
ds_read_b128 v[140:143],v1 offset:128
v_fma_f32 v95,v95,s36,v15
v_mfma_f32_16x16x32_bf16 v[244:247],v[116:119],v[44:47],v[244:247]
ds_read_b128 v[112:115],v0 offset:256
v_fma_f32 v100,v100,s36,v16
v_mfma_f32_16x16x32_bf16 a[36:39],v[116:119],v[48:51],a[36:39]
buffer_load_dwordx4 v6,s[8:11],s21 offen offset:0 lds
v_mfma_f32_16x16x32_bf16 a[84:87],v[116:119],v[52:55],a[84:87]
v_exp_f32 v87,v87
v_mfma_f32_16x16x32_bf16 a[132:135],v[116:119],v[56:59],a[132:135]
ds_read_b128 v[116:119],v1 offset:256
v_cvt_pk_bf16_f32 v27,v86,v87
v_mfma_f32_16x16x32_bf16 v[200:203],v[120:123],v[40:43],v[200:203]
v_exp_f32 v92,v92
v_smfmac_f32_16x16x64_bf16 v[60:63],v[152:155],v[20:27],v18
v_fma_f32 v101,v101,s36,v16
v_mfma_f32_16x16x32_bf16 v[248:251],v[120:123],v[44:47],v[248:251]
v_exp_f32 v93,v93
v_mfma_f32_16x16x32_bf16 a[40:43],v[120:123],v[48:51],a[40:43]
v_exp_f32 v94,v94
v_mfma_f32_16x16x32_bf16 a[88:91],v[120:123],v[52:55],a[88:91]
v_exp_f32 v95,v95
v_mfma_f32_16x16x32_bf16 a[136:139],v[120:123],v[56:59],a[136:139]
ds_read_b128 v[120:123],v0 offset:6144
v_cvt_pk_bf16_f32 v30,v92,v93
v_mfma_f32_16x16x32_bf16 v[204:207],v[124:127],v[40:43],v[204:207]
v_cvt_pk_bf16_f32 v31,v94,v95
v_fma_f32 v102,v102,s36,v16
v_mfma_f32_16x16x32_bf16 v[252:255],v[124:127],v[44:47],v[252:255]
v_fma_f32 v103,v103,s36,v16
v_fma_f32 v108,v108,s36,v17
v_mfma_f32_16x16x32_bf16 a[44:47],v[124:127],v[48:51],a[44:47]
v_exp_f32 v100,v100
v_mfma_f32_16x16x32_bf16 a[92:95],v[124:127],v[52:55],a[92:95]
buffer_load_dwordx4 v7,s[8:11],s21 offen offset:1024 lds
v_mfma_f32_16x16x32_bf16 a[140:143],v[124:127],v[56:59],a[140:143]
s_waitcnt lgkmcnt(1)
ds_read_b128 v[124:127],v1 offset:6144
v_fma_f32 v109,v109,s36,v17
v_mfma_f32_16x16x32_bf16 v[72:75],v[128:131],a[144:147],0
v_exp_f32 v101,v101
v_mfma_f32_16x16x32_bf16 v[80:83],v[128:131],a[168:171],0
v_exp_f32 v102,v102
v_mfma_f32_16x16x32_bf16 v[88:91],v[128:131],a[192:195],0
v_exp_f32 v103,v103
v_mfma_f32_16x16x32_bf16 v[96:99],v[128:131],a[216:219],0
v_cvt_pk_bf16_f32 v34,v100,v101
v_cvt_pk_bf16_f32 v35,v102,v103
v_mfma_f32_16x16x32_bf16 v[104:107],v[128:131],a[240:243],0
ds_read_b128 v[128:131],v0 offset:6272
v_fma_f32 v110,v110,s36,v17
v_smfmac_f32_16x16x64_bf16 v[64:67],v[152:155],v[28:35],v18
v_fma_f32 v111,v111,s36,v17
v_mfma_f32_16x16x32_bf16 v[72:75],v[132:135],a[148:151],v[72:75]
v_exp_f32 v108,v108
v_mfma_f32_16x16x32_bf16 v[80:83],v[132:135],a[172:175],v[80:83]
v_exp_f32 v109,v109
v_mfma_f32_16x16x32_bf16 v[88:91],v[132:135],a[196:199],v[88:91]
v_exp_f32 v110,v110
v_mfma_f32_16x16x32_bf16 v[96:99],v[132:135],a[220:223],v[96:99]
buffer_load_dwordx4 v8,s[8:11],s21 offen offset:2048 lds
v_mfma_f32_16x16x32_bf16 v[104:107],v[132:135],a[244:247],v[104:107]
s_add_u32 s21,s21,12288
v_exp_f32 v111,v111
v_mfma_f32_16x16x32_bf16 v[72:75],v[136:139],a[152:155],v[72:75]
s_add_u32 m0,s22,24576
v_cvt_pk_bf16_f32 v38,v108,v109
v_cvt_pk_bf16_f32 v39,v110,v111
v_mfma_f32_16x16x32_bf16 v[80:83],v[136:139],a[176:179],v[80:83]
ds_read_b128 v[132:135],v1 offset:6272
v_add_u32 v10,9216,v10
v_smfmac_f32_16x16x64_bf16 v[68:71],v[152:155],v[32:39],v18
v_mfma_f32_16x16x32_bf16 v[88:91],v[136:139],a[200:203],v[88:91]
v_mfma_f32_16x16x32_bf16 v[96:99],v[136:139],a[224:227],v[96:99]
v_mfma_f32_16x16x32_bf16 v[104:107],v[136:139],a[248:251],v[104:107]
ds_read_b128 v[136:139],v0 offset:6400
v_mfma_f32_16x16x32_bf16 v[72:75],v[140:143],a[156:159],v[72:75]
v_mfma_f32_16x16x32_bf16 v[80:83],v[140:143],a[180:183],v[80:83]
v_mfma_f32_16x16x32_bf16 v[88:91],v[140:143],a[204:207],v[88:91]
v_mfma_f32_16x16x32_bf16 v[96:99],v[140:143],a[228:231],v[96:99]
buffer_load_dwordx4 v6,s[4:7],s20 offen offset:0 lds
v_mfma_f32_16x16x32_bf16 v[104:107],v[140:143],a[252:255],v[104:107]
ds_read_b128 v[140:143],v1 offset:6400
v_mfma_f32_16x16x32_bf16 v[72:75],v[112:115],a[160:163],v[72:75]
v_mfma_f32_16x16x32_bf16 v[80:83],v[112:115],a[184:187],v[80:83]
v_mfma_f32_16x16x32_bf16 v[88:91],v[112:115],a[208:211],v[88:91]
v_mfma_f32_16x16x32_bf16 v[96:99],v[112:115],a[232:235],v[96:99]
v_mfma_f32_16x16x32_bf16 v[104:107],v[112:115],v[144:147],v[104:107]
v_mfma_f32_16x16x32_bf16 v[72:75],v[116:119],a[164:167],v[72:75]
v_mfma_f32_16x16x32_bf16 v[80:83],v[116:119],a[188:191],v[80:83]
v_mfma_f32_16x16x32_bf16 v[88:91],v[116:119],a[212:215],v[88:91]
v_mfma_f32_16x16x32_bf16 v[96:99],v[116:119],a[236:239],v[96:99]
v_mfma_f32_16x16x32_bf16 v[104:107],v[116:119],v[148:151],v[104:107]
s_waitcnt lgkmcnt(0)
v_mfma_f32_16x16x32_bf16 v[76:79],v[120:123],a[144:147],0
buffer_load_dwordx4 v7,s[4:7],s20 offen offset:1024 lds
v_mfma_f32_16x16x32_bf16 v[84:87],v[120:123],a[168:171],0
v_mfma_f32_16x16x32_bf16 v[92:95],v[120:123],a[192:195],0
v_fma_f32 v72,v72,s36,v13
v_fma_f32 v73,v73,s36,v13
v_mfma_f32_16x16x32_bf16 v[100:103],v[120:123],a[216:219],0
v_fma_f32 v74,v74,s36,v13
v_fma_f32 v75,v75,s36,v13
v_mfma_f32_16x16x32_bf16 v[108:111],v[120:123],a[240:243],0
v_fma_f32 v80,v80,s36,v14
v_fma_f32 v81,v81,s36,v14
v_mfma_f32_16x16x32_bf16 v[76:79],v[124:127],a[148:151],v[76:79]
v_fma_f32 v82,v82,s36,v14
v_fma_f32 v83,v83,s36,v14
v_mfma_f32_16x16x32_bf16 v[84:87],v[124:127],a[172:175],v[84:87]
v_fma_f32 v88,v88,s36,v15
v_fma_f32 v89,v89,s36,v15
v_mfma_f32_16x16x32_bf16 v[92:95],v[124:127],a[196:199],v[92:95]
v_exp_f32 v72,v72
v_mfma_f32_16x16x32_bf16 v[100:103],v[124:127],a[220:223],v[100:103]
v_exp_f32 v73,v73
v_mfma_f32_16x16x32_bf16 v[108:111],v[124:127],a[244:247],v[108:111]
v_exp_f32 v74,v74
v_mfma_f32_16x16x32_bf16 v[76:79],v[128:131],a[152:155],v[76:79]
v_exp_f32 v75,v75
v_mfma_f32_16x16x32_bf16 v[84:87],v[128:131],a[176:179],v[84:87]
buffer_load_dwordx4 v8,s[4:7],s20 offen offset:2048 lds
v_mfma_f32_16x16x32_bf16 v[92:95],v[128:131],a[200:203],v[92:95]
s_add_u32 s20,s20,12288
s_add_u32 s38,s38,1
s_cmp_lt_u32 s38,2
v_mfma_f32_16x16x32_bf16 v[100:103],v[128:131],a[224:227],v[100:103]
v_exp_f32 v80,v80
v_mfma_f32_16x16x32_bf16 v[108:111],v[128:131],a[248:251],v[108:111]
v_exp_f32 v81,v81
v_mfma_f32_16x16x32_bf16 v[76:79],v[132:135],a[156:159],v[76:79]
v_exp_f32 v82,v82
v_mfma_f32_16x16x32_bf16 v[84:87],v[132:135],a[180:183],v[84:87]
ds_read_b64_tr_b16 v[112:113],v2 offset:24576
v_mfma_f32_16x16x32_bf16 v[92:95],v[132:135],a[204:207],v[92:95]
ds_read_b64_tr_b16 v[114:115],v2 offset:30720
v_cvt_pk_bf16_f32 v40,v72,v73
v_mfma_f32_16x16x32_bf16 v[100:103],v[132:135],a[228:231],v[100:103]
v_exp_f32 v83,v83
v_mfma_f32_16x16x32_bf16 v[108:111],v[132:135],a[252:255],v[108:111]
ds_read_b64_tr_b16 v[116:117],v3 offset:24576
ds_read_b64_tr_b16 v[118:119],v3 offset:30720
v_mfma_f32_16x16x32_bf16 v[76:79],v[136:139],a[160:163],v[76:79]
v_exp_f32 v88,v88
v_mfma_f32_16x16x32_bf16 v[84:87],v[136:139],a[184:187],v[84:87]
ds_read_b64_tr_b16 v[120:121],v4 offset:24576
v_mfma_f32_16x16x32_bf16 v[92:95],v[136:139],a[208:211],v[92:95]
ds_read_b64_tr_b16 v[122:123],v4 offset:30720
v_cvt_pk_bf16_f32 v41,v74,v75
v_mfma_f32_16x16x32_bf16 v[100:103],v[136:139],a[232:235],v[100:103]
v_exp_f32 v89,v89
v_mfma_f32_16x16x32_bf16 v[108:111],v[136:139],v[144:147],v[108:111]
ds_read_b64_tr_b16 v[124:125],v5 offset:24576
ds_read_b64_tr_b16 v[126:127],v5 offset:30720
v_mfma_f32_16x16x32_bf16 v[76:79],v[140:143],a[164:167],v[76:79]
v_cvt_pk_bf16_f32 v44,v80,v81
v_cvt_pk_bf16_f32 v45,v82,v83
v_mfma_f32_16x16x32_bf16 v[84:87],v[140:143],a[188:191],v[84:87]
v_cvt_pk_bf16_f32 v48,v88,v89
v_mfma_f32_16x16x32_bf16 v[92:95],v[140:143],a[212:215],v[92:95]
v_mfma_f32_16x16x32_bf16 v[100:103],v[140:143],a[236:239],v[100:103]
v_mfma_f32_16x16x32_bf16 v[108:111],v[140:143],v[148:151],v[108:111]
s_cbranch_scc1 L_loop5w0
s_cmp_ge_u32 s69,6
s_cbranch_scc1 L_end5
s_cmp_eq_u32 s40,0
s_cbranch_scc1 L_tr54
s_branch L_tr55
L_tr54:
s_waitcnt vmcnt(42)
s_waitcnt lgkmcnt(4)
v_mfma_f32_16x16x32_bf16 v[160:163],v[112:115],v[20:23],v[160:163]
s_add_u32 m0,s24,0
ds_read_b128 a[144:147],v11 offset:0
v_fma_f32 v90,v90,s36,v15
v_mfma_f32_16x16x32_bf16 v[208:211],v[112:115],v[24:27],v[208:211]
ds_read_b128 a[148:151],v12 offset:0
v_fma_f32 v91,v91,s36,v15
v_mfma_f32_16x16x32_bf16 a[0:3],v[112:115],v[28:31],a[0:3]
ds_read_b128 a[152:155],v11 offset:128
v_fma_f32 v96,v96,s36,v16
v_mfma_f32_16x16x32_bf16 a[48:51],v[112:115],v[32:35],a[48:51]
ds_read_b128 a[156:159],v12 offset:128
v_fma_f32 v97,v97,s36,v16
v_mfma_f32_16x16x32_bf16 a[96:99],v[112:115],v[36:39],a[96:99]
ds_read_b128 a[160:163],v11 offset:256
v_fma_f32 v98,v98,s36,v16
v_mfma_f32_16x16x32_bf16 v[164:167],v[116:119],v[20:23],v[164:167]
ds_read_b128 a[164:167],v12 offset:256
ds_read_b64_tr_b16 v[128:129],v2 offset:24704
ds_read_b64_tr_b16 v[130:131],v2 offset:30848
ds_read_b64_tr_b16 v[132:133],v3 offset:24704
ds_read_b64_tr_b16 v[134:135],v3 offset:30848
ds_read_b64_tr_b16 v[136:137],v4 offset:24704
ds_read_b64_tr_b16 v[138:139],v4 offset:30848
ds_read_b64_tr_b16 v[140:141],v5 offset:24704
ds_read_b64_tr_b16 v[142:143],v5 offset:30848
ds_read_b64_tr_b16 v[112:113],v2 offset:24832
ds_read_b64_tr_b16 v[114:115],v2 offset:30976
ds_read_b128 a[168:171],v11 offset:6144
v_mfma_f32_16x16x32_bf16 v[212:215],v[116:119],v[24:27],v[212:215]
v_fma_f32 v99,v99,s36,v16
ds_read_b128 a[172:175],v12 offset:6144
ds_read_b128 a[176:179],v11 offset:6272
v_mfma_f32_16x16x32_bf16 a[4:7],v[116:119],v[28:31],a[4:7]
v_fma_f32 v104,v104,s36,v17
ds_read_b128 a[180:183],v12 offset:6272
ds_read_b128 a[184:187],v11 offset:6400
v_mfma_f32_16x16x32_bf16 a[52:55],v[116:119],v[32:35],a[52:55]
s_waitcnt lgkmcnt(15)
buffer_load_dwordx4 v6,s[12:15],s28 offen offset:0 nt lds
v_mfma_f32_16x16x32_bf16 a[100:103],v[116:119],v[36:39],a[100:103]
ds_read_b64_tr_b16 v[116:117],v3 offset:24832
ds_read_b64_tr_b16 v[118:119],v3 offset:30976
v_mfma_f32_16x16x32_bf16 v[168:171],v[120:123],v[20:23],v[168:171]
ds_read_b128 a[188:191],v12 offset:6400
v_fma_f32 v105,v105,s36,v17
v_mfma_f32_16x16x32_bf16 v[216:219],v[120:123],v[24:27],v[216:219]
v_fma_f32 v106,v106,s36,v17
v_fma_f32 v107,v107,s36,v17
v_mfma_f32_16x16x32_bf16 a[8:11],v[120:123],v[28:31],a[8:11]
v_fma_f32 v76,v76,s36,v13
v_fma_f32 v77,v77,s36,v13
v_mfma_f32_16x16x32_bf16 a[56:59],v[120:123],v[32:35],a[56:59]
buffer_load_dwordx4 v7,s[12:15],s28 offen offset:1024 nt lds
v_mfma_f32_16x16x32_bf16 a[104:107],v[120:123],v[36:39],a[104:107]
ds_read_b64_tr_b16 v[120:121],v4 offset:24832
ds_read_b64_tr_b16 v[122:123],v4 offset:30976
v_mfma_f32_16x16x32_bf16 v[172:175],v[124:127],v[20:23],v[172:175]
v_fma_f32 v78,v78,s36,v13
v_fma_f32 v79,v79,s36,v13
v_mfma_f32_16x16x32_bf16 v[220:223],v[124:127],v[24:27],v[220:223]
v_fma_f32 v84,v84,s36,v14
v_fma_f32 v85,v85,s36,v14
v_mfma_f32_16x16x32_bf16 a[12:15],v[124:127],v[28:31],a[12:15]
v_fma_f32 v86,v86,s36,v14
v_fma_f32 v87,v87,s36,v14
v_mfma_f32_16x16x32_bf16 a[60:63],v[124:127],v[32:35],a[60:63]
v_fma_f32 v92,v92,s36,v15
v_fma_f32 v93,v93,s36,v15
v_mfma_f32_16x16x32_bf16 a[108:111],v[124:127],v[36:39],a[108:111]
s_waitcnt lgkmcnt(2)
ds_read_b64_tr_b16 v[124:125],v5 offset:24832
ds_read_b64_tr_b16 v[126:127],v5 offset:30976
v_mfma_f32_16x16x32_bf16 v[176:179],v[128:131],v[20:23],v[176:179]
v_fma_f32 v94,v94,s36,v15
v_fma_f32 v95,v95,s36,v15
v_mfma_f32_16x16x32_bf16 v[224:227],v[128:131],v[24:27],v[224:227]
buffer_load_dwordx4 v8,s[12:15],s28 offen offset:2048 nt lds
v_mfma_f32_16x16x32_bf16 a[16:19],v[128:131],v[28:31],a[16:19]
s_add_u32 s28,s28,3072
v_fma_f32 v100,v100,s36,v16
v_fma_f32 v101,v101,s36,v16
v_mfma_f32_16x16x32_bf16 a[64:67],v[128:131],v[32:35],a[64:67]
s_add_u32 m0,s24,3072
v_fma_f32 v102,v102,s36,v16
v_fma_f32 v103,v103,s36,v16
v_mfma_f32_16x16x32_bf16 a[112:115],v[128:131],v[36:39],a[112:115]
v_fma_f32 v108,v108,s36,v17
v_fma_f32 v109,v109,s36,v17
v_mfma_f32_16x16x32_bf16 v[180:183],v[132:135],v[20:23],v[180:183]
v_fma_f32 v110,v110,s36,v17
v_fma_f32 v111,v111,s36,v17
v_mfma_f32_16x16x32_bf16 v[228:231],v[132:135],v[24:27],v[228:231]
v_exp_f32 v90,v90
v_mfma_f32_16x16x32_bf16 a[20:23],v[132:135],v[28:31],a[20:23]
v_exp_f32 v91,v91
v_mfma_f32_16x16x32_bf16 a[68:71],v[132:135],v[32:35],a[68:71]
v_exp_f32 v96,v96
v_mfma_f32_16x16x32_bf16 a[116:119],v[132:135],v[36:39],a[116:119]
buffer_load_dwordx4 v6,s[12:15],s28 offen offset:0 nt lds
v_mfma_f32_16x16x32_bf16 v[184:187],v[136:139],v[20:23],v[184:187]
v_exp_f32 v97,v97
v_mfma_f32_16x16x32_bf16 v[232:235],v[136:139],v[24:27],v[232:235]
v_exp_f32 v98,v98
v_mfma_f32_16x16x32_bf16 a[24:27],v[136:139],v[28:31],a[24:27]
v_exp_f32 v99,v99
v_mfma_f32_16x16x32_bf16 a[72:75],v[136:139],v[32:35],a[72:75]
v_exp_f32 v104,v104
v_mfma_f32_16x16x32_bf16 a[120:123],v[136:139],v[36:39],a[120:123]
v_exp_f32 v105,v105
v_mfma_f32_16x16x32_bf16 v[188:191],v[140:143],v[20:23],v[188:191]
v_exp_f32 v106,v106
v_mfma_f32_16x16x32_bf16 v[236:239],v[140:143],v[24:27],v[236:239]
buffer_load_dwordx4 v7,s[12:15],s28 offen offset:1024 nt lds
v_mfma_f32_16x16x32_bf16 a[28:31],v[140:143],v[28:31],a[28:31]
v_exp_f32 v107,v107
v_mfma_f32_16x16x32_bf16 a[76:79],v[140:143],v[32:35],a[76:79]
v_exp_f32 v76,v76
v_mfma_f32_16x16x32_bf16 a[124:127],v[140:143],v[36:39],a[124:127]
v_exp_f32 v77,v77
v_mfma_f32_16x16x32_bf16 v[192:195],v[112:115],v[20:23],v[192:195]
v_exp_f32 v78,v78
v_mfma_f32_16x16x32_bf16 v[240:243],v[112:115],v[24:27],v[240:243]
v_exp_f32 v79,v79
v_mfma_f32_16x16x32_bf16 a[32:35],v[112:115],v[28:31],a[32:35]
v_exp_f32 v84,v84
v_mfma_f32_16x16x32_bf16 a[80:83],v[112:115],v[32:35],a[80:83]
v_exp_f32 v85,v85
v_mfma_f32_16x16x32_bf16 a[128:131],v[112:115],v[36:39],a[128:131]
buffer_load_dwordx4 v8,s[12:15],s28 offen offset:2048 nt lds
s_waitcnt vmcnt(20) lgkmcnt(0)
s_barrier
v_mfma_f32_16x16x32_bf16 v[196:199],v[116:119],v[20:23],v[196:199]
s_add_u32 s28,s28,3072
v_exp_f32 v86,v86
v_mfma_f32_16x16x32_bf16 v[244:247],v[116:119],v[24:27],v[244:247]
s_add_u32 m0,s22,0
v_exp_f32 v87,v87
v_mfma_f32_16x16x32_bf16 a[36:39],v[116:119],v[28:31],a[36:39]
buffer_load_dwordx4 v6,s[4:7],s25 offen offset:0 lds
v_mfma_f32_16x16x32_bf16 a[84:87],v[116:119],v[32:35],a[84:87]
buffer_load_dwordx4 v7,s[4:7],s25 offen offset:1024 lds
v_mfma_f32_16x16x32_bf16 a[132:135],v[116:119],v[36:39],a[132:135]
buffer_load_dwordx4 v8,s[4:7],s25 offen offset:2048 lds
v_mfma_f32_16x16x32_bf16 v[200:203],v[120:123],v[20:23],v[200:203]
v_exp_f32 v92,v92
v_mfma_f32_16x16x32_bf16 v[248:251],v[120:123],v[24:27],v[248:251]
v_exp_f32 v93,v93
v_mfma_f32_16x16x32_bf16 a[40:43],v[120:123],v[28:31],a[40:43]
v_exp_f32 v94,v94
v_mfma_f32_16x16x32_bf16 a[88:91],v[120:123],v[32:35],a[88:91]
v_exp_f32 v95,v95
v_mfma_f32_16x16x32_bf16 a[136:139],v[120:123],v[36:39],a[136:139]
ds_read_b64_tr_b16 v[128:129],v2 offset:0
ds_read_b64_tr_b16 v[130:131],v2 offset:6144
v_mfma_f32_16x16x32_bf16 v[204:207],v[124:127],v[20:23],v[204:207]
v_exp_f32 v100,v100
v_mfma_f32_16x16x32_bf16 v[252:255],v[124:127],v[24:27],v[252:255]
v_exp_f32 v101,v101
v_mfma_f32_16x16x32_bf16 a[44:47],v[124:127],v[28:31],a[44:47]
ds_read_b64_tr_b16 v[132:133],v3 offset:0
ds_read_b64_tr_b16 v[134:135],v3 offset:6144
v_mfma_f32_16x16x32_bf16 a[92:95],v[124:127],v[32:35],a[92:95]
v_exp_f32 v102,v102
v_mfma_f32_16x16x32_bf16 a[140:143],v[124:127],v[36:39],a[140:143]
ds_read_b64_tr_b16 v[136:137],v4 offset:0
ds_read_b64_tr_b16 v[138:139],v4 offset:6144
v_exp_f32 v103,v103
v_exp_f32 v108,v108
v_exp_f32 v109,v109
ds_read_b64_tr_b16 v[140:141],v5 offset:0
ds_read_b64_tr_b16 v[142:143],v5 offset:6144
v_exp_f32 v110,v110
v_exp_f32 v111,v111
v_cvt_pk_bf16_f32 v49,v90,v91
v_cvt_pk_bf16_f32 v52,v96,v97
v_cvt_pk_bf16_f32 v53,v98,v99
v_cvt_pk_bf16_f32 v56,v104,v105
v_cvt_pk_bf16_f32 v57,v106,v107
v_cvt_pk_bf16_f32 v42,v76,v77
v_cvt_pk_bf16_f32 v43,v78,v79
v_cvt_pk_bf16_f32 v46,v84,v85
v_cvt_pk_bf16_f32 v47,v86,v87
v_cvt_pk_bf16_f32 v50,v92,v93
v_cvt_pk_bf16_f32 v51,v94,v95
v_smfmac_f32_16x16x64_bf16 v[60:63],v[152:155],v[40:47],v18
v_cvt_pk_bf16_f32 v54,v100,v101
v_cvt_pk_bf16_f32 v55,v102,v103
v_cvt_pk_bf16_f32 v58,v108,v109
v_cvt_pk_bf16_f32 v59,v110,v111
v_smfmac_f32_16x16x64_bf16 v[64:67],v[152:155],v[48:55],v18
v_subrev_u32 v10,18432,v10
v_smfmac_f32_16x16x64_bf16 v[68:71],v[152:155],v[52:59],v18
s_waitcnt lgkmcnt(2)
v_mfma_f32_16x16x32_bf16 v[160:163],v[128:131],v[40:43],v[160:163]
s_add_u32 s87,s42,18432
ds_read_b64_tr_b16 v[112:113],v2 offset:128
ds_read_b64_tr_b16 v[114:115],v2 offset:6272
v_mfma_f32_16x16x32_bf16 v[208:211],v[128:131],v[44:47],v[208:211]
s_add_u32 s66,s42,24576
ds_read_b64_tr_b16 v[116:117],v3 offset:128
ds_read_b64_tr_b16 v[118:119],v3 offset:6272
v_mfma_f32_16x16x32_bf16 a[0:3],v[128:131],v[48:51],a[0:3]
ds_read_b64_tr_b16 v[120:121],v4 offset:128
ds_read_b64_tr_b16 v[122:123],v4 offset:6272
v_mfma_f32_16x16x32_bf16 a[48:51],v[128:131],v[52:55],a[48:51]
ds_read_b64_tr_b16 v[124:125],v5 offset:128
ds_read_b64_tr_b16 v[126:127],v5 offset:6272
v_mfma_f32_16x16x32_bf16 a[96:99],v[128:131],v[56:59],a[96:99]
ds_read_b64_tr_b16 v[128:129],v2 offset:256
ds_read_b64_tr_b16 v[130:131],v2 offset:6400
v_mfma_f32_16x16x32_bf16 v[164:167],v[132:135],v[40:43],v[164:167]
v_mbcnt_lo_u32_b32 v39,-1,0
v_mbcnt_hi_u32_b32 v39,-1,v39
v_mfma_f32_16x16x32_bf16 v[212:215],v[132:135],v[44:47],v[212:215]
v_and_b32 v38,7,v39
v_add_f32 v60,v60,v61
v_mfma_f32_16x16x32_bf16 a[4:7],v[132:135],v[48:51],a[4:7]
v_add_f32 v62,v62,v63
v_add_f32 v64,v64,v65
v_add_f32 v66,v66,v67
v_add_f32 v70,v70,v71
v_max3_f32 v19,v60,v62,v64
v_max3_f32 v19,v19,v66,v70
v_rcp_f32 v66,v66
v_rcp_f32 v70,v70
v_accvgpr_read_b32 v72,a48
v_accvgpr_read_b32 v73,a49
v_pk_mul_f32 v[72:73],v[72:73],v[66:67] op_sel_hi:[1,0]
v_accvgpr_read_b32 v74,a50
v_accvgpr_read_b32 v75,a51
v_pk_mul_f32 v[74:75],v[74:75],v[66:67] op_sel_hi:[1,0]
v_accvgpr_read_b32 v76,a96
v_accvgpr_read_b32 v77,a97
v_pk_mul_f32 v[76:77],v[76:77],v[70:71] op_sel_hi:[1,0]
v_accvgpr_read_b32 v78,a98
v_accvgpr_read_b32 v79,a99
v_pk_mul_f32 v[78:79],v[78:79],v[70:71] op_sel_hi:[1,0]
v_cmp_ngt_f32 vcc,s37,v19
v_lshrrev_b32 v19,5,v39
v_mfma_f32_16x16x32_bf16 a[52:55],v[132:135],v[52:55],a[52:55]
v_xor_b32 v38,v38,v19
v_and_b32 v19,15,v39
v_mfma_f32_16x16x32_bf16 a[100:103],v[132:135],v[56:59],a[100:103]
s_cmp_lg_u64 vcc,0
ds_read_b64_tr_b16 v[132:133],v3 offset:256
ds_read_b64_tr_b16 v[134:135],v3 offset:6400
v_mfma_f32_16x16x32_bf16 v[168:171],v[136:139],v[40:43],v[168:171]
s_cselect_b32 s62,s32,0
v_lshl_add_u32 v19,v19,7,s24
v_lshl_add_u32 v19,v38,4,v19
v_mfma_f32_16x16x32_bf16 v[216:219],v[136:139],v[44:47],v[216:219]
s_or_b32 s31,s31,s62
v_bfe_u32 v38,v39,4,1
v_lshl_add_u32 v36,v38,3,v19
v_mfma_f32_16x16x32_bf16 a[8:11],v[136:139],v[48:51],a[8:11]
s_lshl_b32 s32,s32,1
v_xor_b32 v37,32,v36
v_xor_b32 v38,64,v36
v_bfe_u32 v19,v39,3,1
v_xor_b32 v39,96,v36
v_lshlrev_b32 v19,11,v19
v_accvgpr_read_b32 v80,a52
v_accvgpr_read_b32 v81,a53
v_pk_mul_f32 v[80:81],v[80:81],v[66:67] op_sel_hi:[1,0]
v_accvgpr_read_b32 v82,a54
v_accvgpr_read_b32 v83,a55
v_pk_mul_f32 v[82:83],v[82:83],v[66:67] op_sel_hi:[1,0]
v_accvgpr_read_b32 v84,a100
v_accvgpr_read_b32 v85,a101
v_pk_mul_f32 v[84:85],v[84:85],v[70:71] op_sel_hi:[1,0]
v_accvgpr_read_b32 v86,a102
v_accvgpr_read_b32 v87,a103
v_pk_mul_f32 v[86:87],v[86:87],v[70:71] op_sel_hi:[1,0]
v_cvt_pk_bf16_f32 v72,v72,v73
v_cvt_pk_bf16_f32 v76,v76,v77
v_mfma_f32_16x16x32_bf16 a[56:59],v[136:139],v[52:55],a[56:59]
s_add_u32 m0,s23,0
v_cvt_pk_bf16_f32 v80,v80,v81
v_cvt_pk_bf16_f32 v84,v84,v85
v_mfma_f32_16x16x32_bf16 a[104:107],v[136:139],v[56:59],a[104:107]
s_waitcnt lgkmcnt(0)
ds_read_b64_tr_b16 v[136:137],v4 offset:256
ds_read_b64_tr_b16 v[138:139],v4 offset:6400
v_mfma_f32_16x16x32_bf16 v[172:175],v[140:143],v[40:43],v[172:175]
v_cvt_pk_bf16_f32 v73,v74,v75
v_accvgpr_read_b32 v88,a56
v_mfma_f32_16x16x32_bf16 v[220:223],v[140:143],v[44:47],v[220:223]
v_accvgpr_read_b32 v89,a57
v_accvgpr_read_b32 v90,a58
v_mfma_f32_16x16x32_bf16 a[12:15],v[140:143],v[48:51],a[12:15]
v_accvgpr_read_b32 v91,a59
v_accvgpr_read_b32 v92,a104
v_accvgpr_read_b32 v93,a105
v_accvgpr_read_b32 v94,a106
v_accvgpr_read_b32 v95,a107
v_pk_mul_f32 v[88:89],v[88:89],v[66:67] op_sel_hi:[1,0]
v_pk_mul_f32 v[90:91],v[90:91],v[66:67] op_sel_hi:[1,0]
v_pk_mul_f32 v[92:93],v[92:93],v[70:71] op_sel_hi:[1,0]
v_pk_mul_f32 v[94:95],v[94:95],v[70:71] op_sel_hi:[1,0]
v_cvt_pk_bf16_f32 v77,v78,v79
v_cvt_pk_bf16_f32 v81,v82,v83
v_mfma_f32_16x16x32_bf16 a[60:63],v[140:143],v[52:55],a[60:63]
ds_write2st64_b64 v36,v[72:73],v[76:77] offset0:36 offset1:40
v_mfma_f32_16x16x32_bf16 a[108:111],v[140:143],v[56:59],a[108:111]
v_cvt_pk_bf16_f32 v85,v86,v87
v_cvt_pk_bf16_f32 v88,v88,v89
v_mfma_f32_16x16x32_bf16 v[176:179],v[112:115],v[40:43],v[176:179]
ds_read_b64_tr_b16 v[140:141],v5 offset:256
ds_read_b64_tr_b16 v[142:143],v5 offset:6400
v_mfma_f32_16x16x32_bf16 v[224:227],v[112:115],v[44:47],v[224:227]
v_accvgpr_read_b32 v96,a60
v_accvgpr_read_b32 v97,a61
v_mfma_f32_16x16x32_bf16 a[16:19],v[112:115],v[48:51],a[16:19]
ds_write2st64_b64 v37,v[80:81],v[84:85] offset0:36 offset1:40
v_pk_mul_f32 v[96:97],v[96:97],v[66:67] op_sel_hi:[1,0]
v_accvgpr_read_b32 v98,a62
v_accvgpr_read_b32 v99,a63
v_pk_mul_f32 v[98:99],v[98:99],v[66:67] op_sel_hi:[1,0]
v_accvgpr_read_b32 v100,a108
v_accvgpr_read_b32 v101,a109
v_pk_mul_f32 v[100:101],v[100:101],v[70:71] op_sel_hi:[1,0]
v_accvgpr_read_b32 v102,a110
v_accvgpr_read_b32 v103,a111
v_pk_mul_f32 v[102:103],v[102:103],v[70:71] op_sel_hi:[1,0]
v_cvt_pk_bf16_f32 v92,v92,v93
v_cvt_pk_bf16_f32 v89,v90,v91
v_mfma_f32_16x16x32_bf16 a[64:67],v[112:115],v[52:55],a[64:67]
v_cvt_pk_bf16_f32 v93,v94,v95
v_cvt_pk_bf16_f32 v96,v96,v97
v_mfma_f32_16x16x32_bf16 a[112:115],v[112:115],v[56:59],a[112:115]
ds_write2st64_b64 v38,v[88:89],v[92:93] offset0:36 offset1:40
v_mfma_f32_16x16x32_bf16 v[180:183],v[116:119],v[40:43],v[180:183]
v_cvt_pk_bf16_f32 v100,v100,v101
v_cvt_pk_bf16_f32 v97,v98,v99
v_mfma_f32_16x16x32_bf16 v[228:231],v[116:119],v[44:47],v[228:231]
v_accvgpr_read_b32 v76,a64
v_accvgpr_read_b32 v77,a65
v_mfma_f32_16x16x32_bf16 a[20:23],v[116:119],v[48:51],a[20:23]
v_accvgpr_read_b32 v78,a66
v_accvgpr_read_b32 v79,a67
v_accvgpr_read_b32 v80,a112
v_accvgpr_read_b32 v81,a113
v_accvgpr_read_b32 v82,a114
v_pk_mul_f32 v[76:77],v[76:77],v[66:67] op_sel_hi:[1,0]
v_pk_mul_f32 v[78:79],v[78:79],v[66:67] op_sel_hi:[1,0]
v_pk_mul_f32 v[80:81],v[80:81],v[70:71] op_sel_hi:[1,0]
v_accvgpr_read_b32 v83,a115
v_pk_mul_f32 v[82:83],v[82:83],v[70:71] op_sel_hi:[1,0]
v_cvt_pk_bf16_f32 v101,v102,v103
v_cvt_pk_bf16_f32 v76,v76,v77
v_mfma_f32_16x16x32_bf16 a[68:71],v[116:119],v[52:55],a[68:71]
ds_write2st64_b64 v39,v[96:97],v[100:101] offset0:36 offset1:40
v_mfma_f32_16x16x32_bf16 a[116:119],v[116:119],v[56:59],a[116:119]
v_cvt_pk_bf16_f32 v80,v80,v81
v_cvt_pk_bf16_f32 v77,v78,v79
v_mfma_f32_16x16x32_bf16 v[184:187],v[120:123],v[40:43],v[184:187]
ds_read_b128 v[156:159],v10 offset:18432
v_cvt_pk_bf16_f32 v81,v82,v83
v_mfma_f32_16x16x32_bf16 v[232:235],v[120:123],v[44:47],v[232:235]
ds_read_b128 v[104:107],v10 offset:19456
v_accvgpr_read_b32 v84,a68
v_mfma_f32_16x16x32_bf16 a[24:27],v[120:123],v[48:51],a[24:27]
ds_read_b128 v[108:111],v10 offset:20480
ds_read_b128 v[72:75],v10 offset:21504
v_accvgpr_read_b32 v85,a69
ds_write2st64_b64 v36,v[76:77],v[80:81] offset0:36 offset1:40
v_pk_mul_f32 v[84:85],v[84:85],v[66:67] op_sel_hi:[1,0]
v_accvgpr_read_b32 v86,a70
v_accvgpr_read_b32 v87,a71
v_pk_mul_f32 v[86:87],v[86:87],v[66:67] op_sel_hi:[1,0]
v_accvgpr_read_b32 v88,a116
v_accvgpr_read_b32 v89,a117
v_pk_mul_f32 v[88:89],v[88:89],v[70:71] op_sel_hi:[1,0]
v_accvgpr_read_b32 v90,a118
v_accvgpr_read_b32 v91,a119
v_pk_mul_f32 v[90:91],v[90:91],v[70:71] op_sel_hi:[1,0]
v_cvt_pk_bf16_f32 v84,v84,v85
v_cvt_pk_bf16_f32 v88,v88,v89
v_mfma_f32_16x16x32_bf16 a[72:75],v[120:123],v[52:55],a[72:75]
s_waitcnt vmcnt(15)
ds_read_b128 a[192:195],v11 offset:12288
v_cvt_pk_bf16_f32 v85,v86,v87
v_mfma_f32_16x16x32_bf16 a[120:123],v[120:123],v[56:59],a[120:123]
s_waitcnt lgkmcnt(5)
ds_read_b128 a[196:199],v12 offset:12288
buffer_store_dwordx4 v[156:159],v9,s[16:19],s87 offen offset:0 nt
ds_read_b128 a[200:203],v11 offset:12416
v_cvt_pk_bf16_f32 v89,v90,v91
v_accvgpr_read_b32 v92,a72
v_mfma_f32_16x16x32_bf16 v[188:191],v[124:127],v[40:43],v[188:191]
ds_read_b128 a[204:207],v12 offset:12416
v_accvgpr_read_b32 v93,a73
v_mfma_f32_16x16x32_bf16 v[236:239],v[124:127],v[44:47],v[236:239]
ds_read_b128 a[208:211],v11 offset:12544
v_accvgpr_read_b32 v94,a74
v_mfma_f32_16x16x32_bf16 a[28:31],v[124:127],v[48:51],a[28:31]
ds_read_b128 a[212:215],v12 offset:12544
ds_write2st64_b64 v37,v[84:85],v[88:89] offset0:36 offset1:40
v_pk_mul_f32 v[92:93],v[92:93],v[66:67] op_sel_hi:[1,0]
v_accvgpr_read_b32 v95,a75
v_pk_mul_f32 v[94:95],v[94:95],v[66:67] op_sel_hi:[1,0]
s_waitcnt lgkmcnt(7)
buffer_store_dwordx4 v[104:107],v9,s[16:19],s87 offen offset:3072 nt
v_accvgpr_read_b32 v96,a120
v_accvgpr_read_b32 v97,a121
v_pk_mul_f32 v[96:97],v[96:97],v[70:71] op_sel_hi:[1,0]
v_accvgpr_read_b32 v98,a122
v_accvgpr_read_b32 v99,a123
v_pk_mul_f32 v[98:99],v[98:99],v[70:71] op_sel_hi:[1,0]
v_cvt_pk_bf16_f32 v92,v92,v93
v_cvt_pk_bf16_f32 v96,v96,v97
v_mfma_f32_16x16x32_bf16 a[76:79],v[124:127],v[52:55],a[76:79]
v_cvt_pk_bf16_f32 v93,v94,v95
v_cvt_pk_bf16_f32 v97,v98,v99
v_mfma_f32_16x16x32_bf16 a[124:127],v[124:127],v[56:59],a[124:127]
ds_write2st64_b64 v38,v[92:93],v[96:97] offset0:36 offset1:40
v_mfma_f32_16x16x32_bf16 v[192:195],v[128:131],v[40:43],v[192:195]
v_rcp_f32 v62,v62
v_mfma_f32_16x16x32_bf16 v[240:243],v[128:131],v[44:47],v[240:243]
buffer_store_dwordx4 v[108:111],v9,s[16:19],s66 offen offset:0 nt
v_accvgpr_read_b32 v100,a76
v_accvgpr_read_b32 v101,a77
v_accvgpr_read_b32 v102,a78
v_mfma_f32_16x16x32_bf16 a[32:35],v[128:131],v[48:51],a[32:35]
v_accvgpr_read_b32 v103,a79
v_accvgpr_read_b32 v76,a124
v_accvgpr_read_b32 v77,a125
v_accvgpr_read_b32 v78,a126
v_accvgpr_read_b32 v79,a127
v_pk_mul_f32 v[100:101],v[100:101],v[66:67] op_sel_hi:[1,0]
buffer_store_dwordx4 v[72:75],v9,s[16:19],s66 offen offset:3072 nt
v_pk_mul_f32 v[102:103],v[102:103],v[66:67] op_sel_hi:[1,0]
v_pk_mul_f32 v[76:77],v[76:77],v[70:71] op_sel_hi:[1,0]
v_pk_mul_f32 v[78:79],v[78:79],v[70:71] op_sel_hi:[1,0]
v_cvt_pk_bf16_f32 v100,v100,v101
v_cvt_pk_bf16_f32 v76,v76,v77
v_mfma_f32_16x16x32_bf16 a[80:83],v[128:131],v[52:55],a[80:83]
v_cvt_pk_bf16_f32 v101,v102,v103
v_cvt_pk_bf16_f32 v77,v78,v79
v_mfma_f32_16x16x32_bf16 a[128:131],v[128:131],v[56:59],a[128:131]
ds_write2st64_b64 v39,v[100:101],v[76:77] offset0:36 offset1:40
s_waitcnt vmcnt(4)
s_barrier
v_mfma_f32_16x16x32_bf16 v[196:199],v[132:135],v[40:43],v[196:199]
ds_read_b128 v[156:159],v10 offset:18432
v_accvgpr_read_b32 v80,a80
v_mfma_f32_16x16x32_bf16 v[244:247],v[132:135],v[44:47],v[244:247]
ds_read_b128 v[84:87],v10 offset:19456
v_accvgpr_read_b32 v81,a81
v_mfma_f32_16x16x32_bf16 a[36:39],v[132:135],v[48:51],a[36:39]
ds_read_b128 v[104:107],v10 offset:20480
ds_read_b128 v[108:111],v10 offset:21504
v_accvgpr_read_b32 v82,a82
buffer_load_dwordx4 v6,s[8:11],s25 offen offset:0 lds
ds_read_b128 v[112:115],v0 offset:0
ds_read_b128 v[116:119],v1 offset:0
v_pk_mul_f32 v[80:81],v[80:81],v[66:67] op_sel_hi:[1,0]
ds_read_b128 v[120:123],v0 offset:128
v_accvgpr_read_b32 v83,a83
ds_read_b128 v[124:127],v1 offset:128
v_pk_mul_f32 v[82:83],v[82:83],v[66:67] op_sel_hi:[1,0]
ds_read_b128 v[128:131],v0 offset:256
v_accvgpr_read_b32 v72,a128
s_waitcnt lgkmcnt(8)
buffer_store_dwordx4 v[156:159],v9,s[16:19],s87 offen offset:128 nt
v_accvgpr_read_b32 v73,a129
v_pk_mul_f32 v[72:73],v[72:73],v[70:71] op_sel_hi:[1,0]
v_accvgpr_read_b32 v74,a130
v_accvgpr_read_b32 v75,a131
v_pk_mul_f32 v[74:75],v[74:75],v[70:71] op_sel_hi:[1,0]
v_cvt_pk_bf16_f32 v80,v80,v81
v_cvt_pk_bf16_f32 v72,v72,v73
v_mfma_f32_16x16x32_bf16 a[84:87],v[132:135],v[52:55],a[84:87]
v_cvt_pk_bf16_f32 v81,v82,v83
v_cvt_pk_bf16_f32 v73,v74,v75
v_mfma_f32_16x16x32_bf16 a[132:135],v[132:135],v[56:59],a[132:135]
buffer_load_dwordx4 v7,s[8:11],s25 offen offset:1024 lds
v_mfma_f32_16x16x32_bf16 v[200:203],v[136:139],v[40:43],v[200:203]
ds_write2st64_b64 v36,v[80:81],v[72:73] offset0:36 offset1:40
v_mfma_f32_16x16x32_bf16 v[248:251],v[136:139],v[44:47],v[248:251]
v_add_u32 v36,v36,v19
v_accvgpr_read_b32 v92,a84
v_mfma_f32_16x16x32_bf16 a[40:43],v[136:139],v[48:51],a[40:43]
s_waitcnt lgkmcnt(1)
buffer_store_dwordx4 v[84:87],v9,s[16:19],s87 offen offset:3200 nt
ds_read_b128 v[132:135],v1 offset:256
v_accvgpr_read_b32 v93,a85
v_accvgpr_read_b32 v94,a86
v_pk_mul_f32 v[92:93],v[92:93],v[66:67] op_sel_hi:[1,0]
v_accvgpr_read_b32 v95,a87
v_pk_mul_f32 v[94:95],v[94:95],v[66:67] op_sel_hi:[1,0]
v_accvgpr_read_b32 v96,a132
v_accvgpr_read_b32 v97,a133
v_pk_mul_f32 v[96:97],v[96:97],v[70:71] op_sel_hi:[1,0]
v_accvgpr_read_b32 v98,a134
v_accvgpr_read_b32 v99,a135
buffer_load_dwordx4 v8,s[8:11],s25 offen offset:2048 lds
buffer_store_dwordx4 v[104:107],v9,s[16:19],s66 offen offset:128 nt
v_pk_mul_f32 v[98:99],v[98:99],v[70:71] op_sel_hi:[1,0]
v_cvt_pk_bf16_f32 v92,v92,v93
v_cvt_pk_bf16_f32 v96,v96,v97
v_mfma_f32_16x16x32_bf16 a[88:91],v[136:139],v[52:55],a[88:91]
s_add_u32 m0,s23,24576
v_cvt_pk_bf16_f32 v93,v94,v95
v_cvt_pk_bf16_f32 v97,v98,v99
v_mfma_f32_16x16x32_bf16 a[136:139],v[136:139],v[56:59],a[136:139]
ds_read_b128 v[136:139],v0 offset:6144
v_rcp_f32 v64,v64
v_mfma_f32_16x16x32_bf16 v[204:207],v[140:143],v[40:43],v[204:207]
ds_write2st64_b64 v37,v[92:93],v[96:97] offset0:36 offset1:40
v_mfma_f32_16x16x32_bf16 v[252:255],v[140:143],v[44:47],v[252:255]
v_add_u32 v37,v37,v19
v_accvgpr_read_b32 v76,a88
v_mfma_f32_16x16x32_bf16 a[44:47],v[140:143],v[48:51],a[44:47]
buffer_store_dwordx4 v[108:111],v9,s[16:19],s66 offen offset:3200 nt
buffer_load_dwordx4 v6,s[8:11],s21 offen offset:0 lds
v_accvgpr_read_b32 v77,a89
v_pk_mul_f32 v[76:77],v[76:77],v[66:67] op_sel_hi:[1,0]
v_accvgpr_read_b32 v78,a90
v_accvgpr_read_b32 v79,a91
v_pk_mul_f32 v[78:79],v[78:79],v[66:67] op_sel_hi:[1,0]
v_accvgpr_read_b32 v100,a136
v_accvgpr_read_b32 v101,a137
v_pk_mul_f32 v[100:101],v[100:101],v[70:71] op_sel_hi:[1,0]
v_accvgpr_read_b32 v102,a138
v_accvgpr_read_b32 v103,a139
v_pk_mul_f32 v[102:103],v[102:103],v[70:71] op_sel_hi:[1,0]
v_cvt_pk_bf16_f32 v76,v76,v77
v_cvt_pk_bf16_f32 v100,v100,v101
v_mfma_f32_16x16x32_bf16 a[92:95],v[140:143],v[52:55],a[92:95]
s_waitcnt vmcnt(15)
ds_read_b128 a[216:219],v11 offset:0
v_cvt_pk_bf16_f32 v77,v78,v79
v_mfma_f32_16x16x32_bf16 a[140:143],v[140:143],v[56:59],a[140:143]
ds_read_b128 a[220:223],v12 offset:0
v_cvt_pk_bf16_f32 v101,v102,v103
v_mfma_f32_16x16x32_bf16 v[72:75],v[112:115],a[144:147],0
ds_read_b128 a[224:227],v11 offset:128
v_accvgpr_read_b32 v84,a92
v_mfma_f32_16x16x32_bf16 v[80:83],v[112:115],a[168:171],0
ds_read_b128 a[228:231],v12 offset:128
v_accvgpr_read_b32 v85,a93
v_mfma_f32_16x16x32_bf16 v[88:91],v[112:115],a[192:195],0
ds_read_b128 a[232:235],v11 offset:256
ds_read_b128 a[236:239],v12 offset:256
v_accvgpr_read_b32 v86,a94
ds_write2st64_b64 v38,v[76:77],v[100:101] offset0:36 offset1:40
v_pk_mul_f32 v[84:85],v[84:85],v[66:67] op_sel_hi:[1,0]
v_pk_mul_f32 v[208:209],v[208:209],v[62:63] op_sel_hi:[1,0]
v_pk_mul_f32 v[210:211],v[210:211],v[62:63] op_sel_hi:[1,0]
buffer_load_dwordx4 v7,s[8:11],s21 offen offset:1024 lds
ds_read_b128 v[140:143],v1 offset:6144
ds_read_b128 v[112:115],v0 offset:6272
v_pk_mul_f32 v[224:225],v[224:225],v[62:63] op_sel_hi:[1,0]
v_pk_mul_f32 v[226:227],v[226:227],v[62:63] op_sel_hi:[1,0]
v_pk_mul_f32 v[212:213],v[212:213],v[62:63] op_sel_hi:[1,0]
v_pk_mul_f32 v[214:215],v[214:215],v[62:63] op_sel_hi:[1,0]
v_pk_mul_f32 v[228:229],v[228:229],v[62:63] op_sel_hi:[1,0]
v_pk_mul_f32 v[230:231],v[230:231],v[62:63] op_sel_hi:[1,0]
v_pk_mul_f32 v[216:217],v[216:217],v[62:63] op_sel_hi:[1,0]
v_pk_mul_f32 v[218:219],v[218:219],v[62:63] op_sel_hi:[1,0]
v_pk_mul_f32 v[232:233],v[232:233],v[62:63] op_sel_hi:[1,0]
v_pk_mul_f32 v[234:235],v[234:235],v[62:63] op_sel_hi:[1,0]
v_pk_mul_f32 v[220:221],v[220:221],v[62:63] op_sel_hi:[1,0]
v_pk_mul_f32 v[222:223],v[222:223],v[62:63] op_sel_hi:[1,0]
v_pk_mul_f32 v[236:237],v[236:237],v[62:63] op_sel_hi:[1,0]
v_pk_mul_f32 v[238:239],v[238:239],v[62:63] op_sel_hi:[1,0]
v_pk_mul_f32 v[240:241],v[240:241],v[62:63] op_sel_hi:[1,0]
v_pk_mul_f32 v[242:243],v[242:243],v[62:63] op_sel_hi:[1,0]
v_pk_mul_f32 v[244:245],v[244:245],v[62:63] op_sel_hi:[1,0]
v_pk_mul_f32 v[246:247],v[246:247],v[62:63] op_sel_hi:[1,0]
v_add_u32 v38,v38,v19
v_accvgpr_read_b32 v87,a95
v_pk_mul_f32 v[86:87],v[86:87],v[66:67] op_sel_hi:[1,0]
v_accvgpr_read_b32 v78,a2
v_accvgpr_read_b32 v79,a3
v_pk_mul_f32 v[78:79],v[78:79],v[64:65] op_sel_hi:[1,0]
v_accvgpr_read_b32 v92,a140
v_accvgpr_read_b32 v93,a141
v_pk_mul_f32 v[92:93],v[92:93],v[70:71] op_sel_hi:[1,0]
v_accvgpr_read_b32 v94,a142
v_accvgpr_read_b32 v95,a143
v_pk_mul_f32 v[94:95],v[94:95],v[70:71] op_sel_hi:[1,0]
v_accvgpr_read_b32 v102,a6
v_accvgpr_read_b32 v103,a7
v_pk_mul_f32 v[102:103],v[102:103],v[64:65] op_sel_hi:[1,0]
v_accvgpr_read_b32 v76,a0
v_accvgpr_read_b32 v77,a1
v_pk_mul_f32 v[76:77],v[76:77],v[64:65] op_sel_hi:[1,0]
v_accvgpr_read_b32 v100,a4
v_accvgpr_read_b32 v101,a5
v_pk_mul_f32 v[100:101],v[100:101],v[64:65] op_sel_hi:[1,0]
v_cvt_pk_bf16_f32 v84,v84,v85
v_cvt_pk_bf16_f32 v92,v92,v93
v_mfma_f32_16x16x32_bf16 v[72:75],v[116:119],a[148:151],v[72:75]
v_cvt_pk_bf16_f32 v85,v86,v87
v_cvt_pk_bf16_f32 v93,v94,v95
v_mfma_f32_16x16x32_bf16 v[80:83],v[116:119],a[172:175],v[80:83]
buffer_load_dwordx4 v8,s[8:11],s21 offen offset:2048 lds
v_mfma_f32_16x16x32_bf16 v[88:91],v[116:119],a[196:199],v[88:91]
s_add_u32 s21,s21,12288
ds_write2st64_b64 v39,v[84:85],v[92:93] offset0:36 offset1:40
v_pk_mul_f32 v[248:249],v[248:249],v[62:63] op_sel_hi:[1,0]
v_pk_mul_f32 v[250:251],v[250:251],v[62:63] op_sel_hi:[1,0]
v_add_u32 v39,v39,v19
ds_read_b128 v[156:159],v10 offset:18432
ds_read_b128 v[96:99],v10 offset:19456
v_accvgpr_read_b32 v86,a10
ds_read_b128 v[104:107],v10 offset:20480
v_accvgpr_read_b32 v87,a11
ds_read_b128 v[108:111],v10 offset:21504
v_pk_mul_f32 v[86:87],v[86:87],v[64:65] op_sel_hi:[1,0]
ds_read_b128 v[116:119],v1 offset:6272
v_accvgpr_read_b32 v84,a8
v_accvgpr_read_b32 v85,a9
v_pk_mul_f32 v[84:85],v[84:85],v[64:65] op_sel_hi:[1,0]
v_accvgpr_read_b32 v94,a14
v_accvgpr_read_b32 v95,a15
v_mfma_f32_16x16x32_bf16 v[72:75],v[120:123],a[152:155],v[72:75]
s_mov_b32 s27,s42
v_accvgpr_read_b32 v92,a12
v_accvgpr_read_b32 v93,a13
v_mfma_f32_16x16x32_bf16 v[80:83],v[120:123],a[176:179],v[80:83]
s_mov_b32 s42,s41
v_cvt_pk_bf16_f32 v208,v208,v209
v_cvt_pk_bf16_f32 v224,v224,v225
v_mfma_f32_16x16x32_bf16 v[88:91],v[120:123],a[200:203],v[88:91]
s_add_u32 s69,s69,1
ds_read_b128 v[120:123],v0 offset:6400
v_cvt_pk_bf16_f32 v209,v210,v211
v_cvt_pk_bf16_f32 v225,v226,v227
ds_write2st64_b64 v36,v[208:209],v[224:225] offset0:12 offset1:14
v_pk_mul_f32 v[252:253],v[252:253],v[62:63] op_sel_hi:[1,0]
v_pk_mul_f32 v[254:255],v[254:255],v[62:63] op_sel_hi:[1,0]
v_pk_mul_f32 v[92:93],v[92:93],v[64:65] op_sel_hi:[1,0]
s_waitcnt lgkmcnt(3)
buffer_store_dwordx4 v[156:159],v9,s[16:19],s87 offen offset:256 nt
v_pk_mul_f32 v[94:95],v[94:95],v[64:65] op_sel_hi:[1,0]
v_accvgpr_read_b32 v210,a18
v_accvgpr_read_b32 v211,a19
v_mfma_f32_16x16x32_bf16 v[72:75],v[124:127],a[156:159],v[72:75]
s_lshl_b32 s62,s69,5
v_accvgpr_read_b32 v226,a34
v_accvgpr_read_b32 v227,a35
v_mfma_f32_16x16x32_bf16 v[80:83],v[124:127],a[180:183],v[80:83]
s_add_u32 s62,s62,s34
v_accvgpr_read_b32 v208,a16
v_accvgpr_read_b32 v209,a17
v_mfma_f32_16x16x32_bf16 v[88:91],v[124:127],a[204:207],v[88:91]
s_mul_i32 s63,s62,171
ds_read_b128 v[124:127],v1 offset:6400
buffer_store_dwordx4 v[96:99],v9,s[16:19],s87 offen offset:3328 nt
v_accvgpr_read_b32 v224,a32
v_accvgpr_read_b32 v225,a33
v_accvgpr_read_b32 v96,a20
v_mfma_f32_16x16x32_bf16 v[72:75],v[128:131],a[160:163],v[72:75]
s_lshr_b32 s63,s63,9
v_accvgpr_read_b32 v97,a21
v_accvgpr_read_b32 v98,a22
v_accvgpr_read_b32 v99,a23
v_cvt_pk_bf16_f32 v212,v212,v213
v_cvt_pk_bf16_f32 v228,v228,v229
v_pk_mul_f32 v[208:209],v[208:209],v[64:65] op_sel_hi:[1,0]
buffer_store_dwordx4 v[104:107],v9,s[16:19],s66 offen offset:256 nt
v_pk_mul_f32 v[210:211],v[210:211],v[64:65] op_sel_hi:[1,0]
v_pk_mul_f32 v[224:225],v[224:225],v[64:65] op_sel_hi:[1,0]
v_pk_mul_f32 v[226:227],v[226:227],v[64:65] op_sel_hi:[1,0]
v_accvgpr_read_b32 v104,a36
v_accvgpr_read_b32 v105,a37
v_mfma_f32_16x16x32_bf16 v[80:83],v[128:131],a[184:187],v[80:83]
s_mul_i32 s64,s63,3
v_accvgpr_read_b32 v106,a38
v_accvgpr_read_b32 v107,a39
v_mfma_f32_16x16x32_bf16 v[88:91],v[128:131],a[208:211],v[88:91]
s_sub_u32 s62,s62,s64
ds_read_b128 v[128:131],v0 offset:0
v_cvt_pk_bf16_f32 v216,v216,v217
v_mfma_f32_16x16x32_bf16 v[72:75],v[132:135],a[164:167],v[72:75]
s_add_u32 s63,s63,s33
buffer_store_dwordx4 v[108:111],v9,s[16:19],s66 offen offset:3328 nt
v_cvt_pk_bf16_f32 v232,v232,v233
v_cvt_pk_bf16_f32 v213,v214,v215
v_pk_mul_f32 v[96:97],v[96:97],v[64:65] op_sel_hi:[1,0]
v_pk_mul_f32 v[98:99],v[98:99],v[64:65] op_sel_hi:[1,0]
v_pk_mul_f32 v[104:105],v[104:105],v[64:65] op_sel_hi:[1,0]
v_pk_mul_f32 v[106:107],v[106:107],v[64:65] op_sel_hi:[1,0]
v_cvt_pk_bf16_f32 v229,v230,v231
v_cvt_pk_bf16_f32 v220,v220,v221
v_mfma_f32_16x16x32_bf16 v[80:83],v[132:135],a[188:191],v[80:83]
s_mul_i32 s30,s63,196608
v_cvt_pk_bf16_f32 v236,v236,v237
v_cvt_pk_bf16_f32 v217,v218,v219
v_mfma_f32_16x16x32_bf16 v[88:91],v[132:135],a[212:215],v[88:91]
s_mul_i32 s41,s63,325632
ds_write2st64_b64 v37,v[212:213],v[228:229] offset0:12 offset1:14
v_cvt_pk_bf16_f32 v233,v234,v235
v_cvt_pk_bf16_f32 v240,v240,v241
v_cvt_pk_bf16_f32 v76,v76,v77
ds_read_b128 v[132:135],v1 offset:0
v_cvt_pk_bf16_f32 v221,v222,v223
v_cvt_pk_bf16_f32 v237,v238,v239
v_cvt_pk_bf16_f32 v241,v242,v243
v_cvt_pk_bf16_f32 v77,v78,v79
v_cvt_pk_bf16_f32 v244,v244,v245
ds_write2st64_b64 v38,v[216:217],v[232:233] offset0:12 offset1:14
v_cvt_pk_bf16_f32 v100,v100,v101
v_cvt_pk_bf16_f32 v248,v248,v249
v_cvt_pk_bf16_f32 v84,v84,v85
v_cvt_pk_bf16_f32 v245,v246,v247
v_cvt_pk_bf16_f32 v101,v102,v103
v_accvgpr_read_b32 v108,a24
v_accvgpr_read_b32 v109,a25
v_accvgpr_read_b32 v110,a26
v_accvgpr_read_b32 v111,a27
v_accvgpr_read_b32 v214,a42
v_accvgpr_read_b32 v215,a43
ds_write2st64_b64 v39,v[220:221],v[236:237] offset0:12 offset1:14
v_accvgpr_read_b32 v212,a40
v_accvgpr_read_b32 v213,a41
v_cvt_pk_bf16_f32 v249,v250,v251
v_cvt_pk_bf16_f32 v85,v86,v87
v_cvt_pk_bf16_f32 v252,v252,v253
v_cvt_pk_bf16_f32 v92,v92,v93
v_cvt_pk_bf16_f32 v253,v254,v255
v_cvt_pk_bf16_f32 v93,v94,v95
v_accvgpr_read_b32 v230,a30
v_accvgpr_read_b32 v231,a31
v_accvgpr_read_b32 v218,a46
ds_write2st64_b64 v36,v[240:241],v[76:77] offset0:16 offset1:24
v_mfma_f32_16x16x32_bf16 v[76:79],v[136:139],a[144:147],0
s_lshl_b32 s63,s3,2
v_accvgpr_read_b32 v219,a47
v_accvgpr_read_b32 v228,a28
v_accvgpr_read_b32 v229,a29
v_accvgpr_read_b32 v216,a44
v_accvgpr_read_b32 v217,a45
v_pk_mul_f32 v[108:109],v[108:109],v[64:65] op_sel_hi:[1,0]
v_pk_mul_f32 v[110:111],v[110:111],v[64:65] op_sel_hi:[1,0]
v_pk_mul_f32 v[212:213],v[212:213],v[64:65] op_sel_hi:[1,0]
v_pk_mul_f32 v[214:215],v[214:215],v[64:65] op_sel_hi:[1,0]
ds_write2st64_b64 v37,v[244:245],v[100:101] offset0:16 offset1:24
v_rcp_f32 v60,v60
v_cvt_pk_bf16_f32 v208,v208,v209
v_cvt_pk_bf16_f32 v224,v224,v225
v_cvt_pk_bf16_f32 v96,v96,v97
v_cvt_pk_bf16_f32 v104,v104,v105
v_cvt_pk_bf16_f32 v209,v210,v211
v_cvt_pk_bf16_f32 v225,v226,v227
v_cvt_pk_bf16_f32 v97,v98,v99
v_cvt_pk_bf16_f32 v105,v106,v107
v_max3_f32 v40,v72,v73,v74
ds_write2st64_b64 v38,v[248:249],v[84:85] offset0:16 offset1:24
v_mfma_f32_16x16x32_bf16 v[84:87],v[136:139],a[168:171],0
s_add_u32 s64,s63,21
v_max3_f32 v44,v80,v81,v82
v_max3_f32 v48,v88,v89,v90
v_cvt_pk_bf16_f32 v108,v108,v109
v_cvt_pk_bf16_f32 v212,v212,v213
v_cvt_pk_bf16_f32 v109,v110,v111
v_cvt_pk_bf16_f32 v213,v214,v215
v_mov_b32 v66,0
v_mov_b32 v67,0
v_mov_b32 v62,0
ds_write2st64_b64 v39,v[252:253],v[92:93] offset0:16 offset1:24
v_mfma_f32_16x16x32_bf16 v[92:95],v[136:139],a[192:195],0
s_cmp_eq_u32 s3,0
v_mov_b32 v63,0
s_cselect_b32 s64,20,s64
v_mfma_f32_16x16x32_bf16 v[76:79],v[140:143],a[148:151],v[76:79]
s_cselect_b32 s40,1,0
ds_read_b128 v[136:139],v0 offset:128
s_add_u32 s65,s63,37
s_cmp_eq_u32 s62,2
s_cselect_b32 s64,s65,s64
s_cselect_b32 s40,0,s40
ds_write2st64_b64 v36,v[208:209],v[224:225] offset0:26 offset1:28
v_pk_mul_f32 v[228:229],v[228:229],v[64:65] op_sel_hi:[1,0]
v_pk_mul_f32 v[230:231],v[230:231],v[64:65] op_sel_hi:[1,0]
v_pk_mul_f32 v[216:217],v[216:217],v[64:65] op_sel_hi:[1,0]
v_pk_mul_f32 v[218:219],v[218:219],v[64:65] op_sel_hi:[1,0]
v_cvt_pk_bf16_f32 v228,v228,v229
v_cvt_pk_bf16_f32 v216,v216,v217
v_mfma_f32_16x16x32_bf16 v[84:87],v[140:143],a[172:175],v[84:87]
s_add_u32 s65,s63,s3
v_cvt_pk_bf16_f32 v229,v230,v231
v_cvt_pk_bf16_f32 v217,v218,v219
v_mfma_f32_16x16x32_bf16 v[92:95],v[140:143],a[196:199],v[92:95]
s_cmp_eq_u32 s62,0
ds_read_b128 v[140:143],v1 offset:128
v_mov_b32 v64,0
v_mfma_f32_16x16x32_bf16 v[76:79],v[112:115],a[152:155],v[76:79]
s_cselect_b32 s64,s65,s64
ds_write2st64_b64 v37,v[96:97],v[104:105] offset0:26 offset1:28
v_pk_mul_f32 v[160:161],v[160:161],v[60:61] op_sel_hi:[1,0]
v_pk_mul_f32 v[162:163],v[162:163],v[60:61] op_sel_hi:[1,0]
v_pk_mul_f32 v[176:177],v[176:177],v[60:61] op_sel_hi:[1,0]
v_pk_mul_f32 v[178:179],v[178:179],v[60:61] op_sel_hi:[1,0]
v_cvt_pk_bf16_f32 v160,v160,v161
v_cvt_pk_bf16_f32 v176,v176,v177
v_mfma_f32_16x16x32_bf16 v[84:87],v[112:115],a[176:179],v[84:87]
s_cselect_b32 s40,1,s40
v_cvt_pk_bf16_f32 v161,v162,v163
v_cvt_pk_bf16_f32 v177,v178,v179
v_mfma_f32_16x16x32_bf16 v[92:95],v[112:115],a[200:203],v[92:95]
s_mul_i32 s64,s64,6144
ds_read_b128 v[112:115],v0 offset:256
v_mov_b32 v65,0
s_waitcnt lgkmcnt(3)
v_mfma_f32_16x16x32_bf16 v[76:79],v[116:119],a[156:159],v[76:79]
s_add_u32 s41,s41,s64
ds_write2st64_b64 v38,v[108:109],v[212:213] offset0:26 offset1:28
v_mfma_f32_16x16x32_bf16 v[84:87],v[116:119],a[180:183],v[84:87]
s_cmp_ge_u32 s69,6
s_cselect_b32 s41,166723584,s41
s_cselect_b32 s30,100663296,s30
s_add_u32 s25,s30,s22
s_add_u32 s26,s25,12288
s_add_u32 m0,s22,0
v_pk_mul_f32 v[164:165],v[164:165],v[60:61] op_sel_hi:[1,0]
v_pk_mul_f32 v[166:167],v[166:167],v[60:61] op_sel_hi:[1,0]
v_pk_mul_f32 v[180:181],v[180:181],v[60:61] op_sel_hi:[1,0]
v_pk_mul_f32 v[182:183],v[182:183],v[60:61] op_sel_hi:[1,0]
v_cvt_pk_bf16_f32 v164,v164,v165
v_cvt_pk_bf16_f32 v180,v180,v181
v_mfma_f32_16x16x32_bf16 v[92:95],v[116:119],a[204:207],v[92:95]
s_mov_b32 s28,s41
ds_write2st64_b64 v39,v[228:229],v[216:217] offset0:26 offset1:28
v_mfma_f32_16x16x32_bf16 v[76:79],v[120:123],a[160:163],v[76:79]
s_mov_b32 s29,s24
v_cvt_pk_bf16_f32 v165,v166,v167
v_cvt_pk_bf16_f32 v181,v182,v183
v_mfma_f32_16x16x32_bf16 v[84:87],v[120:123],a[184:187],v[84:87]
ds_read_b128 v[116:119],v1 offset:256
v_pk_mul_f32 v[168:169],v[168:169],v[60:61] op_sel_hi:[1,0]
ds_write2st64_b64 v36,v[160:161],v[176:177] offset0:0 offset1:2
v_pk_mul_f32 v[170:171],v[170:171],v[60:61] op_sel_hi:[1,0]
v_pk_mul_f32 v[184:185],v[184:185],v[60:61] op_sel_hi:[1,0]
v_pk_mul_f32 v[186:187],v[186:187],v[60:61] op_sel_hi:[1,0]
v_cvt_pk_bf16_f32 v168,v168,v169
v_cvt_pk_bf16_f32 v184,v184,v185
v_mfma_f32_16x16x32_bf16 v[92:95],v[120:123],a[208:211],v[92:95]
ds_read_b128 v[120:123],v0 offset:6144
v_cvt_pk_bf16_f32 v169,v170,v171
v_mfma_f32_16x16x32_bf16 v[76:79],v[124:127],a[164:167],v[76:79]
v_cvt_pk_bf16_f32 v185,v186,v187
v_mfma_f32_16x16x32_bf16 v[84:87],v[124:127],a[188:191],v[84:87]
ds_write2st64_b64 v37,v[164:165],v[180:181] offset0:0 offset1:2
v_pk_mul_f32 v[172:173],v[172:173],v[60:61] op_sel_hi:[1,0]
v_pk_mul_f32 v[174:175],v[174:175],v[60:61] op_sel_hi:[1,0]
v_pk_mul_f32 v[188:189],v[188:189],v[60:61] op_sel_hi:[1,0]
v_pk_mul_f32 v[190:191],v[190:191],v[60:61] op_sel_hi:[1,0]
v_cvt_pk_bf16_f32 v172,v172,v173
v_max3_f32 v40,v40,v75,v76
v_mfma_f32_16x16x32_bf16 v[92:95],v[124:127],a[212:215],v[92:95]
ds_read_b128 v[124:127],v1 offset:6144
v_max3_f32 v40,v40,v77,v78
v_mfma_f32_16x16x32_bf16 v[96:99],v[128:131],a[216:219],0
ds_read_b128 v[128:131],v0 offset:6272
v_max_f32 v40,v40,v79
v_mfma_f32_16x16x32_bf16 v[96:99],v[132:135],a[220:223],v[96:99]
ds_write2st64_b64 v38,v[168:169],v[184:185] offset0:0 offset1:2
v_pk_mul_f32 v[192:193],v[192:193],v[60:61] op_sel_hi:[1,0]
v_pk_mul_f32 v[194:195],v[194:195],v[60:61] op_sel_hi:[1,0]
v_mov_b32 v41,v40
v_max3_f32 v44,v44,v83,v84
v_mfma_f32_16x16x32_bf16 v[96:99],v[136:139],a[224:227],v[96:99]
s_waitcnt lgkmcnt(3)
ds_read_b128 v[132:135],v1 offset:6272
v_permlane32_swap_b32 v41,v40
v_mfma_f32_16x16x32_bf16 v[96:99],v[140:143],a[228:231],v[96:99]
ds_read_b128 v[136:139],v0 offset:6400
v_max3_f32 v44,v44,v85,v86
v_mfma_f32_16x16x32_bf16 v[96:99],v[112:115],a[232:235],v[96:99]
ds_read_b128 v[140:143],v1 offset:6400
v_max_f32 v40,v40,v41
v_mfma_f32_16x16x32_bf16 v[96:99],v[116:119],a[236:239],v[96:99]
ds_read_b128 v[112:115],v0 offset:12544
ds_read_b128 v[116:119],v1 offset:12544
v_max_f32 v44,v44,v87
v_mov_b32 v41,v40
v_pk_mul_f32 v[196:197],v[196:197],v[60:61] op_sel_hi:[1,0]
v_pk_mul_f32 v[198:199],v[198:199],v[60:61] op_sel_hi:[1,0]
v_mov_b32 v45,v44
v_permlane16_swap_b32 v41,v40
v_mfma_f32_16x16x32_bf16 v[100:103],v[120:123],a[216:219],0
s_waitcnt lgkmcnt(5)
ds_read_b128 v[120:123],v0 offset:18432
v_max3_f32 v48,v48,v91,v92
v_mfma_f32_16x16x32_bf16 v[100:103],v[124:127],a[220:223],v[100:103]
ds_read_b128 v[124:127],v1 offset:18432
v_permlane32_swap_b32 v45,v44
v_mfma_f32_16x16x32_bf16 v[100:103],v[128:131],a[224:227],v[100:103]
ds_read_b128 v[128:131],v0 offset:12288
v_max_f32 v40,v40,v41
v_max3_f32 v48,v48,v93,v94
v_max_f32 v44,v44,v45
v_mul_f32_e64 v13,-s36,v40
v_pk_mul_f32 v[200:201],v[200:201],v[60:61] op_sel_hi:[1,0]
v_pk_mul_f32 v[202:203],v[202:203],v[60:61] op_sel_hi:[1,0]
v_max_f32 v48,v48,v95
v_mov_b32 v45,v44
s_waitcnt lgkmcnt(5)
v_mfma_f32_16x16x32_bf16 v[100:103],v[132:135],a[228:231],v[100:103]
ds_read_b128 v[132:135],v1 offset:12288
v_fma_f32 v72,v72,s36,v13
v_mfma_f32_16x16x32_bf16 v[100:103],v[136:139],a[232:235],v[100:103]
ds_read_b128 v[136:139],v0 offset:12416
v_fma_f32 v73,v73,s36,v13
v_mfma_f32_16x16x32_bf16 v[100:103],v[140:143],a[236:239],v[100:103]
ds_read_b128 v[140:143],v1 offset:12416
v_fma_f32 v74,v74,s36,v13
v_fma_f32 v75,v75,s36,v13
v_max3_f32 v52,v96,v97,v98
v_mov_b32 v49,v48
v_pk_mul_f32 v[204:205],v[204:205],v[60:61] op_sel_hi:[1,0]
v_pk_mul_f32 v[206:207],v[206:207],v[60:61] op_sel_hi:[1,0]
v_permlane16_swap_b32 v45,v44
v_exp_f32 v72,v72
v_exp_f32 v73,v73
v_exp_f32 v74,v74
v_exp_f32 v75,v75
v_max3_f32 v52,v52,v99,v100
v_permlane32_swap_b32 v49,v48
v_max_f32 v44,v44,v45
v_max3_f32 v52,v52,v101,v102
v_max_f32 v48,v48,v49
v_mul_f32_e64 v14,-s36,v44
v_cvt_pk_bf16_f32 v20,v72,v73
v_cvt_pk_bf16_f32 v21,v74,v75
s_waitcnt lgkmcnt(3)
v_mfma_f32_16x16x32_bf16 v[72:75],v[128:131],a[144:147],0
v_max_f32 v52,v52,v103
v_mov_b32 v49,v48
v_fma_f32 v80,v80,s36,v14
v_fma_f32 v81,v81,s36,v14
v_fma_f32 v82,v82,s36,v14
v_fma_f32 v83,v83,s36,v14
v_mov_b32 v53,v52
v_permlane16_swap_b32 v49,v48
v_exp_f32 v80,v80
v_exp_f32 v81,v81
v_exp_f32 v82,v82
v_exp_f32 v83,v83
v_permlane32_swap_b32 v53,v52
v_max_f32 v48,v48,v49
v_max_f32 v52,v52,v53
v_mul_f32_e64 v15,-s36,v48
v_cvt_pk_bf16_f32 v24,v80,v81
v_cvt_pk_bf16_f32 v25,v82,v83
v_mfma_f32_16x16x32_bf16 v[80:83],v[128:131],a[168:171],0
v_mov_b32 v53,v52
v_fma_f32 v88,v88,s36,v15
v_fma_f32 v89,v89,s36,v15
v_fma_f32 v90,v90,s36,v15
v_fma_f32 v91,v91,s36,v15
v_permlane16_swap_b32 v53,v52
v_exp_f32 v88,v88
v_exp_f32 v89,v89
v_exp_f32 v90,v90
v_exp_f32 v91,v91
v_max_f32 v52,v52,v53
v_mul_f32_e64 v16,-s36,v52
v_cvt_pk_bf16_f32 v28,v88,v89
v_cvt_pk_bf16_f32 v29,v90,v91
v_mfma_f32_16x16x32_bf16 v[88:91],v[128:131],a[192:195],0
v_fma_f32 v96,v96,s36,v16
v_fma_f32 v97,v97,s36,v16
v_fma_f32 v98,v98,s36,v16
v_fma_f32 v99,v99,s36,v16
v_exp_f32 v96,v96
v_exp_f32 v97,v97
v_exp_f32 v98,v98
v_exp_f32 v99,v99
v_cvt_pk_bf16_f32 v32,v96,v97
v_cvt_pk_bf16_f32 v33,v98,v99
v_mfma_f32_16x16x32_bf16 v[96:99],v[128:131],a[216:219],0
s_waitcnt lgkmcnt(0)
ds_read_b128 v[128:131],v0 offset:18560
v_fma_f32 v76,v76,s36,v13
v_mfma_f32_16x16x32_bf16 v[72:75],v[132:135],a[148:151],v[72:75]
v_fma_f32 v77,v77,s36,v13
v_fma_f32 v78,v78,s36,v13
v_mfma_f32_16x16x32_bf16 v[80:83],v[132:135],a[172:175],v[80:83]
v_fma_f32 v79,v79,s36,v13
v_exp_f32 v76,v76
v_mfma_f32_16x16x32_bf16 v[88:91],v[132:135],a[196:199],v[88:91]
v_exp_f32 v77,v77
v_mfma_f32_16x16x32_bf16 v[96:99],v[132:135],a[220:223],v[96:99]
ds_read_b128 v[132:135],v1 offset:18560
v_exp_f32 v78,v78
v_mfma_f32_16x16x32_bf16 v[72:75],v[136:139],a[152:155],v[72:75]
v_exp_f32 v79,v79
v_mfma_f32_16x16x32_bf16 v[80:83],v[136:139],a[176:179],v[80:83]
v_fma_f32 v84,v84,s36,v14
v_fma_f32 v85,v85,s36,v14
v_mfma_f32_16x16x32_bf16 v[88:91],v[136:139],a[200:203],v[88:91]
v_fma_f32 v86,v86,s36,v14
v_fma_f32 v87,v87,s36,v14
v_mfma_f32_16x16x32_bf16 v[96:99],v[136:139],a[224:227],v[96:99]
ds_read_b128 v[136:139],v0 offset:18688
v_cvt_pk_bf16_f32 v22,v76,v77
v_mfma_f32_16x16x32_bf16 v[72:75],v[140:143],a[156:159],v[72:75]
v_cvt_pk_bf16_f32 v23,v78,v79
v_exp_f32 v84,v84
v_mfma_f32_16x16x32_bf16 v[80:83],v[140:143],a[180:183],v[80:83]
v_exp_f32 v85,v85
v_mfma_f32_16x16x32_bf16 v[88:91],v[140:143],a[204:207],v[88:91]
v_exp_f32 v86,v86
v_mfma_f32_16x16x32_bf16 v[96:99],v[140:143],a[228:231],v[96:99]
ds_read_b128 v[140:143],v1 offset:18688
v_exp_f32 v87,v87
v_mfma_f32_16x16x32_bf16 v[72:75],v[112:115],a[160:163],v[72:75]
v_fma_f32 v92,v92,s36,v15
s_waitcnt vmcnt(9)
s_barrier
v_mfma_f32_16x16x32_bf16 v[80:83],v[112:115],a[184:187],v[80:83]
v_fma_f32 v93,v93,s36,v15
v_fma_f32 v94,v94,s36,v15
v_mfma_f32_16x16x32_bf16 v[88:91],v[112:115],a[208:211],v[88:91]
buffer_load_dwordx4 v6,s[4:7],s20 offen offset:0 lds
v_mfma_f32_16x16x32_bf16 v[96:99],v[112:115],a[232:235],v[96:99]
v_fma_f32 v95,v95,s36,v15
v_cvt_pk_bf16_f32 v26,v84,v85
v_mfma_f32_16x16x32_bf16 v[72:75],v[116:119],a[164:167],v[72:75]
v_cvt_pk_bf16_f32 v27,v86,v87
v_exp_f32 v92,v92
v_mfma_f32_16x16x32_bf16 v[80:83],v[116:119],a[188:191],v[80:83]
v_exp_f32 v93,v93
v_mfma_f32_16x16x32_bf16 v[88:91],v[116:119],a[212:215],v[88:91]
v_exp_f32 v94,v94
v_mfma_f32_16x16x32_bf16 v[96:99],v[116:119],a[236:239],v[96:99]
buffer_load_dwordx4 v7,s[4:7],s20 offen offset:1024 lds
v_mfma_f32_16x16x32_bf16 v[76:79],v[120:123],a[144:147],0
v_exp_f32 v95,v95
v_mfma_f32_16x16x32_bf16 v[84:87],v[120:123],a[168:171],0
v_fma_f32 v100,v100,s36,v16
v_fma_f32 v101,v101,s36,v16
v_fma_f32 v102,v102,s36,v16
v_fma_f32 v103,v103,s36,v16
ds_read_b64_tr_b16 v[112:113],v2 offset:0
ds_read_b64_tr_b16 v[114:115],v2 offset:6144
v_cvt_pk_bf16_f32 v30,v92,v93
v_cvt_pk_bf16_f32 v31,v94,v95
v_mfma_f32_16x16x32_bf16 v[92:95],v[120:123],a[192:195],0
v_exp_f32 v100,v100
buffer_load_dwordx4 v8,s[4:7],s20 offen offset:2048 lds
ds_read_b64_tr_b16 v[116:117],v3 offset:0
ds_read_b64_tr_b16 v[118:119],v3 offset:6144
v_exp_f32 v101,v101
v_exp_f32 v102,v102
v_exp_f32 v103,v103
v_cvt_pk_bf16_f32 v34,v100,v101
v_cvt_pk_bf16_f32 v35,v102,v103
v_mfma_f32_16x16x32_bf16 v[100:103],v[120:123],a[216:219],0
s_add_u32 s20,s20,12288
ds_read_b64_tr_b16 v[120:121],v4 offset:0
ds_read_b64_tr_b16 v[122:123],v4 offset:6144
v_smfmac_f32_16x16x64_bf16 v[64:67],v[152:155],v[28:35],v18
v_cvt_pk_bf16_f32 v188,v188,v189
v_mfma_f32_16x16x32_bf16 v[76:79],v[124:127],a[148:151],v[76:79]
v_mov_b32 v60,0
v_mov_b32 v61,0
v_mfma_f32_16x16x32_bf16 v[84:87],v[124:127],a[172:175],v[84:87]
v_cvt_pk_bf16_f32 v173,v174,v175
v_cvt_pk_bf16_f32 v192,v192,v193
v_smfmac_f32_16x16x64_bf16 v[60:63],v[152:155],v[20:27],v18
v_cvt_pk_bf16_f32 v189,v190,v191
v_mfma_f32_16x16x32_bf16 v[92:95],v[124:127],a[196:199],v[92:95]
ds_write2st64_b64 v39,v[172:173],v[188:189] offset0:0 offset1:2
v_mfma_f32_16x16x32_bf16 v[100:103],v[124:127],a[220:223],v[100:103]
s_waitcnt lgkmcnt(3)
v_cvt_pk_bf16_f32 v196,v196,v197
v_fma_f32 v72,v72,s36,v13
v_mfma_f32_16x16x32_bf16 v[76:79],v[128:131],a[152:155],v[76:79]
ds_read_b64_tr_b16 v[124:125],v5 offset:0
ds_read_b64_tr_b16 v[126:127],v5 offset:6144
v_mfma_f32_16x16x32_bf16 v[84:87],v[128:131],a[176:179],v[84:87]
v_fma_f32 v73,v73,s36,v13
v_fma_f32 v74,v74,s36,v13
v_mfma_f32_16x16x32_bf16 v[92:95],v[128:131],a[200:203],v[92:95]
v_fma_f32 v75,v75,s36,v13
v_fma_f32 v80,v80,s36,v14
v_mfma_f32_16x16x32_bf16 v[100:103],v[128:131],a[224:227],v[100:103]
v_fma_f32 v81,v81,s36,v14
v_cvt_pk_bf16_f32 v193,v194,v195
v_mfma_f32_16x16x32_bf16 v[76:79],v[132:135],a[156:159],v[76:79]
ds_write_b64 v36,v[192:193] offset:2048
v_mfma_f32_16x16x32_bf16 v[84:87],v[132:135],a[180:183],v[84:87]
v_cvt_pk_bf16_f32 v200,v200,v201
v_cvt_pk_bf16_f32 v197,v198,v199
v_mfma_f32_16x16x32_bf16 v[92:95],v[132:135],a[204:207],v[92:95]
ds_write_b64 v37,v[196:197] offset:2048
v_mfma_f32_16x16x32_bf16 v[100:103],v[132:135],a[228:231],v[100:103]
v_exp_f32 v72,v72
v_mfma_f32_16x16x32_bf16 v[76:79],v[136:139],a[160:163],v[76:79]
v_exp_f32 v73,v73
v_mfma_f32_16x16x32_bf16 v[84:87],v[136:139],a[184:187],v[84:87]
v_exp_f32 v74,v74
v_mfma_f32_16x16x32_bf16 v[92:95],v[136:139],a[208:211],v[92:95]
v_exp_f32 v75,v75
v_mfma_f32_16x16x32_bf16 v[100:103],v[136:139],a[232:235],v[100:103]
v_exp_f32 v80,v80
v_mfma_f32_16x16x32_bf16 v[76:79],v[140:143],a[164:167],v[76:79]
v_exp_f32 v81,v81
v_mfma_f32_16x16x32_bf16 v[84:87],v[140:143],a[188:191],v[84:87]
v_cvt_pk_bf16_f32 v204,v204,v205
v_cvt_pk_bf16_f32 v201,v202,v203
v_mfma_f32_16x16x32_bf16 v[92:95],v[140:143],a[212:215],v[92:95]
ds_write_b64 v38,v[200:201] offset:2048
v_mfma_f32_16x16x32_bf16 v[100:103],v[140:143],a[236:239],v[100:103]
v_cvt_pk_bf16_f32 v205,v206,v207
v_cvt_pk_bf16_f32 v40,v72,v73
ds_write_b64 v39,v[204:205] offset:2048
v_cvt_pk_bf16_f32 v41,v74,v75
v_cvt_pk_bf16_f32 v44,v80,v81
v_mfma_f32_16x16x32_bf16 v[160:163],v[112:115],v[20:23],0
s_add_u32 m0,s23,0
ds_read_b64_tr_b16 v[128:129],v2 offset:128
ds_read_b64_tr_b16 v[130:131],v2 offset:6272
v_mfma_f32_16x16x32_bf16 v[208:211],v[112:115],v[24:27],0
ds_read_b64_tr_b16 v[132:133],v3 offset:128
ds_read_b64_tr_b16 v[134:135],v3 offset:6272
v_mfma_f32_16x16x32_bf16 a[0:3],v[112:115],v[28:31],0
ds_read_b64_tr_b16 v[136:137],v4 offset:128
ds_read_b64_tr_b16 v[138:139],v4 offset:6272
v_mfma_f32_16x16x32_bf16 a[48:51],v[112:115],v[32:35],0
ds_read_b64_tr_b16 v[140:141],v5 offset:128
ds_read_b64_tr_b16 v[142:143],v5 offset:6272
v_mfma_f32_16x16x32_bf16 v[164:167],v[116:119],v[20:23],0
ds_read_b64_tr_b16 v[112:113],v2 offset:256
ds_read_b64_tr_b16 v[114:115],v2 offset:6400
v_mfma_f32_16x16x32_bf16 v[212:215],v[116:119],v[24:27],0
v_fma_f32 v82,v82,s36,v14
v_fma_f32 v83,v83,s36,v14
v_mfma_f32_16x16x32_bf16 a[4:7],v[116:119],v[28:31],0
v_exp_f32 v82,v82
v_mfma_f32_16x16x32_bf16 a[52:55],v[116:119],v[32:35],0
s_waitcnt lgkmcnt(10)
ds_read_b64_tr_b16 v[116:117],v3 offset:256
ds_read_b64_tr_b16 v[118:119],v3 offset:6400
v_mfma_f32_16x16x32_bf16 v[168:171],v[120:123],v[20:23],0
v_exp_f32 v83,v83
v_mfma_f32_16x16x32_bf16 v[216:219],v[120:123],v[24:27],0
v_cvt_pk_bf16_f32 v45,v82,v83
v_fma_f32 v88,v88,s36,v15
v_mfma_f32_16x16x32_bf16 a[8:11],v[120:123],v[28:31],0
v_fma_f32 v89,v89,s36,v15
v_fma_f32 v90,v90,s36,v15
v_mfma_f32_16x16x32_bf16 a[56:59],v[120:123],v[32:35],0
ds_read_b64_tr_b16 v[120:121],v4 offset:256
ds_read_b64_tr_b16 v[122:123],v4 offset:6400
v_mfma_f32_16x16x32_bf16 v[172:175],v[124:127],v[20:23],0
v_fma_f32 v91,v91,s36,v15
v_fma_f32 v96,v96,s36,v16
v_mfma_f32_16x16x32_bf16 v[220:223],v[124:127],v[24:27],0
v_exp_f32 v88,v88
v_mfma_f32_16x16x32_bf16 a[12:15],v[124:127],v[28:31],0
v_exp_f32 v89,v89
v_mfma_f32_16x16x32_bf16 a[60:63],v[124:127],v[32:35],0
s_waitcnt lgkmcnt(3)
ds_read_b64_tr_b16 v[124:125],v5 offset:256
ds_read_b64_tr_b16 v[126:127],v5 offset:6400
v_mfma_f32_16x16x32_bf16 v[176:179],v[128:131],v[20:23],0
v_exp_f32 v90,v90
v_mfma_f32_16x16x32_bf16 v[224:227],v[128:131],v[24:27],0
v_exp_f32 v91,v91
v_mfma_f32_16x16x32_bf16 a[16:19],v[128:131],v[28:31],0
v_cvt_pk_bf16_f32 v48,v88,v89
v_cvt_pk_bf16_f32 v49,v90,v91
v_mfma_f32_16x16x32_bf16 a[64:67],v[128:131],v[32:35],0
v_fma_f32 v97,v97,s36,v16
v_fma_f32 v98,v98,s36,v16
v_mfma_f32_16x16x32_bf16 v[180:183],v[132:135],v[20:23],0
v_fma_f32 v99,v99,s36,v16
v_fma_f32 v76,v76,s36,v13
v_mfma_f32_16x16x32_bf16 v[228:231],v[132:135],v[24:27],0
v_exp_f32 v96,v96
v_mfma_f32_16x16x32_bf16 a[20:23],v[132:135],v[28:31],0
v_exp_f32 v97,v97
v_mfma_f32_16x16x32_bf16 a[68:71],v[132:135],v[32:35],0
v_exp_f32 v98,v98
v_mfma_f32_16x16x32_bf16 v[184:187],v[136:139],v[20:23],0
v_exp_f32 v99,v99
v_mfma_f32_16x16x32_bf16 v[232:235],v[136:139],v[24:27],0
v_cvt_pk_bf16_f32 v52,v96,v97
v_cvt_pk_bf16_f32 v53,v98,v99
v_mfma_f32_16x16x32_bf16 a[24:27],v[136:139],v[28:31],0
v_fma_f32 v77,v77,s36,v13
v_fma_f32 v78,v78,s36,v13
v_mfma_f32_16x16x32_bf16 a[72:75],v[136:139],v[32:35],0
v_fma_f32 v79,v79,s36,v13
v_fma_f32 v84,v84,s36,v14
v_mfma_f32_16x16x32_bf16 v[188:191],v[140:143],v[20:23],0
v_exp_f32 v76,v76
v_mfma_f32_16x16x32_bf16 v[236:239],v[140:143],v[24:27],0
v_exp_f32 v77,v77
v_mfma_f32_16x16x32_bf16 a[28:31],v[140:143],v[28:31],0
v_exp_f32 v78,v78
v_mfma_f32_16x16x32_bf16 a[76:79],v[140:143],v[32:35],0
v_exp_f32 v79,v79
v_mfma_f32_16x16x32_bf16 v[192:195],v[112:115],v[20:23],0
v_cvt_pk_bf16_f32 v42,v76,v77
v_cvt_pk_bf16_f32 v43,v78,v79
s_waitcnt vmcnt(30) lgkmcnt(0)
v_mfma_f32_16x16x32_bf16 v[240:243],v[112:115],v[24:27],0
s_barrier
v_mfma_f32_16x16x32_bf16 a[32:35],v[112:115],v[28:31],0
ds_read_b128 v[128:131],v0 offset:24576
v_fma_f32 v85,v85,s36,v14
v_mfma_f32_16x16x32_bf16 a[80:83],v[112:115],v[32:35],0
ds_read_b128 v[132:135],v1 offset:24576
v_fma_f32 v86,v86,s36,v14
v_mfma_f32_16x16x32_bf16 v[196:199],v[116:119],v[20:23],0
ds_read_b128 v[136:139],v0 offset:24704
v_fma_f32 v87,v87,s36,v14
v_mfma_f32_16x16x32_bf16 v[244:247],v[116:119],v[24:27],0
ds_read_b128 v[140:143],v1 offset:24704
v_fma_f32 v92,v92,s36,v15
v_mfma_f32_16x16x32_bf16 a[36:39],v[116:119],v[28:31],0
ds_read_b128 v[112:115],v0 offset:24832
v_fma_f32 v93,v93,s36,v15
v_mfma_f32_16x16x32_bf16 a[84:87],v[116:119],v[32:35],0
buffer_load_dwordx4 v6,s[8:11],s21 offen offset:0 lds
v_mfma_f32_16x16x32_bf16 v[200:203],v[120:123],v[20:23],0
ds_read_b128 v[116:119],v1 offset:24832
v_fma_f32 v94,v94,s36,v15
v_mfma_f32_16x16x32_bf16 v[248:251],v[120:123],v[24:27],0
v_exp_f32 v84,v84
v_mfma_f32_16x16x32_bf16 a[40:43],v[120:123],v[28:31],0
v_exp_f32 v85,v85
v_mfma_f32_16x16x32_bf16 a[88:91],v[120:123],v[32:35],0
ds_read_b128 v[120:123],v0 offset:30720
v_cvt_pk_bf16_f32 v46,v84,v85
v_mfma_f32_16x16x32_bf16 v[204:207],v[124:127],v[20:23],0
v_exp_f32 v86,v86
v_mfma_f32_16x16x32_bf16 v[252:255],v[124:127],v[24:27],0
v_exp_f32 v87,v87
v_mfma_f32_16x16x32_bf16 a[44:47],v[124:127],v[28:31],0
v_cvt_pk_bf16_f32 v47,v86,v87
v_fma_f32 v95,v95,s36,v15
v_mfma_f32_16x16x32_bf16 a[92:95],v[124:127],v[32:35],0
ds_read_b128 v[124:127],v1 offset:30720
v_fma_f32 v100,v100,s36,v16
v_smfmac_f32_16x16x64_bf16 v[60:63],v[152:155],v[40:47],v18
buffer_load_dwordx4 v7,s[8:11],s21 offen offset:1024 lds
s_waitcnt lgkmcnt(2)
v_mfma_f32_16x16x32_bf16 v[72:75],v[128:131],a[144:147],0
v_exp_f32 v92,v92
v_mfma_f32_16x16x32_bf16 v[80:83],v[128:131],a[168:171],0
v_exp_f32 v93,v93
v_mfma_f32_16x16x32_bf16 v[88:91],v[128:131],a[192:195],0
v_exp_f32 v94,v94
v_mfma_f32_16x16x32_bf16 v[96:99],v[128:131],a[216:219],0
ds_read_b128 v[128:131],v0 offset:30848
v_cvt_pk_bf16_f32 v50,v92,v93
v_mfma_f32_16x16x32_bf16 v[72:75],v[132:135],a[148:151],v[72:75]
v_exp_f32 v95,v95
v_mfma_f32_16x16x32_bf16 v[80:83],v[132:135],a[172:175],v[80:83]
v_cvt_pk_bf16_f32 v51,v94,v95
v_fma_f32 v101,v101,s36,v16
v_mfma_f32_16x16x32_bf16 v[88:91],v[132:135],a[196:199],v[88:91]
v_fma_f32 v102,v102,s36,v16
v_fma_f32 v103,v103,s36,v16
v_mfma_f32_16x16x32_bf16 v[96:99],v[132:135],a[220:223],v[96:99]
v_exp_f32 v100,v100
v_mfma_f32_16x16x32_bf16 v[72:75],v[136:139],a[152:155],v[72:75]
buffer_load_dwordx4 v8,s[8:11],s21 offen offset:2048 lds
v_mfma_f32_16x16x32_bf16 v[80:83],v[136:139],a[176:179],v[80:83]
s_add_u32 s21,s21,12288
v_exp_f32 v101,v101
v_mfma_f32_16x16x32_bf16 v[88:91],v[136:139],a[200:203],v[88:91]
s_add_u32 m0,s22,12288
v_exp_f32 v102,v102
v_mfma_f32_16x16x32_bf16 v[96:99],v[136:139],a[224:227],v[96:99]
v_exp_f32 v103,v103
v_mfma_f32_16x16x32_bf16 v[72:75],v[140:143],a[156:159],v[72:75]
v_cvt_pk_bf16_f32 v54,v100,v101
v_cvt_pk_bf16_f32 v55,v102,v103
v_mfma_f32_16x16x32_bf16 v[80:83],v[140:143],a[180:183],v[80:83]
ds_read_b128 v[132:135],v1 offset:30848
v_smfmac_f32_16x16x64_bf16 v[64:67],v[152:155],v[48:55],v18
ds_read_b128 v[136:139],v0 offset:30976
v_mfma_f32_16x16x32_bf16 v[88:91],v[140:143],a[204:207],v[88:91]
v_mfma_f32_16x16x32_bf16 v[96:99],v[140:143],a[228:231],v[96:99]
ds_read_b128 v[140:143],v1 offset:30976
v_mfma_f32_16x16x32_bf16 v[72:75],v[112:115],a[160:163],v[72:75]
buffer_load_dwordx4 v6,s[4:7],s20 offen offset:0 lds
v_mfma_f32_16x16x32_bf16 v[80:83],v[112:115],a[184:187],v[80:83]
v_mfma_f32_16x16x32_bf16 v[88:91],v[112:115],a[208:211],v[88:91]
v_mfma_f32_16x16x32_bf16 v[96:99],v[112:115],a[232:235],v[96:99]
v_mfma_f32_16x16x32_bf16 v[72:75],v[116:119],a[164:167],v[72:75]
v_mfma_f32_16x16x32_bf16 v[80:83],v[116:119],a[188:191],v[80:83]
v_mfma_f32_16x16x32_bf16 v[88:91],v[116:119],a[212:215],v[88:91]
v_mfma_f32_16x16x32_bf16 v[96:99],v[116:119],a[236:239],v[96:99]
s_waitcnt lgkmcnt(0)
v_mfma_f32_16x16x32_bf16 v[76:79],v[120:123],a[144:147],0
buffer_load_dwordx4 v7,s[4:7],s20 offen offset:1024 lds
v_mfma_f32_16x16x32_bf16 v[84:87],v[120:123],a[168:171],0
v_mfma_f32_16x16x32_bf16 v[92:95],v[120:123],a[192:195],0
v_mfma_f32_16x16x32_bf16 v[100:103],v[120:123],a[216:219],0
v_fma_f32 v72,v72,s36,v13
v_fma_f32 v73,v73,s36,v13
v_mfma_f32_16x16x32_bf16 v[76:79],v[124:127],a[148:151],v[76:79]
v_fma_f32 v74,v74,s36,v13
v_fma_f32 v75,v75,s36,v13
v_mfma_f32_16x16x32_bf16 v[84:87],v[124:127],a[172:175],v[84:87]
v_fma_f32 v80,v80,s36,v14
v_fma_f32 v81,v81,s36,v14
v_mfma_f32_16x16x32_bf16 v[92:95],v[124:127],a[196:199],v[92:95]
v_exp_f32 v72,v72
v_mfma_f32_16x16x32_bf16 v[100:103],v[124:127],a[220:223],v[100:103]
v_exp_f32 v73,v73
v_mfma_f32_16x16x32_bf16 v[76:79],v[128:131],a[152:155],v[76:79]
v_exp_f32 v74,v74
v_mfma_f32_16x16x32_bf16 v[84:87],v[128:131],a[176:179],v[84:87]
buffer_load_dwordx4 v8,s[4:7],s20 offen offset:2048 lds
v_mfma_f32_16x16x32_bf16 v[92:95],v[128:131],a[200:203],v[92:95]
s_add_u32 s20,s20,12288
v_exp_f32 v75,v75
v_mfma_f32_16x16x32_bf16 v[100:103],v[128:131],a[224:227],v[100:103]
ds_read_b64_tr_b16 v[112:113],v2 offset:12288
ds_read_b64_tr_b16 v[114:115],v2 offset:18432
v_mfma_f32_16x16x32_bf16 v[76:79],v[132:135],a[156:159],v[76:79]
v_exp_f32 v80,v80
v_mfma_f32_16x16x32_bf16 v[84:87],v[132:135],a[180:183],v[84:87]
ds_read_b64_tr_b16 v[116:117],v3 offset:12288
ds_read_b64_tr_b16 v[118:119],v3 offset:18432
v_mfma_f32_16x16x32_bf16 v[92:95],v[132:135],a[204:207],v[92:95]
v_exp_f32 v81,v81
v_mfma_f32_16x16x32_bf16 v[100:103],v[132:135],a[228:231],v[100:103]
ds_read_b64_tr_b16 v[120:121],v4 offset:12288
ds_read_b64_tr_b16 v[122:123],v4 offset:18432
v_mfma_f32_16x16x32_bf16 v[76:79],v[136:139],a[160:163],v[76:79]
v_cvt_pk_bf16_f32 v20,v72,v73
v_cvt_pk_bf16_f32 v21,v74,v75
v_mfma_f32_16x16x32_bf16 v[84:87],v[136:139],a[184:187],v[84:87]
ds_read_b64_tr_b16 v[124:125],v5 offset:12288
ds_read_b64_tr_b16 v[126:127],v5 offset:18432
v_mfma_f32_16x16x32_bf16 v[92:95],v[136:139],a[208:211],v[92:95]
v_cvt_pk_bf16_f32 v24,v80,v81
v_mfma_f32_16x16x32_bf16 v[100:103],v[136:139],a[232:235],v[100:103]
v_mfma_f32_16x16x32_bf16 v[76:79],v[140:143],a[164:167],v[76:79]
v_mfma_f32_16x16x32_bf16 v[84:87],v[140:143],a[188:191],v[84:87]
v_mfma_f32_16x16x32_bf16 v[92:95],v[140:143],a[212:215],v[92:95]
v_mfma_f32_16x16x32_bf16 v[100:103],v[140:143],a[236:239],v[100:103]
s_waitcnt lgkmcnt(4)
v_mfma_f32_16x16x32_bf16 v[160:163],v[112:115],v[40:43],v[160:163]
s_add_u32 m0,s23,12288
ds_read_b64_tr_b16 v[128:129],v2 offset:12416
ds_read_b64_tr_b16 v[130:131],v2 offset:18560
v_mfma_f32_16x16x32_bf16 v[208:211],v[112:115],v[44:47],v[208:211]
ds_read_b64_tr_b16 v[132:133],v3 offset:12416
ds_read_b64_tr_b16 v[134:135],v3 offset:18560
v_mfma_f32_16x16x32_bf16 a[0:3],v[112:115],v[48:51],a[0:3]
ds_read_b64_tr_b16 v[136:137],v4 offset:12416
ds_read_b64_tr_b16 v[138:139],v4 offset:18560
v_mfma_f32_16x16x32_bf16 a[48:51],v[112:115],v[52:55],a[48:51]
ds_read_b64_tr_b16 v[140:141],v5 offset:12416
ds_read_b64_tr_b16 v[142:143],v5 offset:18560
v_mfma_f32_16x16x32_bf16 v[164:167],v[116:119],v[40:43],v[164:167]
ds_read_b64_tr_b16 v[112:113],v2 offset:12544
ds_read_b64_tr_b16 v[114:115],v2 offset:18688
v_mfma_f32_16x16x32_bf16 v[212:215],v[116:119],v[44:47],v[212:215]
v_fma_f32 v82,v82,s36,v14
v_fma_f32 v83,v83,s36,v14
v_mfma_f32_16x16x32_bf16 a[4:7],v[116:119],v[48:51],a[4:7]
v_exp_f32 v82,v82
v_mfma_f32_16x16x32_bf16 a[52:55],v[116:119],v[52:55],a[52:55]
s_waitcnt lgkmcnt(10)
ds_read_b64_tr_b16 v[116:117],v3 offset:12544
ds_read_b64_tr_b16 v[118:119],v3 offset:18688
v_mfma_f32_16x16x32_bf16 v[168:171],v[120:123],v[40:43],v[168:171]
v_exp_f32 v83,v83
v_mfma_f32_16x16x32_bf16 v[216:219],v[120:123],v[44:47],v[216:219]
v_cvt_pk_bf16_f32 v25,v82,v83
v_fma_f32 v88,v88,s36,v15
v_mfma_f32_16x16x32_bf16 a[8:11],v[120:123],v[48:51],a[8:11]
v_fma_f32 v89,v89,s36,v15
v_fma_f32 v90,v90,s36,v15
v_mfma_f32_16x16x32_bf16 a[56:59],v[120:123],v[52:55],a[56:59]
ds_read_b64_tr_b16 v[120:121],v4 offset:12544
ds_read_b64_tr_b16 v[122:123],v4 offset:18688
v_mfma_f32_16x16x32_bf16 v[172:175],v[124:127],v[40:43],v[172:175]
v_fma_f32 v91,v91,s36,v15
v_fma_f32 v96,v96,s36,v16
v_mfma_f32_16x16x32_bf16 v[220:223],v[124:127],v[44:47],v[220:223]
v_exp_f32 v88,v88
v_mfma_f32_16x16x32_bf16 a[12:15],v[124:127],v[48:51],a[12:15]
v_exp_f32 v89,v89
v_mfma_f32_16x16x32_bf16 a[60:63],v[124:127],v[52:55],a[60:63]
s_waitcnt lgkmcnt(3)
ds_read_b64_tr_b16 v[124:125],v5 offset:12544
ds_read_b64_tr_b16 v[126:127],v5 offset:18688
v_mfma_f32_16x16x32_bf16 v[176:179],v[128:131],v[40:43],v[176:179]
v_exp_f32 v90,v90
v_mfma_f32_16x16x32_bf16 v[224:227],v[128:131],v[44:47],v[224:227]
v_exp_f32 v91,v91
v_mfma_f32_16x16x32_bf16 a[16:19],v[128:131],v[48:51],a[16:19]
v_cvt_pk_bf16_f32 v28,v88,v89
v_cvt_pk_bf16_f32 v29,v90,v91
v_mfma_f32_16x16x32_bf16 a[64:67],v[128:131],v[52:55],a[64:67]
v_fma_f32 v97,v97,s36,v16
v_fma_f32 v98,v98,s36,v16
v_mfma_f32_16x16x32_bf16 v[180:183],v[132:135],v[40:43],v[180:183]
v_fma_f32 v99,v99,s36,v16
v_fma_f32 v76,v76,s36,v13
v_mfma_f32_16x16x32_bf16 v[228:231],v[132:135],v[44:47],v[228:231]
v_exp_f32 v96,v96
v_mfma_f32_16x16x32_bf16 a[20:23],v[132:135],v[48:51],a[20:23]
v_exp_f32 v97,v97
v_mfma_f32_16x16x32_bf16 a[68:71],v[132:135],v[52:55],a[68:71]
v_exp_f32 v98,v98
v_mfma_f32_16x16x32_bf16 v[184:187],v[136:139],v[40:43],v[184:187]
v_exp_f32 v99,v99
v_mfma_f32_16x16x32_bf16 v[232:235],v[136:139],v[44:47],v[232:235]
v_cvt_pk_bf16_f32 v32,v96,v97
v_cvt_pk_bf16_f32 v33,v98,v99
v_mfma_f32_16x16x32_bf16 a[24:27],v[136:139],v[48:51],a[24:27]
v_fma_f32 v77,v77,s36,v13
v_fma_f32 v78,v78,s36,v13
v_mfma_f32_16x16x32_bf16 a[72:75],v[136:139],v[52:55],a[72:75]
v_fma_f32 v79,v79,s36,v13
v_fma_f32 v84,v84,s36,v14
v_mfma_f32_16x16x32_bf16 v[188:191],v[140:143],v[40:43],v[188:191]
v_exp_f32 v76,v76
v_mfma_f32_16x16x32_bf16 v[236:239],v[140:143],v[44:47],v[236:239]
v_exp_f32 v77,v77
v_mfma_f32_16x16x32_bf16 a[28:31],v[140:143],v[48:51],a[28:31]
v_exp_f32 v78,v78
v_mfma_f32_16x16x32_bf16 a[76:79],v[140:143],v[52:55],a[76:79]
v_exp_f32 v79,v79
v_mfma_f32_16x16x32_bf16 v[192:195],v[112:115],v[40:43],v[192:195]
v_cvt_pk_bf16_f32 v22,v76,v77
v_cvt_pk_bf16_f32 v23,v78,v79
s_waitcnt vmcnt(6) lgkmcnt(0)
v_mfma_f32_16x16x32_bf16 v[240:243],v[112:115],v[44:47],v[240:243]
s_barrier
v_mfma_f32_16x16x32_bf16 a[32:35],v[112:115],v[48:51],a[32:35]
ds_read_b128 v[128:131],v0 offset:0
v_fma_f32 v85,v85,s36,v14
v_mfma_f32_16x16x32_bf16 a[80:83],v[112:115],v[52:55],a[80:83]
ds_read_b128 v[132:135],v1 offset:0
v_fma_f32 v86,v86,s36,v14
v_mfma_f32_16x16x32_bf16 v[196:199],v[116:119],v[40:43],v[196:199]
ds_read_b128 v[136:139],v0 offset:128
v_fma_f32 v87,v87,s36,v14
v_mfma_f32_16x16x32_bf16 v[244:247],v[116:119],v[44:47],v[244:247]
ds_read_b128 v[140:143],v1 offset:128
v_fma_f32 v92,v92,s36,v15
v_mfma_f32_16x16x32_bf16 a[36:39],v[116:119],v[48:51],a[36:39]
ds_read_b128 v[112:115],v0 offset:256
v_fma_f32 v93,v93,s36,v15
v_mfma_f32_16x16x32_bf16 a[84:87],v[116:119],v[52:55],a[84:87]
buffer_load_dwordx4 v6,s[8:11],s21 offen offset:0 lds
v_mfma_f32_16x16x32_bf16 v[200:203],v[120:123],v[40:43],v[200:203]
ds_read_b128 v[116:119],v1 offset:256
v_fma_f32 v94,v94,s36,v15
v_mfma_f32_16x16x32_bf16 v[248:251],v[120:123],v[44:47],v[248:251]
v_exp_f32 v84,v84
v_mfma_f32_16x16x32_bf16 a[40:43],v[120:123],v[48:51],a[40:43]
v_exp_f32 v85,v85
v_mfma_f32_16x16x32_bf16 a[88:91],v[120:123],v[52:55],a[88:91]
ds_read_b128 v[120:123],v0 offset:6144
v_cvt_pk_bf16_f32 v26,v84,v85
v_mfma_f32_16x16x32_bf16 v[204:207],v[124:127],v[40:43],v[204:207]
v_exp_f32 v86,v86
v_mfma_f32_16x16x32_bf16 v[252:255],v[124:127],v[44:47],v[252:255]
v_exp_f32 v87,v87
v_mfma_f32_16x16x32_bf16 a[44:47],v[124:127],v[48:51],a[44:47]
v_cvt_pk_bf16_f32 v27,v86,v87
v_fma_f32 v95,v95,s36,v15
v_mfma_f32_16x16x32_bf16 a[92:95],v[124:127],v[52:55],a[92:95]
ds_read_b128 v[124:127],v1 offset:6144
v_fma_f32 v100,v100,s36,v16
v_smfmac_f32_16x16x64_bf16 v[60:63],v[152:155],v[20:27],v18
buffer_load_dwordx4 v7,s[8:11],s21 offen offset:1024 lds
s_waitcnt lgkmcnt(2)
v_mfma_f32_16x16x32_bf16 v[72:75],v[128:131],a[144:147],0
v_exp_f32 v92,v92
v_mfma_f32_16x16x32_bf16 v[80:83],v[128:131],a[168:171],0
v_exp_f32 v93,v93
v_mfma_f32_16x16x32_bf16 v[88:91],v[128:131],a[192:195],0
v_exp_f32 v94,v94
v_mfma_f32_16x16x32_bf16 v[96:99],v[128:131],a[216:219],0
ds_read_b128 v[128:131],v0 offset:6272
v_cvt_pk_bf16_f32 v30,v92,v93
v_mfma_f32_16x16x32_bf16 v[72:75],v[132:135],a[148:151],v[72:75]
v_exp_f32 v95,v95
v_mfma_f32_16x16x32_bf16 v[80:83],v[132:135],a[172:175],v[80:83]
v_cvt_pk_bf16_f32 v31,v94,v95
v_fma_f32 v101,v101,s36,v16
v_mfma_f32_16x16x32_bf16 v[88:91],v[132:135],a[196:199],v[88:91]
v_fma_f32 v102,v102,s36,v16
v_fma_f32 v103,v103,s36,v16
v_mfma_f32_16x16x32_bf16 v[96:99],v[132:135],a[220:223],v[96:99]
v_exp_f32 v100,v100
v_mfma_f32_16x16x32_bf16 v[72:75],v[136:139],a[152:155],v[72:75]
buffer_load_dwordx4 v8,s[8:11],s21 offen offset:2048 lds
v_mfma_f32_16x16x32_bf16 v[80:83],v[136:139],a[176:179],v[80:83]
s_add_u32 s21,s21,12288
v_exp_f32 v101,v101
v_mfma_f32_16x16x32_bf16 v[88:91],v[136:139],a[200:203],v[88:91]
s_add_u32 m0,s22,24576
v_exp_f32 v102,v102
v_mfma_f32_16x16x32_bf16 v[96:99],v[136:139],a[224:227],v[96:99]
v_exp_f32 v103,v103
v_mfma_f32_16x16x32_bf16 v[72:75],v[140:143],a[156:159],v[72:75]
v_cvt_pk_bf16_f32 v34,v100,v101
v_cvt_pk_bf16_f32 v35,v102,v103
v_mfma_f32_16x16x32_bf16 v[80:83],v[140:143],a[180:183],v[80:83]
ds_read_b128 v[132:135],v1 offset:6272
v_smfmac_f32_16x16x64_bf16 v[64:67],v[152:155],v[28:35],v18
ds_read_b128 v[136:139],v0 offset:6400
v_mfma_f32_16x16x32_bf16 v[88:91],v[140:143],a[204:207],v[88:91]
v_mfma_f32_16x16x32_bf16 v[96:99],v[140:143],a[228:231],v[96:99]
ds_read_b128 v[140:143],v1 offset:6400
v_mfma_f32_16x16x32_bf16 v[72:75],v[112:115],a[160:163],v[72:75]
buffer_load_dwordx4 v6,s[4:7],s20 offen offset:0 lds
v_mfma_f32_16x16x32_bf16 v[80:83],v[112:115],a[184:187],v[80:83]
v_mfma_f32_16x16x32_bf16 v[88:91],v[112:115],a[208:211],v[88:91]
v_mfma_f32_16x16x32_bf16 v[96:99],v[112:115],a[232:235],v[96:99]
v_mfma_f32_16x16x32_bf16 v[72:75],v[116:119],a[164:167],v[72:75]
v_mfma_f32_16x16x32_bf16 v[80:83],v[116:119],a[188:191],v[80:83]
v_mfma_f32_16x16x32_bf16 v[88:91],v[116:119],a[212:215],v[88:91]
v_mfma_f32_16x16x32_bf16 v[96:99],v[116:119],a[236:239],v[96:99]
s_waitcnt lgkmcnt(0)
v_mfma_f32_16x16x32_bf16 v[76:79],v[120:123],a[144:147],0
buffer_load_dwordx4 v7,s[4:7],s20 offen offset:1024 lds
v_mfma_f32_16x16x32_bf16 v[84:87],v[120:123],a[168:171],0
v_mfma_f32_16x16x32_bf16 v[92:95],v[120:123],a[192:195],0
v_mfma_f32_16x16x32_bf16 v[100:103],v[120:123],a[216:219],0
v_fma_f32 v72,v72,s36,v13
v_fma_f32 v73,v73,s36,v13
v_mfma_f32_16x16x32_bf16 v[76:79],v[124:127],a[148:151],v[76:79]
v_fma_f32 v74,v74,s36,v13
v_fma_f32 v75,v75,s36,v13
v_mfma_f32_16x16x32_bf16 v[84:87],v[124:127],a[172:175],v[84:87]
v_fma_f32 v80,v80,s36,v14
v_fma_f32 v81,v81,s36,v14
v_mfma_f32_16x16x32_bf16 v[92:95],v[124:127],a[196:199],v[92:95]
v_exp_f32 v72,v72
v_mfma_f32_16x16x32_bf16 v[100:103],v[124:127],a[220:223],v[100:103]
v_exp_f32 v73,v73
v_mfma_f32_16x16x32_bf16 v[76:79],v[128:131],a[152:155],v[76:79]
v_exp_f32 v74,v74
v_mfma_f32_16x16x32_bf16 v[84:87],v[128:131],a[176:179],v[84:87]
buffer_load_dwordx4 v8,s[4:7],s20 offen offset:2048 lds
v_mfma_f32_16x16x32_bf16 v[92:95],v[128:131],a[200:203],v[92:95]
s_add_u32 s20,s20,12288
v_exp_f32 v75,v75
v_mfma_f32_16x16x32_bf16 v[100:103],v[128:131],a[224:227],v[100:103]
ds_read_b64_tr_b16 v[112:113],v2 offset:24576
ds_read_b64_tr_b16 v[114:115],v2 offset:30720
v_mfma_f32_16x16x32_bf16 v[76:79],v[132:135],a[156:159],v[76:79]
v_exp_f32 v80,v80
v_mfma_f32_16x16x32_bf16 v[84:87],v[132:135],a[180:183],v[84:87]
ds_read_b64_tr_b16 v[116:117],v3 offset:24576
ds_read_b64_tr_b16 v[118:119],v3 offset:30720
v_mfma_f32_16x16x32_bf16 v[92:95],v[132:135],a[204:207],v[92:95]
v_exp_f32 v81,v81
v_mfma_f32_16x16x32_bf16 v[100:103],v[132:135],a[228:231],v[100:103]
ds_read_b64_tr_b16 v[120:121],v4 offset:24576
ds_read_b64_tr_b16 v[122:123],v4 offset:30720
v_mfma_f32_16x16x32_bf16 v[76:79],v[136:139],a[160:163],v[76:79]
v_cvt_pk_bf16_f32 v40,v72,v73
v_cvt_pk_bf16_f32 v41,v74,v75
v_mfma_f32_16x16x32_bf16 v[84:87],v[136:139],a[184:187],v[84:87]
ds_read_b64_tr_b16 v[124:125],v5 offset:24576
ds_read_b64_tr_b16 v[126:127],v5 offset:30720
v_mfma_f32_16x16x32_bf16 v[92:95],v[136:139],a[208:211],v[92:95]
v_cvt_pk_bf16_f32 v44,v80,v81
v_mfma_f32_16x16x32_bf16 v[100:103],v[136:139],a[232:235],v[100:103]
v_mfma_f32_16x16x32_bf16 v[76:79],v[140:143],a[164:167],v[76:79]
v_mfma_f32_16x16x32_bf16 v[84:87],v[140:143],a[188:191],v[84:87]
v_mfma_f32_16x16x32_bf16 v[92:95],v[140:143],a[212:215],v[92:95]
v_mfma_f32_16x16x32_bf16 v[100:103],v[140:143],a[236:239],v[100:103]
s_mov_b32 s38,0
s_branch L_loop4
L_tr55:
s_waitcnt vmcnt(42)
s_waitcnt lgkmcnt(4)
v_mfma_f32_16x16x32_bf16 v[160:163],v[112:115],v[20:23],v[160:163]
s_add_u32 m0,s24,0
ds_read_b128 a[144:147],v11 offset:0
v_fma_f32 v90,v90,s36,v15
v_mfma_f32_16x16x32_bf16 v[208:211],v[112:115],v[24:27],v[208:211]
ds_read_b128 a[148:151],v12 offset:0
v_fma_f32 v91,v91,s36,v15
v_mfma_f32_16x16x32_bf16 a[0:3],v[112:115],v[28:31],a[0:3]
ds_read_b128 a[152:155],v11 offset:128
v_fma_f32 v96,v96,s36,v16
v_mfma_f32_16x16x32_bf16 a[48:51],v[112:115],v[32:35],a[48:51]
ds_read_b128 a[156:159],v12 offset:128
v_fma_f32 v97,v97,s36,v16
v_mfma_f32_16x16x32_bf16 a[96:99],v[112:115],v[36:39],a[96:99]
ds_read_b128 a[160:163],v11 offset:256
v_fma_f32 v98,v98,s36,v16
v_mfma_f32_16x16x32_bf16 v[164:167],v[116:119],v[20:23],v[164:167]
ds_read_b128 a[164:167],v12 offset:256
ds_read_b64_tr_b16 v[128:129],v2 offset:24704
ds_read_b64_tr_b16 v[130:131],v2 offset:30848
ds_read_b64_tr_b16 v[132:133],v3 offset:24704
ds_read_b64_tr_b16 v[134:135],v3 offset:30848
ds_read_b64_tr_b16 v[136:137],v4 offset:24704
ds_read_b64_tr_b16 v[138:139],v4 offset:30848
ds_read_b64_tr_b16 v[140:141],v5 offset:24704
ds_read_b64_tr_b16 v[142:143],v5 offset:30848
ds_read_b64_tr_b16 v[112:113],v2 offset:24832
ds_read_b64_tr_b16 v[114:115],v2 offset:30976
ds_read_b128 a[168:171],v11 offset:6144
v_mfma_f32_16x16x32_bf16 v[212:215],v[116:119],v[24:27],v[212:215]
v_fma_f32 v99,v99,s36,v16
ds_read_b128 a[172:175],v12 offset:6144
ds_read_b128 a[176:179],v11 offset:6272
v_mfma_f32_16x16x32_bf16 a[4:7],v[116:119],v[28:31],a[4:7]
v_fma_f32 v104,v104,s36,v17
ds_read_b128 a[180:183],v12 offset:6272
ds_read_b128 a[184:187],v11 offset:6400
v_mfma_f32_16x16x32_bf16 a[52:55],v[116:119],v[32:35],a[52:55]
s_waitcnt lgkmcnt(15)
buffer_load_dwordx4 v6,s[12:15],s28 offen offset:0 nt lds
v_mfma_f32_16x16x32_bf16 a[100:103],v[116:119],v[36:39],a[100:103]
ds_read_b64_tr_b16 v[116:117],v3 offset:24832
ds_read_b64_tr_b16 v[118:119],v3 offset:30976
v_mfma_f32_16x16x32_bf16 v[168:171],v[120:123],v[20:23],v[168:171]
ds_read_b128 a[188:191],v12 offset:6400
v_fma_f32 v105,v105,s36,v17
v_mfma_f32_16x16x32_bf16 v[216:219],v[120:123],v[24:27],v[216:219]
v_fma_f32 v106,v106,s36,v17
v_fma_f32 v107,v107,s36,v17
v_mfma_f32_16x16x32_bf16 a[8:11],v[120:123],v[28:31],a[8:11]
v_fma_f32 v76,v76,s36,v13
v_fma_f32 v77,v77,s36,v13
v_mfma_f32_16x16x32_bf16 a[56:59],v[120:123],v[32:35],a[56:59]
buffer_load_dwordx4 v7,s[12:15],s28 offen offset:1024 nt lds
v_mfma_f32_16x16x32_bf16 a[104:107],v[120:123],v[36:39],a[104:107]
ds_read_b64_tr_b16 v[120:121],v4 offset:24832
ds_read_b64_tr_b16 v[122:123],v4 offset:30976
v_mfma_f32_16x16x32_bf16 v[172:175],v[124:127],v[20:23],v[172:175]
v_fma_f32 v78,v78,s36,v13
v_fma_f32 v79,v79,s36,v13
v_mfma_f32_16x16x32_bf16 v[220:223],v[124:127],v[24:27],v[220:223]
v_fma_f32 v84,v84,s36,v14
v_fma_f32 v85,v85,s36,v14
v_mfma_f32_16x16x32_bf16 a[12:15],v[124:127],v[28:31],a[12:15]
v_fma_f32 v86,v86,s36,v14
v_fma_f32 v87,v87,s36,v14
v_mfma_f32_16x16x32_bf16 a[60:63],v[124:127],v[32:35],a[60:63]
v_fma_f32 v92,v92,s36,v15
v_fma_f32 v93,v93,s36,v15
v_mfma_f32_16x16x32_bf16 a[108:111],v[124:127],v[36:39],a[108:111]
s_waitcnt lgkmcnt(2)
ds_read_b64_tr_b16 v[124:125],v5 offset:24832
ds_read_b64_tr_b16 v[126:127],v5 offset:30976
v_mfma_f32_16x16x32_bf16 v[176:179],v[128:131],v[20:23],v[176:179]
v_fma_f32 v94,v94,s36,v15
v_fma_f32 v95,v95,s36,v15
v_mfma_f32_16x16x32_bf16 v[224:227],v[128:131],v[24:27],v[224:227]
buffer_load_dwordx4 v8,s[12:15],s28 offen offset:2048 nt lds
v_mfma_f32_16x16x32_bf16 a[16:19],v[128:131],v[28:31],a[16:19]
s_add_u32 s28,s28,3072
v_fma_f32 v100,v100,s36,v16
v_fma_f32 v101,v101,s36,v16
v_mfma_f32_16x16x32_bf16 a[64:67],v[128:131],v[32:35],a[64:67]
s_add_u32 m0,s24,3072
v_fma_f32 v102,v102,s36,v16
v_fma_f32 v103,v103,s36,v16
v_mfma_f32_16x16x32_bf16 a[112:115],v[128:131],v[36:39],a[112:115]
v_fma_f32 v108,v108,s36,v17
v_fma_f32 v109,v109,s36,v17
v_mfma_f32_16x16x32_bf16 v[180:183],v[132:135],v[20:23],v[180:183]
v_fma_f32 v110,v110,s36,v17
v_fma_f32 v111,v111,s36,v17
v_mfma_f32_16x16x32_bf16 v[228:231],v[132:135],v[24:27],v[228:231]
v_exp_f32 v90,v90
v_mfma_f32_16x16x32_bf16 a[20:23],v[132:135],v[28:31],a[20:23]
v_exp_f32 v91,v91
v_mfma_f32_16x16x32_bf16 a[68:71],v[132:135],v[32:35],a[68:71]
v_exp_f32 v96,v96
v_mfma_f32_16x16x32_bf16 a[116:119],v[132:135],v[36:39],a[116:119]
buffer_load_dwordx4 v6,s[12:15],s28 offen offset:0 nt lds
v_mfma_f32_16x16x32_bf16 v[184:187],v[136:139],v[20:23],v[184:187]
v_exp_f32 v97,v97
v_mfma_f32_16x16x32_bf16 v[232:235],v[136:139],v[24:27],v[232:235]
v_exp_f32 v98,v98
v_mfma_f32_16x16x32_bf16 a[24:27],v[136:139],v[28:31],a[24:27]
v_exp_f32 v99,v99
v_mfma_f32_16x16x32_bf16 a[72:75],v[136:139],v[32:35],a[72:75]
v_exp_f32 v104,v104
v_mfma_f32_16x16x32_bf16 a[120:123],v[136:139],v[36:39],a[120:123]
v_exp_f32 v105,v105
v_mfma_f32_16x16x32_bf16 v[188:191],v[140:143],v[20:23],v[188:191]
v_exp_f32 v106,v106
v_mfma_f32_16x16x32_bf16 v[236:239],v[140:143],v[24:27],v[236:239]
buffer_load_dwordx4 v7,s[12:15],s28 offen offset:1024 nt lds
v_mfma_f32_16x16x32_bf16 a[28:31],v[140:143],v[28:31],a[28:31]
v_exp_f32 v107,v107
v_mfma_f32_16x16x32_bf16 a[76:79],v[140:143],v[32:35],a[76:79]
v_exp_f32 v76,v76
v_mfma_f32_16x16x32_bf16 a[124:127],v[140:143],v[36:39],a[124:127]
v_exp_f32 v77,v77
v_mfma_f32_16x16x32_bf16 v[192:195],v[112:115],v[20:23],v[192:195]
v_exp_f32 v78,v78
v_mfma_f32_16x16x32_bf16 v[240:243],v[112:115],v[24:27],v[240:243]
v_exp_f32 v79,v79
v_mfma_f32_16x16x32_bf16 a[32:35],v[112:115],v[28:31],a[32:35]
v_exp_f32 v84,v84
v_mfma_f32_16x16x32_bf16 a[80:83],v[112:115],v[32:35],a[80:83]
v_exp_f32 v85,v85
v_mfma_f32_16x16x32_bf16 a[128:131],v[112:115],v[36:39],a[128:131]
buffer_load_dwordx4 v8,s[12:15],s28 offen offset:2048 nt lds
s_waitcnt vmcnt(20) lgkmcnt(0)
s_barrier
v_mfma_f32_16x16x32_bf16 v[196:199],v[116:119],v[20:23],v[196:199]
s_add_u32 s28,s28,3072
v_exp_f32 v86,v86
v_mfma_f32_16x16x32_bf16 v[244:247],v[116:119],v[24:27],v[244:247]
s_add_u32 m0,s22,0
v_exp_f32 v87,v87
v_mfma_f32_16x16x32_bf16 a[36:39],v[116:119],v[28:31],a[36:39]
buffer_load_dwordx4 v6,s[4:7],s25 offen offset:0 lds
v_mfma_f32_16x16x32_bf16 a[84:87],v[116:119],v[32:35],a[84:87]
buffer_load_dwordx4 v7,s[4:7],s25 offen offset:1024 lds
v_mfma_f32_16x16x32_bf16 a[132:135],v[116:119],v[36:39],a[132:135]
buffer_load_dwordx4 v8,s[4:7],s25 offen offset:2048 lds
v_mfma_f32_16x16x32_bf16 v[200:203],v[120:123],v[20:23],v[200:203]
v_exp_f32 v92,v92
v_mfma_f32_16x16x32_bf16 v[248:251],v[120:123],v[24:27],v[248:251]
v_exp_f32 v93,v93
v_mfma_f32_16x16x32_bf16 a[40:43],v[120:123],v[28:31],a[40:43]
v_exp_f32 v94,v94
v_mfma_f32_16x16x32_bf16 a[88:91],v[120:123],v[32:35],a[88:91]
v_exp_f32 v95,v95
v_mfma_f32_16x16x32_bf16 a[136:139],v[120:123],v[36:39],a[136:139]
ds_read_b64_tr_b16 v[128:129],v2 offset:0
ds_read_b64_tr_b16 v[130:131],v2 offset:6144
v_mfma_f32_16x16x32_bf16 v[204:207],v[124:127],v[20:23],v[204:207]
v_exp_f32 v100,v100
v_mfma_f32_16x16x32_bf16 v[252:255],v[124:127],v[24:27],v[252:255]
v_exp_f32 v101,v101
v_mfma_f32_16x16x32_bf16 a[44:47],v[124:127],v[28:31],a[44:47]
ds_read_b64_tr_b16 v[132:133],v3 offset:0
ds_read_b64_tr_b16 v[134:135],v3 offset:6144
v_mfma_f32_16x16x32_bf16 a[92:95],v[124:127],v[32:35],a[92:95]
v_exp_f32 v102,v102
v_mfma_f32_16x16x32_bf16 a[140:143],v[124:127],v[36:39],a[140:143]
ds_read_b64_tr_b16 v[136:137],v4 offset:0
ds_read_b64_tr_b16 v[138:139],v4 offset:6144
v_exp_f32 v103,v103
v_exp_f32 v108,v108
v_exp_f32 v109,v109
ds_read_b64_tr_b16 v[140:141],v5 offset:0
ds_read_b64_tr_b16 v[142:143],v5 offset:6144
v_exp_f32 v110,v110
v_exp_f32 v111,v111
v_cvt_pk_bf16_f32 v49,v90,v91
v_cvt_pk_bf16_f32 v52,v96,v97
v_cvt_pk_bf16_f32 v53,v98,v99
v_cvt_pk_bf16_f32 v56,v104,v105
v_cvt_pk_bf16_f32 v57,v106,v107
v_cvt_pk_bf16_f32 v42,v76,v77
v_cvt_pk_bf16_f32 v43,v78,v79
v_cvt_pk_bf16_f32 v46,v84,v85
v_cvt_pk_bf16_f32 v47,v86,v87
v_cvt_pk_bf16_f32 v50,v92,v93
v_cvt_pk_bf16_f32 v51,v94,v95
v_smfmac_f32_16x16x64_bf16 v[60:63],v[152:155],v[40:47],v18
v_cvt_pk_bf16_f32 v54,v100,v101
v_cvt_pk_bf16_f32 v55,v102,v103
v_cvt_pk_bf16_f32 v58,v108,v109
v_cvt_pk_bf16_f32 v59,v110,v111
v_smfmac_f32_16x16x64_bf16 v[64:67],v[152:155],v[48:55],v18
v_subrev_u32 v10,18432,v10
v_smfmac_f32_16x16x64_bf16 v[68:71],v[152:155],v[52:59],v18
s_waitcnt lgkmcnt(2)
v_mfma_f32_16x16x32_bf16 v[160:163],v[128:131],v[40:43],v[160:163]
s_add_u32 s87,s42,18432
ds_read_b64_tr_b16 v[112:113],v2 offset:128
ds_read_b64_tr_b16 v[114:115],v2 offset:6272
v_mfma_f32_16x16x32_bf16 v[208:211],v[128:131],v[44:47],v[208:211]
s_add_u32 s66,s42,24576
ds_read_b64_tr_b16 v[116:117],v3 offset:128
ds_read_b64_tr_b16 v[118:119],v3 offset:6272
v_mfma_f32_16x16x32_bf16 a[0:3],v[128:131],v[48:51],a[0:3]
ds_read_b64_tr_b16 v[120:121],v4 offset:128
ds_read_b64_tr_b16 v[122:123],v4 offset:6272
v_mfma_f32_16x16x32_bf16 a[48:51],v[128:131],v[52:55],a[48:51]
ds_read_b64_tr_b16 v[124:125],v5 offset:128
ds_read_b64_tr_b16 v[126:127],v5 offset:6272
v_mfma_f32_16x16x32_bf16 a[96:99],v[128:131],v[56:59],a[96:99]
ds_read_b64_tr_b16 v[128:129],v2 offset:256
ds_read_b64_tr_b16 v[130:131],v2 offset:6400
v_mfma_f32_16x16x32_bf16 v[164:167],v[132:135],v[40:43],v[164:167]
v_mbcnt_lo_u32_b32 v39,-1,0
v_mbcnt_hi_u32_b32 v39,-1,v39
v_mfma_f32_16x16x32_bf16 v[212:215],v[132:135],v[44:47],v[212:215]
v_and_b32 v38,7,v39
v_add_f32 v60,v60,v61
v_mfma_f32_16x16x32_bf16 a[4:7],v[132:135],v[48:51],a[4:7]
v_add_f32 v62,v62,v63
v_add_f32 v64,v64,v65
v_add_f32 v66,v66,v67
v_add_f32 v70,v70,v71
v_max3_f32 v19,v60,v62,v64
v_max3_f32 v19,v19,v66,v70
v_rcp_f32 v66,v66
v_rcp_f32 v70,v70
v_accvgpr_read_b32 v72,a48
v_accvgpr_read_b32 v73,a49
v_pk_mul_f32 v[72:73],v[72:73],v[66:67] op_sel_hi:[1,0]
v_accvgpr_read_b32 v74,a50
v_accvgpr_read_b32 v75,a51
v_pk_mul_f32 v[74:75],v[74:75],v[66:67] op_sel_hi:[1,0]
v_accvgpr_read_b32 v76,a96
v_accvgpr_read_b32 v77,a97
v_pk_mul_f32 v[76:77],v[76:77],v[70:71] op_sel_hi:[1,0]
v_accvgpr_read_b32 v78,a98
v_accvgpr_read_b32 v79,a99
v_pk_mul_f32 v[78:79],v[78:79],v[70:71] op_sel_hi:[1,0]
v_cmp_ngt_f32 vcc,s37,v19
v_lshrrev_b32 v19,5,v39
v_mfma_f32_16x16x32_bf16 a[52:55],v[132:135],v[52:55],a[52:55]
v_xor_b32 v38,v38,v19
v_and_b32 v19,15,v39
v_mfma_f32_16x16x32_bf16 a[100:103],v[132:135],v[56:59],a[100:103]
s_cmp_lg_u64 vcc,0
ds_read_b64_tr_b16 v[132:133],v3 offset:256
ds_read_b64_tr_b16 v[134:135],v3 offset:6400
v_mfma_f32_16x16x32_bf16 v[168:171],v[136:139],v[40:43],v[168:171]
s_cselect_b32 s62,s32,0
v_lshl_add_u32 v19,v19,7,s24
v_lshl_add_u32 v19,v38,4,v19
v_mfma_f32_16x16x32_bf16 v[216:219],v[136:139],v[44:47],v[216:219]
s_or_b32 s31,s31,s62
v_bfe_u32 v38,v39,4,1
v_lshl_add_u32 v36,v38,3,v19
v_mfma_f32_16x16x32_bf16 a[8:11],v[136:139],v[48:51],a[8:11]
s_lshl_b32 s32,s32,1
v_xor_b32 v37,32,v36
v_xor_b32 v38,64,v36
v_bfe_u32 v19,v39,3,1
v_xor_b32 v39,96,v36
v_lshlrev_b32 v19,11,v19
v_accvgpr_read_b32 v80,a52
v_accvgpr_read_b32 v81,a53
v_pk_mul_f32 v[80:81],v[80:81],v[66:67] op_sel_hi:[1,0]
v_accvgpr_read_b32 v82,a54
v_accvgpr_read_b32 v83,a55
v_pk_mul_f32 v[82:83],v[82:83],v[66:67] op_sel_hi:[1,0]
v_accvgpr_read_b32 v84,a100
v_accvgpr_read_b32 v85,a101
v_pk_mul_f32 v[84:85],v[84:85],v[70:71] op_sel_hi:[1,0]
v_accvgpr_read_b32 v86,a102
v_accvgpr_read_b32 v87,a103
v_pk_mul_f32 v[86:87],v[86:87],v[70:71] op_sel_hi:[1,0]
v_cvt_pk_bf16_f32 v72,v72,v73
v_cvt_pk_bf16_f32 v76,v76,v77
v_mfma_f32_16x16x32_bf16 a[56:59],v[136:139],v[52:55],a[56:59]
s_add_u32 m0,s24,6144
v_cvt_pk_bf16_f32 v80,v80,v81
v_cvt_pk_bf16_f32 v84,v84,v85
v_mfma_f32_16x16x32_bf16 a[104:107],v[136:139],v[56:59],a[104:107]
buffer_load_dwordx4 v6,s[12:15],s28 offen offset:0 nt lds
s_waitcnt lgkmcnt(0)
v_mfma_f32_16x16x32_bf16 v[172:175],v[140:143],v[40:43],v[172:175]
buffer_load_dwordx4 v7,s[12:15],s28 offen offset:1024 nt lds
v_mfma_f32_16x16x32_bf16 v[220:223],v[140:143],v[44:47],v[220:223]
buffer_load_dwordx4 v8,s[12:15],s28 offen offset:2048 nt lds
v_mfma_f32_16x16x32_bf16 a[12:15],v[140:143],v[48:51],a[12:15]
s_add_u32 s28,s28,3072
ds_read_b64_tr_b16 v[136:137],v4 offset:256
ds_read_b64_tr_b16 v[138:139],v4 offset:6400
v_accvgpr_read_b32 v88,a56
v_accvgpr_read_b32 v89,a57
v_accvgpr_read_b32 v90,a58
v_pk_mul_f32 v[88:89],v[88:89],v[66:67] op_sel_hi:[1,0]
v_accvgpr_read_b32 v91,a59
v_pk_mul_f32 v[90:91],v[90:91],v[66:67] op_sel_hi:[1,0]
v_accvgpr_read_b32 v92,a104
v_accvgpr_read_b32 v93,a105
v_pk_mul_f32 v[92:93],v[92:93],v[70:71] op_sel_hi:[1,0]
v_accvgpr_read_b32 v94,a106
v_accvgpr_read_b32 v95,a107
v_pk_mul_f32 v[94:95],v[94:95],v[70:71] op_sel_hi:[1,0]
v_cvt_pk_bf16_f32 v73,v74,v75
v_cvt_pk_bf16_f32 v77,v78,v79
v_mfma_f32_16x16x32_bf16 a[60:63],v[140:143],v[52:55],a[60:63]
s_add_u32 m0,s24,9216
ds_write2st64_b64 v36,v[72:73],v[76:77] offset0:36 offset1:40
v_mfma_f32_16x16x32_bf16 a[108:111],v[140:143],v[56:59],a[108:111]
v_cvt_pk_bf16_f32 v81,v82,v83
v_cvt_pk_bf16_f32 v85,v86,v87
v_mfma_f32_16x16x32_bf16 v[176:179],v[112:115],v[40:43],v[176:179]
buffer_load_dwordx4 v6,s[12:15],s28 offen offset:0 nt lds
v_mfma_f32_16x16x32_bf16 v[224:227],v[112:115],v[44:47],v[224:227]
buffer_load_dwordx4 v7,s[12:15],s28 offen offset:1024 nt lds
v_mfma_f32_16x16x32_bf16 a[16:19],v[112:115],v[48:51],a[16:19]
ds_read_b64_tr_b16 v[140:141],v5 offset:256
ds_read_b64_tr_b16 v[142:143],v5 offset:6400
ds_write2st64_b64 v37,v[80:81],v[84:85] offset0:36 offset1:40
v_accvgpr_read_b32 v96,a60
v_accvgpr_read_b32 v97,a61
v_pk_mul_f32 v[96:97],v[96:97],v[66:67] op_sel_hi:[1,0]
v_accvgpr_read_b32 v98,a62
v_accvgpr_read_b32 v99,a63
v_pk_mul_f32 v[98:99],v[98:99],v[66:67] op_sel_hi:[1,0]
v_accvgpr_read_b32 v100,a108
v_accvgpr_read_b32 v101,a109
v_pk_mul_f32 v[100:101],v[100:101],v[70:71] op_sel_hi:[1,0]
v_accvgpr_read_b32 v102,a110
v_accvgpr_read_b32 v103,a111
v_pk_mul_f32 v[102:103],v[102:103],v[70:71] op_sel_hi:[1,0]
v_cvt_pk_bf16_f32 v88,v88,v89
v_cvt_pk_bf16_f32 v92,v92,v93
v_mfma_f32_16x16x32_bf16 a[64:67],v[112:115],v[52:55],a[64:67]
v_cvt_pk_bf16_f32 v89,v90,v91
v_cvt_pk_bf16_f32 v93,v94,v95
v_mfma_f32_16x16x32_bf16 a[112:115],v[112:115],v[56:59],a[112:115]
buffer_load_dwordx4 v8,s[12:15],s28 offen offset:2048 nt lds
v_mfma_f32_16x16x32_bf16 v[180:183],v[116:119],v[40:43],v[180:183]
s_add_u32 s28,s28,3072
ds_write2st64_b64 v38,v[88:89],v[92:93] offset0:36 offset1:40
v_mfma_f32_16x16x32_bf16 v[228:231],v[116:119],v[44:47],v[228:231]
s_add_u32 m0,s23,0
v_accvgpr_read_b32 v76,a64
v_accvgpr_read_b32 v77,a65
v_mfma_f32_16x16x32_bf16 a[20:23],v[116:119],v[48:51],a[20:23]
v_accvgpr_read_b32 v78,a66
v_accvgpr_read_b32 v79,a67
v_accvgpr_read_b32 v80,a112
v_accvgpr_read_b32 v81,a113
v_accvgpr_read_b32 v82,a114
v_pk_mul_f32 v[76:77],v[76:77],v[66:67] op_sel_hi:[1,0]
v_pk_mul_f32 v[78:79],v[78:79],v[66:67] op_sel_hi:[1,0]
v_pk_mul_f32 v[80:81],v[80:81],v[70:71] op_sel_hi:[1,0]
v_accvgpr_read_b32 v83,a115
v_pk_mul_f32 v[82:83],v[82:83],v[70:71] op_sel_hi:[1,0]
v_cvt_pk_bf16_f32 v96,v96,v97
v_cvt_pk_bf16_f32 v100,v100,v101
v_mfma_f32_16x16x32_bf16 a[68:71],v[116:119],v[52:55],a[68:71]
v_cvt_pk_bf16_f32 v97,v98,v99
v_cvt_pk_bf16_f32 v101,v102,v103
v_mfma_f32_16x16x32_bf16 a[116:119],v[116:119],v[56:59],a[116:119]
ds_write2st64_b64 v39,v[96:97],v[100:101] offset0:36 offset1:40
v_mfma_f32_16x16x32_bf16 v[184:187],v[120:123],v[40:43],v[184:187]
v_cvt_pk_bf16_f32 v76,v76,v77
v_cvt_pk_bf16_f32 v80,v80,v81
v_mfma_f32_16x16x32_bf16 v[232:235],v[120:123],v[44:47],v[232:235]
ds_read_b128 v[156:159],v10 offset:18432
v_accvgpr_read_b32 v84,a68
v_mfma_f32_16x16x32_bf16 a[24:27],v[120:123],v[48:51],a[24:27]
s_waitcnt vmcnt(21)
ds_read_b128 a[192:195],v11 offset:12288
ds_read_b128 a[196:199],v12 offset:12288
v_accvgpr_read_b32 v85,a69
ds_read_b128 a[200:203],v11 offset:12416
v_pk_mul_f32 v[84:85],v[84:85],v[66:67] op_sel_hi:[1,0]
ds_read_b128 a[204:207],v12 offset:12416
v_accvgpr_read_b32 v86,a70
ds_read_b128 a[208:211],v11 offset:12544
v_accvgpr_read_b32 v87,a71
ds_read_b128 a[212:215],v12 offset:12544
v_pk_mul_f32 v[86:87],v[86:87],v[66:67] op_sel_hi:[1,0]
ds_read_b128 v[104:107],v10 offset:19456
v_accvgpr_read_b32 v88,a116
ds_read_b128 v[108:111],v10 offset:20480
v_accvgpr_read_b32 v89,a117
ds_read_b128 v[72:75],v10 offset:21504
s_waitcnt lgkmcnt(9)
buffer_store_dwordx4 v[156:159],v9,s[16:19],s87 offen offset:0 nt
v_pk_mul_f32 v[88:89],v[88:89],v[70:71] op_sel_hi:[1,0]
v_accvgpr_read_b32 v90,a118
v_accvgpr_read_b32 v91,a119
v_pk_mul_f32 v[90:91],v[90:91],v[70:71] op_sel_hi:[1,0]
v_cvt_pk_bf16_f32 v77,v78,v79
v_cvt_pk_bf16_f32 v81,v82,v83
v_mfma_f32_16x16x32_bf16 a[72:75],v[120:123],v[52:55],a[72:75]
v_cvt_pk_bf16_f32 v84,v84,v85
v_cvt_pk_bf16_f32 v88,v88,v89
v_mfma_f32_16x16x32_bf16 a[120:123],v[120:123],v[56:59],a[120:123]
ds_write2st64_b64 v36,v[76:77],v[80:81] offset0:36 offset1:40
v_mfma_f32_16x16x32_bf16 v[188:191],v[124:127],v[40:43],v[188:191]
v_cvt_pk_bf16_f32 v85,v86,v87
v_cvt_pk_bf16_f32 v89,v90,v91
v_mfma_f32_16x16x32_bf16 v[236:239],v[124:127],v[44:47],v[236:239]
v_accvgpr_read_b32 v92,a72
v_accvgpr_read_b32 v93,a73
v_mfma_f32_16x16x32_bf16 a[28:31],v[124:127],v[48:51],a[28:31]
s_waitcnt lgkmcnt(2)
buffer_store_dwordx4 v[104:107],v9,s[16:19],s87 offen offset:3072 nt
v_accvgpr_read_b32 v94,a74
v_accvgpr_read_b32 v95,a75
v_accvgpr_read_b32 v96,a120
v_pk_mul_f32 v[92:93],v[92:93],v[66:67] op_sel_hi:[1,0]
v_pk_mul_f32 v[94:95],v[94:95],v[66:67] op_sel_hi:[1,0]
v_accvgpr_read_b32 v97,a121
v_pk_mul_f32 v[96:97],v[96:97],v[70:71] op_sel_hi:[1,0]
v_accvgpr_read_b32 v98,a122
v_accvgpr_read_b32 v99,a123
ds_write2st64_b64 v37,v[84:85],v[88:89] offset0:36 offset1:40
v_pk_mul_f32 v[98:99],v[98:99],v[70:71] op_sel_hi:[1,0]
v_cvt_pk_bf16_f32 v92,v92,v93
v_cvt_pk_bf16_f32 v96,v96,v97
v_mfma_f32_16x16x32_bf16 a[76:79],v[124:127],v[52:55],a[76:79]
buffer_store_dwordx4 v[108:111],v9,s[16:19],s66 offen offset:0 nt
v_cvt_pk_bf16_f32 v93,v94,v95
v_cvt_pk_bf16_f32 v97,v98,v99
v_rcp_f32 v64,v64
v_mfma_f32_16x16x32_bf16 a[124:127],v[124:127],v[56:59],a[124:127]
v_rcp_f32 v60,v60
v_mfma_f32_16x16x32_bf16 v[192:195],v[128:131],v[40:43],v[192:195]
v_rcp_f32 v62,v62
v_mfma_f32_16x16x32_bf16 v[240:243],v[128:131],v[44:47],v[240:243]
s_waitcnt vmcnt(9)
s_barrier
v_mfma_f32_16x16x32_bf16 a[32:35],v[128:131],v[48:51],a[32:35]
ds_write2st64_b64 v38,v[92:93],v[96:97] offset0:36 offset1:40
v_accvgpr_read_b32 v100,a76
v_accvgpr_read_b32 v101,a77
v_pk_mul_f32 v[100:101],v[100:101],v[66:67] op_sel_hi:[1,0]
s_waitcnt lgkmcnt(1)
buffer_store_dwordx4 v[72:75],v9,s[16:19],s66 offen offset:3072 nt
ds_read_b128 v[112:115],v0 offset:0
ds_read_b128 v[116:119],v1 offset:0
v_accvgpr_read_b32 v102,a78
ds_read_b128 v[120:123],v0 offset:128
v_accvgpr_read_b32 v103,a79
ds_read_b128 v[124:127],v1 offset:128
buffer_load_dwordx4 v6,s[8:11],s25 offen offset:0 lds
v_pk_mul_f32 v[102:103],v[102:103],v[66:67] op_sel_hi:[1,0]
v_accvgpr_read_b32 v76,a124
v_accvgpr_read_b32 v77,a125
v_pk_mul_f32 v[76:77],v[76:77],v[70:71] op_sel_hi:[1,0]
v_accvgpr_read_b32 v78,a126
v_accvgpr_read_b32 v79,a127
v_pk_mul_f32 v[78:79],v[78:79],v[70:71] op_sel_hi:[1,0]
v_cvt_pk_bf16_f32 v100,v100,v101
v_cvt_pk_bf16_f32 v76,v76,v77
v_mfma_f32_16x16x32_bf16 a[80:83],v[128:131],v[52:55],a[80:83]
v_cvt_pk_bf16_f32 v101,v102,v103
v_cvt_pk_bf16_f32 v77,v78,v79
v_mfma_f32_16x16x32_bf16 a[128:131],v[128:131],v[56:59],a[128:131]
ds_write2st64_b64 v39,v[100:101],v[76:77] offset0:36 offset1:40
v_mfma_f32_16x16x32_bf16 v[196:199],v[132:135],v[40:43],v[196:199]
v_mov_b32 v68,0
v_mov_b32 v69,0
v_mfma_f32_16x16x32_bf16 v[244:247],v[132:135],v[44:47],v[244:247]
buffer_load_dwordx4 v7,s[8:11],s25 offen offset:1024 lds
v_mfma_f32_16x16x32_bf16 a[36:39],v[132:135],v[48:51],a[36:39]
ds_read_b128 v[156:159],v10 offset:18432
ds_read_b128 v[84:87],v10 offset:19456
v_accvgpr_read_b32 v80,a80
ds_read_b128 v[104:107],v10 offset:20480
v_accvgpr_read_b32 v81,a81
ds_read_b128 v[108:111],v10 offset:21504
v_pk_mul_f32 v[80:81],v[80:81],v[66:67] op_sel_hi:[1,0]
ds_read_b128 v[128:131],v0 offset:256
v_accvgpr_read_b32 v82,a82
v_accvgpr_read_b32 v83,a83
v_pk_mul_f32 v[82:83],v[82:83],v[66:67] op_sel_hi:[1,0]
v_accvgpr_read_b32 v72,a128
v_accvgpr_read_b32 v73,a129
v_pk_mul_f32 v[72:73],v[72:73],v[70:71] op_sel_hi:[1,0]
v_accvgpr_read_b32 v74,a130
v_accvgpr_read_b32 v75,a131
v_pk_mul_f32 v[74:75],v[74:75],v[70:71] op_sel_hi:[1,0]
v_cvt_pk_bf16_f32 v80,v80,v81
v_cvt_pk_bf16_f32 v72,v72,v73
v_mfma_f32_16x16x32_bf16 a[84:87],v[132:135],v[52:55],a[84:87]
buffer_load_dwordx4 v8,s[8:11],s25 offen offset:2048 lds
v_mfma_f32_16x16x32_bf16 a[132:135],v[132:135],v[56:59],a[132:135]
s_add_u32 m0,s23,24576
ds_read_b128 v[132:135],v1 offset:256
v_cvt_pk_bf16_f32 v81,v82,v83
v_mfma_f32_16x16x32_bf16 v[200:203],v[136:139],v[40:43],v[200:203]
s_waitcnt lgkmcnt(4)
buffer_store_dwordx4 v[156:159],v9,s[16:19],s87 offen offset:128 nt
v_cvt_pk_bf16_f32 v73,v74,v75
v_accvgpr_read_b32 v92,a84
v_accvgpr_read_b32 v93,a85
v_mfma_f32_16x16x32_bf16 v[248:251],v[136:139],v[44:47],v[248:251]
v_accvgpr_read_b32 v94,a86
v_accvgpr_read_b32 v95,a87
v_mfma_f32_16x16x32_bf16 a[40:43],v[136:139],v[48:51],a[40:43]
v_accvgpr_read_b32 v96,a132
ds_write2st64_b64 v36,v[80:81],v[72:73] offset0:36 offset1:40
v_pk_mul_f32 v[92:93],v[92:93],v[66:67] op_sel_hi:[1,0]
v_pk_mul_f32 v[94:95],v[94:95],v[66:67] op_sel_hi:[1,0]
v_add_u32 v36,v36,v19
buffer_load_dwordx4 v6,s[8:11],s21 offen offset:0 lds
buffer_store_dwordx4 v[84:87],v9,s[16:19],s87 offen offset:3200 nt
v_accvgpr_read_b32 v97,a133
v_pk_mul_f32 v[96:97],v[96:97],v[70:71] op_sel_hi:[1,0]
v_accvgpr_read_b32 v98,a134
v_accvgpr_read_b32 v99,a135
v_pk_mul_f32 v[98:99],v[98:99],v[70:71] op_sel_hi:[1,0]
v_cvt_pk_bf16_f32 v92,v92,v93
v_cvt_pk_bf16_f32 v96,v96,v97
v_mfma_f32_16x16x32_bf16 a[88:91],v[136:139],v[52:55],a[88:91]
s_waitcnt vmcnt(19)
ds_read_b128 a[216:219],v11 offset:0
v_cvt_pk_bf16_f32 v93,v94,v95
v_mfma_f32_16x16x32_bf16 a[136:139],v[136:139],v[56:59],a[136:139]
s_waitcnt lgkmcnt(2)
ds_read_b128 a[220:223],v12 offset:0
buffer_store_dwordx4 v[104:107],v9,s[16:19],s66 offen offset:128 nt
ds_read_b128 a[224:227],v11 offset:128
v_cvt_pk_bf16_f32 v97,v98,v99
v_accvgpr_read_b32 v76,a88
v_mfma_f32_16x16x32_bf16 v[204:207],v[140:143],v[40:43],v[204:207]
ds_read_b128 a[228:231],v12 offset:128
v_accvgpr_read_b32 v77,a89
v_mfma_f32_16x16x32_bf16 v[252:255],v[140:143],v[44:47],v[252:255]
ds_read_b128 a[232:235],v11 offset:256
v_accvgpr_read_b32 v78,a90
v_mfma_f32_16x16x32_bf16 a[44:47],v[140:143],v[48:51],a[44:47]
ds_read_b128 a[236:239],v12 offset:256
ds_write2st64_b64 v37,v[92:93],v[96:97] offset0:36 offset1:40
v_pk_mul_f32 v[76:77],v[76:77],v[66:67] op_sel_hi:[1,0]
v_add_u32 v37,v37,v19
v_accvgpr_read_b32 v79,a91
buffer_store_dwordx4 v[108:111],v9,s[16:19],s66 offen offset:3200 nt
buffer_load_dwordx4 v7,s[8:11],s21 offen offset:1024 lds
ds_read_b128 v[136:139],v0 offset:6144
v_pk_mul_f32 v[78:79],v[78:79],v[66:67] op_sel_hi:[1,0]
v_accvgpr_read_b32 v100,a136
v_accvgpr_read_b32 v101,a137
v_pk_mul_f32 v[100:101],v[100:101],v[70:71] op_sel_hi:[1,0]
v_accvgpr_read_b32 v102,a138
v_accvgpr_read_b32 v103,a139
v_pk_mul_f32 v[102:103],v[102:103],v[70:71] op_sel_hi:[1,0]
v_cvt_pk_bf16_f32 v76,v76,v77
v_cvt_pk_bf16_f32 v100,v100,v101
v_mfma_f32_16x16x32_bf16 a[92:95],v[140:143],v[52:55],a[92:95]
v_cvt_pk_bf16_f32 v77,v78,v79
v_cvt_pk_bf16_f32 v101,v102,v103
v_mfma_f32_16x16x32_bf16 a[140:143],v[140:143],v[56:59],a[140:143]
ds_write2st64_b64 v38,v[76:77],v[100:101] offset0:36 offset1:40
v_mfma_f32_16x16x32_bf16 v[72:75],v[112:115],a[144:147],0
v_add_u32 v38,v38,v19
v_accvgpr_read_b32 v76,a0
v_mfma_f32_16x16x32_bf16 v[80:83],v[112:115],a[168:171],0
ds_read_b128 v[140:143],v1 offset:6144
v_accvgpr_read_b32 v84,a92
v_mfma_f32_16x16x32_bf16 v[88:91],v[112:115],a[192:195],0
ds_read_b128 v[112:115],v0 offset:6272
v_accvgpr_read_b32 v85,a93
v_accvgpr_read_b32 v92,a140
v_accvgpr_read_b32 v93,a141
v_accvgpr_read_b32 v86,a94
v_pk_mul_f32 v[84:85],v[84:85],v[66:67] op_sel_hi:[1,0]
v_pk_mul_f32 v[92:93],v[92:93],v[70:71] op_sel_hi:[1,0]
v_accvgpr_read_b32 v87,a95
v_pk_mul_f32 v[86:87],v[86:87],v[66:67] op_sel_hi:[1,0]
v_accvgpr_read_b32 v94,a142
v_accvgpr_read_b32 v95,a143
v_pk_mul_f32 v[94:95],v[94:95],v[70:71] op_sel_hi:[1,0]
v_cvt_pk_bf16_f32 v84,v84,v85
v_cvt_pk_bf16_f32 v92,v92,v93
buffer_load_dwordx4 v8,s[8:11],s21 offen offset:2048 lds
v_cvt_pk_bf16_f32 v85,v86,v87
v_cvt_pk_bf16_f32 v93,v94,v95
ds_write2st64_b64 v39,v[84:85],v[92:93] offset0:36 offset1:40
v_add_u32 v39,v39,v19
v_accvgpr_read_b32 v77,a1
v_pk_mul_f32 v[76:77],v[76:77],v[64:65] op_sel_hi:[1,0]
ds_read_b128 v[156:159],v10 offset:18432
ds_read_b128 v[96:99],v10 offset:19456
v_accvgpr_read_b32 v100,a16
ds_read_b128 v[104:107],v10 offset:20480
v_accvgpr_read_b32 v101,a17
ds_read_b128 v[108:111],v10 offset:21504
v_pk_mul_f32 v[100:101],v[100:101],v[64:65] op_sel_hi:[1,0]
v_accvgpr_read_b32 v78,a2
v_accvgpr_read_b32 v79,a3
v_pk_mul_f32 v[78:79],v[78:79],v[64:65] op_sel_hi:[1,0]
v_accvgpr_read_b32 v102,a18
v_accvgpr_read_b32 v103,a19
v_pk_mul_f32 v[102:103],v[102:103],v[64:65] op_sel_hi:[1,0]
v_accvgpr_read_b32 v84,a4
v_accvgpr_read_b32 v85,a5
v_pk_mul_f32 v[84:85],v[84:85],v[64:65] op_sel_hi:[1,0]
v_accvgpr_read_b32 v92,a20
v_accvgpr_read_b32 v93,a21
v_pk_mul_f32 v[92:93],v[92:93],v[64:65] op_sel_hi:[1,0]
v_accvgpr_read_b32 v86,a6
v_accvgpr_read_b32 v87,a7
v_pk_mul_f32 v[86:87],v[86:87],v[64:65] op_sel_hi:[1,0]
v_accvgpr_read_b32 v94,a22
v_accvgpr_read_b32 v95,a23
v_pk_mul_f32 v[94:95],v[94:95],v[64:65] op_sel_hi:[1,0]
v_cvt_pk_bf16_f32 v76,v76,v77
v_cvt_pk_bf16_f32 v100,v100,v101
v_cvt_pk_bf16_f32 v84,v84,v85
s_waitcnt lgkmcnt(3)
buffer_store_dwordx4 v[156:159],v9,s[16:19],s87 offen offset:256 nt
v_cvt_pk_bf16_f32 v92,v92,v93
v_cvt_pk_bf16_f32 v77,v78,v79
v_cvt_pk_bf16_f32 v101,v102,v103
v_cvt_pk_bf16_f32 v85,v86,v87
v_cvt_pk_bf16_f32 v93,v94,v95
v_accvgpr_read_b32 v78,a10
v_accvgpr_read_b32 v79,a11
v_pk_mul_f32 v[78:79],v[78:79],v[64:65] op_sel_hi:[1,0]
v_accvgpr_read_b32 v102,a26
ds_write2st64_b64 v36,v[76:77],v[100:101] offset0:24 offset1:26
v_accvgpr_read_b32 v103,a27
v_pk_mul_f32 v[102:103],v[102:103],v[64:65] op_sel_hi:[1,0]
v_accvgpr_read_b32 v86,a14
s_waitcnt lgkmcnt(1)
buffer_store_dwordx4 v[96:99],v9,s[16:19],s87 offen offset:3328 nt
v_accvgpr_read_b32 v87,a15
v_pk_mul_f32 v[86:87],v[86:87],v[64:65] op_sel_hi:[1,0]
v_accvgpr_read_b32 v94,a30
v_accvgpr_read_b32 v95,a31
v_pk_mul_f32 v[94:95],v[94:95],v[64:65] op_sel_hi:[1,0]
v_accvgpr_read_b32 v76,a8
v_accvgpr_read_b32 v77,a9
v_pk_mul_f32 v[76:77],v[76:77],v[64:65] op_sel_hi:[1,0]
v_accvgpr_read_b32 v100,a24
ds_write2st64_b64 v37,v[84:85],v[92:93] offset0:24 offset1:26
v_accvgpr_read_b32 v101,a25
v_pk_mul_f32 v[100:101],v[100:101],v[64:65] op_sel_hi:[1,0]
v_accvgpr_read_b32 v84,a12
buffer_store_dwordx4 v[104:107],v9,s[16:19],s66 offen offset:256 nt
v_accvgpr_read_b32 v85,a13
v_pk_mul_f32 v[84:85],v[84:85],v[64:65] op_sel_hi:[1,0]
v_accvgpr_read_b32 v92,a28
v_accvgpr_read_b32 v93,a29
v_pk_mul_f32 v[92:93],v[92:93],v[64:65] op_sel_hi:[1,0]
v_accvgpr_read_b32 v96,a32
v_accvgpr_read_b32 v97,a33
v_mfma_f32_16x16x32_bf16 v[72:75],v[116:119],a[148:151],v[72:75]
s_waitcnt vmcnt(17)
ds_read_b128 a[240:243],v11 offset:6144
v_accvgpr_read_b32 v98,a34
v_mfma_f32_16x16x32_bf16 v[80:83],v[116:119],a[172:175],v[80:83]
s_add_u32 s21,s21,12288
ds_read_b128 a[244:247],v12 offset:6144
buffer_store_dwordx4 v[108:111],v9,s[16:19],s66 offen offset:3328 nt
ds_read_b128 a[248:251],v11 offset:6272
v_accvgpr_read_b32 v99,a35
v_accvgpr_read_b32 v104,a36
v_mfma_f32_16x16x32_bf16 v[88:91],v[116:119],a[196:199],v[88:91]
s_mov_b32 s27,s42
ds_read_b128 a[252:255],v12 offset:6272
ds_read_b128 v[144:147],v11 offset:6400
v_accvgpr_read_b32 v105,a37
ds_read_b128 v[148:151],v12 offset:6400
v_pk_mul_f32 v[96:97],v[96:97],v[64:65] op_sel_hi:[1,0]
ds_read_b128 v[116:119],v1 offset:6272
v_pk_mul_f32 v[98:99],v[98:99],v[64:65] op_sel_hi:[1,0]
v_pk_mul_f32 v[160:161],v[160:161],v[60:61] op_sel_hi:[1,0]
v_pk_mul_f32 v[162:163],v[162:163],v[60:61] op_sel_hi:[1,0]
v_accvgpr_read_b32 v106,a38
v_accvgpr_read_b32 v107,a39
v_mfma_f32_16x16x32_bf16 v[72:75],v[120:123],a[152:155],v[72:75]
s_mov_b32 s42,s41
v_accvgpr_read_b32 v108,a40
v_accvgpr_read_b32 v109,a41
v_mfma_f32_16x16x32_bf16 v[80:83],v[120:123],a[176:179],v[80:83]
s_add_u32 s69,s69,1
v_accvgpr_read_b32 v110,a42
v_accvgpr_read_b32 v111,a43
v_mfma_f32_16x16x32_bf16 v[88:91],v[120:123],a[200:203],v[88:91]
s_lshl_b32 s62,s69,5
ds_read_b128 v[120:123],v0 offset:6400
v_cvt_pk_bf16_f32 v76,v76,v77
v_cvt_pk_bf16_f32 v100,v100,v101
v_cvt_pk_bf16_f32 v77,v78,v79
v_cvt_pk_bf16_f32 v101,v102,v103
ds_write2st64_b64 v38,v[76:77],v[100:101] offset0:24 offset1:26
v_pk_mul_f32 v[104:105],v[104:105],v[64:65] op_sel_hi:[1,0]
v_pk_mul_f32 v[106:107],v[106:107],v[64:65] op_sel_hi:[1,0]
v_pk_mul_f32 v[164:165],v[164:165],v[60:61] op_sel_hi:[1,0]
v_pk_mul_f32 v[166:167],v[166:167],v[60:61] op_sel_hi:[1,0]
v_accvgpr_read_b32 v102,a46
v_accvgpr_read_b32 v103,a47
v_mfma_f32_16x16x32_bf16 v[72:75],v[124:127],a[156:159],v[72:75]
s_add_u32 s62,s62,s34
v_accvgpr_read_b32 v100,a44
v_accvgpr_read_b32 v101,a45
v_mfma_f32_16x16x32_bf16 v[80:83],v[124:127],a[180:183],v[80:83]
s_mul_i32 s63,s62,171
v_cvt_pk_bf16_f32 v84,v84,v85
v_cvt_pk_bf16_f32 v92,v92,v93
v_mfma_f32_16x16x32_bf16 v[88:91],v[124:127],a[204:207],v[88:91]
s_lshr_b32 s63,s63,9
ds_read_b128 v[124:127],v1 offset:6400
v_cvt_pk_bf16_f32 v85,v86,v87
v_mfma_f32_16x16x32_bf16 v[72:75],v[128:131],a[160:163],v[72:75]
s_mul_i32 s64,s63,3
v_cvt_pk_bf16_f32 v93,v94,v95
ds_write2st64_b64 v39,v[84:85],v[92:93] offset0:24 offset1:26
v_pk_mul_f32 v[108:109],v[108:109],v[64:65] op_sel_hi:[1,0]
v_pk_mul_f32 v[110:111],v[110:111],v[64:65] op_sel_hi:[1,0]
v_pk_mul_f32 v[168:169],v[168:169],v[60:61] op_sel_hi:[1,0]
v_pk_mul_f32 v[170:171],v[170:171],v[60:61] op_sel_hi:[1,0]
v_cvt_pk_bf16_f32 v96,v96,v97
v_cvt_pk_bf16_f32 v160,v160,v161
v_mfma_f32_16x16x32_bf16 v[80:83],v[128:131],a[184:187],v[80:83]
s_sub_u32 s62,s62,s64
v_cvt_pk_bf16_f32 v97,v98,v99
v_cvt_pk_bf16_f32 v161,v162,v163
v_mfma_f32_16x16x32_bf16 v[88:91],v[128:131],a[208:211],v[88:91]
s_add_u32 s63,s63,s33
ds_read_b128 v[128:131],v0 offset:0
v_cvt_pk_bf16_f32 v104,v104,v105
v_mfma_f32_16x16x32_bf16 v[72:75],v[132:135],a[164:167],v[72:75]
s_mul_i32 s30,s63,196608
ds_write2st64_b64 v36,v[96:97],v[160:161] offset0:28 offset1:0
v_mfma_f32_16x16x32_bf16 v[80:83],v[132:135],a[188:191],v[80:83]
s_mul_i32 s41,s63,325632
v_cvt_pk_bf16_f32 v164,v164,v165
v_cvt_pk_bf16_f32 v105,v106,v107
v_cvt_pk_bf16_f32 v165,v166,v167
v_cvt_pk_bf16_f32 v108,v108,v109
v_cvt_pk_bf16_f32 v168,v168,v169
v_pk_mul_f32 v[100:101],v[100:101],v[64:65] op_sel_hi:[1,0]
v_pk_mul_f32 v[102:103],v[102:103],v[64:65] op_sel_hi:[1,0]
v_pk_mul_f32 v[172:173],v[172:173],v[60:61] op_sel_hi:[1,0]
v_pk_mul_f32 v[174:175],v[174:175],v[60:61] op_sel_hi:[1,0]
v_cvt_pk_bf16_f32 v109,v110,v111
v_cvt_pk_bf16_f32 v169,v170,v171
v_mfma_f32_16x16x32_bf16 v[88:91],v[132:135],a[212:215],v[88:91]
s_lshl_b32 s63,s3,2
ds_write2st64_b64 v37,v[104:105],v[164:165] offset0:28 offset1:0
v_mfma_f32_16x16x32_bf16 v[76:79],v[136:139],a[144:147],0
s_add_u32 s64,s63,21
v_cvt_pk_bf16_f32 v100,v100,v101
v_cvt_pk_bf16_f32 v172,v172,v173
v_mfma_f32_16x16x32_bf16 v[84:87],v[136:139],a[168:171],0
s_cmp_eq_u32 s3,0
ds_read_b128 v[132:135],v1 offset:0
v_cvt_pk_bf16_f32 v101,v102,v103
v_cvt_pk_bf16_f32 v173,v174,v175
v_max3_f32 v40,v72,v73,v74
v_max3_f32 v44,v80,v81,v82
ds_write2st64_b64 v38,v[108:109],v[168:169] offset0:28 offset1:0
v_pk_mul_f32 v[176:177],v[176:177],v[60:61] op_sel_hi:[1,0]
v_pk_mul_f32 v[178:179],v[178:179],v[60:61] op_sel_hi:[1,0]
v_pk_mul_f32 v[192:193],v[192:193],v[60:61] op_sel_hi:[1,0]
v_pk_mul_f32 v[194:195],v[194:195],v[60:61] op_sel_hi:[1,0]
v_max3_f32 v48,v88,v89,v90
v_cvt_pk_bf16_f32 v176,v176,v177
v_mfma_f32_16x16x32_bf16 v[92:95],v[136:139],a[192:195],0
s_cselect_b32 s64,20,s64
ds_read_b128 v[136:139],v0 offset:128
v_cvt_pk_bf16_f32 v192,v192,v193
v_mfma_f32_16x16x32_bf16 v[76:79],v[140:143],a[148:151],v[76:79]
s_cselect_b32 s40,1,0
v_cvt_pk_bf16_f32 v177,v178,v179
v_cvt_pk_bf16_f32 v193,v194,v195
v_mfma_f32_16x16x32_bf16 v[84:87],v[140:143],a[172:175],v[84:87]
s_add_u32 s65,s63,37
ds_write2st64_b64 v39,v[100:101],v[172:173] offset0:28 offset1:0
v_mfma_f32_16x16x32_bf16 v[92:95],v[140:143],a[196:199],v[92:95]
s_cmp_eq_u32 s62,2
v_mov_b32 v66,0
ds_read_b128 v[140:143],v1 offset:128
v_mov_b32 v67,0
v_pk_mul_f32 v[180:181],v[180:181],v[60:61] op_sel_hi:[1,0]
v_pk_mul_f32 v[182:183],v[182:183],v[60:61] op_sel_hi:[1,0]
v_pk_mul_f32 v[196:197],v[196:197],v[60:61] op_sel_hi:[1,0]
v_pk_mul_f32 v[198:199],v[198:199],v[60:61] op_sel_hi:[1,0]
v_cvt_pk_bf16_f32 v180,v180,v181
v_cvt_pk_bf16_f32 v196,v196,v197
v_mfma_f32_16x16x32_bf16 v[76:79],v[112:115],a[152:155],v[76:79]
s_cselect_b32 s64,s65,s64
ds_write2st64_b64 v36,v[176:177],v[192:193] offset0:2 offset1:4
v_mfma_f32_16x16x32_bf16 v[84:87],v[112:115],a[176:179],v[84:87]
s_cselect_b32 s40,0,s40
v_cvt_pk_bf16_f32 v181,v182,v183
v_cvt_pk_bf16_f32 v197,v198,v199
v_mfma_f32_16x16x32_bf16 v[92:95],v[112:115],a[200:203],v[92:95]
s_add_u32 s65,s63,s3
ds_read_b128 v[112:115],v0 offset:256
v_mov_b32 v70,0
v_mov_b32 v71,0
v_mov_b32 v64,0
v_mov_b32 v65,0
ds_write2st64_b64 v37,v[180:181],v[196:197] offset0:2 offset1:4
v_pk_mul_f32 v[184:185],v[184:185],v[60:61] op_sel_hi:[1,0]
v_pk_mul_f32 v[186:187],v[186:187],v[60:61] op_sel_hi:[1,0]
v_pk_mul_f32 v[200:201],v[200:201],v[60:61] op_sel_hi:[1,0]
v_pk_mul_f32 v[202:203],v[202:203],v[60:61] op_sel_hi:[1,0]
v_cvt_pk_bf16_f32 v184,v184,v185
v_cvt_pk_bf16_f32 v200,v200,v201
s_waitcnt lgkmcnt(3)
v_mfma_f32_16x16x32_bf16 v[76:79],v[116:119],a[156:159],v[76:79]
s_cmp_eq_u32 s62,0
v_cvt_pk_bf16_f32 v185,v186,v187
v_cvt_pk_bf16_f32 v201,v202,v203
v_mfma_f32_16x16x32_bf16 v[84:87],v[116:119],a[180:183],v[84:87]
s_cselect_b32 s64,s65,s64
s_cselect_b32 s40,1,s40
ds_write2st64_b64 v38,v[184:185],v[200:201] offset0:2 offset1:4
v_mfma_f32_16x16x32_bf16 v[92:95],v[116:119],a[204:207],v[92:95]
s_mul_i32 s64,s64,6144
s_add_u32 s41,s41,s64
s_cmp_ge_u32 s69,6
v_mfma_f32_16x16x32_bf16 v[76:79],v[120:123],a[160:163],v[76:79]
s_cselect_b32 s41,166723584,s41
ds_read_b128 v[116:119],v1 offset:256
s_cselect_b32 s30,100663296,s30
s_add_u32 s25,s30,s22
s_add_u32 s26,s25,12288
s_add_u32 m0,s22,0
v_pk_mul_f32 v[188:189],v[188:189],v[60:61] op_sel_hi:[1,0]
v_pk_mul_f32 v[190:191],v[190:191],v[60:61] op_sel_hi:[1,0]
v_pk_mul_f32 v[204:205],v[204:205],v[60:61] op_sel_hi:[1,0]
v_pk_mul_f32 v[206:207],v[206:207],v[60:61] op_sel_hi:[1,0]
v_cvt_pk_bf16_f32 v188,v188,v189
v_cvt_pk_bf16_f32 v204,v204,v205
v_mfma_f32_16x16x32_bf16 v[84:87],v[120:123],a[184:187],v[84:87]
s_mov_b32 s28,s41
v_cvt_pk_bf16_f32 v189,v190,v191
v_cvt_pk_bf16_f32 v205,v206,v207
v_mfma_f32_16x16x32_bf16 v[92:95],v[120:123],a[208:211],v[92:95]
s_mov_b32 s29,s24
ds_write2st64_b64 v39,v[188:189],v[204:205] offset0:2 offset1:4
v_mfma_f32_16x16x32_bf16 v[76:79],v[124:127],a[164:167],v[76:79]
v_mov_b32 v60,0
v_mov_b32 v61,0
v_mfma_f32_16x16x32_bf16 v[84:87],v[124:127],a[188:191],v[84:87]
ds_read_b128 v[120:123],v0 offset:6144
v_pk_mul_f32 v[208:209],v[208:209],v[62:63] op_sel_hi:[1,0]
v_pk_mul_f32 v[210:211],v[210:211],v[62:63] op_sel_hi:[1,0]
v_pk_mul_f32 v[224:225],v[224:225],v[62:63] op_sel_hi:[1,0]
v_pk_mul_f32 v[226:227],v[226:227],v[62:63] op_sel_hi:[1,0]
v_max3_f32 v40,v40,v75,v76
v_max3_f32 v40,v40,v77,v78
v_mfma_f32_16x16x32_bf16 v[92:95],v[124:127],a[212:215],v[92:95]
ds_read_b128 v[124:127],v1 offset:6144
v_max_f32 v40,v40,v79
v_mfma_f32_16x16x32_bf16 v[96:99],v[128:131],a[216:219],0
v_mov_b32 v41,v40
v_max3_f32 v44,v44,v83,v84
v_mfma_f32_16x16x32_bf16 v[104:107],v[128:131],a[240:243],0
ds_read_b128 v[128:131],v0 offset:6272
v_permlane32_swap_b32 v41,v40
v_max3_f32 v44,v44,v85,v86
v_max_f32 v40,v40,v41
v_pk_mul_f32 v[212:213],v[212:213],v[62:63] op_sel_hi:[1,0]
v_pk_mul_f32 v[214:215],v[214:215],v[62:63] op_sel_hi:[1,0]
v_pk_mul_f32 v[228:229],v[228:229],v[62:63] op_sel_hi:[1,0]
v_pk_mul_f32 v[230:231],v[230:231],v[62:63] op_sel_hi:[1,0]
v_max_f32 v44,v44,v87
v_mov_b32 v41,v40
v_mfma_f32_16x16x32_bf16 v[96:99],v[132:135],a[220:223],v[96:99]
v_mov_b32 v45,v44
v_permlane16_swap_b32 v41,v40
v_mfma_f32_16x16x32_bf16 v[104:107],v[132:135],a[244:247],v[104:107]
ds_read_b128 v[132:135],v1 offset:6272
v_max3_f32 v48,v48,v91,v92
v_mfma_f32_16x16x32_bf16 v[96:99],v[136:139],a[224:227],v[96:99]
v_permlane32_swap_b32 v45,v44
v_mfma_f32_16x16x32_bf16 v[104:107],v[136:139],a[248:251],v[104:107]
ds_read_b128 v[136:139],v0 offset:6400
v_max_f32 v40,v40,v41
v_max3_f32 v48,v48,v93,v94
v_max_f32 v44,v44,v45
v_mul_f32_e64 v13,-s36,v40
v_pk_mul_f32 v[216:217],v[216:217],v[62:63] op_sel_hi:[1,0]
v_pk_mul_f32 v[218:219],v[218:219],v[62:63] op_sel_hi:[1,0]
v_pk_mul_f32 v[232:233],v[232:233],v[62:63] op_sel_hi:[1,0]
v_pk_mul_f32 v[234:235],v[234:235],v[62:63] op_sel_hi:[1,0]
v_max_f32 v48,v48,v95
v_mov_b32 v45,v44
v_mfma_f32_16x16x32_bf16 v[96:99],v[140:143],a[228:231],v[96:99]
v_fma_f32 v72,v72,s36,v13
v_fma_f32 v73,v73,s36,v13
v_mfma_f32_16x16x32_bf16 v[104:107],v[140:143],a[252:255],v[104:107]
s_waitcnt lgkmcnt(2)
ds_read_b128 v[140:143],v1 offset:6400
v_fma_f32 v74,v74,s36,v13
v_mfma_f32_16x16x32_bf16 v[96:99],v[112:115],a[232:235],v[96:99]
v_fma_f32 v75,v75,s36,v13
v_mov_b32 v49,v48
v_mfma_f32_16x16x32_bf16 v[104:107],v[112:115],v[144:147],v[104:107]
ds_read_b128 v[112:115],v0 offset:12544
v_permlane16_swap_b32 v45,v44
v_exp_f32 v72,v72
v_pk_mul_f32 v[220:221],v[220:221],v[62:63] op_sel_hi:[1,0]
v_pk_mul_f32 v[222:223],v[222:223],v[62:63] op_sel_hi:[1,0]
v_pk_mul_f32 v[236:237],v[236:237],v[62:63] op_sel_hi:[1,0]
v_pk_mul_f32 v[238:239],v[238:239],v[62:63] op_sel_hi:[1,0]
v_exp_f32 v73,v73
v_exp_f32 v74,v74
v_mfma_f32_16x16x32_bf16 v[96:99],v[116:119],a[236:239],v[96:99]
v_exp_f32 v75,v75
v_mfma_f32_16x16x32_bf16 v[104:107],v[116:119],v[148:151],v[104:107]
ds_read_b128 v[116:119],v1 offset:12544
v_permlane32_swap_b32 v49,v48
v_mfma_f32_16x16x32_bf16 v[100:103],v[120:123],a[216:219],0
v_max_f32 v44,v44,v45
v_max_f32 v48,v48,v49
v_mul_f32_e64 v14,-s36,v44
v_max3_f32 v52,v96,v97,v98
v_cvt_pk_bf16_f32 v20,v72,v73
v_pk_mul_f32 v[240:241],v[240:241],v[62:63] op_sel_hi:[1,0]
v_pk_mul_f32 v[242:243],v[242:243],v[62:63] op_sel_hi:[1,0]
v_cvt_pk_bf16_f32 v21,v74,v75
v_mov_b32 v49,v48
v_mfma_f32_16x16x32_bf16 v[108:111],v[120:123],a[240:243],0
ds_read_b128 v[120:123],v0 offset:18432
v_fma_f32 v80,v80,s36,v14
v_mfma_f32_16x16x32_bf16 v[100:103],v[124:127],a[220:223],v[100:103]
v_fma_f32 v81,v81,s36,v14
v_fma_f32 v82,v82,s36,v14
v_mfma_f32_16x16x32_bf16 v[108:111],v[124:127],a[244:247],v[108:111]
ds_read_b128 v[124:127],v1 offset:18432
v_fma_f32 v83,v83,s36,v14
v_mfma_f32_16x16x32_bf16 v[100:103],v[128:131],a[224:227],v[100:103]
v_max3_f32 v56,v104,v105,v106
v_permlane16_swap_b32 v49,v48
v_exp_f32 v80,v80
v_pk_mul_f32 v[244:245],v[244:245],v[62:63] op_sel_hi:[1,0]
v_pk_mul_f32 v[246:247],v[246:247],v[62:63] op_sel_hi:[1,0]
v_exp_f32 v81,v81
v_exp_f32 v82,v82
v_mfma_f32_16x16x32_bf16 v[108:111],v[128:131],a[248:251],v[108:111]
s_waitcnt lgkmcnt(2)
ds_read_b128 v[128:131],v0 offset:12288
v_exp_f32 v83,v83
v_mfma_f32_16x16x32_bf16 v[100:103],v[132:135],a[228:231],v[100:103]
v_max_f32 v48,v48,v49
v_mul_f32_e64 v15,-s36,v48
v_mfma_f32_16x16x32_bf16 v[108:111],v[132:135],a[252:255],v[108:111]
ds_read_b128 v[132:135],v1 offset:12288
v_cvt_pk_bf16_f32 v24,v80,v81
v_cvt_pk_bf16_f32 v25,v82,v83
v_fma_f32 v88,v88,s36,v15
v_fma_f32 v89,v89,s36,v15
v_pk_mul_f32 v[248:249],v[248:249],v[62:63] op_sel_hi:[1,0]
v_pk_mul_f32 v[250:251],v[250:251],v[62:63] op_sel_hi:[1,0]
v_fma_f32 v90,v90,s36,v15
v_fma_f32 v91,v91,s36,v15
v_mfma_f32_16x16x32_bf16 v[100:103],v[136:139],a[232:235],v[100:103]
v_exp_f32 v88,v88
v_mfma_f32_16x16x32_bf16 v[108:111],v[136:139],v[144:147],v[108:111]
ds_read_b128 v[136:139],v0 offset:12416
v_exp_f32 v89,v89
v_mfma_f32_16x16x32_bf16 v[100:103],v[140:143],a[236:239],v[100:103]
v_exp_f32 v90,v90
v_mfma_f32_16x16x32_bf16 v[108:111],v[140:143],v[148:151],v[108:111]
ds_read_b128 v[140:143],v1 offset:12416
v_exp_f32 v91,v91
v_cvt_pk_bf16_f32 v208,v208,v209
v_cvt_pk_bf16_f32 v224,v224,v225
v_pk_mul_f32 v[252:253],v[252:253],v[62:63] op_sel_hi:[1,0]
v_pk_mul_f32 v[254:255],v[254:255],v[62:63] op_sel_hi:[1,0]
v_max3_f32 v52,v52,v99,v100
v_max3_f32 v52,v52,v101,v102
s_waitcnt lgkmcnt(3)
v_mfma_f32_16x16x32_bf16 v[72:75],v[128:131],a[144:147],0
v_max_f32 v52,v52,v103
v_mov_b32 v53,v52
v_mfma_f32_16x16x32_bf16 v[80:83],v[128:131],a[168:171],0
v_max3_f32 v56,v56,v107,v108
v_permlane32_swap_b32 v53,v52
v_max3_f32 v56,v56,v109,v110
v_max_f32 v52,v52,v53
v_max_f32 v56,v56,v111
v_mov_b32 v53,v52
v_mov_b32 v57,v56
v_cvt_pk_bf16_f32 v28,v88,v89
v_permlane16_swap_b32 v53,v52
v_permlane32_swap_b32 v57,v56
v_max_f32 v52,v52,v53
v_max_f32 v56,v56,v57
v_mul_f32_e64 v16,-s36,v52
v_cvt_pk_bf16_f32 v29,v90,v91
v_mfma_f32_16x16x32_bf16 v[88:91],v[128:131],a[192:195],0
v_mov_b32 v57,v56
v_fma_f32 v96,v96,s36,v16
v_fma_f32 v97,v97,s36,v16
v_fma_f32 v98,v98,s36,v16
v_fma_f32 v99,v99,s36,v16
v_cvt_pk_bf16_f32 v212,v212,v213
v_cvt_pk_bf16_f32 v228,v228,v229
v_cvt_pk_bf16_f32 v209,v210,v211
v_cvt_pk_bf16_f32 v225,v226,v227
ds_write2st64_b64 v36,v[208:209],v[224:225] offset0:12 offset1:14
v_permlane16_swap_b32 v57,v56
v_exp_f32 v96,v96
v_exp_f32 v97,v97
v_exp_f32 v98,v98
v_exp_f32 v99,v99
v_cvt_pk_bf16_f32 v216,v216,v217
v_cvt_pk_bf16_f32 v232,v232,v233
v_cvt_pk_bf16_f32 v213,v214,v215
v_cvt_pk_bf16_f32 v229,v230,v231
ds_write2st64_b64 v37,v[212:213],v[228:229] offset0:12 offset1:14
v_max_f32 v56,v56,v57
v_cvt_pk_bf16_f32 v220,v220,v221
v_cvt_pk_bf16_f32 v236,v236,v237
v_cvt_pk_bf16_f32 v217,v218,v219
v_cvt_pk_bf16_f32 v233,v234,v235
v_mul_f32_e64 v17,-s36,v56
v_cvt_pk_bf16_f32 v240,v240,v241
v_cvt_pk_bf16_f32 v32,v96,v97
v_cvt_pk_bf16_f32 v33,v98,v99
v_mfma_f32_16x16x32_bf16 v[96:99],v[128:131],a[216:219],0
v_cvt_pk_bf16_f32 v221,v222,v223
ds_write2st64_b64 v38,v[216:217],v[232:233] offset0:12 offset1:14
v_cvt_pk_bf16_f32 v237,v238,v239
v_fma_f32 v104,v104,s36,v17
v_fma_f32 v105,v105,s36,v17
v_fma_f32 v106,v106,s36,v17
v_fma_f32 v107,v107,s36,v17
v_cvt_pk_bf16_f32 v244,v244,v245
v_cvt_pk_bf16_f32 v241,v242,v243
v_exp_f32 v104,v104
v_exp_f32 v105,v105
ds_write2st64_b64 v39,v[220:221],v[236:237] offset0:12 offset1:14
v_exp_f32 v106,v106
v_exp_f32 v107,v107
v_cvt_pk_bf16_f32 v245,v246,v247
v_fma_f32 v76,v76,s36,v13
v_fma_f32 v77,v77,s36,v13
v_fma_f32 v78,v78,s36,v13
v_fma_f32 v79,v79,s36,v13
v_exp_f32 v76,v76
ds_write_b64 v36,v[240:241] offset:8192
v_cvt_pk_bf16_f32 v36,v104,v105
v_exp_f32 v77,v77
v_exp_f32 v78,v78
ds_write_b64 v37,v[244:245] offset:8192
v_cvt_pk_bf16_f32 v37,v106,v107
v_mfma_f32_16x16x32_bf16 v[104:107],v[128:131],a[240:243],0
s_waitcnt lgkmcnt(2)
ds_read_b128 v[128:131],v0 offset:18560
v_exp_f32 v79,v79
v_mfma_f32_16x16x32_bf16 v[72:75],v[132:135],a[148:151],v[72:75]
v_fma_f32 v84,v84,s36,v14
v_fma_f32 v85,v85,s36,v14
v_mfma_f32_16x16x32_bf16 v[80:83],v[132:135],a[172:175],v[80:83]
v_fma_f32 v86,v86,s36,v14
v_fma_f32 v87,v87,s36,v14
v_mfma_f32_16x16x32_bf16 v[88:91],v[132:135],a[196:199],v[88:91]
v_cvt_pk_bf16_f32 v22,v76,v77
v_cvt_pk_bf16_f32 v23,v78,v79
v_mfma_f32_16x16x32_bf16 v[96:99],v[132:135],a[220:223],v[96:99]
v_exp_f32 v84,v84
v_mfma_f32_16x16x32_bf16 v[104:107],v[132:135],a[244:247],v[104:107]
ds_read_b128 v[132:135],v1 offset:18560
v_exp_f32 v85,v85
v_mfma_f32_16x16x32_bf16 v[72:75],v[136:139],a[152:155],v[72:75]
s_waitcnt vmcnt(11)
s_barrier
v_mfma_f32_16x16x32_bf16 v[80:83],v[136:139],a[176:179],v[80:83]
v_exp_f32 v86,v86
v_mfma_f32_16x16x32_bf16 v[88:91],v[136:139],a[200:203],v[88:91]
buffer_load_dwordx4 v6,s[4:7],s20 offen offset:0 lds
v_mfma_f32_16x16x32_bf16 v[96:99],v[136:139],a[224:227],v[96:99]
v_exp_f32 v87,v87
v_mfma_f32_16x16x32_bf16 v[104:107],v[136:139],a[248:251],v[104:107]
ds_read_b128 v[136:139],v0 offset:18688
v_fma_f32 v92,v92,s36,v15
v_mfma_f32_16x16x32_bf16 v[72:75],v[140:143],a[156:159],v[72:75]
v_fma_f32 v93,v93,s36,v15
v_fma_f32 v94,v94,s36,v15
v_mfma_f32_16x16x32_bf16 v[80:83],v[140:143],a[180:183],v[80:83]
v_fma_f32 v95,v95,s36,v15
v_cvt_pk_bf16_f32 v26,v84,v85
v_mfma_f32_16x16x32_bf16 v[88:91],v[140:143],a[204:207],v[88:91]
buffer_load_dwordx4 v7,s[4:7],s20 offen offset:1024 lds
v_mfma_f32_16x16x32_bf16 v[96:99],v[140:143],a[228:231],v[96:99]
v_cvt_pk_bf16_f32 v27,v86,v87
v_exp_f32 v92,v92
v_mfma_f32_16x16x32_bf16 v[104:107],v[140:143],a[252:255],v[104:107]
ds_read_b128 v[140:143],v1 offset:18688
v_exp_f32 v93,v93
v_mfma_f32_16x16x32_bf16 v[72:75],v[112:115],a[160:163],v[72:75]
v_exp_f32 v94,v94
v_mfma_f32_16x16x32_bf16 v[80:83],v[112:115],a[184:187],v[80:83]
v_exp_f32 v95,v95
v_mfma_f32_16x16x32_bf16 v[88:91],v[112:115],a[208:211],v[88:91]
v_fma_f32 v100,v100,s36,v16
v_fma_f32 v101,v101,s36,v16
v_mfma_f32_16x16x32_bf16 v[96:99],v[112:115],a[232:235],v[96:99]
buffer_load_dwordx4 v8,s[4:7],s20 offen offset:2048 lds
v_mfma_f32_16x16x32_bf16 v[104:107],v[112:115],v[144:147],v[104:107]
s_add_u32 s20,s20,12288
ds_read_b64_tr_b16 v[112:113],v2 offset:0
ds_read_b64_tr_b16 v[114:115],v2 offset:6144
v_mfma_f32_16x16x32_bf16 v[72:75],v[116:119],a[164:167],v[72:75]
v_fma_f32 v102,v102,s36,v16
v_fma_f32 v103,v103,s36,v16
v_mfma_f32_16x16x32_bf16 v[80:83],v[116:119],a[188:191],v[80:83]
v_cvt_pk_bf16_f32 v30,v92,v93
v_cvt_pk_bf16_f32 v31,v94,v95
v_mfma_f32_16x16x32_bf16 v[88:91],v[116:119],a[212:215],v[88:91]
v_exp_f32 v100,v100
v_mfma_f32_16x16x32_bf16 v[96:99],v[116:119],a[236:239],v[96:99]
v_exp_f32 v101,v101
v_mfma_f32_16x16x32_bf16 v[104:107],v[116:119],v[148:151],v[104:107]
ds_read_b64_tr_b16 v[116:117],v3 offset:0
ds_read_b64_tr_b16 v[118:119],v3 offset:6144
v_mfma_f32_16x16x32_bf16 v[76:79],v[120:123],a[144:147],0
v_exp_f32 v102,v102
v_mfma_f32_16x16x32_bf16 v[84:87],v[120:123],a[168:171],0
v_exp_f32 v103,v103
v_mfma_f32_16x16x32_bf16 v[92:95],v[120:123],a[192:195],0
v_cvt_pk_bf16_f32 v248,v248,v249
v_fma_f32 v108,v108,s36,v17
v_fma_f32 v109,v109,s36,v17
v_fma_f32 v110,v110,s36,v17
v_fma_f32 v111,v111,s36,v17
v_cvt_pk_bf16_f32 v34,v100,v101
v_cvt_pk_bf16_f32 v35,v102,v103
v_mfma_f32_16x16x32_bf16 v[100:103],v[120:123],a[216:219],0
v_cvt_pk_bf16_f32 v252,v252,v253
v_cvt_pk_bf16_f32 v249,v250,v251
v_smfmac_f32_16x16x64_bf16 v[64:67],v[152:155],v[28:35],v18
ds_write_b64 v38,v[248:249] offset:8192
v_exp_f32 v108,v108
v_exp_f32 v109,v109
v_exp_f32 v110,v110
v_exp_f32 v111,v111
v_cvt_pk_bf16_f32 v253,v254,v255
ds_write_b64 v39,v[252:253] offset:8192
v_cvt_pk_bf16_f32 v38,v108,v109
v_cvt_pk_bf16_f32 v39,v110,v111
v_mfma_f32_16x16x32_bf16 v[108:111],v[120:123],a[240:243],0
ds_read_b64_tr_b16 v[120:121],v4 offset:0
ds_read_b64_tr_b16 v[122:123],v4 offset:6144
v_smfmac_f32_16x16x64_bf16 v[68:71],v[152:155],v[32:39],v18
v_mov_b32 v62,0
v_mfma_f32_16x16x32_bf16 v[76:79],v[124:127],a[148:151],v[76:79]
v_mov_b32 v63,0
v_fma_f32 v72,v72,s36,v13
v_mfma_f32_16x16x32_bf16 v[84:87],v[124:127],a[172:175],v[84:87]
v_fma_f32 v73,v73,s36,v13
v_fma_f32 v74,v74,s36,v13
v_smfmac_f32_16x16x64_bf16 v[60:63],v[152:155],v[20:27],v18
v_fma_f32 v75,v75,s36,v13
v_mfma_f32_16x16x32_bf16 v[92:95],v[124:127],a[196:199],v[92:95]
v_fma_f32 v80,v80,s36,v14
v_fma_f32 v81,v81,s36,v14
v_mfma_f32_16x16x32_bf16 v[100:103],v[124:127],a[220:223],v[100:103]
v_fma_f32 v82,v82,s36,v14
v_fma_f32 v83,v83,s36,v14
v_mfma_f32_16x16x32_bf16 v[108:111],v[124:127],a[244:247],v[108:111]
s_waitcnt lgkmcnt(2)
ds_read_b64_tr_b16 v[124:125],v5 offset:0
ds_read_b64_tr_b16 v[126:127],v5 offset:6144
v_mfma_f32_16x16x32_bf16 v[76:79],v[128:131],a[152:155],v[76:79]
v_fma_f32 v88,v88,s36,v15
v_fma_f32 v89,v89,s36,v15
v_mfma_f32_16x16x32_bf16 v[84:87],v[128:131],a[176:179],v[84:87]
v_exp_f32 v72,v72
v_mfma_f32_16x16x32_bf16 v[92:95],v[128:131],a[200:203],v[92:95]
v_exp_f32 v73,v73
v_mfma_f32_16x16x32_bf16 v[100:103],v[128:131],a[224:227],v[100:103]
v_exp_f32 v74,v74
v_mfma_f32_16x16x32_bf16 v[108:111],v[128:131],a[248:251],v[108:111]
v_exp_f32 v75,v75
v_mfma_f32_16x16x32_bf16 v[76:79],v[132:135],a[156:159],v[76:79]
v_exp_f32 v80,v80
v_mfma_f32_16x16x32_bf16 v[84:87],v[132:135],a[180:183],v[84:87]
v_exp_f32 v81,v81
v_mfma_f32_16x16x32_bf16 v[92:95],v[132:135],a[204:207],v[92:95]
v_exp_f32 v82,v82
v_mfma_f32_16x16x32_bf16 v[100:103],v[132:135],a[228:231],v[100:103]
v_exp_f32 v83,v83
v_mfma_f32_16x16x32_bf16 v[108:111],v[132:135],a[252:255],v[108:111]
v_exp_f32 v88,v88
v_mfma_f32_16x16x32_bf16 v[76:79],v[136:139],a[160:163],v[76:79]
v_exp_f32 v89,v89
v_mfma_f32_16x16x32_bf16 v[84:87],v[136:139],a[184:187],v[84:87]
v_cvt_pk_bf16_f32 v40,v72,v73
v_cvt_pk_bf16_f32 v41,v74,v75
v_mfma_f32_16x16x32_bf16 v[92:95],v[136:139],a[208:211],v[92:95]
v_cvt_pk_bf16_f32 v44,v80,v81
v_cvt_pk_bf16_f32 v45,v82,v83
v_mfma_f32_16x16x32_bf16 v[100:103],v[136:139],a[232:235],v[100:103]
v_cvt_pk_bf16_f32 v48,v88,v89
v_mfma_f32_16x16x32_bf16 v[108:111],v[136:139],v[144:147],v[108:111]
v_mfma_f32_16x16x32_bf16 v[76:79],v[140:143],a[164:167],v[76:79]
v_mfma_f32_16x16x32_bf16 v[84:87],v[140:143],a[188:191],v[84:87]
v_mfma_f32_16x16x32_bf16 v[92:95],v[140:143],a[212:215],v[92:95]
v_mfma_f32_16x16x32_bf16 v[100:103],v[140:143],a[236:239],v[100:103]
v_mfma_f32_16x16x32_bf16 v[108:111],v[140:143],v[148:151],v[108:111]
v_mfma_f32_16x16x32_bf16 v[160:163],v[112:115],v[20:23],0
s_add_u32 m0,s23,0
ds_read_b64_tr_b16 v[128:129],v2 offset:128
ds_read_b64_tr_b16 v[130:131],v2 offset:6272
v_mfma_f32_16x16x32_bf16 v[208:211],v[112:115],v[24:27],0
ds_read_b64_tr_b16 v[132:133],v3 offset:128
ds_read_b64_tr_b16 v[134:135],v3 offset:6272
v_mfma_f32_16x16x32_bf16 a[0:3],v[112:115],v[28:31],0
ds_read_b64_tr_b16 v[136:137],v4 offset:128
ds_read_b64_tr_b16 v[138:139],v4 offset:6272
v_mfma_f32_16x16x32_bf16 a[48:51],v[112:115],v[32:35],0
ds_read_b64_tr_b16 v[140:141],v5 offset:128
ds_read_b64_tr_b16 v[142:143],v5 offset:6272
v_mfma_f32_16x16x32_bf16 a[96:99],v[112:115],v[36:39],0
ds_read_b64_tr_b16 v[112:113],v2 offset:256
ds_read_b64_tr_b16 v[114:115],v2 offset:6400
v_mfma_f32_16x16x32_bf16 v[164:167],v[116:119],v[20:23],0
v_fma_f32 v90,v90,s36,v15
v_fma_f32 v91,v91,s36,v15
v_mfma_f32_16x16x32_bf16 v[212:215],v[116:119],v[24:27],0
v_exp_f32 v90,v90
v_mfma_f32_16x16x32_bf16 a[4:7],v[116:119],v[28:31],0
v_exp_f32 v91,v91
v_mfma_f32_16x16x32_bf16 a[52:55],v[116:119],v[32:35],0
v_cvt_pk_bf16_f32 v49,v90,v91
v_fma_f32 v96,v96,s36,v16
v_mfma_f32_16x16x32_bf16 a[100:103],v[116:119],v[36:39],0
s_waitcnt lgkmcnt(8)
ds_read_b64_tr_b16 v[116:117],v3 offset:256
ds_read_b64_tr_b16 v[118:119],v3 offset:6400
v_mfma_f32_16x16x32_bf16 v[168:171],v[120:123],v[20:23],0
v_fma_f32 v97,v97,s36,v16
v_fma_f32 v98,v98,s36,v16
v_mfma_f32_16x16x32_bf16 v[216:219],v[120:123],v[24:27],0
v_fma_f32 v99,v99,s36,v16
v_fma_f32 v104,v104,s36,v17
v_mfma_f32_16x16x32_bf16 a[8:11],v[120:123],v[28:31],0
v_exp_f32 v96,v96
v_mfma_f32_16x16x32_bf16 a[56:59],v[120:123],v[32:35],0
v_exp_f32 v97,v97
v_mfma_f32_16x16x32_bf16 a[104:107],v[120:123],v[36:39],0
ds_read_b64_tr_b16 v[120:121],v4 offset:256
ds_read_b64_tr_b16 v[122:123],v4 offset:6400
v_mfma_f32_16x16x32_bf16 v[172:175],v[124:127],v[20:23],0
v_exp_f32 v98,v98
v_mfma_f32_16x16x32_bf16 v[220:223],v[124:127],v[24:27],0
v_exp_f32 v99,v99
v_mfma_f32_16x16x32_bf16 a[12:15],v[124:127],v[28:31],0
v_cvt_pk_bf16_f32 v52,v96,v97
v_cvt_pk_bf16_f32 v53,v98,v99
v_mfma_f32_16x16x32_bf16 a[60:63],v[124:127],v[32:35],0
v_fma_f32 v105,v105,s36,v17
v_fma_f32 v106,v106,s36,v17
v_mfma_f32_16x16x32_bf16 a[108:111],v[124:127],v[36:39],0
ds_read_b64_tr_b16 v[124:125],v5 offset:256
ds_read_b64_tr_b16 v[126:127],v5 offset:6400
v_mfma_f32_16x16x32_bf16 v[176:179],v[128:131],v[20:23],0
v_fma_f32 v107,v107,s36,v17
v_fma_f32 v76,v76,s36,v13
v_mfma_f32_16x16x32_bf16 v[224:227],v[128:131],v[24:27],0
v_exp_f32 v104,v104
v_mfma_f32_16x16x32_bf16 a[16:19],v[128:131],v[28:31],0
v_exp_f32 v105,v105
v_mfma_f32_16x16x32_bf16 a[64:67],v[128:131],v[32:35],0
v_exp_f32 v106,v106
v_mfma_f32_16x16x32_bf16 a[112:115],v[128:131],v[36:39],0
s_waitcnt lgkmcnt(2)
v_exp_f32 v107,v107
v_mfma_f32_16x16x32_bf16 v[180:183],v[132:135],v[20:23],0
v_cvt_pk_bf16_f32 v56,v104,v105
v_cvt_pk_bf16_f32 v57,v106,v107
v_mfma_f32_16x16x32_bf16 v[228:231],v[132:135],v[24:27],0
v_fma_f32 v77,v77,s36,v13
v_fma_f32 v78,v78,s36,v13
v_mfma_f32_16x16x32_bf16 a[20:23],v[132:135],v[28:31],0
v_fma_f32 v79,v79,s36,v13
v_fma_f32 v84,v84,s36,v14
v_mfma_f32_16x16x32_bf16 a[68:71],v[132:135],v[32:35],0
v_exp_f32 v76,v76
v_mfma_f32_16x16x32_bf16 a[116:119],v[132:135],v[36:39],0
v_exp_f32 v77,v77
v_mfma_f32_16x16x32_bf16 v[184:187],v[136:139],v[20:23],0
v_exp_f32 v78,v78
v_mfma_f32_16x16x32_bf16 v[232:235],v[136:139],v[24:27],0
v_exp_f32 v79,v79
v_mfma_f32_16x16x32_bf16 a[24:27],v[136:139],v[28:31],0
v_cvt_pk_bf16_f32 v42,v76,v77
v_cvt_pk_bf16_f32 v43,v78,v79
v_mfma_f32_16x16x32_bf16 a[72:75],v[136:139],v[32:35],0
v_fma_f32 v85,v85,s36,v14
v_fma_f32 v86,v86,s36,v14
v_mfma_f32_16x16x32_bf16 a[120:123],v[136:139],v[36:39],0
v_fma_f32 v87,v87,s36,v14
v_fma_f32 v92,v92,s36,v15
v_mfma_f32_16x16x32_bf16 v[188:191],v[140:143],v[20:23],0
v_exp_f32 v84,v84
v_mfma_f32_16x16x32_bf16 v[236:239],v[140:143],v[24:27],0
v_exp_f32 v85,v85
v_mfma_f32_16x16x32_bf16 a[28:31],v[140:143],v[28:31],0
v_exp_f32 v86,v86
v_mfma_f32_16x16x32_bf16 a[76:79],v[140:143],v[32:35],0
v_exp_f32 v87,v87
v_mfma_f32_16x16x32_bf16 a[124:127],v[140:143],v[36:39],0
v_cvt_pk_bf16_f32 v46,v84,v85
v_cvt_pk_bf16_f32 v47,v86,v87
v_mfma_f32_16x16x32_bf16 v[192:195],v[112:115],v[20:23],0
v_fma_f32 v93,v93,s36,v15
v_fma_f32 v94,v94,s36,v15
v_smfmac_f32_16x16x64_bf16 v[60:63],v[152:155],v[40:47],v18
v_fma_f32 v95,v95,s36,v15
s_waitcnt vmcnt(36) lgkmcnt(0)
v_mfma_f32_16x16x32_bf16 v[240:243],v[112:115],v[24:27],0
s_barrier
v_mfma_f32_16x16x32_bf16 a[32:35],v[112:115],v[28:31],0
ds_read_b128 v[128:131],v0 offset:24576
v_fma_f32 v100,v100,s36,v16
v_mfma_f32_16x16x32_bf16 a[80:83],v[112:115],v[32:35],0
ds_read_b128 v[132:135],v1 offset:24576
v_fma_f32 v101,v101,s36,v16
v_mfma_f32_16x16x32_bf16 a[128:131],v[112:115],v[36:39],0
ds_read_b128 v[136:139],v0 offset:24704
v_fma_f32 v102,v102,s36,v16
v_mfma_f32_16x16x32_bf16 v[196:199],v[116:119],v[20:23],0
ds_read_b128 v[140:143],v1 offset:24704
v_fma_f32 v103,v103,s36,v16
v_mfma_f32_16x16x32_bf16 v[244:247],v[116:119],v[24:27],0
ds_read_b128 v[112:115],v0 offset:24832
v_fma_f32 v108,v108,s36,v17
v_mfma_f32_16x16x32_bf16 a[36:39],v[116:119],v[28:31],0
buffer_load_dwordx4 v6,s[8:11],s21 offen offset:0 lds
v_mfma_f32_16x16x32_bf16 a[84:87],v[116:119],v[32:35],0
v_exp_f32 v92,v92
v_mfma_f32_16x16x32_bf16 a[132:135],v[116:119],v[36:39],0
ds_read_b128 v[116:119],v1 offset:24832
v_fma_f32 v109,v109,s36,v17
v_mfma_f32_16x16x32_bf16 v[200:203],v[120:123],v[20:23],0
v_exp_f32 v93,v93
v_mfma_f32_16x16x32_bf16 v[248:251],v[120:123],v[24:27],0
v_exp_f32 v94,v94
v_mfma_f32_16x16x32_bf16 a[40:43],v[120:123],v[28:31],0
v_exp_f32 v95,v95
v_mfma_f32_16x16x32_bf16 a[88:91],v[120:123],v[32:35],0
v_cvt_pk_bf16_f32 v50,v92,v93
v_cvt_pk_bf16_f32 v51,v94,v95
v_mfma_f32_16x16x32_bf16 a[136:139],v[120:123],v[36:39],0
ds_read_b128 v[120:123],v0 offset:30720
v_fma_f32 v110,v110,s36,v17
v_mfma_f32_16x16x32_bf16 v[204:207],v[124:127],v[20:23],0
v_exp_f32 v100,v100
v_mfma_f32_16x16x32_bf16 v[252:255],v[124:127],v[24:27],0
v_exp_f32 v101,v101
v_mfma_f32_16x16x32_bf16 a[44:47],v[124:127],v[28:31],0
v_exp_f32 v102,v102
v_mfma_f32_16x16x32_bf16 a[92:95],v[124:127],v[32:35],0
v_exp_f32 v103,v103
v_mfma_f32_16x16x32_bf16 a[140:143],v[124:127],v[36:39],0
buffer_load_dwordx4 v7,s[8:11],s21 offen offset:1024 lds
s_waitcnt lgkmcnt(1)
v_mfma_f32_16x16x32_bf16 v[72:75],v[128:131],a[144:147],0
ds_read_b128 v[124:127],v1 offset:30720
v_cvt_pk_bf16_f32 v54,v100,v101
v_mfma_f32_16x16x32_bf16 v[80:83],v[128:131],a[168:171],0
v_cvt_pk_bf16_f32 v55,v102,v103
v_fma_f32 v111,v111,s36,v17
v_mfma_f32_16x16x32_bf16 v[88:91],v[128:131],a[192:195],0
v_exp_f32 v108,v108
v_smfmac_f32_16x16x64_bf16 v[64:67],v[152:155],v[48:55],v18
v_mfma_f32_16x16x32_bf16 v[96:99],v[128:131],a[216:219],0
v_exp_f32 v109,v109
v_mfma_f32_16x16x32_bf16 v[104:107],v[128:131],a[240:243],0
ds_read_b128 v[128:131],v0 offset:30848
v_cvt_pk_bf16_f32 v58,v108,v109
v_mfma_f32_16x16x32_bf16 v[72:75],v[132:135],a[148:151],v[72:75]
v_exp_f32 v110,v110
v_mfma_f32_16x16x32_bf16 v[80:83],v[132:135],a[172:175],v[80:83]
v_exp_f32 v111,v111
v_mfma_f32_16x16x32_bf16 v[88:91],v[132:135],a[196:199],v[88:91]
v_cvt_pk_bf16_f32 v59,v110,v111
v_mfma_f32_16x16x32_bf16 v[96:99],v[132:135],a[220:223],v[96:99]
v_mfma_f32_16x16x32_bf16 v[104:107],v[132:135],a[244:247],v[104:107]
buffer_load_dwordx4 v8,s[8:11],s21 offen offset:2048 lds
v_smfmac_f32_16x16x64_bf16 v[68:71],v[152:155],v[52:59],v18
s_add_u32 s21,s21,12288
ds_read_b128 v[132:135],v1 offset:30848
v_mfma_f32_16x16x32_bf16 v[72:75],v[136:139],a[152:155],v[72:75]
s_add_u32 m0,s22,12288
v_mfma_f32_16x16x32_bf16 v[80:83],v[136:139],a[176:179],v[80:83]
v_mfma_f32_16x16x32_bf16 v[88:91],v[136:139],a[200:203],v[88:91]
v_mfma_f32_16x16x32_bf16 v[96:99],v[136:139],a[224:227],v[96:99]
v_mfma_f32_16x16x32_bf16 v[104:107],v[136:139],a[248:251],v[104:107]
ds_read_b128 v[136:139],v0 offset:30976
v_mfma_f32_16x16x32_bf16 v[72:75],v[140:143],a[156:159],v[72:75]
v_mfma_f32_16x16x32_bf16 v[80:83],v[140:143],a[180:183],v[80:83]
v_mfma_f32_16x16x32_bf16 v[88:91],v[140:143],a[204:207],v[88:91]
v_mfma_f32_16x16x32_bf16 v[96:99],v[140:143],a[228:231],v[96:99]
v_mfma_f32_16x16x32_bf16 v[104:107],v[140:143],a[252:255],v[104:107]
buffer_load_dwordx4 v6,s[4:7],s20 offen offset:0 lds
v_mfma_f32_16x16x32_bf16 v[72:75],v[112:115],a[160:163],v[72:75]
ds_read_b128 v[140:143],v1 offset:30976
v_mfma_f32_16x16x32_bf16 v[80:83],v[112:115],a[184:187],v[80:83]
v_mfma_f32_16x16x32_bf16 v[88:91],v[112:115],a[208:211],v[88:91]
v_mfma_f32_16x16x32_bf16 v[96:99],v[112:115],a[232:235],v[96:99]
v_mfma_f32_16x16x32_bf16 v[104:107],v[112:115],v[144:147],v[104:107]
v_mfma_f32_16x16x32_bf16 v[72:75],v[116:119],a[164:167],v[72:75]
v_mfma_f32_16x16x32_bf16 v[80:83],v[116:119],a[188:191],v[80:83]
v_mfma_f32_16x16x32_bf16 v[88:91],v[116:119],a[212:215],v[88:91]
v_mfma_f32_16x16x32_bf16 v[96:99],v[116:119],a[236:239],v[96:99]
v_mfma_f32_16x16x32_bf16 v[104:107],v[116:119],v[148:151],v[104:107]
s_waitcnt lgkmcnt(0)
v_mfma_f32_16x16x32_bf16 v[76:79],v[120:123],a[144:147],0
v_mfma_f32_16x16x32_bf16 v[84:87],v[120:123],a[168:171],0
buffer_load_dwordx4 v7,s[4:7],s20 offen offset:1024 lds
v_mfma_f32_16x16x32_bf16 v[92:95],v[120:123],a[192:195],0
v_fma_f32 v72,v72,s36,v13
v_fma_f32 v73,v73,s36,v13
v_mfma_f32_16x16x32_bf16 v[100:103],v[120:123],a[216:219],0
v_fma_f32 v74,v74,s36,v13
v_fma_f32 v75,v75,s36,v13
v_mfma_f32_16x16x32_bf16 v[108:111],v[120:123],a[240:243],0
v_fma_f32 v80,v80,s36,v14
v_fma_f32 v81,v81,s36,v14
v_mfma_f32_16x16x32_bf16 v[76:79],v[124:127],a[148:151],v[76:79]
v_fma_f32 v82,v82,s36,v14
v_fma_f32 v83,v83,s36,v14
v_mfma_f32_16x16x32_bf16 v[84:87],v[124:127],a[172:175],v[84:87]
v_fma_f32 v88,v88,s36,v15
v_fma_f32 v89,v89,s36,v15
v_mfma_f32_16x16x32_bf16 v[92:95],v[124:127],a[196:199],v[92:95]
v_exp_f32 v72,v72
v_mfma_f32_16x16x32_bf16 v[100:103],v[124:127],a[220:223],v[100:103]
v_exp_f32 v73,v73
v_mfma_f32_16x16x32_bf16 v[108:111],v[124:127],a[244:247],v[108:111]
v_exp_f32 v74,v74
v_mfma_f32_16x16x32_bf16 v[76:79],v[128:131],a[152:155],v[76:79]
v_exp_f32 v75,v75
v_mfma_f32_16x16x32_bf16 v[84:87],v[128:131],a[176:179],v[84:87]
v_exp_f32 v80,v80
v_mfma_f32_16x16x32_bf16 v[92:95],v[128:131],a[200:203],v[92:95]
buffer_load_dwordx4 v8,s[4:7],s20 offen offset:2048 lds
v_mfma_f32_16x16x32_bf16 v[100:103],v[128:131],a[224:227],v[100:103]
s_add_u32 s20,s20,12288
v_exp_f32 v81,v81
v_mfma_f32_16x16x32_bf16 v[108:111],v[128:131],a[248:251],v[108:111]
v_exp_f32 v82,v82
v_mfma_f32_16x16x32_bf16 v[76:79],v[132:135],a[156:159],v[76:79]
v_exp_f32 v83,v83
v_mfma_f32_16x16x32_bf16 v[84:87],v[132:135],a[180:183],v[84:87]
v_exp_f32 v88,v88
v_mfma_f32_16x16x32_bf16 v[92:95],v[132:135],a[204:207],v[92:95]
ds_read_b64_tr_b16 v[112:113],v2 offset:12288
v_mfma_f32_16x16x32_bf16 v[100:103],v[132:135],a[228:231],v[100:103]
ds_read_b64_tr_b16 v[114:115],v2 offset:18432
v_cvt_pk_bf16_f32 v20,v72,v73
v_mfma_f32_16x16x32_bf16 v[108:111],v[132:135],a[252:255],v[108:111]
v_exp_f32 v89,v89
v_mfma_f32_16x16x32_bf16 v[76:79],v[136:139],a[160:163],v[76:79]
ds_read_b64_tr_b16 v[116:117],v3 offset:12288
ds_read_b64_tr_b16 v[118:119],v3 offset:18432
v_mfma_f32_16x16x32_bf16 v[84:87],v[136:139],a[184:187],v[84:87]
v_cvt_pk_bf16_f32 v21,v74,v75
v_cvt_pk_bf16_f32 v24,v80,v81
v_mfma_f32_16x16x32_bf16 v[92:95],v[136:139],a[208:211],v[92:95]
ds_read_b64_tr_b16 v[120:121],v4 offset:12288
v_mfma_f32_16x16x32_bf16 v[100:103],v[136:139],a[232:235],v[100:103]
ds_read_b64_tr_b16 v[122:123],v4 offset:18432
v_cvt_pk_bf16_f32 v25,v82,v83
v_mfma_f32_16x16x32_bf16 v[108:111],v[136:139],v[144:147],v[108:111]
v_cvt_pk_bf16_f32 v28,v88,v89
v_mfma_f32_16x16x32_bf16 v[76:79],v[140:143],a[164:167],v[76:79]
ds_read_b64_tr_b16 v[124:125],v5 offset:12288
ds_read_b64_tr_b16 v[126:127],v5 offset:18432
v_mfma_f32_16x16x32_bf16 v[84:87],v[140:143],a[188:191],v[84:87]
v_mfma_f32_16x16x32_bf16 v[92:95],v[140:143],a[212:215],v[92:95]
v_mfma_f32_16x16x32_bf16 v[100:103],v[140:143],a[236:239],v[100:103]
v_mfma_f32_16x16x32_bf16 v[108:111],v[140:143],v[148:151],v[108:111]
s_waitcnt lgkmcnt(4)
v_mfma_f32_16x16x32_bf16 v[160:163],v[112:115],v[40:43],v[160:163]
s_add_u32 m0,s23,12288
ds_read_b64_tr_b16 v[128:129],v2 offset:12416
ds_read_b64_tr_b16 v[130:131],v2 offset:18560
v_mfma_f32_16x16x32_bf16 v[208:211],v[112:115],v[44:47],v[208:211]
ds_read_b64_tr_b16 v[132:133],v3 offset:12416
ds_read_b64_tr_b16 v[134:135],v3 offset:18560
v_mfma_f32_16x16x32_bf16 a[0:3],v[112:115],v[48:51],a[0:3]
ds_read_b64_tr_b16 v[136:137],v4 offset:12416
ds_read_b64_tr_b16 v[138:139],v4 offset:18560
v_mfma_f32_16x16x32_bf16 a[48:51],v[112:115],v[52:55],a[48:51]
ds_read_b64_tr_b16 v[140:141],v5 offset:12416
ds_read_b64_tr_b16 v[142:143],v5 offset:18560
v_mfma_f32_16x16x32_bf16 a[96:99],v[112:115],v[56:59],a[96:99]
ds_read_b64_tr_b16 v[112:113],v2 offset:12544
ds_read_b64_tr_b16 v[114:115],v2 offset:18688
v_mfma_f32_16x16x32_bf16 v[164:167],v[116:119],v[40:43],v[164:167]
v_fma_f32 v90,v90,s36,v15
v_fma_f32 v91,v91,s36,v15
v_mfma_f32_16x16x32_bf16 v[212:215],v[116:119],v[44:47],v[212:215]
v_exp_f32 v90,v90
v_mfma_f32_16x16x32_bf16 a[4:7],v[116:119],v[48:51],a[4:7]
v_exp_f32 v91,v91
v_mfma_f32_16x16x32_bf16 a[52:55],v[116:119],v[52:55],a[52:55]
v_cvt_pk_bf16_f32 v29,v90,v91
v_fma_f32 v96,v96,s36,v16
v_mfma_f32_16x16x32_bf16 a[100:103],v[116:119],v[56:59],a[100:103]
s_waitcnt lgkmcnt(8)
ds_read_b64_tr_b16 v[116:117],v3 offset:12544
ds_read_b64_tr_b16 v[118:119],v3 offset:18688
v_mfma_f32_16x16x32_bf16 v[168:171],v[120:123],v[40:43],v[168:171]
v_fma_f32 v97,v97,s36,v16
v_fma_f32 v98,v98,s36,v16
v_mfma_f32_16x16x32_bf16 v[216:219],v[120:123],v[44:47],v[216:219]
v_fma_f32 v99,v99,s36,v16
v_fma_f32 v104,v104,s36,v17
v_mfma_f32_16x16x32_bf16 a[8:11],v[120:123],v[48:51],a[8:11]
v_exp_f32 v96,v96
v_mfma_f32_16x16x32_bf16 a[56:59],v[120:123],v[52:55],a[56:59]
v_exp_f32 v97,v97
v_mfma_f32_16x16x32_bf16 a[104:107],v[120:123],v[56:59],a[104:107]
ds_read_b64_tr_b16 v[120:121],v4 offset:12544
ds_read_b64_tr_b16 v[122:123],v4 offset:18688
v_mfma_f32_16x16x32_bf16 v[172:175],v[124:127],v[40:43],v[172:175]
v_exp_f32 v98,v98
v_mfma_f32_16x16x32_bf16 v[220:223],v[124:127],v[44:47],v[220:223]
v_exp_f32 v99,v99
v_mfma_f32_16x16x32_bf16 a[12:15],v[124:127],v[48:51],a[12:15]
v_cvt_pk_bf16_f32 v32,v96,v97
v_cvt_pk_bf16_f32 v33,v98,v99
v_mfma_f32_16x16x32_bf16 a[60:63],v[124:127],v[52:55],a[60:63]
v_fma_f32 v105,v105,s36,v17
v_fma_f32 v106,v106,s36,v17
v_mfma_f32_16x16x32_bf16 a[108:111],v[124:127],v[56:59],a[108:111]
ds_read_b64_tr_b16 v[124:125],v5 offset:12544
ds_read_b64_tr_b16 v[126:127],v5 offset:18688
v_mfma_f32_16x16x32_bf16 v[176:179],v[128:131],v[40:43],v[176:179]
v_fma_f32 v107,v107,s36,v17
v_fma_f32 v76,v76,s36,v13
v_mfma_f32_16x16x32_bf16 v[224:227],v[128:131],v[44:47],v[224:227]
v_exp_f32 v104,v104
v_mfma_f32_16x16x32_bf16 a[16:19],v[128:131],v[48:51],a[16:19]
v_exp_f32 v105,v105
v_mfma_f32_16x16x32_bf16 a[64:67],v[128:131],v[52:55],a[64:67]
v_exp_f32 v106,v106
v_mfma_f32_16x16x32_bf16 a[112:115],v[128:131],v[56:59],a[112:115]
s_waitcnt lgkmcnt(2)
v_exp_f32 v107,v107
v_mfma_f32_16x16x32_bf16 v[180:183],v[132:135],v[40:43],v[180:183]
v_cvt_pk_bf16_f32 v36,v104,v105
v_cvt_pk_bf16_f32 v37,v106,v107
v_mfma_f32_16x16x32_bf16 v[228:231],v[132:135],v[44:47],v[228:231]
v_fma_f32 v77,v77,s36,v13
v_fma_f32 v78,v78,s36,v13
v_mfma_f32_16x16x32_bf16 a[20:23],v[132:135],v[48:51],a[20:23]
v_fma_f32 v79,v79,s36,v13
v_fma_f32 v84,v84,s36,v14
v_mfma_f32_16x16x32_bf16 a[68:71],v[132:135],v[52:55],a[68:71]
v_exp_f32 v76,v76
v_mfma_f32_16x16x32_bf16 a[116:119],v[132:135],v[56:59],a[116:119]
v_exp_f32 v77,v77
v_mfma_f32_16x16x32_bf16 v[184:187],v[136:139],v[40:43],v[184:187]
v_exp_f32 v78,v78
v_mfma_f32_16x16x32_bf16 v[232:235],v[136:139],v[44:47],v[232:235]
v_exp_f32 v79,v79
v_mfma_f32_16x16x32_bf16 a[24:27],v[136:139],v[48:51],a[24:27]
v_cvt_pk_bf16_f32 v22,v76,v77
v_cvt_pk_bf16_f32 v23,v78,v79
v_mfma_f32_16x16x32_bf16 a[72:75],v[136:139],v[52:55],a[72:75]
v_fma_f32 v85,v85,s36,v14
v_fma_f32 v86,v86,s36,v14
v_mfma_f32_16x16x32_bf16 a[120:123],v[136:139],v[56:59],a[120:123]
v_fma_f32 v87,v87,s36,v14
v_fma_f32 v92,v92,s36,v15
v_mfma_f32_16x16x32_bf16 v[188:191],v[140:143],v[40:43],v[188:191]
v_exp_f32 v84,v84
v_mfma_f32_16x16x32_bf16 v[236:239],v[140:143],v[44:47],v[236:239]
v_exp_f32 v85,v85
v_mfma_f32_16x16x32_bf16 a[28:31],v[140:143],v[48:51],a[28:31]
v_exp_f32 v86,v86
v_mfma_f32_16x16x32_bf16 a[76:79],v[140:143],v[52:55],a[76:79]
v_exp_f32 v87,v87
v_mfma_f32_16x16x32_bf16 a[124:127],v[140:143],v[56:59],a[124:127]
v_cvt_pk_bf16_f32 v26,v84,v85
v_cvt_pk_bf16_f32 v27,v86,v87
v_mfma_f32_16x16x32_bf16 v[192:195],v[112:115],v[40:43],v[192:195]
v_fma_f32 v93,v93,s36,v15
v_fma_f32 v94,v94,s36,v15
v_smfmac_f32_16x16x64_bf16 v[60:63],v[152:155],v[20:27],v18
v_fma_f32 v95,v95,s36,v15
s_waitcnt vmcnt(6) lgkmcnt(0)
v_mfma_f32_16x16x32_bf16 v[240:243],v[112:115],v[44:47],v[240:243]
s_barrier
v_mfma_f32_16x16x32_bf16 a[32:35],v[112:115],v[48:51],a[32:35]
ds_read_b128 v[128:131],v0 offset:0
v_fma_f32 v100,v100,s36,v16
v_mfma_f32_16x16x32_bf16 a[80:83],v[112:115],v[52:55],a[80:83]
ds_read_b128 v[132:135],v1 offset:0
v_fma_f32 v101,v101,s36,v16
v_mfma_f32_16x16x32_bf16 a[128:131],v[112:115],v[56:59],a[128:131]
ds_read_b128 v[136:139],v0 offset:128
v_fma_f32 v102,v102,s36,v16
v_mfma_f32_16x16x32_bf16 v[196:199],v[116:119],v[40:43],v[196:199]
ds_read_b128 v[140:143],v1 offset:128
v_fma_f32 v103,v103,s36,v16
v_mfma_f32_16x16x32_bf16 v[244:247],v[116:119],v[44:47],v[244:247]
ds_read_b128 v[112:115],v0 offset:256
v_fma_f32 v108,v108,s36,v17
v_mfma_f32_16x16x32_bf16 a[36:39],v[116:119],v[48:51],a[36:39]
buffer_load_dwordx4 v6,s[8:11],s21 offen offset:0 lds
v_mfma_f32_16x16x32_bf16 a[84:87],v[116:119],v[52:55],a[84:87]
v_exp_f32 v92,v92
v_mfma_f32_16x16x32_bf16 a[132:135],v[116:119],v[56:59],a[132:135]
ds_read_b128 v[116:119],v1 offset:256
v_fma_f32 v109,v109,s36,v17
v_mfma_f32_16x16x32_bf16 v[200:203],v[120:123],v[40:43],v[200:203]
v_exp_f32 v93,v93
v_mfma_f32_16x16x32_bf16 v[248:251],v[120:123],v[44:47],v[248:251]
v_exp_f32 v94,v94
v_mfma_f32_16x16x32_bf16 a[40:43],v[120:123],v[48:51],a[40:43]
v_exp_f32 v95,v95
v_mfma_f32_16x16x32_bf16 a[88:91],v[120:123],v[52:55],a[88:91]
v_cvt_pk_bf16_f32 v30,v92,v93
v_cvt_pk_bf16_f32 v31,v94,v95
v_mfma_f32_16x16x32_bf16 a[136:139],v[120:123],v[56:59],a[136:139]
ds_read_b128 v[120:123],v0 offset:6144
v_fma_f32 v110,v110,s36,v17
v_mfma_f32_16x16x32_bf16 v[204:207],v[124:127],v[40:43],v[204:207]
v_exp_f32 v100,v100
v_mfma_f32_16x16x32_bf16 v[252:255],v[124:127],v[44:47],v[252:255]
v_exp_f32 v101,v101
v_mfma_f32_16x16x32_bf16 a[44:47],v[124:127],v[48:51],a[44:47]
v_exp_f32 v102,v102
v_mfma_f32_16x16x32_bf16 a[92:95],v[124:127],v[52:55],a[92:95]
v_exp_f32 v103,v103
v_mfma_f32_16x16x32_bf16 a[140:143],v[124:127],v[56:59],a[140:143]
buffer_load_dwordx4 v7,s[8:11],s21 offen offset:1024 lds
s_waitcnt lgkmcnt(1)
v_mfma_f32_16x16x32_bf16 v[72:75],v[128:131],a[144:147],0
ds_read_b128 v[124:127],v1 offset:6144
v_cvt_pk_bf16_f32 v34,v100,v101
v_mfma_f32_16x16x32_bf16 v[80:83],v[128:131],a[168:171],0
v_cvt_pk_bf16_f32 v35,v102,v103
v_fma_f32 v111,v111,s36,v17
v_mfma_f32_16x16x32_bf16 v[88:91],v[128:131],a[192:195],0
v_exp_f32 v108,v108
v_smfmac_f32_16x16x64_bf16 v[64:67],v[152:155],v[28:35],v18
v_mfma_f32_16x16x32_bf16 v[96:99],v[128:131],a[216:219],0
v_exp_f32 v109,v109
v_mfma_f32_16x16x32_bf16 v[104:107],v[128:131],a[240:243],0
ds_read_b128 v[128:131],v0 offset:6272
v_cvt_pk_bf16_f32 v38,v108,v109
v_mfma_f32_16x16x32_bf16 v[72:75],v[132:135],a[148:151],v[72:75]
v_exp_f32 v110,v110
v_mfma_f32_16x16x32_bf16 v[80:83],v[132:135],a[172:175],v[80:83]
v_exp_f32 v111,v111
v_mfma_f32_16x16x32_bf16 v[88:91],v[132:135],a[196:199],v[88:91]
v_cvt_pk_bf16_f32 v39,v110,v111
v_mfma_f32_16x16x32_bf16 v[96:99],v[132:135],a[220:223],v[96:99]
v_mfma_f32_16x16x32_bf16 v[104:107],v[132:135],a[244:247],v[104:107]
buffer_load_dwordx4 v8,s[8:11],s21 offen offset:2048 lds
v_smfmac_f32_16x16x64_bf16 v[68:71],v[152:155],v[32:39],v18
s_add_u32 s21,s21,12288
ds_read_b128 v[132:135],v1 offset:6272
v_mfma_f32_16x16x32_bf16 v[72:75],v[136:139],a[152:155],v[72:75]
s_add_u32 m0,s22,24576
v_mfma_f32_16x16x32_bf16 v[80:83],v[136:139],a[176:179],v[80:83]
v_mfma_f32_16x16x32_bf16 v[88:91],v[136:139],a[200:203],v[88:91]
v_mfma_f32_16x16x32_bf16 v[96:99],v[136:139],a[224:227],v[96:99]
v_mfma_f32_16x16x32_bf16 v[104:107],v[136:139],a[248:251],v[104:107]
ds_read_b128 v[136:139],v0 offset:6400
v_mfma_f32_16x16x32_bf16 v[72:75],v[140:143],a[156:159],v[72:75]
v_mfma_f32_16x16x32_bf16 v[80:83],v[140:143],a[180:183],v[80:83]
v_mfma_f32_16x16x32_bf16 v[88:91],v[140:143],a[204:207],v[88:91]
v_mfma_f32_16x16x32_bf16 v[96:99],v[140:143],a[228:231],v[96:99]
v_mfma_f32_16x16x32_bf16 v[104:107],v[140:143],a[252:255],v[104:107]
buffer_load_dwordx4 v6,s[4:7],s20 offen offset:0 lds
v_mfma_f32_16x16x32_bf16 v[72:75],v[112:115],a[160:163],v[72:75]
ds_read_b128 v[140:143],v1 offset:6400
v_mfma_f32_16x16x32_bf16 v[80:83],v[112:115],a[184:187],v[80:83]
v_mfma_f32_16x16x32_bf16 v[88:91],v[112:115],a[208:211],v[88:91]
v_mfma_f32_16x16x32_bf16 v[96:99],v[112:115],a[232:235],v[96:99]
v_mfma_f32_16x16x32_bf16 v[104:107],v[112:115],v[144:147],v[104:107]
v_mfma_f32_16x16x32_bf16 v[72:75],v[116:119],a[164:167],v[72:75]
v_mfma_f32_16x16x32_bf16 v[80:83],v[116:119],a[188:191],v[80:83]
v_mfma_f32_16x16x32_bf16 v[88:91],v[116:119],a[212:215],v[88:91]
v_mfma_f32_16x16x32_bf16 v[96:99],v[116:119],a[236:239],v[96:99]
v_mfma_f32_16x16x32_bf16 v[104:107],v[116:119],v[148:151],v[104:107]
s_waitcnt lgkmcnt(0)
v_mfma_f32_16x16x32_bf16 v[76:79],v[120:123],a[144:147],0
v_mfma_f32_16x16x32_bf16 v[84:87],v[120:123],a[168:171],0
buffer_load_dwordx4 v7,s[4:7],s20 offen offset:1024 lds
v_mfma_f32_16x16x32_bf16 v[92:95],v[120:123],a[192:195],0
v_fma_f32 v72,v72,s36,v13
v_fma_f32 v73,v73,s36,v13
v_mfma_f32_16x16x32_bf16 v[100:103],v[120:123],a[216:219],0
v_fma_f32 v74,v74,s36,v13
v_fma_f32 v75,v75,s36,v13
v_mfma_f32_16x16x32_bf16 v[108:111],v[120:123],a[240:243],0
v_fma_f32 v80,v80,s36,v14
v_fma_f32 v81,v81,s36,v14
v_mfma_f32_16x16x32_bf16 v[76:79],v[124:127],a[148:151],v[76:79]
v_fma_f32 v82,v82,s36,v14
v_fma_f32 v83,v83,s36,v14
v_mfma_f32_16x16x32_bf16 v[84:87],v[124:127],a[172:175],v[84:87]
v_fma_f32 v88,v88,s36,v15
v_fma_f32 v89,v89,s36,v15
v_mfma_f32_16x16x32_bf16 v[92:95],v[124:127],a[196:199],v[92:95]
v_exp_f32 v72,v72
v_mfma_f32_16x16x32_bf16 v[100:103],v[124:127],a[220:223],v[100:103]
v_exp_f32 v73,v73
v_mfma_f32_16x16x32_bf16 v[108:111],v[124:127],a[244:247],v[108:111]
v_exp_f32 v74,v74
v_mfma_f32_16x16x32_bf16 v[76:79],v[128:131],a[152:155],v[76:79]
v_exp_f32 v75,v75
v_mfma_f32_16x16x32_bf16 v[84:87],v[128:131],a[176:179],v[84:87]
v_exp_f32 v80,v80
v_mfma_f32_16x16x32_bf16 v[92:95],v[128:131],a[200:203],v[92:95]
buffer_load_dwordx4 v8,s[4:7],s20 offen offset:2048 lds
v_mfma_f32_16x16x32_bf16 v[100:103],v[128:131],a[224:227],v[100:103]
s_add_u32 s20,s20,12288
v_exp_f32 v81,v81
v_mfma_f32_16x16x32_bf16 v[108:111],v[128:131],a[248:251],v[108:111]
v_exp_f32 v82,v82
v_mfma_f32_16x16x32_bf16 v[76:79],v[132:135],a[156:159],v[76:79]
v_exp_f32 v83,v83
v_mfma_f32_16x16x32_bf16 v[84:87],v[132:135],a[180:183],v[84:87]
v_exp_f32 v88,v88
v_mfma_f32_16x16x32_bf16 v[92:95],v[132:135],a[204:207],v[92:95]
ds_read_b64_tr_b16 v[112:113],v2 offset:24576
v_mfma_f32_16x16x32_bf16 v[100:103],v[132:135],a[228:231],v[100:103]
ds_read_b64_tr_b16 v[114:115],v2 offset:30720
v_cvt_pk_bf16_f32 v40,v72,v73
v_mfma_f32_16x16x32_bf16 v[108:111],v[132:135],a[252:255],v[108:111]
v_exp_f32 v89,v89
v_mfma_f32_16x16x32_bf16 v[76:79],v[136:139],a[160:163],v[76:79]
ds_read_b64_tr_b16 v[116:117],v3 offset:24576
ds_read_b64_tr_b16 v[118:119],v3 offset:30720
v_mfma_f32_16x16x32_bf16 v[84:87],v[136:139],a[184:187],v[84:87]
v_cvt_pk_bf16_f32 v41,v74,v75
v_cvt_pk_bf16_f32 v44,v80,v81
v_mfma_f32_16x16x32_bf16 v[92:95],v[136:139],a[208:211],v[92:95]
ds_read_b64_tr_b16 v[120:121],v4 offset:24576
v_mfma_f32_16x16x32_bf16 v[100:103],v[136:139],a[232:235],v[100:103]
ds_read_b64_tr_b16 v[122:123],v4 offset:30720
v_cvt_pk_bf16_f32 v45,v82,v83
v_mfma_f32_16x16x32_bf16 v[108:111],v[136:139],v[144:147],v[108:111]
v_cvt_pk_bf16_f32 v48,v88,v89
v_mfma_f32_16x16x32_bf16 v[76:79],v[140:143],a[164:167],v[76:79]
ds_read_b64_tr_b16 v[124:125],v5 offset:24576
ds_read_b64_tr_b16 v[126:127],v5 offset:30720
v_mfma_f32_16x16x32_bf16 v[84:87],v[140:143],a[188:191],v[84:87]
v_mfma_f32_16x16x32_bf16 v[92:95],v[140:143],a[212:215],v[92:95]
v_mfma_f32_16x16x32_bf16 v[100:103],v[140:143],a[236:239],v[100:103]
v_mfma_f32_16x16x32_bf16 v[108:111],v[140:143],v[148:151],v[108:111]
s_mov_b32 s38,0
s_branch L_loop5
L_loop4:
.p2align 6
L_loop4w0:
s_waitcnt lgkmcnt(4)
v_mfma_f32_16x16x32_bf16 v[160:163],v[112:115],v[20:23],v[160:163]
s_add_u32 m0,s23,24576
ds_read_b64_tr_b16 v[128:129],v2 offset:24704
ds_read_b64_tr_b16 v[130:131],v2 offset:30848
v_mfma_f32_16x16x32_bf16 v[208:211],v[112:115],v[24:27],v[208:211]
ds_read_b64_tr_b16 v[134:135],v3 offset:30848
ds_read_b64_tr_b16 v[132:133],v3 offset:24704
v_mfma_f32_16x16x32_bf16 a[0:3],v[112:115],v[28:31],a[0:3]
ds_read_b64_tr_b16 v[138:139],v4 offset:30848
ds_read_b64_tr_b16 v[136:137],v4 offset:24704
v_mfma_f32_16x16x32_bf16 a[48:51],v[112:115],v[32:35],a[48:51]
ds_read_b64_tr_b16 v[142:143],v5 offset:30848
ds_read_b64_tr_b16 v[140:141],v5 offset:24704
v_mfma_f32_16x16x32_bf16 v[164:167],v[116:119],v[20:23],v[164:167]
ds_read_b64_tr_b16 v[114:115],v2 offset:30976
ds_read_b64_tr_b16 v[112:113],v2 offset:24832
v_mfma_f32_16x16x32_bf16 v[212:215],v[116:119],v[24:27],v[212:215]
v_fma_f32 v83,v83,s36,v14
v_fma_f32 v90,v90,s36,v15
v_mfma_f32_16x16x32_bf16 a[4:7],v[116:119],v[28:31],a[4:7]
v_exp_f32 v83,v83
v_mfma_f32_16x16x32_bf16 a[52:55],v[116:119],v[32:35],a[52:55]
s_waitcnt lgkmcnt(10)
ds_read_b64_tr_b16 v[116:117],v3 offset:24832
ds_read_b64_tr_b16 v[118:119],v3 offset:30976
v_mfma_f32_16x16x32_bf16 v[168:171],v[120:123],v[20:23],v[168:171]
v_exp_f32 v90,v90
v_mfma_f32_16x16x32_bf16 v[216:219],v[120:123],v[24:27],v[216:219]
v_fma_f32 v82,v82,s36,v14
v_fma_f32 v88,v88,s36,v15
v_mfma_f32_16x16x32_bf16 a[8:11],v[120:123],v[28:31],a[8:11]
v_exp_f32 v82,v82
v_mfma_f32_16x16x32_bf16 a[56:59],v[120:123],v[32:35],a[56:59]
ds_read_b64_tr_b16 v[122:123],v4 offset:30976
ds_read_b64_tr_b16 v[120:121],v4 offset:24832
v_mfma_f32_16x16x32_bf16 v[172:175],v[124:127],v[20:23],v[172:175]
v_exp_f32 v88,v88
v_mfma_f32_16x16x32_bf16 v[220:223],v[124:127],v[24:27],v[220:223]
v_cvt_pk_bf16_f32 v45,v82,v83
v_fma_f32 v89,v89,s36,v15
v_mfma_f32_16x16x32_bf16 a[12:15],v[124:127],v[28:31],a[12:15]
v_exp_f32 v89,v89
v_mfma_f32_16x16x32_bf16 a[60:63],v[124:127],v[32:35],a[60:63]
s_waitcnt lgkmcnt(3)
ds_read_b64_tr_b16 v[124:125],v5 offset:24832
ds_read_b64_tr_b16 v[126:127],v5 offset:30976
v_mfma_f32_16x16x32_bf16 v[176:179],v[128:131],v[20:23],v[176:179]
v_fma_f32 v99,v99,s36,v16
v_fma_f32 v91,v91,s36,v15
v_mfma_f32_16x16x32_bf16 v[224:227],v[128:131],v[24:27],v[224:227]
v_exp_f32 v91,v91
v_mfma_f32_16x16x32_bf16 a[16:19],v[128:131],v[28:31],a[16:19]
v_exp_f32 v99,v99
v_mfma_f32_16x16x32_bf16 a[64:67],v[128:131],v[32:35],a[64:67]
v_cvt_pk_bf16_f32 v48,v88,v89
v_fma_f32 v96,v96,s36,v16
v_mfma_f32_16x16x32_bf16 v[180:183],v[132:135],v[20:23],v[180:183]
v_exp_f32 v96,v96
v_mfma_f32_16x16x32_bf16 v[228:231],v[132:135],v[24:27],v[228:231]
v_cvt_pk_bf16_f32 v49,v90,v91
v_fma_f32 v97,v97,s36,v16
v_mfma_f32_16x16x32_bf16 a[20:23],v[132:135],v[28:31],a[20:23]
v_exp_f32 v97,v97
v_mfma_f32_16x16x32_bf16 a[68:71],v[132:135],v[32:35],a[68:71]
v_fma_f32 v98,v98,s36,v16
v_cvt_pk_bf16_f32 v52,v96,v97
v_mfma_f32_16x16x32_bf16 v[184:187],v[136:139],v[20:23],v[184:187]
v_exp_f32 v98,v98
v_mfma_f32_16x16x32_bf16 v[232:235],v[136:139],v[24:27],v[232:235]
v_cvt_pk_bf16_f32 v53,v98,v99
v_fma_f32 v76,v76,s36,v13
v_mfma_f32_16x16x32_bf16 a[24:27],v[136:139],v[28:31],a[24:27]
v_exp_f32 v76,v76
v_mfma_f32_16x16x32_bf16 a[72:75],v[136:139],v[32:35],a[72:75]
v_fma_f32 v79,v79,s36,v13
v_fma_f32 v78,v78,s36,v13
v_mfma_f32_16x16x32_bf16 v[188:191],v[140:143],v[20:23],v[188:191]
v_exp_f32 v79,v79
v_mfma_f32_16x16x32_bf16 v[236:239],v[140:143],v[24:27],v[236:239]
v_exp_f32 v78,v78
v_mfma_f32_16x16x32_bf16 a[28:31],v[140:143],v[28:31],a[28:31]
v_cvt_pk_bf16_f32 v43,v78,v79
v_fma_f32 v77,v77,s36,v13
v_mfma_f32_16x16x32_bf16 a[76:79],v[140:143],v[32:35],a[76:79]
v_exp_f32 v77,v77
v_mfma_f32_16x16x32_bf16 v[192:195],v[112:115],v[20:23],v[192:195]
v_cvt_pk_bf16_f32 v42,v76,v77
v_fma_f32 v86,v86,s36,v14
s_waitcnt vmcnt(6) lgkmcnt(0)
v_mfma_f32_16x16x32_bf16 v[240:243],v[112:115],v[24:27],v[240:243]
s_barrier
v_mfma_f32_16x16x32_bf16 a[32:35],v[112:115],v[28:31],a[32:35]
ds_read_b128 v[128:131],v0 offset:12288
v_fma_f32 v85,v85,s36,v14
v_mfma_f32_16x16x32_bf16 a[80:83],v[112:115],v[32:35],a[80:83]
ds_read_b128 v[132:135],v1 offset:12288
v_fma_f32 v93,v93,s36,v15
v_mfma_f32_16x16x32_bf16 v[196:199],v[116:119],v[20:23],v[196:199]
ds_read_b128 v[136:139],v0 offset:12416
v_fma_f32 v94,v94,s36,v15
v_mfma_f32_16x16x32_bf16 v[244:247],v[116:119],v[24:27],v[244:247]
ds_read_b128 v[140:143],v1 offset:12416
v_fma_f32 v84,v84,s36,v14
v_mfma_f32_16x16x32_bf16 a[36:39],v[116:119],v[28:31],a[36:39]
ds_read_b128 v[156:159],v10 offset:0
v_fma_f32 v92,v92,s36,v15
v_mfma_f32_16x16x32_bf16 a[84:87],v[116:119],v[32:35],a[84:87]
buffer_load_dwordx4 v6,s[8:11],s21 offen offset:0 lds
v_mfma_f32_16x16x32_bf16 v[200:203],v[120:123],v[20:23],v[200:203]
ds_read_b128 v[112:115],v0 offset:12544
v_fma_f32 v87,v87,s36,v14
v_mfma_f32_16x16x32_bf16 v[248:251],v[120:123],v[24:27],v[248:251]
ds_read_b128 v[116:119],v1 offset:12544
v_fma_f32 v95,v95,s36,v15
v_mfma_f32_16x16x32_bf16 a[40:43],v[120:123],v[28:31],a[40:43]
v_exp_f32 v84,v84
v_mfma_f32_16x16x32_bf16 a[88:91],v[120:123],v[32:35],a[88:91]
ds_read_b128 v[120:123],v0 offset:18432
v_fma_f32 v102,v102,s36,v16
v_mfma_f32_16x16x32_bf16 v[204:207],v[124:127],v[20:23],v[204:207]
v_exp_f32 v87,v87
v_mfma_f32_16x16x32_bf16 v[252:255],v[124:127],v[24:27],v[252:255]
v_exp_f32 v85,v85
v_mfma_f32_16x16x32_bf16 a[44:47],v[124:127],v[28:31],a[44:47]
v_exp_f32 v95,v95
v_mfma_f32_16x16x32_bf16 a[92:95],v[124:127],v[32:35],a[92:95]
s_waitcnt lgkmcnt(3)
ds_read_b128 v[124:127],v1 offset:18432
v_cvt_pk_bf16_f32 v46,v84,v85
v_mfma_f32_16x16x32_bf16 v[72:75],v[128:131],a[144:147],0
buffer_store_dwordx4 v[156:159],v9,s[16:19],s27 offen offset:0 nt
buffer_load_dwordx4 v7,s[8:11],s21 offen offset:1024 lds
v_mfma_f32_16x16x32_bf16 v[80:83],v[128:131],a[168:171],0
ds_read_b128 v[156:159],v10 offset:1024
v_mfma_f32_16x16x32_bf16 v[88:91],v[128:131],a[192:195],0
v_exp_f32 v86,v86
v_mfma_f32_16x16x32_bf16 v[96:99],v[128:131],a[216:219],0
v_exp_f32 v93,v93
v_mfma_f32_16x16x32_bf16 v[72:75],v[132:135],a[148:151],v[72:75]
v_exp_f32 v92,v92
v_mfma_f32_16x16x32_bf16 v[80:83],v[132:135],a[172:175],v[80:83]
ds_read_b128 v[128:131],v0 offset:18560
v_fma_f32 v103,v103,s36,v16
v_mfma_f32_16x16x32_bf16 v[88:91],v[132:135],a[196:199],v[88:91]
v_exp_f32 v102,v102
v_mfma_f32_16x16x32_bf16 v[96:99],v[132:135],a[220:223],v[96:99]
v_exp_f32 v94,v94
v_mfma_f32_16x16x32_bf16 v[72:75],v[136:139],a[152:155],v[72:75]
buffer_load_dwordx4 v8,s[8:11],s21 offen offset:2048 lds
v_mfma_f32_16x16x32_bf16 v[80:83],v[136:139],a[176:179],v[80:83]
s_add_u32 s21,s21,12288
v_exp_f32 v103,v103
v_mfma_f32_16x16x32_bf16 v[88:91],v[136:139],a[200:203],v[88:91]
s_add_u32 m0,s22,0
v_cvt_pk_bf16_f32 v51,v94,v95
v_cvt_pk_bf16_f32 v47,v86,v87
v_mfma_f32_16x16x32_bf16 v[96:99],v[136:139],a[224:227],v[96:99]
v_fma_f32 v101,v101,s36,v16
v_fma_f32 v100,v100,s36,v16
v_smfmac_f32_16x16x64_bf16 v[60:63],v[152:155],v[40:47],v18
v_cvt_pk_bf16_f32 v50,v92,v93
v_mfma_f32_16x16x32_bf16 v[72:75],v[140:143],a[156:159],v[72:75]
v_exp_f32 v100,v100
v_mfma_f32_16x16x32_bf16 v[80:83],v[140:143],a[180:183],v[80:83]
v_exp_f32 v101,v101
v_mfma_f32_16x16x32_bf16 v[88:91],v[140:143],a[204:207],v[88:91]
ds_read_b128 v[132:135],v1 offset:18560
v_cvt_pk_bf16_f32 v55,v102,v103
v_mfma_f32_16x16x32_bf16 v[96:99],v[140:143],a[228:231],v[96:99]
s_waitcnt lgkmcnt(1)
v_cvt_pk_bf16_f32 v54,v100,v101
v_mfma_f32_16x16x32_bf16 v[72:75],v[112:115],a[160:163],v[72:75]
buffer_store_dwordx4 v[156:159],v9,s[16:19],s27 offen offset:128 nt
buffer_load_dwordx4 v6,s[4:7],s20 offen offset:0 lds
v_smfmac_f32_16x16x64_bf16 v[64:67],v[152:155],v[48:55],v18
ds_read_b128 v[156:159],v10 offset:2048
v_mfma_f32_16x16x32_bf16 v[80:83],v[112:115],a[184:187],v[80:83]
ds_read_b128 v[136:139],v0 offset:18688
v_mfma_f32_16x16x32_bf16 v[88:91],v[112:115],a[208:211],v[88:91]
ds_read_b128 v[140:143],v1 offset:18688
v_mfma_f32_16x16x32_bf16 v[96:99],v[112:115],a[232:235],v[96:99]
v_mfma_f32_16x16x32_bf16 v[72:75],v[116:119],a[164:167],v[72:75]
v_mfma_f32_16x16x32_bf16 v[80:83],v[116:119],a[188:191],v[80:83]
v_mfma_f32_16x16x32_bf16 v[88:91],v[116:119],a[212:215],v[88:91]
v_mfma_f32_16x16x32_bf16 v[96:99],v[116:119],a[236:239],v[96:99]
buffer_load_dwordx4 v7,s[4:7],s20 offen offset:1024 lds
v_mfma_f32_16x16x32_bf16 v[76:79],v[120:123],a[144:147],0
v_mfma_f32_16x16x32_bf16 v[84:87],v[120:123],a[168:171],0
v_mfma_f32_16x16x32_bf16 v[92:95],v[120:123],a[192:195],0
v_mfma_f32_16x16x32_bf16 v[100:103],v[120:123],a[216:219],0
v_fma_f32 v74,v74,s36,v13
v_fma_f32 v72,v72,s36,v13
v_mfma_f32_16x16x32_bf16 v[76:79],v[124:127],a[148:151],v[76:79]
v_exp_f32 v72,v72
v_mfma_f32_16x16x32_bf16 v[84:87],v[124:127],a[172:175],v[84:87]
v_exp_f32 v74,v74
v_mfma_f32_16x16x32_bf16 v[92:95],v[124:127],a[196:199],v[92:95]
v_fma_f32 v75,v75,s36,v13
v_fma_f32 v73,v73,s36,v13
v_mfma_f32_16x16x32_bf16 v[100:103],v[124:127],a[220:223],v[100:103]
v_exp_f32 v75,v75
v_mfma_f32_16x16x32_bf16 v[76:79],v[128:131],a[152:155],v[76:79]
s_waitcnt lgkmcnt(0)
buffer_store_dwordx4 v[156:159],v9,s[16:19],s27 offen offset:256 nt
buffer_load_dwordx4 v8,s[4:7],s20 offen offset:2048 lds
v_mfma_f32_16x16x32_bf16 v[84:87],v[128:131],a[176:179],v[84:87]
s_add_u32 s20,s20,12288
ds_read_b64_tr_b16 v[114:115],v2 offset:6144
v_mfma_f32_16x16x32_bf16 v[92:95],v[128:131],a[200:203],v[92:95]
s_add_u32 s27,s27,3072
ds_read_b64_tr_b16 v[112:113],v2 offset:0
v_fma_f32 v81,v81,s36,v14
v_mfma_f32_16x16x32_bf16 v[100:103],v[128:131],a[224:227],v[100:103]
ds_read_b64_tr_b16 v[116:117],v3 offset:0
v_mfma_f32_16x16x32_bf16 v[76:79],v[132:135],a[156:159],v[76:79]
ds_read_b64_tr_b16 v[118:119],v3 offset:6144
v_fma_f32 v80,v80,s36,v14
v_mfma_f32_16x16x32_bf16 v[84:87],v[132:135],a[180:183],v[84:87]
ds_read_b64_tr_b16 v[120:121],v4 offset:0
v_mfma_f32_16x16x32_bf16 v[92:95],v[132:135],a[204:207],v[92:95]
ds_read_b64_tr_b16 v[122:123],v4 offset:6144
v_cvt_pk_bf16_f32 v21,v74,v75
v_mfma_f32_16x16x32_bf16 v[100:103],v[132:135],a[228:231],v[100:103]
ds_read_b64_tr_b16 v[124:125],v5 offset:0
v_mfma_f32_16x16x32_bf16 v[76:79],v[136:139],a[160:163],v[76:79]
ds_read_b64_tr_b16 v[126:127],v5 offset:6144
v_mfma_f32_16x16x32_bf16 v[84:87],v[136:139],a[184:187],v[84:87]
v_exp_f32 v73,v73
v_mfma_f32_16x16x32_bf16 v[92:95],v[136:139],a[208:211],v[92:95]
v_exp_f32 v80,v80
v_mfma_f32_16x16x32_bf16 v[100:103],v[136:139],a[232:235],v[100:103]
v_exp_f32 v81,v81
v_mfma_f32_16x16x32_bf16 v[76:79],v[140:143],a[164:167],v[76:79]
v_cvt_pk_bf16_f32 v20,v72,v73
v_cvt_pk_bf16_f32 v24,v80,v81
v_mfma_f32_16x16x32_bf16 v[84:87],v[140:143],a[188:191],v[84:87]
v_mfma_f32_16x16x32_bf16 v[92:95],v[140:143],a[212:215],v[92:95]
v_mfma_f32_16x16x32_bf16 v[100:103],v[140:143],a[236:239],v[100:103]
s_waitcnt lgkmcnt(2)
v_mfma_f32_16x16x32_bf16 v[160:163],v[112:115],v[40:43],v[160:163]
s_add_u32 m0,s29,0
ds_read_b64_tr_b16 v[128:129],v2 offset:128
ds_read_b64_tr_b16 v[130:131],v2 offset:6272
v_mfma_f32_16x16x32_bf16 v[208:211],v[112:115],v[44:47],v[208:211]
ds_read_b64_tr_b16 v[132:133],v3 offset:128
ds_read_b64_tr_b16 v[134:135],v3 offset:6272
v_mfma_f32_16x16x32_bf16 a[0:3],v[112:115],v[48:51],a[0:3]
ds_read_b64_tr_b16 v[136:137],v4 offset:128
ds_read_b64_tr_b16 v[138:139],v4 offset:6272
v_mfma_f32_16x16x32_bf16 a[48:51],v[112:115],v[52:55],a[48:51]
ds_read_b64_tr_b16 v[140:141],v5 offset:128
ds_read_b64_tr_b16 v[142:143],v5 offset:6272
v_mfma_f32_16x16x32_bf16 v[164:167],v[116:119],v[40:43],v[164:167]
ds_read_b64_tr_b16 v[112:113],v2 offset:256
ds_read_b64_tr_b16 v[114:115],v2 offset:6400
v_mfma_f32_16x16x32_bf16 v[212:215],v[116:119],v[44:47],v[212:215]
v_fma_f32 v82,v82,s36,v14
v_fma_f32 v83,v83,s36,v14
v_mfma_f32_16x16x32_bf16 a[4:7],v[116:119],v[48:51],a[4:7]
buffer_load_dwordx4 v6,s[12:15],s28 offen offset:0 nt lds
v_mfma_f32_16x16x32_bf16 a[52:55],v[116:119],v[52:55],a[52:55]
ds_read_b64_tr_b16 v[116:117],v3 offset:256
ds_read_b64_tr_b16 v[118:119],v3 offset:6400
v_mfma_f32_16x16x32_bf16 v[168:171],v[120:123],v[40:43],v[168:171]
v_exp_f32 v82,v82
v_mfma_f32_16x16x32_bf16 v[216:219],v[120:123],v[44:47],v[216:219]
v_exp_f32 v83,v83
v_mfma_f32_16x16x32_bf16 a[8:11],v[120:123],v[48:51],a[8:11]
v_cvt_pk_bf16_f32 v25,v82,v83
v_fma_f32 v88,v88,s36,v15
v_mfma_f32_16x16x32_bf16 a[56:59],v[120:123],v[52:55],a[56:59]
s_waitcnt lgkmcnt(5)
ds_read_b64_tr_b16 v[120:121],v4 offset:256
ds_read_b64_tr_b16 v[122:123],v4 offset:6400
v_mfma_f32_16x16x32_bf16 v[172:175],v[124:127],v[40:43],v[172:175]
v_fma_f32 v89,v89,s36,v15
v_fma_f32 v90,v90,s36,v15
v_mfma_f32_16x16x32_bf16 v[220:223],v[124:127],v[44:47],v[220:223]
buffer_load_dwordx4 v7,s[12:15],s28 offen offset:1024 nt lds
v_mfma_f32_16x16x32_bf16 a[12:15],v[124:127],v[48:51],a[12:15]
v_fma_f32 v91,v91,s36,v15
v_fma_f32 v96,v96,s36,v16
v_mfma_f32_16x16x32_bf16 a[60:63],v[124:127],v[52:55],a[60:63]
ds_read_b64_tr_b16 v[124:125],v5 offset:256
ds_read_b64_tr_b16 v[126:127],v5 offset:6400
v_mfma_f32_16x16x32_bf16 v[176:179],v[128:131],v[40:43],v[176:179]
v_exp_f32 v88,v88
v_mfma_f32_16x16x32_bf16 v[224:227],v[128:131],v[44:47],v[224:227]
v_exp_f32 v89,v89
v_mfma_f32_16x16x32_bf16 a[16:19],v[128:131],v[48:51],a[16:19]
v_exp_f32 v90,v90
v_mfma_f32_16x16x32_bf16 a[64:67],v[128:131],v[52:55],a[64:67]
v_exp_f32 v91,v91
v_mfma_f32_16x16x32_bf16 v[180:183],v[132:135],v[40:43],v[180:183]
v_cvt_pk_bf16_f32 v28,v88,v89
v_cvt_pk_bf16_f32 v29,v90,v91
v_mfma_f32_16x16x32_bf16 v[228:231],v[132:135],v[44:47],v[228:231]
buffer_load_dwordx4 v8,s[12:15],s28 offen offset:2048 nt lds
v_mfma_f32_16x16x32_bf16 a[20:23],v[132:135],v[48:51],a[20:23]
s_add_u32 s28,s28,3072
v_fma_f32 v97,v97,s36,v16
v_fma_f32 v98,v98,s36,v16
v_mfma_f32_16x16x32_bf16 a[68:71],v[132:135],v[52:55],a[68:71]
s_add_u32 s29,s29,3072
v_fma_f32 v99,v99,s36,v16
v_fma_f32 v76,v76,s36,v13
v_mfma_f32_16x16x32_bf16 v[184:187],v[136:139],v[40:43],v[184:187]
s_add_u32 m0,s23,0
v_exp_f32 v96,v96
v_mfma_f32_16x16x32_bf16 v[232:235],v[136:139],v[44:47],v[232:235]
v_exp_f32 v97,v97
v_mfma_f32_16x16x32_bf16 a[24:27],v[136:139],v[48:51],a[24:27]
v_exp_f32 v98,v98
v_mfma_f32_16x16x32_bf16 a[72:75],v[136:139],v[52:55],a[72:75]
s_waitcnt lgkmcnt(0)
v_exp_f32 v99,v99
v_mfma_f32_16x16x32_bf16 v[188:191],v[140:143],v[40:43],v[188:191]
v_cvt_pk_bf16_f32 v32,v96,v97
v_cvt_pk_bf16_f32 v33,v98,v99
v_mfma_f32_16x16x32_bf16 v[236:239],v[140:143],v[44:47],v[236:239]
v_fma_f32 v77,v77,s36,v13
v_fma_f32 v78,v78,s36,v13
v_mfma_f32_16x16x32_bf16 a[28:31],v[140:143],v[48:51],a[28:31]
v_fma_f32 v79,v79,s36,v13
v_fma_f32 v84,v84,s36,v14
v_mfma_f32_16x16x32_bf16 a[76:79],v[140:143],v[52:55],a[76:79]
v_exp_f32 v76,v76
s_waitcnt vmcnt(12)
v_mfma_f32_16x16x32_bf16 v[192:195],v[112:115],v[40:43],v[192:195]
s_barrier
v_mfma_f32_16x16x32_bf16 v[240:243],v[112:115],v[44:47],v[240:243]
ds_read_b128 v[128:131],v0 offset:24576
v_fma_f32 v85,v85,s36,v14
v_mfma_f32_16x16x32_bf16 a[32:35],v[112:115],v[48:51],a[32:35]
ds_read_b128 v[132:135],v1 offset:24576
v_fma_f32 v86,v86,s36,v14
v_mfma_f32_16x16x32_bf16 a[80:83],v[112:115],v[52:55],a[80:83]
ds_read_b128 v[136:139],v0 offset:24704
v_fma_f32 v87,v87,s36,v14
v_mfma_f32_16x16x32_bf16 v[196:199],v[116:119],v[40:43],v[196:199]
ds_read_b128 v[140:143],v1 offset:24704
v_fma_f32 v92,v92,s36,v15
v_mfma_f32_16x16x32_bf16 v[244:247],v[116:119],v[44:47],v[244:247]
ds_read_b128 v[112:115],v0 offset:24832
v_fma_f32 v93,v93,s36,v15
v_mfma_f32_16x16x32_bf16 a[36:39],v[116:119],v[48:51],a[36:39]
buffer_load_dwordx4 v6,s[8:11],s21 offen offset:0 lds
v_mfma_f32_16x16x32_bf16 a[84:87],v[116:119],v[52:55],a[84:87]
ds_read_b128 v[116:119],v1 offset:24832
v_fma_f32 v94,v94,s36,v15
v_mfma_f32_16x16x32_bf16 v[200:203],v[120:123],v[40:43],v[200:203]
v_exp_f32 v77,v77
v_mfma_f32_16x16x32_bf16 v[248:251],v[120:123],v[44:47],v[248:251]
v_exp_f32 v78,v78
v_mfma_f32_16x16x32_bf16 a[40:43],v[120:123],v[48:51],a[40:43]
v_exp_f32 v79,v79
v_mfma_f32_16x16x32_bf16 a[88:91],v[120:123],v[52:55],a[88:91]
ds_read_b128 v[120:123],v0 offset:30720
v_cvt_pk_bf16_f32 v22,v76,v77
v_mfma_f32_16x16x32_bf16 v[204:207],v[124:127],v[40:43],v[204:207]
v_cvt_pk_bf16_f32 v23,v78,v79
v_fma_f32 v95,v95,s36,v15
v_mfma_f32_16x16x32_bf16 v[252:255],v[124:127],v[44:47],v[252:255]
v_exp_f32 v84,v84
v_mfma_f32_16x16x32_bf16 a[44:47],v[124:127],v[48:51],a[44:47]
v_exp_f32 v85,v85
v_mfma_f32_16x16x32_bf16 a[92:95],v[124:127],v[52:55],a[92:95]
buffer_load_dwordx4 v7,s[8:11],s21 offen offset:1024 lds
s_waitcnt lgkmcnt(1)
v_mfma_f32_16x16x32_bf16 v[72:75],v[128:131],a[144:147],0
ds_read_b128 v[124:127],v1 offset:30720
v_cvt_pk_bf16_f32 v26,v84,v85
v_mfma_f32_16x16x32_bf16 v[80:83],v[128:131],a[168:171],0
v_exp_f32 v86,v86
v_mfma_f32_16x16x32_bf16 v[88:91],v[128:131],a[192:195],0
v_exp_f32 v87,v87
v_mfma_f32_16x16x32_bf16 v[96:99],v[128:131],a[216:219],0
ds_read_b128 v[128:131],v0 offset:30848
v_cvt_pk_bf16_f32 v27,v86,v87
v_mfma_f32_16x16x32_bf16 v[72:75],v[132:135],a[148:151],v[72:75]
v_exp_f32 v92,v92
v_smfmac_f32_16x16x64_bf16 v[60:63],v[152:155],v[20:27],v18
v_fma_f32 v100,v100,s36,v16
v_mfma_f32_16x16x32_bf16 v[80:83],v[132:135],a[172:175],v[80:83]
v_exp_f32 v93,v93
v_mfma_f32_16x16x32_bf16 v[88:91],v[132:135],a[196:199],v[88:91]
v_exp_f32 v94,v94
v_mfma_f32_16x16x32_bf16 v[96:99],v[132:135],a[220:223],v[96:99]
buffer_load_dwordx4 v8,s[8:11],s21 offen offset:2048 lds
v_mfma_f32_16x16x32_bf16 v[72:75],v[136:139],a[152:155],v[72:75]
s_add_u32 s21,s21,12288
v_exp_f32 v95,v95
v_mfma_f32_16x16x32_bf16 v[80:83],v[136:139],a[176:179],v[80:83]
s_add_u32 m0,s22,12288
v_cvt_pk_bf16_f32 v30,v92,v93
v_cvt_pk_bf16_f32 v31,v94,v95
v_mfma_f32_16x16x32_bf16 v[88:91],v[136:139],a[200:203],v[88:91]
v_fma_f32 v101,v101,s36,v16
v_fma_f32 v102,v102,s36,v16
v_mfma_f32_16x16x32_bf16 v[96:99],v[136:139],a[224:227],v[96:99]
v_fma_f32 v103,v103,s36,v16
v_mfma_f32_16x16x32_bf16 v[72:75],v[140:143],a[156:159],v[72:75]
v_exp_f32 v100,v100
v_mfma_f32_16x16x32_bf16 v[80:83],v[140:143],a[180:183],v[80:83]
v_exp_f32 v101,v101
v_mfma_f32_16x16x32_bf16 v[88:91],v[140:143],a[204:207],v[88:91]
v_exp_f32 v102,v102
v_mfma_f32_16x16x32_bf16 v[96:99],v[140:143],a[228:231],v[96:99]
v_exp_f32 v103,v103
v_mfma_f32_16x16x32_bf16 v[72:75],v[112:115],a[160:163],v[72:75]
buffer_load_dwordx4 v6,s[4:7],s20 offen offset:0 lds
v_mfma_f32_16x16x32_bf16 v[80:83],v[112:115],a[184:187],v[80:83]
v_cvt_pk_bf16_f32 v34,v100,v101
v_cvt_pk_bf16_f32 v35,v102,v103
v_mfma_f32_16x16x32_bf16 v[88:91],v[112:115],a[208:211],v[88:91]
ds_read_b128 v[132:135],v1 offset:30848
v_smfmac_f32_16x16x64_bf16 v[64:67],v[152:155],v[28:35],v18
ds_read_b128 v[136:139],v0 offset:30976
v_mfma_f32_16x16x32_bf16 v[96:99],v[112:115],a[232:235],v[96:99]
ds_read_b128 v[140:143],v1 offset:30976
v_mfma_f32_16x16x32_bf16 v[72:75],v[116:119],a[164:167],v[72:75]
v_mfma_f32_16x16x32_bf16 v[80:83],v[116:119],a[188:191],v[80:83]
v_mfma_f32_16x16x32_bf16 v[88:91],v[116:119],a[212:215],v[88:91]
v_mfma_f32_16x16x32_bf16 v[96:99],v[116:119],a[236:239],v[96:99]
s_waitcnt lgkmcnt(3)
v_mfma_f32_16x16x32_bf16 v[76:79],v[120:123],a[144:147],0
buffer_load_dwordx4 v7,s[4:7],s20 offen offset:1024 lds
v_mfma_f32_16x16x32_bf16 v[84:87],v[120:123],a[168:171],0
v_mfma_f32_16x16x32_bf16 v[92:95],v[120:123],a[192:195],0
v_mfma_f32_16x16x32_bf16 v[100:103],v[120:123],a[216:219],0
v_fma_f32 v72,v72,s36,v13
v_fma_f32 v73,v73,s36,v13
v_mfma_f32_16x16x32_bf16 v[76:79],v[124:127],a[148:151],v[76:79]
v_fma_f32 v74,v74,s36,v13
v_fma_f32 v75,v75,s36,v13
v_mfma_f32_16x16x32_bf16 v[84:87],v[124:127],a[172:175],v[84:87]
v_fma_f32 v80,v80,s36,v14
v_fma_f32 v81,v81,s36,v14
v_mfma_f32_16x16x32_bf16 v[92:95],v[124:127],a[196:199],v[92:95]
v_exp_f32 v72,v72
v_mfma_f32_16x16x32_bf16 v[100:103],v[124:127],a[220:223],v[100:103]
v_exp_f32 v73,v73
v_mfma_f32_16x16x32_bf16 v[76:79],v[128:131],a[152:155],v[76:79]
v_exp_f32 v74,v74
v_mfma_f32_16x16x32_bf16 v[84:87],v[128:131],a[176:179],v[84:87]
buffer_load_dwordx4 v8,s[4:7],s20 offen offset:2048 lds
v_mfma_f32_16x16x32_bf16 v[92:95],v[128:131],a[200:203],v[92:95]
s_add_u32 s20,s20,12288
ds_read_b64_tr_b16 v[112:113],v2 offset:12288
v_mfma_f32_16x16x32_bf16 v[100:103],v[128:131],a[224:227],v[100:103]
s_waitcnt lgkmcnt(1)
ds_read_b64_tr_b16 v[114:115],v2 offset:18432
v_cvt_pk_bf16_f32 v40,v72,v73
v_mfma_f32_16x16x32_bf16 v[76:79],v[132:135],a[156:159],v[76:79]
ds_read_b64_tr_b16 v[116:117],v3 offset:12288
v_mfma_f32_16x16x32_bf16 v[84:87],v[132:135],a[180:183],v[84:87]
ds_read_b64_tr_b16 v[118:119],v3 offset:18432
v_mfma_f32_16x16x32_bf16 v[92:95],v[132:135],a[204:207],v[92:95]
ds_read_b64_tr_b16 v[120:121],v4 offset:12288
v_mfma_f32_16x16x32_bf16 v[100:103],v[132:135],a[228:231],v[100:103]
ds_read_b64_tr_b16 v[122:123],v4 offset:18432
v_mfma_f32_16x16x32_bf16 v[76:79],v[136:139],a[160:163],v[76:79]
ds_read_b64_tr_b16 v[124:125],v5 offset:12288
v_mfma_f32_16x16x32_bf16 v[84:87],v[136:139],a[184:187],v[84:87]
ds_read_b64_tr_b16 v[126:127],v5 offset:18432
v_mfma_f32_16x16x32_bf16 v[92:95],v[136:139],a[208:211],v[92:95]
v_exp_f32 v75,v75
v_mfma_f32_16x16x32_bf16 v[100:103],v[136:139],a[232:235],v[100:103]
v_exp_f32 v80,v80
v_mfma_f32_16x16x32_bf16 v[76:79],v[140:143],a[164:167],v[76:79]
v_exp_f32 v81,v81
v_mfma_f32_16x16x32_bf16 v[84:87],v[140:143],a[188:191],v[84:87]
v_cvt_pk_bf16_f32 v41,v74,v75
v_cvt_pk_bf16_f32 v44,v80,v81
v_mfma_f32_16x16x32_bf16 v[92:95],v[140:143],a[212:215],v[92:95]
v_mfma_f32_16x16x32_bf16 v[100:103],v[140:143],a[236:239],v[100:103]
s_waitcnt lgkmcnt(3)
v_mfma_f32_16x16x32_bf16 v[160:163],v[112:115],v[20:23],v[160:163]
s_add_u32 m0,s23,12288
ds_read_b64_tr_b16 v[128:129],v2 offset:12416
ds_read_b64_tr_b16 v[130:131],v2 offset:18560
v_mfma_f32_16x16x32_bf16 v[208:211],v[112:115],v[24:27],v[208:211]
ds_read_b64_tr_b16 v[134:135],v3 offset:18560
ds_read_b64_tr_b16 v[132:133],v3 offset:12416
v_mfma_f32_16x16x32_bf16 a[0:3],v[112:115],v[28:31],a[0:3]
ds_read_b64_tr_b16 v[138:139],v4 offset:18560
ds_read_b64_tr_b16 v[136:137],v4 offset:12416
v_mfma_f32_16x16x32_bf16 a[48:51],v[112:115],v[32:35],a[48:51]
ds_read_b64_tr_b16 v[142:143],v5 offset:18560
ds_read_b64_tr_b16 v[140:141],v5 offset:12416
v_mfma_f32_16x16x32_bf16 v[164:167],v[116:119],v[20:23],v[164:167]
ds_read_b64_tr_b16 v[114:115],v2 offset:18688
ds_read_b64_tr_b16 v[112:113],v2 offset:12544
v_mfma_f32_16x16x32_bf16 v[212:215],v[116:119],v[24:27],v[212:215]
v_fma_f32 v83,v83,s36,v14
v_fma_f32 v90,v90,s36,v15
v_mfma_f32_16x16x32_bf16 a[4:7],v[116:119],v[28:31],a[4:7]
v_exp_f32 v83,v83
v_mfma_f32_16x16x32_bf16 a[52:55],v[116:119],v[32:35],a[52:55]
s_waitcnt lgkmcnt(10)
ds_read_b64_tr_b16 v[116:117],v3 offset:12544
ds_read_b64_tr_b16 v[118:119],v3 offset:18688
v_mfma_f32_16x16x32_bf16 v[168:171],v[120:123],v[20:23],v[168:171]
v_exp_f32 v90,v90
v_mfma_f32_16x16x32_bf16 v[216:219],v[120:123],v[24:27],v[216:219]
v_fma_f32 v82,v82,s36,v14
v_fma_f32 v88,v88,s36,v15
v_mfma_f32_16x16x32_bf16 a[8:11],v[120:123],v[28:31],a[8:11]
v_exp_f32 v82,v82
v_mfma_f32_16x16x32_bf16 a[56:59],v[120:123],v[32:35],a[56:59]
ds_read_b64_tr_b16 v[122:123],v4 offset:18688
ds_read_b64_tr_b16 v[120:121],v4 offset:12544
v_mfma_f32_16x16x32_bf16 v[172:175],v[124:127],v[20:23],v[172:175]
v_exp_f32 v88,v88
v_mfma_f32_16x16x32_bf16 v[220:223],v[124:127],v[24:27],v[220:223]
v_cvt_pk_bf16_f32 v45,v82,v83
v_fma_f32 v89,v89,s36,v15
v_mfma_f32_16x16x32_bf16 a[12:15],v[124:127],v[28:31],a[12:15]
v_exp_f32 v89,v89
v_mfma_f32_16x16x32_bf16 a[60:63],v[124:127],v[32:35],a[60:63]
s_waitcnt lgkmcnt(3)
ds_read_b64_tr_b16 v[124:125],v5 offset:12544
ds_read_b64_tr_b16 v[126:127],v5 offset:18688
v_mfma_f32_16x16x32_bf16 v[176:179],v[128:131],v[20:23],v[176:179]
v_fma_f32 v99,v99,s36,v16
v_fma_f32 v91,v91,s36,v15
v_mfma_f32_16x16x32_bf16 v[224:227],v[128:131],v[24:27],v[224:227]
v_exp_f32 v91,v91
v_mfma_f32_16x16x32_bf16 a[16:19],v[128:131],v[28:31],a[16:19]
v_exp_f32 v99,v99
v_mfma_f32_16x16x32_bf16 a[64:67],v[128:131],v[32:35],a[64:67]
v_cvt_pk_bf16_f32 v48,v88,v89
v_fma_f32 v96,v96,s36,v16
v_mfma_f32_16x16x32_bf16 v[180:183],v[132:135],v[20:23],v[180:183]
v_exp_f32 v96,v96
v_mfma_f32_16x16x32_bf16 v[228:231],v[132:135],v[24:27],v[228:231]
v_cvt_pk_bf16_f32 v49,v90,v91
v_fma_f32 v97,v97,s36,v16
v_mfma_f32_16x16x32_bf16 a[20:23],v[132:135],v[28:31],a[20:23]
v_exp_f32 v97,v97
v_mfma_f32_16x16x32_bf16 a[68:71],v[132:135],v[32:35],a[68:71]
v_fma_f32 v98,v98,s36,v16
v_cvt_pk_bf16_f32 v52,v96,v97
v_mfma_f32_16x16x32_bf16 v[184:187],v[136:139],v[20:23],v[184:187]
v_exp_f32 v98,v98
v_mfma_f32_16x16x32_bf16 v[232:235],v[136:139],v[24:27],v[232:235]
v_cvt_pk_bf16_f32 v53,v98,v99
v_fma_f32 v76,v76,s36,v13
v_mfma_f32_16x16x32_bf16 a[24:27],v[136:139],v[28:31],a[24:27]
v_exp_f32 v76,v76
v_mfma_f32_16x16x32_bf16 a[72:75],v[136:139],v[32:35],a[72:75]
v_fma_f32 v79,v79,s36,v13
v_fma_f32 v78,v78,s36,v13
v_mfma_f32_16x16x32_bf16 v[188:191],v[140:143],v[20:23],v[188:191]
v_exp_f32 v79,v79
v_mfma_f32_16x16x32_bf16 v[236:239],v[140:143],v[24:27],v[236:239]
v_exp_f32 v78,v78
v_mfma_f32_16x16x32_bf16 a[28:31],v[140:143],v[28:31],a[28:31]
v_cvt_pk_bf16_f32 v43,v78,v79
v_fma_f32 v77,v77,s36,v13
v_mfma_f32_16x16x32_bf16 a[76:79],v[140:143],v[32:35],a[76:79]
v_exp_f32 v77,v77
v_mfma_f32_16x16x32_bf16 v[192:195],v[112:115],v[20:23],v[192:195]
v_cvt_pk_bf16_f32 v42,v76,v77
v_fma_f32 v86,v86,s36,v14
s_waitcnt vmcnt(9) lgkmcnt(0)
v_mfma_f32_16x16x32_bf16 v[240:243],v[112:115],v[24:27],v[240:243]
s_barrier
v_mfma_f32_16x16x32_bf16 a[32:35],v[112:115],v[28:31],a[32:35]
ds_read_b128 v[128:131],v0 offset:0
v_fma_f32 v85,v85,s36,v14
v_mfma_f32_16x16x32_bf16 a[80:83],v[112:115],v[32:35],a[80:83]
ds_read_b128 v[132:135],v1 offset:0
v_fma_f32 v93,v93,s36,v15
v_mfma_f32_16x16x32_bf16 v[196:199],v[116:119],v[20:23],v[196:199]
ds_read_b128 v[136:139],v0 offset:128
v_fma_f32 v94,v94,s36,v15
v_mfma_f32_16x16x32_bf16 v[244:247],v[116:119],v[24:27],v[244:247]
ds_read_b128 v[140:143],v1 offset:128
v_fma_f32 v84,v84,s36,v14
v_mfma_f32_16x16x32_bf16 a[36:39],v[116:119],v[28:31],a[36:39]
ds_read_b128 v[156:159],v10 offset:3072
v_fma_f32 v92,v92,s36,v15
v_mfma_f32_16x16x32_bf16 a[84:87],v[116:119],v[32:35],a[84:87]
buffer_load_dwordx4 v6,s[8:11],s21 offen offset:0 lds
v_mfma_f32_16x16x32_bf16 v[200:203],v[120:123],v[20:23],v[200:203]
ds_read_b128 v[112:115],v0 offset:256
v_fma_f32 v87,v87,s36,v14
v_mfma_f32_16x16x32_bf16 v[248:251],v[120:123],v[24:27],v[248:251]
ds_read_b128 v[116:119],v1 offset:256
v_fma_f32 v95,v95,s36,v15
v_mfma_f32_16x16x32_bf16 a[40:43],v[120:123],v[28:31],a[40:43]
v_exp_f32 v84,v84
v_mfma_f32_16x16x32_bf16 a[88:91],v[120:123],v[32:35],a[88:91]
ds_read_b128 v[120:123],v0 offset:6144
v_fma_f32 v102,v102,s36,v16
v_mfma_f32_16x16x32_bf16 v[204:207],v[124:127],v[20:23],v[204:207]
v_exp_f32 v87,v87
v_mfma_f32_16x16x32_bf16 v[252:255],v[124:127],v[24:27],v[252:255]
v_exp_f32 v85,v85
v_mfma_f32_16x16x32_bf16 a[44:47],v[124:127],v[28:31],a[44:47]
v_exp_f32 v95,v95
v_mfma_f32_16x16x32_bf16 a[92:95],v[124:127],v[32:35],a[92:95]
s_waitcnt lgkmcnt(3)
ds_read_b128 v[124:127],v1 offset:6144
v_cvt_pk_bf16_f32 v46,v84,v85
v_mfma_f32_16x16x32_bf16 v[72:75],v[128:131],a[144:147],0
buffer_store_dwordx4 v[156:159],v9,s[16:19],s27 offen offset:0 nt
buffer_load_dwordx4 v7,s[8:11],s21 offen offset:1024 lds
v_mfma_f32_16x16x32_bf16 v[80:83],v[128:131],a[168:171],0
ds_read_b128 v[156:159],v10 offset:4096
v_mfma_f32_16x16x32_bf16 v[88:91],v[128:131],a[192:195],0
v_exp_f32 v86,v86
v_mfma_f32_16x16x32_bf16 v[96:99],v[128:131],a[216:219],0
v_exp_f32 v93,v93
v_mfma_f32_16x16x32_bf16 v[72:75],v[132:135],a[148:151],v[72:75]
v_exp_f32 v92,v92
v_mfma_f32_16x16x32_bf16 v[80:83],v[132:135],a[172:175],v[80:83]
ds_read_b128 v[128:131],v0 offset:6272
v_fma_f32 v103,v103,s36,v16
v_mfma_f32_16x16x32_bf16 v[88:91],v[132:135],a[196:199],v[88:91]
v_exp_f32 v102,v102
v_mfma_f32_16x16x32_bf16 v[96:99],v[132:135],a[220:223],v[96:99]
v_exp_f32 v94,v94
v_mfma_f32_16x16x32_bf16 v[72:75],v[136:139],a[152:155],v[72:75]
buffer_load_dwordx4 v8,s[8:11],s21 offen offset:2048 lds
v_mfma_f32_16x16x32_bf16 v[80:83],v[136:139],a[176:179],v[80:83]
s_add_u32 s21,s21,12288
v_exp_f32 v103,v103
v_mfma_f32_16x16x32_bf16 v[88:91],v[136:139],a[200:203],v[88:91]
s_add_u32 m0,s22,24576
v_cvt_pk_bf16_f32 v51,v94,v95
v_cvt_pk_bf16_f32 v47,v86,v87
v_mfma_f32_16x16x32_bf16 v[96:99],v[136:139],a[224:227],v[96:99]
v_fma_f32 v101,v101,s36,v16
v_fma_f32 v100,v100,s36,v16
v_smfmac_f32_16x16x64_bf16 v[60:63],v[152:155],v[40:47],v18
v_cvt_pk_bf16_f32 v50,v92,v93
v_mfma_f32_16x16x32_bf16 v[72:75],v[140:143],a[156:159],v[72:75]
v_exp_f32 v100,v100
v_mfma_f32_16x16x32_bf16 v[80:83],v[140:143],a[180:183],v[80:83]
v_exp_f32 v101,v101
v_mfma_f32_16x16x32_bf16 v[88:91],v[140:143],a[204:207],v[88:91]
ds_read_b128 v[132:135],v1 offset:6272
v_cvt_pk_bf16_f32 v55,v102,v103
v_mfma_f32_16x16x32_bf16 v[96:99],v[140:143],a[228:231],v[96:99]
s_waitcnt lgkmcnt(1)
v_cvt_pk_bf16_f32 v54,v100,v101
v_mfma_f32_16x16x32_bf16 v[72:75],v[112:115],a[160:163],v[72:75]
buffer_store_dwordx4 v[156:159],v9,s[16:19],s27 offen offset:128 nt
buffer_load_dwordx4 v6,s[4:7],s20 offen offset:0 lds
v_smfmac_f32_16x16x64_bf16 v[64:67],v[152:155],v[48:55],v18
ds_read_b128 v[156:159],v10 offset:5120
v_mfma_f32_16x16x32_bf16 v[80:83],v[112:115],a[184:187],v[80:83]
ds_read_b128 v[136:139],v0 offset:6400
v_mfma_f32_16x16x32_bf16 v[88:91],v[112:115],a[208:211],v[88:91]
ds_read_b128 v[140:143],v1 offset:6400
v_mfma_f32_16x16x32_bf16 v[96:99],v[112:115],a[232:235],v[96:99]
v_mfma_f32_16x16x32_bf16 v[72:75],v[116:119],a[164:167],v[72:75]
v_mfma_f32_16x16x32_bf16 v[80:83],v[116:119],a[188:191],v[80:83]
v_mfma_f32_16x16x32_bf16 v[88:91],v[116:119],a[212:215],v[88:91]
v_mfma_f32_16x16x32_bf16 v[96:99],v[116:119],a[236:239],v[96:99]
buffer_load_dwordx4 v7,s[4:7],s20 offen offset:1024 lds
v_mfma_f32_16x16x32_bf16 v[76:79],v[120:123],a[144:147],0
v_mfma_f32_16x16x32_bf16 v[84:87],v[120:123],a[168:171],0
v_mfma_f32_16x16x32_bf16 v[92:95],v[120:123],a[192:195],0
v_mfma_f32_16x16x32_bf16 v[100:103],v[120:123],a[216:219],0
v_fma_f32 v74,v74,s36,v13
v_fma_f32 v72,v72,s36,v13
v_mfma_f32_16x16x32_bf16 v[76:79],v[124:127],a[148:151],v[76:79]
v_exp_f32 v72,v72
v_mfma_f32_16x16x32_bf16 v[84:87],v[124:127],a[172:175],v[84:87]
v_exp_f32 v74,v74
v_mfma_f32_16x16x32_bf16 v[92:95],v[124:127],a[196:199],v[92:95]
v_fma_f32 v75,v75,s36,v13
v_fma_f32 v73,v73,s36,v13
v_mfma_f32_16x16x32_bf16 v[100:103],v[124:127],a[220:223],v[100:103]
v_exp_f32 v75,v75
v_mfma_f32_16x16x32_bf16 v[76:79],v[128:131],a[152:155],v[76:79]
s_waitcnt lgkmcnt(0)
buffer_store_dwordx4 v[156:159],v9,s[16:19],s27 offen offset:256 nt
buffer_load_dwordx4 v8,s[4:7],s20 offen offset:2048 lds
v_mfma_f32_16x16x32_bf16 v[84:87],v[128:131],a[176:179],v[84:87]
s_add_u32 s20,s20,12288
ds_read_b64_tr_b16 v[114:115],v2 offset:30720
v_mfma_f32_16x16x32_bf16 v[92:95],v[128:131],a[200:203],v[92:95]
s_add_u32 s27,s27,3072
ds_read_b64_tr_b16 v[112:113],v2 offset:24576
v_fma_f32 v81,v81,s36,v14
v_mfma_f32_16x16x32_bf16 v[100:103],v[128:131],a[224:227],v[100:103]
ds_read_b64_tr_b16 v[116:117],v3 offset:24576
v_mfma_f32_16x16x32_bf16 v[76:79],v[132:135],a[156:159],v[76:79]
ds_read_b64_tr_b16 v[118:119],v3 offset:30720
v_fma_f32 v80,v80,s36,v14
v_mfma_f32_16x16x32_bf16 v[84:87],v[132:135],a[180:183],v[84:87]
ds_read_b64_tr_b16 v[120:121],v4 offset:24576
v_mfma_f32_16x16x32_bf16 v[92:95],v[132:135],a[204:207],v[92:95]
ds_read_b64_tr_b16 v[122:123],v4 offset:30720
v_cvt_pk_bf16_f32 v21,v74,v75
v_mfma_f32_16x16x32_bf16 v[100:103],v[132:135],a[228:231],v[100:103]
ds_read_b64_tr_b16 v[124:125],v5 offset:24576
v_mfma_f32_16x16x32_bf16 v[76:79],v[136:139],a[160:163],v[76:79]
ds_read_b64_tr_b16 v[126:127],v5 offset:30720
v_mfma_f32_16x16x32_bf16 v[84:87],v[136:139],a[184:187],v[84:87]
v_exp_f32 v73,v73
v_mfma_f32_16x16x32_bf16 v[92:95],v[136:139],a[208:211],v[92:95]
v_exp_f32 v80,v80
v_mfma_f32_16x16x32_bf16 v[100:103],v[136:139],a[232:235],v[100:103]
v_exp_f32 v81,v81
v_mfma_f32_16x16x32_bf16 v[76:79],v[140:143],a[164:167],v[76:79]
v_cvt_pk_bf16_f32 v20,v72,v73
v_cvt_pk_bf16_f32 v24,v80,v81
v_mfma_f32_16x16x32_bf16 v[84:87],v[140:143],a[188:191],v[84:87]
v_mfma_f32_16x16x32_bf16 v[92:95],v[140:143],a[212:215],v[92:95]
v_mfma_f32_16x16x32_bf16 v[100:103],v[140:143],a[236:239],v[100:103]
s_waitcnt lgkmcnt(2)
v_mfma_f32_16x16x32_bf16 v[160:163],v[112:115],v[40:43],v[160:163]
s_add_u32 m0,s29,0
ds_read_b64_tr_b16 v[128:129],v2 offset:24704
ds_read_b64_tr_b16 v[130:131],v2 offset:30848
v_mfma_f32_16x16x32_bf16 v[208:211],v[112:115],v[44:47],v[208:211]
ds_read_b64_tr_b16 v[132:133],v3 offset:24704
ds_read_b64_tr_b16 v[134:135],v3 offset:30848
v_mfma_f32_16x16x32_bf16 a[0:3],v[112:115],v[48:51],a[0:3]
ds_read_b64_tr_b16 v[136:137],v4 offset:24704
ds_read_b64_tr_b16 v[138:139],v4 offset:30848
v_mfma_f32_16x16x32_bf16 a[48:51],v[112:115],v[52:55],a[48:51]
ds_read_b64_tr_b16 v[140:141],v5 offset:24704
ds_read_b64_tr_b16 v[142:143],v5 offset:30848
v_mfma_f32_16x16x32_bf16 v[164:167],v[116:119],v[40:43],v[164:167]
ds_read_b64_tr_b16 v[112:113],v2 offset:24832
ds_read_b64_tr_b16 v[114:115],v2 offset:30976
v_mfma_f32_16x16x32_bf16 v[212:215],v[116:119],v[44:47],v[212:215]
v_fma_f32 v82,v82,s36,v14
v_fma_f32 v83,v83,s36,v14
v_mfma_f32_16x16x32_bf16 a[4:7],v[116:119],v[48:51],a[4:7]
buffer_load_dwordx4 v6,s[12:15],s28 offen offset:0 nt lds
v_mfma_f32_16x16x32_bf16 a[52:55],v[116:119],v[52:55],a[52:55]
ds_read_b64_tr_b16 v[116:117],v3 offset:24832
ds_read_b64_tr_b16 v[118:119],v3 offset:30976
v_mfma_f32_16x16x32_bf16 v[168:171],v[120:123],v[40:43],v[168:171]
v_exp_f32 v82,v82
v_mfma_f32_16x16x32_bf16 v[216:219],v[120:123],v[44:47],v[216:219]
v_exp_f32 v83,v83
v_mfma_f32_16x16x32_bf16 a[8:11],v[120:123],v[48:51],a[8:11]
v_cvt_pk_bf16_f32 v25,v82,v83
v_fma_f32 v88,v88,s36,v15
v_mfma_f32_16x16x32_bf16 a[56:59],v[120:123],v[52:55],a[56:59]
s_waitcnt lgkmcnt(5)
ds_read_b64_tr_b16 v[120:121],v4 offset:24832
ds_read_b64_tr_b16 v[122:123],v4 offset:30976
v_mfma_f32_16x16x32_bf16 v[172:175],v[124:127],v[40:43],v[172:175]
v_fma_f32 v89,v89,s36,v15
v_fma_f32 v90,v90,s36,v15
v_mfma_f32_16x16x32_bf16 v[220:223],v[124:127],v[44:47],v[220:223]
buffer_load_dwordx4 v7,s[12:15],s28 offen offset:1024 nt lds
v_mfma_f32_16x16x32_bf16 a[12:15],v[124:127],v[48:51],a[12:15]
v_fma_f32 v91,v91,s36,v15
v_fma_f32 v96,v96,s36,v16
v_mfma_f32_16x16x32_bf16 a[60:63],v[124:127],v[52:55],a[60:63]
ds_read_b64_tr_b16 v[124:125],v5 offset:24832
ds_read_b64_tr_b16 v[126:127],v5 offset:30976
v_mfma_f32_16x16x32_bf16 v[176:179],v[128:131],v[40:43],v[176:179]
v_exp_f32 v88,v88
v_mfma_f32_16x16x32_bf16 v[224:227],v[128:131],v[44:47],v[224:227]
v_exp_f32 v89,v89
v_mfma_f32_16x16x32_bf16 a[16:19],v[128:131],v[48:51],a[16:19]
v_exp_f32 v90,v90
v_mfma_f32_16x16x32_bf16 a[64:67],v[128:131],v[52:55],a[64:67]
v_exp_f32 v91,v91
v_mfma_f32_16x16x32_bf16 v[180:183],v[132:135],v[40:43],v[180:183]
v_cvt_pk_bf16_f32 v28,v88,v89
v_cvt_pk_bf16_f32 v29,v90,v91
v_mfma_f32_16x16x32_bf16 v[228:231],v[132:135],v[44:47],v[228:231]
buffer_load_dwordx4 v8,s[12:15],s28 offen offset:2048 nt lds
v_mfma_f32_16x16x32_bf16 a[20:23],v[132:135],v[48:51],a[20:23]
s_add_u32 s28,s28,3072
v_fma_f32 v97,v97,s36,v16
v_fma_f32 v98,v98,s36,v16
v_mfma_f32_16x16x32_bf16 a[68:71],v[132:135],v[52:55],a[68:71]
s_add_u32 s29,s29,3072
v_fma_f32 v99,v99,s36,v16
v_fma_f32 v76,v76,s36,v13
v_mfma_f32_16x16x32_bf16 v[184:187],v[136:139],v[40:43],v[184:187]
s_add_u32 m0,s23,24576
v_exp_f32 v96,v96
v_mfma_f32_16x16x32_bf16 v[232:235],v[136:139],v[44:47],v[232:235]
v_exp_f32 v97,v97
v_mfma_f32_16x16x32_bf16 a[24:27],v[136:139],v[48:51],a[24:27]
v_exp_f32 v98,v98
v_mfma_f32_16x16x32_bf16 a[72:75],v[136:139],v[52:55],a[72:75]
s_waitcnt lgkmcnt(0)
v_exp_f32 v99,v99
v_mfma_f32_16x16x32_bf16 v[188:191],v[140:143],v[40:43],v[188:191]
v_cvt_pk_bf16_f32 v32,v96,v97
v_cvt_pk_bf16_f32 v33,v98,v99
v_mfma_f32_16x16x32_bf16 v[236:239],v[140:143],v[44:47],v[236:239]
v_fma_f32 v77,v77,s36,v13
v_fma_f32 v78,v78,s36,v13
v_mfma_f32_16x16x32_bf16 a[28:31],v[140:143],v[48:51],a[28:31]
v_fma_f32 v79,v79,s36,v13
v_fma_f32 v84,v84,s36,v14
v_mfma_f32_16x16x32_bf16 a[76:79],v[140:143],v[52:55],a[76:79]
v_exp_f32 v76,v76
s_waitcnt vmcnt(12)
v_mfma_f32_16x16x32_bf16 v[192:195],v[112:115],v[40:43],v[192:195]
s_barrier
v_mfma_f32_16x16x32_bf16 v[240:243],v[112:115],v[44:47],v[240:243]
ds_read_b128 v[128:131],v0 offset:12288
v_fma_f32 v85,v85,s36,v14
v_mfma_f32_16x16x32_bf16 a[32:35],v[112:115],v[48:51],a[32:35]
ds_read_b128 v[132:135],v1 offset:12288
v_fma_f32 v86,v86,s36,v14
v_mfma_f32_16x16x32_bf16 a[80:83],v[112:115],v[52:55],a[80:83]
ds_read_b128 v[136:139],v0 offset:12416
v_fma_f32 v87,v87,s36,v14
v_mfma_f32_16x16x32_bf16 v[196:199],v[116:119],v[40:43],v[196:199]
ds_read_b128 v[140:143],v1 offset:12416
v_fma_f32 v92,v92,s36,v15
v_mfma_f32_16x16x32_bf16 v[244:247],v[116:119],v[44:47],v[244:247]
ds_read_b128 v[112:115],v0 offset:12544
v_fma_f32 v93,v93,s36,v15
v_mfma_f32_16x16x32_bf16 a[36:39],v[116:119],v[48:51],a[36:39]
buffer_load_dwordx4 v6,s[8:11],s21 offen offset:0 lds
v_mfma_f32_16x16x32_bf16 a[84:87],v[116:119],v[52:55],a[84:87]
ds_read_b128 v[116:119],v1 offset:12544
v_fma_f32 v94,v94,s36,v15
v_mfma_f32_16x16x32_bf16 v[200:203],v[120:123],v[40:43],v[200:203]
v_exp_f32 v77,v77
v_mfma_f32_16x16x32_bf16 v[248:251],v[120:123],v[44:47],v[248:251]
v_exp_f32 v78,v78
v_mfma_f32_16x16x32_bf16 a[40:43],v[120:123],v[48:51],a[40:43]
v_exp_f32 v79,v79
v_mfma_f32_16x16x32_bf16 a[88:91],v[120:123],v[52:55],a[88:91]
ds_read_b128 v[120:123],v0 offset:18432
v_cvt_pk_bf16_f32 v22,v76,v77
v_mfma_f32_16x16x32_bf16 v[204:207],v[124:127],v[40:43],v[204:207]
v_cvt_pk_bf16_f32 v23,v78,v79
v_fma_f32 v95,v95,s36,v15
v_mfma_f32_16x16x32_bf16 v[252:255],v[124:127],v[44:47],v[252:255]
v_exp_f32 v84,v84
v_mfma_f32_16x16x32_bf16 a[44:47],v[124:127],v[48:51],a[44:47]
v_exp_f32 v85,v85
v_mfma_f32_16x16x32_bf16 a[92:95],v[124:127],v[52:55],a[92:95]
buffer_load_dwordx4 v7,s[8:11],s21 offen offset:1024 lds
s_waitcnt lgkmcnt(1)
v_mfma_f32_16x16x32_bf16 v[72:75],v[128:131],a[144:147],0
ds_read_b128 v[124:127],v1 offset:18432
v_cvt_pk_bf16_f32 v26,v84,v85
v_mfma_f32_16x16x32_bf16 v[80:83],v[128:131],a[168:171],0
v_exp_f32 v86,v86
v_mfma_f32_16x16x32_bf16 v[88:91],v[128:131],a[192:195],0
v_exp_f32 v87,v87
v_mfma_f32_16x16x32_bf16 v[96:99],v[128:131],a[216:219],0
ds_read_b128 v[128:131],v0 offset:18560
v_cvt_pk_bf16_f32 v27,v86,v87
v_mfma_f32_16x16x32_bf16 v[72:75],v[132:135],a[148:151],v[72:75]
v_exp_f32 v92,v92
v_smfmac_f32_16x16x64_bf16 v[60:63],v[152:155],v[20:27],v18
v_fma_f32 v100,v100,s36,v16
v_mfma_f32_16x16x32_bf16 v[80:83],v[132:135],a[172:175],v[80:83]
v_exp_f32 v93,v93
v_mfma_f32_16x16x32_bf16 v[88:91],v[132:135],a[196:199],v[88:91]
v_exp_f32 v94,v94
v_mfma_f32_16x16x32_bf16 v[96:99],v[132:135],a[220:223],v[96:99]
buffer_load_dwordx4 v8,s[8:11],s21 offen offset:2048 lds
v_mfma_f32_16x16x32_bf16 v[72:75],v[136:139],a[152:155],v[72:75]
s_add_u32 s21,s21,12288
v_exp_f32 v95,v95
v_mfma_f32_16x16x32_bf16 v[80:83],v[136:139],a[176:179],v[80:83]
s_add_u32 m0,s22,0
v_cvt_pk_bf16_f32 v30,v92,v93
v_cvt_pk_bf16_f32 v31,v94,v95
v_mfma_f32_16x16x32_bf16 v[88:91],v[136:139],a[200:203],v[88:91]
v_fma_f32 v101,v101,s36,v16
v_fma_f32 v102,v102,s36,v16
v_mfma_f32_16x16x32_bf16 v[96:99],v[136:139],a[224:227],v[96:99]
v_fma_f32 v103,v103,s36,v16
v_mfma_f32_16x16x32_bf16 v[72:75],v[140:143],a[156:159],v[72:75]
v_exp_f32 v100,v100
v_mfma_f32_16x16x32_bf16 v[80:83],v[140:143],a[180:183],v[80:83]
v_exp_f32 v101,v101
v_mfma_f32_16x16x32_bf16 v[88:91],v[140:143],a[204:207],v[88:91]
v_exp_f32 v102,v102
v_mfma_f32_16x16x32_bf16 v[96:99],v[140:143],a[228:231],v[96:99]
v_exp_f32 v103,v103
v_mfma_f32_16x16x32_bf16 v[72:75],v[112:115],a[160:163],v[72:75]
buffer_load_dwordx4 v6,s[4:7],s20 offen offset:0 lds
v_mfma_f32_16x16x32_bf16 v[80:83],v[112:115],a[184:187],v[80:83]
v_cvt_pk_bf16_f32 v34,v100,v101
v_cvt_pk_bf16_f32 v35,v102,v103
v_mfma_f32_16x16x32_bf16 v[88:91],v[112:115],a[208:211],v[88:91]
ds_read_b128 v[132:135],v1 offset:18560
v_smfmac_f32_16x16x64_bf16 v[64:67],v[152:155],v[28:35],v18
ds_read_b128 v[136:139],v0 offset:18688
v_mfma_f32_16x16x32_bf16 v[96:99],v[112:115],a[232:235],v[96:99]
ds_read_b128 v[140:143],v1 offset:18688
v_mfma_f32_16x16x32_bf16 v[72:75],v[116:119],a[164:167],v[72:75]
v_mfma_f32_16x16x32_bf16 v[80:83],v[116:119],a[188:191],v[80:83]
v_mfma_f32_16x16x32_bf16 v[88:91],v[116:119],a[212:215],v[88:91]
v_mfma_f32_16x16x32_bf16 v[96:99],v[116:119],a[236:239],v[96:99]
s_waitcnt lgkmcnt(3)
v_mfma_f32_16x16x32_bf16 v[76:79],v[120:123],a[144:147],0
buffer_load_dwordx4 v7,s[4:7],s20 offen offset:1024 lds
v_mfma_f32_16x16x32_bf16 v[84:87],v[120:123],a[168:171],0
v_mfma_f32_16x16x32_bf16 v[92:95],v[120:123],a[192:195],0
v_mfma_f32_16x16x32_bf16 v[100:103],v[120:123],a[216:219],0
v_fma_f32 v72,v72,s36,v13
v_fma_f32 v73,v73,s36,v13
v_mfma_f32_16x16x32_bf16 v[76:79],v[124:127],a[148:151],v[76:79]
v_fma_f32 v74,v74,s36,v13
v_fma_f32 v75,v75,s36,v13
v_mfma_f32_16x16x32_bf16 v[84:87],v[124:127],a[172:175],v[84:87]
v_fma_f32 v80,v80,s36,v14
v_fma_f32 v81,v81,s36,v14
v_mfma_f32_16x16x32_bf16 v[92:95],v[124:127],a[196:199],v[92:95]
v_exp_f32 v72,v72
v_mfma_f32_16x16x32_bf16 v[100:103],v[124:127],a[220:223],v[100:103]
v_exp_f32 v73,v73
v_mfma_f32_16x16x32_bf16 v[76:79],v[128:131],a[152:155],v[76:79]
v_exp_f32 v74,v74
v_mfma_f32_16x16x32_bf16 v[84:87],v[128:131],a[176:179],v[84:87]
buffer_load_dwordx4 v8,s[4:7],s20 offen offset:2048 lds
v_mfma_f32_16x16x32_bf16 v[92:95],v[128:131],a[200:203],v[92:95]
s_add_u32 s20,s20,12288
ds_read_b64_tr_b16 v[112:113],v2 offset:0
v_mfma_f32_16x16x32_bf16 v[100:103],v[128:131],a[224:227],v[100:103]
s_waitcnt lgkmcnt(1)
ds_read_b64_tr_b16 v[114:115],v2 offset:6144
v_cvt_pk_bf16_f32 v40,v72,v73
v_mfma_f32_16x16x32_bf16 v[76:79],v[132:135],a[156:159],v[76:79]
ds_read_b64_tr_b16 v[116:117],v3 offset:0
v_mfma_f32_16x16x32_bf16 v[84:87],v[132:135],a[180:183],v[84:87]
ds_read_b64_tr_b16 v[118:119],v3 offset:6144
v_mfma_f32_16x16x32_bf16 v[92:95],v[132:135],a[204:207],v[92:95]
ds_read_b64_tr_b16 v[120:121],v4 offset:0
v_mfma_f32_16x16x32_bf16 v[100:103],v[132:135],a[228:231],v[100:103]
ds_read_b64_tr_b16 v[122:123],v4 offset:6144
v_mfma_f32_16x16x32_bf16 v[76:79],v[136:139],a[160:163],v[76:79]
ds_read_b64_tr_b16 v[124:125],v5 offset:0
v_mfma_f32_16x16x32_bf16 v[84:87],v[136:139],a[184:187],v[84:87]
ds_read_b64_tr_b16 v[126:127],v5 offset:6144
v_mfma_f32_16x16x32_bf16 v[92:95],v[136:139],a[208:211],v[92:95]
v_exp_f32 v75,v75
v_mfma_f32_16x16x32_bf16 v[100:103],v[136:139],a[232:235],v[100:103]
v_exp_f32 v80,v80
v_mfma_f32_16x16x32_bf16 v[76:79],v[140:143],a[164:167],v[76:79]
v_exp_f32 v81,v81
v_mfma_f32_16x16x32_bf16 v[84:87],v[140:143],a[188:191],v[84:87]
v_cvt_pk_bf16_f32 v41,v74,v75
v_cvt_pk_bf16_f32 v44,v80,v81
v_mfma_f32_16x16x32_bf16 v[92:95],v[140:143],a[212:215],v[92:95]
v_mfma_f32_16x16x32_bf16 v[100:103],v[140:143],a[236:239],v[100:103]
s_waitcnt lgkmcnt(3)
v_mfma_f32_16x16x32_bf16 v[160:163],v[112:115],v[20:23],v[160:163]
s_add_u32 m0,s23,0
ds_read_b64_tr_b16 v[128:129],v2 offset:128
ds_read_b64_tr_b16 v[130:131],v2 offset:6272
v_mfma_f32_16x16x32_bf16 v[208:211],v[112:115],v[24:27],v[208:211]
ds_read_b64_tr_b16 v[134:135],v3 offset:6272
ds_read_b64_tr_b16 v[132:133],v3 offset:128
v_mfma_f32_16x16x32_bf16 a[0:3],v[112:115],v[28:31],a[0:3]
ds_read_b64_tr_b16 v[138:139],v4 offset:6272
ds_read_b64_tr_b16 v[136:137],v4 offset:128
v_mfma_f32_16x16x32_bf16 a[48:51],v[112:115],v[32:35],a[48:51]
ds_read_b64_tr_b16 v[142:143],v5 offset:6272
ds_read_b64_tr_b16 v[140:141],v5 offset:128
v_mfma_f32_16x16x32_bf16 v[164:167],v[116:119],v[20:23],v[164:167]
ds_read_b64_tr_b16 v[114:115],v2 offset:6400
ds_read_b64_tr_b16 v[112:113],v2 offset:256
v_mfma_f32_16x16x32_bf16 v[212:215],v[116:119],v[24:27],v[212:215]
v_fma_f32 v83,v83,s36,v14
v_fma_f32 v90,v90,s36,v15
v_mfma_f32_16x16x32_bf16 a[4:7],v[116:119],v[28:31],a[4:7]
v_exp_f32 v83,v83
v_mfma_f32_16x16x32_bf16 a[52:55],v[116:119],v[32:35],a[52:55]
s_waitcnt lgkmcnt(10)
ds_read_b64_tr_b16 v[116:117],v3 offset:256
ds_read_b64_tr_b16 v[118:119],v3 offset:6400
v_mfma_f32_16x16x32_bf16 v[168:171],v[120:123],v[20:23],v[168:171]
v_exp_f32 v90,v90
v_mfma_f32_16x16x32_bf16 v[216:219],v[120:123],v[24:27],v[216:219]
v_fma_f32 v82,v82,s36,v14
v_fma_f32 v88,v88,s36,v15
v_mfma_f32_16x16x32_bf16 a[8:11],v[120:123],v[28:31],a[8:11]
v_exp_f32 v82,v82
v_mfma_f32_16x16x32_bf16 a[56:59],v[120:123],v[32:35],a[56:59]
ds_read_b64_tr_b16 v[122:123],v4 offset:6400
ds_read_b64_tr_b16 v[120:121],v4 offset:256
v_mfma_f32_16x16x32_bf16 v[172:175],v[124:127],v[20:23],v[172:175]
v_exp_f32 v88,v88
v_mfma_f32_16x16x32_bf16 v[220:223],v[124:127],v[24:27],v[220:223]
v_cvt_pk_bf16_f32 v45,v82,v83
v_fma_f32 v89,v89,s36,v15
v_mfma_f32_16x16x32_bf16 a[12:15],v[124:127],v[28:31],a[12:15]
v_exp_f32 v89,v89
v_mfma_f32_16x16x32_bf16 a[60:63],v[124:127],v[32:35],a[60:63]
s_waitcnt lgkmcnt(3)
ds_read_b64_tr_b16 v[124:125],v5 offset:256
ds_read_b64_tr_b16 v[126:127],v5 offset:6400
v_mfma_f32_16x16x32_bf16 v[176:179],v[128:131],v[20:23],v[176:179]
v_fma_f32 v99,v99,s36,v16
v_fma_f32 v91,v91,s36,v15
v_mfma_f32_16x16x32_bf16 v[224:227],v[128:131],v[24:27],v[224:227]
v_exp_f32 v91,v91
v_mfma_f32_16x16x32_bf16 a[16:19],v[128:131],v[28:31],a[16:19]
v_exp_f32 v99,v99
v_mfma_f32_16x16x32_bf16 a[64:67],v[128:131],v[32:35],a[64:67]
v_cvt_pk_bf16_f32 v48,v88,v89
v_fma_f32 v96,v96,s36,v16
v_mfma_f32_16x16x32_bf16 v[180:183],v[132:135],v[20:23],v[180:183]
v_exp_f32 v96,v96
v_mfma_f32_16x16x32_bf16 v[228:231],v[132:135],v[24:27],v[228:231]
v_cvt_pk_bf16_f32 v49,v90,v91
v_fma_f32 v97,v97,s36,v16
v_mfma_f32_16x16x32_bf16 a[20:23],v[132:135],v[28:31],a[20:23]
v_exp_f32 v97,v97
v_mfma_f32_16x16x32_bf16 a[68:71],v[132:135],v[32:35],a[68:71]
v_fma_f32 v98,v98,s36,v16
v_cvt_pk_bf16_f32 v52,v96,v97
v_mfma_f32_16x16x32_bf16 v[184:187],v[136:139],v[20:23],v[184:187]
v_exp_f32 v98,v98
v_mfma_f32_16x16x32_bf16 v[232:235],v[136:139],v[24:27],v[232:235]
v_cvt_pk_bf16_f32 v53,v98,v99
v_fma_f32 v76,v76,s36,v13
v_mfma_f32_16x16x32_bf16 a[24:27],v[136:139],v[28:31],a[24:27]
v_exp_f32 v76,v76
v_mfma_f32_16x16x32_bf16 a[72:75],v[136:139],v[32:35],a[72:75]
v_fma_f32 v79,v79,s36,v13
v_fma_f32 v78,v78,s36,v13
v_mfma_f32_16x16x32_bf16 v[188:191],v[140:143],v[20:23],v[188:191]
v_exp_f32 v79,v79
v_mfma_f32_16x16x32_bf16 v[236:239],v[140:143],v[24:27],v[236:239]
v_exp_f32 v78,v78
v_mfma_f32_16x16x32_bf16 a[28:31],v[140:143],v[28:31],a[28:31]
v_cvt_pk_bf16_f32 v43,v78,v79
v_fma_f32 v77,v77,s36,v13
v_mfma_f32_16x16x32_bf16 a[76:79],v[140:143],v[32:35],a[76:79]
v_exp_f32 v77,v77
v_mfma_f32_16x16x32_bf16 v[192:195],v[112:115],v[20:23],v[192:195]
v_cvt_pk_bf16_f32 v42,v76,v77
v_fma_f32 v86,v86,s36,v14
s_waitcnt vmcnt(9) lgkmcnt(0)
v_mfma_f32_16x16x32_bf16 v[240:243],v[112:115],v[24:27],v[240:243]
s_barrier
v_mfma_f32_16x16x32_bf16 a[32:35],v[112:115],v[28:31],a[32:35]
ds_read_b128 v[128:131],v0 offset:24576
v_fma_f32 v85,v85,s36,v14
v_mfma_f32_16x16x32_bf16 a[80:83],v[112:115],v[32:35],a[80:83]
ds_read_b128 v[132:135],v1 offset:24576
v_fma_f32 v93,v93,s36,v15
v_mfma_f32_16x16x32_bf16 v[196:199],v[116:119],v[20:23],v[196:199]
ds_read_b128 v[136:139],v0 offset:24704
v_fma_f32 v94,v94,s36,v15
v_mfma_f32_16x16x32_bf16 v[244:247],v[116:119],v[24:27],v[244:247]
ds_read_b128 v[140:143],v1 offset:24704
v_fma_f32 v84,v84,s36,v14
v_mfma_f32_16x16x32_bf16 a[36:39],v[116:119],v[28:31],a[36:39]
ds_read_b128 v[156:159],v10 offset:6144
v_fma_f32 v92,v92,s36,v15
v_mfma_f32_16x16x32_bf16 a[84:87],v[116:119],v[32:35],a[84:87]
buffer_load_dwordx4 v6,s[8:11],s21 offen offset:0 lds
v_mfma_f32_16x16x32_bf16 v[200:203],v[120:123],v[20:23],v[200:203]
ds_read_b128 v[112:115],v0 offset:24832
v_fma_f32 v87,v87,s36,v14
v_mfma_f32_16x16x32_bf16 v[248:251],v[120:123],v[24:27],v[248:251]
ds_read_b128 v[116:119],v1 offset:24832
v_fma_f32 v95,v95,s36,v15
v_mfma_f32_16x16x32_bf16 a[40:43],v[120:123],v[28:31],a[40:43]
v_exp_f32 v84,v84
v_mfma_f32_16x16x32_bf16 a[88:91],v[120:123],v[32:35],a[88:91]
ds_read_b128 v[120:123],v0 offset:30720
v_fma_f32 v102,v102,s36,v16
v_mfma_f32_16x16x32_bf16 v[204:207],v[124:127],v[20:23],v[204:207]
v_exp_f32 v87,v87
v_mfma_f32_16x16x32_bf16 v[252:255],v[124:127],v[24:27],v[252:255]
v_exp_f32 v85,v85
v_mfma_f32_16x16x32_bf16 a[44:47],v[124:127],v[28:31],a[44:47]
v_exp_f32 v95,v95
v_mfma_f32_16x16x32_bf16 a[92:95],v[124:127],v[32:35],a[92:95]
s_waitcnt lgkmcnt(3)
ds_read_b128 v[124:127],v1 offset:30720
v_cvt_pk_bf16_f32 v46,v84,v85
v_mfma_f32_16x16x32_bf16 v[72:75],v[128:131],a[144:147],0
buffer_store_dwordx4 v[156:159],v9,s[16:19],s27 offen offset:0 nt
buffer_load_dwordx4 v7,s[8:11],s21 offen offset:1024 lds
v_mfma_f32_16x16x32_bf16 v[80:83],v[128:131],a[168:171],0
ds_read_b128 v[156:159],v10 offset:7168
v_mfma_f32_16x16x32_bf16 v[88:91],v[128:131],a[192:195],0
v_exp_f32 v86,v86
v_mfma_f32_16x16x32_bf16 v[96:99],v[128:131],a[216:219],0
v_exp_f32 v93,v93
v_mfma_f32_16x16x32_bf16 v[72:75],v[132:135],a[148:151],v[72:75]
v_exp_f32 v92,v92
v_mfma_f32_16x16x32_bf16 v[80:83],v[132:135],a[172:175],v[80:83]
ds_read_b128 v[128:131],v0 offset:30848
v_fma_f32 v103,v103,s36,v16
v_mfma_f32_16x16x32_bf16 v[88:91],v[132:135],a[196:199],v[88:91]
v_exp_f32 v102,v102
v_mfma_f32_16x16x32_bf16 v[96:99],v[132:135],a[220:223],v[96:99]
v_exp_f32 v94,v94
v_mfma_f32_16x16x32_bf16 v[72:75],v[136:139],a[152:155],v[72:75]
buffer_load_dwordx4 v8,s[8:11],s21 offen offset:2048 lds
v_mfma_f32_16x16x32_bf16 v[80:83],v[136:139],a[176:179],v[80:83]
s_add_u32 s21,s21,12288
v_exp_f32 v103,v103
v_mfma_f32_16x16x32_bf16 v[88:91],v[136:139],a[200:203],v[88:91]
s_cmp_eq_u32 s38,1
v_cvt_pk_bf16_f32 v51,v94,v95
v_cvt_pk_bf16_f32 v47,v86,v87
v_mfma_f32_16x16x32_bf16 v[96:99],v[136:139],a[224:227],v[96:99]
s_cselect_b32 s20,s26,s20
v_fma_f32 v101,v101,s36,v16
v_fma_f32 v100,v100,s36,v16
v_smfmac_f32_16x16x64_bf16 v[60:63],v[152:155],v[40:47],v18
s_add_u32 m0,s22,12288
v_cvt_pk_bf16_f32 v50,v92,v93
v_mfma_f32_16x16x32_bf16 v[72:75],v[140:143],a[156:159],v[72:75]
v_exp_f32 v100,v100
v_mfma_f32_16x16x32_bf16 v[80:83],v[140:143],a[180:183],v[80:83]
v_exp_f32 v101,v101
v_mfma_f32_16x16x32_bf16 v[88:91],v[140:143],a[204:207],v[88:91]
ds_read_b128 v[132:135],v1 offset:30848
v_cvt_pk_bf16_f32 v55,v102,v103
v_mfma_f32_16x16x32_bf16 v[96:99],v[140:143],a[228:231],v[96:99]
s_waitcnt lgkmcnt(1)
v_cvt_pk_bf16_f32 v54,v100,v101
v_mfma_f32_16x16x32_bf16 v[72:75],v[112:115],a[160:163],v[72:75]
buffer_store_dwordx4 v[156:159],v9,s[16:19],s27 offen offset:128 nt
buffer_load_dwordx4 v6,s[4:7],s20 offen offset:0 lds
v_smfmac_f32_16x16x64_bf16 v[64:67],v[152:155],v[48:55],v18
ds_read_b128 v[156:159],v10 offset:8192
v_mfma_f32_16x16x32_bf16 v[80:83],v[112:115],a[184:187],v[80:83]
ds_read_b128 v[136:139],v0 offset:30976
v_mfma_f32_16x16x32_bf16 v[88:91],v[112:115],a[208:211],v[88:91]
ds_read_b128 v[140:143],v1 offset:30976
v_mfma_f32_16x16x32_bf16 v[96:99],v[112:115],a[232:235],v[96:99]
v_mfma_f32_16x16x32_bf16 v[72:75],v[116:119],a[164:167],v[72:75]
v_mfma_f32_16x16x32_bf16 v[80:83],v[116:119],a[188:191],v[80:83]
v_mfma_f32_16x16x32_bf16 v[88:91],v[116:119],a[212:215],v[88:91]
v_mfma_f32_16x16x32_bf16 v[96:99],v[116:119],a[236:239],v[96:99]
buffer_load_dwordx4 v7,s[4:7],s20 offen offset:1024 lds
v_mfma_f32_16x16x32_bf16 v[76:79],v[120:123],a[144:147],0
v_mfma_f32_16x16x32_bf16 v[84:87],v[120:123],a[168:171],0
v_mfma_f32_16x16x32_bf16 v[92:95],v[120:123],a[192:195],0
v_mfma_f32_16x16x32_bf16 v[100:103],v[120:123],a[216:219],0
v_fma_f32 v75,v75,s36,v13
v_fma_f32 v73,v73,s36,v13
v_mfma_f32_16x16x32_bf16 v[76:79],v[124:127],a[148:151],v[76:79]
v_exp_f32 v73,v73
v_mfma_f32_16x16x32_bf16 v[84:87],v[124:127],a[172:175],v[84:87]
v_exp_f32 v75,v75
v_mfma_f32_16x16x32_bf16 v[92:95],v[124:127],a[196:199],v[92:95]
v_fma_f32 v80,v80,s36,v14
v_fma_f32 v72,v72,s36,v13
v_mfma_f32_16x16x32_bf16 v[100:103],v[124:127],a[220:223],v[100:103]
v_exp_f32 v72,v72
v_mfma_f32_16x16x32_bf16 v[76:79],v[128:131],a[152:155],v[76:79]
s_waitcnt lgkmcnt(0)
buffer_store_dwordx4 v[156:159],v9,s[16:19],s27 offen offset:256 nt
buffer_load_dwordx4 v8,s[4:7],s20 offen offset:2048 lds
v_mfma_f32_16x16x32_bf16 v[84:87],v[128:131],a[176:179],v[84:87]
s_add_u32 s20,s20,12288
ds_read_b64_tr_b16 v[112:113],v2 offset:12288
v_mfma_f32_16x16x32_bf16 v[92:95],v[128:131],a[200:203],v[92:95]
s_add_u32 s27,s27,3072
ds_read_b64_tr_b16 v[114:115],v2 offset:18432
v_fma_f32 v81,v81,s36,v14
v_mfma_f32_16x16x32_bf16 v[100:103],v[128:131],a[224:227],v[100:103]
ds_read_b64_tr_b16 v[116:117],v3 offset:12288
v_mfma_f32_16x16x32_bf16 v[76:79],v[132:135],a[156:159],v[76:79]
ds_read_b64_tr_b16 v[118:119],v3 offset:18432
v_fma_f32 v74,v74,s36,v13
v_mfma_f32_16x16x32_bf16 v[84:87],v[132:135],a[180:183],v[84:87]
ds_read_b64_tr_b16 v[120:121],v4 offset:12288
v_mfma_f32_16x16x32_bf16 v[92:95],v[132:135],a[204:207],v[92:95]
ds_read_b64_tr_b16 v[122:123],v4 offset:18432
v_cvt_pk_bf16_f32 v20,v72,v73
v_mfma_f32_16x16x32_bf16 v[100:103],v[132:135],a[228:231],v[100:103]
ds_read_b64_tr_b16 v[124:125],v5 offset:12288
v_mfma_f32_16x16x32_bf16 v[76:79],v[136:139],a[160:163],v[76:79]
ds_read_b64_tr_b16 v[126:127],v5 offset:18432
v_mfma_f32_16x16x32_bf16 v[84:87],v[136:139],a[184:187],v[84:87]
v_exp_f32 v81,v81
v_mfma_f32_16x16x32_bf16 v[92:95],v[136:139],a[208:211],v[92:95]
v_exp_f32 v80,v80
v_mfma_f32_16x16x32_bf16 v[100:103],v[136:139],a[232:235],v[100:103]
v_exp_f32 v74,v74
v_mfma_f32_16x16x32_bf16 v[76:79],v[140:143],a[164:167],v[76:79]
v_cvt_pk_bf16_f32 v24,v80,v81
v_cvt_pk_bf16_f32 v21,v74,v75
v_mfma_f32_16x16x32_bf16 v[84:87],v[140:143],a[188:191],v[84:87]
v_mfma_f32_16x16x32_bf16 v[92:95],v[140:143],a[212:215],v[92:95]
v_mfma_f32_16x16x32_bf16 v[100:103],v[140:143],a[236:239],v[100:103]
s_waitcnt lgkmcnt(2)
v_mfma_f32_16x16x32_bf16 v[160:163],v[112:115],v[40:43],v[160:163]
s_add_u32 m0,s29,0
ds_read_b64_tr_b16 v[128:129],v2 offset:12416
ds_read_b64_tr_b16 v[130:131],v2 offset:18560
v_mfma_f32_16x16x32_bf16 v[208:211],v[112:115],v[44:47],v[208:211]
ds_read_b64_tr_b16 v[132:133],v3 offset:12416
ds_read_b64_tr_b16 v[134:135],v3 offset:18560
v_mfma_f32_16x16x32_bf16 a[0:3],v[112:115],v[48:51],a[0:3]
ds_read_b64_tr_b16 v[136:137],v4 offset:12416
ds_read_b64_tr_b16 v[138:139],v4 offset:18560
v_mfma_f32_16x16x32_bf16 a[48:51],v[112:115],v[52:55],a[48:51]
ds_read_b64_tr_b16 v[140:141],v5 offset:12416
ds_read_b64_tr_b16 v[142:143],v5 offset:18560
v_mfma_f32_16x16x32_bf16 v[164:167],v[116:119],v[40:43],v[164:167]
ds_read_b64_tr_b16 v[112:113],v2 offset:12544
ds_read_b64_tr_b16 v[114:115],v2 offset:18688
v_mfma_f32_16x16x32_bf16 v[212:215],v[116:119],v[44:47],v[212:215]
v_fma_f32 v82,v82,s36,v14
v_fma_f32 v83,v83,s36,v14
v_mfma_f32_16x16x32_bf16 a[4:7],v[116:119],v[48:51],a[4:7]
buffer_load_dwordx4 v6,s[12:15],s28 offen offset:0 nt lds
v_mfma_f32_16x16x32_bf16 a[52:55],v[116:119],v[52:55],a[52:55]
ds_read_b64_tr_b16 v[116:117],v3 offset:12544
ds_read_b64_tr_b16 v[118:119],v3 offset:18688
v_mfma_f32_16x16x32_bf16 v[168:171],v[120:123],v[40:43],v[168:171]
v_exp_f32 v82,v82
v_mfma_f32_16x16x32_bf16 v[216:219],v[120:123],v[44:47],v[216:219]
v_exp_f32 v83,v83
v_mfma_f32_16x16x32_bf16 a[8:11],v[120:123],v[48:51],a[8:11]
v_cvt_pk_bf16_f32 v25,v82,v83
v_fma_f32 v88,v88,s36,v15
v_mfma_f32_16x16x32_bf16 a[56:59],v[120:123],v[52:55],a[56:59]
s_waitcnt lgkmcnt(5)
ds_read_b64_tr_b16 v[120:121],v4 offset:12544
ds_read_b64_tr_b16 v[122:123],v4 offset:18688
v_mfma_f32_16x16x32_bf16 v[172:175],v[124:127],v[40:43],v[172:175]
v_fma_f32 v89,v89,s36,v15
v_fma_f32 v90,v90,s36,v15
v_mfma_f32_16x16x32_bf16 v[220:223],v[124:127],v[44:47],v[220:223]
buffer_load_dwordx4 v7,s[12:15],s28 offen offset:1024 nt lds
v_mfma_f32_16x16x32_bf16 a[12:15],v[124:127],v[48:51],a[12:15]
v_fma_f32 v91,v91,s36,v15
v_fma_f32 v96,v96,s36,v16
v_mfma_f32_16x16x32_bf16 a[60:63],v[124:127],v[52:55],a[60:63]
ds_read_b64_tr_b16 v[124:125],v5 offset:12544
ds_read_b64_tr_b16 v[126:127],v5 offset:18688
v_mfma_f32_16x16x32_bf16 v[176:179],v[128:131],v[40:43],v[176:179]
v_exp_f32 v88,v88
v_mfma_f32_16x16x32_bf16 v[224:227],v[128:131],v[44:47],v[224:227]
v_exp_f32 v89,v89
v_mfma_f32_16x16x32_bf16 a[16:19],v[128:131],v[48:51],a[16:19]
v_exp_f32 v90,v90
v_mfma_f32_16x16x32_bf16 a[64:67],v[128:131],v[52:55],a[64:67]
v_exp_f32 v91,v91
v_mfma_f32_16x16x32_bf16 v[180:183],v[132:135],v[40:43],v[180:183]
v_cvt_pk_bf16_f32 v28,v88,v89
v_cvt_pk_bf16_f32 v29,v90,v91
v_mfma_f32_16x16x32_bf16 v[228:231],v[132:135],v[44:47],v[228:231]
buffer_load_dwordx4 v8,s[12:15],s28 offen offset:2048 nt lds
v_mfma_f32_16x16x32_bf16 a[20:23],v[132:135],v[48:51],a[20:23]
s_add_u32 s28,s28,3072
v_fma_f32 v97,v97,s36,v16
v_fma_f32 v98,v98,s36,v16
v_mfma_f32_16x16x32_bf16 a[68:71],v[132:135],v[52:55],a[68:71]
s_add_u32 s29,s29,3072
v_fma_f32 v99,v99,s36,v16
v_fma_f32 v76,v76,s36,v13
v_mfma_f32_16x16x32_bf16 v[184:187],v[136:139],v[40:43],v[184:187]
s_cmp_eq_u32 s38,1
v_exp_f32 v96,v96
v_mfma_f32_16x16x32_bf16 v[232:235],v[136:139],v[44:47],v[232:235]
s_cselect_b32 s21,s26,s21
v_exp_f32 v97,v97
v_mfma_f32_16x16x32_bf16 a[24:27],v[136:139],v[48:51],a[24:27]
s_add_u32 m0,s23,12288
v_exp_f32 v98,v98
v_mfma_f32_16x16x32_bf16 a[72:75],v[136:139],v[52:55],a[72:75]
s_waitcnt lgkmcnt(0)
v_exp_f32 v99,v99
v_mfma_f32_16x16x32_bf16 v[188:191],v[140:143],v[40:43],v[188:191]
v_cvt_pk_bf16_f32 v32,v96,v97
v_cvt_pk_bf16_f32 v33,v98,v99
v_mfma_f32_16x16x32_bf16 v[236:239],v[140:143],v[44:47],v[236:239]
v_fma_f32 v77,v77,s36,v13
v_fma_f32 v78,v78,s36,v13
v_mfma_f32_16x16x32_bf16 a[28:31],v[140:143],v[48:51],a[28:31]
v_fma_f32 v79,v79,s36,v13
v_fma_f32 v84,v84,s36,v14
v_mfma_f32_16x16x32_bf16 a[76:79],v[140:143],v[52:55],a[76:79]
v_exp_f32 v76,v76
s_waitcnt vmcnt(12)
v_mfma_f32_16x16x32_bf16 v[192:195],v[112:115],v[40:43],v[192:195]
s_barrier
v_mfma_f32_16x16x32_bf16 v[240:243],v[112:115],v[44:47],v[240:243]
ds_read_b128 v[128:131],v0 offset:0
v_fma_f32 v85,v85,s36,v14
v_mfma_f32_16x16x32_bf16 a[32:35],v[112:115],v[48:51],a[32:35]
ds_read_b128 v[132:135],v1 offset:0
v_fma_f32 v86,v86,s36,v14
v_mfma_f32_16x16x32_bf16 a[80:83],v[112:115],v[52:55],a[80:83]
ds_read_b128 v[136:139],v0 offset:128
v_fma_f32 v87,v87,s36,v14
v_mfma_f32_16x16x32_bf16 v[196:199],v[116:119],v[40:43],v[196:199]
ds_read_b128 v[140:143],v1 offset:128
v_fma_f32 v92,v92,s36,v15
v_mfma_f32_16x16x32_bf16 v[244:247],v[116:119],v[44:47],v[244:247]
ds_read_b128 v[112:115],v0 offset:256
v_fma_f32 v93,v93,s36,v15
v_mfma_f32_16x16x32_bf16 a[36:39],v[116:119],v[48:51],a[36:39]
buffer_load_dwordx4 v6,s[8:11],s21 offen offset:0 lds
v_mfma_f32_16x16x32_bf16 a[84:87],v[116:119],v[52:55],a[84:87]
ds_read_b128 v[116:119],v1 offset:256
v_fma_f32 v94,v94,s36,v15
v_mfma_f32_16x16x32_bf16 v[200:203],v[120:123],v[40:43],v[200:203]
v_exp_f32 v77,v77
v_mfma_f32_16x16x32_bf16 v[248:251],v[120:123],v[44:47],v[248:251]
v_exp_f32 v78,v78
v_mfma_f32_16x16x32_bf16 a[40:43],v[120:123],v[48:51],a[40:43]
v_exp_f32 v79,v79
v_mfma_f32_16x16x32_bf16 a[88:91],v[120:123],v[52:55],a[88:91]
ds_read_b128 v[120:123],v0 offset:6144
v_cvt_pk_bf16_f32 v22,v76,v77
v_mfma_f32_16x16x32_bf16 v[204:207],v[124:127],v[40:43],v[204:207]
v_cvt_pk_bf16_f32 v23,v78,v79
v_fma_f32 v95,v95,s36,v15
v_mfma_f32_16x16x32_bf16 v[252:255],v[124:127],v[44:47],v[252:255]
v_exp_f32 v84,v84
v_mfma_f32_16x16x32_bf16 a[44:47],v[124:127],v[48:51],a[44:47]
v_exp_f32 v85,v85
v_mfma_f32_16x16x32_bf16 a[92:95],v[124:127],v[52:55],a[92:95]
buffer_load_dwordx4 v7,s[8:11],s21 offen offset:1024 lds
s_waitcnt lgkmcnt(1)
v_mfma_f32_16x16x32_bf16 v[72:75],v[128:131],a[144:147],0
ds_read_b128 v[124:127],v1 offset:6144
v_cvt_pk_bf16_f32 v26,v84,v85
v_mfma_f32_16x16x32_bf16 v[80:83],v[128:131],a[168:171],0
v_exp_f32 v86,v86
v_mfma_f32_16x16x32_bf16 v[88:91],v[128:131],a[192:195],0
v_exp_f32 v87,v87
v_mfma_f32_16x16x32_bf16 v[96:99],v[128:131],a[216:219],0
ds_read_b128 v[128:131],v0 offset:6272
v_cvt_pk_bf16_f32 v27,v86,v87
v_mfma_f32_16x16x32_bf16 v[72:75],v[132:135],a[148:151],v[72:75]
v_exp_f32 v92,v92
v_smfmac_f32_16x16x64_bf16 v[60:63],v[152:155],v[20:27],v18
v_fma_f32 v100,v100,s36,v16
v_mfma_f32_16x16x32_bf16 v[80:83],v[132:135],a[172:175],v[80:83]
v_exp_f32 v93,v93
v_mfma_f32_16x16x32_bf16 v[88:91],v[132:135],a[196:199],v[88:91]
v_exp_f32 v94,v94
v_mfma_f32_16x16x32_bf16 v[96:99],v[132:135],a[220:223],v[96:99]
buffer_load_dwordx4 v8,s[8:11],s21 offen offset:2048 lds
v_mfma_f32_16x16x32_bf16 v[72:75],v[136:139],a[152:155],v[72:75]
s_add_u32 s21,s21,12288
v_exp_f32 v95,v95
v_mfma_f32_16x16x32_bf16 v[80:83],v[136:139],a[176:179],v[80:83]
s_add_u32 m0,s22,24576
v_cvt_pk_bf16_f32 v30,v92,v93
v_cvt_pk_bf16_f32 v31,v94,v95
v_mfma_f32_16x16x32_bf16 v[88:91],v[136:139],a[200:203],v[88:91]
v_fma_f32 v101,v101,s36,v16
v_fma_f32 v102,v102,s36,v16
v_mfma_f32_16x16x32_bf16 v[96:99],v[136:139],a[224:227],v[96:99]
v_fma_f32 v103,v103,s36,v16
v_add_u32 v10,9216,v10
v_mfma_f32_16x16x32_bf16 v[72:75],v[140:143],a[156:159],v[72:75]
v_exp_f32 v100,v100
v_mfma_f32_16x16x32_bf16 v[80:83],v[140:143],a[180:183],v[80:83]
v_exp_f32 v101,v101
v_mfma_f32_16x16x32_bf16 v[88:91],v[140:143],a[204:207],v[88:91]
v_exp_f32 v102,v102
v_mfma_f32_16x16x32_bf16 v[96:99],v[140:143],a[228:231],v[96:99]
v_exp_f32 v103,v103
v_mfma_f32_16x16x32_bf16 v[72:75],v[112:115],a[160:163],v[72:75]
buffer_load_dwordx4 v6,s[4:7],s20 offen offset:0 lds
v_mfma_f32_16x16x32_bf16 v[80:83],v[112:115],a[184:187],v[80:83]
v_cvt_pk_bf16_f32 v34,v100,v101
v_cvt_pk_bf16_f32 v35,v102,v103
v_mfma_f32_16x16x32_bf16 v[88:91],v[112:115],a[208:211],v[88:91]
ds_read_b128 v[132:135],v1 offset:6272
v_smfmac_f32_16x16x64_bf16 v[64:67],v[152:155],v[28:35],v18
ds_read_b128 v[136:139],v0 offset:6400
v_mfma_f32_16x16x32_bf16 v[96:99],v[112:115],a[232:235],v[96:99]
ds_read_b128 v[140:143],v1 offset:6400
v_mfma_f32_16x16x32_bf16 v[72:75],v[116:119],a[164:167],v[72:75]
v_mfma_f32_16x16x32_bf16 v[80:83],v[116:119],a[188:191],v[80:83]
v_mfma_f32_16x16x32_bf16 v[88:91],v[116:119],a[212:215],v[88:91]
v_mfma_f32_16x16x32_bf16 v[96:99],v[116:119],a[236:239],v[96:99]
s_waitcnt lgkmcnt(3)
v_mfma_f32_16x16x32_bf16 v[76:79],v[120:123],a[144:147],0
buffer_load_dwordx4 v7,s[4:7],s20 offen offset:1024 lds
v_mfma_f32_16x16x32_bf16 v[84:87],v[120:123],a[168:171],0
v_mfma_f32_16x16x32_bf16 v[92:95],v[120:123],a[192:195],0
v_mfma_f32_16x16x32_bf16 v[100:103],v[120:123],a[216:219],0
v_fma_f32 v72,v72,s36,v13
v_fma_f32 v73,v73,s36,v13
v_mfma_f32_16x16x32_bf16 v[76:79],v[124:127],a[148:151],v[76:79]
v_fma_f32 v74,v74,s36,v13
v_fma_f32 v75,v75,s36,v13
v_mfma_f32_16x16x32_bf16 v[84:87],v[124:127],a[172:175],v[84:87]
v_fma_f32 v80,v80,s36,v14
v_fma_f32 v81,v81,s36,v14
v_mfma_f32_16x16x32_bf16 v[92:95],v[124:127],a[196:199],v[92:95]
v_exp_f32 v72,v72
v_mfma_f32_16x16x32_bf16 v[100:103],v[124:127],a[220:223],v[100:103]
v_exp_f32 v73,v73
v_mfma_f32_16x16x32_bf16 v[76:79],v[128:131],a[152:155],v[76:79]
v_exp_f32 v74,v74
v_mfma_f32_16x16x32_bf16 v[84:87],v[128:131],a[176:179],v[84:87]
buffer_load_dwordx4 v8,s[4:7],s20 offen offset:2048 lds
v_mfma_f32_16x16x32_bf16 v[92:95],v[128:131],a[200:203],v[92:95]
s_add_u32 s20,s20,12288
s_add_u32 s38,s38,1
s_cmp_lt_u32 s38,2
v_mfma_f32_16x16x32_bf16 v[100:103],v[128:131],a[224:227],v[100:103]
s_waitcnt lgkmcnt(0)
ds_read_b64_tr_b16 v[112:113],v2 offset:24576
ds_read_b64_tr_b16 v[114:115],v2 offset:30720
v_mfma_f32_16x16x32_bf16 v[76:79],v[132:135],a[156:159],v[76:79]
ds_read_b64_tr_b16 v[116:117],v3 offset:24576
v_mfma_f32_16x16x32_bf16 v[84:87],v[132:135],a[180:183],v[84:87]
ds_read_b64_tr_b16 v[118:119],v3 offset:30720
v_cvt_pk_bf16_f32 v40,v72,v73
v_mfma_f32_16x16x32_bf16 v[92:95],v[132:135],a[204:207],v[92:95]
ds_read_b64_tr_b16 v[120:121],v4 offset:24576
v_mfma_f32_16x16x32_bf16 v[100:103],v[132:135],a[228:231],v[100:103]
ds_read_b64_tr_b16 v[122:123],v4 offset:30720
v_mfma_f32_16x16x32_bf16 v[76:79],v[136:139],a[160:163],v[76:79]
ds_read_b64_tr_b16 v[124:125],v5 offset:24576
v_mfma_f32_16x16x32_bf16 v[84:87],v[136:139],a[184:187],v[84:87]
ds_read_b64_tr_b16 v[126:127],v5 offset:30720
v_mfma_f32_16x16x32_bf16 v[92:95],v[136:139],a[208:211],v[92:95]
v_exp_f32 v75,v75
v_mfma_f32_16x16x32_bf16 v[100:103],v[136:139],a[232:235],v[100:103]
v_exp_f32 v80,v80
v_mfma_f32_16x16x32_bf16 v[76:79],v[140:143],a[164:167],v[76:79]
v_exp_f32 v81,v81
v_mfma_f32_16x16x32_bf16 v[84:87],v[140:143],a[188:191],v[84:87]
v_cvt_pk_bf16_f32 v41,v74,v75
v_cvt_pk_bf16_f32 v44,v80,v81
v_mfma_f32_16x16x32_bf16 v[92:95],v[140:143],a[212:215],v[92:95]
v_mfma_f32_16x16x32_bf16 v[100:103],v[140:143],a[236:239],v[100:103]
s_cbranch_scc1 L_loop4w0
s_cmp_ge_u32 s69,6
s_cbranch_scc1 L_end4
s_cmp_eq_u32 s40,0
s_cbranch_scc1 L_tr44
s_branch L_tr45
L_tr45:
s_waitcnt vmcnt(42)
s_waitcnt lgkmcnt(4)
v_mfma_f32_16x16x32_bf16 v[160:163],v[112:115],v[20:23],v[160:163]
s_add_u32 m0,s24,0
ds_read_b128 a[144:147],v11 offset:0
v_fma_f32 v82,v82,s36,v14
v_mfma_f32_16x16x32_bf16 v[208:211],v[112:115],v[24:27],v[208:211]
ds_read_b128 a[148:151],v12 offset:0
v_fma_f32 v83,v83,s36,v14
v_mfma_f32_16x16x32_bf16 a[0:3],v[112:115],v[28:31],a[0:3]
ds_read_b128 a[152:155],v11 offset:128
v_fma_f32 v88,v88,s36,v15
v_mfma_f32_16x16x32_bf16 a[48:51],v[112:115],v[32:35],a[48:51]
ds_read_b128 a[156:159],v12 offset:128
v_fma_f32 v89,v89,s36,v15
v_mfma_f32_16x16x32_bf16 v[164:167],v[116:119],v[20:23],v[164:167]
ds_read_b128 a[160:163],v11 offset:256
v_fma_f32 v90,v90,s36,v15
v_mfma_f32_16x16x32_bf16 v[212:215],v[116:119],v[24:27],v[212:215]
ds_read_b128 a[164:167],v12 offset:256
ds_read_b64_tr_b16 v[128:129],v2 offset:24704
ds_read_b64_tr_b16 v[130:131],v2 offset:30848
ds_read_b64_tr_b16 v[132:133],v3 offset:24704
ds_read_b64_tr_b16 v[134:135],v3 offset:30848
ds_read_b64_tr_b16 v[136:137],v4 offset:24704
ds_read_b64_tr_b16 v[138:139],v4 offset:30848
ds_read_b64_tr_b16 v[140:141],v5 offset:24704
ds_read_b64_tr_b16 v[142:143],v5 offset:30848
ds_read_b64_tr_b16 v[112:113],v2 offset:24832
ds_read_b64_tr_b16 v[114:115],v2 offset:30976
ds_read_b128 a[168:171],v11 offset:6144
v_mfma_f32_16x16x32_bf16 a[4:7],v[116:119],v[28:31],a[4:7]
v_fma_f32 v91,v91,s36,v15
ds_read_b128 a[172:175],v12 offset:6144
ds_read_b128 a[176:179],v11 offset:6272
v_mfma_f32_16x16x32_bf16 a[52:55],v[116:119],v[32:35],a[52:55]
s_waitcnt lgkmcnt(13)
v_fma_f32 v96,v96,s36,v16
ds_read_b128 a[180:183],v12 offset:6272
ds_read_b128 a[184:187],v11 offset:6400
v_mfma_f32_16x16x32_bf16 v[168:171],v[120:123],v[20:23],v[168:171]
buffer_load_dwordx4 v6,s[12:15],s28 offen offset:0 nt lds
v_mfma_f32_16x16x32_bf16 v[216:219],v[120:123],v[24:27],v[216:219]
ds_read_b64_tr_b16 v[116:117],v3 offset:24832
ds_read_b64_tr_b16 v[118:119],v3 offset:30976
v_mfma_f32_16x16x32_bf16 a[8:11],v[120:123],v[28:31],a[8:11]
ds_read_b128 a[188:191],v12 offset:6400
v_fma_f32 v97,v97,s36,v16
v_mfma_f32_16x16x32_bf16 a[56:59],v[120:123],v[32:35],a[56:59]
ds_read_b64_tr_b16 v[120:121],v4 offset:24832
ds_read_b64_tr_b16 v[122:123],v4 offset:30976
v_mfma_f32_16x16x32_bf16 v[172:175],v[124:127],v[20:23],v[172:175]
v_fma_f32 v98,v98,s36,v16
v_fma_f32 v99,v99,s36,v16
v_mfma_f32_16x16x32_bf16 v[220:223],v[124:127],v[24:27],v[220:223]
buffer_load_dwordx4 v7,s[12:15],s28 offen offset:1024 nt lds
v_mfma_f32_16x16x32_bf16 a[12:15],v[124:127],v[28:31],a[12:15]
v_fma_f32 v76,v76,s36,v13
v_fma_f32 v77,v77,s36,v13
v_mfma_f32_16x16x32_bf16 a[60:63],v[124:127],v[32:35],a[60:63]
s_waitcnt lgkmcnt(5)
ds_read_b64_tr_b16 v[124:125],v5 offset:24832
ds_read_b64_tr_b16 v[126:127],v5 offset:30976
v_mfma_f32_16x16x32_bf16 v[176:179],v[128:131],v[20:23],v[176:179]
v_fma_f32 v78,v78,s36,v13
v_fma_f32 v79,v79,s36,v13
v_mfma_f32_16x16x32_bf16 v[224:227],v[128:131],v[24:27],v[224:227]
v_fma_f32 v84,v84,s36,v14
v_fma_f32 v85,v85,s36,v14
v_mfma_f32_16x16x32_bf16 a[16:19],v[128:131],v[28:31],a[16:19]
v_fma_f32 v86,v86,s36,v14
v_fma_f32 v87,v87,s36,v14
v_mfma_f32_16x16x32_bf16 a[64:67],v[128:131],v[32:35],a[64:67]
v_fma_f32 v92,v92,s36,v15
v_fma_f32 v93,v93,s36,v15
v_mfma_f32_16x16x32_bf16 v[180:183],v[132:135],v[20:23],v[180:183]
v_fma_f32 v94,v94,s36,v15
v_fma_f32 v95,v95,s36,v15
v_mfma_f32_16x16x32_bf16 v[228:231],v[132:135],v[24:27],v[228:231]
buffer_load_dwordx4 v8,s[12:15],s28 offen offset:2048 nt lds
v_mfma_f32_16x16x32_bf16 a[20:23],v[132:135],v[28:31],a[20:23]
s_add_u32 s28,s28,3072
v_fma_f32 v100,v100,s36,v16
v_fma_f32 v101,v101,s36,v16
v_mfma_f32_16x16x32_bf16 a[68:71],v[132:135],v[32:35],a[68:71]
s_add_u32 m0,s24,3072
v_fma_f32 v102,v102,s36,v16
v_fma_f32 v103,v103,s36,v16
v_mfma_f32_16x16x32_bf16 v[184:187],v[136:139],v[20:23],v[184:187]
v_exp_f32 v82,v82
v_mfma_f32_16x16x32_bf16 v[232:235],v[136:139],v[24:27],v[232:235]
v_exp_f32 v83,v83
v_mfma_f32_16x16x32_bf16 a[24:27],v[136:139],v[28:31],a[24:27]
v_exp_f32 v88,v88
v_mfma_f32_16x16x32_bf16 a[72:75],v[136:139],v[32:35],a[72:75]
v_exp_f32 v89,v89
v_mfma_f32_16x16x32_bf16 v[188:191],v[140:143],v[20:23],v[188:191]
v_exp_f32 v90,v90
v_mfma_f32_16x16x32_bf16 v[236:239],v[140:143],v[24:27],v[236:239]
buffer_load_dwordx4 v6,s[12:15],s28 offen offset:0 nt lds
v_mfma_f32_16x16x32_bf16 a[28:31],v[140:143],v[28:31],a[28:31]
v_exp_f32 v91,v91
v_mfma_f32_16x16x32_bf16 a[76:79],v[140:143],v[32:35],a[76:79]
v_exp_f32 v96,v96
v_mfma_f32_16x16x32_bf16 v[192:195],v[112:115],v[20:23],v[192:195]
v_exp_f32 v97,v97
v_mfma_f32_16x16x32_bf16 v[240:243],v[112:115],v[24:27],v[240:243]
v_exp_f32 v98,v98
v_mfma_f32_16x16x32_bf16 a[32:35],v[112:115],v[28:31],a[32:35]
v_exp_f32 v99,v99
v_mfma_f32_16x16x32_bf16 a[80:83],v[112:115],v[32:35],a[80:83]
s_waitcnt lgkmcnt(0)
v_exp_f32 v76,v76
v_mfma_f32_16x16x32_bf16 v[196:199],v[116:119],v[20:23],v[196:199]
buffer_load_dwordx4 v7,s[12:15],s28 offen offset:1024 nt lds
v_mfma_f32_16x16x32_bf16 v[244:247],v[116:119],v[24:27],v[244:247]
v_exp_f32 v77,v77
v_mfma_f32_16x16x32_bf16 a[36:39],v[116:119],v[28:31],a[36:39]
v_exp_f32 v78,v78
v_mfma_f32_16x16x32_bf16 a[84:87],v[116:119],v[32:35],a[84:87]
v_exp_f32 v79,v79
v_mfma_f32_16x16x32_bf16 v[200:203],v[120:123],v[20:23],v[200:203]
v_exp_f32 v84,v84
v_mfma_f32_16x16x32_bf16 v[248:251],v[120:123],v[24:27],v[248:251]
v_exp_f32 v85,v85
v_mfma_f32_16x16x32_bf16 a[40:43],v[120:123],v[28:31],a[40:43]
v_exp_f32 v86,v86
v_mfma_f32_16x16x32_bf16 a[88:91],v[120:123],v[32:35],a[88:91]
v_exp_f32 v87,v87
v_mfma_f32_16x16x32_bf16 v[204:207],v[124:127],v[20:23],v[204:207]
buffer_load_dwordx4 v8,s[12:15],s28 offen offset:2048 nt lds
s_waitcnt vmcnt(20)
s_barrier
v_mfma_f32_16x16x32_bf16 v[252:255],v[124:127],v[24:27],v[252:255]
s_add_u32 s28,s28,3072
ds_read_b64_tr_b16 v[128:129],v2 offset:0
ds_read_b64_tr_b16 v[130:131],v2 offset:6144
v_mfma_f32_16x16x32_bf16 a[44:47],v[124:127],v[28:31],a[44:47]
s_add_u32 m0,s22,0
ds_read_b64_tr_b16 v[132:133],v3 offset:0
buffer_load_dwordx4 v6,s[4:7],s25 offen offset:0 lds
v_mfma_f32_16x16x32_bf16 a[92:95],v[124:127],v[32:35],a[92:95]
buffer_load_dwordx4 v7,s[4:7],s25 offen offset:1024 lds
buffer_load_dwordx4 v8,s[4:7],s25 offen offset:2048 lds
ds_read_b64_tr_b16 v[134:135],v3 offset:6144
ds_read_b64_tr_b16 v[136:137],v4 offset:0
ds_read_b64_tr_b16 v[138:139],v4 offset:6144
ds_read_b64_tr_b16 v[140:141],v5 offset:0
ds_read_b64_tr_b16 v[142:143],v5 offset:6144
v_exp_f32 v92,v92
v_exp_f32 v93,v93
v_exp_f32 v94,v94
v_exp_f32 v95,v95
v_exp_f32 v100,v100
v_exp_f32 v101,v101
v_exp_f32 v102,v102
v_exp_f32 v103,v103
v_cvt_pk_bf16_f32 v45,v82,v83
v_cvt_pk_bf16_f32 v48,v88,v89
v_cvt_pk_bf16_f32 v49,v90,v91
v_cvt_pk_bf16_f32 v52,v96,v97
v_cvt_pk_bf16_f32 v53,v98,v99
v_cvt_pk_bf16_f32 v42,v76,v77
v_cvt_pk_bf16_f32 v43,v78,v79
v_cvt_pk_bf16_f32 v46,v84,v85
v_cvt_pk_bf16_f32 v47,v86,v87
v_cvt_pk_bf16_f32 v50,v92,v93
v_cvt_pk_bf16_f32 v51,v94,v95
v_smfmac_f32_16x16x64_bf16 v[60:63],v[152:155],v[40:47],v18
v_cvt_pk_bf16_f32 v54,v100,v101
v_cvt_pk_bf16_f32 v55,v102,v103
v_subrev_u32 v10,18432,v10
s_nop 0
v_smfmac_f32_16x16x64_bf16 v[64:67],v[152:155],v[48:55],v18
s_waitcnt lgkmcnt(0)
v_mfma_f32_16x16x32_bf16 v[160:163],v[128:131],v[40:43],v[160:163]
s_add_u32 s87,s42,18432
ds_read_b64_tr_b16 v[112:113],v2 offset:128
ds_read_b64_tr_b16 v[114:115],v2 offset:6272
v_mfma_f32_16x16x32_bf16 v[208:211],v[128:131],v[44:47],v[208:211]
ds_read_b64_tr_b16 v[116:117],v3 offset:128
ds_read_b64_tr_b16 v[118:119],v3 offset:6272
v_mfma_f32_16x16x32_bf16 a[0:3],v[128:131],v[48:51],a[0:3]
ds_read_b64_tr_b16 v[120:121],v4 offset:128
ds_read_b64_tr_b16 v[122:123],v4 offset:6272
v_mfma_f32_16x16x32_bf16 a[48:51],v[128:131],v[52:55],a[48:51]
ds_read_b64_tr_b16 v[124:125],v5 offset:128
ds_read_b64_tr_b16 v[126:127],v5 offset:6272
v_mfma_f32_16x16x32_bf16 v[164:167],v[132:135],v[40:43],v[164:167]
ds_read_b64_tr_b16 v[128:129],v2 offset:256
ds_read_b64_tr_b16 v[130:131],v2 offset:6400
v_mfma_f32_16x16x32_bf16 v[212:215],v[132:135],v[44:47],v[212:215]
v_mbcnt_lo_u32_b32 v39,-1,0
v_mbcnt_hi_u32_b32 v39,-1,v39
v_mfma_f32_16x16x32_bf16 a[4:7],v[132:135],v[48:51],a[4:7]
v_and_b32 v38,7,v39
v_add_f32 v60,v60,v61
v_mfma_f32_16x16x32_bf16 a[52:55],v[132:135],v[52:55],a[52:55]
ds_read_b64_tr_b16 v[132:133],v3 offset:256
ds_read_b64_tr_b16 v[134:135],v3 offset:6400
v_mfma_f32_16x16x32_bf16 v[168:171],v[136:139],v[40:43],v[168:171]
v_add_f32 v62,v62,v63
v_add_f32 v64,v64,v65
v_mfma_f32_16x16x32_bf16 v[216:219],v[136:139],v[44:47],v[216:219]
v_add_f32 v66,v66,v67
v_max3_f32 v19,v60,v62,v64
v_mfma_f32_16x16x32_bf16 a[8:11],v[136:139],v[48:51],a[8:11]
v_max_f32 v19,v19,v66
v_rcp_f32 v66,v66
v_mfma_f32_16x16x32_bf16 a[56:59],v[136:139],v[52:55],a[56:59]
ds_read_b64_tr_b16 v[136:137],v4 offset:256
ds_read_b64_tr_b16 v[138:139],v4 offset:6400
v_mfma_f32_16x16x32_bf16 v[172:175],v[140:143],v[40:43],v[172:175]
v_accvgpr_read_b32 v72,a48
v_accvgpr_read_b32 v73,a49
v_mfma_f32_16x16x32_bf16 v[220:223],v[140:143],v[44:47],v[220:223]
v_accvgpr_read_b32 v74,a50
v_accvgpr_read_b32 v75,a51
v_mfma_f32_16x16x32_bf16 a[12:15],v[140:143],v[48:51],a[12:15]
v_accvgpr_read_b32 v80,a52
v_accvgpr_read_b32 v81,a53
v_mfma_f32_16x16x32_bf16 a[60:63],v[140:143],v[52:55],a[60:63]
s_waitcnt lgkmcnt(3)
ds_read_b64_tr_b16 v[140:141],v5 offset:256
ds_read_b64_tr_b16 v[142:143],v5 offset:6400
v_mfma_f32_16x16x32_bf16 v[176:179],v[112:115],v[40:43],v[176:179]
v_accvgpr_read_b32 v82,a54
v_accvgpr_read_b32 v83,a55
v_mfma_f32_16x16x32_bf16 v[224:227],v[112:115],v[44:47],v[224:227]
v_accvgpr_read_b32 v88,a56
v_accvgpr_read_b32 v89,a57
v_mfma_f32_16x16x32_bf16 a[16:19],v[112:115],v[48:51],a[16:19]
v_accvgpr_read_b32 v90,a58
v_accvgpr_read_b32 v91,a59
v_mfma_f32_16x16x32_bf16 a[64:67],v[112:115],v[52:55],a[64:67]
v_accvgpr_read_b32 v96,a60
v_accvgpr_read_b32 v97,a61
v_mfma_f32_16x16x32_bf16 v[180:183],v[116:119],v[40:43],v[180:183]
v_accvgpr_read_b32 v98,a62
v_accvgpr_read_b32 v99,a63
v_mfma_f32_16x16x32_bf16 v[228:231],v[116:119],v[44:47],v[228:231]
v_cmp_ngt_f32 vcc,s37,v19
v_lshrrev_b32 v19,5,v39
v_mfma_f32_16x16x32_bf16 a[20:23],v[116:119],v[48:51],a[20:23]
v_xor_b32 v38,v38,v19
v_and_b32 v19,15,v39
v_lshl_add_u32 v19,v19,7,s24
v_lshl_add_u32 v19,v38,4,v19
v_bfe_u32 v38,v39,4,1
v_pk_mul_f32 v[72:73],v[72:73],v[66:67] op_sel_hi:[1,0]
v_pk_mul_f32 v[74:75],v[74:75],v[66:67] op_sel_hi:[1,0]
v_lshl_add_u32 v36,v38,3,v19
v_xor_b32 v37,32,v36
v_bfe_u32 v19,v39,3,1
v_xor_b32 v38,64,v36
v_xor_b32 v39,96,v36
v_lshlrev_b32 v19,11,v19
v_accvgpr_read_b32 v76,a64
v_accvgpr_read_b32 v77,a65
v_pk_mul_f32 v[76:77],v[76:77],v[66:67] op_sel_hi:[1,0]
v_accvgpr_read_b32 v78,a66
v_accvgpr_read_b32 v79,a67
v_pk_mul_f32 v[78:79],v[78:79],v[66:67] op_sel_hi:[1,0]
v_cvt_pk_bf16_f32 v72,v72,v73
v_cvt_pk_bf16_f32 v76,v76,v77
v_mfma_f32_16x16x32_bf16 a[68:71],v[116:119],v[52:55],a[68:71]
s_cmp_lg_u64 vcc,0
v_cvt_pk_bf16_f32 v73,v74,v75
v_cvt_pk_bf16_f32 v77,v78,v79
v_mfma_f32_16x16x32_bf16 v[184:187],v[120:123],v[40:43],v[184:187]
s_cselect_b32 s62,s32,0
ds_write2st64_b64 v36,v[72:73],v[76:77] offset0:36 offset1:40
v_mfma_f32_16x16x32_bf16 v[232:235],v[120:123],v[44:47],v[232:235]
s_or_b32 s31,s31,s62
v_accvgpr_read_b32 v84,a68
v_accvgpr_read_b32 v85,a69
v_mfma_f32_16x16x32_bf16 a[24:27],v[120:123],v[48:51],a[24:27]
s_lshl_b32 s32,s32,1
v_accvgpr_read_b32 v86,a70
v_accvgpr_read_b32 v87,a71
v_rcp_f32 v64,v64
v_rcp_f32 v60,v60
v_pk_mul_f32 v[80:81],v[80:81],v[66:67] op_sel_hi:[1,0]
v_pk_mul_f32 v[82:83],v[82:83],v[66:67] op_sel_hi:[1,0]
v_pk_mul_f32 v[84:85],v[84:85],v[66:67] op_sel_hi:[1,0]
v_pk_mul_f32 v[86:87],v[86:87],v[66:67] op_sel_hi:[1,0]
v_cvt_pk_bf16_f32 v80,v80,v81
v_cvt_pk_bf16_f32 v84,v84,v85
v_mfma_f32_16x16x32_bf16 a[72:75],v[120:123],v[52:55],a[72:75]
s_add_u32 m0,s24,6144
v_cvt_pk_bf16_f32 v81,v82,v83
v_cvt_pk_bf16_f32 v85,v86,v87
v_mfma_f32_16x16x32_bf16 v[188:191],v[124:127],v[40:43],v[188:191]
buffer_load_dwordx4 v6,s[12:15],s28 offen offset:0 nt lds
v_mfma_f32_16x16x32_bf16 v[236:239],v[124:127],v[44:47],v[236:239]
buffer_load_dwordx4 v7,s[12:15],s28 offen offset:1024 nt lds
v_mfma_f32_16x16x32_bf16 a[28:31],v[124:127],v[48:51],a[28:31]
buffer_load_dwordx4 v8,s[12:15],s28 offen offset:2048 nt lds
ds_write2st64_b64 v37,v[80:81],v[84:85] offset0:36 offset1:40
v_pk_mul_f32 v[88:89],v[88:89],v[66:67] op_sel_hi:[1,0]
v_pk_mul_f32 v[90:91],v[90:91],v[66:67] op_sel_hi:[1,0]
v_accvgpr_read_b32 v92,a72
v_accvgpr_read_b32 v93,a73
v_pk_mul_f32 v[92:93],v[92:93],v[66:67] op_sel_hi:[1,0]
v_accvgpr_read_b32 v94,a74
v_accvgpr_read_b32 v95,a75
v_pk_mul_f32 v[94:95],v[94:95],v[66:67] op_sel_hi:[1,0]
v_cvt_pk_bf16_f32 v88,v88,v89
v_cvt_pk_bf16_f32 v92,v92,v93
v_mfma_f32_16x16x32_bf16 a[76:79],v[124:127],v[52:55],a[76:79]
s_add_u32 s28,s28,3072
v_cvt_pk_bf16_f32 v89,v90,v91
v_cvt_pk_bf16_f32 v93,v94,v95
v_mfma_f32_16x16x32_bf16 v[192:195],v[128:131],v[40:43],v[192:195]
s_add_u32 m0,s24,9216
ds_write2st64_b64 v38,v[88:89],v[92:93] offset0:36 offset1:40
v_mfma_f32_16x16x32_bf16 v[240:243],v[128:131],v[44:47],v[240:243]
v_rcp_f32 v62,v62
v_mfma_f32_16x16x32_bf16 a[32:35],v[128:131],v[48:51],a[32:35]
buffer_load_dwordx4 v6,s[12:15],s28 offen offset:0 nt lds
buffer_load_dwordx4 v7,s[12:15],s28 offen offset:1024 nt lds
buffer_load_dwordx4 v8,s[12:15],s28 offen offset:2048 nt lds
v_pk_mul_f32 v[96:97],v[96:97],v[66:67] op_sel_hi:[1,0]
v_pk_mul_f32 v[98:99],v[98:99],v[66:67] op_sel_hi:[1,0]
v_accvgpr_read_b32 v100,a76
v_accvgpr_read_b32 v101,a77
v_pk_mul_f32 v[100:101],v[100:101],v[66:67] op_sel_hi:[1,0]
v_accvgpr_read_b32 v102,a78
v_accvgpr_read_b32 v103,a79
v_pk_mul_f32 v[102:103],v[102:103],v[66:67] op_sel_hi:[1,0]
v_cvt_pk_bf16_f32 v96,v96,v97
v_cvt_pk_bf16_f32 v100,v100,v101
v_mfma_f32_16x16x32_bf16 a[80:83],v[128:131],v[52:55],a[80:83]
s_add_u32 s28,s28,3072
v_cvt_pk_bf16_f32 v97,v98,v99
v_cvt_pk_bf16_f32 v101,v102,v103
s_waitcnt lgkmcnt(1)
v_mfma_f32_16x16x32_bf16 v[196:199],v[132:135],v[40:43],v[196:199]
s_add_u32 m0,s23,0
ds_write2st64_b64 v39,v[96:97],v[100:101] offset0:36 offset1:40
v_mfma_f32_16x16x32_bf16 v[244:247],v[132:135],v[44:47],v[244:247]
v_mov_b32 v68,0
v_accvgpr_read_b32 v72,a80
v_mfma_f32_16x16x32_bf16 a[36:39],v[132:135],v[48:51],a[36:39]
s_waitcnt vmcnt(21)
ds_read_b128 a[192:195],v11 offset:12288
ds_read_b128 a[196:199],v12 offset:12288
v_accvgpr_read_b32 v73,a81
ds_read_b128 a[200:203],v11 offset:12416
v_pk_mul_f32 v[72:73],v[72:73],v[66:67] op_sel_hi:[1,0]
ds_read_b128 a[204:207],v12 offset:12416
v_accvgpr_read_b32 v74,a82
ds_read_b128 a[208:211],v11 offset:12544
v_accvgpr_read_b32 v75,a83
ds_read_b128 a[212:215],v12 offset:12544
v_pk_mul_f32 v[74:75],v[74:75],v[66:67] op_sel_hi:[1,0]
ds_read_b128 v[156:159],v10 offset:18432
v_cvt_pk_bf16_f32 v72,v72,v73
v_mfma_f32_16x16x32_bf16 a[84:87],v[132:135],v[52:55],a[84:87]
ds_read_b128 v[104:107],v10 offset:19456
v_cvt_pk_bf16_f32 v73,v74,v75
v_mfma_f32_16x16x32_bf16 v[200:203],v[136:139],v[40:43],v[200:203]
ds_read_b128 v[108:111],v10 offset:20480
v_mov_b32 v69,0
v_mfma_f32_16x16x32_bf16 v[248:251],v[136:139],v[44:47],v[248:251]
ds_read_b128 v[76:79],v10 offset:21504
v_mov_b32 v70,0
v_mfma_f32_16x16x32_bf16 a[40:43],v[136:139],v[48:51],a[40:43]
ds_write_b64 v36,v[72:73] offset:18432
v_add_u32 v36,v36,v19
v_accvgpr_read_b32 v84,a84
v_accvgpr_read_b32 v85,a85
v_pk_mul_f32 v[84:85],v[84:85],v[66:67] op_sel_hi:[1,0]
v_accvgpr_read_b32 v86,a86
v_accvgpr_read_b32 v87,a87
v_pk_mul_f32 v[86:87],v[86:87],v[66:67] op_sel_hi:[1,0]
v_cvt_pk_bf16_f32 v84,v84,v85
v_cvt_pk_bf16_f32 v85,v86,v87
v_mfma_f32_16x16x32_bf16 a[88:91],v[136:139],v[52:55],a[88:91]
ds_write_b64 v37,v[84:85] offset:18432
v_mfma_f32_16x16x32_bf16 v[204:207],v[140:143],v[40:43],v[204:207]
s_waitcnt lgkmcnt(5)
buffer_store_dwordx4 v[156:159],v9,s[16:19],s87 offen offset:0 nt
v_add_u32 v37,v37,v19
v_accvgpr_read_b32 v84,a16
v_accvgpr_read_b32 v85,a17
v_mfma_f32_16x16x32_bf16 v[252:255],v[140:143],v[44:47],v[252:255]
v_accvgpr_read_b32 v86,a18
v_accvgpr_read_b32 v92,a88
v_mfma_f32_16x16x32_bf16 a[44:47],v[140:143],v[48:51],a[44:47]
s_waitcnt lgkmcnt(2)
v_accvgpr_read_b32 v93,a89
v_accvgpr_read_b32 v94,a90
buffer_store_dwordx4 v[104:107],v9,s[16:19],s87 offen offset:3072 nt
v_pk_mul_f32 v[92:93],v[92:93],v[66:67] op_sel_hi:[1,0]
v_accvgpr_read_b32 v95,a91
v_pk_mul_f32 v[94:95],v[94:95],v[66:67] op_sel_hi:[1,0]
v_cvt_pk_bf16_f32 v92,v92,v93
v_cvt_pk_bf16_f32 v93,v94,v95
v_mfma_f32_16x16x32_bf16 a[92:95],v[140:143],v[52:55],a[92:95]
v_accvgpr_read_b32 v87,a19
v_accvgpr_read_b32 v104,a4
ds_write_b64 v38,v[92:93] offset:18432
buffer_store_dwordx4 v[108:111],v9,s[16:19],s87 offen offset:128 nt
v_add_u32 v38,v38,v19
v_accvgpr_read_b32 v105,a5
v_accvgpr_read_b32 v106,a6
v_accvgpr_read_b32 v107,a7
v_accvgpr_read_b32 v96,a92
s_waitcnt vmcnt(9)
s_barrier
ds_read_b128 v[112:115],v0 offset:0
ds_read_b128 v[116:119],v1 offset:0
buffer_store_dwordx4 v[76:79],v9,s[16:19],s87 offen offset:3200 nt
ds_read_b128 v[120:123],v0 offset:128
v_accvgpr_read_b32 v97,a93
ds_read_b128 v[124:127],v1 offset:128
v_accvgpr_read_b32 v98,a94
ds_read_b128 v[128:131],v0 offset:256
v_accvgpr_read_b32 v99,a95
ds_read_b128 v[132:135],v1 offset:256
buffer_load_dwordx4 v6,s[8:11],s25 offen offset:0 lds
ds_read_b128 v[136:139],v0 offset:6144
ds_read_b128 v[140:143],v1 offset:6144
v_accvgpr_read_b32 v76,a0
v_accvgpr_read_b32 v77,a1
v_accvgpr_read_b32 v78,a2
v_accvgpr_read_b32 v79,a3
v_accvgpr_read_b32 v94,a10
v_accvgpr_read_b32 v95,a11
v_accvgpr_read_b32 v92,a8
v_accvgpr_read_b32 v93,a9
s_waitcnt lgkmcnt(7)
v_mfma_f32_16x16x32_bf16 v[72:75],v[112:115],a[144:147],0
v_accvgpr_read_b32 v108,a20
v_accvgpr_read_b32 v109,a21
v_mfma_f32_16x16x32_bf16 v[80:83],v[112:115],a[168:171],0
v_accvgpr_read_b32 v110,a22
v_accvgpr_read_b32 v111,a23
v_mfma_f32_16x16x32_bf16 v[88:91],v[112:115],a[192:195],0
ds_read_b128 v[112:115],v0 offset:6272
v_mov_b32 v71,0
v_pk_mul_f32 v[96:97],v[96:97],v[66:67] op_sel_hi:[1,0]
v_pk_mul_f32 v[98:99],v[98:99],v[66:67] op_sel_hi:[1,0]
buffer_load_dwordx4 v7,s[8:11],s25 offen offset:1024 lds
v_pk_mul_f32 v[76:77],v[76:77],v[64:65] op_sel_hi:[1,0]
v_pk_mul_f32 v[84:85],v[84:85],v[64:65] op_sel_hi:[1,0]
v_pk_mul_f32 v[78:79],v[78:79],v[64:65] op_sel_hi:[1,0]
v_pk_mul_f32 v[86:87],v[86:87],v[64:65] op_sel_hi:[1,0]
v_pk_mul_f32 v[104:105],v[104:105],v[64:65] op_sel_hi:[1,0]
v_pk_mul_f32 v[106:107],v[106:107],v[64:65] op_sel_hi:[1,0]
v_pk_mul_f32 v[108:109],v[108:109],v[64:65] op_sel_hi:[1,0]
v_pk_mul_f32 v[110:111],v[110:111],v[64:65] op_sel_hi:[1,0]
v_pk_mul_f32 v[92:93],v[92:93],v[64:65] op_sel_hi:[1,0]
v_pk_mul_f32 v[94:95],v[94:95],v[64:65] op_sel_hi:[1,0]
v_cvt_pk_bf16_f32 v96,v96,v97
v_cvt_pk_bf16_f32 v97,v98,v99
ds_write_b64 v39,v[96:97] offset:18432
ds_read_b128 v[100:103],v10 offset:18432
ds_read_b128 v[156:159],v10 offset:19456
v_add_u32 v39,v39,v19
v_cvt_pk_bf16_f32 v76,v76,v77
v_cvt_pk_bf16_f32 v84,v84,v85
v_cvt_pk_bf16_f32 v77,v78,v79
v_cvt_pk_bf16_f32 v85,v86,v87
ds_write2st64_b64 v36,v[76:77],v[84:85] offset0:24 offset1:26
v_accvgpr_read_b32 v98,a26
v_accvgpr_read_b32 v99,a27
v_pk_mul_f32 v[98:99],v[98:99],v[64:65] op_sel_hi:[1,0]
buffer_load_dwordx4 v8,s[8:11],s25 offen offset:2048 lds
v_accvgpr_read_b32 v96,a24
v_accvgpr_read_b32 v97,a25
v_pk_mul_f32 v[96:97],v[96:97],v[64:65] op_sel_hi:[1,0]
v_accvgpr_read_b32 v78,a14
v_accvgpr_read_b32 v79,a15
v_pk_mul_f32 v[78:79],v[78:79],v[64:65] op_sel_hi:[1,0]
v_accvgpr_read_b32 v86,a30
v_accvgpr_read_b32 v87,a31
v_pk_mul_f32 v[86:87],v[86:87],v[64:65] op_sel_hi:[1,0]
v_accvgpr_read_b32 v76,a12
s_waitcnt lgkmcnt(2)
buffer_store_dwordx4 v[100:103],v9,s[16:19],s87 offen offset:256 nt
v_accvgpr_read_b32 v77,a13
v_pk_mul_f32 v[76:77],v[76:77],v[64:65] op_sel_hi:[1,0]
v_accvgpr_read_b32 v84,a28
v_accvgpr_read_b32 v85,a29
v_pk_mul_f32 v[84:85],v[84:85],v[64:65] op_sel_hi:[1,0]
v_accvgpr_read_b32 v100,a32
v_accvgpr_read_b32 v101,a33
v_mfma_f32_16x16x32_bf16 v[72:75],v[116:119],a[148:151],v[72:75]
s_waitcnt vmcnt(17)
ds_read_b128 a[216:219],v11 offset:0
ds_read_b128 a[220:223],v12 offset:0
s_waitcnt lgkmcnt(2)
buffer_store_dwordx4 v[156:159],v9,s[16:19],s87 offen offset:3328 nt
ds_read_b128 a[224:227],v11 offset:128
v_pk_mul_f32 v[100:101],v[100:101],v[64:65] op_sel_hi:[1,0]
ds_read_b128 a[228:231],v12 offset:128
v_pk_mul_f32 v[160:161],v[160:161],v[60:61] op_sel_hi:[1,0]
ds_read_b128 a[232:235],v11 offset:256
v_pk_mul_f32 v[162:163],v[162:163],v[60:61] op_sel_hi:[1,0]
ds_read_b128 a[236:239],v12 offset:256
v_accvgpr_read_b32 v102,a34
v_accvgpr_read_b32 v103,a35
v_pk_mul_f32 v[102:103],v[102:103],v[64:65] op_sel_hi:[1,0]
v_cvt_pk_bf16_f32 v104,v104,v105
v_cvt_pk_bf16_f32 v108,v108,v109
v_mfma_f32_16x16x32_bf16 v[80:83],v[116:119],a[172:175],v[80:83]
s_add_u32 m0,s23,24576
v_cvt_pk_bf16_f32 v105,v106,v107
v_cvt_pk_bf16_f32 v109,v110,v111
v_mfma_f32_16x16x32_bf16 v[88:91],v[116:119],a[196:199],v[88:91]
buffer_load_dwordx4 v6,s[8:11],s21 offen offset:0 lds
v_mfma_f32_16x16x32_bf16 v[72:75],v[120:123],a[152:155],v[72:75]
ds_write2st64_b64 v37,v[104:105],v[108:109] offset0:24 offset1:26
v_mfma_f32_16x16x32_bf16 v[80:83],v[120:123],a[176:179],v[80:83]
v_accvgpr_read_b32 v106,a38
ds_read_b128 v[116:119],v1 offset:6272
buffer_load_dwordx4 v7,s[8:11],s21 offen offset:1024 lds
v_pk_mul_f32 v[164:165],v[164:165],v[60:61] op_sel_hi:[1,0]
v_pk_mul_f32 v[166:167],v[166:167],v[60:61] op_sel_hi:[1,0]
v_accvgpr_read_b32 v107,a39
v_pk_mul_f32 v[106:107],v[106:107],v[64:65] op_sel_hi:[1,0]
v_accvgpr_read_b32 v104,a36
v_accvgpr_read_b32 v105,a37
v_pk_mul_f32 v[104:105],v[104:105],v[64:65] op_sel_hi:[1,0]
v_accvgpr_read_b32 v110,a42
v_accvgpr_read_b32 v111,a43
v_mfma_f32_16x16x32_bf16 v[88:91],v[120:123],a[200:203],v[88:91]
ds_read_b128 v[120:123],v0 offset:6400
v_accvgpr_read_b32 v108,a40
v_mfma_f32_16x16x32_bf16 v[72:75],v[124:127],a[156:159],v[72:75]
v_accvgpr_read_b32 v109,a41
v_cvt_pk_bf16_f32 v92,v92,v93
v_mfma_f32_16x16x32_bf16 v[80:83],v[124:127],a[180:183],v[80:83]
v_cvt_pk_bf16_f32 v96,v96,v97
v_cvt_pk_bf16_f32 v93,v94,v95
v_mfma_f32_16x16x32_bf16 v[88:91],v[124:127],a[204:207],v[88:91]
ds_read_b128 v[124:127],v1 offset:6400
v_cvt_pk_bf16_f32 v97,v98,v99
ds_write2st64_b64 v38,v[92:93],v[96:97] offset0:24 offset1:26
v_pk_mul_f32 v[108:109],v[108:109],v[64:65] op_sel_hi:[1,0]
v_pk_mul_f32 v[110:111],v[110:111],v[64:65] op_sel_hi:[1,0]
v_pk_mul_f32 v[168:169],v[168:169],v[60:61] op_sel_hi:[1,0]
v_pk_mul_f32 v[170:171],v[170:171],v[60:61] op_sel_hi:[1,0]
v_accvgpr_read_b32 v98,a46
v_accvgpr_read_b32 v99,a47
v_mfma_f32_16x16x32_bf16 v[72:75],v[128:131],a[160:163],v[72:75]
v_accvgpr_read_b32 v96,a44
v_accvgpr_read_b32 v97,a45
v_mfma_f32_16x16x32_bf16 v[80:83],v[128:131],a[184:187],v[80:83]
v_cvt_pk_bf16_f32 v76,v76,v77
v_cvt_pk_bf16_f32 v84,v84,v85
v_mfma_f32_16x16x32_bf16 v[88:91],v[128:131],a[208:211],v[88:91]
buffer_load_dwordx4 v8,s[8:11],s21 offen offset:2048 lds
v_mfma_f32_16x16x32_bf16 v[72:75],v[132:135],a[164:167],v[72:75]
s_add_u32 s21,s21,12288
ds_read_b128 v[128:131],v0 offset:0
v_cvt_pk_bf16_f32 v77,v78,v79
v_cvt_pk_bf16_f32 v85,v86,v87
ds_write2st64_b64 v39,v[76:77],v[84:85] offset0:24 offset1:26
v_pk_mul_f32 v[96:97],v[96:97],v[64:65] op_sel_hi:[1,0]
v_pk_mul_f32 v[98:99],v[98:99],v[64:65] op_sel_hi:[1,0]
v_pk_mul_f32 v[172:173],v[172:173],v[60:61] op_sel_hi:[1,0]
v_pk_mul_f32 v[174:175],v[174:175],v[60:61] op_sel_hi:[1,0]
v_cvt_pk_bf16_f32 v100,v100,v101
v_cvt_pk_bf16_f32 v160,v160,v161
v_mfma_f32_16x16x32_bf16 v[80:83],v[132:135],a[188:191],v[80:83]
s_mov_b32 s27,s42
v_cvt_pk_bf16_f32 v164,v164,v165
v_cvt_pk_bf16_f32 v104,v104,v105
v_mfma_f32_16x16x32_bf16 v[88:91],v[132:135],a[212:215],v[88:91]
s_waitcnt vmcnt(12)
ds_read_b128 a[240:243],v11 offset:6144
v_cvt_pk_bf16_f32 v101,v102,v103
v_mfma_f32_16x16x32_bf16 v[76:79],v[136:139],a[144:147],0
s_mov_b32 s42,s41
ds_read_b128 a[244:247],v12 offset:6144
ds_read_b128 a[248:251],v11 offset:6272
v_cvt_pk_bf16_f32 v161,v162,v163
ds_read_b128 a[252:255],v12 offset:6272
v_pk_mul_f32 v[176:177],v[176:177],v[60:61] op_sel_hi:[1,0]
ds_read_b128 v[144:147],v11 offset:6400
v_pk_mul_f32 v[178:179],v[178:179],v[60:61] op_sel_hi:[1,0]
ds_read_b128 v[148:151],v12 offset:6400
v_pk_mul_f32 v[192:193],v[192:193],v[60:61] op_sel_hi:[1,0]
ds_write2st64_b64 v36,v[100:101],v[160:161] offset0:28 offset1:0
v_pk_mul_f32 v[194:195],v[194:195],v[60:61] op_sel_hi:[1,0]
v_cvt_pk_bf16_f32 v108,v108,v109
v_cvt_pk_bf16_f32 v168,v168,v169
ds_read_b128 v[132:135],v1 offset:0
v_mfma_f32_16x16x32_bf16 v[84:87],v[136:139],a[168:171],0
s_add_u32 s69,s69,1
v_cvt_pk_bf16_f32 v165,v166,v167
v_cvt_pk_bf16_f32 v105,v106,v107
v_mfma_f32_16x16x32_bf16 v[92:95],v[136:139],a[192:195],0
s_lshl_b32 s62,s69,5
ds_read_b128 v[136:139],v0 offset:128
v_cvt_pk_bf16_f32 v96,v96,v97
v_mfma_f32_16x16x32_bf16 v[76:79],v[140:143],a[148:151],v[76:79]
s_add_u32 s62,s62,s34
ds_write2st64_b64 v37,v[104:105],v[164:165] offset0:28 offset1:0
v_mfma_f32_16x16x32_bf16 v[84:87],v[140:143],a[172:175],v[84:87]
s_mul_i32 s63,s62,171
v_cvt_pk_bf16_f32 v172,v172,v173
v_cvt_pk_bf16_f32 v109,v110,v111
v_cvt_pk_bf16_f32 v169,v170,v171
v_cvt_pk_bf16_f32 v97,v98,v99
v_cvt_pk_bf16_f32 v173,v174,v175
v_pk_mul_f32 v[180:181],v[180:181],v[60:61] op_sel_hi:[1,0]
v_pk_mul_f32 v[182:183],v[182:183],v[60:61] op_sel_hi:[1,0]
v_pk_mul_f32 v[196:197],v[196:197],v[60:61] op_sel_hi:[1,0]
v_pk_mul_f32 v[198:199],v[198:199],v[60:61] op_sel_hi:[1,0]
v_max3_f32 v40,v72,v73,v74
v_max3_f32 v44,v80,v81,v82
v_mfma_f32_16x16x32_bf16 v[92:95],v[140:143],a[196:199],v[92:95]
s_lshr_b32 s63,s63,9
ds_write2st64_b64 v38,v[108:109],v[168:169] offset0:28 offset1:0
v_mfma_f32_16x16x32_bf16 v[76:79],v[112:115],a[152:155],v[76:79]
s_mul_i32 s64,s63,3
v_max3_f32 v48,v88,v89,v90
v_cvt_pk_bf16_f32 v176,v176,v177
v_mfma_f32_16x16x32_bf16 v[84:87],v[112:115],a[176:179],v[84:87]
s_sub_u32 s62,s62,s64
ds_read_b128 v[140:143],v1 offset:128
v_cvt_pk_bf16_f32 v192,v192,v193
v_mfma_f32_16x16x32_bf16 v[92:95],v[112:115],a[200:203],v[92:95]
s_add_u32 s63,s63,s33
ds_read_b128 v[112:115],v0 offset:256
ds_write2st64_b64 v39,v[96:97],v[172:173] offset0:28 offset1:0
v_pk_mul_f32 v[184:185],v[184:185],v[60:61] op_sel_hi:[1,0]
v_pk_mul_f32 v[186:187],v[186:187],v[60:61] op_sel_hi:[1,0]
v_pk_mul_f32 v[200:201],v[200:201],v[60:61] op_sel_hi:[1,0]
v_pk_mul_f32 v[202:203],v[202:203],v[60:61] op_sel_hi:[1,0]
v_cvt_pk_bf16_f32 v180,v180,v181
v_cvt_pk_bf16_f32 v196,v196,v197
s_waitcnt lgkmcnt(4)
v_mfma_f32_16x16x32_bf16 v[76:79],v[116:119],a[156:159],v[76:79]
s_mul_i32 s30,s63,196608
v_cvt_pk_bf16_f32 v177,v178,v179
v_cvt_pk_bf16_f32 v193,v194,v195
v_mfma_f32_16x16x32_bf16 v[84:87],v[116:119],a[180:183],v[84:87]
s_mul_i32 s41,s63,325632
v_cvt_pk_bf16_f32 v184,v184,v185
v_cvt_pk_bf16_f32 v200,v200,v201
v_mfma_f32_16x16x32_bf16 v[92:95],v[116:119],a[204:207],v[92:95]
s_lshl_b32 s63,s3,2
ds_write2st64_b64 v36,v[176:177],v[192:193] offset0:2 offset1:4
v_pk_mul_f32 v[188:189],v[188:189],v[60:61] op_sel_hi:[1,0]
v_pk_mul_f32 v[190:191],v[190:191],v[60:61] op_sel_hi:[1,0]
v_pk_mul_f32 v[204:205],v[204:205],v[60:61] op_sel_hi:[1,0]
ds_read_b128 v[116:119],v1 offset:256
v_pk_mul_f32 v[206:207],v[206:207],v[60:61] op_sel_hi:[1,0]
v_cvt_pk_bf16_f32 v181,v182,v183
v_cvt_pk_bf16_f32 v197,v198,v199
v_mfma_f32_16x16x32_bf16 v[76:79],v[120:123],a[160:163],v[76:79]
s_add_u32 s64,s63,21
v_cvt_pk_bf16_f32 v185,v186,v187
v_cvt_pk_bf16_f32 v201,v202,v203
v_mfma_f32_16x16x32_bf16 v[84:87],v[120:123],a[184:187],v[84:87]
s_cmp_eq_u32 s3,0
ds_write2st64_b64 v37,v[180:181],v[196:197] offset0:2 offset1:4
v_mfma_f32_16x16x32_bf16 v[92:95],v[120:123],a[208:211],v[92:95]
s_cselect_b32 s64,20,s64
v_cvt_pk_bf16_f32 v188,v188,v189
v_cvt_pk_bf16_f32 v204,v204,v205
v_mfma_f32_16x16x32_bf16 v[76:79],v[124:127],a[164:167],v[76:79]
s_cselect_b32 s40,1,0
ds_read_b128 v[120:123],v0 offset:6144
v_cvt_pk_bf16_f32 v189,v190,v191
v_cvt_pk_bf16_f32 v205,v206,v207
v_mov_b32 v66,0
v_mov_b32 v67,0
ds_write2st64_b64 v38,v[184:185],v[200:201] offset0:2 offset1:4
v_pk_mul_f32 v[208:209],v[208:209],v[62:63] op_sel_hi:[1,0]
v_pk_mul_f32 v[210:211],v[210:211],v[62:63] op_sel_hi:[1,0]
v_pk_mul_f32 v[224:225],v[224:225],v[62:63] op_sel_hi:[1,0]
v_pk_mul_f32 v[226:227],v[226:227],v[62:63] op_sel_hi:[1,0]
v_max3_f32 v40,v40,v75,v76
v_max3_f32 v40,v40,v77,v78
v_mfma_f32_16x16x32_bf16 v[84:87],v[124:127],a[188:191],v[84:87]
s_add_u32 s65,s63,37
v_max_f32 v40,v40,v79
v_mov_b32 v41,v40
v_mfma_f32_16x16x32_bf16 v[92:95],v[124:127],a[212:215],v[92:95]
s_cmp_eq_u32 s62,2
ds_read_b128 v[124:127],v1 offset:6144
v_permlane32_swap_b32 v41,v40
v_mfma_f32_16x16x32_bf16 v[96:99],v[128:131],a[216:219],0
s_cselect_b32 s64,s65,s64
ds_write2st64_b64 v39,v[188:189],v[204:205] offset0:2 offset1:4
v_mfma_f32_16x16x32_bf16 v[104:107],v[128:131],a[240:243],0
s_cselect_b32 s40,0,s40
v_max3_f32 v44,v44,v83,v84
ds_read_b128 v[128:131],v0 offset:6272
v_max_f32 v40,v40,v41
v_pk_mul_f32 v[212:213],v[212:213],v[62:63] op_sel_hi:[1,0]
v_pk_mul_f32 v[214:215],v[214:215],v[62:63] op_sel_hi:[1,0]
v_pk_mul_f32 v[228:229],v[228:229],v[62:63] op_sel_hi:[1,0]
v_pk_mul_f32 v[230:231],v[230:231],v[62:63] op_sel_hi:[1,0]
v_max3_f32 v44,v44,v85,v86
v_mov_b32 v41,v40
v_mfma_f32_16x16x32_bf16 v[96:99],v[132:135],a[220:223],v[96:99]
s_add_u32 s65,s63,s3
v_max_f32 v44,v44,v87
v_permlane16_swap_b32 v41,v40
v_mfma_f32_16x16x32_bf16 v[104:107],v[132:135],a[244:247],v[104:107]
s_cmp_eq_u32 s62,0
ds_read_b128 v[132:135],v1 offset:6272
v_mov_b32 v45,v44
v_mfma_f32_16x16x32_bf16 v[96:99],v[136:139],a[224:227],v[96:99]
s_cselect_b32 s64,s65,s64
v_max3_f32 v48,v48,v91,v92
v_max_f32 v40,v40,v41
v_permlane32_swap_b32 v45,v44
v_max3_f32 v48,v48,v93,v94
v_pk_mul_f32 v[216:217],v[216:217],v[62:63] op_sel_hi:[1,0]
v_pk_mul_f32 v[218:219],v[218:219],v[62:63] op_sel_hi:[1,0]
v_pk_mul_f32 v[232:233],v[232:233],v[62:63] op_sel_hi:[1,0]
v_pk_mul_f32 v[234:235],v[234:235],v[62:63] op_sel_hi:[1,0]
v_mul_f32_e64 v13,-s36,v40
v_max_f32 v44,v44,v45
v_mfma_f32_16x16x32_bf16 v[104:107],v[136:139],a[248:251],v[104:107]
s_cselect_b32 s40,1,s40
ds_read_b128 v[136:139],v0 offset:6400
v_max_f32 v48,v48,v95
s_waitcnt lgkmcnt(3)
v_mfma_f32_16x16x32_bf16 v[96:99],v[140:143],a[228:231],v[96:99]
s_mul_i32 s64,s64,6144
v_fma_f32 v72,v72,s36,v13
v_fma_f32 v73,v73,s36,v13
v_mfma_f32_16x16x32_bf16 v[104:107],v[140:143],a[252:255],v[104:107]
s_add_u32 s41,s41,s64
ds_read_b128 v[140:143],v1 offset:6400
v_fma_f32 v74,v74,s36,v13
v_mfma_f32_16x16x32_bf16 v[96:99],v[112:115],a[232:235],v[96:99]
s_cmp_ge_u32 s69,6
v_fma_f32 v75,v75,s36,v13
v_mov_b32 v45,v44
v_mov_b32 v49,v48
v_exp_f32 v72,v72
v_pk_mul_f32 v[220:221],v[220:221],v[62:63] op_sel_hi:[1,0]
v_pk_mul_f32 v[222:223],v[222:223],v[62:63] op_sel_hi:[1,0]
v_pk_mul_f32 v[236:237],v[236:237],v[62:63] op_sel_hi:[1,0]
v_pk_mul_f32 v[238:239],v[238:239],v[62:63] op_sel_hi:[1,0]
v_exp_f32 v73,v73
v_exp_f32 v74,v74
v_mfma_f32_16x16x32_bf16 v[104:107],v[112:115],v[144:147],v[104:107]
s_cselect_b32 s41,166723584,s41
ds_read_b128 v[112:115],v0 offset:12544
v_exp_f32 v75,v75
v_mfma_f32_16x16x32_bf16 v[96:99],v[116:119],a[236:239],v[96:99]
s_cselect_b32 s30,100663296,s30
v_permlane16_swap_b32 v45,v44
v_mfma_f32_16x16x32_bf16 v[104:107],v[116:119],v[148:151],v[104:107]
s_add_u32 s25,s30,s22
ds_read_b128 v[116:119],v1 offset:12544
v_permlane32_swap_b32 v49,v48
v_mfma_f32_16x16x32_bf16 v[100:103],v[120:123],a[216:219],0
s_add_u32 s26,s25,12288
v_max3_f32 v52,v96,v97,v98
v_max_f32 v44,v44,v45
v_max_f32 v48,v48,v49
v_mul_f32_e64 v14,-s36,v44
v_cvt_pk_bf16_f32 v20,v72,v73
v_pk_mul_f32 v[240:241],v[240:241],v[62:63] op_sel_hi:[1,0]
v_pk_mul_f32 v[242:243],v[242:243],v[62:63] op_sel_hi:[1,0]
v_cvt_pk_bf16_f32 v21,v74,v75
v_mov_b32 v49,v48
v_mfma_f32_16x16x32_bf16 v[108:111],v[120:123],a[240:243],0
s_add_u32 m0,s22,0
ds_read_b128 v[120:123],v0 offset:18432
v_fma_f32 v80,v80,s36,v14
v_mfma_f32_16x16x32_bf16 v[100:103],v[124:127],a[220:223],v[100:103]
s_mov_b32 s28,s41
v_fma_f32 v81,v81,s36,v14
v_fma_f32 v82,v82,s36,v14
v_mfma_f32_16x16x32_bf16 v[108:111],v[124:127],a[244:247],v[108:111]
s_mov_b32 s29,s24
ds_read_b128 v[124:127],v1 offset:18432
v_fma_f32 v83,v83,s36,v14
s_waitcnt lgkmcnt(3)
v_mfma_f32_16x16x32_bf16 v[100:103],v[128:131],a[224:227],v[100:103]
v_max3_f32 v56,v104,v105,v106
v_permlane16_swap_b32 v49,v48
v_exp_f32 v80,v80
v_pk_mul_f32 v[244:245],v[244:245],v[62:63] op_sel_hi:[1,0]
v_pk_mul_f32 v[246:247],v[246:247],v[62:63] op_sel_hi:[1,0]
v_exp_f32 v81,v81
v_exp_f32 v82,v82
v_mfma_f32_16x16x32_bf16 v[108:111],v[128:131],a[248:251],v[108:111]
ds_read_b128 v[128:131],v0 offset:12288
v_exp_f32 v83,v83
v_mfma_f32_16x16x32_bf16 v[100:103],v[132:135],a[228:231],v[100:103]
v_max_f32 v48,v48,v49
v_mul_f32_e64 v15,-s36,v48
v_mfma_f32_16x16x32_bf16 v[108:111],v[132:135],a[252:255],v[108:111]
ds_read_b128 v[132:135],v1 offset:12288
v_cvt_pk_bf16_f32 v24,v80,v81
v_cvt_pk_bf16_f32 v25,v82,v83
v_fma_f32 v88,v88,s36,v15
v_fma_f32 v89,v89,s36,v15
v_pk_mul_f32 v[248:249],v[248:249],v[62:63] op_sel_hi:[1,0]
v_pk_mul_f32 v[250:251],v[250:251],v[62:63] op_sel_hi:[1,0]
v_fma_f32 v90,v90,s36,v15
v_fma_f32 v91,v91,s36,v15
v_mfma_f32_16x16x32_bf16 v[100:103],v[136:139],a[232:235],v[100:103]
v_exp_f32 v88,v88
v_mfma_f32_16x16x32_bf16 v[108:111],v[136:139],v[144:147],v[108:111]
ds_read_b128 v[136:139],v0 offset:12416
v_exp_f32 v89,v89
v_mfma_f32_16x16x32_bf16 v[100:103],v[140:143],a[236:239],v[100:103]
v_exp_f32 v90,v90
v_mfma_f32_16x16x32_bf16 v[108:111],v[140:143],v[148:151],v[108:111]
ds_read_b128 v[140:143],v1 offset:12416
v_exp_f32 v91,v91
v_cvt_pk_bf16_f32 v208,v208,v209
v_cvt_pk_bf16_f32 v224,v224,v225
v_pk_mul_f32 v[252:253],v[252:253],v[62:63] op_sel_hi:[1,0]
v_pk_mul_f32 v[254:255],v[254:255],v[62:63] op_sel_hi:[1,0]
v_max3_f32 v52,v52,v99,v100
v_max3_f32 v52,v52,v101,v102
s_waitcnt lgkmcnt(3)
v_mfma_f32_16x16x32_bf16 v[72:75],v[128:131],a[144:147],0
v_max_f32 v52,v52,v103
v_mov_b32 v53,v52
v_mfma_f32_16x16x32_bf16 v[80:83],v[128:131],a[168:171],0
v_max3_f32 v56,v56,v107,v108
v_permlane32_swap_b32 v53,v52
v_max3_f32 v56,v56,v109,v110
v_max_f32 v52,v52,v53
v_max_f32 v56,v56,v111
v_mov_b32 v53,v52
v_mov_b32 v57,v56
v_cvt_pk_bf16_f32 v28,v88,v89
v_permlane16_swap_b32 v53,v52
v_permlane32_swap_b32 v57,v56
v_max_f32 v52,v52,v53
v_max_f32 v56,v56,v57
v_mul_f32_e64 v16,-s36,v52
v_cvt_pk_bf16_f32 v29,v90,v91
v_mfma_f32_16x16x32_bf16 v[88:91],v[128:131],a[192:195],0
v_mov_b32 v57,v56
v_fma_f32 v96,v96,s36,v16
v_fma_f32 v97,v97,s36,v16
v_fma_f32 v98,v98,s36,v16
v_fma_f32 v99,v99,s36,v16
v_cvt_pk_bf16_f32 v212,v212,v213
v_cvt_pk_bf16_f32 v228,v228,v229
v_cvt_pk_bf16_f32 v209,v210,v211
v_cvt_pk_bf16_f32 v225,v226,v227
ds_write2st64_b64 v36,v[208:209],v[224:225] offset0:12 offset1:14
v_permlane16_swap_b32 v57,v56
v_exp_f32 v96,v96
v_exp_f32 v97,v97
v_exp_f32 v98,v98
v_exp_f32 v99,v99
v_cvt_pk_bf16_f32 v216,v216,v217
v_cvt_pk_bf16_f32 v232,v232,v233
v_cvt_pk_bf16_f32 v213,v214,v215
v_cvt_pk_bf16_f32 v229,v230,v231
ds_write2st64_b64 v37,v[212:213],v[228:229] offset0:12 offset1:14
v_max_f32 v56,v56,v57
v_cvt_pk_bf16_f32 v220,v220,v221
v_cvt_pk_bf16_f32 v236,v236,v237
v_cvt_pk_bf16_f32 v217,v218,v219
v_cvt_pk_bf16_f32 v233,v234,v235
v_mul_f32_e64 v17,-s36,v56
v_cvt_pk_bf16_f32 v240,v240,v241
v_cvt_pk_bf16_f32 v32,v96,v97
v_cvt_pk_bf16_f32 v33,v98,v99
v_mfma_f32_16x16x32_bf16 v[96:99],v[128:131],a[216:219],0
v_cvt_pk_bf16_f32 v221,v222,v223
ds_write2st64_b64 v38,v[216:217],v[232:233] offset0:12 offset1:14
v_cvt_pk_bf16_f32 v237,v238,v239
v_fma_f32 v104,v104,s36,v17
v_fma_f32 v105,v105,s36,v17
v_fma_f32 v106,v106,s36,v17
v_fma_f32 v107,v107,s36,v17
v_cvt_pk_bf16_f32 v244,v244,v245
v_cvt_pk_bf16_f32 v241,v242,v243
v_exp_f32 v104,v104
v_exp_f32 v105,v105
ds_write2st64_b64 v39,v[220:221],v[236:237] offset0:12 offset1:14
v_exp_f32 v106,v106
v_exp_f32 v107,v107
v_cvt_pk_bf16_f32 v245,v246,v247
v_fma_f32 v76,v76,s36,v13
v_fma_f32 v77,v77,s36,v13
v_fma_f32 v78,v78,s36,v13
v_fma_f32 v79,v79,s36,v13
v_exp_f32 v76,v76
ds_write_b64 v36,v[240:241] offset:8192
v_cvt_pk_bf16_f32 v36,v104,v105
v_exp_f32 v77,v77
v_exp_f32 v78,v78
ds_write_b64 v37,v[244:245] offset:8192
v_cvt_pk_bf16_f32 v37,v106,v107
v_mfma_f32_16x16x32_bf16 v[104:107],v[128:131],a[240:243],0
s_waitcnt lgkmcnt(2)
ds_read_b128 v[128:131],v0 offset:18560
v_exp_f32 v79,v79
v_mfma_f32_16x16x32_bf16 v[72:75],v[132:135],a[148:151],v[72:75]
v_fma_f32 v84,v84,s36,v14
v_fma_f32 v85,v85,s36,v14
v_mfma_f32_16x16x32_bf16 v[80:83],v[132:135],a[172:175],v[80:83]
v_fma_f32 v86,v86,s36,v14
v_fma_f32 v87,v87,s36,v14
v_mfma_f32_16x16x32_bf16 v[88:91],v[132:135],a[196:199],v[88:91]
v_cvt_pk_bf16_f32 v22,v76,v77
v_cvt_pk_bf16_f32 v23,v78,v79
v_mfma_f32_16x16x32_bf16 v[96:99],v[132:135],a[220:223],v[96:99]
v_exp_f32 v84,v84
v_mfma_f32_16x16x32_bf16 v[104:107],v[132:135],a[244:247],v[104:107]
ds_read_b128 v[132:135],v1 offset:18560
v_exp_f32 v85,v85
v_mfma_f32_16x16x32_bf16 v[72:75],v[136:139],a[152:155],v[72:75]
v_exp_f32 v86,v86
v_mfma_f32_16x16x32_bf16 v[80:83],v[136:139],a[176:179],v[80:83]
v_exp_f32 v87,v87
s_waitcnt vmcnt(5)
s_barrier
v_mfma_f32_16x16x32_bf16 v[88:91],v[136:139],a[200:203],v[88:91]
buffer_load_dwordx4 v6,s[4:7],s20 offen offset:0 lds
v_mfma_f32_16x16x32_bf16 v[96:99],v[136:139],a[224:227],v[96:99]
v_fma_f32 v92,v92,s36,v15
v_fma_f32 v93,v93,s36,v15
v_mfma_f32_16x16x32_bf16 v[104:107],v[136:139],a[248:251],v[104:107]
ds_read_b128 v[136:139],v0 offset:18688
v_fma_f32 v94,v94,s36,v15
v_mfma_f32_16x16x32_bf16 v[72:75],v[140:143],a[156:159],v[72:75]
v_fma_f32 v95,v95,s36,v15
v_cvt_pk_bf16_f32 v26,v84,v85
v_mfma_f32_16x16x32_bf16 v[80:83],v[140:143],a[180:183],v[80:83]
v_cvt_pk_bf16_f32 v27,v86,v87
v_exp_f32 v92,v92
v_mfma_f32_16x16x32_bf16 v[88:91],v[140:143],a[204:207],v[88:91]
v_exp_f32 v93,v93
v_mfma_f32_16x16x32_bf16 v[96:99],v[140:143],a[228:231],v[96:99]
buffer_load_dwordx4 v7,s[4:7],s20 offen offset:1024 lds
v_mfma_f32_16x16x32_bf16 v[104:107],v[140:143],a[252:255],v[104:107]
ds_read_b128 v[140:143],v1 offset:18688
v_exp_f32 v94,v94
v_mfma_f32_16x16x32_bf16 v[72:75],v[112:115],a[160:163],v[72:75]
v_exp_f32 v95,v95
v_mfma_f32_16x16x32_bf16 v[80:83],v[112:115],a[184:187],v[80:83]
v_fma_f32 v100,v100,s36,v16
v_fma_f32 v101,v101,s36,v16
v_mfma_f32_16x16x32_bf16 v[88:91],v[112:115],a[208:211],v[88:91]
v_fma_f32 v102,v102,s36,v16
v_fma_f32 v103,v103,s36,v16
v_mfma_f32_16x16x32_bf16 v[96:99],v[112:115],a[232:235],v[96:99]
buffer_load_dwordx4 v8,s[4:7],s20 offen offset:2048 lds
v_mfma_f32_16x16x32_bf16 v[104:107],v[112:115],v[144:147],v[104:107]
s_add_u32 s20,s20,12288
ds_read_b64_tr_b16 v[112:113],v2 offset:0
ds_read_b64_tr_b16 v[114:115],v2 offset:6144
v_mfma_f32_16x16x32_bf16 v[72:75],v[116:119],a[164:167],v[72:75]
v_cvt_pk_bf16_f32 v30,v92,v93
v_cvt_pk_bf16_f32 v31,v94,v95
v_mfma_f32_16x16x32_bf16 v[80:83],v[116:119],a[188:191],v[80:83]
v_exp_f32 v100,v100
v_mfma_f32_16x16x32_bf16 v[88:91],v[116:119],a[212:215],v[88:91]
v_exp_f32 v101,v101
v_mfma_f32_16x16x32_bf16 v[96:99],v[116:119],a[236:239],v[96:99]
v_exp_f32 v102,v102
v_mfma_f32_16x16x32_bf16 v[104:107],v[116:119],v[148:151],v[104:107]
ds_read_b64_tr_b16 v[116:117],v3 offset:0
ds_read_b64_tr_b16 v[118:119],v3 offset:6144
v_mfma_f32_16x16x32_bf16 v[76:79],v[120:123],a[144:147],0
v_exp_f32 v103,v103
v_mfma_f32_16x16x32_bf16 v[84:87],v[120:123],a[168:171],0
v_cvt_pk_bf16_f32 v248,v248,v249
v_fma_f32 v108,v108,s36,v17
v_mfma_f32_16x16x32_bf16 v[92:95],v[120:123],a[192:195],0
v_fma_f32 v109,v109,s36,v17
v_fma_f32 v110,v110,s36,v17
v_fma_f32 v111,v111,s36,v17
v_cvt_pk_bf16_f32 v34,v100,v101
v_cvt_pk_bf16_f32 v35,v102,v103
v_mfma_f32_16x16x32_bf16 v[100:103],v[120:123],a[216:219],0
v_cvt_pk_bf16_f32 v252,v252,v253
v_cvt_pk_bf16_f32 v249,v250,v251
ds_write_b64 v38,v[248:249] offset:8192
v_exp_f32 v108,v108
v_exp_f32 v109,v109
v_exp_f32 v110,v110
v_exp_f32 v111,v111
v_cvt_pk_bf16_f32 v253,v254,v255
ds_write_b64 v39,v[252:253] offset:8192
v_cvt_pk_bf16_f32 v38,v108,v109
v_cvt_pk_bf16_f32 v39,v110,v111
v_mfma_f32_16x16x32_bf16 v[108:111],v[120:123],a[240:243],0
ds_read_b64_tr_b16 v[120:121],v4 offset:0
ds_read_b64_tr_b16 v[122:123],v4 offset:6144
v_smfmac_f32_16x16x64_bf16 v[68:71],v[152:155],v[32:39],v18
v_mov_b32 v64,0
v_mfma_f32_16x16x32_bf16 v[76:79],v[124:127],a[148:151],v[76:79]
v_mov_b32 v65,0
v_mov_b32 v60,0
v_mfma_f32_16x16x32_bf16 v[84:87],v[124:127],a[172:175],v[84:87]
v_mov_b32 v61,0
v_mov_b32 v62,0
v_smfmac_f32_16x16x64_bf16 v[64:67],v[152:155],v[28:35],v18
v_mov_b32 v63,0
v_mfma_f32_16x16x32_bf16 v[92:95],v[124:127],a[196:199],v[92:95]
v_fma_f32 v72,v72,s36,v13
v_fma_f32 v73,v73,s36,v13
v_smfmac_f32_16x16x64_bf16 v[60:63],v[152:155],v[20:27],v18
v_fma_f32 v74,v74,s36,v13
v_mfma_f32_16x16x32_bf16 v[100:103],v[124:127],a[220:223],v[100:103]
v_fma_f32 v75,v75,s36,v13
v_fma_f32 v80,v80,s36,v14
v_mfma_f32_16x16x32_bf16 v[108:111],v[124:127],a[244:247],v[108:111]
s_waitcnt lgkmcnt(2)
ds_read_b64_tr_b16 v[124:125],v5 offset:0
ds_read_b64_tr_b16 v[126:127],v5 offset:6144
v_mfma_f32_16x16x32_bf16 v[76:79],v[128:131],a[152:155],v[76:79]
v_fma_f32 v81,v81,s36,v14
v_fma_f32 v82,v82,s36,v14
v_mfma_f32_16x16x32_bf16 v[84:87],v[128:131],a[176:179],v[84:87]
v_fma_f32 v83,v83,s36,v14
v_fma_f32 v88,v88,s36,v15
v_mfma_f32_16x16x32_bf16 v[92:95],v[128:131],a[200:203],v[92:95]
v_fma_f32 v89,v89,s36,v15
v_exp_f32 v72,v72
v_mfma_f32_16x16x32_bf16 v[100:103],v[128:131],a[224:227],v[100:103]
v_exp_f32 v73,v73
v_mfma_f32_16x16x32_bf16 v[108:111],v[128:131],a[248:251],v[108:111]
v_exp_f32 v74,v74
v_mfma_f32_16x16x32_bf16 v[76:79],v[132:135],a[156:159],v[76:79]
v_exp_f32 v75,v75
v_mfma_f32_16x16x32_bf16 v[84:87],v[132:135],a[180:183],v[84:87]
v_exp_f32 v80,v80
v_mfma_f32_16x16x32_bf16 v[92:95],v[132:135],a[204:207],v[92:95]
v_exp_f32 v81,v81
v_mfma_f32_16x16x32_bf16 v[100:103],v[132:135],a[228:231],v[100:103]
v_exp_f32 v82,v82
v_mfma_f32_16x16x32_bf16 v[108:111],v[132:135],a[252:255],v[108:111]
v_exp_f32 v83,v83
v_mfma_f32_16x16x32_bf16 v[76:79],v[136:139],a[160:163],v[76:79]
v_exp_f32 v88,v88
v_mfma_f32_16x16x32_bf16 v[84:87],v[136:139],a[184:187],v[84:87]
v_exp_f32 v89,v89
v_mfma_f32_16x16x32_bf16 v[92:95],v[136:139],a[208:211],v[92:95]
v_cvt_pk_bf16_f32 v40,v72,v73
v_cvt_pk_bf16_f32 v41,v74,v75
v_mfma_f32_16x16x32_bf16 v[100:103],v[136:139],a[232:235],v[100:103]
v_cvt_pk_bf16_f32 v44,v80,v81
v_cvt_pk_bf16_f32 v45,v82,v83
v_mfma_f32_16x16x32_bf16 v[108:111],v[136:139],v[144:147],v[108:111]
v_cvt_pk_bf16_f32 v48,v88,v89
v_mfma_f32_16x16x32_bf16 v[76:79],v[140:143],a[164:167],v[76:79]
v_mfma_f32_16x16x32_bf16 v[84:87],v[140:143],a[188:191],v[84:87]
v_mfma_f32_16x16x32_bf16 v[92:95],v[140:143],a[212:215],v[92:95]
v_mfma_f32_16x16x32_bf16 v[100:103],v[140:143],a[236:239],v[100:103]
v_mfma_f32_16x16x32_bf16 v[108:111],v[140:143],v[148:151],v[108:111]
v_mfma_f32_16x16x32_bf16 v[160:163],v[112:115],v[20:23],0
s_add_u32 m0,s23,0
ds_read_b64_tr_b16 v[128:129],v2 offset:128
ds_read_b64_tr_b16 v[130:131],v2 offset:6272
v_mfma_f32_16x16x32_bf16 v[208:211],v[112:115],v[24:27],0
ds_read_b64_tr_b16 v[132:133],v3 offset:128
ds_read_b64_tr_b16 v[134:135],v3 offset:6272
v_mfma_f32_16x16x32_bf16 a[0:3],v[112:115],v[28:31],0
ds_read_b64_tr_b16 v[136:137],v4 offset:128
ds_read_b64_tr_b16 v[138:139],v4 offset:6272
v_mfma_f32_16x16x32_bf16 a[48:51],v[112:115],v[32:35],0
ds_read_b64_tr_b16 v[140:141],v5 offset:128
ds_read_b64_tr_b16 v[142:143],v5 offset:6272
v_mfma_f32_16x16x32_bf16 a[96:99],v[112:115],v[36:39],0
ds_read_b64_tr_b16 v[112:113],v2 offset:256
ds_read_b64_tr_b16 v[114:115],v2 offset:6400
v_mfma_f32_16x16x32_bf16 v[164:167],v[116:119],v[20:23],0
v_fma_f32 v90,v90,s36,v15
v_fma_f32 v91,v91,s36,v15
v_mfma_f32_16x16x32_bf16 v[212:215],v[116:119],v[24:27],0
v_exp_f32 v90,v90
v_mfma_f32_16x16x32_bf16 a[4:7],v[116:119],v[28:31],0
v_exp_f32 v91,v91
v_mfma_f32_16x16x32_bf16 a[52:55],v[116:119],v[32:35],0
v_cvt_pk_bf16_f32 v49,v90,v91
v_fma_f32 v96,v96,s36,v16
v_mfma_f32_16x16x32_bf16 a[100:103],v[116:119],v[36:39],0
s_waitcnt lgkmcnt(8)
ds_read_b64_tr_b16 v[116:117],v3 offset:256
ds_read_b64_tr_b16 v[118:119],v3 offset:6400
v_mfma_f32_16x16x32_bf16 v[168:171],v[120:123],v[20:23],0
v_fma_f32 v97,v97,s36,v16
v_fma_f32 v98,v98,s36,v16
v_mfma_f32_16x16x32_bf16 v[216:219],v[120:123],v[24:27],0
v_fma_f32 v99,v99,s36,v16
v_fma_f32 v104,v104,s36,v17
v_mfma_f32_16x16x32_bf16 a[8:11],v[120:123],v[28:31],0
v_exp_f32 v96,v96
v_mfma_f32_16x16x32_bf16 a[56:59],v[120:123],v[32:35],0
v_exp_f32 v97,v97
v_mfma_f32_16x16x32_bf16 a[104:107],v[120:123],v[36:39],0
ds_read_b64_tr_b16 v[120:121],v4 offset:256
ds_read_b64_tr_b16 v[122:123],v4 offset:6400
v_mfma_f32_16x16x32_bf16 v[172:175],v[124:127],v[20:23],0
v_exp_f32 v98,v98
v_mfma_f32_16x16x32_bf16 v[220:223],v[124:127],v[24:27],0
v_exp_f32 v99,v99
v_mfma_f32_16x16x32_bf16 a[12:15],v[124:127],v[28:31],0
v_cvt_pk_bf16_f32 v52,v96,v97
v_cvt_pk_bf16_f32 v53,v98,v99
v_mfma_f32_16x16x32_bf16 a[60:63],v[124:127],v[32:35],0
v_fma_f32 v105,v105,s36,v17
v_fma_f32 v106,v106,s36,v17
v_mfma_f32_16x16x32_bf16 a[108:111],v[124:127],v[36:39],0
ds_read_b64_tr_b16 v[124:125],v5 offset:256
ds_read_b64_tr_b16 v[126:127],v5 offset:6400
v_mfma_f32_16x16x32_bf16 v[176:179],v[128:131],v[20:23],0
v_fma_f32 v107,v107,s36,v17
v_fma_f32 v76,v76,s36,v13
v_mfma_f32_16x16x32_bf16 v[224:227],v[128:131],v[24:27],0
v_exp_f32 v104,v104
v_mfma_f32_16x16x32_bf16 a[16:19],v[128:131],v[28:31],0
v_exp_f32 v105,v105
v_mfma_f32_16x16x32_bf16 a[64:67],v[128:131],v[32:35],0
v_exp_f32 v106,v106
v_mfma_f32_16x16x32_bf16 a[112:115],v[128:131],v[36:39],0
s_waitcnt lgkmcnt(2)
v_exp_f32 v107,v107
v_mfma_f32_16x16x32_bf16 v[180:183],v[132:135],v[20:23],0
v_cvt_pk_bf16_f32 v56,v104,v105
v_cvt_pk_bf16_f32 v57,v106,v107
v_mfma_f32_16x16x32_bf16 v[228:231],v[132:135],v[24:27],0
v_fma_f32 v77,v77,s36,v13
v_fma_f32 v78,v78,s36,v13
v_mfma_f32_16x16x32_bf16 a[20:23],v[132:135],v[28:31],0
v_fma_f32 v79,v79,s36,v13
v_fma_f32 v84,v84,s36,v14
v_mfma_f32_16x16x32_bf16 a[68:71],v[132:135],v[32:35],0
v_exp_f32 v76,v76
v_mfma_f32_16x16x32_bf16 a[116:119],v[132:135],v[36:39],0
v_exp_f32 v77,v77
v_mfma_f32_16x16x32_bf16 v[184:187],v[136:139],v[20:23],0
v_exp_f32 v78,v78
v_mfma_f32_16x16x32_bf16 v[232:235],v[136:139],v[24:27],0
v_exp_f32 v79,v79
v_mfma_f32_16x16x32_bf16 a[24:27],v[136:139],v[28:31],0
v_cvt_pk_bf16_f32 v42,v76,v77
v_cvt_pk_bf16_f32 v43,v78,v79
v_mfma_f32_16x16x32_bf16 a[72:75],v[136:139],v[32:35],0
v_fma_f32 v85,v85,s36,v14
v_fma_f32 v86,v86,s36,v14
v_mfma_f32_16x16x32_bf16 a[120:123],v[136:139],v[36:39],0
v_fma_f32 v87,v87,s36,v14
v_fma_f32 v92,v92,s36,v15
v_mfma_f32_16x16x32_bf16 v[188:191],v[140:143],v[20:23],0
v_exp_f32 v84,v84
v_mfma_f32_16x16x32_bf16 v[236:239],v[140:143],v[24:27],0
v_exp_f32 v85,v85
v_mfma_f32_16x16x32_bf16 a[28:31],v[140:143],v[28:31],0
v_exp_f32 v86,v86
v_mfma_f32_16x16x32_bf16 a[76:79],v[140:143],v[32:35],0
v_exp_f32 v87,v87
v_mfma_f32_16x16x32_bf16 a[124:127],v[140:143],v[36:39],0
v_cvt_pk_bf16_f32 v46,v84,v85
v_cvt_pk_bf16_f32 v47,v86,v87
v_mfma_f32_16x16x32_bf16 v[192:195],v[112:115],v[20:23],0
v_fma_f32 v93,v93,s36,v15
v_fma_f32 v94,v94,s36,v15
v_smfmac_f32_16x16x64_bf16 v[60:63],v[152:155],v[40:47],v18
v_fma_f32 v95,v95,s36,v15
s_waitcnt vmcnt(30) lgkmcnt(0)
v_mfma_f32_16x16x32_bf16 v[240:243],v[112:115],v[24:27],0
s_barrier
v_mfma_f32_16x16x32_bf16 a[32:35],v[112:115],v[28:31],0
ds_read_b128 v[128:131],v0 offset:24576
v_fma_f32 v100,v100,s36,v16
v_mfma_f32_16x16x32_bf16 a[80:83],v[112:115],v[32:35],0
ds_read_b128 v[132:135],v1 offset:24576
v_fma_f32 v101,v101,s36,v16
v_mfma_f32_16x16x32_bf16 a[128:131],v[112:115],v[36:39],0
ds_read_b128 v[136:139],v0 offset:24704
v_fma_f32 v102,v102,s36,v16
v_mfma_f32_16x16x32_bf16 v[196:199],v[116:119],v[20:23],0
ds_read_b128 v[140:143],v1 offset:24704
v_fma_f32 v103,v103,s36,v16
v_mfma_f32_16x16x32_bf16 v[244:247],v[116:119],v[24:27],0
ds_read_b128 v[112:115],v0 offset:24832
v_fma_f32 v108,v108,s36,v17
v_mfma_f32_16x16x32_bf16 a[36:39],v[116:119],v[28:31],0
buffer_load_dwordx4 v6,s[8:11],s21 offen offset:0 lds
v_mfma_f32_16x16x32_bf16 a[84:87],v[116:119],v[32:35],0
v_exp_f32 v92,v92
v_mfma_f32_16x16x32_bf16 a[132:135],v[116:119],v[36:39],0
ds_read_b128 v[116:119],v1 offset:24832
v_fma_f32 v109,v109,s36,v17
v_mfma_f32_16x16x32_bf16 v[200:203],v[120:123],v[20:23],0
v_exp_f32 v93,v93
v_mfma_f32_16x16x32_bf16 v[248:251],v[120:123],v[24:27],0
v_exp_f32 v94,v94
v_mfma_f32_16x16x32_bf16 a[40:43],v[120:123],v[28:31],0
v_exp_f32 v95,v95
v_mfma_f32_16x16x32_bf16 a[88:91],v[120:123],v[32:35],0
v_cvt_pk_bf16_f32 v50,v92,v93
v_cvt_pk_bf16_f32 v51,v94,v95
v_mfma_f32_16x16x32_bf16 a[136:139],v[120:123],v[36:39],0
ds_read_b128 v[120:123],v0 offset:30720
v_fma_f32 v110,v110,s36,v17
v_mfma_f32_16x16x32_bf16 v[204:207],v[124:127],v[20:23],0
v_exp_f32 v100,v100
v_mfma_f32_16x16x32_bf16 v[252:255],v[124:127],v[24:27],0
v_exp_f32 v101,v101
v_mfma_f32_16x16x32_bf16 a[44:47],v[124:127],v[28:31],0
v_exp_f32 v102,v102
v_mfma_f32_16x16x32_bf16 a[92:95],v[124:127],v[32:35],0
v_exp_f32 v103,v103
v_mfma_f32_16x16x32_bf16 a[140:143],v[124:127],v[36:39],0
buffer_load_dwordx4 v7,s[8:11],s21 offen offset:1024 lds
s_waitcnt lgkmcnt(1)
v_mfma_f32_16x16x32_bf16 v[72:75],v[128:131],a[144:147],0
ds_read_b128 v[124:127],v1 offset:30720
v_cvt_pk_bf16_f32 v54,v100,v101
v_mfma_f32_16x16x32_bf16 v[80:83],v[128:131],a[168:171],0
v_cvt_pk_bf16_f32 v55,v102,v103
v_fma_f32 v111,v111,s36,v17
v_mfma_f32_16x16x32_bf16 v[88:91],v[128:131],a[192:195],0
v_exp_f32 v108,v108
v_smfmac_f32_16x16x64_bf16 v[64:67],v[152:155],v[48:55],v18
v_mfma_f32_16x16x32_bf16 v[96:99],v[128:131],a[216:219],0
v_exp_f32 v109,v109
v_mfma_f32_16x16x32_bf16 v[104:107],v[128:131],a[240:243],0
ds_read_b128 v[128:131],v0 offset:30848
v_cvt_pk_bf16_f32 v58,v108,v109
v_mfma_f32_16x16x32_bf16 v[72:75],v[132:135],a[148:151],v[72:75]
v_exp_f32 v110,v110
v_mfma_f32_16x16x32_bf16 v[80:83],v[132:135],a[172:175],v[80:83]
v_exp_f32 v111,v111
v_mfma_f32_16x16x32_bf16 v[88:91],v[132:135],a[196:199],v[88:91]
v_cvt_pk_bf16_f32 v59,v110,v111
v_mfma_f32_16x16x32_bf16 v[96:99],v[132:135],a[220:223],v[96:99]
v_mfma_f32_16x16x32_bf16 v[104:107],v[132:135],a[244:247],v[104:107]
buffer_load_dwordx4 v8,s[8:11],s21 offen offset:2048 lds
v_smfmac_f32_16x16x64_bf16 v[68:71],v[152:155],v[52:59],v18
s_add_u32 s21,s21,12288
ds_read_b128 v[132:135],v1 offset:30848
v_mfma_f32_16x16x32_bf16 v[72:75],v[136:139],a[152:155],v[72:75]
s_add_u32 m0,s22,12288
v_mfma_f32_16x16x32_bf16 v[80:83],v[136:139],a[176:179],v[80:83]
v_mfma_f32_16x16x32_bf16 v[88:91],v[136:139],a[200:203],v[88:91]
v_mfma_f32_16x16x32_bf16 v[96:99],v[136:139],a[224:227],v[96:99]
v_mfma_f32_16x16x32_bf16 v[104:107],v[136:139],a[248:251],v[104:107]
ds_read_b128 v[136:139],v0 offset:30976
v_mfma_f32_16x16x32_bf16 v[72:75],v[140:143],a[156:159],v[72:75]
v_mfma_f32_16x16x32_bf16 v[80:83],v[140:143],a[180:183],v[80:83]
v_mfma_f32_16x16x32_bf16 v[88:91],v[140:143],a[204:207],v[88:91]
v_mfma_f32_16x16x32_bf16 v[96:99],v[140:143],a[228:231],v[96:99]
v_mfma_f32_16x16x32_bf16 v[104:107],v[140:143],a[252:255],v[104:107]
buffer_load_dwordx4 v6,s[4:7],s20 offen offset:0 lds
v_mfma_f32_16x16x32_bf16 v[72:75],v[112:115],a[160:163],v[72:75]
ds_read_b128 v[140:143],v1 offset:30976
v_mfma_f32_16x16x32_bf16 v[80:83],v[112:115],a[184:187],v[80:83]
v_mfma_f32_16x16x32_bf16 v[88:91],v[112:115],a[208:211],v[88:91]
v_mfma_f32_16x16x32_bf16 v[96:99],v[112:115],a[232:235],v[96:99]
v_mfma_f32_16x16x32_bf16 v[104:107],v[112:115],v[144:147],v[104:107]
v_mfma_f32_16x16x32_bf16 v[72:75],v[116:119],a[164:167],v[72:75]
v_mfma_f32_16x16x32_bf16 v[80:83],v[116:119],a[188:191],v[80:83]
v_mfma_f32_16x16x32_bf16 v[88:91],v[116:119],a[212:215],v[88:91]
v_mfma_f32_16x16x32_bf16 v[96:99],v[116:119],a[236:239],v[96:99]
v_mfma_f32_16x16x32_bf16 v[104:107],v[116:119],v[148:151],v[104:107]
s_waitcnt lgkmcnt(0)
v_mfma_f32_16x16x32_bf16 v[76:79],v[120:123],a[144:147],0
v_mfma_f32_16x16x32_bf16 v[84:87],v[120:123],a[168:171],0
buffer_load_dwordx4 v7,s[4:7],s20 offen offset:1024 lds
v_mfma_f32_16x16x32_bf16 v[92:95],v[120:123],a[192:195],0
v_fma_f32 v72,v72,s36,v13
v_fma_f32 v73,v73,s36,v13
v_mfma_f32_16x16x32_bf16 v[100:103],v[120:123],a[216:219],0
v_fma_f32 v74,v74,s36,v13
v_fma_f32 v75,v75,s36,v13
v_mfma_f32_16x16x32_bf16 v[108:111],v[120:123],a[240:243],0
v_fma_f32 v80,v80,s36,v14
v_fma_f32 v81,v81,s36,v14
v_mfma_f32_16x16x32_bf16 v[76:79],v[124:127],a[148:151],v[76:79]
v_fma_f32 v82,v82,s36,v14
v_fma_f32 v83,v83,s36,v14
v_mfma_f32_16x16x32_bf16 v[84:87],v[124:127],a[172:175],v[84:87]
v_fma_f32 v88,v88,s36,v15
v_fma_f32 v89,v89,s36,v15
v_mfma_f32_16x16x32_bf16 v[92:95],v[124:127],a[196:199],v[92:95]
v_exp_f32 v72,v72
v_mfma_f32_16x16x32_bf16 v[100:103],v[124:127],a[220:223],v[100:103]
v_exp_f32 v73,v73
v_mfma_f32_16x16x32_bf16 v[108:111],v[124:127],a[244:247],v[108:111]
v_exp_f32 v74,v74
v_mfma_f32_16x16x32_bf16 v[76:79],v[128:131],a[152:155],v[76:79]
v_exp_f32 v75,v75
v_mfma_f32_16x16x32_bf16 v[84:87],v[128:131],a[176:179],v[84:87]
v_exp_f32 v80,v80
v_mfma_f32_16x16x32_bf16 v[92:95],v[128:131],a[200:203],v[92:95]
buffer_load_dwordx4 v8,s[4:7],s20 offen offset:2048 lds
v_mfma_f32_16x16x32_bf16 v[100:103],v[128:131],a[224:227],v[100:103]
s_add_u32 s20,s20,12288
v_exp_f32 v81,v81
v_mfma_f32_16x16x32_bf16 v[108:111],v[128:131],a[248:251],v[108:111]
v_exp_f32 v82,v82
v_mfma_f32_16x16x32_bf16 v[76:79],v[132:135],a[156:159],v[76:79]
v_exp_f32 v83,v83
v_mfma_f32_16x16x32_bf16 v[84:87],v[132:135],a[180:183],v[84:87]
v_exp_f32 v88,v88
v_mfma_f32_16x16x32_bf16 v[92:95],v[132:135],a[204:207],v[92:95]
ds_read_b64_tr_b16 v[112:113],v2 offset:12288
v_mfma_f32_16x16x32_bf16 v[100:103],v[132:135],a[228:231],v[100:103]
ds_read_b64_tr_b16 v[114:115],v2 offset:18432
v_cvt_pk_bf16_f32 v20,v72,v73
v_mfma_f32_16x16x32_bf16 v[108:111],v[132:135],a[252:255],v[108:111]
v_exp_f32 v89,v89
v_mfma_f32_16x16x32_bf16 v[76:79],v[136:139],a[160:163],v[76:79]
ds_read_b64_tr_b16 v[116:117],v3 offset:12288
ds_read_b64_tr_b16 v[118:119],v3 offset:18432
v_mfma_f32_16x16x32_bf16 v[84:87],v[136:139],a[184:187],v[84:87]
v_cvt_pk_bf16_f32 v21,v74,v75
v_cvt_pk_bf16_f32 v24,v80,v81
v_mfma_f32_16x16x32_bf16 v[92:95],v[136:139],a[208:211],v[92:95]
ds_read_b64_tr_b16 v[120:121],v4 offset:12288
v_mfma_f32_16x16x32_bf16 v[100:103],v[136:139],a[232:235],v[100:103]
ds_read_b64_tr_b16 v[122:123],v4 offset:18432
v_cvt_pk_bf16_f32 v25,v82,v83
v_mfma_f32_16x16x32_bf16 v[108:111],v[136:139],v[144:147],v[108:111]
v_cvt_pk_bf16_f32 v28,v88,v89
v_mfma_f32_16x16x32_bf16 v[76:79],v[140:143],a[164:167],v[76:79]
ds_read_b64_tr_b16 v[124:125],v5 offset:12288
ds_read_b64_tr_b16 v[126:127],v5 offset:18432
v_mfma_f32_16x16x32_bf16 v[84:87],v[140:143],a[188:191],v[84:87]
v_mfma_f32_16x16x32_bf16 v[92:95],v[140:143],a[212:215],v[92:95]
v_mfma_f32_16x16x32_bf16 v[100:103],v[140:143],a[236:239],v[100:103]
v_mfma_f32_16x16x32_bf16 v[108:111],v[140:143],v[148:151],v[108:111]
s_waitcnt lgkmcnt(4)
v_mfma_f32_16x16x32_bf16 v[160:163],v[112:115],v[40:43],v[160:163]
s_add_u32 m0,s23,12288
ds_read_b64_tr_b16 v[128:129],v2 offset:12416
ds_read_b64_tr_b16 v[130:131],v2 offset:18560
v_mfma_f32_16x16x32_bf16 v[208:211],v[112:115],v[44:47],v[208:211]
ds_read_b64_tr_b16 v[132:133],v3 offset:12416
ds_read_b64_tr_b16 v[134:135],v3 offset:18560
v_mfma_f32_16x16x32_bf16 a[0:3],v[112:115],v[48:51],a[0:3]
ds_read_b64_tr_b16 v[136:137],v4 offset:12416
ds_read_b64_tr_b16 v[138:139],v4 offset:18560
v_mfma_f32_16x16x32_bf16 a[48:51],v[112:115],v[52:55],a[48:51]
ds_read_b64_tr_b16 v[140:141],v5 offset:12416
ds_read_b64_tr_b16 v[142:143],v5 offset:18560
v_mfma_f32_16x16x32_bf16 a[96:99],v[112:115],v[56:59],a[96:99]
ds_read_b64_tr_b16 v[112:113],v2 offset:12544
ds_read_b64_tr_b16 v[114:115],v2 offset:18688
v_mfma_f32_16x16x32_bf16 v[164:167],v[116:119],v[40:43],v[164:167]
v_fma_f32 v90,v90,s36,v15
v_fma_f32 v91,v91,s36,v15
v_mfma_f32_16x16x32_bf16 v[212:215],v[116:119],v[44:47],v[212:215]
v_exp_f32 v90,v90
v_mfma_f32_16x16x32_bf16 a[4:7],v[116:119],v[48:51],a[4:7]
v_exp_f32 v91,v91
v_mfma_f32_16x16x32_bf16 a[52:55],v[116:119],v[52:55],a[52:55]
v_cvt_pk_bf16_f32 v29,v90,v91
v_fma_f32 v96,v96,s36,v16
v_mfma_f32_16x16x32_bf16 a[100:103],v[116:119],v[56:59],a[100:103]
s_waitcnt lgkmcnt(8)
ds_read_b64_tr_b16 v[116:117],v3 offset:12544
ds_read_b64_tr_b16 v[118:119],v3 offset:18688
v_mfma_f32_16x16x32_bf16 v[168:171],v[120:123],v[40:43],v[168:171]
v_fma_f32 v97,v97,s36,v16
v_fma_f32 v98,v98,s36,v16
v_mfma_f32_16x16x32_bf16 v[216:219],v[120:123],v[44:47],v[216:219]
v_fma_f32 v99,v99,s36,v16
v_fma_f32 v104,v104,s36,v17
v_mfma_f32_16x16x32_bf16 a[8:11],v[120:123],v[48:51],a[8:11]
v_exp_f32 v96,v96
v_mfma_f32_16x16x32_bf16 a[56:59],v[120:123],v[52:55],a[56:59]
v_exp_f32 v97,v97
v_mfma_f32_16x16x32_bf16 a[104:107],v[120:123],v[56:59],a[104:107]
ds_read_b64_tr_b16 v[120:121],v4 offset:12544
ds_read_b64_tr_b16 v[122:123],v4 offset:18688
v_mfma_f32_16x16x32_bf16 v[172:175],v[124:127],v[40:43],v[172:175]
v_exp_f32 v98,v98
v_mfma_f32_16x16x32_bf16 v[220:223],v[124:127],v[44:47],v[220:223]
v_exp_f32 v99,v99
v_mfma_f32_16x16x32_bf16 a[12:15],v[124:127],v[48:51],a[12:15]
v_cvt_pk_bf16_f32 v32,v96,v97
v_cvt_pk_bf16_f32 v33,v98,v99
v_mfma_f32_16x16x32_bf16 a[60:63],v[124:127],v[52:55],a[60:63]
v_fma_f32 v105,v105,s36,v17
v_fma_f32 v106,v106,s36,v17
v_mfma_f32_16x16x32_bf16 a[108:111],v[124:127],v[56:59],a[108:111]
ds_read_b64_tr_b16 v[124:125],v5 offset:12544
ds_read_b64_tr_b16 v[126:127],v5 offset:18688
v_mfma_f32_16x16x32_bf16 v[176:179],v[128:131],v[40:43],v[176:179]
v_fma_f32 v107,v107,s36,v17
v_fma_f32 v76,v76,s36,v13
v_mfma_f32_16x16x32_bf16 v[224:227],v[128:131],v[44:47],v[224:227]
v_exp_f32 v104,v104
v_mfma_f32_16x16x32_bf16 a[16:19],v[128:131],v[48:51],a[16:19]
v_exp_f32 v105,v105
v_mfma_f32_16x16x32_bf16 a[64:67],v[128:131],v[52:55],a[64:67]
v_exp_f32 v106,v106
v_mfma_f32_16x16x32_bf16 a[112:115],v[128:131],v[56:59],a[112:115]
s_waitcnt lgkmcnt(2)
v_exp_f32 v107,v107
v_mfma_f32_16x16x32_bf16 v[180:183],v[132:135],v[40:43],v[180:183]
v_cvt_pk_bf16_f32 v36,v104,v105
v_cvt_pk_bf16_f32 v37,v106,v107
v_mfma_f32_16x16x32_bf16 v[228:231],v[132:135],v[44:47],v[228:231]
v_fma_f32 v77,v77,s36,v13
v_fma_f32 v78,v78,s36,v13
v_mfma_f32_16x16x32_bf16 a[20:23],v[132:135],v[48:51],a[20:23]
v_fma_f32 v79,v79,s36,v13
v_fma_f32 v84,v84,s36,v14
v_mfma_f32_16x16x32_bf16 a[68:71],v[132:135],v[52:55],a[68:71]
v_exp_f32 v76,v76
v_mfma_f32_16x16x32_bf16 a[116:119],v[132:135],v[56:59],a[116:119]
v_exp_f32 v77,v77
v_mfma_f32_16x16x32_bf16 v[184:187],v[136:139],v[40:43],v[184:187]
v_exp_f32 v78,v78
v_mfma_f32_16x16x32_bf16 v[232:235],v[136:139],v[44:47],v[232:235]
v_exp_f32 v79,v79
v_mfma_f32_16x16x32_bf16 a[24:27],v[136:139],v[48:51],a[24:27]
v_cvt_pk_bf16_f32 v22,v76,v77
v_cvt_pk_bf16_f32 v23,v78,v79
v_mfma_f32_16x16x32_bf16 a[72:75],v[136:139],v[52:55],a[72:75]
v_fma_f32 v85,v85,s36,v14
v_fma_f32 v86,v86,s36,v14
v_mfma_f32_16x16x32_bf16 a[120:123],v[136:139],v[56:59],a[120:123]
v_fma_f32 v87,v87,s36,v14
v_fma_f32 v92,v92,s36,v15
v_mfma_f32_16x16x32_bf16 v[188:191],v[140:143],v[40:43],v[188:191]
v_exp_f32 v84,v84
v_mfma_f32_16x16x32_bf16 v[236:239],v[140:143],v[44:47],v[236:239]
v_exp_f32 v85,v85
v_mfma_f32_16x16x32_bf16 a[28:31],v[140:143],v[48:51],a[28:31]
v_exp_f32 v86,v86
v_mfma_f32_16x16x32_bf16 a[76:79],v[140:143],v[52:55],a[76:79]
v_exp_f32 v87,v87
v_mfma_f32_16x16x32_bf16 a[124:127],v[140:143],v[56:59],a[124:127]
v_cvt_pk_bf16_f32 v26,v84,v85
v_cvt_pk_bf16_f32 v27,v86,v87
v_mfma_f32_16x16x32_bf16 v[192:195],v[112:115],v[40:43],v[192:195]
v_fma_f32 v93,v93,s36,v15
v_fma_f32 v94,v94,s36,v15
v_smfmac_f32_16x16x64_bf16 v[60:63],v[152:155],v[20:27],v18
v_fma_f32 v95,v95,s36,v15
s_waitcnt vmcnt(6) lgkmcnt(0)
v_mfma_f32_16x16x32_bf16 v[240:243],v[112:115],v[44:47],v[240:243]
s_barrier
v_mfma_f32_16x16x32_bf16 a[32:35],v[112:115],v[48:51],a[32:35]
ds_read_b128 v[128:131],v0 offset:0
v_fma_f32 v100,v100,s36,v16
v_mfma_f32_16x16x32_bf16 a[80:83],v[112:115],v[52:55],a[80:83]
ds_read_b128 v[132:135],v1 offset:0
v_fma_f32 v101,v101,s36,v16
v_mfma_f32_16x16x32_bf16 a[128:131],v[112:115],v[56:59],a[128:131]
ds_read_b128 v[136:139],v0 offset:128
v_fma_f32 v102,v102,s36,v16
v_mfma_f32_16x16x32_bf16 v[196:199],v[116:119],v[40:43],v[196:199]
ds_read_b128 v[140:143],v1 offset:128
v_fma_f32 v103,v103,s36,v16
v_mfma_f32_16x16x32_bf16 v[244:247],v[116:119],v[44:47],v[244:247]
ds_read_b128 v[112:115],v0 offset:256
v_fma_f32 v108,v108,s36,v17
v_mfma_f32_16x16x32_bf16 a[36:39],v[116:119],v[48:51],a[36:39]
buffer_load_dwordx4 v6,s[8:11],s21 offen offset:0 lds
v_mfma_f32_16x16x32_bf16 a[84:87],v[116:119],v[52:55],a[84:87]
v_exp_f32 v92,v92
v_mfma_f32_16x16x32_bf16 a[132:135],v[116:119],v[56:59],a[132:135]
ds_read_b128 v[116:119],v1 offset:256
v_fma_f32 v109,v109,s36,v17
v_mfma_f32_16x16x32_bf16 v[200:203],v[120:123],v[40:43],v[200:203]
v_exp_f32 v93,v93
v_mfma_f32_16x16x32_bf16 v[248:251],v[120:123],v[44:47],v[248:251]
v_exp_f32 v94,v94
v_mfma_f32_16x16x32_bf16 a[40:43],v[120:123],v[48:51],a[40:43]
v_exp_f32 v95,v95
v_mfma_f32_16x16x32_bf16 a[88:91],v[120:123],v[52:55],a[88:91]
v_cvt_pk_bf16_f32 v30,v92,v93
v_cvt_pk_bf16_f32 v31,v94,v95
v_mfma_f32_16x16x32_bf16 a[136:139],v[120:123],v[56:59],a[136:139]
ds_read_b128 v[120:123],v0 offset:6144
v_fma_f32 v110,v110,s36,v17
v_mfma_f32_16x16x32_bf16 v[204:207],v[124:127],v[40:43],v[204:207]
v_exp_f32 v100,v100
v_mfma_f32_16x16x32_bf16 v[252:255],v[124:127],v[44:47],v[252:255]
v_exp_f32 v101,v101
v_mfma_f32_16x16x32_bf16 a[44:47],v[124:127],v[48:51],a[44:47]
v_exp_f32 v102,v102
v_mfma_f32_16x16x32_bf16 a[92:95],v[124:127],v[52:55],a[92:95]
v_exp_f32 v103,v103
v_mfma_f32_16x16x32_bf16 a[140:143],v[124:127],v[56:59],a[140:143]
buffer_load_dwordx4 v7,s[8:11],s21 offen offset:1024 lds
s_waitcnt lgkmcnt(1)
v_mfma_f32_16x16x32_bf16 v[72:75],v[128:131],a[144:147],0
ds_read_b128 v[124:127],v1 offset:6144
v_cvt_pk_bf16_f32 v34,v100,v101
v_mfma_f32_16x16x32_bf16 v[80:83],v[128:131],a[168:171],0
v_cvt_pk_bf16_f32 v35,v102,v103
v_fma_f32 v111,v111,s36,v17
v_mfma_f32_16x16x32_bf16 v[88:91],v[128:131],a[192:195],0
v_exp_f32 v108,v108
v_smfmac_f32_16x16x64_bf16 v[64:67],v[152:155],v[28:35],v18
v_mfma_f32_16x16x32_bf16 v[96:99],v[128:131],a[216:219],0
v_exp_f32 v109,v109
v_mfma_f32_16x16x32_bf16 v[104:107],v[128:131],a[240:243],0
ds_read_b128 v[128:131],v0 offset:6272
v_cvt_pk_bf16_f32 v38,v108,v109
v_mfma_f32_16x16x32_bf16 v[72:75],v[132:135],a[148:151],v[72:75]
v_exp_f32 v110,v110
v_mfma_f32_16x16x32_bf16 v[80:83],v[132:135],a[172:175],v[80:83]
v_exp_f32 v111,v111
v_mfma_f32_16x16x32_bf16 v[88:91],v[132:135],a[196:199],v[88:91]
v_cvt_pk_bf16_f32 v39,v110,v111
v_mfma_f32_16x16x32_bf16 v[96:99],v[132:135],a[220:223],v[96:99]
v_mfma_f32_16x16x32_bf16 v[104:107],v[132:135],a[244:247],v[104:107]
buffer_load_dwordx4 v8,s[8:11],s21 offen offset:2048 lds
v_smfmac_f32_16x16x64_bf16 v[68:71],v[152:155],v[32:39],v18
s_add_u32 s21,s21,12288
ds_read_b128 v[132:135],v1 offset:6272
v_mfma_f32_16x16x32_bf16 v[72:75],v[136:139],a[152:155],v[72:75]
s_add_u32 m0,s22,24576
v_mfma_f32_16x16x32_bf16 v[80:83],v[136:139],a[176:179],v[80:83]
v_mfma_f32_16x16x32_bf16 v[88:91],v[136:139],a[200:203],v[88:91]
v_mfma_f32_16x16x32_bf16 v[96:99],v[136:139],a[224:227],v[96:99]
v_mfma_f32_16x16x32_bf16 v[104:107],v[136:139],a[248:251],v[104:107]
ds_read_b128 v[136:139],v0 offset:6400
v_mfma_f32_16x16x32_bf16 v[72:75],v[140:143],a[156:159],v[72:75]
v_mfma_f32_16x16x32_bf16 v[80:83],v[140:143],a[180:183],v[80:83]
v_mfma_f32_16x16x32_bf16 v[88:91],v[140:143],a[204:207],v[88:91]
v_mfma_f32_16x16x32_bf16 v[96:99],v[140:143],a[228:231],v[96:99]
v_mfma_f32_16x16x32_bf16 v[104:107],v[140:143],a[252:255],v[104:107]
buffer_load_dwordx4 v6,s[4:7],s20 offen offset:0 lds
v_mfma_f32_16x16x32_bf16 v[72:75],v[112:115],a[160:163],v[72:75]
ds_read_b128 v[140:143],v1 offset:6400
v_mfma_f32_16x16x32_bf16 v[80:83],v[112:115],a[184:187],v[80:83]
v_mfma_f32_16x16x32_bf16 v[88:91],v[112:115],a[208:211],v[88:91]
v_mfma_f32_16x16x32_bf16 v[96:99],v[112:115],a[232:235],v[96:99]
v_mfma_f32_16x16x32_bf16 v[104:107],v[112:115],v[144:147],v[104:107]
v_mfma_f32_16x16x32_bf16 v[72:75],v[116:119],a[164:167],v[72:75]
v_mfma_f32_16x16x32_bf16 v[80:83],v[116:119],a[188:191],v[80:83]
v_mfma_f32_16x16x32_bf16 v[88:91],v[116:119],a[212:215],v[88:91]
v_mfma_f32_16x16x32_bf16 v[96:99],v[116:119],a[236:239],v[96:99]
v_mfma_f32_16x16x32_bf16 v[104:107],v[116:119],v[148:151],v[104:107]
s_waitcnt lgkmcnt(0)
v_mfma_f32_16x16x32_bf16 v[76:79],v[120:123],a[144:147],0
v_mfma_f32_16x16x32_bf16 v[84:87],v[120:123],a[168:171],0
buffer_load_dwordx4 v7,s[4:7],s20 offen offset:1024 lds
v_mfma_f32_16x16x32_bf16 v[92:95],v[120:123],a[192:195],0
v_fma_f32 v72,v72,s36,v13
v_fma_f32 v73,v73,s36,v13
v_mfma_f32_16x16x32_bf16 v[100:103],v[120:123],a[216:219],0
v_fma_f32 v74,v74,s36,v13
v_fma_f32 v75,v75,s36,v13
v_mfma_f32_16x16x32_bf16 v[108:111],v[120:123],a[240:243],0
v_fma_f32 v80,v80,s36,v14
v_fma_f32 v81,v81,s36,v14
v_mfma_f32_16x16x32_bf16 v[76:79],v[124:127],a[148:151],v[76:79]
v_fma_f32 v82,v82,s36,v14
v_fma_f32 v83,v83,s36,v14
v_mfma_f32_16x16x32_bf16 v[84:87],v[124:127],a[172:175],v[84:87]
v_fma_f32 v88,v88,s36,v15
v_fma_f32 v89,v89,s36,v15
v_mfma_f32_16x16x32_bf16 v[92:95],v[124:127],a[196:199],v[92:95]
v_exp_f32 v72,v72
v_mfma_f32_16x16x32_bf16 v[100:103],v[124:127],a[220:223],v[100:103]
v_exp_f32 v73,v73
v_mfma_f32_16x16x32_bf16 v[108:111],v[124:127],a[244:247],v[108:111]
v_exp_f32 v74,v74
v_mfma_f32_16x16x32_bf16 v[76:79],v[128:131],a[152:155],v[76:79]
v_exp_f32 v75,v75
v_mfma_f32_16x16x32_bf16 v[84:87],v[128:131],a[176:179],v[84:87]
v_exp_f32 v80,v80
v_mfma_f32_16x16x32_bf16 v[92:95],v[128:131],a[200:203],v[92:95]
buffer_load_dwordx4 v8,s[4:7],s20 offen offset:2048 lds
v_mfma_f32_16x16x32_bf16 v[100:103],v[128:131],a[224:227],v[100:103]
s_add_u32 s20,s20,12288
v_exp_f32 v81,v81
v_mfma_f32_16x16x32_bf16 v[108:111],v[128:131],a[248:251],v[108:111]
v_exp_f32 v82,v82
v_mfma_f32_16x16x32_bf16 v[76:79],v[132:135],a[156:159],v[76:79]
v_exp_f32 v83,v83
v_mfma_f32_16x16x32_bf16 v[84:87],v[132:135],a[180:183],v[84:87]
v_exp_f32 v88,v88
v_mfma_f32_16x16x32_bf16 v[92:95],v[132:135],a[204:207],v[92:95]
ds_read_b64_tr_b16 v[112:113],v2 offset:24576
v_mfma_f32_16x16x32_bf16 v[100:103],v[132:135],a[228:231],v[100:103]
ds_read_b64_tr_b16 v[114:115],v2 offset:30720
v_cvt_pk_bf16_f32 v40,v72,v73
v_mfma_f32_16x16x32_bf16 v[108:111],v[132:135],a[252:255],v[108:111]
v_exp_f32 v89,v89
v_mfma_f32_16x16x32_bf16 v[76:79],v[136:139],a[160:163],v[76:79]
ds_read_b64_tr_b16 v[116:117],v3 offset:24576
ds_read_b64_tr_b16 v[118:119],v3 offset:30720
v_mfma_f32_16x16x32_bf16 v[84:87],v[136:139],a[184:187],v[84:87]
v_cvt_pk_bf16_f32 v41,v74,v75
v_cvt_pk_bf16_f32 v44,v80,v81
v_mfma_f32_16x16x32_bf16 v[92:95],v[136:139],a[208:211],v[92:95]
ds_read_b64_tr_b16 v[120:121],v4 offset:24576
v_mfma_f32_16x16x32_bf16 v[100:103],v[136:139],a[232:235],v[100:103]
ds_read_b64_tr_b16 v[122:123],v4 offset:30720
v_cvt_pk_bf16_f32 v45,v82,v83
v_mfma_f32_16x16x32_bf16 v[108:111],v[136:139],v[144:147],v[108:111]
v_cvt_pk_bf16_f32 v48,v88,v89
v_mfma_f32_16x16x32_bf16 v[76:79],v[140:143],a[164:167],v[76:79]
ds_read_b64_tr_b16 v[124:125],v5 offset:24576
ds_read_b64_tr_b16 v[126:127],v5 offset:30720
v_mfma_f32_16x16x32_bf16 v[84:87],v[140:143],a[188:191],v[84:87]
v_mfma_f32_16x16x32_bf16 v[92:95],v[140:143],a[212:215],v[92:95]
v_mfma_f32_16x16x32_bf16 v[100:103],v[140:143],a[236:239],v[100:103]
v_mfma_f32_16x16x32_bf16 v[108:111],v[140:143],v[148:151],v[108:111]
s_mov_b32 s38,0
s_branch L_loop5
L_tr44:
s_waitcnt vmcnt(42)
s_waitcnt lgkmcnt(4)
v_mfma_f32_16x16x32_bf16 v[160:163],v[112:115],v[20:23],v[160:163]
s_add_u32 m0,s24,0
ds_read_b128 a[144:147],v11 offset:0
v_fma_f32 v82,v82,s36,v14
v_mfma_f32_16x16x32_bf16 v[208:211],v[112:115],v[24:27],v[208:211]
ds_read_b128 a[148:151],v12 offset:0
v_fma_f32 v83,v83,s36,v14
v_mfma_f32_16x16x32_bf16 a[0:3],v[112:115],v[28:31],a[0:3]
ds_read_b128 a[152:155],v11 offset:128
v_fma_f32 v88,v88,s36,v15
v_mfma_f32_16x16x32_bf16 a[48:51],v[112:115],v[32:35],a[48:51]
ds_read_b128 a[156:159],v12 offset:128
v_fma_f32 v89,v89,s36,v15
v_mfma_f32_16x16x32_bf16 v[164:167],v[116:119],v[20:23],v[164:167]
ds_read_b128 a[160:163],v11 offset:256
v_fma_f32 v90,v90,s36,v15
v_mfma_f32_16x16x32_bf16 v[212:215],v[116:119],v[24:27],v[212:215]
ds_read_b128 a[164:167],v12 offset:256
ds_read_b64_tr_b16 v[128:129],v2 offset:24704
ds_read_b64_tr_b16 v[130:131],v2 offset:30848
ds_read_b64_tr_b16 v[132:133],v3 offset:24704
ds_read_b64_tr_b16 v[134:135],v3 offset:30848
ds_read_b64_tr_b16 v[136:137],v4 offset:24704
ds_read_b64_tr_b16 v[138:139],v4 offset:30848
ds_read_b64_tr_b16 v[140:141],v5 offset:24704
ds_read_b64_tr_b16 v[142:143],v5 offset:30848
ds_read_b64_tr_b16 v[112:113],v2 offset:24832
ds_read_b64_tr_b16 v[114:115],v2 offset:30976
ds_read_b128 a[168:171],v11 offset:6144
v_mfma_f32_16x16x32_bf16 a[4:7],v[116:119],v[28:31],a[4:7]
v_fma_f32 v91,v91,s36,v15
ds_read_b128 a[172:175],v12 offset:6144
ds_read_b128 a[176:179],v11 offset:6272
v_mfma_f32_16x16x32_bf16 a[52:55],v[116:119],v[32:35],a[52:55]
s_waitcnt lgkmcnt(13)
v_fma_f32 v96,v96,s36,v16
ds_read_b128 a[180:183],v12 offset:6272
ds_read_b128 a[184:187],v11 offset:6400
v_mfma_f32_16x16x32_bf16 v[168:171],v[120:123],v[20:23],v[168:171]
buffer_load_dwordx4 v6,s[12:15],s28 offen offset:0 nt lds
v_mfma_f32_16x16x32_bf16 v[216:219],v[120:123],v[24:27],v[216:219]
ds_read_b64_tr_b16 v[116:117],v3 offset:24832
ds_read_b64_tr_b16 v[118:119],v3 offset:30976
v_mfma_f32_16x16x32_bf16 a[8:11],v[120:123],v[28:31],a[8:11]
ds_read_b128 a[188:191],v12 offset:6400
v_fma_f32 v97,v97,s36,v16
v_mfma_f32_16x16x32_bf16 a[56:59],v[120:123],v[32:35],a[56:59]
ds_read_b64_tr_b16 v[120:121],v4 offset:24832
ds_read_b64_tr_b16 v[122:123],v4 offset:30976
v_mfma_f32_16x16x32_bf16 v[172:175],v[124:127],v[20:23],v[172:175]
v_fma_f32 v98,v98,s36,v16
v_fma_f32 v99,v99,s36,v16
v_mfma_f32_16x16x32_bf16 v[220:223],v[124:127],v[24:27],v[220:223]
buffer_load_dwordx4 v7,s[12:15],s28 offen offset:1024 nt lds
v_mfma_f32_16x16x32_bf16 a[12:15],v[124:127],v[28:31],a[12:15]
v_fma_f32 v76,v76,s36,v13
v_fma_f32 v77,v77,s36,v13
v_mfma_f32_16x16x32_bf16 a[60:63],v[124:127],v[32:35],a[60:63]
s_waitcnt lgkmcnt(5)
ds_read_b64_tr_b16 v[124:125],v5 offset:24832
ds_read_b64_tr_b16 v[126:127],v5 offset:30976
v_mfma_f32_16x16x32_bf16 v[176:179],v[128:131],v[20:23],v[176:179]
v_fma_f32 v78,v78,s36,v13
v_fma_f32 v79,v79,s36,v13
v_mfma_f32_16x16x32_bf16 v[224:227],v[128:131],v[24:27],v[224:227]
v_fma_f32 v84,v84,s36,v14
v_fma_f32 v85,v85,s36,v14
v_mfma_f32_16x16x32_bf16 a[16:19],v[128:131],v[28:31],a[16:19]
v_fma_f32 v86,v86,s36,v14
v_fma_f32 v87,v87,s36,v14
v_mfma_f32_16x16x32_bf16 a[64:67],v[128:131],v[32:35],a[64:67]
v_fma_f32 v92,v92,s36,v15
v_fma_f32 v93,v93,s36,v15
v_mfma_f32_16x16x32_bf16 v[180:183],v[132:135],v[20:23],v[180:183]
v_fma_f32 v94,v94,s36,v15
v_fma_f32 v95,v95,s36,v15
v_mfma_f32_16x16x32_bf16 v[228:231],v[132:135],v[24:27],v[228:231]
buffer_load_dwordx4 v8,s[12:15],s28 offen offset:2048 nt lds
v_mfma_f32_16x16x32_bf16 a[20:23],v[132:135],v[28:31],a[20:23]
s_add_u32 s28,s28,3072
v_fma_f32 v100,v100,s36,v16
v_fma_f32 v101,v101,s36,v16
v_mfma_f32_16x16x32_bf16 a[68:71],v[132:135],v[32:35],a[68:71]
s_add_u32 m0,s24,3072
v_fma_f32 v102,v102,s36,v16
v_fma_f32 v103,v103,s36,v16
v_mfma_f32_16x16x32_bf16 v[184:187],v[136:139],v[20:23],v[184:187]
v_exp_f32 v82,v82
v_mfma_f32_16x16x32_bf16 v[232:235],v[136:139],v[24:27],v[232:235]
v_exp_f32 v83,v83
v_mfma_f32_16x16x32_bf16 a[24:27],v[136:139],v[28:31],a[24:27]
v_exp_f32 v88,v88
v_mfma_f32_16x16x32_bf16 a[72:75],v[136:139],v[32:35],a[72:75]
v_exp_f32 v89,v89
v_mfma_f32_16x16x32_bf16 v[188:191],v[140:143],v[20:23],v[188:191]
v_exp_f32 v90,v90
v_mfma_f32_16x16x32_bf16 v[236:239],v[140:143],v[24:27],v[236:239]
buffer_load_dwordx4 v6,s[12:15],s28 offen offset:0 nt lds
v_mfma_f32_16x16x32_bf16 a[28:31],v[140:143],v[28:31],a[28:31]
v_exp_f32 v91,v91
v_mfma_f32_16x16x32_bf16 a[76:79],v[140:143],v[32:35],a[76:79]
v_exp_f32 v96,v96
v_mfma_f32_16x16x32_bf16 v[192:195],v[112:115],v[20:23],v[192:195]
v_exp_f32 v97,v97
v_mfma_f32_16x16x32_bf16 v[240:243],v[112:115],v[24:27],v[240:243]
v_exp_f32 v98,v98
v_mfma_f32_16x16x32_bf16 a[32:35],v[112:115],v[28:31],a[32:35]
v_exp_f32 v99,v99
v_mfma_f32_16x16x32_bf16 a[80:83],v[112:115],v[32:35],a[80:83]
s_waitcnt lgkmcnt(0)
v_exp_f32 v76,v76
v_mfma_f32_16x16x32_bf16 v[196:199],v[116:119],v[20:23],v[196:199]
buffer_load_dwordx4 v7,s[12:15],s28 offen offset:1024 nt lds
v_mfma_f32_16x16x32_bf16 v[244:247],v[116:119],v[24:27],v[244:247]
v_exp_f32 v77,v77
v_mfma_f32_16x16x32_bf16 a[36:39],v[116:119],v[28:31],a[36:39]
v_exp_f32 v78,v78
v_mfma_f32_16x16x32_bf16 a[84:87],v[116:119],v[32:35],a[84:87]
v_exp_f32 v79,v79
v_mfma_f32_16x16x32_bf16 v[200:203],v[120:123],v[20:23],v[200:203]
v_exp_f32 v84,v84
v_mfma_f32_16x16x32_bf16 v[248:251],v[120:123],v[24:27],v[248:251]
v_exp_f32 v85,v85
v_mfma_f32_16x16x32_bf16 a[40:43],v[120:123],v[28:31],a[40:43]
v_exp_f32 v86,v86
v_mfma_f32_16x16x32_bf16 a[88:91],v[120:123],v[32:35],a[88:91]
v_exp_f32 v87,v87
v_mfma_f32_16x16x32_bf16 v[204:207],v[124:127],v[20:23],v[204:207]
buffer_load_dwordx4 v8,s[12:15],s28 offen offset:2048 nt lds
s_waitcnt vmcnt(20)
s_barrier
v_mfma_f32_16x16x32_bf16 v[252:255],v[124:127],v[24:27],v[252:255]
s_add_u32 s28,s28,3072
ds_read_b64_tr_b16 v[128:129],v2 offset:0
ds_read_b64_tr_b16 v[130:131],v2 offset:6144
v_mfma_f32_16x16x32_bf16 a[44:47],v[124:127],v[28:31],a[44:47]
s_add_u32 m0,s22,0
ds_read_b64_tr_b16 v[132:133],v3 offset:0
buffer_load_dwordx4 v6,s[4:7],s25 offen offset:0 lds
v_mfma_f32_16x16x32_bf16 a[92:95],v[124:127],v[32:35],a[92:95]
buffer_load_dwordx4 v7,s[4:7],s25 offen offset:1024 lds
buffer_load_dwordx4 v8,s[4:7],s25 offen offset:2048 lds
ds_read_b64_tr_b16 v[134:135],v3 offset:6144
ds_read_b64_tr_b16 v[136:137],v4 offset:0
ds_read_b64_tr_b16 v[138:139],v4 offset:6144
ds_read_b64_tr_b16 v[140:141],v5 offset:0
ds_read_b64_tr_b16 v[142:143],v5 offset:6144
v_exp_f32 v92,v92
v_exp_f32 v93,v93
v_exp_f32 v94,v94
v_exp_f32 v95,v95
v_exp_f32 v100,v100
v_exp_f32 v101,v101
v_exp_f32 v102,v102
v_exp_f32 v103,v103
v_cvt_pk_bf16_f32 v45,v82,v83
v_cvt_pk_bf16_f32 v48,v88,v89
v_cvt_pk_bf16_f32 v49,v90,v91
v_cvt_pk_bf16_f32 v52,v96,v97
v_cvt_pk_bf16_f32 v53,v98,v99
v_cvt_pk_bf16_f32 v42,v76,v77
v_cvt_pk_bf16_f32 v43,v78,v79
v_cvt_pk_bf16_f32 v46,v84,v85
v_cvt_pk_bf16_f32 v47,v86,v87
v_cvt_pk_bf16_f32 v50,v92,v93
v_cvt_pk_bf16_f32 v51,v94,v95
v_smfmac_f32_16x16x64_bf16 v[60:63],v[152:155],v[40:47],v18
v_cvt_pk_bf16_f32 v54,v100,v101
v_cvt_pk_bf16_f32 v55,v102,v103
v_subrev_u32 v10,18432,v10
s_nop 0
v_smfmac_f32_16x16x64_bf16 v[64:67],v[152:155],v[48:55],v18
s_waitcnt lgkmcnt(0)
v_mfma_f32_16x16x32_bf16 v[160:163],v[128:131],v[40:43],v[160:163]
s_add_u32 s87,s42,18432
ds_read_b64_tr_b16 v[112:113],v2 offset:128
ds_read_b64_tr_b16 v[114:115],v2 offset:6272
v_mfma_f32_16x16x32_bf16 v[208:211],v[128:131],v[44:47],v[208:211]
ds_read_b64_tr_b16 v[116:117],v3 offset:128
ds_read_b64_tr_b16 v[118:119],v3 offset:6272
v_mfma_f32_16x16x32_bf16 a[0:3],v[128:131],v[48:51],a[0:3]
ds_read_b64_tr_b16 v[120:121],v4 offset:128
ds_read_b64_tr_b16 v[122:123],v4 offset:6272
v_mfma_f32_16x16x32_bf16 a[48:51],v[128:131],v[52:55],a[48:51]
ds_read_b64_tr_b16 v[124:125],v5 offset:128
ds_read_b64_tr_b16 v[126:127],v5 offset:6272
v_mfma_f32_16x16x32_bf16 v[164:167],v[132:135],v[40:43],v[164:167]
ds_read_b64_tr_b16 v[128:129],v2 offset:256
ds_read_b64_tr_b16 v[130:131],v2 offset:6400
v_mfma_f32_16x16x32_bf16 v[212:215],v[132:135],v[44:47],v[212:215]
v_mbcnt_lo_u32_b32 v39,-1,0
v_mbcnt_hi_u32_b32 v39,-1,v39
v_mfma_f32_16x16x32_bf16 a[4:7],v[132:135],v[48:51],a[4:7]
v_and_b32 v38,7,v39
v_add_f32 v60,v60,v61
v_mfma_f32_16x16x32_bf16 a[52:55],v[132:135],v[52:55],a[52:55]
ds_read_b64_tr_b16 v[132:133],v3 offset:256
ds_read_b64_tr_b16 v[134:135],v3 offset:6400
v_mfma_f32_16x16x32_bf16 v[168:171],v[136:139],v[40:43],v[168:171]
v_add_f32 v62,v62,v63
v_add_f32 v64,v64,v65
v_mfma_f32_16x16x32_bf16 v[216:219],v[136:139],v[44:47],v[216:219]
v_add_f32 v66,v66,v67
v_max3_f32 v19,v60,v62,v64
v_mfma_f32_16x16x32_bf16 a[8:11],v[136:139],v[48:51],a[8:11]
v_max_f32 v19,v19,v66
v_rcp_f32 v66,v66
v_mfma_f32_16x16x32_bf16 a[56:59],v[136:139],v[52:55],a[56:59]
ds_read_b64_tr_b16 v[136:137],v4 offset:256
ds_read_b64_tr_b16 v[138:139],v4 offset:6400
v_mfma_f32_16x16x32_bf16 v[172:175],v[140:143],v[40:43],v[172:175]
v_accvgpr_read_b32 v72,a48
v_accvgpr_read_b32 v73,a49
v_mfma_f32_16x16x32_bf16 v[220:223],v[140:143],v[44:47],v[220:223]
v_accvgpr_read_b32 v74,a50
v_accvgpr_read_b32 v75,a51
v_mfma_f32_16x16x32_bf16 a[12:15],v[140:143],v[48:51],a[12:15]
v_accvgpr_read_b32 v80,a52
v_accvgpr_read_b32 v81,a53
v_mfma_f32_16x16x32_bf16 a[60:63],v[140:143],v[52:55],a[60:63]
s_waitcnt lgkmcnt(3)
ds_read_b64_tr_b16 v[140:141],v5 offset:256
ds_read_b64_tr_b16 v[142:143],v5 offset:6400
v_mfma_f32_16x16x32_bf16 v[176:179],v[112:115],v[40:43],v[176:179]
v_accvgpr_read_b32 v82,a54
v_accvgpr_read_b32 v83,a55
v_mfma_f32_16x16x32_bf16 v[224:227],v[112:115],v[44:47],v[224:227]
v_accvgpr_read_b32 v88,a56
v_accvgpr_read_b32 v89,a57
v_mfma_f32_16x16x32_bf16 a[16:19],v[112:115],v[48:51],a[16:19]
v_accvgpr_read_b32 v90,a58
v_accvgpr_read_b32 v91,a59
v_mfma_f32_16x16x32_bf16 a[64:67],v[112:115],v[52:55],a[64:67]
v_accvgpr_read_b32 v96,a60
v_accvgpr_read_b32 v97,a61
v_mfma_f32_16x16x32_bf16 v[180:183],v[116:119],v[40:43],v[180:183]
v_accvgpr_read_b32 v98,a62
v_accvgpr_read_b32 v99,a63
v_mfma_f32_16x16x32_bf16 v[228:231],v[116:119],v[44:47],v[228:231]
v_cmp_ngt_f32 vcc,s37,v19
v_lshrrev_b32 v19,5,v39
v_mfma_f32_16x16x32_bf16 a[20:23],v[116:119],v[48:51],a[20:23]
v_xor_b32 v38,v38,v19
v_and_b32 v19,15,v39
v_lshl_add_u32 v19,v19,7,s24
v_lshl_add_u32 v19,v38,4,v19
v_bfe_u32 v38,v39,4,1
v_pk_mul_f32 v[72:73],v[72:73],v[66:67] op_sel_hi:[1,0]
v_pk_mul_f32 v[74:75],v[74:75],v[66:67] op_sel_hi:[1,0]
v_lshl_add_u32 v36,v38,3,v19
v_xor_b32 v37,32,v36
v_bfe_u32 v19,v39,3,1
v_xor_b32 v38,64,v36
v_xor_b32 v39,96,v36
v_lshlrev_b32 v19,11,v19
v_accvgpr_read_b32 v76,a64
v_accvgpr_read_b32 v77,a65
v_pk_mul_f32 v[76:77],v[76:77],v[66:67] op_sel_hi:[1,0]
v_accvgpr_read_b32 v78,a66
v_accvgpr_read_b32 v79,a67
v_pk_mul_f32 v[78:79],v[78:79],v[66:67] op_sel_hi:[1,0]
v_cvt_pk_bf16_f32 v72,v72,v73
v_cvt_pk_bf16_f32 v76,v76,v77
v_mfma_f32_16x16x32_bf16 a[68:71],v[116:119],v[52:55],a[68:71]
s_cmp_lg_u64 vcc,0
v_cvt_pk_bf16_f32 v73,v74,v75
v_cvt_pk_bf16_f32 v77,v78,v79
v_mfma_f32_16x16x32_bf16 v[184:187],v[120:123],v[40:43],v[184:187]
s_cselect_b32 s62,s32,0
ds_write2st64_b64 v36,v[72:73],v[76:77] offset0:36 offset1:40
v_mfma_f32_16x16x32_bf16 v[232:235],v[120:123],v[44:47],v[232:235]
s_or_b32 s31,s31,s62
v_accvgpr_read_b32 v84,a68
v_accvgpr_read_b32 v85,a69
v_mfma_f32_16x16x32_bf16 a[24:27],v[120:123],v[48:51],a[24:27]
s_lshl_b32 s32,s32,1
v_accvgpr_read_b32 v86,a70
v_accvgpr_read_b32 v87,a71
v_rcp_f32 v62,v62
v_rcp_f32 v64,v64
v_pk_mul_f32 v[80:81],v[80:81],v[66:67] op_sel_hi:[1,0]
v_pk_mul_f32 v[82:83],v[82:83],v[66:67] op_sel_hi:[1,0]
v_pk_mul_f32 v[84:85],v[84:85],v[66:67] op_sel_hi:[1,0]
v_pk_mul_f32 v[86:87],v[86:87],v[66:67] op_sel_hi:[1,0]
v_cvt_pk_bf16_f32 v80,v80,v81
v_cvt_pk_bf16_f32 v84,v84,v85
v_mfma_f32_16x16x32_bf16 a[72:75],v[120:123],v[52:55],a[72:75]
s_add_u32 m0,s23,0
v_cvt_pk_bf16_f32 v81,v82,v83
v_cvt_pk_bf16_f32 v85,v86,v87
v_mfma_f32_16x16x32_bf16 v[188:191],v[124:127],v[40:43],v[188:191]
ds_write2st64_b64 v37,v[80:81],v[84:85] offset0:36 offset1:40
v_mfma_f32_16x16x32_bf16 v[236:239],v[124:127],v[44:47],v[236:239]
v_rcp_f32 v60,v60
v_mfma_f32_16x16x32_bf16 a[28:31],v[124:127],v[48:51],a[28:31]
v_accvgpr_read_b32 v92,a72
v_accvgpr_read_b32 v93,a73
v_accvgpr_read_b32 v94,a74
v_accvgpr_read_b32 v95,a75
v_pk_mul_f32 v[88:89],v[88:89],v[66:67] op_sel_hi:[1,0]
v_pk_mul_f32 v[90:91],v[90:91],v[66:67] op_sel_hi:[1,0]
v_pk_mul_f32 v[92:93],v[92:93],v[66:67] op_sel_hi:[1,0]
v_pk_mul_f32 v[94:95],v[94:95],v[66:67] op_sel_hi:[1,0]
v_cvt_pk_bf16_f32 v88,v88,v89
v_cvt_pk_bf16_f32 v92,v92,v93
v_mfma_f32_16x16x32_bf16 a[76:79],v[124:127],v[52:55],a[76:79]
v_cvt_pk_bf16_f32 v89,v90,v91
v_cvt_pk_bf16_f32 v93,v94,v95
v_mfma_f32_16x16x32_bf16 v[192:195],v[128:131],v[40:43],v[192:195]
ds_write2st64_b64 v38,v[88:89],v[92:93] offset0:36 offset1:40
v_mfma_f32_16x16x32_bf16 v[240:243],v[128:131],v[44:47],v[240:243]
v_mfma_f32_16x16x32_bf16 a[32:35],v[128:131],v[48:51],a[32:35]
v_pk_mul_f32 v[96:97],v[96:97],v[66:67] op_sel_hi:[1,0]
v_pk_mul_f32 v[98:99],v[98:99],v[66:67] op_sel_hi:[1,0]
v_accvgpr_read_b32 v100,a76
v_accvgpr_read_b32 v101,a77
v_pk_mul_f32 v[100:101],v[100:101],v[66:67] op_sel_hi:[1,0]
v_accvgpr_read_b32 v102,a78
v_accvgpr_read_b32 v103,a79
v_pk_mul_f32 v[102:103],v[102:103],v[66:67] op_sel_hi:[1,0]
v_cvt_pk_bf16_f32 v96,v96,v97
v_cvt_pk_bf16_f32 v100,v100,v101
v_mfma_f32_16x16x32_bf16 a[80:83],v[128:131],v[52:55],a[80:83]
s_waitcnt lgkmcnt(1)
v_cvt_pk_bf16_f32 v97,v98,v99
v_cvt_pk_bf16_f32 v101,v102,v103
v_mfma_f32_16x16x32_bf16 v[196:199],v[132:135],v[40:43],v[196:199]
ds_write2st64_b64 v39,v[96:97],v[100:101] offset0:36 offset1:40
v_mfma_f32_16x16x32_bf16 v[244:247],v[132:135],v[44:47],v[244:247]
v_mfma_f32_16x16x32_bf16 a[36:39],v[132:135],v[48:51],a[36:39]
ds_read_b128 v[156:159],v10 offset:18432
ds_read_b128 v[104:107],v10 offset:19456
v_accvgpr_read_b32 v72,a80
ds_read_b128 v[108:111],v10 offset:20480
v_accvgpr_read_b32 v73,a81
ds_read_b128 v[76:79],v10 offset:21504
v_pk_mul_f32 v[72:73],v[72:73],v[66:67] op_sel_hi:[1,0]
v_accvgpr_read_b32 v74,a82
v_accvgpr_read_b32 v75,a83
v_pk_mul_f32 v[74:75],v[74:75],v[66:67] op_sel_hi:[1,0]
v_cvt_pk_bf16_f32 v72,v72,v73
v_cvt_pk_bf16_f32 v73,v74,v75
v_mfma_f32_16x16x32_bf16 a[84:87],v[132:135],v[52:55],a[84:87]
s_waitcnt vmcnt(15)
ds_read_b128 a[192:195],v11 offset:12288
v_mfma_f32_16x16x32_bf16 v[200:203],v[136:139],v[40:43],v[200:203]
ds_read_b128 a[196:199],v12 offset:12288
v_mfma_f32_16x16x32_bf16 v[248:251],v[136:139],v[44:47],v[248:251]
ds_read_b128 a[200:203],v11 offset:12416
v_mfma_f32_16x16x32_bf16 a[40:43],v[136:139],v[48:51],a[40:43]
s_waitcnt lgkmcnt(6)
ds_read_b128 a[204:207],v12 offset:12416
ds_read_b128 a[208:211],v11 offset:12544
buffer_store_dwordx4 v[156:159],v9,s[16:19],s87 offen offset:0 nt
ds_read_b128 a[212:215],v12 offset:12544
v_accvgpr_read_b32 v84,a84
v_accvgpr_read_b32 v85,a85
v_pk_mul_f32 v[84:85],v[84:85],v[66:67] op_sel_hi:[1,0]
v_accvgpr_read_b32 v86,a86
v_accvgpr_read_b32 v87,a87
v_pk_mul_f32 v[86:87],v[86:87],v[66:67] op_sel_hi:[1,0]
v_cvt_pk_bf16_f32 v84,v84,v85
v_cvt_pk_bf16_f32 v85,v86,v87
ds_write_b64 v36,v[72:73] offset:18432
v_mfma_f32_16x16x32_bf16 a[88:91],v[136:139],v[52:55],a[88:91]
s_waitcnt lgkmcnt(7)
buffer_store_dwordx4 v[104:107],v9,s[16:19],s87 offen offset:3072 nt
v_add_u32 v36,v36,v19
v_accvgpr_read_b32 v86,a6
v_accvgpr_read_b32 v87,a7
v_mfma_f32_16x16x32_bf16 v[204:207],v[140:143],v[40:43],v[204:207]
v_accvgpr_read_b32 v104,a8
v_accvgpr_read_b32 v105,a9
v_mfma_f32_16x16x32_bf16 v[252:255],v[140:143],v[44:47],v[252:255]
v_accvgpr_read_b32 v92,a88
v_accvgpr_read_b32 v93,a89
v_mfma_f32_16x16x32_bf16 a[44:47],v[140:143],v[48:51],a[44:47]
ds_write_b64 v37,v[84:85] offset:18432
buffer_store_dwordx4 v[108:111],v9,s[16:19],s87 offen offset:128 nt
v_pk_mul_f32 v[92:93],v[92:93],v[66:67] op_sel_hi:[1,0]
v_add_u32 v37,v37,v19
v_accvgpr_read_b32 v94,a90
v_accvgpr_read_b32 v95,a91
v_pk_mul_f32 v[94:95],v[94:95],v[66:67] op_sel_hi:[1,0]
v_accvgpr_read_b32 v84,a4
v_accvgpr_read_b32 v85,a5
v_mfma_f32_16x16x32_bf16 a[92:95],v[140:143],v[52:55],a[92:95]
v_accvgpr_read_b32 v106,a10
v_accvgpr_read_b32 v107,a11
buffer_store_dwordx4 v[76:79],v9,s[16:19],s87 offen offset:3200 nt
v_accvgpr_read_b32 v108,a12
v_accvgpr_read_b32 v109,a13
v_accvgpr_read_b32 v76,a0
v_accvgpr_read_b32 v77,a1
v_accvgpr_read_b32 v78,a2
v_accvgpr_read_b32 v96,a92
v_accvgpr_read_b32 v97,a93
v_accvgpr_read_b32 v98,a94
v_accvgpr_read_b32 v99,a95
v_accvgpr_read_b32 v79,a3
v_accvgpr_read_b32 v110,a14
v_accvgpr_read_b32 v111,a15
v_cvt_pk_bf16_f32 v92,v92,v93
v_cvt_pk_bf16_f32 v93,v94,v95
ds_write_b64 v38,v[92:93] offset:18432
s_waitcnt vmcnt(4)
s_barrier
ds_read_b128 v[112:115],v0 offset:0
ds_read_b128 v[116:119],v1 offset:0
v_add_u32 v38,v38,v19
ds_read_b128 v[120:123],v0 offset:128
v_accvgpr_read_b32 v94,a18
ds_read_b128 v[124:127],v1 offset:128
v_accvgpr_read_b32 v95,a19
ds_read_b128 v[128:131],v0 offset:256
v_accvgpr_read_b32 v92,a16
buffer_load_dwordx4 v6,s[8:11],s25 offen offset:0 lds
ds_read_b128 v[132:135],v1 offset:256
ds_read_b128 v[136:139],v0 offset:6144
v_accvgpr_read_b32 v93,a17
ds_read_b128 v[140:143],v1 offset:6144
s_waitcnt lgkmcnt(7)
v_mfma_f32_16x16x32_bf16 v[72:75],v[112:115],a[144:147],0
v_mfma_f32_16x16x32_bf16 v[80:83],v[112:115],a[168:171],0
v_mfma_f32_16x16x32_bf16 v[88:91],v[112:115],a[192:195],0
ds_read_b128 v[112:115],v0 offset:6272
v_pk_mul_f32 v[96:97],v[96:97],v[66:67] op_sel_hi:[1,0]
buffer_load_dwordx4 v7,s[8:11],s25 offen offset:1024 lds
v_pk_mul_f32 v[98:99],v[98:99],v[66:67] op_sel_hi:[1,0]
v_pk_mul_f32 v[208:209],v[208:209],v[62:63] op_sel_hi:[1,0]
v_pk_mul_f32 v[210:211],v[210:211],v[62:63] op_sel_hi:[1,0]
v_pk_mul_f32 v[224:225],v[224:225],v[62:63] op_sel_hi:[1,0]
v_pk_mul_f32 v[226:227],v[226:227],v[62:63] op_sel_hi:[1,0]
v_pk_mul_f32 v[212:213],v[212:213],v[62:63] op_sel_hi:[1,0]
v_pk_mul_f32 v[214:215],v[214:215],v[62:63] op_sel_hi:[1,0]
v_pk_mul_f32 v[228:229],v[228:229],v[62:63] op_sel_hi:[1,0]
v_pk_mul_f32 v[230:231],v[230:231],v[62:63] op_sel_hi:[1,0]
v_pk_mul_f32 v[216:217],v[216:217],v[62:63] op_sel_hi:[1,0]
v_pk_mul_f32 v[218:219],v[218:219],v[62:63] op_sel_hi:[1,0]
v_pk_mul_f32 v[232:233],v[232:233],v[62:63] op_sel_hi:[1,0]
v_pk_mul_f32 v[234:235],v[234:235],v[62:63] op_sel_hi:[1,0]
v_pk_mul_f32 v[220:221],v[220:221],v[62:63] op_sel_hi:[1,0]
v_pk_mul_f32 v[222:223],v[222:223],v[62:63] op_sel_hi:[1,0]
v_pk_mul_f32 v[236:237],v[236:237],v[62:63] op_sel_hi:[1,0]
v_pk_mul_f32 v[238:239],v[238:239],v[62:63] op_sel_hi:[1,0]
v_pk_mul_f32 v[240:241],v[240:241],v[62:63] op_sel_hi:[1,0]
v_pk_mul_f32 v[242:243],v[242:243],v[62:63] op_sel_hi:[1,0]
v_pk_mul_f32 v[76:77],v[76:77],v[64:65] op_sel_hi:[1,0]
v_pk_mul_f32 v[78:79],v[78:79],v[64:65] op_sel_hi:[1,0]
v_pk_mul_f32 v[244:245],v[244:245],v[62:63] op_sel_hi:[1,0]
v_pk_mul_f32 v[246:247],v[246:247],v[62:63] op_sel_hi:[1,0]
v_pk_mul_f32 v[84:85],v[84:85],v[64:65] op_sel_hi:[1,0]
v_pk_mul_f32 v[86:87],v[86:87],v[64:65] op_sel_hi:[1,0]
v_cvt_pk_bf16_f32 v96,v96,v97
v_cvt_pk_bf16_f32 v97,v98,v99
s_waitcnt lgkmcnt(0)
v_mfma_f32_16x16x32_bf16 v[72:75],v[116:119],a[148:151],v[72:75]
buffer_load_dwordx4 v8,s[8:11],s25 offen offset:2048 lds
v_mfma_f32_16x16x32_bf16 v[80:83],v[116:119],a[172:175],v[80:83]
s_add_u32 m0,s23,24576
ds_write_b64 v39,v[96:97] offset:18432
v_mfma_f32_16x16x32_bf16 v[88:91],v[116:119],a[196:199],v[88:91]
ds_read_b128 v[100:103],v10 offset:18432
ds_read_b128 v[156:159],v10 offset:19456
v_add_u32 v39,v39,v19
ds_read_b128 v[116:119],v1 offset:6272
v_pk_mul_f32 v[248:249],v[248:249],v[62:63] op_sel_hi:[1,0]
v_pk_mul_f32 v[250:251],v[250:251],v[62:63] op_sel_hi:[1,0]
v_pk_mul_f32 v[104:105],v[104:105],v[64:65] op_sel_hi:[1,0]
v_pk_mul_f32 v[106:107],v[106:107],v[64:65] op_sel_hi:[1,0]
v_accvgpr_read_b32 v98,a34
v_accvgpr_read_b32 v99,a35
v_mfma_f32_16x16x32_bf16 v[72:75],v[120:123],a[152:155],v[72:75]
v_accvgpr_read_b32 v96,a32
v_accvgpr_read_b32 v97,a33
v_mfma_f32_16x16x32_bf16 v[80:83],v[120:123],a[176:179],v[80:83]
v_cvt_pk_bf16_f32 v208,v208,v209
v_cvt_pk_bf16_f32 v224,v224,v225
v_mfma_f32_16x16x32_bf16 v[88:91],v[120:123],a[200:203],v[88:91]
buffer_load_dwordx4 v6,s[8:11],s21 offen offset:0 lds
ds_read_b128 v[120:123],v0 offset:6400
v_cvt_pk_bf16_f32 v209,v210,v211
v_pk_mul_f32 v[252:253],v[252:253],v[62:63] op_sel_hi:[1,0]
v_pk_mul_f32 v[254:255],v[254:255],v[62:63] op_sel_hi:[1,0]
v_pk_mul_f32 v[108:109],v[108:109],v[64:65] op_sel_hi:[1,0]
v_pk_mul_f32 v[110:111],v[110:111],v[64:65] op_sel_hi:[1,0]
v_cvt_pk_bf16_f32 v225,v226,v227
v_accvgpr_read_b32 v210,a22
v_mfma_f32_16x16x32_bf16 v[72:75],v[124:127],a[156:159],v[72:75]
s_waitcnt vmcnt(11)
ds_read_b128 a[216:219],v11 offset:0
s_waitcnt lgkmcnt(3)
buffer_store_dwordx4 v[100:103],v9,s[16:19],s87 offen offset:256 nt
ds_read_b128 a[220:223],v12 offset:0
v_accvgpr_read_b32 v211,a23
v_accvgpr_read_b32 v226,a38
v_mfma_f32_16x16x32_bf16 v[80:83],v[124:127],a[180:183],v[80:83]
ds_read_b128 a[224:227],v11 offset:128
v_accvgpr_read_b32 v227,a39
v_mfma_f32_16x16x32_bf16 v[88:91],v[124:127],a[204:207],v[88:91]
ds_read_b128 a[228:231],v12 offset:128
ds_read_b128 a[232:235],v11 offset:256
buffer_store_dwordx4 v[156:159],v9,s[16:19],s87 offen offset:3328 nt
ds_read_b128 a[236:239],v12 offset:256
v_pk_mul_f32 v[92:93],v[92:93],v[64:65] op_sel_hi:[1,0]
ds_read_b128 v[124:127],v1 offset:6400
v_pk_mul_f32 v[94:95],v[94:95],v[64:65] op_sel_hi:[1,0]
v_pk_mul_f32 v[96:97],v[96:97],v[64:65] op_sel_hi:[1,0]
v_pk_mul_f32 v[98:99],v[98:99],v[64:65] op_sel_hi:[1,0]
v_cvt_pk_bf16_f32 v212,v212,v213
ds_write2st64_b64 v36,v[208:209],v[224:225] offset0:12 offset1:14
v_mfma_f32_16x16x32_bf16 v[72:75],v[128:131],a[160:163],v[72:75]
v_accvgpr_read_b32 v208,a20
v_accvgpr_read_b32 v209,a21
v_mfma_f32_16x16x32_bf16 v[80:83],v[128:131],a[184:187],v[80:83]
buffer_load_dwordx4 v7,s[8:11],s21 offen offset:1024 lds
v_mfma_f32_16x16x32_bf16 v[88:91],v[128:131],a[208:211],v[88:91]
ds_read_b128 v[128:131],v0 offset:0
v_accvgpr_read_b32 v224,a36
v_accvgpr_read_b32 v225,a37
v_cvt_pk_bf16_f32 v228,v228,v229
v_cvt_pk_bf16_f32 v216,v216,v217
v_pk_mul_f32 v[208:209],v[208:209],v[64:65] op_sel_hi:[1,0]
v_pk_mul_f32 v[210:211],v[210:211],v[64:65] op_sel_hi:[1,0]
v_pk_mul_f32 v[226:227],v[226:227],v[64:65] op_sel_hi:[1,0]
v_pk_mul_f32 v[224:225],v[224:225],v[64:65] op_sel_hi:[1,0]
v_cvt_pk_bf16_f32 v232,v232,v233
v_cvt_pk_bf16_f32 v213,v214,v215
v_mfma_f32_16x16x32_bf16 v[72:75],v[132:135],a[164:167],v[72:75]
v_cvt_pk_bf16_f32 v229,v230,v231
v_cvt_pk_bf16_f32 v220,v220,v221
v_mfma_f32_16x16x32_bf16 v[80:83],v[132:135],a[188:191],v[80:83]
ds_write2st64_b64 v37,v[212:213],v[228:229] offset0:12 offset1:14
v_mfma_f32_16x16x32_bf16 v[88:91],v[132:135],a[212:215],v[88:91]
v_cvt_pk_bf16_f32 v236,v236,v237
ds_read_b128 v[132:135],v1 offset:0
v_cvt_pk_bf16_f32 v217,v218,v219
v_cvt_pk_bf16_f32 v233,v234,v235
v_cvt_pk_bf16_f32 v240,v240,v241
v_cvt_pk_bf16_f32 v76,v76,v77
v_cvt_pk_bf16_f32 v221,v222,v223
ds_write2st64_b64 v38,v[216:217],v[232:233] offset0:12 offset1:14
v_cvt_pk_bf16_f32 v237,v238,v239
v_cvt_pk_bf16_f32 v241,v242,v243
v_cvt_pk_bf16_f32 v77,v78,v79
buffer_load_dwordx4 v8,s[8:11],s21 offen offset:2048 lds
v_cvt_pk_bf16_f32 v244,v244,v245
v_cvt_pk_bf16_f32 v84,v84,v85
v_accvgpr_read_b32 v100,a24
ds_write2st64_b64 v39,v[220:221],v[236:237] offset0:12 offset1:14
v_accvgpr_read_b32 v101,a25
v_accvgpr_read_b32 v102,a26
v_accvgpr_read_b32 v103,a27
v_accvgpr_read_b32 v214,a42
v_accvgpr_read_b32 v215,a43
v_accvgpr_read_b32 v212,a40
v_accvgpr_read_b32 v213,a41
v_cvt_pk_bf16_f32 v245,v246,v247
v_cvt_pk_bf16_f32 v85,v86,v87
v_cvt_pk_bf16_f32 v248,v248,v249
v_cvt_pk_bf16_f32 v104,v104,v105
ds_write2st64_b64 v36,v[240:241],v[76:77] offset0:16 offset1:24
v_mfma_f32_16x16x32_bf16 v[76:79],v[136:139],a[144:147],0
s_add_u32 s21,s21,12288
v_cvt_pk_bf16_f32 v252,v252,v253
v_cvt_pk_bf16_f32 v108,v108,v109
v_cvt_pk_bf16_f32 v249,v250,v251
v_cvt_pk_bf16_f32 v105,v106,v107
v_cvt_pk_bf16_f32 v92,v92,v93
v_pk_mul_f32 v[100:101],v[100:101],v[64:65] op_sel_hi:[1,0]
v_pk_mul_f32 v[102:103],v[102:103],v[64:65] op_sel_hi:[1,0]
v_pk_mul_f32 v[212:213],v[212:213],v[64:65] op_sel_hi:[1,0]
v_pk_mul_f32 v[214:215],v[214:215],v[64:65] op_sel_hi:[1,0]
ds_write2st64_b64 v37,v[244:245],v[84:85] offset0:16 offset1:24
v_cvt_pk_bf16_f32 v96,v96,v97
v_mfma_f32_16x16x32_bf16 v[84:87],v[136:139],a[168:171],0
s_mov_b32 s27,s42
v_cvt_pk_bf16_f32 v253,v254,v255
v_cvt_pk_bf16_f32 v109,v110,v111
v_cvt_pk_bf16_f32 v93,v94,v95
v_cvt_pk_bf16_f32 v97,v98,v99
v_accvgpr_read_b32 v230,a30
v_accvgpr_read_b32 v231,a31
v_accvgpr_read_b32 v228,a28
v_accvgpr_read_b32 v229,a29
ds_write2st64_b64 v38,v[248:249],v[104:105] offset0:16 offset1:24
v_accvgpr_read_b32 v218,a46
v_accvgpr_read_b32 v219,a47
v_accvgpr_read_b32 v216,a44
v_accvgpr_read_b32 v217,a45
v_cvt_pk_bf16_f32 v208,v208,v209
v_cvt_pk_bf16_f32 v224,v224,v225
v_cvt_pk_bf16_f32 v100,v100,v101
v_cvt_pk_bf16_f32 v212,v212,v213
v_cvt_pk_bf16_f32 v209,v210,v211
v_cvt_pk_bf16_f32 v225,v226,v227
v_cvt_pk_bf16_f32 v101,v102,v103
ds_write2st64_b64 v39,v[252:253],v[108:109] offset0:16 offset1:24
v_cvt_pk_bf16_f32 v213,v214,v215
v_max3_f32 v40,v72,v73,v74
v_max3_f32 v44,v80,v81,v82
v_max3_f32 v48,v88,v89,v90
v_mov_b32 v66,0
v_mov_b32 v67,0
v_mov_b32 v62,0
v_mov_b32 v63,0
s_mov_b32 s42,s41
s_add_u32 s69,s69,1
s_lshl_b32 s62,s69,5
ds_write2st64_b64 v36,v[92:93],v[96:97] offset0:26 offset1:28
v_mfma_f32_16x16x32_bf16 v[92:95],v[136:139],a[192:195],0
s_add_u32 s62,s62,s34
s_mul_i32 s63,s62,171
s_lshr_b32 s63,s63,9
v_mfma_f32_16x16x32_bf16 v[76:79],v[140:143],a[148:151],v[76:79]
s_mul_i32 s64,s63,3
ds_read_b128 v[136:139],v0 offset:128
s_sub_u32 s62,s62,s64
s_add_u32 s63,s63,s33
s_mul_i32 s30,s63,196608
s_mul_i32 s41,s63,325632
ds_write2st64_b64 v37,v[208:209],v[224:225] offset0:26 offset1:28
v_pk_mul_f32 v[228:229],v[228:229],v[64:65] op_sel_hi:[1,0]
v_pk_mul_f32 v[230:231],v[230:231],v[64:65] op_sel_hi:[1,0]
v_pk_mul_f32 v[216:217],v[216:217],v[64:65] op_sel_hi:[1,0]
v_pk_mul_f32 v[218:219],v[218:219],v[64:65] op_sel_hi:[1,0]
v_cvt_pk_bf16_f32 v228,v228,v229
v_cvt_pk_bf16_f32 v216,v216,v217
v_mfma_f32_16x16x32_bf16 v[84:87],v[140:143],a[172:175],v[84:87]
s_lshl_b32 s63,s3,2
v_cvt_pk_bf16_f32 v229,v230,v231
v_cvt_pk_bf16_f32 v217,v218,v219
v_mfma_f32_16x16x32_bf16 v[92:95],v[140:143],a[196:199],v[92:95]
s_add_u32 s64,s63,21
ds_read_b128 v[140:143],v1 offset:128
v_mov_b32 v64,0
v_mfma_f32_16x16x32_bf16 v[76:79],v[112:115],a[152:155],v[76:79]
s_cmp_eq_u32 s3,0
ds_write2st64_b64 v38,v[100:101],v[212:213] offset0:26 offset1:28
v_pk_mul_f32 v[160:161],v[160:161],v[60:61] op_sel_hi:[1,0]
v_pk_mul_f32 v[162:163],v[162:163],v[60:61] op_sel_hi:[1,0]
v_pk_mul_f32 v[176:177],v[176:177],v[60:61] op_sel_hi:[1,0]
v_pk_mul_f32 v[178:179],v[178:179],v[60:61] op_sel_hi:[1,0]
v_cvt_pk_bf16_f32 v160,v160,v161
v_cvt_pk_bf16_f32 v176,v176,v177
v_mfma_f32_16x16x32_bf16 v[84:87],v[112:115],a[176:179],v[84:87]
s_cselect_b32 s64,20,s64
v_cvt_pk_bf16_f32 v161,v162,v163
v_cvt_pk_bf16_f32 v177,v178,v179
v_mfma_f32_16x16x32_bf16 v[92:95],v[112:115],a[200:203],v[92:95]
s_cselect_b32 s40,1,0
ds_read_b128 v[112:115],v0 offset:256
v_mov_b32 v65,0
s_waitcnt lgkmcnt(3)
v_mfma_f32_16x16x32_bf16 v[76:79],v[116:119],a[156:159],v[76:79]
s_add_u32 s65,s63,37
ds_write2st64_b64 v39,v[228:229],v[216:217] offset0:26 offset1:28
v_pk_mul_f32 v[164:165],v[164:165],v[60:61] op_sel_hi:[1,0]
v_pk_mul_f32 v[166:167],v[166:167],v[60:61] op_sel_hi:[1,0]
v_pk_mul_f32 v[180:181],v[180:181],v[60:61] op_sel_hi:[1,0]
v_pk_mul_f32 v[182:183],v[182:183],v[60:61] op_sel_hi:[1,0]
v_cvt_pk_bf16_f32 v164,v164,v165
v_cvt_pk_bf16_f32 v180,v180,v181
v_mfma_f32_16x16x32_bf16 v[84:87],v[116:119],a[180:183],v[84:87]
s_cmp_eq_u32 s62,2
v_cvt_pk_bf16_f32 v165,v166,v167
v_cvt_pk_bf16_f32 v181,v182,v183
v_mfma_f32_16x16x32_bf16 v[92:95],v[116:119],a[204:207],v[92:95]
s_cselect_b32 s64,s65,s64
ds_read_b128 v[116:119],v1 offset:256
s_cselect_b32 s40,0,s40
v_mfma_f32_16x16x32_bf16 v[76:79],v[120:123],a[160:163],v[76:79]
s_add_u32 s65,s63,s3
ds_write2st64_b64 v36,v[160:161],v[176:177] offset0:0 offset1:2
v_mfma_f32_16x16x32_bf16 v[84:87],v[120:123],a[184:187],v[84:87]
s_cmp_eq_u32 s62,0
s_cselect_b32 s64,s65,s64
s_cselect_b32 s40,1,s40
s_mul_i32 s64,s64,6144
s_add_u32 s41,s41,s64
s_cmp_ge_u32 s69,6
v_pk_mul_f32 v[168:169],v[168:169],v[60:61] op_sel_hi:[1,0]
v_pk_mul_f32 v[170:171],v[170:171],v[60:61] op_sel_hi:[1,0]
v_pk_mul_f32 v[184:185],v[184:185],v[60:61] op_sel_hi:[1,0]
v_pk_mul_f32 v[186:187],v[186:187],v[60:61] op_sel_hi:[1,0]
v_cvt_pk_bf16_f32 v168,v168,v169
v_cvt_pk_bf16_f32 v184,v184,v185
v_mfma_f32_16x16x32_bf16 v[92:95],v[120:123],a[208:211],v[92:95]
s_cselect_b32 s41,166723584,s41
ds_write2st64_b64 v37,v[164:165],v[180:181] offset0:0 offset1:2
v_mfma_f32_16x16x32_bf16 v[76:79],v[124:127],a[164:167],v[76:79]
s_cselect_b32 s30,100663296,s30
v_cvt_pk_bf16_f32 v169,v170,v171
v_cvt_pk_bf16_f32 v185,v186,v187
v_mfma_f32_16x16x32_bf16 v[84:87],v[124:127],a[188:191],v[84:87]
s_add_u32 s25,s30,s22
ds_read_b128 v[120:123],v0 offset:6144
s_add_u32 s26,s25,12288
s_add_u32 m0,s22,0
s_mov_b32 s28,s41
v_max3_f32 v40,v40,v75,v76
ds_write2st64_b64 v38,v[168:169],v[184:185] offset0:0 offset1:2
v_pk_mul_f32 v[172:173],v[172:173],v[60:61] op_sel_hi:[1,0]
v_pk_mul_f32 v[174:175],v[174:175],v[60:61] op_sel_hi:[1,0]
v_pk_mul_f32 v[188:189],v[188:189],v[60:61] op_sel_hi:[1,0]
v_pk_mul_f32 v[190:191],v[190:191],v[60:61] op_sel_hi:[1,0]
v_max3_f32 v40,v40,v77,v78
v_max_f32 v40,v40,v79
v_mfma_f32_16x16x32_bf16 v[92:95],v[124:127],a[212:215],v[92:95]
s_mov_b32 s29,s24
ds_read_b128 v[124:127],v1 offset:6144
v_mov_b32 v41,v40
v_mfma_f32_16x16x32_bf16 v[96:99],v[128:131],a[216:219],0
ds_read_b128 v[128:131],v0 offset:6272
v_max3_f32 v44,v44,v83,v84
v_mfma_f32_16x16x32_bf16 v[96:99],v[132:135],a[220:223],v[96:99]
ds_read_b128 v[132:135],v1 offset:6272
v_permlane32_swap_b32 v41,v40
v_max3_f32 v44,v44,v85,v86
v_max_f32 v40,v40,v41
v_pk_mul_f32 v[192:193],v[192:193],v[60:61] op_sel_hi:[1,0]
v_pk_mul_f32 v[194:195],v[194:195],v[60:61] op_sel_hi:[1,0]
v_max_f32 v44,v44,v87
v_mov_b32 v41,v40
v_mfma_f32_16x16x32_bf16 v[96:99],v[136:139],a[224:227],v[96:99]
s_waitcnt lgkmcnt(4)
ds_read_b128 v[136:139],v0 offset:6400
v_mov_b32 v45,v44
v_mfma_f32_16x16x32_bf16 v[96:99],v[140:143],a[228:231],v[96:99]
ds_read_b128 v[140:143],v1 offset:6400
v_permlane16_swap_b32 v41,v40
v_mfma_f32_16x16x32_bf16 v[96:99],v[112:115],a[232:235],v[96:99]
ds_read_b128 v[112:115],v0 offset:12544
v_max3_f32 v48,v48,v91,v92
v_permlane32_swap_b32 v45,v44
v_max_f32 v40,v40,v41
v_pk_mul_f32 v[196:197],v[196:197],v[60:61] op_sel_hi:[1,0]
v_pk_mul_f32 v[198:199],v[198:199],v[60:61] op_sel_hi:[1,0]
v_max3_f32 v48,v48,v93,v94
v_max_f32 v44,v44,v45
v_mfma_f32_16x16x32_bf16 v[96:99],v[116:119],a[236:239],v[96:99]
ds_read_b128 v[116:119],v1 offset:12544
v_mul_f32_e64 v13,-s36,v40
v_mfma_f32_16x16x32_bf16 v[100:103],v[120:123],a[216:219],0
s_waitcnt lgkmcnt(4)
ds_read_b128 v[120:123],v0 offset:18432
v_max_f32 v48,v48,v95
v_mfma_f32_16x16x32_bf16 v[100:103],v[124:127],a[220:223],v[100:103]
ds_read_b128 v[124:127],v1 offset:18432
v_mov_b32 v45,v44
v_mfma_f32_16x16x32_bf16 v[100:103],v[128:131],a[224:227],v[100:103]
ds_read_b128 v[128:131],v0 offset:12288
v_fma_f32 v72,v72,s36,v13
v_fma_f32 v73,v73,s36,v13
v_fma_f32 v74,v74,s36,v13
v_fma_f32 v75,v75,s36,v13
v_pk_mul_f32 v[200:201],v[200:201],v[60:61] op_sel_hi:[1,0]
v_pk_mul_f32 v[202:203],v[202:203],v[60:61] op_sel_hi:[1,0]
v_max3_f32 v52,v96,v97,v98
v_mov_b32 v49,v48
v_mfma_f32_16x16x32_bf16 v[100:103],v[132:135],a[228:231],v[100:103]
s_waitcnt lgkmcnt(4)
ds_read_b128 v[132:135],v1 offset:12288
v_permlane16_swap_b32 v45,v44
v_mfma_f32_16x16x32_bf16 v[100:103],v[136:139],a[232:235],v[100:103]
ds_read_b128 v[136:139],v0 offset:12416
v_exp_f32 v72,v72
v_mfma_f32_16x16x32_bf16 v[100:103],v[140:143],a[236:239],v[100:103]
ds_read_b128 v[140:143],v1 offset:12416
v_exp_f32 v73,v73
v_exp_f32 v74,v74
v_pk_mul_f32 v[204:205],v[204:205],v[60:61] op_sel_hi:[1,0]
v_pk_mul_f32 v[206:207],v[206:207],v[60:61] op_sel_hi:[1,0]
v_exp_f32 v75,v75
v_permlane32_swap_b32 v49,v48
v_max_f32 v44,v44,v45
v_max3_f32 v52,v52,v99,v100
v_max_f32 v48,v48,v49
v_mul_f32_e64 v14,-s36,v44
v_max3_f32 v52,v52,v101,v102
v_cvt_pk_bf16_f32 v20,v72,v73
v_cvt_pk_bf16_f32 v21,v74,v75
s_waitcnt lgkmcnt(3)
v_mfma_f32_16x16x32_bf16 v[72:75],v[128:131],a[144:147],0
v_mov_b32 v49,v48
v_fma_f32 v80,v80,s36,v14
v_fma_f32 v81,v81,s36,v14
v_fma_f32 v82,v82,s36,v14
v_fma_f32 v83,v83,s36,v14
v_max_f32 v52,v52,v103
v_permlane16_swap_b32 v49,v48
v_exp_f32 v80,v80
v_exp_f32 v81,v81
v_exp_f32 v82,v82
v_exp_f32 v83,v83
v_mov_b32 v53,v52
v_max_f32 v48,v48,v49
v_mul_f32_e64 v15,-s36,v48
v_permlane32_swap_b32 v53,v52
v_max_f32 v52,v52,v53
v_cvt_pk_bf16_f32 v24,v80,v81
v_cvt_pk_bf16_f32 v25,v82,v83
v_mfma_f32_16x16x32_bf16 v[80:83],v[128:131],a[168:171],0
v_fma_f32 v88,v88,s36,v15
v_fma_f32 v89,v89,s36,v15
v_fma_f32 v90,v90,s36,v15
v_fma_f32 v91,v91,s36,v15
v_mov_b32 v53,v52
v_exp_f32 v88,v88
v_exp_f32 v89,v89
v_exp_f32 v90,v90
v_exp_f32 v91,v91
v_permlane16_swap_b32 v53,v52
v_max_f32 v52,v52,v53
v_mul_f32_e64 v16,-s36,v52
v_cvt_pk_bf16_f32 v28,v88,v89
v_cvt_pk_bf16_f32 v29,v90,v91
v_mfma_f32_16x16x32_bf16 v[88:91],v[128:131],a[192:195],0
v_fma_f32 v96,v96,s36,v16
v_fma_f32 v97,v97,s36,v16
v_fma_f32 v98,v98,s36,v16
v_fma_f32 v99,v99,s36,v16
v_exp_f32 v96,v96
v_exp_f32 v97,v97
v_exp_f32 v98,v98
v_exp_f32 v99,v99
v_cvt_pk_bf16_f32 v32,v96,v97
v_cvt_pk_bf16_f32 v33,v98,v99
v_mfma_f32_16x16x32_bf16 v[96:99],v[128:131],a[216:219],0
s_waitcnt lgkmcnt(0)
ds_read_b128 v[128:131],v0 offset:18560
v_fma_f32 v76,v76,s36,v13
v_mfma_f32_16x16x32_bf16 v[72:75],v[132:135],a[148:151],v[72:75]
v_fma_f32 v77,v77,s36,v13
v_fma_f32 v78,v78,s36,v13
v_mfma_f32_16x16x32_bf16 v[80:83],v[132:135],a[172:175],v[80:83]
v_fma_f32 v79,v79,s36,v13
v_exp_f32 v76,v76
v_mfma_f32_16x16x32_bf16 v[88:91],v[132:135],a[196:199],v[88:91]
v_exp_f32 v77,v77
v_mfma_f32_16x16x32_bf16 v[96:99],v[132:135],a[220:223],v[96:99]
ds_read_b128 v[132:135],v1 offset:18560
v_exp_f32 v78,v78
v_mfma_f32_16x16x32_bf16 v[72:75],v[136:139],a[152:155],v[72:75]
v_exp_f32 v79,v79
v_mfma_f32_16x16x32_bf16 v[80:83],v[136:139],a[176:179],v[80:83]
s_waitcnt vmcnt(5)
s_barrier
v_mfma_f32_16x16x32_bf16 v[88:91],v[136:139],a[200:203],v[88:91]
v_fma_f32 v84,v84,s36,v14
v_fma_f32 v85,v85,s36,v14
v_mfma_f32_16x16x32_bf16 v[96:99],v[136:139],a[224:227],v[96:99]
buffer_load_dwordx4 v6,s[4:7],s20 offen offset:0 lds
v_mfma_f32_16x16x32_bf16 v[72:75],v[140:143],a[156:159],v[72:75]
ds_read_b128 v[136:139],v0 offset:18688
v_fma_f32 v86,v86,s36,v14
v_mfma_f32_16x16x32_bf16 v[80:83],v[140:143],a[180:183],v[80:83]
v_fma_f32 v87,v87,s36,v14
v_cvt_pk_bf16_f32 v22,v76,v77
v_mfma_f32_16x16x32_bf16 v[88:91],v[140:143],a[204:207],v[88:91]
v_cvt_pk_bf16_f32 v23,v78,v79
v_exp_f32 v84,v84
v_mfma_f32_16x16x32_bf16 v[96:99],v[140:143],a[228:231],v[96:99]
ds_read_b128 v[140:143],v1 offset:18688
v_exp_f32 v85,v85
v_mfma_f32_16x16x32_bf16 v[72:75],v[112:115],a[160:163],v[72:75]
buffer_load_dwordx4 v7,s[4:7],s20 offen offset:1024 lds
v_mfma_f32_16x16x32_bf16 v[80:83],v[112:115],a[184:187],v[80:83]
v_exp_f32 v86,v86
v_mfma_f32_16x16x32_bf16 v[88:91],v[112:115],a[208:211],v[88:91]
v_exp_f32 v87,v87
v_mfma_f32_16x16x32_bf16 v[96:99],v[112:115],a[232:235],v[96:99]
v_fma_f32 v92,v92,s36,v15
v_fma_f32 v93,v93,s36,v15
v_mfma_f32_16x16x32_bf16 v[72:75],v[116:119],a[164:167],v[72:75]
ds_read_b64_tr_b16 v[112:113],v2 offset:0
ds_read_b64_tr_b16 v[114:115],v2 offset:6144
v_mfma_f32_16x16x32_bf16 v[80:83],v[116:119],a[188:191],v[80:83]
v_fma_f32 v94,v94,s36,v15
v_fma_f32 v95,v95,s36,v15
v_mfma_f32_16x16x32_bf16 v[88:91],v[116:119],a[212:215],v[88:91]
buffer_load_dwordx4 v8,s[4:7],s20 offen offset:2048 lds
v_mfma_f32_16x16x32_bf16 v[96:99],v[116:119],a[236:239],v[96:99]
s_add_u32 s20,s20,12288
ds_read_b64_tr_b16 v[116:117],v3 offset:0
ds_read_b64_tr_b16 v[118:119],v3 offset:6144
v_mfma_f32_16x16x32_bf16 v[76:79],v[120:123],a[144:147],0
v_cvt_pk_bf16_f32 v26,v84,v85
v_cvt_pk_bf16_f32 v27,v86,v87
v_mfma_f32_16x16x32_bf16 v[84:87],v[120:123],a[168:171],0
v_exp_f32 v92,v92
v_exp_f32 v93,v93
v_exp_f32 v94,v94
v_exp_f32 v95,v95
v_fma_f32 v100,v100,s36,v16
v_fma_f32 v101,v101,s36,v16
v_fma_f32 v102,v102,s36,v16
v_fma_f32 v103,v103,s36,v16
v_cvt_pk_bf16_f32 v30,v92,v93
v_cvt_pk_bf16_f32 v31,v94,v95
v_mfma_f32_16x16x32_bf16 v[92:95],v[120:123],a[192:195],0
v_exp_f32 v100,v100
v_exp_f32 v101,v101
v_exp_f32 v102,v102
v_exp_f32 v103,v103
v_cvt_pk_bf16_f32 v34,v100,v101
v_cvt_pk_bf16_f32 v35,v102,v103
v_mfma_f32_16x16x32_bf16 v[100:103],v[120:123],a[216:219],0
ds_read_b64_tr_b16 v[120:121],v4 offset:0
ds_read_b64_tr_b16 v[122:123],v4 offset:6144
v_smfmac_f32_16x16x64_bf16 v[64:67],v[152:155],v[28:35],v18
v_cvt_pk_bf16_f32 v172,v172,v173
v_mfma_f32_16x16x32_bf16 v[76:79],v[124:127],a[148:151],v[76:79]
v_cvt_pk_bf16_f32 v188,v188,v189
v_mov_b32 v60,0
v_mfma_f32_16x16x32_bf16 v[84:87],v[124:127],a[172:175],v[84:87]
v_mov_b32 v61,0
v_cvt_pk_bf16_f32 v192,v192,v193
v_mfma_f32_16x16x32_bf16 v[92:95],v[124:127],a[196:199],v[92:95]
v_cvt_pk_bf16_f32 v173,v174,v175
v_cvt_pk_bf16_f32 v189,v190,v191
v_smfmac_f32_16x16x64_bf16 v[60:63],v[152:155],v[20:27],v18
ds_write2st64_b64 v39,v[172:173],v[188:189] offset0:0 offset1:2
v_mfma_f32_16x16x32_bf16 v[100:103],v[124:127],a[220:223],v[100:103]
s_waitcnt lgkmcnt(3)
v_cvt_pk_bf16_f32 v196,v196,v197
v_fma_f32 v72,v72,s36,v13
v_mfma_f32_16x16x32_bf16 v[76:79],v[128:131],a[152:155],v[76:79]
ds_read_b64_tr_b16 v[124:125],v5 offset:0
ds_read_b64_tr_b16 v[126:127],v5 offset:6144
v_mfma_f32_16x16x32_bf16 v[84:87],v[128:131],a[176:179],v[84:87]
v_fma_f32 v73,v73,s36,v13
v_fma_f32 v74,v74,s36,v13
v_mfma_f32_16x16x32_bf16 v[92:95],v[128:131],a[200:203],v[92:95]
v_fma_f32 v75,v75,s36,v13
v_fma_f32 v80,v80,s36,v14
v_mfma_f32_16x16x32_bf16 v[100:103],v[128:131],a[224:227],v[100:103]
v_fma_f32 v81,v81,s36,v14
v_cvt_pk_bf16_f32 v193,v194,v195
v_mfma_f32_16x16x32_bf16 v[76:79],v[132:135],a[156:159],v[76:79]
ds_write_b64 v36,v[192:193] offset:2048
v_mfma_f32_16x16x32_bf16 v[84:87],v[132:135],a[180:183],v[84:87]
v_cvt_pk_bf16_f32 v200,v200,v201
v_cvt_pk_bf16_f32 v197,v198,v199
v_mfma_f32_16x16x32_bf16 v[92:95],v[132:135],a[204:207],v[92:95]
ds_write_b64 v37,v[196:197] offset:2048
v_mfma_f32_16x16x32_bf16 v[100:103],v[132:135],a[228:231],v[100:103]
v_exp_f32 v72,v72
v_mfma_f32_16x16x32_bf16 v[76:79],v[136:139],a[160:163],v[76:79]
v_exp_f32 v73,v73
v_mfma_f32_16x16x32_bf16 v[84:87],v[136:139],a[184:187],v[84:87]
v_exp_f32 v74,v74
v_mfma_f32_16x16x32_bf16 v[92:95],v[136:139],a[208:211],v[92:95]
v_exp_f32 v75,v75
v_mfma_f32_16x16x32_bf16 v[100:103],v[136:139],a[232:235],v[100:103]
v_exp_f32 v80,v80
v_mfma_f32_16x16x32_bf16 v[76:79],v[140:143],a[164:167],v[76:79]
v_exp_f32 v81,v81
v_mfma_f32_16x16x32_bf16 v[84:87],v[140:143],a[188:191],v[84:87]
v_cvt_pk_bf16_f32 v204,v204,v205
v_cvt_pk_bf16_f32 v201,v202,v203
v_mfma_f32_16x16x32_bf16 v[92:95],v[140:143],a[212:215],v[92:95]
ds_write_b64 v38,v[200:201] offset:2048
v_mfma_f32_16x16x32_bf16 v[100:103],v[140:143],a[236:239],v[100:103]
v_cvt_pk_bf16_f32 v205,v206,v207
v_cvt_pk_bf16_f32 v40,v72,v73
ds_write_b64 v39,v[204:205] offset:2048
v_cvt_pk_bf16_f32 v41,v74,v75
v_cvt_pk_bf16_f32 v44,v80,v81
v_mfma_f32_16x16x32_bf16 v[160:163],v[112:115],v[20:23],0
s_add_u32 m0,s23,0
ds_read_b64_tr_b16 v[128:129],v2 offset:128
ds_read_b64_tr_b16 v[130:131],v2 offset:6272
v_mfma_f32_16x16x32_bf16 v[208:211],v[112:115],v[24:27],0
ds_read_b64_tr_b16 v[132:133],v3 offset:128
ds_read_b64_tr_b16 v[134:135],v3 offset:6272
v_mfma_f32_16x16x32_bf16 a[0:3],v[112:115],v[28:31],0
ds_read_b64_tr_b16 v[136:137],v4 offset:128
ds_read_b64_tr_b16 v[138:139],v4 offset:6272
v_mfma_f32_16x16x32_bf16 a[48:51],v[112:115],v[32:35],0
ds_read_b64_tr_b16 v[140:141],v5 offset:128
ds_read_b64_tr_b16 v[142:143],v5 offset:6272
v_mfma_f32_16x16x32_bf16 v[164:167],v[116:119],v[20:23],0
ds_read_b64_tr_b16 v[112:113],v2 offset:256
ds_read_b64_tr_b16 v[114:115],v2 offset:6400
v_mfma_f32_16x16x32_bf16 v[212:215],v[116:119],v[24:27],0
v_fma_f32 v82,v82,s36,v14
v_fma_f32 v83,v83,s36,v14
v_mfma_f32_16x16x32_bf16 a[4:7],v[116:119],v[28:31],0
v_exp_f32 v82,v82
v_mfma_f32_16x16x32_bf16 a[52:55],v[116:119],v[32:35],0
s_waitcnt lgkmcnt(10)
ds_read_b64_tr_b16 v[116:117],v3 offset:256
ds_read_b64_tr_b16 v[118:119],v3 offset:6400
v_mfma_f32_16x16x32_bf16 v[168:171],v[120:123],v[20:23],0
v_exp_f32 v83,v83
v_mfma_f32_16x16x32_bf16 v[216:219],v[120:123],v[24:27],0
v_cvt_pk_bf16_f32 v45,v82,v83
v_fma_f32 v88,v88,s36,v15
v_mfma_f32_16x16x32_bf16 a[8:11],v[120:123],v[28:31],0
v_fma_f32 v89,v89,s36,v15
v_fma_f32 v90,v90,s36,v15
v_mfma_f32_16x16x32_bf16 a[56:59],v[120:123],v[32:35],0
ds_read_b64_tr_b16 v[120:121],v4 offset:256
ds_read_b64_tr_b16 v[122:123],v4 offset:6400
v_mfma_f32_16x16x32_bf16 v[172:175],v[124:127],v[20:23],0
v_fma_f32 v91,v91,s36,v15
v_fma_f32 v96,v96,s36,v16
v_mfma_f32_16x16x32_bf16 v[220:223],v[124:127],v[24:27],0
v_exp_f32 v88,v88
v_mfma_f32_16x16x32_bf16 a[12:15],v[124:127],v[28:31],0
v_exp_f32 v89,v89
v_mfma_f32_16x16x32_bf16 a[60:63],v[124:127],v[32:35],0
s_waitcnt lgkmcnt(3)
ds_read_b64_tr_b16 v[124:125],v5 offset:256
ds_read_b64_tr_b16 v[126:127],v5 offset:6400
v_mfma_f32_16x16x32_bf16 v[176:179],v[128:131],v[20:23],0
v_exp_f32 v90,v90
v_mfma_f32_16x16x32_bf16 v[224:227],v[128:131],v[24:27],0
v_exp_f32 v91,v91
v_mfma_f32_16x16x32_bf16 a[16:19],v[128:131],v[28:31],0
v_cvt_pk_bf16_f32 v48,v88,v89
v_cvt_pk_bf16_f32 v49,v90,v91
v_mfma_f32_16x16x32_bf16 a[64:67],v[128:131],v[32:35],0
v_fma_f32 v97,v97,s36,v16
v_fma_f32 v98,v98,s36,v16
v_mfma_f32_16x16x32_bf16 v[180:183],v[132:135],v[20:23],0
v_fma_f32 v99,v99,s36,v16
v_fma_f32 v76,v76,s36,v13
v_mfma_f32_16x16x32_bf16 v[228:231],v[132:135],v[24:27],0
v_exp_f32 v96,v96
v_mfma_f32_16x16x32_bf16 a[20:23],v[132:135],v[28:31],0
v_exp_f32 v97,v97
v_mfma_f32_16x16x32_bf16 a[68:71],v[132:135],v[32:35],0
v_exp_f32 v98,v98
v_mfma_f32_16x16x32_bf16 v[184:187],v[136:139],v[20:23],0
v_exp_f32 v99,v99
v_mfma_f32_16x16x32_bf16 v[232:235],v[136:139],v[24:27],0
v_cvt_pk_bf16_f32 v52,v96,v97
v_cvt_pk_bf16_f32 v53,v98,v99
v_mfma_f32_16x16x32_bf16 a[24:27],v[136:139],v[28:31],0
v_fma_f32 v77,v77,s36,v13
v_fma_f32 v78,v78,s36,v13
v_mfma_f32_16x16x32_bf16 a[72:75],v[136:139],v[32:35],0
v_fma_f32 v79,v79,s36,v13
v_fma_f32 v84,v84,s36,v14
v_mfma_f32_16x16x32_bf16 v[188:191],v[140:143],v[20:23],0
v_exp_f32 v76,v76
v_mfma_f32_16x16x32_bf16 v[236:239],v[140:143],v[24:27],0
v_exp_f32 v77,v77
v_mfma_f32_16x16x32_bf16 a[28:31],v[140:143],v[28:31],0
v_exp_f32 v78,v78
v_mfma_f32_16x16x32_bf16 a[76:79],v[140:143],v[32:35],0
v_exp_f32 v79,v79
v_mfma_f32_16x16x32_bf16 v[192:195],v[112:115],v[20:23],0
v_cvt_pk_bf16_f32 v42,v76,v77
v_cvt_pk_bf16_f32 v43,v78,v79
s_waitcnt vmcnt(24) lgkmcnt(0)
v_mfma_f32_16x16x32_bf16 v[240:243],v[112:115],v[24:27],0
s_barrier
v_mfma_f32_16x16x32_bf16 a[32:35],v[112:115],v[28:31],0
ds_read_b128 v[128:131],v0 offset:24576
v_fma_f32 v85,v85,s36,v14
v_mfma_f32_16x16x32_bf16 a[80:83],v[112:115],v[32:35],0
ds_read_b128 v[132:135],v1 offset:24576
v_fma_f32 v86,v86,s36,v14
v_mfma_f32_16x16x32_bf16 v[196:199],v[116:119],v[20:23],0
ds_read_b128 v[136:139],v0 offset:24704
v_fma_f32 v87,v87,s36,v14
v_mfma_f32_16x16x32_bf16 v[244:247],v[116:119],v[24:27],0
ds_read_b128 v[140:143],v1 offset:24704
v_fma_f32 v92,v92,s36,v15
v_mfma_f32_16x16x32_bf16 a[36:39],v[116:119],v[28:31],0
ds_read_b128 v[112:115],v0 offset:24832
v_fma_f32 v93,v93,s36,v15
v_mfma_f32_16x16x32_bf16 a[84:87],v[116:119],v[32:35],0
buffer_load_dwordx4 v6,s[8:11],s21 offen offset:0 lds
v_mfma_f32_16x16x32_bf16 v[200:203],v[120:123],v[20:23],0
ds_read_b128 v[116:119],v1 offset:24832
v_fma_f32 v94,v94,s36,v15
v_mfma_f32_16x16x32_bf16 v[248:251],v[120:123],v[24:27],0
v_exp_f32 v84,v84
v_mfma_f32_16x16x32_bf16 a[40:43],v[120:123],v[28:31],0
v_exp_f32 v85,v85
v_mfma_f32_16x16x32_bf16 a[88:91],v[120:123],v[32:35],0
ds_read_b128 v[120:123],v0 offset:30720
v_cvt_pk_bf16_f32 v46,v84,v85
v_mfma_f32_16x16x32_bf16 v[204:207],v[124:127],v[20:23],0
v_exp_f32 v86,v86
v_mfma_f32_16x16x32_bf16 v[252:255],v[124:127],v[24:27],0
v_exp_f32 v87,v87
v_mfma_f32_16x16x32_bf16 a[44:47],v[124:127],v[28:31],0
v_cvt_pk_bf16_f32 v47,v86,v87
v_fma_f32 v95,v95,s36,v15
v_mfma_f32_16x16x32_bf16 a[92:95],v[124:127],v[32:35],0
ds_read_b128 v[124:127],v1 offset:30720
v_fma_f32 v100,v100,s36,v16
v_smfmac_f32_16x16x64_bf16 v[60:63],v[152:155],v[40:47],v18
buffer_load_dwordx4 v7,s[8:11],s21 offen offset:1024 lds
s_waitcnt lgkmcnt(2)
v_mfma_f32_16x16x32_bf16 v[72:75],v[128:131],a[144:147],0
v_exp_f32 v92,v92
v_mfma_f32_16x16x32_bf16 v[80:83],v[128:131],a[168:171],0
v_exp_f32 v93,v93
v_mfma_f32_16x16x32_bf16 v[88:91],v[128:131],a[192:195],0
v_exp_f32 v94,v94
v_mfma_f32_16x16x32_bf16 v[96:99],v[128:131],a[216:219],0
ds_read_b128 v[128:131],v0 offset:30848
v_cvt_pk_bf16_f32 v50,v92,v93
v_mfma_f32_16x16x32_bf16 v[72:75],v[132:135],a[148:151],v[72:75]
v_exp_f32 v95,v95
v_mfma_f32_16x16x32_bf16 v[80:83],v[132:135],a[172:175],v[80:83]
v_cvt_pk_bf16_f32 v51,v94,v95
v_fma_f32 v101,v101,s36,v16
v_mfma_f32_16x16x32_bf16 v[88:91],v[132:135],a[196:199],v[88:91]
v_fma_f32 v102,v102,s36,v16
v_fma_f32 v103,v103,s36,v16
v_mfma_f32_16x16x32_bf16 v[96:99],v[132:135],a[220:223],v[96:99]
v_exp_f32 v100,v100
v_mfma_f32_16x16x32_bf16 v[72:75],v[136:139],a[152:155],v[72:75]
buffer_load_dwordx4 v8,s[8:11],s21 offen offset:2048 lds
v_mfma_f32_16x16x32_bf16 v[80:83],v[136:139],a[176:179],v[80:83]
s_add_u32 s21,s21,12288
v_exp_f32 v101,v101
v_mfma_f32_16x16x32_bf16 v[88:91],v[136:139],a[200:203],v[88:91]
s_add_u32 m0,s22,12288
v_exp_f32 v102,v102
v_mfma_f32_16x16x32_bf16 v[96:99],v[136:139],a[224:227],v[96:99]
v_exp_f32 v103,v103
v_mfma_f32_16x16x32_bf16 v[72:75],v[140:143],a[156:159],v[72:75]
v_cvt_pk_bf16_f32 v54,v100,v101
v_cvt_pk_bf16_f32 v55,v102,v103
v_mfma_f32_16x16x32_bf16 v[80:83],v[140:143],a[180:183],v[80:83]
ds_read_b128 v[132:135],v1 offset:30848
v_smfmac_f32_16x16x64_bf16 v[64:67],v[152:155],v[48:55],v18
ds_read_b128 v[136:139],v0 offset:30976
v_mfma_f32_16x16x32_bf16 v[88:91],v[140:143],a[204:207],v[88:91]
v_mfma_f32_16x16x32_bf16 v[96:99],v[140:143],a[228:231],v[96:99]
ds_read_b128 v[140:143],v1 offset:30976
v_mfma_f32_16x16x32_bf16 v[72:75],v[112:115],a[160:163],v[72:75]
buffer_load_dwordx4 v6,s[4:7],s20 offen offset:0 lds
v_mfma_f32_16x16x32_bf16 v[80:83],v[112:115],a[184:187],v[80:83]
v_mfma_f32_16x16x32_bf16 v[88:91],v[112:115],a[208:211],v[88:91]
v_mfma_f32_16x16x32_bf16 v[96:99],v[112:115],a[232:235],v[96:99]
v_mfma_f32_16x16x32_bf16 v[72:75],v[116:119],a[164:167],v[72:75]
v_mfma_f32_16x16x32_bf16 v[80:83],v[116:119],a[188:191],v[80:83]
v_mfma_f32_16x16x32_bf16 v[88:91],v[116:119],a[212:215],v[88:91]
v_mfma_f32_16x16x32_bf16 v[96:99],v[116:119],a[236:239],v[96:99]
s_waitcnt lgkmcnt(0)
v_mfma_f32_16x16x32_bf16 v[76:79],v[120:123],a[144:147],0
buffer_load_dwordx4 v7,s[4:7],s20 offen offset:1024 lds
v_mfma_f32_16x16x32_bf16 v[84:87],v[120:123],a[168:171],0
v_mfma_f32_16x16x32_bf16 v[92:95],v[120:123],a[192:195],0
v_mfma_f32_16x16x32_bf16 v[100:103],v[120:123],a[216:219],0
v_fma_f32 v72,v72,s36,v13
v_fma_f32 v73,v73,s36,v13
v_mfma_f32_16x16x32_bf16 v[76:79],v[124:127],a[148:151],v[76:79]
v_fma_f32 v74,v74,s36,v13
v_fma_f32 v75,v75,s36,v13
v_mfma_f32_16x16x32_bf16 v[84:87],v[124:127],a[172:175],v[84:87]
v_fma_f32 v80,v80,s36,v14
v_fma_f32 v81,v81,s36,v14
v_mfma_f32_16x16x32_bf16 v[92:95],v[124:127],a[196:199],v[92:95]
v_exp_f32 v72,v72
v_mfma_f32_16x16x32_bf16 v[100:103],v[124:127],a[220:223],v[100:103]
v_exp_f32 v73,v73
v_mfma_f32_16x16x32_bf16 v[76:79],v[128:131],a[152:155],v[76:79]
v_exp_f32 v74,v74
v_mfma_f32_16x16x32_bf16 v[84:87],v[128:131],a[176:179],v[84:87]
buffer_load_dwordx4 v8,s[4:7],s20 offen offset:2048 lds
v_mfma_f32_16x16x32_bf16 v[92:95],v[128:131],a[200:203],v[92:95]
s_add_u32 s20,s20,12288
v_exp_f32 v75,v75
v_mfma_f32_16x16x32_bf16 v[100:103],v[128:131],a[224:227],v[100:103]
ds_read_b64_tr_b16 v[112:113],v2 offset:12288
ds_read_b64_tr_b16 v[114:115],v2 offset:18432
v_mfma_f32_16x16x32_bf16 v[76:79],v[132:135],a[156:159],v[76:79]
v_exp_f32 v80,v80
v_mfma_f32_16x16x32_bf16 v[84:87],v[132:135],a[180:183],v[84:87]
ds_read_b64_tr_b16 v[116:117],v3 offset:12288
ds_read_b64_tr_b16 v[118:119],v3 offset:18432
v_mfma_f32_16x16x32_bf16 v[92:95],v[132:135],a[204:207],v[92:95]
v_exp_f32 v81,v81
v_mfma_f32_16x16x32_bf16 v[100:103],v[132:135],a[228:231],v[100:103]
ds_read_b64_tr_b16 v[120:121],v4 offset:12288
ds_read_b64_tr_b16 v[122:123],v4 offset:18432
v_mfma_f32_16x16x32_bf16 v[76:79],v[136:139],a[160:163],v[76:79]
v_cvt_pk_bf16_f32 v20,v72,v73
v_cvt_pk_bf16_f32 v21,v74,v75
v_mfma_f32_16x16x32_bf16 v[84:87],v[136:139],a[184:187],v[84:87]
ds_read_b64_tr_b16 v[124:125],v5 offset:12288
ds_read_b64_tr_b16 v[126:127],v5 offset:18432
v_mfma_f32_16x16x32_bf16 v[92:95],v[136:139],a[208:211],v[92:95]
v_cvt_pk_bf16_f32 v24,v80,v81
v_mfma_f32_16x16x32_bf16 v[100:103],v[136:139],a[232:235],v[100:103]
v_mfma_f32_16x16x32_bf16 v[76:79],v[140:143],a[164:167],v[76:79]
v_mfma_f32_16x16x32_bf16 v[84:87],v[140:143],a[188:191],v[84:87]
v_mfma_f32_16x16x32_bf16 v[92:95],v[140:143],a[212:215],v[92:95]
v_mfma_f32_16x16x32_bf16 v[100:103],v[140:143],a[236:239],v[100:103]
s_waitcnt lgkmcnt(4)
v_mfma_f32_16x16x32_bf16 v[160:163],v[112:115],v[40:43],v[160:163]
s_add_u32 m0,s23,12288
ds_read_b64_tr_b16 v[128:129],v2 offset:12416
ds_read_b64_tr_b16 v[130:131],v2 offset:18560
v_mfma_f32_16x16x32_bf16 v[208:211],v[112:115],v[44:47],v[208:211]
ds_read_b64_tr_b16 v[132:133],v3 offset:12416
ds_read_b64_tr_b16 v[134:135],v3 offset:18560
v_mfma_f32_16x16x32_bf16 a[0:3],v[112:115],v[48:51],a[0:3]
ds_read_b64_tr_b16 v[136:137],v4 offset:12416
ds_read_b64_tr_b16 v[138:139],v4 offset:18560
v_mfma_f32_16x16x32_bf16 a[48:51],v[112:115],v[52:55],a[48:51]
ds_read_b64_tr_b16 v[140:141],v5 offset:12416
ds_read_b64_tr_b16 v[142:143],v5 offset:18560
v_mfma_f32_16x16x32_bf16 v[164:167],v[116:119],v[40:43],v[164:167]
ds_read_b64_tr_b16 v[112:113],v2 offset:12544
ds_read_b64_tr_b16 v[114:115],v2 offset:18688
v_mfma_f32_16x16x32_bf16 v[212:215],v[116:119],v[44:47],v[212:215]
v_fma_f32 v82,v82,s36,v14
v_fma_f32 v83,v83,s36,v14
v_mfma_f32_16x16x32_bf16 a[4:7],v[116:119],v[48:51],a[4:7]
v_exp_f32 v82,v82
v_mfma_f32_16x16x32_bf16 a[52:55],v[116:119],v[52:55],a[52:55]
s_waitcnt lgkmcnt(10)
ds_read_b64_tr_b16 v[116:117],v3 offset:12544
ds_read_b64_tr_b16 v[118:119],v3 offset:18688
v_mfma_f32_16x16x32_bf16 v[168:171],v[120:123],v[40:43],v[168:171]
v_exp_f32 v83,v83
v_mfma_f32_16x16x32_bf16 v[216:219],v[120:123],v[44:47],v[216:219]
v_cvt_pk_bf16_f32 v25,v82,v83
v_fma_f32 v88,v88,s36,v15
v_mfma_f32_16x16x32_bf16 a[8:11],v[120:123],v[48:51],a[8:11]
v_fma_f32 v89,v89,s36,v15
v_fma_f32 v90,v90,s36,v15
v_mfma_f32_16x16x32_bf16 a[56:59],v[120:123],v[52:55],a[56:59]
ds_read_b64_tr_b16 v[120:121],v4 offset:12544
ds_read_b64_tr_b16 v[122:123],v4 offset:18688
v_mfma_f32_16x16x32_bf16 v[172:175],v[124:127],v[40:43],v[172:175]
v_fma_f32 v91,v91,s36,v15
v_fma_f32 v96,v96,s36,v16
v_mfma_f32_16x16x32_bf16 v[220:223],v[124:127],v[44:47],v[220:223]
v_exp_f32 v88,v88
v_mfma_f32_16x16x32_bf16 a[12:15],v[124:127],v[48:51],a[12:15]
v_exp_f32 v89,v89
v_mfma_f32_16x16x32_bf16 a[60:63],v[124:127],v[52:55],a[60:63]
s_waitcnt lgkmcnt(3)
ds_read_b64_tr_b16 v[124:125],v5 offset:12544
ds_read_b64_tr_b16 v[126:127],v5 offset:18688
v_mfma_f32_16x16x32_bf16 v[176:179],v[128:131],v[40:43],v[176:179]
v_exp_f32 v90,v90
v_mfma_f32_16x16x32_bf16 v[224:227],v[128:131],v[44:47],v[224:227]
v_exp_f32 v91,v91
v_mfma_f32_16x16x32_bf16 a[16:19],v[128:131],v[48:51],a[16:19]
v_cvt_pk_bf16_f32 v28,v88,v89
v_cvt_pk_bf16_f32 v29,v90,v91
v_mfma_f32_16x16x32_bf16 a[64:67],v[128:131],v[52:55],a[64:67]
v_fma_f32 v97,v97,s36,v16
v_fma_f32 v98,v98,s36,v16
v_mfma_f32_16x16x32_bf16 v[180:183],v[132:135],v[40:43],v[180:183]
v_fma_f32 v99,v99,s36,v16
v_fma_f32 v76,v76,s36,v13
v_mfma_f32_16x16x32_bf16 v[228:231],v[132:135],v[44:47],v[228:231]
v_exp_f32 v96,v96
v_mfma_f32_16x16x32_bf16 a[20:23],v[132:135],v[48:51],a[20:23]
v_exp_f32 v97,v97
v_mfma_f32_16x16x32_bf16 a[68:71],v[132:135],v[52:55],a[68:71]
v_exp_f32 v98,v98
v_mfma_f32_16x16x32_bf16 v[184:187],v[136:139],v[40:43],v[184:187]
v_exp_f32 v99,v99
v_mfma_f32_16x16x32_bf16 v[232:235],v[136:139],v[44:47],v[232:235]
v_cvt_pk_bf16_f32 v32,v96,v97
v_cvt_pk_bf16_f32 v33,v98,v99
v_mfma_f32_16x16x32_bf16 a[24:27],v[136:139],v[48:51],a[24:27]
v_fma_f32 v77,v77,s36,v13
v_fma_f32 v78,v78,s36,v13
v_mfma_f32_16x16x32_bf16 a[72:75],v[136:139],v[52:55],a[72:75]
v_fma_f32 v79,v79,s36,v13
v_fma_f32 v84,v84,s36,v14
v_mfma_f32_16x16x32_bf16 v[188:191],v[140:143],v[40:43],v[188:191]
v_exp_f32 v76,v76
v_mfma_f32_16x16x32_bf16 v[236:239],v[140:143],v[44:47],v[236:239]
v_exp_f32 v77,v77
v_mfma_f32_16x16x32_bf16 a[28:31],v[140:143],v[48:51],a[28:31]
v_exp_f32 v78,v78
v_mfma_f32_16x16x32_bf16 a[76:79],v[140:143],v[52:55],a[76:79]
v_exp_f32 v79,v79
v_mfma_f32_16x16x32_bf16 v[192:195],v[112:115],v[40:43],v[192:195]
v_cvt_pk_bf16_f32 v22,v76,v77
v_cvt_pk_bf16_f32 v23,v78,v79
s_waitcnt vmcnt(6) lgkmcnt(0)
v_mfma_f32_16x16x32_bf16 v[240:243],v[112:115],v[44:47],v[240:243]
s_barrier
v_mfma_f32_16x16x32_bf16 a[32:35],v[112:115],v[48:51],a[32:35]
ds_read_b128 v[128:131],v0 offset:0
v_fma_f32 v85,v85,s36,v14
v_mfma_f32_16x16x32_bf16 a[80:83],v[112:115],v[52:55],a[80:83]
ds_read_b128 v[132:135],v1 offset:0
v_fma_f32 v86,v86,s36,v14
v_mfma_f32_16x16x32_bf16 v[196:199],v[116:119],v[40:43],v[196:199]
ds_read_b128 v[136:139],v0 offset:128
v_fma_f32 v87,v87,s36,v14
v_mfma_f32_16x16x32_bf16 v[244:247],v[116:119],v[44:47],v[244:247]
ds_read_b128 v[140:143],v1 offset:128
v_fma_f32 v92,v92,s36,v15
v_mfma_f32_16x16x32_bf16 a[36:39],v[116:119],v[48:51],a[36:39]
ds_read_b128 v[112:115],v0 offset:256
v_fma_f32 v93,v93,s36,v15
v_mfma_f32_16x16x32_bf16 a[84:87],v[116:119],v[52:55],a[84:87]
buffer_load_dwordx4 v6,s[8:11],s21 offen offset:0 lds
v_mfma_f32_16x16x32_bf16 v[200:203],v[120:123],v[40:43],v[200:203]
ds_read_b128 v[116:119],v1 offset:256
v_fma_f32 v94,v94,s36,v15
v_mfma_f32_16x16x32_bf16 v[248:251],v[120:123],v[44:47],v[248:251]
v_exp_f32 v84,v84
v_mfma_f32_16x16x32_bf16 a[40:43],v[120:123],v[48:51],a[40:43]
v_exp_f32 v85,v85
v_mfma_f32_16x16x32_bf16 a[88:91],v[120:123],v[52:55],a[88:91]
ds_read_b128 v[120:123],v0 offset:6144
v_cvt_pk_bf16_f32 v26,v84,v85
v_mfma_f32_16x16x32_bf16 v[204:207],v[124:127],v[40:43],v[204:207]
v_exp_f32 v86,v86
v_mfma_f32_16x16x32_bf16 v[252:255],v[124:127],v[44:47],v[252:255]
v_exp_f32 v87,v87
v_mfma_f32_16x16x32_bf16 a[44:47],v[124:127],v[48:51],a[44:47]
v_cvt_pk_bf16_f32 v27,v86,v87
v_fma_f32 v95,v95,s36,v15
v_mfma_f32_16x16x32_bf16 a[92:95],v[124:127],v[52:55],a[92:95]
ds_read_b128 v[124:127],v1 offset:6144
v_fma_f32 v100,v100,s36,v16
v_smfmac_f32_16x16x64_bf16 v[60:63],v[152:155],v[20:27],v18
buffer_load_dwordx4 v7,s[8:11],s21 offen offset:1024 lds
s_waitcnt lgkmcnt(2)
v_mfma_f32_16x16x32_bf16 v[72:75],v[128:131],a[144:147],0
v_exp_f32 v92,v92
v_mfma_f32_16x16x32_bf16 v[80:83],v[128:131],a[168:171],0
v_exp_f32 v93,v93
v_mfma_f32_16x16x32_bf16 v[88:91],v[128:131],a[192:195],0
v_exp_f32 v94,v94
v_mfma_f32_16x16x32_bf16 v[96:99],v[128:131],a[216:219],0
ds_read_b128 v[128:131],v0 offset:6272
v_cvt_pk_bf16_f32 v30,v92,v93
v_mfma_f32_16x16x32_bf16 v[72:75],v[132:135],a[148:151],v[72:75]
v_exp_f32 v95,v95
v_mfma_f32_16x16x32_bf16 v[80:83],v[132:135],a[172:175],v[80:83]
v_cvt_pk_bf16_f32 v31,v94,v95
v_fma_f32 v101,v101,s36,v16
v_mfma_f32_16x16x32_bf16 v[88:91],v[132:135],a[196:199],v[88:91]
v_fma_f32 v102,v102,s36,v16
v_fma_f32 v103,v103,s36,v16
v_mfma_f32_16x16x32_bf16 v[96:99],v[132:135],a[220:223],v[96:99]
v_exp_f32 v100,v100
v_mfma_f32_16x16x32_bf16 v[72:75],v[136:139],a[152:155],v[72:75]
buffer_load_dwordx4 v8,s[8:11],s21 offen offset:2048 lds
v_mfma_f32_16x16x32_bf16 v[80:83],v[136:139],a[176:179],v[80:83]
s_add_u32 s21,s21,12288
v_exp_f32 v101,v101
v_mfma_f32_16x16x32_bf16 v[88:91],v[136:139],a[200:203],v[88:91]
s_add_u32 m0,s22,24576
v_exp_f32 v102,v102
v_mfma_f32_16x16x32_bf16 v[96:99],v[136:139],a[224:227],v[96:99]
v_exp_f32 v103,v103
v_mfma_f32_16x16x32_bf16 v[72:75],v[140:143],a[156:159],v[72:75]
v_cvt_pk_bf16_f32 v34,v100,v101
v_cvt_pk_bf16_f32 v35,v102,v103
v_mfma_f32_16x16x32_bf16 v[80:83],v[140:143],a[180:183],v[80:83]
ds_read_b128 v[132:135],v1 offset:6272
v_smfmac_f32_16x16x64_bf16 v[64:67],v[152:155],v[28:35],v18
ds_read_b128 v[136:139],v0 offset:6400
v_mfma_f32_16x16x32_bf16 v[88:91],v[140:143],a[204:207],v[88:91]
v_mfma_f32_16x16x32_bf16 v[96:99],v[140:143],a[228:231],v[96:99]
ds_read_b128 v[140:143],v1 offset:6400
v_mfma_f32_16x16x32_bf16 v[72:75],v[112:115],a[160:163],v[72:75]
buffer_load_dwordx4 v6,s[4:7],s20 offen offset:0 lds
v_mfma_f32_16x16x32_bf16 v[80:83],v[112:115],a[184:187],v[80:83]
v_mfma_f32_16x16x32_bf16 v[88:91],v[112:115],a[208:211],v[88:91]
v_mfma_f32_16x16x32_bf16 v[96:99],v[112:115],a[232:235],v[96:99]
v_mfma_f32_16x16x32_bf16 v[72:75],v[116:119],a[164:167],v[72:75]
v_mfma_f32_16x16x32_bf16 v[80:83],v[116:119],a[188:191],v[80:83]
v_mfma_f32_16x16x32_bf16 v[88:91],v[116:119],a[212:215],v[88:91]
v_mfma_f32_16x16x32_bf16 v[96:99],v[116:119],a[236:239],v[96:99]
s_waitcnt lgkmcnt(0)
v_mfma_f32_16x16x32_bf16 v[76:79],v[120:123],a[144:147],0
buffer_load_dwordx4 v7,s[4:7],s20 offen offset:1024 lds
v_mfma_f32_16x16x32_bf16 v[84:87],v[120:123],a[168:171],0
v_mfma_f32_16x16x32_bf16 v[92:95],v[120:123],a[192:195],0
v_mfma_f32_16x16x32_bf16 v[100:103],v[120:123],a[216:219],0
v_fma_f32 v72,v72,s36,v13
v_fma_f32 v73,v73,s36,v13
v_mfma_f32_16x16x32_bf16 v[76:79],v[124:127],a[148:151],v[76:79]
v_fma_f32 v74,v74,s36,v13
v_fma_f32 v75,v75,s36,v13
v_mfma_f32_16x16x32_bf16 v[84:87],v[124:127],a[172:175],v[84:87]
v_fma_f32 v80,v80,s36,v14
v_fma_f32 v81,v81,s36,v14
v_mfma_f32_16x16x32_bf16 v[92:95],v[124:127],a[196:199],v[92:95]
v_exp_f32 v72,v72
v_mfma_f32_16x16x32_bf16 v[100:103],v[124:127],a[220:223],v[100:103]
v_exp_f32 v73,v73
v_mfma_f32_16x16x32_bf16 v[76:79],v[128:131],a[152:155],v[76:79]
v_exp_f32 v74,v74
v_mfma_f32_16x16x32_bf16 v[84:87],v[128:131],a[176:179],v[84:87]
buffer_load_dwordx4 v8,s[4:7],s20 offen offset:2048 lds
v_mfma_f32_16x16x32_bf16 v[92:95],v[128:131],a[200:203],v[92:95]
s_add_u32 s20,s20,12288
v_exp_f32 v75,v75
v_mfma_f32_16x16x32_bf16 v[100:103],v[128:131],a[224:227],v[100:103]
ds_read_b64_tr_b16 v[112:113],v2 offset:24576
ds_read_b64_tr_b16 v[114:115],v2 offset:30720
v_mfma_f32_16x16x32_bf16 v[76:79],v[132:135],a[156:159],v[76:79]
v_exp_f32 v80,v80
v_mfma_f32_16x16x32_bf16 v[84:87],v[132:135],a[180:183],v[84:87]
ds_read_b64_tr_b16 v[116:117],v3 offset:24576
ds_read_b64_tr_b16 v[118:119],v3 offset:30720
v_mfma_f32_16x16x32_bf16 v[92:95],v[132:135],a[204:207],v[92:95]
v_exp_f32 v81,v81
v_mfma_f32_16x16x32_bf16 v[100:103],v[132:135],a[228:231],v[100:103]
ds_read_b64_tr_b16 v[120:121],v4 offset:24576
ds_read_b64_tr_b16 v[122:123],v4 offset:30720
v_mfma_f32_16x16x32_bf16 v[76:79],v[136:139],a[160:163],v[76:79]
v_cvt_pk_bf16_f32 v40,v72,v73
v_cvt_pk_bf16_f32 v41,v74,v75
v_mfma_f32_16x16x32_bf16 v[84:87],v[136:139],a[184:187],v[84:87]
ds_read_b64_tr_b16 v[124:125],v5 offset:24576
ds_read_b64_tr_b16 v[126:127],v5 offset:30720
v_mfma_f32_16x16x32_bf16 v[92:95],v[136:139],a[208:211],v[92:95]
v_cvt_pk_bf16_f32 v44,v80,v81
v_mfma_f32_16x16x32_bf16 v[100:103],v[136:139],a[232:235],v[100:103]
v_mfma_f32_16x16x32_bf16 v[76:79],v[140:143],a[164:167],v[76:79]
v_mfma_f32_16x16x32_bf16 v[84:87],v[140:143],a[188:191],v[84:87]
v_mfma_f32_16x16x32_bf16 v[92:95],v[140:143],a[212:215],v[92:95]
v_mfma_f32_16x16x32_bf16 v[100:103],v[140:143],a[236:239],v[100:103]
s_mov_b32 s38,0
s_branch L_loop4
L_end5:
s_waitcnt lgkmcnt(4)
v_mfma_f32_16x16x32_bf16 v[160:163],v[112:115],v[20:23],v[160:163]
ds_read_b64_tr_b16 v[128:129],v2 offset:24704
ds_read_b64_tr_b16 v[130:131],v2 offset:30848
v_mfma_f32_16x16x32_bf16 v[208:211],v[112:115],v[24:27],v[208:211]
ds_read_b64_tr_b16 v[132:133],v3 offset:24704
ds_read_b64_tr_b16 v[134:135],v3 offset:30848
v_mfma_f32_16x16x32_bf16 a[0:3],v[112:115],v[28:31],a[0:3]
ds_read_b64_tr_b16 v[136:137],v4 offset:24704
ds_read_b64_tr_b16 v[138:139],v4 offset:30848
v_mfma_f32_16x16x32_bf16 a[48:51],v[112:115],v[32:35],a[48:51]
ds_read_b64_tr_b16 v[140:141],v5 offset:24704
ds_read_b64_tr_b16 v[142:143],v5 offset:30848
v_mfma_f32_16x16x32_bf16 a[96:99],v[112:115],v[36:39],a[96:99]
ds_read_b64_tr_b16 v[112:113],v2 offset:24832
ds_read_b64_tr_b16 v[114:115],v2 offset:30976
v_mfma_f32_16x16x32_bf16 v[164:167],v[116:119],v[20:23],v[164:167]
v_fma_f32 v90,v90,s36,v15
v_fma_f32 v91,v91,s36,v15
v_mfma_f32_16x16x32_bf16 v[212:215],v[116:119],v[24:27],v[212:215]
v_fma_f32 v96,v96,s36,v16
v_fma_f32 v97,v97,s36,v16
v_mfma_f32_16x16x32_bf16 a[4:7],v[116:119],v[28:31],a[4:7]
v_fma_f32 v98,v98,s36,v16
v_fma_f32 v99,v99,s36,v16
v_mfma_f32_16x16x32_bf16 a[52:55],v[116:119],v[32:35],a[52:55]
v_fma_f32 v104,v104,s36,v17
v_fma_f32 v105,v105,s36,v17
v_mfma_f32_16x16x32_bf16 a[100:103],v[116:119],v[36:39],a[100:103]
s_waitcnt lgkmcnt(8)
ds_read_b64_tr_b16 v[116:117],v3 offset:24832
ds_read_b64_tr_b16 v[118:119],v3 offset:30976
v_mfma_f32_16x16x32_bf16 v[168:171],v[120:123],v[20:23],v[168:171]
v_fma_f32 v106,v106,s36,v17
v_fma_f32 v107,v107,s36,v17
v_mfma_f32_16x16x32_bf16 v[216:219],v[120:123],v[24:27],v[216:219]
v_fma_f32 v76,v76,s36,v13
v_fma_f32 v77,v77,s36,v13
v_mfma_f32_16x16x32_bf16 a[8:11],v[120:123],v[28:31],a[8:11]
v_fma_f32 v78,v78,s36,v13
v_fma_f32 v79,v79,s36,v13
v_mfma_f32_16x16x32_bf16 a[56:59],v[120:123],v[32:35],a[56:59]
v_fma_f32 v84,v84,s36,v14
v_fma_f32 v85,v85,s36,v14
v_mfma_f32_16x16x32_bf16 a[104:107],v[120:123],v[36:39],a[104:107]
ds_read_b64_tr_b16 v[120:121],v4 offset:24832
ds_read_b64_tr_b16 v[122:123],v4 offset:30976
v_mfma_f32_16x16x32_bf16 v[172:175],v[124:127],v[20:23],v[172:175]
v_fma_f32 v86,v86,s36,v14
v_fma_f32 v87,v87,s36,v14
v_mfma_f32_16x16x32_bf16 v[220:223],v[124:127],v[24:27],v[220:223]
v_fma_f32 v92,v92,s36,v15
v_fma_f32 v93,v93,s36,v15
v_mfma_f32_16x16x32_bf16 a[12:15],v[124:127],v[28:31],a[12:15]
v_fma_f32 v94,v94,s36,v15
v_fma_f32 v95,v95,s36,v15
v_mfma_f32_16x16x32_bf16 a[60:63],v[124:127],v[32:35],a[60:63]
v_fma_f32 v100,v100,s36,v16
v_fma_f32 v101,v101,s36,v16
v_mfma_f32_16x16x32_bf16 a[108:111],v[124:127],v[36:39],a[108:111]
ds_read_b64_tr_b16 v[124:125],v5 offset:24832
ds_read_b64_tr_b16 v[126:127],v5 offset:30976
v_mfma_f32_16x16x32_bf16 v[176:179],v[128:131],v[20:23],v[176:179]
v_fma_f32 v102,v102,s36,v16
v_fma_f32 v103,v103,s36,v16
v_mfma_f32_16x16x32_bf16 v[224:227],v[128:131],v[24:27],v[224:227]
v_fma_f32 v108,v108,s36,v17
v_fma_f32 v109,v109,s36,v17
v_mfma_f32_16x16x32_bf16 a[16:19],v[128:131],v[28:31],a[16:19]
v_fma_f32 v110,v110,s36,v17
v_fma_f32 v111,v111,s36,v17
v_mfma_f32_16x16x32_bf16 a[64:67],v[128:131],v[32:35],a[64:67]
v_exp_f32 v90,v90
v_mfma_f32_16x16x32_bf16 a[112:115],v[128:131],v[36:39],a[112:115]
s_waitcnt lgkmcnt(2)
v_exp_f32 v91,v91
v_mfma_f32_16x16x32_bf16 v[180:183],v[132:135],v[20:23],v[180:183]
v_exp_f32 v96,v96
v_mfma_f32_16x16x32_bf16 v[228:231],v[132:135],v[24:27],v[228:231]
v_exp_f32 v97,v97
v_mfma_f32_16x16x32_bf16 a[20:23],v[132:135],v[28:31],a[20:23]
v_exp_f32 v98,v98
v_mfma_f32_16x16x32_bf16 a[68:71],v[132:135],v[32:35],a[68:71]
v_exp_f32 v99,v99
v_mfma_f32_16x16x32_bf16 a[116:119],v[132:135],v[36:39],a[116:119]
v_exp_f32 v104,v104
v_mfma_f32_16x16x32_bf16 v[184:187],v[136:139],v[20:23],v[184:187]
v_exp_f32 v105,v105
v_mfma_f32_16x16x32_bf16 v[232:235],v[136:139],v[24:27],v[232:235]
v_exp_f32 v106,v106
v_mfma_f32_16x16x32_bf16 a[24:27],v[136:139],v[28:31],a[24:27]
v_exp_f32 v107,v107
v_mfma_f32_16x16x32_bf16 a[72:75],v[136:139],v[32:35],a[72:75]
v_exp_f32 v76,v76
v_mfma_f32_16x16x32_bf16 a[120:123],v[136:139],v[36:39],a[120:123]
v_exp_f32 v77,v77
v_mfma_f32_16x16x32_bf16 v[188:191],v[140:143],v[20:23],v[188:191]
v_exp_f32 v78,v78
v_mfma_f32_16x16x32_bf16 v[236:239],v[140:143],v[24:27],v[236:239]
v_exp_f32 v79,v79
v_mfma_f32_16x16x32_bf16 a[28:31],v[140:143],v[28:31],a[28:31]
v_exp_f32 v84,v84
v_mfma_f32_16x16x32_bf16 a[76:79],v[140:143],v[32:35],a[76:79]
v_exp_f32 v85,v85
v_mfma_f32_16x16x32_bf16 a[124:127],v[140:143],v[36:39],a[124:127]
v_exp_f32 v86,v86
v_mfma_f32_16x16x32_bf16 v[192:195],v[112:115],v[20:23],v[192:195]
v_exp_f32 v87,v87
v_mfma_f32_16x16x32_bf16 v[240:243],v[112:115],v[24:27],v[240:243]
v_exp_f32 v92,v92
v_mfma_f32_16x16x32_bf16 a[32:35],v[112:115],v[28:31],a[32:35]
v_exp_f32 v93,v93
v_mfma_f32_16x16x32_bf16 a[80:83],v[112:115],v[32:35],a[80:83]
v_exp_f32 v94,v94
v_mfma_f32_16x16x32_bf16 a[128:131],v[112:115],v[36:39],a[128:131]
v_exp_f32 v95,v95
v_mfma_f32_16x16x32_bf16 v[196:199],v[116:119],v[20:23],v[196:199]
v_exp_f32 v100,v100
v_mfma_f32_16x16x32_bf16 v[244:247],v[116:119],v[24:27],v[244:247]
v_exp_f32 v101,v101
v_mfma_f32_16x16x32_bf16 a[36:39],v[116:119],v[28:31],a[36:39]
v_exp_f32 v102,v102
v_mfma_f32_16x16x32_bf16 a[84:87],v[116:119],v[32:35],a[84:87]
v_exp_f32 v103,v103
v_mfma_f32_16x16x32_bf16 a[132:135],v[116:119],v[36:39],a[132:135]
v_exp_f32 v108,v108
s_waitcnt vmcnt(14) lgkmcnt(0)
s_barrier
v_mfma_f32_16x16x32_bf16 v[200:203],v[120:123],v[20:23],v[200:203]
v_exp_f32 v109,v109
v_mfma_f32_16x16x32_bf16 v[248:251],v[120:123],v[24:27],v[248:251]
v_exp_f32 v110,v110
v_mfma_f32_16x16x32_bf16 a[40:43],v[120:123],v[28:31],a[40:43]
v_exp_f32 v111,v111
v_mfma_f32_16x16x32_bf16 a[88:91],v[120:123],v[32:35],a[88:91]
v_cvt_pk_bf16_f32 v49,v90,v91
v_cvt_pk_bf16_f32 v52,v96,v97
v_mfma_f32_16x16x32_bf16 a[136:139],v[120:123],v[36:39],a[136:139]
v_cvt_pk_bf16_f32 v53,v98,v99
v_cvt_pk_bf16_f32 v56,v104,v105
v_mfma_f32_16x16x32_bf16 v[204:207],v[124:127],v[20:23],v[204:207]
v_cvt_pk_bf16_f32 v57,v106,v107
v_cvt_pk_bf16_f32 v42,v76,v77
v_mfma_f32_16x16x32_bf16 v[252:255],v[124:127],v[24:27],v[252:255]
v_cvt_pk_bf16_f32 v43,v78,v79
v_cvt_pk_bf16_f32 v46,v84,v85
v_mfma_f32_16x16x32_bf16 a[44:47],v[124:127],v[28:31],a[44:47]
v_cvt_pk_bf16_f32 v47,v86,v87
v_cvt_pk_bf16_f32 v50,v92,v93
v_mfma_f32_16x16x32_bf16 a[92:95],v[124:127],v[32:35],a[92:95]
v_cvt_pk_bf16_f32 v51,v94,v95
v_cvt_pk_bf16_f32 v54,v100,v101
v_smfmac_f32_16x16x64_bf16 v[60:63],v[152:155],v[40:47],v18
v_cvt_pk_bf16_f32 v55,v102,v103
v_mfma_f32_16x16x32_bf16 a[140:143],v[124:127],v[36:39],a[140:143]
v_cvt_pk_bf16_f32 v58,v108,v109
v_cvt_pk_bf16_f32 v59,v110,v111
v_smfmac_f32_16x16x64_bf16 v[64:67],v[152:155],v[48:55],v18
v_subrev_u32 v10,18432,v10
v_smfmac_f32_16x16x64_bf16 v[68:71],v[152:155],v[52:59],v18
ds_read_b64_tr_b16 v[128:129],v2 offset:0
ds_read_b64_tr_b16 v[130:131],v2 offset:6144
ds_read_b64_tr_b16 v[132:133],v3 offset:0
ds_read_b64_tr_b16 v[134:135],v3 offset:6144
ds_read_b64_tr_b16 v[136:137],v4 offset:0
ds_read_b64_tr_b16 v[138:139],v4 offset:6144
ds_read_b64_tr_b16 v[140:141],v5 offset:0
ds_read_b64_tr_b16 v[142:143],v5 offset:6144
s_waitcnt lgkmcnt(6)
v_mfma_f32_16x16x32_bf16 v[160:163],v[128:131],v[40:43],v[160:163]
s_waitcnt vmcnt(6)
ds_read_b64_tr_b16 v[112:113],v2 offset:128
ds_read_b64_tr_b16 v[114:115],v2 offset:6272
v_mfma_f32_16x16x32_bf16 v[208:211],v[128:131],v[44:47],v[208:211]
s_add_u32 s84,s42,0
ds_read_b64_tr_b16 v[116:117],v3 offset:128
ds_read_b64_tr_b16 v[118:119],v3 offset:6272
v_mfma_f32_16x16x32_bf16 a[0:3],v[128:131],v[48:51],a[0:3]
s_add_u32 s85,s42,6144
ds_read_b64_tr_b16 v[120:121],v4 offset:128
ds_read_b64_tr_b16 v[122:123],v4 offset:6272
v_mfma_f32_16x16x32_bf16 a[48:51],v[128:131],v[52:55],a[48:51]
s_add_u32 s86,s42,12288
ds_read_b64_tr_b16 v[124:125],v5 offset:128
ds_read_b64_tr_b16 v[126:127],v5 offset:6272
v_mfma_f32_16x16x32_bf16 a[96:99],v[128:131],v[56:59],a[96:99]
s_add_u32 s87,s42,18432
ds_read_b64_tr_b16 v[128:129],v2 offset:256
ds_read_b64_tr_b16 v[130:131],v2 offset:6400
s_waitcnt lgkmcnt(14)
v_mfma_f32_16x16x32_bf16 v[164:167],v[132:135],v[40:43],v[164:167]
s_add_u32 s66,s42,24576
v_mbcnt_lo_u32_b32 v39,-1,0
v_mbcnt_hi_u32_b32 v39,-1,v39
v_mfma_f32_16x16x32_bf16 v[212:215],v[132:135],v[44:47],v[212:215]
v_and_b32 v38,7,v39
v_add_f32 v60,v60,v61
v_mfma_f32_16x16x32_bf16 a[4:7],v[132:135],v[48:51],a[4:7]
v_add_f32 v62,v62,v63
v_add_f32 v64,v64,v65
v_add_f32 v66,v66,v67
v_add_f32 v70,v70,v71
v_max3_f32 v19,v60,v62,v64
v_max3_f32 v19,v19,v66,v70
v_rcp_f32 v66,v66
v_rcp_f32 v70,v70
v_accvgpr_read_b32 v72,a48
v_accvgpr_read_b32 v73,a49
v_pk_mul_f32 v[72:73],v[72:73],v[66:67] op_sel_hi:[1,0]
v_accvgpr_read_b32 v74,a50
v_accvgpr_read_b32 v75,a51
v_pk_mul_f32 v[74:75],v[74:75],v[66:67] op_sel_hi:[1,0]
v_accvgpr_read_b32 v76,a96
v_accvgpr_read_b32 v77,a97
v_pk_mul_f32 v[76:77],v[76:77],v[70:71] op_sel_hi:[1,0]
v_accvgpr_read_b32 v78,a98
v_accvgpr_read_b32 v79,a99
v_pk_mul_f32 v[78:79],v[78:79],v[70:71] op_sel_hi:[1,0]
v_cmp_ngt_f32 vcc,s37,v19
v_lshrrev_b32 v19,5,v39
v_mfma_f32_16x16x32_bf16 a[52:55],v[132:135],v[52:55],a[52:55]
v_xor_b32 v38,v38,v19
v_and_b32 v19,15,v39
v_mfma_f32_16x16x32_bf16 a[100:103],v[132:135],v[56:59],a[100:103]
s_cmp_lg_u64 vcc,0
ds_read_b64_tr_b16 v[132:133],v3 offset:256
ds_read_b64_tr_b16 v[134:135],v3 offset:6400
s_waitcnt lgkmcnt(2)
v_mfma_f32_16x16x32_bf16 v[168:171],v[136:139],v[40:43],v[168:171]
s_cselect_b32 s62,s32,0
v_lshl_add_u32 v19,v19,7,s24
v_lshl_add_u32 v19,v38,4,v19
v_mfma_f32_16x16x32_bf16 v[216:219],v[136:139],v[44:47],v[216:219]
s_or_b32 s31,s31,s62
v_bfe_u32 v38,v39,4,1
v_lshl_add_u32 v36,v38,3,v19
v_mfma_f32_16x16x32_bf16 a[8:11],v[136:139],v[48:51],a[8:11]
s_lshl_b32 s32,s32,1
v_xor_b32 v37,32,v36
v_xor_b32 v38,64,v36
v_bfe_u32 v19,v39,3,1
v_xor_b32 v39,96,v36
v_lshlrev_b32 v19,11,v19
v_accvgpr_read_b32 v80,a52
v_accvgpr_read_b32 v81,a53
v_pk_mul_f32 v[80:81],v[80:81],v[66:67] op_sel_hi:[1,0]
v_accvgpr_read_b32 v82,a54
v_accvgpr_read_b32 v83,a55
v_pk_mul_f32 v[82:83],v[82:83],v[66:67] op_sel_hi:[1,0]
v_accvgpr_read_b32 v84,a100
v_accvgpr_read_b32 v85,a101
v_pk_mul_f32 v[84:85],v[84:85],v[70:71] op_sel_hi:[1,0]
v_accvgpr_read_b32 v86,a102
v_accvgpr_read_b32 v87,a103
v_pk_mul_f32 v[86:87],v[86:87],v[70:71] op_sel_hi:[1,0]
v_cvt_pk_bf16_f32 v72,v72,v73
v_cvt_pk_bf16_f32 v76,v76,v77
v_mfma_f32_16x16x32_bf16 a[56:59],v[136:139],v[52:55],a[56:59]
v_cvt_pk_bf16_f32 v80,v80,v81
v_cvt_pk_bf16_f32 v84,v84,v85
v_mfma_f32_16x16x32_bf16 a[104:107],v[136:139],v[56:59],a[104:107]
ds_read_b64_tr_b16 v[136:137],v4 offset:256
ds_read_b64_tr_b16 v[138:139],v4 offset:6400
v_mfma_f32_16x16x32_bf16 v[172:175],v[140:143],v[40:43],v[172:175]
v_cvt_pk_bf16_f32 v73,v74,v75
v_cvt_pk_bf16_f32 v77,v78,v79
v_mfma_f32_16x16x32_bf16 v[220:223],v[140:143],v[44:47],v[220:223]
ds_write2st64_b64 v36,v[72:73],v[76:77] offset0:36 offset1:40
v_mfma_f32_16x16x32_bf16 a[12:15],v[140:143],v[48:51],a[12:15]
v_accvgpr_read_b32 v88,a56
v_accvgpr_read_b32 v89,a57
v_accvgpr_read_b32 v90,a58
v_accvgpr_read_b32 v91,a59
v_accvgpr_read_b32 v92,a104
v_pk_mul_f32 v[88:89],v[88:89],v[66:67] op_sel_hi:[1,0]
v_pk_mul_f32 v[90:91],v[90:91],v[66:67] op_sel_hi:[1,0]
v_accvgpr_read_b32 v93,a105
v_pk_mul_f32 v[92:93],v[92:93],v[70:71] op_sel_hi:[1,0]
v_accvgpr_read_b32 v94,a106
v_accvgpr_read_b32 v95,a107
v_pk_mul_f32 v[94:95],v[94:95],v[70:71] op_sel_hi:[1,0]
v_cvt_pk_bf16_f32 v81,v82,v83
v_cvt_pk_bf16_f32 v85,v86,v87
v_mfma_f32_16x16x32_bf16 a[60:63],v[140:143],v[52:55],a[60:63]
ds_write2st64_b64 v37,v[80:81],v[84:85] offset0:36 offset1:40
v_mfma_f32_16x16x32_bf16 a[108:111],v[140:143],v[56:59],a[108:111]
v_cvt_pk_bf16_f32 v88,v88,v89
v_cvt_pk_bf16_f32 v92,v92,v93
v_mfma_f32_16x16x32_bf16 v[176:179],v[112:115],v[40:43],v[176:179]
ds_read_b64_tr_b16 v[140:141],v5 offset:256
ds_read_b64_tr_b16 v[142:143],v5 offset:6400
v_mfma_f32_16x16x32_bf16 v[224:227],v[112:115],v[44:47],v[224:227]
v_accvgpr_read_b32 v96,a60
v_accvgpr_read_b32 v97,a61
v_mfma_f32_16x16x32_bf16 a[16:19],v[112:115],v[48:51],a[16:19]
v_accvgpr_read_b32 v98,a62
v_accvgpr_read_b32 v99,a63
v_accvgpr_read_b32 v100,a108
v_accvgpr_read_b32 v101,a109
v_accvgpr_read_b32 v102,a110
v_pk_mul_f32 v[96:97],v[96:97],v[66:67] op_sel_hi:[1,0]
v_pk_mul_f32 v[98:99],v[98:99],v[66:67] op_sel_hi:[1,0]
v_pk_mul_f32 v[100:101],v[100:101],v[70:71] op_sel_hi:[1,0]
v_accvgpr_read_b32 v103,a111
v_pk_mul_f32 v[102:103],v[102:103],v[70:71] op_sel_hi:[1,0]
v_cvt_pk_bf16_f32 v89,v90,v91
v_cvt_pk_bf16_f32 v93,v94,v95
v_mfma_f32_16x16x32_bf16 a[64:67],v[112:115],v[52:55],a[64:67]
ds_write2st64_b64 v38,v[88:89],v[92:93] offset0:36 offset1:40
v_mfma_f32_16x16x32_bf16 a[112:115],v[112:115],v[56:59],a[112:115]
v_cvt_pk_bf16_f32 v96,v96,v97
v_cvt_pk_bf16_f32 v100,v100,v101
v_mfma_f32_16x16x32_bf16 v[180:183],v[116:119],v[40:43],v[180:183]
v_cvt_pk_bf16_f32 v97,v98,v99
v_cvt_pk_bf16_f32 v101,v102,v103
v_mfma_f32_16x16x32_bf16 v[228:231],v[116:119],v[44:47],v[228:231]
v_accvgpr_read_b32 v76,a64
v_accvgpr_read_b32 v77,a65
v_mfma_f32_16x16x32_bf16 a[20:23],v[116:119],v[48:51],a[20:23]
ds_write2st64_b64 v39,v[96:97],v[100:101] offset0:36 offset1:40
v_pk_mul_f32 v[76:77],v[76:77],v[66:67] op_sel_hi:[1,0]
v_accvgpr_read_b32 v78,a66
v_accvgpr_read_b32 v79,a67
ds_read_b128 v[156:159],v10 offset:18432
ds_read_b128 v[104:107],v10 offset:19456
v_pk_mul_f32 v[78:79],v[78:79],v[66:67] op_sel_hi:[1,0]
ds_read_b128 v[108:111],v10 offset:20480
v_accvgpr_read_b32 v80,a112
ds_read_b128 v[72:75],v10 offset:21504
v_accvgpr_read_b32 v81,a113
v_pk_mul_f32 v[80:81],v[80:81],v[70:71] op_sel_hi:[1,0]
v_accvgpr_read_b32 v82,a114
v_accvgpr_read_b32 v83,a115
v_pk_mul_f32 v[82:83],v[82:83],v[70:71] op_sel_hi:[1,0]
v_cvt_pk_bf16_f32 v76,v76,v77
v_cvt_pk_bf16_f32 v80,v80,v81
v_mfma_f32_16x16x32_bf16 a[68:71],v[116:119],v[52:55],a[68:71]
v_cvt_pk_bf16_f32 v77,v78,v79
v_cvt_pk_bf16_f32 v81,v82,v83
v_mfma_f32_16x16x32_bf16 a[116:119],v[116:119],v[56:59],a[116:119]
ds_write2st64_b64 v36,v[76:77],v[80:81] offset0:36 offset1:40
v_mfma_f32_16x16x32_bf16 v[184:187],v[120:123],v[40:43],v[184:187]
v_rcp_f32 v62,v62
v_mfma_f32_16x16x32_bf16 v[232:235],v[120:123],v[44:47],v[232:235]
s_waitcnt lgkmcnt(4)
buffer_store_dwordx4 v[156:159],v9,s[16:19],s87 offen offset:0 nt
v_accvgpr_read_b32 v84,a68
v_accvgpr_read_b32 v85,a69
v_accvgpr_read_b32 v86,a70
v_mfma_f32_16x16x32_bf16 a[24:27],v[120:123],v[48:51],a[24:27]
v_accvgpr_read_b32 v87,a71
v_accvgpr_read_b32 v88,a116
v_accvgpr_read_b32 v89,a117
v_accvgpr_read_b32 v90,a118
v_accvgpr_read_b32 v91,a119
v_pk_mul_f32 v[84:85],v[84:85],v[66:67] op_sel_hi:[1,0]
s_waitcnt lgkmcnt(1)
buffer_store_dwordx4 v[104:107],v9,s[16:19],s87 offen offset:3072 nt
v_pk_mul_f32 v[86:87],v[86:87],v[66:67] op_sel_hi:[1,0]
v_pk_mul_f32 v[88:89],v[88:89],v[70:71] op_sel_hi:[1,0]
v_pk_mul_f32 v[90:91],v[90:91],v[70:71] op_sel_hi:[1,0]
v_cvt_pk_bf16_f32 v84,v84,v85
v_cvt_pk_bf16_f32 v88,v88,v89
v_mfma_f32_16x16x32_bf16 a[72:75],v[120:123],v[52:55],a[72:75]
v_cvt_pk_bf16_f32 v85,v86,v87
v_cvt_pk_bf16_f32 v89,v90,v91
v_mfma_f32_16x16x32_bf16 a[120:123],v[120:123],v[56:59],a[120:123]
ds_write2st64_b64 v37,v[84:85],v[88:89] offset0:36 offset1:40
v_mfma_f32_16x16x32_bf16 v[188:191],v[124:127],v[40:43],v[188:191]
v_rcp_f32 v64,v64
v_mfma_f32_16x16x32_bf16 v[236:239],v[124:127],v[44:47],v[236:239]
buffer_store_dwordx4 v[108:111],v9,s[16:19],s66 offen offset:0 nt
v_accvgpr_read_b32 v92,a72
v_accvgpr_read_b32 v93,a73
v_accvgpr_read_b32 v94,a74
v_mfma_f32_16x16x32_bf16 a[28:31],v[124:127],v[48:51],a[28:31]
v_accvgpr_read_b32 v95,a75
v_accvgpr_read_b32 v96,a120
v_accvgpr_read_b32 v97,a121
v_accvgpr_read_b32 v98,a122
v_accvgpr_read_b32 v99,a123
v_pk_mul_f32 v[92:93],v[92:93],v[66:67] op_sel_hi:[1,0]
buffer_store_dwordx4 v[72:75],v9,s[16:19],s66 offen offset:3072 nt
v_pk_mul_f32 v[94:95],v[94:95],v[66:67] op_sel_hi:[1,0]
v_pk_mul_f32 v[96:97],v[96:97],v[70:71] op_sel_hi:[1,0]
v_pk_mul_f32 v[98:99],v[98:99],v[70:71] op_sel_hi:[1,0]
v_cvt_pk_bf16_f32 v92,v92,v93
v_cvt_pk_bf16_f32 v96,v96,v97
v_mfma_f32_16x16x32_bf16 a[76:79],v[124:127],v[52:55],a[76:79]
v_cvt_pk_bf16_f32 v93,v94,v95
v_cvt_pk_bf16_f32 v97,v98,v99
v_mfma_f32_16x16x32_bf16 a[124:127],v[124:127],v[56:59],a[124:127]
ds_write2st64_b64 v38,v[92:93],v[96:97] offset0:36 offset1:40
v_mfma_f32_16x16x32_bf16 v[192:195],v[128:131],v[40:43],v[192:195]
v_rcp_f32 v60,v60
v_mfma_f32_16x16x32_bf16 v[240:243],v[128:131],v[44:47],v[240:243]
v_mfma_f32_16x16x32_bf16 a[32:35],v[128:131],v[48:51],a[32:35]
v_accvgpr_read_b32 v100,a76
v_accvgpr_read_b32 v101,a77
v_accvgpr_read_b32 v102,a78
v_accvgpr_read_b32 v103,a79
v_accvgpr_read_b32 v76,a124
v_pk_mul_f32 v[100:101],v[100:101],v[66:67] op_sel_hi:[1,0]
v_pk_mul_f32 v[102:103],v[102:103],v[66:67] op_sel_hi:[1,0]
v_accvgpr_read_b32 v77,a125
v_pk_mul_f32 v[76:77],v[76:77],v[70:71] op_sel_hi:[1,0]
v_accvgpr_read_b32 v78,a126
v_accvgpr_read_b32 v79,a127
v_pk_mul_f32 v[78:79],v[78:79],v[70:71] op_sel_hi:[1,0]
v_cvt_pk_bf16_f32 v100,v100,v101
v_cvt_pk_bf16_f32 v76,v76,v77
v_mfma_f32_16x16x32_bf16 a[80:83],v[128:131],v[52:55],a[80:83]
v_cvt_pk_bf16_f32 v101,v102,v103
v_cvt_pk_bf16_f32 v77,v78,v79
v_mfma_f32_16x16x32_bf16 a[128:131],v[128:131],v[56:59],a[128:131]
ds_write2st64_b64 v39,v[100:101],v[76:77] offset0:36 offset1:40
v_mfma_f32_16x16x32_bf16 v[196:199],v[132:135],v[40:43],v[196:199]
v_mfma_f32_16x16x32_bf16 v[244:247],v[132:135],v[44:47],v[244:247]
ds_read_b128 v[80:83],v10 offset:18432
v_mfma_f32_16x16x32_bf16 a[36:39],v[132:135],v[48:51],a[36:39]
ds_read_b128 v[156:159],v10 offset:19456
ds_read_b128 v[72:75],v10 offset:20480
v_accvgpr_read_b32 v88,a80
ds_read_b128 v[84:87],v10 offset:21504
v_accvgpr_read_b32 v89,a81
v_pk_mul_f32 v[88:89],v[88:89],v[66:67] op_sel_hi:[1,0]
v_accvgpr_read_b32 v90,a82
v_accvgpr_read_b32 v91,a83
v_pk_mul_f32 v[90:91],v[90:91],v[66:67] op_sel_hi:[1,0]
v_accvgpr_read_b32 v104,a128
v_accvgpr_read_b32 v105,a129
v_pk_mul_f32 v[104:105],v[104:105],v[70:71] op_sel_hi:[1,0]
v_accvgpr_read_b32 v106,a130
v_accvgpr_read_b32 v107,a131
v_pk_mul_f32 v[106:107],v[106:107],v[70:71] op_sel_hi:[1,0]
v_cvt_pk_bf16_f32 v88,v88,v89
v_cvt_pk_bf16_f32 v104,v104,v105
v_mfma_f32_16x16x32_bf16 a[84:87],v[132:135],v[52:55],a[84:87]
v_cvt_pk_bf16_f32 v89,v90,v91
v_cvt_pk_bf16_f32 v105,v106,v107
v_mfma_f32_16x16x32_bf16 a[132:135],v[132:135],v[56:59],a[132:135]
ds_write2st64_b64 v36,v[88:89],v[104:105] offset0:36 offset1:40
v_mfma_f32_16x16x32_bf16 v[200:203],v[136:139],v[40:43],v[200:203]
v_add_u32 v36,v36,v19
v_mfma_f32_16x16x32_bf16 v[248:251],v[136:139],v[44:47],v[248:251]
s_waitcnt lgkmcnt(2)
buffer_store_dwordx4 v[80:83],v9,s[16:19],s87 offen offset:128 nt
v_accvgpr_read_b32 v108,a84
v_accvgpr_read_b32 v109,a85
v_accvgpr_read_b32 v110,a86
v_mfma_f32_16x16x32_bf16 a[40:43],v[136:139],v[48:51],a[40:43]
v_accvgpr_read_b32 v111,a87
v_accvgpr_read_b32 v92,a132
v_accvgpr_read_b32 v93,a133
v_accvgpr_read_b32 v94,a134
v_accvgpr_read_b32 v95,a135
v_pk_mul_f32 v[108:109],v[108:109],v[66:67] op_sel_hi:[1,0]
buffer_store_dwordx4 v[156:159],v9,s[16:19],s87 offen offset:3200 nt
v_pk_mul_f32 v[110:111],v[110:111],v[66:67] op_sel_hi:[1,0]
v_pk_mul_f32 v[92:93],v[92:93],v[70:71] op_sel_hi:[1,0]
v_pk_mul_f32 v[94:95],v[94:95],v[70:71] op_sel_hi:[1,0]
v_cvt_pk_bf16_f32 v108,v108,v109
v_cvt_pk_bf16_f32 v92,v92,v93
v_mfma_f32_16x16x32_bf16 a[88:91],v[136:139],v[52:55],a[88:91]
v_cvt_pk_bf16_f32 v109,v110,v111
v_cvt_pk_bf16_f32 v93,v94,v95
v_mfma_f32_16x16x32_bf16 a[136:139],v[136:139],v[56:59],a[136:139]
ds_write2st64_b64 v37,v[108:109],v[92:93] offset0:36 offset1:40
v_mfma_f32_16x16x32_bf16 v[204:207],v[140:143],v[40:43],v[204:207]
v_add_u32 v37,v37,v19
v_mfma_f32_16x16x32_bf16 v[252:255],v[140:143],v[44:47],v[252:255]
buffer_store_dwordx4 v[72:75],v9,s[16:19],s66 offen offset:128 nt
v_accvgpr_read_b32 v96,a88
v_accvgpr_read_b32 v97,a89
v_accvgpr_read_b32 v98,a90
v_mfma_f32_16x16x32_bf16 a[44:47],v[140:143],v[48:51],a[44:47]
v_accvgpr_read_b32 v99,a91
v_accvgpr_read_b32 v76,a136
v_accvgpr_read_b32 v77,a137
v_accvgpr_read_b32 v78,a138
v_accvgpr_read_b32 v79,a139
v_pk_mul_f32 v[96:97],v[96:97],v[66:67] op_sel_hi:[1,0]
s_waitcnt lgkmcnt(1)
buffer_store_dwordx4 v[84:87],v9,s[16:19],s66 offen offset:3200 nt
v_pk_mul_f32 v[98:99],v[98:99],v[66:67] op_sel_hi:[1,0]
v_pk_mul_f32 v[76:77],v[76:77],v[70:71] op_sel_hi:[1,0]
v_pk_mul_f32 v[78:79],v[78:79],v[70:71] op_sel_hi:[1,0]
v_cvt_pk_bf16_f32 v96,v96,v97
v_cvt_pk_bf16_f32 v76,v76,v77
v_mfma_f32_16x16x32_bf16 a[92:95],v[140:143],v[52:55],a[92:95]
v_cvt_pk_bf16_f32 v97,v98,v99
v_cvt_pk_bf16_f32 v77,v78,v79
v_mfma_f32_16x16x32_bf16 a[140:143],v[140:143],v[56:59],a[140:143]
ds_write2st64_b64 v38,v[96:97],v[76:77] offset0:36 offset1:40
v_pk_mul_f32 v[208:209],v[208:209],v[62:63] op_sel_hi:[1,0]
v_pk_mul_f32 v[224:225],v[224:225],v[62:63] op_sel_hi:[1,0]
v_pk_mul_f32 v[210:211],v[210:211],v[62:63] op_sel_hi:[1,0]
v_pk_mul_f32 v[226:227],v[226:227],v[62:63] op_sel_hi:[1,0]
v_pk_mul_f32 v[212:213],v[212:213],v[62:63] op_sel_hi:[1,0]
v_pk_mul_f32 v[228:229],v[228:229],v[62:63] op_sel_hi:[1,0]
v_pk_mul_f32 v[214:215],v[214:215],v[62:63] op_sel_hi:[1,0]
v_pk_mul_f32 v[230:231],v[230:231],v[62:63] op_sel_hi:[1,0]
v_pk_mul_f32 v[216:217],v[216:217],v[62:63] op_sel_hi:[1,0]
v_pk_mul_f32 v[232:233],v[232:233],v[62:63] op_sel_hi:[1,0]
v_pk_mul_f32 v[218:219],v[218:219],v[62:63] op_sel_hi:[1,0]
v_pk_mul_f32 v[234:235],v[234:235],v[62:63] op_sel_hi:[1,0]
v_pk_mul_f32 v[220:221],v[220:221],v[62:63] op_sel_hi:[1,0]
v_pk_mul_f32 v[236:237],v[236:237],v[62:63] op_sel_hi:[1,0]
v_pk_mul_f32 v[222:223],v[222:223],v[62:63] op_sel_hi:[1,0]
v_pk_mul_f32 v[238:239],v[238:239],v[62:63] op_sel_hi:[1,0]
v_pk_mul_f32 v[240:241],v[240:241],v[62:63] op_sel_hi:[1,0]
v_pk_mul_f32 v[242:243],v[242:243],v[62:63] op_sel_hi:[1,0]
v_pk_mul_f32 v[244:245],v[244:245],v[62:63] op_sel_hi:[1,0]
v_pk_mul_f32 v[246:247],v[246:247],v[62:63] op_sel_hi:[1,0]
v_pk_mul_f32 v[248:249],v[248:249],v[62:63] op_sel_hi:[1,0]
v_pk_mul_f32 v[250:251],v[250:251],v[62:63] op_sel_hi:[1,0]
v_pk_mul_f32 v[252:253],v[252:253],v[62:63] op_sel_hi:[1,0]
v_pk_mul_f32 v[254:255],v[254:255],v[62:63] op_sel_hi:[1,0]
v_pk_mul_f32 v[160:161],v[160:161],v[60:61] op_sel_hi:[1,0]
v_pk_mul_f32 v[176:177],v[176:177],v[60:61] op_sel_hi:[1,0]
v_pk_mul_f32 v[162:163],v[162:163],v[60:61] op_sel_hi:[1,0]
v_pk_mul_f32 v[178:179],v[178:179],v[60:61] op_sel_hi:[1,0]
v_pk_mul_f32 v[164:165],v[164:165],v[60:61] op_sel_hi:[1,0]
v_pk_mul_f32 v[180:181],v[180:181],v[60:61] op_sel_hi:[1,0]
v_pk_mul_f32 v[166:167],v[166:167],v[60:61] op_sel_hi:[1,0]
v_pk_mul_f32 v[182:183],v[182:183],v[60:61] op_sel_hi:[1,0]
v_pk_mul_f32 v[168:169],v[168:169],v[60:61] op_sel_hi:[1,0]
v_pk_mul_f32 v[184:185],v[184:185],v[60:61] op_sel_hi:[1,0]
v_pk_mul_f32 v[170:171],v[170:171],v[60:61] op_sel_hi:[1,0]
v_pk_mul_f32 v[186:187],v[186:187],v[60:61] op_sel_hi:[1,0]
v_pk_mul_f32 v[172:173],v[172:173],v[60:61] op_sel_hi:[1,0]
v_pk_mul_f32 v[188:189],v[188:189],v[60:61] op_sel_hi:[1,0]
v_pk_mul_f32 v[174:175],v[174:175],v[60:61] op_sel_hi:[1,0]
v_pk_mul_f32 v[190:191],v[190:191],v[60:61] op_sel_hi:[1,0]
v_pk_mul_f32 v[192:193],v[192:193],v[60:61] op_sel_hi:[1,0]
v_pk_mul_f32 v[194:195],v[194:195],v[60:61] op_sel_hi:[1,0]
v_pk_mul_f32 v[196:197],v[196:197],v[60:61] op_sel_hi:[1,0]
v_pk_mul_f32 v[198:199],v[198:199],v[60:61] op_sel_hi:[1,0]
v_pk_mul_f32 v[200:201],v[200:201],v[60:61] op_sel_hi:[1,0]
v_pk_mul_f32 v[202:203],v[202:203],v[60:61] op_sel_hi:[1,0]
v_pk_mul_f32 v[204:205],v[204:205],v[60:61] op_sel_hi:[1,0]
v_pk_mul_f32 v[206:207],v[206:207],v[60:61] op_sel_hi:[1,0]
v_add_u32 v38,v38,v19
v_accvgpr_read_b32 v100,a92
v_accvgpr_read_b32 v101,a93
v_pk_mul_f32 v[100:101],v[100:101],v[66:67] op_sel_hi:[1,0]
v_accvgpr_read_b32 v88,a140
v_accvgpr_read_b32 v89,a141
v_pk_mul_f32 v[88:89],v[88:89],v[70:71] op_sel_hi:[1,0]
v_accvgpr_read_b32 v102,a94
v_accvgpr_read_b32 v103,a95
v_pk_mul_f32 v[102:103],v[102:103],v[66:67] op_sel_hi:[1,0]
v_accvgpr_read_b32 v90,a142
v_accvgpr_read_b32 v91,a143
v_pk_mul_f32 v[90:91],v[90:91],v[70:71] op_sel_hi:[1,0]
v_cvt_pk_bf16_f32 v100,v100,v101
v_cvt_pk_bf16_f32 v88,v88,v89
v_cvt_pk_bf16_f32 v101,v102,v103
v_cvt_pk_bf16_f32 v89,v90,v91
ds_write2st64_b64 v39,v[100:101],v[88:89] offset0:36 offset1:40
v_add_u32 v39,v39,v19
v_cvt_pk_bf16_f32 v208,v208,v209
v_cvt_pk_bf16_f32 v224,v224,v225
ds_read_b128 v[104:107],v10 offset:18432
ds_read_b128 v[156:159],v10 offset:19456
v_cvt_pk_bf16_f32 v212,v212,v213
ds_read_b128 v[72:75],v10 offset:20480
v_cvt_pk_bf16_f32 v228,v228,v229
ds_read_b128 v[80:83],v10 offset:21504
v_cvt_pk_bf16_f32 v209,v210,v211
v_cvt_pk_bf16_f32 v225,v226,v227
ds_write2st64_b64 v36,v[208:209],v[224:225] offset0:12 offset1:14
v_cvt_pk_bf16_f32 v216,v216,v217
v_cvt_pk_bf16_f32 v232,v232,v233
v_cvt_pk_bf16_f32 v213,v214,v215
v_cvt_pk_bf16_f32 v229,v230,v231
v_cvt_pk_bf16_f32 v220,v220,v221
v_cvt_pk_bf16_f32 v236,v236,v237
v_cvt_pk_bf16_f32 v217,v218,v219
v_cvt_pk_bf16_f32 v233,v234,v235
v_cvt_pk_bf16_f32 v221,v222,v223
v_cvt_pk_bf16_f32 v237,v238,v239
v_accvgpr_read_b32 v96,a0
ds_write2st64_b64 v37,v[212:213],v[228:229] offset0:12 offset1:14
v_accvgpr_read_b32 v97,a1
v_pk_mul_f32 v[96:97],v[96:97],v[64:65] op_sel_hi:[1,0]
v_accvgpr_read_b32 v98,a2
s_waitcnt lgkmcnt(3)
buffer_store_dwordx4 v[104:107],v9,s[16:19],s87 offen offset:256 nt
v_accvgpr_read_b32 v99,a3
v_pk_mul_f32 v[98:99],v[98:99],v[64:65] op_sel_hi:[1,0]
v_accvgpr_read_b32 v88,a4
v_accvgpr_read_b32 v89,a5
v_pk_mul_f32 v[88:89],v[88:89],v[64:65] op_sel_hi:[1,0]
v_cvt_pk_bf16_f32 v240,v240,v241
v_accvgpr_read_b32 v90,a6
v_accvgpr_read_b32 v91,a7
v_pk_mul_f32 v[90:91],v[90:91],v[64:65] op_sel_hi:[1,0]
ds_write2st64_b64 v38,v[216:217],v[232:233] offset0:12 offset1:14
v_accvgpr_read_b32 v100,a8
v_accvgpr_read_b32 v101,a9
v_pk_mul_f32 v[100:101],v[100:101],v[64:65] op_sel_hi:[1,0]
buffer_store_dwordx4 v[156:159],v9,s[16:19],s87 offen offset:3328 nt
v_cvt_pk_bf16_f32 v96,v96,v97
v_cvt_pk_bf16_f32 v244,v244,v245
v_accvgpr_read_b32 v102,a10
v_accvgpr_read_b32 v103,a11
v_pk_mul_f32 v[102:103],v[102:103],v[64:65] op_sel_hi:[1,0]
v_accvgpr_read_b32 v208,a12
v_accvgpr_read_b32 v209,a13
v_pk_mul_f32 v[208:209],v[208:209],v[64:65] op_sel_hi:[1,0]
v_cvt_pk_bf16_f32 v88,v88,v89
ds_write2st64_b64 v39,v[220:221],v[236:237] offset0:12 offset1:14
v_cvt_pk_bf16_f32 v241,v242,v243
v_cvt_pk_bf16_f32 v97,v98,v99
v_cvt_pk_bf16_f32 v248,v248,v249
ds_read_b128 v[84:87],v10 offset:6144
ds_read_b128 v[92:95],v10 offset:9216
buffer_store_dwordx4 v[72:75],v9,s[16:19],s66 offen offset:256 nt
ds_read_b128 v[108:111],v10 offset:7168
v_accvgpr_read_b32 v210,a14
ds_read_b128 v[76:79],v10 offset:10240
v_accvgpr_read_b32 v211,a15
v_pk_mul_f32 v[210:211],v[210:211],v[64:65] op_sel_hi:[1,0]
v_cvt_pk_bf16_f32 v100,v100,v101
ds_write2st64_b64 v36,v[240:241],v[96:97] offset0:16 offset1:24
v_cvt_pk_bf16_f32 v245,v246,v247
v_cvt_pk_bf16_f32 v89,v90,v91
v_cvt_pk_bf16_f32 v252,v252,v253
s_waitcnt lgkmcnt(5)
buffer_store_dwordx4 v[80:83],v9,s[16:19],s66 offen offset:3328 nt
v_cvt_pk_bf16_f32 v208,v208,v209
v_cvt_pk_bf16_f32 v249,v250,v251
v_cvt_pk_bf16_f32 v101,v102,v103
v_cvt_pk_bf16_f32 v253,v254,v255
v_cvt_pk_bf16_f32 v209,v210,v211
v_accvgpr_read_b32 v212,a32
v_accvgpr_read_b32 v213,a33
v_pk_mul_f32 v[212:213],v[212:213],v[64:65] op_sel_hi:[1,0]
v_accvgpr_read_b32 v104,a16
ds_write2st64_b64 v37,v[244:245],v[88:89] offset0:16 offset1:24
v_accvgpr_read_b32 v105,a17
v_pk_mul_f32 v[104:105],v[104:105],v[64:65] op_sel_hi:[1,0]
v_accvgpr_read_b32 v214,a34
s_waitcnt lgkmcnt(2)
buffer_store_dwordx4 v[84:87],v9,s[16:19],s85 offen offset:0 nt
v_accvgpr_read_b32 v215,a35
v_pk_mul_f32 v[214:215],v[214:215],v[64:65] op_sel_hi:[1,0]
v_accvgpr_read_b32 v228,a20
v_accvgpr_read_b32 v229,a21
v_pk_mul_f32 v[228:229],v[228:229],v[64:65] op_sel_hi:[1,0]
v_accvgpr_read_b32 v106,a18
v_accvgpr_read_b32 v107,a19
v_pk_mul_f32 v[106:107],v[106:107],v[64:65] op_sel_hi:[1,0]
v_accvgpr_read_b32 v216,a36
ds_write2st64_b64 v38,v[248:249],v[100:101] offset0:16 offset1:24
v_accvgpr_read_b32 v217,a37
v_pk_mul_f32 v[216:217],v[216:217],v[64:65] op_sel_hi:[1,0]
v_accvgpr_read_b32 v230,a22
buffer_store_dwordx4 v[92:95],v9,s[16:19],s85 offen offset:3072 nt
v_accvgpr_read_b32 v231,a23
v_pk_mul_f32 v[230:231],v[230:231],v[64:65] op_sel_hi:[1,0]
v_accvgpr_read_b32 v218,a38
v_accvgpr_read_b32 v219,a39
v_pk_mul_f32 v[218:219],v[218:219],v[64:65] op_sel_hi:[1,0]
v_accvgpr_read_b32 v232,a24
v_accvgpr_read_b32 v233,a25
v_pk_mul_f32 v[232:233],v[232:233],v[64:65] op_sel_hi:[1,0]
v_accvgpr_read_b32 v220,a40
ds_write2st64_b64 v39,v[252:253],v[208:209] offset0:16 offset1:24
v_accvgpr_read_b32 v221,a41
v_pk_mul_f32 v[220:221],v[220:221],v[64:65] op_sel_hi:[1,0]
v_cvt_pk_bf16_f32 v212,v212,v213
ds_read_b128 v[224:227],v10 offset:8192
ds_read_b128 v[156:159],v10 offset:11264
buffer_store_dwordx4 v[108:111],v9,s[16:19],s85 offen offset:128 nt
ds_read_b128 v[72:75],v10 offset:12288
v_cvt_pk_bf16_f32 v104,v104,v105
ds_read_b128 v[80:83],v10 offset:15360
v_accvgpr_read_b32 v234,a26
v_accvgpr_read_b32 v235,a27
v_pk_mul_f32 v[234:235],v[234:235],v[64:65] op_sel_hi:[1,0]
v_accvgpr_read_b32 v222,a42
v_accvgpr_read_b32 v223,a43
buffer_store_dwordx4 v[76:79],v9,s[16:19],s85 offen offset:3200 nt
v_pk_mul_f32 v[222:223],v[222:223],v[64:65] op_sel_hi:[1,0]
v_accvgpr_read_b32 v236,a28
v_accvgpr_read_b32 v237,a29
v_pk_mul_f32 v[236:237],v[236:237],v[64:65] op_sel_hi:[1,0]
v_accvgpr_read_b32 v96,a44
v_accvgpr_read_b32 v97,a45
v_pk_mul_f32 v[96:97],v[96:97],v[64:65] op_sel_hi:[1,0]
v_cvt_pk_bf16_f32 v228,v228,v229
v_cvt_pk_bf16_f32 v216,v216,v217
v_cvt_pk_bf16_f32 v213,v214,v215
v_cvt_pk_bf16_f32 v105,v106,v107
ds_write2st64_b64 v36,v[104:105],v[212:213] offset0:26 offset1:28
v_accvgpr_read_b32 v238,a30
v_accvgpr_read_b32 v239,a31
v_pk_mul_f32 v[238:239],v[238:239],v[64:65] op_sel_hi:[1,0]
s_waitcnt lgkmcnt(2)
buffer_store_dwordx4 v[224:227],v9,s[16:19],s85 offen offset:256 nt
v_accvgpr_read_b32 v98,a46
v_accvgpr_read_b32 v99,a47
v_pk_mul_f32 v[98:99],v[98:99],v[64:65] op_sel_hi:[1,0]
v_cvt_pk_bf16_f32 v232,v232,v233
v_cvt_pk_bf16_f32 v220,v220,v221
v_cvt_pk_bf16_f32 v229,v230,v231
v_cvt_pk_bf16_f32 v217,v218,v219
v_cvt_pk_bf16_f32 v236,v236,v237
v_cvt_pk_bf16_f32 v96,v96,v97
ds_write2st64_b64 v37,v[228:229],v[216:217] offset0:26 offset1:28
v_cvt_pk_bf16_f32 v233,v234,v235
v_cvt_pk_bf16_f32 v221,v222,v223
v_cvt_pk_bf16_f32 v237,v238,v239
buffer_store_dwordx4 v[156:159],v9,s[16:19],s85 offen offset:3328 nt
v_cvt_pk_bf16_f32 v97,v98,v99
v_cvt_pk_bf16_f32 v160,v160,v161
v_cvt_pk_bf16_f32 v176,v176,v177
v_cvt_pk_bf16_f32 v164,v164,v165
v_cvt_pk_bf16_f32 v180,v180,v181
v_cvt_pk_bf16_f32 v161,v162,v163
v_cvt_pk_bf16_f32 v177,v178,v179
v_cvt_pk_bf16_f32 v168,v168,v169
v_cvt_pk_bf16_f32 v184,v184,v185
ds_write2st64_b64 v38,v[232:233],v[220:221] offset0:26 offset1:28
v_cvt_pk_bf16_f32 v165,v166,v167
v_cvt_pk_bf16_f32 v181,v182,v183
v_cvt_pk_bf16_f32 v172,v172,v173
buffer_store_dwordx4 v[72:75],v9,s[16:19],s86 offen offset:0 nt
v_cvt_pk_bf16_f32 v188,v188,v189
v_cvt_pk_bf16_f32 v169,v170,v171
v_cvt_pk_bf16_f32 v185,v186,v187
v_cvt_pk_bf16_f32 v173,v174,v175
v_cvt_pk_bf16_f32 v189,v190,v191
v_cvt_pk_bf16_f32 v192,v192,v193
v_cvt_pk_bf16_f32 v196,v196,v197
v_cvt_pk_bf16_f32 v193,v194,v195
v_cvt_pk_bf16_f32 v200,v200,v201
ds_write2st64_b64 v39,v[236:237],v[96:97] offset0:26 offset1:28
v_cvt_pk_bf16_f32 v197,v198,v199
v_cvt_pk_bf16_f32 v204,v204,v205
v_cvt_pk_bf16_f32 v201,v202,v203
ds_read_b128 v[240:243],v10 offset:13312
ds_read_b128 v[76:79],v10 offset:16384
s_waitcnt lgkmcnt(3)
buffer_store_dwordx4 v[80:83],v9,s[16:19],s86 offen offset:3072 nt
ds_read_b128 v[84:87],v10 offset:14336
v_cvt_pk_bf16_f32 v205,v206,v207
ds_read_b128 v[88:91],v10 offset:17408
ds_write2st64_b64 v36,v[160:161],v[176:177] offset0:0 offset1:2
ds_write2st64_b64 v37,v[164:165],v[180:181] offset0:0 offset1:2
s_waitcnt lgkmcnt(2)
buffer_store_dwordx4 v[240:243],v9,s[16:19],s86 offen offset:128 nt
ds_write2st64_b64 v38,v[168:169],v[184:185] offset0:0 offset1:2
buffer_store_dwordx4 v[76:79],v9,s[16:19],s86 offen offset:3200 nt
ds_write2st64_b64 v39,v[172:173],v[188:189] offset0:0 offset1:2
ds_read_b128 v[92:95],v10 offset:0
ds_read_b128 v[108:111],v10 offset:3072
buffer_store_dwordx4 v[84:87],v9,s[16:19],s86 offen offset:256 nt
ds_read_b128 v[244:247],v10 offset:1024
ds_read_b128 v[100:103],v10 offset:4096
ds_write_b64 v36,v[192:193] offset:2048
buffer_store_dwordx4 v[88:91],v9,s[16:19],s86 offen offset:3328 nt
ds_write_b64 v37,v[196:197] offset:2048
s_waitcnt lgkmcnt(4)
buffer_store_dwordx4 v[92:95],v9,s[16:19],s84 offen offset:0 nt
ds_write_b64 v38,v[200:201] offset:2048
buffer_store_dwordx4 v[108:111],v9,s[16:19],s84 offen offset:3072 nt
ds_write_b64 v39,v[204:205] offset:2048
ds_read_b128 v[248:251],v10 offset:2048
ds_read_b128 v[208:211],v10 offset:5120
s_waitcnt lgkmcnt(4)
buffer_store_dwordx4 v[244:247],v9,s[16:19],s84 offen offset:128 nt
buffer_store_dwordx4 v[100:103],v9,s[16:19],s84 offen offset:3200 nt
s_waitcnt lgkmcnt(1)
buffer_store_dwordx4 v[248:251],v9,s[16:19],s84 offen offset:256 nt
s_waitcnt lgkmcnt(0)
buffer_store_dwordx4 v[208:211],v9,s[16:19],s84 offen offset:3328 nt
s_branch L_fin
L_end4:
s_waitcnt lgkmcnt(4)
v_mfma_f32_16x16x32_bf16 v[160:163],v[112:115],v[20:23],v[160:163]
ds_read_b64_tr_b16 v[128:129],v2 offset:24704
ds_read_b64_tr_b16 v[130:131],v2 offset:30848
v_mfma_f32_16x16x32_bf16 v[208:211],v[112:115],v[24:27],v[208:211]
ds_read_b64_tr_b16 v[132:133],v3 offset:24704
ds_read_b64_tr_b16 v[134:135],v3 offset:30848
v_mfma_f32_16x16x32_bf16 a[0:3],v[112:115],v[28:31],a[0:3]
ds_read_b64_tr_b16 v[136:137],v4 offset:24704
ds_read_b64_tr_b16 v[138:139],v4 offset:30848
v_mfma_f32_16x16x32_bf16 a[48:51],v[112:115],v[32:35],a[48:51]
ds_read_b64_tr_b16 v[140:141],v5 offset:24704
ds_read_b64_tr_b16 v[142:143],v5 offset:30848
v_mfma_f32_16x16x32_bf16 v[164:167],v[116:119],v[20:23],v[164:167]
ds_read_b64_tr_b16 v[112:113],v2 offset:24832
ds_read_b64_tr_b16 v[114:115],v2 offset:30976
v_mfma_f32_16x16x32_bf16 v[212:215],v[116:119],v[24:27],v[212:215]
v_fma_f32 v82,v82,s36,v14
v_fma_f32 v83,v83,s36,v14
v_mfma_f32_16x16x32_bf16 a[4:7],v[116:119],v[28:31],a[4:7]
v_fma_f32 v88,v88,s36,v15
v_fma_f32 v89,v89,s36,v15
v_mfma_f32_16x16x32_bf16 a[52:55],v[116:119],v[32:35],a[52:55]
s_waitcnt lgkmcnt(10)
ds_read_b64_tr_b16 v[116:117],v3 offset:24832
ds_read_b64_tr_b16 v[118:119],v3 offset:30976
v_mfma_f32_16x16x32_bf16 v[168:171],v[120:123],v[20:23],v[168:171]
v_fma_f32 v90,v90,s36,v15
v_fma_f32 v91,v91,s36,v15
v_mfma_f32_16x16x32_bf16 v[216:219],v[120:123],v[24:27],v[216:219]
v_fma_f32 v96,v96,s36,v16
v_fma_f32 v97,v97,s36,v16
v_mfma_f32_16x16x32_bf16 a[8:11],v[120:123],v[28:31],a[8:11]
v_fma_f32 v98,v98,s36,v16
v_fma_f32 v99,v99,s36,v16
v_mfma_f32_16x16x32_bf16 a[56:59],v[120:123],v[32:35],a[56:59]
ds_read_b64_tr_b16 v[120:121],v4 offset:24832
ds_read_b64_tr_b16 v[122:123],v4 offset:30976
v_mfma_f32_16x16x32_bf16 v[172:175],v[124:127],v[20:23],v[172:175]
v_fma_f32 v76,v76,s36,v13
v_fma_f32 v77,v77,s36,v13
v_mfma_f32_16x16x32_bf16 v[220:223],v[124:127],v[24:27],v[220:223]
v_fma_f32 v78,v78,s36,v13
v_fma_f32 v79,v79,s36,v13
v_mfma_f32_16x16x32_bf16 a[12:15],v[124:127],v[28:31],a[12:15]
v_fma_f32 v84,v84,s36,v14
v_fma_f32 v85,v85,s36,v14
v_mfma_f32_16x16x32_bf16 a[60:63],v[124:127],v[32:35],a[60:63]
s_waitcnt lgkmcnt(3)
ds_read_b64_tr_b16 v[124:125],v5 offset:24832
ds_read_b64_tr_b16 v[126:127],v5 offset:30976
v_mfma_f32_16x16x32_bf16 v[176:179],v[128:131],v[20:23],v[176:179]
v_fma_f32 v86,v86,s36,v14
v_fma_f32 v87,v87,s36,v14
v_mfma_f32_16x16x32_bf16 v[224:227],v[128:131],v[24:27],v[224:227]
v_fma_f32 v92,v92,s36,v15
v_fma_f32 v93,v93,s36,v15
v_mfma_f32_16x16x32_bf16 a[16:19],v[128:131],v[28:31],a[16:19]
v_fma_f32 v94,v94,s36,v15
v_fma_f32 v95,v95,s36,v15
v_mfma_f32_16x16x32_bf16 a[64:67],v[128:131],v[32:35],a[64:67]
v_fma_f32 v100,v100,s36,v16
v_fma_f32 v101,v101,s36,v16
v_mfma_f32_16x16x32_bf16 v[180:183],v[132:135],v[20:23],v[180:183]
v_fma_f32 v102,v102,s36,v16
v_fma_f32 v103,v103,s36,v16
v_mfma_f32_16x16x32_bf16 v[228:231],v[132:135],v[24:27],v[228:231]
v_exp_f32 v82,v82
v_mfma_f32_16x16x32_bf16 a[20:23],v[132:135],v[28:31],a[20:23]
v_exp_f32 v83,v83
v_mfma_f32_16x16x32_bf16 a[68:71],v[132:135],v[32:35],a[68:71]
v_exp_f32 v88,v88
v_mfma_f32_16x16x32_bf16 v[184:187],v[136:139],v[20:23],v[184:187]
v_exp_f32 v89,v89
v_mfma_f32_16x16x32_bf16 v[232:235],v[136:139],v[24:27],v[232:235]
v_exp_f32 v90,v90
v_mfma_f32_16x16x32_bf16 a[24:27],v[136:139],v[28:31],a[24:27]
v_exp_f32 v91,v91
v_mfma_f32_16x16x32_bf16 a[72:75],v[136:139],v[32:35],a[72:75]
v_exp_f32 v96,v96
v_mfma_f32_16x16x32_bf16 v[188:191],v[140:143],v[20:23],v[188:191]
v_exp_f32 v97,v97
v_mfma_f32_16x16x32_bf16 v[236:239],v[140:143],v[24:27],v[236:239]
v_exp_f32 v98,v98
v_mfma_f32_16x16x32_bf16 a[28:31],v[140:143],v[28:31],a[28:31]
v_exp_f32 v99,v99
v_mfma_f32_16x16x32_bf16 a[76:79],v[140:143],v[32:35],a[76:79]
v_exp_f32 v76,v76
v_mfma_f32_16x16x32_bf16 v[192:195],v[112:115],v[20:23],v[192:195]
v_exp_f32 v77,v77
v_mfma_f32_16x16x32_bf16 v[240:243],v[112:115],v[24:27],v[240:243]
v_exp_f32 v78,v78
v_mfma_f32_16x16x32_bf16 a[32:35],v[112:115],v[28:31],a[32:35]
v_exp_f32 v79,v79
v_mfma_f32_16x16x32_bf16 a[80:83],v[112:115],v[32:35],a[80:83]
s_waitcnt lgkmcnt(0)
v_exp_f32 v84,v84
v_mfma_f32_16x16x32_bf16 v[196:199],v[116:119],v[20:23],v[196:199]
v_exp_f32 v85,v85
v_mfma_f32_16x16x32_bf16 v[244:247],v[116:119],v[24:27],v[244:247]
v_exp_f32 v86,v86
v_mfma_f32_16x16x32_bf16 a[36:39],v[116:119],v[28:31],a[36:39]
v_exp_f32 v87,v87
v_mfma_f32_16x16x32_bf16 a[84:87],v[116:119],v[32:35],a[84:87]
v_exp_f32 v92,v92
s_waitcnt vmcnt(14)
s_barrier
v_mfma_f32_16x16x32_bf16 v[200:203],v[120:123],v[20:23],v[200:203]
v_exp_f32 v93,v93
v_mfma_f32_16x16x32_bf16 v[248:251],v[120:123],v[24:27],v[248:251]
v_exp_f32 v94,v94
v_mfma_f32_16x16x32_bf16 a[40:43],v[120:123],v[28:31],a[40:43]
v_exp_f32 v95,v95
v_mfma_f32_16x16x32_bf16 a[88:91],v[120:123],v[32:35],a[88:91]
v_exp_f32 v100,v100
v_mfma_f32_16x16x32_bf16 v[204:207],v[124:127],v[20:23],v[204:207]
v_exp_f32 v101,v101
v_mfma_f32_16x16x32_bf16 v[252:255],v[124:127],v[24:27],v[252:255]
v_exp_f32 v102,v102
v_mfma_f32_16x16x32_bf16 a[44:47],v[124:127],v[28:31],a[44:47]
v_exp_f32 v103,v103
v_mfma_f32_16x16x32_bf16 a[92:95],v[124:127],v[32:35],a[92:95]
v_cvt_pk_bf16_f32 v45,v82,v83
v_cvt_pk_bf16_f32 v48,v88,v89
v_cvt_pk_bf16_f32 v49,v90,v91
v_cvt_pk_bf16_f32 v52,v96,v97
v_cvt_pk_bf16_f32 v53,v98,v99
v_cvt_pk_bf16_f32 v42,v76,v77
v_cvt_pk_bf16_f32 v43,v78,v79
v_cvt_pk_bf16_f32 v46,v84,v85
v_cvt_pk_bf16_f32 v47,v86,v87
v_cvt_pk_bf16_f32 v50,v92,v93
v_cvt_pk_bf16_f32 v51,v94,v95
v_smfmac_f32_16x16x64_bf16 v[60:63],v[152:155],v[40:47],v18
v_cvt_pk_bf16_f32 v54,v100,v101
ds_read_b64_tr_b16 v[128:129],v2 offset:0
ds_read_b64_tr_b16 v[130:131],v2 offset:6144
v_cvt_pk_bf16_f32 v55,v102,v103
v_subrev_u32 v10,18432,v10
ds_read_b64_tr_b16 v[132:133],v3 offset:0
v_smfmac_f32_16x16x64_bf16 v[64:67],v[152:155],v[48:55],v18
ds_read_b64_tr_b16 v[134:135],v3 offset:6144
ds_read_b64_tr_b16 v[136:137],v4 offset:0
ds_read_b64_tr_b16 v[138:139],v4 offset:6144
ds_read_b64_tr_b16 v[140:141],v5 offset:0
ds_read_b64_tr_b16 v[142:143],v5 offset:6144
s_waitcnt lgkmcnt(6)
v_mfma_f32_16x16x32_bf16 v[160:163],v[128:131],v[40:43],v[160:163]
s_waitcnt vmcnt(6)
ds_read_b64_tr_b16 v[112:113],v2 offset:128
ds_read_b64_tr_b16 v[114:115],v2 offset:6272
v_mfma_f32_16x16x32_bf16 v[208:211],v[128:131],v[44:47],v[208:211]
s_add_u32 s84,s42,0
ds_read_b64_tr_b16 v[116:117],v3 offset:128
ds_read_b64_tr_b16 v[118:119],v3 offset:6272
v_mfma_f32_16x16x32_bf16 a[0:3],v[128:131],v[48:51],a[0:3]
s_add_u32 s85,s42,6144
ds_read_b64_tr_b16 v[120:121],v4 offset:128
ds_read_b64_tr_b16 v[122:123],v4 offset:6272
v_mfma_f32_16x16x32_bf16 a[48:51],v[128:131],v[52:55],a[48:51]
s_add_u32 s86,s42,12288
ds_read_b64_tr_b16 v[124:125],v5 offset:128
ds_read_b64_tr_b16 v[126:127],v5 offset:6272
s_waitcnt lgkmcnt(12)
v_mfma_f32_16x16x32_bf16 v[164:167],v[132:135],v[40:43],v[164:167]
s_add_u32 s87,s42,18432
ds_read_b64_tr_b16 v[128:129],v2 offset:256
ds_read_b64_tr_b16 v[130:131],v2 offset:6400
v_mfma_f32_16x16x32_bf16 v[212:215],v[132:135],v[44:47],v[212:215]
v_mbcnt_lo_u32_b32 v39,-1,0
v_mbcnt_hi_u32_b32 v39,-1,v39
v_mfma_f32_16x16x32_bf16 a[4:7],v[132:135],v[48:51],a[4:7]
v_and_b32 v38,7,v39
v_add_f32 v60,v60,v61
v_mfma_f32_16x16x32_bf16 a[52:55],v[132:135],v[52:55],a[52:55]
s_waitcnt lgkmcnt(10)
ds_read_b64_tr_b16 v[132:133],v3 offset:256
ds_read_b64_tr_b16 v[134:135],v3 offset:6400
v_mfma_f32_16x16x32_bf16 v[168:171],v[136:139],v[40:43],v[168:171]
v_add_f32 v62,v62,v63
v_add_f32 v64,v64,v65
v_mfma_f32_16x16x32_bf16 v[216:219],v[136:139],v[44:47],v[216:219]
v_add_f32 v66,v66,v67
v_max3_f32 v19,v60,v62,v64
v_mfma_f32_16x16x32_bf16 a[8:11],v[136:139],v[48:51],a[8:11]
v_max_f32 v19,v19,v66
v_rcp_f32 v66,v66
v_mfma_f32_16x16x32_bf16 a[56:59],v[136:139],v[52:55],a[56:59]
ds_read_b64_tr_b16 v[136:137],v4 offset:256
ds_read_b64_tr_b16 v[138:139],v4 offset:6400
v_mfma_f32_16x16x32_bf16 v[172:175],v[140:143],v[40:43],v[172:175]
v_accvgpr_read_b32 v72,a48
v_accvgpr_read_b32 v73,a49
v_mfma_f32_16x16x32_bf16 v[220:223],v[140:143],v[44:47],v[220:223]
v_accvgpr_read_b32 v74,a50
v_accvgpr_read_b32 v75,a51
v_mfma_f32_16x16x32_bf16 a[12:15],v[140:143],v[48:51],a[12:15]
v_accvgpr_read_b32 v80,a52
v_accvgpr_read_b32 v81,a53
v_mfma_f32_16x16x32_bf16 a[60:63],v[140:143],v[52:55],a[60:63]
s_waitcnt lgkmcnt(2)
ds_read_b64_tr_b16 v[140:141],v5 offset:256
ds_read_b64_tr_b16 v[142:143],v5 offset:6400
v_mfma_f32_16x16x32_bf16 v[176:179],v[112:115],v[40:43],v[176:179]
v_accvgpr_read_b32 v82,a54
v_accvgpr_read_b32 v83,a55
v_mfma_f32_16x16x32_bf16 v[224:227],v[112:115],v[44:47],v[224:227]
v_accvgpr_read_b32 v88,a56
v_accvgpr_read_b32 v89,a57
v_mfma_f32_16x16x32_bf16 a[16:19],v[112:115],v[48:51],a[16:19]
v_accvgpr_read_b32 v90,a58
v_accvgpr_read_b32 v91,a59
v_mfma_f32_16x16x32_bf16 a[64:67],v[112:115],v[52:55],a[64:67]
v_accvgpr_read_b32 v96,a60
v_accvgpr_read_b32 v97,a61
v_mfma_f32_16x16x32_bf16 v[180:183],v[116:119],v[40:43],v[180:183]
v_accvgpr_read_b32 v98,a62
v_accvgpr_read_b32 v99,a63
v_mfma_f32_16x16x32_bf16 v[228:231],v[116:119],v[44:47],v[228:231]
v_cmp_ngt_f32 vcc,s37,v19
v_lshrrev_b32 v19,5,v39
v_mfma_f32_16x16x32_bf16 a[20:23],v[116:119],v[48:51],a[20:23]
v_xor_b32 v38,v38,v19
v_and_b32 v19,15,v39
v_lshl_add_u32 v19,v19,7,s24
v_lshl_add_u32 v19,v38,4,v19
v_bfe_u32 v38,v39,4,1
v_pk_mul_f32 v[72:73],v[72:73],v[66:67] op_sel_hi:[1,0]
v_pk_mul_f32 v[74:75],v[74:75],v[66:67] op_sel_hi:[1,0]
v_lshl_add_u32 v36,v38,3,v19
v_xor_b32 v37,32,v36
v_bfe_u32 v19,v39,3,1
v_xor_b32 v38,64,v36
v_xor_b32 v39,96,v36
v_lshlrev_b32 v19,11,v19
v_accvgpr_read_b32 v76,a64
v_accvgpr_read_b32 v77,a65
v_pk_mul_f32 v[76:77],v[76:77],v[66:67] op_sel_hi:[1,0]
v_accvgpr_read_b32 v78,a66
v_accvgpr_read_b32 v79,a67
v_pk_mul_f32 v[78:79],v[78:79],v[66:67] op_sel_hi:[1,0]
v_cvt_pk_bf16_f32 v72,v72,v73
v_cvt_pk_bf16_f32 v76,v76,v77
v_mfma_f32_16x16x32_bf16 a[68:71],v[116:119],v[52:55],a[68:71]
s_cmp_lg_u64 vcc,0
v_cvt_pk_bf16_f32 v73,v74,v75
v_cvt_pk_bf16_f32 v77,v78,v79
v_mfma_f32_16x16x32_bf16 v[184:187],v[120:123],v[40:43],v[184:187]
s_cselect_b32 s62,s32,0
ds_write2st64_b64 v36,v[72:73],v[76:77] offset0:36 offset1:40
v_mfma_f32_16x16x32_bf16 v[232:235],v[120:123],v[44:47],v[232:235]
s_or_b32 s31,s31,s62
v_accvgpr_read_b32 v84,a68
v_accvgpr_read_b32 v85,a69
v_mfma_f32_16x16x32_bf16 a[24:27],v[120:123],v[48:51],a[24:27]
s_lshl_b32 s32,s32,1
v_accvgpr_read_b32 v86,a70
v_accvgpr_read_b32 v87,a71
v_rcp_f32 v62,v62
v_rcp_f32 v64,v64
v_pk_mul_f32 v[80:81],v[80:81],v[66:67] op_sel_hi:[1,0]
v_pk_mul_f32 v[82:83],v[82:83],v[66:67] op_sel_hi:[1,0]
v_pk_mul_f32 v[84:85],v[84:85],v[66:67] op_sel_hi:[1,0]
v_pk_mul_f32 v[86:87],v[86:87],v[66:67] op_sel_hi:[1,0]
v_cvt_pk_bf16_f32 v80,v80,v81
v_cvt_pk_bf16_f32 v84,v84,v85
v_mfma_f32_16x16x32_bf16 a[72:75],v[120:123],v[52:55],a[72:75]
v_cvt_pk_bf16_f32 v81,v82,v83
v_cvt_pk_bf16_f32 v85,v86,v87
v_mfma_f32_16x16x32_bf16 v[188:191],v[124:127],v[40:43],v[188:191]
ds_write2st64_b64 v37,v[80:81],v[84:85] offset0:36 offset1:40
v_mfma_f32_16x16x32_bf16 v[236:239],v[124:127],v[44:47],v[236:239]
v_rcp_f32 v60,v60
v_mfma_f32_16x16x32_bf16 a[28:31],v[124:127],v[48:51],a[28:31]
v_pk_mul_f32 v[88:89],v[88:89],v[66:67] op_sel_hi:[1,0]
v_pk_mul_f32 v[90:91],v[90:91],v[66:67] op_sel_hi:[1,0]
v_accvgpr_read_b32 v92,a72
v_accvgpr_read_b32 v93,a73
v_pk_mul_f32 v[92:93],v[92:93],v[66:67] op_sel_hi:[1,0]
v_accvgpr_read_b32 v94,a74
v_accvgpr_read_b32 v95,a75
v_pk_mul_f32 v[94:95],v[94:95],v[66:67] op_sel_hi:[1,0]
v_cvt_pk_bf16_f32 v88,v88,v89
v_cvt_pk_bf16_f32 v92,v92,v93
v_mfma_f32_16x16x32_bf16 a[76:79],v[124:127],v[52:55],a[76:79]
v_cvt_pk_bf16_f32 v89,v90,v91
v_cvt_pk_bf16_f32 v93,v94,v95
v_mfma_f32_16x16x32_bf16 v[192:195],v[128:131],v[40:43],v[192:195]
ds_write2st64_b64 v38,v[88:89],v[92:93] offset0:36 offset1:40
v_mfma_f32_16x16x32_bf16 v[240:243],v[128:131],v[44:47],v[240:243]
v_mfma_f32_16x16x32_bf16 a[32:35],v[128:131],v[48:51],a[32:35]
v_pk_mul_f32 v[96:97],v[96:97],v[66:67] op_sel_hi:[1,0]
v_pk_mul_f32 v[98:99],v[98:99],v[66:67] op_sel_hi:[1,0]
v_accvgpr_read_b32 v100,a76
v_accvgpr_read_b32 v101,a77
v_pk_mul_f32 v[100:101],v[100:101],v[66:67] op_sel_hi:[1,0]
v_accvgpr_read_b32 v102,a78
v_accvgpr_read_b32 v103,a79
v_pk_mul_f32 v[102:103],v[102:103],v[66:67] op_sel_hi:[1,0]
v_cvt_pk_bf16_f32 v96,v96,v97
v_cvt_pk_bf16_f32 v100,v100,v101
v_mfma_f32_16x16x32_bf16 a[80:83],v[128:131],v[52:55],a[80:83]
v_cvt_pk_bf16_f32 v97,v98,v99
v_cvt_pk_bf16_f32 v101,v102,v103
v_mfma_f32_16x16x32_bf16 v[196:199],v[132:135],v[40:43],v[196:199]
ds_write2st64_b64 v39,v[96:97],v[100:101] offset0:36 offset1:40
v_mfma_f32_16x16x32_bf16 v[244:247],v[132:135],v[44:47],v[244:247]
v_mfma_f32_16x16x32_bf16 a[36:39],v[132:135],v[48:51],a[36:39]
ds_read_b128 v[156:159],v10 offset:18432
ds_read_b128 v[104:107],v10 offset:19456
v_accvgpr_read_b32 v76,a80
ds_read_b128 v[108:111],v10 offset:20480
v_accvgpr_read_b32 v77,a81
ds_read_b128 v[72:75],v10 offset:21504
v_pk_mul_f32 v[76:77],v[76:77],v[66:67] op_sel_hi:[1,0]
v_accvgpr_read_b32 v78,a82
v_accvgpr_read_b32 v79,a83
v_pk_mul_f32 v[78:79],v[78:79],v[66:67] op_sel_hi:[1,0]
v_cvt_pk_bf16_f32 v76,v76,v77
v_cvt_pk_bf16_f32 v77,v78,v79
v_mfma_f32_16x16x32_bf16 a[84:87],v[132:135],v[52:55],a[84:87]
s_waitcnt lgkmcnt(5)
ds_write_b64 v36,v[76:77] offset:18432
v_mfma_f32_16x16x32_bf16 v[200:203],v[136:139],v[40:43],v[200:203]
v_add_u32 v36,v36,v19
v_mfma_f32_16x16x32_bf16 v[248:251],v[136:139],v[44:47],v[248:251]
v_mfma_f32_16x16x32_bf16 a[40:43],v[136:139],v[48:51],a[40:43]
s_waitcnt lgkmcnt(4)
buffer_store_dwordx4 v[156:159],v9,s[16:19],s87 offen offset:0 nt
s_waitcnt lgkmcnt(1)
buffer_store_dwordx4 v[104:107],v9,s[16:19],s87 offen offset:3072 nt
buffer_store_dwordx4 v[108:111],v9,s[16:19],s87 offen offset:128 nt
v_accvgpr_read_b32 v80,a84
v_accvgpr_read_b32 v81,a85
v_pk_mul_f32 v[80:81],v[80:81],v[66:67] op_sel_hi:[1,0]
v_accvgpr_read_b32 v82,a86
v_accvgpr_read_b32 v83,a87
v_pk_mul_f32 v[82:83],v[82:83],v[66:67] op_sel_hi:[1,0]
v_cvt_pk_bf16_f32 v80,v80,v81
v_cvt_pk_bf16_f32 v81,v82,v83
v_mfma_f32_16x16x32_bf16 a[88:91],v[136:139],v[52:55],a[88:91]
v_accvgpr_read_b32 v104,a4
v_accvgpr_read_b32 v105,a5
v_mfma_f32_16x16x32_bf16 v[204:207],v[140:143],v[40:43],v[204:207]
ds_write_b64 v37,v[80:81] offset:18432
v_mfma_f32_16x16x32_bf16 v[252:255],v[140:143],v[44:47],v[252:255]
buffer_store_dwordx4 v[72:75],v9,s[16:19],s87 offen offset:3200 nt
v_add_u32 v37,v37,v19
v_accvgpr_read_b32 v80,a0
v_accvgpr_read_b32 v84,a88
v_mfma_f32_16x16x32_bf16 a[44:47],v[140:143],v[48:51],a[44:47]
v_accvgpr_read_b32 v85,a89
v_accvgpr_read_b32 v86,a90
v_accvgpr_read_b32 v87,a91
v_accvgpr_read_b32 v81,a1
v_accvgpr_read_b32 v82,a2
v_pk_mul_f32 v[84:85],v[84:85],v[66:67] op_sel_hi:[1,0]
v_pk_mul_f32 v[86:87],v[86:87],v[66:67] op_sel_hi:[1,0]
v_cvt_pk_bf16_f32 v84,v84,v85
v_cvt_pk_bf16_f32 v85,v86,v87
v_mfma_f32_16x16x32_bf16 a[92:95],v[140:143],v[52:55],a[92:95]
ds_write_b64 v38,v[84:85] offset:18432
v_add_u32 v38,v38,v19
v_accvgpr_read_b32 v83,a3
v_pk_mul_f32 v[208:209],v[208:209],v[62:63] op_sel_hi:[1,0]
v_pk_mul_f32 v[224:225],v[224:225],v[62:63] op_sel_hi:[1,0]
v_pk_mul_f32 v[210:211],v[210:211],v[62:63] op_sel_hi:[1,0]
v_pk_mul_f32 v[226:227],v[226:227],v[62:63] op_sel_hi:[1,0]
v_pk_mul_f32 v[212:213],v[212:213],v[62:63] op_sel_hi:[1,0]
v_pk_mul_f32 v[228:229],v[228:229],v[62:63] op_sel_hi:[1,0]
v_pk_mul_f32 v[214:215],v[214:215],v[62:63] op_sel_hi:[1,0]
v_pk_mul_f32 v[230:231],v[230:231],v[62:63] op_sel_hi:[1,0]
v_pk_mul_f32 v[216:217],v[216:217],v[62:63] op_sel_hi:[1,0]
v_pk_mul_f32 v[232:233],v[232:233],v[62:63] op_sel_hi:[1,0]
v_pk_mul_f32 v[218:219],v[218:219],v[62:63] op_sel_hi:[1,0]
v_pk_mul_f32 v[234:235],v[234:235],v[62:63] op_sel_hi:[1,0]
v_pk_mul_f32 v[220:221],v[220:221],v[62:63] op_sel_hi:[1,0]
v_pk_mul_f32 v[236:237],v[236:237],v[62:63] op_sel_hi:[1,0]
v_pk_mul_f32 v[222:223],v[222:223],v[62:63] op_sel_hi:[1,0]
v_pk_mul_f32 v[238:239],v[238:239],v[62:63] op_sel_hi:[1,0]
v_pk_mul_f32 v[240:241],v[240:241],v[62:63] op_sel_hi:[1,0]
v_pk_mul_f32 v[80:81],v[80:81],v[64:65] op_sel_hi:[1,0]
v_pk_mul_f32 v[242:243],v[242:243],v[62:63] op_sel_hi:[1,0]
v_pk_mul_f32 v[244:245],v[244:245],v[62:63] op_sel_hi:[1,0]
v_pk_mul_f32 v[104:105],v[104:105],v[64:65] op_sel_hi:[1,0]
v_pk_mul_f32 v[82:83],v[82:83],v[64:65] op_sel_hi:[1,0]
v_pk_mul_f32 v[246:247],v[246:247],v[62:63] op_sel_hi:[1,0]
v_pk_mul_f32 v[248:249],v[248:249],v[62:63] op_sel_hi:[1,0]
v_pk_mul_f32 v[250:251],v[250:251],v[62:63] op_sel_hi:[1,0]
v_pk_mul_f32 v[252:253],v[252:253],v[62:63] op_sel_hi:[1,0]
v_pk_mul_f32 v[254:255],v[254:255],v[62:63] op_sel_hi:[1,0]
v_pk_mul_f32 v[160:161],v[160:161],v[60:61] op_sel_hi:[1,0]
v_pk_mul_f32 v[176:177],v[176:177],v[60:61] op_sel_hi:[1,0]
v_pk_mul_f32 v[162:163],v[162:163],v[60:61] op_sel_hi:[1,0]
v_pk_mul_f32 v[178:179],v[178:179],v[60:61] op_sel_hi:[1,0]
v_pk_mul_f32 v[164:165],v[164:165],v[60:61] op_sel_hi:[1,0]
v_pk_mul_f32 v[180:181],v[180:181],v[60:61] op_sel_hi:[1,0]
v_pk_mul_f32 v[166:167],v[166:167],v[60:61] op_sel_hi:[1,0]
v_pk_mul_f32 v[182:183],v[182:183],v[60:61] op_sel_hi:[1,0]
v_pk_mul_f32 v[168:169],v[168:169],v[60:61] op_sel_hi:[1,0]
v_pk_mul_f32 v[184:185],v[184:185],v[60:61] op_sel_hi:[1,0]
v_pk_mul_f32 v[170:171],v[170:171],v[60:61] op_sel_hi:[1,0]
v_pk_mul_f32 v[186:187],v[186:187],v[60:61] op_sel_hi:[1,0]
v_pk_mul_f32 v[172:173],v[172:173],v[60:61] op_sel_hi:[1,0]
v_pk_mul_f32 v[188:189],v[188:189],v[60:61] op_sel_hi:[1,0]
v_pk_mul_f32 v[174:175],v[174:175],v[60:61] op_sel_hi:[1,0]
v_pk_mul_f32 v[190:191],v[190:191],v[60:61] op_sel_hi:[1,0]
v_pk_mul_f32 v[192:193],v[192:193],v[60:61] op_sel_hi:[1,0]
v_pk_mul_f32 v[194:195],v[194:195],v[60:61] op_sel_hi:[1,0]
v_pk_mul_f32 v[196:197],v[196:197],v[60:61] op_sel_hi:[1,0]
v_pk_mul_f32 v[198:199],v[198:199],v[60:61] op_sel_hi:[1,0]
v_pk_mul_f32 v[200:201],v[200:201],v[60:61] op_sel_hi:[1,0]
v_pk_mul_f32 v[202:203],v[202:203],v[60:61] op_sel_hi:[1,0]
v_pk_mul_f32 v[204:205],v[204:205],v[60:61] op_sel_hi:[1,0]
v_pk_mul_f32 v[206:207],v[206:207],v[60:61] op_sel_hi:[1,0]
v_accvgpr_read_b32 v88,a92
v_accvgpr_read_b32 v89,a93
v_pk_mul_f32 v[88:89],v[88:89],v[66:67] op_sel_hi:[1,0]
v_accvgpr_read_b32 v90,a94
v_accvgpr_read_b32 v91,a95
v_pk_mul_f32 v[90:91],v[90:91],v[66:67] op_sel_hi:[1,0]
v_cvt_pk_bf16_f32 v88,v88,v89
v_cvt_pk_bf16_f32 v89,v90,v91
ds_write_b64 v39,v[88:89] offset:18432
ds_read_b128 v[92:95],v10 offset:18432
ds_read_b128 v[96:99],v10 offset:19456
v_add_u32 v39,v39,v19
v_cvt_pk_bf16_f32 v208,v208,v209
v_cvt_pk_bf16_f32 v224,v224,v225
v_cvt_pk_bf16_f32 v212,v212,v213
v_cvt_pk_bf16_f32 v228,v228,v229
v_cvt_pk_bf16_f32 v209,v210,v211
v_cvt_pk_bf16_f32 v225,v226,v227
ds_write2st64_b64 v36,v[208:209],v[224:225] offset0:12 offset1:14
v_cvt_pk_bf16_f32 v216,v216,v217
v_cvt_pk_bf16_f32 v232,v232,v233
v_cvt_pk_bf16_f32 v213,v214,v215
v_cvt_pk_bf16_f32 v229,v230,v231
v_cvt_pk_bf16_f32 v220,v220,v221
v_cvt_pk_bf16_f32 v236,v236,v237
v_cvt_pk_bf16_f32 v217,v218,v219
v_cvt_pk_bf16_f32 v233,v234,v235
v_cvt_pk_bf16_f32 v221,v222,v223
v_cvt_pk_bf16_f32 v237,v238,v239
v_accvgpr_read_b32 v106,a6
ds_write2st64_b64 v37,v[212:213],v[228:229] offset0:12 offset1:14
v_accvgpr_read_b32 v107,a7
v_pk_mul_f32 v[106:107],v[106:107],v[64:65] op_sel_hi:[1,0]
v_accvgpr_read_b32 v108,a8
s_waitcnt lgkmcnt(2)
buffer_store_dwordx4 v[92:95],v9,s[16:19],s87 offen offset:256 nt
v_accvgpr_read_b32 v109,a9
v_pk_mul_f32 v[108:109],v[108:109],v[64:65] op_sel_hi:[1,0]
v_cvt_pk_bf16_f32 v240,v240,v241
v_cvt_pk_bf16_f32 v80,v80,v81
v_accvgpr_read_b32 v110,a10
v_accvgpr_read_b32 v111,a11
v_pk_mul_f32 v[110:111],v[110:111],v[64:65] op_sel_hi:[1,0]
v_accvgpr_read_b32 v84,a12
v_accvgpr_read_b32 v85,a13
ds_write2st64_b64 v38,v[216:217],v[232:233] offset0:12 offset1:14
v_pk_mul_f32 v[84:85],v[84:85],v[64:65] op_sel_hi:[1,0]
v_cvt_pk_bf16_f32 v244,v244,v245
v_cvt_pk_bf16_f32 v104,v104,v105
buffer_store_dwordx4 v[96:99],v9,s[16:19],s87 offen offset:3328 nt
v_cvt_pk_bf16_f32 v241,v242,v243
v_cvt_pk_bf16_f32 v81,v82,v83
v_accvgpr_read_b32 v86,a14
v_accvgpr_read_b32 v87,a15
v_pk_mul_f32 v[86:87],v[86:87],v[64:65] op_sel_hi:[1,0]
v_cvt_pk_bf16_f32 v248,v248,v249
v_cvt_pk_bf16_f32 v108,v108,v109
v_cvt_pk_bf16_f32 v245,v246,v247
v_cvt_pk_bf16_f32 v105,v106,v107
ds_write2st64_b64 v39,v[220:221],v[236:237] offset0:12 offset1:14
v_cvt_pk_bf16_f32 v252,v252,v253
v_cvt_pk_bf16_f32 v84,v84,v85
v_cvt_pk_bf16_f32 v249,v250,v251
ds_read_b128 v[100:103],v10 offset:6144
ds_read_b128 v[76:79],v10 offset:9216
v_cvt_pk_bf16_f32 v109,v110,v111
ds_read_b128 v[156:159],v10 offset:7168
v_cvt_pk_bf16_f32 v253,v254,v255
ds_read_b128 v[72:75],v10 offset:10240
v_cvt_pk_bf16_f32 v85,v86,v87
ds_write2st64_b64 v36,v[240:241],v[80:81] offset0:16 offset1:24
v_accvgpr_read_b32 v212,a32
v_accvgpr_read_b32 v213,a33
v_pk_mul_f32 v[212:213],v[212:213],v[64:65] op_sel_hi:[1,0]
v_accvgpr_read_b32 v96,a16
v_accvgpr_read_b32 v97,a17
v_pk_mul_f32 v[96:97],v[96:97],v[64:65] op_sel_hi:[1,0]
v_accvgpr_read_b32 v214,a34
v_accvgpr_read_b32 v215,a35
v_pk_mul_f32 v[214:215],v[214:215],v[64:65] op_sel_hi:[1,0]
v_accvgpr_read_b32 v228,a20
v_accvgpr_read_b32 v229,a21
ds_write2st64_b64 v37,v[244:245],v[104:105] offset0:16 offset1:24
v_pk_mul_f32 v[228:229],v[228:229],v[64:65] op_sel_hi:[1,0]
v_accvgpr_read_b32 v216,a36
v_accvgpr_read_b32 v217,a37
s_waitcnt lgkmcnt(3)
buffer_store_dwordx4 v[100:103],v9,s[16:19],s85 offen offset:0 nt
v_pk_mul_f32 v[216:217],v[216:217],v[64:65] op_sel_hi:[1,0]
v_accvgpr_read_b32 v98,a18
v_accvgpr_read_b32 v99,a19
v_pk_mul_f32 v[98:99],v[98:99],v[64:65] op_sel_hi:[1,0]
v_accvgpr_read_b32 v230,a22
v_accvgpr_read_b32 v231,a23
v_pk_mul_f32 v[230:231],v[230:231],v[64:65] op_sel_hi:[1,0]
v_accvgpr_read_b32 v218,a38
v_accvgpr_read_b32 v219,a39
ds_write2st64_b64 v38,v[248:249],v[108:109] offset0:16 offset1:24
v_pk_mul_f32 v[218:219],v[218:219],v[64:65] op_sel_hi:[1,0]
v_accvgpr_read_b32 v232,a24
v_accvgpr_read_b32 v233,a25
buffer_store_dwordx4 v[76:79],v9,s[16:19],s85 offen offset:3072 nt
v_pk_mul_f32 v[232:233],v[232:233],v[64:65] op_sel_hi:[1,0]
v_accvgpr_read_b32 v220,a40
v_accvgpr_read_b32 v221,a41
v_pk_mul_f32 v[220:221],v[220:221],v[64:65] op_sel_hi:[1,0]
v_cvt_pk_bf16_f32 v212,v212,v213
v_cvt_pk_bf16_f32 v96,v96,v97
v_accvgpr_read_b32 v234,a26
v_accvgpr_read_b32 v235,a27
v_pk_mul_f32 v[234:235],v[234:235],v[64:65] op_sel_hi:[1,0]
ds_write2st64_b64 v39,v[252:253],v[84:85] offset0:16 offset1:24
v_accvgpr_read_b32 v222,a42
v_accvgpr_read_b32 v223,a43
v_pk_mul_f32 v[222:223],v[222:223],v[64:65] op_sel_hi:[1,0]
ds_read_b128 v[88:91],v10 offset:8192
ds_read_b128 v[208:211],v10 offset:11264
buffer_store_dwordx4 v[156:159],v9,s[16:19],s85 offen offset:128 nt
ds_read_b128 v[224:227],v10 offset:12288
v_accvgpr_read_b32 v236,a28
ds_read_b128 v[92:95],v10 offset:15360
v_accvgpr_read_b32 v237,a29
v_pk_mul_f32 v[236:237],v[236:237],v[64:65] op_sel_hi:[1,0]
v_accvgpr_read_b32 v80,a44
v_accvgpr_read_b32 v81,a45
v_pk_mul_f32 v[80:81],v[80:81],v[64:65] op_sel_hi:[1,0]
s_waitcnt lgkmcnt(5)
buffer_store_dwordx4 v[72:75],v9,s[16:19],s85 offen offset:3200 nt
v_cvt_pk_bf16_f32 v228,v228,v229
v_cvt_pk_bf16_f32 v216,v216,v217
v_cvt_pk_bf16_f32 v213,v214,v215
v_cvt_pk_bf16_f32 v97,v98,v99
v_accvgpr_read_b32 v238,a30
v_accvgpr_read_b32 v239,a31
v_pk_mul_f32 v[238:239],v[238:239],v[64:65] op_sel_hi:[1,0]
v_accvgpr_read_b32 v82,a46
v_accvgpr_read_b32 v83,a47
ds_write2st64_b64 v36,v[96:97],v[212:213] offset0:26 offset1:28
v_pk_mul_f32 v[82:83],v[82:83],v[64:65] op_sel_hi:[1,0]
v_cvt_pk_bf16_f32 v232,v232,v233
v_cvt_pk_bf16_f32 v220,v220,v221
s_waitcnt lgkmcnt(2)
buffer_store_dwordx4 v[88:91],v9,s[16:19],s85 offen offset:256 nt
v_cvt_pk_bf16_f32 v229,v230,v231
v_cvt_pk_bf16_f32 v217,v218,v219
v_cvt_pk_bf16_f32 v236,v236,v237
v_cvt_pk_bf16_f32 v80,v80,v81
v_cvt_pk_bf16_f32 v233,v234,v235
v_cvt_pk_bf16_f32 v221,v222,v223
v_cvt_pk_bf16_f32 v237,v238,v239
v_cvt_pk_bf16_f32 v81,v82,v83
v_cvt_pk_bf16_f32 v160,v160,v161
ds_write2st64_b64 v37,v[228:229],v[216:217] offset0:26 offset1:28
v_cvt_pk_bf16_f32 v176,v176,v177
v_cvt_pk_bf16_f32 v164,v164,v165
v_cvt_pk_bf16_f32 v180,v180,v181
buffer_store_dwordx4 v[208:211],v9,s[16:19],s85 offen offset:3328 nt
v_cvt_pk_bf16_f32 v161,v162,v163
v_cvt_pk_bf16_f32 v177,v178,v179
v_cvt_pk_bf16_f32 v168,v168,v169
v_cvt_pk_bf16_f32 v184,v184,v185
v_cvt_pk_bf16_f32 v165,v166,v167
v_cvt_pk_bf16_f32 v181,v182,v183
v_cvt_pk_bf16_f32 v172,v172,v173
v_cvt_pk_bf16_f32 v188,v188,v189
v_cvt_pk_bf16_f32 v169,v170,v171
ds_write2st64_b64 v38,v[232:233],v[220:221] offset0:26 offset1:28
v_cvt_pk_bf16_f32 v185,v186,v187
v_cvt_pk_bf16_f32 v173,v174,v175
v_cvt_pk_bf16_f32 v189,v190,v191
buffer_store_dwordx4 v[224:227],v9,s[16:19],s86 offen offset:0 nt
v_cvt_pk_bf16_f32 v192,v192,v193
v_cvt_pk_bf16_f32 v196,v196,v197
v_cvt_pk_bf16_f32 v193,v194,v195
v_cvt_pk_bf16_f32 v200,v200,v201
v_cvt_pk_bf16_f32 v197,v198,v199
v_cvt_pk_bf16_f32 v204,v204,v205
v_cvt_pk_bf16_f32 v201,v202,v203
v_cvt_pk_bf16_f32 v205,v206,v207
ds_write2st64_b64 v39,v[236:237],v[80:81] offset0:26 offset1:28
ds_read_b128 v[240:243],v10 offset:13312
ds_read_b128 v[156:159],v10 offset:16384
s_waitcnt lgkmcnt(3)
buffer_store_dwordx4 v[92:95],v9,s[16:19],s86 offen offset:3072 nt
ds_read_b128 v[72:75],v10 offset:14336
ds_read_b128 v[76:79],v10 offset:17408
ds_write2st64_b64 v36,v[160:161],v[176:177] offset0:0 offset1:2
ds_write2st64_b64 v37,v[164:165],v[180:181] offset0:0 offset1:2
s_waitcnt lgkmcnt(2)
buffer_store_dwordx4 v[240:243],v9,s[16:19],s86 offen offset:128 nt
ds_write2st64_b64 v38,v[168:169],v[184:185] offset0:0 offset1:2
buffer_store_dwordx4 v[156:159],v9,s[16:19],s86 offen offset:3200 nt
ds_write2st64_b64 v39,v[172:173],v[188:189] offset0:0 offset1:2
ds_read_b128 v[100:103],v10 offset:0
ds_read_b128 v[104:107],v10 offset:3072
buffer_store_dwordx4 v[72:75],v9,s[16:19],s86 offen offset:256 nt
ds_read_b128 v[244:247],v10 offset:1024
ds_read_b128 v[108:111],v10 offset:4096
ds_write_b64 v36,v[192:193] offset:2048
buffer_store_dwordx4 v[76:79],v9,s[16:19],s86 offen offset:3328 nt
ds_write_b64 v37,v[196:197] offset:2048
s_waitcnt lgkmcnt(4)
buffer_store_dwordx4 v[100:103],v9,s[16:19],s84 offen offset:0 nt
ds_write_b64 v38,v[200:201] offset:2048
buffer_store_dwordx4 v[104:107],v9,s[16:19],s84 offen offset:3072 nt
ds_write_b64 v39,v[204:205] offset:2048
ds_read_b128 v[248:251],v10 offset:2048
ds_read_b128 v[84:87],v10 offset:5120
s_waitcnt lgkmcnt(4)
buffer_store_dwordx4 v[244:247],v9,s[16:19],s84 offen offset:128 nt
buffer_store_dwordx4 v[108:111],v9,s[16:19],s84 offen offset:3200 nt
s_waitcnt lgkmcnt(1)
buffer_store_dwordx4 v[248:251],v9,s[16:19],s84 offen offset:256 nt
s_waitcnt lgkmcnt(0)
buffer_store_dwordx4 v[84:87],v9,s[16:19],s84 offen offset:3328 nt
s_branch L_fin
L_fin:
s_waitcnt vmcnt(0)
L_stamped:
s_cmp_lg_u32 s31,0
s_cbranch_scc1 L_fix
L_done:
L_end:
s_endpgm
L_fix:
s_sub_u32 s62,s24,36864
v_add_u32 v112,s62,v2
v_add_u32 v113,s62,v3
v_add_u32 v114,s62,v4
v_add_u32 v115,s62,v5
v_mbcnt_lo_u32_b32 v19,-1,0
v_mbcnt_hi_u32_b32 v19,-1,v19
v_and_b32 v157,15,v19
v_mul_u32_u24 v157,384,v157
v_lshrrev_b32 v158,4,v19
v_lshl_add_u32 v159,v158,3,v157
v_lshl_add_u32 v157,v158,4,v157
L_fix_pass:
s_ff1_i32_b32 s50,s31
s_bitset0_b32 s31,s50
s_lshl_b32 s62,s50,5
s_add_u32 s62,s62,s34
s_mul_i32 s63,s62,171
s_lshr_b32 s63,s63,9
s_mul_i32 s64,s63,3
s_sub_u32 s62,s62,s64
s_add_u32 s63,s63,s33
s_mul_i32 s30,s63,196608
s_mul_i32 s41,s63,325632
s_lshl_b32 s63,s3,2
s_add_u32 s64,s63,21
s_cmp_eq_u32 s3,0
s_cselect_b32 s64,20,s64
s_cselect_b32 s40,1,0
s_add_u32 s65,s63,37
s_cmp_eq_u32 s62,2
s_cselect_b32 s64,s65,s64
s_cselect_b32 s40,0,s40
s_add_u32 s65,s63,s3
s_cmp_eq_u32 s62,0
s_cselect_b32 s64,s65,s64
s_cselect_b32 s40,1,s40
s_mul_i32 s64,s64,6144
s_add_u32 s41,s41,s64
s_add_u32 s55,s40,4
s_mov_b32 s51,0
L_fix_tile:
buffer_load_dwordx4 a[144:147],v157,s[12:15],s41 offen offset:0
buffer_load_dwordx4 a[148:151],v157,s[12:15],s41 offen offset:64
buffer_load_dwordx4 a[152:155],v157,s[12:15],s41 offen offset:128
buffer_load_dwordx4 a[156:159],v157,s[12:15],s41 offen offset:192
buffer_load_dwordx4 a[160:163],v157,s[12:15],s41 offen offset:256
buffer_load_dwordx4 a[164:167],v157,s[12:15],s41 offen offset:320
v_mov_b32 v156,0xff800000
s_mov_b32 s53,s30
s_mov_b32 s52,0
L_fix_max:
s_mov_b32 s63,s53
s_add_u32 m0,s24,0
s_nop 0
buffer_load_dwordx4 v6,s[4:7],s63 offen offset:0 lds
buffer_load_dwordx4 v7,s[4:7],s63 offen offset:1024 lds
buffer_load_dwordx4 v8,s[4:7],s63 offen offset:2048 lds
s_add_u32 s63,s63,3072
s_add_u32 m0,s24,3072
s_nop 0
buffer_load_dwordx4 v6,s[4:7],s63 offen offset:0 lds
buffer_load_dwordx4 v7,s[4:7],s63 offen offset:1024 lds
buffer_load_dwordx4 v8,s[4:7],s63 offen offset:2048 lds
s_add_u32 s63,s63,3072
s_add_u32 m0,s24,6144
s_nop 0
buffer_load_dwordx4 v6,s[4:7],s63 offen offset:0 lds
buffer_load_dwordx4 v7,s[4:7],s63 offen offset:1024 lds
buffer_load_dwordx4 v8,s[4:7],s63 offen offset:2048 lds
s_add_u32 s63,s63,3072
s_add_u32 m0,s24,9216
s_nop 0
buffer_load_dwordx4 v6,s[4:7],s63 offen offset:0 lds
buffer_load_dwordx4 v7,s[4:7],s63 offen offset:1024 lds
buffer_load_dwordx4 v8,s[4:7],s63 offen offset:2048 lds
s_add_u32 s63,s63,3072
s_waitcnt vmcnt(0)
ds_read_b128 a[0:3],v11 offset:0
ds_read_b128 a[4:7],v12 offset:0
ds_read_b128 a[8:11],v11 offset:128
ds_read_b128 a[12:15],v12 offset:128
ds_read_b128 a[16:19],v11 offset:256
ds_read_b128 a[20:23],v12 offset:256
ds_read_b128 a[24:27],v11 offset:6144
ds_read_b128 a[28:31],v12 offset:6144
ds_read_b128 a[32:35],v11 offset:6272
ds_read_b128 a[36:39],v12 offset:6272
ds_read_b128 a[40:43],v11 offset:6400
ds_read_b128 a[44:47],v12 offset:6400
s_waitcnt lgkmcnt(0)
v_mfma_f32_16x16x32_bf16 v[72:75],a[0:3],a[144:147],0
v_mfma_f32_16x16x32_bf16 v[72:75],a[4:7],a[148:151],v[72:75]
v_mfma_f32_16x16x32_bf16 v[72:75],a[8:11],a[152:155],v[72:75]
v_mfma_f32_16x16x32_bf16 v[72:75],a[12:15],a[156:159],v[72:75]
v_mfma_f32_16x16x32_bf16 v[72:75],a[16:19],a[160:163],v[72:75]
v_mfma_f32_16x16x32_bf16 v[72:75],a[20:23],a[164:167],v[72:75]
v_mfma_f32_16x16x32_bf16 v[76:79],a[24:27],a[144:147],0
v_mfma_f32_16x16x32_bf16 v[76:79],a[28:31],a[148:151],v[76:79]
v_mfma_f32_16x16x32_bf16 v[76:79],a[32:35],a[152:155],v[76:79]
v_mfma_f32_16x16x32_bf16 v[76:79],a[36:39],a[156:159],v[76:79]
v_mfma_f32_16x16x32_bf16 v[76:79],a[40:43],a[160:163],v[76:79]
v_mfma_f32_16x16x32_bf16 v[76:79],a[44:47],a[164:167],v[76:79]
s_nop 7
v_max3_f32 v156,v156,v72,v73
v_max3_f32 v156,v156,v74,v75
v_max3_f32 v156,v156,v76,v77
v_max3_f32 v156,v156,v78,v79
s_add_u32 s53,s53,12288
s_add_u32 s52,s52,1
s_cmp_lt_u32 s52,16
s_cbranch_scc1 L_fix_max
v_mov_b32 v19,v156
s_nop 1
v_permlane32_swap_b32 v19,v156
v_max_f32 v156,v156,v19
v_mov_b32 v19,v156
s_nop 1
v_permlane16_swap_b32 v19,v156
v_max_f32 v156,v156,v19
v_mul_f32_e64 v13,-s36,v156
v_mov_b32 v160,0
v_mov_b32 v161,0
v_mov_b32 v162,0
v_mov_b32 v163,0
v_mov_b32 v164,0
v_mov_b32 v165,0
v_mov_b32 v166,0
v_mov_b32 v167,0
v_mov_b32 v168,0
v_mov_b32 v169,0
v_mov_b32 v170,0
v_mov_b32 v171,0
v_mov_b32 v172,0
v_mov_b32 v173,0
v_mov_b32 v174,0
v_mov_b32 v175,0
v_mov_b32 v176,0
v_mov_b32 v177,0
v_mov_b32 v178,0
v_mov_b32 v179,0
v_mov_b32 v180,0
v_mov_b32 v181,0
v_mov_b32 v182,0
v_mov_b32 v183,0
v_mov_b32 v184,0
v_mov_b32 v185,0
v_mov_b32 v186,0
v_mov_b32 v187,0
v_mov_b32 v188,0
v_mov_b32 v189,0
v_mov_b32 v190,0
v_mov_b32 v191,0
v_mov_b32 v192,0
v_mov_b32 v193,0
v_mov_b32 v194,0
v_mov_b32 v195,0
v_mov_b32 v196,0
v_mov_b32 v197,0
v_mov_b32 v198,0
v_mov_b32 v199,0
v_mov_b32 v200,0
v_mov_b32 v201,0
v_mov_b32 v202,0
v_mov_b32 v203,0
v_mov_b32 v204,0
v_mov_b32 v205,0
v_mov_b32 v206,0
v_mov_b32 v207,0
v_mov_b32 v60,0
v_mov_b32 v24,0
v_mov_b32 v61,0
v_mov_b32 v25,0
v_mov_b32 v62,0
v_mov_b32 v26,0
v_mov_b32 v63,0
v_mov_b32 v27,0
s_mov_b32 s53,s30
s_mov_b32 s52,0
L_fix_acc:
s_mov_b32 s63,s53
s_add_u32 m0,s24,0
s_nop 0
buffer_load_dwordx4 v6,s[4:7],s63 offen offset:0 lds
buffer_load_dwordx4 v7,s[4:7],s63 offen offset:1024 lds
buffer_load_dwordx4 v8,s[4:7],s63 offen offset:2048 lds
s_add_u32 s63,s63,3072
s_add_u32 m0,s24,3072
s_nop 0
buffer_load_dwordx4 v6,s[4:7],s63 offen offset:0 lds
buffer_load_dwordx4 v7,s[4:7],s63 offen offset:1024 lds
buffer_load_dwordx4 v8,s[4:7],s63 offen offset:2048 lds
s_add_u32 s63,s63,3072
s_add_u32 m0,s24,6144
s_nop 0
buffer_load_dwordx4 v6,s[4:7],s63 offen offset:0 lds
buffer_load_dwordx4 v7,s[4:7],s63 offen offset:1024 lds
buffer_load_dwordx4 v8,s[4:7],s63 offen offset:2048 lds
s_add_u32 s63,s63,3072
s_add_u32 m0,s24,9216
s_nop 0
buffer_load_dwordx4 v6,s[4:7],s63 offen offset:0 lds
buffer_load_dwordx4 v7,s[4:7],s63 offen offset:1024 lds
buffer_load_dwordx4 v8,s[4:7],s63 offen offset:2048 lds
s_add_u32 s63,s63,3072
s_waitcnt vmcnt(0)
ds_read_b128 a[0:3],v11 offset:0
ds_read_b128 a[4:7],v12 offset:0
ds_read_b128 a[8:11],v11 offset:128
ds_read_b128 a[12:15],v12 offset:128
ds_read_b128 a[16:19],v11 offset:256
ds_read_b128 a[20:23],v12 offset:256
ds_read_b128 a[24:27],v11 offset:6144
ds_read_b128 a[28:31],v12 offset:6144
ds_read_b128 a[32:35],v11 offset:6272
ds_read_b128 a[36:39],v12 offset:6272
ds_read_b128 a[40:43],v11 offset:6400
ds_read_b128 a[44:47],v12 offset:6400
s_waitcnt lgkmcnt(0)
v_mfma_f32_16x16x32_bf16 v[72:75],a[0:3],a[144:147],0
v_mfma_f32_16x16x32_bf16 v[72:75],a[4:7],a[148:151],v[72:75]
v_mfma_f32_16x16x32_bf16 v[72:75],a[8:11],a[152:155],v[72:75]
v_mfma_f32_16x16x32_bf16 v[72:75],a[12:15],a[156:159],v[72:75]
v_mfma_f32_16x16x32_bf16 v[72:75],a[16:19],a[160:163],v[72:75]
v_mfma_f32_16x16x32_bf16 v[72:75],a[20:23],a[164:167],v[72:75]
v_mfma_f32_16x16x32_bf16 v[76:79],a[24:27],a[144:147],0
v_mfma_f32_16x16x32_bf16 v[76:79],a[28:31],a[148:151],v[76:79]
v_mfma_f32_16x16x32_bf16 v[76:79],a[32:35],a[152:155],v[76:79]
v_mfma_f32_16x16x32_bf16 v[76:79],a[36:39],a[156:159],v[76:79]
v_mfma_f32_16x16x32_bf16 v[76:79],a[40:43],a[160:163],v[76:79]
v_mfma_f32_16x16x32_bf16 v[76:79],a[44:47],a[164:167],v[76:79]
s_nop 7
v_fma_f32 v72,v72,s36,v13
v_fma_f32 v73,v73,s36,v13
v_exp_f32 v72,v72
v_exp_f32 v73,v73
s_nop 0
v_cvt_pk_bf16_f32 v20,v72,v73
v_fma_f32 v74,v74,s36,v13
v_fma_f32 v75,v75,s36,v13
v_exp_f32 v74,v74
v_exp_f32 v75,v75
s_nop 0
v_cvt_pk_bf16_f32 v21,v74,v75
v_fma_f32 v76,v76,s36,v13
v_fma_f32 v77,v77,s36,v13
v_exp_f32 v76,v76
v_exp_f32 v77,v77
s_nop 0
v_cvt_pk_bf16_f32 v22,v76,v77
v_fma_f32 v78,v78,s36,v13
v_fma_f32 v79,v79,s36,v13
v_exp_f32 v78,v78
v_exp_f32 v79,v79
s_nop 0
v_cvt_pk_bf16_f32 v23,v78,v79
s_nop 1
v_smfmac_f32_16x16x64_bf16 v[60:63],v[152:155],v[20:27],v18
s_mov_b32 s63,s53
s_add_u32 m0,s24,0
s_nop 0
buffer_load_dwordx4 v6,s[8:11],s63 offen offset:0 lds
buffer_load_dwordx4 v7,s[8:11],s63 offen offset:1024 lds
buffer_load_dwordx4 v8,s[8:11],s63 offen offset:2048 lds
s_add_u32 s63,s63,3072
s_add_u32 m0,s24,3072
s_nop 0
buffer_load_dwordx4 v6,s[8:11],s63 offen offset:0 lds
buffer_load_dwordx4 v7,s[8:11],s63 offen offset:1024 lds
buffer_load_dwordx4 v8,s[8:11],s63 offen offset:2048 lds
s_add_u32 s63,s63,3072
s_add_u32 m0,s24,6144
s_nop 0
buffer_load_dwordx4 v6,s[8:11],s63 offen offset:0 lds
buffer_load_dwordx4 v7,s[8:11],s63 offen offset:1024 lds
buffer_load_dwordx4 v8,s[8:11],s63 offen offset:2048 lds
s_add_u32 s63,s63,3072
s_add_u32 m0,s24,9216
s_nop 0
buffer_load_dwordx4 v6,s[8:11],s63 offen offset:0 lds
buffer_load_dwordx4 v7,s[8:11],s63 offen offset:1024 lds
buffer_load_dwordx4 v8,s[8:11],s63 offen offset:2048 lds
s_add_u32 s63,s63,3072
s_waitcnt vmcnt(0)
ds_read_b64_tr_b16 a[0:1],v112 offset:0
ds_read_b64_tr_b16 a[2:3],v112 offset:6144
ds_read_b64_tr_b16 a[4:5],v113 offset:0
ds_read_b64_tr_b16 a[6:7],v113 offset:6144
ds_read_b64_tr_b16 a[8:9],v114 offset:0
ds_read_b64_tr_b16 a[10:11],v114 offset:6144
ds_read_b64_tr_b16 a[12:13],v115 offset:0
ds_read_b64_tr_b16 a[14:15],v115 offset:6144
ds_read_b64_tr_b16 a[16:17],v112 offset:128
ds_read_b64_tr_b16 a[18:19],v112 offset:6272
ds_read_b64_tr_b16 a[20:21],v113 offset:128
ds_read_b64_tr_b16 a[22:23],v113 offset:6272
ds_read_b64_tr_b16 a[24:25],v114 offset:128
ds_read_b64_tr_b16 a[26:27],v114 offset:6272
ds_read_b64_tr_b16 a[28:29],v115 offset:128
ds_read_b64_tr_b16 a[30:31],v115 offset:6272
ds_read_b64_tr_b16 a[32:33],v112 offset:256
ds_read_b64_tr_b16 a[34:35],v112 offset:6400
ds_read_b64_tr_b16 a[36:37],v113 offset:256
ds_read_b64_tr_b16 a[38:39],v113 offset:6400
ds_read_b64_tr_b16 a[40:41],v114 offset:256
ds_read_b64_tr_b16 a[42:43],v114 offset:6400
ds_read_b64_tr_b16 a[44:45],v115 offset:256
ds_read_b64_tr_b16 a[46:47],v115 offset:6400
s_waitcnt lgkmcnt(0)
v_mfma_f32_16x16x32_bf16 v[160:163],a[0:3],v[20:23],v[160:163]
v_mfma_f32_16x16x32_bf16 v[164:167],a[4:7],v[20:23],v[164:167]
v_mfma_f32_16x16x32_bf16 v[168:171],a[8:11],v[20:23],v[168:171]
v_mfma_f32_16x16x32_bf16 v[172:175],a[12:15],v[20:23],v[172:175]
v_mfma_f32_16x16x32_bf16 v[176:179],a[16:19],v[20:23],v[176:179]
v_mfma_f32_16x16x32_bf16 v[180:183],a[20:23],v[20:23],v[180:183]
v_mfma_f32_16x16x32_bf16 v[184:187],a[24:27],v[20:23],v[184:187]
v_mfma_f32_16x16x32_bf16 v[188:191],a[28:31],v[20:23],v[188:191]
v_mfma_f32_16x16x32_bf16 v[192:195],a[32:35],v[20:23],v[192:195]
v_mfma_f32_16x16x32_bf16 v[196:199],a[36:39],v[20:23],v[196:199]
v_mfma_f32_16x16x32_bf16 v[200:203],a[40:43],v[20:23],v[200:203]
v_mfma_f32_16x16x32_bf16 v[204:207],a[44:47],v[20:23],v[204:207]
s_add_u32 s53,s53,12288
s_add_u32 s52,s52,1
s_cmp_lt_u32 s52,16
s_cbranch_scc1 L_fix_acc
s_nop 7
v_add_f32 v19,v60,v61
v_rcp_f32 v19,v19
s_nop 0
v_mul_f32 v160,v160,v19
v_mul_f32 v161,v161,v19
v_mul_f32 v162,v162,v19
v_mul_f32 v163,v163,v19
v_cvt_pk_bf16_f32 v160,v160,v161
v_cvt_pk_bf16_f32 v161,v162,v163
buffer_store_dwordx2 v[160:161],v159,s[16:19],s41 offen offset:0
v_mul_f32 v164,v164,v19
v_mul_f32 v165,v165,v19
v_mul_f32 v166,v166,v19
v_mul_f32 v167,v167,v19
v_cvt_pk_bf16_f32 v164,v164,v165
v_cvt_pk_bf16_f32 v165,v166,v167
buffer_store_dwordx2 v[164:165],v159,s[16:19],s41 offen offset:32
v_mul_f32 v168,v168,v19
v_mul_f32 v169,v169,v19
v_mul_f32 v170,v170,v19
v_mul_f32 v171,v171,v19
v_cvt_pk_bf16_f32 v168,v168,v169
v_cvt_pk_bf16_f32 v169,v170,v171
buffer_store_dwordx2 v[168:169],v159,s[16:19],s41 offen offset:64
v_mul_f32 v172,v172,v19
v_mul_f32 v173,v173,v19
v_mul_f32 v174,v174,v19
v_mul_f32 v175,v175,v19
v_cvt_pk_bf16_f32 v172,v172,v173
v_cvt_pk_bf16_f32 v173,v174,v175
buffer_store_dwordx2 v[172:173],v159,s[16:19],s41 offen offset:96
v_mul_f32 v176,v176,v19
v_mul_f32 v177,v177,v19
v_mul_f32 v178,v178,v19
v_mul_f32 v179,v179,v19
v_cvt_pk_bf16_f32 v176,v176,v177
v_cvt_pk_bf16_f32 v177,v178,v179
buffer_store_dwordx2 v[176:177],v159,s[16:19],s41 offen offset:128
v_mul_f32 v180,v180,v19
v_mul_f32 v181,v181,v19
v_mul_f32 v182,v182,v19
v_mul_f32 v183,v183,v19
v_cvt_pk_bf16_f32 v180,v180,v181
v_cvt_pk_bf16_f32 v181,v182,v183
buffer_store_dwordx2 v[180:181],v159,s[16:19],s41 offen offset:160
v_mul_f32 v184,v184,v19
v_mul_f32 v185,v185,v19
v_mul_f32 v186,v186,v19
v_mul_f32 v187,v187,v19
v_cvt_pk_bf16_f32 v184,v184,v185
v_cvt_pk_bf16_f32 v185,v186,v187
buffer_store_dwordx2 v[184:185],v159,s[16:19],s41 offen offset:192
v_mul_f32 v188,v188,v19
v_mul_f32 v189,v189,v19
v_mul_f32 v190,v190,v19
v_mul_f32 v191,v191,v19
v_cvt_pk_bf16_f32 v188,v188,v189
v_cvt_pk_bf16_f32 v189,v190,v191
buffer_store_dwordx2 v[188:189],v159,s[16:19],s41 offen offset:224
v_mul_f32 v192,v192,v19
v_mul_f32 v193,v193,v19
v_mul_f32 v194,v194,v19
v_mul_f32 v195,v195,v19
v_cvt_pk_bf16_f32 v192,v192,v193
v_cvt_pk_bf16_f32 v193,v194,v195
buffer_store_dwordx2 v[192:193],v159,s[16:19],s41 offen offset:256
v_mul_f32 v196,v196,v19
v_mul_f32 v197,v197,v19
v_mul_f32 v198,v198,v19
v_mul_f32 v199,v199,v19
v_cvt_pk_bf16_f32 v196,v196,v197
v_cvt_pk_bf16_f32 v197,v198,v199
buffer_store_dwordx2 v[196:197],v159,s[16:19],s41 offen offset:288
v_mul_f32 v200,v200,v19
v_mul_f32 v201,v201,v19
v_mul_f32 v202,v202,v19
v_mul_f32 v203,v203,v19
v_cvt_pk_bf16_f32 v200,v200,v201
v_cvt_pk_bf16_f32 v201,v202,v203
buffer_store_dwordx2 v[200:201],v159,s[16:19],s41 offen offset:320
v_mul_f32 v204,v204,v19
v_mul_f32 v205,v205,v19
v_mul_f32 v206,v206,v19
v_mul_f32 v207,v207,v19
v_cvt_pk_bf16_f32 v204,v204,v205
v_cvt_pk_bf16_f32 v205,v206,v207
buffer_store_dwordx2 v[204:205],v159,s[16:19],s41 offen offset:352
s_waitcnt vmcnt(0)
s_add_u32 s41,s41,6144
s_add_u32 s51,s51,1
s_cmp_lt_u32 s51,s55
s_cbranch_scc1 L_fix_tile
s_cmp_lg_u32 s31,0
s_cbranch_scc1 L_fix_pass
s_branch L_done
L_codeend:
.section .rodata,"a"
.p2align 6
.amdhsa_kernel standalone__gqa_softmax__near_ridge_kernel
  .amdhsa_next_free_vgpr 512
  .amdhsa_next_free_sgpr 102
  .amdhsa_accum_offset 256
  .amdhsa_group_segment_fixed_size 0
  .amdhsa_kernarg_size 48
  .amdhsa_user_sgpr_count 2
  .amdhsa_user_sgpr_kernarg_segment_ptr 1
  .amdhsa_system_sgpr_workgroup_id_x 1
.end_amdhsa_kernel
```

```asm
; @launch grid=(256,1,1) block=(256,1,1) lds=163840
.amdgcn_target "amdgcn-amd-amdhsa--gfx950"
.text
.globl standalone__gqa_softmax__near_ridge_kernel
.p2align 8
.type standalone__gqa_softmax__near_ridge_kernel,@function
standalone__gqa_softmax__near_ridge_kernel:
s_cmp_ge_u32 s2,256
s_cbranch_scc1 L_end
s_load_dwordx4 s[84:87],s[0:1],0
s_load_dwordx4 s[88:91],s[0:1],16
v_lshrrev_b32 v156,6,v0
v_and_b32 v19,63,v0
v_readfirstlane_b32 s3,v156
s_lshr_b32 s34,s2,3
s_getpc_b64 s[92:93]
L_pc:
s_mul_i32 s62,s34,4096
v_min_u32 v156,31,v19
v_lshlrev_b32 v156,7,v156
v_add_u32 v156,s62,v156
v_min_u32 v156,L_codeend-L_pc-4,v156
s_cmp_lg_u32 s3,0
s_cbranch_scc1 L_nopre
global_load_dword v60,v156,s[92:93]
L_nopre:
v_lshrrev_b32 v156,3,v19
v_and_b32 v158,7,v19
v_add_u32 v157,0,v156
v_mul_u32_u24 v157,43,v157
v_lshrrev_b32 v157,7,v157
v_and_b32 v157,6,v157
v_xor_b32 v157,v157,v158
v_lshlrev_b32 v157,4,v157
v_lshl_add_u32 v6,v156,7,v157
v_add_u32 v157,8,v156
v_mul_u32_u24 v157,43,v157
v_lshrrev_b32 v157,7,v157
v_and_b32 v157,6,v157
v_xor_b32 v157,v157,v158
v_lshlrev_b32 v157,4,v157
v_lshl_add_u32 v7,v156,7,v157
v_add_u32 v157,16,v156
v_mul_u32_u24 v157,43,v157
v_lshrrev_b32 v157,7,v157
v_and_b32 v157,6,v157
v_xor_b32 v157,v157,v158
v_lshlrev_b32 v157,4,v157
v_lshl_add_u32 v8,v156,7,v157
s_mov_b32 s37,0x5d800000
s_mov_b32 s36,0x3dd53b95
s_mov_b32 s31,0
s_mov_b32 s32,1
s_and_b32 s62,s2,7
s_lshl_b32 s33,s62,6
s_mul_i32 s22,s3,3072
s_add_u32 s23,s22,36864
s_mul_i32 s24,s3,22528
s_add_u32 s24,s24,73728
s_mov_b32 s69,0
s_lshl_b32 s62,s69,5
s_add_u32 s62,s62,s34
s_mul_i32 s63,s62,171
s_lshr_b32 s63,s63,9
s_mul_i32 s64,s63,3
s_sub_u32 s62,s62,s64
s_add_u32 s63,s63,s33
s_mul_i32 s30,s63,196608
s_mul_i32 s41,s63,325632
s_lshl_b32 s63,s3,2
s_add_u32 s64,s63,21
s_cmp_eq_u32 s3,0
s_cselect_b32 s64,20,s64
s_cselect_b32 s40,1,0
s_add_u32 s65,s63,37
s_cmp_eq_u32 s62,2
s_cselect_b32 s64,s65,s64
s_cselect_b32 s40,0,s40
s_add_u32 s65,s63,s3
s_cmp_eq_u32 s62,0
s_cselect_b32 s64,s65,s64
s_cselect_b32 s40,1,s40
s_mul_i32 s64,s64,6144
s_add_u32 s41,s41,s64
s_add_u32 s20,s30,s22
s_mov_b32 s21,s20
s_waitcnt lgkmcnt(0)
s_mov_b32 s4,s86
s_and_b32 s5,s87,0xffff
s_mov_b32 s6,100663296
s_mov_b32 s7,0x20000
s_mov_b32 s12,s84
s_and_b32 s13,s85,0xffff
s_mov_b32 s14,166723584
s_mov_b32 s15,0x20000
s_mov_b32 s8,s88
s_and_b32 s9,s89,0xffff
s_mov_b32 s10,100663296
s_mov_b32 s11,0x20000
s_mov_b32 s16,s90
s_and_b32 s17,s91,0xffff
s_mov_b32 s18,166723584
s_mov_b32 s19,0x20000
s_mov_b32 s28,s41
s_add_u32 m0,s22,0
s_nop 0
buffer_load_dwordx4 v6,s[4:7],s20 offen offset:0 lds
buffer_load_dwordx4 v7,s[4:7],s20 offen offset:1024 lds
buffer_load_dwordx4 v8,s[4:7],s20 offen offset:2048 lds
s_add_u32 s20,s20,12288
s_add_u32 m0,s24,0
s_nop 0
buffer_load_dwordx4 v6,s[12:15],s28 offen offset:0 nt lds
buffer_load_dwordx4 v7,s[12:15],s28 offen offset:1024 nt lds
buffer_load_dwordx4 v8,s[12:15],s28 offen offset:2048 nt lds
s_add_u32 s28,s28,3072
s_add_u32 m0,s24,3072
s_nop 0
buffer_load_dwordx4 v6,s[12:15],s28 offen offset:0 nt lds
buffer_load_dwordx4 v7,s[12:15],s28 offen offset:1024 nt lds
buffer_load_dwordx4 v8,s[12:15],s28 offen offset:2048 nt lds
s_add_u32 s28,s28,3072
s_add_u32 m0,s22,12288
s_nop 0
buffer_load_dwordx4 v6,s[4:7],s20 offen offset:0 lds
buffer_load_dwordx4 v7,s[4:7],s20 offen offset:1024 lds
buffer_load_dwordx4 v8,s[4:7],s20 offen offset:2048 lds
s_add_u32 s20,s20,12288
s_add_u32 m0,s24,6144
s_nop 0
buffer_load_dwordx4 v6,s[12:15],s28 offen offset:0 nt lds
buffer_load_dwordx4 v7,s[12:15],s28 offen offset:1024 nt lds
buffer_load_dwordx4 v8,s[12:15],s28 offen offset:2048 nt lds
s_add_u32 s28,s28,3072
s_add_u32 m0,s24,9216
s_nop 0
buffer_load_dwordx4 v6,s[12:15],s28 offen offset:0 nt lds
buffer_load_dwordx4 v7,s[12:15],s28 offen offset:1024 nt lds
buffer_load_dwordx4 v8,s[12:15],s28 offen offset:2048 nt lds
s_add_u32 s28,s28,3072
v_and_b32 v156,15,v19
v_lshrrev_b32 v157,4,v19
v_mul_u32_u24 v0,384,v156
v_and_b32 v159,6,v156
v_xor_b32 v159,v159,v157
v_lshl_add_u32 v0,v159,4,v0
v_xor_b32 v1,64,v0
v_add_u32 v11,s24,v0
v_add_u32 v12,s24,v1
v_lshrrev_b32 v156,2,v19
v_mul_u32_u24 v2,384,v156
v_and_b32 v156,6,v156
v_bfe_u32 v159,v19,1,1
v_xor_b32 v156,v156,v159
v_lshl_add_u32 v2,v156,4,v2
v_and_b32 v159,1,v19
v_lshl_add_u32 v2,v159,3,v2
v_add_u32 v2,36864,v2
v_xor_b32 v3,32,v2
v_xor_b32 v4,64,v2
v_xor_b32 v5,96,v2
v_lshrrev_b32 v156,3,v19
v_and_b32 v157,7,v19
v_xor_b32 v159,v157,v156
v_lshl_add_u32 v10,v156,7,s24
v_lshl_add_u32 v10,v159,4,v10
v_mul_u32_u24 v9,384,v156
v_lshl_add_u32 v9,v157,4,v9
v_lshrrev_b32 v156,4,v19
v_xor_b32 v156,v156,v19
v_bfe_u32 v156,v156,1,1
v_subrev_u32 v156,1,v156
v_and_b32 v152,0x3f803f80,v156
v_and_b32 v153,0x3f803f80,v156
v_and_b32 v154,0x3f803f80,v156
v_and_b32 v155,0x3f803f80,v156
v_and_b32 v156,1,v19
v_mul_u32_u24 v156,0xaaaa,v156
v_add_u32 v18,0x4444,v156
s_waitcnt vmcnt(6)
s_barrier
s_cmp_eq_u32 s40,0
s_cbranch_scc1 L_start4
L_start5:
s_add_u32 m0,s24,12288
s_waitcnt vmcnt(9)
ds_read_b128 a[144:147],v11 offset:0
buffer_load_dwordx4 v6,s[12:15],s28 offen offset:0 nt lds
ds_read_b128 a[148:151],v12 offset:0
buffer_load_dwordx4 v7,s[12:15],s28 offen offset:1024 nt lds
ds_read_b128 a[152:155],v11 offset:128
buffer_load_dwordx4 v8,s[12:15],s28 offen offset:2048 nt lds
s_add_u32 s28,s28,3072
s_add_u32 m0,s24,15360
ds_read_b128 a[156:159],v12 offset:128
buffer_load_dwordx4 v6,s[12:15],s28 offen offset:0 nt lds
ds_read_b128 a[160:163],v11 offset:256
buffer_load_dwordx4 v7,s[12:15],s28 offen offset:1024 nt lds
ds_read_b128 a[164:167],v12 offset:256
buffer_load_dwordx4 v8,s[12:15],s28 offen offset:2048 nt lds
s_add_u32 s28,s28,3072
s_add_u32 m0,s24,0
ds_read_b128 v[112:115],v0 offset:0
v_mov_b32 v60,0
ds_read_b128 v[116:119],v1 offset:0
v_mov_b32 v61,0
ds_read_b128 v[120:123],v0 offset:128
v_mov_b32 v62,0
ds_read_b128 v[124:127],v1 offset:128
v_mov_b32 v63,0
ds_read_b128 v[128:131],v0 offset:256
v_mov_b32 v64,0
ds_read_b128 v[132:135],v1 offset:256
v_mov_b32 v65,0
ds_read_b128 v[136:139],v0 offset:6144
v_mov_b32 v66,0
ds_read_b128 v[140:143],v1 offset:6144
v_mov_b32 v67,0
v_mov_b32 v68,0
v_mov_b32 v69,0
v_mov_b32 v70,0
v_mov_b32 v71,0
s_waitcnt lgkmcnt(7)
v_mfma_f32_16x16x32_bf16 v[72:75],v[112:115],a[144:147],0
s_waitcnt lgkmcnt(6)
ds_read_b128 v[112:115],v0 offset:6272
v_mfma_f32_16x16x32_bf16 v[72:75],v[116:119],a[148:151],v[72:75]
s_waitcnt lgkmcnt(6)
ds_read_b128 v[116:119],v1 offset:6272
v_mfma_f32_16x16x32_bf16 v[72:75],v[120:123],a[152:155],v[72:75]
s_waitcnt lgkmcnt(6)
ds_read_b128 v[120:123],v0 offset:6400
v_mfma_f32_16x16x32_bf16 v[72:75],v[124:127],a[156:159],v[72:75]
s_waitcnt lgkmcnt(6)
ds_read_b128 v[124:127],v1 offset:6400
v_mfma_f32_16x16x32_bf16 v[72:75],v[128:131],a[160:163],v[72:75]
s_waitcnt lgkmcnt(6)
ds_read_b128 v[128:131],v0 offset:0
v_mfma_f32_16x16x32_bf16 v[72:75],v[132:135],a[164:167],v[72:75]
s_waitcnt lgkmcnt(6)
ds_read_b128 v[132:135],v1 offset:0
v_mfma_f32_16x16x32_bf16 v[76:79],v[136:139],a[144:147],0
s_waitcnt lgkmcnt(6)
ds_read_b128 v[136:139],v0 offset:128
v_mfma_f32_16x16x32_bf16 v[76:79],v[140:143],a[148:151],v[76:79]
s_waitcnt lgkmcnt(6)
ds_read_b128 v[140:143],v1 offset:128
v_mfma_f32_16x16x32_bf16 v[76:79],v[112:115],a[152:155],v[76:79]
s_waitcnt lgkmcnt(6)
ds_read_b128 v[112:115],v0 offset:256
v_mfma_f32_16x16x32_bf16 v[76:79],v[116:119],a[156:159],v[76:79]
s_waitcnt lgkmcnt(6)
ds_read_b128 v[116:119],v1 offset:256
v_max3_f32 v40,v72,v73,v74
v_mfma_f32_16x16x32_bf16 v[76:79],v[120:123],a[160:163],v[76:79]
s_waitcnt lgkmcnt(6)
ds_read_b128 v[120:123],v0 offset:6144
v_mfma_f32_16x16x32_bf16 v[76:79],v[124:127],a[164:167],v[76:79]
s_waitcnt vmcnt(6)
ds_read_b128 a[168:171],v11 offset:6144
buffer_load_dwordx4 v6,s[12:15],s28 offen offset:0 nt lds
ds_read_b128 a[172:175],v12 offset:6144
buffer_load_dwordx4 v7,s[12:15],s28 offen offset:1024 nt lds
ds_read_b128 a[176:179],v11 offset:6272
buffer_load_dwordx4 v8,s[12:15],s28 offen offset:2048 nt lds
s_add_u32 s28,s28,3072
s_add_u32 m0,s24,3072
ds_read_b128 a[180:183],v12 offset:6272
buffer_load_dwordx4 v6,s[12:15],s28 offen offset:0 nt lds
ds_read_b128 a[184:187],v11 offset:6400
buffer_load_dwordx4 v7,s[12:15],s28 offen offset:1024 nt lds
ds_read_b128 a[188:191],v12 offset:6400
buffer_load_dwordx4 v8,s[12:15],s28 offen offset:2048 nt lds
s_add_u32 s28,s28,3072
s_add_u32 m0,s24,6144
ds_read_b128 v[124:127],v1 offset:6144
v_max3_f32 v40,v40,v75,v76
v_max3_f32 v40,v40,v77,v78
v_max_f32 v40,v40,v79
v_mov_b32 v41,v40
s_waitcnt lgkmcnt(6)
v_mfma_f32_16x16x32_bf16 v[80:83],v[128:131],a[168:171],0
s_waitcnt lgkmcnt(5)
ds_read_b128 v[128:131],v0 offset:6272
v_permlane32_swap_b32 v41,v40
v_mfma_f32_16x16x32_bf16 v[80:83],v[132:135],a[172:175],v[80:83]
s_waitcnt lgkmcnt(5)
ds_read_b128 v[132:135],v1 offset:6272
v_max_f32 v40,v40,v41
v_mfma_f32_16x16x32_bf16 v[80:83],v[136:139],a[176:179],v[80:83]
s_waitcnt lgkmcnt(5)
ds_read_b128 v[136:139],v0 offset:6400
v_mov_b32 v41,v40
v_mfma_f32_16x16x32_bf16 v[80:83],v[140:143],a[180:183],v[80:83]
s_waitcnt lgkmcnt(5)
ds_read_b128 v[140:143],v1 offset:6400
v_permlane16_swap_b32 v41,v40
v_mfma_f32_16x16x32_bf16 v[80:83],v[112:115],a[184:187],v[80:83]
s_waitcnt lgkmcnt(5)
ds_read_b128 v[112:115],v0 offset:12288
v_max_f32 v40,v40,v41
v_mfma_f32_16x16x32_bf16 v[80:83],v[116:119],a[188:191],v[80:83]
ds_read_b128 v[116:119],v1 offset:12288
v_mul_f32_e64 v13,-s36,v40
v_mfma_f32_16x16x32_bf16 v[84:87],v[120:123],a[168:171],0
s_waitcnt lgkmcnt(6)
ds_read_b128 v[120:123],v0 offset:12416
v_fma_f32 v72,v72,s36,v13
v_mfma_f32_16x16x32_bf16 v[84:87],v[124:127],a[172:175],v[84:87]
ds_read_b128 v[124:127],v1 offset:12416
v_fma_f32 v73,v73,s36,v13
v_fma_f32 v74,v74,s36,v13
v_fma_f32 v75,v75,s36,v13
s_waitcnt lgkmcnt(7)
v_mfma_f32_16x16x32_bf16 v[84:87],v[128:131],a[176:179],v[84:87]
s_waitcnt lgkmcnt(5)
ds_read_b128 v[128:131],v0 offset:12544
v_exp_f32 v72,v72
v_mfma_f32_16x16x32_bf16 v[84:87],v[132:135],a[180:183],v[84:87]
ds_read_b128 v[132:135],v1 offset:12544
v_exp_f32 v73,v73
v_mfma_f32_16x16x32_bf16 v[84:87],v[136:139],a[184:187],v[84:87]
s_waitcnt lgkmcnt(5)
ds_read_b128 v[136:139],v0 offset:18432
v_exp_f32 v74,v74
v_mfma_f32_16x16x32_bf16 v[84:87],v[140:143],a[188:191],v[84:87]
ds_read_b128 v[140:143],v1 offset:18432
v_exp_f32 v75,v75
v_cvt_pk_bf16_f32 v20,v72,v73
v_cvt_pk_bf16_f32 v21,v74,v75
v_mfma_f32_16x16x32_bf16 v[72:75],v[112:115],a[144:147],0
s_waitcnt lgkmcnt(5)
ds_read_b128 v[112:115],v0 offset:18560
v_fma_f32 v76,v76,s36,v13
v_mfma_f32_16x16x32_bf16 v[72:75],v[116:119],a[148:151],v[72:75]
ds_read_b128 v[116:119],v1 offset:18560
v_fma_f32 v77,v77,s36,v13
v_mfma_f32_16x16x32_bf16 v[72:75],v[120:123],a[152:155],v[72:75]
s_waitcnt lgkmcnt(5)
ds_read_b128 v[120:123],v0 offset:18688
v_fma_f32 v78,v78,s36,v13
v_mfma_f32_16x16x32_bf16 v[72:75],v[124:127],a[156:159],v[72:75]
ds_read_b128 v[124:127],v1 offset:18688
v_fma_f32 v79,v79,s36,v13
v_mfma_f32_16x16x32_bf16 v[72:75],v[128:131],a[160:163],v[72:75]
s_waitcnt lgkmcnt(6)
ds_read_b128 v[128:131],v0 offset:0
v_exp_f32 v76,v76
v_mfma_f32_16x16x32_bf16 v[72:75],v[132:135],a[164:167],v[72:75]
ds_read_b128 v[132:135],v1 offset:0
v_exp_f32 v77,v77
v_exp_f32 v78,v78
v_exp_f32 v79,v79
v_cvt_pk_bf16_f32 v22,v76,v77
v_cvt_pk_bf16_f32 v23,v78,v79
s_waitcnt lgkmcnt(6)
v_mfma_f32_16x16x32_bf16 v[76:79],v[136:139],a[144:147],0
ds_read_b128 v[136:139],v0 offset:128
v_max3_f32 v44,v80,v81,v82
v_mfma_f32_16x16x32_bf16 v[76:79],v[140:143],a[148:151],v[76:79]
s_waitcnt lgkmcnt(5)
ds_read_b128 v[140:143],v1 offset:128
v_max3_f32 v44,v44,v83,v84
v_mfma_f32_16x16x32_bf16 v[76:79],v[112:115],a[152:155],v[76:79]
ds_read_b128 v[112:115],v0 offset:256
v_max3_f32 v44,v44,v85,v86
v_mfma_f32_16x16x32_bf16 v[76:79],v[116:119],a[156:159],v[76:79]
s_waitcnt lgkmcnt(5)
ds_read_b128 v[116:119],v1 offset:256
v_max_f32 v44,v44,v87
v_mfma_f32_16x16x32_bf16 v[76:79],v[120:123],a[160:163],v[76:79]
ds_read_b128 v[120:123],v0 offset:6144
v_mov_b32 v45,v44
v_mfma_f32_16x16x32_bf16 v[76:79],v[124:127],a[164:167],v[76:79]
s_waitcnt vmcnt(6)
ds_read_b128 a[192:195],v11 offset:12288
buffer_load_dwordx4 v6,s[12:15],s28 offen offset:0 nt lds
ds_read_b128 a[196:199],v12 offset:12288
buffer_load_dwordx4 v7,s[12:15],s28 offen offset:1024 nt lds
ds_read_b128 a[200:203],v11 offset:12416
buffer_load_dwordx4 v8,s[12:15],s28 offen offset:2048 nt lds
s_add_u32 s28,s28,3072
s_add_u32 m0,s24,9216
ds_read_b128 a[204:207],v12 offset:12416
buffer_load_dwordx4 v6,s[12:15],s28 offen offset:0 nt lds
ds_read_b128 a[208:211],v11 offset:12544
buffer_load_dwordx4 v7,s[12:15],s28 offen offset:1024 nt lds
ds_read_b128 a[212:215],v12 offset:12544
buffer_load_dwordx4 v8,s[12:15],s28 offen offset:2048 nt lds
s_add_u32 s28,s28,3072
s_add_u32 m0,s23,0
ds_read_b128 v[124:127],v1 offset:6144
v_permlane32_swap_b32 v45,v44
v_max_f32 v44,v44,v45
v_mov_b32 v45,v44
v_fma_f32 v72,v72,s36,v13
v_fma_f32 v73,v73,s36,v13
s_waitcnt lgkmcnt(6)
v_mfma_f32_16x16x32_bf16 v[88:91],v[128:131],a[192:195],0
s_waitcnt lgkmcnt(5)
ds_read_b128 v[128:131],v0 offset:6272
v_permlane16_swap_b32 v45,v44
v_mfma_f32_16x16x32_bf16 v[88:91],v[132:135],a[196:199],v[88:91]
s_waitcnt lgkmcnt(5)
ds_read_b128 v[132:135],v1 offset:6272
v_max_f32 v44,v44,v45
v_mfma_f32_16x16x32_bf16 v[88:91],v[136:139],a[200:203],v[88:91]
s_waitcnt lgkmcnt(5)
ds_read_b128 v[136:139],v0 offset:6400
v_mul_f32_e64 v14,-s36,v44
v_fma_f32 v80,v80,s36,v14
v_mfma_f32_16x16x32_bf16 v[88:91],v[140:143],a[204:207],v[88:91]
s_waitcnt lgkmcnt(4)
ds_read_b128 v[140:143],v1 offset:6400
v_fma_f32 v81,v81,s36,v14
v_mfma_f32_16x16x32_bf16 v[88:91],v[112:115],a[208:211],v[88:91]
ds_read_b128 v[112:115],v0 offset:12288
v_fma_f32 v82,v82,s36,v14
v_mfma_f32_16x16x32_bf16 v[88:91],v[116:119],a[212:215],v[88:91]
ds_read_b128 v[116:119],v1 offset:12288
v_fma_f32 v83,v83,s36,v14
v_mfma_f32_16x16x32_bf16 v[92:95],v[120:123],a[192:195],0
s_waitcnt lgkmcnt(6)
ds_read_b128 v[120:123],v0 offset:12416
v_exp_f32 v80,v80
v_mfma_f32_16x16x32_bf16 v[92:95],v[124:127],a[196:199],v[92:95]
s_waitcnt lgkmcnt(5)
ds_read_b128 v[124:127],v1 offset:12416
v_exp_f32 v81,v81
v_exp_f32 v82,v82
v_mfma_f32_16x16x32_bf16 v[92:95],v[128:131],a[200:203],v[92:95]
ds_read_b128 v[128:131],v0 offset:12544
v_exp_f32 v83,v83
v_mfma_f32_16x16x32_bf16 v[92:95],v[132:135],a[204:207],v[92:95]
s_waitcnt lgkmcnt(6)
ds_read_b128 v[132:135],v1 offset:12544
v_cvt_pk_bf16_f32 v24,v80,v81
v_mfma_f32_16x16x32_bf16 v[92:95],v[136:139],a[208:211],v[92:95]
s_waitcnt lgkmcnt(6)
ds_read_b128 v[136:139],v0 offset:18432
v_cvt_pk_bf16_f32 v25,v82,v83
v_mfma_f32_16x16x32_bf16 v[92:95],v[140:143],a[212:215],v[92:95]
s_waitcnt lgkmcnt(5)
ds_read_b128 v[140:143],v1 offset:18432
v_fma_f32 v84,v84,s36,v14
v_mfma_f32_16x16x32_bf16 v[80:83],v[112:115],a[168:171],0
ds_read_b128 v[112:115],v0 offset:18560
v_fma_f32 v85,v85,s36,v14
v_mfma_f32_16x16x32_bf16 v[80:83],v[116:119],a[172:175],v[80:83]
s_waitcnt lgkmcnt(6)
ds_read_b128 v[116:119],v1 offset:18560
v_fma_f32 v86,v86,s36,v14
v_mfma_f32_16x16x32_bf16 v[80:83],v[120:123],a[176:179],v[80:83]
s_waitcnt lgkmcnt(6)
ds_read_b128 v[120:123],v0 offset:18688
v_fma_f32 v87,v87,s36,v14
v_exp_f32 v84,v84
v_mfma_f32_16x16x32_bf16 v[80:83],v[124:127],a[180:183],v[80:83]
s_waitcnt lgkmcnt(5)
ds_read_b128 v[124:127],v1 offset:18688
v_exp_f32 v85,v85
v_exp_f32 v86,v86
v_mfma_f32_16x16x32_bf16 v[80:83],v[128:131],a[184:187],v[80:83]
ds_read_b128 v[128:131],v0 offset:0
v_exp_f32 v87,v87
v_mfma_f32_16x16x32_bf16 v[80:83],v[132:135],a[188:191],v[80:83]
s_waitcnt lgkmcnt(5)
ds_read_b128 v[132:135],v1 offset:0
v_cvt_pk_bf16_f32 v26,v84,v85
v_cvt_pk_bf16_f32 v27,v86,v87
v_mfma_f32_16x16x32_bf16 v[84:87],v[136:139],a[168:171],0
ds_read_b128 v[136:139],v0 offset:128
v_max3_f32 v48,v88,v89,v90
v_smfmac_f32_16x16x64_bf16 v[60:63],v[152:155],v[20:27],v18
v_max3_f32 v48,v48,v91,v92
v_mfma_f32_16x16x32_bf16 v[84:87],v[140:143],a[172:175],v[84:87]
s_waitcnt lgkmcnt(4)
ds_read_b128 v[140:143],v1 offset:128
v_max3_f32 v48,v48,v93,v94
v_mfma_f32_16x16x32_bf16 v[84:87],v[112:115],a[176:179],v[84:87]
ds_read_b128 v[112:115],v0 offset:256
v_max_f32 v48,v48,v95
v_mfma_f32_16x16x32_bf16 v[84:87],v[116:119],a[180:183],v[84:87]
ds_read_b128 v[116:119],v1 offset:256
v_mov_b32 v49,v48
v_mfma_f32_16x16x32_bf16 v[84:87],v[120:123],a[184:187],v[84:87]
s_waitcnt lgkmcnt(5)
ds_read_b128 v[120:123],v0 offset:6144
v_permlane32_swap_b32 v49,v48
v_mfma_f32_16x16x32_bf16 v[84:87],v[124:127],a[188:191],v[84:87]
s_waitcnt vmcnt(6)
ds_read_b128 a[216:219],v11 offset:0
buffer_load_dwordx4 v6,s[8:11],s21 offen offset:0 lds
ds_read_b128 a[220:223],v12 offset:0
buffer_load_dwordx4 v7,s[8:11],s21 offen offset:1024 lds
ds_read_b128 a[224:227],v11 offset:128
buffer_load_dwordx4 v8,s[8:11],s21 offen offset:2048 lds
s_add_u32 s21,s21,12288
s_add_u32 m0,s22,24576
ds_read_b128 a[228:231],v12 offset:128
buffer_load_dwordx4 v6,s[4:7],s20 offen offset:0 lds
ds_read_b128 a[232:235],v11 offset:256
buffer_load_dwordx4 v7,s[4:7],s20 offen offset:1024 lds
ds_read_b128 a[236:239],v12 offset:256
buffer_load_dwordx4 v8,s[4:7],s20 offen offset:2048 lds
s_add_u32 s20,s20,12288
s_add_u32 m0,s23,12288
ds_read_b128 v[124:127],v1 offset:6144
v_max_f32 v48,v48,v49
v_mov_b32 v49,v48
v_fma_f32 v74,v74,s36,v13
v_fma_f32 v75,v75,s36,v13
v_permlane16_swap_b32 v49,v48
s_waitcnt lgkmcnt(6)
v_mfma_f32_16x16x32_bf16 v[96:99],v[128:131],a[216:219],0
s_waitcnt lgkmcnt(5)
ds_read_b128 v[128:131],v0 offset:6272
v_max_f32 v48,v48,v49
v_mfma_f32_16x16x32_bf16 v[96:99],v[132:135],a[220:223],v[96:99]
s_waitcnt lgkmcnt(5)
ds_read_b128 v[132:135],v1 offset:6272
v_mul_f32_e64 v15,-s36,v48
v_mfma_f32_16x16x32_bf16 v[96:99],v[136:139],a[224:227],v[96:99]
ds_read_b128 v[136:139],v0 offset:6400
v_fma_f32 v88,v88,s36,v15
v_fma_f32 v89,v89,s36,v15
v_fma_f32 v90,v90,s36,v15
s_waitcnt lgkmcnt(6)
v_mfma_f32_16x16x32_bf16 v[96:99],v[140:143],a[228:231],v[96:99]
s_waitcnt lgkmcnt(4)
ds_read_b128 v[140:143],v1 offset:6400
v_fma_f32 v91,v91,s36,v15
v_mfma_f32_16x16x32_bf16 v[96:99],v[112:115],a[232:235],v[96:99]
ds_read_b128 v[112:115],v0 offset:12288
v_exp_f32 v88,v88
v_mfma_f32_16x16x32_bf16 v[96:99],v[116:119],a[236:239],v[96:99]
ds_read_b128 v[116:119],v1 offset:12288
v_exp_f32 v89,v89
v_mfma_f32_16x16x32_bf16 v[100:103],v[120:123],a[216:219],0
s_waitcnt lgkmcnt(5)
ds_read_b128 v[120:123],v0 offset:12416
v_exp_f32 v90,v90
v_mfma_f32_16x16x32_bf16 v[100:103],v[124:127],a[220:223],v[100:103]
ds_read_b128 v[124:127],v1 offset:12416
v_exp_f32 v91,v91
v_mfma_f32_16x16x32_bf16 v[100:103],v[128:131],a[224:227],v[100:103]
s_waitcnt lgkmcnt(5)
ds_read_b128 v[128:131],v0 offset:12544
v_cvt_pk_bf16_f32 v28,v88,v89
v_mfma_f32_16x16x32_bf16 v[100:103],v[132:135],a[228:231],v[100:103]
ds_read_b128 v[132:135],v1 offset:12544
v_cvt_pk_bf16_f32 v29,v90,v91
v_mfma_f32_16x16x32_bf16 v[100:103],v[136:139],a[232:235],v[100:103]
s_waitcnt lgkmcnt(6)
ds_read_b128 v[136:139],v0 offset:18432
v_fma_f32 v92,v92,s36,v15
v_fma_f32 v93,v93,s36,v15
v_mfma_f32_16x16x32_bf16 v[100:103],v[140:143],a[236:239],v[100:103]
s_waitcnt lgkmcnt(6)
ds_read_b128 v[140:143],v1 offset:18432
v_fma_f32 v94,v94,s36,v15
v_mfma_f32_16x16x32_bf16 v[88:91],v[112:115],a[192:195],0
s_waitcnt lgkmcnt(5)
ds_read_b128 v[112:115],v0 offset:18560
v_fma_f32 v95,v95,s36,v15
v_exp_f32 v92,v92
v_mfma_f32_16x16x32_bf16 v[88:91],v[116:119],a[196:199],v[88:91]
ds_read_b128 v[116:119],v1 offset:18560
v_exp_f32 v93,v93
v_mfma_f32_16x16x32_bf16 v[88:91],v[120:123],a[200:203],v[88:91]
s_waitcnt lgkmcnt(5)
ds_read_b128 v[120:123],v0 offset:18688
v_exp_f32 v94,v94
v_mfma_f32_16x16x32_bf16 v[88:91],v[124:127],a[204:207],v[88:91]
ds_read_b128 v[124:127],v1 offset:18688
v_exp_f32 v95,v95
v_mfma_f32_16x16x32_bf16 v[88:91],v[128:131],a[208:211],v[88:91]
s_waitcnt lgkmcnt(5)
ds_read_b128 v[128:131],v0 offset:0
v_cvt_pk_bf16_f32 v30,v92,v93
v_mfma_f32_16x16x32_bf16 v[88:91],v[132:135],a[212:215],v[88:91]
ds_read_b128 v[132:135],v1 offset:0
v_cvt_pk_bf16_f32 v31,v94,v95
v_mfma_f32_16x16x32_bf16 v[92:95],v[136:139],a[192:195],0
s_waitcnt lgkmcnt(6)
ds_read_b128 v[136:139],v0 offset:128
v_max3_f32 v52,v96,v97,v98
v_mfma_f32_16x16x32_bf16 v[92:95],v[140:143],a[196:199],v[92:95]
s_waitcnt lgkmcnt(6)
ds_read_b128 v[140:143],v1 offset:128
v_max3_f32 v52,v52,v99,v100
v_mfma_f32_16x16x32_bf16 v[92:95],v[112:115],a[200:203],v[92:95]
ds_read_b128 v[112:115],v0 offset:256
v_max3_f32 v52,v52,v101,v102
v_max_f32 v52,v52,v103
v_mov_b32 v53,v52
s_waitcnt lgkmcnt(7)
v_mfma_f32_16x16x32_bf16 v[92:95],v[116:119],a[204:207],v[92:95]
s_waitcnt lgkmcnt(6)
ds_read_b128 v[116:119],v1 offset:256
v_permlane32_swap_b32 v53,v52
v_mfma_f32_16x16x32_bf16 v[92:95],v[120:123],a[208:211],v[92:95]
s_waitcnt lgkmcnt(5)
ds_read_b128 v[120:123],v0 offset:6144
v_max_f32 v52,v52,v53
v_mov_b32 v53,v52
v_mfma_f32_16x16x32_bf16 v[92:95],v[124:127],a[212:215],v[92:95]
s_waitcnt vmcnt(6)
ds_read_b128 a[240:243],v11 offset:6144
buffer_load_dwordx4 v6,s[8:11],s21 offen offset:0 lds
ds_read_b128 a[244:247],v12 offset:6144
buffer_load_dwordx4 v7,s[8:11],s21 offen offset:1024 lds
ds_read_b128 a[248:251],v11 offset:6272
buffer_load_dwordx4 v8,s[8:11],s21 offen offset:2048 lds
s_add_u32 s21,s21,12288
s_add_u32 m0,s23,24576
ds_read_b128 a[252:255],v12 offset:6272
buffer_load_dwordx4 v6,s[8:11],s21 offen offset:0 lds
ds_read_b128 v[144:147],v11 offset:6400
buffer_load_dwordx4 v7,s[8:11],s21 offen offset:1024 lds
ds_read_b128 v[148:151],v12 offset:6400
buffer_load_dwordx4 v8,s[8:11],s21 offen offset:2048 lds
s_add_u32 s21,s21,12288
ds_read_b128 v[124:127],v1 offset:6144
v_permlane16_swap_b32 v53,v52
v_max_f32 v52,v52,v53
v_mul_f32_e64 v16,-s36,v52
v_fma_f32 v96,v96,s36,v16
v_fma_f32 v97,v97,s36,v16
v_fma_f32 v98,v98,s36,v16
s_waitcnt lgkmcnt(6)
v_mfma_f32_16x16x32_bf16 v[104:107],v[128:131],a[240:243],0
s_mov_b32 s27,166723584
ds_read_b128 v[128:131],v0 offset:6272
v_fma_f32 v99,v99,s36,v16
s_waitcnt lgkmcnt(6)
v_mfma_f32_16x16x32_bf16 v[104:107],v[132:135],a[244:247],v[104:107]
s_mov_b32 s42,s41
ds_read_b128 v[132:135],v1 offset:6272
v_exp_f32 v96,v96
s_waitcnt lgkmcnt(6)
v_mfma_f32_16x16x32_bf16 v[104:107],v[136:139],a[248:251],v[104:107]
s_add_u32 s69,s69,1
ds_read_b128 v[136:139],v0 offset:6400
v_exp_f32 v97,v97
s_waitcnt lgkmcnt(6)
v_mfma_f32_16x16x32_bf16 v[104:107],v[140:143],a[252:255],v[104:107]
s_lshl_b32 s62,s69,5
ds_read_b128 v[140:143],v1 offset:6400
v_exp_f32 v98,v98
s_waitcnt lgkmcnt(5)
v_mfma_f32_16x16x32_bf16 v[104:107],v[112:115],v[144:147],v[104:107]
s_add_u32 s62,s62,s34
ds_read_b128 v[112:115],v0 offset:12288
v_exp_f32 v99,v99
v_mfma_f32_16x16x32_bf16 v[104:107],v[116:119],v[148:151],v[104:107]
s_mul_i32 s63,s62,171
ds_read_b128 v[116:119],v1 offset:12288
v_cvt_pk_bf16_f32 v32,v96,v97
v_mfma_f32_16x16x32_bf16 v[108:111],v[120:123],a[240:243],0
s_lshr_b32 s63,s63,9
ds_read_b128 v[120:123],v0 offset:12416
v_cvt_pk_bf16_f32 v33,v98,v99
s_waitcnt lgkmcnt(7)
v_mfma_f32_16x16x32_bf16 v[108:111],v[124:127],a[244:247],v[108:111]
s_mul_i32 s64,s63,3
ds_read_b128 v[124:127],v1 offset:12416
v_fma_f32 v100,v100,s36,v16
v_fma_f32 v101,v101,s36,v16
s_waitcnt lgkmcnt(6)
v_mfma_f32_16x16x32_bf16 v[108:111],v[128:131],a[248:251],v[108:111]
s_sub_u32 s62,s62,s64
ds_read_b128 v[128:131],v0 offset:12544
v_fma_f32 v102,v102,s36,v16
v_mfma_f32_16x16x32_bf16 v[108:111],v[132:135],a[252:255],v[108:111]
s_add_u32 s63,s63,s33
ds_read_b128 v[132:135],v1 offset:12544
v_fma_f32 v103,v103,s36,v16
v_exp_f32 v100,v100
s_waitcnt lgkmcnt(7)
v_mfma_f32_16x16x32_bf16 v[108:111],v[136:139],v[144:147],v[108:111]
s_mul_i32 s30,s63,196608
ds_read_b128 v[136:139],v0 offset:18432
v_exp_f32 v101,v101
s_waitcnt lgkmcnt(7)
v_mfma_f32_16x16x32_bf16 v[108:111],v[140:143],v[148:151],v[108:111]
s_waitcnt vmcnt(9)
s_barrier
s_waitcnt lgkmcnt(5)
v_mfma_f32_16x16x32_bf16 v[96:99],v[112:115],a[216:219],0
s_mul_i32 s41,s63,325632
ds_read_b128 v[140:143],v1 offset:18432
v_exp_f32 v102,v102
v_mfma_f32_16x16x32_bf16 v[96:99],v[116:119],a[220:223],v[96:99]
s_lshl_b32 s63,s3,2
ds_read_b128 v[112:115],v0 offset:18560
v_exp_f32 v103,v103
s_waitcnt lgkmcnt(5)
v_mfma_f32_16x16x32_bf16 v[96:99],v[120:123],a[224:227],v[96:99]
s_add_u32 s64,s63,21
ds_read_b128 v[116:119],v1 offset:18560
v_cvt_pk_bf16_f32 v34,v100,v101
v_mfma_f32_16x16x32_bf16 v[96:99],v[124:127],a[228:231],v[96:99]
s_cmp_eq_u32 s3,0
ds_read_b128 v[120:123],v0 offset:18688
v_cvt_pk_bf16_f32 v35,v102,v103
s_waitcnt lgkmcnt(5)
v_mfma_f32_16x16x32_bf16 v[96:99],v[128:131],a[232:235],v[96:99]
s_cselect_b32 s64,20,s64
ds_read_b128 v[124:127],v1 offset:18688
v_max3_f32 v56,v104,v105,v106
v_smfmac_f32_16x16x64_bf16 v[64:67],v[152:155],v[28:35],v18
s_cselect_b32 s40,1,0
s_add_u32 s65,s63,37
ds_read_b128 v[128:131],v0 offset:12288
v_mfma_f32_16x16x32_bf16 v[96:99],v[132:135],a[236:239],v[96:99]
s_cmp_eq_u32 s62,2
v_max3_f32 v56,v56,v107,v108
v_max3_f32 v56,v56,v109,v110
s_waitcnt lgkmcnt(6)
v_mfma_f32_16x16x32_bf16 v[100:103],v[136:139],a[216:219],0
s_cselect_b32 s64,s65,s64
ds_read_b128 v[132:135],v1 offset:12288
v_max_f32 v56,v56,v111
v_mov_b32 v57,v56
v_fma_f32 v80,v80,s36,v14
v_fma_f32 v81,v81,s36,v14
s_waitcnt lgkmcnt(6)
v_mfma_f32_16x16x32_bf16 v[100:103],v[140:143],a[220:223],v[100:103]
s_cselect_b32 s40,0,s40
ds_read_b128 v[136:139],v0 offset:12416
v_permlane32_swap_b32 v57,v56
s_waitcnt lgkmcnt(6)
v_mfma_f32_16x16x32_bf16 v[100:103],v[112:115],a[224:227],v[100:103]
s_add_u32 s65,s63,s3
ds_read_b128 v[140:143],v1 offset:12416
v_max_f32 v56,v56,v57
v_mov_b32 v57,v56
s_waitcnt lgkmcnt(5)
v_mfma_f32_16x16x32_bf16 v[100:103],v[116:119],a[228:231],v[100:103]
s_cmp_eq_u32 s62,0
ds_read_b128 v[112:115],v0 offset:12544
v_permlane16_swap_b32 v57,v56
v_mfma_f32_16x16x32_bf16 v[100:103],v[120:123],a[232:235],v[100:103]
s_cselect_b32 s64,s65,s64
ds_read_b128 v[116:119],v1 offset:12544
v_max_f32 v56,v56,v57
s_waitcnt lgkmcnt(5)
v_mfma_f32_16x16x32_bf16 v[100:103],v[124:127],a[236:239],v[100:103]
s_cselect_b32 s40,1,s40
ds_read_b128 v[120:123],v0 offset:18432
v_mul_f32_e64 v17,-s36,v56
ds_read_b128 v[124:127],v1 offset:18432
v_fma_f32 v104,v104,s36,v17
v_fma_f32 v105,v105,s36,v17
v_fma_f32 v106,v106,s36,v17
v_fma_f32 v107,v107,s36,v17
v_exp_f32 v104,v104
v_exp_f32 v105,v105
v_exp_f32 v106,v106
v_exp_f32 v107,v107
v_cvt_pk_bf16_f32 v36,v104,v105
v_cvt_pk_bf16_f32 v37,v106,v107
v_mfma_f32_16x16x32_bf16 v[104:107],v[128:131],a[240:243],0
s_mul_i32 s64,s64,6144
ds_read_b128 v[128:131],v0 offset:18560
v_fma_f32 v108,v108,s36,v17
s_waitcnt lgkmcnt(5)
v_mfma_f32_16x16x32_bf16 v[104:107],v[132:135],a[244:247],v[104:107]
s_add_u32 s41,s41,s64
ds_read_b128 v[132:135],v1 offset:18560
v_fma_f32 v109,v109,s36,v17
v_mfma_f32_16x16x32_bf16 v[104:107],v[136:139],a[248:251],v[104:107]
s_cmp_ge_u32 s69,6
ds_read_b128 v[136:139],v0 offset:18688
v_fma_f32 v110,v110,s36,v17
v_mfma_f32_16x16x32_bf16 v[104:107],v[140:143],a[252:255],v[104:107]
s_cselect_b32 s41,166723584,s41
ds_read_b128 v[140:143],v1 offset:18688
v_fma_f32 v111,v111,s36,v17
s_waitcnt lgkmcnt(5)
v_mfma_f32_16x16x32_bf16 v[104:107],v[112:115],v[144:147],v[104:107]
s_cselect_b32 s30,100663296,s30
ds_read_b64_tr_b16 v[112:113],v2 offset:0
v_exp_f32 v108,v108
v_mfma_f32_16x16x32_bf16 v[104:107],v[116:119],v[148:151],v[104:107]
s_add_u32 s25,s30,s22
ds_read_b64_tr_b16 v[114:115],v2 offset:6144
ds_read_b64_tr_b16 v[116:117],v3 offset:0
ds_read_b64_tr_b16 v[118:119],v3 offset:6144
v_exp_f32 v109,v109
v_exp_f32 v110,v110
v_exp_f32 v111,v111
v_cvt_pk_bf16_f32 v38,v108,v109
v_cvt_pk_bf16_f32 v39,v110,v111
v_mfma_f32_16x16x32_bf16 v[108:111],v[120:123],a[240:243],0
s_add_u32 s26,s25,12288
ds_read_b64_tr_b16 v[120:121],v4 offset:0
v_fma_f32 v82,v82,s36,v14
v_smfmac_f32_16x16x64_bf16 v[68:71],v[152:155],v[32:39],v18
s_mov_b32 s28,s41
s_mov_b32 s29,s24
ds_read_b64_tr_b16 v[122:123],v4 offset:6144
s_waitcnt lgkmcnt(8)
v_mfma_f32_16x16x32_bf16 v[108:111],v[124:127],a[244:247],v[108:111]
s_add_u32 m0,s22,0
ds_read_b64_tr_b16 v[124:125],v5 offset:0
buffer_load_dwordx4 v6,s[4:7],s20 offen offset:0 lds
v_mfma_f32_16x16x32_bf16 v[108:111],v[128:131],a[248:251],v[108:111]
buffer_load_dwordx4 v7,s[4:7],s20 offen offset:1024 lds
v_mfma_f32_16x16x32_bf16 v[108:111],v[132:135],a[252:255],v[108:111]
buffer_load_dwordx4 v8,s[4:7],s20 offen offset:2048 lds
s_waitcnt lgkmcnt(4)
v_mfma_f32_16x16x32_bf16 v[108:111],v[136:139],v[144:147],v[108:111]
s_add_u32 s20,s20,12288
ds_read_b64_tr_b16 v[126:127],v5 offset:6144
v_fma_f32 v83,v83,s36,v14
v_mfma_f32_16x16x32_bf16 v[108:111],v[140:143],v[148:151],v[108:111]
v_fma_f32 v88,v88,s36,v15
v_fma_f32 v89,v89,s36,v15
v_exp_f32 v72,v72
v_exp_f32 v73,v73
v_exp_f32 v74,v74
v_exp_f32 v75,v75
v_exp_f32 v80,v80
v_exp_f32 v81,v81
v_exp_f32 v82,v82
v_exp_f32 v83,v83
v_exp_f32 v88,v88
v_exp_f32 v89,v89
v_cvt_pk_bf16_f32 v40,v72,v73
v_cvt_pk_bf16_f32 v41,v74,v75
v_cvt_pk_bf16_f32 v44,v80,v81
v_cvt_pk_bf16_f32 v45,v82,v83
v_cvt_pk_bf16_f32 v48,v88,v89
v_mfma_f32_16x16x32_bf16 v[160:163],v[112:115],v[20:23],0
s_add_u32 m0,s23,0
ds_read_b64_tr_b16 v[128:129],v2 offset:128
v_fma_f32 v90,v90,s36,v15
s_waitcnt lgkmcnt(1)
v_mfma_f32_16x16x32_bf16 v[164:167],v[116:119],v[20:23],0
ds_read_b64_tr_b16 v[130:131],v2 offset:6272
v_fma_f32 v91,v91,s36,v15
v_mfma_f32_16x16x32_bf16 v[212:215],v[116:119],v[24:27],0
ds_read_b64_tr_b16 v[132:133],v3 offset:128
v_fma_f32 v96,v96,s36,v16
v_mfma_f32_16x16x32_bf16 v[208:211],v[112:115],v[24:27],0
ds_read_b64_tr_b16 v[134:135],v3 offset:6272
v_fma_f32 v97,v97,s36,v16
v_mfma_f32_16x16x32_bf16 a[0:3],v[112:115],v[28:31],0
ds_read_b64_tr_b16 v[136:137],v4 offset:128
v_fma_f32 v98,v98,s36,v16
v_mfma_f32_16x16x32_bf16 a[4:7],v[116:119],v[28:31],0
ds_read_b64_tr_b16 v[138:139],v4 offset:6272
v_fma_f32 v99,v99,s36,v16
v_mfma_f32_16x16x32_bf16 a[52:55],v[116:119],v[32:35],0
ds_read_b64_tr_b16 v[140:141],v5 offset:128
v_fma_f32 v104,v104,s36,v17
v_mfma_f32_16x16x32_bf16 a[48:51],v[112:115],v[32:35],0
ds_read_b64_tr_b16 v[142:143],v5 offset:6272
v_fma_f32 v105,v105,s36,v17
v_mfma_f32_16x16x32_bf16 a[96:99],v[112:115],v[36:39],0
ds_read_b64_tr_b16 v[112:113],v2 offset:256
v_fma_f32 v106,v106,s36,v17
v_mfma_f32_16x16x32_bf16 a[100:103],v[116:119],v[36:39],0
ds_read_b64_tr_b16 v[114:115],v2 offset:6400
v_fma_f32 v107,v107,s36,v17
v_mfma_f32_16x16x32_bf16 a[104:107],v[120:123],v[36:39],0
ds_read_b64_tr_b16 v[116:117],v3 offset:256
v_fma_f32 v76,v76,s36,v13
v_mfma_f32_16x16x32_bf16 a[108:111],v[124:127],v[36:39],0
ds_read_b64_tr_b16 v[118:119],v3 offset:6400
v_fma_f32 v77,v77,s36,v13
v_mfma_f32_16x16x32_bf16 a[60:63],v[124:127],v[32:35],0
v_exp_f32 v90,v90
v_mfma_f32_16x16x32_bf16 a[56:59],v[120:123],v[32:35],0
v_exp_f32 v91,v91
v_mfma_f32_16x16x32_bf16 a[8:11],v[120:123],v[28:31],0
v_cvt_pk_bf16_f32 v49,v90,v91
v_fma_f32 v78,v78,s36,v13
v_mfma_f32_16x16x32_bf16 a[12:15],v[124:127],v[28:31],0
v_exp_f32 v96,v96
v_mfma_f32_16x16x32_bf16 v[220:223],v[124:127],v[24:27],0
v_exp_f32 v97,v97
v_mfma_f32_16x16x32_bf16 v[216:219],v[120:123],v[24:27],0
v_exp_f32 v98,v98
v_mfma_f32_16x16x32_bf16 v[168:171],v[120:123],v[20:23],0
ds_read_b64_tr_b16 v[120:121],v4 offset:256
v_cvt_pk_bf16_f32 v52,v96,v97
v_mfma_f32_16x16x32_bf16 v[172:175],v[124:127],v[20:23],0
s_waitcnt lgkmcnt(2)
ds_read_b64_tr_b16 v[122:123],v4 offset:6400
v_fma_f32 v79,v79,s36,v13
v_mfma_f32_16x16x32_bf16 v[176:179],v[128:131],v[20:23],0
ds_read_b64_tr_b16 v[124:125],v5 offset:256
v_fma_f32 v84,v84,s36,v14
v_mfma_f32_16x16x32_bf16 v[180:183],v[132:135],v[20:23],0
ds_read_b64_tr_b16 v[126:127],v5 offset:6400
v_fma_f32 v85,v85,s36,v14
v_mfma_f32_16x16x32_bf16 v[228:231],v[132:135],v[24:27],0
v_exp_f32 v99,v99
v_mfma_f32_16x16x32_bf16 v[224:227],v[128:131],v[24:27],0
v_cvt_pk_bf16_f32 v53,v98,v99
v_fma_f32 v86,v86,s36,v14
v_mfma_f32_16x16x32_bf16 a[16:19],v[128:131],v[28:31],0
v_exp_f32 v104,v104
v_mfma_f32_16x16x32_bf16 a[20:23],v[132:135],v[28:31],0
v_exp_f32 v105,v105
v_mfma_f32_16x16x32_bf16 a[68:71],v[132:135],v[32:35],0
v_exp_f32 v106,v106
v_mfma_f32_16x16x32_bf16 a[64:67],v[128:131],v[32:35],0
v_exp_f32 v107,v107
v_mfma_f32_16x16x32_bf16 a[112:115],v[128:131],v[36:39],0
v_cvt_pk_bf16_f32 v56,v104,v105
v_cvt_pk_bf16_f32 v57,v106,v107
v_mfma_f32_16x16x32_bf16 a[116:119],v[132:135],v[36:39],0
v_exp_f32 v76,v76
v_mfma_f32_16x16x32_bf16 a[120:123],v[136:139],v[36:39],0
v_exp_f32 v77,v77
v_mfma_f32_16x16x32_bf16 a[124:127],v[140:143],v[36:39],0
v_exp_f32 v78,v78
v_mfma_f32_16x16x32_bf16 a[76:79],v[140:143],v[32:35],0
v_exp_f32 v79,v79
v_mfma_f32_16x16x32_bf16 a[72:75],v[136:139],v[32:35],0
v_cvt_pk_bf16_f32 v42,v76,v77
v_cvt_pk_bf16_f32 v43,v78,v79
v_mfma_f32_16x16x32_bf16 a[24:27],v[136:139],v[28:31],0
v_fma_f32 v87,v87,s36,v14
v_fma_f32 v92,v92,s36,v15
v_mfma_f32_16x16x32_bf16 a[28:31],v[140:143],v[28:31],0
v_exp_f32 v84,v84
v_mfma_f32_16x16x32_bf16 v[236:239],v[140:143],v[24:27],0
v_exp_f32 v85,v85
v_mfma_f32_16x16x32_bf16 v[232:235],v[136:139],v[24:27],0
v_exp_f32 v86,v86
v_mfma_f32_16x16x32_bf16 v[184:187],v[136:139],v[20:23],0
v_exp_f32 v87,v87
v_mfma_f32_16x16x32_bf16 v[188:191],v[140:143],v[20:23],0
v_cvt_pk_bf16_f32 v46,v84,v85
v_cvt_pk_bf16_f32 v47,v86,v87
v_mfma_f32_16x16x32_bf16 v[192:195],v[112:115],v[20:23],0
v_fma_f32 v93,v93,s36,v15
v_fma_f32 v94,v94,s36,v15
v_smfmac_f32_16x16x64_bf16 v[60:63],v[152:155],v[40:47],v18
v_fma_f32 v95,v95,s36,v15
s_waitcnt vmcnt(6)
s_waitcnt lgkmcnt(0)
v_mfma_f32_16x16x32_bf16 v[196:199],v[116:119],v[20:23],0
s_barrier
v_mfma_f32_16x16x32_bf16 v[244:247],v[116:119],v[24:27],0
ds_read_b128 v[128:131],v0 offset:24576
v_fma_f32 v100,v100,s36,v16
v_mfma_f32_16x16x32_bf16 v[240:243],v[112:115],v[24:27],0
ds_read_b128 v[132:135],v1 offset:24576
v_fma_f32 v101,v101,s36,v16
v_mfma_f32_16x16x32_bf16 a[32:35],v[112:115],v[28:31],0
ds_read_b128 v[136:139],v0 offset:24704
v_fma_f32 v102,v102,s36,v16
v_mfma_f32_16x16x32_bf16 a[36:39],v[116:119],v[28:31],0
ds_read_b128 v[140:143],v1 offset:24704
v_fma_f32 v103,v103,s36,v16
v_mfma_f32_16x16x32_bf16 a[84:87],v[116:119],v[32:35],0
v_exp_f32 v92,v92
v_mfma_f32_16x16x32_bf16 a[80:83],v[112:115],v[32:35],0
buffer_load_dwordx4 v6,s[8:11],s21 offen offset:0 lds
v_mfma_f32_16x16x32_bf16 a[128:131],v[112:115],v[36:39],0
ds_read_b128 v[112:115],v0 offset:24832
v_fma_f32 v108,v108,s36,v17
v_mfma_f32_16x16x32_bf16 a[132:135],v[116:119],v[36:39],0
ds_read_b128 v[116:119],v1 offset:24832
v_fma_f32 v109,v109,s36,v17
v_mfma_f32_16x16x32_bf16 a[136:139],v[120:123],v[36:39],0
v_exp_f32 v93,v93
v_mfma_f32_16x16x32_bf16 a[140:143],v[124:127],v[36:39],0
v_exp_f32 v94,v94
v_mfma_f32_16x16x32_bf16 a[92:95],v[124:127],v[32:35],0
v_exp_f32 v95,v95
v_mfma_f32_16x16x32_bf16 a[88:91],v[120:123],v[32:35],0
v_cvt_pk_bf16_f32 v50,v92,v93
v_cvt_pk_bf16_f32 v51,v94,v95
v_mfma_f32_16x16x32_bf16 a[40:43],v[120:123],v[28:31],0
v_exp_f32 v100,v100
v_mfma_f32_16x16x32_bf16 a[44:47],v[124:127],v[28:31],0
v_exp_f32 v101,v101
v_mfma_f32_16x16x32_bf16 v[252:255],v[124:127],v[24:27],0
v_exp_f32 v102,v102
v_mfma_f32_16x16x32_bf16 v[248:251],v[120:123],v[24:27],0
v_exp_f32 v103,v103
v_mfma_f32_16x16x32_bf16 v[200:203],v[120:123],v[20:23],0
ds_read_b128 v[120:123],v0 offset:30720
v_cvt_pk_bf16_f32 v54,v100,v101
v_mfma_f32_16x16x32_bf16 v[204:207],v[124:127],v[20:23],0
buffer_load_dwordx4 v7,s[8:11],s21 offen offset:1024 lds
s_waitcnt lgkmcnt(1)
v_mfma_f32_16x16x32_bf16 v[72:75],v[128:131],a[144:147],0
ds_read_b128 v[124:127],v1 offset:30720
v_cvt_pk_bf16_f32 v55,v102,v103
v_mfma_f32_16x16x32_bf16 v[72:75],v[132:135],a[148:151],v[72:75]
v_fma_f32 v110,v110,s36,v17
v_fma_f32 v111,v111,s36,v17
v_smfmac_f32_16x16x64_bf16 v[64:67],v[152:155],v[48:55],v18
v_mfma_f32_16x16x32_bf16 v[72:75],v[136:139],a[152:155],v[72:75]
v_exp_f32 v108,v108
v_mfma_f32_16x16x32_bf16 v[72:75],v[140:143],a[156:159],v[72:75]
v_exp_f32 v109,v109
v_mfma_f32_16x16x32_bf16 v[72:75],v[112:115],a[160:163],v[72:75]
v_exp_f32 v110,v110
v_mfma_f32_16x16x32_bf16 v[72:75],v[116:119],a[164:167],v[72:75]
v_exp_f32 v111,v111
v_mfma_f32_16x16x32_bf16 v[80:83],v[116:119],a[188:191],0
v_cvt_pk_bf16_f32 v58,v108,v109
v_cvt_pk_bf16_f32 v59,v110,v111
v_mfma_f32_16x16x32_bf16 v[80:83],v[112:115],a[184:187],v[80:83]
v_mfma_f32_16x16x32_bf16 v[80:83],v[140:143],a[180:183],v[80:83]
v_smfmac_f32_16x16x64_bf16 v[68:71],v[152:155],v[52:59],v18
buffer_load_dwordx4 v8,s[8:11],s21 offen offset:2048 lds
v_mfma_f32_16x16x32_bf16 v[80:83],v[136:139],a[176:179],v[80:83]
s_add_u32 s21,s21,12288
v_fma_f32 v72,v72,s36,v13
v_fma_f32 v73,v73,s36,v13
v_mfma_f32_16x16x32_bf16 v[80:83],v[132:135],a[172:175],v[80:83]
s_add_u32 m0,s22,12288
v_fma_f32 v74,v74,s36,v13
v_fma_f32 v75,v75,s36,v13
v_mfma_f32_16x16x32_bf16 v[80:83],v[128:131],a[168:171],v[80:83]
v_exp_f32 v72,v72
v_mfma_f32_16x16x32_bf16 v[88:91],v[128:131],a[192:195],0
v_exp_f32 v73,v73
v_mfma_f32_16x16x32_bf16 v[88:91],v[132:135],a[196:199],v[88:91]
v_exp_f32 v74,v74
v_mfma_f32_16x16x32_bf16 v[88:91],v[136:139],a[200:203],v[88:91]
v_exp_f32 v75,v75
v_mfma_f32_16x16x32_bf16 v[88:91],v[140:143],a[204:207],v[88:91]
v_fma_f32 v80,v80,s36,v14
v_fma_f32 v81,v81,s36,v14
v_mfma_f32_16x16x32_bf16 v[88:91],v[112:115],a[208:211],v[88:91]
v_fma_f32 v82,v82,s36,v14
v_fma_f32 v83,v83,s36,v14
v_mfma_f32_16x16x32_bf16 v[88:91],v[116:119],a[212:215],v[88:91]
v_exp_f32 v80,v80
v_mfma_f32_16x16x32_bf16 v[96:99],v[116:119],a[236:239],0
v_exp_f32 v81,v81
v_mfma_f32_16x16x32_bf16 v[96:99],v[112:115],a[232:235],v[96:99]
buffer_load_dwordx4 v6,s[4:7],s20 offen offset:0 lds
v_mfma_f32_16x16x32_bf16 v[96:99],v[140:143],a[228:231],v[96:99]
v_exp_f32 v82,v82
v_mfma_f32_16x16x32_bf16 v[96:99],v[136:139],a[224:227],v[96:99]
v_fma_f32 v88,v88,s36,v15
v_fma_f32 v89,v89,s36,v15
v_mfma_f32_16x16x32_bf16 v[96:99],v[132:135],a[220:223],v[96:99]
v_exp_f32 v83,v83
v_mfma_f32_16x16x32_bf16 v[96:99],v[128:131],a[216:219],v[96:99]
v_exp_f32 v88,v88
v_mfma_f32_16x16x32_bf16 v[104:107],v[128:131],a[240:243],0
ds_read_b128 v[128:131],v0 offset:30848
v_cvt_pk_bf16_f32 v20,v72,v73
v_mfma_f32_16x16x32_bf16 v[104:107],v[132:135],a[244:247],v[104:107]
ds_read_b128 v[132:135],v1 offset:30848
v_cvt_pk_bf16_f32 v21,v74,v75
v_mfma_f32_16x16x32_bf16 v[104:107],v[136:139],a[248:251],v[104:107]
ds_read_b128 v[136:139],v0 offset:30976
v_cvt_pk_bf16_f32 v24,v80,v81
v_mfma_f32_16x16x32_bf16 v[104:107],v[140:143],a[252:255],v[104:107]
ds_read_b128 v[140:143],v1 offset:30976
v_cvt_pk_bf16_f32 v25,v82,v83
v_mfma_f32_16x16x32_bf16 v[104:107],v[112:115],v[144:147],v[104:107]
v_exp_f32 v89,v89
v_mfma_f32_16x16x32_bf16 v[104:107],v[116:119],v[148:151],v[104:107]
s_waitcnt lgkmcnt(4)
v_cvt_pk_bf16_f32 v28,v88,v89
v_mfma_f32_16x16x32_bf16 v[76:79],v[120:123],a[144:147],0
buffer_load_dwordx4 v7,s[4:7],s20 offen offset:1024 lds
v_mfma_f32_16x16x32_bf16 v[76:79],v[124:127],a[148:151],v[76:79]
s_waitcnt lgkmcnt(3)
v_mfma_f32_16x16x32_bf16 v[76:79],v[128:131],a[152:155],v[76:79]
s_waitcnt lgkmcnt(2)
v_mfma_f32_16x16x32_bf16 v[76:79],v[132:135],a[156:159],v[76:79]
s_waitcnt lgkmcnt(1)
v_mfma_f32_16x16x32_bf16 v[76:79],v[136:139],a[160:163],v[76:79]
s_waitcnt lgkmcnt(0)
v_mfma_f32_16x16x32_bf16 v[76:79],v[140:143],a[164:167],v[76:79]
v_mfma_f32_16x16x32_bf16 v[84:87],v[140:143],a[188:191],0
v_mfma_f32_16x16x32_bf16 v[84:87],v[136:139],a[184:187],v[84:87]
v_mfma_f32_16x16x32_bf16 v[84:87],v[132:135],a[180:183],v[84:87]
v_mfma_f32_16x16x32_bf16 v[84:87],v[128:131],a[176:179],v[84:87]
v_mfma_f32_16x16x32_bf16 v[84:87],v[124:127],a[172:175],v[84:87]
v_mfma_f32_16x16x32_bf16 v[84:87],v[120:123],a[168:171],v[84:87]
buffer_load_dwordx4 v8,s[4:7],s20 offen offset:2048 lds
v_mfma_f32_16x16x32_bf16 v[92:95],v[120:123],a[192:195],0
s_add_u32 s20,s20,12288
v_mfma_f32_16x16x32_bf16 v[92:95],v[124:127],a[196:199],v[92:95]
v_mfma_f32_16x16x32_bf16 v[92:95],v[128:131],a[200:203],v[92:95]
v_mfma_f32_16x16x32_bf16 v[92:95],v[132:135],a[204:207],v[92:95]
v_mfma_f32_16x16x32_bf16 v[92:95],v[136:139],a[208:211],v[92:95]
ds_read_b64_tr_b16 v[112:113],v2 offset:12288
v_mfma_f32_16x16x32_bf16 v[92:95],v[140:143],a[212:215],v[92:95]
ds_read_b64_tr_b16 v[114:115],v2 offset:18432
v_mfma_f32_16x16x32_bf16 v[100:103],v[140:143],a[236:239],0
v_mfma_f32_16x16x32_bf16 v[100:103],v[136:139],a[232:235],v[100:103]
ds_read_b64_tr_b16 v[116:117],v3 offset:12288
v_mfma_f32_16x16x32_bf16 v[100:103],v[132:135],a[228:231],v[100:103]
ds_read_b64_tr_b16 v[118:119],v3 offset:18432
v_mfma_f32_16x16x32_bf16 v[100:103],v[128:131],a[224:227],v[100:103]
v_mfma_f32_16x16x32_bf16 v[100:103],v[124:127],a[220:223],v[100:103]
v_mfma_f32_16x16x32_bf16 v[100:103],v[120:123],a[216:219],v[100:103]
v_mfma_f32_16x16x32_bf16 v[108:111],v[120:123],a[240:243],0
ds_read_b64_tr_b16 v[120:121],v4 offset:12288
v_mfma_f32_16x16x32_bf16 v[108:111],v[124:127],a[244:247],v[108:111]
ds_read_b64_tr_b16 v[122:123],v4 offset:18432
v_mfma_f32_16x16x32_bf16 v[108:111],v[128:131],a[248:251],v[108:111]
ds_read_b64_tr_b16 v[124:125],v5 offset:12288
v_mfma_f32_16x16x32_bf16 v[108:111],v[132:135],a[252:255],v[108:111]
ds_read_b64_tr_b16 v[126:127],v5 offset:18432
v_mfma_f32_16x16x32_bf16 v[108:111],v[136:139],v[144:147],v[108:111]
v_mfma_f32_16x16x32_bf16 v[108:111],v[140:143],v[148:151],v[108:111]
s_waitcnt lgkmcnt(4)
v_mfma_f32_16x16x32_bf16 v[160:163],v[112:115],v[40:43],v[160:163]
s_add_u32 m0,s23,12288
ds_read_b64_tr_b16 v[128:129],v2 offset:12416
v_fma_f32 v90,v90,s36,v15
v_mfma_f32_16x16x32_bf16 v[164:167],v[116:119],v[40:43],v[164:167]
ds_read_b64_tr_b16 v[130:131],v2 offset:18560
v_fma_f32 v91,v91,s36,v15
v_mfma_f32_16x16x32_bf16 v[212:215],v[116:119],v[44:47],v[212:215]
ds_read_b64_tr_b16 v[132:133],v3 offset:12416
v_fma_f32 v96,v96,s36,v16
v_mfma_f32_16x16x32_bf16 v[208:211],v[112:115],v[44:47],v[208:211]
ds_read_b64_tr_b16 v[134:135],v3 offset:18560
v_fma_f32 v97,v97,s36,v16
v_mfma_f32_16x16x32_bf16 a[0:3],v[112:115],v[48:51],a[0:3]
ds_read_b64_tr_b16 v[136:137],v4 offset:12416
v_fma_f32 v98,v98,s36,v16
v_mfma_f32_16x16x32_bf16 a[4:7],v[116:119],v[48:51],a[4:7]
ds_read_b64_tr_b16 v[138:139],v4 offset:18560
v_fma_f32 v99,v99,s36,v16
v_mfma_f32_16x16x32_bf16 a[52:55],v[116:119],v[52:55],a[52:55]
ds_read_b64_tr_b16 v[140:141],v5 offset:12416
v_fma_f32 v104,v104,s36,v17
v_mfma_f32_16x16x32_bf16 a[48:51],v[112:115],v[52:55],a[48:51]
ds_read_b64_tr_b16 v[142:143],v5 offset:18560
v_fma_f32 v105,v105,s36,v17
v_mfma_f32_16x16x32_bf16 a[96:99],v[112:115],v[56:59],a[96:99]
ds_read_b64_tr_b16 v[112:113],v2 offset:12544
v_fma_f32 v106,v106,s36,v17
v_mfma_f32_16x16x32_bf16 a[100:103],v[116:119],v[56:59],a[100:103]
s_waitcnt lgkmcnt(8)
ds_read_b64_tr_b16 v[114:115],v2 offset:18688
v_fma_f32 v107,v107,s36,v17
v_mfma_f32_16x16x32_bf16 a[104:107],v[120:123],v[56:59],a[104:107]
ds_read_b64_tr_b16 v[116:117],v3 offset:12544
v_fma_f32 v76,v76,s36,v13
v_mfma_f32_16x16x32_bf16 a[108:111],v[124:127],v[56:59],a[108:111]
ds_read_b64_tr_b16 v[118:119],v3 offset:18688
v_fma_f32 v77,v77,s36,v13
v_mfma_f32_16x16x32_bf16 a[60:63],v[124:127],v[52:55],a[60:63]
v_exp_f32 v90,v90
v_mfma_f32_16x16x32_bf16 a[56:59],v[120:123],v[52:55],a[56:59]
v_exp_f32 v91,v91
v_mfma_f32_16x16x32_bf16 a[8:11],v[120:123],v[48:51],a[8:11]
v_cvt_pk_bf16_f32 v29,v90,v91
v_fma_f32 v78,v78,s36,v13
v_mfma_f32_16x16x32_bf16 a[12:15],v[124:127],v[48:51],a[12:15]
v_exp_f32 v96,v96
v_mfma_f32_16x16x32_bf16 v[220:223],v[124:127],v[44:47],v[220:223]
v_exp_f32 v97,v97
v_mfma_f32_16x16x32_bf16 v[216:219],v[120:123],v[44:47],v[216:219]
v_exp_f32 v98,v98
v_mfma_f32_16x16x32_bf16 v[168:171],v[120:123],v[40:43],v[168:171]
ds_read_b64_tr_b16 v[120:121],v4 offset:12544
v_cvt_pk_bf16_f32 v32,v96,v97
v_mfma_f32_16x16x32_bf16 v[172:175],v[124:127],v[40:43],v[172:175]
s_waitcnt lgkmcnt(2)
ds_read_b64_tr_b16 v[122:123],v4 offset:18688
v_fma_f32 v79,v79,s36,v13
v_mfma_f32_16x16x32_bf16 v[176:179],v[128:131],v[40:43],v[176:179]
ds_read_b64_tr_b16 v[124:125],v5 offset:12544
v_fma_f32 v84,v84,s36,v14
v_mfma_f32_16x16x32_bf16 v[180:183],v[132:135],v[40:43],v[180:183]
ds_read_b64_tr_b16 v[126:127],v5 offset:18688
v_fma_f32 v85,v85,s36,v14
v_mfma_f32_16x16x32_bf16 v[228:231],v[132:135],v[44:47],v[228:231]
v_exp_f32 v99,v99
v_mfma_f32_16x16x32_bf16 v[224:227],v[128:131],v[44:47],v[224:227]
v_cvt_pk_bf16_f32 v33,v98,v99
v_fma_f32 v86,v86,s36,v14
v_mfma_f32_16x16x32_bf16 a[16:19],v[128:131],v[48:51],a[16:19]
v_exp_f32 v104,v104
v_mfma_f32_16x16x32_bf16 a[20:23],v[132:135],v[48:51],a[20:23]
v_exp_f32 v105,v105
v_mfma_f32_16x16x32_bf16 a[68:71],v[132:135],v[52:55],a[68:71]
v_exp_f32 v106,v106
v_mfma_f32_16x16x32_bf16 a[64:67],v[128:131],v[52:55],a[64:67]
v_exp_f32 v107,v107
v_mfma_f32_16x16x32_bf16 a[112:115],v[128:131],v[56:59],a[112:115]
v_cvt_pk_bf16_f32 v36,v104,v105
v_cvt_pk_bf16_f32 v37,v106,v107
v_mfma_f32_16x16x32_bf16 a[116:119],v[132:135],v[56:59],a[116:119]
v_exp_f32 v76,v76
v_mfma_f32_16x16x32_bf16 a[120:123],v[136:139],v[56:59],a[120:123]
v_exp_f32 v77,v77
v_mfma_f32_16x16x32_bf16 a[124:127],v[140:143],v[56:59],a[124:127]
v_exp_f32 v78,v78
v_mfma_f32_16x16x32_bf16 a[76:79],v[140:143],v[52:55],a[76:79]
v_exp_f32 v79,v79
v_mfma_f32_16x16x32_bf16 a[72:75],v[136:139],v[52:55],a[72:75]
v_cvt_pk_bf16_f32 v22,v76,v77
v_cvt_pk_bf16_f32 v23,v78,v79
v_mfma_f32_16x16x32_bf16 a[24:27],v[136:139],v[48:51],a[24:27]
v_fma_f32 v87,v87,s36,v14
v_fma_f32 v92,v92,s36,v15
v_mfma_f32_16x16x32_bf16 a[28:31],v[140:143],v[48:51],a[28:31]
v_exp_f32 v84,v84
v_mfma_f32_16x16x32_bf16 v[236:239],v[140:143],v[44:47],v[236:239]
v_exp_f32 v85,v85
v_mfma_f32_16x16x32_bf16 v[232:235],v[136:139],v[44:47],v[232:235]
v_exp_f32 v86,v86
v_mfma_f32_16x16x32_bf16 v[184:187],v[136:139],v[40:43],v[184:187]
v_exp_f32 v87,v87
v_mfma_f32_16x16x32_bf16 v[188:191],v[140:143],v[40:43],v[188:191]
v_cvt_pk_bf16_f32 v26,v84,v85
v_cvt_pk_bf16_f32 v27,v86,v87
v_mfma_f32_16x16x32_bf16 v[192:195],v[112:115],v[40:43],v[192:195]
v_fma_f32 v93,v93,s36,v15
v_fma_f32 v94,v94,s36,v15
v_smfmac_f32_16x16x64_bf16 v[60:63],v[152:155],v[20:27],v18
v_fma_f32 v95,v95,s36,v15
s_waitcnt vmcnt(6)
s_waitcnt lgkmcnt(0)
v_mfma_f32_16x16x32_bf16 v[196:199],v[116:119],v[40:43],v[196:199]
s_barrier
v_mfma_f32_16x16x32_bf16 v[244:247],v[116:119],v[44:47],v[244:247]
ds_read_b128 v[128:131],v0 offset:0
v_fma_f32 v100,v100,s36,v16
v_mfma_f32_16x16x32_bf16 v[240:243],v[112:115],v[44:47],v[240:243]
ds_read_b128 v[132:135],v1 offset:0
v_fma_f32 v101,v101,s36,v16
v_mfma_f32_16x16x32_bf16 a[32:35],v[112:115],v[48:51],a[32:35]
ds_read_b128 v[136:139],v0 offset:128
v_fma_f32 v102,v102,s36,v16
v_mfma_f32_16x16x32_bf16 a[36:39],v[116:119],v[48:51],a[36:39]
ds_read_b128 v[140:143],v1 offset:128
v_fma_f32 v103,v103,s36,v16
v_mfma_f32_16x16x32_bf16 a[84:87],v[116:119],v[52:55],a[84:87]
v_exp_f32 v92,v92
v_mfma_f32_16x16x32_bf16 a[80:83],v[112:115],v[52:55],a[80:83]
buffer_load_dwordx4 v6,s[8:11],s21 offen offset:0 lds
v_mfma_f32_16x16x32_bf16 a[128:131],v[112:115],v[56:59],a[128:131]
ds_read_b128 v[112:115],v0 offset:256
v_fma_f32 v108,v108,s36,v17
v_mfma_f32_16x16x32_bf16 a[132:135],v[116:119],v[56:59],a[132:135]
ds_read_b128 v[116:119],v1 offset:256
v_fma_f32 v109,v109,s36,v17
v_mfma_f32_16x16x32_bf16 a[136:139],v[120:123],v[56:59],a[136:139]
v_exp_f32 v93,v93
v_mfma_f32_16x16x32_bf16 a[140:143],v[124:127],v[56:59],a[140:143]
v_exp_f32 v94,v94
v_mfma_f32_16x16x32_bf16 a[92:95],v[124:127],v[52:55],a[92:95]
v_exp_f32 v95,v95
v_mfma_f32_16x16x32_bf16 a[88:91],v[120:123],v[52:55],a[88:91]
v_cvt_pk_bf16_f32 v30,v92,v93
v_cvt_pk_bf16_f32 v31,v94,v95
v_mfma_f32_16x16x32_bf16 a[40:43],v[120:123],v[48:51],a[40:43]
v_exp_f32 v100,v100
v_mfma_f32_16x16x32_bf16 a[44:47],v[124:127],v[48:51],a[44:47]
v_exp_f32 v101,v101
v_mfma_f32_16x16x32_bf16 v[252:255],v[124:127],v[44:47],v[252:255]
v_exp_f32 v102,v102
v_mfma_f32_16x16x32_bf16 v[248:251],v[120:123],v[44:47],v[248:251]
v_exp_f32 v103,v103
v_mfma_f32_16x16x32_bf16 v[200:203],v[120:123],v[40:43],v[200:203]
ds_read_b128 v[120:123],v0 offset:6144
v_cvt_pk_bf16_f32 v34,v100,v101
v_mfma_f32_16x16x32_bf16 v[204:207],v[124:127],v[40:43],v[204:207]
buffer_load_dwordx4 v7,s[8:11],s21 offen offset:1024 lds
s_waitcnt lgkmcnt(1)
v_mfma_f32_16x16x32_bf16 v[72:75],v[128:131],a[144:147],0
ds_read_b128 v[124:127],v1 offset:6144
v_cvt_pk_bf16_f32 v35,v102,v103
v_mfma_f32_16x16x32_bf16 v[72:75],v[132:135],a[148:151],v[72:75]
v_fma_f32 v110,v110,s36,v17
v_fma_f32 v111,v111,s36,v17
v_smfmac_f32_16x16x64_bf16 v[64:67],v[152:155],v[28:35],v18
v_mfma_f32_16x16x32_bf16 v[72:75],v[136:139],a[152:155],v[72:75]
v_exp_f32 v108,v108
v_mfma_f32_16x16x32_bf16 v[72:75],v[140:143],a[156:159],v[72:75]
v_exp_f32 v109,v109
v_mfma_f32_16x16x32_bf16 v[72:75],v[112:115],a[160:163],v[72:75]
v_exp_f32 v110,v110
v_mfma_f32_16x16x32_bf16 v[72:75],v[116:119],a[164:167],v[72:75]
v_exp_f32 v111,v111
v_mfma_f32_16x16x32_bf16 v[80:83],v[116:119],a[188:191],0
v_cvt_pk_bf16_f32 v38,v108,v109
v_cvt_pk_bf16_f32 v39,v110,v111
v_mfma_f32_16x16x32_bf16 v[80:83],v[112:115],a[184:187],v[80:83]
v_mfma_f32_16x16x32_bf16 v[80:83],v[140:143],a[180:183],v[80:83]
v_smfmac_f32_16x16x64_bf16 v[68:71],v[152:155],v[32:39],v18
buffer_load_dwordx4 v8,s[8:11],s21 offen offset:2048 lds
v_mfma_f32_16x16x32_bf16 v[80:83],v[136:139],a[176:179],v[80:83]
s_add_u32 s21,s21,12288
v_fma_f32 v72,v72,s36,v13
v_fma_f32 v73,v73,s36,v13
v_mfma_f32_16x16x32_bf16 v[80:83],v[132:135],a[172:175],v[80:83]
s_add_u32 m0,s22,24576
v_fma_f32 v74,v74,s36,v13
v_fma_f32 v75,v75,s36,v13
v_mfma_f32_16x16x32_bf16 v[80:83],v[128:131],a[168:171],v[80:83]
v_exp_f32 v72,v72
v_mfma_f32_16x16x32_bf16 v[88:91],v[128:131],a[192:195],0
v_exp_f32 v73,v73
v_mfma_f32_16x16x32_bf16 v[88:91],v[132:135],a[196:199],v[88:91]
v_exp_f32 v74,v74
v_mfma_f32_16x16x32_bf16 v[88:91],v[136:139],a[200:203],v[88:91]
v_exp_f32 v75,v75
v_mfma_f32_16x16x32_bf16 v[88:91],v[140:143],a[204:207],v[88:91]
v_fma_f32 v80,v80,s36,v14
v_fma_f32 v81,v81,s36,v14
v_mfma_f32_16x16x32_bf16 v[88:91],v[112:115],a[208:211],v[88:91]
v_fma_f32 v82,v82,s36,v14
v_fma_f32 v83,v83,s36,v14
v_mfma_f32_16x16x32_bf16 v[88:91],v[116:119],a[212:215],v[88:91]
v_exp_f32 v80,v80
v_mfma_f32_16x16x32_bf16 v[96:99],v[116:119],a[236:239],0
v_exp_f32 v81,v81
v_mfma_f32_16x16x32_bf16 v[96:99],v[112:115],a[232:235],v[96:99]
buffer_load_dwordx4 v6,s[4:7],s20 offen offset:0 lds
v_mfma_f32_16x16x32_bf16 v[96:99],v[140:143],a[228:231],v[96:99]
v_exp_f32 v82,v82
v_mfma_f32_16x16x32_bf16 v[96:99],v[136:139],a[224:227],v[96:99]
v_fma_f32 v88,v88,s36,v15
v_fma_f32 v89,v89,s36,v15
v_mfma_f32_16x16x32_bf16 v[96:99],v[132:135],a[220:223],v[96:99]
v_exp_f32 v83,v83
v_mfma_f32_16x16x32_bf16 v[96:99],v[128:131],a[216:219],v[96:99]
v_exp_f32 v88,v88
v_mfma_f32_16x16x32_bf16 v[104:107],v[128:131],a[240:243],0
ds_read_b128 v[128:131],v0 offset:6272
v_cvt_pk_bf16_f32 v40,v72,v73
v_mfma_f32_16x16x32_bf16 v[104:107],v[132:135],a[244:247],v[104:107]
ds_read_b128 v[132:135],v1 offset:6272
v_cvt_pk_bf16_f32 v41,v74,v75
v_mfma_f32_16x16x32_bf16 v[104:107],v[136:139],a[248:251],v[104:107]
ds_read_b128 v[136:139],v0 offset:6400
v_cvt_pk_bf16_f32 v44,v80,v81
v_mfma_f32_16x16x32_bf16 v[104:107],v[140:143],a[252:255],v[104:107]
ds_read_b128 v[140:143],v1 offset:6400
v_cvt_pk_bf16_f32 v45,v82,v83
v_mfma_f32_16x16x32_bf16 v[104:107],v[112:115],v[144:147],v[104:107]
v_exp_f32 v89,v89
v_mfma_f32_16x16x32_bf16 v[104:107],v[116:119],v[148:151],v[104:107]
s_waitcnt lgkmcnt(4)
v_cvt_pk_bf16_f32 v48,v88,v89
v_mfma_f32_16x16x32_bf16 v[76:79],v[120:123],a[144:147],0
buffer_load_dwordx4 v7,s[4:7],s20 offen offset:1024 lds
v_mfma_f32_16x16x32_bf16 v[76:79],v[124:127],a[148:151],v[76:79]
s_waitcnt lgkmcnt(3)
v_mfma_f32_16x16x32_bf16 v[76:79],v[128:131],a[152:155],v[76:79]
s_waitcnt lgkmcnt(2)
v_mfma_f32_16x16x32_bf16 v[76:79],v[132:135],a[156:159],v[76:79]
s_waitcnt lgkmcnt(1)
v_mfma_f32_16x16x32_bf16 v[76:79],v[136:139],a[160:163],v[76:79]
s_waitcnt lgkmcnt(0)
v_mfma_f32_16x16x32_bf16 v[76:79],v[140:143],a[164:167],v[76:79]
v_mfma_f32_16x16x32_bf16 v[84:87],v[140:143],a[188:191],0
v_mfma_f32_16x16x32_bf16 v[84:87],v[136:139],a[184:187],v[84:87]
v_mfma_f32_16x16x32_bf16 v[84:87],v[132:135],a[180:183],v[84:87]
v_mfma_f32_16x16x32_bf16 v[84:87],v[128:131],a[176:179],v[84:87]
v_mfma_f32_16x16x32_bf16 v[84:87],v[124:127],a[172:175],v[84:87]
v_mfma_f32_16x16x32_bf16 v[84:87],v[120:123],a[168:171],v[84:87]
buffer_load_dwordx4 v8,s[4:7],s20 offen offset:2048 lds
v_mfma_f32_16x16x32_bf16 v[92:95],v[120:123],a[192:195],0
s_add_u32 s20,s20,12288
v_mfma_f32_16x16x32_bf16 v[92:95],v[124:127],a[196:199],v[92:95]
v_mfma_f32_16x16x32_bf16 v[92:95],v[128:131],a[200:203],v[92:95]
v_mfma_f32_16x16x32_bf16 v[92:95],v[132:135],a[204:207],v[92:95]
v_mfma_f32_16x16x32_bf16 v[92:95],v[136:139],a[208:211],v[92:95]
ds_read_b64_tr_b16 v[112:113],v2 offset:24576
v_mfma_f32_16x16x32_bf16 v[92:95],v[140:143],a[212:215],v[92:95]
ds_read_b64_tr_b16 v[114:115],v2 offset:30720
v_mfma_f32_16x16x32_bf16 v[100:103],v[140:143],a[236:239],0
v_mfma_f32_16x16x32_bf16 v[100:103],v[136:139],a[232:235],v[100:103]
ds_read_b64_tr_b16 v[116:117],v3 offset:24576
v_mfma_f32_16x16x32_bf16 v[100:103],v[132:135],a[228:231],v[100:103]
ds_read_b64_tr_b16 v[118:119],v3 offset:30720
v_mfma_f32_16x16x32_bf16 v[100:103],v[128:131],a[224:227],v[100:103]
v_mfma_f32_16x16x32_bf16 v[100:103],v[124:127],a[220:223],v[100:103]
v_mfma_f32_16x16x32_bf16 v[100:103],v[120:123],a[216:219],v[100:103]
v_mfma_f32_16x16x32_bf16 v[108:111],v[120:123],a[240:243],0
ds_read_b64_tr_b16 v[120:121],v4 offset:24576
v_mfma_f32_16x16x32_bf16 v[108:111],v[124:127],a[244:247],v[108:111]
ds_read_b64_tr_b16 v[122:123],v4 offset:30720
v_mfma_f32_16x16x32_bf16 v[108:111],v[128:131],a[248:251],v[108:111]
ds_read_b64_tr_b16 v[124:125],v5 offset:24576
v_mfma_f32_16x16x32_bf16 v[108:111],v[132:135],a[252:255],v[108:111]
ds_read_b64_tr_b16 v[126:127],v5 offset:30720
v_mfma_f32_16x16x32_bf16 v[108:111],v[136:139],v[144:147],v[108:111]
v_mfma_f32_16x16x32_bf16 v[108:111],v[140:143],v[148:151],v[108:111]
s_mov_b32 s38,0
s_branch L_loop5
L_start4:
s_add_u32 m0,s24,12288
s_waitcnt vmcnt(9)
ds_read_b128 a[144:147],v11 offset:0
buffer_load_dwordx4 v6,s[12:15],s28 offen offset:0 nt lds
ds_read_b128 a[148:151],v12 offset:0
buffer_load_dwordx4 v7,s[12:15],s28 offen offset:1024 nt lds
ds_read_b128 a[152:155],v11 offset:128
buffer_load_dwordx4 v8,s[12:15],s28 offen offset:2048 nt lds
s_add_u32 s28,s28,3072
s_add_u32 m0,s24,15360
ds_read_b128 a[156:159],v12 offset:128
buffer_load_dwordx4 v6,s[12:15],s28 offen offset:0 nt lds
ds_read_b128 a[160:163],v11 offset:256
buffer_load_dwordx4 v7,s[12:15],s28 offen offset:1024 nt lds
ds_read_b128 a[164:167],v12 offset:256
buffer_load_dwordx4 v8,s[12:15],s28 offen offset:2048 nt lds
s_add_u32 s28,s28,3072
s_add_u32 m0,s24,0
ds_read_b128 v[112:115],v0 offset:0
v_mov_b32 v60,0
ds_read_b128 v[116:119],v1 offset:0
v_mov_b32 v61,0
ds_read_b128 v[120:123],v0 offset:128
v_mov_b32 v62,0
ds_read_b128 v[124:127],v1 offset:128
v_mov_b32 v63,0
ds_read_b128 v[128:131],v0 offset:256
v_mov_b32 v64,0
ds_read_b128 v[132:135],v1 offset:256
v_mov_b32 v65,0
ds_read_b128 v[136:139],v0 offset:6144
v_mov_b32 v66,0
ds_read_b128 v[140:143],v1 offset:6144
v_mov_b32 v67,0
s_waitcnt lgkmcnt(7)
v_mfma_f32_16x16x32_bf16 v[72:75],v[112:115],a[144:147],0
s_waitcnt lgkmcnt(6)
ds_read_b128 v[112:115],v0 offset:6272
v_mfma_f32_16x16x32_bf16 v[72:75],v[116:119],a[148:151],v[72:75]
s_waitcnt lgkmcnt(6)
ds_read_b128 v[116:119],v1 offset:6272
v_mfma_f32_16x16x32_bf16 v[72:75],v[120:123],a[152:155],v[72:75]
s_waitcnt lgkmcnt(6)
ds_read_b128 v[120:123],v0 offset:6400
v_mfma_f32_16x16x32_bf16 v[72:75],v[124:127],a[156:159],v[72:75]
s_waitcnt lgkmcnt(6)
ds_read_b128 v[124:127],v1 offset:6400
v_mfma_f32_16x16x32_bf16 v[72:75],v[128:131],a[160:163],v[72:75]
s_waitcnt lgkmcnt(6)
ds_read_b128 v[128:131],v0 offset:0
v_mfma_f32_16x16x32_bf16 v[72:75],v[132:135],a[164:167],v[72:75]
s_waitcnt lgkmcnt(6)
ds_read_b128 v[132:135],v1 offset:0
v_mfma_f32_16x16x32_bf16 v[76:79],v[136:139],a[144:147],0
s_waitcnt lgkmcnt(6)
ds_read_b128 v[136:139],v0 offset:128
v_mfma_f32_16x16x32_bf16 v[76:79],v[140:143],a[148:151],v[76:79]
s_waitcnt lgkmcnt(6)
ds_read_b128 v[140:143],v1 offset:128
v_mfma_f32_16x16x32_bf16 v[76:79],v[112:115],a[152:155],v[76:79]
s_waitcnt lgkmcnt(6)
ds_read_b128 v[112:115],v0 offset:256
v_mfma_f32_16x16x32_bf16 v[76:79],v[116:119],a[156:159],v[76:79]
s_waitcnt lgkmcnt(6)
ds_read_b128 v[116:119],v1 offset:256
v_max3_f32 v40,v72,v73,v74
v_mfma_f32_16x16x32_bf16 v[76:79],v[120:123],a[160:163],v[76:79]
s_waitcnt lgkmcnt(6)
ds_read_b128 v[120:123],v0 offset:6144
v_mfma_f32_16x16x32_bf16 v[76:79],v[124:127],a[164:167],v[76:79]
s_waitcnt vmcnt(6)
ds_read_b128 a[168:171],v11 offset:6144
buffer_load_dwordx4 v6,s[12:15],s28 offen offset:0 nt lds
ds_read_b128 a[172:175],v12 offset:6144
buffer_load_dwordx4 v7,s[12:15],s28 offen offset:1024 nt lds
ds_read_b128 a[176:179],v11 offset:6272
buffer_load_dwordx4 v8,s[12:15],s28 offen offset:2048 nt lds
s_add_u32 s28,s28,3072
s_add_u32 m0,s24,3072
ds_read_b128 a[180:183],v12 offset:6272
buffer_load_dwordx4 v6,s[12:15],s28 offen offset:0 nt lds
ds_read_b128 a[184:187],v11 offset:6400
buffer_load_dwordx4 v7,s[12:15],s28 offen offset:1024 nt lds
ds_read_b128 a[188:191],v12 offset:6400
buffer_load_dwordx4 v8,s[12:15],s28 offen offset:2048 nt lds
s_add_u32 s28,s28,3072
s_add_u32 m0,s23,0
ds_read_b128 v[124:127],v1 offset:6144
v_max3_f32 v40,v40,v75,v76
v_max3_f32 v40,v40,v77,v78
v_max_f32 v40,v40,v79
v_mov_b32 v41,v40
s_waitcnt lgkmcnt(6)
v_mfma_f32_16x16x32_bf16 v[80:83],v[128:131],a[168:171],0
s_waitcnt lgkmcnt(5)
ds_read_b128 v[128:131],v0 offset:6272
v_permlane32_swap_b32 v41,v40
v_mfma_f32_16x16x32_bf16 v[80:83],v[132:135],a[172:175],v[80:83]
s_waitcnt lgkmcnt(5)
ds_read_b128 v[132:135],v1 offset:6272
v_max_f32 v40,v40,v41
v_mfma_f32_16x16x32_bf16 v[80:83],v[136:139],a[176:179],v[80:83]
s_waitcnt lgkmcnt(5)
ds_read_b128 v[136:139],v0 offset:6400
v_mov_b32 v41,v40
v_mfma_f32_16x16x32_bf16 v[80:83],v[140:143],a[180:183],v[80:83]
s_waitcnt lgkmcnt(5)
ds_read_b128 v[140:143],v1 offset:6400
v_permlane16_swap_b32 v41,v40
v_mfma_f32_16x16x32_bf16 v[80:83],v[112:115],a[184:187],v[80:83]
s_waitcnt lgkmcnt(5)
ds_read_b128 v[112:115],v0 offset:12288
v_max_f32 v40,v40,v41
v_mfma_f32_16x16x32_bf16 v[80:83],v[116:119],a[188:191],v[80:83]
ds_read_b128 v[116:119],v1 offset:12288
v_mul_f32_e64 v13,-s36,v40
v_mfma_f32_16x16x32_bf16 v[84:87],v[120:123],a[168:171],0
s_waitcnt lgkmcnt(6)
ds_read_b128 v[120:123],v0 offset:12416
v_fma_f32 v72,v72,s36,v13
v_mfma_f32_16x16x32_bf16 v[84:87],v[124:127],a[172:175],v[84:87]
ds_read_b128 v[124:127],v1 offset:12416
v_fma_f32 v73,v73,s36,v13
v_fma_f32 v74,v74,s36,v13
v_fma_f32 v75,v75,s36,v13
s_waitcnt lgkmcnt(7)
v_mfma_f32_16x16x32_bf16 v[84:87],v[128:131],a[176:179],v[84:87]
s_waitcnt lgkmcnt(5)
ds_read_b128 v[128:131],v0 offset:12544
v_exp_f32 v72,v72
v_mfma_f32_16x16x32_bf16 v[84:87],v[132:135],a[180:183],v[84:87]
ds_read_b128 v[132:135],v1 offset:12544
v_exp_f32 v73,v73
v_mfma_f32_16x16x32_bf16 v[84:87],v[136:139],a[184:187],v[84:87]
s_waitcnt lgkmcnt(5)
ds_read_b128 v[136:139],v0 offset:18432
v_exp_f32 v74,v74
v_mfma_f32_16x16x32_bf16 v[84:87],v[140:143],a[188:191],v[84:87]
ds_read_b128 v[140:143],v1 offset:18432
v_exp_f32 v75,v75
v_cvt_pk_bf16_f32 v20,v72,v73
v_cvt_pk_bf16_f32 v21,v74,v75
v_mfma_f32_16x16x32_bf16 v[72:75],v[112:115],a[144:147],0
s_waitcnt lgkmcnt(5)
ds_read_b128 v[112:115],v0 offset:18560
v_fma_f32 v76,v76,s36,v13
v_mfma_f32_16x16x32_bf16 v[72:75],v[116:119],a[148:151],v[72:75]
ds_read_b128 v[116:119],v1 offset:18560
v_fma_f32 v77,v77,s36,v13
v_mfma_f32_16x16x32_bf16 v[72:75],v[120:123],a[152:155],v[72:75]
s_waitcnt lgkmcnt(5)
ds_read_b128 v[120:123],v0 offset:18688
v_fma_f32 v78,v78,s36,v13
v_mfma_f32_16x16x32_bf16 v[72:75],v[124:127],a[156:159],v[72:75]
ds_read_b128 v[124:127],v1 offset:18688
v_fma_f32 v79,v79,s36,v13
v_mfma_f32_16x16x32_bf16 v[72:75],v[128:131],a[160:163],v[72:75]
s_waitcnt lgkmcnt(6)
ds_read_b128 v[128:131],v0 offset:0
v_exp_f32 v76,v76
v_mfma_f32_16x16x32_bf16 v[72:75],v[132:135],a[164:167],v[72:75]
ds_read_b128 v[132:135],v1 offset:0
v_exp_f32 v77,v77
v_exp_f32 v78,v78
v_exp_f32 v79,v79
v_cvt_pk_bf16_f32 v22,v76,v77
v_cvt_pk_bf16_f32 v23,v78,v79
s_waitcnt lgkmcnt(6)
v_mfma_f32_16x16x32_bf16 v[76:79],v[136:139],a[144:147],0
ds_read_b128 v[136:139],v0 offset:128
v_max3_f32 v44,v80,v81,v82
v_mfma_f32_16x16x32_bf16 v[76:79],v[140:143],a[148:151],v[76:79]
s_waitcnt lgkmcnt(5)
ds_read_b128 v[140:143],v1 offset:128
v_max3_f32 v44,v44,v83,v84
v_mfma_f32_16x16x32_bf16 v[76:79],v[112:115],a[152:155],v[76:79]
ds_read_b128 v[112:115],v0 offset:256
v_max3_f32 v44,v44,v85,v86
v_mfma_f32_16x16x32_bf16 v[76:79],v[116:119],a[156:159],v[76:79]
s_waitcnt lgkmcnt(5)
ds_read_b128 v[116:119],v1 offset:256
v_max_f32 v44,v44,v87
v_mfma_f32_16x16x32_bf16 v[76:79],v[120:123],a[160:163],v[76:79]
ds_read_b128 v[120:123],v0 offset:6144
v_mov_b32 v45,v44
v_mfma_f32_16x16x32_bf16 v[76:79],v[124:127],a[164:167],v[76:79]
s_waitcnt vmcnt(6)
ds_read_b128 a[192:195],v11 offset:12288
buffer_load_dwordx4 v6,s[8:11],s21 offen offset:0 lds
ds_read_b128 a[196:199],v12 offset:12288
buffer_load_dwordx4 v7,s[8:11],s21 offen offset:1024 lds
ds_read_b128 a[200:203],v11 offset:12416
buffer_load_dwordx4 v8,s[8:11],s21 offen offset:2048 lds
s_add_u32 s21,s21,12288
s_add_u32 m0,s22,24576
ds_read_b128 a[204:207],v12 offset:12416
buffer_load_dwordx4 v6,s[4:7],s20 offen offset:0 lds
ds_read_b128 a[208:211],v11 offset:12544
buffer_load_dwordx4 v7,s[4:7],s20 offen offset:1024 lds
ds_read_b128 a[212:215],v12 offset:12544
buffer_load_dwordx4 v8,s[4:7],s20 offen offset:2048 lds
s_add_u32 s20,s20,12288
s_add_u32 m0,s23,12288
ds_read_b128 v[124:127],v1 offset:6144
v_permlane32_swap_b32 v45,v44
v_max_f32 v44,v44,v45
v_mov_b32 v45,v44
v_fma_f32 v72,v72,s36,v13
v_fma_f32 v73,v73,s36,v13
s_waitcnt lgkmcnt(6)
v_mfma_f32_16x16x32_bf16 v[88:91],v[128:131],a[192:195],0
s_waitcnt lgkmcnt(5)
ds_read_b128 v[128:131],v0 offset:6272
v_permlane16_swap_b32 v45,v44
v_mfma_f32_16x16x32_bf16 v[88:91],v[132:135],a[196:199],v[88:91]
s_waitcnt lgkmcnt(5)
ds_read_b128 v[132:135],v1 offset:6272
v_max_f32 v44,v44,v45
v_mfma_f32_16x16x32_bf16 v[88:91],v[136:139],a[200:203],v[88:91]
s_waitcnt lgkmcnt(5)
ds_read_b128 v[136:139],v0 offset:6400
v_mul_f32_e64 v14,-s36,v44
v_fma_f32 v80,v80,s36,v14
v_mfma_f32_16x16x32_bf16 v[88:91],v[140:143],a[204:207],v[88:91]
s_waitcnt lgkmcnt(4)
ds_read_b128 v[140:143],v1 offset:6400
v_fma_f32 v81,v81,s36,v14
v_mfma_f32_16x16x32_bf16 v[88:91],v[112:115],a[208:211],v[88:91]
ds_read_b128 v[112:115],v0 offset:12288
v_fma_f32 v82,v82,s36,v14
v_mfma_f32_16x16x32_bf16 v[88:91],v[116:119],a[212:215],v[88:91]
ds_read_b128 v[116:119],v1 offset:12288
v_fma_f32 v83,v83,s36,v14
v_mfma_f32_16x16x32_bf16 v[92:95],v[120:123],a[192:195],0
s_waitcnt lgkmcnt(6)
ds_read_b128 v[120:123],v0 offset:12416
v_exp_f32 v80,v80
v_mfma_f32_16x16x32_bf16 v[92:95],v[124:127],a[196:199],v[92:95]
s_waitcnt lgkmcnt(5)
ds_read_b128 v[124:127],v1 offset:12416
v_exp_f32 v81,v81
v_exp_f32 v82,v82
v_mfma_f32_16x16x32_bf16 v[92:95],v[128:131],a[200:203],v[92:95]
ds_read_b128 v[128:131],v0 offset:12544
v_exp_f32 v83,v83
v_mfma_f32_16x16x32_bf16 v[92:95],v[132:135],a[204:207],v[92:95]
s_waitcnt lgkmcnt(6)
ds_read_b128 v[132:135],v1 offset:12544
v_cvt_pk_bf16_f32 v24,v80,v81
v_mfma_f32_16x16x32_bf16 v[92:95],v[136:139],a[208:211],v[92:95]
s_waitcnt lgkmcnt(6)
ds_read_b128 v[136:139],v0 offset:18432
v_cvt_pk_bf16_f32 v25,v82,v83
v_mfma_f32_16x16x32_bf16 v[92:95],v[140:143],a[212:215],v[92:95]
s_waitcnt lgkmcnt(5)
ds_read_b128 v[140:143],v1 offset:18432
v_fma_f32 v84,v84,s36,v14
v_mfma_f32_16x16x32_bf16 v[80:83],v[112:115],a[168:171],0
ds_read_b128 v[112:115],v0 offset:18560
v_fma_f32 v85,v85,s36,v14
v_mfma_f32_16x16x32_bf16 v[80:83],v[116:119],a[172:175],v[80:83]
s_waitcnt lgkmcnt(6)
ds_read_b128 v[116:119],v1 offset:18560
v_fma_f32 v86,v86,s36,v14
v_mfma_f32_16x16x32_bf16 v[80:83],v[120:123],a[176:179],v[80:83]
s_waitcnt lgkmcnt(6)
ds_read_b128 v[120:123],v0 offset:18688
v_fma_f32 v87,v87,s36,v14
v_exp_f32 v84,v84
v_mfma_f32_16x16x32_bf16 v[80:83],v[124:127],a[180:183],v[80:83]
s_waitcnt lgkmcnt(5)
ds_read_b128 v[124:127],v1 offset:18688
v_exp_f32 v85,v85
v_exp_f32 v86,v86
v_mfma_f32_16x16x32_bf16 v[80:83],v[128:131],a[184:187],v[80:83]
ds_read_b128 v[128:131],v0 offset:0
v_exp_f32 v87,v87
v_mfma_f32_16x16x32_bf16 v[80:83],v[132:135],a[188:191],v[80:83]
s_waitcnt lgkmcnt(5)
ds_read_b128 v[132:135],v1 offset:0
v_cvt_pk_bf16_f32 v26,v84,v85
v_cvt_pk_bf16_f32 v27,v86,v87
v_mfma_f32_16x16x32_bf16 v[84:87],v[136:139],a[168:171],0
ds_read_b128 v[136:139],v0 offset:128
v_max3_f32 v48,v88,v89,v90
v_smfmac_f32_16x16x64_bf16 v[60:63],v[152:155],v[20:27],v18
v_max3_f32 v48,v48,v91,v92
v_mfma_f32_16x16x32_bf16 v[84:87],v[140:143],a[172:175],v[84:87]
s_waitcnt lgkmcnt(4)
ds_read_b128 v[140:143],v1 offset:128
v_max3_f32 v48,v48,v93,v94
v_mfma_f32_16x16x32_bf16 v[84:87],v[112:115],a[176:179],v[84:87]
ds_read_b128 v[112:115],v0 offset:256
v_max_f32 v48,v48,v95
v_mfma_f32_16x16x32_bf16 v[84:87],v[116:119],a[180:183],v[84:87]
ds_read_b128 v[116:119],v1 offset:256
v_mov_b32 v49,v48
v_mfma_f32_16x16x32_bf16 v[84:87],v[120:123],a[184:187],v[84:87]
s_waitcnt lgkmcnt(5)
ds_read_b128 v[120:123],v0 offset:6144
v_permlane32_swap_b32 v49,v48
v_mfma_f32_16x16x32_bf16 v[84:87],v[124:127],a[188:191],v[84:87]
s_waitcnt vmcnt(6)
ds_read_b128 a[216:219],v11 offset:0
buffer_load_dwordx4 v6,s[8:11],s21 offen offset:0 lds
ds_read_b128 a[220:223],v12 offset:0
buffer_load_dwordx4 v7,s[8:11],s21 offen offset:1024 lds
ds_read_b128 a[224:227],v11 offset:128
buffer_load_dwordx4 v8,s[8:11],s21 offen offset:2048 lds
s_add_u32 s21,s21,12288
s_add_u32 m0,s23,24576
ds_read_b128 a[228:231],v12 offset:128
buffer_load_dwordx4 v6,s[8:11],s21 offen offset:0 lds
ds_read_b128 a[232:235],v11 offset:256
buffer_load_dwordx4 v7,s[8:11],s21 offen offset:1024 lds
ds_read_b128 a[236:239],v12 offset:256
buffer_load_dwordx4 v8,s[8:11],s21 offen offset:2048 lds
s_add_u32 s21,s21,12288
ds_read_b128 v[124:127],v1 offset:6144
v_max_f32 v48,v48,v49
v_mov_b32 v49,v48
v_fma_f32 v74,v74,s36,v13
v_fma_f32 v75,v75,s36,v13
v_permlane16_swap_b32 v49,v48
v_max_f32 v48,v48,v49
s_waitcnt lgkmcnt(6)
v_mfma_f32_16x16x32_bf16 v[96:99],v[128:131],a[216:219],0
s_mov_b32 s27,166723584
ds_read_b128 v[128:131],v0 offset:6272
v_mul_f32_e64 v15,-s36,v48
s_waitcnt lgkmcnt(6)
v_mfma_f32_16x16x32_bf16 v[96:99],v[132:135],a[220:223],v[96:99]
s_mov_b32 s42,s41
ds_read_b128 v[132:135],v1 offset:6272
v_fma_f32 v88,v88,s36,v15
s_waitcnt lgkmcnt(6)
v_mfma_f32_16x16x32_bf16 v[96:99],v[136:139],a[224:227],v[96:99]
s_add_u32 s69,s69,1
ds_read_b128 v[136:139],v0 offset:6400
v_fma_f32 v89,v89,s36,v15
v_fma_f32 v90,v90,s36,v15
v_fma_f32 v91,v91,s36,v15
s_waitcnt lgkmcnt(6)
v_mfma_f32_16x16x32_bf16 v[96:99],v[140:143],a[228:231],v[96:99]
s_lshl_b32 s62,s69,5
ds_read_b128 v[140:143],v1 offset:6400
v_exp_f32 v88,v88
s_waitcnt lgkmcnt(5)
v_mfma_f32_16x16x32_bf16 v[96:99],v[112:115],a[232:235],v[96:99]
s_add_u32 s62,s62,s34
ds_read_b128 v[112:115],v0 offset:12288
v_exp_f32 v89,v89
v_mfma_f32_16x16x32_bf16 v[96:99],v[116:119],a[236:239],v[96:99]
s_mul_i32 s63,s62,171
ds_read_b128 v[116:119],v1 offset:12288
v_exp_f32 v90,v90
v_mfma_f32_16x16x32_bf16 v[100:103],v[120:123],a[216:219],0
s_lshr_b32 s63,s63,9
ds_read_b128 v[120:123],v0 offset:12416
v_exp_f32 v91,v91
s_waitcnt lgkmcnt(6)
v_mfma_f32_16x16x32_bf16 v[100:103],v[124:127],a[220:223],v[100:103]
s_mul_i32 s64,s63,3
ds_read_b128 v[124:127],v1 offset:12416
v_cvt_pk_bf16_f32 v28,v88,v89
v_mfma_f32_16x16x32_bf16 v[100:103],v[128:131],a[224:227],v[100:103]
s_sub_u32 s62,s62,s64
ds_read_b128 v[128:131],v0 offset:12544
v_cvt_pk_bf16_f32 v29,v90,v91
s_waitcnt lgkmcnt(6)
v_mfma_f32_16x16x32_bf16 v[100:103],v[132:135],a[228:231],v[100:103]
s_add_u32 s63,s63,s33
ds_read_b128 v[132:135],v1 offset:12544
v_fma_f32 v92,v92,s36,v15
v_mfma_f32_16x16x32_bf16 v[100:103],v[136:139],a[232:235],v[100:103]
s_mul_i32 s30,s63,196608
ds_read_b128 v[136:139],v0 offset:18432
v_fma_f32 v93,v93,s36,v15
v_fma_f32 v94,v94,s36,v15
s_waitcnt lgkmcnt(7)
v_mfma_f32_16x16x32_bf16 v[100:103],v[140:143],a[236:239],v[100:103]
s_waitcnt vmcnt(9)
s_barrier
s_waitcnt lgkmcnt(6)
v_mfma_f32_16x16x32_bf16 v[88:91],v[112:115],a[192:195],0
s_mul_i32 s41,s63,325632
ds_read_b128 v[140:143],v1 offset:18432
v_fma_f32 v95,v95,s36,v15
s_waitcnt lgkmcnt(6)
v_mfma_f32_16x16x32_bf16 v[88:91],v[116:119],a[196:199],v[88:91]
s_lshl_b32 s63,s3,2
ds_read_b128 v[112:115],v0 offset:18560
v_exp_f32 v92,v92
s_waitcnt lgkmcnt(6)
v_mfma_f32_16x16x32_bf16 v[88:91],v[120:123],a[200:203],v[88:91]
s_add_u32 s64,s63,21
ds_read_b128 v[116:119],v1 offset:18560
v_exp_f32 v93,v93
s_waitcnt lgkmcnt(5)
v_mfma_f32_16x16x32_bf16 v[88:91],v[124:127],a[204:207],v[88:91]
s_cmp_eq_u32 s3,0
ds_read_b128 v[120:123],v0 offset:18688
v_exp_f32 v94,v94
v_mfma_f32_16x16x32_bf16 v[88:91],v[128:131],a[208:211],v[88:91]
s_cselect_b32 s64,20,s64
ds_read_b128 v[124:127],v1 offset:18688
v_exp_f32 v95,v95
s_waitcnt lgkmcnt(5)
v_mfma_f32_16x16x32_bf16 v[88:91],v[132:135],a[212:215],v[88:91]
s_cselect_b32 s40,1,0
ds_read_b128 v[128:131],v0 offset:12288
v_cvt_pk_bf16_f32 v30,v92,v93
ds_read_b128 v[132:135],v1 offset:12288
v_cvt_pk_bf16_f32 v31,v94,v95
v_mfma_f32_16x16x32_bf16 v[92:95],v[136:139],a[192:195],0
s_add_u32 s65,s63,37
ds_read_b128 v[136:139],v0 offset:12416
v_max3_f32 v52,v96,v97,v98
v_max3_f32 v52,v52,v99,v100
s_waitcnt lgkmcnt(7)
v_mfma_f32_16x16x32_bf16 v[92:95],v[140:143],a[196:199],v[92:95]
s_cmp_eq_u32 s62,2
ds_read_b128 v[140:143],v1 offset:12416
v_max3_f32 v52,v52,v101,v102
s_waitcnt lgkmcnt(7)
v_mfma_f32_16x16x32_bf16 v[92:95],v[112:115],a[200:203],v[92:95]
s_cselect_b32 s64,s65,s64
ds_read_b128 v[112:115],v0 offset:12544
v_max_f32 v52,v52,v103
v_mov_b32 v53,v52
s_waitcnt lgkmcnt(7)
v_mfma_f32_16x16x32_bf16 v[92:95],v[116:119],a[204:207],v[92:95]
s_cselect_b32 s40,0,s40
ds_read_b128 v[116:119],v1 offset:12544
v_permlane32_swap_b32 v53,v52
s_waitcnt lgkmcnt(7)
v_mfma_f32_16x16x32_bf16 v[92:95],v[120:123],a[208:211],v[92:95]
s_add_u32 s65,s63,s3
ds_read_b128 v[120:123],v0 offset:18432
v_max_f32 v52,v52,v53
v_mov_b32 v53,v52
s_waitcnt lgkmcnt(7)
v_mfma_f32_16x16x32_bf16 v[92:95],v[124:127],a[212:215],v[92:95]
s_cmp_eq_u32 s62,0
ds_read_b128 v[124:127],v1 offset:18432
v_permlane16_swap_b32 v53,v52
v_max_f32 v52,v52,v53
v_mul_f32_e64 v16,-s36,v52
v_fma_f32 v96,v96,s36,v16
v_fma_f32 v97,v97,s36,v16
v_fma_f32 v98,v98,s36,v16
v_fma_f32 v99,v99,s36,v16
v_exp_f32 v96,v96
v_exp_f32 v97,v97
v_exp_f32 v98,v98
v_exp_f32 v99,v99
v_cvt_pk_bf16_f32 v32,v96,v97
v_cvt_pk_bf16_f32 v33,v98,v99
s_waitcnt lgkmcnt(3)
v_mfma_f32_16x16x32_bf16 v[96:99],v[128:131],a[216:219],0
s_cselect_b32 s64,s65,s64
ds_read_b128 v[128:131],v0 offset:18560
v_fma_f32 v100,v100,s36,v16
v_mfma_f32_16x16x32_bf16 v[96:99],v[132:135],a[220:223],v[96:99]
s_cselect_b32 s40,1,s40
ds_read_b128 v[132:135],v1 offset:18560
v_fma_f32 v101,v101,s36,v16
v_mfma_f32_16x16x32_bf16 v[96:99],v[136:139],a[224:227],v[96:99]
s_mul_i32 s64,s64,6144
ds_read_b128 v[136:139],v0 offset:18688
v_fma_f32 v102,v102,s36,v16
v_mfma_f32_16x16x32_bf16 v[96:99],v[140:143],a[228:231],v[96:99]
s_add_u32 s41,s41,s64
ds_read_b128 v[140:143],v1 offset:18688
v_fma_f32 v103,v103,s36,v16
v_mfma_f32_16x16x32_bf16 v[96:99],v[112:115],a[232:235],v[96:99]
s_cmp_ge_u32 s69,6
ds_read_b64_tr_b16 v[112:113],v2 offset:0
v_exp_f32 v100,v100
s_waitcnt lgkmcnt(5)
v_mfma_f32_16x16x32_bf16 v[96:99],v[116:119],a[236:239],v[96:99]
s_cselect_b32 s41,166723584,s41
ds_read_b64_tr_b16 v[114:115],v2 offset:6144
ds_read_b64_tr_b16 v[116:117],v3 offset:0
ds_read_b64_tr_b16 v[118:119],v3 offset:6144
v_exp_f32 v101,v101
v_exp_f32 v102,v102
v_exp_f32 v103,v103
v_cvt_pk_bf16_f32 v34,v100,v101
v_cvt_pk_bf16_f32 v35,v102,v103
v_mfma_f32_16x16x32_bf16 v[100:103],v[120:123],a[216:219],0
s_cselect_b32 s30,100663296,s30
ds_read_b64_tr_b16 v[120:121],v4 offset:0
v_fma_f32 v80,v80,s36,v14
v_smfmac_f32_16x16x64_bf16 v[64:67],v[152:155],v[28:35],v18
s_add_u32 s25,s30,s22
s_add_u32 s26,s25,12288
ds_read_b64_tr_b16 v[122:123],v4 offset:6144
v_mfma_f32_16x16x32_bf16 v[100:103],v[124:127],a[220:223],v[100:103]
s_mov_b32 s28,s41
ds_read_b64_tr_b16 v[124:125],v5 offset:0
v_fma_f32 v81,v81,s36,v14
s_waitcnt lgkmcnt(8)
v_mfma_f32_16x16x32_bf16 v[100:103],v[128:131],a[224:227],v[100:103]
s_mov_b32 s29,s24
ds_read_b64_tr_b16 v[126:127],v5 offset:6144
v_exp_f32 v72,v72
v_mfma_f32_16x16x32_bf16 v[100:103],v[132:135],a[228:231],v[100:103]
s_add_u32 m0,s22,0
v_exp_f32 v73,v73
v_mfma_f32_16x16x32_bf16 v[100:103],v[136:139],a[232:235],v[100:103]
buffer_load_dwordx4 v6,s[4:7],s20 offen offset:0 lds
s_waitcnt lgkmcnt(4)
v_mfma_f32_16x16x32_bf16 v[100:103],v[140:143],a[236:239],v[100:103]
buffer_load_dwordx4 v7,s[4:7],s20 offen offset:1024 lds
buffer_load_dwordx4 v8,s[4:7],s20 offen offset:2048 lds
v_exp_f32 v74,v74
v_exp_f32 v75,v75
v_exp_f32 v80,v80
v_exp_f32 v81,v81
v_cvt_pk_bf16_f32 v40,v72,v73
v_cvt_pk_bf16_f32 v41,v74,v75
v_cvt_pk_bf16_f32 v44,v80,v81
s_add_u32 s20,s20,12288
v_mfma_f32_16x16x32_bf16 v[160:163],v[112:115],v[20:23],0
s_add_u32 m0,s23,0
ds_read_b64_tr_b16 v[128:129],v2 offset:128
v_fma_f32 v82,v82,s36,v14
v_mfma_f32_16x16x32_bf16 v[164:167],v[116:119],v[20:23],0
ds_read_b64_tr_b16 v[130:131],v2 offset:6272
v_fma_f32 v83,v83,s36,v14
v_mfma_f32_16x16x32_bf16 v[212:215],v[116:119],v[24:27],0
ds_read_b64_tr_b16 v[132:133],v3 offset:128
v_fma_f32 v88,v88,s36,v15
v_mfma_f32_16x16x32_bf16 v[208:211],v[112:115],v[24:27],0
ds_read_b64_tr_b16 v[134:135],v3 offset:6272
v_fma_f32 v89,v89,s36,v15
v_mfma_f32_16x16x32_bf16 a[0:3],v[112:115],v[28:31],0
ds_read_b64_tr_b16 v[136:137],v4 offset:128
v_fma_f32 v90,v90,s36,v15
v_mfma_f32_16x16x32_bf16 a[4:7],v[116:119],v[28:31],0
ds_read_b64_tr_b16 v[138:139],v4 offset:6272
v_fma_f32 v91,v91,s36,v15
v_mfma_f32_16x16x32_bf16 a[52:55],v[116:119],v[32:35],0
ds_read_b64_tr_b16 v[140:141],v5 offset:128
v_fma_f32 v96,v96,s36,v16
v_mfma_f32_16x16x32_bf16 a[48:51],v[112:115],v[32:35],0
s_waitcnt lgkmcnt(7)
ds_read_b64_tr_b16 v[142:143],v5 offset:6272
v_fma_f32 v97,v97,s36,v16
v_mfma_f32_16x16x32_bf16 a[56:59],v[120:123],v[32:35],0
ds_read_b64_tr_b16 v[112:113],v2 offset:256
v_fma_f32 v98,v98,s36,v16
v_mfma_f32_16x16x32_bf16 a[60:63],v[124:127],v[32:35],0
ds_read_b64_tr_b16 v[114:115],v2 offset:6400
v_fma_f32 v99,v99,s36,v16
v_mfma_f32_16x16x32_bf16 a[12:15],v[124:127],v[28:31],0
ds_read_b64_tr_b16 v[116:117],v3 offset:256
v_fma_f32 v76,v76,s36,v13
v_mfma_f32_16x16x32_bf16 a[8:11],v[120:123],v[28:31],0
ds_read_b64_tr_b16 v[118:119],v3 offset:6400
v_fma_f32 v77,v77,s36,v13
v_mfma_f32_16x16x32_bf16 v[216:219],v[120:123],v[24:27],0
v_exp_f32 v82,v82
v_mfma_f32_16x16x32_bf16 v[220:223],v[124:127],v[24:27],0
v_exp_f32 v83,v83
v_mfma_f32_16x16x32_bf16 v[172:175],v[124:127],v[20:23],0
ds_read_b64_tr_b16 v[124:125],v5 offset:256
v_cvt_pk_bf16_f32 v45,v82,v83
v_mfma_f32_16x16x32_bf16 v[168:171],v[120:123],v[20:23],0
s_waitcnt lgkmcnt(5)
ds_read_b64_tr_b16 v[120:121],v4 offset:256
v_fma_f32 v78,v78,s36,v13
v_mfma_f32_16x16x32_bf16 v[176:179],v[128:131],v[20:23],0
ds_read_b64_tr_b16 v[122:123],v4 offset:6400
v_fma_f32 v79,v79,s36,v13
v_mfma_f32_16x16x32_bf16 v[180:183],v[132:135],v[20:23],0
ds_read_b64_tr_b16 v[126:127],v5 offset:6400
v_fma_f32 v84,v84,s36,v14
v_mfma_f32_16x16x32_bf16 v[228:231],v[132:135],v[24:27],0
v_exp_f32 v88,v88
v_mfma_f32_16x16x32_bf16 v[224:227],v[128:131],v[24:27],0
v_exp_f32 v89,v89
v_mfma_f32_16x16x32_bf16 a[16:19],v[128:131],v[28:31],0
v_exp_f32 v90,v90
v_mfma_f32_16x16x32_bf16 a[20:23],v[132:135],v[28:31],0
v_exp_f32 v91,v91
v_mfma_f32_16x16x32_bf16 a[68:71],v[132:135],v[32:35],0
v_cvt_pk_bf16_f32 v48,v88,v89
v_cvt_pk_bf16_f32 v49,v90,v91
v_mfma_f32_16x16x32_bf16 a[64:67],v[128:131],v[32:35],0
v_exp_f32 v96,v96
v_mfma_f32_16x16x32_bf16 a[72:75],v[136:139],v[32:35],0
v_exp_f32 v97,v97
v_mfma_f32_16x16x32_bf16 a[76:79],v[140:143],v[32:35],0
v_exp_f32 v98,v98
v_mfma_f32_16x16x32_bf16 a[28:31],v[140:143],v[28:31],0
v_exp_f32 v99,v99
v_mfma_f32_16x16x32_bf16 a[24:27],v[136:139],v[28:31],0
v_cvt_pk_bf16_f32 v52,v96,v97
v_cvt_pk_bf16_f32 v53,v98,v99
v_mfma_f32_16x16x32_bf16 v[232:235],v[136:139],v[24:27],0
v_exp_f32 v76,v76
v_mfma_f32_16x16x32_bf16 v[236:239],v[140:143],v[24:27],0
v_exp_f32 v77,v77
v_mfma_f32_16x16x32_bf16 v[188:191],v[140:143],v[20:23],0
v_exp_f32 v78,v78
v_mfma_f32_16x16x32_bf16 v[184:187],v[136:139],v[20:23],0
s_waitcnt lgkmcnt(0)
v_exp_f32 v79,v79
v_mfma_f32_16x16x32_bf16 v[192:195],v[112:115],v[20:23],0
v_cvt_pk_bf16_f32 v42,v76,v77
v_cvt_pk_bf16_f32 v43,v78,v79
s_waitcnt vmcnt(6)
v_mfma_f32_16x16x32_bf16 v[196:199],v[116:119],v[20:23],0
s_barrier
v_mfma_f32_16x16x32_bf16 v[244:247],v[116:119],v[24:27],0
ds_read_b128 v[140:143],v1 offset:24704
v_fma_f32 v85,v85,s36,v14
v_mfma_f32_16x16x32_bf16 v[240:243],v[112:115],v[24:27],0
ds_read_b128 v[136:139],v0 offset:24704
v_fma_f32 v86,v86,s36,v14
v_mfma_f32_16x16x32_bf16 a[32:35],v[112:115],v[28:31],0
ds_read_b128 v[132:135],v1 offset:24576
v_fma_f32 v87,v87,s36,v14
v_mfma_f32_16x16x32_bf16 a[36:39],v[116:119],v[28:31],0
ds_read_b128 v[128:131],v0 offset:24576
v_fma_f32 v92,v92,s36,v15
v_mfma_f32_16x16x32_bf16 a[84:87],v[116:119],v[32:35],0
ds_read_b128 v[116:119],v1 offset:24832
v_fma_f32 v93,v93,s36,v15
v_mfma_f32_16x16x32_bf16 a[80:83],v[112:115],v[32:35],0
buffer_load_dwordx4 v6,s[8:11],s21 offen offset:0 lds
v_mfma_f32_16x16x32_bf16 a[88:91],v[120:123],v[32:35],0
ds_read_b128 v[112:115],v0 offset:24832
v_fma_f32 v94,v94,s36,v15
v_mfma_f32_16x16x32_bf16 a[92:95],v[124:127],v[32:35],0
v_exp_f32 v84,v84
v_mfma_f32_16x16x32_bf16 a[44:47],v[124:127],v[28:31],0
v_exp_f32 v85,v85
v_mfma_f32_16x16x32_bf16 a[40:43],v[120:123],v[28:31],0
v_exp_f32 v86,v86
v_mfma_f32_16x16x32_bf16 v[248:251],v[120:123],v[24:27],0
v_exp_f32 v87,v87
v_mfma_f32_16x16x32_bf16 v[252:255],v[124:127],v[24:27],0
v_cvt_pk_bf16_f32 v46,v84,v85
v_cvt_pk_bf16_f32 v47,v86,v87
v_mfma_f32_16x16x32_bf16 v[204:207],v[124:127],v[20:23],0
ds_read_b128 v[124:127],v1 offset:30720
v_fma_f32 v95,v95,s36,v15
v_smfmac_f32_16x16x64_bf16 v[60:63],v[152:155],v[40:47],v18
v_fma_f32 v100,v100,s36,v16
v_mfma_f32_16x16x32_bf16 v[200:203],v[120:123],v[20:23],0
buffer_load_dwordx4 v7,s[8:11],s21 offen offset:1024 lds
s_waitcnt lgkmcnt(1)
v_mfma_f32_16x16x32_bf16 v[72:75],v[116:119],a[164:167],0
ds_read_b128 v[120:123],v0 offset:30720
v_fma_f32 v101,v101,s36,v16
v_mfma_f32_16x16x32_bf16 v[72:75],v[112:115],a[160:163],v[72:75]
v_exp_f32 v92,v92
v_mfma_f32_16x16x32_bf16 v[72:75],v[140:143],a[156:159],v[72:75]
v_exp_f32 v93,v93
v_mfma_f32_16x16x32_bf16 v[72:75],v[136:139],a[152:155],v[72:75]
v_exp_f32 v94,v94
v_mfma_f32_16x16x32_bf16 v[72:75],v[132:135],a[148:151],v[72:75]
v_exp_f32 v95,v95
v_mfma_f32_16x16x32_bf16 v[72:75],v[128:131],a[144:147],v[72:75]
v_cvt_pk_bf16_f32 v50,v92,v93
v_cvt_pk_bf16_f32 v51,v94,v95
v_mfma_f32_16x16x32_bf16 v[80:83],v[128:131],a[168:171],0
v_fma_f32 v102,v102,s36,v16
v_fma_f32 v103,v103,s36,v16
v_mfma_f32_16x16x32_bf16 v[80:83],v[132:135],a[172:175],v[80:83]
v_exp_f32 v100,v100
v_mfma_f32_16x16x32_bf16 v[80:83],v[136:139],a[176:179],v[80:83]
buffer_load_dwordx4 v8,s[8:11],s21 offen offset:2048 lds
v_mfma_f32_16x16x32_bf16 v[80:83],v[140:143],a[180:183],v[80:83]
s_add_u32 s21,s21,12288
v_exp_f32 v101,v101
v_mfma_f32_16x16x32_bf16 v[80:83],v[112:115],a[184:187],v[80:83]
s_add_u32 m0,s22,12288
v_exp_f32 v102,v102
v_mfma_f32_16x16x32_bf16 v[80:83],v[116:119],a[188:191],v[80:83]
v_exp_f32 v103,v103
v_mfma_f32_16x16x32_bf16 v[88:91],v[116:119],a[212:215],0
v_cvt_pk_bf16_f32 v54,v100,v101
v_cvt_pk_bf16_f32 v55,v102,v103
v_mfma_f32_16x16x32_bf16 v[88:91],v[112:115],a[208:211],v[88:91]
v_fma_f32 v72,v72,s36,v13
v_fma_f32 v73,v73,s36,v13
v_smfmac_f32_16x16x64_bf16 v[64:67],v[152:155],v[48:55],v18
v_fma_f32 v74,v74,s36,v13
v_mfma_f32_16x16x32_bf16 v[88:91],v[140:143],a[204:207],v[88:91]
v_fma_f32 v75,v75,s36,v13
v_fma_f32 v80,v80,s36,v14
v_mfma_f32_16x16x32_bf16 v[88:91],v[136:139],a[200:203],v[88:91]
v_fma_f32 v81,v81,s36,v14
v_mfma_f32_16x16x32_bf16 v[88:91],v[132:135],a[196:199],v[88:91]
buffer_load_dwordx4 v6,s[4:7],s20 offen offset:0 lds
v_mfma_f32_16x16x32_bf16 v[88:91],v[128:131],a[192:195],v[88:91]
v_exp_f32 v72,v72
v_mfma_f32_16x16x32_bf16 v[96:99],v[128:131],a[216:219],0
ds_read_b128 v[128:131],v0 offset:30848
v_mfma_f32_16x16x32_bf16 v[96:99],v[132:135],a[220:223],v[96:99]
ds_read_b128 v[132:135],v1 offset:30848
v_mfma_f32_16x16x32_bf16 v[96:99],v[136:139],a[224:227],v[96:99]
ds_read_b128 v[136:139],v0 offset:30976
v_mfma_f32_16x16x32_bf16 v[96:99],v[140:143],a[228:231],v[96:99]
ds_read_b128 v[140:143],v1 offset:30976
v_mfma_f32_16x16x32_bf16 v[96:99],v[112:115],a[232:235],v[96:99]
v_exp_f32 v73,v73
v_mfma_f32_16x16x32_bf16 v[96:99],v[116:119],a[236:239],v[96:99]
s_waitcnt lgkmcnt(4)
v_exp_f32 v74,v74
v_mfma_f32_16x16x32_bf16 v[76:79],v[120:123],a[144:147],0
v_exp_f32 v75,v75
v_mfma_f32_16x16x32_bf16 v[76:79],v[124:127],a[148:151],v[76:79]
buffer_load_dwordx4 v7,s[4:7],s20 offen offset:1024 lds
v_exp_f32 v80,v80
v_exp_f32 v81,v81
s_waitcnt lgkmcnt(3)
v_mfma_f32_16x16x32_bf16 v[76:79],v[128:131],a[152:155],v[76:79]
s_waitcnt lgkmcnt(2)
v_cvt_pk_bf16_f32 v20,v72,v73
v_cvt_pk_bf16_f32 v21,v74,v75
v_mfma_f32_16x16x32_bf16 v[76:79],v[132:135],a[156:159],v[76:79]
s_waitcnt lgkmcnt(1)
v_cvt_pk_bf16_f32 v24,v80,v81
v_mfma_f32_16x16x32_bf16 v[76:79],v[136:139],a[160:163],v[76:79]
s_waitcnt lgkmcnt(0)
v_mfma_f32_16x16x32_bf16 v[76:79],v[140:143],a[164:167],v[76:79]
v_mfma_f32_16x16x32_bf16 v[84:87],v[140:143],a[188:191],0
v_mfma_f32_16x16x32_bf16 v[84:87],v[136:139],a[184:187],v[84:87]
v_mfma_f32_16x16x32_bf16 v[84:87],v[132:135],a[180:183],v[84:87]
v_mfma_f32_16x16x32_bf16 v[84:87],v[128:131],a[176:179],v[84:87]
buffer_load_dwordx4 v8,s[4:7],s20 offen offset:2048 lds
v_mfma_f32_16x16x32_bf16 v[84:87],v[124:127],a[172:175],v[84:87]
s_add_u32 s20,s20,12288
ds_read_b64_tr_b16 v[112:113],v2 offset:12288
v_mfma_f32_16x16x32_bf16 v[84:87],v[120:123],a[168:171],v[84:87]
ds_read_b64_tr_b16 v[114:115],v2 offset:18432
v_mfma_f32_16x16x32_bf16 v[92:95],v[120:123],a[192:195],0
ds_read_b64_tr_b16 v[116:117],v3 offset:12288
v_mfma_f32_16x16x32_bf16 v[92:95],v[124:127],a[196:199],v[92:95]
ds_read_b64_tr_b16 v[118:119],v3 offset:18432
v_mfma_f32_16x16x32_bf16 v[92:95],v[128:131],a[200:203],v[92:95]
v_mfma_f32_16x16x32_bf16 v[92:95],v[132:135],a[204:207],v[92:95]
v_mfma_f32_16x16x32_bf16 v[92:95],v[136:139],a[208:211],v[92:95]
v_mfma_f32_16x16x32_bf16 v[92:95],v[140:143],a[212:215],v[92:95]
v_mfma_f32_16x16x32_bf16 v[100:103],v[140:143],a[236:239],0
v_mfma_f32_16x16x32_bf16 v[100:103],v[136:139],a[232:235],v[100:103]
v_mfma_f32_16x16x32_bf16 v[100:103],v[132:135],a[228:231],v[100:103]
v_mfma_f32_16x16x32_bf16 v[100:103],v[128:131],a[224:227],v[100:103]
v_mfma_f32_16x16x32_bf16 v[100:103],v[124:127],a[220:223],v[100:103]
ds_read_b64_tr_b16 v[124:125],v5 offset:12288
v_mfma_f32_16x16x32_bf16 v[100:103],v[120:123],a[216:219],v[100:103]
s_waitcnt lgkmcnt(1)
ds_read_b64_tr_b16 v[120:121],v4 offset:12288
ds_read_b64_tr_b16 v[122:123],v4 offset:18432
ds_read_b64_tr_b16 v[126:127],v5 offset:18432
v_mfma_f32_16x16x32_bf16 v[160:163],v[112:115],v[40:43],v[160:163]
s_add_u32 m0,s23,12288
ds_read_b64_tr_b16 v[128:129],v2 offset:12416
v_fma_f32 v82,v82,s36,v14
v_mfma_f32_16x16x32_bf16 v[164:167],v[116:119],v[40:43],v[164:167]
ds_read_b64_tr_b16 v[130:131],v2 offset:18560
v_fma_f32 v83,v83,s36,v14
v_mfma_f32_16x16x32_bf16 v[212:215],v[116:119],v[44:47],v[212:215]
ds_read_b64_tr_b16 v[132:133],v3 offset:12416
v_fma_f32 v88,v88,s36,v15
v_mfma_f32_16x16x32_bf16 v[208:211],v[112:115],v[44:47],v[208:211]
ds_read_b64_tr_b16 v[134:135],v3 offset:18560
v_fma_f32 v89,v89,s36,v15
v_mfma_f32_16x16x32_bf16 a[0:3],v[112:115],v[48:51],a[0:3]
ds_read_b64_tr_b16 v[136:137],v4 offset:12416
v_fma_f32 v90,v90,s36,v15
v_mfma_f32_16x16x32_bf16 a[4:7],v[116:119],v[48:51],a[4:7]
ds_read_b64_tr_b16 v[138:139],v4 offset:18560
v_fma_f32 v91,v91,s36,v15
v_mfma_f32_16x16x32_bf16 a[52:55],v[116:119],v[52:55],a[52:55]
ds_read_b64_tr_b16 v[140:141],v5 offset:12416
v_fma_f32 v96,v96,s36,v16
v_mfma_f32_16x16x32_bf16 a[48:51],v[112:115],v[52:55],a[48:51]
s_waitcnt lgkmcnt(8)
ds_read_b64_tr_b16 v[142:143],v5 offset:18560
v_fma_f32 v97,v97,s36,v16
v_mfma_f32_16x16x32_bf16 a[56:59],v[120:123],v[52:55],a[56:59]
s_waitcnt lgkmcnt(7)
ds_read_b64_tr_b16 v[112:113],v2 offset:12544
v_fma_f32 v98,v98,s36,v16
v_mfma_f32_16x16x32_bf16 a[60:63],v[124:127],v[52:55],a[60:63]
ds_read_b64_tr_b16 v[114:115],v2 offset:18688
v_fma_f32 v99,v99,s36,v16
v_mfma_f32_16x16x32_bf16 a[12:15],v[124:127],v[48:51],a[12:15]
ds_read_b64_tr_b16 v[116:117],v3 offset:12544
v_fma_f32 v76,v76,s36,v13
v_mfma_f32_16x16x32_bf16 a[8:11],v[120:123],v[48:51],a[8:11]
ds_read_b64_tr_b16 v[118:119],v3 offset:18688
v_fma_f32 v77,v77,s36,v13
v_mfma_f32_16x16x32_bf16 v[216:219],v[120:123],v[44:47],v[216:219]
v_exp_f32 v82,v82
v_mfma_f32_16x16x32_bf16 v[220:223],v[124:127],v[44:47],v[220:223]
v_exp_f32 v83,v83
v_mfma_f32_16x16x32_bf16 v[172:175],v[124:127],v[40:43],v[172:175]
ds_read_b64_tr_b16 v[124:125],v5 offset:12544
v_cvt_pk_bf16_f32 v25,v82,v83
v_mfma_f32_16x16x32_bf16 v[168:171],v[120:123],v[40:43],v[168:171]
s_waitcnt lgkmcnt(5)
ds_read_b64_tr_b16 v[120:121],v4 offset:12544
v_fma_f32 v78,v78,s36,v13
v_mfma_f32_16x16x32_bf16 v[176:179],v[128:131],v[40:43],v[176:179]
ds_read_b64_tr_b16 v[122:123],v4 offset:18688
v_fma_f32 v79,v79,s36,v13
v_mfma_f32_16x16x32_bf16 v[180:183],v[132:135],v[40:43],v[180:183]
ds_read_b64_tr_b16 v[126:127],v5 offset:18688
v_fma_f32 v84,v84,s36,v14
v_mfma_f32_16x16x32_bf16 v[228:231],v[132:135],v[44:47],v[228:231]
v_exp_f32 v88,v88
v_mfma_f32_16x16x32_bf16 v[224:227],v[128:131],v[44:47],v[224:227]
v_exp_f32 v89,v89
v_mfma_f32_16x16x32_bf16 a[16:19],v[128:131],v[48:51],a[16:19]
v_exp_f32 v90,v90
v_mfma_f32_16x16x32_bf16 a[20:23],v[132:135],v[48:51],a[20:23]
v_exp_f32 v91,v91
v_mfma_f32_16x16x32_bf16 a[68:71],v[132:135],v[52:55],a[68:71]
v_cvt_pk_bf16_f32 v28,v88,v89
v_cvt_pk_bf16_f32 v29,v90,v91
v_mfma_f32_16x16x32_bf16 a[64:67],v[128:131],v[52:55],a[64:67]
v_exp_f32 v96,v96
v_mfma_f32_16x16x32_bf16 a[72:75],v[136:139],v[52:55],a[72:75]
v_exp_f32 v97,v97
v_mfma_f32_16x16x32_bf16 a[76:79],v[140:143],v[52:55],a[76:79]
v_exp_f32 v98,v98
v_mfma_f32_16x16x32_bf16 a[28:31],v[140:143],v[48:51],a[28:31]
v_exp_f32 v99,v99
v_mfma_f32_16x16x32_bf16 a[24:27],v[136:139],v[48:51],a[24:27]
v_cvt_pk_bf16_f32 v32,v96,v97
v_cvt_pk_bf16_f32 v33,v98,v99
v_mfma_f32_16x16x32_bf16 v[232:235],v[136:139],v[44:47],v[232:235]
v_exp_f32 v76,v76
v_mfma_f32_16x16x32_bf16 v[236:239],v[140:143],v[44:47],v[236:239]
v_exp_f32 v77,v77
v_mfma_f32_16x16x32_bf16 v[188:191],v[140:143],v[40:43],v[188:191]
v_exp_f32 v78,v78
v_mfma_f32_16x16x32_bf16 v[184:187],v[136:139],v[40:43],v[184:187]
s_waitcnt lgkmcnt(0)
v_exp_f32 v79,v79
v_mfma_f32_16x16x32_bf16 v[192:195],v[112:115],v[40:43],v[192:195]
v_cvt_pk_bf16_f32 v22,v76,v77
v_cvt_pk_bf16_f32 v23,v78,v79
s_waitcnt vmcnt(6)
v_mfma_f32_16x16x32_bf16 v[196:199],v[116:119],v[40:43],v[196:199]
s_barrier
v_mfma_f32_16x16x32_bf16 v[244:247],v[116:119],v[44:47],v[244:247]
ds_read_b128 v[140:143],v1 offset:128
v_fma_f32 v85,v85,s36,v14
v_mfma_f32_16x16x32_bf16 v[240:243],v[112:115],v[44:47],v[240:243]
ds_read_b128 v[136:139],v0 offset:128
v_fma_f32 v86,v86,s36,v14
v_mfma_f32_16x16x32_bf16 a[32:35],v[112:115],v[48:51],a[32:35]
ds_read_b128 v[132:135],v1 offset:0
v_fma_f32 v87,v87,s36,v14
v_mfma_f32_16x16x32_bf16 a[36:39],v[116:119],v[48:51],a[36:39]
ds_read_b128 v[128:131],v0 offset:0
v_fma_f32 v92,v92,s36,v15
v_mfma_f32_16x16x32_bf16 a[84:87],v[116:119],v[52:55],a[84:87]
ds_read_b128 v[116:119],v1 offset:256
v_fma_f32 v93,v93,s36,v15
v_mfma_f32_16x16x32_bf16 a[80:83],v[112:115],v[52:55],a[80:83]
buffer_load_dwordx4 v6,s[8:11],s21 offen offset:0 lds
v_mfma_f32_16x16x32_bf16 a[88:91],v[120:123],v[52:55],a[88:91]
ds_read_b128 v[112:115],v0 offset:256
v_fma_f32 v94,v94,s36,v15
v_mfma_f32_16x16x32_bf16 a[92:95],v[124:127],v[52:55],a[92:95]
v_exp_f32 v84,v84
v_mfma_f32_16x16x32_bf16 a[44:47],v[124:127],v[48:51],a[44:47]
v_exp_f32 v85,v85
v_mfma_f32_16x16x32_bf16 a[40:43],v[120:123],v[48:51],a[40:43]
v_exp_f32 v86,v86
v_mfma_f32_16x16x32_bf16 v[248:251],v[120:123],v[44:47],v[248:251]
v_exp_f32 v87,v87
v_mfma_f32_16x16x32_bf16 v[252:255],v[124:127],v[44:47],v[252:255]
v_cvt_pk_bf16_f32 v26,v84,v85
v_cvt_pk_bf16_f32 v27,v86,v87
v_mfma_f32_16x16x32_bf16 v[204:207],v[124:127],v[40:43],v[204:207]
ds_read_b128 v[124:127],v1 offset:6144
v_fma_f32 v95,v95,s36,v15
v_smfmac_f32_16x16x64_bf16 v[60:63],v[152:155],v[20:27],v18
v_fma_f32 v100,v100,s36,v16
v_mfma_f32_16x16x32_bf16 v[200:203],v[120:123],v[40:43],v[200:203]
buffer_load_dwordx4 v7,s[8:11],s21 offen offset:1024 lds
s_waitcnt lgkmcnt(1)
v_mfma_f32_16x16x32_bf16 v[72:75],v[116:119],a[164:167],0
ds_read_b128 v[120:123],v0 offset:6144
v_fma_f32 v101,v101,s36,v16
v_mfma_f32_16x16x32_bf16 v[72:75],v[112:115],a[160:163],v[72:75]
v_exp_f32 v92,v92
v_mfma_f32_16x16x32_bf16 v[72:75],v[140:143],a[156:159],v[72:75]
v_exp_f32 v93,v93
v_mfma_f32_16x16x32_bf16 v[72:75],v[136:139],a[152:155],v[72:75]
v_exp_f32 v94,v94
v_mfma_f32_16x16x32_bf16 v[72:75],v[132:135],a[148:151],v[72:75]
v_exp_f32 v95,v95
v_mfma_f32_16x16x32_bf16 v[72:75],v[128:131],a[144:147],v[72:75]
v_cvt_pk_bf16_f32 v30,v92,v93
v_cvt_pk_bf16_f32 v31,v94,v95
v_mfma_f32_16x16x32_bf16 v[80:83],v[128:131],a[168:171],0
v_fma_f32 v102,v102,s36,v16
v_fma_f32 v103,v103,s36,v16
v_mfma_f32_16x16x32_bf16 v[80:83],v[132:135],a[172:175],v[80:83]
v_exp_f32 v100,v100
v_mfma_f32_16x16x32_bf16 v[80:83],v[136:139],a[176:179],v[80:83]
buffer_load_dwordx4 v8,s[8:11],s21 offen offset:2048 lds
v_mfma_f32_16x16x32_bf16 v[80:83],v[140:143],a[180:183],v[80:83]
s_add_u32 s21,s21,12288
v_exp_f32 v101,v101
v_mfma_f32_16x16x32_bf16 v[80:83],v[112:115],a[184:187],v[80:83]
s_add_u32 m0,s22,24576
v_exp_f32 v102,v102
v_mfma_f32_16x16x32_bf16 v[80:83],v[116:119],a[188:191],v[80:83]
v_exp_f32 v103,v103
v_mfma_f32_16x16x32_bf16 v[88:91],v[116:119],a[212:215],0
v_cvt_pk_bf16_f32 v34,v100,v101
v_cvt_pk_bf16_f32 v35,v102,v103
v_mfma_f32_16x16x32_bf16 v[88:91],v[112:115],a[208:211],v[88:91]
v_fma_f32 v72,v72,s36,v13
v_fma_f32 v73,v73,s36,v13
v_smfmac_f32_16x16x64_bf16 v[64:67],v[152:155],v[28:35],v18
v_fma_f32 v74,v74,s36,v13
v_mfma_f32_16x16x32_bf16 v[88:91],v[140:143],a[204:207],v[88:91]
v_fma_f32 v75,v75,s36,v13
v_fma_f32 v80,v80,s36,v14
v_mfma_f32_16x16x32_bf16 v[88:91],v[136:139],a[200:203],v[88:91]
v_fma_f32 v81,v81,s36,v14
v_mfma_f32_16x16x32_bf16 v[88:91],v[132:135],a[196:199],v[88:91]
buffer_load_dwordx4 v6,s[4:7],s20 offen offset:0 lds
v_mfma_f32_16x16x32_bf16 v[88:91],v[128:131],a[192:195],v[88:91]
v_exp_f32 v72,v72
v_mfma_f32_16x16x32_bf16 v[96:99],v[128:131],a[216:219],0
ds_read_b128 v[128:131],v0 offset:6272
v_mfma_f32_16x16x32_bf16 v[96:99],v[132:135],a[220:223],v[96:99]
ds_read_b128 v[132:135],v1 offset:6272
v_mfma_f32_16x16x32_bf16 v[96:99],v[136:139],a[224:227],v[96:99]
ds_read_b128 v[136:139],v0 offset:6400
v_mfma_f32_16x16x32_bf16 v[96:99],v[140:143],a[228:231],v[96:99]
ds_read_b128 v[140:143],v1 offset:6400
v_mfma_f32_16x16x32_bf16 v[96:99],v[112:115],a[232:235],v[96:99]
v_exp_f32 v73,v73
v_mfma_f32_16x16x32_bf16 v[96:99],v[116:119],a[236:239],v[96:99]
s_waitcnt lgkmcnt(4)
v_exp_f32 v74,v74
v_mfma_f32_16x16x32_bf16 v[76:79],v[120:123],a[144:147],0
v_exp_f32 v75,v75
v_mfma_f32_16x16x32_bf16 v[76:79],v[124:127],a[148:151],v[76:79]
buffer_load_dwordx4 v7,s[4:7],s20 offen offset:1024 lds
v_exp_f32 v80,v80
v_exp_f32 v81,v81
s_waitcnt lgkmcnt(3)
v_mfma_f32_16x16x32_bf16 v[76:79],v[128:131],a[152:155],v[76:79]
s_waitcnt lgkmcnt(2)
v_cvt_pk_bf16_f32 v40,v72,v73
v_cvt_pk_bf16_f32 v41,v74,v75
v_mfma_f32_16x16x32_bf16 v[76:79],v[132:135],a[156:159],v[76:79]
s_waitcnt lgkmcnt(1)
v_cvt_pk_bf16_f32 v44,v80,v81
v_mfma_f32_16x16x32_bf16 v[76:79],v[136:139],a[160:163],v[76:79]
s_waitcnt lgkmcnt(0)
v_mfma_f32_16x16x32_bf16 v[76:79],v[140:143],a[164:167],v[76:79]
v_mfma_f32_16x16x32_bf16 v[84:87],v[140:143],a[188:191],0
v_mfma_f32_16x16x32_bf16 v[84:87],v[136:139],a[184:187],v[84:87]
v_mfma_f32_16x16x32_bf16 v[84:87],v[132:135],a[180:183],v[84:87]
v_mfma_f32_16x16x32_bf16 v[84:87],v[128:131],a[176:179],v[84:87]
buffer_load_dwordx4 v8,s[4:7],s20 offen offset:2048 lds
v_mfma_f32_16x16x32_bf16 v[84:87],v[124:127],a[172:175],v[84:87]
s_add_u32 s20,s20,12288
ds_read_b64_tr_b16 v[112:113],v2 offset:24576
v_mfma_f32_16x16x32_bf16 v[84:87],v[120:123],a[168:171],v[84:87]
ds_read_b64_tr_b16 v[114:115],v2 offset:30720
v_mfma_f32_16x16x32_bf16 v[92:95],v[120:123],a[192:195],0
ds_read_b64_tr_b16 v[116:117],v3 offset:24576
v_mfma_f32_16x16x32_bf16 v[92:95],v[124:127],a[196:199],v[92:95]
ds_read_b64_tr_b16 v[118:119],v3 offset:30720
v_mfma_f32_16x16x32_bf16 v[92:95],v[128:131],a[200:203],v[92:95]
v_mfma_f32_16x16x32_bf16 v[92:95],v[132:135],a[204:207],v[92:95]
v_mfma_f32_16x16x32_bf16 v[92:95],v[136:139],a[208:211],v[92:95]
v_mfma_f32_16x16x32_bf16 v[92:95],v[140:143],a[212:215],v[92:95]
v_mfma_f32_16x16x32_bf16 v[100:103],v[140:143],a[236:239],0
v_mfma_f32_16x16x32_bf16 v[100:103],v[136:139],a[232:235],v[100:103]
v_mfma_f32_16x16x32_bf16 v[100:103],v[132:135],a[228:231],v[100:103]
v_mfma_f32_16x16x32_bf16 v[100:103],v[128:131],a[224:227],v[100:103]
v_mfma_f32_16x16x32_bf16 v[100:103],v[124:127],a[220:223],v[100:103]
ds_read_b64_tr_b16 v[124:125],v5 offset:24576
v_mfma_f32_16x16x32_bf16 v[100:103],v[120:123],a[216:219],v[100:103]
ds_read_b64_tr_b16 v[120:121],v4 offset:24576
ds_read_b64_tr_b16 v[122:123],v4 offset:30720
ds_read_b64_tr_b16 v[126:127],v5 offset:30720
s_mov_b32 s38,0
s_branch L_loop4
L_loop5:
.p2align 6
L_loop5w0:
s_waitcnt lgkmcnt(4)
v_mfma_f32_16x16x32_bf16 v[160:163],v[112:115],v[20:23],v[160:163]
s_add_u32 m0,s23,24576
ds_read_b64_tr_b16 v[128:129],v2 offset:24704
v_fma_f32 v90,v90,s36,v15
v_mfma_f32_16x16x32_bf16 v[164:167],v[116:119],v[20:23],v[164:167]
ds_read_b64_tr_b16 v[130:131],v2 offset:30848
v_fma_f32 v91,v91,s36,v15
v_mfma_f32_16x16x32_bf16 v[212:215],v[116:119],v[24:27],v[212:215]
ds_read_b64_tr_b16 v[132:133],v3 offset:24704
v_fma_f32 v96,v96,s36,v16
v_mfma_f32_16x16x32_bf16 v[208:211],v[112:115],v[24:27],v[208:211]
ds_read_b64_tr_b16 v[134:135],v3 offset:30848
v_fma_f32 v97,v97,s36,v16
v_mfma_f32_16x16x32_bf16 a[0:3],v[112:115],v[28:31],a[0:3]
ds_read_b64_tr_b16 v[136:137],v4 offset:24704
v_fma_f32 v98,v98,s36,v16
v_mfma_f32_16x16x32_bf16 a[4:7],v[116:119],v[28:31],a[4:7]
ds_read_b64_tr_b16 v[138:139],v4 offset:30848
v_fma_f32 v99,v99,s36,v16
v_mfma_f32_16x16x32_bf16 a[52:55],v[116:119],v[32:35],a[52:55]
ds_read_b64_tr_b16 v[140:141],v5 offset:24704
v_fma_f32 v104,v104,s36,v17
v_mfma_f32_16x16x32_bf16 a[48:51],v[112:115],v[32:35],a[48:51]
ds_read_b64_tr_b16 v[142:143],v5 offset:30848
v_fma_f32 v105,v105,s36,v17
v_mfma_f32_16x16x32_bf16 a[96:99],v[112:115],v[36:39],a[96:99]
ds_read_b64_tr_b16 v[112:113],v2 offset:24832
v_fma_f32 v106,v106,s36,v17
v_mfma_f32_16x16x32_bf16 a[100:103],v[116:119],v[36:39],a[100:103]
s_waitcnt lgkmcnt(8)
ds_read_b64_tr_b16 v[114:115],v2 offset:30976
v_fma_f32 v107,v107,s36,v17
v_mfma_f32_16x16x32_bf16 a[104:107],v[120:123],v[36:39],a[104:107]
ds_read_b64_tr_b16 v[116:117],v3 offset:24832
v_fma_f32 v76,v76,s36,v13
v_mfma_f32_16x16x32_bf16 a[108:111],v[124:127],v[36:39],a[108:111]
ds_read_b64_tr_b16 v[118:119],v3 offset:30976
v_fma_f32 v77,v77,s36,v13
v_mfma_f32_16x16x32_bf16 a[60:63],v[124:127],v[32:35],a[60:63]
v_exp_f32 v90,v90
v_mfma_f32_16x16x32_bf16 a[56:59],v[120:123],v[32:35],a[56:59]
v_exp_f32 v91,v91
v_mfma_f32_16x16x32_bf16 a[8:11],v[120:123],v[28:31],a[8:11]
v_cvt_pk_bf16_f32 v49,v90,v91
v_fma_f32 v78,v78,s36,v13
v_mfma_f32_16x16x32_bf16 a[12:15],v[124:127],v[28:31],a[12:15]
v_exp_f32 v96,v96
v_mfma_f32_16x16x32_bf16 v[220:223],v[124:127],v[24:27],v[220:223]
v_exp_f32 v97,v97
v_mfma_f32_16x16x32_bf16 v[216:219],v[120:123],v[24:27],v[216:219]
v_exp_f32 v98,v98
v_mfma_f32_16x16x32_bf16 v[168:171],v[120:123],v[20:23],v[168:171]
ds_read_b64_tr_b16 v[120:121],v4 offset:24832
v_cvt_pk_bf16_f32 v52,v96,v97
v_mfma_f32_16x16x32_bf16 v[172:175],v[124:127],v[20:23],v[172:175]
s_waitcnt lgkmcnt(2)
ds_read_b64_tr_b16 v[122:123],v4 offset:30976
v_fma_f32 v79,v79,s36,v13
v_mfma_f32_16x16x32_bf16 v[176:179],v[128:131],v[20:23],v[176:179]
ds_read_b64_tr_b16 v[124:125],v5 offset:24832
v_fma_f32 v84,v84,s36,v14
v_mfma_f32_16x16x32_bf16 v[180:183],v[132:135],v[20:23],v[180:183]
ds_read_b64_tr_b16 v[126:127],v5 offset:30976
v_fma_f32 v85,v85,s36,v14
v_mfma_f32_16x16x32_bf16 v[228:231],v[132:135],v[24:27],v[228:231]
v_exp_f32 v99,v99
v_mfma_f32_16x16x32_bf16 v[224:227],v[128:131],v[24:27],v[224:227]
v_cvt_pk_bf16_f32 v53,v98,v99
v_fma_f32 v86,v86,s36,v14
v_mfma_f32_16x16x32_bf16 a[16:19],v[128:131],v[28:31],a[16:19]
v_exp_f32 v104,v104
v_mfma_f32_16x16x32_bf16 a[20:23],v[132:135],v[28:31],a[20:23]
v_exp_f32 v105,v105
v_mfma_f32_16x16x32_bf16 a[68:71],v[132:135],v[32:35],a[68:71]
v_exp_f32 v106,v106
v_mfma_f32_16x16x32_bf16 a[64:67],v[128:131],v[32:35],a[64:67]
v_exp_f32 v107,v107
v_mfma_f32_16x16x32_bf16 a[112:115],v[128:131],v[36:39],a[112:115]
v_cvt_pk_bf16_f32 v56,v104,v105
v_cvt_pk_bf16_f32 v57,v106,v107
v_mfma_f32_16x16x32_bf16 a[116:119],v[132:135],v[36:39],a[116:119]
v_exp_f32 v76,v76
v_mfma_f32_16x16x32_bf16 a[120:123],v[136:139],v[36:39],a[120:123]
v_exp_f32 v77,v77
v_mfma_f32_16x16x32_bf16 a[124:127],v[140:143],v[36:39],a[124:127]
v_exp_f32 v78,v78
v_mfma_f32_16x16x32_bf16 a[76:79],v[140:143],v[32:35],a[76:79]
v_exp_f32 v79,v79
v_mfma_f32_16x16x32_bf16 a[72:75],v[136:139],v[32:35],a[72:75]
v_cvt_pk_bf16_f32 v42,v76,v77
v_cvt_pk_bf16_f32 v43,v78,v79
v_mfma_f32_16x16x32_bf16 a[24:27],v[136:139],v[28:31],a[24:27]
v_fma_f32 v87,v87,s36,v14
v_fma_f32 v92,v92,s36,v15
v_mfma_f32_16x16x32_bf16 a[28:31],v[140:143],v[28:31],a[28:31]
v_exp_f32 v84,v84
v_mfma_f32_16x16x32_bf16 v[236:239],v[140:143],v[24:27],v[236:239]
v_exp_f32 v85,v85
v_mfma_f32_16x16x32_bf16 v[232:235],v[136:139],v[24:27],v[232:235]
v_exp_f32 v86,v86
v_mfma_f32_16x16x32_bf16 v[184:187],v[136:139],v[20:23],v[184:187]
v_exp_f32 v87,v87
v_mfma_f32_16x16x32_bf16 v[188:191],v[140:143],v[20:23],v[188:191]
v_cvt_pk_bf16_f32 v46,v84,v85
v_cvt_pk_bf16_f32 v47,v86,v87
v_mfma_f32_16x16x32_bf16 v[192:195],v[112:115],v[20:23],v[192:195]
v_fma_f32 v93,v93,s36,v15
v_fma_f32 v94,v94,s36,v15
v_smfmac_f32_16x16x64_bf16 v[60:63],v[152:155],v[40:47],v18
v_fma_f32 v95,v95,s36,v15
s_waitcnt vmcnt(6)
s_waitcnt lgkmcnt(0)
v_mfma_f32_16x16x32_bf16 v[196:199],v[116:119],v[20:23],v[196:199]
s_barrier
v_mfma_f32_16x16x32_bf16 v[244:247],v[116:119],v[24:27],v[244:247]
ds_read_b128 v[128:131],v0 offset:12288
v_fma_f32 v100,v100,s36,v16
v_mfma_f32_16x16x32_bf16 v[240:243],v[112:115],v[24:27],v[240:243]
ds_read_b128 v[132:135],v1 offset:12288
v_fma_f32 v101,v101,s36,v16
v_mfma_f32_16x16x32_bf16 a[32:35],v[112:115],v[28:31],a[32:35]
ds_read_b128 v[136:139],v0 offset:12416
v_fma_f32 v102,v102,s36,v16
v_mfma_f32_16x16x32_bf16 a[36:39],v[116:119],v[28:31],a[36:39]
ds_read_b128 v[140:143],v1 offset:12416
v_fma_f32 v103,v103,s36,v16
v_mfma_f32_16x16x32_bf16 a[84:87],v[116:119],v[32:35],a[84:87]
ds_read_b128 v[156:159],v10 offset:0
v_fma_f32 v108,v108,s36,v17
v_mfma_f32_16x16x32_bf16 a[80:83],v[112:115],v[32:35],a[80:83]
buffer_load_dwordx4 v6,s[8:11],s21 offen offset:0 lds
v_mfma_f32_16x16x32_bf16 a[128:131],v[112:115],v[36:39],a[128:131]
ds_read_b128 v[112:115],v0 offset:12544
v_fma_f32 v109,v109,s36,v17
v_mfma_f32_16x16x32_bf16 a[132:135],v[116:119],v[36:39],a[132:135]
ds_read_b128 v[116:119],v1 offset:12544
v_fma_f32 v110,v110,s36,v17
v_mfma_f32_16x16x32_bf16 a[136:139],v[120:123],v[36:39],a[136:139]
v_exp_f32 v92,v92
v_mfma_f32_16x16x32_bf16 a[140:143],v[124:127],v[36:39],a[140:143]
v_exp_f32 v93,v93
v_mfma_f32_16x16x32_bf16 a[92:95],v[124:127],v[32:35],a[92:95]
v_exp_f32 v94,v94
v_mfma_f32_16x16x32_bf16 a[88:91],v[120:123],v[32:35],a[88:91]
v_exp_f32 v95,v95
v_mfma_f32_16x16x32_bf16 a[40:43],v[120:123],v[28:31],a[40:43]
v_cvt_pk_bf16_f32 v50,v92,v93
v_cvt_pk_bf16_f32 v51,v94,v95
v_mfma_f32_16x16x32_bf16 a[44:47],v[124:127],v[28:31],a[44:47]
v_exp_f32 v100,v100
v_mfma_f32_16x16x32_bf16 v[252:255],v[124:127],v[24:27],v[252:255]
v_exp_f32 v101,v101
v_mfma_f32_16x16x32_bf16 v[248:251],v[120:123],v[24:27],v[248:251]
v_exp_f32 v102,v102
v_mfma_f32_16x16x32_bf16 v[200:203],v[120:123],v[20:23],v[200:203]
ds_read_b128 v[120:123],v0 offset:18432
v_cvt_pk_bf16_f32 v54,v100,v101
v_mfma_f32_16x16x32_bf16 v[204:207],v[124:127],v[20:23],v[204:207]
s_waitcnt lgkmcnt(1)
buffer_store_dwordx4 v[156:159],v9,s[16:19],s27 offen offset:0 nt
buffer_load_dwordx4 v7,s[8:11],s21 offen offset:1024 lds
v_mfma_f32_16x16x32_bf16 v[72:75],v[128:131],a[144:147],0
ds_read_b128 v[124:127],v1 offset:18432
v_fma_f32 v111,v111,s36,v17
v_mfma_f32_16x16x32_bf16 v[72:75],v[132:135],a[148:151],v[72:75]
v_exp_f32 v103,v103
v_mfma_f32_16x16x32_bf16 v[72:75],v[136:139],a[152:155],v[72:75]
v_cvt_pk_bf16_f32 v55,v102,v103
v_mfma_f32_16x16x32_bf16 v[72:75],v[140:143],a[156:159],v[72:75]
v_exp_f32 v108,v108
v_smfmac_f32_16x16x64_bf16 v[64:67],v[152:155],v[48:55],v18
v_mfma_f32_16x16x32_bf16 v[72:75],v[112:115],a[160:163],v[72:75]
ds_read_b128 v[156:159],v10 offset:1024
v_mfma_f32_16x16x32_bf16 v[72:75],v[116:119],a[164:167],v[72:75]
v_exp_f32 v109,v109
v_mfma_f32_16x16x32_bf16 v[80:83],v[116:119],a[188:191],0
v_exp_f32 v110,v110
v_mfma_f32_16x16x32_bf16 v[80:83],v[112:115],a[184:187],v[80:83]
v_exp_f32 v111,v111
v_mfma_f32_16x16x32_bf16 v[80:83],v[140:143],a[180:183],v[80:83]
buffer_load_dwordx4 v8,s[8:11],s21 offen offset:2048 lds
v_mfma_f32_16x16x32_bf16 v[80:83],v[136:139],a[176:179],v[80:83]
s_add_u32 s21,s21,12288
v_cvt_pk_bf16_f32 v58,v108,v109
v_cvt_pk_bf16_f32 v59,v110,v111
v_mfma_f32_16x16x32_bf16 v[80:83],v[132:135],a[172:175],v[80:83]
s_add_u32 m0,s22,0
v_fma_f32 v72,v72,s36,v13
v_fma_f32 v73,v73,s36,v13
v_smfmac_f32_16x16x64_bf16 v[68:71],v[152:155],v[52:59],v18
v_fma_f32 v74,v74,s36,v13
v_mfma_f32_16x16x32_bf16 v[80:83],v[128:131],a[168:171],v[80:83]
v_fma_f32 v75,v75,s36,v13
v_mfma_f32_16x16x32_bf16 v[88:91],v[128:131],a[192:195],0
v_exp_f32 v72,v72
v_mfma_f32_16x16x32_bf16 v[88:91],v[132:135],a[196:199],v[88:91]
v_exp_f32 v73,v73
v_mfma_f32_16x16x32_bf16 v[88:91],v[136:139],a[200:203],v[88:91]
v_exp_f32 v74,v74
v_mfma_f32_16x16x32_bf16 v[88:91],v[140:143],a[204:207],v[88:91]
v_fma_f32 v80,v80,s36,v14
v_fma_f32 v81,v81,s36,v14
v_mfma_f32_16x16x32_bf16 v[88:91],v[112:115],a[208:211],v[88:91]
v_fma_f32 v82,v82,s36,v14
v_fma_f32 v83,v83,s36,v14
v_mfma_f32_16x16x32_bf16 v[88:91],v[116:119],a[212:215],v[88:91]
v_exp_f32 v75,v75
v_mfma_f32_16x16x32_bf16 v[96:99],v[116:119],a[236:239],0
v_exp_f32 v80,v80
v_mfma_f32_16x16x32_bf16 v[96:99],v[112:115],a[232:235],v[96:99]
s_waitcnt lgkmcnt(0)
buffer_store_dwordx4 v[156:159],v9,s[16:19],s27 offen offset:128 nt
buffer_load_dwordx4 v6,s[4:7],s20 offen offset:0 lds
v_mfma_f32_16x16x32_bf16 v[96:99],v[140:143],a[228:231],v[96:99]
v_exp_f32 v81,v81
v_mfma_f32_16x16x32_bf16 v[96:99],v[136:139],a[224:227],v[96:99]
v_fma_f32 v88,v88,s36,v15
v_fma_f32 v89,v89,s36,v15
v_mfma_f32_16x16x32_bf16 v[96:99],v[132:135],a[220:223],v[96:99]
v_exp_f32 v82,v82
v_mfma_f32_16x16x32_bf16 v[96:99],v[128:131],a[216:219],v[96:99]
v_exp_f32 v83,v83
v_mfma_f32_16x16x32_bf16 v[104:107],v[128:131],a[240:243],0
ds_read_b128 v[128:131],v0 offset:18560
v_cvt_pk_bf16_f32 v20,v72,v73
v_mfma_f32_16x16x32_bf16 v[104:107],v[132:135],a[244:247],v[104:107]
ds_read_b128 v[156:159],v10 offset:2048
v_cvt_pk_bf16_f32 v21,v74,v75
v_mfma_f32_16x16x32_bf16 v[104:107],v[136:139],a[248:251],v[104:107]
ds_read_b128 v[132:135],v1 offset:18560
v_cvt_pk_bf16_f32 v24,v80,v81
v_mfma_f32_16x16x32_bf16 v[104:107],v[140:143],a[252:255],v[104:107]
ds_read_b128 v[136:139],v0 offset:18688
v_cvt_pk_bf16_f32 v25,v82,v83
v_mfma_f32_16x16x32_bf16 v[104:107],v[112:115],v[144:147],v[104:107]
ds_read_b128 v[140:143],v1 offset:18688
v_mfma_f32_16x16x32_bf16 v[104:107],v[116:119],v[148:151],v[104:107]
buffer_load_dwordx4 v7,s[4:7],s20 offen offset:1024 lds
v_mfma_f32_16x16x32_bf16 v[76:79],v[120:123],a[144:147],0
v_exp_f32 v88,v88
v_mfma_f32_16x16x32_bf16 v[76:79],v[124:127],a[148:151],v[76:79]
s_waitcnt lgkmcnt(4)
v_exp_f32 v89,v89
v_mfma_f32_16x16x32_bf16 v[76:79],v[128:131],a[152:155],v[76:79]
s_waitcnt lgkmcnt(2)
v_cvt_pk_bf16_f32 v28,v88,v89
v_mfma_f32_16x16x32_bf16 v[76:79],v[132:135],a[156:159],v[76:79]
s_waitcnt lgkmcnt(1)
v_mfma_f32_16x16x32_bf16 v[76:79],v[136:139],a[160:163],v[76:79]
s_waitcnt lgkmcnt(0)
v_mfma_f32_16x16x32_bf16 v[76:79],v[140:143],a[164:167],v[76:79]
v_mfma_f32_16x16x32_bf16 v[84:87],v[140:143],a[188:191],0
v_mfma_f32_16x16x32_bf16 v[84:87],v[136:139],a[184:187],v[84:87]
v_mfma_f32_16x16x32_bf16 v[84:87],v[132:135],a[180:183],v[84:87]
v_mfma_f32_16x16x32_bf16 v[84:87],v[128:131],a[176:179],v[84:87]
buffer_store_dwordx4 v[156:159],v9,s[16:19],s27 offen offset:256 nt
buffer_load_dwordx4 v8,s[4:7],s20 offen offset:2048 lds
v_mfma_f32_16x16x32_bf16 v[84:87],v[124:127],a[172:175],v[84:87]
s_add_u32 s20,s20,12288
v_mfma_f32_16x16x32_bf16 v[84:87],v[120:123],a[168:171],v[84:87]
s_add_u32 s27,s27,3072
v_mfma_f32_16x16x32_bf16 v[92:95],v[120:123],a[192:195],0
v_mfma_f32_16x16x32_bf16 v[92:95],v[124:127],a[196:199],v[92:95]
v_mfma_f32_16x16x32_bf16 v[92:95],v[128:131],a[200:203],v[92:95]
ds_read_b64_tr_b16 v[112:113],v2 offset:0
v_mfma_f32_16x16x32_bf16 v[92:95],v[132:135],a[204:207],v[92:95]
ds_read_b64_tr_b16 v[114:115],v2 offset:6144
v_mfma_f32_16x16x32_bf16 v[92:95],v[136:139],a[208:211],v[92:95]
ds_read_b64_tr_b16 v[116:117],v3 offset:0
v_mfma_f32_16x16x32_bf16 v[92:95],v[140:143],a[212:215],v[92:95]
ds_read_b64_tr_b16 v[118:119],v3 offset:6144
v_mfma_f32_16x16x32_bf16 v[100:103],v[140:143],a[236:239],0
v_mfma_f32_16x16x32_bf16 v[100:103],v[136:139],a[232:235],v[100:103]
v_mfma_f32_16x16x32_bf16 v[100:103],v[132:135],a[228:231],v[100:103]
v_mfma_f32_16x16x32_bf16 v[100:103],v[128:131],a[224:227],v[100:103]
v_mfma_f32_16x16x32_bf16 v[100:103],v[124:127],a[220:223],v[100:103]
v_mfma_f32_16x16x32_bf16 v[100:103],v[120:123],a[216:219],v[100:103]
v_mfma_f32_16x16x32_bf16 v[108:111],v[120:123],a[240:243],0
ds_read_b64_tr_b16 v[120:121],v4 offset:0
v_mfma_f32_16x16x32_bf16 v[108:111],v[124:127],a[244:247],v[108:111]
ds_read_b64_tr_b16 v[122:123],v4 offset:6144
v_mfma_f32_16x16x32_bf16 v[108:111],v[128:131],a[248:251],v[108:111]
ds_read_b64_tr_b16 v[124:125],v5 offset:0
v_mfma_f32_16x16x32_bf16 v[108:111],v[132:135],a[252:255],v[108:111]
ds_read_b64_tr_b16 v[126:127],v5 offset:6144
v_mfma_f32_16x16x32_bf16 v[108:111],v[136:139],v[144:147],v[108:111]
v_mfma_f32_16x16x32_bf16 v[108:111],v[140:143],v[148:151],v[108:111]
s_waitcnt lgkmcnt(4)
v_mfma_f32_16x16x32_bf16 v[160:163],v[112:115],v[40:43],v[160:163]
s_add_u32 m0,s29,0
ds_read_b64_tr_b16 v[130:131],v2 offset:6272
v_fma_f32 v91,v91,s36,v15
v_mfma_f32_16x16x32_bf16 v[164:167],v[116:119],v[40:43],v[164:167]
ds_read_b64_tr_b16 v[128:129],v2 offset:128
v_fma_f32 v90,v90,s36,v15
v_mfma_f32_16x16x32_bf16 v[212:215],v[116:119],v[44:47],v[212:215]
ds_read_b64_tr_b16 v[132:133],v3 offset:128
v_fma_f32 v99,v99,s36,v16
v_mfma_f32_16x16x32_bf16 v[208:211],v[112:115],v[44:47],v[208:211]
ds_read_b64_tr_b16 v[134:135],v3 offset:6272
v_fma_f32 v97,v97,s36,v16
v_mfma_f32_16x16x32_bf16 a[0:3],v[112:115],v[48:51],a[0:3]
ds_read_b64_tr_b16 v[138:139],v4 offset:6272
v_fma_f32 v96,v96,s36,v16
v_mfma_f32_16x16x32_bf16 a[4:7],v[116:119],v[48:51],a[4:7]
ds_read_b64_tr_b16 v[136:137],v4 offset:128
v_fma_f32 v98,v98,s36,v16
v_mfma_f32_16x16x32_bf16 a[52:55],v[116:119],v[52:55],a[52:55]
ds_read_b64_tr_b16 v[142:143],v5 offset:6272
v_fma_f32 v104,v104,s36,v17
v_mfma_f32_16x16x32_bf16 a[48:51],v[112:115],v[52:55],a[48:51]
buffer_load_dwordx4 v6,s[12:15],s28 offen offset:0 nt lds
v_mfma_f32_16x16x32_bf16 a[96:99],v[112:115],v[56:59],a[96:99]
ds_read_b64_tr_b16 v[140:141],v5 offset:128
v_fma_f32 v107,v107,s36,v17
v_mfma_f32_16x16x32_bf16 a[100:103],v[116:119],v[56:59],a[100:103]
s_waitcnt lgkmcnt(6)
ds_read_b64_tr_b16 v[112:113],v2 offset:256
v_fma_f32 v106,v106,s36,v17
v_mfma_f32_16x16x32_bf16 a[104:107],v[120:123],v[56:59],a[104:107]
ds_read_b64_tr_b16 v[116:117],v3 offset:256
v_fma_f32 v105,v105,s36,v17
v_mfma_f32_16x16x32_bf16 a[108:111],v[124:127],v[56:59],a[108:111]
ds_read_b64_tr_b16 v[114:115],v2 offset:6400
v_fma_f32 v79,v79,s36,v13
v_mfma_f32_16x16x32_bf16 a[60:63],v[124:127],v[52:55],a[60:63]
ds_read_b64_tr_b16 v[118:119],v3 offset:6400
v_fma_f32 v77,v77,s36,v13
v_mfma_f32_16x16x32_bf16 a[56:59],v[120:123],v[52:55],a[56:59]
v_exp_f32 v90,v90
v_mfma_f32_16x16x32_bf16 a[8:11],v[120:123],v[48:51],a[8:11]
v_exp_f32 v91,v91
v_mfma_f32_16x16x32_bf16 a[12:15],v[124:127],v[48:51],a[12:15]
v_cvt_pk_bf16_f32 v29,v90,v91
v_fma_f32 v76,v76,s36,v13
v_mfma_f32_16x16x32_bf16 v[220:223],v[124:127],v[44:47],v[220:223]
v_exp_f32 v98,v98
v_mfma_f32_16x16x32_bf16 v[216:219],v[120:123],v[44:47],v[216:219]
buffer_load_dwordx4 v7,s[12:15],s28 offen offset:1024 nt lds
v_mfma_f32_16x16x32_bf16 v[168:171],v[120:123],v[40:43],v[168:171]
ds_read_b64_tr_b16 v[122:123],v4 offset:6400
v_fma_f32 v78,v78,s36,v13
v_mfma_f32_16x16x32_bf16 v[172:175],v[124:127],v[40:43],v[172:175]
ds_read_b64_tr_b16 v[120:121],v4 offset:256
v_fma_f32 v86,v86,s36,v14
v_mfma_f32_16x16x32_bf16 v[176:179],v[128:131],v[40:43],v[176:179]
s_waitcnt lgkmcnt(2)
ds_read_b64_tr_b16 v[124:125],v5 offset:256
v_fma_f32 v87,v87,s36,v14
v_mfma_f32_16x16x32_bf16 v[180:183],v[132:135],v[40:43],v[180:183]
ds_read_b64_tr_b16 v[126:127],v5 offset:6400
v_fma_f32 v85,v85,s36,v14
v_mfma_f32_16x16x32_bf16 v[228:231],v[132:135],v[44:47],v[228:231]
v_exp_f32 v97,v97
v_mfma_f32_16x16x32_bf16 v[224:227],v[128:131],v[44:47],v[224:227]
v_exp_f32 v99,v99
v_mfma_f32_16x16x32_bf16 a[16:19],v[128:131],v[48:51],a[16:19]
v_exp_f32 v96,v96
v_mfma_f32_16x16x32_bf16 a[20:23],v[132:135],v[48:51],a[20:23]
v_cvt_pk_bf16_f32 v32,v96,v97
v_cvt_pk_bf16_f32 v33,v98,v99
v_mfma_f32_16x16x32_bf16 a[68:71],v[132:135],v[52:55],a[68:71]
v_exp_f32 v107,v107
v_mfma_f32_16x16x32_bf16 a[64:67],v[128:131],v[52:55],a[64:67]
buffer_load_dwordx4 v8,s[12:15],s28 offen offset:2048 nt lds
v_mfma_f32_16x16x32_bf16 a[112:115],v[128:131],v[56:59],a[112:115]
s_add_u32 s28,s28,3072
v_exp_f32 v105,v105
v_mfma_f32_16x16x32_bf16 a[116:119],v[132:135],v[56:59],a[116:119]
s_add_u32 s29,s29,3072
v_exp_f32 v106,v106
v_mfma_f32_16x16x32_bf16 a[120:123],v[136:139],v[56:59],a[120:123]
s_add_u32 m0,s23,0
v_exp_f32 v104,v104
v_mfma_f32_16x16x32_bf16 a[124:127],v[140:143],v[56:59],a[124:127]
v_cvt_pk_bf16_f32 v36,v104,v105
v_cvt_pk_bf16_f32 v37,v106,v107
v_mfma_f32_16x16x32_bf16 a[76:79],v[140:143],v[52:55],a[76:79]
v_exp_f32 v77,v77
v_mfma_f32_16x16x32_bf16 a[72:75],v[136:139],v[52:55],a[72:75]
v_exp_f32 v76,v76
v_mfma_f32_16x16x32_bf16 a[24:27],v[136:139],v[48:51],a[24:27]
v_exp_f32 v78,v78
v_mfma_f32_16x16x32_bf16 a[28:31],v[140:143],v[48:51],a[28:31]
v_exp_f32 v79,v79
v_mfma_f32_16x16x32_bf16 v[236:239],v[140:143],v[44:47],v[236:239]
v_cvt_pk_bf16_f32 v23,v78,v79
v_cvt_pk_bf16_f32 v22,v76,v77
v_mfma_f32_16x16x32_bf16 v[232:235],v[136:139],v[44:47],v[232:235]
v_exp_f32 v86,v86
v_mfma_f32_16x16x32_bf16 v[184:187],v[136:139],v[40:43],v[184:187]
v_exp_f32 v87,v87
v_mfma_f32_16x16x32_bf16 v[188:191],v[140:143],v[40:43],v[188:191]
v_exp_f32 v85,v85
v_mfma_f32_16x16x32_bf16 v[192:195],v[112:115],v[40:43],v[192:195]
v_cvt_pk_bf16_f32 v27,v86,v87
v_fma_f32 v84,v84,s36,v14
s_waitcnt vmcnt(12) lgkmcnt(0)
v_mfma_f32_16x16x32_bf16 v[196:199],v[116:119],v[40:43],v[196:199]
s_barrier
v_mfma_f32_16x16x32_bf16 v[244:247],v[116:119],v[44:47],v[244:247]
ds_read_b128 v[128:131],v0 offset:24576
v_fma_f32 v95,v95,s36,v15
v_mfma_f32_16x16x32_bf16 v[240:243],v[112:115],v[44:47],v[240:243]
ds_read_b128 v[132:135],v1 offset:24576
v_fma_f32 v92,v92,s36,v15
v_mfma_f32_16x16x32_bf16 a[32:35],v[112:115],v[48:51],a[32:35]
ds_read_b128 v[136:139],v0 offset:24704
v_fma_f32 v94,v94,s36,v15
v_mfma_f32_16x16x32_bf16 a[36:39],v[116:119],v[48:51],a[36:39]
ds_read_b128 v[140:143],v1 offset:24704
v_fma_f32 v93,v93,s36,v15
v_mfma_f32_16x16x32_bf16 a[84:87],v[116:119],v[52:55],a[84:87]
v_exp_f32 v84,v84
v_mfma_f32_16x16x32_bf16 a[80:83],v[112:115],v[52:55],a[80:83]
buffer_load_dwordx4 v6,s[8:11],s21 offen offset:0 lds
v_mfma_f32_16x16x32_bf16 a[128:131],v[112:115],v[56:59],a[128:131]
ds_read_b128 v[112:115],v0 offset:24832
v_cvt_pk_bf16_f32 v26,v84,v85
v_mfma_f32_16x16x32_bf16 a[132:135],v[116:119],v[56:59],a[132:135]
ds_read_b128 v[116:119],v1 offset:24832
v_fma_f32 v103,v103,s36,v16
v_smfmac_f32_16x16x64_bf16 v[60:63],v[152:155],v[20:27],v18
v_fma_f32 v101,v101,s36,v16
v_mfma_f32_16x16x32_bf16 a[136:139],v[120:123],v[56:59],a[136:139]
v_exp_f32 v92,v92
v_mfma_f32_16x16x32_bf16 a[140:143],v[124:127],v[56:59],a[140:143]
v_exp_f32 v93,v93
v_mfma_f32_16x16x32_bf16 a[92:95],v[124:127],v[52:55],a[92:95]
v_exp_f32 v94,v94
v_mfma_f32_16x16x32_bf16 a[88:91],v[120:123],v[52:55],a[88:91]
v_exp_f32 v95,v95
v_mfma_f32_16x16x32_bf16 a[40:43],v[120:123],v[48:51],a[40:43]
v_cvt_pk_bf16_f32 v31,v94,v95
v_cvt_pk_bf16_f32 v30,v92,v93
v_mfma_f32_16x16x32_bf16 a[44:47],v[124:127],v[48:51],a[44:47]
v_exp_f32 v103,v103
v_mfma_f32_16x16x32_bf16 v[252:255],v[124:127],v[44:47],v[252:255]
v_exp_f32 v101,v101
v_mfma_f32_16x16x32_bf16 v[248:251],v[120:123],v[44:47],v[248:251]
v_fma_f32 v100,v100,s36,v16
v_fma_f32 v102,v102,s36,v16
v_mfma_f32_16x16x32_bf16 v[200:203],v[120:123],v[40:43],v[200:203]
buffer_load_dwordx4 v7,s[8:11],s21 offen offset:1024 lds
v_mfma_f32_16x16x32_bf16 v[204:207],v[124:127],v[40:43],v[204:207]
s_waitcnt lgkmcnt(0)
ds_read_b128 v[120:123],v0 offset:30720
v_fma_f32 v108,v108,s36,v17
v_mfma_f32_16x16x32_bf16 v[72:75],v[128:131],a[144:147],0
ds_read_b128 v[124:127],v1 offset:30720
v_fma_f32 v111,v111,s36,v17
v_mfma_f32_16x16x32_bf16 v[72:75],v[132:135],a[148:151],v[72:75]
v_exp_f32 v100,v100
v_mfma_f32_16x16x32_bf16 v[72:75],v[136:139],a[152:155],v[72:75]
v_exp_f32 v102,v102
v_mfma_f32_16x16x32_bf16 v[72:75],v[140:143],a[156:159],v[72:75]
v_cvt_pk_bf16_f32 v35,v102,v103
v_cvt_pk_bf16_f32 v34,v100,v101
v_mfma_f32_16x16x32_bf16 v[72:75],v[112:115],a[160:163],v[72:75]
v_exp_f32 v111,v111
v_smfmac_f32_16x16x64_bf16 v[64:67],v[152:155],v[28:35],v18
v_fma_f32 v110,v110,s36,v17
v_mfma_f32_16x16x32_bf16 v[72:75],v[116:119],a[164:167],v[72:75]
v_exp_f32 v110,v110
v_mfma_f32_16x16x32_bf16 v[80:83],v[116:119],a[188:191],0
v_exp_f32 v108,v108
v_mfma_f32_16x16x32_bf16 v[80:83],v[112:115],a[184:187],v[80:83]
v_fma_f32 v109,v109,s36,v17
v_cvt_pk_bf16_f32 v39,v110,v111
v_mfma_f32_16x16x32_bf16 v[80:83],v[140:143],a[180:183],v[80:83]
buffer_load_dwordx4 v8,s[8:11],s21 offen offset:2048 lds
v_mfma_f32_16x16x32_bf16 v[80:83],v[136:139],a[176:179],v[80:83]
s_add_u32 s21,s21,12288
v_exp_f32 v109,v109
v_mfma_f32_16x16x32_bf16 v[80:83],v[132:135],a[172:175],v[80:83]
s_add_u32 m0,s22,12288
v_cvt_pk_bf16_f32 v38,v108,v109
v_fma_f32 v74,v74,s36,v13
v_mfma_f32_16x16x32_bf16 v[80:83],v[128:131],a[168:171],v[80:83]
v_exp_f32 v74,v74
v_smfmac_f32_16x16x64_bf16 v[68:71],v[152:155],v[32:39],v18
v_fma_f32 v75,v75,s36,v13
v_mfma_f32_16x16x32_bf16 v[88:91],v[128:131],a[192:195],0
v_exp_f32 v75,v75
v_mfma_f32_16x16x32_bf16 v[88:91],v[132:135],a[196:199],v[88:91]
v_cvt_pk_bf16_f32 v41,v74,v75
v_fma_f32 v72,v72,s36,v13
v_mfma_f32_16x16x32_bf16 v[88:91],v[136:139],a[200:203],v[88:91]
v_exp_f32 v72,v72
v_mfma_f32_16x16x32_bf16 v[88:91],v[140:143],a[204:207],v[88:91]
v_fma_f32 v82,v82,s36,v14
v_fma_f32 v81,v81,s36,v14
v_mfma_f32_16x16x32_bf16 v[88:91],v[112:115],a[208:211],v[88:91]
v_exp_f32 v82,v82
v_mfma_f32_16x16x32_bf16 v[88:91],v[116:119],a[212:215],v[88:91]
v_exp_f32 v81,v81
v_mfma_f32_16x16x32_bf16 v[96:99],v[116:119],a[236:239],0
buffer_load_dwordx4 v6,s[4:7],s20 offen offset:0 lds
v_mfma_f32_16x16x32_bf16 v[96:99],v[112:115],a[232:235],v[96:99]
v_fma_f32 v80,v80,s36,v14
v_fma_f32 v83,v83,s36,v14
v_mfma_f32_16x16x32_bf16 v[96:99],v[140:143],a[228:231],v[96:99]
v_exp_f32 v83,v83
v_mfma_f32_16x16x32_bf16 v[96:99],v[136:139],a[224:227],v[96:99]
v_exp_f32 v80,v80
v_mfma_f32_16x16x32_bf16 v[96:99],v[132:135],a[220:223],v[96:99]
v_fma_f32 v89,v89,s36,v15
v_fma_f32 v73,v73,s36,v13
v_mfma_f32_16x16x32_bf16 v[96:99],v[128:131],a[216:219],v[96:99]
v_exp_f32 v73,v73
v_mfma_f32_16x16x32_bf16 v[104:107],v[128:131],a[240:243],0
ds_read_b128 v[128:131],v0 offset:30848
v_cvt_pk_bf16_f32 v40,v72,v73
v_mfma_f32_16x16x32_bf16 v[104:107],v[132:135],a[244:247],v[104:107]
ds_read_b128 v[132:135],v1 offset:30848
v_fma_f32 v88,v88,s36,v15
v_mfma_f32_16x16x32_bf16 v[104:107],v[136:139],a[248:251],v[104:107]
ds_read_b128 v[136:139],v0 offset:30976
v_cvt_pk_bf16_f32 v44,v80,v81
v_mfma_f32_16x16x32_bf16 v[104:107],v[140:143],a[252:255],v[104:107]
ds_read_b128 v[140:143],v1 offset:30976
v_cvt_pk_bf16_f32 v45,v82,v83
v_mfma_f32_16x16x32_bf16 v[104:107],v[112:115],v[144:147],v[104:107]
v_exp_f32 v88,v88
v_mfma_f32_16x16x32_bf16 v[104:107],v[116:119],v[148:151],v[104:107]
s_waitcnt lgkmcnt(4)
v_exp_f32 v89,v89
v_mfma_f32_16x16x32_bf16 v[76:79],v[120:123],a[144:147],0
buffer_load_dwordx4 v7,s[4:7],s20 offen offset:1024 lds
v_mfma_f32_16x16x32_bf16 v[76:79],v[124:127],a[148:151],v[76:79]
s_waitcnt lgkmcnt(3)
v_cvt_pk_bf16_f32 v48,v88,v89
v_mfma_f32_16x16x32_bf16 v[76:79],v[128:131],a[152:155],v[76:79]
s_waitcnt lgkmcnt(2)
v_mfma_f32_16x16x32_bf16 v[76:79],v[132:135],a[156:159],v[76:79]
s_waitcnt lgkmcnt(1)
v_mfma_f32_16x16x32_bf16 v[76:79],v[136:139],a[160:163],v[76:79]
s_waitcnt lgkmcnt(0)
v_mfma_f32_16x16x32_bf16 v[76:79],v[140:143],a[164:167],v[76:79]
v_mfma_f32_16x16x32_bf16 v[84:87],v[140:143],a[188:191],0
v_mfma_f32_16x16x32_bf16 v[84:87],v[136:139],a[184:187],v[84:87]
v_mfma_f32_16x16x32_bf16 v[84:87],v[132:135],a[180:183],v[84:87]
v_mfma_f32_16x16x32_bf16 v[84:87],v[128:131],a[176:179],v[84:87]
v_mfma_f32_16x16x32_bf16 v[84:87],v[124:127],a[172:175],v[84:87]
buffer_load_dwordx4 v8,s[4:7],s20 offen offset:2048 lds
v_mfma_f32_16x16x32_bf16 v[84:87],v[120:123],a[168:171],v[84:87]
s_add_u32 s20,s20,12288
v_mfma_f32_16x16x32_bf16 v[92:95],v[120:123],a[192:195],0
v_mfma_f32_16x16x32_bf16 v[92:95],v[124:127],a[196:199],v[92:95]
v_mfma_f32_16x16x32_bf16 v[92:95],v[128:131],a[200:203],v[92:95]
v_mfma_f32_16x16x32_bf16 v[92:95],v[132:135],a[204:207],v[92:95]
ds_read_b64_tr_b16 v[114:115],v2 offset:18432
v_mfma_f32_16x16x32_bf16 v[92:95],v[136:139],a[208:211],v[92:95]
ds_read_b64_tr_b16 v[112:113],v2 offset:12288
v_mfma_f32_16x16x32_bf16 v[92:95],v[140:143],a[212:215],v[92:95]
v_mfma_f32_16x16x32_bf16 v[100:103],v[140:143],a[236:239],0
ds_read_b64_tr_b16 v[116:117],v3 offset:12288
v_mfma_f32_16x16x32_bf16 v[100:103],v[136:139],a[232:235],v[100:103]
ds_read_b64_tr_b16 v[118:119],v3 offset:18432
v_mfma_f32_16x16x32_bf16 v[100:103],v[132:135],a[228:231],v[100:103]
v_mfma_f32_16x16x32_bf16 v[100:103],v[128:131],a[224:227],v[100:103]
v_mfma_f32_16x16x32_bf16 v[100:103],v[124:127],a[220:223],v[100:103]
v_mfma_f32_16x16x32_bf16 v[100:103],v[120:123],a[216:219],v[100:103]
v_mfma_f32_16x16x32_bf16 v[108:111],v[120:123],a[240:243],0
ds_read_b64_tr_b16 v[120:121],v4 offset:12288
v_mfma_f32_16x16x32_bf16 v[108:111],v[124:127],a[244:247],v[108:111]
ds_read_b64_tr_b16 v[122:123],v4 offset:18432
v_mfma_f32_16x16x32_bf16 v[108:111],v[128:131],a[248:251],v[108:111]
ds_read_b64_tr_b16 v[124:125],v5 offset:12288
v_mfma_f32_16x16x32_bf16 v[108:111],v[132:135],a[252:255],v[108:111]
ds_read_b64_tr_b16 v[126:127],v5 offset:18432
v_mfma_f32_16x16x32_bf16 v[108:111],v[136:139],v[144:147],v[108:111]
v_mfma_f32_16x16x32_bf16 v[108:111],v[140:143],v[148:151],v[108:111]
s_waitcnt lgkmcnt(4)
v_mfma_f32_16x16x32_bf16 v[160:163],v[112:115],v[20:23],v[160:163]
s_add_u32 m0,s23,12288
ds_read_b64_tr_b16 v[128:129],v2 offset:12416
v_fma_f32 v90,v90,s36,v15
v_mfma_f32_16x16x32_bf16 v[164:167],v[116:119],v[20:23],v[164:167]
ds_read_b64_tr_b16 v[130:131],v2 offset:18560
v_fma_f32 v91,v91,s36,v15
v_mfma_f32_16x16x32_bf16 v[212:215],v[116:119],v[24:27],v[212:215]
ds_read_b64_tr_b16 v[132:133],v3 offset:12416
v_fma_f32 v96,v96,s36,v16
v_mfma_f32_16x16x32_bf16 v[208:211],v[112:115],v[24:27],v[208:211]
ds_read_b64_tr_b16 v[134:135],v3 offset:18560
v_fma_f32 v97,v97,s36,v16
v_mfma_f32_16x16x32_bf16 a[0:3],v[112:115],v[28:31],a[0:3]
ds_read_b64_tr_b16 v[136:137],v4 offset:12416
v_fma_f32 v98,v98,s36,v16
v_mfma_f32_16x16x32_bf16 a[4:7],v[116:119],v[28:31],a[4:7]
ds_read_b64_tr_b16 v[138:139],v4 offset:18560
v_fma_f32 v99,v99,s36,v16
v_mfma_f32_16x16x32_bf16 a[52:55],v[116:119],v[32:35],a[52:55]
ds_read_b64_tr_b16 v[140:141],v5 offset:12416
v_fma_f32 v104,v104,s36,v17
v_mfma_f32_16x16x32_bf16 a[48:51],v[112:115],v[32:35],a[48:51]
ds_read_b64_tr_b16 v[142:143],v5 offset:18560
v_fma_f32 v105,v105,s36,v17
v_mfma_f32_16x16x32_bf16 a[96:99],v[112:115],v[36:39],a[96:99]
ds_read_b64_tr_b16 v[112:113],v2 offset:12544
v_fma_f32 v106,v106,s36,v17
v_mfma_f32_16x16x32_bf16 a[100:103],v[116:119],v[36:39],a[100:103]
s_waitcnt lgkmcnt(8)
ds_read_b64_tr_b16 v[114:115],v2 offset:18688
v_fma_f32 v107,v107,s36,v17
v_mfma_f32_16x16x32_bf16 a[104:107],v[120:123],v[36:39],a[104:107]
ds_read_b64_tr_b16 v[116:117],v3 offset:12544
v_fma_f32 v76,v76,s36,v13
v_mfma_f32_16x16x32_bf16 a[108:111],v[124:127],v[36:39],a[108:111]
ds_read_b64_tr_b16 v[118:119],v3 offset:18688
v_fma_f32 v77,v77,s36,v13
v_mfma_f32_16x16x32_bf16 a[60:63],v[124:127],v[32:35],a[60:63]
v_exp_f32 v90,v90
v_mfma_f32_16x16x32_bf16 a[56:59],v[120:123],v[32:35],a[56:59]
v_exp_f32 v91,v91
v_mfma_f32_16x16x32_bf16 a[8:11],v[120:123],v[28:31],a[8:11]
v_cvt_pk_bf16_f32 v49,v90,v91
v_fma_f32 v78,v78,s36,v13
v_mfma_f32_16x16x32_bf16 a[12:15],v[124:127],v[28:31],a[12:15]
v_exp_f32 v96,v96
v_mfma_f32_16x16x32_bf16 v[220:223],v[124:127],v[24:27],v[220:223]
v_exp_f32 v97,v97
v_mfma_f32_16x16x32_bf16 v[216:219],v[120:123],v[24:27],v[216:219]
v_exp_f32 v98,v98
v_mfma_f32_16x16x32_bf16 v[168:171],v[120:123],v[20:23],v[168:171]
ds_read_b64_tr_b16 v[120:121],v4 offset:12544
v_cvt_pk_bf16_f32 v52,v96,v97
v_mfma_f32_16x16x32_bf16 v[172:175],v[124:127],v[20:23],v[172:175]
s_waitcnt lgkmcnt(2)
ds_read_b64_tr_b16 v[122:123],v4 offset:18688
v_fma_f32 v79,v79,s36,v13
v_mfma_f32_16x16x32_bf16 v[176:179],v[128:131],v[20:23],v[176:179]
ds_read_b64_tr_b16 v[124:125],v5 offset:12544
v_fma_f32 v84,v84,s36,v14
v_mfma_f32_16x16x32_bf16 v[180:183],v[132:135],v[20:23],v[180:183]
ds_read_b64_tr_b16 v[126:127],v5 offset:18688
v_fma_f32 v85,v85,s36,v14
v_mfma_f32_16x16x32_bf16 v[228:231],v[132:135],v[24:27],v[228:231]
v_exp_f32 v99,v99
v_mfma_f32_16x16x32_bf16 v[224:227],v[128:131],v[24:27],v[224:227]
v_cvt_pk_bf16_f32 v53,v98,v99
v_fma_f32 v86,v86,s36,v14
v_mfma_f32_16x16x32_bf16 a[16:19],v[128:131],v[28:31],a[16:19]
v_exp_f32 v104,v104
v_mfma_f32_16x16x32_bf16 a[20:23],v[132:135],v[28:31],a[20:23]
v_exp_f32 v105,v105
v_mfma_f32_16x16x32_bf16 a[68:71],v[132:135],v[32:35],a[68:71]
v_exp_f32 v106,v106
v_mfma_f32_16x16x32_bf16 a[64:67],v[128:131],v[32:35],a[64:67]
v_exp_f32 v107,v107
v_mfma_f32_16x16x32_bf16 a[112:115],v[128:131],v[36:39],a[112:115]
v_cvt_pk_bf16_f32 v56,v104,v105
v_cvt_pk_bf16_f32 v57,v106,v107
v_mfma_f32_16x16x32_bf16 a[116:119],v[132:135],v[36:39],a[116:119]
v_exp_f32 v76,v76
v_mfma_f32_16x16x32_bf16 a[120:123],v[136:139],v[36:39],a[120:123]
v_exp_f32 v77,v77
v_mfma_f32_16x16x32_bf16 a[124:127],v[140:143],v[36:39],a[124:127]
v_exp_f32 v78,v78
v_mfma_f32_16x16x32_bf16 a[76:79],v[140:143],v[32:35],a[76:79]
v_exp_f32 v79,v79
v_mfma_f32_16x16x32_bf16 a[72:75],v[136:139],v[32:35],a[72:75]
v_cvt_pk_bf16_f32 v42,v76,v77
v_cvt_pk_bf16_f32 v43,v78,v79
v_mfma_f32_16x16x32_bf16 a[24:27],v[136:139],v[28:31],a[24:27]
v_fma_f32 v87,v87,s36,v14
v_fma_f32 v92,v92,s36,v15
v_mfma_f32_16x16x32_bf16 a[28:31],v[140:143],v[28:31],a[28:31]
v_exp_f32 v84,v84
v_mfma_f32_16x16x32_bf16 v[236:239],v[140:143],v[24:27],v[236:239]
v_exp_f32 v85,v85
v_mfma_f32_16x16x32_bf16 v[232:235],v[136:139],v[24:27],v[232:235]
v_exp_f32 v86,v86
v_mfma_f32_16x16x32_bf16 v[184:187],v[136:139],v[20:23],v[184:187]
v_exp_f32 v87,v87
v_mfma_f32_16x16x32_bf16 v[188:191],v[140:143],v[20:23],v[188:191]
v_cvt_pk_bf16_f32 v46,v84,v85
v_cvt_pk_bf16_f32 v47,v86,v87
v_mfma_f32_16x16x32_bf16 v[192:195],v[112:115],v[20:23],v[192:195]
v_fma_f32 v93,v93,s36,v15
v_fma_f32 v94,v94,s36,v15
v_smfmac_f32_16x16x64_bf16 v[60:63],v[152:155],v[40:47],v18
v_fma_f32 v95,v95,s36,v15
s_waitcnt vmcnt(9)
s_waitcnt lgkmcnt(0)
v_mfma_f32_16x16x32_bf16 v[196:199],v[116:119],v[20:23],v[196:199]
s_barrier
v_mfma_f32_16x16x32_bf16 v[244:247],v[116:119],v[24:27],v[244:247]
ds_read_b128 v[128:131],v0 offset:0
v_fma_f32 v100,v100,s36,v16
v_mfma_f32_16x16x32_bf16 v[240:243],v[112:115],v[24:27],v[240:243]
ds_read_b128 v[132:135],v1 offset:0
v_fma_f32 v101,v101,s36,v16
v_mfma_f32_16x16x32_bf16 a[32:35],v[112:115],v[28:31],a[32:35]
ds_read_b128 v[136:139],v0 offset:128
v_fma_f32 v102,v102,s36,v16
v_mfma_f32_16x16x32_bf16 a[36:39],v[116:119],v[28:31],a[36:39]
ds_read_b128 v[140:143],v1 offset:128
v_fma_f32 v103,v103,s36,v16
v_mfma_f32_16x16x32_bf16 a[84:87],v[116:119],v[32:35],a[84:87]
ds_read_b128 v[156:159],v10 offset:3072
v_fma_f32 v108,v108,s36,v17
v_mfma_f32_16x16x32_bf16 a[80:83],v[112:115],v[32:35],a[80:83]
buffer_load_dwordx4 v6,s[8:11],s21 offen offset:0 lds
v_mfma_f32_16x16x32_bf16 a[128:131],v[112:115],v[36:39],a[128:131]
ds_read_b128 v[112:115],v0 offset:256
v_fma_f32 v109,v109,s36,v17
v_mfma_f32_16x16x32_bf16 a[132:135],v[116:119],v[36:39],a[132:135]
ds_read_b128 v[116:119],v1 offset:256
v_fma_f32 v110,v110,s36,v17
v_mfma_f32_16x16x32_bf16 a[136:139],v[120:123],v[36:39],a[136:139]
v_exp_f32 v92,v92
v_mfma_f32_16x16x32_bf16 a[140:143],v[124:127],v[36:39],a[140:143]
v_exp_f32 v93,v93
v_mfma_f32_16x16x32_bf16 a[92:95],v[124:127],v[32:35],a[92:95]
v_exp_f32 v94,v94
v_mfma_f32_16x16x32_bf16 a[88:91],v[120:123],v[32:35],a[88:91]
v_exp_f32 v95,v95
v_mfma_f32_16x16x32_bf16 a[40:43],v[120:123],v[28:31],a[40:43]
v_cvt_pk_bf16_f32 v50,v92,v93
v_cvt_pk_bf16_f32 v51,v94,v95
v_mfma_f32_16x16x32_bf16 a[44:47],v[124:127],v[28:31],a[44:47]
v_exp_f32 v100,v100
v_mfma_f32_16x16x32_bf16 v[252:255],v[124:127],v[24:27],v[252:255]
v_exp_f32 v101,v101
v_mfma_f32_16x16x32_bf16 v[248:251],v[120:123],v[24:27],v[248:251]
v_exp_f32 v102,v102
v_mfma_f32_16x16x32_bf16 v[200:203],v[120:123],v[20:23],v[200:203]
ds_read_b128 v[120:123],v0 offset:6144
v_cvt_pk_bf16_f32 v54,v100,v101
v_mfma_f32_16x16x32_bf16 v[204:207],v[124:127],v[20:23],v[204:207]
s_waitcnt lgkmcnt(1)
buffer_store_dwordx4 v[156:159],v9,s[16:19],s27 offen offset:0 nt
buffer_load_dwordx4 v7,s[8:11],s21 offen offset:1024 lds
v_mfma_f32_16x16x32_bf16 v[72:75],v[128:131],a[144:147],0
ds_read_b128 v[124:127],v1 offset:6144
v_fma_f32 v111,v111,s36,v17
v_mfma_f32_16x16x32_bf16 v[72:75],v[132:135],a[148:151],v[72:75]
v_exp_f32 v103,v103
v_mfma_f32_16x16x32_bf16 v[72:75],v[136:139],a[152:155],v[72:75]
v_cvt_pk_bf16_f32 v55,v102,v103
v_mfma_f32_16x16x32_bf16 v[72:75],v[140:143],a[156:159],v[72:75]
v_exp_f32 v108,v108
v_smfmac_f32_16x16x64_bf16 v[64:67],v[152:155],v[48:55],v18
v_mfma_f32_16x16x32_bf16 v[72:75],v[112:115],a[160:163],v[72:75]
ds_read_b128 v[156:159],v10 offset:4096
v_mfma_f32_16x16x32_bf16 v[72:75],v[116:119],a[164:167],v[72:75]
v_exp_f32 v109,v109
v_mfma_f32_16x16x32_bf16 v[80:83],v[116:119],a[188:191],0
v_exp_f32 v110,v110
v_mfma_f32_16x16x32_bf16 v[80:83],v[112:115],a[184:187],v[80:83]
v_exp_f32 v111,v111
v_mfma_f32_16x16x32_bf16 v[80:83],v[140:143],a[180:183],v[80:83]
buffer_load_dwordx4 v8,s[8:11],s21 offen offset:2048 lds
v_mfma_f32_16x16x32_bf16 v[80:83],v[136:139],a[176:179],v[80:83]
s_add_u32 s21,s21,12288
v_cvt_pk_bf16_f32 v58,v108,v109
v_cvt_pk_bf16_f32 v59,v110,v111
v_mfma_f32_16x16x32_bf16 v[80:83],v[132:135],a[172:175],v[80:83]
s_add_u32 m0,s22,24576
v_fma_f32 v72,v72,s36,v13
v_fma_f32 v73,v73,s36,v13
v_smfmac_f32_16x16x64_bf16 v[68:71],v[152:155],v[52:59],v18
v_fma_f32 v74,v74,s36,v13
v_mfma_f32_16x16x32_bf16 v[80:83],v[128:131],a[168:171],v[80:83]
v_fma_f32 v75,v75,s36,v13
v_mfma_f32_16x16x32_bf16 v[88:91],v[128:131],a[192:195],0
v_exp_f32 v72,v72
v_mfma_f32_16x16x32_bf16 v[88:91],v[132:135],a[196:199],v[88:91]
v_exp_f32 v73,v73
v_mfma_f32_16x16x32_bf16 v[88:91],v[136:139],a[200:203],v[88:91]
v_exp_f32 v74,v74
v_mfma_f32_16x16x32_bf16 v[88:91],v[140:143],a[204:207],v[88:91]
v_fma_f32 v80,v80,s36,v14
v_fma_f32 v81,v81,s36,v14
v_mfma_f32_16x16x32_bf16 v[88:91],v[112:115],a[208:211],v[88:91]
v_fma_f32 v82,v82,s36,v14
v_fma_f32 v83,v83,s36,v14
v_mfma_f32_16x16x32_bf16 v[88:91],v[116:119],a[212:215],v[88:91]
v_exp_f32 v75,v75
v_mfma_f32_16x16x32_bf16 v[96:99],v[116:119],a[236:239],0
v_exp_f32 v80,v80
v_mfma_f32_16x16x32_bf16 v[96:99],v[112:115],a[232:235],v[96:99]
s_waitcnt lgkmcnt(0)
buffer_store_dwordx4 v[156:159],v9,s[16:19],s27 offen offset:128 nt
buffer_load_dwordx4 v6,s[4:7],s20 offen offset:0 lds
v_mfma_f32_16x16x32_bf16 v[96:99],v[140:143],a[228:231],v[96:99]
v_exp_f32 v81,v81
v_mfma_f32_16x16x32_bf16 v[96:99],v[136:139],a[224:227],v[96:99]
v_fma_f32 v88,v88,s36,v15
v_fma_f32 v89,v89,s36,v15
v_mfma_f32_16x16x32_bf16 v[96:99],v[132:135],a[220:223],v[96:99]
v_exp_f32 v82,v82
v_mfma_f32_16x16x32_bf16 v[96:99],v[128:131],a[216:219],v[96:99]
v_exp_f32 v83,v83
v_mfma_f32_16x16x32_bf16 v[104:107],v[128:131],a[240:243],0
ds_read_b128 v[128:131],v0 offset:6272
v_cvt_pk_bf16_f32 v20,v72,v73
v_mfma_f32_16x16x32_bf16 v[104:107],v[132:135],a[244:247],v[104:107]
ds_read_b128 v[156:159],v10 offset:5120
v_cvt_pk_bf16_f32 v21,v74,v75
v_mfma_f32_16x16x32_bf16 v[104:107],v[136:139],a[248:251],v[104:107]
ds_read_b128 v[132:135],v1 offset:6272
v_cvt_pk_bf16_f32 v24,v80,v81
v_mfma_f32_16x16x32_bf16 v[104:107],v[140:143],a[252:255],v[104:107]
ds_read_b128 v[136:139],v0 offset:6400
v_cvt_pk_bf16_f32 v25,v82,v83
v_mfma_f32_16x16x32_bf16 v[104:107],v[112:115],v[144:147],v[104:107]
ds_read_b128 v[140:143],v1 offset:6400
v_mfma_f32_16x16x32_bf16 v[104:107],v[116:119],v[148:151],v[104:107]
buffer_load_dwordx4 v7,s[4:7],s20 offen offset:1024 lds
v_mfma_f32_16x16x32_bf16 v[76:79],v[120:123],a[144:147],0
v_exp_f32 v88,v88
v_mfma_f32_16x16x32_bf16 v[76:79],v[124:127],a[148:151],v[76:79]
s_waitcnt lgkmcnt(4)
v_exp_f32 v89,v89
v_mfma_f32_16x16x32_bf16 v[76:79],v[128:131],a[152:155],v[76:79]
s_waitcnt lgkmcnt(2)
v_cvt_pk_bf16_f32 v28,v88,v89
v_mfma_f32_16x16x32_bf16 v[76:79],v[132:135],a[156:159],v[76:79]
s_waitcnt lgkmcnt(1)
v_mfma_f32_16x16x32_bf16 v[76:79],v[136:139],a[160:163],v[76:79]
s_waitcnt lgkmcnt(0)
v_mfma_f32_16x16x32_bf16 v[76:79],v[140:143],a[164:167],v[76:79]
v_mfma_f32_16x16x32_bf16 v[84:87],v[140:143],a[188:191],0
v_mfma_f32_16x16x32_bf16 v[84:87],v[136:139],a[184:187],v[84:87]
v_mfma_f32_16x16x32_bf16 v[84:87],v[132:135],a[180:183],v[84:87]
v_mfma_f32_16x16x32_bf16 v[84:87],v[128:131],a[176:179],v[84:87]
buffer_store_dwordx4 v[156:159],v9,s[16:19],s27 offen offset:256 nt
buffer_load_dwordx4 v8,s[4:7],s20 offen offset:2048 lds
v_mfma_f32_16x16x32_bf16 v[84:87],v[124:127],a[172:175],v[84:87]
s_add_u32 s20,s20,12288
v_mfma_f32_16x16x32_bf16 v[84:87],v[120:123],a[168:171],v[84:87]
s_add_u32 s27,s27,3072
v_mfma_f32_16x16x32_bf16 v[92:95],v[120:123],a[192:195],0
v_mfma_f32_16x16x32_bf16 v[92:95],v[124:127],a[196:199],v[92:95]
v_mfma_f32_16x16x32_bf16 v[92:95],v[128:131],a[200:203],v[92:95]
ds_read_b64_tr_b16 v[112:113],v2 offset:24576
v_mfma_f32_16x16x32_bf16 v[92:95],v[132:135],a[204:207],v[92:95]
ds_read_b64_tr_b16 v[114:115],v2 offset:30720
v_mfma_f32_16x16x32_bf16 v[92:95],v[136:139],a[208:211],v[92:95]
ds_read_b64_tr_b16 v[116:117],v3 offset:24576
v_mfma_f32_16x16x32_bf16 v[92:95],v[140:143],a[212:215],v[92:95]
ds_read_b64_tr_b16 v[118:119],v3 offset:30720
v_mfma_f32_16x16x32_bf16 v[100:103],v[140:143],a[236:239],0
v_mfma_f32_16x16x32_bf16 v[100:103],v[136:139],a[232:235],v[100:103]
v_mfma_f32_16x16x32_bf16 v[100:103],v[132:135],a[228:231],v[100:103]
v_mfma_f32_16x16x32_bf16 v[100:103],v[128:131],a[224:227],v[100:103]
v_mfma_f32_16x16x32_bf16 v[100:103],v[124:127],a[220:223],v[100:103]
v_mfma_f32_16x16x32_bf16 v[100:103],v[120:123],a[216:219],v[100:103]
v_mfma_f32_16x16x32_bf16 v[108:111],v[120:123],a[240:243],0
ds_read_b64_tr_b16 v[120:121],v4 offset:24576
v_mfma_f32_16x16x32_bf16 v[108:111],v[124:127],a[244:247],v[108:111]
ds_read_b64_tr_b16 v[122:123],v4 offset:30720
v_mfma_f32_16x16x32_bf16 v[108:111],v[128:131],a[248:251],v[108:111]
ds_read_b64_tr_b16 v[124:125],v5 offset:24576
v_mfma_f32_16x16x32_bf16 v[108:111],v[132:135],a[252:255],v[108:111]
ds_read_b64_tr_b16 v[126:127],v5 offset:30720
v_mfma_f32_16x16x32_bf16 v[108:111],v[136:139],v[144:147],v[108:111]
v_mfma_f32_16x16x32_bf16 v[108:111],v[140:143],v[148:151],v[108:111]
s_waitcnt lgkmcnt(4)
v_mfma_f32_16x16x32_bf16 v[160:163],v[112:115],v[40:43],v[160:163]
s_add_u32 m0,s29,0
ds_read_b64_tr_b16 v[130:131],v2 offset:30848
v_fma_f32 v91,v91,s36,v15
v_mfma_f32_16x16x32_bf16 v[164:167],v[116:119],v[40:43],v[164:167]
ds_read_b64_tr_b16 v[128:129],v2 offset:24704
v_fma_f32 v90,v90,s36,v15
v_mfma_f32_16x16x32_bf16 v[212:215],v[116:119],v[44:47],v[212:215]
ds_read_b64_tr_b16 v[132:133],v3 offset:24704
v_fma_f32 v99,v99,s36,v16
v_mfma_f32_16x16x32_bf16 v[208:211],v[112:115],v[44:47],v[208:211]
ds_read_b64_tr_b16 v[134:135],v3 offset:30848
v_fma_f32 v97,v97,s36,v16
v_mfma_f32_16x16x32_bf16 a[0:3],v[112:115],v[48:51],a[0:3]
ds_read_b64_tr_b16 v[138:139],v4 offset:30848
v_fma_f32 v96,v96,s36,v16
v_mfma_f32_16x16x32_bf16 a[4:7],v[116:119],v[48:51],a[4:7]
ds_read_b64_tr_b16 v[136:137],v4 offset:24704
v_fma_f32 v98,v98,s36,v16
v_mfma_f32_16x16x32_bf16 a[52:55],v[116:119],v[52:55],a[52:55]
ds_read_b64_tr_b16 v[142:143],v5 offset:30848
v_fma_f32 v104,v104,s36,v17
v_mfma_f32_16x16x32_bf16 a[48:51],v[112:115],v[52:55],a[48:51]
buffer_load_dwordx4 v6,s[12:15],s28 offen offset:0 nt lds
v_mfma_f32_16x16x32_bf16 a[96:99],v[112:115],v[56:59],a[96:99]
ds_read_b64_tr_b16 v[140:141],v5 offset:24704
v_fma_f32 v107,v107,s36,v17
v_mfma_f32_16x16x32_bf16 a[100:103],v[116:119],v[56:59],a[100:103]
s_waitcnt lgkmcnt(6)
ds_read_b64_tr_b16 v[112:113],v2 offset:24832
v_fma_f32 v106,v106,s36,v17
v_mfma_f32_16x16x32_bf16 a[104:107],v[120:123],v[56:59],a[104:107]
ds_read_b64_tr_b16 v[116:117],v3 offset:24832
v_fma_f32 v105,v105,s36,v17
v_mfma_f32_16x16x32_bf16 a[108:111],v[124:127],v[56:59],a[108:111]
ds_read_b64_tr_b16 v[114:115],v2 offset:30976
v_fma_f32 v79,v79,s36,v13
v_mfma_f32_16x16x32_bf16 a[60:63],v[124:127],v[52:55],a[60:63]
ds_read_b64_tr_b16 v[118:119],v3 offset:30976
v_fma_f32 v77,v77,s36,v13
v_mfma_f32_16x16x32_bf16 a[56:59],v[120:123],v[52:55],a[56:59]
v_exp_f32 v90,v90
v_mfma_f32_16x16x32_bf16 a[8:11],v[120:123],v[48:51],a[8:11]
v_exp_f32 v91,v91
v_mfma_f32_16x16x32_bf16 a[12:15],v[124:127],v[48:51],a[12:15]
v_cvt_pk_bf16_f32 v29,v90,v91
v_fma_f32 v76,v76,s36,v13
v_mfma_f32_16x16x32_bf16 v[220:223],v[124:127],v[44:47],v[220:223]
v_exp_f32 v98,v98
v_mfma_f32_16x16x32_bf16 v[216:219],v[120:123],v[44:47],v[216:219]
buffer_load_dwordx4 v7,s[12:15],s28 offen offset:1024 nt lds
v_mfma_f32_16x16x32_bf16 v[168:171],v[120:123],v[40:43],v[168:171]
ds_read_b64_tr_b16 v[122:123],v4 offset:30976
v_fma_f32 v78,v78,s36,v13
v_mfma_f32_16x16x32_bf16 v[172:175],v[124:127],v[40:43],v[172:175]
ds_read_b64_tr_b16 v[120:121],v4 offset:24832
v_fma_f32 v86,v86,s36,v14
v_mfma_f32_16x16x32_bf16 v[176:179],v[128:131],v[40:43],v[176:179]
s_waitcnt lgkmcnt(2)
ds_read_b64_tr_b16 v[124:125],v5 offset:24832
v_fma_f32 v87,v87,s36,v14
v_mfma_f32_16x16x32_bf16 v[180:183],v[132:135],v[40:43],v[180:183]
ds_read_b64_tr_b16 v[126:127],v5 offset:30976
v_fma_f32 v85,v85,s36,v14
v_mfma_f32_16x16x32_bf16 v[228:231],v[132:135],v[44:47],v[228:231]
v_exp_f32 v97,v97
v_mfma_f32_16x16x32_bf16 v[224:227],v[128:131],v[44:47],v[224:227]
v_exp_f32 v99,v99
v_mfma_f32_16x16x32_bf16 a[16:19],v[128:131],v[48:51],a[16:19]
v_exp_f32 v96,v96
v_mfma_f32_16x16x32_bf16 a[20:23],v[132:135],v[48:51],a[20:23]
v_cvt_pk_bf16_f32 v32,v96,v97
v_cvt_pk_bf16_f32 v33,v98,v99
v_mfma_f32_16x16x32_bf16 a[68:71],v[132:135],v[52:55],a[68:71]
v_exp_f32 v107,v107
v_mfma_f32_16x16x32_bf16 a[64:67],v[128:131],v[52:55],a[64:67]
buffer_load_dwordx4 v8,s[12:15],s28 offen offset:2048 nt lds
v_mfma_f32_16x16x32_bf16 a[112:115],v[128:131],v[56:59],a[112:115]
s_add_u32 s28,s28,3072
v_exp_f32 v105,v105
v_mfma_f32_16x16x32_bf16 a[116:119],v[132:135],v[56:59],a[116:119]
s_add_u32 s29,s29,3072
v_exp_f32 v106,v106
v_mfma_f32_16x16x32_bf16 a[120:123],v[136:139],v[56:59],a[120:123]
s_add_u32 m0,s23,24576
v_exp_f32 v104,v104
v_mfma_f32_16x16x32_bf16 a[124:127],v[140:143],v[56:59],a[124:127]
v_cvt_pk_bf16_f32 v36,v104,v105
v_cvt_pk_bf16_f32 v37,v106,v107
v_mfma_f32_16x16x32_bf16 a[76:79],v[140:143],v[52:55],a[76:79]
v_exp_f32 v77,v77
v_mfma_f32_16x16x32_bf16 a[72:75],v[136:139],v[52:55],a[72:75]
v_exp_f32 v76,v76
v_mfma_f32_16x16x32_bf16 a[24:27],v[136:139],v[48:51],a[24:27]
v_exp_f32 v78,v78
v_mfma_f32_16x16x32_bf16 a[28:31],v[140:143],v[48:51],a[28:31]
v_exp_f32 v79,v79
v_mfma_f32_16x16x32_bf16 v[236:239],v[140:143],v[44:47],v[236:239]
v_cvt_pk_bf16_f32 v23,v78,v79
v_cvt_pk_bf16_f32 v22,v76,v77
v_mfma_f32_16x16x32_bf16 v[232:235],v[136:139],v[44:47],v[232:235]
v_exp_f32 v86,v86
v_mfma_f32_16x16x32_bf16 v[184:187],v[136:139],v[40:43],v[184:187]
v_exp_f32 v87,v87
v_mfma_f32_16x16x32_bf16 v[188:191],v[140:143],v[40:43],v[188:191]
v_exp_f32 v85,v85
v_mfma_f32_16x16x32_bf16 v[192:195],v[112:115],v[40:43],v[192:195]
v_cvt_pk_bf16_f32 v27,v86,v87
v_fma_f32 v84,v84,s36,v14
s_waitcnt vmcnt(12) lgkmcnt(0)
v_mfma_f32_16x16x32_bf16 v[196:199],v[116:119],v[40:43],v[196:199]
s_barrier
v_mfma_f32_16x16x32_bf16 v[244:247],v[116:119],v[44:47],v[244:247]
ds_read_b128 v[128:131],v0 offset:12288
v_fma_f32 v95,v95,s36,v15
v_mfma_f32_16x16x32_bf16 v[240:243],v[112:115],v[44:47],v[240:243]
ds_read_b128 v[132:135],v1 offset:12288
v_fma_f32 v92,v92,s36,v15
v_mfma_f32_16x16x32_bf16 a[32:35],v[112:115],v[48:51],a[32:35]
ds_read_b128 v[136:139],v0 offset:12416
v_fma_f32 v94,v94,s36,v15
v_mfma_f32_16x16x32_bf16 a[36:39],v[116:119],v[48:51],a[36:39]
ds_read_b128 v[140:143],v1 offset:12416
v_fma_f32 v93,v93,s36,v15
v_mfma_f32_16x16x32_bf16 a[84:87],v[116:119],v[52:55],a[84:87]
v_exp_f32 v84,v84
v_mfma_f32_16x16x32_bf16 a[80:83],v[112:115],v[52:55],a[80:83]
buffer_load_dwordx4 v6,s[8:11],s21 offen offset:0 lds
v_mfma_f32_16x16x32_bf16 a[128:131],v[112:115],v[56:59],a[128:131]
ds_read_b128 v[112:115],v0 offset:12544
v_cvt_pk_bf16_f32 v26,v84,v85
v_mfma_f32_16x16x32_bf16 a[132:135],v[116:119],v[56:59],a[132:135]
ds_read_b128 v[116:119],v1 offset:12544
v_fma_f32 v103,v103,s36,v16
v_smfmac_f32_16x16x64_bf16 v[60:63],v[152:155],v[20:27],v18
v_fma_f32 v101,v101,s36,v16
v_mfma_f32_16x16x32_bf16 a[136:139],v[120:123],v[56:59],a[136:139]
v_exp_f32 v92,v92
v_mfma_f32_16x16x32_bf16 a[140:143],v[124:127],v[56:59],a[140:143]
v_exp_f32 v93,v93
v_mfma_f32_16x16x32_bf16 a[92:95],v[124:127],v[52:55],a[92:95]
v_exp_f32 v94,v94
v_mfma_f32_16x16x32_bf16 a[88:91],v[120:123],v[52:55],a[88:91]
v_exp_f32 v95,v95
v_mfma_f32_16x16x32_bf16 a[40:43],v[120:123],v[48:51],a[40:43]
v_cvt_pk_bf16_f32 v31,v94,v95
v_cvt_pk_bf16_f32 v30,v92,v93
v_mfma_f32_16x16x32_bf16 a[44:47],v[124:127],v[48:51],a[44:47]
v_exp_f32 v103,v103
v_mfma_f32_16x16x32_bf16 v[252:255],v[124:127],v[44:47],v[252:255]
v_exp_f32 v101,v101
v_mfma_f32_16x16x32_bf16 v[248:251],v[120:123],v[44:47],v[248:251]
v_fma_f32 v100,v100,s36,v16
v_fma_f32 v102,v102,s36,v16
v_mfma_f32_16x16x32_bf16 v[200:203],v[120:123],v[40:43],v[200:203]
buffer_load_dwordx4 v7,s[8:11],s21 offen offset:1024 lds
v_mfma_f32_16x16x32_bf16 v[204:207],v[124:127],v[40:43],v[204:207]
s_waitcnt lgkmcnt(0)
ds_read_b128 v[120:123],v0 offset:18432
v_fma_f32 v108,v108,s36,v17
v_mfma_f32_16x16x32_bf16 v[72:75],v[128:131],a[144:147],0
ds_read_b128 v[124:127],v1 offset:18432
v_fma_f32 v111,v111,s36,v17
v_mfma_f32_16x16x32_bf16 v[72:75],v[132:135],a[148:151],v[72:75]
v_exp_f32 v100,v100
v_mfma_f32_16x16x32_bf16 v[72:75],v[136:139],a[152:155],v[72:75]
v_exp_f32 v102,v102
v_mfma_f32_16x16x32_bf16 v[72:75],v[140:143],a[156:159],v[72:75]
v_cvt_pk_bf16_f32 v35,v102,v103
v_cvt_pk_bf16_f32 v34,v100,v101
v_mfma_f32_16x16x32_bf16 v[72:75],v[112:115],a[160:163],v[72:75]
v_exp_f32 v111,v111
v_smfmac_f32_16x16x64_bf16 v[64:67],v[152:155],v[28:35],v18
v_fma_f32 v110,v110,s36,v17
v_mfma_f32_16x16x32_bf16 v[72:75],v[116:119],a[164:167],v[72:75]
v_exp_f32 v110,v110
v_mfma_f32_16x16x32_bf16 v[80:83],v[116:119],a[188:191],0
v_exp_f32 v108,v108
v_mfma_f32_16x16x32_bf16 v[80:83],v[112:115],a[184:187],v[80:83]
v_fma_f32 v109,v109,s36,v17
v_cvt_pk_bf16_f32 v39,v110,v111
v_mfma_f32_16x16x32_bf16 v[80:83],v[140:143],a[180:183],v[80:83]
buffer_load_dwordx4 v8,s[8:11],s21 offen offset:2048 lds
v_mfma_f32_16x16x32_bf16 v[80:83],v[136:139],a[176:179],v[80:83]
s_add_u32 s21,s21,12288
v_exp_f32 v109,v109
v_mfma_f32_16x16x32_bf16 v[80:83],v[132:135],a[172:175],v[80:83]
s_add_u32 m0,s22,0
v_cvt_pk_bf16_f32 v38,v108,v109
v_fma_f32 v74,v74,s36,v13
v_mfma_f32_16x16x32_bf16 v[80:83],v[128:131],a[168:171],v[80:83]
v_exp_f32 v74,v74
v_smfmac_f32_16x16x64_bf16 v[68:71],v[152:155],v[32:39],v18
v_fma_f32 v75,v75,s36,v13
v_mfma_f32_16x16x32_bf16 v[88:91],v[128:131],a[192:195],0
v_exp_f32 v75,v75
v_mfma_f32_16x16x32_bf16 v[88:91],v[132:135],a[196:199],v[88:91]
v_cvt_pk_bf16_f32 v41,v74,v75
v_fma_f32 v72,v72,s36,v13
v_mfma_f32_16x16x32_bf16 v[88:91],v[136:139],a[200:203],v[88:91]
v_exp_f32 v72,v72
v_mfma_f32_16x16x32_bf16 v[88:91],v[140:143],a[204:207],v[88:91]
v_fma_f32 v82,v82,s36,v14
v_fma_f32 v81,v81,s36,v14
v_mfma_f32_16x16x32_bf16 v[88:91],v[112:115],a[208:211],v[88:91]
v_exp_f32 v82,v82
v_mfma_f32_16x16x32_bf16 v[88:91],v[116:119],a[212:215],v[88:91]
v_exp_f32 v81,v81
v_mfma_f32_16x16x32_bf16 v[96:99],v[116:119],a[236:239],0
buffer_load_dwordx4 v6,s[4:7],s20 offen offset:0 lds
v_mfma_f32_16x16x32_bf16 v[96:99],v[112:115],a[232:235],v[96:99]
v_fma_f32 v80,v80,s36,v14
v_fma_f32 v83,v83,s36,v14
v_mfma_f32_16x16x32_bf16 v[96:99],v[140:143],a[228:231],v[96:99]
v_exp_f32 v83,v83
v_mfma_f32_16x16x32_bf16 v[96:99],v[136:139],a[224:227],v[96:99]
v_exp_f32 v80,v80
v_mfma_f32_16x16x32_bf16 v[96:99],v[132:135],a[220:223],v[96:99]
v_fma_f32 v89,v89,s36,v15
v_fma_f32 v73,v73,s36,v13
v_mfma_f32_16x16x32_bf16 v[96:99],v[128:131],a[216:219],v[96:99]
v_exp_f32 v73,v73
v_mfma_f32_16x16x32_bf16 v[104:107],v[128:131],a[240:243],0
ds_read_b128 v[128:131],v0 offset:18560
v_cvt_pk_bf16_f32 v40,v72,v73
v_mfma_f32_16x16x32_bf16 v[104:107],v[132:135],a[244:247],v[104:107]
ds_read_b128 v[132:135],v1 offset:18560
v_fma_f32 v88,v88,s36,v15
v_mfma_f32_16x16x32_bf16 v[104:107],v[136:139],a[248:251],v[104:107]
ds_read_b128 v[136:139],v0 offset:18688
v_cvt_pk_bf16_f32 v44,v80,v81
v_mfma_f32_16x16x32_bf16 v[104:107],v[140:143],a[252:255],v[104:107]
ds_read_b128 v[140:143],v1 offset:18688
v_cvt_pk_bf16_f32 v45,v82,v83
v_mfma_f32_16x16x32_bf16 v[104:107],v[112:115],v[144:147],v[104:107]
v_exp_f32 v88,v88
v_mfma_f32_16x16x32_bf16 v[104:107],v[116:119],v[148:151],v[104:107]
s_waitcnt lgkmcnt(4)
v_exp_f32 v89,v89
v_mfma_f32_16x16x32_bf16 v[76:79],v[120:123],a[144:147],0
buffer_load_dwordx4 v7,s[4:7],s20 offen offset:1024 lds
v_mfma_f32_16x16x32_bf16 v[76:79],v[124:127],a[148:151],v[76:79]
s_waitcnt lgkmcnt(3)
v_cvt_pk_bf16_f32 v48,v88,v89
v_mfma_f32_16x16x32_bf16 v[76:79],v[128:131],a[152:155],v[76:79]
s_waitcnt lgkmcnt(2)
v_mfma_f32_16x16x32_bf16 v[76:79],v[132:135],a[156:159],v[76:79]
s_waitcnt lgkmcnt(1)
v_mfma_f32_16x16x32_bf16 v[76:79],v[136:139],a[160:163],v[76:79]
s_waitcnt lgkmcnt(0)
v_mfma_f32_16x16x32_bf16 v[76:79],v[140:143],a[164:167],v[76:79]
v_mfma_f32_16x16x32_bf16 v[84:87],v[140:143],a[188:191],0
v_mfma_f32_16x16x32_bf16 v[84:87],v[136:139],a[184:187],v[84:87]
v_mfma_f32_16x16x32_bf16 v[84:87],v[132:135],a[180:183],v[84:87]
v_mfma_f32_16x16x32_bf16 v[84:87],v[128:131],a[176:179],v[84:87]
v_mfma_f32_16x16x32_bf16 v[84:87],v[124:127],a[172:175],v[84:87]
buffer_load_dwordx4 v8,s[4:7],s20 offen offset:2048 lds
v_mfma_f32_16x16x32_bf16 v[84:87],v[120:123],a[168:171],v[84:87]
s_add_u32 s20,s20,12288
v_mfma_f32_16x16x32_bf16 v[92:95],v[120:123],a[192:195],0
v_mfma_f32_16x16x32_bf16 v[92:95],v[124:127],a[196:199],v[92:95]
v_mfma_f32_16x16x32_bf16 v[92:95],v[128:131],a[200:203],v[92:95]
v_mfma_f32_16x16x32_bf16 v[92:95],v[132:135],a[204:207],v[92:95]
ds_read_b64_tr_b16 v[114:115],v2 offset:6144
v_mfma_f32_16x16x32_bf16 v[92:95],v[136:139],a[208:211],v[92:95]
ds_read_b64_tr_b16 v[112:113],v2 offset:0
v_mfma_f32_16x16x32_bf16 v[92:95],v[140:143],a[212:215],v[92:95]
v_mfma_f32_16x16x32_bf16 v[100:103],v[140:143],a[236:239],0
ds_read_b64_tr_b16 v[116:117],v3 offset:0
v_mfma_f32_16x16x32_bf16 v[100:103],v[136:139],a[232:235],v[100:103]
ds_read_b64_tr_b16 v[118:119],v3 offset:6144
v_mfma_f32_16x16x32_bf16 v[100:103],v[132:135],a[228:231],v[100:103]
v_mfma_f32_16x16x32_bf16 v[100:103],v[128:131],a[224:227],v[100:103]
v_mfma_f32_16x16x32_bf16 v[100:103],v[124:127],a[220:223],v[100:103]
v_mfma_f32_16x16x32_bf16 v[100:103],v[120:123],a[216:219],v[100:103]
v_mfma_f32_16x16x32_bf16 v[108:111],v[120:123],a[240:243],0
ds_read_b64_tr_b16 v[120:121],v4 offset:0
v_mfma_f32_16x16x32_bf16 v[108:111],v[124:127],a[244:247],v[108:111]
ds_read_b64_tr_b16 v[122:123],v4 offset:6144
v_mfma_f32_16x16x32_bf16 v[108:111],v[128:131],a[248:251],v[108:111]
ds_read_b64_tr_b16 v[124:125],v5 offset:0
v_mfma_f32_16x16x32_bf16 v[108:111],v[132:135],a[252:255],v[108:111]
ds_read_b64_tr_b16 v[126:127],v5 offset:6144
v_mfma_f32_16x16x32_bf16 v[108:111],v[136:139],v[144:147],v[108:111]
v_mfma_f32_16x16x32_bf16 v[108:111],v[140:143],v[148:151],v[108:111]
s_waitcnt lgkmcnt(4)
v_mfma_f32_16x16x32_bf16 v[160:163],v[112:115],v[20:23],v[160:163]
s_add_u32 m0,s23,0
ds_read_b64_tr_b16 v[128:129],v2 offset:128
v_fma_f32 v90,v90,s36,v15
v_mfma_f32_16x16x32_bf16 v[164:167],v[116:119],v[20:23],v[164:167]
ds_read_b64_tr_b16 v[130:131],v2 offset:6272
v_fma_f32 v91,v91,s36,v15
v_mfma_f32_16x16x32_bf16 v[212:215],v[116:119],v[24:27],v[212:215]
ds_read_b64_tr_b16 v[132:133],v3 offset:128
v_fma_f32 v96,v96,s36,v16
v_mfma_f32_16x16x32_bf16 v[208:211],v[112:115],v[24:27],v[208:211]
ds_read_b64_tr_b16 v[134:135],v3 offset:6272
v_fma_f32 v97,v97,s36,v16
v_mfma_f32_16x16x32_bf16 a[0:3],v[112:115],v[28:31],a[0:3]
ds_read_b64_tr_b16 v[136:137],v4 offset:128
v_fma_f32 v98,v98,s36,v16
v_mfma_f32_16x16x32_bf16 a[4:7],v[116:119],v[28:31],a[4:7]
ds_read_b64_tr_b16 v[138:139],v4 offset:6272
v_fma_f32 v99,v99,s36,v16
v_mfma_f32_16x16x32_bf16 a[52:55],v[116:119],v[32:35],a[52:55]
ds_read_b64_tr_b16 v[140:141],v5 offset:128
v_fma_f32 v104,v104,s36,v17
v_mfma_f32_16x16x32_bf16 a[48:51],v[112:115],v[32:35],a[48:51]
ds_read_b64_tr_b16 v[142:143],v5 offset:6272
v_fma_f32 v105,v105,s36,v17
v_mfma_f32_16x16x32_bf16 a[96:99],v[112:115],v[36:39],a[96:99]
ds_read_b64_tr_b16 v[112:113],v2 offset:256
v_fma_f32 v106,v106,s36,v17
v_mfma_f32_16x16x32_bf16 a[100:103],v[116:119],v[36:39],a[100:103]
s_waitcnt lgkmcnt(8)
ds_read_b64_tr_b16 v[114:115],v2 offset:6400
v_fma_f32 v107,v107,s36,v17
v_mfma_f32_16x16x32_bf16 a[104:107],v[120:123],v[36:39],a[104:107]
ds_read_b64_tr_b16 v[116:117],v3 offset:256
v_fma_f32 v76,v76,s36,v13
v_mfma_f32_16x16x32_bf16 a[108:111],v[124:127],v[36:39],a[108:111]
ds_read_b64_tr_b16 v[118:119],v3 offset:6400
v_fma_f32 v77,v77,s36,v13
v_mfma_f32_16x16x32_bf16 a[60:63],v[124:127],v[32:35],a[60:63]
v_exp_f32 v90,v90
v_mfma_f32_16x16x32_bf16 a[56:59],v[120:123],v[32:35],a[56:59]
v_exp_f32 v91,v91
v_mfma_f32_16x16x32_bf16 a[8:11],v[120:123],v[28:31],a[8:11]
v_cvt_pk_bf16_f32 v49,v90,v91
v_fma_f32 v78,v78,s36,v13
v_mfma_f32_16x16x32_bf16 a[12:15],v[124:127],v[28:31],a[12:15]
v_exp_f32 v96,v96
v_mfma_f32_16x16x32_bf16 v[220:223],v[124:127],v[24:27],v[220:223]
v_exp_f32 v97,v97
v_mfma_f32_16x16x32_bf16 v[216:219],v[120:123],v[24:27],v[216:219]
v_exp_f32 v98,v98
v_mfma_f32_16x16x32_bf16 v[168:171],v[120:123],v[20:23],v[168:171]
ds_read_b64_tr_b16 v[120:121],v4 offset:256
v_cvt_pk_bf16_f32 v52,v96,v97
v_mfma_f32_16x16x32_bf16 v[172:175],v[124:127],v[20:23],v[172:175]
s_waitcnt lgkmcnt(2)
ds_read_b64_tr_b16 v[122:123],v4 offset:6400
v_fma_f32 v79,v79,s36,v13
v_mfma_f32_16x16x32_bf16 v[176:179],v[128:131],v[20:23],v[176:179]
ds_read_b64_tr_b16 v[124:125],v5 offset:256
v_fma_f32 v84,v84,s36,v14
v_mfma_f32_16x16x32_bf16 v[180:183],v[132:135],v[20:23],v[180:183]
ds_read_b64_tr_b16 v[126:127],v5 offset:6400
v_fma_f32 v85,v85,s36,v14
v_mfma_f32_16x16x32_bf16 v[228:231],v[132:135],v[24:27],v[228:231]
v_exp_f32 v99,v99
v_mfma_f32_16x16x32_bf16 v[224:227],v[128:131],v[24:27],v[224:227]
v_cvt_pk_bf16_f32 v53,v98,v99
v_fma_f32 v86,v86,s36,v14
v_mfma_f32_16x16x32_bf16 a[16:19],v[128:131],v[28:31],a[16:19]
v_exp_f32 v104,v104
v_mfma_f32_16x16x32_bf16 a[20:23],v[132:135],v[28:31],a[20:23]
v_exp_f32 v105,v105
v_mfma_f32_16x16x32_bf16 a[68:71],v[132:135],v[32:35],a[68:71]
v_exp_f32 v106,v106
v_mfma_f32_16x16x32_bf16 a[64:67],v[128:131],v[32:35],a[64:67]
v_exp_f32 v107,v107
v_mfma_f32_16x16x32_bf16 a[112:115],v[128:131],v[36:39],a[112:115]
v_cvt_pk_bf16_f32 v56,v104,v105
v_cvt_pk_bf16_f32 v57,v106,v107
v_mfma_f32_16x16x32_bf16 a[116:119],v[132:135],v[36:39],a[116:119]
v_exp_f32 v76,v76
v_mfma_f32_16x16x32_bf16 a[120:123],v[136:139],v[36:39],a[120:123]
v_exp_f32 v77,v77
v_mfma_f32_16x16x32_bf16 a[124:127],v[140:143],v[36:39],a[124:127]
v_exp_f32 v78,v78
v_mfma_f32_16x16x32_bf16 a[76:79],v[140:143],v[32:35],a[76:79]
v_exp_f32 v79,v79
v_mfma_f32_16x16x32_bf16 a[72:75],v[136:139],v[32:35],a[72:75]
v_cvt_pk_bf16_f32 v42,v76,v77
v_cvt_pk_bf16_f32 v43,v78,v79
v_mfma_f32_16x16x32_bf16 a[24:27],v[136:139],v[28:31],a[24:27]
v_fma_f32 v87,v87,s36,v14
v_fma_f32 v92,v92,s36,v15
v_mfma_f32_16x16x32_bf16 a[28:31],v[140:143],v[28:31],a[28:31]
v_exp_f32 v84,v84
v_mfma_f32_16x16x32_bf16 v[236:239],v[140:143],v[24:27],v[236:239]
v_exp_f32 v85,v85
v_mfma_f32_16x16x32_bf16 v[232:235],v[136:139],v[24:27],v[232:235]
v_exp_f32 v86,v86
v_mfma_f32_16x16x32_bf16 v[184:187],v[136:139],v[20:23],v[184:187]
v_exp_f32 v87,v87
v_mfma_f32_16x16x32_bf16 v[188:191],v[140:143],v[20:23],v[188:191]
v_cvt_pk_bf16_f32 v46,v84,v85
v_cvt_pk_bf16_f32 v47,v86,v87
v_mfma_f32_16x16x32_bf16 v[192:195],v[112:115],v[20:23],v[192:195]
v_fma_f32 v93,v93,s36,v15
v_fma_f32 v94,v94,s36,v15
v_smfmac_f32_16x16x64_bf16 v[60:63],v[152:155],v[40:47],v18
v_fma_f32 v95,v95,s36,v15
s_waitcnt vmcnt(9)
s_waitcnt lgkmcnt(0)
v_mfma_f32_16x16x32_bf16 v[196:199],v[116:119],v[20:23],v[196:199]
s_barrier
v_mfma_f32_16x16x32_bf16 v[244:247],v[116:119],v[24:27],v[244:247]
ds_read_b128 v[128:131],v0 offset:24576
v_fma_f32 v100,v100,s36,v16
v_mfma_f32_16x16x32_bf16 v[240:243],v[112:115],v[24:27],v[240:243]
ds_read_b128 v[132:135],v1 offset:24576
v_fma_f32 v101,v101,s36,v16
v_mfma_f32_16x16x32_bf16 a[32:35],v[112:115],v[28:31],a[32:35]
ds_read_b128 v[136:139],v0 offset:24704
v_fma_f32 v102,v102,s36,v16
v_mfma_f32_16x16x32_bf16 a[36:39],v[116:119],v[28:31],a[36:39]
ds_read_b128 v[140:143],v1 offset:24704
v_fma_f32 v103,v103,s36,v16
v_mfma_f32_16x16x32_bf16 a[84:87],v[116:119],v[32:35],a[84:87]
ds_read_b128 v[156:159],v10 offset:6144
v_fma_f32 v108,v108,s36,v17
v_mfma_f32_16x16x32_bf16 a[80:83],v[112:115],v[32:35],a[80:83]
buffer_load_dwordx4 v6,s[8:11],s21 offen offset:0 lds
v_mfma_f32_16x16x32_bf16 a[128:131],v[112:115],v[36:39],a[128:131]
ds_read_b128 v[112:115],v0 offset:24832
v_fma_f32 v109,v109,s36,v17
v_mfma_f32_16x16x32_bf16 a[132:135],v[116:119],v[36:39],a[132:135]
ds_read_b128 v[116:119],v1 offset:24832
v_fma_f32 v110,v110,s36,v17
v_mfma_f32_16x16x32_bf16 a[136:139],v[120:123],v[36:39],a[136:139]
v_exp_f32 v92,v92
v_mfma_f32_16x16x32_bf16 a[140:143],v[124:127],v[36:39],a[140:143]
v_exp_f32 v93,v93
v_mfma_f32_16x16x32_bf16 a[92:95],v[124:127],v[32:35],a[92:95]
v_exp_f32 v94,v94
v_mfma_f32_16x16x32_bf16 a[88:91],v[120:123],v[32:35],a[88:91]
v_exp_f32 v95,v95
v_mfma_f32_16x16x32_bf16 a[40:43],v[120:123],v[28:31],a[40:43]
v_cvt_pk_bf16_f32 v50,v92,v93
v_cvt_pk_bf16_f32 v51,v94,v95
v_mfma_f32_16x16x32_bf16 a[44:47],v[124:127],v[28:31],a[44:47]
v_exp_f32 v100,v100
v_mfma_f32_16x16x32_bf16 v[252:255],v[124:127],v[24:27],v[252:255]
v_exp_f32 v101,v101
v_mfma_f32_16x16x32_bf16 v[248:251],v[120:123],v[24:27],v[248:251]
v_exp_f32 v102,v102
v_mfma_f32_16x16x32_bf16 v[200:203],v[120:123],v[20:23],v[200:203]
ds_read_b128 v[120:123],v0 offset:30720
v_cvt_pk_bf16_f32 v54,v100,v101
v_mfma_f32_16x16x32_bf16 v[204:207],v[124:127],v[20:23],v[204:207]
s_waitcnt lgkmcnt(1)
buffer_store_dwordx4 v[156:159],v9,s[16:19],s27 offen offset:0 nt
buffer_load_dwordx4 v7,s[8:11],s21 offen offset:1024 lds
v_mfma_f32_16x16x32_bf16 v[72:75],v[128:131],a[144:147],0
ds_read_b128 v[124:127],v1 offset:30720
v_fma_f32 v111,v111,s36,v17
v_mfma_f32_16x16x32_bf16 v[72:75],v[132:135],a[148:151],v[72:75]
v_exp_f32 v103,v103
v_mfma_f32_16x16x32_bf16 v[72:75],v[136:139],a[152:155],v[72:75]
v_cvt_pk_bf16_f32 v55,v102,v103
v_mfma_f32_16x16x32_bf16 v[72:75],v[140:143],a[156:159],v[72:75]
v_exp_f32 v108,v108
v_smfmac_f32_16x16x64_bf16 v[64:67],v[152:155],v[48:55],v18
v_mfma_f32_16x16x32_bf16 v[72:75],v[112:115],a[160:163],v[72:75]
ds_read_b128 v[156:159],v10 offset:7168
v_mfma_f32_16x16x32_bf16 v[72:75],v[116:119],a[164:167],v[72:75]
v_exp_f32 v109,v109
v_mfma_f32_16x16x32_bf16 v[80:83],v[116:119],a[188:191],0
v_exp_f32 v110,v110
v_mfma_f32_16x16x32_bf16 v[80:83],v[112:115],a[184:187],v[80:83]
v_exp_f32 v111,v111
v_mfma_f32_16x16x32_bf16 v[80:83],v[140:143],a[180:183],v[80:83]
buffer_load_dwordx4 v8,s[8:11],s21 offen offset:2048 lds
v_mfma_f32_16x16x32_bf16 v[80:83],v[136:139],a[176:179],v[80:83]
s_add_u32 s21,s21,12288
v_cvt_pk_bf16_f32 v58,v108,v109
v_cvt_pk_bf16_f32 v59,v110,v111
v_mfma_f32_16x16x32_bf16 v[80:83],v[132:135],a[172:175],v[80:83]
s_cmp_eq_u32 s38,1
v_fma_f32 v72,v72,s36,v13
v_fma_f32 v73,v73,s36,v13
v_smfmac_f32_16x16x64_bf16 v[68:71],v[152:155],v[52:59],v18
s_cselect_b32 s20,s26,s20
v_fma_f32 v74,v74,s36,v13
v_mfma_f32_16x16x32_bf16 v[80:83],v[128:131],a[168:171],v[80:83]
s_add_u32 m0,s22,12288
v_fma_f32 v75,v75,s36,v13
v_mfma_f32_16x16x32_bf16 v[88:91],v[128:131],a[192:195],0
v_exp_f32 v72,v72
v_mfma_f32_16x16x32_bf16 v[88:91],v[132:135],a[196:199],v[88:91]
v_exp_f32 v73,v73
v_mfma_f32_16x16x32_bf16 v[88:91],v[136:139],a[200:203],v[88:91]
v_exp_f32 v74,v74
v_mfma_f32_16x16x32_bf16 v[88:91],v[140:143],a[204:207],v[88:91]
v_fma_f32 v80,v80,s36,v14
v_fma_f32 v81,v81,s36,v14
v_mfma_f32_16x16x32_bf16 v[88:91],v[112:115],a[208:211],v[88:91]
v_fma_f32 v82,v82,s36,v14
v_fma_f32 v83,v83,s36,v14
v_mfma_f32_16x16x32_bf16 v[88:91],v[116:119],a[212:215],v[88:91]
v_exp_f32 v75,v75
v_mfma_f32_16x16x32_bf16 v[96:99],v[116:119],a[236:239],0
v_exp_f32 v80,v80
v_mfma_f32_16x16x32_bf16 v[96:99],v[112:115],a[232:235],v[96:99]
s_waitcnt lgkmcnt(0)
buffer_store_dwordx4 v[156:159],v9,s[16:19],s27 offen offset:128 nt
buffer_load_dwordx4 v6,s[4:7],s20 offen offset:0 lds
v_mfma_f32_16x16x32_bf16 v[96:99],v[140:143],a[228:231],v[96:99]
v_exp_f32 v81,v81
v_mfma_f32_16x16x32_bf16 v[96:99],v[136:139],a[224:227],v[96:99]
v_fma_f32 v88,v88,s36,v15
v_fma_f32 v89,v89,s36,v15
v_mfma_f32_16x16x32_bf16 v[96:99],v[132:135],a[220:223],v[96:99]
v_exp_f32 v82,v82
v_mfma_f32_16x16x32_bf16 v[96:99],v[128:131],a[216:219],v[96:99]
v_exp_f32 v83,v83
v_mfma_f32_16x16x32_bf16 v[104:107],v[128:131],a[240:243],0
ds_read_b128 v[128:131],v0 offset:30848
v_cvt_pk_bf16_f32 v20,v72,v73
v_mfma_f32_16x16x32_bf16 v[104:107],v[132:135],a[244:247],v[104:107]
ds_read_b128 v[156:159],v10 offset:8192
v_cvt_pk_bf16_f32 v21,v74,v75
v_mfma_f32_16x16x32_bf16 v[104:107],v[136:139],a[248:251],v[104:107]
ds_read_b128 v[132:135],v1 offset:30848
v_cvt_pk_bf16_f32 v24,v80,v81
v_mfma_f32_16x16x32_bf16 v[104:107],v[140:143],a[252:255],v[104:107]
ds_read_b128 v[136:139],v0 offset:30976
v_cvt_pk_bf16_f32 v25,v82,v83
v_mfma_f32_16x16x32_bf16 v[104:107],v[112:115],v[144:147],v[104:107]
ds_read_b128 v[140:143],v1 offset:30976
v_mfma_f32_16x16x32_bf16 v[104:107],v[116:119],v[148:151],v[104:107]
buffer_load_dwordx4 v7,s[4:7],s20 offen offset:1024 lds
v_mfma_f32_16x16x32_bf16 v[76:79],v[120:123],a[144:147],0
v_exp_f32 v88,v88
v_mfma_f32_16x16x32_bf16 v[76:79],v[124:127],a[148:151],v[76:79]
s_waitcnt lgkmcnt(4)
v_exp_f32 v89,v89
v_mfma_f32_16x16x32_bf16 v[76:79],v[128:131],a[152:155],v[76:79]
s_waitcnt lgkmcnt(2)
v_cvt_pk_bf16_f32 v28,v88,v89
v_mfma_f32_16x16x32_bf16 v[76:79],v[132:135],a[156:159],v[76:79]
s_waitcnt lgkmcnt(1)
v_mfma_f32_16x16x32_bf16 v[76:79],v[136:139],a[160:163],v[76:79]
s_waitcnt lgkmcnt(0)
v_mfma_f32_16x16x32_bf16 v[76:79],v[140:143],a[164:167],v[76:79]
v_mfma_f32_16x16x32_bf16 v[84:87],v[140:143],a[188:191],0
v_mfma_f32_16x16x32_bf16 v[84:87],v[136:139],a[184:187],v[84:87]
v_mfma_f32_16x16x32_bf16 v[84:87],v[132:135],a[180:183],v[84:87]
v_mfma_f32_16x16x32_bf16 v[84:87],v[128:131],a[176:179],v[84:87]
buffer_store_dwordx4 v[156:159],v9,s[16:19],s27 offen offset:256 nt
buffer_load_dwordx4 v8,s[4:7],s20 offen offset:2048 lds
v_mfma_f32_16x16x32_bf16 v[84:87],v[124:127],a[172:175],v[84:87]
s_add_u32 s20,s20,12288
v_mfma_f32_16x16x32_bf16 v[84:87],v[120:123],a[168:171],v[84:87]
s_add_u32 s27,s27,3072
v_mfma_f32_16x16x32_bf16 v[92:95],v[120:123],a[192:195],0
v_mfma_f32_16x16x32_bf16 v[92:95],v[124:127],a[196:199],v[92:95]
v_mfma_f32_16x16x32_bf16 v[92:95],v[128:131],a[200:203],v[92:95]
ds_read_b64_tr_b16 v[112:113],v2 offset:12288
v_mfma_f32_16x16x32_bf16 v[92:95],v[132:135],a[204:207],v[92:95]
ds_read_b64_tr_b16 v[114:115],v2 offset:18432
v_mfma_f32_16x16x32_bf16 v[92:95],v[136:139],a[208:211],v[92:95]
ds_read_b64_tr_b16 v[116:117],v3 offset:12288
v_mfma_f32_16x16x32_bf16 v[92:95],v[140:143],a[212:215],v[92:95]
ds_read_b64_tr_b16 v[118:119],v3 offset:18432
v_mfma_f32_16x16x32_bf16 v[100:103],v[140:143],a[236:239],0
v_mfma_f32_16x16x32_bf16 v[100:103],v[136:139],a[232:235],v[100:103]
v_mfma_f32_16x16x32_bf16 v[100:103],v[132:135],a[228:231],v[100:103]
v_mfma_f32_16x16x32_bf16 v[100:103],v[128:131],a[224:227],v[100:103]
v_mfma_f32_16x16x32_bf16 v[100:103],v[124:127],a[220:223],v[100:103]
v_mfma_f32_16x16x32_bf16 v[100:103],v[120:123],a[216:219],v[100:103]
v_mfma_f32_16x16x32_bf16 v[108:111],v[120:123],a[240:243],0
ds_read_b64_tr_b16 v[120:121],v4 offset:12288
v_mfma_f32_16x16x32_bf16 v[108:111],v[124:127],a[244:247],v[108:111]
ds_read_b64_tr_b16 v[122:123],v4 offset:18432
v_mfma_f32_16x16x32_bf16 v[108:111],v[128:131],a[248:251],v[108:111]
ds_read_b64_tr_b16 v[124:125],v5 offset:12288
v_mfma_f32_16x16x32_bf16 v[108:111],v[132:135],a[252:255],v[108:111]
ds_read_b64_tr_b16 v[126:127],v5 offset:18432
v_mfma_f32_16x16x32_bf16 v[108:111],v[136:139],v[144:147],v[108:111]
v_mfma_f32_16x16x32_bf16 v[108:111],v[140:143],v[148:151],v[108:111]
s_waitcnt lgkmcnt(4)
v_mfma_f32_16x16x32_bf16 v[160:163],v[112:115],v[40:43],v[160:163]
s_add_u32 m0,s29,0
ds_read_b64_tr_b16 v[130:131],v2 offset:18560
v_fma_f32 v91,v91,s36,v15
v_mfma_f32_16x16x32_bf16 v[164:167],v[116:119],v[40:43],v[164:167]
ds_read_b64_tr_b16 v[128:129],v2 offset:12416
v_fma_f32 v90,v90,s36,v15
v_mfma_f32_16x16x32_bf16 v[212:215],v[116:119],v[44:47],v[212:215]
ds_read_b64_tr_b16 v[132:133],v3 offset:12416
v_fma_f32 v99,v99,s36,v16
v_mfma_f32_16x16x32_bf16 v[208:211],v[112:115],v[44:47],v[208:211]
ds_read_b64_tr_b16 v[134:135],v3 offset:18560
v_fma_f32 v97,v97,s36,v16
v_mfma_f32_16x16x32_bf16 a[0:3],v[112:115],v[48:51],a[0:3]
ds_read_b64_tr_b16 v[138:139],v4 offset:18560
v_fma_f32 v96,v96,s36,v16
v_mfma_f32_16x16x32_bf16 a[4:7],v[116:119],v[48:51],a[4:7]
ds_read_b64_tr_b16 v[136:137],v4 offset:12416
v_fma_f32 v98,v98,s36,v16
v_mfma_f32_16x16x32_bf16 a[52:55],v[116:119],v[52:55],a[52:55]
ds_read_b64_tr_b16 v[142:143],v5 offset:18560
v_fma_f32 v104,v104,s36,v17
v_mfma_f32_16x16x32_bf16 a[48:51],v[112:115],v[52:55],a[48:51]
buffer_load_dwordx4 v6,s[12:15],s28 offen offset:0 nt lds
v_mfma_f32_16x16x32_bf16 a[96:99],v[112:115],v[56:59],a[96:99]
ds_read_b64_tr_b16 v[140:141],v5 offset:12416
v_fma_f32 v107,v107,s36,v17
v_mfma_f32_16x16x32_bf16 a[100:103],v[116:119],v[56:59],a[100:103]
s_waitcnt lgkmcnt(6)
ds_read_b64_tr_b16 v[112:113],v2 offset:12544
v_fma_f32 v106,v106,s36,v17
v_mfma_f32_16x16x32_bf16 a[104:107],v[120:123],v[56:59],a[104:107]
ds_read_b64_tr_b16 v[116:117],v3 offset:12544
v_fma_f32 v105,v105,s36,v17
v_mfma_f32_16x16x32_bf16 a[108:111],v[124:127],v[56:59],a[108:111]
ds_read_b64_tr_b16 v[114:115],v2 offset:18688
v_fma_f32 v79,v79,s36,v13
v_mfma_f32_16x16x32_bf16 a[60:63],v[124:127],v[52:55],a[60:63]
ds_read_b64_tr_b16 v[118:119],v3 offset:18688
v_fma_f32 v77,v77,s36,v13
v_mfma_f32_16x16x32_bf16 a[56:59],v[120:123],v[52:55],a[56:59]
v_exp_f32 v90,v90
v_mfma_f32_16x16x32_bf16 a[8:11],v[120:123],v[48:51],a[8:11]
v_exp_f32 v91,v91
v_mfma_f32_16x16x32_bf16 a[12:15],v[124:127],v[48:51],a[12:15]
v_cvt_pk_bf16_f32 v29,v90,v91
v_fma_f32 v76,v76,s36,v13
v_mfma_f32_16x16x32_bf16 v[220:223],v[124:127],v[44:47],v[220:223]
v_exp_f32 v98,v98
v_mfma_f32_16x16x32_bf16 v[216:219],v[120:123],v[44:47],v[216:219]
buffer_load_dwordx4 v7,s[12:15],s28 offen offset:1024 nt lds
v_mfma_f32_16x16x32_bf16 v[168:171],v[120:123],v[40:43],v[168:171]
ds_read_b64_tr_b16 v[122:123],v4 offset:18688
v_fma_f32 v78,v78,s36,v13
v_mfma_f32_16x16x32_bf16 v[172:175],v[124:127],v[40:43],v[172:175]
ds_read_b64_tr_b16 v[120:121],v4 offset:12544
v_fma_f32 v86,v86,s36,v14
v_mfma_f32_16x16x32_bf16 v[176:179],v[128:131],v[40:43],v[176:179]
s_waitcnt lgkmcnt(2)
ds_read_b64_tr_b16 v[124:125],v5 offset:12544
v_fma_f32 v87,v87,s36,v14
v_mfma_f32_16x16x32_bf16 v[180:183],v[132:135],v[40:43],v[180:183]
ds_read_b64_tr_b16 v[126:127],v5 offset:18688
v_fma_f32 v85,v85,s36,v14
v_mfma_f32_16x16x32_bf16 v[228:231],v[132:135],v[44:47],v[228:231]
v_exp_f32 v97,v97
v_mfma_f32_16x16x32_bf16 v[224:227],v[128:131],v[44:47],v[224:227]
v_exp_f32 v99,v99
v_mfma_f32_16x16x32_bf16 a[16:19],v[128:131],v[48:51],a[16:19]
v_exp_f32 v96,v96
v_mfma_f32_16x16x32_bf16 a[20:23],v[132:135],v[48:51],a[20:23]
v_cvt_pk_bf16_f32 v32,v96,v97
v_cvt_pk_bf16_f32 v33,v98,v99
v_mfma_f32_16x16x32_bf16 a[68:71],v[132:135],v[52:55],a[68:71]
v_exp_f32 v107,v107
v_mfma_f32_16x16x32_bf16 a[64:67],v[128:131],v[52:55],a[64:67]
buffer_load_dwordx4 v8,s[12:15],s28 offen offset:2048 nt lds
v_mfma_f32_16x16x32_bf16 a[112:115],v[128:131],v[56:59],a[112:115]
s_add_u32 s28,s28,3072
v_exp_f32 v105,v105
v_mfma_f32_16x16x32_bf16 a[116:119],v[132:135],v[56:59],a[116:119]
s_add_u32 s29,s29,3072
v_exp_f32 v106,v106
v_mfma_f32_16x16x32_bf16 a[120:123],v[136:139],v[56:59],a[120:123]
s_cmp_eq_u32 s38,1
v_exp_f32 v104,v104
v_mfma_f32_16x16x32_bf16 a[124:127],v[140:143],v[56:59],a[124:127]
s_cselect_b32 s21,s26,s21
v_cvt_pk_bf16_f32 v36,v104,v105
v_cvt_pk_bf16_f32 v37,v106,v107
v_mfma_f32_16x16x32_bf16 a[76:79],v[140:143],v[52:55],a[76:79]
s_add_u32 m0,s23,12288
v_exp_f32 v77,v77
v_mfma_f32_16x16x32_bf16 a[72:75],v[136:139],v[52:55],a[72:75]
v_exp_f32 v76,v76
v_mfma_f32_16x16x32_bf16 a[24:27],v[136:139],v[48:51],a[24:27]
v_exp_f32 v78,v78
v_mfma_f32_16x16x32_bf16 a[28:31],v[140:143],v[48:51],a[28:31]
v_exp_f32 v79,v79
v_mfma_f32_16x16x32_bf16 v[236:239],v[140:143],v[44:47],v[236:239]
v_cvt_pk_bf16_f32 v23,v78,v79
v_cvt_pk_bf16_f32 v22,v76,v77
v_mfma_f32_16x16x32_bf16 v[232:235],v[136:139],v[44:47],v[232:235]
v_exp_f32 v86,v86
v_mfma_f32_16x16x32_bf16 v[184:187],v[136:139],v[40:43],v[184:187]
v_exp_f32 v87,v87
v_mfma_f32_16x16x32_bf16 v[188:191],v[140:143],v[40:43],v[188:191]
v_exp_f32 v85,v85
v_mfma_f32_16x16x32_bf16 v[192:195],v[112:115],v[40:43],v[192:195]
v_cvt_pk_bf16_f32 v27,v86,v87
v_fma_f32 v84,v84,s36,v14
s_waitcnt vmcnt(12) lgkmcnt(0)
v_mfma_f32_16x16x32_bf16 v[196:199],v[116:119],v[40:43],v[196:199]
s_barrier
v_mfma_f32_16x16x32_bf16 v[244:247],v[116:119],v[44:47],v[244:247]
ds_read_b128 v[128:131],v0 offset:0
v_fma_f32 v95,v95,s36,v15
v_mfma_f32_16x16x32_bf16 v[240:243],v[112:115],v[44:47],v[240:243]
ds_read_b128 v[132:135],v1 offset:0
v_fma_f32 v92,v92,s36,v15
v_mfma_f32_16x16x32_bf16 a[32:35],v[112:115],v[48:51],a[32:35]
ds_read_b128 v[136:139],v0 offset:128
v_fma_f32 v94,v94,s36,v15
v_mfma_f32_16x16x32_bf16 a[36:39],v[116:119],v[48:51],a[36:39]
ds_read_b128 v[140:143],v1 offset:128
v_fma_f32 v93,v93,s36,v15
v_mfma_f32_16x16x32_bf16 a[84:87],v[116:119],v[52:55],a[84:87]
v_exp_f32 v84,v84
v_mfma_f32_16x16x32_bf16 a[80:83],v[112:115],v[52:55],a[80:83]
buffer_load_dwordx4 v6,s[8:11],s21 offen offset:0 lds
v_mfma_f32_16x16x32_bf16 a[128:131],v[112:115],v[56:59],a[128:131]
ds_read_b128 v[112:115],v0 offset:256
v_cvt_pk_bf16_f32 v26,v84,v85
v_mfma_f32_16x16x32_bf16 a[132:135],v[116:119],v[56:59],a[132:135]
ds_read_b128 v[116:119],v1 offset:256
v_fma_f32 v103,v103,s36,v16
v_smfmac_f32_16x16x64_bf16 v[60:63],v[152:155],v[20:27],v18
v_fma_f32 v101,v101,s36,v16
v_mfma_f32_16x16x32_bf16 a[136:139],v[120:123],v[56:59],a[136:139]
v_exp_f32 v92,v92
v_mfma_f32_16x16x32_bf16 a[140:143],v[124:127],v[56:59],a[140:143]
v_exp_f32 v93,v93
v_mfma_f32_16x16x32_bf16 a[92:95],v[124:127],v[52:55],a[92:95]
v_exp_f32 v94,v94
v_mfma_f32_16x16x32_bf16 a[88:91],v[120:123],v[52:55],a[88:91]
v_exp_f32 v95,v95
v_mfma_f32_16x16x32_bf16 a[40:43],v[120:123],v[48:51],a[40:43]
v_cvt_pk_bf16_f32 v31,v94,v95
v_cvt_pk_bf16_f32 v30,v92,v93
v_mfma_f32_16x16x32_bf16 a[44:47],v[124:127],v[48:51],a[44:47]
v_exp_f32 v103,v103
v_mfma_f32_16x16x32_bf16 v[252:255],v[124:127],v[44:47],v[252:255]
v_exp_f32 v101,v101
v_mfma_f32_16x16x32_bf16 v[248:251],v[120:123],v[44:47],v[248:251]
v_fma_f32 v100,v100,s36,v16
v_fma_f32 v102,v102,s36,v16
v_mfma_f32_16x16x32_bf16 v[200:203],v[120:123],v[40:43],v[200:203]
buffer_load_dwordx4 v7,s[8:11],s21 offen offset:1024 lds
v_mfma_f32_16x16x32_bf16 v[204:207],v[124:127],v[40:43],v[204:207]
s_waitcnt lgkmcnt(0)
ds_read_b128 v[120:123],v0 offset:6144
v_fma_f32 v108,v108,s36,v17
v_mfma_f32_16x16x32_bf16 v[72:75],v[128:131],a[144:147],0
ds_read_b128 v[124:127],v1 offset:6144
v_fma_f32 v111,v111,s36,v17
v_mfma_f32_16x16x32_bf16 v[72:75],v[132:135],a[148:151],v[72:75]
v_exp_f32 v100,v100
v_mfma_f32_16x16x32_bf16 v[72:75],v[136:139],a[152:155],v[72:75]
v_exp_f32 v102,v102
v_mfma_f32_16x16x32_bf16 v[72:75],v[140:143],a[156:159],v[72:75]
v_cvt_pk_bf16_f32 v35,v102,v103
v_cvt_pk_bf16_f32 v34,v100,v101
v_mfma_f32_16x16x32_bf16 v[72:75],v[112:115],a[160:163],v[72:75]
v_exp_f32 v111,v111
v_smfmac_f32_16x16x64_bf16 v[64:67],v[152:155],v[28:35],v18
v_fma_f32 v110,v110,s36,v17
v_mfma_f32_16x16x32_bf16 v[72:75],v[116:119],a[164:167],v[72:75]
v_exp_f32 v110,v110
v_mfma_f32_16x16x32_bf16 v[80:83],v[116:119],a[188:191],0
v_exp_f32 v108,v108
v_mfma_f32_16x16x32_bf16 v[80:83],v[112:115],a[184:187],v[80:83]
v_fma_f32 v109,v109,s36,v17
v_cvt_pk_bf16_f32 v39,v110,v111
v_mfma_f32_16x16x32_bf16 v[80:83],v[140:143],a[180:183],v[80:83]
buffer_load_dwordx4 v8,s[8:11],s21 offen offset:2048 lds
v_mfma_f32_16x16x32_bf16 v[80:83],v[136:139],a[176:179],v[80:83]
s_add_u32 s21,s21,12288
v_exp_f32 v109,v109
v_mfma_f32_16x16x32_bf16 v[80:83],v[132:135],a[172:175],v[80:83]
s_add_u32 m0,s22,24576
v_cvt_pk_bf16_f32 v38,v108,v109
v_fma_f32 v75,v75,s36,v13
v_mfma_f32_16x16x32_bf16 v[80:83],v[128:131],a[168:171],v[80:83]
v_exp_f32 v75,v75
v_smfmac_f32_16x16x64_bf16 v[68:71],v[152:155],v[32:39],v18
v_fma_f32 v73,v73,s36,v13
v_mfma_f32_16x16x32_bf16 v[88:91],v[128:131],a[192:195],0
v_exp_f32 v73,v73
v_mfma_f32_16x16x32_bf16 v[88:91],v[132:135],a[196:199],v[88:91]
v_fma_f32 v74,v74,s36,v13
v_fma_f32 v72,v72,s36,v13
v_mfma_f32_16x16x32_bf16 v[88:91],v[136:139],a[200:203],v[88:91]
v_exp_f32 v74,v74
v_mfma_f32_16x16x32_bf16 v[88:91],v[140:143],a[204:207],v[88:91]
v_exp_f32 v72,v72
v_mfma_f32_16x16x32_bf16 v[88:91],v[112:115],a[208:211],v[88:91]
v_fma_f32 v83,v83,s36,v14
v_fma_f32 v80,v80,s36,v14
v_mfma_f32_16x16x32_bf16 v[88:91],v[116:119],a[212:215],v[88:91]
v_exp_f32 v80,v80
v_mfma_f32_16x16x32_bf16 v[96:99],v[116:119],a[236:239],0
buffer_load_dwordx4 v6,s[4:7],s20 offen offset:0 lds
v_mfma_f32_16x16x32_bf16 v[96:99],v[112:115],a[232:235],v[96:99]
v_exp_f32 v83,v83
v_mfma_f32_16x16x32_bf16 v[96:99],v[140:143],a[228:231],v[96:99]
v_fma_f32 v82,v82,s36,v14
v_fma_f32 v81,v81,s36,v14
v_mfma_f32_16x16x32_bf16 v[96:99],v[136:139],a[224:227],v[96:99]
v_exp_f32 v81,v81
v_mfma_f32_16x16x32_bf16 v[96:99],v[132:135],a[220:223],v[96:99]
v_exp_f32 v82,v82
v_mfma_f32_16x16x32_bf16 v[96:99],v[128:131],a[216:219],v[96:99]
v_fma_f32 v88,v88,s36,v15
v_fma_f32 v89,v89,s36,v15
v_mfma_f32_16x16x32_bf16 v[104:107],v[128:131],a[240:243],0
ds_read_b128 v[128:131],v0 offset:6272
v_cvt_pk_bf16_f32 v41,v74,v75
v_mfma_f32_16x16x32_bf16 v[104:107],v[132:135],a[244:247],v[104:107]
ds_read_b128 v[132:135],v1 offset:6272
v_cvt_pk_bf16_f32 v45,v82,v83
v_mfma_f32_16x16x32_bf16 v[104:107],v[136:139],a[248:251],v[104:107]
ds_read_b128 v[136:139],v0 offset:6400
v_cvt_pk_bf16_f32 v40,v72,v73
v_mfma_f32_16x16x32_bf16 v[104:107],v[140:143],a[252:255],v[104:107]
ds_read_b128 v[140:143],v1 offset:6400
v_add_u32 v10,9216,v10
v_mfma_f32_16x16x32_bf16 v[104:107],v[112:115],v[144:147],v[104:107]
v_exp_f32 v88,v88
v_mfma_f32_16x16x32_bf16 v[104:107],v[116:119],v[148:151],v[104:107]
s_waitcnt lgkmcnt(4)
v_exp_f32 v89,v89
v_mfma_f32_16x16x32_bf16 v[76:79],v[120:123],a[144:147],0
buffer_load_dwordx4 v7,s[4:7],s20 offen offset:1024 lds
v_mfma_f32_16x16x32_bf16 v[76:79],v[124:127],a[148:151],v[76:79]
s_waitcnt lgkmcnt(3)
v_cvt_pk_bf16_f32 v48,v88,v89
v_cvt_pk_bf16_f32 v44,v80,v81
v_mfma_f32_16x16x32_bf16 v[76:79],v[128:131],a[152:155],v[76:79]
s_waitcnt lgkmcnt(2)
v_mfma_f32_16x16x32_bf16 v[76:79],v[132:135],a[156:159],v[76:79]
s_waitcnt lgkmcnt(1)
v_mfma_f32_16x16x32_bf16 v[76:79],v[136:139],a[160:163],v[76:79]
s_waitcnt lgkmcnt(0)
v_mfma_f32_16x16x32_bf16 v[76:79],v[140:143],a[164:167],v[76:79]
v_mfma_f32_16x16x32_bf16 v[84:87],v[140:143],a[188:191],0
v_mfma_f32_16x16x32_bf16 v[84:87],v[136:139],a[184:187],v[84:87]
v_mfma_f32_16x16x32_bf16 v[84:87],v[132:135],a[180:183],v[84:87]
v_mfma_f32_16x16x32_bf16 v[84:87],v[128:131],a[176:179],v[84:87]
v_mfma_f32_16x16x32_bf16 v[84:87],v[124:127],a[172:175],v[84:87]
buffer_load_dwordx4 v8,s[4:7],s20 offen offset:2048 lds
v_mfma_f32_16x16x32_bf16 v[84:87],v[120:123],a[168:171],v[84:87]
s_add_u32 s20,s20,12288
s_add_u32 s38,s38,1
s_cmp_lt_u32 s38,2
v_mfma_f32_16x16x32_bf16 v[92:95],v[120:123],a[192:195],0
v_mfma_f32_16x16x32_bf16 v[92:95],v[124:127],a[196:199],v[92:95]
v_mfma_f32_16x16x32_bf16 v[92:95],v[128:131],a[200:203],v[92:95]
v_mfma_f32_16x16x32_bf16 v[92:95],v[132:135],a[204:207],v[92:95]
ds_read_b64_tr_b16 v[114:115],v2 offset:30720
v_mfma_f32_16x16x32_bf16 v[92:95],v[136:139],a[208:211],v[92:95]
ds_read_b64_tr_b16 v[112:113],v2 offset:24576
v_mfma_f32_16x16x32_bf16 v[92:95],v[140:143],a[212:215],v[92:95]
v_mfma_f32_16x16x32_bf16 v[100:103],v[140:143],a[236:239],0
ds_read_b64_tr_b16 v[118:119],v3 offset:30720
v_mfma_f32_16x16x32_bf16 v[100:103],v[136:139],a[232:235],v[100:103]
ds_read_b64_tr_b16 v[116:117],v3 offset:24576
v_mfma_f32_16x16x32_bf16 v[100:103],v[132:135],a[228:231],v[100:103]
v_mfma_f32_16x16x32_bf16 v[100:103],v[128:131],a[224:227],v[100:103]
v_mfma_f32_16x16x32_bf16 v[100:103],v[124:127],a[220:223],v[100:103]
v_mfma_f32_16x16x32_bf16 v[100:103],v[120:123],a[216:219],v[100:103]
v_mfma_f32_16x16x32_bf16 v[108:111],v[120:123],a[240:243],0
ds_read_b64_tr_b16 v[120:121],v4 offset:24576
v_mfma_f32_16x16x32_bf16 v[108:111],v[124:127],a[244:247],v[108:111]
ds_read_b64_tr_b16 v[122:123],v4 offset:30720
v_mfma_f32_16x16x32_bf16 v[108:111],v[128:131],a[248:251],v[108:111]
ds_read_b64_tr_b16 v[124:125],v5 offset:24576
v_mfma_f32_16x16x32_bf16 v[108:111],v[132:135],a[252:255],v[108:111]
ds_read_b64_tr_b16 v[126:127],v5 offset:30720
v_mfma_f32_16x16x32_bf16 v[108:111],v[136:139],v[144:147],v[108:111]
v_mfma_f32_16x16x32_bf16 v[108:111],v[140:143],v[148:151],v[108:111]
s_cbranch_scc1 L_loop5w0
s_cmp_ge_u32 s69,6
s_cbranch_scc1 L_end5
s_cmp_eq_u32 s40,0
s_cbranch_scc1 L_tr54
s_branch L_tr55
L_tr54:
s_waitcnt vmcnt(42)
s_waitcnt lgkmcnt(4)
v_mfma_f32_16x16x32_bf16 v[160:163],v[112:115],v[20:23],v[160:163]
s_add_u32 m0,s24,0
ds_read_b128 a[144:147],v11 offset:0
v_fma_f32 v90,v90,s36,v15
v_mfma_f32_16x16x32_bf16 v[164:167],v[116:119],v[20:23],v[164:167]
ds_read_b128 a[148:151],v12 offset:0
v_fma_f32 v91,v91,s36,v15
v_mfma_f32_16x16x32_bf16 v[212:215],v[116:119],v[24:27],v[212:215]
ds_read_b128 a[152:155],v11 offset:128
v_fma_f32 v96,v96,s36,v16
v_mfma_f32_16x16x32_bf16 v[208:211],v[112:115],v[24:27],v[208:211]
ds_read_b128 a[156:159],v12 offset:128
v_fma_f32 v97,v97,s36,v16
v_mfma_f32_16x16x32_bf16 a[0:3],v[112:115],v[28:31],a[0:3]
ds_read_b128 a[160:163],v11 offset:256
v_fma_f32 v98,v98,s36,v16
v_mfma_f32_16x16x32_bf16 a[4:7],v[116:119],v[28:31],a[4:7]
ds_read_b128 a[164:167],v12 offset:256
v_fma_f32 v99,v99,s36,v16
ds_read_b64_tr_b16 v[128:129],v2 offset:24704
ds_read_b64_tr_b16 v[130:131],v2 offset:30848
ds_read_b64_tr_b16 v[132:133],v3 offset:24704
ds_read_b64_tr_b16 v[134:135],v3 offset:30848
ds_read_b64_tr_b16 v[136:137],v4 offset:24704
ds_read_b64_tr_b16 v[138:139],v4 offset:30848
ds_read_b64_tr_b16 v[140:141],v5 offset:24704
ds_read_b64_tr_b16 v[142:143],v5 offset:30848
ds_read_b128 a[168:171],v11 offset:6144
v_mfma_f32_16x16x32_bf16 a[52:55],v[116:119],v[32:35],a[52:55]
v_fma_f32 v104,v104,s36,v17
ds_read_b128 a[172:175],v12 offset:6144
v_mfma_f32_16x16x32_bf16 a[48:51],v[112:115],v[32:35],a[48:51]
v_fma_f32 v105,v105,s36,v17
ds_read_b128 a[176:179],v11 offset:6272
v_mfma_f32_16x16x32_bf16 a[96:99],v[112:115],v[36:39],a[96:99]
s_waitcnt lgkmcnt(11)
buffer_load_dwordx4 v6,s[12:15],s28 offen offset:0 nt lds
v_mfma_f32_16x16x32_bf16 a[100:103],v[116:119],v[36:39],a[100:103]
ds_read_b64_tr_b16 v[112:113],v2 offset:24832
ds_read_b128 a[180:183],v12 offset:6272
v_mfma_f32_16x16x32_bf16 a[104:107],v[120:123],v[36:39],a[104:107]
v_fma_f32 v106,v106,s36,v17
ds_read_b128 a[184:187],v11 offset:6400
v_mfma_f32_16x16x32_bf16 a[108:111],v[124:127],v[36:39],a[108:111]
v_fma_f32 v107,v107,s36,v17
ds_read_b128 a[188:191],v12 offset:6400
v_mfma_f32_16x16x32_bf16 a[60:63],v[124:127],v[32:35],a[60:63]
v_fma_f32 v76,v76,s36,v13
v_fma_f32 v77,v77,s36,v13
v_mfma_f32_16x16x32_bf16 a[56:59],v[120:123],v[32:35],a[56:59]
buffer_load_dwordx4 v7,s[12:15],s28 offen offset:1024 nt lds
v_mfma_f32_16x16x32_bf16 a[8:11],v[120:123],v[28:31],a[8:11]
ds_read_b64_tr_b16 v[114:115],v2 offset:30976
ds_read_b64_tr_b16 v[116:117],v3 offset:24832
ds_read_b64_tr_b16 v[118:119],v3 offset:30976
v_mfma_f32_16x16x32_bf16 a[12:15],v[124:127],v[28:31],a[12:15]
v_fma_f32 v78,v78,s36,v13
v_fma_f32 v79,v79,s36,v13
v_mfma_f32_16x16x32_bf16 v[220:223],v[124:127],v[24:27],v[220:223]
v_fma_f32 v84,v84,s36,v14
v_fma_f32 v85,v85,s36,v14
v_mfma_f32_16x16x32_bf16 v[216:219],v[120:123],v[24:27],v[216:219]
v_fma_f32 v86,v86,s36,v14
v_fma_f32 v87,v87,s36,v14
v_mfma_f32_16x16x32_bf16 v[168:171],v[120:123],v[20:23],v[168:171]
ds_read_b64_tr_b16 v[120:121],v4 offset:24832
v_fma_f32 v92,v92,s36,v15
v_mfma_f32_16x16x32_bf16 v[172:175],v[124:127],v[20:23],v[172:175]
s_waitcnt lgkmcnt(4)
ds_read_b64_tr_b16 v[122:123],v4 offset:30976
v_fma_f32 v93,v93,s36,v15
v_mfma_f32_16x16x32_bf16 v[176:179],v[128:131],v[20:23],v[176:179]
buffer_load_dwordx4 v8,s[12:15],s28 offen offset:2048 nt lds
v_mfma_f32_16x16x32_bf16 v[180:183],v[132:135],v[20:23],v[180:183]
s_add_u32 s28,s28,3072
ds_read_b64_tr_b16 v[124:125],v5 offset:24832
v_fma_f32 v94,v94,s36,v15
v_mfma_f32_16x16x32_bf16 v[228:231],v[132:135],v[24:27],v[228:231]
s_add_u32 m0,s24,3072
ds_read_b64_tr_b16 v[126:127],v5 offset:30976
v_fma_f32 v95,v95,s36,v15
v_mfma_f32_16x16x32_bf16 v[224:227],v[128:131],v[24:27],v[224:227]
v_fma_f32 v100,v100,s36,v16
v_fma_f32 v101,v101,s36,v16
v_mfma_f32_16x16x32_bf16 a[16:19],v[128:131],v[28:31],a[16:19]
v_fma_f32 v102,v102,s36,v16
v_fma_f32 v103,v103,s36,v16
v_mfma_f32_16x16x32_bf16 a[20:23],v[132:135],v[28:31],a[20:23]
v_fma_f32 v108,v108,s36,v17
v_fma_f32 v109,v109,s36,v17
v_mfma_f32_16x16x32_bf16 a[68:71],v[132:135],v[32:35],a[68:71]
v_fma_f32 v110,v110,s36,v17
v_fma_f32 v111,v111,s36,v17
v_mfma_f32_16x16x32_bf16 a[64:67],v[128:131],v[32:35],a[64:67]
v_exp_f32 v90,v90
v_mfma_f32_16x16x32_bf16 a[112:115],v[128:131],v[36:39],a[112:115]
buffer_load_dwordx4 v6,s[12:15],s28 offen offset:0 nt lds
v_mfma_f32_16x16x32_bf16 a[116:119],v[132:135],v[36:39],a[116:119]
v_exp_f32 v91,v91
v_mfma_f32_16x16x32_bf16 a[120:123],v[136:139],v[36:39],a[120:123]
v_exp_f32 v96,v96
v_mfma_f32_16x16x32_bf16 a[124:127],v[140:143],v[36:39],a[124:127]
v_exp_f32 v97,v97
v_mfma_f32_16x16x32_bf16 a[76:79],v[140:143],v[32:35],a[76:79]
v_exp_f32 v98,v98
v_mfma_f32_16x16x32_bf16 a[72:75],v[136:139],v[32:35],a[72:75]
v_exp_f32 v99,v99
v_mfma_f32_16x16x32_bf16 a[24:27],v[136:139],v[28:31],a[24:27]
v_exp_f32 v104,v104
v_mfma_f32_16x16x32_bf16 a[28:31],v[140:143],v[28:31],a[28:31]
v_exp_f32 v105,v105
v_mfma_f32_16x16x32_bf16 v[236:239],v[140:143],v[24:27],v[236:239]
buffer_load_dwordx4 v7,s[12:15],s28 offen offset:1024 nt lds
v_mfma_f32_16x16x32_bf16 v[232:235],v[136:139],v[24:27],v[232:235]
v_exp_f32 v106,v106
v_mfma_f32_16x16x32_bf16 v[184:187],v[136:139],v[20:23],v[184:187]
v_exp_f32 v107,v107
v_mfma_f32_16x16x32_bf16 v[188:191],v[140:143],v[20:23],v[188:191]
s_waitcnt lgkmcnt(0)
v_exp_f32 v76,v76
v_mfma_f32_16x16x32_bf16 v[192:195],v[112:115],v[20:23],v[192:195]
v_exp_f32 v77,v77
v_mfma_f32_16x16x32_bf16 v[196:199],v[116:119],v[20:23],v[196:199]
v_exp_f32 v78,v78
v_mfma_f32_16x16x32_bf16 v[244:247],v[116:119],v[24:27],v[244:247]
v_exp_f32 v79,v79
v_mfma_f32_16x16x32_bf16 v[240:243],v[112:115],v[24:27],v[240:243]
v_exp_f32 v84,v84
v_mfma_f32_16x16x32_bf16 a[32:35],v[112:115],v[28:31],a[32:35]
buffer_load_dwordx4 v8,s[12:15],s28 offen offset:2048 nt lds
s_waitcnt vmcnt(20)
s_barrier
v_mfma_f32_16x16x32_bf16 a[36:39],v[116:119],v[28:31],a[36:39]
s_add_u32 s28,s28,3072
v_exp_f32 v85,v85
v_mfma_f32_16x16x32_bf16 a[84:87],v[116:119],v[32:35],a[84:87]
s_add_u32 m0,s22,0
v_exp_f32 v86,v86
v_mfma_f32_16x16x32_bf16 a[80:83],v[112:115],v[32:35],a[80:83]
buffer_load_dwordx4 v6,s[4:7],s25 offen offset:0 lds
v_mfma_f32_16x16x32_bf16 a[128:131],v[112:115],v[36:39],a[128:131]
buffer_load_dwordx4 v7,s[4:7],s25 offen offset:1024 lds
v_mfma_f32_16x16x32_bf16 a[132:135],v[116:119],v[36:39],a[132:135]
buffer_load_dwordx4 v8,s[4:7],s25 offen offset:2048 lds
v_mfma_f32_16x16x32_bf16 a[136:139],v[120:123],v[36:39],a[136:139]
v_exp_f32 v87,v87
v_mfma_f32_16x16x32_bf16 a[140:143],v[124:127],v[36:39],a[140:143]
v_exp_f32 v92,v92
v_mfma_f32_16x16x32_bf16 a[92:95],v[124:127],v[32:35],a[92:95]
v_exp_f32 v93,v93
v_mfma_f32_16x16x32_bf16 a[88:91],v[120:123],v[32:35],a[88:91]
v_exp_f32 v94,v94
v_mfma_f32_16x16x32_bf16 a[40:43],v[120:123],v[28:31],a[40:43]
ds_read_b64_tr_b16 v[128:129],v2 offset:0
v_exp_f32 v95,v95
v_mfma_f32_16x16x32_bf16 a[44:47],v[124:127],v[28:31],a[44:47]
ds_read_b64_tr_b16 v[130:131],v2 offset:6144
v_exp_f32 v100,v100
v_mfma_f32_16x16x32_bf16 v[252:255],v[124:127],v[24:27],v[252:255]
ds_read_b64_tr_b16 v[132:133],v3 offset:0
v_exp_f32 v101,v101
v_mfma_f32_16x16x32_bf16 v[248:251],v[120:123],v[24:27],v[248:251]
ds_read_b64_tr_b16 v[134:135],v3 offset:6144
v_exp_f32 v102,v102
v_mfma_f32_16x16x32_bf16 v[200:203],v[120:123],v[20:23],v[200:203]
ds_read_b64_tr_b16 v[136:137],v4 offset:0
v_exp_f32 v103,v103
v_mfma_f32_16x16x32_bf16 v[204:207],v[124:127],v[20:23],v[204:207]
ds_read_b64_tr_b16 v[138:139],v4 offset:6144
ds_read_b64_tr_b16 v[140:141],v5 offset:0
ds_read_b64_tr_b16 v[142:143],v5 offset:6144
v_exp_f32 v108,v108
v_exp_f32 v109,v109
v_exp_f32 v110,v110
v_exp_f32 v111,v111
v_cvt_pk_bf16_f32 v49,v90,v91
v_cvt_pk_bf16_f32 v52,v96,v97
v_cvt_pk_bf16_f32 v53,v98,v99
v_cvt_pk_bf16_f32 v56,v104,v105
v_cvt_pk_bf16_f32 v57,v106,v107
v_cvt_pk_bf16_f32 v42,v76,v77
v_cvt_pk_bf16_f32 v43,v78,v79
v_cvt_pk_bf16_f32 v46,v84,v85
v_cvt_pk_bf16_f32 v47,v86,v87
v_cvt_pk_bf16_f32 v50,v92,v93
v_cvt_pk_bf16_f32 v51,v94,v95
v_smfmac_f32_16x16x64_bf16 v[60:63],v[152:155],v[40:47],v18
v_cvt_pk_bf16_f32 v54,v100,v101
v_cvt_pk_bf16_f32 v55,v102,v103
v_cvt_pk_bf16_f32 v58,v108,v109
v_cvt_pk_bf16_f32 v59,v110,v111
v_smfmac_f32_16x16x64_bf16 v[64:67],v[152:155],v[48:55],v18
v_subrev_u32 v10,18432,v10
v_smfmac_f32_16x16x64_bf16 v[68:71],v[152:155],v[52:59],v18
s_waitcnt lgkmcnt(0)
v_mfma_f32_16x16x32_bf16 v[160:163],v[128:131],v[40:43],v[160:163]
s_add_u32 s87,s42,18432
ds_read_b64_tr_b16 v[112:113],v2 offset:128
v_mbcnt_lo_u32_b32 v39,-1,0
v_mfma_f32_16x16x32_bf16 v[164:167],v[132:135],v[40:43],v[164:167]
s_add_u32 s66,s42,24576
ds_read_b64_tr_b16 v[114:115],v2 offset:6272
v_mbcnt_hi_u32_b32 v39,-1,v39
v_mfma_f32_16x16x32_bf16 v[212:215],v[132:135],v[44:47],v[212:215]
ds_read_b64_tr_b16 v[116:117],v3 offset:128
v_and_b32 v38,7,v39
v_mfma_f32_16x16x32_bf16 v[208:211],v[128:131],v[44:47],v[208:211]
ds_read_b64_tr_b16 v[118:119],v3 offset:6272
v_add_f32 v60,v60,v61
v_mfma_f32_16x16x32_bf16 a[0:3],v[128:131],v[48:51],a[0:3]
ds_read_b64_tr_b16 v[120:121],v4 offset:128
v_add_f32 v62,v62,v63
v_mfma_f32_16x16x32_bf16 a[4:7],v[132:135],v[48:51],a[4:7]
ds_read_b64_tr_b16 v[122:123],v4 offset:6272
ds_read_b64_tr_b16 v[124:125],v5 offset:128
ds_read_b64_tr_b16 v[126:127],v5 offset:6272
v_mfma_f32_16x16x32_bf16 a[52:55],v[132:135],v[52:55],a[52:55]
v_add_f32 v64,v64,v65
v_add_f32 v66,v66,v67
v_mfma_f32_16x16x32_bf16 a[48:51],v[128:131],v[52:55],a[48:51]
v_add_f32 v70,v70,v71
v_max3_f32 v19,v60,v62,v64
v_mfma_f32_16x16x32_bf16 a[96:99],v[128:131],v[56:59],a[96:99]
ds_read_b64_tr_b16 v[128:129],v2 offset:256
v_max3_f32 v19,v19,v66,v70
v_mfma_f32_16x16x32_bf16 a[100:103],v[132:135],v[56:59],a[100:103]
ds_read_b64_tr_b16 v[130:131],v2 offset:6400
v_rcp_f32 v66,v66
v_mfma_f32_16x16x32_bf16 a[104:107],v[136:139],v[56:59],a[104:107]
ds_read_b64_tr_b16 v[132:133],v3 offset:256
v_rcp_f32 v70,v70
v_mfma_f32_16x16x32_bf16 a[108:111],v[140:143],v[56:59],a[108:111]
ds_read_b64_tr_b16 v[134:135],v3 offset:6400
v_accvgpr_read_b32 v72,a48
v_accvgpr_read_b32 v73,a49
v_accvgpr_read_b32 v74,a50
v_accvgpr_read_b32 v75,a51
v_pk_mul_f32 v[72:73],v[72:73],v[66:67] op_sel_hi:[1,0]
v_pk_mul_f32 v[74:75],v[74:75],v[66:67] op_sel_hi:[1,0]
v_accvgpr_read_b32 v76,a96
v_accvgpr_read_b32 v77,a97
v_pk_mul_f32 v[76:77],v[76:77],v[70:71] op_sel_hi:[1,0]
v_accvgpr_read_b32 v78,a98
v_accvgpr_read_b32 v79,a99
v_pk_mul_f32 v[78:79],v[78:79],v[70:71] op_sel_hi:[1,0]
v_accvgpr_read_b32 v80,a52
v_accvgpr_read_b32 v81,a53
v_mfma_f32_16x16x32_bf16 a[60:63],v[140:143],v[52:55],a[60:63]
v_accvgpr_read_b32 v82,a54
v_accvgpr_read_b32 v83,a55
v_accvgpr_read_b32 v84,a100
v_accvgpr_read_b32 v85,a101
v_accvgpr_read_b32 v86,a102
v_pk_mul_f32 v[80:81],v[80:81],v[66:67] op_sel_hi:[1,0]
v_pk_mul_f32 v[82:83],v[82:83],v[66:67] op_sel_hi:[1,0]
v_pk_mul_f32 v[84:85],v[84:85],v[70:71] op_sel_hi:[1,0]
v_accvgpr_read_b32 v87,a103
v_pk_mul_f32 v[86:87],v[86:87],v[70:71] op_sel_hi:[1,0]
v_accvgpr_read_b32 v92,a104
v_accvgpr_read_b32 v93,a105
v_mfma_f32_16x16x32_bf16 a[56:59],v[136:139],v[52:55],a[56:59]
v_accvgpr_read_b32 v94,a106
v_accvgpr_read_b32 v95,a107
v_mfma_f32_16x16x32_bf16 a[8:11],v[136:139],v[48:51],a[8:11]
v_accvgpr_read_b32 v100,a108
v_accvgpr_read_b32 v101,a109
v_mfma_f32_16x16x32_bf16 a[12:15],v[140:143],v[48:51],a[12:15]
v_accvgpr_read_b32 v102,a110
v_accvgpr_read_b32 v103,a111
v_mfma_f32_16x16x32_bf16 v[220:223],v[140:143],v[44:47],v[220:223]
v_accvgpr_read_b32 v88,a56
v_accvgpr_read_b32 v89,a57
v_accvgpr_read_b32 v90,a58
v_accvgpr_read_b32 v91,a59
v_accvgpr_read_b32 v96,a60
v_pk_mul_f32 v[92:93],v[92:93],v[70:71] op_sel_hi:[1,0]
v_pk_mul_f32 v[94:95],v[94:95],v[70:71] op_sel_hi:[1,0]
v_pk_mul_f32 v[88:89],v[88:89],v[66:67] op_sel_hi:[1,0]
v_pk_mul_f32 v[90:91],v[90:91],v[66:67] op_sel_hi:[1,0]
v_accvgpr_read_b32 v97,a61
v_accvgpr_read_b32 v98,a62
v_mfma_f32_16x16x32_bf16 v[216:219],v[136:139],v[44:47],v[216:219]
v_accvgpr_read_b32 v99,a63
v_cmp_ngt_f32 vcc,s37,v19
v_lshrrev_b32 v19,5,v39
v_xor_b32 v38,v38,v19
v_and_b32 v19,15,v39
v_pk_mul_f32 v[96:97],v[96:97],v[66:67] op_sel_hi:[1,0]
v_pk_mul_f32 v[100:101],v[100:101],v[70:71] op_sel_hi:[1,0]
v_pk_mul_f32 v[102:103],v[102:103],v[70:71] op_sel_hi:[1,0]
v_pk_mul_f32 v[98:99],v[98:99],v[66:67] op_sel_hi:[1,0]
v_lshl_add_u32 v19,v19,7,s24
v_lshl_add_u32 v19,v38,4,v19
v_mfma_f32_16x16x32_bf16 v[168:171],v[136:139],v[40:43],v[168:171]
s_cmp_lg_u64 vcc,0
ds_read_b64_tr_b16 v[136:137],v4 offset:256
v_bfe_u32 v38,v39,4,1
v_mfma_f32_16x16x32_bf16 v[172:175],v[140:143],v[40:43],v[172:175]
s_cselect_b32 s62,s32,0
ds_read_b64_tr_b16 v[138:139],v4 offset:6400
v_lshl_add_u32 v36,v38,3,v19
s_waitcnt lgkmcnt(2)
v_mfma_f32_16x16x32_bf16 v[176:179],v[112:115],v[40:43],v[176:179]
s_or_b32 s31,s31,s62
ds_read_b64_tr_b16 v[140:141],v5 offset:256
v_xor_b32 v37,32,v36
v_mfma_f32_16x16x32_bf16 v[180:183],v[116:119],v[40:43],v[180:183]
s_lshl_b32 s32,s32,1
ds_read_b64_tr_b16 v[142:143],v5 offset:6400
v_xor_b32 v38,64,v36
v_mfma_f32_16x16x32_bf16 v[228:231],v[116:119],v[44:47],v[228:231]
s_add_u32 m0,s23,0
v_bfe_u32 v19,v39,3,1
v_xor_b32 v39,96,v36
v_mfma_f32_16x16x32_bf16 v[224:227],v[112:115],v[44:47],v[224:227]
v_lshlrev_b32 v19,11,v19
v_cvt_pk_bf16_f32 v72,v72,v73
v_mfma_f32_16x16x32_bf16 a[16:19],v[112:115],v[48:51],a[16:19]
v_cvt_pk_bf16_f32 v76,v76,v77
v_cvt_pk_bf16_f32 v80,v80,v81
v_mfma_f32_16x16x32_bf16 a[20:23],v[116:119],v[48:51],a[20:23]
v_cvt_pk_bf16_f32 v84,v84,v85
v_cvt_pk_bf16_f32 v73,v74,v75
v_mfma_f32_16x16x32_bf16 a[68:71],v[116:119],v[52:55],a[68:71]
v_cvt_pk_bf16_f32 v77,v78,v79
v_cvt_pk_bf16_f32 v81,v82,v83
v_mfma_f32_16x16x32_bf16 a[64:67],v[112:115],v[52:55],a[64:67]
ds_write2st64_b64 v36,v[72:73],v[76:77] offset0:36 offset1:40
v_mfma_f32_16x16x32_bf16 a[112:115],v[112:115],v[56:59],a[112:115]
v_cvt_pk_bf16_f32 v85,v86,v87
v_cvt_pk_bf16_f32 v92,v92,v93
v_mfma_f32_16x16x32_bf16 a[116:119],v[116:119],v[56:59],a[116:119]
v_cvt_pk_bf16_f32 v88,v88,v89
v_cvt_pk_bf16_f32 v93,v94,v95
v_mfma_f32_16x16x32_bf16 a[120:123],v[120:123],v[56:59],a[120:123]
v_accvgpr_read_b32 v78,a66
v_accvgpr_read_b32 v79,a67
v_mfma_f32_16x16x32_bf16 a[124:127],v[124:127],v[56:59],a[124:127]
ds_write2st64_b64 v37,v[80:81],v[84:85] offset0:36 offset1:40
v_pk_mul_f32 v[78:79],v[78:79],v[66:67] op_sel_hi:[1,0]
v_accvgpr_read_b32 v76,a64
v_accvgpr_read_b32 v77,a65
v_pk_mul_f32 v[76:77],v[76:77],v[66:67] op_sel_hi:[1,0]
v_accvgpr_read_b32 v82,a114
v_accvgpr_read_b32 v83,a115
v_pk_mul_f32 v[82:83],v[82:83],v[70:71] op_sel_hi:[1,0]
v_accvgpr_read_b32 v80,a112
v_accvgpr_read_b32 v81,a113
v_pk_mul_f32 v[80:81],v[80:81],v[70:71] op_sel_hi:[1,0]
v_cvt_pk_bf16_f32 v89,v90,v91
v_accvgpr_read_b32 v86,a70
v_mfma_f32_16x16x32_bf16 a[76:79],v[124:127],v[52:55],a[76:79]
ds_write2st64_b64 v38,v[88:89],v[92:93] offset0:36 offset1:40
v_accvgpr_read_b32 v87,a71
v_pk_mul_f32 v[86:87],v[86:87],v[66:67] op_sel_hi:[1,0]
v_accvgpr_read_b32 v84,a68
v_accvgpr_read_b32 v85,a69
v_pk_mul_f32 v[84:85],v[84:85],v[66:67] op_sel_hi:[1,0]
v_accvgpr_read_b32 v90,a118
v_accvgpr_read_b32 v91,a119
v_pk_mul_f32 v[90:91],v[90:91],v[70:71] op_sel_hi:[1,0]
v_accvgpr_read_b32 v88,a116
v_accvgpr_read_b32 v89,a117
v_pk_mul_f32 v[88:89],v[88:89],v[70:71] op_sel_hi:[1,0]
v_cvt_pk_bf16_f32 v96,v96,v97
v_cvt_pk_bf16_f32 v100,v100,v101
v_mfma_f32_16x16x32_bf16 a[72:75],v[120:123],v[52:55],a[72:75]
v_cvt_pk_bf16_f32 v97,v98,v99
v_cvt_pk_bf16_f32 v101,v102,v103
v_mfma_f32_16x16x32_bf16 a[24:27],v[120:123],v[48:51],a[24:27]
ds_write2st64_b64 v39,v[96:97],v[100:101] offset0:36 offset1:40
v_mfma_f32_16x16x32_bf16 a[28:31],v[124:127],v[48:51],a[28:31]
v_cvt_pk_bf16_f32 v76,v76,v77
v_cvt_pk_bf16_f32 v80,v80,v81
v_mfma_f32_16x16x32_bf16 v[236:239],v[124:127],v[44:47],v[236:239]
s_waitcnt vmcnt(15)
ds_read_b128 a[192:195],v11 offset:12288
v_cvt_pk_bf16_f32 v77,v78,v79
ds_read_b128 a[196:199],v12 offset:12288
v_cvt_pk_bf16_f32 v81,v82,v83
ds_read_b128 a[200:203],v11 offset:12416
v_accvgpr_read_b32 v92,a72
ds_read_b128 a[204:207],v12 offset:12416
v_accvgpr_read_b32 v93,a73
ds_read_b128 a[208:211],v11 offset:12544
v_pk_mul_f32 v[92:93],v[92:93],v[66:67] op_sel_hi:[1,0]
ds_read_b128 a[212:215],v12 offset:12544
v_accvgpr_read_b32 v94,a74
ds_read_b128 v[156:159],v10 offset:18432
v_accvgpr_read_b32 v95,a75
ds_read_b128 v[104:107],v10 offset:19456
v_pk_mul_f32 v[94:95],v[94:95],v[66:67] op_sel_hi:[1,0]
ds_read_b128 v[108:111],v10 offset:20480
v_accvgpr_read_b32 v98,a122
ds_read_b128 v[72:75],v10 offset:21504
v_accvgpr_read_b32 v99,a123
ds_write2st64_b64 v36,v[76:77],v[80:81] offset0:36 offset1:40
v_pk_mul_f32 v[98:99],v[98:99],v[70:71] op_sel_hi:[1,0]
v_accvgpr_read_b32 v102,a78
v_accvgpr_read_b32 v103,a79
v_pk_mul_f32 v[102:103],v[102:103],v[66:67] op_sel_hi:[1,0]
v_accvgpr_read_b32 v96,a120
v_accvgpr_read_b32 v97,a121
v_pk_mul_f32 v[96:97],v[96:97],v[70:71] op_sel_hi:[1,0]
v_accvgpr_read_b32 v100,a76
v_accvgpr_read_b32 v101,a77
v_pk_mul_f32 v[100:101],v[100:101],v[66:67] op_sel_hi:[1,0]
v_accvgpr_read_b32 v78,a126
v_accvgpr_read_b32 v79,a127
s_waitcnt lgkmcnt(4)
buffer_store_dwordx4 v[156:159],v9,s[16:19],s87 offen offset:0 nt
v_pk_mul_f32 v[78:79],v[78:79],v[70:71] op_sel_hi:[1,0]
v_accvgpr_read_b32 v76,a124
v_accvgpr_read_b32 v77,a125
v_pk_mul_f32 v[76:77],v[76:77],v[70:71] op_sel_hi:[1,0]
v_cvt_pk_bf16_f32 v84,v84,v85
v_cvt_pk_bf16_f32 v88,v88,v89
v_mfma_f32_16x16x32_bf16 v[232:235],v[120:123],v[44:47],v[232:235]
v_cvt_pk_bf16_f32 v92,v92,v93
v_cvt_pk_bf16_f32 v96,v96,v97
v_mfma_f32_16x16x32_bf16 v[184:187],v[120:123],v[40:43],v[184:187]
v_cvt_pk_bf16_f32 v85,v86,v87
v_cvt_pk_bf16_f32 v89,v90,v91
v_mfma_f32_16x16x32_bf16 v[188:191],v[124:127],v[40:43],v[188:191]
ds_write2st64_b64 v37,v[84:85],v[88:89] offset0:36 offset1:40
v_mfma_f32_16x16x32_bf16 v[192:195],v[128:131],v[40:43],v[192:195]
v_cvt_pk_bf16_f32 v100,v100,v101
v_cvt_pk_bf16_f32 v76,v76,v77
v_mfma_f32_16x16x32_bf16 v[196:199],v[132:135],v[40:43],v[196:199]
s_waitcnt lgkmcnt(1)
buffer_store_dwordx4 v[104:107],v9,s[16:19],s87 offen offset:3072 nt
v_cvt_pk_bf16_f32 v93,v94,v95
v_cvt_pk_bf16_f32 v97,v98,v99
v_cvt_pk_bf16_f32 v101,v102,v103
v_mfma_f32_16x16x32_bf16 v[244:247],v[132:135],v[44:47],v[244:247]
v_cvt_pk_bf16_f32 v77,v78,v79
s_waitcnt vmcnt(2)
s_barrier
v_mfma_f32_16x16x32_bf16 v[240:243],v[128:131],v[44:47],v[240:243]
ds_write2st64_b64 v38,v[92:93],v[96:97] offset0:36 offset1:40
v_mfma_f32_16x16x32_bf16 a[32:35],v[128:131],v[48:51],a[32:35]
v_rcp_f32 v62,v62
v_mfma_f32_16x16x32_bf16 a[36:39],v[132:135],v[48:51],a[36:39]
buffer_store_dwordx4 v[108:111],v9,s[16:19],s66 offen offset:0 nt
ds_read_b128 v[112:115],v0 offset:0
v_rcp_f32 v64,v64
v_mfma_f32_16x16x32_bf16 a[84:87],v[132:135],v[52:55],a[84:87]
ds_read_b128 v[116:119],v1 offset:0
v_rcp_f32 v60,v60
v_mfma_f32_16x16x32_bf16 a[80:83],v[128:131],v[52:55],a[80:83]
ds_read_b128 v[120:123],v0 offset:128
buffer_load_dwordx4 v6,s[8:11],s25 offen offset:0 lds
v_mfma_f32_16x16x32_bf16 a[128:131],v[128:131],v[56:59],a[128:131]
ds_write2st64_b64 v39,v[100:101],v[76:77] offset0:36 offset1:40
v_mfma_f32_16x16x32_bf16 a[132:135],v[132:135],v[56:59],a[132:135]
v_accvgpr_read_b32 v108,a84
ds_read_b128 v[124:127],v1 offset:128
v_mfma_f32_16x16x32_bf16 a[136:139],v[136:139],v[56:59],a[136:139]
buffer_store_dwordx4 v[72:75],v9,s[16:19],s66 offen offset:3072 nt
ds_read_b128 v[80:83],v10 offset:18432
v_accvgpr_read_b32 v88,a80
v_accvgpr_read_b32 v89,a81
v_mfma_f32_16x16x32_bf16 a[140:143],v[140:143],v[56:59],a[140:143]
ds_read_b128 v[156:159],v10 offset:19456
v_accvgpr_read_b32 v90,a82
ds_read_b128 v[72:75],v10 offset:20480
buffer_load_dwordx4 v7,s[8:11],s25 offen offset:1024 lds
ds_read_b128 v[84:87],v10 offset:21504
v_pk_mul_f32 v[88:89],v[88:89],v[66:67] op_sel_hi:[1,0]
ds_read_b128 v[128:131],v0 offset:256
v_accvgpr_read_b32 v91,a83
ds_read_b128 v[132:135],v1 offset:256
v_pk_mul_f32 v[90:91],v[90:91],v[66:67] op_sel_hi:[1,0]
v_accvgpr_read_b32 v104,a128
v_accvgpr_read_b32 v105,a129
v_pk_mul_f32 v[104:105],v[104:105],v[70:71] op_sel_hi:[1,0]
v_accvgpr_read_b32 v106,a130
v_accvgpr_read_b32 v107,a131
v_pk_mul_f32 v[106:107],v[106:107],v[70:71] op_sel_hi:[1,0]
v_accvgpr_read_b32 v109,a85
v_accvgpr_read_b32 v110,a86
v_mfma_f32_16x16x32_bf16 a[92:95],v[140:143],v[52:55],a[92:95]
s_waitcnt lgkmcnt(5)
v_accvgpr_read_b32 v111,a87
buffer_store_dwordx4 v[80:83],v9,s[16:19],s87 offen offset:128 nt
buffer_load_dwordx4 v8,s[8:11],s25 offen offset:2048 lds
v_pk_mul_f32 v[108:109],v[108:109],v[66:67] op_sel_hi:[1,0]
v_pk_mul_f32 v[110:111],v[110:111],v[66:67] op_sel_hi:[1,0]
v_accvgpr_read_b32 v92,a132
v_accvgpr_read_b32 v93,a133
v_pk_mul_f32 v[92:93],v[92:93],v[70:71] op_sel_hi:[1,0]
v_accvgpr_read_b32 v94,a134
v_accvgpr_read_b32 v95,a135
s_waitcnt lgkmcnt(2)
buffer_store_dwordx4 v[156:159],v9,s[16:19],s87 offen offset:3200 nt
v_pk_mul_f32 v[94:95],v[94:95],v[70:71] op_sel_hi:[1,0]
v_cvt_pk_bf16_f32 v88,v88,v89
v_cvt_pk_bf16_f32 v104,v104,v105
v_mfma_f32_16x16x32_bf16 a[88:91],v[136:139],v[52:55],a[88:91]
s_add_u32 m0,s23,24576
v_cvt_pk_bf16_f32 v89,v90,v91
v_cvt_pk_bf16_f32 v105,v106,v107
v_mfma_f32_16x16x32_bf16 a[40:43],v[136:139],v[48:51],a[40:43]
v_accvgpr_read_b32 v76,a136
v_accvgpr_read_b32 v77,a137
v_mfma_f32_16x16x32_bf16 a[44:47],v[140:143],v[48:51],a[44:47]
ds_write2st64_b64 v36,v[88:89],v[104:105] offset0:36 offset1:40
v_mfma_f32_16x16x32_bf16 v[252:255],v[140:143],v[44:47],v[252:255]
v_add_u32 v36,v36,v19
buffer_load_dwordx4 v6,s[8:11],s21 offen offset:0 lds
buffer_store_dwordx4 v[72:75],v9,s[16:19],s66 offen offset:128 nt
v_pk_mul_f32 v[76:77],v[76:77],v[70:71] op_sel_hi:[1,0]
v_pk_mul_f32 v[208:209],v[208:209],v[62:63] op_sel_hi:[1,0]
v_pk_mul_f32 v[210:211],v[210:211],v[62:63] op_sel_hi:[1,0]
v_pk_mul_f32 v[224:225],v[224:225],v[62:63] op_sel_hi:[1,0]
v_pk_mul_f32 v[226:227],v[226:227],v[62:63] op_sel_hi:[1,0]
v_pk_mul_f32 v[212:213],v[212:213],v[62:63] op_sel_hi:[1,0]
v_pk_mul_f32 v[214:215],v[214:215],v[62:63] op_sel_hi:[1,0]
v_pk_mul_f32 v[228:229],v[228:229],v[62:63] op_sel_hi:[1,0]
v_pk_mul_f32 v[230:231],v[230:231],v[62:63] op_sel_hi:[1,0]
v_pk_mul_f32 v[216:217],v[216:217],v[62:63] op_sel_hi:[1,0]
v_pk_mul_f32 v[218:219],v[218:219],v[62:63] op_sel_hi:[1,0]
buffer_store_dwordx4 v[84:87],v9,s[16:19],s66 offen offset:3200 nt
v_pk_mul_f32 v[232:233],v[232:233],v[62:63] op_sel_hi:[1,0]
v_pk_mul_f32 v[234:235],v[234:235],v[62:63] op_sel_hi:[1,0]
v_pk_mul_f32 v[220:221],v[220:221],v[62:63] op_sel_hi:[1,0]
v_pk_mul_f32 v[222:223],v[222:223],v[62:63] op_sel_hi:[1,0]
v_pk_mul_f32 v[236:237],v[236:237],v[62:63] op_sel_hi:[1,0]
v_pk_mul_f32 v[238:239],v[238:239],v[62:63] op_sel_hi:[1,0]
v_accvgpr_read_b32 v96,a88
v_accvgpr_read_b32 v97,a89
v_pk_mul_f32 v[96:97],v[96:97],v[66:67] op_sel_hi:[1,0]
v_accvgpr_read_b32 v78,a138
v_accvgpr_read_b32 v79,a139
v_pk_mul_f32 v[78:79],v[78:79],v[70:71] op_sel_hi:[1,0]
v_accvgpr_read_b32 v100,a92
v_accvgpr_read_b32 v101,a93
v_pk_mul_f32 v[100:101],v[100:101],v[66:67] op_sel_hi:[1,0]
v_cvt_pk_bf16_f32 v108,v108,v109
v_cvt_pk_bf16_f32 v92,v92,v93
v_accvgpr_read_b32 v98,a90
v_accvgpr_read_b32 v99,a91
v_pk_mul_f32 v[98:99],v[98:99],v[66:67] op_sel_hi:[1,0]
v_accvgpr_read_b32 v88,a140
v_accvgpr_read_b32 v89,a141
v_pk_mul_f32 v[88:89],v[88:89],v[70:71] op_sel_hi:[1,0]
v_accvgpr_read_b32 v102,a94
v_accvgpr_read_b32 v103,a95
buffer_load_dwordx4 v7,s[8:11],s21 offen offset:1024 lds
v_pk_mul_f32 v[102:103],v[102:103],v[66:67] op_sel_hi:[1,0]
v_accvgpr_read_b32 v90,a142
v_accvgpr_read_b32 v91,a143
v_pk_mul_f32 v[90:91],v[90:91],v[70:71] op_sel_hi:[1,0]
v_cvt_pk_bf16_f32 v76,v76,v77
v_cvt_pk_bf16_f32 v96,v96,v97
v_mfma_f32_16x16x32_bf16 v[248:251],v[136:139],v[44:47],v[248:251]
s_waitcnt vmcnt(16)
ds_read_b128 a[216:219],v11 offset:0
v_cvt_pk_bf16_f32 v109,v110,v111
v_mfma_f32_16x16x32_bf16 v[200:203],v[136:139],v[40:43],v[200:203]
ds_read_b128 a[220:223],v12 offset:0
v_cvt_pk_bf16_f32 v93,v94,v95
v_mfma_f32_16x16x32_bf16 v[204:207],v[140:143],v[40:43],v[204:207]
ds_read_b128 a[224:227],v11 offset:128
v_cvt_pk_bf16_f32 v100,v100,v101
ds_read_b128 a[228:231],v12 offset:128
v_pk_mul_f32 v[240:241],v[240:241],v[62:63] op_sel_hi:[1,0]
ds_read_b128 a[232:235],v11 offset:256
v_pk_mul_f32 v[242:243],v[242:243],v[62:63] op_sel_hi:[1,0]
ds_read_b128 a[236:239],v12 offset:256
v_cvt_pk_bf16_f32 v88,v88,v89
ds_write2st64_b64 v37,v[108:109],v[92:93] offset0:36 offset1:40
v_add_u32 v37,v37,v19
v_cvt_pk_bf16_f32 v77,v78,v79
v_cvt_pk_bf16_f32 v97,v98,v99
ds_read_b128 v[136:139],v0 offset:6144
v_cvt_pk_bf16_f32 v101,v102,v103
ds_read_b128 v[140:143],v1 offset:6144
buffer_load_dwordx4 v8,s[8:11],s21 offen offset:2048 lds
ds_write2st64_b64 v38,v[96:97],v[76:77] offset0:36 offset1:40
v_add_u32 v38,v38,v19
v_cvt_pk_bf16_f32 v89,v90,v91
v_accvgpr_read_b32 v84,a0
v_accvgpr_read_b32 v85,a1
v_pk_mul_f32 v[84:85],v[84:85],v[64:65] op_sel_hi:[1,0]
v_accvgpr_read_b32 v86,a2
v_accvgpr_read_b32 v87,a3
v_pk_mul_f32 v[86:87],v[86:87],v[64:65] op_sel_hi:[1,0]
v_accvgpr_read_b32 v94,a6
v_accvgpr_read_b32 v95,a7
v_accvgpr_read_b32 v92,a4
ds_write2st64_b64 v39,v[100:101],v[88:89] offset0:36 offset1:40
v_add_u32 v39,v39,v19
v_accvgpr_read_b32 v93,a5
v_accvgpr_read_b32 v110,a10
ds_read_b128 v[104:107],v10 offset:18432
v_accvgpr_read_b32 v111,a11
ds_read_b128 v[156:159],v10 offset:19456
v_accvgpr_read_b32 v108,a8
ds_read_b128 v[72:75],v10 offset:20480
v_accvgpr_read_b32 v109,a9
ds_read_b128 v[80:83],v10 offset:21504
v_accvgpr_read_b32 v78,a14
v_accvgpr_read_b32 v79,a15
v_accvgpr_read_b32 v76,a12
v_accvgpr_read_b32 v77,a13
v_accvgpr_read_b32 v98,a18
v_accvgpr_read_b32 v99,a19
v_accvgpr_read_b32 v102,a34
v_accvgpr_read_b32 v103,a35
v_accvgpr_read_b32 v96,a16
v_accvgpr_read_b32 v97,a17
v_accvgpr_read_b32 v100,a32
v_accvgpr_read_b32 v101,a33
v_cvt_pk_bf16_f32 v208,v208,v209
v_cvt_pk_bf16_f32 v224,v224,v225
v_cvt_pk_bf16_f32 v209,v210,v211
v_cvt_pk_bf16_f32 v225,v226,v227
ds_write2st64_b64 v36,v[208:209],v[224:225] offset0:12 offset1:14
v_accvgpr_read_b32 v210,a22
v_accvgpr_read_b32 v211,a23
v_accvgpr_read_b32 v226,a38
s_waitcnt lgkmcnt(3)
buffer_store_dwordx4 v[104:107],v9,s[16:19],s87 offen offset:256 nt
v_accvgpr_read_b32 v227,a39
v_accvgpr_read_b32 v208,a20
v_accvgpr_read_b32 v209,a21
v_accvgpr_read_b32 v224,a36
v_accvgpr_read_b32 v225,a37
v_cvt_pk_bf16_f32 v212,v212,v213
v_cvt_pk_bf16_f32 v228,v228,v229
v_cvt_pk_bf16_f32 v216,v216,v217
v_cvt_pk_bf16_f32 v232,v232,v233
v_cvt_pk_bf16_f32 v213,v214,v215
v_cvt_pk_bf16_f32 v229,v230,v231
ds_write2st64_b64 v37,v[212:213],v[228:229] offset0:12 offset1:14
v_cvt_pk_bf16_f32 v220,v220,v221
v_cvt_pk_bf16_f32 v236,v236,v237
v_cvt_pk_bf16_f32 v217,v218,v219
buffer_store_dwordx4 v[156:159],v9,s[16:19],s87 offen offset:3328 nt
v_cvt_pk_bf16_f32 v233,v234,v235
v_cvt_pk_bf16_f32 v240,v240,v241
v_cvt_pk_bf16_f32 v84,v84,v85
v_cvt_pk_bf16_f32 v221,v222,v223
v_cvt_pk_bf16_f32 v237,v238,v239
v_cvt_pk_bf16_f32 v241,v242,v243
v_cvt_pk_bf16_f32 v85,v86,v87
v_accvgpr_read_b32 v104,a24
v_accvgpr_read_b32 v105,a25
ds_write2st64_b64 v38,v[216:217],v[232:233] offset0:12 offset1:14
v_accvgpr_read_b32 v106,a26
v_accvgpr_read_b32 v107,a27
v_accvgpr_read_b32 v214,a42
s_waitcnt lgkmcnt(2)
buffer_store_dwordx4 v[72:75],v9,s[16:19],s66 offen offset:256 nt
v_accvgpr_read_b32 v215,a43
v_accvgpr_read_b32 v212,a40
v_accvgpr_read_b32 v213,a41
v_mfma_f32_16x16x32_bf16 v[72:75],v[112:115],a[144:147],0
s_add_u32 s21,s21,12288
v_accvgpr_read_b32 v230,a30
v_accvgpr_read_b32 v231,a31
v_mfma_f32_16x16x32_bf16 v[72:75],v[116:119],a[148:151],v[72:75]
s_mov_b32 s27,s42
v_accvgpr_read_b32 v228,a28
v_accvgpr_read_b32 v229,a29
v_mfma_f32_16x16x32_bf16 v[72:75],v[120:123],a[152:155],v[72:75]
s_mov_b32 s42,s41
buffer_store_dwordx4 v[80:83],v9,s[16:19],s66 offen offset:3328 nt
v_accvgpr_read_b32 v218,a46
v_accvgpr_read_b32 v219,a47
v_pk_mul_f32 v[244:245],v[244:245],v[62:63] op_sel_hi:[1,0]
v_pk_mul_f32 v[246:247],v[246:247],v[62:63] op_sel_hi:[1,0]
v_pk_mul_f32 v[92:93],v[92:93],v[64:65] op_sel_hi:[1,0]
v_pk_mul_f32 v[94:95],v[94:95],v[64:65] op_sel_hi:[1,0]
v_cvt_pk_bf16_f32 v244,v244,v245
v_cvt_pk_bf16_f32 v92,v92,v93
v_mfma_f32_16x16x32_bf16 v[72:75],v[124:127],a[156:159],v[72:75]
s_add_u32 s69,s69,1
v_cvt_pk_bf16_f32 v245,v246,v247
v_cvt_pk_bf16_f32 v93,v94,v95
v_mfma_f32_16x16x32_bf16 v[72:75],v[128:131],a[160:163],v[72:75]
s_lshl_b32 s62,s69,5
ds_write2st64_b64 v39,v[220:221],v[236:237] offset0:12 offset1:14
v_mfma_f32_16x16x32_bf16 v[72:75],v[132:135],a[164:167],v[72:75]
s_add_u32 s62,s62,s34
v_accvgpr_read_b32 v216,a44
v_accvgpr_read_b32 v217,a45
v_mov_b32 v66,0
v_mov_b32 v67,0
s_mul_i32 s63,s62,171
v_pk_mul_f32 v[248:249],v[248:249],v[62:63] op_sel_hi:[1,0]
v_pk_mul_f32 v[250:251],v[250:251],v[62:63] op_sel_hi:[1,0]
v_pk_mul_f32 v[108:109],v[108:109],v[64:65] op_sel_hi:[1,0]
v_pk_mul_f32 v[110:111],v[110:111],v[64:65] op_sel_hi:[1,0]
v_cvt_pk_bf16_f32 v248,v248,v249
v_cvt_pk_bf16_f32 v108,v108,v109
v_mfma_f32_16x16x32_bf16 v[80:83],v[132:135],a[188:191],0
s_lshr_b32 s63,s63,9
ds_write2st64_b64 v36,v[240:241],v[84:85] offset0:16 offset1:24
v_mfma_f32_16x16x32_bf16 v[80:83],v[128:131],a[184:187],v[80:83]
s_mul_i32 s64,s63,3
v_cvt_pk_bf16_f32 v249,v250,v251
v_cvt_pk_bf16_f32 v109,v110,v111
v_mfma_f32_16x16x32_bf16 v[80:83],v[124:127],a[180:183],v[80:83]
s_sub_u32 s62,s62,s64
v_max3_f32 v40,v72,v73,v74
s_add_u32 s63,s63,s33
s_mul_i32 s30,s63,196608
s_mul_i32 s41,s63,325632
s_lshl_b32 s63,s3,2
ds_write2st64_b64 v37,v[244:245],v[92:93] offset0:16 offset1:24
v_pk_mul_f32 v[252:253],v[252:253],v[62:63] op_sel_hi:[1,0]
v_pk_mul_f32 v[254:255],v[254:255],v[62:63] op_sel_hi:[1,0]
v_pk_mul_f32 v[76:77],v[76:77],v[64:65] op_sel_hi:[1,0]
v_pk_mul_f32 v[78:79],v[78:79],v[64:65] op_sel_hi:[1,0]
v_cvt_pk_bf16_f32 v252,v252,v253
v_cvt_pk_bf16_f32 v76,v76,v77
v_mfma_f32_16x16x32_bf16 v[80:83],v[120:123],a[176:179],v[80:83]
s_add_u32 s64,s63,21
v_cvt_pk_bf16_f32 v253,v254,v255
v_cvt_pk_bf16_f32 v77,v78,v79
v_mfma_f32_16x16x32_bf16 v[80:83],v[116:119],a[172:175],v[80:83]
s_cmp_eq_u32 s3,0
v_mov_b32 v62,0
v_mov_b32 v63,0
v_mfma_f32_16x16x32_bf16 v[80:83],v[112:115],a[168:171],v[80:83]
s_cselect_b32 s64,20,s64
ds_write2st64_b64 v38,v[248:249],v[108:109] offset0:16 offset1:24
v_mfma_f32_16x16x32_bf16 v[88:91],v[112:115],a[192:195],0
s_cselect_b32 s40,1,0
s_add_u32 s65,s63,37
ds_read_b128 v[112:115],v0 offset:6272
s_cmp_eq_u32 s62,2
v_pk_mul_f32 v[96:97],v[96:97],v[64:65] op_sel_hi:[1,0]
v_pk_mul_f32 v[98:99],v[98:99],v[64:65] op_sel_hi:[1,0]
v_pk_mul_f32 v[100:101],v[100:101],v[64:65] op_sel_hi:[1,0]
v_pk_mul_f32 v[102:103],v[102:103],v[64:65] op_sel_hi:[1,0]
v_cvt_pk_bf16_f32 v96,v96,v97
v_cvt_pk_bf16_f32 v100,v100,v101
v_mfma_f32_16x16x32_bf16 v[88:91],v[116:119],a[196:199],v[88:91]
s_cselect_b32 s64,s65,s64
ds_write2st64_b64 v39,v[252:253],v[76:77] offset0:16 offset1:24
v_mfma_f32_16x16x32_bf16 v[88:91],v[120:123],a[200:203],v[88:91]
s_cselect_b32 s40,0,s40
v_cvt_pk_bf16_f32 v97,v98,v99
v_cvt_pk_bf16_f32 v101,v102,v103
v_mfma_f32_16x16x32_bf16 v[88:91],v[124:127],a[204:207],v[88:91]
s_add_u32 s65,s63,s3
ds_read_b128 v[116:119],v1 offset:6272
v_max3_f32 v44,v80,v81,v82
ds_read_b128 v[120:123],v0 offset:6400
v_pk_mul_f32 v[208:209],v[208:209],v[64:65] op_sel_hi:[1,0]
ds_write2st64_b64 v36,v[96:97],v[100:101] offset0:26 offset1:28
v_pk_mul_f32 v[210:211],v[210:211],v[64:65] op_sel_hi:[1,0]
v_pk_mul_f32 v[224:225],v[224:225],v[64:65] op_sel_hi:[1,0]
v_pk_mul_f32 v[226:227],v[226:227],v[64:65] op_sel_hi:[1,0]
v_cvt_pk_bf16_f32 v208,v208,v209
v_cvt_pk_bf16_f32 v224,v224,v225
v_mfma_f32_16x16x32_bf16 v[88:91],v[128:131],a[208:211],v[88:91]
s_cmp_eq_u32 s62,0
ds_read_b128 v[124:127],v1 offset:6400
v_cvt_pk_bf16_f32 v209,v210,v211
v_mfma_f32_16x16x32_bf16 v[88:91],v[132:135],a[212:215],v[88:91]
s_cselect_b32 s64,s65,s64
ds_read_b128 v[128:131],v0 offset:0
v_cvt_pk_bf16_f32 v225,v226,v227
v_mfma_f32_16x16x32_bf16 v[76:79],v[136:139],a[144:147],0
s_cselect_b32 s40,1,s40
ds_write2st64_b64 v37,v[208:209],v[224:225] offset0:26 offset1:28
v_pk_mul_f32 v[104:105],v[104:105],v[64:65] op_sel_hi:[1,0]
v_pk_mul_f32 v[106:107],v[106:107],v[64:65] op_sel_hi:[1,0]
v_pk_mul_f32 v[212:213],v[212:213],v[64:65] op_sel_hi:[1,0]
ds_read_b128 v[132:135],v1 offset:0
v_pk_mul_f32 v[214:215],v[214:215],v[64:65] op_sel_hi:[1,0]
v_max3_f32 v48,v88,v89,v90
v_cvt_pk_bf16_f32 v104,v104,v105
v_mfma_f32_16x16x32_bf16 v[76:79],v[140:143],a[148:151],v[76:79]
s_mul_i32 s64,s64,6144
v_cvt_pk_bf16_f32 v212,v212,v213
v_cvt_pk_bf16_f32 v105,v106,v107
s_waitcnt lgkmcnt(4)
v_mfma_f32_16x16x32_bf16 v[76:79],v[112:115],a[152:155],v[76:79]
s_add_u32 s41,s41,s64
v_cvt_pk_bf16_f32 v213,v214,v215
s_cmp_ge_u32 s69,6
v_mfma_f32_16x16x32_bf16 v[76:79],v[116:119],a[156:159],v[76:79]
s_cselect_b32 s41,166723584,s41
ds_write2st64_b64 v38,v[104:105],v[212:213] offset0:26 offset1:28
v_pk_mul_f32 v[228:229],v[228:229],v[64:65] op_sel_hi:[1,0]
v_pk_mul_f32 v[230:231],v[230:231],v[64:65] op_sel_hi:[1,0]
v_pk_mul_f32 v[216:217],v[216:217],v[64:65] op_sel_hi:[1,0]
v_pk_mul_f32 v[218:219],v[218:219],v[64:65] op_sel_hi:[1,0]
v_cvt_pk_bf16_f32 v228,v228,v229
v_cvt_pk_bf16_f32 v216,v216,v217
v_mfma_f32_16x16x32_bf16 v[76:79],v[120:123],a[160:163],v[76:79]
s_cselect_b32 s30,100663296,s30
v_cvt_pk_bf16_f32 v229,v230,v231
v_cvt_pk_bf16_f32 v217,v218,v219
s_waitcnt lgkmcnt(2)
v_mfma_f32_16x16x32_bf16 v[76:79],v[124:127],a[164:167],v[76:79]
s_add_u32 s25,s30,s22
v_mov_b32 v64,0
v_mov_b32 v65,0
v_mfma_f32_16x16x32_bf16 v[84:87],v[124:127],a[188:191],0
s_add_u32 s26,s25,12288
ds_write2st64_b64 v39,v[228:229],v[216:217] offset0:26 offset1:28
v_pk_mul_f32 v[160:161],v[160:161],v[60:61] op_sel_hi:[1,0]
v_pk_mul_f32 v[162:163],v[162:163],v[60:61] op_sel_hi:[1,0]
v_pk_mul_f32 v[176:177],v[176:177],v[60:61] op_sel_hi:[1,0]
v_pk_mul_f32 v[178:179],v[178:179],v[60:61] op_sel_hi:[1,0]
v_max3_f32 v40,v40,v75,v76
v_max3_f32 v40,v40,v77,v78
v_mfma_f32_16x16x32_bf16 v[84:87],v[120:123],a[184:187],v[84:87]
s_add_u32 m0,s22,0
v_max_f32 v40,v40,v79
v_mov_b32 v41,v40
v_mfma_f32_16x16x32_bf16 v[84:87],v[116:119],a[180:183],v[84:87]
s_mov_b32 s28,s41
v_permlane32_swap_b32 v41,v40
v_mfma_f32_16x16x32_bf16 v[84:87],v[112:115],a[176:179],v[84:87]
s_mov_b32 s29,s24
v_max_f32 v40,v40,v41
v_mov_b32 v41,v40
v_mfma_f32_16x16x32_bf16 v[84:87],v[140:143],a[172:175],v[84:87]
v_cvt_pk_bf16_f32 v160,v160,v161
v_permlane16_swap_b32 v41,v40
v_max_f32 v40,v40,v41
v_mul_f32_e64 v13,-s36,v40
v_pk_mul_f32 v[164:165],v[164:165],v[60:61] op_sel_hi:[1,0]
v_pk_mul_f32 v[166:167],v[166:167],v[60:61] op_sel_hi:[1,0]
v_pk_mul_f32 v[180:181],v[180:181],v[60:61] op_sel_hi:[1,0]
v_pk_mul_f32 v[182:183],v[182:183],v[60:61] op_sel_hi:[1,0]
v_fma_f32 v72,v72,s36,v13
v_fma_f32 v73,v73,s36,v13
v_mfma_f32_16x16x32_bf16 v[84:87],v[136:139],a[168:171],v[84:87]
v_fma_f32 v74,v74,s36,v13
v_fma_f32 v75,v75,s36,v13
v_mfma_f32_16x16x32_bf16 v[92:95],v[136:139],a[192:195],0
ds_read_b128 v[136:139],v0 offset:128
v_exp_f32 v72,v72
v_mfma_f32_16x16x32_bf16 v[92:95],v[140:143],a[196:199],v[92:95]
ds_read_b128 v[140:143],v1 offset:128
v_exp_f32 v73,v73
v_exp_f32 v74,v74
v_pk_mul_f32 v[168:169],v[168:169],v[60:61] op_sel_hi:[1,0]
v_pk_mul_f32 v[170:171],v[170:171],v[60:61] op_sel_hi:[1,0]
v_pk_mul_f32 v[184:185],v[184:185],v[60:61] op_sel_hi:[1,0]
v_pk_mul_f32 v[186:187],v[186:187],v[60:61] op_sel_hi:[1,0]
v_exp_f32 v75,v75
v_cvt_pk_bf16_f32 v20,v72,v73
v_mfma_f32_16x16x32_bf16 v[92:95],v[112:115],a[200:203],v[92:95]
ds_read_b128 v[112:115],v0 offset:256
v_cvt_pk_bf16_f32 v21,v74,v75
v_mfma_f32_16x16x32_bf16 v[92:95],v[116:119],a[204:207],v[92:95]
ds_read_b128 v[116:119],v1 offset:256
v_max3_f32 v44,v44,v83,v84
v_mfma_f32_16x16x32_bf16 v[92:95],v[120:123],a[208:211],v[92:95]
ds_read_b128 v[120:123],v0 offset:6144
v_max3_f32 v44,v44,v85,v86
v_max_f32 v44,v44,v87
v_mov_b32 v45,v44
v_fma_f32 v76,v76,s36,v13
v_pk_mul_f32 v[172:173],v[172:173],v[60:61] op_sel_hi:[1,0]
v_pk_mul_f32 v[174:175],v[174:175],v[60:61] op_sel_hi:[1,0]
v_pk_mul_f32 v[188:189],v[188:189],v[60:61] op_sel_hi:[1,0]
v_pk_mul_f32 v[190:191],v[190:191],v[60:61] op_sel_hi:[1,0]
v_permlane32_swap_b32 v45,v44
v_max_f32 v44,v44,v45
v_mfma_f32_16x16x32_bf16 v[92:95],v[124:127],a[212:215],v[92:95]
ds_read_b128 v[124:127],v1 offset:6144
v_mov_b32 v45,v44
v_mfma_f32_16x16x32_bf16 v[96:99],v[128:131],a[216:219],0
s_waitcnt lgkmcnt(4)
ds_read_b128 v[128:131],v0 offset:6272
v_permlane16_swap_b32 v45,v44
v_mfma_f32_16x16x32_bf16 v[96:99],v[132:135],a[220:223],v[96:99]
ds_read_b128 v[132:135],v1 offset:6272
v_max_f32 v44,v44,v45
v_mul_f32_e64 v14,-s36,v44
v_fma_f32 v80,v80,s36,v14
v_fma_f32 v81,v81,s36,v14
v_pk_mul_f32 v[192:193],v[192:193],v[60:61] op_sel_hi:[1,0]
v_pk_mul_f32 v[194:195],v[194:195],v[60:61] op_sel_hi:[1,0]
v_fma_f32 v82,v82,s36,v14
v_fma_f32 v83,v83,s36,v14
v_mfma_f32_16x16x32_bf16 v[96:99],v[136:139],a[224:227],v[96:99]
ds_read_b128 v[136:139],v0 offset:6400
v_exp_f32 v80,v80
v_mfma_f32_16x16x32_bf16 v[96:99],v[140:143],a[228:231],v[96:99]
s_waitcnt lgkmcnt(4)
ds_read_b128 v[140:143],v1 offset:6400
v_exp_f32 v81,v81
v_mfma_f32_16x16x32_bf16 v[96:99],v[112:115],a[232:235],v[96:99]
ds_read_b128 v[112:115],v0 offset:12544
v_exp_f32 v82,v82
v_mfma_f32_16x16x32_bf16 v[96:99],v[116:119],a[236:239],v[96:99]
ds_read_b128 v[116:119],v1 offset:12544
v_exp_f32 v83,v83
v_cvt_pk_bf16_f32 v24,v80,v81
v_cvt_pk_bf16_f32 v25,v82,v83
v_pk_mul_f32 v[196:197],v[196:197],v[60:61] op_sel_hi:[1,0]
v_pk_mul_f32 v[198:199],v[198:199],v[60:61] op_sel_hi:[1,0]
v_max3_f32 v48,v48,v91,v92
v_max3_f32 v48,v48,v93,v94
v_mfma_f32_16x16x32_bf16 v[100:103],v[120:123],a[216:219],0
s_waitcnt lgkmcnt(4)
ds_read_b128 v[120:123],v0 offset:18432
v_max_f32 v48,v48,v95
v_mfma_f32_16x16x32_bf16 v[100:103],v[124:127],a[220:223],v[100:103]
ds_read_b128 v[124:127],v1 offset:18432
v_mov_b32 v49,v48
v_mfma_f32_16x16x32_bf16 v[100:103],v[128:131],a[224:227],v[100:103]
ds_read_b128 v[128:131],v0 offset:12288
v_permlane32_swap_b32 v49,v48
v_max_f32 v48,v48,v49
v_mov_b32 v49,v48
v_pk_mul_f32 v[200:201],v[200:201],v[60:61] op_sel_hi:[1,0]
v_pk_mul_f32 v[202:203],v[202:203],v[60:61] op_sel_hi:[1,0]
v_permlane16_swap_b32 v49,v48
v_max_f32 v48,v48,v49
v_mfma_f32_16x16x32_bf16 v[100:103],v[132:135],a[228:231],v[100:103]
s_waitcnt lgkmcnt(4)
ds_read_b128 v[132:135],v1 offset:12288
v_mul_f32_e64 v15,-s36,v48
v_mfma_f32_16x16x32_bf16 v[100:103],v[136:139],a[232:235],v[100:103]
ds_read_b128 v[136:139],v0 offset:12416
v_fma_f32 v88,v88,s36,v15
v_mfma_f32_16x16x32_bf16 v[100:103],v[140:143],a[236:239],v[100:103]
ds_read_b128 v[140:143],v1 offset:12416
v_fma_f32 v89,v89,s36,v15
v_fma_f32 v90,v90,s36,v15
v_fma_f32 v91,v91,s36,v15
v_exp_f32 v88,v88
v_pk_mul_f32 v[204:205],v[204:205],v[60:61] op_sel_hi:[1,0]
v_pk_mul_f32 v[206:207],v[206:207],v[60:61] op_sel_hi:[1,0]
v_exp_f32 v89,v89
v_exp_f32 v90,v90
s_waitcnt lgkmcnt(4)
v_mfma_f32_16x16x32_bf16 v[72:75],v[116:119],a[164:167],0
v_exp_f32 v91,v91
v_mfma_f32_16x16x32_bf16 v[72:75],v[112:115],a[160:163],v[72:75]
v_cvt_pk_bf16_f32 v28,v88,v89
v_cvt_pk_bf16_f32 v29,v90,v91
v_max3_f32 v52,v96,v97,v98
v_max3_f32 v52,v52,v99,v100
v_max3_f32 v52,v52,v101,v102
v_max_f32 v52,v52,v103
v_mov_b32 v53,v52
v_fma_f32 v77,v77,s36,v13
v_fma_f32 v78,v78,s36,v13
v_permlane32_swap_b32 v53,v52
v_max_f32 v52,v52,v53
v_mov_b32 v53,v52
v_fma_f32 v79,v79,s36,v13
v_exp_f32 v76,v76
v_permlane16_swap_b32 v53,v52
s_waitcnt lgkmcnt(0)
v_mfma_f32_16x16x32_bf16 v[72:75],v[140:143],a[156:159],v[72:75]
v_max_f32 v52,v52,v53
v_mul_f32_e64 v16,-s36,v52
v_mfma_f32_16x16x32_bf16 v[72:75],v[136:139],a[152:155],v[72:75]
v_fma_f32 v96,v96,s36,v16
v_fma_f32 v97,v97,s36,v16
v_mfma_f32_16x16x32_bf16 v[72:75],v[132:135],a[148:151],v[72:75]
v_fma_f32 v98,v98,s36,v16
v_fma_f32 v99,v99,s36,v16
v_mfma_f32_16x16x32_bf16 v[72:75],v[128:131],a[144:147],v[72:75]
v_exp_f32 v96,v96
v_mfma_f32_16x16x32_bf16 v[80:83],v[128:131],a[168:171],0
v_exp_f32 v97,v97
v_mfma_f32_16x16x32_bf16 v[80:83],v[132:135],a[172:175],v[80:83]
v_exp_f32 v98,v98
v_mfma_f32_16x16x32_bf16 v[80:83],v[136:139],a[176:179],v[80:83]
v_exp_f32 v99,v99
v_mfma_f32_16x16x32_bf16 v[80:83],v[140:143],a[180:183],v[80:83]
v_cvt_pk_bf16_f32 v32,v96,v97
v_cvt_pk_bf16_f32 v33,v98,v99
v_mfma_f32_16x16x32_bf16 v[80:83],v[112:115],a[184:187],v[80:83]
v_exp_f32 v77,v77
v_mfma_f32_16x16x32_bf16 v[80:83],v[116:119],a[188:191],v[80:83]
v_exp_f32 v78,v78
v_mfma_f32_16x16x32_bf16 v[88:91],v[116:119],a[212:215],0
v_exp_f32 v79,v79
v_mfma_f32_16x16x32_bf16 v[88:91],v[112:115],a[208:211],v[88:91]
v_cvt_pk_bf16_f32 v22,v76,v77
v_cvt_pk_bf16_f32 v23,v78,v79
v_mfma_f32_16x16x32_bf16 v[88:91],v[140:143],a[204:207],v[88:91]
v_fma_f32 v84,v84,s36,v14
v_fma_f32 v85,v85,s36,v14
v_mfma_f32_16x16x32_bf16 v[88:91],v[136:139],a[200:203],v[88:91]
v_fma_f32 v86,v86,s36,v14
v_fma_f32 v87,v87,s36,v14
v_mfma_f32_16x16x32_bf16 v[88:91],v[132:135],a[196:199],v[88:91]
v_exp_f32 v84,v84
v_mfma_f32_16x16x32_bf16 v[88:91],v[128:131],a[192:195],v[88:91]
v_exp_f32 v85,v85
v_mfma_f32_16x16x32_bf16 v[96:99],v[128:131],a[216:219],0
ds_read_b128 v[128:131],v0 offset:18560
v_exp_f32 v86,v86
v_mfma_f32_16x16x32_bf16 v[96:99],v[132:135],a[220:223],v[96:99]
ds_read_b128 v[132:135],v1 offset:18560
v_exp_f32 v87,v87
v_mfma_f32_16x16x32_bf16 v[96:99],v[136:139],a[224:227],v[96:99]
ds_read_b128 v[136:139],v0 offset:18688
v_cvt_pk_bf16_f32 v26,v84,v85
v_mfma_f32_16x16x32_bf16 v[96:99],v[140:143],a[228:231],v[96:99]
ds_read_b128 v[140:143],v1 offset:18688
s_waitcnt vmcnt(10)
s_barrier
v_mfma_f32_16x16x32_bf16 v[96:99],v[112:115],a[232:235],v[96:99]
buffer_load_dwordx4 v6,s[4:7],s20 offen offset:0 lds
v_mfma_f32_16x16x32_bf16 v[96:99],v[116:119],a[236:239],v[96:99]
v_cvt_pk_bf16_f32 v27,v86,v87
v_fma_f32 v92,v92,s36,v15
v_mfma_f32_16x16x32_bf16 v[76:79],v[120:123],a[144:147],0
v_fma_f32 v93,v93,s36,v15
v_fma_f32 v94,v94,s36,v15
v_mfma_f32_16x16x32_bf16 v[76:79],v[124:127],a[148:151],v[76:79]
s_waitcnt lgkmcnt(3)
v_fma_f32 v95,v95,s36,v15
v_exp_f32 v92,v92
v_mfma_f32_16x16x32_bf16 v[76:79],v[128:131],a[152:155],v[76:79]
s_waitcnt lgkmcnt(2)
v_exp_f32 v93,v93
v_mfma_f32_16x16x32_bf16 v[76:79],v[132:135],a[156:159],v[76:79]
s_waitcnt lgkmcnt(1)
v_exp_f32 v94,v94
v_mfma_f32_16x16x32_bf16 v[76:79],v[136:139],a[160:163],v[76:79]
buffer_load_dwordx4 v7,s[4:7],s20 offen offset:1024 lds
s_waitcnt lgkmcnt(0)
v_mfma_f32_16x16x32_bf16 v[76:79],v[140:143],a[164:167],v[76:79]
v_exp_f32 v95,v95
v_mfma_f32_16x16x32_bf16 v[84:87],v[140:143],a[188:191],0
v_cvt_pk_bf16_f32 v30,v92,v93
v_cvt_pk_bf16_f32 v31,v94,v95
v_mfma_f32_16x16x32_bf16 v[84:87],v[136:139],a[184:187],v[84:87]
v_fma_f32 v100,v100,s36,v16
v_fma_f32 v101,v101,s36,v16
v_mfma_f32_16x16x32_bf16 v[84:87],v[132:135],a[180:183],v[84:87]
ds_read_b64_tr_b16 v[112:113],v2 offset:0
v_fma_f32 v102,v102,s36,v16
v_mfma_f32_16x16x32_bf16 v[84:87],v[128:131],a[176:179],v[84:87]
ds_read_b64_tr_b16 v[114:115],v2 offset:6144
buffer_load_dwordx4 v8,s[4:7],s20 offen offset:2048 lds
v_mfma_f32_16x16x32_bf16 v[84:87],v[124:127],a[172:175],v[84:87]
s_add_u32 s20,s20,12288
ds_read_b64_tr_b16 v[116:117],v3 offset:0
v_fma_f32 v103,v103,s36,v16
v_mfma_f32_16x16x32_bf16 v[84:87],v[120:123],a[168:171],v[84:87]
ds_read_b64_tr_b16 v[118:119],v3 offset:6144
v_exp_f32 v100,v100
v_mfma_f32_16x16x32_bf16 v[92:95],v[120:123],a[192:195],0
v_exp_f32 v101,v101
v_mfma_f32_16x16x32_bf16 v[92:95],v[124:127],a[196:199],v[92:95]
v_exp_f32 v102,v102
v_mfma_f32_16x16x32_bf16 v[92:95],v[128:131],a[200:203],v[92:95]
v_exp_f32 v103,v103
v_mfma_f32_16x16x32_bf16 v[92:95],v[132:135],a[204:207],v[92:95]
v_cvt_pk_bf16_f32 v34,v100,v101
v_cvt_pk_bf16_f32 v35,v102,v103
v_mfma_f32_16x16x32_bf16 v[92:95],v[136:139],a[208:211],v[92:95]
v_cvt_pk_bf16_f32 v176,v176,v177
v_cvt_pk_bf16_f32 v161,v162,v163
v_smfmac_f32_16x16x64_bf16 v[64:67],v[152:155],v[28:35],v18
v_cvt_pk_bf16_f32 v164,v164,v165
v_mfma_f32_16x16x32_bf16 v[92:95],v[140:143],a[212:215],v[92:95]
v_cvt_pk_bf16_f32 v180,v180,v181
v_cvt_pk_bf16_f32 v177,v178,v179
v_mfma_f32_16x16x32_bf16 v[100:103],v[140:143],a[236:239],0
ds_write2st64_b64 v36,v[160:161],v[176:177] offset0:0 offset1:2
v_mfma_f32_16x16x32_bf16 v[100:103],v[136:139],a[232:235],v[100:103]
v_cvt_pk_bf16_f32 v168,v168,v169
v_cvt_pk_bf16_f32 v184,v184,v185
v_mfma_f32_16x16x32_bf16 v[100:103],v[132:135],a[228:231],v[100:103]
v_cvt_pk_bf16_f32 v165,v166,v167
v_cvt_pk_bf16_f32 v181,v182,v183
v_mfma_f32_16x16x32_bf16 v[100:103],v[128:131],a[224:227],v[100:103]
v_cvt_pk_bf16_f32 v172,v172,v173
v_cvt_pk_bf16_f32 v188,v188,v189
v_mfma_f32_16x16x32_bf16 v[100:103],v[124:127],a[220:223],v[100:103]
ds_write2st64_b64 v37,v[164:165],v[180:181] offset0:0 offset1:2
v_mfma_f32_16x16x32_bf16 v[100:103],v[120:123],a[216:219],v[100:103]
v_mov_b32 v60,0
ds_read_b64_tr_b16 v[120:121],v4 offset:0
ds_read_b64_tr_b16 v[122:123],v4 offset:6144
ds_read_b64_tr_b16 v[124:125],v5 offset:0
ds_read_b64_tr_b16 v[126:127],v5 offset:6144
v_mov_b32 v61,0
v_cvt_pk_bf16_f32 v169,v170,v171
v_cvt_pk_bf16_f32 v185,v186,v187
v_smfmac_f32_16x16x64_bf16 v[60:63],v[152:155],v[20:27],v18
ds_write2st64_b64 v38,v[168:169],v[184:185] offset0:0 offset1:2
v_cvt_pk_bf16_f32 v192,v192,v193
v_cvt_pk_bf16_f32 v173,v174,v175
v_cvt_pk_bf16_f32 v189,v190,v191
v_cvt_pk_bf16_f32 v196,v196,v197
v_fma_f32 v72,v72,s36,v13
v_fma_f32 v73,v73,s36,v13
v_fma_f32 v74,v74,s36,v13
v_fma_f32 v75,v75,s36,v13
v_fma_f32 v80,v80,s36,v14
v_fma_f32 v81,v81,s36,v14
v_cvt_pk_bf16_f32 v193,v194,v195
ds_write2st64_b64 v39,v[172:173],v[188:189] offset0:0 offset1:2
v_cvt_pk_bf16_f32 v200,v200,v201
v_cvt_pk_bf16_f32 v197,v198,v199
v_exp_f32 v72,v72
v_exp_f32 v73,v73
v_exp_f32 v74,v74
v_exp_f32 v75,v75
v_exp_f32 v80,v80
ds_write_b64 v36,v[192:193] offset:2048
v_exp_f32 v81,v81
v_cvt_pk_bf16_f32 v204,v204,v205
v_cvt_pk_bf16_f32 v201,v202,v203
ds_write_b64 v37,v[196:197] offset:2048
v_cvt_pk_bf16_f32 v205,v206,v207
v_cvt_pk_bf16_f32 v40,v72,v73
v_cvt_pk_bf16_f32 v41,v74,v75
v_cvt_pk_bf16_f32 v44,v80,v81
ds_write_b64 v38,v[200:201] offset:2048
ds_write_b64 v39,v[204:205] offset:2048
s_waitcnt lgkmcnt(4)
v_mfma_f32_16x16x32_bf16 v[160:163],v[112:115],v[20:23],0
s_add_u32 m0,s23,0
ds_read_b64_tr_b16 v[128:129],v2 offset:128
v_fma_f32 v82,v82,s36,v14
v_mfma_f32_16x16x32_bf16 v[164:167],v[116:119],v[20:23],0
ds_read_b64_tr_b16 v[130:131],v2 offset:6272
v_fma_f32 v83,v83,s36,v14
v_mfma_f32_16x16x32_bf16 v[212:215],v[116:119],v[24:27],0
ds_read_b64_tr_b16 v[132:133],v3 offset:128
v_fma_f32 v88,v88,s36,v15
v_mfma_f32_16x16x32_bf16 v[208:211],v[112:115],v[24:27],0
ds_read_b64_tr_b16 v[134:135],v3 offset:6272
v_fma_f32 v89,v89,s36,v15
v_mfma_f32_16x16x32_bf16 a[0:3],v[112:115],v[28:31],0
ds_read_b64_tr_b16 v[136:137],v4 offset:128
v_fma_f32 v90,v90,s36,v15
v_mfma_f32_16x16x32_bf16 a[4:7],v[116:119],v[28:31],0
ds_read_b64_tr_b16 v[138:139],v4 offset:6272
v_fma_f32 v91,v91,s36,v15
v_mfma_f32_16x16x32_bf16 a[52:55],v[116:119],v[32:35],0
ds_read_b64_tr_b16 v[140:141],v5 offset:128
v_fma_f32 v96,v96,s36,v16
v_mfma_f32_16x16x32_bf16 a[48:51],v[112:115],v[32:35],0
ds_read_b64_tr_b16 v[142:143],v5 offset:6272
v_fma_f32 v97,v97,s36,v16
v_mfma_f32_16x16x32_bf16 a[56:59],v[120:123],v[32:35],0
ds_read_b64_tr_b16 v[112:113],v2 offset:256
v_fma_f32 v98,v98,s36,v16
v_mfma_f32_16x16x32_bf16 a[60:63],v[124:127],v[32:35],0
ds_read_b64_tr_b16 v[114:115],v2 offset:6400
v_fma_f32 v99,v99,s36,v16
v_mfma_f32_16x16x32_bf16 a[12:15],v[124:127],v[28:31],0
ds_read_b64_tr_b16 v[116:117],v3 offset:256
v_fma_f32 v76,v76,s36,v13
v_mfma_f32_16x16x32_bf16 a[8:11],v[120:123],v[28:31],0
ds_read_b64_tr_b16 v[118:119],v3 offset:6400
v_fma_f32 v77,v77,s36,v13
v_mfma_f32_16x16x32_bf16 v[216:219],v[120:123],v[24:27],0
v_exp_f32 v82,v82
v_mfma_f32_16x16x32_bf16 v[220:223],v[124:127],v[24:27],0
v_exp_f32 v83,v83
v_mfma_f32_16x16x32_bf16 v[172:175],v[124:127],v[20:23],0
ds_read_b64_tr_b16 v[124:125],v5 offset:256
v_cvt_pk_bf16_f32 v45,v82,v83
v_mfma_f32_16x16x32_bf16 v[168:171],v[120:123],v[20:23],0
s_waitcnt lgkmcnt(6)
ds_read_b64_tr_b16 v[120:121],v4 offset:256
v_fma_f32 v78,v78,s36,v13
v_mfma_f32_16x16x32_bf16 v[176:179],v[128:131],v[20:23],0
ds_read_b64_tr_b16 v[122:123],v4 offset:6400
v_fma_f32 v79,v79,s36,v13
v_mfma_f32_16x16x32_bf16 v[180:183],v[132:135],v[20:23],0
ds_read_b64_tr_b16 v[126:127],v5 offset:6400
v_fma_f32 v84,v84,s36,v14
v_mfma_f32_16x16x32_bf16 v[228:231],v[132:135],v[24:27],0
v_exp_f32 v88,v88
v_mfma_f32_16x16x32_bf16 v[224:227],v[128:131],v[24:27],0
v_exp_f32 v89,v89
v_mfma_f32_16x16x32_bf16 a[16:19],v[128:131],v[28:31],0
v_exp_f32 v90,v90
v_mfma_f32_16x16x32_bf16 a[20:23],v[132:135],v[28:31],0
v_exp_f32 v91,v91
v_mfma_f32_16x16x32_bf16 a[68:71],v[132:135],v[32:35],0
v_cvt_pk_bf16_f32 v48,v88,v89
v_cvt_pk_bf16_f32 v49,v90,v91
v_mfma_f32_16x16x32_bf16 a[64:67],v[128:131],v[32:35],0
v_exp_f32 v96,v96
v_mfma_f32_16x16x32_bf16 a[72:75],v[136:139],v[32:35],0
s_waitcnt lgkmcnt(2)
v_exp_f32 v97,v97
v_mfma_f32_16x16x32_bf16 a[76:79],v[140:143],v[32:35],0
v_exp_f32 v98,v98
v_mfma_f32_16x16x32_bf16 a[28:31],v[140:143],v[28:31],0
v_exp_f32 v99,v99
v_mfma_f32_16x16x32_bf16 a[24:27],v[136:139],v[28:31],0
v_cvt_pk_bf16_f32 v52,v96,v97
v_cvt_pk_bf16_f32 v53,v98,v99
v_mfma_f32_16x16x32_bf16 v[232:235],v[136:139],v[24:27],0
v_exp_f32 v76,v76
v_mfma_f32_16x16x32_bf16 v[236:239],v[140:143],v[24:27],0
v_exp_f32 v77,v77
v_mfma_f32_16x16x32_bf16 v[188:191],v[140:143],v[20:23],0
v_exp_f32 v78,v78
v_mfma_f32_16x16x32_bf16 v[184:187],v[136:139],v[20:23],0
v_exp_f32 v79,v79
v_mfma_f32_16x16x32_bf16 v[192:195],v[112:115],v[20:23],0
v_cvt_pk_bf16_f32 v42,v76,v77
v_cvt_pk_bf16_f32 v43,v78,v79
s_waitcnt vmcnt(30) lgkmcnt(0)
v_mfma_f32_16x16x32_bf16 v[196:199],v[116:119],v[20:23],0
s_barrier
v_mfma_f32_16x16x32_bf16 v[244:247],v[116:119],v[24:27],0
ds_read_b128 v[140:143],v1 offset:24704
v_fma_f32 v85,v85,s36,v14
v_mfma_f32_16x16x32_bf16 v[240:243],v[112:115],v[24:27],0
ds_read_b128 v[136:139],v0 offset:24704
v_fma_f32 v86,v86,s36,v14
v_mfma_f32_16x16x32_bf16 a[32:35],v[112:115],v[28:31],0
ds_read_b128 v[132:135],v1 offset:24576
v_fma_f32 v87,v87,s36,v14
v_mfma_f32_16x16x32_bf16 a[36:39],v[116:119],v[28:31],0
ds_read_b128 v[128:131],v0 offset:24576
v_fma_f32 v92,v92,s36,v15
v_mfma_f32_16x16x32_bf16 a[84:87],v[116:119],v[32:35],0
ds_read_b128 v[116:119],v1 offset:24832
v_fma_f32 v93,v93,s36,v15
v_mfma_f32_16x16x32_bf16 a[80:83],v[112:115],v[32:35],0
buffer_load_dwordx4 v6,s[8:11],s21 offen offset:0 lds
v_mfma_f32_16x16x32_bf16 a[88:91],v[120:123],v[32:35],0
ds_read_b128 v[112:115],v0 offset:24832
v_fma_f32 v94,v94,s36,v15
v_mfma_f32_16x16x32_bf16 a[92:95],v[124:127],v[32:35],0
v_exp_f32 v84,v84
v_mfma_f32_16x16x32_bf16 a[44:47],v[124:127],v[28:31],0
v_exp_f32 v85,v85
v_mfma_f32_16x16x32_bf16 a[40:43],v[120:123],v[28:31],0
v_exp_f32 v86,v86
v_mfma_f32_16x16x32_bf16 v[248:251],v[120:123],v[24:27],0
v_exp_f32 v87,v87
v_mfma_f32_16x16x32_bf16 v[252:255],v[124:127],v[24:27],0
v_cvt_pk_bf16_f32 v46,v84,v85
v_cvt_pk_bf16_f32 v47,v86,v87
v_mfma_f32_16x16x32_bf16 v[204:207],v[124:127],v[20:23],0
ds_read_b128 v[124:127],v1 offset:30720
v_fma_f32 v95,v95,s36,v15
v_smfmac_f32_16x16x64_bf16 v[60:63],v[152:155],v[40:47],v18
v_fma_f32 v100,v100,s36,v16
v_mfma_f32_16x16x32_bf16 v[200:203],v[120:123],v[20:23],0
buffer_load_dwordx4 v7,s[8:11],s21 offen offset:1024 lds
s_waitcnt lgkmcnt(1)
v_mfma_f32_16x16x32_bf16 v[72:75],v[116:119],a[164:167],0
ds_read_b128 v[120:123],v0 offset:30720
v_fma_f32 v101,v101,s36,v16
v_mfma_f32_16x16x32_bf16 v[72:75],v[112:115],a[160:163],v[72:75]
v_exp_f32 v92,v92
v_mfma_f32_16x16x32_bf16 v[72:75],v[140:143],a[156:159],v[72:75]
v_exp_f32 v93,v93
v_mfma_f32_16x16x32_bf16 v[72:75],v[136:139],a[152:155],v[72:75]
v_exp_f32 v94,v94
v_mfma_f32_16x16x32_bf16 v[72:75],v[132:135],a[148:151],v[72:75]
v_exp_f32 v95,v95
v_mfma_f32_16x16x32_bf16 v[72:75],v[128:131],a[144:147],v[72:75]
v_cvt_pk_bf16_f32 v50,v92,v93
v_cvt_pk_bf16_f32 v51,v94,v95
v_mfma_f32_16x16x32_bf16 v[80:83],v[128:131],a[168:171],0
v_fma_f32 v102,v102,s36,v16
v_fma_f32 v103,v103,s36,v16
v_mfma_f32_16x16x32_bf16 v[80:83],v[132:135],a[172:175],v[80:83]
v_exp_f32 v100,v100
v_mfma_f32_16x16x32_bf16 v[80:83],v[136:139],a[176:179],v[80:83]
buffer_load_dwordx4 v8,s[8:11],s21 offen offset:2048 lds
v_mfma_f32_16x16x32_bf16 v[80:83],v[140:143],a[180:183],v[80:83]
s_add_u32 s21,s21,12288
v_exp_f32 v101,v101
v_mfma_f32_16x16x32_bf16 v[80:83],v[112:115],a[184:187],v[80:83]
s_add_u32 m0,s22,12288
v_exp_f32 v102,v102
v_mfma_f32_16x16x32_bf16 v[80:83],v[116:119],a[188:191],v[80:83]
v_exp_f32 v103,v103
v_mfma_f32_16x16x32_bf16 v[88:91],v[116:119],a[212:215],0
v_cvt_pk_bf16_f32 v54,v100,v101
v_cvt_pk_bf16_f32 v55,v102,v103
v_mfma_f32_16x16x32_bf16 v[88:91],v[112:115],a[208:211],v[88:91]
v_fma_f32 v72,v72,s36,v13
v_fma_f32 v73,v73,s36,v13
v_smfmac_f32_16x16x64_bf16 v[64:67],v[152:155],v[48:55],v18
v_fma_f32 v74,v74,s36,v13
v_mfma_f32_16x16x32_bf16 v[88:91],v[140:143],a[204:207],v[88:91]
v_fma_f32 v75,v75,s36,v13
v_fma_f32 v80,v80,s36,v14
v_mfma_f32_16x16x32_bf16 v[88:91],v[136:139],a[200:203],v[88:91]
v_fma_f32 v81,v81,s36,v14
v_mfma_f32_16x16x32_bf16 v[88:91],v[132:135],a[196:199],v[88:91]
buffer_load_dwordx4 v6,s[4:7],s20 offen offset:0 lds
v_mfma_f32_16x16x32_bf16 v[88:91],v[128:131],a[192:195],v[88:91]
v_exp_f32 v72,v72
v_mfma_f32_16x16x32_bf16 v[96:99],v[128:131],a[216:219],0
ds_read_b128 v[128:131],v0 offset:30848
v_mfma_f32_16x16x32_bf16 v[96:99],v[132:135],a[220:223],v[96:99]
ds_read_b128 v[132:135],v1 offset:30848
v_mfma_f32_16x16x32_bf16 v[96:99],v[136:139],a[224:227],v[96:99]
ds_read_b128 v[136:139],v0 offset:30976
v_mfma_f32_16x16x32_bf16 v[96:99],v[140:143],a[228:231],v[96:99]
ds_read_b128 v[140:143],v1 offset:30976
v_mfma_f32_16x16x32_bf16 v[96:99],v[112:115],a[232:235],v[96:99]
v_exp_f32 v73,v73
v_mfma_f32_16x16x32_bf16 v[96:99],v[116:119],a[236:239],v[96:99]
s_waitcnt lgkmcnt(4)
v_exp_f32 v74,v74
v_mfma_f32_16x16x32_bf16 v[76:79],v[120:123],a[144:147],0
v_exp_f32 v75,v75
v_mfma_f32_16x16x32_bf16 v[76:79],v[124:127],a[148:151],v[76:79]
buffer_load_dwordx4 v7,s[4:7],s20 offen offset:1024 lds
v_exp_f32 v80,v80
v_exp_f32 v81,v81
s_waitcnt lgkmcnt(3)
v_mfma_f32_16x16x32_bf16 v[76:79],v[128:131],a[152:155],v[76:79]
s_waitcnt lgkmcnt(2)
v_cvt_pk_bf16_f32 v20,v72,v73
v_cvt_pk_bf16_f32 v21,v74,v75
v_mfma_f32_16x16x32_bf16 v[76:79],v[132:135],a[156:159],v[76:79]
s_waitcnt lgkmcnt(1)
v_cvt_pk_bf16_f32 v24,v80,v81
v_mfma_f32_16x16x32_bf16 v[76:79],v[136:139],a[160:163],v[76:79]
s_waitcnt lgkmcnt(0)
v_mfma_f32_16x16x32_bf16 v[76:79],v[140:143],a[164:167],v[76:79]
v_mfma_f32_16x16x32_bf16 v[84:87],v[140:143],a[188:191],0
v_mfma_f32_16x16x32_bf16 v[84:87],v[136:139],a[184:187],v[84:87]
v_mfma_f32_16x16x32_bf16 v[84:87],v[132:135],a[180:183],v[84:87]
v_mfma_f32_16x16x32_bf16 v[84:87],v[128:131],a[176:179],v[84:87]
buffer_load_dwordx4 v8,s[4:7],s20 offen offset:2048 lds
v_mfma_f32_16x16x32_bf16 v[84:87],v[124:127],a[172:175],v[84:87]
s_add_u32 s20,s20,12288
ds_read_b64_tr_b16 v[112:113],v2 offset:12288
v_mfma_f32_16x16x32_bf16 v[84:87],v[120:123],a[168:171],v[84:87]
ds_read_b64_tr_b16 v[114:115],v2 offset:18432
v_mfma_f32_16x16x32_bf16 v[92:95],v[120:123],a[192:195],0
ds_read_b64_tr_b16 v[116:117],v3 offset:12288
v_mfma_f32_16x16x32_bf16 v[92:95],v[124:127],a[196:199],v[92:95]
ds_read_b64_tr_b16 v[118:119],v3 offset:18432
v_mfma_f32_16x16x32_bf16 v[92:95],v[128:131],a[200:203],v[92:95]
v_mfma_f32_16x16x32_bf16 v[92:95],v[132:135],a[204:207],v[92:95]
v_mfma_f32_16x16x32_bf16 v[92:95],v[136:139],a[208:211],v[92:95]
v_mfma_f32_16x16x32_bf16 v[92:95],v[140:143],a[212:215],v[92:95]
v_mfma_f32_16x16x32_bf16 v[100:103],v[140:143],a[236:239],0
v_mfma_f32_16x16x32_bf16 v[100:103],v[136:139],a[232:235],v[100:103]
v_mfma_f32_16x16x32_bf16 v[100:103],v[132:135],a[228:231],v[100:103]
v_mfma_f32_16x16x32_bf16 v[100:103],v[128:131],a[224:227],v[100:103]
v_mfma_f32_16x16x32_bf16 v[100:103],v[124:127],a[220:223],v[100:103]
ds_read_b64_tr_b16 v[124:125],v5 offset:12288
v_mfma_f32_16x16x32_bf16 v[100:103],v[120:123],a[216:219],v[100:103]
s_waitcnt lgkmcnt(1)
ds_read_b64_tr_b16 v[120:121],v4 offset:12288
ds_read_b64_tr_b16 v[122:123],v4 offset:18432
ds_read_b64_tr_b16 v[126:127],v5 offset:18432
v_mfma_f32_16x16x32_bf16 v[160:163],v[112:115],v[40:43],v[160:163]
s_add_u32 m0,s23,12288
ds_read_b64_tr_b16 v[128:129],v2 offset:12416
v_fma_f32 v82,v82,s36,v14
v_mfma_f32_16x16x32_bf16 v[164:167],v[116:119],v[40:43],v[164:167]
ds_read_b64_tr_b16 v[130:131],v2 offset:18560
v_fma_f32 v83,v83,s36,v14
v_mfma_f32_16x16x32_bf16 v[212:215],v[116:119],v[44:47],v[212:215]
ds_read_b64_tr_b16 v[132:133],v3 offset:12416
v_fma_f32 v88,v88,s36,v15
v_mfma_f32_16x16x32_bf16 v[208:211],v[112:115],v[44:47],v[208:211]
ds_read_b64_tr_b16 v[134:135],v3 offset:18560
v_fma_f32 v89,v89,s36,v15
v_mfma_f32_16x16x32_bf16 a[0:3],v[112:115],v[48:51],a[0:3]
ds_read_b64_tr_b16 v[136:137],v4 offset:12416
v_fma_f32 v90,v90,s36,v15
v_mfma_f32_16x16x32_bf16 a[4:7],v[116:119],v[48:51],a[4:7]
ds_read_b64_tr_b16 v[138:139],v4 offset:18560
v_fma_f32 v91,v91,s36,v15
v_mfma_f32_16x16x32_bf16 a[52:55],v[116:119],v[52:55],a[52:55]
ds_read_b64_tr_b16 v[140:141],v5 offset:12416
v_fma_f32 v96,v96,s36,v16
v_mfma_f32_16x16x32_bf16 a[48:51],v[112:115],v[52:55],a[48:51]
s_waitcnt lgkmcnt(8)
ds_read_b64_tr_b16 v[142:143],v5 offset:18560
v_fma_f32 v97,v97,s36,v16
v_mfma_f32_16x16x32_bf16 a[56:59],v[120:123],v[52:55],a[56:59]
s_waitcnt lgkmcnt(7)
ds_read_b64_tr_b16 v[112:113],v2 offset:12544
v_fma_f32 v98,v98,s36,v16
v_mfma_f32_16x16x32_bf16 a[60:63],v[124:127],v[52:55],a[60:63]
ds_read_b64_tr_b16 v[114:115],v2 offset:18688
v_fma_f32 v99,v99,s36,v16
v_mfma_f32_16x16x32_bf16 a[12:15],v[124:127],v[48:51],a[12:15]
ds_read_b64_tr_b16 v[116:117],v3 offset:12544
v_fma_f32 v76,v76,s36,v13
v_mfma_f32_16x16x32_bf16 a[8:11],v[120:123],v[48:51],a[8:11]
ds_read_b64_tr_b16 v[118:119],v3 offset:18688
v_fma_f32 v77,v77,s36,v13
v_mfma_f32_16x16x32_bf16 v[216:219],v[120:123],v[44:47],v[216:219]
v_exp_f32 v82,v82
v_mfma_f32_16x16x32_bf16 v[220:223],v[124:127],v[44:47],v[220:223]
v_exp_f32 v83,v83
v_mfma_f32_16x16x32_bf16 v[172:175],v[124:127],v[40:43],v[172:175]
ds_read_b64_tr_b16 v[124:125],v5 offset:12544
v_cvt_pk_bf16_f32 v25,v82,v83
v_mfma_f32_16x16x32_bf16 v[168:171],v[120:123],v[40:43],v[168:171]
s_waitcnt lgkmcnt(5)
ds_read_b64_tr_b16 v[120:121],v4 offset:12544
v_fma_f32 v78,v78,s36,v13
v_mfma_f32_16x16x32_bf16 v[176:179],v[128:131],v[40:43],v[176:179]
ds_read_b64_tr_b16 v[122:123],v4 offset:18688
v_fma_f32 v79,v79,s36,v13
v_mfma_f32_16x16x32_bf16 v[180:183],v[132:135],v[40:43],v[180:183]
ds_read_b64_tr_b16 v[126:127],v5 offset:18688
v_fma_f32 v84,v84,s36,v14
v_mfma_f32_16x16x32_bf16 v[228:231],v[132:135],v[44:47],v[228:231]
v_exp_f32 v88,v88
v_mfma_f32_16x16x32_bf16 v[224:227],v[128:131],v[44:47],v[224:227]
v_exp_f32 v89,v89
v_mfma_f32_16x16x32_bf16 a[16:19],v[128:131],v[48:51],a[16:19]
v_exp_f32 v90,v90
v_mfma_f32_16x16x32_bf16 a[20:23],v[132:135],v[48:51],a[20:23]
v_exp_f32 v91,v91
v_mfma_f32_16x16x32_bf16 a[68:71],v[132:135],v[52:55],a[68:71]
v_cvt_pk_bf16_f32 v28,v88,v89
v_cvt_pk_bf16_f32 v29,v90,v91
v_mfma_f32_16x16x32_bf16 a[64:67],v[128:131],v[52:55],a[64:67]
v_exp_f32 v96,v96
v_mfma_f32_16x16x32_bf16 a[72:75],v[136:139],v[52:55],a[72:75]
v_exp_f32 v97,v97
v_mfma_f32_16x16x32_bf16 a[76:79],v[140:143],v[52:55],a[76:79]
v_exp_f32 v98,v98
v_mfma_f32_16x16x32_bf16 a[28:31],v[140:143],v[48:51],a[28:31]
v_exp_f32 v99,v99
v_mfma_f32_16x16x32_bf16 a[24:27],v[136:139],v[48:51],a[24:27]
v_cvt_pk_bf16_f32 v32,v96,v97
v_cvt_pk_bf16_f32 v33,v98,v99
v_mfma_f32_16x16x32_bf16 v[232:235],v[136:139],v[44:47],v[232:235]
v_exp_f32 v76,v76
v_mfma_f32_16x16x32_bf16 v[236:239],v[140:143],v[44:47],v[236:239]
v_exp_f32 v77,v77
v_mfma_f32_16x16x32_bf16 v[188:191],v[140:143],v[40:43],v[188:191]
v_exp_f32 v78,v78
v_mfma_f32_16x16x32_bf16 v[184:187],v[136:139],v[40:43],v[184:187]
s_waitcnt lgkmcnt(0)
v_exp_f32 v79,v79
v_mfma_f32_16x16x32_bf16 v[192:195],v[112:115],v[40:43],v[192:195]
v_cvt_pk_bf16_f32 v22,v76,v77
v_cvt_pk_bf16_f32 v23,v78,v79
s_waitcnt vmcnt(6)
v_mfma_f32_16x16x32_bf16 v[196:199],v[116:119],v[40:43],v[196:199]
s_barrier
v_mfma_f32_16x16x32_bf16 v[244:247],v[116:119],v[44:47],v[244:247]
ds_read_b128 v[140:143],v1 offset:128
v_fma_f32 v85,v85,s36,v14
v_mfma_f32_16x16x32_bf16 v[240:243],v[112:115],v[44:47],v[240:243]
ds_read_b128 v[136:139],v0 offset:128
v_fma_f32 v86,v86,s36,v14
v_mfma_f32_16x16x32_bf16 a[32:35],v[112:115],v[48:51],a[32:35]
ds_read_b128 v[132:135],v1 offset:0
v_fma_f32 v87,v87,s36,v14
v_mfma_f32_16x16x32_bf16 a[36:39],v[116:119],v[48:51],a[36:39]
ds_read_b128 v[128:131],v0 offset:0
v_fma_f32 v92,v92,s36,v15
v_mfma_f32_16x16x32_bf16 a[84:87],v[116:119],v[52:55],a[84:87]
ds_read_b128 v[116:119],v1 offset:256
v_fma_f32 v93,v93,s36,v15
v_mfma_f32_16x16x32_bf16 a[80:83],v[112:115],v[52:55],a[80:83]
buffer_load_dwordx4 v6,s[8:11],s21 offen offset:0 lds
v_mfma_f32_16x16x32_bf16 a[88:91],v[120:123],v[52:55],a[88:91]
ds_read_b128 v[112:115],v0 offset:256
v_fma_f32 v94,v94,s36,v15
v_mfma_f32_16x16x32_bf16 a[92:95],v[124:127],v[52:55],a[92:95]
v_exp_f32 v84,v84
v_mfma_f32_16x16x32_bf16 a[44:47],v[124:127],v[48:51],a[44:47]
v_exp_f32 v85,v85
v_mfma_f32_16x16x32_bf16 a[40:43],v[120:123],v[48:51],a[40:43]
v_exp_f32 v86,v86
v_mfma_f32_16x16x32_bf16 v[248:251],v[120:123],v[44:47],v[248:251]
v_exp_f32 v87,v87
v_mfma_f32_16x16x32_bf16 v[252:255],v[124:127],v[44:47],v[252:255]
v_cvt_pk_bf16_f32 v26,v84,v85
v_cvt_pk_bf16_f32 v27,v86,v87
v_mfma_f32_16x16x32_bf16 v[204:207],v[124:127],v[40:43],v[204:207]
ds_read_b128 v[124:127],v1 offset:6144
v_fma_f32 v95,v95,s36,v15
v_smfmac_f32_16x16x64_bf16 v[60:63],v[152:155],v[20:27],v18
v_fma_f32 v100,v100,s36,v16
v_mfma_f32_16x16x32_bf16 v[200:203],v[120:123],v[40:43],v[200:203]
buffer_load_dwordx4 v7,s[8:11],s21 offen offset:1024 lds
s_waitcnt lgkmcnt(1)
v_mfma_f32_16x16x32_bf16 v[72:75],v[116:119],a[164:167],0
ds_read_b128 v[120:123],v0 offset:6144
v_fma_f32 v101,v101,s36,v16
v_mfma_f32_16x16x32_bf16 v[72:75],v[112:115],a[160:163],v[72:75]
v_exp_f32 v92,v92
v_mfma_f32_16x16x32_bf16 v[72:75],v[140:143],a[156:159],v[72:75]
v_exp_f32 v93,v93
v_mfma_f32_16x16x32_bf16 v[72:75],v[136:139],a[152:155],v[72:75]
v_exp_f32 v94,v94
v_mfma_f32_16x16x32_bf16 v[72:75],v[132:135],a[148:151],v[72:75]
v_exp_f32 v95,v95
v_mfma_f32_16x16x32_bf16 v[72:75],v[128:131],a[144:147],v[72:75]
v_cvt_pk_bf16_f32 v30,v92,v93
v_cvt_pk_bf16_f32 v31,v94,v95
v_mfma_f32_16x16x32_bf16 v[80:83],v[128:131],a[168:171],0
v_fma_f32 v102,v102,s36,v16
v_fma_f32 v103,v103,s36,v16
v_mfma_f32_16x16x32_bf16 v[80:83],v[132:135],a[172:175],v[80:83]
v_exp_f32 v100,v100
v_mfma_f32_16x16x32_bf16 v[80:83],v[136:139],a[176:179],v[80:83]
buffer_load_dwordx4 v8,s[8:11],s21 offen offset:2048 lds
v_mfma_f32_16x16x32_bf16 v[80:83],v[140:143],a[180:183],v[80:83]
s_add_u32 s21,s21,12288
v_exp_f32 v101,v101
v_mfma_f32_16x16x32_bf16 v[80:83],v[112:115],a[184:187],v[80:83]
s_add_u32 m0,s22,24576
v_exp_f32 v102,v102
v_mfma_f32_16x16x32_bf16 v[80:83],v[116:119],a[188:191],v[80:83]
v_exp_f32 v103,v103
v_mfma_f32_16x16x32_bf16 v[88:91],v[116:119],a[212:215],0
v_cvt_pk_bf16_f32 v34,v100,v101
v_cvt_pk_bf16_f32 v35,v102,v103
v_mfma_f32_16x16x32_bf16 v[88:91],v[112:115],a[208:211],v[88:91]
v_fma_f32 v72,v72,s36,v13
v_fma_f32 v73,v73,s36,v13
v_smfmac_f32_16x16x64_bf16 v[64:67],v[152:155],v[28:35],v18
v_fma_f32 v74,v74,s36,v13
v_mfma_f32_16x16x32_bf16 v[88:91],v[140:143],a[204:207],v[88:91]
v_fma_f32 v75,v75,s36,v13
v_fma_f32 v80,v80,s36,v14
v_mfma_f32_16x16x32_bf16 v[88:91],v[136:139],a[200:203],v[88:91]
v_fma_f32 v81,v81,s36,v14
v_mfma_f32_16x16x32_bf16 v[88:91],v[132:135],a[196:199],v[88:91]
buffer_load_dwordx4 v6,s[4:7],s20 offen offset:0 lds
v_mfma_f32_16x16x32_bf16 v[88:91],v[128:131],a[192:195],v[88:91]
v_exp_f32 v72,v72
v_mfma_f32_16x16x32_bf16 v[96:99],v[128:131],a[216:219],0
ds_read_b128 v[128:131],v0 offset:6272
v_mfma_f32_16x16x32_bf16 v[96:99],v[132:135],a[220:223],v[96:99]
ds_read_b128 v[132:135],v1 offset:6272
v_mfma_f32_16x16x32_bf16 v[96:99],v[136:139],a[224:227],v[96:99]
ds_read_b128 v[136:139],v0 offset:6400
v_mfma_f32_16x16x32_bf16 v[96:99],v[140:143],a[228:231],v[96:99]
ds_read_b128 v[140:143],v1 offset:6400
v_mfma_f32_16x16x32_bf16 v[96:99],v[112:115],a[232:235],v[96:99]
v_exp_f32 v73,v73
v_mfma_f32_16x16x32_bf16 v[96:99],v[116:119],a[236:239],v[96:99]
s_waitcnt lgkmcnt(4)
v_exp_f32 v74,v74
v_mfma_f32_16x16x32_bf16 v[76:79],v[120:123],a[144:147],0
v_exp_f32 v75,v75
v_mfma_f32_16x16x32_bf16 v[76:79],v[124:127],a[148:151],v[76:79]
buffer_load_dwordx4 v7,s[4:7],s20 offen offset:1024 lds
v_exp_f32 v80,v80
v_exp_f32 v81,v81
s_waitcnt lgkmcnt(3)
v_mfma_f32_16x16x32_bf16 v[76:79],v[128:131],a[152:155],v[76:79]
s_waitcnt lgkmcnt(2)
v_cvt_pk_bf16_f32 v40,v72,v73
v_cvt_pk_bf16_f32 v41,v74,v75
v_mfma_f32_16x16x32_bf16 v[76:79],v[132:135],a[156:159],v[76:79]
s_waitcnt lgkmcnt(1)
v_cvt_pk_bf16_f32 v44,v80,v81
v_mfma_f32_16x16x32_bf16 v[76:79],v[136:139],a[160:163],v[76:79]
s_waitcnt lgkmcnt(0)
v_mfma_f32_16x16x32_bf16 v[76:79],v[140:143],a[164:167],v[76:79]
v_mfma_f32_16x16x32_bf16 v[84:87],v[140:143],a[188:191],0
v_mfma_f32_16x16x32_bf16 v[84:87],v[136:139],a[184:187],v[84:87]
v_mfma_f32_16x16x32_bf16 v[84:87],v[132:135],a[180:183],v[84:87]
v_mfma_f32_16x16x32_bf16 v[84:87],v[128:131],a[176:179],v[84:87]
buffer_load_dwordx4 v8,s[4:7],s20 offen offset:2048 lds
v_mfma_f32_16x16x32_bf16 v[84:87],v[124:127],a[172:175],v[84:87]
s_add_u32 s20,s20,12288
ds_read_b64_tr_b16 v[112:113],v2 offset:24576
v_mfma_f32_16x16x32_bf16 v[84:87],v[120:123],a[168:171],v[84:87]
ds_read_b64_tr_b16 v[114:115],v2 offset:30720
v_mfma_f32_16x16x32_bf16 v[92:95],v[120:123],a[192:195],0
ds_read_b64_tr_b16 v[116:117],v3 offset:24576
v_mfma_f32_16x16x32_bf16 v[92:95],v[124:127],a[196:199],v[92:95]
ds_read_b64_tr_b16 v[118:119],v3 offset:30720
v_mfma_f32_16x16x32_bf16 v[92:95],v[128:131],a[200:203],v[92:95]
v_mfma_f32_16x16x32_bf16 v[92:95],v[132:135],a[204:207],v[92:95]
v_mfma_f32_16x16x32_bf16 v[92:95],v[136:139],a[208:211],v[92:95]
v_mfma_f32_16x16x32_bf16 v[92:95],v[140:143],a[212:215],v[92:95]
v_mfma_f32_16x16x32_bf16 v[100:103],v[140:143],a[236:239],0
v_mfma_f32_16x16x32_bf16 v[100:103],v[136:139],a[232:235],v[100:103]
v_mfma_f32_16x16x32_bf16 v[100:103],v[132:135],a[228:231],v[100:103]
v_mfma_f32_16x16x32_bf16 v[100:103],v[128:131],a[224:227],v[100:103]
v_mfma_f32_16x16x32_bf16 v[100:103],v[124:127],a[220:223],v[100:103]
ds_read_b64_tr_b16 v[124:125],v5 offset:24576
v_mfma_f32_16x16x32_bf16 v[100:103],v[120:123],a[216:219],v[100:103]
ds_read_b64_tr_b16 v[120:121],v4 offset:24576
ds_read_b64_tr_b16 v[122:123],v4 offset:30720
ds_read_b64_tr_b16 v[126:127],v5 offset:30720
s_mov_b32 s38,0
s_branch L_loop4
L_tr55:
s_waitcnt vmcnt(42)
s_waitcnt lgkmcnt(4)
v_mfma_f32_16x16x32_bf16 v[160:163],v[112:115],v[20:23],v[160:163]
s_add_u32 m0,s24,0
ds_read_b128 a[144:147],v11 offset:0
v_fma_f32 v90,v90,s36,v15
v_mfma_f32_16x16x32_bf16 v[164:167],v[116:119],v[20:23],v[164:167]
ds_read_b128 a[148:151],v12 offset:0
v_fma_f32 v91,v91,s36,v15
v_mfma_f32_16x16x32_bf16 v[212:215],v[116:119],v[24:27],v[212:215]
ds_read_b128 a[152:155],v11 offset:128
v_fma_f32 v96,v96,s36,v16
v_mfma_f32_16x16x32_bf16 v[208:211],v[112:115],v[24:27],v[208:211]
ds_read_b128 a[156:159],v12 offset:128
v_fma_f32 v97,v97,s36,v16
v_mfma_f32_16x16x32_bf16 a[0:3],v[112:115],v[28:31],a[0:3]
ds_read_b128 a[160:163],v11 offset:256
v_fma_f32 v98,v98,s36,v16
v_mfma_f32_16x16x32_bf16 a[4:7],v[116:119],v[28:31],a[4:7]
ds_read_b128 a[164:167],v12 offset:256
v_fma_f32 v99,v99,s36,v16
ds_read_b64_tr_b16 v[128:129],v2 offset:24704
ds_read_b64_tr_b16 v[130:131],v2 offset:30848
ds_read_b64_tr_b16 v[132:133],v3 offset:24704
ds_read_b64_tr_b16 v[134:135],v3 offset:30848
ds_read_b64_tr_b16 v[136:137],v4 offset:24704
ds_read_b64_tr_b16 v[138:139],v4 offset:30848
ds_read_b64_tr_b16 v[140:141],v5 offset:24704
ds_read_b64_tr_b16 v[142:143],v5 offset:30848
ds_read_b128 a[168:171],v11 offset:6144
v_mfma_f32_16x16x32_bf16 a[52:55],v[116:119],v[32:35],a[52:55]
v_fma_f32 v104,v104,s36,v17
ds_read_b128 a[172:175],v12 offset:6144
v_mfma_f32_16x16x32_bf16 a[48:51],v[112:115],v[32:35],a[48:51]
v_fma_f32 v105,v105,s36,v17
ds_read_b128 a[176:179],v11 offset:6272
v_mfma_f32_16x16x32_bf16 a[96:99],v[112:115],v[36:39],a[96:99]
s_waitcnt lgkmcnt(11)
buffer_load_dwordx4 v6,s[12:15],s28 offen offset:0 nt lds
v_mfma_f32_16x16x32_bf16 a[100:103],v[116:119],v[36:39],a[100:103]
ds_read_b64_tr_b16 v[112:113],v2 offset:24832
ds_read_b128 a[180:183],v12 offset:6272
v_mfma_f32_16x16x32_bf16 a[104:107],v[120:123],v[36:39],a[104:107]
v_fma_f32 v106,v106,s36,v17
ds_read_b128 a[184:187],v11 offset:6400
v_mfma_f32_16x16x32_bf16 a[108:111],v[124:127],v[36:39],a[108:111]
v_fma_f32 v107,v107,s36,v17
ds_read_b128 a[188:191],v12 offset:6400
v_mfma_f32_16x16x32_bf16 a[60:63],v[124:127],v[32:35],a[60:63]
v_fma_f32 v76,v76,s36,v13
v_fma_f32 v77,v77,s36,v13
v_mfma_f32_16x16x32_bf16 a[56:59],v[120:123],v[32:35],a[56:59]
buffer_load_dwordx4 v7,s[12:15],s28 offen offset:1024 nt lds
v_mfma_f32_16x16x32_bf16 a[8:11],v[120:123],v[28:31],a[8:11]
ds_read_b64_tr_b16 v[114:115],v2 offset:30976
ds_read_b64_tr_b16 v[116:117],v3 offset:24832
ds_read_b64_tr_b16 v[118:119],v3 offset:30976
v_mfma_f32_16x16x32_bf16 a[12:15],v[124:127],v[28:31],a[12:15]
v_fma_f32 v78,v78,s36,v13
v_fma_f32 v79,v79,s36,v13
v_mfma_f32_16x16x32_bf16 v[220:223],v[124:127],v[24:27],v[220:223]
v_fma_f32 v84,v84,s36,v14
v_fma_f32 v85,v85,s36,v14
v_mfma_f32_16x16x32_bf16 v[216:219],v[120:123],v[24:27],v[216:219]
v_fma_f32 v86,v86,s36,v14
v_fma_f32 v87,v87,s36,v14
v_mfma_f32_16x16x32_bf16 v[168:171],v[120:123],v[20:23],v[168:171]
ds_read_b64_tr_b16 v[120:121],v4 offset:24832
v_fma_f32 v92,v92,s36,v15
v_mfma_f32_16x16x32_bf16 v[172:175],v[124:127],v[20:23],v[172:175]
s_waitcnt lgkmcnt(4)
ds_read_b64_tr_b16 v[122:123],v4 offset:30976
v_fma_f32 v93,v93,s36,v15
v_mfma_f32_16x16x32_bf16 v[176:179],v[128:131],v[20:23],v[176:179]
buffer_load_dwordx4 v8,s[12:15],s28 offen offset:2048 nt lds
v_mfma_f32_16x16x32_bf16 v[180:183],v[132:135],v[20:23],v[180:183]
s_add_u32 s28,s28,3072
ds_read_b64_tr_b16 v[124:125],v5 offset:24832
v_fma_f32 v94,v94,s36,v15
v_mfma_f32_16x16x32_bf16 v[228:231],v[132:135],v[24:27],v[228:231]
s_add_u32 m0,s24,3072
ds_read_b64_tr_b16 v[126:127],v5 offset:30976
v_fma_f32 v95,v95,s36,v15
v_mfma_f32_16x16x32_bf16 v[224:227],v[128:131],v[24:27],v[224:227]
v_fma_f32 v100,v100,s36,v16
v_fma_f32 v101,v101,s36,v16
v_mfma_f32_16x16x32_bf16 a[16:19],v[128:131],v[28:31],a[16:19]
v_fma_f32 v102,v102,s36,v16
v_fma_f32 v103,v103,s36,v16
v_mfma_f32_16x16x32_bf16 a[20:23],v[132:135],v[28:31],a[20:23]
v_fma_f32 v108,v108,s36,v17
v_fma_f32 v109,v109,s36,v17
v_mfma_f32_16x16x32_bf16 a[68:71],v[132:135],v[32:35],a[68:71]
v_fma_f32 v110,v110,s36,v17
v_fma_f32 v111,v111,s36,v17
v_mfma_f32_16x16x32_bf16 a[64:67],v[128:131],v[32:35],a[64:67]
v_exp_f32 v90,v90
v_mfma_f32_16x16x32_bf16 a[112:115],v[128:131],v[36:39],a[112:115]
buffer_load_dwordx4 v6,s[12:15],s28 offen offset:0 nt lds
v_mfma_f32_16x16x32_bf16 a[116:119],v[132:135],v[36:39],a[116:119]
v_exp_f32 v91,v91
v_mfma_f32_16x16x32_bf16 a[120:123],v[136:139],v[36:39],a[120:123]
v_exp_f32 v96,v96
v_mfma_f32_16x16x32_bf16 a[124:127],v[140:143],v[36:39],a[124:127]
v_exp_f32 v97,v97
v_mfma_f32_16x16x32_bf16 a[76:79],v[140:143],v[32:35],a[76:79]
v_exp_f32 v98,v98
v_mfma_f32_16x16x32_bf16 a[72:75],v[136:139],v[32:35],a[72:75]
v_exp_f32 v99,v99
v_mfma_f32_16x16x32_bf16 a[24:27],v[136:139],v[28:31],a[24:27]
v_exp_f32 v104,v104
v_mfma_f32_16x16x32_bf16 a[28:31],v[140:143],v[28:31],a[28:31]
v_exp_f32 v105,v105
v_mfma_f32_16x16x32_bf16 v[236:239],v[140:143],v[24:27],v[236:239]
buffer_load_dwordx4 v7,s[12:15],s28 offen offset:1024 nt lds
v_mfma_f32_16x16x32_bf16 v[232:235],v[136:139],v[24:27],v[232:235]
v_exp_f32 v106,v106
v_mfma_f32_16x16x32_bf16 v[184:187],v[136:139],v[20:23],v[184:187]
v_exp_f32 v107,v107
v_mfma_f32_16x16x32_bf16 v[188:191],v[140:143],v[20:23],v[188:191]
s_waitcnt lgkmcnt(0)
v_exp_f32 v76,v76
v_mfma_f32_16x16x32_bf16 v[192:195],v[112:115],v[20:23],v[192:195]
v_exp_f32 v77,v77
v_mfma_f32_16x16x32_bf16 v[196:199],v[116:119],v[20:23],v[196:199]
v_exp_f32 v78,v78
v_mfma_f32_16x16x32_bf16 v[244:247],v[116:119],v[24:27],v[244:247]
v_exp_f32 v79,v79
v_mfma_f32_16x16x32_bf16 v[240:243],v[112:115],v[24:27],v[240:243]
v_exp_f32 v84,v84
v_mfma_f32_16x16x32_bf16 a[32:35],v[112:115],v[28:31],a[32:35]
buffer_load_dwordx4 v8,s[12:15],s28 offen offset:2048 nt lds
s_waitcnt vmcnt(20)
s_barrier
v_mfma_f32_16x16x32_bf16 a[36:39],v[116:119],v[28:31],a[36:39]
s_add_u32 s28,s28,3072
v_exp_f32 v85,v85
v_mfma_f32_16x16x32_bf16 a[84:87],v[116:119],v[32:35],a[84:87]
s_add_u32 m0,s22,0
v_exp_f32 v86,v86
v_mfma_f32_16x16x32_bf16 a[80:83],v[112:115],v[32:35],a[80:83]
buffer_load_dwordx4 v6,s[4:7],s25 offen offset:0 lds
v_mfma_f32_16x16x32_bf16 a[128:131],v[112:115],v[36:39],a[128:131]
buffer_load_dwordx4 v7,s[4:7],s25 offen offset:1024 lds
v_mfma_f32_16x16x32_bf16 a[132:135],v[116:119],v[36:39],a[132:135]
buffer_load_dwordx4 v8,s[4:7],s25 offen offset:2048 lds
v_mfma_f32_16x16x32_bf16 a[136:139],v[120:123],v[36:39],a[136:139]
v_exp_f32 v87,v87
v_mfma_f32_16x16x32_bf16 a[140:143],v[124:127],v[36:39],a[140:143]
v_exp_f32 v92,v92
v_mfma_f32_16x16x32_bf16 a[92:95],v[124:127],v[32:35],a[92:95]
v_exp_f32 v93,v93
v_mfma_f32_16x16x32_bf16 a[88:91],v[120:123],v[32:35],a[88:91]
v_exp_f32 v94,v94
v_mfma_f32_16x16x32_bf16 a[40:43],v[120:123],v[28:31],a[40:43]
ds_read_b64_tr_b16 v[128:129],v2 offset:0
v_exp_f32 v95,v95
v_mfma_f32_16x16x32_bf16 a[44:47],v[124:127],v[28:31],a[44:47]
ds_read_b64_tr_b16 v[130:131],v2 offset:6144
v_exp_f32 v100,v100
v_mfma_f32_16x16x32_bf16 v[252:255],v[124:127],v[24:27],v[252:255]
ds_read_b64_tr_b16 v[132:133],v3 offset:0
v_exp_f32 v101,v101
v_mfma_f32_16x16x32_bf16 v[248:251],v[120:123],v[24:27],v[248:251]
ds_read_b64_tr_b16 v[134:135],v3 offset:6144
v_exp_f32 v102,v102
v_mfma_f32_16x16x32_bf16 v[200:203],v[120:123],v[20:23],v[200:203]
ds_read_b64_tr_b16 v[136:137],v4 offset:0
v_exp_f32 v103,v103
v_mfma_f32_16x16x32_bf16 v[204:207],v[124:127],v[20:23],v[204:207]
ds_read_b64_tr_b16 v[138:139],v4 offset:6144
ds_read_b64_tr_b16 v[140:141],v5 offset:0
ds_read_b64_tr_b16 v[142:143],v5 offset:6144
v_exp_f32 v108,v108
v_exp_f32 v109,v109
v_exp_f32 v110,v110
v_exp_f32 v111,v111
v_cvt_pk_bf16_f32 v49,v90,v91
v_cvt_pk_bf16_f32 v52,v96,v97
v_cvt_pk_bf16_f32 v53,v98,v99
v_cvt_pk_bf16_f32 v56,v104,v105
v_cvt_pk_bf16_f32 v57,v106,v107
v_cvt_pk_bf16_f32 v42,v76,v77
v_cvt_pk_bf16_f32 v43,v78,v79
v_cvt_pk_bf16_f32 v46,v84,v85
v_cvt_pk_bf16_f32 v47,v86,v87
v_cvt_pk_bf16_f32 v50,v92,v93
v_cvt_pk_bf16_f32 v51,v94,v95
v_smfmac_f32_16x16x64_bf16 v[60:63],v[152:155],v[40:47],v18
v_cvt_pk_bf16_f32 v54,v100,v101
v_cvt_pk_bf16_f32 v55,v102,v103
v_cvt_pk_bf16_f32 v58,v108,v109
v_cvt_pk_bf16_f32 v59,v110,v111
v_smfmac_f32_16x16x64_bf16 v[64:67],v[152:155],v[48:55],v18
v_subrev_u32 v10,18432,v10
v_smfmac_f32_16x16x64_bf16 v[68:71],v[152:155],v[52:59],v18
s_waitcnt lgkmcnt(0)
v_mfma_f32_16x16x32_bf16 v[160:163],v[128:131],v[40:43],v[160:163]
s_add_u32 s87,s42,18432
ds_read_b64_tr_b16 v[112:113],v2 offset:128
v_mbcnt_lo_u32_b32 v39,-1,0
v_mfma_f32_16x16x32_bf16 v[164:167],v[132:135],v[40:43],v[164:167]
s_add_u32 s66,s42,24576
ds_read_b64_tr_b16 v[114:115],v2 offset:6272
v_mbcnt_hi_u32_b32 v39,-1,v39
v_mfma_f32_16x16x32_bf16 v[212:215],v[132:135],v[44:47],v[212:215]
ds_read_b64_tr_b16 v[116:117],v3 offset:128
v_and_b32 v38,7,v39
v_mfma_f32_16x16x32_bf16 v[208:211],v[128:131],v[44:47],v[208:211]
ds_read_b64_tr_b16 v[118:119],v3 offset:6272
v_add_f32 v60,v60,v61
v_mfma_f32_16x16x32_bf16 a[0:3],v[128:131],v[48:51],a[0:3]
ds_read_b64_tr_b16 v[120:121],v4 offset:128
v_add_f32 v62,v62,v63
v_mfma_f32_16x16x32_bf16 a[4:7],v[132:135],v[48:51],a[4:7]
ds_read_b64_tr_b16 v[122:123],v4 offset:6272
ds_read_b64_tr_b16 v[124:125],v5 offset:128
ds_read_b64_tr_b16 v[126:127],v5 offset:6272
v_mfma_f32_16x16x32_bf16 a[52:55],v[132:135],v[52:55],a[52:55]
v_add_f32 v64,v64,v65
v_add_f32 v66,v66,v67
v_mfma_f32_16x16x32_bf16 a[48:51],v[128:131],v[52:55],a[48:51]
v_add_f32 v70,v70,v71
v_max3_f32 v19,v60,v62,v64
v_mfma_f32_16x16x32_bf16 a[96:99],v[128:131],v[56:59],a[96:99]
ds_read_b64_tr_b16 v[128:129],v2 offset:256
v_max3_f32 v19,v19,v66,v70
v_mfma_f32_16x16x32_bf16 a[100:103],v[132:135],v[56:59],a[100:103]
ds_read_b64_tr_b16 v[130:131],v2 offset:6400
v_rcp_f32 v66,v66
v_mfma_f32_16x16x32_bf16 a[104:107],v[136:139],v[56:59],a[104:107]
ds_read_b64_tr_b16 v[132:133],v3 offset:256
v_rcp_f32 v70,v70
v_mfma_f32_16x16x32_bf16 a[108:111],v[140:143],v[56:59],a[108:111]
ds_read_b64_tr_b16 v[134:135],v3 offset:6400
v_accvgpr_read_b32 v72,a48
v_accvgpr_read_b32 v73,a49
v_accvgpr_read_b32 v74,a50
v_accvgpr_read_b32 v75,a51
v_pk_mul_f32 v[72:73],v[72:73],v[66:67] op_sel_hi:[1,0]
v_pk_mul_f32 v[74:75],v[74:75],v[66:67] op_sel_hi:[1,0]
v_accvgpr_read_b32 v76,a96
v_accvgpr_read_b32 v77,a97
v_pk_mul_f32 v[76:77],v[76:77],v[70:71] op_sel_hi:[1,0]
v_accvgpr_read_b32 v78,a98
v_accvgpr_read_b32 v79,a99
v_pk_mul_f32 v[78:79],v[78:79],v[70:71] op_sel_hi:[1,0]
v_accvgpr_read_b32 v80,a52
v_accvgpr_read_b32 v81,a53
v_mfma_f32_16x16x32_bf16 a[60:63],v[140:143],v[52:55],a[60:63]
v_accvgpr_read_b32 v82,a54
v_accvgpr_read_b32 v83,a55
v_accvgpr_read_b32 v84,a100
v_accvgpr_read_b32 v85,a101
v_accvgpr_read_b32 v86,a102
v_pk_mul_f32 v[80:81],v[80:81],v[66:67] op_sel_hi:[1,0]
v_pk_mul_f32 v[82:83],v[82:83],v[66:67] op_sel_hi:[1,0]
v_pk_mul_f32 v[84:85],v[84:85],v[70:71] op_sel_hi:[1,0]
v_accvgpr_read_b32 v87,a103
v_pk_mul_f32 v[86:87],v[86:87],v[70:71] op_sel_hi:[1,0]
v_accvgpr_read_b32 v92,a104
v_accvgpr_read_b32 v93,a105
v_mfma_f32_16x16x32_bf16 a[56:59],v[136:139],v[52:55],a[56:59]
v_accvgpr_read_b32 v94,a106
v_accvgpr_read_b32 v95,a107
v_mfma_f32_16x16x32_bf16 a[8:11],v[136:139],v[48:51],a[8:11]
v_accvgpr_read_b32 v100,a108
v_accvgpr_read_b32 v101,a109
v_mfma_f32_16x16x32_bf16 a[12:15],v[140:143],v[48:51],a[12:15]
v_accvgpr_read_b32 v102,a110
v_accvgpr_read_b32 v103,a111
v_mfma_f32_16x16x32_bf16 v[220:223],v[140:143],v[44:47],v[220:223]
v_accvgpr_read_b32 v88,a56
v_accvgpr_read_b32 v89,a57
v_accvgpr_read_b32 v90,a58
v_accvgpr_read_b32 v91,a59
v_accvgpr_read_b32 v96,a60
v_pk_mul_f32 v[92:93],v[92:93],v[70:71] op_sel_hi:[1,0]
v_pk_mul_f32 v[94:95],v[94:95],v[70:71] op_sel_hi:[1,0]
v_pk_mul_f32 v[88:89],v[88:89],v[66:67] op_sel_hi:[1,0]
v_pk_mul_f32 v[90:91],v[90:91],v[66:67] op_sel_hi:[1,0]
v_accvgpr_read_b32 v97,a61
v_accvgpr_read_b32 v98,a62
v_mfma_f32_16x16x32_bf16 v[216:219],v[136:139],v[44:47],v[216:219]
v_accvgpr_read_b32 v99,a63
v_cmp_ngt_f32 vcc,s37,v19
v_mfma_f32_16x16x32_bf16 v[168:171],v[136:139],v[40:43],v[168:171]
ds_read_b64_tr_b16 v[136:137],v4 offset:256
ds_read_b64_tr_b16 v[138:139],v4 offset:6400
v_lshrrev_b32 v19,5,v39
v_xor_b32 v38,v38,v19
v_pk_mul_f32 v[96:97],v[96:97],v[66:67] op_sel_hi:[1,0]
v_pk_mul_f32 v[98:99],v[98:99],v[66:67] op_sel_hi:[1,0]
v_pk_mul_f32 v[100:101],v[100:101],v[70:71] op_sel_hi:[1,0]
v_pk_mul_f32 v[102:103],v[102:103],v[70:71] op_sel_hi:[1,0]
v_and_b32 v19,15,v39
v_lshl_add_u32 v19,v19,7,s24
v_mfma_f32_16x16x32_bf16 v[172:175],v[140:143],v[40:43],v[172:175]
s_cmp_lg_u64 vcc,0
ds_read_b64_tr_b16 v[140:141],v5 offset:256
v_lshl_add_u32 v19,v38,4,v19
s_waitcnt lgkmcnt(3)
v_mfma_f32_16x16x32_bf16 v[176:179],v[112:115],v[40:43],v[176:179]
s_cselect_b32 s62,s32,0
ds_read_b64_tr_b16 v[142:143],v5 offset:6400
v_bfe_u32 v38,v39,4,1
v_mfma_f32_16x16x32_bf16 v[180:183],v[116:119],v[40:43],v[180:183]
s_or_b32 s31,s31,s62
v_lshl_add_u32 v36,v38,3,v19
v_xor_b32 v37,32,v36
v_mfma_f32_16x16x32_bf16 v[228:231],v[116:119],v[44:47],v[228:231]
s_lshl_b32 s32,s32,1
v_xor_b32 v38,64,v36
v_bfe_u32 v19,v39,3,1
v_mfma_f32_16x16x32_bf16 v[224:227],v[112:115],v[44:47],v[224:227]
s_add_u32 m0,s24,6144
v_xor_b32 v39,96,v36
v_lshlrev_b32 v19,11,v19
v_mfma_f32_16x16x32_bf16 a[16:19],v[112:115],v[48:51],a[16:19]
buffer_load_dwordx4 v6,s[12:15],s28 offen offset:0 nt lds
v_mfma_f32_16x16x32_bf16 a[20:23],v[116:119],v[48:51],a[20:23]
buffer_load_dwordx4 v7,s[12:15],s28 offen offset:1024 nt lds
v_mfma_f32_16x16x32_bf16 a[68:71],v[116:119],v[52:55],a[68:71]
buffer_load_dwordx4 v8,s[12:15],s28 offen offset:2048 nt lds
v_mfma_f32_16x16x32_bf16 a[64:67],v[112:115],v[52:55],a[64:67]
s_add_u32 s28,s28,3072
v_cvt_pk_bf16_f32 v72,v72,v73
v_cvt_pk_bf16_f32 v76,v76,v77
v_mfma_f32_16x16x32_bf16 a[112:115],v[112:115],v[56:59],a[112:115]
s_add_u32 m0,s24,9216
v_cvt_pk_bf16_f32 v80,v80,v81
v_cvt_pk_bf16_f32 v84,v84,v85
v_mfma_f32_16x16x32_bf16 a[116:119],v[116:119],v[56:59],a[116:119]
buffer_load_dwordx4 v6,s[12:15],s28 offen offset:0 nt lds
v_mfma_f32_16x16x32_bf16 a[120:123],v[120:123],v[56:59],a[120:123]
buffer_load_dwordx4 v7,s[12:15],s28 offen offset:1024 nt lds
v_mfma_f32_16x16x32_bf16 a[124:127],v[124:127],v[56:59],a[124:127]
v_cvt_pk_bf16_f32 v73,v74,v75
buffer_load_dwordx4 v8,s[12:15],s28 offen offset:2048 nt lds
v_cvt_pk_bf16_f32 v77,v78,v79
ds_write2st64_b64 v36,v[72:73],v[76:77] offset0:36 offset1:40
v_cvt_pk_bf16_f32 v81,v82,v83
v_cvt_pk_bf16_f32 v85,v86,v87
v_accvgpr_read_b32 v78,a66
v_accvgpr_read_b32 v79,a67
v_pk_mul_f32 v[78:79],v[78:79],v[66:67] op_sel_hi:[1,0]
v_accvgpr_read_b32 v76,a64
v_accvgpr_read_b32 v77,a65
v_pk_mul_f32 v[76:77],v[76:77],v[66:67] op_sel_hi:[1,0]
v_accvgpr_read_b32 v82,a114
v_accvgpr_read_b32 v83,a115
v_pk_mul_f32 v[82:83],v[82:83],v[70:71] op_sel_hi:[1,0]
ds_write2st64_b64 v37,v[80:81],v[84:85] offset0:36 offset1:40
v_accvgpr_read_b32 v80,a112
v_accvgpr_read_b32 v81,a113
v_pk_mul_f32 v[80:81],v[80:81],v[70:71] op_sel_hi:[1,0]
v_cvt_pk_bf16_f32 v92,v92,v93
v_cvt_pk_bf16_f32 v88,v88,v89
v_mfma_f32_16x16x32_bf16 a[76:79],v[124:127],v[52:55],a[76:79]
s_add_u32 s28,s28,3072
v_cvt_pk_bf16_f32 v93,v94,v95
v_cvt_pk_bf16_f32 v89,v90,v91
v_accvgpr_read_b32 v86,a70
v_accvgpr_read_b32 v87,a71
ds_write2st64_b64 v38,v[88:89],v[92:93] offset0:36 offset1:40
v_pk_mul_f32 v[86:87],v[86:87],v[66:67] op_sel_hi:[1,0]
v_accvgpr_read_b32 v84,a68
v_accvgpr_read_b32 v85,a69
v_pk_mul_f32 v[84:85],v[84:85],v[66:67] op_sel_hi:[1,0]
v_accvgpr_read_b32 v90,a118
v_accvgpr_read_b32 v91,a119
v_pk_mul_f32 v[90:91],v[90:91],v[70:71] op_sel_hi:[1,0]
v_accvgpr_read_b32 v88,a116
v_accvgpr_read_b32 v89,a117
v_pk_mul_f32 v[88:89],v[88:89],v[70:71] op_sel_hi:[1,0]
v_cvt_pk_bf16_f32 v96,v96,v97
v_cvt_pk_bf16_f32 v100,v100,v101
v_mfma_f32_16x16x32_bf16 a[72:75],v[120:123],v[52:55],a[72:75]
s_waitcnt vmcnt(21)
ds_read_b128 a[192:195],v11 offset:12288
v_cvt_pk_bf16_f32 v97,v98,v99
v_mfma_f32_16x16x32_bf16 a[24:27],v[120:123],v[48:51],a[24:27]
s_add_u32 m0,s23,0
ds_read_b128 a[196:199],v12 offset:12288
v_cvt_pk_bf16_f32 v101,v102,v103
v_mfma_f32_16x16x32_bf16 a[28:31],v[124:127],v[48:51],a[28:31]
ds_read_b128 a[200:203],v11 offset:12416
v_cvt_pk_bf16_f32 v76,v76,v77
v_mfma_f32_16x16x32_bf16 v[236:239],v[124:127],v[44:47],v[236:239]
ds_read_b128 a[204:207],v12 offset:12416
v_cvt_pk_bf16_f32 v80,v80,v81
ds_read_b128 a[208:211],v11 offset:12544
v_cvt_pk_bf16_f32 v77,v78,v79
ds_read_b128 a[212:215],v12 offset:12544
v_cvt_pk_bf16_f32 v81,v82,v83
ds_write2st64_b64 v39,v[96:97],v[100:101] offset0:36 offset1:40
v_accvgpr_read_b32 v92,a72
v_accvgpr_read_b32 v93,a73
v_pk_mul_f32 v[92:93],v[92:93],v[66:67] op_sel_hi:[1,0]
ds_read_b128 v[156:159],v10 offset:18432
v_accvgpr_read_b32 v94,a74
ds_read_b128 v[104:107],v10 offset:19456
v_accvgpr_read_b32 v95,a75
ds_read_b128 v[108:111],v10 offset:20480
v_pk_mul_f32 v[94:95],v[94:95],v[66:67] op_sel_hi:[1,0]
ds_read_b128 v[72:75],v10 offset:21504
v_accvgpr_read_b32 v98,a122
ds_write2st64_b64 v36,v[76:77],v[80:81] offset0:36 offset1:40
v_accvgpr_read_b32 v99,a123
v_pk_mul_f32 v[98:99],v[98:99],v[70:71] op_sel_hi:[1,0]
v_accvgpr_read_b32 v102,a78
v_accvgpr_read_b32 v103,a79
v_pk_mul_f32 v[102:103],v[102:103],v[66:67] op_sel_hi:[1,0]
v_accvgpr_read_b32 v78,a126
v_accvgpr_read_b32 v79,a127
v_pk_mul_f32 v[78:79],v[78:79],v[70:71] op_sel_hi:[1,0]
v_accvgpr_read_b32 v96,a120
v_accvgpr_read_b32 v97,a121
v_pk_mul_f32 v[96:97],v[96:97],v[70:71] op_sel_hi:[1,0]
v_accvgpr_read_b32 v100,a76
s_waitcnt lgkmcnt(4)
buffer_store_dwordx4 v[156:159],v9,s[16:19],s87 offen offset:0 nt
v_accvgpr_read_b32 v101,a77
v_pk_mul_f32 v[100:101],v[100:101],v[66:67] op_sel_hi:[1,0]
v_accvgpr_read_b32 v76,a124
v_accvgpr_read_b32 v77,a125
v_pk_mul_f32 v[76:77],v[76:77],v[70:71] op_sel_hi:[1,0]
v_cvt_pk_bf16_f32 v84,v84,v85
v_cvt_pk_bf16_f32 v88,v88,v89
v_mfma_f32_16x16x32_bf16 v[232:235],v[120:123],v[44:47],v[232:235]
v_cvt_pk_bf16_f32 v92,v92,v93
v_cvt_pk_bf16_f32 v96,v96,v97
v_mfma_f32_16x16x32_bf16 v[184:187],v[120:123],v[40:43],v[184:187]
s_waitcnt lgkmcnt(1)
buffer_store_dwordx4 v[104:107],v9,s[16:19],s87 offen offset:3072 nt
s_waitcnt vmcnt(8)
s_barrier
v_mfma_f32_16x16x32_bf16 v[188:191],v[124:127],v[40:43],v[188:191]
ds_read_b128 v[112:115],v0 offset:0
v_cvt_pk_bf16_f32 v85,v86,v87
v_mfma_f32_16x16x32_bf16 v[192:195],v[128:131],v[40:43],v[192:195]
ds_read_b128 v[116:119],v1 offset:0
v_cvt_pk_bf16_f32 v89,v90,v91
v_mfma_f32_16x16x32_bf16 v[196:199],v[132:135],v[40:43],v[196:199]
ds_write2st64_b64 v37,v[84:85],v[88:89] offset0:36 offset1:40
v_mfma_f32_16x16x32_bf16 v[244:247],v[132:135],v[44:47],v[244:247]
v_cvt_pk_bf16_f32 v100,v100,v101
v_cvt_pk_bf16_f32 v76,v76,v77
v_mfma_f32_16x16x32_bf16 v[240:243],v[128:131],v[44:47],v[240:243]
buffer_load_dwordx4 v6,s[8:11],s25 offen offset:0 lds
v_mfma_f32_16x16x32_bf16 a[32:35],v[128:131],v[48:51],a[32:35]
buffer_store_dwordx4 v[108:111],v9,s[16:19],s66 offen offset:0 nt
ds_read_b128 v[120:123],v0 offset:128
v_cvt_pk_bf16_f32 v93,v94,v95
ds_read_b128 v[124:127],v1 offset:128
v_mfma_f32_16x16x32_bf16 a[36:39],v[132:135],v[48:51],a[36:39]
v_cvt_pk_bf16_f32 v97,v98,v99
v_cvt_pk_bf16_f32 v101,v102,v103
v_mfma_f32_16x16x32_bf16 a[84:87],v[132:135],v[52:55],a[84:87]
ds_write2st64_b64 v38,v[92:93],v[96:97] offset0:36 offset1:40
v_mfma_f32_16x16x32_bf16 a[80:83],v[128:131],v[52:55],a[80:83]
v_cvt_pk_bf16_f32 v77,v78,v79
v_rcp_f32 v64,v64
v_mfma_f32_16x16x32_bf16 a[128:131],v[128:131],v[56:59],a[128:131]
buffer_store_dwordx4 v[72:75],v9,s[16:19],s66 offen offset:3072 nt
buffer_load_dwordx4 v7,s[8:11],s25 offen offset:1024 lds
v_mfma_f32_16x16x32_bf16 a[132:135],v[132:135],v[56:59],a[132:135]
ds_read_b128 v[128:131],v0 offset:256
v_accvgpr_read_b32 v108,a84
v_mfma_f32_16x16x32_bf16 a[136:139],v[136:139],v[56:59],a[136:139]
ds_read_b128 v[132:135],v1 offset:256
v_accvgpr_read_b32 v88,a80
v_mfma_f32_16x16x32_bf16 a[140:143],v[140:143],v[56:59],a[140:143]
ds_write2st64_b64 v39,v[100:101],v[76:77] offset0:36 offset1:40
v_accvgpr_read_b32 v89,a81
v_pk_mul_f32 v[88:89],v[88:89],v[66:67] op_sel_hi:[1,0]
v_accvgpr_read_b32 v90,a82
ds_read_b128 v[80:83],v10 offset:18432
v_accvgpr_read_b32 v91,a83
ds_read_b128 v[156:159],v10 offset:19456
v_pk_mul_f32 v[90:91],v[90:91],v[66:67] op_sel_hi:[1,0]
ds_read_b128 v[72:75],v10 offset:20480
buffer_load_dwordx4 v8,s[8:11],s25 offen offset:2048 lds
ds_read_b128 v[84:87],v10 offset:21504
v_accvgpr_read_b32 v104,a128
v_accvgpr_read_b32 v105,a129
v_pk_mul_f32 v[104:105],v[104:105],v[70:71] op_sel_hi:[1,0]
v_accvgpr_read_b32 v106,a130
v_accvgpr_read_b32 v107,a131
v_pk_mul_f32 v[106:107],v[106:107],v[70:71] op_sel_hi:[1,0]
v_accvgpr_read_b32 v109,a85
v_accvgpr_read_b32 v110,a86
v_mfma_f32_16x16x32_bf16 a[92:95],v[140:143],v[52:55],a[92:95]
s_add_u32 m0,s23,24576
v_accvgpr_read_b32 v111,a87
v_accvgpr_read_b32 v92,a132
v_accvgpr_read_b32 v93,a133
v_accvgpr_read_b32 v94,a134
v_accvgpr_read_b32 v95,a135
v_pk_mul_f32 v[108:109],v[108:109],v[66:67] op_sel_hi:[1,0]
v_pk_mul_f32 v[110:111],v[110:111],v[66:67] op_sel_hi:[1,0]
v_pk_mul_f32 v[92:93],v[92:93],v[70:71] op_sel_hi:[1,0]
v_pk_mul_f32 v[94:95],v[94:95],v[70:71] op_sel_hi:[1,0]
v_cvt_pk_bf16_f32 v88,v88,v89
v_cvt_pk_bf16_f32 v104,v104,v105
v_mfma_f32_16x16x32_bf16 a[88:91],v[136:139],v[52:55],a[88:91]
s_waitcnt lgkmcnt(3)
buffer_store_dwordx4 v[80:83],v9,s[16:19],s87 offen offset:128 nt
v_cvt_pk_bf16_f32 v89,v90,v91
v_cvt_pk_bf16_f32 v105,v106,v107
v_accvgpr_read_b32 v76,a136
v_mfma_f32_16x16x32_bf16 a[40:43],v[136:139],v[48:51],a[40:43]
s_waitcnt vmcnt(17)
ds_read_b128 a[216:219],v11 offset:0
v_accvgpr_read_b32 v77,a137
v_mfma_f32_16x16x32_bf16 a[44:47],v[140:143],v[48:51],a[44:47]
ds_read_b128 a[220:223],v12 offset:0
v_accvgpr_read_b32 v96,a88
v_mfma_f32_16x16x32_bf16 v[252:255],v[140:143],v[44:47],v[252:255]
buffer_load_dwordx4 v6,s[8:11],s21 offen offset:0 lds
ds_read_b128 a[224:227],v11 offset:128
s_waitcnt lgkmcnt(3)
buffer_store_dwordx4 v[156:159],v9,s[16:19],s87 offen offset:3200 nt
ds_read_b128 a[228:231],v12 offset:128
v_pk_mul_f32 v[76:77],v[76:77],v[70:71] op_sel_hi:[1,0]
ds_read_b128 a[232:235],v11 offset:256
v_accvgpr_read_b32 v97,a89
ds_read_b128 a[236:239],v12 offset:256
v_pk_mul_f32 v[96:97],v[96:97],v[66:67] op_sel_hi:[1,0]
ds_write2st64_b64 v36,v[88:89],v[104:105] offset0:36 offset1:40
v_add_u32 v36,v36,v19
v_accvgpr_read_b32 v78,a138
v_accvgpr_read_b32 v79,a139
buffer_store_dwordx4 v[72:75],v9,s[16:19],s66 offen offset:128 nt
v_pk_mul_f32 v[78:79],v[78:79],v[70:71] op_sel_hi:[1,0]
v_accvgpr_read_b32 v100,a92
v_accvgpr_read_b32 v101,a93
v_pk_mul_f32 v[100:101],v[100:101],v[66:67] op_sel_hi:[1,0]
v_cvt_pk_bf16_f32 v108,v108,v109
v_cvt_pk_bf16_f32 v92,v92,v93
v_accvgpr_read_b32 v98,a90
v_accvgpr_read_b32 v99,a91
v_pk_mul_f32 v[98:99],v[98:99],v[66:67] op_sel_hi:[1,0]
buffer_load_dwordx4 v7,s[8:11],s21 offen offset:1024 lds
buffer_store_dwordx4 v[84:87],v9,s[16:19],s66 offen offset:3200 nt
v_accvgpr_read_b32 v88,a140
v_accvgpr_read_b32 v89,a141
v_pk_mul_f32 v[88:89],v[88:89],v[70:71] op_sel_hi:[1,0]
v_accvgpr_read_b32 v102,a94
v_accvgpr_read_b32 v103,a95
v_pk_mul_f32 v[102:103],v[102:103],v[66:67] op_sel_hi:[1,0]
v_accvgpr_read_b32 v90,a142
v_accvgpr_read_b32 v91,a143
v_pk_mul_f32 v[90:91],v[90:91],v[70:71] op_sel_hi:[1,0]
v_cvt_pk_bf16_f32 v76,v76,v77
v_cvt_pk_bf16_f32 v96,v96,v97
v_cvt_pk_bf16_f32 v109,v110,v111
v_cvt_pk_bf16_f32 v93,v94,v95
ds_write2st64_b64 v37,v[108:109],v[92:93] offset0:36 offset1:40
v_add_u32 v37,v37,v19
v_cvt_pk_bf16_f32 v100,v100,v101
v_cvt_pk_bf16_f32 v88,v88,v89
v_cvt_pk_bf16_f32 v77,v78,v79
v_cvt_pk_bf16_f32 v97,v98,v99
v_cvt_pk_bf16_f32 v101,v102,v103
v_cvt_pk_bf16_f32 v89,v90,v91
v_accvgpr_read_b32 v72,a0
v_accvgpr_read_b32 v73,a1
v_pk_mul_f32 v[72:73],v[72:73],v[64:65] op_sel_hi:[1,0]
v_accvgpr_read_b32 v74,a2
ds_write2st64_b64 v38,v[96:97],v[76:77] offset0:36 offset1:40
v_add_u32 v38,v38,v19
v_accvgpr_read_b32 v75,a3
v_pk_mul_f32 v[74:75],v[74:75],v[64:65] op_sel_hi:[1,0]
v_accvgpr_read_b32 v110,a6
buffer_load_dwordx4 v8,s[8:11],s21 offen offset:2048 lds
v_accvgpr_read_b32 v111,a7
v_pk_mul_f32 v[110:111],v[110:111],v[64:65] op_sel_hi:[1,0]
ds_write2st64_b64 v39,v[100:101],v[88:89] offset0:36 offset1:40
v_add_u32 v39,v39,v19
v_accvgpr_read_b32 v94,a18
v_accvgpr_read_b32 v95,a19
ds_read_b128 v[104:107],v10 offset:18432
v_pk_mul_f32 v[94:95],v[94:95],v[64:65] op_sel_hi:[1,0]
ds_read_b128 v[156:159],v10 offset:19456
v_accvgpr_read_b32 v92,a16
ds_read_b128 v[80:83],v10 offset:20480
v_accvgpr_read_b32 v93,a17
ds_read_b128 v[84:87],v10 offset:21504
v_pk_mul_f32 v[92:93],v[92:93],v[64:65] op_sel_hi:[1,0]
v_accvgpr_read_b32 v108,a4
v_accvgpr_read_b32 v109,a5
v_pk_mul_f32 v[108:109],v[108:109],v[64:65] op_sel_hi:[1,0]
v_accvgpr_read_b32 v78,a22
v_accvgpr_read_b32 v79,a23
v_pk_mul_f32 v[78:79],v[78:79],v[64:65] op_sel_hi:[1,0]
v_accvgpr_read_b32 v76,a20
v_accvgpr_read_b32 v77,a21
v_pk_mul_f32 v[76:77],v[76:77],v[64:65] op_sel_hi:[1,0]
v_accvgpr_read_b32 v98,a10
v_accvgpr_read_b32 v99,a11
v_mfma_f32_16x16x32_bf16 v[248:251],v[136:139],v[44:47],v[248:251]
s_waitcnt vmcnt(14)
ds_read_b128 a[240:243],v11 offset:6144
v_accvgpr_read_b32 v90,a26
v_mfma_f32_16x16x32_bf16 v[200:203],v[136:139],v[40:43],v[200:203]
s_add_u32 s21,s21,12288
ds_read_b128 a[244:247],v12 offset:6144
v_accvgpr_read_b32 v91,a27
ds_read_b128 a[248:251],v11 offset:6272
s_waitcnt lgkmcnt(6)
buffer_store_dwordx4 v[104:107],v9,s[16:19],s87 offen offset:256 nt
ds_read_b128 a[252:255],v12 offset:6272
v_pk_mul_f32 v[98:99],v[98:99],v[64:65] op_sel_hi:[1,0]
ds_read_b128 v[144:147],v11 offset:6400
v_pk_mul_f32 v[90:91],v[90:91],v[64:65] op_sel_hi:[1,0]
ds_read_b128 v[148:151],v12 offset:6400
v_accvgpr_read_b32 v96,a8
s_waitcnt lgkmcnt(6)
buffer_store_dwordx4 v[156:159],v9,s[16:19],s87 offen offset:3328 nt
ds_read_b128 v[136:139],v0 offset:6144
v_accvgpr_read_b32 v97,a9
v_pk_mul_f32 v[96:97],v[96:97],v[64:65] op_sel_hi:[1,0]
v_accvgpr_read_b32 v88,a24
v_accvgpr_read_b32 v89,a25
v_pk_mul_f32 v[88:89],v[88:89],v[64:65] op_sel_hi:[1,0]
v_cvt_pk_bf16_f32 v72,v72,v73
v_cvt_pk_bf16_f32 v92,v92,v93
v_mfma_f32_16x16x32_bf16 v[204:207],v[140:143],v[40:43],v[204:207]
s_mov_b32 s27,s42
ds_read_b128 v[140:143],v1 offset:6144
buffer_store_dwordx4 v[80:83],v9,s[16:19],s66 offen offset:256 nt
v_cvt_pk_bf16_f32 v73,v74,v75
v_cvt_pk_bf16_f32 v93,v94,v95
v_accvgpr_read_b32 v102,a14
v_accvgpr_read_b32 v103,a15
v_accvgpr_read_b32 v100,a12
v_accvgpr_read_b32 v101,a13
v_accvgpr_read_b32 v94,a30
v_accvgpr_read_b32 v95,a31
v_cvt_pk_bf16_f32 v108,v108,v109
ds_write2st64_b64 v36,v[72:73],v[92:93] offset0:24 offset1:26
v_mfma_f32_16x16x32_bf16 v[72:75],v[112:115],a[144:147],0
s_mov_b32 s42,s41
v_accvgpr_read_b32 v92,a28
v_accvgpr_read_b32 v93,a29
v_mfma_f32_16x16x32_bf16 v[72:75],v[116:119],a[148:151],v[72:75]
s_add_u32 s69,s69,1
buffer_store_dwordx4 v[84:87],v9,s[16:19],s66 offen offset:3328 nt
v_cvt_pk_bf16_f32 v76,v76,v77
v_rcp_f32 v60,v60
v_pk_mul_f32 v[100:101],v[100:101],v[64:65] op_sel_hi:[1,0]
v_pk_mul_f32 v[102:103],v[102:103],v[64:65] op_sel_hi:[1,0]
v_pk_mul_f32 v[92:93],v[92:93],v[64:65] op_sel_hi:[1,0]
v_pk_mul_f32 v[94:95],v[94:95],v[64:65] op_sel_hi:[1,0]
v_cvt_pk_bf16_f32 v109,v110,v111
v_cvt_pk_bf16_f32 v77,v78,v79
v_mfma_f32_16x16x32_bf16 v[72:75],v[120:123],a[152:155],v[72:75]
s_lshl_b32 s62,s69,5
ds_write2st64_b64 v37,v[108:109],v[76:77] offset0:24 offset1:26
v_mfma_f32_16x16x32_bf16 v[72:75],v[124:127],a[156:159],v[72:75]
s_add_u32 s62,s62,s34
v_accvgpr_read_b32 v78,a34
v_accvgpr_read_b32 v79,a35
v_mfma_f32_16x16x32_bf16 v[72:75],v[128:131],a[160:163],v[72:75]
s_mul_i32 s63,s62,171
v_accvgpr_read_b32 v76,a32
v_accvgpr_read_b32 v77,a33
v_mfma_f32_16x16x32_bf16 v[72:75],v[132:135],a[164:167],v[72:75]
s_lshr_b32 s63,s63,9
v_accvgpr_read_b32 v84,a36
v_accvgpr_read_b32 v85,a37
v_accvgpr_read_b32 v86,a38
v_accvgpr_read_b32 v87,a39
v_cvt_pk_bf16_f32 v96,v96,v97
v_pk_mul_f32 v[76:77],v[76:77],v[64:65] op_sel_hi:[1,0]
v_pk_mul_f32 v[78:79],v[78:79],v[64:65] op_sel_hi:[1,0]
v_pk_mul_f32 v[160:161],v[160:161],v[60:61] op_sel_hi:[1,0]
v_pk_mul_f32 v[162:163],v[162:163],v[60:61] op_sel_hi:[1,0]
v_cvt_pk_bf16_f32 v88,v88,v89
v_cvt_pk_bf16_f32 v97,v98,v99
v_mfma_f32_16x16x32_bf16 v[80:83],v[132:135],a[188:191],0
s_mul_i32 s64,s63,3
v_cvt_pk_bf16_f32 v89,v90,v91
v_accvgpr_read_b32 v104,a40
v_mfma_f32_16x16x32_bf16 v[80:83],v[128:131],a[184:187],v[80:83]
s_sub_u32 s62,s62,s64
ds_write2st64_b64 v38,v[96:97],v[88:89] offset0:24 offset1:26
v_mfma_f32_16x16x32_bf16 v[80:83],v[124:127],a[180:183],v[80:83]
s_add_u32 s63,s63,s33
v_accvgpr_read_b32 v105,a41
v_accvgpr_read_b32 v106,a42
v_accvgpr_read_b32 v107,a43
v_accvgpr_read_b32 v110,a46
v_accvgpr_read_b32 v111,a47
v_pk_mul_f32 v[84:85],v[84:85],v[64:65] op_sel_hi:[1,0]
v_pk_mul_f32 v[86:87],v[86:87],v[64:65] op_sel_hi:[1,0]
v_pk_mul_f32 v[164:165],v[164:165],v[60:61] op_sel_hi:[1,0]
v_pk_mul_f32 v[166:167],v[166:167],v[60:61] op_sel_hi:[1,0]
v_accvgpr_read_b32 v108,a44
v_accvgpr_read_b32 v109,a45
v_mfma_f32_16x16x32_bf16 v[80:83],v[120:123],a[176:179],v[80:83]
s_mul_i32 s30,s63,196608
v_cvt_pk_bf16_f32 v100,v100,v101
v_cvt_pk_bf16_f32 v92,v92,v93
v_mfma_f32_16x16x32_bf16 v[80:83],v[116:119],a[172:175],v[80:83]
s_mul_i32 s41,s63,325632
v_cvt_pk_bf16_f32 v76,v76,v77
v_cvt_pk_bf16_f32 v160,v160,v161
v_mfma_f32_16x16x32_bf16 v[80:83],v[112:115],a[168:171],v[80:83]
s_lshl_b32 s63,s3,2
v_cvt_pk_bf16_f32 v101,v102,v103
v_cvt_pk_bf16_f32 v93,v94,v95
v_mfma_f32_16x16x32_bf16 v[88:91],v[112:115],a[192:195],0
s_add_u32 s64,s63,21
ds_write2st64_b64 v39,v[100:101],v[92:93] offset0:24 offset1:26
v_pk_mul_f32 v[104:105],v[104:105],v[64:65] op_sel_hi:[1,0]
v_pk_mul_f32 v[106:107],v[106:107],v[64:65] op_sel_hi:[1,0]
v_pk_mul_f32 v[168:169],v[168:169],v[60:61] op_sel_hi:[1,0]
ds_read_b128 v[112:115],v0 offset:6272
v_pk_mul_f32 v[170:171],v[170:171],v[60:61] op_sel_hi:[1,0]
v_cvt_pk_bf16_f32 v77,v78,v79
v_cvt_pk_bf16_f32 v161,v162,v163
v_mfma_f32_16x16x32_bf16 v[88:91],v[116:119],a[196:199],v[88:91]
s_cmp_eq_u32 s3,0
ds_read_b128 v[116:119],v1 offset:6272
v_cvt_pk_bf16_f32 v84,v84,v85
v_mfma_f32_16x16x32_bf16 v[88:91],v[120:123],a[200:203],v[88:91]
s_cselect_b32 s64,20,s64
ds_write2st64_b64 v36,v[76:77],v[160:161] offset0:28 offset1:0
v_mfma_f32_16x16x32_bf16 v[88:91],v[124:127],a[204:207],v[88:91]
s_cselect_b32 s40,1,0
v_cvt_pk_bf16_f32 v164,v164,v165
v_cvt_pk_bf16_f32 v85,v86,v87
v_mfma_f32_16x16x32_bf16 v[88:91],v[128:131],a[208:211],v[88:91]
s_add_u32 s65,s63,37
ds_read_b128 v[120:123],v0 offset:6400
v_cvt_pk_bf16_f32 v165,v166,v167
ds_read_b128 v[124:127],v1 offset:6400
v_pk_mul_f32 v[108:109],v[108:109],v[64:65] op_sel_hi:[1,0]
ds_write2st64_b64 v37,v[84:85],v[164:165] offset0:28 offset1:0
v_pk_mul_f32 v[110:111],v[110:111],v[64:65] op_sel_hi:[1,0]
v_pk_mul_f32 v[172:173],v[172:173],v[60:61] op_sel_hi:[1,0]
v_pk_mul_f32 v[174:175],v[174:175],v[60:61] op_sel_hi:[1,0]
v_rcp_f32 v62,v62
v_cvt_pk_bf16_f32 v104,v104,v105
v_mfma_f32_16x16x32_bf16 v[88:91],v[132:135],a[212:215],v[88:91]
s_cmp_eq_u32 s62,2
ds_read_b128 v[132:135],v1 offset:0
v_cvt_pk_bf16_f32 v168,v168,v169
ds_read_b128 v[128:131],v0 offset:0
s_waitcnt lgkmcnt(5)
v_mfma_f32_16x16x32_bf16 v[76:79],v[136:139],a[144:147],0
s_cselect_b32 s64,s65,s64
v_cvt_pk_bf16_f32 v105,v106,v107
v_cvt_pk_bf16_f32 v169,v170,v171
v_mfma_f32_16x16x32_bf16 v[76:79],v[140:143],a[148:151],v[76:79]
s_cselect_b32 s40,0,s40
ds_write2st64_b64 v38,v[104:105],v[168:169] offset0:28 offset1:0
v_pk_mul_f32 v[176:177],v[176:177],v[60:61] op_sel_hi:[1,0]
v_pk_mul_f32 v[178:179],v[178:179],v[60:61] op_sel_hi:[1,0]
v_pk_mul_f32 v[192:193],v[192:193],v[60:61] op_sel_hi:[1,0]
v_pk_mul_f32 v[194:195],v[194:195],v[60:61] op_sel_hi:[1,0]
v_cvt_pk_bf16_f32 v108,v108,v109
v_cvt_pk_bf16_f32 v172,v172,v173
v_mfma_f32_16x16x32_bf16 v[76:79],v[112:115],a[152:155],v[76:79]
s_add_u32 s65,s63,s3
v_cvt_pk_bf16_f32 v109,v110,v111
v_cvt_pk_bf16_f32 v173,v174,v175
v_mfma_f32_16x16x32_bf16 v[76:79],v[116:119],a[156:159],v[76:79]
s_cmp_eq_u32 s62,0
v_max3_f32 v40,v72,v73,v74
v_max3_f32 v44,v80,v81,v82
s_waitcnt lgkmcnt(3)
v_mfma_f32_16x16x32_bf16 v[76:79],v[120:123],a[160:163],v[76:79]
s_cselect_b32 s64,s65,s64
ds_write2st64_b64 v39,v[108:109],v[172:173] offset0:28 offset1:0
v_mfma_f32_16x16x32_bf16 v[76:79],v[124:127],a[164:167],v[76:79]
s_cselect_b32 s40,1,s40
v_max3_f32 v48,v88,v89,v90
v_cvt_pk_bf16_f32 v176,v176,v177
v_cvt_pk_bf16_f32 v192,v192,v193
v_cvt_pk_bf16_f32 v177,v178,v179
v_cvt_pk_bf16_f32 v193,v194,v195
v_pk_mul_f32 v[180:181],v[180:181],v[60:61] op_sel_hi:[1,0]
v_pk_mul_f32 v[182:183],v[182:183],v[60:61] op_sel_hi:[1,0]
v_pk_mul_f32 v[196:197],v[196:197],v[60:61] op_sel_hi:[1,0]
v_pk_mul_f32 v[198:199],v[198:199],v[60:61] op_sel_hi:[1,0]
v_max3_f32 v40,v40,v75,v76
v_max3_f32 v40,v40,v77,v78
v_mfma_f32_16x16x32_bf16 v[84:87],v[124:127],a[188:191],0
s_mul_i32 s64,s64,6144
ds_write2st64_b64 v36,v[176:177],v[192:193] offset0:2 offset1:4
v_mfma_f32_16x16x32_bf16 v[84:87],v[120:123],a[184:187],v[84:87]
s_add_u32 s41,s41,s64
v_max_f32 v40,v40,v79
v_mov_b32 v41,v40
v_mfma_f32_16x16x32_bf16 v[84:87],v[116:119],a[180:183],v[84:87]
s_cmp_ge_u32 s69,6
v_permlane32_swap_b32 v41,v40
v_max_f32 v40,v40,v41
v_mov_b32 v41,v40
v_cvt_pk_bf16_f32 v180,v180,v181
v_pk_mul_f32 v[184:185],v[184:185],v[60:61] op_sel_hi:[1,0]
v_pk_mul_f32 v[186:187],v[186:187],v[60:61] op_sel_hi:[1,0]
v_pk_mul_f32 v[200:201],v[200:201],v[60:61] op_sel_hi:[1,0]
v_pk_mul_f32 v[202:203],v[202:203],v[60:61] op_sel_hi:[1,0]
v_permlane16_swap_b32 v41,v40
v_max_f32 v40,v40,v41
v_mfma_f32_16x16x32_bf16 v[84:87],v[112:115],a[176:179],v[84:87]
s_cselect_b32 s41,166723584,s41
v_mul_f32_e64 v13,-s36,v40
v_fma_f32 v72,v72,s36,v13
v_mfma_f32_16x16x32_bf16 v[84:87],v[140:143],a[172:175],v[84:87]
s_cselect_b32 s30,100663296,s30
v_fma_f32 v73,v73,s36,v13
v_fma_f32 v74,v74,s36,v13
v_mfma_f32_16x16x32_bf16 v[84:87],v[136:139],a[168:171],v[84:87]
s_add_u32 s25,s30,s22
v_fma_f32 v75,v75,s36,v13
v_exp_f32 v72,v72
v_mfma_f32_16x16x32_bf16 v[92:95],v[136:139],a[192:195],0
s_add_u32 s26,s25,12288
ds_read_b128 v[136:139],v0 offset:128
v_exp_f32 v73,v73
v_exp_f32 v74,v74
v_pk_mul_f32 v[188:189],v[188:189],v[60:61] op_sel_hi:[1,0]
v_pk_mul_f32 v[190:191],v[190:191],v[60:61] op_sel_hi:[1,0]
v_pk_mul_f32 v[204:205],v[204:205],v[60:61] op_sel_hi:[1,0]
v_pk_mul_f32 v[206:207],v[206:207],v[60:61] op_sel_hi:[1,0]
v_exp_f32 v75,v75
v_cvt_pk_bf16_f32 v20,v72,v73
v_mfma_f32_16x16x32_bf16 v[92:95],v[140:143],a[196:199],v[92:95]
s_add_u32 m0,s22,0
ds_read_b128 v[140:143],v1 offset:128
v_cvt_pk_bf16_f32 v21,v74,v75
v_mfma_f32_16x16x32_bf16 v[92:95],v[112:115],a[200:203],v[92:95]
s_mov_b32 s28,s41
ds_read_b128 v[112:115],v0 offset:256
v_max3_f32 v44,v44,v83,v84
v_mfma_f32_16x16x32_bf16 v[92:95],v[116:119],a[204:207],v[92:95]
s_mov_b32 s29,s24
ds_read_b128 v[116:119],v1 offset:256
v_max3_f32 v44,v44,v85,v86
v_mfma_f32_16x16x32_bf16 v[92:95],v[120:123],a[208:211],v[92:95]
ds_read_b128 v[120:123],v0 offset:6144
v_max_f32 v44,v44,v87
v_mov_b32 v45,v44
v_cvt_pk_bf16_f32 v196,v196,v197
v_cvt_pk_bf16_f32 v181,v182,v183
v_pk_mul_f32 v[208:209],v[208:209],v[62:63] op_sel_hi:[1,0]
v_pk_mul_f32 v[210:211],v[210:211],v[62:63] op_sel_hi:[1,0]
v_pk_mul_f32 v[224:225],v[224:225],v[62:63] op_sel_hi:[1,0]
v_pk_mul_f32 v[226:227],v[226:227],v[62:63] op_sel_hi:[1,0]
v_permlane32_swap_b32 v45,v44
v_max_f32 v44,v44,v45
v_mfma_f32_16x16x32_bf16 v[92:95],v[124:127],a[212:215],v[92:95]
ds_read_b128 v[124:127],v1 offset:6144
v_mov_b32 v45,v44
v_cvt_pk_bf16_f32 v184,v184,v185
v_cvt_pk_bf16_f32 v200,v200,v201
v_permlane16_swap_b32 v45,v44
v_max_f32 v44,v44,v45
v_mul_f32_e64 v14,-s36,v44
v_fma_f32 v80,v80,s36,v14
v_fma_f32 v81,v81,s36,v14
v_fma_f32 v82,v82,s36,v14
v_fma_f32 v83,v83,s36,v14
v_exp_f32 v80,v80
v_exp_f32 v81,v81
v_exp_f32 v82,v82
s_waitcnt lgkmcnt(2)
v_mfma_f32_16x16x32_bf16 v[96:99],v[116:119],a[236:239],0
v_exp_f32 v83,v83
v_mfma_f32_16x16x32_bf16 v[96:99],v[112:115],a[232:235],v[96:99]
v_cvt_pk_bf16_f32 v24,v80,v81
v_cvt_pk_bf16_f32 v25,v82,v83
v_max3_f32 v48,v48,v91,v92
v_max3_f32 v48,v48,v93,v94
v_max_f32 v48,v48,v95
v_pk_mul_f32 v[212:213],v[212:213],v[62:63] op_sel_hi:[1,0]
v_pk_mul_f32 v[214:215],v[214:215],v[62:63] op_sel_hi:[1,0]
v_pk_mul_f32 v[228:229],v[228:229],v[62:63] op_sel_hi:[1,0]
v_pk_mul_f32 v[230:231],v[230:231],v[62:63] op_sel_hi:[1,0]
v_mov_b32 v49,v48
v_cvt_pk_bf16_f32 v197,v198,v199
v_mfma_f32_16x16x32_bf16 v[96:99],v[140:143],a[228:231],v[96:99]
ds_write2st64_b64 v37,v[180:181],v[196:197] offset0:2 offset1:4
v_mfma_f32_16x16x32_bf16 v[96:99],v[136:139],a[224:227],v[96:99]
v_permlane32_swap_b32 v49,v48
v_mfma_f32_16x16x32_bf16 v[96:99],v[132:135],a[220:223],v[96:99]
v_max_f32 v48,v48,v49
v_mov_b32 v49,v48
v_mfma_f32_16x16x32_bf16 v[96:99],v[128:131],a[216:219],v[96:99]
v_cvt_pk_bf16_f32 v188,v188,v189
v_permlane16_swap_b32 v49,v48
v_max_f32 v48,v48,v49
v_mul_f32_e64 v15,-s36,v48
v_pk_mul_f32 v[216:217],v[216:217],v[62:63] op_sel_hi:[1,0]
v_pk_mul_f32 v[218:219],v[218:219],v[62:63] op_sel_hi:[1,0]
v_pk_mul_f32 v[232:233],v[232:233],v[62:63] op_sel_hi:[1,0]
v_pk_mul_f32 v[234:235],v[234:235],v[62:63] op_sel_hi:[1,0]
v_fma_f32 v88,v88,s36,v15
v_fma_f32 v89,v89,s36,v15
v_mfma_f32_16x16x32_bf16 v[104:107],v[128:131],a[240:243],0
ds_read_b128 v[128:131],v0 offset:6272
v_fma_f32 v90,v90,s36,v15
v_mfma_f32_16x16x32_bf16 v[104:107],v[132:135],a[244:247],v[104:107]
ds_read_b128 v[132:135],v1 offset:6272
v_fma_f32 v91,v91,s36,v15
v_mfma_f32_16x16x32_bf16 v[104:107],v[136:139],a[248:251],v[104:107]
ds_read_b128 v[136:139],v0 offset:6400
v_exp_f32 v88,v88
v_mfma_f32_16x16x32_bf16 v[104:107],v[140:143],a[252:255],v[104:107]
ds_read_b128 v[140:143],v1 offset:6400
v_exp_f32 v89,v89
v_exp_f32 v90,v90
v_pk_mul_f32 v[220:221],v[220:221],v[62:63] op_sel_hi:[1,0]
v_pk_mul_f32 v[222:223],v[222:223],v[62:63] op_sel_hi:[1,0]
v_pk_mul_f32 v[236:237],v[236:237],v[62:63] op_sel_hi:[1,0]
v_pk_mul_f32 v[238:239],v[238:239],v[62:63] op_sel_hi:[1,0]
v_exp_f32 v91,v91
v_cvt_pk_bf16_f32 v28,v88,v89
v_mfma_f32_16x16x32_bf16 v[104:107],v[112:115],v[144:147],v[104:107]
ds_read_b128 v[112:115],v0 offset:12544
v_cvt_pk_bf16_f32 v29,v90,v91
v_mfma_f32_16x16x32_bf16 v[104:107],v[116:119],v[148:151],v[104:107]
s_waitcnt lgkmcnt(5)
ds_read_b128 v[116:119],v1 offset:12544
v_max3_f32 v52,v96,v97,v98
v_mfma_f32_16x16x32_bf16 v[100:103],v[120:123],a[216:219],0
v_cvt_pk_bf16_f32 v204,v204,v205
v_cvt_pk_bf16_f32 v185,v186,v187
v_cvt_pk_bf16_f32 v201,v202,v203
ds_write2st64_b64 v38,v[184:185],v[200:201] offset0:2 offset1:4
v_pk_mul_f32 v[240:241],v[240:241],v[62:63] op_sel_hi:[1,0]
v_pk_mul_f32 v[242:243],v[242:243],v[62:63] op_sel_hi:[1,0]
v_max3_f32 v56,v104,v105,v106
v_cvt_pk_bf16_f32 v208,v208,v209
v_mfma_f32_16x16x32_bf16 v[100:103],v[124:127],a[220:223],v[100:103]
s_waitcnt lgkmcnt(3)
v_cvt_pk_bf16_f32 v224,v224,v225
v_cvt_pk_bf16_f32 v189,v190,v191
v_mfma_f32_16x16x32_bf16 v[100:103],v[128:131],a[224:227],v[100:103]
v_cvt_pk_bf16_f32 v205,v206,v207
v_cvt_pk_bf16_f32 v212,v212,v213
v_mfma_f32_16x16x32_bf16 v[100:103],v[132:135],a[228:231],v[100:103]
ds_write2st64_b64 v39,v[188:189],v[204:205] offset0:2 offset1:4
v_mfma_f32_16x16x32_bf16 v[100:103],v[136:139],a[232:235],v[100:103]
v_cvt_pk_bf16_f32 v228,v228,v229
v_cvt_pk_bf16_f32 v209,v210,v211
v_cvt_pk_bf16_f32 v225,v226,v227
v_cvt_pk_bf16_f32 v216,v216,v217
v_cvt_pk_bf16_f32 v232,v232,v233
v_pk_mul_f32 v[244:245],v[244:245],v[62:63] op_sel_hi:[1,0]
v_pk_mul_f32 v[246:247],v[246:247],v[62:63] op_sel_hi:[1,0]
v_cvt_pk_bf16_f32 v213,v214,v215
v_cvt_pk_bf16_f32 v229,v230,v231
v_mfma_f32_16x16x32_bf16 v[100:103],v[140:143],a[236:239],v[100:103]
ds_write2st64_b64 v36,v[208:209],v[224:225] offset0:12 offset1:14
v_mfma_f32_16x16x32_bf16 v[108:111],v[140:143],v[148:151],0
v_cvt_pk_bf16_f32 v220,v220,v221
v_cvt_pk_bf16_f32 v236,v236,v237
v_mfma_f32_16x16x32_bf16 v[108:111],v[136:139],v[144:147],v[108:111]
ds_read_b128 v[136:139],v0 offset:12416
v_cvt_pk_bf16_f32 v217,v218,v219
ds_read_b128 v[140:143],v1 offset:12416
v_pk_mul_f32 v[248:249],v[248:249],v[62:63] op_sel_hi:[1,0]
ds_write2st64_b64 v37,v[212:213],v[228:229] offset0:12 offset1:14
v_pk_mul_f32 v[250:251],v[250:251],v[62:63] op_sel_hi:[1,0]
v_max3_f32 v52,v52,v99,v100
v_max3_f32 v52,v52,v101,v102
v_mfma_f32_16x16x32_bf16 v[108:111],v[132:135],a[252:255],v[108:111]
ds_read_b128 v[132:135],v1 offset:12288
v_max_f32 v52,v52,v103
v_mfma_f32_16x16x32_bf16 v[108:111],v[128:131],a[248:251],v[108:111]
ds_read_b128 v[128:131],v0 offset:12288
v_mov_b32 v53,v52
v_mfma_f32_16x16x32_bf16 v[108:111],v[124:127],a[244:247],v[108:111]
ds_read_b128 v[124:127],v1 offset:18432
v_permlane32_swap_b32 v53,v52
v_mfma_f32_16x16x32_bf16 v[108:111],v[120:123],a[240:243],v[108:111]
ds_read_b128 v[120:123],v0 offset:18432
v_max_f32 v52,v52,v53
v_mov_b32 v53,v52
v_cvt_pk_bf16_f32 v233,v234,v235
ds_write2st64_b64 v38,v[216:217],v[232:233] offset0:12 offset1:14
v_pk_mul_f32 v[252:253],v[252:253],v[62:63] op_sel_hi:[1,0]
v_pk_mul_f32 v[254:255],v[254:255],v[62:63] op_sel_hi:[1,0]
v_permlane16_swap_b32 v53,v52
v_max_f32 v52,v52,v53
v_mul_f32_e64 v16,-s36,v52
v_fma_f32 v96,v96,s36,v16
v_fma_f32 v97,v97,s36,v16
v_fma_f32 v98,v98,s36,v16
v_fma_f32 v99,v99,s36,v16
v_exp_f32 v96,v96
v_exp_f32 v97,v97
v_exp_f32 v98,v98
s_waitcnt lgkmcnt(3)
v_mfma_f32_16x16x32_bf16 v[72:75],v[128:131],a[144:147],0
v_exp_f32 v99,v99
v_mfma_f32_16x16x32_bf16 v[72:75],v[132:135],a[148:151],v[72:75]
v_cvt_pk_bf16_f32 v32,v96,v97
v_cvt_pk_bf16_f32 v33,v98,v99
v_mfma_f32_16x16x32_bf16 v[72:75],v[136:139],a[152:155],v[72:75]
v_max3_f32 v56,v56,v107,v108
v_max3_f32 v56,v56,v109,v110
v_mfma_f32_16x16x32_bf16 v[72:75],v[140:143],a[156:159],v[72:75]
v_max_f32 v56,v56,v111
v_mov_b32 v57,v56
v_mfma_f32_16x16x32_bf16 v[72:75],v[112:115],a[160:163],v[72:75]
v_cvt_pk_bf16_f32 v240,v240,v241
v_permlane32_swap_b32 v57,v56
v_mfma_f32_16x16x32_bf16 v[72:75],v[116:119],a[164:167],v[72:75]
v_max_f32 v56,v56,v57
v_mov_b32 v57,v56
v_mfma_f32_16x16x32_bf16 v[80:83],v[116:119],a[188:191],0
v_cvt_pk_bf16_f32 v221,v222,v223
v_permlane16_swap_b32 v57,v56
v_mfma_f32_16x16x32_bf16 v[80:83],v[112:115],a[184:187],v[80:83]
v_max_f32 v56,v56,v57
v_mul_f32_e64 v17,-s36,v56
v_mfma_f32_16x16x32_bf16 v[80:83],v[140:143],a[180:183],v[80:83]
v_cvt_pk_bf16_f32 v237,v238,v239
v_fma_f32 v104,v104,s36,v17
v_mfma_f32_16x16x32_bf16 v[80:83],v[136:139],a[176:179],v[80:83]
ds_write2st64_b64 v39,v[220:221],v[236:237] offset0:12 offset1:14
v_mfma_f32_16x16x32_bf16 v[80:83],v[132:135],a[172:175],v[80:83]
v_fma_f32 v105,v105,s36,v17
v_fma_f32 v106,v106,s36,v17
v_mfma_f32_16x16x32_bf16 v[80:83],v[128:131],a[168:171],v[80:83]
v_fma_f32 v107,v107,s36,v17
v_cvt_pk_bf16_f32 v244,v244,v245
v_mfma_f32_16x16x32_bf16 v[88:91],v[128:131],a[192:195],0
v_cvt_pk_bf16_f32 v241,v242,v243
v_exp_f32 v104,v104
v_mfma_f32_16x16x32_bf16 v[88:91],v[132:135],a[196:199],v[88:91]
ds_write_b64 v36,v[240:241] offset:8192
v_mfma_f32_16x16x32_bf16 v[88:91],v[136:139],a[200:203],v[88:91]
v_exp_f32 v105,v105
v_mfma_f32_16x16x32_bf16 v[88:91],v[140:143],a[204:207],v[88:91]
v_exp_f32 v106,v106
v_mfma_f32_16x16x32_bf16 v[88:91],v[112:115],a[208:211],v[88:91]
v_exp_f32 v107,v107
v_mfma_f32_16x16x32_bf16 v[88:91],v[116:119],a[212:215],v[88:91]
v_cvt_pk_bf16_f32 v245,v246,v247
v_cvt_pk_bf16_f32 v36,v104,v105
v_mfma_f32_16x16x32_bf16 v[96:99],v[116:119],a[236:239],0
ds_write_b64 v37,v[244:245] offset:8192
v_mfma_f32_16x16x32_bf16 v[96:99],v[112:115],a[232:235],v[96:99]
v_cvt_pk_bf16_f32 v37,v106,v107
v_fma_f32 v76,v76,s36,v13
v_mfma_f32_16x16x32_bf16 v[96:99],v[140:143],a[228:231],v[96:99]
v_fma_f32 v77,v77,s36,v13
v_fma_f32 v78,v78,s36,v13
v_mfma_f32_16x16x32_bf16 v[96:99],v[136:139],a[224:227],v[96:99]
v_fma_f32 v79,v79,s36,v13
v_exp_f32 v76,v76
v_mfma_f32_16x16x32_bf16 v[96:99],v[132:135],a[220:223],v[96:99]
v_exp_f32 v77,v77
v_mfma_f32_16x16x32_bf16 v[96:99],v[128:131],a[216:219],v[96:99]
v_exp_f32 v78,v78
v_mfma_f32_16x16x32_bf16 v[104:107],v[128:131],a[240:243],0
s_waitcnt vmcnt(11)
s_barrier
v_mfma_f32_16x16x32_bf16 v[104:107],v[132:135],a[244:247],v[104:107]
ds_read_b128 v[128:131],v0 offset:18560
buffer_load_dwordx4 v6,s[4:7],s20 offen offset:0 lds
v_mfma_f32_16x16x32_bf16 v[104:107],v[136:139],a[248:251],v[104:107]
ds_read_b128 v[132:135],v1 offset:18560
v_exp_f32 v79,v79
v_mfma_f32_16x16x32_bf16 v[104:107],v[140:143],a[252:255],v[104:107]
ds_read_b128 v[136:139],v0 offset:18688
v_cvt_pk_bf16_f32 v22,v76,v77
v_mfma_f32_16x16x32_bf16 v[104:107],v[112:115],v[144:147],v[104:107]
ds_read_b128 v[140:143],v1 offset:18688
v_cvt_pk_bf16_f32 v23,v78,v79
v_mfma_f32_16x16x32_bf16 v[104:107],v[116:119],v[148:151],v[104:107]
s_waitcnt lgkmcnt(4)
v_fma_f32 v84,v84,s36,v14
v_fma_f32 v85,v85,s36,v14
v_mfma_f32_16x16x32_bf16 v[76:79],v[120:123],a[144:147],0
v_fma_f32 v86,v86,s36,v14
v_fma_f32 v87,v87,s36,v14
v_mfma_f32_16x16x32_bf16 v[76:79],v[124:127],a[148:151],v[76:79]
buffer_load_dwordx4 v7,s[4:7],s20 offen offset:1024 lds
v_exp_f32 v84,v84
v_exp_f32 v85,v85
v_exp_f32 v86,v86
s_waitcnt lgkmcnt(3)
v_mfma_f32_16x16x32_bf16 v[76:79],v[128:131],a[152:155],v[76:79]
s_waitcnt lgkmcnt(2)
v_exp_f32 v87,v87
v_cvt_pk_bf16_f32 v26,v84,v85
v_mfma_f32_16x16x32_bf16 v[76:79],v[132:135],a[156:159],v[76:79]
s_waitcnt lgkmcnt(1)
ds_read_b64_tr_b16 v[112:113],v2 offset:0
v_cvt_pk_bf16_f32 v27,v86,v87
v_fma_f32 v92,v92,s36,v15
v_mfma_f32_16x16x32_bf16 v[76:79],v[136:139],a[160:163],v[76:79]
ds_read_b64_tr_b16 v[114:115],v2 offset:6144
buffer_load_dwordx4 v8,s[4:7],s20 offen offset:2048 lds
s_waitcnt lgkmcnt(2)
v_mfma_f32_16x16x32_bf16 v[76:79],v[140:143],a[164:167],v[76:79]
s_add_u32 s20,s20,12288
ds_read_b64_tr_b16 v[116:117],v3 offset:0
v_fma_f32 v93,v93,s36,v15
v_mfma_f32_16x16x32_bf16 v[84:87],v[140:143],a[188:191],0
ds_read_b64_tr_b16 v[118:119],v3 offset:6144
v_fma_f32 v94,v94,s36,v15
v_mfma_f32_16x16x32_bf16 v[84:87],v[136:139],a[184:187],v[84:87]
v_fma_f32 v95,v95,s36,v15
v_exp_f32 v92,v92
v_mfma_f32_16x16x32_bf16 v[84:87],v[132:135],a[180:183],v[84:87]
v_exp_f32 v93,v93
v_mfma_f32_16x16x32_bf16 v[84:87],v[128:131],a[176:179],v[84:87]
v_exp_f32 v94,v94
v_mfma_f32_16x16x32_bf16 v[84:87],v[124:127],a[172:175],v[84:87]
v_exp_f32 v95,v95
v_mfma_f32_16x16x32_bf16 v[84:87],v[120:123],a[168:171],v[84:87]
v_cvt_pk_bf16_f32 v30,v92,v93
v_cvt_pk_bf16_f32 v31,v94,v95
v_mfma_f32_16x16x32_bf16 v[92:95],v[120:123],a[192:195],0
v_fma_f32 v100,v100,s36,v16
v_fma_f32 v101,v101,s36,v16
v_mfma_f32_16x16x32_bf16 v[92:95],v[124:127],a[196:199],v[92:95]
v_fma_f32 v102,v102,s36,v16
v_fma_f32 v103,v103,s36,v16
v_mfma_f32_16x16x32_bf16 v[92:95],v[128:131],a[200:203],v[92:95]
v_exp_f32 v100,v100
v_mfma_f32_16x16x32_bf16 v[92:95],v[132:135],a[204:207],v[92:95]
v_exp_f32 v101,v101
v_mfma_f32_16x16x32_bf16 v[92:95],v[136:139],a[208:211],v[92:95]
v_exp_f32 v102,v102
v_mfma_f32_16x16x32_bf16 v[92:95],v[140:143],a[212:215],v[92:95]
v_exp_f32 v103,v103
v_cvt_pk_bf16_f32 v34,v100,v101
v_cvt_pk_bf16_f32 v35,v102,v103
v_mfma_f32_16x16x32_bf16 v[100:103],v[140:143],a[236:239],0
v_cvt_pk_bf16_f32 v248,v248,v249
v_fma_f32 v108,v108,s36,v17
v_mfma_f32_16x16x32_bf16 v[100:103],v[136:139],a[232:235],v[100:103]
v_fma_f32 v109,v109,s36,v17
v_fma_f32 v110,v110,s36,v17
v_mfma_f32_16x16x32_bf16 v[100:103],v[132:135],a[228:231],v[100:103]
v_fma_f32 v111,v111,s36,v17
v_cvt_pk_bf16_f32 v252,v252,v253
v_mfma_f32_16x16x32_bf16 v[100:103],v[128:131],a[224:227],v[100:103]
v_cvt_pk_bf16_f32 v249,v250,v251
v_exp_f32 v108,v108
v_mfma_f32_16x16x32_bf16 v[100:103],v[124:127],a[220:223],v[100:103]
ds_write_b64 v38,v[248:249] offset:8192
v_mfma_f32_16x16x32_bf16 v[100:103],v[120:123],a[216:219],v[100:103]
v_exp_f32 v109,v109
v_exp_f32 v110,v110
v_exp_f32 v111,v111
v_cvt_pk_bf16_f32 v253,v254,v255
ds_write_b64 v39,v[252:253] offset:8192
v_cvt_pk_bf16_f32 v38,v108,v109
v_cvt_pk_bf16_f32 v39,v110,v111
v_mfma_f32_16x16x32_bf16 v[108:111],v[120:123],a[240:243],0
ds_read_b64_tr_b16 v[120:121],v4 offset:0
v_mov_b32 v68,0
v_mfma_f32_16x16x32_bf16 v[108:111],v[124:127],a[244:247],v[108:111]
ds_read_b64_tr_b16 v[122:123],v4 offset:6144
v_mov_b32 v69,0
v_mfma_f32_16x16x32_bf16 v[108:111],v[128:131],a[248:251],v[108:111]
ds_read_b64_tr_b16 v[124:125],v5 offset:0
v_mov_b32 v66,0
v_mfma_f32_16x16x32_bf16 v[108:111],v[132:135],a[252:255],v[108:111]
ds_read_b64_tr_b16 v[126:127],v5 offset:6144
v_mov_b32 v67,0
v_mfma_f32_16x16x32_bf16 v[108:111],v[136:139],v[144:147],v[108:111]
v_mov_b32 v70,0
v_mov_b32 v71,0
v_mfma_f32_16x16x32_bf16 v[108:111],v[140:143],v[148:151],v[108:111]
v_mov_b32 v64,0
v_mov_b32 v65,0
v_smfmac_f32_16x16x64_bf16 v[68:71],v[152:155],v[32:39],v18
v_mov_b32 v60,0
v_smfmac_f32_16x16x64_bf16 v[64:67],v[152:155],v[28:35],v18
v_mov_b32 v61,0
v_mov_b32 v62,0
v_mov_b32 v63,0
v_fma_f32 v72,v72,s36,v13
v_fma_f32 v73,v73,s36,v13
v_smfmac_f32_16x16x64_bf16 v[60:63],v[152:155],v[20:27],v18
v_fma_f32 v74,v74,s36,v13
v_fma_f32 v75,v75,s36,v13
v_fma_f32 v80,v80,s36,v14
v_fma_f32 v81,v81,s36,v14
v_fma_f32 v82,v82,s36,v14
v_fma_f32 v83,v83,s36,v14
v_fma_f32 v88,v88,s36,v15
v_fma_f32 v89,v89,s36,v15
v_exp_f32 v72,v72
v_exp_f32 v73,v73
v_exp_f32 v74,v74
v_exp_f32 v75,v75
v_exp_f32 v80,v80
v_exp_f32 v81,v81
v_exp_f32 v82,v82
v_exp_f32 v83,v83
v_exp_f32 v88,v88
v_exp_f32 v89,v89
v_cvt_pk_bf16_f32 v40,v72,v73
v_cvt_pk_bf16_f32 v41,v74,v75
v_cvt_pk_bf16_f32 v44,v80,v81
v_cvt_pk_bf16_f32 v45,v82,v83
v_cvt_pk_bf16_f32 v48,v88,v89
s_waitcnt lgkmcnt(0)
v_mfma_f32_16x16x32_bf16 v[160:163],v[112:115],v[20:23],0
s_add_u32 m0,s23,0
ds_read_b64_tr_b16 v[128:129],v2 offset:128
v_fma_f32 v90,v90,s36,v15
v_mfma_f32_16x16x32_bf16 v[164:167],v[116:119],v[20:23],0
ds_read_b64_tr_b16 v[130:131],v2 offset:6272
v_fma_f32 v91,v91,s36,v15
v_mfma_f32_16x16x32_bf16 v[212:215],v[116:119],v[24:27],0
ds_read_b64_tr_b16 v[132:133],v3 offset:128
v_fma_f32 v96,v96,s36,v16
v_mfma_f32_16x16x32_bf16 v[208:211],v[112:115],v[24:27],0
ds_read_b64_tr_b16 v[134:135],v3 offset:6272
v_fma_f32 v97,v97,s36,v16
v_mfma_f32_16x16x32_bf16 a[0:3],v[112:115],v[28:31],0
ds_read_b64_tr_b16 v[136:137],v4 offset:128
v_fma_f32 v98,v98,s36,v16
v_mfma_f32_16x16x32_bf16 a[4:7],v[116:119],v[28:31],0
ds_read_b64_tr_b16 v[138:139],v4 offset:6272
v_fma_f32 v99,v99,s36,v16
v_mfma_f32_16x16x32_bf16 a[52:55],v[116:119],v[32:35],0
ds_read_b64_tr_b16 v[140:141],v5 offset:128
v_fma_f32 v104,v104,s36,v17
v_mfma_f32_16x16x32_bf16 a[48:51],v[112:115],v[32:35],0
ds_read_b64_tr_b16 v[142:143],v5 offset:6272
v_fma_f32 v105,v105,s36,v17
v_mfma_f32_16x16x32_bf16 a[96:99],v[112:115],v[36:39],0
ds_read_b64_tr_b16 v[112:113],v2 offset:256
v_fma_f32 v106,v106,s36,v17
v_mfma_f32_16x16x32_bf16 a[100:103],v[116:119],v[36:39],0
ds_read_b64_tr_b16 v[114:115],v2 offset:6400
v_fma_f32 v107,v107,s36,v17
v_mfma_f32_16x16x32_bf16 a[104:107],v[120:123],v[36:39],0
ds_read_b64_tr_b16 v[116:117],v3 offset:256
v_fma_f32 v76,v76,s36,v13
v_mfma_f32_16x16x32_bf16 a[108:111],v[124:127],v[36:39],0
ds_read_b64_tr_b16 v[118:119],v3 offset:6400
v_fma_f32 v77,v77,s36,v13
v_mfma_f32_16x16x32_bf16 a[60:63],v[124:127],v[32:35],0
v_exp_f32 v90,v90
v_mfma_f32_16x16x32_bf16 a[56:59],v[120:123],v[32:35],0
v_exp_f32 v91,v91
v_mfma_f32_16x16x32_bf16 a[8:11],v[120:123],v[28:31],0
v_cvt_pk_bf16_f32 v49,v90,v91
v_fma_f32 v78,v78,s36,v13
v_mfma_f32_16x16x32_bf16 a[12:15],v[124:127],v[28:31],0
v_exp_f32 v96,v96
v_mfma_f32_16x16x32_bf16 v[220:223],v[124:127],v[24:27],0
v_exp_f32 v97,v97
v_mfma_f32_16x16x32_bf16 v[216:219],v[120:123],v[24:27],0
v_exp_f32 v98,v98
v_mfma_f32_16x16x32_bf16 v[168:171],v[120:123],v[20:23],0
ds_read_b64_tr_b16 v[120:121],v4 offset:256
v_cvt_pk_bf16_f32 v52,v96,v97
v_mfma_f32_16x16x32_bf16 v[172:175],v[124:127],v[20:23],0
s_waitcnt lgkmcnt(2)
ds_read_b64_tr_b16 v[122:123],v4 offset:6400
v_fma_f32 v79,v79,s36,v13
v_mfma_f32_16x16x32_bf16 v[176:179],v[128:131],v[20:23],0
ds_read_b64_tr_b16 v[124:125],v5 offset:256
v_fma_f32 v84,v84,s36,v14
v_mfma_f32_16x16x32_bf16 v[180:183],v[132:135],v[20:23],0
ds_read_b64_tr_b16 v[126:127],v5 offset:6400
v_fma_f32 v85,v85,s36,v14
v_mfma_f32_16x16x32_bf16 v[228:231],v[132:135],v[24:27],0
v_exp_f32 v99,v99
v_mfma_f32_16x16x32_bf16 v[224:227],v[128:131],v[24:27],0
v_cvt_pk_bf16_f32 v53,v98,v99
v_fma_f32 v86,v86,s36,v14
v_mfma_f32_16x16x32_bf16 a[16:19],v[128:131],v[28:31],0
v_exp_f32 v104,v104
v_mfma_f32_16x16x32_bf16 a[20:23],v[132:135],v[28:31],0
v_exp_f32 v105,v105
v_mfma_f32_16x16x32_bf16 a[68:71],v[132:135],v[32:35],0
v_exp_f32 v106,v106
v_mfma_f32_16x16x32_bf16 a[64:67],v[128:131],v[32:35],0
v_exp_f32 v107,v107
v_mfma_f32_16x16x32_bf16 a[112:115],v[128:131],v[36:39],0
v_cvt_pk_bf16_f32 v56,v104,v105
v_cvt_pk_bf16_f32 v57,v106,v107
v_mfma_f32_16x16x32_bf16 a[116:119],v[132:135],v[36:39],0
v_exp_f32 v76,v76
v_mfma_f32_16x16x32_bf16 a[120:123],v[136:139],v[36:39],0
v_exp_f32 v77,v77
v_mfma_f32_16x16x32_bf16 a[124:127],v[140:143],v[36:39],0
v_exp_f32 v78,v78
v_mfma_f32_16x16x32_bf16 a[76:79],v[140:143],v[32:35],0
v_exp_f32 v79,v79
v_mfma_f32_16x16x32_bf16 a[72:75],v[136:139],v[32:35],0
v_cvt_pk_bf16_f32 v42,v76,v77
v_cvt_pk_bf16_f32 v43,v78,v79
v_mfma_f32_16x16x32_bf16 a[24:27],v[136:139],v[28:31],0
v_fma_f32 v87,v87,s36,v14
v_fma_f32 v92,v92,s36,v15
v_mfma_f32_16x16x32_bf16 a[28:31],v[140:143],v[28:31],0
v_exp_f32 v84,v84
v_mfma_f32_16x16x32_bf16 v[236:239],v[140:143],v[24:27],0
v_exp_f32 v85,v85
v_mfma_f32_16x16x32_bf16 v[232:235],v[136:139],v[24:27],0
v_exp_f32 v86,v86
v_mfma_f32_16x16x32_bf16 v[184:187],v[136:139],v[20:23],0
v_exp_f32 v87,v87
v_mfma_f32_16x16x32_bf16 v[188:191],v[140:143],v[20:23],0
v_cvt_pk_bf16_f32 v46,v84,v85
v_cvt_pk_bf16_f32 v47,v86,v87
v_mfma_f32_16x16x32_bf16 v[192:195],v[112:115],v[20:23],0
v_fma_f32 v93,v93,s36,v15
v_fma_f32 v94,v94,s36,v15
v_smfmac_f32_16x16x64_bf16 v[60:63],v[152:155],v[40:47],v18
v_fma_f32 v95,v95,s36,v15
s_waitcnt vmcnt(36)
s_waitcnt lgkmcnt(0)
v_mfma_f32_16x16x32_bf16 v[196:199],v[116:119],v[20:23],0
s_barrier
v_mfma_f32_16x16x32_bf16 v[244:247],v[116:119],v[24:27],0
ds_read_b128 v[128:131],v0 offset:24576
v_fma_f32 v100,v100,s36,v16
v_mfma_f32_16x16x32_bf16 v[240:243],v[112:115],v[24:27],0
ds_read_b128 v[132:135],v1 offset:24576
v_fma_f32 v101,v101,s36,v16
v_mfma_f32_16x16x32_bf16 a[32:35],v[112:115],v[28:31],0
ds_read_b128 v[136:139],v0 offset:24704
v_fma_f32 v102,v102,s36,v16
v_mfma_f32_16x16x32_bf16 a[36:39],v[116:119],v[28:31],0
ds_read_b128 v[140:143],v1 offset:24704
v_fma_f32 v103,v103,s36,v16
v_mfma_f32_16x16x32_bf16 a[84:87],v[116:119],v[32:35],0
v_exp_f32 v92,v92
v_mfma_f32_16x16x32_bf16 a[80:83],v[112:115],v[32:35],0
buffer_load_dwordx4 v6,s[8:11],s21 offen offset:0 lds
v_mfma_f32_16x16x32_bf16 a[128:131],v[112:115],v[36:39],0
ds_read_b128 v[112:115],v0 offset:24832
v_fma_f32 v108,v108,s36,v17
v_mfma_f32_16x16x32_bf16 a[132:135],v[116:119],v[36:39],0
ds_read_b128 v[116:119],v1 offset:24832
v_fma_f32 v109,v109,s36,v17
v_mfma_f32_16x16x32_bf16 a[136:139],v[120:123],v[36:39],0
v_exp_f32 v93,v93
v_mfma_f32_16x16x32_bf16 a[140:143],v[124:127],v[36:39],0
v_exp_f32 v94,v94
v_mfma_f32_16x16x32_bf16 a[92:95],v[124:127],v[32:35],0
v_exp_f32 v95,v95
v_mfma_f32_16x16x32_bf16 a[88:91],v[120:123],v[32:35],0
v_cvt_pk_bf16_f32 v50,v92,v93
v_cvt_pk_bf16_f32 v51,v94,v95
v_mfma_f32_16x16x32_bf16 a[40:43],v[120:123],v[28:31],0
v_exp_f32 v100,v100
v_mfma_f32_16x16x32_bf16 a[44:47],v[124:127],v[28:31],0
v_exp_f32 v101,v101
v_mfma_f32_16x16x32_bf16 v[252:255],v[124:127],v[24:27],0
v_exp_f32 v102,v102
v_mfma_f32_16x16x32_bf16 v[248:251],v[120:123],v[24:27],0
v_exp_f32 v103,v103
v_mfma_f32_16x16x32_bf16 v[200:203],v[120:123],v[20:23],0
ds_read_b128 v[120:123],v0 offset:30720
v_cvt_pk_bf16_f32 v54,v100,v101
v_mfma_f32_16x16x32_bf16 v[204:207],v[124:127],v[20:23],0
buffer_load_dwordx4 v7,s[8:11],s21 offen offset:1024 lds
s_waitcnt lgkmcnt(1)
v_mfma_f32_16x16x32_bf16 v[72:75],v[128:131],a[144:147],0
ds_read_b128 v[124:127],v1 offset:30720
v_cvt_pk_bf16_f32 v55,v102,v103
v_mfma_f32_16x16x32_bf16 v[72:75],v[132:135],a[148:151],v[72:75]
v_fma_f32 v110,v110,s36,v17
v_fma_f32 v111,v111,s36,v17
v_smfmac_f32_16x16x64_bf16 v[64:67],v[152:155],v[48:55],v18
v_mfma_f32_16x16x32_bf16 v[72:75],v[136:139],a[152:155],v[72:75]
v_exp_f32 v108,v108
v_mfma_f32_16x16x32_bf16 v[72:75],v[140:143],a[156:159],v[72:75]
v_exp_f32 v109,v109
v_mfma_f32_16x16x32_bf16 v[72:75],v[112:115],a[160:163],v[72:75]
v_exp_f32 v110,v110
v_mfma_f32_16x16x32_bf16 v[72:75],v[116:119],a[164:167],v[72:75]
v_exp_f32 v111,v111
v_mfma_f32_16x16x32_bf16 v[80:83],v[116:119],a[188:191],0
v_cvt_pk_bf16_f32 v58,v108,v109
v_cvt_pk_bf16_f32 v59,v110,v111
v_mfma_f32_16x16x32_bf16 v[80:83],v[112:115],a[184:187],v[80:83]
v_mfma_f32_16x16x32_bf16 v[80:83],v[140:143],a[180:183],v[80:83]
v_smfmac_f32_16x16x64_bf16 v[68:71],v[152:155],v[52:59],v18
buffer_load_dwordx4 v8,s[8:11],s21 offen offset:2048 lds
v_mfma_f32_16x16x32_bf16 v[80:83],v[136:139],a[176:179],v[80:83]
s_add_u32 s21,s21,12288
v_fma_f32 v72,v72,s36,v13
v_fma_f32 v73,v73,s36,v13
v_mfma_f32_16x16x32_bf16 v[80:83],v[132:135],a[172:175],v[80:83]
s_add_u32 m0,s22,12288
v_fma_f32 v74,v74,s36,v13
v_fma_f32 v75,v75,s36,v13
v_mfma_f32_16x16x32_bf16 v[80:83],v[128:131],a[168:171],v[80:83]
v_exp_f32 v72,v72
v_mfma_f32_16x16x32_bf16 v[88:91],v[128:131],a[192:195],0
v_exp_f32 v73,v73
v_mfma_f32_16x16x32_bf16 v[88:91],v[132:135],a[196:199],v[88:91]
v_exp_f32 v74,v74
v_mfma_f32_16x16x32_bf16 v[88:91],v[136:139],a[200:203],v[88:91]
v_exp_f32 v75,v75
v_mfma_f32_16x16x32_bf16 v[88:91],v[140:143],a[204:207],v[88:91]
v_fma_f32 v80,v80,s36,v14
v_fma_f32 v81,v81,s36,v14
v_mfma_f32_16x16x32_bf16 v[88:91],v[112:115],a[208:211],v[88:91]
v_fma_f32 v82,v82,s36,v14
v_fma_f32 v83,v83,s36,v14
v_mfma_f32_16x16x32_bf16 v[88:91],v[116:119],a[212:215],v[88:91]
v_exp_f32 v80,v80
v_mfma_f32_16x16x32_bf16 v[96:99],v[116:119],a[236:239],0
v_exp_f32 v81,v81
v_mfma_f32_16x16x32_bf16 v[96:99],v[112:115],a[232:235],v[96:99]
buffer_load_dwordx4 v6,s[4:7],s20 offen offset:0 lds
v_mfma_f32_16x16x32_bf16 v[96:99],v[140:143],a[228:231],v[96:99]
v_exp_f32 v82,v82
v_mfma_f32_16x16x32_bf16 v[96:99],v[136:139],a[224:227],v[96:99]
v_fma_f32 v88,v88,s36,v15
v_fma_f32 v89,v89,s36,v15
v_mfma_f32_16x16x32_bf16 v[96:99],v[132:135],a[220:223],v[96:99]
v_exp_f32 v83,v83
v_mfma_f32_16x16x32_bf16 v[96:99],v[128:131],a[216:219],v[96:99]
v_exp_f32 v88,v88
v_mfma_f32_16x16x32_bf16 v[104:107],v[128:131],a[240:243],0
ds_read_b128 v[128:131],v0 offset:30848
v_cvt_pk_bf16_f32 v20,v72,v73
v_mfma_f32_16x16x32_bf16 v[104:107],v[132:135],a[244:247],v[104:107]
ds_read_b128 v[132:135],v1 offset:30848
v_cvt_pk_bf16_f32 v21,v74,v75
v_mfma_f32_16x16x32_bf16 v[104:107],v[136:139],a[248:251],v[104:107]
ds_read_b128 v[136:139],v0 offset:30976
v_cvt_pk_bf16_f32 v24,v80,v81
v_mfma_f32_16x16x32_bf16 v[104:107],v[140:143],a[252:255],v[104:107]
ds_read_b128 v[140:143],v1 offset:30976
v_cvt_pk_bf16_f32 v25,v82,v83
v_mfma_f32_16x16x32_bf16 v[104:107],v[112:115],v[144:147],v[104:107]
v_exp_f32 v89,v89
v_mfma_f32_16x16x32_bf16 v[104:107],v[116:119],v[148:151],v[104:107]
s_waitcnt lgkmcnt(4)
v_cvt_pk_bf16_f32 v28,v88,v89
v_mfma_f32_16x16x32_bf16 v[76:79],v[120:123],a[144:147],0
buffer_load_dwordx4 v7,s[4:7],s20 offen offset:1024 lds
v_mfma_f32_16x16x32_bf16 v[76:79],v[124:127],a[148:151],v[76:79]
s_waitcnt lgkmcnt(3)
v_mfma_f32_16x16x32_bf16 v[76:79],v[128:131],a[152:155],v[76:79]
s_waitcnt lgkmcnt(2)
v_mfma_f32_16x16x32_bf16 v[76:79],v[132:135],a[156:159],v[76:79]
s_waitcnt lgkmcnt(1)
v_mfma_f32_16x16x32_bf16 v[76:79],v[136:139],a[160:163],v[76:79]
s_waitcnt lgkmcnt(0)
v_mfma_f32_16x16x32_bf16 v[76:79],v[140:143],a[164:167],v[76:79]
v_mfma_f32_16x16x32_bf16 v[84:87],v[140:143],a[188:191],0
v_mfma_f32_16x16x32_bf16 v[84:87],v[136:139],a[184:187],v[84:87]
v_mfma_f32_16x16x32_bf16 v[84:87],v[132:135],a[180:183],v[84:87]
v_mfma_f32_16x16x32_bf16 v[84:87],v[128:131],a[176:179],v[84:87]
v_mfma_f32_16x16x32_bf16 v[84:87],v[124:127],a[172:175],v[84:87]
v_mfma_f32_16x16x32_bf16 v[84:87],v[120:123],a[168:171],v[84:87]
buffer_load_dwordx4 v8,s[4:7],s20 offen offset:2048 lds
v_mfma_f32_16x16x32_bf16 v[92:95],v[120:123],a[192:195],0
s_add_u32 s20,s20,12288
v_mfma_f32_16x16x32_bf16 v[92:95],v[124:127],a[196:199],v[92:95]
v_mfma_f32_16x16x32_bf16 v[92:95],v[128:131],a[200:203],v[92:95]
v_mfma_f32_16x16x32_bf16 v[92:95],v[132:135],a[204:207],v[92:95]
v_mfma_f32_16x16x32_bf16 v[92:95],v[136:139],a[208:211],v[92:95]
ds_read_b64_tr_b16 v[112:113],v2 offset:12288
v_mfma_f32_16x16x32_bf16 v[92:95],v[140:143],a[212:215],v[92:95]
ds_read_b64_tr_b16 v[114:115],v2 offset:18432
v_mfma_f32_16x16x32_bf16 v[100:103],v[140:143],a[236:239],0
v_mfma_f32_16x16x32_bf16 v[100:103],v[136:139],a[232:235],v[100:103]
ds_read_b64_tr_b16 v[116:117],v3 offset:12288
v_mfma_f32_16x16x32_bf16 v[100:103],v[132:135],a[228:231],v[100:103]
ds_read_b64_tr_b16 v[118:119],v3 offset:18432
v_mfma_f32_16x16x32_bf16 v[100:103],v[128:131],a[224:227],v[100:103]
v_mfma_f32_16x16x32_bf16 v[100:103],v[124:127],a[220:223],v[100:103]
v_mfma_f32_16x16x32_bf16 v[100:103],v[120:123],a[216:219],v[100:103]
v_mfma_f32_16x16x32_bf16 v[108:111],v[120:123],a[240:243],0
ds_read_b64_tr_b16 v[120:121],v4 offset:12288
v_mfma_f32_16x16x32_bf16 v[108:111],v[124:127],a[244:247],v[108:111]
ds_read_b64_tr_b16 v[122:123],v4 offset:18432
v_mfma_f32_16x16x32_bf16 v[108:111],v[128:131],a[248:251],v[108:111]
ds_read_b64_tr_b16 v[124:125],v5 offset:12288
v_mfma_f32_16x16x32_bf16 v[108:111],v[132:135],a[252:255],v[108:111]
ds_read_b64_tr_b16 v[126:127],v5 offset:18432
v_mfma_f32_16x16x32_bf16 v[108:111],v[136:139],v[144:147],v[108:111]
v_mfma_f32_16x16x32_bf16 v[108:111],v[140:143],v[148:151],v[108:111]
s_waitcnt lgkmcnt(4)
v_mfma_f32_16x16x32_bf16 v[160:163],v[112:115],v[40:43],v[160:163]
s_add_u32 m0,s23,12288
ds_read_b64_tr_b16 v[128:129],v2 offset:12416
v_fma_f32 v90,v90,s36,v15
v_mfma_f32_16x16x32_bf16 v[164:167],v[116:119],v[40:43],v[164:167]
ds_read_b64_tr_b16 v[130:131],v2 offset:18560
v_fma_f32 v91,v91,s36,v15
v_mfma_f32_16x16x32_bf16 v[212:215],v[116:119],v[44:47],v[212:215]
ds_read_b64_tr_b16 v[132:133],v3 offset:12416
v_fma_f32 v96,v96,s36,v16
v_mfma_f32_16x16x32_bf16 v[208:211],v[112:115],v[44:47],v[208:211]
ds_read_b64_tr_b16 v[134:135],v3 offset:18560
v_fma_f32 v97,v97,s36,v16
v_mfma_f32_16x16x32_bf16 a[0:3],v[112:115],v[48:51],a[0:3]
ds_read_b64_tr_b16 v[136:137],v4 offset:12416
v_fma_f32 v98,v98,s36,v16
v_mfma_f32_16x16x32_bf16 a[4:7],v[116:119],v[48:51],a[4:7]
ds_read_b64_tr_b16 v[138:139],v4 offset:18560
v_fma_f32 v99,v99,s36,v16
v_mfma_f32_16x16x32_bf16 a[52:55],v[116:119],v[52:55],a[52:55]
ds_read_b64_tr_b16 v[140:141],v5 offset:12416
v_fma_f32 v104,v104,s36,v17
v_mfma_f32_16x16x32_bf16 a[48:51],v[112:115],v[52:55],a[48:51]
ds_read_b64_tr_b16 v[142:143],v5 offset:18560
v_fma_f32 v105,v105,s36,v17
v_mfma_f32_16x16x32_bf16 a[96:99],v[112:115],v[56:59],a[96:99]
ds_read_b64_tr_b16 v[112:113],v2 offset:12544
v_fma_f32 v106,v106,s36,v17
v_mfma_f32_16x16x32_bf16 a[100:103],v[116:119],v[56:59],a[100:103]
s_waitcnt lgkmcnt(8)
ds_read_b64_tr_b16 v[114:115],v2 offset:18688
v_fma_f32 v107,v107,s36,v17
v_mfma_f32_16x16x32_bf16 a[104:107],v[120:123],v[56:59],a[104:107]
ds_read_b64_tr_b16 v[116:117],v3 offset:12544
v_fma_f32 v76,v76,s36,v13
v_mfma_f32_16x16x32_bf16 a[108:111],v[124:127],v[56:59],a[108:111]
ds_read_b64_tr_b16 v[118:119],v3 offset:18688
v_fma_f32 v77,v77,s36,v13
v_mfma_f32_16x16x32_bf16 a[60:63],v[124:127],v[52:55],a[60:63]
v_exp_f32 v90,v90
v_mfma_f32_16x16x32_bf16 a[56:59],v[120:123],v[52:55],a[56:59]
v_exp_f32 v91,v91
v_mfma_f32_16x16x32_bf16 a[8:11],v[120:123],v[48:51],a[8:11]
v_cvt_pk_bf16_f32 v29,v90,v91
v_fma_f32 v78,v78,s36,v13
v_mfma_f32_16x16x32_bf16 a[12:15],v[124:127],v[48:51],a[12:15]
v_exp_f32 v96,v96
v_mfma_f32_16x16x32_bf16 v[220:223],v[124:127],v[44:47],v[220:223]
v_exp_f32 v97,v97
v_mfma_f32_16x16x32_bf16 v[216:219],v[120:123],v[44:47],v[216:219]
v_exp_f32 v98,v98
v_mfma_f32_16x16x32_bf16 v[168:171],v[120:123],v[40:43],v[168:171]
ds_read_b64_tr_b16 v[120:121],v4 offset:12544
v_cvt_pk_bf16_f32 v32,v96,v97
v_mfma_f32_16x16x32_bf16 v[172:175],v[124:127],v[40:43],v[172:175]
s_waitcnt lgkmcnt(2)
ds_read_b64_tr_b16 v[122:123],v4 offset:18688
v_fma_f32 v79,v79,s36,v13
v_mfma_f32_16x16x32_bf16 v[176:179],v[128:131],v[40:43],v[176:179]
ds_read_b64_tr_b16 v[124:125],v5 offset:12544
v_fma_f32 v84,v84,s36,v14
v_mfma_f32_16x16x32_bf16 v[180:183],v[132:135],v[40:43],v[180:183]
ds_read_b64_tr_b16 v[126:127],v5 offset:18688
v_fma_f32 v85,v85,s36,v14
v_mfma_f32_16x16x32_bf16 v[228:231],v[132:135],v[44:47],v[228:231]
v_exp_f32 v99,v99
v_mfma_f32_16x16x32_bf16 v[224:227],v[128:131],v[44:47],v[224:227]
v_cvt_pk_bf16_f32 v33,v98,v99
v_fma_f32 v86,v86,s36,v14
v_mfma_f32_16x16x32_bf16 a[16:19],v[128:131],v[48:51],a[16:19]
v_exp_f32 v104,v104
v_mfma_f32_16x16x32_bf16 a[20:23],v[132:135],v[48:51],a[20:23]
v_exp_f32 v105,v105
v_mfma_f32_16x16x32_bf16 a[68:71],v[132:135],v[52:55],a[68:71]
v_exp_f32 v106,v106
v_mfma_f32_16x16x32_bf16 a[64:67],v[128:131],v[52:55],a[64:67]
v_exp_f32 v107,v107
v_mfma_f32_16x16x32_bf16 a[112:115],v[128:131],v[56:59],a[112:115]
v_cvt_pk_bf16_f32 v36,v104,v105
v_cvt_pk_bf16_f32 v37,v106,v107
v_mfma_f32_16x16x32_bf16 a[116:119],v[132:135],v[56:59],a[116:119]
v_exp_f32 v76,v76
v_mfma_f32_16x16x32_bf16 a[120:123],v[136:139],v[56:59],a[120:123]
v_exp_f32 v77,v77
v_mfma_f32_16x16x32_bf16 a[124:127],v[140:143],v[56:59],a[124:127]
v_exp_f32 v78,v78
v_mfma_f32_16x16x32_bf16 a[76:79],v[140:143],v[52:55],a[76:79]
v_exp_f32 v79,v79
v_mfma_f32_16x16x32_bf16 a[72:75],v[136:139],v[52:55],a[72:75]
v_cvt_pk_bf16_f32 v22,v76,v77
v_cvt_pk_bf16_f32 v23,v78,v79
v_mfma_f32_16x16x32_bf16 a[24:27],v[136:139],v[48:51],a[24:27]
v_fma_f32 v87,v87,s36,v14
v_fma_f32 v92,v92,s36,v15
v_mfma_f32_16x16x32_bf16 a[28:31],v[140:143],v[48:51],a[28:31]
v_exp_f32 v84,v84
v_mfma_f32_16x16x32_bf16 v[236:239],v[140:143],v[44:47],v[236:239]
v_exp_f32 v85,v85
v_mfma_f32_16x16x32_bf16 v[232:235],v[136:139],v[44:47],v[232:235]
v_exp_f32 v86,v86
v_mfma_f32_16x16x32_bf16 v[184:187],v[136:139],v[40:43],v[184:187]
v_exp_f32 v87,v87
v_mfma_f32_16x16x32_bf16 v[188:191],v[140:143],v[40:43],v[188:191]
v_cvt_pk_bf16_f32 v26,v84,v85
v_cvt_pk_bf16_f32 v27,v86,v87
v_mfma_f32_16x16x32_bf16 v[192:195],v[112:115],v[40:43],v[192:195]
v_fma_f32 v93,v93,s36,v15
v_fma_f32 v94,v94,s36,v15
v_smfmac_f32_16x16x64_bf16 v[60:63],v[152:155],v[20:27],v18
v_fma_f32 v95,v95,s36,v15
s_waitcnt vmcnt(6)
s_waitcnt lgkmcnt(0)
v_mfma_f32_16x16x32_bf16 v[196:199],v[116:119],v[40:43],v[196:199]
s_barrier
v_mfma_f32_16x16x32_bf16 v[244:247],v[116:119],v[44:47],v[244:247]
ds_read_b128 v[128:131],v0 offset:0
v_fma_f32 v100,v100,s36,v16
v_mfma_f32_16x16x32_bf16 v[240:243],v[112:115],v[44:47],v[240:243]
ds_read_b128 v[132:135],v1 offset:0
v_fma_f32 v101,v101,s36,v16
v_mfma_f32_16x16x32_bf16 a[32:35],v[112:115],v[48:51],a[32:35]
ds_read_b128 v[136:139],v0 offset:128
v_fma_f32 v102,v102,s36,v16
v_mfma_f32_16x16x32_bf16 a[36:39],v[116:119],v[48:51],a[36:39]
ds_read_b128 v[140:143],v1 offset:128
v_fma_f32 v103,v103,s36,v16
v_mfma_f32_16x16x32_bf16 a[84:87],v[116:119],v[52:55],a[84:87]
v_exp_f32 v92,v92
v_mfma_f32_16x16x32_bf16 a[80:83],v[112:115],v[52:55],a[80:83]
buffer_load_dwordx4 v6,s[8:11],s21 offen offset:0 lds
v_mfma_f32_16x16x32_bf16 a[128:131],v[112:115],v[56:59],a[128:131]
ds_read_b128 v[112:115],v0 offset:256
v_fma_f32 v108,v108,s36,v17
v_mfma_f32_16x16x32_bf16 a[132:135],v[116:119],v[56:59],a[132:135]
ds_read_b128 v[116:119],v1 offset:256
v_fma_f32 v109,v109,s36,v17
v_mfma_f32_16x16x32_bf16 a[136:139],v[120:123],v[56:59],a[136:139]
v_exp_f32 v93,v93
v_mfma_f32_16x16x32_bf16 a[140:143],v[124:127],v[56:59],a[140:143]
v_exp_f32 v94,v94
v_mfma_f32_16x16x32_bf16 a[92:95],v[124:127],v[52:55],a[92:95]
v_exp_f32 v95,v95
v_mfma_f32_16x16x32_bf16 a[88:91],v[120:123],v[52:55],a[88:91]
v_cvt_pk_bf16_f32 v30,v92,v93
v_cvt_pk_bf16_f32 v31,v94,v95
v_mfma_f32_16x16x32_bf16 a[40:43],v[120:123],v[48:51],a[40:43]
v_exp_f32 v100,v100
v_mfma_f32_16x16x32_bf16 a[44:47],v[124:127],v[48:51],a[44:47]
v_exp_f32 v101,v101
v_mfma_f32_16x16x32_bf16 v[252:255],v[124:127],v[44:47],v[252:255]
v_exp_f32 v102,v102
v_mfma_f32_16x16x32_bf16 v[248:251],v[120:123],v[44:47],v[248:251]
v_exp_f32 v103,v103
v_mfma_f32_16x16x32_bf16 v[200:203],v[120:123],v[40:43],v[200:203]
ds_read_b128 v[120:123],v0 offset:6144
v_cvt_pk_bf16_f32 v34,v100,v101
v_mfma_f32_16x16x32_bf16 v[204:207],v[124:127],v[40:43],v[204:207]
buffer_load_dwordx4 v7,s[8:11],s21 offen offset:1024 lds
s_waitcnt lgkmcnt(1)
v_mfma_f32_16x16x32_bf16 v[72:75],v[128:131],a[144:147],0
ds_read_b128 v[124:127],v1 offset:6144
v_cvt_pk_bf16_f32 v35,v102,v103
v_mfma_f32_16x16x32_bf16 v[72:75],v[132:135],a[148:151],v[72:75]
v_fma_f32 v110,v110,s36,v17
v_fma_f32 v111,v111,s36,v17
v_smfmac_f32_16x16x64_bf16 v[64:67],v[152:155],v[28:35],v18
v_mfma_f32_16x16x32_bf16 v[72:75],v[136:139],a[152:155],v[72:75]
v_exp_f32 v108,v108
v_mfma_f32_16x16x32_bf16 v[72:75],v[140:143],a[156:159],v[72:75]
v_exp_f32 v109,v109
v_mfma_f32_16x16x32_bf16 v[72:75],v[112:115],a[160:163],v[72:75]
v_exp_f32 v110,v110
v_mfma_f32_16x16x32_bf16 v[72:75],v[116:119],a[164:167],v[72:75]
v_exp_f32 v111,v111
v_mfma_f32_16x16x32_bf16 v[80:83],v[116:119],a[188:191],0
v_cvt_pk_bf16_f32 v38,v108,v109
v_cvt_pk_bf16_f32 v39,v110,v111
v_mfma_f32_16x16x32_bf16 v[80:83],v[112:115],a[184:187],v[80:83]
v_mfma_f32_16x16x32_bf16 v[80:83],v[140:143],a[180:183],v[80:83]
v_smfmac_f32_16x16x64_bf16 v[68:71],v[152:155],v[32:39],v18
buffer_load_dwordx4 v8,s[8:11],s21 offen offset:2048 lds
v_mfma_f32_16x16x32_bf16 v[80:83],v[136:139],a[176:179],v[80:83]
s_add_u32 s21,s21,12288
v_fma_f32 v72,v72,s36,v13
v_fma_f32 v73,v73,s36,v13
v_mfma_f32_16x16x32_bf16 v[80:83],v[132:135],a[172:175],v[80:83]
s_add_u32 m0,s22,24576
v_fma_f32 v74,v74,s36,v13
v_fma_f32 v75,v75,s36,v13
v_mfma_f32_16x16x32_bf16 v[80:83],v[128:131],a[168:171],v[80:83]
v_exp_f32 v72,v72
v_mfma_f32_16x16x32_bf16 v[88:91],v[128:131],a[192:195],0
v_exp_f32 v73,v73
v_mfma_f32_16x16x32_bf16 v[88:91],v[132:135],a[196:199],v[88:91]
v_exp_f32 v74,v74
v_mfma_f32_16x16x32_bf16 v[88:91],v[136:139],a[200:203],v[88:91]
v_exp_f32 v75,v75
v_mfma_f32_16x16x32_bf16 v[88:91],v[140:143],a[204:207],v[88:91]
v_fma_f32 v80,v80,s36,v14
v_fma_f32 v81,v81,s36,v14
v_mfma_f32_16x16x32_bf16 v[88:91],v[112:115],a[208:211],v[88:91]
v_fma_f32 v82,v82,s36,v14
v_fma_f32 v83,v83,s36,v14
v_mfma_f32_16x16x32_bf16 v[88:91],v[116:119],a[212:215],v[88:91]
v_exp_f32 v80,v80
v_mfma_f32_16x16x32_bf16 v[96:99],v[116:119],a[236:239],0
v_exp_f32 v81,v81
v_mfma_f32_16x16x32_bf16 v[96:99],v[112:115],a[232:235],v[96:99]
buffer_load_dwordx4 v6,s[4:7],s20 offen offset:0 lds
v_mfma_f32_16x16x32_bf16 v[96:99],v[140:143],a[228:231],v[96:99]
v_exp_f32 v82,v82
v_mfma_f32_16x16x32_bf16 v[96:99],v[136:139],a[224:227],v[96:99]
v_fma_f32 v88,v88,s36,v15
v_fma_f32 v89,v89,s36,v15
v_mfma_f32_16x16x32_bf16 v[96:99],v[132:135],a[220:223],v[96:99]
v_exp_f32 v83,v83
v_mfma_f32_16x16x32_bf16 v[96:99],v[128:131],a[216:219],v[96:99]
v_exp_f32 v88,v88
v_mfma_f32_16x16x32_bf16 v[104:107],v[128:131],a[240:243],0
ds_read_b128 v[128:131],v0 offset:6272
v_cvt_pk_bf16_f32 v40,v72,v73
v_mfma_f32_16x16x32_bf16 v[104:107],v[132:135],a[244:247],v[104:107]
ds_read_b128 v[132:135],v1 offset:6272
v_cvt_pk_bf16_f32 v41,v74,v75
v_mfma_f32_16x16x32_bf16 v[104:107],v[136:139],a[248:251],v[104:107]
ds_read_b128 v[136:139],v0 offset:6400
v_cvt_pk_bf16_f32 v44,v80,v81
v_mfma_f32_16x16x32_bf16 v[104:107],v[140:143],a[252:255],v[104:107]
ds_read_b128 v[140:143],v1 offset:6400
v_cvt_pk_bf16_f32 v45,v82,v83
v_mfma_f32_16x16x32_bf16 v[104:107],v[112:115],v[144:147],v[104:107]
v_exp_f32 v89,v89
v_mfma_f32_16x16x32_bf16 v[104:107],v[116:119],v[148:151],v[104:107]
s_waitcnt lgkmcnt(4)
v_cvt_pk_bf16_f32 v48,v88,v89
v_mfma_f32_16x16x32_bf16 v[76:79],v[120:123],a[144:147],0
buffer_load_dwordx4 v7,s[4:7],s20 offen offset:1024 lds
v_mfma_f32_16x16x32_bf16 v[76:79],v[124:127],a[148:151],v[76:79]
s_waitcnt lgkmcnt(3)
v_mfma_f32_16x16x32_bf16 v[76:79],v[128:131],a[152:155],v[76:79]
s_waitcnt lgkmcnt(2)
v_mfma_f32_16x16x32_bf16 v[76:79],v[132:135],a[156:159],v[76:79]
s_waitcnt lgkmcnt(1)
v_mfma_f32_16x16x32_bf16 v[76:79],v[136:139],a[160:163],v[76:79]
s_waitcnt lgkmcnt(0)
v_mfma_f32_16x16x32_bf16 v[76:79],v[140:143],a[164:167],v[76:79]
v_mfma_f32_16x16x32_bf16 v[84:87],v[140:143],a[188:191],0
v_mfma_f32_16x16x32_bf16 v[84:87],v[136:139],a[184:187],v[84:87]
v_mfma_f32_16x16x32_bf16 v[84:87],v[132:135],a[180:183],v[84:87]
v_mfma_f32_16x16x32_bf16 v[84:87],v[128:131],a[176:179],v[84:87]
v_mfma_f32_16x16x32_bf16 v[84:87],v[124:127],a[172:175],v[84:87]
v_mfma_f32_16x16x32_bf16 v[84:87],v[120:123],a[168:171],v[84:87]
buffer_load_dwordx4 v8,s[4:7],s20 offen offset:2048 lds
v_mfma_f32_16x16x32_bf16 v[92:95],v[120:123],a[192:195],0
s_add_u32 s20,s20,12288
v_mfma_f32_16x16x32_bf16 v[92:95],v[124:127],a[196:199],v[92:95]
v_mfma_f32_16x16x32_bf16 v[92:95],v[128:131],a[200:203],v[92:95]
v_mfma_f32_16x16x32_bf16 v[92:95],v[132:135],a[204:207],v[92:95]
v_mfma_f32_16x16x32_bf16 v[92:95],v[136:139],a[208:211],v[92:95]
ds_read_b64_tr_b16 v[112:113],v2 offset:24576
v_mfma_f32_16x16x32_bf16 v[92:95],v[140:143],a[212:215],v[92:95]
ds_read_b64_tr_b16 v[114:115],v2 offset:30720
v_mfma_f32_16x16x32_bf16 v[100:103],v[140:143],a[236:239],0
v_mfma_f32_16x16x32_bf16 v[100:103],v[136:139],a[232:235],v[100:103]
ds_read_b64_tr_b16 v[116:117],v3 offset:24576
v_mfma_f32_16x16x32_bf16 v[100:103],v[132:135],a[228:231],v[100:103]
ds_read_b64_tr_b16 v[118:119],v3 offset:30720
v_mfma_f32_16x16x32_bf16 v[100:103],v[128:131],a[224:227],v[100:103]
v_mfma_f32_16x16x32_bf16 v[100:103],v[124:127],a[220:223],v[100:103]
v_mfma_f32_16x16x32_bf16 v[100:103],v[120:123],a[216:219],v[100:103]
v_mfma_f32_16x16x32_bf16 v[108:111],v[120:123],a[240:243],0
ds_read_b64_tr_b16 v[120:121],v4 offset:24576
v_mfma_f32_16x16x32_bf16 v[108:111],v[124:127],a[244:247],v[108:111]
ds_read_b64_tr_b16 v[122:123],v4 offset:30720
v_mfma_f32_16x16x32_bf16 v[108:111],v[128:131],a[248:251],v[108:111]
ds_read_b64_tr_b16 v[124:125],v5 offset:24576
v_mfma_f32_16x16x32_bf16 v[108:111],v[132:135],a[252:255],v[108:111]
ds_read_b64_tr_b16 v[126:127],v5 offset:30720
v_mfma_f32_16x16x32_bf16 v[108:111],v[136:139],v[144:147],v[108:111]
v_mfma_f32_16x16x32_bf16 v[108:111],v[140:143],v[148:151],v[108:111]
s_mov_b32 s38,0
s_branch L_loop5
L_loop4:
.p2align 6
L_loop4w0:
s_waitcnt lgkmcnt(4)
v_mfma_f32_16x16x32_bf16 v[160:163],v[112:115],v[20:23],v[160:163]
s_add_u32 m0,s23,24576
ds_read_b64_tr_b16 v[128:129],v2 offset:24704
v_fma_f32 v82,v82,s36,v14
v_mfma_f32_16x16x32_bf16 v[164:167],v[116:119],v[20:23],v[164:167]
ds_read_b64_tr_b16 v[130:131],v2 offset:30848
v_fma_f32 v83,v83,s36,v14
v_mfma_f32_16x16x32_bf16 v[212:215],v[116:119],v[24:27],v[212:215]
ds_read_b64_tr_b16 v[132:133],v3 offset:24704
v_fma_f32 v88,v88,s36,v15
v_mfma_f32_16x16x32_bf16 v[208:211],v[112:115],v[24:27],v[208:211]
ds_read_b64_tr_b16 v[134:135],v3 offset:30848
v_fma_f32 v89,v89,s36,v15
v_mfma_f32_16x16x32_bf16 a[0:3],v[112:115],v[28:31],a[0:3]
ds_read_b64_tr_b16 v[136:137],v4 offset:24704
v_fma_f32 v90,v90,s36,v15
v_mfma_f32_16x16x32_bf16 a[4:7],v[116:119],v[28:31],a[4:7]
ds_read_b64_tr_b16 v[138:139],v4 offset:30848
v_fma_f32 v91,v91,s36,v15
v_mfma_f32_16x16x32_bf16 a[52:55],v[116:119],v[32:35],a[52:55]
ds_read_b64_tr_b16 v[140:141],v5 offset:24704
v_fma_f32 v96,v96,s36,v16
v_mfma_f32_16x16x32_bf16 a[48:51],v[112:115],v[32:35],a[48:51]
s_waitcnt lgkmcnt(7)
ds_read_b64_tr_b16 v[142:143],v5 offset:30848
v_fma_f32 v97,v97,s36,v16
v_mfma_f32_16x16x32_bf16 a[56:59],v[120:123],v[32:35],a[56:59]
ds_read_b64_tr_b16 v[112:113],v2 offset:24832
v_fma_f32 v98,v98,s36,v16
v_mfma_f32_16x16x32_bf16 a[60:63],v[124:127],v[32:35],a[60:63]
ds_read_b64_tr_b16 v[114:115],v2 offset:30976
v_fma_f32 v99,v99,s36,v16
v_mfma_f32_16x16x32_bf16 a[12:15],v[124:127],v[28:31],a[12:15]
ds_read_b64_tr_b16 v[116:117],v3 offset:24832
v_fma_f32 v76,v76,s36,v13
v_mfma_f32_16x16x32_bf16 a[8:11],v[120:123],v[28:31],a[8:11]
ds_read_b64_tr_b16 v[118:119],v3 offset:30976
v_fma_f32 v77,v77,s36,v13
v_mfma_f32_16x16x32_bf16 v[216:219],v[120:123],v[24:27],v[216:219]
v_exp_f32 v82,v82
v_mfma_f32_16x16x32_bf16 v[220:223],v[124:127],v[24:27],v[220:223]
v_exp_f32 v83,v83
v_mfma_f32_16x16x32_bf16 v[172:175],v[124:127],v[20:23],v[172:175]
ds_read_b64_tr_b16 v[124:125],v5 offset:24832
v_cvt_pk_bf16_f32 v45,v82,v83
v_mfma_f32_16x16x32_bf16 v[168:171],v[120:123],v[20:23],v[168:171]
s_waitcnt lgkmcnt(5)
ds_read_b64_tr_b16 v[120:121],v4 offset:24832
v_fma_f32 v78,v78,s36,v13
v_mfma_f32_16x16x32_bf16 v[176:179],v[128:131],v[20:23],v[176:179]
ds_read_b64_tr_b16 v[122:123],v4 offset:30976
v_fma_f32 v79,v79,s36,v13
v_mfma_f32_16x16x32_bf16 v[180:183],v[132:135],v[20:23],v[180:183]
ds_read_b64_tr_b16 v[126:127],v5 offset:30976
v_fma_f32 v84,v84,s36,v14
v_mfma_f32_16x16x32_bf16 v[228:231],v[132:135],v[24:27],v[228:231]
v_exp_f32 v88,v88
v_mfma_f32_16x16x32_bf16 v[224:227],v[128:131],v[24:27],v[224:227]
v_exp_f32 v89,v89
v_mfma_f32_16x16x32_bf16 a[16:19],v[128:131],v[28:31],a[16:19]
v_exp_f32 v90,v90
v_mfma_f32_16x16x32_bf16 a[20:23],v[132:135],v[28:31],a[20:23]
v_exp_f32 v91,v91
v_mfma_f32_16x16x32_bf16 a[68:71],v[132:135],v[32:35],a[68:71]
v_cvt_pk_bf16_f32 v48,v88,v89
v_cvt_pk_bf16_f32 v49,v90,v91
v_mfma_f32_16x16x32_bf16 a[64:67],v[128:131],v[32:35],a[64:67]
v_exp_f32 v96,v96
v_mfma_f32_16x16x32_bf16 a[72:75],v[136:139],v[32:35],a[72:75]
v_exp_f32 v97,v97
v_mfma_f32_16x16x32_bf16 a[76:79],v[140:143],v[32:35],a[76:79]
v_exp_f32 v98,v98
v_mfma_f32_16x16x32_bf16 a[28:31],v[140:143],v[28:31],a[28:31]
v_exp_f32 v99,v99
v_mfma_f32_16x16x32_bf16 a[24:27],v[136:139],v[28:31],a[24:27]
v_cvt_pk_bf16_f32 v52,v96,v97
v_cvt_pk_bf16_f32 v53,v98,v99
v_mfma_f32_16x16x32_bf16 v[232:235],v[136:139],v[24:27],v[232:235]
v_exp_f32 v76,v76
v_mfma_f32_16x16x32_bf16 v[236:239],v[140:143],v[24:27],v[236:239]
v_exp_f32 v77,v77
v_mfma_f32_16x16x32_bf16 v[188:191],v[140:143],v[20:23],v[188:191]
v_exp_f32 v78,v78
v_mfma_f32_16x16x32_bf16 v[184:187],v[136:139],v[20:23],v[184:187]
s_waitcnt lgkmcnt(0)
v_exp_f32 v79,v79
v_mfma_f32_16x16x32_bf16 v[192:195],v[112:115],v[20:23],v[192:195]
v_cvt_pk_bf16_f32 v42,v76,v77
v_cvt_pk_bf16_f32 v43,v78,v79
s_waitcnt vmcnt(6)
v_mfma_f32_16x16x32_bf16 v[196:199],v[116:119],v[20:23],v[196:199]
s_barrier
v_mfma_f32_16x16x32_bf16 v[244:247],v[116:119],v[24:27],v[244:247]
ds_read_b128 v[140:143],v1 offset:12416
v_fma_f32 v85,v85,s36,v14
v_mfma_f32_16x16x32_bf16 v[240:243],v[112:115],v[24:27],v[240:243]
ds_read_b128 v[136:139],v0 offset:12416
v_fma_f32 v86,v86,s36,v14
v_mfma_f32_16x16x32_bf16 a[32:35],v[112:115],v[28:31],a[32:35]
ds_read_b128 v[132:135],v1 offset:12288
v_fma_f32 v87,v87,s36,v14
v_mfma_f32_16x16x32_bf16 a[36:39],v[116:119],v[28:31],a[36:39]
ds_read_b128 v[128:131],v0 offset:12288
v_fma_f32 v92,v92,s36,v15
v_mfma_f32_16x16x32_bf16 a[84:87],v[116:119],v[32:35],a[84:87]
ds_read_b128 v[116:119],v1 offset:12544
v_fma_f32 v93,v93,s36,v15
v_mfma_f32_16x16x32_bf16 a[80:83],v[112:115],v[32:35],a[80:83]
buffer_load_dwordx4 v6,s[8:11],s21 offen offset:0 lds
v_mfma_f32_16x16x32_bf16 a[88:91],v[120:123],v[32:35],a[88:91]
ds_read_b128 v[112:115],v0 offset:12544
v_fma_f32 v94,v94,s36,v15
v_mfma_f32_16x16x32_bf16 a[92:95],v[124:127],v[32:35],a[92:95]
ds_read_b128 v[156:159],v10 offset:0
v_fma_f32 v95,v95,s36,v15
v_mfma_f32_16x16x32_bf16 a[44:47],v[124:127],v[28:31],a[44:47]
v_exp_f32 v84,v84
v_mfma_f32_16x16x32_bf16 a[40:43],v[120:123],v[28:31],a[40:43]
v_exp_f32 v85,v85
v_mfma_f32_16x16x32_bf16 v[248:251],v[120:123],v[24:27],v[248:251]
v_exp_f32 v86,v86
v_mfma_f32_16x16x32_bf16 v[252:255],v[124:127],v[24:27],v[252:255]
v_exp_f32 v87,v87
v_mfma_f32_16x16x32_bf16 v[204:207],v[124:127],v[20:23],v[204:207]
ds_read_b128 v[124:127],v1 offset:18432
v_cvt_pk_bf16_f32 v46,v84,v85
v_mfma_f32_16x16x32_bf16 v[200:203],v[120:123],v[20:23],v[200:203]
s_waitcnt lgkmcnt(3)
ds_read_b128 v[120:123],v0 offset:18432
v_cvt_pk_bf16_f32 v47,v86,v87
v_mfma_f32_16x16x32_bf16 v[72:75],v[116:119],a[164:167],0
v_exp_f32 v92,v92
v_smfmac_f32_16x16x64_bf16 v[60:63],v[152:155],v[40:47],v18
s_waitcnt lgkmcnt(2)
v_fma_f32 v100,v100,s36,v16
v_mfma_f32_16x16x32_bf16 v[72:75],v[112:115],a[160:163],v[72:75]
buffer_store_dwordx4 v[156:159],v9,s[16:19],s27 offen offset:0 nt
buffer_load_dwordx4 v7,s[8:11],s21 offen offset:1024 lds
v_mfma_f32_16x16x32_bf16 v[72:75],v[140:143],a[156:159],v[72:75]
ds_read_b128 v[156:159],v10 offset:1024
v_fma_f32 v101,v101,s36,v16
v_mfma_f32_16x16x32_bf16 v[72:75],v[136:139],a[152:155],v[72:75]
v_exp_f32 v93,v93
v_mfma_f32_16x16x32_bf16 v[72:75],v[132:135],a[148:151],v[72:75]
v_exp_f32 v94,v94
v_mfma_f32_16x16x32_bf16 v[72:75],v[128:131],a[144:147],v[72:75]
v_exp_f32 v95,v95
v_mfma_f32_16x16x32_bf16 v[80:83],v[128:131],a[168:171],0
v_cvt_pk_bf16_f32 v50,v92,v93
v_cvt_pk_bf16_f32 v51,v94,v95
v_mfma_f32_16x16x32_bf16 v[80:83],v[132:135],a[172:175],v[80:83]
buffer_load_dwordx4 v8,s[8:11],s21 offen offset:2048 lds
v_mfma_f32_16x16x32_bf16 v[80:83],v[136:139],a[176:179],v[80:83]
s_add_u32 s21,s21,12288
v_fma_f32 v102,v102,s36,v16
v_fma_f32 v103,v103,s36,v16
v_mfma_f32_16x16x32_bf16 v[80:83],v[140:143],a[180:183],v[80:83]
s_add_u32 m0,s22,0
v_exp_f32 v100,v100
v_mfma_f32_16x16x32_bf16 v[80:83],v[112:115],a[184:187],v[80:83]
v_exp_f32 v101,v101
v_mfma_f32_16x16x32_bf16 v[80:83],v[116:119],a[188:191],v[80:83]
v_exp_f32 v102,v102
v_mfma_f32_16x16x32_bf16 v[88:91],v[116:119],a[212:215],0
v_exp_f32 v103,v103
v_mfma_f32_16x16x32_bf16 v[88:91],v[112:115],a[208:211],v[88:91]
v_cvt_pk_bf16_f32 v54,v100,v101
v_cvt_pk_bf16_f32 v55,v102,v103
v_mfma_f32_16x16x32_bf16 v[88:91],v[140:143],a[204:207],v[88:91]
v_fma_f32 v72,v72,s36,v13
v_fma_f32 v73,v73,s36,v13
v_smfmac_f32_16x16x64_bf16 v[64:67],v[152:155],v[48:55],v18
v_fma_f32 v74,v74,s36,v13
v_mfma_f32_16x16x32_bf16 v[88:91],v[136:139],a[200:203],v[88:91]
s_waitcnt lgkmcnt(0)
buffer_store_dwordx4 v[156:159],v9,s[16:19],s27 offen offset:128 nt
buffer_load_dwordx4 v6,s[4:7],s20 offen offset:0 lds
v_mfma_f32_16x16x32_bf16 v[88:91],v[132:135],a[196:199],v[88:91]
ds_read_b128 v[156:159],v10 offset:2048
v_mfma_f32_16x16x32_bf16 v[88:91],v[128:131],a[192:195],v[88:91]
v_fma_f32 v75,v75,s36,v13
v_fma_f32 v80,v80,s36,v14
v_mfma_f32_16x16x32_bf16 v[96:99],v[128:131],a[216:219],0
ds_read_b128 v[128:131],v0 offset:18560
v_fma_f32 v81,v81,s36,v14
v_mfma_f32_16x16x32_bf16 v[96:99],v[132:135],a[220:223],v[96:99]
ds_read_b128 v[132:135],v1 offset:18560
v_mfma_f32_16x16x32_bf16 v[96:99],v[136:139],a[224:227],v[96:99]
ds_read_b128 v[136:139],v0 offset:18688
v_mfma_f32_16x16x32_bf16 v[96:99],v[140:143],a[228:231],v[96:99]
ds_read_b128 v[140:143],v1 offset:18688
v_mfma_f32_16x16x32_bf16 v[96:99],v[112:115],a[232:235],v[96:99]
v_exp_f32 v72,v72
v_mfma_f32_16x16x32_bf16 v[96:99],v[116:119],a[236:239],v[96:99]
buffer_load_dwordx4 v7,s[4:7],s20 offen offset:1024 lds
v_mfma_f32_16x16x32_bf16 v[76:79],v[120:123],a[144:147],0
v_exp_f32 v73,v73
v_mfma_f32_16x16x32_bf16 v[76:79],v[124:127],a[148:151],v[76:79]
s_waitcnt lgkmcnt(3)
v_exp_f32 v74,v74
v_exp_f32 v75,v75
v_cvt_pk_bf16_f32 v20,v72,v73
v_mfma_f32_16x16x32_bf16 v[76:79],v[128:131],a[152:155],v[76:79]
s_waitcnt lgkmcnt(2)
v_exp_f32 v80,v80
v_mfma_f32_16x16x32_bf16 v[76:79],v[132:135],a[156:159],v[76:79]
s_waitcnt lgkmcnt(1)
v_exp_f32 v81,v81
v_mfma_f32_16x16x32_bf16 v[76:79],v[136:139],a[160:163],v[76:79]
s_waitcnt lgkmcnt(0)
v_cvt_pk_bf16_f32 v21,v74,v75
v_cvt_pk_bf16_f32 v24,v80,v81
v_mfma_f32_16x16x32_bf16 v[76:79],v[140:143],a[164:167],v[76:79]
v_mfma_f32_16x16x32_bf16 v[84:87],v[140:143],a[188:191],0
v_mfma_f32_16x16x32_bf16 v[84:87],v[136:139],a[184:187],v[84:87]
buffer_store_dwordx4 v[156:159],v9,s[16:19],s27 offen offset:256 nt
buffer_load_dwordx4 v8,s[4:7],s20 offen offset:2048 lds
v_mfma_f32_16x16x32_bf16 v[84:87],v[132:135],a[180:183],v[84:87]
s_add_u32 s20,s20,12288
v_mfma_f32_16x16x32_bf16 v[84:87],v[128:131],a[176:179],v[84:87]
s_add_u32 s27,s27,3072
ds_read_b64_tr_b16 v[112:113],v2 offset:0
v_mfma_f32_16x16x32_bf16 v[84:87],v[124:127],a[172:175],v[84:87]
ds_read_b64_tr_b16 v[114:115],v2 offset:6144
v_mfma_f32_16x16x32_bf16 v[84:87],v[120:123],a[168:171],v[84:87]
ds_read_b64_tr_b16 v[116:117],v3 offset:0
v_mfma_f32_16x16x32_bf16 v[92:95],v[120:123],a[192:195],0
ds_read_b64_tr_b16 v[118:119],v3 offset:6144
v_mfma_f32_16x16x32_bf16 v[92:95],v[124:127],a[196:199],v[92:95]
v_mfma_f32_16x16x32_bf16 v[92:95],v[128:131],a[200:203],v[92:95]
v_mfma_f32_16x16x32_bf16 v[92:95],v[132:135],a[204:207],v[92:95]
v_mfma_f32_16x16x32_bf16 v[92:95],v[136:139],a[208:211],v[92:95]
v_mfma_f32_16x16x32_bf16 v[92:95],v[140:143],a[212:215],v[92:95]
v_mfma_f32_16x16x32_bf16 v[100:103],v[140:143],a[236:239],0
v_mfma_f32_16x16x32_bf16 v[100:103],v[136:139],a[232:235],v[100:103]
v_mfma_f32_16x16x32_bf16 v[100:103],v[132:135],a[228:231],v[100:103]
v_mfma_f32_16x16x32_bf16 v[100:103],v[128:131],a[224:227],v[100:103]
v_mfma_f32_16x16x32_bf16 v[100:103],v[124:127],a[220:223],v[100:103]
ds_read_b64_tr_b16 v[124:125],v5 offset:0
v_mfma_f32_16x16x32_bf16 v[100:103],v[120:123],a[216:219],v[100:103]
s_waitcnt lgkmcnt(1)
ds_read_b64_tr_b16 v[120:121],v4 offset:0
ds_read_b64_tr_b16 v[122:123],v4 offset:6144
ds_read_b64_tr_b16 v[126:127],v5 offset:6144
v_mfma_f32_16x16x32_bf16 v[160:163],v[112:115],v[40:43],v[160:163]
s_add_u32 m0,s29,0
ds_read_b64_tr_b16 v[132:133],v3 offset:128
v_fma_f32 v82,v82,s36,v14
v_mfma_f32_16x16x32_bf16 v[164:167],v[116:119],v[40:43],v[164:167]
ds_read_b64_tr_b16 v[128:129],v2 offset:128
v_fma_f32 v83,v83,s36,v14
v_mfma_f32_16x16x32_bf16 v[212:215],v[116:119],v[44:47],v[212:215]
ds_read_b64_tr_b16 v[134:135],v3 offset:6272
v_fma_f32 v89,v89,s36,v15
v_mfma_f32_16x16x32_bf16 v[208:211],v[112:115],v[44:47],v[208:211]
ds_read_b64_tr_b16 v[130:131],v2 offset:6272
v_fma_f32 v90,v90,s36,v15
v_mfma_f32_16x16x32_bf16 a[0:3],v[112:115],v[48:51],a[0:3]
ds_read_b64_tr_b16 v[136:137],v4 offset:128
v_fma_f32 v91,v91,s36,v15
v_mfma_f32_16x16x32_bf16 a[4:7],v[116:119],v[48:51],a[4:7]
ds_read_b64_tr_b16 v[138:139],v4 offset:6272
v_fma_f32 v88,v88,s36,v15
v_mfma_f32_16x16x32_bf16 a[52:55],v[116:119],v[52:55],a[52:55]
buffer_load_dwordx4 v6,s[12:15],s28 offen offset:0 nt lds
v_mfma_f32_16x16x32_bf16 a[48:51],v[112:115],v[52:55],a[48:51]
s_waitcnt lgkmcnt(6)
ds_read_b64_tr_b16 v[140:141],v5 offset:128
v_fma_f32 v96,v96,s36,v16
v_mfma_f32_16x16x32_bf16 a[56:59],v[120:123],v[52:55],a[56:59]
ds_read_b64_tr_b16 v[142:143],v5 offset:6272
v_fma_f32 v99,v99,s36,v16
v_mfma_f32_16x16x32_bf16 a[60:63],v[124:127],v[52:55],a[60:63]
ds_read_b64_tr_b16 v[112:113],v2 offset:256
v_fma_f32 v98,v98,s36,v16
v_mfma_f32_16x16x32_bf16 a[12:15],v[124:127],v[48:51],a[12:15]
ds_read_b64_tr_b16 v[114:115],v2 offset:6400
v_fma_f32 v97,v97,s36,v16
v_mfma_f32_16x16x32_bf16 a[8:11],v[120:123],v[48:51],a[8:11]
ds_read_b64_tr_b16 v[116:117],v3 offset:256
v_fma_f32 v76,v76,s36,v13
v_mfma_f32_16x16x32_bf16 v[216:219],v[120:123],v[44:47],v[216:219]
ds_read_b64_tr_b16 v[118:119],v3 offset:6400
v_fma_f32 v78,v78,s36,v13
v_mfma_f32_16x16x32_bf16 v[220:223],v[124:127],v[44:47],v[220:223]
buffer_load_dwordx4 v7,s[12:15],s28 offen offset:1024 nt lds
v_mfma_f32_16x16x32_bf16 v[172:175],v[124:127],v[40:43],v[172:175]
ds_read_b64_tr_b16 v[126:127],v5 offset:6400
v_fma_f32 v77,v77,s36,v13
v_mfma_f32_16x16x32_bf16 v[168:171],v[120:123],v[40:43],v[168:171]
s_waitcnt lgkmcnt(6)
ds_read_b64_tr_b16 v[122:123],v4 offset:6400
v_fma_f32 v79,v79,s36,v13
v_mfma_f32_16x16x32_bf16 v[176:179],v[128:131],v[40:43],v[176:179]
ds_read_b64_tr_b16 v[120:121],v4 offset:256
v_fma_f32 v87,v87,s36,v14
v_mfma_f32_16x16x32_bf16 v[180:183],v[132:135],v[40:43],v[180:183]
ds_read_b64_tr_b16 v[124:125],v5 offset:256
v_fma_f32 v86,v86,s36,v14
v_mfma_f32_16x16x32_bf16 v[228:231],v[132:135],v[44:47],v[228:231]
v_exp_f32 v82,v82
v_mfma_f32_16x16x32_bf16 v[224:227],v[128:131],v[44:47],v[224:227]
v_exp_f32 v83,v83
v_mfma_f32_16x16x32_bf16 a[16:19],v[128:131],v[48:51],a[16:19]
v_cvt_pk_bf16_f32 v25,v82,v83
v_fma_f32 v84,v84,s36,v14
v_mfma_f32_16x16x32_bf16 a[20:23],v[132:135],v[48:51],a[20:23]
buffer_load_dwordx4 v8,s[12:15],s28 offen offset:2048 nt lds
v_mfma_f32_16x16x32_bf16 a[68:71],v[132:135],v[52:55],a[68:71]
s_add_u32 s28,s28,3072
v_exp_f32 v90,v90
v_mfma_f32_16x16x32_bf16 a[64:67],v[128:131],v[52:55],a[64:67]
s_add_u32 s29,s29,3072
v_exp_f32 v88,v88
v_mfma_f32_16x16x32_bf16 a[72:75],v[136:139],v[52:55],a[72:75]
s_add_u32 m0,s23,0
v_exp_f32 v91,v91
s_waitcnt lgkmcnt(1)
v_mfma_f32_16x16x32_bf16 a[76:79],v[140:143],v[52:55],a[76:79]
v_exp_f32 v89,v89
v_mfma_f32_16x16x32_bf16 a[28:31],v[140:143],v[48:51],a[28:31]
v_cvt_pk_bf16_f32 v29,v90,v91
v_cvt_pk_bf16_f32 v28,v88,v89
v_mfma_f32_16x16x32_bf16 a[24:27],v[136:139],v[48:51],a[24:27]
v_exp_f32 v99,v99
v_mfma_f32_16x16x32_bf16 v[232:235],v[136:139],v[44:47],v[232:235]
v_exp_f32 v97,v97
v_mfma_f32_16x16x32_bf16 v[236:239],v[140:143],v[44:47],v[236:239]
v_exp_f32 v96,v96
v_mfma_f32_16x16x32_bf16 v[188:191],v[140:143],v[40:43],v[188:191]
v_exp_f32 v98,v98
v_mfma_f32_16x16x32_bf16 v[184:187],v[136:139],v[40:43],v[184:187]
v_cvt_pk_bf16_f32 v33,v98,v99
v_cvt_pk_bf16_f32 v32,v96,v97
s_waitcnt vmcnt(12) lgkmcnt(0)
v_mfma_f32_16x16x32_bf16 v[192:195],v[112:115],v[40:43],v[192:195]
s_barrier
v_mfma_f32_16x16x32_bf16 v[196:199],v[116:119],v[40:43],v[196:199]
ds_read_b128 v[136:139],v0 offset:24704
v_fma_f32 v85,v85,s36,v14
v_mfma_f32_16x16x32_bf16 v[244:247],v[116:119],v[44:47],v[244:247]
ds_read_b128 v[140:143],v1 offset:24704
v_fma_f32 v92,v92,s36,v15
v_mfma_f32_16x16x32_bf16 v[240:243],v[112:115],v[44:47],v[240:243]
ds_read_b128 v[132:135],v1 offset:24576
v_fma_f32 v95,v95,s36,v15
v_mfma_f32_16x16x32_bf16 a[32:35],v[112:115],v[48:51],a[32:35]
ds_read_b128 v[128:131],v0 offset:24576
v_fma_f32 v93,v93,s36,v15
v_mfma_f32_16x16x32_bf16 a[36:39],v[116:119],v[48:51],a[36:39]
v_exp_f32 v77,v77
v_mfma_f32_16x16x32_bf16 a[84:87],v[116:119],v[52:55],a[84:87]
buffer_load_dwordx4 v6,s[8:11],s21 offen offset:0 lds
v_mfma_f32_16x16x32_bf16 a[80:83],v[112:115],v[52:55],a[80:83]
ds_read_b128 v[116:119],v1 offset:24832
v_fma_f32 v94,v94,s36,v15
v_mfma_f32_16x16x32_bf16 a[88:91],v[120:123],v[52:55],a[88:91]
ds_read_b128 v[112:115],v0 offset:24832
v_fma_f32 v102,v102,s36,v16
v_mfma_f32_16x16x32_bf16 a[92:95],v[124:127],v[52:55],a[92:95]
v_exp_f32 v78,v78
v_mfma_f32_16x16x32_bf16 a[44:47],v[124:127],v[48:51],a[44:47]
v_exp_f32 v76,v76
v_mfma_f32_16x16x32_bf16 a[40:43],v[120:123],v[48:51],a[40:43]
v_cvt_pk_bf16_f32 v22,v76,v77
v_fma_f32 v101,v101,s36,v16
v_mfma_f32_16x16x32_bf16 v[248:251],v[120:123],v[44:47],v[248:251]
v_exp_f32 v79,v79
v_mfma_f32_16x16x32_bf16 v[252:255],v[124:127],v[44:47],v[252:255]
v_cvt_pk_bf16_f32 v23,v78,v79
v_fma_f32 v103,v103,s36,v16
v_mfma_f32_16x16x32_bf16 v[204:207],v[124:127],v[40:43],v[204:207]
ds_read_b128 v[124:127],v1 offset:30720
v_fma_f32 v100,v100,s36,v16
v_mfma_f32_16x16x32_bf16 v[200:203],v[120:123],v[40:43],v[200:203]
buffer_load_dwordx4 v7,s[8:11],s21 offen offset:1024 lds
s_waitcnt lgkmcnt(2)
v_mfma_f32_16x16x32_bf16 v[72:75],v[116:119],a[164:167],0
s_waitcnt lgkmcnt(1)
ds_read_b128 v[120:123],v0 offset:30720
v_mfma_f32_16x16x32_bf16 v[72:75],v[112:115],a[160:163],v[72:75]
v_exp_f32 v84,v84
v_mfma_f32_16x16x32_bf16 v[72:75],v[140:143],a[156:159],v[72:75]
v_exp_f32 v86,v86
v_mfma_f32_16x16x32_bf16 v[72:75],v[136:139],a[152:155],v[72:75]
v_exp_f32 v87,v87
v_mfma_f32_16x16x32_bf16 v[72:75],v[132:135],a[148:151],v[72:75]
v_exp_f32 v85,v85
v_mfma_f32_16x16x32_bf16 v[72:75],v[128:131],a[144:147],v[72:75]
v_cvt_pk_bf16_f32 v26,v84,v85
v_cvt_pk_bf16_f32 v27,v86,v87
v_mfma_f32_16x16x32_bf16 v[80:83],v[128:131],a[168:171],0
v_exp_f32 v95,v95
v_smfmac_f32_16x16x64_bf16 v[60:63],v[152:155],v[20:27],v18
v_mfma_f32_16x16x32_bf16 v[80:83],v[132:135],a[172:175],v[80:83]
buffer_load_dwordx4 v8,s[8:11],s21 offen offset:2048 lds
v_mfma_f32_16x16x32_bf16 v[80:83],v[136:139],a[176:179],v[80:83]
s_add_u32 s21,s21,12288
v_exp_f32 v94,v94
v_mfma_f32_16x16x32_bf16 v[80:83],v[140:143],a[180:183],v[80:83]
s_add_u32 m0,s22,12288
v_cvt_pk_bf16_f32 v31,v94,v95
v_fma_f32 v74,v74,s36,v13
v_mfma_f32_16x16x32_bf16 v[80:83],v[112:115],a[184:187],v[80:83]
v_exp_f32 v93,v93
v_mfma_f32_16x16x32_bf16 v[80:83],v[116:119],a[188:191],v[80:83]
v_exp_f32 v92,v92
v_mfma_f32_16x16x32_bf16 v[88:91],v[116:119],a[212:215],0
v_cvt_pk_bf16_f32 v30,v92,v93
v_fma_f32 v72,v72,s36,v13
v_mfma_f32_16x16x32_bf16 v[88:91],v[112:115],a[208:211],v[88:91]
v_exp_f32 v100,v100
v_mfma_f32_16x16x32_bf16 v[88:91],v[140:143],a[204:207],v[88:91]
v_exp_f32 v103,v103
v_mfma_f32_16x16x32_bf16 v[88:91],v[136:139],a[200:203],v[88:91]
v_exp_f32 v102,v102
v_mfma_f32_16x16x32_bf16 v[88:91],v[132:135],a[196:199],v[88:91]
buffer_load_dwordx4 v6,s[4:7],s20 offen offset:0 lds
v_mfma_f32_16x16x32_bf16 v[88:91],v[128:131],a[192:195],v[88:91]
v_exp_f32 v101,v101
v_mfma_f32_16x16x32_bf16 v[96:99],v[128:131],a[216:219],0
ds_read_b128 v[128:131],v0 offset:30848
v_cvt_pk_bf16_f32 v34,v100,v101
v_mfma_f32_16x16x32_bf16 v[96:99],v[132:135],a[220:223],v[96:99]
ds_read_b128 v[132:135],v1 offset:30848
v_cvt_pk_bf16_f32 v35,v102,v103
v_mfma_f32_16x16x32_bf16 v[96:99],v[136:139],a[224:227],v[96:99]
ds_read_b128 v[136:139],v0 offset:30976
v_fma_f32 v80,v80,s36,v14
v_smfmac_f32_16x16x64_bf16 v[64:67],v[152:155],v[28:35],v18
v_fma_f32 v81,v81,s36,v14
v_mfma_f32_16x16x32_bf16 v[96:99],v[140:143],a[228:231],v[96:99]
ds_read_b128 v[140:143],v1 offset:30976
v_fma_f32 v75,v75,s36,v13
v_mfma_f32_16x16x32_bf16 v[96:99],v[112:115],a[232:235],v[96:99]
v_exp_f32 v74,v74
v_mfma_f32_16x16x32_bf16 v[96:99],v[116:119],a[236:239],v[96:99]
s_waitcnt lgkmcnt(4)
v_exp_f32 v80,v80
v_mfma_f32_16x16x32_bf16 v[76:79],v[120:123],a[144:147],0
buffer_load_dwordx4 v7,s[4:7],s20 offen offset:1024 lds
v_mfma_f32_16x16x32_bf16 v[76:79],v[124:127],a[148:151],v[76:79]
s_waitcnt lgkmcnt(3)
v_exp_f32 v81,v81
v_mfma_f32_16x16x32_bf16 v[76:79],v[128:131],a[152:155],v[76:79]
s_waitcnt lgkmcnt(2)
v_fma_f32 v73,v73,s36,v13
v_cvt_pk_bf16_f32 v44,v80,v81
v_mfma_f32_16x16x32_bf16 v[76:79],v[132:135],a[156:159],v[76:79]
s_waitcnt lgkmcnt(1)
v_exp_f32 v75,v75
v_mfma_f32_16x16x32_bf16 v[76:79],v[136:139],a[160:163],v[76:79]
s_waitcnt lgkmcnt(0)
v_cvt_pk_bf16_f32 v41,v74,v75
v_exp_f32 v73,v73
v_exp_f32 v72,v72
v_mfma_f32_16x16x32_bf16 v[76:79],v[140:143],a[164:167],v[76:79]
v_cvt_pk_bf16_f32 v40,v72,v73
v_mfma_f32_16x16x32_bf16 v[84:87],v[140:143],a[188:191],0
v_mfma_f32_16x16x32_bf16 v[84:87],v[136:139],a[184:187],v[84:87]
v_mfma_f32_16x16x32_bf16 v[84:87],v[132:135],a[180:183],v[84:87]
buffer_load_dwordx4 v8,s[4:7],s20 offen offset:2048 lds
v_mfma_f32_16x16x32_bf16 v[84:87],v[128:131],a[176:179],v[84:87]
s_add_u32 s20,s20,12288
ds_read_b64_tr_b16 v[114:115],v2 offset:18432
v_mfma_f32_16x16x32_bf16 v[84:87],v[124:127],a[172:175],v[84:87]
ds_read_b64_tr_b16 v[112:113],v2 offset:12288
v_mfma_f32_16x16x32_bf16 v[84:87],v[120:123],a[168:171],v[84:87]
ds_read_b64_tr_b16 v[118:119],v3 offset:18432
v_mfma_f32_16x16x32_bf16 v[92:95],v[120:123],a[192:195],0
ds_read_b64_tr_b16 v[116:117],v3 offset:12288
v_mfma_f32_16x16x32_bf16 v[92:95],v[124:127],a[196:199],v[92:95]
v_mfma_f32_16x16x32_bf16 v[92:95],v[128:131],a[200:203],v[92:95]
v_mfma_f32_16x16x32_bf16 v[92:95],v[132:135],a[204:207],v[92:95]
v_mfma_f32_16x16x32_bf16 v[92:95],v[136:139],a[208:211],v[92:95]
v_mfma_f32_16x16x32_bf16 v[92:95],v[140:143],a[212:215],v[92:95]
v_mfma_f32_16x16x32_bf16 v[100:103],v[140:143],a[236:239],0
v_mfma_f32_16x16x32_bf16 v[100:103],v[136:139],a[232:235],v[100:103]
v_mfma_f32_16x16x32_bf16 v[100:103],v[132:135],a[228:231],v[100:103]
v_mfma_f32_16x16x32_bf16 v[100:103],v[128:131],a[224:227],v[100:103]
v_mfma_f32_16x16x32_bf16 v[100:103],v[124:127],a[220:223],v[100:103]
ds_read_b64_tr_b16 v[124:125],v5 offset:12288
v_mfma_f32_16x16x32_bf16 v[100:103],v[120:123],a[216:219],v[100:103]
s_waitcnt lgkmcnt(1)
ds_read_b64_tr_b16 v[122:123],v4 offset:18432
ds_read_b64_tr_b16 v[120:121],v4 offset:12288
ds_read_b64_tr_b16 v[126:127],v5 offset:18432
v_mfma_f32_16x16x32_bf16 v[160:163],v[112:115],v[20:23],v[160:163]
s_add_u32 m0,s23,12288
ds_read_b64_tr_b16 v[128:129],v2 offset:12416
v_fma_f32 v82,v82,s36,v14
v_mfma_f32_16x16x32_bf16 v[164:167],v[116:119],v[20:23],v[164:167]
ds_read_b64_tr_b16 v[130:131],v2 offset:18560
v_fma_f32 v83,v83,s36,v14
v_mfma_f32_16x16x32_bf16 v[212:215],v[116:119],v[24:27],v[212:215]
ds_read_b64_tr_b16 v[132:133],v3 offset:12416
v_fma_f32 v88,v88,s36,v15
v_mfma_f32_16x16x32_bf16 v[208:211],v[112:115],v[24:27],v[208:211]
ds_read_b64_tr_b16 v[134:135],v3 offset:18560
v_fma_f32 v89,v89,s36,v15
v_mfma_f32_16x16x32_bf16 a[0:3],v[112:115],v[28:31],a[0:3]
ds_read_b64_tr_b16 v[136:137],v4 offset:12416
v_fma_f32 v90,v90,s36,v15
v_mfma_f32_16x16x32_bf16 a[4:7],v[116:119],v[28:31],a[4:7]
ds_read_b64_tr_b16 v[138:139],v4 offset:18560
v_fma_f32 v91,v91,s36,v15
v_mfma_f32_16x16x32_bf16 a[52:55],v[116:119],v[32:35],a[52:55]
ds_read_b64_tr_b16 v[140:141],v5 offset:12416
v_fma_f32 v96,v96,s36,v16
v_mfma_f32_16x16x32_bf16 a[48:51],v[112:115],v[32:35],a[48:51]
s_waitcnt lgkmcnt(8)
ds_read_b64_tr_b16 v[142:143],v5 offset:18560
v_fma_f32 v97,v97,s36,v16
v_mfma_f32_16x16x32_bf16 a[56:59],v[120:123],v[32:35],a[56:59]
s_waitcnt lgkmcnt(7)
ds_read_b64_tr_b16 v[112:113],v2 offset:12544
v_fma_f32 v98,v98,s36,v16
v_mfma_f32_16x16x32_bf16 a[60:63],v[124:127],v[32:35],a[60:63]
ds_read_b64_tr_b16 v[114:115],v2 offset:18688
v_fma_f32 v99,v99,s36,v16
v_mfma_f32_16x16x32_bf16 a[12:15],v[124:127],v[28:31],a[12:15]
ds_read_b64_tr_b16 v[116:117],v3 offset:12544
v_fma_f32 v76,v76,s36,v13
v_mfma_f32_16x16x32_bf16 a[8:11],v[120:123],v[28:31],a[8:11]
ds_read_b64_tr_b16 v[118:119],v3 offset:18688
v_fma_f32 v77,v77,s36,v13
v_mfma_f32_16x16x32_bf16 v[216:219],v[120:123],v[24:27],v[216:219]
v_exp_f32 v82,v82
v_mfma_f32_16x16x32_bf16 v[220:223],v[124:127],v[24:27],v[220:223]
v_exp_f32 v83,v83
v_mfma_f32_16x16x32_bf16 v[172:175],v[124:127],v[20:23],v[172:175]
ds_read_b64_tr_b16 v[124:125],v5 offset:12544
v_cvt_pk_bf16_f32 v45,v82,v83
v_mfma_f32_16x16x32_bf16 v[168:171],v[120:123],v[20:23],v[168:171]
s_waitcnt lgkmcnt(5)
ds_read_b64_tr_b16 v[120:121],v4 offset:12544
v_fma_f32 v78,v78,s36,v13
v_mfma_f32_16x16x32_bf16 v[176:179],v[128:131],v[20:23],v[176:179]
ds_read_b64_tr_b16 v[122:123],v4 offset:18688
v_fma_f32 v79,v79,s36,v13
v_mfma_f32_16x16x32_bf16 v[180:183],v[132:135],v[20:23],v[180:183]
ds_read_b64_tr_b16 v[126:127],v5 offset:18688
v_fma_f32 v84,v84,s36,v14
v_mfma_f32_16x16x32_bf16 v[228:231],v[132:135],v[24:27],v[228:231]
v_exp_f32 v88,v88
v_mfma_f32_16x16x32_bf16 v[224:227],v[128:131],v[24:27],v[224:227]
v_exp_f32 v89,v89
v_mfma_f32_16x16x32_bf16 a[16:19],v[128:131],v[28:31],a[16:19]
v_exp_f32 v90,v90
v_mfma_f32_16x16x32_bf16 a[20:23],v[132:135],v[28:31],a[20:23]
v_exp_f32 v91,v91
v_mfma_f32_16x16x32_bf16 a[68:71],v[132:135],v[32:35],a[68:71]
v_cvt_pk_bf16_f32 v48,v88,v89
v_cvt_pk_bf16_f32 v49,v90,v91
v_mfma_f32_16x16x32_bf16 a[64:67],v[128:131],v[32:35],a[64:67]
v_exp_f32 v96,v96
v_mfma_f32_16x16x32_bf16 a[72:75],v[136:139],v[32:35],a[72:75]
v_exp_f32 v97,v97
v_mfma_f32_16x16x32_bf16 a[76:79],v[140:143],v[32:35],a[76:79]
v_exp_f32 v98,v98
v_mfma_f32_16x16x32_bf16 a[28:31],v[140:143],v[28:31],a[28:31]
v_exp_f32 v99,v99
v_mfma_f32_16x16x32_bf16 a[24:27],v[136:139],v[28:31],a[24:27]
v_cvt_pk_bf16_f32 v52,v96,v97
v_cvt_pk_bf16_f32 v53,v98,v99
v_mfma_f32_16x16x32_bf16 v[232:235],v[136:139],v[24:27],v[232:235]
v_exp_f32 v76,v76
v_mfma_f32_16x16x32_bf16 v[236:239],v[140:143],v[24:27],v[236:239]
v_exp_f32 v77,v77
v_mfma_f32_16x16x32_bf16 v[188:191],v[140:143],v[20:23],v[188:191]
v_exp_f32 v78,v78
v_mfma_f32_16x16x32_bf16 v[184:187],v[136:139],v[20:23],v[184:187]
s_waitcnt lgkmcnt(0)
v_exp_f32 v79,v79
v_mfma_f32_16x16x32_bf16 v[192:195],v[112:115],v[20:23],v[192:195]
v_cvt_pk_bf16_f32 v42,v76,v77
v_cvt_pk_bf16_f32 v43,v78,v79
s_waitcnt vmcnt(9)
v_mfma_f32_16x16x32_bf16 v[196:199],v[116:119],v[20:23],v[196:199]
s_barrier
v_mfma_f32_16x16x32_bf16 v[244:247],v[116:119],v[24:27],v[244:247]
ds_read_b128 v[140:143],v1 offset:128
v_fma_f32 v85,v85,s36,v14
v_mfma_f32_16x16x32_bf16 v[240:243],v[112:115],v[24:27],v[240:243]
ds_read_b128 v[136:139],v0 offset:128
v_fma_f32 v86,v86,s36,v14
v_mfma_f32_16x16x32_bf16 a[32:35],v[112:115],v[28:31],a[32:35]
ds_read_b128 v[132:135],v1 offset:0
v_fma_f32 v87,v87,s36,v14
v_mfma_f32_16x16x32_bf16 a[36:39],v[116:119],v[28:31],a[36:39]
ds_read_b128 v[128:131],v0 offset:0
v_fma_f32 v92,v92,s36,v15
v_mfma_f32_16x16x32_bf16 a[84:87],v[116:119],v[32:35],a[84:87]
ds_read_b128 v[116:119],v1 offset:256
v_fma_f32 v93,v93,s36,v15
v_mfma_f32_16x16x32_bf16 a[80:83],v[112:115],v[32:35],a[80:83]
buffer_load_dwordx4 v6,s[8:11],s21 offen offset:0 lds
v_mfma_f32_16x16x32_bf16 a[88:91],v[120:123],v[32:35],a[88:91]
ds_read_b128 v[112:115],v0 offset:256
v_fma_f32 v94,v94,s36,v15
v_mfma_f32_16x16x32_bf16 a[92:95],v[124:127],v[32:35],a[92:95]
ds_read_b128 v[156:159],v10 offset:3072
v_fma_f32 v95,v95,s36,v15
v_mfma_f32_16x16x32_bf16 a[44:47],v[124:127],v[28:31],a[44:47]
v_exp_f32 v84,v84
v_mfma_f32_16x16x32_bf16 a[40:43],v[120:123],v[28:31],a[40:43]
v_exp_f32 v85,v85
v_mfma_f32_16x16x32_bf16 v[248:251],v[120:123],v[24:27],v[248:251]
v_exp_f32 v86,v86
v_mfma_f32_16x16x32_bf16 v[252:255],v[124:127],v[24:27],v[252:255]
v_exp_f32 v87,v87
v_mfma_f32_16x16x32_bf16 v[204:207],v[124:127],v[20:23],v[204:207]
ds_read_b128 v[124:127],v1 offset:6144
v_cvt_pk_bf16_f32 v46,v84,v85
v_mfma_f32_16x16x32_bf16 v[200:203],v[120:123],v[20:23],v[200:203]
s_waitcnt lgkmcnt(3)
ds_read_b128 v[120:123],v0 offset:6144
v_cvt_pk_bf16_f32 v47,v86,v87
v_mfma_f32_16x16x32_bf16 v[72:75],v[116:119],a[164:167],0
v_exp_f32 v92,v92
v_smfmac_f32_16x16x64_bf16 v[60:63],v[152:155],v[40:47],v18
s_waitcnt lgkmcnt(2)
v_fma_f32 v100,v100,s36,v16
v_mfma_f32_16x16x32_bf16 v[72:75],v[112:115],a[160:163],v[72:75]
buffer_store_dwordx4 v[156:159],v9,s[16:19],s27 offen offset:0 nt
buffer_load_dwordx4 v7,s[8:11],s21 offen offset:1024 lds
v_mfma_f32_16x16x32_bf16 v[72:75],v[140:143],a[156:159],v[72:75]
ds_read_b128 v[156:159],v10 offset:4096
v_fma_f32 v101,v101,s36,v16
v_mfma_f32_16x16x32_bf16 v[72:75],v[136:139],a[152:155],v[72:75]
v_exp_f32 v93,v93
v_mfma_f32_16x16x32_bf16 v[72:75],v[132:135],a[148:151],v[72:75]
v_exp_f32 v94,v94
v_mfma_f32_16x16x32_bf16 v[72:75],v[128:131],a[144:147],v[72:75]
v_exp_f32 v95,v95
v_mfma_f32_16x16x32_bf16 v[80:83],v[128:131],a[168:171],0
v_cvt_pk_bf16_f32 v50,v92,v93
v_cvt_pk_bf16_f32 v51,v94,v95
v_mfma_f32_16x16x32_bf16 v[80:83],v[132:135],a[172:175],v[80:83]
buffer_load_dwordx4 v8,s[8:11],s21 offen offset:2048 lds
v_mfma_f32_16x16x32_bf16 v[80:83],v[136:139],a[176:179],v[80:83]
s_add_u32 s21,s21,12288
v_fma_f32 v102,v102,s36,v16
v_fma_f32 v103,v103,s36,v16
v_mfma_f32_16x16x32_bf16 v[80:83],v[140:143],a[180:183],v[80:83]
s_add_u32 m0,s22,24576
v_exp_f32 v100,v100
v_mfma_f32_16x16x32_bf16 v[80:83],v[112:115],a[184:187],v[80:83]
v_exp_f32 v101,v101
v_mfma_f32_16x16x32_bf16 v[80:83],v[116:119],a[188:191],v[80:83]
v_exp_f32 v102,v102
v_mfma_f32_16x16x32_bf16 v[88:91],v[116:119],a[212:215],0
v_exp_f32 v103,v103
v_mfma_f32_16x16x32_bf16 v[88:91],v[112:115],a[208:211],v[88:91]
v_cvt_pk_bf16_f32 v54,v100,v101
v_cvt_pk_bf16_f32 v55,v102,v103
v_mfma_f32_16x16x32_bf16 v[88:91],v[140:143],a[204:207],v[88:91]
v_fma_f32 v72,v72,s36,v13
v_fma_f32 v73,v73,s36,v13
v_smfmac_f32_16x16x64_bf16 v[64:67],v[152:155],v[48:55],v18
v_fma_f32 v74,v74,s36,v13
v_mfma_f32_16x16x32_bf16 v[88:91],v[136:139],a[200:203],v[88:91]
s_waitcnt lgkmcnt(0)
buffer_store_dwordx4 v[156:159],v9,s[16:19],s27 offen offset:128 nt
buffer_load_dwordx4 v6,s[4:7],s20 offen offset:0 lds
v_mfma_f32_16x16x32_bf16 v[88:91],v[132:135],a[196:199],v[88:91]
ds_read_b128 v[156:159],v10 offset:5120
v_mfma_f32_16x16x32_bf16 v[88:91],v[128:131],a[192:195],v[88:91]
v_fma_f32 v75,v75,s36,v13
v_fma_f32 v80,v80,s36,v14
v_mfma_f32_16x16x32_bf16 v[96:99],v[128:131],a[216:219],0
ds_read_b128 v[128:131],v0 offset:6272
v_fma_f32 v81,v81,s36,v14
v_mfma_f32_16x16x32_bf16 v[96:99],v[132:135],a[220:223],v[96:99]
ds_read_b128 v[132:135],v1 offset:6272
v_mfma_f32_16x16x32_bf16 v[96:99],v[136:139],a[224:227],v[96:99]
ds_read_b128 v[136:139],v0 offset:6400
v_mfma_f32_16x16x32_bf16 v[96:99],v[140:143],a[228:231],v[96:99]
ds_read_b128 v[140:143],v1 offset:6400
v_mfma_f32_16x16x32_bf16 v[96:99],v[112:115],a[232:235],v[96:99]
v_exp_f32 v72,v72
v_mfma_f32_16x16x32_bf16 v[96:99],v[116:119],a[236:239],v[96:99]
buffer_load_dwordx4 v7,s[4:7],s20 offen offset:1024 lds
v_mfma_f32_16x16x32_bf16 v[76:79],v[120:123],a[144:147],0
v_exp_f32 v73,v73
v_mfma_f32_16x16x32_bf16 v[76:79],v[124:127],a[148:151],v[76:79]
s_waitcnt lgkmcnt(3)
v_exp_f32 v74,v74
v_exp_f32 v75,v75
v_cvt_pk_bf16_f32 v20,v72,v73
v_mfma_f32_16x16x32_bf16 v[76:79],v[128:131],a[152:155],v[76:79]
s_waitcnt lgkmcnt(2)
v_exp_f32 v80,v80
v_mfma_f32_16x16x32_bf16 v[76:79],v[132:135],a[156:159],v[76:79]
s_waitcnt lgkmcnt(1)
v_exp_f32 v81,v81
v_mfma_f32_16x16x32_bf16 v[76:79],v[136:139],a[160:163],v[76:79]
s_waitcnt lgkmcnt(0)
v_cvt_pk_bf16_f32 v21,v74,v75
v_cvt_pk_bf16_f32 v24,v80,v81
v_mfma_f32_16x16x32_bf16 v[76:79],v[140:143],a[164:167],v[76:79]
v_mfma_f32_16x16x32_bf16 v[84:87],v[140:143],a[188:191],0
v_mfma_f32_16x16x32_bf16 v[84:87],v[136:139],a[184:187],v[84:87]
buffer_store_dwordx4 v[156:159],v9,s[16:19],s27 offen offset:256 nt
buffer_load_dwordx4 v8,s[4:7],s20 offen offset:2048 lds
v_mfma_f32_16x16x32_bf16 v[84:87],v[132:135],a[180:183],v[84:87]
s_add_u32 s20,s20,12288
v_mfma_f32_16x16x32_bf16 v[84:87],v[128:131],a[176:179],v[84:87]
s_add_u32 s27,s27,3072
ds_read_b64_tr_b16 v[112:113],v2 offset:24576
v_mfma_f32_16x16x32_bf16 v[84:87],v[124:127],a[172:175],v[84:87]
ds_read_b64_tr_b16 v[114:115],v2 offset:30720
v_mfma_f32_16x16x32_bf16 v[84:87],v[120:123],a[168:171],v[84:87]
ds_read_b64_tr_b16 v[116:117],v3 offset:24576
v_mfma_f32_16x16x32_bf16 v[92:95],v[120:123],a[192:195],0
ds_read_b64_tr_b16 v[118:119],v3 offset:30720
v_mfma_f32_16x16x32_bf16 v[92:95],v[124:127],a[196:199],v[92:95]
v_mfma_f32_16x16x32_bf16 v[92:95],v[128:131],a[200:203],v[92:95]
v_mfma_f32_16x16x32_bf16 v[92:95],v[132:135],a[204:207],v[92:95]
v_mfma_f32_16x16x32_bf16 v[92:95],v[136:139],a[208:211],v[92:95]
v_mfma_f32_16x16x32_bf16 v[92:95],v[140:143],a[212:215],v[92:95]
v_mfma_f32_16x16x32_bf16 v[100:103],v[140:143],a[236:239],0
v_mfma_f32_16x16x32_bf16 v[100:103],v[136:139],a[232:235],v[100:103]
v_mfma_f32_16x16x32_bf16 v[100:103],v[132:135],a[228:231],v[100:103]
v_mfma_f32_16x16x32_bf16 v[100:103],v[128:131],a[224:227],v[100:103]
v_mfma_f32_16x16x32_bf16 v[100:103],v[124:127],a[220:223],v[100:103]
ds_read_b64_tr_b16 v[124:125],v5 offset:24576
v_mfma_f32_16x16x32_bf16 v[100:103],v[120:123],a[216:219],v[100:103]
s_waitcnt lgkmcnt(1)
ds_read_b64_tr_b16 v[120:121],v4 offset:24576
ds_read_b64_tr_b16 v[122:123],v4 offset:30720
ds_read_b64_tr_b16 v[126:127],v5 offset:30720
v_mfma_f32_16x16x32_bf16 v[160:163],v[112:115],v[40:43],v[160:163]
s_add_u32 m0,s29,0
ds_read_b64_tr_b16 v[132:133],v3 offset:24704
v_fma_f32 v82,v82,s36,v14
v_mfma_f32_16x16x32_bf16 v[164:167],v[116:119],v[40:43],v[164:167]
ds_read_b64_tr_b16 v[128:129],v2 offset:24704
v_fma_f32 v83,v83,s36,v14
v_mfma_f32_16x16x32_bf16 v[212:215],v[116:119],v[44:47],v[212:215]
ds_read_b64_tr_b16 v[134:135],v3 offset:30848
v_fma_f32 v89,v89,s36,v15
v_mfma_f32_16x16x32_bf16 v[208:211],v[112:115],v[44:47],v[208:211]
ds_read_b64_tr_b16 v[130:131],v2 offset:30848
v_fma_f32 v90,v90,s36,v15
v_mfma_f32_16x16x32_bf16 a[0:3],v[112:115],v[48:51],a[0:3]
ds_read_b64_tr_b16 v[136:137],v4 offset:24704
v_fma_f32 v91,v91,s36,v15
v_mfma_f32_16x16x32_bf16 a[4:7],v[116:119],v[48:51],a[4:7]
ds_read_b64_tr_b16 v[138:139],v4 offset:30848
v_fma_f32 v88,v88,s36,v15
v_mfma_f32_16x16x32_bf16 a[52:55],v[116:119],v[52:55],a[52:55]
buffer_load_dwordx4 v6,s[12:15],s28 offen offset:0 nt lds
v_mfma_f32_16x16x32_bf16 a[48:51],v[112:115],v[52:55],a[48:51]
s_waitcnt lgkmcnt(6)
ds_read_b64_tr_b16 v[140:141],v5 offset:24704
v_fma_f32 v96,v96,s36,v16
v_mfma_f32_16x16x32_bf16 a[56:59],v[120:123],v[52:55],a[56:59]
ds_read_b64_tr_b16 v[142:143],v5 offset:30848
v_fma_f32 v99,v99,s36,v16
v_mfma_f32_16x16x32_bf16 a[60:63],v[124:127],v[52:55],a[60:63]
ds_read_b64_tr_b16 v[112:113],v2 offset:24832
v_fma_f32 v98,v98,s36,v16
v_mfma_f32_16x16x32_bf16 a[12:15],v[124:127],v[48:51],a[12:15]
ds_read_b64_tr_b16 v[114:115],v2 offset:30976
v_fma_f32 v97,v97,s36,v16
v_mfma_f32_16x16x32_bf16 a[8:11],v[120:123],v[48:51],a[8:11]
ds_read_b64_tr_b16 v[116:117],v3 offset:24832
v_fma_f32 v76,v76,s36,v13
v_mfma_f32_16x16x32_bf16 v[216:219],v[120:123],v[44:47],v[216:219]
ds_read_b64_tr_b16 v[118:119],v3 offset:30976
v_fma_f32 v78,v78,s36,v13
v_mfma_f32_16x16x32_bf16 v[220:223],v[124:127],v[44:47],v[220:223]
buffer_load_dwordx4 v7,s[12:15],s28 offen offset:1024 nt lds
v_mfma_f32_16x16x32_bf16 v[172:175],v[124:127],v[40:43],v[172:175]
ds_read_b64_tr_b16 v[126:127],v5 offset:30976
v_fma_f32 v77,v77,s36,v13
v_mfma_f32_16x16x32_bf16 v[168:171],v[120:123],v[40:43],v[168:171]
s_waitcnt lgkmcnt(6)
ds_read_b64_tr_b16 v[122:123],v4 offset:30976
v_fma_f32 v79,v79,s36,v13
v_mfma_f32_16x16x32_bf16 v[176:179],v[128:131],v[40:43],v[176:179]
ds_read_b64_tr_b16 v[120:121],v4 offset:24832
v_fma_f32 v87,v87,s36,v14
v_mfma_f32_16x16x32_bf16 v[180:183],v[132:135],v[40:43],v[180:183]
ds_read_b64_tr_b16 v[124:125],v5 offset:24832
v_fma_f32 v86,v86,s36,v14
v_mfma_f32_16x16x32_bf16 v[228:231],v[132:135],v[44:47],v[228:231]
v_exp_f32 v82,v82
v_mfma_f32_16x16x32_bf16 v[224:227],v[128:131],v[44:47],v[224:227]
v_exp_f32 v83,v83
v_mfma_f32_16x16x32_bf16 a[16:19],v[128:131],v[48:51],a[16:19]
v_cvt_pk_bf16_f32 v25,v82,v83
v_fma_f32 v84,v84,s36,v14
v_mfma_f32_16x16x32_bf16 a[20:23],v[132:135],v[48:51],a[20:23]
buffer_load_dwordx4 v8,s[12:15],s28 offen offset:2048 nt lds
v_mfma_f32_16x16x32_bf16 a[68:71],v[132:135],v[52:55],a[68:71]
s_add_u32 s28,s28,3072
v_exp_f32 v90,v90
v_mfma_f32_16x16x32_bf16 a[64:67],v[128:131],v[52:55],a[64:67]
s_add_u32 s29,s29,3072
v_exp_f32 v88,v88
v_mfma_f32_16x16x32_bf16 a[72:75],v[136:139],v[52:55],a[72:75]
s_add_u32 m0,s23,24576
v_exp_f32 v91,v91
s_waitcnt lgkmcnt(1)
v_mfma_f32_16x16x32_bf16 a[76:79],v[140:143],v[52:55],a[76:79]
v_exp_f32 v89,v89
v_mfma_f32_16x16x32_bf16 a[28:31],v[140:143],v[48:51],a[28:31]
v_cvt_pk_bf16_f32 v29,v90,v91
v_cvt_pk_bf16_f32 v28,v88,v89
v_mfma_f32_16x16x32_bf16 a[24:27],v[136:139],v[48:51],a[24:27]
v_exp_f32 v99,v99
v_mfma_f32_16x16x32_bf16 v[232:235],v[136:139],v[44:47],v[232:235]
v_exp_f32 v97,v97
v_mfma_f32_16x16x32_bf16 v[236:239],v[140:143],v[44:47],v[236:239]
v_exp_f32 v96,v96
v_mfma_f32_16x16x32_bf16 v[188:191],v[140:143],v[40:43],v[188:191]
v_exp_f32 v98,v98
v_mfma_f32_16x16x32_bf16 v[184:187],v[136:139],v[40:43],v[184:187]
v_cvt_pk_bf16_f32 v33,v98,v99
v_cvt_pk_bf16_f32 v32,v96,v97
s_waitcnt vmcnt(12) lgkmcnt(0)
v_mfma_f32_16x16x32_bf16 v[192:195],v[112:115],v[40:43],v[192:195]
s_barrier
v_mfma_f32_16x16x32_bf16 v[196:199],v[116:119],v[40:43],v[196:199]
ds_read_b128 v[136:139],v0 offset:12416
v_fma_f32 v85,v85,s36,v14
v_mfma_f32_16x16x32_bf16 v[244:247],v[116:119],v[44:47],v[244:247]
ds_read_b128 v[140:143],v1 offset:12416
v_fma_f32 v92,v92,s36,v15
v_mfma_f32_16x16x32_bf16 v[240:243],v[112:115],v[44:47],v[240:243]
ds_read_b128 v[132:135],v1 offset:12288
v_fma_f32 v95,v95,s36,v15
v_mfma_f32_16x16x32_bf16 a[32:35],v[112:115],v[48:51],a[32:35]
ds_read_b128 v[128:131],v0 offset:12288
v_fma_f32 v93,v93,s36,v15
v_mfma_f32_16x16x32_bf16 a[36:39],v[116:119],v[48:51],a[36:39]
v_exp_f32 v77,v77
v_mfma_f32_16x16x32_bf16 a[84:87],v[116:119],v[52:55],a[84:87]
buffer_load_dwordx4 v6,s[8:11],s21 offen offset:0 lds
v_mfma_f32_16x16x32_bf16 a[80:83],v[112:115],v[52:55],a[80:83]
ds_read_b128 v[116:119],v1 offset:12544
v_fma_f32 v94,v94,s36,v15
v_mfma_f32_16x16x32_bf16 a[88:91],v[120:123],v[52:55],a[88:91]
ds_read_b128 v[112:115],v0 offset:12544
v_fma_f32 v102,v102,s36,v16
v_mfma_f32_16x16x32_bf16 a[92:95],v[124:127],v[52:55],a[92:95]
v_exp_f32 v78,v78
v_mfma_f32_16x16x32_bf16 a[44:47],v[124:127],v[48:51],a[44:47]
v_exp_f32 v76,v76
v_mfma_f32_16x16x32_bf16 a[40:43],v[120:123],v[48:51],a[40:43]
v_cvt_pk_bf16_f32 v22,v76,v77
v_fma_f32 v101,v101,s36,v16
v_mfma_f32_16x16x32_bf16 v[248:251],v[120:123],v[44:47],v[248:251]
v_exp_f32 v79,v79
v_mfma_f32_16x16x32_bf16 v[252:255],v[124:127],v[44:47],v[252:255]
v_cvt_pk_bf16_f32 v23,v78,v79
v_fma_f32 v103,v103,s36,v16
v_mfma_f32_16x16x32_bf16 v[204:207],v[124:127],v[40:43],v[204:207]
ds_read_b128 v[124:127],v1 offset:18432
v_fma_f32 v100,v100,s36,v16
v_mfma_f32_16x16x32_bf16 v[200:203],v[120:123],v[40:43],v[200:203]
buffer_load_dwordx4 v7,s[8:11],s21 offen offset:1024 lds
s_waitcnt lgkmcnt(2)
v_mfma_f32_16x16x32_bf16 v[72:75],v[116:119],a[164:167],0
s_waitcnt lgkmcnt(1)
ds_read_b128 v[120:123],v0 offset:18432
v_mfma_f32_16x16x32_bf16 v[72:75],v[112:115],a[160:163],v[72:75]
v_exp_f32 v84,v84
v_mfma_f32_16x16x32_bf16 v[72:75],v[140:143],a[156:159],v[72:75]
v_exp_f32 v86,v86
v_mfma_f32_16x16x32_bf16 v[72:75],v[136:139],a[152:155],v[72:75]
v_exp_f32 v87,v87
v_mfma_f32_16x16x32_bf16 v[72:75],v[132:135],a[148:151],v[72:75]
v_exp_f32 v85,v85
v_mfma_f32_16x16x32_bf16 v[72:75],v[128:131],a[144:147],v[72:75]
v_cvt_pk_bf16_f32 v26,v84,v85
v_cvt_pk_bf16_f32 v27,v86,v87
v_mfma_f32_16x16x32_bf16 v[80:83],v[128:131],a[168:171],0
v_exp_f32 v95,v95
v_smfmac_f32_16x16x64_bf16 v[60:63],v[152:155],v[20:27],v18
v_mfma_f32_16x16x32_bf16 v[80:83],v[132:135],a[172:175],v[80:83]
buffer_load_dwordx4 v8,s[8:11],s21 offen offset:2048 lds
v_mfma_f32_16x16x32_bf16 v[80:83],v[136:139],a[176:179],v[80:83]
s_add_u32 s21,s21,12288
v_exp_f32 v94,v94
v_mfma_f32_16x16x32_bf16 v[80:83],v[140:143],a[180:183],v[80:83]
s_add_u32 m0,s22,0
v_cvt_pk_bf16_f32 v31,v94,v95
v_fma_f32 v74,v74,s36,v13
v_mfma_f32_16x16x32_bf16 v[80:83],v[112:115],a[184:187],v[80:83]
v_exp_f32 v93,v93
v_mfma_f32_16x16x32_bf16 v[80:83],v[116:119],a[188:191],v[80:83]
v_exp_f32 v92,v92
v_mfma_f32_16x16x32_bf16 v[88:91],v[116:119],a[212:215],0
v_cvt_pk_bf16_f32 v30,v92,v93
v_fma_f32 v72,v72,s36,v13
v_mfma_f32_16x16x32_bf16 v[88:91],v[112:115],a[208:211],v[88:91]
v_exp_f32 v100,v100
v_mfma_f32_16x16x32_bf16 v[88:91],v[140:143],a[204:207],v[88:91]
v_exp_f32 v103,v103
v_mfma_f32_16x16x32_bf16 v[88:91],v[136:139],a[200:203],v[88:91]
v_exp_f32 v102,v102
v_mfma_f32_16x16x32_bf16 v[88:91],v[132:135],a[196:199],v[88:91]
buffer_load_dwordx4 v6,s[4:7],s20 offen offset:0 lds
v_mfma_f32_16x16x32_bf16 v[88:91],v[128:131],a[192:195],v[88:91]
v_exp_f32 v101,v101
v_mfma_f32_16x16x32_bf16 v[96:99],v[128:131],a[216:219],0
ds_read_b128 v[128:131],v0 offset:18560
v_cvt_pk_bf16_f32 v34,v100,v101
v_mfma_f32_16x16x32_bf16 v[96:99],v[132:135],a[220:223],v[96:99]
ds_read_b128 v[132:135],v1 offset:18560
v_cvt_pk_bf16_f32 v35,v102,v103
v_mfma_f32_16x16x32_bf16 v[96:99],v[136:139],a[224:227],v[96:99]
ds_read_b128 v[136:139],v0 offset:18688
v_fma_f32 v80,v80,s36,v14
v_smfmac_f32_16x16x64_bf16 v[64:67],v[152:155],v[28:35],v18
v_fma_f32 v81,v81,s36,v14
v_mfma_f32_16x16x32_bf16 v[96:99],v[140:143],a[228:231],v[96:99]
ds_read_b128 v[140:143],v1 offset:18688
v_fma_f32 v75,v75,s36,v13
v_mfma_f32_16x16x32_bf16 v[96:99],v[112:115],a[232:235],v[96:99]
v_exp_f32 v74,v74
v_mfma_f32_16x16x32_bf16 v[96:99],v[116:119],a[236:239],v[96:99]
s_waitcnt lgkmcnt(4)
v_exp_f32 v80,v80
v_mfma_f32_16x16x32_bf16 v[76:79],v[120:123],a[144:147],0
buffer_load_dwordx4 v7,s[4:7],s20 offen offset:1024 lds
v_mfma_f32_16x16x32_bf16 v[76:79],v[124:127],a[148:151],v[76:79]
s_waitcnt lgkmcnt(3)
v_exp_f32 v81,v81
v_mfma_f32_16x16x32_bf16 v[76:79],v[128:131],a[152:155],v[76:79]
s_waitcnt lgkmcnt(2)
v_fma_f32 v73,v73,s36,v13
v_cvt_pk_bf16_f32 v44,v80,v81
v_mfma_f32_16x16x32_bf16 v[76:79],v[132:135],a[156:159],v[76:79]
s_waitcnt lgkmcnt(1)
v_exp_f32 v75,v75
v_mfma_f32_16x16x32_bf16 v[76:79],v[136:139],a[160:163],v[76:79]
s_waitcnt lgkmcnt(0)
v_cvt_pk_bf16_f32 v41,v74,v75
v_exp_f32 v73,v73
v_exp_f32 v72,v72
v_mfma_f32_16x16x32_bf16 v[76:79],v[140:143],a[164:167],v[76:79]
v_cvt_pk_bf16_f32 v40,v72,v73
v_mfma_f32_16x16x32_bf16 v[84:87],v[140:143],a[188:191],0
v_mfma_f32_16x16x32_bf16 v[84:87],v[136:139],a[184:187],v[84:87]
v_mfma_f32_16x16x32_bf16 v[84:87],v[132:135],a[180:183],v[84:87]
buffer_load_dwordx4 v8,s[4:7],s20 offen offset:2048 lds
v_mfma_f32_16x16x32_bf16 v[84:87],v[128:131],a[176:179],v[84:87]
s_add_u32 s20,s20,12288
ds_read_b64_tr_b16 v[114:115],v2 offset:6144
v_mfma_f32_16x16x32_bf16 v[84:87],v[124:127],a[172:175],v[84:87]
ds_read_b64_tr_b16 v[112:113],v2 offset:0
v_mfma_f32_16x16x32_bf16 v[84:87],v[120:123],a[168:171],v[84:87]
ds_read_b64_tr_b16 v[118:119],v3 offset:6144
v_mfma_f32_16x16x32_bf16 v[92:95],v[120:123],a[192:195],0
ds_read_b64_tr_b16 v[116:117],v3 offset:0
v_mfma_f32_16x16x32_bf16 v[92:95],v[124:127],a[196:199],v[92:95]
v_mfma_f32_16x16x32_bf16 v[92:95],v[128:131],a[200:203],v[92:95]
v_mfma_f32_16x16x32_bf16 v[92:95],v[132:135],a[204:207],v[92:95]
v_mfma_f32_16x16x32_bf16 v[92:95],v[136:139],a[208:211],v[92:95]
v_mfma_f32_16x16x32_bf16 v[92:95],v[140:143],a[212:215],v[92:95]
v_mfma_f32_16x16x32_bf16 v[100:103],v[140:143],a[236:239],0
v_mfma_f32_16x16x32_bf16 v[100:103],v[136:139],a[232:235],v[100:103]
v_mfma_f32_16x16x32_bf16 v[100:103],v[132:135],a[228:231],v[100:103]
v_mfma_f32_16x16x32_bf16 v[100:103],v[128:131],a[224:227],v[100:103]
v_mfma_f32_16x16x32_bf16 v[100:103],v[124:127],a[220:223],v[100:103]
ds_read_b64_tr_b16 v[124:125],v5 offset:0
v_mfma_f32_16x16x32_bf16 v[100:103],v[120:123],a[216:219],v[100:103]
s_waitcnt lgkmcnt(1)
ds_read_b64_tr_b16 v[122:123],v4 offset:6144
ds_read_b64_tr_b16 v[120:121],v4 offset:0
ds_read_b64_tr_b16 v[126:127],v5 offset:6144
v_mfma_f32_16x16x32_bf16 v[160:163],v[112:115],v[20:23],v[160:163]
s_add_u32 m0,s23,0
ds_read_b64_tr_b16 v[128:129],v2 offset:128
v_fma_f32 v82,v82,s36,v14
v_mfma_f32_16x16x32_bf16 v[164:167],v[116:119],v[20:23],v[164:167]
ds_read_b64_tr_b16 v[130:131],v2 offset:6272
v_fma_f32 v83,v83,s36,v14
v_mfma_f32_16x16x32_bf16 v[212:215],v[116:119],v[24:27],v[212:215]
ds_read_b64_tr_b16 v[132:133],v3 offset:128
v_fma_f32 v88,v88,s36,v15
v_mfma_f32_16x16x32_bf16 v[208:211],v[112:115],v[24:27],v[208:211]
ds_read_b64_tr_b16 v[134:135],v3 offset:6272
v_fma_f32 v89,v89,s36,v15
v_mfma_f32_16x16x32_bf16 a[0:3],v[112:115],v[28:31],a[0:3]
ds_read_b64_tr_b16 v[136:137],v4 offset:128
v_fma_f32 v90,v90,s36,v15
v_mfma_f32_16x16x32_bf16 a[4:7],v[116:119],v[28:31],a[4:7]
ds_read_b64_tr_b16 v[138:139],v4 offset:6272
v_fma_f32 v91,v91,s36,v15
v_mfma_f32_16x16x32_bf16 a[52:55],v[116:119],v[32:35],a[52:55]
ds_read_b64_tr_b16 v[140:141],v5 offset:128
v_fma_f32 v96,v96,s36,v16
v_mfma_f32_16x16x32_bf16 a[48:51],v[112:115],v[32:35],a[48:51]
s_waitcnt lgkmcnt(8)
ds_read_b64_tr_b16 v[142:143],v5 offset:6272
v_fma_f32 v97,v97,s36,v16
v_mfma_f32_16x16x32_bf16 a[56:59],v[120:123],v[32:35],a[56:59]
s_waitcnt lgkmcnt(7)
ds_read_b64_tr_b16 v[112:113],v2 offset:256
v_fma_f32 v98,v98,s36,v16
v_mfma_f32_16x16x32_bf16 a[60:63],v[124:127],v[32:35],a[60:63]
ds_read_b64_tr_b16 v[114:115],v2 offset:6400
v_fma_f32 v99,v99,s36,v16
v_mfma_f32_16x16x32_bf16 a[12:15],v[124:127],v[28:31],a[12:15]
ds_read_b64_tr_b16 v[116:117],v3 offset:256
v_fma_f32 v76,v76,s36,v13
v_mfma_f32_16x16x32_bf16 a[8:11],v[120:123],v[28:31],a[8:11]
ds_read_b64_tr_b16 v[118:119],v3 offset:6400
v_fma_f32 v77,v77,s36,v13
v_mfma_f32_16x16x32_bf16 v[216:219],v[120:123],v[24:27],v[216:219]
v_exp_f32 v82,v82
v_mfma_f32_16x16x32_bf16 v[220:223],v[124:127],v[24:27],v[220:223]
v_exp_f32 v83,v83
v_mfma_f32_16x16x32_bf16 v[172:175],v[124:127],v[20:23],v[172:175]
ds_read_b64_tr_b16 v[124:125],v5 offset:256
v_cvt_pk_bf16_f32 v45,v82,v83
v_mfma_f32_16x16x32_bf16 v[168:171],v[120:123],v[20:23],v[168:171]
s_waitcnt lgkmcnt(5)
ds_read_b64_tr_b16 v[120:121],v4 offset:256
v_fma_f32 v78,v78,s36,v13
v_mfma_f32_16x16x32_bf16 v[176:179],v[128:131],v[20:23],v[176:179]
ds_read_b64_tr_b16 v[122:123],v4 offset:6400
v_fma_f32 v79,v79,s36,v13
v_mfma_f32_16x16x32_bf16 v[180:183],v[132:135],v[20:23],v[180:183]
ds_read_b64_tr_b16 v[126:127],v5 offset:6400
v_fma_f32 v84,v84,s36,v14
v_mfma_f32_16x16x32_bf16 v[228:231],v[132:135],v[24:27],v[228:231]
v_exp_f32 v88,v88
v_mfma_f32_16x16x32_bf16 v[224:227],v[128:131],v[24:27],v[224:227]
v_exp_f32 v89,v89
v_mfma_f32_16x16x32_bf16 a[16:19],v[128:131],v[28:31],a[16:19]
v_exp_f32 v90,v90
v_mfma_f32_16x16x32_bf16 a[20:23],v[132:135],v[28:31],a[20:23]
v_exp_f32 v91,v91
v_mfma_f32_16x16x32_bf16 a[68:71],v[132:135],v[32:35],a[68:71]
v_cvt_pk_bf16_f32 v48,v88,v89
v_cvt_pk_bf16_f32 v49,v90,v91
v_mfma_f32_16x16x32_bf16 a[64:67],v[128:131],v[32:35],a[64:67]
v_exp_f32 v96,v96
v_mfma_f32_16x16x32_bf16 a[72:75],v[136:139],v[32:35],a[72:75]
v_exp_f32 v97,v97
v_mfma_f32_16x16x32_bf16 a[76:79],v[140:143],v[32:35],a[76:79]
v_exp_f32 v98,v98
v_mfma_f32_16x16x32_bf16 a[28:31],v[140:143],v[28:31],a[28:31]
v_exp_f32 v99,v99
v_mfma_f32_16x16x32_bf16 a[24:27],v[136:139],v[28:31],a[24:27]
v_cvt_pk_bf16_f32 v52,v96,v97
v_cvt_pk_bf16_f32 v53,v98,v99
v_mfma_f32_16x16x32_bf16 v[232:235],v[136:139],v[24:27],v[232:235]
v_exp_f32 v76,v76
v_mfma_f32_16x16x32_bf16 v[236:239],v[140:143],v[24:27],v[236:239]
v_exp_f32 v77,v77
v_mfma_f32_16x16x32_bf16 v[188:191],v[140:143],v[20:23],v[188:191]
v_exp_f32 v78,v78
v_mfma_f32_16x16x32_bf16 v[184:187],v[136:139],v[20:23],v[184:187]
s_waitcnt lgkmcnt(0)
v_exp_f32 v79,v79
v_mfma_f32_16x16x32_bf16 v[192:195],v[112:115],v[20:23],v[192:195]
v_cvt_pk_bf16_f32 v42,v76,v77
v_cvt_pk_bf16_f32 v43,v78,v79
s_waitcnt vmcnt(9)
v_mfma_f32_16x16x32_bf16 v[196:199],v[116:119],v[20:23],v[196:199]
s_barrier
v_mfma_f32_16x16x32_bf16 v[244:247],v[116:119],v[24:27],v[244:247]
ds_read_b128 v[140:143],v1 offset:24704
v_fma_f32 v85,v85,s36,v14
v_mfma_f32_16x16x32_bf16 v[240:243],v[112:115],v[24:27],v[240:243]
ds_read_b128 v[136:139],v0 offset:24704
v_fma_f32 v86,v86,s36,v14
v_mfma_f32_16x16x32_bf16 a[32:35],v[112:115],v[28:31],a[32:35]
ds_read_b128 v[132:135],v1 offset:24576
v_fma_f32 v87,v87,s36,v14
v_mfma_f32_16x16x32_bf16 a[36:39],v[116:119],v[28:31],a[36:39]
ds_read_b128 v[128:131],v0 offset:24576
v_fma_f32 v92,v92,s36,v15
v_mfma_f32_16x16x32_bf16 a[84:87],v[116:119],v[32:35],a[84:87]
ds_read_b128 v[116:119],v1 offset:24832
v_fma_f32 v93,v93,s36,v15
v_mfma_f32_16x16x32_bf16 a[80:83],v[112:115],v[32:35],a[80:83]
buffer_load_dwordx4 v6,s[8:11],s21 offen offset:0 lds
v_mfma_f32_16x16x32_bf16 a[88:91],v[120:123],v[32:35],a[88:91]
ds_read_b128 v[112:115],v0 offset:24832
v_fma_f32 v94,v94,s36,v15
v_mfma_f32_16x16x32_bf16 a[92:95],v[124:127],v[32:35],a[92:95]
ds_read_b128 v[156:159],v10 offset:6144
v_fma_f32 v95,v95,s36,v15
v_mfma_f32_16x16x32_bf16 a[44:47],v[124:127],v[28:31],a[44:47]
v_exp_f32 v84,v84
v_mfma_f32_16x16x32_bf16 a[40:43],v[120:123],v[28:31],a[40:43]
v_exp_f32 v85,v85
v_mfma_f32_16x16x32_bf16 v[248:251],v[120:123],v[24:27],v[248:251]
v_exp_f32 v86,v86
v_mfma_f32_16x16x32_bf16 v[252:255],v[124:127],v[24:27],v[252:255]
v_exp_f32 v87,v87
v_mfma_f32_16x16x32_bf16 v[204:207],v[124:127],v[20:23],v[204:207]
ds_read_b128 v[124:127],v1 offset:30720
v_cvt_pk_bf16_f32 v46,v84,v85
v_mfma_f32_16x16x32_bf16 v[200:203],v[120:123],v[20:23],v[200:203]
s_waitcnt lgkmcnt(3)
ds_read_b128 v[120:123],v0 offset:30720
v_cvt_pk_bf16_f32 v47,v86,v87
v_mfma_f32_16x16x32_bf16 v[72:75],v[116:119],a[164:167],0
v_exp_f32 v92,v92
v_smfmac_f32_16x16x64_bf16 v[60:63],v[152:155],v[40:47],v18
s_waitcnt lgkmcnt(2)
v_fma_f32 v100,v100,s36,v16
v_mfma_f32_16x16x32_bf16 v[72:75],v[112:115],a[160:163],v[72:75]
buffer_store_dwordx4 v[156:159],v9,s[16:19],s27 offen offset:0 nt
buffer_load_dwordx4 v7,s[8:11],s21 offen offset:1024 lds
v_mfma_f32_16x16x32_bf16 v[72:75],v[140:143],a[156:159],v[72:75]
ds_read_b128 v[156:159],v10 offset:7168
v_fma_f32 v101,v101,s36,v16
v_mfma_f32_16x16x32_bf16 v[72:75],v[136:139],a[152:155],v[72:75]
v_exp_f32 v93,v93
v_mfma_f32_16x16x32_bf16 v[72:75],v[132:135],a[148:151],v[72:75]
v_exp_f32 v94,v94
v_mfma_f32_16x16x32_bf16 v[72:75],v[128:131],a[144:147],v[72:75]
v_exp_f32 v95,v95
v_mfma_f32_16x16x32_bf16 v[80:83],v[128:131],a[168:171],0
v_cvt_pk_bf16_f32 v50,v92,v93
v_cvt_pk_bf16_f32 v51,v94,v95
v_mfma_f32_16x16x32_bf16 v[80:83],v[132:135],a[172:175],v[80:83]
buffer_load_dwordx4 v8,s[8:11],s21 offen offset:2048 lds
v_mfma_f32_16x16x32_bf16 v[80:83],v[136:139],a[176:179],v[80:83]
s_add_u32 s21,s21,12288
v_fma_f32 v102,v102,s36,v16
v_fma_f32 v103,v103,s36,v16
v_mfma_f32_16x16x32_bf16 v[80:83],v[140:143],a[180:183],v[80:83]
s_cmp_eq_u32 s38,1
v_exp_f32 v100,v100
v_mfma_f32_16x16x32_bf16 v[80:83],v[112:115],a[184:187],v[80:83]
s_cselect_b32 s20,s26,s20
v_exp_f32 v101,v101
v_mfma_f32_16x16x32_bf16 v[80:83],v[116:119],a[188:191],v[80:83]
s_add_u32 m0,s22,12288
v_exp_f32 v102,v102
v_mfma_f32_16x16x32_bf16 v[88:91],v[116:119],a[212:215],0
v_exp_f32 v103,v103
v_mfma_f32_16x16x32_bf16 v[88:91],v[112:115],a[208:211],v[88:91]
v_cvt_pk_bf16_f32 v54,v100,v101
v_cvt_pk_bf16_f32 v55,v102,v103
v_mfma_f32_16x16x32_bf16 v[88:91],v[140:143],a[204:207],v[88:91]
v_fma_f32 v72,v72,s36,v13
v_fma_f32 v73,v73,s36,v13
v_smfmac_f32_16x16x64_bf16 v[64:67],v[152:155],v[48:55],v18
v_fma_f32 v74,v74,s36,v13
v_mfma_f32_16x16x32_bf16 v[88:91],v[136:139],a[200:203],v[88:91]
s_waitcnt lgkmcnt(0)
buffer_store_dwordx4 v[156:159],v9,s[16:19],s27 offen offset:128 nt
buffer_load_dwordx4 v6,s[4:7],s20 offen offset:0 lds
v_mfma_f32_16x16x32_bf16 v[88:91],v[132:135],a[196:199],v[88:91]
ds_read_b128 v[156:159],v10 offset:8192
v_mfma_f32_16x16x32_bf16 v[88:91],v[128:131],a[192:195],v[88:91]
v_fma_f32 v75,v75,s36,v13
v_fma_f32 v80,v80,s36,v14
v_mfma_f32_16x16x32_bf16 v[96:99],v[128:131],a[216:219],0
ds_read_b128 v[128:131],v0 offset:30848
v_fma_f32 v81,v81,s36,v14
v_mfma_f32_16x16x32_bf16 v[96:99],v[132:135],a[220:223],v[96:99]
ds_read_b128 v[132:135],v1 offset:30848
v_mfma_f32_16x16x32_bf16 v[96:99],v[136:139],a[224:227],v[96:99]
ds_read_b128 v[136:139],v0 offset:30976
v_mfma_f32_16x16x32_bf16 v[96:99],v[140:143],a[228:231],v[96:99]
ds_read_b128 v[140:143],v1 offset:30976
v_mfma_f32_16x16x32_bf16 v[96:99],v[112:115],a[232:235],v[96:99]
v_exp_f32 v72,v72
v_mfma_f32_16x16x32_bf16 v[96:99],v[116:119],a[236:239],v[96:99]
buffer_load_dwordx4 v7,s[4:7],s20 offen offset:1024 lds
v_mfma_f32_16x16x32_bf16 v[76:79],v[120:123],a[144:147],0
v_exp_f32 v73,v73
v_mfma_f32_16x16x32_bf16 v[76:79],v[124:127],a[148:151],v[76:79]
s_waitcnt lgkmcnt(3)
v_exp_f32 v74,v74
v_exp_f32 v75,v75
v_cvt_pk_bf16_f32 v20,v72,v73
v_mfma_f32_16x16x32_bf16 v[76:79],v[128:131],a[152:155],v[76:79]
s_waitcnt lgkmcnt(2)
v_exp_f32 v80,v80
v_mfma_f32_16x16x32_bf16 v[76:79],v[132:135],a[156:159],v[76:79]
s_waitcnt lgkmcnt(1)
v_exp_f32 v81,v81
v_mfma_f32_16x16x32_bf16 v[76:79],v[136:139],a[160:163],v[76:79]
s_waitcnt lgkmcnt(0)
v_cvt_pk_bf16_f32 v21,v74,v75
v_cvt_pk_bf16_f32 v24,v80,v81
v_mfma_f32_16x16x32_bf16 v[76:79],v[140:143],a[164:167],v[76:79]
v_mfma_f32_16x16x32_bf16 v[84:87],v[140:143],a[188:191],0
v_mfma_f32_16x16x32_bf16 v[84:87],v[136:139],a[184:187],v[84:87]
buffer_store_dwordx4 v[156:159],v9,s[16:19],s27 offen offset:256 nt
buffer_load_dwordx4 v8,s[4:7],s20 offen offset:2048 lds
v_mfma_f32_16x16x32_bf16 v[84:87],v[132:135],a[180:183],v[84:87]
s_add_u32 s20,s20,12288
v_mfma_f32_16x16x32_bf16 v[84:87],v[128:131],a[176:179],v[84:87]
s_add_u32 s27,s27,3072
ds_read_b64_tr_b16 v[112:113],v2 offset:12288
v_mfma_f32_16x16x32_bf16 v[84:87],v[124:127],a[172:175],v[84:87]
ds_read_b64_tr_b16 v[114:115],v2 offset:18432
v_mfma_f32_16x16x32_bf16 v[84:87],v[120:123],a[168:171],v[84:87]
ds_read_b64_tr_b16 v[116:117],v3 offset:12288
v_mfma_f32_16x16x32_bf16 v[92:95],v[120:123],a[192:195],0
ds_read_b64_tr_b16 v[118:119],v3 offset:18432
v_mfma_f32_16x16x32_bf16 v[92:95],v[124:127],a[196:199],v[92:95]
v_mfma_f32_16x16x32_bf16 v[92:95],v[128:131],a[200:203],v[92:95]
v_mfma_f32_16x16x32_bf16 v[92:95],v[132:135],a[204:207],v[92:95]
v_mfma_f32_16x16x32_bf16 v[92:95],v[136:139],a[208:211],v[92:95]
v_mfma_f32_16x16x32_bf16 v[92:95],v[140:143],a[212:215],v[92:95]
v_mfma_f32_16x16x32_bf16 v[100:103],v[140:143],a[236:239],0
v_mfma_f32_16x16x32_bf16 v[100:103],v[136:139],a[232:235],v[100:103]
v_mfma_f32_16x16x32_bf16 v[100:103],v[132:135],a[228:231],v[100:103]
v_mfma_f32_16x16x32_bf16 v[100:103],v[128:131],a[224:227],v[100:103]
v_mfma_f32_16x16x32_bf16 v[100:103],v[124:127],a[220:223],v[100:103]
ds_read_b64_tr_b16 v[124:125],v5 offset:12288
v_mfma_f32_16x16x32_bf16 v[100:103],v[120:123],a[216:219],v[100:103]
s_waitcnt lgkmcnt(1)
ds_read_b64_tr_b16 v[120:121],v4 offset:12288
ds_read_b64_tr_b16 v[122:123],v4 offset:18432
ds_read_b64_tr_b16 v[126:127],v5 offset:18432
v_mfma_f32_16x16x32_bf16 v[160:163],v[112:115],v[40:43],v[160:163]
s_add_u32 m0,s29,0
ds_read_b64_tr_b16 v[128:129],v2 offset:12416
v_fma_f32 v82,v82,s36,v14
v_mfma_f32_16x16x32_bf16 v[164:167],v[116:119],v[40:43],v[164:167]
ds_read_b64_tr_b16 v[130:131],v2 offset:18560
v_fma_f32 v83,v83,s36,v14
v_mfma_f32_16x16x32_bf16 v[212:215],v[116:119],v[44:47],v[212:215]
ds_read_b64_tr_b16 v[132:133],v3 offset:12416
v_fma_f32 v88,v88,s36,v15
v_mfma_f32_16x16x32_bf16 v[208:211],v[112:115],v[44:47],v[208:211]
ds_read_b64_tr_b16 v[134:135],v3 offset:18560
v_fma_f32 v89,v89,s36,v15
v_mfma_f32_16x16x32_bf16 a[0:3],v[112:115],v[48:51],a[0:3]
ds_read_b64_tr_b16 v[136:137],v4 offset:12416
v_fma_f32 v90,v90,s36,v15
v_mfma_f32_16x16x32_bf16 a[4:7],v[116:119],v[48:51],a[4:7]
ds_read_b64_tr_b16 v[138:139],v4 offset:18560
v_fma_f32 v91,v91,s36,v15
v_mfma_f32_16x16x32_bf16 a[52:55],v[116:119],v[52:55],a[52:55]
buffer_load_dwordx4 v6,s[12:15],s28 offen offset:0 nt lds
v_mfma_f32_16x16x32_bf16 a[48:51],v[112:115],v[52:55],a[48:51]
s_waitcnt lgkmcnt(6)
ds_read_b64_tr_b16 v[140:141],v5 offset:12416
v_fma_f32 v96,v96,s36,v16
v_mfma_f32_16x16x32_bf16 a[56:59],v[120:123],v[52:55],a[56:59]
ds_read_b64_tr_b16 v[142:143],v5 offset:18560
v_fma_f32 v97,v97,s36,v16
v_mfma_f32_16x16x32_bf16 a[60:63],v[124:127],v[52:55],a[60:63]
ds_read_b64_tr_b16 v[112:113],v2 offset:12544
v_fma_f32 v98,v98,s36,v16
v_mfma_f32_16x16x32_bf16 a[12:15],v[124:127],v[48:51],a[12:15]
ds_read_b64_tr_b16 v[114:115],v2 offset:18688
v_fma_f32 v99,v99,s36,v16
v_mfma_f32_16x16x32_bf16 a[8:11],v[120:123],v[48:51],a[8:11]
ds_read_b64_tr_b16 v[116:117],v3 offset:12544
v_fma_f32 v76,v76,s36,v13
v_mfma_f32_16x16x32_bf16 v[216:219],v[120:123],v[44:47],v[216:219]
ds_read_b64_tr_b16 v[118:119],v3 offset:18688
v_fma_f32 v77,v77,s36,v13
v_mfma_f32_16x16x32_bf16 v[220:223],v[124:127],v[44:47],v[220:223]
buffer_load_dwordx4 v7,s[12:15],s28 offen offset:1024 nt lds
v_mfma_f32_16x16x32_bf16 v[172:175],v[124:127],v[40:43],v[172:175]
ds_read_b64_tr_b16 v[124:125],v5 offset:12544
v_fma_f32 v78,v78,s36,v13
v_mfma_f32_16x16x32_bf16 v[168:171],v[120:123],v[40:43],v[168:171]
s_waitcnt lgkmcnt(6)
ds_read_b64_tr_b16 v[120:121],v4 offset:12544
v_fma_f32 v79,v79,s36,v13
v_mfma_f32_16x16x32_bf16 v[176:179],v[128:131],v[40:43],v[176:179]
ds_read_b64_tr_b16 v[122:123],v4 offset:18688
v_fma_f32 v84,v84,s36,v14
v_mfma_f32_16x16x32_bf16 v[180:183],v[132:135],v[40:43],v[180:183]
ds_read_b64_tr_b16 v[126:127],v5 offset:18688
v_fma_f32 v85,v85,s36,v14
v_mfma_f32_16x16x32_bf16 v[228:231],v[132:135],v[44:47],v[228:231]
v_exp_f32 v82,v82
v_mfma_f32_16x16x32_bf16 v[224:227],v[128:131],v[44:47],v[224:227]
v_exp_f32 v83,v83
v_mfma_f32_16x16x32_bf16 a[16:19],v[128:131],v[48:51],a[16:19]
v_cvt_pk_bf16_f32 v25,v82,v83
v_fma_f32 v86,v86,s36,v14
v_mfma_f32_16x16x32_bf16 a[20:23],v[132:135],v[48:51],a[20:23]
buffer_load_dwordx4 v8,s[12:15],s28 offen offset:2048 nt lds
v_mfma_f32_16x16x32_bf16 a[68:71],v[132:135],v[52:55],a[68:71]
s_add_u32 s28,s28,3072
v_exp_f32 v88,v88
v_mfma_f32_16x16x32_bf16 a[64:67],v[128:131],v[52:55],a[64:67]
s_add_u32 s29,s29,3072
v_exp_f32 v89,v89
v_mfma_f32_16x16x32_bf16 a[72:75],v[136:139],v[52:55],a[72:75]
s_cmp_eq_u32 s38,1
v_exp_f32 v90,v90
s_waitcnt lgkmcnt(1)
v_mfma_f32_16x16x32_bf16 a[76:79],v[140:143],v[52:55],a[76:79]
s_cselect_b32 s21,s26,s21
v_exp_f32 v91,v91
v_mfma_f32_16x16x32_bf16 a[28:31],v[140:143],v[48:51],a[28:31]
s_add_u32 m0,s23,12288
v_cvt_pk_bf16_f32 v28,v88,v89
v_cvt_pk_bf16_f32 v29,v90,v91
v_mfma_f32_16x16x32_bf16 a[24:27],v[136:139],v[48:51],a[24:27]
v_exp_f32 v96,v96
v_mfma_f32_16x16x32_bf16 v[232:235],v[136:139],v[44:47],v[232:235]
v_exp_f32 v97,v97
v_mfma_f32_16x16x32_bf16 v[236:239],v[140:143],v[44:47],v[236:239]
v_exp_f32 v98,v98
v_mfma_f32_16x16x32_bf16 v[188:191],v[140:143],v[40:43],v[188:191]
v_exp_f32 v99,v99
v_mfma_f32_16x16x32_bf16 v[184:187],v[136:139],v[40:43],v[184:187]
v_cvt_pk_bf16_f32 v32,v96,v97
v_cvt_pk_bf16_f32 v33,v98,v99
s_waitcnt vmcnt(12) lgkmcnt(0)
v_mfma_f32_16x16x32_bf16 v[192:195],v[112:115],v[40:43],v[192:195]
s_barrier
v_mfma_f32_16x16x32_bf16 v[196:199],v[116:119],v[40:43],v[196:199]
ds_read_b128 v[140:143],v1 offset:128
v_fma_f32 v87,v87,s36,v14
v_mfma_f32_16x16x32_bf16 v[244:247],v[116:119],v[44:47],v[244:247]
ds_read_b128 v[136:139],v0 offset:128
v_fma_f32 v92,v92,s36,v15
v_mfma_f32_16x16x32_bf16 v[240:243],v[112:115],v[44:47],v[240:243]
ds_read_b128 v[132:135],v1 offset:0
v_fma_f32 v93,v93,s36,v15
v_mfma_f32_16x16x32_bf16 a[32:35],v[112:115],v[48:51],a[32:35]
ds_read_b128 v[128:131],v0 offset:0
v_fma_f32 v94,v94,s36,v15
v_mfma_f32_16x16x32_bf16 a[36:39],v[116:119],v[48:51],a[36:39]
v_exp_f32 v76,v76
v_mfma_f32_16x16x32_bf16 a[84:87],v[116:119],v[52:55],a[84:87]
buffer_load_dwordx4 v6,s[8:11],s21 offen offset:0 lds
v_mfma_f32_16x16x32_bf16 a[80:83],v[112:115],v[52:55],a[80:83]
ds_read_b128 v[116:119],v1 offset:256
v_fma_f32 v95,v95,s36,v15
v_mfma_f32_16x16x32_bf16 a[88:91],v[120:123],v[52:55],a[88:91]
ds_read_b128 v[112:115],v0 offset:256
v_fma_f32 v100,v100,s36,v16
v_mfma_f32_16x16x32_bf16 a[92:95],v[124:127],v[52:55],a[92:95]
v_exp_f32 v77,v77
v_mfma_f32_16x16x32_bf16 a[44:47],v[124:127],v[48:51],a[44:47]
v_exp_f32 v78,v78
v_mfma_f32_16x16x32_bf16 a[40:43],v[120:123],v[48:51],a[40:43]
v_exp_f32 v79,v79
v_mfma_f32_16x16x32_bf16 v[248:251],v[120:123],v[44:47],v[248:251]
v_cvt_pk_bf16_f32 v22,v76,v77
v_cvt_pk_bf16_f32 v23,v78,v79
v_mfma_f32_16x16x32_bf16 v[252:255],v[124:127],v[44:47],v[252:255]
v_exp_f32 v84,v84
v_mfma_f32_16x16x32_bf16 v[204:207],v[124:127],v[40:43],v[204:207]
ds_read_b128 v[124:127],v1 offset:6144
v_fma_f32 v101,v101,s36,v16
v_mfma_f32_16x16x32_bf16 v[200:203],v[120:123],v[40:43],v[200:203]
buffer_load_dwordx4 v7,s[8:11],s21 offen offset:1024 lds
s_waitcnt lgkmcnt(2)
v_mfma_f32_16x16x32_bf16 v[72:75],v[116:119],a[164:167],0
s_waitcnt lgkmcnt(1)
ds_read_b128 v[120:123],v0 offset:6144
v_fma_f32 v102,v102,s36,v16
v_mfma_f32_16x16x32_bf16 v[72:75],v[112:115],a[160:163],v[72:75]
v_exp_f32 v85,v85
v_mfma_f32_16x16x32_bf16 v[72:75],v[140:143],a[156:159],v[72:75]
v_exp_f32 v86,v86
v_mfma_f32_16x16x32_bf16 v[72:75],v[136:139],a[152:155],v[72:75]
v_exp_f32 v87,v87
v_mfma_f32_16x16x32_bf16 v[72:75],v[132:135],a[148:151],v[72:75]
v_cvt_pk_bf16_f32 v26,v84,v85
v_cvt_pk_bf16_f32 v27,v86,v87
v_mfma_f32_16x16x32_bf16 v[72:75],v[128:131],a[144:147],v[72:75]
v_exp_f32 v92,v92
v_smfmac_f32_16x16x64_bf16 v[60:63],v[152:155],v[20:27],v18
v_fma_f32 v103,v103,s36,v16
v_mfma_f32_16x16x32_bf16 v[80:83],v[128:131],a[168:171],0
v_exp_f32 v93,v93
v_mfma_f32_16x16x32_bf16 v[80:83],v[132:135],a[172:175],v[80:83]
buffer_load_dwordx4 v8,s[8:11],s21 offen offset:2048 lds
v_mfma_f32_16x16x32_bf16 v[80:83],v[136:139],a[176:179],v[80:83]
s_add_u32 s21,s21,12288
v_exp_f32 v94,v94
v_mfma_f32_16x16x32_bf16 v[80:83],v[140:143],a[180:183],v[80:83]
s_add_u32 m0,s22,24576
v_exp_f32 v95,v95
v_mfma_f32_16x16x32_bf16 v[80:83],v[112:115],a[184:187],v[80:83]
v_cvt_pk_bf16_f32 v30,v92,v93
v_cvt_pk_bf16_f32 v31,v94,v95
v_mfma_f32_16x16x32_bf16 v[80:83],v[116:119],a[188:191],v[80:83]
v_exp_f32 v100,v100
v_mfma_f32_16x16x32_bf16 v[88:91],v[116:119],a[212:215],0
v_exp_f32 v101,v101
v_mfma_f32_16x16x32_bf16 v[88:91],v[112:115],a[208:211],v[88:91]
v_exp_f32 v102,v102
v_mfma_f32_16x16x32_bf16 v[88:91],v[140:143],a[204:207],v[88:91]
v_exp_f32 v103,v103
v_mfma_f32_16x16x32_bf16 v[88:91],v[136:139],a[200:203],v[88:91]
v_cvt_pk_bf16_f32 v34,v100,v101
v_cvt_pk_bf16_f32 v35,v102,v103
v_mfma_f32_16x16x32_bf16 v[88:91],v[132:135],a[196:199],v[88:91]
buffer_load_dwordx4 v6,s[4:7],s20 offen offset:0 lds
v_smfmac_f32_16x16x64_bf16 v[64:67],v[152:155],v[28:35],v18
v_fma_f32 v72,v72,s36,v13
v_mfma_f32_16x16x32_bf16 v[88:91],v[128:131],a[192:195],v[88:91]
v_fma_f32 v73,v73,s36,v13
v_fma_f32 v74,v74,s36,v13
v_mfma_f32_16x16x32_bf16 v[96:99],v[128:131],a[216:219],0
ds_read_b128 v[128:131],v0 offset:6272
v_fma_f32 v75,v75,s36,v13
v_mfma_f32_16x16x32_bf16 v[96:99],v[132:135],a[220:223],v[96:99]
ds_read_b128 v[132:135],v1 offset:6272
v_fma_f32 v80,v80,s36,v14
v_mfma_f32_16x16x32_bf16 v[96:99],v[136:139],a[224:227],v[96:99]
ds_read_b128 v[136:139],v0 offset:6400
v_fma_f32 v81,v81,s36,v14
v_mfma_f32_16x16x32_bf16 v[96:99],v[140:143],a[228:231],v[96:99]
ds_read_b128 v[140:143],v1 offset:6400
v_add_u32 v10,9216,v10
v_mfma_f32_16x16x32_bf16 v[96:99],v[112:115],a[232:235],v[96:99]
v_exp_f32 v72,v72
v_mfma_f32_16x16x32_bf16 v[96:99],v[116:119],a[236:239],v[96:99]
s_waitcnt lgkmcnt(4)
v_exp_f32 v73,v73
v_mfma_f32_16x16x32_bf16 v[76:79],v[120:123],a[144:147],0
buffer_load_dwordx4 v7,s[4:7],s20 offen offset:1024 lds
v_mfma_f32_16x16x32_bf16 v[76:79],v[124:127],a[148:151],v[76:79]
s_waitcnt lgkmcnt(3)
v_exp_f32 v74,v74
v_exp_f32 v75,v75
v_exp_f32 v80,v80
v_mfma_f32_16x16x32_bf16 v[76:79],v[128:131],a[152:155],v[76:79]
s_waitcnt lgkmcnt(2)
v_exp_f32 v81,v81
v_mfma_f32_16x16x32_bf16 v[76:79],v[132:135],a[156:159],v[76:79]
s_waitcnt lgkmcnt(1)
v_cvt_pk_bf16_f32 v40,v72,v73
v_cvt_pk_bf16_f32 v41,v74,v75
v_mfma_f32_16x16x32_bf16 v[76:79],v[136:139],a[160:163],v[76:79]
s_waitcnt lgkmcnt(0)
v_cvt_pk_bf16_f32 v44,v80,v81
v_mfma_f32_16x16x32_bf16 v[76:79],v[140:143],a[164:167],v[76:79]
v_mfma_f32_16x16x32_bf16 v[84:87],v[140:143],a[188:191],0
v_mfma_f32_16x16x32_bf16 v[84:87],v[136:139],a[184:187],v[84:87]
v_mfma_f32_16x16x32_bf16 v[84:87],v[132:135],a[180:183],v[84:87]
buffer_load_dwordx4 v8,s[4:7],s20 offen offset:2048 lds
v_mfma_f32_16x16x32_bf16 v[84:87],v[128:131],a[176:179],v[84:87]
s_add_u32 s20,s20,12288
s_add_u32 s38,s38,1
s_cmp_lt_u32 s38,2
v_mfma_f32_16x16x32_bf16 v[84:87],v[124:127],a[172:175],v[84:87]
ds_read_b64_tr_b16 v[112:113],v2 offset:24576
v_mfma_f32_16x16x32_bf16 v[84:87],v[120:123],a[168:171],v[84:87]
ds_read_b64_tr_b16 v[114:115],v2 offset:30720
v_mfma_f32_16x16x32_bf16 v[92:95],v[120:123],a[192:195],0
ds_read_b64_tr_b16 v[116:117],v3 offset:24576
v_mfma_f32_16x16x32_bf16 v[92:95],v[124:127],a[196:199],v[92:95]
ds_read_b64_tr_b16 v[118:119],v3 offset:30720
v_mfma_f32_16x16x32_bf16 v[92:95],v[128:131],a[200:203],v[92:95]
v_mfma_f32_16x16x32_bf16 v[92:95],v[132:135],a[204:207],v[92:95]
v_mfma_f32_16x16x32_bf16 v[92:95],v[136:139],a[208:211],v[92:95]
v_mfma_f32_16x16x32_bf16 v[92:95],v[140:143],a[212:215],v[92:95]
v_mfma_f32_16x16x32_bf16 v[100:103],v[140:143],a[236:239],0
v_mfma_f32_16x16x32_bf16 v[100:103],v[136:139],a[232:235],v[100:103]
v_mfma_f32_16x16x32_bf16 v[100:103],v[132:135],a[228:231],v[100:103]
v_mfma_f32_16x16x32_bf16 v[100:103],v[128:131],a[224:227],v[100:103]
v_mfma_f32_16x16x32_bf16 v[100:103],v[124:127],a[220:223],v[100:103]
ds_read_b64_tr_b16 v[124:125],v5 offset:24576
v_mfma_f32_16x16x32_bf16 v[100:103],v[120:123],a[216:219],v[100:103]
ds_read_b64_tr_b16 v[120:121],v4 offset:24576
ds_read_b64_tr_b16 v[122:123],v4 offset:30720
ds_read_b64_tr_b16 v[126:127],v5 offset:30720
s_cbranch_scc1 L_loop4w0
s_cmp_ge_u32 s69,6
s_cbranch_scc1 L_end4
s_cmp_eq_u32 s40,0
s_cbranch_scc1 L_tr44
s_branch L_tr45
L_tr45:
s_waitcnt vmcnt(42)
s_waitcnt lgkmcnt(4)
v_mfma_f32_16x16x32_bf16 v[160:163],v[112:115],v[20:23],v[160:163]
s_add_u32 m0,s24,0
ds_read_b128 a[144:147],v11 offset:0
v_fma_f32 v82,v82,s36,v14
v_mfma_f32_16x16x32_bf16 v[164:167],v[116:119],v[20:23],v[164:167]
ds_read_b128 a[148:151],v12 offset:0
v_fma_f32 v83,v83,s36,v14
v_mfma_f32_16x16x32_bf16 v[212:215],v[116:119],v[24:27],v[212:215]
ds_read_b128 a[152:155],v11 offset:128
v_fma_f32 v88,v88,s36,v15
v_mfma_f32_16x16x32_bf16 v[208:211],v[112:115],v[24:27],v[208:211]
ds_read_b128 a[156:159],v12 offset:128
v_fma_f32 v89,v89,s36,v15
v_mfma_f32_16x16x32_bf16 a[0:3],v[112:115],v[28:31],a[0:3]
ds_read_b128 a[160:163],v11 offset:256
v_fma_f32 v90,v90,s36,v15
v_mfma_f32_16x16x32_bf16 a[4:7],v[116:119],v[28:31],a[4:7]
ds_read_b128 a[164:167],v12 offset:256
v_fma_f32 v91,v91,s36,v15
ds_read_b64_tr_b16 v[128:129],v2 offset:24704
ds_read_b64_tr_b16 v[130:131],v2 offset:30848
ds_read_b64_tr_b16 v[132:133],v3 offset:24704
ds_read_b64_tr_b16 v[134:135],v3 offset:30848
ds_read_b64_tr_b16 v[136:137],v4 offset:24704
ds_read_b64_tr_b16 v[138:139],v4 offset:30848
ds_read_b64_tr_b16 v[140:141],v5 offset:24704
ds_read_b64_tr_b16 v[142:143],v5 offset:30848
ds_read_b128 a[168:171],v11 offset:6144
v_mfma_f32_16x16x32_bf16 a[52:55],v[116:119],v[32:35],a[52:55]
v_fma_f32 v96,v96,s36,v16
ds_read_b128 a[172:175],v12 offset:6144
v_mfma_f32_16x16x32_bf16 a[48:51],v[112:115],v[32:35],a[48:51]
s_waitcnt lgkmcnt(13)
v_fma_f32 v97,v97,s36,v16
ds_read_b128 a[176:179],v11 offset:6272
v_mfma_f32_16x16x32_bf16 a[56:59],v[120:123],v[32:35],a[56:59]
s_waitcnt lgkmcnt(11)
buffer_load_dwordx4 v6,s[12:15],s28 offen offset:0 nt lds
v_mfma_f32_16x16x32_bf16 a[60:63],v[124:127],v[32:35],a[60:63]
ds_read_b64_tr_b16 v[112:113],v2 offset:24832
ds_read_b128 a[180:183],v12 offset:6272
v_mfma_f32_16x16x32_bf16 a[12:15],v[124:127],v[28:31],a[12:15]
v_fma_f32 v98,v98,s36,v16
ds_read_b64_tr_b16 v[116:117],v3 offset:24832
ds_read_b64_tr_b16 v[118:119],v3 offset:30976
ds_read_b64_tr_b16 v[114:115],v2 offset:30976
ds_read_b128 a[184:187],v11 offset:6400
v_mfma_f32_16x16x32_bf16 a[8:11],v[120:123],v[28:31],a[8:11]
v_fma_f32 v99,v99,s36,v16
ds_read_b128 a[188:191],v12 offset:6400
v_mfma_f32_16x16x32_bf16 v[216:219],v[120:123],v[24:27],v[216:219]
buffer_load_dwordx4 v7,s[12:15],s28 offen offset:1024 nt lds
v_mfma_f32_16x16x32_bf16 v[220:223],v[124:127],v[24:27],v[220:223]
v_fma_f32 v76,v76,s36,v13
v_fma_f32 v77,v77,s36,v13
v_mfma_f32_16x16x32_bf16 v[172:175],v[124:127],v[20:23],v[172:175]
ds_read_b64_tr_b16 v[124:125],v5 offset:24832
v_fma_f32 v78,v78,s36,v13
v_mfma_f32_16x16x32_bf16 v[168:171],v[120:123],v[20:23],v[168:171]
s_waitcnt lgkmcnt(8)
ds_read_b64_tr_b16 v[120:121],v4 offset:24832
v_fma_f32 v79,v79,s36,v13
v_mfma_f32_16x16x32_bf16 v[176:179],v[128:131],v[20:23],v[176:179]
ds_read_b64_tr_b16 v[122:123],v4 offset:30976
v_fma_f32 v84,v84,s36,v14
v_mfma_f32_16x16x32_bf16 v[180:183],v[132:135],v[20:23],v[180:183]
ds_read_b64_tr_b16 v[126:127],v5 offset:30976
v_fma_f32 v85,v85,s36,v14
v_mfma_f32_16x16x32_bf16 v[228:231],v[132:135],v[24:27],v[228:231]
v_fma_f32 v86,v86,s36,v14
v_fma_f32 v87,v87,s36,v14
v_mfma_f32_16x16x32_bf16 v[224:227],v[128:131],v[24:27],v[224:227]
buffer_load_dwordx4 v8,s[12:15],s28 offen offset:2048 nt lds
v_mfma_f32_16x16x32_bf16 a[16:19],v[128:131],v[28:31],a[16:19]
s_add_u32 s28,s28,3072
v_fma_f32 v92,v92,s36,v15
v_fma_f32 v93,v93,s36,v15
v_mfma_f32_16x16x32_bf16 a[20:23],v[132:135],v[28:31],a[20:23]
s_add_u32 m0,s24,3072
v_fma_f32 v94,v94,s36,v15
v_fma_f32 v95,v95,s36,v15
v_mfma_f32_16x16x32_bf16 a[68:71],v[132:135],v[32:35],a[68:71]
v_fma_f32 v100,v100,s36,v16
v_fma_f32 v101,v101,s36,v16
v_mfma_f32_16x16x32_bf16 a[64:67],v[128:131],v[32:35],a[64:67]
v_fma_f32 v102,v102,s36,v16
v_fma_f32 v103,v103,s36,v16
v_mfma_f32_16x16x32_bf16 a[72:75],v[136:139],v[32:35],a[72:75]
v_exp_f32 v82,v82
v_mfma_f32_16x16x32_bf16 a[76:79],v[140:143],v[32:35],a[76:79]
v_exp_f32 v83,v83
v_mfma_f32_16x16x32_bf16 a[28:31],v[140:143],v[28:31],a[28:31]
v_exp_f32 v88,v88
v_mfma_f32_16x16x32_bf16 a[24:27],v[136:139],v[28:31],a[24:27]
buffer_load_dwordx4 v6,s[12:15],s28 offen offset:0 nt lds
v_mfma_f32_16x16x32_bf16 v[232:235],v[136:139],v[24:27],v[232:235]
v_exp_f32 v89,v89
v_mfma_f32_16x16x32_bf16 v[236:239],v[140:143],v[24:27],v[236:239]
v_exp_f32 v90,v90
v_mfma_f32_16x16x32_bf16 v[188:191],v[140:143],v[20:23],v[188:191]
v_exp_f32 v91,v91
v_mfma_f32_16x16x32_bf16 v[184:187],v[136:139],v[20:23],v[184:187]
s_waitcnt lgkmcnt(0)
v_exp_f32 v96,v96
v_mfma_f32_16x16x32_bf16 v[192:195],v[112:115],v[20:23],v[192:195]
v_exp_f32 v97,v97
v_mfma_f32_16x16x32_bf16 v[196:199],v[116:119],v[20:23],v[196:199]
v_exp_f32 v98,v98
v_mfma_f32_16x16x32_bf16 v[244:247],v[116:119],v[24:27],v[244:247]
v_exp_f32 v99,v99
v_mfma_f32_16x16x32_bf16 v[240:243],v[112:115],v[24:27],v[240:243]
buffer_load_dwordx4 v7,s[12:15],s28 offen offset:1024 nt lds
v_mfma_f32_16x16x32_bf16 a[32:35],v[112:115],v[28:31],a[32:35]
v_exp_f32 v76,v76
v_mfma_f32_16x16x32_bf16 a[36:39],v[116:119],v[28:31],a[36:39]
v_exp_f32 v77,v77
v_mfma_f32_16x16x32_bf16 a[84:87],v[116:119],v[32:35],a[84:87]
v_exp_f32 v78,v78
v_mfma_f32_16x16x32_bf16 a[80:83],v[112:115],v[32:35],a[80:83]
v_exp_f32 v79,v79
v_mfma_f32_16x16x32_bf16 a[88:91],v[120:123],v[32:35],a[88:91]
v_exp_f32 v84,v84
v_mfma_f32_16x16x32_bf16 a[92:95],v[124:127],v[32:35],a[92:95]
v_exp_f32 v85,v85
v_mfma_f32_16x16x32_bf16 a[44:47],v[124:127],v[28:31],a[44:47]
v_exp_f32 v86,v86
v_mfma_f32_16x16x32_bf16 a[40:43],v[120:123],v[28:31],a[40:43]
buffer_load_dwordx4 v8,s[12:15],s28 offen offset:2048 nt lds
s_waitcnt vmcnt(20)
s_barrier
v_mfma_f32_16x16x32_bf16 v[248:251],v[120:123],v[24:27],v[248:251]
s_add_u32 s28,s28,3072
ds_read_b64_tr_b16 v[128:129],v2 offset:0
v_exp_f32 v87,v87
v_mfma_f32_16x16x32_bf16 v[252:255],v[124:127],v[24:27],v[252:255]
s_add_u32 m0,s22,0
ds_read_b64_tr_b16 v[130:131],v2 offset:6144
buffer_load_dwordx4 v6,s[4:7],s25 offen offset:0 lds
v_mfma_f32_16x16x32_bf16 v[204:207],v[124:127],v[20:23],v[204:207]
buffer_load_dwordx4 v7,s[4:7],s25 offen offset:1024 lds
v_mfma_f32_16x16x32_bf16 v[200:203],v[120:123],v[20:23],v[200:203]
buffer_load_dwordx4 v8,s[4:7],s25 offen offset:2048 lds
ds_read_b64_tr_b16 v[132:133],v3 offset:0
ds_read_b64_tr_b16 v[134:135],v3 offset:6144
ds_read_b64_tr_b16 v[136:137],v4 offset:0
ds_read_b64_tr_b16 v[138:139],v4 offset:6144
ds_read_b64_tr_b16 v[140:141],v5 offset:0
ds_read_b64_tr_b16 v[142:143],v5 offset:6144
v_exp_f32 v92,v92
v_exp_f32 v93,v93
v_exp_f32 v94,v94
v_exp_f32 v95,v95
v_exp_f32 v100,v100
v_exp_f32 v101,v101
v_exp_f32 v102,v102
v_exp_f32 v103,v103
v_cvt_pk_bf16_f32 v45,v82,v83
v_cvt_pk_bf16_f32 v48,v88,v89
v_cvt_pk_bf16_f32 v49,v90,v91
v_cvt_pk_bf16_f32 v52,v96,v97
v_cvt_pk_bf16_f32 v53,v98,v99
v_cvt_pk_bf16_f32 v42,v76,v77
v_cvt_pk_bf16_f32 v43,v78,v79
v_cvt_pk_bf16_f32 v46,v84,v85
v_cvt_pk_bf16_f32 v47,v86,v87
v_cvt_pk_bf16_f32 v50,v92,v93
v_cvt_pk_bf16_f32 v51,v94,v95
v_smfmac_f32_16x16x64_bf16 v[60:63],v[152:155],v[40:47],v18
v_cvt_pk_bf16_f32 v54,v100,v101
v_cvt_pk_bf16_f32 v55,v102,v103
v_subrev_u32 v10,18432,v10
s_nop 0
v_smfmac_f32_16x16x64_bf16 v[64:67],v[152:155],v[48:55],v18
s_waitcnt lgkmcnt(0)
v_mfma_f32_16x16x32_bf16 v[160:163],v[128:131],v[40:43],v[160:163]
s_add_u32 s87,s42,18432
ds_read_b64_tr_b16 v[112:113],v2 offset:128
v_mbcnt_lo_u32_b32 v39,-1,0
v_mfma_f32_16x16x32_bf16 v[164:167],v[132:135],v[40:43],v[164:167]
ds_read_b64_tr_b16 v[114:115],v2 offset:6272
v_mbcnt_hi_u32_b32 v39,-1,v39
v_mfma_f32_16x16x32_bf16 v[212:215],v[132:135],v[44:47],v[212:215]
ds_read_b64_tr_b16 v[116:117],v3 offset:128
v_and_b32 v38,7,v39
v_mfma_f32_16x16x32_bf16 v[208:211],v[128:131],v[44:47],v[208:211]
ds_read_b64_tr_b16 v[118:119],v3 offset:6272
v_add_f32 v60,v60,v61
v_mfma_f32_16x16x32_bf16 a[0:3],v[128:131],v[48:51],a[0:3]
ds_read_b64_tr_b16 v[120:121],v4 offset:128
v_add_f32 v62,v62,v63
v_mfma_f32_16x16x32_bf16 a[4:7],v[132:135],v[48:51],a[4:7]
ds_read_b64_tr_b16 v[122:123],v4 offset:6272
ds_read_b64_tr_b16 v[124:125],v5 offset:128
ds_read_b64_tr_b16 v[126:127],v5 offset:6272
v_mfma_f32_16x16x32_bf16 a[52:55],v[132:135],v[52:55],a[52:55]
ds_read_b64_tr_b16 v[132:133],v3 offset:256
v_add_f32 v64,v64,v65
v_mfma_f32_16x16x32_bf16 a[48:51],v[128:131],v[52:55],a[48:51]
ds_read_b64_tr_b16 v[128:129],v2 offset:256
v_add_f32 v66,v66,v67
v_mfma_f32_16x16x32_bf16 a[56:59],v[136:139],v[52:55],a[56:59]
ds_read_b64_tr_b16 v[130:131],v2 offset:6400
v_max3_f32 v19,v60,v62,v64
v_mfma_f32_16x16x32_bf16 a[60:63],v[140:143],v[52:55],a[60:63]
ds_read_b64_tr_b16 v[134:135],v3 offset:6400
v_max_f32 v19,v19,v66
v_mfma_f32_16x16x32_bf16 a[12:15],v[140:143],v[48:51],a[12:15]
v_rcp_f32 v66,v66
v_mfma_f32_16x16x32_bf16 a[8:11],v[136:139],v[48:51],a[8:11]
v_accvgpr_read_b32 v80,a52
v_accvgpr_read_b32 v81,a53
v_mfma_f32_16x16x32_bf16 v[216:219],v[136:139],v[44:47],v[216:219]
v_accvgpr_read_b32 v82,a54
v_accvgpr_read_b32 v83,a55
v_mfma_f32_16x16x32_bf16 v[220:223],v[140:143],v[44:47],v[220:223]
v_accvgpr_read_b32 v72,a48
v_accvgpr_read_b32 v73,a49
v_mfma_f32_16x16x32_bf16 v[172:175],v[140:143],v[40:43],v[172:175]
ds_read_b64_tr_b16 v[140:141],v5 offset:256
v_accvgpr_read_b32 v74,a50
v_mfma_f32_16x16x32_bf16 v[168:171],v[136:139],v[40:43],v[168:171]
s_waitcnt lgkmcnt(4)
ds_read_b64_tr_b16 v[142:143],v5 offset:6400
v_accvgpr_read_b32 v75,a51
v_mfma_f32_16x16x32_bf16 v[176:179],v[112:115],v[40:43],v[176:179]
ds_read_b64_tr_b16 v[136:137],v4 offset:256
v_accvgpr_read_b32 v88,a56
v_mfma_f32_16x16x32_bf16 v[180:183],v[116:119],v[40:43],v[180:183]
ds_read_b64_tr_b16 v[138:139],v4 offset:6400
v_accvgpr_read_b32 v89,a57
v_mfma_f32_16x16x32_bf16 v[228:231],v[116:119],v[44:47],v[228:231]
v_accvgpr_read_b32 v90,a58
v_accvgpr_read_b32 v91,a59
v_mfma_f32_16x16x32_bf16 v[224:227],v[112:115],v[44:47],v[224:227]
v_accvgpr_read_b32 v96,a60
v_accvgpr_read_b32 v97,a61
v_mfma_f32_16x16x32_bf16 a[16:19],v[112:115],v[48:51],a[16:19]
v_accvgpr_read_b32 v98,a62
v_accvgpr_read_b32 v99,a63
v_mfma_f32_16x16x32_bf16 a[20:23],v[116:119],v[48:51],a[20:23]
v_cmp_ngt_f32 vcc,s37,v19
v_lshrrev_b32 v19,5,v39
v_mfma_f32_16x16x32_bf16 a[68:71],v[116:119],v[52:55],a[68:71]
v_xor_b32 v38,v38,v19
v_and_b32 v19,15,v39
v_mfma_f32_16x16x32_bf16 a[64:67],v[112:115],v[52:55],a[64:67]
s_cmp_lg_u64 vcc,0
v_lshl_add_u32 v19,v19,7,s24
v_lshl_add_u32 v19,v38,4,v19
v_mfma_f32_16x16x32_bf16 a[72:75],v[120:123],v[52:55],a[72:75]
s_cselect_b32 s62,s32,0
v_bfe_u32 v38,v39,4,1
v_lshl_add_u32 v36,v38,3,v19
v_mfma_f32_16x16x32_bf16 a[76:79],v[124:127],v[52:55],a[76:79]
s_or_b32 s31,s31,s62
v_xor_b32 v37,32,v36
v_bfe_u32 v19,v39,3,1
v_mfma_f32_16x16x32_bf16 a[28:31],v[124:127],v[48:51],a[28:31]
s_lshl_b32 s32,s32,1
v_xor_b32 v38,64,v36
v_xor_b32 v39,96,v36
v_lshlrev_b32 v19,11,v19
v_accvgpr_read_b32 v84,a68
v_accvgpr_read_b32 v85,a69
v_pk_mul_f32 v[72:73],v[72:73],v[66:67] op_sel_hi:[1,0]
v_pk_mul_f32 v[74:75],v[74:75],v[66:67] op_sel_hi:[1,0]
v_pk_mul_f32 v[80:81],v[80:81],v[66:67] op_sel_hi:[1,0]
v_pk_mul_f32 v[82:83],v[82:83],v[66:67] op_sel_hi:[1,0]
v_pk_mul_f32 v[84:85],v[84:85],v[66:67] op_sel_hi:[1,0]
v_accvgpr_read_b32 v86,a70
v_accvgpr_read_b32 v87,a71
v_pk_mul_f32 v[86:87],v[86:87],v[66:67] op_sel_hi:[1,0]
v_accvgpr_read_b32 v76,a64
v_accvgpr_read_b32 v77,a65
v_pk_mul_f32 v[76:77],v[76:77],v[66:67] op_sel_hi:[1,0]
v_accvgpr_read_b32 v78,a66
v_accvgpr_read_b32 v79,a67
v_pk_mul_f32 v[78:79],v[78:79],v[66:67] op_sel_hi:[1,0]
v_accvgpr_read_b32 v92,a72
v_accvgpr_read_b32 v93,a73
v_mfma_f32_16x16x32_bf16 a[24:27],v[120:123],v[48:51],a[24:27]
s_add_u32 m0,s24,6144
v_accvgpr_read_b32 v94,a74
buffer_load_dwordx4 v6,s[12:15],s28 offen offset:0 nt lds
buffer_load_dwordx4 v7,s[12:15],s28 offen offset:1024 nt lds
buffer_load_dwordx4 v8,s[12:15],s28 offen offset:2048 nt lds
v_pk_mul_f32 v[88:89],v[88:89],v[66:67] op_sel_hi:[1,0]
v_pk_mul_f32 v[90:91],v[90:91],v[66:67] op_sel_hi:[1,0]
v_pk_mul_f32 v[92:93],v[92:93],v[66:67] op_sel_hi:[1,0]
v_accvgpr_read_b32 v95,a75
v_pk_mul_f32 v[94:95],v[94:95],v[66:67] op_sel_hi:[1,0]
v_accvgpr_read_b32 v100,a76
v_accvgpr_read_b32 v101,a77
v_mfma_f32_16x16x32_bf16 v[232:235],v[120:123],v[44:47],v[232:235]
s_add_u32 s28,s28,3072
v_accvgpr_read_b32 v102,a78
v_accvgpr_read_b32 v103,a79
v_cvt_pk_bf16_f32 v72,v72,v73
v_cvt_pk_bf16_f32 v76,v76,v77
v_cvt_pk_bf16_f32 v80,v80,v81
v_pk_mul_f32 v[96:97],v[96:97],v[66:67] op_sel_hi:[1,0]
v_pk_mul_f32 v[98:99],v[98:99],v[66:67] op_sel_hi:[1,0]
v_pk_mul_f32 v[100:101],v[100:101],v[66:67] op_sel_hi:[1,0]
v_pk_mul_f32 v[102:103],v[102:103],v[66:67] op_sel_hi:[1,0]
v_cvt_pk_bf16_f32 v84,v84,v85
v_cvt_pk_bf16_f32 v73,v74,v75
v_mfma_f32_16x16x32_bf16 v[236:239],v[124:127],v[44:47],v[236:239]
s_add_u32 m0,s24,9216
v_cvt_pk_bf16_f32 v77,v78,v79
v_cvt_pk_bf16_f32 v88,v88,v89
v_mfma_f32_16x16x32_bf16 v[188:191],v[124:127],v[40:43],v[188:191]
buffer_load_dwordx4 v6,s[12:15],s28 offen offset:0 nt lds
v_mfma_f32_16x16x32_bf16 v[184:187],v[120:123],v[40:43],v[184:187]
buffer_load_dwordx4 v7,s[12:15],s28 offen offset:1024 nt lds
s_waitcnt lgkmcnt(0)
v_mfma_f32_16x16x32_bf16 v[192:195],v[128:131],v[40:43],v[192:195]
buffer_load_dwordx4 v8,s[12:15],s28 offen offset:2048 nt lds
v_mfma_f32_16x16x32_bf16 v[196:199],v[132:135],v[40:43],v[196:199]
s_add_u32 s28,s28,3072
ds_write2st64_b64 v36,v[72:73],v[76:77] offset0:36 offset1:40
v_mfma_f32_16x16x32_bf16 v[244:247],v[132:135],v[44:47],v[244:247]
s_add_u32 m0,s23,0
v_cvt_pk_bf16_f32 v92,v92,v93
v_cvt_pk_bf16_f32 v81,v82,v83
v_mfma_f32_16x16x32_bf16 v[240:243],v[128:131],v[44:47],v[240:243]
v_cvt_pk_bf16_f32 v85,v86,v87
v_cvt_pk_bf16_f32 v96,v96,v97
v_mfma_f32_16x16x32_bf16 a[32:35],v[128:131],v[48:51],a[32:35]
v_cvt_pk_bf16_f32 v100,v100,v101
v_cvt_pk_bf16_f32 v89,v90,v91
v_mfma_f32_16x16x32_bf16 a[36:39],v[132:135],v[48:51],a[36:39]
ds_write2st64_b64 v37,v[80:81],v[84:85] offset0:36 offset1:40
v_mfma_f32_16x16x32_bf16 a[84:87],v[132:135],v[52:55],a[84:87]
v_cvt_pk_bf16_f32 v93,v94,v95
v_cvt_pk_bf16_f32 v97,v98,v99
v_mfma_f32_16x16x32_bf16 a[80:83],v[128:131],v[52:55],a[80:83]
v_cvt_pk_bf16_f32 v101,v102,v103
v_rcp_f32 v64,v64
v_mfma_f32_16x16x32_bf16 a[88:91],v[136:139],v[52:55],a[88:91]
v_accvgpr_read_b32 v102,a2
v_accvgpr_read_b32 v103,a3
v_mfma_f32_16x16x32_bf16 a[92:95],v[140:143],v[52:55],a[92:95]
ds_write2st64_b64 v38,v[88:89],v[92:93] offset0:36 offset1:40
v_mfma_f32_16x16x32_bf16 a[44:47],v[140:143],v[48:51],a[44:47]
s_waitcnt vmcnt(21)
v_accvgpr_read_b32 v80,a84
ds_read_b128 a[192:195],v11 offset:12288
v_accvgpr_read_b32 v81,a85
ds_read_b128 a[196:199],v12 offset:12288
v_pk_mul_f32 v[80:81],v[80:81],v[66:67] op_sel_hi:[1,0]
ds_read_b128 a[200:203],v11 offset:12416
v_accvgpr_read_b32 v82,a86
ds_read_b128 a[204:207],v12 offset:12416
v_accvgpr_read_b32 v83,a87
ds_read_b128 a[208:211],v11 offset:12544
v_pk_mul_f32 v[82:83],v[82:83],v[66:67] op_sel_hi:[1,0]
ds_read_b128 a[212:215],v12 offset:12544
v_accvgpr_read_b32 v76,a80
ds_write2st64_b64 v39,v[96:97],v[100:101] offset0:36 offset1:40
v_accvgpr_read_b32 v77,a81
v_pk_mul_f32 v[76:77],v[76:77],v[66:67] op_sel_hi:[1,0]
v_accvgpr_read_b32 v78,a82
ds_read_b128 v[156:159],v10 offset:18432
v_accvgpr_read_b32 v79,a83
ds_read_b128 v[104:107],v10 offset:19456
v_pk_mul_f32 v[78:79],v[78:79],v[66:67] op_sel_hi:[1,0]
v_accvgpr_read_b32 v84,a88
v_accvgpr_read_b32 v85,a89
v_mfma_f32_16x16x32_bf16 a[40:43],v[136:139],v[48:51],a[40:43]
ds_read_b128 v[108:111],v10 offset:20480
v_cvt_pk_bf16_f32 v76,v76,v77
ds_read_b128 v[72:75],v10 offset:21504
v_pk_mul_f32 v[84:85],v[84:85],v[66:67] op_sel_hi:[1,0]
v_accvgpr_read_b32 v86,a90
v_accvgpr_read_b32 v87,a91
v_pk_mul_f32 v[86:87],v[86:87],v[66:67] op_sel_hi:[1,0]
v_cvt_pk_bf16_f32 v80,v80,v81
v_cvt_pk_bf16_f32 v77,v78,v79
v_mfma_f32_16x16x32_bf16 v[248:251],v[136:139],v[44:47],v[248:251]
ds_write_b64 v36,v[76:77] offset:18432
v_add_u32 v36,v36,v19
v_cvt_pk_bf16_f32 v84,v84,v85
v_pk_mul_f32 v[102:103],v[102:103],v[64:65] op_sel_hi:[1,0]
v_cvt_pk_bf16_f32 v81,v82,v83
ds_write_b64 v37,v[80:81] offset:18432
s_waitcnt lgkmcnt(5)
buffer_store_dwordx4 v[156:159],v9,s[16:19],s87 offen offset:0 nt
v_add_u32 v37,v37,v19
v_cvt_pk_bf16_f32 v85,v86,v87
v_accvgpr_read_b32 v90,a94
v_accvgpr_read_b32 v91,a95
v_pk_mul_f32 v[90:91],v[90:91],v[66:67] op_sel_hi:[1,0]
v_accvgpr_read_b32 v88,a92
v_accvgpr_read_b32 v89,a93
v_pk_mul_f32 v[88:89],v[88:89],v[66:67] op_sel_hi:[1,0]
v_accvgpr_read_b32 v100,a0
ds_write_b64 v38,v[84:85] offset:18432
s_waitcnt lgkmcnt(3)
buffer_store_dwordx4 v[104:107],v9,s[16:19],s87 offen offset:3072 nt
s_waitcnt vmcnt(8)
s_barrier
ds_read_b128 v[112:115],v0 offset:0
v_add_u32 v38,v38,v19
ds_read_b128 v[116:119],v1 offset:0
v_accvgpr_read_b32 v101,a1
ds_read_b128 v[120:123],v0 offset:128
buffer_store_dwordx4 v[108:111],v9,s[16:19],s87 offen offset:128 nt
ds_read_b128 v[124:127],v1 offset:128
v_pk_mul_f32 v[100:101],v[100:101],v[64:65] op_sel_hi:[1,0]
ds_read_b128 v[128:131],v0 offset:256
v_accvgpr_read_b32 v78,a18
ds_read_b128 v[132:135],v1 offset:256
buffer_load_dwordx4 v6,s[8:11],s25 offen offset:0 lds
buffer_store_dwordx4 v[72:75],v9,s[16:19],s87 offen offset:3200 nt
v_accvgpr_read_b32 v79,a19
v_pk_mul_f32 v[78:79],v[78:79],v[64:65] op_sel_hi:[1,0]
v_accvgpr_read_b32 v76,a16
v_accvgpr_read_b32 v77,a17
v_pk_mul_f32 v[76:77],v[76:77],v[64:65] op_sel_hi:[1,0]
v_accvgpr_read_b32 v82,a6
v_accvgpr_read_b32 v83,a7
v_pk_mul_f32 v[82:83],v[82:83],v[64:65] op_sel_hi:[1,0]
v_accvgpr_read_b32 v80,a4
v_accvgpr_read_b32 v81,a5
v_pk_mul_f32 v[80:81],v[80:81],v[64:65] op_sel_hi:[1,0]
v_accvgpr_read_b32 v86,a26
v_accvgpr_read_b32 v87,a27
v_pk_mul_f32 v[86:87],v[86:87],v[64:65] op_sel_hi:[1,0]
v_accvgpr_read_b32 v84,a24
v_accvgpr_read_b32 v85,a25
v_pk_mul_f32 v[84:85],v[84:85],v[64:65] op_sel_hi:[1,0]
v_accvgpr_read_b32 v104,a20
v_accvgpr_read_b32 v105,a21
v_pk_mul_f32 v[104:105],v[104:105],v[64:65] op_sel_hi:[1,0]
v_accvgpr_read_b32 v106,a22
v_accvgpr_read_b32 v107,a23
v_pk_mul_f32 v[106:107],v[106:107],v[64:65] op_sel_hi:[1,0]
v_accvgpr_read_b32 v108,a8
v_accvgpr_read_b32 v109,a9
buffer_load_dwordx4 v7,s[8:11],s25 offen offset:1024 lds
v_pk_mul_f32 v[108:109],v[108:109],v[64:65] op_sel_hi:[1,0]
v_accvgpr_read_b32 v110,a10
v_accvgpr_read_b32 v111,a11
v_pk_mul_f32 v[110:111],v[110:111],v[64:65] op_sel_hi:[1,0]
v_cvt_pk_bf16_f32 v88,v88,v89
v_cvt_pk_bf16_f32 v89,v90,v91
v_mfma_f32_16x16x32_bf16 v[252:255],v[140:143],v[44:47],v[252:255]
ds_write_b64 v39,v[88:89] offset:18432
v_mfma_f32_16x16x32_bf16 v[204:207],v[140:143],v[40:43],v[204:207]
ds_read_b128 v[92:95],v10 offset:18432
v_add_u32 v39,v39,v19
v_mfma_f32_16x16x32_bf16 v[200:203],v[136:139],v[40:43],v[200:203]
s_waitcnt lgkmcnt(2)
ds_read_b128 v[96:99],v10 offset:19456
v_cvt_pk_bf16_f32 v100,v100,v101
v_mfma_f32_16x16x32_bf16 v[72:75],v[112:115],a[144:147],0
ds_read_b128 v[136:139],v0 offset:6144
v_cvt_pk_bf16_f32 v76,v76,v77
ds_read_b128 v[140:143],v1 offset:6144
v_cvt_pk_bf16_f32 v101,v102,v103
v_cvt_pk_bf16_f32 v77,v78,v79
buffer_load_dwordx4 v8,s[8:11],s25 offen offset:2048 lds
ds_write2st64_b64 v36,v[100:101],v[76:77] offset0:24 offset1:26
v_accvgpr_read_b32 v90,a14
v_accvgpr_read_b32 v91,a15
v_pk_mul_f32 v[90:91],v[90:91],v[64:65] op_sel_hi:[1,0]
v_accvgpr_read_b32 v88,a12
v_accvgpr_read_b32 v89,a13
v_pk_mul_f32 v[88:89],v[88:89],v[64:65] op_sel_hi:[1,0]
v_accvgpr_read_b32 v78,a30
v_accvgpr_read_b32 v79,a31
s_waitcnt lgkmcnt(4)
buffer_store_dwordx4 v[92:95],v9,s[16:19],s87 offen offset:256 nt
v_pk_mul_f32 v[78:79],v[78:79],v[64:65] op_sel_hi:[1,0]
v_accvgpr_read_b32 v76,a28
v_accvgpr_read_b32 v77,a29
v_pk_mul_f32 v[76:77],v[76:77],v[64:65] op_sel_hi:[1,0]
v_rcp_f32 v60,v60
v_accvgpr_read_b32 v102,a34
v_mfma_f32_16x16x32_bf16 v[72:75],v[116:119],a[148:151],v[72:75]
s_add_u32 m0,s23,24576
v_accvgpr_read_b32 v103,a35
v_accvgpr_read_b32 v100,a32
v_mfma_f32_16x16x32_bf16 v[72:75],v[120:123],a[152:155],v[72:75]
buffer_load_dwordx4 v6,s[8:11],s21 offen offset:0 lds
v_mfma_f32_16x16x32_bf16 v[72:75],v[124:127],a[156:159],v[72:75]
s_waitcnt vmcnt(18)
ds_read_b128 a[216:219],v11 offset:0
s_waitcnt lgkmcnt(1)
buffer_store_dwordx4 v[96:99],v9,s[16:19],s87 offen offset:3328 nt
ds_read_b128 a[220:223],v12 offset:0
v_pk_mul_f32 v[102:103],v[102:103],v[64:65] op_sel_hi:[1,0]
ds_read_b128 a[224:227],v11 offset:128
v_pk_mul_f32 v[160:161],v[160:161],v[60:61] op_sel_hi:[1,0]
ds_read_b128 a[228:231],v12 offset:128
v_pk_mul_f32 v[162:163],v[162:163],v[60:61] op_sel_hi:[1,0]
ds_read_b128 a[232:235],v11 offset:256
v_accvgpr_read_b32 v101,a33
ds_read_b128 a[236:239],v12 offset:256
v_pk_mul_f32 v[100:101],v[100:101],v[64:65] op_sel_hi:[1,0]
v_cvt_pk_bf16_f32 v80,v80,v81
v_cvt_pk_bf16_f32 v104,v104,v105
v_mfma_f32_16x16x32_bf16 v[72:75],v[128:131],a[160:163],v[72:75]
v_cvt_pk_bf16_f32 v81,v82,v83
v_cvt_pk_bf16_f32 v105,v106,v107
v_mfma_f32_16x16x32_bf16 v[72:75],v[132:135],a[164:167],v[72:75]
ds_write2st64_b64 v37,v[80:81],v[104:105] offset0:24 offset1:26
v_mfma_f32_16x16x32_bf16 v[80:83],v[132:135],a[188:191],0
v_accvgpr_read_b32 v92,a36
v_accvgpr_read_b32 v93,a37
v_mfma_f32_16x16x32_bf16 v[80:83],v[128:131],a[184:187],v[80:83]
v_accvgpr_read_b32 v94,a38
v_accvgpr_read_b32 v95,a39
buffer_load_dwordx4 v7,s[8:11],s21 offen offset:1024 lds
v_pk_mul_f32 v[92:93],v[92:93],v[64:65] op_sel_hi:[1,0]
v_pk_mul_f32 v[164:165],v[164:165],v[60:61] op_sel_hi:[1,0]
v_pk_mul_f32 v[166:167],v[166:167],v[60:61] op_sel_hi:[1,0]
v_pk_mul_f32 v[94:95],v[94:95],v[64:65] op_sel_hi:[1,0]
v_cvt_pk_bf16_f32 v84,v84,v85
v_cvt_pk_bf16_f32 v108,v108,v109
v_mfma_f32_16x16x32_bf16 v[80:83],v[124:127],a[180:183],v[80:83]
v_cvt_pk_bf16_f32 v88,v88,v89
v_cvt_pk_bf16_f32 v76,v76,v77
v_mfma_f32_16x16x32_bf16 v[80:83],v[120:123],a[176:179],v[80:83]
v_cvt_pk_bf16_f32 v85,v86,v87
v_cvt_pk_bf16_f32 v109,v110,v111
v_mfma_f32_16x16x32_bf16 v[80:83],v[116:119],a[172:175],v[80:83]
ds_write2st64_b64 v38,v[108:109],v[84:85] offset0:24 offset1:26
v_mfma_f32_16x16x32_bf16 v[80:83],v[112:115],a[168:171],v[80:83]
v_accvgpr_read_b32 v96,a40
v_accvgpr_read_b32 v97,a41
v_accvgpr_read_b32 v98,a42
v_accvgpr_read_b32 v99,a43
v_cvt_pk_bf16_f32 v89,v90,v91
v_pk_mul_f32 v[168:169],v[168:169],v[60:61] op_sel_hi:[1,0]
v_pk_mul_f32 v[170:171],v[170:171],v[60:61] op_sel_hi:[1,0]
v_pk_mul_f32 v[96:97],v[96:97],v[64:65] op_sel_hi:[1,0]
v_pk_mul_f32 v[98:99],v[98:99],v[64:65] op_sel_hi:[1,0]
v_cvt_pk_bf16_f32 v77,v78,v79
ds_write2st64_b64 v39,v[88:89],v[76:77] offset0:24 offset1:26
v_mfma_f32_16x16x32_bf16 v[88:91],v[112:115],a[192:195],0
v_accvgpr_read_b32 v106,a46
v_accvgpr_read_b32 v107,a47
v_mfma_f32_16x16x32_bf16 v[88:91],v[116:119],a[196:199],v[88:91]
ds_read_b128 v[112:115],v0 offset:6272
buffer_load_dwordx4 v8,s[8:11],s21 offen offset:2048 lds
v_mfma_f32_16x16x32_bf16 v[88:91],v[120:123],a[200:203],v[88:91]
s_add_u32 s21,s21,12288
ds_read_b128 v[116:119],v1 offset:6272
v_accvgpr_read_b32 v104,a44
v_mfma_f32_16x16x32_bf16 v[88:91],v[124:127],a[204:207],v[88:91]
s_mov_b32 s27,s42
ds_read_b128 v[120:123],v0 offset:6400
v_accvgpr_read_b32 v105,a45
ds_read_b128 v[124:127],v1 offset:6400
v_pk_mul_f32 v[106:107],v[106:107],v[64:65] op_sel_hi:[1,0]
v_pk_mul_f32 v[172:173],v[172:173],v[60:61] op_sel_hi:[1,0]
v_pk_mul_f32 v[174:175],v[174:175],v[60:61] op_sel_hi:[1,0]
v_pk_mul_f32 v[104:105],v[104:105],v[64:65] op_sel_hi:[1,0]
v_cvt_pk_bf16_f32 v160,v160,v161
v_cvt_pk_bf16_f32 v100,v100,v101
v_mfma_f32_16x16x32_bf16 v[88:91],v[128:131],a[208:211],v[88:91]
s_mov_b32 s42,s41
ds_read_b128 v[128:131],v0 offset:0
v_cvt_pk_bf16_f32 v92,v92,v93
v_mfma_f32_16x16x32_bf16 v[88:91],v[132:135],a[212:215],v[88:91]
s_waitcnt vmcnt(12)
ds_read_b128 a[240:243],v11 offset:6144
v_cvt_pk_bf16_f32 v164,v164,v165
v_mfma_f32_16x16x32_bf16 v[76:79],v[136:139],a[144:147],0
s_add_u32 s69,s69,1
ds_read_b128 a[244:247],v12 offset:6144
v_cvt_pk_bf16_f32 v161,v162,v163
ds_read_b128 a[248:251],v11 offset:6272
v_pk_mul_f32 v[176:177],v[176:177],v[60:61] op_sel_hi:[1,0]
ds_read_b128 a[252:255],v12 offset:6272
v_pk_mul_f32 v[178:179],v[178:179],v[60:61] op_sel_hi:[1,0]
ds_read_b128 v[144:147],v11 offset:6400
v_pk_mul_f32 v[192:193],v[192:193],v[60:61] op_sel_hi:[1,0]
ds_read_b128 v[148:151],v12 offset:6400
v_pk_mul_f32 v[194:195],v[194:195],v[60:61] op_sel_hi:[1,0]
ds_read_b128 v[132:135],v1 offset:0
v_cvt_pk_bf16_f32 v101,v102,v103
v_mfma_f32_16x16x32_bf16 v[76:79],v[140:143],a[148:151],v[76:79]
s_lshl_b32 s62,s69,5
ds_write2st64_b64 v36,v[100:101],v[160:161] offset0:28 offset1:0
s_waitcnt lgkmcnt(8)
v_mfma_f32_16x16x32_bf16 v[76:79],v[112:115],a[152:155],v[76:79]
s_add_u32 s62,s62,s34
v_cvt_pk_bf16_f32 v93,v94,v95
v_cvt_pk_bf16_f32 v165,v166,v167
v_mfma_f32_16x16x32_bf16 v[76:79],v[116:119],a[156:159],v[76:79]
s_mul_i32 s63,s62,171
v_rcp_f32 v62,v62
v_mfma_f32_16x16x32_bf16 v[76:79],v[120:123],a[160:163],v[76:79]
s_lshr_b32 s63,s63,9
v_cvt_pk_bf16_f32 v168,v168,v169
ds_write2st64_b64 v37,v[92:93],v[164:165] offset0:28 offset1:0
v_pk_mul_f32 v[180:181],v[180:181],v[60:61] op_sel_hi:[1,0]
v_pk_mul_f32 v[182:183],v[182:183],v[60:61] op_sel_hi:[1,0]
v_pk_mul_f32 v[196:197],v[196:197],v[60:61] op_sel_hi:[1,0]
v_pk_mul_f32 v[198:199],v[198:199],v[60:61] op_sel_hi:[1,0]
v_cvt_pk_bf16_f32 v96,v96,v97
v_cvt_pk_bf16_f32 v169,v170,v171
v_mfma_f32_16x16x32_bf16 v[76:79],v[124:127],a[164:167],v[76:79]
s_mul_i32 s64,s63,3
v_cvt_pk_bf16_f32 v97,v98,v99
v_cvt_pk_bf16_f32 v172,v172,v173
v_mfma_f32_16x16x32_bf16 v[84:87],v[124:127],a[188:191],0
s_sub_u32 s62,s62,s64
v_cvt_pk_bf16_f32 v104,v104,v105
v_cvt_pk_bf16_f32 v173,v174,v175
v_mfma_f32_16x16x32_bf16 v[84:87],v[120:123],a[184:187],v[84:87]
s_add_u32 s63,s63,s33
ds_write2st64_b64 v38,v[96:97],v[168:169] offset0:28 offset1:0
v_mfma_f32_16x16x32_bf16 v[84:87],v[116:119],a[180:183],v[84:87]
s_mul_i32 s30,s63,196608
v_cvt_pk_bf16_f32 v105,v106,v107
v_max3_f32 v40,v72,v73,v74
v_max3_f32 v40,v40,v75,v76
v_max3_f32 v40,v40,v77,v78
v_max_f32 v40,v40,v79
v_pk_mul_f32 v[184:185],v[184:185],v[60:61] op_sel_hi:[1,0]
v_pk_mul_f32 v[186:187],v[186:187],v[60:61] op_sel_hi:[1,0]
v_pk_mul_f32 v[200:201],v[200:201],v[60:61] op_sel_hi:[1,0]
v_pk_mul_f32 v[202:203],v[202:203],v[60:61] op_sel_hi:[1,0]
v_mov_b32 v41,v40
v_max3_f32 v44,v80,v81,v82
v_mfma_f32_16x16x32_bf16 v[84:87],v[112:115],a[176:179],v[84:87]
s_mul_i32 s41,s63,325632
ds_write2st64_b64 v39,v[104:105],v[172:173] offset0:28 offset1:0
v_mfma_f32_16x16x32_bf16 v[84:87],v[140:143],a[172:175],v[84:87]
s_lshl_b32 s63,s3,2
v_permlane32_swap_b32 v41,v40
v_mfma_f32_16x16x32_bf16 v[84:87],v[136:139],a[168:171],v[84:87]
s_add_u32 s64,s63,21
v_max_f32 v40,v40,v41
v_mov_b32 v41,v40
v_max3_f32 v48,v88,v89,v90
v_cvt_pk_bf16_f32 v176,v176,v177
v_permlane16_swap_b32 v41,v40
v_pk_mul_f32 v[188:189],v[188:189],v[60:61] op_sel_hi:[1,0]
v_pk_mul_f32 v[190:191],v[190:191],v[60:61] op_sel_hi:[1,0]
v_pk_mul_f32 v[204:205],v[204:205],v[60:61] op_sel_hi:[1,0]
v_pk_mul_f32 v[206:207],v[206:207],v[60:61] op_sel_hi:[1,0]
v_max_f32 v40,v40,v41
v_mul_f32_e64 v13,-s36,v40
v_mfma_f32_16x16x32_bf16 v[92:95],v[136:139],a[192:195],0
s_cmp_eq_u32 s3,0
ds_read_b128 v[136:139],v0 offset:128
v_fma_f32 v72,v72,s36,v13
v_mfma_f32_16x16x32_bf16 v[92:95],v[140:143],a[196:199],v[92:95]
s_cselect_b32 s64,20,s64
ds_read_b128 v[140:143],v1 offset:128
v_fma_f32 v73,v73,s36,v13
v_mfma_f32_16x16x32_bf16 v[92:95],v[112:115],a[200:203],v[92:95]
s_cselect_b32 s40,1,0
ds_read_b128 v[112:115],v0 offset:256
v_fma_f32 v74,v74,s36,v13
v_mfma_f32_16x16x32_bf16 v[92:95],v[116:119],a[204:207],v[92:95]
s_add_u32 s65,s63,37
ds_read_b128 v[116:119],v1 offset:256
v_fma_f32 v75,v75,s36,v13
v_exp_f32 v72,v72
v_exp_f32 v73,v73
v_pk_mul_f32 v[208:209],v[208:209],v[62:63] op_sel_hi:[1,0]
v_pk_mul_f32 v[210:211],v[210:211],v[62:63] op_sel_hi:[1,0]
v_pk_mul_f32 v[224:225],v[224:225],v[62:63] op_sel_hi:[1,0]
v_pk_mul_f32 v[226:227],v[226:227],v[62:63] op_sel_hi:[1,0]
v_exp_f32 v74,v74
v_exp_f32 v75,v75
v_mfma_f32_16x16x32_bf16 v[92:95],v[120:123],a[208:211],v[92:95]
s_cmp_eq_u32 s62,2
ds_read_b128 v[120:123],v0 offset:6144
v_cvt_pk_bf16_f32 v20,v72,v73
v_mfma_f32_16x16x32_bf16 v[92:95],v[124:127],a[212:215],v[92:95]
s_cselect_b32 s64,s65,s64
ds_read_b128 v[124:127],v1 offset:6144
v_cvt_pk_bf16_f32 v21,v74,v75
v_max3_f32 v44,v44,v83,v84
v_max3_f32 v44,v44,v85,v86
v_max_f32 v44,v44,v87
v_mov_b32 v45,v44
v_cvt_pk_bf16_f32 v192,v192,v193
v_cvt_pk_bf16_f32 v180,v180,v181
v_permlane32_swap_b32 v45,v44
v_max_f32 v44,v44,v45
v_mov_b32 v45,v44
v_max3_f32 v48,v48,v91,v92
v_max3_f32 v48,v48,v93,v94
v_permlane16_swap_b32 v45,v44
s_waitcnt lgkmcnt(2)
v_mfma_f32_16x16x32_bf16 v[96:99],v[116:119],a[236:239],0
s_cselect_b32 s40,0,s40
v_max_f32 v44,v44,v45
v_mul_f32_e64 v14,-s36,v44
v_mfma_f32_16x16x32_bf16 v[96:99],v[112:115],a[232:235],v[96:99]
s_add_u32 s65,s63,s3
v_fma_f32 v80,v80,s36,v14
v_fma_f32 v81,v81,s36,v14
v_fma_f32 v82,v82,s36,v14
v_fma_f32 v83,v83,s36,v14
v_exp_f32 v80,v80
v_pk_mul_f32 v[212:213],v[212:213],v[62:63] op_sel_hi:[1,0]
v_pk_mul_f32 v[214:215],v[214:215],v[62:63] op_sel_hi:[1,0]
v_pk_mul_f32 v[228:229],v[228:229],v[62:63] op_sel_hi:[1,0]
v_pk_mul_f32 v[230:231],v[230:231],v[62:63] op_sel_hi:[1,0]
v_exp_f32 v81,v81
v_exp_f32 v82,v82
v_mfma_f32_16x16x32_bf16 v[96:99],v[140:143],a[228:231],v[96:99]
s_cmp_eq_u32 s62,0
v_exp_f32 v83,v83
v_mfma_f32_16x16x32_bf16 v[96:99],v[136:139],a[224:227],v[96:99]
s_cselect_b32 s64,s65,s64
v_cvt_pk_bf16_f32 v24,v80,v81
v_cvt_pk_bf16_f32 v25,v82,v83
v_mfma_f32_16x16x32_bf16 v[96:99],v[132:135],a[220:223],v[96:99]
s_cselect_b32 s40,1,s40
v_max_f32 v48,v48,v95
v_mov_b32 v49,v48
v_cvt_pk_bf16_f32 v196,v196,v197
v_cvt_pk_bf16_f32 v177,v178,v179
v_permlane32_swap_b32 v49,v48
v_pk_mul_f32 v[216:217],v[216:217],v[62:63] op_sel_hi:[1,0]
v_pk_mul_f32 v[218:219],v[218:219],v[62:63] op_sel_hi:[1,0]
v_pk_mul_f32 v[232:233],v[232:233],v[62:63] op_sel_hi:[1,0]
v_pk_mul_f32 v[234:235],v[234:235],v[62:63] op_sel_hi:[1,0]
v_max_f32 v48,v48,v49
v_mov_b32 v49,v48
v_mfma_f32_16x16x32_bf16 v[96:99],v[128:131],a[216:219],v[96:99]
s_mul_i32 s64,s64,6144
v_permlane16_swap_b32 v49,v48
v_mfma_f32_16x16x32_bf16 v[104:107],v[128:131],a[240:243],0
s_add_u32 s41,s41,s64
ds_read_b128 v[128:131],v0 offset:6272
v_max_f32 v48,v48,v49
v_mfma_f32_16x16x32_bf16 v[104:107],v[132:135],a[244:247],v[104:107]
s_cmp_ge_u32 s69,6
ds_read_b128 v[132:135],v1 offset:6272
v_mul_f32_e64 v15,-s36,v48
v_mfma_f32_16x16x32_bf16 v[104:107],v[136:139],a[248:251],v[104:107]
s_cselect_b32 s41,166723584,s41
ds_read_b128 v[136:139],v0 offset:6400
v_fma_f32 v88,v88,s36,v15
v_fma_f32 v89,v89,s36,v15
v_fma_f32 v90,v90,s36,v15
v_fma_f32 v91,v91,s36,v15
v_pk_mul_f32 v[220:221],v[220:221],v[62:63] op_sel_hi:[1,0]
v_pk_mul_f32 v[222:223],v[222:223],v[62:63] op_sel_hi:[1,0]
v_pk_mul_f32 v[236:237],v[236:237],v[62:63] op_sel_hi:[1,0]
v_pk_mul_f32 v[238:239],v[238:239],v[62:63] op_sel_hi:[1,0]
v_exp_f32 v88,v88
v_exp_f32 v89,v89
v_mfma_f32_16x16x32_bf16 v[104:107],v[140:143],a[252:255],v[104:107]
s_cselect_b32 s30,100663296,s30
ds_read_b128 v[140:143],v1 offset:6400
v_exp_f32 v90,v90
v_mfma_f32_16x16x32_bf16 v[104:107],v[112:115],v[144:147],v[104:107]
s_add_u32 s25,s30,s22
ds_read_b128 v[112:115],v0 offset:12544
v_exp_f32 v91,v91
v_mfma_f32_16x16x32_bf16 v[104:107],v[116:119],v[148:151],v[104:107]
s_add_u32 s26,s25,12288
ds_read_b128 v[116:119],v1 offset:12544
v_cvt_pk_bf16_f32 v28,v88,v89
s_waitcnt lgkmcnt(5)
v_mfma_f32_16x16x32_bf16 v[100:103],v[120:123],a[216:219],0
s_add_u32 m0,s22,0
v_cvt_pk_bf16_f32 v29,v90,v91
v_max3_f32 v52,v96,v97,v98
v_cvt_pk_bf16_f32 v193,v194,v195
ds_write2st64_b64 v36,v[176:177],v[192:193] offset0:2 offset1:4
v_pk_mul_f32 v[240:241],v[240:241],v[62:63] op_sel_hi:[1,0]
v_pk_mul_f32 v[242:243],v[242:243],v[62:63] op_sel_hi:[1,0]
v_max3_f32 v56,v104,v105,v106
v_cvt_pk_bf16_f32 v184,v184,v185
v_mfma_f32_16x16x32_bf16 v[100:103],v[124:127],a[220:223],v[100:103]
s_mov_b32 s28,s41
v_cvt_pk_bf16_f32 v200,v200,v201
v_cvt_pk_bf16_f32 v181,v182,v183
v_mfma_f32_16x16x32_bf16 v[100:103],v[128:131],a[224:227],v[100:103]
s_mov_b32 s29,s24
v_cvt_pk_bf16_f32 v197,v198,v199
v_cvt_pk_bf16_f32 v188,v188,v189
s_waitcnt lgkmcnt(3)
v_mfma_f32_16x16x32_bf16 v[100:103],v[132:135],a[228:231],v[100:103]
ds_write2st64_b64 v37,v[180:181],v[196:197] offset0:2 offset1:4
v_mfma_f32_16x16x32_bf16 v[100:103],v[136:139],a[232:235],v[100:103]
v_cvt_pk_bf16_f32 v204,v204,v205
v_cvt_pk_bf16_f32 v185,v186,v187
v_cvt_pk_bf16_f32 v201,v202,v203
v_cvt_pk_bf16_f32 v208,v208,v209
v_cvt_pk_bf16_f32 v224,v224,v225
v_pk_mul_f32 v[244:245],v[244:245],v[62:63] op_sel_hi:[1,0]
v_pk_mul_f32 v[246:247],v[246:247],v[62:63] op_sel_hi:[1,0]
v_cvt_pk_bf16_f32 v189,v190,v191
v_cvt_pk_bf16_f32 v205,v206,v207
v_mfma_f32_16x16x32_bf16 v[100:103],v[140:143],a[236:239],v[100:103]
ds_write2st64_b64 v38,v[184:185],v[200:201] offset0:2 offset1:4
v_mfma_f32_16x16x32_bf16 v[108:111],v[140:143],v[148:151],0
v_cvt_pk_bf16_f32 v212,v212,v213
v_cvt_pk_bf16_f32 v228,v228,v229
v_mfma_f32_16x16x32_bf16 v[108:111],v[136:139],v[144:147],v[108:111]
ds_read_b128 v[136:139],v0 offset:12416
v_cvt_pk_bf16_f32 v209,v210,v211
ds_read_b128 v[140:143],v1 offset:12416
v_pk_mul_f32 v[248:249],v[248:249],v[62:63] op_sel_hi:[1,0]
ds_write2st64_b64 v39,v[188:189],v[204:205] offset0:2 offset1:4
v_pk_mul_f32 v[250:251],v[250:251],v[62:63] op_sel_hi:[1,0]
v_max3_f32 v52,v52,v99,v100
v_max3_f32 v52,v52,v101,v102
v_mfma_f32_16x16x32_bf16 v[108:111],v[132:135],a[252:255],v[108:111]
ds_read_b128 v[132:135],v1 offset:12288
v_max_f32 v52,v52,v103
v_mfma_f32_16x16x32_bf16 v[108:111],v[128:131],a[248:251],v[108:111]
ds_read_b128 v[128:131],v0 offset:12288
v_mov_b32 v53,v52
v_mfma_f32_16x16x32_bf16 v[108:111],v[124:127],a[244:247],v[108:111]
ds_read_b128 v[124:127],v1 offset:18432
v_permlane32_swap_b32 v53,v52
v_mfma_f32_16x16x32_bf16 v[108:111],v[120:123],a[240:243],v[108:111]
ds_read_b128 v[120:123],v0 offset:18432
v_max_f32 v52,v52,v53
v_mov_b32 v53,v52
v_cvt_pk_bf16_f32 v225,v226,v227
ds_write2st64_b64 v36,v[208:209],v[224:225] offset0:12 offset1:14
v_pk_mul_f32 v[252:253],v[252:253],v[62:63] op_sel_hi:[1,0]
v_pk_mul_f32 v[254:255],v[254:255],v[62:63] op_sel_hi:[1,0]
v_permlane16_swap_b32 v53,v52
v_max_f32 v52,v52,v53
v_mul_f32_e64 v16,-s36,v52
v_fma_f32 v96,v96,s36,v16
v_fma_f32 v97,v97,s36,v16
v_fma_f32 v98,v98,s36,v16
v_fma_f32 v99,v99,s36,v16
v_exp_f32 v96,v96
v_exp_f32 v97,v97
v_exp_f32 v98,v98
s_waitcnt lgkmcnt(3)
v_mfma_f32_16x16x32_bf16 v[72:75],v[128:131],a[144:147],0
v_exp_f32 v99,v99
v_mfma_f32_16x16x32_bf16 v[72:75],v[132:135],a[148:151],v[72:75]
v_cvt_pk_bf16_f32 v32,v96,v97
v_cvt_pk_bf16_f32 v33,v98,v99
v_mfma_f32_16x16x32_bf16 v[72:75],v[136:139],a[152:155],v[72:75]
v_max3_f32 v56,v56,v107,v108
v_max3_f32 v56,v56,v109,v110
v_mfma_f32_16x16x32_bf16 v[72:75],v[140:143],a[156:159],v[72:75]
v_max_f32 v56,v56,v111
v_mov_b32 v57,v56
v_mfma_f32_16x16x32_bf16 v[72:75],v[112:115],a[160:163],v[72:75]
v_cvt_pk_bf16_f32 v216,v216,v217
v_permlane32_swap_b32 v57,v56
v_mfma_f32_16x16x32_bf16 v[72:75],v[116:119],a[164:167],v[72:75]
v_max_f32 v56,v56,v57
v_mov_b32 v57,v56
v_mfma_f32_16x16x32_bf16 v[80:83],v[116:119],a[188:191],0
v_cvt_pk_bf16_f32 v232,v232,v233
v_permlane16_swap_b32 v57,v56
v_mfma_f32_16x16x32_bf16 v[80:83],v[112:115],a[184:187],v[80:83]
v_cvt_pk_bf16_f32 v213,v214,v215
v_cvt_pk_bf16_f32 v229,v230,v231
v_mfma_f32_16x16x32_bf16 v[80:83],v[140:143],a[180:183],v[80:83]
ds_write2st64_b64 v37,v[212:213],v[228:229] offset0:12 offset1:14
v_mfma_f32_16x16x32_bf16 v[80:83],v[136:139],a[176:179],v[80:83]
v_max_f32 v56,v56,v57
v_cvt_pk_bf16_f32 v220,v220,v221
v_mfma_f32_16x16x32_bf16 v[80:83],v[132:135],a[172:175],v[80:83]
v_cvt_pk_bf16_f32 v236,v236,v237
v_cvt_pk_bf16_f32 v217,v218,v219
v_mfma_f32_16x16x32_bf16 v[80:83],v[128:131],a[168:171],v[80:83]
v_cvt_pk_bf16_f32 v233,v234,v235
v_mul_f32_e64 v17,-s36,v56
v_mfma_f32_16x16x32_bf16 v[88:91],v[128:131],a[192:195],0
ds_write2st64_b64 v38,v[216:217],v[232:233] offset0:12 offset1:14
v_mfma_f32_16x16x32_bf16 v[88:91],v[132:135],a[196:199],v[88:91]
v_cvt_pk_bf16_f32 v240,v240,v241
v_cvt_pk_bf16_f32 v221,v222,v223
v_mfma_f32_16x16x32_bf16 v[88:91],v[136:139],a[200:203],v[88:91]
v_cvt_pk_bf16_f32 v237,v238,v239
v_fma_f32 v104,v104,s36,v17
v_mfma_f32_16x16x32_bf16 v[88:91],v[140:143],a[204:207],v[88:91]
v_fma_f32 v105,v105,s36,v17
v_fma_f32 v106,v106,s36,v17
v_mfma_f32_16x16x32_bf16 v[88:91],v[112:115],a[208:211],v[88:91]
ds_write2st64_b64 v39,v[220:221],v[236:237] offset0:12 offset1:14
v_mfma_f32_16x16x32_bf16 v[88:91],v[116:119],a[212:215],v[88:91]
v_fma_f32 v107,v107,s36,v17
v_cvt_pk_bf16_f32 v244,v244,v245
v_mfma_f32_16x16x32_bf16 v[96:99],v[116:119],a[236:239],0
v_cvt_pk_bf16_f32 v241,v242,v243
v_exp_f32 v104,v104
v_mfma_f32_16x16x32_bf16 v[96:99],v[112:115],a[232:235],v[96:99]
v_exp_f32 v105,v105
v_mfma_f32_16x16x32_bf16 v[96:99],v[140:143],a[228:231],v[96:99]
ds_write_b64 v36,v[240:241] offset:8192
v_mfma_f32_16x16x32_bf16 v[96:99],v[136:139],a[224:227],v[96:99]
v_exp_f32 v106,v106
v_mfma_f32_16x16x32_bf16 v[96:99],v[132:135],a[220:223],v[96:99]
v_exp_f32 v107,v107
v_mfma_f32_16x16x32_bf16 v[96:99],v[128:131],a[216:219],v[96:99]
v_cvt_pk_bf16_f32 v245,v246,v247
ds_write_b64 v37,v[244:245] offset:8192
v_cvt_pk_bf16_f32 v36,v104,v105
v_cvt_pk_bf16_f32 v37,v106,v107
v_mfma_f32_16x16x32_bf16 v[104:107],v[128:131],a[240:243],0
ds_read_b128 v[128:131],v0 offset:18560
v_fma_f32 v76,v76,s36,v13
v_mfma_f32_16x16x32_bf16 v[104:107],v[132:135],a[244:247],v[104:107]
ds_read_b128 v[132:135],v1 offset:18560
v_fma_f32 v77,v77,s36,v13
v_mfma_f32_16x16x32_bf16 v[104:107],v[136:139],a[248:251],v[104:107]
ds_read_b128 v[136:139],v0 offset:18688
v_fma_f32 v78,v78,s36,v13
s_waitcnt vmcnt(5)
s_barrier
v_mfma_f32_16x16x32_bf16 v[104:107],v[140:143],a[252:255],v[104:107]
ds_read_b128 v[140:143],v1 offset:18688
buffer_load_dwordx4 v6,s[4:7],s20 offen offset:0 lds
v_mfma_f32_16x16x32_bf16 v[104:107],v[112:115],v[144:147],v[104:107]
v_fma_f32 v79,v79,s36,v13
v_exp_f32 v76,v76
v_mfma_f32_16x16x32_bf16 v[104:107],v[116:119],v[148:151],v[104:107]
v_exp_f32 v77,v77
v_exp_f32 v78,v78
v_exp_f32 v79,v79
v_cvt_pk_bf16_f32 v22,v76,v77
v_cvt_pk_bf16_f32 v23,v78,v79
s_waitcnt lgkmcnt(3)
v_mfma_f32_16x16x32_bf16 v[76:79],v[120:123],a[144:147],0
v_fma_f32 v84,v84,s36,v14
v_fma_f32 v85,v85,s36,v14
v_mfma_f32_16x16x32_bf16 v[76:79],v[124:127],a[148:151],v[76:79]
buffer_load_dwordx4 v7,s[4:7],s20 offen offset:1024 lds
v_mfma_f32_16x16x32_bf16 v[76:79],v[128:131],a[152:155],v[76:79]
s_waitcnt lgkmcnt(1)
v_fma_f32 v86,v86,s36,v14
v_fma_f32 v87,v87,s36,v14
v_mfma_f32_16x16x32_bf16 v[76:79],v[132:135],a[156:159],v[76:79]
v_exp_f32 v84,v84
v_mfma_f32_16x16x32_bf16 v[76:79],v[136:139],a[160:163],v[76:79]
s_waitcnt lgkmcnt(0)
v_exp_f32 v85,v85
v_mfma_f32_16x16x32_bf16 v[76:79],v[140:143],a[164:167],v[76:79]
ds_read_b64_tr_b16 v[112:113],v2 offset:0
ds_read_b64_tr_b16 v[114:115],v2 offset:6144
v_exp_f32 v86,v86
buffer_load_dwordx4 v8,s[4:7],s20 offen offset:2048 lds
ds_read_b64_tr_b16 v[116:117],v3 offset:0
ds_read_b64_tr_b16 v[118:119],v3 offset:6144
v_exp_f32 v87,v87
v_cvt_pk_bf16_f32 v26,v84,v85
v_cvt_pk_bf16_f32 v27,v86,v87
v_mfma_f32_16x16x32_bf16 v[84:87],v[140:143],a[188:191],0
s_add_u32 s20,s20,12288
v_fma_f32 v92,v92,s36,v15
v_fma_f32 v93,v93,s36,v15
v_mfma_f32_16x16x32_bf16 v[84:87],v[136:139],a[184:187],v[84:87]
v_fma_f32 v94,v94,s36,v15
v_fma_f32 v95,v95,s36,v15
v_mfma_f32_16x16x32_bf16 v[84:87],v[132:135],a[180:183],v[84:87]
v_exp_f32 v92,v92
v_mfma_f32_16x16x32_bf16 v[84:87],v[128:131],a[176:179],v[84:87]
v_exp_f32 v93,v93
v_mfma_f32_16x16x32_bf16 v[84:87],v[124:127],a[172:175],v[84:87]
v_exp_f32 v94,v94
v_mfma_f32_16x16x32_bf16 v[84:87],v[120:123],a[168:171],v[84:87]
v_exp_f32 v95,v95
v_cvt_pk_bf16_f32 v30,v92,v93
v_cvt_pk_bf16_f32 v31,v94,v95
v_mfma_f32_16x16x32_bf16 v[92:95],v[120:123],a[192:195],0
v_fma_f32 v100,v100,s36,v16
v_fma_f32 v101,v101,s36,v16
v_mfma_f32_16x16x32_bf16 v[92:95],v[124:127],a[196:199],v[92:95]
v_fma_f32 v102,v102,s36,v16
v_fma_f32 v103,v103,s36,v16
v_mfma_f32_16x16x32_bf16 v[92:95],v[128:131],a[200:203],v[92:95]
v_exp_f32 v100,v100
v_mfma_f32_16x16x32_bf16 v[92:95],v[132:135],a[204:207],v[92:95]
v_exp_f32 v101,v101
v_mfma_f32_16x16x32_bf16 v[92:95],v[136:139],a[208:211],v[92:95]
v_exp_f32 v102,v102
v_mfma_f32_16x16x32_bf16 v[92:95],v[140:143],a[212:215],v[92:95]
v_exp_f32 v103,v103
v_cvt_pk_bf16_f32 v34,v100,v101
v_cvt_pk_bf16_f32 v35,v102,v103
v_mfma_f32_16x16x32_bf16 v[100:103],v[140:143],a[236:239],0
v_cvt_pk_bf16_f32 v248,v248,v249
v_fma_f32 v108,v108,s36,v17
v_mfma_f32_16x16x32_bf16 v[100:103],v[136:139],a[232:235],v[100:103]
v_fma_f32 v109,v109,s36,v17
v_fma_f32 v110,v110,s36,v17
v_mfma_f32_16x16x32_bf16 v[100:103],v[132:135],a[228:231],v[100:103]
v_fma_f32 v111,v111,s36,v17
v_cvt_pk_bf16_f32 v252,v252,v253
v_mfma_f32_16x16x32_bf16 v[100:103],v[128:131],a[224:227],v[100:103]
v_cvt_pk_bf16_f32 v249,v250,v251
v_exp_f32 v108,v108
v_mfma_f32_16x16x32_bf16 v[100:103],v[124:127],a[220:223],v[100:103]
ds_write_b64 v38,v[248:249] offset:8192
v_mfma_f32_16x16x32_bf16 v[100:103],v[120:123],a[216:219],v[100:103]
v_exp_f32 v109,v109
v_exp_f32 v110,v110
v_exp_f32 v111,v111
v_cvt_pk_bf16_f32 v253,v254,v255
ds_write_b64 v39,v[252:253] offset:8192
v_cvt_pk_bf16_f32 v38,v108,v109
v_cvt_pk_bf16_f32 v39,v110,v111
v_mfma_f32_16x16x32_bf16 v[108:111],v[120:123],a[240:243],0
ds_read_b64_tr_b16 v[120:121],v4 offset:0
v_mov_b32 v68,0
v_mfma_f32_16x16x32_bf16 v[108:111],v[124:127],a[244:247],v[108:111]
ds_read_b64_tr_b16 v[122:123],v4 offset:6144
v_mov_b32 v69,0
v_mfma_f32_16x16x32_bf16 v[108:111],v[128:131],a[248:251],v[108:111]
ds_read_b64_tr_b16 v[124:125],v5 offset:0
v_mov_b32 v70,0
v_mfma_f32_16x16x32_bf16 v[108:111],v[132:135],a[252:255],v[108:111]
ds_read_b64_tr_b16 v[126:127],v5 offset:6144
v_mov_b32 v71,0
v_mfma_f32_16x16x32_bf16 v[108:111],v[136:139],v[144:147],v[108:111]
v_mov_b32 v66,0
v_mov_b32 v67,0
v_smfmac_f32_16x16x64_bf16 v[68:71],v[152:155],v[32:39],v18
v_mov_b32 v64,0
v_mfma_f32_16x16x32_bf16 v[108:111],v[140:143],v[148:151],v[108:111]
v_mov_b32 v65,0
v_mov_b32 v60,0
v_mov_b32 v61,0
v_smfmac_f32_16x16x64_bf16 v[64:67],v[152:155],v[28:35],v18
v_mov_b32 v62,0
v_mov_b32 v63,0
v_fma_f32 v72,v72,s36,v13
v_fma_f32 v73,v73,s36,v13
v_smfmac_f32_16x16x64_bf16 v[60:63],v[152:155],v[20:27],v18
v_fma_f32 v74,v74,s36,v13
v_fma_f32 v75,v75,s36,v13
v_fma_f32 v80,v80,s36,v14
v_fma_f32 v81,v81,s36,v14
v_fma_f32 v82,v82,s36,v14
v_fma_f32 v83,v83,s36,v14
v_fma_f32 v88,v88,s36,v15
v_fma_f32 v89,v89,s36,v15
v_exp_f32 v72,v72
v_exp_f32 v73,v73
v_exp_f32 v74,v74
v_exp_f32 v75,v75
v_exp_f32 v80,v80
v_exp_f32 v81,v81
v_exp_f32 v82,v82
v_exp_f32 v83,v83
v_exp_f32 v88,v88
v_exp_f32 v89,v89
v_cvt_pk_bf16_f32 v40,v72,v73
v_cvt_pk_bf16_f32 v41,v74,v75
v_cvt_pk_bf16_f32 v44,v80,v81
v_cvt_pk_bf16_f32 v45,v82,v83
v_cvt_pk_bf16_f32 v48,v88,v89
s_waitcnt lgkmcnt(0)
v_mfma_f32_16x16x32_bf16 v[160:163],v[112:115],v[20:23],0
s_add_u32 m0,s23,0
ds_read_b64_tr_b16 v[128:129],v2 offset:128
v_fma_f32 v90,v90,s36,v15
v_mfma_f32_16x16x32_bf16 v[164:167],v[116:119],v[20:23],0
ds_read_b64_tr_b16 v[130:131],v2 offset:6272
v_fma_f32 v91,v91,s36,v15
v_mfma_f32_16x16x32_bf16 v[212:215],v[116:119],v[24:27],0
ds_read_b64_tr_b16 v[132:133],v3 offset:128
v_fma_f32 v96,v96,s36,v16
v_mfma_f32_16x16x32_bf16 v[208:211],v[112:115],v[24:27],0
ds_read_b64_tr_b16 v[134:135],v3 offset:6272
v_fma_f32 v97,v97,s36,v16
v_mfma_f32_16x16x32_bf16 a[0:3],v[112:115],v[28:31],0
ds_read_b64_tr_b16 v[136:137],v4 offset:128
v_fma_f32 v98,v98,s36,v16
v_mfma_f32_16x16x32_bf16 a[4:7],v[116:119],v[28:31],0
ds_read_b64_tr_b16 v[138:139],v4 offset:6272
v_fma_f32 v99,v99,s36,v16
v_mfma_f32_16x16x32_bf16 a[52:55],v[116:119],v[32:35],0
ds_read_b64_tr_b16 v[140:141],v5 offset:128
v_fma_f32 v104,v104,s36,v17
v_mfma_f32_16x16x32_bf16 a[48:51],v[112:115],v[32:35],0
ds_read_b64_tr_b16 v[142:143],v5 offset:6272
v_fma_f32 v105,v105,s36,v17
v_mfma_f32_16x16x32_bf16 a[96:99],v[112:115],v[36:39],0
ds_read_b64_tr_b16 v[112:113],v2 offset:256
v_fma_f32 v106,v106,s36,v17
v_mfma_f32_16x16x32_bf16 a[100:103],v[116:119],v[36:39],0
ds_read_b64_tr_b16 v[114:115],v2 offset:6400
v_fma_f32 v107,v107,s36,v17
v_mfma_f32_16x16x32_bf16 a[104:107],v[120:123],v[36:39],0
ds_read_b64_tr_b16 v[116:117],v3 offset:256
v_fma_f32 v76,v76,s36,v13
v_mfma_f32_16x16x32_bf16 a[108:111],v[124:127],v[36:39],0
ds_read_b64_tr_b16 v[118:119],v3 offset:6400
v_fma_f32 v77,v77,s36,v13
v_mfma_f32_16x16x32_bf16 a[60:63],v[124:127],v[32:35],0
v_exp_f32 v90,v90
v_mfma_f32_16x16x32_bf16 a[56:59],v[120:123],v[32:35],0
v_exp_f32 v91,v91
v_mfma_f32_16x16x32_bf16 a[8:11],v[120:123],v[28:31],0
v_cvt_pk_bf16_f32 v49,v90,v91
v_fma_f32 v78,v78,s36,v13
v_mfma_f32_16x16x32_bf16 a[12:15],v[124:127],v[28:31],0
v_exp_f32 v96,v96
v_mfma_f32_16x16x32_bf16 v[220:223],v[124:127],v[24:27],0
v_exp_f32 v97,v97
v_mfma_f32_16x16x32_bf16 v[216:219],v[120:123],v[24:27],0
v_exp_f32 v98,v98
v_mfma_f32_16x16x32_bf16 v[168:171],v[120:123],v[20:23],0
ds_read_b64_tr_b16 v[120:121],v4 offset:256
v_cvt_pk_bf16_f32 v52,v96,v97
v_mfma_f32_16x16x32_bf16 v[172:175],v[124:127],v[20:23],0
s_waitcnt lgkmcnt(2)
ds_read_b64_tr_b16 v[122:123],v4 offset:6400
v_fma_f32 v79,v79,s36,v13
v_mfma_f32_16x16x32_bf16 v[176:179],v[128:131],v[20:23],0
ds_read_b64_tr_b16 v[124:125],v5 offset:256
v_fma_f32 v84,v84,s36,v14
v_mfma_f32_16x16x32_bf16 v[180:183],v[132:135],v[20:23],0
ds_read_b64_tr_b16 v[126:127],v5 offset:6400
v_fma_f32 v85,v85,s36,v14
v_mfma_f32_16x16x32_bf16 v[228:231],v[132:135],v[24:27],0
v_exp_f32 v99,v99
v_mfma_f32_16x16x32_bf16 v[224:227],v[128:131],v[24:27],0
v_cvt_pk_bf16_f32 v53,v98,v99
v_fma_f32 v86,v86,s36,v14
v_mfma_f32_16x16x32_bf16 a[16:19],v[128:131],v[28:31],0
v_exp_f32 v104,v104
v_mfma_f32_16x16x32_bf16 a[20:23],v[132:135],v[28:31],0
v_exp_f32 v105,v105
v_mfma_f32_16x16x32_bf16 a[68:71],v[132:135],v[32:35],0
v_exp_f32 v106,v106
v_mfma_f32_16x16x32_bf16 a[64:67],v[128:131],v[32:35],0
v_exp_f32 v107,v107
v_mfma_f32_16x16x32_bf16 a[112:115],v[128:131],v[36:39],0
v_cvt_pk_bf16_f32 v56,v104,v105
v_cvt_pk_bf16_f32 v57,v106,v107
v_mfma_f32_16x16x32_bf16 a[116:119],v[132:135],v[36:39],0
v_exp_f32 v76,v76
v_mfma_f32_16x16x32_bf16 a[120:123],v[136:139],v[36:39],0
v_exp_f32 v77,v77
v_mfma_f32_16x16x32_bf16 a[124:127],v[140:143],v[36:39],0
v_exp_f32 v78,v78
v_mfma_f32_16x16x32_bf16 a[76:79],v[140:143],v[32:35],0
v_exp_f32 v79,v79
v_mfma_f32_16x16x32_bf16 a[72:75],v[136:139],v[32:35],0
v_cvt_pk_bf16_f32 v42,v76,v77
v_cvt_pk_bf16_f32 v43,v78,v79
v_mfma_f32_16x16x32_bf16 a[24:27],v[136:139],v[28:31],0
v_fma_f32 v87,v87,s36,v14
v_fma_f32 v92,v92,s36,v15
v_mfma_f32_16x16x32_bf16 a[28:31],v[140:143],v[28:31],0
v_exp_f32 v84,v84
v_mfma_f32_16x16x32_bf16 v[236:239],v[140:143],v[24:27],0
v_exp_f32 v85,v85
v_mfma_f32_16x16x32_bf16 v[232:235],v[136:139],v[24:27],0
v_exp_f32 v86,v86
v_mfma_f32_16x16x32_bf16 v[184:187],v[136:139],v[20:23],0
v_exp_f32 v87,v87
v_mfma_f32_16x16x32_bf16 v[188:191],v[140:143],v[20:23],0
v_cvt_pk_bf16_f32 v46,v84,v85
v_cvt_pk_bf16_f32 v47,v86,v87
v_mfma_f32_16x16x32_bf16 v[192:195],v[112:115],v[20:23],0
v_fma_f32 v93,v93,s36,v15
v_fma_f32 v94,v94,s36,v15
v_smfmac_f32_16x16x64_bf16 v[60:63],v[152:155],v[40:47],v18
v_fma_f32 v95,v95,s36,v15
s_waitcnt vmcnt(30)
s_waitcnt lgkmcnt(0)
v_mfma_f32_16x16x32_bf16 v[196:199],v[116:119],v[20:23],0
s_barrier
v_mfma_f32_16x16x32_bf16 v[244:247],v[116:119],v[24:27],0
ds_read_b128 v[128:131],v0 offset:24576
v_fma_f32 v100,v100,s36,v16
v_mfma_f32_16x16x32_bf16 v[240:243],v[112:115],v[24:27],0
ds_read_b128 v[132:135],v1 offset:24576
v_fma_f32 v101,v101,s36,v16
v_mfma_f32_16x16x32_bf16 a[32:35],v[112:115],v[28:31],0
ds_read_b128 v[136:139],v0 offset:24704
v_fma_f32 v102,v102,s36,v16
v_mfma_f32_16x16x32_bf16 a[36:39],v[116:119],v[28:31],0
ds_read_b128 v[140:143],v1 offset:24704
v_fma_f32 v103,v103,s36,v16
v_mfma_f32_16x16x32_bf16 a[84:87],v[116:119],v[32:35],0
v_exp_f32 v92,v92
v_mfma_f32_16x16x32_bf16 a[80:83],v[112:115],v[32:35],0
buffer_load_dwordx4 v6,s[8:11],s21 offen offset:0 lds
v_mfma_f32_16x16x32_bf16 a[128:131],v[112:115],v[36:39],0
ds_read_b128 v[112:115],v0 offset:24832
v_fma_f32 v108,v108,s36,v17
v_mfma_f32_16x16x32_bf16 a[132:135],v[116:119],v[36:39],0
ds_read_b128 v[116:119],v1 offset:24832
v_fma_f32 v109,v109,s36,v17
v_mfma_f32_16x16x32_bf16 a[136:139],v[120:123],v[36:39],0
v_exp_f32 v93,v93
v_mfma_f32_16x16x32_bf16 a[140:143],v[124:127],v[36:39],0
v_exp_f32 v94,v94
v_mfma_f32_16x16x32_bf16 a[92:95],v[124:127],v[32:35],0
v_exp_f32 v95,v95
v_mfma_f32_16x16x32_bf16 a[88:91],v[120:123],v[32:35],0
v_cvt_pk_bf16_f32 v50,v92,v93
v_cvt_pk_bf16_f32 v51,v94,v95
v_mfma_f32_16x16x32_bf16 a[40:43],v[120:123],v[28:31],0
v_exp_f32 v100,v100
v_mfma_f32_16x16x32_bf16 a[44:47],v[124:127],v[28:31],0
v_exp_f32 v101,v101
v_mfma_f32_16x16x32_bf16 v[252:255],v[124:127],v[24:27],0
v_exp_f32 v102,v102
v_mfma_f32_16x16x32_bf16 v[248:251],v[120:123],v[24:27],0
v_exp_f32 v103,v103
v_mfma_f32_16x16x32_bf16 v[200:203],v[120:123],v[20:23],0
ds_read_b128 v[120:123],v0 offset:30720
v_cvt_pk_bf16_f32 v54,v100,v101
v_mfma_f32_16x16x32_bf16 v[204:207],v[124:127],v[20:23],0
buffer_load_dwordx4 v7,s[8:11],s21 offen offset:1024 lds
s_waitcnt lgkmcnt(1)
v_mfma_f32_16x16x32_bf16 v[72:75],v[128:131],a[144:147],0
ds_read_b128 v[124:127],v1 offset:30720
v_cvt_pk_bf16_f32 v55,v102,v103
v_mfma_f32_16x16x32_bf16 v[72:75],v[132:135],a[148:151],v[72:75]
v_fma_f32 v110,v110,s36,v17
v_fma_f32 v111,v111,s36,v17
v_smfmac_f32_16x16x64_bf16 v[64:67],v[152:155],v[48:55],v18
v_mfma_f32_16x16x32_bf16 v[72:75],v[136:139],a[152:155],v[72:75]
v_exp_f32 v108,v108
v_mfma_f32_16x16x32_bf16 v[72:75],v[140:143],a[156:159],v[72:75]
v_exp_f32 v109,v109
v_mfma_f32_16x16x32_bf16 v[72:75],v[112:115],a[160:163],v[72:75]
v_exp_f32 v110,v110
v_mfma_f32_16x16x32_bf16 v[72:75],v[116:119],a[164:167],v[72:75]
v_exp_f32 v111,v111
v_mfma_f32_16x16x32_bf16 v[80:83],v[116:119],a[188:191],0
v_cvt_pk_bf16_f32 v58,v108,v109
v_cvt_pk_bf16_f32 v59,v110,v111
v_mfma_f32_16x16x32_bf16 v[80:83],v[112:115],a[184:187],v[80:83]
v_mfma_f32_16x16x32_bf16 v[80:83],v[140:143],a[180:183],v[80:83]
v_smfmac_f32_16x16x64_bf16 v[68:71],v[152:155],v[52:59],v18
buffer_load_dwordx4 v8,s[8:11],s21 offen offset:2048 lds
v_mfma_f32_16x16x32_bf16 v[80:83],v[136:139],a[176:179],v[80:83]
s_add_u32 s21,s21,12288
v_fma_f32 v72,v72,s36,v13
v_fma_f32 v73,v73,s36,v13
v_mfma_f32_16x16x32_bf16 v[80:83],v[132:135],a[172:175],v[80:83]
s_add_u32 m0,s22,12288
v_fma_f32 v74,v74,s36,v13
v_fma_f32 v75,v75,s36,v13
v_mfma_f32_16x16x32_bf16 v[80:83],v[128:131],a[168:171],v[80:83]
v_exp_f32 v72,v72
v_mfma_f32_16x16x32_bf16 v[88:91],v[128:131],a[192:195],0
v_exp_f32 v73,v73
v_mfma_f32_16x16x32_bf16 v[88:91],v[132:135],a[196:199],v[88:91]
v_exp_f32 v74,v74
v_mfma_f32_16x16x32_bf16 v[88:91],v[136:139],a[200:203],v[88:91]
v_exp_f32 v75,v75
v_mfma_f32_16x16x32_bf16 v[88:91],v[140:143],a[204:207],v[88:91]
v_fma_f32 v80,v80,s36,v14
v_fma_f32 v81,v81,s36,v14
v_mfma_f32_16x16x32_bf16 v[88:91],v[112:115],a[208:211],v[88:91]
v_fma_f32 v82,v82,s36,v14
v_fma_f32 v83,v83,s36,v14
v_mfma_f32_16x16x32_bf16 v[88:91],v[116:119],a[212:215],v[88:91]
v_exp_f32 v80,v80
v_mfma_f32_16x16x32_bf16 v[96:99],v[116:119],a[236:239],0
v_exp_f32 v81,v81
v_mfma_f32_16x16x32_bf16 v[96:99],v[112:115],a[232:235],v[96:99]
buffer_load_dwordx4 v6,s[4:7],s20 offen offset:0 lds
v_mfma_f32_16x16x32_bf16 v[96:99],v[140:143],a[228:231],v[96:99]
v_exp_f32 v82,v82
v_mfma_f32_16x16x32_bf16 v[96:99],v[136:139],a[224:227],v[96:99]
v_fma_f32 v88,v88,s36,v15
v_fma_f32 v89,v89,s36,v15
v_mfma_f32_16x16x32_bf16 v[96:99],v[132:135],a[220:223],v[96:99]
v_exp_f32 v83,v83
v_mfma_f32_16x16x32_bf16 v[96:99],v[128:131],a[216:219],v[96:99]
v_exp_f32 v88,v88
v_mfma_f32_16x16x32_bf16 v[104:107],v[128:131],a[240:243],0
ds_read_b128 v[128:131],v0 offset:30848
v_cvt_pk_bf16_f32 v20,v72,v73
v_mfma_f32_16x16x32_bf16 v[104:107],v[132:135],a[244:247],v[104:107]
ds_read_b128 v[132:135],v1 offset:30848
v_cvt_pk_bf16_f32 v21,v74,v75
v_mfma_f32_16x16x32_bf16 v[104:107],v[136:139],a[248:251],v[104:107]
ds_read_b128 v[136:139],v0 offset:30976
v_cvt_pk_bf16_f32 v24,v80,v81
v_mfma_f32_16x16x32_bf16 v[104:107],v[140:143],a[252:255],v[104:107]
ds_read_b128 v[140:143],v1 offset:30976
v_cvt_pk_bf16_f32 v25,v82,v83
v_mfma_f32_16x16x32_bf16 v[104:107],v[112:115],v[144:147],v[104:107]
v_exp_f32 v89,v89
v_mfma_f32_16x16x32_bf16 v[104:107],v[116:119],v[148:151],v[104:107]
s_waitcnt lgkmcnt(4)
v_cvt_pk_bf16_f32 v28,v88,v89
v_mfma_f32_16x16x32_bf16 v[76:79],v[120:123],a[144:147],0
buffer_load_dwordx4 v7,s[4:7],s20 offen offset:1024 lds
v_mfma_f32_16x16x32_bf16 v[76:79],v[124:127],a[148:151],v[76:79]
s_waitcnt lgkmcnt(3)
v_mfma_f32_16x16x32_bf16 v[76:79],v[128:131],a[152:155],v[76:79]
s_waitcnt lgkmcnt(2)
v_mfma_f32_16x16x32_bf16 v[76:79],v[132:135],a[156:159],v[76:79]
s_waitcnt lgkmcnt(1)
v_mfma_f32_16x16x32_bf16 v[76:79],v[136:139],a[160:163],v[76:79]
s_waitcnt lgkmcnt(0)
v_mfma_f32_16x16x32_bf16 v[76:79],v[140:143],a[164:167],v[76:79]
v_mfma_f32_16x16x32_bf16 v[84:87],v[140:143],a[188:191],0
v_mfma_f32_16x16x32_bf16 v[84:87],v[136:139],a[184:187],v[84:87]
v_mfma_f32_16x16x32_bf16 v[84:87],v[132:135],a[180:183],v[84:87]
v_mfma_f32_16x16x32_bf16 v[84:87],v[128:131],a[176:179],v[84:87]
v_mfma_f32_16x16x32_bf16 v[84:87],v[124:127],a[172:175],v[84:87]
v_mfma_f32_16x16x32_bf16 v[84:87],v[120:123],a[168:171],v[84:87]
buffer_load_dwordx4 v8,s[4:7],s20 offen offset:2048 lds
v_mfma_f32_16x16x32_bf16 v[92:95],v[120:123],a[192:195],0
s_add_u32 s20,s20,12288
v_mfma_f32_16x16x32_bf16 v[92:95],v[124:127],a[196:199],v[92:95]
v_mfma_f32_16x16x32_bf16 v[92:95],v[128:131],a[200:203],v[92:95]
v_mfma_f32_16x16x32_bf16 v[92:95],v[132:135],a[204:207],v[92:95]
v_mfma_f32_16x16x32_bf16 v[92:95],v[136:139],a[208:211],v[92:95]
ds_read_b64_tr_b16 v[112:113],v2 offset:12288
v_mfma_f32_16x16x32_bf16 v[92:95],v[140:143],a[212:215],v[92:95]
ds_read_b64_tr_b16 v[114:115],v2 offset:18432
v_mfma_f32_16x16x32_bf16 v[100:103],v[140:143],a[236:239],0
v_mfma_f32_16x16x32_bf16 v[100:103],v[136:139],a[232:235],v[100:103]
ds_read_b64_tr_b16 v[116:117],v3 offset:12288
v_mfma_f32_16x16x32_bf16 v[100:103],v[132:135],a[228:231],v[100:103]
ds_read_b64_tr_b16 v[118:119],v3 offset:18432
v_mfma_f32_16x16x32_bf16 v[100:103],v[128:131],a[224:227],v[100:103]
v_mfma_f32_16x16x32_bf16 v[100:103],v[124:127],a[220:223],v[100:103]
v_mfma_f32_16x16x32_bf16 v[100:103],v[120:123],a[216:219],v[100:103]
v_mfma_f32_16x16x32_bf16 v[108:111],v[120:123],a[240:243],0
ds_read_b64_tr_b16 v[120:121],v4 offset:12288
v_mfma_f32_16x16x32_bf16 v[108:111],v[124:127],a[244:247],v[108:111]
ds_read_b64_tr_b16 v[122:123],v4 offset:18432
v_mfma_f32_16x16x32_bf16 v[108:111],v[128:131],a[248:251],v[108:111]
ds_read_b64_tr_b16 v[124:125],v5 offset:12288
v_mfma_f32_16x16x32_bf16 v[108:111],v[132:135],a[252:255],v[108:111]
ds_read_b64_tr_b16 v[126:127],v5 offset:18432
v_mfma_f32_16x16x32_bf16 v[108:111],v[136:139],v[144:147],v[108:111]
v_mfma_f32_16x16x32_bf16 v[108:111],v[140:143],v[148:151],v[108:111]
s_waitcnt lgkmcnt(4)
v_mfma_f32_16x16x32_bf16 v[160:163],v[112:115],v[40:43],v[160:163]
s_add_u32 m0,s23,12288
ds_read_b64_tr_b16 v[128:129],v2 offset:12416
v_fma_f32 v90,v90,s36,v15
v_mfma_f32_16x16x32_bf16 v[164:167],v[116:119],v[40:43],v[164:167]
ds_read_b64_tr_b16 v[130:131],v2 offset:18560
v_fma_f32 v91,v91,s36,v15
v_mfma_f32_16x16x32_bf16 v[212:215],v[116:119],v[44:47],v[212:215]
ds_read_b64_tr_b16 v[132:133],v3 offset:12416
v_fma_f32 v96,v96,s36,v16
v_mfma_f32_16x16x32_bf16 v[208:211],v[112:115],v[44:47],v[208:211]
ds_read_b64_tr_b16 v[134:135],v3 offset:18560
v_fma_f32 v97,v97,s36,v16
v_mfma_f32_16x16x32_bf16 a[0:3],v[112:115],v[48:51],a[0:3]
ds_read_b64_tr_b16 v[136:137],v4 offset:12416
v_fma_f32 v98,v98,s36,v16
v_mfma_f32_16x16x32_bf16 a[4:7],v[116:119],v[48:51],a[4:7]
ds_read_b64_tr_b16 v[138:139],v4 offset:18560
v_fma_f32 v99,v99,s36,v16
v_mfma_f32_16x16x32_bf16 a[52:55],v[116:119],v[52:55],a[52:55]
ds_read_b64_tr_b16 v[140:141],v5 offset:12416
v_fma_f32 v104,v104,s36,v17
v_mfma_f32_16x16x32_bf16 a[48:51],v[112:115],v[52:55],a[48:51]
ds_read_b64_tr_b16 v[142:143],v5 offset:18560
v_fma_f32 v105,v105,s36,v17
v_mfma_f32_16x16x32_bf16 a[96:99],v[112:115],v[56:59],a[96:99]
ds_read_b64_tr_b16 v[112:113],v2 offset:12544
v_fma_f32 v106,v106,s36,v17
v_mfma_f32_16x16x32_bf16 a[100:103],v[116:119],v[56:59],a[100:103]
s_waitcnt lgkmcnt(8)
ds_read_b64_tr_b16 v[114:115],v2 offset:18688
v_fma_f32 v107,v107,s36,v17
v_mfma_f32_16x16x32_bf16 a[104:107],v[120:123],v[56:59],a[104:107]
ds_read_b64_tr_b16 v[116:117],v3 offset:12544
v_fma_f32 v76,v76,s36,v13
v_mfma_f32_16x16x32_bf16 a[108:111],v[124:127],v[56:59],a[108:111]
ds_read_b64_tr_b16 v[118:119],v3 offset:18688
v_fma_f32 v77,v77,s36,v13
v_mfma_f32_16x16x32_bf16 a[60:63],v[124:127],v[52:55],a[60:63]
v_exp_f32 v90,v90
v_mfma_f32_16x16x32_bf16 a[56:59],v[120:123],v[52:55],a[56:59]
v_exp_f32 v91,v91
v_mfma_f32_16x16x32_bf16 a[8:11],v[120:123],v[48:51],a[8:11]
v_cvt_pk_bf16_f32 v29,v90,v91
v_fma_f32 v78,v78,s36,v13
v_mfma_f32_16x16x32_bf16 a[12:15],v[124:127],v[48:51],a[12:15]
v_exp_f32 v96,v96
v_mfma_f32_16x16x32_bf16 v[220:223],v[124:127],v[44:47],v[220:223]
v_exp_f32 v97,v97
v_mfma_f32_16x16x32_bf16 v[216:219],v[120:123],v[44:47],v[216:219]
v_exp_f32 v98,v98
v_mfma_f32_16x16x32_bf16 v[168:171],v[120:123],v[40:43],v[168:171]
ds_read_b64_tr_b16 v[120:121],v4 offset:12544
v_cvt_pk_bf16_f32 v32,v96,v97
v_mfma_f32_16x16x32_bf16 v[172:175],v[124:127],v[40:43],v[172:175]
s_waitcnt lgkmcnt(2)
ds_read_b64_tr_b16 v[122:123],v4 offset:18688
v_fma_f32 v79,v79,s36,v13
v_mfma_f32_16x16x32_bf16 v[176:179],v[128:131],v[40:43],v[176:179]
ds_read_b64_tr_b16 v[124:125],v5 offset:12544
v_fma_f32 v84,v84,s36,v14
v_mfma_f32_16x16x32_bf16 v[180:183],v[132:135],v[40:43],v[180:183]
ds_read_b64_tr_b16 v[126:127],v5 offset:18688
v_fma_f32 v85,v85,s36,v14
v_mfma_f32_16x16x32_bf16 v[228:231],v[132:135],v[44:47],v[228:231]
v_exp_f32 v99,v99
v_mfma_f32_16x16x32_bf16 v[224:227],v[128:131],v[44:47],v[224:227]
v_cvt_pk_bf16_f32 v33,v98,v99
v_fma_f32 v86,v86,s36,v14
v_mfma_f32_16x16x32_bf16 a[16:19],v[128:131],v[48:51],a[16:19]
v_exp_f32 v104,v104
v_mfma_f32_16x16x32_bf16 a[20:23],v[132:135],v[48:51],a[20:23]
v_exp_f32 v105,v105
v_mfma_f32_16x16x32_bf16 a[68:71],v[132:135],v[52:55],a[68:71]
v_exp_f32 v106,v106
v_mfma_f32_16x16x32_bf16 a[64:67],v[128:131],v[52:55],a[64:67]
v_exp_f32 v107,v107
v_mfma_f32_16x16x32_bf16 a[112:115],v[128:131],v[56:59],a[112:115]
v_cvt_pk_bf16_f32 v36,v104,v105
v_cvt_pk_bf16_f32 v37,v106,v107
v_mfma_f32_16x16x32_bf16 a[116:119],v[132:135],v[56:59],a[116:119]
v_exp_f32 v76,v76
v_mfma_f32_16x16x32_bf16 a[120:123],v[136:139],v[56:59],a[120:123]
v_exp_f32 v77,v77
v_mfma_f32_16x16x32_bf16 a[124:127],v[140:143],v[56:59],a[124:127]
v_exp_f32 v78,v78
v_mfma_f32_16x16x32_bf16 a[76:79],v[140:143],v[52:55],a[76:79]
v_exp_f32 v79,v79
v_mfma_f32_16x16x32_bf16 a[72:75],v[136:139],v[52:55],a[72:75]
v_cvt_pk_bf16_f32 v22,v76,v77
v_cvt_pk_bf16_f32 v23,v78,v79
v_mfma_f32_16x16x32_bf16 a[24:27],v[136:139],v[48:51],a[24:27]
v_fma_f32 v87,v87,s36,v14
v_fma_f32 v92,v92,s36,v15
v_mfma_f32_16x16x32_bf16 a[28:31],v[140:143],v[48:51],a[28:31]
v_exp_f32 v84,v84
v_mfma_f32_16x16x32_bf16 v[236:239],v[140:143],v[44:47],v[236:239]
v_exp_f32 v85,v85
v_mfma_f32_16x16x32_bf16 v[232:235],v[136:139],v[44:47],v[232:235]
v_exp_f32 v86,v86
v_mfma_f32_16x16x32_bf16 v[184:187],v[136:139],v[40:43],v[184:187]
v_exp_f32 v87,v87
v_mfma_f32_16x16x32_bf16 v[188:191],v[140:143],v[40:43],v[188:191]
v_cvt_pk_bf16_f32 v26,v84,v85
v_cvt_pk_bf16_f32 v27,v86,v87
v_mfma_f32_16x16x32_bf16 v[192:195],v[112:115],v[40:43],v[192:195]
v_fma_f32 v93,v93,s36,v15
v_fma_f32 v94,v94,s36,v15
v_smfmac_f32_16x16x64_bf16 v[60:63],v[152:155],v[20:27],v18
v_fma_f32 v95,v95,s36,v15
s_waitcnt vmcnt(6)
s_waitcnt lgkmcnt(0)
v_mfma_f32_16x16x32_bf16 v[196:199],v[116:119],v[40:43],v[196:199]
s_barrier
v_mfma_f32_16x16x32_bf16 v[244:247],v[116:119],v[44:47],v[244:247]
ds_read_b128 v[128:131],v0 offset:0
v_fma_f32 v100,v100,s36,v16
v_mfma_f32_16x16x32_bf16 v[240:243],v[112:115],v[44:47],v[240:243]
ds_read_b128 v[132:135],v1 offset:0
v_fma_f32 v101,v101,s36,v16
v_mfma_f32_16x16x32_bf16 a[32:35],v[112:115],v[48:51],a[32:35]
ds_read_b128 v[136:139],v0 offset:128
v_fma_f32 v102,v102,s36,v16
v_mfma_f32_16x16x32_bf16 a[36:39],v[116:119],v[48:51],a[36:39]
ds_read_b128 v[140:143],v1 offset:128
v_fma_f32 v103,v103,s36,v16
v_mfma_f32_16x16x32_bf16 a[84:87],v[116:119],v[52:55],a[84:87]
v_exp_f32 v92,v92
v_mfma_f32_16x16x32_bf16 a[80:83],v[112:115],v[52:55],a[80:83]
buffer_load_dwordx4 v6,s[8:11],s21 offen offset:0 lds
v_mfma_f32_16x16x32_bf16 a[128:131],v[112:115],v[56:59],a[128:131]
ds_read_b128 v[112:115],v0 offset:256
v_fma_f32 v108,v108,s36,v17
v_mfma_f32_16x16x32_bf16 a[132:135],v[116:119],v[56:59],a[132:135]
ds_read_b128 v[116:119],v1 offset:256
v_fma_f32 v109,v109,s36,v17
v_mfma_f32_16x16x32_bf16 a[136:139],v[120:123],v[56:59],a[136:139]
v_exp_f32 v93,v93
v_mfma_f32_16x16x32_bf16 a[140:143],v[124:127],v[56:59],a[140:143]
v_exp_f32 v94,v94
v_mfma_f32_16x16x32_bf16 a[92:95],v[124:127],v[52:55],a[92:95]
v_exp_f32 v95,v95
v_mfma_f32_16x16x32_bf16 a[88:91],v[120:123],v[52:55],a[88:91]
v_cvt_pk_bf16_f32 v30,v92,v93
v_cvt_pk_bf16_f32 v31,v94,v95
v_mfma_f32_16x16x32_bf16 a[40:43],v[120:123],v[48:51],a[40:43]
v_exp_f32 v100,v100
v_mfma_f32_16x16x32_bf16 a[44:47],v[124:127],v[48:51],a[44:47]
v_exp_f32 v101,v101
v_mfma_f32_16x16x32_bf16 v[252:255],v[124:127],v[44:47],v[252:255]
v_exp_f32 v102,v102
v_mfma_f32_16x16x32_bf16 v[248:251],v[120:123],v[44:47],v[248:251]
v_exp_f32 v103,v103
v_mfma_f32_16x16x32_bf16 v[200:203],v[120:123],v[40:43],v[200:203]
ds_read_b128 v[120:123],v0 offset:6144
v_cvt_pk_bf16_f32 v34,v100,v101
v_mfma_f32_16x16x32_bf16 v[204:207],v[124:127],v[40:43],v[204:207]
buffer_load_dwordx4 v7,s[8:11],s21 offen offset:1024 lds
s_waitcnt lgkmcnt(1)
v_mfma_f32_16x16x32_bf16 v[72:75],v[128:131],a[144:147],0
ds_read_b128 v[124:127],v1 offset:6144
v_cvt_pk_bf16_f32 v35,v102,v103
v_mfma_f32_16x16x32_bf16 v[72:75],v[132:135],a[148:151],v[72:75]
v_fma_f32 v110,v110,s36,v17
v_fma_f32 v111,v111,s36,v17
v_smfmac_f32_16x16x64_bf16 v[64:67],v[152:155],v[28:35],v18
v_mfma_f32_16x16x32_bf16 v[72:75],v[136:139],a[152:155],v[72:75]
v_exp_f32 v108,v108
v_mfma_f32_16x16x32_bf16 v[72:75],v[140:143],a[156:159],v[72:75]
v_exp_f32 v109,v109
v_mfma_f32_16x16x32_bf16 v[72:75],v[112:115],a[160:163],v[72:75]
v_exp_f32 v110,v110
v_mfma_f32_16x16x32_bf16 v[72:75],v[116:119],a[164:167],v[72:75]
v_exp_f32 v111,v111
v_mfma_f32_16x16x32_bf16 v[80:83],v[116:119],a[188:191],0
v_cvt_pk_bf16_f32 v38,v108,v109
v_cvt_pk_bf16_f32 v39,v110,v111
v_mfma_f32_16x16x32_bf16 v[80:83],v[112:115],a[184:187],v[80:83]
v_mfma_f32_16x16x32_bf16 v[80:83],v[140:143],a[180:183],v[80:83]
v_smfmac_f32_16x16x64_bf16 v[68:71],v[152:155],v[32:39],v18
buffer_load_dwordx4 v8,s[8:11],s21 offen offset:2048 lds
v_mfma_f32_16x16x32_bf16 v[80:83],v[136:139],a[176:179],v[80:83]
s_add_u32 s21,s21,12288
v_fma_f32 v72,v72,s36,v13
v_fma_f32 v73,v73,s36,v13
v_mfma_f32_16x16x32_bf16 v[80:83],v[132:135],a[172:175],v[80:83]
s_add_u32 m0,s22,24576
v_fma_f32 v74,v74,s36,v13
v_fma_f32 v75,v75,s36,v13
v_mfma_f32_16x16x32_bf16 v[80:83],v[128:131],a[168:171],v[80:83]
v_exp_f32 v72,v72
v_mfma_f32_16x16x32_bf16 v[88:91],v[128:131],a[192:195],0
v_exp_f32 v73,v73
v_mfma_f32_16x16x32_bf16 v[88:91],v[132:135],a[196:199],v[88:91]
v_exp_f32 v74,v74
v_mfma_f32_16x16x32_bf16 v[88:91],v[136:139],a[200:203],v[88:91]
v_exp_f32 v75,v75
v_mfma_f32_16x16x32_bf16 v[88:91],v[140:143],a[204:207],v[88:91]
v_fma_f32 v80,v80,s36,v14
v_fma_f32 v81,v81,s36,v14
v_mfma_f32_16x16x32_bf16 v[88:91],v[112:115],a[208:211],v[88:91]
v_fma_f32 v82,v82,s36,v14
v_fma_f32 v83,v83,s36,v14
v_mfma_f32_16x16x32_bf16 v[88:91],v[116:119],a[212:215],v[88:91]
v_exp_f32 v80,v80
v_mfma_f32_16x16x32_bf16 v[96:99],v[116:119],a[236:239],0
v_exp_f32 v81,v81
v_mfma_f32_16x16x32_bf16 v[96:99],v[112:115],a[232:235],v[96:99]
buffer_load_dwordx4 v6,s[4:7],s20 offen offset:0 lds
v_mfma_f32_16x16x32_bf16 v[96:99],v[140:143],a[228:231],v[96:99]
v_exp_f32 v82,v82
v_mfma_f32_16x16x32_bf16 v[96:99],v[136:139],a[224:227],v[96:99]
v_fma_f32 v88,v88,s36,v15
v_fma_f32 v89,v89,s36,v15
v_mfma_f32_16x16x32_bf16 v[96:99],v[132:135],a[220:223],v[96:99]
v_exp_f32 v83,v83
v_mfma_f32_16x16x32_bf16 v[96:99],v[128:131],a[216:219],v[96:99]
v_exp_f32 v88,v88
v_mfma_f32_16x16x32_bf16 v[104:107],v[128:131],a[240:243],0
ds_read_b128 v[128:131],v0 offset:6272
v_cvt_pk_bf16_f32 v40,v72,v73
v_mfma_f32_16x16x32_bf16 v[104:107],v[132:135],a[244:247],v[104:107]
ds_read_b128 v[132:135],v1 offset:6272
v_cvt_pk_bf16_f32 v41,v74,v75
v_mfma_f32_16x16x32_bf16 v[104:107],v[136:139],a[248:251],v[104:107]
ds_read_b128 v[136:139],v0 offset:6400
v_cvt_pk_bf16_f32 v44,v80,v81
v_mfma_f32_16x16x32_bf16 v[104:107],v[140:143],a[252:255],v[104:107]
ds_read_b128 v[140:143],v1 offset:6400
v_cvt_pk_bf16_f32 v45,v82,v83
v_mfma_f32_16x16x32_bf16 v[104:107],v[112:115],v[144:147],v[104:107]
v_exp_f32 v89,v89
v_mfma_f32_16x16x32_bf16 v[104:107],v[116:119],v[148:151],v[104:107]
s_waitcnt lgkmcnt(4)
v_cvt_pk_bf16_f32 v48,v88,v89
v_mfma_f32_16x16x32_bf16 v[76:79],v[120:123],a[144:147],0
buffer_load_dwordx4 v7,s[4:7],s20 offen offset:1024 lds
v_mfma_f32_16x16x32_bf16 v[76:79],v[124:127],a[148:151],v[76:79]
s_waitcnt lgkmcnt(3)
v_mfma_f32_16x16x32_bf16 v[76:79],v[128:131],a[152:155],v[76:79]
s_waitcnt lgkmcnt(2)
v_mfma_f32_16x16x32_bf16 v[76:79],v[132:135],a[156:159],v[76:79]
s_waitcnt lgkmcnt(1)
v_mfma_f32_16x16x32_bf16 v[76:79],v[136:139],a[160:163],v[76:79]
s_waitcnt lgkmcnt(0)
v_mfma_f32_16x16x32_bf16 v[76:79],v[140:143],a[164:167],v[76:79]
v_mfma_f32_16x16x32_bf16 v[84:87],v[140:143],a[188:191],0
v_mfma_f32_16x16x32_bf16 v[84:87],v[136:139],a[184:187],v[84:87]
v_mfma_f32_16x16x32_bf16 v[84:87],v[132:135],a[180:183],v[84:87]
v_mfma_f32_16x16x32_bf16 v[84:87],v[128:131],a[176:179],v[84:87]
v_mfma_f32_16x16x32_bf16 v[84:87],v[124:127],a[172:175],v[84:87]
v_mfma_f32_16x16x32_bf16 v[84:87],v[120:123],a[168:171],v[84:87]
buffer_load_dwordx4 v8,s[4:7],s20 offen offset:2048 lds
v_mfma_f32_16x16x32_bf16 v[92:95],v[120:123],a[192:195],0
s_add_u32 s20,s20,12288
v_mfma_f32_16x16x32_bf16 v[92:95],v[124:127],a[196:199],v[92:95]
v_mfma_f32_16x16x32_bf16 v[92:95],v[128:131],a[200:203],v[92:95]
v_mfma_f32_16x16x32_bf16 v[92:95],v[132:135],a[204:207],v[92:95]
v_mfma_f32_16x16x32_bf16 v[92:95],v[136:139],a[208:211],v[92:95]
ds_read_b64_tr_b16 v[112:113],v2 offset:24576
v_mfma_f32_16x16x32_bf16 v[92:95],v[140:143],a[212:215],v[92:95]
ds_read_b64_tr_b16 v[114:115],v2 offset:30720
v_mfma_f32_16x16x32_bf16 v[100:103],v[140:143],a[236:239],0
v_mfma_f32_16x16x32_bf16 v[100:103],v[136:139],a[232:235],v[100:103]
ds_read_b64_tr_b16 v[116:117],v3 offset:24576
v_mfma_f32_16x16x32_bf16 v[100:103],v[132:135],a[228:231],v[100:103]
ds_read_b64_tr_b16 v[118:119],v3 offset:30720
v_mfma_f32_16x16x32_bf16 v[100:103],v[128:131],a[224:227],v[100:103]
v_mfma_f32_16x16x32_bf16 v[100:103],v[124:127],a[220:223],v[100:103]
v_mfma_f32_16x16x32_bf16 v[100:103],v[120:123],a[216:219],v[100:103]
v_mfma_f32_16x16x32_bf16 v[108:111],v[120:123],a[240:243],0
ds_read_b64_tr_b16 v[120:121],v4 offset:24576
v_mfma_f32_16x16x32_bf16 v[108:111],v[124:127],a[244:247],v[108:111]
ds_read_b64_tr_b16 v[122:123],v4 offset:30720
v_mfma_f32_16x16x32_bf16 v[108:111],v[128:131],a[248:251],v[108:111]
ds_read_b64_tr_b16 v[124:125],v5 offset:24576
v_mfma_f32_16x16x32_bf16 v[108:111],v[132:135],a[252:255],v[108:111]
ds_read_b64_tr_b16 v[126:127],v5 offset:30720
v_mfma_f32_16x16x32_bf16 v[108:111],v[136:139],v[144:147],v[108:111]
v_mfma_f32_16x16x32_bf16 v[108:111],v[140:143],v[148:151],v[108:111]
s_mov_b32 s38,0
s_branch L_loop5
L_tr44:
s_waitcnt vmcnt(42)
s_waitcnt lgkmcnt(4)
v_mfma_f32_16x16x32_bf16 v[160:163],v[112:115],v[20:23],v[160:163]
s_add_u32 m0,s24,0
ds_read_b128 a[144:147],v11 offset:0
v_fma_f32 v82,v82,s36,v14
v_mfma_f32_16x16x32_bf16 v[164:167],v[116:119],v[20:23],v[164:167]
ds_read_b128 a[148:151],v12 offset:0
v_fma_f32 v83,v83,s36,v14
v_mfma_f32_16x16x32_bf16 v[212:215],v[116:119],v[24:27],v[212:215]
ds_read_b128 a[152:155],v11 offset:128
v_fma_f32 v88,v88,s36,v15
v_mfma_f32_16x16x32_bf16 v[208:211],v[112:115],v[24:27],v[208:211]
ds_read_b128 a[156:159],v12 offset:128
v_fma_f32 v89,v89,s36,v15
v_mfma_f32_16x16x32_bf16 a[0:3],v[112:115],v[28:31],a[0:3]
ds_read_b128 a[160:163],v11 offset:256
v_fma_f32 v90,v90,s36,v15
v_mfma_f32_16x16x32_bf16 a[4:7],v[116:119],v[28:31],a[4:7]
ds_read_b128 a[164:167],v12 offset:256
v_fma_f32 v91,v91,s36,v15
ds_read_b64_tr_b16 v[128:129],v2 offset:24704
ds_read_b64_tr_b16 v[130:131],v2 offset:30848
ds_read_b64_tr_b16 v[132:133],v3 offset:24704
ds_read_b64_tr_b16 v[134:135],v3 offset:30848
ds_read_b64_tr_b16 v[136:137],v4 offset:24704
ds_read_b64_tr_b16 v[138:139],v4 offset:30848
ds_read_b64_tr_b16 v[140:141],v5 offset:24704
ds_read_b64_tr_b16 v[142:143],v5 offset:30848
ds_read_b128 a[168:171],v11 offset:6144
v_mfma_f32_16x16x32_bf16 a[52:55],v[116:119],v[32:35],a[52:55]
v_fma_f32 v96,v96,s36,v16
ds_read_b128 a[172:175],v12 offset:6144
v_mfma_f32_16x16x32_bf16 a[48:51],v[112:115],v[32:35],a[48:51]
s_waitcnt lgkmcnt(13)
v_fma_f32 v97,v97,s36,v16
ds_read_b128 a[176:179],v11 offset:6272
v_mfma_f32_16x16x32_bf16 a[56:59],v[120:123],v[32:35],a[56:59]
s_waitcnt lgkmcnt(11)
buffer_load_dwordx4 v6,s[12:15],s28 offen offset:0 nt lds
v_mfma_f32_16x16x32_bf16 a[60:63],v[124:127],v[32:35],a[60:63]
ds_read_b64_tr_b16 v[112:113],v2 offset:24832
ds_read_b128 a[180:183],v12 offset:6272
v_mfma_f32_16x16x32_bf16 a[12:15],v[124:127],v[28:31],a[12:15]
v_fma_f32 v98,v98,s36,v16
ds_read_b64_tr_b16 v[116:117],v3 offset:24832
ds_read_b64_tr_b16 v[118:119],v3 offset:30976
ds_read_b64_tr_b16 v[114:115],v2 offset:30976
ds_read_b128 a[184:187],v11 offset:6400
v_mfma_f32_16x16x32_bf16 a[8:11],v[120:123],v[28:31],a[8:11]
v_fma_f32 v99,v99,s36,v16
ds_read_b128 a[188:191],v12 offset:6400
v_mfma_f32_16x16x32_bf16 v[216:219],v[120:123],v[24:27],v[216:219]
buffer_load_dwordx4 v7,s[12:15],s28 offen offset:1024 nt lds
v_mfma_f32_16x16x32_bf16 v[220:223],v[124:127],v[24:27],v[220:223]
v_fma_f32 v76,v76,s36,v13
v_fma_f32 v77,v77,s36,v13
v_mfma_f32_16x16x32_bf16 v[172:175],v[124:127],v[20:23],v[172:175]
ds_read_b64_tr_b16 v[124:125],v5 offset:24832
v_fma_f32 v78,v78,s36,v13
v_mfma_f32_16x16x32_bf16 v[168:171],v[120:123],v[20:23],v[168:171]
s_waitcnt lgkmcnt(8)
ds_read_b64_tr_b16 v[120:121],v4 offset:24832
v_fma_f32 v79,v79,s36,v13
v_mfma_f32_16x16x32_bf16 v[176:179],v[128:131],v[20:23],v[176:179]
ds_read_b64_tr_b16 v[122:123],v4 offset:30976
v_fma_f32 v84,v84,s36,v14
v_mfma_f32_16x16x32_bf16 v[180:183],v[132:135],v[20:23],v[180:183]
ds_read_b64_tr_b16 v[126:127],v5 offset:30976
v_fma_f32 v85,v85,s36,v14
v_mfma_f32_16x16x32_bf16 v[228:231],v[132:135],v[24:27],v[228:231]
v_fma_f32 v86,v86,s36,v14
v_fma_f32 v87,v87,s36,v14
v_mfma_f32_16x16x32_bf16 v[224:227],v[128:131],v[24:27],v[224:227]
buffer_load_dwordx4 v8,s[12:15],s28 offen offset:2048 nt lds
v_mfma_f32_16x16x32_bf16 a[16:19],v[128:131],v[28:31],a[16:19]
s_add_u32 s28,s28,3072
v_fma_f32 v92,v92,s36,v15
v_fma_f32 v93,v93,s36,v15
v_mfma_f32_16x16x32_bf16 a[20:23],v[132:135],v[28:31],a[20:23]
s_add_u32 m0,s24,3072
v_fma_f32 v94,v94,s36,v15
v_fma_f32 v95,v95,s36,v15
v_mfma_f32_16x16x32_bf16 a[68:71],v[132:135],v[32:35],a[68:71]
v_fma_f32 v100,v100,s36,v16
v_fma_f32 v101,v101,s36,v16
v_mfma_f32_16x16x32_bf16 a[64:67],v[128:131],v[32:35],a[64:67]
v_fma_f32 v102,v102,s36,v16
v_fma_f32 v103,v103,s36,v16
v_mfma_f32_16x16x32_bf16 a[72:75],v[136:139],v[32:35],a[72:75]
v_exp_f32 v82,v82
v_mfma_f32_16x16x32_bf16 a[76:79],v[140:143],v[32:35],a[76:79]
v_exp_f32 v83,v83
v_mfma_f32_16x16x32_bf16 a[28:31],v[140:143],v[28:31],a[28:31]
v_exp_f32 v88,v88
v_mfma_f32_16x16x32_bf16 a[24:27],v[136:139],v[28:31],a[24:27]
buffer_load_dwordx4 v6,s[12:15],s28 offen offset:0 nt lds
v_mfma_f32_16x16x32_bf16 v[232:235],v[136:139],v[24:27],v[232:235]
v_exp_f32 v89,v89
v_mfma_f32_16x16x32_bf16 v[236:239],v[140:143],v[24:27],v[236:239]
v_exp_f32 v90,v90
v_mfma_f32_16x16x32_bf16 v[188:191],v[140:143],v[20:23],v[188:191]
v_exp_f32 v91,v91
v_mfma_f32_16x16x32_bf16 v[184:187],v[136:139],v[20:23],v[184:187]
s_waitcnt lgkmcnt(0)
v_exp_f32 v96,v96
v_mfma_f32_16x16x32_bf16 v[192:195],v[112:115],v[20:23],v[192:195]
v_exp_f32 v97,v97
v_mfma_f32_16x16x32_bf16 v[196:199],v[116:119],v[20:23],v[196:199]
v_exp_f32 v98,v98
v_mfma_f32_16x16x32_bf16 v[244:247],v[116:119],v[24:27],v[244:247]
v_exp_f32 v99,v99
v_mfma_f32_16x16x32_bf16 v[240:243],v[112:115],v[24:27],v[240:243]
buffer_load_dwordx4 v7,s[12:15],s28 offen offset:1024 nt lds
v_mfma_f32_16x16x32_bf16 a[32:35],v[112:115],v[28:31],a[32:35]
v_exp_f32 v76,v76
v_mfma_f32_16x16x32_bf16 a[36:39],v[116:119],v[28:31],a[36:39]
v_exp_f32 v77,v77
v_mfma_f32_16x16x32_bf16 a[84:87],v[116:119],v[32:35],a[84:87]
v_exp_f32 v78,v78
v_mfma_f32_16x16x32_bf16 a[80:83],v[112:115],v[32:35],a[80:83]
v_exp_f32 v79,v79
v_mfma_f32_16x16x32_bf16 a[88:91],v[120:123],v[32:35],a[88:91]
v_exp_f32 v84,v84
v_mfma_f32_16x16x32_bf16 a[92:95],v[124:127],v[32:35],a[92:95]
v_exp_f32 v85,v85
v_mfma_f32_16x16x32_bf16 a[44:47],v[124:127],v[28:31],a[44:47]
v_exp_f32 v86,v86
v_mfma_f32_16x16x32_bf16 a[40:43],v[120:123],v[28:31],a[40:43]
buffer_load_dwordx4 v8,s[12:15],s28 offen offset:2048 nt lds
s_waitcnt vmcnt(20)
s_barrier
v_mfma_f32_16x16x32_bf16 v[248:251],v[120:123],v[24:27],v[248:251]
s_add_u32 s28,s28,3072
ds_read_b64_tr_b16 v[128:129],v2 offset:0
v_exp_f32 v87,v87
v_mfma_f32_16x16x32_bf16 v[252:255],v[124:127],v[24:27],v[252:255]
s_add_u32 m0,s22,0
ds_read_b64_tr_b16 v[130:131],v2 offset:6144
buffer_load_dwordx4 v6,s[4:7],s25 offen offset:0 lds
v_mfma_f32_16x16x32_bf16 v[204:207],v[124:127],v[20:23],v[204:207]
buffer_load_dwordx4 v7,s[4:7],s25 offen offset:1024 lds
v_mfma_f32_16x16x32_bf16 v[200:203],v[120:123],v[20:23],v[200:203]
buffer_load_dwordx4 v8,s[4:7],s25 offen offset:2048 lds
ds_read_b64_tr_b16 v[132:133],v3 offset:0
ds_read_b64_tr_b16 v[134:135],v3 offset:6144
ds_read_b64_tr_b16 v[136:137],v4 offset:0
ds_read_b64_tr_b16 v[138:139],v4 offset:6144
ds_read_b64_tr_b16 v[140:141],v5 offset:0
ds_read_b64_tr_b16 v[142:143],v5 offset:6144
v_exp_f32 v92,v92
v_exp_f32 v93,v93
v_exp_f32 v94,v94
v_exp_f32 v95,v95
v_exp_f32 v100,v100
v_exp_f32 v101,v101
v_exp_f32 v102,v102
v_exp_f32 v103,v103
v_cvt_pk_bf16_f32 v45,v82,v83
v_cvt_pk_bf16_f32 v48,v88,v89
v_cvt_pk_bf16_f32 v49,v90,v91
v_cvt_pk_bf16_f32 v52,v96,v97
v_cvt_pk_bf16_f32 v53,v98,v99
v_cvt_pk_bf16_f32 v42,v76,v77
v_cvt_pk_bf16_f32 v43,v78,v79
v_cvt_pk_bf16_f32 v46,v84,v85
v_cvt_pk_bf16_f32 v47,v86,v87
v_cvt_pk_bf16_f32 v50,v92,v93
v_cvt_pk_bf16_f32 v51,v94,v95
v_smfmac_f32_16x16x64_bf16 v[60:63],v[152:155],v[40:47],v18
v_cvt_pk_bf16_f32 v54,v100,v101
v_cvt_pk_bf16_f32 v55,v102,v103
v_subrev_u32 v10,18432,v10
s_nop 0
v_smfmac_f32_16x16x64_bf16 v[64:67],v[152:155],v[48:55],v18
s_waitcnt lgkmcnt(0)
v_mfma_f32_16x16x32_bf16 v[160:163],v[128:131],v[40:43],v[160:163]
s_add_u32 s87,s42,18432
ds_read_b64_tr_b16 v[112:113],v2 offset:128
v_mbcnt_lo_u32_b32 v39,-1,0
v_mfma_f32_16x16x32_bf16 v[164:167],v[132:135],v[40:43],v[164:167]
ds_read_b64_tr_b16 v[114:115],v2 offset:6272
v_mbcnt_hi_u32_b32 v39,-1,v39
v_mfma_f32_16x16x32_bf16 v[212:215],v[132:135],v[44:47],v[212:215]
ds_read_b64_tr_b16 v[116:117],v3 offset:128
v_and_b32 v38,7,v39
v_mfma_f32_16x16x32_bf16 v[208:211],v[128:131],v[44:47],v[208:211]
ds_read_b64_tr_b16 v[118:119],v3 offset:6272
v_add_f32 v60,v60,v61
v_mfma_f32_16x16x32_bf16 a[0:3],v[128:131],v[48:51],a[0:3]
ds_read_b64_tr_b16 v[120:121],v4 offset:128
v_add_f32 v62,v62,v63
v_mfma_f32_16x16x32_bf16 a[4:7],v[132:135],v[48:51],a[4:7]
ds_read_b64_tr_b16 v[122:123],v4 offset:6272
ds_read_b64_tr_b16 v[124:125],v5 offset:128
ds_read_b64_tr_b16 v[126:127],v5 offset:6272
v_mfma_f32_16x16x32_bf16 a[52:55],v[132:135],v[52:55],a[52:55]
ds_read_b64_tr_b16 v[132:133],v3 offset:256
v_add_f32 v64,v64,v65
v_mfma_f32_16x16x32_bf16 a[48:51],v[128:131],v[52:55],a[48:51]
ds_read_b64_tr_b16 v[128:129],v2 offset:256
v_add_f32 v66,v66,v67
v_mfma_f32_16x16x32_bf16 a[56:59],v[136:139],v[52:55],a[56:59]
ds_read_b64_tr_b16 v[130:131],v2 offset:6400
v_max3_f32 v19,v60,v62,v64
v_mfma_f32_16x16x32_bf16 a[60:63],v[140:143],v[52:55],a[60:63]
ds_read_b64_tr_b16 v[134:135],v3 offset:6400
v_max_f32 v19,v19,v66
v_mfma_f32_16x16x32_bf16 a[12:15],v[140:143],v[48:51],a[12:15]
v_rcp_f32 v66,v66
v_mfma_f32_16x16x32_bf16 a[8:11],v[136:139],v[48:51],a[8:11]
v_accvgpr_read_b32 v80,a52
v_accvgpr_read_b32 v81,a53
v_mfma_f32_16x16x32_bf16 v[216:219],v[136:139],v[44:47],v[216:219]
v_accvgpr_read_b32 v82,a54
v_accvgpr_read_b32 v83,a55
v_mfma_f32_16x16x32_bf16 v[220:223],v[140:143],v[44:47],v[220:223]
v_accvgpr_read_b32 v72,a48
v_accvgpr_read_b32 v73,a49
v_mfma_f32_16x16x32_bf16 v[172:175],v[140:143],v[40:43],v[172:175]
ds_read_b64_tr_b16 v[140:141],v5 offset:256
v_accvgpr_read_b32 v74,a50
v_mfma_f32_16x16x32_bf16 v[168:171],v[136:139],v[40:43],v[168:171]
s_waitcnt lgkmcnt(4)
ds_read_b64_tr_b16 v[142:143],v5 offset:6400
v_accvgpr_read_b32 v75,a51
v_mfma_f32_16x16x32_bf16 v[176:179],v[112:115],v[40:43],v[176:179]
ds_read_b64_tr_b16 v[136:137],v4 offset:256
v_accvgpr_read_b32 v88,a56
v_mfma_f32_16x16x32_bf16 v[180:183],v[116:119],v[40:43],v[180:183]
ds_read_b64_tr_b16 v[138:139],v4 offset:6400
v_accvgpr_read_b32 v89,a57
v_mfma_f32_16x16x32_bf16 v[228:231],v[116:119],v[44:47],v[228:231]
v_accvgpr_read_b32 v90,a58
v_accvgpr_read_b32 v91,a59
v_mfma_f32_16x16x32_bf16 v[224:227],v[112:115],v[44:47],v[224:227]
v_accvgpr_read_b32 v96,a60
v_accvgpr_read_b32 v97,a61
v_mfma_f32_16x16x32_bf16 a[16:19],v[112:115],v[48:51],a[16:19]
v_accvgpr_read_b32 v98,a62
v_accvgpr_read_b32 v99,a63
v_mfma_f32_16x16x32_bf16 a[20:23],v[116:119],v[48:51],a[20:23]
v_cmp_ngt_f32 vcc,s37,v19
v_lshrrev_b32 v19,5,v39
v_mfma_f32_16x16x32_bf16 a[68:71],v[116:119],v[52:55],a[68:71]
v_xor_b32 v38,v38,v19
v_and_b32 v19,15,v39
v_mfma_f32_16x16x32_bf16 a[64:67],v[112:115],v[52:55],a[64:67]
s_cmp_lg_u64 vcc,0
v_lshl_add_u32 v19,v19,7,s24
v_lshl_add_u32 v19,v38,4,v19
v_mfma_f32_16x16x32_bf16 a[72:75],v[120:123],v[52:55],a[72:75]
s_cselect_b32 s62,s32,0
v_bfe_u32 v38,v39,4,1
v_lshl_add_u32 v36,v38,3,v19
v_mfma_f32_16x16x32_bf16 a[76:79],v[124:127],v[52:55],a[76:79]
s_or_b32 s31,s31,s62
v_xor_b32 v37,32,v36
v_bfe_u32 v19,v39,3,1
v_mfma_f32_16x16x32_bf16 a[28:31],v[124:127],v[48:51],a[28:31]
s_lshl_b32 s32,s32,1
v_xor_b32 v38,64,v36
v_xor_b32 v39,96,v36
v_lshlrev_b32 v19,11,v19
v_accvgpr_read_b32 v84,a68
v_accvgpr_read_b32 v85,a69
v_pk_mul_f32 v[72:73],v[72:73],v[66:67] op_sel_hi:[1,0]
v_pk_mul_f32 v[74:75],v[74:75],v[66:67] op_sel_hi:[1,0]
v_pk_mul_f32 v[80:81],v[80:81],v[66:67] op_sel_hi:[1,0]
v_pk_mul_f32 v[82:83],v[82:83],v[66:67] op_sel_hi:[1,0]
v_pk_mul_f32 v[84:85],v[84:85],v[66:67] op_sel_hi:[1,0]
v_accvgpr_read_b32 v86,a70
v_accvgpr_read_b32 v87,a71
v_pk_mul_f32 v[86:87],v[86:87],v[66:67] op_sel_hi:[1,0]
v_accvgpr_read_b32 v76,a64
v_accvgpr_read_b32 v77,a65
v_pk_mul_f32 v[76:77],v[76:77],v[66:67] op_sel_hi:[1,0]
v_accvgpr_read_b32 v78,a66
v_accvgpr_read_b32 v79,a67
v_pk_mul_f32 v[78:79],v[78:79],v[66:67] op_sel_hi:[1,0]
v_accvgpr_read_b32 v92,a72
v_accvgpr_read_b32 v93,a73
v_mfma_f32_16x16x32_bf16 a[24:27],v[120:123],v[48:51],a[24:27]
s_add_u32 m0,s23,0
v_accvgpr_read_b32 v94,a74
v_accvgpr_read_b32 v95,a75
v_accvgpr_read_b32 v100,a76
v_accvgpr_read_b32 v101,a77
v_accvgpr_read_b32 v102,a78
v_pk_mul_f32 v[88:89],v[88:89],v[66:67] op_sel_hi:[1,0]
v_pk_mul_f32 v[90:91],v[90:91],v[66:67] op_sel_hi:[1,0]
v_pk_mul_f32 v[92:93],v[92:93],v[66:67] op_sel_hi:[1,0]
v_pk_mul_f32 v[94:95],v[94:95],v[66:67] op_sel_hi:[1,0]
v_accvgpr_read_b32 v103,a79
v_cvt_pk_bf16_f32 v72,v72,v73
v_mfma_f32_16x16x32_bf16 v[232:235],v[120:123],v[44:47],v[232:235]
v_cvt_pk_bf16_f32 v76,v76,v77
v_cvt_pk_bf16_f32 v80,v80,v81
v_cvt_pk_bf16_f32 v84,v84,v85
v_cvt_pk_bf16_f32 v73,v74,v75
v_cvt_pk_bf16_f32 v77,v78,v79
ds_write2st64_b64 v36,v[72:73],v[76:77] offset0:36 offset1:40
v_pk_mul_f32 v[96:97],v[96:97],v[66:67] op_sel_hi:[1,0]
v_pk_mul_f32 v[98:99],v[98:99],v[66:67] op_sel_hi:[1,0]
v_pk_mul_f32 v[100:101],v[100:101],v[66:67] op_sel_hi:[1,0]
v_pk_mul_f32 v[102:103],v[102:103],v[66:67] op_sel_hi:[1,0]
v_cvt_pk_bf16_f32 v88,v88,v89
v_cvt_pk_bf16_f32 v92,v92,v93
v_mfma_f32_16x16x32_bf16 v[236:239],v[124:127],v[44:47],v[236:239]
v_cvt_pk_bf16_f32 v81,v82,v83
v_cvt_pk_bf16_f32 v85,v86,v87
v_mfma_f32_16x16x32_bf16 v[188:191],v[124:127],v[40:43],v[188:191]
v_cvt_pk_bf16_f32 v96,v96,v97
v_cvt_pk_bf16_f32 v100,v100,v101
v_mfma_f32_16x16x32_bf16 v[184:187],v[120:123],v[40:43],v[184:187]
s_waitcnt lgkmcnt(1)
ds_write2st64_b64 v37,v[80:81],v[84:85] offset0:36 offset1:40
v_mfma_f32_16x16x32_bf16 v[192:195],v[128:131],v[40:43],v[192:195]
v_cvt_pk_bf16_f32 v89,v90,v91
v_cvt_pk_bf16_f32 v93,v94,v95
v_mfma_f32_16x16x32_bf16 v[196:199],v[132:135],v[40:43],v[196:199]
v_cvt_pk_bf16_f32 v97,v98,v99
v_cvt_pk_bf16_f32 v101,v102,v103
v_mfma_f32_16x16x32_bf16 v[244:247],v[132:135],v[44:47],v[244:247]
v_rcp_f32 v62,v62
v_mfma_f32_16x16x32_bf16 v[240:243],v[128:131],v[44:47],v[240:243]
ds_write2st64_b64 v38,v[88:89],v[92:93] offset0:36 offset1:40
v_mfma_f32_16x16x32_bf16 a[32:35],v[128:131],v[48:51],a[32:35]
v_rcp_f32 v64,v64
v_mfma_f32_16x16x32_bf16 a[36:39],v[132:135],v[48:51],a[36:39]
v_accvgpr_read_b32 v102,a2
v_accvgpr_read_b32 v103,a3
v_mfma_f32_16x16x32_bf16 a[84:87],v[132:135],v[52:55],a[84:87]
v_rcp_f32 v60,v60
v_mfma_f32_16x16x32_bf16 a[80:83],v[128:131],v[52:55],a[80:83]
ds_write2st64_b64 v39,v[96:97],v[100:101] offset0:36 offset1:40
v_mfma_f32_16x16x32_bf16 a[88:91],v[136:139],v[52:55],a[88:91]
v_accvgpr_read_b32 v100,a0
v_accvgpr_read_b32 v101,a1
v_mfma_f32_16x16x32_bf16 a[92:95],v[140:143],v[52:55],a[92:95]
ds_read_b128 v[156:159],v10 offset:18432
v_accvgpr_read_b32 v80,a84
v_mfma_f32_16x16x32_bf16 a[44:47],v[140:143],v[48:51],a[44:47]
s_waitcnt vmcnt(15)
ds_read_b128 a[192:195],v11 offset:12288
v_accvgpr_read_b32 v81,a85
ds_read_b128 a[196:199],v12 offset:12288
v_pk_mul_f32 v[80:81],v[80:81],v[66:67] op_sel_hi:[1,0]
ds_read_b128 a[200:203],v11 offset:12416
v_accvgpr_read_b32 v82,a86
ds_read_b128 a[204:207],v12 offset:12416
v_accvgpr_read_b32 v83,a87
ds_read_b128 a[208:211],v11 offset:12544
v_pk_mul_f32 v[82:83],v[82:83],v[66:67] op_sel_hi:[1,0]
ds_read_b128 a[212:215],v12 offset:12544
v_accvgpr_read_b32 v76,a80
ds_read_b128 v[104:107],v10 offset:19456
v_accvgpr_read_b32 v77,a81
ds_read_b128 v[108:111],v10 offset:20480
s_waitcnt lgkmcnt(8)
buffer_store_dwordx4 v[156:159],v9,s[16:19],s87 offen offset:0 nt
ds_read_b128 v[72:75],v10 offset:21504
v_pk_mul_f32 v[76:77],v[76:77],v[66:67] op_sel_hi:[1,0]
v_accvgpr_read_b32 v78,a82
v_accvgpr_read_b32 v79,a83
v_pk_mul_f32 v[78:79],v[78:79],v[66:67] op_sel_hi:[1,0]
v_accvgpr_read_b32 v84,a88
v_accvgpr_read_b32 v85,a89
v_mfma_f32_16x16x32_bf16 a[40:43],v[136:139],v[48:51],a[40:43]
v_accvgpr_read_b32 v86,a90
v_accvgpr_read_b32 v87,a91
v_accvgpr_read_b32 v88,a92
v_accvgpr_read_b32 v89,a93
v_accvgpr_read_b32 v90,a94
v_pk_mul_f32 v[84:85],v[84:85],v[66:67] op_sel_hi:[1,0]
v_pk_mul_f32 v[86:87],v[86:87],v[66:67] op_sel_hi:[1,0]
v_accvgpr_read_b32 v91,a95
v_cvt_pk_bf16_f32 v76,v76,v77
v_mfma_f32_16x16x32_bf16 v[248:251],v[136:139],v[44:47],v[248:251]
s_waitcnt lgkmcnt(2)
v_cvt_pk_bf16_f32 v77,v78,v79
ds_write_b64 v36,v[76:77] offset:18432
buffer_store_dwordx4 v[104:107],v9,s[16:19],s87 offen offset:3072 nt
v_pk_mul_f32 v[88:89],v[88:89],v[66:67] op_sel_hi:[1,0]
v_pk_mul_f32 v[90:91],v[90:91],v[66:67] op_sel_hi:[1,0]
v_pk_mul_f32 v[208:209],v[208:209],v[62:63] op_sel_hi:[1,0]
v_pk_mul_f32 v[210:211],v[210:211],v[62:63] op_sel_hi:[1,0]
v_pk_mul_f32 v[224:225],v[224:225],v[62:63] op_sel_hi:[1,0]
v_pk_mul_f32 v[226:227],v[226:227],v[62:63] op_sel_hi:[1,0]
v_pk_mul_f32 v[212:213],v[212:213],v[62:63] op_sel_hi:[1,0]
v_pk_mul_f32 v[214:215],v[214:215],v[62:63] op_sel_hi:[1,0]
v_pk_mul_f32 v[228:229],v[228:229],v[62:63] op_sel_hi:[1,0]
v_pk_mul_f32 v[230:231],v[230:231],v[62:63] op_sel_hi:[1,0]
v_pk_mul_f32 v[216:217],v[216:217],v[62:63] op_sel_hi:[1,0]
s_waitcnt lgkmcnt(1)
buffer_store_dwordx4 v[108:111],v9,s[16:19],s87 offen offset:128 nt
v_pk_mul_f32 v[218:219],v[218:219],v[62:63] op_sel_hi:[1,0]
v_pk_mul_f32 v[232:233],v[232:233],v[62:63] op_sel_hi:[1,0]
v_pk_mul_f32 v[234:235],v[234:235],v[62:63] op_sel_hi:[1,0]
v_pk_mul_f32 v[220:221],v[220:221],v[62:63] op_sel_hi:[1,0]
v_pk_mul_f32 v[222:223],v[222:223],v[62:63] op_sel_hi:[1,0]
v_pk_mul_f32 v[236:237],v[236:237],v[62:63] op_sel_hi:[1,0]
v_pk_mul_f32 v[238:239],v[238:239],v[62:63] op_sel_hi:[1,0]
v_add_u32 v36,v36,v19
v_accvgpr_read_b32 v78,a6
v_mfma_f32_16x16x32_bf16 v[252:255],v[140:143],v[44:47],v[252:255]
v_accvgpr_read_b32 v79,a7
v_accvgpr_read_b32 v76,a4
v_mfma_f32_16x16x32_bf16 v[204:207],v[140:143],v[40:43],v[204:207]
buffer_store_dwordx4 v[72:75],v9,s[16:19],s87 offen offset:3200 nt
v_accvgpr_read_b32 v77,a5
v_cvt_pk_bf16_f32 v80,v80,v81
v_cvt_pk_bf16_f32 v84,v84,v85
v_pk_mul_f32 v[240:241],v[240:241],v[62:63] op_sel_hi:[1,0]
s_waitcnt vmcnt(4)
s_barrier
ds_read_b128 v[112:115],v0 offset:0
v_pk_mul_f32 v[242:243],v[242:243],v[62:63] op_sel_hi:[1,0]
ds_read_b128 v[116:119],v1 offset:0
v_pk_mul_f32 v[100:101],v[100:101],v[64:65] op_sel_hi:[1,0]
ds_read_b128 v[120:123],v0 offset:128
v_pk_mul_f32 v[102:103],v[102:103],v[64:65] op_sel_hi:[1,0]
v_cvt_pk_bf16_f32 v81,v82,v83
v_cvt_pk_bf16_f32 v88,v88,v89
v_mfma_f32_16x16x32_bf16 v[200:203],v[136:139],v[40:43],v[200:203]
ds_write_b64 v37,v[80:81] offset:18432
ds_read_b128 v[124:127],v1 offset:128
buffer_load_dwordx4 v6,s[8:11],s25 offen offset:0 lds
ds_read_b128 v[128:131],v0 offset:256
v_add_u32 v37,v37,v19
ds_read_b128 v[132:135],v1 offset:256
v_cvt_pk_bf16_f32 v85,v86,v87
ds_read_b128 v[140:143],v1 offset:6144
v_cvt_pk_bf16_f32 v89,v90,v91
v_accvgpr_read_b32 v104,a8
v_accvgpr_read_b32 v105,a9
s_waitcnt lgkmcnt(7)
v_mfma_f32_16x16x32_bf16 v[72:75],v[112:115],a[144:147],0
s_waitcnt lgkmcnt(5)
ds_write_b64 v38,v[84:85] offset:18432
ds_read_b128 v[136:139],v0 offset:6144
v_mfma_f32_16x16x32_bf16 v[72:75],v[116:119],a[148:151],v[72:75]
v_add_u32 v38,v38,v19
ds_write_b64 v39,v[88:89] offset:18432
ds_read_b128 v[92:95],v10 offset:18432
buffer_load_dwordx4 v7,s[8:11],s25 offen offset:1024 lds
ds_read_b128 v[96:99],v10 offset:19456
v_pk_mul_f32 v[244:245],v[244:245],v[62:63] op_sel_hi:[1,0]
v_pk_mul_f32 v[246:247],v[246:247],v[62:63] op_sel_hi:[1,0]
v_pk_mul_f32 v[76:77],v[76:77],v[64:65] op_sel_hi:[1,0]
v_pk_mul_f32 v[78:79],v[78:79],v[64:65] op_sel_hi:[1,0]
v_add_u32 v39,v39,v19
v_accvgpr_read_b32 v106,a10
v_mfma_f32_16x16x32_bf16 v[72:75],v[120:123],a[152:155],v[72:75]
s_waitcnt lgkmcnt(5)
v_accvgpr_read_b32 v107,a11
v_accvgpr_read_b32 v108,a12
v_mfma_f32_16x16x32_bf16 v[72:75],v[124:127],a[156:159],v[72:75]
v_accvgpr_read_b32 v109,a13
v_accvgpr_read_b32 v110,a14
v_mfma_f32_16x16x32_bf16 v[72:75],v[128:131],a[160:163],v[72:75]
v_accvgpr_read_b32 v111,a15
v_cvt_pk_bf16_f32 v208,v208,v209
v_mfma_f32_16x16x32_bf16 v[72:75],v[132:135],a[164:167],v[72:75]
v_cvt_pk_bf16_f32 v224,v224,v225
v_cvt_pk_bf16_f32 v209,v210,v211
v_cvt_pk_bf16_f32 v225,v226,v227
ds_write2st64_b64 v36,v[208:209],v[224:225] offset0:12 offset1:14
v_pk_mul_f32 v[248:249],v[248:249],v[62:63] op_sel_hi:[1,0]
v_pk_mul_f32 v[250:251],v[250:251],v[62:63] op_sel_hi:[1,0]
v_pk_mul_f32 v[104:105],v[104:105],v[64:65] op_sel_hi:[1,0]
buffer_load_dwordx4 v8,s[8:11],s25 offen offset:2048 lds
s_waitcnt lgkmcnt(1)
buffer_store_dwordx4 v[92:95],v9,s[16:19],s87 offen offset:256 nt
v_pk_mul_f32 v[106:107],v[106:107],v[64:65] op_sel_hi:[1,0]
v_accvgpr_read_b32 v86,a18
v_accvgpr_read_b32 v87,a19
v_mfma_f32_16x16x32_bf16 v[80:83],v[132:135],a[188:191],0
s_add_u32 m0,s23,24576
v_accvgpr_read_b32 v84,a16
v_accvgpr_read_b32 v85,a17
v_mfma_f32_16x16x32_bf16 v[80:83],v[128:131],a[184:187],v[80:83]
v_accvgpr_read_b32 v210,a34
v_accvgpr_read_b32 v211,a35
v_mfma_f32_16x16x32_bf16 v[80:83],v[124:127],a[180:183],v[80:83]
buffer_store_dwordx4 v[96:99],v9,s[16:19],s87 offen offset:3328 nt
v_accvgpr_read_b32 v208,a32
v_accvgpr_read_b32 v209,a33
v_accvgpr_read_b32 v226,a22
v_pk_mul_f32 v[252:253],v[252:253],v[62:63] op_sel_hi:[1,0]
v_pk_mul_f32 v[254:255],v[254:255],v[62:63] op_sel_hi:[1,0]
v_pk_mul_f32 v[108:109],v[108:109],v[64:65] op_sel_hi:[1,0]
v_pk_mul_f32 v[110:111],v[110:111],v[64:65] op_sel_hi:[1,0]
v_accvgpr_read_b32 v227,a23
v_accvgpr_read_b32 v224,a20
v_mfma_f32_16x16x32_bf16 v[80:83],v[120:123],a[176:179],v[80:83]
s_waitcnt vmcnt(12)
buffer_load_dwordx4 v6,s[8:11],s21 offen offset:0 lds
v_mfma_f32_16x16x32_bf16 v[80:83],v[116:119],a[172:175],v[80:83]
ds_read_b128 a[216:219],v11 offset:0
v_accvgpr_read_b32 v225,a21
v_mfma_f32_16x16x32_bf16 v[80:83],v[112:115],a[168:171],v[80:83]
ds_read_b128 a[220:223],v12 offset:0
v_accvgpr_read_b32 v92,a36
ds_read_b128 a[224:227],v11 offset:128
v_pk_mul_f32 v[84:85],v[84:85],v[64:65] op_sel_hi:[1,0]
ds_read_b128 a[228:231],v12 offset:128
v_pk_mul_f32 v[86:87],v[86:87],v[64:65] op_sel_hi:[1,0]
ds_read_b128 a[232:235],v11 offset:256
v_pk_mul_f32 v[208:209],v[208:209],v[64:65] op_sel_hi:[1,0]
ds_read_b128 a[236:239],v12 offset:256
v_pk_mul_f32 v[210:211],v[210:211],v[64:65] op_sel_hi:[1,0]
v_accvgpr_read_b32 v93,a37
v_accvgpr_read_b32 v94,a38
v_mfma_f32_16x16x32_bf16 v[88:91],v[112:115],a[192:195],0
ds_read_b128 v[112:115],v0 offset:6272
v_accvgpr_read_b32 v95,a39
v_mfma_f32_16x16x32_bf16 v[88:91],v[116:119],a[196:199],v[88:91]
ds_read_b128 v[116:119],v1 offset:6272
v_cvt_pk_bf16_f32 v212,v212,v213
v_mfma_f32_16x16x32_bf16 v[88:91],v[120:123],a[200:203],v[88:91]
ds_read_b128 v[120:123],v0 offset:6400
v_cvt_pk_bf16_f32 v228,v228,v229
v_cvt_pk_bf16_f32 v216,v216,v217
v_cvt_pk_bf16_f32 v232,v232,v233
v_cvt_pk_bf16_f32 v213,v214,v215
buffer_load_dwordx4 v7,s[8:11],s21 offen offset:1024 lds
v_pk_mul_f32 v[224:225],v[224:225],v[64:65] op_sel_hi:[1,0]
v_pk_mul_f32 v[226:227],v[226:227],v[64:65] op_sel_hi:[1,0]
v_pk_mul_f32 v[92:93],v[92:93],v[64:65] op_sel_hi:[1,0]
v_pk_mul_f32 v[94:95],v[94:95],v[64:65] op_sel_hi:[1,0]
v_cvt_pk_bf16_f32 v229,v230,v231
v_cvt_pk_bf16_f32 v220,v220,v221
v_mfma_f32_16x16x32_bf16 v[88:91],v[124:127],a[204:207],v[88:91]
ds_write2st64_b64 v37,v[212:213],v[228:229] offset0:12 offset1:14
v_mfma_f32_16x16x32_bf16 v[88:91],v[128:131],a[208:211],v[88:91]
v_cvt_pk_bf16_f32 v236,v236,v237
v_cvt_pk_bf16_f32 v217,v218,v219
v_mfma_f32_16x16x32_bf16 v[88:91],v[132:135],a[212:215],v[88:91]
ds_read_b128 v[124:127],v1 offset:6400
v_cvt_pk_bf16_f32 v233,v234,v235
ds_read_b128 v[128:131],v0 offset:0
v_cvt_pk_bf16_f32 v240,v240,v241
ds_write2st64_b64 v38,v[216:217],v[232:233] offset0:12 offset1:14
v_cvt_pk_bf16_f32 v100,v100,v101
v_cvt_pk_bf16_f32 v221,v222,v223
v_cvt_pk_bf16_f32 v237,v238,v239
ds_read_b128 v[132:135],v1 offset:0
v_cvt_pk_bf16_f32 v244,v244,v245
v_cvt_pk_bf16_f32 v76,v76,v77
v_cvt_pk_bf16_f32 v241,v242,v243
v_cvt_pk_bf16_f32 v101,v102,v103
v_cvt_pk_bf16_f32 v245,v246,v247
ds_write2st64_b64 v39,v[220:221],v[236:237] offset0:12 offset1:14
v_cvt_pk_bf16_f32 v77,v78,v79
v_accvgpr_read_b32 v96,a24
v_accvgpr_read_b32 v97,a25
buffer_load_dwordx4 v8,s[8:11],s21 offen offset:2048 lds
v_accvgpr_read_b32 v98,a26
v_accvgpr_read_b32 v99,a27
v_accvgpr_read_b32 v214,a42
ds_write2st64_b64 v36,v[240:241],v[100:101] offset0:16 offset1:24
v_accvgpr_read_b32 v215,a43
v_accvgpr_read_b32 v212,a40
v_accvgpr_read_b32 v213,a41
v_accvgpr_read_b32 v230,a30
v_accvgpr_read_b32 v231,a31
v_accvgpr_read_b32 v228,a28
v_accvgpr_read_b32 v229,a29
v_accvgpr_read_b32 v218,a46
v_accvgpr_read_b32 v219,a47
v_accvgpr_read_b32 v216,a44
v_accvgpr_read_b32 v217,a45
ds_write2st64_b64 v37,v[244:245],v[76:77] offset0:16 offset1:24
v_mfma_f32_16x16x32_bf16 v[76:79],v[136:139],a[144:147],0
s_add_u32 s21,s21,12288
v_cvt_pk_bf16_f32 v248,v248,v249
v_cvt_pk_bf16_f32 v104,v104,v105
v_cvt_pk_bf16_f32 v252,v252,v253
v_cvt_pk_bf16_f32 v108,v108,v109
v_cvt_pk_bf16_f32 v249,v250,v251
v_pk_mul_f32 v[96:97],v[96:97],v[64:65] op_sel_hi:[1,0]
v_pk_mul_f32 v[98:99],v[98:99],v[64:65] op_sel_hi:[1,0]
v_pk_mul_f32 v[212:213],v[212:213],v[64:65] op_sel_hi:[1,0]
v_pk_mul_f32 v[214:215],v[214:215],v[64:65] op_sel_hi:[1,0]
v_cvt_pk_bf16_f32 v105,v106,v107
v_cvt_pk_bf16_f32 v84,v84,v85
v_mfma_f32_16x16x32_bf16 v[76:79],v[140:143],a[148:151],v[76:79]
s_mov_b32 s27,s42
ds_write2st64_b64 v38,v[248:249],v[104:105] offset0:16 offset1:24
s_waitcnt lgkmcnt(2)
v_mfma_f32_16x16x32_bf16 v[76:79],v[112:115],a[152:155],v[76:79]
s_mov_b32 s42,s41
v_cvt_pk_bf16_f32 v208,v208,v209
v_cvt_pk_bf16_f32 v253,v254,v255
v_mfma_f32_16x16x32_bf16 v[76:79],v[116:119],a[156:159],v[76:79]
s_add_u32 s69,s69,1
v_cvt_pk_bf16_f32 v109,v110,v111
v_cvt_pk_bf16_f32 v85,v86,v87
v_cvt_pk_bf16_f32 v209,v210,v211
v_cvt_pk_bf16_f32 v224,v224,v225
v_cvt_pk_bf16_f32 v92,v92,v93
ds_write2st64_b64 v39,v[252:253],v[108:109] offset0:16 offset1:24
v_pk_mul_f32 v[228:229],v[228:229],v[64:65] op_sel_hi:[1,0]
v_pk_mul_f32 v[230:231],v[230:231],v[64:65] op_sel_hi:[1,0]
v_pk_mul_f32 v[216:217],v[216:217],v[64:65] op_sel_hi:[1,0]
v_pk_mul_f32 v[218:219],v[218:219],v[64:65] op_sel_hi:[1,0]
v_cvt_pk_bf16_f32 v225,v226,v227
v_cvt_pk_bf16_f32 v93,v94,v95
v_mfma_f32_16x16x32_bf16 v[76:79],v[120:123],a[160:163],v[76:79]
s_lshl_b32 s62,s69,5
v_cvt_pk_bf16_f32 v96,v96,v97
v_cvt_pk_bf16_f32 v212,v212,v213
v_mfma_f32_16x16x32_bf16 v[76:79],v[124:127],a[164:167],v[76:79]
s_add_u32 s62,s62,s34
ds_write2st64_b64 v36,v[84:85],v[208:209] offset0:26 offset1:28
v_mfma_f32_16x16x32_bf16 v[84:87],v[124:127],a[188:191],0
s_mul_i32 s63,s62,171
v_cvt_pk_bf16_f32 v97,v98,v99
v_cvt_pk_bf16_f32 v213,v214,v215
v_max3_f32 v40,v72,v73,v74
v_max3_f32 v44,v80,v81,v82
v_max3_f32 v40,v40,v75,v76
v_pk_mul_f32 v[160:161],v[160:161],v[60:61] op_sel_hi:[1,0]
v_pk_mul_f32 v[162:163],v[162:163],v[60:61] op_sel_hi:[1,0]
v_pk_mul_f32 v[176:177],v[176:177],v[60:61] op_sel_hi:[1,0]
v_pk_mul_f32 v[178:179],v[178:179],v[60:61] op_sel_hi:[1,0]
v_max3_f32 v40,v40,v77,v78
v_max_f32 v40,v40,v79
v_mfma_f32_16x16x32_bf16 v[84:87],v[120:123],a[184:187],v[84:87]
s_lshr_b32 s63,s63,9
ds_write2st64_b64 v37,v[224:225],v[92:93] offset0:26 offset1:28
v_mfma_f32_16x16x32_bf16 v[84:87],v[116:119],a[180:183],v[84:87]
s_mul_i32 s64,s63,3
v_mov_b32 v41,v40
v_max3_f32 v48,v88,v89,v90
v_mfma_f32_16x16x32_bf16 v[84:87],v[112:115],a[176:179],v[84:87]
s_sub_u32 s62,s62,s64
v_permlane32_swap_b32 v41,v40
v_max_f32 v40,v40,v41
v_mov_b32 v41,v40
v_cvt_pk_bf16_f32 v228,v228,v229
ds_write2st64_b64 v38,v[96:97],v[212:213] offset0:26 offset1:28
v_pk_mul_f32 v[164:165],v[164:165],v[60:61] op_sel_hi:[1,0]
v_pk_mul_f32 v[166:167],v[166:167],v[60:61] op_sel_hi:[1,0]
v_pk_mul_f32 v[180:181],v[180:181],v[60:61] op_sel_hi:[1,0]
v_pk_mul_f32 v[182:183],v[182:183],v[60:61] op_sel_hi:[1,0]
v_permlane16_swap_b32 v41,v40
v_max_f32 v40,v40,v41
v_mfma_f32_16x16x32_bf16 v[84:87],v[140:143],a[172:175],v[84:87]
s_add_u32 s63,s63,s33
v_mul_f32_e64 v13,-s36,v40
v_fma_f32 v72,v72,s36,v13
v_mfma_f32_16x16x32_bf16 v[84:87],v[136:139],a[168:171],v[84:87]
s_mul_i32 s30,s63,196608
v_fma_f32 v73,v73,s36,v13
v_fma_f32 v74,v74,s36,v13
v_mfma_f32_16x16x32_bf16 v[92:95],v[136:139],a[192:195],0
s_mul_i32 s41,s63,325632
ds_read_b128 v[136:139],v0 offset:128
v_fma_f32 v75,v75,s36,v13
v_mfma_f32_16x16x32_bf16 v[92:95],v[140:143],a[196:199],v[92:95]
s_lshl_b32 s63,s3,2
ds_read_b128 v[140:143],v1 offset:128
v_exp_f32 v72,v72
v_exp_f32 v73,v73
v_pk_mul_f32 v[168:169],v[168:169],v[60:61] op_sel_hi:[1,0]
v_pk_mul_f32 v[170:171],v[170:171],v[60:61] op_sel_hi:[1,0]
v_pk_mul_f32 v[184:185],v[184:185],v[60:61] op_sel_hi:[1,0]
v_pk_mul_f32 v[186:187],v[186:187],v[60:61] op_sel_hi:[1,0]
v_exp_f32 v74,v74
v_exp_f32 v75,v75
v_mfma_f32_16x16x32_bf16 v[92:95],v[112:115],a[200:203],v[92:95]
s_add_u32 s64,s63,21
ds_read_b128 v[112:115],v0 offset:256
v_cvt_pk_bf16_f32 v20,v72,v73
v_mfma_f32_16x16x32_bf16 v[92:95],v[116:119],a[204:207],v[92:95]
s_cmp_eq_u32 s3,0
ds_read_b128 v[116:119],v1 offset:256
v_cvt_pk_bf16_f32 v21,v74,v75
v_mfma_f32_16x16x32_bf16 v[92:95],v[120:123],a[208:211],v[92:95]
s_cselect_b32 s64,20,s64
ds_read_b128 v[120:123],v0 offset:6144
v_max3_f32 v44,v44,v83,v84
v_max3_f32 v44,v44,v85,v86
v_max_f32 v44,v44,v87
v_mov_b32 v45,v44
v_pk_mul_f32 v[172:173],v[172:173],v[60:61] op_sel_hi:[1,0]
v_pk_mul_f32 v[174:175],v[174:175],v[60:61] op_sel_hi:[1,0]
v_pk_mul_f32 v[188:189],v[188:189],v[60:61] op_sel_hi:[1,0]
v_pk_mul_f32 v[190:191],v[190:191],v[60:61] op_sel_hi:[1,0]
v_permlane32_swap_b32 v45,v44
v_max_f32 v44,v44,v45
v_mfma_f32_16x16x32_bf16 v[92:95],v[124:127],a[212:215],v[92:95]
s_cselect_b32 s40,1,0
ds_read_b128 v[124:127],v1 offset:6144
v_mov_b32 v45,v44
v_mfma_f32_16x16x32_bf16 v[96:99],v[128:131],a[216:219],0
s_add_u32 s65,s63,37
ds_read_b128 v[128:131],v0 offset:6272
v_permlane16_swap_b32 v45,v44
v_mfma_f32_16x16x32_bf16 v[96:99],v[132:135],a[220:223],v[96:99]
s_cmp_eq_u32 s62,2
ds_read_b128 v[132:135],v1 offset:6272
v_max_f32 v44,v44,v45
v_mul_f32_e64 v14,-s36,v44
v_fma_f32 v80,v80,s36,v14
v_fma_f32 v81,v81,s36,v14
v_pk_mul_f32 v[192:193],v[192:193],v[60:61] op_sel_hi:[1,0]
v_pk_mul_f32 v[194:195],v[194:195],v[60:61] op_sel_hi:[1,0]
v_fma_f32 v82,v82,s36,v14
v_fma_f32 v83,v83,s36,v14
s_waitcnt lgkmcnt(4)
v_mfma_f32_16x16x32_bf16 v[96:99],v[136:139],a[224:227],v[96:99]
s_cselect_b32 s64,s65,s64
ds_read_b128 v[136:139],v0 offset:6400
v_exp_f32 v80,v80
v_mfma_f32_16x16x32_bf16 v[96:99],v[140:143],a[228:231],v[96:99]
s_cselect_b32 s40,0,s40
ds_read_b128 v[140:143],v1 offset:6400
v_exp_f32 v81,v81
v_mfma_f32_16x16x32_bf16 v[96:99],v[112:115],a[232:235],v[96:99]
s_add_u32 s65,s63,s3
ds_read_b128 v[112:115],v0 offset:12544
v_exp_f32 v82,v82
v_exp_f32 v83,v83
v_pk_mul_f32 v[196:197],v[196:197],v[60:61] op_sel_hi:[1,0]
v_pk_mul_f32 v[198:199],v[198:199],v[60:61] op_sel_hi:[1,0]
v_cvt_pk_bf16_f32 v24,v80,v81
v_cvt_pk_bf16_f32 v25,v82,v83
v_mfma_f32_16x16x32_bf16 v[96:99],v[116:119],a[236:239],v[96:99]
s_cmp_eq_u32 s62,0
ds_read_b128 v[116:119],v1 offset:12544
v_max3_f32 v48,v48,v91,v92
s_waitcnt lgkmcnt(4)
v_mfma_f32_16x16x32_bf16 v[100:103],v[120:123],a[216:219],0
s_cselect_b32 s64,s65,s64
ds_read_b128 v[120:123],v0 offset:18432
v_max3_f32 v48,v48,v93,v94
v_mfma_f32_16x16x32_bf16 v[100:103],v[124:127],a[220:223],v[100:103]
s_cselect_b32 s40,1,s40
ds_read_b128 v[124:127],v1 offset:18432
v_max_f32 v48,v48,v95
v_mfma_f32_16x16x32_bf16 v[100:103],v[128:131],a[224:227],v[100:103]
s_mul_i32 s64,s64,6144
ds_read_b128 v[128:131],v0 offset:12288
v_mov_b32 v49,v48
v_max3_f32 v52,v96,v97,v98
v_fma_f32 v76,v76,s36,v13
v_permlane32_swap_b32 v49,v48
v_pk_mul_f32 v[200:201],v[200:201],v[60:61] op_sel_hi:[1,0]
v_pk_mul_f32 v[202:203],v[202:203],v[60:61] op_sel_hi:[1,0]
v_max_f32 v48,v48,v49
v_mov_b32 v49,v48
v_mfma_f32_16x16x32_bf16 v[100:103],v[132:135],a[228:231],v[100:103]
s_add_u32 s41,s41,s64
ds_read_b128 v[132:135],v1 offset:12288
v_permlane16_swap_b32 v49,v48
s_waitcnt lgkmcnt(5)
v_mfma_f32_16x16x32_bf16 v[100:103],v[136:139],a[232:235],v[100:103]
s_cmp_ge_u32 s69,6
ds_read_b128 v[136:139],v0 offset:12416
v_max_f32 v48,v48,v49
v_mfma_f32_16x16x32_bf16 v[100:103],v[140:143],a[236:239],v[100:103]
s_cselect_b32 s41,166723584,s41
ds_read_b128 v[140:143],v1 offset:12416
v_mul_f32_e64 v15,-s36,v48
v_fma_f32 v88,v88,s36,v15
v_fma_f32 v89,v89,s36,v15
v_fma_f32 v90,v90,s36,v15
v_pk_mul_f32 v[204:205],v[204:205],v[60:61] op_sel_hi:[1,0]
v_pk_mul_f32 v[206:207],v[206:207],v[60:61] op_sel_hi:[1,0]
v_fma_f32 v91,v91,s36,v15
v_exp_f32 v88,v88
s_waitcnt lgkmcnt(4)
v_mfma_f32_16x16x32_bf16 v[72:75],v[116:119],a[164:167],0
s_cselect_b32 s30,100663296,s30
v_exp_f32 v89,v89
v_mfma_f32_16x16x32_bf16 v[72:75],v[112:115],a[160:163],v[72:75]
s_add_u32 s25,s30,s22
v_exp_f32 v90,v90
v_exp_f32 v91,v91
v_cvt_pk_bf16_f32 v28,v88,v89
v_cvt_pk_bf16_f32 v29,v90,v91
v_max3_f32 v52,v52,v99,v100
v_max3_f32 v52,v52,v101,v102
v_max_f32 v52,v52,v103
v_mov_b32 v53,v52
v_fma_f32 v77,v77,s36,v13
v_fma_f32 v78,v78,s36,v13
v_permlane32_swap_b32 v53,v52
v_max_f32 v52,v52,v53
v_mov_b32 v53,v52
v_fma_f32 v79,v79,s36,v13
v_exp_f32 v76,v76
s_waitcnt lgkmcnt(0)
v_mfma_f32_16x16x32_bf16 v[72:75],v[140:143],a[156:159],v[72:75]
s_add_u32 s26,s25,12288
v_permlane16_swap_b32 v53,v52
v_mfma_f32_16x16x32_bf16 v[72:75],v[136:139],a[152:155],v[72:75]
s_add_u32 m0,s22,0
v_max_f32 v52,v52,v53
v_mul_f32_e64 v16,-s36,v52
v_mfma_f32_16x16x32_bf16 v[72:75],v[132:135],a[148:151],v[72:75]
s_mov_b32 s28,s41
v_fma_f32 v96,v96,s36,v16
v_fma_f32 v97,v97,s36,v16
v_mfma_f32_16x16x32_bf16 v[72:75],v[128:131],a[144:147],v[72:75]
s_mov_b32 s29,s24
v_fma_f32 v98,v98,s36,v16
v_fma_f32 v99,v99,s36,v16
v_mfma_f32_16x16x32_bf16 v[80:83],v[128:131],a[168:171],0
v_exp_f32 v96,v96
v_mfma_f32_16x16x32_bf16 v[80:83],v[132:135],a[172:175],v[80:83]
v_exp_f32 v97,v97
v_mfma_f32_16x16x32_bf16 v[80:83],v[136:139],a[176:179],v[80:83]
v_exp_f32 v98,v98
v_mfma_f32_16x16x32_bf16 v[80:83],v[140:143],a[180:183],v[80:83]
v_exp_f32 v99,v99
v_mfma_f32_16x16x32_bf16 v[80:83],v[112:115],a[184:187],v[80:83]
v_cvt_pk_bf16_f32 v32,v96,v97
v_cvt_pk_bf16_f32 v33,v98,v99
v_mfma_f32_16x16x32_bf16 v[80:83],v[116:119],a[188:191],v[80:83]
v_exp_f32 v77,v77
v_mfma_f32_16x16x32_bf16 v[88:91],v[116:119],a[212:215],0
v_exp_f32 v78,v78
v_mfma_f32_16x16x32_bf16 v[88:91],v[112:115],a[208:211],v[88:91]
v_exp_f32 v79,v79
v_mfma_f32_16x16x32_bf16 v[88:91],v[140:143],a[204:207],v[88:91]
v_cvt_pk_bf16_f32 v22,v76,v77
v_cvt_pk_bf16_f32 v23,v78,v79
v_mfma_f32_16x16x32_bf16 v[88:91],v[136:139],a[200:203],v[88:91]
v_fma_f32 v84,v84,s36,v14
v_fma_f32 v85,v85,s36,v14
v_mfma_f32_16x16x32_bf16 v[88:91],v[132:135],a[196:199],v[88:91]
v_fma_f32 v86,v86,s36,v14
v_fma_f32 v87,v87,s36,v14
v_mfma_f32_16x16x32_bf16 v[88:91],v[128:131],a[192:195],v[88:91]
v_exp_f32 v84,v84
v_mfma_f32_16x16x32_bf16 v[96:99],v[128:131],a[216:219],0
ds_read_b128 v[128:131],v0 offset:18560
v_exp_f32 v85,v85
v_mfma_f32_16x16x32_bf16 v[96:99],v[132:135],a[220:223],v[96:99]
ds_read_b128 v[132:135],v1 offset:18560
v_exp_f32 v86,v86
v_mfma_f32_16x16x32_bf16 v[96:99],v[136:139],a[224:227],v[96:99]
ds_read_b128 v[136:139],v0 offset:18688
v_exp_f32 v87,v87
v_mfma_f32_16x16x32_bf16 v[96:99],v[140:143],a[228:231],v[96:99]
ds_read_b128 v[140:143],v1 offset:18688
v_cvt_pk_bf16_f32 v26,v84,v85
v_mfma_f32_16x16x32_bf16 v[96:99],v[112:115],a[232:235],v[96:99]
v_cvt_pk_bf16_f32 v27,v86,v87
v_fma_f32 v92,v92,s36,v15
v_mfma_f32_16x16x32_bf16 v[96:99],v[116:119],a[236:239],v[96:99]
v_fma_f32 v93,v93,s36,v15
v_fma_f32 v94,v94,s36,v15
v_mfma_f32_16x16x32_bf16 v[76:79],v[120:123],a[144:147],0
v_fma_f32 v95,v95,s36,v15
v_exp_f32 v92,v92
v_mfma_f32_16x16x32_bf16 v[76:79],v[124:127],a[148:151],v[76:79]
s_waitcnt lgkmcnt(3)
v_exp_f32 v93,v93
v_exp_f32 v94,v94
v_mfma_f32_16x16x32_bf16 v[76:79],v[128:131],a[152:155],v[76:79]
s_waitcnt lgkmcnt(2)
v_exp_f32 v95,v95
v_mfma_f32_16x16x32_bf16 v[76:79],v[132:135],a[156:159],v[76:79]
s_waitcnt lgkmcnt(1)
v_cvt_pk_bf16_f32 v30,v92,v93
v_cvt_pk_bf16_f32 v31,v94,v95
v_fma_f32 v100,v100,s36,v16
v_mfma_f32_16x16x32_bf16 v[76:79],v[136:139],a[160:163],v[76:79]
v_fma_f32 v101,v101,s36,v16
s_waitcnt vmcnt(5)
s_barrier
s_waitcnt lgkmcnt(0)
v_mfma_f32_16x16x32_bf16 v[76:79],v[140:143],a[164:167],v[76:79]
buffer_load_dwordx4 v6,s[4:7],s20 offen offset:0 lds
v_mfma_f32_16x16x32_bf16 v[84:87],v[140:143],a[188:191],0
v_fma_f32 v102,v102,s36,v16
v_fma_f32 v103,v103,s36,v16
v_mfma_f32_16x16x32_bf16 v[84:87],v[136:139],a[184:187],v[84:87]
v_exp_f32 v100,v100
v_mfma_f32_16x16x32_bf16 v[84:87],v[132:135],a[180:183],v[84:87]
v_exp_f32 v101,v101
v_mfma_f32_16x16x32_bf16 v[84:87],v[128:131],a[176:179],v[84:87]
v_exp_f32 v102,v102
v_mfma_f32_16x16x32_bf16 v[84:87],v[124:127],a[172:175],v[84:87]
v_exp_f32 v103,v103
v_mfma_f32_16x16x32_bf16 v[84:87],v[120:123],a[168:171],v[84:87]
buffer_load_dwordx4 v7,s[4:7],s20 offen offset:1024 lds
v_mfma_f32_16x16x32_bf16 v[92:95],v[120:123],a[192:195],0
v_cvt_pk_bf16_f32 v34,v100,v101
v_cvt_pk_bf16_f32 v35,v102,v103
v_mfma_f32_16x16x32_bf16 v[92:95],v[124:127],a[196:199],v[92:95]
v_cvt_pk_bf16_f32 v216,v216,v217
v_cvt_pk_bf16_f32 v160,v160,v161
v_mfma_f32_16x16x32_bf16 v[92:95],v[128:131],a[200:203],v[92:95]
v_cvt_pk_bf16_f32 v176,v176,v177
v_cvt_pk_bf16_f32 v229,v230,v231
v_mfma_f32_16x16x32_bf16 v[92:95],v[132:135],a[204:207],v[92:95]
ds_read_b64_tr_b16 v[112:113],v2 offset:0
v_cvt_pk_bf16_f32 v217,v218,v219
v_mfma_f32_16x16x32_bf16 v[92:95],v[136:139],a[208:211],v[92:95]
ds_write2st64_b64 v39,v[228:229],v[216:217] offset0:26 offset1:28
v_mfma_f32_16x16x32_bf16 v[92:95],v[140:143],a[212:215],v[92:95]
v_cvt_pk_bf16_f32 v164,v164,v165
v_cvt_pk_bf16_f32 v180,v180,v181
v_mfma_f32_16x16x32_bf16 v[100:103],v[140:143],a[236:239],0
buffer_load_dwordx4 v8,s[4:7],s20 offen offset:2048 lds
v_mfma_f32_16x16x32_bf16 v[100:103],v[136:139],a[232:235],v[100:103]
s_add_u32 s20,s20,12288
ds_read_b64_tr_b16 v[114:115],v2 offset:6144
v_cvt_pk_bf16_f32 v161,v162,v163
v_mfma_f32_16x16x32_bf16 v[100:103],v[132:135],a[228:231],v[100:103]
ds_read_b64_tr_b16 v[116:117],v3 offset:0
v_cvt_pk_bf16_f32 v177,v178,v179
v_mfma_f32_16x16x32_bf16 v[100:103],v[128:131],a[224:227],v[100:103]
ds_write2st64_b64 v36,v[160:161],v[176:177] offset0:0 offset1:2
v_mfma_f32_16x16x32_bf16 v[100:103],v[124:127],a[220:223],v[100:103]
v_cvt_pk_bf16_f32 v168,v168,v169
ds_read_b64_tr_b16 v[118:119],v3 offset:6144
v_mfma_f32_16x16x32_bf16 v[100:103],v[120:123],a[216:219],v[100:103]
ds_read_b64_tr_b16 v[120:121],v4 offset:0
ds_read_b64_tr_b16 v[122:123],v4 offset:6144
ds_read_b64_tr_b16 v[124:125],v5 offset:0
ds_read_b64_tr_b16 v[126:127],v5 offset:6144
v_cvt_pk_bf16_f32 v184,v184,v185
v_cvt_pk_bf16_f32 v165,v166,v167
v_cvt_pk_bf16_f32 v181,v182,v183
ds_write2st64_b64 v37,v[164:165],v[180:181] offset0:0 offset1:2
v_mov_b32 v66,0
v_mov_b32 v67,0
v_mov_b32 v62,0
v_mov_b32 v63,0
v_mov_b32 v64,0
v_mov_b32 v65,0
v_cvt_pk_bf16_f32 v172,v172,v173
v_cvt_pk_bf16_f32 v188,v188,v189
v_smfmac_f32_16x16x64_bf16 v[64:67],v[152:155],v[28:35],v18
v_mov_b32 v60,0
v_mov_b32 v61,0
v_cvt_pk_bf16_f32 v169,v170,v171
v_cvt_pk_bf16_f32 v185,v186,v187
v_smfmac_f32_16x16x64_bf16 v[60:63],v[152:155],v[20:27],v18
ds_write2st64_b64 v38,v[168:169],v[184:185] offset0:0 offset1:2
v_cvt_pk_bf16_f32 v192,v192,v193
v_cvt_pk_bf16_f32 v173,v174,v175
v_cvt_pk_bf16_f32 v189,v190,v191
v_cvt_pk_bf16_f32 v196,v196,v197
v_fma_f32 v72,v72,s36,v13
v_fma_f32 v73,v73,s36,v13
v_fma_f32 v74,v74,s36,v13
v_fma_f32 v75,v75,s36,v13
v_fma_f32 v80,v80,s36,v14
v_fma_f32 v81,v81,s36,v14
v_cvt_pk_bf16_f32 v193,v194,v195
ds_write2st64_b64 v39,v[172:173],v[188:189] offset0:0 offset1:2
v_cvt_pk_bf16_f32 v200,v200,v201
v_cvt_pk_bf16_f32 v197,v198,v199
v_exp_f32 v72,v72
v_exp_f32 v73,v73
v_exp_f32 v74,v74
v_exp_f32 v75,v75
v_exp_f32 v80,v80
ds_write_b64 v36,v[192:193] offset:2048
v_exp_f32 v81,v81
v_cvt_pk_bf16_f32 v204,v204,v205
v_cvt_pk_bf16_f32 v201,v202,v203
ds_write_b64 v37,v[196:197] offset:2048
v_cvt_pk_bf16_f32 v205,v206,v207
v_cvt_pk_bf16_f32 v40,v72,v73
v_cvt_pk_bf16_f32 v41,v74,v75
v_cvt_pk_bf16_f32 v44,v80,v81
ds_write_b64 v38,v[200:201] offset:2048
ds_write_b64 v39,v[204:205] offset:2048
s_waitcnt lgkmcnt(4)
v_mfma_f32_16x16x32_bf16 v[160:163],v[112:115],v[20:23],0
s_add_u32 m0,s23,0
ds_read_b64_tr_b16 v[128:129],v2 offset:128
v_fma_f32 v82,v82,s36,v14
v_mfma_f32_16x16x32_bf16 v[164:167],v[116:119],v[20:23],0
ds_read_b64_tr_b16 v[130:131],v2 offset:6272
v_fma_f32 v83,v83,s36,v14
v_mfma_f32_16x16x32_bf16 v[212:215],v[116:119],v[24:27],0
ds_read_b64_tr_b16 v[132:133],v3 offset:128
v_fma_f32 v88,v88,s36,v15
v_mfma_f32_16x16x32_bf16 v[208:211],v[112:115],v[24:27],0
ds_read_b64_tr_b16 v[134:135],v3 offset:6272
v_fma_f32 v89,v89,s36,v15
v_mfma_f32_16x16x32_bf16 a[0:3],v[112:115],v[28:31],0
ds_read_b64_tr_b16 v[136:137],v4 offset:128
v_fma_f32 v90,v90,s36,v15
v_mfma_f32_16x16x32_bf16 a[4:7],v[116:119],v[28:31],0
ds_read_b64_tr_b16 v[138:139],v4 offset:6272
v_fma_f32 v91,v91,s36,v15
v_mfma_f32_16x16x32_bf16 a[52:55],v[116:119],v[32:35],0
ds_read_b64_tr_b16 v[140:141],v5 offset:128
v_fma_f32 v96,v96,s36,v16
v_mfma_f32_16x16x32_bf16 a[48:51],v[112:115],v[32:35],0
ds_read_b64_tr_b16 v[142:143],v5 offset:6272
v_fma_f32 v97,v97,s36,v16
v_mfma_f32_16x16x32_bf16 a[56:59],v[120:123],v[32:35],0
ds_read_b64_tr_b16 v[112:113],v2 offset:256
v_fma_f32 v98,v98,s36,v16
v_mfma_f32_16x16x32_bf16 a[60:63],v[124:127],v[32:35],0
ds_read_b64_tr_b16 v[114:115],v2 offset:6400
v_fma_f32 v99,v99,s36,v16
v_mfma_f32_16x16x32_bf16 a[12:15],v[124:127],v[28:31],0
ds_read_b64_tr_b16 v[116:117],v3 offset:256
v_fma_f32 v76,v76,s36,v13
v_mfma_f32_16x16x32_bf16 a[8:11],v[120:123],v[28:31],0
ds_read_b64_tr_b16 v[118:119],v3 offset:6400
v_fma_f32 v77,v77,s36,v13
v_mfma_f32_16x16x32_bf16 v[216:219],v[120:123],v[24:27],0
v_exp_f32 v82,v82
v_mfma_f32_16x16x32_bf16 v[220:223],v[124:127],v[24:27],0
v_exp_f32 v83,v83
v_mfma_f32_16x16x32_bf16 v[172:175],v[124:127],v[20:23],0
ds_read_b64_tr_b16 v[124:125],v5 offset:256
v_cvt_pk_bf16_f32 v45,v82,v83
v_mfma_f32_16x16x32_bf16 v[168:171],v[120:123],v[20:23],0
s_waitcnt lgkmcnt(6)
ds_read_b64_tr_b16 v[120:121],v4 offset:256
v_fma_f32 v78,v78,s36,v13
v_mfma_f32_16x16x32_bf16 v[176:179],v[128:131],v[20:23],0
ds_read_b64_tr_b16 v[122:123],v4 offset:6400
v_fma_f32 v79,v79,s36,v13
v_mfma_f32_16x16x32_bf16 v[180:183],v[132:135],v[20:23],0
ds_read_b64_tr_b16 v[126:127],v5 offset:6400
v_fma_f32 v84,v84,s36,v14
v_mfma_f32_16x16x32_bf16 v[228:231],v[132:135],v[24:27],0
v_exp_f32 v88,v88
v_mfma_f32_16x16x32_bf16 v[224:227],v[128:131],v[24:27],0
v_exp_f32 v89,v89
v_mfma_f32_16x16x32_bf16 a[16:19],v[128:131],v[28:31],0
v_exp_f32 v90,v90
v_mfma_f32_16x16x32_bf16 a[20:23],v[132:135],v[28:31],0
v_exp_f32 v91,v91
v_mfma_f32_16x16x32_bf16 a[68:71],v[132:135],v[32:35],0
v_cvt_pk_bf16_f32 v48,v88,v89
v_cvt_pk_bf16_f32 v49,v90,v91
v_mfma_f32_16x16x32_bf16 a[64:67],v[128:131],v[32:35],0
v_exp_f32 v96,v96
v_mfma_f32_16x16x32_bf16 a[72:75],v[136:139],v[32:35],0
s_waitcnt lgkmcnt(2)
v_exp_f32 v97,v97
v_mfma_f32_16x16x32_bf16 a[76:79],v[140:143],v[32:35],0
v_exp_f32 v98,v98
v_mfma_f32_16x16x32_bf16 a[28:31],v[140:143],v[28:31],0
v_exp_f32 v99,v99
v_mfma_f32_16x16x32_bf16 a[24:27],v[136:139],v[28:31],0
v_cvt_pk_bf16_f32 v52,v96,v97
v_cvt_pk_bf16_f32 v53,v98,v99
v_mfma_f32_16x16x32_bf16 v[232:235],v[136:139],v[24:27],0
v_exp_f32 v76,v76
v_mfma_f32_16x16x32_bf16 v[236:239],v[140:143],v[24:27],0
v_exp_f32 v77,v77
v_mfma_f32_16x16x32_bf16 v[188:191],v[140:143],v[20:23],0
v_exp_f32 v78,v78
v_mfma_f32_16x16x32_bf16 v[184:187],v[136:139],v[20:23],0
v_exp_f32 v79,v79
v_mfma_f32_16x16x32_bf16 v[192:195],v[112:115],v[20:23],0
v_cvt_pk_bf16_f32 v42,v76,v77
v_cvt_pk_bf16_f32 v43,v78,v79
s_waitcnt vmcnt(24) lgkmcnt(0)
v_mfma_f32_16x16x32_bf16 v[196:199],v[116:119],v[20:23],0
s_barrier
v_mfma_f32_16x16x32_bf16 v[244:247],v[116:119],v[24:27],0
ds_read_b128 v[140:143],v1 offset:24704
v_fma_f32 v85,v85,s36,v14
v_mfma_f32_16x16x32_bf16 v[240:243],v[112:115],v[24:27],0
ds_read_b128 v[136:139],v0 offset:24704
v_fma_f32 v86,v86,s36,v14
v_mfma_f32_16x16x32_bf16 a[32:35],v[112:115],v[28:31],0
ds_read_b128 v[132:135],v1 offset:24576
v_fma_f32 v87,v87,s36,v14
v_mfma_f32_16x16x32_bf16 a[36:39],v[116:119],v[28:31],0
ds_read_b128 v[128:131],v0 offset:24576
v_fma_f32 v92,v92,s36,v15
v_mfma_f32_16x16x32_bf16 a[84:87],v[116:119],v[32:35],0
ds_read_b128 v[116:119],v1 offset:24832
v_fma_f32 v93,v93,s36,v15
v_mfma_f32_16x16x32_bf16 a[80:83],v[112:115],v[32:35],0
buffer_load_dwordx4 v6,s[8:11],s21 offen offset:0 lds
v_mfma_f32_16x16x32_bf16 a[88:91],v[120:123],v[32:35],0
ds_read_b128 v[112:115],v0 offset:24832
v_fma_f32 v94,v94,s36,v15
v_mfma_f32_16x16x32_bf16 a[92:95],v[124:127],v[32:35],0
v_exp_f32 v84,v84
v_mfma_f32_16x16x32_bf16 a[44:47],v[124:127],v[28:31],0
v_exp_f32 v85,v85
v_mfma_f32_16x16x32_bf16 a[40:43],v[120:123],v[28:31],0
v_exp_f32 v86,v86
v_mfma_f32_16x16x32_bf16 v[248:251],v[120:123],v[24:27],0
v_exp_f32 v87,v87
v_mfma_f32_16x16x32_bf16 v[252:255],v[124:127],v[24:27],0
v_cvt_pk_bf16_f32 v46,v84,v85
v_cvt_pk_bf16_f32 v47,v86,v87
v_mfma_f32_16x16x32_bf16 v[204:207],v[124:127],v[20:23],0
ds_read_b128 v[124:127],v1 offset:30720
v_fma_f32 v95,v95,s36,v15
v_smfmac_f32_16x16x64_bf16 v[60:63],v[152:155],v[40:47],v18
v_fma_f32 v100,v100,s36,v16
v_mfma_f32_16x16x32_bf16 v[200:203],v[120:123],v[20:23],0
buffer_load_dwordx4 v7,s[8:11],s21 offen offset:1024 lds
s_waitcnt lgkmcnt(1)
v_mfma_f32_16x16x32_bf16 v[72:75],v[116:119],a[164:167],0
ds_read_b128 v[120:123],v0 offset:30720
v_fma_f32 v101,v101,s36,v16
v_mfma_f32_16x16x32_bf16 v[72:75],v[112:115],a[160:163],v[72:75]
v_exp_f32 v92,v92
v_mfma_f32_16x16x32_bf16 v[72:75],v[140:143],a[156:159],v[72:75]
v_exp_f32 v93,v93
v_mfma_f32_16x16x32_bf16 v[72:75],v[136:139],a[152:155],v[72:75]
v_exp_f32 v94,v94
v_mfma_f32_16x16x32_bf16 v[72:75],v[132:135],a[148:151],v[72:75]
v_exp_f32 v95,v95
v_mfma_f32_16x16x32_bf16 v[72:75],v[128:131],a[144:147],v[72:75]
v_cvt_pk_bf16_f32 v50,v92,v93
v_cvt_pk_bf16_f32 v51,v94,v95
v_mfma_f32_16x16x32_bf16 v[80:83],v[128:131],a[168:171],0
v_fma_f32 v102,v102,s36,v16
v_fma_f32 v103,v103,s36,v16
v_mfma_f32_16x16x32_bf16 v[80:83],v[132:135],a[172:175],v[80:83]
v_exp_f32 v100,v100
v_mfma_f32_16x16x32_bf16 v[80:83],v[136:139],a[176:179],v[80:83]
buffer_load_dwordx4 v8,s[8:11],s21 offen offset:2048 lds
v_mfma_f32_16x16x32_bf16 v[80:83],v[140:143],a[180:183],v[80:83]
s_add_u32 s21,s21,12288
v_exp_f32 v101,v101
v_mfma_f32_16x16x32_bf16 v[80:83],v[112:115],a[184:187],v[80:83]
s_add_u32 m0,s22,12288
v_exp_f32 v102,v102
v_mfma_f32_16x16x32_bf16 v[80:83],v[116:119],a[188:191],v[80:83]
v_exp_f32 v103,v103
v_mfma_f32_16x16x32_bf16 v[88:91],v[116:119],a[212:215],0
v_cvt_pk_bf16_f32 v54,v100,v101
v_cvt_pk_bf16_f32 v55,v102,v103
v_mfma_f32_16x16x32_bf16 v[88:91],v[112:115],a[208:211],v[88:91]
v_fma_f32 v72,v72,s36,v13
v_fma_f32 v73,v73,s36,v13
v_smfmac_f32_16x16x64_bf16 v[64:67],v[152:155],v[48:55],v18
v_fma_f32 v74,v74,s36,v13
v_mfma_f32_16x16x32_bf16 v[88:91],v[140:143],a[204:207],v[88:91]
v_fma_f32 v75,v75,s36,v13
v_fma_f32 v80,v80,s36,v14
v_mfma_f32_16x16x32_bf16 v[88:91],v[136:139],a[200:203],v[88:91]
v_fma_f32 v81,v81,s36,v14
v_mfma_f32_16x16x32_bf16 v[88:91],v[132:135],a[196:199],v[88:91]
buffer_load_dwordx4 v6,s[4:7],s20 offen offset:0 lds
v_mfma_f32_16x16x32_bf16 v[88:91],v[128:131],a[192:195],v[88:91]
v_exp_f32 v72,v72
v_mfma_f32_16x16x32_bf16 v[96:99],v[128:131],a[216:219],0
ds_read_b128 v[128:131],v0 offset:30848
v_mfma_f32_16x16x32_bf16 v[96:99],v[132:135],a[220:223],v[96:99]
ds_read_b128 v[132:135],v1 offset:30848
v_mfma_f32_16x16x32_bf16 v[96:99],v[136:139],a[224:227],v[96:99]
ds_read_b128 v[136:139],v0 offset:30976
v_mfma_f32_16x16x32_bf16 v[96:99],v[140:143],a[228:231],v[96:99]
ds_read_b128 v[140:143],v1 offset:30976
v_mfma_f32_16x16x32_bf16 v[96:99],v[112:115],a[232:235],v[96:99]
v_exp_f32 v73,v73
v_mfma_f32_16x16x32_bf16 v[96:99],v[116:119],a[236:239],v[96:99]
s_waitcnt lgkmcnt(4)
v_exp_f32 v74,v74
v_mfma_f32_16x16x32_bf16 v[76:79],v[120:123],a[144:147],0
v_exp_f32 v75,v75
v_mfma_f32_16x16x32_bf16 v[76:79],v[124:127],a[148:151],v[76:79]
buffer_load_dwordx4 v7,s[4:7],s20 offen offset:1024 lds
v_exp_f32 v80,v80
v_exp_f32 v81,v81
s_waitcnt lgkmcnt(3)
v_mfma_f32_16x16x32_bf16 v[76:79],v[128:131],a[152:155],v[76:79]
s_waitcnt lgkmcnt(2)
v_cvt_pk_bf16_f32 v20,v72,v73
v_cvt_pk_bf16_f32 v21,v74,v75
v_mfma_f32_16x16x32_bf16 v[76:79],v[132:135],a[156:159],v[76:79]
s_waitcnt lgkmcnt(1)
v_cvt_pk_bf16_f32 v24,v80,v81
v_mfma_f32_16x16x32_bf16 v[76:79],v[136:139],a[160:163],v[76:79]
s_waitcnt lgkmcnt(0)
v_mfma_f32_16x16x32_bf16 v[76:79],v[140:143],a[164:167],v[76:79]
v_mfma_f32_16x16x32_bf16 v[84:87],v[140:143],a[188:191],0
v_mfma_f32_16x16x32_bf16 v[84:87],v[136:139],a[184:187],v[84:87]
v_mfma_f32_16x16x32_bf16 v[84:87],v[132:135],a[180:183],v[84:87]
v_mfma_f32_16x16x32_bf16 v[84:87],v[128:131],a[176:179],v[84:87]
buffer_load_dwordx4 v8,s[4:7],s20 offen offset:2048 lds
v_mfma_f32_16x16x32_bf16 v[84:87],v[124:127],a[172:175],v[84:87]
s_add_u32 s20,s20,12288
ds_read_b64_tr_b16 v[112:113],v2 offset:12288
v_mfma_f32_16x16x32_bf16 v[84:87],v[120:123],a[168:171],v[84:87]
ds_read_b64_tr_b16 v[114:115],v2 offset:18432
v_mfma_f32_16x16x32_bf16 v[92:95],v[120:123],a[192:195],0
ds_read_b64_tr_b16 v[116:117],v3 offset:12288
v_mfma_f32_16x16x32_bf16 v[92:95],v[124:127],a[196:199],v[92:95]
ds_read_b64_tr_b16 v[118:119],v3 offset:18432
v_mfma_f32_16x16x32_bf16 v[92:95],v[128:131],a[200:203],v[92:95]
v_mfma_f32_16x16x32_bf16 v[92:95],v[132:135],a[204:207],v[92:95]
v_mfma_f32_16x16x32_bf16 v[92:95],v[136:139],a[208:211],v[92:95]
v_mfma_f32_16x16x32_bf16 v[92:95],v[140:143],a[212:215],v[92:95]
v_mfma_f32_16x16x32_bf16 v[100:103],v[140:143],a[236:239],0
v_mfma_f32_16x16x32_bf16 v[100:103],v[136:139],a[232:235],v[100:103]
v_mfma_f32_16x16x32_bf16 v[100:103],v[132:135],a[228:231],v[100:103]
v_mfma_f32_16x16x32_bf16 v[100:103],v[128:131],a[224:227],v[100:103]
v_mfma_f32_16x16x32_bf16 v[100:103],v[124:127],a[220:223],v[100:103]
ds_read_b64_tr_b16 v[124:125],v5 offset:12288
v_mfma_f32_16x16x32_bf16 v[100:103],v[120:123],a[216:219],v[100:103]
s_waitcnt lgkmcnt(1)
ds_read_b64_tr_b16 v[120:121],v4 offset:12288
ds_read_b64_tr_b16 v[122:123],v4 offset:18432
ds_read_b64_tr_b16 v[126:127],v5 offset:18432
v_mfma_f32_16x16x32_bf16 v[160:163],v[112:115],v[40:43],v[160:163]
s_add_u32 m0,s23,12288
ds_read_b64_tr_b16 v[128:129],v2 offset:12416
v_fma_f32 v82,v82,s36,v14
v_mfma_f32_16x16x32_bf16 v[164:167],v[116:119],v[40:43],v[164:167]
ds_read_b64_tr_b16 v[130:131],v2 offset:18560
v_fma_f32 v83,v83,s36,v14
v_mfma_f32_16x16x32_bf16 v[212:215],v[116:119],v[44:47],v[212:215]
ds_read_b64_tr_b16 v[132:133],v3 offset:12416
v_fma_f32 v88,v88,s36,v15
v_mfma_f32_16x16x32_bf16 v[208:211],v[112:115],v[44:47],v[208:211]
ds_read_b64_tr_b16 v[134:135],v3 offset:18560
v_fma_f32 v89,v89,s36,v15
v_mfma_f32_16x16x32_bf16 a[0:3],v[112:115],v[48:51],a[0:3]
ds_read_b64_tr_b16 v[136:137],v4 offset:12416
v_fma_f32 v90,v90,s36,v15
v_mfma_f32_16x16x32_bf16 a[4:7],v[116:119],v[48:51],a[4:7]
ds_read_b64_tr_b16 v[138:139],v4 offset:18560
v_fma_f32 v91,v91,s36,v15
v_mfma_f32_16x16x32_bf16 a[52:55],v[116:119],v[52:55],a[52:55]
ds_read_b64_tr_b16 v[140:141],v5 offset:12416
v_fma_f32 v96,v96,s36,v16
v_mfma_f32_16x16x32_bf16 a[48:51],v[112:115],v[52:55],a[48:51]
s_waitcnt lgkmcnt(8)
ds_read_b64_tr_b16 v[142:143],v5 offset:18560
v_fma_f32 v97,v97,s36,v16
v_mfma_f32_16x16x32_bf16 a[56:59],v[120:123],v[52:55],a[56:59]
s_waitcnt lgkmcnt(7)
ds_read_b64_tr_b16 v[112:113],v2 offset:12544
v_fma_f32 v98,v98,s36,v16
v_mfma_f32_16x16x32_bf16 a[60:63],v[124:127],v[52:55],a[60:63]
ds_read_b64_tr_b16 v[114:115],v2 offset:18688
v_fma_f32 v99,v99,s36,v16
v_mfma_f32_16x16x32_bf16 a[12:15],v[124:127],v[48:51],a[12:15]
ds_read_b64_tr_b16 v[116:117],v3 offset:12544
v_fma_f32 v76,v76,s36,v13
v_mfma_f32_16x16x32_bf16 a[8:11],v[120:123],v[48:51],a[8:11]
ds_read_b64_tr_b16 v[118:119],v3 offset:18688
v_fma_f32 v77,v77,s36,v13
v_mfma_f32_16x16x32_bf16 v[216:219],v[120:123],v[44:47],v[216:219]
v_exp_f32 v82,v82
v_mfma_f32_16x16x32_bf16 v[220:223],v[124:127],v[44:47],v[220:223]
v_exp_f32 v83,v83
v_mfma_f32_16x16x32_bf16 v[172:175],v[124:127],v[40:43],v[172:175]
ds_read_b64_tr_b16 v[124:125],v5 offset:12544
v_cvt_pk_bf16_f32 v25,v82,v83
v_mfma_f32_16x16x32_bf16 v[168:171],v[120:123],v[40:43],v[168:171]
s_waitcnt lgkmcnt(5)
ds_read_b64_tr_b16 v[120:121],v4 offset:12544
v_fma_f32 v78,v78,s36,v13
v_mfma_f32_16x16x32_bf16 v[176:179],v[128:131],v[40:43],v[176:179]
ds_read_b64_tr_b16 v[122:123],v4 offset:18688
v_fma_f32 v79,v79,s36,v13
v_mfma_f32_16x16x32_bf16 v[180:183],v[132:135],v[40:43],v[180:183]
ds_read_b64_tr_b16 v[126:127],v5 offset:18688
v_fma_f32 v84,v84,s36,v14
v_mfma_f32_16x16x32_bf16 v[228:231],v[132:135],v[44:47],v[228:231]
v_exp_f32 v88,v88
v_mfma_f32_16x16x32_bf16 v[224:227],v[128:131],v[44:47],v[224:227]
v_exp_f32 v89,v89
v_mfma_f32_16x16x32_bf16 a[16:19],v[128:131],v[48:51],a[16:19]
v_exp_f32 v90,v90
v_mfma_f32_16x16x32_bf16 a[20:23],v[132:135],v[48:51],a[20:23]
v_exp_f32 v91,v91
v_mfma_f32_16x16x32_bf16 a[68:71],v[132:135],v[52:55],a[68:71]
v_cvt_pk_bf16_f32 v28,v88,v89
v_cvt_pk_bf16_f32 v29,v90,v91
v_mfma_f32_16x16x32_bf16 a[64:67],v[128:131],v[52:55],a[64:67]
v_exp_f32 v96,v96
v_mfma_f32_16x16x32_bf16 a[72:75],v[136:139],v[52:55],a[72:75]
v_exp_f32 v97,v97
v_mfma_f32_16x16x32_bf16 a[76:79],v[140:143],v[52:55],a[76:79]
v_exp_f32 v98,v98
v_mfma_f32_16x16x32_bf16 a[28:31],v[140:143],v[48:51],a[28:31]
v_exp_f32 v99,v99
v_mfma_f32_16x16x32_bf16 a[24:27],v[136:139],v[48:51],a[24:27]
v_cvt_pk_bf16_f32 v32,v96,v97
v_cvt_pk_bf16_f32 v33,v98,v99
v_mfma_f32_16x16x32_bf16 v[232:235],v[136:139],v[44:47],v[232:235]
v_exp_f32 v76,v76
v_mfma_f32_16x16x32_bf16 v[236:239],v[140:143],v[44:47],v[236:239]
v_exp_f32 v77,v77
v_mfma_f32_16x16x32_bf16 v[188:191],v[140:143],v[40:43],v[188:191]
v_exp_f32 v78,v78
v_mfma_f32_16x16x32_bf16 v[184:187],v[136:139],v[40:43],v[184:187]
s_waitcnt lgkmcnt(0)
v_exp_f32 v79,v79
v_mfma_f32_16x16x32_bf16 v[192:195],v[112:115],v[40:43],v[192:195]
v_cvt_pk_bf16_f32 v22,v76,v77
v_cvt_pk_bf16_f32 v23,v78,v79
s_waitcnt vmcnt(6)
v_mfma_f32_16x16x32_bf16 v[196:199],v[116:119],v[40:43],v[196:199]
s_barrier
v_mfma_f32_16x16x32_bf16 v[244:247],v[116:119],v[44:47],v[244:247]
ds_read_b128 v[140:143],v1 offset:128
v_fma_f32 v85,v85,s36,v14
v_mfma_f32_16x16x32_bf16 v[240:243],v[112:115],v[44:47],v[240:243]
ds_read_b128 v[136:139],v0 offset:128
v_fma_f32 v86,v86,s36,v14
v_mfma_f32_16x16x32_bf16 a[32:35],v[112:115],v[48:51],a[32:35]
ds_read_b128 v[132:135],v1 offset:0
v_fma_f32 v87,v87,s36,v14
v_mfma_f32_16x16x32_bf16 a[36:39],v[116:119],v[48:51],a[36:39]
ds_read_b128 v[128:131],v0 offset:0
v_fma_f32 v92,v92,s36,v15
v_mfma_f32_16x16x32_bf16 a[84:87],v[116:119],v[52:55],a[84:87]
ds_read_b128 v[116:119],v1 offset:256
v_fma_f32 v93,v93,s36,v15
v_mfma_f32_16x16x32_bf16 a[80:83],v[112:115],v[52:55],a[80:83]
buffer_load_dwordx4 v6,s[8:11],s21 offen offset:0 lds
v_mfma_f32_16x16x32_bf16 a[88:91],v[120:123],v[52:55],a[88:91]
ds_read_b128 v[112:115],v0 offset:256
v_fma_f32 v94,v94,s36,v15
v_mfma_f32_16x16x32_bf16 a[92:95],v[124:127],v[52:55],a[92:95]
v_exp_f32 v84,v84
v_mfma_f32_16x16x32_bf16 a[44:47],v[124:127],v[48:51],a[44:47]
v_exp_f32 v85,v85
v_mfma_f32_16x16x32_bf16 a[40:43],v[120:123],v[48:51],a[40:43]
v_exp_f32 v86,v86
v_mfma_f32_16x16x32_bf16 v[248:251],v[120:123],v[44:47],v[248:251]
v_exp_f32 v87,v87
v_mfma_f32_16x16x32_bf16 v[252:255],v[124:127],v[44:47],v[252:255]
v_cvt_pk_bf16_f32 v26,v84,v85
v_cvt_pk_bf16_f32 v27,v86,v87
v_mfma_f32_16x16x32_bf16 v[204:207],v[124:127],v[40:43],v[204:207]
ds_read_b128 v[124:127],v1 offset:6144
v_fma_f32 v95,v95,s36,v15
v_smfmac_f32_16x16x64_bf16 v[60:63],v[152:155],v[20:27],v18
v_fma_f32 v100,v100,s36,v16
v_mfma_f32_16x16x32_bf16 v[200:203],v[120:123],v[40:43],v[200:203]
buffer_load_dwordx4 v7,s[8:11],s21 offen offset:1024 lds
s_waitcnt lgkmcnt(1)
v_mfma_f32_16x16x32_bf16 v[72:75],v[116:119],a[164:167],0
ds_read_b128 v[120:123],v0 offset:6144
v_fma_f32 v101,v101,s36,v16
v_mfma_f32_16x16x32_bf16 v[72:75],v[112:115],a[160:163],v[72:75]
v_exp_f32 v92,v92
v_mfma_f32_16x16x32_bf16 v[72:75],v[140:143],a[156:159],v[72:75]
v_exp_f32 v93,v93
v_mfma_f32_16x16x32_bf16 v[72:75],v[136:139],a[152:155],v[72:75]
v_exp_f32 v94,v94
v_mfma_f32_16x16x32_bf16 v[72:75],v[132:135],a[148:151],v[72:75]
v_exp_f32 v95,v95
v_mfma_f32_16x16x32_bf16 v[72:75],v[128:131],a[144:147],v[72:75]
v_cvt_pk_bf16_f32 v30,v92,v93
v_cvt_pk_bf16_f32 v31,v94,v95
v_mfma_f32_16x16x32_bf16 v[80:83],v[128:131],a[168:171],0
v_fma_f32 v102,v102,s36,v16
v_fma_f32 v103,v103,s36,v16
v_mfma_f32_16x16x32_bf16 v[80:83],v[132:135],a[172:175],v[80:83]
v_exp_f32 v100,v100
v_mfma_f32_16x16x32_bf16 v[80:83],v[136:139],a[176:179],v[80:83]
buffer_load_dwordx4 v8,s[8:11],s21 offen offset:2048 lds
v_mfma_f32_16x16x32_bf16 v[80:83],v[140:143],a[180:183],v[80:83]
s_add_u32 s21,s21,12288
v_exp_f32 v101,v101
v_mfma_f32_16x16x32_bf16 v[80:83],v[112:115],a[184:187],v[80:83]
s_add_u32 m0,s22,24576
v_exp_f32 v102,v102
v_mfma_f32_16x16x32_bf16 v[80:83],v[116:119],a[188:191],v[80:83]
v_exp_f32 v103,v103
v_mfma_f32_16x16x32_bf16 v[88:91],v[116:119],a[212:215],0
v_cvt_pk_bf16_f32 v34,v100,v101
v_cvt_pk_bf16_f32 v35,v102,v103
v_mfma_f32_16x16x32_bf16 v[88:91],v[112:115],a[208:211],v[88:91]
v_fma_f32 v72,v72,s36,v13
v_fma_f32 v73,v73,s36,v13
v_smfmac_f32_16x16x64_bf16 v[64:67],v[152:155],v[28:35],v18
v_fma_f32 v74,v74,s36,v13
v_mfma_f32_16x16x32_bf16 v[88:91],v[140:143],a[204:207],v[88:91]
v_fma_f32 v75,v75,s36,v13
v_fma_f32 v80,v80,s36,v14
v_mfma_f32_16x16x32_bf16 v[88:91],v[136:139],a[200:203],v[88:91]
v_fma_f32 v81,v81,s36,v14
v_mfma_f32_16x16x32_bf16 v[88:91],v[132:135],a[196:199],v[88:91]
buffer_load_dwordx4 v6,s[4:7],s20 offen offset:0 lds
v_mfma_f32_16x16x32_bf16 v[88:91],v[128:131],a[192:195],v[88:91]
v_exp_f32 v72,v72
v_mfma_f32_16x16x32_bf16 v[96:99],v[128:131],a[216:219],0
ds_read_b128 v[128:131],v0 offset:6272
v_mfma_f32_16x16x32_bf16 v[96:99],v[132:135],a[220:223],v[96:99]
ds_read_b128 v[132:135],v1 offset:6272
v_mfma_f32_16x16x32_bf16 v[96:99],v[136:139],a[224:227],v[96:99]
ds_read_b128 v[136:139],v0 offset:6400
v_mfma_f32_16x16x32_bf16 v[96:99],v[140:143],a[228:231],v[96:99]
ds_read_b128 v[140:143],v1 offset:6400
v_mfma_f32_16x16x32_bf16 v[96:99],v[112:115],a[232:235],v[96:99]
v_exp_f32 v73,v73
v_mfma_f32_16x16x32_bf16 v[96:99],v[116:119],a[236:239],v[96:99]
s_waitcnt lgkmcnt(4)
v_exp_f32 v74,v74
v_mfma_f32_16x16x32_bf16 v[76:79],v[120:123],a[144:147],0
v_exp_f32 v75,v75
v_mfma_f32_16x16x32_bf16 v[76:79],v[124:127],a[148:151],v[76:79]
buffer_load_dwordx4 v7,s[4:7],s20 offen offset:1024 lds
v_exp_f32 v80,v80
v_exp_f32 v81,v81
s_waitcnt lgkmcnt(3)
v_mfma_f32_16x16x32_bf16 v[76:79],v[128:131],a[152:155],v[76:79]
s_waitcnt lgkmcnt(2)
v_cvt_pk_bf16_f32 v40,v72,v73
v_cvt_pk_bf16_f32 v41,v74,v75
v_mfma_f32_16x16x32_bf16 v[76:79],v[132:135],a[156:159],v[76:79]
s_waitcnt lgkmcnt(1)
v_cvt_pk_bf16_f32 v44,v80,v81
v_mfma_f32_16x16x32_bf16 v[76:79],v[136:139],a[160:163],v[76:79]
s_waitcnt lgkmcnt(0)
v_mfma_f32_16x16x32_bf16 v[76:79],v[140:143],a[164:167],v[76:79]
v_mfma_f32_16x16x32_bf16 v[84:87],v[140:143],a[188:191],0
v_mfma_f32_16x16x32_bf16 v[84:87],v[136:139],a[184:187],v[84:87]
v_mfma_f32_16x16x32_bf16 v[84:87],v[132:135],a[180:183],v[84:87]
v_mfma_f32_16x16x32_bf16 v[84:87],v[128:131],a[176:179],v[84:87]
buffer_load_dwordx4 v8,s[4:7],s20 offen offset:2048 lds
v_mfma_f32_16x16x32_bf16 v[84:87],v[124:127],a[172:175],v[84:87]
s_add_u32 s20,s20,12288
ds_read_b64_tr_b16 v[112:113],v2 offset:24576
v_mfma_f32_16x16x32_bf16 v[84:87],v[120:123],a[168:171],v[84:87]
ds_read_b64_tr_b16 v[114:115],v2 offset:30720
v_mfma_f32_16x16x32_bf16 v[92:95],v[120:123],a[192:195],0
ds_read_b64_tr_b16 v[116:117],v3 offset:24576
v_mfma_f32_16x16x32_bf16 v[92:95],v[124:127],a[196:199],v[92:95]
ds_read_b64_tr_b16 v[118:119],v3 offset:30720
v_mfma_f32_16x16x32_bf16 v[92:95],v[128:131],a[200:203],v[92:95]
v_mfma_f32_16x16x32_bf16 v[92:95],v[132:135],a[204:207],v[92:95]
v_mfma_f32_16x16x32_bf16 v[92:95],v[136:139],a[208:211],v[92:95]
v_mfma_f32_16x16x32_bf16 v[92:95],v[140:143],a[212:215],v[92:95]
v_mfma_f32_16x16x32_bf16 v[100:103],v[140:143],a[236:239],0
v_mfma_f32_16x16x32_bf16 v[100:103],v[136:139],a[232:235],v[100:103]
v_mfma_f32_16x16x32_bf16 v[100:103],v[132:135],a[228:231],v[100:103]
v_mfma_f32_16x16x32_bf16 v[100:103],v[128:131],a[224:227],v[100:103]
v_mfma_f32_16x16x32_bf16 v[100:103],v[124:127],a[220:223],v[100:103]
ds_read_b64_tr_b16 v[124:125],v5 offset:24576
v_mfma_f32_16x16x32_bf16 v[100:103],v[120:123],a[216:219],v[100:103]
ds_read_b64_tr_b16 v[120:121],v4 offset:24576
ds_read_b64_tr_b16 v[122:123],v4 offset:30720
ds_read_b64_tr_b16 v[126:127],v5 offset:30720
s_mov_b32 s38,0
s_branch L_loop4
L_end5:
s_waitcnt lgkmcnt(4)
v_mfma_f32_16x16x32_bf16 v[160:163],v[112:115],v[20:23],v[160:163]
ds_read_b64_tr_b16 v[128:129],v2 offset:24704
v_fma_f32 v90,v90,s36,v15
v_mfma_f32_16x16x32_bf16 v[164:167],v[116:119],v[20:23],v[164:167]
ds_read_b64_tr_b16 v[130:131],v2 offset:30848
v_fma_f32 v91,v91,s36,v15
v_mfma_f32_16x16x32_bf16 v[212:215],v[116:119],v[24:27],v[212:215]
ds_read_b64_tr_b16 v[132:133],v3 offset:24704
v_fma_f32 v96,v96,s36,v16
v_mfma_f32_16x16x32_bf16 v[208:211],v[112:115],v[24:27],v[208:211]
ds_read_b64_tr_b16 v[134:135],v3 offset:30848
v_fma_f32 v97,v97,s36,v16
v_mfma_f32_16x16x32_bf16 a[0:3],v[112:115],v[28:31],a[0:3]
ds_read_b64_tr_b16 v[136:137],v4 offset:24704
v_fma_f32 v98,v98,s36,v16
v_mfma_f32_16x16x32_bf16 a[4:7],v[116:119],v[28:31],a[4:7]
ds_read_b64_tr_b16 v[138:139],v4 offset:30848
ds_read_b64_tr_b16 v[140:141],v5 offset:24704
ds_read_b64_tr_b16 v[142:143],v5 offset:30848
v_mfma_f32_16x16x32_bf16 a[52:55],v[116:119],v[32:35],a[52:55]
v_fma_f32 v99,v99,s36,v16
v_fma_f32 v104,v104,s36,v17
v_mfma_f32_16x16x32_bf16 a[48:51],v[112:115],v[32:35],a[48:51]
v_fma_f32 v105,v105,s36,v17
v_fma_f32 v106,v106,s36,v17
v_mfma_f32_16x16x32_bf16 a[96:99],v[112:115],v[36:39],a[96:99]
ds_read_b64_tr_b16 v[112:113],v2 offset:24832
v_fma_f32 v107,v107,s36,v17
v_mfma_f32_16x16x32_bf16 a[100:103],v[116:119],v[36:39],a[100:103]
s_waitcnt lgkmcnt(7)
ds_read_b64_tr_b16 v[114:115],v2 offset:30976
v_fma_f32 v76,v76,s36,v13
v_mfma_f32_16x16x32_bf16 a[104:107],v[120:123],v[36:39],a[104:107]
ds_read_b64_tr_b16 v[116:117],v3 offset:24832
v_fma_f32 v77,v77,s36,v13
v_mfma_f32_16x16x32_bf16 a[108:111],v[124:127],v[36:39],a[108:111]
ds_read_b64_tr_b16 v[118:119],v3 offset:30976
v_fma_f32 v78,v78,s36,v13
v_mfma_f32_16x16x32_bf16 a[60:63],v[124:127],v[32:35],a[60:63]
v_fma_f32 v79,v79,s36,v13
v_fma_f32 v84,v84,s36,v14
v_mfma_f32_16x16x32_bf16 a[56:59],v[120:123],v[32:35],a[56:59]
v_fma_f32 v85,v85,s36,v14
v_fma_f32 v86,v86,s36,v14
v_mfma_f32_16x16x32_bf16 a[8:11],v[120:123],v[28:31],a[8:11]
v_fma_f32 v87,v87,s36,v14
v_fma_f32 v92,v92,s36,v15
v_mfma_f32_16x16x32_bf16 a[12:15],v[124:127],v[28:31],a[12:15]
v_fma_f32 v93,v93,s36,v15
v_fma_f32 v94,v94,s36,v15
v_mfma_f32_16x16x32_bf16 v[220:223],v[124:127],v[24:27],v[220:223]
v_fma_f32 v95,v95,s36,v15
v_fma_f32 v100,v100,s36,v16
v_mfma_f32_16x16x32_bf16 v[216:219],v[120:123],v[24:27],v[216:219]
v_fma_f32 v101,v101,s36,v16
v_fma_f32 v102,v102,s36,v16
v_mfma_f32_16x16x32_bf16 v[168:171],v[120:123],v[20:23],v[168:171]
ds_read_b64_tr_b16 v[120:121],v4 offset:24832
v_fma_f32 v103,v103,s36,v16
v_mfma_f32_16x16x32_bf16 v[172:175],v[124:127],v[20:23],v[172:175]
ds_read_b64_tr_b16 v[122:123],v4 offset:30976
v_fma_f32 v108,v108,s36,v17
v_mfma_f32_16x16x32_bf16 v[176:179],v[128:131],v[20:23],v[176:179]
s_waitcnt lgkmcnt(2)
ds_read_b64_tr_b16 v[124:125],v5 offset:24832
v_fma_f32 v109,v109,s36,v17
v_mfma_f32_16x16x32_bf16 v[180:183],v[132:135],v[20:23],v[180:183]
ds_read_b64_tr_b16 v[126:127],v5 offset:30976
v_fma_f32 v110,v110,s36,v17
v_mfma_f32_16x16x32_bf16 v[228:231],v[132:135],v[24:27],v[228:231]
v_fma_f32 v111,v111,s36,v17
v_exp_f32 v90,v90
v_mfma_f32_16x16x32_bf16 v[224:227],v[128:131],v[24:27],v[224:227]
v_exp_f32 v91,v91
v_mfma_f32_16x16x32_bf16 a[16:19],v[128:131],v[28:31],a[16:19]
v_exp_f32 v96,v96
v_mfma_f32_16x16x32_bf16 a[20:23],v[132:135],v[28:31],a[20:23]
v_exp_f32 v97,v97
v_mfma_f32_16x16x32_bf16 a[68:71],v[132:135],v[32:35],a[68:71]
v_exp_f32 v98,v98
v_mfma_f32_16x16x32_bf16 a[64:67],v[128:131],v[32:35],a[64:67]
v_exp_f32 v99,v99
v_mfma_f32_16x16x32_bf16 a[112:115],v[128:131],v[36:39],a[112:115]
v_exp_f32 v104,v104
v_mfma_f32_16x16x32_bf16 a[116:119],v[132:135],v[36:39],a[116:119]
v_exp_f32 v105,v105
v_mfma_f32_16x16x32_bf16 a[120:123],v[136:139],v[36:39],a[120:123]
v_exp_f32 v106,v106
v_mfma_f32_16x16x32_bf16 a[124:127],v[140:143],v[36:39],a[124:127]
v_exp_f32 v107,v107
v_mfma_f32_16x16x32_bf16 a[76:79],v[140:143],v[32:35],a[76:79]
v_exp_f32 v76,v76
v_mfma_f32_16x16x32_bf16 a[72:75],v[136:139],v[32:35],a[72:75]
v_exp_f32 v77,v77
v_mfma_f32_16x16x32_bf16 a[24:27],v[136:139],v[28:31],a[24:27]
v_exp_f32 v78,v78
v_mfma_f32_16x16x32_bf16 a[28:31],v[140:143],v[28:31],a[28:31]
v_exp_f32 v79,v79
v_mfma_f32_16x16x32_bf16 v[236:239],v[140:143],v[24:27],v[236:239]
v_exp_f32 v84,v84
v_mfma_f32_16x16x32_bf16 v[232:235],v[136:139],v[24:27],v[232:235]
v_exp_f32 v85,v85
v_mfma_f32_16x16x32_bf16 v[184:187],v[136:139],v[20:23],v[184:187]
v_exp_f32 v86,v86
v_mfma_f32_16x16x32_bf16 v[188:191],v[140:143],v[20:23],v[188:191]
v_exp_f32 v87,v87
v_mfma_f32_16x16x32_bf16 v[192:195],v[112:115],v[20:23],v[192:195]
v_exp_f32 v92,v92
v_mfma_f32_16x16x32_bf16 v[196:199],v[116:119],v[20:23],v[196:199]
v_exp_f32 v93,v93
v_mfma_f32_16x16x32_bf16 v[244:247],v[116:119],v[24:27],v[244:247]
v_exp_f32 v94,v94
v_mfma_f32_16x16x32_bf16 v[240:243],v[112:115],v[24:27],v[240:243]
v_exp_f32 v95,v95
v_mfma_f32_16x16x32_bf16 a[32:35],v[112:115],v[28:31],a[32:35]
v_exp_f32 v100,v100
v_mfma_f32_16x16x32_bf16 a[36:39],v[116:119],v[28:31],a[36:39]
v_exp_f32 v101,v101
v_mfma_f32_16x16x32_bf16 a[84:87],v[116:119],v[32:35],a[84:87]
v_exp_f32 v102,v102
v_mfma_f32_16x16x32_bf16 a[80:83],v[112:115],v[32:35],a[80:83]
v_exp_f32 v103,v103
v_mfma_f32_16x16x32_bf16 a[128:131],v[112:115],v[36:39],a[128:131]
v_exp_f32 v108,v108
s_waitcnt vmcnt(14) lgkmcnt(0)
s_barrier
v_mfma_f32_16x16x32_bf16 a[132:135],v[116:119],v[36:39],a[132:135]
v_exp_f32 v109,v109
v_mfma_f32_16x16x32_bf16 a[136:139],v[120:123],v[36:39],a[136:139]
v_exp_f32 v110,v110
v_mfma_f32_16x16x32_bf16 a[140:143],v[124:127],v[36:39],a[140:143]
v_exp_f32 v111,v111
v_mfma_f32_16x16x32_bf16 a[92:95],v[124:127],v[32:35],a[92:95]
v_cvt_pk_bf16_f32 v49,v90,v91
v_cvt_pk_bf16_f32 v52,v96,v97
v_mfma_f32_16x16x32_bf16 a[88:91],v[120:123],v[32:35],a[88:91]
v_cvt_pk_bf16_f32 v53,v98,v99
v_cvt_pk_bf16_f32 v56,v104,v105
v_mfma_f32_16x16x32_bf16 a[40:43],v[120:123],v[28:31],a[40:43]
v_cvt_pk_bf16_f32 v57,v106,v107
v_cvt_pk_bf16_f32 v42,v76,v77
v_mfma_f32_16x16x32_bf16 a[44:47],v[124:127],v[28:31],a[44:47]
v_cvt_pk_bf16_f32 v43,v78,v79
v_cvt_pk_bf16_f32 v46,v84,v85
v_mfma_f32_16x16x32_bf16 v[252:255],v[124:127],v[24:27],v[252:255]
v_cvt_pk_bf16_f32 v47,v86,v87
v_cvt_pk_bf16_f32 v50,v92,v93
v_mfma_f32_16x16x32_bf16 v[248:251],v[120:123],v[24:27],v[248:251]
v_cvt_pk_bf16_f32 v51,v94,v95
v_cvt_pk_bf16_f32 v54,v100,v101
v_smfmac_f32_16x16x64_bf16 v[60:63],v[152:155],v[40:47],v18
v_cvt_pk_bf16_f32 v55,v102,v103
v_mfma_f32_16x16x32_bf16 v[200:203],v[120:123],v[20:23],v[200:203]
v_cvt_pk_bf16_f32 v58,v108,v109
v_cvt_pk_bf16_f32 v59,v110,v111
v_smfmac_f32_16x16x64_bf16 v[64:67],v[152:155],v[48:55],v18
v_subrev_u32 v10,18432,v10
v_smfmac_f32_16x16x64_bf16 v[68:71],v[152:155],v[52:59],v18
v_mfma_f32_16x16x32_bf16 v[204:207],v[124:127],v[20:23],v[204:207]
ds_read_b64_tr_b16 v[128:129],v2 offset:0
ds_read_b64_tr_b16 v[130:131],v2 offset:6144
ds_read_b64_tr_b16 v[132:133],v3 offset:0
ds_read_b64_tr_b16 v[134:135],v3 offset:6144
ds_read_b64_tr_b16 v[136:137],v4 offset:0
ds_read_b64_tr_b16 v[138:139],v4 offset:6144
ds_read_b64_tr_b16 v[140:141],v5 offset:0
ds_read_b64_tr_b16 v[142:143],v5 offset:6144
s_waitcnt lgkmcnt(6)
v_mfma_f32_16x16x32_bf16 v[160:163],v[128:131],v[40:43],v[160:163]
s_waitcnt vmcnt(6)
ds_read_b64_tr_b16 v[112:113],v2 offset:128
v_mbcnt_lo_u32_b32 v39,-1,0
s_waitcnt lgkmcnt(5)
v_mfma_f32_16x16x32_bf16 v[164:167],v[132:135],v[40:43],v[164:167]
s_add_u32 s84,s42,0
ds_read_b64_tr_b16 v[114:115],v2 offset:6272
v_mbcnt_hi_u32_b32 v39,-1,v39
v_mfma_f32_16x16x32_bf16 v[212:215],v[132:135],v[44:47],v[212:215]
s_add_u32 s85,s42,6144
ds_read_b64_tr_b16 v[116:117],v3 offset:128
v_and_b32 v38,7,v39
v_mfma_f32_16x16x32_bf16 v[208:211],v[128:131],v[44:47],v[208:211]
s_add_u32 s86,s42,12288
ds_read_b64_tr_b16 v[118:119],v3 offset:6272
v_add_f32 v60,v60,v61
v_mfma_f32_16x16x32_bf16 a[0:3],v[128:131],v[48:51],a[0:3]
s_add_u32 s87,s42,18432
ds_read_b64_tr_b16 v[120:121],v4 offset:128
v_add_f32 v62,v62,v63
v_mfma_f32_16x16x32_bf16 a[4:7],v[132:135],v[48:51],a[4:7]
s_add_u32 s66,s42,24576
ds_read_b64_tr_b16 v[122:123],v4 offset:6272
ds_read_b64_tr_b16 v[124:125],v5 offset:128
ds_read_b64_tr_b16 v[126:127],v5 offset:6272
v_mfma_f32_16x16x32_bf16 a[52:55],v[132:135],v[52:55],a[52:55]
v_add_f32 v64,v64,v65
v_add_f32 v66,v66,v67
v_mfma_f32_16x16x32_bf16 a[48:51],v[128:131],v[52:55],a[48:51]
v_add_f32 v70,v70,v71
v_max3_f32 v19,v60,v62,v64
v_mfma_f32_16x16x32_bf16 a[96:99],v[128:131],v[56:59],a[96:99]
ds_read_b64_tr_b16 v[128:129],v2 offset:256
v_max3_f32 v19,v19,v66,v70
v_mfma_f32_16x16x32_bf16 a[100:103],v[132:135],v[56:59],a[100:103]
s_waitcnt lgkmcnt(7)
ds_read_b64_tr_b16 v[130:131],v2 offset:6400
v_rcp_f32 v66,v66
v_mfma_f32_16x16x32_bf16 a[104:107],v[136:139],v[56:59],a[104:107]
ds_read_b64_tr_b16 v[132:133],v3 offset:256
v_rcp_f32 v70,v70
v_mfma_f32_16x16x32_bf16 a[108:111],v[140:143],v[56:59],a[108:111]
ds_read_b64_tr_b16 v[134:135],v3 offset:6400
v_accvgpr_read_b32 v72,a48
v_accvgpr_read_b32 v73,a49
v_accvgpr_read_b32 v74,a50
v_accvgpr_read_b32 v75,a51
v_pk_mul_f32 v[72:73],v[72:73],v[66:67] op_sel_hi:[1,0]
v_pk_mul_f32 v[74:75],v[74:75],v[66:67] op_sel_hi:[1,0]
v_accvgpr_read_b32 v76,a96
v_accvgpr_read_b32 v77,a97
v_pk_mul_f32 v[76:77],v[76:77],v[70:71] op_sel_hi:[1,0]
v_accvgpr_read_b32 v78,a98
v_accvgpr_read_b32 v79,a99
v_pk_mul_f32 v[78:79],v[78:79],v[70:71] op_sel_hi:[1,0]
v_accvgpr_read_b32 v80,a52
v_accvgpr_read_b32 v81,a53
v_mfma_f32_16x16x32_bf16 a[60:63],v[140:143],v[52:55],a[60:63]
v_accvgpr_read_b32 v82,a54
v_accvgpr_read_b32 v83,a55
v_accvgpr_read_b32 v84,a100
v_accvgpr_read_b32 v85,a101
v_accvgpr_read_b32 v86,a102
v_pk_mul_f32 v[80:81],v[80:81],v[66:67] op_sel_hi:[1,0]
v_pk_mul_f32 v[82:83],v[82:83],v[66:67] op_sel_hi:[1,0]
v_pk_mul_f32 v[84:85],v[84:85],v[70:71] op_sel_hi:[1,0]
v_accvgpr_read_b32 v87,a103
v_pk_mul_f32 v[86:87],v[86:87],v[70:71] op_sel_hi:[1,0]
v_accvgpr_read_b32 v92,a104
v_accvgpr_read_b32 v93,a105
v_mfma_f32_16x16x32_bf16 a[56:59],v[136:139],v[52:55],a[56:59]
v_accvgpr_read_b32 v94,a106
v_accvgpr_read_b32 v95,a107
v_mfma_f32_16x16x32_bf16 a[8:11],v[136:139],v[48:51],a[8:11]
v_accvgpr_read_b32 v100,a108
v_accvgpr_read_b32 v101,a109
v_mfma_f32_16x16x32_bf16 a[12:15],v[140:143],v[48:51],a[12:15]
v_accvgpr_read_b32 v102,a110
v_accvgpr_read_b32 v103,a111
v_mfma_f32_16x16x32_bf16 v[220:223],v[140:143],v[44:47],v[220:223]
v_accvgpr_read_b32 v96,a60
v_accvgpr_read_b32 v97,a61
v_accvgpr_read_b32 v98,a62
v_accvgpr_read_b32 v99,a63
v_accvgpr_read_b32 v88,a56
v_pk_mul_f32 v[92:93],v[92:93],v[70:71] op_sel_hi:[1,0]
v_pk_mul_f32 v[94:95],v[94:95],v[70:71] op_sel_hi:[1,0]
v_pk_mul_f32 v[100:101],v[100:101],v[70:71] op_sel_hi:[1,0]
v_pk_mul_f32 v[102:103],v[102:103],v[70:71] op_sel_hi:[1,0]
v_pk_mul_f32 v[96:97],v[96:97],v[66:67] op_sel_hi:[1,0]
v_pk_mul_f32 v[98:99],v[98:99],v[66:67] op_sel_hi:[1,0]
v_accvgpr_read_b32 v89,a57
v_pk_mul_f32 v[88:89],v[88:89],v[66:67] op_sel_hi:[1,0]
v_accvgpr_read_b32 v90,a58
v_accvgpr_read_b32 v91,a59
v_pk_mul_f32 v[90:91],v[90:91],v[66:67] op_sel_hi:[1,0]
v_cmp_ngt_f32 vcc,s37,v19
v_lshrrev_b32 v19,5,v39
v_mfma_f32_16x16x32_bf16 v[216:219],v[136:139],v[44:47],v[216:219]
v_xor_b32 v38,v38,v19
v_and_b32 v19,15,v39
v_mfma_f32_16x16x32_bf16 v[168:171],v[136:139],v[40:43],v[168:171]
s_cmp_lg_u64 vcc,0
ds_read_b64_tr_b16 v[136:137],v4 offset:256
v_lshl_add_u32 v19,v19,7,s24
v_mfma_f32_16x16x32_bf16 v[172:175],v[140:143],v[40:43],v[172:175]
s_cselect_b32 s62,s32,0
ds_read_b64_tr_b16 v[138:139],v4 offset:6400
v_lshl_add_u32 v19,v38,4,v19
v_mfma_f32_16x16x32_bf16 v[176:179],v[112:115],v[40:43],v[176:179]
s_or_b32 s31,s31,s62
ds_read_b64_tr_b16 v[140:141],v5 offset:256
v_bfe_u32 v38,v39,4,1
s_waitcnt lgkmcnt(3)
v_mfma_f32_16x16x32_bf16 v[180:183],v[116:119],v[40:43],v[180:183]
s_lshl_b32 s32,s32,1
ds_read_b64_tr_b16 v[142:143],v5 offset:6400
v_lshl_add_u32 v36,v38,3,v19
v_mfma_f32_16x16x32_bf16 v[228:231],v[116:119],v[44:47],v[228:231]
v_xor_b32 v37,32,v36
v_xor_b32 v38,64,v36
v_mfma_f32_16x16x32_bf16 v[224:227],v[112:115],v[44:47],v[224:227]
v_bfe_u32 v19,v39,3,1
v_xor_b32 v39,96,v36
v_mfma_f32_16x16x32_bf16 a[16:19],v[112:115],v[48:51],a[16:19]
v_lshlrev_b32 v19,11,v19
v_cvt_pk_bf16_f32 v72,v72,v73
v_mfma_f32_16x16x32_bf16 a[20:23],v[116:119],v[48:51],a[20:23]
v_cvt_pk_bf16_f32 v76,v76,v77
v_cvt_pk_bf16_f32 v80,v80,v81
v_mfma_f32_16x16x32_bf16 a[68:71],v[116:119],v[52:55],a[68:71]
v_cvt_pk_bf16_f32 v84,v84,v85
v_cvt_pk_bf16_f32 v73,v74,v75
v_mfma_f32_16x16x32_bf16 a[64:67],v[112:115],v[52:55],a[64:67]
v_cvt_pk_bf16_f32 v77,v78,v79
v_cvt_pk_bf16_f32 v81,v82,v83
v_mfma_f32_16x16x32_bf16 a[112:115],v[112:115],v[56:59],a[112:115]
ds_write2st64_b64 v36,v[72:73],v[76:77] offset0:36 offset1:40
v_mfma_f32_16x16x32_bf16 a[116:119],v[116:119],v[56:59],a[116:119]
v_cvt_pk_bf16_f32 v85,v86,v87
v_cvt_pk_bf16_f32 v92,v92,v93
v_mfma_f32_16x16x32_bf16 a[120:123],v[120:123],v[56:59],a[120:123]
v_accvgpr_read_b32 v78,a66
v_accvgpr_read_b32 v79,a67
v_mfma_f32_16x16x32_bf16 a[124:127],v[124:127],v[56:59],a[124:127]
v_accvgpr_read_b32 v82,a114
ds_write2st64_b64 v37,v[80:81],v[84:85] offset0:36 offset1:40
v_pk_mul_f32 v[78:79],v[78:79],v[66:67] op_sel_hi:[1,0]
v_accvgpr_read_b32 v83,a115
v_pk_mul_f32 v[82:83],v[82:83],v[70:71] op_sel_hi:[1,0]
v_accvgpr_read_b32 v76,a64
v_accvgpr_read_b32 v77,a65
v_pk_mul_f32 v[76:77],v[76:77],v[66:67] op_sel_hi:[1,0]
v_accvgpr_read_b32 v80,a112
v_accvgpr_read_b32 v81,a113
v_pk_mul_f32 v[80:81],v[80:81],v[70:71] op_sel_hi:[1,0]
v_cvt_pk_bf16_f32 v88,v88,v89
v_cvt_pk_bf16_f32 v93,v94,v95
v_mfma_f32_16x16x32_bf16 a[76:79],v[124:127],v[52:55],a[76:79]
v_cvt_pk_bf16_f32 v89,v90,v91
ds_write2st64_b64 v38,v[88:89],v[92:93] offset0:36 offset1:40
v_accvgpr_read_b32 v86,a70
v_accvgpr_read_b32 v87,a71
v_pk_mul_f32 v[86:87],v[86:87],v[66:67] op_sel_hi:[1,0]
v_accvgpr_read_b32 v84,a68
v_accvgpr_read_b32 v85,a69
v_pk_mul_f32 v[84:85],v[84:85],v[66:67] op_sel_hi:[1,0]
v_accvgpr_read_b32 v90,a118
v_accvgpr_read_b32 v91,a119
v_pk_mul_f32 v[90:91],v[90:91],v[70:71] op_sel_hi:[1,0]
v_accvgpr_read_b32 v88,a116
v_accvgpr_read_b32 v89,a117
v_pk_mul_f32 v[88:89],v[88:89],v[70:71] op_sel_hi:[1,0]
v_cvt_pk_bf16_f32 v100,v100,v101
v_cvt_pk_bf16_f32 v96,v96,v97
v_mfma_f32_16x16x32_bf16 a[72:75],v[120:123],v[52:55],a[72:75]
v_cvt_pk_bf16_f32 v101,v102,v103
v_cvt_pk_bf16_f32 v97,v98,v99
v_mfma_f32_16x16x32_bf16 a[24:27],v[120:123],v[48:51],a[24:27]
ds_write2st64_b64 v39,v[96:97],v[100:101] offset0:36 offset1:40
v_mfma_f32_16x16x32_bf16 a[28:31],v[124:127],v[48:51],a[28:31]
v_cvt_pk_bf16_f32 v76,v76,v77
v_cvt_pk_bf16_f32 v80,v80,v81
v_mfma_f32_16x16x32_bf16 v[236:239],v[124:127],v[44:47],v[236:239]
ds_read_b128 v[156:159],v10 offset:18432
v_cvt_pk_bf16_f32 v77,v78,v79
ds_read_b128 v[104:107],v10 offset:19456
v_cvt_pk_bf16_f32 v81,v82,v83
ds_read_b128 v[108:111],v10 offset:20480
v_accvgpr_read_b32 v92,a72
ds_read_b128 v[72:75],v10 offset:21504
v_accvgpr_read_b32 v93,a73
ds_write2st64_b64 v36,v[76:77],v[80:81] offset0:36 offset1:40
v_pk_mul_f32 v[92:93],v[92:93],v[66:67] op_sel_hi:[1,0]
v_accvgpr_read_b32 v94,a74
v_accvgpr_read_b32 v95,a75
v_pk_mul_f32 v[94:95],v[94:95],v[66:67] op_sel_hi:[1,0]
v_accvgpr_read_b32 v102,a78
v_accvgpr_read_b32 v103,a79
v_pk_mul_f32 v[102:103],v[102:103],v[66:67] op_sel_hi:[1,0]
v_accvgpr_read_b32 v98,a122
v_accvgpr_read_b32 v99,a123
v_pk_mul_f32 v[98:99],v[98:99],v[70:71] op_sel_hi:[1,0]
v_accvgpr_read_b32 v96,a120
v_accvgpr_read_b32 v97,a121
s_waitcnt lgkmcnt(4)
buffer_store_dwordx4 v[156:159],v9,s[16:19],s87 offen offset:0 nt
v_pk_mul_f32 v[96:97],v[96:97],v[70:71] op_sel_hi:[1,0]
v_accvgpr_read_b32 v100,a76
v_accvgpr_read_b32 v101,a77
v_pk_mul_f32 v[100:101],v[100:101],v[66:67] op_sel_hi:[1,0]
v_accvgpr_read_b32 v78,a126
v_accvgpr_read_b32 v79,a127
v_pk_mul_f32 v[78:79],v[78:79],v[70:71] op_sel_hi:[1,0]
v_accvgpr_read_b32 v76,a124
v_accvgpr_read_b32 v77,a125
v_pk_mul_f32 v[76:77],v[76:77],v[70:71] op_sel_hi:[1,0]
v_cvt_pk_bf16_f32 v84,v84,v85
v_cvt_pk_bf16_f32 v88,v88,v89
v_mfma_f32_16x16x32_bf16 v[232:235],v[120:123],v[44:47],v[232:235]
s_waitcnt lgkmcnt(0)
buffer_store_dwordx4 v[104:107],v9,s[16:19],s87 offen offset:3072 nt
v_cvt_pk_bf16_f32 v92,v92,v93
v_cvt_pk_bf16_f32 v96,v96,v97
v_cvt_pk_bf16_f32 v85,v86,v87
v_mfma_f32_16x16x32_bf16 v[184:187],v[120:123],v[40:43],v[184:187]
v_cvt_pk_bf16_f32 v89,v90,v91
v_cvt_pk_bf16_f32 v100,v100,v101
v_mfma_f32_16x16x32_bf16 v[188:191],v[124:127],v[40:43],v[188:191]
v_cvt_pk_bf16_f32 v76,v76,v77
v_cvt_pk_bf16_f32 v93,v94,v95
v_mfma_f32_16x16x32_bf16 v[192:195],v[128:131],v[40:43],v[192:195]
ds_write2st64_b64 v37,v[84:85],v[88:89] offset0:36 offset1:40
v_mfma_f32_16x16x32_bf16 v[196:199],v[132:135],v[40:43],v[196:199]
v_cvt_pk_bf16_f32 v97,v98,v99
v_cvt_pk_bf16_f32 v101,v102,v103
v_mfma_f32_16x16x32_bf16 v[244:247],v[132:135],v[44:47],v[244:247]
buffer_store_dwordx4 v[108:111],v9,s[16:19],s66 offen offset:0 nt
v_cvt_pk_bf16_f32 v77,v78,v79
v_rcp_f32 v62,v62
v_mfma_f32_16x16x32_bf16 v[240:243],v[128:131],v[44:47],v[240:243]
v_rcp_f32 v64,v64
v_mfma_f32_16x16x32_bf16 a[32:35],v[128:131],v[48:51],a[32:35]
v_rcp_f32 v60,v60
v_mfma_f32_16x16x32_bf16 a[36:39],v[132:135],v[48:51],a[36:39]
ds_write2st64_b64 v38,v[92:93],v[96:97] offset0:36 offset1:40
v_mfma_f32_16x16x32_bf16 a[84:87],v[132:135],v[52:55],a[84:87]
v_mfma_f32_16x16x32_bf16 a[80:83],v[128:131],v[52:55],a[80:83]
buffer_store_dwordx4 v[72:75],v9,s[16:19],s66 offen offset:3072 nt
v_mfma_f32_16x16x32_bf16 a[128:131],v[128:131],v[56:59],a[128:131]
v_mfma_f32_16x16x32_bf16 a[132:135],v[132:135],v[56:59],a[132:135]
v_mfma_f32_16x16x32_bf16 a[136:139],v[136:139],v[56:59],a[136:139]
ds_write2st64_b64 v39,v[100:101],v[76:77] offset0:36 offset1:40
v_mfma_f32_16x16x32_bf16 a[140:143],v[140:143],v[56:59],a[140:143]
ds_read_b128 v[80:83],v10 offset:18432
v_accvgpr_read_b32 v108,a84
ds_read_b128 v[156:159],v10 offset:19456
v_accvgpr_read_b32 v88,a80
ds_read_b128 v[72:75],v10 offset:20480
v_accvgpr_read_b32 v89,a81
ds_read_b128 v[84:87],v10 offset:21504
v_pk_mul_f32 v[88:89],v[88:89],v[66:67] op_sel_hi:[1,0]
v_accvgpr_read_b32 v90,a82
v_accvgpr_read_b32 v91,a83
v_pk_mul_f32 v[90:91],v[90:91],v[66:67] op_sel_hi:[1,0]
v_accvgpr_read_b32 v104,a128
v_accvgpr_read_b32 v105,a129
v_pk_mul_f32 v[104:105],v[104:105],v[70:71] op_sel_hi:[1,0]
v_accvgpr_read_b32 v106,a130
v_accvgpr_read_b32 v107,a131
v_pk_mul_f32 v[106:107],v[106:107],v[70:71] op_sel_hi:[1,0]
v_accvgpr_read_b32 v109,a85
v_accvgpr_read_b32 v110,a86
v_mfma_f32_16x16x32_bf16 a[92:95],v[140:143],v[52:55],a[92:95]
v_accvgpr_read_b32 v111,a87
v_accvgpr_read_b32 v92,a132
v_accvgpr_read_b32 v93,a133
v_accvgpr_read_b32 v94,a134
v_accvgpr_read_b32 v95,a135
v_pk_mul_f32 v[108:109],v[108:109],v[66:67] op_sel_hi:[1,0]
s_waitcnt lgkmcnt(3)
buffer_store_dwordx4 v[80:83],v9,s[16:19],s87 offen offset:128 nt
v_pk_mul_f32 v[110:111],v[110:111],v[66:67] op_sel_hi:[1,0]
v_pk_mul_f32 v[92:93],v[92:93],v[70:71] op_sel_hi:[1,0]
v_pk_mul_f32 v[94:95],v[94:95],v[70:71] op_sel_hi:[1,0]
v_cvt_pk_bf16_f32 v88,v88,v89
v_cvt_pk_bf16_f32 v104,v104,v105
v_mfma_f32_16x16x32_bf16 a[88:91],v[136:139],v[52:55],a[88:91]
v_cvt_pk_bf16_f32 v89,v90,v91
v_cvt_pk_bf16_f32 v105,v106,v107
v_mfma_f32_16x16x32_bf16 a[40:43],v[136:139],v[48:51],a[40:43]
ds_write2st64_b64 v36,v[88:89],v[104:105] offset0:36 offset1:40
v_mfma_f32_16x16x32_bf16 a[44:47],v[140:143],v[48:51],a[44:47]
v_add_u32 v36,v36,v19
v_accvgpr_read_b32 v76,a136
v_mfma_f32_16x16x32_bf16 v[252:255],v[140:143],v[44:47],v[252:255]
s_waitcnt lgkmcnt(1)
buffer_store_dwordx4 v[156:159],v9,s[16:19],s87 offen offset:3200 nt
v_accvgpr_read_b32 v77,a137
v_accvgpr_read_b32 v96,a88
v_accvgpr_read_b32 v97,a89
v_pk_mul_f32 v[76:77],v[76:77],v[70:71] op_sel_hi:[1,0]
v_pk_mul_f32 v[96:97],v[96:97],v[66:67] op_sel_hi:[1,0]
v_pk_mul_f32 v[208:209],v[208:209],v[62:63] op_sel_hi:[1,0]
v_pk_mul_f32 v[224:225],v[224:225],v[62:63] op_sel_hi:[1,0]
v_pk_mul_f32 v[210:211],v[210:211],v[62:63] op_sel_hi:[1,0]
v_pk_mul_f32 v[226:227],v[226:227],v[62:63] op_sel_hi:[1,0]
v_pk_mul_f32 v[212:213],v[212:213],v[62:63] op_sel_hi:[1,0]
v_pk_mul_f32 v[228:229],v[228:229],v[62:63] op_sel_hi:[1,0]
buffer_store_dwordx4 v[72:75],v9,s[16:19],s66 offen offset:128 nt
v_pk_mul_f32 v[214:215],v[214:215],v[62:63] op_sel_hi:[1,0]
v_pk_mul_f32 v[230:231],v[230:231],v[62:63] op_sel_hi:[1,0]
v_pk_mul_f32 v[216:217],v[216:217],v[62:63] op_sel_hi:[1,0]
v_pk_mul_f32 v[232:233],v[232:233],v[62:63] op_sel_hi:[1,0]
v_pk_mul_f32 v[218:219],v[218:219],v[62:63] op_sel_hi:[1,0]
v_pk_mul_f32 v[234:235],v[234:235],v[62:63] op_sel_hi:[1,0]
v_pk_mul_f32 v[220:221],v[220:221],v[62:63] op_sel_hi:[1,0]
v_pk_mul_f32 v[236:237],v[236:237],v[62:63] op_sel_hi:[1,0]
v_pk_mul_f32 v[222:223],v[222:223],v[62:63] op_sel_hi:[1,0]
v_pk_mul_f32 v[238:239],v[238:239],v[62:63] op_sel_hi:[1,0]
v_pk_mul_f32 v[240:241],v[240:241],v[62:63] op_sel_hi:[1,0]
buffer_store_dwordx4 v[84:87],v9,s[16:19],s66 offen offset:3200 nt
v_pk_mul_f32 v[242:243],v[242:243],v[62:63] op_sel_hi:[1,0]
v_pk_mul_f32 v[244:245],v[244:245],v[62:63] op_sel_hi:[1,0]
v_pk_mul_f32 v[246:247],v[246:247],v[62:63] op_sel_hi:[1,0]
v_accvgpr_read_b32 v78,a138
v_accvgpr_read_b32 v79,a139
v_pk_mul_f32 v[78:79],v[78:79],v[70:71] op_sel_hi:[1,0]
v_accvgpr_read_b32 v100,a92
v_accvgpr_read_b32 v101,a93
v_pk_mul_f32 v[100:101],v[100:101],v[66:67] op_sel_hi:[1,0]
v_cvt_pk_bf16_f32 v108,v108,v109
v_cvt_pk_bf16_f32 v92,v92,v93
v_accvgpr_read_b32 v98,a90
v_accvgpr_read_b32 v99,a91
v_pk_mul_f32 v[98:99],v[98:99],v[66:67] op_sel_hi:[1,0]
v_accvgpr_read_b32 v88,a140
v_accvgpr_read_b32 v89,a141
v_pk_mul_f32 v[88:89],v[88:89],v[70:71] op_sel_hi:[1,0]
v_accvgpr_read_b32 v102,a94
v_accvgpr_read_b32 v103,a95
v_pk_mul_f32 v[102:103],v[102:103],v[66:67] op_sel_hi:[1,0]
v_accvgpr_read_b32 v90,a142
v_accvgpr_read_b32 v91,a143
v_pk_mul_f32 v[90:91],v[90:91],v[70:71] op_sel_hi:[1,0]
v_cvt_pk_bf16_f32 v76,v76,v77
v_cvt_pk_bf16_f32 v96,v96,v97
v_cvt_pk_bf16_f32 v109,v110,v111
v_cvt_pk_bf16_f32 v93,v94,v95
ds_write2st64_b64 v37,v[108:109],v[92:93] offset0:36 offset1:40
v_add_u32 v37,v37,v19
v_cvt_pk_bf16_f32 v100,v100,v101
v_cvt_pk_bf16_f32 v88,v88,v89
v_cvt_pk_bf16_f32 v77,v78,v79
v_cvt_pk_bf16_f32 v97,v98,v99
v_cvt_pk_bf16_f32 v101,v102,v103
v_cvt_pk_bf16_f32 v89,v90,v91
v_cvt_pk_bf16_f32 v208,v208,v209
v_cvt_pk_bf16_f32 v224,v224,v225
v_cvt_pk_bf16_f32 v212,v212,v213
v_cvt_pk_bf16_f32 v228,v228,v229
ds_write2st64_b64 v38,v[96:97],v[76:77] offset0:36 offset1:40
v_add_u32 v38,v38,v19
v_cvt_pk_bf16_f32 v209,v210,v211
v_cvt_pk_bf16_f32 v225,v226,v227
v_cvt_pk_bf16_f32 v216,v216,v217
v_cvt_pk_bf16_f32 v232,v232,v233
v_cvt_pk_bf16_f32 v213,v214,v215
v_cvt_pk_bf16_f32 v229,v230,v231
v_cvt_pk_bf16_f32 v220,v220,v221
v_cvt_pk_bf16_f32 v236,v236,v237
v_cvt_pk_bf16_f32 v217,v218,v219
v_cvt_pk_bf16_f32 v233,v234,v235
ds_write2st64_b64 v39,v[100:101],v[88:89] offset0:36 offset1:40
v_add_u32 v39,v39,v19
v_cvt_pk_bf16_f32 v221,v222,v223
v_cvt_pk_bf16_f32 v237,v238,v239
ds_read_b128 v[104:107],v10 offset:18432
v_accvgpr_read_b32 v98,a2
ds_read_b128 v[156:159],v10 offset:19456
v_accvgpr_read_b32 v99,a3
ds_read_b128 v[72:75],v10 offset:20480
v_pk_mul_f32 v[98:99],v[98:99],v[64:65] op_sel_hi:[1,0]
ds_read_b128 v[80:83],v10 offset:21504
v_accvgpr_read_b32 v90,a6
ds_write2st64_b64 v36,v[208:209],v[224:225] offset0:12 offset1:14
v_accvgpr_read_b32 v91,a7
v_pk_mul_f32 v[90:91],v[90:91],v[64:65] op_sel_hi:[1,0]
v_accvgpr_read_b32 v96,a0
v_accvgpr_read_b32 v97,a1
v_pk_mul_f32 v[96:97],v[96:97],v[64:65] op_sel_hi:[1,0]
v_accvgpr_read_b32 v88,a4
v_accvgpr_read_b32 v89,a5
v_pk_mul_f32 v[88:89],v[88:89],v[64:65] op_sel_hi:[1,0]
v_cvt_pk_bf16_f32 v240,v240,v241
v_accvgpr_read_b32 v100,a8
v_mfma_f32_16x16x32_bf16 v[248:251],v[136:139],v[44:47],v[248:251]
v_accvgpr_read_b32 v101,a9
v_cvt_pk_bf16_f32 v96,v96,v97
v_mfma_f32_16x16x32_bf16 v[200:203],v[136:139],v[40:43],v[200:203]
ds_write2st64_b64 v37,v[212:213],v[228:229] offset0:12 offset1:14
v_mfma_f32_16x16x32_bf16 v[204:207],v[140:143],v[40:43],v[204:207]
s_waitcnt lgkmcnt(2)
v_cvt_pk_bf16_f32 v244,v244,v245
buffer_store_dwordx4 v[104:107],v9,s[16:19],s87 offen offset:256 nt
v_pk_mul_f32 v[100:101],v[100:101],v[64:65] op_sel_hi:[1,0]
v_pk_mul_f32 v[248:249],v[248:249],v[62:63] op_sel_hi:[1,0]
v_pk_mul_f32 v[250:251],v[250:251],v[62:63] op_sel_hi:[1,0]
v_pk_mul_f32 v[252:253],v[252:253],v[62:63] op_sel_hi:[1,0]
v_pk_mul_f32 v[254:255],v[254:255],v[62:63] op_sel_hi:[1,0]
v_pk_mul_f32 v[160:161],v[160:161],v[60:61] op_sel_hi:[1,0]
v_pk_mul_f32 v[176:177],v[176:177],v[60:61] op_sel_hi:[1,0]
v_pk_mul_f32 v[162:163],v[162:163],v[60:61] op_sel_hi:[1,0]
v_pk_mul_f32 v[178:179],v[178:179],v[60:61] op_sel_hi:[1,0]
ds_write2st64_b64 v38,v[216:217],v[232:233] offset0:12 offset1:14
v_pk_mul_f32 v[164:165],v[164:165],v[60:61] op_sel_hi:[1,0]
v_pk_mul_f32 v[180:181],v[180:181],v[60:61] op_sel_hi:[1,0]
v_pk_mul_f32 v[166:167],v[166:167],v[60:61] op_sel_hi:[1,0]
buffer_store_dwordx4 v[156:159],v9,s[16:19],s87 offen offset:3328 nt
v_pk_mul_f32 v[182:183],v[182:183],v[60:61] op_sel_hi:[1,0]
v_pk_mul_f32 v[168:169],v[168:169],v[60:61] op_sel_hi:[1,0]
v_pk_mul_f32 v[184:185],v[184:185],v[60:61] op_sel_hi:[1,0]
v_pk_mul_f32 v[170:171],v[170:171],v[60:61] op_sel_hi:[1,0]
v_pk_mul_f32 v[186:187],v[186:187],v[60:61] op_sel_hi:[1,0]
v_pk_mul_f32 v[172:173],v[172:173],v[60:61] op_sel_hi:[1,0]
v_pk_mul_f32 v[188:189],v[188:189],v[60:61] op_sel_hi:[1,0]
v_pk_mul_f32 v[174:175],v[174:175],v[60:61] op_sel_hi:[1,0]
v_pk_mul_f32 v[190:191],v[190:191],v[60:61] op_sel_hi:[1,0]
ds_write2st64_b64 v39,v[220:221],v[236:237] offset0:12 offset1:14
v_pk_mul_f32 v[192:193],v[192:193],v[60:61] op_sel_hi:[1,0]
v_pk_mul_f32 v[194:195],v[194:195],v[60:61] op_sel_hi:[1,0]
v_pk_mul_f32 v[196:197],v[196:197],v[60:61] op_sel_hi:[1,0]
ds_read_b128 v[84:87],v10 offset:6144
buffer_store_dwordx4 v[72:75],v9,s[16:19],s66 offen offset:256 nt
ds_read_b128 v[92:95],v10 offset:9216
v_pk_mul_f32 v[198:199],v[198:199],v[60:61] op_sel_hi:[1,0]
ds_read_b128 v[108:111],v10 offset:7168
v_pk_mul_f32 v[200:201],v[200:201],v[60:61] op_sel_hi:[1,0]
ds_read_b128 v[76:79],v10 offset:10240
v_pk_mul_f32 v[202:203],v[202:203],v[60:61] op_sel_hi:[1,0]
buffer_store_dwordx4 v[80:83],v9,s[16:19],s66 offen offset:3328 nt
v_pk_mul_f32 v[204:205],v[204:205],v[60:61] op_sel_hi:[1,0]
v_pk_mul_f32 v[206:207],v[206:207],v[60:61] op_sel_hi:[1,0]
v_accvgpr_read_b32 v102,a10
v_accvgpr_read_b32 v103,a11
v_pk_mul_f32 v[102:103],v[102:103],v[64:65] op_sel_hi:[1,0]
v_accvgpr_read_b32 v208,a12
v_accvgpr_read_b32 v209,a13
v_pk_mul_f32 v[208:209],v[208:209],v[64:65] op_sel_hi:[1,0]
v_cvt_pk_bf16_f32 v88,v88,v89
v_cvt_pk_bf16_f32 v241,v242,v243
v_cvt_pk_bf16_f32 v97,v98,v99
ds_write2st64_b64 v36,v[240:241],v[96:97] offset0:16 offset1:24
v_accvgpr_read_b32 v210,a14
v_accvgpr_read_b32 v211,a15
v_pk_mul_f32 v[210:211],v[210:211],v[64:65] op_sel_hi:[1,0]
s_waitcnt lgkmcnt(3)
buffer_store_dwordx4 v[84:87],v9,s[16:19],s85 offen offset:0 nt
v_cvt_pk_bf16_f32 v245,v246,v247
v_cvt_pk_bf16_f32 v100,v100,v101
v_cvt_pk_bf16_f32 v248,v248,v249
v_cvt_pk_bf16_f32 v89,v90,v91
v_cvt_pk_bf16_f32 v252,v252,v253
v_cvt_pk_bf16_f32 v208,v208,v209
v_cvt_pk_bf16_f32 v101,v102,v103
v_cvt_pk_bf16_f32 v249,v250,v251
v_cvt_pk_bf16_f32 v253,v254,v255
ds_write2st64_b64 v37,v[244:245],v[88:89] offset0:16 offset1:24
v_cvt_pk_bf16_f32 v209,v210,v211
v_accvgpr_read_b32 v212,a32
v_accvgpr_read_b32 v213,a33
buffer_store_dwordx4 v[92:95],v9,s[16:19],s85 offen offset:3072 nt
v_pk_mul_f32 v[212:213],v[212:213],v[64:65] op_sel_hi:[1,0]
v_accvgpr_read_b32 v104,a16
v_accvgpr_read_b32 v105,a17
v_pk_mul_f32 v[104:105],v[104:105],v[64:65] op_sel_hi:[1,0]
v_accvgpr_read_b32 v214,a34
v_accvgpr_read_b32 v215,a35
v_pk_mul_f32 v[214:215],v[214:215],v[64:65] op_sel_hi:[1,0]
v_accvgpr_read_b32 v228,a20
v_accvgpr_read_b32 v229,a21
ds_write2st64_b64 v38,v[248:249],v[100:101] offset0:16 offset1:24
v_pk_mul_f32 v[228:229],v[228:229],v[64:65] op_sel_hi:[1,0]
v_accvgpr_read_b32 v106,a18
v_accvgpr_read_b32 v107,a19
s_waitcnt lgkmcnt(2)
buffer_store_dwordx4 v[108:111],v9,s[16:19],s85 offen offset:128 nt
v_pk_mul_f32 v[106:107],v[106:107],v[64:65] op_sel_hi:[1,0]
v_accvgpr_read_b32 v216,a36
v_accvgpr_read_b32 v217,a37
v_pk_mul_f32 v[216:217],v[216:217],v[64:65] op_sel_hi:[1,0]
v_accvgpr_read_b32 v230,a22
v_accvgpr_read_b32 v231,a23
v_pk_mul_f32 v[230:231],v[230:231],v[64:65] op_sel_hi:[1,0]
v_accvgpr_read_b32 v218,a38
v_accvgpr_read_b32 v219,a39
ds_write2st64_b64 v39,v[252:253],v[208:209] offset0:16 offset1:24
v_pk_mul_f32 v[218:219],v[218:219],v[64:65] op_sel_hi:[1,0]
v_accvgpr_read_b32 v232,a24
v_accvgpr_read_b32 v233,a25
ds_read_b128 v[224:227],v10 offset:8192
buffer_store_dwordx4 v[76:79],v9,s[16:19],s85 offen offset:3200 nt
ds_read_b128 v[156:159],v10 offset:11264
v_pk_mul_f32 v[232:233],v[232:233],v[64:65] op_sel_hi:[1,0]
ds_read_b128 v[72:75],v10 offset:12288
v_accvgpr_read_b32 v220,a40
ds_read_b128 v[80:83],v10 offset:15360
v_accvgpr_read_b32 v221,a41
v_pk_mul_f32 v[220:221],v[220:221],v[64:65] op_sel_hi:[1,0]
v_cvt_pk_bf16_f32 v212,v212,v213
v_cvt_pk_bf16_f32 v104,v104,v105
v_accvgpr_read_b32 v234,a26
v_accvgpr_read_b32 v235,a27
v_pk_mul_f32 v[234:235],v[234:235],v[64:65] op_sel_hi:[1,0]
v_accvgpr_read_b32 v222,a42
v_accvgpr_read_b32 v223,a43
v_pk_mul_f32 v[222:223],v[222:223],v[64:65] op_sel_hi:[1,0]
v_accvgpr_read_b32 v236,a28
v_accvgpr_read_b32 v237,a29
v_pk_mul_f32 v[236:237],v[236:237],v[64:65] op_sel_hi:[1,0]
v_accvgpr_read_b32 v96,a44
v_accvgpr_read_b32 v97,a45
v_pk_mul_f32 v[96:97],v[96:97],v[64:65] op_sel_hi:[1,0]
v_cvt_pk_bf16_f32 v228,v228,v229
v_cvt_pk_bf16_f32 v216,v216,v217
v_cvt_pk_bf16_f32 v213,v214,v215
v_cvt_pk_bf16_f32 v105,v106,v107
ds_write2st64_b64 v36,v[104:105],v[212:213] offset0:26 offset1:28
v_accvgpr_read_b32 v238,a30
v_accvgpr_read_b32 v239,a31
v_pk_mul_f32 v[238:239],v[238:239],v[64:65] op_sel_hi:[1,0]
s_waitcnt lgkmcnt(2)
buffer_store_dwordx4 v[224:227],v9,s[16:19],s85 offen offset:256 nt
v_accvgpr_read_b32 v98,a46
v_accvgpr_read_b32 v99,a47
v_pk_mul_f32 v[98:99],v[98:99],v[64:65] op_sel_hi:[1,0]
v_cvt_pk_bf16_f32 v232,v232,v233
v_cvt_pk_bf16_f32 v220,v220,v221
v_cvt_pk_bf16_f32 v229,v230,v231
v_cvt_pk_bf16_f32 v217,v218,v219
v_cvt_pk_bf16_f32 v236,v236,v237
v_cvt_pk_bf16_f32 v96,v96,v97
ds_write2st64_b64 v37,v[228:229],v[216:217] offset0:26 offset1:28
v_cvt_pk_bf16_f32 v233,v234,v235
v_cvt_pk_bf16_f32 v221,v222,v223
v_cvt_pk_bf16_f32 v237,v238,v239
buffer_store_dwordx4 v[156:159],v9,s[16:19],s85 offen offset:3328 nt
v_cvt_pk_bf16_f32 v97,v98,v99
v_cvt_pk_bf16_f32 v160,v160,v161
v_cvt_pk_bf16_f32 v176,v176,v177
v_cvt_pk_bf16_f32 v164,v164,v165
v_cvt_pk_bf16_f32 v180,v180,v181
v_cvt_pk_bf16_f32 v161,v162,v163
v_cvt_pk_bf16_f32 v177,v178,v179
v_cvt_pk_bf16_f32 v168,v168,v169
v_cvt_pk_bf16_f32 v184,v184,v185
ds_write2st64_b64 v38,v[232:233],v[220:221] offset0:26 offset1:28
v_cvt_pk_bf16_f32 v165,v166,v167
v_cvt_pk_bf16_f32 v181,v182,v183
v_cvt_pk_bf16_f32 v172,v172,v173
buffer_store_dwordx4 v[72:75],v9,s[16:19],s86 offen offset:0 nt
v_cvt_pk_bf16_f32 v188,v188,v189
v_cvt_pk_bf16_f32 v169,v170,v171
v_cvt_pk_bf16_f32 v185,v186,v187
v_cvt_pk_bf16_f32 v173,v174,v175
v_cvt_pk_bf16_f32 v189,v190,v191
v_cvt_pk_bf16_f32 v192,v192,v193
v_cvt_pk_bf16_f32 v196,v196,v197
v_cvt_pk_bf16_f32 v193,v194,v195
v_cvt_pk_bf16_f32 v200,v200,v201
ds_write2st64_b64 v39,v[236:237],v[96:97] offset0:26 offset1:28
v_cvt_pk_bf16_f32 v197,v198,v199
v_cvt_pk_bf16_f32 v204,v204,v205
v_cvt_pk_bf16_f32 v201,v202,v203
ds_read_b128 v[240:243],v10 offset:13312
s_waitcnt lgkmcnt(3)
buffer_store_dwordx4 v[80:83],v9,s[16:19],s86 offen offset:3072 nt
ds_read_b128 v[76:79],v10 offset:16384
v_cvt_pk_bf16_f32 v205,v206,v207
ds_read_b128 v[84:87],v10 offset:14336
ds_read_b128 v[88:91],v10 offset:17408
ds_write2st64_b64 v36,v[160:161],v[176:177] offset0:0 offset1:2
ds_write2st64_b64 v37,v[164:165],v[180:181] offset0:0 offset1:2
s_waitcnt lgkmcnt(3)
buffer_store_dwordx4 v[240:243],v9,s[16:19],s86 offen offset:128 nt
ds_write2st64_b64 v38,v[168:169],v[184:185] offset0:0 offset1:2
buffer_store_dwordx4 v[76:79],v9,s[16:19],s86 offen offset:3200 nt
ds_write2st64_b64 v39,v[172:173],v[188:189] offset0:0 offset1:2
ds_read_b128 v[92:95],v10 offset:0
buffer_store_dwordx4 v[84:87],v9,s[16:19],s86 offen offset:256 nt
ds_read_b128 v[108:111],v10 offset:3072
ds_read_b128 v[244:247],v10 offset:1024
ds_read_b128 v[100:103],v10 offset:4096
ds_write_b64 v36,v[192:193] offset:2048
s_waitcnt lgkmcnt(6)
buffer_store_dwordx4 v[88:91],v9,s[16:19],s86 offen offset:3328 nt
ds_write_b64 v37,v[196:197] offset:2048
s_waitcnt lgkmcnt(5)
buffer_store_dwordx4 v[92:95],v9,s[16:19],s84 offen offset:0 nt
ds_write_b64 v38,v[200:201] offset:2048
s_waitcnt lgkmcnt(2)
buffer_store_dwordx4 v[108:111],v9,s[16:19],s84 offen offset:3072 nt
ds_write_b64 v39,v[204:205] offset:2048
ds_read_b128 v[248:251],v10 offset:2048
buffer_store_dwordx4 v[244:247],v9,s[16:19],s84 offen offset:128 nt
ds_read_b128 v[208:211],v10 offset:5120
buffer_store_dwordx4 v[100:103],v9,s[16:19],s84 offen offset:3200 nt
s_waitcnt lgkmcnt(1)
buffer_store_dwordx4 v[248:251],v9,s[16:19],s84 offen offset:256 nt
s_waitcnt lgkmcnt(0)
buffer_store_dwordx4 v[208:211],v9,s[16:19],s84 offen offset:3328 nt
s_branch L_fin
L_end4:
s_waitcnt lgkmcnt(4)
v_mfma_f32_16x16x32_bf16 v[160:163],v[112:115],v[20:23],v[160:163]
ds_read_b64_tr_b16 v[128:129],v2 offset:24704
v_fma_f32 v82,v82,s36,v14
v_mfma_f32_16x16x32_bf16 v[164:167],v[116:119],v[20:23],v[164:167]
ds_read_b64_tr_b16 v[130:131],v2 offset:30848
v_fma_f32 v83,v83,s36,v14
v_mfma_f32_16x16x32_bf16 v[212:215],v[116:119],v[24:27],v[212:215]
ds_read_b64_tr_b16 v[132:133],v3 offset:24704
v_fma_f32 v88,v88,s36,v15
v_mfma_f32_16x16x32_bf16 v[208:211],v[112:115],v[24:27],v[208:211]
ds_read_b64_tr_b16 v[134:135],v3 offset:30848
v_fma_f32 v89,v89,s36,v15
v_mfma_f32_16x16x32_bf16 a[0:3],v[112:115],v[28:31],a[0:3]
ds_read_b64_tr_b16 v[136:137],v4 offset:24704
v_fma_f32 v90,v90,s36,v15
v_mfma_f32_16x16x32_bf16 a[4:7],v[116:119],v[28:31],a[4:7]
ds_read_b64_tr_b16 v[138:139],v4 offset:30848
ds_read_b64_tr_b16 v[140:141],v5 offset:24704
ds_read_b64_tr_b16 v[142:143],v5 offset:30848
v_mfma_f32_16x16x32_bf16 a[52:55],v[116:119],v[32:35],a[52:55]
ds_read_b64_tr_b16 v[116:117],v3 offset:24832
v_fma_f32 v91,v91,s36,v15
v_mfma_f32_16x16x32_bf16 a[48:51],v[112:115],v[32:35],a[48:51]
s_waitcnt lgkmcnt(9)
ds_read_b64_tr_b16 v[112:113],v2 offset:24832
v_fma_f32 v96,v96,s36,v16
v_mfma_f32_16x16x32_bf16 a[56:59],v[120:123],v[32:35],a[56:59]
ds_read_b64_tr_b16 v[114:115],v2 offset:30976
v_fma_f32 v97,v97,s36,v16
v_mfma_f32_16x16x32_bf16 a[60:63],v[124:127],v[32:35],a[60:63]
ds_read_b64_tr_b16 v[118:119],v3 offset:30976
v_fma_f32 v98,v98,s36,v16
v_mfma_f32_16x16x32_bf16 a[12:15],v[124:127],v[28:31],a[12:15]
v_fma_f32 v99,v99,s36,v16
v_fma_f32 v76,v76,s36,v13
v_mfma_f32_16x16x32_bf16 a[8:11],v[120:123],v[28:31],a[8:11]
v_fma_f32 v77,v77,s36,v13
v_fma_f32 v78,v78,s36,v13
v_mfma_f32_16x16x32_bf16 v[216:219],v[120:123],v[24:27],v[216:219]
v_fma_f32 v79,v79,s36,v13
v_fma_f32 v84,v84,s36,v14
v_mfma_f32_16x16x32_bf16 v[220:223],v[124:127],v[24:27],v[220:223]
v_fma_f32 v85,v85,s36,v14
v_fma_f32 v86,v86,s36,v14
v_mfma_f32_16x16x32_bf16 v[172:175],v[124:127],v[20:23],v[172:175]
ds_read_b64_tr_b16 v[124:125],v5 offset:24832
v_fma_f32 v87,v87,s36,v14
v_mfma_f32_16x16x32_bf16 v[168:171],v[120:123],v[20:23],v[168:171]
s_waitcnt lgkmcnt(3)
ds_read_b64_tr_b16 v[120:121],v4 offset:24832
v_fma_f32 v92,v92,s36,v15
v_mfma_f32_16x16x32_bf16 v[176:179],v[128:131],v[20:23],v[176:179]
ds_read_b64_tr_b16 v[122:123],v4 offset:30976
v_fma_f32 v93,v93,s36,v15
v_mfma_f32_16x16x32_bf16 v[180:183],v[132:135],v[20:23],v[180:183]
ds_read_b64_tr_b16 v[126:127],v5 offset:30976
v_fma_f32 v94,v94,s36,v15
v_mfma_f32_16x16x32_bf16 v[228:231],v[132:135],v[24:27],v[228:231]
v_fma_f32 v95,v95,s36,v15
v_fma_f32 v100,v100,s36,v16
v_mfma_f32_16x16x32_bf16 v[224:227],v[128:131],v[24:27],v[224:227]
v_fma_f32 v101,v101,s36,v16
v_fma_f32 v102,v102,s36,v16
v_mfma_f32_16x16x32_bf16 a[16:19],v[128:131],v[28:31],a[16:19]
v_fma_f32 v103,v103,s36,v16
v_exp_f32 v82,v82
v_mfma_f32_16x16x32_bf16 a[20:23],v[132:135],v[28:31],a[20:23]
v_exp_f32 v83,v83
v_mfma_f32_16x16x32_bf16 a[68:71],v[132:135],v[32:35],a[68:71]
v_exp_f32 v88,v88
v_mfma_f32_16x16x32_bf16 a[64:67],v[128:131],v[32:35],a[64:67]
v_exp_f32 v89,v89
v_mfma_f32_16x16x32_bf16 a[72:75],v[136:139],v[32:35],a[72:75]
v_exp_f32 v90,v90
v_mfma_f32_16x16x32_bf16 a[76:79],v[140:143],v[32:35],a[76:79]
v_exp_f32 v91,v91
v_mfma_f32_16x16x32_bf16 a[28:31],v[140:143],v[28:31],a[28:31]
v_exp_f32 v96,v96
v_mfma_f32_16x16x32_bf16 a[24:27],v[136:139],v[28:31],a[24:27]
v_exp_f32 v97,v97
v_mfma_f32_16x16x32_bf16 v[232:235],v[136:139],v[24:27],v[232:235]
v_exp_f32 v98,v98
v_mfma_f32_16x16x32_bf16 v[236:239],v[140:143],v[24:27],v[236:239]
v_exp_f32 v99,v99
v_mfma_f32_16x16x32_bf16 v[188:191],v[140:143],v[20:23],v[188:191]
v_exp_f32 v76,v76
v_mfma_f32_16x16x32_bf16 v[184:187],v[136:139],v[20:23],v[184:187]
s_waitcnt lgkmcnt(0)
v_exp_f32 v77,v77
v_mfma_f32_16x16x32_bf16 v[192:195],v[112:115],v[20:23],v[192:195]
v_exp_f32 v78,v78
v_mfma_f32_16x16x32_bf16 v[196:199],v[116:119],v[20:23],v[196:199]
v_exp_f32 v79,v79
v_mfma_f32_16x16x32_bf16 v[244:247],v[116:119],v[24:27],v[244:247]
v_exp_f32 v84,v84
v_mfma_f32_16x16x32_bf16 v[240:243],v[112:115],v[24:27],v[240:243]
v_exp_f32 v85,v85
v_mfma_f32_16x16x32_bf16 a[32:35],v[112:115],v[28:31],a[32:35]
v_exp_f32 v86,v86
v_mfma_f32_16x16x32_bf16 a[36:39],v[116:119],v[28:31],a[36:39]
v_exp_f32 v87,v87
v_mfma_f32_16x16x32_bf16 a[84:87],v[116:119],v[32:35],a[84:87]
v_exp_f32 v92,v92
s_waitcnt vmcnt(14)
s_barrier
v_mfma_f32_16x16x32_bf16 a[80:83],v[112:115],v[32:35],a[80:83]
v_exp_f32 v93,v93
v_mfma_f32_16x16x32_bf16 a[88:91],v[120:123],v[32:35],a[88:91]
v_exp_f32 v94,v94
v_mfma_f32_16x16x32_bf16 a[92:95],v[124:127],v[32:35],a[92:95]
v_exp_f32 v95,v95
v_mfma_f32_16x16x32_bf16 a[44:47],v[124:127],v[28:31],a[44:47]
v_exp_f32 v100,v100
v_mfma_f32_16x16x32_bf16 a[40:43],v[120:123],v[28:31],a[40:43]
v_exp_f32 v101,v101
v_mfma_f32_16x16x32_bf16 v[248:251],v[120:123],v[24:27],v[248:251]
v_exp_f32 v102,v102
v_mfma_f32_16x16x32_bf16 v[252:255],v[124:127],v[24:27],v[252:255]
v_exp_f32 v103,v103
v_mfma_f32_16x16x32_bf16 v[204:207],v[124:127],v[20:23],v[204:207]
v_cvt_pk_bf16_f32 v45,v82,v83
v_cvt_pk_bf16_f32 v48,v88,v89
v_mfma_f32_16x16x32_bf16 v[200:203],v[120:123],v[20:23],v[200:203]
v_cvt_pk_bf16_f32 v49,v90,v91
v_cvt_pk_bf16_f32 v52,v96,v97
v_cvt_pk_bf16_f32 v53,v98,v99
v_cvt_pk_bf16_f32 v42,v76,v77
v_cvt_pk_bf16_f32 v43,v78,v79
v_cvt_pk_bf16_f32 v46,v84,v85
v_cvt_pk_bf16_f32 v47,v86,v87
v_cvt_pk_bf16_f32 v50,v92,v93
v_cvt_pk_bf16_f32 v51,v94,v95
v_smfmac_f32_16x16x64_bf16 v[60:63],v[152:155],v[40:47],v18
ds_read_b64_tr_b16 v[128:129],v2 offset:0
ds_read_b64_tr_b16 v[130:131],v2 offset:6144
v_cvt_pk_bf16_f32 v54,v100,v101
v_cvt_pk_bf16_f32 v55,v102,v103
v_subrev_u32 v10,18432,v10
ds_read_b64_tr_b16 v[132:133],v3 offset:0
v_smfmac_f32_16x16x64_bf16 v[64:67],v[152:155],v[48:55],v18
ds_read_b64_tr_b16 v[134:135],v3 offset:6144
ds_read_b64_tr_b16 v[136:137],v4 offset:0
ds_read_b64_tr_b16 v[138:139],v4 offset:6144
ds_read_b64_tr_b16 v[140:141],v5 offset:0
ds_read_b64_tr_b16 v[142:143],v5 offset:6144
s_waitcnt lgkmcnt(6)
v_mfma_f32_16x16x32_bf16 v[160:163],v[128:131],v[40:43],v[160:163]
s_waitcnt vmcnt(6)
ds_read_b64_tr_b16 v[112:113],v2 offset:128
v_mbcnt_lo_u32_b32 v39,-1,0
s_waitcnt lgkmcnt(5)
v_mfma_f32_16x16x32_bf16 v[164:167],v[132:135],v[40:43],v[164:167]
s_add_u32 s84,s42,0
ds_read_b64_tr_b16 v[114:115],v2 offset:6272
v_mbcnt_hi_u32_b32 v39,-1,v39
v_mfma_f32_16x16x32_bf16 v[212:215],v[132:135],v[44:47],v[212:215]
s_add_u32 s85,s42,6144
ds_read_b64_tr_b16 v[116:117],v3 offset:128
v_and_b32 v38,7,v39
v_mfma_f32_16x16x32_bf16 v[208:211],v[128:131],v[44:47],v[208:211]
s_add_u32 s86,s42,12288
ds_read_b64_tr_b16 v[118:119],v3 offset:6272
v_add_f32 v60,v60,v61
v_mfma_f32_16x16x32_bf16 a[0:3],v[128:131],v[48:51],a[0:3]
s_add_u32 s87,s42,18432
ds_read_b64_tr_b16 v[120:121],v4 offset:128
v_add_f32 v62,v62,v63
v_mfma_f32_16x16x32_bf16 a[4:7],v[132:135],v[48:51],a[4:7]
ds_read_b64_tr_b16 v[122:123],v4 offset:6272
ds_read_b64_tr_b16 v[124:125],v5 offset:128
ds_read_b64_tr_b16 v[126:127],v5 offset:6272
v_mfma_f32_16x16x32_bf16 a[52:55],v[132:135],v[52:55],a[52:55]
ds_read_b64_tr_b16 v[132:133],v3 offset:256
v_add_f32 v64,v64,v65
v_mfma_f32_16x16x32_bf16 a[48:51],v[128:131],v[52:55],a[48:51]
s_waitcnt lgkmcnt(9)
ds_read_b64_tr_b16 v[128:129],v2 offset:256
v_add_f32 v66,v66,v67
v_mfma_f32_16x16x32_bf16 a[56:59],v[136:139],v[52:55],a[56:59]
ds_read_b64_tr_b16 v[130:131],v2 offset:6400
v_max3_f32 v19,v60,v62,v64
v_mfma_f32_16x16x32_bf16 a[60:63],v[140:143],v[52:55],a[60:63]
ds_read_b64_tr_b16 v[134:135],v3 offset:6400
v_max_f32 v19,v19,v66
v_mfma_f32_16x16x32_bf16 a[12:15],v[140:143],v[48:51],a[12:15]
v_rcp_f32 v66,v66
v_mfma_f32_16x16x32_bf16 a[8:11],v[136:139],v[48:51],a[8:11]
v_accvgpr_read_b32 v80,a52
v_accvgpr_read_b32 v81,a53
v_mfma_f32_16x16x32_bf16 v[216:219],v[136:139],v[44:47],v[216:219]
v_accvgpr_read_b32 v82,a54
v_accvgpr_read_b32 v83,a55
v_mfma_f32_16x16x32_bf16 v[220:223],v[140:143],v[44:47],v[220:223]
v_accvgpr_read_b32 v72,a48
v_accvgpr_read_b32 v73,a49
v_mfma_f32_16x16x32_bf16 v[172:175],v[140:143],v[40:43],v[172:175]
ds_read_b64_tr_b16 v[140:141],v5 offset:256
v_accvgpr_read_b32 v74,a50
v_mfma_f32_16x16x32_bf16 v[168:171],v[136:139],v[40:43],v[168:171]
s_waitcnt lgkmcnt(3)
ds_read_b64_tr_b16 v[136:137],v4 offset:256
v_accvgpr_read_b32 v75,a51
v_mfma_f32_16x16x32_bf16 v[176:179],v[112:115],v[40:43],v[176:179]
ds_read_b64_tr_b16 v[138:139],v4 offset:6400
v_accvgpr_read_b32 v88,a56
v_mfma_f32_16x16x32_bf16 v[180:183],v[116:119],v[40:43],v[180:183]
ds_read_b64_tr_b16 v[142:143],v5 offset:6400
v_accvgpr_read_b32 v89,a57
v_mfma_f32_16x16x32_bf16 v[228:231],v[116:119],v[44:47],v[228:231]
v_accvgpr_read_b32 v90,a58
v_accvgpr_read_b32 v91,a59
v_mfma_f32_16x16x32_bf16 v[224:227],v[112:115],v[44:47],v[224:227]
v_accvgpr_read_b32 v96,a60
v_accvgpr_read_b32 v97,a61
v_mfma_f32_16x16x32_bf16 a[16:19],v[112:115],v[48:51],a[16:19]
v_accvgpr_read_b32 v98,a62
v_accvgpr_read_b32 v99,a63
v_mfma_f32_16x16x32_bf16 a[20:23],v[116:119],v[48:51],a[20:23]
v_cmp_ngt_f32 vcc,s37,v19
v_lshrrev_b32 v19,5,v39
v_mfma_f32_16x16x32_bf16 a[68:71],v[116:119],v[52:55],a[68:71]
v_xor_b32 v38,v38,v19
v_and_b32 v19,15,v39
v_mfma_f32_16x16x32_bf16 a[64:67],v[112:115],v[52:55],a[64:67]
s_cmp_lg_u64 vcc,0
v_lshl_add_u32 v19,v19,7,s24
v_lshl_add_u32 v19,v38,4,v19
v_mfma_f32_16x16x32_bf16 a[72:75],v[120:123],v[52:55],a[72:75]
s_cselect_b32 s62,s32,0
v_bfe_u32 v38,v39,4,1
v_lshl_add_u32 v36,v38,3,v19
v_mfma_f32_16x16x32_bf16 a[76:79],v[124:127],v[52:55],a[76:79]
s_or_b32 s31,s31,s62
v_xor_b32 v37,32,v36
v_bfe_u32 v19,v39,3,1
v_mfma_f32_16x16x32_bf16 a[28:31],v[124:127],v[48:51],a[28:31]
s_lshl_b32 s32,s32,1
v_xor_b32 v38,64,v36
v_xor_b32 v39,96,v36
v_lshlrev_b32 v19,11,v19
v_accvgpr_read_b32 v84,a68
v_accvgpr_read_b32 v85,a69
v_pk_mul_f32 v[72:73],v[72:73],v[66:67] op_sel_hi:[1,0]
v_pk_mul_f32 v[74:75],v[74:75],v[66:67] op_sel_hi:[1,0]
v_pk_mul_f32 v[80:81],v[80:81],v[66:67] op_sel_hi:[1,0]
v_pk_mul_f32 v[82:83],v[82:83],v[66:67] op_sel_hi:[1,0]
v_pk_mul_f32 v[84:85],v[84:85],v[66:67] op_sel_hi:[1,0]
v_accvgpr_read_b32 v86,a70
v_accvgpr_read_b32 v87,a71
v_pk_mul_f32 v[86:87],v[86:87],v[66:67] op_sel_hi:[1,0]
v_accvgpr_read_b32 v76,a64
v_accvgpr_read_b32 v77,a65
v_pk_mul_f32 v[76:77],v[76:77],v[66:67] op_sel_hi:[1,0]
v_accvgpr_read_b32 v78,a66
v_accvgpr_read_b32 v79,a67
v_pk_mul_f32 v[78:79],v[78:79],v[66:67] op_sel_hi:[1,0]
v_accvgpr_read_b32 v92,a72
v_accvgpr_read_b32 v93,a73
v_mfma_f32_16x16x32_bf16 a[24:27],v[120:123],v[48:51],a[24:27]
v_accvgpr_read_b32 v94,a74
v_accvgpr_read_b32 v95,a75
v_accvgpr_read_b32 v100,a76
v_accvgpr_read_b32 v101,a77
v_accvgpr_read_b32 v102,a78
v_pk_mul_f32 v[88:89],v[88:89],v[66:67] op_sel_hi:[1,0]
v_pk_mul_f32 v[90:91],v[90:91],v[66:67] op_sel_hi:[1,0]
v_pk_mul_f32 v[92:93],v[92:93],v[66:67] op_sel_hi:[1,0]
v_pk_mul_f32 v[94:95],v[94:95],v[66:67] op_sel_hi:[1,0]
v_accvgpr_read_b32 v103,a79
v_cvt_pk_bf16_f32 v72,v72,v73
v_mfma_f32_16x16x32_bf16 v[232:235],v[120:123],v[44:47],v[232:235]
v_cvt_pk_bf16_f32 v76,v76,v77
v_cvt_pk_bf16_f32 v80,v80,v81
v_cvt_pk_bf16_f32 v84,v84,v85
v_cvt_pk_bf16_f32 v73,v74,v75
v_cvt_pk_bf16_f32 v77,v78,v79
ds_write2st64_b64 v36,v[72:73],v[76:77] offset0:36 offset1:40
v_pk_mul_f32 v[96:97],v[96:97],v[66:67] op_sel_hi:[1,0]
v_pk_mul_f32 v[98:99],v[98:99],v[66:67] op_sel_hi:[1,0]
v_pk_mul_f32 v[100:101],v[100:101],v[66:67] op_sel_hi:[1,0]
v_pk_mul_f32 v[102:103],v[102:103],v[66:67] op_sel_hi:[1,0]
v_cvt_pk_bf16_f32 v88,v88,v89
v_cvt_pk_bf16_f32 v92,v92,v93
v_mfma_f32_16x16x32_bf16 v[236:239],v[124:127],v[44:47],v[236:239]
v_cvt_pk_bf16_f32 v81,v82,v83
v_cvt_pk_bf16_f32 v85,v86,v87
v_mfma_f32_16x16x32_bf16 v[188:191],v[124:127],v[40:43],v[188:191]
v_cvt_pk_bf16_f32 v96,v96,v97
v_cvt_pk_bf16_f32 v100,v100,v101
v_mfma_f32_16x16x32_bf16 v[184:187],v[120:123],v[40:43],v[184:187]
s_waitcnt lgkmcnt(1)
ds_write2st64_b64 v37,v[80:81],v[84:85] offset0:36 offset1:40
v_mfma_f32_16x16x32_bf16 v[192:195],v[128:131],v[40:43],v[192:195]
v_cvt_pk_bf16_f32 v89,v90,v91
v_cvt_pk_bf16_f32 v93,v94,v95
v_mfma_f32_16x16x32_bf16 v[196:199],v[132:135],v[40:43],v[196:199]
v_cvt_pk_bf16_f32 v97,v98,v99
v_cvt_pk_bf16_f32 v101,v102,v103
v_mfma_f32_16x16x32_bf16 v[244:247],v[132:135],v[44:47],v[244:247]
v_rcp_f32 v62,v62
v_mfma_f32_16x16x32_bf16 v[240:243],v[128:131],v[44:47],v[240:243]
ds_write2st64_b64 v38,v[88:89],v[92:93] offset0:36 offset1:40
v_mfma_f32_16x16x32_bf16 a[32:35],v[128:131],v[48:51],a[32:35]
v_rcp_f32 v64,v64
v_mfma_f32_16x16x32_bf16 a[36:39],v[132:135],v[48:51],a[36:39]
v_rcp_f32 v60,v60
v_mfma_f32_16x16x32_bf16 a[84:87],v[132:135],v[52:55],a[84:87]
v_mfma_f32_16x16x32_bf16 a[80:83],v[128:131],v[52:55],a[80:83]
ds_write2st64_b64 v39,v[96:97],v[100:101] offset0:36 offset1:40
v_mfma_f32_16x16x32_bf16 a[88:91],v[136:139],v[52:55],a[88:91]
v_mfma_f32_16x16x32_bf16 a[92:95],v[140:143],v[52:55],a[92:95]
ds_read_b128 v[156:159],v10 offset:18432
v_mfma_f32_16x16x32_bf16 a[44:47],v[140:143],v[48:51],a[44:47]
ds_read_b128 v[104:107],v10 offset:19456
ds_read_b128 v[108:111],v10 offset:20480
v_accvgpr_read_b32 v80,a84
ds_read_b128 v[72:75],v10 offset:21504
v_accvgpr_read_b32 v81,a85
v_pk_mul_f32 v[80:81],v[80:81],v[66:67] op_sel_hi:[1,0]
v_accvgpr_read_b32 v82,a86
v_accvgpr_read_b32 v83,a87
v_pk_mul_f32 v[82:83],v[82:83],v[66:67] op_sel_hi:[1,0]
v_accvgpr_read_b32 v76,a80
v_accvgpr_read_b32 v77,a81
v_pk_mul_f32 v[76:77],v[76:77],v[66:67] op_sel_hi:[1,0]
v_accvgpr_read_b32 v78,a82
v_accvgpr_read_b32 v79,a83
v_pk_mul_f32 v[78:79],v[78:79],v[66:67] op_sel_hi:[1,0]
v_accvgpr_read_b32 v84,a88
v_accvgpr_read_b32 v85,a89
v_mfma_f32_16x16x32_bf16 a[40:43],v[136:139],v[48:51],a[40:43]
v_accvgpr_read_b32 v86,a90
v_accvgpr_read_b32 v87,a91
v_cvt_pk_bf16_f32 v76,v76,v77
v_accvgpr_read_b32 v88,a92
v_accvgpr_read_b32 v89,a93
s_waitcnt lgkmcnt(3)
buffer_store_dwordx4 v[156:159],v9,s[16:19],s87 offen offset:0 nt
v_pk_mul_f32 v[84:85],v[84:85],v[66:67] op_sel_hi:[1,0]
v_pk_mul_f32 v[86:87],v[86:87],v[66:67] op_sel_hi:[1,0]
v_cvt_pk_bf16_f32 v80,v80,v81
v_cvt_pk_bf16_f32 v77,v78,v79
v_mfma_f32_16x16x32_bf16 v[248:251],v[136:139],v[44:47],v[248:251]
v_accvgpr_read_b32 v90,a94
v_accvgpr_read_b32 v91,a95
v_cvt_pk_bf16_f32 v84,v84,v85
ds_write_b64 v36,v[76:77] offset:18432
s_waitcnt lgkmcnt(1)
buffer_store_dwordx4 v[104:107],v9,s[16:19],s87 offen offset:3072 nt
v_pk_mul_f32 v[88:89],v[88:89],v[66:67] op_sel_hi:[1,0]
v_pk_mul_f32 v[90:91],v[90:91],v[66:67] op_sel_hi:[1,0]
v_pk_mul_f32 v[208:209],v[208:209],v[62:63] op_sel_hi:[1,0]
v_pk_mul_f32 v[224:225],v[224:225],v[62:63] op_sel_hi:[1,0]
v_pk_mul_f32 v[210:211],v[210:211],v[62:63] op_sel_hi:[1,0]
v_pk_mul_f32 v[226:227],v[226:227],v[62:63] op_sel_hi:[1,0]
v_pk_mul_f32 v[212:213],v[212:213],v[62:63] op_sel_hi:[1,0]
v_pk_mul_f32 v[228:229],v[228:229],v[62:63] op_sel_hi:[1,0]
v_pk_mul_f32 v[214:215],v[214:215],v[62:63] op_sel_hi:[1,0]
v_pk_mul_f32 v[230:231],v[230:231],v[62:63] op_sel_hi:[1,0]
v_pk_mul_f32 v[216:217],v[216:217],v[62:63] op_sel_hi:[1,0]
buffer_store_dwordx4 v[108:111],v9,s[16:19],s87 offen offset:128 nt
v_pk_mul_f32 v[232:233],v[232:233],v[62:63] op_sel_hi:[1,0]
v_pk_mul_f32 v[218:219],v[218:219],v[62:63] op_sel_hi:[1,0]
v_pk_mul_f32 v[234:235],v[234:235],v[62:63] op_sel_hi:[1,0]
v_pk_mul_f32 v[220:221],v[220:221],v[62:63] op_sel_hi:[1,0]
v_pk_mul_f32 v[236:237],v[236:237],v[62:63] op_sel_hi:[1,0]
v_pk_mul_f32 v[222:223],v[222:223],v[62:63] op_sel_hi:[1,0]
v_pk_mul_f32 v[238:239],v[238:239],v[62:63] op_sel_hi:[1,0]
v_pk_mul_f32 v[240:241],v[240:241],v[62:63] op_sel_hi:[1,0]
v_pk_mul_f32 v[242:243],v[242:243],v[62:63] op_sel_hi:[1,0]
v_pk_mul_f32 v[244:245],v[244:245],v[62:63] op_sel_hi:[1,0]
v_pk_mul_f32 v[246:247],v[246:247],v[62:63] op_sel_hi:[1,0]
buffer_store_dwordx4 v[72:75],v9,s[16:19],s87 offen offset:3200 nt
v_add_u32 v36,v36,v19
v_cvt_pk_bf16_f32 v81,v82,v83
v_cvt_pk_bf16_f32 v85,v86,v87
v_cvt_pk_bf16_f32 v88,v88,v89
v_cvt_pk_bf16_f32 v89,v90,v91
v_cvt_pk_bf16_f32 v208,v208,v209
v_cvt_pk_bf16_f32 v224,v224,v225
v_cvt_pk_bf16_f32 v212,v212,v213
v_cvt_pk_bf16_f32 v228,v228,v229
ds_write_b64 v37,v[80:81] offset:18432
v_add_u32 v37,v37,v19
v_cvt_pk_bf16_f32 v209,v210,v211
v_cvt_pk_bf16_f32 v225,v226,v227
v_cvt_pk_bf16_f32 v216,v216,v217
ds_write_b64 v38,v[84:85] offset:18432
v_add_u32 v38,v38,v19
v_cvt_pk_bf16_f32 v232,v232,v233
v_cvt_pk_bf16_f32 v213,v214,v215
v_cvt_pk_bf16_f32 v229,v230,v231
ds_write_b64 v39,v[88:89] offset:18432
ds_read_b128 v[92:95],v10 offset:18432
v_add_u32 v39,v39,v19
ds_read_b128 v[96:99],v10 offset:19456
v_cvt_pk_bf16_f32 v220,v220,v221
ds_write2st64_b64 v36,v[208:209],v[224:225] offset0:12 offset1:14
v_cvt_pk_bf16_f32 v236,v236,v237
v_cvt_pk_bf16_f32 v217,v218,v219
v_cvt_pk_bf16_f32 v233,v234,v235
v_cvt_pk_bf16_f32 v221,v222,v223
v_cvt_pk_bf16_f32 v237,v238,v239
v_accvgpr_read_b32 v104,a4
v_accvgpr_read_b32 v105,a5
v_pk_mul_f32 v[104:105],v[104:105],v[64:65] op_sel_hi:[1,0]
v_accvgpr_read_b32 v106,a6
v_accvgpr_read_b32 v107,a7
v_pk_mul_f32 v[106:107],v[106:107],v[64:65] op_sel_hi:[1,0]
ds_write2st64_b64 v37,v[212:213],v[228:229] offset0:12 offset1:14
v_accvgpr_read_b32 v82,a2
v_accvgpr_read_b32 v83,a3
v_pk_mul_f32 v[82:83],v[82:83],v[64:65] op_sel_hi:[1,0]
s_waitcnt lgkmcnt(3)
buffer_store_dwordx4 v[92:95],v9,s[16:19],s87 offen offset:256 nt
v_accvgpr_read_b32 v80,a0
v_accvgpr_read_b32 v81,a1
v_pk_mul_f32 v[80:81],v[80:81],v[64:65] op_sel_hi:[1,0]
v_accvgpr_read_b32 v108,a8
v_accvgpr_read_b32 v109,a9
v_mfma_f32_16x16x32_bf16 v[252:255],v[140:143],v[44:47],v[252:255]
v_cvt_pk_bf16_f32 v240,v240,v241
v_cvt_pk_bf16_f32 v80,v80,v81
v_mfma_f32_16x16x32_bf16 v[204:207],v[140:143],v[40:43],v[204:207]
ds_write2st64_b64 v38,v[216:217],v[232:233] offset0:12 offset1:14
v_mfma_f32_16x16x32_bf16 v[200:203],v[136:139],v[40:43],v[200:203]
s_waitcnt lgkmcnt(2)
v_accvgpr_read_b32 v110,a10
buffer_store_dwordx4 v[96:99],v9,s[16:19],s87 offen offset:3328 nt
v_pk_mul_f32 v[248:249],v[248:249],v[62:63] op_sel_hi:[1,0]
v_pk_mul_f32 v[108:109],v[108:109],v[64:65] op_sel_hi:[1,0]
v_pk_mul_f32 v[250:251],v[250:251],v[62:63] op_sel_hi:[1,0]
v_pk_mul_f32 v[252:253],v[252:253],v[62:63] op_sel_hi:[1,0]
v_pk_mul_f32 v[254:255],v[254:255],v[62:63] op_sel_hi:[1,0]
v_pk_mul_f32 v[160:161],v[160:161],v[60:61] op_sel_hi:[1,0]
v_pk_mul_f32 v[176:177],v[176:177],v[60:61] op_sel_hi:[1,0]
v_pk_mul_f32 v[162:163],v[162:163],v[60:61] op_sel_hi:[1,0]
v_pk_mul_f32 v[178:179],v[178:179],v[60:61] op_sel_hi:[1,0]
ds_write2st64_b64 v39,v[220:221],v[236:237] offset0:12 offset1:14
v_pk_mul_f32 v[164:165],v[164:165],v[60:61] op_sel_hi:[1,0]
v_pk_mul_f32 v[180:181],v[180:181],v[60:61] op_sel_hi:[1,0]
v_pk_mul_f32 v[166:167],v[166:167],v[60:61] op_sel_hi:[1,0]
ds_read_b128 v[100:103],v10 offset:6144
v_pk_mul_f32 v[182:183],v[182:183],v[60:61] op_sel_hi:[1,0]
ds_read_b128 v[76:79],v10 offset:9216
v_pk_mul_f32 v[168:169],v[168:169],v[60:61] op_sel_hi:[1,0]
ds_read_b128 v[156:159],v10 offset:7168
v_pk_mul_f32 v[184:185],v[184:185],v[60:61] op_sel_hi:[1,0]
ds_read_b128 v[72:75],v10 offset:10240
v_pk_mul_f32 v[170:171],v[170:171],v[60:61] op_sel_hi:[1,0]
v_pk_mul_f32 v[186:187],v[186:187],v[60:61] op_sel_hi:[1,0]
v_pk_mul_f32 v[172:173],v[172:173],v[60:61] op_sel_hi:[1,0]
v_pk_mul_f32 v[188:189],v[188:189],v[60:61] op_sel_hi:[1,0]
v_pk_mul_f32 v[174:175],v[174:175],v[60:61] op_sel_hi:[1,0]
v_pk_mul_f32 v[190:191],v[190:191],v[60:61] op_sel_hi:[1,0]
v_pk_mul_f32 v[192:193],v[192:193],v[60:61] op_sel_hi:[1,0]
v_pk_mul_f32 v[194:195],v[194:195],v[60:61] op_sel_hi:[1,0]
v_pk_mul_f32 v[196:197],v[196:197],v[60:61] op_sel_hi:[1,0]
v_pk_mul_f32 v[198:199],v[198:199],v[60:61] op_sel_hi:[1,0]
v_pk_mul_f32 v[200:201],v[200:201],v[60:61] op_sel_hi:[1,0]
v_pk_mul_f32 v[202:203],v[202:203],v[60:61] op_sel_hi:[1,0]
v_pk_mul_f32 v[204:205],v[204:205],v[60:61] op_sel_hi:[1,0]
v_pk_mul_f32 v[206:207],v[206:207],v[60:61] op_sel_hi:[1,0]
v_accvgpr_read_b32 v111,a11
v_pk_mul_f32 v[110:111],v[110:111],v[64:65] op_sel_hi:[1,0]
v_cvt_pk_bf16_f32 v244,v244,v245
v_accvgpr_read_b32 v84,a12
v_accvgpr_read_b32 v85,a13
v_pk_mul_f32 v[84:85],v[84:85],v[64:65] op_sel_hi:[1,0]
s_waitcnt lgkmcnt(3)
buffer_store_dwordx4 v[100:103],v9,s[16:19],s85 offen offset:0 nt
v_cvt_pk_bf16_f32 v104,v104,v105
v_cvt_pk_bf16_f32 v241,v242,v243
v_cvt_pk_bf16_f32 v81,v82,v83
v_accvgpr_read_b32 v86,a14
v_accvgpr_read_b32 v87,a15
v_pk_mul_f32 v[86:87],v[86:87],v[64:65] op_sel_hi:[1,0]
v_cvt_pk_bf16_f32 v248,v248,v249
v_cvt_pk_bf16_f32 v108,v108,v109
v_cvt_pk_bf16_f32 v245,v246,v247
ds_write2st64_b64 v36,v[240:241],v[80:81] offset0:16 offset1:24
v_cvt_pk_bf16_f32 v105,v106,v107
v_cvt_pk_bf16_f32 v252,v252,v253
v_cvt_pk_bf16_f32 v84,v84,v85
s_waitcnt lgkmcnt(1)
buffer_store_dwordx4 v[76:79],v9,s[16:19],s85 offen offset:3072 nt
v_cvt_pk_bf16_f32 v249,v250,v251
v_cvt_pk_bf16_f32 v109,v110,v111
v_cvt_pk_bf16_f32 v253,v254,v255
v_cvt_pk_bf16_f32 v85,v86,v87
v_accvgpr_read_b32 v212,a32
v_accvgpr_read_b32 v213,a33
v_pk_mul_f32 v[212:213],v[212:213],v[64:65] op_sel_hi:[1,0]
v_accvgpr_read_b32 v96,a16
v_accvgpr_read_b32 v97,a17
ds_write2st64_b64 v37,v[244:245],v[104:105] offset0:16 offset1:24
v_pk_mul_f32 v[96:97],v[96:97],v[64:65] op_sel_hi:[1,0]
v_accvgpr_read_b32 v214,a34
v_accvgpr_read_b32 v215,a35
buffer_store_dwordx4 v[156:159],v9,s[16:19],s85 offen offset:128 nt
v_pk_mul_f32 v[214:215],v[214:215],v[64:65] op_sel_hi:[1,0]
v_accvgpr_read_b32 v228,a20
v_accvgpr_read_b32 v229,a21
v_pk_mul_f32 v[228:229],v[228:229],v[64:65] op_sel_hi:[1,0]
v_accvgpr_read_b32 v216,a36
v_accvgpr_read_b32 v217,a37
v_pk_mul_f32 v[216:217],v[216:217],v[64:65] op_sel_hi:[1,0]
v_accvgpr_read_b32 v98,a18
v_accvgpr_read_b32 v99,a19
ds_write2st64_b64 v38,v[248:249],v[108:109] offset0:16 offset1:24
v_pk_mul_f32 v[98:99],v[98:99],v[64:65] op_sel_hi:[1,0]
v_accvgpr_read_b32 v230,a22
v_accvgpr_read_b32 v231,a23
buffer_store_dwordx4 v[72:75],v9,s[16:19],s85 offen offset:3200 nt
v_pk_mul_f32 v[230:231],v[230:231],v[64:65] op_sel_hi:[1,0]
v_accvgpr_read_b32 v218,a38
v_accvgpr_read_b32 v219,a39
v_pk_mul_f32 v[218:219],v[218:219],v[64:65] op_sel_hi:[1,0]
v_accvgpr_read_b32 v232,a24
v_accvgpr_read_b32 v233,a25
v_pk_mul_f32 v[232:233],v[232:233],v[64:65] op_sel_hi:[1,0]
v_accvgpr_read_b32 v220,a40
v_accvgpr_read_b32 v221,a41
ds_write2st64_b64 v39,v[252:253],v[84:85] offset0:16 offset1:24
v_pk_mul_f32 v[220:221],v[220:221],v[64:65] op_sel_hi:[1,0]
v_cvt_pk_bf16_f32 v212,v212,v213
v_cvt_pk_bf16_f32 v96,v96,v97
ds_read_b128 v[88:91],v10 offset:8192
v_accvgpr_read_b32 v234,a26
ds_read_b128 v[208:211],v10 offset:11264
v_accvgpr_read_b32 v235,a27
ds_read_b128 v[224:227],v10 offset:12288
v_pk_mul_f32 v[234:235],v[234:235],v[64:65] op_sel_hi:[1,0]
ds_read_b128 v[92:95],v10 offset:15360
v_accvgpr_read_b32 v222,a42
v_accvgpr_read_b32 v223,a43
v_pk_mul_f32 v[222:223],v[222:223],v[64:65] op_sel_hi:[1,0]
v_accvgpr_read_b32 v236,a28
v_accvgpr_read_b32 v237,a29
v_pk_mul_f32 v[236:237],v[236:237],v[64:65] op_sel_hi:[1,0]
v_accvgpr_read_b32 v80,a44
v_accvgpr_read_b32 v81,a45
v_pk_mul_f32 v[80:81],v[80:81],v[64:65] op_sel_hi:[1,0]
v_cvt_pk_bf16_f32 v228,v228,v229
v_cvt_pk_bf16_f32 v216,v216,v217
v_cvt_pk_bf16_f32 v213,v214,v215
v_cvt_pk_bf16_f32 v97,v98,v99
ds_write2st64_b64 v36,v[96:97],v[212:213] offset0:26 offset1:28
v_accvgpr_read_b32 v238,a30
v_accvgpr_read_b32 v239,a31
v_pk_mul_f32 v[238:239],v[238:239],v[64:65] op_sel_hi:[1,0]
s_waitcnt lgkmcnt(4)
buffer_store_dwordx4 v[88:91],v9,s[16:19],s85 offen offset:256 nt
v_accvgpr_read_b32 v82,a46
v_accvgpr_read_b32 v83,a47
v_pk_mul_f32 v[82:83],v[82:83],v[64:65] op_sel_hi:[1,0]
v_cvt_pk_bf16_f32 v232,v232,v233
v_cvt_pk_bf16_f32 v220,v220,v221
v_cvt_pk_bf16_f32 v229,v230,v231
v_cvt_pk_bf16_f32 v217,v218,v219
v_cvt_pk_bf16_f32 v236,v236,v237
v_cvt_pk_bf16_f32 v80,v80,v81
ds_write2st64_b64 v37,v[228:229],v[216:217] offset0:26 offset1:28
v_cvt_pk_bf16_f32 v233,v234,v235
v_cvt_pk_bf16_f32 v221,v222,v223
v_cvt_pk_bf16_f32 v237,v238,v239
s_waitcnt lgkmcnt(2)
buffer_store_dwordx4 v[208:211],v9,s[16:19],s85 offen offset:3328 nt
v_cvt_pk_bf16_f32 v81,v82,v83
v_cvt_pk_bf16_f32 v160,v160,v161
v_cvt_pk_bf16_f32 v176,v176,v177
v_cvt_pk_bf16_f32 v164,v164,v165
v_cvt_pk_bf16_f32 v180,v180,v181
v_cvt_pk_bf16_f32 v161,v162,v163
v_cvt_pk_bf16_f32 v177,v178,v179
v_cvt_pk_bf16_f32 v168,v168,v169
v_cvt_pk_bf16_f32 v184,v184,v185
ds_write2st64_b64 v38,v[232:233],v[220:221] offset0:26 offset1:28
v_cvt_pk_bf16_f32 v165,v166,v167
v_cvt_pk_bf16_f32 v181,v182,v183
v_cvt_pk_bf16_f32 v172,v172,v173
buffer_store_dwordx4 v[224:227],v9,s[16:19],s86 offen offset:0 nt
v_cvt_pk_bf16_f32 v188,v188,v189
v_cvt_pk_bf16_f32 v169,v170,v171
v_cvt_pk_bf16_f32 v185,v186,v187
v_cvt_pk_bf16_f32 v173,v174,v175
v_cvt_pk_bf16_f32 v189,v190,v191
v_cvt_pk_bf16_f32 v192,v192,v193
v_cvt_pk_bf16_f32 v196,v196,v197
v_cvt_pk_bf16_f32 v193,v194,v195
v_cvt_pk_bf16_f32 v200,v200,v201
ds_write2st64_b64 v39,v[236:237],v[80:81] offset0:26 offset1:28
v_cvt_pk_bf16_f32 v197,v198,v199
v_cvt_pk_bf16_f32 v204,v204,v205
v_cvt_pk_bf16_f32 v201,v202,v203
ds_read_b128 v[240:243],v10 offset:13312
buffer_store_dwordx4 v[92:95],v9,s[16:19],s86 offen offset:3072 nt
ds_read_b128 v[156:159],v10 offset:16384
v_cvt_pk_bf16_f32 v205,v206,v207
ds_read_b128 v[72:75],v10 offset:14336
ds_read_b128 v[76:79],v10 offset:17408
ds_write2st64_b64 v36,v[160:161],v[176:177] offset0:0 offset1:2
ds_write2st64_b64 v37,v[164:165],v[180:181] offset0:0 offset1:2
s_waitcnt lgkmcnt(3)
buffer_store_dwordx4 v[240:243],v9,s[16:19],s86 offen offset:128 nt
ds_write2st64_b64 v38,v[168:169],v[184:185] offset0:0 offset1:2
buffer_store_dwordx4 v[156:159],v9,s[16:19],s86 offen offset:3200 nt
ds_write2st64_b64 v39,v[172:173],v[188:189] offset0:0 offset1:2
ds_read_b128 v[100:103],v10 offset:0
buffer_store_dwordx4 v[72:75],v9,s[16:19],s86 offen offset:256 nt
ds_read_b128 v[104:107],v10 offset:3072
ds_read_b128 v[244:247],v10 offset:1024
ds_read_b128 v[108:111],v10 offset:4096
ds_write_b64 v36,v[192:193] offset:2048
s_waitcnt lgkmcnt(6)
buffer_store_dwordx4 v[76:79],v9,s[16:19],s86 offen offset:3328 nt
ds_write_b64 v37,v[196:197] offset:2048
s_waitcnt lgkmcnt(5)
buffer_store_dwordx4 v[100:103],v9,s[16:19],s84 offen offset:0 nt
ds_write_b64 v38,v[200:201] offset:2048
s_waitcnt lgkmcnt(2)
buffer_store_dwordx4 v[104:107],v9,s[16:19],s84 offen offset:3072 nt
ds_write_b64 v39,v[204:205] offset:2048
ds_read_b128 v[248:251],v10 offset:2048
buffer_store_dwordx4 v[244:247],v9,s[16:19],s84 offen offset:128 nt
ds_read_b128 v[84:87],v10 offset:5120
buffer_store_dwordx4 v[108:111],v9,s[16:19],s84 offen offset:3200 nt
s_waitcnt lgkmcnt(1)
buffer_store_dwordx4 v[248:251],v9,s[16:19],s84 offen offset:256 nt
s_waitcnt lgkmcnt(0)
buffer_store_dwordx4 v[84:87],v9,s[16:19],s84 offen offset:3328 nt
s_branch L_fin
L_fin:
s_waitcnt vmcnt(0)
L_stamped:
s_cmp_lg_u32 s31,0
s_cbranch_scc1 L_fix
L_done:
L_end:
s_endpgm
L_fix:
s_sub_u32 s62,s24,36864
v_add_u32 v112,s62,v2
v_add_u32 v113,s62,v3
v_add_u32 v114,s62,v4
v_add_u32 v115,s62,v5
v_mbcnt_lo_u32_b32 v19,-1,0
v_mbcnt_hi_u32_b32 v19,-1,v19
v_and_b32 v157,15,v19
v_mul_u32_u24 v157,384,v157
v_lshrrev_b32 v158,4,v19
v_lshl_add_u32 v159,v158,3,v157
v_lshl_add_u32 v157,v158,4,v157
L_fix_pass:
s_ff1_i32_b32 s50,s31
s_bitset0_b32 s31,s50
s_lshl_b32 s62,s50,5
s_add_u32 s62,s62,s34
s_mul_i32 s63,s62,171
s_lshr_b32 s63,s63,9
s_mul_i32 s64,s63,3
s_sub_u32 s62,s62,s64
s_add_u32 s63,s63,s33
s_mul_i32 s30,s63,196608
s_mul_i32 s41,s63,325632
s_lshl_b32 s63,s3,2
s_add_u32 s64,s63,21
s_cmp_eq_u32 s3,0
s_cselect_b32 s64,20,s64
s_cselect_b32 s40,1,0
s_add_u32 s65,s63,37
s_cmp_eq_u32 s62,2
s_cselect_b32 s64,s65,s64
s_cselect_b32 s40,0,s40
s_add_u32 s65,s63,s3
s_cmp_eq_u32 s62,0
s_cselect_b32 s64,s65,s64
s_cselect_b32 s40,1,s40
s_mul_i32 s64,s64,6144
s_add_u32 s41,s41,s64
s_add_u32 s55,s40,4
s_mov_b32 s51,0
L_fix_tile:
buffer_load_dwordx4 a[144:147],v157,s[12:15],s41 offen offset:0
buffer_load_dwordx4 a[148:151],v157,s[12:15],s41 offen offset:64
buffer_load_dwordx4 a[152:155],v157,s[12:15],s41 offen offset:128
buffer_load_dwordx4 a[156:159],v157,s[12:15],s41 offen offset:192
buffer_load_dwordx4 a[160:163],v157,s[12:15],s41 offen offset:256
buffer_load_dwordx4 a[164:167],v157,s[12:15],s41 offen offset:320
v_mov_b32 v156,0xff800000
s_mov_b32 s53,s30
s_mov_b32 s52,0
L_fix_max:
s_mov_b32 s63,s53
s_add_u32 m0,s24,0
s_nop 0
buffer_load_dwordx4 v6,s[4:7],s63 offen offset:0 lds
buffer_load_dwordx4 v7,s[4:7],s63 offen offset:1024 lds
buffer_load_dwordx4 v8,s[4:7],s63 offen offset:2048 lds
s_add_u32 s63,s63,3072
s_add_u32 m0,s24,3072
s_nop 0
buffer_load_dwordx4 v6,s[4:7],s63 offen offset:0 lds
buffer_load_dwordx4 v7,s[4:7],s63 offen offset:1024 lds
buffer_load_dwordx4 v8,s[4:7],s63 offen offset:2048 lds
s_add_u32 s63,s63,3072
s_add_u32 m0,s24,6144
s_nop 0
buffer_load_dwordx4 v6,s[4:7],s63 offen offset:0 lds
buffer_load_dwordx4 v7,s[4:7],s63 offen offset:1024 lds
buffer_load_dwordx4 v8,s[4:7],s63 offen offset:2048 lds
s_add_u32 s63,s63,3072
s_add_u32 m0,s24,9216
s_nop 0
buffer_load_dwordx4 v6,s[4:7],s63 offen offset:0 lds
buffer_load_dwordx4 v7,s[4:7],s63 offen offset:1024 lds
buffer_load_dwordx4 v8,s[4:7],s63 offen offset:2048 lds
s_add_u32 s63,s63,3072
s_waitcnt vmcnt(0)
ds_read_b128 a[0:3],v11 offset:0
ds_read_b128 a[4:7],v12 offset:0
ds_read_b128 a[8:11],v11 offset:128
ds_read_b128 a[12:15],v12 offset:128
ds_read_b128 a[16:19],v11 offset:256
ds_read_b128 a[20:23],v12 offset:256
ds_read_b128 a[24:27],v11 offset:6144
ds_read_b128 a[28:31],v12 offset:6144
ds_read_b128 a[32:35],v11 offset:6272
ds_read_b128 a[36:39],v12 offset:6272
ds_read_b128 a[40:43],v11 offset:6400
ds_read_b128 a[44:47],v12 offset:6400
s_waitcnt lgkmcnt(0)
v_mfma_f32_16x16x32_bf16 v[72:75],a[0:3],a[144:147],0
v_mfma_f32_16x16x32_bf16 v[72:75],a[4:7],a[148:151],v[72:75]
v_mfma_f32_16x16x32_bf16 v[72:75],a[8:11],a[152:155],v[72:75]
v_mfma_f32_16x16x32_bf16 v[72:75],a[12:15],a[156:159],v[72:75]
v_mfma_f32_16x16x32_bf16 v[72:75],a[16:19],a[160:163],v[72:75]
v_mfma_f32_16x16x32_bf16 v[72:75],a[20:23],a[164:167],v[72:75]
v_mfma_f32_16x16x32_bf16 v[76:79],a[24:27],a[144:147],0
v_mfma_f32_16x16x32_bf16 v[76:79],a[28:31],a[148:151],v[76:79]
v_mfma_f32_16x16x32_bf16 v[76:79],a[32:35],a[152:155],v[76:79]
v_mfma_f32_16x16x32_bf16 v[76:79],a[36:39],a[156:159],v[76:79]
v_mfma_f32_16x16x32_bf16 v[76:79],a[40:43],a[160:163],v[76:79]
v_mfma_f32_16x16x32_bf16 v[76:79],a[44:47],a[164:167],v[76:79]
s_nop 7
v_max3_f32 v156,v156,v72,v73
v_max3_f32 v156,v156,v74,v75
v_max3_f32 v156,v156,v76,v77
v_max3_f32 v156,v156,v78,v79
s_add_u32 s53,s53,12288
s_add_u32 s52,s52,1
s_cmp_lt_u32 s52,16
s_cbranch_scc1 L_fix_max
v_mov_b32 v19,v156
s_nop 1
v_permlane32_swap_b32 v19,v156
v_max_f32 v156,v156,v19
v_mov_b32 v19,v156
s_nop 1
v_permlane16_swap_b32 v19,v156
v_max_f32 v156,v156,v19
v_mul_f32_e64 v13,-s36,v156
v_mov_b32 v160,0
v_mov_b32 v161,0
v_mov_b32 v162,0
v_mov_b32 v163,0
v_mov_b32 v164,0
v_mov_b32 v165,0
v_mov_b32 v166,0
v_mov_b32 v167,0
v_mov_b32 v168,0
v_mov_b32 v169,0
v_mov_b32 v170,0
v_mov_b32 v171,0
v_mov_b32 v172,0
v_mov_b32 v173,0
v_mov_b32 v174,0
v_mov_b32 v175,0
v_mov_b32 v176,0
v_mov_b32 v177,0
v_mov_b32 v178,0
v_mov_b32 v179,0
v_mov_b32 v180,0
v_mov_b32 v181,0
v_mov_b32 v182,0
v_mov_b32 v183,0
v_mov_b32 v184,0
v_mov_b32 v185,0
v_mov_b32 v186,0
v_mov_b32 v187,0
v_mov_b32 v188,0
v_mov_b32 v189,0
v_mov_b32 v190,0
v_mov_b32 v191,0
v_mov_b32 v192,0
v_mov_b32 v193,0
v_mov_b32 v194,0
v_mov_b32 v195,0
v_mov_b32 v196,0
v_mov_b32 v197,0
v_mov_b32 v198,0
v_mov_b32 v199,0
v_mov_b32 v200,0
v_mov_b32 v201,0
v_mov_b32 v202,0
v_mov_b32 v203,0
v_mov_b32 v204,0
v_mov_b32 v205,0
v_mov_b32 v206,0
v_mov_b32 v207,0
v_mov_b32 v60,0
v_mov_b32 v24,0
v_mov_b32 v61,0
v_mov_b32 v25,0
v_mov_b32 v62,0
v_mov_b32 v26,0
v_mov_b32 v63,0
v_mov_b32 v27,0
s_mov_b32 s53,s30
s_mov_b32 s52,0
L_fix_acc:
s_mov_b32 s63,s53
s_add_u32 m0,s24,0
s_nop 0
buffer_load_dwordx4 v6,s[4:7],s63 offen offset:0 lds
buffer_load_dwordx4 v7,s[4:7],s63 offen offset:1024 lds
buffer_load_dwordx4 v8,s[4:7],s63 offen offset:2048 lds
s_add_u32 s63,s63,3072
s_add_u32 m0,s24,3072
s_nop 0
buffer_load_dwordx4 v6,s[4:7],s63 offen offset:0 lds
buffer_load_dwordx4 v7,s[4:7],s63 offen offset:1024 lds
buffer_load_dwordx4 v8,s[4:7],s63 offen offset:2048 lds
s_add_u32 s63,s63,3072
s_add_u32 m0,s24,6144
s_nop 0
buffer_load_dwordx4 v6,s[4:7],s63 offen offset:0 lds
buffer_load_dwordx4 v7,s[4:7],s63 offen offset:1024 lds
buffer_load_dwordx4 v8,s[4:7],s63 offen offset:2048 lds
s_add_u32 s63,s63,3072
s_add_u32 m0,s24,9216
s_nop 0
buffer_load_dwordx4 v6,s[4:7],s63 offen offset:0 lds
buffer_load_dwordx4 v7,s[4:7],s63 offen offset:1024 lds
buffer_load_dwordx4 v8,s[4:7],s63 offen offset:2048 lds
s_add_u32 s63,s63,3072
s_waitcnt vmcnt(0)
ds_read_b128 a[0:3],v11 offset:0
ds_read_b128 a[4:7],v12 offset:0
ds_read_b128 a[8:11],v11 offset:128
ds_read_b128 a[12:15],v12 offset:128
ds_read_b128 a[16:19],v11 offset:256
ds_read_b128 a[20:23],v12 offset:256
ds_read_b128 a[24:27],v11 offset:6144
ds_read_b128 a[28:31],v12 offset:6144
ds_read_b128 a[32:35],v11 offset:6272
ds_read_b128 a[36:39],v12 offset:6272
ds_read_b128 a[40:43],v11 offset:6400
ds_read_b128 a[44:47],v12 offset:6400
s_waitcnt lgkmcnt(0)
v_mfma_f32_16x16x32_bf16 v[72:75],a[0:3],a[144:147],0
v_mfma_f32_16x16x32_bf16 v[72:75],a[4:7],a[148:151],v[72:75]
v_mfma_f32_16x16x32_bf16 v[72:75],a[8:11],a[152:155],v[72:75]
v_mfma_f32_16x16x32_bf16 v[72:75],a[12:15],a[156:159],v[72:75]
v_mfma_f32_16x16x32_bf16 v[72:75],a[16:19],a[160:163],v[72:75]
v_mfma_f32_16x16x32_bf16 v[72:75],a[20:23],a[164:167],v[72:75]
v_mfma_f32_16x16x32_bf16 v[76:79],a[24:27],a[144:147],0
v_mfma_f32_16x16x32_bf16 v[76:79],a[28:31],a[148:151],v[76:79]
v_mfma_f32_16x16x32_bf16 v[76:79],a[32:35],a[152:155],v[76:79]
v_mfma_f32_16x16x32_bf16 v[76:79],a[36:39],a[156:159],v[76:79]
v_mfma_f32_16x16x32_bf16 v[76:79],a[40:43],a[160:163],v[76:79]
v_mfma_f32_16x16x32_bf16 v[76:79],a[44:47],a[164:167],v[76:79]
s_nop 7
v_fma_f32 v72,v72,s36,v13
v_fma_f32 v73,v73,s36,v13
v_exp_f32 v72,v72
v_exp_f32 v73,v73
s_nop 0
v_cvt_pk_bf16_f32 v20,v72,v73
v_fma_f32 v74,v74,s36,v13
v_fma_f32 v75,v75,s36,v13
v_exp_f32 v74,v74
v_exp_f32 v75,v75
s_nop 0
v_cvt_pk_bf16_f32 v21,v74,v75
v_fma_f32 v76,v76,s36,v13
v_fma_f32 v77,v77,s36,v13
v_exp_f32 v76,v76
v_exp_f32 v77,v77
s_nop 0
v_cvt_pk_bf16_f32 v22,v76,v77
v_fma_f32 v78,v78,s36,v13
v_fma_f32 v79,v79,s36,v13
v_exp_f32 v78,v78
v_exp_f32 v79,v79
s_nop 0
v_cvt_pk_bf16_f32 v23,v78,v79
s_nop 1
v_smfmac_f32_16x16x64_bf16 v[60:63],v[152:155],v[20:27],v18
s_mov_b32 s63,s53
s_add_u32 m0,s24,0
s_nop 0
buffer_load_dwordx4 v6,s[8:11],s63 offen offset:0 lds
buffer_load_dwordx4 v7,s[8:11],s63 offen offset:1024 lds
buffer_load_dwordx4 v8,s[8:11],s63 offen offset:2048 lds
s_add_u32 s63,s63,3072
s_add_u32 m0,s24,3072
s_nop 0
buffer_load_dwordx4 v6,s[8:11],s63 offen offset:0 lds
buffer_load_dwordx4 v7,s[8:11],s63 offen offset:1024 lds
buffer_load_dwordx4 v8,s[8:11],s63 offen offset:2048 lds
s_add_u32 s63,s63,3072
s_add_u32 m0,s24,6144
s_nop 0
buffer_load_dwordx4 v6,s[8:11],s63 offen offset:0 lds
buffer_load_dwordx4 v7,s[8:11],s63 offen offset:1024 lds
buffer_load_dwordx4 v8,s[8:11],s63 offen offset:2048 lds
s_add_u32 s63,s63,3072
s_add_u32 m0,s24,9216
s_nop 0
buffer_load_dwordx4 v6,s[8:11],s63 offen offset:0 lds
buffer_load_dwordx4 v7,s[8:11],s63 offen offset:1024 lds
buffer_load_dwordx4 v8,s[8:11],s63 offen offset:2048 lds
s_add_u32 s63,s63,3072
s_waitcnt vmcnt(0)
ds_read_b64_tr_b16 a[0:1],v112 offset:0
ds_read_b64_tr_b16 a[2:3],v112 offset:6144
ds_read_b64_tr_b16 a[4:5],v113 offset:0
ds_read_b64_tr_b16 a[6:7],v113 offset:6144
ds_read_b64_tr_b16 a[8:9],v114 offset:0
ds_read_b64_tr_b16 a[10:11],v114 offset:6144
ds_read_b64_tr_b16 a[12:13],v115 offset:0
ds_read_b64_tr_b16 a[14:15],v115 offset:6144
ds_read_b64_tr_b16 a[16:17],v112 offset:128
ds_read_b64_tr_b16 a[18:19],v112 offset:6272
ds_read_b64_tr_b16 a[20:21],v113 offset:128
ds_read_b64_tr_b16 a[22:23],v113 offset:6272
ds_read_b64_tr_b16 a[24:25],v114 offset:128
ds_read_b64_tr_b16 a[26:27],v114 offset:6272
ds_read_b64_tr_b16 a[28:29],v115 offset:128
ds_read_b64_tr_b16 a[30:31],v115 offset:6272
ds_read_b64_tr_b16 a[32:33],v112 offset:256
ds_read_b64_tr_b16 a[34:35],v112 offset:6400
ds_read_b64_tr_b16 a[36:37],v113 offset:256
ds_read_b64_tr_b16 a[38:39],v113 offset:6400
ds_read_b64_tr_b16 a[40:41],v114 offset:256
ds_read_b64_tr_b16 a[42:43],v114 offset:6400
ds_read_b64_tr_b16 a[44:45],v115 offset:256
ds_read_b64_tr_b16 a[46:47],v115 offset:6400
s_waitcnt lgkmcnt(0)
v_mfma_f32_16x16x32_bf16 v[160:163],a[0:3],v[20:23],v[160:163]
v_mfma_f32_16x16x32_bf16 v[164:167],a[4:7],v[20:23],v[164:167]
v_mfma_f32_16x16x32_bf16 v[168:171],a[8:11],v[20:23],v[168:171]
v_mfma_f32_16x16x32_bf16 v[172:175],a[12:15],v[20:23],v[172:175]
v_mfma_f32_16x16x32_bf16 v[176:179],a[16:19],v[20:23],v[176:179]
v_mfma_f32_16x16x32_bf16 v[180:183],a[20:23],v[20:23],v[180:183]
v_mfma_f32_16x16x32_bf16 v[184:187],a[24:27],v[20:23],v[184:187]
v_mfma_f32_16x16x32_bf16 v[188:191],a[28:31],v[20:23],v[188:191]
v_mfma_f32_16x16x32_bf16 v[192:195],a[32:35],v[20:23],v[192:195]
v_mfma_f32_16x16x32_bf16 v[196:199],a[36:39],v[20:23],v[196:199]
v_mfma_f32_16x16x32_bf16 v[200:203],a[40:43],v[20:23],v[200:203]
v_mfma_f32_16x16x32_bf16 v[204:207],a[44:47],v[20:23],v[204:207]
s_add_u32 s53,s53,12288
s_add_u32 s52,s52,1
s_cmp_lt_u32 s52,16
s_cbranch_scc1 L_fix_acc
s_nop 7
v_add_f32 v19,v60,v61
v_rcp_f32 v19,v19
s_nop 0
v_mul_f32 v160,v160,v19
v_mul_f32 v161,v161,v19
v_mul_f32 v162,v162,v19
v_mul_f32 v163,v163,v19
v_cvt_pk_bf16_f32 v160,v160,v161
v_cvt_pk_bf16_f32 v161,v162,v163
buffer_store_dwordx2 v[160:161],v159,s[16:19],s41 offen offset:0
v_mul_f32 v164,v164,v19
v_mul_f32 v165,v165,v19
v_mul_f32 v166,v166,v19
v_mul_f32 v167,v167,v19
v_cvt_pk_bf16_f32 v164,v164,v165
v_cvt_pk_bf16_f32 v165,v166,v167
buffer_store_dwordx2 v[164:165],v159,s[16:19],s41 offen offset:32
v_mul_f32 v168,v168,v19
v_mul_f32 v169,v169,v19
v_mul_f32 v170,v170,v19
v_mul_f32 v171,v171,v19
v_cvt_pk_bf16_f32 v168,v168,v169
v_cvt_pk_bf16_f32 v169,v170,v171
buffer_store_dwordx2 v[168:169],v159,s[16:19],s41 offen offset:64
v_mul_f32 v172,v172,v19
v_mul_f32 v173,v173,v19
v_mul_f32 v174,v174,v19
v_mul_f32 v175,v175,v19
v_cvt_pk_bf16_f32 v172,v172,v173
v_cvt_pk_bf16_f32 v173,v174,v175
buffer_store_dwordx2 v[172:173],v159,s[16:19],s41 offen offset:96
v_mul_f32 v176,v176,v19
v_mul_f32 v177,v177,v19
v_mul_f32 v178,v178,v19
v_mul_f32 v179,v179,v19
v_cvt_pk_bf16_f32 v176,v176,v177
v_cvt_pk_bf16_f32 v177,v178,v179
buffer_store_dwordx2 v[176:177],v159,s[16:19],s41 offen offset:128
v_mul_f32 v180,v180,v19
v_mul_f32 v181,v181,v19
v_mul_f32 v182,v182,v19
v_mul_f32 v183,v183,v19
v_cvt_pk_bf16_f32 v180,v180,v181
v_cvt_pk_bf16_f32 v181,v182,v183
buffer_store_dwordx2 v[180:181],v159,s[16:19],s41 offen offset:160
v_mul_f32 v184,v184,v19
v_mul_f32 v185,v185,v19
v_mul_f32 v186,v186,v19
v_mul_f32 v187,v187,v19
v_cvt_pk_bf16_f32 v184,v184,v185
v_cvt_pk_bf16_f32 v185,v186,v187
buffer_store_dwordx2 v[184:185],v159,s[16:19],s41 offen offset:192
v_mul_f32 v188,v188,v19
v_mul_f32 v189,v189,v19
v_mul_f32 v190,v190,v19
v_mul_f32 v191,v191,v19
v_cvt_pk_bf16_f32 v188,v188,v189
v_cvt_pk_bf16_f32 v189,v190,v191
buffer_store_dwordx2 v[188:189],v159,s[16:19],s41 offen offset:224
v_mul_f32 v192,v192,v19
v_mul_f32 v193,v193,v19
v_mul_f32 v194,v194,v19
v_mul_f32 v195,v195,v19
v_cvt_pk_bf16_f32 v192,v192,v193
v_cvt_pk_bf16_f32 v193,v194,v195
buffer_store_dwordx2 v[192:193],v159,s[16:19],s41 offen offset:256
v_mul_f32 v196,v196,v19
v_mul_f32 v197,v197,v19
v_mul_f32 v198,v198,v19
v_mul_f32 v199,v199,v19
v_cvt_pk_bf16_f32 v196,v196,v197
v_cvt_pk_bf16_f32 v197,v198,v199
buffer_store_dwordx2 v[196:197],v159,s[16:19],s41 offen offset:288
v_mul_f32 v200,v200,v19
v_mul_f32 v201,v201,v19
v_mul_f32 v202,v202,v19
v_mul_f32 v203,v203,v19
v_cvt_pk_bf16_f32 v200,v200,v201
v_cvt_pk_bf16_f32 v201,v202,v203
buffer_store_dwordx2 v[200:201],v159,s[16:19],s41 offen offset:320
v_mul_f32 v204,v204,v19
v_mul_f32 v205,v205,v19
v_mul_f32 v206,v206,v19
v_mul_f32 v207,v207,v19
v_cvt_pk_bf16_f32 v204,v204,v205
v_cvt_pk_bf16_f32 v205,v206,v207
buffer_store_dwordx2 v[204:205],v159,s[16:19],s41 offen offset:352
s_waitcnt vmcnt(0)
s_add_u32 s41,s41,6144
s_add_u32 s51,s51,1
s_cmp_lt_u32 s51,s55
s_cbranch_scc1 L_fix_tile
s_cmp_lg_u32 s31,0
s_cbranch_scc1 L_fix_pass
s_branch L_done
L_codeend:
.section .rodata,"a"
.p2align 6
.amdhsa_kernel standalone__gqa_softmax__near_ridge_kernel
  .amdhsa_next_free_vgpr 512
  .amdhsa_next_free_sgpr 102
  .amdhsa_accum_offset 256
  .amdhsa_group_segment_fixed_size 0
  .amdhsa_kernarg_size 48
  .amdhsa_user_sgpr_count 2
  .amdhsa_user_sgpr_kernarg_segment_ptr 1
  .amdhsa_system_sgpr_workgroup_id_x 1
.end_amdhsa_kernel
```

```asm
; @launch grid=(256,1,1) block=(256,1,1) lds=163840
.amdgcn_target "amdgcn-amd-amdhsa--gfx950"
.text
.globl standalone__gqa_softmax__near_ridge_kernel
.p2align 8
.type standalone__gqa_softmax__near_ridge_kernel,@function
standalone__gqa_softmax__near_ridge_kernel:
s_cmp_ge_u32 s2,256
s_cbranch_scc1 L_end
s_load_dwordx4 s[84:87],s[0:1],0
s_load_dwordx4 s[88:91],s[0:1],16
v_lshrrev_b32 v156,6,v0
v_and_b32 v19,63,v0
v_readfirstlane_b32 s3,v156
s_lshr_b32 s34,s2,3
s_getpc_b64 s[92:93]
L_pc:
s_mul_i32 s62,s34,4096
v_min_u32 v156,31,v19
v_lshlrev_b32 v156,7,v156
v_add_u32 v156,s62,v156
v_min_u32 v156,L_codeend-L_pc-4,v156
s_cmp_lg_u32 s3,0
s_cbranch_scc1 L_nopre
global_load_dword v60,v156,s[92:93]
L_nopre:
v_lshrrev_b32 v156,3,v19
v_and_b32 v158,7,v19
v_add_u32 v157,0,v156
v_mul_u32_u24 v157,43,v157
v_lshrrev_b32 v157,7,v157
v_and_b32 v157,6,v157
v_xor_b32 v157,v157,v158
v_lshlrev_b32 v157,4,v157
v_lshl_add_u32 v6,v156,7,v157
v_add_u32 v157,8,v156
v_mul_u32_u24 v157,43,v157
v_lshrrev_b32 v157,7,v157
v_and_b32 v157,6,v157
v_xor_b32 v157,v157,v158
v_lshlrev_b32 v157,4,v157
v_lshl_add_u32 v7,v156,7,v157
v_add_u32 v157,16,v156
v_mul_u32_u24 v157,43,v157
v_lshrrev_b32 v157,7,v157
v_and_b32 v157,6,v157
v_xor_b32 v157,v157,v158
v_lshlrev_b32 v157,4,v157
v_lshl_add_u32 v8,v156,7,v157
s_mov_b32 s37,0x5d800000
s_mov_b32 s36,0x3dd53b95
s_mov_b32 s31,0
s_mov_b32 s32,1
s_and_b32 s62,s2,7
s_lshl_b32 s33,s62,6
s_mul_i32 s22,s3,3072
s_add_u32 s23,s22,36864
s_mul_i32 s24,s3,22528
s_add_u32 s24,s24,73728
s_mov_b32 s69,0
s_lshl_b32 s62,s69,5
s_add_u32 s62,s62,s34
s_mul_i32 s63,s62,171
s_lshr_b32 s63,s63,9
s_mul_i32 s64,s63,3
s_sub_u32 s62,s62,s64
s_add_u32 s63,s63,s33
s_mul_i32 s30,s63,196608
s_mul_i32 s41,s63,325632
s_lshl_b32 s63,s3,2
s_add_u32 s64,s63,21
s_cmp_eq_u32 s3,0
s_cselect_b32 s64,20,s64
s_cselect_b32 s40,1,0
s_add_u32 s65,s63,37
s_cmp_eq_u32 s62,2
s_cselect_b32 s64,s65,s64
s_cselect_b32 s40,0,s40
s_add_u32 s65,s63,s3
s_cmp_eq_u32 s62,0
s_cselect_b32 s64,s65,s64
s_cselect_b32 s40,1,s40
s_mul_i32 s64,s64,6144
s_add_u32 s41,s41,s64
s_add_u32 s20,s30,s22
s_mov_b32 s21,s20
s_waitcnt lgkmcnt(0)
s_mov_b32 s4,s86
s_and_b32 s5,s87,0xffff
s_mov_b32 s6,100663296
s_mov_b32 s7,0x20000
s_mov_b32 s12,s84
s_and_b32 s13,s85,0xffff
s_mov_b32 s14,166723584
s_mov_b32 s15,0x20000
s_mov_b32 s8,s88
s_and_b32 s9,s89,0xffff
s_mov_b32 s10,100663296
s_mov_b32 s11,0x20000
s_mov_b32 s16,s90
s_and_b32 s17,s91,0xffff
s_mov_b32 s18,166723584
s_mov_b32 s19,0x20000
s_mov_b32 s28,s41
s_add_u32 m0,s22,0
s_nop 0
buffer_load_dwordx4 v6,s[4:7],s20 offen offset:0 lds
buffer_load_dwordx4 v7,s[4:7],s20 offen offset:1024 lds
buffer_load_dwordx4 v8,s[4:7],s20 offen offset:2048 lds
s_add_u32 s20,s20,12288
s_add_u32 m0,s24,0
s_nop 0
buffer_load_dwordx4 v6,s[12:15],s28 offen offset:0 nt lds
buffer_load_dwordx4 v7,s[12:15],s28 offen offset:1024 nt lds
buffer_load_dwordx4 v8,s[12:15],s28 offen offset:2048 nt lds
s_add_u32 s28,s28,3072
s_add_u32 m0,s24,3072
s_nop 0
buffer_load_dwordx4 v6,s[12:15],s28 offen offset:0 nt lds
buffer_load_dwordx4 v7,s[12:15],s28 offen offset:1024 nt lds
buffer_load_dwordx4 v8,s[12:15],s28 offen offset:2048 nt lds
s_add_u32 s28,s28,3072
s_add_u32 m0,s22,12288
s_nop 0
buffer_load_dwordx4 v6,s[4:7],s20 offen offset:0 lds
buffer_load_dwordx4 v7,s[4:7],s20 offen offset:1024 lds
buffer_load_dwordx4 v8,s[4:7],s20 offen offset:2048 lds
s_add_u32 s20,s20,12288
s_add_u32 m0,s24,6144
s_nop 0
buffer_load_dwordx4 v6,s[12:15],s28 offen offset:0 nt lds
buffer_load_dwordx4 v7,s[12:15],s28 offen offset:1024 nt lds
buffer_load_dwordx4 v8,s[12:15],s28 offen offset:2048 nt lds
s_add_u32 s28,s28,3072
s_add_u32 m0,s24,9216
s_nop 0
buffer_load_dwordx4 v6,s[12:15],s28 offen offset:0 nt lds
buffer_load_dwordx4 v7,s[12:15],s28 offen offset:1024 nt lds
buffer_load_dwordx4 v8,s[12:15],s28 offen offset:2048 nt lds
s_add_u32 s28,s28,3072
v_and_b32 v156,15,v19
v_lshrrev_b32 v157,4,v19
v_mul_u32_u24 v0,384,v156
v_and_b32 v159,6,v156
v_xor_b32 v159,v159,v157
v_lshl_add_u32 v0,v159,4,v0
v_xor_b32 v1,64,v0
v_add_u32 v11,s24,v0
v_add_u32 v12,s24,v1
v_lshrrev_b32 v156,2,v19
v_mul_u32_u24 v2,384,v156
v_and_b32 v156,6,v156
v_bfe_u32 v159,v19,1,1
v_xor_b32 v156,v156,v159
v_lshl_add_u32 v2,v156,4,v2
v_and_b32 v159,1,v19
v_lshl_add_u32 v2,v159,3,v2
v_add_u32 v2,36864,v2
v_xor_b32 v3,32,v2
v_xor_b32 v4,64,v2
v_xor_b32 v5,96,v2
v_lshrrev_b32 v156,3,v19
v_and_b32 v157,7,v19
v_xor_b32 v159,v157,v156
v_lshl_add_u32 v10,v156,7,s24
v_lshl_add_u32 v10,v159,4,v10
v_mul_u32_u24 v9,384,v156
v_lshl_add_u32 v9,v157,4,v9
v_lshrrev_b32 v156,4,v19
v_xor_b32 v156,v156,v19
v_bfe_u32 v156,v156,1,1
v_subrev_u32 v156,1,v156
v_and_b32 v152,0x3f803f80,v156
v_and_b32 v153,0x3f803f80,v156
v_and_b32 v154,0x3f803f80,v156
v_and_b32 v155,0x3f803f80,v156
v_and_b32 v156,1,v19
v_mul_u32_u24 v156,0xaaaa,v156
v_add_u32 v18,0x4444,v156
s_waitcnt vmcnt(6)
s_barrier
s_cmp_eq_u32 s40,0
s_cbranch_scc1 L_start4
L_start5:
s_add_u32 m0,s24,12288
s_waitcnt vmcnt(9)
ds_read_b128 a[144:147],v11 offset:0
buffer_load_dwordx4 v6,s[12:15],s28 offen offset:0 nt lds
ds_read_b128 a[148:151],v12 offset:0
buffer_load_dwordx4 v7,s[12:15],s28 offen offset:1024 nt lds
ds_read_b128 a[152:155],v11 offset:128
buffer_load_dwordx4 v8,s[12:15],s28 offen offset:2048 nt lds
s_add_u32 s28,s28,3072
s_add_u32 m0,s24,15360
ds_read_b128 a[156:159],v12 offset:128
buffer_load_dwordx4 v6,s[12:15],s28 offen offset:0 nt lds
ds_read_b128 a[160:163],v11 offset:256
buffer_load_dwordx4 v7,s[12:15],s28 offen offset:1024 nt lds
ds_read_b128 a[164:167],v12 offset:256
buffer_load_dwordx4 v8,s[12:15],s28 offen offset:2048 nt lds
s_add_u32 s28,s28,3072
s_add_u32 m0,s24,0
ds_read_b128 v[112:115],v0 offset:0
v_mov_b32 v60,0
ds_read_b128 v[116:119],v1 offset:0
v_mov_b32 v61,0
ds_read_b128 v[120:123],v0 offset:128
v_mov_b32 v62,0
ds_read_b128 v[124:127],v1 offset:128
v_mov_b32 v63,0
ds_read_b128 v[128:131],v0 offset:256
v_mov_b32 v64,0
ds_read_b128 v[132:135],v1 offset:256
v_mov_b32 v65,0
ds_read_b128 v[136:139],v0 offset:6144
v_mov_b32 v66,0
ds_read_b128 v[140:143],v1 offset:6144
v_mov_b32 v67,0
s_waitcnt lgkmcnt(7)
v_mfma_f32_16x16x32_bf16 v[72:75],v[112:115],a[144:147],0
s_waitcnt lgkmcnt(6)
ds_read_b128 v[112:115],v0 offset:6272
v_mov_b32 v68,0
v_mfma_f32_16x16x32_bf16 v[72:75],v[116:119],a[148:151],v[72:75]
s_waitcnt lgkmcnt(6)
ds_read_b128 v[116:119],v1 offset:6272
v_mov_b32 v69,0
v_mfma_f32_16x16x32_bf16 v[72:75],v[120:123],a[152:155],v[72:75]
s_waitcnt lgkmcnt(6)
ds_read_b128 v[120:123],v0 offset:6400
v_mov_b32 v70,0
v_mfma_f32_16x16x32_bf16 v[72:75],v[124:127],a[156:159],v[72:75]
s_waitcnt lgkmcnt(5)
ds_read_b128 v[124:127],v1 offset:6400
v_mov_b32 v71,0
v_mfma_f32_16x16x32_bf16 v[72:75],v[128:131],a[160:163],v[72:75]
ds_read_b128 v[128:131],v0 offset:0
v_mfma_f32_16x16x32_bf16 v[72:75],v[132:135],a[164:167],v[72:75]
s_waitcnt lgkmcnt(5)
ds_read_b128 v[132:135],v1 offset:0
v_mfma_f32_16x16x32_bf16 v[76:79],v[136:139],a[144:147],0
ds_read_b128 v[136:139],v0 offset:128
v_mfma_f32_16x16x32_bf16 v[76:79],v[140:143],a[148:151],v[76:79]
s_waitcnt lgkmcnt(6)
ds_read_b128 v[140:143],v1 offset:128
v_mfma_f32_16x16x32_bf16 v[76:79],v[112:115],a[152:155],v[76:79]
s_waitcnt lgkmcnt(6)
ds_read_b128 v[112:115],v0 offset:256
v_mfma_f32_16x16x32_bf16 v[76:79],v[116:119],a[156:159],v[76:79]
s_waitcnt lgkmcnt(6)
ds_read_b128 v[116:119],v1 offset:256
v_max3_f32 v44,v72,v73,v74
v_mfma_f32_16x16x32_bf16 v[76:79],v[120:123],a[160:163],v[76:79]
s_waitcnt lgkmcnt(6)
ds_read_b128 v[120:123],v0 offset:6144
v_mfma_f32_16x16x32_bf16 v[76:79],v[124:127],a[164:167],v[76:79]
s_waitcnt vmcnt(6)
ds_read_b128 a[168:171],v11 offset:6144
buffer_load_dwordx4 v6,s[12:15],s28 offen offset:0 nt lds
ds_read_b128 a[172:175],v12 offset:6144
buffer_load_dwordx4 v7,s[12:15],s28 offen offset:1024 nt lds
ds_read_b128 a[176:179],v11 offset:6272
buffer_load_dwordx4 v8,s[12:15],s28 offen offset:2048 nt lds
s_add_u32 s28,s28,3072
s_add_u32 m0,s24,3072
ds_read_b128 a[180:183],v12 offset:6272
buffer_load_dwordx4 v6,s[12:15],s28 offen offset:0 nt lds
ds_read_b128 a[184:187],v11 offset:6400
buffer_load_dwordx4 v7,s[12:15],s28 offen offset:1024 nt lds
ds_read_b128 a[188:191],v12 offset:6400
buffer_load_dwordx4 v8,s[12:15],s28 offen offset:2048 nt lds
s_add_u32 s28,s28,3072
s_add_u32 m0,s24,6144
ds_read_b128 v[124:127],v1 offset:6144
v_max3_f32 v44,v44,v75,v76
s_waitcnt lgkmcnt(6)
v_mfma_f32_16x16x32_bf16 v[80:83],v[128:131],a[168:171],0
s_waitcnt lgkmcnt(5)
ds_read_b128 v[128:131],v0 offset:6272
v_max3_f32 v44,v44,v77,v78
v_mfma_f32_16x16x32_bf16 v[80:83],v[132:135],a[172:175],v[80:83]
s_waitcnt lgkmcnt(5)
ds_read_b128 v[132:135],v1 offset:6272
v_max_f32 v44,v44,v79
v_mfma_f32_16x16x32_bf16 v[80:83],v[136:139],a[176:179],v[80:83]
s_waitcnt lgkmcnt(5)
ds_read_b128 v[136:139],v0 offset:6400
v_mov_b32 v45,v44
v_mfma_f32_16x16x32_bf16 v[80:83],v[140:143],a[180:183],v[80:83]
s_waitcnt lgkmcnt(5)
ds_read_b128 v[140:143],v1 offset:6400
v_permlane32_swap_b32 v45,v44
v_mfma_f32_16x16x32_bf16 v[80:83],v[112:115],a[184:187],v[80:83]
s_waitcnt lgkmcnt(5)
ds_read_b128 v[112:115],v0 offset:12288
v_max_f32 v44,v44,v45
v_mfma_f32_16x16x32_bf16 v[80:83],v[116:119],a[188:191],v[80:83]
ds_read_b128 v[116:119],v1 offset:12288
v_mov_b32 v45,v44
v_mfma_f32_16x16x32_bf16 v[84:87],v[120:123],a[168:171],0
s_waitcnt lgkmcnt(5)
ds_read_b128 v[120:123],v0 offset:12416
v_permlane16_swap_b32 v45,v44
v_mfma_f32_16x16x32_bf16 v[84:87],v[124:127],a[172:175],v[84:87]
ds_read_b128 v[124:127],v1 offset:12416
v_max_f32 v44,v44,v45
v_mfma_f32_16x16x32_bf16 v[84:87],v[128:131],a[176:179],v[84:87]
s_waitcnt lgkmcnt(5)
ds_read_b128 v[128:131],v0 offset:12544
v_mul_f32_e64 v13,-s36,v44
v_mfma_f32_16x16x32_bf16 v[84:87],v[132:135],a[180:183],v[84:87]
ds_read_b128 v[132:135],v1 offset:12544
v_fma_f32 v72,v72,s36,v13
v_mfma_f32_16x16x32_bf16 v[84:87],v[136:139],a[184:187],v[84:87]
s_waitcnt lgkmcnt(5)
ds_read_b128 v[136:139],v0 offset:18432
v_fma_f32 v73,v73,s36,v13
v_mfma_f32_16x16x32_bf16 v[84:87],v[140:143],a[188:191],v[84:87]
ds_read_b128 v[140:143],v1 offset:18432
v_fma_f32 v74,v74,s36,v13
v_fma_f32 v75,v75,s36,v13
v_exp_f32 v72,v72
v_exp_f32 v73,v73
v_exp_f32 v74,v74
v_exp_f32 v75,v75
v_cvt_pk_bf16_f32 v20,v72,v73
v_cvt_pk_bf16_f32 v21,v74,v75
v_mfma_f32_16x16x32_bf16 v[72:75],v[112:115],a[144:147],0
s_waitcnt lgkmcnt(3)
ds_read_b128 v[112:115],v0 offset:18560
v_fma_f32 v76,v76,s36,v13
v_mfma_f32_16x16x32_bf16 v[72:75],v[116:119],a[148:151],v[72:75]
ds_read_b128 v[116:119],v1 offset:18560
v_fma_f32 v77,v77,s36,v13
v_mfma_f32_16x16x32_bf16 v[72:75],v[120:123],a[152:155],v[72:75]
ds_read_b128 v[120:123],v0 offset:18688
v_fma_f32 v78,v78,s36,v13
v_mfma_f32_16x16x32_bf16 v[72:75],v[124:127],a[156:159],v[72:75]
ds_read_b128 v[124:127],v1 offset:18688
v_fma_f32 v79,v79,s36,v13
v_mfma_f32_16x16x32_bf16 v[72:75],v[128:131],a[160:163],v[72:75]
s_waitcnt lgkmcnt(4)
ds_read_b128 v[128:131],v0 offset:0
v_exp_f32 v76,v76
v_mfma_f32_16x16x32_bf16 v[72:75],v[132:135],a[164:167],v[72:75]
ds_read_b128 v[132:135],v1 offset:0
v_exp_f32 v77,v77
v_exp_f32 v78,v78
v_exp_f32 v79,v79
v_cvt_pk_bf16_f32 v22,v76,v77
v_cvt_pk_bf16_f32 v23,v78,v79
v_mfma_f32_16x16x32_bf16 v[76:79],v[136:139],a[144:147],0
ds_read_b128 v[136:139],v0 offset:128
v_max3_f32 v48,v80,v81,v82
v_mfma_f32_16x16x32_bf16 v[76:79],v[140:143],a[148:151],v[76:79]
s_waitcnt lgkmcnt(4)
ds_read_b128 v[140:143],v1 offset:128
v_max3_f32 v48,v48,v83,v84
v_mfma_f32_16x16x32_bf16 v[76:79],v[112:115],a[152:155],v[76:79]
ds_read_b128 v[112:115],v0 offset:256
v_max3_f32 v48,v48,v85,v86
v_mfma_f32_16x16x32_bf16 v[76:79],v[116:119],a[156:159],v[76:79]
ds_read_b128 v[116:119],v1 offset:256
v_max_f32 v48,v48,v87
v_mfma_f32_16x16x32_bf16 v[76:79],v[120:123],a[160:163],v[76:79]
s_waitcnt lgkmcnt(4)
ds_read_b128 v[120:123],v0 offset:6144
v_mov_b32 v49,v48
v_mfma_f32_16x16x32_bf16 v[76:79],v[124:127],a[164:167],v[76:79]
s_waitcnt vmcnt(6)
ds_read_b128 a[192:195],v11 offset:12288
buffer_load_dwordx4 v6,s[12:15],s28 offen offset:0 nt lds
ds_read_b128 a[196:199],v12 offset:12288
buffer_load_dwordx4 v7,s[12:15],s28 offen offset:1024 nt lds
ds_read_b128 a[200:203],v11 offset:12416
buffer_load_dwordx4 v8,s[12:15],s28 offen offset:2048 nt lds
s_add_u32 s28,s28,3072
s_add_u32 m0,s24,9216
ds_read_b128 a[204:207],v12 offset:12416
buffer_load_dwordx4 v6,s[12:15],s28 offen offset:0 nt lds
ds_read_b128 a[208:211],v11 offset:12544
buffer_load_dwordx4 v7,s[12:15],s28 offen offset:1024 nt lds
ds_read_b128 a[212:215],v12 offset:12544
buffer_load_dwordx4 v8,s[12:15],s28 offen offset:2048 nt lds
s_add_u32 s28,s28,3072
s_add_u32 m0,s23,0
ds_read_b128 v[124:127],v1 offset:6144
v_permlane32_swap_b32 v49,v48
s_waitcnt lgkmcnt(6)
v_mfma_f32_16x16x32_bf16 v[88:91],v[128:131],a[192:195],0
s_waitcnt lgkmcnt(5)
ds_read_b128 v[128:131],v0 offset:6272
v_max_f32 v48,v48,v49
v_mfma_f32_16x16x32_bf16 v[88:91],v[132:135],a[196:199],v[88:91]
s_waitcnt lgkmcnt(5)
ds_read_b128 v[132:135],v1 offset:6272
v_mov_b32 v49,v48
v_mfma_f32_16x16x32_bf16 v[88:91],v[136:139],a[200:203],v[88:91]
s_waitcnt lgkmcnt(5)
ds_read_b128 v[136:139],v0 offset:6400
v_permlane16_swap_b32 v49,v48
v_mfma_f32_16x16x32_bf16 v[88:91],v[140:143],a[204:207],v[88:91]
s_waitcnt lgkmcnt(4)
ds_read_b128 v[140:143],v1 offset:6400
v_max_f32 v48,v48,v49
v_mfma_f32_16x16x32_bf16 v[88:91],v[112:115],a[208:211],v[88:91]
ds_read_b128 v[112:115],v0 offset:12288
v_mul_f32_e64 v14,-s36,v48
v_mfma_f32_16x16x32_bf16 v[88:91],v[116:119],a[212:215],v[88:91]
ds_read_b128 v[116:119],v1 offset:12288
v_fma_f32 v80,v80,s36,v14
v_mfma_f32_16x16x32_bf16 v[92:95],v[120:123],a[192:195],0
s_waitcnt lgkmcnt(5)
ds_read_b128 v[120:123],v0 offset:12416
v_fma_f32 v81,v81,s36,v14
v_mfma_f32_16x16x32_bf16 v[92:95],v[124:127],a[196:199],v[92:95]
ds_read_b128 v[124:127],v1 offset:12416
v_fma_f32 v82,v82,s36,v14
v_mfma_f32_16x16x32_bf16 v[92:95],v[128:131],a[200:203],v[92:95]
s_waitcnt lgkmcnt(5)
ds_read_b128 v[128:131],v0 offset:12544
v_fma_f32 v83,v83,s36,v14
v_mfma_f32_16x16x32_bf16 v[92:95],v[132:135],a[204:207],v[92:95]
ds_read_b128 v[132:135],v1 offset:12544
v_exp_f32 v80,v80
v_mfma_f32_16x16x32_bf16 v[92:95],v[136:139],a[208:211],v[92:95]
s_waitcnt lgkmcnt(5)
ds_read_b128 v[136:139],v0 offset:18432
v_exp_f32 v81,v81
v_mfma_f32_16x16x32_bf16 v[92:95],v[140:143],a[212:215],v[92:95]
ds_read_b128 v[140:143],v1 offset:18432
v_exp_f32 v82,v82
v_exp_f32 v83,v83
v_cvt_pk_bf16_f32 v24,v80,v81
v_cvt_pk_bf16_f32 v25,v82,v83
v_mfma_f32_16x16x32_bf16 v[80:83],v[112:115],a[168:171],0
s_waitcnt lgkmcnt(4)
ds_read_b128 v[112:115],v0 offset:18560
v_fma_f32 v84,v84,s36,v14
v_mfma_f32_16x16x32_bf16 v[80:83],v[116:119],a[172:175],v[80:83]
ds_read_b128 v[116:119],v1 offset:18560
v_fma_f32 v85,v85,s36,v14
v_mfma_f32_16x16x32_bf16 v[80:83],v[120:123],a[176:179],v[80:83]
ds_read_b128 v[120:123],v0 offset:18688
v_fma_f32 v86,v86,s36,v14
v_mfma_f32_16x16x32_bf16 v[80:83],v[124:127],a[180:183],v[80:83]
s_waitcnt lgkmcnt(4)
ds_read_b128 v[124:127],v1 offset:18688
v_fma_f32 v87,v87,s36,v14
v_mfma_f32_16x16x32_bf16 v[80:83],v[128:131],a[184:187],v[80:83]
ds_read_b128 v[128:131],v0 offset:0
v_exp_f32 v84,v84
v_mfma_f32_16x16x32_bf16 v[80:83],v[132:135],a[188:191],v[80:83]
ds_read_b128 v[132:135],v1 offset:0
v_exp_f32 v85,v85
v_exp_f32 v86,v86
v_exp_f32 v87,v87
v_cvt_pk_bf16_f32 v26,v84,v85
v_cvt_pk_bf16_f32 v27,v86,v87
v_mfma_f32_16x16x32_bf16 v[84:87],v[136:139],a[168:171],0
ds_read_b128 v[136:139],v0 offset:128
v_max3_f32 v52,v88,v89,v90
v_smfmac_f32_16x16x64_bf16 v[60:63],v[152:155],v[20:27],v18
s_waitcnt lgkmcnt(4)
v_max3_f32 v52,v52,v91,v92
v_mfma_f32_16x16x32_bf16 v[84:87],v[140:143],a[172:175],v[84:87]
ds_read_b128 v[140:143],v1 offset:128
v_max3_f32 v52,v52,v93,v94
v_mfma_f32_16x16x32_bf16 v[84:87],v[112:115],a[176:179],v[84:87]
ds_read_b128 v[112:115],v0 offset:256
v_max_f32 v52,v52,v95
v_mfma_f32_16x16x32_bf16 v[84:87],v[116:119],a[180:183],v[84:87]
ds_read_b128 v[116:119],v1 offset:256
v_mov_b32 v53,v52
v_mfma_f32_16x16x32_bf16 v[84:87],v[120:123],a[184:187],v[84:87]
s_waitcnt lgkmcnt(4)
ds_read_b128 v[120:123],v0 offset:6144
v_permlane32_swap_b32 v53,v52
v_mfma_f32_16x16x32_bf16 v[84:87],v[124:127],a[188:191],v[84:87]
s_waitcnt vmcnt(6)
ds_read_b128 a[216:219],v11 offset:0
buffer_load_dwordx4 v6,s[8:11],s21 offen offset:0 lds
ds_read_b128 a[220:223],v12 offset:0
buffer_load_dwordx4 v7,s[8:11],s21 offen offset:1024 lds
ds_read_b128 a[224:227],v11 offset:128
buffer_load_dwordx4 v8,s[8:11],s21 offen offset:2048 lds
s_add_u32 s21,s21,12288
s_add_u32 m0,s22,24576
ds_read_b128 a[228:231],v12 offset:128
buffer_load_dwordx4 v6,s[4:7],s20 offen offset:0 lds
ds_read_b128 a[232:235],v11 offset:256
buffer_load_dwordx4 v7,s[4:7],s20 offen offset:1024 lds
ds_read_b128 a[236:239],v12 offset:256
buffer_load_dwordx4 v8,s[4:7],s20 offen offset:2048 lds
s_add_u32 s20,s20,12288
s_add_u32 m0,s23,12288
ds_read_b128 v[124:127],v1 offset:6144
v_max_f32 v52,v52,v53
s_waitcnt lgkmcnt(6)
v_mfma_f32_16x16x32_bf16 v[96:99],v[128:131],a[216:219],0
s_waitcnt lgkmcnt(5)
ds_read_b128 v[128:131],v0 offset:6272
v_mov_b32 v53,v52
v_mfma_f32_16x16x32_bf16 v[96:99],v[132:135],a[220:223],v[96:99]
s_waitcnt lgkmcnt(5)
ds_read_b128 v[132:135],v1 offset:6272
v_permlane16_swap_b32 v53,v52
v_mfma_f32_16x16x32_bf16 v[96:99],v[136:139],a[224:227],v[96:99]
s_waitcnt lgkmcnt(5)
ds_read_b128 v[136:139],v0 offset:6400
v_max_f32 v52,v52,v53
v_mul_f32_e64 v15,-s36,v52
v_mfma_f32_16x16x32_bf16 v[96:99],v[140:143],a[228:231],v[96:99]
s_waitcnt lgkmcnt(4)
ds_read_b128 v[140:143],v1 offset:6400
v_fma_f32 v88,v88,s36,v15
v_mfma_f32_16x16x32_bf16 v[96:99],v[112:115],a[232:235],v[96:99]
ds_read_b128 v[112:115],v0 offset:12288
v_fma_f32 v89,v89,s36,v15
v_mfma_f32_16x16x32_bf16 v[96:99],v[116:119],a[236:239],v[96:99]
ds_read_b128 v[116:119],v1 offset:12288
v_fma_f32 v90,v90,s36,v15
v_mfma_f32_16x16x32_bf16 v[100:103],v[120:123],a[216:219],0
s_waitcnt lgkmcnt(5)
ds_read_b128 v[120:123],v0 offset:12416
v_fma_f32 v91,v91,s36,v15
v_mfma_f32_16x16x32_bf16 v[100:103],v[124:127],a[220:223],v[100:103]
ds_read_b128 v[124:127],v1 offset:12416
v_exp_f32 v88,v88
v_mfma_f32_16x16x32_bf16 v[100:103],v[128:131],a[224:227],v[100:103]
s_waitcnt lgkmcnt(5)
ds_read_b128 v[128:131],v0 offset:12544
v_exp_f32 v89,v89
v_mfma_f32_16x16x32_bf16 v[100:103],v[132:135],a[228:231],v[100:103]
ds_read_b128 v[132:135],v1 offset:12544
v_exp_f32 v90,v90
v_mfma_f32_16x16x32_bf16 v[100:103],v[136:139],a[232:235],v[100:103]
s_waitcnt lgkmcnt(5)
ds_read_b128 v[136:139],v0 offset:18432
v_exp_f32 v91,v91
v_mfma_f32_16x16x32_bf16 v[100:103],v[140:143],a[236:239],v[100:103]
ds_read_b128 v[140:143],v1 offset:18432
v_cvt_pk_bf16_f32 v28,v88,v89
v_cvt_pk_bf16_f32 v29,v90,v91
v_mfma_f32_16x16x32_bf16 v[88:91],v[112:115],a[192:195],0
s_waitcnt lgkmcnt(5)
ds_read_b128 v[112:115],v0 offset:18560
v_fma_f32 v92,v92,s36,v15
v_mfma_f32_16x16x32_bf16 v[88:91],v[116:119],a[196:199],v[88:91]
ds_read_b128 v[116:119],v1 offset:18560
v_fma_f32 v93,v93,s36,v15
v_mfma_f32_16x16x32_bf16 v[88:91],v[120:123],a[200:203],v[88:91]
s_waitcnt lgkmcnt(5)
ds_read_b128 v[120:123],v0 offset:18688
v_fma_f32 v94,v94,s36,v15
v_mfma_f32_16x16x32_bf16 v[88:91],v[124:127],a[204:207],v[88:91]
ds_read_b128 v[124:127],v1 offset:18688
v_fma_f32 v95,v95,s36,v15
v_mfma_f32_16x16x32_bf16 v[88:91],v[128:131],a[208:211],v[88:91]
s_waitcnt lgkmcnt(5)
ds_read_b128 v[128:131],v0 offset:0
v_exp_f32 v92,v92
v_mfma_f32_16x16x32_bf16 v[88:91],v[132:135],a[212:215],v[88:91]
ds_read_b128 v[132:135],v1 offset:0
v_exp_f32 v93,v93
v_exp_f32 v94,v94
v_exp_f32 v95,v95
v_cvt_pk_bf16_f32 v30,v92,v93
v_cvt_pk_bf16_f32 v31,v94,v95
v_mfma_f32_16x16x32_bf16 v[92:95],v[136:139],a[192:195],0
s_waitcnt lgkmcnt(4)
ds_read_b128 v[136:139],v0 offset:128
v_max3_f32 v56,v96,v97,v98
v_mfma_f32_16x16x32_bf16 v[92:95],v[140:143],a[196:199],v[92:95]
ds_read_b128 v[140:143],v1 offset:128
v_max3_f32 v56,v56,v99,v100
v_mfma_f32_16x16x32_bf16 v[92:95],v[112:115],a[200:203],v[92:95]
ds_read_b128 v[112:115],v0 offset:256
v_max3_f32 v56,v56,v101,v102
v_mfma_f32_16x16x32_bf16 v[92:95],v[116:119],a[204:207],v[92:95]
s_waitcnt lgkmcnt(4)
ds_read_b128 v[116:119],v1 offset:256
v_max_f32 v56,v56,v103
v_mfma_f32_16x16x32_bf16 v[92:95],v[120:123],a[208:211],v[92:95]
ds_read_b128 v[120:123],v0 offset:6144
v_mov_b32 v57,v56
v_mfma_f32_16x16x32_bf16 v[92:95],v[124:127],a[212:215],v[92:95]
s_waitcnt vmcnt(6)
ds_read_b128 a[240:243],v11 offset:6144
buffer_load_dwordx4 v6,s[8:11],s21 offen offset:0 lds
ds_read_b128 a[244:247],v12 offset:6144
buffer_load_dwordx4 v7,s[8:11],s21 offen offset:1024 lds
ds_read_b128 a[248:251],v11 offset:6272
buffer_load_dwordx4 v8,s[8:11],s21 offen offset:2048 lds
s_add_u32 s21,s21,12288
s_add_u32 m0,s23,24576
ds_read_b128 a[252:255],v12 offset:6272
buffer_load_dwordx4 v6,s[8:11],s21 offen offset:0 lds
ds_read_b128 v[144:147],v11 offset:6400
buffer_load_dwordx4 v7,s[8:11],s21 offen offset:1024 lds
ds_read_b128 v[148:151],v12 offset:6400
buffer_load_dwordx4 v8,s[8:11],s21 offen offset:2048 lds
s_add_u32 s21,s21,12288
ds_read_b128 v[124:127],v1 offset:6144
v_permlane32_swap_b32 v57,v56
s_waitcnt lgkmcnt(6)
v_mfma_f32_16x16x32_bf16 v[104:107],v[128:131],a[240:243],0
s_mov_b32 s27,166723584
ds_read_b128 v[128:131],v0 offset:6272
v_max_f32 v56,v56,v57
s_waitcnt lgkmcnt(6)
v_mfma_f32_16x16x32_bf16 v[104:107],v[132:135],a[244:247],v[104:107]
s_mov_b32 s42,s41
ds_read_b128 v[132:135],v1 offset:6272
v_mov_b32 v57,v56
s_waitcnt lgkmcnt(6)
v_mfma_f32_16x16x32_bf16 v[104:107],v[136:139],a[248:251],v[104:107]
s_add_u32 s69,s69,1
ds_read_b128 v[136:139],v0 offset:6400
v_permlane16_swap_b32 v57,v56
v_max_f32 v56,v56,v57
s_waitcnt lgkmcnt(6)
v_mfma_f32_16x16x32_bf16 v[104:107],v[140:143],a[252:255],v[104:107]
s_lshl_b32 s62,s69,5
ds_read_b128 v[140:143],v1 offset:6400
v_mul_f32_e64 v16,-s36,v56
s_waitcnt lgkmcnt(5)
v_mfma_f32_16x16x32_bf16 v[104:107],v[112:115],v[144:147],v[104:107]
s_add_u32 s62,s62,s34
ds_read_b128 v[112:115],v0 offset:12288
v_fma_f32 v96,v96,s36,v16
v_mfma_f32_16x16x32_bf16 v[104:107],v[116:119],v[148:151],v[104:107]
s_mul_i32 s63,s62,171
ds_read_b128 v[116:119],v1 offset:12288
v_fma_f32 v97,v97,s36,v16
v_mfma_f32_16x16x32_bf16 v[108:111],v[120:123],a[240:243],0
s_lshr_b32 s63,s63,9
ds_read_b128 v[120:123],v0 offset:12416
v_fma_f32 v98,v98,s36,v16
s_waitcnt lgkmcnt(6)
v_mfma_f32_16x16x32_bf16 v[108:111],v[124:127],a[244:247],v[108:111]
s_mul_i32 s64,s63,3
ds_read_b128 v[124:127],v1 offset:12416
v_fma_f32 v99,v99,s36,v16
v_mfma_f32_16x16x32_bf16 v[108:111],v[128:131],a[248:251],v[108:111]
s_sub_u32 s62,s62,s64
ds_read_b128 v[128:131],v0 offset:12544
v_exp_f32 v96,v96
s_waitcnt lgkmcnt(6)
v_mfma_f32_16x16x32_bf16 v[108:111],v[132:135],a[252:255],v[108:111]
s_add_u32 s63,s63,s33
ds_read_b128 v[132:135],v1 offset:12544
v_exp_f32 v97,v97
v_mfma_f32_16x16x32_bf16 v[108:111],v[136:139],v[144:147],v[108:111]
s_mul_i32 s30,s63,196608
ds_read_b128 v[136:139],v0 offset:18432
v_exp_f32 v98,v98
s_waitcnt lgkmcnt(6)
v_mfma_f32_16x16x32_bf16 v[108:111],v[140:143],v[148:151],v[108:111]
s_waitcnt vmcnt(9)
s_barrier
ds_read_b128 v[140:143],v1 offset:18432
v_exp_f32 v99,v99
v_cvt_pk_bf16_f32 v32,v96,v97
v_cvt_pk_bf16_f32 v33,v98,v99
v_mfma_f32_16x16x32_bf16 v[96:99],v[112:115],a[216:219],0
s_mul_i32 s41,s63,325632
ds_read_b128 v[112:115],v0 offset:18560
v_fma_f32 v100,v100,s36,v16
s_waitcnt lgkmcnt(4)
v_mfma_f32_16x16x32_bf16 v[96:99],v[116:119],a[220:223],v[96:99]
s_lshl_b32 s63,s3,2
ds_read_b128 v[116:119],v1 offset:18560
v_fma_f32 v101,v101,s36,v16
v_mfma_f32_16x16x32_bf16 v[96:99],v[120:123],a[224:227],v[96:99]
s_add_u32 s64,s63,21
ds_read_b128 v[120:123],v0 offset:18688
v_fma_f32 v102,v102,s36,v16
v_mfma_f32_16x16x32_bf16 v[96:99],v[124:127],a[228:231],v[96:99]
s_cmp_eq_u32 s3,0
ds_read_b128 v[124:127],v1 offset:18688
v_fma_f32 v103,v103,s36,v16
v_mfma_f32_16x16x32_bf16 v[96:99],v[128:131],a[232:235],v[96:99]
s_cselect_b32 s64,20,s64
ds_read_b128 v[128:131],v0 offset:12288
v_exp_f32 v100,v100
s_waitcnt lgkmcnt(6)
v_mfma_f32_16x16x32_bf16 v[96:99],v[132:135],a[236:239],v[96:99]
s_cselect_b32 s40,1,0
ds_read_b128 v[132:135],v1 offset:12288
v_exp_f32 v101,v101
v_exp_f32 v102,v102
v_exp_f32 v103,v103
v_cvt_pk_bf16_f32 v34,v100,v101
v_cvt_pk_bf16_f32 v35,v102,v103
v_mfma_f32_16x16x32_bf16 v[100:103],v[136:139],a[216:219],0
s_add_u32 s65,s63,37
ds_read_b128 v[136:139],v0 offset:12416
v_max3_f32 v40,v104,v105,v106
v_smfmac_f32_16x16x64_bf16 v[64:67],v[152:155],v[28:35],v18
s_cmp_eq_u32 s62,2
s_cselect_b32 s64,s65,s64
v_max3_f32 v40,v40,v107,v108
s_waitcnt lgkmcnt(4)
v_mfma_f32_16x16x32_bf16 v[100:103],v[140:143],a[220:223],v[100:103]
s_cselect_b32 s40,0,s40
ds_read_b128 v[140:143],v1 offset:12416
v_max3_f32 v40,v40,v109,v110
v_mfma_f32_16x16x32_bf16 v[100:103],v[112:115],a[224:227],v[100:103]
s_add_u32 s65,s63,s3
ds_read_b128 v[112:115],v0 offset:12544
v_max_f32 v40,v40,v111
v_mfma_f32_16x16x32_bf16 v[100:103],v[116:119],a[228:231],v[100:103]
s_cmp_eq_u32 s62,0
ds_read_b128 v[116:119],v1 offset:12544
v_mov_b32 v41,v40
v_mfma_f32_16x16x32_bf16 v[100:103],v[120:123],a[232:235],v[100:103]
s_cselect_b32 s64,s65,s64
ds_read_b128 v[120:123],v0 offset:18432
v_permlane32_swap_b32 v41,v40
s_waitcnt lgkmcnt(5)
v_mfma_f32_16x16x32_bf16 v[100:103],v[124:127],a[236:239],v[100:103]
s_cselect_b32 s40,1,s40
ds_read_b128 v[124:127],v1 offset:18432
v_max_f32 v40,v40,v41
v_mov_b32 v41,v40
v_fma_f32 v72,v72,s36,v13
v_fma_f32 v73,v73,s36,v13
v_permlane16_swap_b32 v41,v40
v_max_f32 v40,v40,v41
v_mul_f32_e64 v17,-s36,v40
v_fma_f32 v104,v104,s36,v17
v_fma_f32 v105,v105,s36,v17
v_fma_f32 v106,v106,s36,v17
v_fma_f32 v107,v107,s36,v17
v_exp_f32 v104,v104
v_exp_f32 v105,v105
v_exp_f32 v106,v106
v_exp_f32 v107,v107
v_cvt_pk_bf16_f32 v36,v104,v105
v_cvt_pk_bf16_f32 v37,v106,v107
v_mfma_f32_16x16x32_bf16 v[104:107],v[128:131],a[240:243],0
s_mul_i32 s64,s64,6144
ds_read_b128 v[128:131],v0 offset:18560
v_fma_f32 v108,v108,s36,v17
v_mfma_f32_16x16x32_bf16 v[104:107],v[132:135],a[244:247],v[104:107]
s_add_u32 s41,s41,s64
ds_read_b128 v[132:135],v1 offset:18560
v_fma_f32 v109,v109,s36,v17
s_waitcnt lgkmcnt(2)
v_mfma_f32_16x16x32_bf16 v[104:107],v[136:139],a[248:251],v[104:107]
s_cmp_ge_u32 s69,6
ds_read_b128 v[136:139],v0 offset:18688
v_fma_f32 v110,v110,s36,v17
v_mfma_f32_16x16x32_bf16 v[104:107],v[140:143],a[252:255],v[104:107]
s_cselect_b32 s41,166723584,s41
ds_read_b128 v[140:143],v1 offset:18688
v_fma_f32 v111,v111,s36,v17
v_mfma_f32_16x16x32_bf16 v[104:107],v[112:115],v[144:147],v[104:107]
s_cselect_b32 s30,100663296,s30
ds_read_b64_tr_b16 v[112:113],v2 offset:0
v_exp_f32 v108,v108
v_mfma_f32_16x16x32_bf16 v[104:107],v[116:119],v[148:151],v[104:107]
s_add_u32 s25,s30,s22
ds_read_b64_tr_b16 v[114:115],v2 offset:6144
ds_read_b64_tr_b16 v[116:117],v3 offset:0
ds_read_b64_tr_b16 v[118:119],v3 offset:6144
v_exp_f32 v109,v109
v_exp_f32 v110,v110
v_exp_f32 v111,v111
v_cvt_pk_bf16_f32 v38,v108,v109
v_cvt_pk_bf16_f32 v39,v110,v111
v_mfma_f32_16x16x32_bf16 v[108:111],v[120:123],a[240:243],0
s_add_u32 s26,s25,12288
ds_read_b64_tr_b16 v[120:121],v4 offset:0
v_fma_f32 v74,v74,s36,v13
v_mfma_f32_16x16x32_bf16 v[108:111],v[124:127],a[244:247],v[108:111]
s_mov_b32 s28,s41
ds_read_b64_tr_b16 v[122:123],v4 offset:6144
v_fma_f32 v75,v75,s36,v13
s_waitcnt lgkmcnt(7)
v_mfma_f32_16x16x32_bf16 v[108:111],v[128:131],a[248:251],v[108:111]
s_mov_b32 s29,s24
ds_read_b64_tr_b16 v[124:125],v5 offset:0
v_fma_f32 v80,v80,s36,v14
v_mfma_f32_16x16x32_bf16 v[108:111],v[132:135],a[252:255],v[108:111]
s_add_u32 m0,s22,0
ds_read_b64_tr_b16 v[126:127],v5 offset:6144
buffer_load_dwordx4 v6,s[4:7],s20 offen offset:0 lds
v_mfma_f32_16x16x32_bf16 v[108:111],v[136:139],v[144:147],v[108:111]
buffer_load_dwordx4 v7,s[4:7],s20 offen offset:1024 lds
s_waitcnt lgkmcnt(4)
v_mfma_f32_16x16x32_bf16 v[108:111],v[140:143],v[148:151],v[108:111]
buffer_load_dwordx4 v8,s[4:7],s20 offen offset:2048 lds
v_fma_f32 v81,v81,s36,v14
v_fma_f32 v82,v82,s36,v14
v_fma_f32 v83,v83,s36,v14
v_fma_f32 v88,v88,s36,v15
v_fma_f32 v89,v89,s36,v15
v_exp_f32 v72,v72
v_exp_f32 v73,v73
v_exp_f32 v74,v74
v_exp_f32 v75,v75
v_exp_f32 v80,v80
v_exp_f32 v81,v81
v_exp_f32 v82,v82
v_exp_f32 v83,v83
v_exp_f32 v88,v88
v_exp_f32 v89,v89
v_cvt_pk_bf16_f32 v44,v72,v73
v_cvt_pk_bf16_f32 v45,v74,v75
v_cvt_pk_bf16_f32 v48,v80,v81
v_cvt_pk_bf16_f32 v49,v82,v83
v_cvt_pk_bf16_f32 v52,v88,v89
s_add_u32 s20,s20,12288
v_mfma_f32_16x16x32_bf16 v[160:163],v[112:115],v[20:23],0
s_add_u32 m0,s23,0
ds_read_b64_tr_b16 v[128:129],v2 offset:128
v_fma_f32 v90,v90,s36,v15
v_mfma_f32_16x16x32_bf16 v[164:167],v[116:119],v[20:23],0
ds_read_b64_tr_b16 v[130:131],v2 offset:6272
v_fma_f32 v91,v91,s36,v15
v_mfma_f32_16x16x32_bf16 v[212:215],v[116:119],v[24:27],0
ds_read_b64_tr_b16 v[132:133],v3 offset:128
v_fma_f32 v96,v96,s36,v16
v_mfma_f32_16x16x32_bf16 v[208:211],v[112:115],v[24:27],0
ds_read_b64_tr_b16 v[134:135],v3 offset:6272
v_fma_f32 v97,v97,s36,v16
v_mfma_f32_16x16x32_bf16 a[0:3],v[112:115],v[28:31],0
ds_read_b64_tr_b16 v[136:137],v4 offset:128
v_fma_f32 v98,v98,s36,v16
v_mfma_f32_16x16x32_bf16 a[4:7],v[116:119],v[28:31],0
ds_read_b64_tr_b16 v[138:139],v4 offset:6272
v_fma_f32 v99,v99,s36,v16
v_mfma_f32_16x16x32_bf16 a[52:55],v[116:119],v[32:35],0
ds_read_b64_tr_b16 v[140:141],v5 offset:128
v_fma_f32 v104,v104,s36,v17
v_mfma_f32_16x16x32_bf16 a[48:51],v[112:115],v[32:35],0
ds_read_b64_tr_b16 v[142:143],v5 offset:6272
v_fma_f32 v105,v105,s36,v17
v_mfma_f32_16x16x32_bf16 a[96:99],v[112:115],v[36:39],0
ds_read_b64_tr_b16 v[112:113],v2 offset:256
v_fma_f32 v106,v106,s36,v17
v_mfma_f32_16x16x32_bf16 a[100:103],v[116:119],v[36:39],0
s_waitcnt lgkmcnt(6)
ds_read_b64_tr_b16 v[114:115],v2 offset:6400
v_fma_f32 v107,v107,s36,v17
v_mfma_f32_16x16x32_bf16 a[104:107],v[120:123],v[36:39],0
ds_read_b64_tr_b16 v[116:117],v3 offset:256
v_fma_f32 v76,v76,s36,v13
v_mfma_f32_16x16x32_bf16 a[108:111],v[124:127],v[36:39],0
ds_read_b64_tr_b16 v[118:119],v3 offset:6400
v_fma_f32 v77,v77,s36,v13
v_mfma_f32_16x16x32_bf16 a[60:63],v[124:127],v[32:35],0
v_exp_f32 v90,v90
v_mfma_f32_16x16x32_bf16 a[56:59],v[120:123],v[32:35],0
v_exp_f32 v91,v91
v_mfma_f32_16x16x32_bf16 a[8:11],v[120:123],v[28:31],0
v_cvt_pk_bf16_f32 v53,v90,v91
v_fma_f32 v78,v78,s36,v13
v_mfma_f32_16x16x32_bf16 a[12:15],v[124:127],v[28:31],0
v_exp_f32 v96,v96
v_mfma_f32_16x16x32_bf16 v[220:223],v[124:127],v[24:27],0
v_exp_f32 v97,v97
v_mfma_f32_16x16x32_bf16 v[216:219],v[120:123],v[24:27],0
v_exp_f32 v98,v98
v_mfma_f32_16x16x32_bf16 v[168:171],v[120:123],v[20:23],0
ds_read_b64_tr_b16 v[120:121],v4 offset:256
v_cvt_pk_bf16_f32 v56,v96,v97
v_mfma_f32_16x16x32_bf16 v[172:175],v[124:127],v[20:23],0
ds_read_b64_tr_b16 v[122:123],v4 offset:6400
v_fma_f32 v79,v79,s36,v13
v_mfma_f32_16x16x32_bf16 v[176:179],v[128:131],v[20:23],0
s_waitcnt lgkmcnt(2)
ds_read_b64_tr_b16 v[124:125],v5 offset:256
v_fma_f32 v84,v84,s36,v14
v_mfma_f32_16x16x32_bf16 v[180:183],v[132:135],v[20:23],0
ds_read_b64_tr_b16 v[126:127],v5 offset:6400
v_fma_f32 v85,v85,s36,v14
v_mfma_f32_16x16x32_bf16 v[228:231],v[132:135],v[24:27],0
v_exp_f32 v99,v99
v_mfma_f32_16x16x32_bf16 v[224:227],v[128:131],v[24:27],0
v_cvt_pk_bf16_f32 v57,v98,v99
v_fma_f32 v86,v86,s36,v14
v_mfma_f32_16x16x32_bf16 a[16:19],v[128:131],v[28:31],0
v_exp_f32 v104,v104
v_mfma_f32_16x16x32_bf16 a[20:23],v[132:135],v[28:31],0
v_exp_f32 v105,v105
v_mfma_f32_16x16x32_bf16 a[68:71],v[132:135],v[32:35],0
v_exp_f32 v106,v106
v_mfma_f32_16x16x32_bf16 a[64:67],v[128:131],v[32:35],0
v_exp_f32 v107,v107
v_mfma_f32_16x16x32_bf16 a[112:115],v[128:131],v[36:39],0
v_cvt_pk_bf16_f32 v40,v104,v105
v_cvt_pk_bf16_f32 v41,v106,v107
v_mfma_f32_16x16x32_bf16 a[116:119],v[132:135],v[36:39],0
v_exp_f32 v76,v76
v_mfma_f32_16x16x32_bf16 a[120:123],v[136:139],v[36:39],0
v_exp_f32 v77,v77
v_mfma_f32_16x16x32_bf16 a[124:127],v[140:143],v[36:39],0
v_exp_f32 v78,v78
v_mfma_f32_16x16x32_bf16 a[76:79],v[140:143],v[32:35],0
v_exp_f32 v79,v79
v_mfma_f32_16x16x32_bf16 a[72:75],v[136:139],v[32:35],0
v_cvt_pk_bf16_f32 v46,v76,v77
v_cvt_pk_bf16_f32 v47,v78,v79
v_mfma_f32_16x16x32_bf16 a[24:27],v[136:139],v[28:31],0
v_fma_f32 v87,v87,s36,v14
v_fma_f32 v92,v92,s36,v15
v_mfma_f32_16x16x32_bf16 a[28:31],v[140:143],v[28:31],0
v_exp_f32 v84,v84
v_mfma_f32_16x16x32_bf16 v[236:239],v[140:143],v[24:27],0
v_exp_f32 v85,v85
v_mfma_f32_16x16x32_bf16 v[232:235],v[136:139],v[24:27],0
v_exp_f32 v86,v86
v_mfma_f32_16x16x32_bf16 v[184:187],v[136:139],v[20:23],0
v_exp_f32 v87,v87
v_mfma_f32_16x16x32_bf16 v[188:191],v[140:143],v[20:23],0
v_cvt_pk_bf16_f32 v50,v84,v85
v_cvt_pk_bf16_f32 v51,v86,v87
v_mfma_f32_16x16x32_bf16 v[192:195],v[112:115],v[20:23],0
v_fma_f32 v93,v93,s36,v15
v_fma_f32 v94,v94,s36,v15
v_smfmac_f32_16x16x64_bf16 v[60:63],v[152:155],v[44:51],v18
v_fma_f32 v95,v95,s36,v15
v_mfma_f32_16x16x32_bf16 v[196:199],v[116:119],v[20:23],0
s_waitcnt vmcnt(6) lgkmcnt(0)
v_exp_f32 v92,v92
v_mfma_f32_16x16x32_bf16 v[244:247],v[116:119],v[24:27],0
s_barrier
v_mfma_f32_16x16x32_bf16 v[240:243],v[112:115],v[24:27],0
ds_read_b128 v[128:131],v0 offset:24576
v_fma_f32 v100,v100,s36,v16
v_mfma_f32_16x16x32_bf16 a[32:35],v[112:115],v[28:31],0
ds_read_b128 v[132:135],v1 offset:24576
v_fma_f32 v101,v101,s36,v16
v_mfma_f32_16x16x32_bf16 a[36:39],v[116:119],v[28:31],0
ds_read_b128 v[136:139],v0 offset:24704
v_fma_f32 v102,v102,s36,v16
v_mfma_f32_16x16x32_bf16 a[84:87],v[116:119],v[32:35],0
ds_read_b128 v[140:143],v1 offset:24704
v_fma_f32 v103,v103,s36,v16
v_mfma_f32_16x16x32_bf16 a[80:83],v[112:115],v[32:35],0
v_exp_f32 v93,v93
v_mfma_f32_16x16x32_bf16 a[128:131],v[112:115],v[36:39],0
buffer_load_dwordx4 v6,s[8:11],s21 offen offset:0 lds
v_mfma_f32_16x16x32_bf16 a[132:135],v[116:119],v[36:39],0
ds_read_b128 v[112:115],v0 offset:24832
v_cvt_pk_bf16_f32 v54,v92,v93
v_mfma_f32_16x16x32_bf16 a[136:139],v[120:123],v[36:39],0
ds_read_b128 v[116:119],v1 offset:24832
v_fma_f32 v108,v108,s36,v17
v_mfma_f32_16x16x32_bf16 a[140:143],v[124:127],v[36:39],0
v_exp_f32 v94,v94
v_mfma_f32_16x16x32_bf16 a[92:95],v[124:127],v[32:35],0
v_exp_f32 v95,v95
v_mfma_f32_16x16x32_bf16 a[88:91],v[120:123],v[32:35],0
v_cvt_pk_bf16_f32 v55,v94,v95
v_fma_f32 v109,v109,s36,v17
v_mfma_f32_16x16x32_bf16 a[40:43],v[120:123],v[28:31],0
v_exp_f32 v100,v100
v_mfma_f32_16x16x32_bf16 a[44:47],v[124:127],v[28:31],0
v_exp_f32 v101,v101
v_mfma_f32_16x16x32_bf16 v[252:255],v[124:127],v[24:27],0
v_exp_f32 v102,v102
v_mfma_f32_16x16x32_bf16 v[248:251],v[120:123],v[24:27],0
v_exp_f32 v103,v103
v_mfma_f32_16x16x32_bf16 v[200:203],v[120:123],v[20:23],0
ds_read_b128 v[120:123],v0 offset:30720
v_cvt_pk_bf16_f32 v58,v100,v101
v_mfma_f32_16x16x32_bf16 v[204:207],v[124:127],v[20:23],0
buffer_load_dwordx4 v7,s[8:11],s21 offen offset:1024 lds
s_waitcnt lgkmcnt(1)
v_mfma_f32_16x16x32_bf16 v[72:75],v[128:131],a[144:147],0
ds_read_b128 v[124:127],v1 offset:30720
v_cvt_pk_bf16_f32 v59,v102,v103
v_mfma_f32_16x16x32_bf16 v[72:75],v[132:135],a[148:151],v[72:75]
v_fma_f32 v110,v110,s36,v17
v_fma_f32 v111,v111,s36,v17
v_smfmac_f32_16x16x64_bf16 v[64:67],v[152:155],v[52:59],v18
v_mfma_f32_16x16x32_bf16 v[72:75],v[136:139],a[152:155],v[72:75]
v_exp_f32 v108,v108
v_mfma_f32_16x16x32_bf16 v[72:75],v[140:143],a[156:159],v[72:75]
v_exp_f32 v109,v109
v_mfma_f32_16x16x32_bf16 v[72:75],v[112:115],a[160:163],v[72:75]
v_exp_f32 v110,v110
v_mfma_f32_16x16x32_bf16 v[72:75],v[116:119],a[164:167],v[72:75]
v_exp_f32 v111,v111
v_mfma_f32_16x16x32_bf16 v[80:83],v[116:119],a[188:191],0
v_cvt_pk_bf16_f32 v42,v108,v109
v_cvt_pk_bf16_f32 v43,v110,v111
v_mfma_f32_16x16x32_bf16 v[80:83],v[112:115],a[184:187],v[80:83]
v_mfma_f32_16x16x32_bf16 v[80:83],v[140:143],a[180:183],v[80:83]
v_smfmac_f32_16x16x64_bf16 v[68:71],v[152:155],v[36:43],v18
buffer_load_dwordx4 v8,s[8:11],s21 offen offset:2048 lds
v_mfma_f32_16x16x32_bf16 v[80:83],v[136:139],a[176:179],v[80:83]
s_add_u32 s21,s21,12288
v_fma_f32 v72,v72,s36,v13
v_fma_f32 v73,v73,s36,v13
v_mfma_f32_16x16x32_bf16 v[80:83],v[132:135],a[172:175],v[80:83]
s_add_u32 m0,s22,12288
v_fma_f32 v74,v74,s36,v13
v_fma_f32 v75,v75,s36,v13
v_mfma_f32_16x16x32_bf16 v[80:83],v[128:131],a[168:171],v[80:83]
v_exp_f32 v72,v72
v_mfma_f32_16x16x32_bf16 v[88:91],v[128:131],a[192:195],0
v_exp_f32 v73,v73
v_mfma_f32_16x16x32_bf16 v[88:91],v[132:135],a[196:199],v[88:91]
v_exp_f32 v74,v74
v_mfma_f32_16x16x32_bf16 v[88:91],v[136:139],a[200:203],v[88:91]
v_exp_f32 v75,v75
v_mfma_f32_16x16x32_bf16 v[88:91],v[140:143],a[204:207],v[88:91]
v_fma_f32 v80,v80,s36,v14
v_fma_f32 v81,v81,s36,v14
v_mfma_f32_16x16x32_bf16 v[88:91],v[112:115],a[208:211],v[88:91]
v_fma_f32 v82,v82,s36,v14
v_fma_f32 v83,v83,s36,v14
v_mfma_f32_16x16x32_bf16 v[88:91],v[116:119],a[212:215],v[88:91]
v_exp_f32 v80,v80
v_mfma_f32_16x16x32_bf16 v[96:99],v[116:119],a[236:239],0
v_exp_f32 v81,v81
v_mfma_f32_16x16x32_bf16 v[96:99],v[112:115],a[232:235],v[96:99]
buffer_load_dwordx4 v6,s[4:7],s20 offen offset:0 lds
v_mfma_f32_16x16x32_bf16 v[96:99],v[140:143],a[228:231],v[96:99]
v_exp_f32 v82,v82
v_mfma_f32_16x16x32_bf16 v[96:99],v[136:139],a[224:227],v[96:99]
v_fma_f32 v88,v88,s36,v15
v_fma_f32 v89,v89,s36,v15
v_mfma_f32_16x16x32_bf16 v[96:99],v[132:135],a[220:223],v[96:99]
v_exp_f32 v83,v83
v_mfma_f32_16x16x32_bf16 v[96:99],v[128:131],a[216:219],v[96:99]
v_exp_f32 v88,v88
v_mfma_f32_16x16x32_bf16 v[104:107],v[128:131],a[240:243],0
ds_read_b128 v[128:131],v0 offset:30848
v_cvt_pk_bf16_f32 v20,v72,v73
v_mfma_f32_16x16x32_bf16 v[104:107],v[132:135],a[244:247],v[104:107]
ds_read_b128 v[132:135],v1 offset:30848
v_cvt_pk_bf16_f32 v21,v74,v75
v_mfma_f32_16x16x32_bf16 v[104:107],v[136:139],a[248:251],v[104:107]
ds_read_b128 v[136:139],v0 offset:30976
v_cvt_pk_bf16_f32 v24,v80,v81
v_mfma_f32_16x16x32_bf16 v[104:107],v[140:143],a[252:255],v[104:107]
ds_read_b128 v[140:143],v1 offset:30976
v_cvt_pk_bf16_f32 v25,v82,v83
v_mfma_f32_16x16x32_bf16 v[104:107],v[112:115],v[144:147],v[104:107]
v_exp_f32 v89,v89
v_mfma_f32_16x16x32_bf16 v[104:107],v[116:119],v[148:151],v[104:107]
s_waitcnt lgkmcnt(4)
v_cvt_pk_bf16_f32 v28,v88,v89
v_mfma_f32_16x16x32_bf16 v[76:79],v[120:123],a[144:147],0
v_mfma_f32_16x16x32_bf16 v[76:79],v[124:127],a[148:151],v[76:79]
buffer_load_dwordx4 v7,s[4:7],s20 offen offset:1024 lds
s_waitcnt lgkmcnt(3)
v_mfma_f32_16x16x32_bf16 v[76:79],v[128:131],a[152:155],v[76:79]
s_waitcnt lgkmcnt(2)
v_mfma_f32_16x16x32_bf16 v[76:79],v[132:135],a[156:159],v[76:79]
s_waitcnt lgkmcnt(1)
v_mfma_f32_16x16x32_bf16 v[76:79],v[136:139],a[160:163],v[76:79]
s_waitcnt lgkmcnt(0)
v_mfma_f32_16x16x32_bf16 v[76:79],v[140:143],a[164:167],v[76:79]
v_mfma_f32_16x16x32_bf16 v[84:87],v[140:143],a[188:191],0
v_mfma_f32_16x16x32_bf16 v[84:87],v[136:139],a[184:187],v[84:87]
v_mfma_f32_16x16x32_bf16 v[84:87],v[132:135],a[180:183],v[84:87]
v_mfma_f32_16x16x32_bf16 v[84:87],v[128:131],a[176:179],v[84:87]
v_mfma_f32_16x16x32_bf16 v[84:87],v[124:127],a[172:175],v[84:87]
v_mfma_f32_16x16x32_bf16 v[84:87],v[120:123],a[168:171],v[84:87]
v_mfma_f32_16x16x32_bf16 v[92:95],v[120:123],a[192:195],0
buffer_load_dwordx4 v8,s[4:7],s20 offen offset:2048 lds
v_mfma_f32_16x16x32_bf16 v[92:95],v[124:127],a[196:199],v[92:95]
s_add_u32 s20,s20,12288
v_mfma_f32_16x16x32_bf16 v[92:95],v[128:131],a[200:203],v[92:95]
v_mfma_f32_16x16x32_bf16 v[92:95],v[132:135],a[204:207],v[92:95]
v_mfma_f32_16x16x32_bf16 v[92:95],v[136:139],a[208:211],v[92:95]
v_mfma_f32_16x16x32_bf16 v[92:95],v[140:143],a[212:215],v[92:95]
ds_read_b64_tr_b16 v[112:113],v2 offset:12288
v_mfma_f32_16x16x32_bf16 v[100:103],v[140:143],a[236:239],0
ds_read_b64_tr_b16 v[114:115],v2 offset:18432
v_mfma_f32_16x16x32_bf16 v[100:103],v[136:139],a[232:235],v[100:103]
v_mfma_f32_16x16x32_bf16 v[100:103],v[132:135],a[228:231],v[100:103]
ds_read_b64_tr_b16 v[116:117],v3 offset:12288
v_mfma_f32_16x16x32_bf16 v[100:103],v[128:131],a[224:227],v[100:103]
ds_read_b64_tr_b16 v[118:119],v3 offset:18432
v_mfma_f32_16x16x32_bf16 v[100:103],v[124:127],a[220:223],v[100:103]
v_mfma_f32_16x16x32_bf16 v[100:103],v[120:123],a[216:219],v[100:103]
v_mfma_f32_16x16x32_bf16 v[108:111],v[120:123],a[240:243],0
ds_read_b64_tr_b16 v[120:121],v4 offset:12288
v_mfma_f32_16x16x32_bf16 v[108:111],v[124:127],a[244:247],v[108:111]
ds_read_b64_tr_b16 v[122:123],v4 offset:18432
v_mfma_f32_16x16x32_bf16 v[108:111],v[128:131],a[248:251],v[108:111]
ds_read_b64_tr_b16 v[124:125],v5 offset:12288
v_mfma_f32_16x16x32_bf16 v[108:111],v[132:135],a[252:255],v[108:111]
ds_read_b64_tr_b16 v[126:127],v5 offset:18432
v_mfma_f32_16x16x32_bf16 v[108:111],v[136:139],v[144:147],v[108:111]
v_mfma_f32_16x16x32_bf16 v[108:111],v[140:143],v[148:151],v[108:111]
s_waitcnt lgkmcnt(4)
v_mfma_f32_16x16x32_bf16 v[160:163],v[112:115],v[44:47],v[160:163]
s_add_u32 m0,s23,12288
ds_read_b64_tr_b16 v[128:129],v2 offset:12416
v_fma_f32 v90,v90,s36,v15
v_mfma_f32_16x16x32_bf16 v[164:167],v[116:119],v[44:47],v[164:167]
ds_read_b64_tr_b16 v[130:131],v2 offset:18560
v_fma_f32 v91,v91,s36,v15
v_mfma_f32_16x16x32_bf16 v[212:215],v[116:119],v[48:51],v[212:215]
ds_read_b64_tr_b16 v[132:133],v3 offset:12416
v_fma_f32 v96,v96,s36,v16
v_mfma_f32_16x16x32_bf16 v[208:211],v[112:115],v[48:51],v[208:211]
ds_read_b64_tr_b16 v[134:135],v3 offset:18560
v_fma_f32 v97,v97,s36,v16
v_mfma_f32_16x16x32_bf16 a[0:3],v[112:115],v[52:55],a[0:3]
ds_read_b64_tr_b16 v[136:137],v4 offset:12416
v_fma_f32 v98,v98,s36,v16
v_mfma_f32_16x16x32_bf16 a[4:7],v[116:119],v[52:55],a[4:7]
ds_read_b64_tr_b16 v[138:139],v4 offset:18560
v_fma_f32 v99,v99,s36,v16
v_mfma_f32_16x16x32_bf16 a[52:55],v[116:119],v[56:59],a[52:55]
ds_read_b64_tr_b16 v[140:141],v5 offset:12416
v_fma_f32 v104,v104,s36,v17
v_mfma_f32_16x16x32_bf16 a[48:51],v[112:115],v[56:59],a[48:51]
ds_read_b64_tr_b16 v[142:143],v5 offset:18560
v_fma_f32 v105,v105,s36,v17
v_mfma_f32_16x16x32_bf16 a[96:99],v[112:115],v[40:43],a[96:99]
ds_read_b64_tr_b16 v[112:113],v2 offset:12544
v_fma_f32 v106,v106,s36,v17
v_mfma_f32_16x16x32_bf16 a[100:103],v[116:119],v[40:43],a[100:103]
s_waitcnt lgkmcnt(6)
ds_read_b64_tr_b16 v[114:115],v2 offset:18688
v_fma_f32 v107,v107,s36,v17
v_mfma_f32_16x16x32_bf16 a[104:107],v[120:123],v[40:43],a[104:107]
ds_read_b64_tr_b16 v[116:117],v3 offset:12544
v_fma_f32 v76,v76,s36,v13
v_mfma_f32_16x16x32_bf16 a[108:111],v[124:127],v[40:43],a[108:111]
ds_read_b64_tr_b16 v[118:119],v3 offset:18688
v_fma_f32 v77,v77,s36,v13
v_mfma_f32_16x16x32_bf16 a[60:63],v[124:127],v[56:59],a[60:63]
v_exp_f32 v90,v90
v_mfma_f32_16x16x32_bf16 a[56:59],v[120:123],v[56:59],a[56:59]
v_exp_f32 v91,v91
v_mfma_f32_16x16x32_bf16 a[8:11],v[120:123],v[52:55],a[8:11]
v_cvt_pk_bf16_f32 v29,v90,v91
v_fma_f32 v78,v78,s36,v13
v_mfma_f32_16x16x32_bf16 a[12:15],v[124:127],v[52:55],a[12:15]
v_exp_f32 v96,v96
v_mfma_f32_16x16x32_bf16 v[220:223],v[124:127],v[48:51],v[220:223]
v_exp_f32 v97,v97
v_mfma_f32_16x16x32_bf16 v[216:219],v[120:123],v[48:51],v[216:219]
v_exp_f32 v98,v98
v_mfma_f32_16x16x32_bf16 v[168:171],v[120:123],v[44:47],v[168:171]
ds_read_b64_tr_b16 v[120:121],v4 offset:12544
v_cvt_pk_bf16_f32 v32,v96,v97
v_mfma_f32_16x16x32_bf16 v[172:175],v[124:127],v[44:47],v[172:175]
ds_read_b64_tr_b16 v[122:123],v4 offset:18688
v_fma_f32 v79,v79,s36,v13
v_mfma_f32_16x16x32_bf16 v[176:179],v[128:131],v[44:47],v[176:179]
s_waitcnt lgkmcnt(2)
ds_read_b64_tr_b16 v[124:125],v5 offset:12544
v_fma_f32 v84,v84,s36,v14
v_mfma_f32_16x16x32_bf16 v[180:183],v[132:135],v[44:47],v[180:183]
ds_read_b64_tr_b16 v[126:127],v5 offset:18688
v_fma_f32 v85,v85,s36,v14
v_mfma_f32_16x16x32_bf16 v[228:231],v[132:135],v[48:51],v[228:231]
v_exp_f32 v99,v99
v_mfma_f32_16x16x32_bf16 v[224:227],v[128:131],v[48:51],v[224:227]
v_cvt_pk_bf16_f32 v33,v98,v99
v_fma_f32 v86,v86,s36,v14
v_mfma_f32_16x16x32_bf16 a[16:19],v[128:131],v[52:55],a[16:19]
v_exp_f32 v104,v104
v_mfma_f32_16x16x32_bf16 a[20:23],v[132:135],v[52:55],a[20:23]
v_exp_f32 v105,v105
v_mfma_f32_16x16x32_bf16 a[68:71],v[132:135],v[56:59],a[68:71]
v_exp_f32 v106,v106
v_mfma_f32_16x16x32_bf16 a[64:67],v[128:131],v[56:59],a[64:67]
v_exp_f32 v107,v107
v_mfma_f32_16x16x32_bf16 a[112:115],v[128:131],v[40:43],a[112:115]
v_cvt_pk_bf16_f32 v36,v104,v105
v_cvt_pk_bf16_f32 v37,v106,v107
v_mfma_f32_16x16x32_bf16 a[116:119],v[132:135],v[40:43],a[116:119]
v_exp_f32 v76,v76
v_mfma_f32_16x16x32_bf16 a[120:123],v[136:139],v[40:43],a[120:123]
v_exp_f32 v77,v77
v_mfma_f32_16x16x32_bf16 a[124:127],v[140:143],v[40:43],a[124:127]
v_exp_f32 v78,v78
v_mfma_f32_16x16x32_bf16 a[76:79],v[140:143],v[56:59],a[76:79]
v_exp_f32 v79,v79
v_mfma_f32_16x16x32_bf16 a[72:75],v[136:139],v[56:59],a[72:75]
v_cvt_pk_bf16_f32 v22,v76,v77
v_cvt_pk_bf16_f32 v23,v78,v79
v_mfma_f32_16x16x32_bf16 a[24:27],v[136:139],v[52:55],a[24:27]
v_fma_f32 v87,v87,s36,v14
v_fma_f32 v92,v92,s36,v15
v_mfma_f32_16x16x32_bf16 a[28:31],v[140:143],v[52:55],a[28:31]
v_exp_f32 v84,v84
v_mfma_f32_16x16x32_bf16 v[236:239],v[140:143],v[48:51],v[236:239]
v_exp_f32 v85,v85
v_mfma_f32_16x16x32_bf16 v[232:235],v[136:139],v[48:51],v[232:235]
v_exp_f32 v86,v86
v_mfma_f32_16x16x32_bf16 v[184:187],v[136:139],v[44:47],v[184:187]
v_exp_f32 v87,v87
v_mfma_f32_16x16x32_bf16 v[188:191],v[140:143],v[44:47],v[188:191]
v_cvt_pk_bf16_f32 v26,v84,v85
v_cvt_pk_bf16_f32 v27,v86,v87
v_mfma_f32_16x16x32_bf16 v[192:195],v[112:115],v[44:47],v[192:195]
v_fma_f32 v93,v93,s36,v15
v_fma_f32 v94,v94,s36,v15
v_smfmac_f32_16x16x64_bf16 v[60:63],v[152:155],v[20:27],v18
v_fma_f32 v95,v95,s36,v15
v_mfma_f32_16x16x32_bf16 v[196:199],v[116:119],v[44:47],v[196:199]
s_waitcnt vmcnt(6) lgkmcnt(0)
v_exp_f32 v92,v92
v_mfma_f32_16x16x32_bf16 v[244:247],v[116:119],v[48:51],v[244:247]
s_barrier
v_mfma_f32_16x16x32_bf16 v[240:243],v[112:115],v[48:51],v[240:243]
ds_read_b128 v[128:131],v0 offset:0
v_fma_f32 v100,v100,s36,v16
v_mfma_f32_16x16x32_bf16 a[32:35],v[112:115],v[52:55],a[32:35]
ds_read_b128 v[132:135],v1 offset:0
v_fma_f32 v101,v101,s36,v16
v_mfma_f32_16x16x32_bf16 a[36:39],v[116:119],v[52:55],a[36:39]
ds_read_b128 v[136:139],v0 offset:128
v_fma_f32 v102,v102,s36,v16
v_mfma_f32_16x16x32_bf16 a[84:87],v[116:119],v[56:59],a[84:87]
ds_read_b128 v[140:143],v1 offset:128
v_fma_f32 v103,v103,s36,v16
v_mfma_f32_16x16x32_bf16 a[80:83],v[112:115],v[56:59],a[80:83]
v_exp_f32 v93,v93
v_mfma_f32_16x16x32_bf16 a[128:131],v[112:115],v[40:43],a[128:131]
buffer_load_dwordx4 v6,s[8:11],s21 offen offset:0 lds
v_mfma_f32_16x16x32_bf16 a[132:135],v[116:119],v[40:43],a[132:135]
ds_read_b128 v[112:115],v0 offset:256
v_cvt_pk_bf16_f32 v30,v92,v93
v_mfma_f32_16x16x32_bf16 a[136:139],v[120:123],v[40:43],a[136:139]
ds_read_b128 v[116:119],v1 offset:256
v_fma_f32 v108,v108,s36,v17
v_mfma_f32_16x16x32_bf16 a[140:143],v[124:127],v[40:43],a[140:143]
v_exp_f32 v94,v94
v_mfma_f32_16x16x32_bf16 a[92:95],v[124:127],v[56:59],a[92:95]
v_exp_f32 v95,v95
v_mfma_f32_16x16x32_bf16 a[88:91],v[120:123],v[56:59],a[88:91]
v_cvt_pk_bf16_f32 v31,v94,v95
v_fma_f32 v109,v109,s36,v17
v_mfma_f32_16x16x32_bf16 a[40:43],v[120:123],v[52:55],a[40:43]
v_exp_f32 v100,v100
v_mfma_f32_16x16x32_bf16 a[44:47],v[124:127],v[52:55],a[44:47]
v_exp_f32 v101,v101
v_mfma_f32_16x16x32_bf16 v[252:255],v[124:127],v[48:51],v[252:255]
v_exp_f32 v102,v102
v_mfma_f32_16x16x32_bf16 v[248:251],v[120:123],v[48:51],v[248:251]
v_exp_f32 v103,v103
v_mfma_f32_16x16x32_bf16 v[200:203],v[120:123],v[44:47],v[200:203]
ds_read_b128 v[120:123],v0 offset:6144
v_cvt_pk_bf16_f32 v34,v100,v101
v_mfma_f32_16x16x32_bf16 v[204:207],v[124:127],v[44:47],v[204:207]
buffer_load_dwordx4 v7,s[8:11],s21 offen offset:1024 lds
s_waitcnt lgkmcnt(1)
v_mfma_f32_16x16x32_bf16 v[72:75],v[128:131],a[144:147],0
ds_read_b128 v[124:127],v1 offset:6144
v_cvt_pk_bf16_f32 v35,v102,v103
v_mfma_f32_16x16x32_bf16 v[72:75],v[132:135],a[148:151],v[72:75]
v_fma_f32 v110,v110,s36,v17
v_fma_f32 v111,v111,s36,v17
v_smfmac_f32_16x16x64_bf16 v[64:67],v[152:155],v[28:35],v18
v_mfma_f32_16x16x32_bf16 v[72:75],v[136:139],a[152:155],v[72:75]
v_exp_f32 v108,v108
v_mfma_f32_16x16x32_bf16 v[72:75],v[140:143],a[156:159],v[72:75]
v_exp_f32 v109,v109
v_mfma_f32_16x16x32_bf16 v[72:75],v[112:115],a[160:163],v[72:75]
v_exp_f32 v110,v110
v_mfma_f32_16x16x32_bf16 v[72:75],v[116:119],a[164:167],v[72:75]
v_exp_f32 v111,v111
v_mfma_f32_16x16x32_bf16 v[80:83],v[116:119],a[188:191],0
v_cvt_pk_bf16_f32 v38,v108,v109
v_cvt_pk_bf16_f32 v39,v110,v111
v_mfma_f32_16x16x32_bf16 v[80:83],v[112:115],a[184:187],v[80:83]
v_mfma_f32_16x16x32_bf16 v[80:83],v[140:143],a[180:183],v[80:83]
v_mfma_f32_16x16x32_bf16 v[80:83],v[136:139],a[176:179],v[80:83]
buffer_load_dwordx4 v8,s[8:11],s21 offen offset:2048 lds
v_mfma_f32_16x16x32_bf16 v[80:83],v[132:135],a[172:175],v[80:83]
s_add_u32 s21,s21,12288
v_fma_f32 v72,v72,s36,v13
v_fma_f32 v73,v73,s36,v13
v_mfma_f32_16x16x32_bf16 v[80:83],v[128:131],a[168:171],v[80:83]
s_add_u32 m0,s22,24576
v_fma_f32 v74,v74,s36,v13
v_fma_f32 v75,v75,s36,v13
v_mfma_f32_16x16x32_bf16 v[88:91],v[128:131],a[192:195],0
v_exp_f32 v72,v72
v_mfma_f32_16x16x32_bf16 v[88:91],v[132:135],a[196:199],v[88:91]
v_exp_f32 v73,v73
v_mfma_f32_16x16x32_bf16 v[88:91],v[136:139],a[200:203],v[88:91]
v_fma_f32 v80,v80,s36,v14
v_fma_f32 v81,v81,s36,v14
v_mfma_f32_16x16x32_bf16 v[88:91],v[140:143],a[204:207],v[88:91]
v_fma_f32 v82,v82,s36,v14
v_fma_f32 v83,v83,s36,v14
v_mfma_f32_16x16x32_bf16 v[88:91],v[112:115],a[208:211],v[88:91]
v_exp_f32 v74,v74
v_mfma_f32_16x16x32_bf16 v[88:91],v[116:119],a[212:215],v[88:91]
v_exp_f32 v75,v75
v_mfma_f32_16x16x32_bf16 v[96:99],v[116:119],a[236:239],0
v_exp_f32 v80,v80
v_mfma_f32_16x16x32_bf16 v[96:99],v[112:115],a[232:235],v[96:99]
v_exp_f32 v81,v81
v_mfma_f32_16x16x32_bf16 v[96:99],v[140:143],a[228:231],v[96:99]
v_exp_f32 v82,v82
v_mfma_f32_16x16x32_bf16 v[96:99],v[136:139],a[224:227],v[96:99]
buffer_load_dwordx4 v6,s[4:7],s20 offen offset:0 lds
v_mfma_f32_16x16x32_bf16 v[96:99],v[132:135],a[220:223],v[96:99]
v_fma_f32 v88,v88,s36,v15
v_fma_f32 v89,v89,s36,v15
v_mfma_f32_16x16x32_bf16 v[96:99],v[128:131],a[216:219],v[96:99]
v_exp_f32 v83,v83
v_mfma_f32_16x16x32_bf16 v[104:107],v[128:131],a[240:243],0
ds_read_b128 v[128:131],v0 offset:6272
v_cvt_pk_bf16_f32 v44,v72,v73
v_mfma_f32_16x16x32_bf16 v[104:107],v[132:135],a[244:247],v[104:107]
ds_read_b128 v[132:135],v1 offset:6272
v_cvt_pk_bf16_f32 v45,v74,v75
v_mfma_f32_16x16x32_bf16 v[104:107],v[136:139],a[248:251],v[104:107]
ds_read_b128 v[136:139],v0 offset:6400
v_cvt_pk_bf16_f32 v48,v80,v81
v_mfma_f32_16x16x32_bf16 v[104:107],v[140:143],a[252:255],v[104:107]
ds_read_b128 v[140:143],v1 offset:6400
v_cvt_pk_bf16_f32 v49,v82,v83
v_mfma_f32_16x16x32_bf16 v[104:107],v[112:115],v[144:147],v[104:107]
v_exp_f32 v88,v88
v_mfma_f32_16x16x32_bf16 v[104:107],v[116:119],v[148:151],v[104:107]
s_waitcnt lgkmcnt(4)
v_exp_f32 v89,v89
v_mfma_f32_16x16x32_bf16 v[76:79],v[120:123],a[144:147],0
v_cvt_pk_bf16_f32 v52,v88,v89
v_mfma_f32_16x16x32_bf16 v[76:79],v[124:127],a[148:151],v[76:79]
s_waitcnt lgkmcnt(3)
v_mfma_f32_16x16x32_bf16 v[76:79],v[128:131],a[152:155],v[76:79]
buffer_load_dwordx4 v7,s[4:7],s20 offen offset:1024 lds
s_waitcnt lgkmcnt(2)
v_mfma_f32_16x16x32_bf16 v[76:79],v[132:135],a[156:159],v[76:79]
s_waitcnt lgkmcnt(1)
v_mfma_f32_16x16x32_bf16 v[76:79],v[136:139],a[160:163],v[76:79]
s_waitcnt lgkmcnt(0)
v_mfma_f32_16x16x32_bf16 v[76:79],v[140:143],a[164:167],v[76:79]
v_mfma_f32_16x16x32_bf16 v[84:87],v[140:143],a[188:191],0
v_mfma_f32_16x16x32_bf16 v[84:87],v[136:139],a[184:187],v[84:87]
v_mfma_f32_16x16x32_bf16 v[84:87],v[132:135],a[180:183],v[84:87]
v_mfma_f32_16x16x32_bf16 v[84:87],v[128:131],a[176:179],v[84:87]
v_mfma_f32_16x16x32_bf16 v[84:87],v[124:127],a[172:175],v[84:87]
v_mfma_f32_16x16x32_bf16 v[84:87],v[120:123],a[168:171],v[84:87]
v_mfma_f32_16x16x32_bf16 v[92:95],v[120:123],a[192:195],0
v_mfma_f32_16x16x32_bf16 v[92:95],v[124:127],a[196:199],v[92:95]
buffer_load_dwordx4 v8,s[4:7],s20 offen offset:2048 lds
v_mfma_f32_16x16x32_bf16 v[92:95],v[128:131],a[200:203],v[92:95]
s_add_u32 s20,s20,12288
v_mfma_f32_16x16x32_bf16 v[92:95],v[132:135],a[204:207],v[92:95]
v_mfma_f32_16x16x32_bf16 v[92:95],v[136:139],a[208:211],v[92:95]
v_mfma_f32_16x16x32_bf16 v[92:95],v[140:143],a[212:215],v[92:95]
v_mfma_f32_16x16x32_bf16 v[100:103],v[140:143],a[236:239],0
v_mfma_f32_16x16x32_bf16 v[100:103],v[136:139],a[232:235],v[100:103]
ds_read_b64_tr_b16 v[112:113],v2 offset:24576
v_mfma_f32_16x16x32_bf16 v[100:103],v[132:135],a[228:231],v[100:103]
ds_read_b64_tr_b16 v[114:115],v2 offset:30720
v_mfma_f32_16x16x32_bf16 v[100:103],v[128:131],a[224:227],v[100:103]
ds_read_b64_tr_b16 v[116:117],v3 offset:24576
v_mfma_f32_16x16x32_bf16 v[100:103],v[124:127],a[220:223],v[100:103]
ds_read_b64_tr_b16 v[118:119],v3 offset:30720
v_mfma_f32_16x16x32_bf16 v[100:103],v[120:123],a[216:219],v[100:103]
v_mfma_f32_16x16x32_bf16 v[108:111],v[120:123],a[240:243],0
ds_read_b64_tr_b16 v[120:121],v4 offset:24576
v_mfma_f32_16x16x32_bf16 v[108:111],v[124:127],a[244:247],v[108:111]
ds_read_b64_tr_b16 v[122:123],v4 offset:30720
v_mfma_f32_16x16x32_bf16 v[108:111],v[128:131],a[248:251],v[108:111]
ds_read_b64_tr_b16 v[124:125],v5 offset:24576
v_mfma_f32_16x16x32_bf16 v[108:111],v[132:135],a[252:255],v[108:111]
ds_read_b64_tr_b16 v[126:127],v5 offset:30720
v_mfma_f32_16x16x32_bf16 v[108:111],v[136:139],v[144:147],v[108:111]
v_mfma_f32_16x16x32_bf16 v[108:111],v[140:143],v[148:151],v[108:111]
s_mov_b32 s38,0
s_branch L_loop5
L_start4:
s_add_u32 m0,s24,12288
s_waitcnt vmcnt(9)
ds_read_b128 a[144:147],v11 offset:0
buffer_load_dwordx4 v6,s[12:15],s28 offen offset:0 nt lds
ds_read_b128 a[148:151],v12 offset:0
buffer_load_dwordx4 v7,s[12:15],s28 offen offset:1024 nt lds
ds_read_b128 a[152:155],v11 offset:128
buffer_load_dwordx4 v8,s[12:15],s28 offen offset:2048 nt lds
s_add_u32 s28,s28,3072
s_add_u32 m0,s24,15360
ds_read_b128 a[156:159],v12 offset:128
buffer_load_dwordx4 v6,s[12:15],s28 offen offset:0 nt lds
ds_read_b128 a[160:163],v11 offset:256
buffer_load_dwordx4 v7,s[12:15],s28 offen offset:1024 nt lds
ds_read_b128 a[164:167],v12 offset:256
buffer_load_dwordx4 v8,s[12:15],s28 offen offset:2048 nt lds
s_add_u32 s28,s28,3072
s_add_u32 m0,s24,0
ds_read_b128 v[112:115],v0 offset:0
v_mov_b32 v60,0
ds_read_b128 v[116:119],v1 offset:0
v_mov_b32 v61,0
ds_read_b128 v[120:123],v0 offset:128
v_mov_b32 v62,0
ds_read_b128 v[124:127],v1 offset:128
v_mov_b32 v63,0
ds_read_b128 v[128:131],v0 offset:256
v_mov_b32 v64,0
ds_read_b128 v[132:135],v1 offset:256
v_mov_b32 v65,0
ds_read_b128 v[136:139],v0 offset:6144
v_mov_b32 v66,0
ds_read_b128 v[140:143],v1 offset:6144
v_mov_b32 v67,0
s_waitcnt lgkmcnt(7)
v_mfma_f32_16x16x32_bf16 v[72:75],v[112:115],a[144:147],0
s_waitcnt lgkmcnt(6)
ds_read_b128 v[112:115],v0 offset:6272
v_mfma_f32_16x16x32_bf16 v[72:75],v[116:119],a[148:151],v[72:75]
s_waitcnt lgkmcnt(6)
ds_read_b128 v[116:119],v1 offset:6272
v_mfma_f32_16x16x32_bf16 v[72:75],v[120:123],a[152:155],v[72:75]
s_waitcnt lgkmcnt(6)
ds_read_b128 v[120:123],v0 offset:6400
v_mfma_f32_16x16x32_bf16 v[72:75],v[124:127],a[156:159],v[72:75]
s_waitcnt lgkmcnt(6)
ds_read_b128 v[124:127],v1 offset:6400
v_mfma_f32_16x16x32_bf16 v[72:75],v[128:131],a[160:163],v[72:75]
s_waitcnt lgkmcnt(6)
ds_read_b128 v[128:131],v0 offset:0
v_mfma_f32_16x16x32_bf16 v[72:75],v[132:135],a[164:167],v[72:75]
s_waitcnt lgkmcnt(6)
ds_read_b128 v[132:135],v1 offset:0
v_mfma_f32_16x16x32_bf16 v[76:79],v[136:139],a[144:147],0
s_waitcnt lgkmcnt(6)
ds_read_b128 v[136:139],v0 offset:128
v_mfma_f32_16x16x32_bf16 v[76:79],v[140:143],a[148:151],v[76:79]
s_waitcnt lgkmcnt(6)
ds_read_b128 v[140:143],v1 offset:128
v_mfma_f32_16x16x32_bf16 v[76:79],v[112:115],a[152:155],v[76:79]
s_waitcnt lgkmcnt(6)
ds_read_b128 v[112:115],v0 offset:256
v_mfma_f32_16x16x32_bf16 v[76:79],v[116:119],a[156:159],v[76:79]
s_waitcnt lgkmcnt(6)
ds_read_b128 v[116:119],v1 offset:256
v_max3_f32 v44,v72,v73,v74
v_mfma_f32_16x16x32_bf16 v[76:79],v[120:123],a[160:163],v[76:79]
s_waitcnt lgkmcnt(6)
ds_read_b128 v[120:123],v0 offset:6144
v_mfma_f32_16x16x32_bf16 v[76:79],v[124:127],a[164:167],v[76:79]
s_waitcnt vmcnt(6)
ds_read_b128 a[168:171],v11 offset:6144
buffer_load_dwordx4 v6,s[12:15],s28 offen offset:0 nt lds
ds_read_b128 a[172:175],v12 offset:6144
buffer_load_dwordx4 v7,s[12:15],s28 offen offset:1024 nt lds
ds_read_b128 a[176:179],v11 offset:6272
buffer_load_dwordx4 v8,s[12:15],s28 offen offset:2048 nt lds
s_add_u32 s28,s28,3072
s_add_u32 m0,s24,3072
ds_read_b128 a[180:183],v12 offset:6272
buffer_load_dwordx4 v6,s[12:15],s28 offen offset:0 nt lds
ds_read_b128 a[184:187],v11 offset:6400
buffer_load_dwordx4 v7,s[12:15],s28 offen offset:1024 nt lds
ds_read_b128 a[188:191],v12 offset:6400
buffer_load_dwordx4 v8,s[12:15],s28 offen offset:2048 nt lds
s_add_u32 s28,s28,3072
s_add_u32 m0,s23,0
ds_read_b128 v[124:127],v1 offset:6144
v_max3_f32 v44,v44,v75,v76
s_waitcnt lgkmcnt(6)
v_mfma_f32_16x16x32_bf16 v[80:83],v[128:131],a[168:171],0
s_waitcnt lgkmcnt(5)
ds_read_b128 v[128:131],v0 offset:6272
v_max3_f32 v44,v44,v77,v78
v_mfma_f32_16x16x32_bf16 v[80:83],v[132:135],a[172:175],v[80:83]
s_waitcnt lgkmcnt(5)
ds_read_b128 v[132:135],v1 offset:6272
v_max_f32 v44,v44,v79
v_mfma_f32_16x16x32_bf16 v[80:83],v[136:139],a[176:179],v[80:83]
s_waitcnt lgkmcnt(5)
ds_read_b128 v[136:139],v0 offset:6400
v_mov_b32 v45,v44
v_mfma_f32_16x16x32_bf16 v[80:83],v[140:143],a[180:183],v[80:83]
s_waitcnt lgkmcnt(5)
ds_read_b128 v[140:143],v1 offset:6400
v_permlane32_swap_b32 v45,v44
v_mfma_f32_16x16x32_bf16 v[80:83],v[112:115],a[184:187],v[80:83]
s_waitcnt lgkmcnt(5)
ds_read_b128 v[112:115],v0 offset:12288
v_max_f32 v44,v44,v45
v_mfma_f32_16x16x32_bf16 v[80:83],v[116:119],a[188:191],v[80:83]
ds_read_b128 v[116:119],v1 offset:12288
v_mov_b32 v45,v44
v_mfma_f32_16x16x32_bf16 v[84:87],v[120:123],a[168:171],0
s_waitcnt lgkmcnt(5)
ds_read_b128 v[120:123],v0 offset:12416
v_permlane16_swap_b32 v45,v44
v_mfma_f32_16x16x32_bf16 v[84:87],v[124:127],a[172:175],v[84:87]
ds_read_b128 v[124:127],v1 offset:12416
v_max_f32 v44,v44,v45
v_mfma_f32_16x16x32_bf16 v[84:87],v[128:131],a[176:179],v[84:87]
s_waitcnt lgkmcnt(5)
ds_read_b128 v[128:131],v0 offset:12544
v_mul_f32_e64 v13,-s36,v44
v_mfma_f32_16x16x32_bf16 v[84:87],v[132:135],a[180:183],v[84:87]
ds_read_b128 v[132:135],v1 offset:12544
v_fma_f32 v72,v72,s36,v13
v_mfma_f32_16x16x32_bf16 v[84:87],v[136:139],a[184:187],v[84:87]
s_waitcnt lgkmcnt(5)
ds_read_b128 v[136:139],v0 offset:18432
v_fma_f32 v73,v73,s36,v13
v_mfma_f32_16x16x32_bf16 v[84:87],v[140:143],a[188:191],v[84:87]
ds_read_b128 v[140:143],v1 offset:18432
v_fma_f32 v74,v74,s36,v13
v_fma_f32 v75,v75,s36,v13
v_exp_f32 v72,v72
v_exp_f32 v73,v73
v_exp_f32 v74,v74
v_exp_f32 v75,v75
v_cvt_pk_bf16_f32 v20,v72,v73
v_cvt_pk_bf16_f32 v21,v74,v75
v_mfma_f32_16x16x32_bf16 v[72:75],v[112:115],a[144:147],0
s_waitcnt lgkmcnt(3)
ds_read_b128 v[112:115],v0 offset:18560
v_fma_f32 v76,v76,s36,v13
v_mfma_f32_16x16x32_bf16 v[72:75],v[116:119],a[148:151],v[72:75]
ds_read_b128 v[116:119],v1 offset:18560
v_fma_f32 v77,v77,s36,v13
v_mfma_f32_16x16x32_bf16 v[72:75],v[120:123],a[152:155],v[72:75]
ds_read_b128 v[120:123],v0 offset:18688
v_fma_f32 v78,v78,s36,v13
v_mfma_f32_16x16x32_bf16 v[72:75],v[124:127],a[156:159],v[72:75]
ds_read_b128 v[124:127],v1 offset:18688
v_fma_f32 v79,v79,s36,v13
v_mfma_f32_16x16x32_bf16 v[72:75],v[128:131],a[160:163],v[72:75]
s_waitcnt lgkmcnt(4)
ds_read_b128 v[128:131],v0 offset:0
v_exp_f32 v76,v76
v_mfma_f32_16x16x32_bf16 v[72:75],v[132:135],a[164:167],v[72:75]
ds_read_b128 v[132:135],v1 offset:0
v_exp_f32 v77,v77
v_exp_f32 v78,v78
v_exp_f32 v79,v79
v_cvt_pk_bf16_f32 v22,v76,v77
v_cvt_pk_bf16_f32 v23,v78,v79
v_mfma_f32_16x16x32_bf16 v[76:79],v[136:139],a[144:147],0
ds_read_b128 v[136:139],v0 offset:128
v_max3_f32 v48,v80,v81,v82
v_mfma_f32_16x16x32_bf16 v[76:79],v[140:143],a[148:151],v[76:79]
s_waitcnt lgkmcnt(4)
ds_read_b128 v[140:143],v1 offset:128
v_max3_f32 v48,v48,v83,v84
v_mfma_f32_16x16x32_bf16 v[76:79],v[112:115],a[152:155],v[76:79]
ds_read_b128 v[112:115],v0 offset:256
v_max3_f32 v48,v48,v85,v86
v_mfma_f32_16x16x32_bf16 v[76:79],v[116:119],a[156:159],v[76:79]
ds_read_b128 v[116:119],v1 offset:256
v_max_f32 v48,v48,v87
v_mfma_f32_16x16x32_bf16 v[76:79],v[120:123],a[160:163],v[76:79]
s_waitcnt lgkmcnt(4)
ds_read_b128 v[120:123],v0 offset:6144
v_mov_b32 v49,v48
v_mfma_f32_16x16x32_bf16 v[76:79],v[124:127],a[164:167],v[76:79]
s_waitcnt vmcnt(6)
ds_read_b128 a[192:195],v11 offset:12288
buffer_load_dwordx4 v6,s[8:11],s21 offen offset:0 lds
ds_read_b128 a[196:199],v12 offset:12288
buffer_load_dwordx4 v7,s[8:11],s21 offen offset:1024 lds
ds_read_b128 a[200:203],v11 offset:12416
buffer_load_dwordx4 v8,s[8:11],s21 offen offset:2048 lds
s_add_u32 s21,s21,12288
s_add_u32 m0,s22,24576
ds_read_b128 a[204:207],v12 offset:12416
buffer_load_dwordx4 v6,s[4:7],s20 offen offset:0 lds
ds_read_b128 a[208:211],v11 offset:12544
buffer_load_dwordx4 v7,s[4:7],s20 offen offset:1024 lds
ds_read_b128 a[212:215],v12 offset:12544
buffer_load_dwordx4 v8,s[4:7],s20 offen offset:2048 lds
s_add_u32 s20,s20,12288
s_add_u32 m0,s23,12288
ds_read_b128 v[124:127],v1 offset:6144
v_permlane32_swap_b32 v49,v48
s_waitcnt lgkmcnt(6)
v_mfma_f32_16x16x32_bf16 v[88:91],v[128:131],a[192:195],0
s_waitcnt lgkmcnt(5)
ds_read_b128 v[128:131],v0 offset:6272
v_max_f32 v48,v48,v49
v_mfma_f32_16x16x32_bf16 v[88:91],v[132:135],a[196:199],v[88:91]
s_waitcnt lgkmcnt(5)
ds_read_b128 v[132:135],v1 offset:6272
v_mov_b32 v49,v48
v_mfma_f32_16x16x32_bf16 v[88:91],v[136:139],a[200:203],v[88:91]
s_waitcnt lgkmcnt(5)
ds_read_b128 v[136:139],v0 offset:6400
v_permlane16_swap_b32 v49,v48
v_mfma_f32_16x16x32_bf16 v[88:91],v[140:143],a[204:207],v[88:91]
s_waitcnt lgkmcnt(4)
ds_read_b128 v[140:143],v1 offset:6400
v_max_f32 v48,v48,v49
v_mfma_f32_16x16x32_bf16 v[88:91],v[112:115],a[208:211],v[88:91]
ds_read_b128 v[112:115],v0 offset:12288
v_mul_f32_e64 v14,-s36,v48
v_mfma_f32_16x16x32_bf16 v[88:91],v[116:119],a[212:215],v[88:91]
ds_read_b128 v[116:119],v1 offset:12288
v_fma_f32 v80,v80,s36,v14
v_mfma_f32_16x16x32_bf16 v[92:95],v[120:123],a[192:195],0
s_waitcnt lgkmcnt(5)
ds_read_b128 v[120:123],v0 offset:12416
v_fma_f32 v81,v81,s36,v14
v_mfma_f32_16x16x32_bf16 v[92:95],v[124:127],a[196:199],v[92:95]
ds_read_b128 v[124:127],v1 offset:12416
v_fma_f32 v82,v82,s36,v14
v_mfma_f32_16x16x32_bf16 v[92:95],v[128:131],a[200:203],v[92:95]
s_waitcnt lgkmcnt(5)
ds_read_b128 v[128:131],v0 offset:12544
v_fma_f32 v83,v83,s36,v14
v_mfma_f32_16x16x32_bf16 v[92:95],v[132:135],a[204:207],v[92:95]
ds_read_b128 v[132:135],v1 offset:12544
v_exp_f32 v80,v80
v_mfma_f32_16x16x32_bf16 v[92:95],v[136:139],a[208:211],v[92:95]
s_waitcnt lgkmcnt(5)
ds_read_b128 v[136:139],v0 offset:18432
v_exp_f32 v81,v81
v_mfma_f32_16x16x32_bf16 v[92:95],v[140:143],a[212:215],v[92:95]
ds_read_b128 v[140:143],v1 offset:18432
v_exp_f32 v82,v82
v_exp_f32 v83,v83
v_cvt_pk_bf16_f32 v24,v80,v81
v_cvt_pk_bf16_f32 v25,v82,v83
v_mfma_f32_16x16x32_bf16 v[80:83],v[112:115],a[168:171],0
s_waitcnt lgkmcnt(4)
ds_read_b128 v[112:115],v0 offset:18560
v_fma_f32 v84,v84,s36,v14
v_mfma_f32_16x16x32_bf16 v[80:83],v[116:119],a[172:175],v[80:83]
ds_read_b128 v[116:119],v1 offset:18560
v_fma_f32 v85,v85,s36,v14
v_mfma_f32_16x16x32_bf16 v[80:83],v[120:123],a[176:179],v[80:83]
ds_read_b128 v[120:123],v0 offset:18688
v_fma_f32 v86,v86,s36,v14
v_mfma_f32_16x16x32_bf16 v[80:83],v[124:127],a[180:183],v[80:83]
s_waitcnt lgkmcnt(4)
ds_read_b128 v[124:127],v1 offset:18688
v_fma_f32 v87,v87,s36,v14
v_mfma_f32_16x16x32_bf16 v[80:83],v[128:131],a[184:187],v[80:83]
ds_read_b128 v[128:131],v0 offset:0
v_exp_f32 v84,v84
v_mfma_f32_16x16x32_bf16 v[80:83],v[132:135],a[188:191],v[80:83]
ds_read_b128 v[132:135],v1 offset:0
v_exp_f32 v85,v85
v_exp_f32 v86,v86
v_exp_f32 v87,v87
v_cvt_pk_bf16_f32 v26,v84,v85
v_cvt_pk_bf16_f32 v27,v86,v87
v_mfma_f32_16x16x32_bf16 v[84:87],v[136:139],a[168:171],0
ds_read_b128 v[136:139],v0 offset:128
v_max3_f32 v52,v88,v89,v90
v_smfmac_f32_16x16x64_bf16 v[60:63],v[152:155],v[20:27],v18
s_waitcnt lgkmcnt(4)
v_max3_f32 v52,v52,v91,v92
v_mfma_f32_16x16x32_bf16 v[84:87],v[140:143],a[172:175],v[84:87]
ds_read_b128 v[140:143],v1 offset:128
v_max3_f32 v52,v52,v93,v94
v_mfma_f32_16x16x32_bf16 v[84:87],v[112:115],a[176:179],v[84:87]
ds_read_b128 v[112:115],v0 offset:256
v_max_f32 v52,v52,v95
v_mfma_f32_16x16x32_bf16 v[84:87],v[116:119],a[180:183],v[84:87]
ds_read_b128 v[116:119],v1 offset:256
v_mov_b32 v53,v52
v_mfma_f32_16x16x32_bf16 v[84:87],v[120:123],a[184:187],v[84:87]
s_waitcnt lgkmcnt(4)
ds_read_b128 v[120:123],v0 offset:6144
v_permlane32_swap_b32 v53,v52
v_mfma_f32_16x16x32_bf16 v[84:87],v[124:127],a[188:191],v[84:87]
s_waitcnt vmcnt(6)
ds_read_b128 a[216:219],v11 offset:0
buffer_load_dwordx4 v6,s[8:11],s21 offen offset:0 lds
ds_read_b128 a[220:223],v12 offset:0
buffer_load_dwordx4 v7,s[8:11],s21 offen offset:1024 lds
ds_read_b128 a[224:227],v11 offset:128
buffer_load_dwordx4 v8,s[8:11],s21 offen offset:2048 lds
s_add_u32 s21,s21,12288
s_add_u32 m0,s23,24576
ds_read_b128 a[228:231],v12 offset:128
buffer_load_dwordx4 v6,s[8:11],s21 offen offset:0 lds
ds_read_b128 a[232:235],v11 offset:256
buffer_load_dwordx4 v7,s[8:11],s21 offen offset:1024 lds
ds_read_b128 a[236:239],v12 offset:256
buffer_load_dwordx4 v8,s[8:11],s21 offen offset:2048 lds
s_add_u32 s21,s21,12288
ds_read_b128 v[124:127],v1 offset:6144
v_max_f32 v52,v52,v53
v_mov_b32 v53,v52
s_waitcnt lgkmcnt(6)
v_mfma_f32_16x16x32_bf16 v[96:99],v[128:131],a[216:219],0
s_mov_b32 s27,166723584
ds_read_b128 v[128:131],v0 offset:6272
v_permlane16_swap_b32 v53,v52
s_waitcnt lgkmcnt(6)
v_mfma_f32_16x16x32_bf16 v[96:99],v[132:135],a[220:223],v[96:99]
s_mov_b32 s42,s41
ds_read_b128 v[132:135],v1 offset:6272
v_max_f32 v52,v52,v53
s_waitcnt lgkmcnt(6)
v_mfma_f32_16x16x32_bf16 v[96:99],v[136:139],a[224:227],v[96:99]
s_add_u32 s69,s69,1
ds_read_b128 v[136:139],v0 offset:6400
v_mul_f32_e64 v15,-s36,v52
v_fma_f32 v88,v88,s36,v15
s_waitcnt lgkmcnt(6)
v_mfma_f32_16x16x32_bf16 v[96:99],v[140:143],a[228:231],v[96:99]
s_lshl_b32 s62,s69,5
ds_read_b128 v[140:143],v1 offset:6400
v_fma_f32 v89,v89,s36,v15
s_waitcnt lgkmcnt(5)
v_mfma_f32_16x16x32_bf16 v[96:99],v[112:115],a[232:235],v[96:99]
s_add_u32 s62,s62,s34
ds_read_b128 v[112:115],v0 offset:12288
v_fma_f32 v90,v90,s36,v15
v_mfma_f32_16x16x32_bf16 v[96:99],v[116:119],a[236:239],v[96:99]
s_mul_i32 s63,s62,171
ds_read_b128 v[116:119],v1 offset:12288
v_fma_f32 v91,v91,s36,v15
v_mfma_f32_16x16x32_bf16 v[100:103],v[120:123],a[216:219],0
s_lshr_b32 s63,s63,9
ds_read_b128 v[120:123],v0 offset:12416
v_exp_f32 v88,v88
s_waitcnt lgkmcnt(6)
v_mfma_f32_16x16x32_bf16 v[100:103],v[124:127],a[220:223],v[100:103]
s_mul_i32 s64,s63,3
ds_read_b128 v[124:127],v1 offset:12416
v_exp_f32 v89,v89
v_mfma_f32_16x16x32_bf16 v[100:103],v[128:131],a[224:227],v[100:103]
s_sub_u32 s62,s62,s64
ds_read_b128 v[128:131],v0 offset:12544
v_exp_f32 v90,v90
s_waitcnt lgkmcnt(6)
v_mfma_f32_16x16x32_bf16 v[100:103],v[132:135],a[228:231],v[100:103]
s_add_u32 s63,s63,s33
ds_read_b128 v[132:135],v1 offset:12544
v_exp_f32 v91,v91
v_mfma_f32_16x16x32_bf16 v[100:103],v[136:139],a[232:235],v[100:103]
s_mul_i32 s30,s63,196608
ds_read_b128 v[136:139],v0 offset:18432
v_cvt_pk_bf16_f32 v28,v88,v89
s_waitcnt lgkmcnt(6)
v_mfma_f32_16x16x32_bf16 v[100:103],v[140:143],a[236:239],v[100:103]
s_waitcnt vmcnt(9)
s_barrier
ds_read_b128 v[140:143],v1 offset:18432
v_cvt_pk_bf16_f32 v29,v90,v91
v_mfma_f32_16x16x32_bf16 v[88:91],v[112:115],a[192:195],0
s_mul_i32 s41,s63,325632
ds_read_b128 v[112:115],v0 offset:18560
v_fma_f32 v92,v92,s36,v15
s_waitcnt lgkmcnt(5)
v_mfma_f32_16x16x32_bf16 v[88:91],v[116:119],a[196:199],v[88:91]
s_lshl_b32 s63,s3,2
ds_read_b128 v[116:119],v1 offset:18560
v_fma_f32 v93,v93,s36,v15
v_mfma_f32_16x16x32_bf16 v[88:91],v[120:123],a[200:203],v[88:91]
s_add_u32 s64,s63,21
ds_read_b128 v[120:123],v0 offset:18688
v_fma_f32 v94,v94,s36,v15
v_mfma_f32_16x16x32_bf16 v[88:91],v[124:127],a[204:207],v[88:91]
s_cmp_eq_u32 s3,0
ds_read_b128 v[124:127],v1 offset:18688
v_fma_f32 v95,v95,s36,v15
s_waitcnt lgkmcnt(6)
v_mfma_f32_16x16x32_bf16 v[88:91],v[128:131],a[208:211],v[88:91]
s_cselect_b32 s64,20,s64
ds_read_b128 v[128:131],v0 offset:12288
v_exp_f32 v92,v92
v_mfma_f32_16x16x32_bf16 v[88:91],v[132:135],a[212:215],v[88:91]
s_cselect_b32 s40,1,0
ds_read_b128 v[132:135],v1 offset:12288
v_exp_f32 v93,v93
v_exp_f32 v94,v94
v_exp_f32 v95,v95
v_cvt_pk_bf16_f32 v30,v92,v93
v_cvt_pk_bf16_f32 v31,v94,v95
s_waitcnt lgkmcnt(5)
v_mfma_f32_16x16x32_bf16 v[92:95],v[136:139],a[192:195],0
s_add_u32 s65,s63,37
ds_read_b128 v[136:139],v0 offset:12416
v_max3_f32 v56,v96,v97,v98
v_mfma_f32_16x16x32_bf16 v[92:95],v[140:143],a[196:199],v[92:95]
s_cmp_eq_u32 s62,2
ds_read_b128 v[140:143],v1 offset:12416
v_max3_f32 v56,v56,v99,v100
v_mfma_f32_16x16x32_bf16 v[92:95],v[112:115],a[200:203],v[92:95]
s_cselect_b32 s64,s65,s64
ds_read_b128 v[112:115],v0 offset:12544
v_max3_f32 v56,v56,v101,v102
s_waitcnt lgkmcnt(5)
v_mfma_f32_16x16x32_bf16 v[92:95],v[116:119],a[204:207],v[92:95]
s_cselect_b32 s40,0,s40
ds_read_b128 v[116:119],v1 offset:12544
v_max_f32 v56,v56,v103
v_mfma_f32_16x16x32_bf16 v[92:95],v[120:123],a[208:211],v[92:95]
s_add_u32 s65,s63,s3
ds_read_b128 v[120:123],v0 offset:18432
v_mov_b32 v57,v56
v_mfma_f32_16x16x32_bf16 v[92:95],v[124:127],a[212:215],v[92:95]
s_cmp_eq_u32 s62,0
ds_read_b128 v[124:127],v1 offset:18432
v_permlane32_swap_b32 v57,v56
v_max_f32 v56,v56,v57
v_mov_b32 v57,v56
v_fma_f32 v72,v72,s36,v13
v_fma_f32 v73,v73,s36,v13
v_permlane16_swap_b32 v57,v56
v_max_f32 v56,v56,v57
v_mul_f32_e64 v16,-s36,v56
v_fma_f32 v96,v96,s36,v16
v_fma_f32 v97,v97,s36,v16
v_fma_f32 v98,v98,s36,v16
v_fma_f32 v99,v99,s36,v16
v_exp_f32 v96,v96
v_exp_f32 v97,v97
v_exp_f32 v98,v98
v_exp_f32 v99,v99
v_cvt_pk_bf16_f32 v32,v96,v97
v_cvt_pk_bf16_f32 v33,v98,v99
s_waitcnt lgkmcnt(2)
v_mfma_f32_16x16x32_bf16 v[96:99],v[128:131],a[216:219],0
s_cselect_b32 s64,s65,s64
ds_read_b128 v[128:131],v0 offset:18560
v_fma_f32 v100,v100,s36,v16
v_mfma_f32_16x16x32_bf16 v[96:99],v[132:135],a[220:223],v[96:99]
s_cselect_b32 s40,1,s40
ds_read_b128 v[132:135],v1 offset:18560
v_fma_f32 v101,v101,s36,v16
v_mfma_f32_16x16x32_bf16 v[96:99],v[136:139],a[224:227],v[96:99]
s_mul_i32 s64,s64,6144
ds_read_b128 v[136:139],v0 offset:18688
v_fma_f32 v102,v102,s36,v16
v_mfma_f32_16x16x32_bf16 v[96:99],v[140:143],a[228:231],v[96:99]
s_add_u32 s41,s41,s64
ds_read_b128 v[140:143],v1 offset:18688
v_fma_f32 v103,v103,s36,v16
v_mfma_f32_16x16x32_bf16 v[96:99],v[112:115],a[232:235],v[96:99]
s_cmp_ge_u32 s69,6
ds_read_b64_tr_b16 v[112:113],v2 offset:0
v_exp_f32 v100,v100
v_mfma_f32_16x16x32_bf16 v[96:99],v[116:119],a[236:239],v[96:99]
s_cselect_b32 s41,166723584,s41
ds_read_b64_tr_b16 v[114:115],v2 offset:6144
ds_read_b64_tr_b16 v[116:117],v3 offset:0
ds_read_b64_tr_b16 v[118:119],v3 offset:6144
v_exp_f32 v101,v101
v_exp_f32 v102,v102
v_exp_f32 v103,v103
v_cvt_pk_bf16_f32 v34,v100,v101
v_cvt_pk_bf16_f32 v35,v102,v103
s_waitcnt lgkmcnt(7)
v_mfma_f32_16x16x32_bf16 v[100:103],v[120:123],a[216:219],0
s_cselect_b32 s30,100663296,s30
ds_read_b64_tr_b16 v[120:121],v4 offset:0
v_fma_f32 v74,v74,s36,v13
v_smfmac_f32_16x16x64_bf16 v[64:67],v[152:155],v[28:35],v18
s_add_u32 s25,s30,s22
s_add_u32 s26,s25,12288
ds_read_b64_tr_b16 v[122:123],v4 offset:6144
v_mfma_f32_16x16x32_bf16 v[100:103],v[124:127],a[220:223],v[100:103]
s_mov_b32 s28,s41
ds_read_b64_tr_b16 v[124:125],v5 offset:0
v_fma_f32 v75,v75,s36,v13
v_mfma_f32_16x16x32_bf16 v[100:103],v[128:131],a[224:227],v[100:103]
s_mov_b32 s29,s24
ds_read_b64_tr_b16 v[126:127],v5 offset:6144
v_fma_f32 v80,v80,s36,v14
s_waitcnt lgkmcnt(7)
v_mfma_f32_16x16x32_bf16 v[100:103],v[132:135],a[228:231],v[100:103]
s_add_u32 m0,s22,0
v_fma_f32 v81,v81,s36,v14
v_exp_f32 v72,v72
v_mfma_f32_16x16x32_bf16 v[100:103],v[136:139],a[232:235],v[100:103]
buffer_load_dwordx4 v6,s[4:7],s20 offen offset:0 lds
v_mfma_f32_16x16x32_bf16 v[100:103],v[140:143],a[236:239],v[100:103]
buffer_load_dwordx4 v7,s[4:7],s20 offen offset:1024 lds
buffer_load_dwordx4 v8,s[4:7],s20 offen offset:2048 lds
v_exp_f32 v73,v73
v_exp_f32 v74,v74
v_exp_f32 v75,v75
v_exp_f32 v80,v80
v_exp_f32 v81,v81
v_cvt_pk_bf16_f32 v44,v72,v73
v_cvt_pk_bf16_f32 v45,v74,v75
v_cvt_pk_bf16_f32 v48,v80,v81
s_add_u32 s20,s20,12288
s_waitcnt lgkmcnt(0)
v_mfma_f32_16x16x32_bf16 v[160:163],v[112:115],v[20:23],0
s_add_u32 m0,s23,0
ds_read_b64_tr_b16 v[128:129],v2 offset:128
v_fma_f32 v82,v82,s36,v14
v_mfma_f32_16x16x32_bf16 v[164:167],v[116:119],v[20:23],0
ds_read_b64_tr_b16 v[130:131],v2 offset:6272
v_fma_f32 v83,v83,s36,v14
v_mfma_f32_16x16x32_bf16 v[212:215],v[116:119],v[24:27],0
ds_read_b64_tr_b16 v[132:133],v3 offset:128
v_fma_f32 v88,v88,s36,v15
v_mfma_f32_16x16x32_bf16 v[208:211],v[112:115],v[24:27],0
ds_read_b64_tr_b16 v[134:135],v3 offset:6272
v_fma_f32 v89,v89,s36,v15
v_mfma_f32_16x16x32_bf16 a[0:3],v[112:115],v[28:31],0
ds_read_b64_tr_b16 v[136:137],v4 offset:128
v_fma_f32 v90,v90,s36,v15
v_mfma_f32_16x16x32_bf16 a[4:7],v[116:119],v[28:31],0
ds_read_b64_tr_b16 v[138:139],v4 offset:6272
v_fma_f32 v91,v91,s36,v15
v_mfma_f32_16x16x32_bf16 a[52:55],v[116:119],v[32:35],0
ds_read_b64_tr_b16 v[140:141],v5 offset:128
v_fma_f32 v96,v96,s36,v16
v_mfma_f32_16x16x32_bf16 a[48:51],v[112:115],v[32:35],0
ds_read_b64_tr_b16 v[142:143],v5 offset:6272
v_fma_f32 v97,v97,s36,v16
v_mfma_f32_16x16x32_bf16 a[56:59],v[120:123],v[32:35],0
ds_read_b64_tr_b16 v[112:113],v2 offset:256
v_fma_f32 v98,v98,s36,v16
v_mfma_f32_16x16x32_bf16 a[60:63],v[124:127],v[32:35],0
ds_read_b64_tr_b16 v[114:115],v2 offset:6400
v_fma_f32 v99,v99,s36,v16
v_mfma_f32_16x16x32_bf16 a[12:15],v[124:127],v[28:31],0
ds_read_b64_tr_b16 v[116:117],v3 offset:256
v_fma_f32 v76,v76,s36,v13
v_mfma_f32_16x16x32_bf16 a[8:11],v[120:123],v[28:31],0
ds_read_b64_tr_b16 v[118:119],v3 offset:6400
v_fma_f32 v77,v77,s36,v13
v_mfma_f32_16x16x32_bf16 v[216:219],v[120:123],v[24:27],0
v_exp_f32 v82,v82
v_mfma_f32_16x16x32_bf16 v[220:223],v[124:127],v[24:27],0
v_exp_f32 v83,v83
v_mfma_f32_16x16x32_bf16 v[172:175],v[124:127],v[20:23],0
ds_read_b64_tr_b16 v[124:125],v5 offset:256
v_cvt_pk_bf16_f32 v49,v82,v83
v_mfma_f32_16x16x32_bf16 v[168:171],v[120:123],v[20:23],0
s_waitcnt lgkmcnt(4)
ds_read_b64_tr_b16 v[120:121],v4 offset:256
v_fma_f32 v78,v78,s36,v13
v_mfma_f32_16x16x32_bf16 v[176:179],v[128:131],v[20:23],0
ds_read_b64_tr_b16 v[122:123],v4 offset:6400
v_fma_f32 v79,v79,s36,v13
v_mfma_f32_16x16x32_bf16 v[180:183],v[132:135],v[20:23],0
ds_read_b64_tr_b16 v[126:127],v5 offset:6400
v_fma_f32 v84,v84,s36,v14
v_mfma_f32_16x16x32_bf16 v[228:231],v[132:135],v[24:27],0
v_exp_f32 v88,v88
v_mfma_f32_16x16x32_bf16 v[224:227],v[128:131],v[24:27],0
v_exp_f32 v89,v89
v_mfma_f32_16x16x32_bf16 a[16:19],v[128:131],v[28:31],0
v_exp_f32 v90,v90
v_mfma_f32_16x16x32_bf16 a[20:23],v[132:135],v[28:31],0
v_exp_f32 v91,v91
v_mfma_f32_16x16x32_bf16 a[68:71],v[132:135],v[32:35],0
v_cvt_pk_bf16_f32 v52,v88,v89
v_cvt_pk_bf16_f32 v53,v90,v91
v_mfma_f32_16x16x32_bf16 a[64:67],v[128:131],v[32:35],0
v_exp_f32 v96,v96
v_mfma_f32_16x16x32_bf16 a[72:75],v[136:139],v[32:35],0
v_exp_f32 v97,v97
v_mfma_f32_16x16x32_bf16 a[76:79],v[140:143],v[32:35],0
v_exp_f32 v98,v98
v_mfma_f32_16x16x32_bf16 a[28:31],v[140:143],v[28:31],0
v_exp_f32 v99,v99
v_mfma_f32_16x16x32_bf16 a[24:27],v[136:139],v[28:31],0
v_cvt_pk_bf16_f32 v56,v96,v97
v_cvt_pk_bf16_f32 v57,v98,v99
v_mfma_f32_16x16x32_bf16 v[232:235],v[136:139],v[24:27],0
v_exp_f32 v76,v76
v_mfma_f32_16x16x32_bf16 v[236:239],v[140:143],v[24:27],0
v_exp_f32 v77,v77
v_mfma_f32_16x16x32_bf16 v[188:191],v[140:143],v[20:23],0
v_exp_f32 v78,v78
v_mfma_f32_16x16x32_bf16 v[184:187],v[136:139],v[20:23],0
s_waitcnt lgkmcnt(0)
v_exp_f32 v79,v79
v_mfma_f32_16x16x32_bf16 v[192:195],v[112:115],v[20:23],0
v_cvt_pk_bf16_f32 v46,v76,v77
v_cvt_pk_bf16_f32 v47,v78,v79
v_mfma_f32_16x16x32_bf16 v[196:199],v[116:119],v[20:23],0
s_waitcnt vmcnt(6)
v_fma_f32 v85,v85,s36,v14
v_fma_f32 v86,v86,s36,v14
v_mfma_f32_16x16x32_bf16 v[244:247],v[116:119],v[24:27],0
s_barrier
v_mfma_f32_16x16x32_bf16 v[240:243],v[112:115],v[24:27],0
ds_read_b128 v[140:143],v1 offset:24704
v_fma_f32 v87,v87,s36,v14
v_mfma_f32_16x16x32_bf16 a[32:35],v[112:115],v[28:31],0
ds_read_b128 v[136:139],v0 offset:24704
v_fma_f32 v92,v92,s36,v15
v_mfma_f32_16x16x32_bf16 a[36:39],v[116:119],v[28:31],0
ds_read_b128 v[132:135],v1 offset:24576
v_fma_f32 v93,v93,s36,v15
v_mfma_f32_16x16x32_bf16 a[84:87],v[116:119],v[32:35],0
ds_read_b128 v[116:119],v1 offset:24832
v_fma_f32 v94,v94,s36,v15
v_mfma_f32_16x16x32_bf16 a[80:83],v[112:115],v[32:35],0
ds_read_b128 v[112:115],v0 offset:24832
v_fma_f32 v95,v95,s36,v15
v_mfma_f32_16x16x32_bf16 a[88:91],v[120:123],v[32:35],0
buffer_load_dwordx4 v6,s[8:11],s21 offen offset:0 lds
v_mfma_f32_16x16x32_bf16 a[92:95],v[124:127],v[32:35],0
ds_read_b128 v[128:131],v0 offset:24576
v_fma_f32 v100,v100,s36,v16
v_mfma_f32_16x16x32_bf16 a[44:47],v[124:127],v[28:31],0
v_exp_f32 v84,v84
v_mfma_f32_16x16x32_bf16 a[40:43],v[120:123],v[28:31],0
v_exp_f32 v85,v85
v_mfma_f32_16x16x32_bf16 v[248:251],v[120:123],v[24:27],0
v_exp_f32 v86,v86
v_mfma_f32_16x16x32_bf16 v[252:255],v[124:127],v[24:27],0
v_exp_f32 v87,v87
v_mfma_f32_16x16x32_bf16 v[204:207],v[124:127],v[20:23],0
ds_read_b128 v[124:127],v1 offset:30720
v_cvt_pk_bf16_f32 v50,v84,v85
v_mfma_f32_16x16x32_bf16 v[200:203],v[120:123],v[20:23],0
s_waitcnt lgkmcnt(2)
ds_read_b128 v[120:123],v0 offset:30720
v_cvt_pk_bf16_f32 v51,v86,v87
v_mfma_f32_16x16x32_bf16 v[72:75],v[116:119],a[164:167],0
v_exp_f32 v92,v92
v_smfmac_f32_16x16x64_bf16 v[60:63],v[152:155],v[44:51],v18
buffer_load_dwordx4 v7,s[8:11],s21 offen offset:1024 lds
v_mfma_f32_16x16x32_bf16 v[72:75],v[112:115],a[160:163],v[72:75]
v_exp_f32 v93,v93
v_mfma_f32_16x16x32_bf16 v[72:75],v[140:143],a[156:159],v[72:75]
v_exp_f32 v94,v94
v_mfma_f32_16x16x32_bf16 v[72:75],v[136:139],a[152:155],v[72:75]
v_exp_f32 v95,v95
v_mfma_f32_16x16x32_bf16 v[72:75],v[132:135],a[148:151],v[72:75]
s_waitcnt lgkmcnt(1)
v_cvt_pk_bf16_f32 v54,v92,v93
v_cvt_pk_bf16_f32 v55,v94,v95
v_mfma_f32_16x16x32_bf16 v[72:75],v[128:131],a[144:147],v[72:75]
v_fma_f32 v101,v101,s36,v16
v_fma_f32 v102,v102,s36,v16
v_mfma_f32_16x16x32_bf16 v[80:83],v[128:131],a[168:171],0
v_fma_f32 v103,v103,s36,v16
v_mfma_f32_16x16x32_bf16 v[80:83],v[132:135],a[172:175],v[80:83]
v_exp_f32 v100,v100
v_mfma_f32_16x16x32_bf16 v[80:83],v[136:139],a[176:179],v[80:83]
buffer_load_dwordx4 v8,s[8:11],s21 offen offset:2048 lds
v_mfma_f32_16x16x32_bf16 v[80:83],v[140:143],a[180:183],v[80:83]
s_add_u32 s21,s21,12288
v_exp_f32 v101,v101
v_mfma_f32_16x16x32_bf16 v[80:83],v[112:115],a[184:187],v[80:83]
s_add_u32 m0,s22,12288
v_exp_f32 v102,v102
v_mfma_f32_16x16x32_bf16 v[80:83],v[116:119],a[188:191],v[80:83]
v_exp_f32 v103,v103
v_mfma_f32_16x16x32_bf16 v[88:91],v[116:119],a[212:215],0
v_cvt_pk_bf16_f32 v58,v100,v101
v_cvt_pk_bf16_f32 v59,v102,v103
v_mfma_f32_16x16x32_bf16 v[88:91],v[112:115],a[208:211],v[88:91]
v_fma_f32 v72,v72,s36,v13
v_fma_f32 v73,v73,s36,v13
v_smfmac_f32_16x16x64_bf16 v[64:67],v[152:155],v[52:59],v18
v_fma_f32 v74,v74,s36,v13
v_mfma_f32_16x16x32_bf16 v[88:91],v[140:143],a[204:207],v[88:91]
v_fma_f32 v75,v75,s36,v13
v_fma_f32 v80,v80,s36,v14
v_mfma_f32_16x16x32_bf16 v[88:91],v[136:139],a[200:203],v[88:91]
v_fma_f32 v81,v81,s36,v14
v_mfma_f32_16x16x32_bf16 v[88:91],v[132:135],a[196:199],v[88:91]
buffer_load_dwordx4 v6,s[4:7],s20 offen offset:0 lds
v_mfma_f32_16x16x32_bf16 v[88:91],v[128:131],a[192:195],v[88:91]
v_exp_f32 v72,v72
v_mfma_f32_16x16x32_bf16 v[96:99],v[128:131],a[216:219],0
ds_read_b128 v[128:131],v0 offset:30848
v_mfma_f32_16x16x32_bf16 v[96:99],v[132:135],a[220:223],v[96:99]
ds_read_b128 v[132:135],v1 offset:30848
v_mfma_f32_16x16x32_bf16 v[96:99],v[136:139],a[224:227],v[96:99]
ds_read_b128 v[136:139],v0 offset:30976
v_mfma_f32_16x16x32_bf16 v[96:99],v[140:143],a[228:231],v[96:99]
ds_read_b128 v[140:143],v1 offset:30976
v_mfma_f32_16x16x32_bf16 v[96:99],v[112:115],a[232:235],v[96:99]
v_exp_f32 v73,v73
v_mfma_f32_16x16x32_bf16 v[96:99],v[116:119],a[236:239],v[96:99]
s_waitcnt lgkmcnt(4)
v_exp_f32 v74,v74
v_mfma_f32_16x16x32_bf16 v[76:79],v[120:123],a[144:147],0
v_exp_f32 v75,v75
v_mfma_f32_16x16x32_bf16 v[76:79],v[124:127],a[148:151],v[76:79]
buffer_load_dwordx4 v7,s[4:7],s20 offen offset:1024 lds
s_waitcnt lgkmcnt(3)
v_mfma_f32_16x16x32_bf16 v[76:79],v[128:131],a[152:155],v[76:79]
s_waitcnt lgkmcnt(2)
v_exp_f32 v80,v80
v_mfma_f32_16x16x32_bf16 v[76:79],v[132:135],a[156:159],v[76:79]
s_waitcnt lgkmcnt(0)
v_exp_f32 v81,v81
v_mfma_f32_16x16x32_bf16 v[76:79],v[136:139],a[160:163],v[76:79]
v_cvt_pk_bf16_f32 v20,v72,v73
v_cvt_pk_bf16_f32 v21,v74,v75
v_mfma_f32_16x16x32_bf16 v[76:79],v[140:143],a[164:167],v[76:79]
v_cvt_pk_bf16_f32 v24,v80,v81
v_mfma_f32_16x16x32_bf16 v[84:87],v[140:143],a[188:191],0
v_mfma_f32_16x16x32_bf16 v[84:87],v[136:139],a[184:187],v[84:87]
v_mfma_f32_16x16x32_bf16 v[84:87],v[132:135],a[180:183],v[84:87]
v_mfma_f32_16x16x32_bf16 v[84:87],v[128:131],a[176:179],v[84:87]
v_mfma_f32_16x16x32_bf16 v[84:87],v[124:127],a[172:175],v[84:87]
buffer_load_dwordx4 v8,s[4:7],s20 offen offset:2048 lds
v_mfma_f32_16x16x32_bf16 v[84:87],v[120:123],a[168:171],v[84:87]
s_add_u32 s20,s20,12288
v_mfma_f32_16x16x32_bf16 v[92:95],v[120:123],a[192:195],0
ds_read_b64_tr_b16 v[112:113],v2 offset:12288
v_mfma_f32_16x16x32_bf16 v[92:95],v[124:127],a[196:199],v[92:95]
ds_read_b64_tr_b16 v[114:115],v2 offset:18432
v_mfma_f32_16x16x32_bf16 v[92:95],v[128:131],a[200:203],v[92:95]
ds_read_b64_tr_b16 v[116:117],v3 offset:12288
v_mfma_f32_16x16x32_bf16 v[92:95],v[132:135],a[204:207],v[92:95]
ds_read_b64_tr_b16 v[118:119],v3 offset:18432
v_mfma_f32_16x16x32_bf16 v[92:95],v[136:139],a[208:211],v[92:95]
v_mfma_f32_16x16x32_bf16 v[92:95],v[140:143],a[212:215],v[92:95]
v_mfma_f32_16x16x32_bf16 v[100:103],v[140:143],a[236:239],0
v_mfma_f32_16x16x32_bf16 v[100:103],v[136:139],a[232:235],v[100:103]
v_mfma_f32_16x16x32_bf16 v[100:103],v[132:135],a[228:231],v[100:103]
v_mfma_f32_16x16x32_bf16 v[100:103],v[128:131],a[224:227],v[100:103]
v_mfma_f32_16x16x32_bf16 v[100:103],v[124:127],a[220:223],v[100:103]
ds_read_b64_tr_b16 v[124:125],v5 offset:12288
v_mfma_f32_16x16x32_bf16 v[100:103],v[120:123],a[216:219],v[100:103]
s_waitcnt lgkmcnt(1)
ds_read_b64_tr_b16 v[120:121],v4 offset:12288
ds_read_b64_tr_b16 v[122:123],v4 offset:18432
ds_read_b64_tr_b16 v[126:127],v5 offset:18432
v_mfma_f32_16x16x32_bf16 v[160:163],v[112:115],v[44:47],v[160:163]
s_add_u32 m0,s23,12288
ds_read_b64_tr_b16 v[128:129],v2 offset:12416
v_fma_f32 v82,v82,s36,v14
v_mfma_f32_16x16x32_bf16 v[164:167],v[116:119],v[44:47],v[164:167]
ds_read_b64_tr_b16 v[130:131],v2 offset:18560
v_fma_f32 v83,v83,s36,v14
v_mfma_f32_16x16x32_bf16 v[212:215],v[116:119],v[48:51],v[212:215]
ds_read_b64_tr_b16 v[132:133],v3 offset:12416
v_fma_f32 v88,v88,s36,v15
v_mfma_f32_16x16x32_bf16 v[208:211],v[112:115],v[48:51],v[208:211]
ds_read_b64_tr_b16 v[134:135],v3 offset:18560
v_fma_f32 v89,v89,s36,v15
v_mfma_f32_16x16x32_bf16 a[0:3],v[112:115],v[52:55],a[0:3]
ds_read_b64_tr_b16 v[136:137],v4 offset:12416
v_fma_f32 v90,v90,s36,v15
v_mfma_f32_16x16x32_bf16 a[4:7],v[116:119],v[52:55],a[4:7]
ds_read_b64_tr_b16 v[138:139],v4 offset:18560
v_fma_f32 v91,v91,s36,v15
v_mfma_f32_16x16x32_bf16 a[52:55],v[116:119],v[56:59],a[52:55]
ds_read_b64_tr_b16 v[140:141],v5 offset:12416
v_fma_f32 v96,v96,s36,v16
v_mfma_f32_16x16x32_bf16 a[48:51],v[112:115],v[56:59],a[48:51]
s_waitcnt lgkmcnt(6)
ds_read_b64_tr_b16 v[142:143],v5 offset:18560
v_fma_f32 v97,v97,s36,v16
v_mfma_f32_16x16x32_bf16 a[56:59],v[120:123],v[56:59],a[56:59]
ds_read_b64_tr_b16 v[112:113],v2 offset:12544
v_fma_f32 v98,v98,s36,v16
v_mfma_f32_16x16x32_bf16 a[60:63],v[124:127],v[56:59],a[60:63]
ds_read_b64_tr_b16 v[114:115],v2 offset:18688
v_fma_f32 v99,v99,s36,v16
v_mfma_f32_16x16x32_bf16 a[12:15],v[124:127],v[52:55],a[12:15]
ds_read_b64_tr_b16 v[116:117],v3 offset:12544
v_fma_f32 v76,v76,s36,v13
v_mfma_f32_16x16x32_bf16 a[8:11],v[120:123],v[52:55],a[8:11]
ds_read_b64_tr_b16 v[118:119],v3 offset:18688
v_fma_f32 v77,v77,s36,v13
v_mfma_f32_16x16x32_bf16 v[216:219],v[120:123],v[48:51],v[216:219]
v_exp_f32 v82,v82
v_mfma_f32_16x16x32_bf16 v[220:223],v[124:127],v[48:51],v[220:223]
v_exp_f32 v83,v83
v_mfma_f32_16x16x32_bf16 v[172:175],v[124:127],v[44:47],v[172:175]
ds_read_b64_tr_b16 v[124:125],v5 offset:12544
v_cvt_pk_bf16_f32 v25,v82,v83
v_mfma_f32_16x16x32_bf16 v[168:171],v[120:123],v[44:47],v[168:171]
s_waitcnt lgkmcnt(4)
ds_read_b64_tr_b16 v[120:121],v4 offset:12544
v_fma_f32 v78,v78,s36,v13
v_mfma_f32_16x16x32_bf16 v[176:179],v[128:131],v[44:47],v[176:179]
ds_read_b64_tr_b16 v[122:123],v4 offset:18688
v_fma_f32 v79,v79,s36,v13
v_mfma_f32_16x16x32_bf16 v[180:183],v[132:135],v[44:47],v[180:183]
ds_read_b64_tr_b16 v[126:127],v5 offset:18688
v_fma_f32 v84,v84,s36,v14
v_mfma_f32_16x16x32_bf16 v[228:231],v[132:135],v[48:51],v[228:231]
v_exp_f32 v88,v88
v_mfma_f32_16x16x32_bf16 v[224:227],v[128:131],v[48:51],v[224:227]
v_exp_f32 v89,v89
v_mfma_f32_16x16x32_bf16 a[16:19],v[128:131],v[52:55],a[16:19]
v_exp_f32 v90,v90
v_mfma_f32_16x16x32_bf16 a[20:23],v[132:135],v[52:55],a[20:23]
v_exp_f32 v91,v91
v_mfma_f32_16x16x32_bf16 a[68:71],v[132:135],v[56:59],a[68:71]
v_cvt_pk_bf16_f32 v28,v88,v89
v_cvt_pk_bf16_f32 v29,v90,v91
v_mfma_f32_16x16x32_bf16 a[64:67],v[128:131],v[56:59],a[64:67]
v_exp_f32 v96,v96
v_mfma_f32_16x16x32_bf16 a[72:75],v[136:139],v[56:59],a[72:75]
v_exp_f32 v97,v97
v_mfma_f32_16x16x32_bf16 a[76:79],v[140:143],v[56:59],a[76:79]
v_exp_f32 v98,v98
v_mfma_f32_16x16x32_bf16 a[28:31],v[140:143],v[52:55],a[28:31]
v_exp_f32 v99,v99
v_mfma_f32_16x16x32_bf16 a[24:27],v[136:139],v[52:55],a[24:27]
v_cvt_pk_bf16_f32 v32,v96,v97
v_cvt_pk_bf16_f32 v33,v98,v99
v_mfma_f32_16x16x32_bf16 v[232:235],v[136:139],v[48:51],v[232:235]
v_exp_f32 v76,v76
v_mfma_f32_16x16x32_bf16 v[236:239],v[140:143],v[48:51],v[236:239]
v_exp_f32 v77,v77
v_mfma_f32_16x16x32_bf16 v[188:191],v[140:143],v[44:47],v[188:191]
v_exp_f32 v78,v78
v_mfma_f32_16x16x32_bf16 v[184:187],v[136:139],v[44:47],v[184:187]
s_waitcnt lgkmcnt(0)
v_exp_f32 v79,v79
v_mfma_f32_16x16x32_bf16 v[192:195],v[112:115],v[44:47],v[192:195]
v_cvt_pk_bf16_f32 v22,v76,v77
v_cvt_pk_bf16_f32 v23,v78,v79
v_mfma_f32_16x16x32_bf16 v[196:199],v[116:119],v[44:47],v[196:199]
s_waitcnt vmcnt(6)
v_fma_f32 v85,v85,s36,v14
v_fma_f32 v86,v86,s36,v14
v_mfma_f32_16x16x32_bf16 v[244:247],v[116:119],v[48:51],v[244:247]
s_barrier
v_mfma_f32_16x16x32_bf16 v[240:243],v[112:115],v[48:51],v[240:243]
ds_read_b128 v[140:143],v1 offset:128
v_fma_f32 v87,v87,s36,v14
v_mfma_f32_16x16x32_bf16 a[32:35],v[112:115],v[52:55],a[32:35]
ds_read_b128 v[136:139],v0 offset:128
v_fma_f32 v92,v92,s36,v15
v_mfma_f32_16x16x32_bf16 a[36:39],v[116:119],v[52:55],a[36:39]
ds_read_b128 v[132:135],v1 offset:0
v_fma_f32 v93,v93,s36,v15
v_mfma_f32_16x16x32_bf16 a[84:87],v[116:119],v[56:59],a[84:87]
ds_read_b128 v[116:119],v1 offset:256
v_fma_f32 v94,v94,s36,v15
v_mfma_f32_16x16x32_bf16 a[80:83],v[112:115],v[56:59],a[80:83]
ds_read_b128 v[112:115],v0 offset:256
v_fma_f32 v95,v95,s36,v15
v_mfma_f32_16x16x32_bf16 a[88:91],v[120:123],v[56:59],a[88:91]
buffer_load_dwordx4 v6,s[8:11],s21 offen offset:0 lds
v_mfma_f32_16x16x32_bf16 a[92:95],v[124:127],v[56:59],a[92:95]
ds_read_b128 v[128:131],v0 offset:0
v_fma_f32 v100,v100,s36,v16
v_mfma_f32_16x16x32_bf16 a[44:47],v[124:127],v[52:55],a[44:47]
v_exp_f32 v84,v84
v_mfma_f32_16x16x32_bf16 a[40:43],v[120:123],v[52:55],a[40:43]
v_exp_f32 v85,v85
v_mfma_f32_16x16x32_bf16 v[248:251],v[120:123],v[48:51],v[248:251]
v_exp_f32 v86,v86
v_mfma_f32_16x16x32_bf16 v[252:255],v[124:127],v[48:51],v[252:255]
v_exp_f32 v87,v87
v_mfma_f32_16x16x32_bf16 v[204:207],v[124:127],v[44:47],v[204:207]
ds_read_b128 v[124:127],v1 offset:6144
v_cvt_pk_bf16_f32 v26,v84,v85
v_mfma_f32_16x16x32_bf16 v[200:203],v[120:123],v[44:47],v[200:203]
s_waitcnt lgkmcnt(2)
ds_read_b128 v[120:123],v0 offset:6144
v_cvt_pk_bf16_f32 v27,v86,v87
v_mfma_f32_16x16x32_bf16 v[72:75],v[116:119],a[164:167],0
v_exp_f32 v92,v92
v_smfmac_f32_16x16x64_bf16 v[60:63],v[152:155],v[20:27],v18
buffer_load_dwordx4 v7,s[8:11],s21 offen offset:1024 lds
v_mfma_f32_16x16x32_bf16 v[72:75],v[112:115],a[160:163],v[72:75]
v_exp_f32 v93,v93
v_mfma_f32_16x16x32_bf16 v[72:75],v[140:143],a[156:159],v[72:75]
v_exp_f32 v94,v94
v_mfma_f32_16x16x32_bf16 v[72:75],v[136:139],a[152:155],v[72:75]
v_exp_f32 v95,v95
v_mfma_f32_16x16x32_bf16 v[72:75],v[132:135],a[148:151],v[72:75]
s_waitcnt lgkmcnt(1)
v_cvt_pk_bf16_f32 v30,v92,v93
v_cvt_pk_bf16_f32 v31,v94,v95
v_mfma_f32_16x16x32_bf16 v[72:75],v[128:131],a[144:147],v[72:75]
v_fma_f32 v101,v101,s36,v16
v_fma_f32 v102,v102,s36,v16
v_mfma_f32_16x16x32_bf16 v[80:83],v[128:131],a[168:171],0
v_fma_f32 v103,v103,s36,v16
v_mfma_f32_16x16x32_bf16 v[80:83],v[132:135],a[172:175],v[80:83]
v_exp_f32 v100,v100
v_mfma_f32_16x16x32_bf16 v[80:83],v[136:139],a[176:179],v[80:83]
buffer_load_dwordx4 v8,s[8:11],s21 offen offset:2048 lds
v_mfma_f32_16x16x32_bf16 v[80:83],v[140:143],a[180:183],v[80:83]
s_add_u32 s21,s21,12288
v_exp_f32 v101,v101
v_mfma_f32_16x16x32_bf16 v[80:83],v[112:115],a[184:187],v[80:83]
s_add_u32 m0,s22,24576
v_exp_f32 v102,v102
v_mfma_f32_16x16x32_bf16 v[80:83],v[116:119],a[188:191],v[80:83]
v_exp_f32 v103,v103
v_mfma_f32_16x16x32_bf16 v[88:91],v[116:119],a[212:215],0
v_cvt_pk_bf16_f32 v34,v100,v101
v_cvt_pk_bf16_f32 v35,v102,v103
v_mfma_f32_16x16x32_bf16 v[88:91],v[112:115],a[208:211],v[88:91]
v_fma_f32 v72,v72,s36,v13
v_fma_f32 v73,v73,s36,v13
v_smfmac_f32_16x16x64_bf16 v[64:67],v[152:155],v[28:35],v18
v_fma_f32 v74,v74,s36,v13
v_mfma_f32_16x16x32_bf16 v[88:91],v[140:143],a[204:207],v[88:91]
v_fma_f32 v75,v75,s36,v13
v_fma_f32 v80,v80,s36,v14
v_mfma_f32_16x16x32_bf16 v[88:91],v[136:139],a[200:203],v[88:91]
v_fma_f32 v81,v81,s36,v14
v_mfma_f32_16x16x32_bf16 v[88:91],v[132:135],a[196:199],v[88:91]
buffer_load_dwordx4 v6,s[4:7],s20 offen offset:0 lds
v_mfma_f32_16x16x32_bf16 v[88:91],v[128:131],a[192:195],v[88:91]
v_exp_f32 v72,v72
v_mfma_f32_16x16x32_bf16 v[96:99],v[128:131],a[216:219],0
ds_read_b128 v[128:131],v0 offset:6272
v_mfma_f32_16x16x32_bf16 v[96:99],v[132:135],a[220:223],v[96:99]
ds_read_b128 v[132:135],v1 offset:6272
v_mfma_f32_16x16x32_bf16 v[96:99],v[136:139],a[224:227],v[96:99]
ds_read_b128 v[136:139],v0 offset:6400
v_mfma_f32_16x16x32_bf16 v[96:99],v[140:143],a[228:231],v[96:99]
ds_read_b128 v[140:143],v1 offset:6400
v_mfma_f32_16x16x32_bf16 v[96:99],v[112:115],a[232:235],v[96:99]
v_exp_f32 v73,v73
v_mfma_f32_16x16x32_bf16 v[96:99],v[116:119],a[236:239],v[96:99]
s_waitcnt lgkmcnt(4)
v_exp_f32 v74,v74
v_mfma_f32_16x16x32_bf16 v[76:79],v[120:123],a[144:147],0
v_exp_f32 v75,v75
v_mfma_f32_16x16x32_bf16 v[76:79],v[124:127],a[148:151],v[76:79]
buffer_load_dwordx4 v7,s[4:7],s20 offen offset:1024 lds
s_waitcnt lgkmcnt(3)
v_mfma_f32_16x16x32_bf16 v[76:79],v[128:131],a[152:155],v[76:79]
s_waitcnt lgkmcnt(2)
v_exp_f32 v80,v80
v_mfma_f32_16x16x32_bf16 v[76:79],v[132:135],a[156:159],v[76:79]
s_waitcnt lgkmcnt(0)
v_exp_f32 v81,v81
v_mfma_f32_16x16x32_bf16 v[76:79],v[136:139],a[160:163],v[76:79]
v_cvt_pk_bf16_f32 v44,v72,v73
v_cvt_pk_bf16_f32 v45,v74,v75
v_mfma_f32_16x16x32_bf16 v[76:79],v[140:143],a[164:167],v[76:79]
v_cvt_pk_bf16_f32 v48,v80,v81
v_mfma_f32_16x16x32_bf16 v[84:87],v[140:143],a[188:191],0
v_mfma_f32_16x16x32_bf16 v[84:87],v[136:139],a[184:187],v[84:87]
v_mfma_f32_16x16x32_bf16 v[84:87],v[132:135],a[180:183],v[84:87]
v_mfma_f32_16x16x32_bf16 v[84:87],v[128:131],a[176:179],v[84:87]
v_mfma_f32_16x16x32_bf16 v[84:87],v[124:127],a[172:175],v[84:87]
buffer_load_dwordx4 v8,s[4:7],s20 offen offset:2048 lds
v_mfma_f32_16x16x32_bf16 v[84:87],v[120:123],a[168:171],v[84:87]
s_add_u32 s20,s20,12288
v_mfma_f32_16x16x32_bf16 v[92:95],v[120:123],a[192:195],0
ds_read_b64_tr_b16 v[112:113],v2 offset:24576
v_mfma_f32_16x16x32_bf16 v[92:95],v[124:127],a[196:199],v[92:95]
ds_read_b64_tr_b16 v[114:115],v2 offset:30720
v_mfma_f32_16x16x32_bf16 v[92:95],v[128:131],a[200:203],v[92:95]
ds_read_b64_tr_b16 v[116:117],v3 offset:24576
v_mfma_f32_16x16x32_bf16 v[92:95],v[132:135],a[204:207],v[92:95]
ds_read_b64_tr_b16 v[118:119],v3 offset:30720
v_mfma_f32_16x16x32_bf16 v[92:95],v[136:139],a[208:211],v[92:95]
v_mfma_f32_16x16x32_bf16 v[92:95],v[140:143],a[212:215],v[92:95]
v_mfma_f32_16x16x32_bf16 v[100:103],v[140:143],a[236:239],0
v_mfma_f32_16x16x32_bf16 v[100:103],v[136:139],a[232:235],v[100:103]
v_mfma_f32_16x16x32_bf16 v[100:103],v[132:135],a[228:231],v[100:103]
v_mfma_f32_16x16x32_bf16 v[100:103],v[128:131],a[224:227],v[100:103]
v_mfma_f32_16x16x32_bf16 v[100:103],v[124:127],a[220:223],v[100:103]
ds_read_b64_tr_b16 v[124:125],v5 offset:24576
v_mfma_f32_16x16x32_bf16 v[100:103],v[120:123],a[216:219],v[100:103]
ds_read_b64_tr_b16 v[120:121],v4 offset:24576
ds_read_b64_tr_b16 v[122:123],v4 offset:30720
ds_read_b64_tr_b16 v[126:127],v5 offset:30720
s_mov_b32 s38,0
s_branch L_loop4
L_loop5:
.p2align 6
L_loop5w0:
s_waitcnt lgkmcnt(3)
v_mfma_f32_16x16x32_bf16 v[160:163],v[112:115],v[20:23],v[160:163]
s_add_u32 m0,s23,24576
ds_read_b64_tr_b16 v[134:135],v3 offset:30848
v_fma_f32 v90,v90,s36,v15
v_mfma_f32_16x16x32_bf16 v[164:167],v[116:119],v[20:23],v[164:167]
ds_read_b64_tr_b16 v[128:129],v2 offset:24704
v_fma_f32 v91,v91,s36,v15
v_mfma_f32_16x16x32_bf16 v[212:215],v[116:119],v[24:27],v[212:215]
ds_read_b64_tr_b16 v[130:131],v2 offset:30848
v_fma_f32 v97,v97,s36,v16
v_mfma_f32_16x16x32_bf16 v[208:211],v[112:115],v[24:27],v[208:211]
ds_read_b64_tr_b16 v[132:133],v3 offset:24704
v_fma_f32 v96,v96,s36,v16
v_mfma_f32_16x16x32_bf16 a[0:3],v[112:115],v[28:31],a[0:3]
ds_read_b64_tr_b16 v[138:139],v4 offset:30848
v_fma_f32 v98,v98,s36,v16
v_mfma_f32_16x16x32_bf16 a[4:7],v[116:119],v[28:31],a[4:7]
ds_read_b64_tr_b16 v[136:137],v4 offset:24704
v_fma_f32 v99,v99,s36,v16
v_mfma_f32_16x16x32_bf16 a[52:55],v[116:119],v[32:35],a[52:55]
ds_read_b64_tr_b16 v[142:143],v5 offset:30848
v_fma_f32 v106,v106,s36,v17
v_mfma_f32_16x16x32_bf16 a[48:51],v[112:115],v[32:35],a[48:51]
ds_read_b64_tr_b16 v[140:141],v5 offset:24704
v_fma_f32 v107,v107,s36,v17
v_mfma_f32_16x16x32_bf16 a[96:99],v[112:115],v[36:39],a[96:99]
ds_read_b64_tr_b16 v[114:115],v2 offset:30976
v_fma_f32 v104,v104,s36,v17
v_mfma_f32_16x16x32_bf16 a[100:103],v[116:119],v[36:39],a[100:103]
s_waitcnt lgkmcnt(6)
ds_read_b64_tr_b16 v[118:119],v3 offset:30976
v_fma_f32 v105,v105,s36,v17
v_mfma_f32_16x16x32_bf16 a[104:107],v[120:123],v[36:39],a[104:107]
ds_read_b64_tr_b16 v[112:113],v2 offset:24832
v_fma_f32 v77,v77,s36,v13
v_mfma_f32_16x16x32_bf16 a[108:111],v[124:127],v[36:39],a[108:111]
ds_read_b64_tr_b16 v[116:117],v3 offset:24832
v_fma_f32 v79,v79,s36,v13
v_mfma_f32_16x16x32_bf16 a[60:63],v[124:127],v[32:35],a[60:63]
v_exp_f32 v91,v91
v_mfma_f32_16x16x32_bf16 a[56:59],v[120:123],v[32:35],a[56:59]
v_exp_f32 v90,v90
v_mfma_f32_16x16x32_bf16 a[8:11],v[120:123],v[28:31],a[8:11]
v_cvt_pk_bf16_f32 v53,v90,v91
v_fma_f32 v76,v76,s36,v13
v_mfma_f32_16x16x32_bf16 a[12:15],v[124:127],v[28:31],a[12:15]
v_exp_f32 v99,v99
v_mfma_f32_16x16x32_bf16 v[220:223],v[124:127],v[24:27],v[220:223]
v_exp_f32 v96,v96
v_mfma_f32_16x16x32_bf16 v[216:219],v[120:123],v[24:27],v[216:219]
v_exp_f32 v98,v98
v_mfma_f32_16x16x32_bf16 v[168:171],v[120:123],v[20:23],v[168:171]
ds_read_b64_tr_b16 v[120:121],v4 offset:24832
v_cvt_pk_bf16_f32 v57,v98,v99
v_mfma_f32_16x16x32_bf16 v[172:175],v[124:127],v[20:23],v[172:175]
ds_read_b64_tr_b16 v[122:123],v4 offset:30976
v_fma_f32 v78,v78,s36,v13
v_mfma_f32_16x16x32_bf16 v[176:179],v[128:131],v[20:23],v[176:179]
s_waitcnt lgkmcnt(2)
ds_read_b64_tr_b16 v[124:125],v5 offset:24832
v_fma_f32 v86,v86,s36,v14
v_mfma_f32_16x16x32_bf16 v[180:183],v[132:135],v[20:23],v[180:183]
ds_read_b64_tr_b16 v[126:127],v5 offset:30976
v_fma_f32 v84,v84,s36,v14
v_mfma_f32_16x16x32_bf16 v[228:231],v[132:135],v[24:27],v[228:231]
v_exp_f32 v97,v97
v_mfma_f32_16x16x32_bf16 v[224:227],v[128:131],v[24:27],v[224:227]
v_cvt_pk_bf16_f32 v56,v96,v97
v_fma_f32 v87,v87,s36,v14
v_mfma_f32_16x16x32_bf16 a[16:19],v[128:131],v[28:31],a[16:19]
v_exp_f32 v104,v104
v_mfma_f32_16x16x32_bf16 a[20:23],v[132:135],v[28:31],a[20:23]
v_exp_f32 v107,v107
v_mfma_f32_16x16x32_bf16 a[68:71],v[132:135],v[32:35],a[68:71]
v_exp_f32 v105,v105
v_mfma_f32_16x16x32_bf16 a[64:67],v[128:131],v[32:35],a[64:67]
v_exp_f32 v106,v106
v_mfma_f32_16x16x32_bf16 a[112:115],v[128:131],v[36:39],a[112:115]
v_cvt_pk_bf16_f32 v41,v106,v107
v_cvt_pk_bf16_f32 v40,v104,v105
v_mfma_f32_16x16x32_bf16 a[116:119],v[132:135],v[36:39],a[116:119]
v_exp_f32 v78,v78
v_mfma_f32_16x16x32_bf16 a[120:123],v[136:139],v[36:39],a[120:123]
v_exp_f32 v79,v79
v_mfma_f32_16x16x32_bf16 a[124:127],v[140:143],v[36:39],a[124:127]
v_exp_f32 v77,v77
v_mfma_f32_16x16x32_bf16 a[76:79],v[140:143],v[32:35],a[76:79]
v_exp_f32 v76,v76
v_mfma_f32_16x16x32_bf16 a[72:75],v[136:139],v[32:35],a[72:75]
v_cvt_pk_bf16_f32 v46,v76,v77
v_cvt_pk_bf16_f32 v47,v78,v79
v_mfma_f32_16x16x32_bf16 a[24:27],v[136:139],v[28:31],a[24:27]
v_exp_f32 v86,v86
v_mfma_f32_16x16x32_bf16 a[28:31],v[140:143],v[28:31],a[28:31]
v_exp_f32 v87,v87
v_mfma_f32_16x16x32_bf16 v[236:239],v[140:143],v[24:27],v[236:239]
v_exp_f32 v84,v84
v_mfma_f32_16x16x32_bf16 v[232:235],v[136:139],v[24:27],v[232:235]
v_fma_f32 v85,v85,s36,v14
v_cvt_pk_bf16_f32 v51,v86,v87
v_mfma_f32_16x16x32_bf16 v[184:187],v[136:139],v[20:23],v[184:187]
v_exp_f32 v85,v85
v_mfma_f32_16x16x32_bf16 v[188:191],v[140:143],v[20:23],v[188:191]
v_cvt_pk_bf16_f32 v50,v84,v85
v_fma_f32 v92,v92,s36,v15
v_mfma_f32_16x16x32_bf16 v[192:195],v[112:115],v[20:23],v[192:195]
v_fma_f32 v94,v94,s36,v15
v_fma_f32 v93,v93,s36,v15
v_smfmac_f32_16x16x64_bf16 v[60:63],v[152:155],v[44:51],v18
v_fma_f32 v95,v95,s36,v15
v_mfma_f32_16x16x32_bf16 v[196:199],v[116:119],v[20:23],v[196:199]
s_waitcnt vmcnt(6) lgkmcnt(0)
v_exp_f32 v94,v94
v_mfma_f32_16x16x32_bf16 v[244:247],v[116:119],v[24:27],v[244:247]
s_barrier
v_mfma_f32_16x16x32_bf16 v[240:243],v[112:115],v[24:27],v[240:243]
ds_read_b128 v[128:131],v0 offset:12288
v_fma_f32 v102,v102,s36,v16
v_mfma_f32_16x16x32_bf16 a[32:35],v[112:115],v[28:31],a[32:35]
ds_read_b128 v[136:139],v0 offset:12416
v_fma_f32 v101,v101,s36,v16
v_mfma_f32_16x16x32_bf16 a[36:39],v[116:119],v[28:31],a[36:39]
ds_read_b128 v[132:135],v1 offset:12288
v_fma_f32 v100,v100,s36,v16
v_mfma_f32_16x16x32_bf16 a[84:87],v[116:119],v[32:35],a[84:87]
ds_read_b128 v[140:143],v1 offset:12416
v_fma_f32 v103,v103,s36,v16
v_mfma_f32_16x16x32_bf16 a[80:83],v[112:115],v[32:35],a[80:83]
ds_read_b128 v[156:159],v10 offset:0
v_fma_f32 v108,v108,s36,v17
v_mfma_f32_16x16x32_bf16 a[128:131],v[112:115],v[36:39],a[128:131]
buffer_load_dwordx4 v6,s[8:11],s21 offen offset:0 lds
v_mfma_f32_16x16x32_bf16 a[132:135],v[116:119],v[36:39],a[132:135]
ds_read_b128 v[112:115],v0 offset:12544
v_fma_f32 v110,v110,s36,v17
v_mfma_f32_16x16x32_bf16 a[136:139],v[120:123],v[36:39],a[136:139]
ds_read_b128 v[116:119],v1 offset:12544
v_fma_f32 v111,v111,s36,v17
v_mfma_f32_16x16x32_bf16 a[140:143],v[124:127],v[36:39],a[140:143]
v_exp_f32 v92,v92
v_mfma_f32_16x16x32_bf16 a[92:95],v[124:127],v[32:35],a[92:95]
v_exp_f32 v95,v95
v_mfma_f32_16x16x32_bf16 a[88:91],v[120:123],v[32:35],a[88:91]
v_cvt_pk_bf16_f32 v55,v94,v95
v_fma_f32 v109,v109,s36,v17
v_mfma_f32_16x16x32_bf16 a[40:43],v[120:123],v[28:31],a[40:43]
v_exp_f32 v93,v93
v_mfma_f32_16x16x32_bf16 a[44:47],v[124:127],v[28:31],a[44:47]
v_cvt_pk_bf16_f32 v54,v92,v93
v_mfma_f32_16x16x32_bf16 v[252:255],v[124:127],v[24:27],v[252:255]
v_exp_f32 v102,v102
v_mfma_f32_16x16x32_bf16 v[248:251],v[120:123],v[24:27],v[248:251]
v_exp_f32 v101,v101
v_mfma_f32_16x16x32_bf16 v[200:203],v[120:123],v[20:23],v[200:203]
ds_read_b128 v[120:123],v0 offset:18432
v_mfma_f32_16x16x32_bf16 v[204:207],v[124:127],v[20:23],v[204:207]
s_waitcnt lgkmcnt(1)
buffer_store_dwordx4 v[156:159],v9,s[16:19],s27 offen offset:0 nt
buffer_load_dwordx4 v7,s[8:11],s21 offen offset:1024 lds
v_mfma_f32_16x16x32_bf16 v[72:75],v[128:131],a[144:147],0
ds_read_b128 v[124:127],v1 offset:18432
v_mfma_f32_16x16x32_bf16 v[72:75],v[132:135],a[148:151],v[72:75]
v_exp_f32 v103,v103
v_mfma_f32_16x16x32_bf16 v[72:75],v[136:139],a[152:155],v[72:75]
v_exp_f32 v100,v100
v_mfma_f32_16x16x32_bf16 v[72:75],v[140:143],a[156:159],v[72:75]
v_cvt_pk_bf16_f32 v59,v102,v103
v_cvt_pk_bf16_f32 v58,v100,v101
v_mfma_f32_16x16x32_bf16 v[72:75],v[112:115],a[160:163],v[72:75]
v_exp_f32 v109,v109
v_smfmac_f32_16x16x64_bf16 v[64:67],v[152:155],v[52:59],v18
ds_read_b128 v[156:159],v10 offset:1024
v_mfma_f32_16x16x32_bf16 v[72:75],v[116:119],a[164:167],v[72:75]
v_exp_f32 v111,v111
v_mfma_f32_16x16x32_bf16 v[80:83],v[116:119],a[188:191],0
v_exp_f32 v108,v108
v_mfma_f32_16x16x32_bf16 v[80:83],v[112:115],a[184:187],v[80:83]
v_exp_f32 v110,v110
v_mfma_f32_16x16x32_bf16 v[80:83],v[140:143],a[180:183],v[80:83]
v_cvt_pk_bf16_f32 v42,v108,v109
v_cvt_pk_bf16_f32 v43,v110,v111
v_mfma_f32_16x16x32_bf16 v[80:83],v[136:139],a[176:179],v[80:83]
buffer_load_dwordx4 v8,s[8:11],s21 offen offset:2048 lds
v_smfmac_f32_16x16x64_bf16 v[68:71],v[152:155],v[36:43],v18
s_add_u32 s21,s21,12288
v_fma_f32 v73,v73,s36,v13
v_mfma_f32_16x16x32_bf16 v[80:83],v[132:135],a[172:175],v[80:83]
s_add_u32 m0,s22,0
v_fma_f32 v72,v72,s36,v13
v_fma_f32 v74,v74,s36,v13
v_mfma_f32_16x16x32_bf16 v[80:83],v[128:131],a[168:171],v[80:83]
v_exp_f32 v73,v73
v_mfma_f32_16x16x32_bf16 v[88:91],v[128:131],a[192:195],0
v_exp_f32 v72,v72
v_mfma_f32_16x16x32_bf16 v[88:91],v[132:135],a[196:199],v[88:91]
v_exp_f32 v74,v74
v_mfma_f32_16x16x32_bf16 v[88:91],v[136:139],a[200:203],v[88:91]
v_fma_f32 v75,v75,s36,v13
v_cvt_pk_bf16_f32 v20,v72,v73
v_mfma_f32_16x16x32_bf16 v[88:91],v[140:143],a[204:207],v[88:91]
v_exp_f32 v75,v75
v_mfma_f32_16x16x32_bf16 v[88:91],v[112:115],a[208:211],v[88:91]
v_fma_f32 v83,v83,s36,v14
v_fma_f32 v81,v81,s36,v14
v_mfma_f32_16x16x32_bf16 v[88:91],v[116:119],a[212:215],v[88:91]
v_exp_f32 v81,v81
v_mfma_f32_16x16x32_bf16 v[96:99],v[116:119],a[236:239],0
v_cvt_pk_bf16_f32 v21,v74,v75
v_fma_f32 v82,v82,s36,v14
v_mfma_f32_16x16x32_bf16 v[96:99],v[112:115],a[232:235],v[96:99]
s_waitcnt lgkmcnt(0)
buffer_store_dwordx4 v[156:159],v9,s[16:19],s27 offen offset:128 nt
buffer_load_dwordx4 v6,s[4:7],s20 offen offset:0 lds
v_mfma_f32_16x16x32_bf16 v[96:99],v[140:143],a[228:231],v[96:99]
v_fma_f32 v88,v88,s36,v15
v_fma_f32 v89,v89,s36,v15
v_mfma_f32_16x16x32_bf16 v[96:99],v[136:139],a[224:227],v[96:99]
v_exp_f32 v89,v89
v_mfma_f32_16x16x32_bf16 v[96:99],v[132:135],a[220:223],v[96:99]
v_exp_f32 v82,v82
v_mfma_f32_16x16x32_bf16 v[96:99],v[128:131],a[216:219],v[96:99]
v_exp_f32 v88,v88
v_mfma_f32_16x16x32_bf16 v[104:107],v[128:131],a[240:243],0
ds_read_b128 v[128:131],v0 offset:18560
v_fma_f32 v80,v80,s36,v14
v_mfma_f32_16x16x32_bf16 v[104:107],v[132:135],a[244:247],v[104:107]
ds_read_b128 v[156:159],v10 offset:2048
v_mfma_f32_16x16x32_bf16 v[104:107],v[136:139],a[248:251],v[104:107]
ds_read_b128 v[132:135],v1 offset:18560
v_mfma_f32_16x16x32_bf16 v[104:107],v[140:143],a[252:255],v[104:107]
ds_read_b128 v[136:139],v0 offset:18688
v_mfma_f32_16x16x32_bf16 v[104:107],v[112:115],v[144:147],v[104:107]
ds_read_b128 v[140:143],v1 offset:18688
v_mfma_f32_16x16x32_bf16 v[104:107],v[116:119],v[148:151],v[104:107]
v_exp_f32 v80,v80
v_mfma_f32_16x16x32_bf16 v[76:79],v[120:123],a[144:147],0
buffer_load_dwordx4 v7,s[4:7],s20 offen offset:1024 lds
v_mfma_f32_16x16x32_bf16 v[76:79],v[124:127],a[148:151],v[76:79]
s_waitcnt lgkmcnt(4)
v_cvt_pk_bf16_f32 v24,v80,v81
v_cvt_pk_bf16_f32 v28,v88,v89
v_mfma_f32_16x16x32_bf16 v[76:79],v[128:131],a[152:155],v[76:79]
s_waitcnt lgkmcnt(2)
v_exp_f32 v83,v83
v_mfma_f32_16x16x32_bf16 v[76:79],v[132:135],a[156:159],v[76:79]
s_waitcnt lgkmcnt(1)
v_cvt_pk_bf16_f32 v25,v82,v83
v_mfma_f32_16x16x32_bf16 v[76:79],v[136:139],a[160:163],v[76:79]
s_waitcnt lgkmcnt(0)
v_mfma_f32_16x16x32_bf16 v[76:79],v[140:143],a[164:167],v[76:79]
v_mfma_f32_16x16x32_bf16 v[84:87],v[140:143],a[188:191],0
v_mfma_f32_16x16x32_bf16 v[84:87],v[136:139],a[184:187],v[84:87]
v_mfma_f32_16x16x32_bf16 v[84:87],v[132:135],a[180:183],v[84:87]
v_mfma_f32_16x16x32_bf16 v[84:87],v[128:131],a[176:179],v[84:87]
v_mfma_f32_16x16x32_bf16 v[84:87],v[124:127],a[172:175],v[84:87]
buffer_store_dwordx4 v[156:159],v9,s[16:19],s27 offen offset:256 nt
buffer_load_dwordx4 v8,s[4:7],s20 offen offset:2048 lds
v_mfma_f32_16x16x32_bf16 v[84:87],v[120:123],a[168:171],v[84:87]
s_add_u32 s20,s20,12288
v_mfma_f32_16x16x32_bf16 v[92:95],v[120:123],a[192:195],0
s_add_u32 s27,s27,3072
v_mfma_f32_16x16x32_bf16 v[92:95],v[124:127],a[196:199],v[92:95]
v_mfma_f32_16x16x32_bf16 v[92:95],v[128:131],a[200:203],v[92:95]
v_mfma_f32_16x16x32_bf16 v[92:95],v[132:135],a[204:207],v[92:95]
ds_read_b64_tr_b16 v[112:113],v2 offset:0
v_mfma_f32_16x16x32_bf16 v[92:95],v[136:139],a[208:211],v[92:95]
ds_read_b64_tr_b16 v[114:115],v2 offset:6144
v_mfma_f32_16x16x32_bf16 v[92:95],v[140:143],a[212:215],v[92:95]
v_mfma_f32_16x16x32_bf16 v[100:103],v[140:143],a[236:239],0
ds_read_b64_tr_b16 v[116:117],v3 offset:0
v_mfma_f32_16x16x32_bf16 v[100:103],v[136:139],a[232:235],v[100:103]
ds_read_b64_tr_b16 v[118:119],v3 offset:6144
v_mfma_f32_16x16x32_bf16 v[100:103],v[132:135],a[228:231],v[100:103]
v_mfma_f32_16x16x32_bf16 v[100:103],v[128:131],a[224:227],v[100:103]
v_mfma_f32_16x16x32_bf16 v[100:103],v[124:127],a[220:223],v[100:103]
v_mfma_f32_16x16x32_bf16 v[100:103],v[120:123],a[216:219],v[100:103]
v_mfma_f32_16x16x32_bf16 v[108:111],v[120:123],a[240:243],0
ds_read_b64_tr_b16 v[122:123],v4 offset:6144
v_mfma_f32_16x16x32_bf16 v[108:111],v[124:127],a[244:247],v[108:111]
ds_read_b64_tr_b16 v[120:121],v4 offset:0
v_mfma_f32_16x16x32_bf16 v[108:111],v[128:131],a[248:251],v[108:111]
ds_read_b64_tr_b16 v[126:127],v5 offset:6144
v_mfma_f32_16x16x32_bf16 v[108:111],v[132:135],a[252:255],v[108:111]
ds_read_b64_tr_b16 v[124:125],v5 offset:0
v_mfma_f32_16x16x32_bf16 v[108:111],v[136:139],v[144:147],v[108:111]
v_mfma_f32_16x16x32_bf16 v[108:111],v[140:143],v[148:151],v[108:111]
s_waitcnt lgkmcnt(4)
v_mfma_f32_16x16x32_bf16 v[160:163],v[112:115],v[44:47],v[160:163]
s_add_u32 m0,s29,0
ds_read_b64_tr_b16 v[128:129],v2 offset:128
v_fma_f32 v90,v90,s36,v15
v_mfma_f32_16x16x32_bf16 v[164:167],v[116:119],v[44:47],v[164:167]
ds_read_b64_tr_b16 v[130:131],v2 offset:6272
v_fma_f32 v91,v91,s36,v15
v_mfma_f32_16x16x32_bf16 v[212:215],v[116:119],v[48:51],v[212:215]
ds_read_b64_tr_b16 v[132:133],v3 offset:128
v_fma_f32 v96,v96,s36,v16
v_mfma_f32_16x16x32_bf16 v[208:211],v[112:115],v[48:51],v[208:211]
ds_read_b64_tr_b16 v[134:135],v3 offset:6272
v_fma_f32 v97,v97,s36,v16
v_mfma_f32_16x16x32_bf16 a[0:3],v[112:115],v[52:55],a[0:3]
ds_read_b64_tr_b16 v[136:137],v4 offset:128
v_fma_f32 v98,v98,s36,v16
v_mfma_f32_16x16x32_bf16 a[4:7],v[116:119],v[52:55],a[4:7]
ds_read_b64_tr_b16 v[138:139],v4 offset:6272
v_fma_f32 v99,v99,s36,v16
v_mfma_f32_16x16x32_bf16 a[52:55],v[116:119],v[56:59],a[52:55]
ds_read_b64_tr_b16 v[140:141],v5 offset:128
v_fma_f32 v104,v104,s36,v17
v_mfma_f32_16x16x32_bf16 a[48:51],v[112:115],v[56:59],a[48:51]
buffer_load_dwordx4 v6,s[12:15],s28 offen offset:0 nt lds
v_mfma_f32_16x16x32_bf16 a[96:99],v[112:115],v[40:43],a[96:99]
ds_read_b64_tr_b16 v[142:143],v5 offset:6272
v_fma_f32 v105,v105,s36,v17
v_mfma_f32_16x16x32_bf16 a[100:103],v[116:119],v[40:43],a[100:103]
s_waitcnt lgkmcnt(5)
ds_read_b64_tr_b16 v[112:113],v2 offset:256
v_fma_f32 v106,v106,s36,v17
v_mfma_f32_16x16x32_bf16 a[104:107],v[120:123],v[40:43],a[104:107]
ds_read_b64_tr_b16 v[114:115],v2 offset:6400
v_fma_f32 v107,v107,s36,v17
v_mfma_f32_16x16x32_bf16 a[108:111],v[124:127],v[40:43],a[108:111]
ds_read_b64_tr_b16 v[116:117],v3 offset:256
v_fma_f32 v76,v76,s36,v13
v_mfma_f32_16x16x32_bf16 a[60:63],v[124:127],v[56:59],a[60:63]
ds_read_b64_tr_b16 v[118:119],v3 offset:6400
v_fma_f32 v77,v77,s36,v13
v_mfma_f32_16x16x32_bf16 a[56:59],v[120:123],v[56:59],a[56:59]
v_exp_f32 v90,v90
v_mfma_f32_16x16x32_bf16 a[8:11],v[120:123],v[52:55],a[8:11]
v_exp_f32 v91,v91
v_mfma_f32_16x16x32_bf16 a[12:15],v[124:127],v[52:55],a[12:15]
v_cvt_pk_bf16_f32 v29,v90,v91
v_fma_f32 v78,v78,s36,v13
v_mfma_f32_16x16x32_bf16 v[220:223],v[124:127],v[48:51],v[220:223]
v_exp_f32 v96,v96
v_mfma_f32_16x16x32_bf16 v[216:219],v[120:123],v[48:51],v[216:219]
buffer_load_dwordx4 v7,s[12:15],s28 offen offset:1024 nt lds
v_mfma_f32_16x16x32_bf16 v[168:171],v[120:123],v[44:47],v[168:171]
ds_read_b64_tr_b16 v[120:121],v4 offset:256
v_fma_f32 v79,v79,s36,v13
v_mfma_f32_16x16x32_bf16 v[172:175],v[124:127],v[44:47],v[172:175]
ds_read_b64_tr_b16 v[122:123],v4 offset:6400
v_fma_f32 v84,v84,s36,v14
v_mfma_f32_16x16x32_bf16 v[176:179],v[128:131],v[44:47],v[176:179]
s_waitcnt lgkmcnt(2)
ds_read_b64_tr_b16 v[124:125],v5 offset:256
v_fma_f32 v85,v85,s36,v14
v_mfma_f32_16x16x32_bf16 v[180:183],v[132:135],v[44:47],v[180:183]
ds_read_b64_tr_b16 v[126:127],v5 offset:6400
v_fma_f32 v86,v86,s36,v14
v_mfma_f32_16x16x32_bf16 v[228:231],v[132:135],v[48:51],v[228:231]
v_exp_f32 v97,v97
v_mfma_f32_16x16x32_bf16 v[224:227],v[128:131],v[48:51],v[224:227]
v_exp_f32 v98,v98
v_mfma_f32_16x16x32_bf16 a[16:19],v[128:131],v[52:55],a[16:19]
v_exp_f32 v99,v99
v_mfma_f32_16x16x32_bf16 a[20:23],v[132:135],v[52:55],a[20:23]
v_cvt_pk_bf16_f32 v32,v96,v97
v_cvt_pk_bf16_f32 v33,v98,v99
v_mfma_f32_16x16x32_bf16 a[68:71],v[132:135],v[56:59],a[68:71]
v_exp_f32 v104,v104
v_mfma_f32_16x16x32_bf16 a[64:67],v[128:131],v[56:59],a[64:67]
buffer_load_dwordx4 v8,s[12:15],s28 offen offset:2048 nt lds
v_mfma_f32_16x16x32_bf16 a[112:115],v[128:131],v[40:43],a[112:115]
s_add_u32 s28,s28,3072
v_exp_f32 v105,v105
v_mfma_f32_16x16x32_bf16 a[116:119],v[132:135],v[40:43],a[116:119]
s_add_u32 s29,s29,3072
v_exp_f32 v106,v106
v_mfma_f32_16x16x32_bf16 a[120:123],v[136:139],v[40:43],a[120:123]
s_add_u32 m0,s23,0
v_exp_f32 v107,v107
v_mfma_f32_16x16x32_bf16 a[124:127],v[140:143],v[40:43],a[124:127]
v_cvt_pk_bf16_f32 v36,v104,v105
v_cvt_pk_bf16_f32 v37,v106,v107
v_mfma_f32_16x16x32_bf16 a[76:79],v[140:143],v[56:59],a[76:79]
v_exp_f32 v76,v76
v_mfma_f32_16x16x32_bf16 a[72:75],v[136:139],v[56:59],a[72:75]
v_exp_f32 v77,v77
v_mfma_f32_16x16x32_bf16 a[24:27],v[136:139],v[52:55],a[24:27]
v_exp_f32 v78,v78
v_mfma_f32_16x16x32_bf16 a[28:31],v[140:143],v[52:55],a[28:31]
v_exp_f32 v79,v79
v_mfma_f32_16x16x32_bf16 v[236:239],v[140:143],v[48:51],v[236:239]
v_cvt_pk_bf16_f32 v22,v76,v77
v_cvt_pk_bf16_f32 v23,v78,v79
v_mfma_f32_16x16x32_bf16 v[232:235],v[136:139],v[48:51],v[232:235]
v_fma_f32 v87,v87,s36,v14
v_fma_f32 v92,v92,s36,v15
v_mfma_f32_16x16x32_bf16 v[184:187],v[136:139],v[44:47],v[184:187]
v_exp_f32 v84,v84
v_mfma_f32_16x16x32_bf16 v[188:191],v[140:143],v[44:47],v[188:191]
v_exp_f32 v85,v85
v_mfma_f32_16x16x32_bf16 v[192:195],v[112:115],v[44:47],v[192:195]
v_exp_f32 v86,v86
v_mfma_f32_16x16x32_bf16 v[196:199],v[116:119],v[44:47],v[196:199]
s_waitcnt vmcnt(12) lgkmcnt(0)
v_exp_f32 v87,v87
v_mfma_f32_16x16x32_bf16 v[244:247],v[116:119],v[48:51],v[244:247]
s_barrier
v_mfma_f32_16x16x32_bf16 v[240:243],v[112:115],v[48:51],v[240:243]
ds_read_b128 v[128:131],v0 offset:24576
v_cvt_pk_bf16_f32 v26,v84,v85
v_mfma_f32_16x16x32_bf16 a[32:35],v[112:115],v[52:55],a[32:35]
ds_read_b128 v[132:135],v1 offset:24576
v_cvt_pk_bf16_f32 v27,v86,v87
v_mfma_f32_16x16x32_bf16 a[36:39],v[116:119],v[52:55],a[36:39]
ds_read_b128 v[136:139],v0 offset:24704
v_fma_f32 v93,v93,s36,v15
v_smfmac_f32_16x16x64_bf16 v[60:63],v[152:155],v[20:27],v18
ds_read_b128 v[140:143],v1 offset:24704
v_mfma_f32_16x16x32_bf16 a[84:87],v[116:119],v[56:59],a[84:87]
v_fma_f32 v94,v94,s36,v15
v_fma_f32 v95,v95,s36,v15
v_mfma_f32_16x16x32_bf16 a[80:83],v[112:115],v[56:59],a[80:83]
buffer_load_dwordx4 v6,s[8:11],s21 offen offset:0 lds
v_mfma_f32_16x16x32_bf16 a[128:131],v[112:115],v[40:43],a[128:131]
ds_read_b128 v[112:115],v0 offset:24832
v_fma_f32 v100,v100,s36,v16
v_mfma_f32_16x16x32_bf16 a[132:135],v[116:119],v[40:43],a[132:135]
ds_read_b128 v[116:119],v1 offset:24832
v_fma_f32 v101,v101,s36,v16
v_mfma_f32_16x16x32_bf16 a[136:139],v[120:123],v[40:43],a[136:139]
v_exp_f32 v92,v92
v_mfma_f32_16x16x32_bf16 a[140:143],v[124:127],v[40:43],a[140:143]
v_exp_f32 v93,v93
v_mfma_f32_16x16x32_bf16 a[92:95],v[124:127],v[56:59],a[92:95]
v_exp_f32 v94,v94
v_mfma_f32_16x16x32_bf16 a[88:91],v[120:123],v[56:59],a[88:91]
v_exp_f32 v95,v95
v_mfma_f32_16x16x32_bf16 a[40:43],v[120:123],v[52:55],a[40:43]
v_cvt_pk_bf16_f32 v30,v92,v93
v_cvt_pk_bf16_f32 v31,v94,v95
v_mfma_f32_16x16x32_bf16 a[44:47],v[124:127],v[52:55],a[44:47]
v_fma_f32 v102,v102,s36,v16
v_fma_f32 v103,v103,s36,v16
v_mfma_f32_16x16x32_bf16 v[252:255],v[124:127],v[48:51],v[252:255]
v_exp_f32 v100,v100
v_mfma_f32_16x16x32_bf16 v[248:251],v[120:123],v[48:51],v[248:251]
v_exp_f32 v101,v101
v_mfma_f32_16x16x32_bf16 v[200:203],v[120:123],v[44:47],v[200:203]
buffer_load_dwordx4 v7,s[8:11],s21 offen offset:1024 lds
v_mfma_f32_16x16x32_bf16 v[204:207],v[124:127],v[44:47],v[204:207]
s_waitcnt lgkmcnt(0)
ds_read_b128 v[120:123],v0 offset:30720
v_cvt_pk_bf16_f32 v34,v100,v101
v_mfma_f32_16x16x32_bf16 v[72:75],v[128:131],a[144:147],0
ds_read_b128 v[124:127],v1 offset:30720
v_fma_f32 v108,v108,s36,v17
v_mfma_f32_16x16x32_bf16 v[72:75],v[132:135],a[148:151],v[72:75]
v_exp_f32 v102,v102
v_mfma_f32_16x16x32_bf16 v[72:75],v[136:139],a[152:155],v[72:75]
v_exp_f32 v103,v103
v_mfma_f32_16x16x32_bf16 v[72:75],v[140:143],a[156:159],v[72:75]
v_cvt_pk_bf16_f32 v35,v102,v103
v_fma_f32 v109,v109,s36,v17
v_mfma_f32_16x16x32_bf16 v[72:75],v[112:115],a[160:163],v[72:75]
v_fma_f32 v110,v110,s36,v17
v_fma_f32 v111,v111,s36,v17
v_smfmac_f32_16x16x64_bf16 v[64:67],v[152:155],v[28:35],v18
v_mfma_f32_16x16x32_bf16 v[72:75],v[116:119],a[164:167],v[72:75]
v_exp_f32 v108,v108
v_mfma_f32_16x16x32_bf16 v[80:83],v[116:119],a[188:191],0
v_exp_f32 v109,v109
v_mfma_f32_16x16x32_bf16 v[80:83],v[112:115],a[184:187],v[80:83]
v_exp_f32 v110,v110
v_mfma_f32_16x16x32_bf16 v[80:83],v[140:143],a[180:183],v[80:83]
v_exp_f32 v111,v111
v_mfma_f32_16x16x32_bf16 v[80:83],v[136:139],a[176:179],v[80:83]
buffer_load_dwordx4 v8,s[8:11],s21 offen offset:2048 lds
v_mfma_f32_16x16x32_bf16 v[80:83],v[132:135],a[172:175],v[80:83]
s_add_u32 s21,s21,12288
v_cvt_pk_bf16_f32 v38,v108,v109
v_cvt_pk_bf16_f32 v39,v110,v111
v_mfma_f32_16x16x32_bf16 v[80:83],v[128:131],a[168:171],v[80:83]
s_add_u32 m0,s22,12288
v_fma_f32 v72,v72,s36,v13
v_fma_f32 v73,v73,s36,v13
v_mfma_f32_16x16x32_bf16 v[88:91],v[128:131],a[192:195],0
v_fma_f32 v74,v74,s36,v13
v_fma_f32 v75,v75,s36,v13
v_mfma_f32_16x16x32_bf16 v[88:91],v[132:135],a[196:199],v[88:91]
v_exp_f32 v72,v72
v_mfma_f32_16x16x32_bf16 v[88:91],v[136:139],a[200:203],v[88:91]
v_fma_f32 v80,v80,s36,v14
v_fma_f32 v81,v81,s36,v14
v_mfma_f32_16x16x32_bf16 v[88:91],v[140:143],a[204:207],v[88:91]
v_fma_f32 v82,v82,s36,v14
v_fma_f32 v83,v83,s36,v14
v_mfma_f32_16x16x32_bf16 v[88:91],v[112:115],a[208:211],v[88:91]
v_exp_f32 v73,v73
v_mfma_f32_16x16x32_bf16 v[88:91],v[116:119],a[212:215],v[88:91]
v_exp_f32 v74,v74
v_mfma_f32_16x16x32_bf16 v[96:99],v[116:119],a[236:239],0
v_exp_f32 v75,v75
v_mfma_f32_16x16x32_bf16 v[96:99],v[112:115],a[232:235],v[96:99]
v_exp_f32 v80,v80
v_mfma_f32_16x16x32_bf16 v[96:99],v[140:143],a[228:231],v[96:99]
buffer_load_dwordx4 v6,s[4:7],s20 offen offset:0 lds
v_mfma_f32_16x16x32_bf16 v[96:99],v[136:139],a[224:227],v[96:99]
v_fma_f32 v88,v88,s36,v15
v_fma_f32 v89,v89,s36,v15
v_mfma_f32_16x16x32_bf16 v[96:99],v[132:135],a[220:223],v[96:99]
v_exp_f32 v81,v81
v_mfma_f32_16x16x32_bf16 v[96:99],v[128:131],a[216:219],v[96:99]
v_exp_f32 v82,v82
v_mfma_f32_16x16x32_bf16 v[104:107],v[128:131],a[240:243],0
ds_read_b128 v[128:131],v0 offset:30848
v_cvt_pk_bf16_f32 v44,v72,v73
v_mfma_f32_16x16x32_bf16 v[104:107],v[132:135],a[244:247],v[104:107]
ds_read_b128 v[132:135],v1 offset:30848
v_cvt_pk_bf16_f32 v45,v74,v75
v_mfma_f32_16x16x32_bf16 v[104:107],v[136:139],a[248:251],v[104:107]
ds_read_b128 v[136:139],v0 offset:30976
v_cvt_pk_bf16_f32 v48,v80,v81
v_mfma_f32_16x16x32_bf16 v[104:107],v[140:143],a[252:255],v[104:107]
ds_read_b128 v[140:143],v1 offset:30976
v_mfma_f32_16x16x32_bf16 v[104:107],v[112:115],v[144:147],v[104:107]
v_exp_f32 v83,v83
v_mfma_f32_16x16x32_bf16 v[104:107],v[116:119],v[148:151],v[104:107]
s_waitcnt lgkmcnt(4)
v_exp_f32 v88,v88
v_mfma_f32_16x16x32_bf16 v[76:79],v[120:123],a[144:147],0
v_exp_f32 v89,v89
v_mfma_f32_16x16x32_bf16 v[76:79],v[124:127],a[148:151],v[76:79]
buffer_load_dwordx4 v7,s[4:7],s20 offen offset:1024 lds
s_waitcnt lgkmcnt(3)
v_mfma_f32_16x16x32_bf16 v[76:79],v[128:131],a[152:155],v[76:79]
s_waitcnt lgkmcnt(2)
v_cvt_pk_bf16_f32 v49,v82,v83
v_cvt_pk_bf16_f32 v52,v88,v89
v_mfma_f32_16x16x32_bf16 v[76:79],v[132:135],a[156:159],v[76:79]
s_waitcnt lgkmcnt(0)
v_mfma_f32_16x16x32_bf16 v[76:79],v[136:139],a[160:163],v[76:79]
v_mfma_f32_16x16x32_bf16 v[76:79],v[140:143],a[164:167],v[76:79]
v_mfma_f32_16x16x32_bf16 v[84:87],v[140:143],a[188:191],0
v_mfma_f32_16x16x32_bf16 v[84:87],v[136:139],a[184:187],v[84:87]
v_mfma_f32_16x16x32_bf16 v[84:87],v[132:135],a[180:183],v[84:87]
v_mfma_f32_16x16x32_bf16 v[84:87],v[128:131],a[176:179],v[84:87]
v_mfma_f32_16x16x32_bf16 v[84:87],v[124:127],a[172:175],v[84:87]
v_mfma_f32_16x16x32_bf16 v[84:87],v[120:123],a[168:171],v[84:87]
v_mfma_f32_16x16x32_bf16 v[92:95],v[120:123],a[192:195],0
v_mfma_f32_16x16x32_bf16 v[92:95],v[124:127],a[196:199],v[92:95]
buffer_load_dwordx4 v8,s[4:7],s20 offen offset:2048 lds
v_mfma_f32_16x16x32_bf16 v[92:95],v[128:131],a[200:203],v[92:95]
s_add_u32 s20,s20,12288
v_mfma_f32_16x16x32_bf16 v[92:95],v[132:135],a[204:207],v[92:95]
v_mfma_f32_16x16x32_bf16 v[92:95],v[136:139],a[208:211],v[92:95]
v_mfma_f32_16x16x32_bf16 v[92:95],v[140:143],a[212:215],v[92:95]
v_mfma_f32_16x16x32_bf16 v[100:103],v[140:143],a[236:239],0
ds_read_b64_tr_b16 v[112:113],v2 offset:12288
v_mfma_f32_16x16x32_bf16 v[100:103],v[136:139],a[232:235],v[100:103]
ds_read_b64_tr_b16 v[114:115],v2 offset:18432
v_mfma_f32_16x16x32_bf16 v[100:103],v[132:135],a[228:231],v[100:103]
v_mfma_f32_16x16x32_bf16 v[100:103],v[128:131],a[224:227],v[100:103]
ds_read_b64_tr_b16 v[116:117],v3 offset:12288
v_mfma_f32_16x16x32_bf16 v[100:103],v[124:127],a[220:223],v[100:103]
ds_read_b64_tr_b16 v[118:119],v3 offset:18432
v_mfma_f32_16x16x32_bf16 v[100:103],v[120:123],a[216:219],v[100:103]
v_mfma_f32_16x16x32_bf16 v[108:111],v[120:123],a[240:243],0
ds_read_b64_tr_b16 v[120:121],v4 offset:12288
v_mfma_f32_16x16x32_bf16 v[108:111],v[124:127],a[244:247],v[108:111]
ds_read_b64_tr_b16 v[122:123],v4 offset:18432
v_mfma_f32_16x16x32_bf16 v[108:111],v[128:131],a[248:251],v[108:111]
ds_read_b64_tr_b16 v[124:125],v5 offset:12288
v_mfma_f32_16x16x32_bf16 v[108:111],v[132:135],a[252:255],v[108:111]
ds_read_b64_tr_b16 v[126:127],v5 offset:18432
v_mfma_f32_16x16x32_bf16 v[108:111],v[136:139],v[144:147],v[108:111]
v_mfma_f32_16x16x32_bf16 v[108:111],v[140:143],v[148:151],v[108:111]
s_waitcnt lgkmcnt(4)
v_mfma_f32_16x16x32_bf16 v[160:163],v[112:115],v[20:23],v[160:163]
s_add_u32 m0,s23,12288
ds_read_b64_tr_b16 v[134:135],v3 offset:18560
v_fma_f32 v90,v90,s36,v15
v_mfma_f32_16x16x32_bf16 v[164:167],v[116:119],v[20:23],v[164:167]
ds_read_b64_tr_b16 v[128:129],v2 offset:12416
v_fma_f32 v91,v91,s36,v15
v_mfma_f32_16x16x32_bf16 v[212:215],v[116:119],v[24:27],v[212:215]
ds_read_b64_tr_b16 v[130:131],v2 offset:18560
v_fma_f32 v97,v97,s36,v16
v_mfma_f32_16x16x32_bf16 v[208:211],v[112:115],v[24:27],v[208:211]
ds_read_b64_tr_b16 v[132:133],v3 offset:12416
v_fma_f32 v96,v96,s36,v16
v_mfma_f32_16x16x32_bf16 a[0:3],v[112:115],v[28:31],a[0:3]
ds_read_b64_tr_b16 v[138:139],v4 offset:18560
v_fma_f32 v98,v98,s36,v16
v_mfma_f32_16x16x32_bf16 a[4:7],v[116:119],v[28:31],a[4:7]
ds_read_b64_tr_b16 v[136:137],v4 offset:12416
v_fma_f32 v99,v99,s36,v16
v_mfma_f32_16x16x32_bf16 a[52:55],v[116:119],v[32:35],a[52:55]
ds_read_b64_tr_b16 v[142:143],v5 offset:18560
v_fma_f32 v106,v106,s36,v17
v_mfma_f32_16x16x32_bf16 a[48:51],v[112:115],v[32:35],a[48:51]
ds_read_b64_tr_b16 v[140:141],v5 offset:12416
v_fma_f32 v107,v107,s36,v17
v_mfma_f32_16x16x32_bf16 a[96:99],v[112:115],v[36:39],a[96:99]
ds_read_b64_tr_b16 v[114:115],v2 offset:18688
v_fma_f32 v104,v104,s36,v17
v_mfma_f32_16x16x32_bf16 a[100:103],v[116:119],v[36:39],a[100:103]
s_waitcnt lgkmcnt(6)
ds_read_b64_tr_b16 v[118:119],v3 offset:18688
v_fma_f32 v105,v105,s36,v17
v_mfma_f32_16x16x32_bf16 a[104:107],v[120:123],v[36:39],a[104:107]
ds_read_b64_tr_b16 v[112:113],v2 offset:12544
v_fma_f32 v77,v77,s36,v13
v_mfma_f32_16x16x32_bf16 a[108:111],v[124:127],v[36:39],a[108:111]
ds_read_b64_tr_b16 v[116:117],v3 offset:12544
v_fma_f32 v79,v79,s36,v13
v_mfma_f32_16x16x32_bf16 a[60:63],v[124:127],v[32:35],a[60:63]
v_exp_f32 v91,v91
v_mfma_f32_16x16x32_bf16 a[56:59],v[120:123],v[32:35],a[56:59]
v_exp_f32 v90,v90
v_mfma_f32_16x16x32_bf16 a[8:11],v[120:123],v[28:31],a[8:11]
v_cvt_pk_bf16_f32 v53,v90,v91
v_fma_f32 v76,v76,s36,v13
v_mfma_f32_16x16x32_bf16 a[12:15],v[124:127],v[28:31],a[12:15]
v_exp_f32 v99,v99
v_mfma_f32_16x16x32_bf16 v[220:223],v[124:127],v[24:27],v[220:223]
v_exp_f32 v96,v96
v_mfma_f32_16x16x32_bf16 v[216:219],v[120:123],v[24:27],v[216:219]
v_exp_f32 v98,v98
v_mfma_f32_16x16x32_bf16 v[168:171],v[120:123],v[20:23],v[168:171]
ds_read_b64_tr_b16 v[120:121],v4 offset:12544
v_cvt_pk_bf16_f32 v57,v98,v99
v_mfma_f32_16x16x32_bf16 v[172:175],v[124:127],v[20:23],v[172:175]
ds_read_b64_tr_b16 v[122:123],v4 offset:18688
v_fma_f32 v78,v78,s36,v13
v_mfma_f32_16x16x32_bf16 v[176:179],v[128:131],v[20:23],v[176:179]
s_waitcnt lgkmcnt(2)
ds_read_b64_tr_b16 v[124:125],v5 offset:12544
v_fma_f32 v86,v86,s36,v14
v_mfma_f32_16x16x32_bf16 v[180:183],v[132:135],v[20:23],v[180:183]
ds_read_b64_tr_b16 v[126:127],v5 offset:18688
v_fma_f32 v84,v84,s36,v14
v_mfma_f32_16x16x32_bf16 v[228:231],v[132:135],v[24:27],v[228:231]
v_exp_f32 v97,v97
v_mfma_f32_16x16x32_bf16 v[224:227],v[128:131],v[24:27],v[224:227]
v_cvt_pk_bf16_f32 v56,v96,v97
v_fma_f32 v87,v87,s36,v14
v_mfma_f32_16x16x32_bf16 a[16:19],v[128:131],v[28:31],a[16:19]
v_exp_f32 v104,v104
v_mfma_f32_16x16x32_bf16 a[20:23],v[132:135],v[28:31],a[20:23]
v_exp_f32 v107,v107
v_mfma_f32_16x16x32_bf16 a[68:71],v[132:135],v[32:35],a[68:71]
v_exp_f32 v105,v105
v_mfma_f32_16x16x32_bf16 a[64:67],v[128:131],v[32:35],a[64:67]
v_exp_f32 v106,v106
v_mfma_f32_16x16x32_bf16 a[112:115],v[128:131],v[36:39],a[112:115]
v_cvt_pk_bf16_f32 v41,v106,v107
v_cvt_pk_bf16_f32 v40,v104,v105
v_mfma_f32_16x16x32_bf16 a[116:119],v[132:135],v[36:39],a[116:119]
v_exp_f32 v78,v78
v_mfma_f32_16x16x32_bf16 a[120:123],v[136:139],v[36:39],a[120:123]
v_exp_f32 v79,v79
v_mfma_f32_16x16x32_bf16 a[124:127],v[140:143],v[36:39],a[124:127]
v_exp_f32 v77,v77
v_mfma_f32_16x16x32_bf16 a[76:79],v[140:143],v[32:35],a[76:79]
v_exp_f32 v76,v76
v_mfma_f32_16x16x32_bf16 a[72:75],v[136:139],v[32:35],a[72:75]
v_cvt_pk_bf16_f32 v46,v76,v77
v_cvt_pk_bf16_f32 v47,v78,v79
v_mfma_f32_16x16x32_bf16 a[24:27],v[136:139],v[28:31],a[24:27]
v_exp_f32 v86,v86
v_mfma_f32_16x16x32_bf16 a[28:31],v[140:143],v[28:31],a[28:31]
v_exp_f32 v87,v87
v_mfma_f32_16x16x32_bf16 v[236:239],v[140:143],v[24:27],v[236:239]
v_exp_f32 v84,v84
v_mfma_f32_16x16x32_bf16 v[232:235],v[136:139],v[24:27],v[232:235]
v_fma_f32 v85,v85,s36,v14
v_cvt_pk_bf16_f32 v51,v86,v87
v_mfma_f32_16x16x32_bf16 v[184:187],v[136:139],v[20:23],v[184:187]
v_exp_f32 v85,v85
v_mfma_f32_16x16x32_bf16 v[188:191],v[140:143],v[20:23],v[188:191]
v_cvt_pk_bf16_f32 v50,v84,v85
v_fma_f32 v92,v92,s36,v15
v_mfma_f32_16x16x32_bf16 v[192:195],v[112:115],v[20:23],v[192:195]
v_fma_f32 v94,v94,s36,v15
v_fma_f32 v93,v93,s36,v15
v_smfmac_f32_16x16x64_bf16 v[60:63],v[152:155],v[44:51],v18
v_fma_f32 v95,v95,s36,v15
v_mfma_f32_16x16x32_bf16 v[196:199],v[116:119],v[20:23],v[196:199]
s_waitcnt vmcnt(9) lgkmcnt(0)
v_exp_f32 v94,v94
v_mfma_f32_16x16x32_bf16 v[244:247],v[116:119],v[24:27],v[244:247]
s_barrier
v_mfma_f32_16x16x32_bf16 v[240:243],v[112:115],v[24:27],v[240:243]
ds_read_b128 v[128:131],v0 offset:0
v_fma_f32 v102,v102,s36,v16
v_mfma_f32_16x16x32_bf16 a[32:35],v[112:115],v[28:31],a[32:35]
ds_read_b128 v[136:139],v0 offset:128
v_fma_f32 v101,v101,s36,v16
v_mfma_f32_16x16x32_bf16 a[36:39],v[116:119],v[28:31],a[36:39]
ds_read_b128 v[132:135],v1 offset:0
v_fma_f32 v100,v100,s36,v16
v_mfma_f32_16x16x32_bf16 a[84:87],v[116:119],v[32:35],a[84:87]
ds_read_b128 v[140:143],v1 offset:128
v_fma_f32 v103,v103,s36,v16
v_mfma_f32_16x16x32_bf16 a[80:83],v[112:115],v[32:35],a[80:83]
ds_read_b128 v[156:159],v10 offset:3072
v_fma_f32 v108,v108,s36,v17
v_mfma_f32_16x16x32_bf16 a[128:131],v[112:115],v[36:39],a[128:131]
buffer_load_dwordx4 v6,s[8:11],s21 offen offset:0 lds
v_mfma_f32_16x16x32_bf16 a[132:135],v[116:119],v[36:39],a[132:135]
ds_read_b128 v[112:115],v0 offset:256
v_fma_f32 v110,v110,s36,v17
v_mfma_f32_16x16x32_bf16 a[136:139],v[120:123],v[36:39],a[136:139]
ds_read_b128 v[116:119],v1 offset:256
v_fma_f32 v111,v111,s36,v17
v_mfma_f32_16x16x32_bf16 a[140:143],v[124:127],v[36:39],a[140:143]
v_exp_f32 v92,v92
v_mfma_f32_16x16x32_bf16 a[92:95],v[124:127],v[32:35],a[92:95]
v_exp_f32 v95,v95
v_mfma_f32_16x16x32_bf16 a[88:91],v[120:123],v[32:35],a[88:91]
v_cvt_pk_bf16_f32 v55,v94,v95
v_fma_f32 v109,v109,s36,v17
v_mfma_f32_16x16x32_bf16 a[40:43],v[120:123],v[28:31],a[40:43]
v_exp_f32 v93,v93
v_mfma_f32_16x16x32_bf16 a[44:47],v[124:127],v[28:31],a[44:47]
v_cvt_pk_bf16_f32 v54,v92,v93
v_mfma_f32_16x16x32_bf16 v[252:255],v[124:127],v[24:27],v[252:255]
v_exp_f32 v102,v102
v_mfma_f32_16x16x32_bf16 v[248:251],v[120:123],v[24:27],v[248:251]
v_exp_f32 v101,v101
v_mfma_f32_16x16x32_bf16 v[200:203],v[120:123],v[20:23],v[200:203]
ds_read_b128 v[120:123],v0 offset:6144
v_mfma_f32_16x16x32_bf16 v[204:207],v[124:127],v[20:23],v[204:207]
s_waitcnt lgkmcnt(1)
buffer_store_dwordx4 v[156:159],v9,s[16:19],s27 offen offset:0 nt
buffer_load_dwordx4 v7,s[8:11],s21 offen offset:1024 lds
v_mfma_f32_16x16x32_bf16 v[72:75],v[128:131],a[144:147],0
ds_read_b128 v[124:127],v1 offset:6144
v_mfma_f32_16x16x32_bf16 v[72:75],v[132:135],a[148:151],v[72:75]
v_exp_f32 v103,v103
v_mfma_f32_16x16x32_bf16 v[72:75],v[136:139],a[152:155],v[72:75]
v_exp_f32 v100,v100
v_mfma_f32_16x16x32_bf16 v[72:75],v[140:143],a[156:159],v[72:75]
v_cvt_pk_bf16_f32 v59,v102,v103
v_cvt_pk_bf16_f32 v58,v100,v101
v_mfma_f32_16x16x32_bf16 v[72:75],v[112:115],a[160:163],v[72:75]
v_exp_f32 v109,v109
v_smfmac_f32_16x16x64_bf16 v[64:67],v[152:155],v[52:59],v18
ds_read_b128 v[156:159],v10 offset:4096
v_mfma_f32_16x16x32_bf16 v[72:75],v[116:119],a[164:167],v[72:75]
v_exp_f32 v111,v111
v_mfma_f32_16x16x32_bf16 v[80:83],v[116:119],a[188:191],0
v_exp_f32 v108,v108
v_mfma_f32_16x16x32_bf16 v[80:83],v[112:115],a[184:187],v[80:83]
v_exp_f32 v110,v110
v_mfma_f32_16x16x32_bf16 v[80:83],v[140:143],a[180:183],v[80:83]
v_cvt_pk_bf16_f32 v42,v108,v109
v_cvt_pk_bf16_f32 v43,v110,v111
v_mfma_f32_16x16x32_bf16 v[80:83],v[136:139],a[176:179],v[80:83]
buffer_load_dwordx4 v8,s[8:11],s21 offen offset:2048 lds
v_smfmac_f32_16x16x64_bf16 v[68:71],v[152:155],v[36:43],v18
s_add_u32 s21,s21,12288
v_fma_f32 v73,v73,s36,v13
v_mfma_f32_16x16x32_bf16 v[80:83],v[132:135],a[172:175],v[80:83]
s_add_u32 m0,s22,24576
v_fma_f32 v72,v72,s36,v13
v_fma_f32 v74,v74,s36,v13
v_mfma_f32_16x16x32_bf16 v[80:83],v[128:131],a[168:171],v[80:83]
v_exp_f32 v73,v73
v_mfma_f32_16x16x32_bf16 v[88:91],v[128:131],a[192:195],0
v_exp_f32 v72,v72
v_mfma_f32_16x16x32_bf16 v[88:91],v[132:135],a[196:199],v[88:91]
v_exp_f32 v74,v74
v_mfma_f32_16x16x32_bf16 v[88:91],v[136:139],a[200:203],v[88:91]
v_fma_f32 v75,v75,s36,v13
v_cvt_pk_bf16_f32 v20,v72,v73
v_mfma_f32_16x16x32_bf16 v[88:91],v[140:143],a[204:207],v[88:91]
v_exp_f32 v75,v75
v_mfma_f32_16x16x32_bf16 v[88:91],v[112:115],a[208:211],v[88:91]
v_fma_f32 v83,v83,s36,v14
v_fma_f32 v81,v81,s36,v14
v_mfma_f32_16x16x32_bf16 v[88:91],v[116:119],a[212:215],v[88:91]
v_exp_f32 v81,v81
v_mfma_f32_16x16x32_bf16 v[96:99],v[116:119],a[236:239],0
v_cvt_pk_bf16_f32 v21,v74,v75
v_fma_f32 v82,v82,s36,v14
v_mfma_f32_16x16x32_bf16 v[96:99],v[112:115],a[232:235],v[96:99]
s_waitcnt lgkmcnt(0)
buffer_store_dwordx4 v[156:159],v9,s[16:19],s27 offen offset:128 nt
buffer_load_dwordx4 v6,s[4:7],s20 offen offset:0 lds
v_mfma_f32_16x16x32_bf16 v[96:99],v[140:143],a[228:231],v[96:99]
v_fma_f32 v88,v88,s36,v15
v_fma_f32 v89,v89,s36,v15
v_mfma_f32_16x16x32_bf16 v[96:99],v[136:139],a[224:227],v[96:99]
v_exp_f32 v89,v89
v_mfma_f32_16x16x32_bf16 v[96:99],v[132:135],a[220:223],v[96:99]
v_exp_f32 v82,v82
v_mfma_f32_16x16x32_bf16 v[96:99],v[128:131],a[216:219],v[96:99]
v_exp_f32 v88,v88
v_mfma_f32_16x16x32_bf16 v[104:107],v[128:131],a[240:243],0
ds_read_b128 v[128:131],v0 offset:6272
v_fma_f32 v80,v80,s36,v14
v_mfma_f32_16x16x32_bf16 v[104:107],v[132:135],a[244:247],v[104:107]
ds_read_b128 v[156:159],v10 offset:5120
v_mfma_f32_16x16x32_bf16 v[104:107],v[136:139],a[248:251],v[104:107]
ds_read_b128 v[132:135],v1 offset:6272
v_mfma_f32_16x16x32_bf16 v[104:107],v[140:143],a[252:255],v[104:107]
ds_read_b128 v[136:139],v0 offset:6400
v_mfma_f32_16x16x32_bf16 v[104:107],v[112:115],v[144:147],v[104:107]
ds_read_b128 v[140:143],v1 offset:6400
v_mfma_f32_16x16x32_bf16 v[104:107],v[116:119],v[148:151],v[104:107]
v_exp_f32 v80,v80
v_mfma_f32_16x16x32_bf16 v[76:79],v[120:123],a[144:147],0
buffer_load_dwordx4 v7,s[4:7],s20 offen offset:1024 lds
v_mfma_f32_16x16x32_bf16 v[76:79],v[124:127],a[148:151],v[76:79]
s_waitcnt lgkmcnt(4)
v_cvt_pk_bf16_f32 v24,v80,v81
v_cvt_pk_bf16_f32 v28,v88,v89
v_mfma_f32_16x16x32_bf16 v[76:79],v[128:131],a[152:155],v[76:79]
s_waitcnt lgkmcnt(2)
v_exp_f32 v83,v83
v_mfma_f32_16x16x32_bf16 v[76:79],v[132:135],a[156:159],v[76:79]
s_waitcnt lgkmcnt(1)
v_cvt_pk_bf16_f32 v25,v82,v83
v_mfma_f32_16x16x32_bf16 v[76:79],v[136:139],a[160:163],v[76:79]
s_waitcnt lgkmcnt(0)
v_mfma_f32_16x16x32_bf16 v[76:79],v[140:143],a[164:167],v[76:79]
v_mfma_f32_16x16x32_bf16 v[84:87],v[140:143],a[188:191],0
v_mfma_f32_16x16x32_bf16 v[84:87],v[136:139],a[184:187],v[84:87]
v_mfma_f32_16x16x32_bf16 v[84:87],v[132:135],a[180:183],v[84:87]
v_mfma_f32_16x16x32_bf16 v[84:87],v[128:131],a[176:179],v[84:87]
v_mfma_f32_16x16x32_bf16 v[84:87],v[124:127],a[172:175],v[84:87]
buffer_store_dwordx4 v[156:159],v9,s[16:19],s27 offen offset:256 nt
buffer_load_dwordx4 v8,s[4:7],s20 offen offset:2048 lds
v_mfma_f32_16x16x32_bf16 v[84:87],v[120:123],a[168:171],v[84:87]
s_add_u32 s20,s20,12288
v_mfma_f32_16x16x32_bf16 v[92:95],v[120:123],a[192:195],0
s_add_u32 s27,s27,3072
v_mfma_f32_16x16x32_bf16 v[92:95],v[124:127],a[196:199],v[92:95]
v_mfma_f32_16x16x32_bf16 v[92:95],v[128:131],a[200:203],v[92:95]
v_mfma_f32_16x16x32_bf16 v[92:95],v[132:135],a[204:207],v[92:95]
ds_read_b64_tr_b16 v[112:113],v2 offset:24576
v_mfma_f32_16x16x32_bf16 v[92:95],v[136:139],a[208:211],v[92:95]
ds_read_b64_tr_b16 v[114:115],v2 offset:30720
v_mfma_f32_16x16x32_bf16 v[92:95],v[140:143],a[212:215],v[92:95]
v_mfma_f32_16x16x32_bf16 v[100:103],v[140:143],a[236:239],0
ds_read_b64_tr_b16 v[116:117],v3 offset:24576
v_mfma_f32_16x16x32_bf16 v[100:103],v[136:139],a[232:235],v[100:103]
ds_read_b64_tr_b16 v[118:119],v3 offset:30720
v_mfma_f32_16x16x32_bf16 v[100:103],v[132:135],a[228:231],v[100:103]
v_mfma_f32_16x16x32_bf16 v[100:103],v[128:131],a[224:227],v[100:103]
v_mfma_f32_16x16x32_bf16 v[100:103],v[124:127],a[220:223],v[100:103]
v_mfma_f32_16x16x32_bf16 v[100:103],v[120:123],a[216:219],v[100:103]
v_mfma_f32_16x16x32_bf16 v[108:111],v[120:123],a[240:243],0
ds_read_b64_tr_b16 v[122:123],v4 offset:30720
v_mfma_f32_16x16x32_bf16 v[108:111],v[124:127],a[244:247],v[108:111]
ds_read_b64_tr_b16 v[120:121],v4 offset:24576
v_mfma_f32_16x16x32_bf16 v[108:111],v[128:131],a[248:251],v[108:111]
ds_read_b64_tr_b16 v[126:127],v5 offset:30720
v_mfma_f32_16x16x32_bf16 v[108:111],v[132:135],a[252:255],v[108:111]
ds_read_b64_tr_b16 v[124:125],v5 offset:24576
v_mfma_f32_16x16x32_bf16 v[108:111],v[136:139],v[144:147],v[108:111]
v_mfma_f32_16x16x32_bf16 v[108:111],v[140:143],v[148:151],v[108:111]
s_waitcnt lgkmcnt(4)
v_mfma_f32_16x16x32_bf16 v[160:163],v[112:115],v[44:47],v[160:163]
s_add_u32 m0,s29,0
ds_read_b64_tr_b16 v[128:129],v2 offset:24704
v_fma_f32 v90,v90,s36,v15
v_mfma_f32_16x16x32_bf16 v[164:167],v[116:119],v[44:47],v[164:167]
ds_read_b64_tr_b16 v[130:131],v2 offset:30848
v_fma_f32 v91,v91,s36,v15
v_mfma_f32_16x16x32_bf16 v[212:215],v[116:119],v[48:51],v[212:215]
ds_read_b64_tr_b16 v[132:133],v3 offset:24704
v_fma_f32 v96,v96,s36,v16
v_mfma_f32_16x16x32_bf16 v[208:211],v[112:115],v[48:51],v[208:211]
ds_read_b64_tr_b16 v[134:135],v3 offset:30848
v_fma_f32 v97,v97,s36,v16
v_mfma_f32_16x16x32_bf16 a[0:3],v[112:115],v[52:55],a[0:3]
ds_read_b64_tr_b16 v[136:137],v4 offset:24704
v_fma_f32 v98,v98,s36,v16
v_mfma_f32_16x16x32_bf16 a[4:7],v[116:119],v[52:55],a[4:7]
ds_read_b64_tr_b16 v[138:139],v4 offset:30848
v_fma_f32 v99,v99,s36,v16
v_mfma_f32_16x16x32_bf16 a[52:55],v[116:119],v[56:59],a[52:55]
ds_read_b64_tr_b16 v[140:141],v5 offset:24704
v_fma_f32 v104,v104,s36,v17
v_mfma_f32_16x16x32_bf16 a[48:51],v[112:115],v[56:59],a[48:51]
buffer_load_dwordx4 v6,s[12:15],s28 offen offset:0 nt lds
v_mfma_f32_16x16x32_bf16 a[96:99],v[112:115],v[40:43],a[96:99]
ds_read_b64_tr_b16 v[142:143],v5 offset:30848
v_fma_f32 v105,v105,s36,v17
v_mfma_f32_16x16x32_bf16 a[100:103],v[116:119],v[40:43],a[100:103]
s_waitcnt lgkmcnt(5)
ds_read_b64_tr_b16 v[112:113],v2 offset:24832
v_fma_f32 v106,v106,s36,v17
v_mfma_f32_16x16x32_bf16 a[104:107],v[120:123],v[40:43],a[104:107]
ds_read_b64_tr_b16 v[114:115],v2 offset:30976
v_fma_f32 v107,v107,s36,v17
v_mfma_f32_16x16x32_bf16 a[108:111],v[124:127],v[40:43],a[108:111]
ds_read_b64_tr_b16 v[116:117],v3 offset:24832
v_fma_f32 v76,v76,s36,v13
v_mfma_f32_16x16x32_bf16 a[60:63],v[124:127],v[56:59],a[60:63]
ds_read_b64_tr_b16 v[118:119],v3 offset:30976
v_fma_f32 v77,v77,s36,v13
v_mfma_f32_16x16x32_bf16 a[56:59],v[120:123],v[56:59],a[56:59]
v_exp_f32 v90,v90
v_mfma_f32_16x16x32_bf16 a[8:11],v[120:123],v[52:55],a[8:11]
v_exp_f32 v91,v91
v_mfma_f32_16x16x32_bf16 a[12:15],v[124:127],v[52:55],a[12:15]
v_cvt_pk_bf16_f32 v29,v90,v91
v_fma_f32 v78,v78,s36,v13
v_mfma_f32_16x16x32_bf16 v[220:223],v[124:127],v[48:51],v[220:223]
v_exp_f32 v96,v96
v_mfma_f32_16x16x32_bf16 v[216:219],v[120:123],v[48:51],v[216:219]
buffer_load_dwordx4 v7,s[12:15],s28 offen offset:1024 nt lds
v_mfma_f32_16x16x32_bf16 v[168:171],v[120:123],v[44:47],v[168:171]
ds_read_b64_tr_b16 v[120:121],v4 offset:24832
v_fma_f32 v79,v79,s36,v13
v_mfma_f32_16x16x32_bf16 v[172:175],v[124:127],v[44:47],v[172:175]
ds_read_b64_tr_b16 v[122:123],v4 offset:30976
v_fma_f32 v84,v84,s36,v14
v_mfma_f32_16x16x32_bf16 v[176:179],v[128:131],v[44:47],v[176:179]
s_waitcnt lgkmcnt(2)
ds_read_b64_tr_b16 v[124:125],v5 offset:24832
v_fma_f32 v85,v85,s36,v14
v_mfma_f32_16x16x32_bf16 v[180:183],v[132:135],v[44:47],v[180:183]
ds_read_b64_tr_b16 v[126:127],v5 offset:30976
v_fma_f32 v86,v86,s36,v14
v_mfma_f32_16x16x32_bf16 v[228:231],v[132:135],v[48:51],v[228:231]
v_exp_f32 v97,v97
v_mfma_f32_16x16x32_bf16 v[224:227],v[128:131],v[48:51],v[224:227]
v_exp_f32 v98,v98
v_mfma_f32_16x16x32_bf16 a[16:19],v[128:131],v[52:55],a[16:19]
v_exp_f32 v99,v99
v_mfma_f32_16x16x32_bf16 a[20:23],v[132:135],v[52:55],a[20:23]
v_cvt_pk_bf16_f32 v32,v96,v97
v_cvt_pk_bf16_f32 v33,v98,v99
v_mfma_f32_16x16x32_bf16 a[68:71],v[132:135],v[56:59],a[68:71]
v_exp_f32 v104,v104
v_mfma_f32_16x16x32_bf16 a[64:67],v[128:131],v[56:59],a[64:67]
buffer_load_dwordx4 v8,s[12:15],s28 offen offset:2048 nt lds
v_mfma_f32_16x16x32_bf16 a[112:115],v[128:131],v[40:43],a[112:115]
s_add_u32 s28,s28,3072
v_exp_f32 v105,v105
v_mfma_f32_16x16x32_bf16 a[116:119],v[132:135],v[40:43],a[116:119]
s_add_u32 s29,s29,3072
v_exp_f32 v106,v106
v_mfma_f32_16x16x32_bf16 a[120:123],v[136:139],v[40:43],a[120:123]
s_add_u32 m0,s23,24576
v_exp_f32 v107,v107
v_mfma_f32_16x16x32_bf16 a[124:127],v[140:143],v[40:43],a[124:127]
v_cvt_pk_bf16_f32 v36,v104,v105
v_cvt_pk_bf16_f32 v37,v106,v107
v_mfma_f32_16x16x32_bf16 a[76:79],v[140:143],v[56:59],a[76:79]
v_exp_f32 v76,v76
v_mfma_f32_16x16x32_bf16 a[72:75],v[136:139],v[56:59],a[72:75]
v_exp_f32 v77,v77
v_mfma_f32_16x16x32_bf16 a[24:27],v[136:139],v[52:55],a[24:27]
v_exp_f32 v78,v78
v_mfma_f32_16x16x32_bf16 a[28:31],v[140:143],v[52:55],a[28:31]
v_exp_f32 v79,v79
v_mfma_f32_16x16x32_bf16 v[236:239],v[140:143],v[48:51],v[236:239]
v_cvt_pk_bf16_f32 v22,v76,v77
v_cvt_pk_bf16_f32 v23,v78,v79
v_mfma_f32_16x16x32_bf16 v[232:235],v[136:139],v[48:51],v[232:235]
v_fma_f32 v87,v87,s36,v14
v_fma_f32 v92,v92,s36,v15
v_mfma_f32_16x16x32_bf16 v[184:187],v[136:139],v[44:47],v[184:187]
v_exp_f32 v84,v84
v_mfma_f32_16x16x32_bf16 v[188:191],v[140:143],v[44:47],v[188:191]
v_exp_f32 v85,v85
v_mfma_f32_16x16x32_bf16 v[192:195],v[112:115],v[44:47],v[192:195]
v_exp_f32 v86,v86
v_mfma_f32_16x16x32_bf16 v[196:199],v[116:119],v[44:47],v[196:199]
s_waitcnt vmcnt(12) lgkmcnt(0)
v_exp_f32 v87,v87
v_mfma_f32_16x16x32_bf16 v[244:247],v[116:119],v[48:51],v[244:247]
s_barrier
v_mfma_f32_16x16x32_bf16 v[240:243],v[112:115],v[48:51],v[240:243]
ds_read_b128 v[128:131],v0 offset:12288
v_cvt_pk_bf16_f32 v26,v84,v85
v_mfma_f32_16x16x32_bf16 a[32:35],v[112:115],v[52:55],a[32:35]
ds_read_b128 v[132:135],v1 offset:12288
v_cvt_pk_bf16_f32 v27,v86,v87
v_mfma_f32_16x16x32_bf16 a[36:39],v[116:119],v[52:55],a[36:39]
ds_read_b128 v[136:139],v0 offset:12416
v_fma_f32 v93,v93,s36,v15
v_smfmac_f32_16x16x64_bf16 v[60:63],v[152:155],v[20:27],v18
ds_read_b128 v[140:143],v1 offset:12416
v_mfma_f32_16x16x32_bf16 a[84:87],v[116:119],v[56:59],a[84:87]
v_fma_f32 v94,v94,s36,v15
v_fma_f32 v95,v95,s36,v15
v_mfma_f32_16x16x32_bf16 a[80:83],v[112:115],v[56:59],a[80:83]
buffer_load_dwordx4 v6,s[8:11],s21 offen offset:0 lds
v_mfma_f32_16x16x32_bf16 a[128:131],v[112:115],v[40:43],a[128:131]
ds_read_b128 v[112:115],v0 offset:12544
v_fma_f32 v100,v100,s36,v16
v_mfma_f32_16x16x32_bf16 a[132:135],v[116:119],v[40:43],a[132:135]
ds_read_b128 v[116:119],v1 offset:12544
v_fma_f32 v101,v101,s36,v16
v_mfma_f32_16x16x32_bf16 a[136:139],v[120:123],v[40:43],a[136:139]
v_exp_f32 v92,v92
v_mfma_f32_16x16x32_bf16 a[140:143],v[124:127],v[40:43],a[140:143]
v_exp_f32 v93,v93
v_mfma_f32_16x16x32_bf16 a[92:95],v[124:127],v[56:59],a[92:95]
v_exp_f32 v94,v94
v_mfma_f32_16x16x32_bf16 a[88:91],v[120:123],v[56:59],a[88:91]
v_exp_f32 v95,v95
v_mfma_f32_16x16x32_bf16 a[40:43],v[120:123],v[52:55],a[40:43]
v_cvt_pk_bf16_f32 v30,v92,v93
v_cvt_pk_bf16_f32 v31,v94,v95
v_mfma_f32_16x16x32_bf16 a[44:47],v[124:127],v[52:55],a[44:47]
v_fma_f32 v102,v102,s36,v16
v_fma_f32 v103,v103,s36,v16
v_mfma_f32_16x16x32_bf16 v[252:255],v[124:127],v[48:51],v[252:255]
v_exp_f32 v100,v100
v_mfma_f32_16x16x32_bf16 v[248:251],v[120:123],v[48:51],v[248:251]
v_exp_f32 v101,v101
v_mfma_f32_16x16x32_bf16 v[200:203],v[120:123],v[44:47],v[200:203]
buffer_load_dwordx4 v7,s[8:11],s21 offen offset:1024 lds
v_mfma_f32_16x16x32_bf16 v[204:207],v[124:127],v[44:47],v[204:207]
s_waitcnt lgkmcnt(0)
ds_read_b128 v[120:123],v0 offset:18432
v_cvt_pk_bf16_f32 v34,v100,v101
v_mfma_f32_16x16x32_bf16 v[72:75],v[128:131],a[144:147],0
ds_read_b128 v[124:127],v1 offset:18432
v_fma_f32 v108,v108,s36,v17
v_mfma_f32_16x16x32_bf16 v[72:75],v[132:135],a[148:151],v[72:75]
v_exp_f32 v102,v102
v_mfma_f32_16x16x32_bf16 v[72:75],v[136:139],a[152:155],v[72:75]
v_exp_f32 v103,v103
v_mfma_f32_16x16x32_bf16 v[72:75],v[140:143],a[156:159],v[72:75]
v_cvt_pk_bf16_f32 v35,v102,v103
v_fma_f32 v109,v109,s36,v17
v_mfma_f32_16x16x32_bf16 v[72:75],v[112:115],a[160:163],v[72:75]
v_fma_f32 v110,v110,s36,v17
v_fma_f32 v111,v111,s36,v17
v_smfmac_f32_16x16x64_bf16 v[64:67],v[152:155],v[28:35],v18
v_mfma_f32_16x16x32_bf16 v[72:75],v[116:119],a[164:167],v[72:75]
v_exp_f32 v108,v108
v_mfma_f32_16x16x32_bf16 v[80:83],v[116:119],a[188:191],0
v_exp_f32 v109,v109
v_mfma_f32_16x16x32_bf16 v[80:83],v[112:115],a[184:187],v[80:83]
v_exp_f32 v110,v110
v_mfma_f32_16x16x32_bf16 v[80:83],v[140:143],a[180:183],v[80:83]
v_exp_f32 v111,v111
v_mfma_f32_16x16x32_bf16 v[80:83],v[136:139],a[176:179],v[80:83]
buffer_load_dwordx4 v8,s[8:11],s21 offen offset:2048 lds
v_mfma_f32_16x16x32_bf16 v[80:83],v[132:135],a[172:175],v[80:83]
s_add_u32 s21,s21,12288
v_cvt_pk_bf16_f32 v38,v108,v109
v_cvt_pk_bf16_f32 v39,v110,v111
v_mfma_f32_16x16x32_bf16 v[80:83],v[128:131],a[168:171],v[80:83]
s_add_u32 m0,s22,0
v_fma_f32 v72,v72,s36,v13
v_fma_f32 v73,v73,s36,v13
v_mfma_f32_16x16x32_bf16 v[88:91],v[128:131],a[192:195],0
v_fma_f32 v74,v74,s36,v13
v_fma_f32 v75,v75,s36,v13
v_mfma_f32_16x16x32_bf16 v[88:91],v[132:135],a[196:199],v[88:91]
v_exp_f32 v72,v72
v_mfma_f32_16x16x32_bf16 v[88:91],v[136:139],a[200:203],v[88:91]
v_fma_f32 v80,v80,s36,v14
v_fma_f32 v81,v81,s36,v14
v_mfma_f32_16x16x32_bf16 v[88:91],v[140:143],a[204:207],v[88:91]
v_fma_f32 v82,v82,s36,v14
v_fma_f32 v83,v83,s36,v14
v_mfma_f32_16x16x32_bf16 v[88:91],v[112:115],a[208:211],v[88:91]
v_exp_f32 v73,v73
v_mfma_f32_16x16x32_bf16 v[88:91],v[116:119],a[212:215],v[88:91]
v_exp_f32 v74,v74
v_mfma_f32_16x16x32_bf16 v[96:99],v[116:119],a[236:239],0
v_exp_f32 v75,v75
v_mfma_f32_16x16x32_bf16 v[96:99],v[112:115],a[232:235],v[96:99]
v_exp_f32 v80,v80
v_mfma_f32_16x16x32_bf16 v[96:99],v[140:143],a[228:231],v[96:99]
buffer_load_dwordx4 v6,s[4:7],s20 offen offset:0 lds
v_mfma_f32_16x16x32_bf16 v[96:99],v[136:139],a[224:227],v[96:99]
v_fma_f32 v88,v88,s36,v15
v_fma_f32 v89,v89,s36,v15
v_mfma_f32_16x16x32_bf16 v[96:99],v[132:135],a[220:223],v[96:99]
v_exp_f32 v81,v81
v_mfma_f32_16x16x32_bf16 v[96:99],v[128:131],a[216:219],v[96:99]
v_exp_f32 v82,v82
v_mfma_f32_16x16x32_bf16 v[104:107],v[128:131],a[240:243],0
ds_read_b128 v[128:131],v0 offset:18560
v_cvt_pk_bf16_f32 v44,v72,v73
v_mfma_f32_16x16x32_bf16 v[104:107],v[132:135],a[244:247],v[104:107]
ds_read_b128 v[132:135],v1 offset:18560
v_cvt_pk_bf16_f32 v45,v74,v75
v_mfma_f32_16x16x32_bf16 v[104:107],v[136:139],a[248:251],v[104:107]
ds_read_b128 v[136:139],v0 offset:18688
v_cvt_pk_bf16_f32 v48,v80,v81
v_mfma_f32_16x16x32_bf16 v[104:107],v[140:143],a[252:255],v[104:107]
ds_read_b128 v[140:143],v1 offset:18688
v_mfma_f32_16x16x32_bf16 v[104:107],v[112:115],v[144:147],v[104:107]
v_exp_f32 v83,v83
v_mfma_f32_16x16x32_bf16 v[104:107],v[116:119],v[148:151],v[104:107]
s_waitcnt lgkmcnt(4)
v_exp_f32 v88,v88
v_mfma_f32_16x16x32_bf16 v[76:79],v[120:123],a[144:147],0
v_exp_f32 v89,v89
v_mfma_f32_16x16x32_bf16 v[76:79],v[124:127],a[148:151],v[76:79]
buffer_load_dwordx4 v7,s[4:7],s20 offen offset:1024 lds
s_waitcnt lgkmcnt(3)
v_mfma_f32_16x16x32_bf16 v[76:79],v[128:131],a[152:155],v[76:79]
s_waitcnt lgkmcnt(2)
v_cvt_pk_bf16_f32 v49,v82,v83
v_cvt_pk_bf16_f32 v52,v88,v89
v_mfma_f32_16x16x32_bf16 v[76:79],v[132:135],a[156:159],v[76:79]
s_waitcnt lgkmcnt(0)
v_mfma_f32_16x16x32_bf16 v[76:79],v[136:139],a[160:163],v[76:79]
v_mfma_f32_16x16x32_bf16 v[76:79],v[140:143],a[164:167],v[76:79]
v_mfma_f32_16x16x32_bf16 v[84:87],v[140:143],a[188:191],0
v_mfma_f32_16x16x32_bf16 v[84:87],v[136:139],a[184:187],v[84:87]
v_mfma_f32_16x16x32_bf16 v[84:87],v[132:135],a[180:183],v[84:87]
v_mfma_f32_16x16x32_bf16 v[84:87],v[128:131],a[176:179],v[84:87]
v_mfma_f32_16x16x32_bf16 v[84:87],v[124:127],a[172:175],v[84:87]
v_mfma_f32_16x16x32_bf16 v[84:87],v[120:123],a[168:171],v[84:87]
v_mfma_f32_16x16x32_bf16 v[92:95],v[120:123],a[192:195],0
v_mfma_f32_16x16x32_bf16 v[92:95],v[124:127],a[196:199],v[92:95]
buffer_load_dwordx4 v8,s[4:7],s20 offen offset:2048 lds
v_mfma_f32_16x16x32_bf16 v[92:95],v[128:131],a[200:203],v[92:95]
s_add_u32 s20,s20,12288
v_mfma_f32_16x16x32_bf16 v[92:95],v[132:135],a[204:207],v[92:95]
v_mfma_f32_16x16x32_bf16 v[92:95],v[136:139],a[208:211],v[92:95]
v_mfma_f32_16x16x32_bf16 v[92:95],v[140:143],a[212:215],v[92:95]
v_mfma_f32_16x16x32_bf16 v[100:103],v[140:143],a[236:239],0
ds_read_b64_tr_b16 v[112:113],v2 offset:0
v_mfma_f32_16x16x32_bf16 v[100:103],v[136:139],a[232:235],v[100:103]
ds_read_b64_tr_b16 v[114:115],v2 offset:6144
v_mfma_f32_16x16x32_bf16 v[100:103],v[132:135],a[228:231],v[100:103]
v_mfma_f32_16x16x32_bf16 v[100:103],v[128:131],a[224:227],v[100:103]
ds_read_b64_tr_b16 v[116:117],v3 offset:0
v_mfma_f32_16x16x32_bf16 v[100:103],v[124:127],a[220:223],v[100:103]
ds_read_b64_tr_b16 v[118:119],v3 offset:6144
v_mfma_f32_16x16x32_bf16 v[100:103],v[120:123],a[216:219],v[100:103]
v_mfma_f32_16x16x32_bf16 v[108:111],v[120:123],a[240:243],0
ds_read_b64_tr_b16 v[120:121],v4 offset:0
v_mfma_f32_16x16x32_bf16 v[108:111],v[124:127],a[244:247],v[108:111]
ds_read_b64_tr_b16 v[122:123],v4 offset:6144
v_mfma_f32_16x16x32_bf16 v[108:111],v[128:131],a[248:251],v[108:111]
ds_read_b64_tr_b16 v[124:125],v5 offset:0
v_mfma_f32_16x16x32_bf16 v[108:111],v[132:135],a[252:255],v[108:111]
ds_read_b64_tr_b16 v[126:127],v5 offset:6144
v_mfma_f32_16x16x32_bf16 v[108:111],v[136:139],v[144:147],v[108:111]
v_mfma_f32_16x16x32_bf16 v[108:111],v[140:143],v[148:151],v[108:111]
s_waitcnt lgkmcnt(4)
v_mfma_f32_16x16x32_bf16 v[160:163],v[112:115],v[20:23],v[160:163]
s_add_u32 m0,s23,0
ds_read_b64_tr_b16 v[128:129],v2 offset:128
v_fma_f32 v91,v91,s36,v15
v_mfma_f32_16x16x32_bf16 v[164:167],v[116:119],v[20:23],v[164:167]
ds_read_b64_tr_b16 v[130:131],v2 offset:6272
v_fma_f32 v90,v90,s36,v15
v_mfma_f32_16x16x32_bf16 v[212:215],v[116:119],v[24:27],v[212:215]
ds_read_b64_tr_b16 v[132:133],v3 offset:128
v_fma_f32 v98,v98,s36,v16
v_mfma_f32_16x16x32_bf16 v[208:211],v[112:115],v[24:27],v[208:211]
ds_read_b64_tr_b16 v[134:135],v3 offset:6272
v_fma_f32 v96,v96,s36,v16
v_mfma_f32_16x16x32_bf16 a[0:3],v[112:115],v[28:31],a[0:3]
ds_read_b64_tr_b16 v[138:139],v4 offset:6272
v_fma_f32 v97,v97,s36,v16
v_mfma_f32_16x16x32_bf16 a[4:7],v[116:119],v[28:31],a[4:7]
ds_read_b64_tr_b16 v[142:143],v5 offset:6272
v_fma_f32 v99,v99,s36,v16
v_mfma_f32_16x16x32_bf16 a[52:55],v[116:119],v[32:35],a[52:55]
ds_read_b64_tr_b16 v[136:137],v4 offset:128
v_fma_f32 v107,v107,s36,v17
v_mfma_f32_16x16x32_bf16 a[48:51],v[112:115],v[32:35],a[48:51]
ds_read_b64_tr_b16 v[140:141],v5 offset:128
v_fma_f32 v104,v104,s36,v17
v_mfma_f32_16x16x32_bf16 a[96:99],v[112:115],v[36:39],a[96:99]
ds_read_b64_tr_b16 v[112:113],v2 offset:256
v_fma_f32 v105,v105,s36,v17
v_mfma_f32_16x16x32_bf16 a[100:103],v[116:119],v[36:39],a[100:103]
s_waitcnt lgkmcnt(6)
ds_read_b64_tr_b16 v[116:117],v3 offset:256
v_fma_f32 v106,v106,s36,v17
v_mfma_f32_16x16x32_bf16 a[104:107],v[120:123],v[36:39],a[104:107]
ds_read_b64_tr_b16 v[114:115],v2 offset:6400
v_fma_f32 v76,v76,s36,v13
v_mfma_f32_16x16x32_bf16 a[108:111],v[124:127],v[36:39],a[108:111]
ds_read_b64_tr_b16 v[118:119],v3 offset:6400
v_fma_f32 v79,v79,s36,v13
v_mfma_f32_16x16x32_bf16 a[60:63],v[124:127],v[32:35],a[60:63]
v_exp_f32 v91,v91
v_mfma_f32_16x16x32_bf16 a[56:59],v[120:123],v[32:35],a[56:59]
v_exp_f32 v90,v90
v_mfma_f32_16x16x32_bf16 a[8:11],v[120:123],v[28:31],a[8:11]
v_cvt_pk_bf16_f32 v53,v90,v91
v_fma_f32 v78,v78,s36,v13
v_mfma_f32_16x16x32_bf16 a[12:15],v[124:127],v[28:31],a[12:15]
v_exp_f32 v96,v96
v_mfma_f32_16x16x32_bf16 v[220:223],v[124:127],v[24:27],v[220:223]
v_exp_f32 v97,v97
v_mfma_f32_16x16x32_bf16 v[216:219],v[120:123],v[24:27],v[216:219]
v_exp_f32 v98,v98
v_mfma_f32_16x16x32_bf16 v[168:171],v[120:123],v[20:23],v[168:171]
ds_read_b64_tr_b16 v[120:121],v4 offset:256
v_cvt_pk_bf16_f32 v56,v96,v97
v_mfma_f32_16x16x32_bf16 v[172:175],v[124:127],v[20:23],v[172:175]
ds_read_b64_tr_b16 v[122:123],v4 offset:6400
v_fma_f32 v77,v77,s36,v13
v_mfma_f32_16x16x32_bf16 v[176:179],v[128:131],v[20:23],v[176:179]
s_waitcnt lgkmcnt(2)
ds_read_b64_tr_b16 v[124:125],v5 offset:256
v_fma_f32 v86,v86,s36,v14
v_mfma_f32_16x16x32_bf16 v[180:183],v[132:135],v[20:23],v[180:183]
ds_read_b64_tr_b16 v[126:127],v5 offset:6400
v_fma_f32 v85,v85,s36,v14
v_mfma_f32_16x16x32_bf16 v[228:231],v[132:135],v[24:27],v[228:231]
v_exp_f32 v99,v99
v_mfma_f32_16x16x32_bf16 v[224:227],v[128:131],v[24:27],v[224:227]
v_cvt_pk_bf16_f32 v57,v98,v99
v_fma_f32 v84,v84,s36,v14
v_mfma_f32_16x16x32_bf16 a[16:19],v[128:131],v[28:31],a[16:19]
v_exp_f32 v104,v104
v_mfma_f32_16x16x32_bf16 a[20:23],v[132:135],v[28:31],a[20:23]
v_exp_f32 v105,v105
v_mfma_f32_16x16x32_bf16 a[68:71],v[132:135],v[32:35],a[68:71]
v_exp_f32 v107,v107
v_mfma_f32_16x16x32_bf16 a[64:67],v[128:131],v[32:35],a[64:67]
v_exp_f32 v106,v106
v_mfma_f32_16x16x32_bf16 a[112:115],v[128:131],v[36:39],a[112:115]
v_cvt_pk_bf16_f32 v41,v106,v107
v_cvt_pk_bf16_f32 v40,v104,v105
v_mfma_f32_16x16x32_bf16 a[116:119],v[132:135],v[36:39],a[116:119]
v_exp_f32 v79,v79
v_mfma_f32_16x16x32_bf16 a[120:123],v[136:139],v[36:39],a[120:123]
v_exp_f32 v76,v76
v_mfma_f32_16x16x32_bf16 a[124:127],v[140:143],v[36:39],a[124:127]
v_exp_f32 v78,v78
v_mfma_f32_16x16x32_bf16 a[76:79],v[140:143],v[32:35],a[76:79]
v_exp_f32 v77,v77
v_mfma_f32_16x16x32_bf16 a[72:75],v[136:139],v[32:35],a[72:75]
v_cvt_pk_bf16_f32 v47,v78,v79
v_cvt_pk_bf16_f32 v46,v76,v77
v_mfma_f32_16x16x32_bf16 a[24:27],v[136:139],v[28:31],a[24:27]
v_exp_f32 v84,v84
v_mfma_f32_16x16x32_bf16 a[28:31],v[140:143],v[28:31],a[28:31]
v_exp_f32 v85,v85
v_mfma_f32_16x16x32_bf16 v[236:239],v[140:143],v[24:27],v[236:239]
v_exp_f32 v86,v86
v_mfma_f32_16x16x32_bf16 v[232:235],v[136:139],v[24:27],v[232:235]
v_fma_f32 v87,v87,s36,v14
v_cvt_pk_bf16_f32 v50,v84,v85
v_mfma_f32_16x16x32_bf16 v[184:187],v[136:139],v[20:23],v[184:187]
v_exp_f32 v87,v87
v_mfma_f32_16x16x32_bf16 v[188:191],v[140:143],v[20:23],v[188:191]
v_cvt_pk_bf16_f32 v51,v86,v87
v_fma_f32 v93,v93,s36,v15
v_mfma_f32_16x16x32_bf16 v[192:195],v[112:115],v[20:23],v[192:195]
v_exp_f32 v93,v93
v_smfmac_f32_16x16x64_bf16 v[60:63],v[152:155],v[44:51],v18
v_fma_f32 v94,v94,s36,v15
v_mfma_f32_16x16x32_bf16 v[196:199],v[116:119],v[20:23],v[196:199]
s_waitcnt vmcnt(9) lgkmcnt(0)
v_exp_f32 v94,v94
v_mfma_f32_16x16x32_bf16 v[244:247],v[116:119],v[24:27],v[244:247]
s_barrier
v_mfma_f32_16x16x32_bf16 v[240:243],v[112:115],v[24:27],v[240:243]
ds_read_b128 v[128:131],v0 offset:24576
v_fma_f32 v92,v92,s36,v15
v_mfma_f32_16x16x32_bf16 a[32:35],v[112:115],v[28:31],a[32:35]
ds_read_b128 v[132:135],v1 offset:24576
v_fma_f32 v95,v95,s36,v15
v_mfma_f32_16x16x32_bf16 a[36:39],v[116:119],v[28:31],a[36:39]
ds_read_b128 v[136:139],v0 offset:24704
v_fma_f32 v102,v102,s36,v16
v_mfma_f32_16x16x32_bf16 a[84:87],v[116:119],v[32:35],a[84:87]
ds_read_b128 v[140:143],v1 offset:24704
v_fma_f32 v103,v103,s36,v16
v_mfma_f32_16x16x32_bf16 a[80:83],v[112:115],v[32:35],a[80:83]
ds_read_b128 v[156:159],v10 offset:6144
v_fma_f32 v101,v101,s36,v16
v_mfma_f32_16x16x32_bf16 a[128:131],v[112:115],v[36:39],a[128:131]
buffer_load_dwordx4 v6,s[8:11],s21 offen offset:0 lds
v_mfma_f32_16x16x32_bf16 a[132:135],v[116:119],v[36:39],a[132:135]
ds_read_b128 v[112:115],v0 offset:24832
v_fma_f32 v100,v100,s36,v16
v_mfma_f32_16x16x32_bf16 a[136:139],v[120:123],v[36:39],a[136:139]
ds_read_b128 v[116:119],v1 offset:24832
v_fma_f32 v110,v110,s36,v17
v_mfma_f32_16x16x32_bf16 a[140:143],v[124:127],v[36:39],a[140:143]
v_exp_f32 v95,v95
v_mfma_f32_16x16x32_bf16 a[92:95],v[124:127],v[32:35],a[92:95]
v_exp_f32 v92,v92
v_mfma_f32_16x16x32_bf16 a[88:91],v[120:123],v[32:35],a[88:91]
v_cvt_pk_bf16_f32 v55,v94,v95
v_cvt_pk_bf16_f32 v54,v92,v93
v_mfma_f32_16x16x32_bf16 a[40:43],v[120:123],v[28:31],a[40:43]
v_exp_f32 v100,v100
v_mfma_f32_16x16x32_bf16 a[44:47],v[124:127],v[28:31],a[44:47]
v_exp_f32 v102,v102
v_mfma_f32_16x16x32_bf16 v[252:255],v[124:127],v[24:27],v[252:255]
v_exp_f32 v103,v103
v_mfma_f32_16x16x32_bf16 v[248:251],v[120:123],v[24:27],v[248:251]
v_exp_f32 v101,v101
v_mfma_f32_16x16x32_bf16 v[200:203],v[120:123],v[20:23],v[200:203]
ds_read_b128 v[120:123],v0 offset:30720
v_cvt_pk_bf16_f32 v59,v102,v103
v_mfma_f32_16x16x32_bf16 v[204:207],v[124:127],v[20:23],v[204:207]
s_waitcnt lgkmcnt(1)
buffer_store_dwordx4 v[156:159],v9,s[16:19],s27 offen offset:0 nt
buffer_load_dwordx4 v7,s[8:11],s21 offen offset:1024 lds
v_mfma_f32_16x16x32_bf16 v[72:75],v[128:131],a[144:147],0
ds_read_b128 v[124:127],v1 offset:30720
v_cvt_pk_bf16_f32 v58,v100,v101
v_mfma_f32_16x16x32_bf16 v[72:75],v[132:135],a[148:151],v[72:75]
v_exp_f32 v110,v110
v_smfmac_f32_16x16x64_bf16 v[64:67],v[152:155],v[52:59],v18
v_fma_f32 v111,v111,s36,v17
v_mfma_f32_16x16x32_bf16 v[72:75],v[136:139],a[152:155],v[72:75]
v_exp_f32 v111,v111
v_mfma_f32_16x16x32_bf16 v[72:75],v[140:143],a[156:159],v[72:75]
v_fma_f32 v108,v108,s36,v17
v_cvt_pk_bf16_f32 v43,v110,v111
v_mfma_f32_16x16x32_bf16 v[72:75],v[112:115],a[160:163],v[72:75]
ds_read_b128 v[156:159],v10 offset:7168
v_fma_f32 v109,v109,s36,v17
v_mfma_f32_16x16x32_bf16 v[72:75],v[116:119],a[164:167],v[72:75]
v_exp_f32 v108,v108
v_mfma_f32_16x16x32_bf16 v[80:83],v[116:119],a[188:191],0
v_exp_f32 v109,v109
v_mfma_f32_16x16x32_bf16 v[80:83],v[112:115],a[184:187],v[80:83]
v_cvt_pk_bf16_f32 v42,v108,v109
v_mfma_f32_16x16x32_bf16 v[80:83],v[140:143],a[180:183],v[80:83]
v_mfma_f32_16x16x32_bf16 v[80:83],v[136:139],a[176:179],v[80:83]
buffer_load_dwordx4 v8,s[8:11],s21 offen offset:2048 lds
v_smfmac_f32_16x16x64_bf16 v[68:71],v[152:155],v[36:43],v18
s_add_u32 s21,s21,12288
v_fma_f32 v75,v75,s36,v13
v_mfma_f32_16x16x32_bf16 v[80:83],v[132:135],a[172:175],v[80:83]
s_cmp_eq_u32 s38,1
v_exp_f32 v75,v75
v_mfma_f32_16x16x32_bf16 v[80:83],v[128:131],a[168:171],v[80:83]
s_cselect_b32 s20,s26,s20
v_fma_f32 v73,v73,s36,v13
v_fma_f32 v74,v74,s36,v13
v_mfma_f32_16x16x32_bf16 v[88:91],v[128:131],a[192:195],0
s_add_u32 m0,s22,12288
v_exp_f32 v73,v73
v_mfma_f32_16x16x32_bf16 v[88:91],v[132:135],a[196:199],v[88:91]
v_exp_f32 v74,v74
v_mfma_f32_16x16x32_bf16 v[88:91],v[136:139],a[200:203],v[88:91]
v_fma_f32 v82,v82,s36,v14
v_fma_f32 v81,v81,s36,v14
v_mfma_f32_16x16x32_bf16 v[88:91],v[140:143],a[204:207],v[88:91]
v_exp_f32 v81,v81
v_mfma_f32_16x16x32_bf16 v[88:91],v[112:115],a[208:211],v[88:91]
v_exp_f32 v82,v82
v_mfma_f32_16x16x32_bf16 v[88:91],v[116:119],a[212:215],v[88:91]
v_fma_f32 v72,v72,s36,v13
v_fma_f32 v80,v80,s36,v14
v_mfma_f32_16x16x32_bf16 v[96:99],v[116:119],a[236:239],0
v_exp_f32 v72,v72
v_mfma_f32_16x16x32_bf16 v[96:99],v[112:115],a[232:235],v[96:99]
s_waitcnt lgkmcnt(0)
buffer_store_dwordx4 v[156:159],v9,s[16:19],s27 offen offset:128 nt
buffer_load_dwordx4 v6,s[4:7],s20 offen offset:0 lds
v_mfma_f32_16x16x32_bf16 v[96:99],v[140:143],a[228:231],v[96:99]
v_exp_f32 v80,v80
v_mfma_f32_16x16x32_bf16 v[96:99],v[136:139],a[224:227],v[96:99]
v_fma_f32 v89,v89,s36,v15
v_fma_f32 v88,v88,s36,v15
v_mfma_f32_16x16x32_bf16 v[96:99],v[132:135],a[220:223],v[96:99]
v_exp_f32 v89,v89
v_mfma_f32_16x16x32_bf16 v[96:99],v[128:131],a[216:219],v[96:99]
v_exp_f32 v88,v88
v_mfma_f32_16x16x32_bf16 v[104:107],v[128:131],a[240:243],0
ds_read_b128 v[128:131],v0 offset:30848
v_fma_f32 v83,v83,s36,v14
v_mfma_f32_16x16x32_bf16 v[104:107],v[132:135],a[244:247],v[104:107]
ds_read_b128 v[156:159],v10 offset:8192
v_mfma_f32_16x16x32_bf16 v[104:107],v[136:139],a[248:251],v[104:107]
ds_read_b128 v[132:135],v1 offset:30848
v_mfma_f32_16x16x32_bf16 v[104:107],v[140:143],a[252:255],v[104:107]
ds_read_b128 v[136:139],v0 offset:30976
v_mfma_f32_16x16x32_bf16 v[104:107],v[112:115],v[144:147],v[104:107]
ds_read_b128 v[140:143],v1 offset:30976
v_mfma_f32_16x16x32_bf16 v[104:107],v[116:119],v[148:151],v[104:107]
v_exp_f32 v83,v83
v_mfma_f32_16x16x32_bf16 v[76:79],v[120:123],a[144:147],0
buffer_load_dwordx4 v7,s[4:7],s20 offen offset:1024 lds
v_mfma_f32_16x16x32_bf16 v[76:79],v[124:127],a[148:151],v[76:79]
s_waitcnt lgkmcnt(4)
v_cvt_pk_bf16_f32 v25,v82,v83
v_cvt_pk_bf16_f32 v20,v72,v73
v_mfma_f32_16x16x32_bf16 v[76:79],v[128:131],a[152:155],v[76:79]
s_waitcnt lgkmcnt(2)
v_cvt_pk_bf16_f32 v21,v74,v75
v_cvt_pk_bf16_f32 v24,v80,v81
v_cvt_pk_bf16_f32 v28,v88,v89
v_mfma_f32_16x16x32_bf16 v[76:79],v[132:135],a[156:159],v[76:79]
s_waitcnt lgkmcnt(1)
v_mfma_f32_16x16x32_bf16 v[76:79],v[136:139],a[160:163],v[76:79]
s_waitcnt lgkmcnt(0)
v_mfma_f32_16x16x32_bf16 v[76:79],v[140:143],a[164:167],v[76:79]
v_mfma_f32_16x16x32_bf16 v[84:87],v[140:143],a[188:191],0
v_mfma_f32_16x16x32_bf16 v[84:87],v[136:139],a[184:187],v[84:87]
v_mfma_f32_16x16x32_bf16 v[84:87],v[132:135],a[180:183],v[84:87]
v_mfma_f32_16x16x32_bf16 v[84:87],v[128:131],a[176:179],v[84:87]
v_mfma_f32_16x16x32_bf16 v[84:87],v[124:127],a[172:175],v[84:87]
buffer_store_dwordx4 v[156:159],v9,s[16:19],s27 offen offset:256 nt
buffer_load_dwordx4 v8,s[4:7],s20 offen offset:2048 lds
v_mfma_f32_16x16x32_bf16 v[84:87],v[120:123],a[168:171],v[84:87]
s_add_u32 s20,s20,12288
v_mfma_f32_16x16x32_bf16 v[92:95],v[120:123],a[192:195],0
s_add_u32 s27,s27,3072
v_mfma_f32_16x16x32_bf16 v[92:95],v[124:127],a[196:199],v[92:95]
v_mfma_f32_16x16x32_bf16 v[92:95],v[128:131],a[200:203],v[92:95]
v_mfma_f32_16x16x32_bf16 v[92:95],v[132:135],a[204:207],v[92:95]
ds_read_b64_tr_b16 v[112:113],v2 offset:12288
v_mfma_f32_16x16x32_bf16 v[92:95],v[136:139],a[208:211],v[92:95]
ds_read_b64_tr_b16 v[114:115],v2 offset:18432
v_mfma_f32_16x16x32_bf16 v[92:95],v[140:143],a[212:215],v[92:95]
v_mfma_f32_16x16x32_bf16 v[100:103],v[140:143],a[236:239],0
ds_read_b64_tr_b16 v[118:119],v3 offset:18432
v_mfma_f32_16x16x32_bf16 v[100:103],v[136:139],a[232:235],v[100:103]
ds_read_b64_tr_b16 v[116:117],v3 offset:12288
v_mfma_f32_16x16x32_bf16 v[100:103],v[132:135],a[228:231],v[100:103]
v_mfma_f32_16x16x32_bf16 v[100:103],v[128:131],a[224:227],v[100:103]
v_mfma_f32_16x16x32_bf16 v[100:103],v[124:127],a[220:223],v[100:103]
v_mfma_f32_16x16x32_bf16 v[100:103],v[120:123],a[216:219],v[100:103]
v_mfma_f32_16x16x32_bf16 v[108:111],v[120:123],a[240:243],0
ds_read_b64_tr_b16 v[122:123],v4 offset:18432
v_mfma_f32_16x16x32_bf16 v[108:111],v[124:127],a[244:247],v[108:111]
ds_read_b64_tr_b16 v[120:121],v4 offset:12288
v_mfma_f32_16x16x32_bf16 v[108:111],v[128:131],a[248:251],v[108:111]
ds_read_b64_tr_b16 v[124:125],v5 offset:12288
v_mfma_f32_16x16x32_bf16 v[108:111],v[132:135],a[252:255],v[108:111]
ds_read_b64_tr_b16 v[126:127],v5 offset:18432
v_mfma_f32_16x16x32_bf16 v[108:111],v[136:139],v[144:147],v[108:111]
v_mfma_f32_16x16x32_bf16 v[108:111],v[140:143],v[148:151],v[108:111]
s_waitcnt lgkmcnt(4)
v_mfma_f32_16x16x32_bf16 v[160:163],v[112:115],v[44:47],v[160:163]
s_add_u32 m0,s29,0
ds_read_b64_tr_b16 v[128:129],v2 offset:12416
v_fma_f32 v90,v90,s36,v15
v_mfma_f32_16x16x32_bf16 v[164:167],v[116:119],v[44:47],v[164:167]
ds_read_b64_tr_b16 v[130:131],v2 offset:18560
v_fma_f32 v91,v91,s36,v15
v_mfma_f32_16x16x32_bf16 v[212:215],v[116:119],v[48:51],v[212:215]
ds_read_b64_tr_b16 v[132:133],v3 offset:12416
v_fma_f32 v96,v96,s36,v16
v_mfma_f32_16x16x32_bf16 v[208:211],v[112:115],v[48:51],v[208:211]
ds_read_b64_tr_b16 v[134:135],v3 offset:18560
v_fma_f32 v97,v97,s36,v16
v_mfma_f32_16x16x32_bf16 a[0:3],v[112:115],v[52:55],a[0:3]
ds_read_b64_tr_b16 v[136:137],v4 offset:12416
v_fma_f32 v98,v98,s36,v16
v_mfma_f32_16x16x32_bf16 a[4:7],v[116:119],v[52:55],a[4:7]
ds_read_b64_tr_b16 v[138:139],v4 offset:18560
v_fma_f32 v99,v99,s36,v16
v_mfma_f32_16x16x32_bf16 a[52:55],v[116:119],v[56:59],a[52:55]
ds_read_b64_tr_b16 v[140:141],v5 offset:12416
v_fma_f32 v104,v104,s36,v17
v_mfma_f32_16x16x32_bf16 a[48:51],v[112:115],v[56:59],a[48:51]
buffer_load_dwordx4 v6,s[12:15],s28 offen offset:0 nt lds
v_mfma_f32_16x16x32_bf16 a[96:99],v[112:115],v[40:43],a[96:99]
ds_read_b64_tr_b16 v[142:143],v5 offset:18560
v_fma_f32 v105,v105,s36,v17
v_mfma_f32_16x16x32_bf16 a[100:103],v[116:119],v[40:43],a[100:103]
s_waitcnt lgkmcnt(5)
ds_read_b64_tr_b16 v[112:113],v2 offset:12544
v_fma_f32 v106,v106,s36,v17
v_mfma_f32_16x16x32_bf16 a[104:107],v[120:123],v[40:43],a[104:107]
ds_read_b64_tr_b16 v[114:115],v2 offset:18688
v_fma_f32 v107,v107,s36,v17
v_mfma_f32_16x16x32_bf16 a[108:111],v[124:127],v[40:43],a[108:111]
ds_read_b64_tr_b16 v[116:117],v3 offset:12544
v_fma_f32 v76,v76,s36,v13
v_mfma_f32_16x16x32_bf16 a[60:63],v[124:127],v[56:59],a[60:63]
ds_read_b64_tr_b16 v[118:119],v3 offset:18688
v_fma_f32 v77,v77,s36,v13
v_mfma_f32_16x16x32_bf16 a[56:59],v[120:123],v[56:59],a[56:59]
v_exp_f32 v90,v90
v_mfma_f32_16x16x32_bf16 a[8:11],v[120:123],v[52:55],a[8:11]
v_exp_f32 v91,v91
v_mfma_f32_16x16x32_bf16 a[12:15],v[124:127],v[52:55],a[12:15]
v_cvt_pk_bf16_f32 v29,v90,v91
v_fma_f32 v78,v78,s36,v13
v_mfma_f32_16x16x32_bf16 v[220:223],v[124:127],v[48:51],v[220:223]
v_exp_f32 v96,v96
v_mfma_f32_16x16x32_bf16 v[216:219],v[120:123],v[48:51],v[216:219]
buffer_load_dwordx4 v7,s[12:15],s28 offen offset:1024 nt lds
v_mfma_f32_16x16x32_bf16 v[168:171],v[120:123],v[44:47],v[168:171]
ds_read_b64_tr_b16 v[120:121],v4 offset:12544
v_fma_f32 v79,v79,s36,v13
v_mfma_f32_16x16x32_bf16 v[172:175],v[124:127],v[44:47],v[172:175]
ds_read_b64_tr_b16 v[122:123],v4 offset:18688
v_fma_f32 v84,v84,s36,v14
v_mfma_f32_16x16x32_bf16 v[176:179],v[128:131],v[44:47],v[176:179]
s_waitcnt lgkmcnt(2)
ds_read_b64_tr_b16 v[124:125],v5 offset:12544
v_fma_f32 v85,v85,s36,v14
v_mfma_f32_16x16x32_bf16 v[180:183],v[132:135],v[44:47],v[180:183]
ds_read_b64_tr_b16 v[126:127],v5 offset:18688
v_fma_f32 v86,v86,s36,v14
v_mfma_f32_16x16x32_bf16 v[228:231],v[132:135],v[48:51],v[228:231]
v_exp_f32 v97,v97
v_mfma_f32_16x16x32_bf16 v[224:227],v[128:131],v[48:51],v[224:227]
v_exp_f32 v98,v98
v_mfma_f32_16x16x32_bf16 a[16:19],v[128:131],v[52:55],a[16:19]
v_exp_f32 v99,v99
v_mfma_f32_16x16x32_bf16 a[20:23],v[132:135],v[52:55],a[20:23]
v_cvt_pk_bf16_f32 v32,v96,v97
v_cvt_pk_bf16_f32 v33,v98,v99
v_mfma_f32_16x16x32_bf16 a[68:71],v[132:135],v[56:59],a[68:71]
v_exp_f32 v104,v104
v_mfma_f32_16x16x32_bf16 a[64:67],v[128:131],v[56:59],a[64:67]
buffer_load_dwordx4 v8,s[12:15],s28 offen offset:2048 nt lds
v_mfma_f32_16x16x32_bf16 a[112:115],v[128:131],v[40:43],a[112:115]
s_add_u32 s28,s28,3072
v_exp_f32 v105,v105
v_mfma_f32_16x16x32_bf16 a[116:119],v[132:135],v[40:43],a[116:119]
s_add_u32 s29,s29,3072
v_exp_f32 v106,v106
v_mfma_f32_16x16x32_bf16 a[120:123],v[136:139],v[40:43],a[120:123]
s_cmp_eq_u32 s38,1
v_exp_f32 v107,v107
v_mfma_f32_16x16x32_bf16 a[124:127],v[140:143],v[40:43],a[124:127]
s_cselect_b32 s21,s26,s21
v_cvt_pk_bf16_f32 v36,v104,v105
v_cvt_pk_bf16_f32 v37,v106,v107
v_mfma_f32_16x16x32_bf16 a[76:79],v[140:143],v[56:59],a[76:79]
s_add_u32 m0,s23,12288
v_exp_f32 v76,v76
v_mfma_f32_16x16x32_bf16 a[72:75],v[136:139],v[56:59],a[72:75]
v_exp_f32 v77,v77
v_mfma_f32_16x16x32_bf16 a[24:27],v[136:139],v[52:55],a[24:27]
v_exp_f32 v78,v78
v_mfma_f32_16x16x32_bf16 a[28:31],v[140:143],v[52:55],a[28:31]
v_exp_f32 v79,v79
v_mfma_f32_16x16x32_bf16 v[236:239],v[140:143],v[48:51],v[236:239]
v_cvt_pk_bf16_f32 v22,v76,v77
v_cvt_pk_bf16_f32 v23,v78,v79
v_mfma_f32_16x16x32_bf16 v[232:235],v[136:139],v[48:51],v[232:235]
v_fma_f32 v87,v87,s36,v14
v_fma_f32 v92,v92,s36,v15
v_mfma_f32_16x16x32_bf16 v[184:187],v[136:139],v[44:47],v[184:187]
v_exp_f32 v84,v84
v_mfma_f32_16x16x32_bf16 v[188:191],v[140:143],v[44:47],v[188:191]
v_exp_f32 v85,v85
v_mfma_f32_16x16x32_bf16 v[192:195],v[112:115],v[44:47],v[192:195]
v_exp_f32 v86,v86
v_mfma_f32_16x16x32_bf16 v[196:199],v[116:119],v[44:47],v[196:199]
s_waitcnt vmcnt(12) lgkmcnt(0)
v_exp_f32 v87,v87
v_mfma_f32_16x16x32_bf16 v[244:247],v[116:119],v[48:51],v[244:247]
s_barrier
v_mfma_f32_16x16x32_bf16 v[240:243],v[112:115],v[48:51],v[240:243]
ds_read_b128 v[128:131],v0 offset:0
v_cvt_pk_bf16_f32 v26,v84,v85
v_mfma_f32_16x16x32_bf16 a[32:35],v[112:115],v[52:55],a[32:35]
ds_read_b128 v[132:135],v1 offset:0
v_cvt_pk_bf16_f32 v27,v86,v87
v_mfma_f32_16x16x32_bf16 a[36:39],v[116:119],v[52:55],a[36:39]
ds_read_b128 v[136:139],v0 offset:128
v_fma_f32 v93,v93,s36,v15
v_smfmac_f32_16x16x64_bf16 v[60:63],v[152:155],v[20:27],v18
ds_read_b128 v[140:143],v1 offset:128
v_mfma_f32_16x16x32_bf16 a[84:87],v[116:119],v[56:59],a[84:87]
v_fma_f32 v94,v94,s36,v15
v_fma_f32 v95,v95,s36,v15
v_mfma_f32_16x16x32_bf16 a[80:83],v[112:115],v[56:59],a[80:83]
buffer_load_dwordx4 v6,s[8:11],s21 offen offset:0 lds
v_mfma_f32_16x16x32_bf16 a[128:131],v[112:115],v[40:43],a[128:131]
ds_read_b128 v[112:115],v0 offset:256
v_fma_f32 v100,v100,s36,v16
v_mfma_f32_16x16x32_bf16 a[132:135],v[116:119],v[40:43],a[132:135]
ds_read_b128 v[116:119],v1 offset:256
v_fma_f32 v101,v101,s36,v16
v_mfma_f32_16x16x32_bf16 a[136:139],v[120:123],v[40:43],a[136:139]
v_exp_f32 v92,v92
v_mfma_f32_16x16x32_bf16 a[140:143],v[124:127],v[40:43],a[140:143]
v_exp_f32 v93,v93
v_mfma_f32_16x16x32_bf16 a[92:95],v[124:127],v[56:59],a[92:95]
v_exp_f32 v94,v94
v_mfma_f32_16x16x32_bf16 a[88:91],v[120:123],v[56:59],a[88:91]
v_exp_f32 v95,v95
v_mfma_f32_16x16x32_bf16 a[40:43],v[120:123],v[52:55],a[40:43]
v_cvt_pk_bf16_f32 v30,v92,v93
v_cvt_pk_bf16_f32 v31,v94,v95
v_mfma_f32_16x16x32_bf16 a[44:47],v[124:127],v[52:55],a[44:47]
v_fma_f32 v102,v102,s36,v16
v_fma_f32 v103,v103,s36,v16
v_mfma_f32_16x16x32_bf16 v[252:255],v[124:127],v[48:51],v[252:255]
v_exp_f32 v100,v100
v_mfma_f32_16x16x32_bf16 v[248:251],v[120:123],v[48:51],v[248:251]
v_exp_f32 v101,v101
v_mfma_f32_16x16x32_bf16 v[200:203],v[120:123],v[44:47],v[200:203]
buffer_load_dwordx4 v7,s[8:11],s21 offen offset:1024 lds
v_mfma_f32_16x16x32_bf16 v[204:207],v[124:127],v[44:47],v[204:207]
s_waitcnt lgkmcnt(0)
ds_read_b128 v[120:123],v0 offset:6144
v_cvt_pk_bf16_f32 v34,v100,v101
v_mfma_f32_16x16x32_bf16 v[72:75],v[128:131],a[144:147],0
ds_read_b128 v[124:127],v1 offset:6144
v_fma_f32 v108,v108,s36,v17
v_mfma_f32_16x16x32_bf16 v[72:75],v[132:135],a[148:151],v[72:75]
v_exp_f32 v102,v102
v_mfma_f32_16x16x32_bf16 v[72:75],v[136:139],a[152:155],v[72:75]
v_exp_f32 v103,v103
v_mfma_f32_16x16x32_bf16 v[72:75],v[140:143],a[156:159],v[72:75]
v_cvt_pk_bf16_f32 v35,v102,v103
v_fma_f32 v109,v109,s36,v17
v_mfma_f32_16x16x32_bf16 v[72:75],v[112:115],a[160:163],v[72:75]
v_fma_f32 v110,v110,s36,v17
v_fma_f32 v111,v111,s36,v17
v_smfmac_f32_16x16x64_bf16 v[64:67],v[152:155],v[28:35],v18
v_add_u32 v10,9216,v10
v_mfma_f32_16x16x32_bf16 v[72:75],v[116:119],a[164:167],v[72:75]
v_exp_f32 v108,v108
v_mfma_f32_16x16x32_bf16 v[80:83],v[116:119],a[188:191],0
v_exp_f32 v109,v109
v_mfma_f32_16x16x32_bf16 v[80:83],v[112:115],a[184:187],v[80:83]
v_exp_f32 v110,v110
v_mfma_f32_16x16x32_bf16 v[80:83],v[140:143],a[180:183],v[80:83]
v_exp_f32 v111,v111
v_mfma_f32_16x16x32_bf16 v[80:83],v[136:139],a[176:179],v[80:83]
buffer_load_dwordx4 v8,s[8:11],s21 offen offset:2048 lds
v_mfma_f32_16x16x32_bf16 v[80:83],v[132:135],a[172:175],v[80:83]
s_add_u32 s21,s21,12288
v_cvt_pk_bf16_f32 v38,v108,v109
v_cvt_pk_bf16_f32 v39,v110,v111
v_mfma_f32_16x16x32_bf16 v[80:83],v[128:131],a[168:171],v[80:83]
s_add_u32 m0,s22,24576
v_fma_f32 v72,v72,s36,v13
v_fma_f32 v73,v73,s36,v13
v_mfma_f32_16x16x32_bf16 v[88:91],v[128:131],a[192:195],0
v_fma_f32 v74,v74,s36,v13
v_fma_f32 v75,v75,s36,v13
v_mfma_f32_16x16x32_bf16 v[88:91],v[132:135],a[196:199],v[88:91]
v_exp_f32 v72,v72
v_mfma_f32_16x16x32_bf16 v[88:91],v[136:139],a[200:203],v[88:91]
v_fma_f32 v80,v80,s36,v14
v_fma_f32 v81,v81,s36,v14
v_mfma_f32_16x16x32_bf16 v[88:91],v[140:143],a[204:207],v[88:91]
v_fma_f32 v82,v82,s36,v14
v_fma_f32 v83,v83,s36,v14
v_mfma_f32_16x16x32_bf16 v[88:91],v[112:115],a[208:211],v[88:91]
v_exp_f32 v73,v73
v_mfma_f32_16x16x32_bf16 v[88:91],v[116:119],a[212:215],v[88:91]
v_exp_f32 v74,v74
v_mfma_f32_16x16x32_bf16 v[96:99],v[116:119],a[236:239],0
v_exp_f32 v75,v75
v_mfma_f32_16x16x32_bf16 v[96:99],v[112:115],a[232:235],v[96:99]
v_exp_f32 v80,v80
v_mfma_f32_16x16x32_bf16 v[96:99],v[140:143],a[228:231],v[96:99]
buffer_load_dwordx4 v6,s[4:7],s20 offen offset:0 lds
v_mfma_f32_16x16x32_bf16 v[96:99],v[136:139],a[224:227],v[96:99]
v_fma_f32 v88,v88,s36,v15
v_fma_f32 v89,v89,s36,v15
v_mfma_f32_16x16x32_bf16 v[96:99],v[132:135],a[220:223],v[96:99]
v_exp_f32 v81,v81
v_mfma_f32_16x16x32_bf16 v[96:99],v[128:131],a[216:219],v[96:99]
v_exp_f32 v82,v82
v_mfma_f32_16x16x32_bf16 v[104:107],v[128:131],a[240:243],0
ds_read_b128 v[128:131],v0 offset:6272
v_cvt_pk_bf16_f32 v44,v72,v73
v_mfma_f32_16x16x32_bf16 v[104:107],v[132:135],a[244:247],v[104:107]
ds_read_b128 v[132:135],v1 offset:6272
v_cvt_pk_bf16_f32 v45,v74,v75
v_mfma_f32_16x16x32_bf16 v[104:107],v[136:139],a[248:251],v[104:107]
ds_read_b128 v[136:139],v0 offset:6400
v_cvt_pk_bf16_f32 v48,v80,v81
v_mfma_f32_16x16x32_bf16 v[104:107],v[140:143],a[252:255],v[104:107]
ds_read_b128 v[140:143],v1 offset:6400
v_mfma_f32_16x16x32_bf16 v[104:107],v[112:115],v[144:147],v[104:107]
v_exp_f32 v83,v83
v_mfma_f32_16x16x32_bf16 v[104:107],v[116:119],v[148:151],v[104:107]
s_waitcnt lgkmcnt(4)
v_exp_f32 v88,v88
v_mfma_f32_16x16x32_bf16 v[76:79],v[120:123],a[144:147],0
v_exp_f32 v89,v89
v_mfma_f32_16x16x32_bf16 v[76:79],v[124:127],a[148:151],v[76:79]
buffer_load_dwordx4 v7,s[4:7],s20 offen offset:1024 lds
s_waitcnt lgkmcnt(3)
v_mfma_f32_16x16x32_bf16 v[76:79],v[128:131],a[152:155],v[76:79]
s_waitcnt lgkmcnt(2)
v_cvt_pk_bf16_f32 v49,v82,v83
v_cvt_pk_bf16_f32 v52,v88,v89
v_mfma_f32_16x16x32_bf16 v[76:79],v[132:135],a[156:159],v[76:79]
s_waitcnt lgkmcnt(0)
v_mfma_f32_16x16x32_bf16 v[76:79],v[136:139],a[160:163],v[76:79]
v_mfma_f32_16x16x32_bf16 v[76:79],v[140:143],a[164:167],v[76:79]
v_mfma_f32_16x16x32_bf16 v[84:87],v[140:143],a[188:191],0
v_mfma_f32_16x16x32_bf16 v[84:87],v[136:139],a[184:187],v[84:87]
v_mfma_f32_16x16x32_bf16 v[84:87],v[132:135],a[180:183],v[84:87]
v_mfma_f32_16x16x32_bf16 v[84:87],v[128:131],a[176:179],v[84:87]
v_mfma_f32_16x16x32_bf16 v[84:87],v[124:127],a[172:175],v[84:87]
v_mfma_f32_16x16x32_bf16 v[84:87],v[120:123],a[168:171],v[84:87]
v_mfma_f32_16x16x32_bf16 v[92:95],v[120:123],a[192:195],0
v_mfma_f32_16x16x32_bf16 v[92:95],v[124:127],a[196:199],v[92:95]
buffer_load_dwordx4 v8,s[4:7],s20 offen offset:2048 lds
v_mfma_f32_16x16x32_bf16 v[92:95],v[128:131],a[200:203],v[92:95]
s_add_u32 s20,s20,12288
s_add_u32 s38,s38,1
s_cmp_lt_u32 s38,2
v_mfma_f32_16x16x32_bf16 v[92:95],v[132:135],a[204:207],v[92:95]
v_mfma_f32_16x16x32_bf16 v[92:95],v[136:139],a[208:211],v[92:95]
v_mfma_f32_16x16x32_bf16 v[92:95],v[140:143],a[212:215],v[92:95]
v_mfma_f32_16x16x32_bf16 v[100:103],v[140:143],a[236:239],0
ds_read_b64_tr_b16 v[112:113],v2 offset:24576
v_mfma_f32_16x16x32_bf16 v[100:103],v[136:139],a[232:235],v[100:103]
ds_read_b64_tr_b16 v[114:115],v2 offset:30720
v_mfma_f32_16x16x32_bf16 v[100:103],v[132:135],a[228:231],v[100:103]
v_mfma_f32_16x16x32_bf16 v[100:103],v[128:131],a[224:227],v[100:103]
ds_read_b64_tr_b16 v[116:117],v3 offset:24576
v_mfma_f32_16x16x32_bf16 v[100:103],v[124:127],a[220:223],v[100:103]
ds_read_b64_tr_b16 v[118:119],v3 offset:30720
v_mfma_f32_16x16x32_bf16 v[100:103],v[120:123],a[216:219],v[100:103]
v_mfma_f32_16x16x32_bf16 v[108:111],v[120:123],a[240:243],0
ds_read_b64_tr_b16 v[120:121],v4 offset:24576
v_mfma_f32_16x16x32_bf16 v[108:111],v[124:127],a[244:247],v[108:111]
ds_read_b64_tr_b16 v[122:123],v4 offset:30720
v_mfma_f32_16x16x32_bf16 v[108:111],v[128:131],a[248:251],v[108:111]
ds_read_b64_tr_b16 v[124:125],v5 offset:24576
v_mfma_f32_16x16x32_bf16 v[108:111],v[132:135],a[252:255],v[108:111]
ds_read_b64_tr_b16 v[126:127],v5 offset:30720
v_mfma_f32_16x16x32_bf16 v[108:111],v[136:139],v[144:147],v[108:111]
v_mfma_f32_16x16x32_bf16 v[108:111],v[140:143],v[148:151],v[108:111]
s_cbranch_scc1 L_loop5w0
s_cmp_ge_u32 s69,6
s_cbranch_scc1 L_end5
s_cmp_eq_u32 s40,0
s_cbranch_scc1 L_tr54
s_branch L_tr55
L_tr54:
s_waitcnt vmcnt(42)
s_waitcnt lgkmcnt(3)
v_mfma_f32_16x16x32_bf16 v[160:163],v[112:115],v[20:23],v[160:163]
s_add_u32 m0,s24,0
ds_read_b128 a[144:147],v11 offset:0
v_fma_f32 v90,v90,s36,v15
v_mfma_f32_16x16x32_bf16 v[164:167],v[116:119],v[20:23],v[164:167]
ds_read_b128 a[148:151],v12 offset:0
v_fma_f32 v91,v91,s36,v15
v_mfma_f32_16x16x32_bf16 v[212:215],v[116:119],v[24:27],v[212:215]
ds_read_b128 a[152:155],v11 offset:128
v_fma_f32 v96,v96,s36,v16
v_mfma_f32_16x16x32_bf16 v[208:211],v[112:115],v[24:27],v[208:211]
ds_read_b128 a[156:159],v12 offset:128
v_fma_f32 v97,v97,s36,v16
v_mfma_f32_16x16x32_bf16 a[0:3],v[112:115],v[28:31],a[0:3]
ds_read_b128 a[160:163],v11 offset:256
v_fma_f32 v98,v98,s36,v16
v_mfma_f32_16x16x32_bf16 a[4:7],v[116:119],v[28:31],a[4:7]
ds_read_b128 a[164:167],v12 offset:256
v_fma_f32 v99,v99,s36,v16
ds_read_b64_tr_b16 v[128:129],v2 offset:24704
ds_read_b64_tr_b16 v[130:131],v2 offset:30848
ds_read_b64_tr_b16 v[132:133],v3 offset:24704
ds_read_b64_tr_b16 v[134:135],v3 offset:30848
ds_read_b64_tr_b16 v[136:137],v4 offset:24704
ds_read_b64_tr_b16 v[138:139],v4 offset:30848
ds_read_b64_tr_b16 v[140:141],v5 offset:24704
ds_read_b64_tr_b16 v[142:143],v5 offset:30848
ds_read_b128 a[168:171],v11 offset:6144
v_mfma_f32_16x16x32_bf16 a[52:55],v[116:119],v[32:35],a[52:55]
v_fma_f32 v104,v104,s36,v17
ds_read_b128 a[172:175],v12 offset:6144
v_mfma_f32_16x16x32_bf16 a[48:51],v[112:115],v[32:35],a[48:51]
v_fma_f32 v105,v105,s36,v17
ds_read_b128 a[176:179],v11 offset:6272
v_mfma_f32_16x16x32_bf16 a[96:99],v[112:115],v[36:39],a[96:99]
s_waitcnt lgkmcnt(11)
buffer_load_dwordx4 v6,s[12:15],s28 offen offset:0 nt lds
v_mfma_f32_16x16x32_bf16 a[100:103],v[116:119],v[36:39],a[100:103]
ds_read_b64_tr_b16 v[112:113],v2 offset:24832
ds_read_b128 a[180:183],v12 offset:6272
v_mfma_f32_16x16x32_bf16 a[104:107],v[120:123],v[36:39],a[104:107]
v_fma_f32 v106,v106,s36,v17
ds_read_b128 a[184:187],v11 offset:6400
v_mfma_f32_16x16x32_bf16 a[108:111],v[124:127],v[36:39],a[108:111]
v_fma_f32 v107,v107,s36,v17
ds_read_b128 a[188:191],v12 offset:6400
v_mfma_f32_16x16x32_bf16 a[60:63],v[124:127],v[32:35],a[60:63]
v_fma_f32 v76,v76,s36,v13
v_fma_f32 v77,v77,s36,v13
v_mfma_f32_16x16x32_bf16 a[56:59],v[120:123],v[32:35],a[56:59]
buffer_load_dwordx4 v7,s[12:15],s28 offen offset:1024 nt lds
v_mfma_f32_16x16x32_bf16 a[8:11],v[120:123],v[28:31],a[8:11]
ds_read_b64_tr_b16 v[114:115],v2 offset:30976
ds_read_b64_tr_b16 v[116:117],v3 offset:24832
ds_read_b64_tr_b16 v[118:119],v3 offset:30976
v_mfma_f32_16x16x32_bf16 a[12:15],v[124:127],v[28:31],a[12:15]
v_fma_f32 v78,v78,s36,v13
v_fma_f32 v79,v79,s36,v13
v_mfma_f32_16x16x32_bf16 v[220:223],v[124:127],v[24:27],v[220:223]
v_fma_f32 v84,v84,s36,v14
v_fma_f32 v85,v85,s36,v14
v_mfma_f32_16x16x32_bf16 v[216:219],v[120:123],v[24:27],v[216:219]
v_fma_f32 v86,v86,s36,v14
v_fma_f32 v87,v87,s36,v14
v_mfma_f32_16x16x32_bf16 v[168:171],v[120:123],v[20:23],v[168:171]
ds_read_b64_tr_b16 v[120:121],v4 offset:24832
v_fma_f32 v92,v92,s36,v15
v_mfma_f32_16x16x32_bf16 v[172:175],v[124:127],v[20:23],v[172:175]
s_waitcnt lgkmcnt(4)
ds_read_b64_tr_b16 v[122:123],v4 offset:30976
v_fma_f32 v93,v93,s36,v15
v_mfma_f32_16x16x32_bf16 v[176:179],v[128:131],v[20:23],v[176:179]
buffer_load_dwordx4 v8,s[12:15],s28 offen offset:2048 nt lds
v_mfma_f32_16x16x32_bf16 v[180:183],v[132:135],v[20:23],v[180:183]
s_add_u32 s28,s28,3072
ds_read_b64_tr_b16 v[124:125],v5 offset:24832
v_fma_f32 v94,v94,s36,v15
v_mfma_f32_16x16x32_bf16 v[228:231],v[132:135],v[24:27],v[228:231]
s_add_u32 m0,s24,3072
ds_read_b64_tr_b16 v[126:127],v5 offset:30976
v_fma_f32 v95,v95,s36,v15
v_mfma_f32_16x16x32_bf16 v[224:227],v[128:131],v[24:27],v[224:227]
v_fma_f32 v100,v100,s36,v16
v_fma_f32 v101,v101,s36,v16
v_mfma_f32_16x16x32_bf16 a[16:19],v[128:131],v[28:31],a[16:19]
v_fma_f32 v102,v102,s36,v16
v_fma_f32 v103,v103,s36,v16
v_mfma_f32_16x16x32_bf16 a[20:23],v[132:135],v[28:31],a[20:23]
v_fma_f32 v108,v108,s36,v17
v_fma_f32 v109,v109,s36,v17
v_mfma_f32_16x16x32_bf16 a[68:71],v[132:135],v[32:35],a[68:71]
v_fma_f32 v110,v110,s36,v17
v_fma_f32 v111,v111,s36,v17
v_mfma_f32_16x16x32_bf16 a[64:67],v[128:131],v[32:35],a[64:67]
v_exp_f32 v90,v90
v_mfma_f32_16x16x32_bf16 a[112:115],v[128:131],v[36:39],a[112:115]
buffer_load_dwordx4 v6,s[12:15],s28 offen offset:0 nt lds
v_mfma_f32_16x16x32_bf16 a[116:119],v[132:135],v[36:39],a[116:119]
v_exp_f32 v91,v91
v_mfma_f32_16x16x32_bf16 a[120:123],v[136:139],v[36:39],a[120:123]
v_exp_f32 v96,v96
v_mfma_f32_16x16x32_bf16 a[124:127],v[140:143],v[36:39],a[124:127]
v_exp_f32 v97,v97
v_mfma_f32_16x16x32_bf16 a[76:79],v[140:143],v[32:35],a[76:79]
v_exp_f32 v98,v98
v_mfma_f32_16x16x32_bf16 a[72:75],v[136:139],v[32:35],a[72:75]
v_exp_f32 v99,v99
v_mfma_f32_16x16x32_bf16 a[24:27],v[136:139],v[28:31],a[24:27]
v_exp_f32 v104,v104
v_mfma_f32_16x16x32_bf16 a[28:31],v[140:143],v[28:31],a[28:31]
v_exp_f32 v105,v105
v_mfma_f32_16x16x32_bf16 v[236:239],v[140:143],v[24:27],v[236:239]
buffer_load_dwordx4 v7,s[12:15],s28 offen offset:1024 nt lds
v_mfma_f32_16x16x32_bf16 v[232:235],v[136:139],v[24:27],v[232:235]
v_exp_f32 v106,v106
v_mfma_f32_16x16x32_bf16 v[184:187],v[136:139],v[20:23],v[184:187]
v_exp_f32 v107,v107
v_mfma_f32_16x16x32_bf16 v[188:191],v[140:143],v[20:23],v[188:191]
s_waitcnt lgkmcnt(0)
v_exp_f32 v76,v76
v_mfma_f32_16x16x32_bf16 v[192:195],v[112:115],v[20:23],v[192:195]
v_exp_f32 v77,v77
v_mfma_f32_16x16x32_bf16 v[196:199],v[116:119],v[20:23],v[196:199]
v_exp_f32 v78,v78
v_mfma_f32_16x16x32_bf16 v[244:247],v[116:119],v[24:27],v[244:247]
v_exp_f32 v79,v79
v_mfma_f32_16x16x32_bf16 v[240:243],v[112:115],v[24:27],v[240:243]
v_exp_f32 v84,v84
v_mfma_f32_16x16x32_bf16 a[32:35],v[112:115],v[28:31],a[32:35]
buffer_load_dwordx4 v8,s[12:15],s28 offen offset:2048 nt lds
s_waitcnt vmcnt(20)
s_barrier
v_mfma_f32_16x16x32_bf16 a[36:39],v[116:119],v[28:31],a[36:39]
s_add_u32 s28,s28,3072
v_exp_f32 v85,v85
v_mfma_f32_16x16x32_bf16 a[84:87],v[116:119],v[32:35],a[84:87]
s_add_u32 m0,s22,0
v_exp_f32 v86,v86
v_mfma_f32_16x16x32_bf16 a[80:83],v[112:115],v[32:35],a[80:83]
buffer_load_dwordx4 v6,s[4:7],s25 offen offset:0 lds
v_mfma_f32_16x16x32_bf16 a[128:131],v[112:115],v[36:39],a[128:131]
buffer_load_dwordx4 v7,s[4:7],s25 offen offset:1024 lds
v_mfma_f32_16x16x32_bf16 a[132:135],v[116:119],v[36:39],a[132:135]
buffer_load_dwordx4 v8,s[4:7],s25 offen offset:2048 lds
v_mfma_f32_16x16x32_bf16 a[136:139],v[120:123],v[36:39],a[136:139]
v_exp_f32 v87,v87
v_mfma_f32_16x16x32_bf16 a[140:143],v[124:127],v[36:39],a[140:143]
v_exp_f32 v92,v92
v_mfma_f32_16x16x32_bf16 a[92:95],v[124:127],v[32:35],a[92:95]
v_exp_f32 v93,v93
v_mfma_f32_16x16x32_bf16 a[88:91],v[120:123],v[32:35],a[88:91]
v_exp_f32 v94,v94
v_mfma_f32_16x16x32_bf16 a[40:43],v[120:123],v[28:31],a[40:43]
ds_read_b64_tr_b16 v[128:129],v2 offset:0
v_exp_f32 v95,v95
v_mfma_f32_16x16x32_bf16 a[44:47],v[124:127],v[28:31],a[44:47]
ds_read_b64_tr_b16 v[130:131],v2 offset:6144
v_exp_f32 v100,v100
v_mfma_f32_16x16x32_bf16 v[252:255],v[124:127],v[24:27],v[252:255]
ds_read_b64_tr_b16 v[132:133],v3 offset:0
v_exp_f32 v101,v101
v_mfma_f32_16x16x32_bf16 v[248:251],v[120:123],v[24:27],v[248:251]
ds_read_b64_tr_b16 v[134:135],v3 offset:6144
v_exp_f32 v102,v102
v_mfma_f32_16x16x32_bf16 v[200:203],v[120:123],v[20:23],v[200:203]
ds_read_b64_tr_b16 v[136:137],v4 offset:0
v_exp_f32 v103,v103
v_mfma_f32_16x16x32_bf16 v[204:207],v[124:127],v[20:23],v[204:207]
ds_read_b64_tr_b16 v[138:139],v4 offset:6144
ds_read_b64_tr_b16 v[140:141],v5 offset:0
ds_read_b64_tr_b16 v[142:143],v5 offset:6144
v_exp_f32 v108,v108
v_exp_f32 v109,v109
v_exp_f32 v110,v110
v_exp_f32 v111,v111
v_cvt_pk_bf16_f32 v53,v90,v91
v_cvt_pk_bf16_f32 v56,v96,v97
v_cvt_pk_bf16_f32 v57,v98,v99
v_cvt_pk_bf16_f32 v40,v104,v105
v_cvt_pk_bf16_f32 v41,v106,v107
v_cvt_pk_bf16_f32 v46,v76,v77
v_cvt_pk_bf16_f32 v47,v78,v79
v_cvt_pk_bf16_f32 v50,v84,v85
v_cvt_pk_bf16_f32 v51,v86,v87
v_cvt_pk_bf16_f32 v54,v92,v93
v_cvt_pk_bf16_f32 v55,v94,v95
v_smfmac_f32_16x16x64_bf16 v[60:63],v[152:155],v[44:51],v18
v_cvt_pk_bf16_f32 v58,v100,v101
v_cvt_pk_bf16_f32 v59,v102,v103
v_cvt_pk_bf16_f32 v42,v108,v109
v_cvt_pk_bf16_f32 v43,v110,v111
v_smfmac_f32_16x16x64_bf16 v[64:67],v[152:155],v[52:59],v18
v_subrev_u32 v10,18432,v10
v_smfmac_f32_16x16x64_bf16 v[68:71],v[152:155],v[36:43],v18
s_waitcnt lgkmcnt(0)
v_mfma_f32_16x16x32_bf16 v[160:163],v[128:131],v[44:47],v[160:163]
s_add_u32 s87,s42,18432
ds_read_b64_tr_b16 v[112:113],v2 offset:128
v_mbcnt_lo_u32_b32 v39,-1,0
v_mfma_f32_16x16x32_bf16 v[164:167],v[132:135],v[44:47],v[164:167]
s_add_u32 s66,s42,24576
ds_read_b64_tr_b16 v[114:115],v2 offset:6272
v_mbcnt_hi_u32_b32 v39,-1,v39
v_mfma_f32_16x16x32_bf16 v[212:215],v[132:135],v[48:51],v[212:215]
ds_read_b64_tr_b16 v[116:117],v3 offset:128
v_and_b32 v38,7,v39
v_mfma_f32_16x16x32_bf16 v[208:211],v[128:131],v[48:51],v[208:211]
ds_read_b64_tr_b16 v[118:119],v3 offset:6272
v_add_f32 v68,v68,v69
v_mfma_f32_16x16x32_bf16 a[0:3],v[128:131],v[52:55],a[0:3]
ds_read_b64_tr_b16 v[120:121],v4 offset:128
v_add_f32 v60,v60,v61
v_mfma_f32_16x16x32_bf16 a[4:7],v[132:135],v[52:55],a[4:7]
ds_read_b64_tr_b16 v[122:123],v4 offset:6272
ds_read_b64_tr_b16 v[124:125],v5 offset:128
ds_read_b64_tr_b16 v[126:127],v5 offset:6272
v_mfma_f32_16x16x32_bf16 a[52:55],v[132:135],v[56:59],a[52:55]
v_add_f32 v62,v62,v63
v_add_f32 v64,v64,v65
v_mfma_f32_16x16x32_bf16 a[48:51],v[128:131],v[56:59],a[48:51]
v_add_f32 v68,v68,v70
v_add_f32 v66,v66,v67
v_mfma_f32_16x16x32_bf16 a[96:99],v[128:131],v[40:43],a[96:99]
ds_read_b64_tr_b16 v[128:129],v2 offset:256
v_max3_f32 v19,v60,v62,v64
v_mfma_f32_16x16x32_bf16 a[100:103],v[132:135],v[40:43],a[100:103]
ds_read_b64_tr_b16 v[130:131],v2 offset:6400
v_add_f32 v68,v68,v71
v_mfma_f32_16x16x32_bf16 a[104:107],v[136:139],v[40:43],a[104:107]
ds_read_b64_tr_b16 v[132:133],v3 offset:256
v_max3_f32 v19,v19,v66,v68
v_mfma_f32_16x16x32_bf16 a[108:111],v[140:143],v[40:43],a[108:111]
ds_read_b64_tr_b16 v[134:135],v3 offset:6400
v_rcp_f32 v66,v66
v_rcp_f32 v68,v68
v_accvgpr_read_b32 v72,a48
v_accvgpr_read_b32 v73,a49
v_pk_mul_f32 v[72:73],v[72:73],v[66:67] op_sel_hi:[1,0]
v_accvgpr_read_b32 v74,a50
v_accvgpr_read_b32 v75,a51
v_pk_mul_f32 v[74:75],v[74:75],v[66:67] op_sel_hi:[1,0]
v_accvgpr_read_b32 v76,a96
v_accvgpr_read_b32 v77,a97
v_pk_mul_f32 v[76:77],v[76:77],v[68:69] op_sel_hi:[1,0]
v_accvgpr_read_b32 v78,a98
v_accvgpr_read_b32 v79,a99
v_pk_mul_f32 v[78:79],v[78:79],v[68:69] op_sel_hi:[1,0]
v_accvgpr_read_b32 v80,a52
v_accvgpr_read_b32 v81,a53
v_mfma_f32_16x16x32_bf16 a[60:63],v[140:143],v[56:59],a[60:63]
v_accvgpr_read_b32 v82,a54
v_accvgpr_read_b32 v83,a55
v_accvgpr_read_b32 v84,a100
v_accvgpr_read_b32 v85,a101
v_accvgpr_read_b32 v86,a102
v_pk_mul_f32 v[80:81],v[80:81],v[66:67] op_sel_hi:[1,0]
v_pk_mul_f32 v[82:83],v[82:83],v[66:67] op_sel_hi:[1,0]
v_pk_mul_f32 v[84:85],v[84:85],v[68:69] op_sel_hi:[1,0]
v_accvgpr_read_b32 v87,a103
v_pk_mul_f32 v[86:87],v[86:87],v[68:69] op_sel_hi:[1,0]
v_accvgpr_read_b32 v92,a104
v_accvgpr_read_b32 v93,a105
v_mfma_f32_16x16x32_bf16 a[56:59],v[136:139],v[56:59],a[56:59]
v_accvgpr_read_b32 v94,a106
v_accvgpr_read_b32 v95,a107
v_mfma_f32_16x16x32_bf16 a[8:11],v[136:139],v[52:55],a[8:11]
v_accvgpr_read_b32 v100,a108
v_accvgpr_read_b32 v101,a109
v_mfma_f32_16x16x32_bf16 a[12:15],v[140:143],v[52:55],a[12:15]
v_accvgpr_read_b32 v102,a110
v_accvgpr_read_b32 v103,a111
v_mfma_f32_16x16x32_bf16 v[220:223],v[140:143],v[48:51],v[220:223]
v_accvgpr_read_b32 v88,a56
v_accvgpr_read_b32 v89,a57
v_accvgpr_read_b32 v90,a58
v_accvgpr_read_b32 v91,a59
v_accvgpr_read_b32 v96,a60
v_pk_mul_f32 v[92:93],v[92:93],v[68:69] op_sel_hi:[1,0]
v_pk_mul_f32 v[94:95],v[94:95],v[68:69] op_sel_hi:[1,0]
v_pk_mul_f32 v[88:89],v[88:89],v[66:67] op_sel_hi:[1,0]
v_pk_mul_f32 v[90:91],v[90:91],v[66:67] op_sel_hi:[1,0]
v_accvgpr_read_b32 v97,a61
v_accvgpr_read_b32 v98,a62
v_mfma_f32_16x16x32_bf16 v[216:219],v[136:139],v[48:51],v[216:219]
v_accvgpr_read_b32 v99,a63
v_cmp_ngt_f32 vcc,s37,v19
v_lshrrev_b32 v19,5,v39
v_xor_b32 v38,v38,v19
v_and_b32 v19,15,v39
v_pk_mul_f32 v[96:97],v[96:97],v[66:67] op_sel_hi:[1,0]
v_pk_mul_f32 v[100:101],v[100:101],v[68:69] op_sel_hi:[1,0]
v_pk_mul_f32 v[102:103],v[102:103],v[68:69] op_sel_hi:[1,0]
v_pk_mul_f32 v[98:99],v[98:99],v[66:67] op_sel_hi:[1,0]
v_lshl_add_u32 v19,v19,7,s24
v_lshl_add_u32 v19,v38,4,v19
v_mfma_f32_16x16x32_bf16 v[168:171],v[136:139],v[44:47],v[168:171]
s_cmp_lg_u64 vcc,0
ds_read_b64_tr_b16 v[136:137],v4 offset:256
v_bfe_u32 v38,v39,4,1
v_mfma_f32_16x16x32_bf16 v[172:175],v[140:143],v[44:47],v[172:175]
s_cselect_b32 s62,s32,0
ds_read_b64_tr_b16 v[138:139],v4 offset:6400
v_lshl_add_u32 v36,v38,3,v19
s_waitcnt lgkmcnt(2)
v_mfma_f32_16x16x32_bf16 v[176:179],v[112:115],v[44:47],v[176:179]
s_or_b32 s31,s31,s62
ds_read_b64_tr_b16 v[140:141],v5 offset:256
v_xor_b32 v37,32,v36
v_mfma_f32_16x16x32_bf16 v[180:183],v[116:119],v[44:47],v[180:183]
s_lshl_b32 s32,s32,1
ds_read_b64_tr_b16 v[142:143],v5 offset:6400
v_xor_b32 v38,64,v36
v_mfma_f32_16x16x32_bf16 v[228:231],v[116:119],v[48:51],v[228:231]
s_add_u32 m0,s23,0
v_bfe_u32 v19,v39,3,1
v_xor_b32 v39,96,v36
v_mfma_f32_16x16x32_bf16 v[224:227],v[112:115],v[48:51],v[224:227]
v_lshlrev_b32 v19,11,v19
v_cvt_pk_bf16_f32 v72,v72,v73
v_mfma_f32_16x16x32_bf16 a[16:19],v[112:115],v[52:55],a[16:19]
v_cvt_pk_bf16_f32 v76,v76,v77
v_cvt_pk_bf16_f32 v80,v80,v81
v_mfma_f32_16x16x32_bf16 a[20:23],v[116:119],v[52:55],a[20:23]
v_cvt_pk_bf16_f32 v84,v84,v85
v_cvt_pk_bf16_f32 v73,v74,v75
v_mfma_f32_16x16x32_bf16 a[68:71],v[116:119],v[56:59],a[68:71]
v_cvt_pk_bf16_f32 v77,v78,v79
v_cvt_pk_bf16_f32 v81,v82,v83
v_mfma_f32_16x16x32_bf16 a[64:67],v[112:115],v[56:59],a[64:67]
ds_write2st64_b64 v36,v[72:73],v[76:77] offset0:36 offset1:40
v_mfma_f32_16x16x32_bf16 a[112:115],v[112:115],v[40:43],a[112:115]
v_cvt_pk_bf16_f32 v85,v86,v87
v_cvt_pk_bf16_f32 v92,v92,v93
v_mfma_f32_16x16x32_bf16 a[116:119],v[116:119],v[40:43],a[116:119]
v_cvt_pk_bf16_f32 v88,v88,v89
v_cvt_pk_bf16_f32 v93,v94,v95
v_mfma_f32_16x16x32_bf16 a[120:123],v[120:123],v[40:43],a[120:123]
v_accvgpr_read_b32 v78,a66
v_accvgpr_read_b32 v79,a67
v_mfma_f32_16x16x32_bf16 a[124:127],v[124:127],v[40:43],a[124:127]
ds_write2st64_b64 v37,v[80:81],v[84:85] offset0:36 offset1:40
v_pk_mul_f32 v[78:79],v[78:79],v[66:67] op_sel_hi:[1,0]
v_accvgpr_read_b32 v76,a64
v_accvgpr_read_b32 v77,a65
v_pk_mul_f32 v[76:77],v[76:77],v[66:67] op_sel_hi:[1,0]
v_accvgpr_read_b32 v82,a114
v_accvgpr_read_b32 v83,a115
v_pk_mul_f32 v[82:83],v[82:83],v[68:69] op_sel_hi:[1,0]
v_accvgpr_read_b32 v80,a112
v_accvgpr_read_b32 v81,a113
v_pk_mul_f32 v[80:81],v[80:81],v[68:69] op_sel_hi:[1,0]
v_cvt_pk_bf16_f32 v89,v90,v91
v_accvgpr_read_b32 v86,a70
v_mfma_f32_16x16x32_bf16 a[76:79],v[124:127],v[56:59],a[76:79]
ds_write2st64_b64 v38,v[88:89],v[92:93] offset0:36 offset1:40
v_accvgpr_read_b32 v87,a71
v_pk_mul_f32 v[86:87],v[86:87],v[66:67] op_sel_hi:[1,0]
v_accvgpr_read_b32 v84,a68
v_accvgpr_read_b32 v85,a69
v_pk_mul_f32 v[84:85],v[84:85],v[66:67] op_sel_hi:[1,0]
v_accvgpr_read_b32 v90,a118
v_accvgpr_read_b32 v91,a119
v_pk_mul_f32 v[90:91],v[90:91],v[68:69] op_sel_hi:[1,0]
v_accvgpr_read_b32 v88,a116
v_accvgpr_read_b32 v89,a117
v_pk_mul_f32 v[88:89],v[88:89],v[68:69] op_sel_hi:[1,0]
v_cvt_pk_bf16_f32 v96,v96,v97
v_cvt_pk_bf16_f32 v100,v100,v101
v_mfma_f32_16x16x32_bf16 a[72:75],v[120:123],v[56:59],a[72:75]
v_cvt_pk_bf16_f32 v97,v98,v99
v_cvt_pk_bf16_f32 v101,v102,v103
v_mfma_f32_16x16x32_bf16 a[24:27],v[120:123],v[52:55],a[24:27]
ds_write2st64_b64 v39,v[96:97],v[100:101] offset0:36 offset1:40
v_mfma_f32_16x16x32_bf16 a[28:31],v[124:127],v[52:55],a[28:31]
s_waitcnt vmcnt(15)
v_cvt_pk_bf16_f32 v76,v76,v77
v_cvt_pk_bf16_f32 v80,v80,v81
v_mfma_f32_16x16x32_bf16 v[236:239],v[124:127],v[48:51],v[236:239]
ds_read_b128 a[192:195],v11 offset:12288
v_cvt_pk_bf16_f32 v77,v78,v79
ds_read_b128 a[196:199],v12 offset:12288
v_cvt_pk_bf16_f32 v81,v82,v83
ds_read_b128 a[200:203],v11 offset:12416
v_accvgpr_read_b32 v92,a72
ds_read_b128 a[204:207],v12 offset:12416
v_accvgpr_read_b32 v93,a73
ds_read_b128 a[208:211],v11 offset:12544
v_pk_mul_f32 v[92:93],v[92:93],v[66:67] op_sel_hi:[1,0]
ds_read_b128 a[212:215],v12 offset:12544
v_accvgpr_read_b32 v94,a74
ds_read_b128 v[156:159],v10 offset:18432
v_accvgpr_read_b32 v95,a75
ds_read_b128 v[104:107],v10 offset:19456
v_pk_mul_f32 v[94:95],v[94:95],v[66:67] op_sel_hi:[1,0]
ds_read_b128 v[108:111],v10 offset:20480
v_accvgpr_read_b32 v98,a122
ds_read_b128 v[72:75],v10 offset:21504
v_accvgpr_read_b32 v99,a123
ds_write2st64_b64 v36,v[76:77],v[80:81] offset0:36 offset1:40
v_pk_mul_f32 v[98:99],v[98:99],v[68:69] op_sel_hi:[1,0]
v_accvgpr_read_b32 v102,a78
v_accvgpr_read_b32 v103,a79
v_pk_mul_f32 v[102:103],v[102:103],v[66:67] op_sel_hi:[1,0]
v_accvgpr_read_b32 v96,a120
v_accvgpr_read_b32 v97,a121
v_pk_mul_f32 v[96:97],v[96:97],v[68:69] op_sel_hi:[1,0]
s_waitcnt lgkmcnt(4)
buffer_store_dwordx4 v[156:159],v9,s[16:19],s87 offen offset:0 nt
v_accvgpr_read_b32 v100,a76
v_accvgpr_read_b32 v101,a77
v_pk_mul_f32 v[100:101],v[100:101],v[66:67] op_sel_hi:[1,0]
v_accvgpr_read_b32 v78,a126
v_accvgpr_read_b32 v79,a127
v_pk_mul_f32 v[78:79],v[78:79],v[68:69] op_sel_hi:[1,0]
v_accvgpr_read_b32 v76,a124
v_accvgpr_read_b32 v77,a125
v_pk_mul_f32 v[76:77],v[76:77],v[68:69] op_sel_hi:[1,0]
v_cvt_pk_bf16_f32 v84,v84,v85
v_cvt_pk_bf16_f32 v88,v88,v89
v_mfma_f32_16x16x32_bf16 v[232:235],v[120:123],v[48:51],v[232:235]
s_waitcnt lgkmcnt(1)
buffer_store_dwordx4 v[104:107],v9,s[16:19],s87 offen offset:3072 nt
v_cvt_pk_bf16_f32 v92,v92,v93
v_cvt_pk_bf16_f32 v96,v96,v97
v_cvt_pk_bf16_f32 v85,v86,v87
v_mfma_f32_16x16x32_bf16 v[184:187],v[120:123],v[44:47],v[184:187]
v_cvt_pk_bf16_f32 v89,v90,v91
v_cvt_pk_bf16_f32 v100,v100,v101
v_mfma_f32_16x16x32_bf16 v[188:191],v[124:127],v[44:47],v[188:191]
v_cvt_pk_bf16_f32 v76,v76,v77
v_cvt_pk_bf16_f32 v93,v94,v95
v_mfma_f32_16x16x32_bf16 v[192:195],v[128:131],v[44:47],v[192:195]
ds_write2st64_b64 v37,v[84:85],v[88:89] offset0:36 offset1:40
v_mfma_f32_16x16x32_bf16 v[196:199],v[132:135],v[44:47],v[196:199]
v_cvt_pk_bf16_f32 v97,v98,v99
v_cvt_pk_bf16_f32 v101,v102,v103
v_mfma_f32_16x16x32_bf16 v[244:247],v[132:135],v[48:51],v[244:247]
s_waitcnt vmcnt(2)
s_barrier
v_mfma_f32_16x16x32_bf16 v[240:243],v[128:131],v[48:51],v[240:243]
buffer_store_dwordx4 v[108:111],v9,s[16:19],s66 offen offset:0 nt
ds_read_b128 v[112:115],v0 offset:0
v_cvt_pk_bf16_f32 v77,v78,v79
v_rcp_f32 v62,v62
v_mfma_f32_16x16x32_bf16 a[32:35],v[128:131],v[52:55],a[32:35]
ds_read_b128 v[116:119],v1 offset:0
v_rcp_f32 v64,v64
v_mfma_f32_16x16x32_bf16 a[36:39],v[132:135],v[52:55],a[36:39]
ds_write2st64_b64 v38,v[92:93],v[96:97] offset0:36 offset1:40
v_mfma_f32_16x16x32_bf16 a[84:87],v[132:135],v[56:59],a[84:87]
v_rcp_f32 v60,v60
v_mfma_f32_16x16x32_bf16 a[80:83],v[128:131],v[56:59],a[80:83]
buffer_load_dwordx4 v6,s[8:11],s25 offen offset:0 lds
v_mfma_f32_16x16x32_bf16 a[128:131],v[128:131],v[40:43],a[128:131]
buffer_store_dwordx4 v[72:75],v9,s[16:19],s66 offen offset:3072 nt
ds_read_b128 v[120:123],v0 offset:128
v_mfma_f32_16x16x32_bf16 a[132:135],v[132:135],v[40:43],a[132:135]
ds_read_b128 v[124:127],v1 offset:128
v_accvgpr_read_b32 v108,a84
v_mfma_f32_16x16x32_bf16 a[136:139],v[136:139],v[40:43],a[136:139]
ds_read_b128 v[128:131],v0 offset:256
v_accvgpr_read_b32 v88,a80
v_mfma_f32_16x16x32_bf16 a[140:143],v[140:143],v[40:43],a[140:143]
ds_write2st64_b64 v39,v[100:101],v[76:77] offset0:36 offset1:40
v_accvgpr_read_b32 v89,a81
v_pk_mul_f32 v[88:89],v[88:89],v[66:67] op_sel_hi:[1,0]
v_accvgpr_read_b32 v90,a82
buffer_load_dwordx4 v7,s[8:11],s25 offen offset:1024 lds
ds_read_b128 v[80:83],v10 offset:18432
v_accvgpr_read_b32 v91,a83
ds_read_b128 v[156:159],v10 offset:19456
v_pk_mul_f32 v[90:91],v[90:91],v[66:67] op_sel_hi:[1,0]
ds_read_b128 v[72:75],v10 offset:20480
v_accvgpr_read_b32 v104,a128
ds_read_b128 v[84:87],v10 offset:21504
v_accvgpr_read_b32 v105,a129
ds_read_b128 v[132:135],v1 offset:256
v_pk_mul_f32 v[104:105],v[104:105],v[68:69] op_sel_hi:[1,0]
v_accvgpr_read_b32 v106,a130
v_accvgpr_read_b32 v107,a131
v_pk_mul_f32 v[106:107],v[106:107],v[68:69] op_sel_hi:[1,0]
v_accvgpr_read_b32 v109,a85
v_accvgpr_read_b32 v110,a86
v_mfma_f32_16x16x32_bf16 a[92:95],v[140:143],v[56:59],a[92:95]
v_accvgpr_read_b32 v111,a87
buffer_load_dwordx4 v8,s[8:11],s25 offen offset:2048 lds
s_waitcnt lgkmcnt(4)
buffer_store_dwordx4 v[80:83],v9,s[16:19],s87 offen offset:128 nt
v_pk_mul_f32 v[108:109],v[108:109],v[66:67] op_sel_hi:[1,0]
v_pk_mul_f32 v[110:111],v[110:111],v[66:67] op_sel_hi:[1,0]
v_accvgpr_read_b32 v92,a132
v_accvgpr_read_b32 v93,a133
v_pk_mul_f32 v[92:93],v[92:93],v[68:69] op_sel_hi:[1,0]
v_accvgpr_read_b32 v94,a134
v_accvgpr_read_b32 v95,a135
v_pk_mul_f32 v[94:95],v[94:95],v[68:69] op_sel_hi:[1,0]
v_cvt_pk_bf16_f32 v88,v88,v89
v_cvt_pk_bf16_f32 v104,v104,v105
v_mfma_f32_16x16x32_bf16 a[88:91],v[136:139],v[56:59],a[88:91]
s_add_u32 m0,s23,24576
v_cvt_pk_bf16_f32 v89,v90,v91
v_cvt_pk_bf16_f32 v105,v106,v107
v_mfma_f32_16x16x32_bf16 a[40:43],v[136:139],v[52:55],a[40:43]
ds_write2st64_b64 v36,v[88:89],v[104:105] offset0:36 offset1:40
v_mfma_f32_16x16x32_bf16 a[44:47],v[140:143],v[52:55],a[44:47]
v_add_u32 v36,v36,v19
v_accvgpr_read_b32 v76,a136
v_mfma_f32_16x16x32_bf16 v[252:255],v[140:143],v[48:51],v[252:255]
s_waitcnt lgkmcnt(1)
buffer_store_dwordx4 v[156:159],v9,s[16:19],s87 offen offset:3200 nt
buffer_load_dwordx4 v6,s[8:11],s21 offen offset:0 lds
v_pk_mul_f32 v[208:209],v[208:209],v[62:63] op_sel_hi:[1,0]
v_pk_mul_f32 v[210:211],v[210:211],v[62:63] op_sel_hi:[1,0]
v_pk_mul_f32 v[224:225],v[224:225],v[62:63] op_sel_hi:[1,0]
v_pk_mul_f32 v[226:227],v[226:227],v[62:63] op_sel_hi:[1,0]
v_pk_mul_f32 v[212:213],v[212:213],v[62:63] op_sel_hi:[1,0]
v_pk_mul_f32 v[214:215],v[214:215],v[62:63] op_sel_hi:[1,0]
v_pk_mul_f32 v[228:229],v[228:229],v[62:63] op_sel_hi:[1,0]
v_pk_mul_f32 v[230:231],v[230:231],v[62:63] op_sel_hi:[1,0]
buffer_store_dwordx4 v[72:75],v9,s[16:19],s66 offen offset:128 nt
v_pk_mul_f32 v[216:217],v[216:217],v[62:63] op_sel_hi:[1,0]
v_pk_mul_f32 v[218:219],v[218:219],v[62:63] op_sel_hi:[1,0]
v_pk_mul_f32 v[232:233],v[232:233],v[62:63] op_sel_hi:[1,0]
v_pk_mul_f32 v[234:235],v[234:235],v[62:63] op_sel_hi:[1,0]
v_pk_mul_f32 v[220:221],v[220:221],v[62:63] op_sel_hi:[1,0]
v_pk_mul_f32 v[222:223],v[222:223],v[62:63] op_sel_hi:[1,0]
v_pk_mul_f32 v[236:237],v[236:237],v[62:63] op_sel_hi:[1,0]
v_pk_mul_f32 v[238:239],v[238:239],v[62:63] op_sel_hi:[1,0]
v_accvgpr_read_b32 v77,a137
v_pk_mul_f32 v[76:77],v[76:77],v[68:69] op_sel_hi:[1,0]
v_accvgpr_read_b32 v96,a88
buffer_store_dwordx4 v[84:87],v9,s[16:19],s66 offen offset:3200 nt
v_accvgpr_read_b32 v97,a89
v_pk_mul_f32 v[96:97],v[96:97],v[66:67] op_sel_hi:[1,0]
v_accvgpr_read_b32 v78,a138
v_accvgpr_read_b32 v79,a139
v_pk_mul_f32 v[78:79],v[78:79],v[68:69] op_sel_hi:[1,0]
v_accvgpr_read_b32 v100,a92
v_accvgpr_read_b32 v101,a93
v_pk_mul_f32 v[100:101],v[100:101],v[66:67] op_sel_hi:[1,0]
v_cvt_pk_bf16_f32 v108,v108,v109
v_cvt_pk_bf16_f32 v92,v92,v93
v_accvgpr_read_b32 v98,a90
v_accvgpr_read_b32 v99,a91
v_pk_mul_f32 v[98:99],v[98:99],v[66:67] op_sel_hi:[1,0]
v_accvgpr_read_b32 v88,a140
v_accvgpr_read_b32 v89,a141
v_pk_mul_f32 v[88:89],v[88:89],v[68:69] op_sel_hi:[1,0]
v_accvgpr_read_b32 v102,a94
buffer_load_dwordx4 v7,s[8:11],s21 offen offset:1024 lds
v_accvgpr_read_b32 v103,a95
v_pk_mul_f32 v[102:103],v[102:103],v[66:67] op_sel_hi:[1,0]
v_accvgpr_read_b32 v90,a142
v_accvgpr_read_b32 v91,a143
v_pk_mul_f32 v[90:91],v[90:91],v[68:69] op_sel_hi:[1,0]
v_cvt_pk_bf16_f32 v76,v76,v77
v_cvt_pk_bf16_f32 v96,v96,v97
v_mfma_f32_16x16x32_bf16 v[248:251],v[136:139],v[48:51],v[248:251]
s_waitcnt vmcnt(16)
ds_read_b128 a[216:219],v11 offset:0
v_cvt_pk_bf16_f32 v109,v110,v111
v_mfma_f32_16x16x32_bf16 v[200:203],v[136:139],v[44:47],v[200:203]
ds_read_b128 a[220:223],v12 offset:0
v_cvt_pk_bf16_f32 v93,v94,v95
v_mfma_f32_16x16x32_bf16 v[204:207],v[140:143],v[44:47],v[204:207]
ds_read_b128 a[224:227],v11 offset:128
v_cvt_pk_bf16_f32 v100,v100,v101
ds_read_b128 a[228:231],v12 offset:128
v_pk_mul_f32 v[240:241],v[240:241],v[62:63] op_sel_hi:[1,0]
ds_read_b128 a[232:235],v11 offset:256
v_pk_mul_f32 v[242:243],v[242:243],v[62:63] op_sel_hi:[1,0]
ds_read_b128 a[236:239],v12 offset:256
v_cvt_pk_bf16_f32 v88,v88,v89
ds_write2st64_b64 v37,v[108:109],v[92:93] offset0:36 offset1:40
v_add_u32 v37,v37,v19
v_cvt_pk_bf16_f32 v77,v78,v79
v_cvt_pk_bf16_f32 v97,v98,v99
ds_read_b128 v[136:139],v0 offset:6144
v_cvt_pk_bf16_f32 v101,v102,v103
buffer_load_dwordx4 v8,s[8:11],s21 offen offset:2048 lds
ds_write2st64_b64 v38,v[96:97],v[76:77] offset0:36 offset1:40
v_add_u32 v38,v38,v19
v_cvt_pk_bf16_f32 v89,v90,v91
v_accvgpr_read_b32 v84,a0
ds_read_b128 v[140:143],v1 offset:6144
v_accvgpr_read_b32 v85,a1
v_pk_mul_f32 v[84:85],v[84:85],v[64:65] op_sel_hi:[1,0]
v_accvgpr_read_b32 v86,a2
v_accvgpr_read_b32 v87,a3
v_pk_mul_f32 v[86:87],v[86:87],v[64:65] op_sel_hi:[1,0]
ds_write2st64_b64 v39,v[100:101],v[88:89] offset0:36 offset1:40
v_add_u32 v39,v39,v19
v_accvgpr_read_b32 v94,a6
v_accvgpr_read_b32 v95,a7
ds_read_b128 v[104:107],v10 offset:18432
v_accvgpr_read_b32 v92,a4
ds_read_b128 v[156:159],v10 offset:19456
v_accvgpr_read_b32 v93,a5
ds_read_b128 v[72:75],v10 offset:20480
v_accvgpr_read_b32 v110,a10
ds_read_b128 v[80:83],v10 offset:21504
v_accvgpr_read_b32 v111,a11
v_accvgpr_read_b32 v108,a8
v_accvgpr_read_b32 v109,a9
v_accvgpr_read_b32 v78,a14
v_accvgpr_read_b32 v79,a15
v_accvgpr_read_b32 v76,a12
v_accvgpr_read_b32 v77,a13
v_accvgpr_read_b32 v98,a18
v_accvgpr_read_b32 v99,a19
v_accvgpr_read_b32 v102,a34
v_accvgpr_read_b32 v103,a35
v_accvgpr_read_b32 v96,a16
v_accvgpr_read_b32 v97,a17
v_accvgpr_read_b32 v100,a32
v_accvgpr_read_b32 v101,a33
s_waitcnt lgkmcnt(3)
buffer_store_dwordx4 v[104:107],v9,s[16:19],s87 offen offset:256 nt
v_cvt_pk_bf16_f32 v208,v208,v209
v_cvt_pk_bf16_f32 v224,v224,v225
v_cvt_pk_bf16_f32 v209,v210,v211
v_cvt_pk_bf16_f32 v225,v226,v227
v_accvgpr_read_b32 v210,a22
v_accvgpr_read_b32 v211,a23
v_accvgpr_read_b32 v226,a38
v_accvgpr_read_b32 v227,a39
v_cvt_pk_bf16_f32 v212,v212,v213
ds_write2st64_b64 v36,v[208:209],v[224:225] offset0:12 offset1:14
v_accvgpr_read_b32 v208,a20
v_accvgpr_read_b32 v209,a21
v_accvgpr_read_b32 v224,a36
s_waitcnt lgkmcnt(1)
buffer_store_dwordx4 v[156:159],v9,s[16:19],s87 offen offset:3328 nt
v_accvgpr_read_b32 v225,a37
v_cvt_pk_bf16_f32 v228,v228,v229
v_cvt_pk_bf16_f32 v216,v216,v217
v_cvt_pk_bf16_f32 v232,v232,v233
v_cvt_pk_bf16_f32 v213,v214,v215
v_cvt_pk_bf16_f32 v229,v230,v231
v_cvt_pk_bf16_f32 v220,v220,v221
v_cvt_pk_bf16_f32 v236,v236,v237
v_cvt_pk_bf16_f32 v217,v218,v219
ds_write2st64_b64 v37,v[212:213],v[228:229] offset0:12 offset1:14
v_cvt_pk_bf16_f32 v233,v234,v235
v_cvt_pk_bf16_f32 v240,v240,v241
v_cvt_pk_bf16_f32 v84,v84,v85
buffer_store_dwordx4 v[72:75],v9,s[16:19],s66 offen offset:256 nt
v_cvt_pk_bf16_f32 v221,v222,v223
v_cvt_pk_bf16_f32 v237,v238,v239
v_cvt_pk_bf16_f32 v241,v242,v243
v_mfma_f32_16x16x32_bf16 v[72:75],v[112:115],a[144:147],0
s_add_u32 s21,s21,12288
v_cvt_pk_bf16_f32 v85,v86,v87
v_accvgpr_read_b32 v104,a24
v_mfma_f32_16x16x32_bf16 v[72:75],v[116:119],a[148:151],v[72:75]
s_mov_b32 s27,s42
v_accvgpr_read_b32 v105,a25
v_accvgpr_read_b32 v106,a26
v_mfma_f32_16x16x32_bf16 v[72:75],v[120:123],a[152:155],v[72:75]
s_mov_b32 s42,s41
buffer_store_dwordx4 v[80:83],v9,s[16:19],s66 offen offset:3328 nt
v_accvgpr_read_b32 v107,a27
v_accvgpr_read_b32 v214,a42
v_pk_mul_f32 v[244:245],v[244:245],v[62:63] op_sel_hi:[1,0]
v_pk_mul_f32 v[246:247],v[246:247],v[62:63] op_sel_hi:[1,0]
v_pk_mul_f32 v[92:93],v[92:93],v[64:65] op_sel_hi:[1,0]
v_pk_mul_f32 v[94:95],v[94:95],v[64:65] op_sel_hi:[1,0]
v_cvt_pk_bf16_f32 v244,v244,v245
v_cvt_pk_bf16_f32 v92,v92,v93
v_mfma_f32_16x16x32_bf16 v[72:75],v[124:127],a[156:159],v[72:75]
s_add_u32 s69,s69,1
v_cvt_pk_bf16_f32 v245,v246,v247
v_cvt_pk_bf16_f32 v93,v94,v95
v_mfma_f32_16x16x32_bf16 v[72:75],v[128:131],a[160:163],v[72:75]
s_lshl_b32 s62,s69,5
ds_write2st64_b64 v38,v[216:217],v[232:233] offset0:12 offset1:14
v_mfma_f32_16x16x32_bf16 v[72:75],v[132:135],a[164:167],v[72:75]
s_add_u32 s62,s62,s34
v_accvgpr_read_b32 v215,a43
v_accvgpr_read_b32 v212,a40
v_accvgpr_read_b32 v213,a41
v_accvgpr_read_b32 v230,a30
v_accvgpr_read_b32 v231,a31
v_pk_mul_f32 v[248:249],v[248:249],v[62:63] op_sel_hi:[1,0]
v_pk_mul_f32 v[250:251],v[250:251],v[62:63] op_sel_hi:[1,0]
v_pk_mul_f32 v[108:109],v[108:109],v[64:65] op_sel_hi:[1,0]
v_pk_mul_f32 v[110:111],v[110:111],v[64:65] op_sel_hi:[1,0]
v_cvt_pk_bf16_f32 v248,v248,v249
v_cvt_pk_bf16_f32 v108,v108,v109
v_mfma_f32_16x16x32_bf16 v[80:83],v[132:135],a[188:191],0
s_mul_i32 s63,s62,171
ds_write2st64_b64 v39,v[220:221],v[236:237] offset0:12 offset1:14
v_mfma_f32_16x16x32_bf16 v[80:83],v[128:131],a[184:187],v[80:83]
s_lshr_b32 s63,s63,9
v_cvt_pk_bf16_f32 v249,v250,v251
v_cvt_pk_bf16_f32 v109,v110,v111
v_mfma_f32_16x16x32_bf16 v[80:83],v[124:127],a[180:183],v[80:83]
s_mul_i32 s64,s63,3
v_accvgpr_read_b32 v218,a46
v_accvgpr_read_b32 v219,a47
v_accvgpr_read_b32 v228,a28
v_accvgpr_read_b32 v229,a29
v_accvgpr_read_b32 v216,a44
ds_write2st64_b64 v36,v[240:241],v[84:85] offset0:16 offset1:24
v_pk_mul_f32 v[252:253],v[252:253],v[62:63] op_sel_hi:[1,0]
v_pk_mul_f32 v[254:255],v[254:255],v[62:63] op_sel_hi:[1,0]
v_pk_mul_f32 v[76:77],v[76:77],v[64:65] op_sel_hi:[1,0]
v_pk_mul_f32 v[78:79],v[78:79],v[64:65] op_sel_hi:[1,0]
v_cvt_pk_bf16_f32 v252,v252,v253
v_cvt_pk_bf16_f32 v76,v76,v77
v_mfma_f32_16x16x32_bf16 v[80:83],v[120:123],a[176:179],v[80:83]
s_sub_u32 s62,s62,s64
v_cvt_pk_bf16_f32 v253,v254,v255
v_cvt_pk_bf16_f32 v77,v78,v79
v_mfma_f32_16x16x32_bf16 v[80:83],v[116:119],a[172:175],v[80:83]
s_add_u32 s63,s63,s33
v_accvgpr_read_b32 v217,a45
v_max3_f32 v44,v72,v73,v74
v_mfma_f32_16x16x32_bf16 v[80:83],v[112:115],a[168:171],v[80:83]
s_mul_i32 s30,s63,196608
ds_write2st64_b64 v37,v[244:245],v[92:93] offset0:16 offset1:24
v_mfma_f32_16x16x32_bf16 v[88:91],v[112:115],a[192:195],0
s_mul_i32 s41,s63,325632
v_mov_b32 v66,0
ds_read_b128 v[112:115],v0 offset:6272
v_mov_b32 v67,0
v_pk_mul_f32 v[96:97],v[96:97],v[64:65] op_sel_hi:[1,0]
v_pk_mul_f32 v[98:99],v[98:99],v[64:65] op_sel_hi:[1,0]
v_pk_mul_f32 v[100:101],v[100:101],v[64:65] op_sel_hi:[1,0]
v_pk_mul_f32 v[102:103],v[102:103],v[64:65] op_sel_hi:[1,0]
v_cvt_pk_bf16_f32 v96,v96,v97
v_cvt_pk_bf16_f32 v100,v100,v101
v_mfma_f32_16x16x32_bf16 v[88:91],v[116:119],a[196:199],v[88:91]
s_lshl_b32 s63,s3,2
ds_write2st64_b64 v38,v[248:249],v[108:109] offset0:16 offset1:24
v_mfma_f32_16x16x32_bf16 v[88:91],v[120:123],a[200:203],v[88:91]
s_add_u32 s64,s63,21
v_cvt_pk_bf16_f32 v97,v98,v99
v_cvt_pk_bf16_f32 v101,v102,v103
v_mfma_f32_16x16x32_bf16 v[88:91],v[124:127],a[204:207],v[88:91]
s_cmp_eq_u32 s3,0
ds_read_b128 v[116:119],v1 offset:6272
v_max3_f32 v48,v80,v81,v82
ds_read_b128 v[120:123],v0 offset:6400
v_pk_mul_f32 v[208:209],v[208:209],v[64:65] op_sel_hi:[1,0]
ds_write2st64_b64 v39,v[252:253],v[76:77] offset0:16 offset1:24
v_pk_mul_f32 v[210:211],v[210:211],v[64:65] op_sel_hi:[1,0]
v_pk_mul_f32 v[224:225],v[224:225],v[64:65] op_sel_hi:[1,0]
v_pk_mul_f32 v[226:227],v[226:227],v[64:65] op_sel_hi:[1,0]
v_cvt_pk_bf16_f32 v208,v208,v209
v_cvt_pk_bf16_f32 v224,v224,v225
v_mfma_f32_16x16x32_bf16 v[88:91],v[128:131],a[208:211],v[88:91]
s_cselect_b32 s64,20,s64
ds_read_b128 v[124:127],v1 offset:6400
v_cvt_pk_bf16_f32 v209,v210,v211
v_mfma_f32_16x16x32_bf16 v[88:91],v[132:135],a[212:215],v[88:91]
s_cselect_b32 s40,1,0
ds_read_b128 v[128:131],v0 offset:0
v_cvt_pk_bf16_f32 v225,v226,v227
v_mfma_f32_16x16x32_bf16 v[76:79],v[136:139],a[144:147],0
s_add_u32 s65,s63,37
ds_write2st64_b64 v36,v[96:97],v[100:101] offset0:26 offset1:28
v_pk_mul_f32 v[104:105],v[104:105],v[64:65] op_sel_hi:[1,0]
v_pk_mul_f32 v[106:107],v[106:107],v[64:65] op_sel_hi:[1,0]
v_pk_mul_f32 v[212:213],v[212:213],v[64:65] op_sel_hi:[1,0]
ds_read_b128 v[132:135],v1 offset:0
v_pk_mul_f32 v[214:215],v[214:215],v[64:65] op_sel_hi:[1,0]
v_max3_f32 v52,v88,v89,v90
v_cvt_pk_bf16_f32 v104,v104,v105
v_mfma_f32_16x16x32_bf16 v[76:79],v[140:143],a[148:151],v[76:79]
s_cmp_eq_u32 s62,2
v_cvt_pk_bf16_f32 v212,v212,v213
v_cvt_pk_bf16_f32 v105,v106,v107
s_waitcnt lgkmcnt(4)
v_mfma_f32_16x16x32_bf16 v[76:79],v[112:115],a[152:155],v[76:79]
s_cselect_b32 s64,s65,s64
ds_write2st64_b64 v37,v[208:209],v[224:225] offset0:26 offset1:28
v_mfma_f32_16x16x32_bf16 v[76:79],v[116:119],a[156:159],v[76:79]
s_cselect_b32 s40,0,s40
v_cvt_pk_bf16_f32 v213,v214,v215
v_mov_b32 v62,0
v_mov_b32 v63,0
s_add_u32 s65,s63,s3
s_cmp_eq_u32 s62,0
v_pk_mul_f32 v[228:229],v[228:229],v[64:65] op_sel_hi:[1,0]
v_pk_mul_f32 v[230:231],v[230:231],v[64:65] op_sel_hi:[1,0]
v_pk_mul_f32 v[216:217],v[216:217],v[64:65] op_sel_hi:[1,0]
v_pk_mul_f32 v[218:219],v[218:219],v[64:65] op_sel_hi:[1,0]
v_cvt_pk_bf16_f32 v228,v228,v229
v_cvt_pk_bf16_f32 v216,v216,v217
v_mfma_f32_16x16x32_bf16 v[76:79],v[120:123],a[160:163],v[76:79]
s_cselect_b32 s64,s65,s64
ds_write2st64_b64 v38,v[104:105],v[212:213] offset0:26 offset1:28
s_waitcnt lgkmcnt(2)
v_mfma_f32_16x16x32_bf16 v[76:79],v[124:127],a[164:167],v[76:79]
s_cselect_b32 s40,1,s40
v_cvt_pk_bf16_f32 v229,v230,v231
v_cvt_pk_bf16_f32 v217,v218,v219
v_mfma_f32_16x16x32_bf16 v[84:87],v[124:127],a[188:191],0
s_mul_i32 s64,s64,6144
v_mov_b32 v64,0
v_mov_b32 v65,0
s_add_u32 s41,s41,s64
s_cmp_ge_u32 s69,6
v_max3_f32 v44,v44,v75,v76
ds_write2st64_b64 v39,v[228:229],v[216:217] offset0:26 offset1:28
v_pk_mul_f32 v[160:161],v[160:161],v[60:61] op_sel_hi:[1,0]
v_pk_mul_f32 v[162:163],v[162:163],v[60:61] op_sel_hi:[1,0]
v_pk_mul_f32 v[176:177],v[176:177],v[60:61] op_sel_hi:[1,0]
v_pk_mul_f32 v[178:179],v[178:179],v[60:61] op_sel_hi:[1,0]
v_max3_f32 v44,v44,v77,v78
v_max_f32 v44,v44,v79
v_mfma_f32_16x16x32_bf16 v[84:87],v[120:123],a[184:187],v[84:87]
s_cselect_b32 s41,166723584,s41
v_mov_b32 v45,v44
v_cvt_pk_bf16_f32 v160,v160,v161
v_mfma_f32_16x16x32_bf16 v[84:87],v[116:119],a[180:183],v[84:87]
s_cselect_b32 s30,100663296,s30
v_permlane32_swap_b32 v45,v44
v_mfma_f32_16x16x32_bf16 v[84:87],v[112:115],a[176:179],v[84:87]
s_add_u32 s25,s30,s22
v_max_f32 v44,v44,v45
v_mov_b32 v45,v44
v_mfma_f32_16x16x32_bf16 v[84:87],v[140:143],a[172:175],v[84:87]
s_add_u32 s26,s25,12288
v_permlane16_swap_b32 v45,v44
v_max_f32 v44,v44,v45
v_mul_f32_e64 v13,-s36,v44
v_fma_f32 v72,v72,s36,v13
v_pk_mul_f32 v[164:165],v[164:165],v[60:61] op_sel_hi:[1,0]
v_pk_mul_f32 v[166:167],v[166:167],v[60:61] op_sel_hi:[1,0]
v_pk_mul_f32 v[180:181],v[180:181],v[60:61] op_sel_hi:[1,0]
v_pk_mul_f32 v[182:183],v[182:183],v[60:61] op_sel_hi:[1,0]
v_fma_f32 v73,v73,s36,v13
v_fma_f32 v74,v74,s36,v13
v_mfma_f32_16x16x32_bf16 v[84:87],v[136:139],a[168:171],v[84:87]
s_add_u32 m0,s22,0
v_fma_f32 v75,v75,s36,v13
v_exp_f32 v72,v72
v_mfma_f32_16x16x32_bf16 v[92:95],v[136:139],a[192:195],0
s_mov_b32 s28,s41
ds_read_b128 v[136:139],v0 offset:128
v_exp_f32 v73,v73
v_mfma_f32_16x16x32_bf16 v[92:95],v[140:143],a[196:199],v[92:95]
s_mov_b32 s29,s24
ds_read_b128 v[140:143],v1 offset:128
v_exp_f32 v74,v74
v_exp_f32 v75,v75
v_pk_mul_f32 v[168:169],v[168:169],v[60:61] op_sel_hi:[1,0]
v_pk_mul_f32 v[170:171],v[170:171],v[60:61] op_sel_hi:[1,0]
v_pk_mul_f32 v[184:185],v[184:185],v[60:61] op_sel_hi:[1,0]
v_pk_mul_f32 v[186:187],v[186:187],v[60:61] op_sel_hi:[1,0]
v_cvt_pk_bf16_f32 v20,v72,v73
v_cvt_pk_bf16_f32 v21,v74,v75
v_mfma_f32_16x16x32_bf16 v[92:95],v[112:115],a[200:203],v[92:95]
ds_read_b128 v[112:115],v0 offset:256
v_max3_f32 v48,v48,v83,v84
v_mfma_f32_16x16x32_bf16 v[92:95],v[116:119],a[204:207],v[92:95]
ds_read_b128 v[116:119],v1 offset:256
v_max3_f32 v48,v48,v85,v86
v_mfma_f32_16x16x32_bf16 v[92:95],v[120:123],a[208:211],v[92:95]
ds_read_b128 v[120:123],v0 offset:6144
v_max_f32 v48,v48,v87
v_mov_b32 v49,v48
v_fma_f32 v76,v76,s36,v13
v_fma_f32 v77,v77,s36,v13
v_pk_mul_f32 v[172:173],v[172:173],v[60:61] op_sel_hi:[1,0]
v_pk_mul_f32 v[174:175],v[174:175],v[60:61] op_sel_hi:[1,0]
v_pk_mul_f32 v[188:189],v[188:189],v[60:61] op_sel_hi:[1,0]
v_pk_mul_f32 v[190:191],v[190:191],v[60:61] op_sel_hi:[1,0]
v_permlane32_swap_b32 v49,v48
v_max_f32 v48,v48,v49
v_mfma_f32_16x16x32_bf16 v[92:95],v[124:127],a[212:215],v[92:95]
ds_read_b128 v[124:127],v1 offset:6144
v_mov_b32 v49,v48
v_mfma_f32_16x16x32_bf16 v[96:99],v[128:131],a[216:219],0
ds_read_b128 v[128:131],v0 offset:6272
v_permlane16_swap_b32 v49,v48
v_mfma_f32_16x16x32_bf16 v[96:99],v[132:135],a[220:223],v[96:99]
ds_read_b128 v[132:135],v1 offset:6272
v_max_f32 v48,v48,v49
v_mul_f32_e64 v14,-s36,v48
v_fma_f32 v80,v80,s36,v14
v_fma_f32 v81,v81,s36,v14
v_pk_mul_f32 v[192:193],v[192:193],v[60:61] op_sel_hi:[1,0]
v_pk_mul_f32 v[194:195],v[194:195],v[60:61] op_sel_hi:[1,0]
v_fma_f32 v82,v82,s36,v14
v_fma_f32 v83,v83,s36,v14
s_waitcnt lgkmcnt(3)
v_mfma_f32_16x16x32_bf16 v[96:99],v[136:139],a[224:227],v[96:99]
ds_read_b128 v[136:139],v0 offset:6400
v_exp_f32 v80,v80
v_mfma_f32_16x16x32_bf16 v[96:99],v[140:143],a[228:231],v[96:99]
ds_read_b128 v[140:143],v1 offset:6400
v_exp_f32 v81,v81
v_mfma_f32_16x16x32_bf16 v[96:99],v[112:115],a[232:235],v[96:99]
ds_read_b128 v[112:115],v0 offset:12544
v_exp_f32 v82,v82
v_mfma_f32_16x16x32_bf16 v[96:99],v[116:119],a[236:239],v[96:99]
ds_read_b128 v[116:119],v1 offset:12544
v_exp_f32 v83,v83
v_cvt_pk_bf16_f32 v24,v80,v81
v_cvt_pk_bf16_f32 v25,v82,v83
v_pk_mul_f32 v[196:197],v[196:197],v[60:61] op_sel_hi:[1,0]
v_pk_mul_f32 v[198:199],v[198:199],v[60:61] op_sel_hi:[1,0]
v_max3_f32 v52,v52,v91,v92
v_max3_f32 v52,v52,v93,v94
v_mfma_f32_16x16x32_bf16 v[100:103],v[120:123],a[216:219],0
s_waitcnt lgkmcnt(4)
ds_read_b128 v[120:123],v0 offset:18432
v_max_f32 v52,v52,v95
v_mfma_f32_16x16x32_bf16 v[100:103],v[124:127],a[220:223],v[100:103]
ds_read_b128 v[124:127],v1 offset:18432
v_mov_b32 v53,v52
v_mfma_f32_16x16x32_bf16 v[100:103],v[128:131],a[224:227],v[100:103]
ds_read_b128 v[128:131],v0 offset:12288
v_permlane32_swap_b32 v53,v52
v_max_f32 v52,v52,v53
v_mov_b32 v53,v52
v_pk_mul_f32 v[200:201],v[200:201],v[60:61] op_sel_hi:[1,0]
v_pk_mul_f32 v[202:203],v[202:203],v[60:61] op_sel_hi:[1,0]
v_permlane16_swap_b32 v53,v52
v_max_f32 v52,v52,v53
v_mfma_f32_16x16x32_bf16 v[100:103],v[132:135],a[228:231],v[100:103]
s_waitcnt lgkmcnt(3)
ds_read_b128 v[132:135],v1 offset:12288
v_mul_f32_e64 v15,-s36,v52
v_mfma_f32_16x16x32_bf16 v[100:103],v[136:139],a[232:235],v[100:103]
ds_read_b128 v[136:139],v0 offset:12416
v_fma_f32 v88,v88,s36,v15
v_mfma_f32_16x16x32_bf16 v[100:103],v[140:143],a[236:239],v[100:103]
ds_read_b128 v[140:143],v1 offset:12416
v_fma_f32 v89,v89,s36,v15
v_fma_f32 v90,v90,s36,v15
v_fma_f32 v91,v91,s36,v15
v_exp_f32 v88,v88
v_pk_mul_f32 v[204:205],v[204:205],v[60:61] op_sel_hi:[1,0]
v_pk_mul_f32 v[206:207],v[206:207],v[60:61] op_sel_hi:[1,0]
v_exp_f32 v89,v89
v_exp_f32 v90,v90
v_mfma_f32_16x16x32_bf16 v[72:75],v[116:119],a[164:167],0
v_exp_f32 v91,v91
v_mfma_f32_16x16x32_bf16 v[72:75],v[112:115],a[160:163],v[72:75]
v_cvt_pk_bf16_f32 v28,v88,v89
v_cvt_pk_bf16_f32 v29,v90,v91
v_max3_f32 v56,v96,v97,v98
v_max3_f32 v56,v56,v99,v100
v_max3_f32 v56,v56,v101,v102
v_max_f32 v56,v56,v103
v_mov_b32 v57,v56
v_fma_f32 v78,v78,s36,v13
v_fma_f32 v79,v79,s36,v13
v_permlane32_swap_b32 v57,v56
v_max_f32 v56,v56,v57
s_waitcnt lgkmcnt(0)
v_mfma_f32_16x16x32_bf16 v[72:75],v[140:143],a[156:159],v[72:75]
v_mov_b32 v57,v56
v_exp_f32 v76,v76
v_mfma_f32_16x16x32_bf16 v[72:75],v[136:139],a[152:155],v[72:75]
v_permlane16_swap_b32 v57,v56
v_mfma_f32_16x16x32_bf16 v[72:75],v[132:135],a[148:151],v[72:75]
v_max_f32 v56,v56,v57
v_mul_f32_e64 v16,-s36,v56
v_mfma_f32_16x16x32_bf16 v[72:75],v[128:131],a[144:147],v[72:75]
v_fma_f32 v96,v96,s36,v16
v_fma_f32 v97,v97,s36,v16
v_mfma_f32_16x16x32_bf16 v[80:83],v[128:131],a[168:171],0
v_fma_f32 v98,v98,s36,v16
v_fma_f32 v99,v99,s36,v16
v_mfma_f32_16x16x32_bf16 v[80:83],v[132:135],a[172:175],v[80:83]
v_exp_f32 v96,v96
v_mfma_f32_16x16x32_bf16 v[80:83],v[136:139],a[176:179],v[80:83]
v_exp_f32 v97,v97
v_mfma_f32_16x16x32_bf16 v[80:83],v[140:143],a[180:183],v[80:83]
v_exp_f32 v98,v98
v_mfma_f32_16x16x32_bf16 v[80:83],v[112:115],a[184:187],v[80:83]
v_exp_f32 v99,v99
v_mfma_f32_16x16x32_bf16 v[80:83],v[116:119],a[188:191],v[80:83]
v_cvt_pk_bf16_f32 v32,v96,v97
v_cvt_pk_bf16_f32 v33,v98,v99
v_mfma_f32_16x16x32_bf16 v[88:91],v[116:119],a[212:215],0
v_exp_f32 v77,v77
v_mfma_f32_16x16x32_bf16 v[88:91],v[112:115],a[208:211],v[88:91]
v_exp_f32 v78,v78
v_mfma_f32_16x16x32_bf16 v[88:91],v[140:143],a[204:207],v[88:91]
v_exp_f32 v79,v79
v_mfma_f32_16x16x32_bf16 v[88:91],v[136:139],a[200:203],v[88:91]
v_cvt_pk_bf16_f32 v22,v76,v77
v_cvt_pk_bf16_f32 v23,v78,v79
v_mfma_f32_16x16x32_bf16 v[88:91],v[132:135],a[196:199],v[88:91]
v_fma_f32 v84,v84,s36,v14
v_fma_f32 v85,v85,s36,v14
v_mfma_f32_16x16x32_bf16 v[88:91],v[128:131],a[192:195],v[88:91]
v_fma_f32 v86,v86,s36,v14
v_fma_f32 v87,v87,s36,v14
v_mfma_f32_16x16x32_bf16 v[96:99],v[128:131],a[216:219],0
ds_read_b128 v[128:131],v0 offset:18560
v_exp_f32 v84,v84
v_mfma_f32_16x16x32_bf16 v[96:99],v[132:135],a[220:223],v[96:99]
ds_read_b128 v[132:135],v1 offset:18560
v_exp_f32 v85,v85
v_mfma_f32_16x16x32_bf16 v[96:99],v[136:139],a[224:227],v[96:99]
ds_read_b128 v[136:139],v0 offset:18688
v_exp_f32 v86,v86
v_mfma_f32_16x16x32_bf16 v[96:99],v[140:143],a[228:231],v[96:99]
ds_read_b128 v[140:143],v1 offset:18688
v_exp_f32 v87,v87
s_waitcnt vmcnt(11)
s_barrier
v_mfma_f32_16x16x32_bf16 v[96:99],v[112:115],a[232:235],v[96:99]
v_cvt_pk_bf16_f32 v26,v84,v85
v_cvt_pk_bf16_f32 v27,v86,v87
v_mfma_f32_16x16x32_bf16 v[96:99],v[116:119],a[236:239],v[96:99]
buffer_load_dwordx4 v6,s[4:7],s20 offen offset:0 lds
v_mfma_f32_16x16x32_bf16 v[76:79],v[120:123],a[144:147],0
v_fma_f32 v92,v92,s36,v15
v_fma_f32 v93,v93,s36,v15
v_mfma_f32_16x16x32_bf16 v[76:79],v[124:127],a[148:151],v[76:79]
s_waitcnt lgkmcnt(1)
v_fma_f32 v94,v94,s36,v15
v_fma_f32 v95,v95,s36,v15
v_mfma_f32_16x16x32_bf16 v[76:79],v[128:131],a[152:155],v[76:79]
v_exp_f32 v92,v92
v_mfma_f32_16x16x32_bf16 v[76:79],v[132:135],a[156:159],v[76:79]
v_exp_f32 v93,v93
v_mfma_f32_16x16x32_bf16 v[76:79],v[136:139],a[160:163],v[76:79]
buffer_load_dwordx4 v7,s[4:7],s20 offen offset:1024 lds
s_waitcnt lgkmcnt(0)
v_mfma_f32_16x16x32_bf16 v[76:79],v[140:143],a[164:167],v[76:79]
v_exp_f32 v94,v94
v_mfma_f32_16x16x32_bf16 v[84:87],v[140:143],a[188:191],0
v_exp_f32 v95,v95
v_mfma_f32_16x16x32_bf16 v[84:87],v[136:139],a[184:187],v[84:87]
v_cvt_pk_bf16_f32 v30,v92,v93
v_cvt_pk_bf16_f32 v31,v94,v95
v_mfma_f32_16x16x32_bf16 v[84:87],v[132:135],a[180:183],v[84:87]
ds_read_b64_tr_b16 v[112:113],v2 offset:0
v_fma_f32 v100,v100,s36,v16
v_mfma_f32_16x16x32_bf16 v[84:87],v[128:131],a[176:179],v[84:87]
ds_read_b64_tr_b16 v[114:115],v2 offset:6144
v_fma_f32 v101,v101,s36,v16
v_mfma_f32_16x16x32_bf16 v[84:87],v[124:127],a[172:175],v[84:87]
buffer_load_dwordx4 v8,s[4:7],s20 offen offset:2048 lds
v_mfma_f32_16x16x32_bf16 v[84:87],v[120:123],a[168:171],v[84:87]
s_add_u32 s20,s20,12288
ds_read_b64_tr_b16 v[116:117],v3 offset:0
v_fma_f32 v102,v102,s36,v16
v_mfma_f32_16x16x32_bf16 v[92:95],v[120:123],a[192:195],0
ds_read_b64_tr_b16 v[118:119],v3 offset:6144
v_fma_f32 v103,v103,s36,v16
v_mfma_f32_16x16x32_bf16 v[92:95],v[124:127],a[196:199],v[92:95]
v_exp_f32 v100,v100
v_mfma_f32_16x16x32_bf16 v[92:95],v[128:131],a[200:203],v[92:95]
v_exp_f32 v101,v101
v_mfma_f32_16x16x32_bf16 v[92:95],v[132:135],a[204:207],v[92:95]
v_exp_f32 v102,v102
v_mfma_f32_16x16x32_bf16 v[92:95],v[136:139],a[208:211],v[92:95]
v_exp_f32 v103,v103
v_mfma_f32_16x16x32_bf16 v[92:95],v[140:143],a[212:215],v[92:95]
v_cvt_pk_bf16_f32 v34,v100,v101
v_cvt_pk_bf16_f32 v35,v102,v103
v_mfma_f32_16x16x32_bf16 v[100:103],v[140:143],a[236:239],0
v_cvt_pk_bf16_f32 v176,v176,v177
v_cvt_pk_bf16_f32 v161,v162,v163
v_smfmac_f32_16x16x64_bf16 v[64:67],v[152:155],v[28:35],v18
v_cvt_pk_bf16_f32 v164,v164,v165
v_mfma_f32_16x16x32_bf16 v[100:103],v[136:139],a[232:235],v[100:103]
v_cvt_pk_bf16_f32 v180,v180,v181
v_cvt_pk_bf16_f32 v177,v178,v179
v_mfma_f32_16x16x32_bf16 v[100:103],v[132:135],a[228:231],v[100:103]
ds_write2st64_b64 v36,v[160:161],v[176:177] offset0:0 offset1:2
v_mfma_f32_16x16x32_bf16 v[100:103],v[128:131],a[224:227],v[100:103]
v_cvt_pk_bf16_f32 v168,v168,v169
v_cvt_pk_bf16_f32 v184,v184,v185
v_mfma_f32_16x16x32_bf16 v[100:103],v[124:127],a[220:223],v[100:103]
ds_read_b64_tr_b16 v[124:125],v5 offset:0
v_cvt_pk_bf16_f32 v165,v166,v167
v_mfma_f32_16x16x32_bf16 v[100:103],v[120:123],a[216:219],v[100:103]
ds_read_b64_tr_b16 v[120:121],v4 offset:0
ds_read_b64_tr_b16 v[122:123],v4 offset:6144
ds_read_b64_tr_b16 v[126:127],v5 offset:6144
v_cvt_pk_bf16_f32 v181,v182,v183
ds_write2st64_b64 v37,v[164:165],v[180:181] offset0:0 offset1:2
v_cvt_pk_bf16_f32 v172,v172,v173
v_cvt_pk_bf16_f32 v188,v188,v189
v_mov_b32 v60,0
v_mov_b32 v61,0
v_cvt_pk_bf16_f32 v169,v170,v171
v_cvt_pk_bf16_f32 v185,v186,v187
v_smfmac_f32_16x16x64_bf16 v[60:63],v[152:155],v[20:27],v18
v_cvt_pk_bf16_f32 v192,v192,v193
v_cvt_pk_bf16_f32 v173,v174,v175
ds_write2st64_b64 v38,v[168:169],v[184:185] offset0:0 offset1:2
v_cvt_pk_bf16_f32 v189,v190,v191
v_cvt_pk_bf16_f32 v196,v196,v197
v_fma_f32 v72,v72,s36,v13
v_fma_f32 v73,v73,s36,v13
v_fma_f32 v74,v74,s36,v13
v_fma_f32 v75,v75,s36,v13
v_fma_f32 v80,v80,s36,v14
v_fma_f32 v81,v81,s36,v14
v_cvt_pk_bf16_f32 v193,v194,v195
v_cvt_pk_bf16_f32 v200,v200,v201
v_cvt_pk_bf16_f32 v197,v198,v199
ds_write2st64_b64 v39,v[172:173],v[188:189] offset0:0 offset1:2
v_exp_f32 v72,v72
v_exp_f32 v73,v73
v_exp_f32 v74,v74
v_exp_f32 v75,v75
v_exp_f32 v80,v80
v_exp_f32 v81,v81
ds_write_b64 v36,v[192:193] offset:2048
v_cvt_pk_bf16_f32 v204,v204,v205
v_cvt_pk_bf16_f32 v201,v202,v203
v_cvt_pk_bf16_f32 v205,v206,v207
v_cvt_pk_bf16_f32 v44,v72,v73
ds_write_b64 v37,v[196:197] offset:2048
v_cvt_pk_bf16_f32 v45,v74,v75
v_cvt_pk_bf16_f32 v48,v80,v81
ds_write_b64 v38,v[200:201] offset:2048
ds_write_b64 v39,v[204:205] offset:2048
s_waitcnt lgkmcnt(3)
v_mfma_f32_16x16x32_bf16 v[160:163],v[112:115],v[20:23],0
s_add_u32 m0,s23,0
ds_read_b64_tr_b16 v[128:129],v2 offset:128
v_fma_f32 v82,v82,s36,v14
v_mfma_f32_16x16x32_bf16 v[164:167],v[116:119],v[20:23],0
ds_read_b64_tr_b16 v[130:131],v2 offset:6272
v_fma_f32 v83,v83,s36,v14
v_mfma_f32_16x16x32_bf16 v[212:215],v[116:119],v[24:27],0
ds_read_b64_tr_b16 v[132:133],v3 offset:128
v_fma_f32 v88,v88,s36,v15
v_mfma_f32_16x16x32_bf16 v[208:211],v[112:115],v[24:27],0
ds_read_b64_tr_b16 v[134:135],v3 offset:6272
v_fma_f32 v89,v89,s36,v15
v_mfma_f32_16x16x32_bf16 a[0:3],v[112:115],v[28:31],0
ds_read_b64_tr_b16 v[136:137],v4 offset:128
v_fma_f32 v90,v90,s36,v15
v_mfma_f32_16x16x32_bf16 a[4:7],v[116:119],v[28:31],0
ds_read_b64_tr_b16 v[138:139],v4 offset:6272
v_fma_f32 v91,v91,s36,v15
v_mfma_f32_16x16x32_bf16 a[52:55],v[116:119],v[32:35],0
ds_read_b64_tr_b16 v[140:141],v5 offset:128
v_fma_f32 v96,v96,s36,v16
v_mfma_f32_16x16x32_bf16 a[48:51],v[112:115],v[32:35],0
ds_read_b64_tr_b16 v[142:143],v5 offset:6272
v_fma_f32 v97,v97,s36,v16
v_mfma_f32_16x16x32_bf16 a[56:59],v[120:123],v[32:35],0
ds_read_b64_tr_b16 v[112:113],v2 offset:256
v_fma_f32 v98,v98,s36,v16
v_mfma_f32_16x16x32_bf16 a[60:63],v[124:127],v[32:35],0
ds_read_b64_tr_b16 v[114:115],v2 offset:6400
v_fma_f32 v99,v99,s36,v16
v_mfma_f32_16x16x32_bf16 a[12:15],v[124:127],v[28:31],0
ds_read_b64_tr_b16 v[116:117],v3 offset:256
v_fma_f32 v76,v76,s36,v13
v_mfma_f32_16x16x32_bf16 a[8:11],v[120:123],v[28:31],0
ds_read_b64_tr_b16 v[118:119],v3 offset:6400
v_fma_f32 v77,v77,s36,v13
v_mfma_f32_16x16x32_bf16 v[216:219],v[120:123],v[24:27],0
v_exp_f32 v82,v82
v_mfma_f32_16x16x32_bf16 v[220:223],v[124:127],v[24:27],0
v_exp_f32 v83,v83
v_mfma_f32_16x16x32_bf16 v[172:175],v[124:127],v[20:23],0
ds_read_b64_tr_b16 v[124:125],v5 offset:256
v_cvt_pk_bf16_f32 v49,v82,v83
v_mfma_f32_16x16x32_bf16 v[168:171],v[120:123],v[20:23],0
s_waitcnt lgkmcnt(4)
ds_read_b64_tr_b16 v[120:121],v4 offset:256
v_fma_f32 v78,v78,s36,v13
v_mfma_f32_16x16x32_bf16 v[176:179],v[128:131],v[20:23],0
ds_read_b64_tr_b16 v[122:123],v4 offset:6400
v_fma_f32 v79,v79,s36,v13
v_mfma_f32_16x16x32_bf16 v[180:183],v[132:135],v[20:23],0
ds_read_b64_tr_b16 v[126:127],v5 offset:6400
v_fma_f32 v84,v84,s36,v14
v_mfma_f32_16x16x32_bf16 v[228:231],v[132:135],v[24:27],0
v_exp_f32 v88,v88
v_mfma_f32_16x16x32_bf16 v[224:227],v[128:131],v[24:27],0
v_exp_f32 v89,v89
v_mfma_f32_16x16x32_bf16 a[16:19],v[128:131],v[28:31],0
v_exp_f32 v90,v90
v_mfma_f32_16x16x32_bf16 a[20:23],v[132:135],v[28:31],0
v_exp_f32 v91,v91
v_mfma_f32_16x16x32_bf16 a[68:71],v[132:135],v[32:35],0
v_cvt_pk_bf16_f32 v52,v88,v89
v_cvt_pk_bf16_f32 v53,v90,v91
v_mfma_f32_16x16x32_bf16 a[64:67],v[128:131],v[32:35],0
v_exp_f32 v96,v96
v_mfma_f32_16x16x32_bf16 a[72:75],v[136:139],v[32:35],0
v_exp_f32 v97,v97
v_mfma_f32_16x16x32_bf16 a[76:79],v[140:143],v[32:35],0
v_exp_f32 v98,v98
v_mfma_f32_16x16x32_bf16 a[28:31],v[140:143],v[28:31],0
v_exp_f32 v99,v99
v_mfma_f32_16x16x32_bf16 a[24:27],v[136:139],v[28:31],0
v_cvt_pk_bf16_f32 v56,v96,v97
v_cvt_pk_bf16_f32 v57,v98,v99
v_mfma_f32_16x16x32_bf16 v[232:235],v[136:139],v[24:27],0
v_exp_f32 v76,v76
v_mfma_f32_16x16x32_bf16 v[236:239],v[140:143],v[24:27],0
v_exp_f32 v77,v77
v_mfma_f32_16x16x32_bf16 v[188:191],v[140:143],v[20:23],0
v_exp_f32 v78,v78
v_mfma_f32_16x16x32_bf16 v[184:187],v[136:139],v[20:23],0
s_waitcnt lgkmcnt(0)
v_exp_f32 v79,v79
v_mfma_f32_16x16x32_bf16 v[192:195],v[112:115],v[20:23],0
v_cvt_pk_bf16_f32 v46,v76,v77
v_cvt_pk_bf16_f32 v47,v78,v79
v_mfma_f32_16x16x32_bf16 v[196:199],v[116:119],v[20:23],0
s_waitcnt vmcnt(30)
v_fma_f32 v85,v85,s36,v14
v_fma_f32 v86,v86,s36,v14
v_mfma_f32_16x16x32_bf16 v[244:247],v[116:119],v[24:27],0
s_barrier
v_mfma_f32_16x16x32_bf16 v[240:243],v[112:115],v[24:27],0
ds_read_b128 v[140:143],v1 offset:24704
v_fma_f32 v87,v87,s36,v14
v_mfma_f32_16x16x32_bf16 a[32:35],v[112:115],v[28:31],0
ds_read_b128 v[136:139],v0 offset:24704
v_fma_f32 v92,v92,s36,v15
v_mfma_f32_16x16x32_bf16 a[36:39],v[116:119],v[28:31],0
ds_read_b128 v[132:135],v1 offset:24576
v_fma_f32 v93,v93,s36,v15
v_mfma_f32_16x16x32_bf16 a[84:87],v[116:119],v[32:35],0
ds_read_b128 v[116:119],v1 offset:24832
v_fma_f32 v94,v94,s36,v15
v_mfma_f32_16x16x32_bf16 a[80:83],v[112:115],v[32:35],0
ds_read_b128 v[112:115],v0 offset:24832
v_fma_f32 v95,v95,s36,v15
v_mfma_f32_16x16x32_bf16 a[88:91],v[120:123],v[32:35],0
buffer_load_dwordx4 v6,s[8:11],s21 offen offset:0 lds
v_mfma_f32_16x16x32_bf16 a[92:95],v[124:127],v[32:35],0
ds_read_b128 v[128:131],v0 offset:24576
v_fma_f32 v100,v100,s36,v16
v_mfma_f32_16x16x32_bf16 a[44:47],v[124:127],v[28:31],0
v_exp_f32 v84,v84
v_mfma_f32_16x16x32_bf16 a[40:43],v[120:123],v[28:31],0
v_exp_f32 v85,v85
v_mfma_f32_16x16x32_bf16 v[248:251],v[120:123],v[24:27],0
v_exp_f32 v86,v86
v_mfma_f32_16x16x32_bf16 v[252:255],v[124:127],v[24:27],0
v_exp_f32 v87,v87
v_mfma_f32_16x16x32_bf16 v[204:207],v[124:127],v[20:23],0
ds_read_b128 v[124:127],v1 offset:30720
v_cvt_pk_bf16_f32 v50,v84,v85
v_mfma_f32_16x16x32_bf16 v[200:203],v[120:123],v[20:23],0
s_waitcnt lgkmcnt(2)
ds_read_b128 v[120:123],v0 offset:30720
v_cvt_pk_bf16_f32 v51,v86,v87
v_mfma_f32_16x16x32_bf16 v[72:75],v[116:119],a[164:167],0
v_exp_f32 v92,v92
v_smfmac_f32_16x16x64_bf16 v[60:63],v[152:155],v[44:51],v18
buffer_load_dwordx4 v7,s[8:11],s21 offen offset:1024 lds
v_mfma_f32_16x16x32_bf16 v[72:75],v[112:115],a[160:163],v[72:75]
v_exp_f32 v93,v93
v_mfma_f32_16x16x32_bf16 v[72:75],v[140:143],a[156:159],v[72:75]
v_exp_f32 v94,v94
v_mfma_f32_16x16x32_bf16 v[72:75],v[136:139],a[152:155],v[72:75]
v_exp_f32 v95,v95
v_mfma_f32_16x16x32_bf16 v[72:75],v[132:135],a[148:151],v[72:75]
s_waitcnt lgkmcnt(1)
v_cvt_pk_bf16_f32 v54,v92,v93
v_cvt_pk_bf16_f32 v55,v94,v95
v_mfma_f32_16x16x32_bf16 v[72:75],v[128:131],a[144:147],v[72:75]
v_fma_f32 v101,v101,s36,v16
v_fma_f32 v102,v102,s36,v16
v_mfma_f32_16x16x32_bf16 v[80:83],v[128:131],a[168:171],0
v_fma_f32 v103,v103,s36,v16
v_mfma_f32_16x16x32_bf16 v[80:83],v[132:135],a[172:175],v[80:83]
v_exp_f32 v100,v100
v_mfma_f32_16x16x32_bf16 v[80:83],v[136:139],a[176:179],v[80:83]
buffer_load_dwordx4 v8,s[8:11],s21 offen offset:2048 lds
v_mfma_f32_16x16x32_bf16 v[80:83],v[140:143],a[180:183],v[80:83]
s_add_u32 s21,s21,12288
v_exp_f32 v101,v101
v_mfma_f32_16x16x32_bf16 v[80:83],v[112:115],a[184:187],v[80:83]
s_add_u32 m0,s22,12288
v_exp_f32 v102,v102
v_mfma_f32_16x16x32_bf16 v[80:83],v[116:119],a[188:191],v[80:83]
v_exp_f32 v103,v103
v_mfma_f32_16x16x32_bf16 v[88:91],v[116:119],a[212:215],0
v_cvt_pk_bf16_f32 v58,v100,v101
v_cvt_pk_bf16_f32 v59,v102,v103
v_mfma_f32_16x16x32_bf16 v[88:91],v[112:115],a[208:211],v[88:91]
v_fma_f32 v72,v72,s36,v13
v_fma_f32 v73,v73,s36,v13
v_smfmac_f32_16x16x64_bf16 v[64:67],v[152:155],v[52:59],v18
v_fma_f32 v74,v74,s36,v13
v_mfma_f32_16x16x32_bf16 v[88:91],v[140:143],a[204:207],v[88:91]
v_fma_f32 v75,v75,s36,v13
v_fma_f32 v80,v80,s36,v14
v_mfma_f32_16x16x32_bf16 v[88:91],v[136:139],a[200:203],v[88:91]
v_fma_f32 v81,v81,s36,v14
v_mfma_f32_16x16x32_bf16 v[88:91],v[132:135],a[196:199],v[88:91]
buffer_load_dwordx4 v6,s[4:7],s20 offen offset:0 lds
v_mfma_f32_16x16x32_bf16 v[88:91],v[128:131],a[192:195],v[88:91]
v_exp_f32 v72,v72
v_mfma_f32_16x16x32_bf16 v[96:99],v[128:131],a[216:219],0
ds_read_b128 v[128:131],v0 offset:30848
v_mfma_f32_16x16x32_bf16 v[96:99],v[132:135],a[220:223],v[96:99]
ds_read_b128 v[132:135],v1 offset:30848
v_mfma_f32_16x16x32_bf16 v[96:99],v[136:139],a[224:227],v[96:99]
ds_read_b128 v[136:139],v0 offset:30976
v_mfma_f32_16x16x32_bf16 v[96:99],v[140:143],a[228:231],v[96:99]
ds_read_b128 v[140:143],v1 offset:30976
v_mfma_f32_16x16x32_bf16 v[96:99],v[112:115],a[232:235],v[96:99]
v_exp_f32 v73,v73
v_mfma_f32_16x16x32_bf16 v[96:99],v[116:119],a[236:239],v[96:99]
s_waitcnt lgkmcnt(4)
v_exp_f32 v74,v74
v_mfma_f32_16x16x32_bf16 v[76:79],v[120:123],a[144:147],0
v_exp_f32 v75,v75
v_mfma_f32_16x16x32_bf16 v[76:79],v[124:127],a[148:151],v[76:79]
buffer_load_dwordx4 v7,s[4:7],s20 offen offset:1024 lds
s_waitcnt lgkmcnt(3)
v_mfma_f32_16x16x32_bf16 v[76:79],v[128:131],a[152:155],v[76:79]
s_waitcnt lgkmcnt(2)
v_exp_f32 v80,v80
v_mfma_f32_16x16x32_bf16 v[76:79],v[132:135],a[156:159],v[76:79]
s_waitcnt lgkmcnt(0)
v_exp_f32 v81,v81
v_mfma_f32_16x16x32_bf16 v[76:79],v[136:139],a[160:163],v[76:79]
v_cvt_pk_bf16_f32 v20,v72,v73
v_cvt_pk_bf16_f32 v21,v74,v75
v_mfma_f32_16x16x32_bf16 v[76:79],v[140:143],a[164:167],v[76:79]
v_cvt_pk_bf16_f32 v24,v80,v81
v_mfma_f32_16x16x32_bf16 v[84:87],v[140:143],a[188:191],0
v_mfma_f32_16x16x32_bf16 v[84:87],v[136:139],a[184:187],v[84:87]
v_mfma_f32_16x16x32_bf16 v[84:87],v[132:135],a[180:183],v[84:87]
v_mfma_f32_16x16x32_bf16 v[84:87],v[128:131],a[176:179],v[84:87]
v_mfma_f32_16x16x32_bf16 v[84:87],v[124:127],a[172:175],v[84:87]
buffer_load_dwordx4 v8,s[4:7],s20 offen offset:2048 lds
v_mfma_f32_16x16x32_bf16 v[84:87],v[120:123],a[168:171],v[84:87]
s_add_u32 s20,s20,12288
v_mfma_f32_16x16x32_bf16 v[92:95],v[120:123],a[192:195],0
ds_read_b64_tr_b16 v[112:113],v2 offset:12288
v_mfma_f32_16x16x32_bf16 v[92:95],v[124:127],a[196:199],v[92:95]
ds_read_b64_tr_b16 v[114:115],v2 offset:18432
v_mfma_f32_16x16x32_bf16 v[92:95],v[128:131],a[200:203],v[92:95]
ds_read_b64_tr_b16 v[116:117],v3 offset:12288
v_mfma_f32_16x16x32_bf16 v[92:95],v[132:135],a[204:207],v[92:95]
ds_read_b64_tr_b16 v[118:119],v3 offset:18432
v_mfma_f32_16x16x32_bf16 v[92:95],v[136:139],a[208:211],v[92:95]
v_mfma_f32_16x16x32_bf16 v[92:95],v[140:143],a[212:215],v[92:95]
v_mfma_f32_16x16x32_bf16 v[100:103],v[140:143],a[236:239],0
v_mfma_f32_16x16x32_bf16 v[100:103],v[136:139],a[232:235],v[100:103]
v_mfma_f32_16x16x32_bf16 v[100:103],v[132:135],a[228:231],v[100:103]
v_mfma_f32_16x16x32_bf16 v[100:103],v[128:131],a[224:227],v[100:103]
v_mfma_f32_16x16x32_bf16 v[100:103],v[124:127],a[220:223],v[100:103]
ds_read_b64_tr_b16 v[124:125],v5 offset:12288
v_mfma_f32_16x16x32_bf16 v[100:103],v[120:123],a[216:219],v[100:103]
s_waitcnt lgkmcnt(1)
ds_read_b64_tr_b16 v[120:121],v4 offset:12288
ds_read_b64_tr_b16 v[122:123],v4 offset:18432
ds_read_b64_tr_b16 v[126:127],v5 offset:18432
v_mfma_f32_16x16x32_bf16 v[160:163],v[112:115],v[44:47],v[160:163]
s_add_u32 m0,s23,12288
ds_read_b64_tr_b16 v[128:129],v2 offset:12416
v_fma_f32 v82,v82,s36,v14
v_mfma_f32_16x16x32_bf16 v[164:167],v[116:119],v[44:47],v[164:167]
ds_read_b64_tr_b16 v[130:131],v2 offset:18560
v_fma_f32 v83,v83,s36,v14
v_mfma_f32_16x16x32_bf16 v[212:215],v[116:119],v[48:51],v[212:215]
ds_read_b64_tr_b16 v[132:133],v3 offset:12416
v_fma_f32 v88,v88,s36,v15
v_mfma_f32_16x16x32_bf16 v[208:211],v[112:115],v[48:51],v[208:211]
ds_read_b64_tr_b16 v[134:135],v3 offset:18560
v_fma_f32 v89,v89,s36,v15
v_mfma_f32_16x16x32_bf16 a[0:3],v[112:115],v[52:55],a[0:3]
ds_read_b64_tr_b16 v[136:137],v4 offset:12416
v_fma_f32 v90,v90,s36,v15
v_mfma_f32_16x16x32_bf16 a[4:7],v[116:119],v[52:55],a[4:7]
ds_read_b64_tr_b16 v[138:139],v4 offset:18560
v_fma_f32 v91,v91,s36,v15
v_mfma_f32_16x16x32_bf16 a[52:55],v[116:119],v[56:59],a[52:55]
ds_read_b64_tr_b16 v[140:141],v5 offset:12416
v_fma_f32 v96,v96,s36,v16
v_mfma_f32_16x16x32_bf16 a[48:51],v[112:115],v[56:59],a[48:51]
s_waitcnt lgkmcnt(6)
ds_read_b64_tr_b16 v[142:143],v5 offset:18560
v_fma_f32 v97,v97,s36,v16
v_mfma_f32_16x16x32_bf16 a[56:59],v[120:123],v[56:59],a[56:59]
ds_read_b64_tr_b16 v[112:113],v2 offset:12544
v_fma_f32 v98,v98,s36,v16
v_mfma_f32_16x16x32_bf16 a[60:63],v[124:127],v[56:59],a[60:63]
ds_read_b64_tr_b16 v[114:115],v2 offset:18688
v_fma_f32 v99,v99,s36,v16
v_mfma_f32_16x16x32_bf16 a[12:15],v[124:127],v[52:55],a[12:15]
ds_read_b64_tr_b16 v[116:117],v3 offset:12544
v_fma_f32 v76,v76,s36,v13
v_mfma_f32_16x16x32_bf16 a[8:11],v[120:123],v[52:55],a[8:11]
ds_read_b64_tr_b16 v[118:119],v3 offset:18688
v_fma_f32 v77,v77,s36,v13
v_mfma_f32_16x16x32_bf16 v[216:219],v[120:123],v[48:51],v[216:219]
v_exp_f32 v82,v82
v_mfma_f32_16x16x32_bf16 v[220:223],v[124:127],v[48:51],v[220:223]
v_exp_f32 v83,v83
v_mfma_f32_16x16x32_bf16 v[172:175],v[124:127],v[44:47],v[172:175]
ds_read_b64_tr_b16 v[124:125],v5 offset:12544
v_cvt_pk_bf16_f32 v25,v82,v83
v_mfma_f32_16x16x32_bf16 v[168:171],v[120:123],v[44:47],v[168:171]
s_waitcnt lgkmcnt(4)
ds_read_b64_tr_b16 v[120:121],v4 offset:12544
v_fma_f32 v78,v78,s36,v13
v_mfma_f32_16x16x32_bf16 v[176:179],v[128:131],v[44:47],v[176:179]
ds_read_b64_tr_b16 v[122:123],v4 offset:18688
v_fma_f32 v79,v79,s36,v13
v_mfma_f32_16x16x32_bf16 v[180:183],v[132:135],v[44:47],v[180:183]
ds_read_b64_tr_b16 v[126:127],v5 offset:18688
v_fma_f32 v84,v84,s36,v14
v_mfma_f32_16x16x32_bf16 v[228:231],v[132:135],v[48:51],v[228:231]
v_exp_f32 v88,v88
v_mfma_f32_16x16x32_bf16 v[224:227],v[128:131],v[48:51],v[224:227]
v_exp_f32 v89,v89
v_mfma_f32_16x16x32_bf16 a[16:19],v[128:131],v[52:55],a[16:19]
v_exp_f32 v90,v90
v_mfma_f32_16x16x32_bf16 a[20:23],v[132:135],v[52:55],a[20:23]
v_exp_f32 v91,v91
v_mfma_f32_16x16x32_bf16 a[68:71],v[132:135],v[56:59],a[68:71]
v_cvt_pk_bf16_f32 v28,v88,v89
v_cvt_pk_bf16_f32 v29,v90,v91
v_mfma_f32_16x16x32_bf16 a[64:67],v[128:131],v[56:59],a[64:67]
v_exp_f32 v96,v96
v_mfma_f32_16x16x32_bf16 a[72:75],v[136:139],v[56:59],a[72:75]
v_exp_f32 v97,v97
v_mfma_f32_16x16x32_bf16 a[76:79],v[140:143],v[56:59],a[76:79]
v_exp_f32 v98,v98
v_mfma_f32_16x16x32_bf16 a[28:31],v[140:143],v[52:55],a[28:31]
v_exp_f32 v99,v99
v_mfma_f32_16x16x32_bf16 a[24:27],v[136:139],v[52:55],a[24:27]
v_cvt_pk_bf16_f32 v32,v96,v97
v_cvt_pk_bf16_f32 v33,v98,v99
v_mfma_f32_16x16x32_bf16 v[232:235],v[136:139],v[48:51],v[232:235]
v_exp_f32 v76,v76
v_mfma_f32_16x16x32_bf16 v[236:239],v[140:143],v[48:51],v[236:239]
v_exp_f32 v77,v77
v_mfma_f32_16x16x32_bf16 v[188:191],v[140:143],v[44:47],v[188:191]
v_exp_f32 v78,v78
v_mfma_f32_16x16x32_bf16 v[184:187],v[136:139],v[44:47],v[184:187]
s_waitcnt lgkmcnt(0)
v_exp_f32 v79,v79
v_mfma_f32_16x16x32_bf16 v[192:195],v[112:115],v[44:47],v[192:195]
v_cvt_pk_bf16_f32 v22,v76,v77
v_cvt_pk_bf16_f32 v23,v78,v79
v_mfma_f32_16x16x32_bf16 v[196:199],v[116:119],v[44:47],v[196:199]
s_waitcnt vmcnt(6)
v_fma_f32 v85,v85,s36,v14
v_fma_f32 v86,v86,s36,v14
v_mfma_f32_16x16x32_bf16 v[244:247],v[116:119],v[48:51],v[244:247]
s_barrier
v_mfma_f32_16x16x32_bf16 v[240:243],v[112:115],v[48:51],v[240:243]
ds_read_b128 v[140:143],v1 offset:128
v_fma_f32 v87,v87,s36,v14
v_mfma_f32_16x16x32_bf16 a[32:35],v[112:115],v[52:55],a[32:35]
ds_read_b128 v[136:139],v0 offset:128
v_fma_f32 v92,v92,s36,v15
v_mfma_f32_16x16x32_bf16 a[36:39],v[116:119],v[52:55],a[36:39]
ds_read_b128 v[132:135],v1 offset:0
v_fma_f32 v93,v93,s36,v15
v_mfma_f32_16x16x32_bf16 a[84:87],v[116:119],v[56:59],a[84:87]
ds_read_b128 v[116:119],v1 offset:256
v_fma_f32 v94,v94,s36,v15
v_mfma_f32_16x16x32_bf16 a[80:83],v[112:115],v[56:59],a[80:83]
ds_read_b128 v[112:115],v0 offset:256
v_fma_f32 v95,v95,s36,v15
v_mfma_f32_16x16x32_bf16 a[88:91],v[120:123],v[56:59],a[88:91]
buffer_load_dwordx4 v6,s[8:11],s21 offen offset:0 lds
v_mfma_f32_16x16x32_bf16 a[92:95],v[124:127],v[56:59],a[92:95]
ds_read_b128 v[128:131],v0 offset:0
v_fma_f32 v100,v100,s36,v16
v_mfma_f32_16x16x32_bf16 a[44:47],v[124:127],v[52:55],a[44:47]
v_exp_f32 v84,v84
v_mfma_f32_16x16x32_bf16 a[40:43],v[120:123],v[52:55],a[40:43]
v_exp_f32 v85,v85
v_mfma_f32_16x16x32_bf16 v[248:251],v[120:123],v[48:51],v[248:251]
v_exp_f32 v86,v86
v_mfma_f32_16x16x32_bf16 v[252:255],v[124:127],v[48:51],v[252:255]
v_exp_f32 v87,v87
v_mfma_f32_16x16x32_bf16 v[204:207],v[124:127],v[44:47],v[204:207]
ds_read_b128 v[124:127],v1 offset:6144
v_cvt_pk_bf16_f32 v26,v84,v85
v_mfma_f32_16x16x32_bf16 v[200:203],v[120:123],v[44:47],v[200:203]
s_waitcnt lgkmcnt(2)
ds_read_b128 v[120:123],v0 offset:6144
v_cvt_pk_bf16_f32 v27,v86,v87
v_mfma_f32_16x16x32_bf16 v[72:75],v[116:119],a[164:167],0
v_exp_f32 v92,v92
v_smfmac_f32_16x16x64_bf16 v[60:63],v[152:155],v[20:27],v18
buffer_load_dwordx4 v7,s[8:11],s21 offen offset:1024 lds
v_mfma_f32_16x16x32_bf16 v[72:75],v[112:115],a[160:163],v[72:75]
v_exp_f32 v93,v93
v_mfma_f32_16x16x32_bf16 v[72:75],v[140:143],a[156:159],v[72:75]
v_exp_f32 v94,v94
v_mfma_f32_16x16x32_bf16 v[72:75],v[136:139],a[152:155],v[72:75]
v_exp_f32 v95,v95
v_mfma_f32_16x16x32_bf16 v[72:75],v[132:135],a[148:151],v[72:75]
s_waitcnt lgkmcnt(1)
v_cvt_pk_bf16_f32 v30,v92,v93
v_cvt_pk_bf16_f32 v31,v94,v95
v_mfma_f32_16x16x32_bf16 v[72:75],v[128:131],a[144:147],v[72:75]
v_fma_f32 v101,v101,s36,v16
v_fma_f32 v102,v102,s36,v16
v_mfma_f32_16x16x32_bf16 v[80:83],v[128:131],a[168:171],0
v_fma_f32 v103,v103,s36,v16
v_mfma_f32_16x16x32_bf16 v[80:83],v[132:135],a[172:175],v[80:83]
v_exp_f32 v100,v100
v_mfma_f32_16x16x32_bf16 v[80:83],v[136:139],a[176:179],v[80:83]
buffer_load_dwordx4 v8,s[8:11],s21 offen offset:2048 lds
v_mfma_f32_16x16x32_bf16 v[80:83],v[140:143],a[180:183],v[80:83]
s_add_u32 s21,s21,12288
v_exp_f32 v101,v101
v_mfma_f32_16x16x32_bf16 v[80:83],v[112:115],a[184:187],v[80:83]
s_add_u32 m0,s22,24576
v_exp_f32 v102,v102
v_mfma_f32_16x16x32_bf16 v[80:83],v[116:119],a[188:191],v[80:83]
v_exp_f32 v103,v103
v_mfma_f32_16x16x32_bf16 v[88:91],v[116:119],a[212:215],0
v_cvt_pk_bf16_f32 v34,v100,v101
v_cvt_pk_bf16_f32 v35,v102,v103
v_mfma_f32_16x16x32_bf16 v[88:91],v[112:115],a[208:211],v[88:91]
v_fma_f32 v72,v72,s36,v13
v_fma_f32 v73,v73,s36,v13
v_smfmac_f32_16x16x64_bf16 v[64:67],v[152:155],v[28:35],v18
v_fma_f32 v74,v74,s36,v13
v_mfma_f32_16x16x32_bf16 v[88:91],v[140:143],a[204:207],v[88:91]
v_fma_f32 v75,v75,s36,v13
v_fma_f32 v80,v80,s36,v14
v_mfma_f32_16x16x32_bf16 v[88:91],v[136:139],a[200:203],v[88:91]
v_fma_f32 v81,v81,s36,v14
v_mfma_f32_16x16x32_bf16 v[88:91],v[132:135],a[196:199],v[88:91]
buffer_load_dwordx4 v6,s[4:7],s20 offen offset:0 lds
v_mfma_f32_16x16x32_bf16 v[88:91],v[128:131],a[192:195],v[88:91]
v_exp_f32 v72,v72
v_mfma_f32_16x16x32_bf16 v[96:99],v[128:131],a[216:219],0
ds_read_b128 v[128:131],v0 offset:6272
v_mfma_f32_16x16x32_bf16 v[96:99],v[132:135],a[220:223],v[96:99]
ds_read_b128 v[132:135],v1 offset:6272
v_mfma_f32_16x16x32_bf16 v[96:99],v[136:139],a[224:227],v[96:99]
ds_read_b128 v[136:139],v0 offset:6400
v_mfma_f32_16x16x32_bf16 v[96:99],v[140:143],a[228:231],v[96:99]
ds_read_b128 v[140:143],v1 offset:6400
v_mfma_f32_16x16x32_bf16 v[96:99],v[112:115],a[232:235],v[96:99]
v_exp_f32 v73,v73
v_mfma_f32_16x16x32_bf16 v[96:99],v[116:119],a[236:239],v[96:99]
s_waitcnt lgkmcnt(4)
v_exp_f32 v74,v74
v_mfma_f32_16x16x32_bf16 v[76:79],v[120:123],a[144:147],0
v_exp_f32 v75,v75
v_mfma_f32_16x16x32_bf16 v[76:79],v[124:127],a[148:151],v[76:79]
buffer_load_dwordx4 v7,s[4:7],s20 offen offset:1024 lds
s_waitcnt lgkmcnt(3)
v_mfma_f32_16x16x32_bf16 v[76:79],v[128:131],a[152:155],v[76:79]
s_waitcnt lgkmcnt(2)
v_exp_f32 v80,v80
v_mfma_f32_16x16x32_bf16 v[76:79],v[132:135],a[156:159],v[76:79]
s_waitcnt lgkmcnt(0)
v_exp_f32 v81,v81
v_mfma_f32_16x16x32_bf16 v[76:79],v[136:139],a[160:163],v[76:79]
v_cvt_pk_bf16_f32 v44,v72,v73
v_cvt_pk_bf16_f32 v45,v74,v75
v_mfma_f32_16x16x32_bf16 v[76:79],v[140:143],a[164:167],v[76:79]
v_cvt_pk_bf16_f32 v48,v80,v81
v_mfma_f32_16x16x32_bf16 v[84:87],v[140:143],a[188:191],0
v_mfma_f32_16x16x32_bf16 v[84:87],v[136:139],a[184:187],v[84:87]
v_mfma_f32_16x16x32_bf16 v[84:87],v[132:135],a[180:183],v[84:87]
v_mfma_f32_16x16x32_bf16 v[84:87],v[128:131],a[176:179],v[84:87]
v_mfma_f32_16x16x32_bf16 v[84:87],v[124:127],a[172:175],v[84:87]
buffer_load_dwordx4 v8,s[4:7],s20 offen offset:2048 lds
v_mfma_f32_16x16x32_bf16 v[84:87],v[120:123],a[168:171],v[84:87]
s_add_u32 s20,s20,12288
v_mfma_f32_16x16x32_bf16 v[92:95],v[120:123],a[192:195],0
ds_read_b64_tr_b16 v[112:113],v2 offset:24576
v_mfma_f32_16x16x32_bf16 v[92:95],v[124:127],a[196:199],v[92:95]
ds_read_b64_tr_b16 v[114:115],v2 offset:30720
v_mfma_f32_16x16x32_bf16 v[92:95],v[128:131],a[200:203],v[92:95]
ds_read_b64_tr_b16 v[116:117],v3 offset:24576
v_mfma_f32_16x16x32_bf16 v[92:95],v[132:135],a[204:207],v[92:95]
ds_read_b64_tr_b16 v[118:119],v3 offset:30720
v_mfma_f32_16x16x32_bf16 v[92:95],v[136:139],a[208:211],v[92:95]
v_mfma_f32_16x16x32_bf16 v[92:95],v[140:143],a[212:215],v[92:95]
v_mfma_f32_16x16x32_bf16 v[100:103],v[140:143],a[236:239],0
v_mfma_f32_16x16x32_bf16 v[100:103],v[136:139],a[232:235],v[100:103]
v_mfma_f32_16x16x32_bf16 v[100:103],v[132:135],a[228:231],v[100:103]
v_mfma_f32_16x16x32_bf16 v[100:103],v[128:131],a[224:227],v[100:103]
v_mfma_f32_16x16x32_bf16 v[100:103],v[124:127],a[220:223],v[100:103]
ds_read_b64_tr_b16 v[124:125],v5 offset:24576
v_mfma_f32_16x16x32_bf16 v[100:103],v[120:123],a[216:219],v[100:103]
ds_read_b64_tr_b16 v[120:121],v4 offset:24576
ds_read_b64_tr_b16 v[122:123],v4 offset:30720
ds_read_b64_tr_b16 v[126:127],v5 offset:30720
s_mov_b32 s38,0
s_branch L_loop4
L_tr55:
s_waitcnt vmcnt(42)
s_waitcnt lgkmcnt(3)
v_mfma_f32_16x16x32_bf16 v[160:163],v[112:115],v[20:23],v[160:163]
s_add_u32 m0,s24,0
ds_read_b128 a[144:147],v11 offset:0
v_fma_f32 v90,v90,s36,v15
v_mfma_f32_16x16x32_bf16 v[164:167],v[116:119],v[20:23],v[164:167]
ds_read_b128 a[148:151],v12 offset:0
v_fma_f32 v91,v91,s36,v15
v_mfma_f32_16x16x32_bf16 v[212:215],v[116:119],v[24:27],v[212:215]
ds_read_b128 a[152:155],v11 offset:128
v_fma_f32 v96,v96,s36,v16
v_mfma_f32_16x16x32_bf16 v[208:211],v[112:115],v[24:27],v[208:211]
ds_read_b128 a[156:159],v12 offset:128
v_fma_f32 v97,v97,s36,v16
v_mfma_f32_16x16x32_bf16 a[0:3],v[112:115],v[28:31],a[0:3]
ds_read_b128 a[160:163],v11 offset:256
v_fma_f32 v98,v98,s36,v16
v_mfma_f32_16x16x32_bf16 a[4:7],v[116:119],v[28:31],a[4:7]
ds_read_b128 a[164:167],v12 offset:256
v_fma_f32 v99,v99,s36,v16
ds_read_b64_tr_b16 v[128:129],v2 offset:24704
ds_read_b64_tr_b16 v[130:131],v2 offset:30848
ds_read_b64_tr_b16 v[132:133],v3 offset:24704
ds_read_b64_tr_b16 v[134:135],v3 offset:30848
ds_read_b64_tr_b16 v[136:137],v4 offset:24704
ds_read_b64_tr_b16 v[138:139],v4 offset:30848
ds_read_b64_tr_b16 v[140:141],v5 offset:24704
ds_read_b64_tr_b16 v[142:143],v5 offset:30848
ds_read_b128 a[168:171],v11 offset:6144
v_mfma_f32_16x16x32_bf16 a[52:55],v[116:119],v[32:35],a[52:55]
v_fma_f32 v104,v104,s36,v17
ds_read_b128 a[172:175],v12 offset:6144
v_mfma_f32_16x16x32_bf16 a[48:51],v[112:115],v[32:35],a[48:51]
v_fma_f32 v105,v105,s36,v17
ds_read_b128 a[176:179],v11 offset:6272
v_mfma_f32_16x16x32_bf16 a[96:99],v[112:115],v[36:39],a[96:99]
s_waitcnt lgkmcnt(11)
buffer_load_dwordx4 v6,s[12:15],s28 offen offset:0 nt lds
v_mfma_f32_16x16x32_bf16 a[100:103],v[116:119],v[36:39],a[100:103]
ds_read_b64_tr_b16 v[112:113],v2 offset:24832
ds_read_b128 a[180:183],v12 offset:6272
v_mfma_f32_16x16x32_bf16 a[104:107],v[120:123],v[36:39],a[104:107]
v_fma_f32 v106,v106,s36,v17
ds_read_b128 a[184:187],v11 offset:6400
v_mfma_f32_16x16x32_bf16 a[108:111],v[124:127],v[36:39],a[108:111]
v_fma_f32 v107,v107,s36,v17
ds_read_b128 a[188:191],v12 offset:6400
v_mfma_f32_16x16x32_bf16 a[60:63],v[124:127],v[32:35],a[60:63]
v_fma_f32 v76,v76,s36,v13
v_fma_f32 v77,v77,s36,v13
v_mfma_f32_16x16x32_bf16 a[56:59],v[120:123],v[32:35],a[56:59]
buffer_load_dwordx4 v7,s[12:15],s28 offen offset:1024 nt lds
v_mfma_f32_16x16x32_bf16 a[8:11],v[120:123],v[28:31],a[8:11]
ds_read_b64_tr_b16 v[114:115],v2 offset:30976
ds_read_b64_tr_b16 v[116:117],v3 offset:24832
ds_read_b64_tr_b16 v[118:119],v3 offset:30976
v_mfma_f32_16x16x32_bf16 a[12:15],v[124:127],v[28:31],a[12:15]
v_fma_f32 v78,v78,s36,v13
v_fma_f32 v79,v79,s36,v13
v_mfma_f32_16x16x32_bf16 v[220:223],v[124:127],v[24:27],v[220:223]
v_fma_f32 v84,v84,s36,v14
v_fma_f32 v85,v85,s36,v14
v_mfma_f32_16x16x32_bf16 v[216:219],v[120:123],v[24:27],v[216:219]
v_fma_f32 v86,v86,s36,v14
v_fma_f32 v87,v87,s36,v14
v_mfma_f32_16x16x32_bf16 v[168:171],v[120:123],v[20:23],v[168:171]
ds_read_b64_tr_b16 v[120:121],v4 offset:24832
v_fma_f32 v92,v92,s36,v15
v_mfma_f32_16x16x32_bf16 v[172:175],v[124:127],v[20:23],v[172:175]
s_waitcnt lgkmcnt(4)
ds_read_b64_tr_b16 v[122:123],v4 offset:30976
v_fma_f32 v93,v93,s36,v15
v_mfma_f32_16x16x32_bf16 v[176:179],v[128:131],v[20:23],v[176:179]
buffer_load_dwordx4 v8,s[12:15],s28 offen offset:2048 nt lds
v_mfma_f32_16x16x32_bf16 v[180:183],v[132:135],v[20:23],v[180:183]
s_add_u32 s28,s28,3072
ds_read_b64_tr_b16 v[124:125],v5 offset:24832
v_fma_f32 v94,v94,s36,v15
v_mfma_f32_16x16x32_bf16 v[228:231],v[132:135],v[24:27],v[228:231]
s_add_u32 m0,s24,3072
ds_read_b64_tr_b16 v[126:127],v5 offset:30976
v_fma_f32 v95,v95,s36,v15
v_mfma_f32_16x16x32_bf16 v[224:227],v[128:131],v[24:27],v[224:227]
v_fma_f32 v100,v100,s36,v16
v_fma_f32 v101,v101,s36,v16
v_mfma_f32_16x16x32_bf16 a[16:19],v[128:131],v[28:31],a[16:19]
v_fma_f32 v102,v102,s36,v16
v_fma_f32 v103,v103,s36,v16
v_mfma_f32_16x16x32_bf16 a[20:23],v[132:135],v[28:31],a[20:23]
v_fma_f32 v108,v108,s36,v17
v_fma_f32 v109,v109,s36,v17
v_mfma_f32_16x16x32_bf16 a[68:71],v[132:135],v[32:35],a[68:71]
v_fma_f32 v110,v110,s36,v17
v_fma_f32 v111,v111,s36,v17
v_mfma_f32_16x16x32_bf16 a[64:67],v[128:131],v[32:35],a[64:67]
v_exp_f32 v90,v90
v_mfma_f32_16x16x32_bf16 a[112:115],v[128:131],v[36:39],a[112:115]
buffer_load_dwordx4 v6,s[12:15],s28 offen offset:0 nt lds
v_mfma_f32_16x16x32_bf16 a[116:119],v[132:135],v[36:39],a[116:119]
v_exp_f32 v91,v91
v_mfma_f32_16x16x32_bf16 a[120:123],v[136:139],v[36:39],a[120:123]
v_exp_f32 v96,v96
v_mfma_f32_16x16x32_bf16 a[124:127],v[140:143],v[36:39],a[124:127]
v_exp_f32 v97,v97
v_mfma_f32_16x16x32_bf16 a[76:79],v[140:143],v[32:35],a[76:79]
v_exp_f32 v98,v98
v_mfma_f32_16x16x32_bf16 a[72:75],v[136:139],v[32:35],a[72:75]
v_exp_f32 v99,v99
v_mfma_f32_16x16x32_bf16 a[24:27],v[136:139],v[28:31],a[24:27]
v_exp_f32 v104,v104
v_mfma_f32_16x16x32_bf16 a[28:31],v[140:143],v[28:31],a[28:31]
v_exp_f32 v105,v105
v_mfma_f32_16x16x32_bf16 v[236:239],v[140:143],v[24:27],v[236:239]
buffer_load_dwordx4 v7,s[12:15],s28 offen offset:1024 nt lds
v_mfma_f32_16x16x32_bf16 v[232:235],v[136:139],v[24:27],v[232:235]
v_exp_f32 v106,v106
v_mfma_f32_16x16x32_bf16 v[184:187],v[136:139],v[20:23],v[184:187]
v_exp_f32 v107,v107
v_mfma_f32_16x16x32_bf16 v[188:191],v[140:143],v[20:23],v[188:191]
s_waitcnt lgkmcnt(0)
v_exp_f32 v76,v76
v_mfma_f32_16x16x32_bf16 v[192:195],v[112:115],v[20:23],v[192:195]
v_exp_f32 v77,v77
v_mfma_f32_16x16x32_bf16 v[196:199],v[116:119],v[20:23],v[196:199]
v_exp_f32 v78,v78
v_mfma_f32_16x16x32_bf16 v[244:247],v[116:119],v[24:27],v[244:247]
v_exp_f32 v79,v79
v_mfma_f32_16x16x32_bf16 v[240:243],v[112:115],v[24:27],v[240:243]
v_exp_f32 v84,v84
v_mfma_f32_16x16x32_bf16 a[32:35],v[112:115],v[28:31],a[32:35]
buffer_load_dwordx4 v8,s[12:15],s28 offen offset:2048 nt lds
s_waitcnt vmcnt(20)
s_barrier
v_mfma_f32_16x16x32_bf16 a[36:39],v[116:119],v[28:31],a[36:39]
s_add_u32 s28,s28,3072
v_exp_f32 v85,v85
v_mfma_f32_16x16x32_bf16 a[84:87],v[116:119],v[32:35],a[84:87]
s_add_u32 m0,s22,0
v_exp_f32 v86,v86
v_mfma_f32_16x16x32_bf16 a[80:83],v[112:115],v[32:35],a[80:83]
buffer_load_dwordx4 v6,s[4:7],s25 offen offset:0 lds
v_mfma_f32_16x16x32_bf16 a[128:131],v[112:115],v[36:39],a[128:131]
buffer_load_dwordx4 v7,s[4:7],s25 offen offset:1024 lds
v_mfma_f32_16x16x32_bf16 a[132:135],v[116:119],v[36:39],a[132:135]
buffer_load_dwordx4 v8,s[4:7],s25 offen offset:2048 lds
v_mfma_f32_16x16x32_bf16 a[136:139],v[120:123],v[36:39],a[136:139]
v_exp_f32 v87,v87
v_mfma_f32_16x16x32_bf16 a[140:143],v[124:127],v[36:39],a[140:143]
v_exp_f32 v92,v92
v_mfma_f32_16x16x32_bf16 a[92:95],v[124:127],v[32:35],a[92:95]
v_exp_f32 v93,v93
v_mfma_f32_16x16x32_bf16 a[88:91],v[120:123],v[32:35],a[88:91]
v_exp_f32 v94,v94
v_mfma_f32_16x16x32_bf16 a[40:43],v[120:123],v[28:31],a[40:43]
ds_read_b64_tr_b16 v[128:129],v2 offset:0
v_exp_f32 v95,v95
v_mfma_f32_16x16x32_bf16 a[44:47],v[124:127],v[28:31],a[44:47]
ds_read_b64_tr_b16 v[130:131],v2 offset:6144
v_exp_f32 v100,v100
v_mfma_f32_16x16x32_bf16 v[252:255],v[124:127],v[24:27],v[252:255]
ds_read_b64_tr_b16 v[132:133],v3 offset:0
v_exp_f32 v101,v101
v_mfma_f32_16x16x32_bf16 v[248:251],v[120:123],v[24:27],v[248:251]
ds_read_b64_tr_b16 v[134:135],v3 offset:6144
v_exp_f32 v102,v102
v_mfma_f32_16x16x32_bf16 v[200:203],v[120:123],v[20:23],v[200:203]
ds_read_b64_tr_b16 v[136:137],v4 offset:0
v_exp_f32 v103,v103
v_mfma_f32_16x16x32_bf16 v[204:207],v[124:127],v[20:23],v[204:207]
ds_read_b64_tr_b16 v[138:139],v4 offset:6144
ds_read_b64_tr_b16 v[140:141],v5 offset:0
ds_read_b64_tr_b16 v[142:143],v5 offset:6144
v_exp_f32 v108,v108
v_exp_f32 v109,v109
v_exp_f32 v110,v110
v_exp_f32 v111,v111
v_cvt_pk_bf16_f32 v53,v90,v91
v_cvt_pk_bf16_f32 v56,v96,v97
v_cvt_pk_bf16_f32 v57,v98,v99
v_cvt_pk_bf16_f32 v40,v104,v105
v_cvt_pk_bf16_f32 v41,v106,v107
v_cvt_pk_bf16_f32 v46,v76,v77
v_cvt_pk_bf16_f32 v47,v78,v79
v_cvt_pk_bf16_f32 v50,v84,v85
v_cvt_pk_bf16_f32 v51,v86,v87
v_cvt_pk_bf16_f32 v54,v92,v93
v_cvt_pk_bf16_f32 v55,v94,v95
v_smfmac_f32_16x16x64_bf16 v[60:63],v[152:155],v[44:51],v18
v_cvt_pk_bf16_f32 v58,v100,v101
v_cvt_pk_bf16_f32 v59,v102,v103
v_cvt_pk_bf16_f32 v42,v108,v109
v_cvt_pk_bf16_f32 v43,v110,v111
v_smfmac_f32_16x16x64_bf16 v[64:67],v[152:155],v[52:59],v18
v_subrev_u32 v10,18432,v10
v_smfmac_f32_16x16x64_bf16 v[68:71],v[152:155],v[36:43],v18
s_waitcnt lgkmcnt(0)
v_mfma_f32_16x16x32_bf16 v[160:163],v[128:131],v[44:47],v[160:163]
s_add_u32 s87,s42,18432
ds_read_b64_tr_b16 v[112:113],v2 offset:128
v_mbcnt_lo_u32_b32 v39,-1,0
v_mfma_f32_16x16x32_bf16 v[164:167],v[132:135],v[44:47],v[164:167]
s_add_u32 s66,s42,24576
ds_read_b64_tr_b16 v[114:115],v2 offset:6272
v_mbcnt_hi_u32_b32 v39,-1,v39
v_mfma_f32_16x16x32_bf16 v[212:215],v[132:135],v[48:51],v[212:215]
ds_read_b64_tr_b16 v[116:117],v3 offset:128
v_and_b32 v38,7,v39
v_mfma_f32_16x16x32_bf16 v[208:211],v[128:131],v[48:51],v[208:211]
ds_read_b64_tr_b16 v[118:119],v3 offset:6272
v_add_f32 v68,v68,v69
v_mfma_f32_16x16x32_bf16 a[0:3],v[128:131],v[52:55],a[0:3]
ds_read_b64_tr_b16 v[120:121],v4 offset:128
v_add_f32 v60,v60,v61
v_mfma_f32_16x16x32_bf16 a[4:7],v[132:135],v[52:55],a[4:7]
ds_read_b64_tr_b16 v[122:123],v4 offset:6272
ds_read_b64_tr_b16 v[124:125],v5 offset:128
ds_read_b64_tr_b16 v[126:127],v5 offset:6272
v_mfma_f32_16x16x32_bf16 a[52:55],v[132:135],v[56:59],a[52:55]
v_add_f32 v62,v62,v63
v_add_f32 v64,v64,v65
v_mfma_f32_16x16x32_bf16 a[48:51],v[128:131],v[56:59],a[48:51]
v_add_f32 v68,v68,v70
v_add_f32 v66,v66,v67
v_mfma_f32_16x16x32_bf16 a[96:99],v[128:131],v[40:43],a[96:99]
ds_read_b64_tr_b16 v[128:129],v2 offset:256
v_max3_f32 v19,v60,v62,v64
v_mfma_f32_16x16x32_bf16 a[100:103],v[132:135],v[40:43],a[100:103]
ds_read_b64_tr_b16 v[130:131],v2 offset:6400
v_add_f32 v68,v68,v71
v_mfma_f32_16x16x32_bf16 a[104:107],v[136:139],v[40:43],a[104:107]
ds_read_b64_tr_b16 v[132:133],v3 offset:256
v_max3_f32 v19,v19,v66,v68
v_mfma_f32_16x16x32_bf16 a[108:111],v[140:143],v[40:43],a[108:111]
ds_read_b64_tr_b16 v[134:135],v3 offset:6400
v_rcp_f32 v66,v66
v_rcp_f32 v68,v68
v_accvgpr_read_b32 v72,a48
v_accvgpr_read_b32 v73,a49
v_pk_mul_f32 v[72:73],v[72:73],v[66:67] op_sel_hi:[1,0]
v_accvgpr_read_b32 v74,a50
v_accvgpr_read_b32 v75,a51
v_pk_mul_f32 v[74:75],v[74:75],v[66:67] op_sel_hi:[1,0]
v_accvgpr_read_b32 v76,a96
v_accvgpr_read_b32 v77,a97
v_pk_mul_f32 v[76:77],v[76:77],v[68:69] op_sel_hi:[1,0]
v_accvgpr_read_b32 v78,a98
v_accvgpr_read_b32 v79,a99
v_pk_mul_f32 v[78:79],v[78:79],v[68:69] op_sel_hi:[1,0]
v_accvgpr_read_b32 v80,a52
v_accvgpr_read_b32 v81,a53
v_mfma_f32_16x16x32_bf16 a[60:63],v[140:143],v[56:59],a[60:63]
v_accvgpr_read_b32 v82,a54
v_accvgpr_read_b32 v83,a55
v_accvgpr_read_b32 v84,a100
v_accvgpr_read_b32 v85,a101
v_accvgpr_read_b32 v86,a102
v_pk_mul_f32 v[80:81],v[80:81],v[66:67] op_sel_hi:[1,0]
v_pk_mul_f32 v[82:83],v[82:83],v[66:67] op_sel_hi:[1,0]
v_pk_mul_f32 v[84:85],v[84:85],v[68:69] op_sel_hi:[1,0]
v_accvgpr_read_b32 v87,a103
v_pk_mul_f32 v[86:87],v[86:87],v[68:69] op_sel_hi:[1,0]
v_accvgpr_read_b32 v92,a104
v_accvgpr_read_b32 v93,a105
v_mfma_f32_16x16x32_bf16 a[56:59],v[136:139],v[56:59],a[56:59]
v_accvgpr_read_b32 v94,a106
v_accvgpr_read_b32 v95,a107
v_mfma_f32_16x16x32_bf16 a[8:11],v[136:139],v[52:55],a[8:11]
v_accvgpr_read_b32 v100,a108
v_accvgpr_read_b32 v101,a109
v_mfma_f32_16x16x32_bf16 a[12:15],v[140:143],v[52:55],a[12:15]
v_accvgpr_read_b32 v102,a110
v_accvgpr_read_b32 v103,a111
v_mfma_f32_16x16x32_bf16 v[220:223],v[140:143],v[48:51],v[220:223]
v_accvgpr_read_b32 v88,a56
v_accvgpr_read_b32 v89,a57
v_accvgpr_read_b32 v90,a58
v_accvgpr_read_b32 v91,a59
v_accvgpr_read_b32 v96,a60
v_pk_mul_f32 v[92:93],v[92:93],v[68:69] op_sel_hi:[1,0]
v_pk_mul_f32 v[94:95],v[94:95],v[68:69] op_sel_hi:[1,0]
v_pk_mul_f32 v[88:89],v[88:89],v[66:67] op_sel_hi:[1,0]
v_pk_mul_f32 v[90:91],v[90:91],v[66:67] op_sel_hi:[1,0]
v_accvgpr_read_b32 v97,a61
v_accvgpr_read_b32 v98,a62
v_mfma_f32_16x16x32_bf16 v[216:219],v[136:139],v[48:51],v[216:219]
v_accvgpr_read_b32 v99,a63
v_cmp_ngt_f32 vcc,s37,v19
v_mfma_f32_16x16x32_bf16 v[168:171],v[136:139],v[44:47],v[168:171]
ds_read_b64_tr_b16 v[136:137],v4 offset:256
ds_read_b64_tr_b16 v[138:139],v4 offset:6400
v_lshrrev_b32 v19,5,v39
v_xor_b32 v38,v38,v19
v_pk_mul_f32 v[96:97],v[96:97],v[66:67] op_sel_hi:[1,0]
v_pk_mul_f32 v[98:99],v[98:99],v[66:67] op_sel_hi:[1,0]
v_pk_mul_f32 v[100:101],v[100:101],v[68:69] op_sel_hi:[1,0]
v_pk_mul_f32 v[102:103],v[102:103],v[68:69] op_sel_hi:[1,0]
v_and_b32 v19,15,v39
v_lshl_add_u32 v19,v19,7,s24
v_mfma_f32_16x16x32_bf16 v[172:175],v[140:143],v[44:47],v[172:175]
s_cmp_lg_u64 vcc,0
ds_read_b64_tr_b16 v[140:141],v5 offset:256
v_lshl_add_u32 v19,v38,4,v19
s_waitcnt lgkmcnt(3)
v_mfma_f32_16x16x32_bf16 v[176:179],v[112:115],v[44:47],v[176:179]
s_cselect_b32 s62,s32,0
ds_read_b64_tr_b16 v[142:143],v5 offset:6400
v_bfe_u32 v38,v39,4,1
v_mfma_f32_16x16x32_bf16 v[180:183],v[116:119],v[44:47],v[180:183]
s_or_b32 s31,s31,s62
v_lshl_add_u32 v36,v38,3,v19
v_xor_b32 v37,32,v36
v_mfma_f32_16x16x32_bf16 v[228:231],v[116:119],v[48:51],v[228:231]
s_lshl_b32 s32,s32,1
v_xor_b32 v38,64,v36
v_bfe_u32 v19,v39,3,1
v_mfma_f32_16x16x32_bf16 v[224:227],v[112:115],v[48:51],v[224:227]
s_add_u32 m0,s24,6144
v_xor_b32 v39,96,v36
v_lshlrev_b32 v19,11,v19
v_mfma_f32_16x16x32_bf16 a[16:19],v[112:115],v[52:55],a[16:19]
buffer_load_dwordx4 v6,s[12:15],s28 offen offset:0 nt lds
v_mfma_f32_16x16x32_bf16 a[20:23],v[116:119],v[52:55],a[20:23]
buffer_load_dwordx4 v7,s[12:15],s28 offen offset:1024 nt lds
v_mfma_f32_16x16x32_bf16 a[68:71],v[116:119],v[56:59],a[68:71]
buffer_load_dwordx4 v8,s[12:15],s28 offen offset:2048 nt lds
v_mfma_f32_16x16x32_bf16 a[64:67],v[112:115],v[56:59],a[64:67]
s_add_u32 s28,s28,3072
v_cvt_pk_bf16_f32 v72,v72,v73
v_cvt_pk_bf16_f32 v76,v76,v77
v_mfma_f32_16x16x32_bf16 a[112:115],v[112:115],v[40:43],a[112:115]
s_add_u32 m0,s24,9216
v_cvt_pk_bf16_f32 v80,v80,v81
v_cvt_pk_bf16_f32 v84,v84,v85
v_mfma_f32_16x16x32_bf16 a[116:119],v[116:119],v[40:43],a[116:119]
buffer_load_dwordx4 v6,s[12:15],s28 offen offset:0 nt lds
v_mfma_f32_16x16x32_bf16 a[120:123],v[120:123],v[40:43],a[120:123]
buffer_load_dwordx4 v7,s[12:15],s28 offen offset:1024 nt lds
v_mfma_f32_16x16x32_bf16 a[124:127],v[124:127],v[40:43],a[124:127]
buffer_load_dwordx4 v8,s[12:15],s28 offen offset:2048 nt lds
v_cvt_pk_bf16_f32 v73,v74,v75
v_cvt_pk_bf16_f32 v77,v78,v79
ds_write2st64_b64 v36,v[72:73],v[76:77] offset0:36 offset1:40
v_cvt_pk_bf16_f32 v81,v82,v83
v_cvt_pk_bf16_f32 v85,v86,v87
v_accvgpr_read_b32 v78,a66
v_accvgpr_read_b32 v79,a67
v_pk_mul_f32 v[78:79],v[78:79],v[66:67] op_sel_hi:[1,0]
v_accvgpr_read_b32 v76,a64
v_accvgpr_read_b32 v77,a65
v_pk_mul_f32 v[76:77],v[76:77],v[66:67] op_sel_hi:[1,0]
v_accvgpr_read_b32 v82,a114
v_accvgpr_read_b32 v83,a115
v_pk_mul_f32 v[82:83],v[82:83],v[68:69] op_sel_hi:[1,0]
ds_write2st64_b64 v37,v[80:81],v[84:85] offset0:36 offset1:40
v_accvgpr_read_b32 v80,a112
v_accvgpr_read_b32 v81,a113
v_pk_mul_f32 v[80:81],v[80:81],v[68:69] op_sel_hi:[1,0]
v_cvt_pk_bf16_f32 v92,v92,v93
v_cvt_pk_bf16_f32 v88,v88,v89
v_mfma_f32_16x16x32_bf16 a[76:79],v[124:127],v[56:59],a[76:79]
s_add_u32 s28,s28,3072
v_cvt_pk_bf16_f32 v93,v94,v95
v_cvt_pk_bf16_f32 v89,v90,v91
v_accvgpr_read_b32 v86,a70
v_accvgpr_read_b32 v87,a71
ds_write2st64_b64 v38,v[88:89],v[92:93] offset0:36 offset1:40
v_pk_mul_f32 v[86:87],v[86:87],v[66:67] op_sel_hi:[1,0]
v_accvgpr_read_b32 v84,a68
v_accvgpr_read_b32 v85,a69
v_pk_mul_f32 v[84:85],v[84:85],v[66:67] op_sel_hi:[1,0]
v_accvgpr_read_b32 v90,a118
v_accvgpr_read_b32 v91,a119
v_pk_mul_f32 v[90:91],v[90:91],v[68:69] op_sel_hi:[1,0]
v_accvgpr_read_b32 v88,a116
v_accvgpr_read_b32 v89,a117
v_pk_mul_f32 v[88:89],v[88:89],v[68:69] op_sel_hi:[1,0]
v_cvt_pk_bf16_f32 v96,v96,v97
v_cvt_pk_bf16_f32 v100,v100,v101
v_mfma_f32_16x16x32_bf16 a[72:75],v[120:123],v[56:59],a[72:75]
s_waitcnt vmcnt(21)
ds_read_b128 a[192:195],v11 offset:12288
v_cvt_pk_bf16_f32 v97,v98,v99
v_mfma_f32_16x16x32_bf16 a[24:27],v[120:123],v[52:55],a[24:27]
s_add_u32 m0,s23,0
ds_read_b128 a[196:199],v12 offset:12288
v_cvt_pk_bf16_f32 v101,v102,v103
v_mfma_f32_16x16x32_bf16 a[28:31],v[124:127],v[52:55],a[28:31]
ds_read_b128 a[200:203],v11 offset:12416
v_cvt_pk_bf16_f32 v76,v76,v77
v_mfma_f32_16x16x32_bf16 v[236:239],v[124:127],v[48:51],v[236:239]
ds_read_b128 a[204:207],v12 offset:12416
v_cvt_pk_bf16_f32 v80,v80,v81
ds_read_b128 a[208:211],v11 offset:12544
v_cvt_pk_bf16_f32 v77,v78,v79
ds_read_b128 a[212:215],v12 offset:12544
v_cvt_pk_bf16_f32 v81,v82,v83
ds_write2st64_b64 v39,v[96:97],v[100:101] offset0:36 offset1:40
v_accvgpr_read_b32 v92,a72
v_accvgpr_read_b32 v93,a73
v_pk_mul_f32 v[92:93],v[92:93],v[66:67] op_sel_hi:[1,0]
ds_read_b128 v[156:159],v10 offset:18432
v_accvgpr_read_b32 v94,a74
ds_read_b128 v[104:107],v10 offset:19456
v_accvgpr_read_b32 v95,a75
ds_read_b128 v[108:111],v10 offset:20480
v_pk_mul_f32 v[94:95],v[94:95],v[66:67] op_sel_hi:[1,0]
ds_read_b128 v[72:75],v10 offset:21504
v_accvgpr_read_b32 v98,a122
ds_write2st64_b64 v36,v[76:77],v[80:81] offset0:36 offset1:40
v_accvgpr_read_b32 v99,a123
v_pk_mul_f32 v[98:99],v[98:99],v[68:69] op_sel_hi:[1,0]
v_accvgpr_read_b32 v102,a78
v_accvgpr_read_b32 v103,a79
v_pk_mul_f32 v[102:103],v[102:103],v[66:67] op_sel_hi:[1,0]
v_accvgpr_read_b32 v78,a126
v_accvgpr_read_b32 v79,a127
s_waitcnt lgkmcnt(4)
buffer_store_dwordx4 v[156:159],v9,s[16:19],s87 offen offset:0 nt
v_pk_mul_f32 v[78:79],v[78:79],v[68:69] op_sel_hi:[1,0]
v_accvgpr_read_b32 v96,a120
v_accvgpr_read_b32 v97,a121
v_pk_mul_f32 v[96:97],v[96:97],v[68:69] op_sel_hi:[1,0]
v_accvgpr_read_b32 v100,a76
v_accvgpr_read_b32 v101,a77
v_pk_mul_f32 v[100:101],v[100:101],v[66:67] op_sel_hi:[1,0]
v_accvgpr_read_b32 v76,a124
v_accvgpr_read_b32 v77,a125
v_pk_mul_f32 v[76:77],v[76:77],v[68:69] op_sel_hi:[1,0]
v_cvt_pk_bf16_f32 v84,v84,v85
v_cvt_pk_bf16_f32 v88,v88,v89
v_mfma_f32_16x16x32_bf16 v[232:235],v[120:123],v[48:51],v[232:235]
s_waitcnt lgkmcnt(0)
buffer_store_dwordx4 v[104:107],v9,s[16:19],s87 offen offset:3072 nt
v_cvt_pk_bf16_f32 v92,v92,v93
v_cvt_pk_bf16_f32 v96,v96,v97
s_waitcnt vmcnt(8)
s_barrier
v_mfma_f32_16x16x32_bf16 v[184:187],v[120:123],v[44:47],v[184:187]
ds_read_b128 v[112:115],v0 offset:0
v_cvt_pk_bf16_f32 v85,v86,v87
v_mfma_f32_16x16x32_bf16 v[188:191],v[124:127],v[44:47],v[188:191]
buffer_store_dwordx4 v[108:111],v9,s[16:19],s66 offen offset:0 nt
ds_read_b128 v[116:119],v1 offset:0
v_cvt_pk_bf16_f32 v89,v90,v91
v_cvt_pk_bf16_f32 v100,v100,v101
v_mfma_f32_16x16x32_bf16 v[192:195],v[128:131],v[44:47],v[192:195]
ds_read_b128 v[120:123],v0 offset:128
v_cvt_pk_bf16_f32 v76,v76,v77
v_mfma_f32_16x16x32_bf16 v[196:199],v[132:135],v[44:47],v[196:199]
ds_read_b128 v[124:127],v1 offset:128
v_cvt_pk_bf16_f32 v93,v94,v95
v_mfma_f32_16x16x32_bf16 v[244:247],v[132:135],v[48:51],v[244:247]
buffer_load_dwordx4 v6,s[8:11],s25 offen offset:0 lds
v_mfma_f32_16x16x32_bf16 v[240:243],v[128:131],v[48:51],v[240:243]
ds_write2st64_b64 v37,v[84:85],v[88:89] offset0:36 offset1:40
v_mfma_f32_16x16x32_bf16 a[32:35],v[128:131],v[52:55],a[32:35]
v_cvt_pk_bf16_f32 v97,v98,v99
v_cvt_pk_bf16_f32 v101,v102,v103
v_mfma_f32_16x16x32_bf16 a[36:39],v[132:135],v[52:55],a[36:39]
buffer_store_dwordx4 v[72:75],v9,s[16:19],s66 offen offset:3072 nt
v_cvt_pk_bf16_f32 v77,v78,v79
v_rcp_f32 v64,v64
v_mfma_f32_16x16x32_bf16 a[84:87],v[132:135],v[56:59],a[84:87]
v_rcp_f32 v60,v60
v_mfma_f32_16x16x32_bf16 a[80:83],v[128:131],v[56:59],a[80:83]
v_rcp_f32 v62,v62
v_mfma_f32_16x16x32_bf16 a[128:131],v[128:131],v[40:43],a[128:131]
ds_write2st64_b64 v38,v[92:93],v[96:97] offset0:36 offset1:40
v_mfma_f32_16x16x32_bf16 a[132:135],v[132:135],v[40:43],a[132:135]
v_mov_b32 v70,0
v_mov_b32 v71,0
v_mfma_f32_16x16x32_bf16 a[136:139],v[136:139],v[40:43],a[136:139]
buffer_load_dwordx4 v7,s[8:11],s25 offen offset:1024 lds
v_mfma_f32_16x16x32_bf16 a[140:143],v[140:143],v[40:43],a[140:143]
ds_read_b128 v[128:131],v0 offset:256
v_accvgpr_read_b32 v88,a80
ds_write2st64_b64 v39,v[100:101],v[76:77] offset0:36 offset1:40
v_accvgpr_read_b32 v89,a81
v_pk_mul_f32 v[88:89],v[88:89],v[66:67] op_sel_hi:[1,0]
v_accvgpr_read_b32 v90,a82
ds_read_b128 v[80:83],v10 offset:18432
v_accvgpr_read_b32 v91,a83
ds_read_b128 v[156:159],v10 offset:19456
buffer_load_dwordx4 v8,s[8:11],s25 offen offset:2048 lds
ds_read_b128 v[72:75],v10 offset:20480
v_pk_mul_f32 v[90:91],v[90:91],v[66:67] op_sel_hi:[1,0]
ds_read_b128 v[84:87],v10 offset:21504
v_accvgpr_read_b32 v104,a128
ds_read_b128 v[132:135],v1 offset:256
v_accvgpr_read_b32 v105,a129
v_pk_mul_f32 v[104:105],v[104:105],v[68:69] op_sel_hi:[1,0]
v_accvgpr_read_b32 v106,a130
v_accvgpr_read_b32 v107,a131
v_pk_mul_f32 v[106:107],v[106:107],v[68:69] op_sel_hi:[1,0]
v_accvgpr_read_b32 v108,a84
v_accvgpr_read_b32 v109,a85
v_mfma_f32_16x16x32_bf16 a[92:95],v[140:143],v[56:59],a[92:95]
s_add_u32 m0,s23,24576
v_accvgpr_read_b32 v110,a86
v_accvgpr_read_b32 v111,a87
s_waitcnt lgkmcnt(4)
buffer_store_dwordx4 v[80:83],v9,s[16:19],s87 offen offset:128 nt
v_pk_mul_f32 v[108:109],v[108:109],v[66:67] op_sel_hi:[1,0]
v_pk_mul_f32 v[110:111],v[110:111],v[66:67] op_sel_hi:[1,0]
v_accvgpr_read_b32 v92,a132
v_accvgpr_read_b32 v93,a133
v_pk_mul_f32 v[92:93],v[92:93],v[68:69] op_sel_hi:[1,0]
v_accvgpr_read_b32 v94,a134
v_accvgpr_read_b32 v95,a135
v_pk_mul_f32 v[94:95],v[94:95],v[68:69] op_sel_hi:[1,0]
v_accvgpr_read_b32 v76,a136
v_accvgpr_read_b32 v77,a137
v_mfma_f32_16x16x32_bf16 a[88:91],v[136:139],v[56:59],a[88:91]
s_waitcnt vmcnt(17)
buffer_load_dwordx4 v6,s[8:11],s21 offen offset:0 lds
v_mfma_f32_16x16x32_bf16 a[40:43],v[136:139],v[52:55],a[40:43]
s_waitcnt lgkmcnt(0)
ds_read_b128 a[216:219],v11 offset:0
buffer_store_dwordx4 v[156:159],v9,s[16:19],s87 offen offset:3200 nt
v_cvt_pk_bf16_f32 v88,v88,v89
v_cvt_pk_bf16_f32 v104,v104,v105
v_accvgpr_read_b32 v78,a138
v_mfma_f32_16x16x32_bf16 a[44:47],v[140:143],v[52:55],a[44:47]
ds_read_b128 a[220:223],v12 offset:0
v_accvgpr_read_b32 v96,a88
v_mfma_f32_16x16x32_bf16 v[252:255],v[140:143],v[48:51],v[252:255]
ds_read_b128 a[224:227],v11 offset:128
v_accvgpr_read_b32 v97,a89
ds_read_b128 a[228:231],v12 offset:128
buffer_store_dwordx4 v[72:75],v9,s[16:19],s66 offen offset:128 nt
ds_read_b128 a[232:235],v11 offset:256
v_pk_mul_f32 v[76:77],v[76:77],v[68:69] op_sel_hi:[1,0]
ds_read_b128 a[236:239],v12 offset:256
v_pk_mul_f32 v[96:97],v[96:97],v[66:67] op_sel_hi:[1,0]
v_accvgpr_read_b32 v79,a139
v_pk_mul_f32 v[78:79],v[78:79],v[68:69] op_sel_hi:[1,0]
v_cvt_pk_bf16_f32 v108,v108,v109
v_cvt_pk_bf16_f32 v92,v92,v93
buffer_store_dwordx4 v[84:87],v9,s[16:19],s66 offen offset:3200 nt
v_accvgpr_read_b32 v98,a90
v_accvgpr_read_b32 v99,a91
v_pk_mul_f32 v[98:99],v[98:99],v[66:67] op_sel_hi:[1,0]
v_cvt_pk_bf16_f32 v89,v90,v91
v_cvt_pk_bf16_f32 v105,v106,v107
v_cvt_pk_bf16_f32 v76,v76,v77
v_cvt_pk_bf16_f32 v96,v96,v97
v_cvt_pk_bf16_f32 v109,v110,v111
v_cvt_pk_bf16_f32 v93,v94,v95
buffer_load_dwordx4 v7,s[8:11],s21 offen offset:1024 lds
ds_write2st64_b64 v36,v[88:89],v[104:105] offset0:36 offset1:40
v_add_u32 v36,v36,v19
v_cvt_pk_bf16_f32 v77,v78,v79
v_cvt_pk_bf16_f32 v97,v98,v99
v_accvgpr_read_b32 v100,a92
v_accvgpr_read_b32 v101,a93
v_pk_mul_f32 v[100:101],v[100:101],v[66:67] op_sel_hi:[1,0]
v_accvgpr_read_b32 v102,a94
v_accvgpr_read_b32 v103,a95
v_pk_mul_f32 v[102:103],v[102:103],v[66:67] op_sel_hi:[1,0]
v_accvgpr_read_b32 v72,a0
v_accvgpr_read_b32 v73,a1
ds_write2st64_b64 v37,v[108:109],v[92:93] offset0:36 offset1:40
v_pk_mul_f32 v[72:73],v[72:73],v[64:65] op_sel_hi:[1,0]
v_add_u32 v37,v37,v19
v_accvgpr_read_b32 v74,a2
v_accvgpr_read_b32 v75,a3
v_pk_mul_f32 v[74:75],v[74:75],v[64:65] op_sel_hi:[1,0]
v_accvgpr_read_b32 v90,a142
v_accvgpr_read_b32 v91,a143
v_pk_mul_f32 v[90:91],v[90:91],v[68:69] op_sel_hi:[1,0]
v_accvgpr_read_b32 v110,a6
v_accvgpr_read_b32 v111,a7
v_pk_mul_f32 v[110:111],v[110:111],v[64:65] op_sel_hi:[1,0]
ds_write2st64_b64 v38,v[96:97],v[76:77] offset0:36 offset1:40
v_add_u32 v38,v38,v19
v_accvgpr_read_b32 v94,a18
v_accvgpr_read_b32 v95,a19
buffer_load_dwordx4 v8,s[8:11],s21 offen offset:2048 lds
v_pk_mul_f32 v[94:95],v[94:95],v[64:65] op_sel_hi:[1,0]
v_accvgpr_read_b32 v88,a140
v_accvgpr_read_b32 v89,a141
v_pk_mul_f32 v[88:89],v[88:89],v[68:69] op_sel_hi:[1,0]
v_accvgpr_read_b32 v78,a22
v_accvgpr_read_b32 v79,a23
v_pk_mul_f32 v[78:79],v[78:79],v[64:65] op_sel_hi:[1,0]
v_accvgpr_read_b32 v92,a16
v_accvgpr_read_b32 v93,a17
v_pk_mul_f32 v[92:93],v[92:93],v[64:65] op_sel_hi:[1,0]
v_accvgpr_read_b32 v108,a4
v_accvgpr_read_b32 v109,a5
v_pk_mul_f32 v[108:109],v[108:109],v[64:65] op_sel_hi:[1,0]
v_accvgpr_read_b32 v76,a20
v_accvgpr_read_b32 v77,a21
v_pk_mul_f32 v[76:77],v[76:77],v[64:65] op_sel_hi:[1,0]
v_cvt_pk_bf16_f32 v100,v100,v101
v_cvt_pk_bf16_f32 v88,v88,v89
v_mfma_f32_16x16x32_bf16 v[248:251],v[136:139],v[48:51],v[248:251]
s_waitcnt vmcnt(14)
ds_read_b128 a[240:243],v11 offset:6144
v_cvt_pk_bf16_f32 v101,v102,v103
v_mfma_f32_16x16x32_bf16 v[200:203],v[136:139],v[44:47],v[200:203]
s_add_u32 s21,s21,12288
ds_read_b128 a[244:247],v12 offset:6144
v_cvt_pk_bf16_f32 v89,v90,v91
ds_read_b128 a[248:251],v11 offset:6272
v_accvgpr_read_b32 v98,a10
ds_read_b128 a[252:255],v12 offset:6272
v_accvgpr_read_b32 v99,a11
ds_read_b128 v[144:147],v11 offset:6400
v_pk_mul_f32 v[98:99],v[98:99],v[64:65] op_sel_hi:[1,0]
ds_read_b128 v[148:151],v12 offset:6400
v_accvgpr_read_b32 v96,a8
ds_write2st64_b64 v39,v[100:101],v[88:89] offset0:36 offset1:40
v_add_u32 v39,v39,v19
v_accvgpr_read_b32 v97,a9
v_pk_mul_f32 v[96:97],v[96:97],v[64:65] op_sel_hi:[1,0]
ds_read_b128 v[104:107],v10 offset:18432
v_accvgpr_read_b32 v90,a26
ds_read_b128 v[156:159],v10 offset:19456
v_accvgpr_read_b32 v91,a27
ds_read_b128 v[80:83],v10 offset:20480
v_pk_mul_f32 v[90:91],v[90:91],v[64:65] op_sel_hi:[1,0]
ds_read_b128 v[84:87],v10 offset:21504
v_accvgpr_read_b32 v88,a24
ds_read_b128 v[136:139],v0 offset:6144
v_accvgpr_read_b32 v89,a25
v_pk_mul_f32 v[88:89],v[88:89],v[64:65] op_sel_hi:[1,0]
v_cvt_pk_bf16_f32 v72,v72,v73
v_cvt_pk_bf16_f32 v92,v92,v93
v_mfma_f32_16x16x32_bf16 v[204:207],v[140:143],v[44:47],v[204:207]
s_mov_b32 s27,s42
ds_read_b128 v[140:143],v1 offset:6144
v_cvt_pk_bf16_f32 v73,v74,v75
v_cvt_pk_bf16_f32 v93,v94,v95
ds_write2st64_b64 v36,v[72:73],v[92:93] offset0:24 offset1:26
v_mfma_f32_16x16x32_bf16 v[72:75],v[112:115],a[144:147],0
s_mov_b32 s42,s41
v_accvgpr_read_b32 v102,a14
v_accvgpr_read_b32 v103,a15
v_mfma_f32_16x16x32_bf16 v[72:75],v[116:119],a[148:151],v[72:75]
s_add_u32 s69,s69,1
s_waitcnt lgkmcnt(4)
buffer_store_dwordx4 v[104:107],v9,s[16:19],s87 offen offset:256 nt
v_accvgpr_read_b32 v100,a12
v_accvgpr_read_b32 v101,a13
v_pk_mul_f32 v[102:103],v[102:103],v[64:65] op_sel_hi:[1,0]
v_pk_mul_f32 v[100:101],v[100:101],v[64:65] op_sel_hi:[1,0]
v_accvgpr_read_b32 v94,a30
v_accvgpr_read_b32 v95,a31
v_pk_mul_f32 v[94:95],v[94:95],v[64:65] op_sel_hi:[1,0]
v_accvgpr_read_b32 v92,a28
v_accvgpr_read_b32 v93,a29
v_pk_mul_f32 v[92:93],v[92:93],v[64:65] op_sel_hi:[1,0]
v_cvt_pk_bf16_f32 v108,v108,v109
v_cvt_pk_bf16_f32 v76,v76,v77
v_mfma_f32_16x16x32_bf16 v[72:75],v[120:123],a[152:155],v[72:75]
s_lshl_b32 s62,s69,5
v_cvt_pk_bf16_f32 v109,v110,v111
v_cvt_pk_bf16_f32 v77,v78,v79
v_mfma_f32_16x16x32_bf16 v[72:75],v[124:127],a[156:159],v[72:75]
s_add_u32 s62,s62,s34
ds_write2st64_b64 v37,v[108:109],v[76:77] offset0:24 offset1:26
v_mfma_f32_16x16x32_bf16 v[72:75],v[128:131],a[160:163],v[72:75]
s_mul_i32 s63,s62,171
v_accvgpr_read_b32 v78,a34
v_accvgpr_read_b32 v79,a35
v_mfma_f32_16x16x32_bf16 v[72:75],v[132:135],a[164:167],v[72:75]
s_lshr_b32 s63,s63,9
buffer_store_dwordx4 v[156:159],v9,s[16:19],s87 offen offset:3328 nt
v_accvgpr_read_b32 v76,a32
v_accvgpr_read_b32 v77,a33
v_pk_mul_f32 v[78:79],v[78:79],v[64:65] op_sel_hi:[1,0]
v_pk_mul_f32 v[160:161],v[160:161],v[60:61] op_sel_hi:[1,0]
v_pk_mul_f32 v[162:163],v[162:163],v[60:61] op_sel_hi:[1,0]
v_pk_mul_f32 v[76:77],v[76:77],v[64:65] op_sel_hi:[1,0]
v_cvt_pk_bf16_f32 v96,v96,v97
v_cvt_pk_bf16_f32 v88,v88,v89
v_cvt_pk_bf16_f32 v97,v98,v99
v_cvt_pk_bf16_f32 v89,v90,v91
ds_write2st64_b64 v38,v[96:97],v[88:89] offset0:24 offset1:26
v_accvgpr_read_b32 v104,a40
v_accvgpr_read_b32 v105,a41
v_accvgpr_read_b32 v106,a42
buffer_store_dwordx4 v[80:83],v9,s[16:19],s66 offen offset:256 nt
v_accvgpr_read_b32 v107,a43
v_accvgpr_read_b32 v110,a46
v_accvgpr_read_b32 v111,a47
v_mfma_f32_16x16x32_bf16 v[80:83],v[132:135],a[188:191],0
s_mul_i32 s64,s63,3
v_accvgpr_read_b32 v108,a44
v_accvgpr_read_b32 v109,a45
v_mfma_f32_16x16x32_bf16 v[80:83],v[128:131],a[184:187],v[80:83]
s_sub_u32 s62,s62,s64
v_cvt_pk_bf16_f32 v100,v100,v101
v_cvt_pk_bf16_f32 v92,v92,v93
v_mfma_f32_16x16x32_bf16 v[80:83],v[124:127],a[180:183],v[80:83]
s_add_u32 s63,s63,s33
s_waitcnt lgkmcnt(1)
buffer_store_dwordx4 v[84:87],v9,s[16:19],s66 offen offset:3328 nt
v_cvt_pk_bf16_f32 v160,v160,v161
v_cvt_pk_bf16_f32 v76,v76,v77
v_pk_mul_f32 v[164:165],v[164:165],v[60:61] op_sel_hi:[1,0]
v_pk_mul_f32 v[166:167],v[166:167],v[60:61] op_sel_hi:[1,0]
v_accvgpr_read_b32 v84,a36
v_accvgpr_read_b32 v85,a37
v_pk_mul_f32 v[84:85],v[84:85],v[64:65] op_sel_hi:[1,0]
v_accvgpr_read_b32 v86,a38
v_accvgpr_read_b32 v87,a39
v_pk_mul_f32 v[86:87],v[86:87],v[64:65] op_sel_hi:[1,0]
v_cvt_pk_bf16_f32 v101,v102,v103
v_cvt_pk_bf16_f32 v93,v94,v95
v_mfma_f32_16x16x32_bf16 v[80:83],v[120:123],a[176:179],v[80:83]
s_mul_i32 s30,s63,196608
ds_write2st64_b64 v39,v[100:101],v[92:93] offset0:24 offset1:26
v_mfma_f32_16x16x32_bf16 v[80:83],v[116:119],a[172:175],v[80:83]
s_mul_i32 s41,s63,325632
v_cvt_pk_bf16_f32 v161,v162,v163
v_cvt_pk_bf16_f32 v77,v78,v79
v_mfma_f32_16x16x32_bf16 v[80:83],v[112:115],a[168:171],v[80:83]
s_lshl_b32 s63,s3,2
v_cvt_pk_bf16_f32 v164,v164,v165
v_cvt_pk_bf16_f32 v84,v84,v85
v_mfma_f32_16x16x32_bf16 v[88:91],v[112:115],a[192:195],0
s_add_u32 s64,s63,21
ds_read_b128 v[112:115],v0 offset:6272
v_cvt_pk_bf16_f32 v165,v166,v167
ds_write2st64_b64 v36,v[76:77],v[160:161] offset0:28 offset1:0
v_pk_mul_f32 v[104:105],v[104:105],v[64:65] op_sel_hi:[1,0]
v_pk_mul_f32 v[106:107],v[106:107],v[64:65] op_sel_hi:[1,0]
v_pk_mul_f32 v[168:169],v[168:169],v[60:61] op_sel_hi:[1,0]
v_pk_mul_f32 v[170:171],v[170:171],v[60:61] op_sel_hi:[1,0]
v_cvt_pk_bf16_f32 v85,v86,v87
v_cvt_pk_bf16_f32 v104,v104,v105
v_mfma_f32_16x16x32_bf16 v[88:91],v[116:119],a[196:199],v[88:91]
s_cmp_eq_u32 s3,0
ds_read_b128 v[116:119],v1 offset:6272
v_cvt_pk_bf16_f32 v168,v168,v169
v_mfma_f32_16x16x32_bf16 v[88:91],v[120:123],a[200:203],v[88:91]
s_cselect_b32 s64,20,s64
ds_read_b128 v[120:123],v0 offset:6400
v_cvt_pk_bf16_f32 v105,v106,v107
v_mfma_f32_16x16x32_bf16 v[88:91],v[124:127],a[204:207],v[88:91]
s_cselect_b32 s40,1,0
ds_write2st64_b64 v37,v[84:85],v[164:165] offset0:28 offset1:0
v_mfma_f32_16x16x32_bf16 v[88:91],v[128:131],a[208:211],v[88:91]
s_add_u32 s65,s63,37
v_cvt_pk_bf16_f32 v169,v170,v171
ds_read_b128 v[124:127],v1 offset:6400
v_max3_f32 v44,v72,v73,v74
ds_read_b128 v[128:131],v0 offset:0
v_pk_mul_f32 v[108:109],v[108:109],v[64:65] op_sel_hi:[1,0]
ds_write2st64_b64 v38,v[104:105],v[168:169] offset0:28 offset1:0
v_pk_mul_f32 v[110:111],v[110:111],v[64:65] op_sel_hi:[1,0]
v_pk_mul_f32 v[172:173],v[172:173],v[60:61] op_sel_hi:[1,0]
v_pk_mul_f32 v[174:175],v[174:175],v[60:61] op_sel_hi:[1,0]
v_cvt_pk_bf16_f32 v108,v108,v109
v_cvt_pk_bf16_f32 v172,v172,v173
v_mfma_f32_16x16x32_bf16 v[88:91],v[132:135],a[212:215],v[88:91]
s_cmp_eq_u32 s62,2
ds_read_b128 v[132:135],v1 offset:0
v_cvt_pk_bf16_f32 v109,v110,v111
v_mfma_f32_16x16x32_bf16 v[76:79],v[136:139],a[144:147],0
s_cselect_b32 s64,s65,s64
v_cvt_pk_bf16_f32 v173,v174,v175
v_max3_f32 v48,v80,v81,v82
v_mfma_f32_16x16x32_bf16 v[76:79],v[140:143],a[148:151],v[76:79]
s_cselect_b32 s40,0,s40
ds_write2st64_b64 v39,v[108:109],v[172:173] offset0:28 offset1:0
v_pk_mul_f32 v[176:177],v[176:177],v[60:61] op_sel_hi:[1,0]
v_pk_mul_f32 v[178:179],v[178:179],v[60:61] op_sel_hi:[1,0]
v_pk_mul_f32 v[192:193],v[192:193],v[60:61] op_sel_hi:[1,0]
v_pk_mul_f32 v[194:195],v[194:195],v[60:61] op_sel_hi:[1,0]
v_max3_f32 v52,v88,v89,v90
v_cvt_pk_bf16_f32 v176,v176,v177
s_waitcnt lgkmcnt(2)
v_mfma_f32_16x16x32_bf16 v[76:79],v[112:115],a[152:155],v[76:79]
s_add_u32 s65,s63,s3
v_cvt_pk_bf16_f32 v192,v192,v193
v_cvt_pk_bf16_f32 v177,v178,v179
v_mfma_f32_16x16x32_bf16 v[76:79],v[116:119],a[156:159],v[76:79]
s_cmp_eq_u32 s62,0
v_cvt_pk_bf16_f32 v193,v194,v195
v_mov_b32 v66,0
v_mfma_f32_16x16x32_bf16 v[76:79],v[120:123],a[160:163],v[76:79]
s_cselect_b32 s64,s65,s64
ds_write2st64_b64 v36,v[176:177],v[192:193] offset0:2 offset1:4
v_mfma_f32_16x16x32_bf16 v[76:79],v[124:127],a[164:167],v[76:79]
s_cselect_b32 s40,1,s40
v_mov_b32 v67,0
v_mov_b32 v64,0
v_mov_b32 v65,0
v_mov_b32 v68,0
v_mov_b32 v69,0
v_pk_mul_f32 v[180:181],v[180:181],v[60:61] op_sel_hi:[1,0]
v_pk_mul_f32 v[182:183],v[182:183],v[60:61] op_sel_hi:[1,0]
v_pk_mul_f32 v[196:197],v[196:197],v[60:61] op_sel_hi:[1,0]
v_pk_mul_f32 v[198:199],v[198:199],v[60:61] op_sel_hi:[1,0]
v_max3_f32 v44,v44,v75,v76
v_max3_f32 v44,v44,v77,v78
v_mfma_f32_16x16x32_bf16 v[84:87],v[124:127],a[188:191],0
s_mul_i32 s64,s64,6144
v_max_f32 v44,v44,v79
v_mov_b32 v45,v44
v_mfma_f32_16x16x32_bf16 v[84:87],v[120:123],a[184:187],v[84:87]
s_add_u32 s41,s41,s64
v_permlane32_swap_b32 v45,v44
v_mfma_f32_16x16x32_bf16 v[84:87],v[116:119],a[180:183],v[84:87]
s_cmp_ge_u32 s69,6
v_max_f32 v44,v44,v45
v_mov_b32 v45,v44
v_cvt_pk_bf16_f32 v180,v180,v181
v_cvt_pk_bf16_f32 v196,v196,v197
v_permlane16_swap_b32 v45,v44
v_pk_mul_f32 v[184:185],v[184:185],v[60:61] op_sel_hi:[1,0]
v_pk_mul_f32 v[186:187],v[186:187],v[60:61] op_sel_hi:[1,0]
v_pk_mul_f32 v[200:201],v[200:201],v[60:61] op_sel_hi:[1,0]
v_pk_mul_f32 v[202:203],v[202:203],v[60:61] op_sel_hi:[1,0]
v_max_f32 v44,v44,v45
v_mul_f32_e64 v13,-s36,v44
v_mfma_f32_16x16x32_bf16 v[84:87],v[112:115],a[176:179],v[84:87]
s_cselect_b32 s41,166723584,s41
v_fma_f32 v72,v72,s36,v13
v_fma_f32 v73,v73,s36,v13
v_mfma_f32_16x16x32_bf16 v[84:87],v[140:143],a[172:175],v[84:87]
s_cselect_b32 s30,100663296,s30
v_fma_f32 v74,v74,s36,v13
v_fma_f32 v75,v75,s36,v13
v_mfma_f32_16x16x32_bf16 v[84:87],v[136:139],a[168:171],v[84:87]
s_add_u32 s25,s30,s22
v_exp_f32 v72,v72
v_mfma_f32_16x16x32_bf16 v[92:95],v[136:139],a[192:195],0
s_add_u32 s26,s25,12288
ds_read_b128 v[136:139],v0 offset:128
v_exp_f32 v73,v73
v_exp_f32 v74,v74
v_pk_mul_f32 v[188:189],v[188:189],v[60:61] op_sel_hi:[1,0]
v_pk_mul_f32 v[190:191],v[190:191],v[60:61] op_sel_hi:[1,0]
v_pk_mul_f32 v[204:205],v[204:205],v[60:61] op_sel_hi:[1,0]
v_pk_mul_f32 v[206:207],v[206:207],v[60:61] op_sel_hi:[1,0]
v_exp_f32 v75,v75
v_cvt_pk_bf16_f32 v20,v72,v73
v_mfma_f32_16x16x32_bf16 v[92:95],v[140:143],a[196:199],v[92:95]
s_add_u32 m0,s22,0
ds_read_b128 v[140:143],v1 offset:128
v_cvt_pk_bf16_f32 v21,v74,v75
v_mfma_f32_16x16x32_bf16 v[92:95],v[112:115],a[200:203],v[92:95]
s_mov_b32 s28,s41
ds_read_b128 v[112:115],v0 offset:256
v_max3_f32 v48,v48,v83,v84
v_mfma_f32_16x16x32_bf16 v[92:95],v[116:119],a[204:207],v[92:95]
s_mov_b32 s29,s24
ds_read_b128 v[116:119],v1 offset:256
v_max3_f32 v48,v48,v85,v86
v_mfma_f32_16x16x32_bf16 v[92:95],v[120:123],a[208:211],v[92:95]
ds_read_b128 v[120:123],v0 offset:6144
v_max_f32 v48,v48,v87
v_mov_b32 v49,v48
v_cvt_pk_bf16_f32 v181,v182,v183
v_cvt_pk_bf16_f32 v197,v198,v199
ds_write2st64_b64 v37,v[180:181],v[196:197] offset0:2 offset1:4
v_pk_mul_f32 v[208:209],v[208:209],v[62:63] op_sel_hi:[1,0]
v_pk_mul_f32 v[210:211],v[210:211],v[62:63] op_sel_hi:[1,0]
v_pk_mul_f32 v[224:225],v[224:225],v[62:63] op_sel_hi:[1,0]
v_pk_mul_f32 v[226:227],v[226:227],v[62:63] op_sel_hi:[1,0]
v_permlane32_swap_b32 v49,v48
v_max_f32 v48,v48,v49
v_mfma_f32_16x16x32_bf16 v[92:95],v[124:127],a[212:215],v[92:95]
ds_read_b128 v[124:127],v1 offset:6144
v_mov_b32 v49,v48
v_cvt_pk_bf16_f32 v184,v184,v185
v_cvt_pk_bf16_f32 v200,v200,v201
v_permlane16_swap_b32 v49,v48
s_waitcnt lgkmcnt(3)
v_mfma_f32_16x16x32_bf16 v[96:99],v[116:119],a[236:239],0
v_max_f32 v48,v48,v49
v_mul_f32_e64 v14,-s36,v48
v_mfma_f32_16x16x32_bf16 v[96:99],v[112:115],a[232:235],v[96:99]
v_fma_f32 v80,v80,s36,v14
v_fma_f32 v81,v81,s36,v14
v_fma_f32 v82,v82,s36,v14
v_fma_f32 v83,v83,s36,v14
v_exp_f32 v80,v80
v_pk_mul_f32 v[212:213],v[212:213],v[62:63] op_sel_hi:[1,0]
v_pk_mul_f32 v[214:215],v[214:215],v[62:63] op_sel_hi:[1,0]
v_pk_mul_f32 v[228:229],v[228:229],v[62:63] op_sel_hi:[1,0]
v_pk_mul_f32 v[230:231],v[230:231],v[62:63] op_sel_hi:[1,0]
v_exp_f32 v81,v81
v_exp_f32 v82,v82
v_mfma_f32_16x16x32_bf16 v[96:99],v[140:143],a[228:231],v[96:99]
v_exp_f32 v83,v83
v_mfma_f32_16x16x32_bf16 v[96:99],v[136:139],a[224:227],v[96:99]
v_cvt_pk_bf16_f32 v24,v80,v81
v_cvt_pk_bf16_f32 v25,v82,v83
v_mfma_f32_16x16x32_bf16 v[96:99],v[132:135],a[220:223],v[96:99]
v_max3_f32 v52,v52,v91,v92
v_max3_f32 v52,v52,v93,v94
v_mfma_f32_16x16x32_bf16 v[96:99],v[128:131],a[216:219],v[96:99]
v_max_f32 v52,v52,v95
v_mov_b32 v53,v52
v_cvt_pk_bf16_f32 v188,v188,v189
v_cvt_pk_bf16_f32 v204,v204,v205
v_permlane32_swap_b32 v53,v52
v_pk_mul_f32 v[216:217],v[216:217],v[62:63] op_sel_hi:[1,0]
v_pk_mul_f32 v[218:219],v[218:219],v[62:63] op_sel_hi:[1,0]
v_pk_mul_f32 v[232:233],v[232:233],v[62:63] op_sel_hi:[1,0]
v_pk_mul_f32 v[234:235],v[234:235],v[62:63] op_sel_hi:[1,0]
v_max_f32 v52,v52,v53
v_mov_b32 v53,v52
v_mfma_f32_16x16x32_bf16 v[104:107],v[128:131],a[240:243],0
ds_read_b128 v[128:131],v0 offset:6272
v_permlane16_swap_b32 v53,v52
v_mfma_f32_16x16x32_bf16 v[104:107],v[132:135],a[244:247],v[104:107]
ds_read_b128 v[132:135],v1 offset:6272
v_max_f32 v52,v52,v53
v_mfma_f32_16x16x32_bf16 v[104:107],v[136:139],a[248:251],v[104:107]
ds_read_b128 v[136:139],v0 offset:6400
v_mul_f32_e64 v15,-s36,v52
v_mfma_f32_16x16x32_bf16 v[104:107],v[140:143],a[252:255],v[104:107]
ds_read_b128 v[140:143],v1 offset:6400
v_fma_f32 v88,v88,s36,v15
v_fma_f32 v89,v89,s36,v15
v_fma_f32 v90,v90,s36,v15
v_fma_f32 v91,v91,s36,v15
v_pk_mul_f32 v[220:221],v[220:221],v[62:63] op_sel_hi:[1,0]
v_pk_mul_f32 v[222:223],v[222:223],v[62:63] op_sel_hi:[1,0]
v_pk_mul_f32 v[236:237],v[236:237],v[62:63] op_sel_hi:[1,0]
v_pk_mul_f32 v[238:239],v[238:239],v[62:63] op_sel_hi:[1,0]
v_exp_f32 v88,v88
v_exp_f32 v89,v89
v_mfma_f32_16x16x32_bf16 v[104:107],v[112:115],v[144:147],v[104:107]
ds_read_b128 v[112:115],v0 offset:12544
v_exp_f32 v90,v90
v_mfma_f32_16x16x32_bf16 v[104:107],v[116:119],v[148:151],v[104:107]
s_waitcnt lgkmcnt(3)
ds_read_b128 v[116:119],v1 offset:12544
v_exp_f32 v91,v91
v_mfma_f32_16x16x32_bf16 v[100:103],v[120:123],a[216:219],0
v_cvt_pk_bf16_f32 v28,v88,v89
v_cvt_pk_bf16_f32 v29,v90,v91
v_max3_f32 v56,v96,v97,v98
v_cvt_pk_bf16_f32 v185,v186,v187
v_cvt_pk_bf16_f32 v201,v202,v203
ds_write2st64_b64 v38,v[184:185],v[200:201] offset0:2 offset1:4
v_pk_mul_f32 v[240:241],v[240:241],v[62:63] op_sel_hi:[1,0]
v_pk_mul_f32 v[242:243],v[242:243],v[62:63] op_sel_hi:[1,0]
v_max3_f32 v40,v104,v105,v106
v_cvt_pk_bf16_f32 v208,v208,v209
v_mfma_f32_16x16x32_bf16 v[100:103],v[124:127],a[220:223],v[100:103]
v_cvt_pk_bf16_f32 v224,v224,v225
v_cvt_pk_bf16_f32 v189,v190,v191
v_mfma_f32_16x16x32_bf16 v[100:103],v[128:131],a[224:227],v[100:103]
v_cvt_pk_bf16_f32 v205,v206,v207
v_cvt_pk_bf16_f32 v212,v212,v213
v_mfma_f32_16x16x32_bf16 v[100:103],v[132:135],a[228:231],v[100:103]
s_waitcnt lgkmcnt(1)
ds_write2st64_b64 v39,v[188:189],v[204:205] offset0:2 offset1:4
v_mfma_f32_16x16x32_bf16 v[100:103],v[136:139],a[232:235],v[100:103]
v_cvt_pk_bf16_f32 v228,v228,v229
v_cvt_pk_bf16_f32 v209,v210,v211
v_cvt_pk_bf16_f32 v225,v226,v227
v_cvt_pk_bf16_f32 v216,v216,v217
v_cvt_pk_bf16_f32 v232,v232,v233
v_pk_mul_f32 v[244:245],v[244:245],v[62:63] op_sel_hi:[1,0]
v_pk_mul_f32 v[246:247],v[246:247],v[62:63] op_sel_hi:[1,0]
v_cvt_pk_bf16_f32 v213,v214,v215
v_cvt_pk_bf16_f32 v229,v230,v231
v_mfma_f32_16x16x32_bf16 v[100:103],v[140:143],a[236:239],v[100:103]
ds_write2st64_b64 v36,v[208:209],v[224:225] offset0:12 offset1:14
v_mfma_f32_16x16x32_bf16 v[108:111],v[140:143],v[148:151],0
v_cvt_pk_bf16_f32 v220,v220,v221
v_cvt_pk_bf16_f32 v236,v236,v237
v_mfma_f32_16x16x32_bf16 v[108:111],v[136:139],v[144:147],v[108:111]
ds_read_b128 v[136:139],v0 offset:12416
v_cvt_pk_bf16_f32 v217,v218,v219
ds_read_b128 v[140:143],v1 offset:12416
v_pk_mul_f32 v[248:249],v[248:249],v[62:63] op_sel_hi:[1,0]
ds_write2st64_b64 v37,v[212:213],v[228:229] offset0:12 offset1:14
v_pk_mul_f32 v[250:251],v[250:251],v[62:63] op_sel_hi:[1,0]
v_max3_f32 v56,v56,v99,v100
v_max3_f32 v56,v56,v101,v102
v_mfma_f32_16x16x32_bf16 v[108:111],v[132:135],a[252:255],v[108:111]
ds_read_b128 v[132:135],v1 offset:12288
v_max_f32 v56,v56,v103
v_mfma_f32_16x16x32_bf16 v[108:111],v[128:131],a[248:251],v[108:111]
ds_read_b128 v[128:131],v0 offset:12288
v_mov_b32 v57,v56
v_mfma_f32_16x16x32_bf16 v[108:111],v[124:127],a[244:247],v[108:111]
ds_read_b128 v[124:127],v1 offset:18432
v_permlane32_swap_b32 v57,v56
v_mfma_f32_16x16x32_bf16 v[108:111],v[120:123],a[240:243],v[108:111]
ds_read_b128 v[120:123],v0 offset:18432
v_max_f32 v56,v56,v57
v_mov_b32 v57,v56
v_cvt_pk_bf16_f32 v233,v234,v235
ds_write2st64_b64 v38,v[216:217],v[232:233] offset0:12 offset1:14
v_pk_mul_f32 v[252:253],v[252:253],v[62:63] op_sel_hi:[1,0]
v_pk_mul_f32 v[254:255],v[254:255],v[62:63] op_sel_hi:[1,0]
v_permlane16_swap_b32 v57,v56
v_max_f32 v56,v56,v57
v_mul_f32_e64 v16,-s36,v56
v_fma_f32 v96,v96,s36,v16
v_fma_f32 v97,v97,s36,v16
v_fma_f32 v98,v98,s36,v16
v_fma_f32 v99,v99,s36,v16
s_waitcnt lgkmcnt(3)
v_mfma_f32_16x16x32_bf16 v[72:75],v[128:131],a[144:147],0
v_exp_f32 v96,v96
v_mfma_f32_16x16x32_bf16 v[72:75],v[132:135],a[148:151],v[72:75]
v_exp_f32 v97,v97
v_mfma_f32_16x16x32_bf16 v[72:75],v[136:139],a[152:155],v[72:75]
v_exp_f32 v98,v98
v_mfma_f32_16x16x32_bf16 v[72:75],v[140:143],a[156:159],v[72:75]
v_exp_f32 v99,v99
v_mfma_f32_16x16x32_bf16 v[72:75],v[112:115],a[160:163],v[72:75]
v_cvt_pk_bf16_f32 v32,v96,v97
v_cvt_pk_bf16_f32 v33,v98,v99
v_mfma_f32_16x16x32_bf16 v[72:75],v[116:119],a[164:167],v[72:75]
v_max3_f32 v40,v40,v107,v108
v_max3_f32 v40,v40,v109,v110
v_mfma_f32_16x16x32_bf16 v[80:83],v[116:119],a[188:191],0
v_max_f32 v40,v40,v111
v_mov_b32 v41,v40
v_mfma_f32_16x16x32_bf16 v[80:83],v[112:115],a[184:187],v[80:83]
v_cvt_pk_bf16_f32 v240,v240,v241
v_permlane32_swap_b32 v41,v40
v_mfma_f32_16x16x32_bf16 v[80:83],v[140:143],a[180:183],v[80:83]
v_max_f32 v40,v40,v41
v_mov_b32 v41,v40
v_mfma_f32_16x16x32_bf16 v[80:83],v[136:139],a[176:179],v[80:83]
v_cvt_pk_bf16_f32 v221,v222,v223
v_permlane16_swap_b32 v41,v40
v_mfma_f32_16x16x32_bf16 v[80:83],v[132:135],a[172:175],v[80:83]
v_max_f32 v40,v40,v41
v_mul_f32_e64 v17,-s36,v40
v_mfma_f32_16x16x32_bf16 v[80:83],v[128:131],a[168:171],v[80:83]
v_cvt_pk_bf16_f32 v237,v238,v239
v_fma_f32 v104,v104,s36,v17
v_mfma_f32_16x16x32_bf16 v[88:91],v[128:131],a[192:195],0
ds_write2st64_b64 v39,v[220:221],v[236:237] offset0:12 offset1:14
v_mfma_f32_16x16x32_bf16 v[88:91],v[132:135],a[196:199],v[88:91]
v_fma_f32 v105,v105,s36,v17
v_fma_f32 v106,v106,s36,v17
v_mfma_f32_16x16x32_bf16 v[88:91],v[136:139],a[200:203],v[88:91]
v_fma_f32 v107,v107,s36,v17
v_cvt_pk_bf16_f32 v244,v244,v245
v_mfma_f32_16x16x32_bf16 v[88:91],v[140:143],a[204:207],v[88:91]
v_cvt_pk_bf16_f32 v241,v242,v243
v_exp_f32 v104,v104
v_mfma_f32_16x16x32_bf16 v[88:91],v[112:115],a[208:211],v[88:91]
ds_write_b64 v36,v[240:241] offset:8192
v_mfma_f32_16x16x32_bf16 v[88:91],v[116:119],a[212:215],v[88:91]
v_exp_f32 v105,v105
v_mfma_f32_16x16x32_bf16 v[96:99],v[116:119],a[236:239],0
v_exp_f32 v106,v106
v_mfma_f32_16x16x32_bf16 v[96:99],v[112:115],a[232:235],v[96:99]
v_exp_f32 v107,v107
v_mfma_f32_16x16x32_bf16 v[96:99],v[140:143],a[228:231],v[96:99]
v_cvt_pk_bf16_f32 v245,v246,v247
v_cvt_pk_bf16_f32 v36,v104,v105
v_mfma_f32_16x16x32_bf16 v[96:99],v[136:139],a[224:227],v[96:99]
ds_write_b64 v37,v[244:245] offset:8192
s_waitcnt vmcnt(11)
s_barrier
v_mfma_f32_16x16x32_bf16 v[96:99],v[132:135],a[220:223],v[96:99]
buffer_load_dwordx4 v6,s[4:7],s20 offen offset:0 lds
v_mfma_f32_16x16x32_bf16 v[96:99],v[128:131],a[216:219],v[96:99]
v_cvt_pk_bf16_f32 v37,v106,v107
v_fma_f32 v76,v76,s36,v13
v_mfma_f32_16x16x32_bf16 v[104:107],v[128:131],a[240:243],0
ds_read_b128 v[128:131],v0 offset:18560
v_fma_f32 v77,v77,s36,v13
v_mfma_f32_16x16x32_bf16 v[104:107],v[132:135],a[244:247],v[104:107]
ds_read_b128 v[132:135],v1 offset:18560
v_fma_f32 v78,v78,s36,v13
v_mfma_f32_16x16x32_bf16 v[104:107],v[136:139],a[248:251],v[104:107]
ds_read_b128 v[136:139],v0 offset:18688
v_fma_f32 v79,v79,s36,v13
v_mfma_f32_16x16x32_bf16 v[104:107],v[140:143],a[252:255],v[104:107]
ds_read_b128 v[140:143],v1 offset:18688
v_exp_f32 v76,v76
v_mfma_f32_16x16x32_bf16 v[104:107],v[112:115],v[144:147],v[104:107]
buffer_load_dwordx4 v7,s[4:7],s20 offen offset:1024 lds
v_mfma_f32_16x16x32_bf16 v[104:107],v[116:119],v[148:151],v[104:107]
v_exp_f32 v77,v77
v_exp_f32 v78,v78
v_exp_f32 v79,v79
v_cvt_pk_bf16_f32 v22,v76,v77
ds_read_b64_tr_b16 v[112:113],v2 offset:0
ds_read_b64_tr_b16 v[114:115],v2 offset:6144
v_cvt_pk_bf16_f32 v23,v78,v79
s_waitcnt lgkmcnt(4)
v_mfma_f32_16x16x32_bf16 v[76:79],v[120:123],a[144:147],0
v_fma_f32 v84,v84,s36,v14
v_fma_f32 v85,v85,s36,v14
v_mfma_f32_16x16x32_bf16 v[76:79],v[124:127],a[148:151],v[76:79]
buffer_load_dwordx4 v8,s[4:7],s20 offen offset:2048 lds
v_mfma_f32_16x16x32_bf16 v[76:79],v[128:131],a[152:155],v[76:79]
s_add_u32 s20,s20,12288
ds_read_b64_tr_b16 v[116:117],v3 offset:0
v_fma_f32 v86,v86,s36,v14
v_mfma_f32_16x16x32_bf16 v[76:79],v[132:135],a[156:159],v[76:79]
s_waitcnt lgkmcnt(3)
ds_read_b64_tr_b16 v[118:119],v3 offset:6144
v_fma_f32 v87,v87,s36,v14
v_mfma_f32_16x16x32_bf16 v[76:79],v[136:139],a[160:163],v[76:79]
v_exp_f32 v84,v84
v_mfma_f32_16x16x32_bf16 v[76:79],v[140:143],a[164:167],v[76:79]
v_exp_f32 v85,v85
v_exp_f32 v86,v86
v_exp_f32 v87,v87
v_cvt_pk_bf16_f32 v26,v84,v85
v_cvt_pk_bf16_f32 v27,v86,v87
v_mfma_f32_16x16x32_bf16 v[84:87],v[140:143],a[188:191],0
v_fma_f32 v92,v92,s36,v15
v_fma_f32 v93,v93,s36,v15
v_mfma_f32_16x16x32_bf16 v[84:87],v[136:139],a[184:187],v[84:87]
v_fma_f32 v94,v94,s36,v15
v_fma_f32 v95,v95,s36,v15
v_mfma_f32_16x16x32_bf16 v[84:87],v[132:135],a[180:183],v[84:87]
v_exp_f32 v92,v92
v_mfma_f32_16x16x32_bf16 v[84:87],v[128:131],a[176:179],v[84:87]
v_exp_f32 v93,v93
v_mfma_f32_16x16x32_bf16 v[84:87],v[124:127],a[172:175],v[84:87]
v_exp_f32 v94,v94
v_mfma_f32_16x16x32_bf16 v[84:87],v[120:123],a[168:171],v[84:87]
v_exp_f32 v95,v95
v_cvt_pk_bf16_f32 v30,v92,v93
v_cvt_pk_bf16_f32 v31,v94,v95
v_mfma_f32_16x16x32_bf16 v[92:95],v[120:123],a[192:195],0
v_fma_f32 v100,v100,s36,v16
v_fma_f32 v101,v101,s36,v16
v_mfma_f32_16x16x32_bf16 v[92:95],v[124:127],a[196:199],v[92:95]
v_fma_f32 v102,v102,s36,v16
v_fma_f32 v103,v103,s36,v16
v_mfma_f32_16x16x32_bf16 v[92:95],v[128:131],a[200:203],v[92:95]
v_exp_f32 v100,v100
v_mfma_f32_16x16x32_bf16 v[92:95],v[132:135],a[204:207],v[92:95]
v_exp_f32 v101,v101
v_mfma_f32_16x16x32_bf16 v[92:95],v[136:139],a[208:211],v[92:95]
v_exp_f32 v102,v102
v_mfma_f32_16x16x32_bf16 v[92:95],v[140:143],a[212:215],v[92:95]
v_exp_f32 v103,v103
v_cvt_pk_bf16_f32 v34,v100,v101
v_cvt_pk_bf16_f32 v35,v102,v103
v_mfma_f32_16x16x32_bf16 v[100:103],v[140:143],a[236:239],0
v_cvt_pk_bf16_f32 v248,v248,v249
v_fma_f32 v108,v108,s36,v17
v_smfmac_f32_16x16x64_bf16 v[64:67],v[152:155],v[28:35],v18
v_fma_f32 v109,v109,s36,v17
v_mfma_f32_16x16x32_bf16 v[100:103],v[136:139],a[232:235],v[100:103]
v_fma_f32 v110,v110,s36,v17
v_fma_f32 v111,v111,s36,v17
v_mfma_f32_16x16x32_bf16 v[100:103],v[132:135],a[228:231],v[100:103]
v_cvt_pk_bf16_f32 v252,v252,v253
v_cvt_pk_bf16_f32 v249,v250,v251
v_mfma_f32_16x16x32_bf16 v[100:103],v[128:131],a[224:227],v[100:103]
ds_write_b64 v38,v[248:249] offset:8192
v_mfma_f32_16x16x32_bf16 v[100:103],v[124:127],a[220:223],v[100:103]
v_exp_f32 v108,v108
v_mfma_f32_16x16x32_bf16 v[100:103],v[120:123],a[216:219],v[100:103]
v_exp_f32 v109,v109
v_exp_f32 v110,v110
v_exp_f32 v111,v111
v_cvt_pk_bf16_f32 v253,v254,v255
ds_write_b64 v39,v[252:253] offset:8192
v_cvt_pk_bf16_f32 v38,v108,v109
v_cvt_pk_bf16_f32 v39,v110,v111
v_mfma_f32_16x16x32_bf16 v[108:111],v[120:123],a[240:243],0
ds_read_b64_tr_b16 v[120:121],v4 offset:0
v_mov_b32 v60,0
v_mfma_f32_16x16x32_bf16 v[108:111],v[124:127],a[244:247],v[108:111]
ds_read_b64_tr_b16 v[122:123],v4 offset:6144
v_mov_b32 v61,0
v_mfma_f32_16x16x32_bf16 v[108:111],v[128:131],a[248:251],v[108:111]
ds_read_b64_tr_b16 v[124:125],v5 offset:0
v_mov_b32 v62,0
v_mfma_f32_16x16x32_bf16 v[108:111],v[132:135],a[252:255],v[108:111]
ds_read_b64_tr_b16 v[126:127],v5 offset:6144
v_mov_b32 v63,0
v_mfma_f32_16x16x32_bf16 v[108:111],v[136:139],v[144:147],v[108:111]
v_fma_f32 v72,v72,s36,v13
v_fma_f32 v73,v73,s36,v13
v_smfmac_f32_16x16x64_bf16 v[60:63],v[152:155],v[20:27],v18
v_fma_f32 v74,v74,s36,v13
v_mfma_f32_16x16x32_bf16 v[108:111],v[140:143],v[148:151],v[108:111]
v_fma_f32 v75,v75,s36,v13
v_fma_f32 v80,v80,s36,v14
v_fma_f32 v81,v81,s36,v14
v_fma_f32 v82,v82,s36,v14
v_fma_f32 v83,v83,s36,v14
v_fma_f32 v88,v88,s36,v15
v_fma_f32 v89,v89,s36,v15
v_exp_f32 v72,v72
v_exp_f32 v73,v73
v_exp_f32 v74,v74
v_exp_f32 v75,v75
v_exp_f32 v80,v80
v_exp_f32 v81,v81
v_exp_f32 v82,v82
v_exp_f32 v83,v83
v_exp_f32 v88,v88
v_exp_f32 v89,v89
v_cvt_pk_bf16_f32 v44,v72,v73
v_cvt_pk_bf16_f32 v45,v74,v75
v_cvt_pk_bf16_f32 v48,v80,v81
v_cvt_pk_bf16_f32 v49,v82,v83
v_cvt_pk_bf16_f32 v52,v88,v89
s_waitcnt lgkmcnt(0)
v_mfma_f32_16x16x32_bf16 v[160:163],v[112:115],v[20:23],0
s_add_u32 m0,s23,0
ds_read_b64_tr_b16 v[128:129],v2 offset:128
v_fma_f32 v90,v90,s36,v15
v_mfma_f32_16x16x32_bf16 v[164:167],v[116:119],v[20:23],0
ds_read_b64_tr_b16 v[130:131],v2 offset:6272
v_fma_f32 v91,v91,s36,v15
v_mfma_f32_16x16x32_bf16 v[212:215],v[116:119],v[24:27],0
ds_read_b64_tr_b16 v[132:133],v3 offset:128
v_fma_f32 v96,v96,s36,v16
v_mfma_f32_16x16x32_bf16 v[208:211],v[112:115],v[24:27],0
ds_read_b64_tr_b16 v[134:135],v3 offset:6272
v_fma_f32 v97,v97,s36,v16
v_mfma_f32_16x16x32_bf16 a[0:3],v[112:115],v[28:31],0
ds_read_b64_tr_b16 v[136:137],v4 offset:128
v_fma_f32 v98,v98,s36,v16
v_mfma_f32_16x16x32_bf16 a[4:7],v[116:119],v[28:31],0
ds_read_b64_tr_b16 v[138:139],v4 offset:6272
v_fma_f32 v99,v99,s36,v16
v_mfma_f32_16x16x32_bf16 a[52:55],v[116:119],v[32:35],0
ds_read_b64_tr_b16 v[140:141],v5 offset:128
v_fma_f32 v104,v104,s36,v17
v_mfma_f32_16x16x32_bf16 a[48:51],v[112:115],v[32:35],0
ds_read_b64_tr_b16 v[142:143],v5 offset:6272
v_fma_f32 v105,v105,s36,v17
v_mfma_f32_16x16x32_bf16 a[96:99],v[112:115],v[36:39],0
ds_read_b64_tr_b16 v[112:113],v2 offset:256
v_fma_f32 v106,v106,s36,v17
v_mfma_f32_16x16x32_bf16 a[100:103],v[116:119],v[36:39],0
ds_read_b64_tr_b16 v[114:115],v2 offset:6400
v_fma_f32 v107,v107,s36,v17
v_mfma_f32_16x16x32_bf16 a[104:107],v[120:123],v[36:39],0
ds_read_b64_tr_b16 v[116:117],v3 offset:256
v_fma_f32 v76,v76,s36,v13
v_mfma_f32_16x16x32_bf16 a[108:111],v[124:127],v[36:39],0
ds_read_b64_tr_b16 v[118:119],v3 offset:6400
v_fma_f32 v77,v77,s36,v13
v_mfma_f32_16x16x32_bf16 a[60:63],v[124:127],v[32:35],0
v_exp_f32 v90,v90
v_mfma_f32_16x16x32_bf16 a[56:59],v[120:123],v[32:35],0
v_exp_f32 v91,v91
v_mfma_f32_16x16x32_bf16 a[8:11],v[120:123],v[28:31],0
v_cvt_pk_bf16_f32 v53,v90,v91
v_fma_f32 v78,v78,s36,v13
v_mfma_f32_16x16x32_bf16 a[12:15],v[124:127],v[28:31],0
v_exp_f32 v96,v96
v_mfma_f32_16x16x32_bf16 v[220:223],v[124:127],v[24:27],0
v_exp_f32 v97,v97
v_mfma_f32_16x16x32_bf16 v[216:219],v[120:123],v[24:27],0
v_exp_f32 v98,v98
v_mfma_f32_16x16x32_bf16 v[168:171],v[120:123],v[20:23],0
ds_read_b64_tr_b16 v[120:121],v4 offset:256
v_cvt_pk_bf16_f32 v56,v96,v97
v_mfma_f32_16x16x32_bf16 v[172:175],v[124:127],v[20:23],0
s_waitcnt lgkmcnt(1)
ds_read_b64_tr_b16 v[122:123],v4 offset:6400
v_fma_f32 v79,v79,s36,v13
v_mfma_f32_16x16x32_bf16 v[176:179],v[128:131],v[20:23],0
ds_read_b64_tr_b16 v[124:125],v5 offset:256
v_fma_f32 v84,v84,s36,v14
v_mfma_f32_16x16x32_bf16 v[180:183],v[132:135],v[20:23],0
ds_read_b64_tr_b16 v[126:127],v5 offset:6400
v_fma_f32 v85,v85,s36,v14
v_mfma_f32_16x16x32_bf16 v[228:231],v[132:135],v[24:27],0
v_exp_f32 v99,v99
v_mfma_f32_16x16x32_bf16 v[224:227],v[128:131],v[24:27],0
v_cvt_pk_bf16_f32 v57,v98,v99
v_fma_f32 v86,v86,s36,v14
v_mfma_f32_16x16x32_bf16 a[16:19],v[128:131],v[28:31],0
v_exp_f32 v104,v104
v_mfma_f32_16x16x32_bf16 a[20:23],v[132:135],v[28:31],0
v_exp_f32 v105,v105
v_mfma_f32_16x16x32_bf16 a[68:71],v[132:135],v[32:35],0
v_exp_f32 v106,v106
v_mfma_f32_16x16x32_bf16 a[64:67],v[128:131],v[32:35],0
v_exp_f32 v107,v107
v_mfma_f32_16x16x32_bf16 a[112:115],v[128:131],v[36:39],0
v_cvt_pk_bf16_f32 v40,v104,v105
v_cvt_pk_bf16_f32 v41,v106,v107
v_mfma_f32_16x16x32_bf16 a[116:119],v[132:135],v[36:39],0
v_exp_f32 v76,v76
v_mfma_f32_16x16x32_bf16 a[120:123],v[136:139],v[36:39],0
v_exp_f32 v77,v77
v_mfma_f32_16x16x32_bf16 a[124:127],v[140:143],v[36:39],0
v_exp_f32 v78,v78
v_mfma_f32_16x16x32_bf16 a[76:79],v[140:143],v[32:35],0
v_exp_f32 v79,v79
v_mfma_f32_16x16x32_bf16 a[72:75],v[136:139],v[32:35],0
v_cvt_pk_bf16_f32 v46,v76,v77
v_cvt_pk_bf16_f32 v47,v78,v79
v_mfma_f32_16x16x32_bf16 a[24:27],v[136:139],v[28:31],0
v_fma_f32 v87,v87,s36,v14
v_fma_f32 v92,v92,s36,v15
v_mfma_f32_16x16x32_bf16 a[28:31],v[140:143],v[28:31],0
v_exp_f32 v84,v84
v_mfma_f32_16x16x32_bf16 v[236:239],v[140:143],v[24:27],0
v_exp_f32 v85,v85
v_mfma_f32_16x16x32_bf16 v[232:235],v[136:139],v[24:27],0
v_exp_f32 v86,v86
v_mfma_f32_16x16x32_bf16 v[184:187],v[136:139],v[20:23],0
v_exp_f32 v87,v87
v_mfma_f32_16x16x32_bf16 v[188:191],v[140:143],v[20:23],0
v_cvt_pk_bf16_f32 v50,v84,v85
v_cvt_pk_bf16_f32 v51,v86,v87
v_mfma_f32_16x16x32_bf16 v[192:195],v[112:115],v[20:23],0
v_fma_f32 v93,v93,s36,v15
v_fma_f32 v94,v94,s36,v15
v_smfmac_f32_16x16x64_bf16 v[60:63],v[152:155],v[44:51],v18
v_fma_f32 v95,v95,s36,v15
v_mfma_f32_16x16x32_bf16 v[196:199],v[116:119],v[20:23],0
s_waitcnt vmcnt(36) lgkmcnt(0)
v_exp_f32 v92,v92
v_mfma_f32_16x16x32_bf16 v[244:247],v[116:119],v[24:27],0
s_barrier
v_mfma_f32_16x16x32_bf16 v[240:243],v[112:115],v[24:27],0
ds_read_b128 v[128:131],v0 offset:24576
v_fma_f32 v100,v100,s36,v16
v_mfma_f32_16x16x32_bf16 a[32:35],v[112:115],v[28:31],0
ds_read_b128 v[132:135],v1 offset:24576
v_fma_f32 v101,v101,s36,v16
v_mfma_f32_16x16x32_bf16 a[36:39],v[116:119],v[28:31],0
ds_read_b128 v[136:139],v0 offset:24704
v_fma_f32 v102,v102,s36,v16
v_mfma_f32_16x16x32_bf16 a[84:87],v[116:119],v[32:35],0
ds_read_b128 v[140:143],v1 offset:24704
v_fma_f32 v103,v103,s36,v16
v_mfma_f32_16x16x32_bf16 a[80:83],v[112:115],v[32:35],0
v_exp_f32 v93,v93
v_mfma_f32_16x16x32_bf16 a[128:131],v[112:115],v[36:39],0
buffer_load_dwordx4 v6,s[8:11],s21 offen offset:0 lds
v_mfma_f32_16x16x32_bf16 a[132:135],v[116:119],v[36:39],0
ds_read_b128 v[112:115],v0 offset:24832
v_cvt_pk_bf16_f32 v54,v92,v93
v_mfma_f32_16x16x32_bf16 a[136:139],v[120:123],v[36:39],0
ds_read_b128 v[116:119],v1 offset:24832
v_fma_f32 v108,v108,s36,v17
v_mfma_f32_16x16x32_bf16 a[140:143],v[124:127],v[36:39],0
v_exp_f32 v94,v94
v_mfma_f32_16x16x32_bf16 a[92:95],v[124:127],v[32:35],0
v_exp_f32 v95,v95
v_mfma_f32_16x16x32_bf16 a[88:91],v[120:123],v[32:35],0
v_cvt_pk_bf16_f32 v55,v94,v95
v_fma_f32 v109,v109,s36,v17
v_mfma_f32_16x16x32_bf16 a[40:43],v[120:123],v[28:31],0
v_exp_f32 v100,v100
v_mfma_f32_16x16x32_bf16 a[44:47],v[124:127],v[28:31],0
v_exp_f32 v101,v101
v_mfma_f32_16x16x32_bf16 v[252:255],v[124:127],v[24:27],0
v_exp_f32 v102,v102
v_mfma_f32_16x16x32_bf16 v[248:251],v[120:123],v[24:27],0
v_exp_f32 v103,v103
v_mfma_f32_16x16x32_bf16 v[200:203],v[120:123],v[20:23],0
ds_read_b128 v[120:123],v0 offset:30720
v_cvt_pk_bf16_f32 v58,v100,v101
v_mfma_f32_16x16x32_bf16 v[204:207],v[124:127],v[20:23],0
buffer_load_dwordx4 v7,s[8:11],s21 offen offset:1024 lds
s_waitcnt lgkmcnt(1)
v_mfma_f32_16x16x32_bf16 v[72:75],v[128:131],a[144:147],0
ds_read_b128 v[124:127],v1 offset:30720
v_cvt_pk_bf16_f32 v59,v102,v103
v_mfma_f32_16x16x32_bf16 v[72:75],v[132:135],a[148:151],v[72:75]
v_fma_f32 v110,v110,s36,v17
v_fma_f32 v111,v111,s36,v17
v_smfmac_f32_16x16x64_bf16 v[64:67],v[152:155],v[52:59],v18
v_mfma_f32_16x16x32_bf16 v[72:75],v[136:139],a[152:155],v[72:75]
v_exp_f32 v108,v108
v_mfma_f32_16x16x32_bf16 v[72:75],v[140:143],a[156:159],v[72:75]
v_exp_f32 v109,v109
v_mfma_f32_16x16x32_bf16 v[72:75],v[112:115],a[160:163],v[72:75]
v_exp_f32 v110,v110
v_mfma_f32_16x16x32_bf16 v[72:75],v[116:119],a[164:167],v[72:75]
v_exp_f32 v111,v111
v_mfma_f32_16x16x32_bf16 v[80:83],v[116:119],a[188:191],0
v_cvt_pk_bf16_f32 v42,v108,v109
v_cvt_pk_bf16_f32 v43,v110,v111
v_mfma_f32_16x16x32_bf16 v[80:83],v[112:115],a[184:187],v[80:83]
v_mfma_f32_16x16x32_bf16 v[80:83],v[140:143],a[180:183],v[80:83]
v_smfmac_f32_16x16x64_bf16 v[68:71],v[152:155],v[36:43],v18
buffer_load_dwordx4 v8,s[8:11],s21 offen offset:2048 lds
v_mfma_f32_16x16x32_bf16 v[80:83],v[136:139],a[176:179],v[80:83]
s_add_u32 s21,s21,12288
v_fma_f32 v72,v72,s36,v13
v_fma_f32 v73,v73,s36,v13
v_mfma_f32_16x16x32_bf16 v[80:83],v[132:135],a[172:175],v[80:83]
s_add_u32 m0,s22,12288
v_fma_f32 v74,v74,s36,v13
v_fma_f32 v75,v75,s36,v13
v_mfma_f32_16x16x32_bf16 v[80:83],v[128:131],a[168:171],v[80:83]
v_exp_f32 v72,v72
v_mfma_f32_16x16x32_bf16 v[88:91],v[128:131],a[192:195],0
v_exp_f32 v73,v73
v_mfma_f32_16x16x32_bf16 v[88:91],v[132:135],a[196:199],v[88:91]
v_exp_f32 v74,v74
v_mfma_f32_16x16x32_bf16 v[88:91],v[136:139],a[200:203],v[88:91]
v_exp_f32 v75,v75
v_mfma_f32_16x16x32_bf16 v[88:91],v[140:143],a[204:207],v[88:91]
v_fma_f32 v80,v80,s36,v14
v_fma_f32 v81,v81,s36,v14
v_mfma_f32_16x16x32_bf16 v[88:91],v[112:115],a[208:211],v[88:91]
v_fma_f32 v82,v82,s36,v14
v_fma_f32 v83,v83,s36,v14
v_mfma_f32_16x16x32_bf16 v[88:91],v[116:119],a[212:215],v[88:91]
v_exp_f32 v80,v80
v_mfma_f32_16x16x32_bf16 v[96:99],v[116:119],a[236:239],0
v_exp_f32 v81,v81
v_mfma_f32_16x16x32_bf16 v[96:99],v[112:115],a[232:235],v[96:99]
buffer_load_dwordx4 v6,s[4:7],s20 offen offset:0 lds
v_mfma_f32_16x16x32_bf16 v[96:99],v[140:143],a[228:231],v[96:99]
v_exp_f32 v82,v82
v_mfma_f32_16x16x32_bf16 v[96:99],v[136:139],a[224:227],v[96:99]
v_fma_f32 v88,v88,s36,v15
v_fma_f32 v89,v89,s36,v15
v_mfma_f32_16x16x32_bf16 v[96:99],v[132:135],a[220:223],v[96:99]
v_exp_f32 v83,v83
v_mfma_f32_16x16x32_bf16 v[96:99],v[128:131],a[216:219],v[96:99]
v_exp_f32 v88,v88
v_mfma_f32_16x16x32_bf16 v[104:107],v[128:131],a[240:243],0
ds_read_b128 v[128:131],v0 offset:30848
v_cvt_pk_bf16_f32 v20,v72,v73
v_mfma_f32_16x16x32_bf16 v[104:107],v[132:135],a[244:247],v[104:107]
ds_read_b128 v[132:135],v1 offset:30848
v_cvt_pk_bf16_f32 v21,v74,v75
v_mfma_f32_16x16x32_bf16 v[104:107],v[136:139],a[248:251],v[104:107]
ds_read_b128 v[136:139],v0 offset:30976
v_cvt_pk_bf16_f32 v24,v80,v81
v_mfma_f32_16x16x32_bf16 v[104:107],v[140:143],a[252:255],v[104:107]
ds_read_b128 v[140:143],v1 offset:30976
v_cvt_pk_bf16_f32 v25,v82,v83
v_mfma_f32_16x16x32_bf16 v[104:107],v[112:115],v[144:147],v[104:107]
v_exp_f32 v89,v89
v_mfma_f32_16x16x32_bf16 v[104:107],v[116:119],v[148:151],v[104:107]
s_waitcnt lgkmcnt(4)
v_cvt_pk_bf16_f32 v28,v88,v89
v_mfma_f32_16x16x32_bf16 v[76:79],v[120:123],a[144:147],0
v_mfma_f32_16x16x32_bf16 v[76:79],v[124:127],a[148:151],v[76:79]
buffer_load_dwordx4 v7,s[4:7],s20 offen offset:1024 lds
s_waitcnt lgkmcnt(3)
v_mfma_f32_16x16x32_bf16 v[76:79],v[128:131],a[152:155],v[76:79]
s_waitcnt lgkmcnt(2)
v_mfma_f32_16x16x32_bf16 v[76:79],v[132:135],a[156:159],v[76:79]
s_waitcnt lgkmcnt(1)
v_mfma_f32_16x16x32_bf16 v[76:79],v[136:139],a[160:163],v[76:79]
s_waitcnt lgkmcnt(0)
v_mfma_f32_16x16x32_bf16 v[76:79],v[140:143],a[164:167],v[76:79]
v_mfma_f32_16x16x32_bf16 v[84:87],v[140:143],a[188:191],0
v_mfma_f32_16x16x32_bf16 v[84:87],v[136:139],a[184:187],v[84:87]
v_mfma_f32_16x16x32_bf16 v[84:87],v[132:135],a[180:183],v[84:87]
v_mfma_f32_16x16x32_bf16 v[84:87],v[128:131],a[176:179],v[84:87]
v_mfma_f32_16x16x32_bf16 v[84:87],v[124:127],a[172:175],v[84:87]
v_mfma_f32_16x16x32_bf16 v[84:87],v[120:123],a[168:171],v[84:87]
v_mfma_f32_16x16x32_bf16 v[92:95],v[120:123],a[192:195],0
buffer_load_dwordx4 v8,s[4:7],s20 offen offset:2048 lds
v_mfma_f32_16x16x32_bf16 v[92:95],v[124:127],a[196:199],v[92:95]
s_add_u32 s20,s20,12288
v_mfma_f32_16x16x32_bf16 v[92:95],v[128:131],a[200:203],v[92:95]
v_mfma_f32_16x16x32_bf16 v[92:95],v[132:135],a[204:207],v[92:95]
v_mfma_f32_16x16x32_bf16 v[92:95],v[136:139],a[208:211],v[92:95]
v_mfma_f32_16x16x32_bf16 v[92:95],v[140:143],a[212:215],v[92:95]
ds_read_b64_tr_b16 v[112:113],v2 offset:12288
v_mfma_f32_16x16x32_bf16 v[100:103],v[140:143],a[236:239],0
ds_read_b64_tr_b16 v[114:115],v2 offset:18432
v_mfma_f32_16x16x32_bf16 v[100:103],v[136:139],a[232:235],v[100:103]
v_mfma_f32_16x16x32_bf16 v[100:103],v[132:135],a[228:231],v[100:103]
ds_read_b64_tr_b16 v[116:117],v3 offset:12288
v_mfma_f32_16x16x32_bf16 v[100:103],v[128:131],a[224:227],v[100:103]
ds_read_b64_tr_b16 v[118:119],v3 offset:18432
v_mfma_f32_16x16x32_bf16 v[100:103],v[124:127],a[220:223],v[100:103]
v_mfma_f32_16x16x32_bf16 v[100:103],v[120:123],a[216:219],v[100:103]
v_mfma_f32_16x16x32_bf16 v[108:111],v[120:123],a[240:243],0
ds_read_b64_tr_b16 v[120:121],v4 offset:12288
v_mfma_f32_16x16x32_bf16 v[108:111],v[124:127],a[244:247],v[108:111]
ds_read_b64_tr_b16 v[122:123],v4 offset:18432
v_mfma_f32_16x16x32_bf16 v[108:111],v[128:131],a[248:251],v[108:111]
ds_read_b64_tr_b16 v[124:125],v5 offset:12288
v_mfma_f32_16x16x32_bf16 v[108:111],v[132:135],a[252:255],v[108:111]
ds_read_b64_tr_b16 v[126:127],v5 offset:18432
v_mfma_f32_16x16x32_bf16 v[108:111],v[136:139],v[144:147],v[108:111]
v_mfma_f32_16x16x32_bf16 v[108:111],v[140:143],v[148:151],v[108:111]
s_waitcnt lgkmcnt(4)
v_mfma_f32_16x16x32_bf16 v[160:163],v[112:115],v[44:47],v[160:163]
s_add_u32 m0,s23,12288
ds_read_b64_tr_b16 v[128:129],v2 offset:12416
v_fma_f32 v90,v90,s36,v15
v_mfma_f32_16x16x32_bf16 v[164:167],v[116:119],v[44:47],v[164:167]
ds_read_b64_tr_b16 v[130:131],v2 offset:18560
v_fma_f32 v91,v91,s36,v15
v_mfma_f32_16x16x32_bf16 v[212:215],v[116:119],v[48:51],v[212:215]
ds_read_b64_tr_b16 v[132:133],v3 offset:12416
v_fma_f32 v96,v96,s36,v16
v_mfma_f32_16x16x32_bf16 v[208:211],v[112:115],v[48:51],v[208:211]
ds_read_b64_tr_b16 v[134:135],v3 offset:18560
v_fma_f32 v97,v97,s36,v16
v_mfma_f32_16x16x32_bf16 a[0:3],v[112:115],v[52:55],a[0:3]
ds_read_b64_tr_b16 v[136:137],v4 offset:12416
v_fma_f32 v98,v98,s36,v16
v_mfma_f32_16x16x32_bf16 a[4:7],v[116:119],v[52:55],a[4:7]
ds_read_b64_tr_b16 v[138:139],v4 offset:18560
v_fma_f32 v99,v99,s36,v16
v_mfma_f32_16x16x32_bf16 a[52:55],v[116:119],v[56:59],a[52:55]
ds_read_b64_tr_b16 v[140:141],v5 offset:12416
v_fma_f32 v104,v104,s36,v17
v_mfma_f32_16x16x32_bf16 a[48:51],v[112:115],v[56:59],a[48:51]
ds_read_b64_tr_b16 v[142:143],v5 offset:18560
v_fma_f32 v105,v105,s36,v17
v_mfma_f32_16x16x32_bf16 a[96:99],v[112:115],v[40:43],a[96:99]
ds_read_b64_tr_b16 v[112:113],v2 offset:12544
v_fma_f32 v106,v106,s36,v17
v_mfma_f32_16x16x32_bf16 a[100:103],v[116:119],v[40:43],a[100:103]
s_waitcnt lgkmcnt(6)
ds_read_b64_tr_b16 v[114:115],v2 offset:18688
v_fma_f32 v107,v107,s36,v17
v_mfma_f32_16x16x32_bf16 a[104:107],v[120:123],v[40:43],a[104:107]
ds_read_b64_tr_b16 v[116:117],v3 offset:12544
v_fma_f32 v76,v76,s36,v13
v_mfma_f32_16x16x32_bf16 a[108:111],v[124:127],v[40:43],a[108:111]
ds_read_b64_tr_b16 v[118:119],v3 offset:18688
v_fma_f32 v77,v77,s36,v13
v_mfma_f32_16x16x32_bf16 a[60:63],v[124:127],v[56:59],a[60:63]
v_exp_f32 v90,v90
v_mfma_f32_16x16x32_bf16 a[56:59],v[120:123],v[56:59],a[56:59]
v_exp_f32 v91,v91
v_mfma_f32_16x16x32_bf16 a[8:11],v[120:123],v[52:55],a[8:11]
v_cvt_pk_bf16_f32 v29,v90,v91
v_fma_f32 v78,v78,s36,v13
v_mfma_f32_16x16x32_bf16 a[12:15],v[124:127],v[52:55],a[12:15]
v_exp_f32 v96,v96
v_mfma_f32_16x16x32_bf16 v[220:223],v[124:127],v[48:51],v[220:223]
v_exp_f32 v97,v97
v_mfma_f32_16x16x32_bf16 v[216:219],v[120:123],v[48:51],v[216:219]
v_exp_f32 v98,v98
v_mfma_f32_16x16x32_bf16 v[168:171],v[120:123],v[44:47],v[168:171]
ds_read_b64_tr_b16 v[120:121],v4 offset:12544
v_cvt_pk_bf16_f32 v32,v96,v97
v_mfma_f32_16x16x32_bf16 v[172:175],v[124:127],v[44:47],v[172:175]
ds_read_b64_tr_b16 v[122:123],v4 offset:18688
v_fma_f32 v79,v79,s36,v13
v_mfma_f32_16x16x32_bf16 v[176:179],v[128:131],v[44:47],v[176:179]
s_waitcnt lgkmcnt(2)
ds_read_b64_tr_b16 v[124:125],v5 offset:12544
v_fma_f32 v84,v84,s36,v14
v_mfma_f32_16x16x32_bf16 v[180:183],v[132:135],v[44:47],v[180:183]
ds_read_b64_tr_b16 v[126:127],v5 offset:18688
v_fma_f32 v85,v85,s36,v14
v_mfma_f32_16x16x32_bf16 v[228:231],v[132:135],v[48:51],v[228:231]
v_exp_f32 v99,v99
v_mfma_f32_16x16x32_bf16 v[224:227],v[128:131],v[48:51],v[224:227]
v_cvt_pk_bf16_f32 v33,v98,v99
v_fma_f32 v86,v86,s36,v14
v_mfma_f32_16x16x32_bf16 a[16:19],v[128:131],v[52:55],a[16:19]
v_exp_f32 v104,v104
v_mfma_f32_16x16x32_bf16 a[20:23],v[132:135],v[52:55],a[20:23]
v_exp_f32 v105,v105
v_mfma_f32_16x16x32_bf16 a[68:71],v[132:135],v[56:59],a[68:71]
v_exp_f32 v106,v106
v_mfma_f32_16x16x32_bf16 a[64:67],v[128:131],v[56:59],a[64:67]
v_exp_f32 v107,v107
v_mfma_f32_16x16x32_bf16 a[112:115],v[128:131],v[40:43],a[112:115]
v_cvt_pk_bf16_f32 v36,v104,v105
v_cvt_pk_bf16_f32 v37,v106,v107
v_mfma_f32_16x16x32_bf16 a[116:119],v[132:135],v[40:43],a[116:119]
v_exp_f32 v76,v76
v_mfma_f32_16x16x32_bf16 a[120:123],v[136:139],v[40:43],a[120:123]
v_exp_f32 v77,v77
v_mfma_f32_16x16x32_bf16 a[124:127],v[140:143],v[40:43],a[124:127]
v_exp_f32 v78,v78
v_mfma_f32_16x16x32_bf16 a[76:79],v[140:143],v[56:59],a[76:79]
v_exp_f32 v79,v79
v_mfma_f32_16x16x32_bf16 a[72:75],v[136:139],v[56:59],a[72:75]
v_cvt_pk_bf16_f32 v22,v76,v77
v_cvt_pk_bf16_f32 v23,v78,v79
v_mfma_f32_16x16x32_bf16 a[24:27],v[136:139],v[52:55],a[24:27]
v_fma_f32 v87,v87,s36,v14
v_fma_f32 v92,v92,s36,v15
v_mfma_f32_16x16x32_bf16 a[28:31],v[140:143],v[52:55],a[28:31]
v_exp_f32 v84,v84
v_mfma_f32_16x16x32_bf16 v[236:239],v[140:143],v[48:51],v[236:239]
v_exp_f32 v85,v85
v_mfma_f32_16x16x32_bf16 v[232:235],v[136:139],v[48:51],v[232:235]
v_exp_f32 v86,v86
v_mfma_f32_16x16x32_bf16 v[184:187],v[136:139],v[44:47],v[184:187]
v_exp_f32 v87,v87
v_mfma_f32_16x16x32_bf16 v[188:191],v[140:143],v[44:47],v[188:191]
v_cvt_pk_bf16_f32 v26,v84,v85
v_cvt_pk_bf16_f32 v27,v86,v87
v_mfma_f32_16x16x32_bf16 v[192:195],v[112:115],v[44:47],v[192:195]
v_fma_f32 v93,v93,s36,v15
v_fma_f32 v94,v94,s36,v15
v_smfmac_f32_16x16x64_bf16 v[60:63],v[152:155],v[20:27],v18
v_fma_f32 v95,v95,s36,v15
v_mfma_f32_16x16x32_bf16 v[196:199],v[116:119],v[44:47],v[196:199]
s_waitcnt vmcnt(6) lgkmcnt(0)
v_exp_f32 v92,v92
v_mfma_f32_16x16x32_bf16 v[244:247],v[116:119],v[48:51],v[244:247]
s_barrier
v_mfma_f32_16x16x32_bf16 v[240:243],v[112:115],v[48:51],v[240:243]
ds_read_b128 v[128:131],v0 offset:0
v_fma_f32 v100,v100,s36,v16
v_mfma_f32_16x16x32_bf16 a[32:35],v[112:115],v[52:55],a[32:35]
ds_read_b128 v[132:135],v1 offset:0
v_fma_f32 v101,v101,s36,v16
v_mfma_f32_16x16x32_bf16 a[36:39],v[116:119],v[52:55],a[36:39]
ds_read_b128 v[136:139],v0 offset:128
v_fma_f32 v102,v102,s36,v16
v_mfma_f32_16x16x32_bf16 a[84:87],v[116:119],v[56:59],a[84:87]
ds_read_b128 v[140:143],v1 offset:128
v_fma_f32 v103,v103,s36,v16
v_mfma_f32_16x16x32_bf16 a[80:83],v[112:115],v[56:59],a[80:83]
v_exp_f32 v93,v93
v_mfma_f32_16x16x32_bf16 a[128:131],v[112:115],v[40:43],a[128:131]
buffer_load_dwordx4 v6,s[8:11],s21 offen offset:0 lds
v_mfma_f32_16x16x32_bf16 a[132:135],v[116:119],v[40:43],a[132:135]
ds_read_b128 v[112:115],v0 offset:256
v_cvt_pk_bf16_f32 v30,v92,v93
v_mfma_f32_16x16x32_bf16 a[136:139],v[120:123],v[40:43],a[136:139]
ds_read_b128 v[116:119],v1 offset:256
v_fma_f32 v108,v108,s36,v17
v_mfma_f32_16x16x32_bf16 a[140:143],v[124:127],v[40:43],a[140:143]
v_exp_f32 v94,v94
v_mfma_f32_16x16x32_bf16 a[92:95],v[124:127],v[56:59],a[92:95]
v_exp_f32 v95,v95
v_mfma_f32_16x16x32_bf16 a[88:91],v[120:123],v[56:59],a[88:91]
v_cvt_pk_bf16_f32 v31,v94,v95
v_fma_f32 v109,v109,s36,v17
v_mfma_f32_16x16x32_bf16 a[40:43],v[120:123],v[52:55],a[40:43]
v_exp_f32 v100,v100
v_mfma_f32_16x16x32_bf16 a[44:47],v[124:127],v[52:55],a[44:47]
v_exp_f32 v101,v101
v_mfma_f32_16x16x32_bf16 v[252:255],v[124:127],v[48:51],v[252:255]
v_exp_f32 v102,v102
v_mfma_f32_16x16x32_bf16 v[248:251],v[120:123],v[48:51],v[248:251]
v_exp_f32 v103,v103
v_mfma_f32_16x16x32_bf16 v[200:203],v[120:123],v[44:47],v[200:203]
ds_read_b128 v[120:123],v0 offset:6144
v_cvt_pk_bf16_f32 v34,v100,v101
v_mfma_f32_16x16x32_bf16 v[204:207],v[124:127],v[44:47],v[204:207]
buffer_load_dwordx4 v7,s[8:11],s21 offen offset:1024 lds
s_waitcnt lgkmcnt(1)
v_mfma_f32_16x16x32_bf16 v[72:75],v[128:131],a[144:147],0
ds_read_b128 v[124:127],v1 offset:6144
v_cvt_pk_bf16_f32 v35,v102,v103
v_mfma_f32_16x16x32_bf16 v[72:75],v[132:135],a[148:151],v[72:75]
v_fma_f32 v110,v110,s36,v17
v_fma_f32 v111,v111,s36,v17
v_smfmac_f32_16x16x64_bf16 v[64:67],v[152:155],v[28:35],v18
v_mfma_f32_16x16x32_bf16 v[72:75],v[136:139],a[152:155],v[72:75]
v_exp_f32 v108,v108
v_mfma_f32_16x16x32_bf16 v[72:75],v[140:143],a[156:159],v[72:75]
v_exp_f32 v109,v109
v_mfma_f32_16x16x32_bf16 v[72:75],v[112:115],a[160:163],v[72:75]
v_exp_f32 v110,v110
v_mfma_f32_16x16x32_bf16 v[72:75],v[116:119],a[164:167],v[72:75]
v_exp_f32 v111,v111
v_mfma_f32_16x16x32_bf16 v[80:83],v[116:119],a[188:191],0
v_cvt_pk_bf16_f32 v38,v108,v109
v_cvt_pk_bf16_f32 v39,v110,v111
v_mfma_f32_16x16x32_bf16 v[80:83],v[112:115],a[184:187],v[80:83]
v_mfma_f32_16x16x32_bf16 v[80:83],v[140:143],a[180:183],v[80:83]
v_mfma_f32_16x16x32_bf16 v[80:83],v[136:139],a[176:179],v[80:83]
buffer_load_dwordx4 v8,s[8:11],s21 offen offset:2048 lds
v_mfma_f32_16x16x32_bf16 v[80:83],v[132:135],a[172:175],v[80:83]
s_add_u32 s21,s21,12288
v_fma_f32 v72,v72,s36,v13
v_fma_f32 v73,v73,s36,v13
v_mfma_f32_16x16x32_bf16 v[80:83],v[128:131],a[168:171],v[80:83]
s_add_u32 m0,s22,24576
v_fma_f32 v74,v74,s36,v13
v_fma_f32 v75,v75,s36,v13
v_mfma_f32_16x16x32_bf16 v[88:91],v[128:131],a[192:195],0
v_exp_f32 v72,v72
v_mfma_f32_16x16x32_bf16 v[88:91],v[132:135],a[196:199],v[88:91]
v_exp_f32 v73,v73
v_mfma_f32_16x16x32_bf16 v[88:91],v[136:139],a[200:203],v[88:91]
v_fma_f32 v80,v80,s36,v14
v_fma_f32 v81,v81,s36,v14
v_mfma_f32_16x16x32_bf16 v[88:91],v[140:143],a[204:207],v[88:91]
v_fma_f32 v82,v82,s36,v14
v_fma_f32 v83,v83,s36,v14
v_mfma_f32_16x16x32_bf16 v[88:91],v[112:115],a[208:211],v[88:91]
v_exp_f32 v74,v74
v_mfma_f32_16x16x32_bf16 v[88:91],v[116:119],a[212:215],v[88:91]
v_exp_f32 v75,v75
v_mfma_f32_16x16x32_bf16 v[96:99],v[116:119],a[236:239],0
v_exp_f32 v80,v80
v_mfma_f32_16x16x32_bf16 v[96:99],v[112:115],a[232:235],v[96:99]
v_exp_f32 v81,v81
v_mfma_f32_16x16x32_bf16 v[96:99],v[140:143],a[228:231],v[96:99]
v_exp_f32 v82,v82
v_mfma_f32_16x16x32_bf16 v[96:99],v[136:139],a[224:227],v[96:99]
buffer_load_dwordx4 v6,s[4:7],s20 offen offset:0 lds
v_mfma_f32_16x16x32_bf16 v[96:99],v[132:135],a[220:223],v[96:99]
v_fma_f32 v88,v88,s36,v15
v_fma_f32 v89,v89,s36,v15
v_mfma_f32_16x16x32_bf16 v[96:99],v[128:131],a[216:219],v[96:99]
v_exp_f32 v83,v83
v_mfma_f32_16x16x32_bf16 v[104:107],v[128:131],a[240:243],0
ds_read_b128 v[128:131],v0 offset:6272
v_cvt_pk_bf16_f32 v44,v72,v73
v_mfma_f32_16x16x32_bf16 v[104:107],v[132:135],a[244:247],v[104:107]
ds_read_b128 v[132:135],v1 offset:6272
v_cvt_pk_bf16_f32 v45,v74,v75
v_mfma_f32_16x16x32_bf16 v[104:107],v[136:139],a[248:251],v[104:107]
ds_read_b128 v[136:139],v0 offset:6400
v_cvt_pk_bf16_f32 v48,v80,v81
v_mfma_f32_16x16x32_bf16 v[104:107],v[140:143],a[252:255],v[104:107]
ds_read_b128 v[140:143],v1 offset:6400
v_cvt_pk_bf16_f32 v49,v82,v83
v_mfma_f32_16x16x32_bf16 v[104:107],v[112:115],v[144:147],v[104:107]
v_exp_f32 v88,v88
v_mfma_f32_16x16x32_bf16 v[104:107],v[116:119],v[148:151],v[104:107]
s_waitcnt lgkmcnt(4)
v_exp_f32 v89,v89
v_mfma_f32_16x16x32_bf16 v[76:79],v[120:123],a[144:147],0
v_cvt_pk_bf16_f32 v52,v88,v89
v_mfma_f32_16x16x32_bf16 v[76:79],v[124:127],a[148:151],v[76:79]
s_waitcnt lgkmcnt(3)
v_mfma_f32_16x16x32_bf16 v[76:79],v[128:131],a[152:155],v[76:79]
buffer_load_dwordx4 v7,s[4:7],s20 offen offset:1024 lds
s_waitcnt lgkmcnt(2)
v_mfma_f32_16x16x32_bf16 v[76:79],v[132:135],a[156:159],v[76:79]
s_waitcnt lgkmcnt(1)
v_mfma_f32_16x16x32_bf16 v[76:79],v[136:139],a[160:163],v[76:79]
s_waitcnt lgkmcnt(0)
v_mfma_f32_16x16x32_bf16 v[76:79],v[140:143],a[164:167],v[76:79]
v_mfma_f32_16x16x32_bf16 v[84:87],v[140:143],a[188:191],0
v_mfma_f32_16x16x32_bf16 v[84:87],v[136:139],a[184:187],v[84:87]
v_mfma_f32_16x16x32_bf16 v[84:87],v[132:135],a[180:183],v[84:87]
v_mfma_f32_16x16x32_bf16 v[84:87],v[128:131],a[176:179],v[84:87]
v_mfma_f32_16x16x32_bf16 v[84:87],v[124:127],a[172:175],v[84:87]
v_mfma_f32_16x16x32_bf16 v[84:87],v[120:123],a[168:171],v[84:87]
v_mfma_f32_16x16x32_bf16 v[92:95],v[120:123],a[192:195],0
v_mfma_f32_16x16x32_bf16 v[92:95],v[124:127],a[196:199],v[92:95]
buffer_load_dwordx4 v8,s[4:7],s20 offen offset:2048 lds
v_mfma_f32_16x16x32_bf16 v[92:95],v[128:131],a[200:203],v[92:95]
s_add_u32 s20,s20,12288
v_mfma_f32_16x16x32_bf16 v[92:95],v[132:135],a[204:207],v[92:95]
v_mfma_f32_16x16x32_bf16 v[92:95],v[136:139],a[208:211],v[92:95]
v_mfma_f32_16x16x32_bf16 v[92:95],v[140:143],a[212:215],v[92:95]
v_mfma_f32_16x16x32_bf16 v[100:103],v[140:143],a[236:239],0
v_mfma_f32_16x16x32_bf16 v[100:103],v[136:139],a[232:235],v[100:103]
ds_read_b64_tr_b16 v[112:113],v2 offset:24576
v_mfma_f32_16x16x32_bf16 v[100:103],v[132:135],a[228:231],v[100:103]
ds_read_b64_tr_b16 v[114:115],v2 offset:30720
v_mfma_f32_16x16x32_bf16 v[100:103],v[128:131],a[224:227],v[100:103]
ds_read_b64_tr_b16 v[116:117],v3 offset:24576
v_mfma_f32_16x16x32_bf16 v[100:103],v[124:127],a[220:223],v[100:103]
ds_read_b64_tr_b16 v[118:119],v3 offset:30720
v_mfma_f32_16x16x32_bf16 v[100:103],v[120:123],a[216:219],v[100:103]
v_mfma_f32_16x16x32_bf16 v[108:111],v[120:123],a[240:243],0
ds_read_b64_tr_b16 v[120:121],v4 offset:24576
v_mfma_f32_16x16x32_bf16 v[108:111],v[124:127],a[244:247],v[108:111]
ds_read_b64_tr_b16 v[122:123],v4 offset:30720
v_mfma_f32_16x16x32_bf16 v[108:111],v[128:131],a[248:251],v[108:111]
ds_read_b64_tr_b16 v[124:125],v5 offset:24576
v_mfma_f32_16x16x32_bf16 v[108:111],v[132:135],a[252:255],v[108:111]
ds_read_b64_tr_b16 v[126:127],v5 offset:30720
v_mfma_f32_16x16x32_bf16 v[108:111],v[136:139],v[144:147],v[108:111]
v_mfma_f32_16x16x32_bf16 v[108:111],v[140:143],v[148:151],v[108:111]
s_mov_b32 s38,0
s_branch L_loop5
L_loop4:
.p2align 6
L_loop4w0:
s_waitcnt lgkmcnt(3)
v_mfma_f32_16x16x32_bf16 v[160:163],v[112:115],v[20:23],v[160:163]
s_add_u32 m0,s23,24576
ds_read_b64_tr_b16 v[134:135],v3 offset:30848
v_fma_f32 v83,v83,s36,v14
v_mfma_f32_16x16x32_bf16 v[164:167],v[116:119],v[20:23],v[164:167]
ds_read_b64_tr_b16 v[130:131],v2 offset:30848
v_fma_f32 v82,v82,s36,v14
v_mfma_f32_16x16x32_bf16 v[212:215],v[116:119],v[24:27],v[212:215]
ds_read_b64_tr_b16 v[128:129],v2 offset:24704
v_fma_f32 v88,v88,s36,v15
v_mfma_f32_16x16x32_bf16 v[208:211],v[112:115],v[24:27],v[208:211]
ds_read_b64_tr_b16 v[132:133],v3 offset:24704
v_fma_f32 v91,v91,s36,v15
v_mfma_f32_16x16x32_bf16 a[0:3],v[112:115],v[28:31],a[0:3]
ds_read_b64_tr_b16 v[138:139],v4 offset:30848
v_fma_f32 v89,v89,s36,v15
v_mfma_f32_16x16x32_bf16 a[4:7],v[116:119],v[28:31],a[4:7]
ds_read_b64_tr_b16 v[142:143],v5 offset:30848
v_fma_f32 v90,v90,s36,v15
v_mfma_f32_16x16x32_bf16 a[52:55],v[116:119],v[32:35],a[52:55]
ds_read_b64_tr_b16 v[136:137],v4 offset:24704
v_fma_f32 v96,v96,s36,v16
v_mfma_f32_16x16x32_bf16 a[48:51],v[112:115],v[32:35],a[48:51]
s_waitcnt lgkmcnt(6)
ds_read_b64_tr_b16 v[140:141],v5 offset:24704
v_fma_f32 v98,v98,s36,v16
v_mfma_f32_16x16x32_bf16 a[56:59],v[120:123],v[32:35],a[56:59]
ds_read_b64_tr_b16 v[112:113],v2 offset:24832
v_fma_f32 v99,v99,s36,v16
v_mfma_f32_16x16x32_bf16 a[60:63],v[124:127],v[32:35],a[60:63]
ds_read_b64_tr_b16 v[118:119],v3 offset:30976
v_fma_f32 v97,v97,s36,v16
v_mfma_f32_16x16x32_bf16 a[12:15],v[124:127],v[28:31],a[12:15]
ds_read_b64_tr_b16 v[114:115],v2 offset:30976
v_fma_f32 v79,v79,s36,v13
v_mfma_f32_16x16x32_bf16 a[8:11],v[120:123],v[28:31],a[8:11]
ds_read_b64_tr_b16 v[116:117],v3 offset:24832
v_fma_f32 v77,v77,s36,v13
v_mfma_f32_16x16x32_bf16 v[216:219],v[120:123],v[24:27],v[216:219]
v_exp_f32 v82,v82
v_mfma_f32_16x16x32_bf16 v[220:223],v[124:127],v[24:27],v[220:223]
v_exp_f32 v83,v83
v_mfma_f32_16x16x32_bf16 v[172:175],v[124:127],v[20:23],v[172:175]
ds_read_b64_tr_b16 v[124:125],v5 offset:24832
v_cvt_pk_bf16_f32 v49,v82,v83
v_mfma_f32_16x16x32_bf16 v[168:171],v[120:123],v[20:23],v[168:171]
s_waitcnt lgkmcnt(4)
ds_read_b64_tr_b16 v[126:127],v5 offset:30976
v_fma_f32 v76,v76,s36,v13
v_mfma_f32_16x16x32_bf16 v[176:179],v[128:131],v[20:23],v[176:179]
ds_read_b64_tr_b16 v[120:121],v4 offset:24832
v_fma_f32 v78,v78,s36,v13
v_mfma_f32_16x16x32_bf16 v[180:183],v[132:135],v[20:23],v[180:183]
ds_read_b64_tr_b16 v[122:123],v4 offset:30976
v_fma_f32 v86,v86,s36,v14
v_mfma_f32_16x16x32_bf16 v[228:231],v[132:135],v[24:27],v[228:231]
v_exp_f32 v90,v90
v_mfma_f32_16x16x32_bf16 v[224:227],v[128:131],v[24:27],v[224:227]
v_exp_f32 v88,v88
v_mfma_f32_16x16x32_bf16 a[16:19],v[128:131],v[28:31],a[16:19]
v_exp_f32 v89,v89
v_mfma_f32_16x16x32_bf16 a[20:23],v[132:135],v[28:31],a[20:23]
v_cvt_pk_bf16_f32 v52,v88,v89
v_fma_f32 v84,v84,s36,v14
v_mfma_f32_16x16x32_bf16 a[68:71],v[132:135],v[32:35],a[68:71]
v_exp_f32 v91,v91
v_mfma_f32_16x16x32_bf16 a[64:67],v[128:131],v[32:35],a[64:67]
v_cvt_pk_bf16_f32 v53,v90,v91
v_fma_f32 v85,v85,s36,v14
v_mfma_f32_16x16x32_bf16 a[72:75],v[136:139],v[32:35],a[72:75]
v_exp_f32 v99,v99
v_mfma_f32_16x16x32_bf16 a[76:79],v[140:143],v[32:35],a[76:79]
v_exp_f32 v97,v97
v_mfma_f32_16x16x32_bf16 a[28:31],v[140:143],v[28:31],a[28:31]
v_exp_f32 v96,v96
v_mfma_f32_16x16x32_bf16 a[24:27],v[136:139],v[28:31],a[24:27]
v_cvt_pk_bf16_f32 v56,v96,v97
v_fma_f32 v87,v87,s36,v14
v_mfma_f32_16x16x32_bf16 v[232:235],v[136:139],v[24:27],v[232:235]
v_exp_f32 v98,v98
v_mfma_f32_16x16x32_bf16 v[236:239],v[140:143],v[24:27],v[236:239]
v_cvt_pk_bf16_f32 v57,v98,v99
v_fma_f32 v94,v94,s36,v15
v_mfma_f32_16x16x32_bf16 v[188:191],v[140:143],v[20:23],v[188:191]
v_exp_f32 v76,v76
v_mfma_f32_16x16x32_bf16 v[184:187],v[136:139],v[20:23],v[184:187]
s_waitcnt lgkmcnt(0)
v_exp_f32 v79,v79
v_mfma_f32_16x16x32_bf16 v[192:195],v[112:115],v[20:23],v[192:195]
v_exp_f32 v78,v78
v_mfma_f32_16x16x32_bf16 v[196:199],v[116:119],v[20:23],v[196:199]
s_waitcnt vmcnt(6)
ds_read_b128 v[156:159],v10 offset:0
v_cvt_pk_bf16_f32 v47,v78,v79
v_mfma_f32_16x16x32_bf16 v[244:247],v[116:119],v[24:27],v[244:247]
s_barrier
v_mfma_f32_16x16x32_bf16 v[240:243],v[112:115],v[24:27],v[240:243]
ds_read_b128 v[140:143],v1 offset:12416
v_fma_f32 v92,v92,s36,v15
v_mfma_f32_16x16x32_bf16 a[32:35],v[112:115],v[28:31],a[32:35]
ds_read_b128 v[136:139],v0 offset:12416
v_fma_f32 v93,v93,s36,v15
v_mfma_f32_16x16x32_bf16 a[36:39],v[116:119],v[28:31],a[36:39]
ds_read_b128 v[132:135],v1 offset:12288
v_fma_f32 v95,v95,s36,v15
v_mfma_f32_16x16x32_bf16 a[84:87],v[116:119],v[32:35],a[84:87]
ds_read_b128 v[116:119],v1 offset:12544
v_fma_f32 v102,v102,s36,v16
v_mfma_f32_16x16x32_bf16 a[80:83],v[112:115],v[32:35],a[80:83]
ds_read_b128 v[112:115],v0 offset:12544
v_fma_f32 v100,v100,s36,v16
v_mfma_f32_16x16x32_bf16 a[88:91],v[120:123],v[32:35],a[88:91]
buffer_load_dwordx4 v6,s[8:11],s21 offen offset:0 lds
v_mfma_f32_16x16x32_bf16 a[92:95],v[124:127],v[32:35],a[92:95]
ds_read_b128 v[128:131],v0 offset:12288
v_fma_f32 v101,v101,s36,v16
v_mfma_f32_16x16x32_bf16 a[44:47],v[124:127],v[28:31],a[44:47]
v_exp_f32 v77,v77
v_mfma_f32_16x16x32_bf16 a[40:43],v[120:123],v[28:31],a[40:43]
v_cvt_pk_bf16_f32 v46,v76,v77
v_fma_f32 v103,v103,s36,v16
v_mfma_f32_16x16x32_bf16 v[248:251],v[120:123],v[24:27],v[248:251]
v_exp_f32 v86,v86
v_mfma_f32_16x16x32_bf16 v[252:255],v[124:127],v[24:27],v[252:255]
v_exp_f32 v87,v87
v_mfma_f32_16x16x32_bf16 v[204:207],v[124:127],v[20:23],v[204:207]
ds_read_b128 v[124:127],v1 offset:18432
v_cvt_pk_bf16_f32 v51,v86,v87
v_mfma_f32_16x16x32_bf16 v[200:203],v[120:123],v[20:23],v[200:203]
s_waitcnt lgkmcnt(2)
ds_read_b128 v[120:123],v0 offset:18432
v_mfma_f32_16x16x32_bf16 v[72:75],v[116:119],a[164:167],0
v_exp_f32 v85,v85
v_mfma_f32_16x16x32_bf16 v[72:75],v[112:115],a[160:163],v[72:75]
buffer_store_dwordx4 v[156:159],v9,s[16:19],s27 offen offset:0 nt
buffer_load_dwordx4 v7,s[8:11],s21 offen offset:1024 lds
v_mfma_f32_16x16x32_bf16 v[72:75],v[140:143],a[156:159],v[72:75]
ds_read_b128 v[156:159],v10 offset:1024
v_mfma_f32_16x16x32_bf16 v[72:75],v[136:139],a[152:155],v[72:75]
v_exp_f32 v84,v84
v_mfma_f32_16x16x32_bf16 v[72:75],v[132:135],a[148:151],v[72:75]
s_waitcnt lgkmcnt(3)
v_cvt_pk_bf16_f32 v50,v84,v85
v_mfma_f32_16x16x32_bf16 v[72:75],v[128:131],a[144:147],v[72:75]
v_exp_f32 v93,v93
v_smfmac_f32_16x16x64_bf16 v[60:63],v[152:155],v[44:51],v18
v_mfma_f32_16x16x32_bf16 v[80:83],v[128:131],a[168:171],0
v_exp_f32 v94,v94
v_mfma_f32_16x16x32_bf16 v[80:83],v[132:135],a[172:175],v[80:83]
v_exp_f32 v92,v92
v_mfma_f32_16x16x32_bf16 v[80:83],v[136:139],a[176:179],v[80:83]
buffer_load_dwordx4 v8,s[8:11],s21 offen offset:2048 lds
v_mfma_f32_16x16x32_bf16 v[80:83],v[140:143],a[180:183],v[80:83]
s_add_u32 s21,s21,12288
v_cvt_pk_bf16_f32 v54,v92,v93
v_fma_f32 v72,v72,s36,v13
v_mfma_f32_16x16x32_bf16 v[80:83],v[112:115],a[184:187],v[80:83]
s_add_u32 m0,s22,0
v_exp_f32 v95,v95
v_mfma_f32_16x16x32_bf16 v[80:83],v[116:119],a[188:191],v[80:83]
v_cvt_pk_bf16_f32 v55,v94,v95
v_fma_f32 v75,v75,s36,v13
v_mfma_f32_16x16x32_bf16 v[88:91],v[116:119],a[212:215],0
v_exp_f32 v103,v103
v_mfma_f32_16x16x32_bf16 v[88:91],v[112:115],a[208:211],v[88:91]
v_exp_f32 v100,v100
v_mfma_f32_16x16x32_bf16 v[88:91],v[140:143],a[204:207],v[88:91]
v_exp_f32 v102,v102
v_mfma_f32_16x16x32_bf16 v[88:91],v[136:139],a[200:203],v[88:91]
v_cvt_pk_bf16_f32 v59,v102,v103
v_fma_f32 v80,v80,s36,v14
v_mfma_f32_16x16x32_bf16 v[88:91],v[132:135],a[196:199],v[88:91]
v_exp_f32 v101,v101
v_mfma_f32_16x16x32_bf16 v[88:91],v[128:131],a[192:195],v[88:91]
s_waitcnt lgkmcnt(0)
buffer_store_dwordx4 v[156:159],v9,s[16:19],s27 offen offset:128 nt
buffer_load_dwordx4 v6,s[4:7],s20 offen offset:0 lds
v_mfma_f32_16x16x32_bf16 v[96:99],v[128:131],a[216:219],0
ds_read_b128 v[156:159],v10 offset:2048
v_cvt_pk_bf16_f32 v58,v100,v101
v_mfma_f32_16x16x32_bf16 v[96:99],v[132:135],a[220:223],v[96:99]
ds_read_b128 v[128:131],v0 offset:18560
v_fma_f32 v81,v81,s36,v14
v_smfmac_f32_16x16x64_bf16 v[64:67],v[152:155],v[52:59],v18
ds_read_b128 v[132:135],v1 offset:18560
v_mfma_f32_16x16x32_bf16 v[96:99],v[136:139],a[224:227],v[96:99]
ds_read_b128 v[136:139],v0 offset:18688
v_mfma_f32_16x16x32_bf16 v[96:99],v[140:143],a[228:231],v[96:99]
ds_read_b128 v[140:143],v1 offset:18688
v_mfma_f32_16x16x32_bf16 v[96:99],v[112:115],a[232:235],v[96:99]
v_fma_f32 v73,v73,s36,v13
v_fma_f32 v74,v74,s36,v13
v_mfma_f32_16x16x32_bf16 v[96:99],v[116:119],a[236:239],v[96:99]
v_exp_f32 v74,v74
v_mfma_f32_16x16x32_bf16 v[76:79],v[120:123],a[144:147],0
buffer_load_dwordx4 v7,s[4:7],s20 offen offset:1024 lds
v_mfma_f32_16x16x32_bf16 v[76:79],v[124:127],a[148:151],v[76:79]
s_waitcnt lgkmcnt(3)
v_exp_f32 v75,v75
v_mfma_f32_16x16x32_bf16 v[76:79],v[128:131],a[152:155],v[76:79]
s_waitcnt lgkmcnt(2)
v_cvt_pk_bf16_f32 v21,v74,v75
v_mfma_f32_16x16x32_bf16 v[76:79],v[132:135],a[156:159],v[76:79]
s_waitcnt lgkmcnt(1)
v_exp_f32 v73,v73
v_mfma_f32_16x16x32_bf16 v[76:79],v[136:139],a[160:163],v[76:79]
s_waitcnt lgkmcnt(0)
v_exp_f32 v80,v80
v_mfma_f32_16x16x32_bf16 v[76:79],v[140:143],a[164:167],v[76:79]
v_exp_f32 v81,v81
v_mfma_f32_16x16x32_bf16 v[84:87],v[140:143],a[188:191],0
v_cvt_pk_bf16_f32 v24,v80,v81
v_mfma_f32_16x16x32_bf16 v[84:87],v[136:139],a[184:187],v[84:87]
v_exp_f32 v72,v72
v_mfma_f32_16x16x32_bf16 v[84:87],v[132:135],a[180:183],v[84:87]
v_cvt_pk_bf16_f32 v20,v72,v73
v_mfma_f32_16x16x32_bf16 v[84:87],v[128:131],a[176:179],v[84:87]
buffer_store_dwordx4 v[156:159],v9,s[16:19],s27 offen offset:256 nt
buffer_load_dwordx4 v8,s[4:7],s20 offen offset:2048 lds
v_mfma_f32_16x16x32_bf16 v[84:87],v[124:127],a[172:175],v[84:87]
s_add_u32 s20,s20,12288
ds_read_b64_tr_b16 v[114:115],v2 offset:6144
v_mfma_f32_16x16x32_bf16 v[84:87],v[120:123],a[168:171],v[84:87]
s_add_u32 s27,s27,3072
ds_read_b64_tr_b16 v[112:113],v2 offset:0
v_mfma_f32_16x16x32_bf16 v[92:95],v[120:123],a[192:195],0
ds_read_b64_tr_b16 v[116:117],v3 offset:0
v_mfma_f32_16x16x32_bf16 v[92:95],v[124:127],a[196:199],v[92:95]
ds_read_b64_tr_b16 v[118:119],v3 offset:6144
v_mfma_f32_16x16x32_bf16 v[92:95],v[128:131],a[200:203],v[92:95]
v_mfma_f32_16x16x32_bf16 v[92:95],v[132:135],a[204:207],v[92:95]
v_mfma_f32_16x16x32_bf16 v[92:95],v[136:139],a[208:211],v[92:95]
v_mfma_f32_16x16x32_bf16 v[92:95],v[140:143],a[212:215],v[92:95]
v_mfma_f32_16x16x32_bf16 v[100:103],v[140:143],a[236:239],0
v_mfma_f32_16x16x32_bf16 v[100:103],v[136:139],a[232:235],v[100:103]
v_mfma_f32_16x16x32_bf16 v[100:103],v[132:135],a[228:231],v[100:103]
v_mfma_f32_16x16x32_bf16 v[100:103],v[128:131],a[224:227],v[100:103]
v_mfma_f32_16x16x32_bf16 v[100:103],v[124:127],a[220:223],v[100:103]
ds_read_b64_tr_b16 v[126:127],v5 offset:6144
v_mfma_f32_16x16x32_bf16 v[100:103],v[120:123],a[216:219],v[100:103]
s_waitcnt lgkmcnt(1)
ds_read_b64_tr_b16 v[120:121],v4 offset:0
ds_read_b64_tr_b16 v[122:123],v4 offset:6144
ds_read_b64_tr_b16 v[124:125],v5 offset:0
v_mfma_f32_16x16x32_bf16 v[160:163],v[112:115],v[44:47],v[160:163]
s_add_u32 m0,s29,0
ds_read_b64_tr_b16 v[128:129],v2 offset:128
v_fma_f32 v82,v82,s36,v14
v_mfma_f32_16x16x32_bf16 v[164:167],v[116:119],v[44:47],v[164:167]
ds_read_b64_tr_b16 v[130:131],v2 offset:6272
v_fma_f32 v83,v83,s36,v14
v_mfma_f32_16x16x32_bf16 v[212:215],v[116:119],v[48:51],v[212:215]
ds_read_b64_tr_b16 v[132:133],v3 offset:128
v_fma_f32 v88,v88,s36,v15
v_mfma_f32_16x16x32_bf16 v[208:211],v[112:115],v[48:51],v[208:211]
ds_read_b64_tr_b16 v[134:135],v3 offset:6272
v_fma_f32 v89,v89,s36,v15
v_mfma_f32_16x16x32_bf16 a[0:3],v[112:115],v[52:55],a[0:3]
ds_read_b64_tr_b16 v[136:137],v4 offset:128
v_fma_f32 v90,v90,s36,v15
v_mfma_f32_16x16x32_bf16 a[4:7],v[116:119],v[52:55],a[4:7]
ds_read_b64_tr_b16 v[138:139],v4 offset:6272
v_fma_f32 v91,v91,s36,v15
v_mfma_f32_16x16x32_bf16 a[52:55],v[116:119],v[56:59],a[52:55]
buffer_load_dwordx4 v6,s[12:15],s28 offen offset:0 nt lds
v_mfma_f32_16x16x32_bf16 a[48:51],v[112:115],v[56:59],a[48:51]
s_waitcnt lgkmcnt(5)
ds_read_b64_tr_b16 v[140:141],v5 offset:128
v_fma_f32 v96,v96,s36,v16
v_mfma_f32_16x16x32_bf16 a[56:59],v[120:123],v[56:59],a[56:59]
ds_read_b64_tr_b16 v[142:143],v5 offset:6272
v_fma_f32 v97,v97,s36,v16
v_mfma_f32_16x16x32_bf16 a[60:63],v[124:127],v[56:59],a[60:63]
ds_read_b64_tr_b16 v[112:113],v2 offset:256
v_fma_f32 v98,v98,s36,v16
v_mfma_f32_16x16x32_bf16 a[12:15],v[124:127],v[52:55],a[12:15]
ds_read_b64_tr_b16 v[114:115],v2 offset:6400
v_fma_f32 v99,v99,s36,v16
v_mfma_f32_16x16x32_bf16 a[8:11],v[120:123],v[52:55],a[8:11]
ds_read_b64_tr_b16 v[116:117],v3 offset:256
v_fma_f32 v76,v76,s36,v13
v_mfma_f32_16x16x32_bf16 v[216:219],v[120:123],v[48:51],v[216:219]
ds_read_b64_tr_b16 v[118:119],v3 offset:6400
v_fma_f32 v77,v77,s36,v13
v_mfma_f32_16x16x32_bf16 v[220:223],v[124:127],v[48:51],v[220:223]
buffer_load_dwordx4 v7,s[12:15],s28 offen offset:1024 nt lds
v_mfma_f32_16x16x32_bf16 v[172:175],v[124:127],v[44:47],v[172:175]
ds_read_b64_tr_b16 v[124:125],v5 offset:256
v_fma_f32 v78,v78,s36,v13
v_mfma_f32_16x16x32_bf16 v[168:171],v[120:123],v[44:47],v[168:171]
s_waitcnt lgkmcnt(5)
ds_read_b64_tr_b16 v[120:121],v4 offset:256
v_fma_f32 v79,v79,s36,v13
v_mfma_f32_16x16x32_bf16 v[176:179],v[128:131],v[44:47],v[176:179]
ds_read_b64_tr_b16 v[122:123],v4 offset:6400
v_fma_f32 v84,v84,s36,v14
v_mfma_f32_16x16x32_bf16 v[180:183],v[132:135],v[44:47],v[180:183]
ds_read_b64_tr_b16 v[126:127],v5 offset:6400
v_fma_f32 v85,v85,s36,v14
v_mfma_f32_16x16x32_bf16 v[228:231],v[132:135],v[48:51],v[228:231]
v_exp_f32 v82,v82
v_mfma_f32_16x16x32_bf16 v[224:227],v[128:131],v[48:51],v[224:227]
v_exp_f32 v83,v83
v_mfma_f32_16x16x32_bf16 a[16:19],v[128:131],v[52:55],a[16:19]
v_cvt_pk_bf16_f32 v25,v82,v83
v_fma_f32 v86,v86,s36,v14
v_mfma_f32_16x16x32_bf16 a[20:23],v[132:135],v[52:55],a[20:23]
buffer_load_dwordx4 v8,s[12:15],s28 offen offset:2048 nt lds
v_mfma_f32_16x16x32_bf16 a[68:71],v[132:135],v[56:59],a[68:71]
s_add_u32 s28,s28,3072
v_exp_f32 v88,v88
v_mfma_f32_16x16x32_bf16 a[64:67],v[128:131],v[56:59],a[64:67]
s_add_u32 s29,s29,3072
v_exp_f32 v89,v89
v_mfma_f32_16x16x32_bf16 a[72:75],v[136:139],v[56:59],a[72:75]
s_add_u32 m0,s23,0
v_exp_f32 v90,v90
v_mfma_f32_16x16x32_bf16 a[76:79],v[140:143],v[56:59],a[76:79]
v_exp_f32 v91,v91
v_mfma_f32_16x16x32_bf16 a[28:31],v[140:143],v[52:55],a[28:31]
v_cvt_pk_bf16_f32 v28,v88,v89
v_cvt_pk_bf16_f32 v29,v90,v91
v_mfma_f32_16x16x32_bf16 a[24:27],v[136:139],v[52:55],a[24:27]
v_exp_f32 v96,v96
v_mfma_f32_16x16x32_bf16 v[232:235],v[136:139],v[48:51],v[232:235]
v_exp_f32 v97,v97
v_mfma_f32_16x16x32_bf16 v[236:239],v[140:143],v[48:51],v[236:239]
v_exp_f32 v98,v98
v_mfma_f32_16x16x32_bf16 v[188:191],v[140:143],v[44:47],v[188:191]
v_exp_f32 v99,v99
v_mfma_f32_16x16x32_bf16 v[184:187],v[136:139],v[44:47],v[184:187]
s_waitcnt lgkmcnt(0)
v_cvt_pk_bf16_f32 v32,v96,v97
v_cvt_pk_bf16_f32 v33,v98,v99
v_mfma_f32_16x16x32_bf16 v[192:195],v[112:115],v[44:47],v[192:195]
s_waitcnt vmcnt(12)
v_exp_f32 v76,v76
v_mfma_f32_16x16x32_bf16 v[196:199],v[116:119],v[44:47],v[196:199]
s_barrier
v_mfma_f32_16x16x32_bf16 v[244:247],v[116:119],v[48:51],v[244:247]
ds_read_b128 v[140:143],v1 offset:24704
v_fma_f32 v87,v87,s36,v14
v_mfma_f32_16x16x32_bf16 v[240:243],v[112:115],v[48:51],v[240:243]
ds_read_b128 v[136:139],v0 offset:24704
v_fma_f32 v92,v92,s36,v15
v_mfma_f32_16x16x32_bf16 a[32:35],v[112:115],v[52:55],a[32:35]
ds_read_b128 v[132:135],v1 offset:24576
v_fma_f32 v93,v93,s36,v15
v_mfma_f32_16x16x32_bf16 a[36:39],v[116:119],v[52:55],a[36:39]
ds_read_b128 v[128:131],v0 offset:24576
v_fma_f32 v94,v94,s36,v15
v_mfma_f32_16x16x32_bf16 a[84:87],v[116:119],v[56:59],a[84:87]
ds_read_b128 v[116:119],v1 offset:24832
v_fma_f32 v95,v95,s36,v15
v_mfma_f32_16x16x32_bf16 a[80:83],v[112:115],v[56:59],a[80:83]
buffer_load_dwordx4 v6,s[8:11],s21 offen offset:0 lds
v_mfma_f32_16x16x32_bf16 a[88:91],v[120:123],v[56:59],a[88:91]
ds_read_b128 v[112:115],v0 offset:24832
v_fma_f32 v100,v100,s36,v16
v_mfma_f32_16x16x32_bf16 a[92:95],v[124:127],v[56:59],a[92:95]
v_exp_f32 v77,v77
v_mfma_f32_16x16x32_bf16 a[44:47],v[124:127],v[52:55],a[44:47]
v_exp_f32 v78,v78
v_mfma_f32_16x16x32_bf16 a[40:43],v[120:123],v[52:55],a[40:43]
v_exp_f32 v79,v79
v_mfma_f32_16x16x32_bf16 v[248:251],v[120:123],v[48:51],v[248:251]
v_cvt_pk_bf16_f32 v22,v76,v77
v_cvt_pk_bf16_f32 v23,v78,v79
v_mfma_f32_16x16x32_bf16 v[252:255],v[124:127],v[48:51],v[252:255]
v_exp_f32 v84,v84
v_mfma_f32_16x16x32_bf16 v[204:207],v[124:127],v[44:47],v[204:207]
ds_read_b128 v[124:127],v1 offset:30720
v_fma_f32 v101,v101,s36,v16
v_mfma_f32_16x16x32_bf16 v[200:203],v[120:123],v[44:47],v[200:203]
s_waitcnt lgkmcnt(1)
ds_read_b128 v[120:123],v0 offset:30720
v_fma_f32 v102,v102,s36,v16
v_mfma_f32_16x16x32_bf16 v[72:75],v[116:119],a[164:167],0
buffer_load_dwordx4 v7,s[8:11],s21 offen offset:1024 lds
v_mfma_f32_16x16x32_bf16 v[72:75],v[112:115],a[160:163],v[72:75]
v_exp_f32 v85,v85
v_mfma_f32_16x16x32_bf16 v[72:75],v[140:143],a[156:159],v[72:75]
v_exp_f32 v86,v86
v_mfma_f32_16x16x32_bf16 v[72:75],v[136:139],a[152:155],v[72:75]
v_exp_f32 v87,v87
v_mfma_f32_16x16x32_bf16 v[72:75],v[132:135],a[148:151],v[72:75]
v_cvt_pk_bf16_f32 v26,v84,v85
v_cvt_pk_bf16_f32 v27,v86,v87
v_mfma_f32_16x16x32_bf16 v[72:75],v[128:131],a[144:147],v[72:75]
v_exp_f32 v92,v92
v_smfmac_f32_16x16x64_bf16 v[60:63],v[152:155],v[20:27],v18
v_fma_f32 v103,v103,s36,v16
v_mfma_f32_16x16x32_bf16 v[80:83],v[128:131],a[168:171],0
v_exp_f32 v93,v93
v_mfma_f32_16x16x32_bf16 v[80:83],v[132:135],a[172:175],v[80:83]
buffer_load_dwordx4 v8,s[8:11],s21 offen offset:2048 lds
v_mfma_f32_16x16x32_bf16 v[80:83],v[136:139],a[176:179],v[80:83]
s_add_u32 s21,s21,12288
v_exp_f32 v94,v94
v_mfma_f32_16x16x32_bf16 v[80:83],v[140:143],a[180:183],v[80:83]
s_add_u32 m0,s22,12288
v_exp_f32 v95,v95
v_mfma_f32_16x16x32_bf16 v[80:83],v[112:115],a[184:187],v[80:83]
v_cvt_pk_bf16_f32 v30,v92,v93
v_cvt_pk_bf16_f32 v31,v94,v95
v_mfma_f32_16x16x32_bf16 v[80:83],v[116:119],a[188:191],v[80:83]
v_exp_f32 v100,v100
v_mfma_f32_16x16x32_bf16 v[88:91],v[116:119],a[212:215],0
v_exp_f32 v101,v101
v_mfma_f32_16x16x32_bf16 v[88:91],v[112:115],a[208:211],v[88:91]
v_exp_f32 v102,v102
v_mfma_f32_16x16x32_bf16 v[88:91],v[140:143],a[204:207],v[88:91]
v_exp_f32 v103,v103
v_mfma_f32_16x16x32_bf16 v[88:91],v[136:139],a[200:203],v[88:91]
v_cvt_pk_bf16_f32 v34,v100,v101
v_cvt_pk_bf16_f32 v35,v102,v103
v_mfma_f32_16x16x32_bf16 v[88:91],v[132:135],a[196:199],v[88:91]
buffer_load_dwordx4 v6,s[4:7],s20 offen offset:0 lds
v_smfmac_f32_16x16x64_bf16 v[64:67],v[152:155],v[28:35],v18
v_fma_f32 v72,v72,s36,v13
v_mfma_f32_16x16x32_bf16 v[88:91],v[128:131],a[192:195],v[88:91]
v_fma_f32 v73,v73,s36,v13
v_fma_f32 v74,v74,s36,v13
v_mfma_f32_16x16x32_bf16 v[96:99],v[128:131],a[216:219],0
ds_read_b128 v[128:131],v0 offset:30848
v_fma_f32 v75,v75,s36,v13
v_mfma_f32_16x16x32_bf16 v[96:99],v[132:135],a[220:223],v[96:99]
ds_read_b128 v[132:135],v1 offset:30848
v_fma_f32 v80,v80,s36,v14
v_mfma_f32_16x16x32_bf16 v[96:99],v[136:139],a[224:227],v[96:99]
ds_read_b128 v[136:139],v0 offset:30976
v_fma_f32 v81,v81,s36,v14
v_mfma_f32_16x16x32_bf16 v[96:99],v[140:143],a[228:231],v[96:99]
ds_read_b128 v[140:143],v1 offset:30976
v_mfma_f32_16x16x32_bf16 v[96:99],v[112:115],a[232:235],v[96:99]
v_exp_f32 v72,v72
v_mfma_f32_16x16x32_bf16 v[96:99],v[116:119],a[236:239],v[96:99]
s_waitcnt lgkmcnt(4)
v_exp_f32 v73,v73
v_mfma_f32_16x16x32_bf16 v[76:79],v[120:123],a[144:147],0
buffer_load_dwordx4 v7,s[4:7],s20 offen offset:1024 lds
v_mfma_f32_16x16x32_bf16 v[76:79],v[124:127],a[148:151],v[76:79]
s_waitcnt lgkmcnt(3)
v_exp_f32 v74,v74
v_mfma_f32_16x16x32_bf16 v[76:79],v[128:131],a[152:155],v[76:79]
s_waitcnt lgkmcnt(2)
v_exp_f32 v75,v75
v_mfma_f32_16x16x32_bf16 v[76:79],v[132:135],a[156:159],v[76:79]
s_waitcnt lgkmcnt(0)
v_exp_f32 v80,v80
v_mfma_f32_16x16x32_bf16 v[76:79],v[136:139],a[160:163],v[76:79]
v_exp_f32 v81,v81
v_mfma_f32_16x16x32_bf16 v[76:79],v[140:143],a[164:167],v[76:79]
v_cvt_pk_bf16_f32 v44,v72,v73
v_cvt_pk_bf16_f32 v45,v74,v75
v_mfma_f32_16x16x32_bf16 v[84:87],v[140:143],a[188:191],0
v_cvt_pk_bf16_f32 v48,v80,v81
v_mfma_f32_16x16x32_bf16 v[84:87],v[136:139],a[184:187],v[84:87]
v_mfma_f32_16x16x32_bf16 v[84:87],v[132:135],a[180:183],v[84:87]
v_mfma_f32_16x16x32_bf16 v[84:87],v[128:131],a[176:179],v[84:87]
buffer_load_dwordx4 v8,s[4:7],s20 offen offset:2048 lds
v_mfma_f32_16x16x32_bf16 v[84:87],v[124:127],a[172:175],v[84:87]
s_add_u32 s20,s20,12288
v_mfma_f32_16x16x32_bf16 v[84:87],v[120:123],a[168:171],v[84:87]
ds_read_b64_tr_b16 v[112:113],v2 offset:12288
v_mfma_f32_16x16x32_bf16 v[92:95],v[120:123],a[192:195],0
ds_read_b64_tr_b16 v[114:115],v2 offset:18432
v_mfma_f32_16x16x32_bf16 v[92:95],v[124:127],a[196:199],v[92:95]
ds_read_b64_tr_b16 v[116:117],v3 offset:12288
v_mfma_f32_16x16x32_bf16 v[92:95],v[128:131],a[200:203],v[92:95]
ds_read_b64_tr_b16 v[118:119],v3 offset:18432
v_mfma_f32_16x16x32_bf16 v[92:95],v[132:135],a[204:207],v[92:95]
v_mfma_f32_16x16x32_bf16 v[92:95],v[136:139],a[208:211],v[92:95]
v_mfma_f32_16x16x32_bf16 v[92:95],v[140:143],a[212:215],v[92:95]
v_mfma_f32_16x16x32_bf16 v[100:103],v[140:143],a[236:239],0
v_mfma_f32_16x16x32_bf16 v[100:103],v[136:139],a[232:235],v[100:103]
v_mfma_f32_16x16x32_bf16 v[100:103],v[132:135],a[228:231],v[100:103]
v_mfma_f32_16x16x32_bf16 v[100:103],v[128:131],a[224:227],v[100:103]
v_mfma_f32_16x16x32_bf16 v[100:103],v[124:127],a[220:223],v[100:103]
ds_read_b64_tr_b16 v[124:125],v5 offset:12288
v_mfma_f32_16x16x32_bf16 v[100:103],v[120:123],a[216:219],v[100:103]
s_waitcnt lgkmcnt(1)
ds_read_b64_tr_b16 v[120:121],v4 offset:12288
ds_read_b64_tr_b16 v[122:123],v4 offset:18432
ds_read_b64_tr_b16 v[126:127],v5 offset:18432
v_mfma_f32_16x16x32_bf16 v[160:163],v[112:115],v[20:23],v[160:163]
s_add_u32 m0,s23,12288
ds_read_b64_tr_b16 v[134:135],v3 offset:18560
v_fma_f32 v83,v83,s36,v14
v_mfma_f32_16x16x32_bf16 v[164:167],v[116:119],v[20:23],v[164:167]
ds_read_b64_tr_b16 v[130:131],v2 offset:18560
v_fma_f32 v82,v82,s36,v14
v_mfma_f32_16x16x32_bf16 v[212:215],v[116:119],v[24:27],v[212:215]
ds_read_b64_tr_b16 v[128:129],v2 offset:12416
v_fma_f32 v88,v88,s36,v15
v_mfma_f32_16x16x32_bf16 v[208:211],v[112:115],v[24:27],v[208:211]
ds_read_b64_tr_b16 v[132:133],v3 offset:12416
v_fma_f32 v91,v91,s36,v15
v_mfma_f32_16x16x32_bf16 a[0:3],v[112:115],v[28:31],a[0:3]
ds_read_b64_tr_b16 v[138:139],v4 offset:18560
v_fma_f32 v89,v89,s36,v15
v_mfma_f32_16x16x32_bf16 a[4:7],v[116:119],v[28:31],a[4:7]
ds_read_b64_tr_b16 v[142:143],v5 offset:18560
v_fma_f32 v90,v90,s36,v15
v_mfma_f32_16x16x32_bf16 a[52:55],v[116:119],v[32:35],a[52:55]
ds_read_b64_tr_b16 v[136:137],v4 offset:12416
v_fma_f32 v96,v96,s36,v16
v_mfma_f32_16x16x32_bf16 a[48:51],v[112:115],v[32:35],a[48:51]
s_waitcnt lgkmcnt(6)
ds_read_b64_tr_b16 v[140:141],v5 offset:12416
v_fma_f32 v98,v98,s36,v16
v_mfma_f32_16x16x32_bf16 a[56:59],v[120:123],v[32:35],a[56:59]
ds_read_b64_tr_b16 v[112:113],v2 offset:12544
v_fma_f32 v99,v99,s36,v16
v_mfma_f32_16x16x32_bf16 a[60:63],v[124:127],v[32:35],a[60:63]
ds_read_b64_tr_b16 v[118:119],v3 offset:18688
v_fma_f32 v97,v97,s36,v16
v_mfma_f32_16x16x32_bf16 a[12:15],v[124:127],v[28:31],a[12:15]
ds_read_b64_tr_b16 v[114:115],v2 offset:18688
v_fma_f32 v79,v79,s36,v13
v_mfma_f32_16x16x32_bf16 a[8:11],v[120:123],v[28:31],a[8:11]
ds_read_b64_tr_b16 v[116:117],v3 offset:12544
v_fma_f32 v77,v77,s36,v13
v_mfma_f32_16x16x32_bf16 v[216:219],v[120:123],v[24:27],v[216:219]
v_exp_f32 v82,v82
v_mfma_f32_16x16x32_bf16 v[220:223],v[124:127],v[24:27],v[220:223]
v_exp_f32 v83,v83
v_mfma_f32_16x16x32_bf16 v[172:175],v[124:127],v[20:23],v[172:175]
ds_read_b64_tr_b16 v[124:125],v5 offset:12544
v_cvt_pk_bf16_f32 v49,v82,v83
v_mfma_f32_16x16x32_bf16 v[168:171],v[120:123],v[20:23],v[168:171]
s_waitcnt lgkmcnt(4)
ds_read_b64_tr_b16 v[126:127],v5 offset:18688
v_fma_f32 v76,v76,s36,v13
v_mfma_f32_16x16x32_bf16 v[176:179],v[128:131],v[20:23],v[176:179]
ds_read_b64_tr_b16 v[120:121],v4 offset:12544
v_fma_f32 v78,v78,s36,v13
v_mfma_f32_16x16x32_bf16 v[180:183],v[132:135],v[20:23],v[180:183]
ds_read_b64_tr_b16 v[122:123],v4 offset:18688
v_fma_f32 v86,v86,s36,v14
v_mfma_f32_16x16x32_bf16 v[228:231],v[132:135],v[24:27],v[228:231]
v_exp_f32 v90,v90
v_mfma_f32_16x16x32_bf16 v[224:227],v[128:131],v[24:27],v[224:227]
v_exp_f32 v88,v88
v_mfma_f32_16x16x32_bf16 a[16:19],v[128:131],v[28:31],a[16:19]
v_exp_f32 v89,v89
v_mfma_f32_16x16x32_bf16 a[20:23],v[132:135],v[28:31],a[20:23]
v_cvt_pk_bf16_f32 v52,v88,v89
v_fma_f32 v84,v84,s36,v14
v_mfma_f32_16x16x32_bf16 a[68:71],v[132:135],v[32:35],a[68:71]
v_exp_f32 v91,v91
v_mfma_f32_16x16x32_bf16 a[64:67],v[128:131],v[32:35],a[64:67]
v_cvt_pk_bf16_f32 v53,v90,v91
v_fma_f32 v85,v85,s36,v14
v_mfma_f32_16x16x32_bf16 a[72:75],v[136:139],v[32:35],a[72:75]
v_exp_f32 v99,v99
v_mfma_f32_16x16x32_bf16 a[76:79],v[140:143],v[32:35],a[76:79]
v_exp_f32 v97,v97
v_mfma_f32_16x16x32_bf16 a[28:31],v[140:143],v[28:31],a[28:31]
v_exp_f32 v96,v96
v_mfma_f32_16x16x32_bf16 a[24:27],v[136:139],v[28:31],a[24:27]
v_cvt_pk_bf16_f32 v56,v96,v97
v_fma_f32 v87,v87,s36,v14
v_mfma_f32_16x16x32_bf16 v[232:235],v[136:139],v[24:27],v[232:235]
v_exp_f32 v98,v98
v_mfma_f32_16x16x32_bf16 v[236:239],v[140:143],v[24:27],v[236:239]
v_cvt_pk_bf16_f32 v57,v98,v99
v_fma_f32 v94,v94,s36,v15
v_mfma_f32_16x16x32_bf16 v[188:191],v[140:143],v[20:23],v[188:191]
v_exp_f32 v76,v76
v_mfma_f32_16x16x32_bf16 v[184:187],v[136:139],v[20:23],v[184:187]
s_waitcnt lgkmcnt(0)
v_exp_f32 v79,v79
v_mfma_f32_16x16x32_bf16 v[192:195],v[112:115],v[20:23],v[192:195]
v_exp_f32 v78,v78
v_mfma_f32_16x16x32_bf16 v[196:199],v[116:119],v[20:23],v[196:199]
s_waitcnt vmcnt(9)
ds_read_b128 v[156:159],v10 offset:3072
v_cvt_pk_bf16_f32 v47,v78,v79
v_mfma_f32_16x16x32_bf16 v[244:247],v[116:119],v[24:27],v[244:247]
s_barrier
v_mfma_f32_16x16x32_bf16 v[240:243],v[112:115],v[24:27],v[240:243]
ds_read_b128 v[140:143],v1 offset:128
v_fma_f32 v92,v92,s36,v15
v_mfma_f32_16x16x32_bf16 a[32:35],v[112:115],v[28:31],a[32:35]
ds_read_b128 v[136:139],v0 offset:128
v_fma_f32 v93,v93,s36,v15
v_mfma_f32_16x16x32_bf16 a[36:39],v[116:119],v[28:31],a[36:39]
ds_read_b128 v[132:135],v1 offset:0
v_fma_f32 v95,v95,s36,v15
v_mfma_f32_16x16x32_bf16 a[84:87],v[116:119],v[32:35],a[84:87]
ds_read_b128 v[116:119],v1 offset:256
v_fma_f32 v102,v102,s36,v16
v_mfma_f32_16x16x32_bf16 a[80:83],v[112:115],v[32:35],a[80:83]
ds_read_b128 v[112:115],v0 offset:256
v_fma_f32 v100,v100,s36,v16
v_mfma_f32_16x16x32_bf16 a[88:91],v[120:123],v[32:35],a[88:91]
buffer_load_dwordx4 v6,s[8:11],s21 offen offset:0 lds
v_mfma_f32_16x16x32_bf16 a[92:95],v[124:127],v[32:35],a[92:95]
ds_read_b128 v[128:131],v0 offset:0
v_fma_f32 v101,v101,s36,v16
v_mfma_f32_16x16x32_bf16 a[44:47],v[124:127],v[28:31],a[44:47]
v_exp_f32 v77,v77
v_mfma_f32_16x16x32_bf16 a[40:43],v[120:123],v[28:31],a[40:43]
v_cvt_pk_bf16_f32 v46,v76,v77
v_fma_f32 v103,v103,s36,v16
v_mfma_f32_16x16x32_bf16 v[248:251],v[120:123],v[24:27],v[248:251]
v_exp_f32 v86,v86
v_mfma_f32_16x16x32_bf16 v[252:255],v[124:127],v[24:27],v[252:255]
v_exp_f32 v87,v87
v_mfma_f32_16x16x32_bf16 v[204:207],v[124:127],v[20:23],v[204:207]
ds_read_b128 v[124:127],v1 offset:6144
v_cvt_pk_bf16_f32 v51,v86,v87
v_mfma_f32_16x16x32_bf16 v[200:203],v[120:123],v[20:23],v[200:203]
s_waitcnt lgkmcnt(2)
ds_read_b128 v[120:123],v0 offset:6144
v_mfma_f32_16x16x32_bf16 v[72:75],v[116:119],a[164:167],0
v_exp_f32 v85,v85
v_mfma_f32_16x16x32_bf16 v[72:75],v[112:115],a[160:163],v[72:75]
buffer_store_dwordx4 v[156:159],v9,s[16:19],s27 offen offset:0 nt
buffer_load_dwordx4 v7,s[8:11],s21 offen offset:1024 lds
v_mfma_f32_16x16x32_bf16 v[72:75],v[140:143],a[156:159],v[72:75]
ds_read_b128 v[156:159],v10 offset:4096
v_mfma_f32_16x16x32_bf16 v[72:75],v[136:139],a[152:155],v[72:75]
v_exp_f32 v84,v84
v_mfma_f32_16x16x32_bf16 v[72:75],v[132:135],a[148:151],v[72:75]
s_waitcnt lgkmcnt(3)
v_cvt_pk_bf16_f32 v50,v84,v85
v_mfma_f32_16x16x32_bf16 v[72:75],v[128:131],a[144:147],v[72:75]
v_exp_f32 v93,v93
v_smfmac_f32_16x16x64_bf16 v[60:63],v[152:155],v[44:51],v18
v_mfma_f32_16x16x32_bf16 v[80:83],v[128:131],a[168:171],0
v_exp_f32 v94,v94
v_mfma_f32_16x16x32_bf16 v[80:83],v[132:135],a[172:175],v[80:83]
v_exp_f32 v92,v92
v_mfma_f32_16x16x32_bf16 v[80:83],v[136:139],a[176:179],v[80:83]
buffer_load_dwordx4 v8,s[8:11],s21 offen offset:2048 lds
v_mfma_f32_16x16x32_bf16 v[80:83],v[140:143],a[180:183],v[80:83]
s_add_u32 s21,s21,12288
v_cvt_pk_bf16_f32 v54,v92,v93
v_fma_f32 v72,v72,s36,v13
v_mfma_f32_16x16x32_bf16 v[80:83],v[112:115],a[184:187],v[80:83]
s_add_u32 m0,s22,24576
v_exp_f32 v95,v95
v_mfma_f32_16x16x32_bf16 v[80:83],v[116:119],a[188:191],v[80:83]
v_cvt_pk_bf16_f32 v55,v94,v95
v_fma_f32 v75,v75,s36,v13
v_mfma_f32_16x16x32_bf16 v[88:91],v[116:119],a[212:215],0
v_exp_f32 v103,v103
v_mfma_f32_16x16x32_bf16 v[88:91],v[112:115],a[208:211],v[88:91]
v_exp_f32 v100,v100
v_mfma_f32_16x16x32_bf16 v[88:91],v[140:143],a[204:207],v[88:91]
v_exp_f32 v102,v102
v_mfma_f32_16x16x32_bf16 v[88:91],v[136:139],a[200:203],v[88:91]
v_cvt_pk_bf16_f32 v59,v102,v103
v_fma_f32 v80,v80,s36,v14
v_mfma_f32_16x16x32_bf16 v[88:91],v[132:135],a[196:199],v[88:91]
v_exp_f32 v101,v101
v_mfma_f32_16x16x32_bf16 v[88:91],v[128:131],a[192:195],v[88:91]
s_waitcnt lgkmcnt(0)
buffer_store_dwordx4 v[156:159],v9,s[16:19],s27 offen offset:128 nt
buffer_load_dwordx4 v6,s[4:7],s20 offen offset:0 lds
v_mfma_f32_16x16x32_bf16 v[96:99],v[128:131],a[216:219],0
ds_read_b128 v[156:159],v10 offset:5120
v_cvt_pk_bf16_f32 v58,v100,v101
v_mfma_f32_16x16x32_bf16 v[96:99],v[132:135],a[220:223],v[96:99]
ds_read_b128 v[128:131],v0 offset:6272
v_fma_f32 v81,v81,s36,v14
v_smfmac_f32_16x16x64_bf16 v[64:67],v[152:155],v[52:59],v18
ds_read_b128 v[132:135],v1 offset:6272
v_mfma_f32_16x16x32_bf16 v[96:99],v[136:139],a[224:227],v[96:99]
ds_read_b128 v[136:139],v0 offset:6400
v_mfma_f32_16x16x32_bf16 v[96:99],v[140:143],a[228:231],v[96:99]
ds_read_b128 v[140:143],v1 offset:6400
v_mfma_f32_16x16x32_bf16 v[96:99],v[112:115],a[232:235],v[96:99]
v_fma_f32 v73,v73,s36,v13
v_fma_f32 v74,v74,s36,v13
v_mfma_f32_16x16x32_bf16 v[96:99],v[116:119],a[236:239],v[96:99]
v_exp_f32 v74,v74
v_mfma_f32_16x16x32_bf16 v[76:79],v[120:123],a[144:147],0
buffer_load_dwordx4 v7,s[4:7],s20 offen offset:1024 lds
v_mfma_f32_16x16x32_bf16 v[76:79],v[124:127],a[148:151],v[76:79]
s_waitcnt lgkmcnt(3)
v_exp_f32 v75,v75
v_mfma_f32_16x16x32_bf16 v[76:79],v[128:131],a[152:155],v[76:79]
s_waitcnt lgkmcnt(2)
v_cvt_pk_bf16_f32 v21,v74,v75
v_mfma_f32_16x16x32_bf16 v[76:79],v[132:135],a[156:159],v[76:79]
s_waitcnt lgkmcnt(1)
v_exp_f32 v73,v73
v_mfma_f32_16x16x32_bf16 v[76:79],v[136:139],a[160:163],v[76:79]
s_waitcnt lgkmcnt(0)
v_exp_f32 v80,v80
v_mfma_f32_16x16x32_bf16 v[76:79],v[140:143],a[164:167],v[76:79]
v_exp_f32 v81,v81
v_mfma_f32_16x16x32_bf16 v[84:87],v[140:143],a[188:191],0
v_cvt_pk_bf16_f32 v24,v80,v81
v_mfma_f32_16x16x32_bf16 v[84:87],v[136:139],a[184:187],v[84:87]
v_exp_f32 v72,v72
v_mfma_f32_16x16x32_bf16 v[84:87],v[132:135],a[180:183],v[84:87]
v_cvt_pk_bf16_f32 v20,v72,v73
v_mfma_f32_16x16x32_bf16 v[84:87],v[128:131],a[176:179],v[84:87]
buffer_store_dwordx4 v[156:159],v9,s[16:19],s27 offen offset:256 nt
buffer_load_dwordx4 v8,s[4:7],s20 offen offset:2048 lds
v_mfma_f32_16x16x32_bf16 v[84:87],v[124:127],a[172:175],v[84:87]
s_add_u32 s20,s20,12288
ds_read_b64_tr_b16 v[114:115],v2 offset:30720
v_mfma_f32_16x16x32_bf16 v[84:87],v[120:123],a[168:171],v[84:87]
s_add_u32 s27,s27,3072
ds_read_b64_tr_b16 v[112:113],v2 offset:24576
v_mfma_f32_16x16x32_bf16 v[92:95],v[120:123],a[192:195],0
ds_read_b64_tr_b16 v[116:117],v3 offset:24576
v_mfma_f32_16x16x32_bf16 v[92:95],v[124:127],a[196:199],v[92:95]
ds_read_b64_tr_b16 v[118:119],v3 offset:30720
v_mfma_f32_16x16x32_bf16 v[92:95],v[128:131],a[200:203],v[92:95]
v_mfma_f32_16x16x32_bf16 v[92:95],v[132:135],a[204:207],v[92:95]
v_mfma_f32_16x16x32_bf16 v[92:95],v[136:139],a[208:211],v[92:95]
v_mfma_f32_16x16x32_bf16 v[92:95],v[140:143],a[212:215],v[92:95]
v_mfma_f32_16x16x32_bf16 v[100:103],v[140:143],a[236:239],0
v_mfma_f32_16x16x32_bf16 v[100:103],v[136:139],a[232:235],v[100:103]
v_mfma_f32_16x16x32_bf16 v[100:103],v[132:135],a[228:231],v[100:103]
v_mfma_f32_16x16x32_bf16 v[100:103],v[128:131],a[224:227],v[100:103]
v_mfma_f32_16x16x32_bf16 v[100:103],v[124:127],a[220:223],v[100:103]
ds_read_b64_tr_b16 v[126:127],v5 offset:30720
v_mfma_f32_16x16x32_bf16 v[100:103],v[120:123],a[216:219],v[100:103]
s_waitcnt lgkmcnt(1)
ds_read_b64_tr_b16 v[120:121],v4 offset:24576
ds_read_b64_tr_b16 v[122:123],v4 offset:30720
ds_read_b64_tr_b16 v[124:125],v5 offset:24576
v_mfma_f32_16x16x32_bf16 v[160:163],v[112:115],v[44:47],v[160:163]
s_add_u32 m0,s29,0
ds_read_b64_tr_b16 v[128:129],v2 offset:24704
v_fma_f32 v82,v82,s36,v14
v_mfma_f32_16x16x32_bf16 v[164:167],v[116:119],v[44:47],v[164:167]
ds_read_b64_tr_b16 v[130:131],v2 offset:30848
v_fma_f32 v83,v83,s36,v14
v_mfma_f32_16x16x32_bf16 v[212:215],v[116:119],v[48:51],v[212:215]
ds_read_b64_tr_b16 v[132:133],v3 offset:24704
v_fma_f32 v88,v88,s36,v15
v_mfma_f32_16x16x32_bf16 v[208:211],v[112:115],v[48:51],v[208:211]
ds_read_b64_tr_b16 v[134:135],v3 offset:30848
v_fma_f32 v89,v89,s36,v15
v_mfma_f32_16x16x32_bf16 a[0:3],v[112:115],v[52:55],a[0:3]
ds_read_b64_tr_b16 v[136:137],v4 offset:24704
v_fma_f32 v90,v90,s36,v15
v_mfma_f32_16x16x32_bf16 a[4:7],v[116:119],v[52:55],a[4:7]
ds_read_b64_tr_b16 v[138:139],v4 offset:30848
v_fma_f32 v91,v91,s36,v15
v_mfma_f32_16x16x32_bf16 a[52:55],v[116:119],v[56:59],a[52:55]
buffer_load_dwordx4 v6,s[12:15],s28 offen offset:0 nt lds
v_mfma_f32_16x16x32_bf16 a[48:51],v[112:115],v[56:59],a[48:51]
s_waitcnt lgkmcnt(5)
ds_read_b64_tr_b16 v[140:141],v5 offset:24704
v_fma_f32 v96,v96,s36,v16
v_mfma_f32_16x16x32_bf16 a[56:59],v[120:123],v[56:59],a[56:59]
ds_read_b64_tr_b16 v[142:143],v5 offset:30848
v_fma_f32 v97,v97,s36,v16
v_mfma_f32_16x16x32_bf16 a[60:63],v[124:127],v[56:59],a[60:63]
ds_read_b64_tr_b16 v[112:113],v2 offset:24832
v_fma_f32 v98,v98,s36,v16
v_mfma_f32_16x16x32_bf16 a[12:15],v[124:127],v[52:55],a[12:15]
ds_read_b64_tr_b16 v[114:115],v2 offset:30976
v_fma_f32 v99,v99,s36,v16
v_mfma_f32_16x16x32_bf16 a[8:11],v[120:123],v[52:55],a[8:11]
ds_read_b64_tr_b16 v[116:117],v3 offset:24832
v_fma_f32 v76,v76,s36,v13
v_mfma_f32_16x16x32_bf16 v[216:219],v[120:123],v[48:51],v[216:219]
ds_read_b64_tr_b16 v[118:119],v3 offset:30976
v_fma_f32 v77,v77,s36,v13
v_mfma_f32_16x16x32_bf16 v[220:223],v[124:127],v[48:51],v[220:223]
buffer_load_dwordx4 v7,s[12:15],s28 offen offset:1024 nt lds
v_mfma_f32_16x16x32_bf16 v[172:175],v[124:127],v[44:47],v[172:175]
ds_read_b64_tr_b16 v[124:125],v5 offset:24832
v_fma_f32 v78,v78,s36,v13
v_mfma_f32_16x16x32_bf16 v[168:171],v[120:123],v[44:47],v[168:171]
s_waitcnt lgkmcnt(5)
ds_read_b64_tr_b16 v[120:121],v4 offset:24832
v_fma_f32 v79,v79,s36,v13
v_mfma_f32_16x16x32_bf16 v[176:179],v[128:131],v[44:47],v[176:179]
ds_read_b64_tr_b16 v[122:123],v4 offset:30976
v_fma_f32 v84,v84,s36,v14
v_mfma_f32_16x16x32_bf16 v[180:183],v[132:135],v[44:47],v[180:183]
ds_read_b64_tr_b16 v[126:127],v5 offset:30976
v_fma_f32 v85,v85,s36,v14
v_mfma_f32_16x16x32_bf16 v[228:231],v[132:135],v[48:51],v[228:231]
v_exp_f32 v82,v82
v_mfma_f32_16x16x32_bf16 v[224:227],v[128:131],v[48:51],v[224:227]
v_exp_f32 v83,v83
v_mfma_f32_16x16x32_bf16 a[16:19],v[128:131],v[52:55],a[16:19]
v_cvt_pk_bf16_f32 v25,v82,v83
v_fma_f32 v86,v86,s36,v14
v_mfma_f32_16x16x32_bf16 a[20:23],v[132:135],v[52:55],a[20:23]
buffer_load_dwordx4 v8,s[12:15],s28 offen offset:2048 nt lds
v_mfma_f32_16x16x32_bf16 a[68:71],v[132:135],v[56:59],a[68:71]
s_add_u32 s28,s28,3072
v_exp_f32 v88,v88
v_mfma_f32_16x16x32_bf16 a[64:67],v[128:131],v[56:59],a[64:67]
s_add_u32 s29,s29,3072
v_exp_f32 v89,v89
v_mfma_f32_16x16x32_bf16 a[72:75],v[136:139],v[56:59],a[72:75]
s_add_u32 m0,s23,24576
v_exp_f32 v90,v90
v_mfma_f32_16x16x32_bf16 a[76:79],v[140:143],v[56:59],a[76:79]
v_exp_f32 v91,v91
v_mfma_f32_16x16x32_bf16 a[28:31],v[140:143],v[52:55],a[28:31]
v_cvt_pk_bf16_f32 v28,v88,v89
v_cvt_pk_bf16_f32 v29,v90,v91
v_mfma_f32_16x16x32_bf16 a[24:27],v[136:139],v[52:55],a[24:27]
v_exp_f32 v96,v96
v_mfma_f32_16x16x32_bf16 v[232:235],v[136:139],v[48:51],v[232:235]
v_exp_f32 v97,v97
v_mfma_f32_16x16x32_bf16 v[236:239],v[140:143],v[48:51],v[236:239]
v_exp_f32 v98,v98
v_mfma_f32_16x16x32_bf16 v[188:191],v[140:143],v[44:47],v[188:191]
v_exp_f32 v99,v99
v_mfma_f32_16x16x32_bf16 v[184:187],v[136:139],v[44:47],v[184:187]
s_waitcnt lgkmcnt(0)
v_cvt_pk_bf16_f32 v32,v96,v97
v_cvt_pk_bf16_f32 v33,v98,v99
v_mfma_f32_16x16x32_bf16 v[192:195],v[112:115],v[44:47],v[192:195]
s_waitcnt vmcnt(12)
v_exp_f32 v76,v76
v_mfma_f32_16x16x32_bf16 v[196:199],v[116:119],v[44:47],v[196:199]
s_barrier
v_mfma_f32_16x16x32_bf16 v[244:247],v[116:119],v[48:51],v[244:247]
ds_read_b128 v[140:143],v1 offset:12416
v_fma_f32 v87,v87,s36,v14
v_mfma_f32_16x16x32_bf16 v[240:243],v[112:115],v[48:51],v[240:243]
ds_read_b128 v[136:139],v0 offset:12416
v_fma_f32 v92,v92,s36,v15
v_mfma_f32_16x16x32_bf16 a[32:35],v[112:115],v[52:55],a[32:35]
ds_read_b128 v[132:135],v1 offset:12288
v_fma_f32 v93,v93,s36,v15
v_mfma_f32_16x16x32_bf16 a[36:39],v[116:119],v[52:55],a[36:39]
ds_read_b128 v[128:131],v0 offset:12288
v_fma_f32 v94,v94,s36,v15
v_mfma_f32_16x16x32_bf16 a[84:87],v[116:119],v[56:59],a[84:87]
ds_read_b128 v[116:119],v1 offset:12544
v_fma_f32 v95,v95,s36,v15
v_mfma_f32_16x16x32_bf16 a[80:83],v[112:115],v[56:59],a[80:83]
buffer_load_dwordx4 v6,s[8:11],s21 offen offset:0 lds
v_mfma_f32_16x16x32_bf16 a[88:91],v[120:123],v[56:59],a[88:91]
ds_read_b128 v[112:115],v0 offset:12544
v_fma_f32 v100,v100,s36,v16
v_mfma_f32_16x16x32_bf16 a[92:95],v[124:127],v[56:59],a[92:95]
v_exp_f32 v77,v77
v_mfma_f32_16x16x32_bf16 a[44:47],v[124:127],v[52:55],a[44:47]
v_exp_f32 v78,v78
v_mfma_f32_16x16x32_bf16 a[40:43],v[120:123],v[52:55],a[40:43]
v_exp_f32 v79,v79
v_mfma_f32_16x16x32_bf16 v[248:251],v[120:123],v[48:51],v[248:251]
v_cvt_pk_bf16_f32 v22,v76,v77
v_cvt_pk_bf16_f32 v23,v78,v79
v_mfma_f32_16x16x32_bf16 v[252:255],v[124:127],v[48:51],v[252:255]
v_exp_f32 v84,v84
v_mfma_f32_16x16x32_bf16 v[204:207],v[124:127],v[44:47],v[204:207]
ds_read_b128 v[124:127],v1 offset:18432
v_fma_f32 v101,v101,s36,v16
v_mfma_f32_16x16x32_bf16 v[200:203],v[120:123],v[44:47],v[200:203]
s_waitcnt lgkmcnt(1)
ds_read_b128 v[120:123],v0 offset:18432
v_fma_f32 v102,v102,s36,v16
v_mfma_f32_16x16x32_bf16 v[72:75],v[116:119],a[164:167],0
buffer_load_dwordx4 v7,s[8:11],s21 offen offset:1024 lds
v_mfma_f32_16x16x32_bf16 v[72:75],v[112:115],a[160:163],v[72:75]
v_exp_f32 v85,v85
v_mfma_f32_16x16x32_bf16 v[72:75],v[140:143],a[156:159],v[72:75]
v_exp_f32 v86,v86
v_mfma_f32_16x16x32_bf16 v[72:75],v[136:139],a[152:155],v[72:75]
v_exp_f32 v87,v87
v_mfma_f32_16x16x32_bf16 v[72:75],v[132:135],a[148:151],v[72:75]
v_cvt_pk_bf16_f32 v26,v84,v85
v_cvt_pk_bf16_f32 v27,v86,v87
v_mfma_f32_16x16x32_bf16 v[72:75],v[128:131],a[144:147],v[72:75]
v_exp_f32 v92,v92
v_smfmac_f32_16x16x64_bf16 v[60:63],v[152:155],v[20:27],v18
v_fma_f32 v103,v103,s36,v16
v_mfma_f32_16x16x32_bf16 v[80:83],v[128:131],a[168:171],0
v_exp_f32 v93,v93
v_mfma_f32_16x16x32_bf16 v[80:83],v[132:135],a[172:175],v[80:83]
buffer_load_dwordx4 v8,s[8:11],s21 offen offset:2048 lds
v_mfma_f32_16x16x32_bf16 v[80:83],v[136:139],a[176:179],v[80:83]
s_add_u32 s21,s21,12288
v_exp_f32 v94,v94
v_mfma_f32_16x16x32_bf16 v[80:83],v[140:143],a[180:183],v[80:83]
s_add_u32 m0,s22,0
v_exp_f32 v95,v95
v_mfma_f32_16x16x32_bf16 v[80:83],v[112:115],a[184:187],v[80:83]
v_cvt_pk_bf16_f32 v30,v92,v93
v_cvt_pk_bf16_f32 v31,v94,v95
v_mfma_f32_16x16x32_bf16 v[80:83],v[116:119],a[188:191],v[80:83]
v_exp_f32 v100,v100
v_mfma_f32_16x16x32_bf16 v[88:91],v[116:119],a[212:215],0
v_exp_f32 v101,v101
v_mfma_f32_16x16x32_bf16 v[88:91],v[112:115],a[208:211],v[88:91]
v_exp_f32 v102,v102
v_mfma_f32_16x16x32_bf16 v[88:91],v[140:143],a[204:207],v[88:91]
v_exp_f32 v103,v103
v_mfma_f32_16x16x32_bf16 v[88:91],v[136:139],a[200:203],v[88:91]
v_cvt_pk_bf16_f32 v34,v100,v101
v_cvt_pk_bf16_f32 v35,v102,v103
v_mfma_f32_16x16x32_bf16 v[88:91],v[132:135],a[196:199],v[88:91]
buffer_load_dwordx4 v6,s[4:7],s20 offen offset:0 lds
v_smfmac_f32_16x16x64_bf16 v[64:67],v[152:155],v[28:35],v18
v_fma_f32 v72,v72,s36,v13
v_mfma_f32_16x16x32_bf16 v[88:91],v[128:131],a[192:195],v[88:91]
v_fma_f32 v73,v73,s36,v13
v_fma_f32 v74,v74,s36,v13
v_mfma_f32_16x16x32_bf16 v[96:99],v[128:131],a[216:219],0
ds_read_b128 v[128:131],v0 offset:18560
v_fma_f32 v75,v75,s36,v13
v_mfma_f32_16x16x32_bf16 v[96:99],v[132:135],a[220:223],v[96:99]
ds_read_b128 v[132:135],v1 offset:18560
v_fma_f32 v80,v80,s36,v14
v_mfma_f32_16x16x32_bf16 v[96:99],v[136:139],a[224:227],v[96:99]
ds_read_b128 v[136:139],v0 offset:18688
v_fma_f32 v81,v81,s36,v14
v_mfma_f32_16x16x32_bf16 v[96:99],v[140:143],a[228:231],v[96:99]
ds_read_b128 v[140:143],v1 offset:18688
v_mfma_f32_16x16x32_bf16 v[96:99],v[112:115],a[232:235],v[96:99]
v_exp_f32 v72,v72
v_mfma_f32_16x16x32_bf16 v[96:99],v[116:119],a[236:239],v[96:99]
s_waitcnt lgkmcnt(4)
v_exp_f32 v73,v73
v_mfma_f32_16x16x32_bf16 v[76:79],v[120:123],a[144:147],0
buffer_load_dwordx4 v7,s[4:7],s20 offen offset:1024 lds
v_mfma_f32_16x16x32_bf16 v[76:79],v[124:127],a[148:151],v[76:79]
s_waitcnt lgkmcnt(3)
v_exp_f32 v74,v74
v_mfma_f32_16x16x32_bf16 v[76:79],v[128:131],a[152:155],v[76:79]
s_waitcnt lgkmcnt(2)
v_exp_f32 v75,v75
v_mfma_f32_16x16x32_bf16 v[76:79],v[132:135],a[156:159],v[76:79]
s_waitcnt lgkmcnt(0)
v_exp_f32 v80,v80
v_mfma_f32_16x16x32_bf16 v[76:79],v[136:139],a[160:163],v[76:79]
v_exp_f32 v81,v81
v_mfma_f32_16x16x32_bf16 v[76:79],v[140:143],a[164:167],v[76:79]
v_cvt_pk_bf16_f32 v44,v72,v73
v_cvt_pk_bf16_f32 v45,v74,v75
v_mfma_f32_16x16x32_bf16 v[84:87],v[140:143],a[188:191],0
v_cvt_pk_bf16_f32 v48,v80,v81
v_mfma_f32_16x16x32_bf16 v[84:87],v[136:139],a[184:187],v[84:87]
v_mfma_f32_16x16x32_bf16 v[84:87],v[132:135],a[180:183],v[84:87]
v_mfma_f32_16x16x32_bf16 v[84:87],v[128:131],a[176:179],v[84:87]
buffer_load_dwordx4 v8,s[4:7],s20 offen offset:2048 lds
v_mfma_f32_16x16x32_bf16 v[84:87],v[124:127],a[172:175],v[84:87]
s_add_u32 s20,s20,12288
v_mfma_f32_16x16x32_bf16 v[84:87],v[120:123],a[168:171],v[84:87]
ds_read_b64_tr_b16 v[112:113],v2 offset:0
v_mfma_f32_16x16x32_bf16 v[92:95],v[120:123],a[192:195],0
ds_read_b64_tr_b16 v[114:115],v2 offset:6144
v_mfma_f32_16x16x32_bf16 v[92:95],v[124:127],a[196:199],v[92:95]
ds_read_b64_tr_b16 v[116:117],v3 offset:0
v_mfma_f32_16x16x32_bf16 v[92:95],v[128:131],a[200:203],v[92:95]
ds_read_b64_tr_b16 v[118:119],v3 offset:6144
v_mfma_f32_16x16x32_bf16 v[92:95],v[132:135],a[204:207],v[92:95]
v_mfma_f32_16x16x32_bf16 v[92:95],v[136:139],a[208:211],v[92:95]
v_mfma_f32_16x16x32_bf16 v[92:95],v[140:143],a[212:215],v[92:95]
v_mfma_f32_16x16x32_bf16 v[100:103],v[140:143],a[236:239],0
v_mfma_f32_16x16x32_bf16 v[100:103],v[136:139],a[232:235],v[100:103]
v_mfma_f32_16x16x32_bf16 v[100:103],v[132:135],a[228:231],v[100:103]
v_mfma_f32_16x16x32_bf16 v[100:103],v[128:131],a[224:227],v[100:103]
v_mfma_f32_16x16x32_bf16 v[100:103],v[124:127],a[220:223],v[100:103]
ds_read_b64_tr_b16 v[124:125],v5 offset:0
v_mfma_f32_16x16x32_bf16 v[100:103],v[120:123],a[216:219],v[100:103]
s_waitcnt lgkmcnt(1)
ds_read_b64_tr_b16 v[120:121],v4 offset:0
ds_read_b64_tr_b16 v[122:123],v4 offset:6144
ds_read_b64_tr_b16 v[126:127],v5 offset:6144
v_mfma_f32_16x16x32_bf16 v[160:163],v[112:115],v[20:23],v[160:163]
s_add_u32 m0,s23,0
ds_read_b64_tr_b16 v[134:135],v3 offset:6272
v_fma_f32 v83,v83,s36,v14
v_mfma_f32_16x16x32_bf16 v[164:167],v[116:119],v[20:23],v[164:167]
ds_read_b64_tr_b16 v[130:131],v2 offset:6272
v_fma_f32 v82,v82,s36,v14
v_mfma_f32_16x16x32_bf16 v[212:215],v[116:119],v[24:27],v[212:215]
ds_read_b64_tr_b16 v[128:129],v2 offset:128
v_fma_f32 v88,v88,s36,v15
v_mfma_f32_16x16x32_bf16 v[208:211],v[112:115],v[24:27],v[208:211]
ds_read_b64_tr_b16 v[132:133],v3 offset:128
v_fma_f32 v91,v91,s36,v15
v_mfma_f32_16x16x32_bf16 a[0:3],v[112:115],v[28:31],a[0:3]
ds_read_b64_tr_b16 v[138:139],v4 offset:6272
v_fma_f32 v89,v89,s36,v15
v_mfma_f32_16x16x32_bf16 a[4:7],v[116:119],v[28:31],a[4:7]
ds_read_b64_tr_b16 v[142:143],v5 offset:6272
v_fma_f32 v90,v90,s36,v15
v_mfma_f32_16x16x32_bf16 a[52:55],v[116:119],v[32:35],a[52:55]
ds_read_b64_tr_b16 v[136:137],v4 offset:128
v_fma_f32 v96,v96,s36,v16
v_mfma_f32_16x16x32_bf16 a[48:51],v[112:115],v[32:35],a[48:51]
s_waitcnt lgkmcnt(6)
ds_read_b64_tr_b16 v[140:141],v5 offset:128
v_fma_f32 v98,v98,s36,v16
v_mfma_f32_16x16x32_bf16 a[56:59],v[120:123],v[32:35],a[56:59]
ds_read_b64_tr_b16 v[112:113],v2 offset:256
v_fma_f32 v99,v99,s36,v16
v_mfma_f32_16x16x32_bf16 a[60:63],v[124:127],v[32:35],a[60:63]
ds_read_b64_tr_b16 v[118:119],v3 offset:6400
v_fma_f32 v97,v97,s36,v16
v_mfma_f32_16x16x32_bf16 a[12:15],v[124:127],v[28:31],a[12:15]
ds_read_b64_tr_b16 v[114:115],v2 offset:6400
v_fma_f32 v79,v79,s36,v13
v_mfma_f32_16x16x32_bf16 a[8:11],v[120:123],v[28:31],a[8:11]
ds_read_b64_tr_b16 v[116:117],v3 offset:256
v_fma_f32 v77,v77,s36,v13
v_mfma_f32_16x16x32_bf16 v[216:219],v[120:123],v[24:27],v[216:219]
v_exp_f32 v82,v82
v_mfma_f32_16x16x32_bf16 v[220:223],v[124:127],v[24:27],v[220:223]
v_exp_f32 v83,v83
v_mfma_f32_16x16x32_bf16 v[172:175],v[124:127],v[20:23],v[172:175]
ds_read_b64_tr_b16 v[124:125],v5 offset:256
v_cvt_pk_bf16_f32 v49,v82,v83
v_mfma_f32_16x16x32_bf16 v[168:171],v[120:123],v[20:23],v[168:171]
s_waitcnt lgkmcnt(4)
ds_read_b64_tr_b16 v[126:127],v5 offset:6400
v_fma_f32 v76,v76,s36,v13
v_mfma_f32_16x16x32_bf16 v[176:179],v[128:131],v[20:23],v[176:179]
ds_read_b64_tr_b16 v[120:121],v4 offset:256
v_fma_f32 v78,v78,s36,v13
v_mfma_f32_16x16x32_bf16 v[180:183],v[132:135],v[20:23],v[180:183]
ds_read_b64_tr_b16 v[122:123],v4 offset:6400
v_fma_f32 v86,v86,s36,v14
v_mfma_f32_16x16x32_bf16 v[228:231],v[132:135],v[24:27],v[228:231]
v_exp_f32 v90,v90
v_mfma_f32_16x16x32_bf16 v[224:227],v[128:131],v[24:27],v[224:227]
v_exp_f32 v88,v88
v_mfma_f32_16x16x32_bf16 a[16:19],v[128:131],v[28:31],a[16:19]
v_exp_f32 v89,v89
v_mfma_f32_16x16x32_bf16 a[20:23],v[132:135],v[28:31],a[20:23]
v_cvt_pk_bf16_f32 v52,v88,v89
v_fma_f32 v84,v84,s36,v14
v_mfma_f32_16x16x32_bf16 a[68:71],v[132:135],v[32:35],a[68:71]
v_exp_f32 v91,v91
v_mfma_f32_16x16x32_bf16 a[64:67],v[128:131],v[32:35],a[64:67]
v_cvt_pk_bf16_f32 v53,v90,v91
v_fma_f32 v85,v85,s36,v14
v_mfma_f32_16x16x32_bf16 a[72:75],v[136:139],v[32:35],a[72:75]
v_exp_f32 v99,v99
v_mfma_f32_16x16x32_bf16 a[76:79],v[140:143],v[32:35],a[76:79]
v_exp_f32 v97,v97
v_mfma_f32_16x16x32_bf16 a[28:31],v[140:143],v[28:31],a[28:31]
v_exp_f32 v96,v96
v_mfma_f32_16x16x32_bf16 a[24:27],v[136:139],v[28:31],a[24:27]
v_cvt_pk_bf16_f32 v56,v96,v97
v_fma_f32 v87,v87,s36,v14
v_mfma_f32_16x16x32_bf16 v[232:235],v[136:139],v[24:27],v[232:235]
v_exp_f32 v98,v98
v_mfma_f32_16x16x32_bf16 v[236:239],v[140:143],v[24:27],v[236:239]
v_cvt_pk_bf16_f32 v57,v98,v99
v_fma_f32 v94,v94,s36,v15
v_mfma_f32_16x16x32_bf16 v[188:191],v[140:143],v[20:23],v[188:191]
v_exp_f32 v76,v76
v_mfma_f32_16x16x32_bf16 v[184:187],v[136:139],v[20:23],v[184:187]
s_waitcnt lgkmcnt(0)
v_exp_f32 v79,v79
v_mfma_f32_16x16x32_bf16 v[192:195],v[112:115],v[20:23],v[192:195]
v_exp_f32 v78,v78
v_mfma_f32_16x16x32_bf16 v[196:199],v[116:119],v[20:23],v[196:199]
s_waitcnt vmcnt(9)
ds_read_b128 v[156:159],v10 offset:6144
v_cvt_pk_bf16_f32 v47,v78,v79
v_mfma_f32_16x16x32_bf16 v[244:247],v[116:119],v[24:27],v[244:247]
s_barrier
v_mfma_f32_16x16x32_bf16 v[240:243],v[112:115],v[24:27],v[240:243]
ds_read_b128 v[140:143],v1 offset:24704
v_fma_f32 v92,v92,s36,v15
v_mfma_f32_16x16x32_bf16 a[32:35],v[112:115],v[28:31],a[32:35]
ds_read_b128 v[136:139],v0 offset:24704
v_fma_f32 v93,v93,s36,v15
v_mfma_f32_16x16x32_bf16 a[36:39],v[116:119],v[28:31],a[36:39]
ds_read_b128 v[132:135],v1 offset:24576
v_fma_f32 v95,v95,s36,v15
v_mfma_f32_16x16x32_bf16 a[84:87],v[116:119],v[32:35],a[84:87]
ds_read_b128 v[116:119],v1 offset:24832
v_fma_f32 v102,v102,s36,v16
v_mfma_f32_16x16x32_bf16 a[80:83],v[112:115],v[32:35],a[80:83]
ds_read_b128 v[112:115],v0 offset:24832
v_fma_f32 v100,v100,s36,v16
v_mfma_f32_16x16x32_bf16 a[88:91],v[120:123],v[32:35],a[88:91]
buffer_load_dwordx4 v6,s[8:11],s21 offen offset:0 lds
v_mfma_f32_16x16x32_bf16 a[92:95],v[124:127],v[32:35],a[92:95]
ds_read_b128 v[128:131],v0 offset:24576
v_fma_f32 v101,v101,s36,v16
v_mfma_f32_16x16x32_bf16 a[44:47],v[124:127],v[28:31],a[44:47]
v_exp_f32 v77,v77
v_mfma_f32_16x16x32_bf16 a[40:43],v[120:123],v[28:31],a[40:43]
v_cvt_pk_bf16_f32 v46,v76,v77
v_fma_f32 v103,v103,s36,v16
v_mfma_f32_16x16x32_bf16 v[248:251],v[120:123],v[24:27],v[248:251]
v_exp_f32 v86,v86
v_mfma_f32_16x16x32_bf16 v[252:255],v[124:127],v[24:27],v[252:255]
v_exp_f32 v87,v87
v_mfma_f32_16x16x32_bf16 v[204:207],v[124:127],v[20:23],v[204:207]
ds_read_b128 v[124:127],v1 offset:30720
v_cvt_pk_bf16_f32 v51,v86,v87
v_mfma_f32_16x16x32_bf16 v[200:203],v[120:123],v[20:23],v[200:203]
s_waitcnt lgkmcnt(2)
ds_read_b128 v[120:123],v0 offset:30720
v_mfma_f32_16x16x32_bf16 v[72:75],v[116:119],a[164:167],0
v_exp_f32 v85,v85
v_mfma_f32_16x16x32_bf16 v[72:75],v[112:115],a[160:163],v[72:75]
buffer_store_dwordx4 v[156:159],v9,s[16:19],s27 offen offset:0 nt
buffer_load_dwordx4 v7,s[8:11],s21 offen offset:1024 lds
v_mfma_f32_16x16x32_bf16 v[72:75],v[140:143],a[156:159],v[72:75]
ds_read_b128 v[156:159],v10 offset:7168
v_mfma_f32_16x16x32_bf16 v[72:75],v[136:139],a[152:155],v[72:75]
v_exp_f32 v84,v84
v_mfma_f32_16x16x32_bf16 v[72:75],v[132:135],a[148:151],v[72:75]
s_waitcnt lgkmcnt(3)
v_cvt_pk_bf16_f32 v50,v84,v85
v_mfma_f32_16x16x32_bf16 v[72:75],v[128:131],a[144:147],v[72:75]
v_exp_f32 v93,v93
v_smfmac_f32_16x16x64_bf16 v[60:63],v[152:155],v[44:51],v18
v_mfma_f32_16x16x32_bf16 v[80:83],v[128:131],a[168:171],0
v_exp_f32 v94,v94
v_mfma_f32_16x16x32_bf16 v[80:83],v[132:135],a[172:175],v[80:83]
v_exp_f32 v92,v92
v_mfma_f32_16x16x32_bf16 v[80:83],v[136:139],a[176:179],v[80:83]
buffer_load_dwordx4 v8,s[8:11],s21 offen offset:2048 lds
v_mfma_f32_16x16x32_bf16 v[80:83],v[140:143],a[180:183],v[80:83]
s_add_u32 s21,s21,12288
v_cvt_pk_bf16_f32 v54,v92,v93
v_fma_f32 v74,v74,s36,v13
v_mfma_f32_16x16x32_bf16 v[80:83],v[112:115],a[184:187],v[80:83]
s_cmp_eq_u32 s38,1
v_exp_f32 v95,v95
v_mfma_f32_16x16x32_bf16 v[80:83],v[116:119],a[188:191],v[80:83]
s_cselect_b32 s20,s26,s20
v_cvt_pk_bf16_f32 v55,v94,v95
v_fma_f32 v75,v75,s36,v13
v_mfma_f32_16x16x32_bf16 v[88:91],v[116:119],a[212:215],0
s_add_u32 m0,s22,12288
v_exp_f32 v103,v103
v_mfma_f32_16x16x32_bf16 v[88:91],v[112:115],a[208:211],v[88:91]
v_exp_f32 v100,v100
v_mfma_f32_16x16x32_bf16 v[88:91],v[140:143],a[204:207],v[88:91]
v_exp_f32 v102,v102
v_mfma_f32_16x16x32_bf16 v[88:91],v[136:139],a[200:203],v[88:91]
v_cvt_pk_bf16_f32 v59,v102,v103
v_fma_f32 v73,v73,s36,v13
v_mfma_f32_16x16x32_bf16 v[88:91],v[132:135],a[196:199],v[88:91]
v_exp_f32 v101,v101
v_mfma_f32_16x16x32_bf16 v[88:91],v[128:131],a[192:195],v[88:91]
s_waitcnt lgkmcnt(0)
buffer_store_dwordx4 v[156:159],v9,s[16:19],s27 offen offset:128 nt
buffer_load_dwordx4 v6,s[4:7],s20 offen offset:0 lds
v_mfma_f32_16x16x32_bf16 v[96:99],v[128:131],a[216:219],0
ds_read_b128 v[156:159],v10 offset:8192
v_cvt_pk_bf16_f32 v58,v100,v101
v_mfma_f32_16x16x32_bf16 v[96:99],v[132:135],a[220:223],v[96:99]
ds_read_b128 v[128:131],v0 offset:30848
v_fma_f32 v80,v80,s36,v14
v_smfmac_f32_16x16x64_bf16 v[64:67],v[152:155],v[52:59],v18
ds_read_b128 v[132:135],v1 offset:30848
v_mfma_f32_16x16x32_bf16 v[96:99],v[136:139],a[224:227],v[96:99]
ds_read_b128 v[136:139],v0 offset:30976
v_mfma_f32_16x16x32_bf16 v[96:99],v[140:143],a[228:231],v[96:99]
ds_read_b128 v[140:143],v1 offset:30976
v_mfma_f32_16x16x32_bf16 v[96:99],v[112:115],a[232:235],v[96:99]
v_fma_f32 v81,v81,s36,v14
v_fma_f32 v72,v72,s36,v13
v_mfma_f32_16x16x32_bf16 v[96:99],v[116:119],a[236:239],v[96:99]
v_exp_f32 v80,v80
v_mfma_f32_16x16x32_bf16 v[76:79],v[120:123],a[144:147],0
buffer_load_dwordx4 v7,s[4:7],s20 offen offset:1024 lds
v_mfma_f32_16x16x32_bf16 v[76:79],v[124:127],a[148:151],v[76:79]
s_waitcnt lgkmcnt(3)
v_exp_f32 v74,v74
v_mfma_f32_16x16x32_bf16 v[76:79],v[128:131],a[152:155],v[76:79]
s_waitcnt lgkmcnt(2)
v_exp_f32 v75,v75
v_mfma_f32_16x16x32_bf16 v[76:79],v[132:135],a[156:159],v[76:79]
s_waitcnt lgkmcnt(1)
v_cvt_pk_bf16_f32 v21,v74,v75
v_mfma_f32_16x16x32_bf16 v[76:79],v[136:139],a[160:163],v[76:79]
s_waitcnt lgkmcnt(0)
v_exp_f32 v72,v72
v_mfma_f32_16x16x32_bf16 v[76:79],v[140:143],a[164:167],v[76:79]
v_exp_f32 v81,v81
v_mfma_f32_16x16x32_bf16 v[84:87],v[140:143],a[188:191],0
v_cvt_pk_bf16_f32 v24,v80,v81
v_mfma_f32_16x16x32_bf16 v[84:87],v[136:139],a[184:187],v[84:87]
v_exp_f32 v73,v73
v_mfma_f32_16x16x32_bf16 v[84:87],v[132:135],a[180:183],v[84:87]
v_cvt_pk_bf16_f32 v20,v72,v73
v_mfma_f32_16x16x32_bf16 v[84:87],v[128:131],a[176:179],v[84:87]
buffer_store_dwordx4 v[156:159],v9,s[16:19],s27 offen offset:256 nt
buffer_load_dwordx4 v8,s[4:7],s20 offen offset:2048 lds
v_mfma_f32_16x16x32_bf16 v[84:87],v[124:127],a[172:175],v[84:87]
s_add_u32 s20,s20,12288
ds_read_b64_tr_b16 v[112:113],v2 offset:12288
v_mfma_f32_16x16x32_bf16 v[84:87],v[120:123],a[168:171],v[84:87]
s_add_u32 s27,s27,3072
ds_read_b64_tr_b16 v[114:115],v2 offset:18432
v_mfma_f32_16x16x32_bf16 v[92:95],v[120:123],a[192:195],0
ds_read_b64_tr_b16 v[116:117],v3 offset:12288
v_mfma_f32_16x16x32_bf16 v[92:95],v[124:127],a[196:199],v[92:95]
ds_read_b64_tr_b16 v[118:119],v3 offset:18432
v_mfma_f32_16x16x32_bf16 v[92:95],v[128:131],a[200:203],v[92:95]
v_mfma_f32_16x16x32_bf16 v[92:95],v[132:135],a[204:207],v[92:95]
v_mfma_f32_16x16x32_bf16 v[92:95],v[136:139],a[208:211],v[92:95]
v_mfma_f32_16x16x32_bf16 v[92:95],v[140:143],a[212:215],v[92:95]
v_mfma_f32_16x16x32_bf16 v[100:103],v[140:143],a[236:239],0
v_mfma_f32_16x16x32_bf16 v[100:103],v[136:139],a[232:235],v[100:103]
v_mfma_f32_16x16x32_bf16 v[100:103],v[132:135],a[228:231],v[100:103]
v_mfma_f32_16x16x32_bf16 v[100:103],v[128:131],a[224:227],v[100:103]
v_mfma_f32_16x16x32_bf16 v[100:103],v[124:127],a[220:223],v[100:103]
ds_read_b64_tr_b16 v[126:127],v5 offset:18432
v_mfma_f32_16x16x32_bf16 v[100:103],v[120:123],a[216:219],v[100:103]
s_waitcnt lgkmcnt(1)
ds_read_b64_tr_b16 v[122:123],v4 offset:18432
ds_read_b64_tr_b16 v[120:121],v4 offset:12288
ds_read_b64_tr_b16 v[124:125],v5 offset:12288
v_mfma_f32_16x16x32_bf16 v[160:163],v[112:115],v[44:47],v[160:163]
s_add_u32 m0,s29,0
ds_read_b64_tr_b16 v[128:129],v2 offset:12416
v_fma_f32 v82,v82,s36,v14
v_mfma_f32_16x16x32_bf16 v[164:167],v[116:119],v[44:47],v[164:167]
ds_read_b64_tr_b16 v[130:131],v2 offset:18560
v_fma_f32 v83,v83,s36,v14
v_mfma_f32_16x16x32_bf16 v[212:215],v[116:119],v[48:51],v[212:215]
ds_read_b64_tr_b16 v[132:133],v3 offset:12416
v_fma_f32 v88,v88,s36,v15
v_mfma_f32_16x16x32_bf16 v[208:211],v[112:115],v[48:51],v[208:211]
ds_read_b64_tr_b16 v[134:135],v3 offset:18560
v_fma_f32 v89,v89,s36,v15
v_mfma_f32_16x16x32_bf16 a[0:3],v[112:115],v[52:55],a[0:3]
ds_read_b64_tr_b16 v[136:137],v4 offset:12416
v_fma_f32 v90,v90,s36,v15
v_mfma_f32_16x16x32_bf16 a[4:7],v[116:119],v[52:55],a[4:7]
ds_read_b64_tr_b16 v[138:139],v4 offset:18560
v_fma_f32 v91,v91,s36,v15
v_mfma_f32_16x16x32_bf16 a[52:55],v[116:119],v[56:59],a[52:55]
buffer_load_dwordx4 v6,s[12:15],s28 offen offset:0 nt lds
v_mfma_f32_16x16x32_bf16 a[48:51],v[112:115],v[56:59],a[48:51]
s_waitcnt lgkmcnt(5)
ds_read_b64_tr_b16 v[140:141],v5 offset:12416
v_fma_f32 v96,v96,s36,v16
v_mfma_f32_16x16x32_bf16 a[56:59],v[120:123],v[56:59],a[56:59]
ds_read_b64_tr_b16 v[142:143],v5 offset:18560
v_fma_f32 v97,v97,s36,v16
v_mfma_f32_16x16x32_bf16 a[60:63],v[124:127],v[56:59],a[60:63]
ds_read_b64_tr_b16 v[112:113],v2 offset:12544
v_fma_f32 v98,v98,s36,v16
v_mfma_f32_16x16x32_bf16 a[12:15],v[124:127],v[52:55],a[12:15]
ds_read_b64_tr_b16 v[114:115],v2 offset:18688
v_fma_f32 v99,v99,s36,v16
v_mfma_f32_16x16x32_bf16 a[8:11],v[120:123],v[52:55],a[8:11]
ds_read_b64_tr_b16 v[116:117],v3 offset:12544
v_fma_f32 v76,v76,s36,v13
v_mfma_f32_16x16x32_bf16 v[216:219],v[120:123],v[48:51],v[216:219]
ds_read_b64_tr_b16 v[118:119],v3 offset:18688
v_fma_f32 v77,v77,s36,v13
v_mfma_f32_16x16x32_bf16 v[220:223],v[124:127],v[48:51],v[220:223]
buffer_load_dwordx4 v7,s[12:15],s28 offen offset:1024 nt lds
v_mfma_f32_16x16x32_bf16 v[172:175],v[124:127],v[44:47],v[172:175]
ds_read_b64_tr_b16 v[124:125],v5 offset:12544
v_fma_f32 v78,v78,s36,v13
v_mfma_f32_16x16x32_bf16 v[168:171],v[120:123],v[44:47],v[168:171]
s_waitcnt lgkmcnt(5)
ds_read_b64_tr_b16 v[120:121],v4 offset:12544
v_fma_f32 v79,v79,s36,v13
v_mfma_f32_16x16x32_bf16 v[176:179],v[128:131],v[44:47],v[176:179]
ds_read_b64_tr_b16 v[122:123],v4 offset:18688
v_fma_f32 v84,v84,s36,v14
v_mfma_f32_16x16x32_bf16 v[180:183],v[132:135],v[44:47],v[180:183]
ds_read_b64_tr_b16 v[126:127],v5 offset:18688
v_fma_f32 v85,v85,s36,v14
v_mfma_f32_16x16x32_bf16 v[228:231],v[132:135],v[48:51],v[228:231]
v_exp_f32 v82,v82
v_mfma_f32_16x16x32_bf16 v[224:227],v[128:131],v[48:51],v[224:227]
v_exp_f32 v83,v83
v_mfma_f32_16x16x32_bf16 a[16:19],v[128:131],v[52:55],a[16:19]
v_cvt_pk_bf16_f32 v25,v82,v83
v_fma_f32 v86,v86,s36,v14
v_mfma_f32_16x16x32_bf16 a[20:23],v[132:135],v[52:55],a[20:23]
buffer_load_dwordx4 v8,s[12:15],s28 offen offset:2048 nt lds
v_mfma_f32_16x16x32_bf16 a[68:71],v[132:135],v[56:59],a[68:71]
s_add_u32 s28,s28,3072
v_exp_f32 v88,v88
v_mfma_f32_16x16x32_bf16 a[64:67],v[128:131],v[56:59],a[64:67]
s_add_u32 s29,s29,3072
v_exp_f32 v89,v89
v_mfma_f32_16x16x32_bf16 a[72:75],v[136:139],v[56:59],a[72:75]
s_cmp_eq_u32 s38,1
v_exp_f32 v90,v90
v_mfma_f32_16x16x32_bf16 a[76:79],v[140:143],v[56:59],a[76:79]
s_cselect_b32 s21,s26,s21
v_exp_f32 v91,v91
v_mfma_f32_16x16x32_bf16 a[28:31],v[140:143],v[52:55],a[28:31]
s_add_u32 m0,s23,12288
v_cvt_pk_bf16_f32 v28,v88,v89
v_cvt_pk_bf16_f32 v29,v90,v91
v_mfma_f32_16x16x32_bf16 a[24:27],v[136:139],v[52:55],a[24:27]
v_exp_f32 v96,v96
v_mfma_f32_16x16x32_bf16 v[232:235],v[136:139],v[48:51],v[232:235]
v_exp_f32 v97,v97
v_mfma_f32_16x16x32_bf16 v[236:239],v[140:143],v[48:51],v[236:239]
v_exp_f32 v98,v98
v_mfma_f32_16x16x32_bf16 v[188:191],v[140:143],v[44:47],v[188:191]
v_exp_f32 v99,v99
v_mfma_f32_16x16x32_bf16 v[184:187],v[136:139],v[44:47],v[184:187]
s_waitcnt lgkmcnt(0)
v_cvt_pk_bf16_f32 v32,v96,v97
v_cvt_pk_bf16_f32 v33,v98,v99
v_mfma_f32_16x16x32_bf16 v[192:195],v[112:115],v[44:47],v[192:195]
s_waitcnt vmcnt(12)
v_exp_f32 v76,v76
v_mfma_f32_16x16x32_bf16 v[196:199],v[116:119],v[44:47],v[196:199]
s_barrier
v_mfma_f32_16x16x32_bf16 v[244:247],v[116:119],v[48:51],v[244:247]
ds_read_b128 v[140:143],v1 offset:128
v_fma_f32 v87,v87,s36,v14
v_mfma_f32_16x16x32_bf16 v[240:243],v[112:115],v[48:51],v[240:243]
ds_read_b128 v[136:139],v0 offset:128
v_fma_f32 v92,v92,s36,v15
v_mfma_f32_16x16x32_bf16 a[32:35],v[112:115],v[52:55],a[32:35]
ds_read_b128 v[132:135],v1 offset:0
v_fma_f32 v93,v93,s36,v15
v_mfma_f32_16x16x32_bf16 a[36:39],v[116:119],v[52:55],a[36:39]
ds_read_b128 v[128:131],v0 offset:0
v_fma_f32 v94,v94,s36,v15
v_mfma_f32_16x16x32_bf16 a[84:87],v[116:119],v[56:59],a[84:87]
ds_read_b128 v[116:119],v1 offset:256
v_fma_f32 v95,v95,s36,v15
v_mfma_f32_16x16x32_bf16 a[80:83],v[112:115],v[56:59],a[80:83]
buffer_load_dwordx4 v6,s[8:11],s21 offen offset:0 lds
v_mfma_f32_16x16x32_bf16 a[88:91],v[120:123],v[56:59],a[88:91]
ds_read_b128 v[112:115],v0 offset:256
v_fma_f32 v100,v100,s36,v16
v_mfma_f32_16x16x32_bf16 a[92:95],v[124:127],v[56:59],a[92:95]
v_exp_f32 v77,v77
v_mfma_f32_16x16x32_bf16 a[44:47],v[124:127],v[52:55],a[44:47]
v_exp_f32 v78,v78
v_mfma_f32_16x16x32_bf16 a[40:43],v[120:123],v[52:55],a[40:43]
v_exp_f32 v79,v79
v_mfma_f32_16x16x32_bf16 v[248:251],v[120:123],v[48:51],v[248:251]
v_cvt_pk_bf16_f32 v22,v76,v77
v_cvt_pk_bf16_f32 v23,v78,v79
v_mfma_f32_16x16x32_bf16 v[252:255],v[124:127],v[48:51],v[252:255]
v_exp_f32 v84,v84
v_mfma_f32_16x16x32_bf16 v[204:207],v[124:127],v[44:47],v[204:207]
ds_read_b128 v[124:127],v1 offset:6144
v_fma_f32 v101,v101,s36,v16
v_mfma_f32_16x16x32_bf16 v[200:203],v[120:123],v[44:47],v[200:203]
s_waitcnt lgkmcnt(1)
ds_read_b128 v[120:123],v0 offset:6144
v_fma_f32 v102,v102,s36,v16
v_mfma_f32_16x16x32_bf16 v[72:75],v[116:119],a[164:167],0
buffer_load_dwordx4 v7,s[8:11],s21 offen offset:1024 lds
v_mfma_f32_16x16x32_bf16 v[72:75],v[112:115],a[160:163],v[72:75]
v_exp_f32 v85,v85
v_mfma_f32_16x16x32_bf16 v[72:75],v[140:143],a[156:159],v[72:75]
v_exp_f32 v86,v86
v_mfma_f32_16x16x32_bf16 v[72:75],v[136:139],a[152:155],v[72:75]
v_exp_f32 v87,v87
v_mfma_f32_16x16x32_bf16 v[72:75],v[132:135],a[148:151],v[72:75]
v_cvt_pk_bf16_f32 v26,v84,v85
v_cvt_pk_bf16_f32 v27,v86,v87
v_mfma_f32_16x16x32_bf16 v[72:75],v[128:131],a[144:147],v[72:75]
v_exp_f32 v92,v92
v_smfmac_f32_16x16x64_bf16 v[60:63],v[152:155],v[20:27],v18
v_fma_f32 v103,v103,s36,v16
v_mfma_f32_16x16x32_bf16 v[80:83],v[128:131],a[168:171],0
v_exp_f32 v93,v93
v_mfma_f32_16x16x32_bf16 v[80:83],v[132:135],a[172:175],v[80:83]
buffer_load_dwordx4 v8,s[8:11],s21 offen offset:2048 lds
v_mfma_f32_16x16x32_bf16 v[80:83],v[136:139],a[176:179],v[80:83]
s_add_u32 s21,s21,12288
v_exp_f32 v94,v94
v_mfma_f32_16x16x32_bf16 v[80:83],v[140:143],a[180:183],v[80:83]
s_add_u32 m0,s22,24576
v_exp_f32 v95,v95
v_mfma_f32_16x16x32_bf16 v[80:83],v[112:115],a[184:187],v[80:83]
v_cvt_pk_bf16_f32 v30,v92,v93
v_cvt_pk_bf16_f32 v31,v94,v95
v_mfma_f32_16x16x32_bf16 v[80:83],v[116:119],a[188:191],v[80:83]
v_exp_f32 v100,v100
v_mfma_f32_16x16x32_bf16 v[88:91],v[116:119],a[212:215],0
v_exp_f32 v101,v101
v_mfma_f32_16x16x32_bf16 v[88:91],v[112:115],a[208:211],v[88:91]
v_exp_f32 v102,v102
v_mfma_f32_16x16x32_bf16 v[88:91],v[140:143],a[204:207],v[88:91]
v_exp_f32 v103,v103
v_mfma_f32_16x16x32_bf16 v[88:91],v[136:139],a[200:203],v[88:91]
v_cvt_pk_bf16_f32 v34,v100,v101
v_cvt_pk_bf16_f32 v35,v102,v103
v_mfma_f32_16x16x32_bf16 v[88:91],v[132:135],a[196:199],v[88:91]
buffer_load_dwordx4 v6,s[4:7],s20 offen offset:0 lds
v_smfmac_f32_16x16x64_bf16 v[64:67],v[152:155],v[28:35],v18
v_fma_f32 v72,v72,s36,v13
v_mfma_f32_16x16x32_bf16 v[88:91],v[128:131],a[192:195],v[88:91]
v_fma_f32 v73,v73,s36,v13
v_fma_f32 v74,v74,s36,v13
v_mfma_f32_16x16x32_bf16 v[96:99],v[128:131],a[216:219],0
ds_read_b128 v[128:131],v0 offset:6272
v_fma_f32 v75,v75,s36,v13
v_mfma_f32_16x16x32_bf16 v[96:99],v[132:135],a[220:223],v[96:99]
ds_read_b128 v[132:135],v1 offset:6272
v_fma_f32 v80,v80,s36,v14
v_mfma_f32_16x16x32_bf16 v[96:99],v[136:139],a[224:227],v[96:99]
ds_read_b128 v[136:139],v0 offset:6400
v_fma_f32 v81,v81,s36,v14
v_mfma_f32_16x16x32_bf16 v[96:99],v[140:143],a[228:231],v[96:99]
ds_read_b128 v[140:143],v1 offset:6400
v_add_u32 v10,9216,v10
v_mfma_f32_16x16x32_bf16 v[96:99],v[112:115],a[232:235],v[96:99]
v_exp_f32 v72,v72
v_mfma_f32_16x16x32_bf16 v[96:99],v[116:119],a[236:239],v[96:99]
s_waitcnt lgkmcnt(4)
v_exp_f32 v73,v73
v_mfma_f32_16x16x32_bf16 v[76:79],v[120:123],a[144:147],0
buffer_load_dwordx4 v7,s[4:7],s20 offen offset:1024 lds
v_mfma_f32_16x16x32_bf16 v[76:79],v[124:127],a[148:151],v[76:79]
s_waitcnt lgkmcnt(3)
v_exp_f32 v74,v74
v_mfma_f32_16x16x32_bf16 v[76:79],v[128:131],a[152:155],v[76:79]
s_waitcnt lgkmcnt(2)
v_exp_f32 v75,v75
v_mfma_f32_16x16x32_bf16 v[76:79],v[132:135],a[156:159],v[76:79]
s_waitcnt lgkmcnt(0)
v_exp_f32 v80,v80
v_mfma_f32_16x16x32_bf16 v[76:79],v[136:139],a[160:163],v[76:79]
v_exp_f32 v81,v81
v_mfma_f32_16x16x32_bf16 v[76:79],v[140:143],a[164:167],v[76:79]
v_cvt_pk_bf16_f32 v44,v72,v73
v_cvt_pk_bf16_f32 v45,v74,v75
v_mfma_f32_16x16x32_bf16 v[84:87],v[140:143],a[188:191],0
v_cvt_pk_bf16_f32 v48,v80,v81
v_mfma_f32_16x16x32_bf16 v[84:87],v[136:139],a[184:187],v[84:87]
v_mfma_f32_16x16x32_bf16 v[84:87],v[132:135],a[180:183],v[84:87]
v_mfma_f32_16x16x32_bf16 v[84:87],v[128:131],a[176:179],v[84:87]
buffer_load_dwordx4 v8,s[4:7],s20 offen offset:2048 lds
v_mfma_f32_16x16x32_bf16 v[84:87],v[124:127],a[172:175],v[84:87]
s_add_u32 s20,s20,12288
s_add_u32 s38,s38,1
s_cmp_lt_u32 s38,2
v_mfma_f32_16x16x32_bf16 v[84:87],v[120:123],a[168:171],v[84:87]
ds_read_b64_tr_b16 v[112:113],v2 offset:24576
v_mfma_f32_16x16x32_bf16 v[92:95],v[120:123],a[192:195],0
ds_read_b64_tr_b16 v[114:115],v2 offset:30720
v_mfma_f32_16x16x32_bf16 v[92:95],v[124:127],a[196:199],v[92:95]
ds_read_b64_tr_b16 v[116:117],v3 offset:24576
v_mfma_f32_16x16x32_bf16 v[92:95],v[128:131],a[200:203],v[92:95]
ds_read_b64_tr_b16 v[118:119],v3 offset:30720
v_mfma_f32_16x16x32_bf16 v[92:95],v[132:135],a[204:207],v[92:95]
v_mfma_f32_16x16x32_bf16 v[92:95],v[136:139],a[208:211],v[92:95]
v_mfma_f32_16x16x32_bf16 v[92:95],v[140:143],a[212:215],v[92:95]
v_mfma_f32_16x16x32_bf16 v[100:103],v[140:143],a[236:239],0
v_mfma_f32_16x16x32_bf16 v[100:103],v[136:139],a[232:235],v[100:103]
v_mfma_f32_16x16x32_bf16 v[100:103],v[132:135],a[228:231],v[100:103]
v_mfma_f32_16x16x32_bf16 v[100:103],v[128:131],a[224:227],v[100:103]
v_mfma_f32_16x16x32_bf16 v[100:103],v[124:127],a[220:223],v[100:103]
ds_read_b64_tr_b16 v[124:125],v5 offset:24576
v_mfma_f32_16x16x32_bf16 v[100:103],v[120:123],a[216:219],v[100:103]
ds_read_b64_tr_b16 v[120:121],v4 offset:24576
ds_read_b64_tr_b16 v[122:123],v4 offset:30720
ds_read_b64_tr_b16 v[126:127],v5 offset:30720
s_cbranch_scc1 L_loop4w0
s_cmp_ge_u32 s69,6
s_cbranch_scc1 L_end4
s_cmp_eq_u32 s40,0
s_cbranch_scc1 L_tr44
s_branch L_tr45
L_tr45:
s_waitcnt vmcnt(42)
s_waitcnt lgkmcnt(3)
v_mfma_f32_16x16x32_bf16 v[160:163],v[112:115],v[20:23],v[160:163]
s_add_u32 m0,s24,0
ds_read_b128 a[144:147],v11 offset:0
v_fma_f32 v82,v82,s36,v14
v_mfma_f32_16x16x32_bf16 v[164:167],v[116:119],v[20:23],v[164:167]
ds_read_b128 a[148:151],v12 offset:0
v_fma_f32 v83,v83,s36,v14
v_mfma_f32_16x16x32_bf16 v[212:215],v[116:119],v[24:27],v[212:215]
ds_read_b128 a[152:155],v11 offset:128
v_fma_f32 v88,v88,s36,v15
v_mfma_f32_16x16x32_bf16 v[208:211],v[112:115],v[24:27],v[208:211]
ds_read_b128 a[156:159],v12 offset:128
v_fma_f32 v89,v89,s36,v15
v_mfma_f32_16x16x32_bf16 a[0:3],v[112:115],v[28:31],a[0:3]
ds_read_b128 a[160:163],v11 offset:256
v_fma_f32 v90,v90,s36,v15
v_mfma_f32_16x16x32_bf16 a[4:7],v[116:119],v[28:31],a[4:7]
ds_read_b128 a[164:167],v12 offset:256
v_fma_f32 v91,v91,s36,v15
ds_read_b64_tr_b16 v[128:129],v2 offset:24704
ds_read_b64_tr_b16 v[130:131],v2 offset:30848
ds_read_b64_tr_b16 v[132:133],v3 offset:24704
ds_read_b64_tr_b16 v[134:135],v3 offset:30848
ds_read_b64_tr_b16 v[136:137],v4 offset:24704
ds_read_b64_tr_b16 v[138:139],v4 offset:30848
ds_read_b64_tr_b16 v[140:141],v5 offset:24704
ds_read_b64_tr_b16 v[142:143],v5 offset:30848
ds_read_b128 a[168:171],v11 offset:6144
v_mfma_f32_16x16x32_bf16 a[52:55],v[116:119],v[32:35],a[52:55]
v_fma_f32 v96,v96,s36,v16
ds_read_b128 a[172:175],v12 offset:6144
v_mfma_f32_16x16x32_bf16 a[48:51],v[112:115],v[32:35],a[48:51]
s_waitcnt lgkmcnt(12)
v_fma_f32 v97,v97,s36,v16
ds_read_b128 a[176:179],v11 offset:6272
v_mfma_f32_16x16x32_bf16 a[56:59],v[120:123],v[32:35],a[56:59]
s_waitcnt lgkmcnt(11)
buffer_load_dwordx4 v6,s[12:15],s28 offen offset:0 nt lds
v_mfma_f32_16x16x32_bf16 a[60:63],v[124:127],v[32:35],a[60:63]
ds_read_b64_tr_b16 v[112:113],v2 offset:24832
ds_read_b128 a[180:183],v12 offset:6272
v_mfma_f32_16x16x32_bf16 a[12:15],v[124:127],v[28:31],a[12:15]
v_fma_f32 v98,v98,s36,v16
ds_read_b64_tr_b16 v[116:117],v3 offset:24832
ds_read_b64_tr_b16 v[118:119],v3 offset:30976
ds_read_b64_tr_b16 v[114:115],v2 offset:30976
ds_read_b128 a[184:187],v11 offset:6400
v_mfma_f32_16x16x32_bf16 a[8:11],v[120:123],v[28:31],a[8:11]
v_fma_f32 v99,v99,s36,v16
ds_read_b128 a[188:191],v12 offset:6400
v_mfma_f32_16x16x32_bf16 v[216:219],v[120:123],v[24:27],v[216:219]
buffer_load_dwordx4 v7,s[12:15],s28 offen offset:1024 nt lds
v_mfma_f32_16x16x32_bf16 v[220:223],v[124:127],v[24:27],v[220:223]
v_fma_f32 v76,v76,s36,v13
v_fma_f32 v77,v77,s36,v13
v_mfma_f32_16x16x32_bf16 v[172:175],v[124:127],v[20:23],v[172:175]
ds_read_b64_tr_b16 v[124:125],v5 offset:24832
v_fma_f32 v78,v78,s36,v13
v_mfma_f32_16x16x32_bf16 v[168:171],v[120:123],v[20:23],v[168:171]
s_waitcnt lgkmcnt(6)
ds_read_b64_tr_b16 v[120:121],v4 offset:24832
v_fma_f32 v79,v79,s36,v13
v_mfma_f32_16x16x32_bf16 v[176:179],v[128:131],v[20:23],v[176:179]
ds_read_b64_tr_b16 v[122:123],v4 offset:30976
v_fma_f32 v84,v84,s36,v14
v_mfma_f32_16x16x32_bf16 v[180:183],v[132:135],v[20:23],v[180:183]
ds_read_b64_tr_b16 v[126:127],v5 offset:30976
v_fma_f32 v85,v85,s36,v14
v_mfma_f32_16x16x32_bf16 v[228:231],v[132:135],v[24:27],v[228:231]
v_fma_f32 v86,v86,s36,v14
v_fma_f32 v87,v87,s36,v14
v_mfma_f32_16x16x32_bf16 v[224:227],v[128:131],v[24:27],v[224:227]
buffer_load_dwordx4 v8,s[12:15],s28 offen offset:2048 nt lds
v_mfma_f32_16x16x32_bf16 a[16:19],v[128:131],v[28:31],a[16:19]
s_add_u32 s28,s28,3072
v_fma_f32 v92,v92,s36,v15
v_fma_f32 v93,v93,s36,v15
v_mfma_f32_16x16x32_bf16 a[20:23],v[132:135],v[28:31],a[20:23]
s_add_u32 m0,s24,3072
v_fma_f32 v94,v94,s36,v15
v_fma_f32 v95,v95,s36,v15
v_mfma_f32_16x16x32_bf16 a[68:71],v[132:135],v[32:35],a[68:71]
v_fma_f32 v100,v100,s36,v16
v_fma_f32 v101,v101,s36,v16
v_mfma_f32_16x16x32_bf16 a[64:67],v[128:131],v[32:35],a[64:67]
v_fma_f32 v102,v102,s36,v16
v_fma_f32 v103,v103,s36,v16
v_mfma_f32_16x16x32_bf16 a[72:75],v[136:139],v[32:35],a[72:75]
v_exp_f32 v82,v82
v_mfma_f32_16x16x32_bf16 a[76:79],v[140:143],v[32:35],a[76:79]
v_exp_f32 v83,v83
v_mfma_f32_16x16x32_bf16 a[28:31],v[140:143],v[28:31],a[28:31]
v_exp_f32 v88,v88
v_mfma_f32_16x16x32_bf16 a[24:27],v[136:139],v[28:31],a[24:27]
buffer_load_dwordx4 v6,s[12:15],s28 offen offset:0 nt lds
v_mfma_f32_16x16x32_bf16 v[232:235],v[136:139],v[24:27],v[232:235]
v_exp_f32 v89,v89
v_mfma_f32_16x16x32_bf16 v[236:239],v[140:143],v[24:27],v[236:239]
v_exp_f32 v90,v90
v_mfma_f32_16x16x32_bf16 v[188:191],v[140:143],v[20:23],v[188:191]
v_exp_f32 v91,v91
v_mfma_f32_16x16x32_bf16 v[184:187],v[136:139],v[20:23],v[184:187]
s_waitcnt lgkmcnt(0)
v_exp_f32 v96,v96
v_mfma_f32_16x16x32_bf16 v[192:195],v[112:115],v[20:23],v[192:195]
v_exp_f32 v97,v97
v_mfma_f32_16x16x32_bf16 v[196:199],v[116:119],v[20:23],v[196:199]
v_exp_f32 v98,v98
v_mfma_f32_16x16x32_bf16 v[244:247],v[116:119],v[24:27],v[244:247]
v_exp_f32 v99,v99
v_mfma_f32_16x16x32_bf16 v[240:243],v[112:115],v[24:27],v[240:243]
buffer_load_dwordx4 v7,s[12:15],s28 offen offset:1024 nt lds
v_mfma_f32_16x16x32_bf16 a[32:35],v[112:115],v[28:31],a[32:35]
v_exp_f32 v76,v76
v_mfma_f32_16x16x32_bf16 a[36:39],v[116:119],v[28:31],a[36:39]
v_exp_f32 v77,v77
v_mfma_f32_16x16x32_bf16 a[84:87],v[116:119],v[32:35],a[84:87]
v_exp_f32 v78,v78
v_mfma_f32_16x16x32_bf16 a[80:83],v[112:115],v[32:35],a[80:83]
v_exp_f32 v79,v79
v_mfma_f32_16x16x32_bf16 a[88:91],v[120:123],v[32:35],a[88:91]
v_exp_f32 v84,v84
v_mfma_f32_16x16x32_bf16 a[92:95],v[124:127],v[32:35],a[92:95]
v_exp_f32 v85,v85
v_mfma_f32_16x16x32_bf16 a[44:47],v[124:127],v[28:31],a[44:47]
v_exp_f32 v86,v86
v_mfma_f32_16x16x32_bf16 a[40:43],v[120:123],v[28:31],a[40:43]
buffer_load_dwordx4 v8,s[12:15],s28 offen offset:2048 nt lds
s_waitcnt vmcnt(20)
s_barrier
v_mfma_f32_16x16x32_bf16 v[248:251],v[120:123],v[24:27],v[248:251]
s_add_u32 s28,s28,3072
ds_read_b64_tr_b16 v[128:129],v2 offset:0
v_exp_f32 v87,v87
v_mfma_f32_16x16x32_bf16 v[252:255],v[124:127],v[24:27],v[252:255]
s_add_u32 m0,s22,0
ds_read_b64_tr_b16 v[130:131],v2 offset:6144
buffer_load_dwordx4 v6,s[4:7],s25 offen offset:0 lds
v_mfma_f32_16x16x32_bf16 v[204:207],v[124:127],v[20:23],v[204:207]
buffer_load_dwordx4 v7,s[4:7],s25 offen offset:1024 lds
v_mfma_f32_16x16x32_bf16 v[200:203],v[120:123],v[20:23],v[200:203]
buffer_load_dwordx4 v8,s[4:7],s25 offen offset:2048 lds
ds_read_b64_tr_b16 v[132:133],v3 offset:0
ds_read_b64_tr_b16 v[134:135],v3 offset:6144
ds_read_b64_tr_b16 v[136:137],v4 offset:0
ds_read_b64_tr_b16 v[138:139],v4 offset:6144
ds_read_b64_tr_b16 v[140:141],v5 offset:0
ds_read_b64_tr_b16 v[142:143],v5 offset:6144
v_exp_f32 v92,v92
v_exp_f32 v93,v93
v_exp_f32 v94,v94
v_exp_f32 v95,v95
v_exp_f32 v100,v100
v_exp_f32 v101,v101
v_exp_f32 v102,v102
v_exp_f32 v103,v103
v_cvt_pk_bf16_f32 v49,v82,v83
v_cvt_pk_bf16_f32 v52,v88,v89
v_cvt_pk_bf16_f32 v53,v90,v91
v_cvt_pk_bf16_f32 v56,v96,v97
v_cvt_pk_bf16_f32 v57,v98,v99
v_cvt_pk_bf16_f32 v46,v76,v77
v_cvt_pk_bf16_f32 v47,v78,v79
v_cvt_pk_bf16_f32 v50,v84,v85
v_cvt_pk_bf16_f32 v51,v86,v87
v_cvt_pk_bf16_f32 v54,v92,v93
v_cvt_pk_bf16_f32 v55,v94,v95
v_smfmac_f32_16x16x64_bf16 v[60:63],v[152:155],v[44:51],v18
v_cvt_pk_bf16_f32 v58,v100,v101
v_cvt_pk_bf16_f32 v59,v102,v103
v_subrev_u32 v10,18432,v10
s_nop 0
v_smfmac_f32_16x16x64_bf16 v[64:67],v[152:155],v[52:59],v18
s_waitcnt lgkmcnt(0)
v_mfma_f32_16x16x32_bf16 v[160:163],v[128:131],v[44:47],v[160:163]
s_add_u32 s87,s42,18432
ds_read_b64_tr_b16 v[112:113],v2 offset:128
v_mbcnt_lo_u32_b32 v39,-1,0
v_mfma_f32_16x16x32_bf16 v[164:167],v[132:135],v[44:47],v[164:167]
ds_read_b64_tr_b16 v[114:115],v2 offset:6272
v_mbcnt_hi_u32_b32 v39,-1,v39
v_mfma_f32_16x16x32_bf16 v[212:215],v[132:135],v[48:51],v[212:215]
ds_read_b64_tr_b16 v[116:117],v3 offset:128
v_and_b32 v38,7,v39
v_mfma_f32_16x16x32_bf16 v[208:211],v[128:131],v[48:51],v[208:211]
ds_read_b64_tr_b16 v[118:119],v3 offset:6272
v_add_f32 v60,v60,v61
v_mfma_f32_16x16x32_bf16 a[0:3],v[128:131],v[52:55],a[0:3]
ds_read_b64_tr_b16 v[120:121],v4 offset:128
v_add_f32 v62,v62,v63
v_mfma_f32_16x16x32_bf16 a[4:7],v[132:135],v[52:55],a[4:7]
ds_read_b64_tr_b16 v[122:123],v4 offset:6272
ds_read_b64_tr_b16 v[124:125],v5 offset:128
ds_read_b64_tr_b16 v[126:127],v5 offset:6272
v_mfma_f32_16x16x32_bf16 a[52:55],v[132:135],v[56:59],a[52:55]
ds_read_b64_tr_b16 v[132:133],v3 offset:256
v_add_f32 v64,v64,v65
v_mfma_f32_16x16x32_bf16 a[48:51],v[128:131],v[56:59],a[48:51]
ds_read_b64_tr_b16 v[128:129],v2 offset:256
v_add_f32 v66,v66,v67
v_mfma_f32_16x16x32_bf16 a[56:59],v[136:139],v[56:59],a[56:59]
ds_read_b64_tr_b16 v[130:131],v2 offset:6400
v_max3_f32 v19,v60,v62,v64
v_mfma_f32_16x16x32_bf16 a[60:63],v[140:143],v[56:59],a[60:63]
ds_read_b64_tr_b16 v[134:135],v3 offset:6400
v_max_f32 v19,v19,v66
v_mfma_f32_16x16x32_bf16 a[12:15],v[140:143],v[52:55],a[12:15]
v_rcp_f32 v66,v66
v_mfma_f32_16x16x32_bf16 a[8:11],v[136:139],v[52:55],a[8:11]
v_accvgpr_read_b32 v80,a52
v_accvgpr_read_b32 v81,a53
v_mfma_f32_16x16x32_bf16 v[216:219],v[136:139],v[48:51],v[216:219]
v_accvgpr_read_b32 v82,a54
v_accvgpr_read_b32 v83,a55
v_mfma_f32_16x16x32_bf16 v[220:223],v[140:143],v[48:51],v[220:223]
v_accvgpr_read_b32 v72,a48
v_accvgpr_read_b32 v73,a49
v_mfma_f32_16x16x32_bf16 v[172:175],v[140:143],v[44:47],v[172:175]
ds_read_b64_tr_b16 v[140:141],v5 offset:256
v_accvgpr_read_b32 v74,a50
v_mfma_f32_16x16x32_bf16 v[168:171],v[136:139],v[44:47],v[168:171]
s_waitcnt lgkmcnt(2)
ds_read_b64_tr_b16 v[136:137],v4 offset:256
v_accvgpr_read_b32 v75,a51
v_mfma_f32_16x16x32_bf16 v[176:179],v[112:115],v[44:47],v[176:179]
ds_read_b64_tr_b16 v[138:139],v4 offset:6400
v_accvgpr_read_b32 v88,a56
v_mfma_f32_16x16x32_bf16 v[180:183],v[116:119],v[44:47],v[180:183]
ds_read_b64_tr_b16 v[142:143],v5 offset:6400
v_accvgpr_read_b32 v89,a57
v_mfma_f32_16x16x32_bf16 v[228:231],v[116:119],v[48:51],v[228:231]
v_accvgpr_read_b32 v90,a58
v_accvgpr_read_b32 v91,a59
v_mfma_f32_16x16x32_bf16 v[224:227],v[112:115],v[48:51],v[224:227]
v_accvgpr_read_b32 v96,a60
v_accvgpr_read_b32 v97,a61
v_mfma_f32_16x16x32_bf16 a[16:19],v[112:115],v[52:55],a[16:19]
v_accvgpr_read_b32 v98,a62
v_accvgpr_read_b32 v99,a63
v_mfma_f32_16x16x32_bf16 a[20:23],v[116:119],v[52:55],a[20:23]
v_cmp_ngt_f32 vcc,s37,v19
v_lshrrev_b32 v19,5,v39
v_mfma_f32_16x16x32_bf16 a[68:71],v[116:119],v[56:59],a[68:71]
v_xor_b32 v38,v38,v19
v_and_b32 v19,15,v39
v_mfma_f32_16x16x32_bf16 a[64:67],v[112:115],v[56:59],a[64:67]
s_cmp_lg_u64 vcc,0
v_lshl_add_u32 v19,v19,7,s24
v_lshl_add_u32 v19,v38,4,v19
v_mfma_f32_16x16x32_bf16 a[72:75],v[120:123],v[56:59],a[72:75]
s_cselect_b32 s62,s32,0
v_bfe_u32 v38,v39,4,1
v_lshl_add_u32 v36,v38,3,v19
v_mfma_f32_16x16x32_bf16 a[76:79],v[124:127],v[56:59],a[76:79]
s_or_b32 s31,s31,s62
v_xor_b32 v37,32,v36
v_bfe_u32 v19,v39,3,1
v_mfma_f32_16x16x32_bf16 a[28:31],v[124:127],v[52:55],a[28:31]
s_lshl_b32 s32,s32,1
v_xor_b32 v38,64,v36
v_xor_b32 v39,96,v36
v_lshlrev_b32 v19,11,v19
v_accvgpr_read_b32 v84,a68
v_accvgpr_read_b32 v85,a69
v_pk_mul_f32 v[72:73],v[72:73],v[66:67] op_sel_hi:[1,0]
v_pk_mul_f32 v[74:75],v[74:75],v[66:67] op_sel_hi:[1,0]
v_pk_mul_f32 v[80:81],v[80:81],v[66:67] op_sel_hi:[1,0]
v_pk_mul_f32 v[82:83],v[82:83],v[66:67] op_sel_hi:[1,0]
v_pk_mul_f32 v[84:85],v[84:85],v[66:67] op_sel_hi:[1,0]
v_accvgpr_read_b32 v86,a70
v_accvgpr_read_b32 v87,a71
v_pk_mul_f32 v[86:87],v[86:87],v[66:67] op_sel_hi:[1,0]
v_accvgpr_read_b32 v76,a64
v_accvgpr_read_b32 v77,a65
v_pk_mul_f32 v[76:77],v[76:77],v[66:67] op_sel_hi:[1,0]
v_accvgpr_read_b32 v78,a66
v_accvgpr_read_b32 v79,a67
v_pk_mul_f32 v[78:79],v[78:79],v[66:67] op_sel_hi:[1,0]
v_accvgpr_read_b32 v92,a72
v_accvgpr_read_b32 v93,a73
v_mfma_f32_16x16x32_bf16 a[24:27],v[120:123],v[52:55],a[24:27]
s_add_u32 m0,s24,6144
v_accvgpr_read_b32 v94,a74
buffer_load_dwordx4 v6,s[12:15],s28 offen offset:0 nt lds
buffer_load_dwordx4 v7,s[12:15],s28 offen offset:1024 nt lds
buffer_load_dwordx4 v8,s[12:15],s28 offen offset:2048 nt lds
v_pk_mul_f32 v[88:89],v[88:89],v[66:67] op_sel_hi:[1,0]
v_pk_mul_f32 v[90:91],v[90:91],v[66:67] op_sel_hi:[1,0]
v_pk_mul_f32 v[92:93],v[92:93],v[66:67] op_sel_hi:[1,0]
v_accvgpr_read_b32 v95,a75
v_pk_mul_f32 v[94:95],v[94:95],v[66:67] op_sel_hi:[1,0]
v_accvgpr_read_b32 v100,a76
v_accvgpr_read_b32 v101,a77
v_mfma_f32_16x16x32_bf16 v[232:235],v[120:123],v[48:51],v[232:235]
s_add_u32 s28,s28,3072
v_accvgpr_read_b32 v102,a78
v_accvgpr_read_b32 v103,a79
v_cvt_pk_bf16_f32 v72,v72,v73
v_cvt_pk_bf16_f32 v76,v76,v77
v_cvt_pk_bf16_f32 v80,v80,v81
v_pk_mul_f32 v[96:97],v[96:97],v[66:67] op_sel_hi:[1,0]
v_pk_mul_f32 v[98:99],v[98:99],v[66:67] op_sel_hi:[1,0]
v_pk_mul_f32 v[100:101],v[100:101],v[66:67] op_sel_hi:[1,0]
v_pk_mul_f32 v[102:103],v[102:103],v[66:67] op_sel_hi:[1,0]
v_cvt_pk_bf16_f32 v84,v84,v85
v_cvt_pk_bf16_f32 v73,v74,v75
v_mfma_f32_16x16x32_bf16 v[236:239],v[124:127],v[48:51],v[236:239]
s_add_u32 m0,s24,9216
v_cvt_pk_bf16_f32 v77,v78,v79
v_cvt_pk_bf16_f32 v88,v88,v89
v_mfma_f32_16x16x32_bf16 v[188:191],v[124:127],v[44:47],v[188:191]
buffer_load_dwordx4 v6,s[12:15],s28 offen offset:0 nt lds
v_mfma_f32_16x16x32_bf16 v[184:187],v[120:123],v[44:47],v[184:187]
buffer_load_dwordx4 v7,s[12:15],s28 offen offset:1024 nt lds
v_mfma_f32_16x16x32_bf16 v[192:195],v[128:131],v[44:47],v[192:195]
buffer_load_dwordx4 v8,s[12:15],s28 offen offset:2048 nt lds
s_waitcnt lgkmcnt(0)
v_mfma_f32_16x16x32_bf16 v[196:199],v[132:135],v[44:47],v[196:199]
s_add_u32 s28,s28,3072
ds_write2st64_b64 v36,v[72:73],v[76:77] offset0:36 offset1:40
v_mfma_f32_16x16x32_bf16 v[244:247],v[132:135],v[48:51],v[244:247]
s_add_u32 m0,s23,0
v_cvt_pk_bf16_f32 v92,v92,v93
v_cvt_pk_bf16_f32 v81,v82,v83
v_mfma_f32_16x16x32_bf16 v[240:243],v[128:131],v[48:51],v[240:243]
v_cvt_pk_bf16_f32 v85,v86,v87
v_cvt_pk_bf16_f32 v96,v96,v97
v_mfma_f32_16x16x32_bf16 a[32:35],v[128:131],v[52:55],a[32:35]
v_cvt_pk_bf16_f32 v100,v100,v101
v_cvt_pk_bf16_f32 v89,v90,v91
v_mfma_f32_16x16x32_bf16 a[36:39],v[132:135],v[52:55],a[36:39]
ds_write2st64_b64 v37,v[80:81],v[84:85] offset0:36 offset1:40
v_mfma_f32_16x16x32_bf16 a[84:87],v[132:135],v[56:59],a[84:87]
v_cvt_pk_bf16_f32 v93,v94,v95
v_cvt_pk_bf16_f32 v97,v98,v99
v_mfma_f32_16x16x32_bf16 a[80:83],v[128:131],v[56:59],a[80:83]
v_cvt_pk_bf16_f32 v101,v102,v103
v_rcp_f32 v64,v64
v_mfma_f32_16x16x32_bf16 a[88:91],v[136:139],v[56:59],a[88:91]
v_accvgpr_read_b32 v102,a2
v_accvgpr_read_b32 v103,a3
v_mfma_f32_16x16x32_bf16 a[92:95],v[140:143],v[56:59],a[92:95]
ds_write2st64_b64 v38,v[88:89],v[92:93] offset0:36 offset1:40
v_mfma_f32_16x16x32_bf16 a[44:47],v[140:143],v[52:55],a[44:47]
s_waitcnt vmcnt(21)
v_accvgpr_read_b32 v80,a84
ds_read_b128 a[192:195],v11 offset:12288
v_accvgpr_read_b32 v81,a85
ds_read_b128 a[196:199],v12 offset:12288
v_pk_mul_f32 v[80:81],v[80:81],v[66:67] op_sel_hi:[1,0]
ds_read_b128 a[200:203],v11 offset:12416
v_accvgpr_read_b32 v82,a86
ds_read_b128 a[204:207],v12 offset:12416
v_accvgpr_read_b32 v83,a87
ds_read_b128 a[208:211],v11 offset:12544
v_pk_mul_f32 v[82:83],v[82:83],v[66:67] op_sel_hi:[1,0]
ds_read_b128 a[212:215],v12 offset:12544
v_accvgpr_read_b32 v76,a80
ds_write2st64_b64 v39,v[96:97],v[100:101] offset0:36 offset1:40
v_accvgpr_read_b32 v77,a81
v_pk_mul_f32 v[76:77],v[76:77],v[66:67] op_sel_hi:[1,0]
v_accvgpr_read_b32 v78,a82
ds_read_b128 v[156:159],v10 offset:18432
v_accvgpr_read_b32 v79,a83
ds_read_b128 v[104:107],v10 offset:19456
v_pk_mul_f32 v[78:79],v[78:79],v[66:67] op_sel_hi:[1,0]
v_accvgpr_read_b32 v84,a88
v_accvgpr_read_b32 v85,a89
v_mfma_f32_16x16x32_bf16 a[40:43],v[136:139],v[52:55],a[40:43]
ds_read_b128 v[108:111],v10 offset:20480
v_cvt_pk_bf16_f32 v76,v76,v77
ds_read_b128 v[72:75],v10 offset:21504
v_pk_mul_f32 v[84:85],v[84:85],v[66:67] op_sel_hi:[1,0]
v_accvgpr_read_b32 v86,a90
v_accvgpr_read_b32 v87,a91
v_pk_mul_f32 v[86:87],v[86:87],v[66:67] op_sel_hi:[1,0]
v_cvt_pk_bf16_f32 v80,v80,v81
v_cvt_pk_bf16_f32 v77,v78,v79
v_mfma_f32_16x16x32_bf16 v[248:251],v[136:139],v[48:51],v[248:251]
s_waitcnt lgkmcnt(3)
ds_write_b64 v36,v[76:77] offset:18432
v_add_u32 v36,v36,v19
v_cvt_pk_bf16_f32 v84,v84,v85
buffer_store_dwordx4 v[156:159],v9,s[16:19],s87 offen offset:0 nt
v_pk_mul_f32 v[102:103],v[102:103],v[64:65] op_sel_hi:[1,0]
v_cvt_pk_bf16_f32 v81,v82,v83
v_cvt_pk_bf16_f32 v85,v86,v87
v_accvgpr_read_b32 v90,a94
v_accvgpr_read_b32 v91,a95
v_pk_mul_f32 v[90:91],v[90:91],v[66:67] op_sel_hi:[1,0]
v_accvgpr_read_b32 v88,a92
v_accvgpr_read_b32 v89,a93
v_pk_mul_f32 v[88:89],v[88:89],v[66:67] op_sel_hi:[1,0]
ds_write_b64 v37,v[80:81] offset:18432
s_waitcnt lgkmcnt(2)
buffer_store_dwordx4 v[104:107],v9,s[16:19],s87 offen offset:3072 nt
v_add_u32 v37,v37,v19
v_accvgpr_read_b32 v100,a0
v_accvgpr_read_b32 v101,a1
v_pk_mul_f32 v[100:101],v[100:101],v[64:65] op_sel_hi:[1,0]
v_accvgpr_read_b32 v78,a18
v_accvgpr_read_b32 v79,a19
v_pk_mul_f32 v[78:79],v[78:79],v[64:65] op_sel_hi:[1,0]
s_waitcnt vmcnt(8)
s_barrier
buffer_store_dwordx4 v[108:111],v9,s[16:19],s87 offen offset:128 nt
ds_read_b128 v[112:115],v0 offset:0
v_accvgpr_read_b32 v76,a16
ds_read_b128 v[116:119],v1 offset:0
v_accvgpr_read_b32 v77,a17
ds_read_b128 v[120:123],v0 offset:128
v_pk_mul_f32 v[76:77],v[76:77],v[64:65] op_sel_hi:[1,0]
ds_write_b64 v38,v[84:85] offset:18432
buffer_load_dwordx4 v6,s[8:11],s25 offen offset:0 lds
ds_read_b128 v[124:127],v1 offset:128
buffer_store_dwordx4 v[72:75],v9,s[16:19],s87 offen offset:3200 nt
ds_read_b128 v[128:131],v0 offset:256
v_add_u32 v38,v38,v19
ds_read_b128 v[132:135],v1 offset:256
v_accvgpr_read_b32 v82,a6
v_accvgpr_read_b32 v83,a7
v_pk_mul_f32 v[82:83],v[82:83],v[64:65] op_sel_hi:[1,0]
v_accvgpr_read_b32 v86,a26
v_accvgpr_read_b32 v87,a27
v_pk_mul_f32 v[86:87],v[86:87],v[64:65] op_sel_hi:[1,0]
v_accvgpr_read_b32 v80,a4
v_accvgpr_read_b32 v81,a5
v_pk_mul_f32 v[80:81],v[80:81],v[64:65] op_sel_hi:[1,0]
v_accvgpr_read_b32 v104,a20
v_accvgpr_read_b32 v105,a21
v_pk_mul_f32 v[104:105],v[104:105],v[64:65] op_sel_hi:[1,0]
v_accvgpr_read_b32 v106,a22
v_accvgpr_read_b32 v107,a23
v_pk_mul_f32 v[106:107],v[106:107],v[64:65] op_sel_hi:[1,0]
v_accvgpr_read_b32 v108,a8
v_accvgpr_read_b32 v109,a9
v_pk_mul_f32 v[108:109],v[108:109],v[64:65] op_sel_hi:[1,0]
v_accvgpr_read_b32 v110,a10
v_accvgpr_read_b32 v111,a11
buffer_load_dwordx4 v7,s[8:11],s25 offen offset:1024 lds
v_pk_mul_f32 v[110:111],v[110:111],v[64:65] op_sel_hi:[1,0]
v_accvgpr_read_b32 v84,a24
v_accvgpr_read_b32 v85,a25
v_pk_mul_f32 v[84:85],v[84:85],v[64:65] op_sel_hi:[1,0]
v_cvt_pk_bf16_f32 v88,v88,v89
v_cvt_pk_bf16_f32 v89,v90,v91
v_mfma_f32_16x16x32_bf16 v[252:255],v[140:143],v[48:51],v[252:255]
ds_write_b64 v39,v[88:89] offset:18432
v_mfma_f32_16x16x32_bf16 v[204:207],v[140:143],v[44:47],v[204:207]
ds_read_b128 v[92:95],v10 offset:18432
v_add_u32 v39,v39,v19
v_mfma_f32_16x16x32_bf16 v[200:203],v[136:139],v[44:47],v[200:203]
s_waitcnt lgkmcnt(2)
ds_read_b128 v[96:99],v10 offset:19456
v_cvt_pk_bf16_f32 v100,v100,v101
v_mfma_f32_16x16x32_bf16 v[72:75],v[112:115],a[144:147],0
ds_read_b128 v[136:139],v0 offset:6144
v_cvt_pk_bf16_f32 v76,v76,v77
ds_read_b128 v[140:143],v1 offset:6144
v_cvt_pk_bf16_f32 v101,v102,v103
v_cvt_pk_bf16_f32 v77,v78,v79
buffer_load_dwordx4 v8,s[8:11],s25 offen offset:2048 lds
ds_write2st64_b64 v36,v[100:101],v[76:77] offset0:24 offset1:26
v_accvgpr_read_b32 v90,a14
v_accvgpr_read_b32 v91,a15
v_pk_mul_f32 v[90:91],v[90:91],v[64:65] op_sel_hi:[1,0]
s_waitcnt lgkmcnt(4)
buffer_store_dwordx4 v[92:95],v9,s[16:19],s87 offen offset:256 nt
v_accvgpr_read_b32 v88,a12
v_accvgpr_read_b32 v89,a13
v_pk_mul_f32 v[88:89],v[88:89],v[64:65] op_sel_hi:[1,0]
v_accvgpr_read_b32 v78,a30
v_accvgpr_read_b32 v79,a31
v_pk_mul_f32 v[78:79],v[78:79],v[64:65] op_sel_hi:[1,0]
v_accvgpr_read_b32 v76,a28
v_accvgpr_read_b32 v77,a29
v_pk_mul_f32 v[76:77],v[76:77],v[64:65] op_sel_hi:[1,0]
v_rcp_f32 v60,v60
v_accvgpr_read_b32 v102,a34
v_mfma_f32_16x16x32_bf16 v[72:75],v[116:119],a[148:151],v[72:75]
s_add_u32 m0,s23,24576
v_accvgpr_read_b32 v103,a35
v_accvgpr_read_b32 v100,a32
v_mfma_f32_16x16x32_bf16 v[72:75],v[120:123],a[152:155],v[72:75]
buffer_load_dwordx4 v6,s[8:11],s21 offen offset:0 lds
v_mfma_f32_16x16x32_bf16 v[72:75],v[124:127],a[156:159],v[72:75]
s_waitcnt vmcnt(18)
ds_read_b128 a[216:219],v11 offset:0
s_waitcnt lgkmcnt(1)
buffer_store_dwordx4 v[96:99],v9,s[16:19],s87 offen offset:3328 nt
ds_read_b128 a[220:223],v12 offset:0
v_pk_mul_f32 v[102:103],v[102:103],v[64:65] op_sel_hi:[1,0]
ds_read_b128 a[224:227],v11 offset:128
v_pk_mul_f32 v[160:161],v[160:161],v[60:61] op_sel_hi:[1,0]
ds_read_b128 a[228:231],v12 offset:128
v_pk_mul_f32 v[162:163],v[162:163],v[60:61] op_sel_hi:[1,0]
ds_read_b128 a[232:235],v11 offset:256
v_accvgpr_read_b32 v101,a33
ds_read_b128 a[236:239],v12 offset:256
v_pk_mul_f32 v[100:101],v[100:101],v[64:65] op_sel_hi:[1,0]
v_cvt_pk_bf16_f32 v80,v80,v81
v_cvt_pk_bf16_f32 v104,v104,v105
v_mfma_f32_16x16x32_bf16 v[72:75],v[128:131],a[160:163],v[72:75]
v_cvt_pk_bf16_f32 v81,v82,v83
v_cvt_pk_bf16_f32 v105,v106,v107
v_mfma_f32_16x16x32_bf16 v[72:75],v[132:135],a[164:167],v[72:75]
ds_write2st64_b64 v37,v[80:81],v[104:105] offset0:24 offset1:26
v_mfma_f32_16x16x32_bf16 v[80:83],v[132:135],a[188:191],0
v_accvgpr_read_b32 v92,a36
v_accvgpr_read_b32 v93,a37
v_mfma_f32_16x16x32_bf16 v[80:83],v[128:131],a[184:187],v[80:83]
v_accvgpr_read_b32 v94,a38
v_accvgpr_read_b32 v95,a39
buffer_load_dwordx4 v7,s[8:11],s21 offen offset:1024 lds
v_pk_mul_f32 v[92:93],v[92:93],v[64:65] op_sel_hi:[1,0]
v_pk_mul_f32 v[164:165],v[164:165],v[60:61] op_sel_hi:[1,0]
v_pk_mul_f32 v[166:167],v[166:167],v[60:61] op_sel_hi:[1,0]
v_pk_mul_f32 v[94:95],v[94:95],v[64:65] op_sel_hi:[1,0]
v_cvt_pk_bf16_f32 v108,v108,v109
v_cvt_pk_bf16_f32 v84,v84,v85
v_mfma_f32_16x16x32_bf16 v[80:83],v[124:127],a[180:183],v[80:83]
v_cvt_pk_bf16_f32 v88,v88,v89
v_cvt_pk_bf16_f32 v76,v76,v77
v_mfma_f32_16x16x32_bf16 v[80:83],v[120:123],a[176:179],v[80:83]
v_cvt_pk_bf16_f32 v109,v110,v111
v_cvt_pk_bf16_f32 v85,v86,v87
v_mfma_f32_16x16x32_bf16 v[80:83],v[116:119],a[172:175],v[80:83]
ds_write2st64_b64 v38,v[108:109],v[84:85] offset0:24 offset1:26
v_mfma_f32_16x16x32_bf16 v[80:83],v[112:115],a[168:171],v[80:83]
v_accvgpr_read_b32 v96,a40
v_accvgpr_read_b32 v97,a41
v_accvgpr_read_b32 v98,a42
v_accvgpr_read_b32 v99,a43
v_cvt_pk_bf16_f32 v89,v90,v91
v_pk_mul_f32 v[168:169],v[168:169],v[60:61] op_sel_hi:[1,0]
v_pk_mul_f32 v[170:171],v[170:171],v[60:61] op_sel_hi:[1,0]
v_pk_mul_f32 v[96:97],v[96:97],v[64:65] op_sel_hi:[1,0]
v_pk_mul_f32 v[98:99],v[98:99],v[64:65] op_sel_hi:[1,0]
v_cvt_pk_bf16_f32 v77,v78,v79
ds_write2st64_b64 v39,v[88:89],v[76:77] offset0:24 offset1:26
v_mfma_f32_16x16x32_bf16 v[88:91],v[112:115],a[192:195],0
v_accvgpr_read_b32 v106,a46
v_accvgpr_read_b32 v107,a47
v_mfma_f32_16x16x32_bf16 v[88:91],v[116:119],a[196:199],v[88:91]
ds_read_b128 v[112:115],v0 offset:6272
buffer_load_dwordx4 v8,s[8:11],s21 offen offset:2048 lds
v_mfma_f32_16x16x32_bf16 v[88:91],v[120:123],a[200:203],v[88:91]
s_add_u32 s21,s21,12288
ds_read_b128 v[116:119],v1 offset:6272
v_accvgpr_read_b32 v104,a44
v_mfma_f32_16x16x32_bf16 v[88:91],v[124:127],a[204:207],v[88:91]
s_mov_b32 s27,s42
ds_read_b128 v[120:123],v0 offset:6400
v_accvgpr_read_b32 v105,a45
ds_read_b128 v[124:127],v1 offset:6400
v_pk_mul_f32 v[106:107],v[106:107],v[64:65] op_sel_hi:[1,0]
v_pk_mul_f32 v[172:173],v[172:173],v[60:61] op_sel_hi:[1,0]
v_pk_mul_f32 v[174:175],v[174:175],v[60:61] op_sel_hi:[1,0]
v_pk_mul_f32 v[104:105],v[104:105],v[64:65] op_sel_hi:[1,0]
v_cvt_pk_bf16_f32 v160,v160,v161
v_cvt_pk_bf16_f32 v100,v100,v101
v_mfma_f32_16x16x32_bf16 v[88:91],v[128:131],a[208:211],v[88:91]
s_mov_b32 s42,s41
ds_read_b128 v[128:131],v0 offset:0
v_cvt_pk_bf16_f32 v92,v92,v93
v_mfma_f32_16x16x32_bf16 v[88:91],v[132:135],a[212:215],v[88:91]
s_waitcnt vmcnt(12)
ds_read_b128 a[240:243],v11 offset:6144
v_cvt_pk_bf16_f32 v164,v164,v165
v_mfma_f32_16x16x32_bf16 v[76:79],v[136:139],a[144:147],0
s_add_u32 s69,s69,1
ds_read_b128 a[244:247],v12 offset:6144
v_cvt_pk_bf16_f32 v161,v162,v163
ds_read_b128 a[248:251],v11 offset:6272
v_pk_mul_f32 v[176:177],v[176:177],v[60:61] op_sel_hi:[1,0]
ds_read_b128 a[252:255],v12 offset:6272
v_pk_mul_f32 v[178:179],v[178:179],v[60:61] op_sel_hi:[1,0]
ds_read_b128 v[144:147],v11 offset:6400
v_pk_mul_f32 v[192:193],v[192:193],v[60:61] op_sel_hi:[1,0]
ds_read_b128 v[148:151],v12 offset:6400
v_pk_mul_f32 v[194:195],v[194:195],v[60:61] op_sel_hi:[1,0]
ds_read_b128 v[132:135],v1 offset:0
v_cvt_pk_bf16_f32 v101,v102,v103
v_mfma_f32_16x16x32_bf16 v[76:79],v[140:143],a[148:151],v[76:79]
s_lshl_b32 s62,s69,5
ds_write2st64_b64 v36,v[100:101],v[160:161] offset0:28 offset1:0
s_waitcnt lgkmcnt(7)
v_mfma_f32_16x16x32_bf16 v[76:79],v[112:115],a[152:155],v[76:79]
s_add_u32 s62,s62,s34
v_cvt_pk_bf16_f32 v93,v94,v95
v_cvt_pk_bf16_f32 v165,v166,v167
v_mfma_f32_16x16x32_bf16 v[76:79],v[116:119],a[156:159],v[76:79]
s_mul_i32 s63,s62,171
v_rcp_f32 v62,v62
v_mfma_f32_16x16x32_bf16 v[76:79],v[120:123],a[160:163],v[76:79]
s_lshr_b32 s63,s63,9
v_cvt_pk_bf16_f32 v168,v168,v169
ds_write2st64_b64 v37,v[92:93],v[164:165] offset0:28 offset1:0
v_pk_mul_f32 v[180:181],v[180:181],v[60:61] op_sel_hi:[1,0]
v_pk_mul_f32 v[182:183],v[182:183],v[60:61] op_sel_hi:[1,0]
v_pk_mul_f32 v[196:197],v[196:197],v[60:61] op_sel_hi:[1,0]
v_pk_mul_f32 v[198:199],v[198:199],v[60:61] op_sel_hi:[1,0]
v_cvt_pk_bf16_f32 v96,v96,v97
v_cvt_pk_bf16_f32 v169,v170,v171
v_mfma_f32_16x16x32_bf16 v[76:79],v[124:127],a[164:167],v[76:79]
s_mul_i32 s64,s63,3
v_cvt_pk_bf16_f32 v97,v98,v99
v_cvt_pk_bf16_f32 v172,v172,v173
v_mfma_f32_16x16x32_bf16 v[84:87],v[124:127],a[188:191],0
s_sub_u32 s62,s62,s64
v_cvt_pk_bf16_f32 v104,v104,v105
v_cvt_pk_bf16_f32 v173,v174,v175
v_mfma_f32_16x16x32_bf16 v[84:87],v[120:123],a[184:187],v[84:87]
s_add_u32 s63,s63,s33
ds_write2st64_b64 v38,v[96:97],v[168:169] offset0:28 offset1:0
v_mfma_f32_16x16x32_bf16 v[84:87],v[116:119],a[180:183],v[84:87]
s_mul_i32 s30,s63,196608
v_cvt_pk_bf16_f32 v105,v106,v107
v_max3_f32 v44,v72,v73,v74
v_max3_f32 v44,v44,v75,v76
v_max3_f32 v44,v44,v77,v78
v_max_f32 v44,v44,v79
v_pk_mul_f32 v[184:185],v[184:185],v[60:61] op_sel_hi:[1,0]
v_pk_mul_f32 v[186:187],v[186:187],v[60:61] op_sel_hi:[1,0]
v_pk_mul_f32 v[200:201],v[200:201],v[60:61] op_sel_hi:[1,0]
v_pk_mul_f32 v[202:203],v[202:203],v[60:61] op_sel_hi:[1,0]
v_mov_b32 v45,v44
v_max3_f32 v48,v80,v81,v82
v_mfma_f32_16x16x32_bf16 v[84:87],v[112:115],a[176:179],v[84:87]
s_mul_i32 s41,s63,325632
ds_write2st64_b64 v39,v[104:105],v[172:173] offset0:28 offset1:0
v_mfma_f32_16x16x32_bf16 v[84:87],v[140:143],a[172:175],v[84:87]
s_lshl_b32 s63,s3,2
v_permlane32_swap_b32 v45,v44
v_mfma_f32_16x16x32_bf16 v[84:87],v[136:139],a[168:171],v[84:87]
s_add_u32 s64,s63,21
v_max_f32 v44,v44,v45
v_mov_b32 v45,v44
v_max3_f32 v52,v88,v89,v90
v_cvt_pk_bf16_f32 v176,v176,v177
v_permlane16_swap_b32 v45,v44
v_pk_mul_f32 v[188:189],v[188:189],v[60:61] op_sel_hi:[1,0]
v_pk_mul_f32 v[190:191],v[190:191],v[60:61] op_sel_hi:[1,0]
v_pk_mul_f32 v[204:205],v[204:205],v[60:61] op_sel_hi:[1,0]
v_pk_mul_f32 v[206:207],v[206:207],v[60:61] op_sel_hi:[1,0]
v_max_f32 v44,v44,v45
v_mul_f32_e64 v13,-s36,v44
v_mfma_f32_16x16x32_bf16 v[92:95],v[136:139],a[192:195],0
s_cmp_eq_u32 s3,0
ds_read_b128 v[136:139],v0 offset:128
v_fma_f32 v72,v72,s36,v13
v_mfma_f32_16x16x32_bf16 v[92:95],v[140:143],a[196:199],v[92:95]
s_cselect_b32 s64,20,s64
ds_read_b128 v[140:143],v1 offset:128
v_fma_f32 v73,v73,s36,v13
v_mfma_f32_16x16x32_bf16 v[92:95],v[112:115],a[200:203],v[92:95]
s_cselect_b32 s40,1,0
ds_read_b128 v[112:115],v0 offset:256
v_fma_f32 v74,v74,s36,v13
v_mfma_f32_16x16x32_bf16 v[92:95],v[116:119],a[204:207],v[92:95]
s_add_u32 s65,s63,37
ds_read_b128 v[116:119],v1 offset:256
v_fma_f32 v75,v75,s36,v13
v_exp_f32 v72,v72
v_exp_f32 v73,v73
v_pk_mul_f32 v[208:209],v[208:209],v[62:63] op_sel_hi:[1,0]
v_pk_mul_f32 v[210:211],v[210:211],v[62:63] op_sel_hi:[1,0]
v_pk_mul_f32 v[224:225],v[224:225],v[62:63] op_sel_hi:[1,0]
v_pk_mul_f32 v[226:227],v[226:227],v[62:63] op_sel_hi:[1,0]
v_exp_f32 v74,v74
v_exp_f32 v75,v75
v_mfma_f32_16x16x32_bf16 v[92:95],v[120:123],a[208:211],v[92:95]
s_cmp_eq_u32 s62,2
ds_read_b128 v[120:123],v0 offset:6144
v_cvt_pk_bf16_f32 v20,v72,v73
v_mfma_f32_16x16x32_bf16 v[92:95],v[124:127],a[212:215],v[92:95]
s_cselect_b32 s64,s65,s64
ds_read_b128 v[124:127],v1 offset:6144
v_cvt_pk_bf16_f32 v21,v74,v75
v_max3_f32 v48,v48,v83,v84
v_max3_f32 v48,v48,v85,v86
v_max_f32 v48,v48,v87
v_mov_b32 v49,v48
v_cvt_pk_bf16_f32 v192,v192,v193
v_cvt_pk_bf16_f32 v180,v180,v181
v_permlane32_swap_b32 v49,v48
s_waitcnt lgkmcnt(2)
v_mfma_f32_16x16x32_bf16 v[96:99],v[116:119],a[236:239],0
s_cselect_b32 s40,0,s40
v_max_f32 v48,v48,v49
v_mov_b32 v49,v48
v_mfma_f32_16x16x32_bf16 v[96:99],v[112:115],a[232:235],v[96:99]
s_add_u32 s65,s63,s3
v_permlane16_swap_b32 v49,v48
v_max_f32 v48,v48,v49
v_mul_f32_e64 v14,-s36,v48
v_fma_f32 v80,v80,s36,v14
v_pk_mul_f32 v[212:213],v[212:213],v[62:63] op_sel_hi:[1,0]
v_pk_mul_f32 v[214:215],v[214:215],v[62:63] op_sel_hi:[1,0]
v_pk_mul_f32 v[228:229],v[228:229],v[62:63] op_sel_hi:[1,0]
v_pk_mul_f32 v[230:231],v[230:231],v[62:63] op_sel_hi:[1,0]
v_fma_f32 v81,v81,s36,v14
v_fma_f32 v82,v82,s36,v14
v_mfma_f32_16x16x32_bf16 v[96:99],v[140:143],a[228:231],v[96:99]
s_cmp_eq_u32 s62,0
v_fma_f32 v83,v83,s36,v14
v_exp_f32 v80,v80
v_mfma_f32_16x16x32_bf16 v[96:99],v[136:139],a[224:227],v[96:99]
s_cselect_b32 s64,s65,s64
v_exp_f32 v81,v81
v_mfma_f32_16x16x32_bf16 v[96:99],v[132:135],a[220:223],v[96:99]
s_cselect_b32 s40,1,s40
v_exp_f32 v82,v82
v_exp_f32 v83,v83
v_cvt_pk_bf16_f32 v24,v80,v81
v_pk_mul_f32 v[216:217],v[216:217],v[62:63] op_sel_hi:[1,0]
v_pk_mul_f32 v[218:219],v[218:219],v[62:63] op_sel_hi:[1,0]
v_pk_mul_f32 v[232:233],v[232:233],v[62:63] op_sel_hi:[1,0]
v_pk_mul_f32 v[234:235],v[234:235],v[62:63] op_sel_hi:[1,0]
v_cvt_pk_bf16_f32 v25,v82,v83
v_max3_f32 v52,v52,v91,v92
v_mfma_f32_16x16x32_bf16 v[96:99],v[128:131],a[216:219],v[96:99]
s_mul_i32 s64,s64,6144
v_max3_f32 v52,v52,v93,v94
v_max_f32 v52,v52,v95
v_mfma_f32_16x16x32_bf16 v[104:107],v[128:131],a[240:243],0
s_add_u32 s41,s41,s64
ds_read_b128 v[128:131],v0 offset:6272
v_mov_b32 v53,v52
v_mfma_f32_16x16x32_bf16 v[104:107],v[132:135],a[244:247],v[104:107]
s_cmp_ge_u32 s69,6
ds_read_b128 v[132:135],v1 offset:6272
v_permlane32_swap_b32 v53,v52
v_mfma_f32_16x16x32_bf16 v[104:107],v[136:139],a[248:251],v[104:107]
s_cselect_b32 s41,166723584,s41
ds_read_b128 v[136:139],v0 offset:6400
v_max_f32 v52,v52,v53
v_mov_b32 v53,v52
v_max3_f32 v56,v96,v97,v98
v_cvt_pk_bf16_f32 v196,v196,v197
v_pk_mul_f32 v[220:221],v[220:221],v[62:63] op_sel_hi:[1,0]
v_pk_mul_f32 v[222:223],v[222:223],v[62:63] op_sel_hi:[1,0]
v_pk_mul_f32 v[236:237],v[236:237],v[62:63] op_sel_hi:[1,0]
v_pk_mul_f32 v[238:239],v[238:239],v[62:63] op_sel_hi:[1,0]
v_permlane16_swap_b32 v53,v52
v_max_f32 v52,v52,v53
v_mfma_f32_16x16x32_bf16 v[104:107],v[140:143],a[252:255],v[104:107]
s_cselect_b32 s30,100663296,s30
ds_read_b128 v[140:143],v1 offset:6400
v_mul_f32_e64 v15,-s36,v52
v_mfma_f32_16x16x32_bf16 v[104:107],v[112:115],v[144:147],v[104:107]
s_add_u32 s25,s30,s22
ds_read_b128 v[112:115],v0 offset:12544
v_fma_f32 v88,v88,s36,v15
v_mfma_f32_16x16x32_bf16 v[104:107],v[116:119],v[148:151],v[104:107]
s_add_u32 s26,s25,12288
ds_read_b128 v[116:119],v1 offset:12544
v_fma_f32 v89,v89,s36,v15
s_waitcnt lgkmcnt(5)
v_mfma_f32_16x16x32_bf16 v[100:103],v[120:123],a[216:219],0
s_add_u32 m0,s22,0
v_fma_f32 v90,v90,s36,v15
v_fma_f32 v91,v91,s36,v15
v_exp_f32 v88,v88
v_exp_f32 v89,v89
v_pk_mul_f32 v[240:241],v[240:241],v[62:63] op_sel_hi:[1,0]
v_pk_mul_f32 v[242:243],v[242:243],v[62:63] op_sel_hi:[1,0]
v_exp_f32 v90,v90
v_exp_f32 v91,v91
v_mfma_f32_16x16x32_bf16 v[100:103],v[124:127],a[220:223],v[100:103]
s_mov_b32 s28,s41
v_cvt_pk_bf16_f32 v28,v88,v89
v_cvt_pk_bf16_f32 v29,v90,v91
v_mfma_f32_16x16x32_bf16 v[100:103],v[128:131],a[224:227],v[100:103]
s_mov_b32 s29,s24
v_max3_f32 v40,v104,v105,v106
v_cvt_pk_bf16_f32 v177,v178,v179
s_waitcnt lgkmcnt(2)
v_mfma_f32_16x16x32_bf16 v[100:103],v[132:135],a[228:231],v[100:103]
v_cvt_pk_bf16_f32 v193,v194,v195
v_cvt_pk_bf16_f32 v184,v184,v185
v_mfma_f32_16x16x32_bf16 v[100:103],v[136:139],a[232:235],v[100:103]
ds_write2st64_b64 v36,v[176:177],v[192:193] offset0:2 offset1:4
v_pk_mul_f32 v[244:245],v[244:245],v[62:63] op_sel_hi:[1,0]
v_pk_mul_f32 v[246:247],v[246:247],v[62:63] op_sel_hi:[1,0]
v_cvt_pk_bf16_f32 v200,v200,v201
v_cvt_pk_bf16_f32 v181,v182,v183
v_mfma_f32_16x16x32_bf16 v[100:103],v[140:143],a[236:239],v[100:103]
v_cvt_pk_bf16_f32 v197,v198,v199
v_cvt_pk_bf16_f32 v188,v188,v189
v_mfma_f32_16x16x32_bf16 v[108:111],v[140:143],v[148:151],0
ds_read_b128 v[140:143],v1 offset:12416
v_cvt_pk_bf16_f32 v204,v204,v205
v_mfma_f32_16x16x32_bf16 v[108:111],v[136:139],v[144:147],v[108:111]
ds_read_b128 v[136:139],v0 offset:12416
v_cvt_pk_bf16_f32 v185,v186,v187
ds_write2st64_b64 v37,v[180:181],v[196:197] offset0:2 offset1:4
v_pk_mul_f32 v[248:249],v[248:249],v[62:63] op_sel_hi:[1,0]
v_pk_mul_f32 v[250:251],v[250:251],v[62:63] op_sel_hi:[1,0]
v_max3_f32 v56,v56,v99,v100
v_max3_f32 v56,v56,v101,v102
v_mfma_f32_16x16x32_bf16 v[108:111],v[132:135],a[252:255],v[108:111]
ds_read_b128 v[132:135],v1 offset:12288
v_max_f32 v56,v56,v103
v_mfma_f32_16x16x32_bf16 v[108:111],v[128:131],a[248:251],v[108:111]
ds_read_b128 v[128:131],v0 offset:12288
v_mov_b32 v57,v56
v_mfma_f32_16x16x32_bf16 v[108:111],v[124:127],a[244:247],v[108:111]
ds_read_b128 v[124:127],v1 offset:18432
v_permlane32_swap_b32 v57,v56
v_mfma_f32_16x16x32_bf16 v[108:111],v[120:123],a[240:243],v[108:111]
ds_read_b128 v[120:123],v0 offset:18432
v_max_f32 v56,v56,v57
v_mov_b32 v57,v56
v_cvt_pk_bf16_f32 v201,v202,v203
ds_write2st64_b64 v38,v[184:185],v[200:201] offset0:2 offset1:4
v_pk_mul_f32 v[252:253],v[252:253],v[62:63] op_sel_hi:[1,0]
v_pk_mul_f32 v[254:255],v[254:255],v[62:63] op_sel_hi:[1,0]
v_permlane16_swap_b32 v57,v56
v_max_f32 v56,v56,v57
v_mul_f32_e64 v16,-s36,v56
v_fma_f32 v96,v96,s36,v16
v_fma_f32 v97,v97,s36,v16
v_fma_f32 v98,v98,s36,v16
v_fma_f32 v99,v99,s36,v16
s_waitcnt lgkmcnt(3)
v_mfma_f32_16x16x32_bf16 v[72:75],v[128:131],a[144:147],0
v_exp_f32 v96,v96
v_mfma_f32_16x16x32_bf16 v[72:75],v[132:135],a[148:151],v[72:75]
v_exp_f32 v97,v97
v_mfma_f32_16x16x32_bf16 v[72:75],v[136:139],a[152:155],v[72:75]
v_exp_f32 v98,v98
v_mfma_f32_16x16x32_bf16 v[72:75],v[140:143],a[156:159],v[72:75]
v_exp_f32 v99,v99
v_mfma_f32_16x16x32_bf16 v[72:75],v[112:115],a[160:163],v[72:75]
v_cvt_pk_bf16_f32 v32,v96,v97
v_cvt_pk_bf16_f32 v33,v98,v99
v_mfma_f32_16x16x32_bf16 v[72:75],v[116:119],a[164:167],v[72:75]
v_max3_f32 v40,v40,v107,v108
v_max3_f32 v40,v40,v109,v110
v_mfma_f32_16x16x32_bf16 v[80:83],v[116:119],a[188:191],0
v_max_f32 v40,v40,v111
v_mov_b32 v41,v40
v_mfma_f32_16x16x32_bf16 v[80:83],v[112:115],a[184:187],v[80:83]
v_cvt_pk_bf16_f32 v208,v208,v209
v_permlane32_swap_b32 v41,v40
v_mfma_f32_16x16x32_bf16 v[80:83],v[140:143],a[180:183],v[80:83]
v_max_f32 v40,v40,v41
v_cvt_pk_bf16_f32 v224,v224,v225
v_mfma_f32_16x16x32_bf16 v[80:83],v[136:139],a[176:179],v[80:83]
v_cvt_pk_bf16_f32 v189,v190,v191
v_cvt_pk_bf16_f32 v205,v206,v207
v_mfma_f32_16x16x32_bf16 v[80:83],v[132:135],a[172:175],v[80:83]
ds_write2st64_b64 v39,v[188:189],v[204:205] offset0:2 offset1:4
v_mfma_f32_16x16x32_bf16 v[80:83],v[128:131],a[168:171],v[80:83]
v_mov_b32 v41,v40
v_cvt_pk_bf16_f32 v212,v212,v213
v_mfma_f32_16x16x32_bf16 v[88:91],v[128:131],a[192:195],0
v_cvt_pk_bf16_f32 v228,v228,v229
v_cvt_pk_bf16_f32 v209,v210,v211
v_mfma_f32_16x16x32_bf16 v[88:91],v[132:135],a[196:199],v[88:91]
v_cvt_pk_bf16_f32 v225,v226,v227
v_permlane16_swap_b32 v41,v40
v_mfma_f32_16x16x32_bf16 v[88:91],v[136:139],a[200:203],v[88:91]
ds_write2st64_b64 v36,v[208:209],v[224:225] offset0:12 offset1:14
v_mfma_f32_16x16x32_bf16 v[88:91],v[140:143],a[204:207],v[88:91]
v_cvt_pk_bf16_f32 v216,v216,v217
v_cvt_pk_bf16_f32 v232,v232,v233
v_mfma_f32_16x16x32_bf16 v[88:91],v[112:115],a[208:211],v[88:91]
v_cvt_pk_bf16_f32 v213,v214,v215
v_cvt_pk_bf16_f32 v229,v230,v231
v_mfma_f32_16x16x32_bf16 v[88:91],v[116:119],a[212:215],v[88:91]
v_max_f32 v40,v40,v41
v_cvt_pk_bf16_f32 v220,v220,v221
v_mfma_f32_16x16x32_bf16 v[96:99],v[116:119],a[236:239],0
ds_write2st64_b64 v37,v[212:213],v[228:229] offset0:12 offset1:14
v_mfma_f32_16x16x32_bf16 v[96:99],v[112:115],a[232:235],v[96:99]
v_cvt_pk_bf16_f32 v236,v236,v237
v_cvt_pk_bf16_f32 v217,v218,v219
v_mfma_f32_16x16x32_bf16 v[96:99],v[140:143],a[228:231],v[96:99]
v_cvt_pk_bf16_f32 v233,v234,v235
v_mul_f32_e64 v17,-s36,v40
v_mfma_f32_16x16x32_bf16 v[96:99],v[136:139],a[224:227],v[96:99]
v_cvt_pk_bf16_f32 v240,v240,v241
v_cvt_pk_bf16_f32 v221,v222,v223
v_mfma_f32_16x16x32_bf16 v[96:99],v[132:135],a[220:223],v[96:99]
ds_write2st64_b64 v38,v[216:217],v[232:233] offset0:12 offset1:14
v_mfma_f32_16x16x32_bf16 v[96:99],v[128:131],a[216:219],v[96:99]
v_cvt_pk_bf16_f32 v237,v238,v239
v_fma_f32 v104,v104,s36,v17
v_fma_f32 v105,v105,s36,v17
v_fma_f32 v106,v106,s36,v17
v_fma_f32 v107,v107,s36,v17
v_cvt_pk_bf16_f32 v244,v244,v245
v_cvt_pk_bf16_f32 v241,v242,v243
v_exp_f32 v104,v104
ds_write2st64_b64 v39,v[220:221],v[236:237] offset0:12 offset1:14
v_exp_f32 v105,v105
v_exp_f32 v106,v106
v_exp_f32 v107,v107
v_cvt_pk_bf16_f32 v245,v246,v247
v_fma_f32 v76,v76,s36,v13
v_fma_f32 v77,v77,s36,v13
v_fma_f32 v78,v78,s36,v13
v_fma_f32 v79,v79,s36,v13
ds_write_b64 v36,v[240:241] offset:8192
v_cvt_pk_bf16_f32 v36,v104,v105
v_exp_f32 v76,v76
v_exp_f32 v77,v77
ds_write_b64 v37,v[244:245] offset:8192
v_cvt_pk_bf16_f32 v37,v106,v107
v_mfma_f32_16x16x32_bf16 v[104:107],v[128:131],a[240:243],0
ds_read_b128 v[128:131],v0 offset:18560
v_exp_f32 v78,v78
s_waitcnt vmcnt(5)
s_barrier
v_mfma_f32_16x16x32_bf16 v[104:107],v[132:135],a[244:247],v[104:107]
buffer_load_dwordx4 v6,s[4:7],s20 offen offset:0 lds
v_mfma_f32_16x16x32_bf16 v[104:107],v[136:139],a[248:251],v[104:107]
ds_read_b128 v[132:135],v1 offset:18560
v_exp_f32 v79,v79
v_mfma_f32_16x16x32_bf16 v[104:107],v[140:143],a[252:255],v[104:107]
ds_read_b128 v[136:139],v0 offset:18688
v_cvt_pk_bf16_f32 v22,v76,v77
v_mfma_f32_16x16x32_bf16 v[104:107],v[112:115],v[144:147],v[104:107]
ds_read_b128 v[140:143],v1 offset:18688
v_cvt_pk_bf16_f32 v23,v78,v79
v_mfma_f32_16x16x32_bf16 v[104:107],v[116:119],v[148:151],v[104:107]
s_waitcnt lgkmcnt(3)
v_fma_f32 v84,v84,s36,v14
v_fma_f32 v85,v85,s36,v14
v_mfma_f32_16x16x32_bf16 v[76:79],v[120:123],a[144:147],0
v_fma_f32 v86,v86,s36,v14
v_fma_f32 v87,v87,s36,v14
v_mfma_f32_16x16x32_bf16 v[76:79],v[124:127],a[148:151],v[76:79]
buffer_load_dwordx4 v7,s[4:7],s20 offen offset:1024 lds
v_mfma_f32_16x16x32_bf16 v[76:79],v[128:131],a[152:155],v[76:79]
s_waitcnt lgkmcnt(2)
v_exp_f32 v84,v84
v_exp_f32 v85,v85
v_mfma_f32_16x16x32_bf16 v[76:79],v[132:135],a[156:159],v[76:79]
s_waitcnt lgkmcnt(1)
v_exp_f32 v86,v86
v_exp_f32 v87,v87
v_mfma_f32_16x16x32_bf16 v[76:79],v[136:139],a[160:163],v[76:79]
s_waitcnt lgkmcnt(0)
ds_read_b64_tr_b16 v[112:113],v2 offset:0
v_cvt_pk_bf16_f32 v26,v84,v85
v_mfma_f32_16x16x32_bf16 v[76:79],v[140:143],a[164:167],v[76:79]
ds_read_b64_tr_b16 v[114:115],v2 offset:6144
ds_read_b64_tr_b16 v[116:117],v3 offset:0
ds_read_b64_tr_b16 v[118:119],v3 offset:6144
buffer_load_dwordx4 v8,s[4:7],s20 offen offset:2048 lds
v_cvt_pk_bf16_f32 v27,v86,v87
v_mfma_f32_16x16x32_bf16 v[84:87],v[140:143],a[188:191],0
s_add_u32 s20,s20,12288
v_fma_f32 v92,v92,s36,v15
v_fma_f32 v93,v93,s36,v15
v_mfma_f32_16x16x32_bf16 v[84:87],v[136:139],a[184:187],v[84:87]
v_fma_f32 v94,v94,s36,v15
v_fma_f32 v95,v95,s36,v15
v_mfma_f32_16x16x32_bf16 v[84:87],v[132:135],a[180:183],v[84:87]
v_exp_f32 v92,v92
v_mfma_f32_16x16x32_bf16 v[84:87],v[128:131],a[176:179],v[84:87]
v_exp_f32 v93,v93
v_mfma_f32_16x16x32_bf16 v[84:87],v[124:127],a[172:175],v[84:87]
v_exp_f32 v94,v94
v_mfma_f32_16x16x32_bf16 v[84:87],v[120:123],a[168:171],v[84:87]
v_exp_f32 v95,v95
v_cvt_pk_bf16_f32 v30,v92,v93
v_cvt_pk_bf16_f32 v31,v94,v95
v_mfma_f32_16x16x32_bf16 v[92:95],v[120:123],a[192:195],0
v_fma_f32 v100,v100,s36,v16
v_fma_f32 v101,v101,s36,v16
v_mfma_f32_16x16x32_bf16 v[92:95],v[124:127],a[196:199],v[92:95]
v_fma_f32 v102,v102,s36,v16
v_fma_f32 v103,v103,s36,v16
v_mfma_f32_16x16x32_bf16 v[92:95],v[128:131],a[200:203],v[92:95]
v_exp_f32 v100,v100
v_mfma_f32_16x16x32_bf16 v[92:95],v[132:135],a[204:207],v[92:95]
v_exp_f32 v101,v101
v_mfma_f32_16x16x32_bf16 v[92:95],v[136:139],a[208:211],v[92:95]
v_exp_f32 v102,v102
v_mfma_f32_16x16x32_bf16 v[92:95],v[140:143],a[212:215],v[92:95]
v_exp_f32 v103,v103
v_cvt_pk_bf16_f32 v34,v100,v101
v_cvt_pk_bf16_f32 v35,v102,v103
v_mfma_f32_16x16x32_bf16 v[100:103],v[140:143],a[236:239],0
v_cvt_pk_bf16_f32 v248,v248,v249
v_fma_f32 v108,v108,s36,v17
v_mfma_f32_16x16x32_bf16 v[100:103],v[136:139],a[232:235],v[100:103]
v_fma_f32 v109,v109,s36,v17
v_fma_f32 v110,v110,s36,v17
v_mfma_f32_16x16x32_bf16 v[100:103],v[132:135],a[228:231],v[100:103]
v_fma_f32 v111,v111,s36,v17
v_cvt_pk_bf16_f32 v252,v252,v253
v_mfma_f32_16x16x32_bf16 v[100:103],v[128:131],a[224:227],v[100:103]
v_cvt_pk_bf16_f32 v249,v250,v251
v_exp_f32 v108,v108
v_mfma_f32_16x16x32_bf16 v[100:103],v[124:127],a[220:223],v[100:103]
ds_write_b64 v38,v[248:249] offset:8192
v_mfma_f32_16x16x32_bf16 v[100:103],v[120:123],a[216:219],v[100:103]
v_exp_f32 v109,v109
v_exp_f32 v110,v110
v_exp_f32 v111,v111
v_cvt_pk_bf16_f32 v253,v254,v255
ds_write_b64 v39,v[252:253] offset:8192
v_cvt_pk_bf16_f32 v38,v108,v109
v_cvt_pk_bf16_f32 v39,v110,v111
v_mfma_f32_16x16x32_bf16 v[108:111],v[120:123],a[240:243],0
ds_read_b64_tr_b16 v[120:121],v4 offset:0
v_mov_b32 v66,0
v_mfma_f32_16x16x32_bf16 v[108:111],v[124:127],a[244:247],v[108:111]
ds_read_b64_tr_b16 v[122:123],v4 offset:6144
v_mov_b32 v67,0
v_mfma_f32_16x16x32_bf16 v[108:111],v[128:131],a[248:251],v[108:111]
ds_read_b64_tr_b16 v[124:125],v5 offset:0
v_mov_b32 v64,0
v_mfma_f32_16x16x32_bf16 v[108:111],v[132:135],a[252:255],v[108:111]
ds_read_b64_tr_b16 v[126:127],v5 offset:6144
v_mov_b32 v65,0
v_mfma_f32_16x16x32_bf16 v[108:111],v[136:139],v[144:147],v[108:111]
v_mov_b32 v60,0
v_mov_b32 v61,0
v_smfmac_f32_16x16x64_bf16 v[64:67],v[152:155],v[28:35],v18
v_mov_b32 v62,0
v_mfma_f32_16x16x32_bf16 v[108:111],v[140:143],v[148:151],v[108:111]
v_mov_b32 v63,0
v_fma_f32 v72,v72,s36,v13
v_fma_f32 v73,v73,s36,v13
v_smfmac_f32_16x16x64_bf16 v[60:63],v[152:155],v[20:27],v18
v_fma_f32 v74,v74,s36,v13
v_fma_f32 v75,v75,s36,v13
v_fma_f32 v80,v80,s36,v14
v_fma_f32 v81,v81,s36,v14
v_fma_f32 v82,v82,s36,v14
v_fma_f32 v83,v83,s36,v14
v_fma_f32 v88,v88,s36,v15
v_fma_f32 v89,v89,s36,v15
v_exp_f32 v72,v72
v_exp_f32 v73,v73
v_exp_f32 v74,v74
v_exp_f32 v75,v75
v_exp_f32 v80,v80
v_exp_f32 v81,v81
v_exp_f32 v82,v82
v_exp_f32 v83,v83
v_exp_f32 v88,v88
v_exp_f32 v89,v89
v_mov_b32 v68,0
v_mov_b32 v69,0
v_mov_b32 v70,0
v_mov_b32 v71,0
v_cvt_pk_bf16_f32 v44,v72,v73
v_cvt_pk_bf16_f32 v45,v74,v75
v_cvt_pk_bf16_f32 v48,v80,v81
v_cvt_pk_bf16_f32 v49,v82,v83
v_cvt_pk_bf16_f32 v52,v88,v89
s_waitcnt lgkmcnt(0)
v_mfma_f32_16x16x32_bf16 v[160:163],v[112:115],v[20:23],0
s_add_u32 m0,s23,0
ds_read_b64_tr_b16 v[128:129],v2 offset:128
v_fma_f32 v90,v90,s36,v15
v_mfma_f32_16x16x32_bf16 v[164:167],v[116:119],v[20:23],0
ds_read_b64_tr_b16 v[130:131],v2 offset:6272
v_fma_f32 v91,v91,s36,v15
v_mfma_f32_16x16x32_bf16 v[212:215],v[116:119],v[24:27],0
ds_read_b64_tr_b16 v[132:133],v3 offset:128
v_fma_f32 v96,v96,s36,v16
v_mfma_f32_16x16x32_bf16 v[208:211],v[112:115],v[24:27],0
ds_read_b64_tr_b16 v[134:135],v3 offset:6272
v_fma_f32 v97,v97,s36,v16
v_mfma_f32_16x16x32_bf16 a[0:3],v[112:115],v[28:31],0
ds_read_b64_tr_b16 v[136:137],v4 offset:128
v_fma_f32 v98,v98,s36,v16
v_mfma_f32_16x16x32_bf16 a[4:7],v[116:119],v[28:31],0
ds_read_b64_tr_b16 v[138:139],v4 offset:6272
v_fma_f32 v99,v99,s36,v16
v_mfma_f32_16x16x32_bf16 a[52:55],v[116:119],v[32:35],0
ds_read_b64_tr_b16 v[140:141],v5 offset:128
v_fma_f32 v104,v104,s36,v17
v_mfma_f32_16x16x32_bf16 a[48:51],v[112:115],v[32:35],0
ds_read_b64_tr_b16 v[142:143],v5 offset:6272
v_fma_f32 v105,v105,s36,v17
v_mfma_f32_16x16x32_bf16 a[96:99],v[112:115],v[36:39],0
ds_read_b64_tr_b16 v[112:113],v2 offset:256
v_fma_f32 v106,v106,s36,v17
v_mfma_f32_16x16x32_bf16 a[100:103],v[116:119],v[36:39],0
ds_read_b64_tr_b16 v[114:115],v2 offset:6400
v_fma_f32 v107,v107,s36,v17
v_mfma_f32_16x16x32_bf16 a[104:107],v[120:123],v[36:39],0
ds_read_b64_tr_b16 v[116:117],v3 offset:256
v_fma_f32 v76,v76,s36,v13
v_mfma_f32_16x16x32_bf16 a[108:111],v[124:127],v[36:39],0
ds_read_b64_tr_b16 v[118:119],v3 offset:6400
v_fma_f32 v77,v77,s36,v13
v_mfma_f32_16x16x32_bf16 a[60:63],v[124:127],v[32:35],0
v_exp_f32 v90,v90
v_mfma_f32_16x16x32_bf16 a[56:59],v[120:123],v[32:35],0
v_exp_f32 v91,v91
v_mfma_f32_16x16x32_bf16 a[8:11],v[120:123],v[28:31],0
v_cvt_pk_bf16_f32 v53,v90,v91
v_fma_f32 v78,v78,s36,v13
v_mfma_f32_16x16x32_bf16 a[12:15],v[124:127],v[28:31],0
v_exp_f32 v96,v96
v_mfma_f32_16x16x32_bf16 v[220:223],v[124:127],v[24:27],0
v_exp_f32 v97,v97
v_mfma_f32_16x16x32_bf16 v[216:219],v[120:123],v[24:27],0
v_exp_f32 v98,v98
v_mfma_f32_16x16x32_bf16 v[168:171],v[120:123],v[20:23],0
ds_read_b64_tr_b16 v[120:121],v4 offset:256
v_cvt_pk_bf16_f32 v56,v96,v97
v_mfma_f32_16x16x32_bf16 v[172:175],v[124:127],v[20:23],0
s_waitcnt lgkmcnt(1)
ds_read_b64_tr_b16 v[122:123],v4 offset:6400
v_fma_f32 v79,v79,s36,v13
v_mfma_f32_16x16x32_bf16 v[176:179],v[128:131],v[20:23],0
ds_read_b64_tr_b16 v[124:125],v5 offset:256
v_fma_f32 v84,v84,s36,v14
v_mfma_f32_16x16x32_bf16 v[180:183],v[132:135],v[20:23],0
ds_read_b64_tr_b16 v[126:127],v5 offset:6400
v_fma_f32 v85,v85,s36,v14
v_mfma_f32_16x16x32_bf16 v[228:231],v[132:135],v[24:27],0
v_exp_f32 v99,v99
v_mfma_f32_16x16x32_bf16 v[224:227],v[128:131],v[24:27],0
v_cvt_pk_bf16_f32 v57,v98,v99
v_fma_f32 v86,v86,s36,v14
v_mfma_f32_16x16x32_bf16 a[16:19],v[128:131],v[28:31],0
v_exp_f32 v104,v104
v_mfma_f32_16x16x32_bf16 a[20:23],v[132:135],v[28:31],0
v_exp_f32 v105,v105
v_mfma_f32_16x16x32_bf16 a[68:71],v[132:135],v[32:35],0
v_exp_f32 v106,v106
v_mfma_f32_16x16x32_bf16 a[64:67],v[128:131],v[32:35],0
v_exp_f32 v107,v107
v_mfma_f32_16x16x32_bf16 a[112:115],v[128:131],v[36:39],0
v_cvt_pk_bf16_f32 v40,v104,v105
v_cvt_pk_bf16_f32 v41,v106,v107
v_mfma_f32_16x16x32_bf16 a[116:119],v[132:135],v[36:39],0
v_exp_f32 v76,v76
v_mfma_f32_16x16x32_bf16 a[120:123],v[136:139],v[36:39],0
v_exp_f32 v77,v77
v_mfma_f32_16x16x32_bf16 a[124:127],v[140:143],v[36:39],0
v_exp_f32 v78,v78
v_mfma_f32_16x16x32_bf16 a[76:79],v[140:143],v[32:35],0
v_exp_f32 v79,v79
v_mfma_f32_16x16x32_bf16 a[72:75],v[136:139],v[32:35],0
v_cvt_pk_bf16_f32 v46,v76,v77
v_cvt_pk_bf16_f32 v47,v78,v79
v_mfma_f32_16x16x32_bf16 a[24:27],v[136:139],v[28:31],0
v_fma_f32 v87,v87,s36,v14
v_fma_f32 v92,v92,s36,v15
v_mfma_f32_16x16x32_bf16 a[28:31],v[140:143],v[28:31],0
v_exp_f32 v84,v84
v_mfma_f32_16x16x32_bf16 v[236:239],v[140:143],v[24:27],0
v_exp_f32 v85,v85
v_mfma_f32_16x16x32_bf16 v[232:235],v[136:139],v[24:27],0
v_exp_f32 v86,v86
v_mfma_f32_16x16x32_bf16 v[184:187],v[136:139],v[20:23],0
v_exp_f32 v87,v87
v_mfma_f32_16x16x32_bf16 v[188:191],v[140:143],v[20:23],0
v_cvt_pk_bf16_f32 v50,v84,v85
v_cvt_pk_bf16_f32 v51,v86,v87
v_mfma_f32_16x16x32_bf16 v[192:195],v[112:115],v[20:23],0
v_fma_f32 v93,v93,s36,v15
v_fma_f32 v94,v94,s36,v15
v_smfmac_f32_16x16x64_bf16 v[60:63],v[152:155],v[44:51],v18
v_fma_f32 v95,v95,s36,v15
v_mfma_f32_16x16x32_bf16 v[196:199],v[116:119],v[20:23],0
s_waitcnt vmcnt(30) lgkmcnt(0)
v_exp_f32 v92,v92
v_mfma_f32_16x16x32_bf16 v[244:247],v[116:119],v[24:27],0
s_barrier
v_mfma_f32_16x16x32_bf16 v[240:243],v[112:115],v[24:27],0
ds_read_b128 v[128:131],v0 offset:24576
v_fma_f32 v100,v100,s36,v16
v_mfma_f32_16x16x32_bf16 a[32:35],v[112:115],v[28:31],0
ds_read_b128 v[132:135],v1 offset:24576
v_fma_f32 v101,v101,s36,v16
v_mfma_f32_16x16x32_bf16 a[36:39],v[116:119],v[28:31],0
ds_read_b128 v[136:139],v0 offset:24704
v_fma_f32 v102,v102,s36,v16
v_mfma_f32_16x16x32_bf16 a[84:87],v[116:119],v[32:35],0
ds_read_b128 v[140:143],v1 offset:24704
v_fma_f32 v103,v103,s36,v16
v_mfma_f32_16x16x32_bf16 a[80:83],v[112:115],v[32:35],0
v_exp_f32 v93,v93
v_mfma_f32_16x16x32_bf16 a[128:131],v[112:115],v[36:39],0
buffer_load_dwordx4 v6,s[8:11],s21 offen offset:0 lds
v_mfma_f32_16x16x32_bf16 a[132:135],v[116:119],v[36:39],0
ds_read_b128 v[112:115],v0 offset:24832
v_cvt_pk_bf16_f32 v54,v92,v93
v_mfma_f32_16x16x32_bf16 a[136:139],v[120:123],v[36:39],0
ds_read_b128 v[116:119],v1 offset:24832
v_fma_f32 v108,v108,s36,v17
v_mfma_f32_16x16x32_bf16 a[140:143],v[124:127],v[36:39],0
v_exp_f32 v94,v94
v_mfma_f32_16x16x32_bf16 a[92:95],v[124:127],v[32:35],0
v_exp_f32 v95,v95
v_mfma_f32_16x16x32_bf16 a[88:91],v[120:123],v[32:35],0
v_cvt_pk_bf16_f32 v55,v94,v95
v_fma_f32 v109,v109,s36,v17
v_mfma_f32_16x16x32_bf16 a[40:43],v[120:123],v[28:31],0
v_exp_f32 v100,v100
v_mfma_f32_16x16x32_bf16 a[44:47],v[124:127],v[28:31],0
v_exp_f32 v101,v101
v_mfma_f32_16x16x32_bf16 v[252:255],v[124:127],v[24:27],0
v_exp_f32 v102,v102
v_mfma_f32_16x16x32_bf16 v[248:251],v[120:123],v[24:27],0
v_exp_f32 v103,v103
v_mfma_f32_16x16x32_bf16 v[200:203],v[120:123],v[20:23],0
ds_read_b128 v[120:123],v0 offset:30720
v_cvt_pk_bf16_f32 v58,v100,v101
v_mfma_f32_16x16x32_bf16 v[204:207],v[124:127],v[20:23],0
buffer_load_dwordx4 v7,s[8:11],s21 offen offset:1024 lds
s_waitcnt lgkmcnt(1)
v_mfma_f32_16x16x32_bf16 v[72:75],v[128:131],a[144:147],0
ds_read_b128 v[124:127],v1 offset:30720
v_cvt_pk_bf16_f32 v59,v102,v103
v_mfma_f32_16x16x32_bf16 v[72:75],v[132:135],a[148:151],v[72:75]
v_fma_f32 v110,v110,s36,v17
v_fma_f32 v111,v111,s36,v17
v_smfmac_f32_16x16x64_bf16 v[64:67],v[152:155],v[52:59],v18
v_mfma_f32_16x16x32_bf16 v[72:75],v[136:139],a[152:155],v[72:75]
v_exp_f32 v108,v108
v_mfma_f32_16x16x32_bf16 v[72:75],v[140:143],a[156:159],v[72:75]
v_exp_f32 v109,v109
v_mfma_f32_16x16x32_bf16 v[72:75],v[112:115],a[160:163],v[72:75]
v_exp_f32 v110,v110
v_mfma_f32_16x16x32_bf16 v[72:75],v[116:119],a[164:167],v[72:75]
v_exp_f32 v111,v111
v_mfma_f32_16x16x32_bf16 v[80:83],v[116:119],a[188:191],0
v_cvt_pk_bf16_f32 v42,v108,v109
v_cvt_pk_bf16_f32 v43,v110,v111
v_mfma_f32_16x16x32_bf16 v[80:83],v[112:115],a[184:187],v[80:83]
v_mfma_f32_16x16x32_bf16 v[80:83],v[140:143],a[180:183],v[80:83]
v_smfmac_f32_16x16x64_bf16 v[68:71],v[152:155],v[36:43],v18
buffer_load_dwordx4 v8,s[8:11],s21 offen offset:2048 lds
v_mfma_f32_16x16x32_bf16 v[80:83],v[136:139],a[176:179],v[80:83]
s_add_u32 s21,s21,12288
v_fma_f32 v72,v72,s36,v13
v_fma_f32 v73,v73,s36,v13
v_mfma_f32_16x16x32_bf16 v[80:83],v[132:135],a[172:175],v[80:83]
s_add_u32 m0,s22,12288
v_fma_f32 v74,v74,s36,v13
v_fma_f32 v75,v75,s36,v13
v_mfma_f32_16x16x32_bf16 v[80:83],v[128:131],a[168:171],v[80:83]
v_exp_f32 v72,v72
v_mfma_f32_16x16x32_bf16 v[88:91],v[128:131],a[192:195],0
v_exp_f32 v73,v73
v_mfma_f32_16x16x32_bf16 v[88:91],v[132:135],a[196:199],v[88:91]
v_exp_f32 v74,v74
v_mfma_f32_16x16x32_bf16 v[88:91],v[136:139],a[200:203],v[88:91]
v_exp_f32 v75,v75
v_mfma_f32_16x16x32_bf16 v[88:91],v[140:143],a[204:207],v[88:91]
v_fma_f32 v80,v80,s36,v14
v_fma_f32 v81,v81,s36,v14
v_mfma_f32_16x16x32_bf16 v[88:91],v[112:115],a[208:211],v[88:91]
v_fma_f32 v82,v82,s36,v14
v_fma_f32 v83,v83,s36,v14
v_mfma_f32_16x16x32_bf16 v[88:91],v[116:119],a[212:215],v[88:91]
v_exp_f32 v80,v80
v_mfma_f32_16x16x32_bf16 v[96:99],v[116:119],a[236:239],0
v_exp_f32 v81,v81
v_mfma_f32_16x16x32_bf16 v[96:99],v[112:115],a[232:235],v[96:99]
buffer_load_dwordx4 v6,s[4:7],s20 offen offset:0 lds
v_mfma_f32_16x16x32_bf16 v[96:99],v[140:143],a[228:231],v[96:99]
v_exp_f32 v82,v82
v_mfma_f32_16x16x32_bf16 v[96:99],v[136:139],a[224:227],v[96:99]
v_fma_f32 v88,v88,s36,v15
v_fma_f32 v89,v89,s36,v15
v_mfma_f32_16x16x32_bf16 v[96:99],v[132:135],a[220:223],v[96:99]
v_exp_f32 v83,v83
v_mfma_f32_16x16x32_bf16 v[96:99],v[128:131],a[216:219],v[96:99]
v_exp_f32 v88,v88
v_mfma_f32_16x16x32_bf16 v[104:107],v[128:131],a[240:243],0
ds_read_b128 v[128:131],v0 offset:30848
v_cvt_pk_bf16_f32 v20,v72,v73
v_mfma_f32_16x16x32_bf16 v[104:107],v[132:135],a[244:247],v[104:107]
ds_read_b128 v[132:135],v1 offset:30848
v_cvt_pk_bf16_f32 v21,v74,v75
v_mfma_f32_16x16x32_bf16 v[104:107],v[136:139],a[248:251],v[104:107]
ds_read_b128 v[136:139],v0 offset:30976
v_cvt_pk_bf16_f32 v24,v80,v81
v_mfma_f32_16x16x32_bf16 v[104:107],v[140:143],a[252:255],v[104:107]
ds_read_b128 v[140:143],v1 offset:30976
v_cvt_pk_bf16_f32 v25,v82,v83
v_mfma_f32_16x16x32_bf16 v[104:107],v[112:115],v[144:147],v[104:107]
v_exp_f32 v89,v89
v_mfma_f32_16x16x32_bf16 v[104:107],v[116:119],v[148:151],v[104:107]
s_waitcnt lgkmcnt(4)
v_cvt_pk_bf16_f32 v28,v88,v89
v_mfma_f32_16x16x32_bf16 v[76:79],v[120:123],a[144:147],0
v_mfma_f32_16x16x32_bf16 v[76:79],v[124:127],a[148:151],v[76:79]
buffer_load_dwordx4 v7,s[4:7],s20 offen offset:1024 lds
s_waitcnt lgkmcnt(3)
v_mfma_f32_16x16x32_bf16 v[76:79],v[128:131],a[152:155],v[76:79]
s_waitcnt lgkmcnt(2)
v_mfma_f32_16x16x32_bf16 v[76:79],v[132:135],a[156:159],v[76:79]
s_waitcnt lgkmcnt(1)
v_mfma_f32_16x16x32_bf16 v[76:79],v[136:139],a[160:163],v[76:79]
s_waitcnt lgkmcnt(0)
v_mfma_f32_16x16x32_bf16 v[76:79],v[140:143],a[164:167],v[76:79]
v_mfma_f32_16x16x32_bf16 v[84:87],v[140:143],a[188:191],0
v_mfma_f32_16x16x32_bf16 v[84:87],v[136:139],a[184:187],v[84:87]
v_mfma_f32_16x16x32_bf16 v[84:87],v[132:135],a[180:183],v[84:87]
v_mfma_f32_16x16x32_bf16 v[84:87],v[128:131],a[176:179],v[84:87]
v_mfma_f32_16x16x32_bf16 v[84:87],v[124:127],a[172:175],v[84:87]
v_mfma_f32_16x16x32_bf16 v[84:87],v[120:123],a[168:171],v[84:87]
v_mfma_f32_16x16x32_bf16 v[92:95],v[120:123],a[192:195],0
buffer_load_dwordx4 v8,s[4:7],s20 offen offset:2048 lds
v_mfma_f32_16x16x32_bf16 v[92:95],v[124:127],a[196:199],v[92:95]
s_add_u32 s20,s20,12288
v_mfma_f32_16x16x32_bf16 v[92:95],v[128:131],a[200:203],v[92:95]
v_mfma_f32_16x16x32_bf16 v[92:95],v[132:135],a[204:207],v[92:95]
v_mfma_f32_16x16x32_bf16 v[92:95],v[136:139],a[208:211],v[92:95]
v_mfma_f32_16x16x32_bf16 v[92:95],v[140:143],a[212:215],v[92:95]
ds_read_b64_tr_b16 v[112:113],v2 offset:12288
v_mfma_f32_16x16x32_bf16 v[100:103],v[140:143],a[236:239],0
ds_read_b64_tr_b16 v[114:115],v2 offset:18432
v_mfma_f32_16x16x32_bf16 v[100:103],v[136:139],a[232:235],v[100:103]
v_mfma_f32_16x16x32_bf16 v[100:103],v[132:135],a[228:231],v[100:103]
ds_read_b64_tr_b16 v[116:117],v3 offset:12288
v_mfma_f32_16x16x32_bf16 v[100:103],v[128:131],a[224:227],v[100:103]
ds_read_b64_tr_b16 v[118:119],v3 offset:18432
v_mfma_f32_16x16x32_bf16 v[100:103],v[124:127],a[220:223],v[100:103]
v_mfma_f32_16x16x32_bf16 v[100:103],v[120:123],a[216:219],v[100:103]
v_mfma_f32_16x16x32_bf16 v[108:111],v[120:123],a[240:243],0
ds_read_b64_tr_b16 v[120:121],v4 offset:12288
v_mfma_f32_16x16x32_bf16 v[108:111],v[124:127],a[244:247],v[108:111]
ds_read_b64_tr_b16 v[122:123],v4 offset:18432
v_mfma_f32_16x16x32_bf16 v[108:111],v[128:131],a[248:251],v[108:111]
ds_read_b64_tr_b16 v[124:125],v5 offset:12288
v_mfma_f32_16x16x32_bf16 v[108:111],v[132:135],a[252:255],v[108:111]
ds_read_b64_tr_b16 v[126:127],v5 offset:18432
v_mfma_f32_16x16x32_bf16 v[108:111],v[136:139],v[144:147],v[108:111]
v_mfma_f32_16x16x32_bf16 v[108:111],v[140:143],v[148:151],v[108:111]
s_waitcnt lgkmcnt(4)
v_mfma_f32_16x16x32_bf16 v[160:163],v[112:115],v[44:47],v[160:163]
s_add_u32 m0,s23,12288
ds_read_b64_tr_b16 v[128:129],v2 offset:12416
v_fma_f32 v90,v90,s36,v15
v_mfma_f32_16x16x32_bf16 v[164:167],v[116:119],v[44:47],v[164:167]
ds_read_b64_tr_b16 v[130:131],v2 offset:18560
v_fma_f32 v91,v91,s36,v15
v_mfma_f32_16x16x32_bf16 v[212:215],v[116:119],v[48:51],v[212:215]
ds_read_b64_tr_b16 v[132:133],v3 offset:12416
v_fma_f32 v96,v96,s36,v16
v_mfma_f32_16x16x32_bf16 v[208:211],v[112:115],v[48:51],v[208:211]
ds_read_b64_tr_b16 v[134:135],v3 offset:18560
v_fma_f32 v97,v97,s36,v16
v_mfma_f32_16x16x32_bf16 a[0:3],v[112:115],v[52:55],a[0:3]
ds_read_b64_tr_b16 v[136:137],v4 offset:12416
v_fma_f32 v98,v98,s36,v16
v_mfma_f32_16x16x32_bf16 a[4:7],v[116:119],v[52:55],a[4:7]
ds_read_b64_tr_b16 v[138:139],v4 offset:18560
v_fma_f32 v99,v99,s36,v16
v_mfma_f32_16x16x32_bf16 a[52:55],v[116:119],v[56:59],a[52:55]
ds_read_b64_tr_b16 v[140:141],v5 offset:12416
v_fma_f32 v104,v104,s36,v17
v_mfma_f32_16x16x32_bf16 a[48:51],v[112:115],v[56:59],a[48:51]
ds_read_b64_tr_b16 v[142:143],v5 offset:18560
v_fma_f32 v105,v105,s36,v17
v_mfma_f32_16x16x32_bf16 a[96:99],v[112:115],v[40:43],a[96:99]
ds_read_b64_tr_b16 v[112:113],v2 offset:12544
v_fma_f32 v106,v106,s36,v17
v_mfma_f32_16x16x32_bf16 a[100:103],v[116:119],v[40:43],a[100:103]
s_waitcnt lgkmcnt(6)
ds_read_b64_tr_b16 v[114:115],v2 offset:18688
v_fma_f32 v107,v107,s36,v17
v_mfma_f32_16x16x32_bf16 a[104:107],v[120:123],v[40:43],a[104:107]
ds_read_b64_tr_b16 v[116:117],v3 offset:12544
v_fma_f32 v76,v76,s36,v13
v_mfma_f32_16x16x32_bf16 a[108:111],v[124:127],v[40:43],a[108:111]
ds_read_b64_tr_b16 v[118:119],v3 offset:18688
v_fma_f32 v77,v77,s36,v13
v_mfma_f32_16x16x32_bf16 a[60:63],v[124:127],v[56:59],a[60:63]
v_exp_f32 v90,v90
v_mfma_f32_16x16x32_bf16 a[56:59],v[120:123],v[56:59],a[56:59]
v_exp_f32 v91,v91
v_mfma_f32_16x16x32_bf16 a[8:11],v[120:123],v[52:55],a[8:11]
v_cvt_pk_bf16_f32 v29,v90,v91
v_fma_f32 v78,v78,s36,v13
v_mfma_f32_16x16x32_bf16 a[12:15],v[124:127],v[52:55],a[12:15]
v_exp_f32 v96,v96
v_mfma_f32_16x16x32_bf16 v[220:223],v[124:127],v[48:51],v[220:223]
v_exp_f32 v97,v97
v_mfma_f32_16x16x32_bf16 v[216:219],v[120:123],v[48:51],v[216:219]
v_exp_f32 v98,v98
v_mfma_f32_16x16x32_bf16 v[168:171],v[120:123],v[44:47],v[168:171]
ds_read_b64_tr_b16 v[120:121],v4 offset:12544
v_cvt_pk_bf16_f32 v32,v96,v97
v_mfma_f32_16x16x32_bf16 v[172:175],v[124:127],v[44:47],v[172:175]
ds_read_b64_tr_b16 v[122:123],v4 offset:18688
v_fma_f32 v79,v79,s36,v13
v_mfma_f32_16x16x32_bf16 v[176:179],v[128:131],v[44:47],v[176:179]
s_waitcnt lgkmcnt(2)
ds_read_b64_tr_b16 v[124:125],v5 offset:12544
v_fma_f32 v84,v84,s36,v14
v_mfma_f32_16x16x32_bf16 v[180:183],v[132:135],v[44:47],v[180:183]
ds_read_b64_tr_b16 v[126:127],v5 offset:18688
v_fma_f32 v85,v85,s36,v14
v_mfma_f32_16x16x32_bf16 v[228:231],v[132:135],v[48:51],v[228:231]
v_exp_f32 v99,v99
v_mfma_f32_16x16x32_bf16 v[224:227],v[128:131],v[48:51],v[224:227]
v_cvt_pk_bf16_f32 v33,v98,v99
v_fma_f32 v86,v86,s36,v14
v_mfma_f32_16x16x32_bf16 a[16:19],v[128:131],v[52:55],a[16:19]
v_exp_f32 v104,v104
v_mfma_f32_16x16x32_bf16 a[20:23],v[132:135],v[52:55],a[20:23]
v_exp_f32 v105,v105
v_mfma_f32_16x16x32_bf16 a[68:71],v[132:135],v[56:59],a[68:71]
v_exp_f32 v106,v106
v_mfma_f32_16x16x32_bf16 a[64:67],v[128:131],v[56:59],a[64:67]
v_exp_f32 v107,v107
v_mfma_f32_16x16x32_bf16 a[112:115],v[128:131],v[40:43],a[112:115]
v_cvt_pk_bf16_f32 v36,v104,v105
v_cvt_pk_bf16_f32 v37,v106,v107
v_mfma_f32_16x16x32_bf16 a[116:119],v[132:135],v[40:43],a[116:119]
v_exp_f32 v76,v76
v_mfma_f32_16x16x32_bf16 a[120:123],v[136:139],v[40:43],a[120:123]
v_exp_f32 v77,v77
v_mfma_f32_16x16x32_bf16 a[124:127],v[140:143],v[40:43],a[124:127]
v_exp_f32 v78,v78
v_mfma_f32_16x16x32_bf16 a[76:79],v[140:143],v[56:59],a[76:79]
v_exp_f32 v79,v79
v_mfma_f32_16x16x32_bf16 a[72:75],v[136:139],v[56:59],a[72:75]
v_cvt_pk_bf16_f32 v22,v76,v77
v_cvt_pk_bf16_f32 v23,v78,v79
v_mfma_f32_16x16x32_bf16 a[24:27],v[136:139],v[52:55],a[24:27]
v_fma_f32 v87,v87,s36,v14
v_fma_f32 v92,v92,s36,v15
v_mfma_f32_16x16x32_bf16 a[28:31],v[140:143],v[52:55],a[28:31]
v_exp_f32 v84,v84
v_mfma_f32_16x16x32_bf16 v[236:239],v[140:143],v[48:51],v[236:239]
v_exp_f32 v85,v85
v_mfma_f32_16x16x32_bf16 v[232:235],v[136:139],v[48:51],v[232:235]
v_exp_f32 v86,v86
v_mfma_f32_16x16x32_bf16 v[184:187],v[136:139],v[44:47],v[184:187]
v_exp_f32 v87,v87
v_mfma_f32_16x16x32_bf16 v[188:191],v[140:143],v[44:47],v[188:191]
v_cvt_pk_bf16_f32 v26,v84,v85
v_cvt_pk_bf16_f32 v27,v86,v87
v_mfma_f32_16x16x32_bf16 v[192:195],v[112:115],v[44:47],v[192:195]
v_fma_f32 v93,v93,s36,v15
v_fma_f32 v94,v94,s36,v15
v_smfmac_f32_16x16x64_bf16 v[60:63],v[152:155],v[20:27],v18
v_fma_f32 v95,v95,s36,v15
v_mfma_f32_16x16x32_bf16 v[196:199],v[116:119],v[44:47],v[196:199]
s_waitcnt vmcnt(6) lgkmcnt(0)
v_exp_f32 v92,v92
v_mfma_f32_16x16x32_bf16 v[244:247],v[116:119],v[48:51],v[244:247]
s_barrier
v_mfma_f32_16x16x32_bf16 v[240:243],v[112:115],v[48:51],v[240:243]
ds_read_b128 v[128:131],v0 offset:0
v_fma_f32 v100,v100,s36,v16
v_mfma_f32_16x16x32_bf16 a[32:35],v[112:115],v[52:55],a[32:35]
ds_read_b128 v[132:135],v1 offset:0
v_fma_f32 v101,v101,s36,v16
v_mfma_f32_16x16x32_bf16 a[36:39],v[116:119],v[52:55],a[36:39]
ds_read_b128 v[136:139],v0 offset:128
v_fma_f32 v102,v102,s36,v16
v_mfma_f32_16x16x32_bf16 a[84:87],v[116:119],v[56:59],a[84:87]
ds_read_b128 v[140:143],v1 offset:128
v_fma_f32 v103,v103,s36,v16
v_mfma_f32_16x16x32_bf16 a[80:83],v[112:115],v[56:59],a[80:83]
v_exp_f32 v93,v93
v_mfma_f32_16x16x32_bf16 a[128:131],v[112:115],v[40:43],a[128:131]
buffer_load_dwordx4 v6,s[8:11],s21 offen offset:0 lds
v_mfma_f32_16x16x32_bf16 a[132:135],v[116:119],v[40:43],a[132:135]
ds_read_b128 v[112:115],v0 offset:256
v_cvt_pk_bf16_f32 v30,v92,v93
v_mfma_f32_16x16x32_bf16 a[136:139],v[120:123],v[40:43],a[136:139]
ds_read_b128 v[116:119],v1 offset:256
v_fma_f32 v108,v108,s36,v17
v_mfma_f32_16x16x32_bf16 a[140:143],v[124:127],v[40:43],a[140:143]
v_exp_f32 v94,v94
v_mfma_f32_16x16x32_bf16 a[92:95],v[124:127],v[56:59],a[92:95]
v_exp_f32 v95,v95
v_mfma_f32_16x16x32_bf16 a[88:91],v[120:123],v[56:59],a[88:91]
v_cvt_pk_bf16_f32 v31,v94,v95
v_fma_f32 v109,v109,s36,v17
v_mfma_f32_16x16x32_bf16 a[40:43],v[120:123],v[52:55],a[40:43]
v_exp_f32 v100,v100
v_mfma_f32_16x16x32_bf16 a[44:47],v[124:127],v[52:55],a[44:47]
v_exp_f32 v101,v101
v_mfma_f32_16x16x32_bf16 v[252:255],v[124:127],v[48:51],v[252:255]
v_exp_f32 v102,v102
v_mfma_f32_16x16x32_bf16 v[248:251],v[120:123],v[48:51],v[248:251]
v_exp_f32 v103,v103
v_mfma_f32_16x16x32_bf16 v[200:203],v[120:123],v[44:47],v[200:203]
ds_read_b128 v[120:123],v0 offset:6144
v_cvt_pk_bf16_f32 v34,v100,v101
v_mfma_f32_16x16x32_bf16 v[204:207],v[124:127],v[44:47],v[204:207]
buffer_load_dwordx4 v7,s[8:11],s21 offen offset:1024 lds
s_waitcnt lgkmcnt(1)
v_mfma_f32_16x16x32_bf16 v[72:75],v[128:131],a[144:147],0
ds_read_b128 v[124:127],v1 offset:6144
v_cvt_pk_bf16_f32 v35,v102,v103
v_mfma_f32_16x16x32_bf16 v[72:75],v[132:135],a[148:151],v[72:75]
v_fma_f32 v110,v110,s36,v17
v_fma_f32 v111,v111,s36,v17
v_smfmac_f32_16x16x64_bf16 v[64:67],v[152:155],v[28:35],v18
v_mfma_f32_16x16x32_bf16 v[72:75],v[136:139],a[152:155],v[72:75]
v_exp_f32 v108,v108
v_mfma_f32_16x16x32_bf16 v[72:75],v[140:143],a[156:159],v[72:75]
v_exp_f32 v109,v109
v_mfma_f32_16x16x32_bf16 v[72:75],v[112:115],a[160:163],v[72:75]
v_exp_f32 v110,v110
v_mfma_f32_16x16x32_bf16 v[72:75],v[116:119],a[164:167],v[72:75]
v_exp_f32 v111,v111
v_mfma_f32_16x16x32_bf16 v[80:83],v[116:119],a[188:191],0
v_cvt_pk_bf16_f32 v38,v108,v109
v_cvt_pk_bf16_f32 v39,v110,v111
v_mfma_f32_16x16x32_bf16 v[80:83],v[112:115],a[184:187],v[80:83]
v_mfma_f32_16x16x32_bf16 v[80:83],v[140:143],a[180:183],v[80:83]
v_mfma_f32_16x16x32_bf16 v[80:83],v[136:139],a[176:179],v[80:83]
buffer_load_dwordx4 v8,s[8:11],s21 offen offset:2048 lds
v_mfma_f32_16x16x32_bf16 v[80:83],v[132:135],a[172:175],v[80:83]
s_add_u32 s21,s21,12288
v_fma_f32 v72,v72,s36,v13
v_fma_f32 v73,v73,s36,v13
v_mfma_f32_16x16x32_bf16 v[80:83],v[128:131],a[168:171],v[80:83]
s_add_u32 m0,s22,24576
v_fma_f32 v74,v74,s36,v13
v_fma_f32 v75,v75,s36,v13
v_mfma_f32_16x16x32_bf16 v[88:91],v[128:131],a[192:195],0
v_exp_f32 v72,v72
v_mfma_f32_16x16x32_bf16 v[88:91],v[132:135],a[196:199],v[88:91]
v_exp_f32 v73,v73
v_mfma_f32_16x16x32_bf16 v[88:91],v[136:139],a[200:203],v[88:91]
v_fma_f32 v80,v80,s36,v14
v_fma_f32 v81,v81,s36,v14
v_mfma_f32_16x16x32_bf16 v[88:91],v[140:143],a[204:207],v[88:91]
v_fma_f32 v82,v82,s36,v14
v_fma_f32 v83,v83,s36,v14
v_mfma_f32_16x16x32_bf16 v[88:91],v[112:115],a[208:211],v[88:91]
v_exp_f32 v74,v74
v_mfma_f32_16x16x32_bf16 v[88:91],v[116:119],a[212:215],v[88:91]
v_exp_f32 v75,v75
v_mfma_f32_16x16x32_bf16 v[96:99],v[116:119],a[236:239],0
v_exp_f32 v80,v80
v_mfma_f32_16x16x32_bf16 v[96:99],v[112:115],a[232:235],v[96:99]
v_exp_f32 v81,v81
v_mfma_f32_16x16x32_bf16 v[96:99],v[140:143],a[228:231],v[96:99]
v_exp_f32 v82,v82
v_mfma_f32_16x16x32_bf16 v[96:99],v[136:139],a[224:227],v[96:99]
buffer_load_dwordx4 v6,s[4:7],s20 offen offset:0 lds
v_mfma_f32_16x16x32_bf16 v[96:99],v[132:135],a[220:223],v[96:99]
v_fma_f32 v88,v88,s36,v15
v_fma_f32 v89,v89,s36,v15
v_mfma_f32_16x16x32_bf16 v[96:99],v[128:131],a[216:219],v[96:99]
v_exp_f32 v83,v83
v_mfma_f32_16x16x32_bf16 v[104:107],v[128:131],a[240:243],0
ds_read_b128 v[128:131],v0 offset:6272
v_cvt_pk_bf16_f32 v44,v72,v73
v_mfma_f32_16x16x32_bf16 v[104:107],v[132:135],a[244:247],v[104:107]
ds_read_b128 v[132:135],v1 offset:6272
v_cvt_pk_bf16_f32 v45,v74,v75
v_mfma_f32_16x16x32_bf16 v[104:107],v[136:139],a[248:251],v[104:107]
ds_read_b128 v[136:139],v0 offset:6400
v_cvt_pk_bf16_f32 v48,v80,v81
v_mfma_f32_16x16x32_bf16 v[104:107],v[140:143],a[252:255],v[104:107]
ds_read_b128 v[140:143],v1 offset:6400
v_cvt_pk_bf16_f32 v49,v82,v83
v_mfma_f32_16x16x32_bf16 v[104:107],v[112:115],v[144:147],v[104:107]
v_exp_f32 v88,v88
v_mfma_f32_16x16x32_bf16 v[104:107],v[116:119],v[148:151],v[104:107]
s_waitcnt lgkmcnt(4)
v_exp_f32 v89,v89
v_mfma_f32_16x16x32_bf16 v[76:79],v[120:123],a[144:147],0
v_cvt_pk_bf16_f32 v52,v88,v89
v_mfma_f32_16x16x32_bf16 v[76:79],v[124:127],a[148:151],v[76:79]
s_waitcnt lgkmcnt(3)
v_mfma_f32_16x16x32_bf16 v[76:79],v[128:131],a[152:155],v[76:79]
buffer_load_dwordx4 v7,s[4:7],s20 offen offset:1024 lds
s_waitcnt lgkmcnt(2)
v_mfma_f32_16x16x32_bf16 v[76:79],v[132:135],a[156:159],v[76:79]
s_waitcnt lgkmcnt(1)
v_mfma_f32_16x16x32_bf16 v[76:79],v[136:139],a[160:163],v[76:79]
s_waitcnt lgkmcnt(0)
v_mfma_f32_16x16x32_bf16 v[76:79],v[140:143],a[164:167],v[76:79]
v_mfma_f32_16x16x32_bf16 v[84:87],v[140:143],a[188:191],0
v_mfma_f32_16x16x32_bf16 v[84:87],v[136:139],a[184:187],v[84:87]
v_mfma_f32_16x16x32_bf16 v[84:87],v[132:135],a[180:183],v[84:87]
v_mfma_f32_16x16x32_bf16 v[84:87],v[128:131],a[176:179],v[84:87]
v_mfma_f32_16x16x32_bf16 v[84:87],v[124:127],a[172:175],v[84:87]
v_mfma_f32_16x16x32_bf16 v[84:87],v[120:123],a[168:171],v[84:87]
v_mfma_f32_16x16x32_bf16 v[92:95],v[120:123],a[192:195],0
v_mfma_f32_16x16x32_bf16 v[92:95],v[124:127],a[196:199],v[92:95]
buffer_load_dwordx4 v8,s[4:7],s20 offen offset:2048 lds
v_mfma_f32_16x16x32_bf16 v[92:95],v[128:131],a[200:203],v[92:95]
s_add_u32 s20,s20,12288
v_mfma_f32_16x16x32_bf16 v[92:95],v[132:135],a[204:207],v[92:95]
v_mfma_f32_16x16x32_bf16 v[92:95],v[136:139],a[208:211],v[92:95]
v_mfma_f32_16x16x32_bf16 v[92:95],v[140:143],a[212:215],v[92:95]
v_mfma_f32_16x16x32_bf16 v[100:103],v[140:143],a[236:239],0
v_mfma_f32_16x16x32_bf16 v[100:103],v[136:139],a[232:235],v[100:103]
ds_read_b64_tr_b16 v[112:113],v2 offset:24576
v_mfma_f32_16x16x32_bf16 v[100:103],v[132:135],a[228:231],v[100:103]
ds_read_b64_tr_b16 v[114:115],v2 offset:30720
v_mfma_f32_16x16x32_bf16 v[100:103],v[128:131],a[224:227],v[100:103]
ds_read_b64_tr_b16 v[116:117],v3 offset:24576
v_mfma_f32_16x16x32_bf16 v[100:103],v[124:127],a[220:223],v[100:103]
ds_read_b64_tr_b16 v[118:119],v3 offset:30720
v_mfma_f32_16x16x32_bf16 v[100:103],v[120:123],a[216:219],v[100:103]
v_mfma_f32_16x16x32_bf16 v[108:111],v[120:123],a[240:243],0
ds_read_b64_tr_b16 v[120:121],v4 offset:24576
v_mfma_f32_16x16x32_bf16 v[108:111],v[124:127],a[244:247],v[108:111]
ds_read_b64_tr_b16 v[122:123],v4 offset:30720
v_mfma_f32_16x16x32_bf16 v[108:111],v[128:131],a[248:251],v[108:111]
ds_read_b64_tr_b16 v[124:125],v5 offset:24576
v_mfma_f32_16x16x32_bf16 v[108:111],v[132:135],a[252:255],v[108:111]
ds_read_b64_tr_b16 v[126:127],v5 offset:30720
v_mfma_f32_16x16x32_bf16 v[108:111],v[136:139],v[144:147],v[108:111]
v_mfma_f32_16x16x32_bf16 v[108:111],v[140:143],v[148:151],v[108:111]
s_mov_b32 s38,0
s_branch L_loop5
L_tr44:
s_waitcnt vmcnt(42)
s_waitcnt lgkmcnt(3)
v_mfma_f32_16x16x32_bf16 v[160:163],v[112:115],v[20:23],v[160:163]
s_add_u32 m0,s24,0
ds_read_b128 a[144:147],v11 offset:0
v_fma_f32 v82,v82,s36,v14
v_mfma_f32_16x16x32_bf16 v[164:167],v[116:119],v[20:23],v[164:167]
ds_read_b128 a[148:151],v12 offset:0
v_fma_f32 v83,v83,s36,v14
v_mfma_f32_16x16x32_bf16 v[212:215],v[116:119],v[24:27],v[212:215]
ds_read_b128 a[152:155],v11 offset:128
v_fma_f32 v88,v88,s36,v15
v_mfma_f32_16x16x32_bf16 v[208:211],v[112:115],v[24:27],v[208:211]
ds_read_b128 a[156:159],v12 offset:128
v_fma_f32 v89,v89,s36,v15
v_mfma_f32_16x16x32_bf16 a[0:3],v[112:115],v[28:31],a[0:3]
ds_read_b128 a[160:163],v11 offset:256
v_fma_f32 v90,v90,s36,v15
v_mfma_f32_16x16x32_bf16 a[4:7],v[116:119],v[28:31],a[4:7]
ds_read_b128 a[164:167],v12 offset:256
v_fma_f32 v91,v91,s36,v15
ds_read_b64_tr_b16 v[128:129],v2 offset:24704
ds_read_b64_tr_b16 v[130:131],v2 offset:30848
ds_read_b64_tr_b16 v[132:133],v3 offset:24704
ds_read_b64_tr_b16 v[134:135],v3 offset:30848
ds_read_b64_tr_b16 v[136:137],v4 offset:24704
ds_read_b64_tr_b16 v[138:139],v4 offset:30848
ds_read_b64_tr_b16 v[140:141],v5 offset:24704
ds_read_b64_tr_b16 v[142:143],v5 offset:30848
ds_read_b128 a[168:171],v11 offset:6144
v_mfma_f32_16x16x32_bf16 a[52:55],v[116:119],v[32:35],a[52:55]
v_fma_f32 v96,v96,s36,v16
ds_read_b128 a[172:175],v12 offset:6144
v_mfma_f32_16x16x32_bf16 a[48:51],v[112:115],v[32:35],a[48:51]
s_waitcnt lgkmcnt(12)
v_fma_f32 v97,v97,s36,v16
ds_read_b128 a[176:179],v11 offset:6272
v_mfma_f32_16x16x32_bf16 a[56:59],v[120:123],v[32:35],a[56:59]
s_waitcnt lgkmcnt(11)
buffer_load_dwordx4 v6,s[12:15],s28 offen offset:0 nt lds
v_mfma_f32_16x16x32_bf16 a[60:63],v[124:127],v[32:35],a[60:63]
ds_read_b64_tr_b16 v[112:113],v2 offset:24832
ds_read_b128 a[180:183],v12 offset:6272
v_mfma_f32_16x16x32_bf16 a[12:15],v[124:127],v[28:31],a[12:15]
v_fma_f32 v98,v98,s36,v16
ds_read_b64_tr_b16 v[116:117],v3 offset:24832
ds_read_b64_tr_b16 v[118:119],v3 offset:30976
ds_read_b64_tr_b16 v[114:115],v2 offset:30976
ds_read_b128 a[184:187],v11 offset:6400
v_mfma_f32_16x16x32_bf16 a[8:11],v[120:123],v[28:31],a[8:11]
v_fma_f32 v99,v99,s36,v16
ds_read_b128 a[188:191],v12 offset:6400
v_mfma_f32_16x16x32_bf16 v[216:219],v[120:123],v[24:27],v[216:219]
buffer_load_dwordx4 v7,s[12:15],s28 offen offset:1024 nt lds
v_mfma_f32_16x16x32_bf16 v[220:223],v[124:127],v[24:27],v[220:223]
v_fma_f32 v76,v76,s36,v13
v_fma_f32 v77,v77,s36,v13
v_mfma_f32_16x16x32_bf16 v[172:175],v[124:127],v[20:23],v[172:175]
ds_read_b64_tr_b16 v[124:125],v5 offset:24832
v_fma_f32 v78,v78,s36,v13
v_mfma_f32_16x16x32_bf16 v[168:171],v[120:123],v[20:23],v[168:171]
s_waitcnt lgkmcnt(6)
ds_read_b64_tr_b16 v[120:121],v4 offset:24832
v_fma_f32 v79,v79,s36,v13
v_mfma_f32_16x16x32_bf16 v[176:179],v[128:131],v[20:23],v[176:179]
ds_read_b64_tr_b16 v[122:123],v4 offset:30976
v_fma_f32 v84,v84,s36,v14
v_mfma_f32_16x16x32_bf16 v[180:183],v[132:135],v[20:23],v[180:183]
ds_read_b64_tr_b16 v[126:127],v5 offset:30976
v_fma_f32 v85,v85,s36,v14
v_mfma_f32_16x16x32_bf16 v[228:231],v[132:135],v[24:27],v[228:231]
v_fma_f32 v86,v86,s36,v14
v_fma_f32 v87,v87,s36,v14
v_mfma_f32_16x16x32_bf16 v[224:227],v[128:131],v[24:27],v[224:227]
buffer_load_dwordx4 v8,s[12:15],s28 offen offset:2048 nt lds
v_mfma_f32_16x16x32_bf16 a[16:19],v[128:131],v[28:31],a[16:19]
s_add_u32 s28,s28,3072
v_fma_f32 v92,v92,s36,v15
v_fma_f32 v93,v93,s36,v15
v_mfma_f32_16x16x32_bf16 a[20:23],v[132:135],v[28:31],a[20:23]
s_add_u32 m0,s24,3072
v_fma_f32 v94,v94,s36,v15
v_fma_f32 v95,v95,s36,v15
v_mfma_f32_16x16x32_bf16 a[68:71],v[132:135],v[32:35],a[68:71]
v_fma_f32 v100,v100,s36,v16
v_fma_f32 v101,v101,s36,v16
v_mfma_f32_16x16x32_bf16 a[64:67],v[128:131],v[32:35],a[64:67]
v_fma_f32 v102,v102,s36,v16
v_fma_f32 v103,v103,s36,v16
v_mfma_f32_16x16x32_bf16 a[72:75],v[136:139],v[32:35],a[72:75]
v_exp_f32 v82,v82
v_mfma_f32_16x16x32_bf16 a[76:79],v[140:143],v[32:35],a[76:79]
v_exp_f32 v83,v83
v_mfma_f32_16x16x32_bf16 a[28:31],v[140:143],v[28:31],a[28:31]
v_exp_f32 v88,v88
v_mfma_f32_16x16x32_bf16 a[24:27],v[136:139],v[28:31],a[24:27]
buffer_load_dwordx4 v6,s[12:15],s28 offen offset:0 nt lds
v_mfma_f32_16x16x32_bf16 v[232:235],v[136:139],v[24:27],v[232:235]
v_exp_f32 v89,v89
v_mfma_f32_16x16x32_bf16 v[236:239],v[140:143],v[24:27],v[236:239]
v_exp_f32 v90,v90
v_mfma_f32_16x16x32_bf16 v[188:191],v[140:143],v[20:23],v[188:191]
v_exp_f32 v91,v91
v_mfma_f32_16x16x32_bf16 v[184:187],v[136:139],v[20:23],v[184:187]
s_waitcnt lgkmcnt(0)
v_exp_f32 v96,v96
v_mfma_f32_16x16x32_bf16 v[192:195],v[112:115],v[20:23],v[192:195]
v_exp_f32 v97,v97
v_mfma_f32_16x16x32_bf16 v[196:199],v[116:119],v[20:23],v[196:199]
v_exp_f32 v98,v98
v_mfma_f32_16x16x32_bf16 v[244:247],v[116:119],v[24:27],v[244:247]
v_exp_f32 v99,v99
v_mfma_f32_16x16x32_bf16 v[240:243],v[112:115],v[24:27],v[240:243]
buffer_load_dwordx4 v7,s[12:15],s28 offen offset:1024 nt lds
v_mfma_f32_16x16x32_bf16 a[32:35],v[112:115],v[28:31],a[32:35]
v_exp_f32 v76,v76
v_mfma_f32_16x16x32_bf16 a[36:39],v[116:119],v[28:31],a[36:39]
v_exp_f32 v77,v77
v_mfma_f32_16x16x32_bf16 a[84:87],v[116:119],v[32:35],a[84:87]
v_exp_f32 v78,v78
v_mfma_f32_16x16x32_bf16 a[80:83],v[112:115],v[32:35],a[80:83]
v_exp_f32 v79,v79
v_mfma_f32_16x16x32_bf16 a[88:91],v[120:123],v[32:35],a[88:91]
v_exp_f32 v84,v84
v_mfma_f32_16x16x32_bf16 a[92:95],v[124:127],v[32:35],a[92:95]
v_exp_f32 v85,v85
v_mfma_f32_16x16x32_bf16 a[44:47],v[124:127],v[28:31],a[44:47]
v_exp_f32 v86,v86
v_mfma_f32_16x16x32_bf16 a[40:43],v[120:123],v[28:31],a[40:43]
buffer_load_dwordx4 v8,s[12:15],s28 offen offset:2048 nt lds
s_waitcnt vmcnt(20)
s_barrier
v_mfma_f32_16x16x32_bf16 v[248:251],v[120:123],v[24:27],v[248:251]
s_add_u32 s28,s28,3072
ds_read_b64_tr_b16 v[128:129],v2 offset:0
v_exp_f32 v87,v87
v_mfma_f32_16x16x32_bf16 v[252:255],v[124:127],v[24:27],v[252:255]
s_add_u32 m0,s22,0
ds_read_b64_tr_b16 v[130:131],v2 offset:6144
buffer_load_dwordx4 v6,s[4:7],s25 offen offset:0 lds
v_mfma_f32_16x16x32_bf16 v[204:207],v[124:127],v[20:23],v[204:207]
buffer_load_dwordx4 v7,s[4:7],s25 offen offset:1024 lds
v_mfma_f32_16x16x32_bf16 v[200:203],v[120:123],v[20:23],v[200:203]
buffer_load_dwordx4 v8,s[4:7],s25 offen offset:2048 lds
ds_read_b64_tr_b16 v[132:133],v3 offset:0
ds_read_b64_tr_b16 v[134:135],v3 offset:6144
ds_read_b64_tr_b16 v[136:137],v4 offset:0
ds_read_b64_tr_b16 v[138:139],v4 offset:6144
ds_read_b64_tr_b16 v[140:141],v5 offset:0
ds_read_b64_tr_b16 v[142:143],v5 offset:6144
v_exp_f32 v92,v92
v_exp_f32 v93,v93
v_exp_f32 v94,v94
v_exp_f32 v95,v95
v_exp_f32 v100,v100
v_exp_f32 v101,v101
v_exp_f32 v102,v102
v_exp_f32 v103,v103
v_cvt_pk_bf16_f32 v49,v82,v83
v_cvt_pk_bf16_f32 v52,v88,v89
v_cvt_pk_bf16_f32 v53,v90,v91
v_cvt_pk_bf16_f32 v56,v96,v97
v_cvt_pk_bf16_f32 v57,v98,v99
v_cvt_pk_bf16_f32 v46,v76,v77
v_cvt_pk_bf16_f32 v47,v78,v79
v_cvt_pk_bf16_f32 v50,v84,v85
v_cvt_pk_bf16_f32 v51,v86,v87
v_cvt_pk_bf16_f32 v54,v92,v93
v_cvt_pk_bf16_f32 v55,v94,v95
v_smfmac_f32_16x16x64_bf16 v[60:63],v[152:155],v[44:51],v18
v_cvt_pk_bf16_f32 v58,v100,v101
v_cvt_pk_bf16_f32 v59,v102,v103
v_subrev_u32 v10,18432,v10
s_nop 0
v_smfmac_f32_16x16x64_bf16 v[64:67],v[152:155],v[52:59],v18
s_waitcnt lgkmcnt(0)
v_mfma_f32_16x16x32_bf16 v[160:163],v[128:131],v[44:47],v[160:163]
s_add_u32 s87,s42,18432
ds_read_b64_tr_b16 v[112:113],v2 offset:128
v_mbcnt_lo_u32_b32 v39,-1,0
v_mfma_f32_16x16x32_bf16 v[164:167],v[132:135],v[44:47],v[164:167]
ds_read_b64_tr_b16 v[114:115],v2 offset:6272
v_mbcnt_hi_u32_b32 v39,-1,v39
v_mfma_f32_16x16x32_bf16 v[212:215],v[132:135],v[48:51],v[212:215]
ds_read_b64_tr_b16 v[116:117],v3 offset:128
v_and_b32 v38,7,v39
v_mfma_f32_16x16x32_bf16 v[208:211],v[128:131],v[48:51],v[208:211]
ds_read_b64_tr_b16 v[118:119],v3 offset:6272
v_add_f32 v60,v60,v61
v_mfma_f32_16x16x32_bf16 a[0:3],v[128:131],v[52:55],a[0:3]
ds_read_b64_tr_b16 v[120:121],v4 offset:128
v_add_f32 v62,v62,v63
v_mfma_f32_16x16x32_bf16 a[4:7],v[132:135],v[52:55],a[4:7]
ds_read_b64_tr_b16 v[122:123],v4 offset:6272
ds_read_b64_tr_b16 v[124:125],v5 offset:128
ds_read_b64_tr_b16 v[126:127],v5 offset:6272
v_mfma_f32_16x16x32_bf16 a[52:55],v[132:135],v[56:59],a[52:55]
ds_read_b64_tr_b16 v[132:133],v3 offset:256
v_add_f32 v64,v64,v65
v_mfma_f32_16x16x32_bf16 a[48:51],v[128:131],v[56:59],a[48:51]
ds_read_b64_tr_b16 v[128:129],v2 offset:256
v_add_f32 v66,v66,v67
v_mfma_f32_16x16x32_bf16 a[56:59],v[136:139],v[56:59],a[56:59]
ds_read_b64_tr_b16 v[130:131],v2 offset:6400
v_max3_f32 v19,v60,v62,v64
v_mfma_f32_16x16x32_bf16 a[60:63],v[140:143],v[56:59],a[60:63]
ds_read_b64_tr_b16 v[134:135],v3 offset:6400
v_max_f32 v19,v19,v66
v_mfma_f32_16x16x32_bf16 a[12:15],v[140:143],v[52:55],a[12:15]
v_rcp_f32 v66,v66
v_mfma_f32_16x16x32_bf16 a[8:11],v[136:139],v[52:55],a[8:11]
v_accvgpr_read_b32 v80,a52
v_accvgpr_read_b32 v81,a53
v_mfma_f32_16x16x32_bf16 v[216:219],v[136:139],v[48:51],v[216:219]
v_accvgpr_read_b32 v82,a54
v_accvgpr_read_b32 v83,a55
v_mfma_f32_16x16x32_bf16 v[220:223],v[140:143],v[48:51],v[220:223]
v_accvgpr_read_b32 v72,a48
v_accvgpr_read_b32 v73,a49
v_mfma_f32_16x16x32_bf16 v[172:175],v[140:143],v[44:47],v[172:175]
ds_read_b64_tr_b16 v[140:141],v5 offset:256
v_accvgpr_read_b32 v74,a50
v_mfma_f32_16x16x32_bf16 v[168:171],v[136:139],v[44:47],v[168:171]
s_waitcnt lgkmcnt(2)
ds_read_b64_tr_b16 v[136:137],v4 offset:256
v_accvgpr_read_b32 v75,a51
v_mfma_f32_16x16x32_bf16 v[176:179],v[112:115],v[44:47],v[176:179]
ds_read_b64_tr_b16 v[138:139],v4 offset:6400
v_accvgpr_read_b32 v88,a56
v_mfma_f32_16x16x32_bf16 v[180:183],v[116:119],v[44:47],v[180:183]
ds_read_b64_tr_b16 v[142:143],v5 offset:6400
v_accvgpr_read_b32 v89,a57
v_mfma_f32_16x16x32_bf16 v[228:231],v[116:119],v[48:51],v[228:231]
v_accvgpr_read_b32 v90,a58
v_accvgpr_read_b32 v91,a59
v_mfma_f32_16x16x32_bf16 v[224:227],v[112:115],v[48:51],v[224:227]
v_accvgpr_read_b32 v96,a60
v_accvgpr_read_b32 v97,a61
v_mfma_f32_16x16x32_bf16 a[16:19],v[112:115],v[52:55],a[16:19]
v_accvgpr_read_b32 v98,a62
v_accvgpr_read_b32 v99,a63
v_mfma_f32_16x16x32_bf16 a[20:23],v[116:119],v[52:55],a[20:23]
v_cmp_ngt_f32 vcc,s37,v19
v_lshrrev_b32 v19,5,v39
v_mfma_f32_16x16x32_bf16 a[68:71],v[116:119],v[56:59],a[68:71]
v_xor_b32 v38,v38,v19
v_and_b32 v19,15,v39
v_mfma_f32_16x16x32_bf16 a[64:67],v[112:115],v[56:59],a[64:67]
s_cmp_lg_u64 vcc,0
v_lshl_add_u32 v19,v19,7,s24
v_lshl_add_u32 v19,v38,4,v19
v_mfma_f32_16x16x32_bf16 a[72:75],v[120:123],v[56:59],a[72:75]
s_cselect_b32 s62,s32,0
v_bfe_u32 v38,v39,4,1
v_lshl_add_u32 v36,v38,3,v19
v_mfma_f32_16x16x32_bf16 a[76:79],v[124:127],v[56:59],a[76:79]
s_or_b32 s31,s31,s62
v_xor_b32 v37,32,v36
v_bfe_u32 v19,v39,3,1
v_mfma_f32_16x16x32_bf16 a[28:31],v[124:127],v[52:55],a[28:31]
s_lshl_b32 s32,s32,1
v_xor_b32 v38,64,v36
v_xor_b32 v39,96,v36
v_lshlrev_b32 v19,11,v19
v_accvgpr_read_b32 v84,a68
v_accvgpr_read_b32 v85,a69
v_pk_mul_f32 v[72:73],v[72:73],v[66:67] op_sel_hi:[1,0]
v_pk_mul_f32 v[74:75],v[74:75],v[66:67] op_sel_hi:[1,0]
v_pk_mul_f32 v[80:81],v[80:81],v[66:67] op_sel_hi:[1,0]
v_pk_mul_f32 v[82:83],v[82:83],v[66:67] op_sel_hi:[1,0]
v_pk_mul_f32 v[84:85],v[84:85],v[66:67] op_sel_hi:[1,0]
v_accvgpr_read_b32 v86,a70
v_accvgpr_read_b32 v87,a71
v_pk_mul_f32 v[86:87],v[86:87],v[66:67] op_sel_hi:[1,0]
v_accvgpr_read_b32 v76,a64
v_accvgpr_read_b32 v77,a65
v_pk_mul_f32 v[76:77],v[76:77],v[66:67] op_sel_hi:[1,0]
v_accvgpr_read_b32 v78,a66
v_accvgpr_read_b32 v79,a67
v_pk_mul_f32 v[78:79],v[78:79],v[66:67] op_sel_hi:[1,0]
v_accvgpr_read_b32 v92,a72
v_accvgpr_read_b32 v93,a73
v_mfma_f32_16x16x32_bf16 a[24:27],v[120:123],v[52:55],a[24:27]
s_add_u32 m0,s23,0
v_accvgpr_read_b32 v94,a74
v_accvgpr_read_b32 v95,a75
v_accvgpr_read_b32 v100,a76
v_accvgpr_read_b32 v101,a77
v_accvgpr_read_b32 v102,a78
v_pk_mul_f32 v[88:89],v[88:89],v[66:67] op_sel_hi:[1,0]
v_pk_mul_f32 v[90:91],v[90:91],v[66:67] op_sel_hi:[1,0]
v_pk_mul_f32 v[92:93],v[92:93],v[66:67] op_sel_hi:[1,0]
v_pk_mul_f32 v[94:95],v[94:95],v[66:67] op_sel_hi:[1,0]
v_accvgpr_read_b32 v103,a79
v_cvt_pk_bf16_f32 v72,v72,v73
v_mfma_f32_16x16x32_bf16 v[232:235],v[120:123],v[48:51],v[232:235]
v_cvt_pk_bf16_f32 v76,v76,v77
v_cvt_pk_bf16_f32 v80,v80,v81
v_cvt_pk_bf16_f32 v84,v84,v85
v_cvt_pk_bf16_f32 v73,v74,v75
v_cvt_pk_bf16_f32 v77,v78,v79
ds_write2st64_b64 v36,v[72:73],v[76:77] offset0:36 offset1:40
v_pk_mul_f32 v[96:97],v[96:97],v[66:67] op_sel_hi:[1,0]
v_pk_mul_f32 v[98:99],v[98:99],v[66:67] op_sel_hi:[1,0]
v_pk_mul_f32 v[100:101],v[100:101],v[66:67] op_sel_hi:[1,0]
v_pk_mul_f32 v[102:103],v[102:103],v[66:67] op_sel_hi:[1,0]
v_cvt_pk_bf16_f32 v88,v88,v89
v_cvt_pk_bf16_f32 v92,v92,v93
v_mfma_f32_16x16x32_bf16 v[236:239],v[124:127],v[48:51],v[236:239]
v_cvt_pk_bf16_f32 v81,v82,v83
v_cvt_pk_bf16_f32 v85,v86,v87
v_mfma_f32_16x16x32_bf16 v[188:191],v[124:127],v[44:47],v[188:191]
v_cvt_pk_bf16_f32 v96,v96,v97
v_cvt_pk_bf16_f32 v100,v100,v101
v_mfma_f32_16x16x32_bf16 v[184:187],v[120:123],v[44:47],v[184:187]
ds_write2st64_b64 v37,v[80:81],v[84:85] offset0:36 offset1:40
v_mfma_f32_16x16x32_bf16 v[192:195],v[128:131],v[44:47],v[192:195]
s_waitcnt lgkmcnt(1)
v_cvt_pk_bf16_f32 v89,v90,v91
v_cvt_pk_bf16_f32 v93,v94,v95
v_mfma_f32_16x16x32_bf16 v[196:199],v[132:135],v[44:47],v[196:199]
v_cvt_pk_bf16_f32 v97,v98,v99
v_cvt_pk_bf16_f32 v101,v102,v103
v_mfma_f32_16x16x32_bf16 v[244:247],v[132:135],v[48:51],v[244:247]
v_rcp_f32 v62,v62
v_mfma_f32_16x16x32_bf16 v[240:243],v[128:131],v[48:51],v[240:243]
ds_write2st64_b64 v38,v[88:89],v[92:93] offset0:36 offset1:40
v_mfma_f32_16x16x32_bf16 a[32:35],v[128:131],v[52:55],a[32:35]
v_rcp_f32 v64,v64
v_mfma_f32_16x16x32_bf16 a[36:39],v[132:135],v[52:55],a[36:39]
v_accvgpr_read_b32 v102,a2
v_accvgpr_read_b32 v103,a3
v_mfma_f32_16x16x32_bf16 a[84:87],v[132:135],v[56:59],a[84:87]
v_rcp_f32 v60,v60
v_mfma_f32_16x16x32_bf16 a[80:83],v[128:131],v[56:59],a[80:83]
ds_write2st64_b64 v39,v[96:97],v[100:101] offset0:36 offset1:40
v_mfma_f32_16x16x32_bf16 a[88:91],v[136:139],v[56:59],a[88:91]
v_accvgpr_read_b32 v100,a0
v_accvgpr_read_b32 v101,a1
v_mfma_f32_16x16x32_bf16 a[92:95],v[140:143],v[56:59],a[92:95]
ds_read_b128 v[156:159],v10 offset:18432
v_accvgpr_read_b32 v80,a84
v_mfma_f32_16x16x32_bf16 a[44:47],v[140:143],v[52:55],a[44:47]
s_waitcnt vmcnt(15)
ds_read_b128 a[192:195],v11 offset:12288
v_accvgpr_read_b32 v81,a85
ds_read_b128 a[196:199],v12 offset:12288
v_pk_mul_f32 v[80:81],v[80:81],v[66:67] op_sel_hi:[1,0]
ds_read_b128 a[200:203],v11 offset:12416
v_accvgpr_read_b32 v82,a86
ds_read_b128 a[204:207],v12 offset:12416
v_accvgpr_read_b32 v83,a87
ds_read_b128 a[208:211],v11 offset:12544
v_pk_mul_f32 v[82:83],v[82:83],v[66:67] op_sel_hi:[1,0]
ds_read_b128 a[212:215],v12 offset:12544
v_accvgpr_read_b32 v76,a80
ds_read_b128 v[104:107],v10 offset:19456
s_waitcnt lgkmcnt(7)
buffer_store_dwordx4 v[156:159],v9,s[16:19],s87 offen offset:0 nt
ds_read_b128 v[108:111],v10 offset:20480
v_accvgpr_read_b32 v77,a81
ds_read_b128 v[72:75],v10 offset:21504
v_pk_mul_f32 v[76:77],v[76:77],v[66:67] op_sel_hi:[1,0]
v_accvgpr_read_b32 v78,a82
v_accvgpr_read_b32 v79,a83
v_pk_mul_f32 v[78:79],v[78:79],v[66:67] op_sel_hi:[1,0]
v_accvgpr_read_b32 v84,a88
v_accvgpr_read_b32 v85,a89
v_mfma_f32_16x16x32_bf16 a[40:43],v[136:139],v[52:55],a[40:43]
v_accvgpr_read_b32 v86,a90
v_accvgpr_read_b32 v87,a91
v_accvgpr_read_b32 v88,a92
v_accvgpr_read_b32 v89,a93
v_accvgpr_read_b32 v90,a94
v_pk_mul_f32 v[84:85],v[84:85],v[66:67] op_sel_hi:[1,0]
v_pk_mul_f32 v[86:87],v[86:87],v[66:67] op_sel_hi:[1,0]
v_accvgpr_read_b32 v91,a95
v_cvt_pk_bf16_f32 v76,v76,v77
v_mfma_f32_16x16x32_bf16 v[248:251],v[136:139],v[48:51],v[248:251]
s_waitcnt lgkmcnt(1)
v_cvt_pk_bf16_f32 v77,v78,v79
ds_write_b64 v36,v[76:77] offset:18432
buffer_store_dwordx4 v[104:107],v9,s[16:19],s87 offen offset:3072 nt
v_pk_mul_f32 v[88:89],v[88:89],v[66:67] op_sel_hi:[1,0]
v_pk_mul_f32 v[90:91],v[90:91],v[66:67] op_sel_hi:[1,0]
v_pk_mul_f32 v[208:209],v[208:209],v[62:63] op_sel_hi:[1,0]
v_pk_mul_f32 v[210:211],v[210:211],v[62:63] op_sel_hi:[1,0]
v_pk_mul_f32 v[224:225],v[224:225],v[62:63] op_sel_hi:[1,0]
v_pk_mul_f32 v[226:227],v[226:227],v[62:63] op_sel_hi:[1,0]
v_pk_mul_f32 v[212:213],v[212:213],v[62:63] op_sel_hi:[1,0]
v_pk_mul_f32 v[214:215],v[214:215],v[62:63] op_sel_hi:[1,0]
v_pk_mul_f32 v[228:229],v[228:229],v[62:63] op_sel_hi:[1,0]
v_pk_mul_f32 v[230:231],v[230:231],v[62:63] op_sel_hi:[1,0]
v_pk_mul_f32 v[216:217],v[216:217],v[62:63] op_sel_hi:[1,0]
buffer_store_dwordx4 v[108:111],v9,s[16:19],s87 offen offset:128 nt
v_pk_mul_f32 v[218:219],v[218:219],v[62:63] op_sel_hi:[1,0]
v_pk_mul_f32 v[232:233],v[232:233],v[62:63] op_sel_hi:[1,0]
v_pk_mul_f32 v[234:235],v[234:235],v[62:63] op_sel_hi:[1,0]
v_pk_mul_f32 v[220:221],v[220:221],v[62:63] op_sel_hi:[1,0]
v_pk_mul_f32 v[222:223],v[222:223],v[62:63] op_sel_hi:[1,0]
v_pk_mul_f32 v[236:237],v[236:237],v[62:63] op_sel_hi:[1,0]
v_pk_mul_f32 v[238:239],v[238:239],v[62:63] op_sel_hi:[1,0]
v_add_u32 v36,v36,v19
v_accvgpr_read_b32 v78,a6
v_mfma_f32_16x16x32_bf16 v[252:255],v[140:143],v[48:51],v[252:255]
v_accvgpr_read_b32 v79,a7
v_accvgpr_read_b32 v76,a4
v_mfma_f32_16x16x32_bf16 v[204:207],v[140:143],v[44:47],v[204:207]
s_waitcnt lgkmcnt(0)
buffer_store_dwordx4 v[72:75],v9,s[16:19],s87 offen offset:3200 nt
v_accvgpr_read_b32 v77,a5
v_cvt_pk_bf16_f32 v80,v80,v81
v_accvgpr_read_b32 v104,a8
v_pk_mul_f32 v[240:241],v[240:241],v[62:63] op_sel_hi:[1,0]
v_pk_mul_f32 v[242:243],v[242:243],v[62:63] op_sel_hi:[1,0]
s_waitcnt vmcnt(4)
s_barrier
ds_read_b128 v[112:115],v0 offset:0
v_pk_mul_f32 v[100:101],v[100:101],v[64:65] op_sel_hi:[1,0]
ds_read_b128 v[116:119],v1 offset:0
v_pk_mul_f32 v[102:103],v[102:103],v[64:65] op_sel_hi:[1,0]
v_accvgpr_read_b32 v105,a9
v_accvgpr_read_b32 v106,a10
v_mfma_f32_16x16x32_bf16 v[200:203],v[136:139],v[44:47],v[200:203]
ds_read_b128 v[120:123],v0 offset:128
v_accvgpr_read_b32 v107,a11
ds_read_b128 v[124:127],v1 offset:128
v_cvt_pk_bf16_f32 v81,v82,v83
ds_write_b64 v37,v[80:81] offset:18432
buffer_load_dwordx4 v6,s[8:11],s25 offen offset:0 lds
ds_read_b128 v[128:131],v0 offset:256
v_add_u32 v37,v37,v19
ds_read_b128 v[132:135],v1 offset:256
s_waitcnt lgkmcnt(6)
v_mfma_f32_16x16x32_bf16 v[72:75],v[112:115],a[144:147],0
s_waitcnt lgkmcnt(5)
v_cvt_pk_bf16_f32 v84,v84,v85
ds_read_b128 v[136:139],v0 offset:6144
v_mfma_f32_16x16x32_bf16 v[72:75],v[116:119],a[148:151],v[72:75]
v_cvt_pk_bf16_f32 v88,v88,v89
ds_read_b128 v[140:143],v1 offset:6144
v_cvt_pk_bf16_f32 v85,v86,v87
ds_write_b64 v38,v[84:85] offset:18432
v_pk_mul_f32 v[244:245],v[244:245],v[62:63] op_sel_hi:[1,0]
v_pk_mul_f32 v[246:247],v[246:247],v[62:63] op_sel_hi:[1,0]
v_pk_mul_f32 v[76:77],v[76:77],v[64:65] op_sel_hi:[1,0]
buffer_load_dwordx4 v7,s[8:11],s25 offen offset:1024 lds
v_pk_mul_f32 v[78:79],v[78:79],v[64:65] op_sel_hi:[1,0]
v_add_u32 v38,v38,v19
v_cvt_pk_bf16_f32 v89,v90,v91
s_waitcnt lgkmcnt(3)
v_mfma_f32_16x16x32_bf16 v[72:75],v[120:123],a[152:155],v[72:75]
ds_write_b64 v39,v[88:89] offset:18432
v_mfma_f32_16x16x32_bf16 v[72:75],v[124:127],a[156:159],v[72:75]
ds_read_b128 v[92:95],v10 offset:18432
v_add_u32 v39,v39,v19
v_mfma_f32_16x16x32_bf16 v[72:75],v[128:131],a[160:163],v[72:75]
ds_read_b128 v[96:99],v10 offset:19456
v_accvgpr_read_b32 v108,a12
v_mfma_f32_16x16x32_bf16 v[72:75],v[132:135],a[164:167],v[72:75]
v_accvgpr_read_b32 v109,a13
v_accvgpr_read_b32 v110,a14
v_accvgpr_read_b32 v111,a15
v_cvt_pk_bf16_f32 v208,v208,v209
v_cvt_pk_bf16_f32 v224,v224,v225
v_pk_mul_f32 v[248:249],v[248:249],v[62:63] op_sel_hi:[1,0]
v_pk_mul_f32 v[250:251],v[250:251],v[62:63] op_sel_hi:[1,0]
v_pk_mul_f32 v[104:105],v[104:105],v[64:65] op_sel_hi:[1,0]
v_pk_mul_f32 v[106:107],v[106:107],v[64:65] op_sel_hi:[1,0]
v_cvt_pk_bf16_f32 v209,v210,v211
v_cvt_pk_bf16_f32 v225,v226,v227
v_mfma_f32_16x16x32_bf16 v[80:83],v[132:135],a[188:191],0
buffer_load_dwordx4 v8,s[8:11],s25 offen offset:2048 lds
v_mfma_f32_16x16x32_bf16 v[80:83],v[128:131],a[184:187],v[80:83]
s_add_u32 m0,s23,24576
ds_write2st64_b64 v36,v[208:209],v[224:225] offset0:12 offset1:14
v_mfma_f32_16x16x32_bf16 v[80:83],v[124:127],a[180:183],v[80:83]
s_waitcnt lgkmcnt(1)
v_accvgpr_read_b32 v86,a18
buffer_store_dwordx4 v[92:95],v9,s[16:19],s87 offen offset:256 nt
v_pk_mul_f32 v[252:253],v[252:253],v[62:63] op_sel_hi:[1,0]
v_pk_mul_f32 v[254:255],v[254:255],v[62:63] op_sel_hi:[1,0]
v_pk_mul_f32 v[108:109],v[108:109],v[64:65] op_sel_hi:[1,0]
v_pk_mul_f32 v[110:111],v[110:111],v[64:65] op_sel_hi:[1,0]
v_accvgpr_read_b32 v87,a19
v_accvgpr_read_b32 v84,a16
v_mfma_f32_16x16x32_bf16 v[80:83],v[120:123],a[176:179],v[80:83]
v_accvgpr_read_b32 v85,a17
v_accvgpr_read_b32 v210,a34
v_mfma_f32_16x16x32_bf16 v[80:83],v[116:119],a[172:175],v[80:83]
v_accvgpr_read_b32 v211,a35
v_accvgpr_read_b32 v208,a32
v_mfma_f32_16x16x32_bf16 v[80:83],v[112:115],a[168:171],v[80:83]
s_waitcnt vmcnt(11)
buffer_load_dwordx4 v6,s[8:11],s21 offen offset:0 lds
ds_read_b128 a[216:219],v11 offset:0
buffer_store_dwordx4 v[96:99],v9,s[16:19],s87 offen offset:3328 nt
ds_read_b128 a[220:223],v12 offset:0
v_pk_mul_f32 v[84:85],v[84:85],v[64:65] op_sel_hi:[1,0]
ds_read_b128 a[224:227],v11 offset:128
v_pk_mul_f32 v[86:87],v[86:87],v[64:65] op_sel_hi:[1,0]
ds_read_b128 a[228:231],v12 offset:128
v_pk_mul_f32 v[210:211],v[210:211],v[64:65] op_sel_hi:[1,0]
ds_read_b128 a[232:235],v11 offset:256
v_accvgpr_read_b32 v209,a33
ds_read_b128 a[236:239],v12 offset:256
v_pk_mul_f32 v[208:209],v[208:209],v[64:65] op_sel_hi:[1,0]
v_accvgpr_read_b32 v226,a22
v_accvgpr_read_b32 v227,a23
v_mfma_f32_16x16x32_bf16 v[88:91],v[112:115],a[192:195],0
ds_read_b128 v[112:115],v0 offset:6272
v_accvgpr_read_b32 v224,a20
v_mfma_f32_16x16x32_bf16 v[88:91],v[116:119],a[196:199],v[88:91]
ds_read_b128 v[116:119],v1 offset:6272
v_accvgpr_read_b32 v225,a21
v_mfma_f32_16x16x32_bf16 v[88:91],v[120:123],a[200:203],v[88:91]
ds_read_b128 v[120:123],v0 offset:6400
v_accvgpr_read_b32 v92,a36
v_accvgpr_read_b32 v93,a37
v_accvgpr_read_b32 v94,a38
v_accvgpr_read_b32 v95,a39
v_pk_mul_f32 v[224:225],v[224:225],v[64:65] op_sel_hi:[1,0]
v_pk_mul_f32 v[226:227],v[226:227],v[64:65] op_sel_hi:[1,0]
v_pk_mul_f32 v[92:93],v[92:93],v[64:65] op_sel_hi:[1,0]
v_pk_mul_f32 v[94:95],v[94:95],v[64:65] op_sel_hi:[1,0]
v_cvt_pk_bf16_f32 v212,v212,v213
v_cvt_pk_bf16_f32 v228,v228,v229
v_mfma_f32_16x16x32_bf16 v[88:91],v[124:127],a[204:207],v[88:91]
buffer_load_dwordx4 v7,s[8:11],s21 offen offset:1024 lds
v_mfma_f32_16x16x32_bf16 v[88:91],v[128:131],a[208:211],v[88:91]
ds_read_b128 v[124:127],v1 offset:6400
v_cvt_pk_bf16_f32 v216,v216,v217
v_mfma_f32_16x16x32_bf16 v[88:91],v[132:135],a[212:215],v[88:91]
ds_read_b128 v[128:131],v0 offset:0
v_cvt_pk_bf16_f32 v232,v232,v233
ds_read_b128 v[132:135],v1 offset:0
v_cvt_pk_bf16_f32 v213,v214,v215
v_cvt_pk_bf16_f32 v229,v230,v231
ds_write2st64_b64 v37,v[212:213],v[228:229] offset0:12 offset1:14
v_cvt_pk_bf16_f32 v220,v220,v221
v_cvt_pk_bf16_f32 v236,v236,v237
v_cvt_pk_bf16_f32 v217,v218,v219
v_cvt_pk_bf16_f32 v233,v234,v235
v_cvt_pk_bf16_f32 v240,v240,v241
v_cvt_pk_bf16_f32 v100,v100,v101
v_cvt_pk_bf16_f32 v221,v222,v223
v_cvt_pk_bf16_f32 v237,v238,v239
v_cvt_pk_bf16_f32 v244,v244,v245
v_cvt_pk_bf16_f32 v76,v76,v77
v_cvt_pk_bf16_f32 v241,v242,v243
ds_write2st64_b64 v38,v[216:217],v[232:233] offset0:12 offset1:14
v_cvt_pk_bf16_f32 v101,v102,v103
v_cvt_pk_bf16_f32 v245,v246,v247
v_cvt_pk_bf16_f32 v77,v78,v79
v_accvgpr_read_b32 v96,a24
v_accvgpr_read_b32 v97,a25
v_accvgpr_read_b32 v98,a26
buffer_load_dwordx4 v8,s[8:11],s21 offen offset:2048 lds
ds_write2st64_b64 v39,v[220:221],v[236:237] offset0:12 offset1:14
v_accvgpr_read_b32 v99,a27
v_accvgpr_read_b32 v214,a42
v_accvgpr_read_b32 v215,a43
v_accvgpr_read_b32 v212,a40
v_accvgpr_read_b32 v213,a41
v_accvgpr_read_b32 v230,a30
v_accvgpr_read_b32 v231,a31
v_accvgpr_read_b32 v228,a28
v_accvgpr_read_b32 v229,a29
v_accvgpr_read_b32 v218,a46
v_accvgpr_read_b32 v219,a47
ds_write2st64_b64 v36,v[240:241],v[100:101] offset0:16 offset1:24
v_accvgpr_read_b32 v216,a44
v_accvgpr_read_b32 v217,a45
v_cvt_pk_bf16_f32 v248,v248,v249
v_cvt_pk_bf16_f32 v104,v104,v105
v_cvt_pk_bf16_f32 v252,v252,v253
v_cvt_pk_bf16_f32 v108,v108,v109
v_cvt_pk_bf16_f32 v249,v250,v251
v_cvt_pk_bf16_f32 v105,v106,v107
v_cvt_pk_bf16_f32 v84,v84,v85
v_cvt_pk_bf16_f32 v208,v208,v209
v_cvt_pk_bf16_f32 v253,v254,v255
ds_write2st64_b64 v37,v[244:245],v[76:77] offset0:16 offset1:24
v_mfma_f32_16x16x32_bf16 v[76:79],v[136:139],a[144:147],0
s_add_u32 s21,s21,12288
v_cvt_pk_bf16_f32 v109,v110,v111
v_cvt_pk_bf16_f32 v85,v86,v87
v_cvt_pk_bf16_f32 v209,v210,v211
v_cvt_pk_bf16_f32 v224,v224,v225
v_cvt_pk_bf16_f32 v92,v92,v93
v_pk_mul_f32 v[96:97],v[96:97],v[64:65] op_sel_hi:[1,0]
v_pk_mul_f32 v[98:99],v[98:99],v[64:65] op_sel_hi:[1,0]
v_pk_mul_f32 v[212:213],v[212:213],v[64:65] op_sel_hi:[1,0]
v_pk_mul_f32 v[214:215],v[214:215],v[64:65] op_sel_hi:[1,0]
v_cvt_pk_bf16_f32 v225,v226,v227
v_cvt_pk_bf16_f32 v93,v94,v95
v_mfma_f32_16x16x32_bf16 v[76:79],v[140:143],a[148:151],v[76:79]
s_mov_b32 s27,s42
ds_write2st64_b64 v38,v[248:249],v[104:105] offset0:16 offset1:24
s_waitcnt lgkmcnt(2)
v_mfma_f32_16x16x32_bf16 v[76:79],v[112:115],a[152:155],v[76:79]
s_mov_b32 s42,s41
v_cvt_pk_bf16_f32 v96,v96,v97
v_cvt_pk_bf16_f32 v212,v212,v213
v_mfma_f32_16x16x32_bf16 v[76:79],v[116:119],a[156:159],v[76:79]
s_add_u32 s69,s69,1
v_cvt_pk_bf16_f32 v97,v98,v99
v_cvt_pk_bf16_f32 v213,v214,v215
v_max3_f32 v44,v72,v73,v74
v_max3_f32 v48,v80,v81,v82
v_max3_f32 v52,v88,v89,v90
ds_write2st64_b64 v39,v[252:253],v[108:109] offset0:16 offset1:24
v_pk_mul_f32 v[228:229],v[228:229],v[64:65] op_sel_hi:[1,0]
v_pk_mul_f32 v[230:231],v[230:231],v[64:65] op_sel_hi:[1,0]
v_pk_mul_f32 v[216:217],v[216:217],v[64:65] op_sel_hi:[1,0]
v_pk_mul_f32 v[218:219],v[218:219],v[64:65] op_sel_hi:[1,0]
v_cvt_pk_bf16_f32 v228,v228,v229
v_cvt_pk_bf16_f32 v216,v216,v217
v_mfma_f32_16x16x32_bf16 v[76:79],v[120:123],a[160:163],v[76:79]
s_lshl_b32 s62,s69,5
v_cvt_pk_bf16_f32 v229,v230,v231
v_cvt_pk_bf16_f32 v217,v218,v219
v_mfma_f32_16x16x32_bf16 v[76:79],v[124:127],a[164:167],v[76:79]
s_add_u32 s62,s62,s34
ds_write2st64_b64 v36,v[84:85],v[208:209] offset0:26 offset1:28
v_mfma_f32_16x16x32_bf16 v[84:87],v[124:127],a[188:191],0
s_mul_i32 s63,s62,171
v_mov_b32 v66,0
v_mov_b32 v67,0
v_mov_b32 v62,0
v_mov_b32 v63,0
v_max3_f32 v44,v44,v75,v76
v_pk_mul_f32 v[160:161],v[160:161],v[60:61] op_sel_hi:[1,0]
v_pk_mul_f32 v[162:163],v[162:163],v[60:61] op_sel_hi:[1,0]
v_pk_mul_f32 v[176:177],v[176:177],v[60:61] op_sel_hi:[1,0]
v_pk_mul_f32 v[178:179],v[178:179],v[60:61] op_sel_hi:[1,0]
v_max3_f32 v44,v44,v77,v78
v_max_f32 v44,v44,v79
v_mfma_f32_16x16x32_bf16 v[84:87],v[120:123],a[184:187],v[84:87]
s_lshr_b32 s63,s63,9
ds_write2st64_b64 v37,v[224:225],v[92:93] offset0:26 offset1:28
v_mfma_f32_16x16x32_bf16 v[84:87],v[116:119],a[180:183],v[84:87]
s_mul_i32 s64,s63,3
v_mov_b32 v45,v44
v_cvt_pk_bf16_f32 v160,v160,v161
v_mfma_f32_16x16x32_bf16 v[84:87],v[112:115],a[176:179],v[84:87]
s_sub_u32 s62,s62,s64
v_permlane32_swap_b32 v45,v44
v_max_f32 v44,v44,v45
v_mov_b32 v45,v44
v_cvt_pk_bf16_f32 v176,v176,v177
ds_write2st64_b64 v38,v[96:97],v[212:213] offset0:26 offset1:28
v_pk_mul_f32 v[164:165],v[164:165],v[60:61] op_sel_hi:[1,0]
v_pk_mul_f32 v[166:167],v[166:167],v[60:61] op_sel_hi:[1,0]
v_pk_mul_f32 v[180:181],v[180:181],v[60:61] op_sel_hi:[1,0]
v_pk_mul_f32 v[182:183],v[182:183],v[60:61] op_sel_hi:[1,0]
v_permlane16_swap_b32 v45,v44
v_max_f32 v44,v44,v45
v_mfma_f32_16x16x32_bf16 v[84:87],v[140:143],a[172:175],v[84:87]
s_add_u32 s63,s63,s33
v_mul_f32_e64 v13,-s36,v44
v_fma_f32 v72,v72,s36,v13
v_mfma_f32_16x16x32_bf16 v[84:87],v[136:139],a[168:171],v[84:87]
s_mul_i32 s30,s63,196608
ds_write2st64_b64 v39,v[228:229],v[216:217] offset0:26 offset1:28
v_mfma_f32_16x16x32_bf16 v[92:95],v[136:139],a[192:195],0
s_mul_i32 s41,s63,325632
v_fma_f32 v73,v73,s36,v13
v_fma_f32 v74,v74,s36,v13
v_mfma_f32_16x16x32_bf16 v[92:95],v[140:143],a[196:199],v[92:95]
s_lshl_b32 s63,s3,2
ds_read_b128 v[136:139],v0 offset:128
v_fma_f32 v75,v75,s36,v13
ds_read_b128 v[140:143],v1 offset:128
v_pk_mul_f32 v[168:169],v[168:169],v[60:61] op_sel_hi:[1,0]
v_pk_mul_f32 v[170:171],v[170:171],v[60:61] op_sel_hi:[1,0]
v_pk_mul_f32 v[184:185],v[184:185],v[60:61] op_sel_hi:[1,0]
v_pk_mul_f32 v[186:187],v[186:187],v[60:61] op_sel_hi:[1,0]
v_exp_f32 v72,v72
v_exp_f32 v73,v73
v_mfma_f32_16x16x32_bf16 v[92:95],v[112:115],a[200:203],v[92:95]
s_add_u32 s64,s63,21
ds_read_b128 v[112:115],v0 offset:256
v_exp_f32 v74,v74
v_mfma_f32_16x16x32_bf16 v[92:95],v[116:119],a[204:207],v[92:95]
s_cmp_eq_u32 s3,0
ds_read_b128 v[116:119],v1 offset:256
v_exp_f32 v75,v75
v_mfma_f32_16x16x32_bf16 v[92:95],v[120:123],a[208:211],v[92:95]
s_cselect_b32 s64,20,s64
ds_read_b128 v[120:123],v0 offset:6144
v_cvt_pk_bf16_f32 v20,v72,v73
v_cvt_pk_bf16_f32 v21,v74,v75
v_max3_f32 v48,v48,v83,v84
v_max3_f32 v48,v48,v85,v86
v_pk_mul_f32 v[172:173],v[172:173],v[60:61] op_sel_hi:[1,0]
v_pk_mul_f32 v[174:175],v[174:175],v[60:61] op_sel_hi:[1,0]
v_pk_mul_f32 v[188:189],v[188:189],v[60:61] op_sel_hi:[1,0]
v_pk_mul_f32 v[190:191],v[190:191],v[60:61] op_sel_hi:[1,0]
v_max_f32 v48,v48,v87
v_mov_b32 v49,v48
v_mfma_f32_16x16x32_bf16 v[92:95],v[124:127],a[212:215],v[92:95]
s_cselect_b32 s40,1,0
ds_read_b128 v[124:127],v1 offset:6144
v_permlane32_swap_b32 v49,v48
v_mfma_f32_16x16x32_bf16 v[96:99],v[128:131],a[216:219],0
s_add_u32 s65,s63,37
ds_read_b128 v[128:131],v0 offset:6272
v_max_f32 v48,v48,v49
v_mfma_f32_16x16x32_bf16 v[96:99],v[132:135],a[220:223],v[96:99]
s_cmp_eq_u32 s62,2
ds_read_b128 v[132:135],v1 offset:6272
v_mov_b32 v49,v48
v_max3_f32 v52,v52,v91,v92
v_max3_f32 v52,v52,v93,v94
v_permlane16_swap_b32 v49,v48
v_pk_mul_f32 v[192:193],v[192:193],v[60:61] op_sel_hi:[1,0]
v_pk_mul_f32 v[194:195],v[194:195],v[60:61] op_sel_hi:[1,0]
v_max_f32 v48,v48,v49
v_mul_f32_e64 v14,-s36,v48
s_waitcnt lgkmcnt(3)
v_mfma_f32_16x16x32_bf16 v[96:99],v[136:139],a[224:227],v[96:99]
s_cselect_b32 s64,s65,s64
ds_read_b128 v[136:139],v0 offset:6400
v_fma_f32 v80,v80,s36,v14
v_mfma_f32_16x16x32_bf16 v[96:99],v[140:143],a[228:231],v[96:99]
s_cselect_b32 s40,0,s40
ds_read_b128 v[140:143],v1 offset:6400
v_fma_f32 v81,v81,s36,v14
v_mfma_f32_16x16x32_bf16 v[96:99],v[112:115],a[232:235],v[96:99]
s_add_u32 s65,s63,s3
ds_read_b128 v[112:115],v0 offset:12544
v_fma_f32 v82,v82,s36,v14
v_fma_f32 v83,v83,s36,v14
v_exp_f32 v80,v80
v_pk_mul_f32 v[196:197],v[196:197],v[60:61] op_sel_hi:[1,0]
v_pk_mul_f32 v[198:199],v[198:199],v[60:61] op_sel_hi:[1,0]
v_exp_f32 v81,v81
v_exp_f32 v82,v82
v_mfma_f32_16x16x32_bf16 v[96:99],v[116:119],a[236:239],v[96:99]
s_cmp_eq_u32 s62,0
ds_read_b128 v[116:119],v1 offset:12544
v_exp_f32 v83,v83
v_mfma_f32_16x16x32_bf16 v[100:103],v[120:123],a[216:219],0
s_cselect_b32 s64,s65,s64
ds_read_b128 v[120:123],v0 offset:18432
v_cvt_pk_bf16_f32 v24,v80,v81
s_waitcnt lgkmcnt(5)
v_mfma_f32_16x16x32_bf16 v[100:103],v[124:127],a[220:223],v[100:103]
s_cselect_b32 s40,1,s40
ds_read_b128 v[124:127],v1 offset:18432
v_cvt_pk_bf16_f32 v25,v82,v83
v_mfma_f32_16x16x32_bf16 v[100:103],v[128:131],a[224:227],v[100:103]
s_mul_i32 s64,s64,6144
ds_read_b128 v[128:131],v0 offset:12288
v_max_f32 v52,v52,v95
v_mov_b32 v53,v52
v_max3_f32 v56,v96,v97,v98
v_fma_f32 v76,v76,s36,v13
v_pk_mul_f32 v[200:201],v[200:201],v[60:61] op_sel_hi:[1,0]
v_pk_mul_f32 v[202:203],v[202:203],v[60:61] op_sel_hi:[1,0]
v_permlane32_swap_b32 v53,v52
v_max_f32 v52,v52,v53
v_mfma_f32_16x16x32_bf16 v[100:103],v[132:135],a[228:231],v[100:103]
s_add_u32 s41,s41,s64
ds_read_b128 v[132:135],v1 offset:12288
v_mov_b32 v53,v52
s_waitcnt lgkmcnt(5)
v_mfma_f32_16x16x32_bf16 v[100:103],v[136:139],a[232:235],v[100:103]
s_cmp_ge_u32 s69,6
ds_read_b128 v[136:139],v0 offset:12416
v_permlane16_swap_b32 v53,v52
v_mfma_f32_16x16x32_bf16 v[100:103],v[140:143],a[236:239],v[100:103]
s_cselect_b32 s41,166723584,s41
ds_read_b128 v[140:143],v1 offset:12416
v_max_f32 v52,v52,v53
v_mul_f32_e64 v15,-s36,v52
v_fma_f32 v88,v88,s36,v15
v_fma_f32 v89,v89,s36,v15
v_pk_mul_f32 v[204:205],v[204:205],v[60:61] op_sel_hi:[1,0]
v_pk_mul_f32 v[206:207],v[206:207],v[60:61] op_sel_hi:[1,0]
v_fma_f32 v90,v90,s36,v15
v_fma_f32 v91,v91,s36,v15
s_waitcnt lgkmcnt(3)
v_mfma_f32_16x16x32_bf16 v[72:75],v[116:119],a[164:167],0
s_cselect_b32 s30,100663296,s30
v_exp_f32 v88,v88
v_mfma_f32_16x16x32_bf16 v[72:75],v[112:115],a[160:163],v[72:75]
s_add_u32 s25,s30,s22
v_exp_f32 v89,v89
v_exp_f32 v90,v90
v_exp_f32 v91,v91
v_cvt_pk_bf16_f32 v28,v88,v89
v_cvt_pk_bf16_f32 v29,v90,v91
v_max3_f32 v56,v56,v99,v100
v_max3_f32 v56,v56,v101,v102
v_max_f32 v56,v56,v103
v_mov_b32 v57,v56
v_fma_f32 v77,v77,s36,v13
v_fma_f32 v78,v78,s36,v13
v_permlane32_swap_b32 v57,v56
s_waitcnt lgkmcnt(0)
v_mfma_f32_16x16x32_bf16 v[72:75],v[140:143],a[156:159],v[72:75]
s_add_u32 s26,s25,12288
v_max_f32 v56,v56,v57
v_mov_b32 v57,v56
v_mfma_f32_16x16x32_bf16 v[72:75],v[136:139],a[152:155],v[72:75]
s_add_u32 m0,s22,0
v_permlane16_swap_b32 v57,v56
v_mfma_f32_16x16x32_bf16 v[72:75],v[132:135],a[148:151],v[72:75]
s_mov_b32 s28,s41
v_max_f32 v56,v56,v57
v_mul_f32_e64 v16,-s36,v56
v_mfma_f32_16x16x32_bf16 v[72:75],v[128:131],a[144:147],v[72:75]
s_mov_b32 s29,s24
v_fma_f32 v96,v96,s36,v16
v_fma_f32 v97,v97,s36,v16
v_mfma_f32_16x16x32_bf16 v[80:83],v[128:131],a[168:171],0
v_fma_f32 v98,v98,s36,v16
v_fma_f32 v99,v99,s36,v16
v_mfma_f32_16x16x32_bf16 v[80:83],v[132:135],a[172:175],v[80:83]
v_exp_f32 v96,v96
v_mfma_f32_16x16x32_bf16 v[80:83],v[136:139],a[176:179],v[80:83]
v_exp_f32 v97,v97
v_mfma_f32_16x16x32_bf16 v[80:83],v[140:143],a[180:183],v[80:83]
v_exp_f32 v98,v98
v_mfma_f32_16x16x32_bf16 v[80:83],v[112:115],a[184:187],v[80:83]
v_exp_f32 v99,v99
v_mfma_f32_16x16x32_bf16 v[80:83],v[116:119],a[188:191],v[80:83]
v_cvt_pk_bf16_f32 v32,v96,v97
v_cvt_pk_bf16_f32 v33,v98,v99
v_mfma_f32_16x16x32_bf16 v[88:91],v[116:119],a[212:215],0
v_fma_f32 v79,v79,s36,v13
v_exp_f32 v76,v76
v_mfma_f32_16x16x32_bf16 v[88:91],v[112:115],a[208:211],v[88:91]
v_exp_f32 v77,v77
v_mfma_f32_16x16x32_bf16 v[88:91],v[140:143],a[204:207],v[88:91]
v_exp_f32 v78,v78
v_mfma_f32_16x16x32_bf16 v[88:91],v[136:139],a[200:203],v[88:91]
v_exp_f32 v79,v79
v_mfma_f32_16x16x32_bf16 v[88:91],v[132:135],a[196:199],v[88:91]
v_cvt_pk_bf16_f32 v22,v76,v77
v_cvt_pk_bf16_f32 v23,v78,v79
v_mfma_f32_16x16x32_bf16 v[88:91],v[128:131],a[192:195],v[88:91]
v_fma_f32 v84,v84,s36,v14
v_fma_f32 v85,v85,s36,v14
v_mfma_f32_16x16x32_bf16 v[96:99],v[128:131],a[216:219],0
ds_read_b128 v[128:131],v0 offset:18560
v_fma_f32 v86,v86,s36,v14
v_mfma_f32_16x16x32_bf16 v[96:99],v[132:135],a[220:223],v[96:99]
ds_read_b128 v[132:135],v1 offset:18560
v_fma_f32 v87,v87,s36,v14
v_mfma_f32_16x16x32_bf16 v[96:99],v[136:139],a[224:227],v[96:99]
ds_read_b128 v[136:139],v0 offset:18688
v_exp_f32 v84,v84
v_mfma_f32_16x16x32_bf16 v[96:99],v[140:143],a[228:231],v[96:99]
ds_read_b128 v[140:143],v1 offset:18688
v_exp_f32 v85,v85
v_mfma_f32_16x16x32_bf16 v[96:99],v[112:115],a[232:235],v[96:99]
v_exp_f32 v86,v86
v_mfma_f32_16x16x32_bf16 v[96:99],v[116:119],a[236:239],v[96:99]
v_exp_f32 v87,v87
v_mfma_f32_16x16x32_bf16 v[76:79],v[120:123],a[144:147],0
v_cvt_pk_bf16_f32 v26,v84,v85
v_cvt_pk_bf16_f32 v27,v86,v87
v_mfma_f32_16x16x32_bf16 v[76:79],v[124:127],a[148:151],v[76:79]
s_waitcnt lgkmcnt(3)
v_fma_f32 v92,v92,s36,v15
v_fma_f32 v93,v93,s36,v15
v_mfma_f32_16x16x32_bf16 v[76:79],v[128:131],a[152:155],v[76:79]
s_waitcnt lgkmcnt(2)
v_fma_f32 v94,v94,s36,v15
v_fma_f32 v95,v95,s36,v15
v_mfma_f32_16x16x32_bf16 v[76:79],v[132:135],a[156:159],v[76:79]
s_waitcnt vmcnt(5)
s_barrier
s_waitcnt lgkmcnt(0)
v_mfma_f32_16x16x32_bf16 v[76:79],v[136:139],a[160:163],v[76:79]
v_exp_f32 v92,v92
v_mfma_f32_16x16x32_bf16 v[76:79],v[140:143],a[164:167],v[76:79]
buffer_load_dwordx4 v6,s[4:7],s20 offen offset:0 lds
v_mfma_f32_16x16x32_bf16 v[84:87],v[140:143],a[188:191],0
v_exp_f32 v93,v93
v_mfma_f32_16x16x32_bf16 v[84:87],v[136:139],a[184:187],v[84:87]
v_exp_f32 v94,v94
v_mfma_f32_16x16x32_bf16 v[84:87],v[132:135],a[180:183],v[84:87]
v_exp_f32 v95,v95
v_mfma_f32_16x16x32_bf16 v[84:87],v[128:131],a[176:179],v[84:87]
v_cvt_pk_bf16_f32 v30,v92,v93
v_cvt_pk_bf16_f32 v31,v94,v95
v_mfma_f32_16x16x32_bf16 v[84:87],v[124:127],a[172:175],v[84:87]
buffer_load_dwordx4 v7,s[4:7],s20 offen offset:1024 lds
v_mfma_f32_16x16x32_bf16 v[84:87],v[120:123],a[168:171],v[84:87]
v_fma_f32 v100,v100,s36,v16
v_fma_f32 v101,v101,s36,v16
v_mfma_f32_16x16x32_bf16 v[92:95],v[120:123],a[192:195],0
v_fma_f32 v102,v102,s36,v16
v_fma_f32 v103,v103,s36,v16
v_mfma_f32_16x16x32_bf16 v[92:95],v[124:127],a[196:199],v[92:95]
v_exp_f32 v100,v100
v_mfma_f32_16x16x32_bf16 v[92:95],v[128:131],a[200:203],v[92:95]
ds_read_b64_tr_b16 v[112:113],v2 offset:0
v_exp_f32 v101,v101
v_mfma_f32_16x16x32_bf16 v[92:95],v[132:135],a[204:207],v[92:95]
ds_read_b64_tr_b16 v[114:115],v2 offset:6144
v_exp_f32 v102,v102
v_mfma_f32_16x16x32_bf16 v[92:95],v[136:139],a[208:211],v[92:95]
buffer_load_dwordx4 v8,s[4:7],s20 offen offset:2048 lds
v_mfma_f32_16x16x32_bf16 v[92:95],v[140:143],a[212:215],v[92:95]
s_add_u32 s20,s20,12288
ds_read_b64_tr_b16 v[116:117],v3 offset:0
ds_read_b64_tr_b16 v[118:119],v3 offset:6144
v_exp_f32 v103,v103
v_cvt_pk_bf16_f32 v34,v100,v101
v_cvt_pk_bf16_f32 v35,v102,v103
v_mfma_f32_16x16x32_bf16 v[100:103],v[140:143],a[236:239],0
v_cvt_pk_bf16_f32 v161,v162,v163
v_cvt_pk_bf16_f32 v177,v178,v179
v_mfma_f32_16x16x32_bf16 v[100:103],v[136:139],a[232:235],v[100:103]
ds_write2st64_b64 v36,v[160:161],v[176:177] offset0:0 offset1:2
v_mfma_f32_16x16x32_bf16 v[100:103],v[132:135],a[228:231],v[100:103]
v_cvt_pk_bf16_f32 v164,v164,v165
v_cvt_pk_bf16_f32 v180,v180,v181
v_mfma_f32_16x16x32_bf16 v[100:103],v[128:131],a[224:227],v[100:103]
v_cvt_pk_bf16_f32 v168,v168,v169
v_cvt_pk_bf16_f32 v184,v184,v185
v_mfma_f32_16x16x32_bf16 v[100:103],v[124:127],a[220:223],v[100:103]
ds_read_b64_tr_b16 v[124:125],v5 offset:0
v_cvt_pk_bf16_f32 v165,v166,v167
v_mfma_f32_16x16x32_bf16 v[100:103],v[120:123],a[216:219],v[100:103]
ds_read_b64_tr_b16 v[120:121],v4 offset:0
ds_read_b64_tr_b16 v[122:123],v4 offset:6144
ds_read_b64_tr_b16 v[126:127],v5 offset:6144
v_cvt_pk_bf16_f32 v181,v182,v183
ds_write2st64_b64 v37,v[164:165],v[180:181] offset0:0 offset1:2
v_mov_b32 v64,0
v_mov_b32 v65,0
v_cvt_pk_bf16_f32 v172,v172,v173
v_cvt_pk_bf16_f32 v188,v188,v189
v_smfmac_f32_16x16x64_bf16 v[64:67],v[152:155],v[28:35],v18
v_mov_b32 v60,0
v_mov_b32 v61,0
v_cvt_pk_bf16_f32 v169,v170,v171
v_cvt_pk_bf16_f32 v185,v186,v187
v_smfmac_f32_16x16x64_bf16 v[60:63],v[152:155],v[20:27],v18
ds_write2st64_b64 v38,v[168:169],v[184:185] offset0:0 offset1:2
v_cvt_pk_bf16_f32 v192,v192,v193
v_cvt_pk_bf16_f32 v173,v174,v175
v_cvt_pk_bf16_f32 v189,v190,v191
v_cvt_pk_bf16_f32 v196,v196,v197
v_fma_f32 v72,v72,s36,v13
v_fma_f32 v73,v73,s36,v13
v_fma_f32 v74,v74,s36,v13
v_fma_f32 v75,v75,s36,v13
v_fma_f32 v80,v80,s36,v14
v_fma_f32 v81,v81,s36,v14
v_cvt_pk_bf16_f32 v193,v194,v195
ds_write2st64_b64 v39,v[172:173],v[188:189] offset0:0 offset1:2
v_cvt_pk_bf16_f32 v200,v200,v201
v_cvt_pk_bf16_f32 v197,v198,v199
v_exp_f32 v72,v72
v_exp_f32 v73,v73
v_exp_f32 v74,v74
v_exp_f32 v75,v75
v_exp_f32 v80,v80
ds_write_b64 v36,v[192:193] offset:2048
v_exp_f32 v81,v81
v_cvt_pk_bf16_f32 v204,v204,v205
v_cvt_pk_bf16_f32 v201,v202,v203
ds_write_b64 v37,v[196:197] offset:2048
v_cvt_pk_bf16_f32 v205,v206,v207
v_cvt_pk_bf16_f32 v44,v72,v73
v_cvt_pk_bf16_f32 v45,v74,v75
v_cvt_pk_bf16_f32 v48,v80,v81
ds_write_b64 v38,v[200:201] offset:2048
ds_write_b64 v39,v[204:205] offset:2048
s_waitcnt lgkmcnt(3)
v_mfma_f32_16x16x32_bf16 v[160:163],v[112:115],v[20:23],0
s_add_u32 m0,s23,0
ds_read_b64_tr_b16 v[128:129],v2 offset:128
v_fma_f32 v82,v82,s36,v14
v_mfma_f32_16x16x32_bf16 v[164:167],v[116:119],v[20:23],0
ds_read_b64_tr_b16 v[130:131],v2 offset:6272
v_fma_f32 v83,v83,s36,v14
v_mfma_f32_16x16x32_bf16 v[212:215],v[116:119],v[24:27],0
ds_read_b64_tr_b16 v[132:133],v3 offset:128
v_fma_f32 v88,v88,s36,v15
v_mfma_f32_16x16x32_bf16 v[208:211],v[112:115],v[24:27],0
ds_read_b64_tr_b16 v[134:135],v3 offset:6272
v_fma_f32 v89,v89,s36,v15
v_mfma_f32_16x16x32_bf16 a[0:3],v[112:115],v[28:31],0
ds_read_b64_tr_b16 v[136:137],v4 offset:128
v_fma_f32 v90,v90,s36,v15
v_mfma_f32_16x16x32_bf16 a[4:7],v[116:119],v[28:31],0
ds_read_b64_tr_b16 v[138:139],v4 offset:6272
v_fma_f32 v91,v91,s36,v15
v_mfma_f32_16x16x32_bf16 a[52:55],v[116:119],v[32:35],0
ds_read_b64_tr_b16 v[140:141],v5 offset:128
v_fma_f32 v96,v96,s36,v16
v_mfma_f32_16x16x32_bf16 a[48:51],v[112:115],v[32:35],0
ds_read_b64_tr_b16 v[142:143],v5 offset:6272
v_fma_f32 v97,v97,s36,v16
v_mfma_f32_16x16x32_bf16 a[56:59],v[120:123],v[32:35],0
ds_read_b64_tr_b16 v[112:113],v2 offset:256
v_fma_f32 v98,v98,s36,v16
v_mfma_f32_16x16x32_bf16 a[60:63],v[124:127],v[32:35],0
ds_read_b64_tr_b16 v[114:115],v2 offset:6400
v_fma_f32 v99,v99,s36,v16
v_mfma_f32_16x16x32_bf16 a[12:15],v[124:127],v[28:31],0
ds_read_b64_tr_b16 v[116:117],v3 offset:256
v_fma_f32 v76,v76,s36,v13
v_mfma_f32_16x16x32_bf16 a[8:11],v[120:123],v[28:31],0
ds_read_b64_tr_b16 v[118:119],v3 offset:6400
v_fma_f32 v77,v77,s36,v13
v_mfma_f32_16x16x32_bf16 v[216:219],v[120:123],v[24:27],0
v_exp_f32 v82,v82
v_mfma_f32_16x16x32_bf16 v[220:223],v[124:127],v[24:27],0
v_exp_f32 v83,v83
v_mfma_f32_16x16x32_bf16 v[172:175],v[124:127],v[20:23],0
ds_read_b64_tr_b16 v[124:125],v5 offset:256
v_cvt_pk_bf16_f32 v49,v82,v83
v_mfma_f32_16x16x32_bf16 v[168:171],v[120:123],v[20:23],0
s_waitcnt lgkmcnt(4)
ds_read_b64_tr_b16 v[120:121],v4 offset:256
v_fma_f32 v78,v78,s36,v13
v_mfma_f32_16x16x32_bf16 v[176:179],v[128:131],v[20:23],0
ds_read_b64_tr_b16 v[122:123],v4 offset:6400
v_fma_f32 v79,v79,s36,v13
v_mfma_f32_16x16x32_bf16 v[180:183],v[132:135],v[20:23],0
ds_read_b64_tr_b16 v[126:127],v5 offset:6400
v_fma_f32 v84,v84,s36,v14
v_mfma_f32_16x16x32_bf16 v[228:231],v[132:135],v[24:27],0
v_exp_f32 v88,v88
v_mfma_f32_16x16x32_bf16 v[224:227],v[128:131],v[24:27],0
v_exp_f32 v89,v89
v_mfma_f32_16x16x32_bf16 a[16:19],v[128:131],v[28:31],0
v_exp_f32 v90,v90
v_mfma_f32_16x16x32_bf16 a[20:23],v[132:135],v[28:31],0
v_exp_f32 v91,v91
v_mfma_f32_16x16x32_bf16 a[68:71],v[132:135],v[32:35],0
v_cvt_pk_bf16_f32 v52,v88,v89
v_cvt_pk_bf16_f32 v53,v90,v91
v_mfma_f32_16x16x32_bf16 a[64:67],v[128:131],v[32:35],0
v_exp_f32 v96,v96
v_mfma_f32_16x16x32_bf16 a[72:75],v[136:139],v[32:35],0
v_exp_f32 v97,v97
v_mfma_f32_16x16x32_bf16 a[76:79],v[140:143],v[32:35],0
v_exp_f32 v98,v98
v_mfma_f32_16x16x32_bf16 a[28:31],v[140:143],v[28:31],0
v_exp_f32 v99,v99
v_mfma_f32_16x16x32_bf16 a[24:27],v[136:139],v[28:31],0
v_cvt_pk_bf16_f32 v56,v96,v97
v_cvt_pk_bf16_f32 v57,v98,v99
v_mfma_f32_16x16x32_bf16 v[232:235],v[136:139],v[24:27],0
v_exp_f32 v76,v76
v_mfma_f32_16x16x32_bf16 v[236:239],v[140:143],v[24:27],0
v_exp_f32 v77,v77
v_mfma_f32_16x16x32_bf16 v[188:191],v[140:143],v[20:23],0
v_exp_f32 v78,v78
v_mfma_f32_16x16x32_bf16 v[184:187],v[136:139],v[20:23],0
s_waitcnt lgkmcnt(0)
v_exp_f32 v79,v79
v_mfma_f32_16x16x32_bf16 v[192:195],v[112:115],v[20:23],0
v_cvt_pk_bf16_f32 v46,v76,v77
v_cvt_pk_bf16_f32 v47,v78,v79
v_mfma_f32_16x16x32_bf16 v[196:199],v[116:119],v[20:23],0
s_waitcnt vmcnt(24)
v_fma_f32 v85,v85,s36,v14
v_fma_f32 v86,v86,s36,v14
v_mfma_f32_16x16x32_bf16 v[244:247],v[116:119],v[24:27],0
s_barrier
v_mfma_f32_16x16x32_bf16 v[240:243],v[112:115],v[24:27],0
ds_read_b128 v[140:143],v1 offset:24704
v_fma_f32 v87,v87,s36,v14
v_mfma_f32_16x16x32_bf16 a[32:35],v[112:115],v[28:31],0
ds_read_b128 v[136:139],v0 offset:24704
v_fma_f32 v92,v92,s36,v15
v_mfma_f32_16x16x32_bf16 a[36:39],v[116:119],v[28:31],0
ds_read_b128 v[132:135],v1 offset:24576
v_fma_f32 v93,v93,s36,v15
v_mfma_f32_16x16x32_bf16 a[84:87],v[116:119],v[32:35],0
ds_read_b128 v[116:119],v1 offset:24832
v_fma_f32 v94,v94,s36,v15
v_mfma_f32_16x16x32_bf16 a[80:83],v[112:115],v[32:35],0
ds_read_b128 v[112:115],v0 offset:24832
v_fma_f32 v95,v95,s36,v15
v_mfma_f32_16x16x32_bf16 a[88:91],v[120:123],v[32:35],0
buffer_load_dwordx4 v6,s[8:11],s21 offen offset:0 lds
v_mfma_f32_16x16x32_bf16 a[92:95],v[124:127],v[32:35],0
ds_read_b128 v[128:131],v0 offset:24576
v_fma_f32 v100,v100,s36,v16
v_mfma_f32_16x16x32_bf16 a[44:47],v[124:127],v[28:31],0
v_exp_f32 v84,v84
v_mfma_f32_16x16x32_bf16 a[40:43],v[120:123],v[28:31],0
v_exp_f32 v85,v85
v_mfma_f32_16x16x32_bf16 v[248:251],v[120:123],v[24:27],0
v_exp_f32 v86,v86
v_mfma_f32_16x16x32_bf16 v[252:255],v[124:127],v[24:27],0
v_exp_f32 v87,v87
v_mfma_f32_16x16x32_bf16 v[204:207],v[124:127],v[20:23],0
ds_read_b128 v[124:127],v1 offset:30720
v_cvt_pk_bf16_f32 v50,v84,v85
v_mfma_f32_16x16x32_bf16 v[200:203],v[120:123],v[20:23],0
s_waitcnt lgkmcnt(2)
ds_read_b128 v[120:123],v0 offset:30720
v_cvt_pk_bf16_f32 v51,v86,v87
v_mfma_f32_16x16x32_bf16 v[72:75],v[116:119],a[164:167],0
v_exp_f32 v92,v92
v_smfmac_f32_16x16x64_bf16 v[60:63],v[152:155],v[44:51],v18
buffer_load_dwordx4 v7,s[8:11],s21 offen offset:1024 lds
v_mfma_f32_16x16x32_bf16 v[72:75],v[112:115],a[160:163],v[72:75]
v_exp_f32 v93,v93
v_mfma_f32_16x16x32_bf16 v[72:75],v[140:143],a[156:159],v[72:75]
v_exp_f32 v94,v94
v_mfma_f32_16x16x32_bf16 v[72:75],v[136:139],a[152:155],v[72:75]
v_exp_f32 v95,v95
v_mfma_f32_16x16x32_bf16 v[72:75],v[132:135],a[148:151],v[72:75]
s_waitcnt lgkmcnt(1)
v_cvt_pk_bf16_f32 v54,v92,v93
v_cvt_pk_bf16_f32 v55,v94,v95
v_mfma_f32_16x16x32_bf16 v[72:75],v[128:131],a[144:147],v[72:75]
v_fma_f32 v101,v101,s36,v16
v_fma_f32 v102,v102,s36,v16
v_mfma_f32_16x16x32_bf16 v[80:83],v[128:131],a[168:171],0
v_fma_f32 v103,v103,s36,v16
v_mfma_f32_16x16x32_bf16 v[80:83],v[132:135],a[172:175],v[80:83]
v_exp_f32 v100,v100
v_mfma_f32_16x16x32_bf16 v[80:83],v[136:139],a[176:179],v[80:83]
buffer_load_dwordx4 v8,s[8:11],s21 offen offset:2048 lds
v_mfma_f32_16x16x32_bf16 v[80:83],v[140:143],a[180:183],v[80:83]
s_add_u32 s21,s21,12288
v_exp_f32 v101,v101
v_mfma_f32_16x16x32_bf16 v[80:83],v[112:115],a[184:187],v[80:83]
s_add_u32 m0,s22,12288
v_exp_f32 v102,v102
v_mfma_f32_16x16x32_bf16 v[80:83],v[116:119],a[188:191],v[80:83]
v_exp_f32 v103,v103
v_mfma_f32_16x16x32_bf16 v[88:91],v[116:119],a[212:215],0
v_cvt_pk_bf16_f32 v58,v100,v101
v_cvt_pk_bf16_f32 v59,v102,v103
v_mfma_f32_16x16x32_bf16 v[88:91],v[112:115],a[208:211],v[88:91]
v_fma_f32 v72,v72,s36,v13
v_fma_f32 v73,v73,s36,v13
v_smfmac_f32_16x16x64_bf16 v[64:67],v[152:155],v[52:59],v18
v_fma_f32 v74,v74,s36,v13
v_mfma_f32_16x16x32_bf16 v[88:91],v[140:143],a[204:207],v[88:91]
v_fma_f32 v75,v75,s36,v13
v_fma_f32 v80,v80,s36,v14
v_mfma_f32_16x16x32_bf16 v[88:91],v[136:139],a[200:203],v[88:91]
v_fma_f32 v81,v81,s36,v14
v_mfma_f32_16x16x32_bf16 v[88:91],v[132:135],a[196:199],v[88:91]
buffer_load_dwordx4 v6,s[4:7],s20 offen offset:0 lds
v_mfma_f32_16x16x32_bf16 v[88:91],v[128:131],a[192:195],v[88:91]
v_exp_f32 v72,v72
v_mfma_f32_16x16x32_bf16 v[96:99],v[128:131],a[216:219],0
ds_read_b128 v[128:131],v0 offset:30848
v_mfma_f32_16x16x32_bf16 v[96:99],v[132:135],a[220:223],v[96:99]
ds_read_b128 v[132:135],v1 offset:30848
v_mfma_f32_16x16x32_bf16 v[96:99],v[136:139],a[224:227],v[96:99]
ds_read_b128 v[136:139],v0 offset:30976
v_mfma_f32_16x16x32_bf16 v[96:99],v[140:143],a[228:231],v[96:99]
ds_read_b128 v[140:143],v1 offset:30976
v_mfma_f32_16x16x32_bf16 v[96:99],v[112:115],a[232:235],v[96:99]
v_exp_f32 v73,v73
v_mfma_f32_16x16x32_bf16 v[96:99],v[116:119],a[236:239],v[96:99]
s_waitcnt lgkmcnt(4)
v_exp_f32 v74,v74
v_mfma_f32_16x16x32_bf16 v[76:79],v[120:123],a[144:147],0
v_exp_f32 v75,v75
v_mfma_f32_16x16x32_bf16 v[76:79],v[124:127],a[148:151],v[76:79]
buffer_load_dwordx4 v7,s[4:7],s20 offen offset:1024 lds
s_waitcnt lgkmcnt(3)
v_mfma_f32_16x16x32_bf16 v[76:79],v[128:131],a[152:155],v[76:79]
s_waitcnt lgkmcnt(2)
v_exp_f32 v80,v80
v_mfma_f32_16x16x32_bf16 v[76:79],v[132:135],a[156:159],v[76:79]
s_waitcnt lgkmcnt(0)
v_exp_f32 v81,v81
v_mfma_f32_16x16x32_bf16 v[76:79],v[136:139],a[160:163],v[76:79]
v_cvt_pk_bf16_f32 v20,v72,v73
v_cvt_pk_bf16_f32 v21,v74,v75
v_mfma_f32_16x16x32_bf16 v[76:79],v[140:143],a[164:167],v[76:79]
v_cvt_pk_bf16_f32 v24,v80,v81
v_mfma_f32_16x16x32_bf16 v[84:87],v[140:143],a[188:191],0
v_mfma_f32_16x16x32_bf16 v[84:87],v[136:139],a[184:187],v[84:87]
v_mfma_f32_16x16x32_bf16 v[84:87],v[132:135],a[180:183],v[84:87]
v_mfma_f32_16x16x32_bf16 v[84:87],v[128:131],a[176:179],v[84:87]
v_mfma_f32_16x16x32_bf16 v[84:87],v[124:127],a[172:175],v[84:87]
buffer_load_dwordx4 v8,s[4:7],s20 offen offset:2048 lds
v_mfma_f32_16x16x32_bf16 v[84:87],v[120:123],a[168:171],v[84:87]
s_add_u32 s20,s20,12288
v_mfma_f32_16x16x32_bf16 v[92:95],v[120:123],a[192:195],0
ds_read_b64_tr_b16 v[112:113],v2 offset:12288
v_mfma_f32_16x16x32_bf16 v[92:95],v[124:127],a[196:199],v[92:95]
ds_read_b64_tr_b16 v[114:115],v2 offset:18432
v_mfma_f32_16x16x32_bf16 v[92:95],v[128:131],a[200:203],v[92:95]
ds_read_b64_tr_b16 v[116:117],v3 offset:12288
v_mfma_f32_16x16x32_bf16 v[92:95],v[132:135],a[204:207],v[92:95]
ds_read_b64_tr_b16 v[118:119],v3 offset:18432
v_mfma_f32_16x16x32_bf16 v[92:95],v[136:139],a[208:211],v[92:95]
v_mfma_f32_16x16x32_bf16 v[92:95],v[140:143],a[212:215],v[92:95]
v_mfma_f32_16x16x32_bf16 v[100:103],v[140:143],a[236:239],0
v_mfma_f32_16x16x32_bf16 v[100:103],v[136:139],a[232:235],v[100:103]
v_mfma_f32_16x16x32_bf16 v[100:103],v[132:135],a[228:231],v[100:103]
v_mfma_f32_16x16x32_bf16 v[100:103],v[128:131],a[224:227],v[100:103]
v_mfma_f32_16x16x32_bf16 v[100:103],v[124:127],a[220:223],v[100:103]
ds_read_b64_tr_b16 v[124:125],v5 offset:12288
v_mfma_f32_16x16x32_bf16 v[100:103],v[120:123],a[216:219],v[100:103]
s_waitcnt lgkmcnt(1)
ds_read_b64_tr_b16 v[120:121],v4 offset:12288
ds_read_b64_tr_b16 v[122:123],v4 offset:18432
ds_read_b64_tr_b16 v[126:127],v5 offset:18432
v_mfma_f32_16x16x32_bf16 v[160:163],v[112:115],v[44:47],v[160:163]
s_add_u32 m0,s23,12288
ds_read_b64_tr_b16 v[128:129],v2 offset:12416
v_fma_f32 v82,v82,s36,v14
v_mfma_f32_16x16x32_bf16 v[164:167],v[116:119],v[44:47],v[164:167]
ds_read_b64_tr_b16 v[130:131],v2 offset:18560
v_fma_f32 v83,v83,s36,v14
v_mfma_f32_16x16x32_bf16 v[212:215],v[116:119],v[48:51],v[212:215]
ds_read_b64_tr_b16 v[132:133],v3 offset:12416
v_fma_f32 v88,v88,s36,v15
v_mfma_f32_16x16x32_bf16 v[208:211],v[112:115],v[48:51],v[208:211]
ds_read_b64_tr_b16 v[134:135],v3 offset:18560
v_fma_f32 v89,v89,s36,v15
v_mfma_f32_16x16x32_bf16 a[0:3],v[112:115],v[52:55],a[0:3]
ds_read_b64_tr_b16 v[136:137],v4 offset:12416
v_fma_f32 v90,v90,s36,v15
v_mfma_f32_16x16x32_bf16 a[4:7],v[116:119],v[52:55],a[4:7]
ds_read_b64_tr_b16 v[138:139],v4 offset:18560
v_fma_f32 v91,v91,s36,v15
v_mfma_f32_16x16x32_bf16 a[52:55],v[116:119],v[56:59],a[52:55]
ds_read_b64_tr_b16 v[140:141],v5 offset:12416
v_fma_f32 v96,v96,s36,v16
v_mfma_f32_16x16x32_bf16 a[48:51],v[112:115],v[56:59],a[48:51]
s_waitcnt lgkmcnt(6)
ds_read_b64_tr_b16 v[142:143],v5 offset:18560
v_fma_f32 v97,v97,s36,v16
v_mfma_f32_16x16x32_bf16 a[56:59],v[120:123],v[56:59],a[56:59]
ds_read_b64_tr_b16 v[112:113],v2 offset:12544
v_fma_f32 v98,v98,s36,v16
v_mfma_f32_16x16x32_bf16 a[60:63],v[124:127],v[56:59],a[60:63]
ds_read_b64_tr_b16 v[114:115],v2 offset:18688
v_fma_f32 v99,v99,s36,v16
v_mfma_f32_16x16x32_bf16 a[12:15],v[124:127],v[52:55],a[12:15]
ds_read_b64_tr_b16 v[116:117],v3 offset:12544
v_fma_f32 v76,v76,s36,v13
v_mfma_f32_16x16x32_bf16 a[8:11],v[120:123],v[52:55],a[8:11]
ds_read_b64_tr_b16 v[118:119],v3 offset:18688
v_fma_f32 v77,v77,s36,v13
v_mfma_f32_16x16x32_bf16 v[216:219],v[120:123],v[48:51],v[216:219]
v_exp_f32 v82,v82
v_mfma_f32_16x16x32_bf16 v[220:223],v[124:127],v[48:51],v[220:223]
v_exp_f32 v83,v83
v_mfma_f32_16x16x32_bf16 v[172:175],v[124:127],v[44:47],v[172:175]
ds_read_b64_tr_b16 v[124:125],v5 offset:12544
v_cvt_pk_bf16_f32 v25,v82,v83
v_mfma_f32_16x16x32_bf16 v[168:171],v[120:123],v[44:47],v[168:171]
s_waitcnt lgkmcnt(4)
ds_read_b64_tr_b16 v[120:121],v4 offset:12544
v_fma_f32 v78,v78,s36,v13
v_mfma_f32_16x16x32_bf16 v[176:179],v[128:131],v[44:47],v[176:179]
ds_read_b64_tr_b16 v[122:123],v4 offset:18688
v_fma_f32 v79,v79,s36,v13
v_mfma_f32_16x16x32_bf16 v[180:183],v[132:135],v[44:47],v[180:183]
ds_read_b64_tr_b16 v[126:127],v5 offset:18688
v_fma_f32 v84,v84,s36,v14
v_mfma_f32_16x16x32_bf16 v[228:231],v[132:135],v[48:51],v[228:231]
v_exp_f32 v88,v88
v_mfma_f32_16x16x32_bf16 v[224:227],v[128:131],v[48:51],v[224:227]
v_exp_f32 v89,v89
v_mfma_f32_16x16x32_bf16 a[16:19],v[128:131],v[52:55],a[16:19]
v_exp_f32 v90,v90
v_mfma_f32_16x16x32_bf16 a[20:23],v[132:135],v[52:55],a[20:23]
v_exp_f32 v91,v91
v_mfma_f32_16x16x32_bf16 a[68:71],v[132:135],v[56:59],a[68:71]
v_cvt_pk_bf16_f32 v28,v88,v89
v_cvt_pk_bf16_f32 v29,v90,v91
v_mfma_f32_16x16x32_bf16 a[64:67],v[128:131],v[56:59],a[64:67]
v_exp_f32 v96,v96
v_mfma_f32_16x16x32_bf16 a[72:75],v[136:139],v[56:59],a[72:75]
v_exp_f32 v97,v97
v_mfma_f32_16x16x32_bf16 a[76:79],v[140:143],v[56:59],a[76:79]
v_exp_f32 v98,v98
v_mfma_f32_16x16x32_bf16 a[28:31],v[140:143],v[52:55],a[28:31]
v_exp_f32 v99,v99
v_mfma_f32_16x16x32_bf16 a[24:27],v[136:139],v[52:55],a[24:27]
v_cvt_pk_bf16_f32 v32,v96,v97
v_cvt_pk_bf16_f32 v33,v98,v99
v_mfma_f32_16x16x32_bf16 v[232:235],v[136:139],v[48:51],v[232:235]
v_exp_f32 v76,v76
v_mfma_f32_16x16x32_bf16 v[236:239],v[140:143],v[48:51],v[236:239]
v_exp_f32 v77,v77
v_mfma_f32_16x16x32_bf16 v[188:191],v[140:143],v[44:47],v[188:191]
v_exp_f32 v78,v78
v_mfma_f32_16x16x32_bf16 v[184:187],v[136:139],v[44:47],v[184:187]
s_waitcnt lgkmcnt(0)
v_exp_f32 v79,v79
v_mfma_f32_16x16x32_bf16 v[192:195],v[112:115],v[44:47],v[192:195]
v_cvt_pk_bf16_f32 v22,v76,v77
v_cvt_pk_bf16_f32 v23,v78,v79
v_mfma_f32_16x16x32_bf16 v[196:199],v[116:119],v[44:47],v[196:199]
s_waitcnt vmcnt(6)
v_fma_f32 v85,v85,s36,v14
v_fma_f32 v86,v86,s36,v14
v_mfma_f32_16x16x32_bf16 v[244:247],v[116:119],v[48:51],v[244:247]
s_barrier
v_mfma_f32_16x16x32_bf16 v[240:243],v[112:115],v[48:51],v[240:243]
ds_read_b128 v[140:143],v1 offset:128
v_fma_f32 v87,v87,s36,v14
v_mfma_f32_16x16x32_bf16 a[32:35],v[112:115],v[52:55],a[32:35]
ds_read_b128 v[136:139],v0 offset:128
v_fma_f32 v92,v92,s36,v15
v_mfma_f32_16x16x32_bf16 a[36:39],v[116:119],v[52:55],a[36:39]
ds_read_b128 v[132:135],v1 offset:0
v_fma_f32 v93,v93,s36,v15
v_mfma_f32_16x16x32_bf16 a[84:87],v[116:119],v[56:59],a[84:87]
ds_read_b128 v[116:119],v1 offset:256
v_fma_f32 v94,v94,s36,v15
v_mfma_f32_16x16x32_bf16 a[80:83],v[112:115],v[56:59],a[80:83]
ds_read_b128 v[112:115],v0 offset:256
v_fma_f32 v95,v95,s36,v15
v_mfma_f32_16x16x32_bf16 a[88:91],v[120:123],v[56:59],a[88:91]
buffer_load_dwordx4 v6,s[8:11],s21 offen offset:0 lds
v_mfma_f32_16x16x32_bf16 a[92:95],v[124:127],v[56:59],a[92:95]
ds_read_b128 v[128:131],v0 offset:0
v_fma_f32 v100,v100,s36,v16
v_mfma_f32_16x16x32_bf16 a[44:47],v[124:127],v[52:55],a[44:47]
v_exp_f32 v84,v84
v_mfma_f32_16x16x32_bf16 a[40:43],v[120:123],v[52:55],a[40:43]
v_exp_f32 v85,v85
v_mfma_f32_16x16x32_bf16 v[248:251],v[120:123],v[48:51],v[248:251]
v_exp_f32 v86,v86
v_mfma_f32_16x16x32_bf16 v[252:255],v[124:127],v[48:51],v[252:255]
v_exp_f32 v87,v87
v_mfma_f32_16x16x32_bf16 v[204:207],v[124:127],v[44:47],v[204:207]
ds_read_b128 v[124:127],v1 offset:6144
v_cvt_pk_bf16_f32 v26,v84,v85
v_mfma_f32_16x16x32_bf16 v[200:203],v[120:123],v[44:47],v[200:203]
s_waitcnt lgkmcnt(2)
ds_read_b128 v[120:123],v0 offset:6144
v_cvt_pk_bf16_f32 v27,v86,v87
v_mfma_f32_16x16x32_bf16 v[72:75],v[116:119],a[164:167],0
v_exp_f32 v92,v92
v_smfmac_f32_16x16x64_bf16 v[60:63],v[152:155],v[20:27],v18
buffer_load_dwordx4 v7,s[8:11],s21 offen offset:1024 lds
v_mfma_f32_16x16x32_bf16 v[72:75],v[112:115],a[160:163],v[72:75]
v_exp_f32 v93,v93
v_mfma_f32_16x16x32_bf16 v[72:75],v[140:143],a[156:159],v[72:75]
v_exp_f32 v94,v94
v_mfma_f32_16x16x32_bf16 v[72:75],v[136:139],a[152:155],v[72:75]
v_exp_f32 v95,v95
v_mfma_f32_16x16x32_bf16 v[72:75],v[132:135],a[148:151],v[72:75]
s_waitcnt lgkmcnt(1)
v_cvt_pk_bf16_f32 v30,v92,v93
v_cvt_pk_bf16_f32 v31,v94,v95
v_mfma_f32_16x16x32_bf16 v[72:75],v[128:131],a[144:147],v[72:75]
v_fma_f32 v101,v101,s36,v16
v_fma_f32 v102,v102,s36,v16
v_mfma_f32_16x16x32_bf16 v[80:83],v[128:131],a[168:171],0
v_fma_f32 v103,v103,s36,v16
v_mfma_f32_16x16x32_bf16 v[80:83],v[132:135],a[172:175],v[80:83]
v_exp_f32 v100,v100
v_mfma_f32_16x16x32_bf16 v[80:83],v[136:139],a[176:179],v[80:83]
buffer_load_dwordx4 v8,s[8:11],s21 offen offset:2048 lds
v_mfma_f32_16x16x32_bf16 v[80:83],v[140:143],a[180:183],v[80:83]
s_add_u32 s21,s21,12288
v_exp_f32 v101,v101
v_mfma_f32_16x16x32_bf16 v[80:83],v[112:115],a[184:187],v[80:83]
s_add_u32 m0,s22,24576
v_exp_f32 v102,v102
v_mfma_f32_16x16x32_bf16 v[80:83],v[116:119],a[188:191],v[80:83]
v_exp_f32 v103,v103
v_mfma_f32_16x16x32_bf16 v[88:91],v[116:119],a[212:215],0
v_cvt_pk_bf16_f32 v34,v100,v101
v_cvt_pk_bf16_f32 v35,v102,v103
v_mfma_f32_16x16x32_bf16 v[88:91],v[112:115],a[208:211],v[88:91]
v_fma_f32 v72,v72,s36,v13
v_fma_f32 v73,v73,s36,v13
v_smfmac_f32_16x16x64_bf16 v[64:67],v[152:155],v[28:35],v18
v_fma_f32 v74,v74,s36,v13
v_mfma_f32_16x16x32_bf16 v[88:91],v[140:143],a[204:207],v[88:91]
v_fma_f32 v75,v75,s36,v13
v_fma_f32 v80,v80,s36,v14
v_mfma_f32_16x16x32_bf16 v[88:91],v[136:139],a[200:203],v[88:91]
v_fma_f32 v81,v81,s36,v14
v_mfma_f32_16x16x32_bf16 v[88:91],v[132:135],a[196:199],v[88:91]
buffer_load_dwordx4 v6,s[4:7],s20 offen offset:0 lds
v_mfma_f32_16x16x32_bf16 v[88:91],v[128:131],a[192:195],v[88:91]
v_exp_f32 v72,v72
v_mfma_f32_16x16x32_bf16 v[96:99],v[128:131],a[216:219],0
ds_read_b128 v[128:131],v0 offset:6272
v_mfma_f32_16x16x32_bf16 v[96:99],v[132:135],a[220:223],v[96:99]
ds_read_b128 v[132:135],v1 offset:6272
v_mfma_f32_16x16x32_bf16 v[96:99],v[136:139],a[224:227],v[96:99]
ds_read_b128 v[136:139],v0 offset:6400
v_mfma_f32_16x16x32_bf16 v[96:99],v[140:143],a[228:231],v[96:99]
ds_read_b128 v[140:143],v1 offset:6400
v_mfma_f32_16x16x32_bf16 v[96:99],v[112:115],a[232:235],v[96:99]
v_exp_f32 v73,v73
v_mfma_f32_16x16x32_bf16 v[96:99],v[116:119],a[236:239],v[96:99]
s_waitcnt lgkmcnt(4)
v_exp_f32 v74,v74
v_mfma_f32_16x16x32_bf16 v[76:79],v[120:123],a[144:147],0
v_exp_f32 v75,v75
v_mfma_f32_16x16x32_bf16 v[76:79],v[124:127],a[148:151],v[76:79]
buffer_load_dwordx4 v7,s[4:7],s20 offen offset:1024 lds
s_waitcnt lgkmcnt(3)
v_mfma_f32_16x16x32_bf16 v[76:79],v[128:131],a[152:155],v[76:79]
s_waitcnt lgkmcnt(2)
v_exp_f32 v80,v80
v_mfma_f32_16x16x32_bf16 v[76:79],v[132:135],a[156:159],v[76:79]
s_waitcnt lgkmcnt(0)
v_exp_f32 v81,v81
v_mfma_f32_16x16x32_bf16 v[76:79],v[136:139],a[160:163],v[76:79]
v_cvt_pk_bf16_f32 v44,v72,v73
v_cvt_pk_bf16_f32 v45,v74,v75
v_mfma_f32_16x16x32_bf16 v[76:79],v[140:143],a[164:167],v[76:79]
v_cvt_pk_bf16_f32 v48,v80,v81
v_mfma_f32_16x16x32_bf16 v[84:87],v[140:143],a[188:191],0
v_mfma_f32_16x16x32_bf16 v[84:87],v[136:139],a[184:187],v[84:87]
v_mfma_f32_16x16x32_bf16 v[84:87],v[132:135],a[180:183],v[84:87]
v_mfma_f32_16x16x32_bf16 v[84:87],v[128:131],a[176:179],v[84:87]
v_mfma_f32_16x16x32_bf16 v[84:87],v[124:127],a[172:175],v[84:87]
buffer_load_dwordx4 v8,s[4:7],s20 offen offset:2048 lds
v_mfma_f32_16x16x32_bf16 v[84:87],v[120:123],a[168:171],v[84:87]
s_add_u32 s20,s20,12288
v_mfma_f32_16x16x32_bf16 v[92:95],v[120:123],a[192:195],0
ds_read_b64_tr_b16 v[112:113],v2 offset:24576
v_mfma_f32_16x16x32_bf16 v[92:95],v[124:127],a[196:199],v[92:95]
ds_read_b64_tr_b16 v[114:115],v2 offset:30720
v_mfma_f32_16x16x32_bf16 v[92:95],v[128:131],a[200:203],v[92:95]
ds_read_b64_tr_b16 v[116:117],v3 offset:24576
v_mfma_f32_16x16x32_bf16 v[92:95],v[132:135],a[204:207],v[92:95]
ds_read_b64_tr_b16 v[118:119],v3 offset:30720
v_mfma_f32_16x16x32_bf16 v[92:95],v[136:139],a[208:211],v[92:95]
v_mfma_f32_16x16x32_bf16 v[92:95],v[140:143],a[212:215],v[92:95]
v_mfma_f32_16x16x32_bf16 v[100:103],v[140:143],a[236:239],0
v_mfma_f32_16x16x32_bf16 v[100:103],v[136:139],a[232:235],v[100:103]
v_mfma_f32_16x16x32_bf16 v[100:103],v[132:135],a[228:231],v[100:103]
v_mfma_f32_16x16x32_bf16 v[100:103],v[128:131],a[224:227],v[100:103]
v_mfma_f32_16x16x32_bf16 v[100:103],v[124:127],a[220:223],v[100:103]
ds_read_b64_tr_b16 v[124:125],v5 offset:24576
v_mfma_f32_16x16x32_bf16 v[100:103],v[120:123],a[216:219],v[100:103]
ds_read_b64_tr_b16 v[120:121],v4 offset:24576
ds_read_b64_tr_b16 v[122:123],v4 offset:30720
ds_read_b64_tr_b16 v[126:127],v5 offset:30720
s_mov_b32 s38,0
s_branch L_loop4
L_end5:
s_waitcnt lgkmcnt(3)
v_mfma_f32_16x16x32_bf16 v[160:163],v[112:115],v[20:23],v[160:163]
ds_read_b64_tr_b16 v[128:129],v2 offset:24704
v_fma_f32 v90,v90,s36,v15
v_mfma_f32_16x16x32_bf16 v[164:167],v[116:119],v[20:23],v[164:167]
ds_read_b64_tr_b16 v[130:131],v2 offset:30848
v_fma_f32 v91,v91,s36,v15
v_mfma_f32_16x16x32_bf16 v[212:215],v[116:119],v[24:27],v[212:215]
ds_read_b64_tr_b16 v[132:133],v3 offset:24704
v_fma_f32 v96,v96,s36,v16
v_mfma_f32_16x16x32_bf16 v[208:211],v[112:115],v[24:27],v[208:211]
ds_read_b64_tr_b16 v[134:135],v3 offset:30848
v_fma_f32 v97,v97,s36,v16
v_mfma_f32_16x16x32_bf16 a[0:3],v[112:115],v[28:31],a[0:3]
ds_read_b64_tr_b16 v[136:137],v4 offset:24704
v_fma_f32 v98,v98,s36,v16
v_mfma_f32_16x16x32_bf16 a[4:7],v[116:119],v[28:31],a[4:7]
ds_read_b64_tr_b16 v[138:139],v4 offset:30848
ds_read_b64_tr_b16 v[140:141],v5 offset:24704
ds_read_b64_tr_b16 v[142:143],v5 offset:30848
v_mfma_f32_16x16x32_bf16 a[52:55],v[116:119],v[32:35],a[52:55]
v_fma_f32 v99,v99,s36,v16
v_fma_f32 v104,v104,s36,v17
v_mfma_f32_16x16x32_bf16 a[48:51],v[112:115],v[32:35],a[48:51]
v_fma_f32 v105,v105,s36,v17
v_fma_f32 v106,v106,s36,v17
v_mfma_f32_16x16x32_bf16 a[96:99],v[112:115],v[36:39],a[96:99]
ds_read_b64_tr_b16 v[112:113],v2 offset:24832
v_fma_f32 v107,v107,s36,v17
v_mfma_f32_16x16x32_bf16 a[100:103],v[116:119],v[36:39],a[100:103]
s_waitcnt lgkmcnt(6)
ds_read_b64_tr_b16 v[114:115],v2 offset:30976
v_fma_f32 v76,v76,s36,v13
v_mfma_f32_16x16x32_bf16 a[104:107],v[120:123],v[36:39],a[104:107]
ds_read_b64_tr_b16 v[116:117],v3 offset:24832
v_fma_f32 v77,v77,s36,v13
v_mfma_f32_16x16x32_bf16 a[108:111],v[124:127],v[36:39],a[108:111]
ds_read_b64_tr_b16 v[118:119],v3 offset:30976
v_fma_f32 v78,v78,s36,v13
v_mfma_f32_16x16x32_bf16 a[60:63],v[124:127],v[32:35],a[60:63]
v_fma_f32 v79,v79,s36,v13
v_fma_f32 v84,v84,s36,v14
v_mfma_f32_16x16x32_bf16 a[56:59],v[120:123],v[32:35],a[56:59]
v_fma_f32 v85,v85,s36,v14
v_fma_f32 v86,v86,s36,v14
v_mfma_f32_16x16x32_bf16 a[8:11],v[120:123],v[28:31],a[8:11]
v_fma_f32 v87,v87,s36,v14
v_fma_f32 v92,v92,s36,v15
v_mfma_f32_16x16x32_bf16 a[12:15],v[124:127],v[28:31],a[12:15]
v_fma_f32 v93,v93,s36,v15
v_fma_f32 v94,v94,s36,v15
v_mfma_f32_16x16x32_bf16 v[220:223],v[124:127],v[24:27],v[220:223]
v_fma_f32 v95,v95,s36,v15
v_fma_f32 v100,v100,s36,v16
v_mfma_f32_16x16x32_bf16 v[216:219],v[120:123],v[24:27],v[216:219]
v_fma_f32 v101,v101,s36,v16
v_fma_f32 v102,v102,s36,v16
v_mfma_f32_16x16x32_bf16 v[168:171],v[120:123],v[20:23],v[168:171]
ds_read_b64_tr_b16 v[120:121],v4 offset:24832
v_fma_f32 v103,v103,s36,v16
v_mfma_f32_16x16x32_bf16 v[172:175],v[124:127],v[20:23],v[172:175]
ds_read_b64_tr_b16 v[122:123],v4 offset:30976
v_fma_f32 v108,v108,s36,v17
v_mfma_f32_16x16x32_bf16 v[176:179],v[128:131],v[20:23],v[176:179]
s_waitcnt lgkmcnt(2)
ds_read_b64_tr_b16 v[124:125],v5 offset:24832
v_fma_f32 v109,v109,s36,v17
v_mfma_f32_16x16x32_bf16 v[180:183],v[132:135],v[20:23],v[180:183]
ds_read_b64_tr_b16 v[126:127],v5 offset:30976
v_fma_f32 v110,v110,s36,v17
v_mfma_f32_16x16x32_bf16 v[228:231],v[132:135],v[24:27],v[228:231]
v_fma_f32 v111,v111,s36,v17
v_exp_f32 v90,v90
v_mfma_f32_16x16x32_bf16 v[224:227],v[128:131],v[24:27],v[224:227]
v_exp_f32 v91,v91
v_mfma_f32_16x16x32_bf16 a[16:19],v[128:131],v[28:31],a[16:19]
v_exp_f32 v96,v96
v_mfma_f32_16x16x32_bf16 a[20:23],v[132:135],v[28:31],a[20:23]
v_exp_f32 v97,v97
v_mfma_f32_16x16x32_bf16 a[68:71],v[132:135],v[32:35],a[68:71]
v_exp_f32 v98,v98
v_mfma_f32_16x16x32_bf16 a[64:67],v[128:131],v[32:35],a[64:67]
v_exp_f32 v99,v99
v_mfma_f32_16x16x32_bf16 a[112:115],v[128:131],v[36:39],a[112:115]
v_exp_f32 v104,v104
v_mfma_f32_16x16x32_bf16 a[116:119],v[132:135],v[36:39],a[116:119]
v_exp_f32 v105,v105
v_mfma_f32_16x16x32_bf16 a[120:123],v[136:139],v[36:39],a[120:123]
v_exp_f32 v106,v106
v_mfma_f32_16x16x32_bf16 a[124:127],v[140:143],v[36:39],a[124:127]
v_exp_f32 v107,v107
v_mfma_f32_16x16x32_bf16 a[76:79],v[140:143],v[32:35],a[76:79]
v_exp_f32 v76,v76
v_mfma_f32_16x16x32_bf16 a[72:75],v[136:139],v[32:35],a[72:75]
v_exp_f32 v77,v77
v_mfma_f32_16x16x32_bf16 a[24:27],v[136:139],v[28:31],a[24:27]
v_exp_f32 v78,v78
v_mfma_f32_16x16x32_bf16 a[28:31],v[140:143],v[28:31],a[28:31]
v_exp_f32 v79,v79
v_mfma_f32_16x16x32_bf16 v[236:239],v[140:143],v[24:27],v[236:239]
v_exp_f32 v84,v84
v_mfma_f32_16x16x32_bf16 v[232:235],v[136:139],v[24:27],v[232:235]
v_exp_f32 v85,v85
v_mfma_f32_16x16x32_bf16 v[184:187],v[136:139],v[20:23],v[184:187]
v_exp_f32 v86,v86
v_mfma_f32_16x16x32_bf16 v[188:191],v[140:143],v[20:23],v[188:191]
v_exp_f32 v87,v87
v_mfma_f32_16x16x32_bf16 v[192:195],v[112:115],v[20:23],v[192:195]
v_exp_f32 v92,v92
v_mfma_f32_16x16x32_bf16 v[196:199],v[116:119],v[20:23],v[196:199]
v_exp_f32 v93,v93
v_mfma_f32_16x16x32_bf16 v[244:247],v[116:119],v[24:27],v[244:247]
v_exp_f32 v94,v94
v_mfma_f32_16x16x32_bf16 v[240:243],v[112:115],v[24:27],v[240:243]
v_exp_f32 v95,v95
v_mfma_f32_16x16x32_bf16 a[32:35],v[112:115],v[28:31],a[32:35]
v_exp_f32 v100,v100
v_mfma_f32_16x16x32_bf16 a[36:39],v[116:119],v[28:31],a[36:39]
v_exp_f32 v101,v101
v_mfma_f32_16x16x32_bf16 a[84:87],v[116:119],v[32:35],a[84:87]
v_exp_f32 v102,v102
v_mfma_f32_16x16x32_bf16 a[80:83],v[112:115],v[32:35],a[80:83]
v_exp_f32 v103,v103
v_mfma_f32_16x16x32_bf16 a[128:131],v[112:115],v[36:39],a[128:131]
v_exp_f32 v108,v108
s_waitcnt vmcnt(14) lgkmcnt(0)
s_barrier
v_mfma_f32_16x16x32_bf16 a[132:135],v[116:119],v[36:39],a[132:135]
v_exp_f32 v109,v109
v_mfma_f32_16x16x32_bf16 a[136:139],v[120:123],v[36:39],a[136:139]
v_exp_f32 v110,v110
v_mfma_f32_16x16x32_bf16 a[140:143],v[124:127],v[36:39],a[140:143]
v_exp_f32 v111,v111
v_mfma_f32_16x16x32_bf16 a[92:95],v[124:127],v[32:35],a[92:95]
v_cvt_pk_bf16_f32 v53,v90,v91
v_cvt_pk_bf16_f32 v56,v96,v97
v_mfma_f32_16x16x32_bf16 a[88:91],v[120:123],v[32:35],a[88:91]
v_cvt_pk_bf16_f32 v57,v98,v99
v_cvt_pk_bf16_f32 v40,v104,v105
v_mfma_f32_16x16x32_bf16 a[40:43],v[120:123],v[28:31],a[40:43]
v_cvt_pk_bf16_f32 v41,v106,v107
v_cvt_pk_bf16_f32 v46,v76,v77
v_mfma_f32_16x16x32_bf16 a[44:47],v[124:127],v[28:31],a[44:47]
v_cvt_pk_bf16_f32 v47,v78,v79
v_cvt_pk_bf16_f32 v50,v84,v85
v_mfma_f32_16x16x32_bf16 v[252:255],v[124:127],v[24:27],v[252:255]
v_cvt_pk_bf16_f32 v51,v86,v87
v_cvt_pk_bf16_f32 v54,v92,v93
v_mfma_f32_16x16x32_bf16 v[248:251],v[120:123],v[24:27],v[248:251]
v_cvt_pk_bf16_f32 v55,v94,v95
v_cvt_pk_bf16_f32 v58,v100,v101
v_smfmac_f32_16x16x64_bf16 v[60:63],v[152:155],v[44:51],v18
v_cvt_pk_bf16_f32 v59,v102,v103
v_mfma_f32_16x16x32_bf16 v[200:203],v[120:123],v[20:23],v[200:203]
v_cvt_pk_bf16_f32 v42,v108,v109
v_cvt_pk_bf16_f32 v43,v110,v111
v_smfmac_f32_16x16x64_bf16 v[64:67],v[152:155],v[52:59],v18
v_subrev_u32 v10,18432,v10
v_smfmac_f32_16x16x64_bf16 v[68:71],v[152:155],v[36:43],v18
v_mfma_f32_16x16x32_bf16 v[204:207],v[124:127],v[20:23],v[204:207]
ds_read_b64_tr_b16 v[128:129],v2 offset:0
ds_read_b64_tr_b16 v[130:131],v2 offset:6144
ds_read_b64_tr_b16 v[132:133],v3 offset:0
ds_read_b64_tr_b16 v[134:135],v3 offset:6144
ds_read_b64_tr_b16 v[136:137],v4 offset:0
ds_read_b64_tr_b16 v[138:139],v4 offset:6144
ds_read_b64_tr_b16 v[140:141],v5 offset:0
ds_read_b64_tr_b16 v[142:143],v5 offset:6144
s_waitcnt lgkmcnt(6)
v_mfma_f32_16x16x32_bf16 v[160:163],v[128:131],v[44:47],v[160:163]
s_waitcnt vmcnt(6)
ds_read_b64_tr_b16 v[112:113],v2 offset:128
v_mbcnt_lo_u32_b32 v39,-1,0
s_waitcnt lgkmcnt(5)
v_mfma_f32_16x16x32_bf16 v[164:167],v[132:135],v[44:47],v[164:167]
s_add_u32 s84,s42,0
ds_read_b64_tr_b16 v[114:115],v2 offset:6272
v_mbcnt_hi_u32_b32 v39,-1,v39
v_mfma_f32_16x16x32_bf16 v[212:215],v[132:135],v[48:51],v[212:215]
s_add_u32 s85,s42,6144
ds_read_b64_tr_b16 v[116:117],v3 offset:128
v_and_b32 v38,7,v39
v_mfma_f32_16x16x32_bf16 v[208:211],v[128:131],v[48:51],v[208:211]
s_add_u32 s86,s42,12288
ds_read_b64_tr_b16 v[118:119],v3 offset:6272
v_add_f32 v68,v68,v69
v_mfma_f32_16x16x32_bf16 a[0:3],v[128:131],v[52:55],a[0:3]
s_add_u32 s87,s42,18432
ds_read_b64_tr_b16 v[120:121],v4 offset:128
v_add_f32 v60,v60,v61
v_mfma_f32_16x16x32_bf16 a[4:7],v[132:135],v[52:55],a[4:7]
s_add_u32 s66,s42,24576
ds_read_b64_tr_b16 v[122:123],v4 offset:6272
ds_read_b64_tr_b16 v[124:125],v5 offset:128
ds_read_b64_tr_b16 v[126:127],v5 offset:6272
v_mfma_f32_16x16x32_bf16 a[52:55],v[132:135],v[56:59],a[52:55]
v_add_f32 v62,v62,v63
v_add_f32 v64,v64,v65
v_mfma_f32_16x16x32_bf16 a[48:51],v[128:131],v[56:59],a[48:51]
v_add_f32 v68,v68,v70
v_add_f32 v66,v66,v67
v_mfma_f32_16x16x32_bf16 a[96:99],v[128:131],v[40:43],a[96:99]
ds_read_b64_tr_b16 v[128:129],v2 offset:256
v_max3_f32 v19,v60,v62,v64
v_mfma_f32_16x16x32_bf16 a[100:103],v[132:135],v[40:43],a[100:103]
s_waitcnt lgkmcnt(6)
ds_read_b64_tr_b16 v[130:131],v2 offset:6400
v_add_f32 v68,v68,v71
v_mfma_f32_16x16x32_bf16 a[104:107],v[136:139],v[40:43],a[104:107]
ds_read_b64_tr_b16 v[132:133],v3 offset:256
v_max3_f32 v19,v19,v66,v68
v_mfma_f32_16x16x32_bf16 a[108:111],v[140:143],v[40:43],a[108:111]
ds_read_b64_tr_b16 v[134:135],v3 offset:6400
v_rcp_f32 v66,v66
v_rcp_f32 v68,v68
v_accvgpr_read_b32 v72,a48
v_accvgpr_read_b32 v73,a49
v_pk_mul_f32 v[72:73],v[72:73],v[66:67] op_sel_hi:[1,0]
v_accvgpr_read_b32 v74,a50
v_accvgpr_read_b32 v75,a51
v_pk_mul_f32 v[74:75],v[74:75],v[66:67] op_sel_hi:[1,0]
v_accvgpr_read_b32 v76,a96
v_accvgpr_read_b32 v77,a97
v_pk_mul_f32 v[76:77],v[76:77],v[68:69] op_sel_hi:[1,0]
v_accvgpr_read_b32 v78,a98
v_accvgpr_read_b32 v79,a99
v_pk_mul_f32 v[78:79],v[78:79],v[68:69] op_sel_hi:[1,0]
v_accvgpr_read_b32 v80,a52
v_accvgpr_read_b32 v81,a53
v_mfma_f32_16x16x32_bf16 a[60:63],v[140:143],v[56:59],a[60:63]
v_accvgpr_read_b32 v82,a54
v_accvgpr_read_b32 v83,a55
v_accvgpr_read_b32 v84,a100
v_accvgpr_read_b32 v85,a101
v_accvgpr_read_b32 v86,a102
v_pk_mul_f32 v[80:81],v[80:81],v[66:67] op_sel_hi:[1,0]
v_pk_mul_f32 v[82:83],v[82:83],v[66:67] op_sel_hi:[1,0]
v_pk_mul_f32 v[84:85],v[84:85],v[68:69] op_sel_hi:[1,0]
v_accvgpr_read_b32 v87,a103
v_pk_mul_f32 v[86:87],v[86:87],v[68:69] op_sel_hi:[1,0]
v_accvgpr_read_b32 v92,a104
v_accvgpr_read_b32 v93,a105
v_mfma_f32_16x16x32_bf16 a[56:59],v[136:139],v[56:59],a[56:59]
v_accvgpr_read_b32 v94,a106
v_accvgpr_read_b32 v95,a107
v_mfma_f32_16x16x32_bf16 a[8:11],v[136:139],v[52:55],a[8:11]
v_accvgpr_read_b32 v100,a108
v_accvgpr_read_b32 v101,a109
v_mfma_f32_16x16x32_bf16 a[12:15],v[140:143],v[52:55],a[12:15]
v_accvgpr_read_b32 v102,a110
v_accvgpr_read_b32 v103,a111
v_mfma_f32_16x16x32_bf16 v[220:223],v[140:143],v[48:51],v[220:223]
v_accvgpr_read_b32 v96,a60
v_accvgpr_read_b32 v97,a61
v_accvgpr_read_b32 v98,a62
v_accvgpr_read_b32 v99,a63
v_accvgpr_read_b32 v88,a56
v_pk_mul_f32 v[92:93],v[92:93],v[68:69] op_sel_hi:[1,0]
v_pk_mul_f32 v[94:95],v[94:95],v[68:69] op_sel_hi:[1,0]
v_pk_mul_f32 v[100:101],v[100:101],v[68:69] op_sel_hi:[1,0]
v_pk_mul_f32 v[102:103],v[102:103],v[68:69] op_sel_hi:[1,0]
v_pk_mul_f32 v[96:97],v[96:97],v[66:67] op_sel_hi:[1,0]
v_pk_mul_f32 v[98:99],v[98:99],v[66:67] op_sel_hi:[1,0]
v_accvgpr_read_b32 v89,a57
v_pk_mul_f32 v[88:89],v[88:89],v[66:67] op_sel_hi:[1,0]
v_accvgpr_read_b32 v90,a58
v_accvgpr_read_b32 v91,a59
v_pk_mul_f32 v[90:91],v[90:91],v[66:67] op_sel_hi:[1,0]
v_cmp_ngt_f32 vcc,s37,v19
v_lshrrev_b32 v19,5,v39
v_mfma_f32_16x16x32_bf16 v[216:219],v[136:139],v[48:51],v[216:219]
v_xor_b32 v38,v38,v19
v_and_b32 v19,15,v39
v_mfma_f32_16x16x32_bf16 v[168:171],v[136:139],v[44:47],v[168:171]
s_cmp_lg_u64 vcc,0
ds_read_b64_tr_b16 v[136:137],v4 offset:256
v_lshl_add_u32 v19,v19,7,s24
v_mfma_f32_16x16x32_bf16 v[172:175],v[140:143],v[44:47],v[172:175]
s_cselect_b32 s62,s32,0
ds_read_b64_tr_b16 v[138:139],v4 offset:6400
v_lshl_add_u32 v19,v38,4,v19
v_mfma_f32_16x16x32_bf16 v[176:179],v[112:115],v[44:47],v[176:179]
s_or_b32 s31,s31,s62
ds_read_b64_tr_b16 v[140:141],v5 offset:256
v_bfe_u32 v38,v39,4,1
s_waitcnt lgkmcnt(3)
v_mfma_f32_16x16x32_bf16 v[180:183],v[116:119],v[44:47],v[180:183]
s_lshl_b32 s32,s32,1
ds_read_b64_tr_b16 v[142:143],v5 offset:6400
v_lshl_add_u32 v36,v38,3,v19
v_mfma_f32_16x16x32_bf16 v[228:231],v[116:119],v[48:51],v[228:231]
v_xor_b32 v37,32,v36
v_xor_b32 v38,64,v36
v_mfma_f32_16x16x32_bf16 v[224:227],v[112:115],v[48:51],v[224:227]
v_bfe_u32 v19,v39,3,1
v_xor_b32 v39,96,v36
v_mfma_f32_16x16x32_bf16 a[16:19],v[112:115],v[52:55],a[16:19]
v_lshlrev_b32 v19,11,v19
v_cvt_pk_bf16_f32 v72,v72,v73
v_mfma_f32_16x16x32_bf16 a[20:23],v[116:119],v[52:55],a[20:23]
v_cvt_pk_bf16_f32 v76,v76,v77
v_cvt_pk_bf16_f32 v80,v80,v81
v_mfma_f32_16x16x32_bf16 a[68:71],v[116:119],v[56:59],a[68:71]
v_cvt_pk_bf16_f32 v84,v84,v85
v_cvt_pk_bf16_f32 v73,v74,v75
v_mfma_f32_16x16x32_bf16 a[64:67],v[112:115],v[56:59],a[64:67]
v_cvt_pk_bf16_f32 v77,v78,v79
v_cvt_pk_bf16_f32 v81,v82,v83
v_mfma_f32_16x16x32_bf16 a[112:115],v[112:115],v[40:43],a[112:115]
ds_write2st64_b64 v36,v[72:73],v[76:77] offset0:36 offset1:40
v_mfma_f32_16x16x32_bf16 a[116:119],v[116:119],v[40:43],a[116:119]
v_cvt_pk_bf16_f32 v85,v86,v87
v_cvt_pk_bf16_f32 v92,v92,v93
v_mfma_f32_16x16x32_bf16 a[120:123],v[120:123],v[40:43],a[120:123]
v_accvgpr_read_b32 v78,a66
v_accvgpr_read_b32 v79,a67
v_mfma_f32_16x16x32_bf16 a[124:127],v[124:127],v[40:43],a[124:127]
v_accvgpr_read_b32 v82,a114
ds_write2st64_b64 v37,v[80:81],v[84:85] offset0:36 offset1:40
v_pk_mul_f32 v[78:79],v[78:79],v[66:67] op_sel_hi:[1,0]
v_accvgpr_read_b32 v83,a115
v_pk_mul_f32 v[82:83],v[82:83],v[68:69] op_sel_hi:[1,0]
v_accvgpr_read_b32 v76,a64
v_accvgpr_read_b32 v77,a65
v_pk_mul_f32 v[76:77],v[76:77],v[66:67] op_sel_hi:[1,0]
v_accvgpr_read_b32 v80,a112
v_accvgpr_read_b32 v81,a113
v_pk_mul_f32 v[80:81],v[80:81],v[68:69] op_sel_hi:[1,0]
v_cvt_pk_bf16_f32 v88,v88,v89
v_cvt_pk_bf16_f32 v93,v94,v95
v_mfma_f32_16x16x32_bf16 a[76:79],v[124:127],v[56:59],a[76:79]
v_cvt_pk_bf16_f32 v89,v90,v91
ds_write2st64_b64 v38,v[88:89],v[92:93] offset0:36 offset1:40
v_accvgpr_read_b32 v86,a70
v_accvgpr_read_b32 v87,a71
v_pk_mul_f32 v[86:87],v[86:87],v[66:67] op_sel_hi:[1,0]
v_accvgpr_read_b32 v84,a68
v_accvgpr_read_b32 v85,a69
v_pk_mul_f32 v[84:85],v[84:85],v[66:67] op_sel_hi:[1,0]
v_accvgpr_read_b32 v90,a118
v_accvgpr_read_b32 v91,a119
v_pk_mul_f32 v[90:91],v[90:91],v[68:69] op_sel_hi:[1,0]
v_accvgpr_read_b32 v88,a116
v_accvgpr_read_b32 v89,a117
v_pk_mul_f32 v[88:89],v[88:89],v[68:69] op_sel_hi:[1,0]
v_cvt_pk_bf16_f32 v100,v100,v101
v_cvt_pk_bf16_f32 v96,v96,v97
v_mfma_f32_16x16x32_bf16 a[72:75],v[120:123],v[56:59],a[72:75]
v_cvt_pk_bf16_f32 v101,v102,v103
v_cvt_pk_bf16_f32 v97,v98,v99
v_mfma_f32_16x16x32_bf16 a[24:27],v[120:123],v[52:55],a[24:27]
ds_write2st64_b64 v39,v[96:97],v[100:101] offset0:36 offset1:40
v_mfma_f32_16x16x32_bf16 a[28:31],v[124:127],v[52:55],a[28:31]
v_cvt_pk_bf16_f32 v76,v76,v77
v_cvt_pk_bf16_f32 v80,v80,v81
v_mfma_f32_16x16x32_bf16 v[236:239],v[124:127],v[48:51],v[236:239]
ds_read_b128 v[156:159],v10 offset:18432
v_cvt_pk_bf16_f32 v77,v78,v79
ds_read_b128 v[104:107],v10 offset:19456
v_cvt_pk_bf16_f32 v81,v82,v83
ds_read_b128 v[108:111],v10 offset:20480
v_accvgpr_read_b32 v92,a72
ds_read_b128 v[72:75],v10 offset:21504
v_accvgpr_read_b32 v93,a73
ds_write2st64_b64 v36,v[76:77],v[80:81] offset0:36 offset1:40
v_pk_mul_f32 v[92:93],v[92:93],v[66:67] op_sel_hi:[1,0]
v_accvgpr_read_b32 v94,a74
v_accvgpr_read_b32 v95,a75
v_pk_mul_f32 v[94:95],v[94:95],v[66:67] op_sel_hi:[1,0]
v_accvgpr_read_b32 v102,a78
v_accvgpr_read_b32 v103,a79
v_pk_mul_f32 v[102:103],v[102:103],v[66:67] op_sel_hi:[1,0]
s_waitcnt lgkmcnt(4)
buffer_store_dwordx4 v[156:159],v9,s[16:19],s87 offen offset:0 nt
v_accvgpr_read_b32 v98,a122
v_accvgpr_read_b32 v99,a123
v_pk_mul_f32 v[98:99],v[98:99],v[68:69] op_sel_hi:[1,0]
v_accvgpr_read_b32 v96,a120
v_accvgpr_read_b32 v97,a121
v_pk_mul_f32 v[96:97],v[96:97],v[68:69] op_sel_hi:[1,0]
v_accvgpr_read_b32 v100,a76
v_accvgpr_read_b32 v101,a77
v_pk_mul_f32 v[100:101],v[100:101],v[66:67] op_sel_hi:[1,0]
v_accvgpr_read_b32 v78,a126
v_accvgpr_read_b32 v79,a127
s_waitcnt lgkmcnt(1)
buffer_store_dwordx4 v[104:107],v9,s[16:19],s87 offen offset:3072 nt
v_pk_mul_f32 v[78:79],v[78:79],v[68:69] op_sel_hi:[1,0]
v_accvgpr_read_b32 v76,a124
v_accvgpr_read_b32 v77,a125
v_pk_mul_f32 v[76:77],v[76:77],v[68:69] op_sel_hi:[1,0]
v_cvt_pk_bf16_f32 v84,v84,v85
v_cvt_pk_bf16_f32 v88,v88,v89
v_mfma_f32_16x16x32_bf16 v[232:235],v[120:123],v[48:51],v[232:235]
v_cvt_pk_bf16_f32 v92,v92,v93
v_cvt_pk_bf16_f32 v96,v96,v97
v_mfma_f32_16x16x32_bf16 v[184:187],v[120:123],v[44:47],v[184:187]
v_cvt_pk_bf16_f32 v85,v86,v87
v_cvt_pk_bf16_f32 v89,v90,v91
v_mfma_f32_16x16x32_bf16 v[188:191],v[124:127],v[44:47],v[188:191]
ds_write2st64_b64 v37,v[84:85],v[88:89] offset0:36 offset1:40
v_mfma_f32_16x16x32_bf16 v[192:195],v[128:131],v[44:47],v[192:195]
v_cvt_pk_bf16_f32 v100,v100,v101
v_cvt_pk_bf16_f32 v76,v76,v77
v_mfma_f32_16x16x32_bf16 v[196:199],v[132:135],v[44:47],v[196:199]
buffer_store_dwordx4 v[108:111],v9,s[16:19],s66 offen offset:0 nt
v_cvt_pk_bf16_f32 v93,v94,v95
v_cvt_pk_bf16_f32 v97,v98,v99
v_cvt_pk_bf16_f32 v101,v102,v103
v_mfma_f32_16x16x32_bf16 v[244:247],v[132:135],v[48:51],v[244:247]
v_cvt_pk_bf16_f32 v77,v78,v79
v_rcp_f32 v62,v62
v_mfma_f32_16x16x32_bf16 v[240:243],v[128:131],v[48:51],v[240:243]
v_rcp_f32 v64,v64
v_mfma_f32_16x16x32_bf16 a[32:35],v[128:131],v[52:55],a[32:35]
ds_write2st64_b64 v38,v[92:93],v[96:97] offset0:36 offset1:40
v_mfma_f32_16x16x32_bf16 a[36:39],v[132:135],v[52:55],a[36:39]
v_rcp_f32 v60,v60
v_mfma_f32_16x16x32_bf16 a[84:87],v[132:135],v[56:59],a[84:87]
buffer_store_dwordx4 v[72:75],v9,s[16:19],s66 offen offset:3072 nt
v_mfma_f32_16x16x32_bf16 a[80:83],v[128:131],v[56:59],a[80:83]
v_mfma_f32_16x16x32_bf16 a[128:131],v[128:131],v[40:43],a[128:131]
v_mfma_f32_16x16x32_bf16 a[132:135],v[132:135],v[40:43],a[132:135]
ds_write2st64_b64 v39,v[100:101],v[76:77] offset0:36 offset1:40
v_mfma_f32_16x16x32_bf16 a[136:139],v[136:139],v[40:43],a[136:139]
v_mfma_f32_16x16x32_bf16 a[140:143],v[140:143],v[40:43],a[140:143]
ds_read_b128 v[80:83],v10 offset:18432
v_accvgpr_read_b32 v108,a84
ds_read_b128 v[156:159],v10 offset:19456
v_accvgpr_read_b32 v88,a80
ds_read_b128 v[72:75],v10 offset:20480
v_accvgpr_read_b32 v89,a81
ds_read_b128 v[84:87],v10 offset:21504
v_pk_mul_f32 v[88:89],v[88:89],v[66:67] op_sel_hi:[1,0]
v_accvgpr_read_b32 v90,a82
v_accvgpr_read_b32 v91,a83
v_pk_mul_f32 v[90:91],v[90:91],v[66:67] op_sel_hi:[1,0]
v_accvgpr_read_b32 v104,a128
v_accvgpr_read_b32 v105,a129
v_pk_mul_f32 v[104:105],v[104:105],v[68:69] op_sel_hi:[1,0]
v_accvgpr_read_b32 v106,a130
v_accvgpr_read_b32 v107,a131
v_pk_mul_f32 v[106:107],v[106:107],v[68:69] op_sel_hi:[1,0]
v_accvgpr_read_b32 v109,a85
v_accvgpr_read_b32 v110,a86
v_mfma_f32_16x16x32_bf16 a[92:95],v[140:143],v[56:59],a[92:95]
s_waitcnt lgkmcnt(3)
v_accvgpr_read_b32 v111,a87
buffer_store_dwordx4 v[80:83],v9,s[16:19],s87 offen offset:128 nt
v_pk_mul_f32 v[108:109],v[108:109],v[66:67] op_sel_hi:[1,0]
v_pk_mul_f32 v[110:111],v[110:111],v[66:67] op_sel_hi:[1,0]
v_accvgpr_read_b32 v92,a132
v_accvgpr_read_b32 v93,a133
v_pk_mul_f32 v[92:93],v[92:93],v[68:69] op_sel_hi:[1,0]
v_accvgpr_read_b32 v94,a134
v_accvgpr_read_b32 v95,a135
v_pk_mul_f32 v[94:95],v[94:95],v[68:69] op_sel_hi:[1,0]
v_cvt_pk_bf16_f32 v88,v88,v89
v_cvt_pk_bf16_f32 v104,v104,v105
v_mfma_f32_16x16x32_bf16 a[88:91],v[136:139],v[56:59],a[88:91]
v_cvt_pk_bf16_f32 v89,v90,v91
v_cvt_pk_bf16_f32 v105,v106,v107
v_mfma_f32_16x16x32_bf16 a[40:43],v[136:139],v[52:55],a[40:43]
ds_write2st64_b64 v36,v[88:89],v[104:105] offset0:36 offset1:40
v_mfma_f32_16x16x32_bf16 a[44:47],v[140:143],v[52:55],a[44:47]
v_add_u32 v36,v36,v19
v_accvgpr_read_b32 v76,a136
v_mfma_f32_16x16x32_bf16 v[252:255],v[140:143],v[48:51],v[252:255]
s_waitcnt lgkmcnt(1)
buffer_store_dwordx4 v[156:159],v9,s[16:19],s87 offen offset:3200 nt
v_accvgpr_read_b32 v77,a137
v_accvgpr_read_b32 v96,a88
v_accvgpr_read_b32 v97,a89
v_pk_mul_f32 v[76:77],v[76:77],v[68:69] op_sel_hi:[1,0]
v_pk_mul_f32 v[96:97],v[96:97],v[66:67] op_sel_hi:[1,0]
v_pk_mul_f32 v[208:209],v[208:209],v[62:63] op_sel_hi:[1,0]
v_pk_mul_f32 v[224:225],v[224:225],v[62:63] op_sel_hi:[1,0]
v_pk_mul_f32 v[210:211],v[210:211],v[62:63] op_sel_hi:[1,0]
v_pk_mul_f32 v[226:227],v[226:227],v[62:63] op_sel_hi:[1,0]
v_pk_mul_f32 v[212:213],v[212:213],v[62:63] op_sel_hi:[1,0]
v_pk_mul_f32 v[228:229],v[228:229],v[62:63] op_sel_hi:[1,0]
buffer_store_dwordx4 v[72:75],v9,s[16:19],s66 offen offset:128 nt
v_pk_mul_f32 v[214:215],v[214:215],v[62:63] op_sel_hi:[1,0]
v_pk_mul_f32 v[230:231],v[230:231],v[62:63] op_sel_hi:[1,0]
v_pk_mul_f32 v[216:217],v[216:217],v[62:63] op_sel_hi:[1,0]
v_pk_mul_f32 v[232:233],v[232:233],v[62:63] op_sel_hi:[1,0]
v_pk_mul_f32 v[218:219],v[218:219],v[62:63] op_sel_hi:[1,0]
v_pk_mul_f32 v[234:235],v[234:235],v[62:63] op_sel_hi:[1,0]
v_pk_mul_f32 v[220:221],v[220:221],v[62:63] op_sel_hi:[1,0]
v_pk_mul_f32 v[236:237],v[236:237],v[62:63] op_sel_hi:[1,0]
v_pk_mul_f32 v[222:223],v[222:223],v[62:63] op_sel_hi:[1,0]
v_pk_mul_f32 v[238:239],v[238:239],v[62:63] op_sel_hi:[1,0]
v_pk_mul_f32 v[240:241],v[240:241],v[62:63] op_sel_hi:[1,0]
buffer_store_dwordx4 v[84:87],v9,s[16:19],s66 offen offset:3200 nt
v_pk_mul_f32 v[242:243],v[242:243],v[62:63] op_sel_hi:[1,0]
v_pk_mul_f32 v[244:245],v[244:245],v[62:63] op_sel_hi:[1,0]
v_pk_mul_f32 v[246:247],v[246:247],v[62:63] op_sel_hi:[1,0]
v_accvgpr_read_b32 v78,a138
v_accvgpr_read_b32 v79,a139
v_pk_mul_f32 v[78:79],v[78:79],v[68:69] op_sel_hi:[1,0]
v_accvgpr_read_b32 v100,a92
v_accvgpr_read_b32 v101,a93
v_pk_mul_f32 v[100:101],v[100:101],v[66:67] op_sel_hi:[1,0]
v_cvt_pk_bf16_f32 v108,v108,v109
v_cvt_pk_bf16_f32 v92,v92,v93
v_accvgpr_read_b32 v98,a90
v_accvgpr_read_b32 v99,a91
v_pk_mul_f32 v[98:99],v[98:99],v[66:67] op_sel_hi:[1,0]
v_accvgpr_read_b32 v88,a140
v_accvgpr_read_b32 v89,a141
v_pk_mul_f32 v[88:89],v[88:89],v[68:69] op_sel_hi:[1,0]
v_accvgpr_read_b32 v102,a94
v_accvgpr_read_b32 v103,a95
v_pk_mul_f32 v[102:103],v[102:103],v[66:67] op_sel_hi:[1,0]
v_accvgpr_read_b32 v90,a142
v_accvgpr_read_b32 v91,a143
v_pk_mul_f32 v[90:91],v[90:91],v[68:69] op_sel_hi:[1,0]
v_cvt_pk_bf16_f32 v76,v76,v77
v_cvt_pk_bf16_f32 v96,v96,v97
v_cvt_pk_bf16_f32 v109,v110,v111
v_cvt_pk_bf16_f32 v93,v94,v95
ds_write2st64_b64 v37,v[108:109],v[92:93] offset0:36 offset1:40
v_add_u32 v37,v37,v19
v_cvt_pk_bf16_f32 v100,v100,v101
v_cvt_pk_bf16_f32 v88,v88,v89
v_cvt_pk_bf16_f32 v77,v78,v79
v_cvt_pk_bf16_f32 v97,v98,v99
v_cvt_pk_bf16_f32 v101,v102,v103
v_cvt_pk_bf16_f32 v89,v90,v91
v_cvt_pk_bf16_f32 v208,v208,v209
v_cvt_pk_bf16_f32 v224,v224,v225
v_cvt_pk_bf16_f32 v212,v212,v213
v_cvt_pk_bf16_f32 v228,v228,v229
ds_write2st64_b64 v38,v[96:97],v[76:77] offset0:36 offset1:40
v_add_u32 v38,v38,v19
v_cvt_pk_bf16_f32 v209,v210,v211
v_cvt_pk_bf16_f32 v225,v226,v227
v_cvt_pk_bf16_f32 v216,v216,v217
v_cvt_pk_bf16_f32 v232,v232,v233
v_cvt_pk_bf16_f32 v213,v214,v215
v_cvt_pk_bf16_f32 v229,v230,v231
v_cvt_pk_bf16_f32 v220,v220,v221
v_cvt_pk_bf16_f32 v236,v236,v237
v_cvt_pk_bf16_f32 v217,v218,v219
v_cvt_pk_bf16_f32 v233,v234,v235
ds_write2st64_b64 v39,v[100:101],v[88:89] offset0:36 offset1:40
v_add_u32 v39,v39,v19
v_cvt_pk_bf16_f32 v221,v222,v223
v_cvt_pk_bf16_f32 v237,v238,v239
ds_read_b128 v[104:107],v10 offset:18432
v_accvgpr_read_b32 v98,a2
ds_read_b128 v[156:159],v10 offset:19456
v_accvgpr_read_b32 v99,a3
ds_read_b128 v[72:75],v10 offset:20480
v_pk_mul_f32 v[98:99],v[98:99],v[64:65] op_sel_hi:[1,0]
ds_read_b128 v[80:83],v10 offset:21504
v_accvgpr_read_b32 v90,a6
ds_write2st64_b64 v36,v[208:209],v[224:225] offset0:12 offset1:14
v_accvgpr_read_b32 v91,a7
v_pk_mul_f32 v[90:91],v[90:91],v[64:65] op_sel_hi:[1,0]
v_accvgpr_read_b32 v96,a0
v_accvgpr_read_b32 v97,a1
v_pk_mul_f32 v[96:97],v[96:97],v[64:65] op_sel_hi:[1,0]
v_accvgpr_read_b32 v88,a4
v_accvgpr_read_b32 v89,a5
s_waitcnt lgkmcnt(4)
buffer_store_dwordx4 v[104:107],v9,s[16:19],s87 offen offset:256 nt
v_pk_mul_f32 v[88:89],v[88:89],v[64:65] op_sel_hi:[1,0]
v_cvt_pk_bf16_f32 v240,v240,v241
v_accvgpr_read_b32 v100,a8
v_mfma_f32_16x16x32_bf16 v[248:251],v[136:139],v[48:51],v[248:251]
v_accvgpr_read_b32 v101,a9
v_cvt_pk_bf16_f32 v96,v96,v97
v_mfma_f32_16x16x32_bf16 v[200:203],v[136:139],v[44:47],v[200:203]
v_cvt_pk_bf16_f32 v244,v244,v245
v_accvgpr_read_b32 v102,a10
v_mfma_f32_16x16x32_bf16 v[204:207],v[140:143],v[44:47],v[204:207]
ds_write2st64_b64 v37,v[212:213],v[228:229] offset0:12 offset1:14
v_pk_mul_f32 v[100:101],v[100:101],v[64:65] op_sel_hi:[1,0]
v_pk_mul_f32 v[248:249],v[248:249],v[62:63] op_sel_hi:[1,0]
v_pk_mul_f32 v[250:251],v[250:251],v[62:63] op_sel_hi:[1,0]
s_waitcnt lgkmcnt(1)
buffer_store_dwordx4 v[156:159],v9,s[16:19],s87 offen offset:3328 nt
v_pk_mul_f32 v[252:253],v[252:253],v[62:63] op_sel_hi:[1,0]
v_pk_mul_f32 v[254:255],v[254:255],v[62:63] op_sel_hi:[1,0]
v_pk_mul_f32 v[160:161],v[160:161],v[60:61] op_sel_hi:[1,0]
v_pk_mul_f32 v[176:177],v[176:177],v[60:61] op_sel_hi:[1,0]
v_pk_mul_f32 v[162:163],v[162:163],v[60:61] op_sel_hi:[1,0]
v_pk_mul_f32 v[178:179],v[178:179],v[60:61] op_sel_hi:[1,0]
v_pk_mul_f32 v[164:165],v[164:165],v[60:61] op_sel_hi:[1,0]
v_pk_mul_f32 v[180:181],v[180:181],v[60:61] op_sel_hi:[1,0]
v_pk_mul_f32 v[166:167],v[166:167],v[60:61] op_sel_hi:[1,0]
ds_write2st64_b64 v38,v[216:217],v[232:233] offset0:12 offset1:14
v_pk_mul_f32 v[182:183],v[182:183],v[60:61] op_sel_hi:[1,0]
v_pk_mul_f32 v[168:169],v[168:169],v[60:61] op_sel_hi:[1,0]
v_pk_mul_f32 v[184:185],v[184:185],v[60:61] op_sel_hi:[1,0]
buffer_store_dwordx4 v[72:75],v9,s[16:19],s66 offen offset:256 nt
v_pk_mul_f32 v[170:171],v[170:171],v[60:61] op_sel_hi:[1,0]
v_pk_mul_f32 v[186:187],v[186:187],v[60:61] op_sel_hi:[1,0]
v_pk_mul_f32 v[172:173],v[172:173],v[60:61] op_sel_hi:[1,0]
v_pk_mul_f32 v[188:189],v[188:189],v[60:61] op_sel_hi:[1,0]
v_pk_mul_f32 v[174:175],v[174:175],v[60:61] op_sel_hi:[1,0]
v_pk_mul_f32 v[190:191],v[190:191],v[60:61] op_sel_hi:[1,0]
v_pk_mul_f32 v[192:193],v[192:193],v[60:61] op_sel_hi:[1,0]
v_pk_mul_f32 v[194:195],v[194:195],v[60:61] op_sel_hi:[1,0]
v_pk_mul_f32 v[196:197],v[196:197],v[60:61] op_sel_hi:[1,0]
ds_write2st64_b64 v39,v[220:221],v[236:237] offset0:12 offset1:14
v_pk_mul_f32 v[198:199],v[198:199],v[60:61] op_sel_hi:[1,0]
v_pk_mul_f32 v[200:201],v[200:201],v[60:61] op_sel_hi:[1,0]
v_pk_mul_f32 v[202:203],v[202:203],v[60:61] op_sel_hi:[1,0]
ds_read_b128 v[84:87],v10 offset:6144
buffer_store_dwordx4 v[80:83],v9,s[16:19],s66 offen offset:3328 nt
ds_read_b128 v[92:95],v10 offset:9216
v_pk_mul_f32 v[204:205],v[204:205],v[60:61] op_sel_hi:[1,0]
ds_read_b128 v[108:111],v10 offset:7168
v_pk_mul_f32 v[206:207],v[206:207],v[60:61] op_sel_hi:[1,0]
ds_read_b128 v[76:79],v10 offset:10240
v_accvgpr_read_b32 v103,a11
v_pk_mul_f32 v[102:103],v[102:103],v[64:65] op_sel_hi:[1,0]
v_accvgpr_read_b32 v208,a12
v_accvgpr_read_b32 v209,a13
v_pk_mul_f32 v[208:209],v[208:209],v[64:65] op_sel_hi:[1,0]
v_cvt_pk_bf16_f32 v88,v88,v89
v_cvt_pk_bf16_f32 v241,v242,v243
v_cvt_pk_bf16_f32 v97,v98,v99
ds_write2st64_b64 v36,v[240:241],v[96:97] offset0:16 offset1:24
v_accvgpr_read_b32 v210,a14
v_accvgpr_read_b32 v211,a15
v_pk_mul_f32 v[210:211],v[210:211],v[64:65] op_sel_hi:[1,0]
s_waitcnt lgkmcnt(4)
buffer_store_dwordx4 v[84:87],v9,s[16:19],s85 offen offset:0 nt
v_cvt_pk_bf16_f32 v245,v246,v247
v_cvt_pk_bf16_f32 v100,v100,v101
v_cvt_pk_bf16_f32 v248,v248,v249
v_cvt_pk_bf16_f32 v89,v90,v91
v_cvt_pk_bf16_f32 v252,v252,v253
v_cvt_pk_bf16_f32 v208,v208,v209
v_cvt_pk_bf16_f32 v101,v102,v103
v_cvt_pk_bf16_f32 v249,v250,v251
v_cvt_pk_bf16_f32 v253,v254,v255
ds_write2st64_b64 v37,v[244:245],v[88:89] offset0:16 offset1:24
v_cvt_pk_bf16_f32 v209,v210,v211
v_accvgpr_read_b32 v104,a16
v_accvgpr_read_b32 v105,a17
s_waitcnt lgkmcnt(1)
buffer_store_dwordx4 v[92:95],v9,s[16:19],s85 offen offset:3072 nt
v_pk_mul_f32 v[104:105],v[104:105],v[64:65] op_sel_hi:[1,0]
v_accvgpr_read_b32 v212,a32
v_accvgpr_read_b32 v213,a33
v_pk_mul_f32 v[212:213],v[212:213],v[64:65] op_sel_hi:[1,0]
v_accvgpr_read_b32 v214,a34
v_accvgpr_read_b32 v215,a35
v_pk_mul_f32 v[214:215],v[214:215],v[64:65] op_sel_hi:[1,0]
v_accvgpr_read_b32 v106,a18
v_accvgpr_read_b32 v107,a19
ds_write2st64_b64 v38,v[248:249],v[100:101] offset0:16 offset1:24
v_pk_mul_f32 v[106:107],v[106:107],v[64:65] op_sel_hi:[1,0]
v_accvgpr_read_b32 v228,a20
v_accvgpr_read_b32 v229,a21
buffer_store_dwordx4 v[108:111],v9,s[16:19],s85 offen offset:128 nt
v_pk_mul_f32 v[228:229],v[228:229],v[64:65] op_sel_hi:[1,0]
v_accvgpr_read_b32 v216,a36
v_accvgpr_read_b32 v217,a37
v_pk_mul_f32 v[216:217],v[216:217],v[64:65] op_sel_hi:[1,0]
v_accvgpr_read_b32 v230,a22
v_accvgpr_read_b32 v231,a23
v_pk_mul_f32 v[230:231],v[230:231],v[64:65] op_sel_hi:[1,0]
v_accvgpr_read_b32 v218,a38
v_accvgpr_read_b32 v219,a39
ds_write2st64_b64 v39,v[252:253],v[208:209] offset0:16 offset1:24
v_pk_mul_f32 v[218:219],v[218:219],v[64:65] op_sel_hi:[1,0]
v_accvgpr_read_b32 v232,a24
v_accvgpr_read_b32 v233,a25
ds_read_b128 v[224:227],v10 offset:8192
buffer_store_dwordx4 v[76:79],v9,s[16:19],s85 offen offset:3200 nt
ds_read_b128 v[156:159],v10 offset:11264
v_pk_mul_f32 v[232:233],v[232:233],v[64:65] op_sel_hi:[1,0]
ds_read_b128 v[72:75],v10 offset:12288
v_accvgpr_read_b32 v220,a40
ds_read_b128 v[80:83],v10 offset:15360
v_accvgpr_read_b32 v221,a41
v_pk_mul_f32 v[220:221],v[220:221],v[64:65] op_sel_hi:[1,0]
v_cvt_pk_bf16_f32 v104,v104,v105
v_cvt_pk_bf16_f32 v212,v212,v213
v_accvgpr_read_b32 v234,a26
v_accvgpr_read_b32 v235,a27
v_pk_mul_f32 v[234:235],v[234:235],v[64:65] op_sel_hi:[1,0]
v_accvgpr_read_b32 v222,a42
v_accvgpr_read_b32 v223,a43
v_pk_mul_f32 v[222:223],v[222:223],v[64:65] op_sel_hi:[1,0]
v_accvgpr_read_b32 v236,a28
v_accvgpr_read_b32 v237,a29
v_pk_mul_f32 v[236:237],v[236:237],v[64:65] op_sel_hi:[1,0]
v_accvgpr_read_b32 v96,a44
v_accvgpr_read_b32 v97,a45
s_waitcnt lgkmcnt(3)
buffer_store_dwordx4 v[224:227],v9,s[16:19],s85 offen offset:256 nt
v_pk_mul_f32 v[96:97],v[96:97],v[64:65] op_sel_hi:[1,0]
v_cvt_pk_bf16_f32 v228,v228,v229
v_cvt_pk_bf16_f32 v216,v216,v217
v_cvt_pk_bf16_f32 v105,v106,v107
v_cvt_pk_bf16_f32 v213,v214,v215
v_accvgpr_read_b32 v238,a30
v_accvgpr_read_b32 v239,a31
v_pk_mul_f32 v[238:239],v[238:239],v[64:65] op_sel_hi:[1,0]
v_accvgpr_read_b32 v98,a46
ds_write2st64_b64 v36,v[104:105],v[212:213] offset0:26 offset1:28
v_accvgpr_read_b32 v99,a47
v_pk_mul_f32 v[98:99],v[98:99],v[64:65] op_sel_hi:[1,0]
v_cvt_pk_bf16_f32 v232,v232,v233
s_waitcnt lgkmcnt(1)
buffer_store_dwordx4 v[156:159],v9,s[16:19],s85 offen offset:3328 nt
v_cvt_pk_bf16_f32 v220,v220,v221
v_cvt_pk_bf16_f32 v229,v230,v231
v_cvt_pk_bf16_f32 v217,v218,v219
v_cvt_pk_bf16_f32 v236,v236,v237
v_cvt_pk_bf16_f32 v96,v96,v97
v_cvt_pk_bf16_f32 v233,v234,v235
v_cvt_pk_bf16_f32 v221,v222,v223
v_cvt_pk_bf16_f32 v237,v238,v239
v_cvt_pk_bf16_f32 v97,v98,v99
ds_write2st64_b64 v37,v[228:229],v[216:217] offset0:26 offset1:28
v_cvt_pk_bf16_f32 v160,v160,v161
v_cvt_pk_bf16_f32 v176,v176,v177
v_cvt_pk_bf16_f32 v164,v164,v165
buffer_store_dwordx4 v[72:75],v9,s[16:19],s86 offen offset:0 nt
v_cvt_pk_bf16_f32 v180,v180,v181
v_cvt_pk_bf16_f32 v161,v162,v163
v_cvt_pk_bf16_f32 v177,v178,v179
v_cvt_pk_bf16_f32 v168,v168,v169
v_cvt_pk_bf16_f32 v184,v184,v185
v_cvt_pk_bf16_f32 v165,v166,v167
v_cvt_pk_bf16_f32 v181,v182,v183
v_cvt_pk_bf16_f32 v172,v172,v173
v_cvt_pk_bf16_f32 v188,v188,v189
ds_write2st64_b64 v38,v[232:233],v[220:221] offset0:26 offset1:28
v_cvt_pk_bf16_f32 v169,v170,v171
v_cvt_pk_bf16_f32 v185,v186,v187
v_cvt_pk_bf16_f32 v173,v174,v175
buffer_store_dwordx4 v[80:83],v9,s[16:19],s86 offen offset:3072 nt
v_cvt_pk_bf16_f32 v189,v190,v191
v_cvt_pk_bf16_f32 v192,v192,v193
v_cvt_pk_bf16_f32 v196,v196,v197
v_cvt_pk_bf16_f32 v193,v194,v195
v_cvt_pk_bf16_f32 v200,v200,v201
v_cvt_pk_bf16_f32 v197,v198,v199
v_cvt_pk_bf16_f32 v204,v204,v205
v_cvt_pk_bf16_f32 v201,v202,v203
v_cvt_pk_bf16_f32 v205,v206,v207
ds_write2st64_b64 v39,v[236:237],v[96:97] offset0:26 offset1:28
ds_read_b128 v[240:243],v10 offset:13312
ds_read_b128 v[76:79],v10 offset:16384
ds_read_b128 v[84:87],v10 offset:14336
ds_read_b128 v[88:91],v10 offset:17408
ds_write2st64_b64 v36,v[160:161],v[176:177] offset0:0 offset1:2
s_waitcnt lgkmcnt(4)
buffer_store_dwordx4 v[240:243],v9,s[16:19],s86 offen offset:128 nt
ds_write2st64_b64 v37,v[164:165],v[180:181] offset0:0 offset1:2
s_waitcnt lgkmcnt(1)
buffer_store_dwordx4 v[76:79],v9,s[16:19],s86 offen offset:3200 nt
ds_write2st64_b64 v38,v[168:169],v[184:185] offset0:0 offset1:2
buffer_store_dwordx4 v[84:87],v9,s[16:19],s86 offen offset:256 nt
ds_write2st64_b64 v39,v[172:173],v[188:189] offset0:0 offset1:2
ds_read_b128 v[92:95],v10 offset:0
buffer_store_dwordx4 v[88:91],v9,s[16:19],s86 offen offset:3328 nt
ds_read_b128 v[108:111],v10 offset:3072
ds_read_b128 v[244:247],v10 offset:1024
ds_read_b128 v[100:103],v10 offset:4096
ds_write_b64 v36,v[192:193] offset:2048
ds_write_b64 v37,v[196:197] offset:2048
s_waitcnt lgkmcnt(5)
buffer_store_dwordx4 v[92:95],v9,s[16:19],s84 offen offset:0 nt
ds_write_b64 v38,v[200:201] offset:2048
s_waitcnt lgkmcnt(2)
buffer_store_dwordx4 v[108:111],v9,s[16:19],s84 offen offset:3072 nt
ds_write_b64 v39,v[204:205] offset:2048
ds_read_b128 v[248:251],v10 offset:2048
buffer_store_dwordx4 v[244:247],v9,s[16:19],s84 offen offset:128 nt
ds_read_b128 v[208:211],v10 offset:5120
buffer_store_dwordx4 v[100:103],v9,s[16:19],s84 offen offset:3200 nt
s_waitcnt lgkmcnt(1)
buffer_store_dwordx4 v[248:251],v9,s[16:19],s84 offen offset:256 nt
s_waitcnt lgkmcnt(0)
buffer_store_dwordx4 v[208:211],v9,s[16:19],s84 offen offset:3328 nt
s_branch L_fin
L_end4:
s_waitcnt lgkmcnt(3)
v_mfma_f32_16x16x32_bf16 v[160:163],v[112:115],v[20:23],v[160:163]
ds_read_b64_tr_b16 v[128:129],v2 offset:24704
v_fma_f32 v82,v82,s36,v14
v_mfma_f32_16x16x32_bf16 v[164:167],v[116:119],v[20:23],v[164:167]
ds_read_b64_tr_b16 v[130:131],v2 offset:30848
v_fma_f32 v83,v83,s36,v14
v_mfma_f32_16x16x32_bf16 v[212:215],v[116:119],v[24:27],v[212:215]
ds_read_b64_tr_b16 v[132:133],v3 offset:24704
v_fma_f32 v88,v88,s36,v15
v_mfma_f32_16x16x32_bf16 v[208:211],v[112:115],v[24:27],v[208:211]
ds_read_b64_tr_b16 v[134:135],v3 offset:30848
v_fma_f32 v89,v89,s36,v15
v_mfma_f32_16x16x32_bf16 a[0:3],v[112:115],v[28:31],a[0:3]
ds_read_b64_tr_b16 v[136:137],v4 offset:24704
v_fma_f32 v90,v90,s36,v15
v_mfma_f32_16x16x32_bf16 a[4:7],v[116:119],v[28:31],a[4:7]
ds_read_b64_tr_b16 v[138:139],v4 offset:30848
ds_read_b64_tr_b16 v[140:141],v5 offset:24704
ds_read_b64_tr_b16 v[142:143],v5 offset:30848
v_mfma_f32_16x16x32_bf16 a[52:55],v[116:119],v[32:35],a[52:55]
ds_read_b64_tr_b16 v[116:117],v3 offset:24832
v_fma_f32 v91,v91,s36,v15
v_mfma_f32_16x16x32_bf16 a[48:51],v[112:115],v[32:35],a[48:51]
s_waitcnt lgkmcnt(8)
ds_read_b64_tr_b16 v[112:113],v2 offset:24832
v_fma_f32 v96,v96,s36,v16
v_mfma_f32_16x16x32_bf16 a[56:59],v[120:123],v[32:35],a[56:59]
ds_read_b64_tr_b16 v[114:115],v2 offset:30976
v_fma_f32 v97,v97,s36,v16
v_mfma_f32_16x16x32_bf16 a[60:63],v[124:127],v[32:35],a[60:63]
ds_read_b64_tr_b16 v[118:119],v3 offset:30976
v_fma_f32 v98,v98,s36,v16
v_mfma_f32_16x16x32_bf16 a[12:15],v[124:127],v[28:31],a[12:15]
v_fma_f32 v99,v99,s36,v16
v_fma_f32 v76,v76,s36,v13
v_mfma_f32_16x16x32_bf16 a[8:11],v[120:123],v[28:31],a[8:11]
v_fma_f32 v77,v77,s36,v13
v_fma_f32 v78,v78,s36,v13
v_mfma_f32_16x16x32_bf16 v[216:219],v[120:123],v[24:27],v[216:219]
v_fma_f32 v79,v79,s36,v13
v_fma_f32 v84,v84,s36,v14
v_mfma_f32_16x16x32_bf16 v[220:223],v[124:127],v[24:27],v[220:223]
v_fma_f32 v85,v85,s36,v14
v_fma_f32 v86,v86,s36,v14
v_mfma_f32_16x16x32_bf16 v[172:175],v[124:127],v[20:23],v[172:175]
ds_read_b64_tr_b16 v[124:125],v5 offset:24832
v_fma_f32 v87,v87,s36,v14
v_mfma_f32_16x16x32_bf16 v[168:171],v[120:123],v[20:23],v[168:171]
s_waitcnt lgkmcnt(2)
ds_read_b64_tr_b16 v[120:121],v4 offset:24832
v_fma_f32 v92,v92,s36,v15
v_mfma_f32_16x16x32_bf16 v[176:179],v[128:131],v[20:23],v[176:179]
ds_read_b64_tr_b16 v[122:123],v4 offset:30976
v_fma_f32 v93,v93,s36,v15
v_mfma_f32_16x16x32_bf16 v[180:183],v[132:135],v[20:23],v[180:183]
ds_read_b64_tr_b16 v[126:127],v5 offset:30976
v_fma_f32 v94,v94,s36,v15
v_mfma_f32_16x16x32_bf16 v[228:231],v[132:135],v[24:27],v[228:231]
v_fma_f32 v95,v95,s36,v15
v_fma_f32 v100,v100,s36,v16
v_mfma_f32_16x16x32_bf16 v[224:227],v[128:131],v[24:27],v[224:227]
v_fma_f32 v101,v101,s36,v16
v_fma_f32 v102,v102,s36,v16
v_mfma_f32_16x16x32_bf16 a[16:19],v[128:131],v[28:31],a[16:19]
v_fma_f32 v103,v103,s36,v16
v_exp_f32 v82,v82
v_mfma_f32_16x16x32_bf16 a[20:23],v[132:135],v[28:31],a[20:23]
v_exp_f32 v83,v83
v_mfma_f32_16x16x32_bf16 a[68:71],v[132:135],v[32:35],a[68:71]
v_exp_f32 v88,v88
v_mfma_f32_16x16x32_bf16 a[64:67],v[128:131],v[32:35],a[64:67]
v_exp_f32 v89,v89
v_mfma_f32_16x16x32_bf16 a[72:75],v[136:139],v[32:35],a[72:75]
v_exp_f32 v90,v90
v_mfma_f32_16x16x32_bf16 a[76:79],v[140:143],v[32:35],a[76:79]
v_exp_f32 v91,v91
v_mfma_f32_16x16x32_bf16 a[28:31],v[140:143],v[28:31],a[28:31]
v_exp_f32 v96,v96
v_mfma_f32_16x16x32_bf16 a[24:27],v[136:139],v[28:31],a[24:27]
v_exp_f32 v97,v97
v_mfma_f32_16x16x32_bf16 v[232:235],v[136:139],v[24:27],v[232:235]
v_exp_f32 v98,v98
v_mfma_f32_16x16x32_bf16 v[236:239],v[140:143],v[24:27],v[236:239]
v_exp_f32 v99,v99
v_mfma_f32_16x16x32_bf16 v[188:191],v[140:143],v[20:23],v[188:191]
v_exp_f32 v76,v76
v_mfma_f32_16x16x32_bf16 v[184:187],v[136:139],v[20:23],v[184:187]
v_exp_f32 v77,v77
v_mfma_f32_16x16x32_bf16 v[192:195],v[112:115],v[20:23],v[192:195]
s_waitcnt lgkmcnt(0)
v_exp_f32 v78,v78
v_mfma_f32_16x16x32_bf16 v[196:199],v[116:119],v[20:23],v[196:199]
v_exp_f32 v79,v79
v_mfma_f32_16x16x32_bf16 v[244:247],v[116:119],v[24:27],v[244:247]
v_exp_f32 v84,v84
v_mfma_f32_16x16x32_bf16 v[240:243],v[112:115],v[24:27],v[240:243]
v_exp_f32 v85,v85
v_mfma_f32_16x16x32_bf16 a[32:35],v[112:115],v[28:31],a[32:35]
v_exp_f32 v86,v86
v_mfma_f32_16x16x32_bf16 a[36:39],v[116:119],v[28:31],a[36:39]
v_exp_f32 v87,v87
v_mfma_f32_16x16x32_bf16 a[84:87],v[116:119],v[32:35],a[84:87]
v_exp_f32 v92,v92
s_waitcnt vmcnt(14)
s_barrier
v_mfma_f32_16x16x32_bf16 a[80:83],v[112:115],v[32:35],a[80:83]
v_exp_f32 v93,v93
v_mfma_f32_16x16x32_bf16 a[88:91],v[120:123],v[32:35],a[88:91]
v_exp_f32 v94,v94
v_mfma_f32_16x16x32_bf16 a[92:95],v[124:127],v[32:35],a[92:95]
v_exp_f32 v95,v95
v_mfma_f32_16x16x32_bf16 a[44:47],v[124:127],v[28:31],a[44:47]
v_exp_f32 v100,v100
v_mfma_f32_16x16x32_bf16 a[40:43],v[120:123],v[28:31],a[40:43]
v_exp_f32 v101,v101
v_mfma_f32_16x16x32_bf16 v[248:251],v[120:123],v[24:27],v[248:251]
v_exp_f32 v102,v102
v_mfma_f32_16x16x32_bf16 v[252:255],v[124:127],v[24:27],v[252:255]
v_exp_f32 v103,v103
v_mfma_f32_16x16x32_bf16 v[204:207],v[124:127],v[20:23],v[204:207]
v_cvt_pk_bf16_f32 v49,v82,v83
v_cvt_pk_bf16_f32 v52,v88,v89
v_mfma_f32_16x16x32_bf16 v[200:203],v[120:123],v[20:23],v[200:203]
v_cvt_pk_bf16_f32 v53,v90,v91
v_cvt_pk_bf16_f32 v56,v96,v97
v_cvt_pk_bf16_f32 v57,v98,v99
v_cvt_pk_bf16_f32 v46,v76,v77
v_cvt_pk_bf16_f32 v47,v78,v79
v_cvt_pk_bf16_f32 v50,v84,v85
v_cvt_pk_bf16_f32 v51,v86,v87
v_cvt_pk_bf16_f32 v54,v92,v93
v_cvt_pk_bf16_f32 v55,v94,v95
v_smfmac_f32_16x16x64_bf16 v[60:63],v[152:155],v[44:51],v18
ds_read_b64_tr_b16 v[128:129],v2 offset:0
ds_read_b64_tr_b16 v[130:131],v2 offset:6144
v_cvt_pk_bf16_f32 v58,v100,v101
v_cvt_pk_bf16_f32 v59,v102,v103
v_subrev_u32 v10,18432,v10
ds_read_b64_tr_b16 v[132:133],v3 offset:0
v_smfmac_f32_16x16x64_bf16 v[64:67],v[152:155],v[52:59],v18
ds_read_b64_tr_b16 v[134:135],v3 offset:6144
ds_read_b64_tr_b16 v[136:137],v4 offset:0
ds_read_b64_tr_b16 v[138:139],v4 offset:6144
ds_read_b64_tr_b16 v[140:141],v5 offset:0
ds_read_b64_tr_b16 v[142:143],v5 offset:6144
s_waitcnt lgkmcnt(6)
v_mfma_f32_16x16x32_bf16 v[160:163],v[128:131],v[44:47],v[160:163]
s_waitcnt vmcnt(6)
ds_read_b64_tr_b16 v[112:113],v2 offset:128
v_mbcnt_lo_u32_b32 v39,-1,0
s_waitcnt lgkmcnt(5)
v_mfma_f32_16x16x32_bf16 v[164:167],v[132:135],v[44:47],v[164:167]
s_add_u32 s84,s42,0
ds_read_b64_tr_b16 v[114:115],v2 offset:6272
v_mbcnt_hi_u32_b32 v39,-1,v39
v_mfma_f32_16x16x32_bf16 v[212:215],v[132:135],v[48:51],v[212:215]
s_add_u32 s85,s42,6144
ds_read_b64_tr_b16 v[116:117],v3 offset:128
v_and_b32 v38,7,v39
v_mfma_f32_16x16x32_bf16 v[208:211],v[128:131],v[48:51],v[208:211]
s_add_u32 s86,s42,12288
ds_read_b64_tr_b16 v[118:119],v3 offset:6272
v_add_f32 v60,v60,v61
v_mfma_f32_16x16x32_bf16 a[0:3],v[128:131],v[52:55],a[0:3]
s_add_u32 s87,s42,18432
ds_read_b64_tr_b16 v[120:121],v4 offset:128
v_add_f32 v62,v62,v63
v_mfma_f32_16x16x32_bf16 a[4:7],v[132:135],v[52:55],a[4:7]
ds_read_b64_tr_b16 v[122:123],v4 offset:6272
ds_read_b64_tr_b16 v[124:125],v5 offset:128
ds_read_b64_tr_b16 v[126:127],v5 offset:6272
v_mfma_f32_16x16x32_bf16 a[52:55],v[132:135],v[56:59],a[52:55]
ds_read_b64_tr_b16 v[132:133],v3 offset:256
v_add_f32 v64,v64,v65
v_mfma_f32_16x16x32_bf16 a[48:51],v[128:131],v[56:59],a[48:51]
s_waitcnt lgkmcnt(8)
ds_read_b64_tr_b16 v[128:129],v2 offset:256
v_add_f32 v66,v66,v67
v_mfma_f32_16x16x32_bf16 a[56:59],v[136:139],v[56:59],a[56:59]
ds_read_b64_tr_b16 v[130:131],v2 offset:6400
v_max3_f32 v19,v60,v62,v64
v_mfma_f32_16x16x32_bf16 a[60:63],v[140:143],v[56:59],a[60:63]
ds_read_b64_tr_b16 v[134:135],v3 offset:6400
v_max_f32 v19,v19,v66
v_mfma_f32_16x16x32_bf16 a[12:15],v[140:143],v[52:55],a[12:15]
v_rcp_f32 v66,v66
v_mfma_f32_16x16x32_bf16 a[8:11],v[136:139],v[52:55],a[8:11]
v_accvgpr_read_b32 v80,a52
v_accvgpr_read_b32 v81,a53
v_mfma_f32_16x16x32_bf16 v[216:219],v[136:139],v[48:51],v[216:219]
v_accvgpr_read_b32 v82,a54
v_accvgpr_read_b32 v83,a55
v_mfma_f32_16x16x32_bf16 v[220:223],v[140:143],v[48:51],v[220:223]
v_accvgpr_read_b32 v72,a48
v_accvgpr_read_b32 v73,a49
v_mfma_f32_16x16x32_bf16 v[172:175],v[140:143],v[44:47],v[172:175]
ds_read_b64_tr_b16 v[140:141],v5 offset:256
v_accvgpr_read_b32 v74,a50
v_mfma_f32_16x16x32_bf16 v[168:171],v[136:139],v[44:47],v[168:171]
s_waitcnt lgkmcnt(2)
ds_read_b64_tr_b16 v[136:137],v4 offset:256
v_accvgpr_read_b32 v75,a51
v_mfma_f32_16x16x32_bf16 v[176:179],v[112:115],v[44:47],v[176:179]
ds_read_b64_tr_b16 v[138:139],v4 offset:6400
v_accvgpr_read_b32 v88,a56
v_mfma_f32_16x16x32_bf16 v[180:183],v[116:119],v[44:47],v[180:183]
ds_read_b64_tr_b16 v[142:143],v5 offset:6400
v_accvgpr_read_b32 v89,a57
v_mfma_f32_16x16x32_bf16 v[228:231],v[116:119],v[48:51],v[228:231]
v_accvgpr_read_b32 v90,a58
v_accvgpr_read_b32 v91,a59
v_mfma_f32_16x16x32_bf16 v[224:227],v[112:115],v[48:51],v[224:227]
v_accvgpr_read_b32 v96,a60
v_accvgpr_read_b32 v97,a61
v_mfma_f32_16x16x32_bf16 a[16:19],v[112:115],v[52:55],a[16:19]
v_accvgpr_read_b32 v98,a62
v_accvgpr_read_b32 v99,a63
v_mfma_f32_16x16x32_bf16 a[20:23],v[116:119],v[52:55],a[20:23]
v_cmp_ngt_f32 vcc,s37,v19
v_lshrrev_b32 v19,5,v39
v_mfma_f32_16x16x32_bf16 a[68:71],v[116:119],v[56:59],a[68:71]
v_xor_b32 v38,v38,v19
v_and_b32 v19,15,v39
v_mfma_f32_16x16x32_bf16 a[64:67],v[112:115],v[56:59],a[64:67]
s_cmp_lg_u64 vcc,0
v_lshl_add_u32 v19,v19,7,s24
v_lshl_add_u32 v19,v38,4,v19
v_mfma_f32_16x16x32_bf16 a[72:75],v[120:123],v[56:59],a[72:75]
s_cselect_b32 s62,s32,0
v_bfe_u32 v38,v39,4,1
v_lshl_add_u32 v36,v38,3,v19
v_mfma_f32_16x16x32_bf16 a[76:79],v[124:127],v[56:59],a[76:79]
s_or_b32 s31,s31,s62
v_xor_b32 v37,32,v36
v_bfe_u32 v19,v39,3,1
v_mfma_f32_16x16x32_bf16 a[28:31],v[124:127],v[52:55],a[28:31]
s_lshl_b32 s32,s32,1
v_xor_b32 v38,64,v36
v_xor_b32 v39,96,v36
v_lshlrev_b32 v19,11,v19
v_accvgpr_read_b32 v84,a68
v_accvgpr_read_b32 v85,a69
v_pk_mul_f32 v[72:73],v[72:73],v[66:67] op_sel_hi:[1,0]
v_pk_mul_f32 v[74:75],v[74:75],v[66:67] op_sel_hi:[1,0]
v_pk_mul_f32 v[80:81],v[80:81],v[66:67] op_sel_hi:[1,0]
v_pk_mul_f32 v[82:83],v[82:83],v[66:67] op_sel_hi:[1,0]
v_pk_mul_f32 v[84:85],v[84:85],v[66:67] op_sel_hi:[1,0]
v_accvgpr_read_b32 v86,a70
v_accvgpr_read_b32 v87,a71
v_pk_mul_f32 v[86:87],v[86:87],v[66:67] op_sel_hi:[1,0]
v_accvgpr_read_b32 v76,a64
v_accvgpr_read_b32 v77,a65
v_pk_mul_f32 v[76:77],v[76:77],v[66:67] op_sel_hi:[1,0]
v_accvgpr_read_b32 v78,a66
v_accvgpr_read_b32 v79,a67
v_pk_mul_f32 v[78:79],v[78:79],v[66:67] op_sel_hi:[1,0]
v_accvgpr_read_b32 v92,a72
v_accvgpr_read_b32 v93,a73
v_mfma_f32_16x16x32_bf16 a[24:27],v[120:123],v[52:55],a[24:27]
v_accvgpr_read_b32 v94,a74
v_accvgpr_read_b32 v95,a75
v_accvgpr_read_b32 v100,a76
v_accvgpr_read_b32 v101,a77
v_accvgpr_read_b32 v102,a78
v_pk_mul_f32 v[88:89],v[88:89],v[66:67] op_sel_hi:[1,0]
v_pk_mul_f32 v[90:91],v[90:91],v[66:67] op_sel_hi:[1,0]
v_pk_mul_f32 v[92:93],v[92:93],v[66:67] op_sel_hi:[1,0]
v_pk_mul_f32 v[94:95],v[94:95],v[66:67] op_sel_hi:[1,0]
v_accvgpr_read_b32 v103,a79
v_cvt_pk_bf16_f32 v72,v72,v73
v_mfma_f32_16x16x32_bf16 v[232:235],v[120:123],v[48:51],v[232:235]
v_cvt_pk_bf16_f32 v76,v76,v77
v_cvt_pk_bf16_f32 v80,v80,v81
v_cvt_pk_bf16_f32 v84,v84,v85
v_cvt_pk_bf16_f32 v73,v74,v75
v_cvt_pk_bf16_f32 v77,v78,v79
ds_write2st64_b64 v36,v[72:73],v[76:77] offset0:36 offset1:40
v_pk_mul_f32 v[96:97],v[96:97],v[66:67] op_sel_hi:[1,0]
v_pk_mul_f32 v[98:99],v[98:99],v[66:67] op_sel_hi:[1,0]
v_pk_mul_f32 v[100:101],v[100:101],v[66:67] op_sel_hi:[1,0]
v_pk_mul_f32 v[102:103],v[102:103],v[66:67] op_sel_hi:[1,0]
v_cvt_pk_bf16_f32 v88,v88,v89
v_cvt_pk_bf16_f32 v92,v92,v93
v_mfma_f32_16x16x32_bf16 v[236:239],v[124:127],v[48:51],v[236:239]
v_cvt_pk_bf16_f32 v81,v82,v83
v_cvt_pk_bf16_f32 v85,v86,v87
v_mfma_f32_16x16x32_bf16 v[188:191],v[124:127],v[44:47],v[188:191]
v_cvt_pk_bf16_f32 v96,v96,v97
v_cvt_pk_bf16_f32 v100,v100,v101
v_mfma_f32_16x16x32_bf16 v[184:187],v[120:123],v[44:47],v[184:187]
ds_write2st64_b64 v37,v[80:81],v[84:85] offset0:36 offset1:40
v_mfma_f32_16x16x32_bf16 v[192:195],v[128:131],v[44:47],v[192:195]
s_waitcnt lgkmcnt(1)
v_cvt_pk_bf16_f32 v89,v90,v91
v_cvt_pk_bf16_f32 v93,v94,v95
v_mfma_f32_16x16x32_bf16 v[196:199],v[132:135],v[44:47],v[196:199]
v_cvt_pk_bf16_f32 v97,v98,v99
v_cvt_pk_bf16_f32 v101,v102,v103
v_mfma_f32_16x16x32_bf16 v[244:247],v[132:135],v[48:51],v[244:247]
v_rcp_f32 v62,v62
v_mfma_f32_16x16x32_bf16 v[240:243],v[128:131],v[48:51],v[240:243]
ds_write2st64_b64 v38,v[88:89],v[92:93] offset0:36 offset1:40
v_mfma_f32_16x16x32_bf16 a[32:35],v[128:131],v[52:55],a[32:35]
v_rcp_f32 v64,v64
v_mfma_f32_16x16x32_bf16 a[36:39],v[132:135],v[52:55],a[36:39]
v_rcp_f32 v60,v60
v_mfma_f32_16x16x32_bf16 a[84:87],v[132:135],v[56:59],a[84:87]
v_mfma_f32_16x16x32_bf16 a[80:83],v[128:131],v[56:59],a[80:83]
ds_write2st64_b64 v39,v[96:97],v[100:101] offset0:36 offset1:40
v_mfma_f32_16x16x32_bf16 a[88:91],v[136:139],v[56:59],a[88:91]
v_mfma_f32_16x16x32_bf16 a[92:95],v[140:143],v[56:59],a[92:95]
ds_read_b128 v[156:159],v10 offset:18432
v_mfma_f32_16x16x32_bf16 a[44:47],v[140:143],v[52:55],a[44:47]
ds_read_b128 v[104:107],v10 offset:19456
ds_read_b128 v[108:111],v10 offset:20480
v_accvgpr_read_b32 v80,a84
ds_read_b128 v[72:75],v10 offset:21504
v_accvgpr_read_b32 v81,a85
v_pk_mul_f32 v[80:81],v[80:81],v[66:67] op_sel_hi:[1,0]
v_accvgpr_read_b32 v82,a86
v_accvgpr_read_b32 v83,a87
v_pk_mul_f32 v[82:83],v[82:83],v[66:67] op_sel_hi:[1,0]
v_accvgpr_read_b32 v76,a80
v_accvgpr_read_b32 v77,a81
v_pk_mul_f32 v[76:77],v[76:77],v[66:67] op_sel_hi:[1,0]
v_accvgpr_read_b32 v78,a82
v_accvgpr_read_b32 v79,a83
v_pk_mul_f32 v[78:79],v[78:79],v[66:67] op_sel_hi:[1,0]
v_accvgpr_read_b32 v84,a88
v_accvgpr_read_b32 v85,a89
v_mfma_f32_16x16x32_bf16 a[40:43],v[136:139],v[52:55],a[40:43]
s_waitcnt lgkmcnt(3)
v_accvgpr_read_b32 v86,a90
buffer_store_dwordx4 v[156:159],v9,s[16:19],s87 offen offset:0 nt
v_pk_mul_f32 v[84:85],v[84:85],v[66:67] op_sel_hi:[1,0]
v_accvgpr_read_b32 v87,a91
v_pk_mul_f32 v[86:87],v[86:87],v[66:67] op_sel_hi:[1,0]
v_cvt_pk_bf16_f32 v76,v76,v77
v_accvgpr_read_b32 v88,a92
v_mfma_f32_16x16x32_bf16 v[248:251],v[136:139],v[48:51],v[248:251]
v_accvgpr_read_b32 v89,a93
v_cvt_pk_bf16_f32 v80,v80,v81
v_cvt_pk_bf16_f32 v77,v78,v79
ds_write_b64 v36,v[76:77] offset:18432
s_waitcnt lgkmcnt(1)
buffer_store_dwordx4 v[104:107],v9,s[16:19],s87 offen offset:3072 nt
v_pk_mul_f32 v[88:89],v[88:89],v[66:67] op_sel_hi:[1,0]
v_pk_mul_f32 v[208:209],v[208:209],v[62:63] op_sel_hi:[1,0]
v_pk_mul_f32 v[224:225],v[224:225],v[62:63] op_sel_hi:[1,0]
v_pk_mul_f32 v[210:211],v[210:211],v[62:63] op_sel_hi:[1,0]
v_pk_mul_f32 v[226:227],v[226:227],v[62:63] op_sel_hi:[1,0]
v_pk_mul_f32 v[212:213],v[212:213],v[62:63] op_sel_hi:[1,0]
v_pk_mul_f32 v[228:229],v[228:229],v[62:63] op_sel_hi:[1,0]
v_pk_mul_f32 v[214:215],v[214:215],v[62:63] op_sel_hi:[1,0]
v_pk_mul_f32 v[230:231],v[230:231],v[62:63] op_sel_hi:[1,0]
v_pk_mul_f32 v[216:217],v[216:217],v[62:63] op_sel_hi:[1,0]
v_pk_mul_f32 v[232:233],v[232:233],v[62:63] op_sel_hi:[1,0]
buffer_store_dwordx4 v[108:111],v9,s[16:19],s87 offen offset:128 nt
v_pk_mul_f32 v[218:219],v[218:219],v[62:63] op_sel_hi:[1,0]
v_pk_mul_f32 v[234:235],v[234:235],v[62:63] op_sel_hi:[1,0]
v_pk_mul_f32 v[220:221],v[220:221],v[62:63] op_sel_hi:[1,0]
v_pk_mul_f32 v[236:237],v[236:237],v[62:63] op_sel_hi:[1,0]
v_pk_mul_f32 v[222:223],v[222:223],v[62:63] op_sel_hi:[1,0]
v_pk_mul_f32 v[238:239],v[238:239],v[62:63] op_sel_hi:[1,0]
v_pk_mul_f32 v[240:241],v[240:241],v[62:63] op_sel_hi:[1,0]
v_pk_mul_f32 v[242:243],v[242:243],v[62:63] op_sel_hi:[1,0]
v_pk_mul_f32 v[244:245],v[244:245],v[62:63] op_sel_hi:[1,0]
v_pk_mul_f32 v[246:247],v[246:247],v[62:63] op_sel_hi:[1,0]
v_add_u32 v36,v36,v19
buffer_store_dwordx4 v[72:75],v9,s[16:19],s87 offen offset:3200 nt
v_accvgpr_read_b32 v90,a94
v_accvgpr_read_b32 v91,a95
v_pk_mul_f32 v[90:91],v[90:91],v[66:67] op_sel_hi:[1,0]
v_cvt_pk_bf16_f32 v84,v84,v85
v_cvt_pk_bf16_f32 v81,v82,v83
v_cvt_pk_bf16_f32 v88,v88,v89
v_cvt_pk_bf16_f32 v85,v86,v87
v_cvt_pk_bf16_f32 v89,v90,v91
v_cvt_pk_bf16_f32 v208,v208,v209
ds_write_b64 v37,v[80:81] offset:18432
v_add_u32 v37,v37,v19
v_cvt_pk_bf16_f32 v224,v224,v225
v_cvt_pk_bf16_f32 v212,v212,v213
v_cvt_pk_bf16_f32 v228,v228,v229
ds_write_b64 v38,v[84:85] offset:18432
v_add_u32 v38,v38,v19
v_cvt_pk_bf16_f32 v209,v210,v211
v_cvt_pk_bf16_f32 v225,v226,v227
v_cvt_pk_bf16_f32 v216,v216,v217
ds_write_b64 v39,v[88:89] offset:18432
ds_read_b128 v[92:95],v10 offset:18432
v_add_u32 v39,v39,v19
ds_read_b128 v[96:99],v10 offset:19456
v_cvt_pk_bf16_f32 v232,v232,v233
ds_write2st64_b64 v36,v[208:209],v[224:225] offset0:12 offset1:14
v_cvt_pk_bf16_f32 v213,v214,v215
v_cvt_pk_bf16_f32 v229,v230,v231
v_cvt_pk_bf16_f32 v220,v220,v221
v_cvt_pk_bf16_f32 v236,v236,v237
v_cvt_pk_bf16_f32 v217,v218,v219
v_cvt_pk_bf16_f32 v233,v234,v235
v_cvt_pk_bf16_f32 v221,v222,v223
v_cvt_pk_bf16_f32 v237,v238,v239
v_accvgpr_read_b32 v104,a4
v_accvgpr_read_b32 v105,a5
v_pk_mul_f32 v[104:105],v[104:105],v[64:65] op_sel_hi:[1,0]
ds_write2st64_b64 v37,v[212:213],v[228:229] offset0:12 offset1:14
v_accvgpr_read_b32 v106,a6
v_accvgpr_read_b32 v107,a7
v_pk_mul_f32 v[106:107],v[106:107],v[64:65] op_sel_hi:[1,0]
s_waitcnt lgkmcnt(2)
buffer_store_dwordx4 v[92:95],v9,s[16:19],s87 offen offset:256 nt
v_accvgpr_read_b32 v82,a2
v_accvgpr_read_b32 v83,a3
v_pk_mul_f32 v[82:83],v[82:83],v[64:65] op_sel_hi:[1,0]
v_accvgpr_read_b32 v80,a0
v_accvgpr_read_b32 v81,a1
v_pk_mul_f32 v[80:81],v[80:81],v[64:65] op_sel_hi:[1,0]
v_accvgpr_read_b32 v108,a8
v_accvgpr_read_b32 v109,a9
v_mfma_f32_16x16x32_bf16 v[252:255],v[140:143],v[48:51],v[252:255]
v_cvt_pk_bf16_f32 v240,v240,v241
v_cvt_pk_bf16_f32 v80,v80,v81
v_mfma_f32_16x16x32_bf16 v[204:207],v[140:143],v[44:47],v[204:207]
ds_write2st64_b64 v38,v[216:217],v[232:233] offset0:12 offset1:14
v_mfma_f32_16x16x32_bf16 v[200:203],v[136:139],v[44:47],v[200:203]
v_accvgpr_read_b32 v110,a10
buffer_store_dwordx4 v[96:99],v9,s[16:19],s87 offen offset:3328 nt
v_pk_mul_f32 v[248:249],v[248:249],v[62:63] op_sel_hi:[1,0]
v_pk_mul_f32 v[108:109],v[108:109],v[64:65] op_sel_hi:[1,0]
v_pk_mul_f32 v[250:251],v[250:251],v[62:63] op_sel_hi:[1,0]
v_pk_mul_f32 v[252:253],v[252:253],v[62:63] op_sel_hi:[1,0]
v_pk_mul_f32 v[254:255],v[254:255],v[62:63] op_sel_hi:[1,0]
v_pk_mul_f32 v[160:161],v[160:161],v[60:61] op_sel_hi:[1,0]
v_pk_mul_f32 v[176:177],v[176:177],v[60:61] op_sel_hi:[1,0]
v_pk_mul_f32 v[162:163],v[162:163],v[60:61] op_sel_hi:[1,0]
v_pk_mul_f32 v[178:179],v[178:179],v[60:61] op_sel_hi:[1,0]
ds_write2st64_b64 v39,v[220:221],v[236:237] offset0:12 offset1:14
v_pk_mul_f32 v[164:165],v[164:165],v[60:61] op_sel_hi:[1,0]
v_pk_mul_f32 v[180:181],v[180:181],v[60:61] op_sel_hi:[1,0]
v_pk_mul_f32 v[166:167],v[166:167],v[60:61] op_sel_hi:[1,0]
ds_read_b128 v[100:103],v10 offset:6144
v_pk_mul_f32 v[182:183],v[182:183],v[60:61] op_sel_hi:[1,0]
ds_read_b128 v[76:79],v10 offset:9216
v_pk_mul_f32 v[168:169],v[168:169],v[60:61] op_sel_hi:[1,0]
ds_read_b128 v[156:159],v10 offset:7168
v_pk_mul_f32 v[184:185],v[184:185],v[60:61] op_sel_hi:[1,0]
ds_read_b128 v[72:75],v10 offset:10240
v_pk_mul_f32 v[170:171],v[170:171],v[60:61] op_sel_hi:[1,0]
v_pk_mul_f32 v[186:187],v[186:187],v[60:61] op_sel_hi:[1,0]
v_pk_mul_f32 v[172:173],v[172:173],v[60:61] op_sel_hi:[1,0]
v_pk_mul_f32 v[188:189],v[188:189],v[60:61] op_sel_hi:[1,0]
v_pk_mul_f32 v[174:175],v[174:175],v[60:61] op_sel_hi:[1,0]
v_pk_mul_f32 v[190:191],v[190:191],v[60:61] op_sel_hi:[1,0]
v_pk_mul_f32 v[192:193],v[192:193],v[60:61] op_sel_hi:[1,0]
v_pk_mul_f32 v[194:195],v[194:195],v[60:61] op_sel_hi:[1,0]
v_pk_mul_f32 v[196:197],v[196:197],v[60:61] op_sel_hi:[1,0]
v_pk_mul_f32 v[198:199],v[198:199],v[60:61] op_sel_hi:[1,0]
v_pk_mul_f32 v[200:201],v[200:201],v[60:61] op_sel_hi:[1,0]
v_pk_mul_f32 v[202:203],v[202:203],v[60:61] op_sel_hi:[1,0]
v_pk_mul_f32 v[204:205],v[204:205],v[60:61] op_sel_hi:[1,0]
v_pk_mul_f32 v[206:207],v[206:207],v[60:61] op_sel_hi:[1,0]
v_accvgpr_read_b32 v111,a11
s_waitcnt lgkmcnt(3)
buffer_store_dwordx4 v[100:103],v9,s[16:19],s85 offen offset:0 nt
v_pk_mul_f32 v[110:111],v[110:111],v[64:65] op_sel_hi:[1,0]
v_cvt_pk_bf16_f32 v244,v244,v245
v_accvgpr_read_b32 v84,a12
v_accvgpr_read_b32 v85,a13
v_pk_mul_f32 v[84:85],v[84:85],v[64:65] op_sel_hi:[1,0]
v_cvt_pk_bf16_f32 v104,v104,v105
v_cvt_pk_bf16_f32 v241,v242,v243
v_cvt_pk_bf16_f32 v81,v82,v83
v_accvgpr_read_b32 v86,a14
ds_write2st64_b64 v36,v[240:241],v[80:81] offset0:16 offset1:24
v_accvgpr_read_b32 v87,a15
v_pk_mul_f32 v[86:87],v[86:87],v[64:65] op_sel_hi:[1,0]
v_cvt_pk_bf16_f32 v248,v248,v249
s_waitcnt lgkmcnt(1)
buffer_store_dwordx4 v[76:79],v9,s[16:19],s85 offen offset:3072 nt
v_cvt_pk_bf16_f32 v108,v108,v109
v_cvt_pk_bf16_f32 v245,v246,v247
v_cvt_pk_bf16_f32 v105,v106,v107
v_cvt_pk_bf16_f32 v252,v252,v253
v_cvt_pk_bf16_f32 v84,v84,v85
v_cvt_pk_bf16_f32 v249,v250,v251
v_cvt_pk_bf16_f32 v109,v110,v111
v_cvt_pk_bf16_f32 v253,v254,v255
v_cvt_pk_bf16_f32 v85,v86,v87
ds_write2st64_b64 v37,v[244:245],v[104:105] offset0:16 offset1:24
v_accvgpr_read_b32 v212,a32
v_accvgpr_read_b32 v213,a33
v_pk_mul_f32 v[212:213],v[212:213],v[64:65] op_sel_hi:[1,0]
buffer_store_dwordx4 v[156:159],v9,s[16:19],s85 offen offset:128 nt
v_accvgpr_read_b32 v96,a16
v_accvgpr_read_b32 v97,a17
v_pk_mul_f32 v[96:97],v[96:97],v[64:65] op_sel_hi:[1,0]
v_accvgpr_read_b32 v214,a34
v_accvgpr_read_b32 v215,a35
v_pk_mul_f32 v[214:215],v[214:215],v[64:65] op_sel_hi:[1,0]
v_accvgpr_read_b32 v228,a20
v_accvgpr_read_b32 v229,a21
v_pk_mul_f32 v[228:229],v[228:229],v[64:65] op_sel_hi:[1,0]
ds_write2st64_b64 v38,v[248:249],v[108:109] offset0:16 offset1:24
v_accvgpr_read_b32 v216,a36
v_accvgpr_read_b32 v217,a37
v_pk_mul_f32 v[216:217],v[216:217],v[64:65] op_sel_hi:[1,0]
buffer_store_dwordx4 v[72:75],v9,s[16:19],s85 offen offset:3200 nt
v_accvgpr_read_b32 v98,a18
v_accvgpr_read_b32 v99,a19
v_pk_mul_f32 v[98:99],v[98:99],v[64:65] op_sel_hi:[1,0]
v_accvgpr_read_b32 v230,a22
v_accvgpr_read_b32 v231,a23
v_pk_mul_f32 v[230:231],v[230:231],v[64:65] op_sel_hi:[1,0]
v_accvgpr_read_b32 v218,a38
v_accvgpr_read_b32 v219,a39
v_pk_mul_f32 v[218:219],v[218:219],v[64:65] op_sel_hi:[1,0]
ds_write2st64_b64 v39,v[252:253],v[84:85] offset0:16 offset1:24
v_accvgpr_read_b32 v232,a24
v_accvgpr_read_b32 v233,a25
v_pk_mul_f32 v[232:233],v[232:233],v[64:65] op_sel_hi:[1,0]
ds_read_b128 v[88:91],v10 offset:8192
v_accvgpr_read_b32 v220,a40
ds_read_b128 v[208:211],v10 offset:11264
v_accvgpr_read_b32 v221,a41
ds_read_b128 v[224:227],v10 offset:12288
v_pk_mul_f32 v[220:221],v[220:221],v[64:65] op_sel_hi:[1,0]
ds_read_b128 v[92:95],v10 offset:15360
v_cvt_pk_bf16_f32 v212,v212,v213
v_cvt_pk_bf16_f32 v96,v96,v97
v_accvgpr_read_b32 v234,a26
v_accvgpr_read_b32 v235,a27
v_pk_mul_f32 v[234:235],v[234:235],v[64:65] op_sel_hi:[1,0]
v_accvgpr_read_b32 v222,a42
v_accvgpr_read_b32 v223,a43
v_pk_mul_f32 v[222:223],v[222:223],v[64:65] op_sel_hi:[1,0]
v_accvgpr_read_b32 v236,a28
v_accvgpr_read_b32 v237,a29
v_pk_mul_f32 v[236:237],v[236:237],v[64:65] op_sel_hi:[1,0]
v_accvgpr_read_b32 v80,a44
v_accvgpr_read_b32 v81,a45
v_pk_mul_f32 v[80:81],v[80:81],v[64:65] op_sel_hi:[1,0]
v_cvt_pk_bf16_f32 v228,v228,v229
s_waitcnt lgkmcnt(3)
buffer_store_dwordx4 v[88:91],v9,s[16:19],s85 offen offset:256 nt
v_cvt_pk_bf16_f32 v216,v216,v217
v_cvt_pk_bf16_f32 v213,v214,v215
v_cvt_pk_bf16_f32 v97,v98,v99
v_accvgpr_read_b32 v238,a30
v_accvgpr_read_b32 v239,a31
v_pk_mul_f32 v[238:239],v[238:239],v[64:65] op_sel_hi:[1,0]
v_accvgpr_read_b32 v82,a46
v_accvgpr_read_b32 v83,a47
v_pk_mul_f32 v[82:83],v[82:83],v[64:65] op_sel_hi:[1,0]
ds_write2st64_b64 v36,v[96:97],v[212:213] offset0:26 offset1:28
v_cvt_pk_bf16_f32 v232,v232,v233
v_cvt_pk_bf16_f32 v220,v220,v221
v_cvt_pk_bf16_f32 v229,v230,v231
s_waitcnt lgkmcnt(1)
buffer_store_dwordx4 v[208:211],v9,s[16:19],s85 offen offset:3328 nt
v_cvt_pk_bf16_f32 v217,v218,v219
v_cvt_pk_bf16_f32 v236,v236,v237
v_cvt_pk_bf16_f32 v80,v80,v81
v_cvt_pk_bf16_f32 v233,v234,v235
v_cvt_pk_bf16_f32 v221,v222,v223
v_cvt_pk_bf16_f32 v237,v238,v239
v_cvt_pk_bf16_f32 v81,v82,v83
v_cvt_pk_bf16_f32 v160,v160,v161
v_cvt_pk_bf16_f32 v176,v176,v177
ds_write2st64_b64 v37,v[228:229],v[216:217] offset0:26 offset1:28
v_cvt_pk_bf16_f32 v164,v164,v165
v_cvt_pk_bf16_f32 v180,v180,v181
v_cvt_pk_bf16_f32 v161,v162,v163
buffer_store_dwordx4 v[224:227],v9,s[16:19],s86 offen offset:0 nt
v_cvt_pk_bf16_f32 v177,v178,v179
v_cvt_pk_bf16_f32 v168,v168,v169
v_cvt_pk_bf16_f32 v184,v184,v185
v_cvt_pk_bf16_f32 v165,v166,v167
v_cvt_pk_bf16_f32 v181,v182,v183
v_cvt_pk_bf16_f32 v172,v172,v173
v_cvt_pk_bf16_f32 v188,v188,v189
v_cvt_pk_bf16_f32 v169,v170,v171
v_cvt_pk_bf16_f32 v185,v186,v187
ds_write2st64_b64 v38,v[232:233],v[220:221] offset0:26 offset1:28
v_cvt_pk_bf16_f32 v173,v174,v175
v_cvt_pk_bf16_f32 v189,v190,v191
v_cvt_pk_bf16_f32 v192,v192,v193
buffer_store_dwordx4 v[92:95],v9,s[16:19],s86 offen offset:3072 nt
v_cvt_pk_bf16_f32 v196,v196,v197
v_cvt_pk_bf16_f32 v193,v194,v195
v_cvt_pk_bf16_f32 v200,v200,v201
v_cvt_pk_bf16_f32 v197,v198,v199
v_cvt_pk_bf16_f32 v204,v204,v205
v_cvt_pk_bf16_f32 v201,v202,v203
v_cvt_pk_bf16_f32 v205,v206,v207
ds_write2st64_b64 v39,v[236:237],v[80:81] offset0:26 offset1:28
ds_read_b128 v[240:243],v10 offset:13312
ds_read_b128 v[156:159],v10 offset:16384
ds_read_b128 v[72:75],v10 offset:14336
ds_read_b128 v[76:79],v10 offset:17408
ds_write2st64_b64 v36,v[160:161],v[176:177] offset0:0 offset1:2
s_waitcnt lgkmcnt(4)
buffer_store_dwordx4 v[240:243],v9,s[16:19],s86 offen offset:128 nt
ds_write2st64_b64 v37,v[164:165],v[180:181] offset0:0 offset1:2
s_waitcnt lgkmcnt(1)
buffer_store_dwordx4 v[156:159],v9,s[16:19],s86 offen offset:3200 nt
ds_write2st64_b64 v38,v[168:169],v[184:185] offset0:0 offset1:2
buffer_store_dwordx4 v[72:75],v9,s[16:19],s86 offen offset:256 nt
ds_write2st64_b64 v39,v[172:173],v[188:189] offset0:0 offset1:2
ds_read_b128 v[100:103],v10 offset:0
buffer_store_dwordx4 v[76:79],v9,s[16:19],s86 offen offset:3328 nt
ds_read_b128 v[104:107],v10 offset:3072
ds_read_b128 v[244:247],v10 offset:1024
ds_read_b128 v[108:111],v10 offset:4096
ds_write_b64 v36,v[192:193] offset:2048
ds_write_b64 v37,v[196:197] offset:2048
s_waitcnt lgkmcnt(5)
buffer_store_dwordx4 v[100:103],v9,s[16:19],s84 offen offset:0 nt
ds_write_b64 v38,v[200:201] offset:2048
s_waitcnt lgkmcnt(2)
buffer_store_dwordx4 v[104:107],v9,s[16:19],s84 offen offset:3072 nt
ds_write_b64 v39,v[204:205] offset:2048
ds_read_b128 v[248:251],v10 offset:2048
buffer_store_dwordx4 v[244:247],v9,s[16:19],s84 offen offset:128 nt
ds_read_b128 v[84:87],v10 offset:5120
buffer_store_dwordx4 v[108:111],v9,s[16:19],s84 offen offset:3200 nt
s_waitcnt lgkmcnt(1)
buffer_store_dwordx4 v[248:251],v9,s[16:19],s84 offen offset:256 nt
s_waitcnt lgkmcnt(0)
buffer_store_dwordx4 v[84:87],v9,s[16:19],s84 offen offset:3328 nt
s_branch L_fin
L_fin:
s_waitcnt vmcnt(0)
L_stamped:
s_cmp_lg_u32 s31,0
s_cbranch_scc1 L_fix
L_done:
L_end:
s_endpgm
L_fix:
s_sub_u32 s62,s24,36864
v_add_u32 v112,s62,v2
v_add_u32 v113,s62,v3
v_add_u32 v114,s62,v4
v_add_u32 v115,s62,v5
v_mbcnt_lo_u32_b32 v19,-1,0
v_mbcnt_hi_u32_b32 v19,-1,v19
v_and_b32 v157,15,v19
v_mul_u32_u24 v157,384,v157
v_lshrrev_b32 v158,4,v19
v_lshl_add_u32 v159,v158,3,v157
v_lshl_add_u32 v157,v158,4,v157
L_fix_pass:
s_ff1_i32_b32 s50,s31
s_bitset0_b32 s31,s50
s_lshl_b32 s62,s50,5
s_add_u32 s62,s62,s34
s_mul_i32 s63,s62,171
s_lshr_b32 s63,s63,9
s_mul_i32 s64,s63,3
s_sub_u32 s62,s62,s64
s_add_u32 s63,s63,s33
s_mul_i32 s30,s63,196608
s_mul_i32 s41,s63,325632
s_lshl_b32 s63,s3,2
s_add_u32 s64,s63,21
s_cmp_eq_u32 s3,0
s_cselect_b32 s64,20,s64
s_cselect_b32 s40,1,0
s_add_u32 s65,s63,37
s_cmp_eq_u32 s62,2
s_cselect_b32 s64,s65,s64
s_cselect_b32 s40,0,s40
s_add_u32 s65,s63,s3
s_cmp_eq_u32 s62,0
s_cselect_b32 s64,s65,s64
s_cselect_b32 s40,1,s40
s_mul_i32 s64,s64,6144
s_add_u32 s41,s41,s64
s_add_u32 s55,s40,4
s_mov_b32 s51,0
L_fix_tile:
buffer_load_dwordx4 a[144:147],v157,s[12:15],s41 offen offset:0
buffer_load_dwordx4 a[148:151],v157,s[12:15],s41 offen offset:64
buffer_load_dwordx4 a[152:155],v157,s[12:15],s41 offen offset:128
buffer_load_dwordx4 a[156:159],v157,s[12:15],s41 offen offset:192
buffer_load_dwordx4 a[160:163],v157,s[12:15],s41 offen offset:256
buffer_load_dwordx4 a[164:167],v157,s[12:15],s41 offen offset:320
v_mov_b32 v156,0xff800000
s_mov_b32 s53,s30
s_mov_b32 s52,0
L_fix_max:
s_mov_b32 s63,s53
s_add_u32 m0,s24,0
s_nop 0
buffer_load_dwordx4 v6,s[4:7],s63 offen offset:0 lds
buffer_load_dwordx4 v7,s[4:7],s63 offen offset:1024 lds
buffer_load_dwordx4 v8,s[4:7],s63 offen offset:2048 lds
s_add_u32 s63,s63,3072
s_add_u32 m0,s24,3072
s_nop 0
buffer_load_dwordx4 v6,s[4:7],s63 offen offset:0 lds
buffer_load_dwordx4 v7,s[4:7],s63 offen offset:1024 lds
buffer_load_dwordx4 v8,s[4:7],s63 offen offset:2048 lds
s_add_u32 s63,s63,3072
s_add_u32 m0,s24,6144
s_nop 0
buffer_load_dwordx4 v6,s[4:7],s63 offen offset:0 lds
buffer_load_dwordx4 v7,s[4:7],s63 offen offset:1024 lds
buffer_load_dwordx4 v8,s[4:7],s63 offen offset:2048 lds
s_add_u32 s63,s63,3072
s_add_u32 m0,s24,9216
s_nop 0
buffer_load_dwordx4 v6,s[4:7],s63 offen offset:0 lds
buffer_load_dwordx4 v7,s[4:7],s63 offen offset:1024 lds
buffer_load_dwordx4 v8,s[4:7],s63 offen offset:2048 lds
s_add_u32 s63,s63,3072
s_waitcnt vmcnt(0)
ds_read_b128 a[0:3],v11 offset:0
ds_read_b128 a[4:7],v12 offset:0
ds_read_b128 a[8:11],v11 offset:128
ds_read_b128 a[12:15],v12 offset:128
ds_read_b128 a[16:19],v11 offset:256
ds_read_b128 a[20:23],v12 offset:256
ds_read_b128 a[24:27],v11 offset:6144
ds_read_b128 a[28:31],v12 offset:6144
ds_read_b128 a[32:35],v11 offset:6272
ds_read_b128 a[36:39],v12 offset:6272
ds_read_b128 a[40:43],v11 offset:6400
ds_read_b128 a[44:47],v12 offset:6400
s_waitcnt lgkmcnt(0)
v_mfma_f32_16x16x32_bf16 v[72:75],a[0:3],a[144:147],0
v_mfma_f32_16x16x32_bf16 v[72:75],a[4:7],a[148:151],v[72:75]
v_mfma_f32_16x16x32_bf16 v[72:75],a[8:11],a[152:155],v[72:75]
v_mfma_f32_16x16x32_bf16 v[72:75],a[12:15],a[156:159],v[72:75]
v_mfma_f32_16x16x32_bf16 v[72:75],a[16:19],a[160:163],v[72:75]
v_mfma_f32_16x16x32_bf16 v[72:75],a[20:23],a[164:167],v[72:75]
v_mfma_f32_16x16x32_bf16 v[76:79],a[24:27],a[144:147],0
v_mfma_f32_16x16x32_bf16 v[76:79],a[28:31],a[148:151],v[76:79]
v_mfma_f32_16x16x32_bf16 v[76:79],a[32:35],a[152:155],v[76:79]
v_mfma_f32_16x16x32_bf16 v[76:79],a[36:39],a[156:159],v[76:79]
v_mfma_f32_16x16x32_bf16 v[76:79],a[40:43],a[160:163],v[76:79]
v_mfma_f32_16x16x32_bf16 v[76:79],a[44:47],a[164:167],v[76:79]
s_nop 7
v_max3_f32 v156,v156,v72,v73
v_max3_f32 v156,v156,v74,v75
v_max3_f32 v156,v156,v76,v77
v_max3_f32 v156,v156,v78,v79
s_add_u32 s53,s53,12288
s_add_u32 s52,s52,1
s_cmp_lt_u32 s52,16
s_cbranch_scc1 L_fix_max
v_mov_b32 v19,v156
s_nop 1
v_permlane32_swap_b32 v19,v156
v_max_f32 v156,v156,v19
v_mov_b32 v19,v156
s_nop 1
v_permlane16_swap_b32 v19,v156
v_max_f32 v156,v156,v19
v_mul_f32_e64 v13,-s36,v156
v_mov_b32 v160,0
v_mov_b32 v161,0
v_mov_b32 v162,0
v_mov_b32 v163,0
v_mov_b32 v164,0
v_mov_b32 v165,0
v_mov_b32 v166,0
v_mov_b32 v167,0
v_mov_b32 v168,0
v_mov_b32 v169,0
v_mov_b32 v170,0
v_mov_b32 v171,0
v_mov_b32 v172,0
v_mov_b32 v173,0
v_mov_b32 v174,0
v_mov_b32 v175,0
v_mov_b32 v176,0
v_mov_b32 v177,0
v_mov_b32 v178,0
v_mov_b32 v179,0
v_mov_b32 v180,0
v_mov_b32 v181,0
v_mov_b32 v182,0
v_mov_b32 v183,0
v_mov_b32 v184,0
v_mov_b32 v185,0
v_mov_b32 v186,0
v_mov_b32 v187,0
v_mov_b32 v188,0
v_mov_b32 v189,0
v_mov_b32 v190,0
v_mov_b32 v191,0
v_mov_b32 v192,0
v_mov_b32 v193,0
v_mov_b32 v194,0
v_mov_b32 v195,0
v_mov_b32 v196,0
v_mov_b32 v197,0
v_mov_b32 v198,0
v_mov_b32 v199,0
v_mov_b32 v200,0
v_mov_b32 v201,0
v_mov_b32 v202,0
v_mov_b32 v203,0
v_mov_b32 v204,0
v_mov_b32 v205,0
v_mov_b32 v206,0
v_mov_b32 v207,0
v_mov_b32 v60,0
v_mov_b32 v24,0
v_mov_b32 v61,0
v_mov_b32 v25,0
v_mov_b32 v62,0
v_mov_b32 v26,0
v_mov_b32 v63,0
v_mov_b32 v27,0
s_mov_b32 s53,s30
s_mov_b32 s52,0
L_fix_acc:
s_mov_b32 s63,s53
s_add_u32 m0,s24,0
s_nop 0
buffer_load_dwordx4 v6,s[4:7],s63 offen offset:0 lds
buffer_load_dwordx4 v7,s[4:7],s63 offen offset:1024 lds
buffer_load_dwordx4 v8,s[4:7],s63 offen offset:2048 lds
s_add_u32 s63,s63,3072
s_add_u32 m0,s24,3072
s_nop 0
buffer_load_dwordx4 v6,s[4:7],s63 offen offset:0 lds
buffer_load_dwordx4 v7,s[4:7],s63 offen offset:1024 lds
buffer_load_dwordx4 v8,s[4:7],s63 offen offset:2048 lds
s_add_u32 s63,s63,3072
s_add_u32 m0,s24,6144
s_nop 0
buffer_load_dwordx4 v6,s[4:7],s63 offen offset:0 lds
buffer_load_dwordx4 v7,s[4:7],s63 offen offset:1024 lds
buffer_load_dwordx4 v8,s[4:7],s63 offen offset:2048 lds
s_add_u32 s63,s63,3072
s_add_u32 m0,s24,9216
s_nop 0
buffer_load_dwordx4 v6,s[4:7],s63 offen offset:0 lds
buffer_load_dwordx4 v7,s[4:7],s63 offen offset:1024 lds
buffer_load_dwordx4 v8,s[4:7],s63 offen offset:2048 lds
s_add_u32 s63,s63,3072
s_waitcnt vmcnt(0)
ds_read_b128 a[0:3],v11 offset:0
ds_read_b128 a[4:7],v12 offset:0
ds_read_b128 a[8:11],v11 offset:128
ds_read_b128 a[12:15],v12 offset:128
ds_read_b128 a[16:19],v11 offset:256
ds_read_b128 a[20:23],v12 offset:256
ds_read_b128 a[24:27],v11 offset:6144
ds_read_b128 a[28:31],v12 offset:6144
ds_read_b128 a[32:35],v11 offset:6272
ds_read_b128 a[36:39],v12 offset:6272
ds_read_b128 a[40:43],v11 offset:6400
ds_read_b128 a[44:47],v12 offset:6400
s_waitcnt lgkmcnt(0)
v_mfma_f32_16x16x32_bf16 v[72:75],a[0:3],a[144:147],0
v_mfma_f32_16x16x32_bf16 v[72:75],a[4:7],a[148:151],v[72:75]
v_mfma_f32_16x16x32_bf16 v[72:75],a[8:11],a[152:155],v[72:75]
v_mfma_f32_16x16x32_bf16 v[72:75],a[12:15],a[156:159],v[72:75]
v_mfma_f32_16x16x32_bf16 v[72:75],a[16:19],a[160:163],v[72:75]
v_mfma_f32_16x16x32_bf16 v[72:75],a[20:23],a[164:167],v[72:75]
v_mfma_f32_16x16x32_bf16 v[76:79],a[24:27],a[144:147],0
v_mfma_f32_16x16x32_bf16 v[76:79],a[28:31],a[148:151],v[76:79]
v_mfma_f32_16x16x32_bf16 v[76:79],a[32:35],a[152:155],v[76:79]
v_mfma_f32_16x16x32_bf16 v[76:79],a[36:39],a[156:159],v[76:79]
v_mfma_f32_16x16x32_bf16 v[76:79],a[40:43],a[160:163],v[76:79]
v_mfma_f32_16x16x32_bf16 v[76:79],a[44:47],a[164:167],v[76:79]
s_nop 7
v_fma_f32 v72,v72,s36,v13
v_fma_f32 v73,v73,s36,v13
v_exp_f32 v72,v72
v_exp_f32 v73,v73
s_nop 0
v_cvt_pk_bf16_f32 v20,v72,v73
v_fma_f32 v74,v74,s36,v13
v_fma_f32 v75,v75,s36,v13
v_exp_f32 v74,v74
v_exp_f32 v75,v75
s_nop 0
v_cvt_pk_bf16_f32 v21,v74,v75
v_fma_f32 v76,v76,s36,v13
v_fma_f32 v77,v77,s36,v13
v_exp_f32 v76,v76
v_exp_f32 v77,v77
s_nop 0
v_cvt_pk_bf16_f32 v22,v76,v77
v_fma_f32 v78,v78,s36,v13
v_fma_f32 v79,v79,s36,v13
v_exp_f32 v78,v78
v_exp_f32 v79,v79
s_nop 0
v_cvt_pk_bf16_f32 v23,v78,v79
s_nop 1
v_smfmac_f32_16x16x64_bf16 v[60:63],v[152:155],v[20:27],v18
s_mov_b32 s63,s53
s_add_u32 m0,s24,0
s_nop 0
buffer_load_dwordx4 v6,s[8:11],s63 offen offset:0 lds
buffer_load_dwordx4 v7,s[8:11],s63 offen offset:1024 lds
buffer_load_dwordx4 v8,s[8:11],s63 offen offset:2048 lds
s_add_u32 s63,s63,3072
s_add_u32 m0,s24,3072
s_nop 0
buffer_load_dwordx4 v6,s[8:11],s63 offen offset:0 lds
buffer_load_dwordx4 v7,s[8:11],s63 offen offset:1024 lds
buffer_load_dwordx4 v8,s[8:11],s63 offen offset:2048 lds
s_add_u32 s63,s63,3072
s_add_u32 m0,s24,6144
s_nop 0
buffer_load_dwordx4 v6,s[8:11],s63 offen offset:0 lds
buffer_load_dwordx4 v7,s[8:11],s63 offen offset:1024 lds
buffer_load_dwordx4 v8,s[8:11],s63 offen offset:2048 lds
s_add_u32 s63,s63,3072
s_add_u32 m0,s24,9216
s_nop 0
buffer_load_dwordx4 v6,s[8:11],s63 offen offset:0 lds
buffer_load_dwordx4 v7,s[8:11],s63 offen offset:1024 lds
buffer_load_dwordx4 v8,s[8:11],s63 offen offset:2048 lds
s_add_u32 s63,s63,3072
s_waitcnt vmcnt(0)
ds_read_b64_tr_b16 a[0:1],v112 offset:0
ds_read_b64_tr_b16 a[2:3],v112 offset:6144
ds_read_b64_tr_b16 a[4:5],v113 offset:0
ds_read_b64_tr_b16 a[6:7],v113 offset:6144
ds_read_b64_tr_b16 a[8:9],v114 offset:0
ds_read_b64_tr_b16 a[10:11],v114 offset:6144
ds_read_b64_tr_b16 a[12:13],v115 offset:0
ds_read_b64_tr_b16 a[14:15],v115 offset:6144
ds_read_b64_tr_b16 a[16:17],v112 offset:128
ds_read_b64_tr_b16 a[18:19],v112 offset:6272
ds_read_b64_tr_b16 a[20:21],v113 offset:128
ds_read_b64_tr_b16 a[22:23],v113 offset:6272
ds_read_b64_tr_b16 a[24:25],v114 offset:128
ds_read_b64_tr_b16 a[26:27],v114 offset:6272
ds_read_b64_tr_b16 a[28:29],v115 offset:128
ds_read_b64_tr_b16 a[30:31],v115 offset:6272
ds_read_b64_tr_b16 a[32:33],v112 offset:256
ds_read_b64_tr_b16 a[34:35],v112 offset:6400
ds_read_b64_tr_b16 a[36:37],v113 offset:256
ds_read_b64_tr_b16 a[38:39],v113 offset:6400
ds_read_b64_tr_b16 a[40:41],v114 offset:256
ds_read_b64_tr_b16 a[42:43],v114 offset:6400
ds_read_b64_tr_b16 a[44:45],v115 offset:256
ds_read_b64_tr_b16 a[46:47],v115 offset:6400
s_waitcnt lgkmcnt(0)
v_mfma_f32_16x16x32_bf16 v[160:163],a[0:3],v[20:23],v[160:163]
v_mfma_f32_16x16x32_bf16 v[164:167],a[4:7],v[20:23],v[164:167]
v_mfma_f32_16x16x32_bf16 v[168:171],a[8:11],v[20:23],v[168:171]
v_mfma_f32_16x16x32_bf16 v[172:175],a[12:15],v[20:23],v[172:175]
v_mfma_f32_16x16x32_bf16 v[176:179],a[16:19],v[20:23],v[176:179]
v_mfma_f32_16x16x32_bf16 v[180:183],a[20:23],v[20:23],v[180:183]
v_mfma_f32_16x16x32_bf16 v[184:187],a[24:27],v[20:23],v[184:187]
v_mfma_f32_16x16x32_bf16 v[188:191],a[28:31],v[20:23],v[188:191]
v_mfma_f32_16x16x32_bf16 v[192:195],a[32:35],v[20:23],v[192:195]
v_mfma_f32_16x16x32_bf16 v[196:199],a[36:39],v[20:23],v[196:199]
v_mfma_f32_16x16x32_bf16 v[200:203],a[40:43],v[20:23],v[200:203]
v_mfma_f32_16x16x32_bf16 v[204:207],a[44:47],v[20:23],v[204:207]
s_add_u32 s53,s53,12288
s_add_u32 s52,s52,1
s_cmp_lt_u32 s52,16
s_cbranch_scc1 L_fix_acc
s_nop 7
v_add_f32 v19,v60,v61
v_rcp_f32 v19,v19
s_nop 0
v_mul_f32 v160,v160,v19
v_mul_f32 v161,v161,v19
v_mul_f32 v162,v162,v19
v_mul_f32 v163,v163,v19
v_cvt_pk_bf16_f32 v160,v160,v161
v_cvt_pk_bf16_f32 v161,v162,v163
buffer_store_dwordx2 v[160:161],v159,s[16:19],s41 offen offset:0
v_mul_f32 v164,v164,v19
v_mul_f32 v165,v165,v19
v_mul_f32 v166,v166,v19
v_mul_f32 v167,v167,v19
v_cvt_pk_bf16_f32 v164,v164,v165
v_cvt_pk_bf16_f32 v165,v166,v167
buffer_store_dwordx2 v[164:165],v159,s[16:19],s41 offen offset:32
v_mul_f32 v168,v168,v19
v_mul_f32 v169,v169,v19
v_mul_f32 v170,v170,v19
v_mul_f32 v171,v171,v19
v_cvt_pk_bf16_f32 v168,v168,v169
v_cvt_pk_bf16_f32 v169,v170,v171
buffer_store_dwordx2 v[168:169],v159,s[16:19],s41 offen offset:64
v_mul_f32 v172,v172,v19
v_mul_f32 v173,v173,v19
v_mul_f32 v174,v174,v19
v_mul_f32 v175,v175,v19
v_cvt_pk_bf16_f32 v172,v172,v173
v_cvt_pk_bf16_f32 v173,v174,v175
buffer_store_dwordx2 v[172:173],v159,s[16:19],s41 offen offset:96
v_mul_f32 v176,v176,v19
v_mul_f32 v177,v177,v19
v_mul_f32 v178,v178,v19
v_mul_f32 v179,v179,v19
v_cvt_pk_bf16_f32 v176,v176,v177
v_cvt_pk_bf16_f32 v177,v178,v179
buffer_store_dwordx2 v[176:177],v159,s[16:19],s41 offen offset:128
v_mul_f32 v180,v180,v19
v_mul_f32 v181,v181,v19
v_mul_f32 v182,v182,v19
v_mul_f32 v183,v183,v19
v_cvt_pk_bf16_f32 v180,v180,v181
v_cvt_pk_bf16_f32 v181,v182,v183
buffer_store_dwordx2 v[180:181],v159,s[16:19],s41 offen offset:160
v_mul_f32 v184,v184,v19
v_mul_f32 v185,v185,v19
v_mul_f32 v186,v186,v19
v_mul_f32 v187,v187,v19
v_cvt_pk_bf16_f32 v184,v184,v185
v_cvt_pk_bf16_f32 v185,v186,v187
buffer_store_dwordx2 v[184:185],v159,s[16:19],s41 offen offset:192
v_mul_f32 v188,v188,v19
v_mul_f32 v189,v189,v19
v_mul_f32 v190,v190,v19
v_mul_f32 v191,v191,v19
v_cvt_pk_bf16_f32 v188,v188,v189
v_cvt_pk_bf16_f32 v189,v190,v191
buffer_store_dwordx2 v[188:189],v159,s[16:19],s41 offen offset:224
v_mul_f32 v192,v192,v19
v_mul_f32 v193,v193,v19
v_mul_f32 v194,v194,v19
v_mul_f32 v195,v195,v19
v_cvt_pk_bf16_f32 v192,v192,v193
v_cvt_pk_bf16_f32 v193,v194,v195
buffer_store_dwordx2 v[192:193],v159,s[16:19],s41 offen offset:256
v_mul_f32 v196,v196,v19
v_mul_f32 v197,v197,v19
v_mul_f32 v198,v198,v19
v_mul_f32 v199,v199,v19
v_cvt_pk_bf16_f32 v196,v196,v197
v_cvt_pk_bf16_f32 v197,v198,v199
buffer_store_dwordx2 v[196:197],v159,s[16:19],s41 offen offset:288
v_mul_f32 v200,v200,v19
v_mul_f32 v201,v201,v19
v_mul_f32 v202,v202,v19
v_mul_f32 v203,v203,v19
v_cvt_pk_bf16_f32 v200,v200,v201
v_cvt_pk_bf16_f32 v201,v202,v203
buffer_store_dwordx2 v[200:201],v159,s[16:19],s41 offen offset:320
v_mul_f32 v204,v204,v19
v_mul_f32 v205,v205,v19
v_mul_f32 v206,v206,v19
v_mul_f32 v207,v207,v19
v_cvt_pk_bf16_f32 v204,v204,v205
v_cvt_pk_bf16_f32 v205,v206,v207
buffer_store_dwordx2 v[204:205],v159,s[16:19],s41 offen offset:352
s_waitcnt vmcnt(0)
s_add_u32 s41,s41,6144
s_add_u32 s51,s51,1
s_cmp_lt_u32 s51,s55
s_cbranch_scc1 L_fix_tile
s_cmp_lg_u32 s31,0
s_cbranch_scc1 L_fix_pass
s_branch L_done
L_codeend:
.section .rodata,"a"
.p2align 6
.amdhsa_kernel standalone__gqa_softmax__near_ridge_kernel
  .amdhsa_next_free_vgpr 512
  .amdhsa_next_free_sgpr 102
  .amdhsa_accum_offset 256
  .amdhsa_group_segment_fixed_size 0
  .amdhsa_kernarg_size 48
  .amdhsa_user_sgpr_count 2
  .amdhsa_user_sgpr_kernarg_segment_ptr 1
  .amdhsa_system_sgpr_workgroup_id_x 1
.end_amdhsa_kernel
```

```asm
; @launch grid=(256,1,1) block=(256,1,1) lds=163840
.amdgcn_target "amdgcn-amd-amdhsa--gfx950"
.text
.globl standalone__gqa_softmax__near_ridge_kernel
.p2align 8
.type standalone__gqa_softmax__near_ridge_kernel,@function
standalone__gqa_softmax__near_ridge_kernel:
s_cmp_ge_u32 s2,256
s_cbranch_scc1 L_end
s_load_dwordx4 s[84:87],s[0:1],0
s_load_dwordx4 s[88:91],s[0:1],16
v_lshrrev_b32 v80,6,v0
v_and_b32 v19,63,v0
v_readfirstlane_b32 s3,v80
s_lshr_b32 s34,s2,3
s_getpc_b64 s[92:93]
L_pc:
s_mul_i32 s62,s34,4096
v_min_u32 v80,31,v19
v_lshlrev_b32 v80,7,v80
v_add_u32 v80,s62,v80
v_min_u32 v80,L_codeend-L_pc-4,v80
s_cmp_lg_u32 s3,0
s_cbranch_scc1 L_nopre
global_load_dword v60,v80,s[92:93]
L_nopre:
v_lshrrev_b32 v80,3,v19
v_and_b32 v82,7,v19
v_add_u32 v81,0,v80
v_mul_u32_u24 v81,43,v81
v_lshrrev_b32 v81,7,v81
v_and_b32 v81,6,v81
v_xor_b32 v81,v81,v82
v_lshlrev_b32 v81,4,v81
v_lshl_add_u32 v6,v80,7,v81
v_add_u32 v81,8,v80
v_mul_u32_u24 v81,43,v81
v_lshrrev_b32 v81,7,v81
v_and_b32 v81,6,v81
v_xor_b32 v81,v81,v82
v_lshlrev_b32 v81,4,v81
v_lshl_add_u32 v7,v80,7,v81
v_add_u32 v81,16,v80
v_mul_u32_u24 v81,43,v81
v_lshrrev_b32 v81,7,v81
v_and_b32 v81,6,v81
v_xor_b32 v81,v81,v82
v_lshlrev_b32 v81,4,v81
v_lshl_add_u32 v8,v80,7,v81
s_mov_b32 s37,0x5d800000
s_mov_b32 s36,0x3dd53b95
s_mov_b32 s31,0
s_mov_b32 s32,1
s_and_b32 s62,s2,7
s_lshl_b32 s33,s62,6
s_mul_i32 s22,s3,3072
s_add_u32 s23,s22,36864
s_mul_i32 s24,s3,22528
s_add_u32 s24,s24,73728
s_mov_b32 s69,0
s_lshl_b32 s62,s69,5
s_add_u32 s62,s62,s34
s_mul_i32 s63,s62,171
s_lshr_b32 s63,s63,9
s_mul_i32 s64,s63,3
s_sub_u32 s62,s62,s64
s_add_u32 s63,s63,s33
s_mul_i32 s30,s63,196608
s_mul_i32 s41,s63,325632
s_lshl_b32 s63,s3,2
s_add_u32 s64,s63,21
s_cmp_eq_u32 s3,0
s_cselect_b32 s64,20,s64
s_cselect_b32 s40,1,0
s_add_u32 s65,s63,37
s_cmp_eq_u32 s62,2
s_cselect_b32 s64,s65,s64
s_cselect_b32 s40,0,s40
s_add_u32 s65,s63,s3
s_cmp_eq_u32 s62,0
s_cselect_b32 s64,s65,s64
s_cselect_b32 s40,1,s40
s_mul_i32 s64,s64,6144
s_add_u32 s41,s41,s64
s_add_u32 s20,s30,s22
s_mov_b32 s21,s20
s_waitcnt lgkmcnt(0)
s_mov_b32 s4,s86
s_and_b32 s5,s87,0xffff
s_mov_b32 s6,100663296
s_mov_b32 s7,0x20000
s_mov_b32 s12,s84
s_and_b32 s13,s85,0xffff
s_mov_b32 s14,166723584
s_mov_b32 s15,0x20000
s_mov_b32 s8,s88
s_and_b32 s9,s89,0xffff
s_mov_b32 s10,100663296
s_mov_b32 s11,0x20000
s_mov_b32 s16,s90
s_and_b32 s17,s91,0xffff
s_mov_b32 s18,166723584
s_mov_b32 s19,0x20000
s_mov_b32 s28,s41
s_add_u32 m0,s22,0
s_nop 0
buffer_load_dwordx4 v6,s[4:7],s20 offen offset:0 lds
buffer_load_dwordx4 v7,s[4:7],s20 offen offset:1024 lds
buffer_load_dwordx4 v8,s[4:7],s20 offen offset:2048 lds
s_add_u32 s20,s20,12288
s_add_u32 m0,s24,0
s_nop 0
buffer_load_dwordx4 v6,s[12:15],s28 offen offset:0 nt lds
buffer_load_dwordx4 v7,s[12:15],s28 offen offset:1024 nt lds
buffer_load_dwordx4 v8,s[12:15],s28 offen offset:2048 nt lds
s_add_u32 s28,s28,3072
s_add_u32 m0,s24,3072
s_nop 0
buffer_load_dwordx4 v6,s[12:15],s28 offen offset:0 nt lds
buffer_load_dwordx4 v7,s[12:15],s28 offen offset:1024 nt lds
buffer_load_dwordx4 v8,s[12:15],s28 offen offset:2048 nt lds
s_add_u32 s28,s28,3072
s_add_u32 m0,s22,12288
s_nop 0
buffer_load_dwordx4 v6,s[4:7],s20 offen offset:0 lds
buffer_load_dwordx4 v7,s[4:7],s20 offen offset:1024 lds
buffer_load_dwordx4 v8,s[4:7],s20 offen offset:2048 lds
s_add_u32 s20,s20,12288
s_add_u32 m0,s24,6144
s_nop 0
buffer_load_dwordx4 v6,s[12:15],s28 offen offset:0 nt lds
buffer_load_dwordx4 v7,s[12:15],s28 offen offset:1024 nt lds
buffer_load_dwordx4 v8,s[12:15],s28 offen offset:2048 nt lds
s_add_u32 s28,s28,3072
s_add_u32 m0,s24,9216
s_nop 0
buffer_load_dwordx4 v6,s[12:15],s28 offen offset:0 nt lds
buffer_load_dwordx4 v7,s[12:15],s28 offen offset:1024 nt lds
buffer_load_dwordx4 v8,s[12:15],s28 offen offset:2048 nt lds
s_add_u32 s28,s28,3072
v_and_b32 v80,15,v19
v_lshrrev_b32 v81,4,v19
v_mul_u32_u24 v0,384,v80
v_and_b32 v83,6,v80
v_xor_b32 v83,v83,v81
v_lshl_add_u32 v0,v83,4,v0
v_xor_b32 v1,64,v0
v_add_u32 v11,s24,v0
v_add_u32 v12,s24,v1
v_lshrrev_b32 v80,2,v19
v_mul_u32_u24 v2,384,v80
v_and_b32 v80,6,v80
v_bfe_u32 v83,v19,1,1
v_xor_b32 v80,v80,v83
v_lshl_add_u32 v2,v80,4,v2
v_and_b32 v83,1,v19
v_lshl_add_u32 v2,v83,3,v2
v_add_u32 v2,36864,v2
v_xor_b32 v3,32,v2
v_xor_b32 v4,64,v2
v_xor_b32 v5,96,v2
v_lshrrev_b32 v80,3,v19
v_and_b32 v81,7,v19
v_xor_b32 v83,v81,v80
v_lshl_add_u32 v10,v80,7,s24
v_lshl_add_u32 v10,v83,4,v10
v_mul_u32_u24 v9,384,v80
v_lshl_add_u32 v9,v81,4,v9
v_lshrrev_b32 v80,4,v19
v_xor_b32 v80,v80,v19
v_bfe_u32 v80,v80,1,1
v_subrev_u32 v80,1,v80
v_and_b32 v80,0x3f803f80,v80
v_accvgpr_write_b32 a152,v80
v_accvgpr_write_b32 a153,v80
v_accvgpr_write_b32 a154,v80
v_accvgpr_write_b32 a155,v80
v_and_b32 v80,1,v19
v_mul_u32_u24 v80,0xaaaa,v80
v_add_u32 v18,0x4444,v80
s_waitcnt vmcnt(6)
s_barrier
s_cmp_eq_u32 s40,0
s_cbranch_scc1 L_start4
L_start5:
s_add_u32 m0,s24,12288
s_waitcnt vmcnt(9)
ds_read_b128 a[0:3],v11 offset:0
buffer_load_dwordx4 v6,s[12:15],s28 offen offset:0 nt lds
ds_read_b128 a[4:7],v12 offset:0
buffer_load_dwordx4 v7,s[12:15],s28 offen offset:1024 nt lds
ds_read_b128 a[8:11],v11 offset:128
buffer_load_dwordx4 v8,s[12:15],s28 offen offset:2048 nt lds
s_add_u32 s28,s28,3072
s_add_u32 m0,s24,15360
ds_read_b128 a[12:15],v12 offset:128
buffer_load_dwordx4 v6,s[12:15],s28 offen offset:0 nt lds
ds_read_b128 a[16:19],v11 offset:256
buffer_load_dwordx4 v7,s[12:15],s28 offen offset:1024 nt lds
ds_read_b128 a[20:23],v12 offset:256
buffer_load_dwordx4 v8,s[12:15],s28 offen offset:2048 nt lds
s_add_u32 s28,s28,3072
s_add_u32 m0,s24,0
ds_read_b128 a[120:123],v0 offset:0
v_mov_b32 v60,0
ds_read_b128 a[124:127],v1 offset:0
v_mov_b32 v61,0
ds_read_b128 a[128:131],v0 offset:128
v_mov_b32 v62,0
ds_read_b128 a[132:135],v1 offset:128
v_mov_b32 v63,0
ds_read_b128 a[136:139],v0 offset:256
v_mov_b32 v64,0
ds_read_b128 a[140:143],v1 offset:256
v_mov_b32 v65,0
ds_read_b128 a[144:147],v0 offset:6144
v_mov_b32 v66,0
ds_read_b128 a[148:151],v1 offset:6144
v_mov_b32 v67,0
s_waitcnt lgkmcnt(7)
v_mfma_f32_16x16x32_bf16 v[72:75],a[120:123],a[0:3],0
s_waitcnt lgkmcnt(6)
ds_read_b128 a[120:123],v0 offset:6272
v_mov_b32 v68,0
v_mfma_f32_16x16x32_bf16 v[72:75],a[124:127],a[4:7],v[72:75]
s_waitcnt lgkmcnt(6)
ds_read_b128 a[124:127],v1 offset:6272
v_mov_b32 v69,0
v_mfma_f32_16x16x32_bf16 v[72:75],a[128:131],a[8:11],v[72:75]
s_waitcnt lgkmcnt(6)
ds_read_b128 a[128:131],v0 offset:6400
v_mov_b32 v70,0
v_mfma_f32_16x16x32_bf16 v[72:75],a[132:135],a[12:15],v[72:75]
s_waitcnt lgkmcnt(5)
ds_read_b128 a[132:135],v1 offset:6400
v_mov_b32 v71,0
v_mfma_f32_16x16x32_bf16 v[72:75],a[136:139],a[16:19],v[72:75]
ds_read_b128 a[136:139],v0 offset:0
v_mfma_f32_16x16x32_bf16 v[72:75],a[140:143],a[20:23],v[72:75]
s_waitcnt lgkmcnt(5)
ds_read_b128 a[140:143],v1 offset:0
v_mfma_f32_16x16x32_bf16 v[76:79],a[144:147],a[0:3],0
ds_read_b128 a[144:147],v0 offset:128
v_mfma_f32_16x16x32_bf16 v[76:79],a[148:151],a[4:7],v[76:79]
s_waitcnt lgkmcnt(6)
ds_read_b128 a[148:151],v1 offset:128
v_mfma_f32_16x16x32_bf16 v[76:79],a[120:123],a[8:11],v[76:79]
s_waitcnt lgkmcnt(6)
ds_read_b128 a[120:123],v0 offset:256
v_mfma_f32_16x16x32_bf16 v[76:79],a[124:127],a[12:15],v[76:79]
s_waitcnt lgkmcnt(6)
ds_read_b128 a[124:127],v1 offset:256
v_max3_f32 v44,v72,v73,v74
v_mfma_f32_16x16x32_bf16 v[76:79],a[128:131],a[16:19],v[76:79]
s_waitcnt lgkmcnt(6)
ds_read_b128 a[128:131],v0 offset:6144
v_mfma_f32_16x16x32_bf16 v[76:79],a[132:135],a[20:23],v[76:79]
s_waitcnt vmcnt(6)
ds_read_b128 a[24:27],v11 offset:6144
buffer_load_dwordx4 v6,s[12:15],s28 offen offset:0 nt lds
ds_read_b128 a[28:31],v12 offset:6144
buffer_load_dwordx4 v7,s[12:15],s28 offen offset:1024 nt lds
ds_read_b128 a[32:35],v11 offset:6272
buffer_load_dwordx4 v8,s[12:15],s28 offen offset:2048 nt lds
s_add_u32 s28,s28,3072
s_add_u32 m0,s24,3072
ds_read_b128 a[36:39],v12 offset:6272
buffer_load_dwordx4 v6,s[12:15],s28 offen offset:0 nt lds
ds_read_b128 a[40:43],v11 offset:6400
buffer_load_dwordx4 v7,s[12:15],s28 offen offset:1024 nt lds
ds_read_b128 a[44:47],v12 offset:6400
buffer_load_dwordx4 v8,s[12:15],s28 offen offset:2048 nt lds
s_add_u32 s28,s28,3072
s_add_u32 m0,s24,6144
ds_read_b128 a[132:135],v1 offset:6144
v_max3_f32 v44,v44,v75,v76
s_waitcnt lgkmcnt(6)
v_mfma_f32_16x16x32_bf16 v[80:83],a[136:139],a[24:27],0
s_waitcnt lgkmcnt(5)
ds_read_b128 a[136:139],v0 offset:6272
v_max3_f32 v44,v44,v77,v78
v_mfma_f32_16x16x32_bf16 v[80:83],a[140:143],a[28:31],v[80:83]
s_waitcnt lgkmcnt(5)
ds_read_b128 a[140:143],v1 offset:6272
v_max_f32 v44,v44,v79
v_mfma_f32_16x16x32_bf16 v[80:83],a[144:147],a[32:35],v[80:83]
s_waitcnt lgkmcnt(5)
ds_read_b128 a[144:147],v0 offset:6400
v_mov_b32 v45,v44
v_mfma_f32_16x16x32_bf16 v[80:83],a[148:151],a[36:39],v[80:83]
s_waitcnt lgkmcnt(5)
ds_read_b128 a[148:151],v1 offset:6400
v_permlane32_swap_b32 v45,v44
v_mfma_f32_16x16x32_bf16 v[80:83],a[120:123],a[40:43],v[80:83]
s_waitcnt lgkmcnt(5)
ds_read_b128 a[120:123],v0 offset:12288
v_max_f32 v44,v44,v45
v_mfma_f32_16x16x32_bf16 v[80:83],a[124:127],a[44:47],v[80:83]
ds_read_b128 a[124:127],v1 offset:12288
v_mov_b32 v45,v44
v_mfma_f32_16x16x32_bf16 v[84:87],a[128:131],a[24:27],0
s_waitcnt lgkmcnt(5)
ds_read_b128 a[128:131],v0 offset:12416
v_permlane16_swap_b32 v45,v44
v_mfma_f32_16x16x32_bf16 v[84:87],a[132:135],a[28:31],v[84:87]
ds_read_b128 a[132:135],v1 offset:12416
v_max_f32 v44,v44,v45
v_mfma_f32_16x16x32_bf16 v[84:87],a[136:139],a[32:35],v[84:87]
s_waitcnt lgkmcnt(5)
ds_read_b128 a[136:139],v0 offset:12544
v_mul_f32_e64 v13,-s36,v44
v_mfma_f32_16x16x32_bf16 v[84:87],a[140:143],a[36:39],v[84:87]
ds_read_b128 a[140:143],v1 offset:12544
v_fma_f32 v72,v72,s36,v13
v_mfma_f32_16x16x32_bf16 v[84:87],a[144:147],a[40:43],v[84:87]
s_waitcnt lgkmcnt(5)
ds_read_b128 a[144:147],v0 offset:18432
v_fma_f32 v73,v73,s36,v13
v_mfma_f32_16x16x32_bf16 v[84:87],a[148:151],a[44:47],v[84:87]
ds_read_b128 a[148:151],v1 offset:18432
v_fma_f32 v74,v74,s36,v13
v_fma_f32 v75,v75,s36,v13
v_exp_f32 v72,v72
v_exp_f32 v73,v73
v_exp_f32 v74,v74
v_exp_f32 v75,v75
v_cvt_pk_bf16_f32 v20,v72,v73
v_cvt_pk_bf16_f32 v21,v74,v75
v_mfma_f32_16x16x32_bf16 v[72:75],a[120:123],a[0:3],0
s_waitcnt lgkmcnt(3)
ds_read_b128 a[120:123],v0 offset:18560
v_fma_f32 v76,v76,s36,v13
v_mfma_f32_16x16x32_bf16 v[72:75],a[124:127],a[4:7],v[72:75]
ds_read_b128 a[124:127],v1 offset:18560
v_fma_f32 v77,v77,s36,v13
v_mfma_f32_16x16x32_bf16 v[72:75],a[128:131],a[8:11],v[72:75]
ds_read_b128 a[128:131],v0 offset:18688
v_fma_f32 v78,v78,s36,v13
v_mfma_f32_16x16x32_bf16 v[72:75],a[132:135],a[12:15],v[72:75]
ds_read_b128 a[132:135],v1 offset:18688
v_fma_f32 v79,v79,s36,v13
v_mfma_f32_16x16x32_bf16 v[72:75],a[136:139],a[16:19],v[72:75]
s_waitcnt lgkmcnt(4)
ds_read_b128 a[136:139],v0 offset:0
v_exp_f32 v76,v76
v_mfma_f32_16x16x32_bf16 v[72:75],a[140:143],a[20:23],v[72:75]
ds_read_b128 a[140:143],v1 offset:0
v_exp_f32 v77,v77
v_exp_f32 v78,v78
v_exp_f32 v79,v79
v_cvt_pk_bf16_f32 v22,v76,v77
v_cvt_pk_bf16_f32 v23,v78,v79
v_mfma_f32_16x16x32_bf16 v[76:79],a[144:147],a[0:3],0
ds_read_b128 a[144:147],v0 offset:128
v_max3_f32 v48,v80,v81,v82
v_mfma_f32_16x16x32_bf16 v[76:79],a[148:151],a[4:7],v[76:79]
s_waitcnt lgkmcnt(4)
ds_read_b128 a[148:151],v1 offset:128
v_max3_f32 v48,v48,v83,v84
v_mfma_f32_16x16x32_bf16 v[76:79],a[120:123],a[8:11],v[76:79]
ds_read_b128 a[120:123],v0 offset:256
v_max3_f32 v48,v48,v85,v86
v_mfma_f32_16x16x32_bf16 v[76:79],a[124:127],a[12:15],v[76:79]
ds_read_b128 a[124:127],v1 offset:256
v_max_f32 v48,v48,v87
v_mfma_f32_16x16x32_bf16 v[76:79],a[128:131],a[16:19],v[76:79]
s_waitcnt lgkmcnt(4)
ds_read_b128 a[128:131],v0 offset:6144
v_mov_b32 v49,v48
v_mfma_f32_16x16x32_bf16 v[76:79],a[132:135],a[20:23],v[76:79]
s_waitcnt vmcnt(6)
ds_read_b128 a[48:51],v11 offset:12288
buffer_load_dwordx4 v6,s[12:15],s28 offen offset:0 nt lds
ds_read_b128 a[52:55],v12 offset:12288
buffer_load_dwordx4 v7,s[12:15],s28 offen offset:1024 nt lds
ds_read_b128 a[56:59],v11 offset:12416
buffer_load_dwordx4 v8,s[12:15],s28 offen offset:2048 nt lds
s_add_u32 s28,s28,3072
s_add_u32 m0,s24,9216
ds_read_b128 a[60:63],v12 offset:12416
buffer_load_dwordx4 v6,s[12:15],s28 offen offset:0 nt lds
ds_read_b128 a[64:67],v11 offset:12544
buffer_load_dwordx4 v7,s[12:15],s28 offen offset:1024 nt lds
ds_read_b128 a[68:71],v12 offset:12544
buffer_load_dwordx4 v8,s[12:15],s28 offen offset:2048 nt lds
s_add_u32 s28,s28,3072
s_add_u32 m0,s23,0
ds_read_b128 a[132:135],v1 offset:6144
v_permlane32_swap_b32 v49,v48
s_waitcnt lgkmcnt(6)
v_mfma_f32_16x16x32_bf16 v[88:91],a[136:139],a[48:51],0
s_waitcnt lgkmcnt(5)
ds_read_b128 a[136:139],v0 offset:6272
v_max_f32 v48,v48,v49
v_mfma_f32_16x16x32_bf16 v[88:91],a[140:143],a[52:55],v[88:91]
s_waitcnt lgkmcnt(5)
ds_read_b128 a[140:143],v1 offset:6272
v_mov_b32 v49,v48
v_mfma_f32_16x16x32_bf16 v[88:91],a[144:147],a[56:59],v[88:91]
s_waitcnt lgkmcnt(5)
ds_read_b128 a[144:147],v0 offset:6400
v_permlane16_swap_b32 v49,v48
v_mfma_f32_16x16x32_bf16 v[88:91],a[148:151],a[60:63],v[88:91]
s_waitcnt lgkmcnt(4)
ds_read_b128 a[148:151],v1 offset:6400
v_max_f32 v48,v48,v49
v_mfma_f32_16x16x32_bf16 v[88:91],a[120:123],a[64:67],v[88:91]
ds_read_b128 a[120:123],v0 offset:12288
v_mul_f32_e64 v14,-s36,v48
v_mfma_f32_16x16x32_bf16 v[88:91],a[124:127],a[68:71],v[88:91]
ds_read_b128 a[124:127],v1 offset:12288
v_fma_f32 v80,v80,s36,v14
v_mfma_f32_16x16x32_bf16 v[92:95],a[128:131],a[48:51],0
s_waitcnt lgkmcnt(5)
ds_read_b128 a[128:131],v0 offset:12416
v_fma_f32 v81,v81,s36,v14
v_mfma_f32_16x16x32_bf16 v[92:95],a[132:135],a[52:55],v[92:95]
ds_read_b128 a[132:135],v1 offset:12416
v_fma_f32 v82,v82,s36,v14
v_mfma_f32_16x16x32_bf16 v[92:95],a[136:139],a[56:59],v[92:95]
s_waitcnt lgkmcnt(5)
ds_read_b128 a[136:139],v0 offset:12544
v_fma_f32 v83,v83,s36,v14
v_mfma_f32_16x16x32_bf16 v[92:95],a[140:143],a[60:63],v[92:95]
ds_read_b128 a[140:143],v1 offset:12544
v_exp_f32 v80,v80
v_mfma_f32_16x16x32_bf16 v[92:95],a[144:147],a[64:67],v[92:95]
s_waitcnt lgkmcnt(5)
ds_read_b128 a[144:147],v0 offset:18432
v_exp_f32 v81,v81
v_mfma_f32_16x16x32_bf16 v[92:95],a[148:151],a[68:71],v[92:95]
ds_read_b128 a[148:151],v1 offset:18432
v_exp_f32 v82,v82
v_exp_f32 v83,v83
v_cvt_pk_bf16_f32 v24,v80,v81
v_cvt_pk_bf16_f32 v25,v82,v83
v_mfma_f32_16x16x32_bf16 v[80:83],a[120:123],a[24:27],0
s_waitcnt lgkmcnt(4)
ds_read_b128 a[120:123],v0 offset:18560
v_fma_f32 v84,v84,s36,v14
v_mfma_f32_16x16x32_bf16 v[80:83],a[124:127],a[28:31],v[80:83]
ds_read_b128 a[124:127],v1 offset:18560
v_fma_f32 v85,v85,s36,v14
v_mfma_f32_16x16x32_bf16 v[80:83],a[128:131],a[32:35],v[80:83]
ds_read_b128 a[128:131],v0 offset:18688
v_fma_f32 v86,v86,s36,v14
v_mfma_f32_16x16x32_bf16 v[80:83],a[132:135],a[36:39],v[80:83]
s_waitcnt lgkmcnt(4)
ds_read_b128 a[132:135],v1 offset:18688
v_fma_f32 v87,v87,s36,v14
v_mfma_f32_16x16x32_bf16 v[80:83],a[136:139],a[40:43],v[80:83]
ds_read_b128 a[136:139],v0 offset:0
v_exp_f32 v84,v84
v_mfma_f32_16x16x32_bf16 v[80:83],a[140:143],a[44:47],v[80:83]
ds_read_b128 a[140:143],v1 offset:0
v_exp_f32 v85,v85
v_exp_f32 v86,v86
v_exp_f32 v87,v87
v_cvt_pk_bf16_f32 v26,v84,v85
v_cvt_pk_bf16_f32 v27,v86,v87
v_mfma_f32_16x16x32_bf16 v[84:87],a[144:147],a[24:27],0
ds_read_b128 a[144:147],v0 offset:128
v_max3_f32 v52,v88,v89,v90
v_smfmac_f32_16x16x64_bf16 v[60:63],a[152:155],v[20:27],v18
s_waitcnt lgkmcnt(4)
v_max3_f32 v52,v52,v91,v92
v_mfma_f32_16x16x32_bf16 v[84:87],a[148:151],a[28:31],v[84:87]
ds_read_b128 a[148:151],v1 offset:128
v_max3_f32 v52,v52,v93,v94
v_mfma_f32_16x16x32_bf16 v[84:87],a[120:123],a[32:35],v[84:87]
ds_read_b128 a[120:123],v0 offset:256
v_max_f32 v52,v52,v95
v_mfma_f32_16x16x32_bf16 v[84:87],a[124:127],a[36:39],v[84:87]
ds_read_b128 a[124:127],v1 offset:256
v_mov_b32 v53,v52
v_mfma_f32_16x16x32_bf16 v[84:87],a[128:131],a[40:43],v[84:87]
s_waitcnt lgkmcnt(4)
ds_read_b128 a[128:131],v0 offset:6144
v_permlane32_swap_b32 v53,v52
v_mfma_f32_16x16x32_bf16 v[84:87],a[132:135],a[44:47],v[84:87]
s_waitcnt vmcnt(6)
ds_read_b128 a[72:75],v11 offset:0
buffer_load_dwordx4 v6,s[8:11],s21 offen offset:0 lds
ds_read_b128 a[76:79],v12 offset:0
buffer_load_dwordx4 v7,s[8:11],s21 offen offset:1024 lds
ds_read_b128 a[80:83],v11 offset:128
buffer_load_dwordx4 v8,s[8:11],s21 offen offset:2048 lds
s_add_u32 s21,s21,12288
s_add_u32 m0,s22,24576
ds_read_b128 a[84:87],v12 offset:128
buffer_load_dwordx4 v6,s[4:7],s20 offen offset:0 lds
ds_read_b128 a[88:91],v11 offset:256
buffer_load_dwordx4 v7,s[4:7],s20 offen offset:1024 lds
ds_read_b128 a[92:95],v12 offset:256
buffer_load_dwordx4 v8,s[4:7],s20 offen offset:2048 lds
s_add_u32 s20,s20,12288
s_add_u32 m0,s23,12288
ds_read_b128 a[132:135],v1 offset:6144
v_max_f32 v52,v52,v53
s_waitcnt lgkmcnt(6)
v_mfma_f32_16x16x32_bf16 v[96:99],a[136:139],a[72:75],0
s_waitcnt lgkmcnt(5)
ds_read_b128 a[136:139],v0 offset:6272
v_mov_b32 v53,v52
v_mfma_f32_16x16x32_bf16 v[96:99],a[140:143],a[76:79],v[96:99]
s_waitcnt lgkmcnt(5)
ds_read_b128 a[140:143],v1 offset:6272
v_permlane16_swap_b32 v53,v52
v_mfma_f32_16x16x32_bf16 v[96:99],a[144:147],a[80:83],v[96:99]
s_waitcnt lgkmcnt(5)
ds_read_b128 a[144:147],v0 offset:6400
v_max_f32 v52,v52,v53
v_mul_f32_e64 v15,-s36,v52
v_mfma_f32_16x16x32_bf16 v[96:99],a[148:151],a[84:87],v[96:99]
s_waitcnt lgkmcnt(4)
ds_read_b128 a[148:151],v1 offset:6400
v_fma_f32 v88,v88,s36,v15
v_mfma_f32_16x16x32_bf16 v[96:99],a[120:123],a[88:91],v[96:99]
ds_read_b128 a[120:123],v0 offset:12288
v_fma_f32 v89,v89,s36,v15
v_mfma_f32_16x16x32_bf16 v[96:99],a[124:127],a[92:95],v[96:99]
ds_read_b128 a[124:127],v1 offset:12288
v_fma_f32 v90,v90,s36,v15
v_mfma_f32_16x16x32_bf16 v[100:103],a[128:131],a[72:75],0
s_waitcnt lgkmcnt(5)
ds_read_b128 a[128:131],v0 offset:12416
v_fma_f32 v91,v91,s36,v15
v_mfma_f32_16x16x32_bf16 v[100:103],a[132:135],a[76:79],v[100:103]
ds_read_b128 a[132:135],v1 offset:12416
v_exp_f32 v88,v88
v_mfma_f32_16x16x32_bf16 v[100:103],a[136:139],a[80:83],v[100:103]
s_waitcnt lgkmcnt(5)
ds_read_b128 a[136:139],v0 offset:12544
v_exp_f32 v89,v89
v_mfma_f32_16x16x32_bf16 v[100:103],a[140:143],a[84:87],v[100:103]
ds_read_b128 a[140:143],v1 offset:12544
v_exp_f32 v90,v90
v_mfma_f32_16x16x32_bf16 v[100:103],a[144:147],a[88:91],v[100:103]
s_waitcnt lgkmcnt(5)
ds_read_b128 a[144:147],v0 offset:18432
v_exp_f32 v91,v91
v_mfma_f32_16x16x32_bf16 v[100:103],a[148:151],a[92:95],v[100:103]
ds_read_b128 a[148:151],v1 offset:18432
v_cvt_pk_bf16_f32 v28,v88,v89
v_cvt_pk_bf16_f32 v29,v90,v91
v_mfma_f32_16x16x32_bf16 v[88:91],a[120:123],a[48:51],0
s_waitcnt lgkmcnt(5)
ds_read_b128 a[120:123],v0 offset:18560
v_fma_f32 v92,v92,s36,v15
v_mfma_f32_16x16x32_bf16 v[88:91],a[124:127],a[52:55],v[88:91]
ds_read_b128 a[124:127],v1 offset:18560
v_fma_f32 v93,v93,s36,v15
v_mfma_f32_16x16x32_bf16 v[88:91],a[128:131],a[56:59],v[88:91]
s_waitcnt lgkmcnt(5)
ds_read_b128 a[128:131],v0 offset:18688
v_fma_f32 v94,v94,s36,v15
v_mfma_f32_16x16x32_bf16 v[88:91],a[132:135],a[60:63],v[88:91]
ds_read_b128 a[132:135],v1 offset:18688
v_fma_f32 v95,v95,s36,v15
v_mfma_f32_16x16x32_bf16 v[88:91],a[136:139],a[64:67],v[88:91]
s_waitcnt lgkmcnt(5)
ds_read_b128 a[136:139],v0 offset:0
v_exp_f32 v92,v92
v_mfma_f32_16x16x32_bf16 v[88:91],a[140:143],a[68:71],v[88:91]
ds_read_b128 a[140:143],v1 offset:0
v_exp_f32 v93,v93
v_exp_f32 v94,v94
v_exp_f32 v95,v95
v_cvt_pk_bf16_f32 v30,v92,v93
v_cvt_pk_bf16_f32 v31,v94,v95
v_mfma_f32_16x16x32_bf16 v[92:95],a[144:147],a[48:51],0
s_waitcnt lgkmcnt(4)
ds_read_b128 a[144:147],v0 offset:128
v_max3_f32 v56,v96,v97,v98
v_mfma_f32_16x16x32_bf16 v[92:95],a[148:151],a[52:55],v[92:95]
ds_read_b128 a[148:151],v1 offset:128
v_max3_f32 v56,v56,v99,v100
v_mfma_f32_16x16x32_bf16 v[92:95],a[120:123],a[56:59],v[92:95]
ds_read_b128 a[120:123],v0 offset:256
v_max3_f32 v56,v56,v101,v102
v_mfma_f32_16x16x32_bf16 v[92:95],a[124:127],a[60:63],v[92:95]
s_waitcnt lgkmcnt(4)
ds_read_b128 a[124:127],v1 offset:256
v_max_f32 v56,v56,v103
v_mfma_f32_16x16x32_bf16 v[92:95],a[128:131],a[64:67],v[92:95]
ds_read_b128 a[128:131],v0 offset:6144
v_mov_b32 v57,v56
v_mfma_f32_16x16x32_bf16 v[92:95],a[132:135],a[68:71],v[92:95]
s_waitcnt vmcnt(6)
ds_read_b128 a[96:99],v11 offset:6144
buffer_load_dwordx4 v6,s[8:11],s21 offen offset:0 lds
ds_read_b128 a[100:103],v12 offset:6144
buffer_load_dwordx4 v7,s[8:11],s21 offen offset:1024 lds
ds_read_b128 a[104:107],v11 offset:6272
buffer_load_dwordx4 v8,s[8:11],s21 offen offset:2048 lds
s_add_u32 s21,s21,12288
s_add_u32 m0,s23,24576
ds_read_b128 a[108:111],v12 offset:6272
buffer_load_dwordx4 v6,s[8:11],s21 offen offset:0 lds
ds_read_b128 a[112:115],v11 offset:6400
buffer_load_dwordx4 v7,s[8:11],s21 offen offset:1024 lds
ds_read_b128 a[116:119],v12 offset:6400
buffer_load_dwordx4 v8,s[8:11],s21 offen offset:2048 lds
s_add_u32 s21,s21,12288
ds_read_b128 a[132:135],v1 offset:6144
v_permlane32_swap_b32 v57,v56
s_waitcnt lgkmcnt(6)
v_mfma_f32_16x16x32_bf16 v[104:107],a[136:139],a[96:99],0
s_mov_b32 s27,166723584
ds_read_b128 a[136:139],v0 offset:6272
v_max_f32 v56,v56,v57
s_waitcnt lgkmcnt(6)
v_mfma_f32_16x16x32_bf16 v[104:107],a[140:143],a[100:103],v[104:107]
s_mov_b32 s42,s41
ds_read_b128 a[140:143],v1 offset:6272
v_mov_b32 v57,v56
s_waitcnt lgkmcnt(6)
v_mfma_f32_16x16x32_bf16 v[104:107],a[144:147],a[104:107],v[104:107]
s_add_u32 s69,s69,1
ds_read_b128 a[144:147],v0 offset:6400
v_permlane16_swap_b32 v57,v56
v_max_f32 v56,v56,v57
s_waitcnt lgkmcnt(6)
v_mfma_f32_16x16x32_bf16 v[104:107],a[148:151],a[108:111],v[104:107]
s_lshl_b32 s62,s69,5
ds_read_b128 a[148:151],v1 offset:6400
v_mul_f32_e64 v16,-s36,v56
s_waitcnt lgkmcnt(5)
v_mfma_f32_16x16x32_bf16 v[104:107],a[120:123],a[112:115],v[104:107]
s_add_u32 s62,s62,s34
ds_read_b128 a[120:123],v0 offset:12288
v_fma_f32 v96,v96,s36,v16
v_mfma_f32_16x16x32_bf16 v[104:107],a[124:127],a[116:119],v[104:107]
s_mul_i32 s63,s62,171
ds_read_b128 a[124:127],v1 offset:12288
v_fma_f32 v97,v97,s36,v16
v_mfma_f32_16x16x32_bf16 v[108:111],a[128:131],a[96:99],0
s_lshr_b32 s63,s63,9
ds_read_b128 a[128:131],v0 offset:12416
v_fma_f32 v98,v98,s36,v16
s_waitcnt lgkmcnt(6)
v_mfma_f32_16x16x32_bf16 v[108:111],a[132:135],a[100:103],v[108:111]
s_mul_i32 s64,s63,3
ds_read_b128 a[132:135],v1 offset:12416
v_fma_f32 v99,v99,s36,v16
v_mfma_f32_16x16x32_bf16 v[108:111],a[136:139],a[104:107],v[108:111]
s_sub_u32 s62,s62,s64
ds_read_b128 a[136:139],v0 offset:12544
v_exp_f32 v96,v96
s_waitcnt lgkmcnt(6)
v_mfma_f32_16x16x32_bf16 v[108:111],a[140:143],a[108:111],v[108:111]
s_add_u32 s63,s63,s33
ds_read_b128 a[140:143],v1 offset:12544
v_exp_f32 v97,v97
v_mfma_f32_16x16x32_bf16 v[108:111],a[144:147],a[112:115],v[108:111]
s_mul_i32 s30,s63,196608
ds_read_b128 a[144:147],v0 offset:18432
v_exp_f32 v98,v98
s_waitcnt lgkmcnt(6)
v_mfma_f32_16x16x32_bf16 v[108:111],a[148:151],a[116:119],v[108:111]
s_waitcnt vmcnt(9)
s_barrier
ds_read_b128 a[148:151],v1 offset:18432
v_exp_f32 v99,v99
v_cvt_pk_bf16_f32 v32,v96,v97
v_cvt_pk_bf16_f32 v33,v98,v99
v_mfma_f32_16x16x32_bf16 v[96:99],a[120:123],a[72:75],0
s_mul_i32 s41,s63,325632
ds_read_b128 a[120:123],v0 offset:18560
v_fma_f32 v100,v100,s36,v16
s_waitcnt lgkmcnt(4)
v_mfma_f32_16x16x32_bf16 v[96:99],a[124:127],a[76:79],v[96:99]
s_lshl_b32 s63,s3,2
ds_read_b128 a[124:127],v1 offset:18560
v_fma_f32 v101,v101,s36,v16
v_mfma_f32_16x16x32_bf16 v[96:99],a[128:131],a[80:83],v[96:99]
s_add_u32 s64,s63,21
ds_read_b128 a[128:131],v0 offset:18688
v_fma_f32 v102,v102,s36,v16
v_mfma_f32_16x16x32_bf16 v[96:99],a[132:135],a[84:87],v[96:99]
s_cmp_eq_u32 s3,0
ds_read_b128 a[132:135],v1 offset:18688
v_fma_f32 v103,v103,s36,v16
v_mfma_f32_16x16x32_bf16 v[96:99],a[136:139],a[88:91],v[96:99]
s_cselect_b32 s64,20,s64
ds_read_b128 a[136:139],v0 offset:12288
v_exp_f32 v100,v100
s_waitcnt lgkmcnt(6)
v_mfma_f32_16x16x32_bf16 v[96:99],a[140:143],a[92:95],v[96:99]
s_cselect_b32 s40,1,0
ds_read_b128 a[140:143],v1 offset:12288
v_exp_f32 v101,v101
v_exp_f32 v102,v102
v_exp_f32 v103,v103
v_cvt_pk_bf16_f32 v34,v100,v101
v_cvt_pk_bf16_f32 v35,v102,v103
v_mfma_f32_16x16x32_bf16 v[100:103],a[144:147],a[72:75],0
s_add_u32 s65,s63,37
ds_read_b128 a[144:147],v0 offset:12416
v_max3_f32 v40,v104,v105,v106
v_smfmac_f32_16x16x64_bf16 v[64:67],a[152:155],v[28:35],v18
s_cmp_eq_u32 s62,2
s_cselect_b32 s64,s65,s64
v_max3_f32 v40,v40,v107,v108
s_waitcnt lgkmcnt(4)
v_mfma_f32_16x16x32_bf16 v[100:103],a[148:151],a[76:79],v[100:103]
s_cselect_b32 s40,0,s40
ds_read_b128 a[148:151],v1 offset:12416
v_max3_f32 v40,v40,v109,v110
v_mfma_f32_16x16x32_bf16 v[100:103],a[120:123],a[80:83],v[100:103]
s_add_u32 s65,s63,s3
ds_read_b128 a[120:123],v0 offset:12544
v_max_f32 v40,v40,v111
v_mfma_f32_16x16x32_bf16 v[100:103],a[124:127],a[84:87],v[100:103]
s_cmp_eq_u32 s62,0
ds_read_b128 a[124:127],v1 offset:12544
v_mov_b32 v41,v40
v_mfma_f32_16x16x32_bf16 v[100:103],a[128:131],a[88:91],v[100:103]
s_cselect_b32 s64,s65,s64
ds_read_b128 a[128:131],v0 offset:18432
v_permlane32_swap_b32 v41,v40
s_waitcnt lgkmcnt(5)
v_mfma_f32_16x16x32_bf16 v[100:103],a[132:135],a[92:95],v[100:103]
s_cselect_b32 s40,1,s40
ds_read_b128 a[132:135],v1 offset:18432
v_max_f32 v40,v40,v41
v_mov_b32 v41,v40
v_fma_f32 v72,v72,s36,v13
v_fma_f32 v73,v73,s36,v13
v_permlane16_swap_b32 v41,v40
v_max_f32 v40,v40,v41
v_mul_f32_e64 v17,-s36,v40
v_fma_f32 v104,v104,s36,v17
v_fma_f32 v105,v105,s36,v17
v_fma_f32 v106,v106,s36,v17
v_fma_f32 v107,v107,s36,v17
v_exp_f32 v104,v104
v_exp_f32 v105,v105
v_exp_f32 v106,v106
v_exp_f32 v107,v107
v_cvt_pk_bf16_f32 v36,v104,v105
v_cvt_pk_bf16_f32 v37,v106,v107
v_mfma_f32_16x16x32_bf16 v[104:107],a[136:139],a[96:99],0
s_mul_i32 s64,s64,6144
ds_read_b128 a[136:139],v0 offset:18560
v_fma_f32 v108,v108,s36,v17
v_mfma_f32_16x16x32_bf16 v[104:107],a[140:143],a[100:103],v[104:107]
s_add_u32 s41,s41,s64
ds_read_b128 a[140:143],v1 offset:18560
v_fma_f32 v109,v109,s36,v17
s_waitcnt lgkmcnt(2)
v_mfma_f32_16x16x32_bf16 v[104:107],a[144:147],a[104:107],v[104:107]
s_cmp_ge_u32 s69,6
ds_read_b128 a[144:147],v0 offset:18688
v_fma_f32 v110,v110,s36,v17
v_mfma_f32_16x16x32_bf16 v[104:107],a[148:151],a[108:111],v[104:107]
s_cselect_b32 s41,166723584,s41
ds_read_b128 a[148:151],v1 offset:18688
v_fma_f32 v111,v111,s36,v17
v_mfma_f32_16x16x32_bf16 v[104:107],a[120:123],a[112:115],v[104:107]
s_cselect_b32 s30,100663296,s30
ds_read_b64_tr_b16 a[120:121],v2 offset:0
v_exp_f32 v108,v108
v_mfma_f32_16x16x32_bf16 v[104:107],a[124:127],a[116:119],v[104:107]
s_add_u32 s25,s30,s22
ds_read_b64_tr_b16 a[122:123],v2 offset:6144
ds_read_b64_tr_b16 a[124:125],v3 offset:0
ds_read_b64_tr_b16 a[126:127],v3 offset:6144
v_exp_f32 v109,v109
v_exp_f32 v110,v110
v_exp_f32 v111,v111
v_cvt_pk_bf16_f32 v38,v108,v109
v_cvt_pk_bf16_f32 v39,v110,v111
v_mfma_f32_16x16x32_bf16 v[108:111],a[128:131],a[96:99],0
s_add_u32 s26,s25,12288
ds_read_b64_tr_b16 a[128:129],v4 offset:0
v_fma_f32 v74,v74,s36,v13
v_mfma_f32_16x16x32_bf16 v[108:111],a[132:135],a[100:103],v[108:111]
s_mov_b32 s28,s41
ds_read_b64_tr_b16 a[130:131],v4 offset:6144
v_fma_f32 v75,v75,s36,v13
s_waitcnt lgkmcnt(7)
v_mfma_f32_16x16x32_bf16 v[108:111],a[136:139],a[104:107],v[108:111]
s_mov_b32 s29,s24
ds_read_b64_tr_b16 a[132:133],v5 offset:0
v_fma_f32 v80,v80,s36,v14
v_mfma_f32_16x16x32_bf16 v[108:111],a[140:143],a[108:111],v[108:111]
s_add_u32 m0,s22,0
ds_read_b64_tr_b16 a[134:135],v5 offset:6144
buffer_load_dwordx4 v6,s[4:7],s20 offen offset:0 lds
v_mfma_f32_16x16x32_bf16 v[108:111],a[144:147],a[112:115],v[108:111]
buffer_load_dwordx4 v7,s[4:7],s20 offen offset:1024 lds
s_waitcnt lgkmcnt(4)
v_mfma_f32_16x16x32_bf16 v[108:111],a[148:151],a[116:119],v[108:111]
buffer_load_dwordx4 v8,s[4:7],s20 offen offset:2048 lds
v_fma_f32 v81,v81,s36,v14
v_fma_f32 v82,v82,s36,v14
v_fma_f32 v83,v83,s36,v14
v_fma_f32 v88,v88,s36,v15
v_fma_f32 v89,v89,s36,v15
v_exp_f32 v72,v72
v_exp_f32 v73,v73
v_exp_f32 v74,v74
v_exp_f32 v75,v75
v_exp_f32 v80,v80
v_exp_f32 v81,v81
v_exp_f32 v82,v82
v_exp_f32 v83,v83
v_exp_f32 v88,v88
v_exp_f32 v89,v89
v_cvt_pk_bf16_f32 v44,v72,v73
v_cvt_pk_bf16_f32 v45,v74,v75
v_cvt_pk_bf16_f32 v48,v80,v81
v_cvt_pk_bf16_f32 v49,v82,v83
v_cvt_pk_bf16_f32 v52,v88,v89
s_add_u32 s20,s20,12288
v_mfma_f32_16x16x32_bf16 v[160:163],a[120:123],v[20:23],0
s_add_u32 m0,s23,0
ds_read_b64_tr_b16 a[136:137],v2 offset:128
v_fma_f32 v90,v90,s36,v15
v_mfma_f32_16x16x32_bf16 v[164:167],a[124:127],v[20:23],0
ds_read_b64_tr_b16 a[138:139],v2 offset:6272
v_fma_f32 v91,v91,s36,v15
v_mfma_f32_16x16x32_bf16 v[212:215],a[124:127],v[24:27],0
ds_read_b64_tr_b16 a[140:141],v3 offset:128
v_fma_f32 v96,v96,s36,v16
v_mfma_f32_16x16x32_bf16 v[208:211],a[120:123],v[24:27],0
ds_read_b64_tr_b16 a[142:143],v3 offset:6272
v_fma_f32 v97,v97,s36,v16
v_mfma_f32_16x16x32_bf16 v[112:115],a[120:123],v[28:31],0
ds_read_b64_tr_b16 a[144:145],v4 offset:128
v_fma_f32 v98,v98,s36,v16
v_mfma_f32_16x16x32_bf16 v[116:119],a[124:127],v[28:31],0
ds_read_b64_tr_b16 a[146:147],v4 offset:6272
v_fma_f32 v99,v99,s36,v16
v_mfma_f32_16x16x32_bf16 a[164:167],a[124:127],v[32:35],0
ds_read_b64_tr_b16 a[148:149],v5 offset:128
v_fma_f32 v104,v104,s36,v17
v_mfma_f32_16x16x32_bf16 a[160:163],a[120:123],v[32:35],0
ds_read_b64_tr_b16 a[150:151],v5 offset:6272
v_fma_f32 v105,v105,s36,v17
v_mfma_f32_16x16x32_bf16 a[208:211],a[120:123],v[36:39],0
ds_read_b64_tr_b16 a[120:121],v2 offset:256
v_fma_f32 v106,v106,s36,v17
v_mfma_f32_16x16x32_bf16 a[212:215],a[124:127],v[36:39],0
s_waitcnt lgkmcnt(6)
ds_read_b64_tr_b16 a[122:123],v2 offset:6400
v_fma_f32 v107,v107,s36,v17
v_mfma_f32_16x16x32_bf16 a[216:219],a[128:131],v[36:39],0
ds_read_b64_tr_b16 a[124:125],v3 offset:256
v_fma_f32 v76,v76,s36,v13
v_mfma_f32_16x16x32_bf16 a[220:223],a[132:135],v[36:39],0
ds_read_b64_tr_b16 a[126:127],v3 offset:6400
v_fma_f32 v77,v77,s36,v13
v_mfma_f32_16x16x32_bf16 a[172:175],a[132:135],v[32:35],0
v_exp_f32 v90,v90
v_mfma_f32_16x16x32_bf16 a[168:171],a[128:131],v[32:35],0
v_exp_f32 v91,v91
v_mfma_f32_16x16x32_bf16 v[120:123],a[128:131],v[28:31],0
v_cvt_pk_bf16_f32 v53,v90,v91
v_fma_f32 v78,v78,s36,v13
v_mfma_f32_16x16x32_bf16 v[124:127],a[132:135],v[28:31],0
v_exp_f32 v96,v96
v_mfma_f32_16x16x32_bf16 v[220:223],a[132:135],v[24:27],0
v_exp_f32 v97,v97
v_mfma_f32_16x16x32_bf16 v[216:219],a[128:131],v[24:27],0
v_exp_f32 v98,v98
v_mfma_f32_16x16x32_bf16 v[168:171],a[128:131],v[20:23],0
ds_read_b64_tr_b16 a[128:129],v4 offset:256
v_cvt_pk_bf16_f32 v56,v96,v97
v_mfma_f32_16x16x32_bf16 v[172:175],a[132:135],v[20:23],0
ds_read_b64_tr_b16 a[130:131],v4 offset:6400
v_fma_f32 v79,v79,s36,v13
v_mfma_f32_16x16x32_bf16 v[176:179],a[136:139],v[20:23],0
s_waitcnt lgkmcnt(2)
ds_read_b64_tr_b16 a[132:133],v5 offset:256
v_fma_f32 v84,v84,s36,v14
v_mfma_f32_16x16x32_bf16 v[180:183],a[140:143],v[20:23],0
ds_read_b64_tr_b16 a[134:135],v5 offset:6400
v_fma_f32 v85,v85,s36,v14
v_mfma_f32_16x16x32_bf16 v[228:231],a[140:143],v[24:27],0
v_exp_f32 v99,v99
v_mfma_f32_16x16x32_bf16 v[224:227],a[136:139],v[24:27],0
v_cvt_pk_bf16_f32 v57,v98,v99
v_fma_f32 v86,v86,s36,v14
v_mfma_f32_16x16x32_bf16 v[128:131],a[136:139],v[28:31],0
v_exp_f32 v104,v104
v_mfma_f32_16x16x32_bf16 v[132:135],a[140:143],v[28:31],0
v_exp_f32 v105,v105
v_mfma_f32_16x16x32_bf16 a[180:183],a[140:143],v[32:35],0
v_exp_f32 v106,v106
v_mfma_f32_16x16x32_bf16 a[176:179],a[136:139],v[32:35],0
v_exp_f32 v107,v107
v_mfma_f32_16x16x32_bf16 a[224:227],a[136:139],v[36:39],0
v_cvt_pk_bf16_f32 v40,v104,v105
v_cvt_pk_bf16_f32 v41,v106,v107
v_mfma_f32_16x16x32_bf16 a[228:231],a[140:143],v[36:39],0
v_exp_f32 v76,v76
v_mfma_f32_16x16x32_bf16 a[232:235],a[144:147],v[36:39],0
v_exp_f32 v77,v77
v_mfma_f32_16x16x32_bf16 a[236:239],a[148:151],v[36:39],0
v_exp_f32 v78,v78
v_mfma_f32_16x16x32_bf16 a[188:191],a[148:151],v[32:35],0
v_exp_f32 v79,v79
v_mfma_f32_16x16x32_bf16 a[184:187],a[144:147],v[32:35],0
v_cvt_pk_bf16_f32 v46,v76,v77
v_cvt_pk_bf16_f32 v47,v78,v79
v_mfma_f32_16x16x32_bf16 v[136:139],a[144:147],v[28:31],0
v_fma_f32 v87,v87,s36,v14
v_fma_f32 v92,v92,s36,v15
v_mfma_f32_16x16x32_bf16 v[140:143],a[148:151],v[28:31],0
v_exp_f32 v84,v84
v_mfma_f32_16x16x32_bf16 v[236:239],a[148:151],v[24:27],0
v_exp_f32 v85,v85
v_mfma_f32_16x16x32_bf16 v[232:235],a[144:147],v[24:27],0
v_exp_f32 v86,v86
v_mfma_f32_16x16x32_bf16 v[184:187],a[144:147],v[20:23],0
v_exp_f32 v87,v87
v_mfma_f32_16x16x32_bf16 v[188:191],a[148:151],v[20:23],0
v_cvt_pk_bf16_f32 v50,v84,v85
v_cvt_pk_bf16_f32 v51,v86,v87
v_mfma_f32_16x16x32_bf16 v[192:195],a[120:123],v[20:23],0
v_fma_f32 v93,v93,s36,v15
v_fma_f32 v94,v94,s36,v15
v_smfmac_f32_16x16x64_bf16 v[60:63],a[152:155],v[44:51],v18
v_fma_f32 v95,v95,s36,v15
v_mfma_f32_16x16x32_bf16 v[196:199],a[124:127],v[20:23],0
s_waitcnt vmcnt(6) lgkmcnt(0)
v_exp_f32 v92,v92
v_mfma_f32_16x16x32_bf16 v[244:247],a[124:127],v[24:27],0
s_barrier
v_mfma_f32_16x16x32_bf16 v[240:243],a[120:123],v[24:27],0
ds_read_b128 a[136:139],v0 offset:24576
v_fma_f32 v100,v100,s36,v16
v_mfma_f32_16x16x32_bf16 v[144:147],a[120:123],v[28:31],0
ds_read_b128 a[140:143],v1 offset:24576
v_fma_f32 v101,v101,s36,v16
v_mfma_f32_16x16x32_bf16 v[148:151],a[124:127],v[28:31],0
ds_read_b128 a[144:147],v0 offset:24704
v_fma_f32 v102,v102,s36,v16
v_mfma_f32_16x16x32_bf16 a[196:199],a[124:127],v[32:35],0
ds_read_b128 a[148:151],v1 offset:24704
v_fma_f32 v103,v103,s36,v16
v_mfma_f32_16x16x32_bf16 a[192:195],a[120:123],v[32:35],0
v_exp_f32 v93,v93
v_mfma_f32_16x16x32_bf16 a[240:243],a[120:123],v[36:39],0
buffer_load_dwordx4 v6,s[8:11],s21 offen offset:0 lds
v_mfma_f32_16x16x32_bf16 a[244:247],a[124:127],v[36:39],0
ds_read_b128 a[120:123],v0 offset:24832
v_cvt_pk_bf16_f32 v54,v92,v93
v_mfma_f32_16x16x32_bf16 a[248:251],a[128:131],v[36:39],0
ds_read_b128 a[124:127],v1 offset:24832
v_fma_f32 v108,v108,s36,v17
v_mfma_f32_16x16x32_bf16 a[252:255],a[132:135],v[36:39],0
v_exp_f32 v94,v94
v_mfma_f32_16x16x32_bf16 a[204:207],a[132:135],v[32:35],0
v_exp_f32 v95,v95
v_mfma_f32_16x16x32_bf16 a[200:203],a[128:131],v[32:35],0
v_cvt_pk_bf16_f32 v55,v94,v95
v_fma_f32 v109,v109,s36,v17
v_mfma_f32_16x16x32_bf16 v[152:155],a[128:131],v[28:31],0
v_exp_f32 v100,v100
v_mfma_f32_16x16x32_bf16 v[156:159],a[132:135],v[28:31],0
v_exp_f32 v101,v101
v_mfma_f32_16x16x32_bf16 v[252:255],a[132:135],v[24:27],0
v_exp_f32 v102,v102
v_mfma_f32_16x16x32_bf16 v[248:251],a[128:131],v[24:27],0
v_exp_f32 v103,v103
v_mfma_f32_16x16x32_bf16 v[200:203],a[128:131],v[20:23],0
ds_read_b128 a[128:131],v0 offset:30720
v_cvt_pk_bf16_f32 v58,v100,v101
v_mfma_f32_16x16x32_bf16 v[204:207],a[132:135],v[20:23],0
buffer_load_dwordx4 v7,s[8:11],s21 offen offset:1024 lds
s_waitcnt lgkmcnt(1)
v_mfma_f32_16x16x32_bf16 v[72:75],a[136:139],a[0:3],0
ds_read_b128 a[132:135],v1 offset:30720
v_cvt_pk_bf16_f32 v59,v102,v103
v_mfma_f32_16x16x32_bf16 v[72:75],a[140:143],a[4:7],v[72:75]
v_fma_f32 v110,v110,s36,v17
v_fma_f32 v111,v111,s36,v17
v_smfmac_f32_16x16x64_bf16 v[64:67],a[152:155],v[52:59],v18
v_mfma_f32_16x16x32_bf16 v[72:75],a[144:147],a[8:11],v[72:75]
v_exp_f32 v108,v108
v_mfma_f32_16x16x32_bf16 v[72:75],a[148:151],a[12:15],v[72:75]
v_exp_f32 v109,v109
v_mfma_f32_16x16x32_bf16 v[72:75],a[120:123],a[16:19],v[72:75]
v_exp_f32 v110,v110
v_mfma_f32_16x16x32_bf16 v[72:75],a[124:127],a[20:23],v[72:75]
v_exp_f32 v111,v111
v_mfma_f32_16x16x32_bf16 v[80:83],a[124:127],a[44:47],0
v_cvt_pk_bf16_f32 v42,v108,v109
v_cvt_pk_bf16_f32 v43,v110,v111
v_mfma_f32_16x16x32_bf16 v[80:83],a[120:123],a[40:43],v[80:83]
v_mfma_f32_16x16x32_bf16 v[80:83],a[148:151],a[36:39],v[80:83]
v_smfmac_f32_16x16x64_bf16 v[68:71],a[152:155],v[36:43],v18
buffer_load_dwordx4 v8,s[8:11],s21 offen offset:2048 lds
v_mfma_f32_16x16x32_bf16 v[80:83],a[144:147],a[32:35],v[80:83]
s_add_u32 s21,s21,12288
v_fma_f32 v72,v72,s36,v13
v_fma_f32 v73,v73,s36,v13
v_mfma_f32_16x16x32_bf16 v[80:83],a[140:143],a[28:31],v[80:83]
s_add_u32 m0,s22,12288
v_fma_f32 v74,v74,s36,v13
v_fma_f32 v75,v75,s36,v13
v_mfma_f32_16x16x32_bf16 v[80:83],a[136:139],a[24:27],v[80:83]
v_exp_f32 v72,v72
v_mfma_f32_16x16x32_bf16 v[88:91],a[136:139],a[48:51],0
v_exp_f32 v73,v73
v_mfma_f32_16x16x32_bf16 v[88:91],a[140:143],a[52:55],v[88:91]
v_exp_f32 v74,v74
v_mfma_f32_16x16x32_bf16 v[88:91],a[144:147],a[56:59],v[88:91]
v_exp_f32 v75,v75
v_mfma_f32_16x16x32_bf16 v[88:91],a[148:151],a[60:63],v[88:91]
v_fma_f32 v80,v80,s36,v14
v_fma_f32 v81,v81,s36,v14
v_mfma_f32_16x16x32_bf16 v[88:91],a[120:123],a[64:67],v[88:91]
v_fma_f32 v82,v82,s36,v14
v_fma_f32 v83,v83,s36,v14
v_mfma_f32_16x16x32_bf16 v[88:91],a[124:127],a[68:71],v[88:91]
v_exp_f32 v80,v80
v_mfma_f32_16x16x32_bf16 v[96:99],a[124:127],a[92:95],0
v_exp_f32 v81,v81
v_mfma_f32_16x16x32_bf16 v[96:99],a[120:123],a[88:91],v[96:99]
buffer_load_dwordx4 v6,s[4:7],s20 offen offset:0 lds
v_mfma_f32_16x16x32_bf16 v[96:99],a[148:151],a[84:87],v[96:99]
v_exp_f32 v82,v82
v_mfma_f32_16x16x32_bf16 v[96:99],a[144:147],a[80:83],v[96:99]
v_fma_f32 v88,v88,s36,v15
v_fma_f32 v89,v89,s36,v15
v_mfma_f32_16x16x32_bf16 v[96:99],a[140:143],a[76:79],v[96:99]
v_exp_f32 v83,v83
v_mfma_f32_16x16x32_bf16 v[96:99],a[136:139],a[72:75],v[96:99]
v_exp_f32 v88,v88
v_mfma_f32_16x16x32_bf16 v[104:107],a[136:139],a[96:99],0
ds_read_b128 a[136:139],v0 offset:30848
v_cvt_pk_bf16_f32 v20,v72,v73
v_mfma_f32_16x16x32_bf16 v[104:107],a[140:143],a[100:103],v[104:107]
ds_read_b128 a[140:143],v1 offset:30848
v_cvt_pk_bf16_f32 v21,v74,v75
v_mfma_f32_16x16x32_bf16 v[104:107],a[144:147],a[104:107],v[104:107]
ds_read_b128 a[144:147],v0 offset:30976
v_cvt_pk_bf16_f32 v24,v80,v81
v_mfma_f32_16x16x32_bf16 v[104:107],a[148:151],a[108:111],v[104:107]
ds_read_b128 a[148:151],v1 offset:30976
v_cvt_pk_bf16_f32 v25,v82,v83
v_mfma_f32_16x16x32_bf16 v[104:107],a[120:123],a[112:115],v[104:107]
v_exp_f32 v89,v89
v_mfma_f32_16x16x32_bf16 v[104:107],a[124:127],a[116:119],v[104:107]
s_waitcnt lgkmcnt(4)
v_cvt_pk_bf16_f32 v28,v88,v89
v_mfma_f32_16x16x32_bf16 v[76:79],a[128:131],a[0:3],0
v_mfma_f32_16x16x32_bf16 v[76:79],a[132:135],a[4:7],v[76:79]
buffer_load_dwordx4 v7,s[4:7],s20 offen offset:1024 lds
s_waitcnt lgkmcnt(3)
v_mfma_f32_16x16x32_bf16 v[76:79],a[136:139],a[8:11],v[76:79]
s_waitcnt lgkmcnt(2)
v_mfma_f32_16x16x32_bf16 v[76:79],a[140:143],a[12:15],v[76:79]
s_waitcnt lgkmcnt(1)
v_mfma_f32_16x16x32_bf16 v[76:79],a[144:147],a[16:19],v[76:79]
s_waitcnt lgkmcnt(0)
v_mfma_f32_16x16x32_bf16 v[76:79],a[148:151],a[20:23],v[76:79]
v_mfma_f32_16x16x32_bf16 v[84:87],a[148:151],a[44:47],0
v_mfma_f32_16x16x32_bf16 v[84:87],a[144:147],a[40:43],v[84:87]
v_mfma_f32_16x16x32_bf16 v[84:87],a[140:143],a[36:39],v[84:87]
v_mfma_f32_16x16x32_bf16 v[84:87],a[136:139],a[32:35],v[84:87]
v_mfma_f32_16x16x32_bf16 v[84:87],a[132:135],a[28:31],v[84:87]
v_mfma_f32_16x16x32_bf16 v[84:87],a[128:131],a[24:27],v[84:87]
v_mfma_f32_16x16x32_bf16 v[92:95],a[128:131],a[48:51],0
buffer_load_dwordx4 v8,s[4:7],s20 offen offset:2048 lds
v_mfma_f32_16x16x32_bf16 v[92:95],a[132:135],a[52:55],v[92:95]
s_add_u32 s20,s20,12288
v_mfma_f32_16x16x32_bf16 v[92:95],a[136:139],a[56:59],v[92:95]
v_mfma_f32_16x16x32_bf16 v[92:95],a[140:143],a[60:63],v[92:95]
v_mfma_f32_16x16x32_bf16 v[92:95],a[144:147],a[64:67],v[92:95]
v_mfma_f32_16x16x32_bf16 v[92:95],a[148:151],a[68:71],v[92:95]
ds_read_b64_tr_b16 a[120:121],v2 offset:12288
v_mfma_f32_16x16x32_bf16 v[100:103],a[148:151],a[92:95],0
ds_read_b64_tr_b16 a[122:123],v2 offset:18432
v_mfma_f32_16x16x32_bf16 v[100:103],a[144:147],a[88:91],v[100:103]
v_mfma_f32_16x16x32_bf16 v[100:103],a[140:143],a[84:87],v[100:103]
ds_read_b64_tr_b16 a[124:125],v3 offset:12288
v_mfma_f32_16x16x32_bf16 v[100:103],a[136:139],a[80:83],v[100:103]
ds_read_b64_tr_b16 a[126:127],v3 offset:18432
v_mfma_f32_16x16x32_bf16 v[100:103],a[132:135],a[76:79],v[100:103]
v_mfma_f32_16x16x32_bf16 v[100:103],a[128:131],a[72:75],v[100:103]
v_mfma_f32_16x16x32_bf16 v[108:111],a[128:131],a[96:99],0
ds_read_b64_tr_b16 a[128:129],v4 offset:12288
v_mfma_f32_16x16x32_bf16 v[108:111],a[132:135],a[100:103],v[108:111]
ds_read_b64_tr_b16 a[130:131],v4 offset:18432
v_mfma_f32_16x16x32_bf16 v[108:111],a[136:139],a[104:107],v[108:111]
ds_read_b64_tr_b16 a[132:133],v5 offset:12288
v_mfma_f32_16x16x32_bf16 v[108:111],a[140:143],a[108:111],v[108:111]
ds_read_b64_tr_b16 a[134:135],v5 offset:18432
v_mfma_f32_16x16x32_bf16 v[108:111],a[144:147],a[112:115],v[108:111]
v_mfma_f32_16x16x32_bf16 v[108:111],a[148:151],a[116:119],v[108:111]
s_waitcnt lgkmcnt(4)
v_mfma_f32_16x16x32_bf16 v[160:163],a[120:123],v[44:47],v[160:163]
s_add_u32 m0,s23,12288
ds_read_b64_tr_b16 a[136:137],v2 offset:12416
v_fma_f32 v90,v90,s36,v15
v_mfma_f32_16x16x32_bf16 v[164:167],a[124:127],v[44:47],v[164:167]
ds_read_b64_tr_b16 a[138:139],v2 offset:18560
v_fma_f32 v91,v91,s36,v15
v_mfma_f32_16x16x32_bf16 v[212:215],a[124:127],v[48:51],v[212:215]
ds_read_b64_tr_b16 a[140:141],v3 offset:12416
v_fma_f32 v96,v96,s36,v16
v_mfma_f32_16x16x32_bf16 v[208:211],a[120:123],v[48:51],v[208:211]
ds_read_b64_tr_b16 a[142:143],v3 offset:18560
v_fma_f32 v97,v97,s36,v16
v_mfma_f32_16x16x32_bf16 v[112:115],a[120:123],v[52:55],v[112:115]
ds_read_b64_tr_b16 a[144:145],v4 offset:12416
v_fma_f32 v98,v98,s36,v16
v_mfma_f32_16x16x32_bf16 v[116:119],a[124:127],v[52:55],v[116:119]
ds_read_b64_tr_b16 a[146:147],v4 offset:18560
v_fma_f32 v99,v99,s36,v16
v_mfma_f32_16x16x32_bf16 a[164:167],a[124:127],v[56:59],a[164:167]
ds_read_b64_tr_b16 a[148:149],v5 offset:12416
v_fma_f32 v104,v104,s36,v17
v_mfma_f32_16x16x32_bf16 a[160:163],a[120:123],v[56:59],a[160:163]
ds_read_b64_tr_b16 a[150:151],v5 offset:18560
v_fma_f32 v105,v105,s36,v17
v_mfma_f32_16x16x32_bf16 a[208:211],a[120:123],v[40:43],a[208:211]
ds_read_b64_tr_b16 a[120:121],v2 offset:12544
v_fma_f32 v106,v106,s36,v17
v_mfma_f32_16x16x32_bf16 a[212:215],a[124:127],v[40:43],a[212:215]
s_waitcnt lgkmcnt(6)
ds_read_b64_tr_b16 a[122:123],v2 offset:18688
v_fma_f32 v107,v107,s36,v17
v_mfma_f32_16x16x32_bf16 a[216:219],a[128:131],v[40:43],a[216:219]
ds_read_b64_tr_b16 a[124:125],v3 offset:12544
v_fma_f32 v76,v76,s36,v13
v_mfma_f32_16x16x32_bf16 a[220:223],a[132:135],v[40:43],a[220:223]
ds_read_b64_tr_b16 a[126:127],v3 offset:18688
v_fma_f32 v77,v77,s36,v13
v_mfma_f32_16x16x32_bf16 a[172:175],a[132:135],v[56:59],a[172:175]
v_exp_f32 v90,v90
v_mfma_f32_16x16x32_bf16 a[168:171],a[128:131],v[56:59],a[168:171]
v_exp_f32 v91,v91
v_mfma_f32_16x16x32_bf16 v[120:123],a[128:131],v[52:55],v[120:123]
v_cvt_pk_bf16_f32 v29,v90,v91
v_fma_f32 v78,v78,s36,v13
v_mfma_f32_16x16x32_bf16 v[124:127],a[132:135],v[52:55],v[124:127]
v_exp_f32 v96,v96
v_mfma_f32_16x16x32_bf16 v[220:223],a[132:135],v[48:51],v[220:223]
v_exp_f32 v97,v97
v_mfma_f32_16x16x32_bf16 v[216:219],a[128:131],v[48:51],v[216:219]
v_exp_f32 v98,v98
v_mfma_f32_16x16x32_bf16 v[168:171],a[128:131],v[44:47],v[168:171]
ds_read_b64_tr_b16 a[128:129],v4 offset:12544
v_cvt_pk_bf16_f32 v32,v96,v97
v_mfma_f32_16x16x32_bf16 v[172:175],a[132:135],v[44:47],v[172:175]
ds_read_b64_tr_b16 a[130:131],v4 offset:18688
v_fma_f32 v79,v79,s36,v13
v_mfma_f32_16x16x32_bf16 v[176:179],a[136:139],v[44:47],v[176:179]
s_waitcnt lgkmcnt(2)
ds_read_b64_tr_b16 a[132:133],v5 offset:12544
v_fma_f32 v84,v84,s36,v14
v_mfma_f32_16x16x32_bf16 v[180:183],a[140:143],v[44:47],v[180:183]
ds_read_b64_tr_b16 a[134:135],v5 offset:18688
v_fma_f32 v85,v85,s36,v14
v_mfma_f32_16x16x32_bf16 v[228:231],a[140:143],v[48:51],v[228:231]
v_exp_f32 v99,v99
v_mfma_f32_16x16x32_bf16 v[224:227],a[136:139],v[48:51],v[224:227]
v_cvt_pk_bf16_f32 v33,v98,v99
v_fma_f32 v86,v86,s36,v14
v_mfma_f32_16x16x32_bf16 v[128:131],a[136:139],v[52:55],v[128:131]
v_exp_f32 v104,v104
v_mfma_f32_16x16x32_bf16 v[132:135],a[140:143],v[52:55],v[132:135]
v_exp_f32 v105,v105
v_mfma_f32_16x16x32_bf16 a[180:183],a[140:143],v[56:59],a[180:183]
v_exp_f32 v106,v106
v_mfma_f32_16x16x32_bf16 a[176:179],a[136:139],v[56:59],a[176:179]
v_exp_f32 v107,v107
v_mfma_f32_16x16x32_bf16 a[224:227],a[136:139],v[40:43],a[224:227]
v_cvt_pk_bf16_f32 v36,v104,v105
v_cvt_pk_bf16_f32 v37,v106,v107
v_mfma_f32_16x16x32_bf16 a[228:231],a[140:143],v[40:43],a[228:231]
v_exp_f32 v76,v76
v_mfma_f32_16x16x32_bf16 a[232:235],a[144:147],v[40:43],a[232:235]
v_exp_f32 v77,v77
v_mfma_f32_16x16x32_bf16 a[236:239],a[148:151],v[40:43],a[236:239]
v_exp_f32 v78,v78
v_mfma_f32_16x16x32_bf16 a[188:191],a[148:151],v[56:59],a[188:191]
v_exp_f32 v79,v79
v_mfma_f32_16x16x32_bf16 a[184:187],a[144:147],v[56:59],a[184:187]
v_cvt_pk_bf16_f32 v22,v76,v77
v_cvt_pk_bf16_f32 v23,v78,v79
v_mfma_f32_16x16x32_bf16 v[136:139],a[144:147],v[52:55],v[136:139]
v_fma_f32 v87,v87,s36,v14
v_fma_f32 v92,v92,s36,v15
v_mfma_f32_16x16x32_bf16 v[140:143],a[148:151],v[52:55],v[140:143]
v_exp_f32 v84,v84
v_mfma_f32_16x16x32_bf16 v[236:239],a[148:151],v[48:51],v[236:239]
v_exp_f32 v85,v85
v_mfma_f32_16x16x32_bf16 v[232:235],a[144:147],v[48:51],v[232:235]
v_exp_f32 v86,v86
v_mfma_f32_16x16x32_bf16 v[184:187],a[144:147],v[44:47],v[184:187]
v_exp_f32 v87,v87
v_mfma_f32_16x16x32_bf16 v[188:191],a[148:151],v[44:47],v[188:191]
v_cvt_pk_bf16_f32 v26,v84,v85
v_cvt_pk_bf16_f32 v27,v86,v87
v_mfma_f32_16x16x32_bf16 v[192:195],a[120:123],v[44:47],v[192:195]
v_fma_f32 v93,v93,s36,v15
v_fma_f32 v94,v94,s36,v15
v_smfmac_f32_16x16x64_bf16 v[60:63],a[152:155],v[20:27],v18
v_fma_f32 v95,v95,s36,v15
v_mfma_f32_16x16x32_bf16 v[196:199],a[124:127],v[44:47],v[196:199]
s_waitcnt vmcnt(6) lgkmcnt(0)
v_exp_f32 v92,v92
v_mfma_f32_16x16x32_bf16 v[244:247],a[124:127],v[48:51],v[244:247]
s_barrier
v_mfma_f32_16x16x32_bf16 v[240:243],a[120:123],v[48:51],v[240:243]
ds_read_b128 a[136:139],v0 offset:0
v_fma_f32 v100,v100,s36,v16
v_mfma_f32_16x16x32_bf16 v[144:147],a[120:123],v[52:55],v[144:147]
ds_read_b128 a[140:143],v1 offset:0
v_fma_f32 v101,v101,s36,v16
v_mfma_f32_16x16x32_bf16 v[148:151],a[124:127],v[52:55],v[148:151]
ds_read_b128 a[144:147],v0 offset:128
v_fma_f32 v102,v102,s36,v16
v_mfma_f32_16x16x32_bf16 a[196:199],a[124:127],v[56:59],a[196:199]
ds_read_b128 a[148:151],v1 offset:128
v_fma_f32 v103,v103,s36,v16
v_mfma_f32_16x16x32_bf16 a[192:195],a[120:123],v[56:59],a[192:195]
v_exp_f32 v93,v93
v_mfma_f32_16x16x32_bf16 a[240:243],a[120:123],v[40:43],a[240:243]
buffer_load_dwordx4 v6,s[8:11],s21 offen offset:0 lds
v_mfma_f32_16x16x32_bf16 a[244:247],a[124:127],v[40:43],a[244:247]
ds_read_b128 a[120:123],v0 offset:256
v_cvt_pk_bf16_f32 v30,v92,v93
v_mfma_f32_16x16x32_bf16 a[248:251],a[128:131],v[40:43],a[248:251]
ds_read_b128 a[124:127],v1 offset:256
v_fma_f32 v108,v108,s36,v17
v_mfma_f32_16x16x32_bf16 a[252:255],a[132:135],v[40:43],a[252:255]
v_exp_f32 v94,v94
v_mfma_f32_16x16x32_bf16 a[204:207],a[132:135],v[56:59],a[204:207]
v_exp_f32 v95,v95
v_mfma_f32_16x16x32_bf16 a[200:203],a[128:131],v[56:59],a[200:203]
v_cvt_pk_bf16_f32 v31,v94,v95
v_fma_f32 v109,v109,s36,v17
v_mfma_f32_16x16x32_bf16 v[152:155],a[128:131],v[52:55],v[152:155]
v_exp_f32 v100,v100
v_mfma_f32_16x16x32_bf16 v[156:159],a[132:135],v[52:55],v[156:159]
v_exp_f32 v101,v101
v_mfma_f32_16x16x32_bf16 v[252:255],a[132:135],v[48:51],v[252:255]
v_exp_f32 v102,v102
v_mfma_f32_16x16x32_bf16 v[248:251],a[128:131],v[48:51],v[248:251]
v_exp_f32 v103,v103
v_mfma_f32_16x16x32_bf16 v[200:203],a[128:131],v[44:47],v[200:203]
ds_read_b128 a[128:131],v0 offset:6144
v_cvt_pk_bf16_f32 v34,v100,v101
v_mfma_f32_16x16x32_bf16 v[204:207],a[132:135],v[44:47],v[204:207]
buffer_load_dwordx4 v7,s[8:11],s21 offen offset:1024 lds
s_waitcnt lgkmcnt(1)
v_mfma_f32_16x16x32_bf16 v[72:75],a[136:139],a[0:3],0
ds_read_b128 a[132:135],v1 offset:6144
v_cvt_pk_bf16_f32 v35,v102,v103
v_mfma_f32_16x16x32_bf16 v[72:75],a[140:143],a[4:7],v[72:75]
v_fma_f32 v110,v110,s36,v17
v_fma_f32 v111,v111,s36,v17
v_smfmac_f32_16x16x64_bf16 v[64:67],a[152:155],v[28:35],v18
v_mfma_f32_16x16x32_bf16 v[72:75],a[144:147],a[8:11],v[72:75]
v_exp_f32 v108,v108
v_mfma_f32_16x16x32_bf16 v[72:75],a[148:151],a[12:15],v[72:75]
v_exp_f32 v109,v109
v_mfma_f32_16x16x32_bf16 v[72:75],a[120:123],a[16:19],v[72:75]
v_exp_f32 v110,v110
v_mfma_f32_16x16x32_bf16 v[72:75],a[124:127],a[20:23],v[72:75]
v_exp_f32 v111,v111
v_mfma_f32_16x16x32_bf16 v[80:83],a[124:127],a[44:47],0
v_cvt_pk_bf16_f32 v38,v108,v109
v_cvt_pk_bf16_f32 v39,v110,v111
v_mfma_f32_16x16x32_bf16 v[80:83],a[120:123],a[40:43],v[80:83]
v_mfma_f32_16x16x32_bf16 v[80:83],a[148:151],a[36:39],v[80:83]
v_mfma_f32_16x16x32_bf16 v[80:83],a[144:147],a[32:35],v[80:83]
buffer_load_dwordx4 v8,s[8:11],s21 offen offset:2048 lds
v_mfma_f32_16x16x32_bf16 v[80:83],a[140:143],a[28:31],v[80:83]
s_add_u32 s21,s21,12288
v_fma_f32 v72,v72,s36,v13
v_fma_f32 v73,v73,s36,v13
v_mfma_f32_16x16x32_bf16 v[80:83],a[136:139],a[24:27],v[80:83]
s_add_u32 m0,s22,24576
v_fma_f32 v74,v74,s36,v13
v_fma_f32 v75,v75,s36,v13
v_mfma_f32_16x16x32_bf16 v[88:91],a[136:139],a[48:51],0
v_exp_f32 v72,v72
v_mfma_f32_16x16x32_bf16 v[88:91],a[140:143],a[52:55],v[88:91]
v_exp_f32 v73,v73
v_mfma_f32_16x16x32_bf16 v[88:91],a[144:147],a[56:59],v[88:91]
v_fma_f32 v80,v80,s36,v14
v_fma_f32 v81,v81,s36,v14
v_mfma_f32_16x16x32_bf16 v[88:91],a[148:151],a[60:63],v[88:91]
v_fma_f32 v82,v82,s36,v14
v_fma_f32 v83,v83,s36,v14
v_mfma_f32_16x16x32_bf16 v[88:91],a[120:123],a[64:67],v[88:91]
v_exp_f32 v74,v74
v_mfma_f32_16x16x32_bf16 v[88:91],a[124:127],a[68:71],v[88:91]
v_exp_f32 v75,v75
v_mfma_f32_16x16x32_bf16 v[96:99],a[124:127],a[92:95],0
v_exp_f32 v80,v80
v_mfma_f32_16x16x32_bf16 v[96:99],a[120:123],a[88:91],v[96:99]
v_exp_f32 v81,v81
v_mfma_f32_16x16x32_bf16 v[96:99],a[148:151],a[84:87],v[96:99]
v_exp_f32 v82,v82
v_mfma_f32_16x16x32_bf16 v[96:99],a[144:147],a[80:83],v[96:99]
buffer_load_dwordx4 v6,s[4:7],s20 offen offset:0 lds
v_mfma_f32_16x16x32_bf16 v[96:99],a[140:143],a[76:79],v[96:99]
v_fma_f32 v88,v88,s36,v15
v_fma_f32 v89,v89,s36,v15
v_mfma_f32_16x16x32_bf16 v[96:99],a[136:139],a[72:75],v[96:99]
v_exp_f32 v83,v83
v_mfma_f32_16x16x32_bf16 v[104:107],a[136:139],a[96:99],0
ds_read_b128 a[136:139],v0 offset:6272
v_cvt_pk_bf16_f32 v44,v72,v73
v_mfma_f32_16x16x32_bf16 v[104:107],a[140:143],a[100:103],v[104:107]
ds_read_b128 a[140:143],v1 offset:6272
v_cvt_pk_bf16_f32 v45,v74,v75
v_mfma_f32_16x16x32_bf16 v[104:107],a[144:147],a[104:107],v[104:107]
ds_read_b128 a[144:147],v0 offset:6400
v_cvt_pk_bf16_f32 v48,v80,v81
v_mfma_f32_16x16x32_bf16 v[104:107],a[148:151],a[108:111],v[104:107]
ds_read_b128 a[148:151],v1 offset:6400
v_cvt_pk_bf16_f32 v49,v82,v83
v_mfma_f32_16x16x32_bf16 v[104:107],a[120:123],a[112:115],v[104:107]
v_exp_f32 v88,v88
v_mfma_f32_16x16x32_bf16 v[104:107],a[124:127],a[116:119],v[104:107]
s_waitcnt lgkmcnt(4)
v_exp_f32 v89,v89
v_mfma_f32_16x16x32_bf16 v[76:79],a[128:131],a[0:3],0
v_cvt_pk_bf16_f32 v52,v88,v89
v_mfma_f32_16x16x32_bf16 v[76:79],a[132:135],a[4:7],v[76:79]
s_waitcnt lgkmcnt(3)
v_mfma_f32_16x16x32_bf16 v[76:79],a[136:139],a[8:11],v[76:79]
buffer_load_dwordx4 v7,s[4:7],s20 offen offset:1024 lds
s_waitcnt lgkmcnt(2)
v_mfma_f32_16x16x32_bf16 v[76:79],a[140:143],a[12:15],v[76:79]
s_waitcnt lgkmcnt(1)
v_mfma_f32_16x16x32_bf16 v[76:79],a[144:147],a[16:19],v[76:79]
s_waitcnt lgkmcnt(0)
v_mfma_f32_16x16x32_bf16 v[76:79],a[148:151],a[20:23],v[76:79]
v_mfma_f32_16x16x32_bf16 v[84:87],a[148:151],a[44:47],0
v_mfma_f32_16x16x32_bf16 v[84:87],a[144:147],a[40:43],v[84:87]
v_mfma_f32_16x16x32_bf16 v[84:87],a[140:143],a[36:39],v[84:87]
v_mfma_f32_16x16x32_bf16 v[84:87],a[136:139],a[32:35],v[84:87]
v_mfma_f32_16x16x32_bf16 v[84:87],a[132:135],a[28:31],v[84:87]
v_mfma_f32_16x16x32_bf16 v[84:87],a[128:131],a[24:27],v[84:87]
v_mfma_f32_16x16x32_bf16 v[92:95],a[128:131],a[48:51],0
v_mfma_f32_16x16x32_bf16 v[92:95],a[132:135],a[52:55],v[92:95]
buffer_load_dwordx4 v8,s[4:7],s20 offen offset:2048 lds
v_mfma_f32_16x16x32_bf16 v[92:95],a[136:139],a[56:59],v[92:95]
s_add_u32 s20,s20,12288
v_mfma_f32_16x16x32_bf16 v[92:95],a[140:143],a[60:63],v[92:95]
v_mfma_f32_16x16x32_bf16 v[92:95],a[144:147],a[64:67],v[92:95]
v_mfma_f32_16x16x32_bf16 v[92:95],a[148:151],a[68:71],v[92:95]
v_mfma_f32_16x16x32_bf16 v[100:103],a[148:151],a[92:95],0
v_mfma_f32_16x16x32_bf16 v[100:103],a[144:147],a[88:91],v[100:103]
ds_read_b64_tr_b16 a[120:121],v2 offset:24576
v_mfma_f32_16x16x32_bf16 v[100:103],a[140:143],a[84:87],v[100:103]
ds_read_b64_tr_b16 a[122:123],v2 offset:30720
v_mfma_f32_16x16x32_bf16 v[100:103],a[136:139],a[80:83],v[100:103]
ds_read_b64_tr_b16 a[124:125],v3 offset:24576
v_mfma_f32_16x16x32_bf16 v[100:103],a[132:135],a[76:79],v[100:103]
ds_read_b64_tr_b16 a[126:127],v3 offset:30720
v_mfma_f32_16x16x32_bf16 v[100:103],a[128:131],a[72:75],v[100:103]
v_mfma_f32_16x16x32_bf16 v[108:111],a[128:131],a[96:99],0
ds_read_b64_tr_b16 a[128:129],v4 offset:24576
v_mfma_f32_16x16x32_bf16 v[108:111],a[132:135],a[100:103],v[108:111]
ds_read_b64_tr_b16 a[130:131],v4 offset:30720
v_mfma_f32_16x16x32_bf16 v[108:111],a[136:139],a[104:107],v[108:111]
ds_read_b64_tr_b16 a[132:133],v5 offset:24576
v_mfma_f32_16x16x32_bf16 v[108:111],a[140:143],a[108:111],v[108:111]
ds_read_b64_tr_b16 a[134:135],v5 offset:30720
v_mfma_f32_16x16x32_bf16 v[108:111],a[144:147],a[112:115],v[108:111]
v_mfma_f32_16x16x32_bf16 v[108:111],a[148:151],a[116:119],v[108:111]
s_mov_b32 s38,0
s_branch L_loop5
L_start4:
s_add_u32 m0,s24,12288
s_waitcnt vmcnt(9)
ds_read_b128 a[0:3],v11 offset:0
buffer_load_dwordx4 v6,s[12:15],s28 offen offset:0 nt lds
ds_read_b128 a[4:7],v12 offset:0
buffer_load_dwordx4 v7,s[12:15],s28 offen offset:1024 nt lds
ds_read_b128 a[8:11],v11 offset:128
buffer_load_dwordx4 v8,s[12:15],s28 offen offset:2048 nt lds
s_add_u32 s28,s28,3072
s_add_u32 m0,s24,15360
ds_read_b128 a[12:15],v12 offset:128
buffer_load_dwordx4 v6,s[12:15],s28 offen offset:0 nt lds
ds_read_b128 a[16:19],v11 offset:256
buffer_load_dwordx4 v7,s[12:15],s28 offen offset:1024 nt lds
ds_read_b128 a[20:23],v12 offset:256
buffer_load_dwordx4 v8,s[12:15],s28 offen offset:2048 nt lds
s_add_u32 s28,s28,3072
s_add_u32 m0,s24,0
ds_read_b128 a[120:123],v0 offset:0
v_mov_b32 v60,0
ds_read_b128 a[124:127],v1 offset:0
v_mov_b32 v61,0
ds_read_b128 a[128:131],v0 offset:128
v_mov_b32 v62,0
ds_read_b128 a[132:135],v1 offset:128
v_mov_b32 v63,0
ds_read_b128 a[136:139],v0 offset:256
v_mov_b32 v64,0
ds_read_b128 a[140:143],v1 offset:256
v_mov_b32 v65,0
ds_read_b128 a[144:147],v0 offset:6144
v_mov_b32 v66,0
ds_read_b128 a[148:151],v1 offset:6144
v_mov_b32 v67,0
s_waitcnt lgkmcnt(7)
v_mfma_f32_16x16x32_bf16 v[72:75],a[120:123],a[0:3],0
s_waitcnt lgkmcnt(6)
ds_read_b128 a[120:123],v0 offset:6272
v_mfma_f32_16x16x32_bf16 v[72:75],a[124:127],a[4:7],v[72:75]
s_waitcnt lgkmcnt(6)
ds_read_b128 a[124:127],v1 offset:6272
v_mfma_f32_16x16x32_bf16 v[72:75],a[128:131],a[8:11],v[72:75]
s_waitcnt lgkmcnt(6)
ds_read_b128 a[128:131],v0 offset:6400
v_mfma_f32_16x16x32_bf16 v[72:75],a[132:135],a[12:15],v[72:75]
s_waitcnt lgkmcnt(6)
ds_read_b128 a[132:135],v1 offset:6400
v_mfma_f32_16x16x32_bf16 v[72:75],a[136:139],a[16:19],v[72:75]
s_waitcnt lgkmcnt(6)
ds_read_b128 a[136:139],v0 offset:0
v_mfma_f32_16x16x32_bf16 v[72:75],a[140:143],a[20:23],v[72:75]
s_waitcnt lgkmcnt(6)
ds_read_b128 a[140:143],v1 offset:0
v_mfma_f32_16x16x32_bf16 v[76:79],a[144:147],a[0:3],0
s_waitcnt lgkmcnt(6)
ds_read_b128 a[144:147],v0 offset:128
v_mfma_f32_16x16x32_bf16 v[76:79],a[148:151],a[4:7],v[76:79]
s_waitcnt lgkmcnt(6)
ds_read_b128 a[148:151],v1 offset:128
v_mfma_f32_16x16x32_bf16 v[76:79],a[120:123],a[8:11],v[76:79]
s_waitcnt lgkmcnt(6)
ds_read_b128 a[120:123],v0 offset:256
v_mfma_f32_16x16x32_bf16 v[76:79],a[124:127],a[12:15],v[76:79]
s_waitcnt lgkmcnt(6)
ds_read_b128 a[124:127],v1 offset:256
v_max3_f32 v44,v72,v73,v74
v_mfma_f32_16x16x32_bf16 v[76:79],a[128:131],a[16:19],v[76:79]
s_waitcnt lgkmcnt(6)
ds_read_b128 a[128:131],v0 offset:6144
v_mfma_f32_16x16x32_bf16 v[76:79],a[132:135],a[20:23],v[76:79]
s_waitcnt vmcnt(6)
ds_read_b128 a[24:27],v11 offset:6144
buffer_load_dwordx4 v6,s[12:15],s28 offen offset:0 nt lds
ds_read_b128 a[28:31],v12 offset:6144
buffer_load_dwordx4 v7,s[12:15],s28 offen offset:1024 nt lds
ds_read_b128 a[32:35],v11 offset:6272
buffer_load_dwordx4 v8,s[12:15],s28 offen offset:2048 nt lds
s_add_u32 s28,s28,3072
s_add_u32 m0,s24,3072
ds_read_b128 a[36:39],v12 offset:6272
buffer_load_dwordx4 v6,s[12:15],s28 offen offset:0 nt lds
ds_read_b128 a[40:43],v11 offset:6400
buffer_load_dwordx4 v7,s[12:15],s28 offen offset:1024 nt lds
ds_read_b128 a[44:47],v12 offset:6400
buffer_load_dwordx4 v8,s[12:15],s28 offen offset:2048 nt lds
s_add_u32 s28,s28,3072
s_add_u32 m0,s23,0
ds_read_b128 a[132:135],v1 offset:6144
v_max3_f32 v44,v44,v75,v76
s_waitcnt lgkmcnt(6)
v_mfma_f32_16x16x32_bf16 v[80:83],a[136:139],a[24:27],0
s_waitcnt lgkmcnt(5)
ds_read_b128 a[136:139],v0 offset:6272
v_max3_f32 v44,v44,v77,v78
v_mfma_f32_16x16x32_bf16 v[80:83],a[140:143],a[28:31],v[80:83]
s_waitcnt lgkmcnt(5)
ds_read_b128 a[140:143],v1 offset:6272
v_max_f32 v44,v44,v79
v_mfma_f32_16x16x32_bf16 v[80:83],a[144:147],a[32:35],v[80:83]
s_waitcnt lgkmcnt(5)
ds_read_b128 a[144:147],v0 offset:6400
v_mov_b32 v45,v44
v_mfma_f32_16x16x32_bf16 v[80:83],a[148:151],a[36:39],v[80:83]
s_waitcnt lgkmcnt(5)
ds_read_b128 a[148:151],v1 offset:6400
v_permlane32_swap_b32 v45,v44
v_mfma_f32_16x16x32_bf16 v[80:83],a[120:123],a[40:43],v[80:83]
s_waitcnt lgkmcnt(5)
ds_read_b128 a[120:123],v0 offset:12288
v_max_f32 v44,v44,v45
v_mfma_f32_16x16x32_bf16 v[80:83],a[124:127],a[44:47],v[80:83]
ds_read_b128 a[124:127],v1 offset:12288
v_mov_b32 v45,v44
v_mfma_f32_16x16x32_bf16 v[84:87],a[128:131],a[24:27],0
s_waitcnt lgkmcnt(5)
ds_read_b128 a[128:131],v0 offset:12416
v_permlane16_swap_b32 v45,v44
v_mfma_f32_16x16x32_bf16 v[84:87],a[132:135],a[28:31],v[84:87]
ds_read_b128 a[132:135],v1 offset:12416
v_max_f32 v44,v44,v45
v_mfma_f32_16x16x32_bf16 v[84:87],a[136:139],a[32:35],v[84:87]
s_waitcnt lgkmcnt(5)
ds_read_b128 a[136:139],v0 offset:12544
v_mul_f32_e64 v13,-s36,v44
v_mfma_f32_16x16x32_bf16 v[84:87],a[140:143],a[36:39],v[84:87]
ds_read_b128 a[140:143],v1 offset:12544
v_fma_f32 v72,v72,s36,v13
v_mfma_f32_16x16x32_bf16 v[84:87],a[144:147],a[40:43],v[84:87]
s_waitcnt lgkmcnt(5)
ds_read_b128 a[144:147],v0 offset:18432
v_fma_f32 v73,v73,s36,v13
v_mfma_f32_16x16x32_bf16 v[84:87],a[148:151],a[44:47],v[84:87]
ds_read_b128 a[148:151],v1 offset:18432
v_fma_f32 v74,v74,s36,v13
v_fma_f32 v75,v75,s36,v13
v_exp_f32 v72,v72
v_exp_f32 v73,v73
v_exp_f32 v74,v74
v_exp_f32 v75,v75
v_cvt_pk_bf16_f32 v20,v72,v73
v_cvt_pk_bf16_f32 v21,v74,v75
v_mfma_f32_16x16x32_bf16 v[72:75],a[120:123],a[0:3],0
s_waitcnt lgkmcnt(3)
ds_read_b128 a[120:123],v0 offset:18560
v_fma_f32 v76,v76,s36,v13
v_mfma_f32_16x16x32_bf16 v[72:75],a[124:127],a[4:7],v[72:75]
ds_read_b128 a[124:127],v1 offset:18560
v_fma_f32 v77,v77,s36,v13
v_mfma_f32_16x16x32_bf16 v[72:75],a[128:131],a[8:11],v[72:75]
ds_read_b128 a[128:131],v0 offset:18688
v_fma_f32 v78,v78,s36,v13
v_mfma_f32_16x16x32_bf16 v[72:75],a[132:135],a[12:15],v[72:75]
ds_read_b128 a[132:135],v1 offset:18688
v_fma_f32 v79,v79,s36,v13
v_mfma_f32_16x16x32_bf16 v[72:75],a[136:139],a[16:19],v[72:75]
s_waitcnt lgkmcnt(4)
ds_read_b128 a[136:139],v0 offset:0
v_exp_f32 v76,v76
v_mfma_f32_16x16x32_bf16 v[72:75],a[140:143],a[20:23],v[72:75]
ds_read_b128 a[140:143],v1 offset:0
v_exp_f32 v77,v77
v_exp_f32 v78,v78
v_exp_f32 v79,v79
v_cvt_pk_bf16_f32 v22,v76,v77
v_cvt_pk_bf16_f32 v23,v78,v79
v_mfma_f32_16x16x32_bf16 v[76:79],a[144:147],a[0:3],0
ds_read_b128 a[144:147],v0 offset:128
v_max3_f32 v48,v80,v81,v82
v_mfma_f32_16x16x32_bf16 v[76:79],a[148:151],a[4:7],v[76:79]
s_waitcnt lgkmcnt(4)
ds_read_b128 a[148:151],v1 offset:128
v_max3_f32 v48,v48,v83,v84
v_mfma_f32_16x16x32_bf16 v[76:79],a[120:123],a[8:11],v[76:79]
ds_read_b128 a[120:123],v0 offset:256
v_max3_f32 v48,v48,v85,v86
v_mfma_f32_16x16x32_bf16 v[76:79],a[124:127],a[12:15],v[76:79]
ds_read_b128 a[124:127],v1 offset:256
v_max_f32 v48,v48,v87
v_mfma_f32_16x16x32_bf16 v[76:79],a[128:131],a[16:19],v[76:79]
s_waitcnt lgkmcnt(4)
ds_read_b128 a[128:131],v0 offset:6144
v_mov_b32 v49,v48
v_mfma_f32_16x16x32_bf16 v[76:79],a[132:135],a[20:23],v[76:79]
s_waitcnt vmcnt(6)
ds_read_b128 a[48:51],v11 offset:12288
buffer_load_dwordx4 v6,s[8:11],s21 offen offset:0 lds
ds_read_b128 a[52:55],v12 offset:12288
buffer_load_dwordx4 v7,s[8:11],s21 offen offset:1024 lds
ds_read_b128 a[56:59],v11 offset:12416
buffer_load_dwordx4 v8,s[8:11],s21 offen offset:2048 lds
s_add_u32 s21,s21,12288
s_add_u32 m0,s22,24576
ds_read_b128 a[60:63],v12 offset:12416
buffer_load_dwordx4 v6,s[4:7],s20 offen offset:0 lds
ds_read_b128 a[64:67],v11 offset:12544
buffer_load_dwordx4 v7,s[4:7],s20 offen offset:1024 lds
ds_read_b128 a[68:71],v12 offset:12544
buffer_load_dwordx4 v8,s[4:7],s20 offen offset:2048 lds
s_add_u32 s20,s20,12288
s_add_u32 m0,s23,12288
ds_read_b128 a[132:135],v1 offset:6144
v_permlane32_swap_b32 v49,v48
s_waitcnt lgkmcnt(6)
v_mfma_f32_16x16x32_bf16 v[88:91],a[136:139],a[48:51],0
s_waitcnt lgkmcnt(5)
ds_read_b128 a[136:139],v0 offset:6272
v_max_f32 v48,v48,v49
v_mfma_f32_16x16x32_bf16 v[88:91],a[140:143],a[52:55],v[88:91]
s_waitcnt lgkmcnt(5)
ds_read_b128 a[140:143],v1 offset:6272
v_mov_b32 v49,v48
v_mfma_f32_16x16x32_bf16 v[88:91],a[144:147],a[56:59],v[88:91]
s_waitcnt lgkmcnt(5)
ds_read_b128 a[144:147],v0 offset:6400
v_permlane16_swap_b32 v49,v48
v_mfma_f32_16x16x32_bf16 v[88:91],a[148:151],a[60:63],v[88:91]
s_waitcnt lgkmcnt(4)
ds_read_b128 a[148:151],v1 offset:6400
v_max_f32 v48,v48,v49
v_mfma_f32_16x16x32_bf16 v[88:91],a[120:123],a[64:67],v[88:91]
ds_read_b128 a[120:123],v0 offset:12288
v_mul_f32_e64 v14,-s36,v48
v_mfma_f32_16x16x32_bf16 v[88:91],a[124:127],a[68:71],v[88:91]
ds_read_b128 a[124:127],v1 offset:12288
v_fma_f32 v80,v80,s36,v14
v_mfma_f32_16x16x32_bf16 v[92:95],a[128:131],a[48:51],0
s_waitcnt lgkmcnt(5)
ds_read_b128 a[128:131],v0 offset:12416
v_fma_f32 v81,v81,s36,v14
v_mfma_f32_16x16x32_bf16 v[92:95],a[132:135],a[52:55],v[92:95]
ds_read_b128 a[132:135],v1 offset:12416
v_fma_f32 v82,v82,s36,v14
v_mfma_f32_16x16x32_bf16 v[92:95],a[136:139],a[56:59],v[92:95]
s_waitcnt lgkmcnt(5)
ds_read_b128 a[136:139],v0 offset:12544
v_fma_f32 v83,v83,s36,v14
v_mfma_f32_16x16x32_bf16 v[92:95],a[140:143],a[60:63],v[92:95]
ds_read_b128 a[140:143],v1 offset:12544
v_exp_f32 v80,v80
v_mfma_f32_16x16x32_bf16 v[92:95],a[144:147],a[64:67],v[92:95]
s_waitcnt lgkmcnt(5)
ds_read_b128 a[144:147],v0 offset:18432
v_exp_f32 v81,v81
v_mfma_f32_16x16x32_bf16 v[92:95],a[148:151],a[68:71],v[92:95]
ds_read_b128 a[148:151],v1 offset:18432
v_exp_f32 v82,v82
v_exp_f32 v83,v83
v_cvt_pk_bf16_f32 v24,v80,v81
v_cvt_pk_bf16_f32 v25,v82,v83
v_mfma_f32_16x16x32_bf16 v[80:83],a[120:123],a[24:27],0
s_waitcnt lgkmcnt(4)
ds_read_b128 a[120:123],v0 offset:18560
v_fma_f32 v84,v84,s36,v14
v_mfma_f32_16x16x32_bf16 v[80:83],a[124:127],a[28:31],v[80:83]
ds_read_b128 a[124:127],v1 offset:18560
v_fma_f32 v85,v85,s36,v14
v_mfma_f32_16x16x32_bf16 v[80:83],a[128:131],a[32:35],v[80:83]
ds_read_b128 a[128:131],v0 offset:18688
v_fma_f32 v86,v86,s36,v14
v_mfma_f32_16x16x32_bf16 v[80:83],a[132:135],a[36:39],v[80:83]
s_waitcnt lgkmcnt(4)
ds_read_b128 a[132:135],v1 offset:18688
v_fma_f32 v87,v87,s36,v14
v_mfma_f32_16x16x32_bf16 v[80:83],a[136:139],a[40:43],v[80:83]
ds_read_b128 a[136:139],v0 offset:0
v_exp_f32 v84,v84
v_mfma_f32_16x16x32_bf16 v[80:83],a[140:143],a[44:47],v[80:83]
ds_read_b128 a[140:143],v1 offset:0
v_exp_f32 v85,v85
v_exp_f32 v86,v86
v_exp_f32 v87,v87
v_cvt_pk_bf16_f32 v26,v84,v85
v_cvt_pk_bf16_f32 v27,v86,v87
v_mfma_f32_16x16x32_bf16 v[84:87],a[144:147],a[24:27],0
ds_read_b128 a[144:147],v0 offset:128
v_max3_f32 v52,v88,v89,v90
v_smfmac_f32_16x16x64_bf16 v[60:63],a[152:155],v[20:27],v18
s_waitcnt lgkmcnt(4)
v_max3_f32 v52,v52,v91,v92
v_mfma_f32_16x16x32_bf16 v[84:87],a[148:151],a[28:31],v[84:87]
ds_read_b128 a[148:151],v1 offset:128
v_max3_f32 v52,v52,v93,v94
v_mfma_f32_16x16x32_bf16 v[84:87],a[120:123],a[32:35],v[84:87]
ds_read_b128 a[120:123],v0 offset:256
v_max_f32 v52,v52,v95
v_mfma_f32_16x16x32_bf16 v[84:87],a[124:127],a[36:39],v[84:87]
ds_read_b128 a[124:127],v1 offset:256
v_mov_b32 v53,v52
v_mfma_f32_16x16x32_bf16 v[84:87],a[128:131],a[40:43],v[84:87]
s_waitcnt lgkmcnt(4)
ds_read_b128 a[128:131],v0 offset:6144
v_permlane32_swap_b32 v53,v52
v_mfma_f32_16x16x32_bf16 v[84:87],a[132:135],a[44:47],v[84:87]
s_waitcnt vmcnt(6)
ds_read_b128 a[72:75],v11 offset:0
buffer_load_dwordx4 v6,s[8:11],s21 offen offset:0 lds
ds_read_b128 a[76:79],v12 offset:0
buffer_load_dwordx4 v7,s[8:11],s21 offen offset:1024 lds
ds_read_b128 a[80:83],v11 offset:128
buffer_load_dwordx4 v8,s[8:11],s21 offen offset:2048 lds
s_add_u32 s21,s21,12288
s_add_u32 m0,s23,24576
ds_read_b128 a[84:87],v12 offset:128
buffer_load_dwordx4 v6,s[8:11],s21 offen offset:0 lds
ds_read_b128 a[88:91],v11 offset:256
buffer_load_dwordx4 v7,s[8:11],s21 offen offset:1024 lds
ds_read_b128 a[92:95],v12 offset:256
buffer_load_dwordx4 v8,s[8:11],s21 offen offset:2048 lds
s_add_u32 s21,s21,12288
ds_read_b128 a[132:135],v1 offset:6144
v_max_f32 v52,v52,v53
v_mov_b32 v53,v52
s_waitcnt lgkmcnt(6)
v_mfma_f32_16x16x32_bf16 v[96:99],a[136:139],a[72:75],0
s_mov_b32 s27,166723584
ds_read_b128 a[136:139],v0 offset:6272
v_permlane16_swap_b32 v53,v52
s_waitcnt lgkmcnt(6)
v_mfma_f32_16x16x32_bf16 v[96:99],a[140:143],a[76:79],v[96:99]
s_mov_b32 s42,s41
ds_read_b128 a[140:143],v1 offset:6272
v_max_f32 v52,v52,v53
s_waitcnt lgkmcnt(6)
v_mfma_f32_16x16x32_bf16 v[96:99],a[144:147],a[80:83],v[96:99]
s_add_u32 s69,s69,1
ds_read_b128 a[144:147],v0 offset:6400
v_mul_f32_e64 v15,-s36,v52
v_fma_f32 v88,v88,s36,v15
s_waitcnt lgkmcnt(6)
v_mfma_f32_16x16x32_bf16 v[96:99],a[148:151],a[84:87],v[96:99]
s_lshl_b32 s62,s69,5
ds_read_b128 a[148:151],v1 offset:6400
v_fma_f32 v89,v89,s36,v15
s_waitcnt lgkmcnt(5)
v_mfma_f32_16x16x32_bf16 v[96:99],a[120:123],a[88:91],v[96:99]
s_add_u32 s62,s62,s34
ds_read_b128 a[120:123],v0 offset:12288
v_fma_f32 v90,v90,s36,v15
v_mfma_f32_16x16x32_bf16 v[96:99],a[124:127],a[92:95],v[96:99]
s_mul_i32 s63,s62,171
ds_read_b128 a[124:127],v1 offset:12288
v_fma_f32 v91,v91,s36,v15
v_mfma_f32_16x16x32_bf16 v[100:103],a[128:131],a[72:75],0
s_lshr_b32 s63,s63,9
ds_read_b128 a[128:131],v0 offset:12416
v_exp_f32 v88,v88
s_waitcnt lgkmcnt(6)
v_mfma_f32_16x16x32_bf16 v[100:103],a[132:135],a[76:79],v[100:103]
s_mul_i32 s64,s63,3
ds_read_b128 a[132:135],v1 offset:12416
v_exp_f32 v89,v89
v_mfma_f32_16x16x32_bf16 v[100:103],a[136:139],a[80:83],v[100:103]
s_sub_u32 s62,s62,s64
ds_read_b128 a[136:139],v0 offset:12544
v_exp_f32 v90,v90
s_waitcnt lgkmcnt(6)
v_mfma_f32_16x16x32_bf16 v[100:103],a[140:143],a[84:87],v[100:103]
s_add_u32 s63,s63,s33
ds_read_b128 a[140:143],v1 offset:12544
v_exp_f32 v91,v91
v_mfma_f32_16x16x32_bf16 v[100:103],a[144:147],a[88:91],v[100:103]
s_mul_i32 s30,s63,196608
ds_read_b128 a[144:147],v0 offset:18432
v_cvt_pk_bf16_f32 v28,v88,v89
s_waitcnt lgkmcnt(6)
v_mfma_f32_16x16x32_bf16 v[100:103],a[148:151],a[92:95],v[100:103]
s_waitcnt vmcnt(9)
s_barrier
ds_read_b128 a[148:151],v1 offset:18432
v_cvt_pk_bf16_f32 v29,v90,v91
v_mfma_f32_16x16x32_bf16 v[88:91],a[120:123],a[48:51],0
s_mul_i32 s41,s63,325632
ds_read_b128 a[120:123],v0 offset:18560
v_fma_f32 v92,v92,s36,v15
s_waitcnt lgkmcnt(5)
v_mfma_f32_16x16x32_bf16 v[88:91],a[124:127],a[52:55],v[88:91]
s_lshl_b32 s63,s3,2
ds_read_b128 a[124:127],v1 offset:18560
v_fma_f32 v93,v93,s36,v15
v_mfma_f32_16x16x32_bf16 v[88:91],a[128:131],a[56:59],v[88:91]
s_add_u32 s64,s63,21
ds_read_b128 a[128:131],v0 offset:18688
v_fma_f32 v94,v94,s36,v15
v_mfma_f32_16x16x32_bf16 v[88:91],a[132:135],a[60:63],v[88:91]
s_cmp_eq_u32 s3,0
ds_read_b128 a[132:135],v1 offset:18688
v_fma_f32 v95,v95,s36,v15
s_waitcnt lgkmcnt(6)
v_mfma_f32_16x16x32_bf16 v[88:91],a[136:139],a[64:67],v[88:91]
s_cselect_b32 s64,20,s64
ds_read_b128 a[136:139],v0 offset:12288
v_exp_f32 v92,v92
v_mfma_f32_16x16x32_bf16 v[88:91],a[140:143],a[68:71],v[88:91]
s_cselect_b32 s40,1,0
ds_read_b128 a[140:143],v1 offset:12288
v_exp_f32 v93,v93
v_exp_f32 v94,v94
v_exp_f32 v95,v95
v_cvt_pk_bf16_f32 v30,v92,v93
v_cvt_pk_bf16_f32 v31,v94,v95
s_waitcnt lgkmcnt(5)
v_mfma_f32_16x16x32_bf16 v[92:95],a[144:147],a[48:51],0
s_add_u32 s65,s63,37
ds_read_b128 a[144:147],v0 offset:12416
v_max3_f32 v56,v96,v97,v98
v_mfma_f32_16x16x32_bf16 v[92:95],a[148:151],a[52:55],v[92:95]
s_cmp_eq_u32 s62,2
ds_read_b128 a[148:151],v1 offset:12416
v_max3_f32 v56,v56,v99,v100
v_mfma_f32_16x16x32_bf16 v[92:95],a[120:123],a[56:59],v[92:95]
s_cselect_b32 s64,s65,s64
ds_read_b128 a[120:123],v0 offset:12544
v_max3_f32 v56,v56,v101,v102
s_waitcnt lgkmcnt(5)
v_mfma_f32_16x16x32_bf16 v[92:95],a[124:127],a[60:63],v[92:95]
s_cselect_b32 s40,0,s40
ds_read_b128 a[124:127],v1 offset:12544
v_max_f32 v56,v56,v103
v_mfma_f32_16x16x32_bf16 v[92:95],a[128:131],a[64:67],v[92:95]
s_add_u32 s65,s63,s3
ds_read_b128 a[128:131],v0 offset:18432
v_mov_b32 v57,v56
v_mfma_f32_16x16x32_bf16 v[92:95],a[132:135],a[68:71],v[92:95]
s_cmp_eq_u32 s62,0
ds_read_b128 a[132:135],v1 offset:18432
v_permlane32_swap_b32 v57,v56
v_max_f32 v56,v56,v57
v_mov_b32 v57,v56
v_fma_f32 v72,v72,s36,v13
v_fma_f32 v73,v73,s36,v13
v_permlane16_swap_b32 v57,v56
v_max_f32 v56,v56,v57
v_mul_f32_e64 v16,-s36,v56
v_fma_f32 v96,v96,s36,v16
v_fma_f32 v97,v97,s36,v16
v_fma_f32 v98,v98,s36,v16
v_fma_f32 v99,v99,s36,v16
v_exp_f32 v96,v96
v_exp_f32 v97,v97
v_exp_f32 v98,v98
v_exp_f32 v99,v99
v_cvt_pk_bf16_f32 v32,v96,v97
v_cvt_pk_bf16_f32 v33,v98,v99
s_waitcnt lgkmcnt(2)
v_mfma_f32_16x16x32_bf16 v[96:99],a[136:139],a[72:75],0
s_cselect_b32 s64,s65,s64
ds_read_b128 a[136:139],v0 offset:18560
v_fma_f32 v100,v100,s36,v16
v_mfma_f32_16x16x32_bf16 v[96:99],a[140:143],a[76:79],v[96:99]
s_cselect_b32 s40,1,s40
ds_read_b128 a[140:143],v1 offset:18560
v_fma_f32 v101,v101,s36,v16
v_mfma_f32_16x16x32_bf16 v[96:99],a[144:147],a[80:83],v[96:99]
s_mul_i32 s64,s64,6144
ds_read_b128 a[144:147],v0 offset:18688
v_fma_f32 v102,v102,s36,v16
v_mfma_f32_16x16x32_bf16 v[96:99],a[148:151],a[84:87],v[96:99]
s_add_u32 s41,s41,s64
ds_read_b128 a[148:151],v1 offset:18688
v_fma_f32 v103,v103,s36,v16
v_mfma_f32_16x16x32_bf16 v[96:99],a[120:123],a[88:91],v[96:99]
s_cmp_ge_u32 s69,6
ds_read_b64_tr_b16 a[120:121],v2 offset:0
v_exp_f32 v100,v100
v_mfma_f32_16x16x32_bf16 v[96:99],a[124:127],a[92:95],v[96:99]
s_cselect_b32 s41,166723584,s41
ds_read_b64_tr_b16 a[122:123],v2 offset:6144
ds_read_b64_tr_b16 a[124:125],v3 offset:0
ds_read_b64_tr_b16 a[126:127],v3 offset:6144
v_exp_f32 v101,v101
v_exp_f32 v102,v102
v_exp_f32 v103,v103
v_cvt_pk_bf16_f32 v34,v100,v101
v_cvt_pk_bf16_f32 v35,v102,v103
s_waitcnt lgkmcnt(7)
v_mfma_f32_16x16x32_bf16 v[100:103],a[128:131],a[72:75],0
s_cselect_b32 s30,100663296,s30
ds_read_b64_tr_b16 a[128:129],v4 offset:0
v_fma_f32 v74,v74,s36,v13
v_smfmac_f32_16x16x64_bf16 v[64:67],a[152:155],v[28:35],v18
s_add_u32 s25,s30,s22
s_add_u32 s26,s25,12288
ds_read_b64_tr_b16 a[130:131],v4 offset:6144
v_mfma_f32_16x16x32_bf16 v[100:103],a[132:135],a[76:79],v[100:103]
s_mov_b32 s28,s41
ds_read_b64_tr_b16 a[132:133],v5 offset:0
v_fma_f32 v75,v75,s36,v13
v_mfma_f32_16x16x32_bf16 v[100:103],a[136:139],a[80:83],v[100:103]
s_mov_b32 s29,s24
ds_read_b64_tr_b16 a[134:135],v5 offset:6144
v_fma_f32 v80,v80,s36,v14
s_waitcnt lgkmcnt(7)
v_mfma_f32_16x16x32_bf16 v[100:103],a[140:143],a[84:87],v[100:103]
s_add_u32 m0,s22,0
v_fma_f32 v81,v81,s36,v14
v_exp_f32 v72,v72
v_mfma_f32_16x16x32_bf16 v[100:103],a[144:147],a[88:91],v[100:103]
buffer_load_dwordx4 v6,s[4:7],s20 offen offset:0 lds
v_mfma_f32_16x16x32_bf16 v[100:103],a[148:151],a[92:95],v[100:103]
buffer_load_dwordx4 v7,s[4:7],s20 offen offset:1024 lds
buffer_load_dwordx4 v8,s[4:7],s20 offen offset:2048 lds
v_exp_f32 v73,v73
v_exp_f32 v74,v74
v_exp_f32 v75,v75
v_exp_f32 v80,v80
v_exp_f32 v81,v81
v_cvt_pk_bf16_f32 v44,v72,v73
v_cvt_pk_bf16_f32 v45,v74,v75
v_cvt_pk_bf16_f32 v48,v80,v81
s_add_u32 s20,s20,12288
s_waitcnt lgkmcnt(0)
v_mfma_f32_16x16x32_bf16 v[160:163],a[120:123],v[20:23],0
s_add_u32 m0,s23,0
ds_read_b64_tr_b16 a[136:137],v2 offset:128
v_fma_f32 v82,v82,s36,v14
v_mfma_f32_16x16x32_bf16 v[164:167],a[124:127],v[20:23],0
ds_read_b64_tr_b16 a[138:139],v2 offset:6272
v_fma_f32 v83,v83,s36,v14
v_mfma_f32_16x16x32_bf16 v[212:215],a[124:127],v[24:27],0
ds_read_b64_tr_b16 a[140:141],v3 offset:128
v_fma_f32 v88,v88,s36,v15
v_mfma_f32_16x16x32_bf16 v[208:211],a[120:123],v[24:27],0
ds_read_b64_tr_b16 a[142:143],v3 offset:6272
v_fma_f32 v89,v89,s36,v15
v_mfma_f32_16x16x32_bf16 v[112:115],a[120:123],v[28:31],0
ds_read_b64_tr_b16 a[144:145],v4 offset:128
v_fma_f32 v90,v90,s36,v15
v_mfma_f32_16x16x32_bf16 v[116:119],a[124:127],v[28:31],0
ds_read_b64_tr_b16 a[146:147],v4 offset:6272
v_fma_f32 v91,v91,s36,v15
v_mfma_f32_16x16x32_bf16 a[164:167],a[124:127],v[32:35],0
ds_read_b64_tr_b16 a[148:149],v5 offset:128
v_fma_f32 v96,v96,s36,v16
v_mfma_f32_16x16x32_bf16 a[160:163],a[120:123],v[32:35],0
ds_read_b64_tr_b16 a[150:151],v5 offset:6272
v_fma_f32 v97,v97,s36,v16
v_mfma_f32_16x16x32_bf16 a[168:171],a[128:131],v[32:35],0
ds_read_b64_tr_b16 a[120:121],v2 offset:256
v_fma_f32 v98,v98,s36,v16
v_mfma_f32_16x16x32_bf16 a[172:175],a[132:135],v[32:35],0
ds_read_b64_tr_b16 a[122:123],v2 offset:6400
v_fma_f32 v99,v99,s36,v16
v_mfma_f32_16x16x32_bf16 v[124:127],a[132:135],v[28:31],0
ds_read_b64_tr_b16 a[124:125],v3 offset:256
v_fma_f32 v76,v76,s36,v13
v_mfma_f32_16x16x32_bf16 v[120:123],a[128:131],v[28:31],0
ds_read_b64_tr_b16 a[126:127],v3 offset:6400
v_fma_f32 v77,v77,s36,v13
v_mfma_f32_16x16x32_bf16 v[216:219],a[128:131],v[24:27],0
v_exp_f32 v82,v82
v_mfma_f32_16x16x32_bf16 v[220:223],a[132:135],v[24:27],0
v_exp_f32 v83,v83
v_mfma_f32_16x16x32_bf16 v[172:175],a[132:135],v[20:23],0
ds_read_b64_tr_b16 a[132:133],v5 offset:256
v_cvt_pk_bf16_f32 v49,v82,v83
v_mfma_f32_16x16x32_bf16 v[168:171],a[128:131],v[20:23],0
s_waitcnt lgkmcnt(4)
ds_read_b64_tr_b16 a[128:129],v4 offset:256
v_fma_f32 v78,v78,s36,v13
v_mfma_f32_16x16x32_bf16 v[176:179],a[136:139],v[20:23],0
ds_read_b64_tr_b16 a[130:131],v4 offset:6400
v_fma_f32 v79,v79,s36,v13
v_mfma_f32_16x16x32_bf16 v[180:183],a[140:143],v[20:23],0
ds_read_b64_tr_b16 a[134:135],v5 offset:6400
v_fma_f32 v84,v84,s36,v14
v_mfma_f32_16x16x32_bf16 v[228:231],a[140:143],v[24:27],0
v_exp_f32 v88,v88
v_mfma_f32_16x16x32_bf16 v[224:227],a[136:139],v[24:27],0
v_exp_f32 v89,v89
v_mfma_f32_16x16x32_bf16 v[128:131],a[136:139],v[28:31],0
v_exp_f32 v90,v90
v_mfma_f32_16x16x32_bf16 v[132:135],a[140:143],v[28:31],0
v_exp_f32 v91,v91
v_mfma_f32_16x16x32_bf16 a[180:183],a[140:143],v[32:35],0
v_cvt_pk_bf16_f32 v52,v88,v89
v_cvt_pk_bf16_f32 v53,v90,v91
v_mfma_f32_16x16x32_bf16 a[176:179],a[136:139],v[32:35],0
v_exp_f32 v96,v96
v_mfma_f32_16x16x32_bf16 a[184:187],a[144:147],v[32:35],0
v_exp_f32 v97,v97
v_mfma_f32_16x16x32_bf16 a[188:191],a[148:151],v[32:35],0
v_exp_f32 v98,v98
v_mfma_f32_16x16x32_bf16 v[140:143],a[148:151],v[28:31],0
v_exp_f32 v99,v99
v_mfma_f32_16x16x32_bf16 v[136:139],a[144:147],v[28:31],0
v_cvt_pk_bf16_f32 v56,v96,v97
v_cvt_pk_bf16_f32 v57,v98,v99
v_mfma_f32_16x16x32_bf16 v[232:235],a[144:147],v[24:27],0
v_exp_f32 v76,v76
v_mfma_f32_16x16x32_bf16 v[236:239],a[148:151],v[24:27],0
v_exp_f32 v77,v77
v_mfma_f32_16x16x32_bf16 v[188:191],a[148:151],v[20:23],0
v_exp_f32 v78,v78
v_mfma_f32_16x16x32_bf16 v[184:187],a[144:147],v[20:23],0
s_waitcnt lgkmcnt(0)
v_exp_f32 v79,v79
v_mfma_f32_16x16x32_bf16 v[192:195],a[120:123],v[20:23],0
v_cvt_pk_bf16_f32 v46,v76,v77
v_cvt_pk_bf16_f32 v47,v78,v79
v_mfma_f32_16x16x32_bf16 v[196:199],a[124:127],v[20:23],0
s_waitcnt vmcnt(6)
v_fma_f32 v85,v85,s36,v14
v_fma_f32 v86,v86,s36,v14
v_mfma_f32_16x16x32_bf16 v[244:247],a[124:127],v[24:27],0
s_barrier
v_mfma_f32_16x16x32_bf16 v[240:243],a[120:123],v[24:27],0
ds_read_b128 a[148:151],v1 offset:24704
v_fma_f32 v87,v87,s36,v14
v_mfma_f32_16x16x32_bf16 v[144:147],a[120:123],v[28:31],0
ds_read_b128 a[144:147],v0 offset:24704
v_fma_f32 v92,v92,s36,v15
v_mfma_f32_16x16x32_bf16 v[148:151],a[124:127],v[28:31],0
ds_read_b128 a[140:143],v1 offset:24576
v_fma_f32 v93,v93,s36,v15
v_mfma_f32_16x16x32_bf16 a[196:199],a[124:127],v[32:35],0
ds_read_b128 a[124:127],v1 offset:24832
v_fma_f32 v94,v94,s36,v15
v_mfma_f32_16x16x32_bf16 a[192:195],a[120:123],v[32:35],0
ds_read_b128 a[120:123],v0 offset:24832
v_fma_f32 v95,v95,s36,v15
v_mfma_f32_16x16x32_bf16 a[200:203],a[128:131],v[32:35],0
buffer_load_dwordx4 v6,s[8:11],s21 offen offset:0 lds
v_mfma_f32_16x16x32_bf16 a[204:207],a[132:135],v[32:35],0
ds_read_b128 a[136:139],v0 offset:24576
v_fma_f32 v100,v100,s36,v16
v_mfma_f32_16x16x32_bf16 v[156:159],a[132:135],v[28:31],0
v_exp_f32 v84,v84
v_mfma_f32_16x16x32_bf16 v[152:155],a[128:131],v[28:31],0
v_exp_f32 v85,v85
v_mfma_f32_16x16x32_bf16 v[248:251],a[128:131],v[24:27],0
v_exp_f32 v86,v86
v_mfma_f32_16x16x32_bf16 v[252:255],a[132:135],v[24:27],0
v_exp_f32 v87,v87
v_mfma_f32_16x16x32_bf16 v[204:207],a[132:135],v[20:23],0
ds_read_b128 a[132:135],v1 offset:30720
v_cvt_pk_bf16_f32 v50,v84,v85
v_mfma_f32_16x16x32_bf16 v[200:203],a[128:131],v[20:23],0
s_waitcnt lgkmcnt(2)
ds_read_b128 a[128:131],v0 offset:30720
v_cvt_pk_bf16_f32 v51,v86,v87
v_mfma_f32_16x16x32_bf16 v[72:75],a[124:127],a[20:23],0
v_exp_f32 v92,v92
v_smfmac_f32_16x16x64_bf16 v[60:63],a[152:155],v[44:51],v18
buffer_load_dwordx4 v7,s[8:11],s21 offen offset:1024 lds
v_mfma_f32_16x16x32_bf16 v[72:75],a[120:123],a[16:19],v[72:75]
v_exp_f32 v93,v93
v_mfma_f32_16x16x32_bf16 v[72:75],a[148:151],a[12:15],v[72:75]
v_exp_f32 v94,v94
v_mfma_f32_16x16x32_bf16 v[72:75],a[144:147],a[8:11],v[72:75]
v_exp_f32 v95,v95
v_mfma_f32_16x16x32_bf16 v[72:75],a[140:143],a[4:7],v[72:75]
s_waitcnt lgkmcnt(1)
v_cvt_pk_bf16_f32 v54,v92,v93
v_cvt_pk_bf16_f32 v55,v94,v95
v_mfma_f32_16x16x32_bf16 v[72:75],a[136:139],a[0:3],v[72:75]
v_fma_f32 v101,v101,s36,v16
v_fma_f32 v102,v102,s36,v16
v_mfma_f32_16x16x32_bf16 v[80:83],a[136:139],a[24:27],0
v_fma_f32 v103,v103,s36,v16
v_mfma_f32_16x16x32_bf16 v[80:83],a[140:143],a[28:31],v[80:83]
v_exp_f32 v100,v100
v_mfma_f32_16x16x32_bf16 v[80:83],a[144:147],a[32:35],v[80:83]
buffer_load_dwordx4 v8,s[8:11],s21 offen offset:2048 lds
v_mfma_f32_16x16x32_bf16 v[80:83],a[148:151],a[36:39],v[80:83]
s_add_u32 s21,s21,12288
v_exp_f32 v101,v101
v_mfma_f32_16x16x32_bf16 v[80:83],a[120:123],a[40:43],v[80:83]
s_add_u32 m0,s22,12288
v_exp_f32 v102,v102
v_mfma_f32_16x16x32_bf16 v[80:83],a[124:127],a[44:47],v[80:83]
v_exp_f32 v103,v103
v_mfma_f32_16x16x32_bf16 v[88:91],a[124:127],a[68:71],0
v_cvt_pk_bf16_f32 v58,v100,v101
v_cvt_pk_bf16_f32 v59,v102,v103
v_mfma_f32_16x16x32_bf16 v[88:91],a[120:123],a[64:67],v[88:91]
v_fma_f32 v72,v72,s36,v13
v_fma_f32 v73,v73,s36,v13
v_smfmac_f32_16x16x64_bf16 v[64:67],a[152:155],v[52:59],v18
v_fma_f32 v74,v74,s36,v13
v_mfma_f32_16x16x32_bf16 v[88:91],a[148:151],a[60:63],v[88:91]
v_fma_f32 v75,v75,s36,v13
v_fma_f32 v80,v80,s36,v14
v_mfma_f32_16x16x32_bf16 v[88:91],a[144:147],a[56:59],v[88:91]
v_fma_f32 v81,v81,s36,v14
v_mfma_f32_16x16x32_bf16 v[88:91],a[140:143],a[52:55],v[88:91]
buffer_load_dwordx4 v6,s[4:7],s20 offen offset:0 lds
v_mfma_f32_16x16x32_bf16 v[88:91],a[136:139],a[48:51],v[88:91]
v_exp_f32 v72,v72
v_mfma_f32_16x16x32_bf16 v[96:99],a[136:139],a[72:75],0
ds_read_b128 a[136:139],v0 offset:30848
v_mfma_f32_16x16x32_bf16 v[96:99],a[140:143],a[76:79],v[96:99]
ds_read_b128 a[140:143],v1 offset:30848
v_mfma_f32_16x16x32_bf16 v[96:99],a[144:147],a[80:83],v[96:99]
ds_read_b128 a[144:147],v0 offset:30976
v_mfma_f32_16x16x32_bf16 v[96:99],a[148:151],a[84:87],v[96:99]
ds_read_b128 a[148:151],v1 offset:30976
v_mfma_f32_16x16x32_bf16 v[96:99],a[120:123],a[88:91],v[96:99]
v_exp_f32 v73,v73
v_mfma_f32_16x16x32_bf16 v[96:99],a[124:127],a[92:95],v[96:99]
s_waitcnt lgkmcnt(4)
v_exp_f32 v74,v74
v_mfma_f32_16x16x32_bf16 v[76:79],a[128:131],a[0:3],0
v_exp_f32 v75,v75
v_mfma_f32_16x16x32_bf16 v[76:79],a[132:135],a[4:7],v[76:79]
buffer_load_dwordx4 v7,s[4:7],s20 offen offset:1024 lds
s_waitcnt lgkmcnt(3)
v_mfma_f32_16x16x32_bf16 v[76:79],a[136:139],a[8:11],v[76:79]
s_waitcnt lgkmcnt(2)
v_exp_f32 v80,v80
v_mfma_f32_16x16x32_bf16 v[76:79],a[140:143],a[12:15],v[76:79]
s_waitcnt lgkmcnt(0)
v_exp_f32 v81,v81
v_mfma_f32_16x16x32_bf16 v[76:79],a[144:147],a[16:19],v[76:79]
v_cvt_pk_bf16_f32 v20,v72,v73
v_cvt_pk_bf16_f32 v21,v74,v75
v_mfma_f32_16x16x32_bf16 v[76:79],a[148:151],a[20:23],v[76:79]
v_cvt_pk_bf16_f32 v24,v80,v81
v_mfma_f32_16x16x32_bf16 v[84:87],a[148:151],a[44:47],0
v_mfma_f32_16x16x32_bf16 v[84:87],a[144:147],a[40:43],v[84:87]
v_mfma_f32_16x16x32_bf16 v[84:87],a[140:143],a[36:39],v[84:87]
v_mfma_f32_16x16x32_bf16 v[84:87],a[136:139],a[32:35],v[84:87]
v_mfma_f32_16x16x32_bf16 v[84:87],a[132:135],a[28:31],v[84:87]
buffer_load_dwordx4 v8,s[4:7],s20 offen offset:2048 lds
v_mfma_f32_16x16x32_bf16 v[84:87],a[128:131],a[24:27],v[84:87]
s_add_u32 s20,s20,12288
v_mfma_f32_16x16x32_bf16 v[92:95],a[128:131],a[48:51],0
ds_read_b64_tr_b16 a[120:121],v2 offset:12288
v_mfma_f32_16x16x32_bf16 v[92:95],a[132:135],a[52:55],v[92:95]
ds_read_b64_tr_b16 a[122:123],v2 offset:18432
v_mfma_f32_16x16x32_bf16 v[92:95],a[136:139],a[56:59],v[92:95]
ds_read_b64_tr_b16 a[124:125],v3 offset:12288
v_mfma_f32_16x16x32_bf16 v[92:95],a[140:143],a[60:63],v[92:95]
ds_read_b64_tr_b16 a[126:127],v3 offset:18432
v_mfma_f32_16x16x32_bf16 v[92:95],a[144:147],a[64:67],v[92:95]
v_mfma_f32_16x16x32_bf16 v[92:95],a[148:151],a[68:71],v[92:95]
v_mfma_f32_16x16x32_bf16 v[100:103],a[148:151],a[92:95],0
v_mfma_f32_16x16x32_bf16 v[100:103],a[144:147],a[88:91],v[100:103]
v_mfma_f32_16x16x32_bf16 v[100:103],a[140:143],a[84:87],v[100:103]
v_mfma_f32_16x16x32_bf16 v[100:103],a[136:139],a[80:83],v[100:103]
v_mfma_f32_16x16x32_bf16 v[100:103],a[132:135],a[76:79],v[100:103]
ds_read_b64_tr_b16 a[132:133],v5 offset:12288
v_mfma_f32_16x16x32_bf16 v[100:103],a[128:131],a[72:75],v[100:103]
s_waitcnt lgkmcnt(1)
ds_read_b64_tr_b16 a[128:129],v4 offset:12288
ds_read_b64_tr_b16 a[130:131],v4 offset:18432
ds_read_b64_tr_b16 a[134:135],v5 offset:18432
v_mfma_f32_16x16x32_bf16 v[160:163],a[120:123],v[44:47],v[160:163]
s_add_u32 m0,s23,12288
ds_read_b64_tr_b16 a[136:137],v2 offset:12416
v_fma_f32 v82,v82,s36,v14
v_mfma_f32_16x16x32_bf16 v[164:167],a[124:127],v[44:47],v[164:167]
ds_read_b64_tr_b16 a[138:139],v2 offset:18560
v_fma_f32 v83,v83,s36,v14
v_mfma_f32_16x16x32_bf16 v[212:215],a[124:127],v[48:51],v[212:215]
ds_read_b64_tr_b16 a[140:141],v3 offset:12416
v_fma_f32 v88,v88,s36,v15
v_mfma_f32_16x16x32_bf16 v[208:211],a[120:123],v[48:51],v[208:211]
ds_read_b64_tr_b16 a[142:143],v3 offset:18560
v_fma_f32 v89,v89,s36,v15
v_mfma_f32_16x16x32_bf16 v[112:115],a[120:123],v[52:55],v[112:115]
ds_read_b64_tr_b16 a[144:145],v4 offset:12416
v_fma_f32 v90,v90,s36,v15
v_mfma_f32_16x16x32_bf16 v[116:119],a[124:127],v[52:55],v[116:119]
ds_read_b64_tr_b16 a[146:147],v4 offset:18560
v_fma_f32 v91,v91,s36,v15
v_mfma_f32_16x16x32_bf16 a[164:167],a[124:127],v[56:59],a[164:167]
ds_read_b64_tr_b16 a[148:149],v5 offset:12416
v_fma_f32 v96,v96,s36,v16
v_mfma_f32_16x16x32_bf16 a[160:163],a[120:123],v[56:59],a[160:163]
s_waitcnt lgkmcnt(6)
ds_read_b64_tr_b16 a[150:151],v5 offset:18560
v_fma_f32 v97,v97,s36,v16
v_mfma_f32_16x16x32_bf16 a[168:171],a[128:131],v[56:59],a[168:171]
ds_read_b64_tr_b16 a[120:121],v2 offset:12544
v_fma_f32 v98,v98,s36,v16
v_mfma_f32_16x16x32_bf16 a[172:175],a[132:135],v[56:59],a[172:175]
ds_read_b64_tr_b16 a[122:123],v2 offset:18688
v_fma_f32 v99,v99,s36,v16
v_mfma_f32_16x16x32_bf16 v[124:127],a[132:135],v[52:55],v[124:127]
ds_read_b64_tr_b16 a[124:125],v3 offset:12544
v_fma_f32 v76,v76,s36,v13
v_mfma_f32_16x16x32_bf16 v[120:123],a[128:131],v[52:55],v[120:123]
ds_read_b64_tr_b16 a[126:127],v3 offset:18688
v_fma_f32 v77,v77,s36,v13
v_mfma_f32_16x16x32_bf16 v[216:219],a[128:131],v[48:51],v[216:219]
v_exp_f32 v82,v82
v_mfma_f32_16x16x32_bf16 v[220:223],a[132:135],v[48:51],v[220:223]
v_exp_f32 v83,v83
v_mfma_f32_16x16x32_bf16 v[172:175],a[132:135],v[44:47],v[172:175]
ds_read_b64_tr_b16 a[132:133],v5 offset:12544
v_cvt_pk_bf16_f32 v25,v82,v83
v_mfma_f32_16x16x32_bf16 v[168:171],a[128:131],v[44:47],v[168:171]
s_waitcnt lgkmcnt(4)
ds_read_b64_tr_b16 a[128:129],v4 offset:12544
v_fma_f32 v78,v78,s36,v13
v_mfma_f32_16x16x32_bf16 v[176:179],a[136:139],v[44:47],v[176:179]
ds_read_b64_tr_b16 a[130:131],v4 offset:18688
v_fma_f32 v79,v79,s36,v13
v_mfma_f32_16x16x32_bf16 v[180:183],a[140:143],v[44:47],v[180:183]
ds_read_b64_tr_b16 a[134:135],v5 offset:18688
v_fma_f32 v84,v84,s36,v14
v_mfma_f32_16x16x32_bf16 v[228:231],a[140:143],v[48:51],v[228:231]
v_exp_f32 v88,v88
v_mfma_f32_16x16x32_bf16 v[224:227],a[136:139],v[48:51],v[224:227]
v_exp_f32 v89,v89
v_mfma_f32_16x16x32_bf16 v[128:131],a[136:139],v[52:55],v[128:131]
v_exp_f32 v90,v90
v_mfma_f32_16x16x32_bf16 v[132:135],a[140:143],v[52:55],v[132:135]
v_exp_f32 v91,v91
v_mfma_f32_16x16x32_bf16 a[180:183],a[140:143],v[56:59],a[180:183]
v_cvt_pk_bf16_f32 v28,v88,v89
v_cvt_pk_bf16_f32 v29,v90,v91
v_mfma_f32_16x16x32_bf16 a[176:179],a[136:139],v[56:59],a[176:179]
v_exp_f32 v96,v96
v_mfma_f32_16x16x32_bf16 a[184:187],a[144:147],v[56:59],a[184:187]
v_exp_f32 v97,v97
v_mfma_f32_16x16x32_bf16 a[188:191],a[148:151],v[56:59],a[188:191]
v_exp_f32 v98,v98
v_mfma_f32_16x16x32_bf16 v[140:143],a[148:151],v[52:55],v[140:143]
v_exp_f32 v99,v99
v_mfma_f32_16x16x32_bf16 v[136:139],a[144:147],v[52:55],v[136:139]
v_cvt_pk_bf16_f32 v32,v96,v97
v_cvt_pk_bf16_f32 v33,v98,v99
v_mfma_f32_16x16x32_bf16 v[232:235],a[144:147],v[48:51],v[232:235]
v_exp_f32 v76,v76
v_mfma_f32_16x16x32_bf16 v[236:239],a[148:151],v[48:51],v[236:239]
v_exp_f32 v77,v77
v_mfma_f32_16x16x32_bf16 v[188:191],a[148:151],v[44:47],v[188:191]
v_exp_f32 v78,v78
v_mfma_f32_16x16x32_bf16 v[184:187],a[144:147],v[44:47],v[184:187]
s_waitcnt lgkmcnt(0)
v_exp_f32 v79,v79
v_mfma_f32_16x16x32_bf16 v[192:195],a[120:123],v[44:47],v[192:195]
v_cvt_pk_bf16_f32 v22,v76,v77
v_cvt_pk_bf16_f32 v23,v78,v79
v_mfma_f32_16x16x32_bf16 v[196:199],a[124:127],v[44:47],v[196:199]
s_waitcnt vmcnt(6)
v_fma_f32 v85,v85,s36,v14
v_fma_f32 v86,v86,s36,v14
v_mfma_f32_16x16x32_bf16 v[244:247],a[124:127],v[48:51],v[244:247]
s_barrier
v_mfma_f32_16x16x32_bf16 v[240:243],a[120:123],v[48:51],v[240:243]
ds_read_b128 a[148:151],v1 offset:128
v_fma_f32 v87,v87,s36,v14
v_mfma_f32_16x16x32_bf16 v[144:147],a[120:123],v[52:55],v[144:147]
ds_read_b128 a[144:147],v0 offset:128
v_fma_f32 v92,v92,s36,v15
v_mfma_f32_16x16x32_bf16 v[148:151],a[124:127],v[52:55],v[148:151]
ds_read_b128 a[140:143],v1 offset:0
v_fma_f32 v93,v93,s36,v15
v_mfma_f32_16x16x32_bf16 a[196:199],a[124:127],v[56:59],a[196:199]
ds_read_b128 a[124:127],v1 offset:256
v_fma_f32 v94,v94,s36,v15
v_mfma_f32_16x16x32_bf16 a[192:195],a[120:123],v[56:59],a[192:195]
ds_read_b128 a[120:123],v0 offset:256
v_fma_f32 v95,v95,s36,v15
v_mfma_f32_16x16x32_bf16 a[200:203],a[128:131],v[56:59],a[200:203]
buffer_load_dwordx4 v6,s[8:11],s21 offen offset:0 lds
v_mfma_f32_16x16x32_bf16 a[204:207],a[132:135],v[56:59],a[204:207]
ds_read_b128 a[136:139],v0 offset:0
v_fma_f32 v100,v100,s36,v16
v_mfma_f32_16x16x32_bf16 v[156:159],a[132:135],v[52:55],v[156:159]
v_exp_f32 v84,v84
v_mfma_f32_16x16x32_bf16 v[152:155],a[128:131],v[52:55],v[152:155]
v_exp_f32 v85,v85
v_mfma_f32_16x16x32_bf16 v[248:251],a[128:131],v[48:51],v[248:251]
v_exp_f32 v86,v86
v_mfma_f32_16x16x32_bf16 v[252:255],a[132:135],v[48:51],v[252:255]
v_exp_f32 v87,v87
v_mfma_f32_16x16x32_bf16 v[204:207],a[132:135],v[44:47],v[204:207]
ds_read_b128 a[132:135],v1 offset:6144
v_cvt_pk_bf16_f32 v26,v84,v85
v_mfma_f32_16x16x32_bf16 v[200:203],a[128:131],v[44:47],v[200:203]
s_waitcnt lgkmcnt(2)
ds_read_b128 a[128:131],v0 offset:6144
v_cvt_pk_bf16_f32 v27,v86,v87
v_mfma_f32_16x16x32_bf16 v[72:75],a[124:127],a[20:23],0
v_exp_f32 v92,v92
v_smfmac_f32_16x16x64_bf16 v[60:63],a[152:155],v[20:27],v18
buffer_load_dwordx4 v7,s[8:11],s21 offen offset:1024 lds
v_mfma_f32_16x16x32_bf16 v[72:75],a[120:123],a[16:19],v[72:75]
v_exp_f32 v93,v93
v_mfma_f32_16x16x32_bf16 v[72:75],a[148:151],a[12:15],v[72:75]
v_exp_f32 v94,v94
v_mfma_f32_16x16x32_bf16 v[72:75],a[144:147],a[8:11],v[72:75]
v_exp_f32 v95,v95
v_mfma_f32_16x16x32_bf16 v[72:75],a[140:143],a[4:7],v[72:75]
s_waitcnt lgkmcnt(1)
v_cvt_pk_bf16_f32 v30,v92,v93
v_cvt_pk_bf16_f32 v31,v94,v95
v_mfma_f32_16x16x32_bf16 v[72:75],a[136:139],a[0:3],v[72:75]
v_fma_f32 v101,v101,s36,v16
v_fma_f32 v102,v102,s36,v16
v_mfma_f32_16x16x32_bf16 v[80:83],a[136:139],a[24:27],0
v_fma_f32 v103,v103,s36,v16
v_mfma_f32_16x16x32_bf16 v[80:83],a[140:143],a[28:31],v[80:83]
v_exp_f32 v100,v100
v_mfma_f32_16x16x32_bf16 v[80:83],a[144:147],a[32:35],v[80:83]
buffer_load_dwordx4 v8,s[8:11],s21 offen offset:2048 lds
v_mfma_f32_16x16x32_bf16 v[80:83],a[148:151],a[36:39],v[80:83]
s_add_u32 s21,s21,12288
v_exp_f32 v101,v101
v_mfma_f32_16x16x32_bf16 v[80:83],a[120:123],a[40:43],v[80:83]
s_add_u32 m0,s22,24576
v_exp_f32 v102,v102
v_mfma_f32_16x16x32_bf16 v[80:83],a[124:127],a[44:47],v[80:83]
v_exp_f32 v103,v103
v_mfma_f32_16x16x32_bf16 v[88:91],a[124:127],a[68:71],0
v_cvt_pk_bf16_f32 v34,v100,v101
v_cvt_pk_bf16_f32 v35,v102,v103
v_mfma_f32_16x16x32_bf16 v[88:91],a[120:123],a[64:67],v[88:91]
v_fma_f32 v72,v72,s36,v13
v_fma_f32 v73,v73,s36,v13
v_smfmac_f32_16x16x64_bf16 v[64:67],a[152:155],v[28:35],v18
v_fma_f32 v74,v74,s36,v13
v_mfma_f32_16x16x32_bf16 v[88:91],a[148:151],a[60:63],v[88:91]
v_fma_f32 v75,v75,s36,v13
v_fma_f32 v80,v80,s36,v14
v_mfma_f32_16x16x32_bf16 v[88:91],a[144:147],a[56:59],v[88:91]
v_fma_f32 v81,v81,s36,v14
v_mfma_f32_16x16x32_bf16 v[88:91],a[140:143],a[52:55],v[88:91]
buffer_load_dwordx4 v6,s[4:7],s20 offen offset:0 lds
v_mfma_f32_16x16x32_bf16 v[88:91],a[136:139],a[48:51],v[88:91]
v_exp_f32 v72,v72
v_mfma_f32_16x16x32_bf16 v[96:99],a[136:139],a[72:75],0
ds_read_b128 a[136:139],v0 offset:6272
v_mfma_f32_16x16x32_bf16 v[96:99],a[140:143],a[76:79],v[96:99]
ds_read_b128 a[140:143],v1 offset:6272
v_mfma_f32_16x16x32_bf16 v[96:99],a[144:147],a[80:83],v[96:99]
ds_read_b128 a[144:147],v0 offset:6400
v_mfma_f32_16x16x32_bf16 v[96:99],a[148:151],a[84:87],v[96:99]
ds_read_b128 a[148:151],v1 offset:6400
v_mfma_f32_16x16x32_bf16 v[96:99],a[120:123],a[88:91],v[96:99]
v_exp_f32 v73,v73
v_mfma_f32_16x16x32_bf16 v[96:99],a[124:127],a[92:95],v[96:99]
s_waitcnt lgkmcnt(4)
v_exp_f32 v74,v74
v_mfma_f32_16x16x32_bf16 v[76:79],a[128:131],a[0:3],0
v_exp_f32 v75,v75
v_mfma_f32_16x16x32_bf16 v[76:79],a[132:135],a[4:7],v[76:79]
buffer_load_dwordx4 v7,s[4:7],s20 offen offset:1024 lds
s_waitcnt lgkmcnt(3)
v_mfma_f32_16x16x32_bf16 v[76:79],a[136:139],a[8:11],v[76:79]
s_waitcnt lgkmcnt(2)
v_exp_f32 v80,v80
v_mfma_f32_16x16x32_bf16 v[76:79],a[140:143],a[12:15],v[76:79]
s_waitcnt lgkmcnt(0)
v_exp_f32 v81,v81
v_mfma_f32_16x16x32_bf16 v[76:79],a[144:147],a[16:19],v[76:79]
v_cvt_pk_bf16_f32 v44,v72,v73
v_cvt_pk_bf16_f32 v45,v74,v75
v_mfma_f32_16x16x32_bf16 v[76:79],a[148:151],a[20:23],v[76:79]
v_cvt_pk_bf16_f32 v48,v80,v81
v_mfma_f32_16x16x32_bf16 v[84:87],a[148:151],a[44:47],0
v_mfma_f32_16x16x32_bf16 v[84:87],a[144:147],a[40:43],v[84:87]
v_mfma_f32_16x16x32_bf16 v[84:87],a[140:143],a[36:39],v[84:87]
v_mfma_f32_16x16x32_bf16 v[84:87],a[136:139],a[32:35],v[84:87]
v_mfma_f32_16x16x32_bf16 v[84:87],a[132:135],a[28:31],v[84:87]
buffer_load_dwordx4 v8,s[4:7],s20 offen offset:2048 lds
v_mfma_f32_16x16x32_bf16 v[84:87],a[128:131],a[24:27],v[84:87]
s_add_u32 s20,s20,12288
v_mfma_f32_16x16x32_bf16 v[92:95],a[128:131],a[48:51],0
ds_read_b64_tr_b16 a[120:121],v2 offset:24576
v_mfma_f32_16x16x32_bf16 v[92:95],a[132:135],a[52:55],v[92:95]
ds_read_b64_tr_b16 a[122:123],v2 offset:30720
v_mfma_f32_16x16x32_bf16 v[92:95],a[136:139],a[56:59],v[92:95]
ds_read_b64_tr_b16 a[124:125],v3 offset:24576
v_mfma_f32_16x16x32_bf16 v[92:95],a[140:143],a[60:63],v[92:95]
ds_read_b64_tr_b16 a[126:127],v3 offset:30720
v_mfma_f32_16x16x32_bf16 v[92:95],a[144:147],a[64:67],v[92:95]
v_mfma_f32_16x16x32_bf16 v[92:95],a[148:151],a[68:71],v[92:95]
v_mfma_f32_16x16x32_bf16 v[100:103],a[148:151],a[92:95],0
v_mfma_f32_16x16x32_bf16 v[100:103],a[144:147],a[88:91],v[100:103]
v_mfma_f32_16x16x32_bf16 v[100:103],a[140:143],a[84:87],v[100:103]
v_mfma_f32_16x16x32_bf16 v[100:103],a[136:139],a[80:83],v[100:103]
v_mfma_f32_16x16x32_bf16 v[100:103],a[132:135],a[76:79],v[100:103]
ds_read_b64_tr_b16 a[132:133],v5 offset:24576
v_mfma_f32_16x16x32_bf16 v[100:103],a[128:131],a[72:75],v[100:103]
ds_read_b64_tr_b16 a[128:129],v4 offset:24576
ds_read_b64_tr_b16 a[130:131],v4 offset:30720
ds_read_b64_tr_b16 a[134:135],v5 offset:30720
s_mov_b32 s38,0
s_branch L_loop4
L_loop5:
.p2align 6
L_loop5w0:
s_waitcnt lgkmcnt(3)
v_mfma_f32_16x16x32_bf16 v[160:163],a[120:123],v[20:23],v[160:163]
s_add_u32 m0,s23,24576
ds_read_b64_tr_b16 a[142:143],v3 offset:30848
v_fma_f32 v90,v90,s36,v15
v_mfma_f32_16x16x32_bf16 v[164:167],a[124:127],v[20:23],v[164:167]
ds_read_b64_tr_b16 a[136:137],v2 offset:24704
v_fma_f32 v91,v91,s36,v15
v_mfma_f32_16x16x32_bf16 v[212:215],a[124:127],v[24:27],v[212:215]
ds_read_b64_tr_b16 a[138:139],v2 offset:30848
v_fma_f32 v97,v97,s36,v16
v_mfma_f32_16x16x32_bf16 v[208:211],a[120:123],v[24:27],v[208:211]
ds_read_b64_tr_b16 a[140:141],v3 offset:24704
v_fma_f32 v96,v96,s36,v16
v_mfma_f32_16x16x32_bf16 v[112:115],a[120:123],v[28:31],v[112:115]
ds_read_b64_tr_b16 a[146:147],v4 offset:30848
v_fma_f32 v98,v98,s36,v16
v_mfma_f32_16x16x32_bf16 v[116:119],a[124:127],v[28:31],v[116:119]
ds_read_b64_tr_b16 a[144:145],v4 offset:24704
v_fma_f32 v99,v99,s36,v16
v_mfma_f32_16x16x32_bf16 a[164:167],a[124:127],v[32:35],a[164:167]
ds_read_b64_tr_b16 a[150:151],v5 offset:30848
v_fma_f32 v106,v106,s36,v17
v_mfma_f32_16x16x32_bf16 a[160:163],a[120:123],v[32:35],a[160:163]
ds_read_b64_tr_b16 a[148:149],v5 offset:24704
v_fma_f32 v107,v107,s36,v17
v_mfma_f32_16x16x32_bf16 a[208:211],a[120:123],v[36:39],a[208:211]
ds_read_b64_tr_b16 a[122:123],v2 offset:30976
v_fma_f32 v104,v104,s36,v17
v_mfma_f32_16x16x32_bf16 a[212:215],a[124:127],v[36:39],a[212:215]
s_waitcnt lgkmcnt(6)
ds_read_b64_tr_b16 a[126:127],v3 offset:30976
v_fma_f32 v105,v105,s36,v17
v_mfma_f32_16x16x32_bf16 a[216:219],a[128:131],v[36:39],a[216:219]
ds_read_b64_tr_b16 a[120:121],v2 offset:24832
v_fma_f32 v77,v77,s36,v13
v_mfma_f32_16x16x32_bf16 a[220:223],a[132:135],v[36:39],a[220:223]
ds_read_b64_tr_b16 a[124:125],v3 offset:24832
v_fma_f32 v79,v79,s36,v13
v_mfma_f32_16x16x32_bf16 a[172:175],a[132:135],v[32:35],a[172:175]
v_exp_f32 v91,v91
v_mfma_f32_16x16x32_bf16 a[168:171],a[128:131],v[32:35],a[168:171]
v_exp_f32 v90,v90
v_mfma_f32_16x16x32_bf16 v[120:123],a[128:131],v[28:31],v[120:123]
v_cvt_pk_bf16_f32 v53,v90,v91
v_fma_f32 v76,v76,s36,v13
v_mfma_f32_16x16x32_bf16 v[124:127],a[132:135],v[28:31],v[124:127]
v_exp_f32 v99,v99
v_mfma_f32_16x16x32_bf16 v[220:223],a[132:135],v[24:27],v[220:223]
v_exp_f32 v96,v96
v_mfma_f32_16x16x32_bf16 v[216:219],a[128:131],v[24:27],v[216:219]
v_exp_f32 v98,v98
v_mfma_f32_16x16x32_bf16 v[168:171],a[128:131],v[20:23],v[168:171]
ds_read_b64_tr_b16 a[128:129],v4 offset:24832
v_cvt_pk_bf16_f32 v57,v98,v99
v_mfma_f32_16x16x32_bf16 v[172:175],a[132:135],v[20:23],v[172:175]
ds_read_b64_tr_b16 a[130:131],v4 offset:30976
v_fma_f32 v78,v78,s36,v13
v_mfma_f32_16x16x32_bf16 v[176:179],a[136:139],v[20:23],v[176:179]
s_waitcnt lgkmcnt(2)
ds_read_b64_tr_b16 a[132:133],v5 offset:24832
v_fma_f32 v86,v86,s36,v14
v_mfma_f32_16x16x32_bf16 v[180:183],a[140:143],v[20:23],v[180:183]
ds_read_b64_tr_b16 a[134:135],v5 offset:30976
v_fma_f32 v84,v84,s36,v14
v_mfma_f32_16x16x32_bf16 v[228:231],a[140:143],v[24:27],v[228:231]
v_exp_f32 v97,v97
v_mfma_f32_16x16x32_bf16 v[224:227],a[136:139],v[24:27],v[224:227]
v_cvt_pk_bf16_f32 v56,v96,v97
v_fma_f32 v87,v87,s36,v14
v_mfma_f32_16x16x32_bf16 v[128:131],a[136:139],v[28:31],v[128:131]
v_exp_f32 v104,v104
v_mfma_f32_16x16x32_bf16 v[132:135],a[140:143],v[28:31],v[132:135]
v_exp_f32 v107,v107
v_mfma_f32_16x16x32_bf16 a[180:183],a[140:143],v[32:35],a[180:183]
v_exp_f32 v105,v105
v_mfma_f32_16x16x32_bf16 a[176:179],a[136:139],v[32:35],a[176:179]
v_exp_f32 v106,v106
v_mfma_f32_16x16x32_bf16 a[224:227],a[136:139],v[36:39],a[224:227]
v_cvt_pk_bf16_f32 v41,v106,v107
v_cvt_pk_bf16_f32 v40,v104,v105
v_mfma_f32_16x16x32_bf16 a[228:231],a[140:143],v[36:39],a[228:231]
v_exp_f32 v78,v78
v_mfma_f32_16x16x32_bf16 a[232:235],a[144:147],v[36:39],a[232:235]
v_exp_f32 v79,v79
v_mfma_f32_16x16x32_bf16 a[236:239],a[148:151],v[36:39],a[236:239]
v_exp_f32 v77,v77
v_mfma_f32_16x16x32_bf16 a[188:191],a[148:151],v[32:35],a[188:191]
v_exp_f32 v76,v76
v_mfma_f32_16x16x32_bf16 a[184:187],a[144:147],v[32:35],a[184:187]
v_cvt_pk_bf16_f32 v46,v76,v77
v_cvt_pk_bf16_f32 v47,v78,v79
v_mfma_f32_16x16x32_bf16 v[136:139],a[144:147],v[28:31],v[136:139]
v_exp_f32 v86,v86
v_mfma_f32_16x16x32_bf16 v[140:143],a[148:151],v[28:31],v[140:143]
v_exp_f32 v87,v87
v_mfma_f32_16x16x32_bf16 v[236:239],a[148:151],v[24:27],v[236:239]
v_exp_f32 v84,v84
v_mfma_f32_16x16x32_bf16 v[232:235],a[144:147],v[24:27],v[232:235]
v_fma_f32 v85,v85,s36,v14
v_cvt_pk_bf16_f32 v51,v86,v87
v_mfma_f32_16x16x32_bf16 v[184:187],a[144:147],v[20:23],v[184:187]
v_exp_f32 v85,v85
v_mfma_f32_16x16x32_bf16 v[188:191],a[148:151],v[20:23],v[188:191]
v_cvt_pk_bf16_f32 v50,v84,v85
v_fma_f32 v92,v92,s36,v15
v_mfma_f32_16x16x32_bf16 v[192:195],a[120:123],v[20:23],v[192:195]
v_fma_f32 v94,v94,s36,v15
v_fma_f32 v93,v93,s36,v15
v_smfmac_f32_16x16x64_bf16 v[60:63],a[152:155],v[44:51],v18
v_fma_f32 v95,v95,s36,v15
v_mfma_f32_16x16x32_bf16 v[196:199],a[124:127],v[20:23],v[196:199]
s_waitcnt vmcnt(6) lgkmcnt(0)
v_exp_f32 v94,v94
v_mfma_f32_16x16x32_bf16 v[244:247],a[124:127],v[24:27],v[244:247]
s_barrier
v_mfma_f32_16x16x32_bf16 v[240:243],a[120:123],v[24:27],v[240:243]
ds_read_b128 a[136:139],v0 offset:12288
v_fma_f32 v102,v102,s36,v16
v_mfma_f32_16x16x32_bf16 v[144:147],a[120:123],v[28:31],v[144:147]
ds_read_b128 a[144:147],v0 offset:12416
v_fma_f32 v101,v101,s36,v16
v_mfma_f32_16x16x32_bf16 v[148:151],a[124:127],v[28:31],v[148:151]
ds_read_b128 a[140:143],v1 offset:12288
v_fma_f32 v100,v100,s36,v16
v_mfma_f32_16x16x32_bf16 a[196:199],a[124:127],v[32:35],a[196:199]
ds_read_b128 a[148:151],v1 offset:12416
v_fma_f32 v103,v103,s36,v16
v_mfma_f32_16x16x32_bf16 a[192:195],a[120:123],v[32:35],a[192:195]
ds_read_b128 a[156:159],v10 offset:0
v_fma_f32 v108,v108,s36,v17
v_mfma_f32_16x16x32_bf16 a[240:243],a[120:123],v[36:39],a[240:243]
buffer_load_dwordx4 v6,s[8:11],s21 offen offset:0 lds
v_mfma_f32_16x16x32_bf16 a[244:247],a[124:127],v[36:39],a[244:247]
ds_read_b128 a[120:123],v0 offset:12544
v_fma_f32 v110,v110,s36,v17
v_mfma_f32_16x16x32_bf16 a[248:251],a[128:131],v[36:39],a[248:251]
ds_read_b128 a[124:127],v1 offset:12544
v_fma_f32 v111,v111,s36,v17
v_mfma_f32_16x16x32_bf16 a[252:255],a[132:135],v[36:39],a[252:255]
v_exp_f32 v92,v92
v_mfma_f32_16x16x32_bf16 a[204:207],a[132:135],v[32:35],a[204:207]
v_exp_f32 v95,v95
v_mfma_f32_16x16x32_bf16 a[200:203],a[128:131],v[32:35],a[200:203]
v_cvt_pk_bf16_f32 v55,v94,v95
v_fma_f32 v109,v109,s36,v17
v_mfma_f32_16x16x32_bf16 v[152:155],a[128:131],v[28:31],v[152:155]
v_exp_f32 v93,v93
v_mfma_f32_16x16x32_bf16 v[156:159],a[132:135],v[28:31],v[156:159]
v_cvt_pk_bf16_f32 v54,v92,v93
v_mfma_f32_16x16x32_bf16 v[252:255],a[132:135],v[24:27],v[252:255]
v_exp_f32 v102,v102
v_mfma_f32_16x16x32_bf16 v[248:251],a[128:131],v[24:27],v[248:251]
v_exp_f32 v101,v101
v_mfma_f32_16x16x32_bf16 v[200:203],a[128:131],v[20:23],v[200:203]
ds_read_b128 a[128:131],v0 offset:18432
v_mfma_f32_16x16x32_bf16 v[204:207],a[132:135],v[20:23],v[204:207]
s_waitcnt lgkmcnt(1)
buffer_store_dwordx4 a[156:159],v9,s[16:19],s27 offen offset:0 nt
buffer_load_dwordx4 v7,s[8:11],s21 offen offset:1024 lds
v_mfma_f32_16x16x32_bf16 v[72:75],a[136:139],a[0:3],0
ds_read_b128 a[132:135],v1 offset:18432
v_mfma_f32_16x16x32_bf16 v[72:75],a[140:143],a[4:7],v[72:75]
v_exp_f32 v103,v103
v_mfma_f32_16x16x32_bf16 v[72:75],a[144:147],a[8:11],v[72:75]
v_exp_f32 v100,v100
v_mfma_f32_16x16x32_bf16 v[72:75],a[148:151],a[12:15],v[72:75]
v_cvt_pk_bf16_f32 v59,v102,v103
v_cvt_pk_bf16_f32 v58,v100,v101
v_mfma_f32_16x16x32_bf16 v[72:75],a[120:123],a[16:19],v[72:75]
v_exp_f32 v109,v109
v_smfmac_f32_16x16x64_bf16 v[64:67],a[152:155],v[52:59],v18
ds_read_b128 a[156:159],v10 offset:1024
v_mfma_f32_16x16x32_bf16 v[72:75],a[124:127],a[20:23],v[72:75]
v_exp_f32 v111,v111
v_mfma_f32_16x16x32_bf16 v[80:83],a[124:127],a[44:47],0
v_exp_f32 v108,v108
v_mfma_f32_16x16x32_bf16 v[80:83],a[120:123],a[40:43],v[80:83]
v_exp_f32 v110,v110
v_mfma_f32_16x16x32_bf16 v[80:83],a[148:151],a[36:39],v[80:83]
v_cvt_pk_bf16_f32 v42,v108,v109
v_cvt_pk_bf16_f32 v43,v110,v111
v_mfma_f32_16x16x32_bf16 v[80:83],a[144:147],a[32:35],v[80:83]
buffer_load_dwordx4 v8,s[8:11],s21 offen offset:2048 lds
v_smfmac_f32_16x16x64_bf16 v[68:71],a[152:155],v[36:43],v18
s_add_u32 s21,s21,12288
v_fma_f32 v73,v73,s36,v13
v_mfma_f32_16x16x32_bf16 v[80:83],a[140:143],a[28:31],v[80:83]
s_add_u32 m0,s22,0
v_fma_f32 v72,v72,s36,v13
v_fma_f32 v74,v74,s36,v13
v_mfma_f32_16x16x32_bf16 v[80:83],a[136:139],a[24:27],v[80:83]
v_exp_f32 v73,v73
v_mfma_f32_16x16x32_bf16 v[88:91],a[136:139],a[48:51],0
v_exp_f32 v72,v72
v_mfma_f32_16x16x32_bf16 v[88:91],a[140:143],a[52:55],v[88:91]
v_exp_f32 v74,v74
v_mfma_f32_16x16x32_bf16 v[88:91],a[144:147],a[56:59],v[88:91]
v_fma_f32 v75,v75,s36,v13
v_cvt_pk_bf16_f32 v20,v72,v73
v_mfma_f32_16x16x32_bf16 v[88:91],a[148:151],a[60:63],v[88:91]
v_exp_f32 v75,v75
v_mfma_f32_16x16x32_bf16 v[88:91],a[120:123],a[64:67],v[88:91]
v_fma_f32 v83,v83,s36,v14
v_fma_f32 v81,v81,s36,v14
v_mfma_f32_16x16x32_bf16 v[88:91],a[124:127],a[68:71],v[88:91]
v_exp_f32 v81,v81
v_mfma_f32_16x16x32_bf16 v[96:99],a[124:127],a[92:95],0
v_cvt_pk_bf16_f32 v21,v74,v75
v_fma_f32 v82,v82,s36,v14
v_mfma_f32_16x16x32_bf16 v[96:99],a[120:123],a[88:91],v[96:99]
s_waitcnt lgkmcnt(0)
buffer_store_dwordx4 a[156:159],v9,s[16:19],s27 offen offset:128 nt
buffer_load_dwordx4 v6,s[4:7],s20 offen offset:0 lds
v_mfma_f32_16x16x32_bf16 v[96:99],a[148:151],a[84:87],v[96:99]
v_fma_f32 v88,v88,s36,v15
v_fma_f32 v89,v89,s36,v15
v_mfma_f32_16x16x32_bf16 v[96:99],a[144:147],a[80:83],v[96:99]
v_exp_f32 v89,v89
v_mfma_f32_16x16x32_bf16 v[96:99],a[140:143],a[76:79],v[96:99]
v_exp_f32 v82,v82
v_mfma_f32_16x16x32_bf16 v[96:99],a[136:139],a[72:75],v[96:99]
v_exp_f32 v88,v88
v_mfma_f32_16x16x32_bf16 v[104:107],a[136:139],a[96:99],0
ds_read_b128 a[136:139],v0 offset:18560
v_fma_f32 v80,v80,s36,v14
v_mfma_f32_16x16x32_bf16 v[104:107],a[140:143],a[100:103],v[104:107]
ds_read_b128 a[156:159],v10 offset:2048
v_mfma_f32_16x16x32_bf16 v[104:107],a[144:147],a[104:107],v[104:107]
ds_read_b128 a[140:143],v1 offset:18560
v_mfma_f32_16x16x32_bf16 v[104:107],a[148:151],a[108:111],v[104:107]
ds_read_b128 a[144:147],v0 offset:18688
v_mfma_f32_16x16x32_bf16 v[104:107],a[120:123],a[112:115],v[104:107]
ds_read_b128 a[148:151],v1 offset:18688
v_mfma_f32_16x16x32_bf16 v[104:107],a[124:127],a[116:119],v[104:107]
v_exp_f32 v80,v80
v_mfma_f32_16x16x32_bf16 v[76:79],a[128:131],a[0:3],0
buffer_load_dwordx4 v7,s[4:7],s20 offen offset:1024 lds
v_mfma_f32_16x16x32_bf16 v[76:79],a[132:135],a[4:7],v[76:79]
s_waitcnt lgkmcnt(4)
v_cvt_pk_bf16_f32 v24,v80,v81
v_cvt_pk_bf16_f32 v28,v88,v89
v_mfma_f32_16x16x32_bf16 v[76:79],a[136:139],a[8:11],v[76:79]
s_waitcnt lgkmcnt(2)
v_exp_f32 v83,v83
v_mfma_f32_16x16x32_bf16 v[76:79],a[140:143],a[12:15],v[76:79]
s_waitcnt lgkmcnt(1)
v_cvt_pk_bf16_f32 v25,v82,v83
v_mfma_f32_16x16x32_bf16 v[76:79],a[144:147],a[16:19],v[76:79]
s_waitcnt lgkmcnt(0)
v_mfma_f32_16x16x32_bf16 v[76:79],a[148:151],a[20:23],v[76:79]
v_mfma_f32_16x16x32_bf16 v[84:87],a[148:151],a[44:47],0
v_mfma_f32_16x16x32_bf16 v[84:87],a[144:147],a[40:43],v[84:87]
v_mfma_f32_16x16x32_bf16 v[84:87],a[140:143],a[36:39],v[84:87]
v_mfma_f32_16x16x32_bf16 v[84:87],a[136:139],a[32:35],v[84:87]
v_mfma_f32_16x16x32_bf16 v[84:87],a[132:135],a[28:31],v[84:87]
buffer_store_dwordx4 a[156:159],v9,s[16:19],s27 offen offset:256 nt
buffer_load_dwordx4 v8,s[4:7],s20 offen offset:2048 lds
v_mfma_f32_16x16x32_bf16 v[84:87],a[128:131],a[24:27],v[84:87]
s_add_u32 s20,s20,12288
v_mfma_f32_16x16x32_bf16 v[92:95],a[128:131],a[48:51],0
s_add_u32 s27,s27,3072
v_mfma_f32_16x16x32_bf16 v[92:95],a[132:135],a[52:55],v[92:95]
v_mfma_f32_16x16x32_bf16 v[92:95],a[136:139],a[56:59],v[92:95]
v_mfma_f32_16x16x32_bf16 v[92:95],a[140:143],a[60:63],v[92:95]
ds_read_b64_tr_b16 a[120:121],v2 offset:0
v_mfma_f32_16x16x32_bf16 v[92:95],a[144:147],a[64:67],v[92:95]
ds_read_b64_tr_b16 a[122:123],v2 offset:6144
v_mfma_f32_16x16x32_bf16 v[92:95],a[148:151],a[68:71],v[92:95]
v_mfma_f32_16x16x32_bf16 v[100:103],a[148:151],a[92:95],0
ds_read_b64_tr_b16 a[124:125],v3 offset:0
v_mfma_f32_16x16x32_bf16 v[100:103],a[144:147],a[88:91],v[100:103]
ds_read_b64_tr_b16 a[126:127],v3 offset:6144
v_mfma_f32_16x16x32_bf16 v[100:103],a[140:143],a[84:87],v[100:103]
v_mfma_f32_16x16x32_bf16 v[100:103],a[136:139],a[80:83],v[100:103]
v_mfma_f32_16x16x32_bf16 v[100:103],a[132:135],a[76:79],v[100:103]
v_mfma_f32_16x16x32_bf16 v[100:103],a[128:131],a[72:75],v[100:103]
v_mfma_f32_16x16x32_bf16 v[108:111],a[128:131],a[96:99],0
ds_read_b64_tr_b16 a[130:131],v4 offset:6144
v_mfma_f32_16x16x32_bf16 v[108:111],a[132:135],a[100:103],v[108:111]
ds_read_b64_tr_b16 a[128:129],v4 offset:0
v_mfma_f32_16x16x32_bf16 v[108:111],a[136:139],a[104:107],v[108:111]
ds_read_b64_tr_b16 a[134:135],v5 offset:6144
v_mfma_f32_16x16x32_bf16 v[108:111],a[140:143],a[108:111],v[108:111]
ds_read_b64_tr_b16 a[132:133],v5 offset:0
v_mfma_f32_16x16x32_bf16 v[108:111],a[144:147],a[112:115],v[108:111]
v_mfma_f32_16x16x32_bf16 v[108:111],a[148:151],a[116:119],v[108:111]
s_waitcnt lgkmcnt(4)
v_mfma_f32_16x16x32_bf16 v[160:163],a[120:123],v[44:47],v[160:163]
s_add_u32 m0,s29,0
ds_read_b64_tr_b16 a[136:137],v2 offset:128
v_fma_f32 v90,v90,s36,v15
v_mfma_f32_16x16x32_bf16 v[164:167],a[124:127],v[44:47],v[164:167]
ds_read_b64_tr_b16 a[138:139],v2 offset:6272
v_fma_f32 v91,v91,s36,v15
v_mfma_f32_16x16x32_bf16 v[212:215],a[124:127],v[48:51],v[212:215]
ds_read_b64_tr_b16 a[140:141],v3 offset:128
v_fma_f32 v96,v96,s36,v16
v_mfma_f32_16x16x32_bf16 v[208:211],a[120:123],v[48:51],v[208:211]
ds_read_b64_tr_b16 a[142:143],v3 offset:6272
v_fma_f32 v97,v97,s36,v16
v_mfma_f32_16x16x32_bf16 v[112:115],a[120:123],v[52:55],v[112:115]
ds_read_b64_tr_b16 a[144:145],v4 offset:128
v_fma_f32 v98,v98,s36,v16
v_mfma_f32_16x16x32_bf16 v[116:119],a[124:127],v[52:55],v[116:119]
ds_read_b64_tr_b16 a[146:147],v4 offset:6272
v_fma_f32 v99,v99,s36,v16
v_mfma_f32_16x16x32_bf16 a[164:167],a[124:127],v[56:59],a[164:167]
ds_read_b64_tr_b16 a[148:149],v5 offset:128
v_fma_f32 v104,v104,s36,v17
v_mfma_f32_16x16x32_bf16 a[160:163],a[120:123],v[56:59],a[160:163]
buffer_load_dwordx4 v6,s[12:15],s28 offen offset:0 nt lds
v_mfma_f32_16x16x32_bf16 a[208:211],a[120:123],v[40:43],a[208:211]
ds_read_b64_tr_b16 a[150:151],v5 offset:6272
v_fma_f32 v105,v105,s36,v17
v_mfma_f32_16x16x32_bf16 a[212:215],a[124:127],v[40:43],a[212:215]
s_waitcnt lgkmcnt(5)
ds_read_b64_tr_b16 a[120:121],v2 offset:256
v_fma_f32 v106,v106,s36,v17
v_mfma_f32_16x16x32_bf16 a[216:219],a[128:131],v[40:43],a[216:219]
ds_read_b64_tr_b16 a[122:123],v2 offset:6400
v_fma_f32 v107,v107,s36,v17
v_mfma_f32_16x16x32_bf16 a[220:223],a[132:135],v[40:43],a[220:223]
ds_read_b64_tr_b16 a[124:125],v3 offset:256
v_fma_f32 v76,v76,s36,v13
v_mfma_f32_16x16x32_bf16 a[172:175],a[132:135],v[56:59],a[172:175]
ds_read_b64_tr_b16 a[126:127],v3 offset:6400
v_fma_f32 v77,v77,s36,v13
v_mfma_f32_16x16x32_bf16 a[168:171],a[128:131],v[56:59],a[168:171]
v_exp_f32 v90,v90
v_mfma_f32_16x16x32_bf16 v[120:123],a[128:131],v[52:55],v[120:123]
v_exp_f32 v91,v91
v_mfma_f32_16x16x32_bf16 v[124:127],a[132:135],v[52:55],v[124:127]
v_cvt_pk_bf16_f32 v29,v90,v91
v_fma_f32 v78,v78,s36,v13
v_mfma_f32_16x16x32_bf16 v[220:223],a[132:135],v[48:51],v[220:223]
v_exp_f32 v96,v96
v_mfma_f32_16x16x32_bf16 v[216:219],a[128:131],v[48:51],v[216:219]
buffer_load_dwordx4 v7,s[12:15],s28 offen offset:1024 nt lds
v_mfma_f32_16x16x32_bf16 v[168:171],a[128:131],v[44:47],v[168:171]
ds_read_b64_tr_b16 a[128:129],v4 offset:256
v_fma_f32 v79,v79,s36,v13
v_mfma_f32_16x16x32_bf16 v[172:175],a[132:135],v[44:47],v[172:175]
ds_read_b64_tr_b16 a[130:131],v4 offset:6400
v_fma_f32 v84,v84,s36,v14
v_mfma_f32_16x16x32_bf16 v[176:179],a[136:139],v[44:47],v[176:179]
s_waitcnt lgkmcnt(2)
ds_read_b64_tr_b16 a[132:133],v5 offset:256
v_fma_f32 v85,v85,s36,v14
v_mfma_f32_16x16x32_bf16 v[180:183],a[140:143],v[44:47],v[180:183]
ds_read_b64_tr_b16 a[134:135],v5 offset:6400
v_fma_f32 v86,v86,s36,v14
v_mfma_f32_16x16x32_bf16 v[228:231],a[140:143],v[48:51],v[228:231]
v_exp_f32 v97,v97
v_mfma_f32_16x16x32_bf16 v[224:227],a[136:139],v[48:51],v[224:227]
v_exp_f32 v98,v98
v_mfma_f32_16x16x32_bf16 v[128:131],a[136:139],v[52:55],v[128:131]
v_exp_f32 v99,v99
v_mfma_f32_16x16x32_bf16 v[132:135],a[140:143],v[52:55],v[132:135]
v_cvt_pk_bf16_f32 v32,v96,v97
v_cvt_pk_bf16_f32 v33,v98,v99
v_mfma_f32_16x16x32_bf16 a[180:183],a[140:143],v[56:59],a[180:183]
v_exp_f32 v104,v104
v_mfma_f32_16x16x32_bf16 a[176:179],a[136:139],v[56:59],a[176:179]
buffer_load_dwordx4 v8,s[12:15],s28 offen offset:2048 nt lds
v_mfma_f32_16x16x32_bf16 a[224:227],a[136:139],v[40:43],a[224:227]
s_add_u32 s28,s28,3072
v_exp_f32 v105,v105
v_mfma_f32_16x16x32_bf16 a[228:231],a[140:143],v[40:43],a[228:231]
s_add_u32 s29,s29,3072
v_exp_f32 v106,v106
v_mfma_f32_16x16x32_bf16 a[232:235],a[144:147],v[40:43],a[232:235]
s_add_u32 m0,s23,0
v_exp_f32 v107,v107
v_mfma_f32_16x16x32_bf16 a[236:239],a[148:151],v[40:43],a[236:239]
v_cvt_pk_bf16_f32 v36,v104,v105
v_cvt_pk_bf16_f32 v37,v106,v107
v_mfma_f32_16x16x32_bf16 a[188:191],a[148:151],v[56:59],a[188:191]
v_exp_f32 v76,v76
v_mfma_f32_16x16x32_bf16 a[184:187],a[144:147],v[56:59],a[184:187]
v_exp_f32 v77,v77
v_mfma_f32_16x16x32_bf16 v[136:139],a[144:147],v[52:55],v[136:139]
v_exp_f32 v78,v78
v_mfma_f32_16x16x32_bf16 v[140:143],a[148:151],v[52:55],v[140:143]
v_exp_f32 v79,v79
v_mfma_f32_16x16x32_bf16 v[236:239],a[148:151],v[48:51],v[236:239]
v_cvt_pk_bf16_f32 v22,v76,v77
v_cvt_pk_bf16_f32 v23,v78,v79
v_mfma_f32_16x16x32_bf16 v[232:235],a[144:147],v[48:51],v[232:235]
v_fma_f32 v87,v87,s36,v14
v_fma_f32 v92,v92,s36,v15
v_mfma_f32_16x16x32_bf16 v[184:187],a[144:147],v[44:47],v[184:187]
v_exp_f32 v84,v84
v_mfma_f32_16x16x32_bf16 v[188:191],a[148:151],v[44:47],v[188:191]
v_exp_f32 v85,v85
v_mfma_f32_16x16x32_bf16 v[192:195],a[120:123],v[44:47],v[192:195]
v_exp_f32 v86,v86
v_mfma_f32_16x16x32_bf16 v[196:199],a[124:127],v[44:47],v[196:199]
s_waitcnt vmcnt(12) lgkmcnt(0)
v_exp_f32 v87,v87
v_mfma_f32_16x16x32_bf16 v[244:247],a[124:127],v[48:51],v[244:247]
s_barrier
v_mfma_f32_16x16x32_bf16 v[240:243],a[120:123],v[48:51],v[240:243]
ds_read_b128 a[136:139],v0 offset:24576
v_cvt_pk_bf16_f32 v26,v84,v85
v_mfma_f32_16x16x32_bf16 v[144:147],a[120:123],v[52:55],v[144:147]
ds_read_b128 a[140:143],v1 offset:24576
v_cvt_pk_bf16_f32 v27,v86,v87
v_mfma_f32_16x16x32_bf16 v[148:151],a[124:127],v[52:55],v[148:151]
ds_read_b128 a[144:147],v0 offset:24704
v_fma_f32 v93,v93,s36,v15
v_smfmac_f32_16x16x64_bf16 v[60:63],a[152:155],v[20:27],v18
ds_read_b128 a[148:151],v1 offset:24704
v_mfma_f32_16x16x32_bf16 a[196:199],a[124:127],v[56:59],a[196:199]
v_fma_f32 v94,v94,s36,v15
v_fma_f32 v95,v95,s36,v15
v_mfma_f32_16x16x32_bf16 a[192:195],a[120:123],v[56:59],a[192:195]
buffer_load_dwordx4 v6,s[8:11],s21 offen offset:0 lds
v_mfma_f32_16x16x32_bf16 a[240:243],a[120:123],v[40:43],a[240:243]
ds_read_b128 a[120:123],v0 offset:24832
v_fma_f32 v100,v100,s36,v16
v_mfma_f32_16x16x32_bf16 a[244:247],a[124:127],v[40:43],a[244:247]
ds_read_b128 a[124:127],v1 offset:24832
v_fma_f32 v101,v101,s36,v16
v_mfma_f32_16x16x32_bf16 a[248:251],a[128:131],v[40:43],a[248:251]
v_exp_f32 v92,v92
v_mfma_f32_16x16x32_bf16 a[252:255],a[132:135],v[40:43],a[252:255]
v_exp_f32 v93,v93
v_mfma_f32_16x16x32_bf16 a[204:207],a[132:135],v[56:59],a[204:207]
v_exp_f32 v94,v94
v_mfma_f32_16x16x32_bf16 a[200:203],a[128:131],v[56:59],a[200:203]
v_exp_f32 v95,v95
v_mfma_f32_16x16x32_bf16 v[152:155],a[128:131],v[52:55],v[152:155]
v_cvt_pk_bf16_f32 v30,v92,v93
v_cvt_pk_bf16_f32 v31,v94,v95
v_mfma_f32_16x16x32_bf16 v[156:159],a[132:135],v[52:55],v[156:159]
v_fma_f32 v102,v102,s36,v16
v_fma_f32 v103,v103,s36,v16
v_mfma_f32_16x16x32_bf16 v[252:255],a[132:135],v[48:51],v[252:255]
v_exp_f32 v100,v100
v_mfma_f32_16x16x32_bf16 v[248:251],a[128:131],v[48:51],v[248:251]
v_exp_f32 v101,v101
v_mfma_f32_16x16x32_bf16 v[200:203],a[128:131],v[44:47],v[200:203]
buffer_load_dwordx4 v7,s[8:11],s21 offen offset:1024 lds
v_mfma_f32_16x16x32_bf16 v[204:207],a[132:135],v[44:47],v[204:207]
s_waitcnt lgkmcnt(0)
ds_read_b128 a[128:131],v0 offset:30720
v_cvt_pk_bf16_f32 v34,v100,v101
v_mfma_f32_16x16x32_bf16 v[72:75],a[136:139],a[0:3],0
ds_read_b128 a[132:135],v1 offset:30720
v_fma_f32 v108,v108,s36,v17
v_mfma_f32_16x16x32_bf16 v[72:75],a[140:143],a[4:7],v[72:75]
v_exp_f32 v102,v102
v_mfma_f32_16x16x32_bf16 v[72:75],a[144:147],a[8:11],v[72:75]
v_exp_f32 v103,v103
v_mfma_f32_16x16x32_bf16 v[72:75],a[148:151],a[12:15],v[72:75]
v_cvt_pk_bf16_f32 v35,v102,v103
v_fma_f32 v109,v109,s36,v17
v_mfma_f32_16x16x32_bf16 v[72:75],a[120:123],a[16:19],v[72:75]
v_fma_f32 v110,v110,s36,v17
v_fma_f32 v111,v111,s36,v17
v_smfmac_f32_16x16x64_bf16 v[64:67],a[152:155],v[28:35],v18
v_mfma_f32_16x16x32_bf16 v[72:75],a[124:127],a[20:23],v[72:75]
v_exp_f32 v108,v108
v_mfma_f32_16x16x32_bf16 v[80:83],a[124:127],a[44:47],0
v_exp_f32 v109,v109
v_mfma_f32_16x16x32_bf16 v[80:83],a[120:123],a[40:43],v[80:83]
v_exp_f32 v110,v110
v_mfma_f32_16x16x32_bf16 v[80:83],a[148:151],a[36:39],v[80:83]
v_exp_f32 v111,v111
v_mfma_f32_16x16x32_bf16 v[80:83],a[144:147],a[32:35],v[80:83]
buffer_load_dwordx4 v8,s[8:11],s21 offen offset:2048 lds
v_mfma_f32_16x16x32_bf16 v[80:83],a[140:143],a[28:31],v[80:83]
s_add_u32 s21,s21,12288
v_cvt_pk_bf16_f32 v38,v108,v109
v_cvt_pk_bf16_f32 v39,v110,v111
v_mfma_f32_16x16x32_bf16 v[80:83],a[136:139],a[24:27],v[80:83]
s_add_u32 m0,s22,12288
v_fma_f32 v72,v72,s36,v13
v_fma_f32 v73,v73,s36,v13
v_mfma_f32_16x16x32_bf16 v[88:91],a[136:139],a[48:51],0
v_fma_f32 v74,v74,s36,v13
v_fma_f32 v75,v75,s36,v13
v_mfma_f32_16x16x32_bf16 v[88:91],a[140:143],a[52:55],v[88:91]
v_exp_f32 v72,v72
v_mfma_f32_16x16x32_bf16 v[88:91],a[144:147],a[56:59],v[88:91]
v_fma_f32 v80,v80,s36,v14
v_fma_f32 v81,v81,s36,v14
v_mfma_f32_16x16x32_bf16 v[88:91],a[148:151],a[60:63],v[88:91]
v_fma_f32 v82,v82,s36,v14
v_fma_f32 v83,v83,s36,v14
v_mfma_f32_16x16x32_bf16 v[88:91],a[120:123],a[64:67],v[88:91]
v_exp_f32 v73,v73
v_mfma_f32_16x16x32_bf16 v[88:91],a[124:127],a[68:71],v[88:91]
v_exp_f32 v74,v74
v_mfma_f32_16x16x32_bf16 v[96:99],a[124:127],a[92:95],0
v_exp_f32 v75,v75
v_mfma_f32_16x16x32_bf16 v[96:99],a[120:123],a[88:91],v[96:99]
v_exp_f32 v80,v80
v_mfma_f32_16x16x32_bf16 v[96:99],a[148:151],a[84:87],v[96:99]
buffer_load_dwordx4 v6,s[4:7],s20 offen offset:0 lds
v_mfma_f32_16x16x32_bf16 v[96:99],a[144:147],a[80:83],v[96:99]
v_fma_f32 v88,v88,s36,v15
v_fma_f32 v89,v89,s36,v15
v_mfma_f32_16x16x32_bf16 v[96:99],a[140:143],a[76:79],v[96:99]
v_exp_f32 v81,v81
v_mfma_f32_16x16x32_bf16 v[96:99],a[136:139],a[72:75],v[96:99]
v_exp_f32 v82,v82
v_mfma_f32_16x16x32_bf16 v[104:107],a[136:139],a[96:99],0
ds_read_b128 a[136:139],v0 offset:30848
v_cvt_pk_bf16_f32 v44,v72,v73
v_mfma_f32_16x16x32_bf16 v[104:107],a[140:143],a[100:103],v[104:107]
ds_read_b128 a[140:143],v1 offset:30848
v_cvt_pk_bf16_f32 v45,v74,v75
v_mfma_f32_16x16x32_bf16 v[104:107],a[144:147],a[104:107],v[104:107]
ds_read_b128 a[144:147],v0 offset:30976
v_cvt_pk_bf16_f32 v48,v80,v81
v_mfma_f32_16x16x32_bf16 v[104:107],a[148:151],a[108:111],v[104:107]
ds_read_b128 a[148:151],v1 offset:30976
v_mfma_f32_16x16x32_bf16 v[104:107],a[120:123],a[112:115],v[104:107]
v_exp_f32 v83,v83
v_mfma_f32_16x16x32_bf16 v[104:107],a[124:127],a[116:119],v[104:107]
s_waitcnt lgkmcnt(4)
v_exp_f32 v88,v88
v_mfma_f32_16x16x32_bf16 v[76:79],a[128:131],a[0:3],0
v_exp_f32 v89,v89
v_mfma_f32_16x16x32_bf16 v[76:79],a[132:135],a[4:7],v[76:79]
buffer_load_dwordx4 v7,s[4:7],s20 offen offset:1024 lds
s_waitcnt lgkmcnt(3)
v_mfma_f32_16x16x32_bf16 v[76:79],a[136:139],a[8:11],v[76:79]
s_waitcnt lgkmcnt(2)
v_cvt_pk_bf16_f32 v49,v82,v83
v_cvt_pk_bf16_f32 v52,v88,v89
v_mfma_f32_16x16x32_bf16 v[76:79],a[140:143],a[12:15],v[76:79]
s_waitcnt lgkmcnt(0)
v_mfma_f32_16x16x32_bf16 v[76:79],a[144:147],a[16:19],v[76:79]
v_mfma_f32_16x16x32_bf16 v[76:79],a[148:151],a[20:23],v[76:79]
v_mfma_f32_16x16x32_bf16 v[84:87],a[148:151],a[44:47],0
v_mfma_f32_16x16x32_bf16 v[84:87],a[144:147],a[40:43],v[84:87]
v_mfma_f32_16x16x32_bf16 v[84:87],a[140:143],a[36:39],v[84:87]
v_mfma_f32_16x16x32_bf16 v[84:87],a[136:139],a[32:35],v[84:87]
v_mfma_f32_16x16x32_bf16 v[84:87],a[132:135],a[28:31],v[84:87]
v_mfma_f32_16x16x32_bf16 v[84:87],a[128:131],a[24:27],v[84:87]
v_mfma_f32_16x16x32_bf16 v[92:95],a[128:131],a[48:51],0
v_mfma_f32_16x16x32_bf16 v[92:95],a[132:135],a[52:55],v[92:95]
buffer_load_dwordx4 v8,s[4:7],s20 offen offset:2048 lds
v_mfma_f32_16x16x32_bf16 v[92:95],a[136:139],a[56:59],v[92:95]
s_add_u32 s20,s20,12288
v_mfma_f32_16x16x32_bf16 v[92:95],a[140:143],a[60:63],v[92:95]
v_mfma_f32_16x16x32_bf16 v[92:95],a[144:147],a[64:67],v[92:95]
v_mfma_f32_16x16x32_bf16 v[92:95],a[148:151],a[68:71],v[92:95]
v_mfma_f32_16x16x32_bf16 v[100:103],a[148:151],a[92:95],0
ds_read_b64_tr_b16 a[120:121],v2 offset:12288
v_mfma_f32_16x16x32_bf16 v[100:103],a[144:147],a[88:91],v[100:103]
ds_read_b64_tr_b16 a[122:123],v2 offset:18432
v_mfma_f32_16x16x32_bf16 v[100:103],a[140:143],a[84:87],v[100:103]
v_mfma_f32_16x16x32_bf16 v[100:103],a[136:139],a[80:83],v[100:103]
ds_read_b64_tr_b16 a[124:125],v3 offset:12288
v_mfma_f32_16x16x32_bf16 v[100:103],a[132:135],a[76:79],v[100:103]
ds_read_b64_tr_b16 a[126:127],v3 offset:18432
v_mfma_f32_16x16x32_bf16 v[100:103],a[128:131],a[72:75],v[100:103]
v_mfma_f32_16x16x32_bf16 v[108:111],a[128:131],a[96:99],0
ds_read_b64_tr_b16 a[128:129],v4 offset:12288
v_mfma_f32_16x16x32_bf16 v[108:111],a[132:135],a[100:103],v[108:111]
ds_read_b64_tr_b16 a[130:131],v4 offset:18432
v_mfma_f32_16x16x32_bf16 v[108:111],a[136:139],a[104:107],v[108:111]
ds_read_b64_tr_b16 a[132:133],v5 offset:12288
v_mfma_f32_16x16x32_bf16 v[108:111],a[140:143],a[108:111],v[108:111]
ds_read_b64_tr_b16 a[134:135],v5 offset:18432
v_mfma_f32_16x16x32_bf16 v[108:111],a[144:147],a[112:115],v[108:111]
v_mfma_f32_16x16x32_bf16 v[108:111],a[148:151],a[116:119],v[108:111]
s_waitcnt lgkmcnt(4)
v_mfma_f32_16x16x32_bf16 v[160:163],a[120:123],v[20:23],v[160:163]
s_add_u32 m0,s23,12288
ds_read_b64_tr_b16 a[142:143],v3 offset:18560
v_fma_f32 v90,v90,s36,v15
v_mfma_f32_16x16x32_bf16 v[164:167],a[124:127],v[20:23],v[164:167]
ds_read_b64_tr_b16 a[136:137],v2 offset:12416
v_fma_f32 v91,v91,s36,v15
v_mfma_f32_16x16x32_bf16 v[212:215],a[124:127],v[24:27],v[212:215]
ds_read_b64_tr_b16 a[138:139],v2 offset:18560
v_fma_f32 v97,v97,s36,v16
v_mfma_f32_16x16x32_bf16 v[208:211],a[120:123],v[24:27],v[208:211]
ds_read_b64_tr_b16 a[140:141],v3 offset:12416
v_fma_f32 v96,v96,s36,v16
v_mfma_f32_16x16x32_bf16 v[112:115],a[120:123],v[28:31],v[112:115]
ds_read_b64_tr_b16 a[146:147],v4 offset:18560
v_fma_f32 v98,v98,s36,v16
v_mfma_f32_16x16x32_bf16 v[116:119],a[124:127],v[28:31],v[116:119]
ds_read_b64_tr_b16 a[144:145],v4 offset:12416
v_fma_f32 v99,v99,s36,v16
v_mfma_f32_16x16x32_bf16 a[164:167],a[124:127],v[32:35],a[164:167]
ds_read_b64_tr_b16 a[150:151],v5 offset:18560
v_fma_f32 v106,v106,s36,v17
v_mfma_f32_16x16x32_bf16 a[160:163],a[120:123],v[32:35],a[160:163]
ds_read_b64_tr_b16 a[148:149],v5 offset:12416
v_fma_f32 v107,v107,s36,v17
v_mfma_f32_16x16x32_bf16 a[208:211],a[120:123],v[36:39],a[208:211]
ds_read_b64_tr_b16 a[122:123],v2 offset:18688
v_fma_f32 v104,v104,s36,v17
v_mfma_f32_16x16x32_bf16 a[212:215],a[124:127],v[36:39],a[212:215]
s_waitcnt lgkmcnt(6)
ds_read_b64_tr_b16 a[126:127],v3 offset:18688
v_fma_f32 v105,v105,s36,v17
v_mfma_f32_16x16x32_bf16 a[216:219],a[128:131],v[36:39],a[216:219]
ds_read_b64_tr_b16 a[120:121],v2 offset:12544
v_fma_f32 v77,v77,s36,v13
v_mfma_f32_16x16x32_bf16 a[220:223],a[132:135],v[36:39],a[220:223]
ds_read_b64_tr_b16 a[124:125],v3 offset:12544
v_fma_f32 v79,v79,s36,v13
v_mfma_f32_16x16x32_bf16 a[172:175],a[132:135],v[32:35],a[172:175]
v_exp_f32 v91,v91
v_mfma_f32_16x16x32_bf16 a[168:171],a[128:131],v[32:35],a[168:171]
v_exp_f32 v90,v90
v_mfma_f32_16x16x32_bf16 v[120:123],a[128:131],v[28:31],v[120:123]
v_cvt_pk_bf16_f32 v53,v90,v91
v_fma_f32 v76,v76,s36,v13
v_mfma_f32_16x16x32_bf16 v[124:127],a[132:135],v[28:31],v[124:127]
v_exp_f32 v99,v99
v_mfma_f32_16x16x32_bf16 v[220:223],a[132:135],v[24:27],v[220:223]
v_exp_f32 v96,v96
v_mfma_f32_16x16x32_bf16 v[216:219],a[128:131],v[24:27],v[216:219]
v_exp_f32 v98,v98
v_mfma_f32_16x16x32_bf16 v[168:171],a[128:131],v[20:23],v[168:171]
ds_read_b64_tr_b16 a[128:129],v4 offset:12544
v_cvt_pk_bf16_f32 v57,v98,v99
v_mfma_f32_16x16x32_bf16 v[172:175],a[132:135],v[20:23],v[172:175]
ds_read_b64_tr_b16 a[130:131],v4 offset:18688
v_fma_f32 v78,v78,s36,v13
v_mfma_f32_16x16x32_bf16 v[176:179],a[136:139],v[20:23],v[176:179]
s_waitcnt lgkmcnt(2)
ds_read_b64_tr_b16 a[132:133],v5 offset:12544
v_fma_f32 v86,v86,s36,v14
v_mfma_f32_16x16x32_bf16 v[180:183],a[140:143],v[20:23],v[180:183]
ds_read_b64_tr_b16 a[134:135],v5 offset:18688
v_fma_f32 v84,v84,s36,v14
v_mfma_f32_16x16x32_bf16 v[228:231],a[140:143],v[24:27],v[228:231]
v_exp_f32 v97,v97
v_mfma_f32_16x16x32_bf16 v[224:227],a[136:139],v[24:27],v[224:227]
v_cvt_pk_bf16_f32 v56,v96,v97
v_fma_f32 v87,v87,s36,v14
v_mfma_f32_16x16x32_bf16 v[128:131],a[136:139],v[28:31],v[128:131]
v_exp_f32 v104,v104
v_mfma_f32_16x16x32_bf16 v[132:135],a[140:143],v[28:31],v[132:135]
v_exp_f32 v107,v107
v_mfma_f32_16x16x32_bf16 a[180:183],a[140:143],v[32:35],a[180:183]
v_exp_f32 v105,v105
v_mfma_f32_16x16x32_bf16 a[176:179],a[136:139],v[32:35],a[176:179]
v_exp_f32 v106,v106
v_mfma_f32_16x16x32_bf16 a[224:227],a[136:139],v[36:39],a[224:227]
v_cvt_pk_bf16_f32 v41,v106,v107
v_cvt_pk_bf16_f32 v40,v104,v105
v_mfma_f32_16x16x32_bf16 a[228:231],a[140:143],v[36:39],a[228:231]
v_exp_f32 v78,v78
v_mfma_f32_16x16x32_bf16 a[232:235],a[144:147],v[36:39],a[232:235]
v_exp_f32 v79,v79
v_mfma_f32_16x16x32_bf16 a[236:239],a[148:151],v[36:39],a[236:239]
v_exp_f32 v77,v77
v_mfma_f32_16x16x32_bf16 a[188:191],a[148:151],v[32:35],a[188:191]
v_exp_f32 v76,v76
v_mfma_f32_16x16x32_bf16 a[184:187],a[144:147],v[32:35],a[184:187]
v_cvt_pk_bf16_f32 v46,v76,v77
v_cvt_pk_bf16_f32 v47,v78,v79
v_mfma_f32_16x16x32_bf16 v[136:139],a[144:147],v[28:31],v[136:139]
v_exp_f32 v86,v86
v_mfma_f32_16x16x32_bf16 v[140:143],a[148:151],v[28:31],v[140:143]
v_exp_f32 v87,v87
v_mfma_f32_16x16x32_bf16 v[236:239],a[148:151],v[24:27],v[236:239]
v_exp_f32 v84,v84
v_mfma_f32_16x16x32_bf16 v[232:235],a[144:147],v[24:27],v[232:235]
v_fma_f32 v85,v85,s36,v14
v_cvt_pk_bf16_f32 v51,v86,v87
v_mfma_f32_16x16x32_bf16 v[184:187],a[144:147],v[20:23],v[184:187]
v_exp_f32 v85,v85
v_mfma_f32_16x16x32_bf16 v[188:191],a[148:151],v[20:23],v[188:191]
v_cvt_pk_bf16_f32 v50,v84,v85
v_fma_f32 v92,v92,s36,v15
v_mfma_f32_16x16x32_bf16 v[192:195],a[120:123],v[20:23],v[192:195]
v_fma_f32 v94,v94,s36,v15
v_fma_f32 v93,v93,s36,v15
v_smfmac_f32_16x16x64_bf16 v[60:63],a[152:155],v[44:51],v18
v_fma_f32 v95,v95,s36,v15
v_mfma_f32_16x16x32_bf16 v[196:199],a[124:127],v[20:23],v[196:199]
s_waitcnt vmcnt(9) lgkmcnt(0)
v_exp_f32 v94,v94
v_mfma_f32_16x16x32_bf16 v[244:247],a[124:127],v[24:27],v[244:247]
s_barrier
v_mfma_f32_16x16x32_bf16 v[240:243],a[120:123],v[24:27],v[240:243]
ds_read_b128 a[136:139],v0 offset:0
v_fma_f32 v102,v102,s36,v16
v_mfma_f32_16x16x32_bf16 v[144:147],a[120:123],v[28:31],v[144:147]
ds_read_b128 a[144:147],v0 offset:128
v_fma_f32 v101,v101,s36,v16
v_mfma_f32_16x16x32_bf16 v[148:151],a[124:127],v[28:31],v[148:151]
ds_read_b128 a[140:143],v1 offset:0
v_fma_f32 v100,v100,s36,v16
v_mfma_f32_16x16x32_bf16 a[196:199],a[124:127],v[32:35],a[196:199]
ds_read_b128 a[148:151],v1 offset:128
v_fma_f32 v103,v103,s36,v16
v_mfma_f32_16x16x32_bf16 a[192:195],a[120:123],v[32:35],a[192:195]
ds_read_b128 a[156:159],v10 offset:3072
v_fma_f32 v108,v108,s36,v17
v_mfma_f32_16x16x32_bf16 a[240:243],a[120:123],v[36:39],a[240:243]
buffer_load_dwordx4 v6,s[8:11],s21 offen offset:0 lds
v_mfma_f32_16x16x32_bf16 a[244:247],a[124:127],v[36:39],a[244:247]
ds_read_b128 a[120:123],v0 offset:256
v_fma_f32 v110,v110,s36,v17
v_mfma_f32_16x16x32_bf16 a[248:251],a[128:131],v[36:39],a[248:251]
ds_read_b128 a[124:127],v1 offset:256
v_fma_f32 v111,v111,s36,v17
v_mfma_f32_16x16x32_bf16 a[252:255],a[132:135],v[36:39],a[252:255]
v_exp_f32 v92,v92
v_mfma_f32_16x16x32_bf16 a[204:207],a[132:135],v[32:35],a[204:207]
v_exp_f32 v95,v95
v_mfma_f32_16x16x32_bf16 a[200:203],a[128:131],v[32:35],a[200:203]
v_cvt_pk_bf16_f32 v55,v94,v95
v_fma_f32 v109,v109,s36,v17
v_mfma_f32_16x16x32_bf16 v[152:155],a[128:131],v[28:31],v[152:155]
v_exp_f32 v93,v93
v_mfma_f32_16x16x32_bf16 v[156:159],a[132:135],v[28:31],v[156:159]
v_cvt_pk_bf16_f32 v54,v92,v93
v_mfma_f32_16x16x32_bf16 v[252:255],a[132:135],v[24:27],v[252:255]
v_exp_f32 v102,v102
v_mfma_f32_16x16x32_bf16 v[248:251],a[128:131],v[24:27],v[248:251]
v_exp_f32 v101,v101
v_mfma_f32_16x16x32_bf16 v[200:203],a[128:131],v[20:23],v[200:203]
ds_read_b128 a[128:131],v0 offset:6144
v_mfma_f32_16x16x32_bf16 v[204:207],a[132:135],v[20:23],v[204:207]
s_waitcnt lgkmcnt(1)
buffer_store_dwordx4 a[156:159],v9,s[16:19],s27 offen offset:0 nt
buffer_load_dwordx4 v7,s[8:11],s21 offen offset:1024 lds
v_mfma_f32_16x16x32_bf16 v[72:75],a[136:139],a[0:3],0
ds_read_b128 a[132:135],v1 offset:6144
v_mfma_f32_16x16x32_bf16 v[72:75],a[140:143],a[4:7],v[72:75]
v_exp_f32 v103,v103
v_mfma_f32_16x16x32_bf16 v[72:75],a[144:147],a[8:11],v[72:75]
v_exp_f32 v100,v100
v_mfma_f32_16x16x32_bf16 v[72:75],a[148:151],a[12:15],v[72:75]
v_cvt_pk_bf16_f32 v59,v102,v103
v_cvt_pk_bf16_f32 v58,v100,v101
v_mfma_f32_16x16x32_bf16 v[72:75],a[120:123],a[16:19],v[72:75]
v_exp_f32 v109,v109
v_smfmac_f32_16x16x64_bf16 v[64:67],a[152:155],v[52:59],v18
ds_read_b128 a[156:159],v10 offset:4096
v_mfma_f32_16x16x32_bf16 v[72:75],a[124:127],a[20:23],v[72:75]
v_exp_f32 v111,v111
v_mfma_f32_16x16x32_bf16 v[80:83],a[124:127],a[44:47],0
v_exp_f32 v108,v108
v_mfma_f32_16x16x32_bf16 v[80:83],a[120:123],a[40:43],v[80:83]
v_exp_f32 v110,v110
v_mfma_f32_16x16x32_bf16 v[80:83],a[148:151],a[36:39],v[80:83]
v_cvt_pk_bf16_f32 v42,v108,v109
v_cvt_pk_bf16_f32 v43,v110,v111
v_mfma_f32_16x16x32_bf16 v[80:83],a[144:147],a[32:35],v[80:83]
buffer_load_dwordx4 v8,s[8:11],s21 offen offset:2048 lds
v_smfmac_f32_16x16x64_bf16 v[68:71],a[152:155],v[36:43],v18
s_add_u32 s21,s21,12288
v_fma_f32 v73,v73,s36,v13
v_mfma_f32_16x16x32_bf16 v[80:83],a[140:143],a[28:31],v[80:83]
s_add_u32 m0,s22,24576
v_fma_f32 v72,v72,s36,v13
v_fma_f32 v74,v74,s36,v13
v_mfma_f32_16x16x32_bf16 v[80:83],a[136:139],a[24:27],v[80:83]
v_exp_f32 v73,v73
v_mfma_f32_16x16x32_bf16 v[88:91],a[136:139],a[48:51],0
v_exp_f32 v72,v72
v_mfma_f32_16x16x32_bf16 v[88:91],a[140:143],a[52:55],v[88:91]
v_exp_f32 v74,v74
v_mfma_f32_16x16x32_bf16 v[88:91],a[144:147],a[56:59],v[88:91]
v_fma_f32 v75,v75,s36,v13
v_cvt_pk_bf16_f32 v20,v72,v73
v_mfma_f32_16x16x32_bf16 v[88:91],a[148:151],a[60:63],v[88:91]
v_exp_f32 v75,v75
v_mfma_f32_16x16x32_bf16 v[88:91],a[120:123],a[64:67],v[88:91]
v_fma_f32 v83,v83,s36,v14
v_fma_f32 v81,v81,s36,v14
v_mfma_f32_16x16x32_bf16 v[88:91],a[124:127],a[68:71],v[88:91]
v_exp_f32 v81,v81
v_mfma_f32_16x16x32_bf16 v[96:99],a[124:127],a[92:95],0
v_cvt_pk_bf16_f32 v21,v74,v75
v_fma_f32 v82,v82,s36,v14
v_mfma_f32_16x16x32_bf16 v[96:99],a[120:123],a[88:91],v[96:99]
s_waitcnt lgkmcnt(0)
buffer_store_dwordx4 a[156:159],v9,s[16:19],s27 offen offset:128 nt
buffer_load_dwordx4 v6,s[4:7],s20 offen offset:0 lds
v_mfma_f32_16x16x32_bf16 v[96:99],a[148:151],a[84:87],v[96:99]
v_fma_f32 v88,v88,s36,v15
v_fma_f32 v89,v89,s36,v15
v_mfma_f32_16x16x32_bf16 v[96:99],a[144:147],a[80:83],v[96:99]
v_exp_f32 v89,v89
v_mfma_f32_16x16x32_bf16 v[96:99],a[140:143],a[76:79],v[96:99]
v_exp_f32 v82,v82
v_mfma_f32_16x16x32_bf16 v[96:99],a[136:139],a[72:75],v[96:99]
v_exp_f32 v88,v88
v_mfma_f32_16x16x32_bf16 v[104:107],a[136:139],a[96:99],0
ds_read_b128 a[136:139],v0 offset:6272
v_fma_f32 v80,v80,s36,v14
v_mfma_f32_16x16x32_bf16 v[104:107],a[140:143],a[100:103],v[104:107]
ds_read_b128 a[156:159],v10 offset:5120
v_mfma_f32_16x16x32_bf16 v[104:107],a[144:147],a[104:107],v[104:107]
ds_read_b128 a[140:143],v1 offset:6272
v_mfma_f32_16x16x32_bf16 v[104:107],a[148:151],a[108:111],v[104:107]
ds_read_b128 a[144:147],v0 offset:6400
v_mfma_f32_16x16x32_bf16 v[104:107],a[120:123],a[112:115],v[104:107]
ds_read_b128 a[148:151],v1 offset:6400
v_mfma_f32_16x16x32_bf16 v[104:107],a[124:127],a[116:119],v[104:107]
v_exp_f32 v80,v80
v_mfma_f32_16x16x32_bf16 v[76:79],a[128:131],a[0:3],0
buffer_load_dwordx4 v7,s[4:7],s20 offen offset:1024 lds
v_mfma_f32_16x16x32_bf16 v[76:79],a[132:135],a[4:7],v[76:79]
s_waitcnt lgkmcnt(4)
v_cvt_pk_bf16_f32 v24,v80,v81
v_cvt_pk_bf16_f32 v28,v88,v89
v_mfma_f32_16x16x32_bf16 v[76:79],a[136:139],a[8:11],v[76:79]
s_waitcnt lgkmcnt(2)
v_exp_f32 v83,v83
v_mfma_f32_16x16x32_bf16 v[76:79],a[140:143],a[12:15],v[76:79]
s_waitcnt lgkmcnt(1)
v_cvt_pk_bf16_f32 v25,v82,v83
v_mfma_f32_16x16x32_bf16 v[76:79],a[144:147],a[16:19],v[76:79]
s_waitcnt lgkmcnt(0)
v_mfma_f32_16x16x32_bf16 v[76:79],a[148:151],a[20:23],v[76:79]
v_mfma_f32_16x16x32_bf16 v[84:87],a[148:151],a[44:47],0
v_mfma_f32_16x16x32_bf16 v[84:87],a[144:147],a[40:43],v[84:87]
v_mfma_f32_16x16x32_bf16 v[84:87],a[140:143],a[36:39],v[84:87]
v_mfma_f32_16x16x32_bf16 v[84:87],a[136:139],a[32:35],v[84:87]
v_mfma_f32_16x16x32_bf16 v[84:87],a[132:135],a[28:31],v[84:87]
buffer_store_dwordx4 a[156:159],v9,s[16:19],s27 offen offset:256 nt
buffer_load_dwordx4 v8,s[4:7],s20 offen offset:2048 lds
v_mfma_f32_16x16x32_bf16 v[84:87],a[128:131],a[24:27],v[84:87]
s_add_u32 s20,s20,12288
v_mfma_f32_16x16x32_bf16 v[92:95],a[128:131],a[48:51],0
s_add_u32 s27,s27,3072
v_mfma_f32_16x16x32_bf16 v[92:95],a[132:135],a[52:55],v[92:95]
v_mfma_f32_16x16x32_bf16 v[92:95],a[136:139],a[56:59],v[92:95]
v_mfma_f32_16x16x32_bf16 v[92:95],a[140:143],a[60:63],v[92:95]
ds_read_b64_tr_b16 a[120:121],v2 offset:24576
v_mfma_f32_16x16x32_bf16 v[92:95],a[144:147],a[64:67],v[92:95]
ds_read_b64_tr_b16 a[122:123],v2 offset:30720
v_mfma_f32_16x16x32_bf16 v[92:95],a[148:151],a[68:71],v[92:95]
v_mfma_f32_16x16x32_bf16 v[100:103],a[148:151],a[92:95],0
ds_read_b64_tr_b16 a[124:125],v3 offset:24576
v_mfma_f32_16x16x32_bf16 v[100:103],a[144:147],a[88:91],v[100:103]
ds_read_b64_tr_b16 a[126:127],v3 offset:30720
v_mfma_f32_16x16x32_bf16 v[100:103],a[140:143],a[84:87],v[100:103]
v_mfma_f32_16x16x32_bf16 v[100:103],a[136:139],a[80:83],v[100:103]
v_mfma_f32_16x16x32_bf16 v[100:103],a[132:135],a[76:79],v[100:103]
v_mfma_f32_16x16x32_bf16 v[100:103],a[128:131],a[72:75],v[100:103]
v_mfma_f32_16x16x32_bf16 v[108:111],a[128:131],a[96:99],0
ds_read_b64_tr_b16 a[130:131],v4 offset:30720
v_mfma_f32_16x16x32_bf16 v[108:111],a[132:135],a[100:103],v[108:111]
ds_read_b64_tr_b16 a[128:129],v4 offset:24576
v_mfma_f32_16x16x32_bf16 v[108:111],a[136:139],a[104:107],v[108:111]
ds_read_b64_tr_b16 a[134:135],v5 offset:30720
v_mfma_f32_16x16x32_bf16 v[108:111],a[140:143],a[108:111],v[108:111]
ds_read_b64_tr_b16 a[132:133],v5 offset:24576
v_mfma_f32_16x16x32_bf16 v[108:111],a[144:147],a[112:115],v[108:111]
v_mfma_f32_16x16x32_bf16 v[108:111],a[148:151],a[116:119],v[108:111]
s_waitcnt lgkmcnt(4)
v_mfma_f32_16x16x32_bf16 v[160:163],a[120:123],v[44:47],v[160:163]
s_add_u32 m0,s29,0
ds_read_b64_tr_b16 a[136:137],v2 offset:24704
v_fma_f32 v90,v90,s36,v15
v_mfma_f32_16x16x32_bf16 v[164:167],a[124:127],v[44:47],v[164:167]
ds_read_b64_tr_b16 a[138:139],v2 offset:30848
v_fma_f32 v91,v91,s36,v15
v_mfma_f32_16x16x32_bf16 v[212:215],a[124:127],v[48:51],v[212:215]
ds_read_b64_tr_b16 a[140:141],v3 offset:24704
v_fma_f32 v96,v96,s36,v16
v_mfma_f32_16x16x32_bf16 v[208:211],a[120:123],v[48:51],v[208:211]
ds_read_b64_tr_b16 a[142:143],v3 offset:30848
v_fma_f32 v97,v97,s36,v16
v_mfma_f32_16x16x32_bf16 v[112:115],a[120:123],v[52:55],v[112:115]
ds_read_b64_tr_b16 a[144:145],v4 offset:24704
v_fma_f32 v98,v98,s36,v16
v_mfma_f32_16x16x32_bf16 v[116:119],a[124:127],v[52:55],v[116:119]
ds_read_b64_tr_b16 a[146:147],v4 offset:30848
v_fma_f32 v99,v99,s36,v16
v_mfma_f32_16x16x32_bf16 a[164:167],a[124:127],v[56:59],a[164:167]
ds_read_b64_tr_b16 a[148:149],v5 offset:24704
v_fma_f32 v104,v104,s36,v17
v_mfma_f32_16x16x32_bf16 a[160:163],a[120:123],v[56:59],a[160:163]
buffer_load_dwordx4 v6,s[12:15],s28 offen offset:0 nt lds
v_mfma_f32_16x16x32_bf16 a[208:211],a[120:123],v[40:43],a[208:211]
ds_read_b64_tr_b16 a[150:151],v5 offset:30848
v_fma_f32 v105,v105,s36,v17
v_mfma_f32_16x16x32_bf16 a[212:215],a[124:127],v[40:43],a[212:215]
s_waitcnt lgkmcnt(5)
ds_read_b64_tr_b16 a[120:121],v2 offset:24832
v_fma_f32 v106,v106,s36,v17
v_mfma_f32_16x16x32_bf16 a[216:219],a[128:131],v[40:43],a[216:219]
ds_read_b64_tr_b16 a[122:123],v2 offset:30976
v_fma_f32 v107,v107,s36,v17
v_mfma_f32_16x16x32_bf16 a[220:223],a[132:135],v[40:43],a[220:223]
ds_read_b64_tr_b16 a[124:125],v3 offset:24832
v_fma_f32 v76,v76,s36,v13
v_mfma_f32_16x16x32_bf16 a[172:175],a[132:135],v[56:59],a[172:175]
ds_read_b64_tr_b16 a[126:127],v3 offset:30976
v_fma_f32 v77,v77,s36,v13
v_mfma_f32_16x16x32_bf16 a[168:171],a[128:131],v[56:59],a[168:171]
v_exp_f32 v90,v90
v_mfma_f32_16x16x32_bf16 v[120:123],a[128:131],v[52:55],v[120:123]
v_exp_f32 v91,v91
v_mfma_f32_16x16x32_bf16 v[124:127],a[132:135],v[52:55],v[124:127]
v_cvt_pk_bf16_f32 v29,v90,v91
v_fma_f32 v78,v78,s36,v13
v_mfma_f32_16x16x32_bf16 v[220:223],a[132:135],v[48:51],v[220:223]
v_exp_f32 v96,v96
v_mfma_f32_16x16x32_bf16 v[216:219],a[128:131],v[48:51],v[216:219]
buffer_load_dwordx4 v7,s[12:15],s28 offen offset:1024 nt lds
v_mfma_f32_16x16x32_bf16 v[168:171],a[128:131],v[44:47],v[168:171]
ds_read_b64_tr_b16 a[128:129],v4 offset:24832
v_fma_f32 v79,v79,s36,v13
v_mfma_f32_16x16x32_bf16 v[172:175],a[132:135],v[44:47],v[172:175]
ds_read_b64_tr_b16 a[130:131],v4 offset:30976
v_fma_f32 v84,v84,s36,v14
v_mfma_f32_16x16x32_bf16 v[176:179],a[136:139],v[44:47],v[176:179]
s_waitcnt lgkmcnt(2)
ds_read_b64_tr_b16 a[132:133],v5 offset:24832
v_fma_f32 v85,v85,s36,v14
v_mfma_f32_16x16x32_bf16 v[180:183],a[140:143],v[44:47],v[180:183]
ds_read_b64_tr_b16 a[134:135],v5 offset:30976
v_fma_f32 v86,v86,s36,v14
v_mfma_f32_16x16x32_bf16 v[228:231],a[140:143],v[48:51],v[228:231]
v_exp_f32 v97,v97
v_mfma_f32_16x16x32_bf16 v[224:227],a[136:139],v[48:51],v[224:227]
v_exp_f32 v98,v98
v_mfma_f32_16x16x32_bf16 v[128:131],a[136:139],v[52:55],v[128:131]
v_exp_f32 v99,v99
v_mfma_f32_16x16x32_bf16 v[132:135],a[140:143],v[52:55],v[132:135]
v_cvt_pk_bf16_f32 v32,v96,v97
v_cvt_pk_bf16_f32 v33,v98,v99
v_mfma_f32_16x16x32_bf16 a[180:183],a[140:143],v[56:59],a[180:183]
v_exp_f32 v104,v104
v_mfma_f32_16x16x32_bf16 a[176:179],a[136:139],v[56:59],a[176:179]
buffer_load_dwordx4 v8,s[12:15],s28 offen offset:2048 nt lds
v_mfma_f32_16x16x32_bf16 a[224:227],a[136:139],v[40:43],a[224:227]
s_add_u32 s28,s28,3072
v_exp_f32 v105,v105
v_mfma_f32_16x16x32_bf16 a[228:231],a[140:143],v[40:43],a[228:231]
s_add_u32 s29,s29,3072
v_exp_f32 v106,v106
v_mfma_f32_16x16x32_bf16 a[232:235],a[144:147],v[40:43],a[232:235]
s_add_u32 m0,s23,24576
v_exp_f32 v107,v107
v_mfma_f32_16x16x32_bf16 a[236:239],a[148:151],v[40:43],a[236:239]
v_cvt_pk_bf16_f32 v36,v104,v105
v_cvt_pk_bf16_f32 v37,v106,v107
v_mfma_f32_16x16x32_bf16 a[188:191],a[148:151],v[56:59],a[188:191]
v_exp_f32 v76,v76
v_mfma_f32_16x16x32_bf16 a[184:187],a[144:147],v[56:59],a[184:187]
v_exp_f32 v77,v77
v_mfma_f32_16x16x32_bf16 v[136:139],a[144:147],v[52:55],v[136:139]
v_exp_f32 v78,v78
v_mfma_f32_16x16x32_bf16 v[140:143],a[148:151],v[52:55],v[140:143]
v_exp_f32 v79,v79
v_mfma_f32_16x16x32_bf16 v[236:239],a[148:151],v[48:51],v[236:239]
v_cvt_pk_bf16_f32 v22,v76,v77
v_cvt_pk_bf16_f32 v23,v78,v79
v_mfma_f32_16x16x32_bf16 v[232:235],a[144:147],v[48:51],v[232:235]
v_fma_f32 v87,v87,s36,v14
v_fma_f32 v92,v92,s36,v15
v_mfma_f32_16x16x32_bf16 v[184:187],a[144:147],v[44:47],v[184:187]
v_exp_f32 v84,v84
v_mfma_f32_16x16x32_bf16 v[188:191],a[148:151],v[44:47],v[188:191]
v_exp_f32 v85,v85
v_mfma_f32_16x16x32_bf16 v[192:195],a[120:123],v[44:47],v[192:195]
v_exp_f32 v86,v86
v_mfma_f32_16x16x32_bf16 v[196:199],a[124:127],v[44:47],v[196:199]
s_waitcnt vmcnt(12) lgkmcnt(0)
v_exp_f32 v87,v87
v_mfma_f32_16x16x32_bf16 v[244:247],a[124:127],v[48:51],v[244:247]
s_barrier
v_mfma_f32_16x16x32_bf16 v[240:243],a[120:123],v[48:51],v[240:243]
ds_read_b128 a[136:139],v0 offset:12288
v_cvt_pk_bf16_f32 v26,v84,v85
v_mfma_f32_16x16x32_bf16 v[144:147],a[120:123],v[52:55],v[144:147]
ds_read_b128 a[140:143],v1 offset:12288
v_cvt_pk_bf16_f32 v27,v86,v87
v_mfma_f32_16x16x32_bf16 v[148:151],a[124:127],v[52:55],v[148:151]
ds_read_b128 a[144:147],v0 offset:12416
v_fma_f32 v93,v93,s36,v15
v_smfmac_f32_16x16x64_bf16 v[60:63],a[152:155],v[20:27],v18
ds_read_b128 a[148:151],v1 offset:12416
v_mfma_f32_16x16x32_bf16 a[196:199],a[124:127],v[56:59],a[196:199]
v_fma_f32 v94,v94,s36,v15
v_fma_f32 v95,v95,s36,v15
v_mfma_f32_16x16x32_bf16 a[192:195],a[120:123],v[56:59],a[192:195]
buffer_load_dwordx4 v6,s[8:11],s21 offen offset:0 lds
v_mfma_f32_16x16x32_bf16 a[240:243],a[120:123],v[40:43],a[240:243]
ds_read_b128 a[120:123],v0 offset:12544
v_fma_f32 v100,v100,s36,v16
v_mfma_f32_16x16x32_bf16 a[244:247],a[124:127],v[40:43],a[244:247]
ds_read_b128 a[124:127],v1 offset:12544
v_fma_f32 v101,v101,s36,v16
v_mfma_f32_16x16x32_bf16 a[248:251],a[128:131],v[40:43],a[248:251]
v_exp_f32 v92,v92
v_mfma_f32_16x16x32_bf16 a[252:255],a[132:135],v[40:43],a[252:255]
v_exp_f32 v93,v93
v_mfma_f32_16x16x32_bf16 a[204:207],a[132:135],v[56:59],a[204:207]
v_exp_f32 v94,v94
v_mfma_f32_16x16x32_bf16 a[200:203],a[128:131],v[56:59],a[200:203]
v_exp_f32 v95,v95
v_mfma_f32_16x16x32_bf16 v[152:155],a[128:131],v[52:55],v[152:155]
v_cvt_pk_bf16_f32 v30,v92,v93
v_cvt_pk_bf16_f32 v31,v94,v95
v_mfma_f32_16x16x32_bf16 v[156:159],a[132:135],v[52:55],v[156:159]
v_fma_f32 v102,v102,s36,v16
v_fma_f32 v103,v103,s36,v16
v_mfma_f32_16x16x32_bf16 v[252:255],a[132:135],v[48:51],v[252:255]
v_exp_f32 v100,v100
v_mfma_f32_16x16x32_bf16 v[248:251],a[128:131],v[48:51],v[248:251]
v_exp_f32 v101,v101
v_mfma_f32_16x16x32_bf16 v[200:203],a[128:131],v[44:47],v[200:203]
buffer_load_dwordx4 v7,s[8:11],s21 offen offset:1024 lds
v_mfma_f32_16x16x32_bf16 v[204:207],a[132:135],v[44:47],v[204:207]
s_waitcnt lgkmcnt(0)
ds_read_b128 a[128:131],v0 offset:18432
v_cvt_pk_bf16_f32 v34,v100,v101
v_mfma_f32_16x16x32_bf16 v[72:75],a[136:139],a[0:3],0
ds_read_b128 a[132:135],v1 offset:18432
v_fma_f32 v108,v108,s36,v17
v_mfma_f32_16x16x32_bf16 v[72:75],a[140:143],a[4:7],v[72:75]
v_exp_f32 v102,v102
v_mfma_f32_16x16x32_bf16 v[72:75],a[144:147],a[8:11],v[72:75]
v_exp_f32 v103,v103
v_mfma_f32_16x16x32_bf16 v[72:75],a[148:151],a[12:15],v[72:75]
v_cvt_pk_bf16_f32 v35,v102,v103
v_fma_f32 v109,v109,s36,v17
v_mfma_f32_16x16x32_bf16 v[72:75],a[120:123],a[16:19],v[72:75]
v_fma_f32 v110,v110,s36,v17
v_fma_f32 v111,v111,s36,v17
v_smfmac_f32_16x16x64_bf16 v[64:67],a[152:155],v[28:35],v18
v_mfma_f32_16x16x32_bf16 v[72:75],a[124:127],a[20:23],v[72:75]
v_exp_f32 v108,v108
v_mfma_f32_16x16x32_bf16 v[80:83],a[124:127],a[44:47],0
v_exp_f32 v109,v109
v_mfma_f32_16x16x32_bf16 v[80:83],a[120:123],a[40:43],v[80:83]
v_exp_f32 v110,v110
v_mfma_f32_16x16x32_bf16 v[80:83],a[148:151],a[36:39],v[80:83]
v_exp_f32 v111,v111
v_mfma_f32_16x16x32_bf16 v[80:83],a[144:147],a[32:35],v[80:83]
buffer_load_dwordx4 v8,s[8:11],s21 offen offset:2048 lds
v_mfma_f32_16x16x32_bf16 v[80:83],a[140:143],a[28:31],v[80:83]
s_add_u32 s21,s21,12288
v_cvt_pk_bf16_f32 v38,v108,v109
v_cvt_pk_bf16_f32 v39,v110,v111
v_mfma_f32_16x16x32_bf16 v[80:83],a[136:139],a[24:27],v[80:83]
s_add_u32 m0,s22,0
v_fma_f32 v72,v72,s36,v13
v_fma_f32 v73,v73,s36,v13
v_mfma_f32_16x16x32_bf16 v[88:91],a[136:139],a[48:51],0
v_fma_f32 v74,v74,s36,v13
v_fma_f32 v75,v75,s36,v13
v_mfma_f32_16x16x32_bf16 v[88:91],a[140:143],a[52:55],v[88:91]
v_exp_f32 v72,v72
v_mfma_f32_16x16x32_bf16 v[88:91],a[144:147],a[56:59],v[88:91]
v_fma_f32 v80,v80,s36,v14
v_fma_f32 v81,v81,s36,v14
v_mfma_f32_16x16x32_bf16 v[88:91],a[148:151],a[60:63],v[88:91]
v_fma_f32 v82,v82,s36,v14
v_fma_f32 v83,v83,s36,v14
v_mfma_f32_16x16x32_bf16 v[88:91],a[120:123],a[64:67],v[88:91]
v_exp_f32 v73,v73
v_mfma_f32_16x16x32_bf16 v[88:91],a[124:127],a[68:71],v[88:91]
v_exp_f32 v74,v74
v_mfma_f32_16x16x32_bf16 v[96:99],a[124:127],a[92:95],0
v_exp_f32 v75,v75
v_mfma_f32_16x16x32_bf16 v[96:99],a[120:123],a[88:91],v[96:99]
v_exp_f32 v80,v80
v_mfma_f32_16x16x32_bf16 v[96:99],a[148:151],a[84:87],v[96:99]
buffer_load_dwordx4 v6,s[4:7],s20 offen offset:0 lds
v_mfma_f32_16x16x32_bf16 v[96:99],a[144:147],a[80:83],v[96:99]
v_fma_f32 v88,v88,s36,v15
v_fma_f32 v89,v89,s36,v15
v_mfma_f32_16x16x32_bf16 v[96:99],a[140:143],a[76:79],v[96:99]
v_exp_f32 v81,v81
v_mfma_f32_16x16x32_bf16 v[96:99],a[136:139],a[72:75],v[96:99]
v_exp_f32 v82,v82
v_mfma_f32_16x16x32_bf16 v[104:107],a[136:139],a[96:99],0
ds_read_b128 a[136:139],v0 offset:18560
v_cvt_pk_bf16_f32 v44,v72,v73
v_mfma_f32_16x16x32_bf16 v[104:107],a[140:143],a[100:103],v[104:107]
ds_read_b128 a[140:143],v1 offset:18560
v_cvt_pk_bf16_f32 v45,v74,v75
v_mfma_f32_16x16x32_bf16 v[104:107],a[144:147],a[104:107],v[104:107]
ds_read_b128 a[144:147],v0 offset:18688
v_cvt_pk_bf16_f32 v48,v80,v81
v_mfma_f32_16x16x32_bf16 v[104:107],a[148:151],a[108:111],v[104:107]
ds_read_b128 a[148:151],v1 offset:18688
v_mfma_f32_16x16x32_bf16 v[104:107],a[120:123],a[112:115],v[104:107]
v_exp_f32 v83,v83
v_mfma_f32_16x16x32_bf16 v[104:107],a[124:127],a[116:119],v[104:107]
s_waitcnt lgkmcnt(4)
v_exp_f32 v88,v88
v_mfma_f32_16x16x32_bf16 v[76:79],a[128:131],a[0:3],0
v_exp_f32 v89,v89
v_mfma_f32_16x16x32_bf16 v[76:79],a[132:135],a[4:7],v[76:79]
buffer_load_dwordx4 v7,s[4:7],s20 offen offset:1024 lds
s_waitcnt lgkmcnt(3)
v_mfma_f32_16x16x32_bf16 v[76:79],a[136:139],a[8:11],v[76:79]
s_waitcnt lgkmcnt(2)
v_cvt_pk_bf16_f32 v49,v82,v83
v_cvt_pk_bf16_f32 v52,v88,v89
v_mfma_f32_16x16x32_bf16 v[76:79],a[140:143],a[12:15],v[76:79]
s_waitcnt lgkmcnt(0)
v_mfma_f32_16x16x32_bf16 v[76:79],a[144:147],a[16:19],v[76:79]
v_mfma_f32_16x16x32_bf16 v[76:79],a[148:151],a[20:23],v[76:79]
v_mfma_f32_16x16x32_bf16 v[84:87],a[148:151],a[44:47],0
v_mfma_f32_16x16x32_bf16 v[84:87],a[144:147],a[40:43],v[84:87]
v_mfma_f32_16x16x32_bf16 v[84:87],a[140:143],a[36:39],v[84:87]
v_mfma_f32_16x16x32_bf16 v[84:87],a[136:139],a[32:35],v[84:87]
v_mfma_f32_16x16x32_bf16 v[84:87],a[132:135],a[28:31],v[84:87]
v_mfma_f32_16x16x32_bf16 v[84:87],a[128:131],a[24:27],v[84:87]
v_mfma_f32_16x16x32_bf16 v[92:95],a[128:131],a[48:51],0
v_mfma_f32_16x16x32_bf16 v[92:95],a[132:135],a[52:55],v[92:95]
buffer_load_dwordx4 v8,s[4:7],s20 offen offset:2048 lds
v_mfma_f32_16x16x32_bf16 v[92:95],a[136:139],a[56:59],v[92:95]
s_add_u32 s20,s20,12288
v_mfma_f32_16x16x32_bf16 v[92:95],a[140:143],a[60:63],v[92:95]
v_mfma_f32_16x16x32_bf16 v[92:95],a[144:147],a[64:67],v[92:95]
v_mfma_f32_16x16x32_bf16 v[92:95],a[148:151],a[68:71],v[92:95]
v_mfma_f32_16x16x32_bf16 v[100:103],a[148:151],a[92:95],0
ds_read_b64_tr_b16 a[120:121],v2 offset:0
v_mfma_f32_16x16x32_bf16 v[100:103],a[144:147],a[88:91],v[100:103]
ds_read_b64_tr_b16 a[122:123],v2 offset:6144
v_mfma_f32_16x16x32_bf16 v[100:103],a[140:143],a[84:87],v[100:103]
v_mfma_f32_16x16x32_bf16 v[100:103],a[136:139],a[80:83],v[100:103]
ds_read_b64_tr_b16 a[124:125],v3 offset:0
v_mfma_f32_16x16x32_bf16 v[100:103],a[132:135],a[76:79],v[100:103]
ds_read_b64_tr_b16 a[126:127],v3 offset:6144
v_mfma_f32_16x16x32_bf16 v[100:103],a[128:131],a[72:75],v[100:103]
v_mfma_f32_16x16x32_bf16 v[108:111],a[128:131],a[96:99],0
ds_read_b64_tr_b16 a[128:129],v4 offset:0
v_mfma_f32_16x16x32_bf16 v[108:111],a[132:135],a[100:103],v[108:111]
ds_read_b64_tr_b16 a[130:131],v4 offset:6144
v_mfma_f32_16x16x32_bf16 v[108:111],a[136:139],a[104:107],v[108:111]
ds_read_b64_tr_b16 a[132:133],v5 offset:0
v_mfma_f32_16x16x32_bf16 v[108:111],a[140:143],a[108:111],v[108:111]
ds_read_b64_tr_b16 a[134:135],v5 offset:6144
v_mfma_f32_16x16x32_bf16 v[108:111],a[144:147],a[112:115],v[108:111]
v_mfma_f32_16x16x32_bf16 v[108:111],a[148:151],a[116:119],v[108:111]
s_waitcnt lgkmcnt(4)
v_mfma_f32_16x16x32_bf16 v[160:163],a[120:123],v[20:23],v[160:163]
s_add_u32 m0,s23,0
ds_read_b64_tr_b16 a[136:137],v2 offset:128
v_fma_f32 v91,v91,s36,v15
v_mfma_f32_16x16x32_bf16 v[164:167],a[124:127],v[20:23],v[164:167]
ds_read_b64_tr_b16 a[138:139],v2 offset:6272
v_fma_f32 v90,v90,s36,v15
v_mfma_f32_16x16x32_bf16 v[212:215],a[124:127],v[24:27],v[212:215]
ds_read_b64_tr_b16 a[140:141],v3 offset:128
v_fma_f32 v98,v98,s36,v16
v_mfma_f32_16x16x32_bf16 v[208:211],a[120:123],v[24:27],v[208:211]
ds_read_b64_tr_b16 a[142:143],v3 offset:6272
v_fma_f32 v96,v96,s36,v16
v_mfma_f32_16x16x32_bf16 v[112:115],a[120:123],v[28:31],v[112:115]
ds_read_b64_tr_b16 a[146:147],v4 offset:6272
v_fma_f32 v97,v97,s36,v16
v_mfma_f32_16x16x32_bf16 v[116:119],a[124:127],v[28:31],v[116:119]
ds_read_b64_tr_b16 a[150:151],v5 offset:6272
v_fma_f32 v99,v99,s36,v16
v_mfma_f32_16x16x32_bf16 a[164:167],a[124:127],v[32:35],a[164:167]
ds_read_b64_tr_b16 a[144:145],v4 offset:128
v_fma_f32 v107,v107,s36,v17
v_mfma_f32_16x16x32_bf16 a[160:163],a[120:123],v[32:35],a[160:163]
ds_read_b64_tr_b16 a[148:149],v5 offset:128
v_fma_f32 v104,v104,s36,v17
v_mfma_f32_16x16x32_bf16 a[208:211],a[120:123],v[36:39],a[208:211]
ds_read_b64_tr_b16 a[120:121],v2 offset:256
v_fma_f32 v105,v105,s36,v17
v_mfma_f32_16x16x32_bf16 a[212:215],a[124:127],v[36:39],a[212:215]
s_waitcnt lgkmcnt(6)
ds_read_b64_tr_b16 a[124:125],v3 offset:256
v_fma_f32 v106,v106,s36,v17
v_mfma_f32_16x16x32_bf16 a[216:219],a[128:131],v[36:39],a[216:219]
ds_read_b64_tr_b16 a[122:123],v2 offset:6400
v_fma_f32 v76,v76,s36,v13
v_mfma_f32_16x16x32_bf16 a[220:223],a[132:135],v[36:39],a[220:223]
ds_read_b64_tr_b16 a[126:127],v3 offset:6400
v_fma_f32 v79,v79,s36,v13
v_mfma_f32_16x16x32_bf16 a[172:175],a[132:135],v[32:35],a[172:175]
v_exp_f32 v91,v91
v_mfma_f32_16x16x32_bf16 a[168:171],a[128:131],v[32:35],a[168:171]
v_exp_f32 v90,v90
v_mfma_f32_16x16x32_bf16 v[120:123],a[128:131],v[28:31],v[120:123]
v_cvt_pk_bf16_f32 v53,v90,v91
v_fma_f32 v78,v78,s36,v13
v_mfma_f32_16x16x32_bf16 v[124:127],a[132:135],v[28:31],v[124:127]
v_exp_f32 v96,v96
v_mfma_f32_16x16x32_bf16 v[220:223],a[132:135],v[24:27],v[220:223]
v_exp_f32 v97,v97
v_mfma_f32_16x16x32_bf16 v[216:219],a[128:131],v[24:27],v[216:219]
v_exp_f32 v98,v98
v_mfma_f32_16x16x32_bf16 v[168:171],a[128:131],v[20:23],v[168:171]
ds_read_b64_tr_b16 a[128:129],v4 offset:256
v_cvt_pk_bf16_f32 v56,v96,v97
v_mfma_f32_16x16x32_bf16 v[172:175],a[132:135],v[20:23],v[172:175]
ds_read_b64_tr_b16 a[130:131],v4 offset:6400
v_fma_f32 v77,v77,s36,v13
v_mfma_f32_16x16x32_bf16 v[176:179],a[136:139],v[20:23],v[176:179]
s_waitcnt lgkmcnt(2)
ds_read_b64_tr_b16 a[132:133],v5 offset:256
v_fma_f32 v86,v86,s36,v14
v_mfma_f32_16x16x32_bf16 v[180:183],a[140:143],v[20:23],v[180:183]
ds_read_b64_tr_b16 a[134:135],v5 offset:6400
v_fma_f32 v85,v85,s36,v14
v_mfma_f32_16x16x32_bf16 v[228:231],a[140:143],v[24:27],v[228:231]
v_exp_f32 v99,v99
v_mfma_f32_16x16x32_bf16 v[224:227],a[136:139],v[24:27],v[224:227]
v_cvt_pk_bf16_f32 v57,v98,v99
v_fma_f32 v84,v84,s36,v14
v_mfma_f32_16x16x32_bf16 v[128:131],a[136:139],v[28:31],v[128:131]
v_exp_f32 v104,v104
v_mfma_f32_16x16x32_bf16 v[132:135],a[140:143],v[28:31],v[132:135]
v_exp_f32 v105,v105
v_mfma_f32_16x16x32_bf16 a[180:183],a[140:143],v[32:35],a[180:183]
v_exp_f32 v107,v107
v_mfma_f32_16x16x32_bf16 a[176:179],a[136:139],v[32:35],a[176:179]
v_exp_f32 v106,v106
v_mfma_f32_16x16x32_bf16 a[224:227],a[136:139],v[36:39],a[224:227]
v_cvt_pk_bf16_f32 v41,v106,v107
v_cvt_pk_bf16_f32 v40,v104,v105
v_mfma_f32_16x16x32_bf16 a[228:231],a[140:143],v[36:39],a[228:231]
v_exp_f32 v79,v79
v_mfma_f32_16x16x32_bf16 a[232:235],a[144:147],v[36:39],a[232:235]
v_exp_f32 v76,v76
v_mfma_f32_16x16x32_bf16 a[236:239],a[148:151],v[36:39],a[236:239]
v_exp_f32 v78,v78
v_mfma_f32_16x16x32_bf16 a[188:191],a[148:151],v[32:35],a[188:191]
v_exp_f32 v77,v77
v_mfma_f32_16x16x32_bf16 a[184:187],a[144:147],v[32:35],a[184:187]
v_cvt_pk_bf16_f32 v47,v78,v79
v_cvt_pk_bf16_f32 v46,v76,v77
v_mfma_f32_16x16x32_bf16 v[136:139],a[144:147],v[28:31],v[136:139]
v_exp_f32 v84,v84
v_mfma_f32_16x16x32_bf16 v[140:143],a[148:151],v[28:31],v[140:143]
v_exp_f32 v85,v85
v_mfma_f32_16x16x32_bf16 v[236:239],a[148:151],v[24:27],v[236:239]
v_exp_f32 v86,v86
v_mfma_f32_16x16x32_bf16 v[232:235],a[144:147],v[24:27],v[232:235]
v_fma_f32 v87,v87,s36,v14
v_cvt_pk_bf16_f32 v50,v84,v85
v_mfma_f32_16x16x32_bf16 v[184:187],a[144:147],v[20:23],v[184:187]
v_exp_f32 v87,v87
v_mfma_f32_16x16x32_bf16 v[188:191],a[148:151],v[20:23],v[188:191]
v_cvt_pk_bf16_f32 v51,v86,v87
v_fma_f32 v93,v93,s36,v15
v_mfma_f32_16x16x32_bf16 v[192:195],a[120:123],v[20:23],v[192:195]
v_exp_f32 v93,v93
v_smfmac_f32_16x16x64_bf16 v[60:63],a[152:155],v[44:51],v18
v_fma_f32 v94,v94,s36,v15
v_mfma_f32_16x16x32_bf16 v[196:199],a[124:127],v[20:23],v[196:199]
s_waitcnt vmcnt(9) lgkmcnt(0)
v_exp_f32 v94,v94
v_mfma_f32_16x16x32_bf16 v[244:247],a[124:127],v[24:27],v[244:247]
s_barrier
v_mfma_f32_16x16x32_bf16 v[240:243],a[120:123],v[24:27],v[240:243]
ds_read_b128 a[136:139],v0 offset:24576
v_fma_f32 v92,v92,s36,v15
v_mfma_f32_16x16x32_bf16 v[144:147],a[120:123],v[28:31],v[144:147]
ds_read_b128 a[140:143],v1 offset:24576
v_fma_f32 v95,v95,s36,v15
v_mfma_f32_16x16x32_bf16 v[148:151],a[124:127],v[28:31],v[148:151]
ds_read_b128 a[144:147],v0 offset:24704
v_fma_f32 v102,v102,s36,v16
v_mfma_f32_16x16x32_bf16 a[196:199],a[124:127],v[32:35],a[196:199]
ds_read_b128 a[148:151],v1 offset:24704
v_fma_f32 v103,v103,s36,v16
v_mfma_f32_16x16x32_bf16 a[192:195],a[120:123],v[32:35],a[192:195]
ds_read_b128 a[156:159],v10 offset:6144
v_fma_f32 v101,v101,s36,v16
v_mfma_f32_16x16x32_bf16 a[240:243],a[120:123],v[36:39],a[240:243]
buffer_load_dwordx4 v6,s[8:11],s21 offen offset:0 lds
v_mfma_f32_16x16x32_bf16 a[244:247],a[124:127],v[36:39],a[244:247]
ds_read_b128 a[120:123],v0 offset:24832
v_fma_f32 v100,v100,s36,v16
v_mfma_f32_16x16x32_bf16 a[248:251],a[128:131],v[36:39],a[248:251]
ds_read_b128 a[124:127],v1 offset:24832
v_fma_f32 v110,v110,s36,v17
v_mfma_f32_16x16x32_bf16 a[252:255],a[132:135],v[36:39],a[252:255]
v_exp_f32 v95,v95
v_mfma_f32_16x16x32_bf16 a[204:207],a[132:135],v[32:35],a[204:207]
v_exp_f32 v92,v92
v_mfma_f32_16x16x32_bf16 a[200:203],a[128:131],v[32:35],a[200:203]
v_cvt_pk_bf16_f32 v55,v94,v95
v_cvt_pk_bf16_f32 v54,v92,v93
v_mfma_f32_16x16x32_bf16 v[152:155],a[128:131],v[28:31],v[152:155]
v_exp_f32 v100,v100
v_mfma_f32_16x16x32_bf16 v[156:159],a[132:135],v[28:31],v[156:159]
v_exp_f32 v102,v102
v_mfma_f32_16x16x32_bf16 v[252:255],a[132:135],v[24:27],v[252:255]
v_exp_f32 v103,v103
v_mfma_f32_16x16x32_bf16 v[248:251],a[128:131],v[24:27],v[248:251]
v_exp_f32 v101,v101
v_mfma_f32_16x16x32_bf16 v[200:203],a[128:131],v[20:23],v[200:203]
ds_read_b128 a[128:131],v0 offset:30720
v_cvt_pk_bf16_f32 v59,v102,v103
v_mfma_f32_16x16x32_bf16 v[204:207],a[132:135],v[20:23],v[204:207]
s_waitcnt lgkmcnt(1)
buffer_store_dwordx4 a[156:159],v9,s[16:19],s27 offen offset:0 nt
buffer_load_dwordx4 v7,s[8:11],s21 offen offset:1024 lds
v_mfma_f32_16x16x32_bf16 v[72:75],a[136:139],a[0:3],0
ds_read_b128 a[132:135],v1 offset:30720
v_cvt_pk_bf16_f32 v58,v100,v101
v_mfma_f32_16x16x32_bf16 v[72:75],a[140:143],a[4:7],v[72:75]
v_exp_f32 v110,v110
v_smfmac_f32_16x16x64_bf16 v[64:67],a[152:155],v[52:59],v18
v_fma_f32 v111,v111,s36,v17
v_mfma_f32_16x16x32_bf16 v[72:75],a[144:147],a[8:11],v[72:75]
v_exp_f32 v111,v111
v_mfma_f32_16x16x32_bf16 v[72:75],a[148:151],a[12:15],v[72:75]
v_fma_f32 v108,v108,s36,v17
v_cvt_pk_bf16_f32 v43,v110,v111
v_mfma_f32_16x16x32_bf16 v[72:75],a[120:123],a[16:19],v[72:75]
ds_read_b128 a[156:159],v10 offset:7168
v_fma_f32 v109,v109,s36,v17
v_mfma_f32_16x16x32_bf16 v[72:75],a[124:127],a[20:23],v[72:75]
v_exp_f32 v108,v108
v_mfma_f32_16x16x32_bf16 v[80:83],a[124:127],a[44:47],0
v_exp_f32 v109,v109
v_mfma_f32_16x16x32_bf16 v[80:83],a[120:123],a[40:43],v[80:83]
v_cvt_pk_bf16_f32 v42,v108,v109
v_mfma_f32_16x16x32_bf16 v[80:83],a[148:151],a[36:39],v[80:83]
v_mfma_f32_16x16x32_bf16 v[80:83],a[144:147],a[32:35],v[80:83]
buffer_load_dwordx4 v8,s[8:11],s21 offen offset:2048 lds
v_smfmac_f32_16x16x64_bf16 v[68:71],a[152:155],v[36:43],v18
s_add_u32 s21,s21,12288
v_fma_f32 v75,v75,s36,v13
v_mfma_f32_16x16x32_bf16 v[80:83],a[140:143],a[28:31],v[80:83]
s_cmp_eq_u32 s38,1
v_exp_f32 v75,v75
v_mfma_f32_16x16x32_bf16 v[80:83],a[136:139],a[24:27],v[80:83]
s_cselect_b32 s20,s26,s20
v_fma_f32 v73,v73,s36,v13
v_fma_f32 v74,v74,s36,v13
v_mfma_f32_16x16x32_bf16 v[88:91],a[136:139],a[48:51],0
s_add_u32 m0,s22,12288
v_exp_f32 v73,v73
v_mfma_f32_16x16x32_bf16 v[88:91],a[140:143],a[52:55],v[88:91]
v_exp_f32 v74,v74
v_mfma_f32_16x16x32_bf16 v[88:91],a[144:147],a[56:59],v[88:91]
v_fma_f32 v82,v82,s36,v14
v_fma_f32 v81,v81,s36,v14
v_mfma_f32_16x16x32_bf16 v[88:91],a[148:151],a[60:63],v[88:91]
v_exp_f32 v81,v81
v_mfma_f32_16x16x32_bf16 v[88:91],a[120:123],a[64:67],v[88:91]
v_exp_f32 v82,v82
v_mfma_f32_16x16x32_bf16 v[88:91],a[124:127],a[68:71],v[88:91]
v_fma_f32 v72,v72,s36,v13
v_fma_f32 v80,v80,s36,v14
v_mfma_f32_16x16x32_bf16 v[96:99],a[124:127],a[92:95],0
v_exp_f32 v72,v72
v_mfma_f32_16x16x32_bf16 v[96:99],a[120:123],a[88:91],v[96:99]
s_waitcnt lgkmcnt(0)
buffer_store_dwordx4 a[156:159],v9,s[16:19],s27 offen offset:128 nt
buffer_load_dwordx4 v6,s[4:7],s20 offen offset:0 lds
v_mfma_f32_16x16x32_bf16 v[96:99],a[148:151],a[84:87],v[96:99]
v_exp_f32 v80,v80
v_mfma_f32_16x16x32_bf16 v[96:99],a[144:147],a[80:83],v[96:99]
v_fma_f32 v89,v89,s36,v15
v_fma_f32 v88,v88,s36,v15
v_mfma_f32_16x16x32_bf16 v[96:99],a[140:143],a[76:79],v[96:99]
v_exp_f32 v89,v89
v_mfma_f32_16x16x32_bf16 v[96:99],a[136:139],a[72:75],v[96:99]
v_exp_f32 v88,v88
v_mfma_f32_16x16x32_bf16 v[104:107],a[136:139],a[96:99],0
ds_read_b128 a[136:139],v0 offset:30848
v_fma_f32 v83,v83,s36,v14
v_mfma_f32_16x16x32_bf16 v[104:107],a[140:143],a[100:103],v[104:107]
ds_read_b128 a[156:159],v10 offset:8192
v_mfma_f32_16x16x32_bf16 v[104:107],a[144:147],a[104:107],v[104:107]
ds_read_b128 a[140:143],v1 offset:30848
v_mfma_f32_16x16x32_bf16 v[104:107],a[148:151],a[108:111],v[104:107]
ds_read_b128 a[144:147],v0 offset:30976
v_mfma_f32_16x16x32_bf16 v[104:107],a[120:123],a[112:115],v[104:107]
ds_read_b128 a[148:151],v1 offset:30976
v_mfma_f32_16x16x32_bf16 v[104:107],a[124:127],a[116:119],v[104:107]
v_exp_f32 v83,v83
v_mfma_f32_16x16x32_bf16 v[76:79],a[128:131],a[0:3],0
buffer_load_dwordx4 v7,s[4:7],s20 offen offset:1024 lds
v_mfma_f32_16x16x32_bf16 v[76:79],a[132:135],a[4:7],v[76:79]
s_waitcnt lgkmcnt(4)
v_cvt_pk_bf16_f32 v25,v82,v83
v_cvt_pk_bf16_f32 v20,v72,v73
v_mfma_f32_16x16x32_bf16 v[76:79],a[136:139],a[8:11],v[76:79]
s_waitcnt lgkmcnt(2)
v_cvt_pk_bf16_f32 v21,v74,v75
v_cvt_pk_bf16_f32 v24,v80,v81
v_cvt_pk_bf16_f32 v28,v88,v89
v_mfma_f32_16x16x32_bf16 v[76:79],a[140:143],a[12:15],v[76:79]
s_waitcnt lgkmcnt(1)
v_mfma_f32_16x16x32_bf16 v[76:79],a[144:147],a[16:19],v[76:79]
s_waitcnt lgkmcnt(0)
v_mfma_f32_16x16x32_bf16 v[76:79],a[148:151],a[20:23],v[76:79]
v_mfma_f32_16x16x32_bf16 v[84:87],a[148:151],a[44:47],0
v_mfma_f32_16x16x32_bf16 v[84:87],a[144:147],a[40:43],v[84:87]
v_mfma_f32_16x16x32_bf16 v[84:87],a[140:143],a[36:39],v[84:87]
v_mfma_f32_16x16x32_bf16 v[84:87],a[136:139],a[32:35],v[84:87]
v_mfma_f32_16x16x32_bf16 v[84:87],a[132:135],a[28:31],v[84:87]
buffer_store_dwordx4 a[156:159],v9,s[16:19],s27 offen offset:256 nt
buffer_load_dwordx4 v8,s[4:7],s20 offen offset:2048 lds
v_mfma_f32_16x16x32_bf16 v[84:87],a[128:131],a[24:27],v[84:87]
s_add_u32 s20,s20,12288
v_mfma_f32_16x16x32_bf16 v[92:95],a[128:131],a[48:51],0
s_add_u32 s27,s27,3072
v_mfma_f32_16x16x32_bf16 v[92:95],a[132:135],a[52:55],v[92:95]
v_mfma_f32_16x16x32_bf16 v[92:95],a[136:139],a[56:59],v[92:95]
v_mfma_f32_16x16x32_bf16 v[92:95],a[140:143],a[60:63],v[92:95]
ds_read_b64_tr_b16 a[120:121],v2 offset:12288
v_mfma_f32_16x16x32_bf16 v[92:95],a[144:147],a[64:67],v[92:95]
ds_read_b64_tr_b16 a[122:123],v2 offset:18432
v_mfma_f32_16x16x32_bf16 v[92:95],a[148:151],a[68:71],v[92:95]
v_mfma_f32_16x16x32_bf16 v[100:103],a[148:151],a[92:95],0
ds_read_b64_tr_b16 a[126:127],v3 offset:18432
v_mfma_f32_16x16x32_bf16 v[100:103],a[144:147],a[88:91],v[100:103]
ds_read_b64_tr_b16 a[124:125],v3 offset:12288
v_mfma_f32_16x16x32_bf16 v[100:103],a[140:143],a[84:87],v[100:103]
v_mfma_f32_16x16x32_bf16 v[100:103],a[136:139],a[80:83],v[100:103]
v_mfma_f32_16x16x32_bf16 v[100:103],a[132:135],a[76:79],v[100:103]
v_mfma_f32_16x16x32_bf16 v[100:103],a[128:131],a[72:75],v[100:103]
v_mfma_f32_16x16x32_bf16 v[108:111],a[128:131],a[96:99],0
ds_read_b64_tr_b16 a[130:131],v4 offset:18432
v_mfma_f32_16x16x32_bf16 v[108:111],a[132:135],a[100:103],v[108:111]
ds_read_b64_tr_b16 a[128:129],v4 offset:12288
v_mfma_f32_16x16x32_bf16 v[108:111],a[136:139],a[104:107],v[108:111]
ds_read_b64_tr_b16 a[132:133],v5 offset:12288
v_mfma_f32_16x16x32_bf16 v[108:111],a[140:143],a[108:111],v[108:111]
ds_read_b64_tr_b16 a[134:135],v5 offset:18432
v_mfma_f32_16x16x32_bf16 v[108:111],a[144:147],a[112:115],v[108:111]
v_mfma_f32_16x16x32_bf16 v[108:111],a[148:151],a[116:119],v[108:111]
s_waitcnt lgkmcnt(4)
v_mfma_f32_16x16x32_bf16 v[160:163],a[120:123],v[44:47],v[160:163]
s_add_u32 m0,s29,0
ds_read_b64_tr_b16 a[136:137],v2 offset:12416
v_fma_f32 v90,v90,s36,v15
v_mfma_f32_16x16x32_bf16 v[164:167],a[124:127],v[44:47],v[164:167]
ds_read_b64_tr_b16 a[138:139],v2 offset:18560
v_fma_f32 v91,v91,s36,v15
v_mfma_f32_16x16x32_bf16 v[212:215],a[124:127],v[48:51],v[212:215]
ds_read_b64_tr_b16 a[140:141],v3 offset:12416
v_fma_f32 v96,v96,s36,v16
v_mfma_f32_16x16x32_bf16 v[208:211],a[120:123],v[48:51],v[208:211]
ds_read_b64_tr_b16 a[142:143],v3 offset:18560
v_fma_f32 v97,v97,s36,v16
v_mfma_f32_16x16x32_bf16 v[112:115],a[120:123],v[52:55],v[112:115]
ds_read_b64_tr_b16 a[144:145],v4 offset:12416
v_fma_f32 v98,v98,s36,v16
v_mfma_f32_16x16x32_bf16 v[116:119],a[124:127],v[52:55],v[116:119]
ds_read_b64_tr_b16 a[146:147],v4 offset:18560
v_fma_f32 v99,v99,s36,v16
v_mfma_f32_16x16x32_bf16 a[164:167],a[124:127],v[56:59],a[164:167]
ds_read_b64_tr_b16 a[148:149],v5 offset:12416
v_fma_f32 v104,v104,s36,v17
v_mfma_f32_16x16x32_bf16 a[160:163],a[120:123],v[56:59],a[160:163]
buffer_load_dwordx4 v6,s[12:15],s28 offen offset:0 nt lds
v_mfma_f32_16x16x32_bf16 a[208:211],a[120:123],v[40:43],a[208:211]
ds_read_b64_tr_b16 a[150:151],v5 offset:18560
v_fma_f32 v105,v105,s36,v17
v_mfma_f32_16x16x32_bf16 a[212:215],a[124:127],v[40:43],a[212:215]
s_waitcnt lgkmcnt(5)
ds_read_b64_tr_b16 a[120:121],v2 offset:12544
v_fma_f32 v106,v106,s36,v17
v_mfma_f32_16x16x32_bf16 a[216:219],a[128:131],v[40:43],a[216:219]
ds_read_b64_tr_b16 a[122:123],v2 offset:18688
v_fma_f32 v107,v107,s36,v17
v_mfma_f32_16x16x32_bf16 a[220:223],a[132:135],v[40:43],a[220:223]
ds_read_b64_tr_b16 a[124:125],v3 offset:12544
v_fma_f32 v76,v76,s36,v13
v_mfma_f32_16x16x32_bf16 a[172:175],a[132:135],v[56:59],a[172:175]
ds_read_b64_tr_b16 a[126:127],v3 offset:18688
v_fma_f32 v77,v77,s36,v13
v_mfma_f32_16x16x32_bf16 a[168:171],a[128:131],v[56:59],a[168:171]
v_exp_f32 v90,v90
v_mfma_f32_16x16x32_bf16 v[120:123],a[128:131],v[52:55],v[120:123]
v_exp_f32 v91,v91
v_mfma_f32_16x16x32_bf16 v[124:127],a[132:135],v[52:55],v[124:127]
v_cvt_pk_bf16_f32 v29,v90,v91
v_fma_f32 v78,v78,s36,v13
v_mfma_f32_16x16x32_bf16 v[220:223],a[132:135],v[48:51],v[220:223]
v_exp_f32 v96,v96
v_mfma_f32_16x16x32_bf16 v[216:219],a[128:131],v[48:51],v[216:219]
buffer_load_dwordx4 v7,s[12:15],s28 offen offset:1024 nt lds
v_mfma_f32_16x16x32_bf16 v[168:171],a[128:131],v[44:47],v[168:171]
ds_read_b64_tr_b16 a[128:129],v4 offset:12544
v_fma_f32 v79,v79,s36,v13
v_mfma_f32_16x16x32_bf16 v[172:175],a[132:135],v[44:47],v[172:175]
ds_read_b64_tr_b16 a[130:131],v4 offset:18688
v_fma_f32 v84,v84,s36,v14
v_mfma_f32_16x16x32_bf16 v[176:179],a[136:139],v[44:47],v[176:179]
s_waitcnt lgkmcnt(2)
ds_read_b64_tr_b16 a[132:133],v5 offset:12544
v_fma_f32 v85,v85,s36,v14
v_mfma_f32_16x16x32_bf16 v[180:183],a[140:143],v[44:47],v[180:183]
ds_read_b64_tr_b16 a[134:135],v5 offset:18688
v_fma_f32 v86,v86,s36,v14
v_mfma_f32_16x16x32_bf16 v[228:231],a[140:143],v[48:51],v[228:231]
v_exp_f32 v97,v97
v_mfma_f32_16x16x32_bf16 v[224:227],a[136:139],v[48:51],v[224:227]
v_exp_f32 v98,v98
v_mfma_f32_16x16x32_bf16 v[128:131],a[136:139],v[52:55],v[128:131]
v_exp_f32 v99,v99
v_mfma_f32_16x16x32_bf16 v[132:135],a[140:143],v[52:55],v[132:135]
v_cvt_pk_bf16_f32 v32,v96,v97
v_cvt_pk_bf16_f32 v33,v98,v99
v_mfma_f32_16x16x32_bf16 a[180:183],a[140:143],v[56:59],a[180:183]
v_exp_f32 v104,v104
v_mfma_f32_16x16x32_bf16 a[176:179],a[136:139],v[56:59],a[176:179]
buffer_load_dwordx4 v8,s[12:15],s28 offen offset:2048 nt lds
v_mfma_f32_16x16x32_bf16 a[224:227],a[136:139],v[40:43],a[224:227]
s_add_u32 s28,s28,3072
v_exp_f32 v105,v105
v_mfma_f32_16x16x32_bf16 a[228:231],a[140:143],v[40:43],a[228:231]
s_add_u32 s29,s29,3072
v_exp_f32 v106,v106
v_mfma_f32_16x16x32_bf16 a[232:235],a[144:147],v[40:43],a[232:235]
s_cmp_eq_u32 s38,1
v_exp_f32 v107,v107
v_mfma_f32_16x16x32_bf16 a[236:239],a[148:151],v[40:43],a[236:239]
s_cselect_b32 s21,s26,s21
v_cvt_pk_bf16_f32 v36,v104,v105
v_cvt_pk_bf16_f32 v37,v106,v107
v_mfma_f32_16x16x32_bf16 a[188:191],a[148:151],v[56:59],a[188:191]
s_add_u32 m0,s23,12288
v_exp_f32 v76,v76
v_mfma_f32_16x16x32_bf16 a[184:187],a[144:147],v[56:59],a[184:187]
v_exp_f32 v77,v77
v_mfma_f32_16x16x32_bf16 v[136:139],a[144:147],v[52:55],v[136:139]
v_exp_f32 v78,v78
v_mfma_f32_16x16x32_bf16 v[140:143],a[148:151],v[52:55],v[140:143]
v_exp_f32 v79,v79
v_mfma_f32_16x16x32_bf16 v[236:239],a[148:151],v[48:51],v[236:239]
v_cvt_pk_bf16_f32 v22,v76,v77
v_cvt_pk_bf16_f32 v23,v78,v79
v_mfma_f32_16x16x32_bf16 v[232:235],a[144:147],v[48:51],v[232:235]
v_fma_f32 v87,v87,s36,v14
v_fma_f32 v92,v92,s36,v15
v_mfma_f32_16x16x32_bf16 v[184:187],a[144:147],v[44:47],v[184:187]
v_exp_f32 v84,v84
v_mfma_f32_16x16x32_bf16 v[188:191],a[148:151],v[44:47],v[188:191]
v_exp_f32 v85,v85
v_mfma_f32_16x16x32_bf16 v[192:195],a[120:123],v[44:47],v[192:195]
v_exp_f32 v86,v86
v_mfma_f32_16x16x32_bf16 v[196:199],a[124:127],v[44:47],v[196:199]
s_waitcnt vmcnt(12) lgkmcnt(0)
v_exp_f32 v87,v87
v_mfma_f32_16x16x32_bf16 v[244:247],a[124:127],v[48:51],v[244:247]
s_barrier
v_mfma_f32_16x16x32_bf16 v[240:243],a[120:123],v[48:51],v[240:243]
ds_read_b128 a[136:139],v0 offset:0
v_cvt_pk_bf16_f32 v26,v84,v85
v_mfma_f32_16x16x32_bf16 v[144:147],a[120:123],v[52:55],v[144:147]
ds_read_b128 a[140:143],v1 offset:0
v_cvt_pk_bf16_f32 v27,v86,v87
v_mfma_f32_16x16x32_bf16 v[148:151],a[124:127],v[52:55],v[148:151]
ds_read_b128 a[144:147],v0 offset:128
v_fma_f32 v93,v93,s36,v15
v_smfmac_f32_16x16x64_bf16 v[60:63],a[152:155],v[20:27],v18
ds_read_b128 a[148:151],v1 offset:128
v_mfma_f32_16x16x32_bf16 a[196:199],a[124:127],v[56:59],a[196:199]
v_fma_f32 v94,v94,s36,v15
v_fma_f32 v95,v95,s36,v15
v_mfma_f32_16x16x32_bf16 a[192:195],a[120:123],v[56:59],a[192:195]
buffer_load_dwordx4 v6,s[8:11],s21 offen offset:0 lds
v_mfma_f32_16x16x32_bf16 a[240:243],a[120:123],v[40:43],a[240:243]
ds_read_b128 a[120:123],v0 offset:256
v_fma_f32 v100,v100,s36,v16
v_mfma_f32_16x16x32_bf16 a[244:247],a[124:127],v[40:43],a[244:247]
ds_read_b128 a[124:127],v1 offset:256
v_fma_f32 v101,v101,s36,v16
v_mfma_f32_16x16x32_bf16 a[248:251],a[128:131],v[40:43],a[248:251]
v_exp_f32 v92,v92
v_mfma_f32_16x16x32_bf16 a[252:255],a[132:135],v[40:43],a[252:255]
v_exp_f32 v93,v93
v_mfma_f32_16x16x32_bf16 a[204:207],a[132:135],v[56:59],a[204:207]
v_exp_f32 v94,v94
v_mfma_f32_16x16x32_bf16 a[200:203],a[128:131],v[56:59],a[200:203]
v_exp_f32 v95,v95
v_mfma_f32_16x16x32_bf16 v[152:155],a[128:131],v[52:55],v[152:155]
v_cvt_pk_bf16_f32 v30,v92,v93
v_cvt_pk_bf16_f32 v31,v94,v95
v_mfma_f32_16x16x32_bf16 v[156:159],a[132:135],v[52:55],v[156:159]
v_fma_f32 v102,v102,s36,v16
v_fma_f32 v103,v103,s36,v16
v_mfma_f32_16x16x32_bf16 v[252:255],a[132:135],v[48:51],v[252:255]
v_exp_f32 v100,v100
v_mfma_f32_16x16x32_bf16 v[248:251],a[128:131],v[48:51],v[248:251]
v_exp_f32 v101,v101
v_mfma_f32_16x16x32_bf16 v[200:203],a[128:131],v[44:47],v[200:203]
buffer_load_dwordx4 v7,s[8:11],s21 offen offset:1024 lds
v_mfma_f32_16x16x32_bf16 v[204:207],a[132:135],v[44:47],v[204:207]
s_waitcnt lgkmcnt(0)
ds_read_b128 a[128:131],v0 offset:6144
v_cvt_pk_bf16_f32 v34,v100,v101
v_mfma_f32_16x16x32_bf16 v[72:75],a[136:139],a[0:3],0
ds_read_b128 a[132:135],v1 offset:6144
v_fma_f32 v108,v108,s36,v17
v_mfma_f32_16x16x32_bf16 v[72:75],a[140:143],a[4:7],v[72:75]
v_exp_f32 v102,v102
v_mfma_f32_16x16x32_bf16 v[72:75],a[144:147],a[8:11],v[72:75]
v_exp_f32 v103,v103
v_mfma_f32_16x16x32_bf16 v[72:75],a[148:151],a[12:15],v[72:75]
v_cvt_pk_bf16_f32 v35,v102,v103
v_fma_f32 v109,v109,s36,v17
v_mfma_f32_16x16x32_bf16 v[72:75],a[120:123],a[16:19],v[72:75]
v_fma_f32 v110,v110,s36,v17
v_fma_f32 v111,v111,s36,v17
v_smfmac_f32_16x16x64_bf16 v[64:67],a[152:155],v[28:35],v18
v_add_u32 v10,9216,v10
v_mfma_f32_16x16x32_bf16 v[72:75],a[124:127],a[20:23],v[72:75]
v_exp_f32 v108,v108
v_mfma_f32_16x16x32_bf16 v[80:83],a[124:127],a[44:47],0
v_exp_f32 v109,v109
v_mfma_f32_16x16x32_bf16 v[80:83],a[120:123],a[40:43],v[80:83]
v_exp_f32 v110,v110
v_mfma_f32_16x16x32_bf16 v[80:83],a[148:151],a[36:39],v[80:83]
v_exp_f32 v111,v111
v_mfma_f32_16x16x32_bf16 v[80:83],a[144:147],a[32:35],v[80:83]
buffer_load_dwordx4 v8,s[8:11],s21 offen offset:2048 lds
v_mfma_f32_16x16x32_bf16 v[80:83],a[140:143],a[28:31],v[80:83]
s_add_u32 s21,s21,12288
v_cvt_pk_bf16_f32 v38,v108,v109
v_cvt_pk_bf16_f32 v39,v110,v111
v_mfma_f32_16x16x32_bf16 v[80:83],a[136:139],a[24:27],v[80:83]
s_add_u32 m0,s22,24576
v_fma_f32 v72,v72,s36,v13
v_fma_f32 v73,v73,s36,v13
v_mfma_f32_16x16x32_bf16 v[88:91],a[136:139],a[48:51],0
v_fma_f32 v74,v74,s36,v13
v_fma_f32 v75,v75,s36,v13
v_mfma_f32_16x16x32_bf16 v[88:91],a[140:143],a[52:55],v[88:91]
v_exp_f32 v72,v72
v_mfma_f32_16x16x32_bf16 v[88:91],a[144:147],a[56:59],v[88:91]
v_fma_f32 v80,v80,s36,v14
v_fma_f32 v81,v81,s36,v14
v_mfma_f32_16x16x32_bf16 v[88:91],a[148:151],a[60:63],v[88:91]
v_fma_f32 v82,v82,s36,v14
v_fma_f32 v83,v83,s36,v14
v_mfma_f32_16x16x32_bf16 v[88:91],a[120:123],a[64:67],v[88:91]
v_exp_f32 v73,v73
v_mfma_f32_16x16x32_bf16 v[88:91],a[124:127],a[68:71],v[88:91]
v_exp_f32 v74,v74
v_mfma_f32_16x16x32_bf16 v[96:99],a[124:127],a[92:95],0
v_exp_f32 v75,v75
v_mfma_f32_16x16x32_bf16 v[96:99],a[120:123],a[88:91],v[96:99]
v_exp_f32 v80,v80
v_mfma_f32_16x16x32_bf16 v[96:99],a[148:151],a[84:87],v[96:99]
buffer_load_dwordx4 v6,s[4:7],s20 offen offset:0 lds
v_mfma_f32_16x16x32_bf16 v[96:99],a[144:147],a[80:83],v[96:99]
v_fma_f32 v88,v88,s36,v15
v_fma_f32 v89,v89,s36,v15
v_mfma_f32_16x16x32_bf16 v[96:99],a[140:143],a[76:79],v[96:99]
v_exp_f32 v81,v81
v_mfma_f32_16x16x32_bf16 v[96:99],a[136:139],a[72:75],v[96:99]
v_exp_f32 v82,v82
v_mfma_f32_16x16x32_bf16 v[104:107],a[136:139],a[96:99],0
ds_read_b128 a[136:139],v0 offset:6272
v_cvt_pk_bf16_f32 v44,v72,v73
v_mfma_f32_16x16x32_bf16 v[104:107],a[140:143],a[100:103],v[104:107]
ds_read_b128 a[140:143],v1 offset:6272
v_cvt_pk_bf16_f32 v45,v74,v75
v_mfma_f32_16x16x32_bf16 v[104:107],a[144:147],a[104:107],v[104:107]
ds_read_b128 a[144:147],v0 offset:6400
v_cvt_pk_bf16_f32 v48,v80,v81
v_mfma_f32_16x16x32_bf16 v[104:107],a[148:151],a[108:111],v[104:107]
ds_read_b128 a[148:151],v1 offset:6400
v_mfma_f32_16x16x32_bf16 v[104:107],a[120:123],a[112:115],v[104:107]
v_exp_f32 v83,v83
v_mfma_f32_16x16x32_bf16 v[104:107],a[124:127],a[116:119],v[104:107]
s_waitcnt lgkmcnt(4)
v_exp_f32 v88,v88
v_mfma_f32_16x16x32_bf16 v[76:79],a[128:131],a[0:3],0
v_exp_f32 v89,v89
v_mfma_f32_16x16x32_bf16 v[76:79],a[132:135],a[4:7],v[76:79]
buffer_load_dwordx4 v7,s[4:7],s20 offen offset:1024 lds
s_waitcnt lgkmcnt(3)
v_mfma_f32_16x16x32_bf16 v[76:79],a[136:139],a[8:11],v[76:79]
s_waitcnt lgkmcnt(2)
v_cvt_pk_bf16_f32 v49,v82,v83
v_cvt_pk_bf16_f32 v52,v88,v89
v_mfma_f32_16x16x32_bf16 v[76:79],a[140:143],a[12:15],v[76:79]
s_waitcnt lgkmcnt(0)
v_mfma_f32_16x16x32_bf16 v[76:79],a[144:147],a[16:19],v[76:79]
v_mfma_f32_16x16x32_bf16 v[76:79],a[148:151],a[20:23],v[76:79]
v_mfma_f32_16x16x32_bf16 v[84:87],a[148:151],a[44:47],0
v_mfma_f32_16x16x32_bf16 v[84:87],a[144:147],a[40:43],v[84:87]
v_mfma_f32_16x16x32_bf16 v[84:87],a[140:143],a[36:39],v[84:87]
v_mfma_f32_16x16x32_bf16 v[84:87],a[136:139],a[32:35],v[84:87]
v_mfma_f32_16x16x32_bf16 v[84:87],a[132:135],a[28:31],v[84:87]
v_mfma_f32_16x16x32_bf16 v[84:87],a[128:131],a[24:27],v[84:87]
v_mfma_f32_16x16x32_bf16 v[92:95],a[128:131],a[48:51],0
v_mfma_f32_16x16x32_bf16 v[92:95],a[132:135],a[52:55],v[92:95]
buffer_load_dwordx4 v8,s[4:7],s20 offen offset:2048 lds
v_mfma_f32_16x16x32_bf16 v[92:95],a[136:139],a[56:59],v[92:95]
s_add_u32 s20,s20,12288
s_add_u32 s38,s38,1
s_cmp_lt_u32 s38,2
v_mfma_f32_16x16x32_bf16 v[92:95],a[140:143],a[60:63],v[92:95]
v_mfma_f32_16x16x32_bf16 v[92:95],a[144:147],a[64:67],v[92:95]
v_mfma_f32_16x16x32_bf16 v[92:95],a[148:151],a[68:71],v[92:95]
v_mfma_f32_16x16x32_bf16 v[100:103],a[148:151],a[92:95],0
ds_read_b64_tr_b16 a[120:121],v2 offset:24576
v_mfma_f32_16x16x32_bf16 v[100:103],a[144:147],a[88:91],v[100:103]
ds_read_b64_tr_b16 a[122:123],v2 offset:30720
v_mfma_f32_16x16x32_bf16 v[100:103],a[140:143],a[84:87],v[100:103]
v_mfma_f32_16x16x32_bf16 v[100:103],a[136:139],a[80:83],v[100:103]
ds_read_b64_tr_b16 a[124:125],v3 offset:24576
v_mfma_f32_16x16x32_bf16 v[100:103],a[132:135],a[76:79],v[100:103]
ds_read_b64_tr_b16 a[126:127],v3 offset:30720
v_mfma_f32_16x16x32_bf16 v[100:103],a[128:131],a[72:75],v[100:103]
v_mfma_f32_16x16x32_bf16 v[108:111],a[128:131],a[96:99],0
ds_read_b64_tr_b16 a[128:129],v4 offset:24576
v_mfma_f32_16x16x32_bf16 v[108:111],a[132:135],a[100:103],v[108:111]
ds_read_b64_tr_b16 a[130:131],v4 offset:30720
v_mfma_f32_16x16x32_bf16 v[108:111],a[136:139],a[104:107],v[108:111]
ds_read_b64_tr_b16 a[132:133],v5 offset:24576
v_mfma_f32_16x16x32_bf16 v[108:111],a[140:143],a[108:111],v[108:111]
ds_read_b64_tr_b16 a[134:135],v5 offset:30720
v_mfma_f32_16x16x32_bf16 v[108:111],a[144:147],a[112:115],v[108:111]
v_mfma_f32_16x16x32_bf16 v[108:111],a[148:151],a[116:119],v[108:111]
s_cbranch_scc1 L_loop5w0
s_cmp_ge_u32 s69,6
s_cbranch_scc1 L_end5
s_cmp_eq_u32 s40,0
s_cbranch_scc1 L_tr54
s_branch L_tr55
L_tr54:
s_waitcnt vmcnt(42)
s_waitcnt lgkmcnt(3)
v_mfma_f32_16x16x32_bf16 v[160:163],a[120:123],v[20:23],v[160:163]
s_add_u32 m0,s24,0
ds_read_b128 a[0:3],v11 offset:0
v_fma_f32 v90,v90,s36,v15
v_mfma_f32_16x16x32_bf16 v[164:167],a[124:127],v[20:23],v[164:167]
ds_read_b128 a[4:7],v12 offset:0
v_fma_f32 v91,v91,s36,v15
v_mfma_f32_16x16x32_bf16 v[212:215],a[124:127],v[24:27],v[212:215]
ds_read_b128 a[8:11],v11 offset:128
v_fma_f32 v96,v96,s36,v16
v_mfma_f32_16x16x32_bf16 v[208:211],a[120:123],v[24:27],v[208:211]
ds_read_b128 a[12:15],v12 offset:128
v_fma_f32 v97,v97,s36,v16
v_mfma_f32_16x16x32_bf16 v[112:115],a[120:123],v[28:31],v[112:115]
ds_read_b128 a[16:19],v11 offset:256
v_fma_f32 v98,v98,s36,v16
v_mfma_f32_16x16x32_bf16 v[116:119],a[124:127],v[28:31],v[116:119]
ds_read_b128 a[20:23],v12 offset:256
v_fma_f32 v99,v99,s36,v16
ds_read_b64_tr_b16 a[136:137],v2 offset:24704
ds_read_b64_tr_b16 a[138:139],v2 offset:30848
ds_read_b64_tr_b16 a[140:141],v3 offset:24704
ds_read_b64_tr_b16 a[142:143],v3 offset:30848
ds_read_b64_tr_b16 a[144:145],v4 offset:24704
ds_read_b64_tr_b16 a[146:147],v4 offset:30848
ds_read_b64_tr_b16 a[148:149],v5 offset:24704
ds_read_b64_tr_b16 a[150:151],v5 offset:30848
ds_read_b128 a[24:27],v11 offset:6144
v_mfma_f32_16x16x32_bf16 a[164:167],a[124:127],v[32:35],a[164:167]
v_fma_f32 v104,v104,s36,v17
ds_read_b128 a[28:31],v12 offset:6144
v_mfma_f32_16x16x32_bf16 a[160:163],a[120:123],v[32:35],a[160:163]
v_fma_f32 v105,v105,s36,v17
ds_read_b128 a[32:35],v11 offset:6272
v_mfma_f32_16x16x32_bf16 a[208:211],a[120:123],v[36:39],a[208:211]
s_waitcnt lgkmcnt(11)
buffer_load_dwordx4 v6,s[12:15],s28 offen offset:0 nt lds
v_mfma_f32_16x16x32_bf16 a[212:215],a[124:127],v[36:39],a[212:215]
ds_read_b64_tr_b16 a[120:121],v2 offset:24832
ds_read_b128 a[36:39],v12 offset:6272
v_mfma_f32_16x16x32_bf16 a[216:219],a[128:131],v[36:39],a[216:219]
v_fma_f32 v106,v106,s36,v17
ds_read_b128 a[40:43],v11 offset:6400
v_mfma_f32_16x16x32_bf16 a[220:223],a[132:135],v[36:39],a[220:223]
v_fma_f32 v107,v107,s36,v17
ds_read_b128 a[44:47],v12 offset:6400
v_mfma_f32_16x16x32_bf16 a[172:175],a[132:135],v[32:35],a[172:175]
v_fma_f32 v76,v76,s36,v13
v_fma_f32 v77,v77,s36,v13
v_mfma_f32_16x16x32_bf16 a[168:171],a[128:131],v[32:35],a[168:171]
buffer_load_dwordx4 v7,s[12:15],s28 offen offset:1024 nt lds
v_mfma_f32_16x16x32_bf16 v[120:123],a[128:131],v[28:31],v[120:123]
ds_read_b64_tr_b16 a[122:123],v2 offset:30976
ds_read_b64_tr_b16 a[124:125],v3 offset:24832
ds_read_b64_tr_b16 a[126:127],v3 offset:30976
v_mfma_f32_16x16x32_bf16 v[124:127],a[132:135],v[28:31],v[124:127]
v_fma_f32 v78,v78,s36,v13
v_fma_f32 v79,v79,s36,v13
v_mfma_f32_16x16x32_bf16 v[220:223],a[132:135],v[24:27],v[220:223]
v_fma_f32 v84,v84,s36,v14
v_fma_f32 v85,v85,s36,v14
v_mfma_f32_16x16x32_bf16 v[216:219],a[128:131],v[24:27],v[216:219]
v_fma_f32 v86,v86,s36,v14
v_fma_f32 v87,v87,s36,v14
v_mfma_f32_16x16x32_bf16 v[168:171],a[128:131],v[20:23],v[168:171]
ds_read_b64_tr_b16 a[128:129],v4 offset:24832
v_fma_f32 v92,v92,s36,v15
v_mfma_f32_16x16x32_bf16 v[172:175],a[132:135],v[20:23],v[172:175]
s_waitcnt lgkmcnt(4)
ds_read_b64_tr_b16 a[130:131],v4 offset:30976
v_fma_f32 v93,v93,s36,v15
v_mfma_f32_16x16x32_bf16 v[176:179],a[136:139],v[20:23],v[176:179]
buffer_load_dwordx4 v8,s[12:15],s28 offen offset:2048 nt lds
v_mfma_f32_16x16x32_bf16 v[180:183],a[140:143],v[20:23],v[180:183]
s_add_u32 s28,s28,3072
ds_read_b64_tr_b16 a[132:133],v5 offset:24832
v_fma_f32 v94,v94,s36,v15
v_mfma_f32_16x16x32_bf16 v[228:231],a[140:143],v[24:27],v[228:231]
s_add_u32 m0,s24,3072
ds_read_b64_tr_b16 a[134:135],v5 offset:30976
v_fma_f32 v95,v95,s36,v15
v_mfma_f32_16x16x32_bf16 v[224:227],a[136:139],v[24:27],v[224:227]
v_fma_f32 v100,v100,s36,v16
v_fma_f32 v101,v101,s36,v16
v_mfma_f32_16x16x32_bf16 v[128:131],a[136:139],v[28:31],v[128:131]
v_fma_f32 v102,v102,s36,v16
v_fma_f32 v103,v103,s36,v16
v_mfma_f32_16x16x32_bf16 v[132:135],a[140:143],v[28:31],v[132:135]
v_fma_f32 v108,v108,s36,v17
v_fma_f32 v109,v109,s36,v17
v_mfma_f32_16x16x32_bf16 a[180:183],a[140:143],v[32:35],a[180:183]
v_fma_f32 v110,v110,s36,v17
v_fma_f32 v111,v111,s36,v17
v_mfma_f32_16x16x32_bf16 a[176:179],a[136:139],v[32:35],a[176:179]
v_exp_f32 v90,v90
v_mfma_f32_16x16x32_bf16 a[224:227],a[136:139],v[36:39],a[224:227]
buffer_load_dwordx4 v6,s[12:15],s28 offen offset:0 nt lds
v_mfma_f32_16x16x32_bf16 a[228:231],a[140:143],v[36:39],a[228:231]
v_exp_f32 v91,v91
v_mfma_f32_16x16x32_bf16 a[232:235],a[144:147],v[36:39],a[232:235]
v_exp_f32 v96,v96
v_mfma_f32_16x16x32_bf16 a[236:239],a[148:151],v[36:39],a[236:239]
v_exp_f32 v97,v97
v_mfma_f32_16x16x32_bf16 a[188:191],a[148:151],v[32:35],a[188:191]
v_exp_f32 v98,v98
v_mfma_f32_16x16x32_bf16 a[184:187],a[144:147],v[32:35],a[184:187]
v_exp_f32 v99,v99
v_mfma_f32_16x16x32_bf16 v[136:139],a[144:147],v[28:31],v[136:139]
v_exp_f32 v104,v104
v_mfma_f32_16x16x32_bf16 v[140:143],a[148:151],v[28:31],v[140:143]
v_exp_f32 v105,v105
v_mfma_f32_16x16x32_bf16 v[236:239],a[148:151],v[24:27],v[236:239]
buffer_load_dwordx4 v7,s[12:15],s28 offen offset:1024 nt lds
v_mfma_f32_16x16x32_bf16 v[232:235],a[144:147],v[24:27],v[232:235]
v_exp_f32 v106,v106
v_mfma_f32_16x16x32_bf16 v[184:187],a[144:147],v[20:23],v[184:187]
v_exp_f32 v107,v107
v_mfma_f32_16x16x32_bf16 v[188:191],a[148:151],v[20:23],v[188:191]
s_waitcnt lgkmcnt(0)
v_exp_f32 v76,v76
v_mfma_f32_16x16x32_bf16 v[192:195],a[120:123],v[20:23],v[192:195]
v_exp_f32 v77,v77
v_mfma_f32_16x16x32_bf16 v[196:199],a[124:127],v[20:23],v[196:199]
v_exp_f32 v78,v78
v_mfma_f32_16x16x32_bf16 v[244:247],a[124:127],v[24:27],v[244:247]
v_exp_f32 v79,v79
v_mfma_f32_16x16x32_bf16 v[240:243],a[120:123],v[24:27],v[240:243]
v_exp_f32 v84,v84
v_mfma_f32_16x16x32_bf16 v[144:147],a[120:123],v[28:31],v[144:147]
buffer_load_dwordx4 v8,s[12:15],s28 offen offset:2048 nt lds
s_waitcnt vmcnt(20)
s_barrier
v_mfma_f32_16x16x32_bf16 v[148:151],a[124:127],v[28:31],v[148:151]
s_add_u32 s28,s28,3072
v_exp_f32 v85,v85
v_mfma_f32_16x16x32_bf16 a[196:199],a[124:127],v[32:35],a[196:199]
s_add_u32 m0,s22,0
v_exp_f32 v86,v86
v_mfma_f32_16x16x32_bf16 a[192:195],a[120:123],v[32:35],a[192:195]
buffer_load_dwordx4 v6,s[4:7],s25 offen offset:0 lds
v_mfma_f32_16x16x32_bf16 a[240:243],a[120:123],v[36:39],a[240:243]
buffer_load_dwordx4 v7,s[4:7],s25 offen offset:1024 lds
v_mfma_f32_16x16x32_bf16 a[244:247],a[124:127],v[36:39],a[244:247]
buffer_load_dwordx4 v8,s[4:7],s25 offen offset:2048 lds
v_mfma_f32_16x16x32_bf16 a[248:251],a[128:131],v[36:39],a[248:251]
v_exp_f32 v87,v87
v_mfma_f32_16x16x32_bf16 a[252:255],a[132:135],v[36:39],a[252:255]
v_exp_f32 v92,v92
v_mfma_f32_16x16x32_bf16 a[204:207],a[132:135],v[32:35],a[204:207]
v_exp_f32 v93,v93
v_mfma_f32_16x16x32_bf16 a[200:203],a[128:131],v[32:35],a[200:203]
v_exp_f32 v94,v94
v_mfma_f32_16x16x32_bf16 v[152:155],a[128:131],v[28:31],v[152:155]
ds_read_b64_tr_b16 a[136:137],v2 offset:0
v_exp_f32 v95,v95
v_mfma_f32_16x16x32_bf16 v[156:159],a[132:135],v[28:31],v[156:159]
ds_read_b64_tr_b16 a[138:139],v2 offset:6144
v_exp_f32 v100,v100
v_mfma_f32_16x16x32_bf16 v[252:255],a[132:135],v[24:27],v[252:255]
ds_read_b64_tr_b16 a[140:141],v3 offset:0
v_exp_f32 v101,v101
v_mfma_f32_16x16x32_bf16 v[248:251],a[128:131],v[24:27],v[248:251]
ds_read_b64_tr_b16 a[142:143],v3 offset:6144
v_exp_f32 v102,v102
v_mfma_f32_16x16x32_bf16 v[200:203],a[128:131],v[20:23],v[200:203]
ds_read_b64_tr_b16 a[144:145],v4 offset:0
v_exp_f32 v103,v103
v_mfma_f32_16x16x32_bf16 v[204:207],a[132:135],v[20:23],v[204:207]
ds_read_b64_tr_b16 a[146:147],v4 offset:6144
ds_read_b64_tr_b16 a[148:149],v5 offset:0
ds_read_b64_tr_b16 a[150:151],v5 offset:6144
v_exp_f32 v108,v108
v_exp_f32 v109,v109
v_exp_f32 v110,v110
v_exp_f32 v111,v111
v_cvt_pk_bf16_f32 v53,v90,v91
v_cvt_pk_bf16_f32 v56,v96,v97
v_cvt_pk_bf16_f32 v57,v98,v99
v_cvt_pk_bf16_f32 v40,v104,v105
v_cvt_pk_bf16_f32 v41,v106,v107
v_cvt_pk_bf16_f32 v46,v76,v77
v_cvt_pk_bf16_f32 v47,v78,v79
v_cvt_pk_bf16_f32 v50,v84,v85
v_cvt_pk_bf16_f32 v51,v86,v87
v_cvt_pk_bf16_f32 v54,v92,v93
v_cvt_pk_bf16_f32 v55,v94,v95
v_smfmac_f32_16x16x64_bf16 v[60:63],a[152:155],v[44:51],v18
v_cvt_pk_bf16_f32 v58,v100,v101
v_cvt_pk_bf16_f32 v59,v102,v103
v_cvt_pk_bf16_f32 v42,v108,v109
v_cvt_pk_bf16_f32 v43,v110,v111
v_smfmac_f32_16x16x64_bf16 v[64:67],a[152:155],v[52:59],v18
v_subrev_u32 v10,18432,v10
v_smfmac_f32_16x16x64_bf16 v[68:71],a[152:155],v[36:43],v18
s_waitcnt lgkmcnt(0)
v_mfma_f32_16x16x32_bf16 v[160:163],a[136:139],v[44:47],v[160:163]
s_add_u32 s87,s42,18432
ds_read_b64_tr_b16 a[120:121],v2 offset:128
v_mbcnt_lo_u32_b32 v39,-1,0
v_mfma_f32_16x16x32_bf16 v[164:167],a[140:143],v[44:47],v[164:167]
s_add_u32 s66,s42,24576
ds_read_b64_tr_b16 a[122:123],v2 offset:6272
v_mbcnt_hi_u32_b32 v39,-1,v39
v_mfma_f32_16x16x32_bf16 v[212:215],a[140:143],v[48:51],v[212:215]
ds_read_b64_tr_b16 a[124:125],v3 offset:128
v_and_b32 v38,7,v39
v_mfma_f32_16x16x32_bf16 v[208:211],a[136:139],v[48:51],v[208:211]
ds_read_b64_tr_b16 a[126:127],v3 offset:6272
v_add_f32 v68,v68,v69
v_mfma_f32_16x16x32_bf16 v[112:115],a[136:139],v[52:55],v[112:115]
ds_read_b64_tr_b16 a[128:129],v4 offset:128
v_add_f32 v60,v60,v61
v_mfma_f32_16x16x32_bf16 v[116:119],a[140:143],v[52:55],v[116:119]
ds_read_b64_tr_b16 a[130:131],v4 offset:6272
ds_read_b64_tr_b16 a[132:133],v5 offset:128
ds_read_b64_tr_b16 a[134:135],v5 offset:6272
v_mfma_f32_16x16x32_bf16 a[164:167],a[140:143],v[56:59],a[164:167]
v_add_f32 v62,v62,v63
v_add_f32 v64,v64,v65
v_mfma_f32_16x16x32_bf16 a[160:163],a[136:139],v[56:59],a[160:163]
v_add_f32 v68,v68,v70
v_add_f32 v66,v66,v67
v_mfma_f32_16x16x32_bf16 a[208:211],a[136:139],v[40:43],a[208:211]
ds_read_b64_tr_b16 a[136:137],v2 offset:256
v_max3_f32 v19,v60,v62,v64
v_mfma_f32_16x16x32_bf16 a[212:215],a[140:143],v[40:43],a[212:215]
ds_read_b64_tr_b16 a[138:139],v2 offset:6400
v_add_f32 v68,v68,v71
v_mfma_f32_16x16x32_bf16 a[216:219],a[144:147],v[40:43],a[216:219]
ds_read_b64_tr_b16 a[140:141],v3 offset:256
v_max3_f32 v19,v19,v66,v68
v_mfma_f32_16x16x32_bf16 a[220:223],a[148:151],v[40:43],a[220:223]
ds_read_b64_tr_b16 a[142:143],v3 offset:6400
v_rcp_f32 v66,v66
v_rcp_f32 v68,v68
v_accvgpr_read_b32 v72,a160
v_accvgpr_read_b32 v73,a161
v_pk_mul_f32 v[72:73],v[72:73],v[66:67] op_sel_hi:[1,0]
v_accvgpr_read_b32 v74,a162
v_accvgpr_read_b32 v75,a163
v_pk_mul_f32 v[74:75],v[74:75],v[66:67] op_sel_hi:[1,0]
v_accvgpr_read_b32 v76,a208
v_accvgpr_read_b32 v77,a209
v_pk_mul_f32 v[76:77],v[76:77],v[68:69] op_sel_hi:[1,0]
v_accvgpr_read_b32 v78,a210
v_accvgpr_read_b32 v79,a211
v_pk_mul_f32 v[78:79],v[78:79],v[68:69] op_sel_hi:[1,0]
v_accvgpr_read_b32 v80,a164
v_accvgpr_read_b32 v81,a165
v_mfma_f32_16x16x32_bf16 a[172:175],a[148:151],v[56:59],a[172:175]
v_accvgpr_read_b32 v82,a166
v_accvgpr_read_b32 v83,a167
v_accvgpr_read_b32 v84,a212
v_accvgpr_read_b32 v85,a213
v_accvgpr_read_b32 v86,a214
v_pk_mul_f32 v[80:81],v[80:81],v[66:67] op_sel_hi:[1,0]
v_pk_mul_f32 v[82:83],v[82:83],v[66:67] op_sel_hi:[1,0]
v_pk_mul_f32 v[84:85],v[84:85],v[68:69] op_sel_hi:[1,0]
v_accvgpr_read_b32 v87,a215
v_pk_mul_f32 v[86:87],v[86:87],v[68:69] op_sel_hi:[1,0]
v_accvgpr_read_b32 v92,a216
v_accvgpr_read_b32 v93,a217
v_mfma_f32_16x16x32_bf16 a[168:171],a[144:147],v[56:59],a[168:171]
v_accvgpr_read_b32 v94,a218
v_accvgpr_read_b32 v95,a219
v_mfma_f32_16x16x32_bf16 v[120:123],a[144:147],v[52:55],v[120:123]
v_accvgpr_read_b32 v100,a220
v_accvgpr_read_b32 v101,a221
v_mfma_f32_16x16x32_bf16 v[124:127],a[148:151],v[52:55],v[124:127]
v_accvgpr_read_b32 v102,a222
v_accvgpr_read_b32 v103,a223
v_mfma_f32_16x16x32_bf16 v[220:223],a[148:151],v[48:51],v[220:223]
v_accvgpr_read_b32 v88,a168
v_accvgpr_read_b32 v89,a169
v_accvgpr_read_b32 v90,a170
v_accvgpr_read_b32 v91,a171
v_accvgpr_read_b32 v96,a172
v_pk_mul_f32 v[92:93],v[92:93],v[68:69] op_sel_hi:[1,0]
v_pk_mul_f32 v[94:95],v[94:95],v[68:69] op_sel_hi:[1,0]
v_pk_mul_f32 v[88:89],v[88:89],v[66:67] op_sel_hi:[1,0]
v_pk_mul_f32 v[90:91],v[90:91],v[66:67] op_sel_hi:[1,0]
v_accvgpr_read_b32 v97,a173
v_accvgpr_read_b32 v98,a174
v_mfma_f32_16x16x32_bf16 v[216:219],a[144:147],v[48:51],v[216:219]
v_accvgpr_read_b32 v99,a175
v_cmp_ngt_f32 vcc,s37,v19
v_lshrrev_b32 v19,5,v39
v_xor_b32 v38,v38,v19
v_and_b32 v19,15,v39
v_pk_mul_f32 v[96:97],v[96:97],v[66:67] op_sel_hi:[1,0]
v_pk_mul_f32 v[100:101],v[100:101],v[68:69] op_sel_hi:[1,0]
v_pk_mul_f32 v[102:103],v[102:103],v[68:69] op_sel_hi:[1,0]
v_pk_mul_f32 v[98:99],v[98:99],v[66:67] op_sel_hi:[1,0]
v_lshl_add_u32 v19,v19,7,s24
v_lshl_add_u32 v19,v38,4,v19
v_mfma_f32_16x16x32_bf16 v[168:171],a[144:147],v[44:47],v[168:171]
s_cmp_lg_u64 vcc,0
ds_read_b64_tr_b16 a[144:145],v4 offset:256
v_bfe_u32 v38,v39,4,1
v_mfma_f32_16x16x32_bf16 v[172:175],a[148:151],v[44:47],v[172:175]
s_cselect_b32 s62,s32,0
ds_read_b64_tr_b16 a[146:147],v4 offset:6400
v_lshl_add_u32 v36,v38,3,v19
s_waitcnt lgkmcnt(2)
v_mfma_f32_16x16x32_bf16 v[176:179],a[120:123],v[44:47],v[176:179]
s_or_b32 s31,s31,s62
ds_read_b64_tr_b16 a[148:149],v5 offset:256
v_xor_b32 v37,32,v36
v_mfma_f32_16x16x32_bf16 v[180:183],a[124:127],v[44:47],v[180:183]
s_lshl_b32 s32,s32,1
ds_read_b64_tr_b16 a[150:151],v5 offset:6400
v_xor_b32 v38,64,v36
v_mfma_f32_16x16x32_bf16 v[228:231],a[124:127],v[48:51],v[228:231]
s_add_u32 m0,s23,0
v_bfe_u32 v19,v39,3,1
v_xor_b32 v39,96,v36
v_mfma_f32_16x16x32_bf16 v[224:227],a[120:123],v[48:51],v[224:227]
v_lshlrev_b32 v19,11,v19
v_cvt_pk_bf16_f32 v72,v72,v73
v_mfma_f32_16x16x32_bf16 v[128:131],a[120:123],v[52:55],v[128:131]
v_cvt_pk_bf16_f32 v76,v76,v77
v_cvt_pk_bf16_f32 v80,v80,v81
v_mfma_f32_16x16x32_bf16 v[132:135],a[124:127],v[52:55],v[132:135]
v_cvt_pk_bf16_f32 v84,v84,v85
v_cvt_pk_bf16_f32 v73,v74,v75
v_mfma_f32_16x16x32_bf16 a[180:183],a[124:127],v[56:59],a[180:183]
v_cvt_pk_bf16_f32 v77,v78,v79
v_cvt_pk_bf16_f32 v81,v82,v83
v_mfma_f32_16x16x32_bf16 a[176:179],a[120:123],v[56:59],a[176:179]
ds_write2st64_b64 v36,v[72:73],v[76:77] offset0:36 offset1:40
v_mfma_f32_16x16x32_bf16 a[224:227],a[120:123],v[40:43],a[224:227]
v_cvt_pk_bf16_f32 v85,v86,v87
v_cvt_pk_bf16_f32 v92,v92,v93
v_mfma_f32_16x16x32_bf16 a[228:231],a[124:127],v[40:43],a[228:231]
v_cvt_pk_bf16_f32 v88,v88,v89
v_cvt_pk_bf16_f32 v93,v94,v95
v_mfma_f32_16x16x32_bf16 a[232:235],a[128:131],v[40:43],a[232:235]
v_accvgpr_read_b32 v82,a178
v_accvgpr_read_b32 v83,a179
v_mfma_f32_16x16x32_bf16 a[236:239],a[132:135],v[40:43],a[236:239]
ds_write2st64_b64 v37,v[80:81],v[84:85] offset0:36 offset1:40
v_pk_mul_f32 v[82:83],v[82:83],v[66:67] op_sel_hi:[1,0]
v_accvgpr_read_b32 v86,a226
v_accvgpr_read_b32 v87,a227
v_pk_mul_f32 v[86:87],v[86:87],v[68:69] op_sel_hi:[1,0]
v_accvgpr_read_b32 v80,a176
v_accvgpr_read_b32 v81,a177
v_pk_mul_f32 v[80:81],v[80:81],v[66:67] op_sel_hi:[1,0]
v_accvgpr_read_b32 v84,a224
v_accvgpr_read_b32 v85,a225
v_pk_mul_f32 v[84:85],v[84:85],v[68:69] op_sel_hi:[1,0]
v_cvt_pk_bf16_f32 v89,v90,v91
v_accvgpr_read_b32 v94,a230
v_mfma_f32_16x16x32_bf16 a[188:191],a[132:135],v[56:59],a[188:191]
ds_write2st64_b64 v38,v[88:89],v[92:93] offset0:36 offset1:40
v_accvgpr_read_b32 v95,a231
v_pk_mul_f32 v[94:95],v[94:95],v[68:69] op_sel_hi:[1,0]
v_accvgpr_read_b32 v90,a182
v_accvgpr_read_b32 v91,a183
v_pk_mul_f32 v[90:91],v[90:91],v[66:67] op_sel_hi:[1,0]
v_accvgpr_read_b32 v88,a180
v_accvgpr_read_b32 v89,a181
v_pk_mul_f32 v[88:89],v[88:89],v[66:67] op_sel_hi:[1,0]
v_accvgpr_read_b32 v92,a228
v_accvgpr_read_b32 v93,a229
v_pk_mul_f32 v[92:93],v[92:93],v[68:69] op_sel_hi:[1,0]
v_cvt_pk_bf16_f32 v96,v96,v97
v_cvt_pk_bf16_f32 v100,v100,v101
v_mfma_f32_16x16x32_bf16 a[184:187],a[128:131],v[56:59],a[184:187]
v_cvt_pk_bf16_f32 v97,v98,v99
v_cvt_pk_bf16_f32 v101,v102,v103
v_mfma_f32_16x16x32_bf16 v[136:139],a[128:131],v[52:55],v[136:139]
ds_write2st64_b64 v39,v[96:97],v[100:101] offset0:36 offset1:40
v_mfma_f32_16x16x32_bf16 v[140:143],a[132:135],v[52:55],v[140:143]
s_waitcnt vmcnt(15)
v_cvt_pk_bf16_f32 v80,v80,v81
v_cvt_pk_bf16_f32 v84,v84,v85
v_mfma_f32_16x16x32_bf16 v[236:239],a[132:135],v[48:51],v[236:239]
ds_read_b128 a[48:51],v11 offset:12288
v_cvt_pk_bf16_f32 v81,v82,v83
ds_read_b128 a[52:55],v12 offset:12288
v_cvt_pk_bf16_f32 v85,v86,v87
ds_read_b128 a[56:59],v11 offset:12416
v_accvgpr_read_b32 v98,a186
ds_read_b128 a[60:63],v12 offset:12416
v_accvgpr_read_b32 v99,a187
ds_read_b128 a[64:67],v11 offset:12544
v_pk_mul_f32 v[98:99],v[98:99],v[66:67] op_sel_hi:[1,0]
ds_read_b128 a[68:71],v12 offset:12544
v_accvgpr_read_b32 v102,a234
ds_read_b128 v[104:107],v10 offset:18432
v_accvgpr_read_b32 v103,a235
ds_read_b128 v[108:111],v10 offset:19456
v_pk_mul_f32 v[102:103],v[102:103],v[68:69] op_sel_hi:[1,0]
ds_read_b128 v[72:75],v10 offset:20480
v_accvgpr_read_b32 v96,a184
ds_read_b128 v[76:79],v10 offset:21504
v_accvgpr_read_b32 v97,a185
ds_write2st64_b64 v36,v[80:81],v[84:85] offset0:36 offset1:40
v_pk_mul_f32 v[96:97],v[96:97],v[66:67] op_sel_hi:[1,0]
v_accvgpr_read_b32 v100,a232
v_accvgpr_read_b32 v101,a233
v_pk_mul_f32 v[100:101],v[100:101],v[68:69] op_sel_hi:[1,0]
v_accvgpr_read_b32 v82,a190
v_accvgpr_read_b32 v83,a191
v_pk_mul_f32 v[82:83],v[82:83],v[66:67] op_sel_hi:[1,0]
s_waitcnt lgkmcnt(4)
buffer_store_dwordx4 v[104:107],v9,s[16:19],s87 offen offset:0 nt
v_accvgpr_read_b32 v86,a238
v_accvgpr_read_b32 v87,a239
v_pk_mul_f32 v[86:87],v[86:87],v[68:69] op_sel_hi:[1,0]
v_accvgpr_read_b32 v80,a188
v_accvgpr_read_b32 v81,a189
v_pk_mul_f32 v[80:81],v[80:81],v[66:67] op_sel_hi:[1,0]
v_accvgpr_read_b32 v84,a236
v_accvgpr_read_b32 v85,a237
v_pk_mul_f32 v[84:85],v[84:85],v[68:69] op_sel_hi:[1,0]
v_cvt_pk_bf16_f32 v88,v88,v89
v_cvt_pk_bf16_f32 v92,v92,v93
v_mfma_f32_16x16x32_bf16 v[232:235],a[128:131],v[48:51],v[232:235]
s_waitcnt lgkmcnt(1)
buffer_store_dwordx4 v[108:111],v9,s[16:19],s87 offen offset:3072 nt
v_cvt_pk_bf16_f32 v96,v96,v97
v_cvt_pk_bf16_f32 v100,v100,v101
v_cvt_pk_bf16_f32 v89,v90,v91
v_mfma_f32_16x16x32_bf16 v[184:187],a[128:131],v[44:47],v[184:187]
v_cvt_pk_bf16_f32 v93,v94,v95
v_cvt_pk_bf16_f32 v80,v80,v81
v_mfma_f32_16x16x32_bf16 v[188:191],a[132:135],v[44:47],v[188:191]
v_cvt_pk_bf16_f32 v84,v84,v85
v_cvt_pk_bf16_f32 v97,v98,v99
v_mfma_f32_16x16x32_bf16 v[192:195],a[136:139],v[44:47],v[192:195]
ds_write2st64_b64 v37,v[88:89],v[92:93] offset0:36 offset1:40
v_mfma_f32_16x16x32_bf16 v[196:199],a[140:143],v[44:47],v[196:199]
v_cvt_pk_bf16_f32 v101,v102,v103
v_cvt_pk_bf16_f32 v81,v82,v83
v_mfma_f32_16x16x32_bf16 v[244:247],a[140:143],v[48:51],v[244:247]
buffer_store_dwordx4 v[72:75],v9,s[16:19],s66 offen offset:0 nt
v_cvt_pk_bf16_f32 v85,v86,v87
v_rcp_f32 v62,v62
v_mfma_f32_16x16x32_bf16 v[240:243],a[136:139],v[48:51],v[240:243]
v_rcp_f32 v64,v64
v_mfma_f32_16x16x32_bf16 v[144:147],a[136:139],v[52:55],v[144:147]
v_rcp_f32 v60,v60
v_mfma_f32_16x16x32_bf16 v[148:151],a[140:143],v[52:55],v[148:151]
ds_write2st64_b64 v38,v[96:97],v[100:101] offset0:36 offset1:40
v_mfma_f32_16x16x32_bf16 a[196:199],a[140:143],v[56:59],a[196:199]
v_mfma_f32_16x16x32_bf16 a[192:195],a[136:139],v[56:59],a[192:195]
buffer_store_dwordx4 v[76:79],v9,s[16:19],s66 offen offset:3072 nt
v_mfma_f32_16x16x32_bf16 a[240:243],a[136:139],v[40:43],a[240:243]
v_mfma_f32_16x16x32_bf16 a[244:247],a[140:143],v[40:43],a[244:247]
v_mfma_f32_16x16x32_bf16 a[248:251],a[144:147],v[40:43],a[248:251]
ds_write2st64_b64 v39,v[80:81],v[84:85] offset0:36 offset1:40
v_mfma_f32_16x16x32_bf16 a[252:255],a[148:151],v[40:43],a[252:255]
s_waitcnt vmcnt(4)
s_barrier
ds_read_b128 v[72:75],v10 offset:18432
v_accvgpr_read_b32 v104,a192
ds_read_b128 v[76:79],v10 offset:19456
v_accvgpr_read_b32 v105,a193
ds_read_b128 v[88:91],v10 offset:20480
v_pk_mul_f32 v[104:105],v[104:105],v[66:67] op_sel_hi:[1,0]
ds_read_b128 v[92:95],v10 offset:21504
v_accvgpr_read_b32 v106,a194
ds_read_b128 a[120:123],v0 offset:0
v_accvgpr_read_b32 v107,a195
buffer_load_dwordx4 v6,s[8:11],s25 offen offset:0 lds
ds_read_b128 a[124:127],v1 offset:0
v_pk_mul_f32 v[106:107],v[106:107],v[66:67] op_sel_hi:[1,0]
ds_read_b128 a[128:131],v0 offset:128
s_waitcnt lgkmcnt(6)
buffer_store_dwordx4 v[72:75],v9,s[16:19],s87 offen offset:128 nt
ds_read_b128 a[132:135],v1 offset:128
v_accvgpr_read_b32 v108,a240
ds_read_b128 a[136:139],v0 offset:256
v_accvgpr_read_b32 v109,a241
ds_read_b128 a[140:143],v1 offset:256
v_pk_mul_f32 v[108:109],v[108:109],v[68:69] op_sel_hi:[1,0]
v_accvgpr_read_b32 v110,a242
s_waitcnt lgkmcnt(6)
buffer_store_dwordx4 v[76:79],v9,s[16:19],s87 offen offset:3200 nt
v_accvgpr_read_b32 v111,a243
v_pk_mul_f32 v[110:111],v[110:111],v[68:69] op_sel_hi:[1,0]
v_accvgpr_read_b32 v96,a196
v_accvgpr_read_b32 v97,a197
v_mfma_f32_16x16x32_bf16 a[204:207],a[148:151],v[56:59],a[204:207]
v_accvgpr_read_b32 v98,a198
v_accvgpr_read_b32 v99,a199
v_accvgpr_read_b32 v100,a244
buffer_load_dwordx4 v7,s[8:11],s25 offen offset:1024 lds
buffer_store_dwordx4 v[88:91],v9,s[16:19],s66 offen offset:128 nt
v_pk_mul_f32 v[96:97],v[96:97],v[66:67] op_sel_hi:[1,0]
v_pk_mul_f32 v[98:99],v[98:99],v[66:67] op_sel_hi:[1,0]
v_accvgpr_read_b32 v101,a245
v_pk_mul_f32 v[100:101],v[100:101],v[68:69] op_sel_hi:[1,0]
v_accvgpr_read_b32 v102,a246
v_accvgpr_read_b32 v103,a247
v_pk_mul_f32 v[102:103],v[102:103],v[68:69] op_sel_hi:[1,0]
v_cvt_pk_bf16_f32 v104,v104,v105
v_cvt_pk_bf16_f32 v108,v108,v109
v_mfma_f32_16x16x32_bf16 a[200:203],a[144:147],v[56:59],a[200:203]
v_cvt_pk_bf16_f32 v105,v106,v107
v_cvt_pk_bf16_f32 v109,v110,v111
v_mfma_f32_16x16x32_bf16 v[152:155],a[144:147],v[52:55],v[152:155]
ds_write2st64_b64 v36,v[104:105],v[108:109] offset0:36 offset1:40
v_mfma_f32_16x16x32_bf16 v[156:159],a[148:151],v[52:55],v[156:159]
v_add_u32 v36,v36,v19
v_accvgpr_read_b32 v84,a248
v_mfma_f32_16x16x32_bf16 v[252:255],a[148:151],v[48:51],v[252:255]
buffer_load_dwordx4 v8,s[8:11],s25 offen offset:2048 lds
buffer_store_dwordx4 v[92:95],v9,s[16:19],s66 offen offset:3200 nt
v_pk_mul_f32 v[208:209],v[208:209],v[62:63] op_sel_hi:[1,0]
v_pk_mul_f32 v[210:211],v[210:211],v[62:63] op_sel_hi:[1,0]
v_pk_mul_f32 v[224:225],v[224:225],v[62:63] op_sel_hi:[1,0]
v_pk_mul_f32 v[226:227],v[226:227],v[62:63] op_sel_hi:[1,0]
v_pk_mul_f32 v[212:213],v[212:213],v[62:63] op_sel_hi:[1,0]
v_pk_mul_f32 v[214:215],v[214:215],v[62:63] op_sel_hi:[1,0]
v_pk_mul_f32 v[228:229],v[228:229],v[62:63] op_sel_hi:[1,0]
v_pk_mul_f32 v[230:231],v[230:231],v[62:63] op_sel_hi:[1,0]
v_pk_mul_f32 v[216:217],v[216:217],v[62:63] op_sel_hi:[1,0]
v_pk_mul_f32 v[218:219],v[218:219],v[62:63] op_sel_hi:[1,0]
v_pk_mul_f32 v[232:233],v[232:233],v[62:63] op_sel_hi:[1,0]
v_pk_mul_f32 v[234:235],v[234:235],v[62:63] op_sel_hi:[1,0]
v_pk_mul_f32 v[220:221],v[220:221],v[62:63] op_sel_hi:[1,0]
v_pk_mul_f32 v[222:223],v[222:223],v[62:63] op_sel_hi:[1,0]
v_pk_mul_f32 v[236:237],v[236:237],v[62:63] op_sel_hi:[1,0]
v_pk_mul_f32 v[238:239],v[238:239],v[62:63] op_sel_hi:[1,0]
v_accvgpr_read_b32 v85,a249
v_pk_mul_f32 v[84:85],v[84:85],v[68:69] op_sel_hi:[1,0]
v_accvgpr_read_b32 v80,a200
v_accvgpr_read_b32 v81,a201
v_pk_mul_f32 v[80:81],v[80:81],v[66:67] op_sel_hi:[1,0]
v_accvgpr_read_b32 v86,a250
v_accvgpr_read_b32 v87,a251
v_pk_mul_f32 v[86:87],v[86:87],v[68:69] op_sel_hi:[1,0]
v_cvt_pk_bf16_f32 v96,v96,v97
v_cvt_pk_bf16_f32 v100,v100,v101
v_accvgpr_read_b32 v82,a202
v_accvgpr_read_b32 v83,a203
v_pk_mul_f32 v[82:83],v[82:83],v[66:67] op_sel_hi:[1,0]
v_accvgpr_read_b32 v104,a204
v_accvgpr_read_b32 v105,a205
v_pk_mul_f32 v[104:105],v[104:105],v[66:67] op_sel_hi:[1,0]
v_accvgpr_read_b32 v108,a252
v_accvgpr_read_b32 v109,a253
v_pk_mul_f32 v[108:109],v[108:109],v[68:69] op_sel_hi:[1,0]
v_accvgpr_read_b32 v106,a206
v_accvgpr_read_b32 v107,a207
v_pk_mul_f32 v[106:107],v[106:107],v[66:67] op_sel_hi:[1,0]
v_accvgpr_read_b32 v110,a254
v_accvgpr_read_b32 v111,a255
v_pk_mul_f32 v[110:111],v[110:111],v[68:69] op_sel_hi:[1,0]
v_cvt_pk_bf16_f32 v84,v84,v85
v_cvt_pk_bf16_f32 v80,v80,v81
v_mfma_f32_16x16x32_bf16 v[248:251],a[144:147],v[48:51],v[248:251]
s_waitcnt vmcnt(14)
ds_read_b128 a[72:75],v11 offset:0
v_cvt_pk_bf16_f32 v97,v98,v99
v_mfma_f32_16x16x32_bf16 v[200:203],a[144:147],v[44:47],v[200:203]
s_mov_b32 s27,s42
ds_read_b128 a[76:79],v12 offset:0
v_cvt_pk_bf16_f32 v101,v102,v103
v_mfma_f32_16x16x32_bf16 v[204:207],a[148:151],v[44:47],v[204:207]
s_mov_b32 s42,s41
ds_read_b128 a[80:83],v11 offset:128
v_cvt_pk_bf16_f32 v104,v104,v105
ds_read_b128 a[84:87],v12 offset:128
v_pk_mul_f32 v[240:241],v[240:241],v[62:63] op_sel_hi:[1,0]
ds_read_b128 a[88:91],v11 offset:256
v_pk_mul_f32 v[242:243],v[242:243],v[62:63] op_sel_hi:[1,0]
ds_read_b128 a[92:95],v12 offset:256
v_pk_mul_f32 v[112:113],v[112:113],v[64:65] op_sel_hi:[1,0]
ds_write2st64_b64 v37,v[96:97],v[100:101] offset0:36 offset1:40
v_pk_mul_f32 v[114:115],v[114:115],v[64:65] op_sel_hi:[1,0]
v_add_u32 v37,v37,v19
v_cvt_pk_bf16_f32 v108,v108,v109
ds_read_b128 a[144:147],v0 offset:6144
v_cvt_pk_bf16_f32 v85,v86,v87
ds_read_b128 a[148:151],v1 offset:6144
v_cvt_pk_bf16_f32 v81,v82,v83
ds_write2st64_b64 v38,v[80:81],v[84:85] offset0:36 offset1:40
v_add_u32 v38,v38,v19
v_cvt_pk_bf16_f32 v105,v106,v107
v_cvt_pk_bf16_f32 v109,v110,v111
v_cvt_pk_bf16_f32 v208,v208,v209
v_cvt_pk_bf16_f32 v224,v224,v225
v_cvt_pk_bf16_f32 v212,v212,v213
v_cvt_pk_bf16_f32 v228,v228,v229
v_cvt_pk_bf16_f32 v209,v210,v211
v_cvt_pk_bf16_f32 v225,v226,v227
v_cvt_pk_bf16_f32 v216,v216,v217
v_cvt_pk_bf16_f32 v232,v232,v233
ds_write2st64_b64 v39,v[104:105],v[108:109] offset0:36 offset1:40
v_add_u32 v39,v39,v19
v_cvt_pk_bf16_f32 v213,v214,v215
v_cvt_pk_bf16_f32 v229,v230,v231
ds_read_b128 v[72:75],v10 offset:18432
v_cvt_pk_bf16_f32 v220,v220,v221
ds_read_b128 v[76:79],v10 offset:19456
v_cvt_pk_bf16_f32 v236,v236,v237
ds_read_b128 v[88:91],v10 offset:20480
v_cvt_pk_bf16_f32 v217,v218,v219
ds_read_b128 v[92:95],v10 offset:21504
v_cvt_pk_bf16_f32 v233,v234,v235
ds_write2st64_b64 v36,v[208:209],v[224:225] offset0:12 offset1:14
v_cvt_pk_bf16_f32 v240,v240,v241
v_cvt_pk_bf16_f32 v112,v112,v113
v_cvt_pk_bf16_f32 v221,v222,v223
v_cvt_pk_bf16_f32 v237,v238,v239
v_cvt_pk_bf16_f32 v241,v242,v243
v_cvt_pk_bf16_f32 v113,v114,v115
v_mov_b32 v66,0
s_waitcnt lgkmcnt(4)
buffer_store_dwordx4 v[72:75],v9,s[16:19],s87 offen offset:256 nt
v_mov_b32 v67,0
s_add_u32 s69,s69,1
s_lshl_b32 s62,s69,5
v_mfma_f32_16x16x32_bf16 v[72:75],a[120:123],a[0:3],0
s_add_u32 s62,s62,s34
s_mul_i32 s63,s62,171
s_lshr_b32 s63,s63,9
v_mfma_f32_16x16x32_bf16 v[72:75],a[124:127],a[4:7],v[72:75]
s_mul_i32 s64,s63,3
s_sub_u32 s62,s62,s64
s_add_u32 s63,s63,s33
v_mfma_f32_16x16x32_bf16 v[72:75],a[128:131],a[8:11],v[72:75]
s_mul_i32 s30,s63,196608
s_waitcnt lgkmcnt(0)
buffer_store_dwordx4 v[76:79],v9,s[16:19],s87 offen offset:3328 nt
s_mul_i32 s41,s63,325632
s_lshl_b32 s63,s3,2
v_pk_mul_f32 v[244:245],v[244:245],v[62:63] op_sel_hi:[1,0]
v_pk_mul_f32 v[246:247],v[246:247],v[62:63] op_sel_hi:[1,0]
v_pk_mul_f32 v[116:117],v[116:117],v[64:65] op_sel_hi:[1,0]
v_pk_mul_f32 v[118:119],v[118:119],v[64:65] op_sel_hi:[1,0]
v_cvt_pk_bf16_f32 v244,v244,v245
v_cvt_pk_bf16_f32 v116,v116,v117
v_mfma_f32_16x16x32_bf16 v[72:75],a[132:135],a[12:15],v[72:75]
s_add_u32 s64,s63,21
v_cvt_pk_bf16_f32 v245,v246,v247
v_cvt_pk_bf16_f32 v117,v118,v119
v_mfma_f32_16x16x32_bf16 v[72:75],a[136:139],a[16:19],v[72:75]
s_cmp_eq_u32 s3,0
ds_write2st64_b64 v37,v[212:213],v[228:229] offset0:12 offset1:14
v_mfma_f32_16x16x32_bf16 v[72:75],a[140:143],a[20:23],v[72:75]
s_cselect_b32 s64,20,s64
s_cselect_b32 s40,1,0
buffer_store_dwordx4 v[88:91],v9,s[16:19],s66 offen offset:256 nt
v_pk_mul_f32 v[248:249],v[248:249],v[62:63] op_sel_hi:[1,0]
v_pk_mul_f32 v[250:251],v[250:251],v[62:63] op_sel_hi:[1,0]
v_pk_mul_f32 v[120:121],v[120:121],v[64:65] op_sel_hi:[1,0]
v_pk_mul_f32 v[122:123],v[122:123],v[64:65] op_sel_hi:[1,0]
v_cvt_pk_bf16_f32 v248,v248,v249
v_max3_f32 v44,v72,v73,v74
v_mfma_f32_16x16x32_bf16 v[80:83],a[140:143],a[44:47],0
s_add_u32 s65,s63,37
v_cvt_pk_bf16_f32 v120,v120,v121
v_cvt_pk_bf16_f32 v249,v250,v251
v_mfma_f32_16x16x32_bf16 v[80:83],a[136:139],a[40:43],v[80:83]
s_cmp_eq_u32 s62,2
ds_write2st64_b64 v38,v[216:217],v[232:233] offset0:12 offset1:14
v_mfma_f32_16x16x32_bf16 v[80:83],a[132:135],a[36:39],v[80:83]
s_cselect_b32 s64,s65,s64
v_cvt_pk_bf16_f32 v121,v122,v123
buffer_store_dwordx4 v[92:95],v9,s[16:19],s66 offen offset:3328 nt
v_pk_mul_f32 v[252:253],v[252:253],v[62:63] op_sel_hi:[1,0]
v_pk_mul_f32 v[254:255],v[254:255],v[62:63] op_sel_hi:[1,0]
v_pk_mul_f32 v[124:125],v[124:125],v[64:65] op_sel_hi:[1,0]
v_pk_mul_f32 v[126:127],v[126:127],v[64:65] op_sel_hi:[1,0]
v_cvt_pk_bf16_f32 v252,v252,v253
v_cvt_pk_bf16_f32 v124,v124,v125
v_mfma_f32_16x16x32_bf16 v[80:83],a[128:131],a[32:35],v[80:83]
s_cselect_b32 s40,0,s40
v_cvt_pk_bf16_f32 v253,v254,v255
v_cvt_pk_bf16_f32 v125,v126,v127
v_mfma_f32_16x16x32_bf16 v[80:83],a[124:127],a[28:31],v[80:83]
s_add_u32 s65,s63,s3
ds_write2st64_b64 v39,v[220:221],v[236:237] offset0:12 offset1:14
v_mfma_f32_16x16x32_bf16 v[80:83],a[120:123],a[24:27],v[80:83]
s_cmp_eq_u32 s62,0
v_mov_b32 v62,0
v_mov_b32 v63,0
v_mfma_f32_16x16x32_bf16 v[88:91],a[120:123],a[48:51],0
s_cselect_b32 s64,s65,s64
ds_read_b128 a[120:123],v0 offset:6272
s_cselect_b32 s40,1,s40
s_mul_i32 s64,s64,6144
s_add_u32 s41,s41,s64
v_max3_f32 v48,v80,v81,v82
ds_write2st64_b64 v36,v[240:241],v[112:113] offset0:16 offset1:24
v_pk_mul_f32 v[128:129],v[128:129],v[64:65] op_sel_hi:[1,0]
v_pk_mul_f32 v[130:131],v[130:131],v[64:65] op_sel_hi:[1,0]
v_pk_mul_f32 v[144:145],v[144:145],v[64:65] op_sel_hi:[1,0]
v_pk_mul_f32 v[146:147],v[146:147],v[64:65] op_sel_hi:[1,0]
v_cvt_pk_bf16_f32 v128,v128,v129
v_cvt_pk_bf16_f32 v144,v144,v145
v_mfma_f32_16x16x32_bf16 v[88:91],a[124:127],a[52:55],v[88:91]
s_cmp_ge_u32 s69,6
ds_read_b128 a[124:127],v1 offset:6272
v_cvt_pk_bf16_f32 v129,v130,v131
v_mfma_f32_16x16x32_bf16 v[88:91],a[128:131],a[56:59],v[88:91]
s_cselect_b32 s41,166723584,s41
ds_read_b128 a[128:131],v0 offset:6400
v_cvt_pk_bf16_f32 v145,v146,v147
v_mfma_f32_16x16x32_bf16 v[88:91],a[132:135],a[60:63],v[88:91]
s_cselect_b32 s30,100663296,s30
ds_write2st64_b64 v37,v[244:245],v[116:117] offset0:16 offset1:24
v_pk_mul_f32 v[132:133],v[132:133],v[64:65] op_sel_hi:[1,0]
v_pk_mul_f32 v[134:135],v[134:135],v[64:65] op_sel_hi:[1,0]
v_pk_mul_f32 v[148:149],v[148:149],v[64:65] op_sel_hi:[1,0]
ds_read_b128 a[132:135],v1 offset:6400
v_pk_mul_f32 v[150:151],v[150:151],v[64:65] op_sel_hi:[1,0]
v_cvt_pk_bf16_f32 v132,v132,v133
v_cvt_pk_bf16_f32 v148,v148,v149
v_mfma_f32_16x16x32_bf16 v[88:91],a[136:139],a[64:67],v[88:91]
s_add_u32 s25,s30,s22
ds_read_b128 a[136:139],v0 offset:0
v_cvt_pk_bf16_f32 v133,v134,v135
v_mfma_f32_16x16x32_bf16 v[88:91],a[140:143],a[68:71],v[88:91]
s_add_u32 s26,s25,12288
ds_write2st64_b64 v38,v[248:249],v[120:121] offset0:16 offset1:24
v_mfma_f32_16x16x32_bf16 v[76:79],a[144:147],a[0:3],0
s_add_u32 m0,s23,24576
v_cvt_pk_bf16_f32 v149,v150,v151
ds_read_b128 a[140:143],v1 offset:0
s_mov_b32 s28,s41
v_pk_mul_f32 v[136:137],v[136:137],v[64:65] op_sel_hi:[1,0]
v_pk_mul_f32 v[138:139],v[138:139],v[64:65] op_sel_hi:[1,0]
v_pk_mul_f32 v[152:153],v[152:153],v[64:65] op_sel_hi:[1,0]
v_pk_mul_f32 v[154:155],v[154:155],v[64:65] op_sel_hi:[1,0]
v_max3_f32 v52,v88,v89,v90
v_cvt_pk_bf16_f32 v136,v136,v137
v_mfma_f32_16x16x32_bf16 v[76:79],a[148:151],a[4:7],v[76:79]
s_mov_b32 s29,s24
ds_write2st64_b64 v39,v[252:253],v[124:125] offset0:16 offset1:24
s_waitcnt lgkmcnt(4)
v_mfma_f32_16x16x32_bf16 v[76:79],a[120:123],a[8:11],v[76:79]
v_cvt_pk_bf16_f32 v152,v152,v153
v_cvt_pk_bf16_f32 v137,v138,v139
v_mfma_f32_16x16x32_bf16 v[76:79],a[124:127],a[12:15],v[76:79]
v_cvt_pk_bf16_f32 v153,v154,v155
v_pk_mul_f32 v[140:141],v[140:141],v[64:65] op_sel_hi:[1,0]
ds_write2st64_b64 v36,v[128:129],v[144:145] offset0:26 offset1:28
v_pk_mul_f32 v[142:143],v[142:143],v[64:65] op_sel_hi:[1,0]
v_pk_mul_f32 v[156:157],v[156:157],v[64:65] op_sel_hi:[1,0]
v_pk_mul_f32 v[158:159],v[158:159],v[64:65] op_sel_hi:[1,0]
v_cvt_pk_bf16_f32 v140,v140,v141
v_cvt_pk_bf16_f32 v156,v156,v157
v_mfma_f32_16x16x32_bf16 v[76:79],a[128:131],a[16:19],v[76:79]
v_cvt_pk_bf16_f32 v141,v142,v143
v_cvt_pk_bf16_f32 v157,v158,v159
v_mfma_f32_16x16x32_bf16 v[76:79],a[132:135],a[20:23],v[76:79]
v_mov_b32 v64,0
v_mov_b32 v65,0
v_mfma_f32_16x16x32_bf16 v[84:87],a[132:135],a[44:47],0
ds_write2st64_b64 v37,v[132:133],v[148:149] offset0:26 offset1:28
v_pk_mul_f32 v[160:161],v[160:161],v[60:61] op_sel_hi:[1,0]
v_pk_mul_f32 v[162:163],v[162:163],v[60:61] op_sel_hi:[1,0]
v_pk_mul_f32 v[176:177],v[176:177],v[60:61] op_sel_hi:[1,0]
v_pk_mul_f32 v[178:179],v[178:179],v[60:61] op_sel_hi:[1,0]
v_max3_f32 v44,v44,v75,v76
v_max3_f32 v44,v44,v77,v78
v_mfma_f32_16x16x32_bf16 v[84:87],a[128:131],a[40:43],v[84:87]
v_max_f32 v44,v44,v79
v_mov_b32 v45,v44
v_mfma_f32_16x16x32_bf16 v[84:87],a[124:127],a[36:39],v[84:87]
v_cvt_pk_bf16_f32 v160,v160,v161
v_permlane32_swap_b32 v45,v44
v_mfma_f32_16x16x32_bf16 v[84:87],a[120:123],a[32:35],v[84:87]
ds_write2st64_b64 v38,v[136:137],v[152:153] offset0:26 offset1:28
v_mfma_f32_16x16x32_bf16 v[84:87],a[148:151],a[28:31],v[84:87]
v_max_f32 v44,v44,v45
v_mov_b32 v45,v44
v_cvt_pk_bf16_f32 v176,v176,v177
v_cvt_pk_bf16_f32 v161,v162,v163
v_permlane16_swap_b32 v45,v44
v_pk_mul_f32 v[164:165],v[164:165],v[60:61] op_sel_hi:[1,0]
v_pk_mul_f32 v[166:167],v[166:167],v[60:61] op_sel_hi:[1,0]
v_pk_mul_f32 v[180:181],v[180:181],v[60:61] op_sel_hi:[1,0]
ds_write2st64_b64 v39,v[140:141],v[156:157] offset0:26 offset1:28
v_pk_mul_f32 v[182:183],v[182:183],v[60:61] op_sel_hi:[1,0]
v_max_f32 v44,v44,v45
v_mul_f32_e64 v13,-s36,v44
v_mfma_f32_16x16x32_bf16 v[84:87],a[144:147],a[24:27],v[84:87]
buffer_load_dwordx4 v6,s[8:11],s21 offen offset:0 lds
v_mfma_f32_16x16x32_bf16 v[92:95],a[144:147],a[48:51],0
ds_read_b128 a[144:147],v0 offset:128
v_fma_f32 v72,v72,s36,v13
v_mfma_f32_16x16x32_bf16 v[92:95],a[148:151],a[52:55],v[92:95]
ds_read_b128 a[148:151],v1 offset:128
v_fma_f32 v73,v73,s36,v13
v_fma_f32 v74,v74,s36,v13
v_fma_f32 v75,v75,s36,v13
v_exp_f32 v72,v72
v_pk_mul_f32 v[168:169],v[168:169],v[60:61] op_sel_hi:[1,0]
v_pk_mul_f32 v[170:171],v[170:171],v[60:61] op_sel_hi:[1,0]
v_pk_mul_f32 v[184:185],v[184:185],v[60:61] op_sel_hi:[1,0]
v_pk_mul_f32 v[186:187],v[186:187],v[60:61] op_sel_hi:[1,0]
v_exp_f32 v73,v73
v_exp_f32 v74,v74
v_mfma_f32_16x16x32_bf16 v[92:95],a[120:123],a[56:59],v[92:95]
buffer_load_dwordx4 v7,s[8:11],s21 offen offset:1024 lds
v_mfma_f32_16x16x32_bf16 v[92:95],a[124:127],a[60:63],v[92:95]
ds_read_b128 a[120:123],v0 offset:256
v_exp_f32 v75,v75
v_mfma_f32_16x16x32_bf16 v[92:95],a[128:131],a[64:67],v[92:95]
ds_read_b128 a[124:127],v1 offset:256
v_cvt_pk_bf16_f32 v20,v72,v73
ds_read_b128 a[128:131],v0 offset:6144
v_pk_mul_f32 v[172:173],v[172:173],v[60:61] op_sel_hi:[1,0]
v_pk_mul_f32 v[174:175],v[174:175],v[60:61] op_sel_hi:[1,0]
v_pk_mul_f32 v[188:189],v[188:189],v[60:61] op_sel_hi:[1,0]
v_pk_mul_f32 v[190:191],v[190:191],v[60:61] op_sel_hi:[1,0]
v_cvt_pk_bf16_f32 v21,v74,v75
v_max3_f32 v48,v48,v83,v84
v_mfma_f32_16x16x32_bf16 v[92:95],a[132:135],a[68:71],v[92:95]
s_waitcnt lgkmcnt(3)
ds_read_b128 a[132:135],v1 offset:6144
v_max3_f32 v48,v48,v85,v86
v_mfma_f32_16x16x32_bf16 v[96:99],a[136:139],a[72:75],0
ds_read_b128 a[136:139],v0 offset:6272
v_max_f32 v48,v48,v87
v_mfma_f32_16x16x32_bf16 v[96:99],a[140:143],a[76:79],v[96:99]
ds_read_b128 a[140:143],v1 offset:6272
buffer_load_dwordx4 v8,s[8:11],s21 offen offset:2048 lds
v_mov_b32 v49,v48
v_pk_mul_f32 v[192:193],v[192:193],v[60:61] op_sel_hi:[1,0]
v_pk_mul_f32 v[194:195],v[194:195],v[60:61] op_sel_hi:[1,0]
v_permlane32_swap_b32 v49,v48
v_max_f32 v48,v48,v49
v_mfma_f32_16x16x32_bf16 v[96:99],a[144:147],a[80:83],v[96:99]
s_add_u32 s21,s21,12288
ds_read_b128 a[144:147],v0 offset:6400
v_mov_b32 v49,v48
v_mfma_f32_16x16x32_bf16 v[96:99],a[148:151],a[84:87],v[96:99]
s_add_u32 m0,s22,0
ds_read_b128 a[148:151],v1 offset:6400
v_permlane16_swap_b32 v49,v48
s_waitcnt lgkmcnt(5)
v_mfma_f32_16x16x32_bf16 v[96:99],a[120:123],a[88:91],v[96:99]
ds_read_b128 a[120:123],v0 offset:12544
v_max_f32 v48,v48,v49
v_mfma_f32_16x16x32_bf16 v[96:99],a[124:127],a[92:95],v[96:99]
ds_read_b128 a[124:127],v1 offset:12544
v_mul_f32_e64 v14,-s36,v48
v_fma_f32 v80,v80,s36,v14
v_fma_f32 v81,v81,s36,v14
v_fma_f32 v82,v82,s36,v14
v_pk_mul_f32 v[196:197],v[196:197],v[60:61] op_sel_hi:[1,0]
v_pk_mul_f32 v[198:199],v[198:199],v[60:61] op_sel_hi:[1,0]
v_fma_f32 v83,v83,s36,v14
v_exp_f32 v80,v80
v_mfma_f32_16x16x32_bf16 v[100:103],a[128:131],a[72:75],0
s_waitcnt lgkmcnt(4)
ds_read_b128 a[128:131],v0 offset:18432
v_exp_f32 v81,v81
v_mfma_f32_16x16x32_bf16 v[100:103],a[132:135],a[76:79],v[100:103]
ds_read_b128 a[132:135],v1 offset:18432
v_exp_f32 v82,v82
v_mfma_f32_16x16x32_bf16 v[100:103],a[136:139],a[80:83],v[100:103]
ds_read_b128 a[136:139],v0 offset:12288
v_exp_f32 v83,v83
v_cvt_pk_bf16_f32 v24,v80,v81
v_cvt_pk_bf16_f32 v25,v82,v83
v_pk_mul_f32 v[200:201],v[200:201],v[60:61] op_sel_hi:[1,0]
v_pk_mul_f32 v[202:203],v[202:203],v[60:61] op_sel_hi:[1,0]
v_max3_f32 v52,v52,v91,v92
v_max3_f32 v52,v52,v93,v94
v_mfma_f32_16x16x32_bf16 v[100:103],a[140:143],a[84:87],v[100:103]
s_waitcnt lgkmcnt(3)
ds_read_b128 a[140:143],v1 offset:12288
v_max_f32 v52,v52,v95
v_mfma_f32_16x16x32_bf16 v[100:103],a[144:147],a[88:91],v[100:103]
ds_read_b128 a[144:147],v0 offset:12416
v_mov_b32 v53,v52
v_mfma_f32_16x16x32_bf16 v[100:103],a[148:151],a[92:95],v[100:103]
ds_read_b128 a[148:151],v1 offset:12416
v_permlane32_swap_b32 v53,v52
v_max_f32 v52,v52,v53
v_mov_b32 v53,v52
v_pk_mul_f32 v[204:205],v[204:205],v[60:61] op_sel_hi:[1,0]
v_pk_mul_f32 v[206:207],v[206:207],v[60:61] op_sel_hi:[1,0]
v_permlane16_swap_b32 v53,v52
v_max_f32 v52,v52,v53
v_mfma_f32_16x16x32_bf16 v[72:75],a[124:127],a[20:23],0
v_mul_f32_e64 v15,-s36,v52
v_fma_f32 v88,v88,s36,v15
v_mfma_f32_16x16x32_bf16 v[72:75],a[120:123],a[16:19],v[72:75]
v_fma_f32 v89,v89,s36,v15
v_fma_f32 v90,v90,s36,v15
v_fma_f32 v91,v91,s36,v15
v_exp_f32 v88,v88
v_exp_f32 v89,v89
v_exp_f32 v90,v90
v_exp_f32 v91,v91
v_cvt_pk_bf16_f32 v28,v88,v89
v_cvt_pk_bf16_f32 v29,v90,v91
v_max3_f32 v56,v96,v97,v98
s_waitcnt lgkmcnt(0)
v_mfma_f32_16x16x32_bf16 v[72:75],a[148:151],a[12:15],v[72:75]
v_max3_f32 v56,v56,v99,v100
v_max3_f32 v56,v56,v101,v102
v_mfma_f32_16x16x32_bf16 v[72:75],a[144:147],a[8:11],v[72:75]
v_max_f32 v56,v56,v103
v_mov_b32 v57,v56
v_mfma_f32_16x16x32_bf16 v[72:75],a[140:143],a[4:7],v[72:75]
v_fma_f32 v76,v76,s36,v13
v_permlane32_swap_b32 v57,v56
v_mfma_f32_16x16x32_bf16 v[72:75],a[136:139],a[0:3],v[72:75]
v_max_f32 v56,v56,v57
v_mov_b32 v57,v56
v_mfma_f32_16x16x32_bf16 v[80:83],a[136:139],a[24:27],0
v_fma_f32 v77,v77,s36,v13
v_permlane16_swap_b32 v57,v56
v_mfma_f32_16x16x32_bf16 v[80:83],a[140:143],a[28:31],v[80:83]
v_max_f32 v56,v56,v57
v_mul_f32_e64 v16,-s36,v56
v_mfma_f32_16x16x32_bf16 v[80:83],a[144:147],a[32:35],v[80:83]
v_fma_f32 v96,v96,s36,v16
v_fma_f32 v97,v97,s36,v16
v_mfma_f32_16x16x32_bf16 v[80:83],a[148:151],a[36:39],v[80:83]
v_fma_f32 v98,v98,s36,v16
v_fma_f32 v99,v99,s36,v16
v_mfma_f32_16x16x32_bf16 v[80:83],a[120:123],a[40:43],v[80:83]
v_exp_f32 v96,v96
v_mfma_f32_16x16x32_bf16 v[80:83],a[124:127],a[44:47],v[80:83]
v_exp_f32 v97,v97
v_mfma_f32_16x16x32_bf16 v[88:91],a[124:127],a[68:71],0
v_exp_f32 v98,v98
v_mfma_f32_16x16x32_bf16 v[88:91],a[120:123],a[64:67],v[88:91]
v_exp_f32 v99,v99
v_mfma_f32_16x16x32_bf16 v[88:91],a[148:151],a[60:63],v[88:91]
v_cvt_pk_bf16_f32 v32,v96,v97
v_cvt_pk_bf16_f32 v33,v98,v99
v_mfma_f32_16x16x32_bf16 v[88:91],a[144:147],a[56:59],v[88:91]
v_fma_f32 v78,v78,s36,v13
v_fma_f32 v79,v79,s36,v13
v_mfma_f32_16x16x32_bf16 v[88:91],a[140:143],a[52:55],v[88:91]
v_exp_f32 v76,v76
v_mfma_f32_16x16x32_bf16 v[88:91],a[136:139],a[48:51],v[88:91]
v_exp_f32 v77,v77
v_mfma_f32_16x16x32_bf16 v[96:99],a[136:139],a[72:75],0
ds_read_b128 a[136:139],v0 offset:18560
v_exp_f32 v78,v78
v_mfma_f32_16x16x32_bf16 v[96:99],a[140:143],a[76:79],v[96:99]
ds_read_b128 a[140:143],v1 offset:18560
v_exp_f32 v79,v79
v_mfma_f32_16x16x32_bf16 v[96:99],a[144:147],a[80:83],v[96:99]
ds_read_b128 a[144:147],v0 offset:18688
v_cvt_pk_bf16_f32 v22,v76,v77
v_mfma_f32_16x16x32_bf16 v[96:99],a[148:151],a[84:87],v[96:99]
ds_read_b128 a[148:151],v1 offset:18688
v_cvt_pk_bf16_f32 v23,v78,v79
v_mfma_f32_16x16x32_bf16 v[96:99],a[120:123],a[88:91],v[96:99]
v_fma_f32 v84,v84,s36,v14
v_fma_f32 v85,v85,s36,v14
v_mfma_f32_16x16x32_bf16 v[96:99],a[124:127],a[92:95],v[96:99]
v_fma_f32 v86,v86,s36,v14
v_fma_f32 v87,v87,s36,v14
v_mfma_f32_16x16x32_bf16 v[76:79],a[128:131],a[0:3],0
v_exp_f32 v84,v84
v_mfma_f32_16x16x32_bf16 v[76:79],a[132:135],a[4:7],v[76:79]
s_waitcnt lgkmcnt(3)
v_exp_f32 v85,v85
v_mfma_f32_16x16x32_bf16 v[76:79],a[136:139],a[8:11],v[76:79]
s_waitcnt lgkmcnt(2)
v_exp_f32 v86,v86
v_mfma_f32_16x16x32_bf16 v[76:79],a[140:143],a[12:15],v[76:79]
s_waitcnt lgkmcnt(1)
v_exp_f32 v87,v87
v_mfma_f32_16x16x32_bf16 v[76:79],a[144:147],a[16:19],v[76:79]
s_waitcnt lgkmcnt(0)
v_cvt_pk_bf16_f32 v26,v84,v85
v_cvt_pk_bf16_f32 v27,v86,v87
v_mfma_f32_16x16x32_bf16 v[76:79],a[148:151],a[20:23],v[76:79]
v_fma_f32 v92,v92,s36,v15
v_fma_f32 v93,v93,s36,v15
v_mfma_f32_16x16x32_bf16 v[84:87],a[148:151],a[44:47],0
v_fma_f32 v94,v94,s36,v15
s_waitcnt vmcnt(8)
s_barrier
v_mfma_f32_16x16x32_bf16 v[84:87],a[144:147],a[40:43],v[84:87]
v_fma_f32 v95,v95,s36,v15
v_exp_f32 v92,v92
v_mfma_f32_16x16x32_bf16 v[84:87],a[140:143],a[36:39],v[84:87]
buffer_load_dwordx4 v6,s[4:7],s20 offen offset:0 lds
v_mfma_f32_16x16x32_bf16 v[84:87],a[136:139],a[32:35],v[84:87]
v_exp_f32 v93,v93
v_mfma_f32_16x16x32_bf16 v[84:87],a[132:135],a[28:31],v[84:87]
v_exp_f32 v94,v94
v_mfma_f32_16x16x32_bf16 v[84:87],a[128:131],a[24:27],v[84:87]
v_exp_f32 v95,v95
v_cvt_pk_bf16_f32 v30,v92,v93
v_cvt_pk_bf16_f32 v31,v94,v95
v_mfma_f32_16x16x32_bf16 v[92:95],a[128:131],a[48:51],0
v_fma_f32 v100,v100,s36,v16
v_fma_f32 v101,v101,s36,v16
v_mfma_f32_16x16x32_bf16 v[92:95],a[132:135],a[52:55],v[92:95]
buffer_load_dwordx4 v7,s[4:7],s20 offen offset:1024 lds
v_mfma_f32_16x16x32_bf16 v[92:95],a[136:139],a[56:59],v[92:95]
v_fma_f32 v102,v102,s36,v16
v_fma_f32 v103,v103,s36,v16
v_mfma_f32_16x16x32_bf16 v[92:95],a[140:143],a[60:63],v[92:95]
v_exp_f32 v100,v100
v_mfma_f32_16x16x32_bf16 v[92:95],a[144:147],a[64:67],v[92:95]
ds_read_b64_tr_b16 a[120:121],v2 offset:0
v_exp_f32 v101,v101
v_mfma_f32_16x16x32_bf16 v[92:95],a[148:151],a[68:71],v[92:95]
ds_read_b64_tr_b16 a[122:123],v2 offset:6144
buffer_load_dwordx4 v8,s[4:7],s20 offen offset:2048 lds
ds_read_b64_tr_b16 a[124:125],v3 offset:0
ds_read_b64_tr_b16 a[126:127],v3 offset:6144
v_exp_f32 v102,v102
v_exp_f32 v103,v103
v_cvt_pk_bf16_f32 v34,v100,v101
v_cvt_pk_bf16_f32 v35,v102,v103
v_mfma_f32_16x16x32_bf16 v[100:103],a[148:151],a[92:95],0
s_add_u32 s20,s20,12288
v_cvt_pk_bf16_f32 v177,v178,v179
v_cvt_pk_bf16_f32 v164,v164,v165
v_smfmac_f32_16x16x64_bf16 v[64:67],a[152:155],v[28:35],v18
ds_write2st64_b64 v36,v[160:161],v[176:177] offset0:0 offset1:2
v_mfma_f32_16x16x32_bf16 v[100:103],a[144:147],a[88:91],v[100:103]
v_cvt_pk_bf16_f32 v180,v180,v181
v_cvt_pk_bf16_f32 v168,v168,v169
v_mfma_f32_16x16x32_bf16 v[100:103],a[140:143],a[84:87],v[100:103]
v_cvt_pk_bf16_f32 v184,v184,v185
v_cvt_pk_bf16_f32 v165,v166,v167
v_mfma_f32_16x16x32_bf16 v[100:103],a[136:139],a[80:83],v[100:103]
v_cvt_pk_bf16_f32 v181,v182,v183
v_cvt_pk_bf16_f32 v172,v172,v173
v_mfma_f32_16x16x32_bf16 v[100:103],a[132:135],a[76:79],v[100:103]
ds_write2st64_b64 v37,v[164:165],v[180:181] offset0:0 offset1:2
v_mfma_f32_16x16x32_bf16 v[100:103],a[128:131],a[72:75],v[100:103]
v_cvt_pk_bf16_f32 v188,v188,v189
ds_read_b64_tr_b16 a[128:129],v4 offset:0
ds_read_b64_tr_b16 a[130:131],v4 offset:6144
ds_read_b64_tr_b16 a[132:133],v5 offset:0
ds_read_b64_tr_b16 a[134:135],v5 offset:6144
v_mov_b32 v60,0
v_mov_b32 v61,0
v_cvt_pk_bf16_f32 v169,v170,v171
v_cvt_pk_bf16_f32 v185,v186,v187
v_smfmac_f32_16x16x64_bf16 v[60:63],a[152:155],v[20:27],v18
ds_write2st64_b64 v38,v[168:169],v[184:185] offset0:0 offset1:2
v_cvt_pk_bf16_f32 v192,v192,v193
v_cvt_pk_bf16_f32 v173,v174,v175
v_cvt_pk_bf16_f32 v189,v190,v191
v_cvt_pk_bf16_f32 v196,v196,v197
v_fma_f32 v72,v72,s36,v13
v_fma_f32 v73,v73,s36,v13
v_fma_f32 v74,v74,s36,v13
v_fma_f32 v75,v75,s36,v13
v_fma_f32 v80,v80,s36,v14
v_fma_f32 v81,v81,s36,v14
v_cvt_pk_bf16_f32 v193,v194,v195
ds_write2st64_b64 v39,v[172:173],v[188:189] offset0:0 offset1:2
v_cvt_pk_bf16_f32 v200,v200,v201
v_cvt_pk_bf16_f32 v197,v198,v199
v_exp_f32 v72,v72
v_exp_f32 v73,v73
v_exp_f32 v74,v74
v_exp_f32 v75,v75
v_exp_f32 v80,v80
ds_write_b64 v36,v[192:193] offset:2048
v_exp_f32 v81,v81
v_cvt_pk_bf16_f32 v204,v204,v205
v_cvt_pk_bf16_f32 v201,v202,v203
ds_write_b64 v37,v[196:197] offset:2048
v_cvt_pk_bf16_f32 v205,v206,v207
v_cvt_pk_bf16_f32 v44,v72,v73
v_cvt_pk_bf16_f32 v45,v74,v75
v_cvt_pk_bf16_f32 v48,v80,v81
ds_write_b64 v38,v[200:201] offset:2048
ds_write_b64 v39,v[204:205] offset:2048
s_waitcnt lgkmcnt(3)
v_mfma_f32_16x16x32_bf16 v[160:163],a[120:123],v[20:23],0
s_add_u32 m0,s23,0
ds_read_b64_tr_b16 a[136:137],v2 offset:128
v_fma_f32 v82,v82,s36,v14
v_mfma_f32_16x16x32_bf16 v[164:167],a[124:127],v[20:23],0
ds_read_b64_tr_b16 a[138:139],v2 offset:6272
v_fma_f32 v83,v83,s36,v14
v_mfma_f32_16x16x32_bf16 v[212:215],a[124:127],v[24:27],0
ds_read_b64_tr_b16 a[140:141],v3 offset:128
v_fma_f32 v88,v88,s36,v15
v_mfma_f32_16x16x32_bf16 v[208:211],a[120:123],v[24:27],0
ds_read_b64_tr_b16 a[142:143],v3 offset:6272
v_fma_f32 v89,v89,s36,v15
v_mfma_f32_16x16x32_bf16 v[112:115],a[120:123],v[28:31],0
ds_read_b64_tr_b16 a[144:145],v4 offset:128
v_fma_f32 v90,v90,s36,v15
v_mfma_f32_16x16x32_bf16 v[116:119],a[124:127],v[28:31],0
ds_read_b64_tr_b16 a[146:147],v4 offset:6272
v_fma_f32 v91,v91,s36,v15
v_mfma_f32_16x16x32_bf16 a[164:167],a[124:127],v[32:35],0
ds_read_b64_tr_b16 a[148:149],v5 offset:128
v_fma_f32 v96,v96,s36,v16
v_mfma_f32_16x16x32_bf16 a[160:163],a[120:123],v[32:35],0
ds_read_b64_tr_b16 a[150:151],v5 offset:6272
v_fma_f32 v97,v97,s36,v16
v_mfma_f32_16x16x32_bf16 a[168:171],a[128:131],v[32:35],0
ds_read_b64_tr_b16 a[120:121],v2 offset:256
v_fma_f32 v98,v98,s36,v16
v_mfma_f32_16x16x32_bf16 a[172:175],a[132:135],v[32:35],0
ds_read_b64_tr_b16 a[122:123],v2 offset:6400
v_fma_f32 v99,v99,s36,v16
v_mfma_f32_16x16x32_bf16 v[124:127],a[132:135],v[28:31],0
ds_read_b64_tr_b16 a[124:125],v3 offset:256
v_fma_f32 v76,v76,s36,v13
v_mfma_f32_16x16x32_bf16 v[120:123],a[128:131],v[28:31],0
ds_read_b64_tr_b16 a[126:127],v3 offset:6400
v_fma_f32 v77,v77,s36,v13
v_mfma_f32_16x16x32_bf16 v[216:219],a[128:131],v[24:27],0
v_exp_f32 v82,v82
v_mfma_f32_16x16x32_bf16 v[220:223],a[132:135],v[24:27],0
v_exp_f32 v83,v83
v_mfma_f32_16x16x32_bf16 v[172:175],a[132:135],v[20:23],0
ds_read_b64_tr_b16 a[132:133],v5 offset:256
v_cvt_pk_bf16_f32 v49,v82,v83
v_mfma_f32_16x16x32_bf16 v[168:171],a[128:131],v[20:23],0
s_waitcnt lgkmcnt(4)
ds_read_b64_tr_b16 a[128:129],v4 offset:256
v_fma_f32 v78,v78,s36,v13
v_mfma_f32_16x16x32_bf16 v[176:179],a[136:139],v[20:23],0
ds_read_b64_tr_b16 a[130:131],v4 offset:6400
v_fma_f32 v79,v79,s36,v13
v_mfma_f32_16x16x32_bf16 v[180:183],a[140:143],v[20:23],0
ds_read_b64_tr_b16 a[134:135],v5 offset:6400
v_fma_f32 v84,v84,s36,v14
v_mfma_f32_16x16x32_bf16 v[228:231],a[140:143],v[24:27],0
v_exp_f32 v88,v88
v_mfma_f32_16x16x32_bf16 v[224:227],a[136:139],v[24:27],0
v_exp_f32 v89,v89
v_mfma_f32_16x16x32_bf16 v[128:131],a[136:139],v[28:31],0
v_exp_f32 v90,v90
v_mfma_f32_16x16x32_bf16 v[132:135],a[140:143],v[28:31],0
v_exp_f32 v91,v91
v_mfma_f32_16x16x32_bf16 a[180:183],a[140:143],v[32:35],0
v_cvt_pk_bf16_f32 v52,v88,v89
v_cvt_pk_bf16_f32 v53,v90,v91
v_mfma_f32_16x16x32_bf16 a[176:179],a[136:139],v[32:35],0
v_exp_f32 v96,v96
v_mfma_f32_16x16x32_bf16 a[184:187],a[144:147],v[32:35],0
v_exp_f32 v97,v97
v_mfma_f32_16x16x32_bf16 a[188:191],a[148:151],v[32:35],0
v_exp_f32 v98,v98
v_mfma_f32_16x16x32_bf16 v[140:143],a[148:151],v[28:31],0
v_exp_f32 v99,v99
v_mfma_f32_16x16x32_bf16 v[136:139],a[144:147],v[28:31],0
v_cvt_pk_bf16_f32 v56,v96,v97
v_cvt_pk_bf16_f32 v57,v98,v99
v_mfma_f32_16x16x32_bf16 v[232:235],a[144:147],v[24:27],0
v_exp_f32 v76,v76
v_mfma_f32_16x16x32_bf16 v[236:239],a[148:151],v[24:27],0
v_exp_f32 v77,v77
v_mfma_f32_16x16x32_bf16 v[188:191],a[148:151],v[20:23],0
v_exp_f32 v78,v78
v_mfma_f32_16x16x32_bf16 v[184:187],a[144:147],v[20:23],0
s_waitcnt lgkmcnt(0)
v_exp_f32 v79,v79
v_mfma_f32_16x16x32_bf16 v[192:195],a[120:123],v[20:23],0
v_cvt_pk_bf16_f32 v46,v76,v77
v_cvt_pk_bf16_f32 v47,v78,v79
v_mfma_f32_16x16x32_bf16 v[196:199],a[124:127],v[20:23],0
s_waitcnt vmcnt(30)
v_fma_f32 v85,v85,s36,v14
v_fma_f32 v86,v86,s36,v14
v_mfma_f32_16x16x32_bf16 v[244:247],a[124:127],v[24:27],0
s_barrier
v_mfma_f32_16x16x32_bf16 v[240:243],a[120:123],v[24:27],0
ds_read_b128 a[148:151],v1 offset:24704
v_fma_f32 v87,v87,s36,v14
v_mfma_f32_16x16x32_bf16 v[144:147],a[120:123],v[28:31],0
ds_read_b128 a[144:147],v0 offset:24704
v_fma_f32 v92,v92,s36,v15
v_mfma_f32_16x16x32_bf16 v[148:151],a[124:127],v[28:31],0
ds_read_b128 a[140:143],v1 offset:24576
v_fma_f32 v93,v93,s36,v15
v_mfma_f32_16x16x32_bf16 a[196:199],a[124:127],v[32:35],0
ds_read_b128 a[124:127],v1 offset:24832
v_fma_f32 v94,v94,s36,v15
v_mfma_f32_16x16x32_bf16 a[192:195],a[120:123],v[32:35],0
ds_read_b128 a[120:123],v0 offset:24832
v_fma_f32 v95,v95,s36,v15
v_mfma_f32_16x16x32_bf16 a[200:203],a[128:131],v[32:35],0
buffer_load_dwordx4 v6,s[8:11],s21 offen offset:0 lds
v_mfma_f32_16x16x32_bf16 a[204:207],a[132:135],v[32:35],0
ds_read_b128 a[136:139],v0 offset:24576
v_fma_f32 v100,v100,s36,v16
v_mfma_f32_16x16x32_bf16 v[156:159],a[132:135],v[28:31],0
v_exp_f32 v84,v84
v_mfma_f32_16x16x32_bf16 v[152:155],a[128:131],v[28:31],0
v_exp_f32 v85,v85
v_mfma_f32_16x16x32_bf16 v[248:251],a[128:131],v[24:27],0
v_exp_f32 v86,v86
v_mfma_f32_16x16x32_bf16 v[252:255],a[132:135],v[24:27],0
v_exp_f32 v87,v87
v_mfma_f32_16x16x32_bf16 v[204:207],a[132:135],v[20:23],0
ds_read_b128 a[132:135],v1 offset:30720
v_cvt_pk_bf16_f32 v50,v84,v85
v_mfma_f32_16x16x32_bf16 v[200:203],a[128:131],v[20:23],0
s_waitcnt lgkmcnt(2)
ds_read_b128 a[128:131],v0 offset:30720
v_cvt_pk_bf16_f32 v51,v86,v87
v_mfma_f32_16x16x32_bf16 v[72:75],a[124:127],a[20:23],0
v_exp_f32 v92,v92
v_smfmac_f32_16x16x64_bf16 v[60:63],a[152:155],v[44:51],v18
buffer_load_dwordx4 v7,s[8:11],s21 offen offset:1024 lds
v_mfma_f32_16x16x32_bf16 v[72:75],a[120:123],a[16:19],v[72:75]
v_exp_f32 v93,v93
v_mfma_f32_16x16x32_bf16 v[72:75],a[148:151],a[12:15],v[72:75]
v_exp_f32 v94,v94
v_mfma_f32_16x16x32_bf16 v[72:75],a[144:147],a[8:11],v[72:75]
v_exp_f32 v95,v95
v_mfma_f32_16x16x32_bf16 v[72:75],a[140:143],a[4:7],v[72:75]
s_waitcnt lgkmcnt(1)
v_cvt_pk_bf16_f32 v54,v92,v93
v_cvt_pk_bf16_f32 v55,v94,v95
v_mfma_f32_16x16x32_bf16 v[72:75],a[136:139],a[0:3],v[72:75]
v_fma_f32 v101,v101,s36,v16
v_fma_f32 v102,v102,s36,v16
v_mfma_f32_16x16x32_bf16 v[80:83],a[136:139],a[24:27],0
v_fma_f32 v103,v103,s36,v16
v_mfma_f32_16x16x32_bf16 v[80:83],a[140:143],a[28:31],v[80:83]
v_exp_f32 v100,v100
v_mfma_f32_16x16x32_bf16 v[80:83],a[144:147],a[32:35],v[80:83]
buffer_load_dwordx4 v8,s[8:11],s21 offen offset:2048 lds
v_mfma_f32_16x16x32_bf16 v[80:83],a[148:151],a[36:39],v[80:83]
s_add_u32 s21,s21,12288
v_exp_f32 v101,v101
v_mfma_f32_16x16x32_bf16 v[80:83],a[120:123],a[40:43],v[80:83]
s_add_u32 m0,s22,12288
v_exp_f32 v102,v102
v_mfma_f32_16x16x32_bf16 v[80:83],a[124:127],a[44:47],v[80:83]
v_exp_f32 v103,v103
v_mfma_f32_16x16x32_bf16 v[88:91],a[124:127],a[68:71],0
v_cvt_pk_bf16_f32 v58,v100,v101
v_cvt_pk_bf16_f32 v59,v102,v103
v_mfma_f32_16x16x32_bf16 v[88:91],a[120:123],a[64:67],v[88:91]
v_fma_f32 v72,v72,s36,v13
v_fma_f32 v73,v73,s36,v13
v_smfmac_f32_16x16x64_bf16 v[64:67],a[152:155],v[52:59],v18
v_fma_f32 v74,v74,s36,v13
v_mfma_f32_16x16x32_bf16 v[88:91],a[148:151],a[60:63],v[88:91]
v_fma_f32 v75,v75,s36,v13
v_fma_f32 v80,v80,s36,v14
v_mfma_f32_16x16x32_bf16 v[88:91],a[144:147],a[56:59],v[88:91]
v_fma_f32 v81,v81,s36,v14
v_mfma_f32_16x16x32_bf16 v[88:91],a[140:143],a[52:55],v[88:91]
buffer_load_dwordx4 v6,s[4:7],s20 offen offset:0 lds
v_mfma_f32_16x16x32_bf16 v[88:91],a[136:139],a[48:51],v[88:91]
v_exp_f32 v72,v72
v_mfma_f32_16x16x32_bf16 v[96:99],a[136:139],a[72:75],0
ds_read_b128 a[136:139],v0 offset:30848
v_mfma_f32_16x16x32_bf16 v[96:99],a[140:143],a[76:79],v[96:99]
ds_read_b128 a[140:143],v1 offset:30848
v_mfma_f32_16x16x32_bf16 v[96:99],a[144:147],a[80:83],v[96:99]
ds_read_b128 a[144:147],v0 offset:30976
v_mfma_f32_16x16x32_bf16 v[96:99],a[148:151],a[84:87],v[96:99]
ds_read_b128 a[148:151],v1 offset:30976
v_mfma_f32_16x16x32_bf16 v[96:99],a[120:123],a[88:91],v[96:99]
v_exp_f32 v73,v73
v_mfma_f32_16x16x32_bf16 v[96:99],a[124:127],a[92:95],v[96:99]
s_waitcnt lgkmcnt(4)
v_exp_f32 v74,v74
v_mfma_f32_16x16x32_bf16 v[76:79],a[128:131],a[0:3],0
v_exp_f32 v75,v75
v_mfma_f32_16x16x32_bf16 v[76:79],a[132:135],a[4:7],v[76:79]
buffer_load_dwordx4 v7,s[4:7],s20 offen offset:1024 lds
s_waitcnt lgkmcnt(3)
v_mfma_f32_16x16x32_bf16 v[76:79],a[136:139],a[8:11],v[76:79]
s_waitcnt lgkmcnt(2)
v_exp_f32 v80,v80
v_mfma_f32_16x16x32_bf16 v[76:79],a[140:143],a[12:15],v[76:79]
s_waitcnt lgkmcnt(0)
v_exp_f32 v81,v81
v_mfma_f32_16x16x32_bf16 v[76:79],a[144:147],a[16:19],v[76:79]
v_cvt_pk_bf16_f32 v20,v72,v73
v_cvt_pk_bf16_f32 v21,v74,v75
v_mfma_f32_16x16x32_bf16 v[76:79],a[148:151],a[20:23],v[76:79]
v_cvt_pk_bf16_f32 v24,v80,v81
v_mfma_f32_16x16x32_bf16 v[84:87],a[148:151],a[44:47],0
v_mfma_f32_16x16x32_bf16 v[84:87],a[144:147],a[40:43],v[84:87]
v_mfma_f32_16x16x32_bf16 v[84:87],a[140:143],a[36:39],v[84:87]
v_mfma_f32_16x16x32_bf16 v[84:87],a[136:139],a[32:35],v[84:87]
v_mfma_f32_16x16x32_bf16 v[84:87],a[132:135],a[28:31],v[84:87]
buffer_load_dwordx4 v8,s[4:7],s20 offen offset:2048 lds
v_mfma_f32_16x16x32_bf16 v[84:87],a[128:131],a[24:27],v[84:87]
s_add_u32 s20,s20,12288
v_mfma_f32_16x16x32_bf16 v[92:95],a[128:131],a[48:51],0
ds_read_b64_tr_b16 a[120:121],v2 offset:12288
v_mfma_f32_16x16x32_bf16 v[92:95],a[132:135],a[52:55],v[92:95]
ds_read_b64_tr_b16 a[122:123],v2 offset:18432
v_mfma_f32_16x16x32_bf16 v[92:95],a[136:139],a[56:59],v[92:95]
ds_read_b64_tr_b16 a[124:125],v3 offset:12288
v_mfma_f32_16x16x32_bf16 v[92:95],a[140:143],a[60:63],v[92:95]
ds_read_b64_tr_b16 a[126:127],v3 offset:18432
v_mfma_f32_16x16x32_bf16 v[92:95],a[144:147],a[64:67],v[92:95]
v_mfma_f32_16x16x32_bf16 v[92:95],a[148:151],a[68:71],v[92:95]
v_mfma_f32_16x16x32_bf16 v[100:103],a[148:151],a[92:95],0
v_mfma_f32_16x16x32_bf16 v[100:103],a[144:147],a[88:91],v[100:103]
v_mfma_f32_16x16x32_bf16 v[100:103],a[140:143],a[84:87],v[100:103]
v_mfma_f32_16x16x32_bf16 v[100:103],a[136:139],a[80:83],v[100:103]
v_mfma_f32_16x16x32_bf16 v[100:103],a[132:135],a[76:79],v[100:103]
ds_read_b64_tr_b16 a[132:133],v5 offset:12288
v_mfma_f32_16x16x32_bf16 v[100:103],a[128:131],a[72:75],v[100:103]
s_waitcnt lgkmcnt(1)
ds_read_b64_tr_b16 a[128:129],v4 offset:12288
ds_read_b64_tr_b16 a[130:131],v4 offset:18432
ds_read_b64_tr_b16 a[134:135],v5 offset:18432
v_mfma_f32_16x16x32_bf16 v[160:163],a[120:123],v[44:47],v[160:163]
s_add_u32 m0,s23,12288
ds_read_b64_tr_b16 a[136:137],v2 offset:12416
v_fma_f32 v82,v82,s36,v14
v_mfma_f32_16x16x32_bf16 v[164:167],a[124:127],v[44:47],v[164:167]
ds_read_b64_tr_b16 a[138:139],v2 offset:18560
v_fma_f32 v83,v83,s36,v14
v_mfma_f32_16x16x32_bf16 v[212:215],a[124:127],v[48:51],v[212:215]
ds_read_b64_tr_b16 a[140:141],v3 offset:12416
v_fma_f32 v88,v88,s36,v15
v_mfma_f32_16x16x32_bf16 v[208:211],a[120:123],v[48:51],v[208:211]
ds_read_b64_tr_b16 a[142:143],v3 offset:18560
v_fma_f32 v89,v89,s36,v15
v_mfma_f32_16x16x32_bf16 v[112:115],a[120:123],v[52:55],v[112:115]
ds_read_b64_tr_b16 a[144:145],v4 offset:12416
v_fma_f32 v90,v90,s36,v15
v_mfma_f32_16x16x32_bf16 v[116:119],a[124:127],v[52:55],v[116:119]
ds_read_b64_tr_b16 a[146:147],v4 offset:18560
v_fma_f32 v91,v91,s36,v15
v_mfma_f32_16x16x32_bf16 a[164:167],a[124:127],v[56:59],a[164:167]
ds_read_b64_tr_b16 a[148:149],v5 offset:12416
v_fma_f32 v96,v96,s36,v16
v_mfma_f32_16x16x32_bf16 a[160:163],a[120:123],v[56:59],a[160:163]
s_waitcnt lgkmcnt(6)
ds_read_b64_tr_b16 a[150:151],v5 offset:18560
v_fma_f32 v97,v97,s36,v16
v_mfma_f32_16x16x32_bf16 a[168:171],a[128:131],v[56:59],a[168:171]
ds_read_b64_tr_b16 a[120:121],v2 offset:12544
v_fma_f32 v98,v98,s36,v16
v_mfma_f32_16x16x32_bf16 a[172:175],a[132:135],v[56:59],a[172:175]
ds_read_b64_tr_b16 a[122:123],v2 offset:18688
v_fma_f32 v99,v99,s36,v16
v_mfma_f32_16x16x32_bf16 v[124:127],a[132:135],v[52:55],v[124:127]
ds_read_b64_tr_b16 a[124:125],v3 offset:12544
v_fma_f32 v76,v76,s36,v13
v_mfma_f32_16x16x32_bf16 v[120:123],a[128:131],v[52:55],v[120:123]
ds_read_b64_tr_b16 a[126:127],v3 offset:18688
v_fma_f32 v77,v77,s36,v13
v_mfma_f32_16x16x32_bf16 v[216:219],a[128:131],v[48:51],v[216:219]
v_exp_f32 v82,v82
v_mfma_f32_16x16x32_bf16 v[220:223],a[132:135],v[48:51],v[220:223]
v_exp_f32 v83,v83
v_mfma_f32_16x16x32_bf16 v[172:175],a[132:135],v[44:47],v[172:175]
ds_read_b64_tr_b16 a[132:133],v5 offset:12544
v_cvt_pk_bf16_f32 v25,v82,v83
v_mfma_f32_16x16x32_bf16 v[168:171],a[128:131],v[44:47],v[168:171]
s_waitcnt lgkmcnt(4)
ds_read_b64_tr_b16 a[128:129],v4 offset:12544
v_fma_f32 v78,v78,s36,v13
v_mfma_f32_16x16x32_bf16 v[176:179],a[136:139],v[44:47],v[176:179]
ds_read_b64_tr_b16 a[130:131],v4 offset:18688
v_fma_f32 v79,v79,s36,v13
v_mfma_f32_16x16x32_bf16 v[180:183],a[140:143],v[44:47],v[180:183]
ds_read_b64_tr_b16 a[134:135],v5 offset:18688
v_fma_f32 v84,v84,s36,v14
v_mfma_f32_16x16x32_bf16 v[228:231],a[140:143],v[48:51],v[228:231]
v_exp_f32 v88,v88
v_mfma_f32_16x16x32_bf16 v[224:227],a[136:139],v[48:51],v[224:227]
v_exp_f32 v89,v89
v_mfma_f32_16x16x32_bf16 v[128:131],a[136:139],v[52:55],v[128:131]
v_exp_f32 v90,v90
v_mfma_f32_16x16x32_bf16 v[132:135],a[140:143],v[52:55],v[132:135]
v_exp_f32 v91,v91
v_mfma_f32_16x16x32_bf16 a[180:183],a[140:143],v[56:59],a[180:183]
v_cvt_pk_bf16_f32 v28,v88,v89
v_cvt_pk_bf16_f32 v29,v90,v91
v_mfma_f32_16x16x32_bf16 a[176:179],a[136:139],v[56:59],a[176:179]
v_exp_f32 v96,v96
v_mfma_f32_16x16x32_bf16 a[184:187],a[144:147],v[56:59],a[184:187]
v_exp_f32 v97,v97
v_mfma_f32_16x16x32_bf16 a[188:191],a[148:151],v[56:59],a[188:191]
v_exp_f32 v98,v98
v_mfma_f32_16x16x32_bf16 v[140:143],a[148:151],v[52:55],v[140:143]
v_exp_f32 v99,v99
v_mfma_f32_16x16x32_bf16 v[136:139],a[144:147],v[52:55],v[136:139]
v_cvt_pk_bf16_f32 v32,v96,v97
v_cvt_pk_bf16_f32 v33,v98,v99
v_mfma_f32_16x16x32_bf16 v[232:235],a[144:147],v[48:51],v[232:235]
v_exp_f32 v76,v76
v_mfma_f32_16x16x32_bf16 v[236:239],a[148:151],v[48:51],v[236:239]
v_exp_f32 v77,v77
v_mfma_f32_16x16x32_bf16 v[188:191],a[148:151],v[44:47],v[188:191]
v_exp_f32 v78,v78
v_mfma_f32_16x16x32_bf16 v[184:187],a[144:147],v[44:47],v[184:187]
s_waitcnt lgkmcnt(0)
v_exp_f32 v79,v79
v_mfma_f32_16x16x32_bf16 v[192:195],a[120:123],v[44:47],v[192:195]
v_cvt_pk_bf16_f32 v22,v76,v77
v_cvt_pk_bf16_f32 v23,v78,v79
v_mfma_f32_16x16x32_bf16 v[196:199],a[124:127],v[44:47],v[196:199]
s_waitcnt vmcnt(6)
v_fma_f32 v85,v85,s36,v14
v_fma_f32 v86,v86,s36,v14
v_mfma_f32_16x16x32_bf16 v[244:247],a[124:127],v[48:51],v[244:247]
s_barrier
v_mfma_f32_16x16x32_bf16 v[240:243],a[120:123],v[48:51],v[240:243]
ds_read_b128 a[148:151],v1 offset:128
v_fma_f32 v87,v87,s36,v14
v_mfma_f32_16x16x32_bf16 v[144:147],a[120:123],v[52:55],v[144:147]
ds_read_b128 a[144:147],v0 offset:128
v_fma_f32 v92,v92,s36,v15
v_mfma_f32_16x16x32_bf16 v[148:151],a[124:127],v[52:55],v[148:151]
ds_read_b128 a[140:143],v1 offset:0
v_fma_f32 v93,v93,s36,v15
v_mfma_f32_16x16x32_bf16 a[196:199],a[124:127],v[56:59],a[196:199]
ds_read_b128 a[124:127],v1 offset:256
v_fma_f32 v94,v94,s36,v15
v_mfma_f32_16x16x32_bf16 a[192:195],a[120:123],v[56:59],a[192:195]
ds_read_b128 a[120:123],v0 offset:256
v_fma_f32 v95,v95,s36,v15
v_mfma_f32_16x16x32_bf16 a[200:203],a[128:131],v[56:59],a[200:203]
buffer_load_dwordx4 v6,s[8:11],s21 offen offset:0 lds
v_mfma_f32_16x16x32_bf16 a[204:207],a[132:135],v[56:59],a[204:207]
ds_read_b128 a[136:139],v0 offset:0
v_fma_f32 v100,v100,s36,v16
v_mfma_f32_16x16x32_bf16 v[156:159],a[132:135],v[52:55],v[156:159]
v_exp_f32 v84,v84
v_mfma_f32_16x16x32_bf16 v[152:155],a[128:131],v[52:55],v[152:155]
v_exp_f32 v85,v85
v_mfma_f32_16x16x32_bf16 v[248:251],a[128:131],v[48:51],v[248:251]
v_exp_f32 v86,v86
v_mfma_f32_16x16x32_bf16 v[252:255],a[132:135],v[48:51],v[252:255]
v_exp_f32 v87,v87
v_mfma_f32_16x16x32_bf16 v[204:207],a[132:135],v[44:47],v[204:207]
ds_read_b128 a[132:135],v1 offset:6144
v_cvt_pk_bf16_f32 v26,v84,v85
v_mfma_f32_16x16x32_bf16 v[200:203],a[128:131],v[44:47],v[200:203]
s_waitcnt lgkmcnt(2)
ds_read_b128 a[128:131],v0 offset:6144
v_cvt_pk_bf16_f32 v27,v86,v87
v_mfma_f32_16x16x32_bf16 v[72:75],a[124:127],a[20:23],0
v_exp_f32 v92,v92
v_smfmac_f32_16x16x64_bf16 v[60:63],a[152:155],v[20:27],v18
buffer_load_dwordx4 v7,s[8:11],s21 offen offset:1024 lds
v_mfma_f32_16x16x32_bf16 v[72:75],a[120:123],a[16:19],v[72:75]
v_exp_f32 v93,v93
v_mfma_f32_16x16x32_bf16 v[72:75],a[148:151],a[12:15],v[72:75]
v_exp_f32 v94,v94
v_mfma_f32_16x16x32_bf16 v[72:75],a[144:147],a[8:11],v[72:75]
v_exp_f32 v95,v95
v_mfma_f32_16x16x32_bf16 v[72:75],a[140:143],a[4:7],v[72:75]
s_waitcnt lgkmcnt(1)
v_cvt_pk_bf16_f32 v30,v92,v93
v_cvt_pk_bf16_f32 v31,v94,v95
v_mfma_f32_16x16x32_bf16 v[72:75],a[136:139],a[0:3],v[72:75]
v_fma_f32 v101,v101,s36,v16
v_fma_f32 v102,v102,s36,v16
v_mfma_f32_16x16x32_bf16 v[80:83],a[136:139],a[24:27],0
v_fma_f32 v103,v103,s36,v16
v_mfma_f32_16x16x32_bf16 v[80:83],a[140:143],a[28:31],v[80:83]
v_exp_f32 v100,v100
v_mfma_f32_16x16x32_bf16 v[80:83],a[144:147],a[32:35],v[80:83]
buffer_load_dwordx4 v8,s[8:11],s21 offen offset:2048 lds
v_mfma_f32_16x16x32_bf16 v[80:83],a[148:151],a[36:39],v[80:83]
s_add_u32 s21,s21,12288
v_exp_f32 v101,v101
v_mfma_f32_16x16x32_bf16 v[80:83],a[120:123],a[40:43],v[80:83]
s_add_u32 m0,s22,24576
v_exp_f32 v102,v102
v_mfma_f32_16x16x32_bf16 v[80:83],a[124:127],a[44:47],v[80:83]
v_exp_f32 v103,v103
v_mfma_f32_16x16x32_bf16 v[88:91],a[124:127],a[68:71],0
v_cvt_pk_bf16_f32 v34,v100,v101
v_cvt_pk_bf16_f32 v35,v102,v103
v_mfma_f32_16x16x32_bf16 v[88:91],a[120:123],a[64:67],v[88:91]
v_fma_f32 v72,v72,s36,v13
v_fma_f32 v73,v73,s36,v13
v_smfmac_f32_16x16x64_bf16 v[64:67],a[152:155],v[28:35],v18
v_fma_f32 v74,v74,s36,v13
v_mfma_f32_16x16x32_bf16 v[88:91],a[148:151],a[60:63],v[88:91]
v_fma_f32 v75,v75,s36,v13
v_fma_f32 v80,v80,s36,v14
v_mfma_f32_16x16x32_bf16 v[88:91],a[144:147],a[56:59],v[88:91]
v_fma_f32 v81,v81,s36,v14
v_mfma_f32_16x16x32_bf16 v[88:91],a[140:143],a[52:55],v[88:91]
buffer_load_dwordx4 v6,s[4:7],s20 offen offset:0 lds
v_mfma_f32_16x16x32_bf16 v[88:91],a[136:139],a[48:51],v[88:91]
v_exp_f32 v72,v72
v_mfma_f32_16x16x32_bf16 v[96:99],a[136:139],a[72:75],0
ds_read_b128 a[136:139],v0 offset:6272
v_mfma_f32_16x16x32_bf16 v[96:99],a[140:143],a[76:79],v[96:99]
ds_read_b128 a[140:143],v1 offset:6272
v_mfma_f32_16x16x32_bf16 v[96:99],a[144:147],a[80:83],v[96:99]
ds_read_b128 a[144:147],v0 offset:6400
v_mfma_f32_16x16x32_bf16 v[96:99],a[148:151],a[84:87],v[96:99]
ds_read_b128 a[148:151],v1 offset:6400
v_mfma_f32_16x16x32_bf16 v[96:99],a[120:123],a[88:91],v[96:99]
v_exp_f32 v73,v73
v_mfma_f32_16x16x32_bf16 v[96:99],a[124:127],a[92:95],v[96:99]
s_waitcnt lgkmcnt(4)
v_exp_f32 v74,v74
v_mfma_f32_16x16x32_bf16 v[76:79],a[128:131],a[0:3],0
v_exp_f32 v75,v75
v_mfma_f32_16x16x32_bf16 v[76:79],a[132:135],a[4:7],v[76:79]
buffer_load_dwordx4 v7,s[4:7],s20 offen offset:1024 lds
s_waitcnt lgkmcnt(3)
v_mfma_f32_16x16x32_bf16 v[76:79],a[136:139],a[8:11],v[76:79]
s_waitcnt lgkmcnt(2)
v_exp_f32 v80,v80
v_mfma_f32_16x16x32_bf16 v[76:79],a[140:143],a[12:15],v[76:79]
s_waitcnt lgkmcnt(0)
v_exp_f32 v81,v81
v_mfma_f32_16x16x32_bf16 v[76:79],a[144:147],a[16:19],v[76:79]
v_cvt_pk_bf16_f32 v44,v72,v73
v_cvt_pk_bf16_f32 v45,v74,v75
v_mfma_f32_16x16x32_bf16 v[76:79],a[148:151],a[20:23],v[76:79]
v_cvt_pk_bf16_f32 v48,v80,v81
v_mfma_f32_16x16x32_bf16 v[84:87],a[148:151],a[44:47],0
v_mfma_f32_16x16x32_bf16 v[84:87],a[144:147],a[40:43],v[84:87]
v_mfma_f32_16x16x32_bf16 v[84:87],a[140:143],a[36:39],v[84:87]
v_mfma_f32_16x16x32_bf16 v[84:87],a[136:139],a[32:35],v[84:87]
v_mfma_f32_16x16x32_bf16 v[84:87],a[132:135],a[28:31],v[84:87]
buffer_load_dwordx4 v8,s[4:7],s20 offen offset:2048 lds
v_mfma_f32_16x16x32_bf16 v[84:87],a[128:131],a[24:27],v[84:87]
s_add_u32 s20,s20,12288
v_mfma_f32_16x16x32_bf16 v[92:95],a[128:131],a[48:51],0
ds_read_b64_tr_b16 a[120:121],v2 offset:24576
v_mfma_f32_16x16x32_bf16 v[92:95],a[132:135],a[52:55],v[92:95]
ds_read_b64_tr_b16 a[122:123],v2 offset:30720
v_mfma_f32_16x16x32_bf16 v[92:95],a[136:139],a[56:59],v[92:95]
ds_read_b64_tr_b16 a[124:125],v3 offset:24576
v_mfma_f32_16x16x32_bf16 v[92:95],a[140:143],a[60:63],v[92:95]
ds_read_b64_tr_b16 a[126:127],v3 offset:30720
v_mfma_f32_16x16x32_bf16 v[92:95],a[144:147],a[64:67],v[92:95]
v_mfma_f32_16x16x32_bf16 v[92:95],a[148:151],a[68:71],v[92:95]
v_mfma_f32_16x16x32_bf16 v[100:103],a[148:151],a[92:95],0
v_mfma_f32_16x16x32_bf16 v[100:103],a[144:147],a[88:91],v[100:103]
v_mfma_f32_16x16x32_bf16 v[100:103],a[140:143],a[84:87],v[100:103]
v_mfma_f32_16x16x32_bf16 v[100:103],a[136:139],a[80:83],v[100:103]
v_mfma_f32_16x16x32_bf16 v[100:103],a[132:135],a[76:79],v[100:103]
ds_read_b64_tr_b16 a[132:133],v5 offset:24576
v_mfma_f32_16x16x32_bf16 v[100:103],a[128:131],a[72:75],v[100:103]
ds_read_b64_tr_b16 a[128:129],v4 offset:24576
ds_read_b64_tr_b16 a[130:131],v4 offset:30720
ds_read_b64_tr_b16 a[134:135],v5 offset:30720
s_mov_b32 s38,0
s_branch L_loop4
L_tr55:
s_waitcnt vmcnt(42)
s_waitcnt lgkmcnt(3)
v_mfma_f32_16x16x32_bf16 v[160:163],a[120:123],v[20:23],v[160:163]
s_add_u32 m0,s24,0
ds_read_b128 a[0:3],v11 offset:0
v_fma_f32 v90,v90,s36,v15
v_mfma_f32_16x16x32_bf16 v[164:167],a[124:127],v[20:23],v[164:167]
ds_read_b128 a[4:7],v12 offset:0
v_fma_f32 v91,v91,s36,v15
v_mfma_f32_16x16x32_bf16 v[212:215],a[124:127],v[24:27],v[212:215]
ds_read_b128 a[8:11],v11 offset:128
v_fma_f32 v96,v96,s36,v16
v_mfma_f32_16x16x32_bf16 v[208:211],a[120:123],v[24:27],v[208:211]
ds_read_b128 a[12:15],v12 offset:128
v_fma_f32 v97,v97,s36,v16
v_mfma_f32_16x16x32_bf16 v[112:115],a[120:123],v[28:31],v[112:115]
ds_read_b128 a[16:19],v11 offset:256
v_fma_f32 v98,v98,s36,v16
v_mfma_f32_16x16x32_bf16 v[116:119],a[124:127],v[28:31],v[116:119]
ds_read_b128 a[20:23],v12 offset:256
v_fma_f32 v99,v99,s36,v16
ds_read_b64_tr_b16 a[136:137],v2 offset:24704
ds_read_b64_tr_b16 a[138:139],v2 offset:30848
ds_read_b64_tr_b16 a[140:141],v3 offset:24704
ds_read_b64_tr_b16 a[142:143],v3 offset:30848
ds_read_b64_tr_b16 a[144:145],v4 offset:24704
ds_read_b64_tr_b16 a[146:147],v4 offset:30848
ds_read_b64_tr_b16 a[148:149],v5 offset:24704
ds_read_b64_tr_b16 a[150:151],v5 offset:30848
ds_read_b128 a[24:27],v11 offset:6144
v_mfma_f32_16x16x32_bf16 a[164:167],a[124:127],v[32:35],a[164:167]
v_fma_f32 v104,v104,s36,v17
ds_read_b128 a[28:31],v12 offset:6144
v_mfma_f32_16x16x32_bf16 a[160:163],a[120:123],v[32:35],a[160:163]
v_fma_f32 v105,v105,s36,v17
ds_read_b128 a[32:35],v11 offset:6272
v_mfma_f32_16x16x32_bf16 a[208:211],a[120:123],v[36:39],a[208:211]
s_waitcnt lgkmcnt(11)
buffer_load_dwordx4 v6,s[12:15],s28 offen offset:0 nt lds
v_mfma_f32_16x16x32_bf16 a[212:215],a[124:127],v[36:39],a[212:215]
ds_read_b64_tr_b16 a[120:121],v2 offset:24832
ds_read_b128 a[36:39],v12 offset:6272
v_mfma_f32_16x16x32_bf16 a[216:219],a[128:131],v[36:39],a[216:219]
v_fma_f32 v106,v106,s36,v17
ds_read_b128 a[40:43],v11 offset:6400
v_mfma_f32_16x16x32_bf16 a[220:223],a[132:135],v[36:39],a[220:223]
v_fma_f32 v107,v107,s36,v17
ds_read_b128 a[44:47],v12 offset:6400
v_mfma_f32_16x16x32_bf16 a[172:175],a[132:135],v[32:35],a[172:175]
v_fma_f32 v76,v76,s36,v13
v_fma_f32 v77,v77,s36,v13
v_mfma_f32_16x16x32_bf16 a[168:171],a[128:131],v[32:35],a[168:171]
buffer_load_dwordx4 v7,s[12:15],s28 offen offset:1024 nt lds
v_mfma_f32_16x16x32_bf16 v[120:123],a[128:131],v[28:31],v[120:123]
ds_read_b64_tr_b16 a[122:123],v2 offset:30976
ds_read_b64_tr_b16 a[124:125],v3 offset:24832
ds_read_b64_tr_b16 a[126:127],v3 offset:30976
v_mfma_f32_16x16x32_bf16 v[124:127],a[132:135],v[28:31],v[124:127]
v_fma_f32 v78,v78,s36,v13
v_fma_f32 v79,v79,s36,v13
v_mfma_f32_16x16x32_bf16 v[220:223],a[132:135],v[24:27],v[220:223]
v_fma_f32 v84,v84,s36,v14
v_fma_f32 v85,v85,s36,v14
v_mfma_f32_16x16x32_bf16 v[216:219],a[128:131],v[24:27],v[216:219]
v_fma_f32 v86,v86,s36,v14
v_fma_f32 v87,v87,s36,v14
v_mfma_f32_16x16x32_bf16 v[168:171],a[128:131],v[20:23],v[168:171]
ds_read_b64_tr_b16 a[128:129],v4 offset:24832
v_fma_f32 v92,v92,s36,v15
v_mfma_f32_16x16x32_bf16 v[172:175],a[132:135],v[20:23],v[172:175]
s_waitcnt lgkmcnt(4)
ds_read_b64_tr_b16 a[130:131],v4 offset:30976
v_fma_f32 v93,v93,s36,v15
v_mfma_f32_16x16x32_bf16 v[176:179],a[136:139],v[20:23],v[176:179]
buffer_load_dwordx4 v8,s[12:15],s28 offen offset:2048 nt lds
v_mfma_f32_16x16x32_bf16 v[180:183],a[140:143],v[20:23],v[180:183]
s_add_u32 s28,s28,3072
ds_read_b64_tr_b16 a[132:133],v5 offset:24832
v_fma_f32 v94,v94,s36,v15
v_mfma_f32_16x16x32_bf16 v[228:231],a[140:143],v[24:27],v[228:231]
s_add_u32 m0,s24,3072
ds_read_b64_tr_b16 a[134:135],v5 offset:30976
v_fma_f32 v95,v95,s36,v15
v_mfma_f32_16x16x32_bf16 v[224:227],a[136:139],v[24:27],v[224:227]
v_fma_f32 v100,v100,s36,v16
v_fma_f32 v101,v101,s36,v16
v_mfma_f32_16x16x32_bf16 v[128:131],a[136:139],v[28:31],v[128:131]
v_fma_f32 v102,v102,s36,v16
v_fma_f32 v103,v103,s36,v16
v_mfma_f32_16x16x32_bf16 v[132:135],a[140:143],v[28:31],v[132:135]
v_fma_f32 v108,v108,s36,v17
v_fma_f32 v109,v109,s36,v17
v_mfma_f32_16x16x32_bf16 a[180:183],a[140:143],v[32:35],a[180:183]
v_fma_f32 v110,v110,s36,v17
v_fma_f32 v111,v111,s36,v17
v_mfma_f32_16x16x32_bf16 a[176:179],a[136:139],v[32:35],a[176:179]
v_exp_f32 v90,v90
v_mfma_f32_16x16x32_bf16 a[224:227],a[136:139],v[36:39],a[224:227]
buffer_load_dwordx4 v6,s[12:15],s28 offen offset:0 nt lds
v_mfma_f32_16x16x32_bf16 a[228:231],a[140:143],v[36:39],a[228:231]
v_exp_f32 v91,v91
v_mfma_f32_16x16x32_bf16 a[232:235],a[144:147],v[36:39],a[232:235]
v_exp_f32 v96,v96
v_mfma_f32_16x16x32_bf16 a[236:239],a[148:151],v[36:39],a[236:239]
v_exp_f32 v97,v97
v_mfma_f32_16x16x32_bf16 a[188:191],a[148:151],v[32:35],a[188:191]
v_exp_f32 v98,v98
v_mfma_f32_16x16x32_bf16 a[184:187],a[144:147],v[32:35],a[184:187]
v_exp_f32 v99,v99
v_mfma_f32_16x16x32_bf16 v[136:139],a[144:147],v[28:31],v[136:139]
v_exp_f32 v104,v104
v_mfma_f32_16x16x32_bf16 v[140:143],a[148:151],v[28:31],v[140:143]
v_exp_f32 v105,v105
v_mfma_f32_16x16x32_bf16 v[236:239],a[148:151],v[24:27],v[236:239]
buffer_load_dwordx4 v7,s[12:15],s28 offen offset:1024 nt lds
v_mfma_f32_16x16x32_bf16 v[232:235],a[144:147],v[24:27],v[232:235]
v_exp_f32 v106,v106
v_mfma_f32_16x16x32_bf16 v[184:187],a[144:147],v[20:23],v[184:187]
v_exp_f32 v107,v107
v_mfma_f32_16x16x32_bf16 v[188:191],a[148:151],v[20:23],v[188:191]
s_waitcnt lgkmcnt(0)
v_exp_f32 v76,v76
v_mfma_f32_16x16x32_bf16 v[192:195],a[120:123],v[20:23],v[192:195]
v_exp_f32 v77,v77
v_mfma_f32_16x16x32_bf16 v[196:199],a[124:127],v[20:23],v[196:199]
v_exp_f32 v78,v78
v_mfma_f32_16x16x32_bf16 v[244:247],a[124:127],v[24:27],v[244:247]
v_exp_f32 v79,v79
v_mfma_f32_16x16x32_bf16 v[240:243],a[120:123],v[24:27],v[240:243]
v_exp_f32 v84,v84
v_mfma_f32_16x16x32_bf16 v[144:147],a[120:123],v[28:31],v[144:147]
buffer_load_dwordx4 v8,s[12:15],s28 offen offset:2048 nt lds
s_waitcnt vmcnt(20)
s_barrier
v_mfma_f32_16x16x32_bf16 v[148:151],a[124:127],v[28:31],v[148:151]
s_add_u32 s28,s28,3072
v_exp_f32 v85,v85
v_mfma_f32_16x16x32_bf16 a[196:199],a[124:127],v[32:35],a[196:199]
s_add_u32 m0,s22,0
v_exp_f32 v86,v86
v_mfma_f32_16x16x32_bf16 a[192:195],a[120:123],v[32:35],a[192:195]
buffer_load_dwordx4 v6,s[4:7],s25 offen offset:0 lds
v_mfma_f32_16x16x32_bf16 a[240:243],a[120:123],v[36:39],a[240:243]
buffer_load_dwordx4 v7,s[4:7],s25 offen offset:1024 lds
v_mfma_f32_16x16x32_bf16 a[244:247],a[124:127],v[36:39],a[244:247]
buffer_load_dwordx4 v8,s[4:7],s25 offen offset:2048 lds
v_mfma_f32_16x16x32_bf16 a[248:251],a[128:131],v[36:39],a[248:251]
v_exp_f32 v87,v87
v_mfma_f32_16x16x32_bf16 a[252:255],a[132:135],v[36:39],a[252:255]
v_exp_f32 v92,v92
v_mfma_f32_16x16x32_bf16 a[204:207],a[132:135],v[32:35],a[204:207]
v_exp_f32 v93,v93
v_mfma_f32_16x16x32_bf16 a[200:203],a[128:131],v[32:35],a[200:203]
v_exp_f32 v94,v94
v_mfma_f32_16x16x32_bf16 v[152:155],a[128:131],v[28:31],v[152:155]
ds_read_b64_tr_b16 a[136:137],v2 offset:0
v_exp_f32 v95,v95
v_mfma_f32_16x16x32_bf16 v[156:159],a[132:135],v[28:31],v[156:159]
ds_read_b64_tr_b16 a[138:139],v2 offset:6144
v_exp_f32 v100,v100
v_mfma_f32_16x16x32_bf16 v[252:255],a[132:135],v[24:27],v[252:255]
ds_read_b64_tr_b16 a[140:141],v3 offset:0
v_exp_f32 v101,v101
v_mfma_f32_16x16x32_bf16 v[248:251],a[128:131],v[24:27],v[248:251]
ds_read_b64_tr_b16 a[142:143],v3 offset:6144
v_exp_f32 v102,v102
v_mfma_f32_16x16x32_bf16 v[200:203],a[128:131],v[20:23],v[200:203]
ds_read_b64_tr_b16 a[144:145],v4 offset:0
v_exp_f32 v103,v103
v_mfma_f32_16x16x32_bf16 v[204:207],a[132:135],v[20:23],v[204:207]
ds_read_b64_tr_b16 a[146:147],v4 offset:6144
ds_read_b64_tr_b16 a[148:149],v5 offset:0
ds_read_b64_tr_b16 a[150:151],v5 offset:6144
v_exp_f32 v108,v108
v_exp_f32 v109,v109
v_exp_f32 v110,v110
v_exp_f32 v111,v111
v_cvt_pk_bf16_f32 v53,v90,v91
v_cvt_pk_bf16_f32 v56,v96,v97
v_cvt_pk_bf16_f32 v57,v98,v99
v_cvt_pk_bf16_f32 v40,v104,v105
v_cvt_pk_bf16_f32 v41,v106,v107
v_cvt_pk_bf16_f32 v46,v76,v77
v_cvt_pk_bf16_f32 v47,v78,v79
v_cvt_pk_bf16_f32 v50,v84,v85
v_cvt_pk_bf16_f32 v51,v86,v87
v_cvt_pk_bf16_f32 v54,v92,v93
v_cvt_pk_bf16_f32 v55,v94,v95
v_smfmac_f32_16x16x64_bf16 v[60:63],a[152:155],v[44:51],v18
v_cvt_pk_bf16_f32 v58,v100,v101
v_cvt_pk_bf16_f32 v59,v102,v103
v_cvt_pk_bf16_f32 v42,v108,v109
v_cvt_pk_bf16_f32 v43,v110,v111
v_smfmac_f32_16x16x64_bf16 v[64:67],a[152:155],v[52:59],v18
v_subrev_u32 v10,18432,v10
v_smfmac_f32_16x16x64_bf16 v[68:71],a[152:155],v[36:43],v18
s_waitcnt lgkmcnt(0)
v_mfma_f32_16x16x32_bf16 v[160:163],a[136:139],v[44:47],v[160:163]
s_add_u32 s87,s42,18432
ds_read_b64_tr_b16 a[120:121],v2 offset:128
v_mbcnt_lo_u32_b32 v39,-1,0
v_mfma_f32_16x16x32_bf16 v[164:167],a[140:143],v[44:47],v[164:167]
s_add_u32 s66,s42,24576
ds_read_b64_tr_b16 a[122:123],v2 offset:6272
v_mbcnt_hi_u32_b32 v39,-1,v39
v_mfma_f32_16x16x32_bf16 v[212:215],a[140:143],v[48:51],v[212:215]
ds_read_b64_tr_b16 a[124:125],v3 offset:128
v_and_b32 v38,7,v39
v_mfma_f32_16x16x32_bf16 v[208:211],a[136:139],v[48:51],v[208:211]
ds_read_b64_tr_b16 a[126:127],v3 offset:6272
v_add_f32 v68,v68,v69
v_mfma_f32_16x16x32_bf16 v[112:115],a[136:139],v[52:55],v[112:115]
ds_read_b64_tr_b16 a[128:129],v4 offset:128
v_add_f32 v60,v60,v61
v_mfma_f32_16x16x32_bf16 v[116:119],a[140:143],v[52:55],v[116:119]
ds_read_b64_tr_b16 a[130:131],v4 offset:6272
ds_read_b64_tr_b16 a[132:133],v5 offset:128
ds_read_b64_tr_b16 a[134:135],v5 offset:6272
v_mfma_f32_16x16x32_bf16 a[164:167],a[140:143],v[56:59],a[164:167]
v_add_f32 v62,v62,v63
v_add_f32 v64,v64,v65
v_mfma_f32_16x16x32_bf16 a[160:163],a[136:139],v[56:59],a[160:163]
v_add_f32 v68,v68,v70
v_add_f32 v66,v66,v67
v_mfma_f32_16x16x32_bf16 a[208:211],a[136:139],v[40:43],a[208:211]
ds_read_b64_tr_b16 a[136:137],v2 offset:256
v_max3_f32 v19,v60,v62,v64
v_mfma_f32_16x16x32_bf16 a[212:215],a[140:143],v[40:43],a[212:215]
ds_read_b64_tr_b16 a[138:139],v2 offset:6400
v_add_f32 v68,v68,v71
v_mfma_f32_16x16x32_bf16 a[216:219],a[144:147],v[40:43],a[216:219]
ds_read_b64_tr_b16 a[140:141],v3 offset:256
v_max3_f32 v19,v19,v66,v68
v_mfma_f32_16x16x32_bf16 a[220:223],a[148:151],v[40:43],a[220:223]
ds_read_b64_tr_b16 a[142:143],v3 offset:6400
v_rcp_f32 v66,v66
v_rcp_f32 v68,v68
v_accvgpr_read_b32 v72,a160
v_accvgpr_read_b32 v73,a161
v_pk_mul_f32 v[72:73],v[72:73],v[66:67] op_sel_hi:[1,0]
v_accvgpr_read_b32 v74,a162
v_accvgpr_read_b32 v75,a163
v_pk_mul_f32 v[74:75],v[74:75],v[66:67] op_sel_hi:[1,0]
v_accvgpr_read_b32 v76,a208
v_accvgpr_read_b32 v77,a209
v_pk_mul_f32 v[76:77],v[76:77],v[68:69] op_sel_hi:[1,0]
v_accvgpr_read_b32 v78,a210
v_accvgpr_read_b32 v79,a211
v_pk_mul_f32 v[78:79],v[78:79],v[68:69] op_sel_hi:[1,0]
v_accvgpr_read_b32 v80,a164
v_accvgpr_read_b32 v81,a165
v_mfma_f32_16x16x32_bf16 a[172:175],a[148:151],v[56:59],a[172:175]
v_accvgpr_read_b32 v82,a166
v_accvgpr_read_b32 v83,a167
v_accvgpr_read_b32 v84,a212
v_accvgpr_read_b32 v85,a213
v_accvgpr_read_b32 v86,a214
v_pk_mul_f32 v[80:81],v[80:81],v[66:67] op_sel_hi:[1,0]
v_pk_mul_f32 v[82:83],v[82:83],v[66:67] op_sel_hi:[1,0]
v_pk_mul_f32 v[84:85],v[84:85],v[68:69] op_sel_hi:[1,0]
v_accvgpr_read_b32 v87,a215
v_pk_mul_f32 v[86:87],v[86:87],v[68:69] op_sel_hi:[1,0]
v_accvgpr_read_b32 v92,a216
v_accvgpr_read_b32 v93,a217
v_mfma_f32_16x16x32_bf16 a[168:171],a[144:147],v[56:59],a[168:171]
v_accvgpr_read_b32 v94,a218
v_accvgpr_read_b32 v95,a219
v_mfma_f32_16x16x32_bf16 v[120:123],a[144:147],v[52:55],v[120:123]
v_accvgpr_read_b32 v100,a220
v_accvgpr_read_b32 v101,a221
v_mfma_f32_16x16x32_bf16 v[124:127],a[148:151],v[52:55],v[124:127]
v_accvgpr_read_b32 v102,a222
v_accvgpr_read_b32 v103,a223
v_mfma_f32_16x16x32_bf16 v[220:223],a[148:151],v[48:51],v[220:223]
v_accvgpr_read_b32 v88,a168
v_accvgpr_read_b32 v89,a169
v_accvgpr_read_b32 v90,a170
v_accvgpr_read_b32 v91,a171
v_accvgpr_read_b32 v96,a172
v_pk_mul_f32 v[92:93],v[92:93],v[68:69] op_sel_hi:[1,0]
v_pk_mul_f32 v[94:95],v[94:95],v[68:69] op_sel_hi:[1,0]
v_pk_mul_f32 v[88:89],v[88:89],v[66:67] op_sel_hi:[1,0]
v_pk_mul_f32 v[90:91],v[90:91],v[66:67] op_sel_hi:[1,0]
v_accvgpr_read_b32 v97,a173
v_accvgpr_read_b32 v98,a174
v_mfma_f32_16x16x32_bf16 v[216:219],a[144:147],v[48:51],v[216:219]
v_accvgpr_read_b32 v99,a175
v_cmp_ngt_f32 vcc,s37,v19
v_mfma_f32_16x16x32_bf16 v[168:171],a[144:147],v[44:47],v[168:171]
ds_read_b64_tr_b16 a[144:145],v4 offset:256
ds_read_b64_tr_b16 a[146:147],v4 offset:6400
v_lshrrev_b32 v19,5,v39
v_xor_b32 v38,v38,v19
v_pk_mul_f32 v[96:97],v[96:97],v[66:67] op_sel_hi:[1,0]
v_pk_mul_f32 v[98:99],v[98:99],v[66:67] op_sel_hi:[1,0]
v_pk_mul_f32 v[100:101],v[100:101],v[68:69] op_sel_hi:[1,0]
v_pk_mul_f32 v[102:103],v[102:103],v[68:69] op_sel_hi:[1,0]
v_and_b32 v19,15,v39
v_lshl_add_u32 v19,v19,7,s24
v_mfma_f32_16x16x32_bf16 v[172:175],a[148:151],v[44:47],v[172:175]
s_cmp_lg_u64 vcc,0
ds_read_b64_tr_b16 a[148:149],v5 offset:256
v_lshl_add_u32 v19,v38,4,v19
s_waitcnt lgkmcnt(3)
v_mfma_f32_16x16x32_bf16 v[176:179],a[120:123],v[44:47],v[176:179]
s_cselect_b32 s62,s32,0
ds_read_b64_tr_b16 a[150:151],v5 offset:6400
v_bfe_u32 v38,v39,4,1
v_mfma_f32_16x16x32_bf16 v[180:183],a[124:127],v[44:47],v[180:183]
s_or_b32 s31,s31,s62
v_lshl_add_u32 v36,v38,3,v19
v_xor_b32 v37,32,v36
v_mfma_f32_16x16x32_bf16 v[228:231],a[124:127],v[48:51],v[228:231]
s_lshl_b32 s32,s32,1
v_xor_b32 v38,64,v36
v_bfe_u32 v19,v39,3,1
v_mfma_f32_16x16x32_bf16 v[224:227],a[120:123],v[48:51],v[224:227]
s_add_u32 m0,s24,6144
v_xor_b32 v39,96,v36
v_lshlrev_b32 v19,11,v19
v_mfma_f32_16x16x32_bf16 v[128:131],a[120:123],v[52:55],v[128:131]
buffer_load_dwordx4 v6,s[12:15],s28 offen offset:0 nt lds
v_mfma_f32_16x16x32_bf16 v[132:135],a[124:127],v[52:55],v[132:135]
buffer_load_dwordx4 v7,s[12:15],s28 offen offset:1024 nt lds
v_mfma_f32_16x16x32_bf16 a[180:183],a[124:127],v[56:59],a[180:183]
buffer_load_dwordx4 v8,s[12:15],s28 offen offset:2048 nt lds
v_mfma_f32_16x16x32_bf16 a[176:179],a[120:123],v[56:59],a[176:179]
s_add_u32 s28,s28,3072
v_cvt_pk_bf16_f32 v72,v72,v73
v_cvt_pk_bf16_f32 v76,v76,v77
v_mfma_f32_16x16x32_bf16 a[224:227],a[120:123],v[40:43],a[224:227]
s_add_u32 m0,s24,9216
v_cvt_pk_bf16_f32 v80,v80,v81
v_cvt_pk_bf16_f32 v84,v84,v85
v_mfma_f32_16x16x32_bf16 a[228:231],a[124:127],v[40:43],a[228:231]
buffer_load_dwordx4 v6,s[12:15],s28 offen offset:0 nt lds
v_mfma_f32_16x16x32_bf16 a[232:235],a[128:131],v[40:43],a[232:235]
buffer_load_dwordx4 v7,s[12:15],s28 offen offset:1024 nt lds
v_mfma_f32_16x16x32_bf16 a[236:239],a[132:135],v[40:43],a[236:239]
buffer_load_dwordx4 v8,s[12:15],s28 offen offset:2048 nt lds
v_cvt_pk_bf16_f32 v73,v74,v75
v_cvt_pk_bf16_f32 v77,v78,v79
ds_write2st64_b64 v36,v[72:73],v[76:77] offset0:36 offset1:40
v_cvt_pk_bf16_f32 v81,v82,v83
v_cvt_pk_bf16_f32 v85,v86,v87
v_accvgpr_read_b32 v82,a178
v_accvgpr_read_b32 v83,a179
v_pk_mul_f32 v[82:83],v[82:83],v[66:67] op_sel_hi:[1,0]
v_accvgpr_read_b32 v86,a226
v_accvgpr_read_b32 v87,a227
v_pk_mul_f32 v[86:87],v[86:87],v[68:69] op_sel_hi:[1,0]
v_cvt_pk_bf16_f32 v92,v92,v93
v_cvt_pk_bf16_f32 v88,v88,v89
v_cvt_pk_bf16_f32 v93,v94,v95
ds_write2st64_b64 v37,v[80:81],v[84:85] offset0:36 offset1:40
v_accvgpr_read_b32 v80,a176
v_accvgpr_read_b32 v81,a177
v_pk_mul_f32 v[80:81],v[80:81],v[66:67] op_sel_hi:[1,0]
v_accvgpr_read_b32 v84,a224
v_accvgpr_read_b32 v85,a225
v_pk_mul_f32 v[84:85],v[84:85],v[68:69] op_sel_hi:[1,0]
v_cvt_pk_bf16_f32 v89,v90,v91
v_accvgpr_read_b32 v94,a230
v_mfma_f32_16x16x32_bf16 a[188:191],a[132:135],v[56:59],a[188:191]
s_add_u32 s28,s28,3072
v_accvgpr_read_b32 v95,a231
ds_write2st64_b64 v38,v[88:89],v[92:93] offset0:36 offset1:40
v_pk_mul_f32 v[94:95],v[94:95],v[68:69] op_sel_hi:[1,0]
v_accvgpr_read_b32 v90,a182
v_accvgpr_read_b32 v91,a183
v_pk_mul_f32 v[90:91],v[90:91],v[66:67] op_sel_hi:[1,0]
v_accvgpr_read_b32 v88,a180
v_accvgpr_read_b32 v89,a181
v_pk_mul_f32 v[88:89],v[88:89],v[66:67] op_sel_hi:[1,0]
v_accvgpr_read_b32 v92,a228
v_accvgpr_read_b32 v93,a229
v_pk_mul_f32 v[92:93],v[92:93],v[68:69] op_sel_hi:[1,0]
v_cvt_pk_bf16_f32 v96,v96,v97
v_cvt_pk_bf16_f32 v100,v100,v101
v_mfma_f32_16x16x32_bf16 a[184:187],a[128:131],v[56:59],a[184:187]
s_waitcnt vmcnt(21)
ds_read_b128 a[48:51],v11 offset:12288
v_cvt_pk_bf16_f32 v97,v98,v99
v_mfma_f32_16x16x32_bf16 v[136:139],a[128:131],v[52:55],v[136:139]
s_add_u32 m0,s23,0
ds_read_b128 a[52:55],v12 offset:12288
v_cvt_pk_bf16_f32 v101,v102,v103
v_mfma_f32_16x16x32_bf16 v[140:143],a[132:135],v[52:55],v[140:143]
ds_read_b128 a[56:59],v11 offset:12416
v_cvt_pk_bf16_f32 v80,v80,v81
v_mfma_f32_16x16x32_bf16 v[236:239],a[132:135],v[48:51],v[236:239]
ds_read_b128 a[60:63],v12 offset:12416
v_cvt_pk_bf16_f32 v84,v84,v85
ds_read_b128 a[64:67],v11 offset:12544
v_cvt_pk_bf16_f32 v81,v82,v83
ds_read_b128 a[68:71],v12 offset:12544
v_cvt_pk_bf16_f32 v85,v86,v87
ds_write2st64_b64 v39,v[96:97],v[100:101] offset0:36 offset1:40
v_accvgpr_read_b32 v98,a186
v_accvgpr_read_b32 v99,a187
v_pk_mul_f32 v[98:99],v[98:99],v[66:67] op_sel_hi:[1,0]
ds_read_b128 v[104:107],v10 offset:18432
v_accvgpr_read_b32 v102,a234
ds_read_b128 v[108:111],v10 offset:19456
v_accvgpr_read_b32 v103,a235
ds_read_b128 v[72:75],v10 offset:20480
v_pk_mul_f32 v[102:103],v[102:103],v[68:69] op_sel_hi:[1,0]
ds_read_b128 v[76:79],v10 offset:21504
v_accvgpr_read_b32 v82,a190
ds_write2st64_b64 v36,v[80:81],v[84:85] offset0:36 offset1:40
v_accvgpr_read_b32 v83,a191
v_pk_mul_f32 v[82:83],v[82:83],v[66:67] op_sel_hi:[1,0]
v_accvgpr_read_b32 v86,a238
v_accvgpr_read_b32 v87,a239
v_pk_mul_f32 v[86:87],v[86:87],v[68:69] op_sel_hi:[1,0]
v_accvgpr_read_b32 v96,a184
v_accvgpr_read_b32 v97,a185
s_waitcnt lgkmcnt(4)
buffer_store_dwordx4 v[104:107],v9,s[16:19],s87 offen offset:0 nt
v_pk_mul_f32 v[96:97],v[96:97],v[66:67] op_sel_hi:[1,0]
v_accvgpr_read_b32 v100,a232
v_accvgpr_read_b32 v101,a233
v_pk_mul_f32 v[100:101],v[100:101],v[68:69] op_sel_hi:[1,0]
v_accvgpr_read_b32 v80,a188
v_accvgpr_read_b32 v81,a189
v_pk_mul_f32 v[80:81],v[80:81],v[66:67] op_sel_hi:[1,0]
v_accvgpr_read_b32 v84,a236
v_accvgpr_read_b32 v85,a237
v_pk_mul_f32 v[84:85],v[84:85],v[68:69] op_sel_hi:[1,0]
v_cvt_pk_bf16_f32 v88,v88,v89
v_cvt_pk_bf16_f32 v92,v92,v93
v_mfma_f32_16x16x32_bf16 v[232:235],a[128:131],v[48:51],v[232:235]
s_waitcnt lgkmcnt(0)
buffer_store_dwordx4 v[108:111],v9,s[16:19],s87 offen offset:3072 nt
v_cvt_pk_bf16_f32 v96,v96,v97
v_cvt_pk_bf16_f32 v100,v100,v101
v_cvt_pk_bf16_f32 v89,v90,v91
v_mfma_f32_16x16x32_bf16 v[184:187],a[128:131],v[44:47],v[184:187]
v_cvt_pk_bf16_f32 v93,v94,v95
v_cvt_pk_bf16_f32 v80,v80,v81
v_mfma_f32_16x16x32_bf16 v[188:191],a[132:135],v[44:47],v[188:191]
v_cvt_pk_bf16_f32 v84,v84,v85
v_cvt_pk_bf16_f32 v97,v98,v99
v_mfma_f32_16x16x32_bf16 v[192:195],a[136:139],v[44:47],v[192:195]
ds_write2st64_b64 v37,v[88:89],v[92:93] offset0:36 offset1:40
v_mfma_f32_16x16x32_bf16 v[196:199],a[140:143],v[44:47],v[196:199]
v_cvt_pk_bf16_f32 v101,v102,v103
v_cvt_pk_bf16_f32 v81,v82,v83
v_mfma_f32_16x16x32_bf16 v[244:247],a[140:143],v[48:51],v[244:247]
buffer_store_dwordx4 v[72:75],v9,s[16:19],s66 offen offset:0 nt
v_cvt_pk_bf16_f32 v85,v86,v87
v_rcp_f32 v64,v64
v_mfma_f32_16x16x32_bf16 v[240:243],a[136:139],v[48:51],v[240:243]
v_rcp_f32 v60,v60
v_mfma_f32_16x16x32_bf16 v[144:147],a[136:139],v[52:55],v[144:147]
v_rcp_f32 v62,v62
v_mfma_f32_16x16x32_bf16 v[148:151],a[140:143],v[52:55],v[148:151]
ds_write2st64_b64 v38,v[96:97],v[100:101] offset0:36 offset1:40
v_mfma_f32_16x16x32_bf16 a[196:199],a[140:143],v[56:59],a[196:199]
v_mov_b32 v70,0
v_mov_b32 v71,0
v_mfma_f32_16x16x32_bf16 a[192:195],a[136:139],v[56:59],a[192:195]
buffer_store_dwordx4 v[76:79],v9,s[16:19],s66 offen offset:3072 nt
s_waitcnt vmcnt(10)
s_barrier
v_mfma_f32_16x16x32_bf16 a[240:243],a[136:139],v[40:43],a[240:243]
ds_read_b128 a[120:123],v0 offset:0
v_accvgpr_read_b32 v96,a196
v_mfma_f32_16x16x32_bf16 a[244:247],a[140:143],v[40:43],a[244:247]
ds_write2st64_b64 v39,v[80:81],v[84:85] offset0:36 offset1:40
v_mfma_f32_16x16x32_bf16 a[248:251],a[144:147],v[40:43],a[248:251]
v_accvgpr_read_b32 v104,a192
v_accvgpr_read_b32 v105,a193
v_mfma_f32_16x16x32_bf16 a[252:255],a[148:151],v[40:43],a[252:255]
ds_read_b128 v[72:75],v10 offset:18432
buffer_load_dwordx4 v6,s[8:11],s25 offen offset:0 lds
ds_read_b128 v[76:79],v10 offset:19456
v_pk_mul_f32 v[104:105],v[104:105],v[66:67] op_sel_hi:[1,0]
ds_read_b128 v[88:91],v10 offset:20480
v_accvgpr_read_b32 v106,a194
ds_read_b128 v[92:95],v10 offset:21504
v_accvgpr_read_b32 v107,a195
ds_read_b128 a[124:127],v1 offset:0
v_pk_mul_f32 v[106:107],v[106:107],v[66:67] op_sel_hi:[1,0]
ds_read_b128 a[128:131],v0 offset:128
v_accvgpr_read_b32 v108,a240
ds_read_b128 a[132:135],v1 offset:128
v_accvgpr_read_b32 v109,a241
ds_read_b128 a[136:139],v0 offset:256
s_waitcnt lgkmcnt(7)
buffer_store_dwordx4 v[72:75],v9,s[16:19],s87 offen offset:128 nt
ds_read_b128 a[140:143],v1 offset:256
v_pk_mul_f32 v[108:109],v[108:109],v[68:69] op_sel_hi:[1,0]
v_accvgpr_read_b32 v110,a242
v_accvgpr_read_b32 v111,a243
v_pk_mul_f32 v[110:111],v[110:111],v[68:69] op_sel_hi:[1,0]
v_accvgpr_read_b32 v97,a197
v_accvgpr_read_b32 v98,a198
v_mfma_f32_16x16x32_bf16 a[204:207],a[148:151],v[56:59],a[204:207]
v_accvgpr_read_b32 v99,a199
buffer_load_dwordx4 v7,s[8:11],s25 offen offset:1024 lds
s_waitcnt lgkmcnt(4)
buffer_store_dwordx4 v[76:79],v9,s[16:19],s87 offen offset:3200 nt
v_pk_mul_f32 v[96:97],v[96:97],v[66:67] op_sel_hi:[1,0]
v_pk_mul_f32 v[98:99],v[98:99],v[66:67] op_sel_hi:[1,0]
v_accvgpr_read_b32 v100,a244
v_accvgpr_read_b32 v101,a245
v_pk_mul_f32 v[100:101],v[100:101],v[68:69] op_sel_hi:[1,0]
v_accvgpr_read_b32 v102,a246
v_accvgpr_read_b32 v103,a247
v_pk_mul_f32 v[102:103],v[102:103],v[68:69] op_sel_hi:[1,0]
v_cvt_pk_bf16_f32 v104,v104,v105
v_cvt_pk_bf16_f32 v108,v108,v109
v_mfma_f32_16x16x32_bf16 a[200:203],a[144:147],v[56:59],a[200:203]
v_cvt_pk_bf16_f32 v105,v106,v107
v_cvt_pk_bf16_f32 v109,v110,v111
v_mfma_f32_16x16x32_bf16 v[152:155],a[144:147],v[52:55],v[152:155]
ds_write2st64_b64 v36,v[104:105],v[108:109] offset0:36 offset1:40
v_mfma_f32_16x16x32_bf16 v[156:159],a[148:151],v[52:55],v[156:159]
v_add_u32 v36,v36,v19
v_accvgpr_read_b32 v84,a248
v_mfma_f32_16x16x32_bf16 v[252:255],a[148:151],v[48:51],v[252:255]
buffer_load_dwordx4 v8,s[8:11],s25 offen offset:2048 lds
buffer_store_dwordx4 v[88:91],v9,s[16:19],s66 offen offset:128 nt
v_pk_mul_f32 v[112:113],v[112:113],v[64:65] op_sel_hi:[1,0]
v_pk_mul_f32 v[114:115],v[114:115],v[64:65] op_sel_hi:[1,0]
v_pk_mul_f32 v[128:129],v[128:129],v[64:65] op_sel_hi:[1,0]
v_pk_mul_f32 v[130:131],v[130:131],v[64:65] op_sel_hi:[1,0]
v_pk_mul_f32 v[116:117],v[116:117],v[64:65] op_sel_hi:[1,0]
v_pk_mul_f32 v[118:119],v[118:119],v[64:65] op_sel_hi:[1,0]
v_pk_mul_f32 v[132:133],v[132:133],v[64:65] op_sel_hi:[1,0]
v_pk_mul_f32 v[134:135],v[134:135],v[64:65] op_sel_hi:[1,0]
v_accvgpr_read_b32 v85,a249
v_pk_mul_f32 v[84:85],v[84:85],v[68:69] op_sel_hi:[1,0]
v_accvgpr_read_b32 v86,a250
buffer_store_dwordx4 v[92:95],v9,s[16:19],s66 offen offset:3200 nt
v_accvgpr_read_b32 v87,a251
v_pk_mul_f32 v[86:87],v[86:87],v[68:69] op_sel_hi:[1,0]
v_accvgpr_read_b32 v80,a200
v_accvgpr_read_b32 v81,a201
v_pk_mul_f32 v[80:81],v[80:81],v[66:67] op_sel_hi:[1,0]
v_accvgpr_read_b32 v82,a202
v_accvgpr_read_b32 v83,a203
v_pk_mul_f32 v[82:83],v[82:83],v[66:67] op_sel_hi:[1,0]
v_accvgpr_read_b32 v106,a206
v_accvgpr_read_b32 v107,a207
v_pk_mul_f32 v[106:107],v[106:107],v[66:67] op_sel_hi:[1,0]
v_accvgpr_read_b32 v110,a254
v_accvgpr_read_b32 v111,a255
v_pk_mul_f32 v[110:111],v[110:111],v[68:69] op_sel_hi:[1,0]
v_accvgpr_read_b32 v104,a204
v_accvgpr_read_b32 v105,a205
v_pk_mul_f32 v[104:105],v[104:105],v[66:67] op_sel_hi:[1,0]
v_accvgpr_read_b32 v108,a252
v_accvgpr_read_b32 v109,a253
v_pk_mul_f32 v[108:109],v[108:109],v[68:69] op_sel_hi:[1,0]
v_cvt_pk_bf16_f32 v96,v96,v97
v_cvt_pk_bf16_f32 v100,v100,v101
v_mfma_f32_16x16x32_bf16 v[248:251],a[144:147],v[48:51],v[248:251]
s_waitcnt vmcnt(20)
ds_read_b128 a[92:95],v12 offset:256
v_cvt_pk_bf16_f32 v84,v84,v85
v_mfma_f32_16x16x32_bf16 v[200:203],a[144:147],v[44:47],v[200:203]
s_mov_b32 s27,s42
ds_read_b128 a[88:91],v11 offset:256
v_cvt_pk_bf16_f32 v80,v80,v81
ds_read_b128 a[84:87],v12 offset:128
v_pk_mul_f32 v[120:121],v[120:121],v[64:65] op_sel_hi:[1,0]
ds_read_b128 a[80:83],v11 offset:128
v_pk_mul_f32 v[122:123],v[122:123],v[64:65] op_sel_hi:[1,0]
ds_read_b128 a[76:79],v12 offset:0
v_pk_mul_f32 v[136:137],v[136:137],v[64:65] op_sel_hi:[1,0]
ds_read_b128 a[72:75],v11 offset:0
v_pk_mul_f32 v[138:139],v[138:139],v[64:65] op_sel_hi:[1,0]
v_cvt_pk_bf16_f32 v97,v98,v99
v_cvt_pk_bf16_f32 v101,v102,v103
v_mfma_f32_16x16x32_bf16 v[204:207],a[148:151],v[44:47],v[204:207]
s_mov_b32 s42,s41
ds_write2st64_b64 v37,v[96:97],v[100:101] offset0:36 offset1:40
v_mfma_f32_16x16x32_bf16 v[72:75],a[120:123],a[0:3],0
s_add_u32 s69,s69,1
v_add_u32 v37,v37,v19
ds_read_b128 a[144:147],v0 offset:6144
v_mfma_f32_16x16x32_bf16 v[72:75],a[124:127],a[4:7],v[72:75]
s_lshl_b32 s62,s69,5
ds_read_b128 a[148:151],v1 offset:6144
v_cvt_pk_bf16_f32 v104,v104,v105
v_cvt_pk_bf16_f32 v108,v108,v109
v_cvt_pk_bf16_f32 v85,v86,v87
v_pk_mul_f32 v[124:125],v[124:125],v[64:65] op_sel_hi:[1,0]
v_pk_mul_f32 v[126:127],v[126:127],v[64:65] op_sel_hi:[1,0]
v_pk_mul_f32 v[140:141],v[140:141],v[64:65] op_sel_hi:[1,0]
v_pk_mul_f32 v[142:143],v[142:143],v[64:65] op_sel_hi:[1,0]
v_cvt_pk_bf16_f32 v81,v82,v83
v_cvt_pk_bf16_f32 v105,v106,v107
s_waitcnt lgkmcnt(3)
v_mfma_f32_16x16x32_bf16 v[72:75],a[128:131],a[8:11],v[72:75]
s_add_u32 s62,s62,s34
ds_write2st64_b64 v38,v[80:81],v[84:85] offset0:36 offset1:40
v_mfma_f32_16x16x32_bf16 v[72:75],a[132:135],a[12:15],v[72:75]
s_waitcnt vmcnt(11)
v_add_u32 v38,v38,v19
v_cvt_pk_bf16_f32 v109,v110,v111
v_mfma_f32_16x16x32_bf16 v[72:75],a[136:139],a[16:19],v[72:75]
s_mul_i32 s63,s62,171
ds_read_b128 a[96:99],v11 offset:6144
v_cvt_pk_bf16_f32 v112,v112,v113
v_mfma_f32_16x16x32_bf16 v[72:75],a[140:143],a[20:23],v[72:75]
s_lshr_b32 s63,s63,9
ds_read_b128 a[100:103],v12 offset:6144
v_cvt_pk_bf16_f32 v128,v128,v129
ds_read_b128 a[104:107],v11 offset:6272
v_pk_mul_f32 v[144:145],v[144:145],v[64:65] op_sel_hi:[1,0]
ds_read_b128 a[108:111],v12 offset:6272
v_pk_mul_f32 v[146:147],v[146:147],v[64:65] op_sel_hi:[1,0]
ds_read_b128 a[112:115],v11 offset:6400
v_pk_mul_f32 v[160:161],v[160:161],v[60:61] op_sel_hi:[1,0]
ds_read_b128 a[116:119],v12 offset:6400
v_pk_mul_f32 v[162:163],v[162:163],v[60:61] op_sel_hi:[1,0]
v_max3_f32 v44,v72,v73,v74
v_cvt_pk_bf16_f32 v116,v116,v117
v_mfma_f32_16x16x32_bf16 v[80:83],a[140:143],a[44:47],0
s_mul_i32 s64,s63,3
ds_write2st64_b64 v39,v[104:105],v[108:109] offset0:36 offset1:40
v_mfma_f32_16x16x32_bf16 v[80:83],a[136:139],a[40:43],v[80:83]
s_sub_u32 s62,s62,s64
v_add_u32 v39,v39,v19
v_cvt_pk_bf16_f32 v132,v132,v133
v_mfma_f32_16x16x32_bf16 v[80:83],a[132:135],a[36:39],v[80:83]
s_add_u32 s63,s63,s33
ds_read_b128 v[76:79],v10 offset:18432
v_cvt_pk_bf16_f32 v113,v114,v115
ds_read_b128 v[88:91],v10 offset:19456
v_pk_mul_f32 v[148:149],v[148:149],v[64:65] op_sel_hi:[1,0]
ds_read_b128 v[92:95],v10 offset:20480
v_pk_mul_f32 v[150:151],v[150:151],v[64:65] op_sel_hi:[1,0]
ds_read_b128 v[96:99],v10 offset:21504
v_pk_mul_f32 v[164:165],v[164:165],v[60:61] op_sel_hi:[1,0]
v_pk_mul_f32 v[166:167],v[166:167],v[60:61] op_sel_hi:[1,0]
v_cvt_pk_bf16_f32 v129,v130,v131
v_cvt_pk_bf16_f32 v120,v120,v121
v_mfma_f32_16x16x32_bf16 v[80:83],a[128:131],a[32:35],v[80:83]
s_mul_i32 s30,s63,196608
ds_write2st64_b64 v36,v[112:113],v[128:129] offset0:24 offset1:26
v_mfma_f32_16x16x32_bf16 v[80:83],a[124:127],a[28:31],v[80:83]
s_mul_i32 s41,s63,325632
v_cvt_pk_bf16_f32 v136,v136,v137
v_cvt_pk_bf16_f32 v117,v118,v119
v_mfma_f32_16x16x32_bf16 v[80:83],a[120:123],a[24:27],v[80:83]
s_lshl_b32 s63,s3,2
s_waitcnt lgkmcnt(4)
buffer_store_dwordx4 v[76:79],v9,s[16:19],s87 offen offset:256 nt
v_cvt_pk_bf16_f32 v133,v134,v135
v_cvt_pk_bf16_f32 v124,v124,v125
v_cvt_pk_bf16_f32 v140,v140,v141
v_cvt_pk_bf16_f32 v121,v122,v123
v_cvt_pk_bf16_f32 v137,v138,v139
v_cvt_pk_bf16_f32 v144,v144,v145
v_max3_f32 v48,v80,v81,v82
v_cvt_pk_bf16_f32 v160,v160,v161
v_cvt_pk_bf16_f32 v125,v126,v127
ds_write2st64_b64 v37,v[116:117],v[132:133] offset0:24 offset1:26
v_cvt_pk_bf16_f32 v141,v142,v143
v_cvt_pk_bf16_f32 v148,v148,v149
v_cvt_pk_bf16_f32 v164,v164,v165
s_waitcnt lgkmcnt(1)
buffer_store_dwordx4 v[88:91],v9,s[16:19],s87 offen offset:3328 nt
v_cvt_pk_bf16_f32 v145,v146,v147
v_cvt_pk_bf16_f32 v161,v162,v163
v_cvt_pk_bf16_f32 v149,v150,v151
v_mfma_f32_16x16x32_bf16 v[88:91],a[120:123],a[48:51],0
s_add_u32 s64,s63,21
ds_read_b128 a[120:123],v0 offset:6272
v_cvt_pk_bf16_f32 v165,v166,v167
v_mov_b32 v66,0
v_mov_b32 v67,0
ds_write2st64_b64 v38,v[120:121],v[136:137] offset0:24 offset1:26
v_pk_mul_f32 v[152:153],v[152:153],v[64:65] op_sel_hi:[1,0]
v_pk_mul_f32 v[154:155],v[154:155],v[64:65] op_sel_hi:[1,0]
v_pk_mul_f32 v[168:169],v[168:169],v[60:61] op_sel_hi:[1,0]
buffer_store_dwordx4 v[92:95],v9,s[16:19],s66 offen offset:256 nt
v_pk_mul_f32 v[170:171],v[170:171],v[60:61] op_sel_hi:[1,0]
v_cvt_pk_bf16_f32 v152,v152,v153
v_cvt_pk_bf16_f32 v168,v168,v169
v_mfma_f32_16x16x32_bf16 v[88:91],a[124:127],a[52:55],v[88:91]
s_cmp_eq_u32 s3,0
ds_read_b128 a[124:127],v1 offset:6272
v_cvt_pk_bf16_f32 v153,v154,v155
v_mfma_f32_16x16x32_bf16 v[88:91],a[128:131],a[56:59],v[88:91]
s_cselect_b32 s64,20,s64
ds_read_b128 a[128:131],v0 offset:6400
v_cvt_pk_bf16_f32 v169,v170,v171
v_mfma_f32_16x16x32_bf16 v[88:91],a[132:135],a[60:63],v[88:91]
s_cselect_b32 s40,1,0
ds_write2st64_b64 v39,v[124:125],v[140:141] offset0:24 offset1:26
v_mfma_f32_16x16x32_bf16 v[88:91],a[136:139],a[64:67],v[88:91]
s_add_u32 s65,s63,37
v_mov_b32 v68,0
ds_read_b128 a[132:135],v1 offset:6400
buffer_store_dwordx4 v[96:99],v9,s[16:19],s66 offen offset:3328 nt
ds_read_b128 a[136:139],v0 offset:0
v_pk_mul_f32 v[156:157],v[156:157],v[64:65] op_sel_hi:[1,0]
v_pk_mul_f32 v[158:159],v[158:159],v[64:65] op_sel_hi:[1,0]
v_pk_mul_f32 v[172:173],v[172:173],v[60:61] op_sel_hi:[1,0]
v_pk_mul_f32 v[174:175],v[174:175],v[60:61] op_sel_hi:[1,0]
v_cvt_pk_bf16_f32 v156,v156,v157
v_cvt_pk_bf16_f32 v172,v172,v173
v_mfma_f32_16x16x32_bf16 v[88:91],a[140:143],a[68:71],v[88:91]
s_cmp_eq_u32 s62,2
ds_read_b128 a[140:143],v1 offset:0
v_cvt_pk_bf16_f32 v157,v158,v159
v_mfma_f32_16x16x32_bf16 v[76:79],a[144:147],a[0:3],0
s_cselect_b32 s64,s65,s64
ds_write2st64_b64 v36,v[144:145],v[160:161] offset0:28 offset1:0
v_mfma_f32_16x16x32_bf16 v[76:79],a[148:151],a[4:7],v[76:79]
s_cselect_b32 s40,0,s40
v_max3_f32 v52,v88,v89,v90
v_cvt_pk_bf16_f32 v173,v174,v175
v_mov_b32 v64,0
v_mov_b32 v65,0
v_mov_b32 v69,0
v_pk_mul_f32 v[176:177],v[176:177],v[60:61] op_sel_hi:[1,0]
v_pk_mul_f32 v[178:179],v[178:179],v[60:61] op_sel_hi:[1,0]
v_pk_mul_f32 v[192:193],v[192:193],v[60:61] op_sel_hi:[1,0]
v_pk_mul_f32 v[194:195],v[194:195],v[60:61] op_sel_hi:[1,0]
v_cvt_pk_bf16_f32 v176,v176,v177
v_cvt_pk_bf16_f32 v192,v192,v193
s_waitcnt lgkmcnt(2)
v_mfma_f32_16x16x32_bf16 v[76:79],a[120:123],a[8:11],v[76:79]
s_add_u32 s65,s63,s3
ds_write2st64_b64 v37,v[148:149],v[164:165] offset0:28 offset1:0
v_mfma_f32_16x16x32_bf16 v[76:79],a[124:127],a[12:15],v[76:79]
s_cmp_eq_u32 s62,0
v_cvt_pk_bf16_f32 v177,v178,v179
v_cvt_pk_bf16_f32 v193,v194,v195
v_mfma_f32_16x16x32_bf16 v[76:79],a[128:131],a[16:19],v[76:79]
s_cselect_b32 s64,s65,s64
s_cselect_b32 s40,1,s40
s_mul_i32 s64,s64,6144
v_mfma_f32_16x16x32_bf16 v[76:79],a[132:135],a[20:23],v[76:79]
s_add_u32 s41,s41,s64
s_cmp_ge_u32 s69,6
ds_write2st64_b64 v38,v[152:153],v[168:169] offset0:28 offset1:0
v_pk_mul_f32 v[180:181],v[180:181],v[60:61] op_sel_hi:[1,0]
v_pk_mul_f32 v[182:183],v[182:183],v[60:61] op_sel_hi:[1,0]
v_pk_mul_f32 v[196:197],v[196:197],v[60:61] op_sel_hi:[1,0]
v_pk_mul_f32 v[198:199],v[198:199],v[60:61] op_sel_hi:[1,0]
v_cvt_pk_bf16_f32 v180,v180,v181
v_max3_f32 v44,v44,v75,v76
v_mfma_f32_16x16x32_bf16 v[84:87],a[132:135],a[44:47],0
s_cselect_b32 s41,166723584,s41
v_max3_f32 v44,v44,v77,v78
v_max_f32 v44,v44,v79
v_mfma_f32_16x16x32_bf16 v[84:87],a[128:131],a[40:43],v[84:87]
s_cselect_b32 s30,100663296,s30
v_mov_b32 v45,v44
v_cvt_pk_bf16_f32 v196,v196,v197
v_mfma_f32_16x16x32_bf16 v[84:87],a[124:127],a[36:39],v[84:87]
s_add_u32 s25,s30,s22
ds_write2st64_b64 v39,v[156:157],v[172:173] offset0:28 offset1:0
v_pk_mul_f32 v[184:185],v[184:185],v[60:61] op_sel_hi:[1,0]
v_pk_mul_f32 v[186:187],v[186:187],v[60:61] op_sel_hi:[1,0]
v_pk_mul_f32 v[200:201],v[200:201],v[60:61] op_sel_hi:[1,0]
v_pk_mul_f32 v[202:203],v[202:203],v[60:61] op_sel_hi:[1,0]
v_permlane32_swap_b32 v45,v44
v_max_f32 v44,v44,v45
v_mfma_f32_16x16x32_bf16 v[84:87],a[120:123],a[32:35],v[84:87]
s_add_u32 s26,s25,12288
v_mov_b32 v45,v44
v_cvt_pk_bf16_f32 v181,v182,v183
v_mfma_f32_16x16x32_bf16 v[84:87],a[148:151],a[28:31],v[84:87]
s_add_u32 m0,s23,24576
ds_write2st64_b64 v36,v[176:177],v[192:193] offset0:2 offset1:4
v_mfma_f32_16x16x32_bf16 v[84:87],a[144:147],a[24:27],v[84:87]
s_mov_b32 s28,s41
v_permlane16_swap_b32 v45,v44
v_mfma_f32_16x16x32_bf16 v[92:95],a[144:147],a[48:51],0
s_mov_b32 s29,s24
ds_read_b128 a[144:147],v0 offset:128
v_max_f32 v44,v44,v45
v_mul_f32_e64 v13,-s36,v44
v_fma_f32 v72,v72,s36,v13
v_fma_f32 v73,v73,s36,v13
v_pk_mul_f32 v[188:189],v[188:189],v[60:61] op_sel_hi:[1,0]
v_pk_mul_f32 v[190:191],v[190:191],v[60:61] op_sel_hi:[1,0]
v_pk_mul_f32 v[204:205],v[204:205],v[60:61] op_sel_hi:[1,0]
v_pk_mul_f32 v[206:207],v[206:207],v[60:61] op_sel_hi:[1,0]
v_fma_f32 v74,v74,s36,v13
v_fma_f32 v75,v75,s36,v13
v_mfma_f32_16x16x32_bf16 v[92:95],a[148:151],a[52:55],v[92:95]
ds_read_b128 a[148:151],v1 offset:128
v_exp_f32 v72,v72
v_mfma_f32_16x16x32_bf16 v[92:95],a[120:123],a[56:59],v[92:95]
ds_read_b128 a[120:123],v0 offset:256
v_exp_f32 v73,v73
v_mfma_f32_16x16x32_bf16 v[92:95],a[124:127],a[60:63],v[92:95]
ds_read_b128 a[124:127],v1 offset:256
v_exp_f32 v74,v74
v_mfma_f32_16x16x32_bf16 v[92:95],a[128:131],a[64:67],v[92:95]
ds_read_b128 a[128:131],v0 offset:6144
v_exp_f32 v75,v75
buffer_load_dwordx4 v6,s[8:11],s21 offen offset:0 lds
v_pk_mul_f32 v[208:209],v[208:209],v[62:63] op_sel_hi:[1,0]
v_pk_mul_f32 v[210:211],v[210:211],v[62:63] op_sel_hi:[1,0]
v_pk_mul_f32 v[224:225],v[224:225],v[62:63] op_sel_hi:[1,0]
v_pk_mul_f32 v[226:227],v[226:227],v[62:63] op_sel_hi:[1,0]
v_cvt_pk_bf16_f32 v20,v72,v73
v_cvt_pk_bf16_f32 v21,v74,v75
v_mfma_f32_16x16x32_bf16 v[92:95],a[132:135],a[68:71],v[92:95]
ds_read_b128 a[132:135],v1 offset:6144
v_max3_f32 v48,v48,v83,v84
v_max3_f32 v48,v48,v85,v86
v_max_f32 v48,v48,v87
v_mov_b32 v49,v48
v_cvt_pk_bf16_f32 v197,v198,v199
v_cvt_pk_bf16_f32 v184,v184,v185
v_permlane32_swap_b32 v49,v48
s_waitcnt lgkmcnt(2)
v_mfma_f32_16x16x32_bf16 v[96:99],a[124:127],a[92:95],0
ds_write2st64_b64 v37,v[180:181],v[196:197] offset0:2 offset1:4
v_mfma_f32_16x16x32_bf16 v[96:99],a[120:123],a[88:91],v[96:99]
v_max_f32 v48,v48,v49
v_mov_b32 v49,v48
buffer_load_dwordx4 v7,s[8:11],s21 offen offset:1024 lds
v_pk_mul_f32 v[212:213],v[212:213],v[62:63] op_sel_hi:[1,0]
v_pk_mul_f32 v[214:215],v[214:215],v[62:63] op_sel_hi:[1,0]
v_pk_mul_f32 v[228:229],v[228:229],v[62:63] op_sel_hi:[1,0]
v_pk_mul_f32 v[230:231],v[230:231],v[62:63] op_sel_hi:[1,0]
v_permlane16_swap_b32 v49,v48
v_max_f32 v48,v48,v49
v_mfma_f32_16x16x32_bf16 v[96:99],a[148:151],a[84:87],v[96:99]
v_mul_f32_e64 v14,-s36,v48
v_fma_f32 v80,v80,s36,v14
v_mfma_f32_16x16x32_bf16 v[96:99],a[144:147],a[80:83],v[96:99]
v_fma_f32 v81,v81,s36,v14
v_fma_f32 v82,v82,s36,v14
v_mfma_f32_16x16x32_bf16 v[96:99],a[140:143],a[76:79],v[96:99]
v_fma_f32 v83,v83,s36,v14
v_exp_f32 v80,v80
v_mfma_f32_16x16x32_bf16 v[96:99],a[136:139],a[72:75],v[96:99]
v_exp_f32 v81,v81
v_exp_f32 v82,v82
v_exp_f32 v83,v83
buffer_load_dwordx4 v8,s[8:11],s21 offen offset:2048 lds
v_pk_mul_f32 v[216:217],v[216:217],v[62:63] op_sel_hi:[1,0]
v_pk_mul_f32 v[218:219],v[218:219],v[62:63] op_sel_hi:[1,0]
v_pk_mul_f32 v[232:233],v[232:233],v[62:63] op_sel_hi:[1,0]
v_pk_mul_f32 v[234:235],v[234:235],v[62:63] op_sel_hi:[1,0]
v_cvt_pk_bf16_f32 v24,v80,v81
v_cvt_pk_bf16_f32 v25,v82,v83
v_mfma_f32_16x16x32_bf16 v[104:107],a[136:139],a[96:99],0
s_add_u32 s21,s21,12288
ds_read_b128 a[136:139],v0 offset:6272
v_max3_f32 v52,v52,v91,v92
v_mfma_f32_16x16x32_bf16 v[104:107],a[140:143],a[100:103],v[104:107]
s_add_u32 m0,s22,0
ds_read_b128 a[140:143],v1 offset:6272
v_max3_f32 v52,v52,v93,v94
v_mfma_f32_16x16x32_bf16 v[104:107],a[144:147],a[104:107],v[104:107]
ds_read_b128 a[144:147],v0 offset:6400
v_max_f32 v52,v52,v95
v_mfma_f32_16x16x32_bf16 v[104:107],a[148:151],a[108:111],v[104:107]
ds_read_b128 a[148:151],v1 offset:6400
v_mov_b32 v53,v52
v_max3_f32 v56,v96,v97,v98
v_cvt_pk_bf16_f32 v200,v200,v201
v_permlane32_swap_b32 v53,v52
v_pk_mul_f32 v[220:221],v[220:221],v[62:63] op_sel_hi:[1,0]
v_pk_mul_f32 v[222:223],v[222:223],v[62:63] op_sel_hi:[1,0]
v_pk_mul_f32 v[236:237],v[236:237],v[62:63] op_sel_hi:[1,0]
v_pk_mul_f32 v[238:239],v[238:239],v[62:63] op_sel_hi:[1,0]
v_max_f32 v52,v52,v53
v_mov_b32 v53,v52
v_mfma_f32_16x16x32_bf16 v[104:107],a[120:123],a[112:115],v[104:107]
ds_read_b128 a[120:123],v0 offset:12544
v_permlane16_swap_b32 v53,v52
v_mfma_f32_16x16x32_bf16 v[104:107],a[124:127],a[116:119],v[104:107]
s_waitcnt lgkmcnt(4)
ds_read_b128 a[124:127],v1 offset:12544
v_max_f32 v52,v52,v53
v_mfma_f32_16x16x32_bf16 v[100:103],a[128:131],a[72:75],0
v_mul_f32_e64 v15,-s36,v52
v_fma_f32 v88,v88,s36,v15
v_fma_f32 v89,v89,s36,v15
v_fma_f32 v90,v90,s36,v15
v_fma_f32 v91,v91,s36,v15
v_pk_mul_f32 v[240:241],v[240:241],v[62:63] op_sel_hi:[1,0]
v_pk_mul_f32 v[242:243],v[242:243],v[62:63] op_sel_hi:[1,0]
v_exp_f32 v88,v88
v_exp_f32 v89,v89
v_mfma_f32_16x16x32_bf16 v[100:103],a[132:135],a[76:79],v[100:103]
v_exp_f32 v90,v90
v_mfma_f32_16x16x32_bf16 v[100:103],a[136:139],a[80:83],v[100:103]
s_waitcnt lgkmcnt(2)
v_exp_f32 v91,v91
v_mfma_f32_16x16x32_bf16 v[100:103],a[140:143],a[84:87],v[100:103]
v_cvt_pk_bf16_f32 v28,v88,v89
v_cvt_pk_bf16_f32 v29,v90,v91
v_mfma_f32_16x16x32_bf16 v[100:103],a[144:147],a[88:91],v[100:103]
v_max3_f32 v40,v104,v105,v106
v_cvt_pk_bf16_f32 v188,v188,v189
v_cvt_pk_bf16_f32 v204,v204,v205
v_cvt_pk_bf16_f32 v185,v186,v187
v_cvt_pk_bf16_f32 v201,v202,v203
ds_write2st64_b64 v38,v[184:185],v[200:201] offset0:2 offset1:4
v_pk_mul_f32 v[244:245],v[244:245],v[62:63] op_sel_hi:[1,0]
v_pk_mul_f32 v[246:247],v[246:247],v[62:63] op_sel_hi:[1,0]
v_cvt_pk_bf16_f32 v208,v208,v209
v_cvt_pk_bf16_f32 v224,v224,v225
v_mfma_f32_16x16x32_bf16 v[100:103],a[148:151],a[92:95],v[100:103]
v_cvt_pk_bf16_f32 v189,v190,v191
v_cvt_pk_bf16_f32 v205,v206,v207
v_mfma_f32_16x16x32_bf16 v[108:111],a[148:151],a[116:119],0
ds_read_b128 a[148:151],v1 offset:12416
v_cvt_pk_bf16_f32 v212,v212,v213
v_mfma_f32_16x16x32_bf16 v[108:111],a[144:147],a[112:115],v[108:111]
ds_read_b128 a[144:147],v0 offset:12416
v_cvt_pk_bf16_f32 v228,v228,v229
ds_write2st64_b64 v39,v[188:189],v[204:205] offset0:2 offset1:4
v_pk_mul_f32 v[248:249],v[248:249],v[62:63] op_sel_hi:[1,0]
v_pk_mul_f32 v[250:251],v[250:251],v[62:63] op_sel_hi:[1,0]
v_max3_f32 v56,v56,v99,v100
v_max3_f32 v56,v56,v101,v102
v_mfma_f32_16x16x32_bf16 v[108:111],a[140:143],a[108:111],v[108:111]
ds_read_b128 a[140:143],v1 offset:12288
v_max_f32 v56,v56,v103
v_mfma_f32_16x16x32_bf16 v[108:111],a[136:139],a[104:107],v[108:111]
ds_read_b128 a[136:139],v0 offset:12288
v_mov_b32 v57,v56
v_mfma_f32_16x16x32_bf16 v[108:111],a[132:135],a[100:103],v[108:111]
ds_read_b128 a[132:135],v1 offset:18432
v_permlane32_swap_b32 v57,v56
v_mfma_f32_16x16x32_bf16 v[108:111],a[128:131],a[96:99],v[108:111]
ds_read_b128 a[128:131],v0 offset:18432
v_max_f32 v56,v56,v57
v_mov_b32 v57,v56
v_cvt_pk_bf16_f32 v209,v210,v211
v_cvt_pk_bf16_f32 v225,v226,v227
ds_write2st64_b64 v36,v[208:209],v[224:225] offset0:12 offset1:14
v_pk_mul_f32 v[252:253],v[252:253],v[62:63] op_sel_hi:[1,0]
v_pk_mul_f32 v[254:255],v[254:255],v[62:63] op_sel_hi:[1,0]
v_permlane16_swap_b32 v57,v56
v_max_f32 v56,v56,v57
v_mul_f32_e64 v16,-s36,v56
v_fma_f32 v96,v96,s36,v16
v_fma_f32 v97,v97,s36,v16
v_fma_f32 v98,v98,s36,v16
s_waitcnt lgkmcnt(3)
v_mfma_f32_16x16x32_bf16 v[72:75],a[136:139],a[0:3],0
v_fma_f32 v99,v99,s36,v16
v_exp_f32 v96,v96
v_mfma_f32_16x16x32_bf16 v[72:75],a[140:143],a[4:7],v[72:75]
v_exp_f32 v97,v97
v_mfma_f32_16x16x32_bf16 v[72:75],a[144:147],a[8:11],v[72:75]
v_exp_f32 v98,v98
v_mfma_f32_16x16x32_bf16 v[72:75],a[148:151],a[12:15],v[72:75]
v_exp_f32 v99,v99
v_mfma_f32_16x16x32_bf16 v[72:75],a[120:123],a[16:19],v[72:75]
v_cvt_pk_bf16_f32 v32,v96,v97
v_cvt_pk_bf16_f32 v33,v98,v99
v_mfma_f32_16x16x32_bf16 v[72:75],a[124:127],a[20:23],v[72:75]
v_max3_f32 v40,v40,v107,v108
v_max3_f32 v40,v40,v109,v110
v_mfma_f32_16x16x32_bf16 v[80:83],a[124:127],a[44:47],0
v_max_f32 v40,v40,v111
v_mov_b32 v41,v40
v_mfma_f32_16x16x32_bf16 v[80:83],a[120:123],a[40:43],v[80:83]
v_cvt_pk_bf16_f32 v216,v216,v217
v_permlane32_swap_b32 v41,v40
v_mfma_f32_16x16x32_bf16 v[80:83],a[148:151],a[36:39],v[80:83]
v_max_f32 v40,v40,v41
v_mov_b32 v41,v40
v_mfma_f32_16x16x32_bf16 v[80:83],a[144:147],a[32:35],v[80:83]
v_cvt_pk_bf16_f32 v232,v232,v233
v_permlane16_swap_b32 v41,v40
v_mfma_f32_16x16x32_bf16 v[80:83],a[140:143],a[28:31],v[80:83]
v_cvt_pk_bf16_f32 v213,v214,v215
v_cvt_pk_bf16_f32 v229,v230,v231
v_mfma_f32_16x16x32_bf16 v[80:83],a[136:139],a[24:27],v[80:83]
ds_write2st64_b64 v37,v[212:213],v[228:229] offset0:12 offset1:14
v_mfma_f32_16x16x32_bf16 v[88:91],a[136:139],a[48:51],0
v_max_f32 v40,v40,v41
v_cvt_pk_bf16_f32 v220,v220,v221
v_mfma_f32_16x16x32_bf16 v[88:91],a[140:143],a[52:55],v[88:91]
v_cvt_pk_bf16_f32 v236,v236,v237
v_cvt_pk_bf16_f32 v217,v218,v219
v_mfma_f32_16x16x32_bf16 v[88:91],a[144:147],a[56:59],v[88:91]
v_cvt_pk_bf16_f32 v233,v234,v235
v_mul_f32_e64 v17,-s36,v40
v_mfma_f32_16x16x32_bf16 v[88:91],a[148:151],a[60:63],v[88:91]
ds_write2st64_b64 v38,v[216:217],v[232:233] offset0:12 offset1:14
v_mfma_f32_16x16x32_bf16 v[88:91],a[120:123],a[64:67],v[88:91]
v_cvt_pk_bf16_f32 v240,v240,v241
v_cvt_pk_bf16_f32 v221,v222,v223
v_mfma_f32_16x16x32_bf16 v[88:91],a[124:127],a[68:71],v[88:91]
v_cvt_pk_bf16_f32 v237,v238,v239
v_fma_f32 v104,v104,s36,v17
v_mfma_f32_16x16x32_bf16 v[96:99],a[124:127],a[92:95],0
v_fma_f32 v105,v105,s36,v17
v_fma_f32 v106,v106,s36,v17
v_mfma_f32_16x16x32_bf16 v[96:99],a[120:123],a[88:91],v[96:99]
ds_write2st64_b64 v39,v[220:221],v[236:237] offset0:12 offset1:14
v_mfma_f32_16x16x32_bf16 v[96:99],a[148:151],a[84:87],v[96:99]
v_fma_f32 v107,v107,s36,v17
v_cvt_pk_bf16_f32 v244,v244,v245
v_mfma_f32_16x16x32_bf16 v[96:99],a[144:147],a[80:83],v[96:99]
v_cvt_pk_bf16_f32 v241,v242,v243
v_exp_f32 v104,v104
v_mfma_f32_16x16x32_bf16 v[96:99],a[140:143],a[76:79],v[96:99]
v_exp_f32 v105,v105
v_mfma_f32_16x16x32_bf16 v[96:99],a[136:139],a[72:75],v[96:99]
ds_write_b64 v36,v[240:241] offset:8192
v_exp_f32 v106,v106
v_exp_f32 v107,v107
v_cvt_pk_bf16_f32 v245,v246,v247
ds_write_b64 v37,v[244:245] offset:8192
v_cvt_pk_bf16_f32 v36,v104,v105
v_cvt_pk_bf16_f32 v37,v106,v107
v_mfma_f32_16x16x32_bf16 v[104:107],a[136:139],a[96:99],0
ds_read_b128 a[136:139],v0 offset:18560
v_fma_f32 v76,v76,s36,v13
v_mfma_f32_16x16x32_bf16 v[104:107],a[140:143],a[100:103],v[104:107]
ds_read_b128 a[140:143],v1 offset:18560
v_fma_f32 v77,v77,s36,v13
v_mfma_f32_16x16x32_bf16 v[104:107],a[144:147],a[104:107],v[104:107]
ds_read_b128 a[144:147],v0 offset:18688
v_fma_f32 v78,v78,s36,v13
v_mfma_f32_16x16x32_bf16 v[104:107],a[148:151],a[108:111],v[104:107]
ds_read_b128 a[148:151],v1 offset:18688
v_fma_f32 v79,v79,s36,v13
v_mfma_f32_16x16x32_bf16 v[104:107],a[120:123],a[112:115],v[104:107]
v_exp_f32 v76,v76
v_mfma_f32_16x16x32_bf16 v[104:107],a[124:127],a[116:119],v[104:107]
v_exp_f32 v77,v77
v_exp_f32 v78,v78
v_exp_f32 v79,v79
v_cvt_pk_bf16_f32 v22,v76,v77
v_cvt_pk_bf16_f32 v23,v78,v79
s_waitcnt lgkmcnt(4)
v_mfma_f32_16x16x32_bf16 v[76:79],a[128:131],a[0:3],0
v_fma_f32 v84,v84,s36,v14
v_fma_f32 v85,v85,s36,v14
v_mfma_f32_16x16x32_bf16 v[76:79],a[132:135],a[4:7],v[76:79]
s_waitcnt lgkmcnt(2)
v_fma_f32 v86,v86,s36,v14
v_fma_f32 v87,v87,s36,v14
v_mfma_f32_16x16x32_bf16 v[76:79],a[136:139],a[8:11],v[76:79]
v_exp_f32 v84,v84
s_waitcnt vmcnt(9)
s_barrier
v_mfma_f32_16x16x32_bf16 v[76:79],a[140:143],a[12:15],v[76:79]
buffer_load_dwordx4 v6,s[4:7],s20 offen offset:0 lds
s_waitcnt lgkmcnt(0)
v_mfma_f32_16x16x32_bf16 v[76:79],a[144:147],a[16:19],v[76:79]
v_exp_f32 v85,v85
v_mfma_f32_16x16x32_bf16 v[76:79],a[148:151],a[20:23],v[76:79]
v_exp_f32 v86,v86
v_exp_f32 v87,v87
v_cvt_pk_bf16_f32 v26,v84,v85
v_cvt_pk_bf16_f32 v27,v86,v87
v_mfma_f32_16x16x32_bf16 v[84:87],a[148:151],a[44:47],0
v_fma_f32 v92,v92,s36,v15
v_fma_f32 v93,v93,s36,v15
v_mfma_f32_16x16x32_bf16 v[84:87],a[144:147],a[40:43],v[84:87]
v_fma_f32 v94,v94,s36,v15
v_fma_f32 v95,v95,s36,v15
v_mfma_f32_16x16x32_bf16 v[84:87],a[140:143],a[36:39],v[84:87]
buffer_load_dwordx4 v7,s[4:7],s20 offen offset:1024 lds
v_mfma_f32_16x16x32_bf16 v[84:87],a[136:139],a[32:35],v[84:87]
v_exp_f32 v92,v92
v_mfma_f32_16x16x32_bf16 v[84:87],a[132:135],a[28:31],v[84:87]
v_exp_f32 v93,v93
v_mfma_f32_16x16x32_bf16 v[84:87],a[128:131],a[24:27],v[84:87]
v_exp_f32 v94,v94
ds_read_b64_tr_b16 a[120:121],v2 offset:0
ds_read_b64_tr_b16 a[122:123],v2 offset:6144
v_exp_f32 v95,v95
buffer_load_dwordx4 v8,s[4:7],s20 offen offset:2048 lds
ds_read_b64_tr_b16 a[124:125],v3 offset:0
ds_read_b64_tr_b16 a[126:127],v3 offset:6144
v_cvt_pk_bf16_f32 v30,v92,v93
v_cvt_pk_bf16_f32 v31,v94,v95
v_mfma_f32_16x16x32_bf16 v[92:95],a[128:131],a[48:51],0
s_add_u32 s20,s20,12288
v_fma_f32 v100,v100,s36,v16
v_fma_f32 v101,v101,s36,v16
v_mfma_f32_16x16x32_bf16 v[92:95],a[132:135],a[52:55],v[92:95]
v_fma_f32 v102,v102,s36,v16
v_fma_f32 v103,v103,s36,v16
v_mfma_f32_16x16x32_bf16 v[92:95],a[136:139],a[56:59],v[92:95]
v_exp_f32 v100,v100
v_mfma_f32_16x16x32_bf16 v[92:95],a[140:143],a[60:63],v[92:95]
v_exp_f32 v101,v101
v_mfma_f32_16x16x32_bf16 v[92:95],a[144:147],a[64:67],v[92:95]
v_exp_f32 v102,v102
v_mfma_f32_16x16x32_bf16 v[92:95],a[148:151],a[68:71],v[92:95]
v_exp_f32 v103,v103
v_cvt_pk_bf16_f32 v34,v100,v101
v_cvt_pk_bf16_f32 v35,v102,v103
v_mfma_f32_16x16x32_bf16 v[100:103],a[148:151],a[92:95],0
v_cvt_pk_bf16_f32 v248,v248,v249
v_fma_f32 v108,v108,s36,v17
v_smfmac_f32_16x16x64_bf16 v[64:67],a[152:155],v[28:35],v18
v_fma_f32 v109,v109,s36,v17
v_mfma_f32_16x16x32_bf16 v[100:103],a[144:147],a[88:91],v[100:103]
v_fma_f32 v110,v110,s36,v17
v_fma_f32 v111,v111,s36,v17
v_mfma_f32_16x16x32_bf16 v[100:103],a[140:143],a[84:87],v[100:103]
v_cvt_pk_bf16_f32 v252,v252,v253
v_cvt_pk_bf16_f32 v249,v250,v251
v_mfma_f32_16x16x32_bf16 v[100:103],a[136:139],a[80:83],v[100:103]
ds_write_b64 v38,v[248:249] offset:8192
v_mfma_f32_16x16x32_bf16 v[100:103],a[132:135],a[76:79],v[100:103]
v_exp_f32 v108,v108
v_mfma_f32_16x16x32_bf16 v[100:103],a[128:131],a[72:75],v[100:103]
v_exp_f32 v109,v109
v_exp_f32 v110,v110
v_exp_f32 v111,v111
v_cvt_pk_bf16_f32 v253,v254,v255
ds_write_b64 v39,v[252:253] offset:8192
v_cvt_pk_bf16_f32 v38,v108,v109
v_cvt_pk_bf16_f32 v39,v110,v111
v_mfma_f32_16x16x32_bf16 v[108:111],a[128:131],a[96:99],0
ds_read_b64_tr_b16 a[128:129],v4 offset:0
v_mov_b32 v60,0
v_mfma_f32_16x16x32_bf16 v[108:111],a[132:135],a[100:103],v[108:111]
ds_read_b64_tr_b16 a[130:131],v4 offset:6144
v_mov_b32 v61,0
v_mfma_f32_16x16x32_bf16 v[108:111],a[136:139],a[104:107],v[108:111]
ds_read_b64_tr_b16 a[132:133],v5 offset:0
v_mov_b32 v62,0
v_mfma_f32_16x16x32_bf16 v[108:111],a[140:143],a[108:111],v[108:111]
ds_read_b64_tr_b16 a[134:135],v5 offset:6144
v_mov_b32 v63,0
v_mfma_f32_16x16x32_bf16 v[108:111],a[144:147],a[112:115],v[108:111]
v_fma_f32 v72,v72,s36,v13
v_fma_f32 v73,v73,s36,v13
v_smfmac_f32_16x16x64_bf16 v[60:63],a[152:155],v[20:27],v18
v_fma_f32 v74,v74,s36,v13
v_mfma_f32_16x16x32_bf16 v[108:111],a[148:151],a[116:119],v[108:111]
v_fma_f32 v75,v75,s36,v13
v_fma_f32 v80,v80,s36,v14
v_fma_f32 v81,v81,s36,v14
v_fma_f32 v82,v82,s36,v14
v_fma_f32 v83,v83,s36,v14
v_fma_f32 v88,v88,s36,v15
v_fma_f32 v89,v89,s36,v15
v_exp_f32 v72,v72
v_exp_f32 v73,v73
v_exp_f32 v74,v74
v_exp_f32 v75,v75
v_exp_f32 v80,v80
v_exp_f32 v81,v81
v_exp_f32 v82,v82
v_exp_f32 v83,v83
v_exp_f32 v88,v88
v_exp_f32 v89,v89
v_cvt_pk_bf16_f32 v44,v72,v73
v_cvt_pk_bf16_f32 v45,v74,v75
v_cvt_pk_bf16_f32 v48,v80,v81
v_cvt_pk_bf16_f32 v49,v82,v83
v_cvt_pk_bf16_f32 v52,v88,v89
s_waitcnt lgkmcnt(0)
v_mfma_f32_16x16x32_bf16 v[160:163],a[120:123],v[20:23],0
s_add_u32 m0,s23,0
ds_read_b64_tr_b16 a[136:137],v2 offset:128
v_fma_f32 v90,v90,s36,v15
v_mfma_f32_16x16x32_bf16 v[164:167],a[124:127],v[20:23],0
ds_read_b64_tr_b16 a[138:139],v2 offset:6272
v_fma_f32 v91,v91,s36,v15
v_mfma_f32_16x16x32_bf16 v[212:215],a[124:127],v[24:27],0
ds_read_b64_tr_b16 a[140:141],v3 offset:128
v_fma_f32 v96,v96,s36,v16
v_mfma_f32_16x16x32_bf16 v[208:211],a[120:123],v[24:27],0
ds_read_b64_tr_b16 a[142:143],v3 offset:6272
v_fma_f32 v97,v97,s36,v16
v_mfma_f32_16x16x32_bf16 v[112:115],a[120:123],v[28:31],0
ds_read_b64_tr_b16 a[144:145],v4 offset:128
v_fma_f32 v98,v98,s36,v16
v_mfma_f32_16x16x32_bf16 v[116:119],a[124:127],v[28:31],0
ds_read_b64_tr_b16 a[146:147],v4 offset:6272
v_fma_f32 v99,v99,s36,v16
v_mfma_f32_16x16x32_bf16 a[164:167],a[124:127],v[32:35],0
ds_read_b64_tr_b16 a[148:149],v5 offset:128
v_fma_f32 v104,v104,s36,v17
v_mfma_f32_16x16x32_bf16 a[160:163],a[120:123],v[32:35],0
ds_read_b64_tr_b16 a[150:151],v5 offset:6272
v_fma_f32 v105,v105,s36,v17
v_mfma_f32_16x16x32_bf16 a[208:211],a[120:123],v[36:39],0
ds_read_b64_tr_b16 a[120:121],v2 offset:256
v_fma_f32 v106,v106,s36,v17
v_mfma_f32_16x16x32_bf16 a[212:215],a[124:127],v[36:39],0
ds_read_b64_tr_b16 a[122:123],v2 offset:6400
v_fma_f32 v107,v107,s36,v17
v_mfma_f32_16x16x32_bf16 a[216:219],a[128:131],v[36:39],0
ds_read_b64_tr_b16 a[124:125],v3 offset:256
v_fma_f32 v76,v76,s36,v13
v_mfma_f32_16x16x32_bf16 a[220:223],a[132:135],v[36:39],0
ds_read_b64_tr_b16 a[126:127],v3 offset:6400
v_fma_f32 v77,v77,s36,v13
v_mfma_f32_16x16x32_bf16 a[172:175],a[132:135],v[32:35],0
v_exp_f32 v90,v90
v_mfma_f32_16x16x32_bf16 a[168:171],a[128:131],v[32:35],0
v_exp_f32 v91,v91
v_mfma_f32_16x16x32_bf16 v[120:123],a[128:131],v[28:31],0
v_cvt_pk_bf16_f32 v53,v90,v91
v_fma_f32 v78,v78,s36,v13
v_mfma_f32_16x16x32_bf16 v[124:127],a[132:135],v[28:31],0
v_exp_f32 v96,v96
v_mfma_f32_16x16x32_bf16 v[220:223],a[132:135],v[24:27],0
v_exp_f32 v97,v97
v_mfma_f32_16x16x32_bf16 v[216:219],a[128:131],v[24:27],0
v_exp_f32 v98,v98
v_mfma_f32_16x16x32_bf16 v[168:171],a[128:131],v[20:23],0
ds_read_b64_tr_b16 a[128:129],v4 offset:256
v_cvt_pk_bf16_f32 v56,v96,v97
v_mfma_f32_16x16x32_bf16 v[172:175],a[132:135],v[20:23],0
s_waitcnt lgkmcnt(1)
ds_read_b64_tr_b16 a[130:131],v4 offset:6400
v_fma_f32 v79,v79,s36,v13
v_mfma_f32_16x16x32_bf16 v[176:179],a[136:139],v[20:23],0
ds_read_b64_tr_b16 a[132:133],v5 offset:256
v_fma_f32 v84,v84,s36,v14
v_mfma_f32_16x16x32_bf16 v[180:183],a[140:143],v[20:23],0
ds_read_b64_tr_b16 a[134:135],v5 offset:6400
v_fma_f32 v85,v85,s36,v14
v_mfma_f32_16x16x32_bf16 v[228:231],a[140:143],v[24:27],0
v_exp_f32 v99,v99
v_mfma_f32_16x16x32_bf16 v[224:227],a[136:139],v[24:27],0
v_cvt_pk_bf16_f32 v57,v98,v99
v_fma_f32 v86,v86,s36,v14
v_mfma_f32_16x16x32_bf16 v[128:131],a[136:139],v[28:31],0
v_exp_f32 v104,v104
v_mfma_f32_16x16x32_bf16 v[132:135],a[140:143],v[28:31],0
v_exp_f32 v105,v105
v_mfma_f32_16x16x32_bf16 a[180:183],a[140:143],v[32:35],0
v_exp_f32 v106,v106
v_mfma_f32_16x16x32_bf16 a[176:179],a[136:139],v[32:35],0
v_exp_f32 v107,v107
v_mfma_f32_16x16x32_bf16 a[224:227],a[136:139],v[36:39],0
v_cvt_pk_bf16_f32 v40,v104,v105
v_cvt_pk_bf16_f32 v41,v106,v107
v_mfma_f32_16x16x32_bf16 a[228:231],a[140:143],v[36:39],0
v_exp_f32 v76,v76
v_mfma_f32_16x16x32_bf16 a[232:235],a[144:147],v[36:39],0
v_exp_f32 v77,v77
v_mfma_f32_16x16x32_bf16 a[236:239],a[148:151],v[36:39],0
v_exp_f32 v78,v78
v_mfma_f32_16x16x32_bf16 a[188:191],a[148:151],v[32:35],0
v_exp_f32 v79,v79
v_mfma_f32_16x16x32_bf16 a[184:187],a[144:147],v[32:35],0
v_cvt_pk_bf16_f32 v46,v76,v77
v_cvt_pk_bf16_f32 v47,v78,v79
v_mfma_f32_16x16x32_bf16 v[136:139],a[144:147],v[28:31],0
v_fma_f32 v87,v87,s36,v14
v_fma_f32 v92,v92,s36,v15
v_mfma_f32_16x16x32_bf16 v[140:143],a[148:151],v[28:31],0
v_exp_f32 v84,v84
v_mfma_f32_16x16x32_bf16 v[236:239],a[148:151],v[24:27],0
v_exp_f32 v85,v85
v_mfma_f32_16x16x32_bf16 v[232:235],a[144:147],v[24:27],0
v_exp_f32 v86,v86
v_mfma_f32_16x16x32_bf16 v[184:187],a[144:147],v[20:23],0
v_exp_f32 v87,v87
v_mfma_f32_16x16x32_bf16 v[188:191],a[148:151],v[20:23],0
v_cvt_pk_bf16_f32 v50,v84,v85
v_cvt_pk_bf16_f32 v51,v86,v87
v_mfma_f32_16x16x32_bf16 v[192:195],a[120:123],v[20:23],0
v_fma_f32 v93,v93,s36,v15
v_fma_f32 v94,v94,s36,v15
v_smfmac_f32_16x16x64_bf16 v[60:63],a[152:155],v[44:51],v18
v_fma_f32 v95,v95,s36,v15
v_mfma_f32_16x16x32_bf16 v[196:199],a[124:127],v[20:23],0
s_waitcnt vmcnt(36) lgkmcnt(0)
v_exp_f32 v92,v92
v_mfma_f32_16x16x32_bf16 v[244:247],a[124:127],v[24:27],0
s_barrier
v_mfma_f32_16x16x32_bf16 v[240:243],a[120:123],v[24:27],0
ds_read_b128 a[136:139],v0 offset:24576
v_fma_f32 v100,v100,s36,v16
v_mfma_f32_16x16x32_bf16 v[144:147],a[120:123],v[28:31],0
ds_read_b128 a[140:143],v1 offset:24576
v_fma_f32 v101,v101,s36,v16
v_mfma_f32_16x16x32_bf16 v[148:151],a[124:127],v[28:31],0
ds_read_b128 a[144:147],v0 offset:24704
v_fma_f32 v102,v102,s36,v16
v_mfma_f32_16x16x32_bf16 a[196:199],a[124:127],v[32:35],0
ds_read_b128 a[148:151],v1 offset:24704
v_fma_f32 v103,v103,s36,v16
v_mfma_f32_16x16x32_bf16 a[192:195],a[120:123],v[32:35],0
v_exp_f32 v93,v93
v_mfma_f32_16x16x32_bf16 a[240:243],a[120:123],v[36:39],0
buffer_load_dwordx4 v6,s[8:11],s21 offen offset:0 lds
v_mfma_f32_16x16x32_bf16 a[244:247],a[124:127],v[36:39],0
ds_read_b128 a[120:123],v0 offset:24832
v_cvt_pk_bf16_f32 v54,v92,v93
v_mfma_f32_16x16x32_bf16 a[248:251],a[128:131],v[36:39],0
ds_read_b128 a[124:127],v1 offset:24832
v_fma_f32 v108,v108,s36,v17
v_mfma_f32_16x16x32_bf16 a[252:255],a[132:135],v[36:39],0
v_exp_f32 v94,v94
v_mfma_f32_16x16x32_bf16 a[204:207],a[132:135],v[32:35],0
v_exp_f32 v95,v95
v_mfma_f32_16x16x32_bf16 a[200:203],a[128:131],v[32:35],0
v_cvt_pk_bf16_f32 v55,v94,v95
v_fma_f32 v109,v109,s36,v17
v_mfma_f32_16x16x32_bf16 v[152:155],a[128:131],v[28:31],0
v_exp_f32 v100,v100
v_mfma_f32_16x16x32_bf16 v[156:159],a[132:135],v[28:31],0
v_exp_f32 v101,v101
v_mfma_f32_16x16x32_bf16 v[252:255],a[132:135],v[24:27],0
v_exp_f32 v102,v102
v_mfma_f32_16x16x32_bf16 v[248:251],a[128:131],v[24:27],0
v_exp_f32 v103,v103
v_mfma_f32_16x16x32_bf16 v[200:203],a[128:131],v[20:23],0
ds_read_b128 a[128:131],v0 offset:30720
v_cvt_pk_bf16_f32 v58,v100,v101
v_mfma_f32_16x16x32_bf16 v[204:207],a[132:135],v[20:23],0
buffer_load_dwordx4 v7,s[8:11],s21 offen offset:1024 lds
s_waitcnt lgkmcnt(1)
v_mfma_f32_16x16x32_bf16 v[72:75],a[136:139],a[0:3],0
ds_read_b128 a[132:135],v1 offset:30720
v_cvt_pk_bf16_f32 v59,v102,v103
v_mfma_f32_16x16x32_bf16 v[72:75],a[140:143],a[4:7],v[72:75]
v_fma_f32 v110,v110,s36,v17
v_fma_f32 v111,v111,s36,v17
v_smfmac_f32_16x16x64_bf16 v[64:67],a[152:155],v[52:59],v18
v_mfma_f32_16x16x32_bf16 v[72:75],a[144:147],a[8:11],v[72:75]
v_exp_f32 v108,v108
v_mfma_f32_16x16x32_bf16 v[72:75],a[148:151],a[12:15],v[72:75]
v_exp_f32 v109,v109
v_mfma_f32_16x16x32_bf16 v[72:75],a[120:123],a[16:19],v[72:75]
v_exp_f32 v110,v110
v_mfma_f32_16x16x32_bf16 v[72:75],a[124:127],a[20:23],v[72:75]
v_exp_f32 v111,v111
v_mfma_f32_16x16x32_bf16 v[80:83],a[124:127],a[44:47],0
v_cvt_pk_bf16_f32 v42,v108,v109
v_cvt_pk_bf16_f32 v43,v110,v111
v_mfma_f32_16x16x32_bf16 v[80:83],a[120:123],a[40:43],v[80:83]
v_mfma_f32_16x16x32_bf16 v[80:83],a[148:151],a[36:39],v[80:83]
v_smfmac_f32_16x16x64_bf16 v[68:71],a[152:155],v[36:43],v18
buffer_load_dwordx4 v8,s[8:11],s21 offen offset:2048 lds
v_mfma_f32_16x16x32_bf16 v[80:83],a[144:147],a[32:35],v[80:83]
s_add_u32 s21,s21,12288
v_fma_f32 v72,v72,s36,v13
v_fma_f32 v73,v73,s36,v13
v_mfma_f32_16x16x32_bf16 v[80:83],a[140:143],a[28:31],v[80:83]
s_add_u32 m0,s22,12288
v_fma_f32 v74,v74,s36,v13
v_fma_f32 v75,v75,s36,v13
v_mfma_f32_16x16x32_bf16 v[80:83],a[136:139],a[24:27],v[80:83]
v_exp_f32 v72,v72
v_mfma_f32_16x16x32_bf16 v[88:91],a[136:139],a[48:51],0
v_exp_f32 v73,v73
v_mfma_f32_16x16x32_bf16 v[88:91],a[140:143],a[52:55],v[88:91]
v_exp_f32 v74,v74
v_mfma_f32_16x16x32_bf16 v[88:91],a[144:147],a[56:59],v[88:91]
v_exp_f32 v75,v75
v_mfma_f32_16x16x32_bf16 v[88:91],a[148:151],a[60:63],v[88:91]
v_fma_f32 v80,v80,s36,v14
v_fma_f32 v81,v81,s36,v14
v_mfma_f32_16x16x32_bf16 v[88:91],a[120:123],a[64:67],v[88:91]
v_fma_f32 v82,v82,s36,v14
v_fma_f32 v83,v83,s36,v14
v_mfma_f32_16x16x32_bf16 v[88:91],a[124:127],a[68:71],v[88:91]
v_exp_f32 v80,v80
v_mfma_f32_16x16x32_bf16 v[96:99],a[124:127],a[92:95],0
v_exp_f32 v81,v81
v_mfma_f32_16x16x32_bf16 v[96:99],a[120:123],a[88:91],v[96:99]
buffer_load_dwordx4 v6,s[4:7],s20 offen offset:0 lds
v_mfma_f32_16x16x32_bf16 v[96:99],a[148:151],a[84:87],v[96:99]
v_exp_f32 v82,v82
v_mfma_f32_16x16x32_bf16 v[96:99],a[144:147],a[80:83],v[96:99]
v_fma_f32 v88,v88,s36,v15
v_fma_f32 v89,v89,s36,v15
v_mfma_f32_16x16x32_bf16 v[96:99],a[140:143],a[76:79],v[96:99]
v_exp_f32 v83,v83
v_mfma_f32_16x16x32_bf16 v[96:99],a[136:139],a[72:75],v[96:99]
v_exp_f32 v88,v88
v_mfma_f32_16x16x32_bf16 v[104:107],a[136:139],a[96:99],0
ds_read_b128 a[136:139],v0 offset:30848
v_cvt_pk_bf16_f32 v20,v72,v73
v_mfma_f32_16x16x32_bf16 v[104:107],a[140:143],a[100:103],v[104:107]
ds_read_b128 a[140:143],v1 offset:30848
v_cvt_pk_bf16_f32 v21,v74,v75
v_mfma_f32_16x16x32_bf16 v[104:107],a[144:147],a[104:107],v[104:107]
ds_read_b128 a[144:147],v0 offset:30976
v_cvt_pk_bf16_f32 v24,v80,v81
v_mfma_f32_16x16x32_bf16 v[104:107],a[148:151],a[108:111],v[104:107]
ds_read_b128 a[148:151],v1 offset:30976
v_cvt_pk_bf16_f32 v25,v82,v83
v_mfma_f32_16x16x32_bf16 v[104:107],a[120:123],a[112:115],v[104:107]
v_exp_f32 v89,v89
v_mfma_f32_16x16x32_bf16 v[104:107],a[124:127],a[116:119],v[104:107]
s_waitcnt lgkmcnt(4)
v_cvt_pk_bf16_f32 v28,v88,v89
v_mfma_f32_16x16x32_bf16 v[76:79],a[128:131],a[0:3],0
v_mfma_f32_16x16x32_bf16 v[76:79],a[132:135],a[4:7],v[76:79]
buffer_load_dwordx4 v7,s[4:7],s20 offen offset:1024 lds
s_waitcnt lgkmcnt(3)
v_mfma_f32_16x16x32_bf16 v[76:79],a[136:139],a[8:11],v[76:79]
s_waitcnt lgkmcnt(2)
v_mfma_f32_16x16x32_bf16 v[76:79],a[140:143],a[12:15],v[76:79]
s_waitcnt lgkmcnt(1)
v_mfma_f32_16x16x32_bf16 v[76:79],a[144:147],a[16:19],v[76:79]
s_waitcnt lgkmcnt(0)
v_mfma_f32_16x16x32_bf16 v[76:79],a[148:151],a[20:23],v[76:79]
v_mfma_f32_16x16x32_bf16 v[84:87],a[148:151],a[44:47],0
v_mfma_f32_16x16x32_bf16 v[84:87],a[144:147],a[40:43],v[84:87]
v_mfma_f32_16x16x32_bf16 v[84:87],a[140:143],a[36:39],v[84:87]
v_mfma_f32_16x16x32_bf16 v[84:87],a[136:139],a[32:35],v[84:87]
v_mfma_f32_16x16x32_bf16 v[84:87],a[132:135],a[28:31],v[84:87]
v_mfma_f32_16x16x32_bf16 v[84:87],a[128:131],a[24:27],v[84:87]
v_mfma_f32_16x16x32_bf16 v[92:95],a[128:131],a[48:51],0
buffer_load_dwordx4 v8,s[4:7],s20 offen offset:2048 lds
v_mfma_f32_16x16x32_bf16 v[92:95],a[132:135],a[52:55],v[92:95]
s_add_u32 s20,s20,12288
v_mfma_f32_16x16x32_bf16 v[92:95],a[136:139],a[56:59],v[92:95]
v_mfma_f32_16x16x32_bf16 v[92:95],a[140:143],a[60:63],v[92:95]
v_mfma_f32_16x16x32_bf16 v[92:95],a[144:147],a[64:67],v[92:95]
v_mfma_f32_16x16x32_bf16 v[92:95],a[148:151],a[68:71],v[92:95]
ds_read_b64_tr_b16 a[120:121],v2 offset:12288
v_mfma_f32_16x16x32_bf16 v[100:103],a[148:151],a[92:95],0
ds_read_b64_tr_b16 a[122:123],v2 offset:18432
v_mfma_f32_16x16x32_bf16 v[100:103],a[144:147],a[88:91],v[100:103]
v_mfma_f32_16x16x32_bf16 v[100:103],a[140:143],a[84:87],v[100:103]
ds_read_b64_tr_b16 a[124:125],v3 offset:12288
v_mfma_f32_16x16x32_bf16 v[100:103],a[136:139],a[80:83],v[100:103]
ds_read_b64_tr_b16 a[126:127],v3 offset:18432
v_mfma_f32_16x16x32_bf16 v[100:103],a[132:135],a[76:79],v[100:103]
v_mfma_f32_16x16x32_bf16 v[100:103],a[128:131],a[72:75],v[100:103]
v_mfma_f32_16x16x32_bf16 v[108:111],a[128:131],a[96:99],0
ds_read_b64_tr_b16 a[128:129],v4 offset:12288
v_mfma_f32_16x16x32_bf16 v[108:111],a[132:135],a[100:103],v[108:111]
ds_read_b64_tr_b16 a[130:131],v4 offset:18432
v_mfma_f32_16x16x32_bf16 v[108:111],a[136:139],a[104:107],v[108:111]
ds_read_b64_tr_b16 a[132:133],v5 offset:12288
v_mfma_f32_16x16x32_bf16 v[108:111],a[140:143],a[108:111],v[108:111]
ds_read_b64_tr_b16 a[134:135],v5 offset:18432
v_mfma_f32_16x16x32_bf16 v[108:111],a[144:147],a[112:115],v[108:111]
v_mfma_f32_16x16x32_bf16 v[108:111],a[148:151],a[116:119],v[108:111]
s_waitcnt lgkmcnt(4)
v_mfma_f32_16x16x32_bf16 v[160:163],a[120:123],v[44:47],v[160:163]
s_add_u32 m0,s23,12288
ds_read_b64_tr_b16 a[136:137],v2 offset:12416
v_fma_f32 v90,v90,s36,v15
v_mfma_f32_16x16x32_bf16 v[164:167],a[124:127],v[44:47],v[164:167]
ds_read_b64_tr_b16 a[138:139],v2 offset:18560
v_fma_f32 v91,v91,s36,v15
v_mfma_f32_16x16x32_bf16 v[212:215],a[124:127],v[48:51],v[212:215]
ds_read_b64_tr_b16 a[140:141],v3 offset:12416
v_fma_f32 v96,v96,s36,v16
v_mfma_f32_16x16x32_bf16 v[208:211],a[120:123],v[48:51],v[208:211]
ds_read_b64_tr_b16 a[142:143],v3 offset:18560
v_fma_f32 v97,v97,s36,v16
v_mfma_f32_16x16x32_bf16 v[112:115],a[120:123],v[52:55],v[112:115]
ds_read_b64_tr_b16 a[144:145],v4 offset:12416
v_fma_f32 v98,v98,s36,v16
v_mfma_f32_16x16x32_bf16 v[116:119],a[124:127],v[52:55],v[116:119]
ds_read_b64_tr_b16 a[146:147],v4 offset:18560
v_fma_f32 v99,v99,s36,v16
v_mfma_f32_16x16x32_bf16 a[164:167],a[124:127],v[56:59],a[164:167]
ds_read_b64_tr_b16 a[148:149],v5 offset:12416
v_fma_f32 v104,v104,s36,v17
v_mfma_f32_16x16x32_bf16 a[160:163],a[120:123],v[56:59],a[160:163]
ds_read_b64_tr_b16 a[150:151],v5 offset:18560
v_fma_f32 v105,v105,s36,v17
v_mfma_f32_16x16x32_bf16 a[208:211],a[120:123],v[40:43],a[208:211]
ds_read_b64_tr_b16 a[120:121],v2 offset:12544
v_fma_f32 v106,v106,s36,v17
v_mfma_f32_16x16x32_bf16 a[212:215],a[124:127],v[40:43],a[212:215]
s_waitcnt lgkmcnt(6)
ds_read_b64_tr_b16 a[122:123],v2 offset:18688
v_fma_f32 v107,v107,s36,v17
v_mfma_f32_16x16x32_bf16 a[216:219],a[128:131],v[40:43],a[216:219]
ds_read_b64_tr_b16 a[124:125],v3 offset:12544
v_fma_f32 v76,v76,s36,v13
v_mfma_f32_16x16x32_bf16 a[220:223],a[132:135],v[40:43],a[220:223]
ds_read_b64_tr_b16 a[126:127],v3 offset:18688
v_fma_f32 v77,v77,s36,v13
v_mfma_f32_16x16x32_bf16 a[172:175],a[132:135],v[56:59],a[172:175]
v_exp_f32 v90,v90
v_mfma_f32_16x16x32_bf16 a[168:171],a[128:131],v[56:59],a[168:171]
v_exp_f32 v91,v91
v_mfma_f32_16x16x32_bf16 v[120:123],a[128:131],v[52:55],v[120:123]
v_cvt_pk_bf16_f32 v29,v90,v91
v_fma_f32 v78,v78,s36,v13
v_mfma_f32_16x16x32_bf16 v[124:127],a[132:135],v[52:55],v[124:127]
v_exp_f32 v96,v96
v_mfma_f32_16x16x32_bf16 v[220:223],a[132:135],v[48:51],v[220:223]
v_exp_f32 v97,v97
v_mfma_f32_16x16x32_bf16 v[216:219],a[128:131],v[48:51],v[216:219]
v_exp_f32 v98,v98
v_mfma_f32_16x16x32_bf16 v[168:171],a[128:131],v[44:47],v[168:171]
ds_read_b64_tr_b16 a[128:129],v4 offset:12544
v_cvt_pk_bf16_f32 v32,v96,v97
v_mfma_f32_16x16x32_bf16 v[172:175],a[132:135],v[44:47],v[172:175]
ds_read_b64_tr_b16 a[130:131],v4 offset:18688
v_fma_f32 v79,v79,s36,v13
v_mfma_f32_16x16x32_bf16 v[176:179],a[136:139],v[44:47],v[176:179]
s_waitcnt lgkmcnt(2)
ds_read_b64_tr_b16 a[132:133],v5 offset:12544
v_fma_f32 v84,v84,s36,v14
v_mfma_f32_16x16x32_bf16 v[180:183],a[140:143],v[44:47],v[180:183]
ds_read_b64_tr_b16 a[134:135],v5 offset:18688
v_fma_f32 v85,v85,s36,v14
v_mfma_f32_16x16x32_bf16 v[228:231],a[140:143],v[48:51],v[228:231]
v_exp_f32 v99,v99
v_mfma_f32_16x16x32_bf16 v[224:227],a[136:139],v[48:51],v[224:227]
v_cvt_pk_bf16_f32 v33,v98,v99
v_fma_f32 v86,v86,s36,v14
v_mfma_f32_16x16x32_bf16 v[128:131],a[136:139],v[52:55],v[128:131]
v_exp_f32 v104,v104
v_mfma_f32_16x16x32_bf16 v[132:135],a[140:143],v[52:55],v[132:135]
v_exp_f32 v105,v105
v_mfma_f32_16x16x32_bf16 a[180:183],a[140:143],v[56:59],a[180:183]
v_exp_f32 v106,v106
v_mfma_f32_16x16x32_bf16 a[176:179],a[136:139],v[56:59],a[176:179]
v_exp_f32 v107,v107
v_mfma_f32_16x16x32_bf16 a[224:227],a[136:139],v[40:43],a[224:227]
v_cvt_pk_bf16_f32 v36,v104,v105
v_cvt_pk_bf16_f32 v37,v106,v107
v_mfma_f32_16x16x32_bf16 a[228:231],a[140:143],v[40:43],a[228:231]
v_exp_f32 v76,v76
v_mfma_f32_16x16x32_bf16 a[232:235],a[144:147],v[40:43],a[232:235]
v_exp_f32 v77,v77
v_mfma_f32_16x16x32_bf16 a[236:239],a[148:151],v[40:43],a[236:239]
v_exp_f32 v78,v78
v_mfma_f32_16x16x32_bf16 a[188:191],a[148:151],v[56:59],a[188:191]
v_exp_f32 v79,v79
v_mfma_f32_16x16x32_bf16 a[184:187],a[144:147],v[56:59],a[184:187]
v_cvt_pk_bf16_f32 v22,v76,v77
v_cvt_pk_bf16_f32 v23,v78,v79
v_mfma_f32_16x16x32_bf16 v[136:139],a[144:147],v[52:55],v[136:139]
v_fma_f32 v87,v87,s36,v14
v_fma_f32 v92,v92,s36,v15
v_mfma_f32_16x16x32_bf16 v[140:143],a[148:151],v[52:55],v[140:143]
v_exp_f32 v84,v84
v_mfma_f32_16x16x32_bf16 v[236:239],a[148:151],v[48:51],v[236:239]
v_exp_f32 v85,v85
v_mfma_f32_16x16x32_bf16 v[232:235],a[144:147],v[48:51],v[232:235]
v_exp_f32 v86,v86
v_mfma_f32_16x16x32_bf16 v[184:187],a[144:147],v[44:47],v[184:187]
v_exp_f32 v87,v87
v_mfma_f32_16x16x32_bf16 v[188:191],a[148:151],v[44:47],v[188:191]
v_cvt_pk_bf16_f32 v26,v84,v85
v_cvt_pk_bf16_f32 v27,v86,v87
v_mfma_f32_16x16x32_bf16 v[192:195],a[120:123],v[44:47],v[192:195]
v_fma_f32 v93,v93,s36,v15
v_fma_f32 v94,v94,s36,v15
v_smfmac_f32_16x16x64_bf16 v[60:63],a[152:155],v[20:27],v18
v_fma_f32 v95,v95,s36,v15
v_mfma_f32_16x16x32_bf16 v[196:199],a[124:127],v[44:47],v[196:199]
s_waitcnt vmcnt(6) lgkmcnt(0)
v_exp_f32 v92,v92
v_mfma_f32_16x16x32_bf16 v[244:247],a[124:127],v[48:51],v[244:247]
s_barrier
v_mfma_f32_16x16x32_bf16 v[240:243],a[120:123],v[48:51],v[240:243]
ds_read_b128 a[136:139],v0 offset:0
v_fma_f32 v100,v100,s36,v16
v_mfma_f32_16x16x32_bf16 v[144:147],a[120:123],v[52:55],v[144:147]
ds_read_b128 a[140:143],v1 offset:0
v_fma_f32 v101,v101,s36,v16
v_mfma_f32_16x16x32_bf16 v[148:151],a[124:127],v[52:55],v[148:151]
ds_read_b128 a[144:147],v0 offset:128
v_fma_f32 v102,v102,s36,v16
v_mfma_f32_16x16x32_bf16 a[196:199],a[124:127],v[56:59],a[196:199]
ds_read_b128 a[148:151],v1 offset:128
v_fma_f32 v103,v103,s36,v16
v_mfma_f32_16x16x32_bf16 a[192:195],a[120:123],v[56:59],a[192:195]
v_exp_f32 v93,v93
v_mfma_f32_16x16x32_bf16 a[240:243],a[120:123],v[40:43],a[240:243]
buffer_load_dwordx4 v6,s[8:11],s21 offen offset:0 lds
v_mfma_f32_16x16x32_bf16 a[244:247],a[124:127],v[40:43],a[244:247]
ds_read_b128 a[120:123],v0 offset:256
v_cvt_pk_bf16_f32 v30,v92,v93
v_mfma_f32_16x16x32_bf16 a[248:251],a[128:131],v[40:43],a[248:251]
ds_read_b128 a[124:127],v1 offset:256
v_fma_f32 v108,v108,s36,v17
v_mfma_f32_16x16x32_bf16 a[252:255],a[132:135],v[40:43],a[252:255]
v_exp_f32 v94,v94
v_mfma_f32_16x16x32_bf16 a[204:207],a[132:135],v[56:59],a[204:207]
v_exp_f32 v95,v95
v_mfma_f32_16x16x32_bf16 a[200:203],a[128:131],v[56:59],a[200:203]
v_cvt_pk_bf16_f32 v31,v94,v95
v_fma_f32 v109,v109,s36,v17
v_mfma_f32_16x16x32_bf16 v[152:155],a[128:131],v[52:55],v[152:155]
v_exp_f32 v100,v100
v_mfma_f32_16x16x32_bf16 v[156:159],a[132:135],v[52:55],v[156:159]
v_exp_f32 v101,v101
v_mfma_f32_16x16x32_bf16 v[252:255],a[132:135],v[48:51],v[252:255]
v_exp_f32 v102,v102
v_mfma_f32_16x16x32_bf16 v[248:251],a[128:131],v[48:51],v[248:251]
v_exp_f32 v103,v103
v_mfma_f32_16x16x32_bf16 v[200:203],a[128:131],v[44:47],v[200:203]
ds_read_b128 a[128:131],v0 offset:6144
v_cvt_pk_bf16_f32 v34,v100,v101
v_mfma_f32_16x16x32_bf16 v[204:207],a[132:135],v[44:47],v[204:207]
buffer_load_dwordx4 v7,s[8:11],s21 offen offset:1024 lds
s_waitcnt lgkmcnt(1)
v_mfma_f32_16x16x32_bf16 v[72:75],a[136:139],a[0:3],0
ds_read_b128 a[132:135],v1 offset:6144
v_cvt_pk_bf16_f32 v35,v102,v103
v_mfma_f32_16x16x32_bf16 v[72:75],a[140:143],a[4:7],v[72:75]
v_fma_f32 v110,v110,s36,v17
v_fma_f32 v111,v111,s36,v17
v_smfmac_f32_16x16x64_bf16 v[64:67],a[152:155],v[28:35],v18
v_mfma_f32_16x16x32_bf16 v[72:75],a[144:147],a[8:11],v[72:75]
v_exp_f32 v108,v108
v_mfma_f32_16x16x32_bf16 v[72:75],a[148:151],a[12:15],v[72:75]
v_exp_f32 v109,v109
v_mfma_f32_16x16x32_bf16 v[72:75],a[120:123],a[16:19],v[72:75]
v_exp_f32 v110,v110
v_mfma_f32_16x16x32_bf16 v[72:75],a[124:127],a[20:23],v[72:75]
v_exp_f32 v111,v111
v_mfma_f32_16x16x32_bf16 v[80:83],a[124:127],a[44:47],0
v_cvt_pk_bf16_f32 v38,v108,v109
v_cvt_pk_bf16_f32 v39,v110,v111
v_mfma_f32_16x16x32_bf16 v[80:83],a[120:123],a[40:43],v[80:83]
v_mfma_f32_16x16x32_bf16 v[80:83],a[148:151],a[36:39],v[80:83]
v_mfma_f32_16x16x32_bf16 v[80:83],a[144:147],a[32:35],v[80:83]
buffer_load_dwordx4 v8,s[8:11],s21 offen offset:2048 lds
v_mfma_f32_16x16x32_bf16 v[80:83],a[140:143],a[28:31],v[80:83]
s_add_u32 s21,s21,12288
v_fma_f32 v72,v72,s36,v13
v_fma_f32 v73,v73,s36,v13
v_mfma_f32_16x16x32_bf16 v[80:83],a[136:139],a[24:27],v[80:83]
s_add_u32 m0,s22,24576
v_fma_f32 v74,v74,s36,v13
v_fma_f32 v75,v75,s36,v13
v_mfma_f32_16x16x32_bf16 v[88:91],a[136:139],a[48:51],0
v_exp_f32 v72,v72
v_mfma_f32_16x16x32_bf16 v[88:91],a[140:143],a[52:55],v[88:91]
v_exp_f32 v73,v73
v_mfma_f32_16x16x32_bf16 v[88:91],a[144:147],a[56:59],v[88:91]
v_fma_f32 v80,v80,s36,v14
v_fma_f32 v81,v81,s36,v14
v_mfma_f32_16x16x32_bf16 v[88:91],a[148:151],a[60:63],v[88:91]
v_fma_f32 v82,v82,s36,v14
v_fma_f32 v83,v83,s36,v14
v_mfma_f32_16x16x32_bf16 v[88:91],a[120:123],a[64:67],v[88:91]
v_exp_f32 v74,v74
v_mfma_f32_16x16x32_bf16 v[88:91],a[124:127],a[68:71],v[88:91]
v_exp_f32 v75,v75
v_mfma_f32_16x16x32_bf16 v[96:99],a[124:127],a[92:95],0
v_exp_f32 v80,v80
v_mfma_f32_16x16x32_bf16 v[96:99],a[120:123],a[88:91],v[96:99]
v_exp_f32 v81,v81
v_mfma_f32_16x16x32_bf16 v[96:99],a[148:151],a[84:87],v[96:99]
v_exp_f32 v82,v82
v_mfma_f32_16x16x32_bf16 v[96:99],a[144:147],a[80:83],v[96:99]
buffer_load_dwordx4 v6,s[4:7],s20 offen offset:0 lds
v_mfma_f32_16x16x32_bf16 v[96:99],a[140:143],a[76:79],v[96:99]
v_fma_f32 v88,v88,s36,v15
v_fma_f32 v89,v89,s36,v15
v_mfma_f32_16x16x32_bf16 v[96:99],a[136:139],a[72:75],v[96:99]
v_exp_f32 v83,v83
v_mfma_f32_16x16x32_bf16 v[104:107],a[136:139],a[96:99],0
ds_read_b128 a[136:139],v0 offset:6272
v_cvt_pk_bf16_f32 v44,v72,v73
v_mfma_f32_16x16x32_bf16 v[104:107],a[140:143],a[100:103],v[104:107]
ds_read_b128 a[140:143],v1 offset:6272
v_cvt_pk_bf16_f32 v45,v74,v75
v_mfma_f32_16x16x32_bf16 v[104:107],a[144:147],a[104:107],v[104:107]
ds_read_b128 a[144:147],v0 offset:6400
v_cvt_pk_bf16_f32 v48,v80,v81
v_mfma_f32_16x16x32_bf16 v[104:107],a[148:151],a[108:111],v[104:107]
ds_read_b128 a[148:151],v1 offset:6400
v_cvt_pk_bf16_f32 v49,v82,v83
v_mfma_f32_16x16x32_bf16 v[104:107],a[120:123],a[112:115],v[104:107]
v_exp_f32 v88,v88
v_mfma_f32_16x16x32_bf16 v[104:107],a[124:127],a[116:119],v[104:107]
s_waitcnt lgkmcnt(4)
v_exp_f32 v89,v89
v_mfma_f32_16x16x32_bf16 v[76:79],a[128:131],a[0:3],0
v_cvt_pk_bf16_f32 v52,v88,v89
v_mfma_f32_16x16x32_bf16 v[76:79],a[132:135],a[4:7],v[76:79]
s_waitcnt lgkmcnt(3)
v_mfma_f32_16x16x32_bf16 v[76:79],a[136:139],a[8:11],v[76:79]
buffer_load_dwordx4 v7,s[4:7],s20 offen offset:1024 lds
s_waitcnt lgkmcnt(2)
v_mfma_f32_16x16x32_bf16 v[76:79],a[140:143],a[12:15],v[76:79]
s_waitcnt lgkmcnt(1)
v_mfma_f32_16x16x32_bf16 v[76:79],a[144:147],a[16:19],v[76:79]
s_waitcnt lgkmcnt(0)
v_mfma_f32_16x16x32_bf16 v[76:79],a[148:151],a[20:23],v[76:79]
v_mfma_f32_16x16x32_bf16 v[84:87],a[148:151],a[44:47],0
v_mfma_f32_16x16x32_bf16 v[84:87],a[144:147],a[40:43],v[84:87]
v_mfma_f32_16x16x32_bf16 v[84:87],a[140:143],a[36:39],v[84:87]
v_mfma_f32_16x16x32_bf16 v[84:87],a[136:139],a[32:35],v[84:87]
v_mfma_f32_16x16x32_bf16 v[84:87],a[132:135],a[28:31],v[84:87]
v_mfma_f32_16x16x32_bf16 v[84:87],a[128:131],a[24:27],v[84:87]
v_mfma_f32_16x16x32_bf16 v[92:95],a[128:131],a[48:51],0
v_mfma_f32_16x16x32_bf16 v[92:95],a[132:135],a[52:55],v[92:95]
buffer_load_dwordx4 v8,s[4:7],s20 offen offset:2048 lds
v_mfma_f32_16x16x32_bf16 v[92:95],a[136:139],a[56:59],v[92:95]
s_add_u32 s20,s20,12288
v_mfma_f32_16x16x32_bf16 v[92:95],a[140:143],a[60:63],v[92:95]
v_mfma_f32_16x16x32_bf16 v[92:95],a[144:147],a[64:67],v[92:95]
v_mfma_f32_16x16x32_bf16 v[92:95],a[148:151],a[68:71],v[92:95]
v_mfma_f32_16x16x32_bf16 v[100:103],a[148:151],a[92:95],0
v_mfma_f32_16x16x32_bf16 v[100:103],a[144:147],a[88:91],v[100:103]
ds_read_b64_tr_b16 a[120:121],v2 offset:24576
v_mfma_f32_16x16x32_bf16 v[100:103],a[140:143],a[84:87],v[100:103]
ds_read_b64_tr_b16 a[122:123],v2 offset:30720
v_mfma_f32_16x16x32_bf16 v[100:103],a[136:139],a[80:83],v[100:103]
ds_read_b64_tr_b16 a[124:125],v3 offset:24576
v_mfma_f32_16x16x32_bf16 v[100:103],a[132:135],a[76:79],v[100:103]
ds_read_b64_tr_b16 a[126:127],v3 offset:30720
v_mfma_f32_16x16x32_bf16 v[100:103],a[128:131],a[72:75],v[100:103]
v_mfma_f32_16x16x32_bf16 v[108:111],a[128:131],a[96:99],0
ds_read_b64_tr_b16 a[128:129],v4 offset:24576
v_mfma_f32_16x16x32_bf16 v[108:111],a[132:135],a[100:103],v[108:111]
ds_read_b64_tr_b16 a[130:131],v4 offset:30720
v_mfma_f32_16x16x32_bf16 v[108:111],a[136:139],a[104:107],v[108:111]
ds_read_b64_tr_b16 a[132:133],v5 offset:24576
v_mfma_f32_16x16x32_bf16 v[108:111],a[140:143],a[108:111],v[108:111]
ds_read_b64_tr_b16 a[134:135],v5 offset:30720
v_mfma_f32_16x16x32_bf16 v[108:111],a[144:147],a[112:115],v[108:111]
v_mfma_f32_16x16x32_bf16 v[108:111],a[148:151],a[116:119],v[108:111]
s_mov_b32 s38,0
s_branch L_loop5
L_loop4:
.p2align 6
L_loop4w0:
s_waitcnt lgkmcnt(3)
v_mfma_f32_16x16x32_bf16 v[160:163],a[120:123],v[20:23],v[160:163]
s_add_u32 m0,s23,24576
ds_read_b64_tr_b16 a[142:143],v3 offset:30848
v_fma_f32 v83,v83,s36,v14
v_mfma_f32_16x16x32_bf16 v[164:167],a[124:127],v[20:23],v[164:167]
ds_read_b64_tr_b16 a[138:139],v2 offset:30848
v_fma_f32 v82,v82,s36,v14
v_mfma_f32_16x16x32_bf16 v[212:215],a[124:127],v[24:27],v[212:215]
ds_read_b64_tr_b16 a[136:137],v2 offset:24704
v_fma_f32 v88,v88,s36,v15
v_mfma_f32_16x16x32_bf16 v[208:211],a[120:123],v[24:27],v[208:211]
ds_read_b64_tr_b16 a[140:141],v3 offset:24704
v_fma_f32 v91,v91,s36,v15
v_mfma_f32_16x16x32_bf16 v[112:115],a[120:123],v[28:31],v[112:115]
ds_read_b64_tr_b16 a[146:147],v4 offset:30848
v_fma_f32 v89,v89,s36,v15
v_mfma_f32_16x16x32_bf16 v[116:119],a[124:127],v[28:31],v[116:119]
ds_read_b64_tr_b16 a[150:151],v5 offset:30848
v_fma_f32 v90,v90,s36,v15
v_mfma_f32_16x16x32_bf16 a[164:167],a[124:127],v[32:35],a[164:167]
ds_read_b64_tr_b16 a[144:145],v4 offset:24704
v_fma_f32 v96,v96,s36,v16
v_mfma_f32_16x16x32_bf16 a[160:163],a[120:123],v[32:35],a[160:163]
s_waitcnt lgkmcnt(6)
ds_read_b64_tr_b16 a[148:149],v5 offset:24704
v_fma_f32 v98,v98,s36,v16
v_mfma_f32_16x16x32_bf16 a[168:171],a[128:131],v[32:35],a[168:171]
ds_read_b64_tr_b16 a[120:121],v2 offset:24832
v_fma_f32 v99,v99,s36,v16
v_mfma_f32_16x16x32_bf16 a[172:175],a[132:135],v[32:35],a[172:175]
ds_read_b64_tr_b16 a[126:127],v3 offset:30976
v_fma_f32 v97,v97,s36,v16
v_mfma_f32_16x16x32_bf16 v[124:127],a[132:135],v[28:31],v[124:127]
ds_read_b64_tr_b16 a[122:123],v2 offset:30976
v_fma_f32 v79,v79,s36,v13
v_mfma_f32_16x16x32_bf16 v[120:123],a[128:131],v[28:31],v[120:123]
ds_read_b64_tr_b16 a[124:125],v3 offset:24832
v_fma_f32 v77,v77,s36,v13
v_mfma_f32_16x16x32_bf16 v[216:219],a[128:131],v[24:27],v[216:219]
v_exp_f32 v82,v82
v_mfma_f32_16x16x32_bf16 v[220:223],a[132:135],v[24:27],v[220:223]
v_exp_f32 v83,v83
v_mfma_f32_16x16x32_bf16 v[172:175],a[132:135],v[20:23],v[172:175]
ds_read_b64_tr_b16 a[132:133],v5 offset:24832
v_cvt_pk_bf16_f32 v49,v82,v83
v_mfma_f32_16x16x32_bf16 v[168:171],a[128:131],v[20:23],v[168:171]
s_waitcnt lgkmcnt(4)
ds_read_b64_tr_b16 a[134:135],v5 offset:30976
v_fma_f32 v76,v76,s36,v13
v_mfma_f32_16x16x32_bf16 v[176:179],a[136:139],v[20:23],v[176:179]
ds_read_b64_tr_b16 a[128:129],v4 offset:24832
v_fma_f32 v78,v78,s36,v13
v_mfma_f32_16x16x32_bf16 v[180:183],a[140:143],v[20:23],v[180:183]
ds_read_b64_tr_b16 a[130:131],v4 offset:30976
v_fma_f32 v86,v86,s36,v14
v_mfma_f32_16x16x32_bf16 v[228:231],a[140:143],v[24:27],v[228:231]
v_exp_f32 v90,v90
v_mfma_f32_16x16x32_bf16 v[224:227],a[136:139],v[24:27],v[224:227]
v_exp_f32 v88,v88
v_mfma_f32_16x16x32_bf16 v[128:131],a[136:139],v[28:31],v[128:131]
v_exp_f32 v89,v89
v_mfma_f32_16x16x32_bf16 v[132:135],a[140:143],v[28:31],v[132:135]
v_cvt_pk_bf16_f32 v52,v88,v89
v_fma_f32 v84,v84,s36,v14
v_mfma_f32_16x16x32_bf16 a[180:183],a[140:143],v[32:35],a[180:183]
v_exp_f32 v91,v91
v_mfma_f32_16x16x32_bf16 a[176:179],a[136:139],v[32:35],a[176:179]
v_cvt_pk_bf16_f32 v53,v90,v91
v_fma_f32 v85,v85,s36,v14
v_mfma_f32_16x16x32_bf16 a[184:187],a[144:147],v[32:35],a[184:187]
v_exp_f32 v99,v99
v_mfma_f32_16x16x32_bf16 a[188:191],a[148:151],v[32:35],a[188:191]
v_exp_f32 v97,v97
v_mfma_f32_16x16x32_bf16 v[140:143],a[148:151],v[28:31],v[140:143]
v_exp_f32 v96,v96
v_mfma_f32_16x16x32_bf16 v[136:139],a[144:147],v[28:31],v[136:139]
v_cvt_pk_bf16_f32 v56,v96,v97
v_fma_f32 v87,v87,s36,v14
v_mfma_f32_16x16x32_bf16 v[232:235],a[144:147],v[24:27],v[232:235]
v_exp_f32 v98,v98
v_mfma_f32_16x16x32_bf16 v[236:239],a[148:151],v[24:27],v[236:239]
v_cvt_pk_bf16_f32 v57,v98,v99
v_fma_f32 v94,v94,s36,v15
v_mfma_f32_16x16x32_bf16 v[188:191],a[148:151],v[20:23],v[188:191]
v_exp_f32 v76,v76
v_mfma_f32_16x16x32_bf16 v[184:187],a[144:147],v[20:23],v[184:187]
s_waitcnt lgkmcnt(0)
v_exp_f32 v79,v79
v_mfma_f32_16x16x32_bf16 v[192:195],a[120:123],v[20:23],v[192:195]
v_exp_f32 v78,v78
v_mfma_f32_16x16x32_bf16 v[196:199],a[124:127],v[20:23],v[196:199]
s_waitcnt vmcnt(6)
ds_read_b128 a[156:159],v10 offset:0
v_cvt_pk_bf16_f32 v47,v78,v79
v_mfma_f32_16x16x32_bf16 v[244:247],a[124:127],v[24:27],v[244:247]
s_barrier
v_mfma_f32_16x16x32_bf16 v[240:243],a[120:123],v[24:27],v[240:243]
ds_read_b128 a[148:151],v1 offset:12416
v_fma_f32 v92,v92,s36,v15
v_mfma_f32_16x16x32_bf16 v[144:147],a[120:123],v[28:31],v[144:147]
ds_read_b128 a[144:147],v0 offset:12416
v_fma_f32 v93,v93,s36,v15
v_mfma_f32_16x16x32_bf16 v[148:151],a[124:127],v[28:31],v[148:151]
ds_read_b128 a[140:143],v1 offset:12288
v_fma_f32 v95,v95,s36,v15
v_mfma_f32_16x16x32_bf16 a[196:199],a[124:127],v[32:35],a[196:199]
ds_read_b128 a[124:127],v1 offset:12544
v_fma_f32 v102,v102,s36,v16
v_mfma_f32_16x16x32_bf16 a[192:195],a[120:123],v[32:35],a[192:195]
ds_read_b128 a[120:123],v0 offset:12544
v_fma_f32 v100,v100,s36,v16
v_mfma_f32_16x16x32_bf16 a[200:203],a[128:131],v[32:35],a[200:203]
buffer_load_dwordx4 v6,s[8:11],s21 offen offset:0 lds
v_mfma_f32_16x16x32_bf16 a[204:207],a[132:135],v[32:35],a[204:207]
ds_read_b128 a[136:139],v0 offset:12288
v_fma_f32 v101,v101,s36,v16
v_mfma_f32_16x16x32_bf16 v[156:159],a[132:135],v[28:31],v[156:159]
v_exp_f32 v77,v77
v_mfma_f32_16x16x32_bf16 v[152:155],a[128:131],v[28:31],v[152:155]
v_cvt_pk_bf16_f32 v46,v76,v77
v_fma_f32 v103,v103,s36,v16
v_mfma_f32_16x16x32_bf16 v[248:251],a[128:131],v[24:27],v[248:251]
v_exp_f32 v86,v86
v_mfma_f32_16x16x32_bf16 v[252:255],a[132:135],v[24:27],v[252:255]
v_exp_f32 v87,v87
v_mfma_f32_16x16x32_bf16 v[204:207],a[132:135],v[20:23],v[204:207]
ds_read_b128 a[132:135],v1 offset:18432
v_cvt_pk_bf16_f32 v51,v86,v87
v_mfma_f32_16x16x32_bf16 v[200:203],a[128:131],v[20:23],v[200:203]
s_waitcnt lgkmcnt(2)
ds_read_b128 a[128:131],v0 offset:18432
v_mfma_f32_16x16x32_bf16 v[72:75],a[124:127],a[20:23],0
v_exp_f32 v85,v85
v_mfma_f32_16x16x32_bf16 v[72:75],a[120:123],a[16:19],v[72:75]
buffer_store_dwordx4 a[156:159],v9,s[16:19],s27 offen offset:0 nt
buffer_load_dwordx4 v7,s[8:11],s21 offen offset:1024 lds
v_mfma_f32_16x16x32_bf16 v[72:75],a[148:151],a[12:15],v[72:75]
ds_read_b128 a[156:159],v10 offset:1024
v_mfma_f32_16x16x32_bf16 v[72:75],a[144:147],a[8:11],v[72:75]
v_exp_f32 v84,v84
v_mfma_f32_16x16x32_bf16 v[72:75],a[140:143],a[4:7],v[72:75]
s_waitcnt lgkmcnt(3)
v_cvt_pk_bf16_f32 v50,v84,v85
v_mfma_f32_16x16x32_bf16 v[72:75],a[136:139],a[0:3],v[72:75]
v_exp_f32 v93,v93
v_smfmac_f32_16x16x64_bf16 v[60:63],a[152:155],v[44:51],v18
v_mfma_f32_16x16x32_bf16 v[80:83],a[136:139],a[24:27],0
v_exp_f32 v94,v94
v_mfma_f32_16x16x32_bf16 v[80:83],a[140:143],a[28:31],v[80:83]
v_exp_f32 v92,v92
v_mfma_f32_16x16x32_bf16 v[80:83],a[144:147],a[32:35],v[80:83]
buffer_load_dwordx4 v8,s[8:11],s21 offen offset:2048 lds
v_mfma_f32_16x16x32_bf16 v[80:83],a[148:151],a[36:39],v[80:83]
s_add_u32 s21,s21,12288
v_cvt_pk_bf16_f32 v54,v92,v93
v_fma_f32 v72,v72,s36,v13
v_mfma_f32_16x16x32_bf16 v[80:83],a[120:123],a[40:43],v[80:83]
s_add_u32 m0,s22,0
v_exp_f32 v95,v95
v_mfma_f32_16x16x32_bf16 v[80:83],a[124:127],a[44:47],v[80:83]
v_cvt_pk_bf16_f32 v55,v94,v95
v_fma_f32 v75,v75,s36,v13
v_mfma_f32_16x16x32_bf16 v[88:91],a[124:127],a[68:71],0
v_exp_f32 v103,v103
v_mfma_f32_16x16x32_bf16 v[88:91],a[120:123],a[64:67],v[88:91]
v_exp_f32 v100,v100
v_mfma_f32_16x16x32_bf16 v[88:91],a[148:151],a[60:63],v[88:91]
v_exp_f32 v102,v102
v_mfma_f32_16x16x32_bf16 v[88:91],a[144:147],a[56:59],v[88:91]
v_cvt_pk_bf16_f32 v59,v102,v103
v_fma_f32 v80,v80,s36,v14
v_mfma_f32_16x16x32_bf16 v[88:91],a[140:143],a[52:55],v[88:91]
v_exp_f32 v101,v101
v_mfma_f32_16x16x32_bf16 v[88:91],a[136:139],a[48:51],v[88:91]
s_waitcnt lgkmcnt(0)
buffer_store_dwordx4 a[156:159],v9,s[16:19],s27 offen offset:128 nt
buffer_load_dwordx4 v6,s[4:7],s20 offen offset:0 lds
v_mfma_f32_16x16x32_bf16 v[96:99],a[136:139],a[72:75],0
ds_read_b128 a[156:159],v10 offset:2048
v_cvt_pk_bf16_f32 v58,v100,v101
v_mfma_f32_16x16x32_bf16 v[96:99],a[140:143],a[76:79],v[96:99]
ds_read_b128 a[136:139],v0 offset:18560
v_fma_f32 v81,v81,s36,v14
v_smfmac_f32_16x16x64_bf16 v[64:67],a[152:155],v[52:59],v18
ds_read_b128 a[140:143],v1 offset:18560
v_mfma_f32_16x16x32_bf16 v[96:99],a[144:147],a[80:83],v[96:99]
ds_read_b128 a[144:147],v0 offset:18688
v_mfma_f32_16x16x32_bf16 v[96:99],a[148:151],a[84:87],v[96:99]
ds_read_b128 a[148:151],v1 offset:18688
v_mfma_f32_16x16x32_bf16 v[96:99],a[120:123],a[88:91],v[96:99]
v_fma_f32 v73,v73,s36,v13
v_fma_f32 v74,v74,s36,v13
v_mfma_f32_16x16x32_bf16 v[96:99],a[124:127],a[92:95],v[96:99]
v_exp_f32 v74,v74
v_mfma_f32_16x16x32_bf16 v[76:79],a[128:131],a[0:3],0
buffer_load_dwordx4 v7,s[4:7],s20 offen offset:1024 lds
v_mfma_f32_16x16x32_bf16 v[76:79],a[132:135],a[4:7],v[76:79]
s_waitcnt lgkmcnt(3)
v_exp_f32 v75,v75
v_mfma_f32_16x16x32_bf16 v[76:79],a[136:139],a[8:11],v[76:79]
s_waitcnt lgkmcnt(2)
v_cvt_pk_bf16_f32 v21,v74,v75
v_mfma_f32_16x16x32_bf16 v[76:79],a[140:143],a[12:15],v[76:79]
s_waitcnt lgkmcnt(1)
v_exp_f32 v73,v73
v_mfma_f32_16x16x32_bf16 v[76:79],a[144:147],a[16:19],v[76:79]
s_waitcnt lgkmcnt(0)
v_exp_f32 v80,v80
v_mfma_f32_16x16x32_bf16 v[76:79],a[148:151],a[20:23],v[76:79]
v_exp_f32 v81,v81
v_mfma_f32_16x16x32_bf16 v[84:87],a[148:151],a[44:47],0
v_cvt_pk_bf16_f32 v24,v80,v81
v_mfma_f32_16x16x32_bf16 v[84:87],a[144:147],a[40:43],v[84:87]
v_exp_f32 v72,v72
v_mfma_f32_16x16x32_bf16 v[84:87],a[140:143],a[36:39],v[84:87]
v_cvt_pk_bf16_f32 v20,v72,v73
v_mfma_f32_16x16x32_bf16 v[84:87],a[136:139],a[32:35],v[84:87]
buffer_store_dwordx4 a[156:159],v9,s[16:19],s27 offen offset:256 nt
buffer_load_dwordx4 v8,s[4:7],s20 offen offset:2048 lds
v_mfma_f32_16x16x32_bf16 v[84:87],a[132:135],a[28:31],v[84:87]
s_add_u32 s20,s20,12288
ds_read_b64_tr_b16 a[122:123],v2 offset:6144
v_mfma_f32_16x16x32_bf16 v[84:87],a[128:131],a[24:27],v[84:87]
s_add_u32 s27,s27,3072
ds_read_b64_tr_b16 a[120:121],v2 offset:0
v_mfma_f32_16x16x32_bf16 v[92:95],a[128:131],a[48:51],0
ds_read_b64_tr_b16 a[124:125],v3 offset:0
v_mfma_f32_16x16x32_bf16 v[92:95],a[132:135],a[52:55],v[92:95]
ds_read_b64_tr_b16 a[126:127],v3 offset:6144
v_mfma_f32_16x16x32_bf16 v[92:95],a[136:139],a[56:59],v[92:95]
v_mfma_f32_16x16x32_bf16 v[92:95],a[140:143],a[60:63],v[92:95]
v_mfma_f32_16x16x32_bf16 v[92:95],a[144:147],a[64:67],v[92:95]
v_mfma_f32_16x16x32_bf16 v[92:95],a[148:151],a[68:71],v[92:95]
v_mfma_f32_16x16x32_bf16 v[100:103],a[148:151],a[92:95],0
v_mfma_f32_16x16x32_bf16 v[100:103],a[144:147],a[88:91],v[100:103]
v_mfma_f32_16x16x32_bf16 v[100:103],a[140:143],a[84:87],v[100:103]
v_mfma_f32_16x16x32_bf16 v[100:103],a[136:139],a[80:83],v[100:103]
v_mfma_f32_16x16x32_bf16 v[100:103],a[132:135],a[76:79],v[100:103]
ds_read_b64_tr_b16 a[134:135],v5 offset:6144
v_mfma_f32_16x16x32_bf16 v[100:103],a[128:131],a[72:75],v[100:103]
s_waitcnt lgkmcnt(1)
ds_read_b64_tr_b16 a[128:129],v4 offset:0
ds_read_b64_tr_b16 a[130:131],v4 offset:6144
ds_read_b64_tr_b16 a[132:133],v5 offset:0
v_mfma_f32_16x16x32_bf16 v[160:163],a[120:123],v[44:47],v[160:163]
s_add_u32 m0,s29,0
ds_read_b64_tr_b16 a[136:137],v2 offset:128
v_fma_f32 v82,v82,s36,v14
v_mfma_f32_16x16x32_bf16 v[164:167],a[124:127],v[44:47],v[164:167]
ds_read_b64_tr_b16 a[138:139],v2 offset:6272
v_fma_f32 v83,v83,s36,v14
v_mfma_f32_16x16x32_bf16 v[212:215],a[124:127],v[48:51],v[212:215]
ds_read_b64_tr_b16 a[140:141],v3 offset:128
v_fma_f32 v88,v88,s36,v15
v_mfma_f32_16x16x32_bf16 v[208:211],a[120:123],v[48:51],v[208:211]
ds_read_b64_tr_b16 a[142:143],v3 offset:6272
v_fma_f32 v89,v89,s36,v15
v_mfma_f32_16x16x32_bf16 v[112:115],a[120:123],v[52:55],v[112:115]
ds_read_b64_tr_b16 a[144:145],v4 offset:128
v_fma_f32 v90,v90,s36,v15
v_mfma_f32_16x16x32_bf16 v[116:119],a[124:127],v[52:55],v[116:119]
ds_read_b64_tr_b16 a[146:147],v4 offset:6272
v_fma_f32 v91,v91,s36,v15
v_mfma_f32_16x16x32_bf16 a[164:167],a[124:127],v[56:59],a[164:167]
buffer_load_dwordx4 v6,s[12:15],s28 offen offset:0 nt lds
v_mfma_f32_16x16x32_bf16 a[160:163],a[120:123],v[56:59],a[160:163]
s_waitcnt lgkmcnt(5)
ds_read_b64_tr_b16 a[148:149],v5 offset:128
v_fma_f32 v96,v96,s36,v16
v_mfma_f32_16x16x32_bf16 a[168:171],a[128:131],v[56:59],a[168:171]
ds_read_b64_tr_b16 a[150:151],v5 offset:6272
v_fma_f32 v97,v97,s36,v16
v_mfma_f32_16x16x32_bf16 a[172:175],a[132:135],v[56:59],a[172:175]
ds_read_b64_tr_b16 a[120:121],v2 offset:256
v_fma_f32 v98,v98,s36,v16
v_mfma_f32_16x16x32_bf16 v[124:127],a[132:135],v[52:55],v[124:127]
ds_read_b64_tr_b16 a[122:123],v2 offset:6400
v_fma_f32 v99,v99,s36,v16
v_mfma_f32_16x16x32_bf16 v[120:123],a[128:131],v[52:55],v[120:123]
ds_read_b64_tr_b16 a[124:125],v3 offset:256
v_fma_f32 v76,v76,s36,v13
v_mfma_f32_16x16x32_bf16 v[216:219],a[128:131],v[48:51],v[216:219]
ds_read_b64_tr_b16 a[126:127],v3 offset:6400
v_fma_f32 v77,v77,s36,v13
v_mfma_f32_16x16x32_bf16 v[220:223],a[132:135],v[48:51],v[220:223]
buffer_load_dwordx4 v7,s[12:15],s28 offen offset:1024 nt lds
v_mfma_f32_16x16x32_bf16 v[172:175],a[132:135],v[44:47],v[172:175]
ds_read_b64_tr_b16 a[132:133],v5 offset:256
v_fma_f32 v78,v78,s36,v13
v_mfma_f32_16x16x32_bf16 v[168:171],a[128:131],v[44:47],v[168:171]
s_waitcnt lgkmcnt(5)
ds_read_b64_tr_b16 a[128:129],v4 offset:256
v_fma_f32 v79,v79,s36,v13
v_mfma_f32_16x16x32_bf16 v[176:179],a[136:139],v[44:47],v[176:179]
ds_read_b64_tr_b16 a[130:131],v4 offset:6400
v_fma_f32 v84,v84,s36,v14
v_mfma_f32_16x16x32_bf16 v[180:183],a[140:143],v[44:47],v[180:183]
ds_read_b64_tr_b16 a[134:135],v5 offset:6400
v_fma_f32 v85,v85,s36,v14
v_mfma_f32_16x16x32_bf16 v[228:231],a[140:143],v[48:51],v[228:231]
v_exp_f32 v82,v82
v_mfma_f32_16x16x32_bf16 v[224:227],a[136:139],v[48:51],v[224:227]
v_exp_f32 v83,v83
v_mfma_f32_16x16x32_bf16 v[128:131],a[136:139],v[52:55],v[128:131]
v_cvt_pk_bf16_f32 v25,v82,v83
v_fma_f32 v86,v86,s36,v14
v_mfma_f32_16x16x32_bf16 v[132:135],a[140:143],v[52:55],v[132:135]
buffer_load_dwordx4 v8,s[12:15],s28 offen offset:2048 nt lds
v_mfma_f32_16x16x32_bf16 a[180:183],a[140:143],v[56:59],a[180:183]
s_add_u32 s28,s28,3072
v_exp_f32 v88,v88
v_mfma_f32_16x16x32_bf16 a[176:179],a[136:139],v[56:59],a[176:179]
s_add_u32 s29,s29,3072
v_exp_f32 v89,v89
v_mfma_f32_16x16x32_bf16 a[184:187],a[144:147],v[56:59],a[184:187]
s_add_u32 m0,s23,0
v_exp_f32 v90,v90
v_mfma_f32_16x16x32_bf16 a[188:191],a[148:151],v[56:59],a[188:191]
v_exp_f32 v91,v91
v_mfma_f32_16x16x32_bf16 v[140:143],a[148:151],v[52:55],v[140:143]
v_cvt_pk_bf16_f32 v28,v88,v89
v_cvt_pk_bf16_f32 v29,v90,v91
v_mfma_f32_16x16x32_bf16 v[136:139],a[144:147],v[52:55],v[136:139]
v_exp_f32 v96,v96
v_mfma_f32_16x16x32_bf16 v[232:235],a[144:147],v[48:51],v[232:235]
v_exp_f32 v97,v97
v_mfma_f32_16x16x32_bf16 v[236:239],a[148:151],v[48:51],v[236:239]
v_exp_f32 v98,v98
v_mfma_f32_16x16x32_bf16 v[188:191],a[148:151],v[44:47],v[188:191]
v_exp_f32 v99,v99
v_mfma_f32_16x16x32_bf16 v[184:187],a[144:147],v[44:47],v[184:187]
s_waitcnt lgkmcnt(0)
v_cvt_pk_bf16_f32 v32,v96,v97
v_cvt_pk_bf16_f32 v33,v98,v99
v_mfma_f32_16x16x32_bf16 v[192:195],a[120:123],v[44:47],v[192:195]
s_waitcnt vmcnt(12)
v_exp_f32 v76,v76
v_mfma_f32_16x16x32_bf16 v[196:199],a[124:127],v[44:47],v[196:199]
s_barrier
v_mfma_f32_16x16x32_bf16 v[244:247],a[124:127],v[48:51],v[244:247]
ds_read_b128 a[148:151],v1 offset:24704
v_fma_f32 v87,v87,s36,v14
v_mfma_f32_16x16x32_bf16 v[240:243],a[120:123],v[48:51],v[240:243]
ds_read_b128 a[144:147],v0 offset:24704
v_fma_f32 v92,v92,s36,v15
v_mfma_f32_16x16x32_bf16 v[144:147],a[120:123],v[52:55],v[144:147]
ds_read_b128 a[140:143],v1 offset:24576
v_fma_f32 v93,v93,s36,v15
v_mfma_f32_16x16x32_bf16 v[148:151],a[124:127],v[52:55],v[148:151]
ds_read_b128 a[136:139],v0 offset:24576
v_fma_f32 v94,v94,s36,v15
v_mfma_f32_16x16x32_bf16 a[196:199],a[124:127],v[56:59],a[196:199]
ds_read_b128 a[124:127],v1 offset:24832
v_fma_f32 v95,v95,s36,v15
v_mfma_f32_16x16x32_bf16 a[192:195],a[120:123],v[56:59],a[192:195]
buffer_load_dwordx4 v6,s[8:11],s21 offen offset:0 lds
v_mfma_f32_16x16x32_bf16 a[200:203],a[128:131],v[56:59],a[200:203]
ds_read_b128 a[120:123],v0 offset:24832
v_fma_f32 v100,v100,s36,v16
v_mfma_f32_16x16x32_bf16 a[204:207],a[132:135],v[56:59],a[204:207]
v_exp_f32 v77,v77
v_mfma_f32_16x16x32_bf16 v[156:159],a[132:135],v[52:55],v[156:159]
v_exp_f32 v78,v78
v_mfma_f32_16x16x32_bf16 v[152:155],a[128:131],v[52:55],v[152:155]
v_exp_f32 v79,v79
v_mfma_f32_16x16x32_bf16 v[248:251],a[128:131],v[48:51],v[248:251]
v_cvt_pk_bf16_f32 v22,v76,v77
v_cvt_pk_bf16_f32 v23,v78,v79
v_mfma_f32_16x16x32_bf16 v[252:255],a[132:135],v[48:51],v[252:255]
v_exp_f32 v84,v84
v_mfma_f32_16x16x32_bf16 v[204:207],a[132:135],v[44:47],v[204:207]
ds_read_b128 a[132:135],v1 offset:30720
v_fma_f32 v101,v101,s36,v16
v_mfma_f32_16x16x32_bf16 v[200:203],a[128:131],v[44:47],v[200:203]
s_waitcnt lgkmcnt(1)
ds_read_b128 a[128:131],v0 offset:30720
v_fma_f32 v102,v102,s36,v16
v_mfma_f32_16x16x32_bf16 v[72:75],a[124:127],a[20:23],0
buffer_load_dwordx4 v7,s[8:11],s21 offen offset:1024 lds
v_mfma_f32_16x16x32_bf16 v[72:75],a[120:123],a[16:19],v[72:75]
v_exp_f32 v85,v85
v_mfma_f32_16x16x32_bf16 v[72:75],a[148:151],a[12:15],v[72:75]
v_exp_f32 v86,v86
v_mfma_f32_16x16x32_bf16 v[72:75],a[144:147],a[8:11],v[72:75]
v_exp_f32 v87,v87
v_mfma_f32_16x16x32_bf16 v[72:75],a[140:143],a[4:7],v[72:75]
v_cvt_pk_bf16_f32 v26,v84,v85
v_cvt_pk_bf16_f32 v27,v86,v87
v_mfma_f32_16x16x32_bf16 v[72:75],a[136:139],a[0:3],v[72:75]
v_exp_f32 v92,v92
v_smfmac_f32_16x16x64_bf16 v[60:63],a[152:155],v[20:27],v18
v_fma_f32 v103,v103,s36,v16
v_mfma_f32_16x16x32_bf16 v[80:83],a[136:139],a[24:27],0
v_exp_f32 v93,v93
v_mfma_f32_16x16x32_bf16 v[80:83],a[140:143],a[28:31],v[80:83]
buffer_load_dwordx4 v8,s[8:11],s21 offen offset:2048 lds
v_mfma_f32_16x16x32_bf16 v[80:83],a[144:147],a[32:35],v[80:83]
s_add_u32 s21,s21,12288
v_exp_f32 v94,v94
v_mfma_f32_16x16x32_bf16 v[80:83],a[148:151],a[36:39],v[80:83]
s_add_u32 m0,s22,12288
v_exp_f32 v95,v95
v_mfma_f32_16x16x32_bf16 v[80:83],a[120:123],a[40:43],v[80:83]
v_cvt_pk_bf16_f32 v30,v92,v93
v_cvt_pk_bf16_f32 v31,v94,v95
v_mfma_f32_16x16x32_bf16 v[80:83],a[124:127],a[44:47],v[80:83]
v_exp_f32 v100,v100
v_mfma_f32_16x16x32_bf16 v[88:91],a[124:127],a[68:71],0
v_exp_f32 v101,v101
v_mfma_f32_16x16x32_bf16 v[88:91],a[120:123],a[64:67],v[88:91]
v_exp_f32 v102,v102
v_mfma_f32_16x16x32_bf16 v[88:91],a[148:151],a[60:63],v[88:91]
v_exp_f32 v103,v103
v_mfma_f32_16x16x32_bf16 v[88:91],a[144:147],a[56:59],v[88:91]
v_cvt_pk_bf16_f32 v34,v100,v101
v_cvt_pk_bf16_f32 v35,v102,v103
v_mfma_f32_16x16x32_bf16 v[88:91],a[140:143],a[52:55],v[88:91]
buffer_load_dwordx4 v6,s[4:7],s20 offen offset:0 lds
v_smfmac_f32_16x16x64_bf16 v[64:67],a[152:155],v[28:35],v18
v_fma_f32 v72,v72,s36,v13
v_mfma_f32_16x16x32_bf16 v[88:91],a[136:139],a[48:51],v[88:91]
v_fma_f32 v73,v73,s36,v13
v_fma_f32 v74,v74,s36,v13
v_mfma_f32_16x16x32_bf16 v[96:99],a[136:139],a[72:75],0
ds_read_b128 a[136:139],v0 offset:30848
v_fma_f32 v75,v75,s36,v13
v_mfma_f32_16x16x32_bf16 v[96:99],a[140:143],a[76:79],v[96:99]
ds_read_b128 a[140:143],v1 offset:30848
v_fma_f32 v80,v80,s36,v14
v_mfma_f32_16x16x32_bf16 v[96:99],a[144:147],a[80:83],v[96:99]
ds_read_b128 a[144:147],v0 offset:30976
v_fma_f32 v81,v81,s36,v14
v_mfma_f32_16x16x32_bf16 v[96:99],a[148:151],a[84:87],v[96:99]
ds_read_b128 a[148:151],v1 offset:30976
v_mfma_f32_16x16x32_bf16 v[96:99],a[120:123],a[88:91],v[96:99]
v_exp_f32 v72,v72
v_mfma_f32_16x16x32_bf16 v[96:99],a[124:127],a[92:95],v[96:99]
s_waitcnt lgkmcnt(4)
v_exp_f32 v73,v73
v_mfma_f32_16x16x32_bf16 v[76:79],a[128:131],a[0:3],0
buffer_load_dwordx4 v7,s[4:7],s20 offen offset:1024 lds
v_mfma_f32_16x16x32_bf16 v[76:79],a[132:135],a[4:7],v[76:79]
s_waitcnt lgkmcnt(3)
v_exp_f32 v74,v74
v_mfma_f32_16x16x32_bf16 v[76:79],a[136:139],a[8:11],v[76:79]
s_waitcnt lgkmcnt(2)
v_exp_f32 v75,v75
v_mfma_f32_16x16x32_bf16 v[76:79],a[140:143],a[12:15],v[76:79]
s_waitcnt lgkmcnt(0)
v_exp_f32 v80,v80
v_mfma_f32_16x16x32_bf16 v[76:79],a[144:147],a[16:19],v[76:79]
v_exp_f32 v81,v81
v_mfma_f32_16x16x32_bf16 v[76:79],a[148:151],a[20:23],v[76:79]
v_cvt_pk_bf16_f32 v44,v72,v73
v_cvt_pk_bf16_f32 v45,v74,v75
v_mfma_f32_16x16x32_bf16 v[84:87],a[148:151],a[44:47],0
v_cvt_pk_bf16_f32 v48,v80,v81
v_mfma_f32_16x16x32_bf16 v[84:87],a[144:147],a[40:43],v[84:87]
v_mfma_f32_16x16x32_bf16 v[84:87],a[140:143],a[36:39],v[84:87]
v_mfma_f32_16x16x32_bf16 v[84:87],a[136:139],a[32:35],v[84:87]
buffer_load_dwordx4 v8,s[4:7],s20 offen offset:2048 lds
v_mfma_f32_16x16x32_bf16 v[84:87],a[132:135],a[28:31],v[84:87]
s_add_u32 s20,s20,12288
v_mfma_f32_16x16x32_bf16 v[84:87],a[128:131],a[24:27],v[84:87]
ds_read_b64_tr_b16 a[120:121],v2 offset:12288
v_mfma_f32_16x16x32_bf16 v[92:95],a[128:131],a[48:51],0
ds_read_b64_tr_b16 a[122:123],v2 offset:18432
v_mfma_f32_16x16x32_bf16 v[92:95],a[132:135],a[52:55],v[92:95]
ds_read_b64_tr_b16 a[124:125],v3 offset:12288
v_mfma_f32_16x16x32_bf16 v[92:95],a[136:139],a[56:59],v[92:95]
ds_read_b64_tr_b16 a[126:127],v3 offset:18432
v_mfma_f32_16x16x32_bf16 v[92:95],a[140:143],a[60:63],v[92:95]
v_mfma_f32_16x16x32_bf16 v[92:95],a[144:147],a[64:67],v[92:95]
v_mfma_f32_16x16x32_bf16 v[92:95],a[148:151],a[68:71],v[92:95]
v_mfma_f32_16x16x32_bf16 v[100:103],a[148:151],a[92:95],0
v_mfma_f32_16x16x32_bf16 v[100:103],a[144:147],a[88:91],v[100:103]
v_mfma_f32_16x16x32_bf16 v[100:103],a[140:143],a[84:87],v[100:103]
v_mfma_f32_16x16x32_bf16 v[100:103],a[136:139],a[80:83],v[100:103]
v_mfma_f32_16x16x32_bf16 v[100:103],a[132:135],a[76:79],v[100:103]
ds_read_b64_tr_b16 a[132:133],v5 offset:12288
v_mfma_f32_16x16x32_bf16 v[100:103],a[128:131],a[72:75],v[100:103]
s_waitcnt lgkmcnt(1)
ds_read_b64_tr_b16 a[128:129],v4 offset:12288
ds_read_b64_tr_b16 a[130:131],v4 offset:18432
ds_read_b64_tr_b16 a[134:135],v5 offset:18432
v_mfma_f32_16x16x32_bf16 v[160:163],a[120:123],v[20:23],v[160:163]
s_add_u32 m0,s23,12288
ds_read_b64_tr_b16 a[142:143],v3 offset:18560
v_fma_f32 v83,v83,s36,v14
v_mfma_f32_16x16x32_bf16 v[164:167],a[124:127],v[20:23],v[164:167]
ds_read_b64_tr_b16 a[138:139],v2 offset:18560
v_fma_f32 v82,v82,s36,v14
v_mfma_f32_16x16x32_bf16 v[212:215],a[124:127],v[24:27],v[212:215]
ds_read_b64_tr_b16 a[136:137],v2 offset:12416
v_fma_f32 v88,v88,s36,v15
v_mfma_f32_16x16x32_bf16 v[208:211],a[120:123],v[24:27],v[208:211]
ds_read_b64_tr_b16 a[140:141],v3 offset:12416
v_fma_f32 v91,v91,s36,v15
v_mfma_f32_16x16x32_bf16 v[112:115],a[120:123],v[28:31],v[112:115]
ds_read_b64_tr_b16 a[146:147],v4 offset:18560
v_fma_f32 v89,v89,s36,v15
v_mfma_f32_16x16x32_bf16 v[116:119],a[124:127],v[28:31],v[116:119]
ds_read_b64_tr_b16 a[150:151],v5 offset:18560
v_fma_f32 v90,v90,s36,v15
v_mfma_f32_16x16x32_bf16 a[164:167],a[124:127],v[32:35],a[164:167]
ds_read_b64_tr_b16 a[144:145],v4 offset:12416
v_fma_f32 v96,v96,s36,v16
v_mfma_f32_16x16x32_bf16 a[160:163],a[120:123],v[32:35],a[160:163]
s_waitcnt lgkmcnt(6)
ds_read_b64_tr_b16 a[148:149],v5 offset:12416
v_fma_f32 v98,v98,s36,v16
v_mfma_f32_16x16x32_bf16 a[168:171],a[128:131],v[32:35],a[168:171]
ds_read_b64_tr_b16 a[120:121],v2 offset:12544
v_fma_f32 v99,v99,s36,v16
v_mfma_f32_16x16x32_bf16 a[172:175],a[132:135],v[32:35],a[172:175]
ds_read_b64_tr_b16 a[126:127],v3 offset:18688
v_fma_f32 v97,v97,s36,v16
v_mfma_f32_16x16x32_bf16 v[124:127],a[132:135],v[28:31],v[124:127]
ds_read_b64_tr_b16 a[122:123],v2 offset:18688
v_fma_f32 v79,v79,s36,v13
v_mfma_f32_16x16x32_bf16 v[120:123],a[128:131],v[28:31],v[120:123]
ds_read_b64_tr_b16 a[124:125],v3 offset:12544
v_fma_f32 v77,v77,s36,v13
v_mfma_f32_16x16x32_bf16 v[216:219],a[128:131],v[24:27],v[216:219]
v_exp_f32 v82,v82
v_mfma_f32_16x16x32_bf16 v[220:223],a[132:135],v[24:27],v[220:223]
v_exp_f32 v83,v83
v_mfma_f32_16x16x32_bf16 v[172:175],a[132:135],v[20:23],v[172:175]
ds_read_b64_tr_b16 a[132:133],v5 offset:12544
v_cvt_pk_bf16_f32 v49,v82,v83
v_mfma_f32_16x16x32_bf16 v[168:171],a[128:131],v[20:23],v[168:171]
s_waitcnt lgkmcnt(4)
ds_read_b64_tr_b16 a[134:135],v5 offset:18688
v_fma_f32 v76,v76,s36,v13
v_mfma_f32_16x16x32_bf16 v[176:179],a[136:139],v[20:23],v[176:179]
ds_read_b64_tr_b16 a[128:129],v4 offset:12544
v_fma_f32 v78,v78,s36,v13
v_mfma_f32_16x16x32_bf16 v[180:183],a[140:143],v[20:23],v[180:183]
ds_read_b64_tr_b16 a[130:131],v4 offset:18688
v_fma_f32 v86,v86,s36,v14
v_mfma_f32_16x16x32_bf16 v[228:231],a[140:143],v[24:27],v[228:231]
v_exp_f32 v90,v90
v_mfma_f32_16x16x32_bf16 v[224:227],a[136:139],v[24:27],v[224:227]
v_exp_f32 v88,v88
v_mfma_f32_16x16x32_bf16 v[128:131],a[136:139],v[28:31],v[128:131]
v_exp_f32 v89,v89
v_mfma_f32_16x16x32_bf16 v[132:135],a[140:143],v[28:31],v[132:135]
v_cvt_pk_bf16_f32 v52,v88,v89
v_fma_f32 v84,v84,s36,v14
v_mfma_f32_16x16x32_bf16 a[180:183],a[140:143],v[32:35],a[180:183]
v_exp_f32 v91,v91
v_mfma_f32_16x16x32_bf16 a[176:179],a[136:139],v[32:35],a[176:179]
v_cvt_pk_bf16_f32 v53,v90,v91
v_fma_f32 v85,v85,s36,v14
v_mfma_f32_16x16x32_bf16 a[184:187],a[144:147],v[32:35],a[184:187]
v_exp_f32 v99,v99
v_mfma_f32_16x16x32_bf16 a[188:191],a[148:151],v[32:35],a[188:191]
v_exp_f32 v97,v97
v_mfma_f32_16x16x32_bf16 v[140:143],a[148:151],v[28:31],v[140:143]
v_exp_f32 v96,v96
v_mfma_f32_16x16x32_bf16 v[136:139],a[144:147],v[28:31],v[136:139]
v_cvt_pk_bf16_f32 v56,v96,v97
v_fma_f32 v87,v87,s36,v14
v_mfma_f32_16x16x32_bf16 v[232:235],a[144:147],v[24:27],v[232:235]
v_exp_f32 v98,v98
v_mfma_f32_16x16x32_bf16 v[236:239],a[148:151],v[24:27],v[236:239]
v_cvt_pk_bf16_f32 v57,v98,v99
v_fma_f32 v94,v94,s36,v15
v_mfma_f32_16x16x32_bf16 v[188:191],a[148:151],v[20:23],v[188:191]
v_exp_f32 v76,v76
v_mfma_f32_16x16x32_bf16 v[184:187],a[144:147],v[20:23],v[184:187]
s_waitcnt lgkmcnt(0)
v_exp_f32 v79,v79
v_mfma_f32_16x16x32_bf16 v[192:195],a[120:123],v[20:23],v[192:195]
v_exp_f32 v78,v78
v_mfma_f32_16x16x32_bf16 v[196:199],a[124:127],v[20:23],v[196:199]
s_waitcnt vmcnt(9)
ds_read_b128 a[156:159],v10 offset:3072
v_cvt_pk_bf16_f32 v47,v78,v79
v_mfma_f32_16x16x32_bf16 v[244:247],a[124:127],v[24:27],v[244:247]
s_barrier
v_mfma_f32_16x16x32_bf16 v[240:243],a[120:123],v[24:27],v[240:243]
ds_read_b128 a[148:151],v1 offset:128
v_fma_f32 v92,v92,s36,v15
v_mfma_f32_16x16x32_bf16 v[144:147],a[120:123],v[28:31],v[144:147]
ds_read_b128 a[144:147],v0 offset:128
v_fma_f32 v93,v93,s36,v15
v_mfma_f32_16x16x32_bf16 v[148:151],a[124:127],v[28:31],v[148:151]
ds_read_b128 a[140:143],v1 offset:0
v_fma_f32 v95,v95,s36,v15
v_mfma_f32_16x16x32_bf16 a[196:199],a[124:127],v[32:35],a[196:199]
ds_read_b128 a[124:127],v1 offset:256
v_fma_f32 v102,v102,s36,v16
v_mfma_f32_16x16x32_bf16 a[192:195],a[120:123],v[32:35],a[192:195]
ds_read_b128 a[120:123],v0 offset:256
v_fma_f32 v100,v100,s36,v16
v_mfma_f32_16x16x32_bf16 a[200:203],a[128:131],v[32:35],a[200:203]
buffer_load_dwordx4 v6,s[8:11],s21 offen offset:0 lds
v_mfma_f32_16x16x32_bf16 a[204:207],a[132:135],v[32:35],a[204:207]
ds_read_b128 a[136:139],v0 offset:0
v_fma_f32 v101,v101,s36,v16
v_mfma_f32_16x16x32_bf16 v[156:159],a[132:135],v[28:31],v[156:159]
v_exp_f32 v77,v77
v_mfma_f32_16x16x32_bf16 v[152:155],a[128:131],v[28:31],v[152:155]
v_cvt_pk_bf16_f32 v46,v76,v77
v_fma_f32 v103,v103,s36,v16
v_mfma_f32_16x16x32_bf16 v[248:251],a[128:131],v[24:27],v[248:251]
v_exp_f32 v86,v86
v_mfma_f32_16x16x32_bf16 v[252:255],a[132:135],v[24:27],v[252:255]
v_exp_f32 v87,v87
v_mfma_f32_16x16x32_bf16 v[204:207],a[132:135],v[20:23],v[204:207]
ds_read_b128 a[132:135],v1 offset:6144
v_cvt_pk_bf16_f32 v51,v86,v87
v_mfma_f32_16x16x32_bf16 v[200:203],a[128:131],v[20:23],v[200:203]
s_waitcnt lgkmcnt(2)
ds_read_b128 a[128:131],v0 offset:6144
v_mfma_f32_16x16x32_bf16 v[72:75],a[124:127],a[20:23],0
v_exp_f32 v85,v85
v_mfma_f32_16x16x32_bf16 v[72:75],a[120:123],a[16:19],v[72:75]
buffer_store_dwordx4 a[156:159],v9,s[16:19],s27 offen offset:0 nt
buffer_load_dwordx4 v7,s[8:11],s21 offen offset:1024 lds
v_mfma_f32_16x16x32_bf16 v[72:75],a[148:151],a[12:15],v[72:75]
ds_read_b128 a[156:159],v10 offset:4096
v_mfma_f32_16x16x32_bf16 v[72:75],a[144:147],a[8:11],v[72:75]
v_exp_f32 v84,v84
v_mfma_f32_16x16x32_bf16 v[72:75],a[140:143],a[4:7],v[72:75]
s_waitcnt lgkmcnt(3)
v_cvt_pk_bf16_f32 v50,v84,v85
v_mfma_f32_16x16x32_bf16 v[72:75],a[136:139],a[0:3],v[72:75]
v_exp_f32 v93,v93
v_smfmac_f32_16x16x64_bf16 v[60:63],a[152:155],v[44:51],v18
v_mfma_f32_16x16x32_bf16 v[80:83],a[136:139],a[24:27],0
v_exp_f32 v94,v94
v_mfma_f32_16x16x32_bf16 v[80:83],a[140:143],a[28:31],v[80:83]
v_exp_f32 v92,v92
v_mfma_f32_16x16x32_bf16 v[80:83],a[144:147],a[32:35],v[80:83]
buffer_load_dwordx4 v8,s[8:11],s21 offen offset:2048 lds
v_mfma_f32_16x16x32_bf16 v[80:83],a[148:151],a[36:39],v[80:83]
s_add_u32 s21,s21,12288
v_cvt_pk_bf16_f32 v54,v92,v93
v_fma_f32 v72,v72,s36,v13
v_mfma_f32_16x16x32_bf16 v[80:83],a[120:123],a[40:43],v[80:83]
s_add_u32 m0,s22,24576
v_exp_f32 v95,v95
v_mfma_f32_16x16x32_bf16 v[80:83],a[124:127],a[44:47],v[80:83]
v_cvt_pk_bf16_f32 v55,v94,v95
v_fma_f32 v75,v75,s36,v13
v_mfma_f32_16x16x32_bf16 v[88:91],a[124:127],a[68:71],0
v_exp_f32 v103,v103
v_mfma_f32_16x16x32_bf16 v[88:91],a[120:123],a[64:67],v[88:91]
v_exp_f32 v100,v100
v_mfma_f32_16x16x32_bf16 v[88:91],a[148:151],a[60:63],v[88:91]
v_exp_f32 v102,v102
v_mfma_f32_16x16x32_bf16 v[88:91],a[144:147],a[56:59],v[88:91]
v_cvt_pk_bf16_f32 v59,v102,v103
v_fma_f32 v80,v80,s36,v14
v_mfma_f32_16x16x32_bf16 v[88:91],a[140:143],a[52:55],v[88:91]
v_exp_f32 v101,v101
v_mfma_f32_16x16x32_bf16 v[88:91],a[136:139],a[48:51],v[88:91]
s_waitcnt lgkmcnt(0)
buffer_store_dwordx4 a[156:159],v9,s[16:19],s27 offen offset:128 nt
buffer_load_dwordx4 v6,s[4:7],s20 offen offset:0 lds
v_mfma_f32_16x16x32_bf16 v[96:99],a[136:139],a[72:75],0
ds_read_b128 a[156:159],v10 offset:5120
v_cvt_pk_bf16_f32 v58,v100,v101
v_mfma_f32_16x16x32_bf16 v[96:99],a[140:143],a[76:79],v[96:99]
ds_read_b128 a[136:139],v0 offset:6272
v_fma_f32 v81,v81,s36,v14
v_smfmac_f32_16x16x64_bf16 v[64:67],a[152:155],v[52:59],v18
ds_read_b128 a[140:143],v1 offset:6272
v_mfma_f32_16x16x32_bf16 v[96:99],a[144:147],a[80:83],v[96:99]
ds_read_b128 a[144:147],v0 offset:6400
v_mfma_f32_16x16x32_bf16 v[96:99],a[148:151],a[84:87],v[96:99]
ds_read_b128 a[148:151],v1 offset:6400
v_mfma_f32_16x16x32_bf16 v[96:99],a[120:123],a[88:91],v[96:99]
v_fma_f32 v73,v73,s36,v13
v_fma_f32 v74,v74,s36,v13
v_mfma_f32_16x16x32_bf16 v[96:99],a[124:127],a[92:95],v[96:99]
v_exp_f32 v74,v74
v_mfma_f32_16x16x32_bf16 v[76:79],a[128:131],a[0:3],0
buffer_load_dwordx4 v7,s[4:7],s20 offen offset:1024 lds
v_mfma_f32_16x16x32_bf16 v[76:79],a[132:135],a[4:7],v[76:79]
s_waitcnt lgkmcnt(3)
v_exp_f32 v75,v75
v_mfma_f32_16x16x32_bf16 v[76:79],a[136:139],a[8:11],v[76:79]
s_waitcnt lgkmcnt(2)
v_cvt_pk_bf16_f32 v21,v74,v75
v_mfma_f32_16x16x32_bf16 v[76:79],a[140:143],a[12:15],v[76:79]
s_waitcnt lgkmcnt(1)
v_exp_f32 v73,v73
v_mfma_f32_16x16x32_bf16 v[76:79],a[144:147],a[16:19],v[76:79]
s_waitcnt lgkmcnt(0)
v_exp_f32 v80,v80
v_mfma_f32_16x16x32_bf16 v[76:79],a[148:151],a[20:23],v[76:79]
v_exp_f32 v81,v81
v_mfma_f32_16x16x32_bf16 v[84:87],a[148:151],a[44:47],0
v_cvt_pk_bf16_f32 v24,v80,v81
v_mfma_f32_16x16x32_bf16 v[84:87],a[144:147],a[40:43],v[84:87]
v_exp_f32 v72,v72
v_mfma_f32_16x16x32_bf16 v[84:87],a[140:143],a[36:39],v[84:87]
v_cvt_pk_bf16_f32 v20,v72,v73
v_mfma_f32_16x16x32_bf16 v[84:87],a[136:139],a[32:35],v[84:87]
buffer_store_dwordx4 a[156:159],v9,s[16:19],s27 offen offset:256 nt
buffer_load_dwordx4 v8,s[4:7],s20 offen offset:2048 lds
v_mfma_f32_16x16x32_bf16 v[84:87],a[132:135],a[28:31],v[84:87]
s_add_u32 s20,s20,12288
ds_read_b64_tr_b16 a[122:123],v2 offset:30720
v_mfma_f32_16x16x32_bf16 v[84:87],a[128:131],a[24:27],v[84:87]
s_add_u32 s27,s27,3072
ds_read_b64_tr_b16 a[120:121],v2 offset:24576
v_mfma_f32_16x16x32_bf16 v[92:95],a[128:131],a[48:51],0
ds_read_b64_tr_b16 a[124:125],v3 offset:24576
v_mfma_f32_16x16x32_bf16 v[92:95],a[132:135],a[52:55],v[92:95]
ds_read_b64_tr_b16 a[126:127],v3 offset:30720
v_mfma_f32_16x16x32_bf16 v[92:95],a[136:139],a[56:59],v[92:95]
v_mfma_f32_16x16x32_bf16 v[92:95],a[140:143],a[60:63],v[92:95]
v_mfma_f32_16x16x32_bf16 v[92:95],a[144:147],a[64:67],v[92:95]
v_mfma_f32_16x16x32_bf16 v[92:95],a[148:151],a[68:71],v[92:95]
v_mfma_f32_16x16x32_bf16 v[100:103],a[148:151],a[92:95],0
v_mfma_f32_16x16x32_bf16 v[100:103],a[144:147],a[88:91],v[100:103]
v_mfma_f32_16x16x32_bf16 v[100:103],a[140:143],a[84:87],v[100:103]
v_mfma_f32_16x16x32_bf16 v[100:103],a[136:139],a[80:83],v[100:103]
v_mfma_f32_16x16x32_bf16 v[100:103],a[132:135],a[76:79],v[100:103]
ds_read_b64_tr_b16 a[134:135],v5 offset:30720
v_mfma_f32_16x16x32_bf16 v[100:103],a[128:131],a[72:75],v[100:103]
s_waitcnt lgkmcnt(1)
ds_read_b64_tr_b16 a[128:129],v4 offset:24576
ds_read_b64_tr_b16 a[130:131],v4 offset:30720
ds_read_b64_tr_b16 a[132:133],v5 offset:24576
v_mfma_f32_16x16x32_bf16 v[160:163],a[120:123],v[44:47],v[160:163]
s_add_u32 m0,s29,0
ds_read_b64_tr_b16 a[136:137],v2 offset:24704
v_fma_f32 v82,v82,s36,v14
v_mfma_f32_16x16x32_bf16 v[164:167],a[124:127],v[44:47],v[164:167]
ds_read_b64_tr_b16 a[138:139],v2 offset:30848
v_fma_f32 v83,v83,s36,v14
v_mfma_f32_16x16x32_bf16 v[212:215],a[124:127],v[48:51],v[212:215]
ds_read_b64_tr_b16 a[140:141],v3 offset:24704
v_fma_f32 v88,v88,s36,v15
v_mfma_f32_16x16x32_bf16 v[208:211],a[120:123],v[48:51],v[208:211]
ds_read_b64_tr_b16 a[142:143],v3 offset:30848
v_fma_f32 v89,v89,s36,v15
v_mfma_f32_16x16x32_bf16 v[112:115],a[120:123],v[52:55],v[112:115]
ds_read_b64_tr_b16 a[144:145],v4 offset:24704
v_fma_f32 v90,v90,s36,v15
v_mfma_f32_16x16x32_bf16 v[116:119],a[124:127],v[52:55],v[116:119]
ds_read_b64_tr_b16 a[146:147],v4 offset:30848
v_fma_f32 v91,v91,s36,v15
v_mfma_f32_16x16x32_bf16 a[164:167],a[124:127],v[56:59],a[164:167]
buffer_load_dwordx4 v6,s[12:15],s28 offen offset:0 nt lds
v_mfma_f32_16x16x32_bf16 a[160:163],a[120:123],v[56:59],a[160:163]
s_waitcnt lgkmcnt(5)
ds_read_b64_tr_b16 a[148:149],v5 offset:24704
v_fma_f32 v96,v96,s36,v16
v_mfma_f32_16x16x32_bf16 a[168:171],a[128:131],v[56:59],a[168:171]
ds_read_b64_tr_b16 a[150:151],v5 offset:30848
v_fma_f32 v97,v97,s36,v16
v_mfma_f32_16x16x32_bf16 a[172:175],a[132:135],v[56:59],a[172:175]
ds_read_b64_tr_b16 a[120:121],v2 offset:24832
v_fma_f32 v98,v98,s36,v16
v_mfma_f32_16x16x32_bf16 v[124:127],a[132:135],v[52:55],v[124:127]
ds_read_b64_tr_b16 a[122:123],v2 offset:30976
v_fma_f32 v99,v99,s36,v16
v_mfma_f32_16x16x32_bf16 v[120:123],a[128:131],v[52:55],v[120:123]
ds_read_b64_tr_b16 a[124:125],v3 offset:24832
v_fma_f32 v76,v76,s36,v13
v_mfma_f32_16x16x32_bf16 v[216:219],a[128:131],v[48:51],v[216:219]
ds_read_b64_tr_b16 a[126:127],v3 offset:30976
v_fma_f32 v77,v77,s36,v13
v_mfma_f32_16x16x32_bf16 v[220:223],a[132:135],v[48:51],v[220:223]
buffer_load_dwordx4 v7,s[12:15],s28 offen offset:1024 nt lds
v_mfma_f32_16x16x32_bf16 v[172:175],a[132:135],v[44:47],v[172:175]
ds_read_b64_tr_b16 a[132:133],v5 offset:24832
v_fma_f32 v78,v78,s36,v13
v_mfma_f32_16x16x32_bf16 v[168:171],a[128:131],v[44:47],v[168:171]
s_waitcnt lgkmcnt(5)
ds_read_b64_tr_b16 a[128:129],v4 offset:24832
v_fma_f32 v79,v79,s36,v13
v_mfma_f32_16x16x32_bf16 v[176:179],a[136:139],v[44:47],v[176:179]
ds_read_b64_tr_b16 a[130:131],v4 offset:30976
v_fma_f32 v84,v84,s36,v14
v_mfma_f32_16x16x32_bf16 v[180:183],a[140:143],v[44:47],v[180:183]
ds_read_b64_tr_b16 a[134:135],v5 offset:30976
v_fma_f32 v85,v85,s36,v14
v_mfma_f32_16x16x32_bf16 v[228:231],a[140:143],v[48:51],v[228:231]
v_exp_f32 v82,v82
v_mfma_f32_16x16x32_bf16 v[224:227],a[136:139],v[48:51],v[224:227]
v_exp_f32 v83,v83
v_mfma_f32_16x16x32_bf16 v[128:131],a[136:139],v[52:55],v[128:131]
v_cvt_pk_bf16_f32 v25,v82,v83
v_fma_f32 v86,v86,s36,v14
v_mfma_f32_16x16x32_bf16 v[132:135],a[140:143],v[52:55],v[132:135]
buffer_load_dwordx4 v8,s[12:15],s28 offen offset:2048 nt lds
v_mfma_f32_16x16x32_bf16 a[180:183],a[140:143],v[56:59],a[180:183]
s_add_u32 s28,s28,3072
v_exp_f32 v88,v88
v_mfma_f32_16x16x32_bf16 a[176:179],a[136:139],v[56:59],a[176:179]
s_add_u32 s29,s29,3072
v_exp_f32 v89,v89
v_mfma_f32_16x16x32_bf16 a[184:187],a[144:147],v[56:59],a[184:187]
s_add_u32 m0,s23,24576
v_exp_f32 v90,v90
v_mfma_f32_16x16x32_bf16 a[188:191],a[148:151],v[56:59],a[188:191]
v_exp_f32 v91,v91
v_mfma_f32_16x16x32_bf16 v[140:143],a[148:151],v[52:55],v[140:143]
v_cvt_pk_bf16_f32 v28,v88,v89
v_cvt_pk_bf16_f32 v29,v90,v91
v_mfma_f32_16x16x32_bf16 v[136:139],a[144:147],v[52:55],v[136:139]
v_exp_f32 v96,v96
v_mfma_f32_16x16x32_bf16 v[232:235],a[144:147],v[48:51],v[232:235]
v_exp_f32 v97,v97
v_mfma_f32_16x16x32_bf16 v[236:239],a[148:151],v[48:51],v[236:239]
v_exp_f32 v98,v98
v_mfma_f32_16x16x32_bf16 v[188:191],a[148:151],v[44:47],v[188:191]
v_exp_f32 v99,v99
v_mfma_f32_16x16x32_bf16 v[184:187],a[144:147],v[44:47],v[184:187]
s_waitcnt lgkmcnt(0)
v_cvt_pk_bf16_f32 v32,v96,v97
v_cvt_pk_bf16_f32 v33,v98,v99
v_mfma_f32_16x16x32_bf16 v[192:195],a[120:123],v[44:47],v[192:195]
s_waitcnt vmcnt(12)
v_exp_f32 v76,v76
v_mfma_f32_16x16x32_bf16 v[196:199],a[124:127],v[44:47],v[196:199]
s_barrier
v_mfma_f32_16x16x32_bf16 v[244:247],a[124:127],v[48:51],v[244:247]
ds_read_b128 a[148:151],v1 offset:12416
v_fma_f32 v87,v87,s36,v14
v_mfma_f32_16x16x32_bf16 v[240:243],a[120:123],v[48:51],v[240:243]
ds_read_b128 a[144:147],v0 offset:12416
v_fma_f32 v92,v92,s36,v15
v_mfma_f32_16x16x32_bf16 v[144:147],a[120:123],v[52:55],v[144:147]
ds_read_b128 a[140:143],v1 offset:12288
v_fma_f32 v93,v93,s36,v15
v_mfma_f32_16x16x32_bf16 v[148:151],a[124:127],v[52:55],v[148:151]
ds_read_b128 a[136:139],v0 offset:12288
v_fma_f32 v94,v94,s36,v15
v_mfma_f32_16x16x32_bf16 a[196:199],a[124:127],v[56:59],a[196:199]
ds_read_b128 a[124:127],v1 offset:12544
v_fma_f32 v95,v95,s36,v15
v_mfma_f32_16x16x32_bf16 a[192:195],a[120:123],v[56:59],a[192:195]
buffer_load_dwordx4 v6,s[8:11],s21 offen offset:0 lds
v_mfma_f32_16x16x32_bf16 a[200:203],a[128:131],v[56:59],a[200:203]
ds_read_b128 a[120:123],v0 offset:12544
v_fma_f32 v100,v100,s36,v16
v_mfma_f32_16x16x32_bf16 a[204:207],a[132:135],v[56:59],a[204:207]
v_exp_f32 v77,v77
v_mfma_f32_16x16x32_bf16 v[156:159],a[132:135],v[52:55],v[156:159]
v_exp_f32 v78,v78
v_mfma_f32_16x16x32_bf16 v[152:155],a[128:131],v[52:55],v[152:155]
v_exp_f32 v79,v79
v_mfma_f32_16x16x32_bf16 v[248:251],a[128:131],v[48:51],v[248:251]
v_cvt_pk_bf16_f32 v22,v76,v77
v_cvt_pk_bf16_f32 v23,v78,v79
v_mfma_f32_16x16x32_bf16 v[252:255],a[132:135],v[48:51],v[252:255]
v_exp_f32 v84,v84
v_mfma_f32_16x16x32_bf16 v[204:207],a[132:135],v[44:47],v[204:207]
ds_read_b128 a[132:135],v1 offset:18432
v_fma_f32 v101,v101,s36,v16
v_mfma_f32_16x16x32_bf16 v[200:203],a[128:131],v[44:47],v[200:203]
s_waitcnt lgkmcnt(1)
ds_read_b128 a[128:131],v0 offset:18432
v_fma_f32 v102,v102,s36,v16
v_mfma_f32_16x16x32_bf16 v[72:75],a[124:127],a[20:23],0
buffer_load_dwordx4 v7,s[8:11],s21 offen offset:1024 lds
v_mfma_f32_16x16x32_bf16 v[72:75],a[120:123],a[16:19],v[72:75]
v_exp_f32 v85,v85
v_mfma_f32_16x16x32_bf16 v[72:75],a[148:151],a[12:15],v[72:75]
v_exp_f32 v86,v86
v_mfma_f32_16x16x32_bf16 v[72:75],a[144:147],a[8:11],v[72:75]
v_exp_f32 v87,v87
v_mfma_f32_16x16x32_bf16 v[72:75],a[140:143],a[4:7],v[72:75]
v_cvt_pk_bf16_f32 v26,v84,v85
v_cvt_pk_bf16_f32 v27,v86,v87
v_mfma_f32_16x16x32_bf16 v[72:75],a[136:139],a[0:3],v[72:75]
v_exp_f32 v92,v92
v_smfmac_f32_16x16x64_bf16 v[60:63],a[152:155],v[20:27],v18
v_fma_f32 v103,v103,s36,v16
v_mfma_f32_16x16x32_bf16 v[80:83],a[136:139],a[24:27],0
v_exp_f32 v93,v93
v_mfma_f32_16x16x32_bf16 v[80:83],a[140:143],a[28:31],v[80:83]
buffer_load_dwordx4 v8,s[8:11],s21 offen offset:2048 lds
v_mfma_f32_16x16x32_bf16 v[80:83],a[144:147],a[32:35],v[80:83]
s_add_u32 s21,s21,12288
v_exp_f32 v94,v94
v_mfma_f32_16x16x32_bf16 v[80:83],a[148:151],a[36:39],v[80:83]
s_add_u32 m0,s22,0
v_exp_f32 v95,v95
v_mfma_f32_16x16x32_bf16 v[80:83],a[120:123],a[40:43],v[80:83]
v_cvt_pk_bf16_f32 v30,v92,v93
v_cvt_pk_bf16_f32 v31,v94,v95
v_mfma_f32_16x16x32_bf16 v[80:83],a[124:127],a[44:47],v[80:83]
v_exp_f32 v100,v100
v_mfma_f32_16x16x32_bf16 v[88:91],a[124:127],a[68:71],0
v_exp_f32 v101,v101
v_mfma_f32_16x16x32_bf16 v[88:91],a[120:123],a[64:67],v[88:91]
v_exp_f32 v102,v102
v_mfma_f32_16x16x32_bf16 v[88:91],a[148:151],a[60:63],v[88:91]
v_exp_f32 v103,v103
v_mfma_f32_16x16x32_bf16 v[88:91],a[144:147],a[56:59],v[88:91]
v_cvt_pk_bf16_f32 v34,v100,v101
v_cvt_pk_bf16_f32 v35,v102,v103
v_mfma_f32_16x16x32_bf16 v[88:91],a[140:143],a[52:55],v[88:91]
buffer_load_dwordx4 v6,s[4:7],s20 offen offset:0 lds
v_smfmac_f32_16x16x64_bf16 v[64:67],a[152:155],v[28:35],v18
v_fma_f32 v72,v72,s36,v13
v_mfma_f32_16x16x32_bf16 v[88:91],a[136:139],a[48:51],v[88:91]
v_fma_f32 v73,v73,s36,v13
v_fma_f32 v74,v74,s36,v13
v_mfma_f32_16x16x32_bf16 v[96:99],a[136:139],a[72:75],0
ds_read_b128 a[136:139],v0 offset:18560
v_fma_f32 v75,v75,s36,v13
v_mfma_f32_16x16x32_bf16 v[96:99],a[140:143],a[76:79],v[96:99]
ds_read_b128 a[140:143],v1 offset:18560
v_fma_f32 v80,v80,s36,v14
v_mfma_f32_16x16x32_bf16 v[96:99],a[144:147],a[80:83],v[96:99]
ds_read_b128 a[144:147],v0 offset:18688
v_fma_f32 v81,v81,s36,v14
v_mfma_f32_16x16x32_bf16 v[96:99],a[148:151],a[84:87],v[96:99]
ds_read_b128 a[148:151],v1 offset:18688
v_mfma_f32_16x16x32_bf16 v[96:99],a[120:123],a[88:91],v[96:99]
v_exp_f32 v72,v72
v_mfma_f32_16x16x32_bf16 v[96:99],a[124:127],a[92:95],v[96:99]
s_waitcnt lgkmcnt(4)
v_exp_f32 v73,v73
v_mfma_f32_16x16x32_bf16 v[76:79],a[128:131],a[0:3],0
buffer_load_dwordx4 v7,s[4:7],s20 offen offset:1024 lds
v_mfma_f32_16x16x32_bf16 v[76:79],a[132:135],a[4:7],v[76:79]
s_waitcnt lgkmcnt(3)
v_exp_f32 v74,v74
v_mfma_f32_16x16x32_bf16 v[76:79],a[136:139],a[8:11],v[76:79]
s_waitcnt lgkmcnt(2)
v_exp_f32 v75,v75
v_mfma_f32_16x16x32_bf16 v[76:79],a[140:143],a[12:15],v[76:79]
s_waitcnt lgkmcnt(0)
v_exp_f32 v80,v80
v_mfma_f32_16x16x32_bf16 v[76:79],a[144:147],a[16:19],v[76:79]
v_exp_f32 v81,v81
v_mfma_f32_16x16x32_bf16 v[76:79],a[148:151],a[20:23],v[76:79]
v_cvt_pk_bf16_f32 v44,v72,v73
v_cvt_pk_bf16_f32 v45,v74,v75
v_mfma_f32_16x16x32_bf16 v[84:87],a[148:151],a[44:47],0
v_cvt_pk_bf16_f32 v48,v80,v81
v_mfma_f32_16x16x32_bf16 v[84:87],a[144:147],a[40:43],v[84:87]
v_mfma_f32_16x16x32_bf16 v[84:87],a[140:143],a[36:39],v[84:87]
v_mfma_f32_16x16x32_bf16 v[84:87],a[136:139],a[32:35],v[84:87]
buffer_load_dwordx4 v8,s[4:7],s20 offen offset:2048 lds
v_mfma_f32_16x16x32_bf16 v[84:87],a[132:135],a[28:31],v[84:87]
s_add_u32 s20,s20,12288
v_mfma_f32_16x16x32_bf16 v[84:87],a[128:131],a[24:27],v[84:87]
ds_read_b64_tr_b16 a[120:121],v2 offset:0
v_mfma_f32_16x16x32_bf16 v[92:95],a[128:131],a[48:51],0
ds_read_b64_tr_b16 a[122:123],v2 offset:6144
v_mfma_f32_16x16x32_bf16 v[92:95],a[132:135],a[52:55],v[92:95]
ds_read_b64_tr_b16 a[124:125],v3 offset:0
v_mfma_f32_16x16x32_bf16 v[92:95],a[136:139],a[56:59],v[92:95]
ds_read_b64_tr_b16 a[126:127],v3 offset:6144
v_mfma_f32_16x16x32_bf16 v[92:95],a[140:143],a[60:63],v[92:95]
v_mfma_f32_16x16x32_bf16 v[92:95],a[144:147],a[64:67],v[92:95]
v_mfma_f32_16x16x32_bf16 v[92:95],a[148:151],a[68:71],v[92:95]
v_mfma_f32_16x16x32_bf16 v[100:103],a[148:151],a[92:95],0
v_mfma_f32_16x16x32_bf16 v[100:103],a[144:147],a[88:91],v[100:103]
v_mfma_f32_16x16x32_bf16 v[100:103],a[140:143],a[84:87],v[100:103]
v_mfma_f32_16x16x32_bf16 v[100:103],a[136:139],a[80:83],v[100:103]
v_mfma_f32_16x16x32_bf16 v[100:103],a[132:135],a[76:79],v[100:103]
ds_read_b64_tr_b16 a[132:133],v5 offset:0
v_mfma_f32_16x16x32_bf16 v[100:103],a[128:131],a[72:75],v[100:103]
s_waitcnt lgkmcnt(1)
ds_read_b64_tr_b16 a[128:129],v4 offset:0
ds_read_b64_tr_b16 a[130:131],v4 offset:6144
ds_read_b64_tr_b16 a[134:135],v5 offset:6144
v_mfma_f32_16x16x32_bf16 v[160:163],a[120:123],v[20:23],v[160:163]
s_add_u32 m0,s23,0
ds_read_b64_tr_b16 a[142:143],v3 offset:6272
v_fma_f32 v83,v83,s36,v14
v_mfma_f32_16x16x32_bf16 v[164:167],a[124:127],v[20:23],v[164:167]
ds_read_b64_tr_b16 a[138:139],v2 offset:6272
v_fma_f32 v82,v82,s36,v14
v_mfma_f32_16x16x32_bf16 v[212:215],a[124:127],v[24:27],v[212:215]
ds_read_b64_tr_b16 a[136:137],v2 offset:128
v_fma_f32 v88,v88,s36,v15
v_mfma_f32_16x16x32_bf16 v[208:211],a[120:123],v[24:27],v[208:211]
ds_read_b64_tr_b16 a[140:141],v3 offset:128
v_fma_f32 v91,v91,s36,v15
v_mfma_f32_16x16x32_bf16 v[112:115],a[120:123],v[28:31],v[112:115]
ds_read_b64_tr_b16 a[146:147],v4 offset:6272
v_fma_f32 v89,v89,s36,v15
v_mfma_f32_16x16x32_bf16 v[116:119],a[124:127],v[28:31],v[116:119]
ds_read_b64_tr_b16 a[150:151],v5 offset:6272
v_fma_f32 v90,v90,s36,v15
v_mfma_f32_16x16x32_bf16 a[164:167],a[124:127],v[32:35],a[164:167]
ds_read_b64_tr_b16 a[144:145],v4 offset:128
v_fma_f32 v96,v96,s36,v16
v_mfma_f32_16x16x32_bf16 a[160:163],a[120:123],v[32:35],a[160:163]
s_waitcnt lgkmcnt(6)
ds_read_b64_tr_b16 a[148:149],v5 offset:128
v_fma_f32 v98,v98,s36,v16
v_mfma_f32_16x16x32_bf16 a[168:171],a[128:131],v[32:35],a[168:171]
ds_read_b64_tr_b16 a[120:121],v2 offset:256
v_fma_f32 v99,v99,s36,v16
v_mfma_f32_16x16x32_bf16 a[172:175],a[132:135],v[32:35],a[172:175]
ds_read_b64_tr_b16 a[126:127],v3 offset:6400
v_fma_f32 v97,v97,s36,v16
v_mfma_f32_16x16x32_bf16 v[124:127],a[132:135],v[28:31],v[124:127]
ds_read_b64_tr_b16 a[122:123],v2 offset:6400
v_fma_f32 v79,v79,s36,v13
v_mfma_f32_16x16x32_bf16 v[120:123],a[128:131],v[28:31],v[120:123]
ds_read_b64_tr_b16 a[124:125],v3 offset:256
v_fma_f32 v77,v77,s36,v13
v_mfma_f32_16x16x32_bf16 v[216:219],a[128:131],v[24:27],v[216:219]
v_exp_f32 v82,v82
v_mfma_f32_16x16x32_bf16 v[220:223],a[132:135],v[24:27],v[220:223]
v_exp_f32 v83,v83
v_mfma_f32_16x16x32_bf16 v[172:175],a[132:135],v[20:23],v[172:175]
ds_read_b64_tr_b16 a[132:133],v5 offset:256
v_cvt_pk_bf16_f32 v49,v82,v83
v_mfma_f32_16x16x32_bf16 v[168:171],a[128:131],v[20:23],v[168:171]
s_waitcnt lgkmcnt(4)
ds_read_b64_tr_b16 a[134:135],v5 offset:6400
v_fma_f32 v76,v76,s36,v13
v_mfma_f32_16x16x32_bf16 v[176:179],a[136:139],v[20:23],v[176:179]
ds_read_b64_tr_b16 a[128:129],v4 offset:256
v_fma_f32 v78,v78,s36,v13
v_mfma_f32_16x16x32_bf16 v[180:183],a[140:143],v[20:23],v[180:183]
ds_read_b64_tr_b16 a[130:131],v4 offset:6400
v_fma_f32 v86,v86,s36,v14
v_mfma_f32_16x16x32_bf16 v[228:231],a[140:143],v[24:27],v[228:231]
v_exp_f32 v90,v90
v_mfma_f32_16x16x32_bf16 v[224:227],a[136:139],v[24:27],v[224:227]
v_exp_f32 v88,v88
v_mfma_f32_16x16x32_bf16 v[128:131],a[136:139],v[28:31],v[128:131]
v_exp_f32 v89,v89
v_mfma_f32_16x16x32_bf16 v[132:135],a[140:143],v[28:31],v[132:135]
v_cvt_pk_bf16_f32 v52,v88,v89
v_fma_f32 v84,v84,s36,v14
v_mfma_f32_16x16x32_bf16 a[180:183],a[140:143],v[32:35],a[180:183]
v_exp_f32 v91,v91
v_mfma_f32_16x16x32_bf16 a[176:179],a[136:139],v[32:35],a[176:179]
v_cvt_pk_bf16_f32 v53,v90,v91
v_fma_f32 v85,v85,s36,v14
v_mfma_f32_16x16x32_bf16 a[184:187],a[144:147],v[32:35],a[184:187]
v_exp_f32 v99,v99
v_mfma_f32_16x16x32_bf16 a[188:191],a[148:151],v[32:35],a[188:191]
v_exp_f32 v97,v97
v_mfma_f32_16x16x32_bf16 v[140:143],a[148:151],v[28:31],v[140:143]
v_exp_f32 v96,v96
v_mfma_f32_16x16x32_bf16 v[136:139],a[144:147],v[28:31],v[136:139]
v_cvt_pk_bf16_f32 v56,v96,v97
v_fma_f32 v87,v87,s36,v14
v_mfma_f32_16x16x32_bf16 v[232:235],a[144:147],v[24:27],v[232:235]
v_exp_f32 v98,v98
v_mfma_f32_16x16x32_bf16 v[236:239],a[148:151],v[24:27],v[236:239]
v_cvt_pk_bf16_f32 v57,v98,v99
v_fma_f32 v94,v94,s36,v15
v_mfma_f32_16x16x32_bf16 v[188:191],a[148:151],v[20:23],v[188:191]
v_exp_f32 v76,v76
v_mfma_f32_16x16x32_bf16 v[184:187],a[144:147],v[20:23],v[184:187]
s_waitcnt lgkmcnt(0)
v_exp_f32 v79,v79
v_mfma_f32_16x16x32_bf16 v[192:195],a[120:123],v[20:23],v[192:195]
v_exp_f32 v78,v78
v_mfma_f32_16x16x32_bf16 v[196:199],a[124:127],v[20:23],v[196:199]
s_waitcnt vmcnt(9)
ds_read_b128 a[156:159],v10 offset:6144
v_cvt_pk_bf16_f32 v47,v78,v79
v_mfma_f32_16x16x32_bf16 v[244:247],a[124:127],v[24:27],v[244:247]
s_barrier
v_mfma_f32_16x16x32_bf16 v[240:243],a[120:123],v[24:27],v[240:243]
ds_read_b128 a[148:151],v1 offset:24704
v_fma_f32 v92,v92,s36,v15
v_mfma_f32_16x16x32_bf16 v[144:147],a[120:123],v[28:31],v[144:147]
ds_read_b128 a[144:147],v0 offset:24704
v_fma_f32 v93,v93,s36,v15
v_mfma_f32_16x16x32_bf16 v[148:151],a[124:127],v[28:31],v[148:151]
ds_read_b128 a[140:143],v1 offset:24576
v_fma_f32 v95,v95,s36,v15
v_mfma_f32_16x16x32_bf16 a[196:199],a[124:127],v[32:35],a[196:199]
ds_read_b128 a[124:127],v1 offset:24832
v_fma_f32 v102,v102,s36,v16
v_mfma_f32_16x16x32_bf16 a[192:195],a[120:123],v[32:35],a[192:195]
ds_read_b128 a[120:123],v0 offset:24832
v_fma_f32 v100,v100,s36,v16
v_mfma_f32_16x16x32_bf16 a[200:203],a[128:131],v[32:35],a[200:203]
buffer_load_dwordx4 v6,s[8:11],s21 offen offset:0 lds
v_mfma_f32_16x16x32_bf16 a[204:207],a[132:135],v[32:35],a[204:207]
ds_read_b128 a[136:139],v0 offset:24576
v_fma_f32 v101,v101,s36,v16
v_mfma_f32_16x16x32_bf16 v[156:159],a[132:135],v[28:31],v[156:159]
v_exp_f32 v77,v77
v_mfma_f32_16x16x32_bf16 v[152:155],a[128:131],v[28:31],v[152:155]
v_cvt_pk_bf16_f32 v46,v76,v77
v_fma_f32 v103,v103,s36,v16
v_mfma_f32_16x16x32_bf16 v[248:251],a[128:131],v[24:27],v[248:251]
v_exp_f32 v86,v86
v_mfma_f32_16x16x32_bf16 v[252:255],a[132:135],v[24:27],v[252:255]
v_exp_f32 v87,v87
v_mfma_f32_16x16x32_bf16 v[204:207],a[132:135],v[20:23],v[204:207]
ds_read_b128 a[132:135],v1 offset:30720
v_cvt_pk_bf16_f32 v51,v86,v87
v_mfma_f32_16x16x32_bf16 v[200:203],a[128:131],v[20:23],v[200:203]
s_waitcnt lgkmcnt(2)
ds_read_b128 a[128:131],v0 offset:30720
v_mfma_f32_16x16x32_bf16 v[72:75],a[124:127],a[20:23],0
v_exp_f32 v85,v85
v_mfma_f32_16x16x32_bf16 v[72:75],a[120:123],a[16:19],v[72:75]
buffer_store_dwordx4 a[156:159],v9,s[16:19],s27 offen offset:0 nt
buffer_load_dwordx4 v7,s[8:11],s21 offen offset:1024 lds
v_mfma_f32_16x16x32_bf16 v[72:75],a[148:151],a[12:15],v[72:75]
ds_read_b128 a[156:159],v10 offset:7168
v_mfma_f32_16x16x32_bf16 v[72:75],a[144:147],a[8:11],v[72:75]
v_exp_f32 v84,v84
v_mfma_f32_16x16x32_bf16 v[72:75],a[140:143],a[4:7],v[72:75]
s_waitcnt lgkmcnt(3)
v_cvt_pk_bf16_f32 v50,v84,v85
v_mfma_f32_16x16x32_bf16 v[72:75],a[136:139],a[0:3],v[72:75]
v_exp_f32 v93,v93
v_smfmac_f32_16x16x64_bf16 v[60:63],a[152:155],v[44:51],v18
v_mfma_f32_16x16x32_bf16 v[80:83],a[136:139],a[24:27],0
v_exp_f32 v94,v94
v_mfma_f32_16x16x32_bf16 v[80:83],a[140:143],a[28:31],v[80:83]
v_exp_f32 v92,v92
v_mfma_f32_16x16x32_bf16 v[80:83],a[144:147],a[32:35],v[80:83]
buffer_load_dwordx4 v8,s[8:11],s21 offen offset:2048 lds
v_mfma_f32_16x16x32_bf16 v[80:83],a[148:151],a[36:39],v[80:83]
s_add_u32 s21,s21,12288
v_cvt_pk_bf16_f32 v54,v92,v93
v_fma_f32 v74,v74,s36,v13
v_mfma_f32_16x16x32_bf16 v[80:83],a[120:123],a[40:43],v[80:83]
s_cmp_eq_u32 s38,1
v_exp_f32 v95,v95
v_mfma_f32_16x16x32_bf16 v[80:83],a[124:127],a[44:47],v[80:83]
s_cselect_b32 s20,s26,s20
v_cvt_pk_bf16_f32 v55,v94,v95
v_fma_f32 v75,v75,s36,v13
v_mfma_f32_16x16x32_bf16 v[88:91],a[124:127],a[68:71],0
s_add_u32 m0,s22,12288
v_exp_f32 v103,v103
v_mfma_f32_16x16x32_bf16 v[88:91],a[120:123],a[64:67],v[88:91]
v_exp_f32 v100,v100
v_mfma_f32_16x16x32_bf16 v[88:91],a[148:151],a[60:63],v[88:91]
v_exp_f32 v102,v102
v_mfma_f32_16x16x32_bf16 v[88:91],a[144:147],a[56:59],v[88:91]
v_cvt_pk_bf16_f32 v59,v102,v103
v_fma_f32 v73,v73,s36,v13
v_mfma_f32_16x16x32_bf16 v[88:91],a[140:143],a[52:55],v[88:91]
v_exp_f32 v101,v101
v_mfma_f32_16x16x32_bf16 v[88:91],a[136:139],a[48:51],v[88:91]
s_waitcnt lgkmcnt(0)
buffer_store_dwordx4 a[156:159],v9,s[16:19],s27 offen offset:128 nt
buffer_load_dwordx4 v6,s[4:7],s20 offen offset:0 lds
v_mfma_f32_16x16x32_bf16 v[96:99],a[136:139],a[72:75],0
ds_read_b128 a[156:159],v10 offset:8192
v_cvt_pk_bf16_f32 v58,v100,v101
v_mfma_f32_16x16x32_bf16 v[96:99],a[140:143],a[76:79],v[96:99]
ds_read_b128 a[136:139],v0 offset:30848
v_fma_f32 v80,v80,s36,v14
v_smfmac_f32_16x16x64_bf16 v[64:67],a[152:155],v[52:59],v18
ds_read_b128 a[140:143],v1 offset:30848
v_mfma_f32_16x16x32_bf16 v[96:99],a[144:147],a[80:83],v[96:99]
ds_read_b128 a[144:147],v0 offset:30976
v_mfma_f32_16x16x32_bf16 v[96:99],a[148:151],a[84:87],v[96:99]
ds_read_b128 a[148:151],v1 offset:30976
v_mfma_f32_16x16x32_bf16 v[96:99],a[120:123],a[88:91],v[96:99]
v_fma_f32 v81,v81,s36,v14
v_fma_f32 v72,v72,s36,v13
v_mfma_f32_16x16x32_bf16 v[96:99],a[124:127],a[92:95],v[96:99]
v_exp_f32 v80,v80
v_mfma_f32_16x16x32_bf16 v[76:79],a[128:131],a[0:3],0
buffer_load_dwordx4 v7,s[4:7],s20 offen offset:1024 lds
v_mfma_f32_16x16x32_bf16 v[76:79],a[132:135],a[4:7],v[76:79]
s_waitcnt lgkmcnt(3)
v_exp_f32 v74,v74
v_mfma_f32_16x16x32_bf16 v[76:79],a[136:139],a[8:11],v[76:79]
s_waitcnt lgkmcnt(2)
v_exp_f32 v75,v75
v_mfma_f32_16x16x32_bf16 v[76:79],a[140:143],a[12:15],v[76:79]
s_waitcnt lgkmcnt(1)
v_cvt_pk_bf16_f32 v21,v74,v75
v_mfma_f32_16x16x32_bf16 v[76:79],a[144:147],a[16:19],v[76:79]
s_waitcnt lgkmcnt(0)
v_exp_f32 v72,v72
v_mfma_f32_16x16x32_bf16 v[76:79],a[148:151],a[20:23],v[76:79]
v_exp_f32 v81,v81
v_mfma_f32_16x16x32_bf16 v[84:87],a[148:151],a[44:47],0
v_cvt_pk_bf16_f32 v24,v80,v81
v_mfma_f32_16x16x32_bf16 v[84:87],a[144:147],a[40:43],v[84:87]
v_exp_f32 v73,v73
v_mfma_f32_16x16x32_bf16 v[84:87],a[140:143],a[36:39],v[84:87]
v_cvt_pk_bf16_f32 v20,v72,v73
v_mfma_f32_16x16x32_bf16 v[84:87],a[136:139],a[32:35],v[84:87]
buffer_store_dwordx4 a[156:159],v9,s[16:19],s27 offen offset:256 nt
buffer_load_dwordx4 v8,s[4:7],s20 offen offset:2048 lds
v_mfma_f32_16x16x32_bf16 v[84:87],a[132:135],a[28:31],v[84:87]
s_add_u32 s20,s20,12288
ds_read_b64_tr_b16 a[120:121],v2 offset:12288
v_mfma_f32_16x16x32_bf16 v[84:87],a[128:131],a[24:27],v[84:87]
s_add_u32 s27,s27,3072
ds_read_b64_tr_b16 a[122:123],v2 offset:18432
v_mfma_f32_16x16x32_bf16 v[92:95],a[128:131],a[48:51],0
ds_read_b64_tr_b16 a[124:125],v3 offset:12288
v_mfma_f32_16x16x32_bf16 v[92:95],a[132:135],a[52:55],v[92:95]
ds_read_b64_tr_b16 a[126:127],v3 offset:18432
v_mfma_f32_16x16x32_bf16 v[92:95],a[136:139],a[56:59],v[92:95]
v_mfma_f32_16x16x32_bf16 v[92:95],a[140:143],a[60:63],v[92:95]
v_mfma_f32_16x16x32_bf16 v[92:95],a[144:147],a[64:67],v[92:95]
v_mfma_f32_16x16x32_bf16 v[92:95],a[148:151],a[68:71],v[92:95]
v_mfma_f32_16x16x32_bf16 v[100:103],a[148:151],a[92:95],0
v_mfma_f32_16x16x32_bf16 v[100:103],a[144:147],a[88:91],v[100:103]
v_mfma_f32_16x16x32_bf16 v[100:103],a[140:143],a[84:87],v[100:103]
v_mfma_f32_16x16x32_bf16 v[100:103],a[136:139],a[80:83],v[100:103]
v_mfma_f32_16x16x32_bf16 v[100:103],a[132:135],a[76:79],v[100:103]
ds_read_b64_tr_b16 a[134:135],v5 offset:18432
v_mfma_f32_16x16x32_bf16 v[100:103],a[128:131],a[72:75],v[100:103]
s_waitcnt lgkmcnt(1)
ds_read_b64_tr_b16 a[130:131],v4 offset:18432
ds_read_b64_tr_b16 a[128:129],v4 offset:12288
ds_read_b64_tr_b16 a[132:133],v5 offset:12288
v_mfma_f32_16x16x32_bf16 v[160:163],a[120:123],v[44:47],v[160:163]
s_add_u32 m0,s29,0
ds_read_b64_tr_b16 a[136:137],v2 offset:12416
v_fma_f32 v82,v82,s36,v14
v_mfma_f32_16x16x32_bf16 v[164:167],a[124:127],v[44:47],v[164:167]
ds_read_b64_tr_b16 a[138:139],v2 offset:18560
v_fma_f32 v83,v83,s36,v14
v_mfma_f32_16x16x32_bf16 v[212:215],a[124:127],v[48:51],v[212:215]
ds_read_b64_tr_b16 a[140:141],v3 offset:12416
v_fma_f32 v88,v88,s36,v15
v_mfma_f32_16x16x32_bf16 v[208:211],a[120:123],v[48:51],v[208:211]
ds_read_b64_tr_b16 a[142:143],v3 offset:18560
v_fma_f32 v89,v89,s36,v15
v_mfma_f32_16x16x32_bf16 v[112:115],a[120:123],v[52:55],v[112:115]
ds_read_b64_tr_b16 a[144:145],v4 offset:12416
v_fma_f32 v90,v90,s36,v15
v_mfma_f32_16x16x32_bf16 v[116:119],a[124:127],v[52:55],v[116:119]
ds_read_b64_tr_b16 a[146:147],v4 offset:18560
v_fma_f32 v91,v91,s36,v15
v_mfma_f32_16x16x32_bf16 a[164:167],a[124:127],v[56:59],a[164:167]
buffer_load_dwordx4 v6,s[12:15],s28 offen offset:0 nt lds
v_mfma_f32_16x16x32_bf16 a[160:163],a[120:123],v[56:59],a[160:163]
s_waitcnt lgkmcnt(5)
ds_read_b64_tr_b16 a[148:149],v5 offset:12416
v_fma_f32 v96,v96,s36,v16
v_mfma_f32_16x16x32_bf16 a[168:171],a[128:131],v[56:59],a[168:171]
ds_read_b64_tr_b16 a[150:151],v5 offset:18560
v_fma_f32 v97,v97,s36,v16
v_mfma_f32_16x16x32_bf16 a[172:175],a[132:135],v[56:59],a[172:175]
ds_read_b64_tr_b16 a[120:121],v2 offset:12544
v_fma_f32 v98,v98,s36,v16
v_mfma_f32_16x16x32_bf16 v[124:127],a[132:135],v[52:55],v[124:127]
ds_read_b64_tr_b16 a[122:123],v2 offset:18688
v_fma_f32 v99,v99,s36,v16
v_mfma_f32_16x16x32_bf16 v[120:123],a[128:131],v[52:55],v[120:123]
ds_read_b64_tr_b16 a[124:125],v3 offset:12544
v_fma_f32 v76,v76,s36,v13
v_mfma_f32_16x16x32_bf16 v[216:219],a[128:131],v[48:51],v[216:219]
ds_read_b64_tr_b16 a[126:127],v3 offset:18688
v_fma_f32 v77,v77,s36,v13
v_mfma_f32_16x16x32_bf16 v[220:223],a[132:135],v[48:51],v[220:223]
buffer_load_dwordx4 v7,s[12:15],s28 offen offset:1024 nt lds
v_mfma_f32_16x16x32_bf16 v[172:175],a[132:135],v[44:47],v[172:175]
ds_read_b64_tr_b16 a[132:133],v5 offset:12544
v_fma_f32 v78,v78,s36,v13
v_mfma_f32_16x16x32_bf16 v[168:171],a[128:131],v[44:47],v[168:171]
s_waitcnt lgkmcnt(5)
ds_read_b64_tr_b16 a[128:129],v4 offset:12544
v_fma_f32 v79,v79,s36,v13
v_mfma_f32_16x16x32_bf16 v[176:179],a[136:139],v[44:47],v[176:179]
ds_read_b64_tr_b16 a[130:131],v4 offset:18688
v_fma_f32 v84,v84,s36,v14
v_mfma_f32_16x16x32_bf16 v[180:183],a[140:143],v[44:47],v[180:183]
ds_read_b64_tr_b16 a[134:135],v5 offset:18688
v_fma_f32 v85,v85,s36,v14
v_mfma_f32_16x16x32_bf16 v[228:231],a[140:143],v[48:51],v[228:231]
v_exp_f32 v82,v82
v_mfma_f32_16x16x32_bf16 v[224:227],a[136:139],v[48:51],v[224:227]
v_exp_f32 v83,v83
v_mfma_f32_16x16x32_bf16 v[128:131],a[136:139],v[52:55],v[128:131]
v_cvt_pk_bf16_f32 v25,v82,v83
v_fma_f32 v86,v86,s36,v14
v_mfma_f32_16x16x32_bf16 v[132:135],a[140:143],v[52:55],v[132:135]
buffer_load_dwordx4 v8,s[12:15],s28 offen offset:2048 nt lds
v_mfma_f32_16x16x32_bf16 a[180:183],a[140:143],v[56:59],a[180:183]
s_add_u32 s28,s28,3072
v_exp_f32 v88,v88
v_mfma_f32_16x16x32_bf16 a[176:179],a[136:139],v[56:59],a[176:179]
s_add_u32 s29,s29,3072
v_exp_f32 v89,v89
v_mfma_f32_16x16x32_bf16 a[184:187],a[144:147],v[56:59],a[184:187]
s_cmp_eq_u32 s38,1
v_exp_f32 v90,v90
v_mfma_f32_16x16x32_bf16 a[188:191],a[148:151],v[56:59],a[188:191]
s_cselect_b32 s21,s26,s21
v_exp_f32 v91,v91
v_mfma_f32_16x16x32_bf16 v[140:143],a[148:151],v[52:55],v[140:143]
s_add_u32 m0,s23,12288
v_cvt_pk_bf16_f32 v28,v88,v89
v_cvt_pk_bf16_f32 v29,v90,v91
v_mfma_f32_16x16x32_bf16 v[136:139],a[144:147],v[52:55],v[136:139]
v_exp_f32 v96,v96
v_mfma_f32_16x16x32_bf16 v[232:235],a[144:147],v[48:51],v[232:235]
v_exp_f32 v97,v97
v_mfma_f32_16x16x32_bf16 v[236:239],a[148:151],v[48:51],v[236:239]
v_exp_f32 v98,v98
v_mfma_f32_16x16x32_bf16 v[188:191],a[148:151],v[44:47],v[188:191]
v_exp_f32 v99,v99
v_mfma_f32_16x16x32_bf16 v[184:187],a[144:147],v[44:47],v[184:187]
s_waitcnt lgkmcnt(0)
v_cvt_pk_bf16_f32 v32,v96,v97
v_cvt_pk_bf16_f32 v33,v98,v99
v_mfma_f32_16x16x32_bf16 v[192:195],a[120:123],v[44:47],v[192:195]
s_waitcnt vmcnt(12)
v_exp_f32 v76,v76
v_mfma_f32_16x16x32_bf16 v[196:199],a[124:127],v[44:47],v[196:199]
s_barrier
v_mfma_f32_16x16x32_bf16 v[244:247],a[124:127],v[48:51],v[244:247]
ds_read_b128 a[148:151],v1 offset:128
v_fma_f32 v87,v87,s36,v14
v_mfma_f32_16x16x32_bf16 v[240:243],a[120:123],v[48:51],v[240:243]
ds_read_b128 a[144:147],v0 offset:128
v_fma_f32 v92,v92,s36,v15
v_mfma_f32_16x16x32_bf16 v[144:147],a[120:123],v[52:55],v[144:147]
ds_read_b128 a[140:143],v1 offset:0
v_fma_f32 v93,v93,s36,v15
v_mfma_f32_16x16x32_bf16 v[148:151],a[124:127],v[52:55],v[148:151]
ds_read_b128 a[136:139],v0 offset:0
v_fma_f32 v94,v94,s36,v15
v_mfma_f32_16x16x32_bf16 a[196:199],a[124:127],v[56:59],a[196:199]
ds_read_b128 a[124:127],v1 offset:256
v_fma_f32 v95,v95,s36,v15
v_mfma_f32_16x16x32_bf16 a[192:195],a[120:123],v[56:59],a[192:195]
buffer_load_dwordx4 v6,s[8:11],s21 offen offset:0 lds
v_mfma_f32_16x16x32_bf16 a[200:203],a[128:131],v[56:59],a[200:203]
ds_read_b128 a[120:123],v0 offset:256
v_fma_f32 v100,v100,s36,v16
v_mfma_f32_16x16x32_bf16 a[204:207],a[132:135],v[56:59],a[204:207]
v_exp_f32 v77,v77
v_mfma_f32_16x16x32_bf16 v[156:159],a[132:135],v[52:55],v[156:159]
v_exp_f32 v78,v78
v_mfma_f32_16x16x32_bf16 v[152:155],a[128:131],v[52:55],v[152:155]
v_exp_f32 v79,v79
v_mfma_f32_16x16x32_bf16 v[248:251],a[128:131],v[48:51],v[248:251]
v_cvt_pk_bf16_f32 v22,v76,v77
v_cvt_pk_bf16_f32 v23,v78,v79
v_mfma_f32_16x16x32_bf16 v[252:255],a[132:135],v[48:51],v[252:255]
v_exp_f32 v84,v84
v_mfma_f32_16x16x32_bf16 v[204:207],a[132:135],v[44:47],v[204:207]
ds_read_b128 a[132:135],v1 offset:6144
v_fma_f32 v101,v101,s36,v16
v_mfma_f32_16x16x32_bf16 v[200:203],a[128:131],v[44:47],v[200:203]
s_waitcnt lgkmcnt(1)
ds_read_b128 a[128:131],v0 offset:6144
v_fma_f32 v102,v102,s36,v16
v_mfma_f32_16x16x32_bf16 v[72:75],a[124:127],a[20:23],0
buffer_load_dwordx4 v7,s[8:11],s21 offen offset:1024 lds
v_mfma_f32_16x16x32_bf16 v[72:75],a[120:123],a[16:19],v[72:75]
v_exp_f32 v85,v85
v_mfma_f32_16x16x32_bf16 v[72:75],a[148:151],a[12:15],v[72:75]
v_exp_f32 v86,v86
v_mfma_f32_16x16x32_bf16 v[72:75],a[144:147],a[8:11],v[72:75]
v_exp_f32 v87,v87
v_mfma_f32_16x16x32_bf16 v[72:75],a[140:143],a[4:7],v[72:75]
v_cvt_pk_bf16_f32 v26,v84,v85
v_cvt_pk_bf16_f32 v27,v86,v87
v_mfma_f32_16x16x32_bf16 v[72:75],a[136:139],a[0:3],v[72:75]
v_exp_f32 v92,v92
v_smfmac_f32_16x16x64_bf16 v[60:63],a[152:155],v[20:27],v18
v_fma_f32 v103,v103,s36,v16
v_mfma_f32_16x16x32_bf16 v[80:83],a[136:139],a[24:27],0
v_exp_f32 v93,v93
v_mfma_f32_16x16x32_bf16 v[80:83],a[140:143],a[28:31],v[80:83]
buffer_load_dwordx4 v8,s[8:11],s21 offen offset:2048 lds
v_mfma_f32_16x16x32_bf16 v[80:83],a[144:147],a[32:35],v[80:83]
s_add_u32 s21,s21,12288
v_exp_f32 v94,v94
v_mfma_f32_16x16x32_bf16 v[80:83],a[148:151],a[36:39],v[80:83]
s_add_u32 m0,s22,24576
v_exp_f32 v95,v95
v_mfma_f32_16x16x32_bf16 v[80:83],a[120:123],a[40:43],v[80:83]
v_cvt_pk_bf16_f32 v30,v92,v93
v_cvt_pk_bf16_f32 v31,v94,v95
v_mfma_f32_16x16x32_bf16 v[80:83],a[124:127],a[44:47],v[80:83]
v_exp_f32 v100,v100
v_mfma_f32_16x16x32_bf16 v[88:91],a[124:127],a[68:71],0
v_exp_f32 v101,v101
v_mfma_f32_16x16x32_bf16 v[88:91],a[120:123],a[64:67],v[88:91]
v_exp_f32 v102,v102
v_mfma_f32_16x16x32_bf16 v[88:91],a[148:151],a[60:63],v[88:91]
v_exp_f32 v103,v103
v_mfma_f32_16x16x32_bf16 v[88:91],a[144:147],a[56:59],v[88:91]
v_cvt_pk_bf16_f32 v34,v100,v101
v_cvt_pk_bf16_f32 v35,v102,v103
v_mfma_f32_16x16x32_bf16 v[88:91],a[140:143],a[52:55],v[88:91]
buffer_load_dwordx4 v6,s[4:7],s20 offen offset:0 lds
v_smfmac_f32_16x16x64_bf16 v[64:67],a[152:155],v[28:35],v18
v_fma_f32 v72,v72,s36,v13
v_mfma_f32_16x16x32_bf16 v[88:91],a[136:139],a[48:51],v[88:91]
v_fma_f32 v73,v73,s36,v13
v_fma_f32 v74,v74,s36,v13
v_mfma_f32_16x16x32_bf16 v[96:99],a[136:139],a[72:75],0
ds_read_b128 a[136:139],v0 offset:6272
v_fma_f32 v75,v75,s36,v13
v_mfma_f32_16x16x32_bf16 v[96:99],a[140:143],a[76:79],v[96:99]
ds_read_b128 a[140:143],v1 offset:6272
v_fma_f32 v80,v80,s36,v14
v_mfma_f32_16x16x32_bf16 v[96:99],a[144:147],a[80:83],v[96:99]
ds_read_b128 a[144:147],v0 offset:6400
v_fma_f32 v81,v81,s36,v14
v_mfma_f32_16x16x32_bf16 v[96:99],a[148:151],a[84:87],v[96:99]
ds_read_b128 a[148:151],v1 offset:6400
v_add_u32 v10,9216,v10
v_mfma_f32_16x16x32_bf16 v[96:99],a[120:123],a[88:91],v[96:99]
v_exp_f32 v72,v72
v_mfma_f32_16x16x32_bf16 v[96:99],a[124:127],a[92:95],v[96:99]
s_waitcnt lgkmcnt(4)
v_exp_f32 v73,v73
v_mfma_f32_16x16x32_bf16 v[76:79],a[128:131],a[0:3],0
buffer_load_dwordx4 v7,s[4:7],s20 offen offset:1024 lds
v_mfma_f32_16x16x32_bf16 v[76:79],a[132:135],a[4:7],v[76:79]
s_waitcnt lgkmcnt(3)
v_exp_f32 v74,v74
v_mfma_f32_16x16x32_bf16 v[76:79],a[136:139],a[8:11],v[76:79]
s_waitcnt lgkmcnt(2)
v_exp_f32 v75,v75
v_mfma_f32_16x16x32_bf16 v[76:79],a[140:143],a[12:15],v[76:79]
s_waitcnt lgkmcnt(0)
v_exp_f32 v80,v80
v_mfma_f32_16x16x32_bf16 v[76:79],a[144:147],a[16:19],v[76:79]
v_exp_f32 v81,v81
v_mfma_f32_16x16x32_bf16 v[76:79],a[148:151],a[20:23],v[76:79]
v_cvt_pk_bf16_f32 v44,v72,v73
v_cvt_pk_bf16_f32 v45,v74,v75
v_mfma_f32_16x16x32_bf16 v[84:87],a[148:151],a[44:47],0
v_cvt_pk_bf16_f32 v48,v80,v81
v_mfma_f32_16x16x32_bf16 v[84:87],a[144:147],a[40:43],v[84:87]
v_mfma_f32_16x16x32_bf16 v[84:87],a[140:143],a[36:39],v[84:87]
v_mfma_f32_16x16x32_bf16 v[84:87],a[136:139],a[32:35],v[84:87]
buffer_load_dwordx4 v8,s[4:7],s20 offen offset:2048 lds
v_mfma_f32_16x16x32_bf16 v[84:87],a[132:135],a[28:31],v[84:87]
s_add_u32 s20,s20,12288
s_add_u32 s38,s38,1
s_cmp_lt_u32 s38,2
v_mfma_f32_16x16x32_bf16 v[84:87],a[128:131],a[24:27],v[84:87]
ds_read_b64_tr_b16 a[120:121],v2 offset:24576
v_mfma_f32_16x16x32_bf16 v[92:95],a[128:131],a[48:51],0
ds_read_b64_tr_b16 a[122:123],v2 offset:30720
v_mfma_f32_16x16x32_bf16 v[92:95],a[132:135],a[52:55],v[92:95]
ds_read_b64_tr_b16 a[124:125],v3 offset:24576
v_mfma_f32_16x16x32_bf16 v[92:95],a[136:139],a[56:59],v[92:95]
ds_read_b64_tr_b16 a[126:127],v3 offset:30720
v_mfma_f32_16x16x32_bf16 v[92:95],a[140:143],a[60:63],v[92:95]
v_mfma_f32_16x16x32_bf16 v[92:95],a[144:147],a[64:67],v[92:95]
v_mfma_f32_16x16x32_bf16 v[92:95],a[148:151],a[68:71],v[92:95]
v_mfma_f32_16x16x32_bf16 v[100:103],a[148:151],a[92:95],0
v_mfma_f32_16x16x32_bf16 v[100:103],a[144:147],a[88:91],v[100:103]
v_mfma_f32_16x16x32_bf16 v[100:103],a[140:143],a[84:87],v[100:103]
v_mfma_f32_16x16x32_bf16 v[100:103],a[136:139],a[80:83],v[100:103]
v_mfma_f32_16x16x32_bf16 v[100:103],a[132:135],a[76:79],v[100:103]
ds_read_b64_tr_b16 a[132:133],v5 offset:24576
v_mfma_f32_16x16x32_bf16 v[100:103],a[128:131],a[72:75],v[100:103]
ds_read_b64_tr_b16 a[128:129],v4 offset:24576
ds_read_b64_tr_b16 a[130:131],v4 offset:30720
ds_read_b64_tr_b16 a[134:135],v5 offset:30720
s_cbranch_scc1 L_loop4w0
s_cmp_ge_u32 s69,6
s_cbranch_scc1 L_end4
s_cmp_eq_u32 s40,0
s_cbranch_scc1 L_tr44
s_branch L_tr45
L_tr45:
s_waitcnt vmcnt(42)
s_waitcnt lgkmcnt(3)
v_mfma_f32_16x16x32_bf16 v[160:163],a[120:123],v[20:23],v[160:163]
s_add_u32 m0,s24,0
ds_read_b128 a[0:3],v11 offset:0
v_fma_f32 v82,v82,s36,v14
v_mfma_f32_16x16x32_bf16 v[164:167],a[124:127],v[20:23],v[164:167]
ds_read_b128 a[4:7],v12 offset:0
v_fma_f32 v83,v83,s36,v14
v_mfma_f32_16x16x32_bf16 v[212:215],a[124:127],v[24:27],v[212:215]
ds_read_b128 a[8:11],v11 offset:128
v_fma_f32 v88,v88,s36,v15
v_mfma_f32_16x16x32_bf16 v[208:211],a[120:123],v[24:27],v[208:211]
ds_read_b128 a[12:15],v12 offset:128
v_fma_f32 v89,v89,s36,v15
v_mfma_f32_16x16x32_bf16 v[112:115],a[120:123],v[28:31],v[112:115]
ds_read_b128 a[16:19],v11 offset:256
v_fma_f32 v90,v90,s36,v15
v_mfma_f32_16x16x32_bf16 v[116:119],a[124:127],v[28:31],v[116:119]
ds_read_b128 a[20:23],v12 offset:256
v_fma_f32 v91,v91,s36,v15
ds_read_b64_tr_b16 a[136:137],v2 offset:24704
ds_read_b64_tr_b16 a[138:139],v2 offset:30848
ds_read_b64_tr_b16 a[140:141],v3 offset:24704
ds_read_b64_tr_b16 a[142:143],v3 offset:30848
ds_read_b64_tr_b16 a[144:145],v4 offset:24704
ds_read_b64_tr_b16 a[146:147],v4 offset:30848
ds_read_b64_tr_b16 a[148:149],v5 offset:24704
ds_read_b64_tr_b16 a[150:151],v5 offset:30848
ds_read_b128 a[24:27],v11 offset:6144
v_mfma_f32_16x16x32_bf16 a[164:167],a[124:127],v[32:35],a[164:167]
v_fma_f32 v96,v96,s36,v16
ds_read_b128 a[28:31],v12 offset:6144
v_mfma_f32_16x16x32_bf16 a[160:163],a[120:123],v[32:35],a[160:163]
s_waitcnt lgkmcnt(12)
v_fma_f32 v97,v97,s36,v16
ds_read_b128 a[32:35],v11 offset:6272
v_mfma_f32_16x16x32_bf16 a[168:171],a[128:131],v[32:35],a[168:171]
s_waitcnt lgkmcnt(11)
buffer_load_dwordx4 v6,s[12:15],s28 offen offset:0 nt lds
v_mfma_f32_16x16x32_bf16 a[172:175],a[132:135],v[32:35],a[172:175]
ds_read_b64_tr_b16 a[120:121],v2 offset:24832
ds_read_b128 a[36:39],v12 offset:6272
v_mfma_f32_16x16x32_bf16 v[124:127],a[132:135],v[28:31],v[124:127]
v_fma_f32 v98,v98,s36,v16
ds_read_b64_tr_b16 a[124:125],v3 offset:24832
ds_read_b64_tr_b16 a[126:127],v3 offset:30976
ds_read_b64_tr_b16 a[122:123],v2 offset:30976
ds_read_b128 a[40:43],v11 offset:6400
v_mfma_f32_16x16x32_bf16 v[120:123],a[128:131],v[28:31],v[120:123]
v_fma_f32 v99,v99,s36,v16
ds_read_b128 a[44:47],v12 offset:6400
v_mfma_f32_16x16x32_bf16 v[216:219],a[128:131],v[24:27],v[216:219]
buffer_load_dwordx4 v7,s[12:15],s28 offen offset:1024 nt lds
v_mfma_f32_16x16x32_bf16 v[220:223],a[132:135],v[24:27],v[220:223]
v_fma_f32 v76,v76,s36,v13
v_fma_f32 v77,v77,s36,v13
v_mfma_f32_16x16x32_bf16 v[172:175],a[132:135],v[20:23],v[172:175]
ds_read_b64_tr_b16 a[132:133],v5 offset:24832
v_fma_f32 v78,v78,s36,v13
v_mfma_f32_16x16x32_bf16 v[168:171],a[128:131],v[20:23],v[168:171]
s_waitcnt lgkmcnt(6)
ds_read_b64_tr_b16 a[128:129],v4 offset:24832
v_fma_f32 v79,v79,s36,v13
v_mfma_f32_16x16x32_bf16 v[176:179],a[136:139],v[20:23],v[176:179]
ds_read_b64_tr_b16 a[130:131],v4 offset:30976
v_fma_f32 v84,v84,s36,v14
v_mfma_f32_16x16x32_bf16 v[180:183],a[140:143],v[20:23],v[180:183]
ds_read_b64_tr_b16 a[134:135],v5 offset:30976
v_fma_f32 v85,v85,s36,v14
v_mfma_f32_16x16x32_bf16 v[228:231],a[140:143],v[24:27],v[228:231]
v_fma_f32 v86,v86,s36,v14
v_fma_f32 v87,v87,s36,v14
v_mfma_f32_16x16x32_bf16 v[224:227],a[136:139],v[24:27],v[224:227]
buffer_load_dwordx4 v8,s[12:15],s28 offen offset:2048 nt lds
v_mfma_f32_16x16x32_bf16 v[128:131],a[136:139],v[28:31],v[128:131]
s_add_u32 s28,s28,3072
v_fma_f32 v92,v92,s36,v15
v_fma_f32 v93,v93,s36,v15
v_mfma_f32_16x16x32_bf16 v[132:135],a[140:143],v[28:31],v[132:135]
s_add_u32 m0,s24,3072
v_fma_f32 v94,v94,s36,v15
v_fma_f32 v95,v95,s36,v15
v_mfma_f32_16x16x32_bf16 a[180:183],a[140:143],v[32:35],a[180:183]
v_fma_f32 v100,v100,s36,v16
v_fma_f32 v101,v101,s36,v16
v_mfma_f32_16x16x32_bf16 a[176:179],a[136:139],v[32:35],a[176:179]
v_fma_f32 v102,v102,s36,v16
v_fma_f32 v103,v103,s36,v16
v_mfma_f32_16x16x32_bf16 a[184:187],a[144:147],v[32:35],a[184:187]
v_exp_f32 v82,v82
v_mfma_f32_16x16x32_bf16 a[188:191],a[148:151],v[32:35],a[188:191]
v_exp_f32 v83,v83
v_mfma_f32_16x16x32_bf16 v[140:143],a[148:151],v[28:31],v[140:143]
v_exp_f32 v88,v88
v_mfma_f32_16x16x32_bf16 v[136:139],a[144:147],v[28:31],v[136:139]
buffer_load_dwordx4 v6,s[12:15],s28 offen offset:0 nt lds
v_mfma_f32_16x16x32_bf16 v[232:235],a[144:147],v[24:27],v[232:235]
v_exp_f32 v89,v89
v_mfma_f32_16x16x32_bf16 v[236:239],a[148:151],v[24:27],v[236:239]
v_exp_f32 v90,v90
v_mfma_f32_16x16x32_bf16 v[188:191],a[148:151],v[20:23],v[188:191]
v_exp_f32 v91,v91
v_mfma_f32_16x16x32_bf16 v[184:187],a[144:147],v[20:23],v[184:187]
s_waitcnt lgkmcnt(0)
v_exp_f32 v96,v96
v_mfma_f32_16x16x32_bf16 v[192:195],a[120:123],v[20:23],v[192:195]
v_exp_f32 v97,v97
v_mfma_f32_16x16x32_bf16 v[196:199],a[124:127],v[20:23],v[196:199]
v_exp_f32 v98,v98
v_mfma_f32_16x16x32_bf16 v[244:247],a[124:127],v[24:27],v[244:247]
v_exp_f32 v99,v99
v_mfma_f32_16x16x32_bf16 v[240:243],a[120:123],v[24:27],v[240:243]
buffer_load_dwordx4 v7,s[12:15],s28 offen offset:1024 nt lds
v_mfma_f32_16x16x32_bf16 v[144:147],a[120:123],v[28:31],v[144:147]
v_exp_f32 v76,v76
v_mfma_f32_16x16x32_bf16 v[148:151],a[124:127],v[28:31],v[148:151]
v_exp_f32 v77,v77
v_mfma_f32_16x16x32_bf16 a[196:199],a[124:127],v[32:35],a[196:199]
v_exp_f32 v78,v78
v_mfma_f32_16x16x32_bf16 a[192:195],a[120:123],v[32:35],a[192:195]
v_exp_f32 v79,v79
v_mfma_f32_16x16x32_bf16 a[200:203],a[128:131],v[32:35],a[200:203]
v_exp_f32 v84,v84
v_mfma_f32_16x16x32_bf16 a[204:207],a[132:135],v[32:35],a[204:207]
v_exp_f32 v85,v85
v_mfma_f32_16x16x32_bf16 v[156:159],a[132:135],v[28:31],v[156:159]
v_exp_f32 v86,v86
v_mfma_f32_16x16x32_bf16 v[152:155],a[128:131],v[28:31],v[152:155]
buffer_load_dwordx4 v8,s[12:15],s28 offen offset:2048 nt lds
s_waitcnt vmcnt(20)
s_barrier
v_mfma_f32_16x16x32_bf16 v[248:251],a[128:131],v[24:27],v[248:251]
s_add_u32 s28,s28,3072
ds_read_b64_tr_b16 a[136:137],v2 offset:0
v_exp_f32 v87,v87
v_mfma_f32_16x16x32_bf16 v[252:255],a[132:135],v[24:27],v[252:255]
s_add_u32 m0,s22,0
ds_read_b64_tr_b16 a[138:139],v2 offset:6144
buffer_load_dwordx4 v6,s[4:7],s25 offen offset:0 lds
v_mfma_f32_16x16x32_bf16 v[204:207],a[132:135],v[20:23],v[204:207]
buffer_load_dwordx4 v7,s[4:7],s25 offen offset:1024 lds
v_mfma_f32_16x16x32_bf16 v[200:203],a[128:131],v[20:23],v[200:203]
buffer_load_dwordx4 v8,s[4:7],s25 offen offset:2048 lds
ds_read_b64_tr_b16 a[140:141],v3 offset:0
ds_read_b64_tr_b16 a[142:143],v3 offset:6144
ds_read_b64_tr_b16 a[144:145],v4 offset:0
ds_read_b64_tr_b16 a[146:147],v4 offset:6144
ds_read_b64_tr_b16 a[148:149],v5 offset:0
ds_read_b64_tr_b16 a[150:151],v5 offset:6144
v_exp_f32 v92,v92
v_exp_f32 v93,v93
v_exp_f32 v94,v94
v_exp_f32 v95,v95
v_exp_f32 v100,v100
v_exp_f32 v101,v101
v_exp_f32 v102,v102
v_exp_f32 v103,v103
v_cvt_pk_bf16_f32 v49,v82,v83
v_cvt_pk_bf16_f32 v52,v88,v89
v_cvt_pk_bf16_f32 v53,v90,v91
v_cvt_pk_bf16_f32 v56,v96,v97
v_cvt_pk_bf16_f32 v57,v98,v99
v_cvt_pk_bf16_f32 v46,v76,v77
v_cvt_pk_bf16_f32 v47,v78,v79
v_cvt_pk_bf16_f32 v50,v84,v85
v_cvt_pk_bf16_f32 v51,v86,v87
v_cvt_pk_bf16_f32 v54,v92,v93
v_cvt_pk_bf16_f32 v55,v94,v95
v_smfmac_f32_16x16x64_bf16 v[60:63],a[152:155],v[44:51],v18
v_cvt_pk_bf16_f32 v58,v100,v101
v_cvt_pk_bf16_f32 v59,v102,v103
v_subrev_u32 v10,18432,v10
s_nop 0
v_smfmac_f32_16x16x64_bf16 v[64:67],a[152:155],v[52:59],v18
s_waitcnt lgkmcnt(0)
v_mfma_f32_16x16x32_bf16 v[160:163],a[136:139],v[44:47],v[160:163]
s_add_u32 s87,s42,18432
ds_read_b64_tr_b16 a[120:121],v2 offset:128
v_mbcnt_lo_u32_b32 v39,-1,0
v_mfma_f32_16x16x32_bf16 v[164:167],a[140:143],v[44:47],v[164:167]
ds_read_b64_tr_b16 a[122:123],v2 offset:6272
v_mbcnt_hi_u32_b32 v39,-1,v39
v_mfma_f32_16x16x32_bf16 v[212:215],a[140:143],v[48:51],v[212:215]
ds_read_b64_tr_b16 a[124:125],v3 offset:128
v_and_b32 v38,7,v39
v_mfma_f32_16x16x32_bf16 v[208:211],a[136:139],v[48:51],v[208:211]
ds_read_b64_tr_b16 a[126:127],v3 offset:6272
v_add_f32 v60,v60,v61
v_mfma_f32_16x16x32_bf16 v[112:115],a[136:139],v[52:55],v[112:115]
ds_read_b64_tr_b16 a[128:129],v4 offset:128
v_add_f32 v62,v62,v63
v_mfma_f32_16x16x32_bf16 v[116:119],a[140:143],v[52:55],v[116:119]
ds_read_b64_tr_b16 a[130:131],v4 offset:6272
ds_read_b64_tr_b16 a[132:133],v5 offset:128
ds_read_b64_tr_b16 a[134:135],v5 offset:6272
v_mfma_f32_16x16x32_bf16 a[164:167],a[140:143],v[56:59],a[164:167]
ds_read_b64_tr_b16 a[140:141],v3 offset:256
v_add_f32 v64,v64,v65
v_mfma_f32_16x16x32_bf16 a[160:163],a[136:139],v[56:59],a[160:163]
ds_read_b64_tr_b16 a[136:137],v2 offset:256
v_add_f32 v66,v66,v67
v_mfma_f32_16x16x32_bf16 a[168:171],a[144:147],v[56:59],a[168:171]
ds_read_b64_tr_b16 a[138:139],v2 offset:6400
v_max3_f32 v19,v60,v62,v64
v_mfma_f32_16x16x32_bf16 a[172:175],a[148:151],v[56:59],a[172:175]
ds_read_b64_tr_b16 a[142:143],v3 offset:6400
v_max_f32 v19,v19,v66
v_mfma_f32_16x16x32_bf16 v[124:127],a[148:151],v[52:55],v[124:127]
v_rcp_f32 v66,v66
v_mfma_f32_16x16x32_bf16 v[120:123],a[144:147],v[52:55],v[120:123]
v_accvgpr_read_b32 v80,a164
v_accvgpr_read_b32 v81,a165
v_mfma_f32_16x16x32_bf16 v[216:219],a[144:147],v[48:51],v[216:219]
v_accvgpr_read_b32 v82,a166
v_accvgpr_read_b32 v83,a167
v_mfma_f32_16x16x32_bf16 v[220:223],a[148:151],v[48:51],v[220:223]
v_accvgpr_read_b32 v72,a160
v_accvgpr_read_b32 v73,a161
v_mfma_f32_16x16x32_bf16 v[172:175],a[148:151],v[44:47],v[172:175]
ds_read_b64_tr_b16 a[148:149],v5 offset:256
v_accvgpr_read_b32 v74,a162
v_mfma_f32_16x16x32_bf16 v[168:171],a[144:147],v[44:47],v[168:171]
s_waitcnt lgkmcnt(2)
ds_read_b64_tr_b16 a[144:145],v4 offset:256
v_accvgpr_read_b32 v75,a163
v_mfma_f32_16x16x32_bf16 v[176:179],a[120:123],v[44:47],v[176:179]
ds_read_b64_tr_b16 a[146:147],v4 offset:6400
v_accvgpr_read_b32 v88,a168
v_mfma_f32_16x16x32_bf16 v[180:183],a[124:127],v[44:47],v[180:183]
ds_read_b64_tr_b16 a[150:151],v5 offset:6400
v_accvgpr_read_b32 v89,a169
v_mfma_f32_16x16x32_bf16 v[228:231],a[124:127],v[48:51],v[228:231]
v_accvgpr_read_b32 v90,a170
v_accvgpr_read_b32 v91,a171
v_mfma_f32_16x16x32_bf16 v[224:227],a[120:123],v[48:51],v[224:227]
v_accvgpr_read_b32 v96,a172
v_accvgpr_read_b32 v97,a173
v_mfma_f32_16x16x32_bf16 v[128:131],a[120:123],v[52:55],v[128:131]
v_accvgpr_read_b32 v98,a174
v_accvgpr_read_b32 v99,a175
v_mfma_f32_16x16x32_bf16 v[132:135],a[124:127],v[52:55],v[132:135]
v_cmp_ngt_f32 vcc,s37,v19
v_lshrrev_b32 v19,5,v39
v_mfma_f32_16x16x32_bf16 a[180:183],a[124:127],v[56:59],a[180:183]
v_xor_b32 v38,v38,v19
v_and_b32 v19,15,v39
v_mfma_f32_16x16x32_bf16 a[176:179],a[120:123],v[56:59],a[176:179]
s_cmp_lg_u64 vcc,0
v_lshl_add_u32 v19,v19,7,s24
v_lshl_add_u32 v19,v38,4,v19
v_mfma_f32_16x16x32_bf16 a[184:187],a[128:131],v[56:59],a[184:187]
s_cselect_b32 s62,s32,0
v_bfe_u32 v38,v39,4,1
v_lshl_add_u32 v36,v38,3,v19
v_mfma_f32_16x16x32_bf16 a[188:191],a[132:135],v[56:59],a[188:191]
s_or_b32 s31,s31,s62
v_xor_b32 v37,32,v36
v_bfe_u32 v19,v39,3,1
v_mfma_f32_16x16x32_bf16 v[140:143],a[132:135],v[52:55],v[140:143]
s_lshl_b32 s32,s32,1
v_xor_b32 v38,64,v36
v_xor_b32 v39,96,v36
v_lshlrev_b32 v19,11,v19
v_accvgpr_read_b32 v84,a180
v_accvgpr_read_b32 v85,a181
v_pk_mul_f32 v[72:73],v[72:73],v[66:67] op_sel_hi:[1,0]
v_pk_mul_f32 v[74:75],v[74:75],v[66:67] op_sel_hi:[1,0]
v_pk_mul_f32 v[80:81],v[80:81],v[66:67] op_sel_hi:[1,0]
v_pk_mul_f32 v[82:83],v[82:83],v[66:67] op_sel_hi:[1,0]
v_pk_mul_f32 v[84:85],v[84:85],v[66:67] op_sel_hi:[1,0]
v_accvgpr_read_b32 v86,a182
v_accvgpr_read_b32 v87,a183
v_pk_mul_f32 v[86:87],v[86:87],v[66:67] op_sel_hi:[1,0]
v_accvgpr_read_b32 v76,a176
v_accvgpr_read_b32 v77,a177
v_pk_mul_f32 v[76:77],v[76:77],v[66:67] op_sel_hi:[1,0]
v_accvgpr_read_b32 v78,a178
v_accvgpr_read_b32 v79,a179
v_pk_mul_f32 v[78:79],v[78:79],v[66:67] op_sel_hi:[1,0]
v_accvgpr_read_b32 v92,a184
v_accvgpr_read_b32 v93,a185
v_mfma_f32_16x16x32_bf16 v[136:139],a[128:131],v[52:55],v[136:139]
s_add_u32 m0,s24,6144
v_accvgpr_read_b32 v94,a186
buffer_load_dwordx4 v6,s[12:15],s28 offen offset:0 nt lds
buffer_load_dwordx4 v7,s[12:15],s28 offen offset:1024 nt lds
buffer_load_dwordx4 v8,s[12:15],s28 offen offset:2048 nt lds
v_pk_mul_f32 v[88:89],v[88:89],v[66:67] op_sel_hi:[1,0]
v_pk_mul_f32 v[90:91],v[90:91],v[66:67] op_sel_hi:[1,0]
v_pk_mul_f32 v[92:93],v[92:93],v[66:67] op_sel_hi:[1,0]
v_accvgpr_read_b32 v95,a187
v_pk_mul_f32 v[94:95],v[94:95],v[66:67] op_sel_hi:[1,0]
v_accvgpr_read_b32 v100,a188
v_accvgpr_read_b32 v101,a189
v_mfma_f32_16x16x32_bf16 v[232:235],a[128:131],v[48:51],v[232:235]
s_add_u32 s28,s28,3072
v_accvgpr_read_b32 v102,a190
v_accvgpr_read_b32 v103,a191
v_cvt_pk_bf16_f32 v72,v72,v73
v_cvt_pk_bf16_f32 v76,v76,v77
v_cvt_pk_bf16_f32 v80,v80,v81
v_pk_mul_f32 v[96:97],v[96:97],v[66:67] op_sel_hi:[1,0]
v_pk_mul_f32 v[98:99],v[98:99],v[66:67] op_sel_hi:[1,0]
v_pk_mul_f32 v[100:101],v[100:101],v[66:67] op_sel_hi:[1,0]
v_pk_mul_f32 v[102:103],v[102:103],v[66:67] op_sel_hi:[1,0]
v_cvt_pk_bf16_f32 v84,v84,v85
v_cvt_pk_bf16_f32 v73,v74,v75
v_mfma_f32_16x16x32_bf16 v[236:239],a[132:135],v[48:51],v[236:239]
s_add_u32 m0,s24,9216
v_cvt_pk_bf16_f32 v77,v78,v79
v_cvt_pk_bf16_f32 v88,v88,v89
v_mfma_f32_16x16x32_bf16 v[188:191],a[132:135],v[44:47],v[188:191]
buffer_load_dwordx4 v6,s[12:15],s28 offen offset:0 nt lds
v_mfma_f32_16x16x32_bf16 v[184:187],a[128:131],v[44:47],v[184:187]
buffer_load_dwordx4 v7,s[12:15],s28 offen offset:1024 nt lds
v_mfma_f32_16x16x32_bf16 v[192:195],a[136:139],v[44:47],v[192:195]
buffer_load_dwordx4 v8,s[12:15],s28 offen offset:2048 nt lds
s_waitcnt lgkmcnt(0)
v_mfma_f32_16x16x32_bf16 v[196:199],a[140:143],v[44:47],v[196:199]
s_add_u32 s28,s28,3072
ds_write2st64_b64 v36,v[72:73],v[76:77] offset0:36 offset1:40
v_mfma_f32_16x16x32_bf16 v[244:247],a[140:143],v[48:51],v[244:247]
s_add_u32 m0,s23,0
v_cvt_pk_bf16_f32 v92,v92,v93
v_cvt_pk_bf16_f32 v81,v82,v83
v_mfma_f32_16x16x32_bf16 v[240:243],a[136:139],v[48:51],v[240:243]
v_cvt_pk_bf16_f32 v85,v86,v87
v_cvt_pk_bf16_f32 v96,v96,v97
v_mfma_f32_16x16x32_bf16 v[144:147],a[136:139],v[52:55],v[144:147]
v_cvt_pk_bf16_f32 v100,v100,v101
v_cvt_pk_bf16_f32 v89,v90,v91
v_mfma_f32_16x16x32_bf16 v[148:151],a[140:143],v[52:55],v[148:151]
ds_write2st64_b64 v37,v[80:81],v[84:85] offset0:36 offset1:40
v_mfma_f32_16x16x32_bf16 a[196:199],a[140:143],v[56:59],a[196:199]
v_cvt_pk_bf16_f32 v93,v94,v95
v_cvt_pk_bf16_f32 v97,v98,v99
v_mfma_f32_16x16x32_bf16 a[192:195],a[136:139],v[56:59],a[192:195]
v_cvt_pk_bf16_f32 v101,v102,v103
v_rcp_f32 v64,v64
v_mfma_f32_16x16x32_bf16 a[200:203],a[144:147],v[56:59],a[200:203]
v_rcp_f32 v60,v60
v_mfma_f32_16x16x32_bf16 a[204:207],a[148:151],v[56:59],a[204:207]
ds_write2st64_b64 v38,v[88:89],v[92:93] offset0:36 offset1:40
v_mfma_f32_16x16x32_bf16 v[156:159],a[148:151],v[52:55],v[156:159]
s_waitcnt vmcnt(21)
v_accvgpr_read_b32 v84,a196
ds_read_b128 a[48:51],v11 offset:12288
v_accvgpr_read_b32 v85,a197
ds_read_b128 a[52:55],v12 offset:12288
v_pk_mul_f32 v[84:85],v[84:85],v[66:67] op_sel_hi:[1,0]
ds_read_b128 a[56:59],v11 offset:12416
v_accvgpr_read_b32 v86,a198
ds_read_b128 a[60:63],v12 offset:12416
v_accvgpr_read_b32 v87,a199
ds_read_b128 a[64:67],v11 offset:12544
v_pk_mul_f32 v[86:87],v[86:87],v[66:67] op_sel_hi:[1,0]
ds_read_b128 a[68:71],v12 offset:12544
v_accvgpr_read_b32 v80,a192
ds_write2st64_b64 v39,v[96:97],v[100:101] offset0:36 offset1:40
v_accvgpr_read_b32 v81,a193
v_pk_mul_f32 v[80:81],v[80:81],v[66:67] op_sel_hi:[1,0]
v_accvgpr_read_b32 v82,a194
ds_read_b128 v[104:107],v10 offset:18432
v_accvgpr_read_b32 v83,a195
ds_read_b128 v[108:111],v10 offset:19456
v_pk_mul_f32 v[82:83],v[82:83],v[66:67] op_sel_hi:[1,0]
v_accvgpr_read_b32 v90,a202
v_accvgpr_read_b32 v91,a203
v_mfma_f32_16x16x32_bf16 v[152:155],a[144:147],v[52:55],v[152:155]
ds_read_b128 v[72:75],v10 offset:20480
v_accvgpr_read_b32 v88,a200
ds_read_b128 v[76:79],v10 offset:21504
v_pk_mul_f32 v[90:91],v[90:91],v[66:67] op_sel_hi:[1,0]
v_accvgpr_read_b32 v89,a201
v_pk_mul_f32 v[88:89],v[88:89],v[66:67] op_sel_hi:[1,0]
v_accvgpr_read_b32 v94,a206
v_accvgpr_read_b32 v95,a207
v_mfma_f32_16x16x32_bf16 v[248:251],a[144:147],v[48:51],v[248:251]
v_accvgpr_read_b32 v92,a204
v_accvgpr_read_b32 v93,a205
v_cvt_pk_bf16_f32 v80,v80,v81
v_cvt_pk_bf16_f32 v81,v82,v83
ds_write_b64 v36,v[80:81] offset:18432
s_waitcnt lgkmcnt(4)
buffer_store_dwordx4 v[104:107],v9,s[16:19],s87 offen offset:0 nt
v_pk_mul_f32 v[94:95],v[94:95],v[66:67] op_sel_hi:[1,0]
v_pk_mul_f32 v[112:113],v[112:113],v[64:65] op_sel_hi:[1,0]
v_pk_mul_f32 v[114:115],v[114:115],v[64:65] op_sel_hi:[1,0]
v_pk_mul_f32 v[128:129],v[128:129],v[64:65] op_sel_hi:[1,0]
v_pk_mul_f32 v[130:131],v[130:131],v[64:65] op_sel_hi:[1,0]
v_pk_mul_f32 v[116:117],v[116:117],v[64:65] op_sel_hi:[1,0]
v_pk_mul_f32 v[118:119],v[118:119],v[64:65] op_sel_hi:[1,0]
v_pk_mul_f32 v[132:133],v[132:133],v[64:65] op_sel_hi:[1,0]
v_pk_mul_f32 v[134:135],v[134:135],v[64:65] op_sel_hi:[1,0]
v_pk_mul_f32 v[120:121],v[120:121],v[64:65] op_sel_hi:[1,0]
v_pk_mul_f32 v[122:123],v[122:123],v[64:65] op_sel_hi:[1,0]
s_waitcnt lgkmcnt(1)
buffer_store_dwordx4 v[108:111],v9,s[16:19],s87 offen offset:3072 nt
v_pk_mul_f32 v[136:137],v[136:137],v[64:65] op_sel_hi:[1,0]
v_pk_mul_f32 v[138:139],v[138:139],v[64:65] op_sel_hi:[1,0]
v_pk_mul_f32 v[92:93],v[92:93],v[66:67] op_sel_hi:[1,0]
v_add_u32 v36,v36,v19
v_cvt_pk_bf16_f32 v84,v84,v85
v_mfma_f32_16x16x32_bf16 v[252:255],a[148:151],v[48:51],v[252:255]
v_cvt_pk_bf16_f32 v88,v88,v89
v_cvt_pk_bf16_f32 v85,v86,v87
v_mfma_f32_16x16x32_bf16 v[204:207],a[148:151],v[44:47],v[204:207]
ds_write_b64 v37,v[84:85] offset:18432
v_mfma_f32_16x16x32_bf16 v[200:203],a[144:147],v[44:47],v[200:203]
buffer_store_dwordx4 v[72:75],v9,s[16:19],s87 offen offset:128 nt
v_add_u32 v37,v37,v19
v_cvt_pk_bf16_f32 v89,v90,v91
v_cvt_pk_bf16_f32 v92,v92,v93
v_cvt_pk_bf16_f32 v93,v94,v95
v_rcp_f32 v62,v62
v_cvt_pk_bf16_f32 v112,v112,v113
v_cvt_pk_bf16_f32 v128,v128,v129
v_cvt_pk_bf16_f32 v116,v116,v117
ds_write_b64 v38,v[88:89] offset:18432
buffer_store_dwordx4 v[76:79],v9,s[16:19],s87 offen offset:3200 nt
v_add_u32 v38,v38,v19
v_cvt_pk_bf16_f32 v132,v132,v133
v_cvt_pk_bf16_f32 v113,v114,v115
v_cvt_pk_bf16_f32 v129,v130,v131
v_cvt_pk_bf16_f32 v120,v120,v121
v_cvt_pk_bf16_f32 v136,v136,v137
v_cvt_pk_bf16_f32 v117,v118,v119
v_cvt_pk_bf16_f32 v133,v134,v135
v_cvt_pk_bf16_f32 v121,v122,v123
ds_write_b64 v39,v[92:93] offset:18432
ds_read_b128 v[96:99],v10 offset:18432
v_add_u32 v39,v39,v19
ds_read_b128 v[100:103],v10 offset:19456
s_waitcnt vmcnt(10)
s_barrier
ds_write2st64_b64 v36,v[112:113],v[128:129] offset0:24 offset1:26
v_cvt_pk_bf16_f32 v137,v138,v139
v_mov_b32 v66,0
v_mov_b32 v67,0
ds_read_b128 a[120:123],v0 offset:0
v_mov_b32 v68,0
ds_read_b128 a[124:127],v1 offset:0
v_mov_b32 v69,0
ds_write2st64_b64 v37,v[116:117],v[132:133] offset0:24 offset1:26
v_mov_b32 v70,0
v_mov_b32 v71,0
buffer_load_dwordx4 v6,s[8:11],s25 offen offset:0 lds
ds_read_b128 a[128:131],v0 offset:128
s_waitcnt lgkmcnt(4)
buffer_store_dwordx4 v[96:99],v9,s[16:19],s87 offen offset:256 nt
ds_read_b128 a[132:135],v1 offset:128
ds_read_b128 a[136:139],v0 offset:256
s_waitcnt lgkmcnt(5)
v_mfma_f32_16x16x32_bf16 v[72:75],a[120:123],a[0:3],0
ds_read_b128 a[140:143],v1 offset:256
ds_write2st64_b64 v38,v[120:121],v[136:137] offset0:24 offset1:26
v_pk_mul_f32 v[124:125],v[124:125],v[64:65] op_sel_hi:[1,0]
v_pk_mul_f32 v[126:127],v[126:127],v[64:65] op_sel_hi:[1,0]
v_pk_mul_f32 v[140:141],v[140:141],v[64:65] op_sel_hi:[1,0]
buffer_load_dwordx4 v7,s[8:11],s25 offen offset:1024 lds
ds_read_b128 a[144:147],v0 offset:6144
buffer_store_dwordx4 v[100:103],v9,s[16:19],s87 offen offset:3328 nt
ds_read_b128 a[148:151],v1 offset:6144
v_pk_mul_f32 v[142:143],v[142:143],v[64:65] op_sel_hi:[1,0]
v_cvt_pk_bf16_f32 v124,v124,v125
v_cvt_pk_bf16_f32 v140,v140,v141
s_waitcnt lgkmcnt(4)
v_mfma_f32_16x16x32_bf16 v[72:75],a[124:127],a[4:7],v[72:75]
v_cvt_pk_bf16_f32 v125,v126,v127
v_cvt_pk_bf16_f32 v141,v142,v143
v_mfma_f32_16x16x32_bf16 v[72:75],a[128:131],a[8:11],v[72:75]
ds_write2st64_b64 v39,v[124:125],v[140:141] offset0:24 offset1:26
v_mfma_f32_16x16x32_bf16 v[72:75],a[132:135],a[12:15],v[72:75]
v_pk_mul_f32 v[144:145],v[144:145],v[64:65] op_sel_hi:[1,0]
buffer_load_dwordx4 v8,s[8:11],s25 offen offset:2048 lds
v_pk_mul_f32 v[146:147],v[146:147],v[64:65] op_sel_hi:[1,0]
v_pk_mul_f32 v[160:161],v[160:161],v[60:61] op_sel_hi:[1,0]
v_pk_mul_f32 v[162:163],v[162:163],v[60:61] op_sel_hi:[1,0]
v_cvt_pk_bf16_f32 v144,v144,v145
v_cvt_pk_bf16_f32 v160,v160,v161
v_mfma_f32_16x16x32_bf16 v[72:75],a[136:139],a[16:19],v[72:75]
s_waitcnt vmcnt(18)
ds_read_b128 a[92:95],v12 offset:256
v_cvt_pk_bf16_f32 v145,v146,v147
s_waitcnt lgkmcnt(2)
v_mfma_f32_16x16x32_bf16 v[72:75],a[140:143],a[20:23],v[72:75]
s_mov_b32 s27,s42
ds_read_b128 a[88:91],v11 offset:256
v_cvt_pk_bf16_f32 v161,v162,v163
v_mfma_f32_16x16x32_bf16 v[80:83],a[140:143],a[44:47],0
s_mov_b32 s42,s41
ds_read_b128 a[84:87],v12 offset:128
s_add_u32 s69,s69,1
v_mfma_f32_16x16x32_bf16 v[80:83],a[136:139],a[40:43],v[80:83]
s_lshl_b32 s62,s69,5
ds_read_b128 a[80:83],v11 offset:128
v_max3_f32 v44,v72,v73,v74
ds_read_b128 a[76:79],v12 offset:0
v_pk_mul_f32 v[148:149],v[148:149],v[64:65] op_sel_hi:[1,0]
ds_read_b128 a[72:75],v11 offset:0
v_pk_mul_f32 v[150:151],v[150:151],v[64:65] op_sel_hi:[1,0]
ds_write2st64_b64 v36,v[144:145],v[160:161] offset0:28 offset1:0
v_pk_mul_f32 v[164:165],v[164:165],v[60:61] op_sel_hi:[1,0]
v_pk_mul_f32 v[166:167],v[166:167],v[60:61] op_sel_hi:[1,0]
v_cvt_pk_bf16_f32 v148,v148,v149
v_cvt_pk_bf16_f32 v164,v164,v165
v_mfma_f32_16x16x32_bf16 v[80:83],a[132:135],a[36:39],v[80:83]
s_add_u32 s62,s62,s34
v_cvt_pk_bf16_f32 v149,v150,v151
v_cvt_pk_bf16_f32 v165,v166,v167
v_mfma_f32_16x16x32_bf16 v[80:83],a[128:131],a[32:35],v[80:83]
s_mul_i32 s63,s62,171
s_lshr_b32 s63,s63,9
s_mul_i32 s64,s63,3
v_mfma_f32_16x16x32_bf16 v[80:83],a[124:127],a[28:31],v[80:83]
s_sub_u32 s62,s62,s64
ds_write2st64_b64 v37,v[148:149],v[164:165] offset0:28 offset1:0
v_mfma_f32_16x16x32_bf16 v[80:83],a[120:123],a[24:27],v[80:83]
s_add_u32 s63,s63,s33
s_mul_i32 s30,s63,196608
s_mul_i32 s41,s63,325632
s_lshl_b32 s63,s3,2
s_add_u32 s64,s63,21
s_cmp_eq_u32 s3,0
v_pk_mul_f32 v[152:153],v[152:153],v[64:65] op_sel_hi:[1,0]
v_pk_mul_f32 v[154:155],v[154:155],v[64:65] op_sel_hi:[1,0]
v_pk_mul_f32 v[168:169],v[168:169],v[60:61] op_sel_hi:[1,0]
v_pk_mul_f32 v[170:171],v[170:171],v[60:61] op_sel_hi:[1,0]
v_max3_f32 v48,v80,v81,v82
v_cvt_pk_bf16_f32 v152,v152,v153
v_mfma_f32_16x16x32_bf16 v[88:91],a[120:123],a[48:51],0
s_cselect_b32 s64,20,s64
ds_read_b128 a[120:123],v0 offset:6272
v_cvt_pk_bf16_f32 v168,v168,v169
v_mfma_f32_16x16x32_bf16 v[88:91],a[124:127],a[52:55],v[88:91]
s_cselect_b32 s40,1,0
ds_read_b128 a[124:127],v1 offset:6272
v_cvt_pk_bf16_f32 v153,v154,v155
v_mfma_f32_16x16x32_bf16 v[88:91],a[128:131],a[56:59],v[88:91]
s_add_u32 s65,s63,37
ds_read_b128 a[128:131],v0 offset:6400
v_cvt_pk_bf16_f32 v169,v170,v171
v_mfma_f32_16x16x32_bf16 v[88:91],a[132:135],a[60:63],v[88:91]
s_cmp_eq_u32 s62,2
ds_write2st64_b64 v38,v[152:153],v[168:169] offset0:28 offset1:0
v_pk_mul_f32 v[156:157],v[156:157],v[64:65] op_sel_hi:[1,0]
v_pk_mul_f32 v[158:159],v[158:159],v[64:65] op_sel_hi:[1,0]
v_pk_mul_f32 v[172:173],v[172:173],v[60:61] op_sel_hi:[1,0]
ds_read_b128 a[132:135],v1 offset:6400
v_pk_mul_f32 v[174:175],v[174:175],v[60:61] op_sel_hi:[1,0]
v_cvt_pk_bf16_f32 v156,v156,v157
v_cvt_pk_bf16_f32 v172,v172,v173
v_mfma_f32_16x16x32_bf16 v[88:91],a[136:139],a[64:67],v[88:91]
s_cselect_b32 s64,s65,s64
ds_read_b128 a[136:139],v0 offset:0
v_cvt_pk_bf16_f32 v157,v158,v159
v_mfma_f32_16x16x32_bf16 v[88:91],a[140:143],a[68:71],v[88:91]
s_cselect_b32 s40,0,s40
ds_read_b128 a[140:143],v1 offset:0
v_cvt_pk_bf16_f32 v173,v174,v175
v_mfma_f32_16x16x32_bf16 v[76:79],a[144:147],a[0:3],0
s_waitcnt vmcnt(9)
ds_read_b128 a[96:99],v11 offset:6144
v_mov_b32 v64,0
ds_read_b128 a[100:103],v12 offset:6144
v_pk_mul_f32 v[176:177],v[176:177],v[60:61] op_sel_hi:[1,0]
ds_read_b128 a[104:107],v11 offset:6272
v_pk_mul_f32 v[178:179],v[178:179],v[60:61] op_sel_hi:[1,0]
ds_read_b128 a[108:111],v12 offset:6272
v_pk_mul_f32 v[192:193],v[192:193],v[60:61] op_sel_hi:[1,0]
ds_read_b128 a[112:115],v11 offset:6400
v_pk_mul_f32 v[194:195],v[194:195],v[60:61] op_sel_hi:[1,0]
ds_write2st64_b64 v39,v[156:157],v[172:173] offset0:28 offset1:0
v_max3_f32 v52,v88,v89,v90
v_mfma_f32_16x16x32_bf16 v[76:79],a[148:151],a[4:7],v[76:79]
s_add_u32 s65,s63,s3
ds_read_b128 a[116:119],v12 offset:6400
s_waitcnt lgkmcnt(6)
v_mfma_f32_16x16x32_bf16 v[76:79],a[120:123],a[8:11],v[76:79]
s_cmp_eq_u32 s62,0
v_cvt_pk_bf16_f32 v176,v176,v177
v_cvt_pk_bf16_f32 v192,v192,v193
v_mfma_f32_16x16x32_bf16 v[76:79],a[124:127],a[12:15],v[76:79]
s_cselect_b32 s64,s65,s64
v_cvt_pk_bf16_f32 v177,v178,v179
v_cvt_pk_bf16_f32 v193,v194,v195
v_mfma_f32_16x16x32_bf16 v[76:79],a[128:131],a[16:19],v[76:79]
s_cselect_b32 s40,1,s40
ds_write2st64_b64 v36,v[176:177],v[192:193] offset0:2 offset1:4
v_pk_mul_f32 v[180:181],v[180:181],v[60:61] op_sel_hi:[1,0]
v_pk_mul_f32 v[182:183],v[182:183],v[60:61] op_sel_hi:[1,0]
v_pk_mul_f32 v[196:197],v[196:197],v[60:61] op_sel_hi:[1,0]
v_pk_mul_f32 v[198:199],v[198:199],v[60:61] op_sel_hi:[1,0]
v_cvt_pk_bf16_f32 v180,v180,v181
v_cvt_pk_bf16_f32 v196,v196,v197
v_mfma_f32_16x16x32_bf16 v[76:79],a[132:135],a[20:23],v[76:79]
s_mul_i32 s64,s64,6144
v_cvt_pk_bf16_f32 v181,v182,v183
v_cvt_pk_bf16_f32 v197,v198,v199
v_mfma_f32_16x16x32_bf16 v[84:87],a[132:135],a[44:47],0
s_add_u32 s41,s41,s64
v_mov_b32 v65,0
s_cmp_ge_u32 s69,6
v_mfma_f32_16x16x32_bf16 v[84:87],a[128:131],a[40:43],v[84:87]
s_cselect_b32 s41,166723584,s41
ds_write2st64_b64 v37,v[180:181],v[196:197] offset0:2 offset1:4
v_mfma_f32_16x16x32_bf16 v[84:87],a[124:127],a[36:39],v[84:87]
s_cselect_b32 s30,100663296,s30
v_max3_f32 v44,v44,v75,v76
v_max3_f32 v44,v44,v77,v78
v_max_f32 v44,v44,v79
v_mov_b32 v45,v44
s_add_u32 s25,s30,s22
v_pk_mul_f32 v[184:185],v[184:185],v[60:61] op_sel_hi:[1,0]
v_pk_mul_f32 v[186:187],v[186:187],v[60:61] op_sel_hi:[1,0]
v_pk_mul_f32 v[200:201],v[200:201],v[60:61] op_sel_hi:[1,0]
v_pk_mul_f32 v[202:203],v[202:203],v[60:61] op_sel_hi:[1,0]
v_permlane32_swap_b32 v45,v44
v_max_f32 v44,v44,v45
v_mfma_f32_16x16x32_bf16 v[84:87],a[120:123],a[32:35],v[84:87]
s_add_u32 s26,s25,12288
v_mov_b32 v45,v44
v_cvt_pk_bf16_f32 v184,v184,v185
v_mfma_f32_16x16x32_bf16 v[84:87],a[148:151],a[28:31],v[84:87]
s_add_u32 m0,s23,24576
v_permlane16_swap_b32 v45,v44
v_mfma_f32_16x16x32_bf16 v[84:87],a[144:147],a[24:27],v[84:87]
s_mov_b32 s28,s41
v_max_f32 v44,v44,v45
v_mul_f32_e64 v13,-s36,v44
v_fma_f32 v72,v72,s36,v13
v_fma_f32 v73,v73,s36,v13
v_fma_f32 v74,v74,s36,v13
v_pk_mul_f32 v[188:189],v[188:189],v[60:61] op_sel_hi:[1,0]
v_pk_mul_f32 v[190:191],v[190:191],v[60:61] op_sel_hi:[1,0]
v_pk_mul_f32 v[204:205],v[204:205],v[60:61] op_sel_hi:[1,0]
v_pk_mul_f32 v[206:207],v[206:207],v[60:61] op_sel_hi:[1,0]
v_fma_f32 v75,v75,s36,v13
v_exp_f32 v72,v72
v_mfma_f32_16x16x32_bf16 v[92:95],a[144:147],a[48:51],0
s_mov_b32 s29,s24
ds_read_b128 a[144:147],v0 offset:128
buffer_load_dwordx4 v6,s[8:11],s21 offen offset:0 lds
v_mfma_f32_16x16x32_bf16 v[92:95],a[148:151],a[52:55],v[92:95]
ds_read_b128 a[148:151],v1 offset:128
v_exp_f32 v73,v73
v_mfma_f32_16x16x32_bf16 v[92:95],a[120:123],a[56:59],v[92:95]
ds_read_b128 a[120:123],v0 offset:256
v_exp_f32 v74,v74
v_mfma_f32_16x16x32_bf16 v[92:95],a[124:127],a[60:63],v[92:95]
ds_read_b128 a[124:127],v1 offset:256
v_exp_f32 v75,v75
v_cvt_pk_bf16_f32 v20,v72,v73
v_cvt_pk_bf16_f32 v21,v74,v75
v_pk_mul_f32 v[208:209],v[208:209],v[62:63] op_sel_hi:[1,0]
v_pk_mul_f32 v[210:211],v[210:211],v[62:63] op_sel_hi:[1,0]
v_pk_mul_f32 v[224:225],v[224:225],v[62:63] op_sel_hi:[1,0]
v_pk_mul_f32 v[226:227],v[226:227],v[62:63] op_sel_hi:[1,0]
v_max3_f32 v48,v48,v83,v84
v_max3_f32 v48,v48,v85,v86
v_mfma_f32_16x16x32_bf16 v[92:95],a[128:131],a[64:67],v[92:95]
ds_read_b128 a[128:131],v0 offset:6144
v_max_f32 v48,v48,v87
v_mfma_f32_16x16x32_bf16 v[92:95],a[132:135],a[68:71],v[92:95]
ds_read_b128 a[132:135],v1 offset:6144
buffer_load_dwordx4 v7,s[8:11],s21 offen offset:1024 lds
v_mov_b32 v49,v48
v_cvt_pk_bf16_f32 v200,v200,v201
v_cvt_pk_bf16_f32 v185,v186,v187
v_permlane32_swap_b32 v49,v48
v_max_f32 v48,v48,v49
v_mov_b32 v49,v48
v_max3_f32 v52,v52,v91,v92
v_max3_f32 v52,v52,v93,v94
s_waitcnt lgkmcnt(2)
v_mfma_f32_16x16x32_bf16 v[96:99],a[124:127],a[92:95],0
v_permlane16_swap_b32 v49,v48
v_mfma_f32_16x16x32_bf16 v[96:99],a[120:123],a[88:91],v[96:99]
v_max_f32 v48,v48,v49
v_mul_f32_e64 v14,-s36,v48
v_fma_f32 v80,v80,s36,v14
v_fma_f32 v81,v81,s36,v14
v_fma_f32 v82,v82,s36,v14
v_pk_mul_f32 v[212:213],v[212:213],v[62:63] op_sel_hi:[1,0]
v_pk_mul_f32 v[214:215],v[214:215],v[62:63] op_sel_hi:[1,0]
v_pk_mul_f32 v[228:229],v[228:229],v[62:63] op_sel_hi:[1,0]
v_pk_mul_f32 v[230:231],v[230:231],v[62:63] op_sel_hi:[1,0]
v_fma_f32 v83,v83,s36,v14
v_exp_f32 v80,v80
v_mfma_f32_16x16x32_bf16 v[96:99],a[148:151],a[84:87],v[96:99]
v_exp_f32 v81,v81
v_mfma_f32_16x16x32_bf16 v[96:99],a[144:147],a[80:83],v[96:99]
buffer_load_dwordx4 v8,s[8:11],s21 offen offset:2048 lds
v_mfma_f32_16x16x32_bf16 v[96:99],a[140:143],a[76:79],v[96:99]
s_add_u32 s21,s21,12288
v_exp_f32 v82,v82
v_exp_f32 v83,v83
v_cvt_pk_bf16_f32 v24,v80,v81
v_pk_mul_f32 v[216:217],v[216:217],v[62:63] op_sel_hi:[1,0]
v_pk_mul_f32 v[218:219],v[218:219],v[62:63] op_sel_hi:[1,0]
v_pk_mul_f32 v[232:233],v[232:233],v[62:63] op_sel_hi:[1,0]
v_pk_mul_f32 v[234:235],v[234:235],v[62:63] op_sel_hi:[1,0]
v_cvt_pk_bf16_f32 v25,v82,v83
v_max_f32 v52,v52,v95
v_mfma_f32_16x16x32_bf16 v[96:99],a[136:139],a[72:75],v[96:99]
s_add_u32 m0,s22,0
v_mov_b32 v53,v52
v_cvt_pk_bf16_f32 v188,v188,v189
v_mfma_f32_16x16x32_bf16 v[104:107],a[136:139],a[96:99],0
ds_read_b128 a[136:139],v0 offset:6272
v_permlane32_swap_b32 v53,v52
v_mfma_f32_16x16x32_bf16 v[104:107],a[140:143],a[100:103],v[104:107]
ds_read_b128 a[140:143],v1 offset:6272
v_max_f32 v52,v52,v53
v_mfma_f32_16x16x32_bf16 v[104:107],a[144:147],a[104:107],v[104:107]
ds_read_b128 a[144:147],v0 offset:6400
v_mov_b32 v53,v52
v_max3_f32 v56,v96,v97,v98
v_cvt_pk_bf16_f32 v204,v204,v205
v_permlane16_swap_b32 v53,v52
v_pk_mul_f32 v[220:221],v[220:221],v[62:63] op_sel_hi:[1,0]
v_pk_mul_f32 v[222:223],v[222:223],v[62:63] op_sel_hi:[1,0]
v_pk_mul_f32 v[236:237],v[236:237],v[62:63] op_sel_hi:[1,0]
v_pk_mul_f32 v[238:239],v[238:239],v[62:63] op_sel_hi:[1,0]
v_max_f32 v52,v52,v53
v_mul_f32_e64 v15,-s36,v52
v_mfma_f32_16x16x32_bf16 v[104:107],a[148:151],a[108:111],v[104:107]
ds_read_b128 a[148:151],v1 offset:6400
v_fma_f32 v88,v88,s36,v15
v_mfma_f32_16x16x32_bf16 v[104:107],a[120:123],a[112:115],v[104:107]
ds_read_b128 a[120:123],v0 offset:12544
v_fma_f32 v89,v89,s36,v15
v_mfma_f32_16x16x32_bf16 v[104:107],a[124:127],a[116:119],v[104:107]
s_waitcnt lgkmcnt(4)
ds_read_b128 a[124:127],v1 offset:12544
v_fma_f32 v90,v90,s36,v15
v_mfma_f32_16x16x32_bf16 v[100:103],a[128:131],a[72:75],0
v_fma_f32 v91,v91,s36,v15
v_exp_f32 v88,v88
v_exp_f32 v89,v89
v_pk_mul_f32 v[240:241],v[240:241],v[62:63] op_sel_hi:[1,0]
v_pk_mul_f32 v[242:243],v[242:243],v[62:63] op_sel_hi:[1,0]
v_exp_f32 v90,v90
v_exp_f32 v91,v91
v_mfma_f32_16x16x32_bf16 v[100:103],a[132:135],a[76:79],v[100:103]
v_cvt_pk_bf16_f32 v28,v88,v89
v_cvt_pk_bf16_f32 v29,v90,v91
v_mfma_f32_16x16x32_bf16 v[100:103],a[136:139],a[80:83],v[100:103]
s_waitcnt lgkmcnt(2)
v_max3_f32 v40,v104,v105,v106
v_cvt_pk_bf16_f32 v201,v202,v203
v_mfma_f32_16x16x32_bf16 v[100:103],a[140:143],a[84:87],v[100:103]
ds_write2st64_b64 v38,v[184:185],v[200:201] offset0:2 offset1:4
v_mfma_f32_16x16x32_bf16 v[100:103],a[144:147],a[88:91],v[100:103]
v_cvt_pk_bf16_f32 v208,v208,v209
v_cvt_pk_bf16_f32 v224,v224,v225
v_cvt_pk_bf16_f32 v189,v190,v191
v_cvt_pk_bf16_f32 v205,v206,v207
v_cvt_pk_bf16_f32 v212,v212,v213
v_pk_mul_f32 v[244:245],v[244:245],v[62:63] op_sel_hi:[1,0]
v_pk_mul_f32 v[246:247],v[246:247],v[62:63] op_sel_hi:[1,0]
v_cvt_pk_bf16_f32 v228,v228,v229
v_cvt_pk_bf16_f32 v209,v210,v211
v_mfma_f32_16x16x32_bf16 v[100:103],a[148:151],a[92:95],v[100:103]
ds_write2st64_b64 v39,v[188:189],v[204:205] offset0:2 offset1:4
v_mfma_f32_16x16x32_bf16 v[108:111],a[148:151],a[116:119],0
v_cvt_pk_bf16_f32 v225,v226,v227
v_cvt_pk_bf16_f32 v216,v216,v217
v_mfma_f32_16x16x32_bf16 v[108:111],a[144:147],a[112:115],v[108:111]
ds_read_b128 a[144:147],v0 offset:12416
v_cvt_pk_bf16_f32 v232,v232,v233
ds_read_b128 a[148:151],v1 offset:12416
v_pk_mul_f32 v[248:249],v[248:249],v[62:63] op_sel_hi:[1,0]
ds_write2st64_b64 v36,v[208:209],v[224:225] offset0:12 offset1:14
v_pk_mul_f32 v[250:251],v[250:251],v[62:63] op_sel_hi:[1,0]
v_max3_f32 v56,v56,v99,v100
v_max3_f32 v56,v56,v101,v102
v_mfma_f32_16x16x32_bf16 v[108:111],a[140:143],a[108:111],v[108:111]
ds_read_b128 a[140:143],v1 offset:12288
v_max_f32 v56,v56,v103
v_mfma_f32_16x16x32_bf16 v[108:111],a[136:139],a[104:107],v[108:111]
ds_read_b128 a[136:139],v0 offset:12288
v_mov_b32 v57,v56
v_mfma_f32_16x16x32_bf16 v[108:111],a[132:135],a[100:103],v[108:111]
ds_read_b128 a[132:135],v1 offset:18432
v_permlane32_swap_b32 v57,v56
v_mfma_f32_16x16x32_bf16 v[108:111],a[128:131],a[96:99],v[108:111]
ds_read_b128 a[128:131],v0 offset:18432
v_max_f32 v56,v56,v57
v_mov_b32 v57,v56
v_cvt_pk_bf16_f32 v213,v214,v215
v_cvt_pk_bf16_f32 v229,v230,v231
ds_write2st64_b64 v37,v[212:213],v[228:229] offset0:12 offset1:14
v_pk_mul_f32 v[252:253],v[252:253],v[62:63] op_sel_hi:[1,0]
v_pk_mul_f32 v[254:255],v[254:255],v[62:63] op_sel_hi:[1,0]
v_permlane16_swap_b32 v57,v56
v_max_f32 v56,v56,v57
v_mul_f32_e64 v16,-s36,v56
v_fma_f32 v96,v96,s36,v16
v_fma_f32 v97,v97,s36,v16
v_fma_f32 v98,v98,s36,v16
s_waitcnt lgkmcnt(3)
v_mfma_f32_16x16x32_bf16 v[72:75],a[136:139],a[0:3],0
v_fma_f32 v99,v99,s36,v16
v_exp_f32 v96,v96
v_mfma_f32_16x16x32_bf16 v[72:75],a[140:143],a[4:7],v[72:75]
v_exp_f32 v97,v97
v_mfma_f32_16x16x32_bf16 v[72:75],a[144:147],a[8:11],v[72:75]
v_exp_f32 v98,v98
v_mfma_f32_16x16x32_bf16 v[72:75],a[148:151],a[12:15],v[72:75]
v_exp_f32 v99,v99
v_mfma_f32_16x16x32_bf16 v[72:75],a[120:123],a[16:19],v[72:75]
v_cvt_pk_bf16_f32 v32,v96,v97
v_cvt_pk_bf16_f32 v33,v98,v99
v_mfma_f32_16x16x32_bf16 v[72:75],a[124:127],a[20:23],v[72:75]
v_max3_f32 v40,v40,v107,v108
v_max3_f32 v40,v40,v109,v110
v_mfma_f32_16x16x32_bf16 v[80:83],a[124:127],a[44:47],0
v_max_f32 v40,v40,v111
v_mov_b32 v41,v40
v_mfma_f32_16x16x32_bf16 v[80:83],a[120:123],a[40:43],v[80:83]
v_cvt_pk_bf16_f32 v220,v220,v221
v_permlane32_swap_b32 v41,v40
v_mfma_f32_16x16x32_bf16 v[80:83],a[148:151],a[36:39],v[80:83]
v_max_f32 v40,v40,v41
v_mov_b32 v41,v40
v_mfma_f32_16x16x32_bf16 v[80:83],a[144:147],a[32:35],v[80:83]
v_cvt_pk_bf16_f32 v236,v236,v237
v_permlane16_swap_b32 v41,v40
v_mfma_f32_16x16x32_bf16 v[80:83],a[140:143],a[28:31],v[80:83]
v_max_f32 v40,v40,v41
v_cvt_pk_bf16_f32 v217,v218,v219
v_mfma_f32_16x16x32_bf16 v[80:83],a[136:139],a[24:27],v[80:83]
v_cvt_pk_bf16_f32 v233,v234,v235
v_mul_f32_e64 v17,-s36,v40
v_mfma_f32_16x16x32_bf16 v[88:91],a[136:139],a[48:51],0
ds_write2st64_b64 v38,v[216:217],v[232:233] offset0:12 offset1:14
v_mfma_f32_16x16x32_bf16 v[88:91],a[140:143],a[52:55],v[88:91]
v_cvt_pk_bf16_f32 v240,v240,v241
v_cvt_pk_bf16_f32 v221,v222,v223
v_mfma_f32_16x16x32_bf16 v[88:91],a[144:147],a[56:59],v[88:91]
v_cvt_pk_bf16_f32 v237,v238,v239
v_fma_f32 v104,v104,s36,v17
v_mfma_f32_16x16x32_bf16 v[88:91],a[148:151],a[60:63],v[88:91]
v_fma_f32 v105,v105,s36,v17
v_fma_f32 v106,v106,s36,v17
v_mfma_f32_16x16x32_bf16 v[88:91],a[120:123],a[64:67],v[88:91]
ds_write2st64_b64 v39,v[220:221],v[236:237] offset0:12 offset1:14
v_mfma_f32_16x16x32_bf16 v[88:91],a[124:127],a[68:71],v[88:91]
v_fma_f32 v107,v107,s36,v17
v_cvt_pk_bf16_f32 v244,v244,v245
v_mfma_f32_16x16x32_bf16 v[96:99],a[124:127],a[92:95],0
v_cvt_pk_bf16_f32 v241,v242,v243
v_exp_f32 v104,v104
v_mfma_f32_16x16x32_bf16 v[96:99],a[120:123],a[88:91],v[96:99]
v_exp_f32 v105,v105
v_mfma_f32_16x16x32_bf16 v[96:99],a[148:151],a[84:87],v[96:99]
ds_write_b64 v36,v[240:241] offset:8192
v_mfma_f32_16x16x32_bf16 v[96:99],a[144:147],a[80:83],v[96:99]
v_exp_f32 v106,v106
v_mfma_f32_16x16x32_bf16 v[96:99],a[140:143],a[76:79],v[96:99]
v_exp_f32 v107,v107
v_mfma_f32_16x16x32_bf16 v[96:99],a[136:139],a[72:75],v[96:99]
v_cvt_pk_bf16_f32 v245,v246,v247
ds_write_b64 v37,v[244:245] offset:8192
v_cvt_pk_bf16_f32 v36,v104,v105
v_cvt_pk_bf16_f32 v37,v106,v107
v_mfma_f32_16x16x32_bf16 v[104:107],a[136:139],a[96:99],0
ds_read_b128 a[136:139],v0 offset:18560
v_fma_f32 v76,v76,s36,v13
v_mfma_f32_16x16x32_bf16 v[104:107],a[140:143],a[100:103],v[104:107]
ds_read_b128 a[140:143],v1 offset:18560
v_fma_f32 v77,v77,s36,v13
v_mfma_f32_16x16x32_bf16 v[104:107],a[144:147],a[104:107],v[104:107]
ds_read_b128 a[144:147],v0 offset:18688
v_fma_f32 v78,v78,s36,v13
v_mfma_f32_16x16x32_bf16 v[104:107],a[148:151],a[108:111],v[104:107]
ds_read_b128 a[148:151],v1 offset:18688
v_fma_f32 v79,v79,s36,v13
v_mfma_f32_16x16x32_bf16 v[104:107],a[120:123],a[112:115],v[104:107]
v_exp_f32 v76,v76
v_mfma_f32_16x16x32_bf16 v[104:107],a[124:127],a[116:119],v[104:107]
v_exp_f32 v77,v77
v_exp_f32 v78,v78
v_exp_f32 v79,v79
v_cvt_pk_bf16_f32 v22,v76,v77
v_cvt_pk_bf16_f32 v23,v78,v79
s_waitcnt lgkmcnt(4)
v_mfma_f32_16x16x32_bf16 v[76:79],a[128:131],a[0:3],0
v_fma_f32 v84,v84,s36,v14
v_fma_f32 v85,v85,s36,v14
s_waitcnt vmcnt(3)
s_barrier
v_mfma_f32_16x16x32_bf16 v[76:79],a[132:135],a[4:7],v[76:79]
s_waitcnt lgkmcnt(0)
v_fma_f32 v86,v86,s36,v14
v_fma_f32 v87,v87,s36,v14
v_mfma_f32_16x16x32_bf16 v[76:79],a[136:139],a[8:11],v[76:79]
buffer_load_dwordx4 v6,s[4:7],s20 offen offset:0 lds
v_mfma_f32_16x16x32_bf16 v[76:79],a[140:143],a[12:15],v[76:79]
v_exp_f32 v84,v84
v_mfma_f32_16x16x32_bf16 v[76:79],a[144:147],a[16:19],v[76:79]
v_exp_f32 v85,v85
v_mfma_f32_16x16x32_bf16 v[76:79],a[148:151],a[20:23],v[76:79]
v_exp_f32 v86,v86
v_exp_f32 v87,v87
v_cvt_pk_bf16_f32 v26,v84,v85
v_cvt_pk_bf16_f32 v27,v86,v87
v_mfma_f32_16x16x32_bf16 v[84:87],a[148:151],a[44:47],0
buffer_load_dwordx4 v7,s[4:7],s20 offen offset:1024 lds
v_mfma_f32_16x16x32_bf16 v[84:87],a[144:147],a[40:43],v[84:87]
v_fma_f32 v92,v92,s36,v15
v_fma_f32 v93,v93,s36,v15
v_mfma_f32_16x16x32_bf16 v[84:87],a[140:143],a[36:39],v[84:87]
v_fma_f32 v94,v94,s36,v15
v_fma_f32 v95,v95,s36,v15
v_mfma_f32_16x16x32_bf16 v[84:87],a[136:139],a[32:35],v[84:87]
v_exp_f32 v92,v92
v_mfma_f32_16x16x32_bf16 v[84:87],a[132:135],a[28:31],v[84:87]
ds_read_b64_tr_b16 a[120:121],v2 offset:0
v_exp_f32 v93,v93
v_mfma_f32_16x16x32_bf16 v[84:87],a[128:131],a[24:27],v[84:87]
ds_read_b64_tr_b16 a[122:123],v2 offset:6144
buffer_load_dwordx4 v8,s[4:7],s20 offen offset:2048 lds
ds_read_b64_tr_b16 a[124:125],v3 offset:0
ds_read_b64_tr_b16 a[126:127],v3 offset:6144
v_exp_f32 v94,v94
v_exp_f32 v95,v95
v_cvt_pk_bf16_f32 v30,v92,v93
v_cvt_pk_bf16_f32 v31,v94,v95
v_mfma_f32_16x16x32_bf16 v[92:95],a[128:131],a[48:51],0
s_add_u32 s20,s20,12288
v_fma_f32 v100,v100,s36,v16
v_fma_f32 v101,v101,s36,v16
v_mfma_f32_16x16x32_bf16 v[92:95],a[132:135],a[52:55],v[92:95]
v_fma_f32 v102,v102,s36,v16
v_fma_f32 v103,v103,s36,v16
v_mfma_f32_16x16x32_bf16 v[92:95],a[136:139],a[56:59],v[92:95]
v_exp_f32 v100,v100
v_mfma_f32_16x16x32_bf16 v[92:95],a[140:143],a[60:63],v[92:95]
v_exp_f32 v101,v101
v_mfma_f32_16x16x32_bf16 v[92:95],a[144:147],a[64:67],v[92:95]
v_exp_f32 v102,v102
v_mfma_f32_16x16x32_bf16 v[92:95],a[148:151],a[68:71],v[92:95]
v_exp_f32 v103,v103
v_cvt_pk_bf16_f32 v34,v100,v101
v_cvt_pk_bf16_f32 v35,v102,v103
v_mfma_f32_16x16x32_bf16 v[100:103],a[148:151],a[92:95],0
v_cvt_pk_bf16_f32 v248,v248,v249
v_fma_f32 v108,v108,s36,v17
v_smfmac_f32_16x16x64_bf16 v[64:67],a[152:155],v[28:35],v18
v_fma_f32 v109,v109,s36,v17
v_mfma_f32_16x16x32_bf16 v[100:103],a[144:147],a[88:91],v[100:103]
v_fma_f32 v110,v110,s36,v17
v_fma_f32 v111,v111,s36,v17
v_mfma_f32_16x16x32_bf16 v[100:103],a[140:143],a[84:87],v[100:103]
v_cvt_pk_bf16_f32 v252,v252,v253
v_cvt_pk_bf16_f32 v249,v250,v251
v_mfma_f32_16x16x32_bf16 v[100:103],a[136:139],a[80:83],v[100:103]
ds_write_b64 v38,v[248:249] offset:8192
v_mfma_f32_16x16x32_bf16 v[100:103],a[132:135],a[76:79],v[100:103]
v_exp_f32 v108,v108
v_mfma_f32_16x16x32_bf16 v[100:103],a[128:131],a[72:75],v[100:103]
v_exp_f32 v109,v109
v_exp_f32 v110,v110
v_exp_f32 v111,v111
v_cvt_pk_bf16_f32 v253,v254,v255
ds_write_b64 v39,v[252:253] offset:8192
v_cvt_pk_bf16_f32 v38,v108,v109
v_cvt_pk_bf16_f32 v39,v110,v111
v_mfma_f32_16x16x32_bf16 v[108:111],a[128:131],a[96:99],0
ds_read_b64_tr_b16 a[128:129],v4 offset:0
v_mov_b32 v60,0
v_mfma_f32_16x16x32_bf16 v[108:111],a[132:135],a[100:103],v[108:111]
ds_read_b64_tr_b16 a[130:131],v4 offset:6144
v_mov_b32 v61,0
v_mfma_f32_16x16x32_bf16 v[108:111],a[136:139],a[104:107],v[108:111]
ds_read_b64_tr_b16 a[132:133],v5 offset:0
v_mov_b32 v62,0
v_mfma_f32_16x16x32_bf16 v[108:111],a[140:143],a[108:111],v[108:111]
ds_read_b64_tr_b16 a[134:135],v5 offset:6144
v_mov_b32 v63,0
v_mfma_f32_16x16x32_bf16 v[108:111],a[144:147],a[112:115],v[108:111]
v_fma_f32 v72,v72,s36,v13
v_fma_f32 v73,v73,s36,v13
v_smfmac_f32_16x16x64_bf16 v[60:63],a[152:155],v[20:27],v18
v_fma_f32 v74,v74,s36,v13
v_mfma_f32_16x16x32_bf16 v[108:111],a[148:151],a[116:119],v[108:111]
v_fma_f32 v75,v75,s36,v13
v_fma_f32 v80,v80,s36,v14
v_fma_f32 v81,v81,s36,v14
v_fma_f32 v82,v82,s36,v14
v_fma_f32 v83,v83,s36,v14
v_fma_f32 v88,v88,s36,v15
v_fma_f32 v89,v89,s36,v15
v_exp_f32 v72,v72
v_exp_f32 v73,v73
v_exp_f32 v74,v74
v_exp_f32 v75,v75
v_exp_f32 v80,v80
v_exp_f32 v81,v81
v_exp_f32 v82,v82
v_exp_f32 v83,v83
v_exp_f32 v88,v88
v_exp_f32 v89,v89
v_cvt_pk_bf16_f32 v44,v72,v73
v_cvt_pk_bf16_f32 v45,v74,v75
v_cvt_pk_bf16_f32 v48,v80,v81
v_cvt_pk_bf16_f32 v49,v82,v83
v_cvt_pk_bf16_f32 v52,v88,v89
s_waitcnt lgkmcnt(0)
v_mfma_f32_16x16x32_bf16 v[160:163],a[120:123],v[20:23],0
s_add_u32 m0,s23,0
ds_read_b64_tr_b16 a[136:137],v2 offset:128
v_fma_f32 v90,v90,s36,v15
v_mfma_f32_16x16x32_bf16 v[164:167],a[124:127],v[20:23],0
ds_read_b64_tr_b16 a[138:139],v2 offset:6272
v_fma_f32 v91,v91,s36,v15
v_mfma_f32_16x16x32_bf16 v[212:215],a[124:127],v[24:27],0
ds_read_b64_tr_b16 a[140:141],v3 offset:128
v_fma_f32 v96,v96,s36,v16
v_mfma_f32_16x16x32_bf16 v[208:211],a[120:123],v[24:27],0
ds_read_b64_tr_b16 a[142:143],v3 offset:6272
v_fma_f32 v97,v97,s36,v16
v_mfma_f32_16x16x32_bf16 v[112:115],a[120:123],v[28:31],0
ds_read_b64_tr_b16 a[144:145],v4 offset:128
v_fma_f32 v98,v98,s36,v16
v_mfma_f32_16x16x32_bf16 v[116:119],a[124:127],v[28:31],0
ds_read_b64_tr_b16 a[146:147],v4 offset:6272
v_fma_f32 v99,v99,s36,v16
v_mfma_f32_16x16x32_bf16 a[164:167],a[124:127],v[32:35],0
ds_read_b64_tr_b16 a[148:149],v5 offset:128
v_fma_f32 v104,v104,s36,v17
v_mfma_f32_16x16x32_bf16 a[160:163],a[120:123],v[32:35],0
ds_read_b64_tr_b16 a[150:151],v5 offset:6272
v_fma_f32 v105,v105,s36,v17
v_mfma_f32_16x16x32_bf16 a[208:211],a[120:123],v[36:39],0
ds_read_b64_tr_b16 a[120:121],v2 offset:256
v_fma_f32 v106,v106,s36,v17
v_mfma_f32_16x16x32_bf16 a[212:215],a[124:127],v[36:39],0
ds_read_b64_tr_b16 a[122:123],v2 offset:6400
v_fma_f32 v107,v107,s36,v17
v_mfma_f32_16x16x32_bf16 a[216:219],a[128:131],v[36:39],0
ds_read_b64_tr_b16 a[124:125],v3 offset:256
v_fma_f32 v76,v76,s36,v13
v_mfma_f32_16x16x32_bf16 a[220:223],a[132:135],v[36:39],0
ds_read_b64_tr_b16 a[126:127],v3 offset:6400
v_fma_f32 v77,v77,s36,v13
v_mfma_f32_16x16x32_bf16 a[172:175],a[132:135],v[32:35],0
v_exp_f32 v90,v90
v_mfma_f32_16x16x32_bf16 a[168:171],a[128:131],v[32:35],0
v_exp_f32 v91,v91
v_mfma_f32_16x16x32_bf16 v[120:123],a[128:131],v[28:31],0
v_cvt_pk_bf16_f32 v53,v90,v91
v_fma_f32 v78,v78,s36,v13
v_mfma_f32_16x16x32_bf16 v[124:127],a[132:135],v[28:31],0
v_exp_f32 v96,v96
v_mfma_f32_16x16x32_bf16 v[220:223],a[132:135],v[24:27],0
v_exp_f32 v97,v97
v_mfma_f32_16x16x32_bf16 v[216:219],a[128:131],v[24:27],0
v_exp_f32 v98,v98
v_mfma_f32_16x16x32_bf16 v[168:171],a[128:131],v[20:23],0
ds_read_b64_tr_b16 a[128:129],v4 offset:256
v_cvt_pk_bf16_f32 v56,v96,v97
v_mfma_f32_16x16x32_bf16 v[172:175],a[132:135],v[20:23],0
s_waitcnt lgkmcnt(1)
ds_read_b64_tr_b16 a[130:131],v4 offset:6400
v_fma_f32 v79,v79,s36,v13
v_mfma_f32_16x16x32_bf16 v[176:179],a[136:139],v[20:23],0
ds_read_b64_tr_b16 a[132:133],v5 offset:256
v_fma_f32 v84,v84,s36,v14
v_mfma_f32_16x16x32_bf16 v[180:183],a[140:143],v[20:23],0
ds_read_b64_tr_b16 a[134:135],v5 offset:6400
v_fma_f32 v85,v85,s36,v14
v_mfma_f32_16x16x32_bf16 v[228:231],a[140:143],v[24:27],0
v_exp_f32 v99,v99
v_mfma_f32_16x16x32_bf16 v[224:227],a[136:139],v[24:27],0
v_cvt_pk_bf16_f32 v57,v98,v99
v_fma_f32 v86,v86,s36,v14
v_mfma_f32_16x16x32_bf16 v[128:131],a[136:139],v[28:31],0
v_exp_f32 v104,v104
v_mfma_f32_16x16x32_bf16 v[132:135],a[140:143],v[28:31],0
v_exp_f32 v105,v105
v_mfma_f32_16x16x32_bf16 a[180:183],a[140:143],v[32:35],0
v_exp_f32 v106,v106
v_mfma_f32_16x16x32_bf16 a[176:179],a[136:139],v[32:35],0
v_exp_f32 v107,v107
v_mfma_f32_16x16x32_bf16 a[224:227],a[136:139],v[36:39],0
v_cvt_pk_bf16_f32 v40,v104,v105
v_cvt_pk_bf16_f32 v41,v106,v107
v_mfma_f32_16x16x32_bf16 a[228:231],a[140:143],v[36:39],0
v_exp_f32 v76,v76
v_mfma_f32_16x16x32_bf16 a[232:235],a[144:147],v[36:39],0
v_exp_f32 v77,v77
v_mfma_f32_16x16x32_bf16 a[236:239],a[148:151],v[36:39],0
v_exp_f32 v78,v78
v_mfma_f32_16x16x32_bf16 a[188:191],a[148:151],v[32:35],0
v_exp_f32 v79,v79
v_mfma_f32_16x16x32_bf16 a[184:187],a[144:147],v[32:35],0
v_cvt_pk_bf16_f32 v46,v76,v77
v_cvt_pk_bf16_f32 v47,v78,v79
v_mfma_f32_16x16x32_bf16 v[136:139],a[144:147],v[28:31],0
v_fma_f32 v87,v87,s36,v14
v_fma_f32 v92,v92,s36,v15
v_mfma_f32_16x16x32_bf16 v[140:143],a[148:151],v[28:31],0
v_exp_f32 v84,v84
v_mfma_f32_16x16x32_bf16 v[236:239],a[148:151],v[24:27],0
v_exp_f32 v85,v85
v_mfma_f32_16x16x32_bf16 v[232:235],a[144:147],v[24:27],0
v_exp_f32 v86,v86
v_mfma_f32_16x16x32_bf16 v[184:187],a[144:147],v[20:23],0
v_exp_f32 v87,v87
v_mfma_f32_16x16x32_bf16 v[188:191],a[148:151],v[20:23],0
v_cvt_pk_bf16_f32 v50,v84,v85
v_cvt_pk_bf16_f32 v51,v86,v87
v_mfma_f32_16x16x32_bf16 v[192:195],a[120:123],v[20:23],0
v_fma_f32 v93,v93,s36,v15
v_fma_f32 v94,v94,s36,v15
v_smfmac_f32_16x16x64_bf16 v[60:63],a[152:155],v[44:51],v18
v_fma_f32 v95,v95,s36,v15
v_mfma_f32_16x16x32_bf16 v[196:199],a[124:127],v[20:23],0
s_waitcnt vmcnt(30) lgkmcnt(0)
v_exp_f32 v92,v92
v_mfma_f32_16x16x32_bf16 v[244:247],a[124:127],v[24:27],0
s_barrier
v_mfma_f32_16x16x32_bf16 v[240:243],a[120:123],v[24:27],0
ds_read_b128 a[136:139],v0 offset:24576
v_fma_f32 v100,v100,s36,v16
v_mfma_f32_16x16x32_bf16 v[144:147],a[120:123],v[28:31],0
ds_read_b128 a[140:143],v1 offset:24576
v_fma_f32 v101,v101,s36,v16
v_mfma_f32_16x16x32_bf16 v[148:151],a[124:127],v[28:31],0
ds_read_b128 a[144:147],v0 offset:24704
v_fma_f32 v102,v102,s36,v16
v_mfma_f32_16x16x32_bf16 a[196:199],a[124:127],v[32:35],0
ds_read_b128 a[148:151],v1 offset:24704
v_fma_f32 v103,v103,s36,v16
v_mfma_f32_16x16x32_bf16 a[192:195],a[120:123],v[32:35],0
v_exp_f32 v93,v93
v_mfma_f32_16x16x32_bf16 a[240:243],a[120:123],v[36:39],0
buffer_load_dwordx4 v6,s[8:11],s21 offen offset:0 lds
v_mfma_f32_16x16x32_bf16 a[244:247],a[124:127],v[36:39],0
ds_read_b128 a[120:123],v0 offset:24832
v_cvt_pk_bf16_f32 v54,v92,v93
v_mfma_f32_16x16x32_bf16 a[248:251],a[128:131],v[36:39],0
ds_read_b128 a[124:127],v1 offset:24832
v_fma_f32 v108,v108,s36,v17
v_mfma_f32_16x16x32_bf16 a[252:255],a[132:135],v[36:39],0
v_exp_f32 v94,v94
v_mfma_f32_16x16x32_bf16 a[204:207],a[132:135],v[32:35],0
v_exp_f32 v95,v95
v_mfma_f32_16x16x32_bf16 a[200:203],a[128:131],v[32:35],0
v_cvt_pk_bf16_f32 v55,v94,v95
v_fma_f32 v109,v109,s36,v17
v_mfma_f32_16x16x32_bf16 v[152:155],a[128:131],v[28:31],0
v_exp_f32 v100,v100
v_mfma_f32_16x16x32_bf16 v[156:159],a[132:135],v[28:31],0
v_exp_f32 v101,v101
v_mfma_f32_16x16x32_bf16 v[252:255],a[132:135],v[24:27],0
v_exp_f32 v102,v102
v_mfma_f32_16x16x32_bf16 v[248:251],a[128:131],v[24:27],0
v_exp_f32 v103,v103
v_mfma_f32_16x16x32_bf16 v[200:203],a[128:131],v[20:23],0
ds_read_b128 a[128:131],v0 offset:30720
v_cvt_pk_bf16_f32 v58,v100,v101
v_mfma_f32_16x16x32_bf16 v[204:207],a[132:135],v[20:23],0
buffer_load_dwordx4 v7,s[8:11],s21 offen offset:1024 lds
s_waitcnt lgkmcnt(1)
v_mfma_f32_16x16x32_bf16 v[72:75],a[136:139],a[0:3],0
ds_read_b128 a[132:135],v1 offset:30720
v_cvt_pk_bf16_f32 v59,v102,v103
v_mfma_f32_16x16x32_bf16 v[72:75],a[140:143],a[4:7],v[72:75]
v_fma_f32 v110,v110,s36,v17
v_fma_f32 v111,v111,s36,v17
v_smfmac_f32_16x16x64_bf16 v[64:67],a[152:155],v[52:59],v18
v_mfma_f32_16x16x32_bf16 v[72:75],a[144:147],a[8:11],v[72:75]
v_exp_f32 v108,v108
v_mfma_f32_16x16x32_bf16 v[72:75],a[148:151],a[12:15],v[72:75]
v_exp_f32 v109,v109
v_mfma_f32_16x16x32_bf16 v[72:75],a[120:123],a[16:19],v[72:75]
v_exp_f32 v110,v110
v_mfma_f32_16x16x32_bf16 v[72:75],a[124:127],a[20:23],v[72:75]
v_exp_f32 v111,v111
v_mfma_f32_16x16x32_bf16 v[80:83],a[124:127],a[44:47],0
v_cvt_pk_bf16_f32 v42,v108,v109
v_cvt_pk_bf16_f32 v43,v110,v111
v_mfma_f32_16x16x32_bf16 v[80:83],a[120:123],a[40:43],v[80:83]
v_mfma_f32_16x16x32_bf16 v[80:83],a[148:151],a[36:39],v[80:83]
v_smfmac_f32_16x16x64_bf16 v[68:71],a[152:155],v[36:43],v18
buffer_load_dwordx4 v8,s[8:11],s21 offen offset:2048 lds
v_mfma_f32_16x16x32_bf16 v[80:83],a[144:147],a[32:35],v[80:83]
s_add_u32 s21,s21,12288
v_fma_f32 v72,v72,s36,v13
v_fma_f32 v73,v73,s36,v13
v_mfma_f32_16x16x32_bf16 v[80:83],a[140:143],a[28:31],v[80:83]
s_add_u32 m0,s22,12288
v_fma_f32 v74,v74,s36,v13
v_fma_f32 v75,v75,s36,v13
v_mfma_f32_16x16x32_bf16 v[80:83],a[136:139],a[24:27],v[80:83]
v_exp_f32 v72,v72
v_mfma_f32_16x16x32_bf16 v[88:91],a[136:139],a[48:51],0
v_exp_f32 v73,v73
v_mfma_f32_16x16x32_bf16 v[88:91],a[140:143],a[52:55],v[88:91]
v_exp_f32 v74,v74
v_mfma_f32_16x16x32_bf16 v[88:91],a[144:147],a[56:59],v[88:91]
v_exp_f32 v75,v75
v_mfma_f32_16x16x32_bf16 v[88:91],a[148:151],a[60:63],v[88:91]
v_fma_f32 v80,v80,s36,v14
v_fma_f32 v81,v81,s36,v14
v_mfma_f32_16x16x32_bf16 v[88:91],a[120:123],a[64:67],v[88:91]
v_fma_f32 v82,v82,s36,v14
v_fma_f32 v83,v83,s36,v14
v_mfma_f32_16x16x32_bf16 v[88:91],a[124:127],a[68:71],v[88:91]
v_exp_f32 v80,v80
v_mfma_f32_16x16x32_bf16 v[96:99],a[124:127],a[92:95],0
v_exp_f32 v81,v81
v_mfma_f32_16x16x32_bf16 v[96:99],a[120:123],a[88:91],v[96:99]
buffer_load_dwordx4 v6,s[4:7],s20 offen offset:0 lds
v_mfma_f32_16x16x32_bf16 v[96:99],a[148:151],a[84:87],v[96:99]
v_exp_f32 v82,v82
v_mfma_f32_16x16x32_bf16 v[96:99],a[144:147],a[80:83],v[96:99]
v_fma_f32 v88,v88,s36,v15
v_fma_f32 v89,v89,s36,v15
v_mfma_f32_16x16x32_bf16 v[96:99],a[140:143],a[76:79],v[96:99]
v_exp_f32 v83,v83
v_mfma_f32_16x16x32_bf16 v[96:99],a[136:139],a[72:75],v[96:99]
v_exp_f32 v88,v88
v_mfma_f32_16x16x32_bf16 v[104:107],a[136:139],a[96:99],0
ds_read_b128 a[136:139],v0 offset:30848
v_cvt_pk_bf16_f32 v20,v72,v73
v_mfma_f32_16x16x32_bf16 v[104:107],a[140:143],a[100:103],v[104:107]
ds_read_b128 a[140:143],v1 offset:30848
v_cvt_pk_bf16_f32 v21,v74,v75
v_mfma_f32_16x16x32_bf16 v[104:107],a[144:147],a[104:107],v[104:107]
ds_read_b128 a[144:147],v0 offset:30976
v_cvt_pk_bf16_f32 v24,v80,v81
v_mfma_f32_16x16x32_bf16 v[104:107],a[148:151],a[108:111],v[104:107]
ds_read_b128 a[148:151],v1 offset:30976
v_cvt_pk_bf16_f32 v25,v82,v83
v_mfma_f32_16x16x32_bf16 v[104:107],a[120:123],a[112:115],v[104:107]
v_exp_f32 v89,v89
v_mfma_f32_16x16x32_bf16 v[104:107],a[124:127],a[116:119],v[104:107]
s_waitcnt lgkmcnt(4)
v_cvt_pk_bf16_f32 v28,v88,v89
v_mfma_f32_16x16x32_bf16 v[76:79],a[128:131],a[0:3],0
v_mfma_f32_16x16x32_bf16 v[76:79],a[132:135],a[4:7],v[76:79]
buffer_load_dwordx4 v7,s[4:7],s20 offen offset:1024 lds
s_waitcnt lgkmcnt(3)
v_mfma_f32_16x16x32_bf16 v[76:79],a[136:139],a[8:11],v[76:79]
s_waitcnt lgkmcnt(2)
v_mfma_f32_16x16x32_bf16 v[76:79],a[140:143],a[12:15],v[76:79]
s_waitcnt lgkmcnt(1)
v_mfma_f32_16x16x32_bf16 v[76:79],a[144:147],a[16:19],v[76:79]
s_waitcnt lgkmcnt(0)
v_mfma_f32_16x16x32_bf16 v[76:79],a[148:151],a[20:23],v[76:79]
v_mfma_f32_16x16x32_bf16 v[84:87],a[148:151],a[44:47],0
v_mfma_f32_16x16x32_bf16 v[84:87],a[144:147],a[40:43],v[84:87]
v_mfma_f32_16x16x32_bf16 v[84:87],a[140:143],a[36:39],v[84:87]
v_mfma_f32_16x16x32_bf16 v[84:87],a[136:139],a[32:35],v[84:87]
v_mfma_f32_16x16x32_bf16 v[84:87],a[132:135],a[28:31],v[84:87]
v_mfma_f32_16x16x32_bf16 v[84:87],a[128:131],a[24:27],v[84:87]
v_mfma_f32_16x16x32_bf16 v[92:95],a[128:131],a[48:51],0
buffer_load_dwordx4 v8,s[4:7],s20 offen offset:2048 lds
v_mfma_f32_16x16x32_bf16 v[92:95],a[132:135],a[52:55],v[92:95]
s_add_u32 s20,s20,12288
v_mfma_f32_16x16x32_bf16 v[92:95],a[136:139],a[56:59],v[92:95]
v_mfma_f32_16x16x32_bf16 v[92:95],a[140:143],a[60:63],v[92:95]
v_mfma_f32_16x16x32_bf16 v[92:95],a[144:147],a[64:67],v[92:95]
v_mfma_f32_16x16x32_bf16 v[92:95],a[148:151],a[68:71],v[92:95]
ds_read_b64_tr_b16 a[120:121],v2 offset:12288
v_mfma_f32_16x16x32_bf16 v[100:103],a[148:151],a[92:95],0
ds_read_b64_tr_b16 a[122:123],v2 offset:18432
v_mfma_f32_16x16x32_bf16 v[100:103],a[144:147],a[88:91],v[100:103]
v_mfma_f32_16x16x32_bf16 v[100:103],a[140:143],a[84:87],v[100:103]
ds_read_b64_tr_b16 a[124:125],v3 offset:12288
v_mfma_f32_16x16x32_bf16 v[100:103],a[136:139],a[80:83],v[100:103]
ds_read_b64_tr_b16 a[126:127],v3 offset:18432
v_mfma_f32_16x16x32_bf16 v[100:103],a[132:135],a[76:79],v[100:103]
v_mfma_f32_16x16x32_bf16 v[100:103],a[128:131],a[72:75],v[100:103]
v_mfma_f32_16x16x32_bf16 v[108:111],a[128:131],a[96:99],0
ds_read_b64_tr_b16 a[128:129],v4 offset:12288
v_mfma_f32_16x16x32_bf16 v[108:111],a[132:135],a[100:103],v[108:111]
ds_read_b64_tr_b16 a[130:131],v4 offset:18432
v_mfma_f32_16x16x32_bf16 v[108:111],a[136:139],a[104:107],v[108:111]
ds_read_b64_tr_b16 a[132:133],v5 offset:12288
v_mfma_f32_16x16x32_bf16 v[108:111],a[140:143],a[108:111],v[108:111]
ds_read_b64_tr_b16 a[134:135],v5 offset:18432
v_mfma_f32_16x16x32_bf16 v[108:111],a[144:147],a[112:115],v[108:111]
v_mfma_f32_16x16x32_bf16 v[108:111],a[148:151],a[116:119],v[108:111]
s_waitcnt lgkmcnt(4)
v_mfma_f32_16x16x32_bf16 v[160:163],a[120:123],v[44:47],v[160:163]
s_add_u32 m0,s23,12288
ds_read_b64_tr_b16 a[136:137],v2 offset:12416
v_fma_f32 v90,v90,s36,v15
v_mfma_f32_16x16x32_bf16 v[164:167],a[124:127],v[44:47],v[164:167]
ds_read_b64_tr_b16 a[138:139],v2 offset:18560
v_fma_f32 v91,v91,s36,v15
v_mfma_f32_16x16x32_bf16 v[212:215],a[124:127],v[48:51],v[212:215]
ds_read_b64_tr_b16 a[140:141],v3 offset:12416
v_fma_f32 v96,v96,s36,v16
v_mfma_f32_16x16x32_bf16 v[208:211],a[120:123],v[48:51],v[208:211]
ds_read_b64_tr_b16 a[142:143],v3 offset:18560
v_fma_f32 v97,v97,s36,v16
v_mfma_f32_16x16x32_bf16 v[112:115],a[120:123],v[52:55],v[112:115]
ds_read_b64_tr_b16 a[144:145],v4 offset:12416
v_fma_f32 v98,v98,s36,v16
v_mfma_f32_16x16x32_bf16 v[116:119],a[124:127],v[52:55],v[116:119]
ds_read_b64_tr_b16 a[146:147],v4 offset:18560
v_fma_f32 v99,v99,s36,v16
v_mfma_f32_16x16x32_bf16 a[164:167],a[124:127],v[56:59],a[164:167]
ds_read_b64_tr_b16 a[148:149],v5 offset:12416
v_fma_f32 v104,v104,s36,v17
v_mfma_f32_16x16x32_bf16 a[160:163],a[120:123],v[56:59],a[160:163]
ds_read_b64_tr_b16 a[150:151],v5 offset:18560
v_fma_f32 v105,v105,s36,v17
v_mfma_f32_16x16x32_bf16 a[208:211],a[120:123],v[40:43],a[208:211]
ds_read_b64_tr_b16 a[120:121],v2 offset:12544
v_fma_f32 v106,v106,s36,v17
v_mfma_f32_16x16x32_bf16 a[212:215],a[124:127],v[40:43],a[212:215]
s_waitcnt lgkmcnt(6)
ds_read_b64_tr_b16 a[122:123],v2 offset:18688
v_fma_f32 v107,v107,s36,v17
v_mfma_f32_16x16x32_bf16 a[216:219],a[128:131],v[40:43],a[216:219]
ds_read_b64_tr_b16 a[124:125],v3 offset:12544
v_fma_f32 v76,v76,s36,v13
v_mfma_f32_16x16x32_bf16 a[220:223],a[132:135],v[40:43],a[220:223]
ds_read_b64_tr_b16 a[126:127],v3 offset:18688
v_fma_f32 v77,v77,s36,v13
v_mfma_f32_16x16x32_bf16 a[172:175],a[132:135],v[56:59],a[172:175]
v_exp_f32 v90,v90
v_mfma_f32_16x16x32_bf16 a[168:171],a[128:131],v[56:59],a[168:171]
v_exp_f32 v91,v91
v_mfma_f32_16x16x32_bf16 v[120:123],a[128:131],v[52:55],v[120:123]
v_cvt_pk_bf16_f32 v29,v90,v91
v_fma_f32 v78,v78,s36,v13
v_mfma_f32_16x16x32_bf16 v[124:127],a[132:135],v[52:55],v[124:127]
v_exp_f32 v96,v96
v_mfma_f32_16x16x32_bf16 v[220:223],a[132:135],v[48:51],v[220:223]
v_exp_f32 v97,v97
v_mfma_f32_16x16x32_bf16 v[216:219],a[128:131],v[48:51],v[216:219]
v_exp_f32 v98,v98
v_mfma_f32_16x16x32_bf16 v[168:171],a[128:131],v[44:47],v[168:171]
ds_read_b64_tr_b16 a[128:129],v4 offset:12544
v_cvt_pk_bf16_f32 v32,v96,v97
v_mfma_f32_16x16x32_bf16 v[172:175],a[132:135],v[44:47],v[172:175]
ds_read_b64_tr_b16 a[130:131],v4 offset:18688
v_fma_f32 v79,v79,s36,v13
v_mfma_f32_16x16x32_bf16 v[176:179],a[136:139],v[44:47],v[176:179]
s_waitcnt lgkmcnt(2)
ds_read_b64_tr_b16 a[132:133],v5 offset:12544
v_fma_f32 v84,v84,s36,v14
v_mfma_f32_16x16x32_bf16 v[180:183],a[140:143],v[44:47],v[180:183]
ds_read_b64_tr_b16 a[134:135],v5 offset:18688
v_fma_f32 v85,v85,s36,v14
v_mfma_f32_16x16x32_bf16 v[228:231],a[140:143],v[48:51],v[228:231]
v_exp_f32 v99,v99
v_mfma_f32_16x16x32_bf16 v[224:227],a[136:139],v[48:51],v[224:227]
v_cvt_pk_bf16_f32 v33,v98,v99
v_fma_f32 v86,v86,s36,v14
v_mfma_f32_16x16x32_bf16 v[128:131],a[136:139],v[52:55],v[128:131]
v_exp_f32 v104,v104
v_mfma_f32_16x16x32_bf16 v[132:135],a[140:143],v[52:55],v[132:135]
v_exp_f32 v105,v105
v_mfma_f32_16x16x32_bf16 a[180:183],a[140:143],v[56:59],a[180:183]
v_exp_f32 v106,v106
v_mfma_f32_16x16x32_bf16 a[176:179],a[136:139],v[56:59],a[176:179]
v_exp_f32 v107,v107
v_mfma_f32_16x16x32_bf16 a[224:227],a[136:139],v[40:43],a[224:227]
v_cvt_pk_bf16_f32 v36,v104,v105
v_cvt_pk_bf16_f32 v37,v106,v107
v_mfma_f32_16x16x32_bf16 a[228:231],a[140:143],v[40:43],a[228:231]
v_exp_f32 v76,v76
v_mfma_f32_16x16x32_bf16 a[232:235],a[144:147],v[40:43],a[232:235]
v_exp_f32 v77,v77
v_mfma_f32_16x16x32_bf16 a[236:239],a[148:151],v[40:43],a[236:239]
v_exp_f32 v78,v78
v_mfma_f32_16x16x32_bf16 a[188:191],a[148:151],v[56:59],a[188:191]
v_exp_f32 v79,v79
v_mfma_f32_16x16x32_bf16 a[184:187],a[144:147],v[56:59],a[184:187]
v_cvt_pk_bf16_f32 v22,v76,v77
v_cvt_pk_bf16_f32 v23,v78,v79
v_mfma_f32_16x16x32_bf16 v[136:139],a[144:147],v[52:55],v[136:139]
v_fma_f32 v87,v87,s36,v14
v_fma_f32 v92,v92,s36,v15
v_mfma_f32_16x16x32_bf16 v[140:143],a[148:151],v[52:55],v[140:143]
v_exp_f32 v84,v84
v_mfma_f32_16x16x32_bf16 v[236:239],a[148:151],v[48:51],v[236:239]
v_exp_f32 v85,v85
v_mfma_f32_16x16x32_bf16 v[232:235],a[144:147],v[48:51],v[232:235]
v_exp_f32 v86,v86
v_mfma_f32_16x16x32_bf16 v[184:187],a[144:147],v[44:47],v[184:187]
v_exp_f32 v87,v87
v_mfma_f32_16x16x32_bf16 v[188:191],a[148:151],v[44:47],v[188:191]
v_cvt_pk_bf16_f32 v26,v84,v85
v_cvt_pk_bf16_f32 v27,v86,v87
v_mfma_f32_16x16x32_bf16 v[192:195],a[120:123],v[44:47],v[192:195]
v_fma_f32 v93,v93,s36,v15
v_fma_f32 v94,v94,s36,v15
v_smfmac_f32_16x16x64_bf16 v[60:63],a[152:155],v[20:27],v18
v_fma_f32 v95,v95,s36,v15
v_mfma_f32_16x16x32_bf16 v[196:199],a[124:127],v[44:47],v[196:199]
s_waitcnt vmcnt(6) lgkmcnt(0)
v_exp_f32 v92,v92
v_mfma_f32_16x16x32_bf16 v[244:247],a[124:127],v[48:51],v[244:247]
s_barrier
v_mfma_f32_16x16x32_bf16 v[240:243],a[120:123],v[48:51],v[240:243]
ds_read_b128 a[136:139],v0 offset:0
v_fma_f32 v100,v100,s36,v16
v_mfma_f32_16x16x32_bf16 v[144:147],a[120:123],v[52:55],v[144:147]
ds_read_b128 a[140:143],v1 offset:0
v_fma_f32 v101,v101,s36,v16
v_mfma_f32_16x16x32_bf16 v[148:151],a[124:127],v[52:55],v[148:151]
ds_read_b128 a[144:147],v0 offset:128
v_fma_f32 v102,v102,s36,v16
v_mfma_f32_16x16x32_bf16 a[196:199],a[124:127],v[56:59],a[196:199]
ds_read_b128 a[148:151],v1 offset:128
v_fma_f32 v103,v103,s36,v16
v_mfma_f32_16x16x32_bf16 a[192:195],a[120:123],v[56:59],a[192:195]
v_exp_f32 v93,v93
v_mfma_f32_16x16x32_bf16 a[240:243],a[120:123],v[40:43],a[240:243]
buffer_load_dwordx4 v6,s[8:11],s21 offen offset:0 lds
v_mfma_f32_16x16x32_bf16 a[244:247],a[124:127],v[40:43],a[244:247]
ds_read_b128 a[120:123],v0 offset:256
v_cvt_pk_bf16_f32 v30,v92,v93
v_mfma_f32_16x16x32_bf16 a[248:251],a[128:131],v[40:43],a[248:251]
ds_read_b128 a[124:127],v1 offset:256
v_fma_f32 v108,v108,s36,v17
v_mfma_f32_16x16x32_bf16 a[252:255],a[132:135],v[40:43],a[252:255]
v_exp_f32 v94,v94
v_mfma_f32_16x16x32_bf16 a[204:207],a[132:135],v[56:59],a[204:207]
v_exp_f32 v95,v95
v_mfma_f32_16x16x32_bf16 a[200:203],a[128:131],v[56:59],a[200:203]
v_cvt_pk_bf16_f32 v31,v94,v95
v_fma_f32 v109,v109,s36,v17
v_mfma_f32_16x16x32_bf16 v[152:155],a[128:131],v[52:55],v[152:155]
v_exp_f32 v100,v100
v_mfma_f32_16x16x32_bf16 v[156:159],a[132:135],v[52:55],v[156:159]
v_exp_f32 v101,v101
v_mfma_f32_16x16x32_bf16 v[252:255],a[132:135],v[48:51],v[252:255]
v_exp_f32 v102,v102
v_mfma_f32_16x16x32_bf16 v[248:251],a[128:131],v[48:51],v[248:251]
v_exp_f32 v103,v103
v_mfma_f32_16x16x32_bf16 v[200:203],a[128:131],v[44:47],v[200:203]
ds_read_b128 a[128:131],v0 offset:6144
v_cvt_pk_bf16_f32 v34,v100,v101
v_mfma_f32_16x16x32_bf16 v[204:207],a[132:135],v[44:47],v[204:207]
buffer_load_dwordx4 v7,s[8:11],s21 offen offset:1024 lds
s_waitcnt lgkmcnt(1)
v_mfma_f32_16x16x32_bf16 v[72:75],a[136:139],a[0:3],0
ds_read_b128 a[132:135],v1 offset:6144
v_cvt_pk_bf16_f32 v35,v102,v103
v_mfma_f32_16x16x32_bf16 v[72:75],a[140:143],a[4:7],v[72:75]
v_fma_f32 v110,v110,s36,v17
v_fma_f32 v111,v111,s36,v17
v_smfmac_f32_16x16x64_bf16 v[64:67],a[152:155],v[28:35],v18
v_mfma_f32_16x16x32_bf16 v[72:75],a[144:147],a[8:11],v[72:75]
v_exp_f32 v108,v108
v_mfma_f32_16x16x32_bf16 v[72:75],a[148:151],a[12:15],v[72:75]
v_exp_f32 v109,v109
v_mfma_f32_16x16x32_bf16 v[72:75],a[120:123],a[16:19],v[72:75]
v_exp_f32 v110,v110
v_mfma_f32_16x16x32_bf16 v[72:75],a[124:127],a[20:23],v[72:75]
v_exp_f32 v111,v111
v_mfma_f32_16x16x32_bf16 v[80:83],a[124:127],a[44:47],0
v_cvt_pk_bf16_f32 v38,v108,v109
v_cvt_pk_bf16_f32 v39,v110,v111
v_mfma_f32_16x16x32_bf16 v[80:83],a[120:123],a[40:43],v[80:83]
v_mfma_f32_16x16x32_bf16 v[80:83],a[148:151],a[36:39],v[80:83]
v_mfma_f32_16x16x32_bf16 v[80:83],a[144:147],a[32:35],v[80:83]
buffer_load_dwordx4 v8,s[8:11],s21 offen offset:2048 lds
v_mfma_f32_16x16x32_bf16 v[80:83],a[140:143],a[28:31],v[80:83]
s_add_u32 s21,s21,12288
v_fma_f32 v72,v72,s36,v13
v_fma_f32 v73,v73,s36,v13
v_mfma_f32_16x16x32_bf16 v[80:83],a[136:139],a[24:27],v[80:83]
s_add_u32 m0,s22,24576
v_fma_f32 v74,v74,s36,v13
v_fma_f32 v75,v75,s36,v13
v_mfma_f32_16x16x32_bf16 v[88:91],a[136:139],a[48:51],0
v_exp_f32 v72,v72
v_mfma_f32_16x16x32_bf16 v[88:91],a[140:143],a[52:55],v[88:91]
v_exp_f32 v73,v73
v_mfma_f32_16x16x32_bf16 v[88:91],a[144:147],a[56:59],v[88:91]
v_fma_f32 v80,v80,s36,v14
v_fma_f32 v81,v81,s36,v14
v_mfma_f32_16x16x32_bf16 v[88:91],a[148:151],a[60:63],v[88:91]
v_fma_f32 v82,v82,s36,v14
v_fma_f32 v83,v83,s36,v14
v_mfma_f32_16x16x32_bf16 v[88:91],a[120:123],a[64:67],v[88:91]
v_exp_f32 v74,v74
v_mfma_f32_16x16x32_bf16 v[88:91],a[124:127],a[68:71],v[88:91]
v_exp_f32 v75,v75
v_mfma_f32_16x16x32_bf16 v[96:99],a[124:127],a[92:95],0
v_exp_f32 v80,v80
v_mfma_f32_16x16x32_bf16 v[96:99],a[120:123],a[88:91],v[96:99]
v_exp_f32 v81,v81
v_mfma_f32_16x16x32_bf16 v[96:99],a[148:151],a[84:87],v[96:99]
v_exp_f32 v82,v82
v_mfma_f32_16x16x32_bf16 v[96:99],a[144:147],a[80:83],v[96:99]
buffer_load_dwordx4 v6,s[4:7],s20 offen offset:0 lds
v_mfma_f32_16x16x32_bf16 v[96:99],a[140:143],a[76:79],v[96:99]
v_fma_f32 v88,v88,s36,v15
v_fma_f32 v89,v89,s36,v15
v_mfma_f32_16x16x32_bf16 v[96:99],a[136:139],a[72:75],v[96:99]
v_exp_f32 v83,v83
v_mfma_f32_16x16x32_bf16 v[104:107],a[136:139],a[96:99],0
ds_read_b128 a[136:139],v0 offset:6272
v_cvt_pk_bf16_f32 v44,v72,v73
v_mfma_f32_16x16x32_bf16 v[104:107],a[140:143],a[100:103],v[104:107]
ds_read_b128 a[140:143],v1 offset:6272
v_cvt_pk_bf16_f32 v45,v74,v75
v_mfma_f32_16x16x32_bf16 v[104:107],a[144:147],a[104:107],v[104:107]
ds_read_b128 a[144:147],v0 offset:6400
v_cvt_pk_bf16_f32 v48,v80,v81
v_mfma_f32_16x16x32_bf16 v[104:107],a[148:151],a[108:111],v[104:107]
ds_read_b128 a[148:151],v1 offset:6400
v_cvt_pk_bf16_f32 v49,v82,v83
v_mfma_f32_16x16x32_bf16 v[104:107],a[120:123],a[112:115],v[104:107]
v_exp_f32 v88,v88
v_mfma_f32_16x16x32_bf16 v[104:107],a[124:127],a[116:119],v[104:107]
s_waitcnt lgkmcnt(4)
v_exp_f32 v89,v89
v_mfma_f32_16x16x32_bf16 v[76:79],a[128:131],a[0:3],0
v_cvt_pk_bf16_f32 v52,v88,v89
v_mfma_f32_16x16x32_bf16 v[76:79],a[132:135],a[4:7],v[76:79]
s_waitcnt lgkmcnt(3)
v_mfma_f32_16x16x32_bf16 v[76:79],a[136:139],a[8:11],v[76:79]
buffer_load_dwordx4 v7,s[4:7],s20 offen offset:1024 lds
s_waitcnt lgkmcnt(2)
v_mfma_f32_16x16x32_bf16 v[76:79],a[140:143],a[12:15],v[76:79]
s_waitcnt lgkmcnt(1)
v_mfma_f32_16x16x32_bf16 v[76:79],a[144:147],a[16:19],v[76:79]
s_waitcnt lgkmcnt(0)
v_mfma_f32_16x16x32_bf16 v[76:79],a[148:151],a[20:23],v[76:79]
v_mfma_f32_16x16x32_bf16 v[84:87],a[148:151],a[44:47],0
v_mfma_f32_16x16x32_bf16 v[84:87],a[144:147],a[40:43],v[84:87]
v_mfma_f32_16x16x32_bf16 v[84:87],a[140:143],a[36:39],v[84:87]
v_mfma_f32_16x16x32_bf16 v[84:87],a[136:139],a[32:35],v[84:87]
v_mfma_f32_16x16x32_bf16 v[84:87],a[132:135],a[28:31],v[84:87]
v_mfma_f32_16x16x32_bf16 v[84:87],a[128:131],a[24:27],v[84:87]
v_mfma_f32_16x16x32_bf16 v[92:95],a[128:131],a[48:51],0
v_mfma_f32_16x16x32_bf16 v[92:95],a[132:135],a[52:55],v[92:95]
buffer_load_dwordx4 v8,s[4:7],s20 offen offset:2048 lds
v_mfma_f32_16x16x32_bf16 v[92:95],a[136:139],a[56:59],v[92:95]
s_add_u32 s20,s20,12288
v_mfma_f32_16x16x32_bf16 v[92:95],a[140:143],a[60:63],v[92:95]
v_mfma_f32_16x16x32_bf16 v[92:95],a[144:147],a[64:67],v[92:95]
v_mfma_f32_16x16x32_bf16 v[92:95],a[148:151],a[68:71],v[92:95]
v_mfma_f32_16x16x32_bf16 v[100:103],a[148:151],a[92:95],0
v_mfma_f32_16x16x32_bf16 v[100:103],a[144:147],a[88:91],v[100:103]
ds_read_b64_tr_b16 a[120:121],v2 offset:24576
v_mfma_f32_16x16x32_bf16 v[100:103],a[140:143],a[84:87],v[100:103]
ds_read_b64_tr_b16 a[122:123],v2 offset:30720
v_mfma_f32_16x16x32_bf16 v[100:103],a[136:139],a[80:83],v[100:103]
ds_read_b64_tr_b16 a[124:125],v3 offset:24576
v_mfma_f32_16x16x32_bf16 v[100:103],a[132:135],a[76:79],v[100:103]
ds_read_b64_tr_b16 a[126:127],v3 offset:30720
v_mfma_f32_16x16x32_bf16 v[100:103],a[128:131],a[72:75],v[100:103]
v_mfma_f32_16x16x32_bf16 v[108:111],a[128:131],a[96:99],0
ds_read_b64_tr_b16 a[128:129],v4 offset:24576
v_mfma_f32_16x16x32_bf16 v[108:111],a[132:135],a[100:103],v[108:111]
ds_read_b64_tr_b16 a[130:131],v4 offset:30720
v_mfma_f32_16x16x32_bf16 v[108:111],a[136:139],a[104:107],v[108:111]
ds_read_b64_tr_b16 a[132:133],v5 offset:24576
v_mfma_f32_16x16x32_bf16 v[108:111],a[140:143],a[108:111],v[108:111]
ds_read_b64_tr_b16 a[134:135],v5 offset:30720
v_mfma_f32_16x16x32_bf16 v[108:111],a[144:147],a[112:115],v[108:111]
v_mfma_f32_16x16x32_bf16 v[108:111],a[148:151],a[116:119],v[108:111]
s_mov_b32 s38,0
s_branch L_loop5
L_tr44:
s_waitcnt vmcnt(42)
s_waitcnt lgkmcnt(3)
v_mfma_f32_16x16x32_bf16 v[160:163],a[120:123],v[20:23],v[160:163]
s_add_u32 m0,s24,0
ds_read_b128 a[0:3],v11 offset:0
v_fma_f32 v82,v82,s36,v14
v_mfma_f32_16x16x32_bf16 v[164:167],a[124:127],v[20:23],v[164:167]
ds_read_b128 a[4:7],v12 offset:0
v_fma_f32 v83,v83,s36,v14
v_mfma_f32_16x16x32_bf16 v[212:215],a[124:127],v[24:27],v[212:215]
ds_read_b128 a[8:11],v11 offset:128
v_fma_f32 v88,v88,s36,v15
v_mfma_f32_16x16x32_bf16 v[208:211],a[120:123],v[24:27],v[208:211]
ds_read_b128 a[12:15],v12 offset:128
v_fma_f32 v89,v89,s36,v15
v_mfma_f32_16x16x32_bf16 v[112:115],a[120:123],v[28:31],v[112:115]
ds_read_b128 a[16:19],v11 offset:256
v_fma_f32 v90,v90,s36,v15
v_mfma_f32_16x16x32_bf16 v[116:119],a[124:127],v[28:31],v[116:119]
ds_read_b128 a[20:23],v12 offset:256
v_fma_f32 v91,v91,s36,v15
ds_read_b64_tr_b16 a[136:137],v2 offset:24704
ds_read_b64_tr_b16 a[138:139],v2 offset:30848
ds_read_b64_tr_b16 a[140:141],v3 offset:24704
ds_read_b64_tr_b16 a[142:143],v3 offset:30848
ds_read_b64_tr_b16 a[144:145],v4 offset:24704
ds_read_b64_tr_b16 a[146:147],v4 offset:30848
ds_read_b64_tr_b16 a[148:149],v5 offset:24704
ds_read_b64_tr_b16 a[150:151],v5 offset:30848
ds_read_b128 a[24:27],v11 offset:6144
v_mfma_f32_16x16x32_bf16 a[164:167],a[124:127],v[32:35],a[164:167]
v_fma_f32 v96,v96,s36,v16
ds_read_b128 a[28:31],v12 offset:6144
v_mfma_f32_16x16x32_bf16 a[160:163],a[120:123],v[32:35],a[160:163]
s_waitcnt lgkmcnt(12)
v_fma_f32 v97,v97,s36,v16
ds_read_b128 a[32:35],v11 offset:6272
v_mfma_f32_16x16x32_bf16 a[168:171],a[128:131],v[32:35],a[168:171]
s_waitcnt lgkmcnt(11)
buffer_load_dwordx4 v6,s[12:15],s28 offen offset:0 nt lds
v_mfma_f32_16x16x32_bf16 a[172:175],a[132:135],v[32:35],a[172:175]
ds_read_b64_tr_b16 a[120:121],v2 offset:24832
ds_read_b128 a[36:39],v12 offset:6272
v_mfma_f32_16x16x32_bf16 v[124:127],a[132:135],v[28:31],v[124:127]
v_fma_f32 v98,v98,s36,v16
ds_read_b64_tr_b16 a[124:125],v3 offset:24832
ds_read_b64_tr_b16 a[126:127],v3 offset:30976
ds_read_b64_tr_b16 a[122:123],v2 offset:30976
ds_read_b128 a[40:43],v11 offset:6400
v_mfma_f32_16x16x32_bf16 v[120:123],a[128:131],v[28:31],v[120:123]
v_fma_f32 v99,v99,s36,v16
ds_read_b128 a[44:47],v12 offset:6400
v_mfma_f32_16x16x32_bf16 v[216:219],a[128:131],v[24:27],v[216:219]
buffer_load_dwordx4 v7,s[12:15],s28 offen offset:1024 nt lds
v_mfma_f32_16x16x32_bf16 v[220:223],a[132:135],v[24:27],v[220:223]
v_fma_f32 v76,v76,s36,v13
v_fma_f32 v77,v77,s36,v13
v_mfma_f32_16x16x32_bf16 v[172:175],a[132:135],v[20:23],v[172:175]
ds_read_b64_tr_b16 a[132:133],v5 offset:24832
v_fma_f32 v78,v78,s36,v13
v_mfma_f32_16x16x32_bf16 v[168:171],a[128:131],v[20:23],v[168:171]
s_waitcnt lgkmcnt(6)
ds_read_b64_tr_b16 a[128:129],v4 offset:24832
v_fma_f32 v79,v79,s36,v13
v_mfma_f32_16x16x32_bf16 v[176:179],a[136:139],v[20:23],v[176:179]
ds_read_b64_tr_b16 a[130:131],v4 offset:30976
v_fma_f32 v84,v84,s36,v14
v_mfma_f32_16x16x32_bf16 v[180:183],a[140:143],v[20:23],v[180:183]
ds_read_b64_tr_b16 a[134:135],v5 offset:30976
v_fma_f32 v85,v85,s36,v14
v_mfma_f32_16x16x32_bf16 v[228:231],a[140:143],v[24:27],v[228:231]
v_fma_f32 v86,v86,s36,v14
v_fma_f32 v87,v87,s36,v14
v_mfma_f32_16x16x32_bf16 v[224:227],a[136:139],v[24:27],v[224:227]
buffer_load_dwordx4 v8,s[12:15],s28 offen offset:2048 nt lds
v_mfma_f32_16x16x32_bf16 v[128:131],a[136:139],v[28:31],v[128:131]
s_add_u32 s28,s28,3072
v_fma_f32 v92,v92,s36,v15
v_fma_f32 v93,v93,s36,v15
v_mfma_f32_16x16x32_bf16 v[132:135],a[140:143],v[28:31],v[132:135]
s_add_u32 m0,s24,3072
v_fma_f32 v94,v94,s36,v15
v_fma_f32 v95,v95,s36,v15
v_mfma_f32_16x16x32_bf16 a[180:183],a[140:143],v[32:35],a[180:183]
v_fma_f32 v100,v100,s36,v16
v_fma_f32 v101,v101,s36,v16
v_mfma_f32_16x16x32_bf16 a[176:179],a[136:139],v[32:35],a[176:179]
v_fma_f32 v102,v102,s36,v16
v_fma_f32 v103,v103,s36,v16
v_mfma_f32_16x16x32_bf16 a[184:187],a[144:147],v[32:35],a[184:187]
v_exp_f32 v82,v82
v_mfma_f32_16x16x32_bf16 a[188:191],a[148:151],v[32:35],a[188:191]
v_exp_f32 v83,v83
v_mfma_f32_16x16x32_bf16 v[140:143],a[148:151],v[28:31],v[140:143]
v_exp_f32 v88,v88
v_mfma_f32_16x16x32_bf16 v[136:139],a[144:147],v[28:31],v[136:139]
buffer_load_dwordx4 v6,s[12:15],s28 offen offset:0 nt lds
v_mfma_f32_16x16x32_bf16 v[232:235],a[144:147],v[24:27],v[232:235]
v_exp_f32 v89,v89
v_mfma_f32_16x16x32_bf16 v[236:239],a[148:151],v[24:27],v[236:239]
v_exp_f32 v90,v90
v_mfma_f32_16x16x32_bf16 v[188:191],a[148:151],v[20:23],v[188:191]
v_exp_f32 v91,v91
v_mfma_f32_16x16x32_bf16 v[184:187],a[144:147],v[20:23],v[184:187]
s_waitcnt lgkmcnt(0)
v_exp_f32 v96,v96
v_mfma_f32_16x16x32_bf16 v[192:195],a[120:123],v[20:23],v[192:195]
v_exp_f32 v97,v97
v_mfma_f32_16x16x32_bf16 v[196:199],a[124:127],v[20:23],v[196:199]
v_exp_f32 v98,v98
v_mfma_f32_16x16x32_bf16 v[244:247],a[124:127],v[24:27],v[244:247]
v_exp_f32 v99,v99
v_mfma_f32_16x16x32_bf16 v[240:243],a[120:123],v[24:27],v[240:243]
buffer_load_dwordx4 v7,s[12:15],s28 offen offset:1024 nt lds
v_mfma_f32_16x16x32_bf16 v[144:147],a[120:123],v[28:31],v[144:147]
v_exp_f32 v76,v76
v_mfma_f32_16x16x32_bf16 v[148:151],a[124:127],v[28:31],v[148:151]
v_exp_f32 v77,v77
v_mfma_f32_16x16x32_bf16 a[196:199],a[124:127],v[32:35],a[196:199]
v_exp_f32 v78,v78
v_mfma_f32_16x16x32_bf16 a[192:195],a[120:123],v[32:35],a[192:195]
v_exp_f32 v79,v79
v_mfma_f32_16x16x32_bf16 a[200:203],a[128:131],v[32:35],a[200:203]
v_exp_f32 v84,v84
v_mfma_f32_16x16x32_bf16 a[204:207],a[132:135],v[32:35],a[204:207]
v_exp_f32 v85,v85
v_mfma_f32_16x16x32_bf16 v[156:159],a[132:135],v[28:31],v[156:159]
v_exp_f32 v86,v86
v_mfma_f32_16x16x32_bf16 v[152:155],a[128:131],v[28:31],v[152:155]
buffer_load_dwordx4 v8,s[12:15],s28 offen offset:2048 nt lds
s_waitcnt vmcnt(20)
s_barrier
v_mfma_f32_16x16x32_bf16 v[248:251],a[128:131],v[24:27],v[248:251]
s_add_u32 s28,s28,3072
ds_read_b64_tr_b16 a[136:137],v2 offset:0
v_exp_f32 v87,v87
v_mfma_f32_16x16x32_bf16 v[252:255],a[132:135],v[24:27],v[252:255]
s_add_u32 m0,s22,0
ds_read_b64_tr_b16 a[138:139],v2 offset:6144
buffer_load_dwordx4 v6,s[4:7],s25 offen offset:0 lds
v_mfma_f32_16x16x32_bf16 v[204:207],a[132:135],v[20:23],v[204:207]
buffer_load_dwordx4 v7,s[4:7],s25 offen offset:1024 lds
v_mfma_f32_16x16x32_bf16 v[200:203],a[128:131],v[20:23],v[200:203]
buffer_load_dwordx4 v8,s[4:7],s25 offen offset:2048 lds
ds_read_b64_tr_b16 a[140:141],v3 offset:0
ds_read_b64_tr_b16 a[142:143],v3 offset:6144
ds_read_b64_tr_b16 a[144:145],v4 offset:0
ds_read_b64_tr_b16 a[146:147],v4 offset:6144
ds_read_b64_tr_b16 a[148:149],v5 offset:0
ds_read_b64_tr_b16 a[150:151],v5 offset:6144
v_exp_f32 v92,v92
v_exp_f32 v93,v93
v_exp_f32 v94,v94
v_exp_f32 v95,v95
v_exp_f32 v100,v100
v_exp_f32 v101,v101
v_exp_f32 v102,v102
v_exp_f32 v103,v103
v_cvt_pk_bf16_f32 v49,v82,v83
v_cvt_pk_bf16_f32 v52,v88,v89
v_cvt_pk_bf16_f32 v53,v90,v91
v_cvt_pk_bf16_f32 v56,v96,v97
v_cvt_pk_bf16_f32 v57,v98,v99
v_cvt_pk_bf16_f32 v46,v76,v77
v_cvt_pk_bf16_f32 v47,v78,v79
v_cvt_pk_bf16_f32 v50,v84,v85
v_cvt_pk_bf16_f32 v51,v86,v87
v_cvt_pk_bf16_f32 v54,v92,v93
v_cvt_pk_bf16_f32 v55,v94,v95
v_smfmac_f32_16x16x64_bf16 v[60:63],a[152:155],v[44:51],v18
v_cvt_pk_bf16_f32 v58,v100,v101
v_cvt_pk_bf16_f32 v59,v102,v103
v_subrev_u32 v10,18432,v10
s_nop 0
v_smfmac_f32_16x16x64_bf16 v[64:67],a[152:155],v[52:59],v18
s_waitcnt lgkmcnt(0)
v_mfma_f32_16x16x32_bf16 v[160:163],a[136:139],v[44:47],v[160:163]
s_add_u32 s87,s42,18432
ds_read_b64_tr_b16 a[120:121],v2 offset:128
v_mbcnt_lo_u32_b32 v39,-1,0
v_mfma_f32_16x16x32_bf16 v[164:167],a[140:143],v[44:47],v[164:167]
ds_read_b64_tr_b16 a[122:123],v2 offset:6272
v_mbcnt_hi_u32_b32 v39,-1,v39
v_mfma_f32_16x16x32_bf16 v[212:215],a[140:143],v[48:51],v[212:215]
ds_read_b64_tr_b16 a[124:125],v3 offset:128
v_and_b32 v38,7,v39
v_mfma_f32_16x16x32_bf16 v[208:211],a[136:139],v[48:51],v[208:211]
ds_read_b64_tr_b16 a[126:127],v3 offset:6272
v_add_f32 v60,v60,v61
v_mfma_f32_16x16x32_bf16 v[112:115],a[136:139],v[52:55],v[112:115]
ds_read_b64_tr_b16 a[128:129],v4 offset:128
v_add_f32 v62,v62,v63
v_mfma_f32_16x16x32_bf16 v[116:119],a[140:143],v[52:55],v[116:119]
ds_read_b64_tr_b16 a[130:131],v4 offset:6272
ds_read_b64_tr_b16 a[132:133],v5 offset:128
ds_read_b64_tr_b16 a[134:135],v5 offset:6272
v_mfma_f32_16x16x32_bf16 a[164:167],a[140:143],v[56:59],a[164:167]
ds_read_b64_tr_b16 a[140:141],v3 offset:256
v_add_f32 v64,v64,v65
v_mfma_f32_16x16x32_bf16 a[160:163],a[136:139],v[56:59],a[160:163]
ds_read_b64_tr_b16 a[136:137],v2 offset:256
v_add_f32 v66,v66,v67
v_mfma_f32_16x16x32_bf16 a[168:171],a[144:147],v[56:59],a[168:171]
ds_read_b64_tr_b16 a[138:139],v2 offset:6400
v_max3_f32 v19,v60,v62,v64
v_mfma_f32_16x16x32_bf16 a[172:175],a[148:151],v[56:59],a[172:175]
ds_read_b64_tr_b16 a[142:143],v3 offset:6400
v_max_f32 v19,v19,v66
v_mfma_f32_16x16x32_bf16 v[124:127],a[148:151],v[52:55],v[124:127]
v_rcp_f32 v66,v66
v_mfma_f32_16x16x32_bf16 v[120:123],a[144:147],v[52:55],v[120:123]
v_accvgpr_read_b32 v80,a164
v_accvgpr_read_b32 v81,a165
v_mfma_f32_16x16x32_bf16 v[216:219],a[144:147],v[48:51],v[216:219]
v_accvgpr_read_b32 v82,a166
v_accvgpr_read_b32 v83,a167
v_mfma_f32_16x16x32_bf16 v[220:223],a[148:151],v[48:51],v[220:223]
v_accvgpr_read_b32 v72,a160
v_accvgpr_read_b32 v73,a161
v_mfma_f32_16x16x32_bf16 v[172:175],a[148:151],v[44:47],v[172:175]
ds_read_b64_tr_b16 a[148:149],v5 offset:256
v_accvgpr_read_b32 v74,a162
v_mfma_f32_16x16x32_bf16 v[168:171],a[144:147],v[44:47],v[168:171]
s_waitcnt lgkmcnt(2)
ds_read_b64_tr_b16 a[144:145],v4 offset:256
v_accvgpr_read_b32 v75,a163
v_mfma_f32_16x16x32_bf16 v[176:179],a[120:123],v[44:47],v[176:179]
ds_read_b64_tr_b16 a[146:147],v4 offset:6400
v_accvgpr_read_b32 v88,a168
v_mfma_f32_16x16x32_bf16 v[180:183],a[124:127],v[44:47],v[180:183]
ds_read_b64_tr_b16 a[150:151],v5 offset:6400
v_accvgpr_read_b32 v89,a169
v_mfma_f32_16x16x32_bf16 v[228:231],a[124:127],v[48:51],v[228:231]
v_accvgpr_read_b32 v90,a170
v_accvgpr_read_b32 v91,a171
v_mfma_f32_16x16x32_bf16 v[224:227],a[120:123],v[48:51],v[224:227]
v_accvgpr_read_b32 v96,a172
v_accvgpr_read_b32 v97,a173
v_mfma_f32_16x16x32_bf16 v[128:131],a[120:123],v[52:55],v[128:131]
v_accvgpr_read_b32 v98,a174
v_accvgpr_read_b32 v99,a175
v_mfma_f32_16x16x32_bf16 v[132:135],a[124:127],v[52:55],v[132:135]
v_cmp_ngt_f32 vcc,s37,v19
v_lshrrev_b32 v19,5,v39
v_mfma_f32_16x16x32_bf16 a[180:183],a[124:127],v[56:59],a[180:183]
v_xor_b32 v38,v38,v19
v_and_b32 v19,15,v39
v_mfma_f32_16x16x32_bf16 a[176:179],a[120:123],v[56:59],a[176:179]
s_cmp_lg_u64 vcc,0
v_lshl_add_u32 v19,v19,7,s24
v_lshl_add_u32 v19,v38,4,v19
v_mfma_f32_16x16x32_bf16 a[184:187],a[128:131],v[56:59],a[184:187]
s_cselect_b32 s62,s32,0
v_bfe_u32 v38,v39,4,1
v_lshl_add_u32 v36,v38,3,v19
v_mfma_f32_16x16x32_bf16 a[188:191],a[132:135],v[56:59],a[188:191]
s_or_b32 s31,s31,s62
v_xor_b32 v37,32,v36
v_bfe_u32 v19,v39,3,1
v_mfma_f32_16x16x32_bf16 v[140:143],a[132:135],v[52:55],v[140:143]
s_lshl_b32 s32,s32,1
v_xor_b32 v38,64,v36
v_xor_b32 v39,96,v36
v_lshlrev_b32 v19,11,v19
v_accvgpr_read_b32 v84,a180
v_accvgpr_read_b32 v85,a181
v_pk_mul_f32 v[72:73],v[72:73],v[66:67] op_sel_hi:[1,0]
v_pk_mul_f32 v[74:75],v[74:75],v[66:67] op_sel_hi:[1,0]
v_pk_mul_f32 v[80:81],v[80:81],v[66:67] op_sel_hi:[1,0]
v_pk_mul_f32 v[82:83],v[82:83],v[66:67] op_sel_hi:[1,0]
v_pk_mul_f32 v[84:85],v[84:85],v[66:67] op_sel_hi:[1,0]
v_accvgpr_read_b32 v86,a182
v_accvgpr_read_b32 v87,a183
v_pk_mul_f32 v[86:87],v[86:87],v[66:67] op_sel_hi:[1,0]
v_accvgpr_read_b32 v76,a176
v_accvgpr_read_b32 v77,a177
v_pk_mul_f32 v[76:77],v[76:77],v[66:67] op_sel_hi:[1,0]
v_accvgpr_read_b32 v78,a178
v_accvgpr_read_b32 v79,a179
v_pk_mul_f32 v[78:79],v[78:79],v[66:67] op_sel_hi:[1,0]
v_accvgpr_read_b32 v92,a184
v_accvgpr_read_b32 v93,a185
v_mfma_f32_16x16x32_bf16 v[136:139],a[128:131],v[52:55],v[136:139]
s_add_u32 m0,s23,0
v_accvgpr_read_b32 v94,a186
v_accvgpr_read_b32 v95,a187
v_accvgpr_read_b32 v100,a188
v_accvgpr_read_b32 v101,a189
v_accvgpr_read_b32 v102,a190
v_pk_mul_f32 v[88:89],v[88:89],v[66:67] op_sel_hi:[1,0]
v_pk_mul_f32 v[90:91],v[90:91],v[66:67] op_sel_hi:[1,0]
v_pk_mul_f32 v[92:93],v[92:93],v[66:67] op_sel_hi:[1,0]
v_pk_mul_f32 v[94:95],v[94:95],v[66:67] op_sel_hi:[1,0]
v_accvgpr_read_b32 v103,a191
v_cvt_pk_bf16_f32 v72,v72,v73
v_mfma_f32_16x16x32_bf16 v[232:235],a[128:131],v[48:51],v[232:235]
v_cvt_pk_bf16_f32 v76,v76,v77
v_cvt_pk_bf16_f32 v80,v80,v81
v_cvt_pk_bf16_f32 v84,v84,v85
v_cvt_pk_bf16_f32 v73,v74,v75
v_cvt_pk_bf16_f32 v77,v78,v79
ds_write2st64_b64 v36,v[72:73],v[76:77] offset0:36 offset1:40
v_pk_mul_f32 v[96:97],v[96:97],v[66:67] op_sel_hi:[1,0]
v_pk_mul_f32 v[98:99],v[98:99],v[66:67] op_sel_hi:[1,0]
v_pk_mul_f32 v[100:101],v[100:101],v[66:67] op_sel_hi:[1,0]
v_pk_mul_f32 v[102:103],v[102:103],v[66:67] op_sel_hi:[1,0]
v_cvt_pk_bf16_f32 v88,v88,v89
v_cvt_pk_bf16_f32 v92,v92,v93
v_mfma_f32_16x16x32_bf16 v[236:239],a[132:135],v[48:51],v[236:239]
v_cvt_pk_bf16_f32 v81,v82,v83
v_cvt_pk_bf16_f32 v85,v86,v87
v_mfma_f32_16x16x32_bf16 v[188:191],a[132:135],v[44:47],v[188:191]
v_cvt_pk_bf16_f32 v96,v96,v97
v_cvt_pk_bf16_f32 v100,v100,v101
v_mfma_f32_16x16x32_bf16 v[184:187],a[128:131],v[44:47],v[184:187]
ds_write2st64_b64 v37,v[80:81],v[84:85] offset0:36 offset1:40
v_mfma_f32_16x16x32_bf16 v[192:195],a[136:139],v[44:47],v[192:195]
s_waitcnt lgkmcnt(1)
v_cvt_pk_bf16_f32 v89,v90,v91
v_cvt_pk_bf16_f32 v93,v94,v95
v_mfma_f32_16x16x32_bf16 v[196:199],a[140:143],v[44:47],v[196:199]
v_cvt_pk_bf16_f32 v97,v98,v99
v_cvt_pk_bf16_f32 v101,v102,v103
v_mfma_f32_16x16x32_bf16 v[244:247],a[140:143],v[48:51],v[244:247]
v_rcp_f32 v62,v62
v_mfma_f32_16x16x32_bf16 v[240:243],a[136:139],v[48:51],v[240:243]
ds_write2st64_b64 v38,v[88:89],v[92:93] offset0:36 offset1:40
v_mfma_f32_16x16x32_bf16 v[144:147],a[136:139],v[52:55],v[144:147]
v_rcp_f32 v64,v64
v_mfma_f32_16x16x32_bf16 v[148:151],a[140:143],v[52:55],v[148:151]
v_rcp_f32 v60,v60
v_mfma_f32_16x16x32_bf16 a[196:199],a[140:143],v[56:59],a[196:199]
v_mfma_f32_16x16x32_bf16 a[192:195],a[136:139],v[56:59],a[192:195]
ds_write2st64_b64 v39,v[96:97],v[100:101] offset0:36 offset1:40
v_mfma_f32_16x16x32_bf16 a[200:203],a[144:147],v[56:59],a[200:203]
v_mfma_f32_16x16x32_bf16 a[204:207],a[148:151],v[56:59],a[204:207]
ds_read_b128 v[104:107],v10 offset:18432
v_mfma_f32_16x16x32_bf16 v[156:159],a[148:151],v[52:55],v[156:159]
s_waitcnt vmcnt(15)
ds_read_b128 a[48:51],v11 offset:12288
v_accvgpr_read_b32 v84,a196
ds_read_b128 a[52:55],v12 offset:12288
v_accvgpr_read_b32 v85,a197
ds_read_b128 a[56:59],v11 offset:12416
v_pk_mul_f32 v[84:85],v[84:85],v[66:67] op_sel_hi:[1,0]
ds_read_b128 a[60:63],v12 offset:12416
v_accvgpr_read_b32 v86,a198
ds_read_b128 a[64:67],v11 offset:12544
v_accvgpr_read_b32 v87,a199
ds_read_b128 a[68:71],v12 offset:12544
v_pk_mul_f32 v[86:87],v[86:87],v[66:67] op_sel_hi:[1,0]
ds_read_b128 v[108:111],v10 offset:19456
s_waitcnt lgkmcnt(7)
buffer_store_dwordx4 v[104:107],v9,s[16:19],s87 offen offset:0 nt
ds_read_b128 v[72:75],v10 offset:20480
v_accvgpr_read_b32 v80,a192
ds_read_b128 v[76:79],v10 offset:21504
v_accvgpr_read_b32 v81,a193
v_pk_mul_f32 v[80:81],v[80:81],v[66:67] op_sel_hi:[1,0]
v_accvgpr_read_b32 v82,a194
v_accvgpr_read_b32 v83,a195
v_pk_mul_f32 v[82:83],v[82:83],v[66:67] op_sel_hi:[1,0]
v_accvgpr_read_b32 v88,a200
v_accvgpr_read_b32 v89,a201
v_mfma_f32_16x16x32_bf16 v[152:155],a[144:147],v[52:55],v[152:155]
v_accvgpr_read_b32 v90,a202
v_accvgpr_read_b32 v91,a203
v_accvgpr_read_b32 v92,a204
v_accvgpr_read_b32 v93,a205
v_accvgpr_read_b32 v94,a206
v_pk_mul_f32 v[88:89],v[88:89],v[66:67] op_sel_hi:[1,0]
v_pk_mul_f32 v[90:91],v[90:91],v[66:67] op_sel_hi:[1,0]
v_accvgpr_read_b32 v95,a207
v_cvt_pk_bf16_f32 v80,v80,v81
v_mfma_f32_16x16x32_bf16 v[248:251],a[144:147],v[48:51],v[248:251]
s_waitcnt lgkmcnt(1)
v_cvt_pk_bf16_f32 v81,v82,v83
ds_write_b64 v36,v[80:81] offset:18432
buffer_store_dwordx4 v[108:111],v9,s[16:19],s87 offen offset:3072 nt
v_pk_mul_f32 v[92:93],v[92:93],v[66:67] op_sel_hi:[1,0]
v_pk_mul_f32 v[94:95],v[94:95],v[66:67] op_sel_hi:[1,0]
v_pk_mul_f32 v[208:209],v[208:209],v[62:63] op_sel_hi:[1,0]
v_pk_mul_f32 v[210:211],v[210:211],v[62:63] op_sel_hi:[1,0]
v_pk_mul_f32 v[224:225],v[224:225],v[62:63] op_sel_hi:[1,0]
v_pk_mul_f32 v[226:227],v[226:227],v[62:63] op_sel_hi:[1,0]
v_pk_mul_f32 v[212:213],v[212:213],v[62:63] op_sel_hi:[1,0]
v_pk_mul_f32 v[214:215],v[214:215],v[62:63] op_sel_hi:[1,0]
v_pk_mul_f32 v[228:229],v[228:229],v[62:63] op_sel_hi:[1,0]
v_pk_mul_f32 v[230:231],v[230:231],v[62:63] op_sel_hi:[1,0]
v_pk_mul_f32 v[216:217],v[216:217],v[62:63] op_sel_hi:[1,0]
buffer_store_dwordx4 v[72:75],v9,s[16:19],s87 offen offset:128 nt
v_pk_mul_f32 v[218:219],v[218:219],v[62:63] op_sel_hi:[1,0]
v_pk_mul_f32 v[232:233],v[232:233],v[62:63] op_sel_hi:[1,0]
v_pk_mul_f32 v[234:235],v[234:235],v[62:63] op_sel_hi:[1,0]
v_pk_mul_f32 v[220:221],v[220:221],v[62:63] op_sel_hi:[1,0]
v_pk_mul_f32 v[222:223],v[222:223],v[62:63] op_sel_hi:[1,0]
v_pk_mul_f32 v[236:237],v[236:237],v[62:63] op_sel_hi:[1,0]
v_pk_mul_f32 v[238:239],v[238:239],v[62:63] op_sel_hi:[1,0]
v_add_u32 v36,v36,v19
v_cvt_pk_bf16_f32 v84,v84,v85
v_mfma_f32_16x16x32_bf16 v[252:255],a[148:151],v[48:51],v[252:255]
v_cvt_pk_bf16_f32 v88,v88,v89
v_cvt_pk_bf16_f32 v85,v86,v87
v_mfma_f32_16x16x32_bf16 v[204:207],a[148:151],v[44:47],v[204:207]
s_waitcnt lgkmcnt(0)
ds_write_b64 v37,v[84:85] offset:18432
buffer_store_dwordx4 v[76:79],v9,s[16:19],s87 offen offset:3200 nt
v_pk_mul_f32 v[240:241],v[240:241],v[62:63] op_sel_hi:[1,0]
v_pk_mul_f32 v[242:243],v[242:243],v[62:63] op_sel_hi:[1,0]
v_pk_mul_f32 v[112:113],v[112:113],v[64:65] op_sel_hi:[1,0]
v_pk_mul_f32 v[114:115],v[114:115],v[64:65] op_sel_hi:[1,0]
v_add_u32 v37,v37,v19
v_cvt_pk_bf16_f32 v89,v90,v91
v_mfma_f32_16x16x32_bf16 v[200:203],a[144:147],v[44:47],v[200:203]
v_cvt_pk_bf16_f32 v92,v92,v93
ds_write_b64 v38,v[88:89] offset:18432
v_add_u32 v38,v38,v19
v_cvt_pk_bf16_f32 v93,v94,v95
v_cvt_pk_bf16_f32 v208,v208,v209
v_cvt_pk_bf16_f32 v224,v224,v225
ds_write_b64 v39,v[92:93] offset:18432
ds_read_b128 v[96:99],v10 offset:18432
v_add_u32 v39,v39,v19
ds_read_b128 v[100:103],v10 offset:19456
v_cvt_pk_bf16_f32 v212,v212,v213
v_cvt_pk_bf16_f32 v228,v228,v229
v_cvt_pk_bf16_f32 v209,v210,v211
v_cvt_pk_bf16_f32 v225,v226,v227
ds_write2st64_b64 v36,v[208:209],v[224:225] offset0:12 offset1:14
v_cvt_pk_bf16_f32 v216,v216,v217
v_cvt_pk_bf16_f32 v232,v232,v233
v_cvt_pk_bf16_f32 v213,v214,v215
v_cvt_pk_bf16_f32 v229,v230,v231
v_cvt_pk_bf16_f32 v220,v220,v221
v_cvt_pk_bf16_f32 v236,v236,v237
v_cvt_pk_bf16_f32 v217,v218,v219
v_cvt_pk_bf16_f32 v233,v234,v235
s_waitcnt vmcnt(4)
s_barrier
s_waitcnt lgkmcnt(2)
buffer_store_dwordx4 v[96:99],v9,s[16:19],s87 offen offset:256 nt
ds_read_b128 a[120:123],v0 offset:0
v_cvt_pk_bf16_f32 v240,v240,v241
ds_read_b128 a[124:127],v1 offset:0
v_cvt_pk_bf16_f32 v112,v112,v113
ds_read_b128 a[128:131],v0 offset:128
v_cvt_pk_bf16_f32 v221,v222,v223
ds_write2st64_b64 v37,v[212:213],v[228:229] offset0:12 offset1:14
v_cvt_pk_bf16_f32 v237,v238,v239
v_cvt_pk_bf16_f32 v241,v242,v243
v_cvt_pk_bf16_f32 v113,v114,v115
buffer_load_dwordx4 v6,s[8:11],s25 offen offset:0 lds
ds_read_b128 a[132:135],v1 offset:128
s_waitcnt lgkmcnt(5)
buffer_store_dwordx4 v[100:103],v9,s[16:19],s87 offen offset:3328 nt
ds_read_b128 a[136:139],v0 offset:256
v_mov_b32 v66,0
ds_read_b128 a[140:143],v1 offset:256
s_waitcnt lgkmcnt(5)
v_mfma_f32_16x16x32_bf16 v[72:75],a[120:123],a[0:3],0
v_mov_b32 v67,0
ds_read_b128 a[144:147],v0 offset:6144
v_mfma_f32_16x16x32_bf16 v[72:75],a[124:127],a[4:7],v[72:75]
ds_write2st64_b64 v38,v[216:217],v[232:233] offset0:12 offset1:14
v_pk_mul_f32 v[244:245],v[244:245],v[62:63] op_sel_hi:[1,0]
v_pk_mul_f32 v[246:247],v[246:247],v[62:63] op_sel_hi:[1,0]
v_pk_mul_f32 v[116:117],v[116:117],v[64:65] op_sel_hi:[1,0]
buffer_load_dwordx4 v7,s[8:11],s25 offen offset:1024 lds
ds_read_b128 a[148:151],v1 offset:6144
v_pk_mul_f32 v[118:119],v[118:119],v[64:65] op_sel_hi:[1,0]
v_cvt_pk_bf16_f32 v244,v244,v245
v_cvt_pk_bf16_f32 v116,v116,v117
s_waitcnt lgkmcnt(4)
v_mfma_f32_16x16x32_bf16 v[72:75],a[128:131],a[8:11],v[72:75]
ds_write2st64_b64 v39,v[220:221],v[236:237] offset0:12 offset1:14
v_mfma_f32_16x16x32_bf16 v[72:75],a[132:135],a[12:15],v[72:75]
v_cvt_pk_bf16_f32 v245,v246,v247
v_cvt_pk_bf16_f32 v117,v118,v119
v_mfma_f32_16x16x32_bf16 v[72:75],a[136:139],a[16:19],v[72:75]
s_waitcnt lgkmcnt(2)
v_mfma_f32_16x16x32_bf16 v[72:75],a[140:143],a[20:23],v[72:75]
ds_write2st64_b64 v36,v[240:241],v[112:113] offset0:16 offset1:24
v_pk_mul_f32 v[248:249],v[248:249],v[62:63] op_sel_hi:[1,0]
v_pk_mul_f32 v[250:251],v[250:251],v[62:63] op_sel_hi:[1,0]
v_pk_mul_f32 v[120:121],v[120:121],v[64:65] op_sel_hi:[1,0]
buffer_load_dwordx4 v8,s[8:11],s25 offen offset:2048 lds
v_pk_mul_f32 v[122:123],v[122:123],v[64:65] op_sel_hi:[1,0]
v_cvt_pk_bf16_f32 v248,v248,v249
v_cvt_pk_bf16_f32 v120,v120,v121
v_mfma_f32_16x16x32_bf16 v[80:83],a[140:143],a[44:47],0
s_waitcnt vmcnt(12)
ds_read_b128 a[72:75],v11 offset:0
v_max3_f32 v44,v72,v73,v74
v_mfma_f32_16x16x32_bf16 v[80:83],a[136:139],a[40:43],v[80:83]
s_mov_b32 s27,s42
ds_read_b128 a[76:79],v12 offset:0
v_cvt_pk_bf16_f32 v249,v250,v251
v_mfma_f32_16x16x32_bf16 v[80:83],a[132:135],a[36:39],v[80:83]
s_mov_b32 s42,s41
ds_read_b128 a[80:83],v11 offset:128
v_cvt_pk_bf16_f32 v121,v122,v123
ds_read_b128 a[84:87],v12 offset:128
v_pk_mul_f32 v[252:253],v[252:253],v[62:63] op_sel_hi:[1,0]
ds_read_b128 a[88:91],v11 offset:256
v_pk_mul_f32 v[254:255],v[254:255],v[62:63] op_sel_hi:[1,0]
ds_read_b128 a[92:95],v12 offset:256
v_pk_mul_f32 v[124:125],v[124:125],v[64:65] op_sel_hi:[1,0]
ds_write2st64_b64 v37,v[244:245],v[116:117] offset0:16 offset1:24
v_pk_mul_f32 v[126:127],v[126:127],v[64:65] op_sel_hi:[1,0]
v_cvt_pk_bf16_f32 v252,v252,v253
v_cvt_pk_bf16_f32 v124,v124,v125
v_mfma_f32_16x16x32_bf16 v[80:83],a[128:131],a[32:35],v[80:83]
s_add_u32 s69,s69,1
v_cvt_pk_bf16_f32 v253,v254,v255
v_cvt_pk_bf16_f32 v125,v126,v127
v_mfma_f32_16x16x32_bf16 v[80:83],a[124:127],a[28:31],v[80:83]
s_lshl_b32 s62,s69,5
v_mov_b32 v62,0
v_mov_b32 v63,0
v_mfma_f32_16x16x32_bf16 v[80:83],a[120:123],a[24:27],v[80:83]
s_add_u32 s62,s62,s34
ds_write2st64_b64 v38,v[248:249],v[120:121] offset0:16 offset1:24
v_pk_mul_f32 v[128:129],v[128:129],v[64:65] op_sel_hi:[1,0]
v_pk_mul_f32 v[130:131],v[130:131],v[64:65] op_sel_hi:[1,0]
v_pk_mul_f32 v[144:145],v[144:145],v[64:65] op_sel_hi:[1,0]
v_pk_mul_f32 v[146:147],v[146:147],v[64:65] op_sel_hi:[1,0]
v_cvt_pk_bf16_f32 v128,v128,v129
v_cvt_pk_bf16_f32 v144,v144,v145
v_mfma_f32_16x16x32_bf16 v[88:91],a[120:123],a[48:51],0
s_mul_i32 s63,s62,171
ds_read_b128 a[120:123],v0 offset:6272
v_max3_f32 v48,v80,v81,v82
v_mfma_f32_16x16x32_bf16 v[88:91],a[124:127],a[52:55],v[88:91]
s_lshr_b32 s63,s63,9
ds_read_b128 a[124:127],v1 offset:6272
v_cvt_pk_bf16_f32 v129,v130,v131
v_mfma_f32_16x16x32_bf16 v[88:91],a[128:131],a[56:59],v[88:91]
s_mul_i32 s64,s63,3
ds_write2st64_b64 v39,v[252:253],v[124:125] offset0:16 offset1:24
v_pk_mul_f32 v[132:133],v[132:133],v[64:65] op_sel_hi:[1,0]
v_pk_mul_f32 v[134:135],v[134:135],v[64:65] op_sel_hi:[1,0]
v_pk_mul_f32 v[148:149],v[148:149],v[64:65] op_sel_hi:[1,0]
ds_read_b128 a[128:131],v0 offset:6400
v_pk_mul_f32 v[150:151],v[150:151],v[64:65] op_sel_hi:[1,0]
v_cvt_pk_bf16_f32 v145,v146,v147
v_cvt_pk_bf16_f32 v132,v132,v133
v_mfma_f32_16x16x32_bf16 v[88:91],a[132:135],a[60:63],v[88:91]
s_sub_u32 s62,s62,s64
ds_read_b128 a[132:135],v1 offset:6400
v_cvt_pk_bf16_f32 v148,v148,v149
v_mfma_f32_16x16x32_bf16 v[88:91],a[136:139],a[64:67],v[88:91]
s_add_u32 s63,s63,s33
ds_write2st64_b64 v36,v[128:129],v[144:145] offset0:26 offset1:28
v_mfma_f32_16x16x32_bf16 v[88:91],a[140:143],a[68:71],v[88:91]
s_mul_i32 s30,s63,196608
v_cvt_pk_bf16_f32 v133,v134,v135
v_cvt_pk_bf16_f32 v149,v150,v151
v_mfma_f32_16x16x32_bf16 v[76:79],a[144:147],a[0:3],0
s_mul_i32 s41,s63,325632
ds_read_b128 a[136:139],v0 offset:0
s_lshl_b32 s63,s3,2
ds_read_b128 a[140:143],v1 offset:0
v_pk_mul_f32 v[136:137],v[136:137],v[64:65] op_sel_hi:[1,0]
ds_write2st64_b64 v37,v[132:133],v[148:149] offset0:26 offset1:28
v_pk_mul_f32 v[138:139],v[138:139],v[64:65] op_sel_hi:[1,0]
v_pk_mul_f32 v[152:153],v[152:153],v[64:65] op_sel_hi:[1,0]
v_pk_mul_f32 v[154:155],v[154:155],v[64:65] op_sel_hi:[1,0]
v_max3_f32 v52,v88,v89,v90
v_cvt_pk_bf16_f32 v136,v136,v137
s_waitcnt lgkmcnt(4)
v_mfma_f32_16x16x32_bf16 v[76:79],a[148:151],a[4:7],v[76:79]
s_add_u32 s64,s63,21
v_cvt_pk_bf16_f32 v152,v152,v153
v_cvt_pk_bf16_f32 v137,v138,v139
v_mfma_f32_16x16x32_bf16 v[76:79],a[120:123],a[8:11],v[76:79]
s_cmp_eq_u32 s3,0
v_cvt_pk_bf16_f32 v153,v154,v155
s_cselect_b32 s64,20,s64
v_mfma_f32_16x16x32_bf16 v[76:79],a[124:127],a[12:15],v[76:79]
s_cselect_b32 s40,1,0
ds_write2st64_b64 v38,v[136:137],v[152:153] offset0:26 offset1:28
v_pk_mul_f32 v[140:141],v[140:141],v[64:65] op_sel_hi:[1,0]
v_pk_mul_f32 v[142:143],v[142:143],v[64:65] op_sel_hi:[1,0]
v_pk_mul_f32 v[156:157],v[156:157],v[64:65] op_sel_hi:[1,0]
v_pk_mul_f32 v[158:159],v[158:159],v[64:65] op_sel_hi:[1,0]
v_cvt_pk_bf16_f32 v140,v140,v141
v_cvt_pk_bf16_f32 v156,v156,v157
v_mfma_f32_16x16x32_bf16 v[76:79],a[128:131],a[16:19],v[76:79]
s_add_u32 s65,s63,37
v_cvt_pk_bf16_f32 v141,v142,v143
v_cvt_pk_bf16_f32 v157,v158,v159
v_mfma_f32_16x16x32_bf16 v[76:79],a[132:135],a[20:23],v[76:79]
s_cmp_eq_u32 s62,2
v_mov_b32 v64,0
v_mov_b32 v65,0
v_mfma_f32_16x16x32_bf16 v[84:87],a[132:135],a[44:47],0
s_cselect_b32 s64,s65,s64
ds_write2st64_b64 v39,v[140:141],v[156:157] offset0:26 offset1:28
v_pk_mul_f32 v[160:161],v[160:161],v[60:61] op_sel_hi:[1,0]
v_pk_mul_f32 v[162:163],v[162:163],v[60:61] op_sel_hi:[1,0]
v_pk_mul_f32 v[176:177],v[176:177],v[60:61] op_sel_hi:[1,0]
v_pk_mul_f32 v[178:179],v[178:179],v[60:61] op_sel_hi:[1,0]
v_max3_f32 v44,v44,v75,v76
v_max3_f32 v44,v44,v77,v78
v_mfma_f32_16x16x32_bf16 v[84:87],a[128:131],a[40:43],v[84:87]
s_cselect_b32 s40,0,s40
v_max_f32 v44,v44,v79
v_mov_b32 v45,v44
v_mfma_f32_16x16x32_bf16 v[84:87],a[124:127],a[36:39],v[84:87]
s_add_u32 s65,s63,s3
v_permlane32_swap_b32 v45,v44
v_mfma_f32_16x16x32_bf16 v[84:87],a[120:123],a[32:35],v[84:87]
s_cmp_eq_u32 s62,0
v_max_f32 v44,v44,v45
v_mov_b32 v45,v44
v_cvt_pk_bf16_f32 v160,v160,v161
v_cvt_pk_bf16_f32 v176,v176,v177
v_permlane16_swap_b32 v45,v44
v_pk_mul_f32 v[164:165],v[164:165],v[60:61] op_sel_hi:[1,0]
v_pk_mul_f32 v[166:167],v[166:167],v[60:61] op_sel_hi:[1,0]
v_pk_mul_f32 v[180:181],v[180:181],v[60:61] op_sel_hi:[1,0]
v_pk_mul_f32 v[182:183],v[182:183],v[60:61] op_sel_hi:[1,0]
v_max_f32 v44,v44,v45
v_mul_f32_e64 v13,-s36,v44
v_mfma_f32_16x16x32_bf16 v[84:87],a[148:151],a[28:31],v[84:87]
s_cselect_b32 s64,s65,s64
v_fma_f32 v72,v72,s36,v13
v_fma_f32 v73,v73,s36,v13
v_mfma_f32_16x16x32_bf16 v[84:87],a[144:147],a[24:27],v[84:87]
s_cselect_b32 s40,1,s40
v_fma_f32 v74,v74,s36,v13
v_fma_f32 v75,v75,s36,v13
v_mfma_f32_16x16x32_bf16 v[92:95],a[144:147],a[48:51],0
s_mul_i32 s64,s64,6144
ds_read_b128 a[144:147],v0 offset:128
v_exp_f32 v72,v72
v_mfma_f32_16x16x32_bf16 v[92:95],a[148:151],a[52:55],v[92:95]
s_add_u32 s41,s41,s64
ds_read_b128 a[148:151],v1 offset:128
v_exp_f32 v73,v73
v_exp_f32 v74,v74
v_pk_mul_f32 v[168:169],v[168:169],v[60:61] op_sel_hi:[1,0]
v_pk_mul_f32 v[170:171],v[170:171],v[60:61] op_sel_hi:[1,0]
v_pk_mul_f32 v[184:185],v[184:185],v[60:61] op_sel_hi:[1,0]
v_pk_mul_f32 v[186:187],v[186:187],v[60:61] op_sel_hi:[1,0]
v_exp_f32 v75,v75
v_cvt_pk_bf16_f32 v20,v72,v73
v_mfma_f32_16x16x32_bf16 v[92:95],a[120:123],a[56:59],v[92:95]
s_cmp_ge_u32 s69,6
ds_read_b128 a[120:123],v0 offset:256
v_cvt_pk_bf16_f32 v21,v74,v75
v_mfma_f32_16x16x32_bf16 v[92:95],a[124:127],a[60:63],v[92:95]
s_cselect_b32 s41,166723584,s41
ds_read_b128 a[124:127],v1 offset:256
v_max3_f32 v48,v48,v83,v84
v_mfma_f32_16x16x32_bf16 v[92:95],a[128:131],a[64:67],v[92:95]
s_cselect_b32 s30,100663296,s30
ds_read_b128 a[128:131],v0 offset:6144
v_max3_f32 v48,v48,v85,v86
v_max_f32 v48,v48,v87
v_mov_b32 v49,v48
v_fma_f32 v76,v76,s36,v13
v_pk_mul_f32 v[172:173],v[172:173],v[60:61] op_sel_hi:[1,0]
v_pk_mul_f32 v[174:175],v[174:175],v[60:61] op_sel_hi:[1,0]
v_pk_mul_f32 v[188:189],v[188:189],v[60:61] op_sel_hi:[1,0]
v_pk_mul_f32 v[190:191],v[190:191],v[60:61] op_sel_hi:[1,0]
v_permlane32_swap_b32 v49,v48
v_max_f32 v48,v48,v49
v_mfma_f32_16x16x32_bf16 v[92:95],a[132:135],a[68:71],v[92:95]
s_add_u32 s25,s30,s22
ds_read_b128 a[132:135],v1 offset:6144
v_mov_b32 v49,v48
s_waitcnt lgkmcnt(4)
v_mfma_f32_16x16x32_bf16 v[96:99],a[136:139],a[72:75],0
s_add_u32 s26,s25,12288
ds_read_b128 a[136:139],v0 offset:6272
v_permlane16_swap_b32 v49,v48
v_mfma_f32_16x16x32_bf16 v[96:99],a[140:143],a[76:79],v[96:99]
s_add_u32 m0,s23,24576
ds_read_b128 a[140:143],v1 offset:6272
buffer_load_dwordx4 v6,s[8:11],s21 offen offset:0 lds
buffer_load_dwordx4 v7,s[8:11],s21 offen offset:1024 lds
v_pk_mul_f32 v[192:193],v[192:193],v[60:61] op_sel_hi:[1,0]
v_pk_mul_f32 v[194:195],v[194:195],v[60:61] op_sel_hi:[1,0]
v_max_f32 v48,v48,v49
v_mul_f32_e64 v14,-s36,v48
v_mfma_f32_16x16x32_bf16 v[96:99],a[144:147],a[80:83],v[96:99]
s_mov_b32 s28,s41
ds_read_b128 a[144:147],v0 offset:6400
v_fma_f32 v80,v80,s36,v14
v_mfma_f32_16x16x32_bf16 v[96:99],a[148:151],a[84:87],v[96:99]
s_mov_b32 s29,s24
ds_read_b128 a[148:151],v1 offset:6400
v_fma_f32 v81,v81,s36,v14
s_waitcnt lgkmcnt(5)
v_mfma_f32_16x16x32_bf16 v[96:99],a[120:123],a[88:91],v[96:99]
ds_read_b128 a[120:123],v0 offset:12544
v_fma_f32 v82,v82,s36,v14
v_fma_f32 v83,v83,s36,v14
v_exp_f32 v80,v80
v_pk_mul_f32 v[196:197],v[196:197],v[60:61] op_sel_hi:[1,0]
v_pk_mul_f32 v[198:199],v[198:199],v[60:61] op_sel_hi:[1,0]
v_exp_f32 v81,v81
v_exp_f32 v82,v82
v_mfma_f32_16x16x32_bf16 v[96:99],a[124:127],a[92:95],v[96:99]
buffer_load_dwordx4 v8,s[8:11],s21 offen offset:2048 lds
v_mfma_f32_16x16x32_bf16 v[100:103],a[128:131],a[72:75],0
s_add_u32 s21,s21,12288
ds_read_b128 a[124:127],v1 offset:12544
v_exp_f32 v83,v83
s_waitcnt lgkmcnt(3)
v_mfma_f32_16x16x32_bf16 v[100:103],a[132:135],a[76:79],v[100:103]
s_add_u32 m0,s22,0
ds_read_b128 a[128:131],v0 offset:18432
v_cvt_pk_bf16_f32 v24,v80,v81
v_mfma_f32_16x16x32_bf16 v[100:103],a[136:139],a[80:83],v[100:103]
ds_read_b128 a[136:139],v0 offset:12288
v_cvt_pk_bf16_f32 v25,v82,v83
ds_read_b128 a[132:135],v1 offset:18432
v_pk_mul_f32 v[200:201],v[200:201],v[60:61] op_sel_hi:[1,0]
v_pk_mul_f32 v[202:203],v[202:203],v[60:61] op_sel_hi:[1,0]
v_max3_f32 v52,v52,v91,v92
v_max3_f32 v52,v52,v93,v94
v_mfma_f32_16x16x32_bf16 v[100:103],a[140:143],a[84:87],v[100:103]
ds_read_b128 a[140:143],v1 offset:12288
v_max_f32 v52,v52,v95
v_mfma_f32_16x16x32_bf16 v[100:103],a[144:147],a[88:91],v[100:103]
s_waitcnt lgkmcnt(5)
ds_read_b128 a[144:147],v0 offset:12416
v_mov_b32 v53,v52
v_mfma_f32_16x16x32_bf16 v[100:103],a[148:151],a[92:95],v[100:103]
ds_read_b128 a[148:151],v1 offset:12416
v_permlane32_swap_b32 v53,v52
v_max_f32 v52,v52,v53
v_mov_b32 v53,v52
v_pk_mul_f32 v[204:205],v[204:205],v[60:61] op_sel_hi:[1,0]
v_pk_mul_f32 v[206:207],v[206:207],v[60:61] op_sel_hi:[1,0]
v_permlane16_swap_b32 v53,v52
v_max_f32 v52,v52,v53
s_waitcnt lgkmcnt(4)
v_mfma_f32_16x16x32_bf16 v[72:75],a[124:127],a[20:23],0
v_mul_f32_e64 v15,-s36,v52
v_fma_f32 v88,v88,s36,v15
v_mfma_f32_16x16x32_bf16 v[72:75],a[120:123],a[16:19],v[72:75]
v_fma_f32 v89,v89,s36,v15
v_fma_f32 v90,v90,s36,v15
v_fma_f32 v91,v91,s36,v15
v_exp_f32 v88,v88
v_exp_f32 v89,v89
v_exp_f32 v90,v90
v_exp_f32 v91,v91
v_cvt_pk_bf16_f32 v28,v88,v89
v_cvt_pk_bf16_f32 v29,v90,v91
v_max3_f32 v56,v96,v97,v98
s_waitcnt lgkmcnt(0)
v_mfma_f32_16x16x32_bf16 v[72:75],a[148:151],a[12:15],v[72:75]
v_max3_f32 v56,v56,v99,v100
v_max3_f32 v56,v56,v101,v102
v_mfma_f32_16x16x32_bf16 v[72:75],a[144:147],a[8:11],v[72:75]
v_max_f32 v56,v56,v103
v_mov_b32 v57,v56
v_mfma_f32_16x16x32_bf16 v[72:75],a[140:143],a[4:7],v[72:75]
v_fma_f32 v77,v77,s36,v13
v_permlane32_swap_b32 v57,v56
v_mfma_f32_16x16x32_bf16 v[72:75],a[136:139],a[0:3],v[72:75]
v_max_f32 v56,v56,v57
v_mov_b32 v57,v56
v_mfma_f32_16x16x32_bf16 v[80:83],a[136:139],a[24:27],0
v_fma_f32 v78,v78,s36,v13
v_permlane16_swap_b32 v57,v56
v_mfma_f32_16x16x32_bf16 v[80:83],a[140:143],a[28:31],v[80:83]
v_max_f32 v56,v56,v57
v_mul_f32_e64 v16,-s36,v56
v_mfma_f32_16x16x32_bf16 v[80:83],a[144:147],a[32:35],v[80:83]
v_fma_f32 v96,v96,s36,v16
v_fma_f32 v97,v97,s36,v16
v_mfma_f32_16x16x32_bf16 v[80:83],a[148:151],a[36:39],v[80:83]
v_fma_f32 v98,v98,s36,v16
v_fma_f32 v99,v99,s36,v16
v_mfma_f32_16x16x32_bf16 v[80:83],a[120:123],a[40:43],v[80:83]
v_exp_f32 v96,v96
v_mfma_f32_16x16x32_bf16 v[80:83],a[124:127],a[44:47],v[80:83]
v_exp_f32 v97,v97
v_mfma_f32_16x16x32_bf16 v[88:91],a[124:127],a[68:71],0
v_exp_f32 v98,v98
v_mfma_f32_16x16x32_bf16 v[88:91],a[120:123],a[64:67],v[88:91]
v_exp_f32 v99,v99
v_mfma_f32_16x16x32_bf16 v[88:91],a[148:151],a[60:63],v[88:91]
v_cvt_pk_bf16_f32 v32,v96,v97
v_cvt_pk_bf16_f32 v33,v98,v99
v_mfma_f32_16x16x32_bf16 v[88:91],a[144:147],a[56:59],v[88:91]
v_fma_f32 v79,v79,s36,v13
v_exp_f32 v76,v76
v_mfma_f32_16x16x32_bf16 v[88:91],a[140:143],a[52:55],v[88:91]
v_exp_f32 v77,v77
v_mfma_f32_16x16x32_bf16 v[88:91],a[136:139],a[48:51],v[88:91]
v_exp_f32 v78,v78
v_mfma_f32_16x16x32_bf16 v[96:99],a[136:139],a[72:75],0
ds_read_b128 a[136:139],v0 offset:18560
v_exp_f32 v79,v79
v_mfma_f32_16x16x32_bf16 v[96:99],a[140:143],a[76:79],v[96:99]
ds_read_b128 a[140:143],v1 offset:18560
v_cvt_pk_bf16_f32 v22,v76,v77
v_mfma_f32_16x16x32_bf16 v[96:99],a[144:147],a[80:83],v[96:99]
ds_read_b128 a[144:147],v0 offset:18688
v_cvt_pk_bf16_f32 v23,v78,v79
v_mfma_f32_16x16x32_bf16 v[96:99],a[148:151],a[84:87],v[96:99]
ds_read_b128 a[148:151],v1 offset:18688
v_fma_f32 v84,v84,s36,v14
v_mfma_f32_16x16x32_bf16 v[96:99],a[120:123],a[88:91],v[96:99]
v_fma_f32 v85,v85,s36,v14
v_fma_f32 v86,v86,s36,v14
v_mfma_f32_16x16x32_bf16 v[96:99],a[124:127],a[92:95],v[96:99]
v_fma_f32 v87,v87,s36,v14
v_exp_f32 v84,v84
v_mfma_f32_16x16x32_bf16 v[76:79],a[128:131],a[0:3],0
v_exp_f32 v85,v85
v_mfma_f32_16x16x32_bf16 v[76:79],a[132:135],a[4:7],v[76:79]
s_waitcnt lgkmcnt(3)
v_exp_f32 v86,v86
v_mfma_f32_16x16x32_bf16 v[76:79],a[136:139],a[8:11],v[76:79]
s_waitcnt lgkmcnt(2)
v_exp_f32 v87,v87
v_mfma_f32_16x16x32_bf16 v[76:79],a[140:143],a[12:15],v[76:79]
s_waitcnt lgkmcnt(1)
v_cvt_pk_bf16_f32 v26,v84,v85
v_cvt_pk_bf16_f32 v27,v86,v87
v_mfma_f32_16x16x32_bf16 v[76:79],a[144:147],a[16:19],v[76:79]
s_waitcnt lgkmcnt(0)
v_fma_f32 v92,v92,s36,v15
v_fma_f32 v93,v93,s36,v15
v_mfma_f32_16x16x32_bf16 v[76:79],a[148:151],a[20:23],v[76:79]
v_fma_f32 v94,v94,s36,v15
v_fma_f32 v95,v95,s36,v15
v_mfma_f32_16x16x32_bf16 v[84:87],a[148:151],a[44:47],0
v_exp_f32 v92,v92
v_mfma_f32_16x16x32_bf16 v[84:87],a[144:147],a[40:43],v[84:87]
v_exp_f32 v93,v93
v_mfma_f32_16x16x32_bf16 v[84:87],a[140:143],a[36:39],v[84:87]
v_exp_f32 v94,v94
v_mfma_f32_16x16x32_bf16 v[84:87],a[136:139],a[32:35],v[84:87]
v_exp_f32 v95,v95
v_mfma_f32_16x16x32_bf16 v[84:87],a[132:135],a[28:31],v[84:87]
v_cvt_pk_bf16_f32 v30,v92,v93
v_cvt_pk_bf16_f32 v31,v94,v95
v_mfma_f32_16x16x32_bf16 v[84:87],a[128:131],a[24:27],v[84:87]
v_fma_f32 v100,v100,s36,v16
v_fma_f32 v101,v101,s36,v16
v_mfma_f32_16x16x32_bf16 v[92:95],a[128:131],a[48:51],0
v_fma_f32 v102,v102,s36,v16
v_fma_f32 v103,v103,s36,v16
v_mfma_f32_16x16x32_bf16 v[92:95],a[132:135],a[52:55],v[92:95]
v_exp_f32 v100,v100
s_waitcnt vmcnt(3)
s_barrier
v_mfma_f32_16x16x32_bf16 v[92:95],a[136:139],a[56:59],v[92:95]
v_exp_f32 v101,v101
v_mfma_f32_16x16x32_bf16 v[92:95],a[140:143],a[60:63],v[92:95]
buffer_load_dwordx4 v6,s[4:7],s20 offen offset:0 lds
v_mfma_f32_16x16x32_bf16 v[92:95],a[144:147],a[64:67],v[92:95]
v_exp_f32 v102,v102
v_mfma_f32_16x16x32_bf16 v[92:95],a[148:151],a[68:71],v[92:95]
v_exp_f32 v103,v103
v_cvt_pk_bf16_f32 v34,v100,v101
v_cvt_pk_bf16_f32 v35,v102,v103
v_mfma_f32_16x16x32_bf16 v[100:103],a[148:151],a[92:95],0
v_cvt_pk_bf16_f32 v161,v162,v163
v_cvt_pk_bf16_f32 v177,v178,v179
v_smfmac_f32_16x16x64_bf16 v[64:67],a[152:155],v[28:35],v18
ds_write2st64_b64 v36,v[160:161],v[176:177] offset0:0 offset1:2
v_mfma_f32_16x16x32_bf16 v[100:103],a[144:147],a[88:91],v[100:103]
v_cvt_pk_bf16_f32 v164,v164,v165
v_cvt_pk_bf16_f32 v180,v180,v181
v_mfma_f32_16x16x32_bf16 v[100:103],a[140:143],a[84:87],v[100:103]
buffer_load_dwordx4 v7,s[4:7],s20 offen offset:1024 lds
v_mfma_f32_16x16x32_bf16 v[100:103],a[136:139],a[80:83],v[100:103]
v_cvt_pk_bf16_f32 v168,v168,v169
v_cvt_pk_bf16_f32 v184,v184,v185
v_mfma_f32_16x16x32_bf16 v[100:103],a[132:135],a[76:79],v[100:103]
ds_read_b64_tr_b16 a[120:121],v2 offset:0
v_cvt_pk_bf16_f32 v165,v166,v167
v_mfma_f32_16x16x32_bf16 v[100:103],a[128:131],a[72:75],v[100:103]
ds_read_b64_tr_b16 a[122:123],v2 offset:6144
ds_read_b64_tr_b16 a[124:125],v3 offset:0
ds_read_b64_tr_b16 a[126:127],v3 offset:6144
buffer_load_dwordx4 v8,s[4:7],s20 offen offset:2048 lds
ds_read_b64_tr_b16 a[128:129],v4 offset:0
ds_read_b64_tr_b16 a[130:131],v4 offset:6144
v_cvt_pk_bf16_f32 v181,v182,v183
ds_write2st64_b64 v37,v[164:165],v[180:181] offset0:0 offset1:2
v_cvt_pk_bf16_f32 v172,v172,v173
v_cvt_pk_bf16_f32 v188,v188,v189
v_mov_b32 v60,0
ds_read_b64_tr_b16 a[132:133],v5 offset:0
ds_read_b64_tr_b16 a[134:135],v5 offset:6144
v_mov_b32 v61,0
v_cvt_pk_bf16_f32 v169,v170,v171
v_cvt_pk_bf16_f32 v185,v186,v187
v_smfmac_f32_16x16x64_bf16 v[60:63],a[152:155],v[20:27],v18
s_add_u32 s20,s20,12288
ds_write2st64_b64 v38,v[168:169],v[184:185] offset0:0 offset1:2
v_cvt_pk_bf16_f32 v192,v192,v193
v_cvt_pk_bf16_f32 v173,v174,v175
v_cvt_pk_bf16_f32 v189,v190,v191
v_cvt_pk_bf16_f32 v196,v196,v197
v_fma_f32 v72,v72,s36,v13
v_fma_f32 v73,v73,s36,v13
v_fma_f32 v74,v74,s36,v13
v_fma_f32 v75,v75,s36,v13
v_fma_f32 v80,v80,s36,v14
v_fma_f32 v81,v81,s36,v14
v_cvt_pk_bf16_f32 v193,v194,v195
ds_write2st64_b64 v39,v[172:173],v[188:189] offset0:0 offset1:2
v_cvt_pk_bf16_f32 v200,v200,v201
v_cvt_pk_bf16_f32 v197,v198,v199
v_exp_f32 v72,v72
v_exp_f32 v73,v73
v_exp_f32 v74,v74
v_exp_f32 v75,v75
v_exp_f32 v80,v80
ds_write_b64 v36,v[192:193] offset:2048
v_exp_f32 v81,v81
v_cvt_pk_bf16_f32 v204,v204,v205
v_cvt_pk_bf16_f32 v201,v202,v203
ds_write_b64 v37,v[196:197] offset:2048
v_cvt_pk_bf16_f32 v205,v206,v207
v_cvt_pk_bf16_f32 v44,v72,v73
v_cvt_pk_bf16_f32 v45,v74,v75
v_cvt_pk_bf16_f32 v48,v80,v81
ds_write_b64 v38,v[200:201] offset:2048
ds_write_b64 v39,v[204:205] offset:2048
s_waitcnt lgkmcnt(3)
v_mfma_f32_16x16x32_bf16 v[160:163],a[120:123],v[20:23],0
s_add_u32 m0,s23,0
ds_read_b64_tr_b16 a[136:137],v2 offset:128
v_fma_f32 v82,v82,s36,v14
v_mfma_f32_16x16x32_bf16 v[164:167],a[124:127],v[20:23],0
ds_read_b64_tr_b16 a[138:139],v2 offset:6272
v_fma_f32 v83,v83,s36,v14
v_mfma_f32_16x16x32_bf16 v[212:215],a[124:127],v[24:27],0
ds_read_b64_tr_b16 a[140:141],v3 offset:128
v_fma_f32 v88,v88,s36,v15
v_mfma_f32_16x16x32_bf16 v[208:211],a[120:123],v[24:27],0
ds_read_b64_tr_b16 a[142:143],v3 offset:6272
v_fma_f32 v89,v89,s36,v15
v_mfma_f32_16x16x32_bf16 v[112:115],a[120:123],v[28:31],0
ds_read_b64_tr_b16 a[144:145],v4 offset:128
v_fma_f32 v90,v90,s36,v15
v_mfma_f32_16x16x32_bf16 v[116:119],a[124:127],v[28:31],0
ds_read_b64_tr_b16 a[146:147],v4 offset:6272
v_fma_f32 v91,v91,s36,v15
v_mfma_f32_16x16x32_bf16 a[164:167],a[124:127],v[32:35],0
ds_read_b64_tr_b16 a[148:149],v5 offset:128
v_fma_f32 v96,v96,s36,v16
v_mfma_f32_16x16x32_bf16 a[160:163],a[120:123],v[32:35],0
ds_read_b64_tr_b16 a[150:151],v5 offset:6272
v_fma_f32 v97,v97,s36,v16
v_mfma_f32_16x16x32_bf16 a[168:171],a[128:131],v[32:35],0
ds_read_b64_tr_b16 a[120:121],v2 offset:256
v_fma_f32 v98,v98,s36,v16
v_mfma_f32_16x16x32_bf16 a[172:175],a[132:135],v[32:35],0
ds_read_b64_tr_b16 a[122:123],v2 offset:6400
v_fma_f32 v99,v99,s36,v16
v_mfma_f32_16x16x32_bf16 v[124:127],a[132:135],v[28:31],0
ds_read_b64_tr_b16 a[124:125],v3 offset:256
v_fma_f32 v76,v76,s36,v13
v_mfma_f32_16x16x32_bf16 v[120:123],a[128:131],v[28:31],0
ds_read_b64_tr_b16 a[126:127],v3 offset:6400
v_fma_f32 v77,v77,s36,v13
v_mfma_f32_16x16x32_bf16 v[216:219],a[128:131],v[24:27],0
v_exp_f32 v82,v82
v_mfma_f32_16x16x32_bf16 v[220:223],a[132:135],v[24:27],0
v_exp_f32 v83,v83
v_mfma_f32_16x16x32_bf16 v[172:175],a[132:135],v[20:23],0
ds_read_b64_tr_b16 a[132:133],v5 offset:256
v_cvt_pk_bf16_f32 v49,v82,v83
v_mfma_f32_16x16x32_bf16 v[168:171],a[128:131],v[20:23],0
s_waitcnt lgkmcnt(4)
ds_read_b64_tr_b16 a[128:129],v4 offset:256
v_fma_f32 v78,v78,s36,v13
v_mfma_f32_16x16x32_bf16 v[176:179],a[136:139],v[20:23],0
ds_read_b64_tr_b16 a[130:131],v4 offset:6400
v_fma_f32 v79,v79,s36,v13
v_mfma_f32_16x16x32_bf16 v[180:183],a[140:143],v[20:23],0
ds_read_b64_tr_b16 a[134:135],v5 offset:6400
v_fma_f32 v84,v84,s36,v14
v_mfma_f32_16x16x32_bf16 v[228:231],a[140:143],v[24:27],0
v_exp_f32 v88,v88
v_mfma_f32_16x16x32_bf16 v[224:227],a[136:139],v[24:27],0
v_exp_f32 v89,v89
v_mfma_f32_16x16x32_bf16 v[128:131],a[136:139],v[28:31],0
v_exp_f32 v90,v90
v_mfma_f32_16x16x32_bf16 v[132:135],a[140:143],v[28:31],0
v_exp_f32 v91,v91
v_mfma_f32_16x16x32_bf16 a[180:183],a[140:143],v[32:35],0
v_cvt_pk_bf16_f32 v52,v88,v89
v_cvt_pk_bf16_f32 v53,v90,v91
v_mfma_f32_16x16x32_bf16 a[176:179],a[136:139],v[32:35],0
v_exp_f32 v96,v96
v_mfma_f32_16x16x32_bf16 a[184:187],a[144:147],v[32:35],0
v_exp_f32 v97,v97
v_mfma_f32_16x16x32_bf16 a[188:191],a[148:151],v[32:35],0
v_exp_f32 v98,v98
v_mfma_f32_16x16x32_bf16 v[140:143],a[148:151],v[28:31],0
v_exp_f32 v99,v99
v_mfma_f32_16x16x32_bf16 v[136:139],a[144:147],v[28:31],0
v_cvt_pk_bf16_f32 v56,v96,v97
v_cvt_pk_bf16_f32 v57,v98,v99
v_mfma_f32_16x16x32_bf16 v[232:235],a[144:147],v[24:27],0
v_exp_f32 v76,v76
v_mfma_f32_16x16x32_bf16 v[236:239],a[148:151],v[24:27],0
v_exp_f32 v77,v77
v_mfma_f32_16x16x32_bf16 v[188:191],a[148:151],v[20:23],0
v_exp_f32 v78,v78
v_mfma_f32_16x16x32_bf16 v[184:187],a[144:147],v[20:23],0
s_waitcnt lgkmcnt(0)
v_exp_f32 v79,v79
v_mfma_f32_16x16x32_bf16 v[192:195],a[120:123],v[20:23],0
v_cvt_pk_bf16_f32 v46,v76,v77
v_cvt_pk_bf16_f32 v47,v78,v79
v_mfma_f32_16x16x32_bf16 v[196:199],a[124:127],v[20:23],0
s_waitcnt vmcnt(24)
v_fma_f32 v85,v85,s36,v14
v_fma_f32 v86,v86,s36,v14
v_mfma_f32_16x16x32_bf16 v[244:247],a[124:127],v[24:27],0
s_barrier
v_mfma_f32_16x16x32_bf16 v[240:243],a[120:123],v[24:27],0
ds_read_b128 a[148:151],v1 offset:24704
v_fma_f32 v87,v87,s36,v14
v_mfma_f32_16x16x32_bf16 v[144:147],a[120:123],v[28:31],0
ds_read_b128 a[144:147],v0 offset:24704
v_fma_f32 v92,v92,s36,v15
v_mfma_f32_16x16x32_bf16 v[148:151],a[124:127],v[28:31],0
ds_read_b128 a[140:143],v1 offset:24576
v_fma_f32 v93,v93,s36,v15
v_mfma_f32_16x16x32_bf16 a[196:199],a[124:127],v[32:35],0
ds_read_b128 a[124:127],v1 offset:24832
v_fma_f32 v94,v94,s36,v15
v_mfma_f32_16x16x32_bf16 a[192:195],a[120:123],v[32:35],0
ds_read_b128 a[120:123],v0 offset:24832
v_fma_f32 v95,v95,s36,v15
v_mfma_f32_16x16x32_bf16 a[200:203],a[128:131],v[32:35],0
buffer_load_dwordx4 v6,s[8:11],s21 offen offset:0 lds
v_mfma_f32_16x16x32_bf16 a[204:207],a[132:135],v[32:35],0
ds_read_b128 a[136:139],v0 offset:24576
v_fma_f32 v100,v100,s36,v16
v_mfma_f32_16x16x32_bf16 v[156:159],a[132:135],v[28:31],0
v_exp_f32 v84,v84
v_mfma_f32_16x16x32_bf16 v[152:155],a[128:131],v[28:31],0
v_exp_f32 v85,v85
v_mfma_f32_16x16x32_bf16 v[248:251],a[128:131],v[24:27],0
v_exp_f32 v86,v86
v_mfma_f32_16x16x32_bf16 v[252:255],a[132:135],v[24:27],0
v_exp_f32 v87,v87
v_mfma_f32_16x16x32_bf16 v[204:207],a[132:135],v[20:23],0
ds_read_b128 a[132:135],v1 offset:30720
v_cvt_pk_bf16_f32 v50,v84,v85
v_mfma_f32_16x16x32_bf16 v[200:203],a[128:131],v[20:23],0
s_waitcnt lgkmcnt(2)
ds_read_b128 a[128:131],v0 offset:30720
v_cvt_pk_bf16_f32 v51,v86,v87
v_mfma_f32_16x16x32_bf16 v[72:75],a[124:127],a[20:23],0
v_exp_f32 v92,v92
v_smfmac_f32_16x16x64_bf16 v[60:63],a[152:155],v[44:51],v18
buffer_load_dwordx4 v7,s[8:11],s21 offen offset:1024 lds
v_mfma_f32_16x16x32_bf16 v[72:75],a[120:123],a[16:19],v[72:75]
v_exp_f32 v93,v93
v_mfma_f32_16x16x32_bf16 v[72:75],a[148:151],a[12:15],v[72:75]
v_exp_f32 v94,v94
v_mfma_f32_16x16x32_bf16 v[72:75],a[144:147],a[8:11],v[72:75]
v_exp_f32 v95,v95
v_mfma_f32_16x16x32_bf16 v[72:75],a[140:143],a[4:7],v[72:75]
s_waitcnt lgkmcnt(1)
v_cvt_pk_bf16_f32 v54,v92,v93
v_cvt_pk_bf16_f32 v55,v94,v95
v_mfma_f32_16x16x32_bf16 v[72:75],a[136:139],a[0:3],v[72:75]
v_fma_f32 v101,v101,s36,v16
v_fma_f32 v102,v102,s36,v16
v_mfma_f32_16x16x32_bf16 v[80:83],a[136:139],a[24:27],0
v_fma_f32 v103,v103,s36,v16
v_mfma_f32_16x16x32_bf16 v[80:83],a[140:143],a[28:31],v[80:83]
v_exp_f32 v100,v100
v_mfma_f32_16x16x32_bf16 v[80:83],a[144:147],a[32:35],v[80:83]
buffer_load_dwordx4 v8,s[8:11],s21 offen offset:2048 lds
v_mfma_f32_16x16x32_bf16 v[80:83],a[148:151],a[36:39],v[80:83]
s_add_u32 s21,s21,12288
v_exp_f32 v101,v101
v_mfma_f32_16x16x32_bf16 v[80:83],a[120:123],a[40:43],v[80:83]
s_add_u32 m0,s22,12288
v_exp_f32 v102,v102
v_mfma_f32_16x16x32_bf16 v[80:83],a[124:127],a[44:47],v[80:83]
v_exp_f32 v103,v103
v_mfma_f32_16x16x32_bf16 v[88:91],a[124:127],a[68:71],0
v_cvt_pk_bf16_f32 v58,v100,v101
v_cvt_pk_bf16_f32 v59,v102,v103
v_mfma_f32_16x16x32_bf16 v[88:91],a[120:123],a[64:67],v[88:91]
v_fma_f32 v72,v72,s36,v13
v_fma_f32 v73,v73,s36,v13
v_smfmac_f32_16x16x64_bf16 v[64:67],a[152:155],v[52:59],v18
v_fma_f32 v74,v74,s36,v13
v_mfma_f32_16x16x32_bf16 v[88:91],a[148:151],a[60:63],v[88:91]
v_fma_f32 v75,v75,s36,v13
v_fma_f32 v80,v80,s36,v14
v_mfma_f32_16x16x32_bf16 v[88:91],a[144:147],a[56:59],v[88:91]
v_fma_f32 v81,v81,s36,v14
v_mfma_f32_16x16x32_bf16 v[88:91],a[140:143],a[52:55],v[88:91]
buffer_load_dwordx4 v6,s[4:7],s20 offen offset:0 lds
v_mfma_f32_16x16x32_bf16 v[88:91],a[136:139],a[48:51],v[88:91]
v_exp_f32 v72,v72
v_mfma_f32_16x16x32_bf16 v[96:99],a[136:139],a[72:75],0
ds_read_b128 a[136:139],v0 offset:30848
v_mfma_f32_16x16x32_bf16 v[96:99],a[140:143],a[76:79],v[96:99]
ds_read_b128 a[140:143],v1 offset:30848
v_mfma_f32_16x16x32_bf16 v[96:99],a[144:147],a[80:83],v[96:99]
ds_read_b128 a[144:147],v0 offset:30976
v_mfma_f32_16x16x32_bf16 v[96:99],a[148:151],a[84:87],v[96:99]
ds_read_b128 a[148:151],v1 offset:30976
v_mfma_f32_16x16x32_bf16 v[96:99],a[120:123],a[88:91],v[96:99]
v_exp_f32 v73,v73
v_mfma_f32_16x16x32_bf16 v[96:99],a[124:127],a[92:95],v[96:99]
s_waitcnt lgkmcnt(4)
v_exp_f32 v74,v74
v_mfma_f32_16x16x32_bf16 v[76:79],a[128:131],a[0:3],0
v_exp_f32 v75,v75
v_mfma_f32_16x16x32_bf16 v[76:79],a[132:135],a[4:7],v[76:79]
buffer_load_dwordx4 v7,s[4:7],s20 offen offset:1024 lds
s_waitcnt lgkmcnt(3)
v_mfma_f32_16x16x32_bf16 v[76:79],a[136:139],a[8:11],v[76:79]
s_waitcnt lgkmcnt(2)
v_exp_f32 v80,v80
v_mfma_f32_16x16x32_bf16 v[76:79],a[140:143],a[12:15],v[76:79]
s_waitcnt lgkmcnt(0)
v_exp_f32 v81,v81
v_mfma_f32_16x16x32_bf16 v[76:79],a[144:147],a[16:19],v[76:79]
v_cvt_pk_bf16_f32 v20,v72,v73
v_cvt_pk_bf16_f32 v21,v74,v75
v_mfma_f32_16x16x32_bf16 v[76:79],a[148:151],a[20:23],v[76:79]
v_cvt_pk_bf16_f32 v24,v80,v81
v_mfma_f32_16x16x32_bf16 v[84:87],a[148:151],a[44:47],0
v_mfma_f32_16x16x32_bf16 v[84:87],a[144:147],a[40:43],v[84:87]
v_mfma_f32_16x16x32_bf16 v[84:87],a[140:143],a[36:39],v[84:87]
v_mfma_f32_16x16x32_bf16 v[84:87],a[136:139],a[32:35],v[84:87]
v_mfma_f32_16x16x32_bf16 v[84:87],a[132:135],a[28:31],v[84:87]
buffer_load_dwordx4 v8,s[4:7],s20 offen offset:2048 lds
v_mfma_f32_16x16x32_bf16 v[84:87],a[128:131],a[24:27],v[84:87]
s_add_u32 s20,s20,12288
v_mfma_f32_16x16x32_bf16 v[92:95],a[128:131],a[48:51],0
ds_read_b64_tr_b16 a[120:121],v2 offset:12288
v_mfma_f32_16x16x32_bf16 v[92:95],a[132:135],a[52:55],v[92:95]
ds_read_b64_tr_b16 a[122:123],v2 offset:18432
v_mfma_f32_16x16x32_bf16 v[92:95],a[136:139],a[56:59],v[92:95]
ds_read_b64_tr_b16 a[124:125],v3 offset:12288
v_mfma_f32_16x16x32_bf16 v[92:95],a[140:143],a[60:63],v[92:95]
ds_read_b64_tr_b16 a[126:127],v3 offset:18432
v_mfma_f32_16x16x32_bf16 v[92:95],a[144:147],a[64:67],v[92:95]
v_mfma_f32_16x16x32_bf16 v[92:95],a[148:151],a[68:71],v[92:95]
v_mfma_f32_16x16x32_bf16 v[100:103],a[148:151],a[92:95],0
v_mfma_f32_16x16x32_bf16 v[100:103],a[144:147],a[88:91],v[100:103]
v_mfma_f32_16x16x32_bf16 v[100:103],a[140:143],a[84:87],v[100:103]
v_mfma_f32_16x16x32_bf16 v[100:103],a[136:139],a[80:83],v[100:103]
v_mfma_f32_16x16x32_bf16 v[100:103],a[132:135],a[76:79],v[100:103]
ds_read_b64_tr_b16 a[132:133],v5 offset:12288
v_mfma_f32_16x16x32_bf16 v[100:103],a[128:131],a[72:75],v[100:103]
s_waitcnt lgkmcnt(1)
ds_read_b64_tr_b16 a[128:129],v4 offset:12288
ds_read_b64_tr_b16 a[130:131],v4 offset:18432
ds_read_b64_tr_b16 a[134:135],v5 offset:18432
v_mfma_f32_16x16x32_bf16 v[160:163],a[120:123],v[44:47],v[160:163]
s_add_u32 m0,s23,12288
ds_read_b64_tr_b16 a[136:137],v2 offset:12416
v_fma_f32 v82,v82,s36,v14
v_mfma_f32_16x16x32_bf16 v[164:167],a[124:127],v[44:47],v[164:167]
ds_read_b64_tr_b16 a[138:139],v2 offset:18560
v_fma_f32 v83,v83,s36,v14
v_mfma_f32_16x16x32_bf16 v[212:215],a[124:127],v[48:51],v[212:215]
ds_read_b64_tr_b16 a[140:141],v3 offset:12416
v_fma_f32 v88,v88,s36,v15
v_mfma_f32_16x16x32_bf16 v[208:211],a[120:123],v[48:51],v[208:211]
ds_read_b64_tr_b16 a[142:143],v3 offset:18560
v_fma_f32 v89,v89,s36,v15
v_mfma_f32_16x16x32_bf16 v[112:115],a[120:123],v[52:55],v[112:115]
ds_read_b64_tr_b16 a[144:145],v4 offset:12416
v_fma_f32 v90,v90,s36,v15
v_mfma_f32_16x16x32_bf16 v[116:119],a[124:127],v[52:55],v[116:119]
ds_read_b64_tr_b16 a[146:147],v4 offset:18560
v_fma_f32 v91,v91,s36,v15
v_mfma_f32_16x16x32_bf16 a[164:167],a[124:127],v[56:59],a[164:167]
ds_read_b64_tr_b16 a[148:149],v5 offset:12416
v_fma_f32 v96,v96,s36,v16
v_mfma_f32_16x16x32_bf16 a[160:163],a[120:123],v[56:59],a[160:163]
s_waitcnt lgkmcnt(6)
ds_read_b64_tr_b16 a[150:151],v5 offset:18560
v_fma_f32 v97,v97,s36,v16
v_mfma_f32_16x16x32_bf16 a[168:171],a[128:131],v[56:59],a[168:171]
ds_read_b64_tr_b16 a[120:121],v2 offset:12544
v_fma_f32 v98,v98,s36,v16
v_mfma_f32_16x16x32_bf16 a[172:175],a[132:135],v[56:59],a[172:175]
ds_read_b64_tr_b16 a[122:123],v2 offset:18688
v_fma_f32 v99,v99,s36,v16
v_mfma_f32_16x16x32_bf16 v[124:127],a[132:135],v[52:55],v[124:127]
ds_read_b64_tr_b16 a[124:125],v3 offset:12544
v_fma_f32 v76,v76,s36,v13
v_mfma_f32_16x16x32_bf16 v[120:123],a[128:131],v[52:55],v[120:123]
ds_read_b64_tr_b16 a[126:127],v3 offset:18688
v_fma_f32 v77,v77,s36,v13
v_mfma_f32_16x16x32_bf16 v[216:219],a[128:131],v[48:51],v[216:219]
v_exp_f32 v82,v82
v_mfma_f32_16x16x32_bf16 v[220:223],a[132:135],v[48:51],v[220:223]
v_exp_f32 v83,v83
v_mfma_f32_16x16x32_bf16 v[172:175],a[132:135],v[44:47],v[172:175]
ds_read_b64_tr_b16 a[132:133],v5 offset:12544
v_cvt_pk_bf16_f32 v25,v82,v83
v_mfma_f32_16x16x32_bf16 v[168:171],a[128:131],v[44:47],v[168:171]
s_waitcnt lgkmcnt(4)
ds_read_b64_tr_b16 a[128:129],v4 offset:12544
v_fma_f32 v78,v78,s36,v13
v_mfma_f32_16x16x32_bf16 v[176:179],a[136:139],v[44:47],v[176:179]
ds_read_b64_tr_b16 a[130:131],v4 offset:18688
v_fma_f32 v79,v79,s36,v13
v_mfma_f32_16x16x32_bf16 v[180:183],a[140:143],v[44:47],v[180:183]
ds_read_b64_tr_b16 a[134:135],v5 offset:18688
v_fma_f32 v84,v84,s36,v14
v_mfma_f32_16x16x32_bf16 v[228:231],a[140:143],v[48:51],v[228:231]
v_exp_f32 v88,v88
v_mfma_f32_16x16x32_bf16 v[224:227],a[136:139],v[48:51],v[224:227]
v_exp_f32 v89,v89
v_mfma_f32_16x16x32_bf16 v[128:131],a[136:139],v[52:55],v[128:131]
v_exp_f32 v90,v90
v_mfma_f32_16x16x32_bf16 v[132:135],a[140:143],v[52:55],v[132:135]
v_exp_f32 v91,v91
v_mfma_f32_16x16x32_bf16 a[180:183],a[140:143],v[56:59],a[180:183]
v_cvt_pk_bf16_f32 v28,v88,v89
v_cvt_pk_bf16_f32 v29,v90,v91
v_mfma_f32_16x16x32_bf16 a[176:179],a[136:139],v[56:59],a[176:179]
v_exp_f32 v96,v96
v_mfma_f32_16x16x32_bf16 a[184:187],a[144:147],v[56:59],a[184:187]
v_exp_f32 v97,v97
v_mfma_f32_16x16x32_bf16 a[188:191],a[148:151],v[56:59],a[188:191]
v_exp_f32 v98,v98
v_mfma_f32_16x16x32_bf16 v[140:143],a[148:151],v[52:55],v[140:143]
v_exp_f32 v99,v99
v_mfma_f32_16x16x32_bf16 v[136:139],a[144:147],v[52:55],v[136:139]
v_cvt_pk_bf16_f32 v32,v96,v97
v_cvt_pk_bf16_f32 v33,v98,v99
v_mfma_f32_16x16x32_bf16 v[232:235],a[144:147],v[48:51],v[232:235]
v_exp_f32 v76,v76
v_mfma_f32_16x16x32_bf16 v[236:239],a[148:151],v[48:51],v[236:239]
v_exp_f32 v77,v77
v_mfma_f32_16x16x32_bf16 v[188:191],a[148:151],v[44:47],v[188:191]
v_exp_f32 v78,v78
v_mfma_f32_16x16x32_bf16 v[184:187],a[144:147],v[44:47],v[184:187]
s_waitcnt lgkmcnt(0)
v_exp_f32 v79,v79
v_mfma_f32_16x16x32_bf16 v[192:195],a[120:123],v[44:47],v[192:195]
v_cvt_pk_bf16_f32 v22,v76,v77
v_cvt_pk_bf16_f32 v23,v78,v79
v_mfma_f32_16x16x32_bf16 v[196:199],a[124:127],v[44:47],v[196:199]
s_waitcnt vmcnt(6)
v_fma_f32 v85,v85,s36,v14
v_fma_f32 v86,v86,s36,v14
v_mfma_f32_16x16x32_bf16 v[244:247],a[124:127],v[48:51],v[244:247]
s_barrier
v_mfma_f32_16x16x32_bf16 v[240:243],a[120:123],v[48:51],v[240:243]
ds_read_b128 a[148:151],v1 offset:128
v_fma_f32 v87,v87,s36,v14
v_mfma_f32_16x16x32_bf16 v[144:147],a[120:123],v[52:55],v[144:147]
ds_read_b128 a[144:147],v0 offset:128
v_fma_f32 v92,v92,s36,v15
v_mfma_f32_16x16x32_bf16 v[148:151],a[124:127],v[52:55],v[148:151]
ds_read_b128 a[140:143],v1 offset:0
v_fma_f32 v93,v93,s36,v15
v_mfma_f32_16x16x32_bf16 a[196:199],a[124:127],v[56:59],a[196:199]
ds_read_b128 a[124:127],v1 offset:256
v_fma_f32 v94,v94,s36,v15
v_mfma_f32_16x16x32_bf16 a[192:195],a[120:123],v[56:59],a[192:195]
ds_read_b128 a[120:123],v0 offset:256
v_fma_f32 v95,v95,s36,v15
v_mfma_f32_16x16x32_bf16 a[200:203],a[128:131],v[56:59],a[200:203]
buffer_load_dwordx4 v6,s[8:11],s21 offen offset:0 lds
v_mfma_f32_16x16x32_bf16 a[204:207],a[132:135],v[56:59],a[204:207]
ds_read_b128 a[136:139],v0 offset:0
v_fma_f32 v100,v100,s36,v16
v_mfma_f32_16x16x32_bf16 v[156:159],a[132:135],v[52:55],v[156:159]
v_exp_f32 v84,v84
v_mfma_f32_16x16x32_bf16 v[152:155],a[128:131],v[52:55],v[152:155]
v_exp_f32 v85,v85
v_mfma_f32_16x16x32_bf16 v[248:251],a[128:131],v[48:51],v[248:251]
v_exp_f32 v86,v86
v_mfma_f32_16x16x32_bf16 v[252:255],a[132:135],v[48:51],v[252:255]
v_exp_f32 v87,v87
v_mfma_f32_16x16x32_bf16 v[204:207],a[132:135],v[44:47],v[204:207]
ds_read_b128 a[132:135],v1 offset:6144
v_cvt_pk_bf16_f32 v26,v84,v85
v_mfma_f32_16x16x32_bf16 v[200:203],a[128:131],v[44:47],v[200:203]
s_waitcnt lgkmcnt(2)
ds_read_b128 a[128:131],v0 offset:6144
v_cvt_pk_bf16_f32 v27,v86,v87
v_mfma_f32_16x16x32_bf16 v[72:75],a[124:127],a[20:23],0
v_exp_f32 v92,v92
v_smfmac_f32_16x16x64_bf16 v[60:63],a[152:155],v[20:27],v18
buffer_load_dwordx4 v7,s[8:11],s21 offen offset:1024 lds
v_mfma_f32_16x16x32_bf16 v[72:75],a[120:123],a[16:19],v[72:75]
v_exp_f32 v93,v93
v_mfma_f32_16x16x32_bf16 v[72:75],a[148:151],a[12:15],v[72:75]
v_exp_f32 v94,v94
v_mfma_f32_16x16x32_bf16 v[72:75],a[144:147],a[8:11],v[72:75]
v_exp_f32 v95,v95
v_mfma_f32_16x16x32_bf16 v[72:75],a[140:143],a[4:7],v[72:75]
s_waitcnt lgkmcnt(1)
v_cvt_pk_bf16_f32 v30,v92,v93
v_cvt_pk_bf16_f32 v31,v94,v95
v_mfma_f32_16x16x32_bf16 v[72:75],a[136:139],a[0:3],v[72:75]
v_fma_f32 v101,v101,s36,v16
v_fma_f32 v102,v102,s36,v16
v_mfma_f32_16x16x32_bf16 v[80:83],a[136:139],a[24:27],0
v_fma_f32 v103,v103,s36,v16
v_mfma_f32_16x16x32_bf16 v[80:83],a[140:143],a[28:31],v[80:83]
v_exp_f32 v100,v100
v_mfma_f32_16x16x32_bf16 v[80:83],a[144:147],a[32:35],v[80:83]
buffer_load_dwordx4 v8,s[8:11],s21 offen offset:2048 lds
v_mfma_f32_16x16x32_bf16 v[80:83],a[148:151],a[36:39],v[80:83]
s_add_u32 s21,s21,12288
v_exp_f32 v101,v101
v_mfma_f32_16x16x32_bf16 v[80:83],a[120:123],a[40:43],v[80:83]
s_add_u32 m0,s22,24576
v_exp_f32 v102,v102
v_mfma_f32_16x16x32_bf16 v[80:83],a[124:127],a[44:47],v[80:83]
v_exp_f32 v103,v103
v_mfma_f32_16x16x32_bf16 v[88:91],a[124:127],a[68:71],0
v_cvt_pk_bf16_f32 v34,v100,v101
v_cvt_pk_bf16_f32 v35,v102,v103
v_mfma_f32_16x16x32_bf16 v[88:91],a[120:123],a[64:67],v[88:91]
v_fma_f32 v72,v72,s36,v13
v_fma_f32 v73,v73,s36,v13
v_smfmac_f32_16x16x64_bf16 v[64:67],a[152:155],v[28:35],v18
v_fma_f32 v74,v74,s36,v13
v_mfma_f32_16x16x32_bf16 v[88:91],a[148:151],a[60:63],v[88:91]
v_fma_f32 v75,v75,s36,v13
v_fma_f32 v80,v80,s36,v14
v_mfma_f32_16x16x32_bf16 v[88:91],a[144:147],a[56:59],v[88:91]
v_fma_f32 v81,v81,s36,v14
v_mfma_f32_16x16x32_bf16 v[88:91],a[140:143],a[52:55],v[88:91]
buffer_load_dwordx4 v6,s[4:7],s20 offen offset:0 lds
v_mfma_f32_16x16x32_bf16 v[88:91],a[136:139],a[48:51],v[88:91]
v_exp_f32 v72,v72
v_mfma_f32_16x16x32_bf16 v[96:99],a[136:139],a[72:75],0
ds_read_b128 a[136:139],v0 offset:6272
v_mfma_f32_16x16x32_bf16 v[96:99],a[140:143],a[76:79],v[96:99]
ds_read_b128 a[140:143],v1 offset:6272
v_mfma_f32_16x16x32_bf16 v[96:99],a[144:147],a[80:83],v[96:99]
ds_read_b128 a[144:147],v0 offset:6400
v_mfma_f32_16x16x32_bf16 v[96:99],a[148:151],a[84:87],v[96:99]
ds_read_b128 a[148:151],v1 offset:6400
v_mfma_f32_16x16x32_bf16 v[96:99],a[120:123],a[88:91],v[96:99]
v_exp_f32 v73,v73
v_mfma_f32_16x16x32_bf16 v[96:99],a[124:127],a[92:95],v[96:99]
s_waitcnt lgkmcnt(4)
v_exp_f32 v74,v74
v_mfma_f32_16x16x32_bf16 v[76:79],a[128:131],a[0:3],0
v_exp_f32 v75,v75
v_mfma_f32_16x16x32_bf16 v[76:79],a[132:135],a[4:7],v[76:79]
buffer_load_dwordx4 v7,s[4:7],s20 offen offset:1024 lds
s_waitcnt lgkmcnt(3)
v_mfma_f32_16x16x32_bf16 v[76:79],a[136:139],a[8:11],v[76:79]
s_waitcnt lgkmcnt(2)
v_exp_f32 v80,v80
v_mfma_f32_16x16x32_bf16 v[76:79],a[140:143],a[12:15],v[76:79]
s_waitcnt lgkmcnt(0)
v_exp_f32 v81,v81
v_mfma_f32_16x16x32_bf16 v[76:79],a[144:147],a[16:19],v[76:79]
v_cvt_pk_bf16_f32 v44,v72,v73
v_cvt_pk_bf16_f32 v45,v74,v75
v_mfma_f32_16x16x32_bf16 v[76:79],a[148:151],a[20:23],v[76:79]
v_cvt_pk_bf16_f32 v48,v80,v81
v_mfma_f32_16x16x32_bf16 v[84:87],a[148:151],a[44:47],0
v_mfma_f32_16x16x32_bf16 v[84:87],a[144:147],a[40:43],v[84:87]
v_mfma_f32_16x16x32_bf16 v[84:87],a[140:143],a[36:39],v[84:87]
v_mfma_f32_16x16x32_bf16 v[84:87],a[136:139],a[32:35],v[84:87]
v_mfma_f32_16x16x32_bf16 v[84:87],a[132:135],a[28:31],v[84:87]
buffer_load_dwordx4 v8,s[4:7],s20 offen offset:2048 lds
v_mfma_f32_16x16x32_bf16 v[84:87],a[128:131],a[24:27],v[84:87]
s_add_u32 s20,s20,12288
v_mfma_f32_16x16x32_bf16 v[92:95],a[128:131],a[48:51],0
ds_read_b64_tr_b16 a[120:121],v2 offset:24576
v_mfma_f32_16x16x32_bf16 v[92:95],a[132:135],a[52:55],v[92:95]
ds_read_b64_tr_b16 a[122:123],v2 offset:30720
v_mfma_f32_16x16x32_bf16 v[92:95],a[136:139],a[56:59],v[92:95]
ds_read_b64_tr_b16 a[124:125],v3 offset:24576
v_mfma_f32_16x16x32_bf16 v[92:95],a[140:143],a[60:63],v[92:95]
ds_read_b64_tr_b16 a[126:127],v3 offset:30720
v_mfma_f32_16x16x32_bf16 v[92:95],a[144:147],a[64:67],v[92:95]
v_mfma_f32_16x16x32_bf16 v[92:95],a[148:151],a[68:71],v[92:95]
v_mfma_f32_16x16x32_bf16 v[100:103],a[148:151],a[92:95],0
v_mfma_f32_16x16x32_bf16 v[100:103],a[144:147],a[88:91],v[100:103]
v_mfma_f32_16x16x32_bf16 v[100:103],a[140:143],a[84:87],v[100:103]
v_mfma_f32_16x16x32_bf16 v[100:103],a[136:139],a[80:83],v[100:103]
v_mfma_f32_16x16x32_bf16 v[100:103],a[132:135],a[76:79],v[100:103]
ds_read_b64_tr_b16 a[132:133],v5 offset:24576
v_mfma_f32_16x16x32_bf16 v[100:103],a[128:131],a[72:75],v[100:103]
ds_read_b64_tr_b16 a[128:129],v4 offset:24576
ds_read_b64_tr_b16 a[130:131],v4 offset:30720
ds_read_b64_tr_b16 a[134:135],v5 offset:30720
s_mov_b32 s38,0
s_branch L_loop4
L_end5:
s_waitcnt lgkmcnt(3)
v_mfma_f32_16x16x32_bf16 v[160:163],a[120:123],v[20:23],v[160:163]
ds_read_b64_tr_b16 a[136:137],v2 offset:24704
v_fma_f32 v90,v90,s36,v15
v_mfma_f32_16x16x32_bf16 v[164:167],a[124:127],v[20:23],v[164:167]
ds_read_b64_tr_b16 a[138:139],v2 offset:30848
v_fma_f32 v91,v91,s36,v15
v_mfma_f32_16x16x32_bf16 v[212:215],a[124:127],v[24:27],v[212:215]
ds_read_b64_tr_b16 a[140:141],v3 offset:24704
v_fma_f32 v96,v96,s36,v16
v_mfma_f32_16x16x32_bf16 v[208:211],a[120:123],v[24:27],v[208:211]
ds_read_b64_tr_b16 a[142:143],v3 offset:30848
v_fma_f32 v97,v97,s36,v16
v_mfma_f32_16x16x32_bf16 v[112:115],a[120:123],v[28:31],v[112:115]
ds_read_b64_tr_b16 a[144:145],v4 offset:24704
v_fma_f32 v98,v98,s36,v16
v_mfma_f32_16x16x32_bf16 v[116:119],a[124:127],v[28:31],v[116:119]
ds_read_b64_tr_b16 a[146:147],v4 offset:30848
ds_read_b64_tr_b16 a[148:149],v5 offset:24704
ds_read_b64_tr_b16 a[150:151],v5 offset:30848
v_mfma_f32_16x16x32_bf16 a[164:167],a[124:127],v[32:35],a[164:167]
v_fma_f32 v99,v99,s36,v16
v_fma_f32 v104,v104,s36,v17
v_mfma_f32_16x16x32_bf16 a[160:163],a[120:123],v[32:35],a[160:163]
v_fma_f32 v105,v105,s36,v17
v_fma_f32 v106,v106,s36,v17
v_mfma_f32_16x16x32_bf16 a[208:211],a[120:123],v[36:39],a[208:211]
ds_read_b64_tr_b16 a[120:121],v2 offset:24832
v_fma_f32 v107,v107,s36,v17
v_mfma_f32_16x16x32_bf16 a[212:215],a[124:127],v[36:39],a[212:215]
s_waitcnt lgkmcnt(6)
ds_read_b64_tr_b16 a[122:123],v2 offset:30976
v_fma_f32 v76,v76,s36,v13
v_mfma_f32_16x16x32_bf16 a[216:219],a[128:131],v[36:39],a[216:219]
ds_read_b64_tr_b16 a[124:125],v3 offset:24832
v_fma_f32 v77,v77,s36,v13
v_mfma_f32_16x16x32_bf16 a[220:223],a[132:135],v[36:39],a[220:223]
ds_read_b64_tr_b16 a[126:127],v3 offset:30976
v_fma_f32 v78,v78,s36,v13
v_mfma_f32_16x16x32_bf16 a[172:175],a[132:135],v[32:35],a[172:175]
v_fma_f32 v79,v79,s36,v13
v_fma_f32 v84,v84,s36,v14
v_mfma_f32_16x16x32_bf16 a[168:171],a[128:131],v[32:35],a[168:171]
v_fma_f32 v85,v85,s36,v14
v_fma_f32 v86,v86,s36,v14
v_mfma_f32_16x16x32_bf16 v[120:123],a[128:131],v[28:31],v[120:123]
v_fma_f32 v87,v87,s36,v14
v_fma_f32 v92,v92,s36,v15
v_mfma_f32_16x16x32_bf16 v[124:127],a[132:135],v[28:31],v[124:127]
v_fma_f32 v93,v93,s36,v15
v_fma_f32 v94,v94,s36,v15
v_mfma_f32_16x16x32_bf16 v[220:223],a[132:135],v[24:27],v[220:223]
v_fma_f32 v95,v95,s36,v15
v_fma_f32 v100,v100,s36,v16
v_mfma_f32_16x16x32_bf16 v[216:219],a[128:131],v[24:27],v[216:219]
v_fma_f32 v101,v101,s36,v16
v_fma_f32 v102,v102,s36,v16
v_mfma_f32_16x16x32_bf16 v[168:171],a[128:131],v[20:23],v[168:171]
ds_read_b64_tr_b16 a[128:129],v4 offset:24832
v_fma_f32 v103,v103,s36,v16
v_mfma_f32_16x16x32_bf16 v[172:175],a[132:135],v[20:23],v[172:175]
ds_read_b64_tr_b16 a[130:131],v4 offset:30976
v_fma_f32 v108,v108,s36,v17
v_mfma_f32_16x16x32_bf16 v[176:179],a[136:139],v[20:23],v[176:179]
s_waitcnt lgkmcnt(2)
ds_read_b64_tr_b16 a[132:133],v5 offset:24832
v_fma_f32 v109,v109,s36,v17
v_mfma_f32_16x16x32_bf16 v[180:183],a[140:143],v[20:23],v[180:183]
ds_read_b64_tr_b16 a[134:135],v5 offset:30976
v_fma_f32 v110,v110,s36,v17
v_mfma_f32_16x16x32_bf16 v[228:231],a[140:143],v[24:27],v[228:231]
v_fma_f32 v111,v111,s36,v17
v_exp_f32 v90,v90
v_mfma_f32_16x16x32_bf16 v[224:227],a[136:139],v[24:27],v[224:227]
v_exp_f32 v91,v91
v_mfma_f32_16x16x32_bf16 v[128:131],a[136:139],v[28:31],v[128:131]
v_exp_f32 v96,v96
v_mfma_f32_16x16x32_bf16 v[132:135],a[140:143],v[28:31],v[132:135]
v_exp_f32 v97,v97
v_mfma_f32_16x16x32_bf16 a[180:183],a[140:143],v[32:35],a[180:183]
v_exp_f32 v98,v98
v_mfma_f32_16x16x32_bf16 a[176:179],a[136:139],v[32:35],a[176:179]
v_exp_f32 v99,v99
v_mfma_f32_16x16x32_bf16 a[224:227],a[136:139],v[36:39],a[224:227]
v_exp_f32 v104,v104
v_mfma_f32_16x16x32_bf16 a[228:231],a[140:143],v[36:39],a[228:231]
v_exp_f32 v105,v105
v_mfma_f32_16x16x32_bf16 a[232:235],a[144:147],v[36:39],a[232:235]
v_exp_f32 v106,v106
v_mfma_f32_16x16x32_bf16 a[236:239],a[148:151],v[36:39],a[236:239]
v_exp_f32 v107,v107
v_mfma_f32_16x16x32_bf16 a[188:191],a[148:151],v[32:35],a[188:191]
v_exp_f32 v76,v76
v_mfma_f32_16x16x32_bf16 a[184:187],a[144:147],v[32:35],a[184:187]
v_exp_f32 v77,v77
v_mfma_f32_16x16x32_bf16 v[136:139],a[144:147],v[28:31],v[136:139]
v_exp_f32 v78,v78
v_mfma_f32_16x16x32_bf16 v[140:143],a[148:151],v[28:31],v[140:143]
v_exp_f32 v79,v79
v_mfma_f32_16x16x32_bf16 v[236:239],a[148:151],v[24:27],v[236:239]
v_exp_f32 v84,v84
v_mfma_f32_16x16x32_bf16 v[232:235],a[144:147],v[24:27],v[232:235]
v_exp_f32 v85,v85
v_mfma_f32_16x16x32_bf16 v[184:187],a[144:147],v[20:23],v[184:187]
v_exp_f32 v86,v86
v_mfma_f32_16x16x32_bf16 v[188:191],a[148:151],v[20:23],v[188:191]
v_exp_f32 v87,v87
v_mfma_f32_16x16x32_bf16 v[192:195],a[120:123],v[20:23],v[192:195]
v_exp_f32 v92,v92
v_mfma_f32_16x16x32_bf16 v[196:199],a[124:127],v[20:23],v[196:199]
v_exp_f32 v93,v93
v_mfma_f32_16x16x32_bf16 v[244:247],a[124:127],v[24:27],v[244:247]
v_exp_f32 v94,v94
v_mfma_f32_16x16x32_bf16 v[240:243],a[120:123],v[24:27],v[240:243]
v_exp_f32 v95,v95
v_mfma_f32_16x16x32_bf16 v[144:147],a[120:123],v[28:31],v[144:147]
v_exp_f32 v100,v100
v_mfma_f32_16x16x32_bf16 v[148:151],a[124:127],v[28:31],v[148:151]
v_exp_f32 v101,v101
v_mfma_f32_16x16x32_bf16 a[196:199],a[124:127],v[32:35],a[196:199]
v_exp_f32 v102,v102
v_mfma_f32_16x16x32_bf16 a[192:195],a[120:123],v[32:35],a[192:195]
v_exp_f32 v103,v103
v_mfma_f32_16x16x32_bf16 a[240:243],a[120:123],v[36:39],a[240:243]
v_exp_f32 v108,v108
s_waitcnt vmcnt(14) lgkmcnt(0)
s_barrier
v_mfma_f32_16x16x32_bf16 a[244:247],a[124:127],v[36:39],a[244:247]
v_exp_f32 v109,v109
v_mfma_f32_16x16x32_bf16 a[248:251],a[128:131],v[36:39],a[248:251]
v_exp_f32 v110,v110
v_mfma_f32_16x16x32_bf16 a[252:255],a[132:135],v[36:39],a[252:255]
v_exp_f32 v111,v111
v_mfma_f32_16x16x32_bf16 a[204:207],a[132:135],v[32:35],a[204:207]
v_cvt_pk_bf16_f32 v53,v90,v91
v_cvt_pk_bf16_f32 v56,v96,v97
v_mfma_f32_16x16x32_bf16 a[200:203],a[128:131],v[32:35],a[200:203]
v_cvt_pk_bf16_f32 v57,v98,v99
v_cvt_pk_bf16_f32 v40,v104,v105
v_mfma_f32_16x16x32_bf16 v[152:155],a[128:131],v[28:31],v[152:155]
v_cvt_pk_bf16_f32 v41,v106,v107
v_cvt_pk_bf16_f32 v46,v76,v77
v_mfma_f32_16x16x32_bf16 v[156:159],a[132:135],v[28:31],v[156:159]
v_cvt_pk_bf16_f32 v47,v78,v79
v_cvt_pk_bf16_f32 v50,v84,v85
v_mfma_f32_16x16x32_bf16 v[252:255],a[132:135],v[24:27],v[252:255]
v_cvt_pk_bf16_f32 v51,v86,v87
v_cvt_pk_bf16_f32 v54,v92,v93
v_mfma_f32_16x16x32_bf16 v[248:251],a[128:131],v[24:27],v[248:251]
v_cvt_pk_bf16_f32 v55,v94,v95
v_cvt_pk_bf16_f32 v58,v100,v101
v_smfmac_f32_16x16x64_bf16 v[60:63],a[152:155],v[44:51],v18
v_cvt_pk_bf16_f32 v59,v102,v103
v_mfma_f32_16x16x32_bf16 v[200:203],a[128:131],v[20:23],v[200:203]
v_cvt_pk_bf16_f32 v42,v108,v109
v_cvt_pk_bf16_f32 v43,v110,v111
v_smfmac_f32_16x16x64_bf16 v[64:67],a[152:155],v[52:59],v18
v_subrev_u32 v10,18432,v10
v_smfmac_f32_16x16x64_bf16 v[68:71],a[152:155],v[36:43],v18
v_mfma_f32_16x16x32_bf16 v[204:207],a[132:135],v[20:23],v[204:207]
ds_read_b64_tr_b16 a[136:137],v2 offset:0
ds_read_b64_tr_b16 a[138:139],v2 offset:6144
ds_read_b64_tr_b16 a[140:141],v3 offset:0
ds_read_b64_tr_b16 a[142:143],v3 offset:6144
ds_read_b64_tr_b16 a[144:145],v4 offset:0
ds_read_b64_tr_b16 a[146:147],v4 offset:6144
ds_read_b64_tr_b16 a[148:149],v5 offset:0
ds_read_b64_tr_b16 a[150:151],v5 offset:6144
s_waitcnt lgkmcnt(6)
v_mfma_f32_16x16x32_bf16 v[160:163],a[136:139],v[44:47],v[160:163]
s_waitcnt vmcnt(6)
ds_read_b64_tr_b16 a[120:121],v2 offset:128
v_mbcnt_lo_u32_b32 v39,-1,0
s_waitcnt lgkmcnt(5)
v_mfma_f32_16x16x32_bf16 v[164:167],a[140:143],v[44:47],v[164:167]
s_add_u32 s84,s42,0
ds_read_b64_tr_b16 a[122:123],v2 offset:6272
v_mbcnt_hi_u32_b32 v39,-1,v39
v_mfma_f32_16x16x32_bf16 v[212:215],a[140:143],v[48:51],v[212:215]
s_add_u32 s85,s42,6144
ds_read_b64_tr_b16 a[124:125],v3 offset:128
v_and_b32 v38,7,v39
v_mfma_f32_16x16x32_bf16 v[208:211],a[136:139],v[48:51],v[208:211]
s_add_u32 s86,s42,12288
ds_read_b64_tr_b16 a[126:127],v3 offset:6272
v_add_f32 v68,v68,v69
v_mfma_f32_16x16x32_bf16 v[112:115],a[136:139],v[52:55],v[112:115]
s_add_u32 s87,s42,18432
ds_read_b64_tr_b16 a[128:129],v4 offset:128
v_add_f32 v60,v60,v61
v_mfma_f32_16x16x32_bf16 v[116:119],a[140:143],v[52:55],v[116:119]
s_add_u32 s66,s42,24576
ds_read_b64_tr_b16 a[130:131],v4 offset:6272
ds_read_b64_tr_b16 a[132:133],v5 offset:128
ds_read_b64_tr_b16 a[134:135],v5 offset:6272
v_mfma_f32_16x16x32_bf16 a[164:167],a[140:143],v[56:59],a[164:167]
v_add_f32 v62,v62,v63
v_add_f32 v64,v64,v65
v_mfma_f32_16x16x32_bf16 a[160:163],a[136:139],v[56:59],a[160:163]
v_add_f32 v68,v68,v70
v_add_f32 v66,v66,v67
v_mfma_f32_16x16x32_bf16 a[208:211],a[136:139],v[40:43],a[208:211]
ds_read_b64_tr_b16 a[136:137],v2 offset:256
v_max3_f32 v19,v60,v62,v64
v_mfma_f32_16x16x32_bf16 a[212:215],a[140:143],v[40:43],a[212:215]
s_waitcnt lgkmcnt(6)
ds_read_b64_tr_b16 a[138:139],v2 offset:6400
v_add_f32 v68,v68,v71
v_mfma_f32_16x16x32_bf16 a[216:219],a[144:147],v[40:43],a[216:219]
ds_read_b64_tr_b16 a[140:141],v3 offset:256
v_max3_f32 v19,v19,v66,v68
v_mfma_f32_16x16x32_bf16 a[220:223],a[148:151],v[40:43],a[220:223]
ds_read_b64_tr_b16 a[142:143],v3 offset:6400
v_rcp_f32 v66,v66
v_rcp_f32 v68,v68
v_accvgpr_read_b32 v72,a160
v_accvgpr_read_b32 v73,a161
v_pk_mul_f32 v[72:73],v[72:73],v[66:67] op_sel_hi:[1,0]
v_accvgpr_read_b32 v74,a162
v_accvgpr_read_b32 v75,a163
v_pk_mul_f32 v[74:75],v[74:75],v[66:67] op_sel_hi:[1,0]
v_accvgpr_read_b32 v76,a208
v_accvgpr_read_b32 v77,a209
v_pk_mul_f32 v[76:77],v[76:77],v[68:69] op_sel_hi:[1,0]
v_accvgpr_read_b32 v78,a210
v_accvgpr_read_b32 v79,a211
v_pk_mul_f32 v[78:79],v[78:79],v[68:69] op_sel_hi:[1,0]
v_accvgpr_read_b32 v80,a164
v_accvgpr_read_b32 v81,a165
v_mfma_f32_16x16x32_bf16 a[172:175],a[148:151],v[56:59],a[172:175]
v_accvgpr_read_b32 v82,a166
v_accvgpr_read_b32 v83,a167
v_accvgpr_read_b32 v84,a212
v_accvgpr_read_b32 v85,a213
v_accvgpr_read_b32 v86,a214
v_pk_mul_f32 v[80:81],v[80:81],v[66:67] op_sel_hi:[1,0]
v_pk_mul_f32 v[82:83],v[82:83],v[66:67] op_sel_hi:[1,0]
v_pk_mul_f32 v[84:85],v[84:85],v[68:69] op_sel_hi:[1,0]
v_accvgpr_read_b32 v87,a215
v_pk_mul_f32 v[86:87],v[86:87],v[68:69] op_sel_hi:[1,0]
v_accvgpr_read_b32 v92,a216
v_accvgpr_read_b32 v93,a217
v_mfma_f32_16x16x32_bf16 a[168:171],a[144:147],v[56:59],a[168:171]
v_accvgpr_read_b32 v94,a218
v_accvgpr_read_b32 v95,a219
v_mfma_f32_16x16x32_bf16 v[120:123],a[144:147],v[52:55],v[120:123]
v_accvgpr_read_b32 v100,a220
v_accvgpr_read_b32 v101,a221
v_mfma_f32_16x16x32_bf16 v[124:127],a[148:151],v[52:55],v[124:127]
v_accvgpr_read_b32 v102,a222
v_accvgpr_read_b32 v103,a223
v_mfma_f32_16x16x32_bf16 v[220:223],a[148:151],v[48:51],v[220:223]
v_accvgpr_read_b32 v96,a172
v_accvgpr_read_b32 v97,a173
v_accvgpr_read_b32 v98,a174
v_accvgpr_read_b32 v99,a175
v_accvgpr_read_b32 v88,a168
v_pk_mul_f32 v[92:93],v[92:93],v[68:69] op_sel_hi:[1,0]
v_pk_mul_f32 v[94:95],v[94:95],v[68:69] op_sel_hi:[1,0]
v_pk_mul_f32 v[100:101],v[100:101],v[68:69] op_sel_hi:[1,0]
v_pk_mul_f32 v[102:103],v[102:103],v[68:69] op_sel_hi:[1,0]
v_pk_mul_f32 v[96:97],v[96:97],v[66:67] op_sel_hi:[1,0]
v_pk_mul_f32 v[98:99],v[98:99],v[66:67] op_sel_hi:[1,0]
v_accvgpr_read_b32 v89,a169
v_pk_mul_f32 v[88:89],v[88:89],v[66:67] op_sel_hi:[1,0]
v_accvgpr_read_b32 v90,a170
v_accvgpr_read_b32 v91,a171
v_pk_mul_f32 v[90:91],v[90:91],v[66:67] op_sel_hi:[1,0]
v_cmp_ngt_f32 vcc,s37,v19
v_lshrrev_b32 v19,5,v39
v_mfma_f32_16x16x32_bf16 v[216:219],a[144:147],v[48:51],v[216:219]
v_xor_b32 v38,v38,v19
v_and_b32 v19,15,v39
v_mfma_f32_16x16x32_bf16 v[168:171],a[144:147],v[44:47],v[168:171]
s_cmp_lg_u64 vcc,0
ds_read_b64_tr_b16 a[144:145],v4 offset:256
v_lshl_add_u32 v19,v19,7,s24
v_mfma_f32_16x16x32_bf16 v[172:175],a[148:151],v[44:47],v[172:175]
s_cselect_b32 s62,s32,0
ds_read_b64_tr_b16 a[146:147],v4 offset:6400
v_lshl_add_u32 v19,v38,4,v19
v_mfma_f32_16x16x32_bf16 v[176:179],a[120:123],v[44:47],v[176:179]
s_or_b32 s31,s31,s62
ds_read_b64_tr_b16 a[148:149],v5 offset:256
v_bfe_u32 v38,v39,4,1
s_waitcnt lgkmcnt(3)
v_mfma_f32_16x16x32_bf16 v[180:183],a[124:127],v[44:47],v[180:183]
s_lshl_b32 s32,s32,1
ds_read_b64_tr_b16 a[150:151],v5 offset:6400
v_lshl_add_u32 v36,v38,3,v19
v_mfma_f32_16x16x32_bf16 v[228:231],a[124:127],v[48:51],v[228:231]
v_xor_b32 v37,32,v36
v_xor_b32 v38,64,v36
v_mfma_f32_16x16x32_bf16 v[224:227],a[120:123],v[48:51],v[224:227]
v_bfe_u32 v19,v39,3,1
v_xor_b32 v39,96,v36
v_mfma_f32_16x16x32_bf16 v[128:131],a[120:123],v[52:55],v[128:131]
v_lshlrev_b32 v19,11,v19
v_cvt_pk_bf16_f32 v72,v72,v73
v_mfma_f32_16x16x32_bf16 v[132:135],a[124:127],v[52:55],v[132:135]
v_cvt_pk_bf16_f32 v76,v76,v77
v_cvt_pk_bf16_f32 v80,v80,v81
v_mfma_f32_16x16x32_bf16 a[180:183],a[124:127],v[56:59],a[180:183]
v_cvt_pk_bf16_f32 v84,v84,v85
v_cvt_pk_bf16_f32 v73,v74,v75
v_mfma_f32_16x16x32_bf16 a[176:179],a[120:123],v[56:59],a[176:179]
v_cvt_pk_bf16_f32 v77,v78,v79
v_cvt_pk_bf16_f32 v81,v82,v83
v_mfma_f32_16x16x32_bf16 a[224:227],a[120:123],v[40:43],a[224:227]
ds_write2st64_b64 v36,v[72:73],v[76:77] offset0:36 offset1:40
v_mfma_f32_16x16x32_bf16 a[228:231],a[124:127],v[40:43],a[228:231]
v_cvt_pk_bf16_f32 v85,v86,v87
v_cvt_pk_bf16_f32 v92,v92,v93
v_mfma_f32_16x16x32_bf16 a[232:235],a[128:131],v[40:43],a[232:235]
v_accvgpr_read_b32 v82,a178
v_accvgpr_read_b32 v83,a179
v_mfma_f32_16x16x32_bf16 a[236:239],a[132:135],v[40:43],a[236:239]
v_accvgpr_read_b32 v86,a226
ds_write2st64_b64 v37,v[80:81],v[84:85] offset0:36 offset1:40
v_pk_mul_f32 v[82:83],v[82:83],v[66:67] op_sel_hi:[1,0]
v_accvgpr_read_b32 v87,a227
v_pk_mul_f32 v[86:87],v[86:87],v[68:69] op_sel_hi:[1,0]
v_accvgpr_read_b32 v80,a176
v_accvgpr_read_b32 v81,a177
v_pk_mul_f32 v[80:81],v[80:81],v[66:67] op_sel_hi:[1,0]
v_accvgpr_read_b32 v84,a224
v_accvgpr_read_b32 v85,a225
v_pk_mul_f32 v[84:85],v[84:85],v[68:69] op_sel_hi:[1,0]
v_cvt_pk_bf16_f32 v88,v88,v89
v_cvt_pk_bf16_f32 v93,v94,v95
v_mfma_f32_16x16x32_bf16 a[188:191],a[132:135],v[56:59],a[188:191]
v_cvt_pk_bf16_f32 v89,v90,v91
ds_write2st64_b64 v38,v[88:89],v[92:93] offset0:36 offset1:40
v_accvgpr_read_b32 v94,a230
v_accvgpr_read_b32 v95,a231
v_pk_mul_f32 v[94:95],v[94:95],v[68:69] op_sel_hi:[1,0]
v_accvgpr_read_b32 v90,a182
v_accvgpr_read_b32 v91,a183
v_pk_mul_f32 v[90:91],v[90:91],v[66:67] op_sel_hi:[1,0]
v_accvgpr_read_b32 v88,a180
v_accvgpr_read_b32 v89,a181
v_pk_mul_f32 v[88:89],v[88:89],v[66:67] op_sel_hi:[1,0]
v_accvgpr_read_b32 v92,a228
v_accvgpr_read_b32 v93,a229
v_pk_mul_f32 v[92:93],v[92:93],v[68:69] op_sel_hi:[1,0]
v_cvt_pk_bf16_f32 v100,v100,v101
v_cvt_pk_bf16_f32 v96,v96,v97
v_mfma_f32_16x16x32_bf16 a[184:187],a[128:131],v[56:59],a[184:187]
v_cvt_pk_bf16_f32 v101,v102,v103
v_cvt_pk_bf16_f32 v97,v98,v99
v_mfma_f32_16x16x32_bf16 v[136:139],a[128:131],v[52:55],v[136:139]
ds_write2st64_b64 v39,v[96:97],v[100:101] offset0:36 offset1:40
v_mfma_f32_16x16x32_bf16 v[140:143],a[132:135],v[52:55],v[140:143]
v_cvt_pk_bf16_f32 v80,v80,v81
v_cvt_pk_bf16_f32 v84,v84,v85
v_mfma_f32_16x16x32_bf16 v[236:239],a[132:135],v[48:51],v[236:239]
ds_read_b128 v[104:107],v10 offset:18432
v_cvt_pk_bf16_f32 v81,v82,v83
ds_read_b128 v[108:111],v10 offset:19456
v_cvt_pk_bf16_f32 v85,v86,v87
ds_read_b128 v[72:75],v10 offset:20480
v_accvgpr_read_b32 v102,a234
ds_read_b128 v[76:79],v10 offset:21504
v_accvgpr_read_b32 v103,a235
ds_write2st64_b64 v36,v[80:81],v[84:85] offset0:36 offset1:40
v_pk_mul_f32 v[102:103],v[102:103],v[68:69] op_sel_hi:[1,0]
v_accvgpr_read_b32 v98,a186
v_accvgpr_read_b32 v99,a187
v_pk_mul_f32 v[98:99],v[98:99],v[66:67] op_sel_hi:[1,0]
v_accvgpr_read_b32 v96,a184
v_accvgpr_read_b32 v97,a185
v_pk_mul_f32 v[96:97],v[96:97],v[66:67] op_sel_hi:[1,0]
s_waitcnt lgkmcnt(4)
buffer_store_dwordx4 v[104:107],v9,s[16:19],s87 offen offset:0 nt
v_accvgpr_read_b32 v100,a232
v_accvgpr_read_b32 v101,a233
v_pk_mul_f32 v[100:101],v[100:101],v[68:69] op_sel_hi:[1,0]
v_accvgpr_read_b32 v82,a190
v_accvgpr_read_b32 v83,a191
v_pk_mul_f32 v[82:83],v[82:83],v[66:67] op_sel_hi:[1,0]
v_accvgpr_read_b32 v86,a238
v_accvgpr_read_b32 v87,a239
v_pk_mul_f32 v[86:87],v[86:87],v[68:69] op_sel_hi:[1,0]
v_accvgpr_read_b32 v80,a188
v_accvgpr_read_b32 v81,a189
s_waitcnt lgkmcnt(1)
buffer_store_dwordx4 v[108:111],v9,s[16:19],s87 offen offset:3072 nt
v_pk_mul_f32 v[80:81],v[80:81],v[66:67] op_sel_hi:[1,0]
v_accvgpr_read_b32 v84,a236
v_accvgpr_read_b32 v85,a237
v_pk_mul_f32 v[84:85],v[84:85],v[68:69] op_sel_hi:[1,0]
v_cvt_pk_bf16_f32 v88,v88,v89
v_cvt_pk_bf16_f32 v92,v92,v93
v_mfma_f32_16x16x32_bf16 v[232:235],a[128:131],v[48:51],v[232:235]
v_cvt_pk_bf16_f32 v96,v96,v97
v_cvt_pk_bf16_f32 v100,v100,v101
v_mfma_f32_16x16x32_bf16 v[184:187],a[128:131],v[44:47],v[184:187]
v_cvt_pk_bf16_f32 v89,v90,v91
v_cvt_pk_bf16_f32 v93,v94,v95
v_mfma_f32_16x16x32_bf16 v[188:191],a[132:135],v[44:47],v[188:191]
ds_write2st64_b64 v37,v[88:89],v[92:93] offset0:36 offset1:40
v_mfma_f32_16x16x32_bf16 v[192:195],a[136:139],v[44:47],v[192:195]
v_cvt_pk_bf16_f32 v80,v80,v81
v_cvt_pk_bf16_f32 v84,v84,v85
v_mfma_f32_16x16x32_bf16 v[196:199],a[140:143],v[44:47],v[196:199]
buffer_store_dwordx4 v[72:75],v9,s[16:19],s66 offen offset:0 nt
v_cvt_pk_bf16_f32 v97,v98,v99
v_cvt_pk_bf16_f32 v101,v102,v103
v_cvt_pk_bf16_f32 v81,v82,v83
v_mfma_f32_16x16x32_bf16 v[244:247],a[140:143],v[48:51],v[244:247]
v_cvt_pk_bf16_f32 v85,v86,v87
v_rcp_f32 v62,v62
v_mfma_f32_16x16x32_bf16 v[240:243],a[136:139],v[48:51],v[240:243]
v_rcp_f32 v64,v64
v_mfma_f32_16x16x32_bf16 v[144:147],a[136:139],v[52:55],v[144:147]
ds_write2st64_b64 v38,v[96:97],v[100:101] offset0:36 offset1:40
v_mfma_f32_16x16x32_bf16 v[148:151],a[140:143],v[52:55],v[148:151]
v_rcp_f32 v60,v60
v_mfma_f32_16x16x32_bf16 a[196:199],a[140:143],v[56:59],a[196:199]
buffer_store_dwordx4 v[76:79],v9,s[16:19],s66 offen offset:3072 nt
v_mfma_f32_16x16x32_bf16 a[192:195],a[136:139],v[56:59],a[192:195]
v_mfma_f32_16x16x32_bf16 a[240:243],a[136:139],v[40:43],a[240:243]
v_mfma_f32_16x16x32_bf16 a[244:247],a[140:143],v[40:43],a[244:247]
ds_write2st64_b64 v39,v[80:81],v[84:85] offset0:36 offset1:40
v_mfma_f32_16x16x32_bf16 a[248:251],a[144:147],v[40:43],a[248:251]
v_mfma_f32_16x16x32_bf16 a[252:255],a[148:151],v[40:43],a[252:255]
ds_read_b128 v[72:75],v10 offset:18432
v_accvgpr_read_b32 v96,a196
ds_read_b128 v[76:79],v10 offset:19456
v_accvgpr_read_b32 v104,a192
ds_read_b128 v[88:91],v10 offset:20480
v_accvgpr_read_b32 v105,a193
ds_read_b128 v[92:95],v10 offset:21504
v_pk_mul_f32 v[104:105],v[104:105],v[66:67] op_sel_hi:[1,0]
v_accvgpr_read_b32 v106,a194
v_accvgpr_read_b32 v107,a195
v_pk_mul_f32 v[106:107],v[106:107],v[66:67] op_sel_hi:[1,0]
v_accvgpr_read_b32 v108,a240
v_accvgpr_read_b32 v109,a241
v_pk_mul_f32 v[108:109],v[108:109],v[68:69] op_sel_hi:[1,0]
v_accvgpr_read_b32 v110,a242
v_accvgpr_read_b32 v111,a243
v_pk_mul_f32 v[110:111],v[110:111],v[68:69] op_sel_hi:[1,0]
v_accvgpr_read_b32 v97,a197
v_accvgpr_read_b32 v98,a198
v_mfma_f32_16x16x32_bf16 a[204:207],a[148:151],v[56:59],a[204:207]
s_waitcnt lgkmcnt(3)
v_accvgpr_read_b32 v99,a199
buffer_store_dwordx4 v[72:75],v9,s[16:19],s87 offen offset:128 nt
v_pk_mul_f32 v[96:97],v[96:97],v[66:67] op_sel_hi:[1,0]
v_pk_mul_f32 v[98:99],v[98:99],v[66:67] op_sel_hi:[1,0]
v_accvgpr_read_b32 v100,a244
v_accvgpr_read_b32 v101,a245
v_pk_mul_f32 v[100:101],v[100:101],v[68:69] op_sel_hi:[1,0]
v_accvgpr_read_b32 v102,a246
v_accvgpr_read_b32 v103,a247
v_pk_mul_f32 v[102:103],v[102:103],v[68:69] op_sel_hi:[1,0]
v_cvt_pk_bf16_f32 v104,v104,v105
v_cvt_pk_bf16_f32 v108,v108,v109
v_mfma_f32_16x16x32_bf16 a[200:203],a[144:147],v[56:59],a[200:203]
v_cvt_pk_bf16_f32 v105,v106,v107
v_cvt_pk_bf16_f32 v109,v110,v111
v_mfma_f32_16x16x32_bf16 v[152:155],a[144:147],v[52:55],v[152:155]
ds_write2st64_b64 v36,v[104:105],v[108:109] offset0:36 offset1:40
v_mfma_f32_16x16x32_bf16 v[156:159],a[148:151],v[52:55],v[156:159]
v_add_u32 v36,v36,v19
v_accvgpr_read_b32 v84,a248
v_mfma_f32_16x16x32_bf16 v[252:255],a[148:151],v[48:51],v[252:255]
s_waitcnt lgkmcnt(1)
buffer_store_dwordx4 v[76:79],v9,s[16:19],s87 offen offset:3200 nt
v_accvgpr_read_b32 v85,a249
v_accvgpr_read_b32 v80,a200
v_accvgpr_read_b32 v81,a201
v_pk_mul_f32 v[84:85],v[84:85],v[68:69] op_sel_hi:[1,0]
v_pk_mul_f32 v[80:81],v[80:81],v[66:67] op_sel_hi:[1,0]
v_pk_mul_f32 v[208:209],v[208:209],v[62:63] op_sel_hi:[1,0]
v_pk_mul_f32 v[210:211],v[210:211],v[62:63] op_sel_hi:[1,0]
v_pk_mul_f32 v[224:225],v[224:225],v[62:63] op_sel_hi:[1,0]
v_pk_mul_f32 v[226:227],v[226:227],v[62:63] op_sel_hi:[1,0]
v_pk_mul_f32 v[212:213],v[212:213],v[62:63] op_sel_hi:[1,0]
v_pk_mul_f32 v[214:215],v[214:215],v[62:63] op_sel_hi:[1,0]
buffer_store_dwordx4 v[88:91],v9,s[16:19],s66 offen offset:128 nt
v_pk_mul_f32 v[228:229],v[228:229],v[62:63] op_sel_hi:[1,0]
v_pk_mul_f32 v[230:231],v[230:231],v[62:63] op_sel_hi:[1,0]
v_pk_mul_f32 v[216:217],v[216:217],v[62:63] op_sel_hi:[1,0]
v_pk_mul_f32 v[218:219],v[218:219],v[62:63] op_sel_hi:[1,0]
v_pk_mul_f32 v[232:233],v[232:233],v[62:63] op_sel_hi:[1,0]
v_pk_mul_f32 v[234:235],v[234:235],v[62:63] op_sel_hi:[1,0]
v_pk_mul_f32 v[220:221],v[220:221],v[62:63] op_sel_hi:[1,0]
v_pk_mul_f32 v[222:223],v[222:223],v[62:63] op_sel_hi:[1,0]
v_pk_mul_f32 v[236:237],v[236:237],v[62:63] op_sel_hi:[1,0]
v_pk_mul_f32 v[238:239],v[238:239],v[62:63] op_sel_hi:[1,0]
v_pk_mul_f32 v[240:241],v[240:241],v[62:63] op_sel_hi:[1,0]
buffer_store_dwordx4 v[92:95],v9,s[16:19],s66 offen offset:3200 nt
v_pk_mul_f32 v[242:243],v[242:243],v[62:63] op_sel_hi:[1,0]
v_pk_mul_f32 v[112:113],v[112:113],v[64:65] op_sel_hi:[1,0]
v_pk_mul_f32 v[114:115],v[114:115],v[64:65] op_sel_hi:[1,0]
v_pk_mul_f32 v[244:245],v[244:245],v[62:63] op_sel_hi:[1,0]
v_pk_mul_f32 v[246:247],v[246:247],v[62:63] op_sel_hi:[1,0]
v_pk_mul_f32 v[116:117],v[116:117],v[64:65] op_sel_hi:[1,0]
v_pk_mul_f32 v[118:119],v[118:119],v[64:65] op_sel_hi:[1,0]
v_accvgpr_read_b32 v86,a250
v_accvgpr_read_b32 v87,a251
v_pk_mul_f32 v[86:87],v[86:87],v[68:69] op_sel_hi:[1,0]
v_cvt_pk_bf16_f32 v96,v96,v97
v_cvt_pk_bf16_f32 v100,v100,v101
v_accvgpr_read_b32 v82,a202
v_accvgpr_read_b32 v83,a203
v_pk_mul_f32 v[82:83],v[82:83],v[66:67] op_sel_hi:[1,0]
v_accvgpr_read_b32 v104,a204
v_accvgpr_read_b32 v105,a205
v_pk_mul_f32 v[104:105],v[104:105],v[66:67] op_sel_hi:[1,0]
v_accvgpr_read_b32 v108,a252
v_accvgpr_read_b32 v109,a253
v_pk_mul_f32 v[108:109],v[108:109],v[68:69] op_sel_hi:[1,0]
v_accvgpr_read_b32 v106,a206
v_accvgpr_read_b32 v107,a207
v_pk_mul_f32 v[106:107],v[106:107],v[66:67] op_sel_hi:[1,0]
v_accvgpr_read_b32 v110,a254
v_accvgpr_read_b32 v111,a255
v_pk_mul_f32 v[110:111],v[110:111],v[68:69] op_sel_hi:[1,0]
v_cvt_pk_bf16_f32 v84,v84,v85
v_cvt_pk_bf16_f32 v80,v80,v81
v_mfma_f32_16x16x32_bf16 v[248:251],a[144:147],v[48:51],v[248:251]
v_cvt_pk_bf16_f32 v97,v98,v99
v_cvt_pk_bf16_f32 v101,v102,v103
v_mfma_f32_16x16x32_bf16 v[200:203],a[144:147],v[44:47],v[200:203]
ds_write2st64_b64 v37,v[96:97],v[100:101] offset0:36 offset1:40
v_mfma_f32_16x16x32_bf16 v[204:207],a[148:151],v[44:47],v[204:207]
v_add_u32 v37,v37,v19
v_cvt_pk_bf16_f32 v104,v104,v105
v_cvt_pk_bf16_f32 v108,v108,v109
v_cvt_pk_bf16_f32 v85,v86,v87
v_cvt_pk_bf16_f32 v81,v82,v83
v_pk_mul_f32 v[248:249],v[248:249],v[62:63] op_sel_hi:[1,0]
v_pk_mul_f32 v[120:121],v[120:121],v[64:65] op_sel_hi:[1,0]
v_pk_mul_f32 v[250:251],v[250:251],v[62:63] op_sel_hi:[1,0]
v_pk_mul_f32 v[122:123],v[122:123],v[64:65] op_sel_hi:[1,0]
ds_write2st64_b64 v38,v[80:81],v[84:85] offset0:36 offset1:40
v_pk_mul_f32 v[252:253],v[252:253],v[62:63] op_sel_hi:[1,0]
v_pk_mul_f32 v[124:125],v[124:125],v[64:65] op_sel_hi:[1,0]
v_pk_mul_f32 v[254:255],v[254:255],v[62:63] op_sel_hi:[1,0]
v_pk_mul_f32 v[126:127],v[126:127],v[64:65] op_sel_hi:[1,0]
v_pk_mul_f32 v[128:129],v[128:129],v[64:65] op_sel_hi:[1,0]
v_pk_mul_f32 v[144:145],v[144:145],v[64:65] op_sel_hi:[1,0]
v_pk_mul_f32 v[130:131],v[130:131],v[64:65] op_sel_hi:[1,0]
v_pk_mul_f32 v[146:147],v[146:147],v[64:65] op_sel_hi:[1,0]
v_pk_mul_f32 v[132:133],v[132:133],v[64:65] op_sel_hi:[1,0]
v_pk_mul_f32 v[148:149],v[148:149],v[64:65] op_sel_hi:[1,0]
v_pk_mul_f32 v[134:135],v[134:135],v[64:65] op_sel_hi:[1,0]
v_pk_mul_f32 v[150:151],v[150:151],v[64:65] op_sel_hi:[1,0]
v_pk_mul_f32 v[136:137],v[136:137],v[64:65] op_sel_hi:[1,0]
v_pk_mul_f32 v[152:153],v[152:153],v[64:65] op_sel_hi:[1,0]
v_pk_mul_f32 v[138:139],v[138:139],v[64:65] op_sel_hi:[1,0]
v_pk_mul_f32 v[154:155],v[154:155],v[64:65] op_sel_hi:[1,0]
v_pk_mul_f32 v[140:141],v[140:141],v[64:65] op_sel_hi:[1,0]
v_pk_mul_f32 v[156:157],v[156:157],v[64:65] op_sel_hi:[1,0]
v_pk_mul_f32 v[142:143],v[142:143],v[64:65] op_sel_hi:[1,0]
v_pk_mul_f32 v[158:159],v[158:159],v[64:65] op_sel_hi:[1,0]
v_pk_mul_f32 v[160:161],v[160:161],v[60:61] op_sel_hi:[1,0]
v_pk_mul_f32 v[176:177],v[176:177],v[60:61] op_sel_hi:[1,0]
v_pk_mul_f32 v[162:163],v[162:163],v[60:61] op_sel_hi:[1,0]
v_pk_mul_f32 v[178:179],v[178:179],v[60:61] op_sel_hi:[1,0]
v_pk_mul_f32 v[164:165],v[164:165],v[60:61] op_sel_hi:[1,0]
v_pk_mul_f32 v[180:181],v[180:181],v[60:61] op_sel_hi:[1,0]
v_pk_mul_f32 v[166:167],v[166:167],v[60:61] op_sel_hi:[1,0]
v_pk_mul_f32 v[182:183],v[182:183],v[60:61] op_sel_hi:[1,0]
v_pk_mul_f32 v[168:169],v[168:169],v[60:61] op_sel_hi:[1,0]
v_pk_mul_f32 v[184:185],v[184:185],v[60:61] op_sel_hi:[1,0]
v_pk_mul_f32 v[170:171],v[170:171],v[60:61] op_sel_hi:[1,0]
v_pk_mul_f32 v[186:187],v[186:187],v[60:61] op_sel_hi:[1,0]
v_pk_mul_f32 v[172:173],v[172:173],v[60:61] op_sel_hi:[1,0]
v_pk_mul_f32 v[188:189],v[188:189],v[60:61] op_sel_hi:[1,0]
v_pk_mul_f32 v[174:175],v[174:175],v[60:61] op_sel_hi:[1,0]
v_pk_mul_f32 v[190:191],v[190:191],v[60:61] op_sel_hi:[1,0]
v_pk_mul_f32 v[192:193],v[192:193],v[60:61] op_sel_hi:[1,0]
v_pk_mul_f32 v[194:195],v[194:195],v[60:61] op_sel_hi:[1,0]
v_pk_mul_f32 v[196:197],v[196:197],v[60:61] op_sel_hi:[1,0]
v_pk_mul_f32 v[198:199],v[198:199],v[60:61] op_sel_hi:[1,0]
v_pk_mul_f32 v[200:201],v[200:201],v[60:61] op_sel_hi:[1,0]
v_pk_mul_f32 v[202:203],v[202:203],v[60:61] op_sel_hi:[1,0]
v_pk_mul_f32 v[204:205],v[204:205],v[60:61] op_sel_hi:[1,0]
v_pk_mul_f32 v[206:207],v[206:207],v[60:61] op_sel_hi:[1,0]
v_add_u32 v38,v38,v19
v_cvt_pk_bf16_f32 v105,v106,v107
v_cvt_pk_bf16_f32 v109,v110,v111
ds_write2st64_b64 v39,v[104:105],v[108:109] offset0:36 offset1:40
v_add_u32 v39,v39,v19
v_cvt_pk_bf16_f32 v208,v208,v209
v_cvt_pk_bf16_f32 v224,v224,v225
ds_read_b128 v[72:75],v10 offset:18432
v_cvt_pk_bf16_f32 v212,v212,v213
ds_read_b128 v[76:79],v10 offset:19456
v_cvt_pk_bf16_f32 v228,v228,v229
ds_read_b128 v[88:91],v10 offset:20480
v_cvt_pk_bf16_f32 v209,v210,v211
ds_read_b128 v[92:95],v10 offset:21504
v_cvt_pk_bf16_f32 v225,v226,v227
ds_write2st64_b64 v36,v[208:209],v[224:225] offset0:12 offset1:14
v_cvt_pk_bf16_f32 v216,v216,v217
v_cvt_pk_bf16_f32 v232,v232,v233
v_cvt_pk_bf16_f32 v213,v214,v215
v_cvt_pk_bf16_f32 v229,v230,v231
v_cvt_pk_bf16_f32 v220,v220,v221
v_cvt_pk_bf16_f32 v236,v236,v237
v_cvt_pk_bf16_f32 v217,v218,v219
s_waitcnt lgkmcnt(4)
buffer_store_dwordx4 v[72:75],v9,s[16:19],s87 offen offset:256 nt
v_cvt_pk_bf16_f32 v233,v234,v235
v_cvt_pk_bf16_f32 v221,v222,v223
v_cvt_pk_bf16_f32 v237,v238,v239
v_cvt_pk_bf16_f32 v240,v240,v241
v_cvt_pk_bf16_f32 v112,v112,v113
v_cvt_pk_bf16_f32 v244,v244,v245
v_cvt_pk_bf16_f32 v116,v116,v117
v_cvt_pk_bf16_f32 v241,v242,v243
v_cvt_pk_bf16_f32 v113,v114,v115
ds_write2st64_b64 v37,v[212:213],v[228:229] offset0:12 offset1:14
v_cvt_pk_bf16_f32 v248,v248,v249
v_cvt_pk_bf16_f32 v120,v120,v121
v_cvt_pk_bf16_f32 v245,v246,v247
s_waitcnt lgkmcnt(1)
buffer_store_dwordx4 v[76:79],v9,s[16:19],s87 offen offset:3328 nt
v_cvt_pk_bf16_f32 v117,v118,v119
v_cvt_pk_bf16_f32 v252,v252,v253
v_cvt_pk_bf16_f32 v124,v124,v125
v_cvt_pk_bf16_f32 v249,v250,v251
v_cvt_pk_bf16_f32 v121,v122,v123
v_cvt_pk_bf16_f32 v253,v254,v255
v_cvt_pk_bf16_f32 v125,v126,v127
v_cvt_pk_bf16_f32 v128,v128,v129
v_cvt_pk_bf16_f32 v144,v144,v145
ds_write2st64_b64 v38,v[216:217],v[232:233] offset0:12 offset1:14
v_cvt_pk_bf16_f32 v132,v132,v133
v_cvt_pk_bf16_f32 v148,v148,v149
v_cvt_pk_bf16_f32 v129,v130,v131
buffer_store_dwordx4 v[88:91],v9,s[16:19],s66 offen offset:256 nt
v_cvt_pk_bf16_f32 v145,v146,v147
v_cvt_pk_bf16_f32 v136,v136,v137
v_cvt_pk_bf16_f32 v152,v152,v153
v_cvt_pk_bf16_f32 v133,v134,v135
v_cvt_pk_bf16_f32 v149,v150,v151
v_cvt_pk_bf16_f32 v140,v140,v141
v_cvt_pk_bf16_f32 v156,v156,v157
v_cvt_pk_bf16_f32 v137,v138,v139
v_cvt_pk_bf16_f32 v153,v154,v155
ds_write2st64_b64 v39,v[220:221],v[236:237] offset0:12 offset1:14
v_cvt_pk_bf16_f32 v141,v142,v143
v_cvt_pk_bf16_f32 v157,v158,v159
v_cvt_pk_bf16_f32 v160,v160,v161
ds_read_b128 v[96:99],v10 offset:6144
buffer_store_dwordx4 v[92:95],v9,s[16:19],s66 offen offset:3328 nt
ds_read_b128 v[100:103],v10 offset:9216
v_cvt_pk_bf16_f32 v176,v176,v177
ds_read_b128 v[80:83],v10 offset:7168
v_cvt_pk_bf16_f32 v164,v164,v165
ds_read_b128 v[84:87],v10 offset:10240
v_cvt_pk_bf16_f32 v180,v180,v181
ds_write2st64_b64 v36,v[240:241],v[112:113] offset0:16 offset1:24
v_cvt_pk_bf16_f32 v161,v162,v163
v_cvt_pk_bf16_f32 v177,v178,v179
v_cvt_pk_bf16_f32 v168,v168,v169
v_cvt_pk_bf16_f32 v184,v184,v185
v_cvt_pk_bf16_f32 v165,v166,v167
v_cvt_pk_bf16_f32 v181,v182,v183
v_cvt_pk_bf16_f32 v172,v172,v173
s_waitcnt lgkmcnt(4)
buffer_store_dwordx4 v[96:99],v9,s[16:19],s85 offen offset:0 nt
v_cvt_pk_bf16_f32 v188,v188,v189
v_cvt_pk_bf16_f32 v169,v170,v171
v_cvt_pk_bf16_f32 v185,v186,v187
v_cvt_pk_bf16_f32 v173,v174,v175
v_cvt_pk_bf16_f32 v189,v190,v191
v_cvt_pk_bf16_f32 v192,v192,v193
v_cvt_pk_bf16_f32 v196,v196,v197
v_cvt_pk_bf16_f32 v193,v194,v195
v_cvt_pk_bf16_f32 v200,v200,v201
ds_write2st64_b64 v37,v[244:245],v[116:117] offset0:16 offset1:24
v_cvt_pk_bf16_f32 v197,v198,v199
v_cvt_pk_bf16_f32 v204,v204,v205
v_cvt_pk_bf16_f32 v201,v202,v203
s_waitcnt lgkmcnt(1)
buffer_store_dwordx4 v[100:103],v9,s[16:19],s85 offen offset:3072 nt
v_cvt_pk_bf16_f32 v205,v206,v207
ds_write2st64_b64 v38,v[248:249],v[120:121] offset0:16 offset1:24
buffer_store_dwordx4 v[80:83],v9,s[16:19],s85 offen offset:128 nt
ds_write2st64_b64 v39,v[252:253],v[124:125] offset0:16 offset1:24
ds_read_b128 v[104:107],v10 offset:8192
buffer_store_dwordx4 v[84:87],v9,s[16:19],s85 offen offset:3200 nt
ds_read_b128 v[108:111],v10 offset:11264
ds_read_b128 v[208:211],v10 offset:12288
ds_read_b128 v[224:227],v10 offset:15360
ds_write2st64_b64 v36,v[128:129],v[144:145] offset0:26 offset1:28
s_waitcnt lgkmcnt(4)
buffer_store_dwordx4 v[104:107],v9,s[16:19],s85 offen offset:256 nt
ds_write2st64_b64 v37,v[132:133],v[148:149] offset0:26 offset1:28
s_waitcnt lgkmcnt(1)
buffer_store_dwordx4 v[108:111],v9,s[16:19],s85 offen offset:3328 nt
ds_write2st64_b64 v38,v[136:137],v[152:153] offset0:26 offset1:28
buffer_store_dwordx4 v[208:211],v9,s[16:19],s86 offen offset:0 nt
ds_write2st64_b64 v39,v[140:141],v[156:157] offset0:26 offset1:28
ds_read_b128 v[72:75],v10 offset:13312
buffer_store_dwordx4 v[224:227],v9,s[16:19],s86 offen offset:3072 nt
ds_read_b128 v[76:79],v10 offset:16384
ds_read_b128 v[88:91],v10 offset:14336
ds_read_b128 v[92:95],v10 offset:17408
ds_write2st64_b64 v36,v[160:161],v[176:177] offset0:0 offset1:2
s_waitcnt lgkmcnt(4)
buffer_store_dwordx4 v[72:75],v9,s[16:19],s86 offen offset:128 nt
ds_write2st64_b64 v37,v[164:165],v[180:181] offset0:0 offset1:2
s_waitcnt lgkmcnt(1)
buffer_store_dwordx4 v[76:79],v9,s[16:19],s86 offen offset:3200 nt
ds_write2st64_b64 v38,v[168:169],v[184:185] offset0:0 offset1:2
buffer_store_dwordx4 v[88:91],v9,s[16:19],s86 offen offset:256 nt
ds_write2st64_b64 v39,v[172:173],v[188:189] offset0:0 offset1:2
ds_read_b128 v[212:215],v10 offset:0
buffer_store_dwordx4 v[92:95],v9,s[16:19],s86 offen offset:3328 nt
ds_read_b128 v[228:231],v10 offset:3072
ds_read_b128 v[216:219],v10 offset:1024
ds_read_b128 v[232:235],v10 offset:4096
ds_write_b64 v36,v[192:193] offset:2048
ds_write_b64 v37,v[196:197] offset:2048
s_waitcnt lgkmcnt(5)
buffer_store_dwordx4 v[212:215],v9,s[16:19],s84 offen offset:0 nt
ds_write_b64 v38,v[200:201] offset:2048
s_waitcnt lgkmcnt(2)
buffer_store_dwordx4 v[228:231],v9,s[16:19],s84 offen offset:3072 nt
ds_write_b64 v39,v[204:205] offset:2048
ds_read_b128 v[220:223],v10 offset:2048
buffer_store_dwordx4 v[216:219],v9,s[16:19],s84 offen offset:128 nt
ds_read_b128 v[236:239],v10 offset:5120
buffer_store_dwordx4 v[232:235],v9,s[16:19],s84 offen offset:3200 nt
s_waitcnt lgkmcnt(1)
buffer_store_dwordx4 v[220:223],v9,s[16:19],s84 offen offset:256 nt
s_waitcnt lgkmcnt(0)
buffer_store_dwordx4 v[236:239],v9,s[16:19],s84 offen offset:3328 nt
s_branch L_fin
L_end4:
s_waitcnt lgkmcnt(3)
v_mfma_f32_16x16x32_bf16 v[160:163],a[120:123],v[20:23],v[160:163]
ds_read_b64_tr_b16 a[136:137],v2 offset:24704
v_fma_f32 v82,v82,s36,v14
v_mfma_f32_16x16x32_bf16 v[164:167],a[124:127],v[20:23],v[164:167]
ds_read_b64_tr_b16 a[138:139],v2 offset:30848
v_fma_f32 v83,v83,s36,v14
v_mfma_f32_16x16x32_bf16 v[212:215],a[124:127],v[24:27],v[212:215]
ds_read_b64_tr_b16 a[140:141],v3 offset:24704
v_fma_f32 v88,v88,s36,v15
v_mfma_f32_16x16x32_bf16 v[208:211],a[120:123],v[24:27],v[208:211]
ds_read_b64_tr_b16 a[142:143],v3 offset:30848
v_fma_f32 v89,v89,s36,v15
v_mfma_f32_16x16x32_bf16 v[112:115],a[120:123],v[28:31],v[112:115]
ds_read_b64_tr_b16 a[144:145],v4 offset:24704
v_fma_f32 v90,v90,s36,v15
v_mfma_f32_16x16x32_bf16 v[116:119],a[124:127],v[28:31],v[116:119]
ds_read_b64_tr_b16 a[146:147],v4 offset:30848
ds_read_b64_tr_b16 a[148:149],v5 offset:24704
ds_read_b64_tr_b16 a[150:151],v5 offset:30848
v_mfma_f32_16x16x32_bf16 a[164:167],a[124:127],v[32:35],a[164:167]
ds_read_b64_tr_b16 a[124:125],v3 offset:24832
v_fma_f32 v91,v91,s36,v15
v_mfma_f32_16x16x32_bf16 a[160:163],a[120:123],v[32:35],a[160:163]
s_waitcnt lgkmcnt(8)
ds_read_b64_tr_b16 a[120:121],v2 offset:24832
v_fma_f32 v96,v96,s36,v16
v_mfma_f32_16x16x32_bf16 a[168:171],a[128:131],v[32:35],a[168:171]
ds_read_b64_tr_b16 a[122:123],v2 offset:30976
v_fma_f32 v97,v97,s36,v16
v_mfma_f32_16x16x32_bf16 a[172:175],a[132:135],v[32:35],a[172:175]
ds_read_b64_tr_b16 a[126:127],v3 offset:30976
v_fma_f32 v98,v98,s36,v16
v_mfma_f32_16x16x32_bf16 v[124:127],a[132:135],v[28:31],v[124:127]
v_fma_f32 v99,v99,s36,v16
v_fma_f32 v76,v76,s36,v13
v_mfma_f32_16x16x32_bf16 v[120:123],a[128:131],v[28:31],v[120:123]
v_fma_f32 v77,v77,s36,v13
v_fma_f32 v78,v78,s36,v13
v_mfma_f32_16x16x32_bf16 v[216:219],a[128:131],v[24:27],v[216:219]
v_fma_f32 v79,v79,s36,v13
v_fma_f32 v84,v84,s36,v14
v_mfma_f32_16x16x32_bf16 v[220:223],a[132:135],v[24:27],v[220:223]
v_fma_f32 v85,v85,s36,v14
v_fma_f32 v86,v86,s36,v14
v_mfma_f32_16x16x32_bf16 v[172:175],a[132:135],v[20:23],v[172:175]
ds_read_b64_tr_b16 a[132:133],v5 offset:24832
v_fma_f32 v87,v87,s36,v14
v_mfma_f32_16x16x32_bf16 v[168:171],a[128:131],v[20:23],v[168:171]
s_waitcnt lgkmcnt(2)
ds_read_b64_tr_b16 a[128:129],v4 offset:24832
v_fma_f32 v92,v92,s36,v15
v_mfma_f32_16x16x32_bf16 v[176:179],a[136:139],v[20:23],v[176:179]
ds_read_b64_tr_b16 a[130:131],v4 offset:30976
v_fma_f32 v93,v93,s36,v15
v_mfma_f32_16x16x32_bf16 v[180:183],a[140:143],v[20:23],v[180:183]
ds_read_b64_tr_b16 a[134:135],v5 offset:30976
v_fma_f32 v94,v94,s36,v15
v_mfma_f32_16x16x32_bf16 v[228:231],a[140:143],v[24:27],v[228:231]
v_fma_f32 v95,v95,s36,v15
v_fma_f32 v100,v100,s36,v16
v_mfma_f32_16x16x32_bf16 v[224:227],a[136:139],v[24:27],v[224:227]
v_fma_f32 v101,v101,s36,v16
v_fma_f32 v102,v102,s36,v16
v_mfma_f32_16x16x32_bf16 v[128:131],a[136:139],v[28:31],v[128:131]
v_fma_f32 v103,v103,s36,v16
v_exp_f32 v82,v82
v_mfma_f32_16x16x32_bf16 v[132:135],a[140:143],v[28:31],v[132:135]
v_exp_f32 v83,v83
v_mfma_f32_16x16x32_bf16 a[180:183],a[140:143],v[32:35],a[180:183]
v_exp_f32 v88,v88
v_mfma_f32_16x16x32_bf16 a[176:179],a[136:139],v[32:35],a[176:179]
v_exp_f32 v89,v89
v_mfma_f32_16x16x32_bf16 a[184:187],a[144:147],v[32:35],a[184:187]
v_exp_f32 v90,v90
v_mfma_f32_16x16x32_bf16 a[188:191],a[148:151],v[32:35],a[188:191]
v_exp_f32 v91,v91
v_mfma_f32_16x16x32_bf16 v[140:143],a[148:151],v[28:31],v[140:143]
v_exp_f32 v96,v96
v_mfma_f32_16x16x32_bf16 v[136:139],a[144:147],v[28:31],v[136:139]
v_exp_f32 v97,v97
v_mfma_f32_16x16x32_bf16 v[232:235],a[144:147],v[24:27],v[232:235]
v_exp_f32 v98,v98
v_mfma_f32_16x16x32_bf16 v[236:239],a[148:151],v[24:27],v[236:239]
v_exp_f32 v99,v99
v_mfma_f32_16x16x32_bf16 v[188:191],a[148:151],v[20:23],v[188:191]
v_exp_f32 v76,v76
v_mfma_f32_16x16x32_bf16 v[184:187],a[144:147],v[20:23],v[184:187]
v_exp_f32 v77,v77
v_mfma_f32_16x16x32_bf16 v[192:195],a[120:123],v[20:23],v[192:195]
s_waitcnt lgkmcnt(0)
v_exp_f32 v78,v78
v_mfma_f32_16x16x32_bf16 v[196:199],a[124:127],v[20:23],v[196:199]
v_exp_f32 v79,v79
v_mfma_f32_16x16x32_bf16 v[244:247],a[124:127],v[24:27],v[244:247]
v_exp_f32 v84,v84
v_mfma_f32_16x16x32_bf16 v[240:243],a[120:123],v[24:27],v[240:243]
v_exp_f32 v85,v85
v_mfma_f32_16x16x32_bf16 v[144:147],a[120:123],v[28:31],v[144:147]
v_exp_f32 v86,v86
v_mfma_f32_16x16x32_bf16 v[148:151],a[124:127],v[28:31],v[148:151]
v_exp_f32 v87,v87
v_mfma_f32_16x16x32_bf16 a[196:199],a[124:127],v[32:35],a[196:199]
v_exp_f32 v92,v92
s_waitcnt vmcnt(14)
s_barrier
v_mfma_f32_16x16x32_bf16 a[192:195],a[120:123],v[32:35],a[192:195]
v_exp_f32 v93,v93
v_mfma_f32_16x16x32_bf16 a[200:203],a[128:131],v[32:35],a[200:203]
v_exp_f32 v94,v94
v_mfma_f32_16x16x32_bf16 a[204:207],a[132:135],v[32:35],a[204:207]
v_exp_f32 v95,v95
v_mfma_f32_16x16x32_bf16 v[156:159],a[132:135],v[28:31],v[156:159]
v_exp_f32 v100,v100
v_mfma_f32_16x16x32_bf16 v[152:155],a[128:131],v[28:31],v[152:155]
v_exp_f32 v101,v101
v_mfma_f32_16x16x32_bf16 v[248:251],a[128:131],v[24:27],v[248:251]
v_exp_f32 v102,v102
v_mfma_f32_16x16x32_bf16 v[252:255],a[132:135],v[24:27],v[252:255]
v_exp_f32 v103,v103
v_mfma_f32_16x16x32_bf16 v[204:207],a[132:135],v[20:23],v[204:207]
v_cvt_pk_bf16_f32 v49,v82,v83
v_cvt_pk_bf16_f32 v52,v88,v89
v_mfma_f32_16x16x32_bf16 v[200:203],a[128:131],v[20:23],v[200:203]
v_cvt_pk_bf16_f32 v53,v90,v91
v_cvt_pk_bf16_f32 v56,v96,v97
v_cvt_pk_bf16_f32 v57,v98,v99
v_cvt_pk_bf16_f32 v46,v76,v77
v_cvt_pk_bf16_f32 v47,v78,v79
v_cvt_pk_bf16_f32 v50,v84,v85
v_cvt_pk_bf16_f32 v51,v86,v87
v_cvt_pk_bf16_f32 v54,v92,v93
v_cvt_pk_bf16_f32 v55,v94,v95
v_smfmac_f32_16x16x64_bf16 v[60:63],a[152:155],v[44:51],v18
ds_read_b64_tr_b16 a[136:137],v2 offset:0
ds_read_b64_tr_b16 a[138:139],v2 offset:6144
v_cvt_pk_bf16_f32 v58,v100,v101
v_cvt_pk_bf16_f32 v59,v102,v103
v_subrev_u32 v10,18432,v10
ds_read_b64_tr_b16 a[140:141],v3 offset:0
v_smfmac_f32_16x16x64_bf16 v[64:67],a[152:155],v[52:59],v18
ds_read_b64_tr_b16 a[142:143],v3 offset:6144
ds_read_b64_tr_b16 a[144:145],v4 offset:0
ds_read_b64_tr_b16 a[146:147],v4 offset:6144
ds_read_b64_tr_b16 a[148:149],v5 offset:0
ds_read_b64_tr_b16 a[150:151],v5 offset:6144
s_waitcnt lgkmcnt(6)
v_mfma_f32_16x16x32_bf16 v[160:163],a[136:139],v[44:47],v[160:163]
s_waitcnt vmcnt(6)
ds_read_b64_tr_b16 a[120:121],v2 offset:128
v_mbcnt_lo_u32_b32 v39,-1,0
s_waitcnt lgkmcnt(5)
v_mfma_f32_16x16x32_bf16 v[164:167],a[140:143],v[44:47],v[164:167]
s_add_u32 s84,s42,0
ds_read_b64_tr_b16 a[122:123],v2 offset:6272
v_mbcnt_hi_u32_b32 v39,-1,v39
v_mfma_f32_16x16x32_bf16 v[212:215],a[140:143],v[48:51],v[212:215]
s_add_u32 s85,s42,6144
ds_read_b64_tr_b16 a[124:125],v3 offset:128
v_and_b32 v38,7,v39
v_mfma_f32_16x16x32_bf16 v[208:211],a[136:139],v[48:51],v[208:211]
s_add_u32 s86,s42,12288
ds_read_b64_tr_b16 a[126:127],v3 offset:6272
v_add_f32 v60,v60,v61
v_mfma_f32_16x16x32_bf16 v[112:115],a[136:139],v[52:55],v[112:115]
s_add_u32 s87,s42,18432
ds_read_b64_tr_b16 a[128:129],v4 offset:128
v_add_f32 v62,v62,v63
v_mfma_f32_16x16x32_bf16 v[116:119],a[140:143],v[52:55],v[116:119]
ds_read_b64_tr_b16 a[130:131],v4 offset:6272
ds_read_b64_tr_b16 a[132:133],v5 offset:128
ds_read_b64_tr_b16 a[134:135],v5 offset:6272
v_mfma_f32_16x16x32_bf16 a[164:167],a[140:143],v[56:59],a[164:167]
ds_read_b64_tr_b16 a[140:141],v3 offset:256
v_add_f32 v64,v64,v65
v_mfma_f32_16x16x32_bf16 a[160:163],a[136:139],v[56:59],a[160:163]
s_waitcnt lgkmcnt(8)
ds_read_b64_tr_b16 a[136:137],v2 offset:256
v_add_f32 v66,v66,v67
v_mfma_f32_16x16x32_bf16 a[168:171],a[144:147],v[56:59],a[168:171]
ds_read_b64_tr_b16 a[138:139],v2 offset:6400
v_max3_f32 v19,v60,v62,v64
v_mfma_f32_16x16x32_bf16 a[172:175],a[148:151],v[56:59],a[172:175]
ds_read_b64_tr_b16 a[142:143],v3 offset:6400
v_max_f32 v19,v19,v66
v_mfma_f32_16x16x32_bf16 v[124:127],a[148:151],v[52:55],v[124:127]
v_rcp_f32 v66,v66
v_mfma_f32_16x16x32_bf16 v[120:123],a[144:147],v[52:55],v[120:123]
v_accvgpr_read_b32 v80,a164
v_accvgpr_read_b32 v81,a165
v_mfma_f32_16x16x32_bf16 v[216:219],a[144:147],v[48:51],v[216:219]
v_accvgpr_read_b32 v82,a166
v_accvgpr_read_b32 v83,a167
v_mfma_f32_16x16x32_bf16 v[220:223],a[148:151],v[48:51],v[220:223]
v_accvgpr_read_b32 v72,a160
v_accvgpr_read_b32 v73,a161
v_mfma_f32_16x16x32_bf16 v[172:175],a[148:151],v[44:47],v[172:175]
ds_read_b64_tr_b16 a[148:149],v5 offset:256
v_accvgpr_read_b32 v74,a162
v_mfma_f32_16x16x32_bf16 v[168:171],a[144:147],v[44:47],v[168:171]
s_waitcnt lgkmcnt(2)
ds_read_b64_tr_b16 a[144:145],v4 offset:256
v_accvgpr_read_b32 v75,a163
v_mfma_f32_16x16x32_bf16 v[176:179],a[120:123],v[44:47],v[176:179]
ds_read_b64_tr_b16 a[146:147],v4 offset:6400
v_accvgpr_read_b32 v88,a168
v_mfma_f32_16x16x32_bf16 v[180:183],a[124:127],v[44:47],v[180:183]
ds_read_b64_tr_b16 a[150:151],v5 offset:6400
v_accvgpr_read_b32 v89,a169
v_mfma_f32_16x16x32_bf16 v[228:231],a[124:127],v[48:51],v[228:231]
v_accvgpr_read_b32 v90,a170
v_accvgpr_read_b32 v91,a171
v_mfma_f32_16x16x32_bf16 v[224:227],a[120:123],v[48:51],v[224:227]
v_accvgpr_read_b32 v96,a172
v_accvgpr_read_b32 v97,a173
v_mfma_f32_16x16x32_bf16 v[128:131],a[120:123],v[52:55],v[128:131]
v_accvgpr_read_b32 v98,a174
v_accvgpr_read_b32 v99,a175
v_mfma_f32_16x16x32_bf16 v[132:135],a[124:127],v[52:55],v[132:135]
v_cmp_ngt_f32 vcc,s37,v19
v_lshrrev_b32 v19,5,v39
v_mfma_f32_16x16x32_bf16 a[180:183],a[124:127],v[56:59],a[180:183]
v_xor_b32 v38,v38,v19
v_and_b32 v19,15,v39
v_mfma_f32_16x16x32_bf16 a[176:179],a[120:123],v[56:59],a[176:179]
s_cmp_lg_u64 vcc,0
v_lshl_add_u32 v19,v19,7,s24
v_lshl_add_u32 v19,v38,4,v19
v_mfma_f32_16x16x32_bf16 a[184:187],a[128:131],v[56:59],a[184:187]
s_cselect_b32 s62,s32,0
v_bfe_u32 v38,v39,4,1
v_lshl_add_u32 v36,v38,3,v19
v_mfma_f32_16x16x32_bf16 a[188:191],a[132:135],v[56:59],a[188:191]
s_or_b32 s31,s31,s62
v_xor_b32 v37,32,v36
v_bfe_u32 v19,v39,3,1
v_mfma_f32_16x16x32_bf16 v[140:143],a[132:135],v[52:55],v[140:143]
s_lshl_b32 s32,s32,1
v_xor_b32 v38,64,v36
v_xor_b32 v39,96,v36
v_lshlrev_b32 v19,11,v19
v_accvgpr_read_b32 v84,a180
v_accvgpr_read_b32 v85,a181
v_pk_mul_f32 v[72:73],v[72:73],v[66:67] op_sel_hi:[1,0]
v_pk_mul_f32 v[74:75],v[74:75],v[66:67] op_sel_hi:[1,0]
v_pk_mul_f32 v[80:81],v[80:81],v[66:67] op_sel_hi:[1,0]
v_pk_mul_f32 v[82:83],v[82:83],v[66:67] op_sel_hi:[1,0]
v_pk_mul_f32 v[84:85],v[84:85],v[66:67] op_sel_hi:[1,0]
v_accvgpr_read_b32 v86,a182
v_accvgpr_read_b32 v87,a183
v_pk_mul_f32 v[86:87],v[86:87],v[66:67] op_sel_hi:[1,0]
v_accvgpr_read_b32 v76,a176
v_accvgpr_read_b32 v77,a177
v_pk_mul_f32 v[76:77],v[76:77],v[66:67] op_sel_hi:[1,0]
v_accvgpr_read_b32 v78,a178
v_accvgpr_read_b32 v79,a179
v_pk_mul_f32 v[78:79],v[78:79],v[66:67] op_sel_hi:[1,0]
v_accvgpr_read_b32 v92,a184
v_accvgpr_read_b32 v93,a185
v_mfma_f32_16x16x32_bf16 v[136:139],a[128:131],v[52:55],v[136:139]
v_accvgpr_read_b32 v94,a186
v_accvgpr_read_b32 v95,a187
v_accvgpr_read_b32 v100,a188
v_accvgpr_read_b32 v101,a189
v_accvgpr_read_b32 v102,a190
v_pk_mul_f32 v[88:89],v[88:89],v[66:67] op_sel_hi:[1,0]
v_pk_mul_f32 v[90:91],v[90:91],v[66:67] op_sel_hi:[1,0]
v_pk_mul_f32 v[92:93],v[92:93],v[66:67] op_sel_hi:[1,0]
v_pk_mul_f32 v[94:95],v[94:95],v[66:67] op_sel_hi:[1,0]
v_accvgpr_read_b32 v103,a191
v_cvt_pk_bf16_f32 v72,v72,v73
v_mfma_f32_16x16x32_bf16 v[232:235],a[128:131],v[48:51],v[232:235]
v_cvt_pk_bf16_f32 v76,v76,v77
v_cvt_pk_bf16_f32 v80,v80,v81
v_cvt_pk_bf16_f32 v84,v84,v85
v_cvt_pk_bf16_f32 v73,v74,v75
v_cvt_pk_bf16_f32 v77,v78,v79
ds_write2st64_b64 v36,v[72:73],v[76:77] offset0:36 offset1:40
v_pk_mul_f32 v[96:97],v[96:97],v[66:67] op_sel_hi:[1,0]
v_pk_mul_f32 v[98:99],v[98:99],v[66:67] op_sel_hi:[1,0]
v_pk_mul_f32 v[100:101],v[100:101],v[66:67] op_sel_hi:[1,0]
v_pk_mul_f32 v[102:103],v[102:103],v[66:67] op_sel_hi:[1,0]
v_cvt_pk_bf16_f32 v88,v88,v89
v_cvt_pk_bf16_f32 v92,v92,v93
v_mfma_f32_16x16x32_bf16 v[236:239],a[132:135],v[48:51],v[236:239]
v_cvt_pk_bf16_f32 v81,v82,v83
v_cvt_pk_bf16_f32 v85,v86,v87
v_mfma_f32_16x16x32_bf16 v[188:191],a[132:135],v[44:47],v[188:191]
v_cvt_pk_bf16_f32 v96,v96,v97
v_cvt_pk_bf16_f32 v100,v100,v101
v_mfma_f32_16x16x32_bf16 v[184:187],a[128:131],v[44:47],v[184:187]
ds_write2st64_b64 v37,v[80:81],v[84:85] offset0:36 offset1:40
v_mfma_f32_16x16x32_bf16 v[192:195],a[136:139],v[44:47],v[192:195]
s_waitcnt lgkmcnt(1)
v_cvt_pk_bf16_f32 v89,v90,v91
v_cvt_pk_bf16_f32 v93,v94,v95
v_mfma_f32_16x16x32_bf16 v[196:199],a[140:143],v[44:47],v[196:199]
v_cvt_pk_bf16_f32 v97,v98,v99
v_cvt_pk_bf16_f32 v101,v102,v103
v_mfma_f32_16x16x32_bf16 v[244:247],a[140:143],v[48:51],v[244:247]
v_rcp_f32 v62,v62
v_mfma_f32_16x16x32_bf16 v[240:243],a[136:139],v[48:51],v[240:243]
ds_write2st64_b64 v38,v[88:89],v[92:93] offset0:36 offset1:40
v_mfma_f32_16x16x32_bf16 v[144:147],a[136:139],v[52:55],v[144:147]
v_rcp_f32 v64,v64
v_mfma_f32_16x16x32_bf16 v[148:151],a[140:143],v[52:55],v[148:151]
v_rcp_f32 v60,v60
v_mfma_f32_16x16x32_bf16 a[196:199],a[140:143],v[56:59],a[196:199]
v_mfma_f32_16x16x32_bf16 a[192:195],a[136:139],v[56:59],a[192:195]
ds_write2st64_b64 v39,v[96:97],v[100:101] offset0:36 offset1:40
v_mfma_f32_16x16x32_bf16 a[200:203],a[144:147],v[56:59],a[200:203]
v_mfma_f32_16x16x32_bf16 a[204:207],a[148:151],v[56:59],a[204:207]
ds_read_b128 v[104:107],v10 offset:18432
v_mfma_f32_16x16x32_bf16 v[156:159],a[148:151],v[52:55],v[156:159]
ds_read_b128 v[108:111],v10 offset:19456
ds_read_b128 v[72:75],v10 offset:20480
v_accvgpr_read_b32 v84,a196
ds_read_b128 v[76:79],v10 offset:21504
v_accvgpr_read_b32 v85,a197
v_pk_mul_f32 v[84:85],v[84:85],v[66:67] op_sel_hi:[1,0]
v_accvgpr_read_b32 v86,a198
v_accvgpr_read_b32 v87,a199
v_pk_mul_f32 v[86:87],v[86:87],v[66:67] op_sel_hi:[1,0]
v_accvgpr_read_b32 v80,a192
v_accvgpr_read_b32 v81,a193
v_pk_mul_f32 v[80:81],v[80:81],v[66:67] op_sel_hi:[1,0]
v_accvgpr_read_b32 v82,a194
v_accvgpr_read_b32 v83,a195
v_pk_mul_f32 v[82:83],v[82:83],v[66:67] op_sel_hi:[1,0]
v_accvgpr_read_b32 v88,a200
v_accvgpr_read_b32 v89,a201
v_mfma_f32_16x16x32_bf16 v[152:155],a[144:147],v[52:55],v[152:155]
s_waitcnt lgkmcnt(3)
v_accvgpr_read_b32 v90,a202
buffer_store_dwordx4 v[104:107],v9,s[16:19],s87 offen offset:0 nt
v_pk_mul_f32 v[88:89],v[88:89],v[66:67] op_sel_hi:[1,0]
v_accvgpr_read_b32 v91,a203
v_pk_mul_f32 v[90:91],v[90:91],v[66:67] op_sel_hi:[1,0]
v_cvt_pk_bf16_f32 v80,v80,v81
v_accvgpr_read_b32 v92,a204
v_mfma_f32_16x16x32_bf16 v[248:251],a[144:147],v[48:51],v[248:251]
v_accvgpr_read_b32 v93,a205
v_cvt_pk_bf16_f32 v84,v84,v85
v_cvt_pk_bf16_f32 v81,v82,v83
ds_write_b64 v36,v[80:81] offset:18432
s_waitcnt lgkmcnt(1)
buffer_store_dwordx4 v[108:111],v9,s[16:19],s87 offen offset:3072 nt
v_pk_mul_f32 v[92:93],v[92:93],v[66:67] op_sel_hi:[1,0]
v_pk_mul_f32 v[208:209],v[208:209],v[62:63] op_sel_hi:[1,0]
v_pk_mul_f32 v[210:211],v[210:211],v[62:63] op_sel_hi:[1,0]
v_pk_mul_f32 v[224:225],v[224:225],v[62:63] op_sel_hi:[1,0]
v_pk_mul_f32 v[226:227],v[226:227],v[62:63] op_sel_hi:[1,0]
v_pk_mul_f32 v[212:213],v[212:213],v[62:63] op_sel_hi:[1,0]
v_pk_mul_f32 v[214:215],v[214:215],v[62:63] op_sel_hi:[1,0]
v_pk_mul_f32 v[228:229],v[228:229],v[62:63] op_sel_hi:[1,0]
v_pk_mul_f32 v[230:231],v[230:231],v[62:63] op_sel_hi:[1,0]
v_pk_mul_f32 v[216:217],v[216:217],v[62:63] op_sel_hi:[1,0]
v_pk_mul_f32 v[218:219],v[218:219],v[62:63] op_sel_hi:[1,0]
buffer_store_dwordx4 v[72:75],v9,s[16:19],s87 offen offset:128 nt
v_pk_mul_f32 v[232:233],v[232:233],v[62:63] op_sel_hi:[1,0]
v_pk_mul_f32 v[234:235],v[234:235],v[62:63] op_sel_hi:[1,0]
v_pk_mul_f32 v[220:221],v[220:221],v[62:63] op_sel_hi:[1,0]
v_pk_mul_f32 v[222:223],v[222:223],v[62:63] op_sel_hi:[1,0]
v_pk_mul_f32 v[236:237],v[236:237],v[62:63] op_sel_hi:[1,0]
v_pk_mul_f32 v[238:239],v[238:239],v[62:63] op_sel_hi:[1,0]
v_pk_mul_f32 v[240:241],v[240:241],v[62:63] op_sel_hi:[1,0]
v_pk_mul_f32 v[242:243],v[242:243],v[62:63] op_sel_hi:[1,0]
v_pk_mul_f32 v[112:113],v[112:113],v[64:65] op_sel_hi:[1,0]
v_pk_mul_f32 v[114:115],v[114:115],v[64:65] op_sel_hi:[1,0]
v_pk_mul_f32 v[244:245],v[244:245],v[62:63] op_sel_hi:[1,0]
buffer_store_dwordx4 v[76:79],v9,s[16:19],s87 offen offset:3200 nt
v_pk_mul_f32 v[246:247],v[246:247],v[62:63] op_sel_hi:[1,0]
v_pk_mul_f32 v[116:117],v[116:117],v[64:65] op_sel_hi:[1,0]
v_pk_mul_f32 v[118:119],v[118:119],v[64:65] op_sel_hi:[1,0]
v_add_u32 v36,v36,v19
v_accvgpr_read_b32 v94,a206
v_accvgpr_read_b32 v95,a207
v_pk_mul_f32 v[94:95],v[94:95],v[66:67] op_sel_hi:[1,0]
v_cvt_pk_bf16_f32 v88,v88,v89
v_cvt_pk_bf16_f32 v85,v86,v87
v_mfma_f32_16x16x32_bf16 v[252:255],a[148:151],v[48:51],v[252:255]
ds_write_b64 v37,v[84:85] offset:18432
v_mfma_f32_16x16x32_bf16 v[204:207],a[148:151],v[44:47],v[204:207]
v_add_u32 v37,v37,v19
v_cvt_pk_bf16_f32 v92,v92,v93
v_mfma_f32_16x16x32_bf16 v[200:203],a[144:147],v[44:47],v[200:203]
v_cvt_pk_bf16_f32 v89,v90,v91
ds_write_b64 v38,v[88:89] offset:18432
v_pk_mul_f32 v[248:249],v[248:249],v[62:63] op_sel_hi:[1,0]
v_pk_mul_f32 v[120:121],v[120:121],v[64:65] op_sel_hi:[1,0]
v_pk_mul_f32 v[250:251],v[250:251],v[62:63] op_sel_hi:[1,0]
v_pk_mul_f32 v[122:123],v[122:123],v[64:65] op_sel_hi:[1,0]
v_pk_mul_f32 v[252:253],v[252:253],v[62:63] op_sel_hi:[1,0]
v_pk_mul_f32 v[124:125],v[124:125],v[64:65] op_sel_hi:[1,0]
v_pk_mul_f32 v[254:255],v[254:255],v[62:63] op_sel_hi:[1,0]
v_pk_mul_f32 v[126:127],v[126:127],v[64:65] op_sel_hi:[1,0]
v_pk_mul_f32 v[128:129],v[128:129],v[64:65] op_sel_hi:[1,0]
v_pk_mul_f32 v[144:145],v[144:145],v[64:65] op_sel_hi:[1,0]
v_pk_mul_f32 v[130:131],v[130:131],v[64:65] op_sel_hi:[1,0]
v_pk_mul_f32 v[146:147],v[146:147],v[64:65] op_sel_hi:[1,0]
v_pk_mul_f32 v[132:133],v[132:133],v[64:65] op_sel_hi:[1,0]
v_pk_mul_f32 v[148:149],v[148:149],v[64:65] op_sel_hi:[1,0]
v_pk_mul_f32 v[134:135],v[134:135],v[64:65] op_sel_hi:[1,0]
v_pk_mul_f32 v[150:151],v[150:151],v[64:65] op_sel_hi:[1,0]
v_pk_mul_f32 v[136:137],v[136:137],v[64:65] op_sel_hi:[1,0]
v_pk_mul_f32 v[152:153],v[152:153],v[64:65] op_sel_hi:[1,0]
v_pk_mul_f32 v[138:139],v[138:139],v[64:65] op_sel_hi:[1,0]
v_pk_mul_f32 v[154:155],v[154:155],v[64:65] op_sel_hi:[1,0]
v_pk_mul_f32 v[140:141],v[140:141],v[64:65] op_sel_hi:[1,0]
v_pk_mul_f32 v[156:157],v[156:157],v[64:65] op_sel_hi:[1,0]
v_pk_mul_f32 v[142:143],v[142:143],v[64:65] op_sel_hi:[1,0]
v_pk_mul_f32 v[158:159],v[158:159],v[64:65] op_sel_hi:[1,0]
v_pk_mul_f32 v[160:161],v[160:161],v[60:61] op_sel_hi:[1,0]
v_pk_mul_f32 v[176:177],v[176:177],v[60:61] op_sel_hi:[1,0]
v_pk_mul_f32 v[162:163],v[162:163],v[60:61] op_sel_hi:[1,0]
v_pk_mul_f32 v[178:179],v[178:179],v[60:61] op_sel_hi:[1,0]
v_pk_mul_f32 v[164:165],v[164:165],v[60:61] op_sel_hi:[1,0]
v_pk_mul_f32 v[180:181],v[180:181],v[60:61] op_sel_hi:[1,0]
v_pk_mul_f32 v[166:167],v[166:167],v[60:61] op_sel_hi:[1,0]
v_pk_mul_f32 v[182:183],v[182:183],v[60:61] op_sel_hi:[1,0]
v_pk_mul_f32 v[168:169],v[168:169],v[60:61] op_sel_hi:[1,0]
v_pk_mul_f32 v[184:185],v[184:185],v[60:61] op_sel_hi:[1,0]
v_pk_mul_f32 v[170:171],v[170:171],v[60:61] op_sel_hi:[1,0]
v_pk_mul_f32 v[186:187],v[186:187],v[60:61] op_sel_hi:[1,0]
v_pk_mul_f32 v[172:173],v[172:173],v[60:61] op_sel_hi:[1,0]
v_pk_mul_f32 v[188:189],v[188:189],v[60:61] op_sel_hi:[1,0]
v_pk_mul_f32 v[174:175],v[174:175],v[60:61] op_sel_hi:[1,0]
v_pk_mul_f32 v[190:191],v[190:191],v[60:61] op_sel_hi:[1,0]
v_pk_mul_f32 v[192:193],v[192:193],v[60:61] op_sel_hi:[1,0]
v_pk_mul_f32 v[194:195],v[194:195],v[60:61] op_sel_hi:[1,0]
v_pk_mul_f32 v[196:197],v[196:197],v[60:61] op_sel_hi:[1,0]
v_pk_mul_f32 v[198:199],v[198:199],v[60:61] op_sel_hi:[1,0]
v_pk_mul_f32 v[200:201],v[200:201],v[60:61] op_sel_hi:[1,0]
v_pk_mul_f32 v[202:203],v[202:203],v[60:61] op_sel_hi:[1,0]
v_pk_mul_f32 v[204:205],v[204:205],v[60:61] op_sel_hi:[1,0]
v_pk_mul_f32 v[206:207],v[206:207],v[60:61] op_sel_hi:[1,0]
v_add_u32 v38,v38,v19
v_cvt_pk_bf16_f32 v93,v94,v95
ds_write_b64 v39,v[92:93] offset:18432
ds_read_b128 v[96:99],v10 offset:18432
v_add_u32 v39,v39,v19
ds_read_b128 v[100:103],v10 offset:19456
v_cvt_pk_bf16_f32 v208,v208,v209
v_cvt_pk_bf16_f32 v224,v224,v225
v_cvt_pk_bf16_f32 v212,v212,v213
v_cvt_pk_bf16_f32 v228,v228,v229
v_cvt_pk_bf16_f32 v209,v210,v211
v_cvt_pk_bf16_f32 v225,v226,v227
ds_write2st64_b64 v36,v[208:209],v[224:225] offset0:12 offset1:14
v_cvt_pk_bf16_f32 v216,v216,v217
v_cvt_pk_bf16_f32 v232,v232,v233
v_cvt_pk_bf16_f32 v213,v214,v215
v_cvt_pk_bf16_f32 v229,v230,v231
v_cvt_pk_bf16_f32 v220,v220,v221
v_cvt_pk_bf16_f32 v236,v236,v237
v_cvt_pk_bf16_f32 v217,v218,v219
v_cvt_pk_bf16_f32 v233,v234,v235
v_cvt_pk_bf16_f32 v221,v222,v223
v_cvt_pk_bf16_f32 v237,v238,v239
s_waitcnt lgkmcnt(2)
buffer_store_dwordx4 v[96:99],v9,s[16:19],s87 offen offset:256 nt
v_cvt_pk_bf16_f32 v240,v240,v241
v_cvt_pk_bf16_f32 v112,v112,v113
v_cvt_pk_bf16_f32 v244,v244,v245
v_cvt_pk_bf16_f32 v116,v116,v117
v_cvt_pk_bf16_f32 v241,v242,v243
v_cvt_pk_bf16_f32 v113,v114,v115
v_cvt_pk_bf16_f32 v248,v248,v249
v_cvt_pk_bf16_f32 v120,v120,v121
v_cvt_pk_bf16_f32 v245,v246,v247
ds_write2st64_b64 v37,v[212:213],v[228:229] offset0:12 offset1:14
v_cvt_pk_bf16_f32 v117,v118,v119
v_cvt_pk_bf16_f32 v252,v252,v253
v_cvt_pk_bf16_f32 v124,v124,v125
s_waitcnt lgkmcnt(1)
buffer_store_dwordx4 v[100:103],v9,s[16:19],s87 offen offset:3328 nt
v_cvt_pk_bf16_f32 v249,v250,v251
v_cvt_pk_bf16_f32 v121,v122,v123
v_cvt_pk_bf16_f32 v253,v254,v255
v_cvt_pk_bf16_f32 v125,v126,v127
v_cvt_pk_bf16_f32 v128,v128,v129
v_cvt_pk_bf16_f32 v144,v144,v145
v_cvt_pk_bf16_f32 v132,v132,v133
v_cvt_pk_bf16_f32 v148,v148,v149
v_cvt_pk_bf16_f32 v129,v130,v131
ds_write2st64_b64 v38,v[216:217],v[232:233] offset0:12 offset1:14
v_cvt_pk_bf16_f32 v145,v146,v147
v_cvt_pk_bf16_f32 v136,v136,v137
v_cvt_pk_bf16_f32 v152,v152,v153
v_cvt_pk_bf16_f32 v133,v134,v135
v_cvt_pk_bf16_f32 v149,v150,v151
v_cvt_pk_bf16_f32 v140,v140,v141
v_cvt_pk_bf16_f32 v156,v156,v157
v_cvt_pk_bf16_f32 v137,v138,v139
v_cvt_pk_bf16_f32 v153,v154,v155
v_cvt_pk_bf16_f32 v141,v142,v143
v_cvt_pk_bf16_f32 v157,v158,v159
ds_write2st64_b64 v39,v[220:221],v[236:237] offset0:12 offset1:14
v_cvt_pk_bf16_f32 v160,v160,v161
v_cvt_pk_bf16_f32 v176,v176,v177
v_cvt_pk_bf16_f32 v164,v164,v165
ds_read_b128 v[80:83],v10 offset:6144
v_cvt_pk_bf16_f32 v180,v180,v181
ds_read_b128 v[72:75],v10 offset:9216
v_cvt_pk_bf16_f32 v161,v162,v163
ds_read_b128 v[76:79],v10 offset:7168
v_cvt_pk_bf16_f32 v177,v178,v179
ds_read_b128 v[84:87],v10 offset:10240
v_cvt_pk_bf16_f32 v168,v168,v169
ds_write2st64_b64 v36,v[240:241],v[112:113] offset0:16 offset1:24
v_cvt_pk_bf16_f32 v184,v184,v185
v_cvt_pk_bf16_f32 v165,v166,v167
v_cvt_pk_bf16_f32 v181,v182,v183
v_cvt_pk_bf16_f32 v172,v172,v173
v_cvt_pk_bf16_f32 v188,v188,v189
v_cvt_pk_bf16_f32 v169,v170,v171
v_cvt_pk_bf16_f32 v185,v186,v187
s_waitcnt lgkmcnt(4)
buffer_store_dwordx4 v[80:83],v9,s[16:19],s85 offen offset:0 nt
v_cvt_pk_bf16_f32 v173,v174,v175
v_cvt_pk_bf16_f32 v189,v190,v191
v_cvt_pk_bf16_f32 v192,v192,v193
v_cvt_pk_bf16_f32 v196,v196,v197
v_cvt_pk_bf16_f32 v193,v194,v195
v_cvt_pk_bf16_f32 v200,v200,v201
v_cvt_pk_bf16_f32 v197,v198,v199
v_cvt_pk_bf16_f32 v204,v204,v205
v_cvt_pk_bf16_f32 v201,v202,v203
ds_write2st64_b64 v37,v[244:245],v[116:117] offset0:16 offset1:24
v_cvt_pk_bf16_f32 v205,v206,v207
s_waitcnt lgkmcnt(1)
buffer_store_dwordx4 v[72:75],v9,s[16:19],s85 offen offset:3072 nt
ds_write2st64_b64 v38,v[248:249],v[120:121] offset0:16 offset1:24
buffer_store_dwordx4 v[76:79],v9,s[16:19],s85 offen offset:128 nt
ds_write2st64_b64 v39,v[252:253],v[124:125] offset0:16 offset1:24
ds_read_b128 v[104:107],v10 offset:8192
buffer_store_dwordx4 v[84:87],v9,s[16:19],s85 offen offset:3200 nt
ds_read_b128 v[108:111],v10 offset:11264
ds_read_b128 v[88:91],v10 offset:12288
ds_read_b128 v[92:95],v10 offset:15360
ds_write2st64_b64 v36,v[128:129],v[144:145] offset0:26 offset1:28
s_waitcnt lgkmcnt(4)
buffer_store_dwordx4 v[104:107],v9,s[16:19],s85 offen offset:256 nt
ds_write2st64_b64 v37,v[132:133],v[148:149] offset0:26 offset1:28
s_waitcnt lgkmcnt(1)
buffer_store_dwordx4 v[108:111],v9,s[16:19],s85 offen offset:3328 nt
ds_write2st64_b64 v38,v[136:137],v[152:153] offset0:26 offset1:28
buffer_store_dwordx4 v[88:91],v9,s[16:19],s86 offen offset:0 nt
ds_write2st64_b64 v39,v[140:141],v[156:157] offset0:26 offset1:28
ds_read_b128 v[208:211],v10 offset:13312
buffer_store_dwordx4 v[92:95],v9,s[16:19],s86 offen offset:3072 nt
ds_read_b128 v[224:227],v10 offset:16384
ds_read_b128 v[96:99],v10 offset:14336
ds_read_b128 v[100:103],v10 offset:17408
ds_write2st64_b64 v36,v[160:161],v[176:177] offset0:0 offset1:2
s_waitcnt lgkmcnt(4)
buffer_store_dwordx4 v[208:211],v9,s[16:19],s86 offen offset:128 nt
ds_write2st64_b64 v37,v[164:165],v[180:181] offset0:0 offset1:2
s_waitcnt lgkmcnt(1)
buffer_store_dwordx4 v[224:227],v9,s[16:19],s86 offen offset:3200 nt
ds_write2st64_b64 v38,v[168:169],v[184:185] offset0:0 offset1:2
buffer_store_dwordx4 v[96:99],v9,s[16:19],s86 offen offset:256 nt
ds_write2st64_b64 v39,v[172:173],v[188:189] offset0:0 offset1:2
ds_read_b128 v[212:215],v10 offset:0
buffer_store_dwordx4 v[100:103],v9,s[16:19],s86 offen offset:3328 nt
ds_read_b128 v[228:231],v10 offset:3072
ds_read_b128 v[216:219],v10 offset:1024
ds_read_b128 v[232:235],v10 offset:4096
ds_write_b64 v36,v[192:193] offset:2048
ds_write_b64 v37,v[196:197] offset:2048
s_waitcnt lgkmcnt(5)
buffer_store_dwordx4 v[212:215],v9,s[16:19],s84 offen offset:0 nt
ds_write_b64 v38,v[200:201] offset:2048
s_waitcnt lgkmcnt(2)
buffer_store_dwordx4 v[228:231],v9,s[16:19],s84 offen offset:3072 nt
ds_write_b64 v39,v[204:205] offset:2048
ds_read_b128 v[220:223],v10 offset:2048
buffer_store_dwordx4 v[216:219],v9,s[16:19],s84 offen offset:128 nt
ds_read_b128 v[236:239],v10 offset:5120
buffer_store_dwordx4 v[232:235],v9,s[16:19],s84 offen offset:3200 nt
s_waitcnt lgkmcnt(1)
buffer_store_dwordx4 v[220:223],v9,s[16:19],s84 offen offset:256 nt
s_waitcnt lgkmcnt(0)
buffer_store_dwordx4 v[236:239],v9,s[16:19],s84 offen offset:3328 nt
s_branch L_fin
L_fin:
s_waitcnt vmcnt(0)
L_stamped:
s_cmp_lg_u32 s31,0
s_cbranch_scc1 L_fix
L_done:
L_end:
s_endpgm
L_fix:
s_sub_u32 s62,s24,36864
v_add_u32 v112,s62,v2
v_add_u32 v113,s62,v3
v_add_u32 v114,s62,v4
v_add_u32 v115,s62,v5
v_mbcnt_lo_u32_b32 v19,-1,0
v_mbcnt_hi_u32_b32 v19,-1,v19
v_and_b32 v81,15,v19
v_mul_u32_u24 v81,384,v81
v_lshrrev_b32 v82,4,v19
v_lshl_add_u32 v83,v82,3,v81
v_lshl_add_u32 v81,v82,4,v81
L_fix_pass:
s_ff1_i32_b32 s50,s31
s_bitset0_b32 s31,s50
s_lshl_b32 s62,s50,5
s_add_u32 s62,s62,s34
s_mul_i32 s63,s62,171
s_lshr_b32 s63,s63,9
s_mul_i32 s64,s63,3
s_sub_u32 s62,s62,s64
s_add_u32 s63,s63,s33
s_mul_i32 s30,s63,196608
s_mul_i32 s41,s63,325632
s_lshl_b32 s63,s3,2
s_add_u32 s64,s63,21
s_cmp_eq_u32 s3,0
s_cselect_b32 s64,20,s64
s_cselect_b32 s40,1,0
s_add_u32 s65,s63,37
s_cmp_eq_u32 s62,2
s_cselect_b32 s64,s65,s64
s_cselect_b32 s40,0,s40
s_add_u32 s65,s63,s3
s_cmp_eq_u32 s62,0
s_cselect_b32 s64,s65,s64
s_cselect_b32 s40,1,s40
s_mul_i32 s64,s64,6144
s_add_u32 s41,s41,s64
s_add_u32 s55,s40,4
s_mov_b32 s51,0
L_fix_tile:
buffer_load_dwordx4 a[0:3],v81,s[12:15],s41 offen offset:0
buffer_load_dwordx4 a[4:7],v81,s[12:15],s41 offen offset:64
buffer_load_dwordx4 a[8:11],v81,s[12:15],s41 offen offset:128
buffer_load_dwordx4 a[12:15],v81,s[12:15],s41 offen offset:192
buffer_load_dwordx4 a[16:19],v81,s[12:15],s41 offen offset:256
buffer_load_dwordx4 a[20:23],v81,s[12:15],s41 offen offset:320
v_mov_b32 v80,0xff800000
s_mov_b32 s53,s30
s_mov_b32 s52,0
L_fix_max:
s_mov_b32 s63,s53
s_add_u32 m0,s24,0
s_nop 0
buffer_load_dwordx4 v6,s[4:7],s63 offen offset:0 lds
buffer_load_dwordx4 v7,s[4:7],s63 offen offset:1024 lds
buffer_load_dwordx4 v8,s[4:7],s63 offen offset:2048 lds
s_add_u32 s63,s63,3072
s_add_u32 m0,s24,3072
s_nop 0
buffer_load_dwordx4 v6,s[4:7],s63 offen offset:0 lds
buffer_load_dwordx4 v7,s[4:7],s63 offen offset:1024 lds
buffer_load_dwordx4 v8,s[4:7],s63 offen offset:2048 lds
s_add_u32 s63,s63,3072
s_add_u32 m0,s24,6144
s_nop 0
buffer_load_dwordx4 v6,s[4:7],s63 offen offset:0 lds
buffer_load_dwordx4 v7,s[4:7],s63 offen offset:1024 lds
buffer_load_dwordx4 v8,s[4:7],s63 offen offset:2048 lds
s_add_u32 s63,s63,3072
s_add_u32 m0,s24,9216
s_nop 0
buffer_load_dwordx4 v6,s[4:7],s63 offen offset:0 lds
buffer_load_dwordx4 v7,s[4:7],s63 offen offset:1024 lds
buffer_load_dwordx4 v8,s[4:7],s63 offen offset:2048 lds
s_add_u32 s63,s63,3072
s_waitcnt vmcnt(0)
ds_read_b128 a[160:163],v11 offset:0
ds_read_b128 a[164:167],v12 offset:0
ds_read_b128 a[168:171],v11 offset:128
ds_read_b128 a[172:175],v12 offset:128
ds_read_b128 a[176:179],v11 offset:256
ds_read_b128 a[180:183],v12 offset:256
ds_read_b128 a[184:187],v11 offset:6144
ds_read_b128 a[188:191],v12 offset:6144
ds_read_b128 a[192:195],v11 offset:6272
ds_read_b128 a[196:199],v12 offset:6272
ds_read_b128 a[200:203],v11 offset:6400
ds_read_b128 a[204:207],v12 offset:6400
s_waitcnt lgkmcnt(0)
v_mfma_f32_16x16x32_bf16 v[72:75],a[160:163],a[0:3],0
v_mfma_f32_16x16x32_bf16 v[72:75],a[164:167],a[4:7],v[72:75]
v_mfma_f32_16x16x32_bf16 v[72:75],a[168:171],a[8:11],v[72:75]
v_mfma_f32_16x16x32_bf16 v[72:75],a[172:175],a[12:15],v[72:75]
v_mfma_f32_16x16x32_bf16 v[72:75],a[176:179],a[16:19],v[72:75]
v_mfma_f32_16x16x32_bf16 v[72:75],a[180:183],a[20:23],v[72:75]
v_mfma_f32_16x16x32_bf16 v[76:79],a[184:187],a[0:3],0
v_mfma_f32_16x16x32_bf16 v[76:79],a[188:191],a[4:7],v[76:79]
v_mfma_f32_16x16x32_bf16 v[76:79],a[192:195],a[8:11],v[76:79]
v_mfma_f32_16x16x32_bf16 v[76:79],a[196:199],a[12:15],v[76:79]
v_mfma_f32_16x16x32_bf16 v[76:79],a[200:203],a[16:19],v[76:79]
v_mfma_f32_16x16x32_bf16 v[76:79],a[204:207],a[20:23],v[76:79]
s_nop 7
v_max3_f32 v80,v80,v72,v73
v_max3_f32 v80,v80,v74,v75
v_max3_f32 v80,v80,v76,v77
v_max3_f32 v80,v80,v78,v79
s_add_u32 s53,s53,12288
s_add_u32 s52,s52,1
s_cmp_lt_u32 s52,16
s_cbranch_scc1 L_fix_max
v_mov_b32 v19,v80
s_nop 1
v_permlane32_swap_b32 v19,v80
v_max_f32 v80,v80,v19
v_mov_b32 v19,v80
s_nop 1
v_permlane16_swap_b32 v19,v80
v_max_f32 v80,v80,v19
v_mul_f32_e64 v13,-s36,v80
v_mov_b32 v160,0
v_mov_b32 v161,0
v_mov_b32 v162,0
v_mov_b32 v163,0
v_mov_b32 v164,0
v_mov_b32 v165,0
v_mov_b32 v166,0
v_mov_b32 v167,0
v_mov_b32 v168,0
v_mov_b32 v169,0
v_mov_b32 v170,0
v_mov_b32 v171,0
v_mov_b32 v172,0
v_mov_b32 v173,0
v_mov_b32 v174,0
v_mov_b32 v175,0
v_mov_b32 v176,0
v_mov_b32 v177,0
v_mov_b32 v178,0
v_mov_b32 v179,0
v_mov_b32 v180,0
v_mov_b32 v181,0
v_mov_b32 v182,0
v_mov_b32 v183,0
v_mov_b32 v184,0
v_mov_b32 v185,0
v_mov_b32 v186,0
v_mov_b32 v187,0
v_mov_b32 v188,0
v_mov_b32 v189,0
v_mov_b32 v190,0
v_mov_b32 v191,0
v_mov_b32 v192,0
v_mov_b32 v193,0
v_mov_b32 v194,0
v_mov_b32 v195,0
v_mov_b32 v196,0
v_mov_b32 v197,0
v_mov_b32 v198,0
v_mov_b32 v199,0
v_mov_b32 v200,0
v_mov_b32 v201,0
v_mov_b32 v202,0
v_mov_b32 v203,0
v_mov_b32 v204,0
v_mov_b32 v205,0
v_mov_b32 v206,0
v_mov_b32 v207,0
v_mov_b32 v60,0
v_mov_b32 v24,0
v_mov_b32 v61,0
v_mov_b32 v25,0
v_mov_b32 v62,0
v_mov_b32 v26,0
v_mov_b32 v63,0
v_mov_b32 v27,0
s_mov_b32 s53,s30
s_mov_b32 s52,0
L_fix_acc:
s_mov_b32 s63,s53
s_add_u32 m0,s24,0
s_nop 0
buffer_load_dwordx4 v6,s[4:7],s63 offen offset:0 lds
buffer_load_dwordx4 v7,s[4:7],s63 offen offset:1024 lds
buffer_load_dwordx4 v8,s[4:7],s63 offen offset:2048 lds
s_add_u32 s63,s63,3072
s_add_u32 m0,s24,3072
s_nop 0
buffer_load_dwordx4 v6,s[4:7],s63 offen offset:0 lds
buffer_load_dwordx4 v7,s[4:7],s63 offen offset:1024 lds
buffer_load_dwordx4 v8,s[4:7],s63 offen offset:2048 lds
s_add_u32 s63,s63,3072
s_add_u32 m0,s24,6144
s_nop 0
buffer_load_dwordx4 v6,s[4:7],s63 offen offset:0 lds
buffer_load_dwordx4 v7,s[4:7],s63 offen offset:1024 lds
buffer_load_dwordx4 v8,s[4:7],s63 offen offset:2048 lds
s_add_u32 s63,s63,3072
s_add_u32 m0,s24,9216
s_nop 0
buffer_load_dwordx4 v6,s[4:7],s63 offen offset:0 lds
buffer_load_dwordx4 v7,s[4:7],s63 offen offset:1024 lds
buffer_load_dwordx4 v8,s[4:7],s63 offen offset:2048 lds
s_add_u32 s63,s63,3072
s_waitcnt vmcnt(0)
ds_read_b128 a[160:163],v11 offset:0
ds_read_b128 a[164:167],v12 offset:0
ds_read_b128 a[168:171],v11 offset:128
ds_read_b128 a[172:175],v12 offset:128
ds_read_b128 a[176:179],v11 offset:256
ds_read_b128 a[180:183],v12 offset:256
ds_read_b128 a[184:187],v11 offset:6144
ds_read_b128 a[188:191],v12 offset:6144
ds_read_b128 a[192:195],v11 offset:6272
ds_read_b128 a[196:199],v12 offset:6272
ds_read_b128 a[200:203],v11 offset:6400
ds_read_b128 a[204:207],v12 offset:6400
s_waitcnt lgkmcnt(0)
v_mfma_f32_16x16x32_bf16 v[72:75],a[160:163],a[0:3],0
v_mfma_f32_16x16x32_bf16 v[72:75],a[164:167],a[4:7],v[72:75]
v_mfma_f32_16x16x32_bf16 v[72:75],a[168:171],a[8:11],v[72:75]
v_mfma_f32_16x16x32_bf16 v[72:75],a[172:175],a[12:15],v[72:75]
v_mfma_f32_16x16x32_bf16 v[72:75],a[176:179],a[16:19],v[72:75]
v_mfma_f32_16x16x32_bf16 v[72:75],a[180:183],a[20:23],v[72:75]
v_mfma_f32_16x16x32_bf16 v[76:79],a[184:187],a[0:3],0
v_mfma_f32_16x16x32_bf16 v[76:79],a[188:191],a[4:7],v[76:79]
v_mfma_f32_16x16x32_bf16 v[76:79],a[192:195],a[8:11],v[76:79]
v_mfma_f32_16x16x32_bf16 v[76:79],a[196:199],a[12:15],v[76:79]
v_mfma_f32_16x16x32_bf16 v[76:79],a[200:203],a[16:19],v[76:79]
v_mfma_f32_16x16x32_bf16 v[76:79],a[204:207],a[20:23],v[76:79]
s_nop 7
v_fma_f32 v72,v72,s36,v13
v_fma_f32 v73,v73,s36,v13
v_exp_f32 v72,v72
v_exp_f32 v73,v73
s_nop 0
v_cvt_pk_bf16_f32 v20,v72,v73
v_fma_f32 v74,v74,s36,v13
v_fma_f32 v75,v75,s36,v13
v_exp_f32 v74,v74
v_exp_f32 v75,v75
s_nop 0
v_cvt_pk_bf16_f32 v21,v74,v75
v_fma_f32 v76,v76,s36,v13
v_fma_f32 v77,v77,s36,v13
v_exp_f32 v76,v76
v_exp_f32 v77,v77
s_nop 0
v_cvt_pk_bf16_f32 v22,v76,v77
v_fma_f32 v78,v78,s36,v13
v_fma_f32 v79,v79,s36,v13
v_exp_f32 v78,v78
v_exp_f32 v79,v79
s_nop 0
v_cvt_pk_bf16_f32 v23,v78,v79
s_nop 1
v_smfmac_f32_16x16x64_bf16 v[60:63],a[152:155],v[20:27],v18
s_mov_b32 s63,s53
s_add_u32 m0,s24,0
s_nop 0
buffer_load_dwordx4 v6,s[8:11],s63 offen offset:0 lds
buffer_load_dwordx4 v7,s[8:11],s63 offen offset:1024 lds
buffer_load_dwordx4 v8,s[8:11],s63 offen offset:2048 lds
s_add_u32 s63,s63,3072
s_add_u32 m0,s24,3072
s_nop 0
buffer_load_dwordx4 v6,s[8:11],s63 offen offset:0 lds
buffer_load_dwordx4 v7,s[8:11],s63 offen offset:1024 lds
buffer_load_dwordx4 v8,s[8:11],s63 offen offset:2048 lds
s_add_u32 s63,s63,3072
s_add_u32 m0,s24,6144
s_nop 0
buffer_load_dwordx4 v6,s[8:11],s63 offen offset:0 lds
buffer_load_dwordx4 v7,s[8:11],s63 offen offset:1024 lds
buffer_load_dwordx4 v8,s[8:11],s63 offen offset:2048 lds
s_add_u32 s63,s63,3072
s_add_u32 m0,s24,9216
s_nop 0
buffer_load_dwordx4 v6,s[8:11],s63 offen offset:0 lds
buffer_load_dwordx4 v7,s[8:11],s63 offen offset:1024 lds
buffer_load_dwordx4 v8,s[8:11],s63 offen offset:2048 lds
s_add_u32 s63,s63,3072
s_waitcnt vmcnt(0)
ds_read_b64_tr_b16 a[160:161],v112 offset:0
ds_read_b64_tr_b16 a[162:163],v112 offset:6144
ds_read_b64_tr_b16 a[164:165],v113 offset:0
ds_read_b64_tr_b16 a[166:167],v113 offset:6144
ds_read_b64_tr_b16 a[168:169],v114 offset:0
ds_read_b64_tr_b16 a[170:171],v114 offset:6144
ds_read_b64_tr_b16 a[172:173],v115 offset:0
ds_read_b64_tr_b16 a[174:175],v115 offset:6144
ds_read_b64_tr_b16 a[176:177],v112 offset:128
ds_read_b64_tr_b16 a[178:179],v112 offset:6272
ds_read_b64_tr_b16 a[180:181],v113 offset:128
ds_read_b64_tr_b16 a[182:183],v113 offset:6272
ds_read_b64_tr_b16 a[184:185],v114 offset:128
ds_read_b64_tr_b16 a[186:187],v114 offset:6272
ds_read_b64_tr_b16 a[188:189],v115 offset:128
ds_read_b64_tr_b16 a[190:191],v115 offset:6272
ds_read_b64_tr_b16 a[192:193],v112 offset:256
ds_read_b64_tr_b16 a[194:195],v112 offset:6400
ds_read_b64_tr_b16 a[196:197],v113 offset:256
ds_read_b64_tr_b16 a[198:199],v113 offset:6400
ds_read_b64_tr_b16 a[200:201],v114 offset:256
ds_read_b64_tr_b16 a[202:203],v114 offset:6400
ds_read_b64_tr_b16 a[204:205],v115 offset:256
ds_read_b64_tr_b16 a[206:207],v115 offset:6400
s_waitcnt lgkmcnt(0)
v_mfma_f32_16x16x32_bf16 v[160:163],a[160:163],v[20:23],v[160:163]
v_mfma_f32_16x16x32_bf16 v[164:167],a[164:167],v[20:23],v[164:167]
v_mfma_f32_16x16x32_bf16 v[168:171],a[168:171],v[20:23],v[168:171]
v_mfma_f32_16x16x32_bf16 v[172:175],a[172:175],v[20:23],v[172:175]
v_mfma_f32_16x16x32_bf16 v[176:179],a[176:179],v[20:23],v[176:179]
v_mfma_f32_16x16x32_bf16 v[180:183],a[180:183],v[20:23],v[180:183]
v_mfma_f32_16x16x32_bf16 v[184:187],a[184:187],v[20:23],v[184:187]
v_mfma_f32_16x16x32_bf16 v[188:191],a[188:191],v[20:23],v[188:191]
v_mfma_f32_16x16x32_bf16 v[192:195],a[192:195],v[20:23],v[192:195]
v_mfma_f32_16x16x32_bf16 v[196:199],a[196:199],v[20:23],v[196:199]
v_mfma_f32_16x16x32_bf16 v[200:203],a[200:203],v[20:23],v[200:203]
v_mfma_f32_16x16x32_bf16 v[204:207],a[204:207],v[20:23],v[204:207]
s_add_u32 s53,s53,12288
s_add_u32 s52,s52,1
s_cmp_lt_u32 s52,16
s_cbranch_scc1 L_fix_acc
s_nop 7
v_add_f32 v19,v60,v61
v_rcp_f32 v19,v19
s_nop 0
v_mul_f32 v160,v160,v19
v_mul_f32 v161,v161,v19
v_mul_f32 v162,v162,v19
v_mul_f32 v163,v163,v19
v_cvt_pk_bf16_f32 v160,v160,v161
v_cvt_pk_bf16_f32 v161,v162,v163
buffer_store_dwordx2 v[160:161],v83,s[16:19],s41 offen offset:0
v_mul_f32 v164,v164,v19
v_mul_f32 v165,v165,v19
v_mul_f32 v166,v166,v19
v_mul_f32 v167,v167,v19
v_cvt_pk_bf16_f32 v164,v164,v165
v_cvt_pk_bf16_f32 v165,v166,v167
buffer_store_dwordx2 v[164:165],v83,s[16:19],s41 offen offset:32
v_mul_f32 v168,v168,v19
v_mul_f32 v169,v169,v19
v_mul_f32 v170,v170,v19
v_mul_f32 v171,v171,v19
v_cvt_pk_bf16_f32 v168,v168,v169
v_cvt_pk_bf16_f32 v169,v170,v171
buffer_store_dwordx2 v[168:169],v83,s[16:19],s41 offen offset:64
v_mul_f32 v172,v172,v19
v_mul_f32 v173,v173,v19
v_mul_f32 v174,v174,v19
v_mul_f32 v175,v175,v19
v_cvt_pk_bf16_f32 v172,v172,v173
v_cvt_pk_bf16_f32 v173,v174,v175
buffer_store_dwordx2 v[172:173],v83,s[16:19],s41 offen offset:96
v_mul_f32 v176,v176,v19
v_mul_f32 v177,v177,v19
v_mul_f32 v178,v178,v19
v_mul_f32 v179,v179,v19
v_cvt_pk_bf16_f32 v176,v176,v177
v_cvt_pk_bf16_f32 v177,v178,v179
buffer_store_dwordx2 v[176:177],v83,s[16:19],s41 offen offset:128
v_mul_f32 v180,v180,v19
v_mul_f32 v181,v181,v19
v_mul_f32 v182,v182,v19
v_mul_f32 v183,v183,v19
v_cvt_pk_bf16_f32 v180,v180,v181
v_cvt_pk_bf16_f32 v181,v182,v183
buffer_store_dwordx2 v[180:181],v83,s[16:19],s41 offen offset:160
v_mul_f32 v184,v184,v19
v_mul_f32 v185,v185,v19
v_mul_f32 v186,v186,v19
v_mul_f32 v187,v187,v19
v_cvt_pk_bf16_f32 v184,v184,v185
v_cvt_pk_bf16_f32 v185,v186,v187
buffer_store_dwordx2 v[184:185],v83,s[16:19],s41 offen offset:192
v_mul_f32 v188,v188,v19
v_mul_f32 v189,v189,v19
v_mul_f32 v190,v190,v19
v_mul_f32 v191,v191,v19
v_cvt_pk_bf16_f32 v188,v188,v189
v_cvt_pk_bf16_f32 v189,v190,v191
buffer_store_dwordx2 v[188:189],v83,s[16:19],s41 offen offset:224
v_mul_f32 v192,v192,v19
v_mul_f32 v193,v193,v19
v_mul_f32 v194,v194,v19
v_mul_f32 v195,v195,v19
v_cvt_pk_bf16_f32 v192,v192,v193
v_cvt_pk_bf16_f32 v193,v194,v195
buffer_store_dwordx2 v[192:193],v83,s[16:19],s41 offen offset:256
v_mul_f32 v196,v196,v19
v_mul_f32 v197,v197,v19
v_mul_f32 v198,v198,v19
v_mul_f32 v199,v199,v19
v_cvt_pk_bf16_f32 v196,v196,v197
v_cvt_pk_bf16_f32 v197,v198,v199
buffer_store_dwordx2 v[196:197],v83,s[16:19],s41 offen offset:288
v_mul_f32 v200,v200,v19
v_mul_f32 v201,v201,v19
v_mul_f32 v202,v202,v19
v_mul_f32 v203,v203,v19
v_cvt_pk_bf16_f32 v200,v200,v201
v_cvt_pk_bf16_f32 v201,v202,v203
buffer_store_dwordx2 v[200:201],v83,s[16:19],s41 offen offset:320
v_mul_f32 v204,v204,v19
v_mul_f32 v205,v205,v19
v_mul_f32 v206,v206,v19
v_mul_f32 v207,v207,v19
v_cvt_pk_bf16_f32 v204,v204,v205
v_cvt_pk_bf16_f32 v205,v206,v207
buffer_store_dwordx2 v[204:205],v83,s[16:19],s41 offen offset:352
s_waitcnt vmcnt(0)
s_add_u32 s41,s41,6144
s_add_u32 s51,s51,1
s_cmp_lt_u32 s51,s55
s_cbranch_scc1 L_fix_tile
s_cmp_lg_u32 s31,0
s_cbranch_scc1 L_fix_pass
s_branch L_done
L_codeend:
.section .rodata,"a"
.p2align 6
.amdhsa_kernel standalone__gqa_softmax__near_ridge_kernel
  .amdhsa_next_free_vgpr 512
  .amdhsa_next_free_sgpr 102
  .amdhsa_accum_offset 256
  .amdhsa_group_segment_fixed_size 0
  .amdhsa_kernarg_size 48
  .amdhsa_user_sgpr_count 2
  .amdhsa_user_sgpr_kernarg_segment_ptr 1
  .amdhsa_system_sgpr_workgroup_id_x 1
.end_amdhsa_kernel
```

```asm
; @launch grid=(256,1,1) block=(256,1,1) lds=163840
.amdgcn_target "amdgcn-amd-amdhsa--gfx950"
.text
.globl standalone__gqa_softmax__near_ridge_kernel
.p2align 8
.type standalone__gqa_softmax__near_ridge_kernel,@function
standalone__gqa_softmax__near_ridge_kernel:
s_cmp_ge_u32 s2,256
s_cbranch_scc1 L_end
s_load_dwordx4 s[84:87],s[0:1],0
s_load_dwordx4 s[88:91],s[0:1],16
v_lshrrev_b32 v80,6,v0
v_and_b32 v19,63,v0
v_readfirstlane_b32 s3,v80
s_lshr_b32 s34,s2,3
s_getpc_b64 s[92:93]
L_pc:
s_mul_i32 s62,s34,4096
v_min_u32 v80,31,v19
v_lshlrev_b32 v80,7,v80
v_add_u32 v80,s62,v80
v_min_u32 v80,L_codeend-L_pc-4,v80
s_cmp_lg_u32 s3,0
s_cbranch_scc1 L_nopre
global_load_dword v60,v80,s[92:93]
L_nopre:
v_lshrrev_b32 v80,3,v19
v_and_b32 v82,7,v19
v_add_u32 v81,0,v80
v_mul_u32_u24 v81,43,v81
v_lshrrev_b32 v81,7,v81
v_and_b32 v81,6,v81
v_xor_b32 v81,v81,v82
v_lshlrev_b32 v81,4,v81
v_lshl_add_u32 v6,v80,7,v81
v_add_u32 v81,8,v80
v_mul_u32_u24 v81,43,v81
v_lshrrev_b32 v81,7,v81
v_and_b32 v81,6,v81
v_xor_b32 v81,v81,v82
v_lshlrev_b32 v81,4,v81
v_lshl_add_u32 v7,v80,7,v81
v_add_u32 v81,16,v80
v_mul_u32_u24 v81,43,v81
v_lshrrev_b32 v81,7,v81
v_and_b32 v81,6,v81
v_xor_b32 v81,v81,v82
v_lshlrev_b32 v81,4,v81
v_lshl_add_u32 v8,v80,7,v81
s_mov_b32 s37,0x5d800000
s_mov_b32 s36,0x3dd53b95
s_mov_b32 s31,0
s_mov_b32 s32,1
s_and_b32 s62,s2,7
s_lshl_b32 s33,s62,6
s_mul_i32 s22,s3,3072
s_add_u32 s23,s22,36864
s_mul_i32 s24,s3,22528
s_add_u32 s24,s24,73728
s_mov_b32 s69,0
s_lshl_b32 s62,s69,5
s_add_u32 s62,s62,s34
s_mul_i32 s63,s62,171
s_lshr_b32 s63,s63,9
s_mul_i32 s64,s63,3
s_sub_u32 s62,s62,s64
s_add_u32 s63,s63,s33
s_mul_i32 s30,s63,196608
s_mul_i32 s41,s63,325632
s_lshl_b32 s63,s3,2
s_add_u32 s64,s63,21
s_cmp_eq_u32 s3,0
s_cselect_b32 s64,20,s64
s_cselect_b32 s40,1,0
s_add_u32 s65,s63,37
s_cmp_eq_u32 s62,2
s_cselect_b32 s64,s65,s64
s_cselect_b32 s40,0,s40
s_add_u32 s65,s63,s3
s_cmp_eq_u32 s62,0
s_cselect_b32 s64,s65,s64
s_cselect_b32 s40,1,s40
s_mul_i32 s64,s64,6144
s_add_u32 s41,s41,s64
s_add_u32 s20,s30,s22
s_mov_b32 s21,s20
s_waitcnt lgkmcnt(0)
s_mov_b32 s4,s86
s_and_b32 s5,s87,0xffff
s_mov_b32 s6,100663296
s_mov_b32 s7,0x20000
s_mov_b32 s12,s84
s_and_b32 s13,s85,0xffff
s_mov_b32 s14,166723584
s_mov_b32 s15,0x20000
s_mov_b32 s8,s88
s_and_b32 s9,s89,0xffff
s_mov_b32 s10,100663296
s_mov_b32 s11,0x20000
s_mov_b32 s16,s90
s_and_b32 s17,s91,0xffff
s_mov_b32 s18,166723584
s_mov_b32 s19,0x20000
s_mov_b32 s28,s41
s_add_u32 m0,s22,0
s_nop 0
buffer_load_dwordx4 v6,s[4:7],s20 offen offset:0 lds
buffer_load_dwordx4 v7,s[4:7],s20 offen offset:1024 lds
buffer_load_dwordx4 v8,s[4:7],s20 offen offset:2048 lds
s_add_u32 s20,s20,12288
s_add_u32 m0,s24,0
s_nop 0
buffer_load_dwordx4 v6,s[12:15],s28 offen offset:0 nt lds
buffer_load_dwordx4 v7,s[12:15],s28 offen offset:1024 nt lds
buffer_load_dwordx4 v8,s[12:15],s28 offen offset:2048 nt lds
s_add_u32 s28,s28,3072
s_add_u32 m0,s24,3072
s_nop 0
buffer_load_dwordx4 v6,s[12:15],s28 offen offset:0 nt lds
buffer_load_dwordx4 v7,s[12:15],s28 offen offset:1024 nt lds
buffer_load_dwordx4 v8,s[12:15],s28 offen offset:2048 nt lds
s_add_u32 s28,s28,3072
s_add_u32 m0,s22,12288
s_nop 0
buffer_load_dwordx4 v6,s[4:7],s20 offen offset:0 lds
buffer_load_dwordx4 v7,s[4:7],s20 offen offset:1024 lds
buffer_load_dwordx4 v8,s[4:7],s20 offen offset:2048 lds
s_add_u32 s20,s20,12288
s_add_u32 m0,s24,6144
s_nop 0
buffer_load_dwordx4 v6,s[12:15],s28 offen offset:0 nt lds
buffer_load_dwordx4 v7,s[12:15],s28 offen offset:1024 nt lds
buffer_load_dwordx4 v8,s[12:15],s28 offen offset:2048 nt lds
s_add_u32 s28,s28,3072
s_add_u32 m0,s24,9216
s_nop 0
buffer_load_dwordx4 v6,s[12:15],s28 offen offset:0 nt lds
buffer_load_dwordx4 v7,s[12:15],s28 offen offset:1024 nt lds
buffer_load_dwordx4 v8,s[12:15],s28 offen offset:2048 nt lds
s_add_u32 s28,s28,3072
v_and_b32 v80,15,v19
v_lshrrev_b32 v81,4,v19
v_mul_u32_u24 v0,384,v80
v_and_b32 v83,6,v80
v_xor_b32 v83,v83,v81
v_lshl_add_u32 v0,v83,4,v0
v_xor_b32 v1,64,v0
v_add_u32 v11,s24,v0
v_add_u32 v12,s24,v1
v_lshrrev_b32 v80,2,v19
v_mul_u32_u24 v2,384,v80
v_and_b32 v80,6,v80
v_bfe_u32 v83,v19,1,1
v_xor_b32 v80,v80,v83
v_lshl_add_u32 v2,v80,4,v2
v_and_b32 v83,1,v19
v_lshl_add_u32 v2,v83,3,v2
v_add_u32 v2,36864,v2
v_xor_b32 v3,32,v2
v_xor_b32 v4,64,v2
v_xor_b32 v5,96,v2
v_lshrrev_b32 v80,3,v19
v_and_b32 v81,7,v19
v_xor_b32 v83,v81,v80
v_lshl_add_u32 v10,v80,7,s24
v_lshl_add_u32 v10,v83,4,v10
v_mul_u32_u24 v9,384,v80
v_lshl_add_u32 v9,v81,4,v9
v_lshrrev_b32 v80,4,v19
v_xor_b32 v80,v80,v19
v_bfe_u32 v80,v80,1,1
v_subrev_u32 v80,1,v80
v_and_b32 v80,0x3f803f80,v80
v_accvgpr_write_b32 a152,v80
v_accvgpr_write_b32 a153,v80
v_accvgpr_write_b32 a154,v80
v_accvgpr_write_b32 a155,v80
v_and_b32 v80,1,v19
v_mul_u32_u24 v80,0xaaaa,v80
v_add_u32 v18,0x4444,v80
s_waitcnt vmcnt(6)
s_barrier
s_cmp_eq_u32 s40,0
s_cbranch_scc1 L_start4
L_start5:
s_add_u32 m0,s24,12288
s_waitcnt vmcnt(9)
ds_read_b128 a[0:3],v11 offset:0
buffer_load_dwordx4 v6,s[12:15],s28 offen offset:0 nt lds
ds_read_b128 a[4:7],v12 offset:0
buffer_load_dwordx4 v7,s[12:15],s28 offen offset:1024 nt lds
ds_read_b128 a[8:11],v11 offset:128
buffer_load_dwordx4 v8,s[12:15],s28 offen offset:2048 nt lds
s_add_u32 s28,s28,3072
s_add_u32 m0,s24,15360
ds_read_b128 a[12:15],v12 offset:128
buffer_load_dwordx4 v6,s[12:15],s28 offen offset:0 nt lds
ds_read_b128 a[16:19],v11 offset:256
buffer_load_dwordx4 v7,s[12:15],s28 offen offset:1024 nt lds
ds_read_b128 a[20:23],v12 offset:256
buffer_load_dwordx4 v8,s[12:15],s28 offen offset:2048 nt lds
s_add_u32 s28,s28,3072
s_add_u32 m0,s24,0
ds_read_b128 a[120:123],v0 offset:0
v_mov_b32 v60,0
ds_read_b128 a[124:127],v1 offset:0
v_mov_b32 v61,0
ds_read_b128 a[128:131],v0 offset:128
v_mov_b32 v62,0
ds_read_b128 a[132:135],v1 offset:128
v_mov_b32 v63,0
ds_read_b128 a[136:139],v0 offset:256
v_mov_b32 v64,0
ds_read_b128 a[140:143],v1 offset:256
v_mov_b32 v65,0
ds_read_b128 a[144:147],v0 offset:6144
v_mov_b32 v66,0
ds_read_b128 a[148:151],v1 offset:6144
v_mov_b32 v67,0
s_waitcnt lgkmcnt(7)
v_mfma_f32_16x16x32_bf16 v[72:75],a[120:123],a[0:3],0
s_waitcnt lgkmcnt(6)
ds_read_b128 a[120:123],v0 offset:6272
v_mov_b32 v68,0
v_mfma_f32_16x16x32_bf16 v[72:75],a[124:127],a[4:7],v[72:75]
s_waitcnt lgkmcnt(6)
ds_read_b128 a[124:127],v1 offset:6272
v_mov_b32 v69,0
v_mfma_f32_16x16x32_bf16 v[72:75],a[128:131],a[8:11],v[72:75]
s_waitcnt lgkmcnt(6)
ds_read_b128 a[128:131],v0 offset:6400
v_mov_b32 v70,0
v_mfma_f32_16x16x32_bf16 v[72:75],a[132:135],a[12:15],v[72:75]
s_waitcnt lgkmcnt(5)
ds_read_b128 a[132:135],v1 offset:6400
v_mov_b32 v71,0
v_mfma_f32_16x16x32_bf16 v[72:75],a[136:139],a[16:19],v[72:75]
ds_read_b128 a[136:139],v0 offset:0
v_mfma_f32_16x16x32_bf16 v[72:75],a[140:143],a[20:23],v[72:75]
s_waitcnt lgkmcnt(5)
ds_read_b128 a[140:143],v1 offset:0
v_mfma_f32_16x16x32_bf16 v[76:79],a[144:147],a[0:3],0
ds_read_b128 a[144:147],v0 offset:128
v_mfma_f32_16x16x32_bf16 v[76:79],a[148:151],a[4:7],v[76:79]
s_waitcnt lgkmcnt(6)
ds_read_b128 a[148:151],v1 offset:128
v_mfma_f32_16x16x32_bf16 v[76:79],a[120:123],a[8:11],v[76:79]
s_waitcnt lgkmcnt(6)
ds_read_b128 a[120:123],v0 offset:256
v_mfma_f32_16x16x32_bf16 v[76:79],a[124:127],a[12:15],v[76:79]
s_waitcnt lgkmcnt(6)
ds_read_b128 a[124:127],v1 offset:256
v_max3_f32 v44,v72,v73,v74
v_mfma_f32_16x16x32_bf16 v[76:79],a[128:131],a[16:19],v[76:79]
s_waitcnt lgkmcnt(6)
ds_read_b128 a[128:131],v0 offset:6144
v_mfma_f32_16x16x32_bf16 v[76:79],a[132:135],a[20:23],v[76:79]
s_waitcnt vmcnt(6)
ds_read_b128 a[24:27],v11 offset:6144
buffer_load_dwordx4 v6,s[12:15],s28 offen offset:0 nt lds
ds_read_b128 a[28:31],v12 offset:6144
buffer_load_dwordx4 v7,s[12:15],s28 offen offset:1024 nt lds
ds_read_b128 a[32:35],v11 offset:6272
buffer_load_dwordx4 v8,s[12:15],s28 offen offset:2048 nt lds
s_add_u32 s28,s28,3072
s_add_u32 m0,s24,3072
ds_read_b128 a[36:39],v12 offset:6272
buffer_load_dwordx4 v6,s[12:15],s28 offen offset:0 nt lds
ds_read_b128 a[40:43],v11 offset:6400
buffer_load_dwordx4 v7,s[12:15],s28 offen offset:1024 nt lds
ds_read_b128 a[44:47],v12 offset:6400
buffer_load_dwordx4 v8,s[12:15],s28 offen offset:2048 nt lds
s_add_u32 s28,s28,3072
s_add_u32 m0,s24,6144
ds_read_b128 a[132:135],v1 offset:6144
v_max3_f32 v44,v44,v75,v76
s_waitcnt lgkmcnt(6)
v_mfma_f32_16x16x32_bf16 v[80:83],a[136:139],a[24:27],0
s_waitcnt lgkmcnt(5)
ds_read_b128 a[136:139],v0 offset:6272
v_max3_f32 v44,v44,v77,v78
v_mfma_f32_16x16x32_bf16 v[80:83],a[140:143],a[28:31],v[80:83]
s_waitcnt lgkmcnt(5)
ds_read_b128 a[140:143],v1 offset:6272
v_max_f32 v44,v44,v79
v_mfma_f32_16x16x32_bf16 v[80:83],a[144:147],a[32:35],v[80:83]
s_waitcnt lgkmcnt(5)
ds_read_b128 a[144:147],v0 offset:6400
v_mov_b32 v45,v44
v_mfma_f32_16x16x32_bf16 v[80:83],a[148:151],a[36:39],v[80:83]
s_waitcnt lgkmcnt(5)
ds_read_b128 a[148:151],v1 offset:6400
v_permlane32_swap_b32 v45,v44
v_mfma_f32_16x16x32_bf16 v[80:83],a[120:123],a[40:43],v[80:83]
s_waitcnt lgkmcnt(5)
ds_read_b128 a[120:123],v0 offset:12288
v_max_f32 v44,v44,v45
v_mfma_f32_16x16x32_bf16 v[80:83],a[124:127],a[44:47],v[80:83]
ds_read_b128 a[124:127],v1 offset:12288
v_mov_b32 v45,v44
v_mfma_f32_16x16x32_bf16 v[84:87],a[128:131],a[24:27],0
s_waitcnt lgkmcnt(5)
ds_read_b128 a[128:131],v0 offset:12416
v_permlane16_swap_b32 v45,v44
v_mfma_f32_16x16x32_bf16 v[84:87],a[132:135],a[28:31],v[84:87]
ds_read_b128 a[132:135],v1 offset:12416
v_max_f32 v44,v44,v45
v_mfma_f32_16x16x32_bf16 v[84:87],a[136:139],a[32:35],v[84:87]
s_waitcnt lgkmcnt(5)
ds_read_b128 a[136:139],v0 offset:12544
v_mul_f32_e64 v13,-s36,v44
v_mfma_f32_16x16x32_bf16 v[84:87],a[140:143],a[36:39],v[84:87]
ds_read_b128 a[140:143],v1 offset:12544
v_fma_f32 v72,v72,s36,v13
v_mfma_f32_16x16x32_bf16 v[84:87],a[144:147],a[40:43],v[84:87]
s_waitcnt lgkmcnt(5)
ds_read_b128 a[144:147],v0 offset:18432
v_fma_f32 v73,v73,s36,v13
v_mfma_f32_16x16x32_bf16 v[84:87],a[148:151],a[44:47],v[84:87]
ds_read_b128 a[148:151],v1 offset:18432
v_fma_f32 v74,v74,s36,v13
v_fma_f32 v75,v75,s36,v13
v_exp_f32 v72,v72
v_exp_f32 v73,v73
v_exp_f32 v74,v74
v_exp_f32 v75,v75
v_cvt_pk_bf16_f32 v20,v72,v73
v_cvt_pk_bf16_f32 v21,v74,v75
v_mfma_f32_16x16x32_bf16 v[72:75],a[120:123],a[0:3],0
s_waitcnt lgkmcnt(3)
ds_read_b128 a[120:123],v0 offset:18560
v_fma_f32 v76,v76,s36,v13
v_mfma_f32_16x16x32_bf16 v[72:75],a[124:127],a[4:7],v[72:75]
ds_read_b128 a[124:127],v1 offset:18560
v_fma_f32 v77,v77,s36,v13
v_mfma_f32_16x16x32_bf16 v[72:75],a[128:131],a[8:11],v[72:75]
ds_read_b128 a[128:131],v0 offset:18688
v_fma_f32 v78,v78,s36,v13
v_mfma_f32_16x16x32_bf16 v[72:75],a[132:135],a[12:15],v[72:75]
ds_read_b128 a[132:135],v1 offset:18688
v_fma_f32 v79,v79,s36,v13
v_mfma_f32_16x16x32_bf16 v[72:75],a[136:139],a[16:19],v[72:75]
s_waitcnt lgkmcnt(4)
ds_read_b128 a[136:139],v0 offset:0
v_exp_f32 v76,v76
v_mfma_f32_16x16x32_bf16 v[72:75],a[140:143],a[20:23],v[72:75]
ds_read_b128 a[140:143],v1 offset:0
v_exp_f32 v77,v77
v_exp_f32 v78,v78
v_exp_f32 v79,v79
v_cvt_pk_bf16_f32 v22,v76,v77
v_cvt_pk_bf16_f32 v23,v78,v79
v_mfma_f32_16x16x32_bf16 v[76:79],a[144:147],a[0:3],0
ds_read_b128 a[144:147],v0 offset:128
v_max3_f32 v48,v80,v81,v82
v_mfma_f32_16x16x32_bf16 v[76:79],a[148:151],a[4:7],v[76:79]
s_waitcnt lgkmcnt(4)
ds_read_b128 a[148:151],v1 offset:128
v_max3_f32 v48,v48,v83,v84
v_mfma_f32_16x16x32_bf16 v[76:79],a[120:123],a[8:11],v[76:79]
ds_read_b128 a[120:123],v0 offset:256
v_max3_f32 v48,v48,v85,v86
v_mfma_f32_16x16x32_bf16 v[76:79],a[124:127],a[12:15],v[76:79]
ds_read_b128 a[124:127],v1 offset:256
v_max_f32 v48,v48,v87
v_mfma_f32_16x16x32_bf16 v[76:79],a[128:131],a[16:19],v[76:79]
s_waitcnt lgkmcnt(4)
ds_read_b128 a[128:131],v0 offset:6144
v_mov_b32 v49,v48
v_mfma_f32_16x16x32_bf16 v[76:79],a[132:135],a[20:23],v[76:79]
s_waitcnt vmcnt(6)
ds_read_b128 a[48:51],v11 offset:12288
buffer_load_dwordx4 v6,s[12:15],s28 offen offset:0 nt lds
ds_read_b128 a[52:55],v12 offset:12288
buffer_load_dwordx4 v7,s[12:15],s28 offen offset:1024 nt lds
ds_read_b128 a[56:59],v11 offset:12416
buffer_load_dwordx4 v8,s[12:15],s28 offen offset:2048 nt lds
s_add_u32 s28,s28,3072
s_add_u32 m0,s24,9216
ds_read_b128 a[60:63],v12 offset:12416
buffer_load_dwordx4 v6,s[12:15],s28 offen offset:0 nt lds
ds_read_b128 a[64:67],v11 offset:12544
buffer_load_dwordx4 v7,s[12:15],s28 offen offset:1024 nt lds
ds_read_b128 a[68:71],v12 offset:12544
buffer_load_dwordx4 v8,s[12:15],s28 offen offset:2048 nt lds
s_add_u32 s28,s28,3072
s_add_u32 m0,s23,0
ds_read_b128 a[132:135],v1 offset:6144
v_permlane32_swap_b32 v49,v48
s_waitcnt lgkmcnt(6)
v_mfma_f32_16x16x32_bf16 v[88:91],a[136:139],a[48:51],0
s_waitcnt lgkmcnt(5)
ds_read_b128 a[136:139],v0 offset:6272
v_max_f32 v48,v48,v49
v_mfma_f32_16x16x32_bf16 v[88:91],a[140:143],a[52:55],v[88:91]
s_waitcnt lgkmcnt(5)
ds_read_b128 a[140:143],v1 offset:6272
v_mov_b32 v49,v48
v_mfma_f32_16x16x32_bf16 v[88:91],a[144:147],a[56:59],v[88:91]
s_waitcnt lgkmcnt(5)
ds_read_b128 a[144:147],v0 offset:6400
v_permlane16_swap_b32 v49,v48
v_mfma_f32_16x16x32_bf16 v[88:91],a[148:151],a[60:63],v[88:91]
s_waitcnt lgkmcnt(4)
ds_read_b128 a[148:151],v1 offset:6400
v_max_f32 v48,v48,v49
v_mfma_f32_16x16x32_bf16 v[88:91],a[120:123],a[64:67],v[88:91]
ds_read_b128 a[120:123],v0 offset:12288
v_mul_f32_e64 v14,-s36,v48
v_mfma_f32_16x16x32_bf16 v[88:91],a[124:127],a[68:71],v[88:91]
ds_read_b128 a[124:127],v1 offset:12288
v_fma_f32 v80,v80,s36,v14
v_mfma_f32_16x16x32_bf16 v[92:95],a[128:131],a[48:51],0
s_waitcnt lgkmcnt(5)
ds_read_b128 a[128:131],v0 offset:12416
v_fma_f32 v81,v81,s36,v14
v_mfma_f32_16x16x32_bf16 v[92:95],a[132:135],a[52:55],v[92:95]
ds_read_b128 a[132:135],v1 offset:12416
v_fma_f32 v82,v82,s36,v14
v_mfma_f32_16x16x32_bf16 v[92:95],a[136:139],a[56:59],v[92:95]
s_waitcnt lgkmcnt(5)
ds_read_b128 a[136:139],v0 offset:12544
v_fma_f32 v83,v83,s36,v14
v_mfma_f32_16x16x32_bf16 v[92:95],a[140:143],a[60:63],v[92:95]
ds_read_b128 a[140:143],v1 offset:12544
v_exp_f32 v80,v80
v_mfma_f32_16x16x32_bf16 v[92:95],a[144:147],a[64:67],v[92:95]
s_waitcnt lgkmcnt(5)
ds_read_b128 a[144:147],v0 offset:18432
v_exp_f32 v81,v81
v_mfma_f32_16x16x32_bf16 v[92:95],a[148:151],a[68:71],v[92:95]
ds_read_b128 a[148:151],v1 offset:18432
v_exp_f32 v82,v82
v_exp_f32 v83,v83
v_cvt_pk_bf16_f32 v24,v80,v81
v_cvt_pk_bf16_f32 v25,v82,v83
v_mfma_f32_16x16x32_bf16 v[80:83],a[120:123],a[24:27],0
s_waitcnt lgkmcnt(4)
ds_read_b128 a[120:123],v0 offset:18560
v_fma_f32 v84,v84,s36,v14
v_mfma_f32_16x16x32_bf16 v[80:83],a[124:127],a[28:31],v[80:83]
ds_read_b128 a[124:127],v1 offset:18560
v_fma_f32 v85,v85,s36,v14
v_mfma_f32_16x16x32_bf16 v[80:83],a[128:131],a[32:35],v[80:83]
ds_read_b128 a[128:131],v0 offset:18688
v_fma_f32 v86,v86,s36,v14
v_mfma_f32_16x16x32_bf16 v[80:83],a[132:135],a[36:39],v[80:83]
s_waitcnt lgkmcnt(4)
ds_read_b128 a[132:135],v1 offset:18688
v_fma_f32 v87,v87,s36,v14
v_mfma_f32_16x16x32_bf16 v[80:83],a[136:139],a[40:43],v[80:83]
ds_read_b128 a[136:139],v0 offset:0
v_exp_f32 v84,v84
v_mfma_f32_16x16x32_bf16 v[80:83],a[140:143],a[44:47],v[80:83]
ds_read_b128 a[140:143],v1 offset:0
v_exp_f32 v85,v85
v_exp_f32 v86,v86
v_exp_f32 v87,v87
v_cvt_pk_bf16_f32 v26,v84,v85
v_cvt_pk_bf16_f32 v27,v86,v87
v_mfma_f32_16x16x32_bf16 v[84:87],a[144:147],a[24:27],0
ds_read_b128 a[144:147],v0 offset:128
v_max3_f32 v52,v88,v89,v90
v_smfmac_f32_16x16x64_bf16 v[60:63],a[152:155],v[20:27],v18
s_waitcnt lgkmcnt(4)
v_max3_f32 v52,v52,v91,v92
v_mfma_f32_16x16x32_bf16 v[84:87],a[148:151],a[28:31],v[84:87]
ds_read_b128 a[148:151],v1 offset:128
v_max3_f32 v52,v52,v93,v94
v_mfma_f32_16x16x32_bf16 v[84:87],a[120:123],a[32:35],v[84:87]
ds_read_b128 a[120:123],v0 offset:256
v_max_f32 v52,v52,v95
v_mfma_f32_16x16x32_bf16 v[84:87],a[124:127],a[36:39],v[84:87]
ds_read_b128 a[124:127],v1 offset:256
v_mov_b32 v53,v52
v_mfma_f32_16x16x32_bf16 v[84:87],a[128:131],a[40:43],v[84:87]
s_waitcnt lgkmcnt(4)
ds_read_b128 a[128:131],v0 offset:6144
v_permlane32_swap_b32 v53,v52
v_mfma_f32_16x16x32_bf16 v[84:87],a[132:135],a[44:47],v[84:87]
s_waitcnt vmcnt(6)
ds_read_b128 a[72:75],v11 offset:0
buffer_load_dwordx4 v6,s[8:11],s21 offen offset:0 lds
ds_read_b128 a[76:79],v12 offset:0
buffer_load_dwordx4 v7,s[8:11],s21 offen offset:1024 lds
ds_read_b128 a[80:83],v11 offset:128
buffer_load_dwordx4 v8,s[8:11],s21 offen offset:2048 lds
s_add_u32 s21,s21,12288
s_add_u32 m0,s22,24576
ds_read_b128 a[84:87],v12 offset:128
buffer_load_dwordx4 v6,s[4:7],s20 offen offset:0 lds
ds_read_b128 a[88:91],v11 offset:256
buffer_load_dwordx4 v7,s[4:7],s20 offen offset:1024 lds
ds_read_b128 a[92:95],v12 offset:256
buffer_load_dwordx4 v8,s[4:7],s20 offen offset:2048 lds
s_add_u32 s20,s20,12288
s_add_u32 m0,s23,12288
ds_read_b128 a[132:135],v1 offset:6144
v_max_f32 v52,v52,v53
s_waitcnt lgkmcnt(6)
v_mfma_f32_16x16x32_bf16 v[96:99],a[136:139],a[72:75],0
s_waitcnt lgkmcnt(5)
ds_read_b128 a[136:139],v0 offset:6272
v_mov_b32 v53,v52
v_mfma_f32_16x16x32_bf16 v[96:99],a[140:143],a[76:79],v[96:99]
s_waitcnt lgkmcnt(5)
ds_read_b128 a[140:143],v1 offset:6272
v_permlane16_swap_b32 v53,v52
v_mfma_f32_16x16x32_bf16 v[96:99],a[144:147],a[80:83],v[96:99]
s_waitcnt lgkmcnt(5)
ds_read_b128 a[144:147],v0 offset:6400
v_max_f32 v52,v52,v53
v_mul_f32_e64 v15,-s36,v52
v_mfma_f32_16x16x32_bf16 v[96:99],a[148:151],a[84:87],v[96:99]
s_waitcnt lgkmcnt(4)
ds_read_b128 a[148:151],v1 offset:6400
v_fma_f32 v88,v88,s36,v15
v_mfma_f32_16x16x32_bf16 v[96:99],a[120:123],a[88:91],v[96:99]
ds_read_b128 a[120:123],v0 offset:12288
v_fma_f32 v89,v89,s36,v15
v_mfma_f32_16x16x32_bf16 v[96:99],a[124:127],a[92:95],v[96:99]
ds_read_b128 a[124:127],v1 offset:12288
v_fma_f32 v90,v90,s36,v15
v_mfma_f32_16x16x32_bf16 v[100:103],a[128:131],a[72:75],0
s_waitcnt lgkmcnt(5)
ds_read_b128 a[128:131],v0 offset:12416
v_fma_f32 v91,v91,s36,v15
v_mfma_f32_16x16x32_bf16 v[100:103],a[132:135],a[76:79],v[100:103]
ds_read_b128 a[132:135],v1 offset:12416
v_exp_f32 v88,v88
v_mfma_f32_16x16x32_bf16 v[100:103],a[136:139],a[80:83],v[100:103]
s_waitcnt lgkmcnt(5)
ds_read_b128 a[136:139],v0 offset:12544
v_exp_f32 v89,v89
v_mfma_f32_16x16x32_bf16 v[100:103],a[140:143],a[84:87],v[100:103]
ds_read_b128 a[140:143],v1 offset:12544
v_exp_f32 v90,v90
v_mfma_f32_16x16x32_bf16 v[100:103],a[144:147],a[88:91],v[100:103]
s_waitcnt lgkmcnt(5)
ds_read_b128 a[144:147],v0 offset:18432
v_exp_f32 v91,v91
v_mfma_f32_16x16x32_bf16 v[100:103],a[148:151],a[92:95],v[100:103]
ds_read_b128 a[148:151],v1 offset:18432
v_cvt_pk_bf16_f32 v28,v88,v89
v_cvt_pk_bf16_f32 v29,v90,v91
v_mfma_f32_16x16x32_bf16 v[88:91],a[120:123],a[48:51],0
s_waitcnt lgkmcnt(5)
ds_read_b128 a[120:123],v0 offset:18560
v_fma_f32 v92,v92,s36,v15
v_mfma_f32_16x16x32_bf16 v[88:91],a[124:127],a[52:55],v[88:91]
ds_read_b128 a[124:127],v1 offset:18560
v_fma_f32 v93,v93,s36,v15
v_mfma_f32_16x16x32_bf16 v[88:91],a[128:131],a[56:59],v[88:91]
s_waitcnt lgkmcnt(5)
ds_read_b128 a[128:131],v0 offset:18688
v_fma_f32 v94,v94,s36,v15
v_mfma_f32_16x16x32_bf16 v[88:91],a[132:135],a[60:63],v[88:91]
ds_read_b128 a[132:135],v1 offset:18688
v_fma_f32 v95,v95,s36,v15
v_mfma_f32_16x16x32_bf16 v[88:91],a[136:139],a[64:67],v[88:91]
s_waitcnt lgkmcnt(5)
ds_read_b128 a[136:139],v0 offset:0
v_exp_f32 v92,v92
v_mfma_f32_16x16x32_bf16 v[88:91],a[140:143],a[68:71],v[88:91]
ds_read_b128 a[140:143],v1 offset:0
v_exp_f32 v93,v93
v_exp_f32 v94,v94
v_exp_f32 v95,v95
v_cvt_pk_bf16_f32 v30,v92,v93
v_cvt_pk_bf16_f32 v31,v94,v95
v_mfma_f32_16x16x32_bf16 v[92:95],a[144:147],a[48:51],0
s_waitcnt lgkmcnt(4)
ds_read_b128 a[144:147],v0 offset:128
v_max3_f32 v56,v96,v97,v98
v_mfma_f32_16x16x32_bf16 v[92:95],a[148:151],a[52:55],v[92:95]
ds_read_b128 a[148:151],v1 offset:128
v_max3_f32 v56,v56,v99,v100
v_mfma_f32_16x16x32_bf16 v[92:95],a[120:123],a[56:59],v[92:95]
ds_read_b128 a[120:123],v0 offset:256
v_max3_f32 v56,v56,v101,v102
v_mfma_f32_16x16x32_bf16 v[92:95],a[124:127],a[60:63],v[92:95]
s_waitcnt lgkmcnt(4)
ds_read_b128 a[124:127],v1 offset:256
v_max_f32 v56,v56,v103
v_mfma_f32_16x16x32_bf16 v[92:95],a[128:131],a[64:67],v[92:95]
ds_read_b128 a[128:131],v0 offset:6144
v_mov_b32 v57,v56
v_mfma_f32_16x16x32_bf16 v[92:95],a[132:135],a[68:71],v[92:95]
s_waitcnt vmcnt(6)
ds_read_b128 a[96:99],v11 offset:6144
buffer_load_dwordx4 v6,s[8:11],s21 offen offset:0 lds
ds_read_b128 a[100:103],v12 offset:6144
buffer_load_dwordx4 v7,s[8:11],s21 offen offset:1024 lds
ds_read_b128 a[104:107],v11 offset:6272
buffer_load_dwordx4 v8,s[8:11],s21 offen offset:2048 lds
s_add_u32 s21,s21,12288
s_add_u32 m0,s23,24576
ds_read_b128 a[108:111],v12 offset:6272
buffer_load_dwordx4 v6,s[8:11],s21 offen offset:0 lds
ds_read_b128 a[112:115],v11 offset:6400
buffer_load_dwordx4 v7,s[8:11],s21 offen offset:1024 lds
ds_read_b128 a[116:119],v12 offset:6400
buffer_load_dwordx4 v8,s[8:11],s21 offen offset:2048 lds
s_add_u32 s21,s21,12288
ds_read_b128 a[132:135],v1 offset:6144
v_permlane32_swap_b32 v57,v56
s_waitcnt lgkmcnt(6)
v_mfma_f32_16x16x32_bf16 v[104:107],a[136:139],a[96:99],0
s_mov_b32 s27,166723584
ds_read_b128 a[136:139],v0 offset:6272
v_max_f32 v56,v56,v57
s_waitcnt lgkmcnt(6)
v_mfma_f32_16x16x32_bf16 v[104:107],a[140:143],a[100:103],v[104:107]
s_mov_b32 s42,s41
ds_read_b128 a[140:143],v1 offset:6272
v_mov_b32 v57,v56
s_waitcnt lgkmcnt(6)
v_mfma_f32_16x16x32_bf16 v[104:107],a[144:147],a[104:107],v[104:107]
s_add_u32 s69,s69,1
ds_read_b128 a[144:147],v0 offset:6400
v_permlane16_swap_b32 v57,v56
v_max_f32 v56,v56,v57
s_waitcnt lgkmcnt(6)
v_mfma_f32_16x16x32_bf16 v[104:107],a[148:151],a[108:111],v[104:107]
s_lshl_b32 s62,s69,5
ds_read_b128 a[148:151],v1 offset:6400
v_mul_f32_e64 v16,-s36,v56
s_waitcnt lgkmcnt(5)
v_mfma_f32_16x16x32_bf16 v[104:107],a[120:123],a[112:115],v[104:107]
s_add_u32 s62,s62,s34
ds_read_b128 a[120:123],v0 offset:12288
v_fma_f32 v96,v96,s36,v16
v_mfma_f32_16x16x32_bf16 v[104:107],a[124:127],a[116:119],v[104:107]
s_mul_i32 s63,s62,171
ds_read_b128 a[124:127],v1 offset:12288
v_fma_f32 v97,v97,s36,v16
v_mfma_f32_16x16x32_bf16 v[108:111],a[128:131],a[96:99],0
s_lshr_b32 s63,s63,9
ds_read_b128 a[128:131],v0 offset:12416
v_fma_f32 v98,v98,s36,v16
s_waitcnt lgkmcnt(6)
v_mfma_f32_16x16x32_bf16 v[108:111],a[132:135],a[100:103],v[108:111]
s_mul_i32 s64,s63,3
ds_read_b128 a[132:135],v1 offset:12416
v_fma_f32 v99,v99,s36,v16
v_mfma_f32_16x16x32_bf16 v[108:111],a[136:139],a[104:107],v[108:111]
s_sub_u32 s62,s62,s64
ds_read_b128 a[136:139],v0 offset:12544
v_exp_f32 v96,v96
s_waitcnt lgkmcnt(6)
v_mfma_f32_16x16x32_bf16 v[108:111],a[140:143],a[108:111],v[108:111]
s_add_u32 s63,s63,s33
ds_read_b128 a[140:143],v1 offset:12544
v_exp_f32 v97,v97
v_mfma_f32_16x16x32_bf16 v[108:111],a[144:147],a[112:115],v[108:111]
s_mul_i32 s30,s63,196608
ds_read_b128 a[144:147],v0 offset:18432
v_exp_f32 v98,v98
s_waitcnt lgkmcnt(6)
v_mfma_f32_16x16x32_bf16 v[108:111],a[148:151],a[116:119],v[108:111]
s_waitcnt vmcnt(9)
s_barrier
ds_read_b128 a[148:151],v1 offset:18432
v_exp_f32 v99,v99
v_cvt_pk_bf16_f32 v32,v96,v97
v_cvt_pk_bf16_f32 v33,v98,v99
v_mfma_f32_16x16x32_bf16 v[96:99],a[120:123],a[72:75],0
s_mul_i32 s41,s63,325632
ds_read_b128 a[120:123],v0 offset:18560
v_fma_f32 v100,v100,s36,v16
s_waitcnt lgkmcnt(4)
v_mfma_f32_16x16x32_bf16 v[96:99],a[124:127],a[76:79],v[96:99]
s_lshl_b32 s63,s3,2
ds_read_b128 a[124:127],v1 offset:18560
v_fma_f32 v101,v101,s36,v16
v_mfma_f32_16x16x32_bf16 v[96:99],a[128:131],a[80:83],v[96:99]
s_add_u32 s64,s63,21
ds_read_b128 a[128:131],v0 offset:18688
v_fma_f32 v102,v102,s36,v16
v_mfma_f32_16x16x32_bf16 v[96:99],a[132:135],a[84:87],v[96:99]
s_cmp_eq_u32 s3,0
ds_read_b128 a[132:135],v1 offset:18688
v_fma_f32 v103,v103,s36,v16
v_mfma_f32_16x16x32_bf16 v[96:99],a[136:139],a[88:91],v[96:99]
s_cselect_b32 s64,20,s64
ds_read_b128 a[136:139],v0 offset:12288
v_exp_f32 v100,v100
s_waitcnt lgkmcnt(6)
v_mfma_f32_16x16x32_bf16 v[96:99],a[140:143],a[92:95],v[96:99]
s_cselect_b32 s40,1,0
ds_read_b128 a[140:143],v1 offset:12288
v_exp_f32 v101,v101
v_exp_f32 v102,v102
v_exp_f32 v103,v103
v_cvt_pk_bf16_f32 v34,v100,v101
v_cvt_pk_bf16_f32 v35,v102,v103
v_mfma_f32_16x16x32_bf16 v[100:103],a[144:147],a[72:75],0
s_add_u32 s65,s63,37
ds_read_b128 a[144:147],v0 offset:12416
v_max3_f32 v40,v104,v105,v106
v_smfmac_f32_16x16x64_bf16 v[64:67],a[152:155],v[28:35],v18
s_cmp_eq_u32 s62,2
s_cselect_b32 s64,s65,s64
v_max3_f32 v40,v40,v107,v108
s_waitcnt lgkmcnt(4)
v_mfma_f32_16x16x32_bf16 v[100:103],a[148:151],a[76:79],v[100:103]
s_cselect_b32 s40,0,s40
ds_read_b128 a[148:151],v1 offset:12416
v_max3_f32 v40,v40,v109,v110
v_mfma_f32_16x16x32_bf16 v[100:103],a[120:123],a[80:83],v[100:103]
s_add_u32 s65,s63,s3
ds_read_b128 a[120:123],v0 offset:12544
v_max_f32 v40,v40,v111
v_mfma_f32_16x16x32_bf16 v[100:103],a[124:127],a[84:87],v[100:103]
s_cmp_eq_u32 s62,0
ds_read_b128 a[124:127],v1 offset:12544
v_mov_b32 v41,v40
v_mfma_f32_16x16x32_bf16 v[100:103],a[128:131],a[88:91],v[100:103]
s_cselect_b32 s64,s65,s64
ds_read_b128 a[128:131],v0 offset:18432
v_permlane32_swap_b32 v41,v40
s_waitcnt lgkmcnt(5)
v_mfma_f32_16x16x32_bf16 v[100:103],a[132:135],a[92:95],v[100:103]
s_cselect_b32 s40,1,s40
ds_read_b128 a[132:135],v1 offset:18432
v_max_f32 v40,v40,v41
v_mov_b32 v41,v40
v_fma_f32 v72,v72,s36,v13
v_fma_f32 v73,v73,s36,v13
v_permlane16_swap_b32 v41,v40
v_max_f32 v40,v40,v41
v_mul_f32_e64 v17,-s36,v40
v_fma_f32 v104,v104,s36,v17
v_fma_f32 v105,v105,s36,v17
v_fma_f32 v106,v106,s36,v17
v_fma_f32 v107,v107,s36,v17
v_exp_f32 v104,v104
v_exp_f32 v105,v105
v_exp_f32 v106,v106
v_exp_f32 v107,v107
v_cvt_pk_bf16_f32 v36,v104,v105
v_cvt_pk_bf16_f32 v37,v106,v107
v_mfma_f32_16x16x32_bf16 v[104:107],a[136:139],a[96:99],0
s_mul_i32 s64,s64,6144
ds_read_b128 a[136:139],v0 offset:18560
v_fma_f32 v108,v108,s36,v17
v_mfma_f32_16x16x32_bf16 v[104:107],a[140:143],a[100:103],v[104:107]
s_add_u32 s41,s41,s64
ds_read_b128 a[140:143],v1 offset:18560
v_fma_f32 v109,v109,s36,v17
s_waitcnt lgkmcnt(2)
v_mfma_f32_16x16x32_bf16 v[104:107],a[144:147],a[104:107],v[104:107]
s_cmp_ge_u32 s69,6
ds_read_b128 a[144:147],v0 offset:18688
v_fma_f32 v110,v110,s36,v17
v_mfma_f32_16x16x32_bf16 v[104:107],a[148:151],a[108:111],v[104:107]
s_cselect_b32 s41,166723584,s41
ds_read_b128 a[148:151],v1 offset:18688
v_fma_f32 v111,v111,s36,v17
v_mfma_f32_16x16x32_bf16 v[104:107],a[120:123],a[112:115],v[104:107]
s_cselect_b32 s30,100663296,s30
ds_read_b64_tr_b16 a[120:121],v2 offset:0
v_exp_f32 v108,v108
v_mfma_f32_16x16x32_bf16 v[104:107],a[124:127],a[116:119],v[104:107]
s_add_u32 s25,s30,s22
ds_read_b64_tr_b16 a[122:123],v2 offset:6144
ds_read_b64_tr_b16 a[124:125],v3 offset:0
ds_read_b64_tr_b16 a[126:127],v3 offset:6144
v_exp_f32 v109,v109
v_exp_f32 v110,v110
v_exp_f32 v111,v111
v_cvt_pk_bf16_f32 v38,v108,v109
v_cvt_pk_bf16_f32 v39,v110,v111
v_mfma_f32_16x16x32_bf16 v[108:111],a[128:131],a[96:99],0
s_add_u32 s26,s25,12288
ds_read_b64_tr_b16 a[128:129],v4 offset:0
v_fma_f32 v74,v74,s36,v13
v_mfma_f32_16x16x32_bf16 v[108:111],a[132:135],a[100:103],v[108:111]
s_mov_b32 s28,s41
ds_read_b64_tr_b16 a[130:131],v4 offset:6144
v_fma_f32 v75,v75,s36,v13
s_waitcnt lgkmcnt(7)
v_mfma_f32_16x16x32_bf16 v[108:111],a[136:139],a[104:107],v[108:111]
s_mov_b32 s29,s24
ds_read_b64_tr_b16 a[132:133],v5 offset:0
v_fma_f32 v80,v80,s36,v14
v_mfma_f32_16x16x32_bf16 v[108:111],a[140:143],a[108:111],v[108:111]
s_add_u32 m0,s22,0
ds_read_b64_tr_b16 a[134:135],v5 offset:6144
buffer_load_dwordx4 v6,s[4:7],s20 offen offset:0 lds
v_mfma_f32_16x16x32_bf16 v[108:111],a[144:147],a[112:115],v[108:111]
buffer_load_dwordx4 v7,s[4:7],s20 offen offset:1024 lds
s_waitcnt lgkmcnt(4)
v_mfma_f32_16x16x32_bf16 v[108:111],a[148:151],a[116:119],v[108:111]
buffer_load_dwordx4 v8,s[4:7],s20 offen offset:2048 lds
v_fma_f32 v81,v81,s36,v14
v_fma_f32 v82,v82,s36,v14
v_fma_f32 v83,v83,s36,v14
v_fma_f32 v88,v88,s36,v15
v_fma_f32 v89,v89,s36,v15
v_exp_f32 v72,v72
v_exp_f32 v73,v73
v_exp_f32 v74,v74
v_exp_f32 v75,v75
v_exp_f32 v80,v80
v_exp_f32 v81,v81
v_exp_f32 v82,v82
v_exp_f32 v83,v83
v_exp_f32 v88,v88
v_exp_f32 v89,v89
v_cvt_pk_bf16_f32 v44,v72,v73
v_cvt_pk_bf16_f32 v45,v74,v75
v_cvt_pk_bf16_f32 v48,v80,v81
v_cvt_pk_bf16_f32 v49,v82,v83
v_cvt_pk_bf16_f32 v52,v88,v89
s_add_u32 s20,s20,12288
v_mfma_f32_16x16x32_bf16 v[160:163],a[120:123],v[20:23],0
s_add_u32 m0,s23,0
ds_read_b64_tr_b16 a[136:137],v2 offset:128
v_fma_f32 v90,v90,s36,v15
v_mfma_f32_16x16x32_bf16 v[164:167],a[124:127],v[20:23],0
ds_read_b64_tr_b16 a[138:139],v2 offset:6272
v_fma_f32 v91,v91,s36,v15
v_mfma_f32_16x16x32_bf16 v[212:215],a[124:127],v[24:27],0
ds_read_b64_tr_b16 a[140:141],v3 offset:128
v_fma_f32 v96,v96,s36,v16
v_mfma_f32_16x16x32_bf16 v[208:211],a[120:123],v[24:27],0
ds_read_b64_tr_b16 a[142:143],v3 offset:6272
v_fma_f32 v97,v97,s36,v16
v_mfma_f32_16x16x32_bf16 v[112:115],a[120:123],v[28:31],0
ds_read_b64_tr_b16 a[144:145],v4 offset:128
v_fma_f32 v98,v98,s36,v16
v_mfma_f32_16x16x32_bf16 v[116:119],a[124:127],v[28:31],0
ds_read_b64_tr_b16 a[146:147],v4 offset:6272
v_fma_f32 v99,v99,s36,v16
v_mfma_f32_16x16x32_bf16 a[164:167],a[124:127],v[32:35],0
ds_read_b64_tr_b16 a[148:149],v5 offset:128
v_fma_f32 v104,v104,s36,v17
v_mfma_f32_16x16x32_bf16 a[160:163],a[120:123],v[32:35],0
ds_read_b64_tr_b16 a[150:151],v5 offset:6272
v_fma_f32 v105,v105,s36,v17
v_mfma_f32_16x16x32_bf16 a[208:211],a[120:123],v[36:39],0
ds_read_b64_tr_b16 a[120:121],v2 offset:256
v_fma_f32 v106,v106,s36,v17
v_mfma_f32_16x16x32_bf16 a[212:215],a[124:127],v[36:39],0
s_waitcnt lgkmcnt(6)
ds_read_b64_tr_b16 a[122:123],v2 offset:6400
v_fma_f32 v107,v107,s36,v17
v_mfma_f32_16x16x32_bf16 a[216:219],a[128:131],v[36:39],0
ds_read_b64_tr_b16 a[124:125],v3 offset:256
v_fma_f32 v76,v76,s36,v13
v_mfma_f32_16x16x32_bf16 a[220:223],a[132:135],v[36:39],0
ds_read_b64_tr_b16 a[126:127],v3 offset:6400
v_fma_f32 v77,v77,s36,v13
v_mfma_f32_16x16x32_bf16 a[172:175],a[132:135],v[32:35],0
v_exp_f32 v90,v90
v_mfma_f32_16x16x32_bf16 a[168:171],a[128:131],v[32:35],0
v_exp_f32 v91,v91
v_mfma_f32_16x16x32_bf16 v[120:123],a[128:131],v[28:31],0
v_cvt_pk_bf16_f32 v53,v90,v91
v_fma_f32 v78,v78,s36,v13
v_mfma_f32_16x16x32_bf16 v[124:127],a[132:135],v[28:31],0
v_exp_f32 v96,v96
v_mfma_f32_16x16x32_bf16 v[220:223],a[132:135],v[24:27],0
v_exp_f32 v97,v97
v_mfma_f32_16x16x32_bf16 v[216:219],a[128:131],v[24:27],0
v_exp_f32 v98,v98
v_mfma_f32_16x16x32_bf16 v[168:171],a[128:131],v[20:23],0
ds_read_b64_tr_b16 a[128:129],v4 offset:256
v_cvt_pk_bf16_f32 v56,v96,v97
v_mfma_f32_16x16x32_bf16 v[172:175],a[132:135],v[20:23],0
ds_read_b64_tr_b16 a[130:131],v4 offset:6400
v_fma_f32 v79,v79,s36,v13
v_mfma_f32_16x16x32_bf16 v[176:179],a[136:139],v[20:23],0
s_waitcnt lgkmcnt(2)
ds_read_b64_tr_b16 a[132:133],v5 offset:256
v_fma_f32 v84,v84,s36,v14
v_mfma_f32_16x16x32_bf16 v[180:183],a[140:143],v[20:23],0
ds_read_b64_tr_b16 a[134:135],v5 offset:6400
v_fma_f32 v85,v85,s36,v14
v_mfma_f32_16x16x32_bf16 v[228:231],a[140:143],v[24:27],0
v_exp_f32 v99,v99
v_mfma_f32_16x16x32_bf16 v[224:227],a[136:139],v[24:27],0
v_cvt_pk_bf16_f32 v57,v98,v99
v_fma_f32 v86,v86,s36,v14
v_mfma_f32_16x16x32_bf16 v[128:131],a[136:139],v[28:31],0
v_exp_f32 v104,v104
v_mfma_f32_16x16x32_bf16 v[132:135],a[140:143],v[28:31],0
v_exp_f32 v105,v105
v_mfma_f32_16x16x32_bf16 a[180:183],a[140:143],v[32:35],0
v_exp_f32 v106,v106
v_mfma_f32_16x16x32_bf16 a[176:179],a[136:139],v[32:35],0
v_exp_f32 v107,v107
v_mfma_f32_16x16x32_bf16 a[224:227],a[136:139],v[36:39],0
v_cvt_pk_bf16_f32 v40,v104,v105
v_cvt_pk_bf16_f32 v41,v106,v107
v_mfma_f32_16x16x32_bf16 a[228:231],a[140:143],v[36:39],0
v_exp_f32 v76,v76
v_mfma_f32_16x16x32_bf16 a[232:235],a[144:147],v[36:39],0
v_exp_f32 v77,v77
v_mfma_f32_16x16x32_bf16 a[236:239],a[148:151],v[36:39],0
v_exp_f32 v78,v78
v_mfma_f32_16x16x32_bf16 a[188:191],a[148:151],v[32:35],0
v_exp_f32 v79,v79
v_mfma_f32_16x16x32_bf16 a[184:187],a[144:147],v[32:35],0
v_cvt_pk_bf16_f32 v46,v76,v77
v_cvt_pk_bf16_f32 v47,v78,v79
v_mfma_f32_16x16x32_bf16 v[136:139],a[144:147],v[28:31],0
v_fma_f32 v87,v87,s36,v14
v_fma_f32 v92,v92,s36,v15
v_mfma_f32_16x16x32_bf16 v[140:143],a[148:151],v[28:31],0
v_exp_f32 v84,v84
v_mfma_f32_16x16x32_bf16 v[236:239],a[148:151],v[24:27],0
v_exp_f32 v85,v85
v_mfma_f32_16x16x32_bf16 v[232:235],a[144:147],v[24:27],0
v_exp_f32 v86,v86
v_mfma_f32_16x16x32_bf16 v[184:187],a[144:147],v[20:23],0
v_exp_f32 v87,v87
v_mfma_f32_16x16x32_bf16 v[188:191],a[148:151],v[20:23],0
v_cvt_pk_bf16_f32 v50,v84,v85
v_cvt_pk_bf16_f32 v51,v86,v87
v_mfma_f32_16x16x32_bf16 v[192:195],a[120:123],v[20:23],0
v_fma_f32 v93,v93,s36,v15
v_fma_f32 v94,v94,s36,v15
v_smfmac_f32_16x16x64_bf16 v[60:63],a[152:155],v[44:51],v18
v_fma_f32 v95,v95,s36,v15
v_mfma_f32_16x16x32_bf16 v[196:199],a[124:127],v[20:23],0
s_waitcnt vmcnt(6) lgkmcnt(0)
v_exp_f32 v92,v92
v_mfma_f32_16x16x32_bf16 v[244:247],a[124:127],v[24:27],0
s_barrier
v_mfma_f32_16x16x32_bf16 v[240:243],a[120:123],v[24:27],0
ds_read_b128 a[136:139],v0 offset:24576
v_fma_f32 v100,v100,s36,v16
v_mfma_f32_16x16x32_bf16 v[144:147],a[120:123],v[28:31],0
ds_read_b128 a[140:143],v1 offset:24576
v_fma_f32 v101,v101,s36,v16
v_mfma_f32_16x16x32_bf16 v[148:151],a[124:127],v[28:31],0
ds_read_b128 a[144:147],v0 offset:24704
v_fma_f32 v102,v102,s36,v16
v_mfma_f32_16x16x32_bf16 a[196:199],a[124:127],v[32:35],0
ds_read_b128 a[148:151],v1 offset:24704
v_fma_f32 v103,v103,s36,v16
v_mfma_f32_16x16x32_bf16 a[192:195],a[120:123],v[32:35],0
v_exp_f32 v93,v93
v_mfma_f32_16x16x32_bf16 a[240:243],a[120:123],v[36:39],0
buffer_load_dwordx4 v6,s[8:11],s21 offen offset:0 lds
v_mfma_f32_16x16x32_bf16 a[244:247],a[124:127],v[36:39],0
ds_read_b128 a[120:123],v0 offset:24832
v_cvt_pk_bf16_f32 v54,v92,v93
v_mfma_f32_16x16x32_bf16 a[248:251],a[128:131],v[36:39],0
ds_read_b128 a[124:127],v1 offset:24832
v_fma_f32 v108,v108,s36,v17
v_mfma_f32_16x16x32_bf16 a[252:255],a[132:135],v[36:39],0
v_exp_f32 v94,v94
v_mfma_f32_16x16x32_bf16 a[204:207],a[132:135],v[32:35],0
v_exp_f32 v95,v95
v_mfma_f32_16x16x32_bf16 a[200:203],a[128:131],v[32:35],0
v_cvt_pk_bf16_f32 v55,v94,v95
v_fma_f32 v109,v109,s36,v17
v_mfma_f32_16x16x32_bf16 v[152:155],a[128:131],v[28:31],0
v_exp_f32 v100,v100
v_mfma_f32_16x16x32_bf16 v[156:159],a[132:135],v[28:31],0
v_exp_f32 v101,v101
v_mfma_f32_16x16x32_bf16 v[252:255],a[132:135],v[24:27],0
v_exp_f32 v102,v102
v_mfma_f32_16x16x32_bf16 v[248:251],a[128:131],v[24:27],0
v_exp_f32 v103,v103
v_mfma_f32_16x16x32_bf16 v[200:203],a[128:131],v[20:23],0
ds_read_b128 a[128:131],v0 offset:30720
v_cvt_pk_bf16_f32 v58,v100,v101
v_mfma_f32_16x16x32_bf16 v[204:207],a[132:135],v[20:23],0
buffer_load_dwordx4 v7,s[8:11],s21 offen offset:1024 lds
s_waitcnt lgkmcnt(1)
v_mfma_f32_16x16x32_bf16 v[72:75],a[136:139],a[0:3],0
ds_read_b128 a[132:135],v1 offset:30720
v_cvt_pk_bf16_f32 v59,v102,v103
v_mfma_f32_16x16x32_bf16 v[72:75],a[140:143],a[4:7],v[72:75]
v_fma_f32 v110,v110,s36,v17
v_fma_f32 v111,v111,s36,v17
v_smfmac_f32_16x16x64_bf16 v[64:67],a[152:155],v[52:59],v18
v_mfma_f32_16x16x32_bf16 v[72:75],a[144:147],a[8:11],v[72:75]
v_exp_f32 v108,v108
v_mfma_f32_16x16x32_bf16 v[72:75],a[148:151],a[12:15],v[72:75]
v_exp_f32 v109,v109
v_mfma_f32_16x16x32_bf16 v[72:75],a[120:123],a[16:19],v[72:75]
v_exp_f32 v110,v110
v_mfma_f32_16x16x32_bf16 v[72:75],a[124:127],a[20:23],v[72:75]
v_exp_f32 v111,v111
v_mfma_f32_16x16x32_bf16 v[80:83],a[124:127],a[44:47],0
v_cvt_pk_bf16_f32 v42,v108,v109
v_cvt_pk_bf16_f32 v43,v110,v111
v_mfma_f32_16x16x32_bf16 v[80:83],a[120:123],a[40:43],v[80:83]
v_mfma_f32_16x16x32_bf16 v[80:83],a[148:151],a[36:39],v[80:83]
v_smfmac_f32_16x16x64_bf16 v[68:71],a[152:155],v[36:43],v18
buffer_load_dwordx4 v8,s[8:11],s21 offen offset:2048 lds
v_mfma_f32_16x16x32_bf16 v[80:83],a[144:147],a[32:35],v[80:83]
s_add_u32 s21,s21,12288
v_fma_f32 v72,v72,s36,v13
v_fma_f32 v73,v73,s36,v13
v_mfma_f32_16x16x32_bf16 v[80:83],a[140:143],a[28:31],v[80:83]
s_add_u32 m0,s22,12288
v_fma_f32 v74,v74,s36,v13
v_fma_f32 v75,v75,s36,v13
v_mfma_f32_16x16x32_bf16 v[80:83],a[136:139],a[24:27],v[80:83]
v_exp_f32 v72,v72
v_mfma_f32_16x16x32_bf16 v[88:91],a[136:139],a[48:51],0
v_exp_f32 v73,v73
v_mfma_f32_16x16x32_bf16 v[88:91],a[140:143],a[52:55],v[88:91]
v_exp_f32 v74,v74
v_mfma_f32_16x16x32_bf16 v[88:91],a[144:147],a[56:59],v[88:91]
v_exp_f32 v75,v75
v_mfma_f32_16x16x32_bf16 v[88:91],a[148:151],a[60:63],v[88:91]
v_fma_f32 v80,v80,s36,v14
v_fma_f32 v81,v81,s36,v14
v_mfma_f32_16x16x32_bf16 v[88:91],a[120:123],a[64:67],v[88:91]
v_fma_f32 v82,v82,s36,v14
v_fma_f32 v83,v83,s36,v14
v_mfma_f32_16x16x32_bf16 v[88:91],a[124:127],a[68:71],v[88:91]
v_exp_f32 v80,v80
v_mfma_f32_16x16x32_bf16 v[96:99],a[124:127],a[92:95],0
v_exp_f32 v81,v81
v_mfma_f32_16x16x32_bf16 v[96:99],a[120:123],a[88:91],v[96:99]
buffer_load_dwordx4 v6,s[4:7],s20 offen offset:0 lds
v_mfma_f32_16x16x32_bf16 v[96:99],a[148:151],a[84:87],v[96:99]
v_exp_f32 v82,v82
v_mfma_f32_16x16x32_bf16 v[96:99],a[144:147],a[80:83],v[96:99]
v_fma_f32 v88,v88,s36,v15
v_fma_f32 v89,v89,s36,v15
v_mfma_f32_16x16x32_bf16 v[96:99],a[140:143],a[76:79],v[96:99]
v_exp_f32 v83,v83
v_mfma_f32_16x16x32_bf16 v[96:99],a[136:139],a[72:75],v[96:99]
v_exp_f32 v88,v88
v_mfma_f32_16x16x32_bf16 v[104:107],a[136:139],a[96:99],0
ds_read_b128 a[136:139],v0 offset:30848
v_cvt_pk_bf16_f32 v20,v72,v73
v_mfma_f32_16x16x32_bf16 v[104:107],a[140:143],a[100:103],v[104:107]
ds_read_b128 a[140:143],v1 offset:30848
v_cvt_pk_bf16_f32 v21,v74,v75
v_mfma_f32_16x16x32_bf16 v[104:107],a[144:147],a[104:107],v[104:107]
ds_read_b128 a[144:147],v0 offset:30976
v_cvt_pk_bf16_f32 v24,v80,v81
v_mfma_f32_16x16x32_bf16 v[104:107],a[148:151],a[108:111],v[104:107]
ds_read_b128 a[148:151],v1 offset:30976
v_cvt_pk_bf16_f32 v25,v82,v83
v_mfma_f32_16x16x32_bf16 v[104:107],a[120:123],a[112:115],v[104:107]
v_exp_f32 v89,v89
v_mfma_f32_16x16x32_bf16 v[104:107],a[124:127],a[116:119],v[104:107]
s_waitcnt lgkmcnt(4)
v_cvt_pk_bf16_f32 v28,v88,v89
v_mfma_f32_16x16x32_bf16 v[76:79],a[128:131],a[0:3],0
v_mfma_f32_16x16x32_bf16 v[76:79],a[132:135],a[4:7],v[76:79]
buffer_load_dwordx4 v7,s[4:7],s20 offen offset:1024 lds
s_waitcnt lgkmcnt(3)
v_mfma_f32_16x16x32_bf16 v[76:79],a[136:139],a[8:11],v[76:79]
s_waitcnt lgkmcnt(2)
v_mfma_f32_16x16x32_bf16 v[76:79],a[140:143],a[12:15],v[76:79]
s_waitcnt lgkmcnt(1)
v_mfma_f32_16x16x32_bf16 v[76:79],a[144:147],a[16:19],v[76:79]
s_waitcnt lgkmcnt(0)
v_mfma_f32_16x16x32_bf16 v[76:79],a[148:151],a[20:23],v[76:79]
v_mfma_f32_16x16x32_bf16 v[84:87],a[148:151],a[44:47],0
v_mfma_f32_16x16x32_bf16 v[84:87],a[144:147],a[40:43],v[84:87]
v_mfma_f32_16x16x32_bf16 v[84:87],a[140:143],a[36:39],v[84:87]
v_mfma_f32_16x16x32_bf16 v[84:87],a[136:139],a[32:35],v[84:87]
v_mfma_f32_16x16x32_bf16 v[84:87],a[132:135],a[28:31],v[84:87]
v_mfma_f32_16x16x32_bf16 v[84:87],a[128:131],a[24:27],v[84:87]
v_mfma_f32_16x16x32_bf16 v[92:95],a[128:131],a[48:51],0
buffer_load_dwordx4 v8,s[4:7],s20 offen offset:2048 lds
v_mfma_f32_16x16x32_bf16 v[92:95],a[132:135],a[52:55],v[92:95]
s_add_u32 s20,s20,12288
v_mfma_f32_16x16x32_bf16 v[92:95],a[136:139],a[56:59],v[92:95]
v_mfma_f32_16x16x32_bf16 v[92:95],a[140:143],a[60:63],v[92:95]
v_mfma_f32_16x16x32_bf16 v[92:95],a[144:147],a[64:67],v[92:95]
v_mfma_f32_16x16x32_bf16 v[92:95],a[148:151],a[68:71],v[92:95]
ds_read_b64_tr_b16 a[120:121],v2 offset:12288
v_mfma_f32_16x16x32_bf16 v[100:103],a[148:151],a[92:95],0
ds_read_b64_tr_b16 a[122:123],v2 offset:18432
v_mfma_f32_16x16x32_bf16 v[100:103],a[144:147],a[88:91],v[100:103]
v_mfma_f32_16x16x32_bf16 v[100:103],a[140:143],a[84:87],v[100:103]
ds_read_b64_tr_b16 a[124:125],v3 offset:12288
v_mfma_f32_16x16x32_bf16 v[100:103],a[136:139],a[80:83],v[100:103]
ds_read_b64_tr_b16 a[126:127],v3 offset:18432
v_mfma_f32_16x16x32_bf16 v[100:103],a[132:135],a[76:79],v[100:103]
v_mfma_f32_16x16x32_bf16 v[100:103],a[128:131],a[72:75],v[100:103]
v_mfma_f32_16x16x32_bf16 v[108:111],a[128:131],a[96:99],0
ds_read_b64_tr_b16 a[128:129],v4 offset:12288
v_mfma_f32_16x16x32_bf16 v[108:111],a[132:135],a[100:103],v[108:111]
ds_read_b64_tr_b16 a[130:131],v4 offset:18432
v_mfma_f32_16x16x32_bf16 v[108:111],a[136:139],a[104:107],v[108:111]
ds_read_b64_tr_b16 a[132:133],v5 offset:12288
v_mfma_f32_16x16x32_bf16 v[108:111],a[140:143],a[108:111],v[108:111]
ds_read_b64_tr_b16 a[134:135],v5 offset:18432
v_mfma_f32_16x16x32_bf16 v[108:111],a[144:147],a[112:115],v[108:111]
v_mfma_f32_16x16x32_bf16 v[108:111],a[148:151],a[116:119],v[108:111]
s_waitcnt lgkmcnt(4)
v_mfma_f32_16x16x32_bf16 v[160:163],a[120:123],v[44:47],v[160:163]
s_add_u32 m0,s23,12288
ds_read_b64_tr_b16 a[136:137],v2 offset:12416
v_fma_f32 v90,v90,s36,v15
v_mfma_f32_16x16x32_bf16 v[164:167],a[124:127],v[44:47],v[164:167]
ds_read_b64_tr_b16 a[138:139],v2 offset:18560
v_fma_f32 v91,v91,s36,v15
v_mfma_f32_16x16x32_bf16 v[212:215],a[124:127],v[48:51],v[212:215]
ds_read_b64_tr_b16 a[140:141],v3 offset:12416
v_fma_f32 v96,v96,s36,v16
v_mfma_f32_16x16x32_bf16 v[208:211],a[120:123],v[48:51],v[208:211]
ds_read_b64_tr_b16 a[142:143],v3 offset:18560
v_fma_f32 v97,v97,s36,v16
v_mfma_f32_16x16x32_bf16 v[112:115],a[120:123],v[52:55],v[112:115]
ds_read_b64_tr_b16 a[144:145],v4 offset:12416
v_fma_f32 v98,v98,s36,v16
v_mfma_f32_16x16x32_bf16 v[116:119],a[124:127],v[52:55],v[116:119]
ds_read_b64_tr_b16 a[146:147],v4 offset:18560
v_fma_f32 v99,v99,s36,v16
v_mfma_f32_16x16x32_bf16 a[164:167],a[124:127],v[56:59],a[164:167]
ds_read_b64_tr_b16 a[148:149],v5 offset:12416
v_fma_f32 v104,v104,s36,v17
v_mfma_f32_16x16x32_bf16 a[160:163],a[120:123],v[56:59],a[160:163]
ds_read_b64_tr_b16 a[150:151],v5 offset:18560
v_fma_f32 v105,v105,s36,v17
v_mfma_f32_16x16x32_bf16 a[208:211],a[120:123],v[40:43],a[208:211]
ds_read_b64_tr_b16 a[120:121],v2 offset:12544
v_fma_f32 v106,v106,s36,v17
v_mfma_f32_16x16x32_bf16 a[212:215],a[124:127],v[40:43],a[212:215]
s_waitcnt lgkmcnt(6)
ds_read_b64_tr_b16 a[122:123],v2 offset:18688
v_fma_f32 v107,v107,s36,v17
v_mfma_f32_16x16x32_bf16 a[216:219],a[128:131],v[40:43],a[216:219]
ds_read_b64_tr_b16 a[124:125],v3 offset:12544
v_fma_f32 v76,v76,s36,v13
v_mfma_f32_16x16x32_bf16 a[220:223],a[132:135],v[40:43],a[220:223]
ds_read_b64_tr_b16 a[126:127],v3 offset:18688
v_fma_f32 v77,v77,s36,v13
v_mfma_f32_16x16x32_bf16 a[172:175],a[132:135],v[56:59],a[172:175]
v_exp_f32 v90,v90
v_mfma_f32_16x16x32_bf16 a[168:171],a[128:131],v[56:59],a[168:171]
v_exp_f32 v91,v91
v_mfma_f32_16x16x32_bf16 v[120:123],a[128:131],v[52:55],v[120:123]
v_cvt_pk_bf16_f32 v29,v90,v91
v_fma_f32 v78,v78,s36,v13
v_mfma_f32_16x16x32_bf16 v[124:127],a[132:135],v[52:55],v[124:127]
v_exp_f32 v96,v96
v_mfma_f32_16x16x32_bf16 v[220:223],a[132:135],v[48:51],v[220:223]
v_exp_f32 v97,v97
v_mfma_f32_16x16x32_bf16 v[216:219],a[128:131],v[48:51],v[216:219]
v_exp_f32 v98,v98
v_mfma_f32_16x16x32_bf16 v[168:171],a[128:131],v[44:47],v[168:171]
ds_read_b64_tr_b16 a[128:129],v4 offset:12544
v_cvt_pk_bf16_f32 v32,v96,v97
v_mfma_f32_16x16x32_bf16 v[172:175],a[132:135],v[44:47],v[172:175]
ds_read_b64_tr_b16 a[130:131],v4 offset:18688
v_fma_f32 v79,v79,s36,v13
v_mfma_f32_16x16x32_bf16 v[176:179],a[136:139],v[44:47],v[176:179]
s_waitcnt lgkmcnt(2)
ds_read_b64_tr_b16 a[132:133],v5 offset:12544
v_fma_f32 v84,v84,s36,v14
v_mfma_f32_16x16x32_bf16 v[180:183],a[140:143],v[44:47],v[180:183]
ds_read_b64_tr_b16 a[134:135],v5 offset:18688
v_fma_f32 v85,v85,s36,v14
v_mfma_f32_16x16x32_bf16 v[228:231],a[140:143],v[48:51],v[228:231]
v_exp_f32 v99,v99
v_mfma_f32_16x16x32_bf16 v[224:227],a[136:139],v[48:51],v[224:227]
v_cvt_pk_bf16_f32 v33,v98,v99
v_fma_f32 v86,v86,s36,v14
v_mfma_f32_16x16x32_bf16 v[128:131],a[136:139],v[52:55],v[128:131]
v_exp_f32 v104,v104
v_mfma_f32_16x16x32_bf16 v[132:135],a[140:143],v[52:55],v[132:135]
v_exp_f32 v105,v105
v_mfma_f32_16x16x32_bf16 a[180:183],a[140:143],v[56:59],a[180:183]
v_exp_f32 v106,v106
v_mfma_f32_16x16x32_bf16 a[176:179],a[136:139],v[56:59],a[176:179]
v_exp_f32 v107,v107
v_mfma_f32_16x16x32_bf16 a[224:227],a[136:139],v[40:43],a[224:227]
v_cvt_pk_bf16_f32 v36,v104,v105
v_cvt_pk_bf16_f32 v37,v106,v107
v_mfma_f32_16x16x32_bf16 a[228:231],a[140:143],v[40:43],a[228:231]
v_exp_f32 v76,v76
v_mfma_f32_16x16x32_bf16 a[232:235],a[144:147],v[40:43],a[232:235]
v_exp_f32 v77,v77
v_mfma_f32_16x16x32_bf16 a[236:239],a[148:151],v[40:43],a[236:239]
v_exp_f32 v78,v78
v_mfma_f32_16x16x32_bf16 a[188:191],a[148:151],v[56:59],a[188:191]
v_exp_f32 v79,v79
v_mfma_f32_16x16x32_bf16 a[184:187],a[144:147],v[56:59],a[184:187]
v_cvt_pk_bf16_f32 v22,v76,v77
v_cvt_pk_bf16_f32 v23,v78,v79
v_mfma_f32_16x16x32_bf16 v[136:139],a[144:147],v[52:55],v[136:139]
v_fma_f32 v87,v87,s36,v14
v_fma_f32 v92,v92,s36,v15
v_mfma_f32_16x16x32_bf16 v[140:143],a[148:151],v[52:55],v[140:143]
v_exp_f32 v84,v84
v_mfma_f32_16x16x32_bf16 v[236:239],a[148:151],v[48:51],v[236:239]
v_exp_f32 v85,v85
v_mfma_f32_16x16x32_bf16 v[232:235],a[144:147],v[48:51],v[232:235]
v_exp_f32 v86,v86
v_mfma_f32_16x16x32_bf16 v[184:187],a[144:147],v[44:47],v[184:187]
v_exp_f32 v87,v87
v_mfma_f32_16x16x32_bf16 v[188:191],a[148:151],v[44:47],v[188:191]
v_cvt_pk_bf16_f32 v26,v84,v85
v_cvt_pk_bf16_f32 v27,v86,v87
v_mfma_f32_16x16x32_bf16 v[192:195],a[120:123],v[44:47],v[192:195]
v_fma_f32 v93,v93,s36,v15
v_fma_f32 v94,v94,s36,v15
v_smfmac_f32_16x16x64_bf16 v[60:63],a[152:155],v[20:27],v18
v_fma_f32 v95,v95,s36,v15
v_mfma_f32_16x16x32_bf16 v[196:199],a[124:127],v[44:47],v[196:199]
s_waitcnt vmcnt(6) lgkmcnt(0)
v_exp_f32 v92,v92
v_mfma_f32_16x16x32_bf16 v[244:247],a[124:127],v[48:51],v[244:247]
s_barrier
v_mfma_f32_16x16x32_bf16 v[240:243],a[120:123],v[48:51],v[240:243]
ds_read_b128 a[136:139],v0 offset:0
v_fma_f32 v100,v100,s36,v16
v_mfma_f32_16x16x32_bf16 v[144:147],a[120:123],v[52:55],v[144:147]
ds_read_b128 a[140:143],v1 offset:0
v_fma_f32 v101,v101,s36,v16
v_mfma_f32_16x16x32_bf16 v[148:151],a[124:127],v[52:55],v[148:151]
ds_read_b128 a[144:147],v0 offset:128
v_fma_f32 v102,v102,s36,v16
v_mfma_f32_16x16x32_bf16 a[196:199],a[124:127],v[56:59],a[196:199]
ds_read_b128 a[148:151],v1 offset:128
v_fma_f32 v103,v103,s36,v16
v_mfma_f32_16x16x32_bf16 a[192:195],a[120:123],v[56:59],a[192:195]
v_exp_f32 v93,v93
v_mfma_f32_16x16x32_bf16 a[240:243],a[120:123],v[40:43],a[240:243]
buffer_load_dwordx4 v6,s[8:11],s21 offen offset:0 lds
v_mfma_f32_16x16x32_bf16 a[244:247],a[124:127],v[40:43],a[244:247]
ds_read_b128 a[120:123],v0 offset:256
v_cvt_pk_bf16_f32 v30,v92,v93
v_mfma_f32_16x16x32_bf16 a[248:251],a[128:131],v[40:43],a[248:251]
ds_read_b128 a[124:127],v1 offset:256
v_fma_f32 v108,v108,s36,v17
v_mfma_f32_16x16x32_bf16 a[252:255],a[132:135],v[40:43],a[252:255]
v_exp_f32 v94,v94
v_mfma_f32_16x16x32_bf16 a[204:207],a[132:135],v[56:59],a[204:207]
v_exp_f32 v95,v95
v_mfma_f32_16x16x32_bf16 a[200:203],a[128:131],v[56:59],a[200:203]
v_cvt_pk_bf16_f32 v31,v94,v95
v_fma_f32 v109,v109,s36,v17
v_mfma_f32_16x16x32_bf16 v[152:155],a[128:131],v[52:55],v[152:155]
v_exp_f32 v100,v100
v_mfma_f32_16x16x32_bf16 v[156:159],a[132:135],v[52:55],v[156:159]
v_exp_f32 v101,v101
v_mfma_f32_16x16x32_bf16 v[252:255],a[132:135],v[48:51],v[252:255]
v_exp_f32 v102,v102
v_mfma_f32_16x16x32_bf16 v[248:251],a[128:131],v[48:51],v[248:251]
v_exp_f32 v103,v103
v_mfma_f32_16x16x32_bf16 v[200:203],a[128:131],v[44:47],v[200:203]
ds_read_b128 a[128:131],v0 offset:6144
v_cvt_pk_bf16_f32 v34,v100,v101
v_mfma_f32_16x16x32_bf16 v[204:207],a[132:135],v[44:47],v[204:207]
buffer_load_dwordx4 v7,s[8:11],s21 offen offset:1024 lds
s_waitcnt lgkmcnt(1)
v_mfma_f32_16x16x32_bf16 v[72:75],a[136:139],a[0:3],0
ds_read_b128 a[132:135],v1 offset:6144
v_cvt_pk_bf16_f32 v35,v102,v103
v_mfma_f32_16x16x32_bf16 v[72:75],a[140:143],a[4:7],v[72:75]
v_fma_f32 v110,v110,s36,v17
v_fma_f32 v111,v111,s36,v17
v_smfmac_f32_16x16x64_bf16 v[64:67],a[152:155],v[28:35],v18
v_mfma_f32_16x16x32_bf16 v[72:75],a[144:147],a[8:11],v[72:75]
v_exp_f32 v108,v108
v_mfma_f32_16x16x32_bf16 v[72:75],a[148:151],a[12:15],v[72:75]
v_exp_f32 v109,v109
v_mfma_f32_16x16x32_bf16 v[72:75],a[120:123],a[16:19],v[72:75]
v_exp_f32 v110,v110
v_mfma_f32_16x16x32_bf16 v[72:75],a[124:127],a[20:23],v[72:75]
v_exp_f32 v111,v111
v_mfma_f32_16x16x32_bf16 v[80:83],a[124:127],a[44:47],0
v_cvt_pk_bf16_f32 v38,v108,v109
v_cvt_pk_bf16_f32 v39,v110,v111
v_mfma_f32_16x16x32_bf16 v[80:83],a[120:123],a[40:43],v[80:83]
v_mfma_f32_16x16x32_bf16 v[80:83],a[148:151],a[36:39],v[80:83]
v_mfma_f32_16x16x32_bf16 v[80:83],a[144:147],a[32:35],v[80:83]
buffer_load_dwordx4 v8,s[8:11],s21 offen offset:2048 lds
v_mfma_f32_16x16x32_bf16 v[80:83],a[140:143],a[28:31],v[80:83]
s_add_u32 s21,s21,12288
v_fma_f32 v72,v72,s36,v13
v_fma_f32 v73,v73,s36,v13
v_mfma_f32_16x16x32_bf16 v[80:83],a[136:139],a[24:27],v[80:83]
s_add_u32 m0,s22,24576
v_fma_f32 v74,v74,s36,v13
v_fma_f32 v75,v75,s36,v13
v_mfma_f32_16x16x32_bf16 v[88:91],a[136:139],a[48:51],0
v_exp_f32 v72,v72
v_mfma_f32_16x16x32_bf16 v[88:91],a[140:143],a[52:55],v[88:91]
v_exp_f32 v73,v73
v_mfma_f32_16x16x32_bf16 v[88:91],a[144:147],a[56:59],v[88:91]
v_fma_f32 v80,v80,s36,v14
v_fma_f32 v81,v81,s36,v14
v_mfma_f32_16x16x32_bf16 v[88:91],a[148:151],a[60:63],v[88:91]
v_fma_f32 v82,v82,s36,v14
v_fma_f32 v83,v83,s36,v14
v_mfma_f32_16x16x32_bf16 v[88:91],a[120:123],a[64:67],v[88:91]
v_exp_f32 v74,v74
v_mfma_f32_16x16x32_bf16 v[88:91],a[124:127],a[68:71],v[88:91]
v_exp_f32 v75,v75
v_mfma_f32_16x16x32_bf16 v[96:99],a[124:127],a[92:95],0
v_exp_f32 v80,v80
v_mfma_f32_16x16x32_bf16 v[96:99],a[120:123],a[88:91],v[96:99]
v_exp_f32 v81,v81
v_mfma_f32_16x16x32_bf16 v[96:99],a[148:151],a[84:87],v[96:99]
v_exp_f32 v82,v82
v_mfma_f32_16x16x32_bf16 v[96:99],a[144:147],a[80:83],v[96:99]
buffer_load_dwordx4 v6,s[4:7],s20 offen offset:0 lds
v_mfma_f32_16x16x32_bf16 v[96:99],a[140:143],a[76:79],v[96:99]
v_fma_f32 v88,v88,s36,v15
v_fma_f32 v89,v89,s36,v15
v_mfma_f32_16x16x32_bf16 v[96:99],a[136:139],a[72:75],v[96:99]
v_exp_f32 v83,v83
v_mfma_f32_16x16x32_bf16 v[104:107],a[136:139],a[96:99],0
ds_read_b128 a[136:139],v0 offset:6272
v_cvt_pk_bf16_f32 v44,v72,v73
v_mfma_f32_16x16x32_bf16 v[104:107],a[140:143],a[100:103],v[104:107]
ds_read_b128 a[140:143],v1 offset:6272
v_cvt_pk_bf16_f32 v45,v74,v75
v_mfma_f32_16x16x32_bf16 v[104:107],a[144:147],a[104:107],v[104:107]
ds_read_b128 a[144:147],v0 offset:6400
v_cvt_pk_bf16_f32 v48,v80,v81
v_mfma_f32_16x16x32_bf16 v[104:107],a[148:151],a[108:111],v[104:107]
ds_read_b128 a[148:151],v1 offset:6400
v_cvt_pk_bf16_f32 v49,v82,v83
v_mfma_f32_16x16x32_bf16 v[104:107],a[120:123],a[112:115],v[104:107]
v_exp_f32 v88,v88
v_mfma_f32_16x16x32_bf16 v[104:107],a[124:127],a[116:119],v[104:107]
s_waitcnt lgkmcnt(4)
v_exp_f32 v89,v89
v_mfma_f32_16x16x32_bf16 v[76:79],a[128:131],a[0:3],0
v_cvt_pk_bf16_f32 v52,v88,v89
v_mfma_f32_16x16x32_bf16 v[76:79],a[132:135],a[4:7],v[76:79]
s_waitcnt lgkmcnt(3)
v_mfma_f32_16x16x32_bf16 v[76:79],a[136:139],a[8:11],v[76:79]
buffer_load_dwordx4 v7,s[4:7],s20 offen offset:1024 lds
s_waitcnt lgkmcnt(2)
v_mfma_f32_16x16x32_bf16 v[76:79],a[140:143],a[12:15],v[76:79]
s_waitcnt lgkmcnt(1)
v_mfma_f32_16x16x32_bf16 v[76:79],a[144:147],a[16:19],v[76:79]
s_waitcnt lgkmcnt(0)
v_mfma_f32_16x16x32_bf16 v[76:79],a[148:151],a[20:23],v[76:79]
v_mfma_f32_16x16x32_bf16 v[84:87],a[148:151],a[44:47],0
v_mfma_f32_16x16x32_bf16 v[84:87],a[144:147],a[40:43],v[84:87]
v_mfma_f32_16x16x32_bf16 v[84:87],a[140:143],a[36:39],v[84:87]
v_mfma_f32_16x16x32_bf16 v[84:87],a[136:139],a[32:35],v[84:87]
v_mfma_f32_16x16x32_bf16 v[84:87],a[132:135],a[28:31],v[84:87]
v_mfma_f32_16x16x32_bf16 v[84:87],a[128:131],a[24:27],v[84:87]
v_mfma_f32_16x16x32_bf16 v[92:95],a[128:131],a[48:51],0
v_mfma_f32_16x16x32_bf16 v[92:95],a[132:135],a[52:55],v[92:95]
buffer_load_dwordx4 v8,s[4:7],s20 offen offset:2048 lds
v_mfma_f32_16x16x32_bf16 v[92:95],a[136:139],a[56:59],v[92:95]
s_add_u32 s20,s20,12288
v_mfma_f32_16x16x32_bf16 v[92:95],a[140:143],a[60:63],v[92:95]
v_mfma_f32_16x16x32_bf16 v[92:95],a[144:147],a[64:67],v[92:95]
v_mfma_f32_16x16x32_bf16 v[92:95],a[148:151],a[68:71],v[92:95]
v_mfma_f32_16x16x32_bf16 v[100:103],a[148:151],a[92:95],0
v_mfma_f32_16x16x32_bf16 v[100:103],a[144:147],a[88:91],v[100:103]
ds_read_b64_tr_b16 a[120:121],v2 offset:24576
v_mfma_f32_16x16x32_bf16 v[100:103],a[140:143],a[84:87],v[100:103]
ds_read_b64_tr_b16 a[122:123],v2 offset:30720
v_mfma_f32_16x16x32_bf16 v[100:103],a[136:139],a[80:83],v[100:103]
ds_read_b64_tr_b16 a[124:125],v3 offset:24576
v_mfma_f32_16x16x32_bf16 v[100:103],a[132:135],a[76:79],v[100:103]
ds_read_b64_tr_b16 a[126:127],v3 offset:30720
v_mfma_f32_16x16x32_bf16 v[100:103],a[128:131],a[72:75],v[100:103]
v_mfma_f32_16x16x32_bf16 v[108:111],a[128:131],a[96:99],0
ds_read_b64_tr_b16 a[128:129],v4 offset:24576
v_mfma_f32_16x16x32_bf16 v[108:111],a[132:135],a[100:103],v[108:111]
ds_read_b64_tr_b16 a[130:131],v4 offset:30720
v_mfma_f32_16x16x32_bf16 v[108:111],a[136:139],a[104:107],v[108:111]
ds_read_b64_tr_b16 a[132:133],v5 offset:24576
v_mfma_f32_16x16x32_bf16 v[108:111],a[140:143],a[108:111],v[108:111]
ds_read_b64_tr_b16 a[134:135],v5 offset:30720
v_mfma_f32_16x16x32_bf16 v[108:111],a[144:147],a[112:115],v[108:111]
v_mfma_f32_16x16x32_bf16 v[108:111],a[148:151],a[116:119],v[108:111]
s_mov_b32 s38,0
s_branch L_loop5
L_start4:
s_add_u32 m0,s24,12288
s_waitcnt vmcnt(9)
ds_read_b128 a[0:3],v11 offset:0
buffer_load_dwordx4 v6,s[12:15],s28 offen offset:0 nt lds
ds_read_b128 a[4:7],v12 offset:0
buffer_load_dwordx4 v7,s[12:15],s28 offen offset:1024 nt lds
ds_read_b128 a[8:11],v11 offset:128
buffer_load_dwordx4 v8,s[12:15],s28 offen offset:2048 nt lds
s_add_u32 s28,s28,3072
s_add_u32 m0,s24,15360
ds_read_b128 a[12:15],v12 offset:128
buffer_load_dwordx4 v6,s[12:15],s28 offen offset:0 nt lds
ds_read_b128 a[16:19],v11 offset:256
buffer_load_dwordx4 v7,s[12:15],s28 offen offset:1024 nt lds
ds_read_b128 a[20:23],v12 offset:256
buffer_load_dwordx4 v8,s[12:15],s28 offen offset:2048 nt lds
s_add_u32 s28,s28,3072
s_add_u32 m0,s24,0
ds_read_b128 a[120:123],v0 offset:0
v_mov_b32 v60,0
ds_read_b128 a[124:127],v1 offset:0
v_mov_b32 v61,0
ds_read_b128 a[128:131],v0 offset:128
v_mov_b32 v62,0
ds_read_b128 a[132:135],v1 offset:128
v_mov_b32 v63,0
ds_read_b128 a[136:139],v0 offset:256
v_mov_b32 v64,0
ds_read_b128 a[140:143],v1 offset:256
v_mov_b32 v65,0
ds_read_b128 a[144:147],v0 offset:6144
v_mov_b32 v66,0
ds_read_b128 a[148:151],v1 offset:6144
v_mov_b32 v67,0
s_waitcnt lgkmcnt(7)
v_mfma_f32_16x16x32_bf16 v[72:75],a[120:123],a[0:3],0
s_waitcnt lgkmcnt(6)
ds_read_b128 a[120:123],v0 offset:6272
v_mfma_f32_16x16x32_bf16 v[72:75],a[124:127],a[4:7],v[72:75]
s_waitcnt lgkmcnt(6)
ds_read_b128 a[124:127],v1 offset:6272
v_mfma_f32_16x16x32_bf16 v[72:75],a[128:131],a[8:11],v[72:75]
s_waitcnt lgkmcnt(6)
ds_read_b128 a[128:131],v0 offset:6400
v_mfma_f32_16x16x32_bf16 v[72:75],a[132:135],a[12:15],v[72:75]
s_waitcnt lgkmcnt(6)
ds_read_b128 a[132:135],v1 offset:6400
v_mfma_f32_16x16x32_bf16 v[72:75],a[136:139],a[16:19],v[72:75]
s_waitcnt lgkmcnt(6)
ds_read_b128 a[136:139],v0 offset:0
v_mfma_f32_16x16x32_bf16 v[72:75],a[140:143],a[20:23],v[72:75]
s_waitcnt lgkmcnt(6)
ds_read_b128 a[140:143],v1 offset:0
v_mfma_f32_16x16x32_bf16 v[76:79],a[144:147],a[0:3],0
s_waitcnt lgkmcnt(6)
ds_read_b128 a[144:147],v0 offset:128
v_mfma_f32_16x16x32_bf16 v[76:79],a[148:151],a[4:7],v[76:79]
s_waitcnt lgkmcnt(6)
ds_read_b128 a[148:151],v1 offset:128
v_mfma_f32_16x16x32_bf16 v[76:79],a[120:123],a[8:11],v[76:79]
s_waitcnt lgkmcnt(6)
ds_read_b128 a[120:123],v0 offset:256
v_mfma_f32_16x16x32_bf16 v[76:79],a[124:127],a[12:15],v[76:79]
s_waitcnt lgkmcnt(6)
ds_read_b128 a[124:127],v1 offset:256
v_max3_f32 v44,v72,v73,v74
v_mfma_f32_16x16x32_bf16 v[76:79],a[128:131],a[16:19],v[76:79]
s_waitcnt lgkmcnt(6)
ds_read_b128 a[128:131],v0 offset:6144
v_mfma_f32_16x16x32_bf16 v[76:79],a[132:135],a[20:23],v[76:79]
s_waitcnt vmcnt(6)
ds_read_b128 a[24:27],v11 offset:6144
buffer_load_dwordx4 v6,s[12:15],s28 offen offset:0 nt lds
ds_read_b128 a[28:31],v12 offset:6144
buffer_load_dwordx4 v7,s[12:15],s28 offen offset:1024 nt lds
ds_read_b128 a[32:35],v11 offset:6272
buffer_load_dwordx4 v8,s[12:15],s28 offen offset:2048 nt lds
s_add_u32 s28,s28,3072
s_add_u32 m0,s24,3072
ds_read_b128 a[36:39],v12 offset:6272
buffer_load_dwordx4 v6,s[12:15],s28 offen offset:0 nt lds
ds_read_b128 a[40:43],v11 offset:6400
buffer_load_dwordx4 v7,s[12:15],s28 offen offset:1024 nt lds
ds_read_b128 a[44:47],v12 offset:6400
buffer_load_dwordx4 v8,s[12:15],s28 offen offset:2048 nt lds
s_add_u32 s28,s28,3072
s_add_u32 m0,s23,0
ds_read_b128 a[132:135],v1 offset:6144
v_max3_f32 v44,v44,v75,v76
s_waitcnt lgkmcnt(6)
v_mfma_f32_16x16x32_bf16 v[80:83],a[136:139],a[24:27],0
s_waitcnt lgkmcnt(5)
ds_read_b128 a[136:139],v0 offset:6272
v_max3_f32 v44,v44,v77,v78
v_mfma_f32_16x16x32_bf16 v[80:83],a[140:143],a[28:31],v[80:83]
s_waitcnt lgkmcnt(5)
ds_read_b128 a[140:143],v1 offset:6272
v_max_f32 v44,v44,v79
v_mfma_f32_16x16x32_bf16 v[80:83],a[144:147],a[32:35],v[80:83]
s_waitcnt lgkmcnt(5)
ds_read_b128 a[144:147],v0 offset:6400
v_mov_b32 v45,v44
v_mfma_f32_16x16x32_bf16 v[80:83],a[148:151],a[36:39],v[80:83]
s_waitcnt lgkmcnt(5)
ds_read_b128 a[148:151],v1 offset:6400
v_permlane32_swap_b32 v45,v44
v_mfma_f32_16x16x32_bf16 v[80:83],a[120:123],a[40:43],v[80:83]
s_waitcnt lgkmcnt(5)
ds_read_b128 a[120:123],v0 offset:12288
v_max_f32 v44,v44,v45
v_mfma_f32_16x16x32_bf16 v[80:83],a[124:127],a[44:47],v[80:83]
ds_read_b128 a[124:127],v1 offset:12288
v_mov_b32 v45,v44
v_mfma_f32_16x16x32_bf16 v[84:87],a[128:131],a[24:27],0
s_waitcnt lgkmcnt(5)
ds_read_b128 a[128:131],v0 offset:12416
v_permlane16_swap_b32 v45,v44
v_mfma_f32_16x16x32_bf16 v[84:87],a[132:135],a[28:31],v[84:87]
ds_read_b128 a[132:135],v1 offset:12416
v_max_f32 v44,v44,v45
v_mfma_f32_16x16x32_bf16 v[84:87],a[136:139],a[32:35],v[84:87]
s_waitcnt lgkmcnt(5)
ds_read_b128 a[136:139],v0 offset:12544
v_mul_f32_e64 v13,-s36,v44
v_mfma_f32_16x16x32_bf16 v[84:87],a[140:143],a[36:39],v[84:87]
ds_read_b128 a[140:143],v1 offset:12544
v_fma_f32 v72,v72,s36,v13
v_mfma_f32_16x16x32_bf16 v[84:87],a[144:147],a[40:43],v[84:87]
s_waitcnt lgkmcnt(5)
ds_read_b128 a[144:147],v0 offset:18432
v_fma_f32 v73,v73,s36,v13
v_mfma_f32_16x16x32_bf16 v[84:87],a[148:151],a[44:47],v[84:87]
ds_read_b128 a[148:151],v1 offset:18432
v_fma_f32 v74,v74,s36,v13
v_fma_f32 v75,v75,s36,v13
v_exp_f32 v72,v72
v_exp_f32 v73,v73
v_exp_f32 v74,v74
v_exp_f32 v75,v75
v_cvt_pk_bf16_f32 v20,v72,v73
v_cvt_pk_bf16_f32 v21,v74,v75
v_mfma_f32_16x16x32_bf16 v[72:75],a[120:123],a[0:3],0
s_waitcnt lgkmcnt(3)
ds_read_b128 a[120:123],v0 offset:18560
v_fma_f32 v76,v76,s36,v13
v_mfma_f32_16x16x32_bf16 v[72:75],a[124:127],a[4:7],v[72:75]
ds_read_b128 a[124:127],v1 offset:18560
v_fma_f32 v77,v77,s36,v13
v_mfma_f32_16x16x32_bf16 v[72:75],a[128:131],a[8:11],v[72:75]
ds_read_b128 a[128:131],v0 offset:18688
v_fma_f32 v78,v78,s36,v13
v_mfma_f32_16x16x32_bf16 v[72:75],a[132:135],a[12:15],v[72:75]
ds_read_b128 a[132:135],v1 offset:18688
v_fma_f32 v79,v79,s36,v13
v_mfma_f32_16x16x32_bf16 v[72:75],a[136:139],a[16:19],v[72:75]
s_waitcnt lgkmcnt(4)
ds_read_b128 a[136:139],v0 offset:0
v_exp_f32 v76,v76
v_mfma_f32_16x16x32_bf16 v[72:75],a[140:143],a[20:23],v[72:75]
ds_read_b128 a[140:143],v1 offset:0
v_exp_f32 v77,v77
v_exp_f32 v78,v78
v_exp_f32 v79,v79
v_cvt_pk_bf16_f32 v22,v76,v77
v_cvt_pk_bf16_f32 v23,v78,v79
v_mfma_f32_16x16x32_bf16 v[76:79],a[144:147],a[0:3],0
ds_read_b128 a[144:147],v0 offset:128
v_max3_f32 v48,v80,v81,v82
v_mfma_f32_16x16x32_bf16 v[76:79],a[148:151],a[4:7],v[76:79]
s_waitcnt lgkmcnt(4)
ds_read_b128 a[148:151],v1 offset:128
v_max3_f32 v48,v48,v83,v84
v_mfma_f32_16x16x32_bf16 v[76:79],a[120:123],a[8:11],v[76:79]
ds_read_b128 a[120:123],v0 offset:256
v_max3_f32 v48,v48,v85,v86
v_mfma_f32_16x16x32_bf16 v[76:79],a[124:127],a[12:15],v[76:79]
ds_read_b128 a[124:127],v1 offset:256
v_max_f32 v48,v48,v87
v_mfma_f32_16x16x32_bf16 v[76:79],a[128:131],a[16:19],v[76:79]
s_waitcnt lgkmcnt(4)
ds_read_b128 a[128:131],v0 offset:6144
v_mov_b32 v49,v48
v_mfma_f32_16x16x32_bf16 v[76:79],a[132:135],a[20:23],v[76:79]
s_waitcnt vmcnt(6)
ds_read_b128 a[48:51],v11 offset:12288
buffer_load_dwordx4 v6,s[8:11],s21 offen offset:0 lds
ds_read_b128 a[52:55],v12 offset:12288
buffer_load_dwordx4 v7,s[8:11],s21 offen offset:1024 lds
ds_read_b128 a[56:59],v11 offset:12416
buffer_load_dwordx4 v8,s[8:11],s21 offen offset:2048 lds
s_add_u32 s21,s21,12288
s_add_u32 m0,s22,24576
ds_read_b128 a[60:63],v12 offset:12416
buffer_load_dwordx4 v6,s[4:7],s20 offen offset:0 lds
ds_read_b128 a[64:67],v11 offset:12544
buffer_load_dwordx4 v7,s[4:7],s20 offen offset:1024 lds
ds_read_b128 a[68:71],v12 offset:12544
buffer_load_dwordx4 v8,s[4:7],s20 offen offset:2048 lds
s_add_u32 s20,s20,12288
s_add_u32 m0,s23,12288
ds_read_b128 a[132:135],v1 offset:6144
v_permlane32_swap_b32 v49,v48
s_waitcnt lgkmcnt(6)
v_mfma_f32_16x16x32_bf16 v[88:91],a[136:139],a[48:51],0
s_waitcnt lgkmcnt(5)
ds_read_b128 a[136:139],v0 offset:6272
v_max_f32 v48,v48,v49
v_mfma_f32_16x16x32_bf16 v[88:91],a[140:143],a[52:55],v[88:91]
s_waitcnt lgkmcnt(5)
ds_read_b128 a[140:143],v1 offset:6272
v_mov_b32 v49,v48
v_mfma_f32_16x16x32_bf16 v[88:91],a[144:147],a[56:59],v[88:91]
s_waitcnt lgkmcnt(5)
ds_read_b128 a[144:147],v0 offset:6400
v_permlane16_swap_b32 v49,v48
v_mfma_f32_16x16x32_bf16 v[88:91],a[148:151],a[60:63],v[88:91]
s_waitcnt lgkmcnt(4)
ds_read_b128 a[148:151],v1 offset:6400
v_max_f32 v48,v48,v49
v_mfma_f32_16x16x32_bf16 v[88:91],a[120:123],a[64:67],v[88:91]
ds_read_b128 a[120:123],v0 offset:12288
v_mul_f32_e64 v14,-s36,v48
v_mfma_f32_16x16x32_bf16 v[88:91],a[124:127],a[68:71],v[88:91]
ds_read_b128 a[124:127],v1 offset:12288
v_fma_f32 v80,v80,s36,v14
v_mfma_f32_16x16x32_bf16 v[92:95],a[128:131],a[48:51],0
s_waitcnt lgkmcnt(5)
ds_read_b128 a[128:131],v0 offset:12416
v_fma_f32 v81,v81,s36,v14
v_mfma_f32_16x16x32_bf16 v[92:95],a[132:135],a[52:55],v[92:95]
ds_read_b128 a[132:135],v1 offset:12416
v_fma_f32 v82,v82,s36,v14
v_mfma_f32_16x16x32_bf16 v[92:95],a[136:139],a[56:59],v[92:95]
s_waitcnt lgkmcnt(5)
ds_read_b128 a[136:139],v0 offset:12544
v_fma_f32 v83,v83,s36,v14
v_mfma_f32_16x16x32_bf16 v[92:95],a[140:143],a[60:63],v[92:95]
ds_read_b128 a[140:143],v1 offset:12544
v_exp_f32 v80,v80
v_mfma_f32_16x16x32_bf16 v[92:95],a[144:147],a[64:67],v[92:95]
s_waitcnt lgkmcnt(5)
ds_read_b128 a[144:147],v0 offset:18432
v_exp_f32 v81,v81
v_mfma_f32_16x16x32_bf16 v[92:95],a[148:151],a[68:71],v[92:95]
ds_read_b128 a[148:151],v1 offset:18432
v_exp_f32 v82,v82
v_exp_f32 v83,v83
v_cvt_pk_bf16_f32 v24,v80,v81
v_cvt_pk_bf16_f32 v25,v82,v83
v_mfma_f32_16x16x32_bf16 v[80:83],a[120:123],a[24:27],0
s_waitcnt lgkmcnt(4)
ds_read_b128 a[120:123],v0 offset:18560
v_fma_f32 v84,v84,s36,v14
v_mfma_f32_16x16x32_bf16 v[80:83],a[124:127],a[28:31],v[80:83]
ds_read_b128 a[124:127],v1 offset:18560
v_fma_f32 v85,v85,s36,v14
v_mfma_f32_16x16x32_bf16 v[80:83],a[128:131],a[32:35],v[80:83]
ds_read_b128 a[128:131],v0 offset:18688
v_fma_f32 v86,v86,s36,v14
v_mfma_f32_16x16x32_bf16 v[80:83],a[132:135],a[36:39],v[80:83]
s_waitcnt lgkmcnt(4)
ds_read_b128 a[132:135],v1 offset:18688
v_fma_f32 v87,v87,s36,v14
v_mfma_f32_16x16x32_bf16 v[80:83],a[136:139],a[40:43],v[80:83]
ds_read_b128 a[136:139],v0 offset:0
v_exp_f32 v84,v84
v_mfma_f32_16x16x32_bf16 v[80:83],a[140:143],a[44:47],v[80:83]
ds_read_b128 a[140:143],v1 offset:0
v_exp_f32 v85,v85
v_exp_f32 v86,v86
v_exp_f32 v87,v87
v_cvt_pk_bf16_f32 v26,v84,v85
v_cvt_pk_bf16_f32 v27,v86,v87
v_mfma_f32_16x16x32_bf16 v[84:87],a[144:147],a[24:27],0
ds_read_b128 a[144:147],v0 offset:128
v_max3_f32 v52,v88,v89,v90
v_smfmac_f32_16x16x64_bf16 v[60:63],a[152:155],v[20:27],v18
s_waitcnt lgkmcnt(4)
v_max3_f32 v52,v52,v91,v92
v_mfma_f32_16x16x32_bf16 v[84:87],a[148:151],a[28:31],v[84:87]
ds_read_b128 a[148:151],v1 offset:128
v_max3_f32 v52,v52,v93,v94
v_mfma_f32_16x16x32_bf16 v[84:87],a[120:123],a[32:35],v[84:87]
ds_read_b128 a[120:123],v0 offset:256
v_max_f32 v52,v52,v95
v_mfma_f32_16x16x32_bf16 v[84:87],a[124:127],a[36:39],v[84:87]
ds_read_b128 a[124:127],v1 offset:256
v_mov_b32 v53,v52
v_mfma_f32_16x16x32_bf16 v[84:87],a[128:131],a[40:43],v[84:87]
s_waitcnt lgkmcnt(4)
ds_read_b128 a[128:131],v0 offset:6144
v_permlane32_swap_b32 v53,v52
v_mfma_f32_16x16x32_bf16 v[84:87],a[132:135],a[44:47],v[84:87]
s_waitcnt vmcnt(6)
ds_read_b128 a[72:75],v11 offset:0
buffer_load_dwordx4 v6,s[8:11],s21 offen offset:0 lds
ds_read_b128 a[76:79],v12 offset:0
buffer_load_dwordx4 v7,s[8:11],s21 offen offset:1024 lds
ds_read_b128 a[80:83],v11 offset:128
buffer_load_dwordx4 v8,s[8:11],s21 offen offset:2048 lds
s_add_u32 s21,s21,12288
s_add_u32 m0,s23,24576
ds_read_b128 a[84:87],v12 offset:128
buffer_load_dwordx4 v6,s[8:11],s21 offen offset:0 lds
ds_read_b128 a[88:91],v11 offset:256
buffer_load_dwordx4 v7,s[8:11],s21 offen offset:1024 lds
ds_read_b128 a[92:95],v12 offset:256
buffer_load_dwordx4 v8,s[8:11],s21 offen offset:2048 lds
s_add_u32 s21,s21,12288
ds_read_b128 a[132:135],v1 offset:6144
v_max_f32 v52,v52,v53
v_mov_b32 v53,v52
s_waitcnt lgkmcnt(6)
v_mfma_f32_16x16x32_bf16 v[96:99],a[136:139],a[72:75],0
s_mov_b32 s27,166723584
ds_read_b128 a[136:139],v0 offset:6272
v_permlane16_swap_b32 v53,v52
s_waitcnt lgkmcnt(6)
v_mfma_f32_16x16x32_bf16 v[96:99],a[140:143],a[76:79],v[96:99]
s_mov_b32 s42,s41
ds_read_b128 a[140:143],v1 offset:6272
v_max_f32 v52,v52,v53
s_waitcnt lgkmcnt(6)
v_mfma_f32_16x16x32_bf16 v[96:99],a[144:147],a[80:83],v[96:99]
s_add_u32 s69,s69,1
ds_read_b128 a[144:147],v0 offset:6400
v_mul_f32_e64 v15,-s36,v52
v_fma_f32 v88,v88,s36,v15
s_waitcnt lgkmcnt(6)
v_mfma_f32_16x16x32_bf16 v[96:99],a[148:151],a[84:87],v[96:99]
s_lshl_b32 s62,s69,5
ds_read_b128 a[148:151],v1 offset:6400
v_fma_f32 v89,v89,s36,v15
s_waitcnt lgkmcnt(5)
v_mfma_f32_16x16x32_bf16 v[96:99],a[120:123],a[88:91],v[96:99]
s_add_u32 s62,s62,s34
ds_read_b128 a[120:123],v0 offset:12288
v_fma_f32 v90,v90,s36,v15
v_mfma_f32_16x16x32_bf16 v[96:99],a[124:127],a[92:95],v[96:99]
s_mul_i32 s63,s62,171
ds_read_b128 a[124:127],v1 offset:12288
v_fma_f32 v91,v91,s36,v15
v_mfma_f32_16x16x32_bf16 v[100:103],a[128:131],a[72:75],0
s_lshr_b32 s63,s63,9
ds_read_b128 a[128:131],v0 offset:12416
v_exp_f32 v88,v88
s_waitcnt lgkmcnt(6)
v_mfma_f32_16x16x32_bf16 v[100:103],a[132:135],a[76:79],v[100:103]
s_mul_i32 s64,s63,3
ds_read_b128 a[132:135],v1 offset:12416
v_exp_f32 v89,v89
v_mfma_f32_16x16x32_bf16 v[100:103],a[136:139],a[80:83],v[100:103]
s_sub_u32 s62,s62,s64
ds_read_b128 a[136:139],v0 offset:12544
v_exp_f32 v90,v90
s_waitcnt lgkmcnt(6)
v_mfma_f32_16x16x32_bf16 v[100:103],a[140:143],a[84:87],v[100:103]
s_add_u32 s63,s63,s33
ds_read_b128 a[140:143],v1 offset:12544
v_exp_f32 v91,v91
v_mfma_f32_16x16x32_bf16 v[100:103],a[144:147],a[88:91],v[100:103]
s_mul_i32 s30,s63,196608
ds_read_b128 a[144:147],v0 offset:18432
v_cvt_pk_bf16_f32 v28,v88,v89
s_waitcnt lgkmcnt(6)
v_mfma_f32_16x16x32_bf16 v[100:103],a[148:151],a[92:95],v[100:103]
s_waitcnt vmcnt(9)
s_barrier
ds_read_b128 a[148:151],v1 offset:18432
v_cvt_pk_bf16_f32 v29,v90,v91
v_mfma_f32_16x16x32_bf16 v[88:91],a[120:123],a[48:51],0
s_mul_i32 s41,s63,325632
ds_read_b128 a[120:123],v0 offset:18560
v_fma_f32 v92,v92,s36,v15
s_waitcnt lgkmcnt(5)
v_mfma_f32_16x16x32_bf16 v[88:91],a[124:127],a[52:55],v[88:91]
s_lshl_b32 s63,s3,2
ds_read_b128 a[124:127],v1 offset:18560
v_fma_f32 v93,v93,s36,v15
v_mfma_f32_16x16x32_bf16 v[88:91],a[128:131],a[56:59],v[88:91]
s_add_u32 s64,s63,21
ds_read_b128 a[128:131],v0 offset:18688
v_fma_f32 v94,v94,s36,v15
v_mfma_f32_16x16x32_bf16 v[88:91],a[132:135],a[60:63],v[88:91]
s_cmp_eq_u32 s3,0
ds_read_b128 a[132:135],v1 offset:18688
v_fma_f32 v95,v95,s36,v15
s_waitcnt lgkmcnt(6)
v_mfma_f32_16x16x32_bf16 v[88:91],a[136:139],a[64:67],v[88:91]
s_cselect_b32 s64,20,s64
ds_read_b128 a[136:139],v0 offset:12288
v_exp_f32 v92,v92
v_mfma_f32_16x16x32_bf16 v[88:91],a[140:143],a[68:71],v[88:91]
s_cselect_b32 s40,1,0
ds_read_b128 a[140:143],v1 offset:12288
v_exp_f32 v93,v93
v_exp_f32 v94,v94
v_exp_f32 v95,v95
v_cvt_pk_bf16_f32 v30,v92,v93
v_cvt_pk_bf16_f32 v31,v94,v95
s_waitcnt lgkmcnt(5)
v_mfma_f32_16x16x32_bf16 v[92:95],a[144:147],a[48:51],0
s_add_u32 s65,s63,37
ds_read_b128 a[144:147],v0 offset:12416
v_max3_f32 v56,v96,v97,v98
v_mfma_f32_16x16x32_bf16 v[92:95],a[148:151],a[52:55],v[92:95]
s_cmp_eq_u32 s62,2
ds_read_b128 a[148:151],v1 offset:12416
v_max3_f32 v56,v56,v99,v100
v_mfma_f32_16x16x32_bf16 v[92:95],a[120:123],a[56:59],v[92:95]
s_cselect_b32 s64,s65,s64
ds_read_b128 a[120:123],v0 offset:12544
v_max3_f32 v56,v56,v101,v102
s_waitcnt lgkmcnt(5)
v_mfma_f32_16x16x32_bf16 v[92:95],a[124:127],a[60:63],v[92:95]
s_cselect_b32 s40,0,s40
ds_read_b128 a[124:127],v1 offset:12544
v_max_f32 v56,v56,v103
v_mfma_f32_16x16x32_bf16 v[92:95],a[128:131],a[64:67],v[92:95]
s_add_u32 s65,s63,s3
ds_read_b128 a[128:131],v0 offset:18432
v_mov_b32 v57,v56
v_mfma_f32_16x16x32_bf16 v[92:95],a[132:135],a[68:71],v[92:95]
s_cmp_eq_u32 s62,0
ds_read_b128 a[132:135],v1 offset:18432
v_permlane32_swap_b32 v57,v56
v_max_f32 v56,v56,v57
v_mov_b32 v57,v56
v_fma_f32 v72,v72,s36,v13
v_fma_f32 v73,v73,s36,v13
v_permlane16_swap_b32 v57,v56
v_max_f32 v56,v56,v57
v_mul_f32_e64 v16,-s36,v56
v_fma_f32 v96,v96,s36,v16
v_fma_f32 v97,v97,s36,v16
v_fma_f32 v98,v98,s36,v16
v_fma_f32 v99,v99,s36,v16
v_exp_f32 v96,v96
v_exp_f32 v97,v97
v_exp_f32 v98,v98
v_exp_f32 v99,v99
v_cvt_pk_bf16_f32 v32,v96,v97
v_cvt_pk_bf16_f32 v33,v98,v99
s_waitcnt lgkmcnt(2)
v_mfma_f32_16x16x32_bf16 v[96:99],a[136:139],a[72:75],0
s_cselect_b32 s64,s65,s64
ds_read_b128 a[136:139],v0 offset:18560
v_fma_f32 v100,v100,s36,v16
v_mfma_f32_16x16x32_bf16 v[96:99],a[140:143],a[76:79],v[96:99]
s_cselect_b32 s40,1,s40
ds_read_b128 a[140:143],v1 offset:18560
v_fma_f32 v101,v101,s36,v16
v_mfma_f32_16x16x32_bf16 v[96:99],a[144:147],a[80:83],v[96:99]
s_mul_i32 s64,s64,6144
ds_read_b128 a[144:147],v0 offset:18688
v_fma_f32 v102,v102,s36,v16
v_mfma_f32_16x16x32_bf16 v[96:99],a[148:151],a[84:87],v[96:99]
s_add_u32 s41,s41,s64
ds_read_b128 a[148:151],v1 offset:18688
v_fma_f32 v103,v103,s36,v16
v_mfma_f32_16x16x32_bf16 v[96:99],a[120:123],a[88:91],v[96:99]
s_cmp_ge_u32 s69,6
ds_read_b64_tr_b16 a[120:121],v2 offset:0
v_exp_f32 v100,v100
v_mfma_f32_16x16x32_bf16 v[96:99],a[124:127],a[92:95],v[96:99]
s_cselect_b32 s41,166723584,s41
ds_read_b64_tr_b16 a[122:123],v2 offset:6144
ds_read_b64_tr_b16 a[124:125],v3 offset:0
ds_read_b64_tr_b16 a[126:127],v3 offset:6144
v_exp_f32 v101,v101
v_exp_f32 v102,v102
v_exp_f32 v103,v103
v_cvt_pk_bf16_f32 v34,v100,v101
v_cvt_pk_bf16_f32 v35,v102,v103
s_waitcnt lgkmcnt(7)
v_mfma_f32_16x16x32_bf16 v[100:103],a[128:131],a[72:75],0
s_cselect_b32 s30,100663296,s30
ds_read_b64_tr_b16 a[128:129],v4 offset:0
v_fma_f32 v74,v74,s36,v13
v_smfmac_f32_16x16x64_bf16 v[64:67],a[152:155],v[28:35],v18
s_add_u32 s25,s30,s22
s_add_u32 s26,s25,12288
ds_read_b64_tr_b16 a[130:131],v4 offset:6144
v_mfma_f32_16x16x32_bf16 v[100:103],a[132:135],a[76:79],v[100:103]
s_mov_b32 s28,s41
ds_read_b64_tr_b16 a[132:133],v5 offset:0
v_fma_f32 v75,v75,s36,v13
v_mfma_f32_16x16x32_bf16 v[100:103],a[136:139],a[80:83],v[100:103]
s_mov_b32 s29,s24
ds_read_b64_tr_b16 a[134:135],v5 offset:6144
v_fma_f32 v80,v80,s36,v14
s_waitcnt lgkmcnt(7)
v_mfma_f32_16x16x32_bf16 v[100:103],a[140:143],a[84:87],v[100:103]
s_add_u32 m0,s22,0
v_fma_f32 v81,v81,s36,v14
v_exp_f32 v72,v72
v_mfma_f32_16x16x32_bf16 v[100:103],a[144:147],a[88:91],v[100:103]
buffer_load_dwordx4 v6,s[4:7],s20 offen offset:0 lds
v_mfma_f32_16x16x32_bf16 v[100:103],a[148:151],a[92:95],v[100:103]
buffer_load_dwordx4 v7,s[4:7],s20 offen offset:1024 lds
buffer_load_dwordx4 v8,s[4:7],s20 offen offset:2048 lds
v_exp_f32 v73,v73
v_exp_f32 v74,v74
v_exp_f32 v75,v75
v_exp_f32 v80,v80
v_exp_f32 v81,v81
v_cvt_pk_bf16_f32 v44,v72,v73
v_cvt_pk_bf16_f32 v45,v74,v75
v_cvt_pk_bf16_f32 v48,v80,v81
s_add_u32 s20,s20,12288
s_waitcnt lgkmcnt(0)
v_mfma_f32_16x16x32_bf16 v[160:163],a[120:123],v[20:23],0
s_add_u32 m0,s23,0
ds_read_b64_tr_b16 a[136:137],v2 offset:128
v_fma_f32 v82,v82,s36,v14
v_mfma_f32_16x16x32_bf16 v[164:167],a[124:127],v[20:23],0
ds_read_b64_tr_b16 a[138:139],v2 offset:6272
v_fma_f32 v83,v83,s36,v14
v_mfma_f32_16x16x32_bf16 v[212:215],a[124:127],v[24:27],0
ds_read_b64_tr_b16 a[140:141],v3 offset:128
v_fma_f32 v88,v88,s36,v15
v_mfma_f32_16x16x32_bf16 v[208:211],a[120:123],v[24:27],0
ds_read_b64_tr_b16 a[142:143],v3 offset:6272
v_fma_f32 v89,v89,s36,v15
v_mfma_f32_16x16x32_bf16 v[112:115],a[120:123],v[28:31],0
ds_read_b64_tr_b16 a[144:145],v4 offset:128
v_fma_f32 v90,v90,s36,v15
v_mfma_f32_16x16x32_bf16 v[116:119],a[124:127],v[28:31],0
ds_read_b64_tr_b16 a[146:147],v4 offset:6272
v_fma_f32 v91,v91,s36,v15
v_mfma_f32_16x16x32_bf16 a[164:167],a[124:127],v[32:35],0
ds_read_b64_tr_b16 a[148:149],v5 offset:128
v_fma_f32 v96,v96,s36,v16
v_mfma_f32_16x16x32_bf16 a[160:163],a[120:123],v[32:35],0
ds_read_b64_tr_b16 a[150:151],v5 offset:6272
v_fma_f32 v97,v97,s36,v16
v_mfma_f32_16x16x32_bf16 a[168:171],a[128:131],v[32:35],0
ds_read_b64_tr_b16 a[120:121],v2 offset:256
v_fma_f32 v98,v98,s36,v16
v_mfma_f32_16x16x32_bf16 a[172:175],a[132:135],v[32:35],0
ds_read_b64_tr_b16 a[122:123],v2 offset:6400
v_fma_f32 v99,v99,s36,v16
v_mfma_f32_16x16x32_bf16 v[124:127],a[132:135],v[28:31],0
ds_read_b64_tr_b16 a[124:125],v3 offset:256
v_fma_f32 v76,v76,s36,v13
v_mfma_f32_16x16x32_bf16 v[120:123],a[128:131],v[28:31],0
ds_read_b64_tr_b16 a[126:127],v3 offset:6400
v_fma_f32 v77,v77,s36,v13
v_mfma_f32_16x16x32_bf16 v[216:219],a[128:131],v[24:27],0
v_exp_f32 v82,v82
v_mfma_f32_16x16x32_bf16 v[220:223],a[132:135],v[24:27],0
v_exp_f32 v83,v83
v_mfma_f32_16x16x32_bf16 v[172:175],a[132:135],v[20:23],0
ds_read_b64_tr_b16 a[132:133],v5 offset:256
v_cvt_pk_bf16_f32 v49,v82,v83
v_mfma_f32_16x16x32_bf16 v[168:171],a[128:131],v[20:23],0
s_waitcnt lgkmcnt(4)
ds_read_b64_tr_b16 a[128:129],v4 offset:256
v_fma_f32 v78,v78,s36,v13
v_mfma_f32_16x16x32_bf16 v[176:179],a[136:139],v[20:23],0
ds_read_b64_tr_b16 a[130:131],v4 offset:6400
v_fma_f32 v79,v79,s36,v13
v_mfma_f32_16x16x32_bf16 v[180:183],a[140:143],v[20:23],0
ds_read_b64_tr_b16 a[134:135],v5 offset:6400
v_fma_f32 v84,v84,s36,v14
v_mfma_f32_16x16x32_bf16 v[228:231],a[140:143],v[24:27],0
v_exp_f32 v88,v88
v_mfma_f32_16x16x32_bf16 v[224:227],a[136:139],v[24:27],0
v_exp_f32 v89,v89
v_mfma_f32_16x16x32_bf16 v[128:131],a[136:139],v[28:31],0
v_exp_f32 v90,v90
v_mfma_f32_16x16x32_bf16 v[132:135],a[140:143],v[28:31],0
v_exp_f32 v91,v91
v_mfma_f32_16x16x32_bf16 a[180:183],a[140:143],v[32:35],0
v_cvt_pk_bf16_f32 v52,v88,v89
v_cvt_pk_bf16_f32 v53,v90,v91
v_mfma_f32_16x16x32_bf16 a[176:179],a[136:139],v[32:35],0
v_exp_f32 v96,v96
v_mfma_f32_16x16x32_bf16 a[184:187],a[144:147],v[32:35],0
v_exp_f32 v97,v97
v_mfma_f32_16x16x32_bf16 a[188:191],a[148:151],v[32:35],0
v_exp_f32 v98,v98
v_mfma_f32_16x16x32_bf16 v[140:143],a[148:151],v[28:31],0
v_exp_f32 v99,v99
v_mfma_f32_16x16x32_bf16 v[136:139],a[144:147],v[28:31],0
v_cvt_pk_bf16_f32 v56,v96,v97
v_cvt_pk_bf16_f32 v57,v98,v99
v_mfma_f32_16x16x32_bf16 v[232:235],a[144:147],v[24:27],0
v_exp_f32 v76,v76
v_mfma_f32_16x16x32_bf16 v[236:239],a[148:151],v[24:27],0
v_exp_f32 v77,v77
v_mfma_f32_16x16x32_bf16 v[188:191],a[148:151],v[20:23],0
v_exp_f32 v78,v78
v_mfma_f32_16x16x32_bf16 v[184:187],a[144:147],v[20:23],0
s_waitcnt lgkmcnt(0)
v_exp_f32 v79,v79
v_mfma_f32_16x16x32_bf16 v[192:195],a[120:123],v[20:23],0
v_cvt_pk_bf16_f32 v46,v76,v77
v_cvt_pk_bf16_f32 v47,v78,v79
v_mfma_f32_16x16x32_bf16 v[196:199],a[124:127],v[20:23],0
s_waitcnt vmcnt(6)
v_fma_f32 v85,v85,s36,v14
v_fma_f32 v86,v86,s36,v14
v_mfma_f32_16x16x32_bf16 v[244:247],a[124:127],v[24:27],0
s_barrier
v_mfma_f32_16x16x32_bf16 v[240:243],a[120:123],v[24:27],0
ds_read_b128 a[148:151],v1 offset:24704
v_fma_f32 v87,v87,s36,v14
v_mfma_f32_16x16x32_bf16 v[144:147],a[120:123],v[28:31],0
ds_read_b128 a[144:147],v0 offset:24704
v_fma_f32 v92,v92,s36,v15
v_mfma_f32_16x16x32_bf16 v[148:151],a[124:127],v[28:31],0
ds_read_b128 a[140:143],v1 offset:24576
v_fma_f32 v93,v93,s36,v15
v_mfma_f32_16x16x32_bf16 a[196:199],a[124:127],v[32:35],0
ds_read_b128 a[124:127],v1 offset:24832
v_fma_f32 v94,v94,s36,v15
v_mfma_f32_16x16x32_bf16 a[192:195],a[120:123],v[32:35],0
ds_read_b128 a[120:123],v0 offset:24832
v_fma_f32 v95,v95,s36,v15
v_mfma_f32_16x16x32_bf16 a[200:203],a[128:131],v[32:35],0
buffer_load_dwordx4 v6,s[8:11],s21 offen offset:0 lds
v_mfma_f32_16x16x32_bf16 a[204:207],a[132:135],v[32:35],0
ds_read_b128 a[136:139],v0 offset:24576
v_fma_f32 v100,v100,s36,v16
v_mfma_f32_16x16x32_bf16 v[156:159],a[132:135],v[28:31],0
v_exp_f32 v84,v84
v_mfma_f32_16x16x32_bf16 v[152:155],a[128:131],v[28:31],0
v_exp_f32 v85,v85
v_mfma_f32_16x16x32_bf16 v[248:251],a[128:131],v[24:27],0
v_exp_f32 v86,v86
v_mfma_f32_16x16x32_bf16 v[252:255],a[132:135],v[24:27],0
v_exp_f32 v87,v87
v_mfma_f32_16x16x32_bf16 v[204:207],a[132:135],v[20:23],0
ds_read_b128 a[132:135],v1 offset:30720
v_cvt_pk_bf16_f32 v50,v84,v85
v_mfma_f32_16x16x32_bf16 v[200:203],a[128:131],v[20:23],0
s_waitcnt lgkmcnt(2)
ds_read_b128 a[128:131],v0 offset:30720
v_cvt_pk_bf16_f32 v51,v86,v87
v_mfma_f32_16x16x32_bf16 v[72:75],a[124:127],a[20:23],0
v_exp_f32 v92,v92
v_smfmac_f32_16x16x64_bf16 v[60:63],a[152:155],v[44:51],v18
buffer_load_dwordx4 v7,s[8:11],s21 offen offset:1024 lds
v_mfma_f32_16x16x32_bf16 v[72:75],a[120:123],a[16:19],v[72:75]
v_exp_f32 v93,v93
v_mfma_f32_16x16x32_bf16 v[72:75],a[148:151],a[12:15],v[72:75]
v_exp_f32 v94,v94
v_mfma_f32_16x16x32_bf16 v[72:75],a[144:147],a[8:11],v[72:75]
v_exp_f32 v95,v95
v_mfma_f32_16x16x32_bf16 v[72:75],a[140:143],a[4:7],v[72:75]
s_waitcnt lgkmcnt(1)
v_cvt_pk_bf16_f32 v54,v92,v93
v_cvt_pk_bf16_f32 v55,v94,v95
v_mfma_f32_16x16x32_bf16 v[72:75],a[136:139],a[0:3],v[72:75]
v_fma_f32 v101,v101,s36,v16
v_fma_f32 v102,v102,s36,v16
v_mfma_f32_16x16x32_bf16 v[80:83],a[136:139],a[24:27],0
v_fma_f32 v103,v103,s36,v16
v_mfma_f32_16x16x32_bf16 v[80:83],a[140:143],a[28:31],v[80:83]
v_exp_f32 v100,v100
v_mfma_f32_16x16x32_bf16 v[80:83],a[144:147],a[32:35],v[80:83]
buffer_load_dwordx4 v8,s[8:11],s21 offen offset:2048 lds
v_mfma_f32_16x16x32_bf16 v[80:83],a[148:151],a[36:39],v[80:83]
s_add_u32 s21,s21,12288
v_exp_f32 v101,v101
v_mfma_f32_16x16x32_bf16 v[80:83],a[120:123],a[40:43],v[80:83]
s_add_u32 m0,s22,12288
v_exp_f32 v102,v102
v_mfma_f32_16x16x32_bf16 v[80:83],a[124:127],a[44:47],v[80:83]
v_exp_f32 v103,v103
v_mfma_f32_16x16x32_bf16 v[88:91],a[124:127],a[68:71],0
v_cvt_pk_bf16_f32 v58,v100,v101
v_cvt_pk_bf16_f32 v59,v102,v103
v_mfma_f32_16x16x32_bf16 v[88:91],a[120:123],a[64:67],v[88:91]
v_fma_f32 v72,v72,s36,v13
v_fma_f32 v73,v73,s36,v13
v_smfmac_f32_16x16x64_bf16 v[64:67],a[152:155],v[52:59],v18
v_fma_f32 v74,v74,s36,v13
v_mfma_f32_16x16x32_bf16 v[88:91],a[148:151],a[60:63],v[88:91]
v_fma_f32 v75,v75,s36,v13
v_fma_f32 v80,v80,s36,v14
v_mfma_f32_16x16x32_bf16 v[88:91],a[144:147],a[56:59],v[88:91]
v_fma_f32 v81,v81,s36,v14
v_mfma_f32_16x16x32_bf16 v[88:91],a[140:143],a[52:55],v[88:91]
buffer_load_dwordx4 v6,s[4:7],s20 offen offset:0 lds
v_mfma_f32_16x16x32_bf16 v[88:91],a[136:139],a[48:51],v[88:91]
v_exp_f32 v72,v72
v_mfma_f32_16x16x32_bf16 v[96:99],a[136:139],a[72:75],0
ds_read_b128 a[136:139],v0 offset:30848
v_mfma_f32_16x16x32_bf16 v[96:99],a[140:143],a[76:79],v[96:99]
ds_read_b128 a[140:143],v1 offset:30848
v_mfma_f32_16x16x32_bf16 v[96:99],a[144:147],a[80:83],v[96:99]
ds_read_b128 a[144:147],v0 offset:30976
v_mfma_f32_16x16x32_bf16 v[96:99],a[148:151],a[84:87],v[96:99]
ds_read_b128 a[148:151],v1 offset:30976
v_mfma_f32_16x16x32_bf16 v[96:99],a[120:123],a[88:91],v[96:99]
v_exp_f32 v73,v73
v_mfma_f32_16x16x32_bf16 v[96:99],a[124:127],a[92:95],v[96:99]
s_waitcnt lgkmcnt(4)
v_exp_f32 v74,v74
v_mfma_f32_16x16x32_bf16 v[76:79],a[128:131],a[0:3],0
v_exp_f32 v75,v75
v_mfma_f32_16x16x32_bf16 v[76:79],a[132:135],a[4:7],v[76:79]
buffer_load_dwordx4 v7,s[4:7],s20 offen offset:1024 lds
s_waitcnt lgkmcnt(3)
v_mfma_f32_16x16x32_bf16 v[76:79],a[136:139],a[8:11],v[76:79]
s_waitcnt lgkmcnt(2)
v_exp_f32 v80,v80
v_mfma_f32_16x16x32_bf16 v[76:79],a[140:143],a[12:15],v[76:79]
s_waitcnt lgkmcnt(0)
v_exp_f32 v81,v81
v_mfma_f32_16x16x32_bf16 v[76:79],a[144:147],a[16:19],v[76:79]
v_cvt_pk_bf16_f32 v20,v72,v73
v_cvt_pk_bf16_f32 v21,v74,v75
v_mfma_f32_16x16x32_bf16 v[76:79],a[148:151],a[20:23],v[76:79]
v_cvt_pk_bf16_f32 v24,v80,v81
v_mfma_f32_16x16x32_bf16 v[84:87],a[148:151],a[44:47],0
v_mfma_f32_16x16x32_bf16 v[84:87],a[144:147],a[40:43],v[84:87]
v_mfma_f32_16x16x32_bf16 v[84:87],a[140:143],a[36:39],v[84:87]
v_mfma_f32_16x16x32_bf16 v[84:87],a[136:139],a[32:35],v[84:87]
v_mfma_f32_16x16x32_bf16 v[84:87],a[132:135],a[28:31],v[84:87]
buffer_load_dwordx4 v8,s[4:7],s20 offen offset:2048 lds
v_mfma_f32_16x16x32_bf16 v[84:87],a[128:131],a[24:27],v[84:87]
s_add_u32 s20,s20,12288
v_mfma_f32_16x16x32_bf16 v[92:95],a[128:131],a[48:51],0
ds_read_b64_tr_b16 a[120:121],v2 offset:12288
v_mfma_f32_16x16x32_bf16 v[92:95],a[132:135],a[52:55],v[92:95]
ds_read_b64_tr_b16 a[122:123],v2 offset:18432
v_mfma_f32_16x16x32_bf16 v[92:95],a[136:139],a[56:59],v[92:95]
ds_read_b64_tr_b16 a[124:125],v3 offset:12288
v_mfma_f32_16x16x32_bf16 v[92:95],a[140:143],a[60:63],v[92:95]
ds_read_b64_tr_b16 a[126:127],v3 offset:18432
v_mfma_f32_16x16x32_bf16 v[92:95],a[144:147],a[64:67],v[92:95]
v_mfma_f32_16x16x32_bf16 v[92:95],a[148:151],a[68:71],v[92:95]
v_mfma_f32_16x16x32_bf16 v[100:103],a[148:151],a[92:95],0
v_mfma_f32_16x16x32_bf16 v[100:103],a[144:147],a[88:91],v[100:103]
v_mfma_f32_16x16x32_bf16 v[100:103],a[140:143],a[84:87],v[100:103]
v_mfma_f32_16x16x32_bf16 v[100:103],a[136:139],a[80:83],v[100:103]
v_mfma_f32_16x16x32_bf16 v[100:103],a[132:135],a[76:79],v[100:103]
ds_read_b64_tr_b16 a[132:133],v5 offset:12288
v_mfma_f32_16x16x32_bf16 v[100:103],a[128:131],a[72:75],v[100:103]
s_waitcnt lgkmcnt(1)
ds_read_b64_tr_b16 a[128:129],v4 offset:12288
ds_read_b64_tr_b16 a[130:131],v4 offset:18432
ds_read_b64_tr_b16 a[134:135],v5 offset:18432
v_mfma_f32_16x16x32_bf16 v[160:163],a[120:123],v[44:47],v[160:163]
s_add_u32 m0,s23,12288
ds_read_b64_tr_b16 a[136:137],v2 offset:12416
v_fma_f32 v82,v82,s36,v14
v_mfma_f32_16x16x32_bf16 v[164:167],a[124:127],v[44:47],v[164:167]
ds_read_b64_tr_b16 a[138:139],v2 offset:18560
v_fma_f32 v83,v83,s36,v14
v_mfma_f32_16x16x32_bf16 v[212:215],a[124:127],v[48:51],v[212:215]
ds_read_b64_tr_b16 a[140:141],v3 offset:12416
v_fma_f32 v88,v88,s36,v15
v_mfma_f32_16x16x32_bf16 v[208:211],a[120:123],v[48:51],v[208:211]
ds_read_b64_tr_b16 a[142:143],v3 offset:18560
v_fma_f32 v89,v89,s36,v15
v_mfma_f32_16x16x32_bf16 v[112:115],a[120:123],v[52:55],v[112:115]
ds_read_b64_tr_b16 a[144:145],v4 offset:12416
v_fma_f32 v90,v90,s36,v15
v_mfma_f32_16x16x32_bf16 v[116:119],a[124:127],v[52:55],v[116:119]
ds_read_b64_tr_b16 a[146:147],v4 offset:18560
v_fma_f32 v91,v91,s36,v15
v_mfma_f32_16x16x32_bf16 a[164:167],a[124:127],v[56:59],a[164:167]
ds_read_b64_tr_b16 a[148:149],v5 offset:12416
v_fma_f32 v96,v96,s36,v16
v_mfma_f32_16x16x32_bf16 a[160:163],a[120:123],v[56:59],a[160:163]
s_waitcnt lgkmcnt(6)
ds_read_b64_tr_b16 a[150:151],v5 offset:18560
v_fma_f32 v97,v97,s36,v16
v_mfma_f32_16x16x32_bf16 a[168:171],a[128:131],v[56:59],a[168:171]
ds_read_b64_tr_b16 a[120:121],v2 offset:12544
v_fma_f32 v98,v98,s36,v16
v_mfma_f32_16x16x32_bf16 a[172:175],a[132:135],v[56:59],a[172:175]
ds_read_b64_tr_b16 a[122:123],v2 offset:18688
v_fma_f32 v99,v99,s36,v16
v_mfma_f32_16x16x32_bf16 v[124:127],a[132:135],v[52:55],v[124:127]
ds_read_b64_tr_b16 a[124:125],v3 offset:12544
v_fma_f32 v76,v76,s36,v13
v_mfma_f32_16x16x32_bf16 v[120:123],a[128:131],v[52:55],v[120:123]
ds_read_b64_tr_b16 a[126:127],v3 offset:18688
v_fma_f32 v77,v77,s36,v13
v_mfma_f32_16x16x32_bf16 v[216:219],a[128:131],v[48:51],v[216:219]
v_exp_f32 v82,v82
v_mfma_f32_16x16x32_bf16 v[220:223],a[132:135],v[48:51],v[220:223]
v_exp_f32 v83,v83
v_mfma_f32_16x16x32_bf16 v[172:175],a[132:135],v[44:47],v[172:175]
ds_read_b64_tr_b16 a[132:133],v5 offset:12544
v_cvt_pk_bf16_f32 v25,v82,v83
v_mfma_f32_16x16x32_bf16 v[168:171],a[128:131],v[44:47],v[168:171]
s_waitcnt lgkmcnt(4)
ds_read_b64_tr_b16 a[128:129],v4 offset:12544
v_fma_f32 v78,v78,s36,v13
v_mfma_f32_16x16x32_bf16 v[176:179],a[136:139],v[44:47],v[176:179]
ds_read_b64_tr_b16 a[130:131],v4 offset:18688
v_fma_f32 v79,v79,s36,v13
v_mfma_f32_16x16x32_bf16 v[180:183],a[140:143],v[44:47],v[180:183]
ds_read_b64_tr_b16 a[134:135],v5 offset:18688
v_fma_f32 v84,v84,s36,v14
v_mfma_f32_16x16x32_bf16 v[228:231],a[140:143],v[48:51],v[228:231]
v_exp_f32 v88,v88
v_mfma_f32_16x16x32_bf16 v[224:227],a[136:139],v[48:51],v[224:227]
v_exp_f32 v89,v89
v_mfma_f32_16x16x32_bf16 v[128:131],a[136:139],v[52:55],v[128:131]
v_exp_f32 v90,v90
v_mfma_f32_16x16x32_bf16 v[132:135],a[140:143],v[52:55],v[132:135]
v_exp_f32 v91,v91
v_mfma_f32_16x16x32_bf16 a[180:183],a[140:143],v[56:59],a[180:183]
v_cvt_pk_bf16_f32 v28,v88,v89
v_cvt_pk_bf16_f32 v29,v90,v91
v_mfma_f32_16x16x32_bf16 a[176:179],a[136:139],v[56:59],a[176:179]
v_exp_f32 v96,v96
v_mfma_f32_16x16x32_bf16 a[184:187],a[144:147],v[56:59],a[184:187]
v_exp_f32 v97,v97
v_mfma_f32_16x16x32_bf16 a[188:191],a[148:151],v[56:59],a[188:191]
v_exp_f32 v98,v98
v_mfma_f32_16x16x32_bf16 v[140:143],a[148:151],v[52:55],v[140:143]
v_exp_f32 v99,v99
v_mfma_f32_16x16x32_bf16 v[136:139],a[144:147],v[52:55],v[136:139]
v_cvt_pk_bf16_f32 v32,v96,v97
v_cvt_pk_bf16_f32 v33,v98,v99
v_mfma_f32_16x16x32_bf16 v[232:235],a[144:147],v[48:51],v[232:235]
v_exp_f32 v76,v76
v_mfma_f32_16x16x32_bf16 v[236:239],a[148:151],v[48:51],v[236:239]
v_exp_f32 v77,v77
v_mfma_f32_16x16x32_bf16 v[188:191],a[148:151],v[44:47],v[188:191]
v_exp_f32 v78,v78
v_mfma_f32_16x16x32_bf16 v[184:187],a[144:147],v[44:47],v[184:187]
s_waitcnt lgkmcnt(0)
v_exp_f32 v79,v79
v_mfma_f32_16x16x32_bf16 v[192:195],a[120:123],v[44:47],v[192:195]
v_cvt_pk_bf16_f32 v22,v76,v77
v_cvt_pk_bf16_f32 v23,v78,v79
v_mfma_f32_16x16x32_bf16 v[196:199],a[124:127],v[44:47],v[196:199]
s_waitcnt vmcnt(6)
v_fma_f32 v85,v85,s36,v14
v_fma_f32 v86,v86,s36,v14
v_mfma_f32_16x16x32_bf16 v[244:247],a[124:127],v[48:51],v[244:247]
s_barrier
v_mfma_f32_16x16x32_bf16 v[240:243],a[120:123],v[48:51],v[240:243]
ds_read_b128 a[148:151],v1 offset:128
v_fma_f32 v87,v87,s36,v14
v_mfma_f32_16x16x32_bf16 v[144:147],a[120:123],v[52:55],v[144:147]
ds_read_b128 a[144:147],v0 offset:128
v_fma_f32 v92,v92,s36,v15
v_mfma_f32_16x16x32_bf16 v[148:151],a[124:127],v[52:55],v[148:151]
ds_read_b128 a[140:143],v1 offset:0
v_fma_f32 v93,v93,s36,v15
v_mfma_f32_16x16x32_bf16 a[196:199],a[124:127],v[56:59],a[196:199]
ds_read_b128 a[124:127],v1 offset:256
v_fma_f32 v94,v94,s36,v15
v_mfma_f32_16x16x32_bf16 a[192:195],a[120:123],v[56:59],a[192:195]
ds_read_b128 a[120:123],v0 offset:256
v_fma_f32 v95,v95,s36,v15
v_mfma_f32_16x16x32_bf16 a[200:203],a[128:131],v[56:59],a[200:203]
buffer_load_dwordx4 v6,s[8:11],s21 offen offset:0 lds
v_mfma_f32_16x16x32_bf16 a[204:207],a[132:135],v[56:59],a[204:207]
ds_read_b128 a[136:139],v0 offset:0
v_fma_f32 v100,v100,s36,v16
v_mfma_f32_16x16x32_bf16 v[156:159],a[132:135],v[52:55],v[156:159]
v_exp_f32 v84,v84
v_mfma_f32_16x16x32_bf16 v[152:155],a[128:131],v[52:55],v[152:155]
v_exp_f32 v85,v85
v_mfma_f32_16x16x32_bf16 v[248:251],a[128:131],v[48:51],v[248:251]
v_exp_f32 v86,v86
v_mfma_f32_16x16x32_bf16 v[252:255],a[132:135],v[48:51],v[252:255]
v_exp_f32 v87,v87
v_mfma_f32_16x16x32_bf16 v[204:207],a[132:135],v[44:47],v[204:207]
ds_read_b128 a[132:135],v1 offset:6144
v_cvt_pk_bf16_f32 v26,v84,v85
v_mfma_f32_16x16x32_bf16 v[200:203],a[128:131],v[44:47],v[200:203]
s_waitcnt lgkmcnt(2)
ds_read_b128 a[128:131],v0 offset:6144
v_cvt_pk_bf16_f32 v27,v86,v87
v_mfma_f32_16x16x32_bf16 v[72:75],a[124:127],a[20:23],0
v_exp_f32 v92,v92
v_smfmac_f32_16x16x64_bf16 v[60:63],a[152:155],v[20:27],v18
buffer_load_dwordx4 v7,s[8:11],s21 offen offset:1024 lds
v_mfma_f32_16x16x32_bf16 v[72:75],a[120:123],a[16:19],v[72:75]
v_exp_f32 v93,v93
v_mfma_f32_16x16x32_bf16 v[72:75],a[148:151],a[12:15],v[72:75]
v_exp_f32 v94,v94
v_mfma_f32_16x16x32_bf16 v[72:75],a[144:147],a[8:11],v[72:75]
v_exp_f32 v95,v95
v_mfma_f32_16x16x32_bf16 v[72:75],a[140:143],a[4:7],v[72:75]
s_waitcnt lgkmcnt(1)
v_cvt_pk_bf16_f32 v30,v92,v93
v_cvt_pk_bf16_f32 v31,v94,v95
v_mfma_f32_16x16x32_bf16 v[72:75],a[136:139],a[0:3],v[72:75]
v_fma_f32 v101,v101,s36,v16
v_fma_f32 v102,v102,s36,v16
v_mfma_f32_16x16x32_bf16 v[80:83],a[136:139],a[24:27],0
v_fma_f32 v103,v103,s36,v16
v_mfma_f32_16x16x32_bf16 v[80:83],a[140:143],a[28:31],v[80:83]
v_exp_f32 v100,v100
v_mfma_f32_16x16x32_bf16 v[80:83],a[144:147],a[32:35],v[80:83]
buffer_load_dwordx4 v8,s[8:11],s21 offen offset:2048 lds
v_mfma_f32_16x16x32_bf16 v[80:83],a[148:151],a[36:39],v[80:83]
s_add_u32 s21,s21,12288
v_exp_f32 v101,v101
v_mfma_f32_16x16x32_bf16 v[80:83],a[120:123],a[40:43],v[80:83]
s_add_u32 m0,s22,24576
v_exp_f32 v102,v102
v_mfma_f32_16x16x32_bf16 v[80:83],a[124:127],a[44:47],v[80:83]
v_exp_f32 v103,v103
v_mfma_f32_16x16x32_bf16 v[88:91],a[124:127],a[68:71],0
v_cvt_pk_bf16_f32 v34,v100,v101
v_cvt_pk_bf16_f32 v35,v102,v103
v_mfma_f32_16x16x32_bf16 v[88:91],a[120:123],a[64:67],v[88:91]
v_fma_f32 v72,v72,s36,v13
v_fma_f32 v73,v73,s36,v13
v_smfmac_f32_16x16x64_bf16 v[64:67],a[152:155],v[28:35],v18
v_fma_f32 v74,v74,s36,v13
v_mfma_f32_16x16x32_bf16 v[88:91],a[148:151],a[60:63],v[88:91]
v_fma_f32 v75,v75,s36,v13
v_fma_f32 v80,v80,s36,v14
v_mfma_f32_16x16x32_bf16 v[88:91],a[144:147],a[56:59],v[88:91]
v_fma_f32 v81,v81,s36,v14
v_mfma_f32_16x16x32_bf16 v[88:91],a[140:143],a[52:55],v[88:91]
buffer_load_dwordx4 v6,s[4:7],s20 offen offset:0 lds
v_mfma_f32_16x16x32_bf16 v[88:91],a[136:139],a[48:51],v[88:91]
v_exp_f32 v72,v72
v_mfma_f32_16x16x32_bf16 v[96:99],a[136:139],a[72:75],0
ds_read_b128 a[136:139],v0 offset:6272
v_mfma_f32_16x16x32_bf16 v[96:99],a[140:143],a[76:79],v[96:99]
ds_read_b128 a[140:143],v1 offset:6272
v_mfma_f32_16x16x32_bf16 v[96:99],a[144:147],a[80:83],v[96:99]
ds_read_b128 a[144:147],v0 offset:6400
v_mfma_f32_16x16x32_bf16 v[96:99],a[148:151],a[84:87],v[96:99]
ds_read_b128 a[148:151],v1 offset:6400
v_mfma_f32_16x16x32_bf16 v[96:99],a[120:123],a[88:91],v[96:99]
v_exp_f32 v73,v73
v_mfma_f32_16x16x32_bf16 v[96:99],a[124:127],a[92:95],v[96:99]
s_waitcnt lgkmcnt(4)
v_exp_f32 v74,v74
v_mfma_f32_16x16x32_bf16 v[76:79],a[128:131],a[0:3],0
v_exp_f32 v75,v75
v_mfma_f32_16x16x32_bf16 v[76:79],a[132:135],a[4:7],v[76:79]
buffer_load_dwordx4 v7,s[4:7],s20 offen offset:1024 lds
s_waitcnt lgkmcnt(3)
v_mfma_f32_16x16x32_bf16 v[76:79],a[136:139],a[8:11],v[76:79]
s_waitcnt lgkmcnt(2)
v_exp_f32 v80,v80
v_mfma_f32_16x16x32_bf16 v[76:79],a[140:143],a[12:15],v[76:79]
s_waitcnt lgkmcnt(0)
v_exp_f32 v81,v81
v_mfma_f32_16x16x32_bf16 v[76:79],a[144:147],a[16:19],v[76:79]
v_cvt_pk_bf16_f32 v44,v72,v73
v_cvt_pk_bf16_f32 v45,v74,v75
v_mfma_f32_16x16x32_bf16 v[76:79],a[148:151],a[20:23],v[76:79]
v_cvt_pk_bf16_f32 v48,v80,v81
v_mfma_f32_16x16x32_bf16 v[84:87],a[148:151],a[44:47],0
v_mfma_f32_16x16x32_bf16 v[84:87],a[144:147],a[40:43],v[84:87]
v_mfma_f32_16x16x32_bf16 v[84:87],a[140:143],a[36:39],v[84:87]
v_mfma_f32_16x16x32_bf16 v[84:87],a[136:139],a[32:35],v[84:87]
v_mfma_f32_16x16x32_bf16 v[84:87],a[132:135],a[28:31],v[84:87]
buffer_load_dwordx4 v8,s[4:7],s20 offen offset:2048 lds
v_mfma_f32_16x16x32_bf16 v[84:87],a[128:131],a[24:27],v[84:87]
s_add_u32 s20,s20,12288
v_mfma_f32_16x16x32_bf16 v[92:95],a[128:131],a[48:51],0
ds_read_b64_tr_b16 a[120:121],v2 offset:24576
v_mfma_f32_16x16x32_bf16 v[92:95],a[132:135],a[52:55],v[92:95]
ds_read_b64_tr_b16 a[122:123],v2 offset:30720
v_mfma_f32_16x16x32_bf16 v[92:95],a[136:139],a[56:59],v[92:95]
ds_read_b64_tr_b16 a[124:125],v3 offset:24576
v_mfma_f32_16x16x32_bf16 v[92:95],a[140:143],a[60:63],v[92:95]
ds_read_b64_tr_b16 a[126:127],v3 offset:30720
v_mfma_f32_16x16x32_bf16 v[92:95],a[144:147],a[64:67],v[92:95]
v_mfma_f32_16x16x32_bf16 v[92:95],a[148:151],a[68:71],v[92:95]
v_mfma_f32_16x16x32_bf16 v[100:103],a[148:151],a[92:95],0
v_mfma_f32_16x16x32_bf16 v[100:103],a[144:147],a[88:91],v[100:103]
v_mfma_f32_16x16x32_bf16 v[100:103],a[140:143],a[84:87],v[100:103]
v_mfma_f32_16x16x32_bf16 v[100:103],a[136:139],a[80:83],v[100:103]
v_mfma_f32_16x16x32_bf16 v[100:103],a[132:135],a[76:79],v[100:103]
ds_read_b64_tr_b16 a[132:133],v5 offset:24576
v_mfma_f32_16x16x32_bf16 v[100:103],a[128:131],a[72:75],v[100:103]
ds_read_b64_tr_b16 a[128:129],v4 offset:24576
ds_read_b64_tr_b16 a[130:131],v4 offset:30720
ds_read_b64_tr_b16 a[134:135],v5 offset:30720
s_mov_b32 s38,0
s_branch L_loop4
L_loop5:
.p2align 6
L_loop5w0:
s_waitcnt lgkmcnt(3)
v_mfma_f32_16x16x32_bf16 v[160:163],a[120:123],v[20:23],v[160:163]
s_add_u32 m0,s23,24576
ds_read_b64_tr_b16 a[142:143],v3 offset:30848
v_fma_f32 v90,v90,s36,v15
v_mfma_f32_16x16x32_bf16 v[164:167],a[124:127],v[20:23],v[164:167]
ds_read_b64_tr_b16 a[136:137],v2 offset:24704
v_fma_f32 v91,v91,s36,v15
v_mfma_f32_16x16x32_bf16 v[212:215],a[124:127],v[24:27],v[212:215]
ds_read_b64_tr_b16 a[138:139],v2 offset:30848
v_fma_f32 v97,v97,s36,v16
v_mfma_f32_16x16x32_bf16 v[208:211],a[120:123],v[24:27],v[208:211]
ds_read_b64_tr_b16 a[140:141],v3 offset:24704
v_fma_f32 v96,v96,s36,v16
v_mfma_f32_16x16x32_bf16 v[112:115],a[120:123],v[28:31],v[112:115]
ds_read_b64_tr_b16 a[146:147],v4 offset:30848
v_fma_f32 v98,v98,s36,v16
v_mfma_f32_16x16x32_bf16 v[116:119],a[124:127],v[28:31],v[116:119]
ds_read_b64_tr_b16 a[144:145],v4 offset:24704
v_fma_f32 v99,v99,s36,v16
v_mfma_f32_16x16x32_bf16 a[164:167],a[124:127],v[32:35],a[164:167]
ds_read_b64_tr_b16 a[150:151],v5 offset:30848
v_fma_f32 v106,v106,s36,v17
v_mfma_f32_16x16x32_bf16 a[160:163],a[120:123],v[32:35],a[160:163]
ds_read_b64_tr_b16 a[148:149],v5 offset:24704
v_fma_f32 v107,v107,s36,v17
v_mfma_f32_16x16x32_bf16 a[208:211],a[120:123],v[36:39],a[208:211]
ds_read_b64_tr_b16 a[122:123],v2 offset:30976
v_fma_f32 v104,v104,s36,v17
v_mfma_f32_16x16x32_bf16 a[212:215],a[124:127],v[36:39],a[212:215]
s_waitcnt lgkmcnt(6)
ds_read_b64_tr_b16 a[126:127],v3 offset:30976
v_fma_f32 v105,v105,s36,v17
v_mfma_f32_16x16x32_bf16 a[216:219],a[128:131],v[36:39],a[216:219]
ds_read_b64_tr_b16 a[120:121],v2 offset:24832
v_fma_f32 v77,v77,s36,v13
v_mfma_f32_16x16x32_bf16 a[220:223],a[132:135],v[36:39],a[220:223]
ds_read_b64_tr_b16 a[124:125],v3 offset:24832
v_fma_f32 v79,v79,s36,v13
v_mfma_f32_16x16x32_bf16 a[172:175],a[132:135],v[32:35],a[172:175]
v_exp_f32 v91,v91
v_mfma_f32_16x16x32_bf16 a[168:171],a[128:131],v[32:35],a[168:171]
v_exp_f32 v90,v90
v_mfma_f32_16x16x32_bf16 v[120:123],a[128:131],v[28:31],v[120:123]
v_cvt_pk_bf16_f32 v53,v90,v91
v_fma_f32 v76,v76,s36,v13
v_mfma_f32_16x16x32_bf16 v[124:127],a[132:135],v[28:31],v[124:127]
v_exp_f32 v99,v99
v_mfma_f32_16x16x32_bf16 v[220:223],a[132:135],v[24:27],v[220:223]
v_exp_f32 v96,v96
v_mfma_f32_16x16x32_bf16 v[216:219],a[128:131],v[24:27],v[216:219]
v_exp_f32 v98,v98
v_mfma_f32_16x16x32_bf16 v[168:171],a[128:131],v[20:23],v[168:171]
ds_read_b64_tr_b16 a[128:129],v4 offset:24832
v_cvt_pk_bf16_f32 v57,v98,v99
v_mfma_f32_16x16x32_bf16 v[172:175],a[132:135],v[20:23],v[172:175]
ds_read_b64_tr_b16 a[130:131],v4 offset:30976
v_fma_f32 v78,v78,s36,v13
v_mfma_f32_16x16x32_bf16 v[176:179],a[136:139],v[20:23],v[176:179]
s_waitcnt lgkmcnt(2)
ds_read_b64_tr_b16 a[132:133],v5 offset:24832
v_fma_f32 v86,v86,s36,v14
v_mfma_f32_16x16x32_bf16 v[180:183],a[140:143],v[20:23],v[180:183]
ds_read_b64_tr_b16 a[134:135],v5 offset:30976
v_fma_f32 v84,v84,s36,v14
v_mfma_f32_16x16x32_bf16 v[228:231],a[140:143],v[24:27],v[228:231]
v_exp_f32 v97,v97
v_mfma_f32_16x16x32_bf16 v[224:227],a[136:139],v[24:27],v[224:227]
v_cvt_pk_bf16_f32 v56,v96,v97
v_fma_f32 v87,v87,s36,v14
v_mfma_f32_16x16x32_bf16 v[128:131],a[136:139],v[28:31],v[128:131]
v_exp_f32 v104,v104
v_mfma_f32_16x16x32_bf16 v[132:135],a[140:143],v[28:31],v[132:135]
v_exp_f32 v107,v107
v_mfma_f32_16x16x32_bf16 a[180:183],a[140:143],v[32:35],a[180:183]
v_exp_f32 v105,v105
v_mfma_f32_16x16x32_bf16 a[176:179],a[136:139],v[32:35],a[176:179]
v_exp_f32 v106,v106
v_mfma_f32_16x16x32_bf16 a[224:227],a[136:139],v[36:39],a[224:227]
v_cvt_pk_bf16_f32 v41,v106,v107
v_cvt_pk_bf16_f32 v40,v104,v105
v_mfma_f32_16x16x32_bf16 a[228:231],a[140:143],v[36:39],a[228:231]
v_exp_f32 v78,v78
v_mfma_f32_16x16x32_bf16 a[232:235],a[144:147],v[36:39],a[232:235]
v_exp_f32 v79,v79
v_mfma_f32_16x16x32_bf16 a[236:239],a[148:151],v[36:39],a[236:239]
v_exp_f32 v77,v77
v_mfma_f32_16x16x32_bf16 a[188:191],a[148:151],v[32:35],a[188:191]
v_exp_f32 v76,v76
v_mfma_f32_16x16x32_bf16 a[184:187],a[144:147],v[32:35],a[184:187]
v_cvt_pk_bf16_f32 v46,v76,v77
v_cvt_pk_bf16_f32 v47,v78,v79
v_mfma_f32_16x16x32_bf16 v[136:139],a[144:147],v[28:31],v[136:139]
v_exp_f32 v86,v86
v_mfma_f32_16x16x32_bf16 v[140:143],a[148:151],v[28:31],v[140:143]
v_exp_f32 v87,v87
v_mfma_f32_16x16x32_bf16 v[236:239],a[148:151],v[24:27],v[236:239]
v_exp_f32 v84,v84
v_mfma_f32_16x16x32_bf16 v[232:235],a[144:147],v[24:27],v[232:235]
v_fma_f32 v85,v85,s36,v14
v_cvt_pk_bf16_f32 v51,v86,v87
v_mfma_f32_16x16x32_bf16 v[184:187],a[144:147],v[20:23],v[184:187]
v_exp_f32 v85,v85
v_mfma_f32_16x16x32_bf16 v[188:191],a[148:151],v[20:23],v[188:191]
v_cvt_pk_bf16_f32 v50,v84,v85
v_fma_f32 v92,v92,s36,v15
v_mfma_f32_16x16x32_bf16 v[192:195],a[120:123],v[20:23],v[192:195]
v_fma_f32 v94,v94,s36,v15
v_fma_f32 v93,v93,s36,v15
v_smfmac_f32_16x16x64_bf16 v[60:63],a[152:155],v[44:51],v18
v_fma_f32 v95,v95,s36,v15
v_mfma_f32_16x16x32_bf16 v[196:199],a[124:127],v[20:23],v[196:199]
s_waitcnt vmcnt(6) lgkmcnt(0)
v_exp_f32 v94,v94
v_mfma_f32_16x16x32_bf16 v[244:247],a[124:127],v[24:27],v[244:247]
s_barrier
v_mfma_f32_16x16x32_bf16 v[240:243],a[120:123],v[24:27],v[240:243]
ds_read_b128 a[136:139],v0 offset:12288
v_fma_f32 v102,v102,s36,v16
v_mfma_f32_16x16x32_bf16 v[144:147],a[120:123],v[28:31],v[144:147]
ds_read_b128 a[144:147],v0 offset:12416
v_fma_f32 v101,v101,s36,v16
v_mfma_f32_16x16x32_bf16 v[148:151],a[124:127],v[28:31],v[148:151]
ds_read_b128 a[140:143],v1 offset:12288
v_fma_f32 v100,v100,s36,v16
v_mfma_f32_16x16x32_bf16 a[196:199],a[124:127],v[32:35],a[196:199]
ds_read_b128 a[148:151],v1 offset:12416
v_fma_f32 v103,v103,s36,v16
v_mfma_f32_16x16x32_bf16 a[192:195],a[120:123],v[32:35],a[192:195]
ds_read_b128 a[156:159],v10 offset:0
v_fma_f32 v108,v108,s36,v17
v_mfma_f32_16x16x32_bf16 a[240:243],a[120:123],v[36:39],a[240:243]
buffer_load_dwordx4 v6,s[8:11],s21 offen offset:0 lds
v_mfma_f32_16x16x32_bf16 a[244:247],a[124:127],v[36:39],a[244:247]
ds_read_b128 a[120:123],v0 offset:12544
v_fma_f32 v110,v110,s36,v17
v_mfma_f32_16x16x32_bf16 a[248:251],a[128:131],v[36:39],a[248:251]
ds_read_b128 a[124:127],v1 offset:12544
v_fma_f32 v111,v111,s36,v17
v_mfma_f32_16x16x32_bf16 a[252:255],a[132:135],v[36:39],a[252:255]
v_exp_f32 v92,v92
v_mfma_f32_16x16x32_bf16 a[204:207],a[132:135],v[32:35],a[204:207]
v_exp_f32 v95,v95
v_mfma_f32_16x16x32_bf16 a[200:203],a[128:131],v[32:35],a[200:203]
v_cvt_pk_bf16_f32 v55,v94,v95
v_fma_f32 v109,v109,s36,v17
v_mfma_f32_16x16x32_bf16 v[152:155],a[128:131],v[28:31],v[152:155]
v_exp_f32 v93,v93
v_mfma_f32_16x16x32_bf16 v[156:159],a[132:135],v[28:31],v[156:159]
v_cvt_pk_bf16_f32 v54,v92,v93
v_mfma_f32_16x16x32_bf16 v[252:255],a[132:135],v[24:27],v[252:255]
v_exp_f32 v102,v102
v_mfma_f32_16x16x32_bf16 v[248:251],a[128:131],v[24:27],v[248:251]
v_exp_f32 v101,v101
v_mfma_f32_16x16x32_bf16 v[200:203],a[128:131],v[20:23],v[200:203]
ds_read_b128 a[128:131],v0 offset:18432
v_mfma_f32_16x16x32_bf16 v[204:207],a[132:135],v[20:23],v[204:207]
s_waitcnt lgkmcnt(1)
buffer_store_dwordx4 a[156:159],v9,s[16:19],s27 offen offset:0 nt
buffer_load_dwordx4 v7,s[8:11],s21 offen offset:1024 lds
v_mfma_f32_16x16x32_bf16 v[72:75],a[136:139],a[0:3],0
ds_read_b128 a[132:135],v1 offset:18432
v_mfma_f32_16x16x32_bf16 v[72:75],a[140:143],a[4:7],v[72:75]
v_exp_f32 v103,v103
v_mfma_f32_16x16x32_bf16 v[72:75],a[144:147],a[8:11],v[72:75]
v_exp_f32 v100,v100
v_mfma_f32_16x16x32_bf16 v[72:75],a[148:151],a[12:15],v[72:75]
v_cvt_pk_bf16_f32 v59,v102,v103
v_cvt_pk_bf16_f32 v58,v100,v101
v_mfma_f32_16x16x32_bf16 v[72:75],a[120:123],a[16:19],v[72:75]
v_exp_f32 v109,v109
v_smfmac_f32_16x16x64_bf16 v[64:67],a[152:155],v[52:59],v18
ds_read_b128 a[156:159],v10 offset:1024
v_mfma_f32_16x16x32_bf16 v[72:75],a[124:127],a[20:23],v[72:75]
v_exp_f32 v111,v111
v_mfma_f32_16x16x32_bf16 v[80:83],a[124:127],a[44:47],0
v_exp_f32 v108,v108
v_mfma_f32_16x16x32_bf16 v[80:83],a[120:123],a[40:43],v[80:83]
v_exp_f32 v110,v110
v_mfma_f32_16x16x32_bf16 v[80:83],a[148:151],a[36:39],v[80:83]
v_cvt_pk_bf16_f32 v42,v108,v109
v_cvt_pk_bf16_f32 v43,v110,v111
v_mfma_f32_16x16x32_bf16 v[80:83],a[144:147],a[32:35],v[80:83]
buffer_load_dwordx4 v8,s[8:11],s21 offen offset:2048 lds
v_smfmac_f32_16x16x64_bf16 v[68:71],a[152:155],v[36:43],v18
s_add_u32 s21,s21,12288
v_fma_f32 v73,v73,s36,v13
v_mfma_f32_16x16x32_bf16 v[80:83],a[140:143],a[28:31],v[80:83]
s_add_u32 m0,s22,0
v_fma_f32 v72,v72,s36,v13
v_fma_f32 v74,v74,s36,v13
v_mfma_f32_16x16x32_bf16 v[80:83],a[136:139],a[24:27],v[80:83]
v_exp_f32 v73,v73
v_mfma_f32_16x16x32_bf16 v[88:91],a[136:139],a[48:51],0
v_exp_f32 v72,v72
v_mfma_f32_16x16x32_bf16 v[88:91],a[140:143],a[52:55],v[88:91]
v_exp_f32 v74,v74
v_mfma_f32_16x16x32_bf16 v[88:91],a[144:147],a[56:59],v[88:91]
v_fma_f32 v75,v75,s36,v13
v_cvt_pk_bf16_f32 v20,v72,v73
v_mfma_f32_16x16x32_bf16 v[88:91],a[148:151],a[60:63],v[88:91]
v_exp_f32 v75,v75
v_mfma_f32_16x16x32_bf16 v[88:91],a[120:123],a[64:67],v[88:91]
v_fma_f32 v83,v83,s36,v14
v_fma_f32 v81,v81,s36,v14
v_mfma_f32_16x16x32_bf16 v[88:91],a[124:127],a[68:71],v[88:91]
v_exp_f32 v81,v81
v_mfma_f32_16x16x32_bf16 v[96:99],a[124:127],a[92:95],0
v_cvt_pk_bf16_f32 v21,v74,v75
v_fma_f32 v82,v82,s36,v14
v_mfma_f32_16x16x32_bf16 v[96:99],a[120:123],a[88:91],v[96:99]
s_waitcnt lgkmcnt(0)
buffer_store_dwordx4 a[156:159],v9,s[16:19],s27 offen offset:128 nt
buffer_load_dwordx4 v6,s[4:7],s20 offen offset:0 lds
v_mfma_f32_16x16x32_bf16 v[96:99],a[148:151],a[84:87],v[96:99]
v_fma_f32 v88,v88,s36,v15
v_fma_f32 v89,v89,s36,v15
v_mfma_f32_16x16x32_bf16 v[96:99],a[144:147],a[80:83],v[96:99]
v_exp_f32 v89,v89
v_mfma_f32_16x16x32_bf16 v[96:99],a[140:143],a[76:79],v[96:99]
v_exp_f32 v82,v82
v_mfma_f32_16x16x32_bf16 v[96:99],a[136:139],a[72:75],v[96:99]
v_exp_f32 v88,v88
v_mfma_f32_16x16x32_bf16 v[104:107],a[136:139],a[96:99],0
ds_read_b128 a[136:139],v0 offset:18560
v_fma_f32 v80,v80,s36,v14
v_mfma_f32_16x16x32_bf16 v[104:107],a[140:143],a[100:103],v[104:107]
ds_read_b128 a[156:159],v10 offset:2048
v_mfma_f32_16x16x32_bf16 v[104:107],a[144:147],a[104:107],v[104:107]
ds_read_b128 a[140:143],v1 offset:18560
v_mfma_f32_16x16x32_bf16 v[104:107],a[148:151],a[108:111],v[104:107]
ds_read_b128 a[144:147],v0 offset:18688
v_mfma_f32_16x16x32_bf16 v[104:107],a[120:123],a[112:115],v[104:107]
ds_read_b128 a[148:151],v1 offset:18688
v_mfma_f32_16x16x32_bf16 v[104:107],a[124:127],a[116:119],v[104:107]
v_exp_f32 v80,v80
v_mfma_f32_16x16x32_bf16 v[76:79],a[128:131],a[0:3],0
buffer_load_dwordx4 v7,s[4:7],s20 offen offset:1024 lds
v_mfma_f32_16x16x32_bf16 v[76:79],a[132:135],a[4:7],v[76:79]
s_waitcnt lgkmcnt(4)
v_cvt_pk_bf16_f32 v24,v80,v81
v_cvt_pk_bf16_f32 v28,v88,v89
v_mfma_f32_16x16x32_bf16 v[76:79],a[136:139],a[8:11],v[76:79]
s_waitcnt lgkmcnt(2)
v_exp_f32 v83,v83
v_mfma_f32_16x16x32_bf16 v[76:79],a[140:143],a[12:15],v[76:79]
s_waitcnt lgkmcnt(1)
v_cvt_pk_bf16_f32 v25,v82,v83
v_mfma_f32_16x16x32_bf16 v[76:79],a[144:147],a[16:19],v[76:79]
s_waitcnt lgkmcnt(0)
v_mfma_f32_16x16x32_bf16 v[76:79],a[148:151],a[20:23],v[76:79]
v_mfma_f32_16x16x32_bf16 v[84:87],a[148:151],a[44:47],0
v_mfma_f32_16x16x32_bf16 v[84:87],a[144:147],a[40:43],v[84:87]
v_mfma_f32_16x16x32_bf16 v[84:87],a[140:143],a[36:39],v[84:87]
v_mfma_f32_16x16x32_bf16 v[84:87],a[136:139],a[32:35],v[84:87]
v_mfma_f32_16x16x32_bf16 v[84:87],a[132:135],a[28:31],v[84:87]
buffer_store_dwordx4 a[156:159],v9,s[16:19],s27 offen offset:256 nt
buffer_load_dwordx4 v8,s[4:7],s20 offen offset:2048 lds
v_mfma_f32_16x16x32_bf16 v[84:87],a[128:131],a[24:27],v[84:87]
s_add_u32 s20,s20,12288
v_mfma_f32_16x16x32_bf16 v[92:95],a[128:131],a[48:51],0
s_add_u32 s27,s27,3072
v_mfma_f32_16x16x32_bf16 v[92:95],a[132:135],a[52:55],v[92:95]
v_mfma_f32_16x16x32_bf16 v[92:95],a[136:139],a[56:59],v[92:95]
v_mfma_f32_16x16x32_bf16 v[92:95],a[140:143],a[60:63],v[92:95]
ds_read_b64_tr_b16 a[120:121],v2 offset:0
v_mfma_f32_16x16x32_bf16 v[92:95],a[144:147],a[64:67],v[92:95]
ds_read_b64_tr_b16 a[122:123],v2 offset:6144
v_mfma_f32_16x16x32_bf16 v[92:95],a[148:151],a[68:71],v[92:95]
v_mfma_f32_16x16x32_bf16 v[100:103],a[148:151],a[92:95],0
ds_read_b64_tr_b16 a[124:125],v3 offset:0
v_mfma_f32_16x16x32_bf16 v[100:103],a[144:147],a[88:91],v[100:103]
ds_read_b64_tr_b16 a[126:127],v3 offset:6144
v_mfma_f32_16x16x32_bf16 v[100:103],a[140:143],a[84:87],v[100:103]
v_mfma_f32_16x16x32_bf16 v[100:103],a[136:139],a[80:83],v[100:103]
v_mfma_f32_16x16x32_bf16 v[100:103],a[132:135],a[76:79],v[100:103]
v_mfma_f32_16x16x32_bf16 v[100:103],a[128:131],a[72:75],v[100:103]
v_mfma_f32_16x16x32_bf16 v[108:111],a[128:131],a[96:99],0
ds_read_b64_tr_b16 a[130:131],v4 offset:6144
v_mfma_f32_16x16x32_bf16 v[108:111],a[132:135],a[100:103],v[108:111]
ds_read_b64_tr_b16 a[128:129],v4 offset:0
v_mfma_f32_16x16x32_bf16 v[108:111],a[136:139],a[104:107],v[108:111]
ds_read_b64_tr_b16 a[134:135],v5 offset:6144
v_mfma_f32_16x16x32_bf16 v[108:111],a[140:143],a[108:111],v[108:111]
ds_read_b64_tr_b16 a[132:133],v5 offset:0
v_mfma_f32_16x16x32_bf16 v[108:111],a[144:147],a[112:115],v[108:111]
v_mfma_f32_16x16x32_bf16 v[108:111],a[148:151],a[116:119],v[108:111]
s_waitcnt lgkmcnt(4)
v_mfma_f32_16x16x32_bf16 v[160:163],a[120:123],v[44:47],v[160:163]
s_add_u32 m0,s29,0
ds_read_b64_tr_b16 a[136:137],v2 offset:128
v_fma_f32 v90,v90,s36,v15
v_mfma_f32_16x16x32_bf16 v[164:167],a[124:127],v[44:47],v[164:167]
ds_read_b64_tr_b16 a[138:139],v2 offset:6272
v_fma_f32 v91,v91,s36,v15
v_mfma_f32_16x16x32_bf16 v[212:215],a[124:127],v[48:51],v[212:215]
ds_read_b64_tr_b16 a[140:141],v3 offset:128
v_fma_f32 v96,v96,s36,v16
v_mfma_f32_16x16x32_bf16 v[208:211],a[120:123],v[48:51],v[208:211]
ds_read_b64_tr_b16 a[142:143],v3 offset:6272
v_fma_f32 v97,v97,s36,v16
v_mfma_f32_16x16x32_bf16 v[112:115],a[120:123],v[52:55],v[112:115]
ds_read_b64_tr_b16 a[144:145],v4 offset:128
v_fma_f32 v98,v98,s36,v16
v_mfma_f32_16x16x32_bf16 v[116:119],a[124:127],v[52:55],v[116:119]
ds_read_b64_tr_b16 a[146:147],v4 offset:6272
v_fma_f32 v99,v99,s36,v16
v_mfma_f32_16x16x32_bf16 a[164:167],a[124:127],v[56:59],a[164:167]
ds_read_b64_tr_b16 a[148:149],v5 offset:128
v_fma_f32 v104,v104,s36,v17
v_mfma_f32_16x16x32_bf16 a[160:163],a[120:123],v[56:59],a[160:163]
buffer_load_dwordx4 v6,s[12:15],s28 offen offset:0 nt lds
v_mfma_f32_16x16x32_bf16 a[208:211],a[120:123],v[40:43],a[208:211]
ds_read_b64_tr_b16 a[150:151],v5 offset:6272
v_fma_f32 v105,v105,s36,v17
v_mfma_f32_16x16x32_bf16 a[212:215],a[124:127],v[40:43],a[212:215]
s_waitcnt lgkmcnt(5)
ds_read_b64_tr_b16 a[120:121],v2 offset:256
v_fma_f32 v106,v106,s36,v17
v_mfma_f32_16x16x32_bf16 a[216:219],a[128:131],v[40:43],a[216:219]
ds_read_b64_tr_b16 a[122:123],v2 offset:6400
v_fma_f32 v107,v107,s36,v17
v_mfma_f32_16x16x32_bf16 a[220:223],a[132:135],v[40:43],a[220:223]
ds_read_b64_tr_b16 a[124:125],v3 offset:256
v_fma_f32 v76,v76,s36,v13
v_mfma_f32_16x16x32_bf16 a[172:175],a[132:135],v[56:59],a[172:175]
ds_read_b64_tr_b16 a[126:127],v3 offset:6400
v_fma_f32 v77,v77,s36,v13
v_mfma_f32_16x16x32_bf16 a[168:171],a[128:131],v[56:59],a[168:171]
v_exp_f32 v90,v90
v_mfma_f32_16x16x32_bf16 v[120:123],a[128:131],v[52:55],v[120:123]
v_exp_f32 v91,v91
v_mfma_f32_16x16x32_bf16 v[124:127],a[132:135],v[52:55],v[124:127]
v_cvt_pk_bf16_f32 v29,v90,v91
v_fma_f32 v78,v78,s36,v13
v_mfma_f32_16x16x32_bf16 v[220:223],a[132:135],v[48:51],v[220:223]
v_exp_f32 v96,v96
v_mfma_f32_16x16x32_bf16 v[216:219],a[128:131],v[48:51],v[216:219]
buffer_load_dwordx4 v7,s[12:15],s28 offen offset:1024 nt lds
v_mfma_f32_16x16x32_bf16 v[168:171],a[128:131],v[44:47],v[168:171]
ds_read_b64_tr_b16 a[128:129],v4 offset:256
v_fma_f32 v79,v79,s36,v13
v_mfma_f32_16x16x32_bf16 v[172:175],a[132:135],v[44:47],v[172:175]
ds_read_b64_tr_b16 a[130:131],v4 offset:6400
v_fma_f32 v84,v84,s36,v14
v_mfma_f32_16x16x32_bf16 v[176:179],a[136:139],v[44:47],v[176:179]
s_waitcnt lgkmcnt(2)
ds_read_b64_tr_b16 a[132:133],v5 offset:256
v_fma_f32 v85,v85,s36,v14
v_mfma_f32_16x16x32_bf16 v[180:183],a[140:143],v[44:47],v[180:183]
ds_read_b64_tr_b16 a[134:135],v5 offset:6400
v_fma_f32 v86,v86,s36,v14
v_mfma_f32_16x16x32_bf16 v[228:231],a[140:143],v[48:51],v[228:231]
v_exp_f32 v97,v97
v_mfma_f32_16x16x32_bf16 v[224:227],a[136:139],v[48:51],v[224:227]
v_exp_f32 v98,v98
v_mfma_f32_16x16x32_bf16 v[128:131],a[136:139],v[52:55],v[128:131]
v_exp_f32 v99,v99
v_mfma_f32_16x16x32_bf16 v[132:135],a[140:143],v[52:55],v[132:135]
v_cvt_pk_bf16_f32 v32,v96,v97
v_cvt_pk_bf16_f32 v33,v98,v99
v_mfma_f32_16x16x32_bf16 a[180:183],a[140:143],v[56:59],a[180:183]
v_exp_f32 v104,v104
v_mfma_f32_16x16x32_bf16 a[176:179],a[136:139],v[56:59],a[176:179]
buffer_load_dwordx4 v8,s[12:15],s28 offen offset:2048 nt lds
v_mfma_f32_16x16x32_bf16 a[224:227],a[136:139],v[40:43],a[224:227]
s_add_u32 s28,s28,3072
v_exp_f32 v105,v105
v_mfma_f32_16x16x32_bf16 a[228:231],a[140:143],v[40:43],a[228:231]
s_add_u32 s29,s29,3072
v_exp_f32 v106,v106
v_mfma_f32_16x16x32_bf16 a[232:235],a[144:147],v[40:43],a[232:235]
s_add_u32 m0,s23,0
v_exp_f32 v107,v107
v_mfma_f32_16x16x32_bf16 a[236:239],a[148:151],v[40:43],a[236:239]
v_cvt_pk_bf16_f32 v36,v104,v105
v_cvt_pk_bf16_f32 v37,v106,v107
v_mfma_f32_16x16x32_bf16 a[188:191],a[148:151],v[56:59],a[188:191]
v_exp_f32 v76,v76
v_mfma_f32_16x16x32_bf16 a[184:187],a[144:147],v[56:59],a[184:187]
v_exp_f32 v77,v77
v_mfma_f32_16x16x32_bf16 v[136:139],a[144:147],v[52:55],v[136:139]
v_exp_f32 v78,v78
v_mfma_f32_16x16x32_bf16 v[140:143],a[148:151],v[52:55],v[140:143]
v_exp_f32 v79,v79
v_mfma_f32_16x16x32_bf16 v[236:239],a[148:151],v[48:51],v[236:239]
v_cvt_pk_bf16_f32 v22,v76,v77
v_cvt_pk_bf16_f32 v23,v78,v79
v_mfma_f32_16x16x32_bf16 v[232:235],a[144:147],v[48:51],v[232:235]
v_fma_f32 v87,v87,s36,v14
v_fma_f32 v92,v92,s36,v15
v_mfma_f32_16x16x32_bf16 v[184:187],a[144:147],v[44:47],v[184:187]
v_exp_f32 v84,v84
v_mfma_f32_16x16x32_bf16 v[188:191],a[148:151],v[44:47],v[188:191]
v_exp_f32 v85,v85
v_mfma_f32_16x16x32_bf16 v[192:195],a[120:123],v[44:47],v[192:195]
v_exp_f32 v86,v86
v_mfma_f32_16x16x32_bf16 v[196:199],a[124:127],v[44:47],v[196:199]
s_waitcnt vmcnt(12) lgkmcnt(0)
v_exp_f32 v87,v87
v_mfma_f32_16x16x32_bf16 v[244:247],a[124:127],v[48:51],v[244:247]
s_barrier
v_mfma_f32_16x16x32_bf16 v[240:243],a[120:123],v[48:51],v[240:243]
ds_read_b128 a[136:139],v0 offset:24576
v_cvt_pk_bf16_f32 v26,v84,v85
v_mfma_f32_16x16x32_bf16 v[144:147],a[120:123],v[52:55],v[144:147]
ds_read_b128 a[140:143],v1 offset:24576
v_cvt_pk_bf16_f32 v27,v86,v87
v_mfma_f32_16x16x32_bf16 v[148:151],a[124:127],v[52:55],v[148:151]
ds_read_b128 a[144:147],v0 offset:24704
v_fma_f32 v93,v93,s36,v15
v_smfmac_f32_16x16x64_bf16 v[60:63],a[152:155],v[20:27],v18
ds_read_b128 a[148:151],v1 offset:24704
v_mfma_f32_16x16x32_bf16 a[196:199],a[124:127],v[56:59],a[196:199]
v_fma_f32 v94,v94,s36,v15
v_fma_f32 v95,v95,s36,v15
v_mfma_f32_16x16x32_bf16 a[192:195],a[120:123],v[56:59],a[192:195]
buffer_load_dwordx4 v6,s[8:11],s21 offen offset:0 lds
v_mfma_f32_16x16x32_bf16 a[240:243],a[120:123],v[40:43],a[240:243]
ds_read_b128 a[120:123],v0 offset:24832
v_fma_f32 v100,v100,s36,v16
v_mfma_f32_16x16x32_bf16 a[244:247],a[124:127],v[40:43],a[244:247]
ds_read_b128 a[124:127],v1 offset:24832
v_fma_f32 v101,v101,s36,v16
v_mfma_f32_16x16x32_bf16 a[248:251],a[128:131],v[40:43],a[248:251]
v_exp_f32 v92,v92
v_mfma_f32_16x16x32_bf16 a[252:255],a[132:135],v[40:43],a[252:255]
v_exp_f32 v93,v93
v_mfma_f32_16x16x32_bf16 a[204:207],a[132:135],v[56:59],a[204:207]
v_exp_f32 v94,v94
v_mfma_f32_16x16x32_bf16 a[200:203],a[128:131],v[56:59],a[200:203]
v_exp_f32 v95,v95
v_mfma_f32_16x16x32_bf16 v[152:155],a[128:131],v[52:55],v[152:155]
v_cvt_pk_bf16_f32 v30,v92,v93
v_cvt_pk_bf16_f32 v31,v94,v95
v_mfma_f32_16x16x32_bf16 v[156:159],a[132:135],v[52:55],v[156:159]
v_fma_f32 v102,v102,s36,v16
v_fma_f32 v103,v103,s36,v16
v_mfma_f32_16x16x32_bf16 v[252:255],a[132:135],v[48:51],v[252:255]
v_exp_f32 v100,v100
v_mfma_f32_16x16x32_bf16 v[248:251],a[128:131],v[48:51],v[248:251]
v_exp_f32 v101,v101
v_mfma_f32_16x16x32_bf16 v[200:203],a[128:131],v[44:47],v[200:203]
buffer_load_dwordx4 v7,s[8:11],s21 offen offset:1024 lds
v_mfma_f32_16x16x32_bf16 v[204:207],a[132:135],v[44:47],v[204:207]
s_waitcnt lgkmcnt(0)
ds_read_b128 a[128:131],v0 offset:30720
v_cvt_pk_bf16_f32 v34,v100,v101
v_mfma_f32_16x16x32_bf16 v[72:75],a[136:139],a[0:3],0
ds_read_b128 a[132:135],v1 offset:30720
v_fma_f32 v108,v108,s36,v17
v_mfma_f32_16x16x32_bf16 v[72:75],a[140:143],a[4:7],v[72:75]
v_exp_f32 v102,v102
v_mfma_f32_16x16x32_bf16 v[72:75],a[144:147],a[8:11],v[72:75]
v_exp_f32 v103,v103
v_mfma_f32_16x16x32_bf16 v[72:75],a[148:151],a[12:15],v[72:75]
v_cvt_pk_bf16_f32 v35,v102,v103
v_fma_f32 v109,v109,s36,v17
v_mfma_f32_16x16x32_bf16 v[72:75],a[120:123],a[16:19],v[72:75]
v_fma_f32 v110,v110,s36,v17
v_fma_f32 v111,v111,s36,v17
v_smfmac_f32_16x16x64_bf16 v[64:67],a[152:155],v[28:35],v18
v_mfma_f32_16x16x32_bf16 v[72:75],a[124:127],a[20:23],v[72:75]
v_exp_f32 v108,v108
v_mfma_f32_16x16x32_bf16 v[80:83],a[124:127],a[44:47],0
v_exp_f32 v109,v109
v_mfma_f32_16x16x32_bf16 v[80:83],a[120:123],a[40:43],v[80:83]
v_exp_f32 v110,v110
v_mfma_f32_16x16x32_bf16 v[80:83],a[148:151],a[36:39],v[80:83]
v_exp_f32 v111,v111
v_mfma_f32_16x16x32_bf16 v[80:83],a[144:147],a[32:35],v[80:83]
buffer_load_dwordx4 v8,s[8:11],s21 offen offset:2048 lds
v_mfma_f32_16x16x32_bf16 v[80:83],a[140:143],a[28:31],v[80:83]
s_add_u32 s21,s21,12288
v_cvt_pk_bf16_f32 v38,v108,v109
v_cvt_pk_bf16_f32 v39,v110,v111
v_mfma_f32_16x16x32_bf16 v[80:83],a[136:139],a[24:27],v[80:83]
s_add_u32 m0,s22,12288
v_fma_f32 v72,v72,s36,v13
v_fma_f32 v73,v73,s36,v13
v_mfma_f32_16x16x32_bf16 v[88:91],a[136:139],a[48:51],0
v_fma_f32 v74,v74,s36,v13
v_fma_f32 v75,v75,s36,v13
v_mfma_f32_16x16x32_bf16 v[88:91],a[140:143],a[52:55],v[88:91]
v_exp_f32 v72,v72
v_mfma_f32_16x16x32_bf16 v[88:91],a[144:147],a[56:59],v[88:91]
v_fma_f32 v80,v80,s36,v14
v_fma_f32 v81,v81,s36,v14
v_mfma_f32_16x16x32_bf16 v[88:91],a[148:151],a[60:63],v[88:91]
v_fma_f32 v82,v82,s36,v14
v_fma_f32 v83,v83,s36,v14
v_mfma_f32_16x16x32_bf16 v[88:91],a[120:123],a[64:67],v[88:91]
v_exp_f32 v73,v73
v_mfma_f32_16x16x32_bf16 v[88:91],a[124:127],a[68:71],v[88:91]
v_exp_f32 v74,v74
v_mfma_f32_16x16x32_bf16 v[96:99],a[124:127],a[92:95],0
v_exp_f32 v75,v75
v_mfma_f32_16x16x32_bf16 v[96:99],a[120:123],a[88:91],v[96:99]
v_exp_f32 v80,v80
v_mfma_f32_16x16x32_bf16 v[96:99],a[148:151],a[84:87],v[96:99]
buffer_load_dwordx4 v6,s[4:7],s20 offen offset:0 lds
v_mfma_f32_16x16x32_bf16 v[96:99],a[144:147],a[80:83],v[96:99]
v_fma_f32 v88,v88,s36,v15
v_fma_f32 v89,v89,s36,v15
v_mfma_f32_16x16x32_bf16 v[96:99],a[140:143],a[76:79],v[96:99]
v_exp_f32 v81,v81
v_mfma_f32_16x16x32_bf16 v[96:99],a[136:139],a[72:75],v[96:99]
v_exp_f32 v82,v82
v_mfma_f32_16x16x32_bf16 v[104:107],a[136:139],a[96:99],0
ds_read_b128 a[136:139],v0 offset:30848
v_cvt_pk_bf16_f32 v44,v72,v73
v_mfma_f32_16x16x32_bf16 v[104:107],a[140:143],a[100:103],v[104:107]
ds_read_b128 a[140:143],v1 offset:30848
v_cvt_pk_bf16_f32 v45,v74,v75
v_mfma_f32_16x16x32_bf16 v[104:107],a[144:147],a[104:107],v[104:107]
ds_read_b128 a[144:147],v0 offset:30976
v_cvt_pk_bf16_f32 v48,v80,v81
v_mfma_f32_16x16x32_bf16 v[104:107],a[148:151],a[108:111],v[104:107]
ds_read_b128 a[148:151],v1 offset:30976
v_mfma_f32_16x16x32_bf16 v[104:107],a[120:123],a[112:115],v[104:107]
v_exp_f32 v83,v83
v_mfma_f32_16x16x32_bf16 v[104:107],a[124:127],a[116:119],v[104:107]
s_waitcnt lgkmcnt(4)
v_exp_f32 v88,v88
v_mfma_f32_16x16x32_bf16 v[76:79],a[128:131],a[0:3],0
v_exp_f32 v89,v89
v_mfma_f32_16x16x32_bf16 v[76:79],a[132:135],a[4:7],v[76:79]
buffer_load_dwordx4 v7,s[4:7],s20 offen offset:1024 lds
s_waitcnt lgkmcnt(3)
v_mfma_f32_16x16x32_bf16 v[76:79],a[136:139],a[8:11],v[76:79]
s_waitcnt lgkmcnt(2)
v_cvt_pk_bf16_f32 v49,v82,v83
v_cvt_pk_bf16_f32 v52,v88,v89
v_mfma_f32_16x16x32_bf16 v[76:79],a[140:143],a[12:15],v[76:79]
s_waitcnt lgkmcnt(0)
v_mfma_f32_16x16x32_bf16 v[76:79],a[144:147],a[16:19],v[76:79]
v_mfma_f32_16x16x32_bf16 v[76:79],a[148:151],a[20:23],v[76:79]
v_mfma_f32_16x16x32_bf16 v[84:87],a[148:151],a[44:47],0
v_mfma_f32_16x16x32_bf16 v[84:87],a[144:147],a[40:43],v[84:87]
v_mfma_f32_16x16x32_bf16 v[84:87],a[140:143],a[36:39],v[84:87]
v_mfma_f32_16x16x32_bf16 v[84:87],a[136:139],a[32:35],v[84:87]
v_mfma_f32_16x16x32_bf16 v[84:87],a[132:135],a[28:31],v[84:87]
v_mfma_f32_16x16x32_bf16 v[84:87],a[128:131],a[24:27],v[84:87]
v_mfma_f32_16x16x32_bf16 v[92:95],a[128:131],a[48:51],0
v_mfma_f32_16x16x32_bf16 v[92:95],a[132:135],a[52:55],v[92:95]
buffer_load_dwordx4 v8,s[4:7],s20 offen offset:2048 lds
v_mfma_f32_16x16x32_bf16 v[92:95],a[136:139],a[56:59],v[92:95]
s_add_u32 s20,s20,12288
v_mfma_f32_16x16x32_bf16 v[92:95],a[140:143],a[60:63],v[92:95]
v_mfma_f32_16x16x32_bf16 v[92:95],a[144:147],a[64:67],v[92:95]
v_mfma_f32_16x16x32_bf16 v[92:95],a[148:151],a[68:71],v[92:95]
v_mfma_f32_16x16x32_bf16 v[100:103],a[148:151],a[92:95],0
ds_read_b64_tr_b16 a[120:121],v2 offset:12288
v_mfma_f32_16x16x32_bf16 v[100:103],a[144:147],a[88:91],v[100:103]
ds_read_b64_tr_b16 a[122:123],v2 offset:18432
v_mfma_f32_16x16x32_bf16 v[100:103],a[140:143],a[84:87],v[100:103]
v_mfma_f32_16x16x32_bf16 v[100:103],a[136:139],a[80:83],v[100:103]
ds_read_b64_tr_b16 a[124:125],v3 offset:12288
v_mfma_f32_16x16x32_bf16 v[100:103],a[132:135],a[76:79],v[100:103]
ds_read_b64_tr_b16 a[126:127],v3 offset:18432
v_mfma_f32_16x16x32_bf16 v[100:103],a[128:131],a[72:75],v[100:103]
v_mfma_f32_16x16x32_bf16 v[108:111],a[128:131],a[96:99],0
ds_read_b64_tr_b16 a[128:129],v4 offset:12288
v_mfma_f32_16x16x32_bf16 v[108:111],a[132:135],a[100:103],v[108:111]
ds_read_b64_tr_b16 a[130:131],v4 offset:18432
v_mfma_f32_16x16x32_bf16 v[108:111],a[136:139],a[104:107],v[108:111]
ds_read_b64_tr_b16 a[132:133],v5 offset:12288
v_mfma_f32_16x16x32_bf16 v[108:111],a[140:143],a[108:111],v[108:111]
ds_read_b64_tr_b16 a[134:135],v5 offset:18432
v_mfma_f32_16x16x32_bf16 v[108:111],a[144:147],a[112:115],v[108:111]
v_mfma_f32_16x16x32_bf16 v[108:111],a[148:151],a[116:119],v[108:111]
s_waitcnt lgkmcnt(4)
v_mfma_f32_16x16x32_bf16 v[160:163],a[120:123],v[20:23],v[160:163]
s_add_u32 m0,s23,12288
ds_read_b64_tr_b16 a[142:143],v3 offset:18560
v_fma_f32 v90,v90,s36,v15
v_mfma_f32_16x16x32_bf16 v[164:167],a[124:127],v[20:23],v[164:167]
ds_read_b64_tr_b16 a[136:137],v2 offset:12416
v_fma_f32 v91,v91,s36,v15
v_mfma_f32_16x16x32_bf16 v[212:215],a[124:127],v[24:27],v[212:215]
ds_read_b64_tr_b16 a[138:139],v2 offset:18560
v_fma_f32 v97,v97,s36,v16
v_mfma_f32_16x16x32_bf16 v[208:211],a[120:123],v[24:27],v[208:211]
ds_read_b64_tr_b16 a[140:141],v3 offset:12416
v_fma_f32 v96,v96,s36,v16
v_mfma_f32_16x16x32_bf16 v[112:115],a[120:123],v[28:31],v[112:115]
ds_read_b64_tr_b16 a[146:147],v4 offset:18560
v_fma_f32 v98,v98,s36,v16
v_mfma_f32_16x16x32_bf16 v[116:119],a[124:127],v[28:31],v[116:119]
ds_read_b64_tr_b16 a[144:145],v4 offset:12416
v_fma_f32 v99,v99,s36,v16
v_mfma_f32_16x16x32_bf16 a[164:167],a[124:127],v[32:35],a[164:167]
ds_read_b64_tr_b16 a[150:151],v5 offset:18560
v_fma_f32 v106,v106,s36,v17
v_mfma_f32_16x16x32_bf16 a[160:163],a[120:123],v[32:35],a[160:163]
ds_read_b64_tr_b16 a[148:149],v5 offset:12416
v_fma_f32 v107,v107,s36,v17
v_mfma_f32_16x16x32_bf16 a[208:211],a[120:123],v[36:39],a[208:211]
ds_read_b64_tr_b16 a[122:123],v2 offset:18688
v_fma_f32 v104,v104,s36,v17
v_mfma_f32_16x16x32_bf16 a[212:215],a[124:127],v[36:39],a[212:215]
s_waitcnt lgkmcnt(6)
ds_read_b64_tr_b16 a[126:127],v3 offset:18688
v_fma_f32 v105,v105,s36,v17
v_mfma_f32_16x16x32_bf16 a[216:219],a[128:131],v[36:39],a[216:219]
ds_read_b64_tr_b16 a[120:121],v2 offset:12544
v_fma_f32 v77,v77,s36,v13
v_mfma_f32_16x16x32_bf16 a[220:223],a[132:135],v[36:39],a[220:223]
ds_read_b64_tr_b16 a[124:125],v3 offset:12544
v_fma_f32 v79,v79,s36,v13
v_mfma_f32_16x16x32_bf16 a[172:175],a[132:135],v[32:35],a[172:175]
v_exp_f32 v91,v91
v_mfma_f32_16x16x32_bf16 a[168:171],a[128:131],v[32:35],a[168:171]
v_exp_f32 v90,v90
v_mfma_f32_16x16x32_bf16 v[120:123],a[128:131],v[28:31],v[120:123]
v_cvt_pk_bf16_f32 v53,v90,v91
v_fma_f32 v76,v76,s36,v13
v_mfma_f32_16x16x32_bf16 v[124:127],a[132:135],v[28:31],v[124:127]
v_exp_f32 v99,v99
v_mfma_f32_16x16x32_bf16 v[220:223],a[132:135],v[24:27],v[220:223]
v_exp_f32 v96,v96
v_mfma_f32_16x16x32_bf16 v[216:219],a[128:131],v[24:27],v[216:219]
v_exp_f32 v98,v98
v_mfma_f32_16x16x32_bf16 v[168:171],a[128:131],v[20:23],v[168:171]
ds_read_b64_tr_b16 a[128:129],v4 offset:12544
v_cvt_pk_bf16_f32 v57,v98,v99
v_mfma_f32_16x16x32_bf16 v[172:175],a[132:135],v[20:23],v[172:175]
ds_read_b64_tr_b16 a[130:131],v4 offset:18688
v_fma_f32 v78,v78,s36,v13
v_mfma_f32_16x16x32_bf16 v[176:179],a[136:139],v[20:23],v[176:179]
s_waitcnt lgkmcnt(2)
ds_read_b64_tr_b16 a[132:133],v5 offset:12544
v_fma_f32 v86,v86,s36,v14
v_mfma_f32_16x16x32_bf16 v[180:183],a[140:143],v[20:23],v[180:183]
ds_read_b64_tr_b16 a[134:135],v5 offset:18688
v_fma_f32 v84,v84,s36,v14
v_mfma_f32_16x16x32_bf16 v[228:231],a[140:143],v[24:27],v[228:231]
v_exp_f32 v97,v97
v_mfma_f32_16x16x32_bf16 v[224:227],a[136:139],v[24:27],v[224:227]
v_cvt_pk_bf16_f32 v56,v96,v97
v_fma_f32 v87,v87,s36,v14
v_mfma_f32_16x16x32_bf16 v[128:131],a[136:139],v[28:31],v[128:131]
v_exp_f32 v104,v104
v_mfma_f32_16x16x32_bf16 v[132:135],a[140:143],v[28:31],v[132:135]
v_exp_f32 v107,v107
v_mfma_f32_16x16x32_bf16 a[180:183],a[140:143],v[32:35],a[180:183]
v_exp_f32 v105,v105
v_mfma_f32_16x16x32_bf16 a[176:179],a[136:139],v[32:35],a[176:179]
v_exp_f32 v106,v106
v_mfma_f32_16x16x32_bf16 a[224:227],a[136:139],v[36:39],a[224:227]
v_cvt_pk_bf16_f32 v41,v106,v107
v_cvt_pk_bf16_f32 v40,v104,v105
v_mfma_f32_16x16x32_bf16 a[228:231],a[140:143],v[36:39],a[228:231]
v_exp_f32 v78,v78
v_mfma_f32_16x16x32_bf16 a[232:235],a[144:147],v[36:39],a[232:235]
v_exp_f32 v79,v79
v_mfma_f32_16x16x32_bf16 a[236:239],a[148:151],v[36:39],a[236:239]
v_exp_f32 v77,v77
v_mfma_f32_16x16x32_bf16 a[188:191],a[148:151],v[32:35],a[188:191]
v_exp_f32 v76,v76
v_mfma_f32_16x16x32_bf16 a[184:187],a[144:147],v[32:35],a[184:187]
v_cvt_pk_bf16_f32 v46,v76,v77
v_cvt_pk_bf16_f32 v47,v78,v79
v_mfma_f32_16x16x32_bf16 v[136:139],a[144:147],v[28:31],v[136:139]
v_exp_f32 v86,v86
v_mfma_f32_16x16x32_bf16 v[140:143],a[148:151],v[28:31],v[140:143]
v_exp_f32 v87,v87
v_mfma_f32_16x16x32_bf16 v[236:239],a[148:151],v[24:27],v[236:239]
v_exp_f32 v84,v84
v_mfma_f32_16x16x32_bf16 v[232:235],a[144:147],v[24:27],v[232:235]
v_fma_f32 v85,v85,s36,v14
v_cvt_pk_bf16_f32 v51,v86,v87
v_mfma_f32_16x16x32_bf16 v[184:187],a[144:147],v[20:23],v[184:187]
v_exp_f32 v85,v85
v_mfma_f32_16x16x32_bf16 v[188:191],a[148:151],v[20:23],v[188:191]
v_cvt_pk_bf16_f32 v50,v84,v85
v_fma_f32 v92,v92,s36,v15
v_mfma_f32_16x16x32_bf16 v[192:195],a[120:123],v[20:23],v[192:195]
v_fma_f32 v94,v94,s36,v15
v_fma_f32 v93,v93,s36,v15
v_smfmac_f32_16x16x64_bf16 v[60:63],a[152:155],v[44:51],v18
v_fma_f32 v95,v95,s36,v15
v_mfma_f32_16x16x32_bf16 v[196:199],a[124:127],v[20:23],v[196:199]
s_waitcnt vmcnt(9) lgkmcnt(0)
v_exp_f32 v94,v94
v_mfma_f32_16x16x32_bf16 v[244:247],a[124:127],v[24:27],v[244:247]
s_barrier
v_mfma_f32_16x16x32_bf16 v[240:243],a[120:123],v[24:27],v[240:243]
ds_read_b128 a[136:139],v0 offset:0
v_fma_f32 v102,v102,s36,v16
v_mfma_f32_16x16x32_bf16 v[144:147],a[120:123],v[28:31],v[144:147]
ds_read_b128 a[144:147],v0 offset:128
v_fma_f32 v101,v101,s36,v16
v_mfma_f32_16x16x32_bf16 v[148:151],a[124:127],v[28:31],v[148:151]
ds_read_b128 a[140:143],v1 offset:0
v_fma_f32 v100,v100,s36,v16
v_mfma_f32_16x16x32_bf16 a[196:199],a[124:127],v[32:35],a[196:199]
ds_read_b128 a[148:151],v1 offset:128
v_fma_f32 v103,v103,s36,v16
v_mfma_f32_16x16x32_bf16 a[192:195],a[120:123],v[32:35],a[192:195]
ds_read_b128 a[156:159],v10 offset:3072
v_fma_f32 v108,v108,s36,v17
v_mfma_f32_16x16x32_bf16 a[240:243],a[120:123],v[36:39],a[240:243]
buffer_load_dwordx4 v6,s[8:11],s21 offen offset:0 lds
v_mfma_f32_16x16x32_bf16 a[244:247],a[124:127],v[36:39],a[244:247]
ds_read_b128 a[120:123],v0 offset:256
v_fma_f32 v110,v110,s36,v17
v_mfma_f32_16x16x32_bf16 a[248:251],a[128:131],v[36:39],a[248:251]
ds_read_b128 a[124:127],v1 offset:256
v_fma_f32 v111,v111,s36,v17
v_mfma_f32_16x16x32_bf16 a[252:255],a[132:135],v[36:39],a[252:255]
v_exp_f32 v92,v92
v_mfma_f32_16x16x32_bf16 a[204:207],a[132:135],v[32:35],a[204:207]
v_exp_f32 v95,v95
v_mfma_f32_16x16x32_bf16 a[200:203],a[128:131],v[32:35],a[200:203]
v_cvt_pk_bf16_f32 v55,v94,v95
v_fma_f32 v109,v109,s36,v17
v_mfma_f32_16x16x32_bf16 v[152:155],a[128:131],v[28:31],v[152:155]
v_exp_f32 v93,v93
v_mfma_f32_16x16x32_bf16 v[156:159],a[132:135],v[28:31],v[156:159]
v_cvt_pk_bf16_f32 v54,v92,v93
v_mfma_f32_16x16x32_bf16 v[252:255],a[132:135],v[24:27],v[252:255]
v_exp_f32 v102,v102
v_mfma_f32_16x16x32_bf16 v[248:251],a[128:131],v[24:27],v[248:251]
v_exp_f32 v101,v101
v_mfma_f32_16x16x32_bf16 v[200:203],a[128:131],v[20:23],v[200:203]
ds_read_b128 a[128:131],v0 offset:6144
v_mfma_f32_16x16x32_bf16 v[204:207],a[132:135],v[20:23],v[204:207]
s_waitcnt lgkmcnt(1)
buffer_store_dwordx4 a[156:159],v9,s[16:19],s27 offen offset:0 nt
buffer_load_dwordx4 v7,s[8:11],s21 offen offset:1024 lds
v_mfma_f32_16x16x32_bf16 v[72:75],a[136:139],a[0:3],0
ds_read_b128 a[132:135],v1 offset:6144
v_mfma_f32_16x16x32_bf16 v[72:75],a[140:143],a[4:7],v[72:75]
v_exp_f32 v103,v103
v_mfma_f32_16x16x32_bf16 v[72:75],a[144:147],a[8:11],v[72:75]
v_exp_f32 v100,v100
v_mfma_f32_16x16x32_bf16 v[72:75],a[148:151],a[12:15],v[72:75]
v_cvt_pk_bf16_f32 v59,v102,v103
v_cvt_pk_bf16_f32 v58,v100,v101
v_mfma_f32_16x16x32_bf16 v[72:75],a[120:123],a[16:19],v[72:75]
v_exp_f32 v109,v109
v_smfmac_f32_16x16x64_bf16 v[64:67],a[152:155],v[52:59],v18
ds_read_b128 a[156:159],v10 offset:4096
v_mfma_f32_16x16x32_bf16 v[72:75],a[124:127],a[20:23],v[72:75]
v_exp_f32 v111,v111
v_mfma_f32_16x16x32_bf16 v[80:83],a[124:127],a[44:47],0
v_exp_f32 v108,v108
v_mfma_f32_16x16x32_bf16 v[80:83],a[120:123],a[40:43],v[80:83]
v_exp_f32 v110,v110
v_mfma_f32_16x16x32_bf16 v[80:83],a[148:151],a[36:39],v[80:83]
v_cvt_pk_bf16_f32 v42,v108,v109
v_cvt_pk_bf16_f32 v43,v110,v111
v_mfma_f32_16x16x32_bf16 v[80:83],a[144:147],a[32:35],v[80:83]
buffer_load_dwordx4 v8,s[8:11],s21 offen offset:2048 lds
v_smfmac_f32_16x16x64_bf16 v[68:71],a[152:155],v[36:43],v18
s_add_u32 s21,s21,12288
v_fma_f32 v73,v73,s36,v13
v_mfma_f32_16x16x32_bf16 v[80:83],a[140:143],a[28:31],v[80:83]
s_add_u32 m0,s22,24576
v_fma_f32 v72,v72,s36,v13
v_fma_f32 v74,v74,s36,v13
v_mfma_f32_16x16x32_bf16 v[80:83],a[136:139],a[24:27],v[80:83]
v_exp_f32 v73,v73
v_mfma_f32_16x16x32_bf16 v[88:91],a[136:139],a[48:51],0
v_exp_f32 v72,v72
v_mfma_f32_16x16x32_bf16 v[88:91],a[140:143],a[52:55],v[88:91]
v_exp_f32 v74,v74
v_mfma_f32_16x16x32_bf16 v[88:91],a[144:147],a[56:59],v[88:91]
v_fma_f32 v75,v75,s36,v13
v_cvt_pk_bf16_f32 v20,v72,v73
v_mfma_f32_16x16x32_bf16 v[88:91],a[148:151],a[60:63],v[88:91]
v_exp_f32 v75,v75
v_mfma_f32_16x16x32_bf16 v[88:91],a[120:123],a[64:67],v[88:91]
v_fma_f32 v83,v83,s36,v14
v_fma_f32 v81,v81,s36,v14
v_mfma_f32_16x16x32_bf16 v[88:91],a[124:127],a[68:71],v[88:91]
v_exp_f32 v81,v81
v_mfma_f32_16x16x32_bf16 v[96:99],a[124:127],a[92:95],0
v_cvt_pk_bf16_f32 v21,v74,v75
v_fma_f32 v82,v82,s36,v14
v_mfma_f32_16x16x32_bf16 v[96:99],a[120:123],a[88:91],v[96:99]
s_waitcnt lgkmcnt(0)
buffer_store_dwordx4 a[156:159],v9,s[16:19],s27 offen offset:128 nt
buffer_load_dwordx4 v6,s[4:7],s20 offen offset:0 lds
v_mfma_f32_16x16x32_bf16 v[96:99],a[148:151],a[84:87],v[96:99]
v_fma_f32 v88,v88,s36,v15
v_fma_f32 v89,v89,s36,v15
v_mfma_f32_16x16x32_bf16 v[96:99],a[144:147],a[80:83],v[96:99]
v_exp_f32 v89,v89
v_mfma_f32_16x16x32_bf16 v[96:99],a[140:143],a[76:79],v[96:99]
v_exp_f32 v82,v82
v_mfma_f32_16x16x32_bf16 v[96:99],a[136:139],a[72:75],v[96:99]
v_exp_f32 v88,v88
v_mfma_f32_16x16x32_bf16 v[104:107],a[136:139],a[96:99],0
ds_read_b128 a[136:139],v0 offset:6272
v_fma_f32 v80,v80,s36,v14
v_mfma_f32_16x16x32_bf16 v[104:107],a[140:143],a[100:103],v[104:107]
ds_read_b128 a[156:159],v10 offset:5120
v_mfma_f32_16x16x32_bf16 v[104:107],a[144:147],a[104:107],v[104:107]
ds_read_b128 a[140:143],v1 offset:6272
v_mfma_f32_16x16x32_bf16 v[104:107],a[148:151],a[108:111],v[104:107]
ds_read_b128 a[144:147],v0 offset:6400
v_mfma_f32_16x16x32_bf16 v[104:107],a[120:123],a[112:115],v[104:107]
ds_read_b128 a[148:151],v1 offset:6400
v_mfma_f32_16x16x32_bf16 v[104:107],a[124:127],a[116:119],v[104:107]
v_exp_f32 v80,v80
v_mfma_f32_16x16x32_bf16 v[76:79],a[128:131],a[0:3],0
buffer_load_dwordx4 v7,s[4:7],s20 offen offset:1024 lds
v_mfma_f32_16x16x32_bf16 v[76:79],a[132:135],a[4:7],v[76:79]
s_waitcnt lgkmcnt(4)
v_cvt_pk_bf16_f32 v24,v80,v81
v_cvt_pk_bf16_f32 v28,v88,v89
v_mfma_f32_16x16x32_bf16 v[76:79],a[136:139],a[8:11],v[76:79]
s_waitcnt lgkmcnt(2)
v_exp_f32 v83,v83
v_mfma_f32_16x16x32_bf16 v[76:79],a[140:143],a[12:15],v[76:79]
s_waitcnt lgkmcnt(1)
v_cvt_pk_bf16_f32 v25,v82,v83
v_mfma_f32_16x16x32_bf16 v[76:79],a[144:147],a[16:19],v[76:79]
s_waitcnt lgkmcnt(0)
v_mfma_f32_16x16x32_bf16 v[76:79],a[148:151],a[20:23],v[76:79]
v_mfma_f32_16x16x32_bf16 v[84:87],a[148:151],a[44:47],0
v_mfma_f32_16x16x32_bf16 v[84:87],a[144:147],a[40:43],v[84:87]
v_mfma_f32_16x16x32_bf16 v[84:87],a[140:143],a[36:39],v[84:87]
v_mfma_f32_16x16x32_bf16 v[84:87],a[136:139],a[32:35],v[84:87]
v_mfma_f32_16x16x32_bf16 v[84:87],a[132:135],a[28:31],v[84:87]
buffer_store_dwordx4 a[156:159],v9,s[16:19],s27 offen offset:256 nt
buffer_load_dwordx4 v8,s[4:7],s20 offen offset:2048 lds
v_mfma_f32_16x16x32_bf16 v[84:87],a[128:131],a[24:27],v[84:87]
s_add_u32 s20,s20,12288
v_mfma_f32_16x16x32_bf16 v[92:95],a[128:131],a[48:51],0
s_add_u32 s27,s27,3072
v_mfma_f32_16x16x32_bf16 v[92:95],a[132:135],a[52:55],v[92:95]
v_mfma_f32_16x16x32_bf16 v[92:95],a[136:139],a[56:59],v[92:95]
v_mfma_f32_16x16x32_bf16 v[92:95],a[140:143],a[60:63],v[92:95]
ds_read_b64_tr_b16 a[120:121],v2 offset:24576
v_mfma_f32_16x16x32_bf16 v[92:95],a[144:147],a[64:67],v[92:95]
ds_read_b64_tr_b16 a[122:123],v2 offset:30720
v_mfma_f32_16x16x32_bf16 v[92:95],a[148:151],a[68:71],v[92:95]
v_mfma_f32_16x16x32_bf16 v[100:103],a[148:151],a[92:95],0
ds_read_b64_tr_b16 a[124:125],v3 offset:24576
v_mfma_f32_16x16x32_bf16 v[100:103],a[144:147],a[88:91],v[100:103]
ds_read_b64_tr_b16 a[126:127],v3 offset:30720
v_mfma_f32_16x16x32_bf16 v[100:103],a[140:143],a[84:87],v[100:103]
v_mfma_f32_16x16x32_bf16 v[100:103],a[136:139],a[80:83],v[100:103]
v_mfma_f32_16x16x32_bf16 v[100:103],a[132:135],a[76:79],v[100:103]
v_mfma_f32_16x16x32_bf16 v[100:103],a[128:131],a[72:75],v[100:103]
v_mfma_f32_16x16x32_bf16 v[108:111],a[128:131],a[96:99],0
ds_read_b64_tr_b16 a[130:131],v4 offset:30720
v_mfma_f32_16x16x32_bf16 v[108:111],a[132:135],a[100:103],v[108:111]
ds_read_b64_tr_b16 a[128:129],v4 offset:24576
v_mfma_f32_16x16x32_bf16 v[108:111],a[136:139],a[104:107],v[108:111]
ds_read_b64_tr_b16 a[134:135],v5 offset:30720
v_mfma_f32_16x16x32_bf16 v[108:111],a[140:143],a[108:111],v[108:111]
ds_read_b64_tr_b16 a[132:133],v5 offset:24576
v_mfma_f32_16x16x32_bf16 v[108:111],a[144:147],a[112:115],v[108:111]
v_mfma_f32_16x16x32_bf16 v[108:111],a[148:151],a[116:119],v[108:111]
s_waitcnt lgkmcnt(4)
v_mfma_f32_16x16x32_bf16 v[160:163],a[120:123],v[44:47],v[160:163]
s_add_u32 m0,s29,0
ds_read_b64_tr_b16 a[136:137],v2 offset:24704
v_fma_f32 v90,v90,s36,v15
v_mfma_f32_16x16x32_bf16 v[164:167],a[124:127],v[44:47],v[164:167]
ds_read_b64_tr_b16 a[138:139],v2 offset:30848
v_fma_f32 v91,v91,s36,v15
v_mfma_f32_16x16x32_bf16 v[212:215],a[124:127],v[48:51],v[212:215]
ds_read_b64_tr_b16 a[140:141],v3 offset:24704
v_fma_f32 v96,v96,s36,v16
v_mfma_f32_16x16x32_bf16 v[208:211],a[120:123],v[48:51],v[208:211]
ds_read_b64_tr_b16 a[142:143],v3 offset:30848
v_fma_f32 v97,v97,s36,v16
v_mfma_f32_16x16x32_bf16 v[112:115],a[120:123],v[52:55],v[112:115]
ds_read_b64_tr_b16 a[144:145],v4 offset:24704
v_fma_f32 v98,v98,s36,v16
v_mfma_f32_16x16x32_bf16 v[116:119],a[124:127],v[52:55],v[116:119]
ds_read_b64_tr_b16 a[146:147],v4 offset:30848
v_fma_f32 v99,v99,s36,v16
v_mfma_f32_16x16x32_bf16 a[164:167],a[124:127],v[56:59],a[164:167]
ds_read_b64_tr_b16 a[148:149],v5 offset:24704
v_fma_f32 v104,v104,s36,v17
v_mfma_f32_16x16x32_bf16 a[160:163],a[120:123],v[56:59],a[160:163]
buffer_load_dwordx4 v6,s[12:15],s28 offen offset:0 nt lds
v_mfma_f32_16x16x32_bf16 a[208:211],a[120:123],v[40:43],a[208:211]
ds_read_b64_tr_b16 a[150:151],v5 offset:30848
v_fma_f32 v105,v105,s36,v17
v_mfma_f32_16x16x32_bf16 a[212:215],a[124:127],v[40:43],a[212:215]
s_waitcnt lgkmcnt(5)
ds_read_b64_tr_b16 a[120:121],v2 offset:24832
v_fma_f32 v106,v106,s36,v17
v_mfma_f32_16x16x32_bf16 a[216:219],a[128:131],v[40:43],a[216:219]
ds_read_b64_tr_b16 a[122:123],v2 offset:30976
v_fma_f32 v107,v107,s36,v17
v_mfma_f32_16x16x32_bf16 a[220:223],a[132:135],v[40:43],a[220:223]
ds_read_b64_tr_b16 a[124:125],v3 offset:24832
v_fma_f32 v76,v76,s36,v13
v_mfma_f32_16x16x32_bf16 a[172:175],a[132:135],v[56:59],a[172:175]
ds_read_b64_tr_b16 a[126:127],v3 offset:30976
v_fma_f32 v77,v77,s36,v13
v_mfma_f32_16x16x32_bf16 a[168:171],a[128:131],v[56:59],a[168:171]
v_exp_f32 v90,v90
v_mfma_f32_16x16x32_bf16 v[120:123],a[128:131],v[52:55],v[120:123]
v_exp_f32 v91,v91
v_mfma_f32_16x16x32_bf16 v[124:127],a[132:135],v[52:55],v[124:127]
v_cvt_pk_bf16_f32 v29,v90,v91
v_fma_f32 v78,v78,s36,v13
v_mfma_f32_16x16x32_bf16 v[220:223],a[132:135],v[48:51],v[220:223]
v_exp_f32 v96,v96
v_mfma_f32_16x16x32_bf16 v[216:219],a[128:131],v[48:51],v[216:219]
buffer_load_dwordx4 v7,s[12:15],s28 offen offset:1024 nt lds
v_mfma_f32_16x16x32_bf16 v[168:171],a[128:131],v[44:47],v[168:171]
ds_read_b64_tr_b16 a[128:129],v4 offset:24832
v_fma_f32 v79,v79,s36,v13
v_mfma_f32_16x16x32_bf16 v[172:175],a[132:135],v[44:47],v[172:175]
ds_read_b64_tr_b16 a[130:131],v4 offset:30976
v_fma_f32 v84,v84,s36,v14
v_mfma_f32_16x16x32_bf16 v[176:179],a[136:139],v[44:47],v[176:179]
s_waitcnt lgkmcnt(2)
ds_read_b64_tr_b16 a[132:133],v5 offset:24832
v_fma_f32 v85,v85,s36,v14
v_mfma_f32_16x16x32_bf16 v[180:183],a[140:143],v[44:47],v[180:183]
ds_read_b64_tr_b16 a[134:135],v5 offset:30976
v_fma_f32 v86,v86,s36,v14
v_mfma_f32_16x16x32_bf16 v[228:231],a[140:143],v[48:51],v[228:231]
v_exp_f32 v97,v97
v_mfma_f32_16x16x32_bf16 v[224:227],a[136:139],v[48:51],v[224:227]
v_exp_f32 v98,v98
v_mfma_f32_16x16x32_bf16 v[128:131],a[136:139],v[52:55],v[128:131]
v_exp_f32 v99,v99
v_mfma_f32_16x16x32_bf16 v[132:135],a[140:143],v[52:55],v[132:135]
v_cvt_pk_bf16_f32 v32,v96,v97
v_cvt_pk_bf16_f32 v33,v98,v99
v_mfma_f32_16x16x32_bf16 a[180:183],a[140:143],v[56:59],a[180:183]
v_exp_f32 v104,v104
v_mfma_f32_16x16x32_bf16 a[176:179],a[136:139],v[56:59],a[176:179]
buffer_load_dwordx4 v8,s[12:15],s28 offen offset:2048 nt lds
v_mfma_f32_16x16x32_bf16 a[224:227],a[136:139],v[40:43],a[224:227]
s_add_u32 s28,s28,3072
v_exp_f32 v105,v105
v_mfma_f32_16x16x32_bf16 a[228:231],a[140:143],v[40:43],a[228:231]
s_add_u32 s29,s29,3072
v_exp_f32 v106,v106
v_mfma_f32_16x16x32_bf16 a[232:235],a[144:147],v[40:43],a[232:235]
s_add_u32 m0,s23,24576
v_exp_f32 v107,v107
v_mfma_f32_16x16x32_bf16 a[236:239],a[148:151],v[40:43],a[236:239]
v_cvt_pk_bf16_f32 v36,v104,v105
v_cvt_pk_bf16_f32 v37,v106,v107
v_mfma_f32_16x16x32_bf16 a[188:191],a[148:151],v[56:59],a[188:191]
v_exp_f32 v76,v76
v_mfma_f32_16x16x32_bf16 a[184:187],a[144:147],v[56:59],a[184:187]
v_exp_f32 v77,v77
v_mfma_f32_16x16x32_bf16 v[136:139],a[144:147],v[52:55],v[136:139]
v_exp_f32 v78,v78
v_mfma_f32_16x16x32_bf16 v[140:143],a[148:151],v[52:55],v[140:143]
v_exp_f32 v79,v79
v_mfma_f32_16x16x32_bf16 v[236:239],a[148:151],v[48:51],v[236:239]
v_cvt_pk_bf16_f32 v22,v76,v77
v_cvt_pk_bf16_f32 v23,v78,v79
v_mfma_f32_16x16x32_bf16 v[232:235],a[144:147],v[48:51],v[232:235]
v_fma_f32 v87,v87,s36,v14
v_fma_f32 v92,v92,s36,v15
v_mfma_f32_16x16x32_bf16 v[184:187],a[144:147],v[44:47],v[184:187]
v_exp_f32 v84,v84
v_mfma_f32_16x16x32_bf16 v[188:191],a[148:151],v[44:47],v[188:191]
v_exp_f32 v85,v85
v_mfma_f32_16x16x32_bf16 v[192:195],a[120:123],v[44:47],v[192:195]
v_exp_f32 v86,v86
v_mfma_f32_16x16x32_bf16 v[196:199],a[124:127],v[44:47],v[196:199]
s_waitcnt vmcnt(12) lgkmcnt(0)
v_exp_f32 v87,v87
v_mfma_f32_16x16x32_bf16 v[244:247],a[124:127],v[48:51],v[244:247]
s_barrier
v_mfma_f32_16x16x32_bf16 v[240:243],a[120:123],v[48:51],v[240:243]
ds_read_b128 a[136:139],v0 offset:12288
v_cvt_pk_bf16_f32 v26,v84,v85
v_mfma_f32_16x16x32_bf16 v[144:147],a[120:123],v[52:55],v[144:147]
ds_read_b128 a[140:143],v1 offset:12288
v_cvt_pk_bf16_f32 v27,v86,v87
v_mfma_f32_16x16x32_bf16 v[148:151],a[124:127],v[52:55],v[148:151]
ds_read_b128 a[144:147],v0 offset:12416
v_fma_f32 v93,v93,s36,v15
v_smfmac_f32_16x16x64_bf16 v[60:63],a[152:155],v[20:27],v18
ds_read_b128 a[148:151],v1 offset:12416
v_mfma_f32_16x16x32_bf16 a[196:199],a[124:127],v[56:59],a[196:199]
v_fma_f32 v94,v94,s36,v15
v_fma_f32 v95,v95,s36,v15
v_mfma_f32_16x16x32_bf16 a[192:195],a[120:123],v[56:59],a[192:195]
buffer_load_dwordx4 v6,s[8:11],s21 offen offset:0 lds
v_mfma_f32_16x16x32_bf16 a[240:243],a[120:123],v[40:43],a[240:243]
ds_read_b128 a[120:123],v0 offset:12544
v_fma_f32 v100,v100,s36,v16
v_mfma_f32_16x16x32_bf16 a[244:247],a[124:127],v[40:43],a[244:247]
ds_read_b128 a[124:127],v1 offset:12544
v_fma_f32 v101,v101,s36,v16
v_mfma_f32_16x16x32_bf16 a[248:251],a[128:131],v[40:43],a[248:251]
v_exp_f32 v92,v92
v_mfma_f32_16x16x32_bf16 a[252:255],a[132:135],v[40:43],a[252:255]
v_exp_f32 v93,v93
v_mfma_f32_16x16x32_bf16 a[204:207],a[132:135],v[56:59],a[204:207]
v_exp_f32 v94,v94
v_mfma_f32_16x16x32_bf16 a[200:203],a[128:131],v[56:59],a[200:203]
v_exp_f32 v95,v95
v_mfma_f32_16x16x32_bf16 v[152:155],a[128:131],v[52:55],v[152:155]
v_cvt_pk_bf16_f32 v30,v92,v93
v_cvt_pk_bf16_f32 v31,v94,v95
v_mfma_f32_16x16x32_bf16 v[156:159],a[132:135],v[52:55],v[156:159]
v_fma_f32 v102,v102,s36,v16
v_fma_f32 v103,v103,s36,v16
v_mfma_f32_16x16x32_bf16 v[252:255],a[132:135],v[48:51],v[252:255]
v_exp_f32 v100,v100
v_mfma_f32_16x16x32_bf16 v[248:251],a[128:131],v[48:51],v[248:251]
v_exp_f32 v101,v101
v_mfma_f32_16x16x32_bf16 v[200:203],a[128:131],v[44:47],v[200:203]
buffer_load_dwordx4 v7,s[8:11],s21 offen offset:1024 lds
v_mfma_f32_16x16x32_bf16 v[204:207],a[132:135],v[44:47],v[204:207]
s_waitcnt lgkmcnt(0)
ds_read_b128 a[128:131],v0 offset:18432
v_cvt_pk_bf16_f32 v34,v100,v101
v_mfma_f32_16x16x32_bf16 v[72:75],a[136:139],a[0:3],0
ds_read_b128 a[132:135],v1 offset:18432
v_fma_f32 v108,v108,s36,v17
v_mfma_f32_16x16x32_bf16 v[72:75],a[140:143],a[4:7],v[72:75]
v_exp_f32 v102,v102
v_mfma_f32_16x16x32_bf16 v[72:75],a[144:147],a[8:11],v[72:75]
v_exp_f32 v103,v103
v_mfma_f32_16x16x32_bf16 v[72:75],a[148:151],a[12:15],v[72:75]
v_cvt_pk_bf16_f32 v35,v102,v103
v_fma_f32 v109,v109,s36,v17
v_mfma_f32_16x16x32_bf16 v[72:75],a[120:123],a[16:19],v[72:75]
v_fma_f32 v110,v110,s36,v17
v_fma_f32 v111,v111,s36,v17
v_smfmac_f32_16x16x64_bf16 v[64:67],a[152:155],v[28:35],v18
v_mfma_f32_16x16x32_bf16 v[72:75],a[124:127],a[20:23],v[72:75]
v_exp_f32 v108,v108
v_mfma_f32_16x16x32_bf16 v[80:83],a[124:127],a[44:47],0
v_exp_f32 v109,v109
v_mfma_f32_16x16x32_bf16 v[80:83],a[120:123],a[40:43],v[80:83]
v_exp_f32 v110,v110
v_mfma_f32_16x16x32_bf16 v[80:83],a[148:151],a[36:39],v[80:83]
v_exp_f32 v111,v111
v_mfma_f32_16x16x32_bf16 v[80:83],a[144:147],a[32:35],v[80:83]
buffer_load_dwordx4 v8,s[8:11],s21 offen offset:2048 lds
v_mfma_f32_16x16x32_bf16 v[80:83],a[140:143],a[28:31],v[80:83]
s_add_u32 s21,s21,12288
v_cvt_pk_bf16_f32 v38,v108,v109
v_cvt_pk_bf16_f32 v39,v110,v111
v_mfma_f32_16x16x32_bf16 v[80:83],a[136:139],a[24:27],v[80:83]
s_add_u32 m0,s22,0
v_fma_f32 v72,v72,s36,v13
v_fma_f32 v73,v73,s36,v13
v_mfma_f32_16x16x32_bf16 v[88:91],a[136:139],a[48:51],0
v_fma_f32 v74,v74,s36,v13
v_fma_f32 v75,v75,s36,v13
v_mfma_f32_16x16x32_bf16 v[88:91],a[140:143],a[52:55],v[88:91]
v_exp_f32 v72,v72
v_mfma_f32_16x16x32_bf16 v[88:91],a[144:147],a[56:59],v[88:91]
v_fma_f32 v80,v80,s36,v14
v_fma_f32 v81,v81,s36,v14
v_mfma_f32_16x16x32_bf16 v[88:91],a[148:151],a[60:63],v[88:91]
v_fma_f32 v82,v82,s36,v14
v_fma_f32 v83,v83,s36,v14
v_mfma_f32_16x16x32_bf16 v[88:91],a[120:123],a[64:67],v[88:91]
v_exp_f32 v73,v73
v_mfma_f32_16x16x32_bf16 v[88:91],a[124:127],a[68:71],v[88:91]
v_exp_f32 v74,v74
v_mfma_f32_16x16x32_bf16 v[96:99],a[124:127],a[92:95],0
v_exp_f32 v75,v75
v_mfma_f32_16x16x32_bf16 v[96:99],a[120:123],a[88:91],v[96:99]
v_exp_f32 v80,v80
v_mfma_f32_16x16x32_bf16 v[96:99],a[148:151],a[84:87],v[96:99]
buffer_load_dwordx4 v6,s[4:7],s20 offen offset:0 lds
v_mfma_f32_16x16x32_bf16 v[96:99],a[144:147],a[80:83],v[96:99]
v_fma_f32 v88,v88,s36,v15
v_fma_f32 v89,v89,s36,v15
v_mfma_f32_16x16x32_bf16 v[96:99],a[140:143],a[76:79],v[96:99]
v_exp_f32 v81,v81
v_mfma_f32_16x16x32_bf16 v[96:99],a[136:139],a[72:75],v[96:99]
v_exp_f32 v82,v82
v_mfma_f32_16x16x32_bf16 v[104:107],a[136:139],a[96:99],0
ds_read_b128 a[136:139],v0 offset:18560
v_cvt_pk_bf16_f32 v44,v72,v73
v_mfma_f32_16x16x32_bf16 v[104:107],a[140:143],a[100:103],v[104:107]
ds_read_b128 a[140:143],v1 offset:18560
v_cvt_pk_bf16_f32 v45,v74,v75
v_mfma_f32_16x16x32_bf16 v[104:107],a[144:147],a[104:107],v[104:107]
ds_read_b128 a[144:147],v0 offset:18688
v_cvt_pk_bf16_f32 v48,v80,v81
v_mfma_f32_16x16x32_bf16 v[104:107],a[148:151],a[108:111],v[104:107]
ds_read_b128 a[148:151],v1 offset:18688
v_mfma_f32_16x16x32_bf16 v[104:107],a[120:123],a[112:115],v[104:107]
v_exp_f32 v83,v83
v_mfma_f32_16x16x32_bf16 v[104:107],a[124:127],a[116:119],v[104:107]
s_waitcnt lgkmcnt(4)
v_exp_f32 v88,v88
v_mfma_f32_16x16x32_bf16 v[76:79],a[128:131],a[0:3],0
v_exp_f32 v89,v89
v_mfma_f32_16x16x32_bf16 v[76:79],a[132:135],a[4:7],v[76:79]
buffer_load_dwordx4 v7,s[4:7],s20 offen offset:1024 lds
s_waitcnt lgkmcnt(3)
v_mfma_f32_16x16x32_bf16 v[76:79],a[136:139],a[8:11],v[76:79]
s_waitcnt lgkmcnt(2)
v_cvt_pk_bf16_f32 v49,v82,v83
v_cvt_pk_bf16_f32 v52,v88,v89
v_mfma_f32_16x16x32_bf16 v[76:79],a[140:143],a[12:15],v[76:79]
s_waitcnt lgkmcnt(0)
v_mfma_f32_16x16x32_bf16 v[76:79],a[144:147],a[16:19],v[76:79]
v_mfma_f32_16x16x32_bf16 v[76:79],a[148:151],a[20:23],v[76:79]
v_mfma_f32_16x16x32_bf16 v[84:87],a[148:151],a[44:47],0
v_mfma_f32_16x16x32_bf16 v[84:87],a[144:147],a[40:43],v[84:87]
v_mfma_f32_16x16x32_bf16 v[84:87],a[140:143],a[36:39],v[84:87]
v_mfma_f32_16x16x32_bf16 v[84:87],a[136:139],a[32:35],v[84:87]
v_mfma_f32_16x16x32_bf16 v[84:87],a[132:135],a[28:31],v[84:87]
v_mfma_f32_16x16x32_bf16 v[84:87],a[128:131],a[24:27],v[84:87]
v_mfma_f32_16x16x32_bf16 v[92:95],a[128:131],a[48:51],0
v_mfma_f32_16x16x32_bf16 v[92:95],a[132:135],a[52:55],v[92:95]
buffer_load_dwordx4 v8,s[4:7],s20 offen offset:2048 lds
v_mfma_f32_16x16x32_bf16 v[92:95],a[136:139],a[56:59],v[92:95]
s_add_u32 s20,s20,12288
v_mfma_f32_16x16x32_bf16 v[92:95],a[140:143],a[60:63],v[92:95]
v_mfma_f32_16x16x32_bf16 v[92:95],a[144:147],a[64:67],v[92:95]
v_mfma_f32_16x16x32_bf16 v[92:95],a[148:151],a[68:71],v[92:95]
v_mfma_f32_16x16x32_bf16 v[100:103],a[148:151],a[92:95],0
ds_read_b64_tr_b16 a[120:121],v2 offset:0
v_mfma_f32_16x16x32_bf16 v[100:103],a[144:147],a[88:91],v[100:103]
ds_read_b64_tr_b16 a[122:123],v2 offset:6144
v_mfma_f32_16x16x32_bf16 v[100:103],a[140:143],a[84:87],v[100:103]
v_mfma_f32_16x16x32_bf16 v[100:103],a[136:139],a[80:83],v[100:103]
ds_read_b64_tr_b16 a[124:125],v3 offset:0
v_mfma_f32_16x16x32_bf16 v[100:103],a[132:135],a[76:79],v[100:103]
ds_read_b64_tr_b16 a[126:127],v3 offset:6144
v_mfma_f32_16x16x32_bf16 v[100:103],a[128:131],a[72:75],v[100:103]
v_mfma_f32_16x16x32_bf16 v[108:111],a[128:131],a[96:99],0
ds_read_b64_tr_b16 a[128:129],v4 offset:0
v_mfma_f32_16x16x32_bf16 v[108:111],a[132:135],a[100:103],v[108:111]
ds_read_b64_tr_b16 a[130:131],v4 offset:6144
v_mfma_f32_16x16x32_bf16 v[108:111],a[136:139],a[104:107],v[108:111]
ds_read_b64_tr_b16 a[132:133],v5 offset:0
v_mfma_f32_16x16x32_bf16 v[108:111],a[140:143],a[108:111],v[108:111]
ds_read_b64_tr_b16 a[134:135],v5 offset:6144
v_mfma_f32_16x16x32_bf16 v[108:111],a[144:147],a[112:115],v[108:111]
v_mfma_f32_16x16x32_bf16 v[108:111],a[148:151],a[116:119],v[108:111]
s_waitcnt lgkmcnt(4)
v_mfma_f32_16x16x32_bf16 v[160:163],a[120:123],v[20:23],v[160:163]
s_add_u32 m0,s23,0
ds_read_b64_tr_b16 a[136:137],v2 offset:128
v_fma_f32 v91,v91,s36,v15
v_mfma_f32_16x16x32_bf16 v[164:167],a[124:127],v[20:23],v[164:167]
ds_read_b64_tr_b16 a[138:139],v2 offset:6272
v_fma_f32 v90,v90,s36,v15
v_mfma_f32_16x16x32_bf16 v[212:215],a[124:127],v[24:27],v[212:215]
ds_read_b64_tr_b16 a[140:141],v3 offset:128
v_fma_f32 v98,v98,s36,v16
v_mfma_f32_16x16x32_bf16 v[208:211],a[120:123],v[24:27],v[208:211]
ds_read_b64_tr_b16 a[142:143],v3 offset:6272
v_fma_f32 v96,v96,s36,v16
v_mfma_f32_16x16x32_bf16 v[112:115],a[120:123],v[28:31],v[112:115]
ds_read_b64_tr_b16 a[146:147],v4 offset:6272
v_fma_f32 v97,v97,s36,v16
v_mfma_f32_16x16x32_bf16 v[116:119],a[124:127],v[28:31],v[116:119]
ds_read_b64_tr_b16 a[150:151],v5 offset:6272
v_fma_f32 v99,v99,s36,v16
v_mfma_f32_16x16x32_bf16 a[164:167],a[124:127],v[32:35],a[164:167]
ds_read_b64_tr_b16 a[144:145],v4 offset:128
v_fma_f32 v107,v107,s36,v17
v_mfma_f32_16x16x32_bf16 a[160:163],a[120:123],v[32:35],a[160:163]
ds_read_b64_tr_b16 a[148:149],v5 offset:128
v_fma_f32 v104,v104,s36,v17
v_mfma_f32_16x16x32_bf16 a[208:211],a[120:123],v[36:39],a[208:211]
ds_read_b64_tr_b16 a[120:121],v2 offset:256
v_fma_f32 v105,v105,s36,v17
v_mfma_f32_16x16x32_bf16 a[212:215],a[124:127],v[36:39],a[212:215]
s_waitcnt lgkmcnt(6)
ds_read_b64_tr_b16 a[124:125],v3 offset:256
v_fma_f32 v106,v106,s36,v17
v_mfma_f32_16x16x32_bf16 a[216:219],a[128:131],v[36:39],a[216:219]
ds_read_b64_tr_b16 a[122:123],v2 offset:6400
v_fma_f32 v76,v76,s36,v13
v_mfma_f32_16x16x32_bf16 a[220:223],a[132:135],v[36:39],a[220:223]
ds_read_b64_tr_b16 a[126:127],v3 offset:6400
v_fma_f32 v79,v79,s36,v13
v_mfma_f32_16x16x32_bf16 a[172:175],a[132:135],v[32:35],a[172:175]
v_exp_f32 v91,v91
v_mfma_f32_16x16x32_bf16 a[168:171],a[128:131],v[32:35],a[168:171]
v_exp_f32 v90,v90
v_mfma_f32_16x16x32_bf16 v[120:123],a[128:131],v[28:31],v[120:123]
v_cvt_pk_bf16_f32 v53,v90,v91
v_fma_f32 v78,v78,s36,v13
v_mfma_f32_16x16x32_bf16 v[124:127],a[132:135],v[28:31],v[124:127]
v_exp_f32 v96,v96
v_mfma_f32_16x16x32_bf16 v[220:223],a[132:135],v[24:27],v[220:223]
v_exp_f32 v97,v97
v_mfma_f32_16x16x32_bf16 v[216:219],a[128:131],v[24:27],v[216:219]
v_exp_f32 v98,v98
v_mfma_f32_16x16x32_bf16 v[168:171],a[128:131],v[20:23],v[168:171]
ds_read_b64_tr_b16 a[128:129],v4 offset:256
v_cvt_pk_bf16_f32 v56,v96,v97
v_mfma_f32_16x16x32_bf16 v[172:175],a[132:135],v[20:23],v[172:175]
ds_read_b64_tr_b16 a[130:131],v4 offset:6400
v_fma_f32 v77,v77,s36,v13
v_mfma_f32_16x16x32_bf16 v[176:179],a[136:139],v[20:23],v[176:179]
s_waitcnt lgkmcnt(2)
ds_read_b64_tr_b16 a[132:133],v5 offset:256
v_fma_f32 v86,v86,s36,v14
v_mfma_f32_16x16x32_bf16 v[180:183],a[140:143],v[20:23],v[180:183]
ds_read_b64_tr_b16 a[134:135],v5 offset:6400
v_fma_f32 v85,v85,s36,v14
v_mfma_f32_16x16x32_bf16 v[228:231],a[140:143],v[24:27],v[228:231]
v_exp_f32 v99,v99
v_mfma_f32_16x16x32_bf16 v[224:227],a[136:139],v[24:27],v[224:227]
v_cvt_pk_bf16_f32 v57,v98,v99
v_fma_f32 v84,v84,s36,v14
v_mfma_f32_16x16x32_bf16 v[128:131],a[136:139],v[28:31],v[128:131]
v_exp_f32 v104,v104
v_mfma_f32_16x16x32_bf16 v[132:135],a[140:143],v[28:31],v[132:135]
v_exp_f32 v105,v105
v_mfma_f32_16x16x32_bf16 a[180:183],a[140:143],v[32:35],a[180:183]
v_exp_f32 v107,v107
v_mfma_f32_16x16x32_bf16 a[176:179],a[136:139],v[32:35],a[176:179]
v_exp_f32 v106,v106
v_mfma_f32_16x16x32_bf16 a[224:227],a[136:139],v[36:39],a[224:227]
v_cvt_pk_bf16_f32 v41,v106,v107
v_cvt_pk_bf16_f32 v40,v104,v105
v_mfma_f32_16x16x32_bf16 a[228:231],a[140:143],v[36:39],a[228:231]
v_exp_f32 v79,v79
v_mfma_f32_16x16x32_bf16 a[232:235],a[144:147],v[36:39],a[232:235]
v_exp_f32 v76,v76
v_mfma_f32_16x16x32_bf16 a[236:239],a[148:151],v[36:39],a[236:239]
v_exp_f32 v78,v78
v_mfma_f32_16x16x32_bf16 a[188:191],a[148:151],v[32:35],a[188:191]
v_exp_f32 v77,v77
v_mfma_f32_16x16x32_bf16 a[184:187],a[144:147],v[32:35],a[184:187]
v_cvt_pk_bf16_f32 v47,v78,v79
v_cvt_pk_bf16_f32 v46,v76,v77
v_mfma_f32_16x16x32_bf16 v[136:139],a[144:147],v[28:31],v[136:139]
v_exp_f32 v84,v84
v_mfma_f32_16x16x32_bf16 v[140:143],a[148:151],v[28:31],v[140:143]
v_exp_f32 v85,v85
v_mfma_f32_16x16x32_bf16 v[236:239],a[148:151],v[24:27],v[236:239]
v_exp_f32 v86,v86
v_mfma_f32_16x16x32_bf16 v[232:235],a[144:147],v[24:27],v[232:235]
v_fma_f32 v87,v87,s36,v14
v_cvt_pk_bf16_f32 v50,v84,v85
v_mfma_f32_16x16x32_bf16 v[184:187],a[144:147],v[20:23],v[184:187]
v_exp_f32 v87,v87
v_mfma_f32_16x16x32_bf16 v[188:191],a[148:151],v[20:23],v[188:191]
v_cvt_pk_bf16_f32 v51,v86,v87
v_fma_f32 v93,v93,s36,v15
v_mfma_f32_16x16x32_bf16 v[192:195],a[120:123],v[20:23],v[192:195]
v_exp_f32 v93,v93
v_smfmac_f32_16x16x64_bf16 v[60:63],a[152:155],v[44:51],v18
v_fma_f32 v94,v94,s36,v15
v_mfma_f32_16x16x32_bf16 v[196:199],a[124:127],v[20:23],v[196:199]
s_waitcnt vmcnt(9) lgkmcnt(0)
v_exp_f32 v94,v94
v_mfma_f32_16x16x32_bf16 v[244:247],a[124:127],v[24:27],v[244:247]
s_barrier
v_mfma_f32_16x16x32_bf16 v[240:243],a[120:123],v[24:27],v[240:243]
ds_read_b128 a[136:139],v0 offset:24576
v_fma_f32 v92,v92,s36,v15
v_mfma_f32_16x16x32_bf16 v[144:147],a[120:123],v[28:31],v[144:147]
ds_read_b128 a[140:143],v1 offset:24576
v_fma_f32 v95,v95,s36,v15
v_mfma_f32_16x16x32_bf16 v[148:151],a[124:127],v[28:31],v[148:151]
ds_read_b128 a[144:147],v0 offset:24704
v_fma_f32 v102,v102,s36,v16
v_mfma_f32_16x16x32_bf16 a[196:199],a[124:127],v[32:35],a[196:199]
ds_read_b128 a[148:151],v1 offset:24704
v_fma_f32 v103,v103,s36,v16
v_mfma_f32_16x16x32_bf16 a[192:195],a[120:123],v[32:35],a[192:195]
ds_read_b128 a[156:159],v10 offset:6144
v_fma_f32 v101,v101,s36,v16
v_mfma_f32_16x16x32_bf16 a[240:243],a[120:123],v[36:39],a[240:243]
buffer_load_dwordx4 v6,s[8:11],s21 offen offset:0 lds
v_mfma_f32_16x16x32_bf16 a[244:247],a[124:127],v[36:39],a[244:247]
ds_read_b128 a[120:123],v0 offset:24832
v_fma_f32 v100,v100,s36,v16
v_mfma_f32_16x16x32_bf16 a[248:251],a[128:131],v[36:39],a[248:251]
ds_read_b128 a[124:127],v1 offset:24832
v_fma_f32 v110,v110,s36,v17
v_mfma_f32_16x16x32_bf16 a[252:255],a[132:135],v[36:39],a[252:255]
v_exp_f32 v95,v95
v_mfma_f32_16x16x32_bf16 a[204:207],a[132:135],v[32:35],a[204:207]
v_exp_f32 v92,v92
v_mfma_f32_16x16x32_bf16 a[200:203],a[128:131],v[32:35],a[200:203]
v_cvt_pk_bf16_f32 v55,v94,v95
v_cvt_pk_bf16_f32 v54,v92,v93
v_mfma_f32_16x16x32_bf16 v[152:155],a[128:131],v[28:31],v[152:155]
v_exp_f32 v100,v100
v_mfma_f32_16x16x32_bf16 v[156:159],a[132:135],v[28:31],v[156:159]
v_exp_f32 v102,v102
v_mfma_f32_16x16x32_bf16 v[252:255],a[132:135],v[24:27],v[252:255]
v_exp_f32 v103,v103
v_mfma_f32_16x16x32_bf16 v[248:251],a[128:131],v[24:27],v[248:251]
v_exp_f32 v101,v101
v_mfma_f32_16x16x32_bf16 v[200:203],a[128:131],v[20:23],v[200:203]
ds_read_b128 a[128:131],v0 offset:30720
v_cvt_pk_bf16_f32 v59,v102,v103
v_mfma_f32_16x16x32_bf16 v[204:207],a[132:135],v[20:23],v[204:207]
s_waitcnt lgkmcnt(1)
buffer_store_dwordx4 a[156:159],v9,s[16:19],s27 offen offset:0 nt
buffer_load_dwordx4 v7,s[8:11],s21 offen offset:1024 lds
v_mfma_f32_16x16x32_bf16 v[72:75],a[136:139],a[0:3],0
ds_read_b128 a[132:135],v1 offset:30720
v_cvt_pk_bf16_f32 v58,v100,v101
v_mfma_f32_16x16x32_bf16 v[72:75],a[140:143],a[4:7],v[72:75]
v_exp_f32 v110,v110
v_smfmac_f32_16x16x64_bf16 v[64:67],a[152:155],v[52:59],v18
v_fma_f32 v111,v111,s36,v17
v_mfma_f32_16x16x32_bf16 v[72:75],a[144:147],a[8:11],v[72:75]
v_exp_f32 v111,v111
v_mfma_f32_16x16x32_bf16 v[72:75],a[148:151],a[12:15],v[72:75]
v_fma_f32 v108,v108,s36,v17
v_cvt_pk_bf16_f32 v43,v110,v111
v_mfma_f32_16x16x32_bf16 v[72:75],a[120:123],a[16:19],v[72:75]
ds_read_b128 a[156:159],v10 offset:7168
v_fma_f32 v109,v109,s36,v17
v_mfma_f32_16x16x32_bf16 v[72:75],a[124:127],a[20:23],v[72:75]
v_exp_f32 v108,v108
v_mfma_f32_16x16x32_bf16 v[80:83],a[124:127],a[44:47],0
v_exp_f32 v109,v109
v_mfma_f32_16x16x32_bf16 v[80:83],a[120:123],a[40:43],v[80:83]
v_cvt_pk_bf16_f32 v42,v108,v109
v_mfma_f32_16x16x32_bf16 v[80:83],a[148:151],a[36:39],v[80:83]
v_mfma_f32_16x16x32_bf16 v[80:83],a[144:147],a[32:35],v[80:83]
buffer_load_dwordx4 v8,s[8:11],s21 offen offset:2048 lds
v_smfmac_f32_16x16x64_bf16 v[68:71],a[152:155],v[36:43],v18
s_add_u32 s21,s21,12288
v_fma_f32 v75,v75,s36,v13
v_mfma_f32_16x16x32_bf16 v[80:83],a[140:143],a[28:31],v[80:83]
s_cmp_eq_u32 s38,1
v_exp_f32 v75,v75
v_mfma_f32_16x16x32_bf16 v[80:83],a[136:139],a[24:27],v[80:83]
s_cselect_b32 s20,s26,s20
v_fma_f32 v73,v73,s36,v13
v_fma_f32 v74,v74,s36,v13
v_mfma_f32_16x16x32_bf16 v[88:91],a[136:139],a[48:51],0
s_add_u32 m0,s22,12288
v_exp_f32 v73,v73
v_mfma_f32_16x16x32_bf16 v[88:91],a[140:143],a[52:55],v[88:91]
v_exp_f32 v74,v74
v_mfma_f32_16x16x32_bf16 v[88:91],a[144:147],a[56:59],v[88:91]
v_fma_f32 v82,v82,s36,v14
v_fma_f32 v81,v81,s36,v14
v_mfma_f32_16x16x32_bf16 v[88:91],a[148:151],a[60:63],v[88:91]
v_exp_f32 v81,v81
v_mfma_f32_16x16x32_bf16 v[88:91],a[120:123],a[64:67],v[88:91]
v_exp_f32 v82,v82
v_mfma_f32_16x16x32_bf16 v[88:91],a[124:127],a[68:71],v[88:91]
v_fma_f32 v72,v72,s36,v13
v_fma_f32 v80,v80,s36,v14
v_mfma_f32_16x16x32_bf16 v[96:99],a[124:127],a[92:95],0
v_exp_f32 v72,v72
v_mfma_f32_16x16x32_bf16 v[96:99],a[120:123],a[88:91],v[96:99]
s_waitcnt lgkmcnt(0)
buffer_store_dwordx4 a[156:159],v9,s[16:19],s27 offen offset:128 nt
buffer_load_dwordx4 v6,s[4:7],s20 offen offset:0 lds
v_mfma_f32_16x16x32_bf16 v[96:99],a[148:151],a[84:87],v[96:99]
v_exp_f32 v80,v80
v_mfma_f32_16x16x32_bf16 v[96:99],a[144:147],a[80:83],v[96:99]
v_fma_f32 v89,v89,s36,v15
v_fma_f32 v88,v88,s36,v15
v_mfma_f32_16x16x32_bf16 v[96:99],a[140:143],a[76:79],v[96:99]
v_exp_f32 v89,v89
v_mfma_f32_16x16x32_bf16 v[96:99],a[136:139],a[72:75],v[96:99]
v_exp_f32 v88,v88
v_mfma_f32_16x16x32_bf16 v[104:107],a[136:139],a[96:99],0
ds_read_b128 a[136:139],v0 offset:30848
v_fma_f32 v83,v83,s36,v14
v_mfma_f32_16x16x32_bf16 v[104:107],a[140:143],a[100:103],v[104:107]
ds_read_b128 a[156:159],v10 offset:8192
v_mfma_f32_16x16x32_bf16 v[104:107],a[144:147],a[104:107],v[104:107]
ds_read_b128 a[140:143],v1 offset:30848
v_mfma_f32_16x16x32_bf16 v[104:107],a[148:151],a[108:111],v[104:107]
ds_read_b128 a[144:147],v0 offset:30976
v_mfma_f32_16x16x32_bf16 v[104:107],a[120:123],a[112:115],v[104:107]
ds_read_b128 a[148:151],v1 offset:30976
v_mfma_f32_16x16x32_bf16 v[104:107],a[124:127],a[116:119],v[104:107]
v_exp_f32 v83,v83
v_mfma_f32_16x16x32_bf16 v[76:79],a[128:131],a[0:3],0
buffer_load_dwordx4 v7,s[4:7],s20 offen offset:1024 lds
v_mfma_f32_16x16x32_bf16 v[76:79],a[132:135],a[4:7],v[76:79]
s_waitcnt lgkmcnt(4)
v_cvt_pk_bf16_f32 v25,v82,v83
v_cvt_pk_bf16_f32 v20,v72,v73
v_mfma_f32_16x16x32_bf16 v[76:79],a[136:139],a[8:11],v[76:79]
s_waitcnt lgkmcnt(2)
v_cvt_pk_bf16_f32 v21,v74,v75
v_cvt_pk_bf16_f32 v24,v80,v81
v_cvt_pk_bf16_f32 v28,v88,v89
v_mfma_f32_16x16x32_bf16 v[76:79],a[140:143],a[12:15],v[76:79]
s_waitcnt lgkmcnt(1)
v_mfma_f32_16x16x32_bf16 v[76:79],a[144:147],a[16:19],v[76:79]
s_waitcnt lgkmcnt(0)
v_mfma_f32_16x16x32_bf16 v[76:79],a[148:151],a[20:23],v[76:79]
v_mfma_f32_16x16x32_bf16 v[84:87],a[148:151],a[44:47],0
v_mfma_f32_16x16x32_bf16 v[84:87],a[144:147],a[40:43],v[84:87]
v_mfma_f32_16x16x32_bf16 v[84:87],a[140:143],a[36:39],v[84:87]
v_mfma_f32_16x16x32_bf16 v[84:87],a[136:139],a[32:35],v[84:87]
v_mfma_f32_16x16x32_bf16 v[84:87],a[132:135],a[28:31],v[84:87]
buffer_store_dwordx4 a[156:159],v9,s[16:19],s27 offen offset:256 nt
buffer_load_dwordx4 v8,s[4:7],s20 offen offset:2048 lds
v_mfma_f32_16x16x32_bf16 v[84:87],a[128:131],a[24:27],v[84:87]
s_add_u32 s20,s20,12288
v_mfma_f32_16x16x32_bf16 v[92:95],a[128:131],a[48:51],0
s_add_u32 s27,s27,3072
v_mfma_f32_16x16x32_bf16 v[92:95],a[132:135],a[52:55],v[92:95]
v_mfma_f32_16x16x32_bf16 v[92:95],a[136:139],a[56:59],v[92:95]
v_mfma_f32_16x16x32_bf16 v[92:95],a[140:143],a[60:63],v[92:95]
ds_read_b64_tr_b16 a[120:121],v2 offset:12288
v_mfma_f32_16x16x32_bf16 v[92:95],a[144:147],a[64:67],v[92:95]
ds_read_b64_tr_b16 a[122:123],v2 offset:18432
v_mfma_f32_16x16x32_bf16 v[92:95],a[148:151],a[68:71],v[92:95]
v_mfma_f32_16x16x32_bf16 v[100:103],a[148:151],a[92:95],0
ds_read_b64_tr_b16 a[126:127],v3 offset:18432
v_mfma_f32_16x16x32_bf16 v[100:103],a[144:147],a[88:91],v[100:103]
ds_read_b64_tr_b16 a[124:125],v3 offset:12288
v_mfma_f32_16x16x32_bf16 v[100:103],a[140:143],a[84:87],v[100:103]
v_mfma_f32_16x16x32_bf16 v[100:103],a[136:139],a[80:83],v[100:103]
v_mfma_f32_16x16x32_bf16 v[100:103],a[132:135],a[76:79],v[100:103]
v_mfma_f32_16x16x32_bf16 v[100:103],a[128:131],a[72:75],v[100:103]
v_mfma_f32_16x16x32_bf16 v[108:111],a[128:131],a[96:99],0
ds_read_b64_tr_b16 a[130:131],v4 offset:18432
v_mfma_f32_16x16x32_bf16 v[108:111],a[132:135],a[100:103],v[108:111]
ds_read_b64_tr_b16 a[128:129],v4 offset:12288
v_mfma_f32_16x16x32_bf16 v[108:111],a[136:139],a[104:107],v[108:111]
ds_read_b64_tr_b16 a[132:133],v5 offset:12288
v_mfma_f32_16x16x32_bf16 v[108:111],a[140:143],a[108:111],v[108:111]
ds_read_b64_tr_b16 a[134:135],v5 offset:18432
v_mfma_f32_16x16x32_bf16 v[108:111],a[144:147],a[112:115],v[108:111]
v_mfma_f32_16x16x32_bf16 v[108:111],a[148:151],a[116:119],v[108:111]
s_waitcnt lgkmcnt(4)
v_mfma_f32_16x16x32_bf16 v[160:163],a[120:123],v[44:47],v[160:163]
s_add_u32 m0,s29,0
ds_read_b64_tr_b16 a[136:137],v2 offset:12416
v_fma_f32 v90,v90,s36,v15
v_mfma_f32_16x16x32_bf16 v[164:167],a[124:127],v[44:47],v[164:167]
ds_read_b64_tr_b16 a[138:139],v2 offset:18560
v_fma_f32 v91,v91,s36,v15
v_mfma_f32_16x16x32_bf16 v[212:215],a[124:127],v[48:51],v[212:215]
ds_read_b64_tr_b16 a[140:141],v3 offset:12416
v_fma_f32 v96,v96,s36,v16
v_mfma_f32_16x16x32_bf16 v[208:211],a[120:123],v[48:51],v[208:211]
ds_read_b64_tr_b16 a[142:143],v3 offset:18560
v_fma_f32 v97,v97,s36,v16
v_mfma_f32_16x16x32_bf16 v[112:115],a[120:123],v[52:55],v[112:115]
ds_read_b64_tr_b16 a[144:145],v4 offset:12416
v_fma_f32 v98,v98,s36,v16
v_mfma_f32_16x16x32_bf16 v[116:119],a[124:127],v[52:55],v[116:119]
ds_read_b64_tr_b16 a[146:147],v4 offset:18560
v_fma_f32 v99,v99,s36,v16
v_mfma_f32_16x16x32_bf16 a[164:167],a[124:127],v[56:59],a[164:167]
ds_read_b64_tr_b16 a[148:149],v5 offset:12416
v_fma_f32 v104,v104,s36,v17
v_mfma_f32_16x16x32_bf16 a[160:163],a[120:123],v[56:59],a[160:163]
buffer_load_dwordx4 v6,s[12:15],s28 offen offset:0 nt lds
v_mfma_f32_16x16x32_bf16 a[208:211],a[120:123],v[40:43],a[208:211]
ds_read_b64_tr_b16 a[150:151],v5 offset:18560
v_fma_f32 v105,v105,s36,v17
v_mfma_f32_16x16x32_bf16 a[212:215],a[124:127],v[40:43],a[212:215]
s_waitcnt lgkmcnt(5)
ds_read_b64_tr_b16 a[120:121],v2 offset:12544
v_fma_f32 v106,v106,s36,v17
v_mfma_f32_16x16x32_bf16 a[216:219],a[128:131],v[40:43],a[216:219]
ds_read_b64_tr_b16 a[122:123],v2 offset:18688
v_fma_f32 v107,v107,s36,v17
v_mfma_f32_16x16x32_bf16 a[220:223],a[132:135],v[40:43],a[220:223]
ds_read_b64_tr_b16 a[124:125],v3 offset:12544
v_fma_f32 v76,v76,s36,v13
v_mfma_f32_16x16x32_bf16 a[172:175],a[132:135],v[56:59],a[172:175]
ds_read_b64_tr_b16 a[126:127],v3 offset:18688
v_fma_f32 v77,v77,s36,v13
v_mfma_f32_16x16x32_bf16 a[168:171],a[128:131],v[56:59],a[168:171]
v_exp_f32 v90,v90
v_mfma_f32_16x16x32_bf16 v[120:123],a[128:131],v[52:55],v[120:123]
v_exp_f32 v91,v91
v_mfma_f32_16x16x32_bf16 v[124:127],a[132:135],v[52:55],v[124:127]
v_cvt_pk_bf16_f32 v29,v90,v91
v_fma_f32 v78,v78,s36,v13
v_mfma_f32_16x16x32_bf16 v[220:223],a[132:135],v[48:51],v[220:223]
v_exp_f32 v96,v96
v_mfma_f32_16x16x32_bf16 v[216:219],a[128:131],v[48:51],v[216:219]
buffer_load_dwordx4 v7,s[12:15],s28 offen offset:1024 nt lds
v_mfma_f32_16x16x32_bf16 v[168:171],a[128:131],v[44:47],v[168:171]
ds_read_b64_tr_b16 a[128:129],v4 offset:12544
v_fma_f32 v79,v79,s36,v13
v_mfma_f32_16x16x32_bf16 v[172:175],a[132:135],v[44:47],v[172:175]
ds_read_b64_tr_b16 a[130:131],v4 offset:18688
v_fma_f32 v84,v84,s36,v14
v_mfma_f32_16x16x32_bf16 v[176:179],a[136:139],v[44:47],v[176:179]
s_waitcnt lgkmcnt(2)
ds_read_b64_tr_b16 a[132:133],v5 offset:12544
v_fma_f32 v85,v85,s36,v14
v_mfma_f32_16x16x32_bf16 v[180:183],a[140:143],v[44:47],v[180:183]
ds_read_b64_tr_b16 a[134:135],v5 offset:18688
v_fma_f32 v86,v86,s36,v14
v_mfma_f32_16x16x32_bf16 v[228:231],a[140:143],v[48:51],v[228:231]
v_exp_f32 v97,v97
v_mfma_f32_16x16x32_bf16 v[224:227],a[136:139],v[48:51],v[224:227]
v_exp_f32 v98,v98
v_mfma_f32_16x16x32_bf16 v[128:131],a[136:139],v[52:55],v[128:131]
v_exp_f32 v99,v99
v_mfma_f32_16x16x32_bf16 v[132:135],a[140:143],v[52:55],v[132:135]
v_cvt_pk_bf16_f32 v32,v96,v97
v_cvt_pk_bf16_f32 v33,v98,v99
v_mfma_f32_16x16x32_bf16 a[180:183],a[140:143],v[56:59],a[180:183]
v_exp_f32 v104,v104
v_mfma_f32_16x16x32_bf16 a[176:179],a[136:139],v[56:59],a[176:179]
buffer_load_dwordx4 v8,s[12:15],s28 offen offset:2048 nt lds
v_mfma_f32_16x16x32_bf16 a[224:227],a[136:139],v[40:43],a[224:227]
s_add_u32 s28,s28,3072
v_exp_f32 v105,v105
v_mfma_f32_16x16x32_bf16 a[228:231],a[140:143],v[40:43],a[228:231]
s_add_u32 s29,s29,3072
v_exp_f32 v106,v106
v_mfma_f32_16x16x32_bf16 a[232:235],a[144:147],v[40:43],a[232:235]
s_cmp_eq_u32 s38,1
v_exp_f32 v107,v107
v_mfma_f32_16x16x32_bf16 a[236:239],a[148:151],v[40:43],a[236:239]
s_cselect_b32 s21,s26,s21
v_cvt_pk_bf16_f32 v36,v104,v105
v_cvt_pk_bf16_f32 v37,v106,v107
v_mfma_f32_16x16x32_bf16 a[188:191],a[148:151],v[56:59],a[188:191]
s_add_u32 m0,s23,12288
v_exp_f32 v76,v76
v_mfma_f32_16x16x32_bf16 a[184:187],a[144:147],v[56:59],a[184:187]
v_exp_f32 v77,v77
v_mfma_f32_16x16x32_bf16 v[136:139],a[144:147],v[52:55],v[136:139]
v_exp_f32 v78,v78
v_mfma_f32_16x16x32_bf16 v[140:143],a[148:151],v[52:55],v[140:143]
v_exp_f32 v79,v79
v_mfma_f32_16x16x32_bf16 v[236:239],a[148:151],v[48:51],v[236:239]
v_cvt_pk_bf16_f32 v22,v76,v77
v_cvt_pk_bf16_f32 v23,v78,v79
v_mfma_f32_16x16x32_bf16 v[232:235],a[144:147],v[48:51],v[232:235]
v_fma_f32 v87,v87,s36,v14
v_fma_f32 v92,v92,s36,v15
v_mfma_f32_16x16x32_bf16 v[184:187],a[144:147],v[44:47],v[184:187]
v_exp_f32 v84,v84
v_mfma_f32_16x16x32_bf16 v[188:191],a[148:151],v[44:47],v[188:191]
v_exp_f32 v85,v85
v_mfma_f32_16x16x32_bf16 v[192:195],a[120:123],v[44:47],v[192:195]
v_exp_f32 v86,v86
v_mfma_f32_16x16x32_bf16 v[196:199],a[124:127],v[44:47],v[196:199]
s_waitcnt vmcnt(12) lgkmcnt(0)
v_exp_f32 v87,v87
v_mfma_f32_16x16x32_bf16 v[244:247],a[124:127],v[48:51],v[244:247]
s_barrier
v_mfma_f32_16x16x32_bf16 v[240:243],a[120:123],v[48:51],v[240:243]
ds_read_b128 a[136:139],v0 offset:0
v_cvt_pk_bf16_f32 v26,v84,v85
v_mfma_f32_16x16x32_bf16 v[144:147],a[120:123],v[52:55],v[144:147]
ds_read_b128 a[140:143],v1 offset:0
v_cvt_pk_bf16_f32 v27,v86,v87
v_mfma_f32_16x16x32_bf16 v[148:151],a[124:127],v[52:55],v[148:151]
ds_read_b128 a[144:147],v0 offset:128
v_fma_f32 v93,v93,s36,v15
v_smfmac_f32_16x16x64_bf16 v[60:63],a[152:155],v[20:27],v18
ds_read_b128 a[148:151],v1 offset:128
v_mfma_f32_16x16x32_bf16 a[196:199],a[124:127],v[56:59],a[196:199]
v_fma_f32 v94,v94,s36,v15
v_fma_f32 v95,v95,s36,v15
v_mfma_f32_16x16x32_bf16 a[192:195],a[120:123],v[56:59],a[192:195]
buffer_load_dwordx4 v6,s[8:11],s21 offen offset:0 lds
v_mfma_f32_16x16x32_bf16 a[240:243],a[120:123],v[40:43],a[240:243]
ds_read_b128 a[120:123],v0 offset:256
v_fma_f32 v100,v100,s36,v16
v_mfma_f32_16x16x32_bf16 a[244:247],a[124:127],v[40:43],a[244:247]
ds_read_b128 a[124:127],v1 offset:256
v_fma_f32 v101,v101,s36,v16
v_mfma_f32_16x16x32_bf16 a[248:251],a[128:131],v[40:43],a[248:251]
v_exp_f32 v92,v92
v_mfma_f32_16x16x32_bf16 a[252:255],a[132:135],v[40:43],a[252:255]
v_exp_f32 v93,v93
v_mfma_f32_16x16x32_bf16 a[204:207],a[132:135],v[56:59],a[204:207]
v_exp_f32 v94,v94
v_mfma_f32_16x16x32_bf16 a[200:203],a[128:131],v[56:59],a[200:203]
v_exp_f32 v95,v95
v_mfma_f32_16x16x32_bf16 v[152:155],a[128:131],v[52:55],v[152:155]
v_cvt_pk_bf16_f32 v30,v92,v93
v_cvt_pk_bf16_f32 v31,v94,v95
v_mfma_f32_16x16x32_bf16 v[156:159],a[132:135],v[52:55],v[156:159]
v_fma_f32 v102,v102,s36,v16
v_fma_f32 v103,v103,s36,v16
v_mfma_f32_16x16x32_bf16 v[252:255],a[132:135],v[48:51],v[252:255]
v_exp_f32 v100,v100
v_mfma_f32_16x16x32_bf16 v[248:251],a[128:131],v[48:51],v[248:251]
v_exp_f32 v101,v101
v_mfma_f32_16x16x32_bf16 v[200:203],a[128:131],v[44:47],v[200:203]
buffer_load_dwordx4 v7,s[8:11],s21 offen offset:1024 lds
v_mfma_f32_16x16x32_bf16 v[204:207],a[132:135],v[44:47],v[204:207]
s_waitcnt lgkmcnt(0)
ds_read_b128 a[128:131],v0 offset:6144
v_cvt_pk_bf16_f32 v34,v100,v101
v_mfma_f32_16x16x32_bf16 v[72:75],a[136:139],a[0:3],0
ds_read_b128 a[132:135],v1 offset:6144
v_fma_f32 v108,v108,s36,v17
v_mfma_f32_16x16x32_bf16 v[72:75],a[140:143],a[4:7],v[72:75]
v_exp_f32 v102,v102
v_mfma_f32_16x16x32_bf16 v[72:75],a[144:147],a[8:11],v[72:75]
v_exp_f32 v103,v103
v_mfma_f32_16x16x32_bf16 v[72:75],a[148:151],a[12:15],v[72:75]
v_cvt_pk_bf16_f32 v35,v102,v103
v_fma_f32 v109,v109,s36,v17
v_mfma_f32_16x16x32_bf16 v[72:75],a[120:123],a[16:19],v[72:75]
v_fma_f32 v110,v110,s36,v17
v_fma_f32 v111,v111,s36,v17
v_smfmac_f32_16x16x64_bf16 v[64:67],a[152:155],v[28:35],v18
v_add_u32 v10,9216,v10
v_mfma_f32_16x16x32_bf16 v[72:75],a[124:127],a[20:23],v[72:75]
v_exp_f32 v108,v108
v_mfma_f32_16x16x32_bf16 v[80:83],a[124:127],a[44:47],0
v_exp_f32 v109,v109
v_mfma_f32_16x16x32_bf16 v[80:83],a[120:123],a[40:43],v[80:83]
v_exp_f32 v110,v110
v_mfma_f32_16x16x32_bf16 v[80:83],a[148:151],a[36:39],v[80:83]
v_exp_f32 v111,v111
v_mfma_f32_16x16x32_bf16 v[80:83],a[144:147],a[32:35],v[80:83]
buffer_load_dwordx4 v8,s[8:11],s21 offen offset:2048 lds
v_mfma_f32_16x16x32_bf16 v[80:83],a[140:143],a[28:31],v[80:83]
s_add_u32 s21,s21,12288
v_cvt_pk_bf16_f32 v38,v108,v109
v_cvt_pk_bf16_f32 v39,v110,v111
v_mfma_f32_16x16x32_bf16 v[80:83],a[136:139],a[24:27],v[80:83]
s_add_u32 m0,s22,24576
v_fma_f32 v72,v72,s36,v13
v_fma_f32 v73,v73,s36,v13
v_mfma_f32_16x16x32_bf16 v[88:91],a[136:139],a[48:51],0
v_fma_f32 v74,v74,s36,v13
v_fma_f32 v75,v75,s36,v13
v_mfma_f32_16x16x32_bf16 v[88:91],a[140:143],a[52:55],v[88:91]
v_exp_f32 v72,v72
v_mfma_f32_16x16x32_bf16 v[88:91],a[144:147],a[56:59],v[88:91]
v_fma_f32 v80,v80,s36,v14
v_fma_f32 v81,v81,s36,v14
v_mfma_f32_16x16x32_bf16 v[88:91],a[148:151],a[60:63],v[88:91]
v_fma_f32 v82,v82,s36,v14
v_fma_f32 v83,v83,s36,v14
v_mfma_f32_16x16x32_bf16 v[88:91],a[120:123],a[64:67],v[88:91]
v_exp_f32 v73,v73
v_mfma_f32_16x16x32_bf16 v[88:91],a[124:127],a[68:71],v[88:91]
v_exp_f32 v74,v74
v_mfma_f32_16x16x32_bf16 v[96:99],a[124:127],a[92:95],0
v_exp_f32 v75,v75
v_mfma_f32_16x16x32_bf16 v[96:99],a[120:123],a[88:91],v[96:99]
v_exp_f32 v80,v80
v_mfma_f32_16x16x32_bf16 v[96:99],a[148:151],a[84:87],v[96:99]
buffer_load_dwordx4 v6,s[4:7],s20 offen offset:0 lds
v_mfma_f32_16x16x32_bf16 v[96:99],a[144:147],a[80:83],v[96:99]
v_fma_f32 v88,v88,s36,v15
v_fma_f32 v89,v89,s36,v15
v_mfma_f32_16x16x32_bf16 v[96:99],a[140:143],a[76:79],v[96:99]
v_exp_f32 v81,v81
v_mfma_f32_16x16x32_bf16 v[96:99],a[136:139],a[72:75],v[96:99]
v_exp_f32 v82,v82
v_mfma_f32_16x16x32_bf16 v[104:107],a[136:139],a[96:99],0
ds_read_b128 a[136:139],v0 offset:6272
v_cvt_pk_bf16_f32 v44,v72,v73
v_mfma_f32_16x16x32_bf16 v[104:107],a[140:143],a[100:103],v[104:107]
ds_read_b128 a[140:143],v1 offset:6272
v_cvt_pk_bf16_f32 v45,v74,v75
v_mfma_f32_16x16x32_bf16 v[104:107],a[144:147],a[104:107],v[104:107]
ds_read_b128 a[144:147],v0 offset:6400
v_cvt_pk_bf16_f32 v48,v80,v81
v_mfma_f32_16x16x32_bf16 v[104:107],a[148:151],a[108:111],v[104:107]
ds_read_b128 a[148:151],v1 offset:6400
v_mfma_f32_16x16x32_bf16 v[104:107],a[120:123],a[112:115],v[104:107]
v_exp_f32 v83,v83
v_mfma_f32_16x16x32_bf16 v[104:107],a[124:127],a[116:119],v[104:107]
s_waitcnt lgkmcnt(4)
v_exp_f32 v88,v88
v_mfma_f32_16x16x32_bf16 v[76:79],a[128:131],a[0:3],0
v_exp_f32 v89,v89
v_mfma_f32_16x16x32_bf16 v[76:79],a[132:135],a[4:7],v[76:79]
buffer_load_dwordx4 v7,s[4:7],s20 offen offset:1024 lds
s_waitcnt lgkmcnt(3)
v_mfma_f32_16x16x32_bf16 v[76:79],a[136:139],a[8:11],v[76:79]
s_waitcnt lgkmcnt(2)
v_cvt_pk_bf16_f32 v49,v82,v83
v_cvt_pk_bf16_f32 v52,v88,v89
v_mfma_f32_16x16x32_bf16 v[76:79],a[140:143],a[12:15],v[76:79]
s_waitcnt lgkmcnt(0)
v_mfma_f32_16x16x32_bf16 v[76:79],a[144:147],a[16:19],v[76:79]
v_mfma_f32_16x16x32_bf16 v[76:79],a[148:151],a[20:23],v[76:79]
v_mfma_f32_16x16x32_bf16 v[84:87],a[148:151],a[44:47],0
v_mfma_f32_16x16x32_bf16 v[84:87],a[144:147],a[40:43],v[84:87]
v_mfma_f32_16x16x32_bf16 v[84:87],a[140:143],a[36:39],v[84:87]
v_mfma_f32_16x16x32_bf16 v[84:87],a[136:139],a[32:35],v[84:87]
v_mfma_f32_16x16x32_bf16 v[84:87],a[132:135],a[28:31],v[84:87]
v_mfma_f32_16x16x32_bf16 v[84:87],a[128:131],a[24:27],v[84:87]
v_mfma_f32_16x16x32_bf16 v[92:95],a[128:131],a[48:51],0
v_mfma_f32_16x16x32_bf16 v[92:95],a[132:135],a[52:55],v[92:95]
buffer_load_dwordx4 v8,s[4:7],s20 offen offset:2048 lds
v_mfma_f32_16x16x32_bf16 v[92:95],a[136:139],a[56:59],v[92:95]
s_add_u32 s20,s20,12288
s_add_u32 s38,s38,1
s_cmp_lt_u32 s38,2
v_mfma_f32_16x16x32_bf16 v[92:95],a[140:143],a[60:63],v[92:95]
v_mfma_f32_16x16x32_bf16 v[92:95],a[144:147],a[64:67],v[92:95]
v_mfma_f32_16x16x32_bf16 v[92:95],a[148:151],a[68:71],v[92:95]
v_mfma_f32_16x16x32_bf16 v[100:103],a[148:151],a[92:95],0
ds_read_b64_tr_b16 a[120:121],v2 offset:24576
v_mfma_f32_16x16x32_bf16 v[100:103],a[144:147],a[88:91],v[100:103]
ds_read_b64_tr_b16 a[122:123],v2 offset:30720
v_mfma_f32_16x16x32_bf16 v[100:103],a[140:143],a[84:87],v[100:103]
v_mfma_f32_16x16x32_bf16 v[100:103],a[136:139],a[80:83],v[100:103]
ds_read_b64_tr_b16 a[124:125],v3 offset:24576
v_mfma_f32_16x16x32_bf16 v[100:103],a[132:135],a[76:79],v[100:103]
ds_read_b64_tr_b16 a[126:127],v3 offset:30720
v_mfma_f32_16x16x32_bf16 v[100:103],a[128:131],a[72:75],v[100:103]
v_mfma_f32_16x16x32_bf16 v[108:111],a[128:131],a[96:99],0
ds_read_b64_tr_b16 a[128:129],v4 offset:24576
v_mfma_f32_16x16x32_bf16 v[108:111],a[132:135],a[100:103],v[108:111]
ds_read_b64_tr_b16 a[130:131],v4 offset:30720
v_mfma_f32_16x16x32_bf16 v[108:111],a[136:139],a[104:107],v[108:111]
ds_read_b64_tr_b16 a[132:133],v5 offset:24576
v_mfma_f32_16x16x32_bf16 v[108:111],a[140:143],a[108:111],v[108:111]
ds_read_b64_tr_b16 a[134:135],v5 offset:30720
v_mfma_f32_16x16x32_bf16 v[108:111],a[144:147],a[112:115],v[108:111]
v_mfma_f32_16x16x32_bf16 v[108:111],a[148:151],a[116:119],v[108:111]
s_cbranch_scc1 L_loop5w0
s_cmp_ge_u32 s69,6
s_cbranch_scc1 L_end5
s_cmp_eq_u32 s40,0
s_cbranch_scc1 L_tr54
s_branch L_tr55
L_tr54:
s_waitcnt vmcnt(42)
s_waitcnt lgkmcnt(3)
v_mfma_f32_16x16x32_bf16 v[160:163],a[120:123],v[20:23],v[160:163]
s_add_u32 m0,s24,0
ds_read_b128 a[12:15],v12 offset:128
v_fma_f32 v101,v101,s36,v16
v_mfma_f32_16x16x32_bf16 v[164:167],a[124:127],v[20:23],v[164:167]
ds_read_b128 a[20:23],v12 offset:256
v_fma_f32 v103,v103,s36,v16
v_mfma_f32_16x16x32_bf16 v[212:215],a[124:127],v[24:27],v[212:215]
ds_read_b128 a[4:7],v12 offset:0
v_fma_f32 v87,v87,s36,v14
v_mfma_f32_16x16x32_bf16 v[208:211],a[120:123],v[24:27],v[208:211]
ds_read_b128 a[16:19],v11 offset:256
v_fma_f32 v106,v106,s36,v17
v_mfma_f32_16x16x32_bf16 v[112:115],a[120:123],v[28:31],v[112:115]
ds_read_b128 a[0:3],v11 offset:0
v_fma_f32 v99,v99,s36,v16
v_mfma_f32_16x16x32_bf16 v[116:119],a[124:127],v[28:31],v[116:119]
ds_read_b128 a[8:11],v11 offset:128
v_fma_f32 v96,v96,s36,v16
v_mfma_f32_16x16x32_bf16 a[164:167],a[124:127],v[32:35],a[164:167]
ds_read_b64_tr_b16 a[136:137],v2 offset:24704
v_fma_f32 v77,v77,s36,v13
v_mfma_f32_16x16x32_bf16 a[160:163],a[120:123],v[32:35],a[160:163]
ds_read_b64_tr_b16 a[138:139],v2 offset:30848
v_fma_f32 v85,v85,s36,v14
v_mfma_f32_16x16x32_bf16 a[208:211],a[120:123],v[36:39],a[208:211]
ds_read_b64_tr_b16 a[140:141],v3 offset:24704
ds_read_b64_tr_b16 a[142:143],v3 offset:30848
ds_read_b64_tr_b16 a[144:145],v4 offset:24704
ds_read_b64_tr_b16 a[146:147],v4 offset:30848
ds_read_b64_tr_b16 a[150:151],v5 offset:30848
ds_read_b64_tr_b16 a[148:149],v5 offset:24704
ds_read_b128 a[40:43],v11 offset:6400
v_mfma_f32_16x16x32_bf16 a[212:215],a[124:127],v[36:39],a[212:215]
s_waitcnt lgkmcnt(11)
v_fma_f32 v84,v84,s36,v14
ds_read_b128 a[32:35],v11 offset:6272
v_mfma_f32_16x16x32_bf16 a[216:219],a[128:131],v[36:39],a[216:219]
s_waitcnt lgkmcnt(10)
buffer_load_dwordx4 v6,s[12:15],s28 offen offset:0 nt lds
v_mfma_f32_16x16x32_bf16 a[220:223],a[132:135],v[36:39],a[220:223]
ds_read_b64_tr_b16 a[122:123],v2 offset:30976
ds_read_b128 a[44:47],v12 offset:6400
v_mfma_f32_16x16x32_bf16 a[172:175],a[132:135],v[32:35],a[172:175]
v_exp_f32 v101,v101
ds_read_b64_tr_b16 a[120:121],v2 offset:24832
ds_read_b128 a[24:27],v11 offset:6144
v_mfma_f32_16x16x32_bf16 a[168:171],a[128:131],v[32:35],a[168:171]
v_exp_f32 v77,v77
ds_read_b128 a[28:31],v12 offset:6144
v_mfma_f32_16x16x32_bf16 v[120:123],a[128:131],v[28:31],v[120:123]
v_fma_f32 v111,v111,s36,v17
ds_read_b64_tr_b16 a[126:127],v3 offset:30976
ds_read_b64_tr_b16 a[124:125],v3 offset:24832
ds_read_b128 a[36:39],v12 offset:6272
v_mfma_f32_16x16x32_bf16 v[124:127],a[132:135],v[28:31],v[124:127]
buffer_load_dwordx4 v7,s[12:15],s28 offen offset:1024 nt lds
v_mfma_f32_16x16x32_bf16 v[220:223],a[132:135],v[24:27],v[220:223]
v_fma_f32 v95,v95,s36,v15
v_fma_f32 v100,v100,s36,v16
v_mfma_f32_16x16x32_bf16 v[216:219],a[128:131],v[24:27],v[216:219]
v_exp_f32 v106,v106
v_mfma_f32_16x16x32_bf16 v[168:171],a[128:131],v[20:23],v[168:171]
ds_read_b64_tr_b16 a[130:131],v4 offset:30976
v_fma_f32 v93,v93,s36,v15
v_mfma_f32_16x16x32_bf16 v[172:175],a[132:135],v[20:23],v[172:175]
s_waitcnt lgkmcnt(4)
ds_read_b64_tr_b16 a[128:129],v4 offset:24832
v_exp_f32 v111,v111
v_mfma_f32_16x16x32_bf16 v[176:179],a[136:139],v[20:23],v[176:179]
ds_read_b64_tr_b16 a[132:133],v5 offset:24832
buffer_load_dwordx4 v8,s[12:15],s28 offen offset:2048 nt lds
v_mfma_f32_16x16x32_bf16 v[180:183],a[140:143],v[20:23],v[180:183]
s_add_u32 s28,s28,3072
ds_read_b64_tr_b16 a[134:135],v5 offset:30976
v_fma_f32 v107,v107,s36,v17
v_mfma_f32_16x16x32_bf16 v[228:231],a[140:143],v[24:27],v[228:231]
s_add_u32 m0,s24,3072
v_fma_f32 v92,v92,s36,v15
v_exp_f32 v92,v92
v_mfma_f32_16x16x32_bf16 v[224:227],a[136:139],v[24:27],v[224:227]
v_fma_f32 v109,v109,s36,v17
v_exp_f32 v109,v109
v_mfma_f32_16x16x32_bf16 v[128:131],a[136:139],v[28:31],v[128:131]
v_fma_f32 v97,v97,s36,v16
v_exp_f32 v84,v84
v_mfma_f32_16x16x32_bf16 v[132:135],a[140:143],v[28:31],v[132:135]
v_fma_f32 v94,v94,s36,v15
v_exp_f32 v94,v94
v_mfma_f32_16x16x32_bf16 a[180:183],a[140:143],v[32:35],a[180:183]
v_fma_f32 v104,v104,s36,v17
v_fma_f32 v90,v90,s36,v15
v_mfma_f32_16x16x32_bf16 a[176:179],a[136:139],v[32:35],a[176:179]
buffer_load_dwordx4 v6,s[12:15],s28 offen offset:0 nt lds
v_mfma_f32_16x16x32_bf16 a[224:227],a[136:139],v[36:39],a[224:227]
v_exp_f32 v93,v93
v_mfma_f32_16x16x32_bf16 a[228:231],a[140:143],v[36:39],a[228:231]
v_exp_f32 v104,v104
v_mfma_f32_16x16x32_bf16 a[232:235],a[144:147],v[36:39],a[232:235]
v_exp_f32 v96,v96
v_mfma_f32_16x16x32_bf16 a[236:239],a[148:151],v[36:39],a[236:239]
v_fma_f32 v78,v78,s36,v13
v_exp_f32 v78,v78
v_mfma_f32_16x16x32_bf16 a[188:191],a[148:151],v[32:35],a[188:191]
v_fma_f32 v110,v110,s36,v17
v_exp_f32 v110,v110
v_mfma_f32_16x16x32_bf16 a[184:187],a[144:147],v[32:35],a[184:187]
v_exp_f32 v97,v97
v_mfma_f32_16x16x32_bf16 v[136:139],a[144:147],v[28:31],v[136:139]
v_exp_f32 v100,v100
v_mfma_f32_16x16x32_bf16 v[140:143],a[148:151],v[28:31],v[140:143]
buffer_load_dwordx4 v7,s[12:15],s28 offen offset:1024 nt lds
v_mfma_f32_16x16x32_bf16 v[236:239],a[148:151],v[24:27],v[236:239]
v_fma_f32 v102,v102,s36,v16
v_exp_f32 v102,v102
v_mfma_f32_16x16x32_bf16 v[232:235],a[144:147],v[24:27],v[232:235]
v_fma_f32 v79,v79,s36,v13
v_exp_f32 v79,v79
v_mfma_f32_16x16x32_bf16 v[184:187],a[144:147],v[20:23],v[184:187]
v_exp_f32 v85,v85
v_mfma_f32_16x16x32_bf16 v[188:191],a[148:151],v[20:23],v[188:191]
v_fma_f32 v108,v108,s36,v17
v_exp_f32 v108,v108
v_mfma_f32_16x16x32_bf16 v[192:195],a[120:123],v[20:23],v[192:195]
s_waitcnt lgkmcnt(0)
v_fma_f32 v98,v98,s36,v16
v_exp_f32 v87,v87
v_mfma_f32_16x16x32_bf16 v[196:199],a[124:127],v[20:23],v[196:199]
v_fma_f32 v76,v76,s36,v13
v_exp_f32 v76,v76
v_mfma_f32_16x16x32_bf16 v[244:247],a[124:127],v[24:27],v[244:247]
buffer_load_dwordx4 v8,s[12:15],s28 offen offset:2048 nt lds
s_waitcnt vmcnt(20)
s_barrier
v_mfma_f32_16x16x32_bf16 v[240:243],a[120:123],v[24:27],v[240:243]
s_add_u32 s28,s28,3072
v_fma_f32 v105,v105,s36,v17
v_exp_f32 v107,v107
v_mfma_f32_16x16x32_bf16 v[144:147],a[120:123],v[28:31],v[144:147]
s_add_u32 m0,s22,0
v_fma_f32 v91,v91,s36,v15
v_exp_f32 v91,v91
v_mfma_f32_16x16x32_bf16 v[148:151],a[124:127],v[28:31],v[148:151]
buffer_load_dwordx4 v6,s[4:7],s25 offen offset:0 lds
v_mfma_f32_16x16x32_bf16 a[196:199],a[124:127],v[32:35],a[196:199]
buffer_load_dwordx4 v7,s[4:7],s25 offen offset:1024 lds
v_mfma_f32_16x16x32_bf16 a[192:195],a[120:123],v[32:35],a[192:195]
buffer_load_dwordx4 v8,s[4:7],s25 offen offset:2048 lds
v_mfma_f32_16x16x32_bf16 a[240:243],a[120:123],v[36:39],a[240:243]
v_fma_f32 v86,v86,s36,v14
v_exp_f32 v86,v86
v_mfma_f32_16x16x32_bf16 a[244:247],a[124:127],v[36:39],a[244:247]
v_exp_f32 v95,v95
v_mfma_f32_16x16x32_bf16 a[248:251],a[128:131],v[36:39],a[248:251]
v_exp_f32 v103,v103
v_mfma_f32_16x16x32_bf16 a[252:255],a[132:135],v[36:39],a[252:255]
ds_read_b64_tr_b16 a[136:137],v2 offset:0
v_cvt_pk_bf16_f32 v41,v106,v107
v_mfma_f32_16x16x32_bf16 a[204:207],a[132:135],v[32:35],a[204:207]
ds_read_b64_tr_b16 a[138:139],v2 offset:6144
v_exp_f32 v99,v99
v_mfma_f32_16x16x32_bf16 a[200:203],a[128:131],v[32:35],a[200:203]
ds_read_b64_tr_b16 a[140:141],v3 offset:0
v_cvt_pk_bf16_f32 v42,v108,v109
v_mfma_f32_16x16x32_bf16 v[152:155],a[128:131],v[28:31],v[152:155]
ds_read_b64_tr_b16 a[142:143],v3 offset:6144
v_cvt_pk_bf16_f32 v50,v84,v85
v_mfma_f32_16x16x32_bf16 v[156:159],a[132:135],v[28:31],v[156:159]
ds_read_b64_tr_b16 a[144:145],v4 offset:0
v_exp_f32 v90,v90
v_mfma_f32_16x16x32_bf16 v[252:255],a[132:135],v[24:27],v[252:255]
ds_read_b64_tr_b16 a[146:147],v4 offset:6144
v_exp_f32 v105,v105
v_mfma_f32_16x16x32_bf16 v[248:251],a[128:131],v[24:27],v[248:251]
ds_read_b64_tr_b16 a[148:149],v5 offset:0
v_cvt_pk_bf16_f32 v55,v94,v95
v_mfma_f32_16x16x32_bf16 v[200:203],a[128:131],v[20:23],v[200:203]
ds_read_b64_tr_b16 a[150:151],v5 offset:6144
v_cvt_pk_bf16_f32 v51,v86,v87
v_mfma_f32_16x16x32_bf16 v[204:207],a[132:135],v[20:23],v[204:207]
v_cvt_pk_bf16_f32 v59,v102,v103
v_exp_f32 v98,v98
v_cvt_pk_bf16_f32 v54,v92,v93
v_cvt_pk_bf16_f32 v56,v96,v97
v_cvt_pk_bf16_f32 v53,v90,v91
v_cvt_pk_bf16_f32 v47,v78,v79
v_cvt_pk_bf16_f32 v43,v110,v111
v_cvt_pk_bf16_f32 v58,v100,v101
v_cvt_pk_bf16_f32 v46,v76,v77
v_cvt_pk_bf16_f32 v57,v98,v99
v_cvt_pk_bf16_f32 v40,v104,v105
v_smfmac_f32_16x16x64_bf16 v[60:63],a[152:155],v[44:51],v18
v_subrev_u32 v10,18432,v10
v_smfmac_f32_16x16x64_bf16 v[64:67],a[152:155],v[52:59],v18
v_smfmac_f32_16x16x64_bf16 v[68:71],a[152:155],v[36:43],v18
s_waitcnt lgkmcnt(1)
v_mfma_f32_16x16x32_bf16 v[160:163],a[136:139],v[44:47],v[160:163]
s_add_u32 s87,s42,18432
ds_read_b64_tr_b16 a[122:123],v2 offset:6272
v_mbcnt_lo_u32_b32 v39,-1,0
v_mfma_f32_16x16x32_bf16 v[164:167],a[140:143],v[44:47],v[164:167]
s_add_u32 s66,s42,24576
ds_read_b64_tr_b16 a[120:121],v2 offset:128
v_mbcnt_hi_u32_b32 v39,-1,v39
v_mfma_f32_16x16x32_bf16 v[212:215],a[140:143],v[48:51],v[212:215]
ds_read_b64_tr_b16 a[124:125],v3 offset:128
v_and_b32 v38,7,v39
v_mfma_f32_16x16x32_bf16 v[208:211],a[136:139],v[48:51],v[208:211]
ds_read_b64_tr_b16 a[126:127],v3 offset:6272
v_add_f32 v68,v68,v69
v_mfma_f32_16x16x32_bf16 v[112:115],a[136:139],v[52:55],v[112:115]
ds_read_b64_tr_b16 a[128:129],v4 offset:128
v_add_f32 v68,v68,v70
v_mfma_f32_16x16x32_bf16 v[116:119],a[140:143],v[52:55],v[116:119]
ds_read_b64_tr_b16 a[130:131],v4 offset:6272
v_add_f32 v62,v62,v63
v_mfma_f32_16x16x32_bf16 a[164:167],a[140:143],v[56:59],a[164:167]
ds_read_b64_tr_b16 a[132:133],v5 offset:128
v_add_f32 v66,v66,v67
v_mfma_f32_16x16x32_bf16 a[160:163],a[136:139],v[56:59],a[160:163]
ds_read_b64_tr_b16 a[134:135],v5 offset:6272
v_add_f32 v60,v60,v61
v_mfma_f32_16x16x32_bf16 a[208:211],a[136:139],v[40:43],a[208:211]
ds_read_b64_tr_b16 a[136:137],v2 offset:256
v_add_f32 v64,v64,v65
v_mfma_f32_16x16x32_bf16 a[212:215],a[140:143],v[40:43],a[212:215]
ds_read_b64_tr_b16 a[138:139],v2 offset:6400
v_add_f32 v68,v68,v71
v_mfma_f32_16x16x32_bf16 a[216:219],a[144:147],v[40:43],a[216:219]
s_waitcnt lgkmcnt(6)
ds_read_b64_tr_b16 a[142:143],v3 offset:6400
v_max3_f32 v19,v60,v62,v64
v_mfma_f32_16x16x32_bf16 a[220:223],a[148:151],v[40:43],a[220:223]
ds_read_b64_tr_b16 a[140:141],v3 offset:256
v_max3_f32 v19,v19,v66,v68
v_rcp_f32 v68,v68
v_rcp_f32 v66,v66
v_accvgpr_read_b32 v72,a160
v_accvgpr_read_b32 v77,a209
v_accvgpr_read_b32 v75,a163
v_accvgpr_read_b32 v73,a161
v_pk_mul_f32 v[72:73],v[72:73],v[66:67] op_sel_hi:[1,0]
v_accvgpr_read_b32 v74,a162
v_pk_mul_f32 v[74:75],v[74:75],v[66:67] op_sel_hi:[1,0]
v_accvgpr_read_b32 v76,a208
v_pk_mul_f32 v[76:77],v[76:77],v[68:69] op_sel_hi:[1,0]
v_accvgpr_read_b32 v79,a211
v_accvgpr_read_b32 v78,a210
v_pk_mul_f32 v[78:79],v[78:79],v[68:69] op_sel_hi:[1,0]
v_accvgpr_read_b32 v80,a164
v_accvgpr_read_b32 v83,a167
v_mfma_f32_16x16x32_bf16 a[172:175],a[148:151],v[56:59],a[172:175]
v_accvgpr_read_b32 v84,a212
v_accvgpr_read_b32 v82,a166
v_accvgpr_read_b32 v87,a215
v_accvgpr_read_b32 v81,a165
v_accvgpr_read_b32 v86,a214
v_pk_mul_f32 v[80:81],v[80:81],v[66:67] op_sel_hi:[1,0]
v_pk_mul_f32 v[86:87],v[86:87],v[68:69] op_sel_hi:[1,0]
v_pk_mul_f32 v[82:83],v[82:83],v[66:67] op_sel_hi:[1,0]
v_accvgpr_read_b32 v85,a213
v_pk_mul_f32 v[84:85],v[84:85],v[68:69] op_sel_hi:[1,0]
v_accvgpr_read_b32 v95,a219
v_accvgpr_read_b32 v92,a216
v_mfma_f32_16x16x32_bf16 a[168:171],a[144:147],v[56:59],a[168:171]
v_accvgpr_read_b32 v93,a217
v_accvgpr_read_b32 v94,a218
v_mfma_f32_16x16x32_bf16 v[120:123],a[144:147],v[52:55],v[120:123]
v_accvgpr_read_b32 v97,a173
v_accvgpr_read_b32 v100,a220
v_mfma_f32_16x16x32_bf16 v[124:127],a[148:151],v[52:55],v[124:127]
v_accvgpr_read_b32 v102,a222
v_accvgpr_read_b32 v96,a172
v_mfma_f32_16x16x32_bf16 v[220:223],a[148:151],v[48:51],v[220:223]
v_accvgpr_read_b32 v89,a169
v_accvgpr_read_b32 v90,a170
v_accvgpr_read_b32 v91,a171
v_accvgpr_read_b32 v88,a168
v_accvgpr_read_b32 v103,a223
v_pk_mul_f32 v[92:93],v[92:93],v[68:69] op_sel_hi:[1,0]
v_pk_mul_f32 v[88:89],v[88:89],v[66:67] op_sel_hi:[1,0]
v_pk_mul_f32 v[94:95],v[94:95],v[68:69] op_sel_hi:[1,0]
v_pk_mul_f32 v[90:91],v[90:91],v[66:67] op_sel_hi:[1,0]
v_accvgpr_read_b32 v99,a175
v_accvgpr_read_b32 v98,a174
v_mfma_f32_16x16x32_bf16 v[216:219],a[144:147],v[48:51],v[216:219]
v_accvgpr_read_b32 v101,a221
v_cmp_ngt_f32 vcc,s37,v19
v_lshrrev_b32 v19,5,v39
v_xor_b32 v38,v38,v19
v_and_b32 v19,15,v39
v_pk_mul_f32 v[102:103],v[102:103],v[68:69] op_sel_hi:[1,0]
v_pk_mul_f32 v[100:101],v[100:101],v[68:69] op_sel_hi:[1,0]
v_pk_mul_f32 v[98:99],v[98:99],v[66:67] op_sel_hi:[1,0]
v_pk_mul_f32 v[96:97],v[96:97],v[66:67] op_sel_hi:[1,0]
v_lshl_add_u32 v19,v19,7,s24
v_lshl_add_u32 v19,v38,4,v19
v_mfma_f32_16x16x32_bf16 v[168:171],a[144:147],v[44:47],v[168:171]
s_cmp_lg_u64 vcc,0
ds_read_b64_tr_b16 a[144:145],v4 offset:256
v_bfe_u32 v38,v39,4,1
v_mfma_f32_16x16x32_bf16 v[172:175],a[148:151],v[44:47],v[172:175]
s_cselect_b32 s62,s32,0
ds_read_b64_tr_b16 a[146:147],v4 offset:6400
v_lshl_add_u32 v36,v38,3,v19
v_mfma_f32_16x16x32_bf16 v[176:179],a[120:123],v[44:47],v[176:179]
s_or_b32 s31,s31,s62
ds_read_b64_tr_b16 a[148:149],v5 offset:256
v_xor_b32 v37,32,v36
v_mfma_f32_16x16x32_bf16 v[180:183],a[124:127],v[44:47],v[180:183]
s_lshl_b32 s32,s32,1
ds_read_b64_tr_b16 a[150:151],v5 offset:6400
v_xor_b32 v38,64,v36
v_mfma_f32_16x16x32_bf16 v[228:231],a[124:127],v[48:51],v[228:231]
s_add_u32 m0,s23,0
v_bfe_u32 v19,v39,3,1
v_xor_b32 v39,96,v36
v_mfma_f32_16x16x32_bf16 v[224:227],a[120:123],v[48:51],v[224:227]
v_lshlrev_b32 v19,11,v19
v_cvt_pk_bf16_f32 v76,v76,v77
v_mfma_f32_16x16x32_bf16 v[128:131],a[120:123],v[52:55],v[128:131]
v_cvt_pk_bf16_f32 v77,v78,v79
v_cvt_pk_bf16_f32 v84,v84,v85
v_mfma_f32_16x16x32_bf16 v[132:135],a[124:127],v[52:55],v[132:135]
v_cvt_pk_bf16_f32 v85,v86,v87
v_cvt_pk_bf16_f32 v72,v72,v73
v_mfma_f32_16x16x32_bf16 a[180:183],a[124:127],v[56:59],a[180:183]
v_cvt_pk_bf16_f32 v80,v80,v81
v_cvt_pk_bf16_f32 v73,v74,v75
v_mfma_f32_16x16x32_bf16 a[176:179],a[120:123],v[56:59],a[176:179]
ds_write2st64_b64 v36,v[72:73],v[76:77] offset0:36 offset1:40
v_mfma_f32_16x16x32_bf16 a[224:227],a[120:123],v[40:43],a[224:227]
v_cvt_pk_bf16_f32 v81,v82,v83
v_cvt_pk_bf16_f32 v92,v92,v93
v_mfma_f32_16x16x32_bf16 a[228:231],a[124:127],v[40:43],a[228:231]
s_waitcnt lgkmcnt(1)
v_cvt_pk_bf16_f32 v88,v88,v89
v_cvt_pk_bf16_f32 v93,v94,v95
v_mfma_f32_16x16x32_bf16 a[232:235],a[128:131],v[40:43],a[232:235]
v_accvgpr_read_b32 v83,a179
v_accvgpr_read_b32 v82,a178
v_mfma_f32_16x16x32_bf16 a[236:239],a[132:135],v[40:43],a[236:239]
ds_write2st64_b64 v37,v[80:81],v[84:85] offset0:36 offset1:40
v_pk_mul_f32 v[82:83],v[82:83],v[66:67] op_sel_hi:[1,0]
v_accvgpr_read_b32 v81,a177
v_accvgpr_read_b32 v84,a224
v_accvgpr_read_b32 v86,a226
v_accvgpr_read_b32 v87,a227
v_pk_mul_f32 v[86:87],v[86:87],v[68:69] op_sel_hi:[1,0]
v_accvgpr_read_b32 v80,a176
v_pk_mul_f32 v[80:81],v[80:81],v[66:67] op_sel_hi:[1,0]
v_accvgpr_read_b32 v85,a225
v_pk_mul_f32 v[84:85],v[84:85],v[68:69] op_sel_hi:[1,0]
v_accvgpr_read_b32 v94,a230
v_cvt_pk_bf16_f32 v89,v90,v91
v_mfma_f32_16x16x32_bf16 a[188:191],a[132:135],v[56:59],a[188:191]
ds_write2st64_b64 v38,v[88:89],v[92:93] offset0:36 offset1:40
v_accvgpr_read_b32 v89,a181
v_accvgpr_read_b32 v91,a183
v_accvgpr_read_b32 v92,a228
v_accvgpr_read_b32 v93,a229
v_pk_mul_f32 v[92:93],v[92:93],v[68:69] op_sel_hi:[1,0]
v_accvgpr_read_b32 v95,a231
v_pk_mul_f32 v[94:95],v[94:95],v[68:69] op_sel_hi:[1,0]
v_accvgpr_read_b32 v88,a180
v_pk_mul_f32 v[88:89],v[88:89],v[66:67] op_sel_hi:[1,0]
v_accvgpr_read_b32 v90,a182
v_pk_mul_f32 v[90:91],v[90:91],v[66:67] op_sel_hi:[1,0]
v_cvt_pk_bf16_f32 v100,v100,v101
v_cvt_pk_bf16_f32 v101,v102,v103
v_mfma_f32_16x16x32_bf16 a[184:187],a[128:131],v[56:59],a[184:187]
v_cvt_pk_bf16_f32 v96,v96,v97
v_cvt_pk_bf16_f32 v97,v98,v99
v_mfma_f32_16x16x32_bf16 v[136:139],a[128:131],v[52:55],v[136:139]
ds_write2st64_b64 v39,v[96:97],v[100:101] offset0:36 offset1:40
v_mfma_f32_16x16x32_bf16 v[140:143],a[132:135],v[52:55],v[140:143]
v_cvt_pk_bf16_f32 v84,v84,v85
v_cvt_pk_bf16_f32 v80,v80,v81
v_mfma_f32_16x16x32_bf16 v[236:239],a[132:135],v[48:51],v[236:239]
s_waitcnt vmcnt(15)
ds_read_b128 a[68:71],v12 offset:12544
v_cvt_pk_bf16_f32 v81,v82,v83
ds_read_b128 a[64:67],v11 offset:12544
v_accvgpr_read_b32 v83,a191
ds_read_b128 a[60:63],v12 offset:12416
v_cvt_pk_bf16_f32 v85,v86,v87
ds_read_b128 a[56:59],v11 offset:12416
v_accvgpr_read_b32 v100,a232
ds_read_b128 a[52:55],v12 offset:12288
v_accvgpr_read_b32 v82,a190
ds_read_b128 a[48:51],v11 offset:12288
v_pk_mul_f32 v[82:83],v[82:83],v[66:67] op_sel_hi:[1,0]
ds_read_b128 v[104:107],v10 offset:18432
v_accvgpr_read_b32 v103,a235
ds_read_b128 v[108:111],v10 offset:19456
v_accvgpr_read_b32 v98,a186
ds_read_b128 v[72:75],v10 offset:20480
v_accvgpr_read_b32 v97,a185
ds_read_b128 v[76:79],v10 offset:21504
v_accvgpr_read_b32 v102,a234
ds_write2st64_b64 v36,v[80:81],v[84:85] offset0:36 offset1:40
v_pk_mul_f32 v[102:103],v[102:103],v[68:69] op_sel_hi:[1,0]
v_accvgpr_read_b32 v85,a237
v_accvgpr_read_b32 v101,a233
v_pk_mul_f32 v[100:101],v[100:101],v[68:69] op_sel_hi:[1,0]
v_accvgpr_read_b32 v80,a188
v_accvgpr_read_b32 v96,a184
v_pk_mul_f32 v[96:97],v[96:97],v[66:67] op_sel_hi:[1,0]
s_waitcnt lgkmcnt(4)
buffer_store_dwordx4 v[104:107],v9,s[16:19],s87 offen offset:0 nt
v_accvgpr_read_b32 v87,a239
v_accvgpr_read_b32 v86,a238
v_pk_mul_f32 v[86:87],v[86:87],v[68:69] op_sel_hi:[1,0]
v_accvgpr_read_b32 v99,a187
v_pk_mul_f32 v[98:99],v[98:99],v[66:67] op_sel_hi:[1,0]
v_accvgpr_read_b32 v81,a189
v_pk_mul_f32 v[80:81],v[80:81],v[66:67] op_sel_hi:[1,0]
v_accvgpr_read_b32 v84,a236
v_pk_mul_f32 v[84:85],v[84:85],v[68:69] op_sel_hi:[1,0]
v_cvt_pk_bf16_f32 v100,v100,v101
v_cvt_pk_bf16_f32 v96,v96,v97
v_mfma_f32_16x16x32_bf16 v[232:235],a[128:131],v[48:51],v[232:235]
s_waitcnt lgkmcnt(1)
buffer_store_dwordx4 v[108:111],v9,s[16:19],s87 offen offset:3072 nt
v_cvt_pk_bf16_f32 v88,v88,v89
v_cvt_pk_bf16_f32 v92,v92,v93
v_cvt_pk_bf16_f32 v80,v80,v81
v_mfma_f32_16x16x32_bf16 v[184:187],a[128:131],v[44:47],v[184:187]
v_cvt_pk_bf16_f32 v89,v90,v91
v_cvt_pk_bf16_f32 v93,v94,v95
v_mfma_f32_16x16x32_bf16 v[188:191],a[132:135],v[44:47],v[188:191]
v_cvt_pk_bf16_f32 v84,v84,v85
v_cvt_pk_bf16_f32 v97,v98,v99
v_mfma_f32_16x16x32_bf16 v[192:195],a[136:139],v[44:47],v[192:195]
ds_write2st64_b64 v37,v[88:89],v[92:93] offset0:36 offset1:40
v_mfma_f32_16x16x32_bf16 v[196:199],a[140:143],v[44:47],v[196:199]
v_cvt_pk_bf16_f32 v101,v102,v103
v_cvt_pk_bf16_f32 v81,v82,v83
v_mfma_f32_16x16x32_bf16 v[244:247],a[140:143],v[48:51],v[244:247]
buffer_store_dwordx4 v[72:75],v9,s[16:19],s66 offen offset:0 nt
v_cvt_pk_bf16_f32 v85,v86,v87
v_rcp_f32 v62,v62
v_mfma_f32_16x16x32_bf16 v[240:243],a[136:139],v[48:51],v[240:243]
v_rcp_f32 v64,v64
v_mfma_f32_16x16x32_bf16 v[144:147],a[136:139],v[52:55],v[144:147]
v_rcp_f32 v60,v60
v_mfma_f32_16x16x32_bf16 v[148:151],a[140:143],v[52:55],v[148:151]
ds_write2st64_b64 v38,v[96:97],v[100:101] offset0:36 offset1:40
v_mfma_f32_16x16x32_bf16 a[196:199],a[140:143],v[56:59],a[196:199]
v_mfma_f32_16x16x32_bf16 a[192:195],a[136:139],v[56:59],a[192:195]
buffer_store_dwordx4 v[76:79],v9,s[16:19],s66 offen offset:3072 nt
v_mfma_f32_16x16x32_bf16 a[240:243],a[136:139],v[40:43],a[240:243]
v_mfma_f32_16x16x32_bf16 a[244:247],a[140:143],v[40:43],a[244:247]
v_mfma_f32_16x16x32_bf16 a[248:251],a[144:147],v[40:43],a[248:251]
ds_write2st64_b64 v39,v[80:81],v[84:85] offset0:36 offset1:40
v_mfma_f32_16x16x32_bf16 a[252:255],a[148:151],v[40:43],a[252:255]
ds_read_b128 v[72:75],v10 offset:18432
s_waitcnt vmcnt(4)
s_barrier
ds_read_b128 v[76:79],v10 offset:19456
v_accvgpr_read_b32 v104,a192
ds_read_b128 v[88:91],v10 offset:20480
v_accvgpr_read_b32 v109,a241
ds_read_b128 v[92:95],v10 offset:21504
v_accvgpr_read_b32 v107,a195
ds_read_b128 a[140:143],v1 offset:256
v_accvgpr_read_b32 v106,a194
ds_read_b128 a[136:139],v0 offset:256
buffer_load_dwordx4 v6,s[8:11],s25 offen offset:0 lds
s_waitcnt lgkmcnt(5)
buffer_store_dwordx4 v[72:75],v9,s[16:19],s87 offen offset:128 nt
ds_read_b128 a[132:135],v1 offset:128
v_pk_mul_f32 v[106:107],v[106:107],v[66:67] op_sel_hi:[1,0]
ds_read_b128 a[128:131],v0 offset:128
v_accvgpr_read_b32 v111,a243
ds_read_b128 a[124:127],v1 offset:0
v_accvgpr_read_b32 v110,a242
ds_read_b128 a[120:123],v0 offset:0
s_waitcnt lgkmcnt(7)
buffer_store_dwordx4 v[76:79],v9,s[16:19],s87 offen offset:3200 nt
v_pk_mul_f32 v[110:111],v[110:111],v[68:69] op_sel_hi:[1,0]
v_accvgpr_read_b32 v108,a240
v_pk_mul_f32 v[108:109],v[108:109],v[68:69] op_sel_hi:[1,0]
v_accvgpr_read_b32 v105,a193
v_pk_mul_f32 v[104:105],v[104:105],v[66:67] op_sel_hi:[1,0]
v_accvgpr_read_b32 v103,a247
v_accvgpr_read_b32 v100,a244
v_mfma_f32_16x16x32_bf16 a[204:207],a[148:151],v[56:59],a[204:207]
v_accvgpr_read_b32 v98,a198
buffer_load_dwordx4 v7,s[8:11],s25 offen offset:1024 lds
buffer_store_dwordx4 v[88:91],v9,s[16:19],s66 offen offset:128 nt
v_accvgpr_read_b32 v97,a197
v_accvgpr_read_b32 v99,a199
v_pk_mul_f32 v[98:99],v[98:99],v[66:67] op_sel_hi:[1,0]
v_accvgpr_read_b32 v101,a245
v_pk_mul_f32 v[100:101],v[100:101],v[68:69] op_sel_hi:[1,0]
v_accvgpr_read_b32 v96,a196
v_pk_mul_f32 v[96:97],v[96:97],v[66:67] op_sel_hi:[1,0]
v_accvgpr_read_b32 v102,a246
v_pk_mul_f32 v[102:103],v[102:103],v[68:69] op_sel_hi:[1,0]
v_accvgpr_read_b32 v85,a249
v_cvt_pk_bf16_f32 v104,v104,v105
v_mfma_f32_16x16x32_bf16 a[200:203],a[144:147],v[56:59],a[200:203]
s_waitcnt lgkmcnt(0)
buffer_store_dwordx4 v[92:95],v9,s[16:19],s66 offen offset:3200 nt
v_cvt_pk_bf16_f32 v108,v108,v109
v_cvt_pk_bf16_f32 v96,v96,v97
v_cvt_pk_bf16_f32 v100,v100,v101
v_mfma_f32_16x16x32_bf16 v[152:155],a[144:147],v[52:55],v[152:155]
v_accvgpr_read_b32 v86,a250
v_cvt_pk_bf16_f32 v109,v110,v111
v_mfma_f32_16x16x32_bf16 v[156:159],a[148:151],v[52:55],v[156:159]
v_accvgpr_read_b32 v81,a201
v_accvgpr_read_b32 v83,a203
v_mfma_f32_16x16x32_bf16 v[252:255],a[148:151],v[48:51],v[252:255]
buffer_load_dwordx4 v8,s[8:11],s25 offen offset:2048 lds
v_accvgpr_read_b32 v82,a202
v_cvt_pk_bf16_f32 v105,v106,v107
ds_write2st64_b64 v36,v[104:105],v[108:109] offset0:36 offset1:40
v_pk_mul_f32 v[82:83],v[82:83],v[66:67] op_sel_hi:[1,0]
v_pk_mul_f32 v[232:233],v[232:233],v[62:63] op_sel_hi:[1,0]
v_pk_mul_f32 v[238:239],v[238:239],v[62:63] op_sel_hi:[1,0]
v_pk_mul_f32 v[210:211],v[210:211],v[62:63] op_sel_hi:[1,0]
v_pk_mul_f32 v[212:213],v[212:213],v[62:63] op_sel_hi:[1,0]
v_pk_mul_f32 v[236:237],v[236:237],v[62:63] op_sel_hi:[1,0]
v_pk_mul_f32 v[214:215],v[214:215],v[62:63] op_sel_hi:[1,0]
v_pk_mul_f32 v[228:229],v[228:229],v[62:63] op_sel_hi:[1,0]
v_pk_mul_f32 v[220:221],v[220:221],v[62:63] op_sel_hi:[1,0]
v_pk_mul_f32 v[224:225],v[224:225],v[62:63] op_sel_hi:[1,0]
v_pk_mul_f32 v[218:219],v[218:219],v[62:63] op_sel_hi:[1,0]
v_pk_mul_f32 v[222:223],v[222:223],v[62:63] op_sel_hi:[1,0]
v_pk_mul_f32 v[226:227],v[226:227],v[62:63] op_sel_hi:[1,0]
v_pk_mul_f32 v[230:231],v[230:231],v[62:63] op_sel_hi:[1,0]
v_pk_mul_f32 v[234:235],v[234:235],v[62:63] op_sel_hi:[1,0]
v_pk_mul_f32 v[208:209],v[208:209],v[62:63] op_sel_hi:[1,0]
v_pk_mul_f32 v[216:217],v[216:217],v[62:63] op_sel_hi:[1,0]
v_add_u32 v36,v36,v19
v_accvgpr_read_b32 v108,a252
v_accvgpr_read_b32 v109,a253
v_pk_mul_f32 v[108:109],v[108:109],v[68:69] op_sel_hi:[1,0]
v_accvgpr_read_b32 v104,a204
v_accvgpr_read_b32 v106,a206
v_cvt_pk_bf16_f32 v97,v98,v99
v_cvt_pk_bf16_f32 v101,v102,v103
ds_write2st64_b64 v37,v[96:97],v[100:101] offset0:36 offset1:40
v_add_u32 v37,v37,v19
v_accvgpr_read_b32 v87,a251
v_pk_mul_f32 v[86:87],v[86:87],v[68:69] op_sel_hi:[1,0]
v_accvgpr_read_b32 v105,a205
v_pk_mul_f32 v[104:105],v[104:105],v[66:67] op_sel_hi:[1,0]
v_accvgpr_read_b32 v110,a254
v_accvgpr_read_b32 v80,a200
v_pk_mul_f32 v[80:81],v[80:81],v[66:67] op_sel_hi:[1,0]
v_cvt_pk_bf16_f32 v104,v104,v105
v_accvgpr_read_b32 v84,a248
v_pk_mul_f32 v[84:85],v[84:85],v[68:69] op_sel_hi:[1,0]
v_accvgpr_read_b32 v107,a207
v_pk_mul_f32 v[106:107],v[106:107],v[66:67] op_sel_hi:[1,0]
v_cvt_pk_bf16_f32 v80,v80,v81
v_cvt_pk_bf16_f32 v81,v82,v83
v_cvt_pk_bf16_f32 v108,v108,v109
v_cvt_pk_bf16_f32 v84,v84,v85
v_cvt_pk_bf16_f32 v85,v86,v87
ds_write2st64_b64 v38,v[80:81],v[84:85] offset0:36 offset1:40
v_add_u32 v38,v38,v19
v_accvgpr_read_b32 v111,a255
v_pk_mul_f32 v[110:111],v[110:111],v[68:69] op_sel_hi:[1,0]
v_cvt_pk_bf16_f32 v105,v106,v107
v_cvt_pk_bf16_f32 v109,v110,v111
v_mfma_f32_16x16x32_bf16 v[248:251],a[144:147],v[48:51],v[248:251]
s_waitcnt vmcnt(14)
ds_read_b128 a[72:75],v11 offset:0
v_cvt_pk_bf16_f32 v224,v224,v225
v_mfma_f32_16x16x32_bf16 v[200:203],a[144:147],v[44:47],v[200:203]
s_mov_b32 s27,s42
ds_read_b128 a[76:79],v12 offset:0
v_cvt_pk_bf16_f32 v212,v212,v213
v_mfma_f32_16x16x32_bf16 v[204:207],a[148:151],v[44:47],v[204:207]
s_mov_b32 s42,s41
ds_read_b128 a[80:83],v11 offset:128
v_cvt_pk_bf16_f32 v228,v228,v229
ds_read_b128 a[84:87],v12 offset:128
v_pk_mul_f32 v[112:113],v[112:113],v[64:65] op_sel_hi:[1,0]
ds_read_b128 a[88:91],v11 offset:256
v_pk_mul_f32 v[240:241],v[240:241],v[62:63] op_sel_hi:[1,0]
ds_read_b128 a[92:95],v12 offset:256
v_pk_mul_f32 v[114:115],v[114:115],v[64:65] op_sel_hi:[1,0]
ds_write2st64_b64 v39,v[104:105],v[108:109] offset0:36 offset1:40
v_pk_mul_f32 v[242:243],v[242:243],v[62:63] op_sel_hi:[1,0]
v_add_u32 v39,v39,v19
v_cvt_pk_bf16_f32 v229,v230,v231
ds_read_b128 v[72:75],v10 offset:18432
v_cvt_pk_bf16_f32 v225,v226,v227
ds_read_b128 v[76:79],v10 offset:19456
v_cvt_pk_bf16_f32 v236,v236,v237
ds_read_b128 v[88:91],v10 offset:20480
v_cvt_pk_bf16_f32 v208,v208,v209
ds_read_b128 v[92:95],v10 offset:21504
v_cvt_pk_bf16_f32 v209,v210,v211
ds_write2st64_b64 v36,v[208:209],v[224:225] offset0:12 offset1:14
v_cvt_pk_bf16_f32 v220,v220,v221
v_cvt_pk_bf16_f32 v216,v216,v217
v_cvt_pk_bf16_f32 v213,v214,v215
ds_read_b128 a[144:147],v0 offset:6144
v_cvt_pk_bf16_f32 v221,v222,v223
s_waitcnt lgkmcnt(5)
buffer_store_dwordx4 v[72:75],v9,s[16:19],s87 offen offset:256 nt
ds_read_b128 a[148:151],v1 offset:6144
v_cvt_pk_bf16_f32 v232,v232,v233
v_cvt_pk_bf16_f32 v233,v234,v235
v_mfma_f32_16x16x32_bf16 v[72:75],a[140:143],a[20:23],0
s_add_u32 s69,s69,1
v_cvt_pk_bf16_f32 v112,v112,v113
v_cvt_pk_bf16_f32 v217,v218,v219
v_mfma_f32_16x16x32_bf16 v[72:75],a[136:139],a[16:19],v[72:75]
s_lshl_b32 s62,s69,5
v_cvt_pk_bf16_f32 v237,v238,v239
v_cvt_pk_bf16_f32 v240,v240,v241
v_mfma_f32_16x16x32_bf16 v[72:75],a[132:135],a[12:15],v[72:75]
s_add_u32 s62,s62,s34
s_waitcnt lgkmcnt(2)
buffer_store_dwordx4 v[76:79],v9,s[16:19],s87 offen offset:3328 nt
v_cvt_pk_bf16_f32 v241,v242,v243
v_cvt_pk_bf16_f32 v113,v114,v115
v_pk_mul_f32 v[118:119],v[118:119],v[64:65] op_sel_hi:[1,0]
v_pk_mul_f32 v[116:117],v[116:117],v[64:65] op_sel_hi:[1,0]
v_pk_mul_f32 v[244:245],v[244:245],v[62:63] op_sel_hi:[1,0]
v_pk_mul_f32 v[246:247],v[246:247],v[62:63] op_sel_hi:[1,0]
v_cvt_pk_bf16_f32 v244,v244,v245
v_cvt_pk_bf16_f32 v116,v116,v117
v_mfma_f32_16x16x32_bf16 v[72:75],a[128:131],a[8:11],v[72:75]
s_mul_i32 s63,s62,171
v_cvt_pk_bf16_f32 v245,v246,v247
v_cvt_pk_bf16_f32 v117,v118,v119
v_mfma_f32_16x16x32_bf16 v[72:75],a[124:127],a[4:7],v[72:75]
s_lshr_b32 s63,s63,9
ds_write2st64_b64 v37,v[212:213],v[228:229] offset0:12 offset1:14
v_mfma_f32_16x16x32_bf16 v[72:75],a[120:123],a[0:3],v[72:75]
s_mul_i32 s64,s63,3
v_mov_b32 v66,0
buffer_store_dwordx4 v[88:91],v9,s[16:19],s66 offen offset:256 nt
v_pk_mul_f32 v[250:251],v[250:251],v[62:63] op_sel_hi:[1,0]
v_pk_mul_f32 v[120:121],v[120:121],v[64:65] op_sel_hi:[1,0]
v_pk_mul_f32 v[248:249],v[248:249],v[62:63] op_sel_hi:[1,0]
v_pk_mul_f32 v[122:123],v[122:123],v[64:65] op_sel_hi:[1,0]
v_cvt_pk_bf16_f32 v248,v248,v249
v_max3_f32 v44,v72,v73,v74
v_mfma_f32_16x16x32_bf16 v[80:83],a[120:123],a[24:27],0
s_sub_u32 s62,s62,s64
v_cvt_pk_bf16_f32 v249,v250,v251
v_cvt_pk_bf16_f32 v120,v120,v121
v_mfma_f32_16x16x32_bf16 v[80:83],a[124:127],a[28:31],v[80:83]
s_add_u32 s63,s63,s33
ds_write2st64_b64 v38,v[216:217],v[232:233] offset0:12 offset1:14
v_mfma_f32_16x16x32_bf16 v[80:83],a[128:131],a[32:35],v[80:83]
s_mul_i32 s30,s63,196608
v_cvt_pk_bf16_f32 v121,v122,v123
buffer_store_dwordx4 v[92:95],v9,s[16:19],s66 offen offset:3328 nt
v_pk_mul_f32 v[254:255],v[254:255],v[62:63] op_sel_hi:[1,0]
v_pk_mul_f32 v[126:127],v[126:127],v[64:65] op_sel_hi:[1,0]
v_pk_mul_f32 v[124:125],v[124:125],v[64:65] op_sel_hi:[1,0]
v_pk_mul_f32 v[252:253],v[252:253],v[62:63] op_sel_hi:[1,0]
v_cvt_pk_bf16_f32 v124,v124,v125
v_cvt_pk_bf16_f32 v252,v252,v253
v_mfma_f32_16x16x32_bf16 v[80:83],a[132:135],a[36:39],v[80:83]
s_mul_i32 s41,s63,325632
v_cvt_pk_bf16_f32 v253,v254,v255
v_cvt_pk_bf16_f32 v125,v126,v127
v_mfma_f32_16x16x32_bf16 v[80:83],a[136:139],a[40:43],v[80:83]
s_lshl_b32 s63,s3,2
ds_write2st64_b64 v39,v[220:221],v[236:237] offset0:12 offset1:14
v_mfma_f32_16x16x32_bf16 v[80:83],a[140:143],a[44:47],v[80:83]
s_add_u32 s64,s63,21
v_mov_b32 v63,0
v_mov_b32 v62,0
v_mfma_f32_16x16x32_bf16 v[88:91],a[140:143],a[68:71],0
s_cmp_eq_u32 s3,0
v_mov_b32 v67,0
s_cselect_b32 s64,20,s64
s_cselect_b32 s40,1,0
s_add_u32 s65,s63,37
v_max3_f32 v48,v80,v81,v82
ds_write2st64_b64 v36,v[240:241],v[112:113] offset0:16 offset1:24
v_pk_mul_f32 v[130:131],v[130:131],v[64:65] op_sel_hi:[1,0]
v_pk_mul_f32 v[146:147],v[146:147],v[64:65] op_sel_hi:[1,0]
v_pk_mul_f32 v[128:129],v[128:129],v[64:65] op_sel_hi:[1,0]
v_pk_mul_f32 v[144:145],v[144:145],v[64:65] op_sel_hi:[1,0]
v_cvt_pk_bf16_f32 v128,v128,v129
v_cvt_pk_bf16_f32 v129,v130,v131
v_mfma_f32_16x16x32_bf16 v[88:91],a[136:139],a[64:67],v[88:91]
s_cmp_eq_u32 s62,2
v_cvt_pk_bf16_f32 v144,v144,v145
v_cvt_pk_bf16_f32 v145,v146,v147
v_mfma_f32_16x16x32_bf16 v[88:91],a[132:135],a[60:63],v[88:91]
s_cselect_b32 s64,s65,s64
s_cselect_b32 s40,0,s40
ds_write2st64_b64 v37,v[244:245],v[116:117] offset0:16 offset1:24
v_mfma_f32_16x16x32_bf16 v[88:91],a[128:131],a[56:59],v[88:91]
s_add_u32 s65,s63,s3
s_cmp_eq_u32 s62,0
s_cselect_b32 s64,s65,s64
s_cselect_b32 s40,1,s40
s_mul_i32 s64,s64,6144
s_add_u32 s41,s41,s64
v_pk_mul_f32 v[132:133],v[132:133],v[64:65] op_sel_hi:[1,0]
v_pk_mul_f32 v[148:149],v[148:149],v[64:65] op_sel_hi:[1,0]
v_pk_mul_f32 v[134:135],v[134:135],v[64:65] op_sel_hi:[1,0]
v_pk_mul_f32 v[150:151],v[150:151],v[64:65] op_sel_hi:[1,0]
v_cvt_pk_bf16_f32 v132,v132,v133
v_cvt_pk_bf16_f32 v148,v148,v149
v_mfma_f32_16x16x32_bf16 v[88:91],a[124:127],a[52:55],v[88:91]
s_cmp_ge_u32 s69,6
ds_write2st64_b64 v38,v[248:249],v[120:121] offset0:16 offset1:24
v_mfma_f32_16x16x32_bf16 v[88:91],a[120:123],a[48:51],v[88:91]
s_cselect_b32 s41,166723584,s41
v_cvt_pk_bf16_f32 v133,v134,v135
v_cvt_pk_bf16_f32 v149,v150,v151
v_mfma_f32_16x16x32_bf16 v[96:99],a[120:123],a[72:75],0
s_cselect_b32 s30,100663296,s30
ds_read_b128 a[120:123],v0 offset:6272
s_add_u32 s25,s30,s22
s_add_u32 s26,s25,12288
s_add_u32 m0,s23,24576
v_max3_f32 v52,v88,v89,v90
ds_write2st64_b64 v39,v[252:253],v[124:125] offset0:16 offset1:24
v_pk_mul_f32 v[154:155],v[154:155],v[64:65] op_sel_hi:[1,0]
v_pk_mul_f32 v[152:153],v[152:153],v[64:65] op_sel_hi:[1,0]
v_pk_mul_f32 v[138:139],v[138:139],v[64:65] op_sel_hi:[1,0]
v_pk_mul_f32 v[136:137],v[136:137],v[64:65] op_sel_hi:[1,0]
v_cvt_pk_bf16_f32 v152,v152,v153
v_cvt_pk_bf16_f32 v136,v136,v137
v_mfma_f32_16x16x32_bf16 v[96:99],a[124:127],a[76:79],v[96:99]
s_mov_b32 s28,s41
ds_read_b128 a[124:127],v1 offset:6272
v_cvt_pk_bf16_f32 v137,v138,v139
v_mfma_f32_16x16x32_bf16 v[96:99],a[128:131],a[80:83],v[96:99]
s_mov_b32 s29,s24
ds_read_b128 a[128:131],v0 offset:6400
v_cvt_pk_bf16_f32 v153,v154,v155
v_mfma_f32_16x16x32_bf16 v[96:99],a[132:135],a[84:87],v[96:99]
ds_write2st64_b64 v36,v[128:129],v[144:145] offset0:26 offset1:28
v_pk_mul_f32 v[156:157],v[156:157],v[64:65] op_sel_hi:[1,0]
v_pk_mul_f32 v[142:143],v[142:143],v[64:65] op_sel_hi:[1,0]
v_pk_mul_f32 v[158:159],v[158:159],v[64:65] op_sel_hi:[1,0]
ds_read_b128 a[132:135],v1 offset:6400
v_pk_mul_f32 v[140:141],v[140:141],v[64:65] op_sel_hi:[1,0]
v_cvt_pk_bf16_f32 v156,v156,v157
v_cvt_pk_bf16_f32 v140,v140,v141
v_mfma_f32_16x16x32_bf16 v[96:99],a[136:139],a[88:91],v[96:99]
ds_read_b128 a[136:139],v0 offset:12288
v_cvt_pk_bf16_f32 v141,v142,v143
v_mfma_f32_16x16x32_bf16 v[96:99],a[140:143],a[92:95],v[96:99]
s_waitcnt lgkmcnt(4)
ds_write2st64_b64 v37,v[132:133],v[148:149] offset0:26 offset1:28
v_mfma_f32_16x16x32_bf16 v[76:79],a[144:147],a[0:3],0
v_cvt_pk_bf16_f32 v157,v158,v159
ds_read_b128 a[140:143],v1 offset:12288
v_mov_b32 v65,0
v_pk_mul_f32 v[162:163],v[162:163],v[60:61] op_sel_hi:[1,0]
v_pk_mul_f32 v[176:177],v[176:177],v[60:61] op_sel_hi:[1,0]
v_pk_mul_f32 v[160:161],v[160:161],v[60:61] op_sel_hi:[1,0]
v_pk_mul_f32 v[178:179],v[178:179],v[60:61] op_sel_hi:[1,0]
v_max3_f32 v56,v96,v97,v98
v_cvt_pk_bf16_f32 v160,v160,v161
v_mfma_f32_16x16x32_bf16 v[76:79],a[148:151],a[4:7],v[76:79]
ds_write2st64_b64 v38,v[136:137],v[152:153] offset0:26 offset1:28
v_mfma_f32_16x16x32_bf16 v[76:79],a[120:123],a[8:11],v[76:79]
v_cvt_pk_bf16_f32 v161,v162,v163
v_cvt_pk_bf16_f32 v176,v176,v177
v_mfma_f32_16x16x32_bf16 v[76:79],a[124:127],a[12:15],v[76:79]
s_waitcnt lgkmcnt(2)
v_cvt_pk_bf16_f32 v177,v178,v179
v_mov_b32 v64,0
v_mfma_f32_16x16x32_bf16 v[76:79],a[128:131],a[16:19],v[76:79]
ds_write2st64_b64 v39,v[140:141],v[156:157] offset0:26 offset1:28
v_pk_mul_f32 v[180:181],v[180:181],v[60:61] op_sel_hi:[1,0]
v_pk_mul_f32 v[164:165],v[164:165],v[60:61] op_sel_hi:[1,0]
v_pk_mul_f32 v[166:167],v[166:167],v[60:61] op_sel_hi:[1,0]
v_pk_mul_f32 v[182:183],v[182:183],v[60:61] op_sel_hi:[1,0]
v_cvt_pk_bf16_f32 v164,v164,v165
v_cvt_pk_bf16_f32 v180,v180,v181
v_mfma_f32_16x16x32_bf16 v[76:79],a[132:135],a[20:23],v[76:79]
v_cvt_pk_bf16_f32 v181,v182,v183
v_cvt_pk_bf16_f32 v165,v166,v167
v_mfma_f32_16x16x32_bf16 v[84:87],a[132:135],a[44:47],0
buffer_load_dwordx4 v6,s[8:11],s21 offen offset:0 lds
v_mfma_f32_16x16x32_bf16 v[84:87],a[128:131],a[40:43],v[84:87]
ds_write2st64_b64 v36,v[160:161],v[176:177] offset0:0 offset1:2
v_pk_mul_f32 v[186:187],v[186:187],v[60:61] op_sel_hi:[1,0]
v_pk_mul_f32 v[170:171],v[170:171],v[60:61] op_sel_hi:[1,0]
v_pk_mul_f32 v[168:169],v[168:169],v[60:61] op_sel_hi:[1,0]
v_pk_mul_f32 v[184:185],v[184:185],v[60:61] op_sel_hi:[1,0]
v_max3_f32 v44,v44,v75,v76
v_max3_f32 v44,v44,v77,v78
v_mfma_f32_16x16x32_bf16 v[84:87],a[124:127],a[36:39],v[84:87]
v_max_f32 v44,v44,v79
v_mov_b32 v45,v44
v_mfma_f32_16x16x32_bf16 v[84:87],a[120:123],a[32:35],v[84:87]
v_cvt_pk_bf16_f32 v168,v168,v169
v_permlane32_swap_b32 v45,v44
v_mfma_f32_16x16x32_bf16 v[84:87],a[148:151],a[28:31],v[84:87]
ds_write2st64_b64 v37,v[164:165],v[180:181] offset0:0 offset1:2
v_pk_mul_f32 v[174:175],v[174:175],v[60:61] op_sel_hi:[1,0]
v_pk_mul_f32 v[190:191],v[190:191],v[60:61] op_sel_hi:[1,0]
v_pk_mul_f32 v[188:189],v[188:189],v[60:61] op_sel_hi:[1,0]
buffer_load_dwordx4 v7,s[8:11],s21 offen offset:1024 lds
v_pk_mul_f32 v[172:173],v[172:173],v[60:61] op_sel_hi:[1,0]
v_max_f32 v44,v44,v45
v_mov_b32 v45,v44
v_mfma_f32_16x16x32_bf16 v[84:87],a[144:147],a[24:27],v[84:87]
v_cvt_pk_bf16_f32 v169,v170,v171
v_permlane16_swap_b32 v45,v44
v_mfma_f32_16x16x32_bf16 v[92:95],a[144:147],a[48:51],0
v_max_f32 v44,v44,v45
v_mul_f32_e64 v13,-s36,v44
v_mfma_f32_16x16x32_bf16 v[92:95],a[148:151],a[52:55],v[92:95]
v_fma_f32 v72,v72,s36,v13
v_fma_f32 v74,v74,s36,v13
v_fma_f32 v75,v75,s36,v13
v_exp_f32 v74,v74
v_pk_mul_f32 v[194:195],v[194:195],v[60:61] op_sel_hi:[1,0]
v_pk_mul_f32 v[192:193],v[192:193],v[60:61] op_sel_hi:[1,0]
v_exp_f32 v72,v72
v_exp_f32 v75,v75
v_mfma_f32_16x16x32_bf16 v[92:95],a[120:123],a[56:59],v[92:95]
buffer_load_dwordx4 v8,s[8:11],s21 offen offset:2048 lds
v_mfma_f32_16x16x32_bf16 v[92:95],a[124:127],a[60:63],v[92:95]
s_add_u32 s21,s21,12288
v_fma_f32 v73,v73,s36,v13
v_exp_f32 v73,v73
v_mfma_f32_16x16x32_bf16 v[92:95],a[128:131],a[64:67],v[92:95]
s_add_u32 m0,s22,0
v_cvt_pk_bf16_f32 v21,v74,v75
v_cvt_pk_bf16_f32 v20,v72,v73
v_mfma_f32_16x16x32_bf16 v[92:95],a[132:135],a[68:71],v[92:95]
v_max3_f32 v48,v48,v83,v84
v_max3_f32 v48,v48,v85,v86
v_max_f32 v48,v48,v87
v_mov_b32 v49,v48
v_fma_f32 v78,v78,s36,v13
v_pk_mul_f32 v[198:199],v[198:199],v[60:61] op_sel_hi:[1,0]
v_pk_mul_f32 v[196:197],v[196:197],v[60:61] op_sel_hi:[1,0]
v_permlane32_swap_b32 v49,v48
v_max_f32 v48,v48,v49
v_mfma_f32_16x16x32_bf16 v[100:103],a[132:135],a[92:95],0
ds_read_b128 a[132:135],v1 offset:18432
v_mov_b32 v49,v48
v_mfma_f32_16x16x32_bf16 v[100:103],a[128:131],a[88:91],v[100:103]
ds_read_b128 a[128:131],v0 offset:18432
v_permlane16_swap_b32 v49,v48
v_mfma_f32_16x16x32_bf16 v[100:103],a[124:127],a[84:87],v[100:103]
ds_read_b128 a[124:127],v1 offset:12544
v_max_f32 v48,v48,v49
v_mul_f32_e64 v14,-s36,v48
v_fma_f32 v82,v82,s36,v14
v_fma_f32 v80,v80,s36,v14
v_pk_mul_f32 v[200:201],v[200:201],v[60:61] op_sel_hi:[1,0]
v_pk_mul_f32 v[202:203],v[202:203],v[60:61] op_sel_hi:[1,0]
v_exp_f32 v80,v80
v_exp_f32 v82,v82
v_mfma_f32_16x16x32_bf16 v[100:103],a[120:123],a[80:83],v[100:103]
ds_read_b128 a[120:123],v0 offset:12544
v_fma_f32 v83,v83,s36,v14
v_mfma_f32_16x16x32_bf16 v[100:103],a[148:151],a[76:79],v[100:103]
ds_read_b128 a[148:151],v1 offset:12416
v_exp_f32 v83,v83
v_mfma_f32_16x16x32_bf16 v[100:103],a[144:147],a[72:75],v[100:103]
ds_read_b128 a[144:147],v0 offset:12416
v_fma_f32 v81,v81,s36,v14
v_exp_f32 v81,v81
v_cvt_pk_bf16_f32 v25,v82,v83
v_pk_mul_f32 v[206:207],v[206:207],v[60:61] op_sel_hi:[1,0]
v_pk_mul_f32 v[204:205],v[204:205],v[60:61] op_sel_hi:[1,0]
v_cvt_pk_bf16_f32 v24,v80,v81
v_max3_f32 v52,v52,v91,v92
s_waitcnt lgkmcnt(3)
v_mfma_f32_16x16x32_bf16 v[72:75],a[124:127],a[20:23],0
v_max3_f32 v52,v52,v93,v94
v_max_f32 v52,v52,v95
v_mov_b32 v53,v52
v_max3_f32 v56,v56,v99,v100
v_max3_f32 v56,v56,v101,v102
v_permlane32_swap_b32 v53,v52
v_max_f32 v52,v52,v53
v_mov_b32 v53,v52
v_max_f32 v56,v56,v103
s_waitcnt lgkmcnt(2)
v_mfma_f32_16x16x32_bf16 v[72:75],a[120:123],a[16:19],v[72:75]
s_waitcnt lgkmcnt(1)
v_permlane16_swap_b32 v53,v52
v_mfma_f32_16x16x32_bf16 v[72:75],a[148:151],a[12:15],v[72:75]
s_waitcnt lgkmcnt(0)
v_max_f32 v52,v52,v53
v_mul_f32_e64 v15,-s36,v52
v_fma_f32 v91,v91,s36,v15
v_mfma_f32_16x16x32_bf16 v[72:75],a[144:147],a[8:11],v[72:75]
v_fma_f32 v88,v88,s36,v15
v_exp_f32 v88,v88
v_mfma_f32_16x16x32_bf16 v[72:75],a[140:143],a[4:7],v[72:75]
v_fma_f32 v89,v89,s36,v15
v_exp_f32 v89,v89
v_mfma_f32_16x16x32_bf16 v[72:75],a[136:139],a[0:3],v[72:75]
v_fma_f32 v90,v90,s36,v15
v_exp_f32 v90,v90
v_mfma_f32_16x16x32_bf16 v[80:83],a[136:139],a[24:27],0
v_exp_f32 v91,v91
v_mfma_f32_16x16x32_bf16 v[80:83],a[140:143],a[28:31],v[80:83]
v_cvt_pk_bf16_f32 v28,v88,v89
v_cvt_pk_bf16_f32 v29,v90,v91
v_mfma_f32_16x16x32_bf16 v[80:83],a[144:147],a[32:35],v[80:83]
v_mov_b32 v57,v56
v_fma_f32 v79,v79,s36,v13
v_mfma_f32_16x16x32_bf16 v[80:83],a[148:151],a[36:39],v[80:83]
v_permlane32_swap_b32 v57,v56
v_mfma_f32_16x16x32_bf16 v[80:83],a[120:123],a[40:43],v[80:83]
v_max_f32 v56,v56,v57
v_mov_b32 v57,v56
v_mfma_f32_16x16x32_bf16 v[80:83],a[124:127],a[44:47],v[80:83]
v_fma_f32 v76,v76,s36,v13
v_permlane16_swap_b32 v57,v56
v_mfma_f32_16x16x32_bf16 v[88:91],a[124:127],a[68:71],0
v_max_f32 v56,v56,v57
v_mul_f32_e64 v16,-s36,v56
v_mfma_f32_16x16x32_bf16 v[88:91],a[120:123],a[64:67],v[88:91]
v_fma_f32 v96,v96,s36,v16
v_fma_f32 v98,v98,s36,v16
v_mfma_f32_16x16x32_bf16 v[88:91],a[148:151],a[60:63],v[88:91]
v_exp_f32 v98,v98
v_mfma_f32_16x16x32_bf16 v[88:91],a[144:147],a[56:59],v[88:91]
v_fma_f32 v97,v97,s36,v16
v_fma_f32 v99,v99,s36,v16
v_mfma_f32_16x16x32_bf16 v[88:91],a[140:143],a[52:55],v[88:91]
v_exp_f32 v96,v96
v_mfma_f32_16x16x32_bf16 v[88:91],a[136:139],a[48:51],v[88:91]
v_exp_f32 v99,v99
v_exp_f32 v97,v97
v_cvt_pk_bf16_f32 v33,v98,v99
v_cvt_pk_bf16_f32 v32,v96,v97
v_mfma_f32_16x16x32_bf16 v[96:99],a[136:139],a[72:75],0
ds_read_b128 a[136:139],v0 offset:18560
v_exp_f32 v78,v78
v_mfma_f32_16x16x32_bf16 v[96:99],a[140:143],a[76:79],v[96:99]
ds_read_b128 a[140:143],v1 offset:18560
v_exp_f32 v76,v76
v_mfma_f32_16x16x32_bf16 v[96:99],a[144:147],a[80:83],v[96:99]
ds_read_b128 a[144:147],v0 offset:18688
v_fma_f32 v77,v77,s36,v13
v_mfma_f32_16x16x32_bf16 v[96:99],a[148:151],a[84:87],v[96:99]
ds_read_b128 a[148:151],v1 offset:18688
v_exp_f32 v77,v77
v_mfma_f32_16x16x32_bf16 v[96:99],a[120:123],a[88:91],v[96:99]
v_exp_f32 v79,v79
v_mfma_f32_16x16x32_bf16 v[96:99],a[124:127],a[92:95],v[96:99]
v_cvt_pk_bf16_f32 v23,v78,v79
v_cvt_pk_bf16_f32 v22,v76,v77
v_mfma_f32_16x16x32_bf16 v[76:79],a[128:131],a[0:3],0
v_fma_f32 v84,v84,s36,v14
v_fma_f32 v87,v87,s36,v14
v_mfma_f32_16x16x32_bf16 v[76:79],a[132:135],a[4:7],v[76:79]
s_waitcnt lgkmcnt(3)
v_fma_f32 v86,v86,s36,v14
v_exp_f32 v84,v84
v_mfma_f32_16x16x32_bf16 v[76:79],a[136:139],a[8:11],v[76:79]
s_waitcnt lgkmcnt(2)
v_exp_f32 v87,v87
v_mfma_f32_16x16x32_bf16 v[76:79],a[140:143],a[12:15],v[76:79]
s_waitcnt lgkmcnt(0)
v_fma_f32 v85,v85,s36,v14
v_exp_f32 v85,v85
v_mfma_f32_16x16x32_bf16 v[76:79],a[144:147],a[16:19],v[76:79]
v_cvt_pk_bf16_f32 v26,v84,v85
v_exp_f32 v86,v86
v_mfma_f32_16x16x32_bf16 v[76:79],a[148:151],a[20:23],v[76:79]
v_cvt_pk_bf16_f32 v27,v86,v87
v_fma_f32 v94,v94,s36,v15
v_mfma_f32_16x16x32_bf16 v[84:87],a[148:151],a[44:47],0
v_fma_f32 v92,v92,s36,v15
v_exp_f32 v92,v92
s_waitcnt vmcnt(7)
s_barrier
v_mfma_f32_16x16x32_bf16 v[84:87],a[144:147],a[40:43],v[84:87]
buffer_load_dwordx4 v6,s[4:7],s20 offen offset:0 lds
v_mfma_f32_16x16x32_bf16 v[84:87],a[140:143],a[36:39],v[84:87]
v_fma_f32 v93,v93,s36,v15
v_exp_f32 v93,v93
v_mfma_f32_16x16x32_bf16 v[84:87],a[136:139],a[32:35],v[84:87]
v_fma_f32 v95,v95,s36,v15
v_exp_f32 v94,v94
v_mfma_f32_16x16x32_bf16 v[84:87],a[132:135],a[28:31],v[84:87]
v_exp_f32 v95,v95
v_mfma_f32_16x16x32_bf16 v[84:87],a[128:131],a[24:27],v[84:87]
v_cvt_pk_bf16_f32 v31,v94,v95
v_cvt_pk_bf16_f32 v30,v92,v93
v_mfma_f32_16x16x32_bf16 v[92:95],a[128:131],a[48:51],0
v_fma_f32 v100,v100,s36,v16
v_fma_f32 v103,v103,s36,v16
v_mfma_f32_16x16x32_bf16 v[92:95],a[132:135],a[52:55],v[92:95]
buffer_load_dwordx4 v7,s[4:7],s20 offen offset:1024 lds
v_mfma_f32_16x16x32_bf16 v[92:95],a[136:139],a[56:59],v[92:95]
v_exp_f32 v100,v100
v_mfma_f32_16x16x32_bf16 v[92:95],a[140:143],a[60:63],v[92:95]
v_fma_f32 v101,v101,s36,v16
v_exp_f32 v103,v103
v_mfma_f32_16x16x32_bf16 v[92:95],a[144:147],a[64:67],v[92:95]
ds_read_b64_tr_b16 a[122:123],v2 offset:6144
v_exp_f32 v101,v101
v_mfma_f32_16x16x32_bf16 v[92:95],a[148:151],a[68:71],v[92:95]
ds_read_b64_tr_b16 a[120:121],v2 offset:0
buffer_load_dwordx4 v8,s[4:7],s20 offen offset:2048 lds
ds_read_b64_tr_b16 a[124:125],v3 offset:0
ds_read_b64_tr_b16 a[126:127],v3 offset:6144
v_fma_f32 v102,v102,s36,v16
v_exp_f32 v102,v102
v_cvt_pk_bf16_f32 v34,v100,v101
v_cvt_pk_bf16_f32 v35,v102,v103
v_mfma_f32_16x16x32_bf16 v[100:103],a[148:151],a[92:95],0
s_add_u32 s20,s20,12288
v_cvt_pk_bf16_f32 v184,v184,v185
v_cvt_pk_bf16_f32 v188,v188,v189
v_smfmac_f32_16x16x64_bf16 v[64:67],a[152:155],v[28:35],v18
v_mov_b32 v61,0
v_mfma_f32_16x16x32_bf16 v[100:103],a[144:147],a[88:91],v[100:103]
v_mov_b32 v60,0
v_cvt_pk_bf16_f32 v192,v192,v193
v_mfma_f32_16x16x32_bf16 v[100:103],a[140:143],a[84:87],v[100:103]
v_cvt_pk_bf16_f32 v185,v186,v187
v_cvt_pk_bf16_f32 v189,v190,v191
v_smfmac_f32_16x16x64_bf16 v[60:63],a[152:155],v[20:27],v18
ds_write2st64_b64 v38,v[168:169],v[184:185] offset0:0 offset1:2
v_mfma_f32_16x16x32_bf16 v[100:103],a[136:139],a[80:83],v[100:103]
v_fma_f32 v75,v75,s36,v13
v_fma_f32 v73,v73,s36,v13
v_mfma_f32_16x16x32_bf16 v[100:103],a[132:135],a[76:79],v[100:103]
ds_read_b64_tr_b16 a[134:135],v5 offset:6144
v_fma_f32 v74,v74,s36,v13
v_mfma_f32_16x16x32_bf16 v[100:103],a[128:131],a[72:75],v[100:103]
ds_read_b64_tr_b16 a[130:131],v4 offset:6144
ds_read_b64_tr_b16 a[128:129],v4 offset:0
ds_read_b64_tr_b16 a[132:133],v5 offset:0
v_cvt_pk_bf16_f32 v172,v172,v173
v_cvt_pk_bf16_f32 v173,v174,v175
ds_write2st64_b64 v39,v[172:173],v[188:189] offset0:0 offset1:2
v_fma_f32 v81,v81,s36,v14
v_fma_f32 v80,v80,s36,v14
v_exp_f32 v80,v80
v_fma_f32 v72,v72,s36,v13
v_exp_f32 v72,v72
v_exp_f32 v74,v74
v_cvt_pk_bf16_f32 v193,v194,v195
v_exp_f32 v81,v81
ds_write_b64 v36,v[192:193] offset:2048
v_exp_f32 v73,v73
v_cvt_pk_bf16_f32 v196,v196,v197
v_cvt_pk_bf16_f32 v197,v198,v199
ds_write_b64 v37,v[196:197] offset:2048
v_cvt_pk_bf16_f32 v204,v204,v205
v_cvt_pk_bf16_f32 v205,v206,v207
v_cvt_pk_bf16_f32 v200,v200,v201
v_exp_f32 v75,v75
v_cvt_pk_bf16_f32 v44,v72,v73
v_cvt_pk_bf16_f32 v48,v80,v81
v_cvt_pk_bf16_f32 v201,v202,v203
ds_write_b64 v38,v[200:201] offset:2048
v_cvt_pk_bf16_f32 v45,v74,v75
ds_write_b64 v39,v[204:205] offset:2048
s_waitcnt lgkmcnt(3)
v_mfma_f32_16x16x32_bf16 v[160:163],a[120:123],v[20:23],0
s_add_u32 m0,s23,0
ds_read_b64_tr_b16 a[136:137],v2 offset:128
v_fma_f32 v82,v82,s36,v14
v_mfma_f32_16x16x32_bf16 v[164:167],a[124:127],v[20:23],0
ds_read_b64_tr_b16 a[138:139],v2 offset:6272
v_fma_f32 v83,v83,s36,v14
v_mfma_f32_16x16x32_bf16 v[212:215],a[124:127],v[24:27],0
ds_read_b64_tr_b16 a[140:141],v3 offset:128
v_fma_f32 v88,v88,s36,v15
v_mfma_f32_16x16x32_bf16 v[208:211],a[120:123],v[24:27],0
ds_read_b64_tr_b16 a[142:143],v3 offset:6272
v_fma_f32 v89,v89,s36,v15
v_mfma_f32_16x16x32_bf16 v[112:115],a[120:123],v[28:31],0
ds_read_b64_tr_b16 a[144:145],v4 offset:128
v_fma_f32 v90,v90,s36,v15
v_mfma_f32_16x16x32_bf16 v[116:119],a[124:127],v[28:31],0
ds_read_b64_tr_b16 a[146:147],v4 offset:6272
v_fma_f32 v91,v91,s36,v15
v_mfma_f32_16x16x32_bf16 a[164:167],a[124:127],v[32:35],0
ds_read_b64_tr_b16 a[148:149],v5 offset:128
v_fma_f32 v96,v96,s36,v16
v_mfma_f32_16x16x32_bf16 a[160:163],a[120:123],v[32:35],0
ds_read_b64_tr_b16 a[150:151],v5 offset:6272
v_fma_f32 v97,v97,s36,v16
v_mfma_f32_16x16x32_bf16 a[168:171],a[128:131],v[32:35],0
ds_read_b64_tr_b16 a[120:121],v2 offset:256
v_fma_f32 v98,v98,s36,v16
v_mfma_f32_16x16x32_bf16 a[172:175],a[132:135],v[32:35],0
ds_read_b64_tr_b16 a[122:123],v2 offset:6400
v_fma_f32 v99,v99,s36,v16
v_mfma_f32_16x16x32_bf16 v[124:127],a[132:135],v[28:31],0
ds_read_b64_tr_b16 a[124:125],v3 offset:256
v_fma_f32 v76,v76,s36,v13
v_mfma_f32_16x16x32_bf16 v[120:123],a[128:131],v[28:31],0
ds_read_b64_tr_b16 a[126:127],v3 offset:6400
v_fma_f32 v77,v77,s36,v13
v_mfma_f32_16x16x32_bf16 v[216:219],a[128:131],v[24:27],0
v_exp_f32 v82,v82
v_mfma_f32_16x16x32_bf16 v[220:223],a[132:135],v[24:27],0
v_exp_f32 v83,v83
v_mfma_f32_16x16x32_bf16 v[172:175],a[132:135],v[20:23],0
ds_read_b64_tr_b16 a[132:133],v5 offset:256
v_cvt_pk_bf16_f32 v49,v82,v83
v_mfma_f32_16x16x32_bf16 v[168:171],a[128:131],v[20:23],0
s_waitcnt lgkmcnt(4)
ds_read_b64_tr_b16 a[128:129],v4 offset:256
v_fma_f32 v78,v78,s36,v13
v_mfma_f32_16x16x32_bf16 v[176:179],a[136:139],v[20:23],0
ds_read_b64_tr_b16 a[130:131],v4 offset:6400
v_fma_f32 v79,v79,s36,v13
v_mfma_f32_16x16x32_bf16 v[180:183],a[140:143],v[20:23],0
ds_read_b64_tr_b16 a[134:135],v5 offset:6400
v_fma_f32 v84,v84,s36,v14
v_mfma_f32_16x16x32_bf16 v[228:231],a[140:143],v[24:27],0
v_exp_f32 v88,v88
v_mfma_f32_16x16x32_bf16 v[224:227],a[136:139],v[24:27],0
v_exp_f32 v89,v89
v_mfma_f32_16x16x32_bf16 v[128:131],a[136:139],v[28:31],0
v_exp_f32 v90,v90
v_mfma_f32_16x16x32_bf16 v[132:135],a[140:143],v[28:31],0
v_exp_f32 v91,v91
v_mfma_f32_16x16x32_bf16 a[180:183],a[140:143],v[32:35],0
v_cvt_pk_bf16_f32 v52,v88,v89
v_cvt_pk_bf16_f32 v53,v90,v91
v_mfma_f32_16x16x32_bf16 a[176:179],a[136:139],v[32:35],0
v_exp_f32 v96,v96
v_mfma_f32_16x16x32_bf16 a[184:187],a[144:147],v[32:35],0
v_exp_f32 v97,v97
v_mfma_f32_16x16x32_bf16 a[188:191],a[148:151],v[32:35],0
v_exp_f32 v98,v98
v_mfma_f32_16x16x32_bf16 v[140:143],a[148:151],v[28:31],0
v_exp_f32 v99,v99
v_mfma_f32_16x16x32_bf16 v[136:139],a[144:147],v[28:31],0
v_cvt_pk_bf16_f32 v56,v96,v97
v_cvt_pk_bf16_f32 v57,v98,v99
v_mfma_f32_16x16x32_bf16 v[232:235],a[144:147],v[24:27],0
v_exp_f32 v76,v76
v_mfma_f32_16x16x32_bf16 v[236:239],a[148:151],v[24:27],0
v_exp_f32 v77,v77
v_mfma_f32_16x16x32_bf16 v[188:191],a[148:151],v[20:23],0
v_exp_f32 v78,v78
v_mfma_f32_16x16x32_bf16 v[184:187],a[144:147],v[20:23],0
s_waitcnt lgkmcnt(0)
v_exp_f32 v79,v79
v_mfma_f32_16x16x32_bf16 v[192:195],a[120:123],v[20:23],0
v_cvt_pk_bf16_f32 v46,v76,v77
v_cvt_pk_bf16_f32 v47,v78,v79
v_mfma_f32_16x16x32_bf16 v[196:199],a[124:127],v[20:23],0
s_waitcnt vmcnt(30)
v_fma_f32 v85,v85,s36,v14
v_fma_f32 v86,v86,s36,v14
v_mfma_f32_16x16x32_bf16 v[244:247],a[124:127],v[24:27],0
s_barrier
v_mfma_f32_16x16x32_bf16 v[240:243],a[120:123],v[24:27],0
ds_read_b128 a[148:151],v1 offset:24704
v_fma_f32 v87,v87,s36,v14
v_mfma_f32_16x16x32_bf16 v[144:147],a[120:123],v[28:31],0
ds_read_b128 a[144:147],v0 offset:24704
v_fma_f32 v92,v92,s36,v15
v_mfma_f32_16x16x32_bf16 v[148:151],a[124:127],v[28:31],0
ds_read_b128 a[140:143],v1 offset:24576
v_fma_f32 v93,v93,s36,v15
v_mfma_f32_16x16x32_bf16 a[196:199],a[124:127],v[32:35],0
ds_read_b128 a[124:127],v1 offset:24832
v_fma_f32 v94,v94,s36,v15
v_mfma_f32_16x16x32_bf16 a[192:195],a[120:123],v[32:35],0
ds_read_b128 a[120:123],v0 offset:24832
v_fma_f32 v95,v95,s36,v15
v_mfma_f32_16x16x32_bf16 a[200:203],a[128:131],v[32:35],0
buffer_load_dwordx4 v6,s[8:11],s21 offen offset:0 lds
v_mfma_f32_16x16x32_bf16 a[204:207],a[132:135],v[32:35],0
ds_read_b128 a[136:139],v0 offset:24576
v_fma_f32 v100,v100,s36,v16
v_mfma_f32_16x16x32_bf16 v[156:159],a[132:135],v[28:31],0
v_exp_f32 v84,v84
v_mfma_f32_16x16x32_bf16 v[152:155],a[128:131],v[28:31],0
v_exp_f32 v85,v85
v_mfma_f32_16x16x32_bf16 v[248:251],a[128:131],v[24:27],0
v_exp_f32 v86,v86
v_mfma_f32_16x16x32_bf16 v[252:255],a[132:135],v[24:27],0
v_exp_f32 v87,v87
v_mfma_f32_16x16x32_bf16 v[204:207],a[132:135],v[20:23],0
ds_read_b128 a[132:135],v1 offset:30720
v_cvt_pk_bf16_f32 v50,v84,v85
v_mfma_f32_16x16x32_bf16 v[200:203],a[128:131],v[20:23],0
s_waitcnt lgkmcnt(2)
ds_read_b128 a[128:131],v0 offset:30720
v_cvt_pk_bf16_f32 v51,v86,v87
v_mfma_f32_16x16x32_bf16 v[72:75],a[124:127],a[20:23],0
v_exp_f32 v92,v92
v_smfmac_f32_16x16x64_bf16 v[60:63],a[152:155],v[44:51],v18
buffer_load_dwordx4 v7,s[8:11],s21 offen offset:1024 lds
v_mfma_f32_16x16x32_bf16 v[72:75],a[120:123],a[16:19],v[72:75]
v_exp_f32 v93,v93
v_mfma_f32_16x16x32_bf16 v[72:75],a[148:151],a[12:15],v[72:75]
v_exp_f32 v94,v94
v_mfma_f32_16x16x32_bf16 v[72:75],a[144:147],a[8:11],v[72:75]
v_exp_f32 v95,v95
v_mfma_f32_16x16x32_bf16 v[72:75],a[140:143],a[4:7],v[72:75]
s_waitcnt lgkmcnt(1)
v_cvt_pk_bf16_f32 v54,v92,v93
v_cvt_pk_bf16_f32 v55,v94,v95
v_mfma_f32_16x16x32_bf16 v[72:75],a[136:139],a[0:3],v[72:75]
v_fma_f32 v101,v101,s36,v16
v_fma_f32 v102,v102,s36,v16
v_mfma_f32_16x16x32_bf16 v[80:83],a[136:139],a[24:27],0
v_fma_f32 v103,v103,s36,v16
v_mfma_f32_16x16x32_bf16 v[80:83],a[140:143],a[28:31],v[80:83]
v_exp_f32 v100,v100
v_mfma_f32_16x16x32_bf16 v[80:83],a[144:147],a[32:35],v[80:83]
buffer_load_dwordx4 v8,s[8:11],s21 offen offset:2048 lds
v_mfma_f32_16x16x32_bf16 v[80:83],a[148:151],a[36:39],v[80:83]
s_add_u32 s21,s21,12288
v_exp_f32 v101,v101
v_mfma_f32_16x16x32_bf16 v[80:83],a[120:123],a[40:43],v[80:83]
s_add_u32 m0,s22,12288
v_exp_f32 v102,v102
v_mfma_f32_16x16x32_bf16 v[80:83],a[124:127],a[44:47],v[80:83]
v_exp_f32 v103,v103
v_mfma_f32_16x16x32_bf16 v[88:91],a[124:127],a[68:71],0
v_cvt_pk_bf16_f32 v58,v100,v101
v_cvt_pk_bf16_f32 v59,v102,v103
v_mfma_f32_16x16x32_bf16 v[88:91],a[120:123],a[64:67],v[88:91]
v_fma_f32 v72,v72,s36,v13
v_fma_f32 v73,v73,s36,v13
v_smfmac_f32_16x16x64_bf16 v[64:67],a[152:155],v[52:59],v18
v_fma_f32 v74,v74,s36,v13
v_mfma_f32_16x16x32_bf16 v[88:91],a[148:151],a[60:63],v[88:91]
v_fma_f32 v75,v75,s36,v13
v_fma_f32 v80,v80,s36,v14
v_mfma_f32_16x16x32_bf16 v[88:91],a[144:147],a[56:59],v[88:91]
v_fma_f32 v81,v81,s36,v14
v_mfma_f32_16x16x32_bf16 v[88:91],a[140:143],a[52:55],v[88:91]
buffer_load_dwordx4 v6,s[4:7],s20 offen offset:0 lds
v_mfma_f32_16x16x32_bf16 v[88:91],a[136:139],a[48:51],v[88:91]
v_exp_f32 v72,v72
v_mfma_f32_16x16x32_bf16 v[96:99],a[136:139],a[72:75],0
ds_read_b128 a[136:139],v0 offset:30848
v_mfma_f32_16x16x32_bf16 v[96:99],a[140:143],a[76:79],v[96:99]
ds_read_b128 a[140:143],v1 offset:30848
v_mfma_f32_16x16x32_bf16 v[96:99],a[144:147],a[80:83],v[96:99]
ds_read_b128 a[144:147],v0 offset:30976
v_mfma_f32_16x16x32_bf16 v[96:99],a[148:151],a[84:87],v[96:99]
ds_read_b128 a[148:151],v1 offset:30976
v_mfma_f32_16x16x32_bf16 v[96:99],a[120:123],a[88:91],v[96:99]
v_exp_f32 v73,v73
v_mfma_f32_16x16x32_bf16 v[96:99],a[124:127],a[92:95],v[96:99]
s_waitcnt lgkmcnt(4)
v_exp_f32 v74,v74
v_mfma_f32_16x16x32_bf16 v[76:79],a[128:131],a[0:3],0
v_exp_f32 v75,v75
v_mfma_f32_16x16x32_bf16 v[76:79],a[132:135],a[4:7],v[76:79]
buffer_load_dwordx4 v7,s[4:7],s20 offen offset:1024 lds
s_waitcnt lgkmcnt(3)
v_mfma_f32_16x16x32_bf16 v[76:79],a[136:139],a[8:11],v[76:79]
s_waitcnt lgkmcnt(2)
v_exp_f32 v80,v80
v_mfma_f32_16x16x32_bf16 v[76:79],a[140:143],a[12:15],v[76:79]
s_waitcnt lgkmcnt(0)
v_exp_f32 v81,v81
v_mfma_f32_16x16x32_bf16 v[76:79],a[144:147],a[16:19],v[76:79]
v_cvt_pk_bf16_f32 v20,v72,v73
v_cvt_pk_bf16_f32 v21,v74,v75
v_mfma_f32_16x16x32_bf16 v[76:79],a[148:151],a[20:23],v[76:79]
v_cvt_pk_bf16_f32 v24,v80,v81
v_mfma_f32_16x16x32_bf16 v[84:87],a[148:151],a[44:47],0
v_mfma_f32_16x16x32_bf16 v[84:87],a[144:147],a[40:43],v[84:87]
v_mfma_f32_16x16x32_bf16 v[84:87],a[140:143],a[36:39],v[84:87]
v_mfma_f32_16x16x32_bf16 v[84:87],a[136:139],a[32:35],v[84:87]
v_mfma_f32_16x16x32_bf16 v[84:87],a[132:135],a[28:31],v[84:87]
buffer_load_dwordx4 v8,s[4:7],s20 offen offset:2048 lds
v_mfma_f32_16x16x32_bf16 v[84:87],a[128:131],a[24:27],v[84:87]
s_add_u32 s20,s20,12288
v_mfma_f32_16x16x32_bf16 v[92:95],a[128:131],a[48:51],0
ds_read_b64_tr_b16 a[120:121],v2 offset:12288
v_mfma_f32_16x16x32_bf16 v[92:95],a[132:135],a[52:55],v[92:95]
ds_read_b64_tr_b16 a[122:123],v2 offset:18432
v_mfma_f32_16x16x32_bf16 v[92:95],a[136:139],a[56:59],v[92:95]
ds_read_b64_tr_b16 a[124:125],v3 offset:12288
v_mfma_f32_16x16x32_bf16 v[92:95],a[140:143],a[60:63],v[92:95]
ds_read_b64_tr_b16 a[126:127],v3 offset:18432
v_mfma_f32_16x16x32_bf16 v[92:95],a[144:147],a[64:67],v[92:95]
v_mfma_f32_16x16x32_bf16 v[92:95],a[148:151],a[68:71],v[92:95]
v_mfma_f32_16x16x32_bf16 v[100:103],a[148:151],a[92:95],0
v_mfma_f32_16x16x32_bf16 v[100:103],a[144:147],a[88:91],v[100:103]
v_mfma_f32_16x16x32_bf16 v[100:103],a[140:143],a[84:87],v[100:103]
v_mfma_f32_16x16x32_bf16 v[100:103],a[136:139],a[80:83],v[100:103]
v_mfma_f32_16x16x32_bf16 v[100:103],a[132:135],a[76:79],v[100:103]
ds_read_b64_tr_b16 a[132:133],v5 offset:12288
v_mfma_f32_16x16x32_bf16 v[100:103],a[128:131],a[72:75],v[100:103]
s_waitcnt lgkmcnt(1)
ds_read_b64_tr_b16 a[128:129],v4 offset:12288
ds_read_b64_tr_b16 a[130:131],v4 offset:18432
ds_read_b64_tr_b16 a[134:135],v5 offset:18432
v_mfma_f32_16x16x32_bf16 v[160:163],a[120:123],v[44:47],v[160:163]
s_add_u32 m0,s23,12288
ds_read_b64_tr_b16 a[136:137],v2 offset:12416
v_fma_f32 v82,v82,s36,v14
v_mfma_f32_16x16x32_bf16 v[164:167],a[124:127],v[44:47],v[164:167]
ds_read_b64_tr_b16 a[138:139],v2 offset:18560
v_fma_f32 v83,v83,s36,v14
v_mfma_f32_16x16x32_bf16 v[212:215],a[124:127],v[48:51],v[212:215]
ds_read_b64_tr_b16 a[140:141],v3 offset:12416
v_fma_f32 v88,v88,s36,v15
v_mfma_f32_16x16x32_bf16 v[208:211],a[120:123],v[48:51],v[208:211]
ds_read_b64_tr_b16 a[142:143],v3 offset:18560
v_fma_f32 v89,v89,s36,v15
v_mfma_f32_16x16x32_bf16 v[112:115],a[120:123],v[52:55],v[112:115]
ds_read_b64_tr_b16 a[144:145],v4 offset:12416
v_fma_f32 v90,v90,s36,v15
v_mfma_f32_16x16x32_bf16 v[116:119],a[124:127],v[52:55],v[116:119]
ds_read_b64_tr_b16 a[146:147],v4 offset:18560
v_fma_f32 v91,v91,s36,v15
v_mfma_f32_16x16x32_bf16 a[164:167],a[124:127],v[56:59],a[164:167]
ds_read_b64_tr_b16 a[148:149],v5 offset:12416
v_fma_f32 v96,v96,s36,v16
v_mfma_f32_16x16x32_bf16 a[160:163],a[120:123],v[56:59],a[160:163]
s_waitcnt lgkmcnt(6)
ds_read_b64_tr_b16 a[150:151],v5 offset:18560
v_fma_f32 v97,v97,s36,v16
v_mfma_f32_16x16x32_bf16 a[168:171],a[128:131],v[56:59],a[168:171]
ds_read_b64_tr_b16 a[120:121],v2 offset:12544
v_fma_f32 v98,v98,s36,v16
v_mfma_f32_16x16x32_bf16 a[172:175],a[132:135],v[56:59],a[172:175]
ds_read_b64_tr_b16 a[122:123],v2 offset:18688
v_fma_f32 v99,v99,s36,v16
v_mfma_f32_16x16x32_bf16 v[124:127],a[132:135],v[52:55],v[124:127]
ds_read_b64_tr_b16 a[124:125],v3 offset:12544
v_fma_f32 v76,v76,s36,v13
v_mfma_f32_16x16x32_bf16 v[120:123],a[128:131],v[52:55],v[120:123]
ds_read_b64_tr_b16 a[126:127],v3 offset:18688
v_fma_f32 v77,v77,s36,v13
v_mfma_f32_16x16x32_bf16 v[216:219],a[128:131],v[48:51],v[216:219]
v_exp_f32 v82,v82
v_mfma_f32_16x16x32_bf16 v[220:223],a[132:135],v[48:51],v[220:223]
v_exp_f32 v83,v83
v_mfma_f32_16x16x32_bf16 v[172:175],a[132:135],v[44:47],v[172:175]
ds_read_b64_tr_b16 a[132:133],v5 offset:12544
v_cvt_pk_bf16_f32 v25,v82,v83
v_mfma_f32_16x16x32_bf16 v[168:171],a[128:131],v[44:47],v[168:171]
s_waitcnt lgkmcnt(4)
ds_read_b64_tr_b16 a[128:129],v4 offset:12544
v_fma_f32 v78,v78,s36,v13
v_mfma_f32_16x16x32_bf16 v[176:179],a[136:139],v[44:47],v[176:179]
ds_read_b64_tr_b16 a[130:131],v4 offset:18688
v_fma_f32 v79,v79,s36,v13
v_mfma_f32_16x16x32_bf16 v[180:183],a[140:143],v[44:47],v[180:183]
ds_read_b64_tr_b16 a[134:135],v5 offset:18688
v_fma_f32 v84,v84,s36,v14
v_mfma_f32_16x16x32_bf16 v[228:231],a[140:143],v[48:51],v[228:231]
v_exp_f32 v88,v88
v_mfma_f32_16x16x32_bf16 v[224:227],a[136:139],v[48:51],v[224:227]
v_exp_f32 v89,v89
v_mfma_f32_16x16x32_bf16 v[128:131],a[136:139],v[52:55],v[128:131]
v_exp_f32 v90,v90
v_mfma_f32_16x16x32_bf16 v[132:135],a[140:143],v[52:55],v[132:135]
v_exp_f32 v91,v91
v_mfma_f32_16x16x32_bf16 a[180:183],a[140:143],v[56:59],a[180:183]
v_cvt_pk_bf16_f32 v28,v88,v89
v_cvt_pk_bf16_f32 v29,v90,v91
v_mfma_f32_16x16x32_bf16 a[176:179],a[136:139],v[56:59],a[176:179]
v_exp_f32 v96,v96
v_mfma_f32_16x16x32_bf16 a[184:187],a[144:147],v[56:59],a[184:187]
v_exp_f32 v97,v97
v_mfma_f32_16x16x32_bf16 a[188:191],a[148:151],v[56:59],a[188:191]
v_exp_f32 v98,v98
v_mfma_f32_16x16x32_bf16 v[140:143],a[148:151],v[52:55],v[140:143]
v_exp_f32 v99,v99
v_mfma_f32_16x16x32_bf16 v[136:139],a[144:147],v[52:55],v[136:139]
v_cvt_pk_bf16_f32 v32,v96,v97
v_cvt_pk_bf16_f32 v33,v98,v99
v_mfma_f32_16x16x32_bf16 v[232:235],a[144:147],v[48:51],v[232:235]
v_exp_f32 v76,v76
v_mfma_f32_16x16x32_bf16 v[236:239],a[148:151],v[48:51],v[236:239]
v_exp_f32 v77,v77
v_mfma_f32_16x16x32_bf16 v[188:191],a[148:151],v[44:47],v[188:191]
v_exp_f32 v78,v78
v_mfma_f32_16x16x32_bf16 v[184:187],a[144:147],v[44:47],v[184:187]
s_waitcnt lgkmcnt(0)
v_exp_f32 v79,v79
v_mfma_f32_16x16x32_bf16 v[192:195],a[120:123],v[44:47],v[192:195]
v_cvt_pk_bf16_f32 v22,v76,v77
v_cvt_pk_bf16_f32 v23,v78,v79
v_mfma_f32_16x16x32_bf16 v[196:199],a[124:127],v[44:47],v[196:199]
s_waitcnt vmcnt(6)
v_fma_f32 v85,v85,s36,v14
v_fma_f32 v86,v86,s36,v14
v_mfma_f32_16x16x32_bf16 v[244:247],a[124:127],v[48:51],v[244:247]
s_barrier
v_mfma_f32_16x16x32_bf16 v[240:243],a[120:123],v[48:51],v[240:243]
ds_read_b128 a[148:151],v1 offset:128
v_fma_f32 v87,v87,s36,v14
v_mfma_f32_16x16x32_bf16 v[144:147],a[120:123],v[52:55],v[144:147]
ds_read_b128 a[144:147],v0 offset:128
v_fma_f32 v92,v92,s36,v15
v_mfma_f32_16x16x32_bf16 v[148:151],a[124:127],v[52:55],v[148:151]
ds_read_b128 a[140:143],v1 offset:0
v_fma_f32 v93,v93,s36,v15
v_mfma_f32_16x16x32_bf16 a[196:199],a[124:127],v[56:59],a[196:199]
ds_read_b128 a[124:127],v1 offset:256
v_fma_f32 v94,v94,s36,v15
v_mfma_f32_16x16x32_bf16 a[192:195],a[120:123],v[56:59],a[192:195]
ds_read_b128 a[120:123],v0 offset:256
v_fma_f32 v95,v95,s36,v15
v_mfma_f32_16x16x32_bf16 a[200:203],a[128:131],v[56:59],a[200:203]
buffer_load_dwordx4 v6,s[8:11],s21 offen offset:0 lds
v_mfma_f32_16x16x32_bf16 a[204:207],a[132:135],v[56:59],a[204:207]
ds_read_b128 a[136:139],v0 offset:0
v_fma_f32 v100,v100,s36,v16
v_mfma_f32_16x16x32_bf16 v[156:159],a[132:135],v[52:55],v[156:159]
v_exp_f32 v84,v84
v_mfma_f32_16x16x32_bf16 v[152:155],a[128:131],v[52:55],v[152:155]
v_exp_f32 v85,v85
v_mfma_f32_16x16x32_bf16 v[248:251],a[128:131],v[48:51],v[248:251]
v_exp_f32 v86,v86
v_mfma_f32_16x16x32_bf16 v[252:255],a[132:135],v[48:51],v[252:255]
v_exp_f32 v87,v87
v_mfma_f32_16x16x32_bf16 v[204:207],a[132:135],v[44:47],v[204:207]
ds_read_b128 a[132:135],v1 offset:6144
v_cvt_pk_bf16_f32 v26,v84,v85
v_mfma_f32_16x16x32_bf16 v[200:203],a[128:131],v[44:47],v[200:203]
s_waitcnt lgkmcnt(2)
ds_read_b128 a[128:131],v0 offset:6144
v_cvt_pk_bf16_f32 v27,v86,v87
v_mfma_f32_16x16x32_bf16 v[72:75],a[124:127],a[20:23],0
v_exp_f32 v92,v92
v_smfmac_f32_16x16x64_bf16 v[60:63],a[152:155],v[20:27],v18
buffer_load_dwordx4 v7,s[8:11],s21 offen offset:1024 lds
v_mfma_f32_16x16x32_bf16 v[72:75],a[120:123],a[16:19],v[72:75]
v_exp_f32 v93,v93
v_mfma_f32_16x16x32_bf16 v[72:75],a[148:151],a[12:15],v[72:75]
v_exp_f32 v94,v94
v_mfma_f32_16x16x32_bf16 v[72:75],a[144:147],a[8:11],v[72:75]
v_exp_f32 v95,v95
v_mfma_f32_16x16x32_bf16 v[72:75],a[140:143],a[4:7],v[72:75]
s_waitcnt lgkmcnt(1)
v_cvt_pk_bf16_f32 v30,v92,v93
v_cvt_pk_bf16_f32 v31,v94,v95
v_mfma_f32_16x16x32_bf16 v[72:75],a[136:139],a[0:3],v[72:75]
v_fma_f32 v101,v101,s36,v16
v_fma_f32 v102,v102,s36,v16
v_mfma_f32_16x16x32_bf16 v[80:83],a[136:139],a[24:27],0
v_fma_f32 v103,v103,s36,v16
v_mfma_f32_16x16x32_bf16 v[80:83],a[140:143],a[28:31],v[80:83]
v_exp_f32 v100,v100
v_mfma_f32_16x16x32_bf16 v[80:83],a[144:147],a[32:35],v[80:83]
buffer_load_dwordx4 v8,s[8:11],s21 offen offset:2048 lds
v_mfma_f32_16x16x32_bf16 v[80:83],a[148:151],a[36:39],v[80:83]
s_add_u32 s21,s21,12288
v_exp_f32 v101,v101
v_mfma_f32_16x16x32_bf16 v[80:83],a[120:123],a[40:43],v[80:83]
s_add_u32 m0,s22,24576
v_exp_f32 v102,v102
v_mfma_f32_16x16x32_bf16 v[80:83],a[124:127],a[44:47],v[80:83]
v_exp_f32 v103,v103
v_mfma_f32_16x16x32_bf16 v[88:91],a[124:127],a[68:71],0
v_cvt_pk_bf16_f32 v34,v100,v101
v_cvt_pk_bf16_f32 v35,v102,v103
v_mfma_f32_16x16x32_bf16 v[88:91],a[120:123],a[64:67],v[88:91]
v_fma_f32 v72,v72,s36,v13
v_fma_f32 v73,v73,s36,v13
v_smfmac_f32_16x16x64_bf16 v[64:67],a[152:155],v[28:35],v18
v_fma_f32 v74,v74,s36,v13
v_mfma_f32_16x16x32_bf16 v[88:91],a[148:151],a[60:63],v[88:91]
v_fma_f32 v75,v75,s36,v13
v_fma_f32 v80,v80,s36,v14
v_mfma_f32_16x16x32_bf16 v[88:91],a[144:147],a[56:59],v[88:91]
v_fma_f32 v81,v81,s36,v14
v_mfma_f32_16x16x32_bf16 v[88:91],a[140:143],a[52:55],v[88:91]
buffer_load_dwordx4 v6,s[4:7],s20 offen offset:0 lds
v_mfma_f32_16x16x32_bf16 v[88:91],a[136:139],a[48:51],v[88:91]
v_exp_f32 v72,v72
v_mfma_f32_16x16x32_bf16 v[96:99],a[136:139],a[72:75],0
ds_read_b128 a[136:139],v0 offset:6272
v_mfma_f32_16x16x32_bf16 v[96:99],a[140:143],a[76:79],v[96:99]
ds_read_b128 a[140:143],v1 offset:6272
v_mfma_f32_16x16x32_bf16 v[96:99],a[144:147],a[80:83],v[96:99]
ds_read_b128 a[144:147],v0 offset:6400
v_mfma_f32_16x16x32_bf16 v[96:99],a[148:151],a[84:87],v[96:99]
ds_read_b128 a[148:151],v1 offset:6400
v_mfma_f32_16x16x32_bf16 v[96:99],a[120:123],a[88:91],v[96:99]
v_exp_f32 v73,v73
v_mfma_f32_16x16x32_bf16 v[96:99],a[124:127],a[92:95],v[96:99]
s_waitcnt lgkmcnt(4)
v_exp_f32 v74,v74
v_mfma_f32_16x16x32_bf16 v[76:79],a[128:131],a[0:3],0
v_exp_f32 v75,v75
v_mfma_f32_16x16x32_bf16 v[76:79],a[132:135],a[4:7],v[76:79]
buffer_load_dwordx4 v7,s[4:7],s20 offen offset:1024 lds
s_waitcnt lgkmcnt(3)
v_mfma_f32_16x16x32_bf16 v[76:79],a[136:139],a[8:11],v[76:79]
s_waitcnt lgkmcnt(2)
v_exp_f32 v80,v80
v_mfma_f32_16x16x32_bf16 v[76:79],a[140:143],a[12:15],v[76:79]
s_waitcnt lgkmcnt(0)
v_exp_f32 v81,v81
v_mfma_f32_16x16x32_bf16 v[76:79],a[144:147],a[16:19],v[76:79]
v_cvt_pk_bf16_f32 v44,v72,v73
v_cvt_pk_bf16_f32 v45,v74,v75
v_mfma_f32_16x16x32_bf16 v[76:79],a[148:151],a[20:23],v[76:79]
v_cvt_pk_bf16_f32 v48,v80,v81
v_mfma_f32_16x16x32_bf16 v[84:87],a[148:151],a[44:47],0
v_mfma_f32_16x16x32_bf16 v[84:87],a[144:147],a[40:43],v[84:87]
v_mfma_f32_16x16x32_bf16 v[84:87],a[140:143],a[36:39],v[84:87]
v_mfma_f32_16x16x32_bf16 v[84:87],a[136:139],a[32:35],v[84:87]
v_mfma_f32_16x16x32_bf16 v[84:87],a[132:135],a[28:31],v[84:87]
buffer_load_dwordx4 v8,s[4:7],s20 offen offset:2048 lds
v_mfma_f32_16x16x32_bf16 v[84:87],a[128:131],a[24:27],v[84:87]
s_add_u32 s20,s20,12288
v_mfma_f32_16x16x32_bf16 v[92:95],a[128:131],a[48:51],0
ds_read_b64_tr_b16 a[120:121],v2 offset:24576
v_mfma_f32_16x16x32_bf16 v[92:95],a[132:135],a[52:55],v[92:95]
ds_read_b64_tr_b16 a[122:123],v2 offset:30720
v_mfma_f32_16x16x32_bf16 v[92:95],a[136:139],a[56:59],v[92:95]
ds_read_b64_tr_b16 a[124:125],v3 offset:24576
v_mfma_f32_16x16x32_bf16 v[92:95],a[140:143],a[60:63],v[92:95]
ds_read_b64_tr_b16 a[126:127],v3 offset:30720
v_mfma_f32_16x16x32_bf16 v[92:95],a[144:147],a[64:67],v[92:95]
v_mfma_f32_16x16x32_bf16 v[92:95],a[148:151],a[68:71],v[92:95]
v_mfma_f32_16x16x32_bf16 v[100:103],a[148:151],a[92:95],0
v_mfma_f32_16x16x32_bf16 v[100:103],a[144:147],a[88:91],v[100:103]
v_mfma_f32_16x16x32_bf16 v[100:103],a[140:143],a[84:87],v[100:103]
v_mfma_f32_16x16x32_bf16 v[100:103],a[136:139],a[80:83],v[100:103]
v_mfma_f32_16x16x32_bf16 v[100:103],a[132:135],a[76:79],v[100:103]
ds_read_b64_tr_b16 a[132:133],v5 offset:24576
v_mfma_f32_16x16x32_bf16 v[100:103],a[128:131],a[72:75],v[100:103]
ds_read_b64_tr_b16 a[128:129],v4 offset:24576
ds_read_b64_tr_b16 a[130:131],v4 offset:30720
ds_read_b64_tr_b16 a[134:135],v5 offset:30720
s_mov_b32 s38,0
s_branch L_loop4
L_tr55:
s_waitcnt vmcnt(42)
s_waitcnt lgkmcnt(3)
v_mfma_f32_16x16x32_bf16 v[160:163],a[120:123],v[20:23],v[160:163]
s_add_u32 m0,s24,0
ds_read_b128 a[12:15],v12 offset:128
v_fma_f32 v101,v101,s36,v16
v_mfma_f32_16x16x32_bf16 v[164:167],a[124:127],v[20:23],v[164:167]
ds_read_b128 a[20:23],v12 offset:256
v_fma_f32 v103,v103,s36,v16
v_mfma_f32_16x16x32_bf16 v[212:215],a[124:127],v[24:27],v[212:215]
ds_read_b128 a[4:7],v12 offset:0
v_fma_f32 v87,v87,s36,v14
v_mfma_f32_16x16x32_bf16 v[208:211],a[120:123],v[24:27],v[208:211]
ds_read_b128 a[16:19],v11 offset:256
v_fma_f32 v106,v106,s36,v17
v_mfma_f32_16x16x32_bf16 v[112:115],a[120:123],v[28:31],v[112:115]
ds_read_b128 a[0:3],v11 offset:0
v_fma_f32 v99,v99,s36,v16
v_mfma_f32_16x16x32_bf16 v[116:119],a[124:127],v[28:31],v[116:119]
ds_read_b128 a[8:11],v11 offset:128
v_fma_f32 v96,v96,s36,v16
v_mfma_f32_16x16x32_bf16 a[164:167],a[124:127],v[32:35],a[164:167]
ds_read_b64_tr_b16 a[136:137],v2 offset:24704
v_fma_f32 v77,v77,s36,v13
v_mfma_f32_16x16x32_bf16 a[160:163],a[120:123],v[32:35],a[160:163]
ds_read_b64_tr_b16 a[138:139],v2 offset:30848
v_fma_f32 v85,v85,s36,v14
v_mfma_f32_16x16x32_bf16 a[208:211],a[120:123],v[36:39],a[208:211]
ds_read_b64_tr_b16 a[140:141],v3 offset:24704
ds_read_b64_tr_b16 a[142:143],v3 offset:30848
ds_read_b64_tr_b16 a[144:145],v4 offset:24704
ds_read_b64_tr_b16 a[146:147],v4 offset:30848
ds_read_b64_tr_b16 a[150:151],v5 offset:30848
ds_read_b64_tr_b16 a[148:149],v5 offset:24704
ds_read_b128 a[40:43],v11 offset:6400
v_mfma_f32_16x16x32_bf16 a[212:215],a[124:127],v[36:39],a[212:215]
s_waitcnt lgkmcnt(11)
v_fma_f32 v84,v84,s36,v14
ds_read_b128 a[32:35],v11 offset:6272
v_mfma_f32_16x16x32_bf16 a[216:219],a[128:131],v[36:39],a[216:219]
s_waitcnt lgkmcnt(10)
buffer_load_dwordx4 v6,s[12:15],s28 offen offset:0 nt lds
v_mfma_f32_16x16x32_bf16 a[220:223],a[132:135],v[36:39],a[220:223]
ds_read_b64_tr_b16 a[122:123],v2 offset:30976
ds_read_b128 a[44:47],v12 offset:6400
v_mfma_f32_16x16x32_bf16 a[172:175],a[132:135],v[32:35],a[172:175]
v_exp_f32 v101,v101
ds_read_b64_tr_b16 a[120:121],v2 offset:24832
ds_read_b128 a[24:27],v11 offset:6144
v_mfma_f32_16x16x32_bf16 a[168:171],a[128:131],v[32:35],a[168:171]
v_exp_f32 v77,v77
ds_read_b128 a[28:31],v12 offset:6144
v_mfma_f32_16x16x32_bf16 v[120:123],a[128:131],v[28:31],v[120:123]
v_fma_f32 v111,v111,s36,v17
ds_read_b64_tr_b16 a[126:127],v3 offset:30976
ds_read_b64_tr_b16 a[124:125],v3 offset:24832
ds_read_b128 a[36:39],v12 offset:6272
v_mfma_f32_16x16x32_bf16 v[124:127],a[132:135],v[28:31],v[124:127]
buffer_load_dwordx4 v7,s[12:15],s28 offen offset:1024 nt lds
v_mfma_f32_16x16x32_bf16 v[220:223],a[132:135],v[24:27],v[220:223]
v_fma_f32 v95,v95,s36,v15
v_fma_f32 v100,v100,s36,v16
v_mfma_f32_16x16x32_bf16 v[216:219],a[128:131],v[24:27],v[216:219]
v_exp_f32 v106,v106
v_mfma_f32_16x16x32_bf16 v[168:171],a[128:131],v[20:23],v[168:171]
ds_read_b64_tr_b16 a[130:131],v4 offset:30976
v_fma_f32 v93,v93,s36,v15
v_mfma_f32_16x16x32_bf16 v[172:175],a[132:135],v[20:23],v[172:175]
s_waitcnt lgkmcnt(4)
ds_read_b64_tr_b16 a[128:129],v4 offset:24832
v_exp_f32 v111,v111
v_mfma_f32_16x16x32_bf16 v[176:179],a[136:139],v[20:23],v[176:179]
ds_read_b64_tr_b16 a[132:133],v5 offset:24832
buffer_load_dwordx4 v8,s[12:15],s28 offen offset:2048 nt lds
v_mfma_f32_16x16x32_bf16 v[180:183],a[140:143],v[20:23],v[180:183]
s_add_u32 s28,s28,3072
ds_read_b64_tr_b16 a[134:135],v5 offset:30976
v_fma_f32 v107,v107,s36,v17
v_mfma_f32_16x16x32_bf16 v[228:231],a[140:143],v[24:27],v[228:231]
s_add_u32 m0,s24,3072
v_fma_f32 v92,v92,s36,v15
v_exp_f32 v92,v92
v_mfma_f32_16x16x32_bf16 v[224:227],a[136:139],v[24:27],v[224:227]
v_fma_f32 v109,v109,s36,v17
v_exp_f32 v109,v109
v_mfma_f32_16x16x32_bf16 v[128:131],a[136:139],v[28:31],v[128:131]
v_fma_f32 v97,v97,s36,v16
v_exp_f32 v84,v84
v_mfma_f32_16x16x32_bf16 v[132:135],a[140:143],v[28:31],v[132:135]
v_fma_f32 v94,v94,s36,v15
v_exp_f32 v94,v94
v_mfma_f32_16x16x32_bf16 a[180:183],a[140:143],v[32:35],a[180:183]
v_fma_f32 v104,v104,s36,v17
v_fma_f32 v90,v90,s36,v15
v_mfma_f32_16x16x32_bf16 a[176:179],a[136:139],v[32:35],a[176:179]
buffer_load_dwordx4 v6,s[12:15],s28 offen offset:0 nt lds
v_mfma_f32_16x16x32_bf16 a[224:227],a[136:139],v[36:39],a[224:227]
v_exp_f32 v93,v93
v_mfma_f32_16x16x32_bf16 a[228:231],a[140:143],v[36:39],a[228:231]
v_exp_f32 v104,v104
v_mfma_f32_16x16x32_bf16 a[232:235],a[144:147],v[36:39],a[232:235]
v_exp_f32 v96,v96
v_mfma_f32_16x16x32_bf16 a[236:239],a[148:151],v[36:39],a[236:239]
v_fma_f32 v78,v78,s36,v13
v_exp_f32 v78,v78
v_mfma_f32_16x16x32_bf16 a[188:191],a[148:151],v[32:35],a[188:191]
v_fma_f32 v110,v110,s36,v17
v_exp_f32 v110,v110
v_mfma_f32_16x16x32_bf16 a[184:187],a[144:147],v[32:35],a[184:187]
v_exp_f32 v97,v97
v_mfma_f32_16x16x32_bf16 v[136:139],a[144:147],v[28:31],v[136:139]
v_exp_f32 v100,v100
v_mfma_f32_16x16x32_bf16 v[140:143],a[148:151],v[28:31],v[140:143]
buffer_load_dwordx4 v7,s[12:15],s28 offen offset:1024 nt lds
v_mfma_f32_16x16x32_bf16 v[236:239],a[148:151],v[24:27],v[236:239]
v_fma_f32 v102,v102,s36,v16
v_exp_f32 v102,v102
v_mfma_f32_16x16x32_bf16 v[232:235],a[144:147],v[24:27],v[232:235]
v_fma_f32 v79,v79,s36,v13
v_exp_f32 v79,v79
v_mfma_f32_16x16x32_bf16 v[184:187],a[144:147],v[20:23],v[184:187]
v_exp_f32 v85,v85
v_mfma_f32_16x16x32_bf16 v[188:191],a[148:151],v[20:23],v[188:191]
v_fma_f32 v108,v108,s36,v17
v_exp_f32 v108,v108
v_mfma_f32_16x16x32_bf16 v[192:195],a[120:123],v[20:23],v[192:195]
s_waitcnt lgkmcnt(0)
v_fma_f32 v98,v98,s36,v16
v_exp_f32 v87,v87
v_mfma_f32_16x16x32_bf16 v[196:199],a[124:127],v[20:23],v[196:199]
v_fma_f32 v76,v76,s36,v13
v_exp_f32 v76,v76
v_mfma_f32_16x16x32_bf16 v[244:247],a[124:127],v[24:27],v[244:247]
buffer_load_dwordx4 v8,s[12:15],s28 offen offset:2048 nt lds
s_waitcnt vmcnt(20)
s_barrier
v_mfma_f32_16x16x32_bf16 v[240:243],a[120:123],v[24:27],v[240:243]
s_add_u32 s28,s28,3072
v_fma_f32 v105,v105,s36,v17
v_exp_f32 v107,v107
v_mfma_f32_16x16x32_bf16 v[144:147],a[120:123],v[28:31],v[144:147]
s_add_u32 m0,s22,0
v_fma_f32 v91,v91,s36,v15
v_exp_f32 v91,v91
v_mfma_f32_16x16x32_bf16 v[148:151],a[124:127],v[28:31],v[148:151]
buffer_load_dwordx4 v6,s[4:7],s25 offen offset:0 lds
v_mfma_f32_16x16x32_bf16 a[196:199],a[124:127],v[32:35],a[196:199]
buffer_load_dwordx4 v7,s[4:7],s25 offen offset:1024 lds
v_mfma_f32_16x16x32_bf16 a[192:195],a[120:123],v[32:35],a[192:195]
buffer_load_dwordx4 v8,s[4:7],s25 offen offset:2048 lds
v_mfma_f32_16x16x32_bf16 a[240:243],a[120:123],v[36:39],a[240:243]
v_fma_f32 v86,v86,s36,v14
v_exp_f32 v86,v86
v_mfma_f32_16x16x32_bf16 a[244:247],a[124:127],v[36:39],a[244:247]
v_exp_f32 v95,v95
v_mfma_f32_16x16x32_bf16 a[248:251],a[128:131],v[36:39],a[248:251]
v_exp_f32 v103,v103
v_mfma_f32_16x16x32_bf16 a[252:255],a[132:135],v[36:39],a[252:255]
ds_read_b64_tr_b16 a[136:137],v2 offset:0
v_cvt_pk_bf16_f32 v41,v106,v107
v_mfma_f32_16x16x32_bf16 a[204:207],a[132:135],v[32:35],a[204:207]
ds_read_b64_tr_b16 a[138:139],v2 offset:6144
v_exp_f32 v99,v99
v_mfma_f32_16x16x32_bf16 a[200:203],a[128:131],v[32:35],a[200:203]
ds_read_b64_tr_b16 a[140:141],v3 offset:0
v_cvt_pk_bf16_f32 v42,v108,v109
v_mfma_f32_16x16x32_bf16 v[152:155],a[128:131],v[28:31],v[152:155]
ds_read_b64_tr_b16 a[142:143],v3 offset:6144
v_cvt_pk_bf16_f32 v50,v84,v85
v_mfma_f32_16x16x32_bf16 v[156:159],a[132:135],v[28:31],v[156:159]
ds_read_b64_tr_b16 a[144:145],v4 offset:0
v_exp_f32 v90,v90
v_mfma_f32_16x16x32_bf16 v[252:255],a[132:135],v[24:27],v[252:255]
ds_read_b64_tr_b16 a[146:147],v4 offset:6144
v_exp_f32 v105,v105
v_mfma_f32_16x16x32_bf16 v[248:251],a[128:131],v[24:27],v[248:251]
ds_read_b64_tr_b16 a[148:149],v5 offset:0
v_cvt_pk_bf16_f32 v55,v94,v95
v_mfma_f32_16x16x32_bf16 v[200:203],a[128:131],v[20:23],v[200:203]
ds_read_b64_tr_b16 a[150:151],v5 offset:6144
v_cvt_pk_bf16_f32 v51,v86,v87
v_mfma_f32_16x16x32_bf16 v[204:207],a[132:135],v[20:23],v[204:207]
v_cvt_pk_bf16_f32 v59,v102,v103
v_exp_f32 v98,v98
v_cvt_pk_bf16_f32 v54,v92,v93
v_cvt_pk_bf16_f32 v56,v96,v97
v_cvt_pk_bf16_f32 v53,v90,v91
v_cvt_pk_bf16_f32 v47,v78,v79
v_cvt_pk_bf16_f32 v43,v110,v111
v_cvt_pk_bf16_f32 v58,v100,v101
v_cvt_pk_bf16_f32 v46,v76,v77
v_cvt_pk_bf16_f32 v57,v98,v99
v_cvt_pk_bf16_f32 v40,v104,v105
v_smfmac_f32_16x16x64_bf16 v[60:63],a[152:155],v[44:51],v18
v_subrev_u32 v10,18432,v10
v_smfmac_f32_16x16x64_bf16 v[64:67],a[152:155],v[52:59],v18
v_smfmac_f32_16x16x64_bf16 v[68:71],a[152:155],v[36:43],v18
s_waitcnt lgkmcnt(1)
v_mfma_f32_16x16x32_bf16 v[160:163],a[136:139],v[44:47],v[160:163]
s_add_u32 s87,s42,18432
ds_read_b64_tr_b16 a[120:121],v2 offset:128
v_mbcnt_lo_u32_b32 v39,-1,0
v_mfma_f32_16x16x32_bf16 v[164:167],a[140:143],v[44:47],v[164:167]
s_add_u32 s66,s42,24576
ds_read_b64_tr_b16 a[122:123],v2 offset:6272
v_mbcnt_hi_u32_b32 v39,-1,v39
v_mfma_f32_16x16x32_bf16 v[212:215],a[140:143],v[48:51],v[212:215]
ds_read_b64_tr_b16 a[124:125],v3 offset:128
v_and_b32 v38,7,v39
v_mfma_f32_16x16x32_bf16 v[208:211],a[136:139],v[48:51],v[208:211]
ds_read_b64_tr_b16 a[126:127],v3 offset:6272
v_add_f32 v68,v68,v69
v_mfma_f32_16x16x32_bf16 v[112:115],a[136:139],v[52:55],v[112:115]
ds_read_b64_tr_b16 a[128:129],v4 offset:128
v_add_f32 v60,v60,v61
v_mfma_f32_16x16x32_bf16 v[116:119],a[140:143],v[52:55],v[116:119]
ds_read_b64_tr_b16 a[130:131],v4 offset:6272
ds_read_b64_tr_b16 a[132:133],v5 offset:128
ds_read_b64_tr_b16 a[134:135],v5 offset:6272
v_mfma_f32_16x16x32_bf16 a[164:167],a[140:143],v[56:59],a[164:167]
v_add_f32 v62,v62,v63
v_add_f32 v64,v64,v65
v_mfma_f32_16x16x32_bf16 a[160:163],a[136:139],v[56:59],a[160:163]
v_add_f32 v68,v68,v70
v_add_f32 v66,v66,v67
v_mfma_f32_16x16x32_bf16 a[208:211],a[136:139],v[40:43],a[208:211]
ds_read_b64_tr_b16 a[136:137],v2 offset:256
v_max3_f32 v19,v60,v62,v64
v_mfma_f32_16x16x32_bf16 a[212:215],a[140:143],v[40:43],a[212:215]
ds_read_b64_tr_b16 a[138:139],v2 offset:6400
v_add_f32 v68,v68,v71
v_mfma_f32_16x16x32_bf16 a[216:219],a[144:147],v[40:43],a[216:219]
s_waitcnt lgkmcnt(6)
ds_read_b64_tr_b16 a[140:141],v3 offset:256
v_max3_f32 v19,v19,v66,v68
v_mfma_f32_16x16x32_bf16 a[220:223],a[148:151],v[40:43],a[220:223]
ds_read_b64_tr_b16 a[142:143],v3 offset:6400
v_rcp_f32 v66,v66
v_rcp_f32 v68,v68
v_accvgpr_read_b32 v72,a160
v_accvgpr_read_b32 v73,a161
v_pk_mul_f32 v[72:73],v[72:73],v[66:67] op_sel_hi:[1,0]
v_accvgpr_read_b32 v74,a162
v_accvgpr_read_b32 v75,a163
v_pk_mul_f32 v[74:75],v[74:75],v[66:67] op_sel_hi:[1,0]
v_accvgpr_read_b32 v76,a208
v_accvgpr_read_b32 v77,a209
v_pk_mul_f32 v[76:77],v[76:77],v[68:69] op_sel_hi:[1,0]
v_accvgpr_read_b32 v78,a210
v_accvgpr_read_b32 v79,a211
v_pk_mul_f32 v[78:79],v[78:79],v[68:69] op_sel_hi:[1,0]
v_accvgpr_read_b32 v80,a164
v_accvgpr_read_b32 v81,a165
v_mfma_f32_16x16x32_bf16 a[172:175],a[148:151],v[56:59],a[172:175]
v_accvgpr_read_b32 v82,a166
v_accvgpr_read_b32 v83,a167
v_accvgpr_read_b32 v84,a212
v_accvgpr_read_b32 v85,a213
v_accvgpr_read_b32 v86,a214
v_pk_mul_f32 v[80:81],v[80:81],v[66:67] op_sel_hi:[1,0]
v_pk_mul_f32 v[82:83],v[82:83],v[66:67] op_sel_hi:[1,0]
v_pk_mul_f32 v[84:85],v[84:85],v[68:69] op_sel_hi:[1,0]
v_accvgpr_read_b32 v87,a215
v_pk_mul_f32 v[86:87],v[86:87],v[68:69] op_sel_hi:[1,0]
v_accvgpr_read_b32 v92,a216
v_accvgpr_read_b32 v93,a217
v_mfma_f32_16x16x32_bf16 a[168:171],a[144:147],v[56:59],a[168:171]
v_accvgpr_read_b32 v94,a218
v_accvgpr_read_b32 v95,a219
v_mfma_f32_16x16x32_bf16 v[120:123],a[144:147],v[52:55],v[120:123]
v_accvgpr_read_b32 v100,a220
v_accvgpr_read_b32 v101,a221
v_mfma_f32_16x16x32_bf16 v[124:127],a[148:151],v[52:55],v[124:127]
v_accvgpr_read_b32 v102,a222
v_accvgpr_read_b32 v103,a223
v_mfma_f32_16x16x32_bf16 v[220:223],a[148:151],v[48:51],v[220:223]
v_accvgpr_read_b32 v88,a168
v_accvgpr_read_b32 v89,a169
v_accvgpr_read_b32 v90,a170
v_accvgpr_read_b32 v91,a171
v_accvgpr_read_b32 v96,a172
v_pk_mul_f32 v[92:93],v[92:93],v[68:69] op_sel_hi:[1,0]
v_pk_mul_f32 v[94:95],v[94:95],v[68:69] op_sel_hi:[1,0]
v_pk_mul_f32 v[88:89],v[88:89],v[66:67] op_sel_hi:[1,0]
v_pk_mul_f32 v[90:91],v[90:91],v[66:67] op_sel_hi:[1,0]
v_accvgpr_read_b32 v97,a173
v_accvgpr_read_b32 v98,a174
v_mfma_f32_16x16x32_bf16 v[216:219],a[144:147],v[48:51],v[216:219]
v_accvgpr_read_b32 v99,a175
v_cmp_ngt_f32 vcc,s37,v19
v_mfma_f32_16x16x32_bf16 v[168:171],a[144:147],v[44:47],v[168:171]
ds_read_b64_tr_b16 a[144:145],v4 offset:256
ds_read_b64_tr_b16 a[146:147],v4 offset:6400
v_lshrrev_b32 v19,5,v39
v_xor_b32 v38,v38,v19
v_pk_mul_f32 v[96:97],v[96:97],v[66:67] op_sel_hi:[1,0]
v_pk_mul_f32 v[98:99],v[98:99],v[66:67] op_sel_hi:[1,0]
v_pk_mul_f32 v[100:101],v[100:101],v[68:69] op_sel_hi:[1,0]
v_pk_mul_f32 v[102:103],v[102:103],v[68:69] op_sel_hi:[1,0]
v_and_b32 v19,15,v39
v_lshl_add_u32 v19,v19,7,s24
v_mfma_f32_16x16x32_bf16 v[172:175],a[148:151],v[44:47],v[172:175]
s_cmp_lg_u64 vcc,0
ds_read_b64_tr_b16 a[148:149],v5 offset:256
v_lshl_add_u32 v19,v38,4,v19
v_mfma_f32_16x16x32_bf16 v[176:179],a[120:123],v[44:47],v[176:179]
s_cselect_b32 s62,s32,0
ds_read_b64_tr_b16 a[150:151],v5 offset:6400
v_bfe_u32 v38,v39,4,1
v_mfma_f32_16x16x32_bf16 v[180:183],a[124:127],v[44:47],v[180:183]
s_or_b32 s31,s31,s62
v_lshl_add_u32 v36,v38,3,v19
v_xor_b32 v37,32,v36
v_mfma_f32_16x16x32_bf16 v[228:231],a[124:127],v[48:51],v[228:231]
s_lshl_b32 s32,s32,1
v_xor_b32 v38,64,v36
v_bfe_u32 v19,v39,3,1
v_mfma_f32_16x16x32_bf16 v[224:227],a[120:123],v[48:51],v[224:227]
s_add_u32 m0,s24,6144
v_xor_b32 v39,96,v36
v_lshlrev_b32 v19,11,v19
v_mfma_f32_16x16x32_bf16 v[128:131],a[120:123],v[52:55],v[128:131]
buffer_load_dwordx4 v6,s[12:15],s28 offen offset:0 nt lds
v_mfma_f32_16x16x32_bf16 v[132:135],a[124:127],v[52:55],v[132:135]
buffer_load_dwordx4 v7,s[12:15],s28 offen offset:1024 nt lds
v_mfma_f32_16x16x32_bf16 a[180:183],a[124:127],v[56:59],a[180:183]
buffer_load_dwordx4 v8,s[12:15],s28 offen offset:2048 nt lds
v_mfma_f32_16x16x32_bf16 a[176:179],a[120:123],v[56:59],a[176:179]
s_add_u32 s28,s28,3072
v_cvt_pk_bf16_f32 v72,v72,v73
v_cvt_pk_bf16_f32 v76,v76,v77
v_mfma_f32_16x16x32_bf16 a[224:227],a[120:123],v[40:43],a[224:227]
s_add_u32 m0,s24,9216
v_cvt_pk_bf16_f32 v80,v80,v81
v_cvt_pk_bf16_f32 v84,v84,v85
v_mfma_f32_16x16x32_bf16 a[228:231],a[124:127],v[40:43],a[228:231]
buffer_load_dwordx4 v6,s[12:15],s28 offen offset:0 nt lds
s_waitcnt lgkmcnt(0)
v_mfma_f32_16x16x32_bf16 a[232:235],a[128:131],v[40:43],a[232:235]
buffer_load_dwordx4 v7,s[12:15],s28 offen offset:1024 nt lds
v_mfma_f32_16x16x32_bf16 a[236:239],a[132:135],v[40:43],a[236:239]
buffer_load_dwordx4 v8,s[12:15],s28 offen offset:2048 nt lds
v_cvt_pk_bf16_f32 v73,v74,v75
v_cvt_pk_bf16_f32 v77,v78,v79
ds_write2st64_b64 v36,v[72:73],v[76:77] offset0:36 offset1:40
v_cvt_pk_bf16_f32 v81,v82,v83
v_cvt_pk_bf16_f32 v85,v86,v87
v_accvgpr_read_b32 v82,a178
v_accvgpr_read_b32 v83,a179
v_pk_mul_f32 v[82:83],v[82:83],v[66:67] op_sel_hi:[1,0]
v_accvgpr_read_b32 v86,a226
v_accvgpr_read_b32 v87,a227
v_pk_mul_f32 v[86:87],v[86:87],v[68:69] op_sel_hi:[1,0]
v_cvt_pk_bf16_f32 v92,v92,v93
v_cvt_pk_bf16_f32 v88,v88,v89
v_cvt_pk_bf16_f32 v93,v94,v95
ds_write2st64_b64 v37,v[80:81],v[84:85] offset0:36 offset1:40
v_accvgpr_read_b32 v80,a176
v_accvgpr_read_b32 v81,a177
v_pk_mul_f32 v[80:81],v[80:81],v[66:67] op_sel_hi:[1,0]
v_accvgpr_read_b32 v84,a224
v_accvgpr_read_b32 v85,a225
v_pk_mul_f32 v[84:85],v[84:85],v[68:69] op_sel_hi:[1,0]
v_cvt_pk_bf16_f32 v89,v90,v91
v_accvgpr_read_b32 v94,a230
v_mfma_f32_16x16x32_bf16 a[188:191],a[132:135],v[56:59],a[188:191]
s_add_u32 s28,s28,3072
v_accvgpr_read_b32 v95,a231
ds_write2st64_b64 v38,v[88:89],v[92:93] offset0:36 offset1:40
v_pk_mul_f32 v[94:95],v[94:95],v[68:69] op_sel_hi:[1,0]
v_accvgpr_read_b32 v90,a182
v_accvgpr_read_b32 v91,a183
v_pk_mul_f32 v[90:91],v[90:91],v[66:67] op_sel_hi:[1,0]
v_accvgpr_read_b32 v88,a180
v_accvgpr_read_b32 v89,a181
v_pk_mul_f32 v[88:89],v[88:89],v[66:67] op_sel_hi:[1,0]
v_accvgpr_read_b32 v92,a228
v_accvgpr_read_b32 v93,a229
v_pk_mul_f32 v[92:93],v[92:93],v[68:69] op_sel_hi:[1,0]
v_cvt_pk_bf16_f32 v96,v96,v97
v_cvt_pk_bf16_f32 v100,v100,v101
v_mfma_f32_16x16x32_bf16 a[184:187],a[128:131],v[56:59],a[184:187]
s_waitcnt vmcnt(21)
ds_read_b128 a[48:51],v11 offset:12288
v_cvt_pk_bf16_f32 v97,v98,v99
v_mfma_f32_16x16x32_bf16 v[136:139],a[128:131],v[52:55],v[136:139]
s_add_u32 m0,s23,0
ds_read_b128 a[52:55],v12 offset:12288
v_cvt_pk_bf16_f32 v101,v102,v103
v_mfma_f32_16x16x32_bf16 v[140:143],a[132:135],v[52:55],v[140:143]
ds_read_b128 a[56:59],v11 offset:12416
v_cvt_pk_bf16_f32 v80,v80,v81
v_mfma_f32_16x16x32_bf16 v[236:239],a[132:135],v[48:51],v[236:239]
ds_read_b128 a[60:63],v12 offset:12416
v_cvt_pk_bf16_f32 v84,v84,v85
ds_read_b128 a[64:67],v11 offset:12544
v_cvt_pk_bf16_f32 v81,v82,v83
ds_read_b128 a[68:71],v12 offset:12544
v_cvt_pk_bf16_f32 v85,v86,v87
ds_write2st64_b64 v39,v[96:97],v[100:101] offset0:36 offset1:40
v_accvgpr_read_b32 v98,a186
v_accvgpr_read_b32 v99,a187
v_pk_mul_f32 v[98:99],v[98:99],v[66:67] op_sel_hi:[1,0]
ds_read_b128 v[104:107],v10 offset:18432
v_accvgpr_read_b32 v102,a234
ds_read_b128 v[108:111],v10 offset:19456
v_accvgpr_read_b32 v103,a235
ds_read_b128 v[72:75],v10 offset:20480
v_pk_mul_f32 v[102:103],v[102:103],v[68:69] op_sel_hi:[1,0]
ds_read_b128 v[76:79],v10 offset:21504
v_accvgpr_read_b32 v82,a190
ds_write2st64_b64 v36,v[80:81],v[84:85] offset0:36 offset1:40
v_accvgpr_read_b32 v83,a191
v_pk_mul_f32 v[82:83],v[82:83],v[66:67] op_sel_hi:[1,0]
v_accvgpr_read_b32 v86,a238
v_accvgpr_read_b32 v87,a239
v_pk_mul_f32 v[86:87],v[86:87],v[68:69] op_sel_hi:[1,0]
v_accvgpr_read_b32 v96,a184
v_accvgpr_read_b32 v97,a185
s_waitcnt lgkmcnt(4)
buffer_store_dwordx4 v[104:107],v9,s[16:19],s87 offen offset:0 nt
v_pk_mul_f32 v[96:97],v[96:97],v[66:67] op_sel_hi:[1,0]
v_accvgpr_read_b32 v100,a232
v_accvgpr_read_b32 v101,a233
v_pk_mul_f32 v[100:101],v[100:101],v[68:69] op_sel_hi:[1,0]
v_accvgpr_read_b32 v80,a188
v_accvgpr_read_b32 v81,a189
v_pk_mul_f32 v[80:81],v[80:81],v[66:67] op_sel_hi:[1,0]
v_accvgpr_read_b32 v84,a236
v_accvgpr_read_b32 v85,a237
v_pk_mul_f32 v[84:85],v[84:85],v[68:69] op_sel_hi:[1,0]
v_cvt_pk_bf16_f32 v88,v88,v89
v_cvt_pk_bf16_f32 v92,v92,v93
v_mfma_f32_16x16x32_bf16 v[232:235],a[128:131],v[48:51],v[232:235]
s_waitcnt lgkmcnt(0)
buffer_store_dwordx4 v[108:111],v9,s[16:19],s87 offen offset:3072 nt
v_cvt_pk_bf16_f32 v96,v96,v97
v_cvt_pk_bf16_f32 v100,v100,v101
v_cvt_pk_bf16_f32 v89,v90,v91
v_mfma_f32_16x16x32_bf16 v[184:187],a[128:131],v[44:47],v[184:187]
v_cvt_pk_bf16_f32 v93,v94,v95
v_cvt_pk_bf16_f32 v80,v80,v81
v_mfma_f32_16x16x32_bf16 v[188:191],a[132:135],v[44:47],v[188:191]
v_cvt_pk_bf16_f32 v84,v84,v85
v_cvt_pk_bf16_f32 v97,v98,v99
v_mfma_f32_16x16x32_bf16 v[192:195],a[136:139],v[44:47],v[192:195]
ds_write2st64_b64 v37,v[88:89],v[92:93] offset0:36 offset1:40
v_mfma_f32_16x16x32_bf16 v[196:199],a[140:143],v[44:47],v[196:199]
v_cvt_pk_bf16_f32 v101,v102,v103
v_cvt_pk_bf16_f32 v81,v82,v83
v_mfma_f32_16x16x32_bf16 v[244:247],a[140:143],v[48:51],v[244:247]
buffer_store_dwordx4 v[72:75],v9,s[16:19],s66 offen offset:0 nt
v_cvt_pk_bf16_f32 v85,v86,v87
v_rcp_f32 v64,v64
v_mfma_f32_16x16x32_bf16 v[240:243],a[136:139],v[48:51],v[240:243]
v_rcp_f32 v60,v60
v_mfma_f32_16x16x32_bf16 v[144:147],a[136:139],v[52:55],v[144:147]
v_rcp_f32 v62,v62
v_mfma_f32_16x16x32_bf16 v[148:151],a[140:143],v[52:55],v[148:151]
ds_write2st64_b64 v38,v[96:97],v[100:101] offset0:36 offset1:40
v_mfma_f32_16x16x32_bf16 a[196:199],a[140:143],v[56:59],a[196:199]
v_mov_b32 v70,0
v_mov_b32 v71,0
v_mfma_f32_16x16x32_bf16 a[192:195],a[136:139],v[56:59],a[192:195]
buffer_store_dwordx4 v[76:79],v9,s[16:19],s66 offen offset:3072 nt
s_waitcnt vmcnt(10)
s_barrier
v_mfma_f32_16x16x32_bf16 a[240:243],a[136:139],v[40:43],a[240:243]
ds_read_b128 a[120:123],v0 offset:0
v_accvgpr_read_b32 v96,a196
v_mfma_f32_16x16x32_bf16 a[244:247],a[140:143],v[40:43],a[244:247]
ds_write2st64_b64 v39,v[80:81],v[84:85] offset0:36 offset1:40
v_mfma_f32_16x16x32_bf16 a[248:251],a[144:147],v[40:43],a[248:251]
v_accvgpr_read_b32 v104,a192
v_accvgpr_read_b32 v105,a193
v_mfma_f32_16x16x32_bf16 a[252:255],a[148:151],v[40:43],a[252:255]
ds_read_b128 v[72:75],v10 offset:18432
buffer_load_dwordx4 v6,s[8:11],s25 offen offset:0 lds
ds_read_b128 v[76:79],v10 offset:19456
v_pk_mul_f32 v[104:105],v[104:105],v[66:67] op_sel_hi:[1,0]
ds_read_b128 v[88:91],v10 offset:20480
v_accvgpr_read_b32 v106,a194
ds_read_b128 v[92:95],v10 offset:21504
v_accvgpr_read_b32 v107,a195
ds_read_b128 a[124:127],v1 offset:0
v_pk_mul_f32 v[106:107],v[106:107],v[66:67] op_sel_hi:[1,0]
ds_read_b128 a[128:131],v0 offset:128
v_accvgpr_read_b32 v108,a240
ds_read_b128 a[132:135],v1 offset:128
v_accvgpr_read_b32 v109,a241
ds_read_b128 a[136:139],v0 offset:256
s_waitcnt lgkmcnt(7)
buffer_store_dwordx4 v[72:75],v9,s[16:19],s87 offen offset:128 nt
ds_read_b128 a[140:143],v1 offset:256
v_pk_mul_f32 v[108:109],v[108:109],v[68:69] op_sel_hi:[1,0]
v_accvgpr_read_b32 v110,a242
v_accvgpr_read_b32 v111,a243
v_pk_mul_f32 v[110:111],v[110:111],v[68:69] op_sel_hi:[1,0]
v_accvgpr_read_b32 v97,a197
v_accvgpr_read_b32 v98,a198
v_mfma_f32_16x16x32_bf16 a[204:207],a[148:151],v[56:59],a[204:207]
v_accvgpr_read_b32 v99,a199
buffer_load_dwordx4 v7,s[8:11],s25 offen offset:1024 lds
s_waitcnt lgkmcnt(4)
buffer_store_dwordx4 v[76:79],v9,s[16:19],s87 offen offset:3200 nt
v_pk_mul_f32 v[96:97],v[96:97],v[66:67] op_sel_hi:[1,0]
v_pk_mul_f32 v[98:99],v[98:99],v[66:67] op_sel_hi:[1,0]
v_accvgpr_read_b32 v100,a244
v_accvgpr_read_b32 v101,a245
v_pk_mul_f32 v[100:101],v[100:101],v[68:69] op_sel_hi:[1,0]
v_accvgpr_read_b32 v102,a246
v_accvgpr_read_b32 v103,a247
v_pk_mul_f32 v[102:103],v[102:103],v[68:69] op_sel_hi:[1,0]
v_cvt_pk_bf16_f32 v104,v104,v105
v_cvt_pk_bf16_f32 v108,v108,v109
v_mfma_f32_16x16x32_bf16 a[200:203],a[144:147],v[56:59],a[200:203]
v_cvt_pk_bf16_f32 v105,v106,v107
v_cvt_pk_bf16_f32 v109,v110,v111
v_mfma_f32_16x16x32_bf16 v[152:155],a[144:147],v[52:55],v[152:155]
ds_write2st64_b64 v36,v[104:105],v[108:109] offset0:36 offset1:40
v_mfma_f32_16x16x32_bf16 v[156:159],a[148:151],v[52:55],v[156:159]
v_add_u32 v36,v36,v19
v_accvgpr_read_b32 v84,a248
v_mfma_f32_16x16x32_bf16 v[252:255],a[148:151],v[48:51],v[252:255]
buffer_load_dwordx4 v8,s[8:11],s25 offen offset:2048 lds
buffer_store_dwordx4 v[88:91],v9,s[16:19],s66 offen offset:128 nt
v_pk_mul_f32 v[112:113],v[112:113],v[64:65] op_sel_hi:[1,0]
v_pk_mul_f32 v[114:115],v[114:115],v[64:65] op_sel_hi:[1,0]
v_pk_mul_f32 v[128:129],v[128:129],v[64:65] op_sel_hi:[1,0]
v_pk_mul_f32 v[130:131],v[130:131],v[64:65] op_sel_hi:[1,0]
v_pk_mul_f32 v[116:117],v[116:117],v[64:65] op_sel_hi:[1,0]
v_pk_mul_f32 v[118:119],v[118:119],v[64:65] op_sel_hi:[1,0]
v_pk_mul_f32 v[132:133],v[132:133],v[64:65] op_sel_hi:[1,0]
v_pk_mul_f32 v[134:135],v[134:135],v[64:65] op_sel_hi:[1,0]
v_accvgpr_read_b32 v85,a249
v_pk_mul_f32 v[84:85],v[84:85],v[68:69] op_sel_hi:[1,0]
v_accvgpr_read_b32 v86,a250
buffer_store_dwordx4 v[92:95],v9,s[16:19],s66 offen offset:3200 nt
v_accvgpr_read_b32 v87,a251
v_pk_mul_f32 v[86:87],v[86:87],v[68:69] op_sel_hi:[1,0]
v_accvgpr_read_b32 v80,a200
v_accvgpr_read_b32 v81,a201
v_pk_mul_f32 v[80:81],v[80:81],v[66:67] op_sel_hi:[1,0]
v_accvgpr_read_b32 v82,a202
v_accvgpr_read_b32 v83,a203
v_pk_mul_f32 v[82:83],v[82:83],v[66:67] op_sel_hi:[1,0]
v_accvgpr_read_b32 v106,a206
v_accvgpr_read_b32 v107,a207
v_pk_mul_f32 v[106:107],v[106:107],v[66:67] op_sel_hi:[1,0]
v_accvgpr_read_b32 v110,a254
v_accvgpr_read_b32 v111,a255
v_pk_mul_f32 v[110:111],v[110:111],v[68:69] op_sel_hi:[1,0]
v_accvgpr_read_b32 v104,a204
v_accvgpr_read_b32 v105,a205
v_pk_mul_f32 v[104:105],v[104:105],v[66:67] op_sel_hi:[1,0]
v_accvgpr_read_b32 v108,a252
v_accvgpr_read_b32 v109,a253
v_pk_mul_f32 v[108:109],v[108:109],v[68:69] op_sel_hi:[1,0]
v_cvt_pk_bf16_f32 v96,v96,v97
v_cvt_pk_bf16_f32 v100,v100,v101
v_mfma_f32_16x16x32_bf16 v[248:251],a[144:147],v[48:51],v[248:251]
s_waitcnt vmcnt(20)
ds_read_b128 a[92:95],v12 offset:256
v_cvt_pk_bf16_f32 v84,v84,v85
v_mfma_f32_16x16x32_bf16 v[200:203],a[144:147],v[44:47],v[200:203]
s_mov_b32 s27,s42
ds_read_b128 a[88:91],v11 offset:256
v_cvt_pk_bf16_f32 v80,v80,v81
ds_read_b128 a[84:87],v12 offset:128
v_pk_mul_f32 v[120:121],v[120:121],v[64:65] op_sel_hi:[1,0]
ds_read_b128 a[80:83],v11 offset:128
v_pk_mul_f32 v[122:123],v[122:123],v[64:65] op_sel_hi:[1,0]
ds_read_b128 a[76:79],v12 offset:0
v_pk_mul_f32 v[136:137],v[136:137],v[64:65] op_sel_hi:[1,0]
ds_read_b128 a[72:75],v11 offset:0
v_pk_mul_f32 v[138:139],v[138:139],v[64:65] op_sel_hi:[1,0]
v_cvt_pk_bf16_f32 v97,v98,v99
v_cvt_pk_bf16_f32 v101,v102,v103
v_mfma_f32_16x16x32_bf16 v[204:207],a[148:151],v[44:47],v[204:207]
s_mov_b32 s42,s41
ds_write2st64_b64 v37,v[96:97],v[100:101] offset0:36 offset1:40
v_mfma_f32_16x16x32_bf16 v[72:75],a[120:123],a[0:3],0
s_add_u32 s69,s69,1
v_add_u32 v37,v37,v19
ds_read_b128 a[144:147],v0 offset:6144
v_mfma_f32_16x16x32_bf16 v[72:75],a[124:127],a[4:7],v[72:75]
s_lshl_b32 s62,s69,5
ds_read_b128 a[148:151],v1 offset:6144
v_cvt_pk_bf16_f32 v104,v104,v105
v_cvt_pk_bf16_f32 v108,v108,v109
v_cvt_pk_bf16_f32 v85,v86,v87
v_pk_mul_f32 v[124:125],v[124:125],v[64:65] op_sel_hi:[1,0]
v_pk_mul_f32 v[126:127],v[126:127],v[64:65] op_sel_hi:[1,0]
v_pk_mul_f32 v[140:141],v[140:141],v[64:65] op_sel_hi:[1,0]
v_pk_mul_f32 v[142:143],v[142:143],v[64:65] op_sel_hi:[1,0]
v_cvt_pk_bf16_f32 v81,v82,v83
v_cvt_pk_bf16_f32 v105,v106,v107
s_waitcnt lgkmcnt(3)
v_mfma_f32_16x16x32_bf16 v[72:75],a[128:131],a[8:11],v[72:75]
s_add_u32 s62,s62,s34
ds_write2st64_b64 v38,v[80:81],v[84:85] offset0:36 offset1:40
v_mfma_f32_16x16x32_bf16 v[72:75],a[132:135],a[12:15],v[72:75]
s_waitcnt vmcnt(11)
v_add_u32 v38,v38,v19
v_cvt_pk_bf16_f32 v109,v110,v111
v_mfma_f32_16x16x32_bf16 v[72:75],a[136:139],a[16:19],v[72:75]
s_mul_i32 s63,s62,171
ds_read_b128 a[96:99],v11 offset:6144
v_cvt_pk_bf16_f32 v112,v112,v113
v_mfma_f32_16x16x32_bf16 v[72:75],a[140:143],a[20:23],v[72:75]
s_lshr_b32 s63,s63,9
ds_read_b128 a[100:103],v12 offset:6144
v_cvt_pk_bf16_f32 v128,v128,v129
ds_read_b128 a[104:107],v11 offset:6272
v_pk_mul_f32 v[144:145],v[144:145],v[64:65] op_sel_hi:[1,0]
ds_read_b128 a[108:111],v12 offset:6272
v_pk_mul_f32 v[146:147],v[146:147],v[64:65] op_sel_hi:[1,0]
ds_read_b128 a[112:115],v11 offset:6400
v_pk_mul_f32 v[160:161],v[160:161],v[60:61] op_sel_hi:[1,0]
ds_read_b128 a[116:119],v12 offset:6400
v_pk_mul_f32 v[162:163],v[162:163],v[60:61] op_sel_hi:[1,0]
v_max3_f32 v44,v72,v73,v74
v_cvt_pk_bf16_f32 v116,v116,v117
v_mfma_f32_16x16x32_bf16 v[80:83],a[140:143],a[44:47],0
s_mul_i32 s64,s63,3
ds_write2st64_b64 v39,v[104:105],v[108:109] offset0:36 offset1:40
v_mfma_f32_16x16x32_bf16 v[80:83],a[136:139],a[40:43],v[80:83]
s_sub_u32 s62,s62,s64
v_add_u32 v39,v39,v19
v_cvt_pk_bf16_f32 v132,v132,v133
v_mfma_f32_16x16x32_bf16 v[80:83],a[132:135],a[36:39],v[80:83]
s_add_u32 s63,s63,s33
ds_read_b128 v[76:79],v10 offset:18432
v_cvt_pk_bf16_f32 v113,v114,v115
ds_read_b128 v[88:91],v10 offset:19456
v_pk_mul_f32 v[148:149],v[148:149],v[64:65] op_sel_hi:[1,0]
ds_read_b128 v[92:95],v10 offset:20480
v_pk_mul_f32 v[150:151],v[150:151],v[64:65] op_sel_hi:[1,0]
ds_read_b128 v[96:99],v10 offset:21504
v_pk_mul_f32 v[164:165],v[164:165],v[60:61] op_sel_hi:[1,0]
v_pk_mul_f32 v[166:167],v[166:167],v[60:61] op_sel_hi:[1,0]
v_cvt_pk_bf16_f32 v129,v130,v131
v_cvt_pk_bf16_f32 v120,v120,v121
v_mfma_f32_16x16x32_bf16 v[80:83],a[128:131],a[32:35],v[80:83]
s_mul_i32 s30,s63,196608
ds_write2st64_b64 v36,v[112:113],v[128:129] offset0:24 offset1:26
v_mfma_f32_16x16x32_bf16 v[80:83],a[124:127],a[28:31],v[80:83]
s_mul_i32 s41,s63,325632
v_cvt_pk_bf16_f32 v136,v136,v137
v_cvt_pk_bf16_f32 v117,v118,v119
v_mfma_f32_16x16x32_bf16 v[80:83],a[120:123],a[24:27],v[80:83]
s_lshl_b32 s63,s3,2
s_waitcnt lgkmcnt(4)
buffer_store_dwordx4 v[76:79],v9,s[16:19],s87 offen offset:256 nt
v_cvt_pk_bf16_f32 v133,v134,v135
v_cvt_pk_bf16_f32 v124,v124,v125
v_cvt_pk_bf16_f32 v140,v140,v141
v_cvt_pk_bf16_f32 v121,v122,v123
v_cvt_pk_bf16_f32 v137,v138,v139
v_cvt_pk_bf16_f32 v144,v144,v145
v_max3_f32 v48,v80,v81,v82
v_cvt_pk_bf16_f32 v160,v160,v161
v_cvt_pk_bf16_f32 v125,v126,v127
ds_write2st64_b64 v37,v[116:117],v[132:133] offset0:24 offset1:26
v_cvt_pk_bf16_f32 v141,v142,v143
v_cvt_pk_bf16_f32 v148,v148,v149
v_cvt_pk_bf16_f32 v164,v164,v165
s_waitcnt lgkmcnt(1)
buffer_store_dwordx4 v[88:91],v9,s[16:19],s87 offen offset:3328 nt
v_cvt_pk_bf16_f32 v145,v146,v147
v_cvt_pk_bf16_f32 v161,v162,v163
v_cvt_pk_bf16_f32 v149,v150,v151
v_mfma_f32_16x16x32_bf16 v[88:91],a[120:123],a[48:51],0
s_add_u32 s64,s63,21
v_cvt_pk_bf16_f32 v165,v166,v167
v_mov_b32 v66,0
v_mov_b32 v67,0
v_mov_b32 v68,0
ds_write2st64_b64 v38,v[120:121],v[136:137] offset0:24 offset1:26
v_pk_mul_f32 v[152:153],v[152:153],v[64:65] op_sel_hi:[1,0]
v_pk_mul_f32 v[154:155],v[154:155],v[64:65] op_sel_hi:[1,0]
v_pk_mul_f32 v[168:169],v[168:169],v[60:61] op_sel_hi:[1,0]
buffer_store_dwordx4 v[92:95],v9,s[16:19],s66 offen offset:256 nt
v_pk_mul_f32 v[170:171],v[170:171],v[60:61] op_sel_hi:[1,0]
v_cvt_pk_bf16_f32 v152,v152,v153
v_cvt_pk_bf16_f32 v168,v168,v169
v_mfma_f32_16x16x32_bf16 v[88:91],a[124:127],a[52:55],v[88:91]
s_cmp_eq_u32 s3,0
v_cvt_pk_bf16_f32 v153,v154,v155
v_cvt_pk_bf16_f32 v169,v170,v171
v_mfma_f32_16x16x32_bf16 v[88:91],a[128:131],a[56:59],v[88:91]
s_cselect_b32 s64,20,s64
v_mov_b32 v69,0
s_cselect_b32 s40,1,0
v_mfma_f32_16x16x32_bf16 v[88:91],a[132:135],a[60:63],v[88:91]
s_add_u32 s65,s63,37
ds_write2st64_b64 v39,v[124:125],v[140:141] offset0:24 offset1:26
v_mfma_f32_16x16x32_bf16 v[88:91],a[136:139],a[64:67],v[88:91]
s_cmp_eq_u32 s62,2
s_cselect_b32 s64,s65,s64
buffer_store_dwordx4 v[96:99],v9,s[16:19],s66 offen offset:3328 nt
v_pk_mul_f32 v[156:157],v[156:157],v[64:65] op_sel_hi:[1,0]
v_pk_mul_f32 v[158:159],v[158:159],v[64:65] op_sel_hi:[1,0]
v_pk_mul_f32 v[172:173],v[172:173],v[60:61] op_sel_hi:[1,0]
v_pk_mul_f32 v[174:175],v[174:175],v[60:61] op_sel_hi:[1,0]
v_cvt_pk_bf16_f32 v156,v156,v157
v_cvt_pk_bf16_f32 v172,v172,v173
v_mfma_f32_16x16x32_bf16 v[88:91],a[140:143],a[68:71],v[88:91]
s_cselect_b32 s40,0,s40
v_cvt_pk_bf16_f32 v157,v158,v159
v_cvt_pk_bf16_f32 v173,v174,v175
v_mfma_f32_16x16x32_bf16 v[96:99],a[140:143],a[92:95],0
s_add_u32 s65,s63,s3
ds_write2st64_b64 v36,v[144:145],v[160:161] offset0:28 offset1:0
v_mfma_f32_16x16x32_bf16 v[96:99],a[136:139],a[88:91],v[96:99]
s_cmp_eq_u32 s62,0
v_max3_f32 v52,v88,v89,v90
v_mov_b32 v64,0
v_mov_b32 v65,0
s_cselect_b32 s64,s65,s64
s_cselect_b32 s40,1,s40
v_pk_mul_f32 v[176:177],v[176:177],v[60:61] op_sel_hi:[1,0]
v_pk_mul_f32 v[178:179],v[178:179],v[60:61] op_sel_hi:[1,0]
v_pk_mul_f32 v[192:193],v[192:193],v[60:61] op_sel_hi:[1,0]
v_pk_mul_f32 v[194:195],v[194:195],v[60:61] op_sel_hi:[1,0]
v_cvt_pk_bf16_f32 v176,v176,v177
v_cvt_pk_bf16_f32 v192,v192,v193
v_mfma_f32_16x16x32_bf16 v[96:99],a[132:135],a[84:87],v[96:99]
s_mul_i32 s64,s64,6144
ds_write2st64_b64 v37,v[148:149],v[164:165] offset0:28 offset1:0
v_mfma_f32_16x16x32_bf16 v[96:99],a[128:131],a[80:83],v[96:99]
s_add_u32 s41,s41,s64
v_cvt_pk_bf16_f32 v177,v178,v179
v_cvt_pk_bf16_f32 v193,v194,v195
v_mfma_f32_16x16x32_bf16 v[96:99],a[124:127],a[76:79],v[96:99]
s_cmp_ge_u32 s69,6
s_cselect_b32 s41,166723584,s41
s_cselect_b32 s30,100663296,s30
v_mfma_f32_16x16x32_bf16 v[96:99],a[120:123],a[72:75],v[96:99]
s_add_u32 s25,s30,s22
s_add_u32 s26,s25,12288
ds_write2st64_b64 v38,v[152:153],v[168:169] offset0:28 offset1:0
v_pk_mul_f32 v[180:181],v[180:181],v[60:61] op_sel_hi:[1,0]
v_pk_mul_f32 v[182:183],v[182:183],v[60:61] op_sel_hi:[1,0]
v_pk_mul_f32 v[196:197],v[196:197],v[60:61] op_sel_hi:[1,0]
v_pk_mul_f32 v[198:199],v[198:199],v[60:61] op_sel_hi:[1,0]
v_cvt_pk_bf16_f32 v180,v180,v181
v_max3_f32 v56,v96,v97,v98
v_mfma_f32_16x16x32_bf16 v[104:107],a[120:123],a[96:99],0
s_add_u32 m0,s23,24576
ds_read_b128 a[120:123],v0 offset:6272
v_cvt_pk_bf16_f32 v196,v196,v197
v_mfma_f32_16x16x32_bf16 v[104:107],a[124:127],a[100:103],v[104:107]
s_mov_b32 s28,s41
ds_read_b128 a[124:127],v1 offset:6272
v_cvt_pk_bf16_f32 v181,v182,v183
v_mfma_f32_16x16x32_bf16 v[104:107],a[128:131],a[104:107],v[104:107]
s_mov_b32 s29,s24
ds_write2st64_b64 v39,v[156:157],v[172:173] offset0:28 offset1:0
v_pk_mul_f32 v[184:185],v[184:185],v[60:61] op_sel_hi:[1,0]
v_pk_mul_f32 v[186:187],v[186:187],v[60:61] op_sel_hi:[1,0]
v_pk_mul_f32 v[200:201],v[200:201],v[60:61] op_sel_hi:[1,0]
ds_read_b128 a[128:131],v0 offset:6400
v_pk_mul_f32 v[202:203],v[202:203],v[60:61] op_sel_hi:[1,0]
v_cvt_pk_bf16_f32 v197,v198,v199
v_cvt_pk_bf16_f32 v184,v184,v185
v_mfma_f32_16x16x32_bf16 v[104:107],a[132:135],a[108:111],v[104:107]
ds_read_b128 a[132:135],v1 offset:6400
v_cvt_pk_bf16_f32 v200,v200,v201
v_mfma_f32_16x16x32_bf16 v[104:107],a[136:139],a[112:115],v[104:107]
ds_read_b128 a[136:139],v0 offset:12288
v_cvt_pk_bf16_f32 v185,v186,v187
v_mfma_f32_16x16x32_bf16 v[104:107],a[140:143],a[116:119],v[104:107]
ds_read_b128 a[140:143],v1 offset:12288
v_cvt_pk_bf16_f32 v201,v202,v203
v_mfma_f32_16x16x32_bf16 v[76:79],a[144:147],a[0:3],0
ds_write2st64_b64 v36,v[176:177],v[192:193] offset0:2 offset1:4
v_pk_mul_f32 v[188:189],v[188:189],v[60:61] op_sel_hi:[1,0]
v_pk_mul_f32 v[190:191],v[190:191],v[60:61] op_sel_hi:[1,0]
v_pk_mul_f32 v[204:205],v[204:205],v[60:61] op_sel_hi:[1,0]
v_pk_mul_f32 v[206:207],v[206:207],v[60:61] op_sel_hi:[1,0]
v_max3_f32 v40,v104,v105,v106
v_cvt_pk_bf16_f32 v188,v188,v189
v_mfma_f32_16x16x32_bf16 v[76:79],a[148:151],a[4:7],v[76:79]
s_waitcnt lgkmcnt(4)
v_cvt_pk_bf16_f32 v204,v204,v205
v_cvt_pk_bf16_f32 v189,v190,v191
v_mfma_f32_16x16x32_bf16 v[76:79],a[120:123],a[8:11],v[76:79]
v_cvt_pk_bf16_f32 v205,v206,v207
v_mov_b32 v60,0
v_mfma_f32_16x16x32_bf16 v[76:79],a[124:127],a[12:15],v[76:79]
ds_write2st64_b64 v37,v[180:181],v[196:197] offset0:2 offset1:4
v_mfma_f32_16x16x32_bf16 v[76:79],a[128:131],a[16:19],v[76:79]
v_mov_b32 v61,0
v_pk_mul_f32 v[208:209],v[208:209],v[62:63] op_sel_hi:[1,0]
buffer_load_dwordx4 v6,s[8:11],s21 offen offset:0 lds
ds_write2st64_b64 v38,v[184:185],v[200:201] offset0:2 offset1:4
v_pk_mul_f32 v[210:211],v[210:211],v[62:63] op_sel_hi:[1,0]
v_pk_mul_f32 v[224:225],v[224:225],v[62:63] op_sel_hi:[1,0]
v_pk_mul_f32 v[226:227],v[226:227],v[62:63] op_sel_hi:[1,0]
v_cvt_pk_bf16_f32 v208,v208,v209
v_cvt_pk_bf16_f32 v224,v224,v225
s_waitcnt lgkmcnt(2)
v_mfma_f32_16x16x32_bf16 v[76:79],a[132:135],a[20:23],v[76:79]
v_cvt_pk_bf16_f32 v209,v210,v211
v_cvt_pk_bf16_f32 v225,v226,v227
v_mfma_f32_16x16x32_bf16 v[84:87],a[132:135],a[44:47],0
v_mfma_f32_16x16x32_bf16 v[84:87],a[128:131],a[40:43],v[84:87]
ds_write2st64_b64 v39,v[188:189],v[204:205] offset0:2 offset1:4
v_pk_mul_f32 v[212:213],v[212:213],v[62:63] op_sel_hi:[1,0]
v_pk_mul_f32 v[214:215],v[214:215],v[62:63] op_sel_hi:[1,0]
v_pk_mul_f32 v[228:229],v[228:229],v[62:63] op_sel_hi:[1,0]
v_pk_mul_f32 v[230:231],v[230:231],v[62:63] op_sel_hi:[1,0]
v_max3_f32 v44,v44,v75,v76
v_max3_f32 v44,v44,v77,v78
v_mfma_f32_16x16x32_bf16 v[84:87],a[124:127],a[36:39],v[84:87]
buffer_load_dwordx4 v7,s[8:11],s21 offen offset:1024 lds
v_mfma_f32_16x16x32_bf16 v[84:87],a[120:123],a[32:35],v[84:87]
ds_write2st64_b64 v36,v[208:209],v[224:225] offset0:12 offset1:14
v_mfma_f32_16x16x32_bf16 v[84:87],a[148:151],a[28:31],v[84:87]
v_max_f32 v44,v44,v79
v_mov_b32 v45,v44
v_mfma_f32_16x16x32_bf16 v[84:87],a[144:147],a[24:27],v[84:87]
v_cvt_pk_bf16_f32 v212,v212,v213
v_permlane32_swap_b32 v45,v44
v_max_f32 v44,v44,v45
v_mov_b32 v45,v44
v_pk_mul_f32 v[216:217],v[216:217],v[62:63] op_sel_hi:[1,0]
v_pk_mul_f32 v[218:219],v[218:219],v[62:63] op_sel_hi:[1,0]
v_pk_mul_f32 v[232:233],v[232:233],v[62:63] op_sel_hi:[1,0]
v_pk_mul_f32 v[234:235],v[234:235],v[62:63] op_sel_hi:[1,0]
v_permlane16_swap_b32 v45,v44
v_max_f32 v44,v44,v45
v_mfma_f32_16x16x32_bf16 v[92:95],a[144:147],a[48:51],0
v_mul_f32_e64 v13,-s36,v44
v_fma_f32 v72,v72,s36,v13
v_mfma_f32_16x16x32_bf16 v[92:95],a[148:151],a[52:55],v[92:95]
buffer_load_dwordx4 v8,s[8:11],s21 offen offset:2048 lds
v_mfma_f32_16x16x32_bf16 v[92:95],a[120:123],a[56:59],v[92:95]
s_add_u32 s21,s21,12288
v_fma_f32 v73,v73,s36,v13
v_fma_f32 v74,v74,s36,v13
v_mfma_f32_16x16x32_bf16 v[92:95],a[124:127],a[60:63],v[92:95]
s_add_u32 m0,s22,0
v_fma_f32 v75,v75,s36,v13
v_exp_f32 v72,v72
v_exp_f32 v73,v73
v_pk_mul_f32 v[220:221],v[220:221],v[62:63] op_sel_hi:[1,0]
v_pk_mul_f32 v[222:223],v[222:223],v[62:63] op_sel_hi:[1,0]
v_pk_mul_f32 v[236:237],v[236:237],v[62:63] op_sel_hi:[1,0]
v_pk_mul_f32 v[238:239],v[238:239],v[62:63] op_sel_hi:[1,0]
v_exp_f32 v74,v74
v_exp_f32 v75,v75
v_mfma_f32_16x16x32_bf16 v[92:95],a[128:131],a[64:67],v[92:95]
v_cvt_pk_bf16_f32 v20,v72,v73
v_cvt_pk_bf16_f32 v21,v74,v75
v_mfma_f32_16x16x32_bf16 v[92:95],a[132:135],a[68:71],v[92:95]
v_max3_f32 v48,v48,v83,v84
v_max3_f32 v48,v48,v85,v86
v_mfma_f32_16x16x32_bf16 v[100:103],a[132:135],a[92:95],0
v_max_f32 v48,v48,v87
v_mov_b32 v49,v48
v_cvt_pk_bf16_f32 v228,v228,v229
v_cvt_pk_bf16_f32 v213,v214,v215
v_permlane32_swap_b32 v49,v48
v_pk_mul_f32 v[240:241],v[240:241],v[62:63] op_sel_hi:[1,0]
v_pk_mul_f32 v[242:243],v[242:243],v[62:63] op_sel_hi:[1,0]
v_max_f32 v48,v48,v49
v_mov_b32 v49,v48
v_mfma_f32_16x16x32_bf16 v[100:103],a[128:131],a[88:91],v[100:103]
v_max3_f32 v52,v52,v91,v92
v_permlane16_swap_b32 v49,v48
v_mfma_f32_16x16x32_bf16 v[100:103],a[124:127],a[84:87],v[100:103]
v_max_f32 v48,v48,v49
v_mul_f32_e64 v14,-s36,v48
v_mfma_f32_16x16x32_bf16 v[100:103],a[120:123],a[80:83],v[100:103]
v_fma_f32 v80,v80,s36,v14
v_fma_f32 v81,v81,s36,v14
v_mfma_f32_16x16x32_bf16 v[100:103],a[148:151],a[76:79],v[100:103]
v_fma_f32 v82,v82,s36,v14
v_fma_f32 v83,v83,s36,v14
v_exp_f32 v80,v80
v_exp_f32 v81,v81
v_pk_mul_f32 v[244:245],v[244:245],v[62:63] op_sel_hi:[1,0]
v_pk_mul_f32 v[246:247],v[246:247],v[62:63] op_sel_hi:[1,0]
v_exp_f32 v82,v82
v_exp_f32 v83,v83
v_mfma_f32_16x16x32_bf16 v[100:103],a[144:147],a[72:75],v[100:103]
v_cvt_pk_bf16_f32 v24,v80,v81
v_cvt_pk_bf16_f32 v25,v82,v83
v_mfma_f32_16x16x32_bf16 v[108:111],a[144:147],a[96:99],0
ds_read_b128 a[144:147],v0 offset:12416
v_max3_f32 v52,v52,v93,v94
v_mfma_f32_16x16x32_bf16 v[108:111],a[148:151],a[100:103],v[108:111]
ds_read_b128 a[148:151],v1 offset:12416
v_max_f32 v52,v52,v95
v_mov_b32 v53,v52
v_max3_f32 v56,v56,v99,v100
v_max3_f32 v56,v56,v101,v102
v_pk_mul_f32 v[248:249],v[248:249],v[62:63] op_sel_hi:[1,0]
v_pk_mul_f32 v[250:251],v[250:251],v[62:63] op_sel_hi:[1,0]
v_permlane32_swap_b32 v53,v52
v_max_f32 v52,v52,v53
v_mfma_f32_16x16x32_bf16 v[108:111],a[120:123],a[104:107],v[108:111]
ds_read_b128 a[120:123],v0 offset:12544
v_mov_b32 v53,v52
v_mfma_f32_16x16x32_bf16 v[108:111],a[124:127],a[108:111],v[108:111]
ds_read_b128 a[124:127],v1 offset:12544
v_permlane16_swap_b32 v53,v52
v_mfma_f32_16x16x32_bf16 v[108:111],a[128:131],a[112:115],v[108:111]
ds_read_b128 a[128:131],v0 offset:18432
v_max_f32 v52,v52,v53
v_mfma_f32_16x16x32_bf16 v[108:111],a[132:135],a[116:119],v[108:111]
ds_read_b128 a[132:135],v1 offset:18432
v_mul_f32_e64 v15,-s36,v52
v_fma_f32 v88,v88,s36,v15
v_fma_f32 v89,v89,s36,v15
v_fma_f32 v90,v90,s36,v15
v_pk_mul_f32 v[252:253],v[252:253],v[62:63] op_sel_hi:[1,0]
v_pk_mul_f32 v[254:255],v[254:255],v[62:63] op_sel_hi:[1,0]
v_fma_f32 v91,v91,s36,v15
v_exp_f32 v88,v88
v_mfma_f32_16x16x32_bf16 v[72:75],a[136:139],a[0:3],0
v_exp_f32 v89,v89
v_mfma_f32_16x16x32_bf16 v[72:75],a[140:143],a[4:7],v[72:75]
s_waitcnt lgkmcnt(3)
v_exp_f32 v90,v90
v_mfma_f32_16x16x32_bf16 v[72:75],a[144:147],a[8:11],v[72:75]
v_exp_f32 v91,v91
v_mfma_f32_16x16x32_bf16 v[72:75],a[148:151],a[12:15],v[72:75]
v_cvt_pk_bf16_f32 v28,v88,v89
v_cvt_pk_bf16_f32 v29,v90,v91
v_mfma_f32_16x16x32_bf16 v[72:75],a[120:123],a[16:19],v[72:75]
s_waitcnt lgkmcnt(0)
v_max_f32 v56,v56,v103
v_mov_b32 v57,v56
v_mfma_f32_16x16x32_bf16 v[72:75],a[124:127],a[20:23],v[72:75]
v_max3_f32 v40,v40,v107,v108
v_permlane32_swap_b32 v57,v56
v_mfma_f32_16x16x32_bf16 v[80:83],a[124:127],a[44:47],0
v_max_f32 v56,v56,v57
v_mov_b32 v57,v56
v_mfma_f32_16x16x32_bf16 v[80:83],a[120:123],a[40:43],v[80:83]
v_max3_f32 v40,v40,v109,v110
v_permlane16_swap_b32 v57,v56
v_mfma_f32_16x16x32_bf16 v[80:83],a[148:151],a[36:39],v[80:83]
v_max_f32 v56,v56,v57
v_mul_f32_e64 v16,-s36,v56
v_mfma_f32_16x16x32_bf16 v[80:83],a[144:147],a[32:35],v[80:83]
v_fma_f32 v96,v96,s36,v16
v_fma_f32 v97,v97,s36,v16
v_mfma_f32_16x16x32_bf16 v[80:83],a[140:143],a[28:31],v[80:83]
v_fma_f32 v98,v98,s36,v16
v_fma_f32 v99,v99,s36,v16
v_mfma_f32_16x16x32_bf16 v[80:83],a[136:139],a[24:27],v[80:83]
v_exp_f32 v96,v96
v_mfma_f32_16x16x32_bf16 v[88:91],a[136:139],a[48:51],0
v_exp_f32 v97,v97
v_mfma_f32_16x16x32_bf16 v[88:91],a[140:143],a[52:55],v[88:91]
v_exp_f32 v98,v98
v_mfma_f32_16x16x32_bf16 v[88:91],a[144:147],a[56:59],v[88:91]
v_exp_f32 v99,v99
v_mfma_f32_16x16x32_bf16 v[88:91],a[148:151],a[60:63],v[88:91]
v_cvt_pk_bf16_f32 v32,v96,v97
v_cvt_pk_bf16_f32 v33,v98,v99
v_mfma_f32_16x16x32_bf16 v[88:91],a[120:123],a[64:67],v[88:91]
v_max_f32 v40,v40,v111
v_mov_b32 v41,v40
v_mfma_f32_16x16x32_bf16 v[88:91],a[124:127],a[68:71],v[88:91]
v_cvt_pk_bf16_f32 v216,v216,v217
v_permlane32_swap_b32 v41,v40
v_mfma_f32_16x16x32_bf16 v[96:99],a[124:127],a[92:95],0
v_max_f32 v40,v40,v41
v_mov_b32 v41,v40
v_mfma_f32_16x16x32_bf16 v[96:99],a[120:123],a[88:91],v[96:99]
v_cvt_pk_bf16_f32 v232,v232,v233
v_permlane16_swap_b32 v41,v40
v_mfma_f32_16x16x32_bf16 v[96:99],a[148:151],a[84:87],v[96:99]
v_cvt_pk_bf16_f32 v229,v230,v231
v_max_f32 v40,v40,v41
v_mfma_f32_16x16x32_bf16 v[96:99],a[144:147],a[80:83],v[96:99]
ds_write2st64_b64 v37,v[212:213],v[228:229] offset0:12 offset1:14
v_mfma_f32_16x16x32_bf16 v[96:99],a[140:143],a[76:79],v[96:99]
v_cvt_pk_bf16_f32 v220,v220,v221
v_cvt_pk_bf16_f32 v236,v236,v237
v_mfma_f32_16x16x32_bf16 v[96:99],a[136:139],a[72:75],v[96:99]
v_cvt_pk_bf16_f32 v217,v218,v219
v_cvt_pk_bf16_f32 v233,v234,v235
v_mul_f32_e64 v17,-s36,v40
v_cvt_pk_bf16_f32 v240,v240,v241
v_cvt_pk_bf16_f32 v221,v222,v223
ds_write2st64_b64 v38,v[216:217],v[232:233] offset0:12 offset1:14
v_cvt_pk_bf16_f32 v237,v238,v239
v_fma_f32 v104,v104,s36,v17
v_fma_f32 v105,v105,s36,v17
v_fma_f32 v106,v106,s36,v17
v_fma_f32 v107,v107,s36,v17
v_cvt_pk_bf16_f32 v244,v244,v245
v_cvt_pk_bf16_f32 v241,v242,v243
v_exp_f32 v104,v104
v_exp_f32 v105,v105
ds_write2st64_b64 v39,v[220:221],v[236:237] offset0:12 offset1:14
v_exp_f32 v106,v106
v_exp_f32 v107,v107
v_cvt_pk_bf16_f32 v245,v246,v247
v_fma_f32 v76,v76,s36,v13
v_fma_f32 v77,v77,s36,v13
v_fma_f32 v78,v78,s36,v13
v_fma_f32 v79,v79,s36,v13
v_exp_f32 v76,v76
ds_write_b64 v36,v[240:241] offset:8192
v_cvt_pk_bf16_f32 v36,v104,v105
v_exp_f32 v77,v77
v_exp_f32 v78,v78
ds_write_b64 v37,v[244:245] offset:8192
v_cvt_pk_bf16_f32 v37,v106,v107
v_mfma_f32_16x16x32_bf16 v[104:107],a[136:139],a[96:99],0
ds_read_b128 a[136:139],v0 offset:18560
v_exp_f32 v79,v79
v_mfma_f32_16x16x32_bf16 v[104:107],a[140:143],a[100:103],v[104:107]
ds_read_b128 a[140:143],v1 offset:18560
v_cvt_pk_bf16_f32 v22,v76,v77
v_mfma_f32_16x16x32_bf16 v[104:107],a[144:147],a[104:107],v[104:107]
ds_read_b128 a[144:147],v0 offset:18688
v_cvt_pk_bf16_f32 v23,v78,v79
v_mfma_f32_16x16x32_bf16 v[104:107],a[148:151],a[108:111],v[104:107]
ds_read_b128 a[148:151],v1 offset:18688
v_fma_f32 v84,v84,s36,v14
v_mfma_f32_16x16x32_bf16 v[104:107],a[120:123],a[112:115],v[104:107]
v_fma_f32 v85,v85,s36,v14
v_fma_f32 v86,v86,s36,v14
v_mfma_f32_16x16x32_bf16 v[104:107],a[124:127],a[116:119],v[104:107]
v_fma_f32 v87,v87,s36,v14
v_exp_f32 v84,v84
v_mfma_f32_16x16x32_bf16 v[76:79],a[128:131],a[0:3],0
v_exp_f32 v85,v85
v_mfma_f32_16x16x32_bf16 v[76:79],a[132:135],a[4:7],v[76:79]
v_exp_f32 v86,v86
s_waitcnt vmcnt(9)
s_barrier
s_waitcnt lgkmcnt(2)
v_mfma_f32_16x16x32_bf16 v[76:79],a[136:139],a[8:11],v[76:79]
v_exp_f32 v87,v87
v_mfma_f32_16x16x32_bf16 v[76:79],a[140:143],a[12:15],v[76:79]
buffer_load_dwordx4 v6,s[4:7],s20 offen offset:0 lds
s_waitcnt lgkmcnt(0)
v_mfma_f32_16x16x32_bf16 v[76:79],a[144:147],a[16:19],v[76:79]
v_cvt_pk_bf16_f32 v26,v84,v85
v_cvt_pk_bf16_f32 v27,v86,v87
v_mfma_f32_16x16x32_bf16 v[76:79],a[148:151],a[20:23],v[76:79]
v_fma_f32 v92,v92,s36,v15
v_fma_f32 v93,v93,s36,v15
v_mfma_f32_16x16x32_bf16 v[84:87],a[148:151],a[44:47],0
v_fma_f32 v94,v94,s36,v15
v_fma_f32 v95,v95,s36,v15
v_mfma_f32_16x16x32_bf16 v[84:87],a[144:147],a[40:43],v[84:87]
v_exp_f32 v92,v92
v_mfma_f32_16x16x32_bf16 v[84:87],a[140:143],a[36:39],v[84:87]
buffer_load_dwordx4 v7,s[4:7],s20 offen offset:1024 lds
v_mfma_f32_16x16x32_bf16 v[84:87],a[136:139],a[32:35],v[84:87]
v_exp_f32 v93,v93
v_mfma_f32_16x16x32_bf16 v[84:87],a[132:135],a[28:31],v[84:87]
v_exp_f32 v94,v94
v_mfma_f32_16x16x32_bf16 v[84:87],a[128:131],a[24:27],v[84:87]
v_exp_f32 v95,v95
ds_read_b64_tr_b16 a[120:121],v2 offset:0
ds_read_b64_tr_b16 a[122:123],v2 offset:6144
v_cvt_pk_bf16_f32 v30,v92,v93
v_cvt_pk_bf16_f32 v31,v94,v95
v_mfma_f32_16x16x32_bf16 v[92:95],a[128:131],a[48:51],0
buffer_load_dwordx4 v8,s[4:7],s20 offen offset:2048 lds
v_mfma_f32_16x16x32_bf16 v[92:95],a[132:135],a[52:55],v[92:95]
s_add_u32 s20,s20,12288
ds_read_b64_tr_b16 a[124:125],v3 offset:0
v_fma_f32 v100,v100,s36,v16
v_mfma_f32_16x16x32_bf16 v[92:95],a[136:139],a[56:59],v[92:95]
ds_read_b64_tr_b16 a[126:127],v3 offset:6144
v_fma_f32 v101,v101,s36,v16
v_mfma_f32_16x16x32_bf16 v[92:95],a[140:143],a[60:63],v[92:95]
v_fma_f32 v102,v102,s36,v16
v_fma_f32 v103,v103,s36,v16
v_mfma_f32_16x16x32_bf16 v[92:95],a[144:147],a[64:67],v[92:95]
v_exp_f32 v100,v100
v_mfma_f32_16x16x32_bf16 v[92:95],a[148:151],a[68:71],v[92:95]
v_exp_f32 v101,v101
v_exp_f32 v102,v102
v_exp_f32 v103,v103
v_cvt_pk_bf16_f32 v34,v100,v101
v_cvt_pk_bf16_f32 v35,v102,v103
v_mfma_f32_16x16x32_bf16 v[100:103],a[148:151],a[92:95],0
v_cvt_pk_bf16_f32 v248,v248,v249
v_fma_f32 v108,v108,s36,v17
v_smfmac_f32_16x16x64_bf16 v[64:67],a[152:155],v[28:35],v18
v_fma_f32 v109,v109,s36,v17
v_mfma_f32_16x16x32_bf16 v[100:103],a[144:147],a[88:91],v[100:103]
v_fma_f32 v110,v110,s36,v17
v_fma_f32 v111,v111,s36,v17
v_mfma_f32_16x16x32_bf16 v[100:103],a[140:143],a[84:87],v[100:103]
v_cvt_pk_bf16_f32 v252,v252,v253
v_cvt_pk_bf16_f32 v249,v250,v251
v_mfma_f32_16x16x32_bf16 v[100:103],a[136:139],a[80:83],v[100:103]
ds_write_b64 v38,v[248:249] offset:8192
v_mfma_f32_16x16x32_bf16 v[100:103],a[132:135],a[76:79],v[100:103]
v_exp_f32 v108,v108
v_mfma_f32_16x16x32_bf16 v[100:103],a[128:131],a[72:75],v[100:103]
v_exp_f32 v109,v109
v_exp_f32 v110,v110
v_exp_f32 v111,v111
v_cvt_pk_bf16_f32 v253,v254,v255
ds_write_b64 v39,v[252:253] offset:8192
v_cvt_pk_bf16_f32 v38,v108,v109
v_cvt_pk_bf16_f32 v39,v110,v111
v_mfma_f32_16x16x32_bf16 v[108:111],a[128:131],a[96:99],0
ds_read_b64_tr_b16 a[128:129],v4 offset:0
v_mov_b32 v62,0
v_mfma_f32_16x16x32_bf16 v[108:111],a[132:135],a[100:103],v[108:111]
ds_read_b64_tr_b16 a[130:131],v4 offset:6144
v_mov_b32 v63,0
v_mfma_f32_16x16x32_bf16 v[108:111],a[136:139],a[104:107],v[108:111]
ds_read_b64_tr_b16 a[132:133],v5 offset:0
v_fma_f32 v72,v72,s36,v13
v_smfmac_f32_16x16x64_bf16 v[60:63],a[152:155],v[20:27],v18
ds_read_b64_tr_b16 a[134:135],v5 offset:6144
v_mfma_f32_16x16x32_bf16 v[108:111],a[140:143],a[108:111],v[108:111]
v_fma_f32 v73,v73,s36,v13
v_fma_f32 v74,v74,s36,v13
v_mfma_f32_16x16x32_bf16 v[108:111],a[144:147],a[112:115],v[108:111]
v_fma_f32 v75,v75,s36,v13
v_fma_f32 v80,v80,s36,v14
v_mfma_f32_16x16x32_bf16 v[108:111],a[148:151],a[116:119],v[108:111]
v_fma_f32 v81,v81,s36,v14
v_fma_f32 v82,v82,s36,v14
v_fma_f32 v83,v83,s36,v14
v_fma_f32 v88,v88,s36,v15
v_fma_f32 v89,v89,s36,v15
v_exp_f32 v72,v72
v_exp_f32 v73,v73
v_exp_f32 v74,v74
v_exp_f32 v75,v75
v_exp_f32 v80,v80
v_exp_f32 v81,v81
v_exp_f32 v82,v82
v_exp_f32 v83,v83
v_exp_f32 v88,v88
v_exp_f32 v89,v89
v_cvt_pk_bf16_f32 v44,v72,v73
v_cvt_pk_bf16_f32 v45,v74,v75
v_cvt_pk_bf16_f32 v48,v80,v81
v_cvt_pk_bf16_f32 v49,v82,v83
v_cvt_pk_bf16_f32 v52,v88,v89
s_waitcnt lgkmcnt(0)
v_mfma_f32_16x16x32_bf16 v[160:163],a[120:123],v[20:23],0
s_add_u32 m0,s23,0
ds_read_b64_tr_b16 a[136:137],v2 offset:128
v_fma_f32 v90,v90,s36,v15
v_mfma_f32_16x16x32_bf16 v[164:167],a[124:127],v[20:23],0
ds_read_b64_tr_b16 a[138:139],v2 offset:6272
v_fma_f32 v91,v91,s36,v15
v_mfma_f32_16x16x32_bf16 v[212:215],a[124:127],v[24:27],0
ds_read_b64_tr_b16 a[140:141],v3 offset:128
v_fma_f32 v96,v96,s36,v16
v_mfma_f32_16x16x32_bf16 v[208:211],a[120:123],v[24:27],0
ds_read_b64_tr_b16 a[142:143],v3 offset:6272
v_fma_f32 v97,v97,s36,v16
v_mfma_f32_16x16x32_bf16 v[112:115],a[120:123],v[28:31],0
ds_read_b64_tr_b16 a[144:145],v4 offset:128
v_fma_f32 v98,v98,s36,v16
v_mfma_f32_16x16x32_bf16 v[116:119],a[124:127],v[28:31],0
ds_read_b64_tr_b16 a[146:147],v4 offset:6272
v_fma_f32 v99,v99,s36,v16
v_mfma_f32_16x16x32_bf16 a[164:167],a[124:127],v[32:35],0
ds_read_b64_tr_b16 a[148:149],v5 offset:128
v_fma_f32 v104,v104,s36,v17
v_mfma_f32_16x16x32_bf16 a[160:163],a[120:123],v[32:35],0
ds_read_b64_tr_b16 a[150:151],v5 offset:6272
v_fma_f32 v105,v105,s36,v17
v_mfma_f32_16x16x32_bf16 a[208:211],a[120:123],v[36:39],0
ds_read_b64_tr_b16 a[120:121],v2 offset:256
v_fma_f32 v106,v106,s36,v17
v_mfma_f32_16x16x32_bf16 a[212:215],a[124:127],v[36:39],0
ds_read_b64_tr_b16 a[122:123],v2 offset:6400
v_fma_f32 v107,v107,s36,v17
v_mfma_f32_16x16x32_bf16 a[216:219],a[128:131],v[36:39],0
ds_read_b64_tr_b16 a[124:125],v3 offset:256
v_fma_f32 v76,v76,s36,v13
v_mfma_f32_16x16x32_bf16 a[220:223],a[132:135],v[36:39],0
ds_read_b64_tr_b16 a[126:127],v3 offset:6400
v_fma_f32 v77,v77,s36,v13
v_mfma_f32_16x16x32_bf16 a[172:175],a[132:135],v[32:35],0
v_exp_f32 v90,v90
v_mfma_f32_16x16x32_bf16 a[168:171],a[128:131],v[32:35],0
v_exp_f32 v91,v91
v_mfma_f32_16x16x32_bf16 v[120:123],a[128:131],v[28:31],0
v_cvt_pk_bf16_f32 v53,v90,v91
v_fma_f32 v78,v78,s36,v13
v_mfma_f32_16x16x32_bf16 v[124:127],a[132:135],v[28:31],0
v_exp_f32 v96,v96
v_mfma_f32_16x16x32_bf16 v[220:223],a[132:135],v[24:27],0
v_exp_f32 v97,v97
v_mfma_f32_16x16x32_bf16 v[216:219],a[128:131],v[24:27],0
v_exp_f32 v98,v98
v_mfma_f32_16x16x32_bf16 v[168:171],a[128:131],v[20:23],0
ds_read_b64_tr_b16 a[128:129],v4 offset:256
v_cvt_pk_bf16_f32 v56,v96,v97
v_mfma_f32_16x16x32_bf16 v[172:175],a[132:135],v[20:23],0
s_waitcnt lgkmcnt(1)
ds_read_b64_tr_b16 a[130:131],v4 offset:6400
v_fma_f32 v79,v79,s36,v13
v_mfma_f32_16x16x32_bf16 v[176:179],a[136:139],v[20:23],0
ds_read_b64_tr_b16 a[132:133],v5 offset:256
v_fma_f32 v84,v84,s36,v14
v_mfma_f32_16x16x32_bf16 v[180:183],a[140:143],v[20:23],0
ds_read_b64_tr_b16 a[134:135],v5 offset:6400
v_fma_f32 v85,v85,s36,v14
v_mfma_f32_16x16x32_bf16 v[228:231],a[140:143],v[24:27],0
v_exp_f32 v99,v99
v_mfma_f32_16x16x32_bf16 v[224:227],a[136:139],v[24:27],0
v_cvt_pk_bf16_f32 v57,v98,v99
v_fma_f32 v86,v86,s36,v14
v_mfma_f32_16x16x32_bf16 v[128:131],a[136:139],v[28:31],0
v_exp_f32 v104,v104
v_mfma_f32_16x16x32_bf16 v[132:135],a[140:143],v[28:31],0
v_exp_f32 v105,v105
v_mfma_f32_16x16x32_bf16 a[180:183],a[140:143],v[32:35],0
v_exp_f32 v106,v106
v_mfma_f32_16x16x32_bf16 a[176:179],a[136:139],v[32:35],0
v_exp_f32 v107,v107
v_mfma_f32_16x16x32_bf16 a[224:227],a[136:139],v[36:39],0
v_cvt_pk_bf16_f32 v40,v104,v105
v_cvt_pk_bf16_f32 v41,v106,v107
v_mfma_f32_16x16x32_bf16 a[228:231],a[140:143],v[36:39],0
v_exp_f32 v76,v76
v_mfma_f32_16x16x32_bf16 a[232:235],a[144:147],v[36:39],0
v_exp_f32 v77,v77
v_mfma_f32_16x16x32_bf16 a[236:239],a[148:151],v[36:39],0
v_exp_f32 v78,v78
v_mfma_f32_16x16x32_bf16 a[188:191],a[148:151],v[32:35],0
v_exp_f32 v79,v79
v_mfma_f32_16x16x32_bf16 a[184:187],a[144:147],v[32:35],0
v_cvt_pk_bf16_f32 v46,v76,v77
v_cvt_pk_bf16_f32 v47,v78,v79
v_mfma_f32_16x16x32_bf16 v[136:139],a[144:147],v[28:31],0
v_fma_f32 v87,v87,s36,v14
v_fma_f32 v92,v92,s36,v15
v_mfma_f32_16x16x32_bf16 v[140:143],a[148:151],v[28:31],0
v_exp_f32 v84,v84
v_mfma_f32_16x16x32_bf16 v[236:239],a[148:151],v[24:27],0
v_exp_f32 v85,v85
v_mfma_f32_16x16x32_bf16 v[232:235],a[144:147],v[24:27],0
v_exp_f32 v86,v86
v_mfma_f32_16x16x32_bf16 v[184:187],a[144:147],v[20:23],0
v_exp_f32 v87,v87
v_mfma_f32_16x16x32_bf16 v[188:191],a[148:151],v[20:23],0
v_cvt_pk_bf16_f32 v50,v84,v85
v_cvt_pk_bf16_f32 v51,v86,v87
v_mfma_f32_16x16x32_bf16 v[192:195],a[120:123],v[20:23],0
v_fma_f32 v93,v93,s36,v15
v_fma_f32 v94,v94,s36,v15
v_smfmac_f32_16x16x64_bf16 v[60:63],a[152:155],v[44:51],v18
v_fma_f32 v95,v95,s36,v15
v_mfma_f32_16x16x32_bf16 v[196:199],a[124:127],v[20:23],0
s_waitcnt vmcnt(36) lgkmcnt(0)
v_exp_f32 v92,v92
v_mfma_f32_16x16x32_bf16 v[244:247],a[124:127],v[24:27],0
s_barrier
v_mfma_f32_16x16x32_bf16 v[240:243],a[120:123],v[24:27],0
ds_read_b128 a[136:139],v0 offset:24576
v_fma_f32 v100,v100,s36,v16
v_mfma_f32_16x16x32_bf16 v[144:147],a[120:123],v[28:31],0
ds_read_b128 a[140:143],v1 offset:24576
v_fma_f32 v101,v101,s36,v16
v_mfma_f32_16x16x32_bf16 v[148:151],a[124:127],v[28:31],0
ds_read_b128 a[144:147],v0 offset:24704
v_fma_f32 v102,v102,s36,v16
v_mfma_f32_16x16x32_bf16 a[196:199],a[124:127],v[32:35],0
ds_read_b128 a[148:151],v1 offset:24704
v_fma_f32 v103,v103,s36,v16
v_mfma_f32_16x16x32_bf16 a[192:195],a[120:123],v[32:35],0
v_exp_f32 v93,v93
v_mfma_f32_16x16x32_bf16 a[240:243],a[120:123],v[36:39],0
buffer_load_dwordx4 v6,s[8:11],s21 offen offset:0 lds
v_mfma_f32_16x16x32_bf16 a[244:247],a[124:127],v[36:39],0
ds_read_b128 a[120:123],v0 offset:24832
v_cvt_pk_bf16_f32 v54,v92,v93
v_mfma_f32_16x16x32_bf16 a[248:251],a[128:131],v[36:39],0
ds_read_b128 a[124:127],v1 offset:24832
v_fma_f32 v108,v108,s36,v17
v_mfma_f32_16x16x32_bf16 a[252:255],a[132:135],v[36:39],0
v_exp_f32 v94,v94
v_mfma_f32_16x16x32_bf16 a[204:207],a[132:135],v[32:35],0
v_exp_f32 v95,v95
v_mfma_f32_16x16x32_bf16 a[200:203],a[128:131],v[32:35],0
v_cvt_pk_bf16_f32 v55,v94,v95
v_fma_f32 v109,v109,s36,v17
v_mfma_f32_16x16x32_bf16 v[152:155],a[128:131],v[28:31],0
v_exp_f32 v100,v100
v_mfma_f32_16x16x32_bf16 v[156:159],a[132:135],v[28:31],0
v_exp_f32 v101,v101
v_mfma_f32_16x16x32_bf16 v[252:255],a[132:135],v[24:27],0
v_exp_f32 v102,v102
v_mfma_f32_16x16x32_bf16 v[248:251],a[128:131],v[24:27],0
v_exp_f32 v103,v103
v_mfma_f32_16x16x32_bf16 v[200:203],a[128:131],v[20:23],0
ds_read_b128 a[128:131],v0 offset:30720
v_cvt_pk_bf16_f32 v58,v100,v101
v_mfma_f32_16x16x32_bf16 v[204:207],a[132:135],v[20:23],0
buffer_load_dwordx4 v7,s[8:11],s21 offen offset:1024 lds
s_waitcnt lgkmcnt(1)
v_mfma_f32_16x16x32_bf16 v[72:75],a[136:139],a[0:3],0
ds_read_b128 a[132:135],v1 offset:30720
v_cvt_pk_bf16_f32 v59,v102,v103
v_mfma_f32_16x16x32_bf16 v[72:75],a[140:143],a[4:7],v[72:75]
v_fma_f32 v110,v110,s36,v17
v_fma_f32 v111,v111,s36,v17
v_smfmac_f32_16x16x64_bf16 v[64:67],a[152:155],v[52:59],v18
v_mfma_f32_16x16x32_bf16 v[72:75],a[144:147],a[8:11],v[72:75]
v_exp_f32 v108,v108
v_mfma_f32_16x16x32_bf16 v[72:75],a[148:151],a[12:15],v[72:75]
v_exp_f32 v109,v109
v_mfma_f32_16x16x32_bf16 v[72:75],a[120:123],a[16:19],v[72:75]
v_exp_f32 v110,v110
v_mfma_f32_16x16x32_bf16 v[72:75],a[124:127],a[20:23],v[72:75]
v_exp_f32 v111,v111
v_mfma_f32_16x16x32_bf16 v[80:83],a[124:127],a[44:47],0
v_cvt_pk_bf16_f32 v42,v108,v109
v_cvt_pk_bf16_f32 v43,v110,v111
v_mfma_f32_16x16x32_bf16 v[80:83],a[120:123],a[40:43],v[80:83]
v_mfma_f32_16x16x32_bf16 v[80:83],a[148:151],a[36:39],v[80:83]
v_smfmac_f32_16x16x64_bf16 v[68:71],a[152:155],v[36:43],v18
buffer_load_dwordx4 v8,s[8:11],s21 offen offset:2048 lds
v_mfma_f32_16x16x32_bf16 v[80:83],a[144:147],a[32:35],v[80:83]
s_add_u32 s21,s21,12288
v_fma_f32 v72,v72,s36,v13
v_fma_f32 v73,v73,s36,v13
v_mfma_f32_16x16x32_bf16 v[80:83],a[140:143],a[28:31],v[80:83]
s_add_u32 m0,s22,12288
v_fma_f32 v74,v74,s36,v13
v_fma_f32 v75,v75,s36,v13
v_mfma_f32_16x16x32_bf16 v[80:83],a[136:139],a[24:27],v[80:83]
v_exp_f32 v72,v72
v_mfma_f32_16x16x32_bf16 v[88:91],a[136:139],a[48:51],0
v_exp_f32 v73,v73
v_mfma_f32_16x16x32_bf16 v[88:91],a[140:143],a[52:55],v[88:91]
v_exp_f32 v74,v74
v_mfma_f32_16x16x32_bf16 v[88:91],a[144:147],a[56:59],v[88:91]
v_exp_f32 v75,v75
v_mfma_f32_16x16x32_bf16 v[88:91],a[148:151],a[60:63],v[88:91]
v_fma_f32 v80,v80,s36,v14
v_fma_f32 v81,v81,s36,v14
v_mfma_f32_16x16x32_bf16 v[88:91],a[120:123],a[64:67],v[88:91]
v_fma_f32 v82,v82,s36,v14
v_fma_f32 v83,v83,s36,v14
v_mfma_f32_16x16x32_bf16 v[88:91],a[124:127],a[68:71],v[88:91]
v_exp_f32 v80,v80
v_mfma_f32_16x16x32_bf16 v[96:99],a[124:127],a[92:95],0
v_exp_f32 v81,v81
v_mfma_f32_16x16x32_bf16 v[96:99],a[120:123],a[88:91],v[96:99]
buffer_load_dwordx4 v6,s[4:7],s20 offen offset:0 lds
v_mfma_f32_16x16x32_bf16 v[96:99],a[148:151],a[84:87],v[96:99]
v_exp_f32 v82,v82
v_mfma_f32_16x16x32_bf16 v[96:99],a[144:147],a[80:83],v[96:99]
v_fma_f32 v88,v88,s36,v15
v_fma_f32 v89,v89,s36,v15
v_mfma_f32_16x16x32_bf16 v[96:99],a[140:143],a[76:79],v[96:99]
v_exp_f32 v83,v83
v_mfma_f32_16x16x32_bf16 v[96:99],a[136:139],a[72:75],v[96:99]
v_exp_f32 v88,v88
v_mfma_f32_16x16x32_bf16 v[104:107],a[136:139],a[96:99],0
ds_read_b128 a[136:139],v0 offset:30848
v_cvt_pk_bf16_f32 v20,v72,v73
v_mfma_f32_16x16x32_bf16 v[104:107],a[140:143],a[100:103],v[104:107]
ds_read_b128 a[140:143],v1 offset:30848
v_cvt_pk_bf16_f32 v21,v74,v75
v_mfma_f32_16x16x32_bf16 v[104:107],a[144:147],a[104:107],v[104:107]
ds_read_b128 a[144:147],v0 offset:30976
v_cvt_pk_bf16_f32 v24,v80,v81
v_mfma_f32_16x16x32_bf16 v[104:107],a[148:151],a[108:111],v[104:107]
ds_read_b128 a[148:151],v1 offset:30976
v_cvt_pk_bf16_f32 v25,v82,v83
v_mfma_f32_16x16x32_bf16 v[104:107],a[120:123],a[112:115],v[104:107]
v_exp_f32 v89,v89
v_mfma_f32_16x16x32_bf16 v[104:107],a[124:127],a[116:119],v[104:107]
s_waitcnt lgkmcnt(4)
v_cvt_pk_bf16_f32 v28,v88,v89
v_mfma_f32_16x16x32_bf16 v[76:79],a[128:131],a[0:3],0
v_mfma_f32_16x16x32_bf16 v[76:79],a[132:135],a[4:7],v[76:79]
buffer_load_dwordx4 v7,s[4:7],s20 offen offset:1024 lds
s_waitcnt lgkmcnt(3)
v_mfma_f32_16x16x32_bf16 v[76:79],a[136:139],a[8:11],v[76:79]
s_waitcnt lgkmcnt(2)
v_mfma_f32_16x16x32_bf16 v[76:79],a[140:143],a[12:15],v[76:79]
s_waitcnt lgkmcnt(1)
v_mfma_f32_16x16x32_bf16 v[76:79],a[144:147],a[16:19],v[76:79]
s_waitcnt lgkmcnt(0)
v_mfma_f32_16x16x32_bf16 v[76:79],a[148:151],a[20:23],v[76:79]
v_mfma_f32_16x16x32_bf16 v[84:87],a[148:151],a[44:47],0
v_mfma_f32_16x16x32_bf16 v[84:87],a[144:147],a[40:43],v[84:87]
v_mfma_f32_16x16x32_bf16 v[84:87],a[140:143],a[36:39],v[84:87]
v_mfma_f32_16x16x32_bf16 v[84:87],a[136:139],a[32:35],v[84:87]
v_mfma_f32_16x16x32_bf16 v[84:87],a[132:135],a[28:31],v[84:87]
v_mfma_f32_16x16x32_bf16 v[84:87],a[128:131],a[24:27],v[84:87]
v_mfma_f32_16x16x32_bf16 v[92:95],a[128:131],a[48:51],0
buffer_load_dwordx4 v8,s[4:7],s20 offen offset:2048 lds
v_mfma_f32_16x16x32_bf16 v[92:95],a[132:135],a[52:55],v[92:95]
s_add_u32 s20,s20,12288
v_mfma_f32_16x16x32_bf16 v[92:95],a[136:139],a[56:59],v[92:95]
v_mfma_f32_16x16x32_bf16 v[92:95],a[140:143],a[60:63],v[92:95]
v_mfma_f32_16x16x32_bf16 v[92:95],a[144:147],a[64:67],v[92:95]
v_mfma_f32_16x16x32_bf16 v[92:95],a[148:151],a[68:71],v[92:95]
ds_read_b64_tr_b16 a[120:121],v2 offset:12288
v_mfma_f32_16x16x32_bf16 v[100:103],a[148:151],a[92:95],0
ds_read_b64_tr_b16 a[122:123],v2 offset:18432
v_mfma_f32_16x16x32_bf16 v[100:103],a[144:147],a[88:91],v[100:103]
v_mfma_f32_16x16x32_bf16 v[100:103],a[140:143],a[84:87],v[100:103]
ds_read_b64_tr_b16 a[124:125],v3 offset:12288
v_mfma_f32_16x16x32_bf16 v[100:103],a[136:139],a[80:83],v[100:103]
ds_read_b64_tr_b16 a[126:127],v3 offset:18432
v_mfma_f32_16x16x32_bf16 v[100:103],a[132:135],a[76:79],v[100:103]
v_mfma_f32_16x16x32_bf16 v[100:103],a[128:131],a[72:75],v[100:103]
v_mfma_f32_16x16x32_bf16 v[108:111],a[128:131],a[96:99],0
ds_read_b64_tr_b16 a[128:129],v4 offset:12288
v_mfma_f32_16x16x32_bf16 v[108:111],a[132:135],a[100:103],v[108:111]
ds_read_b64_tr_b16 a[130:131],v4 offset:18432
v_mfma_f32_16x16x32_bf16 v[108:111],a[136:139],a[104:107],v[108:111]
ds_read_b64_tr_b16 a[132:133],v5 offset:12288
v_mfma_f32_16x16x32_bf16 v[108:111],a[140:143],a[108:111],v[108:111]
ds_read_b64_tr_b16 a[134:135],v5 offset:18432
v_mfma_f32_16x16x32_bf16 v[108:111],a[144:147],a[112:115],v[108:111]
v_mfma_f32_16x16x32_bf16 v[108:111],a[148:151],a[116:119],v[108:111]
s_waitcnt lgkmcnt(4)
v_mfma_f32_16x16x32_bf16 v[160:163],a[120:123],v[44:47],v[160:163]
s_add_u32 m0,s23,12288
ds_read_b64_tr_b16 a[136:137],v2 offset:12416
v_fma_f32 v90,v90,s36,v15
v_mfma_f32_16x16x32_bf16 v[164:167],a[124:127],v[44:47],v[164:167]
ds_read_b64_tr_b16 a[138:139],v2 offset:18560
v_fma_f32 v91,v91,s36,v15
v_mfma_f32_16x16x32_bf16 v[212:215],a[124:127],v[48:51],v[212:215]
ds_read_b64_tr_b16 a[140:141],v3 offset:12416
v_fma_f32 v96,v96,s36,v16
v_mfma_f32_16x16x32_bf16 v[208:211],a[120:123],v[48:51],v[208:211]
ds_read_b64_tr_b16 a[142:143],v3 offset:18560
v_fma_f32 v97,v97,s36,v16
v_mfma_f32_16x16x32_bf16 v[112:115],a[120:123],v[52:55],v[112:115]
ds_read_b64_tr_b16 a[144:145],v4 offset:12416
v_fma_f32 v98,v98,s36,v16
v_mfma_f32_16x16x32_bf16 v[116:119],a[124:127],v[52:55],v[116:119]
ds_read_b64_tr_b16 a[146:147],v4 offset:18560
v_fma_f32 v99,v99,s36,v16
v_mfma_f32_16x16x32_bf16 a[164:167],a[124:127],v[56:59],a[164:167]
ds_read_b64_tr_b16 a[148:149],v5 offset:12416
v_fma_f32 v104,v104,s36,v17
v_mfma_f32_16x16x32_bf16 a[160:163],a[120:123],v[56:59],a[160:163]
ds_read_b64_tr_b16 a[150:151],v5 offset:18560
v_fma_f32 v105,v105,s36,v17
v_mfma_f32_16x16x32_bf16 a[208:211],a[120:123],v[40:43],a[208:211]
ds_read_b64_tr_b16 a[120:121],v2 offset:12544
v_fma_f32 v106,v106,s36,v17
v_mfma_f32_16x16x32_bf16 a[212:215],a[124:127],v[40:43],a[212:215]
s_waitcnt lgkmcnt(6)
ds_read_b64_tr_b16 a[122:123],v2 offset:18688
v_fma_f32 v107,v107,s36,v17
v_mfma_f32_16x16x32_bf16 a[216:219],a[128:131],v[40:43],a[216:219]
ds_read_b64_tr_b16 a[124:125],v3 offset:12544
v_fma_f32 v76,v76,s36,v13
v_mfma_f32_16x16x32_bf16 a[220:223],a[132:135],v[40:43],a[220:223]
ds_read_b64_tr_b16 a[126:127],v3 offset:18688
v_fma_f32 v77,v77,s36,v13
v_mfma_f32_16x16x32_bf16 a[172:175],a[132:135],v[56:59],a[172:175]
v_exp_f32 v90,v90
v_mfma_f32_16x16x32_bf16 a[168:171],a[128:131],v[56:59],a[168:171]
v_exp_f32 v91,v91
v_mfma_f32_16x16x32_bf16 v[120:123],a[128:131],v[52:55],v[120:123]
v_cvt_pk_bf16_f32 v29,v90,v91
v_fma_f32 v78,v78,s36,v13
v_mfma_f32_16x16x32_bf16 v[124:127],a[132:135],v[52:55],v[124:127]
v_exp_f32 v96,v96
v_mfma_f32_16x16x32_bf16 v[220:223],a[132:135],v[48:51],v[220:223]
v_exp_f32 v97,v97
v_mfma_f32_16x16x32_bf16 v[216:219],a[128:131],v[48:51],v[216:219]
v_exp_f32 v98,v98
v_mfma_f32_16x16x32_bf16 v[168:171],a[128:131],v[44:47],v[168:171]
ds_read_b64_tr_b16 a[128:129],v4 offset:12544
v_cvt_pk_bf16_f32 v32,v96,v97
v_mfma_f32_16x16x32_bf16 v[172:175],a[132:135],v[44:47],v[172:175]
ds_read_b64_tr_b16 a[130:131],v4 offset:18688
v_fma_f32 v79,v79,s36,v13
v_mfma_f32_16x16x32_bf16 v[176:179],a[136:139],v[44:47],v[176:179]
s_waitcnt lgkmcnt(2)
ds_read_b64_tr_b16 a[132:133],v5 offset:12544
v_fma_f32 v84,v84,s36,v14
v_mfma_f32_16x16x32_bf16 v[180:183],a[140:143],v[44:47],v[180:183]
ds_read_b64_tr_b16 a[134:135],v5 offset:18688
v_fma_f32 v85,v85,s36,v14
v_mfma_f32_16x16x32_bf16 v[228:231],a[140:143],v[48:51],v[228:231]
v_exp_f32 v99,v99
v_mfma_f32_16x16x32_bf16 v[224:227],a[136:139],v[48:51],v[224:227]
v_cvt_pk_bf16_f32 v33,v98,v99
v_fma_f32 v86,v86,s36,v14
v_mfma_f32_16x16x32_bf16 v[128:131],a[136:139],v[52:55],v[128:131]
v_exp_f32 v104,v104
v_mfma_f32_16x16x32_bf16 v[132:135],a[140:143],v[52:55],v[132:135]
v_exp_f32 v105,v105
v_mfma_f32_16x16x32_bf16 a[180:183],a[140:143],v[56:59],a[180:183]
v_exp_f32 v106,v106
v_mfma_f32_16x16x32_bf16 a[176:179],a[136:139],v[56:59],a[176:179]
v_exp_f32 v107,v107
v_mfma_f32_16x16x32_bf16 a[224:227],a[136:139],v[40:43],a[224:227]
v_cvt_pk_bf16_f32 v36,v104,v105
v_cvt_pk_bf16_f32 v37,v106,v107
v_mfma_f32_16x16x32_bf16 a[228:231],a[140:143],v[40:43],a[228:231]
v_exp_f32 v76,v76
v_mfma_f32_16x16x32_bf16 a[232:235],a[144:147],v[40:43],a[232:235]
v_exp_f32 v77,v77
v_mfma_f32_16x16x32_bf16 a[236:239],a[148:151],v[40:43],a[236:239]
v_exp_f32 v78,v78
v_mfma_f32_16x16x32_bf16 a[188:191],a[148:151],v[56:59],a[188:191]
v_exp_f32 v79,v79
v_mfma_f32_16x16x32_bf16 a[184:187],a[144:147],v[56:59],a[184:187]
v_cvt_pk_bf16_f32 v22,v76,v77
v_cvt_pk_bf16_f32 v23,v78,v79
v_mfma_f32_16x16x32_bf16 v[136:139],a[144:147],v[52:55],v[136:139]
v_fma_f32 v87,v87,s36,v14
v_fma_f32 v92,v92,s36,v15
v_mfma_f32_16x16x32_bf16 v[140:143],a[148:151],v[52:55],v[140:143]
v_exp_f32 v84,v84
v_mfma_f32_16x16x32_bf16 v[236:239],a[148:151],v[48:51],v[236:239]
v_exp_f32 v85,v85
v_mfma_f32_16x16x32_bf16 v[232:235],a[144:147],v[48:51],v[232:235]
v_exp_f32 v86,v86
v_mfma_f32_16x16x32_bf16 v[184:187],a[144:147],v[44:47],v[184:187]
v_exp_f32 v87,v87
v_mfma_f32_16x16x32_bf16 v[188:191],a[148:151],v[44:47],v[188:191]
v_cvt_pk_bf16_f32 v26,v84,v85
v_cvt_pk_bf16_f32 v27,v86,v87
v_mfma_f32_16x16x32_bf16 v[192:195],a[120:123],v[44:47],v[192:195]
v_fma_f32 v93,v93,s36,v15
v_fma_f32 v94,v94,s36,v15
v_smfmac_f32_16x16x64_bf16 v[60:63],a[152:155],v[20:27],v18
v_fma_f32 v95,v95,s36,v15
v_mfma_f32_16x16x32_bf16 v[196:199],a[124:127],v[44:47],v[196:199]
s_waitcnt vmcnt(6) lgkmcnt(0)
v_exp_f32 v92,v92
v_mfma_f32_16x16x32_bf16 v[244:247],a[124:127],v[48:51],v[244:247]
s_barrier
v_mfma_f32_16x16x32_bf16 v[240:243],a[120:123],v[48:51],v[240:243]
ds_read_b128 a[136:139],v0 offset:0
v_fma_f32 v100,v100,s36,v16
v_mfma_f32_16x16x32_bf16 v[144:147],a[120:123],v[52:55],v[144:147]
ds_read_b128 a[140:143],v1 offset:0
v_fma_f32 v101,v101,s36,v16
v_mfma_f32_16x16x32_bf16 v[148:151],a[124:127],v[52:55],v[148:151]
ds_read_b128 a[144:147],v0 offset:128
v_fma_f32 v102,v102,s36,v16
v_mfma_f32_16x16x32_bf16 a[196:199],a[124:127],v[56:59],a[196:199]
ds_read_b128 a[148:151],v1 offset:128
v_fma_f32 v103,v103,s36,v16
v_mfma_f32_16x16x32_bf16 a[192:195],a[120:123],v[56:59],a[192:195]
v_exp_f32 v93,v93
v_mfma_f32_16x16x32_bf16 a[240:243],a[120:123],v[40:43],a[240:243]
buffer_load_dwordx4 v6,s[8:11],s21 offen offset:0 lds
v_mfma_f32_16x16x32_bf16 a[244:247],a[124:127],v[40:43],a[244:247]
ds_read_b128 a[120:123],v0 offset:256
v_cvt_pk_bf16_f32 v30,v92,v93
v_mfma_f32_16x16x32_bf16 a[248:251],a[128:131],v[40:43],a[248:251]
ds_read_b128 a[124:127],v1 offset:256
v_fma_f32 v108,v108,s36,v17
v_mfma_f32_16x16x32_bf16 a[252:255],a[132:135],v[40:43],a[252:255]
v_exp_f32 v94,v94
v_mfma_f32_16x16x32_bf16 a[204:207],a[132:135],v[56:59],a[204:207]
v_exp_f32 v95,v95
v_mfma_f32_16x16x32_bf16 a[200:203],a[128:131],v[56:59],a[200:203]
v_cvt_pk_bf16_f32 v31,v94,v95
v_fma_f32 v109,v109,s36,v17
v_mfma_f32_16x16x32_bf16 v[152:155],a[128:131],v[52:55],v[152:155]
v_exp_f32 v100,v100
v_mfma_f32_16x16x32_bf16 v[156:159],a[132:135],v[52:55],v[156:159]
v_exp_f32 v101,v101
v_mfma_f32_16x16x32_bf16 v[252:255],a[132:135],v[48:51],v[252:255]
v_exp_f32 v102,v102
v_mfma_f32_16x16x32_bf16 v[248:251],a[128:131],v[48:51],v[248:251]
v_exp_f32 v103,v103
v_mfma_f32_16x16x32_bf16 v[200:203],a[128:131],v[44:47],v[200:203]
ds_read_b128 a[128:131],v0 offset:6144
v_cvt_pk_bf16_f32 v34,v100,v101
v_mfma_f32_16x16x32_bf16 v[204:207],a[132:135],v[44:47],v[204:207]
buffer_load_dwordx4 v7,s[8:11],s21 offen offset:1024 lds
s_waitcnt lgkmcnt(1)
v_mfma_f32_16x16x32_bf16 v[72:75],a[136:139],a[0:3],0
ds_read_b128 a[132:135],v1 offset:6144
v_cvt_pk_bf16_f32 v35,v102,v103
v_mfma_f32_16x16x32_bf16 v[72:75],a[140:143],a[4:7],v[72:75]
v_fma_f32 v110,v110,s36,v17
v_fma_f32 v111,v111,s36,v17
v_smfmac_f32_16x16x64_bf16 v[64:67],a[152:155],v[28:35],v18
v_mfma_f32_16x16x32_bf16 v[72:75],a[144:147],a[8:11],v[72:75]
v_exp_f32 v108,v108
v_mfma_f32_16x16x32_bf16 v[72:75],a[148:151],a[12:15],v[72:75]
v_exp_f32 v109,v109
v_mfma_f32_16x16x32_bf16 v[72:75],a[120:123],a[16:19],v[72:75]
v_exp_f32 v110,v110
v_mfma_f32_16x16x32_bf16 v[72:75],a[124:127],a[20:23],v[72:75]
v_exp_f32 v111,v111
v_mfma_f32_16x16x32_bf16 v[80:83],a[124:127],a[44:47],0
v_cvt_pk_bf16_f32 v38,v108,v109
v_cvt_pk_bf16_f32 v39,v110,v111
v_mfma_f32_16x16x32_bf16 v[80:83],a[120:123],a[40:43],v[80:83]
v_mfma_f32_16x16x32_bf16 v[80:83],a[148:151],a[36:39],v[80:83]
v_mfma_f32_16x16x32_bf16 v[80:83],a[144:147],a[32:35],v[80:83]
buffer_load_dwordx4 v8,s[8:11],s21 offen offset:2048 lds
v_mfma_f32_16x16x32_bf16 v[80:83],a[140:143],a[28:31],v[80:83]
s_add_u32 s21,s21,12288
v_fma_f32 v72,v72,s36,v13
v_fma_f32 v73,v73,s36,v13
v_mfma_f32_16x16x32_bf16 v[80:83],a[136:139],a[24:27],v[80:83]
s_add_u32 m0,s22,24576
v_fma_f32 v74,v74,s36,v13
v_fma_f32 v75,v75,s36,v13
v_mfma_f32_16x16x32_bf16 v[88:91],a[136:139],a[48:51],0
v_exp_f32 v72,v72
v_mfma_f32_16x16x32_bf16 v[88:91],a[140:143],a[52:55],v[88:91]
v_exp_f32 v73,v73
v_mfma_f32_16x16x32_bf16 v[88:91],a[144:147],a[56:59],v[88:91]
v_fma_f32 v80,v80,s36,v14
v_fma_f32 v81,v81,s36,v14
v_mfma_f32_16x16x32_bf16 v[88:91],a[148:151],a[60:63],v[88:91]
v_fma_f32 v82,v82,s36,v14
v_fma_f32 v83,v83,s36,v14
v_mfma_f32_16x16x32_bf16 v[88:91],a[120:123],a[64:67],v[88:91]
v_exp_f32 v74,v74
v_mfma_f32_16x16x32_bf16 v[88:91],a[124:127],a[68:71],v[88:91]
v_exp_f32 v75,v75
v_mfma_f32_16x16x32_bf16 v[96:99],a[124:127],a[92:95],0
v_exp_f32 v80,v80
v_mfma_f32_16x16x32_bf16 v[96:99],a[120:123],a[88:91],v[96:99]
v_exp_f32 v81,v81
v_mfma_f32_16x16x32_bf16 v[96:99],a[148:151],a[84:87],v[96:99]
v_exp_f32 v82,v82
v_mfma_f32_16x16x32_bf16 v[96:99],a[144:147],a[80:83],v[96:99]
buffer_load_dwordx4 v6,s[4:7],s20 offen offset:0 lds
v_mfma_f32_16x16x32_bf16 v[96:99],a[140:143],a[76:79],v[96:99]
v_fma_f32 v88,v88,s36,v15
v_fma_f32 v89,v89,s36,v15
v_mfma_f32_16x16x32_bf16 v[96:99],a[136:139],a[72:75],v[96:99]
v_exp_f32 v83,v83
v_mfma_f32_16x16x32_bf16 v[104:107],a[136:139],a[96:99],0
ds_read_b128 a[136:139],v0 offset:6272
v_cvt_pk_bf16_f32 v44,v72,v73
v_mfma_f32_16x16x32_bf16 v[104:107],a[140:143],a[100:103],v[104:107]
ds_read_b128 a[140:143],v1 offset:6272
v_cvt_pk_bf16_f32 v45,v74,v75
v_mfma_f32_16x16x32_bf16 v[104:107],a[144:147],a[104:107],v[104:107]
ds_read_b128 a[144:147],v0 offset:6400
v_cvt_pk_bf16_f32 v48,v80,v81
v_mfma_f32_16x16x32_bf16 v[104:107],a[148:151],a[108:111],v[104:107]
ds_read_b128 a[148:151],v1 offset:6400
v_cvt_pk_bf16_f32 v49,v82,v83
v_mfma_f32_16x16x32_bf16 v[104:107],a[120:123],a[112:115],v[104:107]
v_exp_f32 v88,v88
v_mfma_f32_16x16x32_bf16 v[104:107],a[124:127],a[116:119],v[104:107]
s_waitcnt lgkmcnt(4)
v_exp_f32 v89,v89
v_mfma_f32_16x16x32_bf16 v[76:79],a[128:131],a[0:3],0
v_cvt_pk_bf16_f32 v52,v88,v89
v_mfma_f32_16x16x32_bf16 v[76:79],a[132:135],a[4:7],v[76:79]
s_waitcnt lgkmcnt(3)
v_mfma_f32_16x16x32_bf16 v[76:79],a[136:139],a[8:11],v[76:79]
buffer_load_dwordx4 v7,s[4:7],s20 offen offset:1024 lds
s_waitcnt lgkmcnt(2)
v_mfma_f32_16x16x32_bf16 v[76:79],a[140:143],a[12:15],v[76:79]
s_waitcnt lgkmcnt(1)
v_mfma_f32_16x16x32_bf16 v[76:79],a[144:147],a[16:19],v[76:79]
s_waitcnt lgkmcnt(0)
v_mfma_f32_16x16x32_bf16 v[76:79],a[148:151],a[20:23],v[76:79]
v_mfma_f32_16x16x32_bf16 v[84:87],a[148:151],a[44:47],0
v_mfma_f32_16x16x32_bf16 v[84:87],a[144:147],a[40:43],v[84:87]
v_mfma_f32_16x16x32_bf16 v[84:87],a[140:143],a[36:39],v[84:87]
v_mfma_f32_16x16x32_bf16 v[84:87],a[136:139],a[32:35],v[84:87]
v_mfma_f32_16x16x32_bf16 v[84:87],a[132:135],a[28:31],v[84:87]
v_mfma_f32_16x16x32_bf16 v[84:87],a[128:131],a[24:27],v[84:87]
v_mfma_f32_16x16x32_bf16 v[92:95],a[128:131],a[48:51],0
v_mfma_f32_16x16x32_bf16 v[92:95],a[132:135],a[52:55],v[92:95]
buffer_load_dwordx4 v8,s[4:7],s20 offen offset:2048 lds
v_mfma_f32_16x16x32_bf16 v[92:95],a[136:139],a[56:59],v[92:95]
s_add_u32 s20,s20,12288
v_mfma_f32_16x16x32_bf16 v[92:95],a[140:143],a[60:63],v[92:95]
v_mfma_f32_16x16x32_bf16 v[92:95],a[144:147],a[64:67],v[92:95]
v_mfma_f32_16x16x32_bf16 v[92:95],a[148:151],a[68:71],v[92:95]
v_mfma_f32_16x16x32_bf16 v[100:103],a[148:151],a[92:95],0
v_mfma_f32_16x16x32_bf16 v[100:103],a[144:147],a[88:91],v[100:103]
ds_read_b64_tr_b16 a[120:121],v2 offset:24576
v_mfma_f32_16x16x32_bf16 v[100:103],a[140:143],a[84:87],v[100:103]
ds_read_b64_tr_b16 a[122:123],v2 offset:30720
v_mfma_f32_16x16x32_bf16 v[100:103],a[136:139],a[80:83],v[100:103]
ds_read_b64_tr_b16 a[124:125],v3 offset:24576
v_mfma_f32_16x16x32_bf16 v[100:103],a[132:135],a[76:79],v[100:103]
ds_read_b64_tr_b16 a[126:127],v3 offset:30720
v_mfma_f32_16x16x32_bf16 v[100:103],a[128:131],a[72:75],v[100:103]
v_mfma_f32_16x16x32_bf16 v[108:111],a[128:131],a[96:99],0
ds_read_b64_tr_b16 a[128:129],v4 offset:24576
v_mfma_f32_16x16x32_bf16 v[108:111],a[132:135],a[100:103],v[108:111]
ds_read_b64_tr_b16 a[130:131],v4 offset:30720
v_mfma_f32_16x16x32_bf16 v[108:111],a[136:139],a[104:107],v[108:111]
ds_read_b64_tr_b16 a[132:133],v5 offset:24576
v_mfma_f32_16x16x32_bf16 v[108:111],a[140:143],a[108:111],v[108:111]
ds_read_b64_tr_b16 a[134:135],v5 offset:30720
v_mfma_f32_16x16x32_bf16 v[108:111],a[144:147],a[112:115],v[108:111]
v_mfma_f32_16x16x32_bf16 v[108:111],a[148:151],a[116:119],v[108:111]
s_mov_b32 s38,0
s_branch L_loop5
L_loop4:
.p2align 6
L_loop4w0:
s_waitcnt lgkmcnt(3)
v_mfma_f32_16x16x32_bf16 v[160:163],a[120:123],v[20:23],v[160:163]
s_add_u32 m0,s23,24576
ds_read_b64_tr_b16 a[142:143],v3 offset:30848
v_fma_f32 v83,v83,s36,v14
v_mfma_f32_16x16x32_bf16 v[164:167],a[124:127],v[20:23],v[164:167]
ds_read_b64_tr_b16 a[138:139],v2 offset:30848
v_fma_f32 v82,v82,s36,v14
v_mfma_f32_16x16x32_bf16 v[212:215],a[124:127],v[24:27],v[212:215]
ds_read_b64_tr_b16 a[136:137],v2 offset:24704
v_fma_f32 v88,v88,s36,v15
v_mfma_f32_16x16x32_bf16 v[208:211],a[120:123],v[24:27],v[208:211]
ds_read_b64_tr_b16 a[140:141],v3 offset:24704
v_fma_f32 v91,v91,s36,v15
v_mfma_f32_16x16x32_bf16 v[112:115],a[120:123],v[28:31],v[112:115]
ds_read_b64_tr_b16 a[146:147],v4 offset:30848
v_fma_f32 v89,v89,s36,v15
v_mfma_f32_16x16x32_bf16 v[116:119],a[124:127],v[28:31],v[116:119]
ds_read_b64_tr_b16 a[150:151],v5 offset:30848
v_fma_f32 v90,v90,s36,v15
v_mfma_f32_16x16x32_bf16 a[164:167],a[124:127],v[32:35],a[164:167]
ds_read_b64_tr_b16 a[144:145],v4 offset:24704
v_fma_f32 v96,v96,s36,v16
v_mfma_f32_16x16x32_bf16 a[160:163],a[120:123],v[32:35],a[160:163]
s_waitcnt lgkmcnt(6)
ds_read_b64_tr_b16 a[148:149],v5 offset:24704
v_fma_f32 v98,v98,s36,v16
v_mfma_f32_16x16x32_bf16 a[168:171],a[128:131],v[32:35],a[168:171]
ds_read_b64_tr_b16 a[120:121],v2 offset:24832
v_fma_f32 v99,v99,s36,v16
v_mfma_f32_16x16x32_bf16 a[172:175],a[132:135],v[32:35],a[172:175]
ds_read_b64_tr_b16 a[126:127],v3 offset:30976
v_fma_f32 v97,v97,s36,v16
v_mfma_f32_16x16x32_bf16 v[124:127],a[132:135],v[28:31],v[124:127]
ds_read_b64_tr_b16 a[122:123],v2 offset:30976
v_fma_f32 v79,v79,s36,v13
v_mfma_f32_16x16x32_bf16 v[120:123],a[128:131],v[28:31],v[120:123]
ds_read_b64_tr_b16 a[124:125],v3 offset:24832
v_fma_f32 v77,v77,s36,v13
v_mfma_f32_16x16x32_bf16 v[216:219],a[128:131],v[24:27],v[216:219]
v_exp_f32 v82,v82
v_mfma_f32_16x16x32_bf16 v[220:223],a[132:135],v[24:27],v[220:223]
v_exp_f32 v83,v83
v_mfma_f32_16x16x32_bf16 v[172:175],a[132:135],v[20:23],v[172:175]
ds_read_b64_tr_b16 a[132:133],v5 offset:24832
v_cvt_pk_bf16_f32 v49,v82,v83
v_mfma_f32_16x16x32_bf16 v[168:171],a[128:131],v[20:23],v[168:171]
s_waitcnt lgkmcnt(4)
ds_read_b64_tr_b16 a[134:135],v5 offset:30976
v_fma_f32 v76,v76,s36,v13
v_mfma_f32_16x16x32_bf16 v[176:179],a[136:139],v[20:23],v[176:179]
ds_read_b64_tr_b16 a[128:129],v4 offset:24832
v_fma_f32 v78,v78,s36,v13
v_mfma_f32_16x16x32_bf16 v[180:183],a[140:143],v[20:23],v[180:183]
ds_read_b64_tr_b16 a[130:131],v4 offset:30976
v_fma_f32 v86,v86,s36,v14
v_mfma_f32_16x16x32_bf16 v[228:231],a[140:143],v[24:27],v[228:231]
v_exp_f32 v90,v90
v_mfma_f32_16x16x32_bf16 v[224:227],a[136:139],v[24:27],v[224:227]
v_exp_f32 v88,v88
v_mfma_f32_16x16x32_bf16 v[128:131],a[136:139],v[28:31],v[128:131]
v_exp_f32 v89,v89
v_mfma_f32_16x16x32_bf16 v[132:135],a[140:143],v[28:31],v[132:135]
v_cvt_pk_bf16_f32 v52,v88,v89
v_fma_f32 v84,v84,s36,v14
v_mfma_f32_16x16x32_bf16 a[180:183],a[140:143],v[32:35],a[180:183]
v_exp_f32 v91,v91
v_mfma_f32_16x16x32_bf16 a[176:179],a[136:139],v[32:35],a[176:179]
v_cvt_pk_bf16_f32 v53,v90,v91
v_fma_f32 v85,v85,s36,v14
v_mfma_f32_16x16x32_bf16 a[184:187],a[144:147],v[32:35],a[184:187]
v_exp_f32 v99,v99
v_mfma_f32_16x16x32_bf16 a[188:191],a[148:151],v[32:35],a[188:191]
v_exp_f32 v97,v97
v_mfma_f32_16x16x32_bf16 v[140:143],a[148:151],v[28:31],v[140:143]
v_exp_f32 v96,v96
v_mfma_f32_16x16x32_bf16 v[136:139],a[144:147],v[28:31],v[136:139]
v_cvt_pk_bf16_f32 v56,v96,v97
v_fma_f32 v87,v87,s36,v14
v_mfma_f32_16x16x32_bf16 v[232:235],a[144:147],v[24:27],v[232:235]
v_exp_f32 v98,v98
v_mfma_f32_16x16x32_bf16 v[236:239],a[148:151],v[24:27],v[236:239]
v_cvt_pk_bf16_f32 v57,v98,v99
v_fma_f32 v94,v94,s36,v15
v_mfma_f32_16x16x32_bf16 v[188:191],a[148:151],v[20:23],v[188:191]
v_exp_f32 v76,v76
v_mfma_f32_16x16x32_bf16 v[184:187],a[144:147],v[20:23],v[184:187]
s_waitcnt lgkmcnt(0)
v_exp_f32 v79,v79
v_mfma_f32_16x16x32_bf16 v[192:195],a[120:123],v[20:23],v[192:195]
v_exp_f32 v78,v78
v_mfma_f32_16x16x32_bf16 v[196:199],a[124:127],v[20:23],v[196:199]
s_waitcnt vmcnt(6)
ds_read_b128 a[156:159],v10 offset:0
v_cvt_pk_bf16_f32 v47,v78,v79
v_mfma_f32_16x16x32_bf16 v[244:247],a[124:127],v[24:27],v[244:247]
s_barrier
v_mfma_f32_16x16x32_bf16 v[240:243],a[120:123],v[24:27],v[240:243]
ds_read_b128 a[148:151],v1 offset:12416
v_fma_f32 v92,v92,s36,v15
v_mfma_f32_16x16x32_bf16 v[144:147],a[120:123],v[28:31],v[144:147]
ds_read_b128 a[144:147],v0 offset:12416
v_fma_f32 v93,v93,s36,v15
v_mfma_f32_16x16x32_bf16 v[148:151],a[124:127],v[28:31],v[148:151]
ds_read_b128 a[140:143],v1 offset:12288
v_fma_f32 v95,v95,s36,v15
v_mfma_f32_16x16x32_bf16 a[196:199],a[124:127],v[32:35],a[196:199]
ds_read_b128 a[124:127],v1 offset:12544
v_fma_f32 v102,v102,s36,v16
v_mfma_f32_16x16x32_bf16 a[192:195],a[120:123],v[32:35],a[192:195]
ds_read_b128 a[120:123],v0 offset:12544
v_fma_f32 v100,v100,s36,v16
v_mfma_f32_16x16x32_bf16 a[200:203],a[128:131],v[32:35],a[200:203]
buffer_load_dwordx4 v6,s[8:11],s21 offen offset:0 lds
v_mfma_f32_16x16x32_bf16 a[204:207],a[132:135],v[32:35],a[204:207]
ds_read_b128 a[136:139],v0 offset:12288
v_fma_f32 v101,v101,s36,v16
v_mfma_f32_16x16x32_bf16 v[156:159],a[132:135],v[28:31],v[156:159]
v_exp_f32 v77,v77
v_mfma_f32_16x16x32_bf16 v[152:155],a[128:131],v[28:31],v[152:155]
v_cvt_pk_bf16_f32 v46,v76,v77
v_fma_f32 v103,v103,s36,v16
v_mfma_f32_16x16x32_bf16 v[248:251],a[128:131],v[24:27],v[248:251]
v_exp_f32 v86,v86
v_mfma_f32_16x16x32_bf16 v[252:255],a[132:135],v[24:27],v[252:255]
v_exp_f32 v87,v87
v_mfma_f32_16x16x32_bf16 v[204:207],a[132:135],v[20:23],v[204:207]
ds_read_b128 a[132:135],v1 offset:18432
v_cvt_pk_bf16_f32 v51,v86,v87
v_mfma_f32_16x16x32_bf16 v[200:203],a[128:131],v[20:23],v[200:203]
s_waitcnt lgkmcnt(2)
ds_read_b128 a[128:131],v0 offset:18432
v_mfma_f32_16x16x32_bf16 v[72:75],a[124:127],a[20:23],0
v_exp_f32 v85,v85
v_mfma_f32_16x16x32_bf16 v[72:75],a[120:123],a[16:19],v[72:75]
buffer_store_dwordx4 a[156:159],v9,s[16:19],s27 offen offset:0 nt
buffer_load_dwordx4 v7,s[8:11],s21 offen offset:1024 lds
v_mfma_f32_16x16x32_bf16 v[72:75],a[148:151],a[12:15],v[72:75]
ds_read_b128 a[156:159],v10 offset:1024
v_mfma_f32_16x16x32_bf16 v[72:75],a[144:147],a[8:11],v[72:75]
v_exp_f32 v84,v84
v_mfma_f32_16x16x32_bf16 v[72:75],a[140:143],a[4:7],v[72:75]
s_waitcnt lgkmcnt(3)
v_cvt_pk_bf16_f32 v50,v84,v85
v_mfma_f32_16x16x32_bf16 v[72:75],a[136:139],a[0:3],v[72:75]
v_exp_f32 v93,v93
v_smfmac_f32_16x16x64_bf16 v[60:63],a[152:155],v[44:51],v18
v_mfma_f32_16x16x32_bf16 v[80:83],a[136:139],a[24:27],0
v_exp_f32 v94,v94
v_mfma_f32_16x16x32_bf16 v[80:83],a[140:143],a[28:31],v[80:83]
v_exp_f32 v92,v92
v_mfma_f32_16x16x32_bf16 v[80:83],a[144:147],a[32:35],v[80:83]
buffer_load_dwordx4 v8,s[8:11],s21 offen offset:2048 lds
v_mfma_f32_16x16x32_bf16 v[80:83],a[148:151],a[36:39],v[80:83]
s_add_u32 s21,s21,12288
v_cvt_pk_bf16_f32 v54,v92,v93
v_fma_f32 v72,v72,s36,v13
v_mfma_f32_16x16x32_bf16 v[80:83],a[120:123],a[40:43],v[80:83]
s_add_u32 m0,s22,0
v_exp_f32 v95,v95
v_mfma_f32_16x16x32_bf16 v[80:83],a[124:127],a[44:47],v[80:83]
v_cvt_pk_bf16_f32 v55,v94,v95
v_fma_f32 v75,v75,s36,v13
v_mfma_f32_16x16x32_bf16 v[88:91],a[124:127],a[68:71],0
v_exp_f32 v103,v103
v_mfma_f32_16x16x32_bf16 v[88:91],a[120:123],a[64:67],v[88:91]
v_exp_f32 v100,v100
v_mfma_f32_16x16x32_bf16 v[88:91],a[148:151],a[60:63],v[88:91]
v_exp_f32 v102,v102
v_mfma_f32_16x16x32_bf16 v[88:91],a[144:147],a[56:59],v[88:91]
v_cvt_pk_bf16_f32 v59,v102,v103
v_fma_f32 v80,v80,s36,v14
v_mfma_f32_16x16x32_bf16 v[88:91],a[140:143],a[52:55],v[88:91]
v_exp_f32 v101,v101
v_mfma_f32_16x16x32_bf16 v[88:91],a[136:139],a[48:51],v[88:91]
s_waitcnt lgkmcnt(0)
buffer_store_dwordx4 a[156:159],v9,s[16:19],s27 offen offset:128 nt
buffer_load_dwordx4 v6,s[4:7],s20 offen offset:0 lds
v_mfma_f32_16x16x32_bf16 v[96:99],a[136:139],a[72:75],0
ds_read_b128 a[156:159],v10 offset:2048
v_cvt_pk_bf16_f32 v58,v100,v101
v_mfma_f32_16x16x32_bf16 v[96:99],a[140:143],a[76:79],v[96:99]
ds_read_b128 a[136:139],v0 offset:18560
v_fma_f32 v81,v81,s36,v14
v_smfmac_f32_16x16x64_bf16 v[64:67],a[152:155],v[52:59],v18
ds_read_b128 a[140:143],v1 offset:18560
v_mfma_f32_16x16x32_bf16 v[96:99],a[144:147],a[80:83],v[96:99]
ds_read_b128 a[144:147],v0 offset:18688
v_mfma_f32_16x16x32_bf16 v[96:99],a[148:151],a[84:87],v[96:99]
ds_read_b128 a[148:151],v1 offset:18688
v_mfma_f32_16x16x32_bf16 v[96:99],a[120:123],a[88:91],v[96:99]
v_fma_f32 v73,v73,s36,v13
v_fma_f32 v74,v74,s36,v13
v_mfma_f32_16x16x32_bf16 v[96:99],a[124:127],a[92:95],v[96:99]
v_exp_f32 v74,v74
v_mfma_f32_16x16x32_bf16 v[76:79],a[128:131],a[0:3],0
buffer_load_dwordx4 v7,s[4:7],s20 offen offset:1024 lds
v_mfma_f32_16x16x32_bf16 v[76:79],a[132:135],a[4:7],v[76:79]
s_waitcnt lgkmcnt(3)
v_exp_f32 v75,v75
v_mfma_f32_16x16x32_bf16 v[76:79],a[136:139],a[8:11],v[76:79]
s_waitcnt lgkmcnt(2)
v_cvt_pk_bf16_f32 v21,v74,v75
v_mfma_f32_16x16x32_bf16 v[76:79],a[140:143],a[12:15],v[76:79]
s_waitcnt lgkmcnt(1)
v_exp_f32 v73,v73
v_mfma_f32_16x16x32_bf16 v[76:79],a[144:147],a[16:19],v[76:79]
s_waitcnt lgkmcnt(0)
v_exp_f32 v80,v80
v_mfma_f32_16x16x32_bf16 v[76:79],a[148:151],a[20:23],v[76:79]
v_exp_f32 v81,v81
v_mfma_f32_16x16x32_bf16 v[84:87],a[148:151],a[44:47],0
v_cvt_pk_bf16_f32 v24,v80,v81
v_mfma_f32_16x16x32_bf16 v[84:87],a[144:147],a[40:43],v[84:87]
v_exp_f32 v72,v72
v_mfma_f32_16x16x32_bf16 v[84:87],a[140:143],a[36:39],v[84:87]
v_cvt_pk_bf16_f32 v20,v72,v73
v_mfma_f32_16x16x32_bf16 v[84:87],a[136:139],a[32:35],v[84:87]
buffer_store_dwordx4 a[156:159],v9,s[16:19],s27 offen offset:256 nt
buffer_load_dwordx4 v8,s[4:7],s20 offen offset:2048 lds
v_mfma_f32_16x16x32_bf16 v[84:87],a[132:135],a[28:31],v[84:87]
s_add_u32 s20,s20,12288
ds_read_b64_tr_b16 a[122:123],v2 offset:6144
v_mfma_f32_16x16x32_bf16 v[84:87],a[128:131],a[24:27],v[84:87]
s_add_u32 s27,s27,3072
ds_read_b64_tr_b16 a[120:121],v2 offset:0
v_mfma_f32_16x16x32_bf16 v[92:95],a[128:131],a[48:51],0
ds_read_b64_tr_b16 a[124:125],v3 offset:0
v_mfma_f32_16x16x32_bf16 v[92:95],a[132:135],a[52:55],v[92:95]
ds_read_b64_tr_b16 a[126:127],v3 offset:6144
v_mfma_f32_16x16x32_bf16 v[92:95],a[136:139],a[56:59],v[92:95]
v_mfma_f32_16x16x32_bf16 v[92:95],a[140:143],a[60:63],v[92:95]
v_mfma_f32_16x16x32_bf16 v[92:95],a[144:147],a[64:67],v[92:95]
v_mfma_f32_16x16x32_bf16 v[92:95],a[148:151],a[68:71],v[92:95]
v_mfma_f32_16x16x32_bf16 v[100:103],a[148:151],a[92:95],0
v_mfma_f32_16x16x32_bf16 v[100:103],a[144:147],a[88:91],v[100:103]
v_mfma_f32_16x16x32_bf16 v[100:103],a[140:143],a[84:87],v[100:103]
v_mfma_f32_16x16x32_bf16 v[100:103],a[136:139],a[80:83],v[100:103]
v_mfma_f32_16x16x32_bf16 v[100:103],a[132:135],a[76:79],v[100:103]
ds_read_b64_tr_b16 a[134:135],v5 offset:6144
v_mfma_f32_16x16x32_bf16 v[100:103],a[128:131],a[72:75],v[100:103]
s_waitcnt lgkmcnt(1)
ds_read_b64_tr_b16 a[128:129],v4 offset:0
ds_read_b64_tr_b16 a[130:131],v4 offset:6144
ds_read_b64_tr_b16 a[132:133],v5 offset:0
v_mfma_f32_16x16x32_bf16 v[160:163],a[120:123],v[44:47],v[160:163]
s_add_u32 m0,s29,0
ds_read_b64_tr_b16 a[136:137],v2 offset:128
v_fma_f32 v82,v82,s36,v14
v_mfma_f32_16x16x32_bf16 v[164:167],a[124:127],v[44:47],v[164:167]
ds_read_b64_tr_b16 a[138:139],v2 offset:6272
v_fma_f32 v83,v83,s36,v14
v_mfma_f32_16x16x32_bf16 v[212:215],a[124:127],v[48:51],v[212:215]
ds_read_b64_tr_b16 a[140:141],v3 offset:128
v_fma_f32 v88,v88,s36,v15
v_mfma_f32_16x16x32_bf16 v[208:211],a[120:123],v[48:51],v[208:211]
ds_read_b64_tr_b16 a[142:143],v3 offset:6272
v_fma_f32 v89,v89,s36,v15
v_mfma_f32_16x16x32_bf16 v[112:115],a[120:123],v[52:55],v[112:115]
ds_read_b64_tr_b16 a[144:145],v4 offset:128
v_fma_f32 v90,v90,s36,v15
v_mfma_f32_16x16x32_bf16 v[116:119],a[124:127],v[52:55],v[116:119]
ds_read_b64_tr_b16 a[146:147],v4 offset:6272
v_fma_f32 v91,v91,s36,v15
v_mfma_f32_16x16x32_bf16 a[164:167],a[124:127],v[56:59],a[164:167]
buffer_load_dwordx4 v6,s[12:15],s28 offen offset:0 nt lds
v_mfma_f32_16x16x32_bf16 a[160:163],a[120:123],v[56:59],a[160:163]
s_waitcnt lgkmcnt(5)
ds_read_b64_tr_b16 a[148:149],v5 offset:128
v_fma_f32 v96,v96,s36,v16
v_mfma_f32_16x16x32_bf16 a[168:171],a[128:131],v[56:59],a[168:171]
ds_read_b64_tr_b16 a[150:151],v5 offset:6272
v_fma_f32 v97,v97,s36,v16
v_mfma_f32_16x16x32_bf16 a[172:175],a[132:135],v[56:59],a[172:175]
ds_read_b64_tr_b16 a[120:121],v2 offset:256
v_fma_f32 v98,v98,s36,v16
v_mfma_f32_16x16x32_bf16 v[124:127],a[132:135],v[52:55],v[124:127]
ds_read_b64_tr_b16 a[122:123],v2 offset:6400
v_fma_f32 v99,v99,s36,v16
v_mfma_f32_16x16x32_bf16 v[120:123],a[128:131],v[52:55],v[120:123]
ds_read_b64_tr_b16 a[124:125],v3 offset:256
v_fma_f32 v76,v76,s36,v13
v_mfma_f32_16x16x32_bf16 v[216:219],a[128:131],v[48:51],v[216:219]
ds_read_b64_tr_b16 a[126:127],v3 offset:6400
v_fma_f32 v77,v77,s36,v13
v_mfma_f32_16x16x32_bf16 v[220:223],a[132:135],v[48:51],v[220:223]
buffer_load_dwordx4 v7,s[12:15],s28 offen offset:1024 nt lds
v_mfma_f32_16x16x32_bf16 v[172:175],a[132:135],v[44:47],v[172:175]
ds_read_b64_tr_b16 a[132:133],v5 offset:256
v_fma_f32 v78,v78,s36,v13
v_mfma_f32_16x16x32_bf16 v[168:171],a[128:131],v[44:47],v[168:171]
s_waitcnt lgkmcnt(5)
ds_read_b64_tr_b16 a[128:129],v4 offset:256
v_fma_f32 v79,v79,s36,v13
v_mfma_f32_16x16x32_bf16 v[176:179],a[136:139],v[44:47],v[176:179]
ds_read_b64_tr_b16 a[130:131],v4 offset:6400
v_fma_f32 v84,v84,s36,v14
v_mfma_f32_16x16x32_bf16 v[180:183],a[140:143],v[44:47],v[180:183]
ds_read_b64_tr_b16 a[134:135],v5 offset:6400
v_fma_f32 v85,v85,s36,v14
v_mfma_f32_16x16x32_bf16 v[228:231],a[140:143],v[48:51],v[228:231]
v_exp_f32 v82,v82
v_mfma_f32_16x16x32_bf16 v[224:227],a[136:139],v[48:51],v[224:227]
v_exp_f32 v83,v83
v_mfma_f32_16x16x32_bf16 v[128:131],a[136:139],v[52:55],v[128:131]
v_cvt_pk_bf16_f32 v25,v82,v83
v_fma_f32 v86,v86,s36,v14
v_mfma_f32_16x16x32_bf16 v[132:135],a[140:143],v[52:55],v[132:135]
buffer_load_dwordx4 v8,s[12:15],s28 offen offset:2048 nt lds
v_mfma_f32_16x16x32_bf16 a[180:183],a[140:143],v[56:59],a[180:183]
s_add_u32 s28,s28,3072
v_exp_f32 v88,v88
v_mfma_f32_16x16x32_bf16 a[176:179],a[136:139],v[56:59],a[176:179]
s_add_u32 s29,s29,3072
v_exp_f32 v89,v89
v_mfma_f32_16x16x32_bf16 a[184:187],a[144:147],v[56:59],a[184:187]
s_add_u32 m0,s23,0
v_exp_f32 v90,v90
v_mfma_f32_16x16x32_bf16 a[188:191],a[148:151],v[56:59],a[188:191]
v_exp_f32 v91,v91
v_mfma_f32_16x16x32_bf16 v[140:143],a[148:151],v[52:55],v[140:143]
v_cvt_pk_bf16_f32 v28,v88,v89
v_cvt_pk_bf16_f32 v29,v90,v91
v_mfma_f32_16x16x32_bf16 v[136:139],a[144:147],v[52:55],v[136:139]
v_exp_f32 v96,v96
v_mfma_f32_16x16x32_bf16 v[232:235],a[144:147],v[48:51],v[232:235]
v_exp_f32 v97,v97
v_mfma_f32_16x16x32_bf16 v[236:239],a[148:151],v[48:51],v[236:239]
v_exp_f32 v98,v98
v_mfma_f32_16x16x32_bf16 v[188:191],a[148:151],v[44:47],v[188:191]
v_exp_f32 v99,v99
v_mfma_f32_16x16x32_bf16 v[184:187],a[144:147],v[44:47],v[184:187]
s_waitcnt lgkmcnt(0)
v_cvt_pk_bf16_f32 v32,v96,v97
v_cvt_pk_bf16_f32 v33,v98,v99
v_mfma_f32_16x16x32_bf16 v[192:195],a[120:123],v[44:47],v[192:195]
s_waitcnt vmcnt(12)
v_exp_f32 v76,v76
v_mfma_f32_16x16x32_bf16 v[196:199],a[124:127],v[44:47],v[196:199]
s_barrier
v_mfma_f32_16x16x32_bf16 v[244:247],a[124:127],v[48:51],v[244:247]
ds_read_b128 a[148:151],v1 offset:24704
v_fma_f32 v87,v87,s36,v14
v_mfma_f32_16x16x32_bf16 v[240:243],a[120:123],v[48:51],v[240:243]
ds_read_b128 a[144:147],v0 offset:24704
v_fma_f32 v92,v92,s36,v15
v_mfma_f32_16x16x32_bf16 v[144:147],a[120:123],v[52:55],v[144:147]
ds_read_b128 a[140:143],v1 offset:24576
v_fma_f32 v93,v93,s36,v15
v_mfma_f32_16x16x32_bf16 v[148:151],a[124:127],v[52:55],v[148:151]
ds_read_b128 a[136:139],v0 offset:24576
v_fma_f32 v94,v94,s36,v15
v_mfma_f32_16x16x32_bf16 a[196:199],a[124:127],v[56:59],a[196:199]
ds_read_b128 a[124:127],v1 offset:24832
v_fma_f32 v95,v95,s36,v15
v_mfma_f32_16x16x32_bf16 a[192:195],a[120:123],v[56:59],a[192:195]
buffer_load_dwordx4 v6,s[8:11],s21 offen offset:0 lds
v_mfma_f32_16x16x32_bf16 a[200:203],a[128:131],v[56:59],a[200:203]
ds_read_b128 a[120:123],v0 offset:24832
v_fma_f32 v100,v100,s36,v16
v_mfma_f32_16x16x32_bf16 a[204:207],a[132:135],v[56:59],a[204:207]
v_exp_f32 v77,v77
v_mfma_f32_16x16x32_bf16 v[156:159],a[132:135],v[52:55],v[156:159]
v_exp_f32 v78,v78
v_mfma_f32_16x16x32_bf16 v[152:155],a[128:131],v[52:55],v[152:155]
v_exp_f32 v79,v79
v_mfma_f32_16x16x32_bf16 v[248:251],a[128:131],v[48:51],v[248:251]
v_cvt_pk_bf16_f32 v22,v76,v77
v_cvt_pk_bf16_f32 v23,v78,v79
v_mfma_f32_16x16x32_bf16 v[252:255],a[132:135],v[48:51],v[252:255]
v_exp_f32 v84,v84
v_mfma_f32_16x16x32_bf16 v[204:207],a[132:135],v[44:47],v[204:207]
ds_read_b128 a[132:135],v1 offset:30720
v_fma_f32 v101,v101,s36,v16
v_mfma_f32_16x16x32_bf16 v[200:203],a[128:131],v[44:47],v[200:203]
s_waitcnt lgkmcnt(1)
ds_read_b128 a[128:131],v0 offset:30720
v_fma_f32 v102,v102,s36,v16
v_mfma_f32_16x16x32_bf16 v[72:75],a[124:127],a[20:23],0
buffer_load_dwordx4 v7,s[8:11],s21 offen offset:1024 lds
v_mfma_f32_16x16x32_bf16 v[72:75],a[120:123],a[16:19],v[72:75]
v_exp_f32 v85,v85
v_mfma_f32_16x16x32_bf16 v[72:75],a[148:151],a[12:15],v[72:75]
v_exp_f32 v86,v86
v_mfma_f32_16x16x32_bf16 v[72:75],a[144:147],a[8:11],v[72:75]
v_exp_f32 v87,v87
v_mfma_f32_16x16x32_bf16 v[72:75],a[140:143],a[4:7],v[72:75]
v_cvt_pk_bf16_f32 v26,v84,v85
v_cvt_pk_bf16_f32 v27,v86,v87
v_mfma_f32_16x16x32_bf16 v[72:75],a[136:139],a[0:3],v[72:75]
v_exp_f32 v92,v92
v_smfmac_f32_16x16x64_bf16 v[60:63],a[152:155],v[20:27],v18
v_fma_f32 v103,v103,s36,v16
v_mfma_f32_16x16x32_bf16 v[80:83],a[136:139],a[24:27],0
v_exp_f32 v93,v93
v_mfma_f32_16x16x32_bf16 v[80:83],a[140:143],a[28:31],v[80:83]
buffer_load_dwordx4 v8,s[8:11],s21 offen offset:2048 lds
v_mfma_f32_16x16x32_bf16 v[80:83],a[144:147],a[32:35],v[80:83]
s_add_u32 s21,s21,12288
v_exp_f32 v94,v94
v_mfma_f32_16x16x32_bf16 v[80:83],a[148:151],a[36:39],v[80:83]
s_add_u32 m0,s22,12288
v_exp_f32 v95,v95
v_mfma_f32_16x16x32_bf16 v[80:83],a[120:123],a[40:43],v[80:83]
v_cvt_pk_bf16_f32 v30,v92,v93
v_cvt_pk_bf16_f32 v31,v94,v95
v_mfma_f32_16x16x32_bf16 v[80:83],a[124:127],a[44:47],v[80:83]
v_exp_f32 v100,v100
v_mfma_f32_16x16x32_bf16 v[88:91],a[124:127],a[68:71],0
v_exp_f32 v101,v101
v_mfma_f32_16x16x32_bf16 v[88:91],a[120:123],a[64:67],v[88:91]
v_exp_f32 v102,v102
v_mfma_f32_16x16x32_bf16 v[88:91],a[148:151],a[60:63],v[88:91]
v_exp_f32 v103,v103
v_mfma_f32_16x16x32_bf16 v[88:91],a[144:147],a[56:59],v[88:91]
v_cvt_pk_bf16_f32 v34,v100,v101
v_cvt_pk_bf16_f32 v35,v102,v103
v_mfma_f32_16x16x32_bf16 v[88:91],a[140:143],a[52:55],v[88:91]
buffer_load_dwordx4 v6,s[4:7],s20 offen offset:0 lds
v_smfmac_f32_16x16x64_bf16 v[64:67],a[152:155],v[28:35],v18
v_fma_f32 v72,v72,s36,v13
v_mfma_f32_16x16x32_bf16 v[88:91],a[136:139],a[48:51],v[88:91]
v_fma_f32 v73,v73,s36,v13
v_fma_f32 v74,v74,s36,v13
v_mfma_f32_16x16x32_bf16 v[96:99],a[136:139],a[72:75],0
ds_read_b128 a[136:139],v0 offset:30848
v_fma_f32 v75,v75,s36,v13
v_mfma_f32_16x16x32_bf16 v[96:99],a[140:143],a[76:79],v[96:99]
ds_read_b128 a[140:143],v1 offset:30848
v_fma_f32 v80,v80,s36,v14
v_mfma_f32_16x16x32_bf16 v[96:99],a[144:147],a[80:83],v[96:99]
ds_read_b128 a[144:147],v0 offset:30976
v_fma_f32 v81,v81,s36,v14
v_mfma_f32_16x16x32_bf16 v[96:99],a[148:151],a[84:87],v[96:99]
ds_read_b128 a[148:151],v1 offset:30976
v_mfma_f32_16x16x32_bf16 v[96:99],a[120:123],a[88:91],v[96:99]
v_exp_f32 v72,v72
v_mfma_f32_16x16x32_bf16 v[96:99],a[124:127],a[92:95],v[96:99]
s_waitcnt lgkmcnt(4)
v_exp_f32 v73,v73
v_mfma_f32_16x16x32_bf16 v[76:79],a[128:131],a[0:3],0
buffer_load_dwordx4 v7,s[4:7],s20 offen offset:1024 lds
v_mfma_f32_16x16x32_bf16 v[76:79],a[132:135],a[4:7],v[76:79]
s_waitcnt lgkmcnt(3)
v_exp_f32 v74,v74
v_mfma_f32_16x16x32_bf16 v[76:79],a[136:139],a[8:11],v[76:79]
s_waitcnt lgkmcnt(2)
v_exp_f32 v75,v75
v_mfma_f32_16x16x32_bf16 v[76:79],a[140:143],a[12:15],v[76:79]
s_waitcnt lgkmcnt(0)
v_exp_f32 v80,v80
v_mfma_f32_16x16x32_bf16 v[76:79],a[144:147],a[16:19],v[76:79]
v_exp_f32 v81,v81
v_mfma_f32_16x16x32_bf16 v[76:79],a[148:151],a[20:23],v[76:79]
v_cvt_pk_bf16_f32 v44,v72,v73
v_cvt_pk_bf16_f32 v45,v74,v75
v_mfma_f32_16x16x32_bf16 v[84:87],a[148:151],a[44:47],0
v_cvt_pk_bf16_f32 v48,v80,v81
v_mfma_f32_16x16x32_bf16 v[84:87],a[144:147],a[40:43],v[84:87]
v_mfma_f32_16x16x32_bf16 v[84:87],a[140:143],a[36:39],v[84:87]
v_mfma_f32_16x16x32_bf16 v[84:87],a[136:139],a[32:35],v[84:87]
buffer_load_dwordx4 v8,s[4:7],s20 offen offset:2048 lds
v_mfma_f32_16x16x32_bf16 v[84:87],a[132:135],a[28:31],v[84:87]
s_add_u32 s20,s20,12288
v_mfma_f32_16x16x32_bf16 v[84:87],a[128:131],a[24:27],v[84:87]
ds_read_b64_tr_b16 a[120:121],v2 offset:12288
v_mfma_f32_16x16x32_bf16 v[92:95],a[128:131],a[48:51],0
ds_read_b64_tr_b16 a[122:123],v2 offset:18432
v_mfma_f32_16x16x32_bf16 v[92:95],a[132:135],a[52:55],v[92:95]
ds_read_b64_tr_b16 a[124:125],v3 offset:12288
v_mfma_f32_16x16x32_bf16 v[92:95],a[136:139],a[56:59],v[92:95]
ds_read_b64_tr_b16 a[126:127],v3 offset:18432
v_mfma_f32_16x16x32_bf16 v[92:95],a[140:143],a[60:63],v[92:95]
v_mfma_f32_16x16x32_bf16 v[92:95],a[144:147],a[64:67],v[92:95]
v_mfma_f32_16x16x32_bf16 v[92:95],a[148:151],a[68:71],v[92:95]
v_mfma_f32_16x16x32_bf16 v[100:103],a[148:151],a[92:95],0
v_mfma_f32_16x16x32_bf16 v[100:103],a[144:147],a[88:91],v[100:103]
v_mfma_f32_16x16x32_bf16 v[100:103],a[140:143],a[84:87],v[100:103]
v_mfma_f32_16x16x32_bf16 v[100:103],a[136:139],a[80:83],v[100:103]
v_mfma_f32_16x16x32_bf16 v[100:103],a[132:135],a[76:79],v[100:103]
ds_read_b64_tr_b16 a[132:133],v5 offset:12288
v_mfma_f32_16x16x32_bf16 v[100:103],a[128:131],a[72:75],v[100:103]
s_waitcnt lgkmcnt(1)
ds_read_b64_tr_b16 a[128:129],v4 offset:12288
ds_read_b64_tr_b16 a[130:131],v4 offset:18432
ds_read_b64_tr_b16 a[134:135],v5 offset:18432
v_mfma_f32_16x16x32_bf16 v[160:163],a[120:123],v[20:23],v[160:163]
s_add_u32 m0,s23,12288
ds_read_b64_tr_b16 a[142:143],v3 offset:18560
v_fma_f32 v83,v83,s36,v14
v_mfma_f32_16x16x32_bf16 v[164:167],a[124:127],v[20:23],v[164:167]
ds_read_b64_tr_b16 a[138:139],v2 offset:18560
v_fma_f32 v82,v82,s36,v14
v_mfma_f32_16x16x32_bf16 v[212:215],a[124:127],v[24:27],v[212:215]
ds_read_b64_tr_b16 a[136:137],v2 offset:12416
v_fma_f32 v88,v88,s36,v15
v_mfma_f32_16x16x32_bf16 v[208:211],a[120:123],v[24:27],v[208:211]
ds_read_b64_tr_b16 a[140:141],v3 offset:12416
v_fma_f32 v91,v91,s36,v15
v_mfma_f32_16x16x32_bf16 v[112:115],a[120:123],v[28:31],v[112:115]
ds_read_b64_tr_b16 a[146:147],v4 offset:18560
v_fma_f32 v89,v89,s36,v15
v_mfma_f32_16x16x32_bf16 v[116:119],a[124:127],v[28:31],v[116:119]
ds_read_b64_tr_b16 a[150:151],v5 offset:18560
v_fma_f32 v90,v90,s36,v15
v_mfma_f32_16x16x32_bf16 a[164:167],a[124:127],v[32:35],a[164:167]
ds_read_b64_tr_b16 a[144:145],v4 offset:12416
v_fma_f32 v96,v96,s36,v16
v_mfma_f32_16x16x32_bf16 a[160:163],a[120:123],v[32:35],a[160:163]
s_waitcnt lgkmcnt(6)
ds_read_b64_tr_b16 a[148:149],v5 offset:12416
v_fma_f32 v98,v98,s36,v16
v_mfma_f32_16x16x32_bf16 a[168:171],a[128:131],v[32:35],a[168:171]
ds_read_b64_tr_b16 a[120:121],v2 offset:12544
v_fma_f32 v99,v99,s36,v16
v_mfma_f32_16x16x32_bf16 a[172:175],a[132:135],v[32:35],a[172:175]
ds_read_b64_tr_b16 a[126:127],v3 offset:18688
v_fma_f32 v97,v97,s36,v16
v_mfma_f32_16x16x32_bf16 v[124:127],a[132:135],v[28:31],v[124:127]
ds_read_b64_tr_b16 a[122:123],v2 offset:18688
v_fma_f32 v79,v79,s36,v13
v_mfma_f32_16x16x32_bf16 v[120:123],a[128:131],v[28:31],v[120:123]
ds_read_b64_tr_b16 a[124:125],v3 offset:12544
v_fma_f32 v77,v77,s36,v13
v_mfma_f32_16x16x32_bf16 v[216:219],a[128:131],v[24:27],v[216:219]
v_exp_f32 v82,v82
v_mfma_f32_16x16x32_bf16 v[220:223],a[132:135],v[24:27],v[220:223]
v_exp_f32 v83,v83
v_mfma_f32_16x16x32_bf16 v[172:175],a[132:135],v[20:23],v[172:175]
ds_read_b64_tr_b16 a[132:133],v5 offset:12544
v_cvt_pk_bf16_f32 v49,v82,v83
v_mfma_f32_16x16x32_bf16 v[168:171],a[128:131],v[20:23],v[168:171]
s_waitcnt lgkmcnt(4)
ds_read_b64_tr_b16 a[134:135],v5 offset:18688
v_fma_f32 v76,v76,s36,v13
v_mfma_f32_16x16x32_bf16 v[176:179],a[136:139],v[20:23],v[176:179]
ds_read_b64_tr_b16 a[128:129],v4 offset:12544
v_fma_f32 v78,v78,s36,v13
v_mfma_f32_16x16x32_bf16 v[180:183],a[140:143],v[20:23],v[180:183]
ds_read_b64_tr_b16 a[130:131],v4 offset:18688
v_fma_f32 v86,v86,s36,v14
v_mfma_f32_16x16x32_bf16 v[228:231],a[140:143],v[24:27],v[228:231]
v_exp_f32 v90,v90
v_mfma_f32_16x16x32_bf16 v[224:227],a[136:139],v[24:27],v[224:227]
v_exp_f32 v88,v88
v_mfma_f32_16x16x32_bf16 v[128:131],a[136:139],v[28:31],v[128:131]
v_exp_f32 v89,v89
v_mfma_f32_16x16x32_bf16 v[132:135],a[140:143],v[28:31],v[132:135]
v_cvt_pk_bf16_f32 v52,v88,v89
v_fma_f32 v84,v84,s36,v14
v_mfma_f32_16x16x32_bf16 a[180:183],a[140:143],v[32:35],a[180:183]
v_exp_f32 v91,v91
v_mfma_f32_16x16x32_bf16 a[176:179],a[136:139],v[32:35],a[176:179]
v_cvt_pk_bf16_f32 v53,v90,v91
v_fma_f32 v85,v85,s36,v14
v_mfma_f32_16x16x32_bf16 a[184:187],a[144:147],v[32:35],a[184:187]
v_exp_f32 v99,v99
v_mfma_f32_16x16x32_bf16 a[188:191],a[148:151],v[32:35],a[188:191]
v_exp_f32 v97,v97
v_mfma_f32_16x16x32_bf16 v[140:143],a[148:151],v[28:31],v[140:143]
v_exp_f32 v96,v96
v_mfma_f32_16x16x32_bf16 v[136:139],a[144:147],v[28:31],v[136:139]
v_cvt_pk_bf16_f32 v56,v96,v97
v_fma_f32 v87,v87,s36,v14
v_mfma_f32_16x16x32_bf16 v[232:235],a[144:147],v[24:27],v[232:235]
v_exp_f32 v98,v98
v_mfma_f32_16x16x32_bf16 v[236:239],a[148:151],v[24:27],v[236:239]
v_cvt_pk_bf16_f32 v57,v98,v99
v_fma_f32 v94,v94,s36,v15
v_mfma_f32_16x16x32_bf16 v[188:191],a[148:151],v[20:23],v[188:191]
v_exp_f32 v76,v76
v_mfma_f32_16x16x32_bf16 v[184:187],a[144:147],v[20:23],v[184:187]
s_waitcnt lgkmcnt(0)
v_exp_f32 v79,v79
v_mfma_f32_16x16x32_bf16 v[192:195],a[120:123],v[20:23],v[192:195]
v_exp_f32 v78,v78
v_mfma_f32_16x16x32_bf16 v[196:199],a[124:127],v[20:23],v[196:199]
s_waitcnt vmcnt(9)
ds_read_b128 a[156:159],v10 offset:3072
v_cvt_pk_bf16_f32 v47,v78,v79
v_mfma_f32_16x16x32_bf16 v[244:247],a[124:127],v[24:27],v[244:247]
s_barrier
v_mfma_f32_16x16x32_bf16 v[240:243],a[120:123],v[24:27],v[240:243]
ds_read_b128 a[148:151],v1 offset:128
v_fma_f32 v92,v92,s36,v15
v_mfma_f32_16x16x32_bf16 v[144:147],a[120:123],v[28:31],v[144:147]
ds_read_b128 a[144:147],v0 offset:128
v_fma_f32 v93,v93,s36,v15
v_mfma_f32_16x16x32_bf16 v[148:151],a[124:127],v[28:31],v[148:151]
ds_read_b128 a[140:143],v1 offset:0
v_fma_f32 v95,v95,s36,v15
v_mfma_f32_16x16x32_bf16 a[196:199],a[124:127],v[32:35],a[196:199]
ds_read_b128 a[124:127],v1 offset:256
v_fma_f32 v102,v102,s36,v16
v_mfma_f32_16x16x32_bf16 a[192:195],a[120:123],v[32:35],a[192:195]
ds_read_b128 a[120:123],v0 offset:256
v_fma_f32 v100,v100,s36,v16
v_mfma_f32_16x16x32_bf16 a[200:203],a[128:131],v[32:35],a[200:203]
buffer_load_dwordx4 v6,s[8:11],s21 offen offset:0 lds
v_mfma_f32_16x16x32_bf16 a[204:207],a[132:135],v[32:35],a[204:207]
ds_read_b128 a[136:139],v0 offset:0
v_fma_f32 v101,v101,s36,v16
v_mfma_f32_16x16x32_bf16 v[156:159],a[132:135],v[28:31],v[156:159]
v_exp_f32 v77,v77
v_mfma_f32_16x16x32_bf16 v[152:155],a[128:131],v[28:31],v[152:155]
v_cvt_pk_bf16_f32 v46,v76,v77
v_fma_f32 v103,v103,s36,v16
v_mfma_f32_16x16x32_bf16 v[248:251],a[128:131],v[24:27],v[248:251]
v_exp_f32 v86,v86
v_mfma_f32_16x16x32_bf16 v[252:255],a[132:135],v[24:27],v[252:255]
v_exp_f32 v87,v87
v_mfma_f32_16x16x32_bf16 v[204:207],a[132:135],v[20:23],v[204:207]
ds_read_b128 a[132:135],v1 offset:6144
v_cvt_pk_bf16_f32 v51,v86,v87
v_mfma_f32_16x16x32_bf16 v[200:203],a[128:131],v[20:23],v[200:203]
s_waitcnt lgkmcnt(2)
ds_read_b128 a[128:131],v0 offset:6144
v_mfma_f32_16x16x32_bf16 v[72:75],a[124:127],a[20:23],0
v_exp_f32 v85,v85
v_mfma_f32_16x16x32_bf16 v[72:75],a[120:123],a[16:19],v[72:75]
buffer_store_dwordx4 a[156:159],v9,s[16:19],s27 offen offset:0 nt
buffer_load_dwordx4 v7,s[8:11],s21 offen offset:1024 lds
v_mfma_f32_16x16x32_bf16 v[72:75],a[148:151],a[12:15],v[72:75]
ds_read_b128 a[156:159],v10 offset:4096
v_mfma_f32_16x16x32_bf16 v[72:75],a[144:147],a[8:11],v[72:75]
v_exp_f32 v84,v84
v_mfma_f32_16x16x32_bf16 v[72:75],a[140:143],a[4:7],v[72:75]
s_waitcnt lgkmcnt(3)
v_cvt_pk_bf16_f32 v50,v84,v85
v_mfma_f32_16x16x32_bf16 v[72:75],a[136:139],a[0:3],v[72:75]
v_exp_f32 v93,v93
v_smfmac_f32_16x16x64_bf16 v[60:63],a[152:155],v[44:51],v18
v_mfma_f32_16x16x32_bf16 v[80:83],a[136:139],a[24:27],0
v_exp_f32 v94,v94
v_mfma_f32_16x16x32_bf16 v[80:83],a[140:143],a[28:31],v[80:83]
v_exp_f32 v92,v92
v_mfma_f32_16x16x32_bf16 v[80:83],a[144:147],a[32:35],v[80:83]
buffer_load_dwordx4 v8,s[8:11],s21 offen offset:2048 lds
v_mfma_f32_16x16x32_bf16 v[80:83],a[148:151],a[36:39],v[80:83]
s_add_u32 s21,s21,12288
v_cvt_pk_bf16_f32 v54,v92,v93
v_fma_f32 v72,v72,s36,v13
v_mfma_f32_16x16x32_bf16 v[80:83],a[120:123],a[40:43],v[80:83]
s_add_u32 m0,s22,24576
v_exp_f32 v95,v95
v_mfma_f32_16x16x32_bf16 v[80:83],a[124:127],a[44:47],v[80:83]
v_cvt_pk_bf16_f32 v55,v94,v95
v_fma_f32 v75,v75,s36,v13
v_mfma_f32_16x16x32_bf16 v[88:91],a[124:127],a[68:71],0
v_exp_f32 v103,v103
v_mfma_f32_16x16x32_bf16 v[88:91],a[120:123],a[64:67],v[88:91]
v_exp_f32 v100,v100
v_mfma_f32_16x16x32_bf16 v[88:91],a[148:151],a[60:63],v[88:91]
v_exp_f32 v102,v102
v_mfma_f32_16x16x32_bf16 v[88:91],a[144:147],a[56:59],v[88:91]
v_cvt_pk_bf16_f32 v59,v102,v103
v_fma_f32 v80,v80,s36,v14
v_mfma_f32_16x16x32_bf16 v[88:91],a[140:143],a[52:55],v[88:91]
v_exp_f32 v101,v101
v_mfma_f32_16x16x32_bf16 v[88:91],a[136:139],a[48:51],v[88:91]
s_waitcnt lgkmcnt(0)
buffer_store_dwordx4 a[156:159],v9,s[16:19],s27 offen offset:128 nt
buffer_load_dwordx4 v6,s[4:7],s20 offen offset:0 lds
v_mfma_f32_16x16x32_bf16 v[96:99],a[136:139],a[72:75],0
ds_read_b128 a[156:159],v10 offset:5120
v_cvt_pk_bf16_f32 v58,v100,v101
v_mfma_f32_16x16x32_bf16 v[96:99],a[140:143],a[76:79],v[96:99]
ds_read_b128 a[136:139],v0 offset:6272
v_fma_f32 v81,v81,s36,v14
v_smfmac_f32_16x16x64_bf16 v[64:67],a[152:155],v[52:59],v18
ds_read_b128 a[140:143],v1 offset:6272
v_mfma_f32_16x16x32_bf16 v[96:99],a[144:147],a[80:83],v[96:99]
ds_read_b128 a[144:147],v0 offset:6400
v_mfma_f32_16x16x32_bf16 v[96:99],a[148:151],a[84:87],v[96:99]
ds_read_b128 a[148:151],v1 offset:6400
v_mfma_f32_16x16x32_bf16 v[96:99],a[120:123],a[88:91],v[96:99]
v_fma_f32 v73,v73,s36,v13
v_fma_f32 v74,v74,s36,v13
v_mfma_f32_16x16x32_bf16 v[96:99],a[124:127],a[92:95],v[96:99]
v_exp_f32 v74,v74
v_mfma_f32_16x16x32_bf16 v[76:79],a[128:131],a[0:3],0
buffer_load_dwordx4 v7,s[4:7],s20 offen offset:1024 lds
v_mfma_f32_16x16x32_bf16 v[76:79],a[132:135],a[4:7],v[76:79]
s_waitcnt lgkmcnt(3)
v_exp_f32 v75,v75
v_mfma_f32_16x16x32_bf16 v[76:79],a[136:139],a[8:11],v[76:79]
s_waitcnt lgkmcnt(2)
v_cvt_pk_bf16_f32 v21,v74,v75
v_mfma_f32_16x16x32_bf16 v[76:79],a[140:143],a[12:15],v[76:79]
s_waitcnt lgkmcnt(1)
v_exp_f32 v73,v73
v_mfma_f32_16x16x32_bf16 v[76:79],a[144:147],a[16:19],v[76:79]
s_waitcnt lgkmcnt(0)
v_exp_f32 v80,v80
v_mfma_f32_16x16x32_bf16 v[76:79],a[148:151],a[20:23],v[76:79]
v_exp_f32 v81,v81
v_mfma_f32_16x16x32_bf16 v[84:87],a[148:151],a[44:47],0
v_cvt_pk_bf16_f32 v24,v80,v81
v_mfma_f32_16x16x32_bf16 v[84:87],a[144:147],a[40:43],v[84:87]
v_exp_f32 v72,v72
v_mfma_f32_16x16x32_bf16 v[84:87],a[140:143],a[36:39],v[84:87]
v_cvt_pk_bf16_f32 v20,v72,v73
v_mfma_f32_16x16x32_bf16 v[84:87],a[136:139],a[32:35],v[84:87]
buffer_store_dwordx4 a[156:159],v9,s[16:19],s27 offen offset:256 nt
buffer_load_dwordx4 v8,s[4:7],s20 offen offset:2048 lds
v_mfma_f32_16x16x32_bf16 v[84:87],a[132:135],a[28:31],v[84:87]
s_add_u32 s20,s20,12288
ds_read_b64_tr_b16 a[122:123],v2 offset:30720
v_mfma_f32_16x16x32_bf16 v[84:87],a[128:131],a[24:27],v[84:87]
s_add_u32 s27,s27,3072
ds_read_b64_tr_b16 a[120:121],v2 offset:24576
v_mfma_f32_16x16x32_bf16 v[92:95],a[128:131],a[48:51],0
ds_read_b64_tr_b16 a[124:125],v3 offset:24576
v_mfma_f32_16x16x32_bf16 v[92:95],a[132:135],a[52:55],v[92:95]
ds_read_b64_tr_b16 a[126:127],v3 offset:30720
v_mfma_f32_16x16x32_bf16 v[92:95],a[136:139],a[56:59],v[92:95]
v_mfma_f32_16x16x32_bf16 v[92:95],a[140:143],a[60:63],v[92:95]
v_mfma_f32_16x16x32_bf16 v[92:95],a[144:147],a[64:67],v[92:95]
v_mfma_f32_16x16x32_bf16 v[92:95],a[148:151],a[68:71],v[92:95]
v_mfma_f32_16x16x32_bf16 v[100:103],a[148:151],a[92:95],0
v_mfma_f32_16x16x32_bf16 v[100:103],a[144:147],a[88:91],v[100:103]
v_mfma_f32_16x16x32_bf16 v[100:103],a[140:143],a[84:87],v[100:103]
v_mfma_f32_16x16x32_bf16 v[100:103],a[136:139],a[80:83],v[100:103]
v_mfma_f32_16x16x32_bf16 v[100:103],a[132:135],a[76:79],v[100:103]
ds_read_b64_tr_b16 a[134:135],v5 offset:30720
v_mfma_f32_16x16x32_bf16 v[100:103],a[128:131],a[72:75],v[100:103]
s_waitcnt lgkmcnt(1)
ds_read_b64_tr_b16 a[128:129],v4 offset:24576
ds_read_b64_tr_b16 a[130:131],v4 offset:30720
ds_read_b64_tr_b16 a[132:133],v5 offset:24576
v_mfma_f32_16x16x32_bf16 v[160:163],a[120:123],v[44:47],v[160:163]
s_add_u32 m0,s29,0
ds_read_b64_tr_b16 a[136:137],v2 offset:24704
v_fma_f32 v82,v82,s36,v14
v_mfma_f32_16x16x32_bf16 v[164:167],a[124:127],v[44:47],v[164:167]
ds_read_b64_tr_b16 a[138:139],v2 offset:30848
v_fma_f32 v83,v83,s36,v14
v_mfma_f32_16x16x32_bf16 v[212:215],a[124:127],v[48:51],v[212:215]
ds_read_b64_tr_b16 a[140:141],v3 offset:24704
v_fma_f32 v88,v88,s36,v15
v_mfma_f32_16x16x32_bf16 v[208:211],a[120:123],v[48:51],v[208:211]
ds_read_b64_tr_b16 a[142:143],v3 offset:30848
v_fma_f32 v89,v89,s36,v15
v_mfma_f32_16x16x32_bf16 v[112:115],a[120:123],v[52:55],v[112:115]
ds_read_b64_tr_b16 a[144:145],v4 offset:24704
v_fma_f32 v90,v90,s36,v15
v_mfma_f32_16x16x32_bf16 v[116:119],a[124:127],v[52:55],v[116:119]
ds_read_b64_tr_b16 a[146:147],v4 offset:30848
v_fma_f32 v91,v91,s36,v15
v_mfma_f32_16x16x32_bf16 a[164:167],a[124:127],v[56:59],a[164:167]
buffer_load_dwordx4 v6,s[12:15],s28 offen offset:0 nt lds
v_mfma_f32_16x16x32_bf16 a[160:163],a[120:123],v[56:59],a[160:163]
s_waitcnt lgkmcnt(5)
ds_read_b64_tr_b16 a[148:149],v5 offset:24704
v_fma_f32 v96,v96,s36,v16
v_mfma_f32_16x16x32_bf16 a[168:171],a[128:131],v[56:59],a[168:171]
ds_read_b64_tr_b16 a[150:151],v5 offset:30848
v_fma_f32 v97,v97,s36,v16
v_mfma_f32_16x16x32_bf16 a[172:175],a[132:135],v[56:59],a[172:175]
ds_read_b64_tr_b16 a[120:121],v2 offset:24832
v_fma_f32 v98,v98,s36,v16
v_mfma_f32_16x16x32_bf16 v[124:127],a[132:135],v[52:55],v[124:127]
ds_read_b64_tr_b16 a[122:123],v2 offset:30976
v_fma_f32 v99,v99,s36,v16
v_mfma_f32_16x16x32_bf16 v[120:123],a[128:131],v[52:55],v[120:123]
ds_read_b64_tr_b16 a[124:125],v3 offset:24832
v_fma_f32 v76,v76,s36,v13
v_mfma_f32_16x16x32_bf16 v[216:219],a[128:131],v[48:51],v[216:219]
ds_read_b64_tr_b16 a[126:127],v3 offset:30976
v_fma_f32 v77,v77,s36,v13
v_mfma_f32_16x16x32_bf16 v[220:223],a[132:135],v[48:51],v[220:223]
buffer_load_dwordx4 v7,s[12:15],s28 offen offset:1024 nt lds
v_mfma_f32_16x16x32_bf16 v[172:175],a[132:135],v[44:47],v[172:175]
ds_read_b64_tr_b16 a[132:133],v5 offset:24832
v_fma_f32 v78,v78,s36,v13
v_mfma_f32_16x16x32_bf16 v[168:171],a[128:131],v[44:47],v[168:171]
s_waitcnt lgkmcnt(5)
ds_read_b64_tr_b16 a[128:129],v4 offset:24832
v_fma_f32 v79,v79,s36,v13
v_mfma_f32_16x16x32_bf16 v[176:179],a[136:139],v[44:47],v[176:179]
ds_read_b64_tr_b16 a[130:131],v4 offset:30976
v_fma_f32 v84,v84,s36,v14
v_mfma_f32_16x16x32_bf16 v[180:183],a[140:143],v[44:47],v[180:183]
ds_read_b64_tr_b16 a[134:135],v5 offset:30976
v_fma_f32 v85,v85,s36,v14
v_mfma_f32_16x16x32_bf16 v[228:231],a[140:143],v[48:51],v[228:231]
v_exp_f32 v82,v82
v_mfma_f32_16x16x32_bf16 v[224:227],a[136:139],v[48:51],v[224:227]
v_exp_f32 v83,v83
v_mfma_f32_16x16x32_bf16 v[128:131],a[136:139],v[52:55],v[128:131]
v_cvt_pk_bf16_f32 v25,v82,v83
v_fma_f32 v86,v86,s36,v14
v_mfma_f32_16x16x32_bf16 v[132:135],a[140:143],v[52:55],v[132:135]
buffer_load_dwordx4 v8,s[12:15],s28 offen offset:2048 nt lds
v_mfma_f32_16x16x32_bf16 a[180:183],a[140:143],v[56:59],a[180:183]
s_add_u32 s28,s28,3072
v_exp_f32 v88,v88
v_mfma_f32_16x16x32_bf16 a[176:179],a[136:139],v[56:59],a[176:179]
s_add_u32 s29,s29,3072
v_exp_f32 v89,v89
v_mfma_f32_16x16x32_bf16 a[184:187],a[144:147],v[56:59],a[184:187]
s_add_u32 m0,s23,24576
v_exp_f32 v90,v90
v_mfma_f32_16x16x32_bf16 a[188:191],a[148:151],v[56:59],a[188:191]
v_exp_f32 v91,v91
v_mfma_f32_16x16x32_bf16 v[140:143],a[148:151],v[52:55],v[140:143]
v_cvt_pk_bf16_f32 v28,v88,v89
v_cvt_pk_bf16_f32 v29,v90,v91
v_mfma_f32_16x16x32_bf16 v[136:139],a[144:147],v[52:55],v[136:139]
v_exp_f32 v96,v96
v_mfma_f32_16x16x32_bf16 v[232:235],a[144:147],v[48:51],v[232:235]
v_exp_f32 v97,v97
v_mfma_f32_16x16x32_bf16 v[236:239],a[148:151],v[48:51],v[236:239]
v_exp_f32 v98,v98
v_mfma_f32_16x16x32_bf16 v[188:191],a[148:151],v[44:47],v[188:191]
v_exp_f32 v99,v99
v_mfma_f32_16x16x32_bf16 v[184:187],a[144:147],v[44:47],v[184:187]
s_waitcnt lgkmcnt(0)
v_cvt_pk_bf16_f32 v32,v96,v97
v_cvt_pk_bf16_f32 v33,v98,v99
v_mfma_f32_16x16x32_bf16 v[192:195],a[120:123],v[44:47],v[192:195]
s_waitcnt vmcnt(12)
v_exp_f32 v76,v76
v_mfma_f32_16x16x32_bf16 v[196:199],a[124:127],v[44:47],v[196:199]
s_barrier
v_mfma_f32_16x16x32_bf16 v[244:247],a[124:127],v[48:51],v[244:247]
ds_read_b128 a[148:151],v1 offset:12416
v_fma_f32 v87,v87,s36,v14
v_mfma_f32_16x16x32_bf16 v[240:243],a[120:123],v[48:51],v[240:243]
ds_read_b128 a[144:147],v0 offset:12416
v_fma_f32 v92,v92,s36,v15
v_mfma_f32_16x16x32_bf16 v[144:147],a[120:123],v[52:55],v[144:147]
ds_read_b128 a[140:143],v1 offset:12288
v_fma_f32 v93,v93,s36,v15
v_mfma_f32_16x16x32_bf16 v[148:151],a[124:127],v[52:55],v[148:151]
ds_read_b128 a[136:139],v0 offset:12288
v_fma_f32 v94,v94,s36,v15
v_mfma_f32_16x16x32_bf16 a[196:199],a[124:127],v[56:59],a[196:199]
ds_read_b128 a[124:127],v1 offset:12544
v_fma_f32 v95,v95,s36,v15
v_mfma_f32_16x16x32_bf16 a[192:195],a[120:123],v[56:59],a[192:195]
buffer_load_dwordx4 v6,s[8:11],s21 offen offset:0 lds
v_mfma_f32_16x16x32_bf16 a[200:203],a[128:131],v[56:59],a[200:203]
ds_read_b128 a[120:123],v0 offset:12544
v_fma_f32 v100,v100,s36,v16
v_mfma_f32_16x16x32_bf16 a[204:207],a[132:135],v[56:59],a[204:207]
v_exp_f32 v77,v77
v_mfma_f32_16x16x32_bf16 v[156:159],a[132:135],v[52:55],v[156:159]
v_exp_f32 v78,v78
v_mfma_f32_16x16x32_bf16 v[152:155],a[128:131],v[52:55],v[152:155]
v_exp_f32 v79,v79
v_mfma_f32_16x16x32_bf16 v[248:251],a[128:131],v[48:51],v[248:251]
v_cvt_pk_bf16_f32 v22,v76,v77
v_cvt_pk_bf16_f32 v23,v78,v79
v_mfma_f32_16x16x32_bf16 v[252:255],a[132:135],v[48:51],v[252:255]
v_exp_f32 v84,v84
v_mfma_f32_16x16x32_bf16 v[204:207],a[132:135],v[44:47],v[204:207]
ds_read_b128 a[132:135],v1 offset:18432
v_fma_f32 v101,v101,s36,v16
v_mfma_f32_16x16x32_bf16 v[200:203],a[128:131],v[44:47],v[200:203]
s_waitcnt lgkmcnt(1)
ds_read_b128 a[128:131],v0 offset:18432
v_fma_f32 v102,v102,s36,v16
v_mfma_f32_16x16x32_bf16 v[72:75],a[124:127],a[20:23],0
buffer_load_dwordx4 v7,s[8:11],s21 offen offset:1024 lds
v_mfma_f32_16x16x32_bf16 v[72:75],a[120:123],a[16:19],v[72:75]
v_exp_f32 v85,v85
v_mfma_f32_16x16x32_bf16 v[72:75],a[148:151],a[12:15],v[72:75]
v_exp_f32 v86,v86
v_mfma_f32_16x16x32_bf16 v[72:75],a[144:147],a[8:11],v[72:75]
v_exp_f32 v87,v87
v_mfma_f32_16x16x32_bf16 v[72:75],a[140:143],a[4:7],v[72:75]
v_cvt_pk_bf16_f32 v26,v84,v85
v_cvt_pk_bf16_f32 v27,v86,v87
v_mfma_f32_16x16x32_bf16 v[72:75],a[136:139],a[0:3],v[72:75]
v_exp_f32 v92,v92
v_smfmac_f32_16x16x64_bf16 v[60:63],a[152:155],v[20:27],v18
v_fma_f32 v103,v103,s36,v16
v_mfma_f32_16x16x32_bf16 v[80:83],a[136:139],a[24:27],0
v_exp_f32 v93,v93
v_mfma_f32_16x16x32_bf16 v[80:83],a[140:143],a[28:31],v[80:83]
buffer_load_dwordx4 v8,s[8:11],s21 offen offset:2048 lds
v_mfma_f32_16x16x32_bf16 v[80:83],a[144:147],a[32:35],v[80:83]
s_add_u32 s21,s21,12288
v_exp_f32 v94,v94
v_mfma_f32_16x16x32_bf16 v[80:83],a[148:151],a[36:39],v[80:83]
s_add_u32 m0,s22,0
v_exp_f32 v95,v95
v_mfma_f32_16x16x32_bf16 v[80:83],a[120:123],a[40:43],v[80:83]
v_cvt_pk_bf16_f32 v30,v92,v93
v_cvt_pk_bf16_f32 v31,v94,v95
v_mfma_f32_16x16x32_bf16 v[80:83],a[124:127],a[44:47],v[80:83]
v_exp_f32 v100,v100
v_mfma_f32_16x16x32_bf16 v[88:91],a[124:127],a[68:71],0
v_exp_f32 v101,v101
v_mfma_f32_16x16x32_bf16 v[88:91],a[120:123],a[64:67],v[88:91]
v_exp_f32 v102,v102
v_mfma_f32_16x16x32_bf16 v[88:91],a[148:151],a[60:63],v[88:91]
v_exp_f32 v103,v103
v_mfma_f32_16x16x32_bf16 v[88:91],a[144:147],a[56:59],v[88:91]
v_cvt_pk_bf16_f32 v34,v100,v101
v_cvt_pk_bf16_f32 v35,v102,v103
v_mfma_f32_16x16x32_bf16 v[88:91],a[140:143],a[52:55],v[88:91]
buffer_load_dwordx4 v6,s[4:7],s20 offen offset:0 lds
v_smfmac_f32_16x16x64_bf16 v[64:67],a[152:155],v[28:35],v18
v_fma_f32 v72,v72,s36,v13
v_mfma_f32_16x16x32_bf16 v[88:91],a[136:139],a[48:51],v[88:91]
v_fma_f32 v73,v73,s36,v13
v_fma_f32 v74,v74,s36,v13
v_mfma_f32_16x16x32_bf16 v[96:99],a[136:139],a[72:75],0
ds_read_b128 a[136:139],v0 offset:18560
v_fma_f32 v75,v75,s36,v13
v_mfma_f32_16x16x32_bf16 v[96:99],a[140:143],a[76:79],v[96:99]
ds_read_b128 a[140:143],v1 offset:18560
v_fma_f32 v80,v80,s36,v14
v_mfma_f32_16x16x32_bf16 v[96:99],a[144:147],a[80:83],v[96:99]
ds_read_b128 a[144:147],v0 offset:18688
v_fma_f32 v81,v81,s36,v14
v_mfma_f32_16x16x32_bf16 v[96:99],a[148:151],a[84:87],v[96:99]
ds_read_b128 a[148:151],v1 offset:18688
v_mfma_f32_16x16x32_bf16 v[96:99],a[120:123],a[88:91],v[96:99]
v_exp_f32 v72,v72
v_mfma_f32_16x16x32_bf16 v[96:99],a[124:127],a[92:95],v[96:99]
s_waitcnt lgkmcnt(4)
v_exp_f32 v73,v73
v_mfma_f32_16x16x32_bf16 v[76:79],a[128:131],a[0:3],0
buffer_load_dwordx4 v7,s[4:7],s20 offen offset:1024 lds
v_mfma_f32_16x16x32_bf16 v[76:79],a[132:135],a[4:7],v[76:79]
s_waitcnt lgkmcnt(3)
v_exp_f32 v74,v74
v_mfma_f32_16x16x32_bf16 v[76:79],a[136:139],a[8:11],v[76:79]
s_waitcnt lgkmcnt(2)
v_exp_f32 v75,v75
v_mfma_f32_16x16x32_bf16 v[76:79],a[140:143],a[12:15],v[76:79]
s_waitcnt lgkmcnt(0)
v_exp_f32 v80,v80
v_mfma_f32_16x16x32_bf16 v[76:79],a[144:147],a[16:19],v[76:79]
v_exp_f32 v81,v81
v_mfma_f32_16x16x32_bf16 v[76:79],a[148:151],a[20:23],v[76:79]
v_cvt_pk_bf16_f32 v44,v72,v73
v_cvt_pk_bf16_f32 v45,v74,v75
v_mfma_f32_16x16x32_bf16 v[84:87],a[148:151],a[44:47],0
v_cvt_pk_bf16_f32 v48,v80,v81
v_mfma_f32_16x16x32_bf16 v[84:87],a[144:147],a[40:43],v[84:87]
v_mfma_f32_16x16x32_bf16 v[84:87],a[140:143],a[36:39],v[84:87]
v_mfma_f32_16x16x32_bf16 v[84:87],a[136:139],a[32:35],v[84:87]
buffer_load_dwordx4 v8,s[4:7],s20 offen offset:2048 lds
v_mfma_f32_16x16x32_bf16 v[84:87],a[132:135],a[28:31],v[84:87]
s_add_u32 s20,s20,12288
v_mfma_f32_16x16x32_bf16 v[84:87],a[128:131],a[24:27],v[84:87]
ds_read_b64_tr_b16 a[120:121],v2 offset:0
v_mfma_f32_16x16x32_bf16 v[92:95],a[128:131],a[48:51],0
ds_read_b64_tr_b16 a[122:123],v2 offset:6144
v_mfma_f32_16x16x32_bf16 v[92:95],a[132:135],a[52:55],v[92:95]
ds_read_b64_tr_b16 a[124:125],v3 offset:0
v_mfma_f32_16x16x32_bf16 v[92:95],a[136:139],a[56:59],v[92:95]
ds_read_b64_tr_b16 a[126:127],v3 offset:6144
v_mfma_f32_16x16x32_bf16 v[92:95],a[140:143],a[60:63],v[92:95]
v_mfma_f32_16x16x32_bf16 v[92:95],a[144:147],a[64:67],v[92:95]
v_mfma_f32_16x16x32_bf16 v[92:95],a[148:151],a[68:71],v[92:95]
v_mfma_f32_16x16x32_bf16 v[100:103],a[148:151],a[92:95],0
v_mfma_f32_16x16x32_bf16 v[100:103],a[144:147],a[88:91],v[100:103]
v_mfma_f32_16x16x32_bf16 v[100:103],a[140:143],a[84:87],v[100:103]
v_mfma_f32_16x16x32_bf16 v[100:103],a[136:139],a[80:83],v[100:103]
v_mfma_f32_16x16x32_bf16 v[100:103],a[132:135],a[76:79],v[100:103]
ds_read_b64_tr_b16 a[132:133],v5 offset:0
v_mfma_f32_16x16x32_bf16 v[100:103],a[128:131],a[72:75],v[100:103]
s_waitcnt lgkmcnt(1)
ds_read_b64_tr_b16 a[128:129],v4 offset:0
ds_read_b64_tr_b16 a[130:131],v4 offset:6144
ds_read_b64_tr_b16 a[134:135],v5 offset:6144
v_mfma_f32_16x16x32_bf16 v[160:163],a[120:123],v[20:23],v[160:163]
s_add_u32 m0,s23,0
ds_read_b64_tr_b16 a[142:143],v3 offset:6272
v_fma_f32 v83,v83,s36,v14
v_mfma_f32_16x16x32_bf16 v[164:167],a[124:127],v[20:23],v[164:167]
ds_read_b64_tr_b16 a[138:139],v2 offset:6272
v_fma_f32 v82,v82,s36,v14
v_mfma_f32_16x16x32_bf16 v[212:215],a[124:127],v[24:27],v[212:215]
ds_read_b64_tr_b16 a[136:137],v2 offset:128
v_fma_f32 v88,v88,s36,v15
v_mfma_f32_16x16x32_bf16 v[208:211],a[120:123],v[24:27],v[208:211]
ds_read_b64_tr_b16 a[140:141],v3 offset:128
v_fma_f32 v91,v91,s36,v15
v_mfma_f32_16x16x32_bf16 v[112:115],a[120:123],v[28:31],v[112:115]
ds_read_b64_tr_b16 a[146:147],v4 offset:6272
v_fma_f32 v89,v89,s36,v15
v_mfma_f32_16x16x32_bf16 v[116:119],a[124:127],v[28:31],v[116:119]
ds_read_b64_tr_b16 a[150:151],v5 offset:6272
v_fma_f32 v90,v90,s36,v15
v_mfma_f32_16x16x32_bf16 a[164:167],a[124:127],v[32:35],a[164:167]
ds_read_b64_tr_b16 a[144:145],v4 offset:128
v_fma_f32 v96,v96,s36,v16
v_mfma_f32_16x16x32_bf16 a[160:163],a[120:123],v[32:35],a[160:163]
s_waitcnt lgkmcnt(6)
ds_read_b64_tr_b16 a[148:149],v5 offset:128
v_fma_f32 v98,v98,s36,v16
v_mfma_f32_16x16x32_bf16 a[168:171],a[128:131],v[32:35],a[168:171]
ds_read_b64_tr_b16 a[120:121],v2 offset:256
v_fma_f32 v99,v99,s36,v16
v_mfma_f32_16x16x32_bf16 a[172:175],a[132:135],v[32:35],a[172:175]
ds_read_b64_tr_b16 a[126:127],v3 offset:6400
v_fma_f32 v97,v97,s36,v16
v_mfma_f32_16x16x32_bf16 v[124:127],a[132:135],v[28:31],v[124:127]
ds_read_b64_tr_b16 a[122:123],v2 offset:6400
v_fma_f32 v79,v79,s36,v13
v_mfma_f32_16x16x32_bf16 v[120:123],a[128:131],v[28:31],v[120:123]
ds_read_b64_tr_b16 a[124:125],v3 offset:256
v_fma_f32 v77,v77,s36,v13
v_mfma_f32_16x16x32_bf16 v[216:219],a[128:131],v[24:27],v[216:219]
v_exp_f32 v82,v82
v_mfma_f32_16x16x32_bf16 v[220:223],a[132:135],v[24:27],v[220:223]
v_exp_f32 v83,v83
v_mfma_f32_16x16x32_bf16 v[172:175],a[132:135],v[20:23],v[172:175]
ds_read_b64_tr_b16 a[132:133],v5 offset:256
v_cvt_pk_bf16_f32 v49,v82,v83
v_mfma_f32_16x16x32_bf16 v[168:171],a[128:131],v[20:23],v[168:171]
s_waitcnt lgkmcnt(4)
ds_read_b64_tr_b16 a[134:135],v5 offset:6400
v_fma_f32 v76,v76,s36,v13
v_mfma_f32_16x16x32_bf16 v[176:179],a[136:139],v[20:23],v[176:179]
ds_read_b64_tr_b16 a[128:129],v4 offset:256
v_fma_f32 v78,v78,s36,v13
v_mfma_f32_16x16x32_bf16 v[180:183],a[140:143],v[20:23],v[180:183]
ds_read_b64_tr_b16 a[130:131],v4 offset:6400
v_fma_f32 v86,v86,s36,v14
v_mfma_f32_16x16x32_bf16 v[228:231],a[140:143],v[24:27],v[228:231]
v_exp_f32 v90,v90
v_mfma_f32_16x16x32_bf16 v[224:227],a[136:139],v[24:27],v[224:227]
v_exp_f32 v88,v88
v_mfma_f32_16x16x32_bf16 v[128:131],a[136:139],v[28:31],v[128:131]
v_exp_f32 v89,v89
v_mfma_f32_16x16x32_bf16 v[132:135],a[140:143],v[28:31],v[132:135]
v_cvt_pk_bf16_f32 v52,v88,v89
v_fma_f32 v84,v84,s36,v14
v_mfma_f32_16x16x32_bf16 a[180:183],a[140:143],v[32:35],a[180:183]
v_exp_f32 v91,v91
v_mfma_f32_16x16x32_bf16 a[176:179],a[136:139],v[32:35],a[176:179]
v_cvt_pk_bf16_f32 v53,v90,v91
v_fma_f32 v85,v85,s36,v14
v_mfma_f32_16x16x32_bf16 a[184:187],a[144:147],v[32:35],a[184:187]
v_exp_f32 v99,v99
v_mfma_f32_16x16x32_bf16 a[188:191],a[148:151],v[32:35],a[188:191]
v_exp_f32 v97,v97
v_mfma_f32_16x16x32_bf16 v[140:143],a[148:151],v[28:31],v[140:143]
v_exp_f32 v96,v96
v_mfma_f32_16x16x32_bf16 v[136:139],a[144:147],v[28:31],v[136:139]
v_cvt_pk_bf16_f32 v56,v96,v97
v_fma_f32 v87,v87,s36,v14
v_mfma_f32_16x16x32_bf16 v[232:235],a[144:147],v[24:27],v[232:235]
v_exp_f32 v98,v98
v_mfma_f32_16x16x32_bf16 v[236:239],a[148:151],v[24:27],v[236:239]
v_cvt_pk_bf16_f32 v57,v98,v99
v_fma_f32 v94,v94,s36,v15
v_mfma_f32_16x16x32_bf16 v[188:191],a[148:151],v[20:23],v[188:191]
v_exp_f32 v76,v76
v_mfma_f32_16x16x32_bf16 v[184:187],a[144:147],v[20:23],v[184:187]
s_waitcnt lgkmcnt(0)
v_exp_f32 v79,v79
v_mfma_f32_16x16x32_bf16 v[192:195],a[120:123],v[20:23],v[192:195]
v_exp_f32 v78,v78
v_mfma_f32_16x16x32_bf16 v[196:199],a[124:127],v[20:23],v[196:199]
s_waitcnt vmcnt(9)
ds_read_b128 a[156:159],v10 offset:6144
v_cvt_pk_bf16_f32 v47,v78,v79
v_mfma_f32_16x16x32_bf16 v[244:247],a[124:127],v[24:27],v[244:247]
s_barrier
v_mfma_f32_16x16x32_bf16 v[240:243],a[120:123],v[24:27],v[240:243]
ds_read_b128 a[148:151],v1 offset:24704
v_fma_f32 v92,v92,s36,v15
v_mfma_f32_16x16x32_bf16 v[144:147],a[120:123],v[28:31],v[144:147]
ds_read_b128 a[144:147],v0 offset:24704
v_fma_f32 v93,v93,s36,v15
v_mfma_f32_16x16x32_bf16 v[148:151],a[124:127],v[28:31],v[148:151]
ds_read_b128 a[140:143],v1 offset:24576
v_fma_f32 v95,v95,s36,v15
v_mfma_f32_16x16x32_bf16 a[196:199],a[124:127],v[32:35],a[196:199]
ds_read_b128 a[124:127],v1 offset:24832
v_fma_f32 v102,v102,s36,v16
v_mfma_f32_16x16x32_bf16 a[192:195],a[120:123],v[32:35],a[192:195]
ds_read_b128 a[120:123],v0 offset:24832
v_fma_f32 v100,v100,s36,v16
v_mfma_f32_16x16x32_bf16 a[200:203],a[128:131],v[32:35],a[200:203]
buffer_load_dwordx4 v6,s[8:11],s21 offen offset:0 lds
v_mfma_f32_16x16x32_bf16 a[204:207],a[132:135],v[32:35],a[204:207]
ds_read_b128 a[136:139],v0 offset:24576
v_fma_f32 v101,v101,s36,v16
v_mfma_f32_16x16x32_bf16 v[156:159],a[132:135],v[28:31],v[156:159]
v_exp_f32 v77,v77
v_mfma_f32_16x16x32_bf16 v[152:155],a[128:131],v[28:31],v[152:155]
v_cvt_pk_bf16_f32 v46,v76,v77
v_fma_f32 v103,v103,s36,v16
v_mfma_f32_16x16x32_bf16 v[248:251],a[128:131],v[24:27],v[248:251]
v_exp_f32 v86,v86
v_mfma_f32_16x16x32_bf16 v[252:255],a[132:135],v[24:27],v[252:255]
v_exp_f32 v87,v87
v_mfma_f32_16x16x32_bf16 v[204:207],a[132:135],v[20:23],v[204:207]
ds_read_b128 a[132:135],v1 offset:30720
v_cvt_pk_bf16_f32 v51,v86,v87
v_mfma_f32_16x16x32_bf16 v[200:203],a[128:131],v[20:23],v[200:203]
s_waitcnt lgkmcnt(2)
ds_read_b128 a[128:131],v0 offset:30720
v_mfma_f32_16x16x32_bf16 v[72:75],a[124:127],a[20:23],0
v_exp_f32 v85,v85
v_mfma_f32_16x16x32_bf16 v[72:75],a[120:123],a[16:19],v[72:75]
buffer_store_dwordx4 a[156:159],v9,s[16:19],s27 offen offset:0 nt
buffer_load_dwordx4 v7,s[8:11],s21 offen offset:1024 lds
v_mfma_f32_16x16x32_bf16 v[72:75],a[148:151],a[12:15],v[72:75]
ds_read_b128 a[156:159],v10 offset:7168
v_mfma_f32_16x16x32_bf16 v[72:75],a[144:147],a[8:11],v[72:75]
v_exp_f32 v84,v84
v_mfma_f32_16x16x32_bf16 v[72:75],a[140:143],a[4:7],v[72:75]
s_waitcnt lgkmcnt(3)
v_cvt_pk_bf16_f32 v50,v84,v85
v_mfma_f32_16x16x32_bf16 v[72:75],a[136:139],a[0:3],v[72:75]
v_exp_f32 v93,v93
v_smfmac_f32_16x16x64_bf16 v[60:63],a[152:155],v[44:51],v18
v_mfma_f32_16x16x32_bf16 v[80:83],a[136:139],a[24:27],0
v_exp_f32 v94,v94
v_mfma_f32_16x16x32_bf16 v[80:83],a[140:143],a[28:31],v[80:83]
v_exp_f32 v92,v92
v_mfma_f32_16x16x32_bf16 v[80:83],a[144:147],a[32:35],v[80:83]
buffer_load_dwordx4 v8,s[8:11],s21 offen offset:2048 lds
v_mfma_f32_16x16x32_bf16 v[80:83],a[148:151],a[36:39],v[80:83]
s_add_u32 s21,s21,12288
v_cvt_pk_bf16_f32 v54,v92,v93
v_fma_f32 v74,v74,s36,v13
v_mfma_f32_16x16x32_bf16 v[80:83],a[120:123],a[40:43],v[80:83]
s_cmp_eq_u32 s38,1
v_exp_f32 v95,v95
v_mfma_f32_16x16x32_bf16 v[80:83],a[124:127],a[44:47],v[80:83]
s_cselect_b32 s20,s26,s20
v_cvt_pk_bf16_f32 v55,v94,v95
v_fma_f32 v75,v75,s36,v13
v_mfma_f32_16x16x32_bf16 v[88:91],a[124:127],a[68:71],0
s_add_u32 m0,s22,12288
v_exp_f32 v103,v103
v_mfma_f32_16x16x32_bf16 v[88:91],a[120:123],a[64:67],v[88:91]
v_exp_f32 v100,v100
v_mfma_f32_16x16x32_bf16 v[88:91],a[148:151],a[60:63],v[88:91]
v_exp_f32 v102,v102
v_mfma_f32_16x16x32_bf16 v[88:91],a[144:147],a[56:59],v[88:91]
v_cvt_pk_bf16_f32 v59,v102,v103
v_fma_f32 v73,v73,s36,v13
v_mfma_f32_16x16x32_bf16 v[88:91],a[140:143],a[52:55],v[88:91]
v_exp_f32 v101,v101
v_mfma_f32_16x16x32_bf16 v[88:91],a[136:139],a[48:51],v[88:91]
s_waitcnt lgkmcnt(0)
buffer_store_dwordx4 a[156:159],v9,s[16:19],s27 offen offset:128 nt
buffer_load_dwordx4 v6,s[4:7],s20 offen offset:0 lds
v_mfma_f32_16x16x32_bf16 v[96:99],a[136:139],a[72:75],0
ds_read_b128 a[156:159],v10 offset:8192
v_cvt_pk_bf16_f32 v58,v100,v101
v_mfma_f32_16x16x32_bf16 v[96:99],a[140:143],a[76:79],v[96:99]
ds_read_b128 a[136:139],v0 offset:30848
v_fma_f32 v80,v80,s36,v14
v_smfmac_f32_16x16x64_bf16 v[64:67],a[152:155],v[52:59],v18
ds_read_b128 a[140:143],v1 offset:30848
v_mfma_f32_16x16x32_bf16 v[96:99],a[144:147],a[80:83],v[96:99]
ds_read_b128 a[144:147],v0 offset:30976
v_mfma_f32_16x16x32_bf16 v[96:99],a[148:151],a[84:87],v[96:99]
ds_read_b128 a[148:151],v1 offset:30976
v_mfma_f32_16x16x32_bf16 v[96:99],a[120:123],a[88:91],v[96:99]
v_fma_f32 v81,v81,s36,v14
v_fma_f32 v72,v72,s36,v13
v_mfma_f32_16x16x32_bf16 v[96:99],a[124:127],a[92:95],v[96:99]
v_exp_f32 v80,v80
v_mfma_f32_16x16x32_bf16 v[76:79],a[128:131],a[0:3],0
buffer_load_dwordx4 v7,s[4:7],s20 offen offset:1024 lds
v_mfma_f32_16x16x32_bf16 v[76:79],a[132:135],a[4:7],v[76:79]
s_waitcnt lgkmcnt(3)
v_exp_f32 v74,v74
v_mfma_f32_16x16x32_bf16 v[76:79],a[136:139],a[8:11],v[76:79]
s_waitcnt lgkmcnt(2)
v_exp_f32 v75,v75
v_mfma_f32_16x16x32_bf16 v[76:79],a[140:143],a[12:15],v[76:79]
s_waitcnt lgkmcnt(1)
v_cvt_pk_bf16_f32 v21,v74,v75
v_mfma_f32_16x16x32_bf16 v[76:79],a[144:147],a[16:19],v[76:79]
s_waitcnt lgkmcnt(0)
v_exp_f32 v72,v72
v_mfma_f32_16x16x32_bf16 v[76:79],a[148:151],a[20:23],v[76:79]
v_exp_f32 v81,v81
v_mfma_f32_16x16x32_bf16 v[84:87],a[148:151],a[44:47],0
v_cvt_pk_bf16_f32 v24,v80,v81
v_mfma_f32_16x16x32_bf16 v[84:87],a[144:147],a[40:43],v[84:87]
v_exp_f32 v73,v73
v_mfma_f32_16x16x32_bf16 v[84:87],a[140:143],a[36:39],v[84:87]
v_cvt_pk_bf16_f32 v20,v72,v73
v_mfma_f32_16x16x32_bf16 v[84:87],a[136:139],a[32:35],v[84:87]
buffer_store_dwordx4 a[156:159],v9,s[16:19],s27 offen offset:256 nt
buffer_load_dwordx4 v8,s[4:7],s20 offen offset:2048 lds
v_mfma_f32_16x16x32_bf16 v[84:87],a[132:135],a[28:31],v[84:87]
s_add_u32 s20,s20,12288
ds_read_b64_tr_b16 a[120:121],v2 offset:12288
v_mfma_f32_16x16x32_bf16 v[84:87],a[128:131],a[24:27],v[84:87]
s_add_u32 s27,s27,3072
ds_read_b64_tr_b16 a[122:123],v2 offset:18432
v_mfma_f32_16x16x32_bf16 v[92:95],a[128:131],a[48:51],0
ds_read_b64_tr_b16 a[124:125],v3 offset:12288
v_mfma_f32_16x16x32_bf16 v[92:95],a[132:135],a[52:55],v[92:95]
ds_read_b64_tr_b16 a[126:127],v3 offset:18432
v_mfma_f32_16x16x32_bf16 v[92:95],a[136:139],a[56:59],v[92:95]
v_mfma_f32_16x16x32_bf16 v[92:95],a[140:143],a[60:63],v[92:95]
v_mfma_f32_16x16x32_bf16 v[92:95],a[144:147],a[64:67],v[92:95]
v_mfma_f32_16x16x32_bf16 v[92:95],a[148:151],a[68:71],v[92:95]
v_mfma_f32_16x16x32_bf16 v[100:103],a[148:151],a[92:95],0
v_mfma_f32_16x16x32_bf16 v[100:103],a[144:147],a[88:91],v[100:103]
v_mfma_f32_16x16x32_bf16 v[100:103],a[140:143],a[84:87],v[100:103]
v_mfma_f32_16x16x32_bf16 v[100:103],a[136:139],a[80:83],v[100:103]
v_mfma_f32_16x16x32_bf16 v[100:103],a[132:135],a[76:79],v[100:103]
ds_read_b64_tr_b16 a[134:135],v5 offset:18432
v_mfma_f32_16x16x32_bf16 v[100:103],a[128:131],a[72:75],v[100:103]
s_waitcnt lgkmcnt(1)
ds_read_b64_tr_b16 a[130:131],v4 offset:18432
ds_read_b64_tr_b16 a[128:129],v4 offset:12288
ds_read_b64_tr_b16 a[132:133],v5 offset:12288
v_mfma_f32_16x16x32_bf16 v[160:163],a[120:123],v[44:47],v[160:163]
s_add_u32 m0,s29,0
ds_read_b64_tr_b16 a[136:137],v2 offset:12416
v_fma_f32 v82,v82,s36,v14
v_mfma_f32_16x16x32_bf16 v[164:167],a[124:127],v[44:47],v[164:167]
ds_read_b64_tr_b16 a[138:139],v2 offset:18560
v_fma_f32 v83,v83,s36,v14
v_mfma_f32_16x16x32_bf16 v[212:215],a[124:127],v[48:51],v[212:215]
ds_read_b64_tr_b16 a[140:141],v3 offset:12416
v_fma_f32 v88,v88,s36,v15
v_mfma_f32_16x16x32_bf16 v[208:211],a[120:123],v[48:51],v[208:211]
ds_read_b64_tr_b16 a[142:143],v3 offset:18560
v_fma_f32 v89,v89,s36,v15
v_mfma_f32_16x16x32_bf16 v[112:115],a[120:123],v[52:55],v[112:115]
ds_read_b64_tr_b16 a[144:145],v4 offset:12416
v_fma_f32 v90,v90,s36,v15
v_mfma_f32_16x16x32_bf16 v[116:119],a[124:127],v[52:55],v[116:119]
ds_read_b64_tr_b16 a[146:147],v4 offset:18560
v_fma_f32 v91,v91,s36,v15
v_mfma_f32_16x16x32_bf16 a[164:167],a[124:127],v[56:59],a[164:167]
buffer_load_dwordx4 v6,s[12:15],s28 offen offset:0 nt lds
v_mfma_f32_16x16x32_bf16 a[160:163],a[120:123],v[56:59],a[160:163]
s_waitcnt lgkmcnt(5)
ds_read_b64_tr_b16 a[148:149],v5 offset:12416
v_fma_f32 v96,v96,s36,v16
v_mfma_f32_16x16x32_bf16 a[168:171],a[128:131],v[56:59],a[168:171]
ds_read_b64_tr_b16 a[150:151],v5 offset:18560
v_fma_f32 v97,v97,s36,v16
v_mfma_f32_16x16x32_bf16 a[172:175],a[132:135],v[56:59],a[172:175]
ds_read_b64_tr_b16 a[120:121],v2 offset:12544
v_fma_f32 v98,v98,s36,v16
v_mfma_f32_16x16x32_bf16 v[124:127],a[132:135],v[52:55],v[124:127]
ds_read_b64_tr_b16 a[122:123],v2 offset:18688
v_fma_f32 v99,v99,s36,v16
v_mfma_f32_16x16x32_bf16 v[120:123],a[128:131],v[52:55],v[120:123]
ds_read_b64_tr_b16 a[124:125],v3 offset:12544
v_fma_f32 v76,v76,s36,v13
v_mfma_f32_16x16x32_bf16 v[216:219],a[128:131],v[48:51],v[216:219]
ds_read_b64_tr_b16 a[126:127],v3 offset:18688
v_fma_f32 v77,v77,s36,v13
v_mfma_f32_16x16x32_bf16 v[220:223],a[132:135],v[48:51],v[220:223]
buffer_load_dwordx4 v7,s[12:15],s28 offen offset:1024 nt lds
v_mfma_f32_16x16x32_bf16 v[172:175],a[132:135],v[44:47],v[172:175]
ds_read_b64_tr_b16 a[132:133],v5 offset:12544
v_fma_f32 v78,v78,s36,v13
v_mfma_f32_16x16x32_bf16 v[168:171],a[128:131],v[44:47],v[168:171]
s_waitcnt lgkmcnt(5)
ds_read_b64_tr_b16 a[128:129],v4 offset:12544
v_fma_f32 v79,v79,s36,v13
v_mfma_f32_16x16x32_bf16 v[176:179],a[136:139],v[44:47],v[176:179]
ds_read_b64_tr_b16 a[130:131],v4 offset:18688
v_fma_f32 v84,v84,s36,v14
v_mfma_f32_16x16x32_bf16 v[180:183],a[140:143],v[44:47],v[180:183]
ds_read_b64_tr_b16 a[134:135],v5 offset:18688
v_fma_f32 v85,v85,s36,v14
v_mfma_f32_16x16x32_bf16 v[228:231],a[140:143],v[48:51],v[228:231]
v_exp_f32 v82,v82
v_mfma_f32_16x16x32_bf16 v[224:227],a[136:139],v[48:51],v[224:227]
v_exp_f32 v83,v83
v_mfma_f32_16x16x32_bf16 v[128:131],a[136:139],v[52:55],v[128:131]
v_cvt_pk_bf16_f32 v25,v82,v83
v_fma_f32 v86,v86,s36,v14
v_mfma_f32_16x16x32_bf16 v[132:135],a[140:143],v[52:55],v[132:135]
buffer_load_dwordx4 v8,s[12:15],s28 offen offset:2048 nt lds
v_mfma_f32_16x16x32_bf16 a[180:183],a[140:143],v[56:59],a[180:183]
s_add_u32 s28,s28,3072
v_exp_f32 v88,v88
v_mfma_f32_16x16x32_bf16 a[176:179],a[136:139],v[56:59],a[176:179]
s_add_u32 s29,s29,3072
v_exp_f32 v89,v89
v_mfma_f32_16x16x32_bf16 a[184:187],a[144:147],v[56:59],a[184:187]
s_cmp_eq_u32 s38,1
v_exp_f32 v90,v90
v_mfma_f32_16x16x32_bf16 a[188:191],a[148:151],v[56:59],a[188:191]
s_cselect_b32 s21,s26,s21
v_exp_f32 v91,v91
v_mfma_f32_16x16x32_bf16 v[140:143],a[148:151],v[52:55],v[140:143]
s_add_u32 m0,s23,12288
v_cvt_pk_bf16_f32 v28,v88,v89
v_cvt_pk_bf16_f32 v29,v90,v91
v_mfma_f32_16x16x32_bf16 v[136:139],a[144:147],v[52:55],v[136:139]
v_exp_f32 v96,v96
v_mfma_f32_16x16x32_bf16 v[232:235],a[144:147],v[48:51],v[232:235]
v_exp_f32 v97,v97
v_mfma_f32_16x16x32_bf16 v[236:239],a[148:151],v[48:51],v[236:239]
v_exp_f32 v98,v98
v_mfma_f32_16x16x32_bf16 v[188:191],a[148:151],v[44:47],v[188:191]
v_exp_f32 v99,v99
v_mfma_f32_16x16x32_bf16 v[184:187],a[144:147],v[44:47],v[184:187]
s_waitcnt lgkmcnt(0)
v_cvt_pk_bf16_f32 v32,v96,v97
v_cvt_pk_bf16_f32 v33,v98,v99
v_mfma_f32_16x16x32_bf16 v[192:195],a[120:123],v[44:47],v[192:195]
s_waitcnt vmcnt(12)
v_exp_f32 v76,v76
v_mfma_f32_16x16x32_bf16 v[196:199],a[124:127],v[44:47],v[196:199]
s_barrier
v_mfma_f32_16x16x32_bf16 v[244:247],a[124:127],v[48:51],v[244:247]
ds_read_b128 a[148:151],v1 offset:128
v_fma_f32 v87,v87,s36,v14
v_mfma_f32_16x16x32_bf16 v[240:243],a[120:123],v[48:51],v[240:243]
ds_read_b128 a[144:147],v0 offset:128
v_fma_f32 v92,v92,s36,v15
v_mfma_f32_16x16x32_bf16 v[144:147],a[120:123],v[52:55],v[144:147]
ds_read_b128 a[140:143],v1 offset:0
v_fma_f32 v93,v93,s36,v15
v_mfma_f32_16x16x32_bf16 v[148:151],a[124:127],v[52:55],v[148:151]
ds_read_b128 a[136:139],v0 offset:0
v_fma_f32 v94,v94,s36,v15
v_mfma_f32_16x16x32_bf16 a[196:199],a[124:127],v[56:59],a[196:199]
ds_read_b128 a[124:127],v1 offset:256
v_fma_f32 v95,v95,s36,v15
v_mfma_f32_16x16x32_bf16 a[192:195],a[120:123],v[56:59],a[192:195]
buffer_load_dwordx4 v6,s[8:11],s21 offen offset:0 lds
v_mfma_f32_16x16x32_bf16 a[200:203],a[128:131],v[56:59],a[200:203]
ds_read_b128 a[120:123],v0 offset:256
v_fma_f32 v100,v100,s36,v16
v_mfma_f32_16x16x32_bf16 a[204:207],a[132:135],v[56:59],a[204:207]
v_exp_f32 v77,v77
v_mfma_f32_16x16x32_bf16 v[156:159],a[132:135],v[52:55],v[156:159]
v_exp_f32 v78,v78
v_mfma_f32_16x16x32_bf16 v[152:155],a[128:131],v[52:55],v[152:155]
v_exp_f32 v79,v79
v_mfma_f32_16x16x32_bf16 v[248:251],a[128:131],v[48:51],v[248:251]
v_cvt_pk_bf16_f32 v22,v76,v77
v_cvt_pk_bf16_f32 v23,v78,v79
v_mfma_f32_16x16x32_bf16 v[252:255],a[132:135],v[48:51],v[252:255]
v_exp_f32 v84,v84
v_mfma_f32_16x16x32_bf16 v[204:207],a[132:135],v[44:47],v[204:207]
ds_read_b128 a[132:135],v1 offset:6144
v_fma_f32 v101,v101,s36,v16
v_mfma_f32_16x16x32_bf16 v[200:203],a[128:131],v[44:47],v[200:203]
s_waitcnt lgkmcnt(1)
ds_read_b128 a[128:131],v0 offset:6144
v_fma_f32 v102,v102,s36,v16
v_mfma_f32_16x16x32_bf16 v[72:75],a[124:127],a[20:23],0
buffer_load_dwordx4 v7,s[8:11],s21 offen offset:1024 lds
v_mfma_f32_16x16x32_bf16 v[72:75],a[120:123],a[16:19],v[72:75]
v_exp_f32 v85,v85
v_mfma_f32_16x16x32_bf16 v[72:75],a[148:151],a[12:15],v[72:75]
v_exp_f32 v86,v86
v_mfma_f32_16x16x32_bf16 v[72:75],a[144:147],a[8:11],v[72:75]
v_exp_f32 v87,v87
v_mfma_f32_16x16x32_bf16 v[72:75],a[140:143],a[4:7],v[72:75]
v_cvt_pk_bf16_f32 v26,v84,v85
v_cvt_pk_bf16_f32 v27,v86,v87
v_mfma_f32_16x16x32_bf16 v[72:75],a[136:139],a[0:3],v[72:75]
v_exp_f32 v92,v92
v_smfmac_f32_16x16x64_bf16 v[60:63],a[152:155],v[20:27],v18
v_fma_f32 v103,v103,s36,v16
v_mfma_f32_16x16x32_bf16 v[80:83],a[136:139],a[24:27],0
v_exp_f32 v93,v93
v_mfma_f32_16x16x32_bf16 v[80:83],a[140:143],a[28:31],v[80:83]
buffer_load_dwordx4 v8,s[8:11],s21 offen offset:2048 lds
v_mfma_f32_16x16x32_bf16 v[80:83],a[144:147],a[32:35],v[80:83]
s_add_u32 s21,s21,12288
v_exp_f32 v94,v94
v_mfma_f32_16x16x32_bf16 v[80:83],a[148:151],a[36:39],v[80:83]
s_add_u32 m0,s22,24576
v_exp_f32 v95,v95
v_mfma_f32_16x16x32_bf16 v[80:83],a[120:123],a[40:43],v[80:83]
v_cvt_pk_bf16_f32 v30,v92,v93
v_cvt_pk_bf16_f32 v31,v94,v95
v_mfma_f32_16x16x32_bf16 v[80:83],a[124:127],a[44:47],v[80:83]
v_exp_f32 v100,v100
v_mfma_f32_16x16x32_bf16 v[88:91],a[124:127],a[68:71],0
v_exp_f32 v101,v101
v_mfma_f32_16x16x32_bf16 v[88:91],a[120:123],a[64:67],v[88:91]
v_exp_f32 v102,v102
v_mfma_f32_16x16x32_bf16 v[88:91],a[148:151],a[60:63],v[88:91]
v_exp_f32 v103,v103
v_mfma_f32_16x16x32_bf16 v[88:91],a[144:147],a[56:59],v[88:91]
v_cvt_pk_bf16_f32 v34,v100,v101
v_cvt_pk_bf16_f32 v35,v102,v103
v_mfma_f32_16x16x32_bf16 v[88:91],a[140:143],a[52:55],v[88:91]
buffer_load_dwordx4 v6,s[4:7],s20 offen offset:0 lds
v_smfmac_f32_16x16x64_bf16 v[64:67],a[152:155],v[28:35],v18
v_fma_f32 v72,v72,s36,v13
v_mfma_f32_16x16x32_bf16 v[88:91],a[136:139],a[48:51],v[88:91]
v_fma_f32 v73,v73,s36,v13
v_fma_f32 v74,v74,s36,v13
v_mfma_f32_16x16x32_bf16 v[96:99],a[136:139],a[72:75],0
ds_read_b128 a[136:139],v0 offset:6272
v_fma_f32 v75,v75,s36,v13
v_mfma_f32_16x16x32_bf16 v[96:99],a[140:143],a[76:79],v[96:99]
ds_read_b128 a[140:143],v1 offset:6272
v_fma_f32 v80,v80,s36,v14
v_mfma_f32_16x16x32_bf16 v[96:99],a[144:147],a[80:83],v[96:99]
ds_read_b128 a[144:147],v0 offset:6400
v_fma_f32 v81,v81,s36,v14
v_mfma_f32_16x16x32_bf16 v[96:99],a[148:151],a[84:87],v[96:99]
ds_read_b128 a[148:151],v1 offset:6400
v_add_u32 v10,9216,v10
v_mfma_f32_16x16x32_bf16 v[96:99],a[120:123],a[88:91],v[96:99]
v_exp_f32 v72,v72
v_mfma_f32_16x16x32_bf16 v[96:99],a[124:127],a[92:95],v[96:99]
s_waitcnt lgkmcnt(4)
v_exp_f32 v73,v73
v_mfma_f32_16x16x32_bf16 v[76:79],a[128:131],a[0:3],0
buffer_load_dwordx4 v7,s[4:7],s20 offen offset:1024 lds
v_mfma_f32_16x16x32_bf16 v[76:79],a[132:135],a[4:7],v[76:79]
s_waitcnt lgkmcnt(3)
v_exp_f32 v74,v74
v_mfma_f32_16x16x32_bf16 v[76:79],a[136:139],a[8:11],v[76:79]
s_waitcnt lgkmcnt(2)
v_exp_f32 v75,v75
v_mfma_f32_16x16x32_bf16 v[76:79],a[140:143],a[12:15],v[76:79]
s_waitcnt lgkmcnt(0)
v_exp_f32 v80,v80
v_mfma_f32_16x16x32_bf16 v[76:79],a[144:147],a[16:19],v[76:79]
v_exp_f32 v81,v81
v_mfma_f32_16x16x32_bf16 v[76:79],a[148:151],a[20:23],v[76:79]
v_cvt_pk_bf16_f32 v44,v72,v73
v_cvt_pk_bf16_f32 v45,v74,v75
v_mfma_f32_16x16x32_bf16 v[84:87],a[148:151],a[44:47],0
v_cvt_pk_bf16_f32 v48,v80,v81
v_mfma_f32_16x16x32_bf16 v[84:87],a[144:147],a[40:43],v[84:87]
v_mfma_f32_16x16x32_bf16 v[84:87],a[140:143],a[36:39],v[84:87]
v_mfma_f32_16x16x32_bf16 v[84:87],a[136:139],a[32:35],v[84:87]
buffer_load_dwordx4 v8,s[4:7],s20 offen offset:2048 lds
v_mfma_f32_16x16x32_bf16 v[84:87],a[132:135],a[28:31],v[84:87]
s_add_u32 s20,s20,12288
s_add_u32 s38,s38,1
s_cmp_lt_u32 s38,2
v_mfma_f32_16x16x32_bf16 v[84:87],a[128:131],a[24:27],v[84:87]
ds_read_b64_tr_b16 a[120:121],v2 offset:24576
v_mfma_f32_16x16x32_bf16 v[92:95],a[128:131],a[48:51],0
ds_read_b64_tr_b16 a[122:123],v2 offset:30720
v_mfma_f32_16x16x32_bf16 v[92:95],a[132:135],a[52:55],v[92:95]
ds_read_b64_tr_b16 a[124:125],v3 offset:24576
v_mfma_f32_16x16x32_bf16 v[92:95],a[136:139],a[56:59],v[92:95]
ds_read_b64_tr_b16 a[126:127],v3 offset:30720
v_mfma_f32_16x16x32_bf16 v[92:95],a[140:143],a[60:63],v[92:95]
v_mfma_f32_16x16x32_bf16 v[92:95],a[144:147],a[64:67],v[92:95]
v_mfma_f32_16x16x32_bf16 v[92:95],a[148:151],a[68:71],v[92:95]
v_mfma_f32_16x16x32_bf16 v[100:103],a[148:151],a[92:95],0
v_mfma_f32_16x16x32_bf16 v[100:103],a[144:147],a[88:91],v[100:103]
v_mfma_f32_16x16x32_bf16 v[100:103],a[140:143],a[84:87],v[100:103]
v_mfma_f32_16x16x32_bf16 v[100:103],a[136:139],a[80:83],v[100:103]
v_mfma_f32_16x16x32_bf16 v[100:103],a[132:135],a[76:79],v[100:103]
ds_read_b64_tr_b16 a[132:133],v5 offset:24576
v_mfma_f32_16x16x32_bf16 v[100:103],a[128:131],a[72:75],v[100:103]
ds_read_b64_tr_b16 a[128:129],v4 offset:24576
ds_read_b64_tr_b16 a[130:131],v4 offset:30720
ds_read_b64_tr_b16 a[134:135],v5 offset:30720
s_cbranch_scc1 L_loop4w0
s_cmp_ge_u32 s69,6
s_cbranch_scc1 L_end4
s_cmp_eq_u32 s40,0
s_cbranch_scc1 L_tr44
s_branch L_tr45
L_tr45:
s_waitcnt vmcnt(42)
s_waitcnt lgkmcnt(3)
v_mfma_f32_16x16x32_bf16 v[160:163],a[120:123],v[20:23],v[160:163]
s_add_u32 m0,s24,0
ds_read_b128 a[4:7],v12 offset:0
v_fma_f32 v79,v79,s36,v13
v_mfma_f32_16x16x32_bf16 v[164:167],a[124:127],v[20:23],v[164:167]
ds_read_b128 a[12:15],v12 offset:128
v_fma_f32 v100,v100,s36,v16
v_mfma_f32_16x16x32_bf16 v[212:215],a[124:127],v[24:27],v[212:215]
ds_read_b128 a[20:23],v12 offset:256
v_fma_f32 v101,v101,s36,v16
v_mfma_f32_16x16x32_bf16 v[208:211],a[120:123],v[24:27],v[208:211]
ds_read_b128 a[8:11],v11 offset:128
v_fma_f32 v89,v89,s36,v15
v_mfma_f32_16x16x32_bf16 v[112:115],a[120:123],v[28:31],v[112:115]
ds_read_b128 a[0:3],v11 offset:0
v_fma_f32 v76,v76,s36,v13
v_mfma_f32_16x16x32_bf16 v[116:119],a[124:127],v[28:31],v[116:119]
ds_read_b128 a[16:19],v11 offset:256
v_fma_f32 v83,v83,s36,v14
v_mfma_f32_16x16x32_bf16 a[164:167],a[124:127],v[32:35],a[164:167]
ds_read_b64_tr_b16 a[138:139],v2 offset:30848
v_fma_f32 v90,v90,s36,v15
v_mfma_f32_16x16x32_bf16 a[160:163],a[120:123],v[32:35],a[160:163]
s_waitcnt lgkmcnt(6)
ds_read_b64_tr_b16 a[136:137],v2 offset:24704
v_fma_f32 v88,v88,s36,v15
v_mfma_f32_16x16x32_bf16 a[168:171],a[128:131],v[32:35],a[168:171]
ds_read_b64_tr_b16 a[142:143],v3 offset:30848
ds_read_b64_tr_b16 a[140:141],v3 offset:24704
ds_read_b64_tr_b16 a[146:147],v4 offset:30848
ds_read_b64_tr_b16 a[144:145],v4 offset:24704
ds_read_b64_tr_b16 a[150:151],v5 offset:30848
ds_read_b64_tr_b16 a[148:149],v5 offset:24704
ds_read_b128 a[32:35],v11 offset:6272
v_mfma_f32_16x16x32_bf16 a[172:175],a[132:135],v[32:35],a[172:175]
v_fma_f32 v91,v91,s36,v15
ds_read_b128 a[40:43],v11 offset:6400
v_mfma_f32_16x16x32_bf16 v[124:127],a[132:135],v[28:31],v[124:127]
s_waitcnt lgkmcnt(10)
buffer_load_dwordx4 v6,s[12:15],s28 offen offset:0 nt lds
v_mfma_f32_16x16x32_bf16 v[120:123],a[128:131],v[28:31],v[120:123]
ds_read_b64_tr_b16 a[122:123],v2 offset:30976
ds_read_b64_tr_b16 a[120:121],v2 offset:24832
ds_read_b64_tr_b16 a[124:125],v3 offset:24832
ds_read_b64_tr_b16 a[126:127],v3 offset:30976
ds_read_b128 a[44:47],v12 offset:6400
v_mfma_f32_16x16x32_bf16 v[216:219],a[128:131],v[24:27],v[216:219]
v_fma_f32 v93,v93,s36,v15
ds_read_b128 a[28:31],v12 offset:6144
v_mfma_f32_16x16x32_bf16 v[220:223],a[132:135],v[24:27],v[220:223]
v_fma_f32 v98,v98,s36,v16
ds_read_b128 a[36:39],v12 offset:6272
v_mfma_f32_16x16x32_bf16 v[172:175],a[132:135],v[20:23],v[172:175]
buffer_load_dwordx4 v7,s[12:15],s28 offen offset:1024 nt lds
v_mfma_f32_16x16x32_bf16 v[168:171],a[128:131],v[20:23],v[168:171]
s_waitcnt lgkmcnt(7)
ds_read_b64_tr_b16 a[130:131],v4 offset:30976
ds_read_b128 a[24:27],v11 offset:6144
v_mfma_f32_16x16x32_bf16 v[176:179],a[136:139],v[20:23],v[176:179]
v_fma_f32 v82,v82,s36,v14
v_exp_f32 v93,v93
v_mfma_f32_16x16x32_bf16 v[180:183],a[140:143],v[20:23],v[180:183]
ds_read_b64_tr_b16 a[128:129],v4 offset:24832
v_fma_f32 v85,v85,s36,v14
v_mfma_f32_16x16x32_bf16 v[228:231],a[140:143],v[24:27],v[228:231]
ds_read_b64_tr_b16 a[134:135],v5 offset:30976
v_exp_f32 v82,v82
v_mfma_f32_16x16x32_bf16 v[224:227],a[136:139],v[24:27],v[224:227]
ds_read_b64_tr_b16 a[132:133],v5 offset:24832
v_fma_f32 v84,v84,s36,v14
v_mfma_f32_16x16x32_bf16 v[128:131],a[136:139],v[28:31],v[128:131]
v_exp_f32 v84,v84
v_mfma_f32_16x16x32_bf16 v[132:135],a[140:143],v[28:31],v[132:135]
buffer_load_dwordx4 v8,s[12:15],s28 offen offset:2048 nt lds
v_mfma_f32_16x16x32_bf16 a[180:183],a[140:143],v[32:35],a[180:183]
s_add_u32 s28,s28,3072
v_fma_f32 v103,v103,s36,v16
v_exp_f32 v103,v103
v_mfma_f32_16x16x32_bf16 a[176:179],a[136:139],v[32:35],a[176:179]
s_add_u32 m0,s24,3072
v_fma_f32 v87,v87,s36,v14
v_exp_f32 v87,v87
v_mfma_f32_16x16x32_bf16 a[184:187],a[144:147],v[32:35],a[184:187]
v_fma_f32 v77,v77,s36,v13
v_exp_f32 v77,v77
v_mfma_f32_16x16x32_bf16 a[188:191],a[148:151],v[32:35],a[188:191]
v_fma_f32 v97,v97,s36,v16
v_exp_f32 v91,v91
v_mfma_f32_16x16x32_bf16 v[140:143],a[148:151],v[28:31],v[140:143]
v_fma_f32 v102,v102,s36,v16
v_exp_f32 v85,v85
v_mfma_f32_16x16x32_bf16 v[136:139],a[144:147],v[28:31],v[136:139]
v_exp_f32 v89,v89
v_mfma_f32_16x16x32_bf16 v[232:235],a[144:147],v[24:27],v[232:235]
buffer_load_dwordx4 v6,s[12:15],s28 offen offset:0 nt lds
v_mfma_f32_16x16x32_bf16 v[236:239],a[148:151],v[24:27],v[236:239]
v_fma_f32 v92,v92,s36,v15
v_exp_f32 v101,v101
v_mfma_f32_16x16x32_bf16 v[188:191],a[148:151],v[20:23],v[188:191]
v_fma_f32 v94,v94,s36,v15
v_fma_f32 v95,v95,s36,v15
v_mfma_f32_16x16x32_bf16 v[184:187],a[144:147],v[20:23],v[184:187]
s_waitcnt lgkmcnt(0)
v_exp_f32 v95,v95
v_mfma_f32_16x16x32_bf16 v[192:195],a[120:123],v[20:23],v[192:195]
v_fma_f32 v86,v86,s36,v14
v_fma_f32 v78,v78,s36,v13
v_mfma_f32_16x16x32_bf16 v[196:199],a[124:127],v[20:23],v[196:199]
v_exp_f32 v92,v92
v_mfma_f32_16x16x32_bf16 v[244:247],a[124:127],v[24:27],v[244:247]
v_exp_f32 v78,v78
v_mfma_f32_16x16x32_bf16 v[240:243],a[120:123],v[24:27],v[240:243]
buffer_load_dwordx4 v7,s[12:15],s28 offen offset:1024 nt lds
v_mfma_f32_16x16x32_bf16 v[144:147],a[120:123],v[28:31],v[144:147]
v_exp_f32 v94,v94
v_mfma_f32_16x16x32_bf16 v[148:151],a[124:127],v[28:31],v[148:151]
v_exp_f32 v90,v90
v_mfma_f32_16x16x32_bf16 a[196:199],a[124:127],v[32:35],a[196:199]
v_fma_f32 v96,v96,s36,v16
v_exp_f32 v96,v96
v_mfma_f32_16x16x32_bf16 a[192:195],a[120:123],v[32:35],a[192:195]
v_fma_f32 v99,v99,s36,v16
v_exp_f32 v83,v83
v_mfma_f32_16x16x32_bf16 a[200:203],a[128:131],v[32:35],a[200:203]
v_exp_f32 v97,v97
v_mfma_f32_16x16x32_bf16 a[204:207],a[132:135],v[32:35],a[204:207]
v_exp_f32 v88,v88
v_mfma_f32_16x16x32_bf16 v[156:159],a[132:135],v[28:31],v[156:159]
v_exp_f32 v98,v98
v_mfma_f32_16x16x32_bf16 v[152:155],a[128:131],v[28:31],v[152:155]
buffer_load_dwordx4 v8,s[12:15],s28 offen offset:2048 nt lds
s_waitcnt vmcnt(20)
s_barrier
v_mfma_f32_16x16x32_bf16 v[248:251],a[128:131],v[24:27],v[248:251]
s_add_u32 s28,s28,3072
ds_read_b64_tr_b16 a[138:139],v2 offset:6144
v_exp_f32 v79,v79
v_mfma_f32_16x16x32_bf16 v[252:255],a[132:135],v[24:27],v[252:255]
s_add_u32 m0,s22,0
ds_read_b64_tr_b16 a[136:137],v2 offset:0
buffer_load_dwordx4 v6,s[4:7],s25 offen offset:0 lds
v_mfma_f32_16x16x32_bf16 v[204:207],a[132:135],v[20:23],v[204:207]
buffer_load_dwordx4 v7,s[4:7],s25 offen offset:1024 lds
v_mfma_f32_16x16x32_bf16 v[200:203],a[128:131],v[20:23],v[200:203]
buffer_load_dwordx4 v8,s[4:7],s25 offen offset:2048 lds
ds_read_b64_tr_b16 a[142:143],v3 offset:6144
ds_read_b64_tr_b16 a[140:141],v3 offset:0
ds_read_b64_tr_b16 a[144:145],v4 offset:0
ds_read_b64_tr_b16 a[146:147],v4 offset:6144
ds_read_b64_tr_b16 a[148:149],v5 offset:0
ds_read_b64_tr_b16 a[150:151],v5 offset:6144
v_exp_f32 v100,v100
v_cvt_pk_bf16_f32 v47,v78,v79
v_cvt_pk_bf16_f32 v49,v82,v83
v_exp_f32 v76,v76
v_exp_f32 v102,v102
v_exp_f32 v86,v86
v_cvt_pk_bf16_f32 v59,v102,v103
v_exp_f32 v99,v99
v_cvt_pk_bf16_f32 v50,v84,v85
v_cvt_pk_bf16_f32 v57,v98,v99
v_cvt_pk_bf16_f32 v55,v94,v95
v_cvt_pk_bf16_f32 v54,v92,v93
v_cvt_pk_bf16_f32 v58,v100,v101
v_cvt_pk_bf16_f32 v51,v86,v87
v_cvt_pk_bf16_f32 v53,v90,v91
v_cvt_pk_bf16_f32 v46,v76,v77
v_cvt_pk_bf16_f32 v52,v88,v89
v_cvt_pk_bf16_f32 v56,v96,v97
v_smfmac_f32_16x16x64_bf16 v[60:63],a[152:155],v[44:51],v18
v_subrev_u32 v10,18432,v10
v_smfmac_f32_16x16x64_bf16 v[64:67],a[152:155],v[52:59],v18
s_waitcnt lgkmcnt(0)
v_mfma_f32_16x16x32_bf16 v[160:163],a[136:139],v[44:47],v[160:163]
s_add_u32 s87,s42,18432
ds_read_b64_tr_b16 a[122:123],v2 offset:6272
v_mbcnt_lo_u32_b32 v39,-1,0
v_mfma_f32_16x16x32_bf16 v[164:167],a[140:143],v[44:47],v[164:167]
ds_read_b64_tr_b16 a[120:121],v2 offset:128
v_mbcnt_hi_u32_b32 v39,-1,v39
v_mfma_f32_16x16x32_bf16 v[212:215],a[140:143],v[48:51],v[212:215]
ds_read_b64_tr_b16 a[124:125],v3 offset:128
v_and_b32 v38,7,v39
v_mfma_f32_16x16x32_bf16 v[208:211],a[136:139],v[48:51],v[208:211]
ds_read_b64_tr_b16 a[126:127],v3 offset:6272
v_add_f32 v64,v64,v65
v_mfma_f32_16x16x32_bf16 v[112:115],a[136:139],v[52:55],v[112:115]
ds_read_b64_tr_b16 a[130:131],v4 offset:6272
v_add_f32 v60,v60,v61
v_mfma_f32_16x16x32_bf16 v[116:119],a[140:143],v[52:55],v[116:119]
ds_read_b64_tr_b16 a[128:129],v4 offset:128
v_add_f32 v62,v62,v63
v_mfma_f32_16x16x32_bf16 a[164:167],a[140:143],v[56:59],a[164:167]
ds_read_b64_tr_b16 a[134:135],v5 offset:6272
v_max3_f32 v19,v60,v62,v64
v_mfma_f32_16x16x32_bf16 a[160:163],a[136:139],v[56:59],a[160:163]
ds_read_b64_tr_b16 a[132:133],v5 offset:128
v_add_f32 v66,v66,v67
v_mfma_f32_16x16x32_bf16 a[168:171],a[144:147],v[56:59],a[168:171]
ds_read_b64_tr_b16 a[138:139],v2 offset:6400
v_max_f32 v19,v19,v66
v_mfma_f32_16x16x32_bf16 a[172:175],a[148:151],v[56:59],a[172:175]
ds_read_b64_tr_b16 a[136:137],v2 offset:256
v_accvgpr_read_b32 v80,a164
v_mfma_f32_16x16x32_bf16 v[124:127],a[148:151],v[52:55],v[124:127]
ds_read_b64_tr_b16 a[140:141],v3 offset:256
v_accvgpr_read_b32 v75,a163
v_mfma_f32_16x16x32_bf16 v[120:123],a[144:147],v[52:55],v[120:123]
ds_read_b64_tr_b16 a[142:143],v3 offset:6400
v_accvgpr_read_b32 v81,a165
v_mfma_f32_16x16x32_bf16 v[216:219],a[144:147],v[48:51],v[216:219]
v_accvgpr_read_b32 v72,a160
v_accvgpr_read_b32 v83,a167
v_mfma_f32_16x16x32_bf16 v[220:223],a[148:151],v[48:51],v[220:223]
v_rcp_f32 v66,v66
v_mfma_f32_16x16x32_bf16 v[172:175],a[148:151],v[44:47],v[172:175]
ds_read_b64_tr_b16 a[150:151],v5 offset:6400
v_accvgpr_read_b32 v74,a162
v_mfma_f32_16x16x32_bf16 v[168:171],a[144:147],v[44:47],v[168:171]
s_waitcnt lgkmcnt(4)
ds_read_b64_tr_b16 a[146:147],v4 offset:6400
v_accvgpr_read_b32 v73,a161
v_mfma_f32_16x16x32_bf16 v[176:179],a[120:123],v[44:47],v[176:179]
ds_read_b64_tr_b16 a[144:145],v4 offset:256
v_accvgpr_read_b32 v82,a166
v_mfma_f32_16x16x32_bf16 v[180:183],a[124:127],v[44:47],v[180:183]
ds_read_b64_tr_b16 a[148:149],v5 offset:256
v_accvgpr_read_b32 v89,a169
v_mfma_f32_16x16x32_bf16 v[228:231],a[124:127],v[48:51],v[228:231]
v_accvgpr_read_b32 v90,a170
v_accvgpr_read_b32 v88,a168
v_mfma_f32_16x16x32_bf16 v[224:227],a[120:123],v[48:51],v[224:227]
v_accvgpr_read_b32 v91,a171
v_accvgpr_read_b32 v98,a174
v_mfma_f32_16x16x32_bf16 v[128:131],a[120:123],v[52:55],v[128:131]
v_accvgpr_read_b32 v97,a173
v_accvgpr_read_b32 v96,a172
v_mfma_f32_16x16x32_bf16 v[132:135],a[124:127],v[52:55],v[132:135]
v_accvgpr_read_b32 v99,a175
v_cmp_ngt_f32 vcc,s37,v19
v_mfma_f32_16x16x32_bf16 a[180:183],a[124:127],v[56:59],a[180:183]
v_lshrrev_b32 v19,5,v39
v_xor_b32 v38,v38,v19
v_mfma_f32_16x16x32_bf16 a[176:179],a[120:123],v[56:59],a[176:179]
s_cmp_lg_u64 vcc,0
v_and_b32 v19,15,v39
v_lshl_add_u32 v19,v19,7,s24
v_mfma_f32_16x16x32_bf16 a[184:187],a[128:131],v[56:59],a[184:187]
s_cselect_b32 s62,s32,0
v_lshl_add_u32 v19,v38,4,v19
v_bfe_u32 v38,v39,4,1
v_mfma_f32_16x16x32_bf16 a[188:191],a[132:135],v[56:59],a[188:191]
s_or_b32 s31,s31,s62
v_lshl_add_u32 v36,v38,3,v19
v_xor_b32 v38,64,v36
v_mfma_f32_16x16x32_bf16 v[140:143],a[132:135],v[52:55],v[140:143]
s_lshl_b32 s32,s32,1
v_xor_b32 v37,32,v36
v_bfe_u32 v19,v39,3,1
v_xor_b32 v39,96,v36
v_lshlrev_b32 v19,11,v19
v_accvgpr_read_b32 v86,a182
v_pk_mul_f32 v[82:83],v[82:83],v[66:67] op_sel_hi:[1,0]
v_pk_mul_f32 v[80:81],v[80:81],v[66:67] op_sel_hi:[1,0]
v_pk_mul_f32 v[74:75],v[74:75],v[66:67] op_sel_hi:[1,0]
v_pk_mul_f32 v[72:73],v[72:73],v[66:67] op_sel_hi:[1,0]
v_accvgpr_read_b32 v79,a179
v_accvgpr_read_b32 v78,a178
v_pk_mul_f32 v[78:79],v[78:79],v[66:67] op_sel_hi:[1,0]
v_accvgpr_read_b32 v77,a177
v_accvgpr_read_b32 v84,a180
v_accvgpr_read_b32 v87,a183
v_pk_mul_f32 v[86:87],v[86:87],v[66:67] op_sel_hi:[1,0]
v_accvgpr_read_b32 v85,a181
v_pk_mul_f32 v[84:85],v[84:85],v[66:67] op_sel_hi:[1,0]
v_accvgpr_read_b32 v76,a176
v_pk_mul_f32 v[76:77],v[76:77],v[66:67] op_sel_hi:[1,0]
v_accvgpr_read_b32 v94,a186
v_accvgpr_read_b32 v95,a187
v_mfma_f32_16x16x32_bf16 v[136:139],a[128:131],v[52:55],v[136:139]
s_add_u32 m0,s24,6144
v_accvgpr_read_b32 v92,a184
v_accvgpr_read_b32 v93,a185
v_accvgpr_read_b32 v103,a191
v_accvgpr_read_b32 v102,a190
buffer_load_dwordx4 v6,s[12:15],s28 offen offset:0 nt lds
buffer_load_dwordx4 v7,s[12:15],s28 offen offset:1024 nt lds
buffer_load_dwordx4 v8,s[12:15],s28 offen offset:2048 nt lds
v_pk_mul_f32 v[92:93],v[92:93],v[66:67] op_sel_hi:[1,0]
v_pk_mul_f32 v[88:89],v[88:89],v[66:67] op_sel_hi:[1,0]
v_pk_mul_f32 v[94:95],v[94:95],v[66:67] op_sel_hi:[1,0]
v_pk_mul_f32 v[90:91],v[90:91],v[66:67] op_sel_hi:[1,0]
v_accvgpr_read_b32 v101,a189
v_accvgpr_read_b32 v100,a188
v_mfma_f32_16x16x32_bf16 v[232:235],a[128:131],v[48:51],v[232:235]
s_add_u32 s28,s28,3072
v_cvt_pk_bf16_f32 v84,v84,v85
v_cvt_pk_bf16_f32 v85,v86,v87
v_cvt_pk_bf16_f32 v76,v76,v77
v_cvt_pk_bf16_f32 v77,v78,v79
v_cvt_pk_bf16_f32 v80,v80,v81
v_pk_mul_f32 v[96:97],v[96:97],v[66:67] op_sel_hi:[1,0]
v_pk_mul_f32 v[98:99],v[98:99],v[66:67] op_sel_hi:[1,0]
v_pk_mul_f32 v[100:101],v[100:101],v[66:67] op_sel_hi:[1,0]
v_pk_mul_f32 v[102:103],v[102:103],v[66:67] op_sel_hi:[1,0]
v_cvt_pk_bf16_f32 v88,v88,v89
v_cvt_pk_bf16_f32 v72,v72,v73
v_mfma_f32_16x16x32_bf16 v[236:239],a[132:135],v[48:51],v[236:239]
s_add_u32 m0,s24,9216
v_cvt_pk_bf16_f32 v89,v90,v91
v_cvt_pk_bf16_f32 v73,v74,v75
v_mfma_f32_16x16x32_bf16 v[188:191],a[132:135],v[44:47],v[188:191]
buffer_load_dwordx4 v6,s[12:15],s28 offen offset:0 nt lds
v_mfma_f32_16x16x32_bf16 v[184:187],a[128:131],v[44:47],v[184:187]
buffer_load_dwordx4 v7,s[12:15],s28 offen offset:1024 nt lds
s_waitcnt lgkmcnt(0)
v_mfma_f32_16x16x32_bf16 v[192:195],a[136:139],v[44:47],v[192:195]
buffer_load_dwordx4 v8,s[12:15],s28 offen offset:2048 nt lds
v_mfma_f32_16x16x32_bf16 v[196:199],a[140:143],v[44:47],v[196:199]
s_add_u32 s28,s28,3072
ds_write2st64_b64 v36,v[72:73],v[76:77] offset0:36 offset1:40
v_mfma_f32_16x16x32_bf16 v[244:247],a[140:143],v[48:51],v[244:247]
s_add_u32 m0,s23,0
v_cvt_pk_bf16_f32 v100,v100,v101
v_cvt_pk_bf16_f32 v81,v82,v83
v_mfma_f32_16x16x32_bf16 v[240:243],a[136:139],v[48:51],v[240:243]
v_cvt_pk_bf16_f32 v92,v92,v93
v_cvt_pk_bf16_f32 v93,v94,v95
v_mfma_f32_16x16x32_bf16 v[144:147],a[136:139],v[52:55],v[144:147]
v_cvt_pk_bf16_f32 v96,v96,v97
v_cvt_pk_bf16_f32 v101,v102,v103
v_mfma_f32_16x16x32_bf16 v[148:151],a[140:143],v[52:55],v[148:151]
ds_write2st64_b64 v37,v[80:81],v[84:85] offset0:36 offset1:40
v_mfma_f32_16x16x32_bf16 a[196:199],a[140:143],v[56:59],a[196:199]
v_cvt_pk_bf16_f32 v97,v98,v99
v_rcp_f32 v64,v64
v_mfma_f32_16x16x32_bf16 a[192:195],a[136:139],v[56:59],a[192:195]
v_rcp_f32 v60,v60
v_mfma_f32_16x16x32_bf16 a[200:203],a[144:147],v[56:59],a[200:203]
v_rcp_f32 v62,v62
v_mfma_f32_16x16x32_bf16 a[204:207],a[148:151],v[56:59],a[204:207]
ds_write2st64_b64 v38,v[88:89],v[92:93] offset0:36 offset1:40
v_mfma_f32_16x16x32_bf16 v[156:159],a[148:151],v[52:55],v[156:159]
s_waitcnt vmcnt(21)
v_accvgpr_read_b32 v86,a198
v_accvgpr_read_b32 v83,a195
v_accvgpr_read_b32 v85,a197
v_accvgpr_read_b32 v87,a199
ds_read_b128 a[48:51],v11 offset:12288
v_pk_mul_f32 v[86:87],v[86:87],v[66:67] op_sel_hi:[1,0]
ds_read_b128 a[52:55],v12 offset:12288
v_accvgpr_read_b32 v81,a193
ds_read_b128 a[56:59],v11 offset:12416
v_accvgpr_read_b32 v82,a194
ds_read_b128 a[60:63],v12 offset:12416
v_pk_mul_f32 v[82:83],v[82:83],v[66:67] op_sel_hi:[1,0]
ds_read_b128 a[64:67],v11 offset:12544
v_accvgpr_read_b32 v80,a192
ds_read_b128 a[68:71],v12 offset:12544
v_pk_mul_f32 v[80:81],v[80:81],v[66:67] op_sel_hi:[1,0]
ds_write2st64_b64 v39,v[96:97],v[100:101] offset0:36 offset1:40
v_accvgpr_read_b32 v84,a196
v_pk_mul_f32 v[84:85],v[84:85],v[66:67] op_sel_hi:[1,0]
v_accvgpr_read_b32 v90,a202
v_accvgpr_read_b32 v89,a201
v_mfma_f32_16x16x32_bf16 v[152:155],a[144:147],v[52:55],v[152:155]
ds_read_b128 v[104:107],v10 offset:18432
v_accvgpr_read_b32 v88,a200
v_accvgpr_read_b32 v91,a203
v_accvgpr_read_b32 v92,a204
v_accvgpr_read_b32 v95,a207
ds_read_b128 v[108:111],v10 offset:19456
v_pk_mul_f32 v[90:91],v[90:91],v[66:67] op_sel_hi:[1,0]
v_pk_mul_f32 v[88:89],v[88:89],v[66:67] op_sel_hi:[1,0]
v_accvgpr_read_b32 v93,a205
v_accvgpr_read_b32 v94,a206
v_mfma_f32_16x16x32_bf16 v[248:251],a[144:147],v[48:51],v[248:251]
ds_read_b128 v[72:75],v10 offset:20480
v_cvt_pk_bf16_f32 v80,v80,v81
v_cvt_pk_bf16_f32 v81,v82,v83
v_cvt_pk_bf16_f32 v84,v84,v85
v_cvt_pk_bf16_f32 v88,v88,v89
ds_read_b128 v[76:79],v10 offset:21504
v_pk_mul_f32 v[116:117],v[116:117],v[64:65] op_sel_hi:[1,0]
v_pk_mul_f32 v[130:131],v[130:131],v[64:65] op_sel_hi:[1,0]
v_pk_mul_f32 v[132:133],v[132:133],v[64:65] op_sel_hi:[1,0]
v_pk_mul_f32 v[136:137],v[136:137],v[64:65] op_sel_hi:[1,0]
ds_write_b64 v36,v[80:81] offset:18432
v_pk_mul_f32 v[92:93],v[92:93],v[66:67] op_sel_hi:[1,0]
v_pk_mul_f32 v[118:119],v[118:119],v[64:65] op_sel_hi:[1,0]
v_pk_mul_f32 v[134:135],v[134:135],v[64:65] op_sel_hi:[1,0]
s_waitcnt lgkmcnt(4)
buffer_store_dwordx4 v[104:107],v9,s[16:19],s87 offen offset:0 nt
v_pk_mul_f32 v[128:129],v[128:129],v[64:65] op_sel_hi:[1,0]
v_pk_mul_f32 v[120:121],v[120:121],v[64:65] op_sel_hi:[1,0]
v_pk_mul_f32 v[94:95],v[94:95],v[66:67] op_sel_hi:[1,0]
v_pk_mul_f32 v[122:123],v[122:123],v[64:65] op_sel_hi:[1,0]
v_pk_mul_f32 v[138:139],v[138:139],v[64:65] op_sel_hi:[1,0]
v_pk_mul_f32 v[114:115],v[114:115],v[64:65] op_sel_hi:[1,0]
v_pk_mul_f32 v[112:113],v[112:113],v[64:65] op_sel_hi:[1,0]
v_add_u32 v36,v36,v19
v_cvt_pk_bf16_f32 v92,v92,v93
v_mfma_f32_16x16x32_bf16 v[252:255],a[148:151],v[48:51],v[252:255]
v_cvt_pk_bf16_f32 v89,v90,v91
v_cvt_pk_bf16_f32 v85,v86,v87
v_mfma_f32_16x16x32_bf16 v[204:207],a[148:151],v[44:47],v[204:207]
ds_write_b64 v37,v[84:85] offset:18432
v_mfma_f32_16x16x32_bf16 v[200:203],a[144:147],v[44:47],v[200:203]
s_waitcnt lgkmcnt(1)
buffer_store_dwordx4 v[108:111],v9,s[16:19],s87 offen offset:3072 nt
v_add_u32 v37,v37,v19
v_cvt_pk_bf16_f32 v93,v94,v95
v_cvt_pk_bf16_f32 v128,v128,v129
v_cvt_pk_bf16_f32 v112,v112,v113
v_cvt_pk_bf16_f32 v113,v114,v115
v_cvt_pk_bf16_f32 v116,v116,v117
v_cvt_pk_bf16_f32 v129,v130,v131
v_cvt_pk_bf16_f32 v132,v132,v133
v_cvt_pk_bf16_f32 v136,v136,v137
v_cvt_pk_bf16_f32 v120,v120,v121
v_cvt_pk_bf16_f32 v133,v134,v135
v_cvt_pk_bf16_f32 v137,v138,v139
ds_write_b64 v38,v[88:89] offset:18432
buffer_store_dwordx4 v[72:75],v9,s[16:19],s87 offen offset:128 nt
v_add_u32 v38,v38,v19
v_cvt_pk_bf16_f32 v117,v118,v119
v_cvt_pk_bf16_f32 v121,v122,v123
v_mov_b32 v67,0
v_mov_b32 v66,0
v_mov_b32 v71,0
v_mov_b32 v70,0
v_mov_b32 v68,0
v_mov_b32 v69,0
ds_write_b64 v39,v[92:93] offset:18432
v_add_u32 v39,v39,v19
ds_read_b128 v[96:99],v10 offset:18432
buffer_store_dwordx4 v[76:79],v9,s[16:19],s87 offen offset:3200 nt
ds_read_b128 v[100:103],v10 offset:19456
s_waitcnt vmcnt(10)
s_barrier
ds_read_b128 a[120:123],v0 offset:0
ds_write2st64_b64 v36,v[112:113],v[128:129] offset0:24 offset1:26
ds_read_b128 a[124:127],v1 offset:0
ds_read_b128 a[128:131],v0 offset:128
buffer_load_dwordx4 v6,s[8:11],s25 offen offset:0 lds
ds_write2st64_b64 v37,v[116:117],v[132:133] offset0:24 offset1:26
s_waitcnt lgkmcnt(4)
v_mfma_f32_16x16x32_bf16 v[72:75],a[120:123],a[0:3],0
ds_read_b128 a[132:135],v1 offset:128
buffer_store_dwordx4 v[96:99],v9,s[16:19],s87 offen offset:256 nt
ds_read_b128 a[136:139],v0 offset:256
v_pk_mul_f32 v[126:127],v[126:127],v[64:65] op_sel_hi:[1,0]
ds_read_b128 a[140:143],v1 offset:256
v_pk_mul_f32 v[142:143],v[142:143],v[64:65] op_sel_hi:[1,0]
ds_read_b128 a[144:147],v0 offset:6144
v_pk_mul_f32 v[124:125],v[124:125],v[64:65] op_sel_hi:[1,0]
ds_read_b128 a[148:151],v1 offset:6144
buffer_store_dwordx4 v[100:103],v9,s[16:19],s87 offen offset:3328 nt
v_pk_mul_f32 v[140:141],v[140:141],v[64:65] op_sel_hi:[1,0]
v_cvt_pk_bf16_f32 v124,v124,v125
v_cvt_pk_bf16_f32 v140,v140,v141
s_waitcnt lgkmcnt(5)
v_mfma_f32_16x16x32_bf16 v[72:75],a[124:127],a[4:7],v[72:75]
v_cvt_pk_bf16_f32 v141,v142,v143
v_cvt_pk_bf16_f32 v125,v126,v127
v_mfma_f32_16x16x32_bf16 v[72:75],a[128:131],a[8:11],v[72:75]
s_waitcnt lgkmcnt(4)
v_mfma_f32_16x16x32_bf16 v[72:75],a[132:135],a[12:15],v[72:75]
buffer_load_dwordx4 v7,s[8:11],s25 offen offset:1024 lds
ds_write2st64_b64 v38,v[120:121],v[136:137] offset0:24 offset1:26
v_pk_mul_f32 v[162:163],v[162:163],v[60:61] op_sel_hi:[1,0]
v_pk_mul_f32 v[146:147],v[146:147],v[64:65] op_sel_hi:[1,0]
v_pk_mul_f32 v[144:145],v[144:145],v[64:65] op_sel_hi:[1,0]
v_pk_mul_f32 v[160:161],v[160:161],v[60:61] op_sel_hi:[1,0]
v_cvt_pk_bf16_f32 v144,v144,v145
v_cvt_pk_bf16_f32 v160,v160,v161
s_waitcnt lgkmcnt(1)
v_mfma_f32_16x16x32_bf16 v[72:75],a[136:139],a[16:19],v[72:75]
v_cvt_pk_bf16_f32 v161,v162,v163
v_cvt_pk_bf16_f32 v145,v146,v147
v_mfma_f32_16x16x32_bf16 v[72:75],a[140:143],a[20:23],v[72:75]
ds_write2st64_b64 v39,v[124:125],v[140:141] offset0:24 offset1:26
v_mfma_f32_16x16x32_bf16 v[80:83],a[140:143],a[44:47],0
v_mfma_f32_16x16x32_bf16 v[80:83],a[136:139],a[40:43],v[80:83]
buffer_load_dwordx4 v8,s[8:11],s25 offen offset:2048 lds
s_waitcnt vmcnt(18)
ds_read_b128 a[92:95],v12 offset:256
v_pk_mul_f32 v[166:167],v[166:167],v[60:61] op_sel_hi:[1,0]
v_pk_mul_f32 v[164:165],v[164:165],v[60:61] op_sel_hi:[1,0]
v_pk_mul_f32 v[150:151],v[150:151],v[64:65] op_sel_hi:[1,0]
v_pk_mul_f32 v[148:149],v[148:149],v[64:65] op_sel_hi:[1,0]
v_max3_f32 v44,v72,v73,v74
v_cvt_pk_bf16_f32 v164,v164,v165
v_mfma_f32_16x16x32_bf16 v[80:83],a[132:135],a[36:39],v[80:83]
s_mov_b32 s27,s42
ds_read_b128 a[88:91],v11 offset:256
v_cvt_pk_bf16_f32 v148,v148,v149
v_mfma_f32_16x16x32_bf16 v[80:83],a[128:131],a[32:35],v[80:83]
s_mov_b32 s42,s41
ds_read_b128 a[84:87],v12 offset:128
v_cvt_pk_bf16_f32 v165,v166,v167
v_mfma_f32_16x16x32_bf16 v[80:83],a[124:127],a[28:31],v[80:83]
s_add_u32 s69,s69,1
ds_read_b128 a[80:83],v11 offset:128
v_cvt_pk_bf16_f32 v149,v150,v151
v_mfma_f32_16x16x32_bf16 v[80:83],a[120:123],a[24:27],v[80:83]
s_lshl_b32 s62,s69,5
ds_read_b128 a[76:79],v12 offset:0
s_add_u32 s62,s62,s34
ds_read_b128 a[72:75],v11 offset:0
v_pk_mul_f32 v[170:171],v[170:171],v[60:61] op_sel_hi:[1,0]
v_pk_mul_f32 v[168:169],v[168:169],v[60:61] op_sel_hi:[1,0]
v_pk_mul_f32 v[154:155],v[154:155],v[64:65] op_sel_hi:[1,0]
v_pk_mul_f32 v[152:153],v[152:153],v[64:65] op_sel_hi:[1,0]
v_max3_f32 v48,v80,v81,v82
v_cvt_pk_bf16_f32 v152,v152,v153
v_mfma_f32_16x16x32_bf16 v[88:91],a[120:123],a[48:51],0
s_mul_i32 s63,s62,171
ds_write2st64_b64 v36,v[144:145],v[160:161] offset0:28 offset1:0
v_mfma_f32_16x16x32_bf16 v[88:91],a[124:127],a[52:55],v[88:91]
s_lshr_b32 s63,s63,9
v_cvt_pk_bf16_f32 v168,v168,v169
v_cvt_pk_bf16_f32 v169,v170,v171
v_mfma_f32_16x16x32_bf16 v[88:91],a[128:131],a[56:59],v[88:91]
s_mul_i32 s64,s63,3
v_cvt_pk_bf16_f32 v153,v154,v155
s_sub_u32 s62,s62,s64
v_mfma_f32_16x16x32_bf16 v[88:91],a[132:135],a[60:63],v[88:91]
s_add_u32 s63,s63,s33
s_mul_i32 s30,s63,196608
s_mul_i32 s41,s63,325632
s_lshl_b32 s63,s3,2
ds_write2st64_b64 v37,v[148:149],v[164:165] offset0:28 offset1:0
v_pk_mul_f32 v[174:175],v[174:175],v[60:61] op_sel_hi:[1,0]
v_pk_mul_f32 v[172:173],v[172:173],v[60:61] op_sel_hi:[1,0]
v_pk_mul_f32 v[156:157],v[156:157],v[64:65] op_sel_hi:[1,0]
v_pk_mul_f32 v[158:159],v[158:159],v[64:65] op_sel_hi:[1,0]
v_cvt_pk_bf16_f32 v172,v172,v173
v_cvt_pk_bf16_f32 v156,v156,v157
v_mfma_f32_16x16x32_bf16 v[88:91],a[136:139],a[64:67],v[88:91]
s_add_u32 s64,s63,21
v_cvt_pk_bf16_f32 v157,v158,v159
v_cvt_pk_bf16_f32 v173,v174,v175
v_mfma_f32_16x16x32_bf16 v[88:91],a[140:143],a[68:71],v[88:91]
s_cmp_eq_u32 s3,0
v_mov_b32 v65,0
v_mov_b32 v64,0
s_waitcnt lgkmcnt(1)
v_mfma_f32_16x16x32_bf16 v[96:99],a[140:143],a[92:95],0
s_cselect_b32 s64,20,s64
ds_write2st64_b64 v38,v[152:153],v[168:169] offset0:28 offset1:0
v_pk_mul_f32 v[176:177],v[176:177],v[60:61] op_sel_hi:[1,0]
v_pk_mul_f32 v[194:195],v[194:195],v[60:61] op_sel_hi:[1,0]
v_pk_mul_f32 v[192:193],v[192:193],v[60:61] op_sel_hi:[1,0]
v_pk_mul_f32 v[178:179],v[178:179],v[60:61] op_sel_hi:[1,0]
v_max3_f32 v52,v88,v89,v90
v_cvt_pk_bf16_f32 v176,v176,v177
v_mfma_f32_16x16x32_bf16 v[96:99],a[136:139],a[88:91],v[96:99]
s_cselect_b32 s40,1,0
v_cvt_pk_bf16_f32 v192,v192,v193
v_cvt_pk_bf16_f32 v177,v178,v179
v_mfma_f32_16x16x32_bf16 v[96:99],a[132:135],a[84:87],v[96:99]
s_add_u32 s65,s63,37
v_cvt_pk_bf16_f32 v193,v194,v195
s_cmp_eq_u32 s62,2
v_mfma_f32_16x16x32_bf16 v[96:99],a[128:131],a[80:83],v[96:99]
s_cselect_b32 s64,s65,s64
ds_write2st64_b64 v39,v[156:157],v[172:173] offset0:28 offset1:0
v_mfma_f32_16x16x32_bf16 v[96:99],a[124:127],a[76:79],v[96:99]
s_waitcnt vmcnt(9)
s_cselect_b32 s40,0,s40
s_add_u32 s65,s63,s3
s_cmp_eq_u32 s62,0
ds_read_b128 a[96:99],v11 offset:6144
s_cselect_b32 s64,s65,s64
ds_read_b128 a[100:103],v12 offset:6144
v_pk_mul_f32 v[198:199],v[198:199],v[60:61] op_sel_hi:[1,0]
ds_read_b128 a[104:107],v11 offset:6272
v_pk_mul_f32 v[196:197],v[196:197],v[60:61] op_sel_hi:[1,0]
ds_read_b128 a[108:111],v12 offset:6272
v_pk_mul_f32 v[180:181],v[180:181],v[60:61] op_sel_hi:[1,0]
ds_read_b128 a[112:115],v11 offset:6400
v_pk_mul_f32 v[182:183],v[182:183],v[60:61] op_sel_hi:[1,0]
v_cvt_pk_bf16_f32 v180,v180,v181
v_cvt_pk_bf16_f32 v196,v196,v197
v_mfma_f32_16x16x32_bf16 v[96:99],a[120:123],a[72:75],v[96:99]
s_cselect_b32 s40,1,s40
ds_read_b128 a[116:119],v12 offset:6400
v_cvt_pk_bf16_f32 v181,v182,v183
ds_write2st64_b64 v36,v[176:177],v[192:193] offset0:2 offset1:4
s_waitcnt lgkmcnt(6)
v_mfma_f32_16x16x32_bf16 v[104:107],a[120:123],a[96:99],0
s_mul_i32 s64,s64,6144
v_cvt_pk_bf16_f32 v197,v198,v199
s_add_u32 s41,s41,s64
s_waitcnt lgkmcnt(5)
v_mfma_f32_16x16x32_bf16 v[104:107],a[124:127],a[100:103],v[104:107]
s_cmp_ge_u32 s69,6
ds_read_b128 a[120:123],v0 offset:6272
v_max3_f32 v56,v96,v97,v98
s_waitcnt lgkmcnt(5)
v_mfma_f32_16x16x32_bf16 v[104:107],a[128:131],a[104:107],v[104:107]
s_cselect_b32 s41,166723584,s41
ds_read_b128 a[124:127],v1 offset:6272
s_cselect_b32 s30,100663296,s30
s_add_u32 s25,s30,s22
s_add_u32 s26,s25,12288
ds_write2st64_b64 v37,v[180:181],v[196:197] offset0:2 offset1:4
v_pk_mul_f32 v[184:185],v[184:185],v[60:61] op_sel_hi:[1,0]
v_pk_mul_f32 v[200:201],v[200:201],v[60:61] op_sel_hi:[1,0]
v_pk_mul_f32 v[202:203],v[202:203],v[60:61] op_sel_hi:[1,0]
ds_read_b128 a[128:131],v0 offset:6400
v_pk_mul_f32 v[186:187],v[186:187],v[60:61] op_sel_hi:[1,0]
v_cvt_pk_bf16_f32 v200,v200,v201
v_cvt_pk_bf16_f32 v184,v184,v185
s_waitcnt lgkmcnt(4)
v_mfma_f32_16x16x32_bf16 v[104:107],a[132:135],a[108:111],v[104:107]
s_add_u32 m0,s23,24576
ds_read_b128 a[132:135],v1 offset:6400
v_cvt_pk_bf16_f32 v185,v186,v187
v_mfma_f32_16x16x32_bf16 v[104:107],a[136:139],a[112:115],v[104:107]
s_mov_b32 s28,s41
ds_read_b128 a[136:139],v0 offset:12288
v_cvt_pk_bf16_f32 v201,v202,v203
v_mfma_f32_16x16x32_bf16 v[104:107],a[140:143],a[116:119],v[104:107]
s_mov_b32 s29,s24
ds_read_b128 a[140:143],v1 offset:12288
ds_write2st64_b64 v38,v[184:185],v[200:201] offset0:2 offset1:4
v_pk_mul_f32 v[206:207],v[206:207],v[60:61] op_sel_hi:[1,0]
v_pk_mul_f32 v[190:191],v[190:191],v[60:61] op_sel_hi:[1,0]
v_pk_mul_f32 v[204:205],v[204:205],v[60:61] op_sel_hi:[1,0]
v_pk_mul_f32 v[188:189],v[188:189],v[60:61] op_sel_hi:[1,0]
v_cvt_pk_bf16_f32 v204,v204,v205
v_max3_f32 v40,v104,v105,v106
v_mfma_f32_16x16x32_bf16 v[76:79],a[144:147],a[0:3],0
v_cvt_pk_bf16_f32 v188,v188,v189
v_cvt_pk_bf16_f32 v205,v206,v207
v_mfma_f32_16x16x32_bf16 v[76:79],a[148:151],a[4:7],v[76:79]
s_waitcnt lgkmcnt(4)
v_cvt_pk_bf16_f32 v189,v190,v191
v_mov_b32 v61,0
v_mfma_f32_16x16x32_bf16 v[76:79],a[120:123],a[8:11],v[76:79]
ds_write2st64_b64 v39,v[188:189],v[204:205] offset0:2 offset1:4
v_mfma_f32_16x16x32_bf16 v[76:79],a[124:127],a[12:15],v[76:79]
v_mov_b32 v60,0
buffer_load_dwordx4 v6,s[8:11],s21 offen offset:0 lds
v_pk_mul_f32 v[210:211],v[210:211],v[62:63] op_sel_hi:[1,0]
v_pk_mul_f32 v[208:209],v[208:209],v[62:63] op_sel_hi:[1,0]
v_pk_mul_f32 v[224:225],v[224:225],v[62:63] op_sel_hi:[1,0]
v_pk_mul_f32 v[226:227],v[226:227],v[62:63] op_sel_hi:[1,0]
v_cvt_pk_bf16_f32 v224,v224,v225
v_cvt_pk_bf16_f32 v225,v226,v227
v_mfma_f32_16x16x32_bf16 v[76:79],a[128:131],a[16:19],v[76:79]
s_waitcnt lgkmcnt(1)
v_cvt_pk_bf16_f32 v208,v208,v209
v_cvt_pk_bf16_f32 v209,v210,v211
v_mfma_f32_16x16x32_bf16 v[76:79],a[132:135],a[20:23],v[76:79]
ds_write2st64_b64 v36,v[208:209],v[224:225] offset0:12 offset1:14
v_mfma_f32_16x16x32_bf16 v[84:87],a[132:135],a[44:47],0
v_mfma_f32_16x16x32_bf16 v[84:87],a[128:131],a[40:43],v[84:87]
buffer_load_dwordx4 v7,s[8:11],s21 offen offset:1024 lds
v_pk_mul_f32 v[214:215],v[214:215],v[62:63] op_sel_hi:[1,0]
v_pk_mul_f32 v[230:231],v[230:231],v[62:63] op_sel_hi:[1,0]
v_pk_mul_f32 v[228:229],v[228:229],v[62:63] op_sel_hi:[1,0]
v_pk_mul_f32 v[212:213],v[212:213],v[62:63] op_sel_hi:[1,0]
v_max3_f32 v44,v44,v75,v76
v_max3_f32 v44,v44,v77,v78
v_mfma_f32_16x16x32_bf16 v[84:87],a[124:127],a[36:39],v[84:87]
v_max_f32 v44,v44,v79
v_mov_b32 v45,v44
v_mfma_f32_16x16x32_bf16 v[84:87],a[120:123],a[32:35],v[84:87]
v_cvt_pk_bf16_f32 v212,v212,v213
v_permlane32_swap_b32 v45,v44
v_mfma_f32_16x16x32_bf16 v[84:87],a[148:151],a[28:31],v[84:87]
v_max_f32 v44,v44,v45
v_mov_b32 v45,v44
v_cvt_pk_bf16_f32 v213,v214,v215
v_cvt_pk_bf16_f32 v228,v228,v229
v_permlane16_swap_b32 v45,v44
v_pk_mul_f32 v[234:235],v[234:235],v[62:63] op_sel_hi:[1,0]
v_pk_mul_f32 v[218:219],v[218:219],v[62:63] op_sel_hi:[1,0]
v_pk_mul_f32 v[232:233],v[232:233],v[62:63] op_sel_hi:[1,0]
v_pk_mul_f32 v[216:217],v[216:217],v[62:63] op_sel_hi:[1,0]
v_max_f32 v44,v44,v45
v_mul_f32_e64 v13,-s36,v44
v_mfma_f32_16x16x32_bf16 v[84:87],a[144:147],a[24:27],v[84:87]
buffer_load_dwordx4 v8,s[8:11],s21 offen offset:2048 lds
v_mfma_f32_16x16x32_bf16 v[92:95],a[144:147],a[48:51],0
s_add_u32 s21,s21,12288
v_fma_f32 v72,v72,s36,v13
v_fma_f32 v74,v74,s36,v13
v_mfma_f32_16x16x32_bf16 v[92:95],a[148:151],a[52:55],v[92:95]
s_add_u32 m0,s22,0
v_exp_f32 v74,v74
v_mfma_f32_16x16x32_bf16 v[92:95],a[120:123],a[56:59],v[92:95]
v_fma_f32 v75,v75,s36,v13
v_exp_f32 v75,v75
v_exp_f32 v72,v72
v_pk_mul_f32 v[236:237],v[236:237],v[62:63] op_sel_hi:[1,0]
v_pk_mul_f32 v[238:239],v[238:239],v[62:63] op_sel_hi:[1,0]
v_pk_mul_f32 v[220:221],v[220:221],v[62:63] op_sel_hi:[1,0]
v_pk_mul_f32 v[222:223],v[222:223],v[62:63] op_sel_hi:[1,0]
v_fma_f32 v73,v73,s36,v13
v_exp_f32 v73,v73
v_mfma_f32_16x16x32_bf16 v[92:95],a[124:127],a[60:63],v[92:95]
v_cvt_pk_bf16_f32 v20,v72,v73
v_cvt_pk_bf16_f32 v21,v74,v75
v_mfma_f32_16x16x32_bf16 v[92:95],a[128:131],a[64:67],v[92:95]
v_max3_f32 v48,v48,v83,v84
v_max3_f32 v48,v48,v85,v86
v_mfma_f32_16x16x32_bf16 v[92:95],a[132:135],a[68:71],v[92:95]
v_max_f32 v48,v48,v87
v_mov_b32 v49,v48
v_mfma_f32_16x16x32_bf16 v[100:103],a[132:135],a[92:95],0
v_cvt_pk_bf16_f32 v236,v236,v237
v_permlane32_swap_b32 v49,v48
v_max_f32 v48,v48,v49
v_mov_b32 v49,v48
v_pk_mul_f32 v[242:243],v[242:243],v[62:63] op_sel_hi:[1,0]
v_pk_mul_f32 v[240:241],v[240:241],v[62:63] op_sel_hi:[1,0]
v_permlane16_swap_b32 v49,v48
v_max_f32 v48,v48,v49
v_mfma_f32_16x16x32_bf16 v[100:103],a[128:131],a[88:91],v[100:103]
v_mul_f32_e64 v14,-s36,v48
v_fma_f32 v81,v81,s36,v14
v_mfma_f32_16x16x32_bf16 v[100:103],a[124:127],a[84:87],v[100:103]
v_fma_f32 v83,v83,s36,v14
v_fma_f32 v80,v80,s36,v14
v_mfma_f32_16x16x32_bf16 v[100:103],a[120:123],a[80:83],v[100:103]
v_exp_f32 v81,v81
v_mfma_f32_16x16x32_bf16 v[100:103],a[148:151],a[76:79],v[100:103]
v_exp_f32 v80,v80
v_fma_f32 v82,v82,s36,v14
v_exp_f32 v82,v82
v_pk_mul_f32 v[246:247],v[246:247],v[62:63] op_sel_hi:[1,0]
v_pk_mul_f32 v[244:245],v[244:245],v[62:63] op_sel_hi:[1,0]
v_exp_f32 v83,v83
v_cvt_pk_bf16_f32 v24,v80,v81
v_mfma_f32_16x16x32_bf16 v[100:103],a[144:147],a[72:75],v[100:103]
v_cvt_pk_bf16_f32 v25,v82,v83
v_max3_f32 v52,v52,v91,v92
v_mfma_f32_16x16x32_bf16 v[108:111],a[144:147],a[96:99],0
ds_read_b128 a[144:147],v0 offset:12416
v_max3_f32 v52,v52,v93,v94
v_mfma_f32_16x16x32_bf16 v[108:111],a[148:151],a[100:103],v[108:111]
ds_read_b128 a[148:151],v1 offset:12416
v_max_f32 v52,v52,v95
v_mov_b32 v53,v52
v_max3_f32 v56,v56,v99,v100
v_max3_f32 v56,v56,v101,v102
v_pk_mul_f32 v[248:249],v[248:249],v[62:63] op_sel_hi:[1,0]
v_pk_mul_f32 v[250:251],v[250:251],v[62:63] op_sel_hi:[1,0]
v_permlane32_swap_b32 v53,v52
v_max_f32 v52,v52,v53
v_mfma_f32_16x16x32_bf16 v[108:111],a[120:123],a[104:107],v[108:111]
ds_read_b128 a[120:123],v0 offset:12544
v_mov_b32 v53,v52
v_mfma_f32_16x16x32_bf16 v[108:111],a[124:127],a[108:111],v[108:111]
ds_read_b128 a[124:127],v1 offset:12544
v_permlane16_swap_b32 v53,v52
v_mfma_f32_16x16x32_bf16 v[108:111],a[128:131],a[112:115],v[108:111]
ds_read_b128 a[128:131],v0 offset:18432
v_max_f32 v52,v52,v53
v_mfma_f32_16x16x32_bf16 v[108:111],a[132:135],a[116:119],v[108:111]
ds_read_b128 a[132:135],v1 offset:18432
v_mul_f32_e64 v15,-s36,v52
v_fma_f32 v88,v88,s36,v15
v_fma_f32 v89,v89,s36,v15
v_fma_f32 v91,v91,s36,v15
v_pk_mul_f32 v[252:253],v[252:253],v[62:63] op_sel_hi:[1,0]
v_pk_mul_f32 v[254:255],v[254:255],v[62:63] op_sel_hi:[1,0]
v_fma_f32 v90,v90,s36,v15
v_exp_f32 v90,v90
v_mfma_f32_16x16x32_bf16 v[72:75],a[136:139],a[0:3],0
v_exp_f32 v91,v91
v_mfma_f32_16x16x32_bf16 v[72:75],a[140:143],a[4:7],v[72:75]
s_waitcnt lgkmcnt(3)
v_exp_f32 v89,v89
v_mfma_f32_16x16x32_bf16 v[72:75],a[144:147],a[8:11],v[72:75]
v_exp_f32 v88,v88
v_mfma_f32_16x16x32_bf16 v[72:75],a[148:151],a[12:15],v[72:75]
v_cvt_pk_bf16_f32 v29,v90,v91
v_cvt_pk_bf16_f32 v28,v88,v89
v_mfma_f32_16x16x32_bf16 v[72:75],a[120:123],a[16:19],v[72:75]
s_waitcnt lgkmcnt(0)
v_max_f32 v56,v56,v103
v_mov_b32 v57,v56
v_mfma_f32_16x16x32_bf16 v[72:75],a[124:127],a[20:23],v[72:75]
v_max3_f32 v40,v40,v107,v108
v_permlane32_swap_b32 v57,v56
v_mfma_f32_16x16x32_bf16 v[80:83],a[124:127],a[44:47],0
v_max_f32 v56,v56,v57
v_mov_b32 v57,v56
v_mfma_f32_16x16x32_bf16 v[80:83],a[120:123],a[40:43],v[80:83]
v_max3_f32 v40,v40,v109,v110
v_permlane16_swap_b32 v57,v56
v_mfma_f32_16x16x32_bf16 v[80:83],a[148:151],a[36:39],v[80:83]
v_max_f32 v56,v56,v57
v_mul_f32_e64 v16,-s36,v56
v_mfma_f32_16x16x32_bf16 v[80:83],a[144:147],a[32:35],v[80:83]
v_fma_f32 v97,v97,s36,v16
v_fma_f32 v98,v98,s36,v16
v_mfma_f32_16x16x32_bf16 v[80:83],a[140:143],a[28:31],v[80:83]
v_fma_f32 v99,v99,s36,v16
v_exp_f32 v99,v99
v_mfma_f32_16x16x32_bf16 v[80:83],a[136:139],a[24:27],v[80:83]
v_exp_f32 v97,v97
v_mfma_f32_16x16x32_bf16 v[88:91],a[136:139],a[48:51],0
v_fma_f32 v96,v96,s36,v16
v_exp_f32 v96,v96
v_mfma_f32_16x16x32_bf16 v[88:91],a[140:143],a[52:55],v[88:91]
v_exp_f32 v98,v98
v_mfma_f32_16x16x32_bf16 v[88:91],a[144:147],a[56:59],v[88:91]
v_cvt_pk_bf16_f32 v33,v98,v99
v_cvt_pk_bf16_f32 v32,v96,v97
v_mfma_f32_16x16x32_bf16 v[88:91],a[148:151],a[60:63],v[88:91]
v_max_f32 v40,v40,v111
v_mov_b32 v41,v40
v_mfma_f32_16x16x32_bf16 v[88:91],a[120:123],a[64:67],v[88:91]
v_cvt_pk_bf16_f32 v232,v232,v233
v_permlane32_swap_b32 v41,v40
v_mfma_f32_16x16x32_bf16 v[88:91],a[124:127],a[68:71],v[88:91]
v_max_f32 v40,v40,v41
v_mov_b32 v41,v40
v_mfma_f32_16x16x32_bf16 v[96:99],a[124:127],a[92:95],0
v_cvt_pk_bf16_f32 v216,v216,v217
v_cvt_pk_bf16_f32 v217,v218,v219
v_mfma_f32_16x16x32_bf16 v[96:99],a[120:123],a[88:91],v[96:99]
v_permlane16_swap_b32 v41,v40
v_mfma_f32_16x16x32_bf16 v[96:99],a[148:151],a[84:87],v[96:99]
v_cvt_pk_bf16_f32 v240,v240,v241
v_cvt_pk_bf16_f32 v237,v238,v239
v_mfma_f32_16x16x32_bf16 v[96:99],a[144:147],a[80:83],v[96:99]
v_max_f32 v40,v40,v41
v_cvt_pk_bf16_f32 v233,v234,v235
v_mfma_f32_16x16x32_bf16 v[96:99],a[140:143],a[76:79],v[96:99]
v_cvt_pk_bf16_f32 v229,v230,v231
v_cvt_pk_bf16_f32 v220,v220,v221
v_mfma_f32_16x16x32_bf16 v[96:99],a[136:139],a[72:75],v[96:99]
ds_write2st64_b64 v37,v[212:213],v[228:229] offset0:12 offset1:14
v_cvt_pk_bf16_f32 v221,v222,v223
v_mul_f32_e64 v17,-s36,v40
v_fma_f32 v105,v105,s36,v17
v_fma_f32 v104,v104,s36,v17
v_fma_f32 v107,v107,s36,v17
v_exp_f32 v107,v107
v_exp_f32 v104,v104
v_cvt_pk_bf16_f32 v241,v242,v243
v_fma_f32 v106,v106,s36,v17
v_exp_f32 v105,v105
v_exp_f32 v106,v106
ds_write2st64_b64 v38,v[216:217],v[232:233] offset0:12 offset1:14
v_cvt_pk_bf16_f32 v244,v244,v245
v_cvt_pk_bf16_f32 v245,v246,v247
v_fma_f32 v78,v78,s36,v13
v_fma_f32 v77,v77,s36,v13
v_exp_f32 v78,v78
v_fma_f32 v76,v76,s36,v13
v_exp_f32 v77,v77
v_fma_f32 v79,v79,s36,v13
v_exp_f32 v79,v79
v_exp_f32 v76,v76
v_cvt_pk_bf16_f32 v23,v78,v79
ds_write2st64_b64 v39,v[220:221],v[236:237] offset0:12 offset1:14
v_cvt_pk_bf16_f32 v22,v76,v77
v_fma_f32 v84,v84,s36,v14
v_exp_f32 v84,v84
v_fma_f32 v85,v85,s36,v14
v_fma_f32 v86,v86,s36,v14
v_fma_f32 v87,v87,s36,v14
v_exp_f32 v87,v87
v_exp_f32 v86,v86
v_exp_f32 v85,v85
v_cvt_pk_bf16_f32 v27,v86,v87
ds_write_b64 v36,v[240:241] offset:8192
v_cvt_pk_bf16_f32 v36,v104,v105
v_cvt_pk_bf16_f32 v26,v84,v85
v_fma_f32 v93,v93,s36,v15
v_fma_f32 v92,v92,s36,v15
v_fma_f32 v95,v95,s36,v15
v_exp_f32 v95,v95
ds_write_b64 v37,v[244:245] offset:8192
v_cvt_pk_bf16_f32 v37,v106,v107
v_mfma_f32_16x16x32_bf16 v[104:107],a[136:139],a[96:99],0
ds_read_b128 a[136:139],v0 offset:18560
v_fma_f32 v94,v94,s36,v15
v_mfma_f32_16x16x32_bf16 v[104:107],a[140:143],a[100:103],v[104:107]
ds_read_b128 a[140:143],v1 offset:18560
v_exp_f32 v93,v93
v_mfma_f32_16x16x32_bf16 v[104:107],a[144:147],a[104:107],v[104:107]
s_waitcnt vmcnt(3)
s_barrier
v_mfma_f32_16x16x32_bf16 v[104:107],a[148:151],a[108:111],v[104:107]
ds_read_b128 a[144:147],v0 offset:18688
buffer_load_dwordx4 v6,s[4:7],s20 offen offset:0 lds
v_mfma_f32_16x16x32_bf16 v[104:107],a[120:123],a[112:115],v[104:107]
ds_read_b128 a[148:151],v1 offset:18688
v_exp_f32 v94,v94
v_mfma_f32_16x16x32_bf16 v[104:107],a[124:127],a[116:119],v[104:107]
v_exp_f32 v92,v92
v_mfma_f32_16x16x32_bf16 v[76:79],a[128:131],a[0:3],0
v_cvt_pk_bf16_f32 v31,v94,v95
v_cvt_pk_bf16_f32 v30,v92,v93
v_mfma_f32_16x16x32_bf16 v[76:79],a[132:135],a[4:7],v[76:79]
s_waitcnt lgkmcnt(2)
v_fma_f32 v100,v100,s36,v16
v_fma_f32 v103,v103,s36,v16
v_mfma_f32_16x16x32_bf16 v[76:79],a[136:139],a[8:11],v[76:79]
v_fma_f32 v101,v101,s36,v16
v_exp_f32 v100,v100
v_mfma_f32_16x16x32_bf16 v[76:79],a[140:143],a[12:15],v[76:79]
buffer_load_dwordx4 v7,s[4:7],s20 offen offset:1024 lds
s_waitcnt lgkmcnt(1)
v_mfma_f32_16x16x32_bf16 v[76:79],a[144:147],a[16:19],v[76:79]
s_waitcnt lgkmcnt(0)
v_exp_f32 v103,v103
v_fma_f32 v102,v102,s36,v16
v_mfma_f32_16x16x32_bf16 v[76:79],a[148:151],a[20:23],v[76:79]
v_exp_f32 v101,v101
v_mfma_f32_16x16x32_bf16 v[84:87],a[148:151],a[44:47],0
ds_read_b64_tr_b16 a[120:121],v2 offset:0
v_exp_f32 v102,v102
v_mfma_f32_16x16x32_bf16 v[84:87],a[144:147],a[40:43],v[84:87]
ds_read_b64_tr_b16 a[122:123],v2 offset:6144
v_cvt_pk_bf16_f32 v35,v102,v103
v_mfma_f32_16x16x32_bf16 v[84:87],a[140:143],a[36:39],v[84:87]
buffer_load_dwordx4 v8,s[4:7],s20 offen offset:2048 lds
v_mfma_f32_16x16x32_bf16 v[84:87],a[136:139],a[32:35],v[84:87]
s_add_u32 s20,s20,12288
ds_read_b64_tr_b16 a[126:127],v3 offset:6144
v_cvt_pk_bf16_f32 v34,v100,v101
v_mfma_f32_16x16x32_bf16 v[84:87],a[132:135],a[28:31],v[84:87]
ds_read_b64_tr_b16 a[124:125],v3 offset:0
v_fma_f32 v111,v111,s36,v17
v_smfmac_f32_16x16x64_bf16 v[64:67],a[152:155],v[28:35],v18
v_fma_f32 v109,v109,s36,v17
v_mfma_f32_16x16x32_bf16 v[84:87],a[128:131],a[24:27],v[84:87]
v_cvt_pk_bf16_f32 v252,v252,v253
v_fma_f32 v110,v110,s36,v17
v_mfma_f32_16x16x32_bf16 v[92:95],a[128:131],a[48:51],0
v_exp_f32 v110,v110
v_mfma_f32_16x16x32_bf16 v[92:95],a[132:135],a[52:55],v[92:95]
v_cvt_pk_bf16_f32 v248,v248,v249
v_cvt_pk_bf16_f32 v249,v250,v251
v_mfma_f32_16x16x32_bf16 v[92:95],a[136:139],a[56:59],v[92:95]
ds_write_b64 v38,v[248:249] offset:8192
v_mfma_f32_16x16x32_bf16 v[92:95],a[140:143],a[60:63],v[92:95]
v_fma_f32 v108,v108,s36,v17
v_exp_f32 v111,v111
v_mfma_f32_16x16x32_bf16 v[92:95],a[144:147],a[64:67],v[92:95]
v_exp_f32 v109,v109
v_mfma_f32_16x16x32_bf16 v[92:95],a[148:151],a[68:71],v[92:95]
v_exp_f32 v108,v108
v_mfma_f32_16x16x32_bf16 v[100:103],a[148:151],a[92:95],0
v_cvt_pk_bf16_f32 v253,v254,v255
v_cvt_pk_bf16_f32 v38,v108,v109
v_mfma_f32_16x16x32_bf16 v[100:103],a[144:147],a[88:91],v[100:103]
ds_write_b64 v39,v[252:253] offset:8192
v_mfma_f32_16x16x32_bf16 v[100:103],a[140:143],a[84:87],v[100:103]
v_cvt_pk_bf16_f32 v39,v110,v111
v_mov_b32 v62,0
v_mfma_f32_16x16x32_bf16 v[100:103],a[136:139],a[80:83],v[100:103]
v_fma_f32 v80,v80,s36,v14
v_fma_f32 v88,v88,s36,v15
v_mfma_f32_16x16x32_bf16 v[100:103],a[132:135],a[76:79],v[100:103]
v_fma_f32 v81,v81,s36,v14
v_fma_f32 v75,v75,s36,v13
v_mfma_f32_16x16x32_bf16 v[100:103],a[128:131],a[72:75],v[100:103]
v_fma_f32 v83,v83,s36,v14
v_mov_b32 v63,0
v_mfma_f32_16x16x32_bf16 v[108:111],a[128:131],a[96:99],0
ds_read_b64_tr_b16 a[128:129],v4 offset:0
v_fma_f32 v82,v82,s36,v14
v_smfmac_f32_16x16x64_bf16 v[60:63],a[152:155],v[20:27],v18
ds_read_b64_tr_b16 a[130:131],v4 offset:6144
v_mfma_f32_16x16x32_bf16 v[108:111],a[132:135],a[100:103],v[108:111]
ds_read_b64_tr_b16 a[134:135],v5 offset:6144
v_fma_f32 v74,v74,s36,v13
v_mfma_f32_16x16x32_bf16 v[108:111],a[136:139],a[104:107],v[108:111]
ds_read_b64_tr_b16 a[132:133],v5 offset:0
v_exp_f32 v88,v88
v_mfma_f32_16x16x32_bf16 v[108:111],a[140:143],a[108:111],v[108:111]
v_exp_f32 v80,v80
v_mfma_f32_16x16x32_bf16 v[108:111],a[144:147],a[112:115],v[108:111]
v_exp_f32 v75,v75
v_mfma_f32_16x16x32_bf16 v[108:111],a[148:151],a[116:119],v[108:111]
v_fma_f32 v89,v89,s36,v15
v_exp_f32 v89,v89
v_fma_f32 v72,v72,s36,v13
v_exp_f32 v72,v72
v_fma_f32 v73,v73,s36,v13
v_exp_f32 v83,v83
v_exp_f32 v81,v81
v_exp_f32 v82,v82
v_exp_f32 v73,v73
v_cvt_pk_bf16_f32 v52,v88,v89
v_exp_f32 v74,v74
v_cvt_pk_bf16_f32 v49,v82,v83
v_cvt_pk_bf16_f32 v44,v72,v73
v_cvt_pk_bf16_f32 v45,v74,v75
v_cvt_pk_bf16_f32 v48,v80,v81
s_waitcnt lgkmcnt(0)
v_mfma_f32_16x16x32_bf16 v[160:163],a[120:123],v[20:23],0
s_add_u32 m0,s23,0
ds_read_b64_tr_b16 a[136:137],v2 offset:128
v_fma_f32 v90,v90,s36,v15
v_mfma_f32_16x16x32_bf16 v[164:167],a[124:127],v[20:23],0
ds_read_b64_tr_b16 a[138:139],v2 offset:6272
v_fma_f32 v91,v91,s36,v15
v_mfma_f32_16x16x32_bf16 v[212:215],a[124:127],v[24:27],0
ds_read_b64_tr_b16 a[140:141],v3 offset:128
v_fma_f32 v96,v96,s36,v16
v_mfma_f32_16x16x32_bf16 v[208:211],a[120:123],v[24:27],0
ds_read_b64_tr_b16 a[142:143],v3 offset:6272
v_fma_f32 v97,v97,s36,v16
v_mfma_f32_16x16x32_bf16 v[112:115],a[120:123],v[28:31],0
ds_read_b64_tr_b16 a[144:145],v4 offset:128
v_fma_f32 v98,v98,s36,v16
v_mfma_f32_16x16x32_bf16 v[116:119],a[124:127],v[28:31],0
ds_read_b64_tr_b16 a[146:147],v4 offset:6272
v_fma_f32 v99,v99,s36,v16
v_mfma_f32_16x16x32_bf16 a[164:167],a[124:127],v[32:35],0
ds_read_b64_tr_b16 a[148:149],v5 offset:128
v_fma_f32 v104,v104,s36,v17
v_mfma_f32_16x16x32_bf16 a[160:163],a[120:123],v[32:35],0
ds_read_b64_tr_b16 a[150:151],v5 offset:6272
v_fma_f32 v105,v105,s36,v17
v_mfma_f32_16x16x32_bf16 a[208:211],a[120:123],v[36:39],0
ds_read_b64_tr_b16 a[120:121],v2 offset:256
v_fma_f32 v106,v106,s36,v17
v_mfma_f32_16x16x32_bf16 a[212:215],a[124:127],v[36:39],0
ds_read_b64_tr_b16 a[122:123],v2 offset:6400
v_fma_f32 v107,v107,s36,v17
v_mfma_f32_16x16x32_bf16 a[216:219],a[128:131],v[36:39],0
ds_read_b64_tr_b16 a[124:125],v3 offset:256
v_fma_f32 v76,v76,s36,v13
v_mfma_f32_16x16x32_bf16 a[220:223],a[132:135],v[36:39],0
ds_read_b64_tr_b16 a[126:127],v3 offset:6400
v_fma_f32 v77,v77,s36,v13
v_mfma_f32_16x16x32_bf16 a[172:175],a[132:135],v[32:35],0
v_exp_f32 v90,v90
v_mfma_f32_16x16x32_bf16 a[168:171],a[128:131],v[32:35],0
v_exp_f32 v91,v91
v_mfma_f32_16x16x32_bf16 v[120:123],a[128:131],v[28:31],0
v_cvt_pk_bf16_f32 v53,v90,v91
v_fma_f32 v78,v78,s36,v13
v_mfma_f32_16x16x32_bf16 v[124:127],a[132:135],v[28:31],0
v_exp_f32 v96,v96
v_mfma_f32_16x16x32_bf16 v[220:223],a[132:135],v[24:27],0
v_exp_f32 v97,v97
v_mfma_f32_16x16x32_bf16 v[216:219],a[128:131],v[24:27],0
v_exp_f32 v98,v98
v_mfma_f32_16x16x32_bf16 v[168:171],a[128:131],v[20:23],0
ds_read_b64_tr_b16 a[128:129],v4 offset:256
v_cvt_pk_bf16_f32 v56,v96,v97
v_mfma_f32_16x16x32_bf16 v[172:175],a[132:135],v[20:23],0
s_waitcnt lgkmcnt(1)
ds_read_b64_tr_b16 a[130:131],v4 offset:6400
v_fma_f32 v79,v79,s36,v13
v_mfma_f32_16x16x32_bf16 v[176:179],a[136:139],v[20:23],0
ds_read_b64_tr_b16 a[132:133],v5 offset:256
v_fma_f32 v84,v84,s36,v14
v_mfma_f32_16x16x32_bf16 v[180:183],a[140:143],v[20:23],0
ds_read_b64_tr_b16 a[134:135],v5 offset:6400
v_fma_f32 v85,v85,s36,v14
v_mfma_f32_16x16x32_bf16 v[228:231],a[140:143],v[24:27],0
v_exp_f32 v99,v99
v_mfma_f32_16x16x32_bf16 v[224:227],a[136:139],v[24:27],0
v_cvt_pk_bf16_f32 v57,v98,v99
v_fma_f32 v86,v86,s36,v14
v_mfma_f32_16x16x32_bf16 v[128:131],a[136:139],v[28:31],0
v_exp_f32 v104,v104
v_mfma_f32_16x16x32_bf16 v[132:135],a[140:143],v[28:31],0
v_exp_f32 v105,v105
v_mfma_f32_16x16x32_bf16 a[180:183],a[140:143],v[32:35],0
v_exp_f32 v106,v106
v_mfma_f32_16x16x32_bf16 a[176:179],a[136:139],v[32:35],0
v_exp_f32 v107,v107
v_mfma_f32_16x16x32_bf16 a[224:227],a[136:139],v[36:39],0
v_cvt_pk_bf16_f32 v40,v104,v105
v_cvt_pk_bf16_f32 v41,v106,v107
v_mfma_f32_16x16x32_bf16 a[228:231],a[140:143],v[36:39],0
v_exp_f32 v76,v76
v_mfma_f32_16x16x32_bf16 a[232:235],a[144:147],v[36:39],0
v_exp_f32 v77,v77
v_mfma_f32_16x16x32_bf16 a[236:239],a[148:151],v[36:39],0
v_exp_f32 v78,v78
v_mfma_f32_16x16x32_bf16 a[188:191],a[148:151],v[32:35],0
v_exp_f32 v79,v79
v_mfma_f32_16x16x32_bf16 a[184:187],a[144:147],v[32:35],0
v_cvt_pk_bf16_f32 v46,v76,v77
v_cvt_pk_bf16_f32 v47,v78,v79
v_mfma_f32_16x16x32_bf16 v[136:139],a[144:147],v[28:31],0
v_fma_f32 v87,v87,s36,v14
v_fma_f32 v92,v92,s36,v15
v_mfma_f32_16x16x32_bf16 v[140:143],a[148:151],v[28:31],0
v_exp_f32 v84,v84
v_mfma_f32_16x16x32_bf16 v[236:239],a[148:151],v[24:27],0
v_exp_f32 v85,v85
v_mfma_f32_16x16x32_bf16 v[232:235],a[144:147],v[24:27],0
v_exp_f32 v86,v86
v_mfma_f32_16x16x32_bf16 v[184:187],a[144:147],v[20:23],0
v_exp_f32 v87,v87
v_mfma_f32_16x16x32_bf16 v[188:191],a[148:151],v[20:23],0
v_cvt_pk_bf16_f32 v50,v84,v85
v_cvt_pk_bf16_f32 v51,v86,v87
v_mfma_f32_16x16x32_bf16 v[192:195],a[120:123],v[20:23],0
v_fma_f32 v93,v93,s36,v15
v_fma_f32 v94,v94,s36,v15
v_smfmac_f32_16x16x64_bf16 v[60:63],a[152:155],v[44:51],v18
v_fma_f32 v95,v95,s36,v15
v_mfma_f32_16x16x32_bf16 v[196:199],a[124:127],v[20:23],0
s_waitcnt vmcnt(30) lgkmcnt(0)
v_exp_f32 v92,v92
v_mfma_f32_16x16x32_bf16 v[244:247],a[124:127],v[24:27],0
s_barrier
v_mfma_f32_16x16x32_bf16 v[240:243],a[120:123],v[24:27],0
ds_read_b128 a[136:139],v0 offset:24576
v_fma_f32 v100,v100,s36,v16
v_mfma_f32_16x16x32_bf16 v[144:147],a[120:123],v[28:31],0
ds_read_b128 a[140:143],v1 offset:24576
v_fma_f32 v101,v101,s36,v16
v_mfma_f32_16x16x32_bf16 v[148:151],a[124:127],v[28:31],0
ds_read_b128 a[144:147],v0 offset:24704
v_fma_f32 v102,v102,s36,v16
v_mfma_f32_16x16x32_bf16 a[196:199],a[124:127],v[32:35],0
ds_read_b128 a[148:151],v1 offset:24704
v_fma_f32 v103,v103,s36,v16
v_mfma_f32_16x16x32_bf16 a[192:195],a[120:123],v[32:35],0
v_exp_f32 v93,v93
v_mfma_f32_16x16x32_bf16 a[240:243],a[120:123],v[36:39],0
buffer_load_dwordx4 v6,s[8:11],s21 offen offset:0 lds
v_mfma_f32_16x16x32_bf16 a[244:247],a[124:127],v[36:39],0
ds_read_b128 a[120:123],v0 offset:24832
v_cvt_pk_bf16_f32 v54,v92,v93
v_mfma_f32_16x16x32_bf16 a[248:251],a[128:131],v[36:39],0
ds_read_b128 a[124:127],v1 offset:24832
v_fma_f32 v108,v108,s36,v17
v_mfma_f32_16x16x32_bf16 a[252:255],a[132:135],v[36:39],0
v_exp_f32 v94,v94
v_mfma_f32_16x16x32_bf16 a[204:207],a[132:135],v[32:35],0
v_exp_f32 v95,v95
v_mfma_f32_16x16x32_bf16 a[200:203],a[128:131],v[32:35],0
v_cvt_pk_bf16_f32 v55,v94,v95
v_fma_f32 v109,v109,s36,v17
v_mfma_f32_16x16x32_bf16 v[152:155],a[128:131],v[28:31],0
v_exp_f32 v100,v100
v_mfma_f32_16x16x32_bf16 v[156:159],a[132:135],v[28:31],0
v_exp_f32 v101,v101
v_mfma_f32_16x16x32_bf16 v[252:255],a[132:135],v[24:27],0
v_exp_f32 v102,v102
v_mfma_f32_16x16x32_bf16 v[248:251],a[128:131],v[24:27],0
v_exp_f32 v103,v103
v_mfma_f32_16x16x32_bf16 v[200:203],a[128:131],v[20:23],0
ds_read_b128 a[128:131],v0 offset:30720
v_cvt_pk_bf16_f32 v58,v100,v101
v_mfma_f32_16x16x32_bf16 v[204:207],a[132:135],v[20:23],0
buffer_load_dwordx4 v7,s[8:11],s21 offen offset:1024 lds
s_waitcnt lgkmcnt(1)
v_mfma_f32_16x16x32_bf16 v[72:75],a[136:139],a[0:3],0
ds_read_b128 a[132:135],v1 offset:30720
v_cvt_pk_bf16_f32 v59,v102,v103
v_mfma_f32_16x16x32_bf16 v[72:75],a[140:143],a[4:7],v[72:75]
v_fma_f32 v110,v110,s36,v17
v_fma_f32 v111,v111,s36,v17
v_smfmac_f32_16x16x64_bf16 v[64:67],a[152:155],v[52:59],v18
v_mfma_f32_16x16x32_bf16 v[72:75],a[144:147],a[8:11],v[72:75]
v_exp_f32 v108,v108
v_mfma_f32_16x16x32_bf16 v[72:75],a[148:151],a[12:15],v[72:75]
v_exp_f32 v109,v109
v_mfma_f32_16x16x32_bf16 v[72:75],a[120:123],a[16:19],v[72:75]
v_exp_f32 v110,v110
v_mfma_f32_16x16x32_bf16 v[72:75],a[124:127],a[20:23],v[72:75]
v_exp_f32 v111,v111
v_mfma_f32_16x16x32_bf16 v[80:83],a[124:127],a[44:47],0
v_cvt_pk_bf16_f32 v42,v108,v109
v_cvt_pk_bf16_f32 v43,v110,v111
v_mfma_f32_16x16x32_bf16 v[80:83],a[120:123],a[40:43],v[80:83]
v_mfma_f32_16x16x32_bf16 v[80:83],a[148:151],a[36:39],v[80:83]
v_smfmac_f32_16x16x64_bf16 v[68:71],a[152:155],v[36:43],v18
buffer_load_dwordx4 v8,s[8:11],s21 offen offset:2048 lds
v_mfma_f32_16x16x32_bf16 v[80:83],a[144:147],a[32:35],v[80:83]
s_add_u32 s21,s21,12288
v_fma_f32 v72,v72,s36,v13
v_fma_f32 v73,v73,s36,v13
v_mfma_f32_16x16x32_bf16 v[80:83],a[140:143],a[28:31],v[80:83]
s_add_u32 m0,s22,12288
v_fma_f32 v74,v74,s36,v13
v_fma_f32 v75,v75,s36,v13
v_mfma_f32_16x16x32_bf16 v[80:83],a[136:139],a[24:27],v[80:83]
v_exp_f32 v72,v72
v_mfma_f32_16x16x32_bf16 v[88:91],a[136:139],a[48:51],0
v_exp_f32 v73,v73
v_mfma_f32_16x16x32_bf16 v[88:91],a[140:143],a[52:55],v[88:91]
v_exp_f32 v74,v74
v_mfma_f32_16x16x32_bf16 v[88:91],a[144:147],a[56:59],v[88:91]
v_exp_f32 v75,v75
v_mfma_f32_16x16x32_bf16 v[88:91],a[148:151],a[60:63],v[88:91]
v_fma_f32 v80,v80,s36,v14
v_fma_f32 v81,v81,s36,v14
v_mfma_f32_16x16x32_bf16 v[88:91],a[120:123],a[64:67],v[88:91]
v_fma_f32 v82,v82,s36,v14
v_fma_f32 v83,v83,s36,v14
v_mfma_f32_16x16x32_bf16 v[88:91],a[124:127],a[68:71],v[88:91]
v_exp_f32 v80,v80
v_mfma_f32_16x16x32_bf16 v[96:99],a[124:127],a[92:95],0
v_exp_f32 v81,v81
v_mfma_f32_16x16x32_bf16 v[96:99],a[120:123],a[88:91],v[96:99]
buffer_load_dwordx4 v6,s[4:7],s20 offen offset:0 lds
v_mfma_f32_16x16x32_bf16 v[96:99],a[148:151],a[84:87],v[96:99]
v_exp_f32 v82,v82
v_mfma_f32_16x16x32_bf16 v[96:99],a[144:147],a[80:83],v[96:99]
v_fma_f32 v88,v88,s36,v15
v_fma_f32 v89,v89,s36,v15
v_mfma_f32_16x16x32_bf16 v[96:99],a[140:143],a[76:79],v[96:99]
v_exp_f32 v83,v83
v_mfma_f32_16x16x32_bf16 v[96:99],a[136:139],a[72:75],v[96:99]
v_exp_f32 v88,v88
v_mfma_f32_16x16x32_bf16 v[104:107],a[136:139],a[96:99],0
ds_read_b128 a[136:139],v0 offset:30848
v_cvt_pk_bf16_f32 v20,v72,v73
v_mfma_f32_16x16x32_bf16 v[104:107],a[140:143],a[100:103],v[104:107]
ds_read_b128 a[140:143],v1 offset:30848
v_cvt_pk_bf16_f32 v21,v74,v75
v_mfma_f32_16x16x32_bf16 v[104:107],a[144:147],a[104:107],v[104:107]
ds_read_b128 a[144:147],v0 offset:30976
v_cvt_pk_bf16_f32 v24,v80,v81
v_mfma_f32_16x16x32_bf16 v[104:107],a[148:151],a[108:111],v[104:107]
ds_read_b128 a[148:151],v1 offset:30976
v_cvt_pk_bf16_f32 v25,v82,v83
v_mfma_f32_16x16x32_bf16 v[104:107],a[120:123],a[112:115],v[104:107]
v_exp_f32 v89,v89
v_mfma_f32_16x16x32_bf16 v[104:107],a[124:127],a[116:119],v[104:107]
s_waitcnt lgkmcnt(4)
v_cvt_pk_bf16_f32 v28,v88,v89
v_mfma_f32_16x16x32_bf16 v[76:79],a[128:131],a[0:3],0
v_mfma_f32_16x16x32_bf16 v[76:79],a[132:135],a[4:7],v[76:79]
buffer_load_dwordx4 v7,s[4:7],s20 offen offset:1024 lds
s_waitcnt lgkmcnt(3)
v_mfma_f32_16x16x32_bf16 v[76:79],a[136:139],a[8:11],v[76:79]
s_waitcnt lgkmcnt(2)
v_mfma_f32_16x16x32_bf16 v[76:79],a[140:143],a[12:15],v[76:79]
s_waitcnt lgkmcnt(1)
v_mfma_f32_16x16x32_bf16 v[76:79],a[144:147],a[16:19],v[76:79]
s_waitcnt lgkmcnt(0)
v_mfma_f32_16x16x32_bf16 v[76:79],a[148:151],a[20:23],v[76:79]
v_mfma_f32_16x16x32_bf16 v[84:87],a[148:151],a[44:47],0
v_mfma_f32_16x16x32_bf16 v[84:87],a[144:147],a[40:43],v[84:87]
v_mfma_f32_16x16x32_bf16 v[84:87],a[140:143],a[36:39],v[84:87]
v_mfma_f32_16x16x32_bf16 v[84:87],a[136:139],a[32:35],v[84:87]
v_mfma_f32_16x16x32_bf16 v[84:87],a[132:135],a[28:31],v[84:87]
v_mfma_f32_16x16x32_bf16 v[84:87],a[128:131],a[24:27],v[84:87]
v_mfma_f32_16x16x32_bf16 v[92:95],a[128:131],a[48:51],0
buffer_load_dwordx4 v8,s[4:7],s20 offen offset:2048 lds
v_mfma_f32_16x16x32_bf16 v[92:95],a[132:135],a[52:55],v[92:95]
s_add_u32 s20,s20,12288
v_mfma_f32_16x16x32_bf16 v[92:95],a[136:139],a[56:59],v[92:95]
v_mfma_f32_16x16x32_bf16 v[92:95],a[140:143],a[60:63],v[92:95]
v_mfma_f32_16x16x32_bf16 v[92:95],a[144:147],a[64:67],v[92:95]
v_mfma_f32_16x16x32_bf16 v[92:95],a[148:151],a[68:71],v[92:95]
ds_read_b64_tr_b16 a[120:121],v2 offset:12288
v_mfma_f32_16x16x32_bf16 v[100:103],a[148:151],a[92:95],0
ds_read_b64_tr_b16 a[122:123],v2 offset:18432
v_mfma_f32_16x16x32_bf16 v[100:103],a[144:147],a[88:91],v[100:103]
v_mfma_f32_16x16x32_bf16 v[100:103],a[140:143],a[84:87],v[100:103]
ds_read_b64_tr_b16 a[124:125],v3 offset:12288
v_mfma_f32_16x16x32_bf16 v[100:103],a[136:139],a[80:83],v[100:103]
ds_read_b64_tr_b16 a[126:127],v3 offset:18432
v_mfma_f32_16x16x32_bf16 v[100:103],a[132:135],a[76:79],v[100:103]
v_mfma_f32_16x16x32_bf16 v[100:103],a[128:131],a[72:75],v[100:103]
v_mfma_f32_16x16x32_bf16 v[108:111],a[128:131],a[96:99],0
ds_read_b64_tr_b16 a[128:129],v4 offset:12288
v_mfma_f32_16x16x32_bf16 v[108:111],a[132:135],a[100:103],v[108:111]
ds_read_b64_tr_b16 a[130:131],v4 offset:18432
v_mfma_f32_16x16x32_bf16 v[108:111],a[136:139],a[104:107],v[108:111]
ds_read_b64_tr_b16 a[132:133],v5 offset:12288
v_mfma_f32_16x16x32_bf16 v[108:111],a[140:143],a[108:111],v[108:111]
ds_read_b64_tr_b16 a[134:135],v5 offset:18432
v_mfma_f32_16x16x32_bf16 v[108:111],a[144:147],a[112:115],v[108:111]
v_mfma_f32_16x16x32_bf16 v[108:111],a[148:151],a[116:119],v[108:111]
s_waitcnt lgkmcnt(4)
v_mfma_f32_16x16x32_bf16 v[160:163],a[120:123],v[44:47],v[160:163]
s_add_u32 m0,s23,12288
ds_read_b64_tr_b16 a[136:137],v2 offset:12416
v_fma_f32 v90,v90,s36,v15
v_mfma_f32_16x16x32_bf16 v[164:167],a[124:127],v[44:47],v[164:167]
ds_read_b64_tr_b16 a[138:139],v2 offset:18560
v_fma_f32 v91,v91,s36,v15
v_mfma_f32_16x16x32_bf16 v[212:215],a[124:127],v[48:51],v[212:215]
ds_read_b64_tr_b16 a[140:141],v3 offset:12416
v_fma_f32 v96,v96,s36,v16
v_mfma_f32_16x16x32_bf16 v[208:211],a[120:123],v[48:51],v[208:211]
ds_read_b64_tr_b16 a[142:143],v3 offset:18560
v_fma_f32 v97,v97,s36,v16
v_mfma_f32_16x16x32_bf16 v[112:115],a[120:123],v[52:55],v[112:115]
ds_read_b64_tr_b16 a[144:145],v4 offset:12416
v_fma_f32 v98,v98,s36,v16
v_mfma_f32_16x16x32_bf16 v[116:119],a[124:127],v[52:55],v[116:119]
ds_read_b64_tr_b16 a[146:147],v4 offset:18560
v_fma_f32 v99,v99,s36,v16
v_mfma_f32_16x16x32_bf16 a[164:167],a[124:127],v[56:59],a[164:167]
ds_read_b64_tr_b16 a[148:149],v5 offset:12416
v_fma_f32 v104,v104,s36,v17
v_mfma_f32_16x16x32_bf16 a[160:163],a[120:123],v[56:59],a[160:163]
ds_read_b64_tr_b16 a[150:151],v5 offset:18560
v_fma_f32 v105,v105,s36,v17
v_mfma_f32_16x16x32_bf16 a[208:211],a[120:123],v[40:43],a[208:211]
ds_read_b64_tr_b16 a[120:121],v2 offset:12544
v_fma_f32 v106,v106,s36,v17
v_mfma_f32_16x16x32_bf16 a[212:215],a[124:127],v[40:43],a[212:215]
s_waitcnt lgkmcnt(6)
ds_read_b64_tr_b16 a[122:123],v2 offset:18688
v_fma_f32 v107,v107,s36,v17
v_mfma_f32_16x16x32_bf16 a[216:219],a[128:131],v[40:43],a[216:219]
ds_read_b64_tr_b16 a[124:125],v3 offset:12544
v_fma_f32 v76,v76,s36,v13
v_mfma_f32_16x16x32_bf16 a[220:223],a[132:135],v[40:43],a[220:223]
ds_read_b64_tr_b16 a[126:127],v3 offset:18688
v_fma_f32 v77,v77,s36,v13
v_mfma_f32_16x16x32_bf16 a[172:175],a[132:135],v[56:59],a[172:175]
v_exp_f32 v90,v90
v_mfma_f32_16x16x32_bf16 a[168:171],a[128:131],v[56:59],a[168:171]
v_exp_f32 v91,v91
v_mfma_f32_16x16x32_bf16 v[120:123],a[128:131],v[52:55],v[120:123]
v_cvt_pk_bf16_f32 v29,v90,v91
v_fma_f32 v78,v78,s36,v13
v_mfma_f32_16x16x32_bf16 v[124:127],a[132:135],v[52:55],v[124:127]
v_exp_f32 v96,v96
v_mfma_f32_16x16x32_bf16 v[220:223],a[132:135],v[48:51],v[220:223]
v_exp_f32 v97,v97
v_mfma_f32_16x16x32_bf16 v[216:219],a[128:131],v[48:51],v[216:219]
v_exp_f32 v98,v98
v_mfma_f32_16x16x32_bf16 v[168:171],a[128:131],v[44:47],v[168:171]
ds_read_b64_tr_b16 a[128:129],v4 offset:12544
v_cvt_pk_bf16_f32 v32,v96,v97
v_mfma_f32_16x16x32_bf16 v[172:175],a[132:135],v[44:47],v[172:175]
ds_read_b64_tr_b16 a[130:131],v4 offset:18688
v_fma_f32 v79,v79,s36,v13
v_mfma_f32_16x16x32_bf16 v[176:179],a[136:139],v[44:47],v[176:179]
s_waitcnt lgkmcnt(2)
ds_read_b64_tr_b16 a[132:133],v5 offset:12544
v_fma_f32 v84,v84,s36,v14
v_mfma_f32_16x16x32_bf16 v[180:183],a[140:143],v[44:47],v[180:183]
ds_read_b64_tr_b16 a[134:135],v5 offset:18688
v_fma_f32 v85,v85,s36,v14
v_mfma_f32_16x16x32_bf16 v[228:231],a[140:143],v[48:51],v[228:231]
v_exp_f32 v99,v99
v_mfma_f32_16x16x32_bf16 v[224:227],a[136:139],v[48:51],v[224:227]
v_cvt_pk_bf16_f32 v33,v98,v99
v_fma_f32 v86,v86,s36,v14
v_mfma_f32_16x16x32_bf16 v[128:131],a[136:139],v[52:55],v[128:131]
v_exp_f32 v104,v104
v_mfma_f32_16x16x32_bf16 v[132:135],a[140:143],v[52:55],v[132:135]
v_exp_f32 v105,v105
v_mfma_f32_16x16x32_bf16 a[180:183],a[140:143],v[56:59],a[180:183]
v_exp_f32 v106,v106
v_mfma_f32_16x16x32_bf16 a[176:179],a[136:139],v[56:59],a[176:179]
v_exp_f32 v107,v107
v_mfma_f32_16x16x32_bf16 a[224:227],a[136:139],v[40:43],a[224:227]
v_cvt_pk_bf16_f32 v36,v104,v105
v_cvt_pk_bf16_f32 v37,v106,v107
v_mfma_f32_16x16x32_bf16 a[228:231],a[140:143],v[40:43],a[228:231]
v_exp_f32 v76,v76
v_mfma_f32_16x16x32_bf16 a[232:235],a[144:147],v[40:43],a[232:235]
v_exp_f32 v77,v77
v_mfma_f32_16x16x32_bf16 a[236:239],a[148:151],v[40:43],a[236:239]
v_exp_f32 v78,v78
v_mfma_f32_16x16x32_bf16 a[188:191],a[148:151],v[56:59],a[188:191]
v_exp_f32 v79,v79
v_mfma_f32_16x16x32_bf16 a[184:187],a[144:147],v[56:59],a[184:187]
v_cvt_pk_bf16_f32 v22,v76,v77
v_cvt_pk_bf16_f32 v23,v78,v79
v_mfma_f32_16x16x32_bf16 v[136:139],a[144:147],v[52:55],v[136:139]
v_fma_f32 v87,v87,s36,v14
v_fma_f32 v92,v92,s36,v15
v_mfma_f32_16x16x32_bf16 v[140:143],a[148:151],v[52:55],v[140:143]
v_exp_f32 v84,v84
v_mfma_f32_16x16x32_bf16 v[236:239],a[148:151],v[48:51],v[236:239]
v_exp_f32 v85,v85
v_mfma_f32_16x16x32_bf16 v[232:235],a[144:147],v[48:51],v[232:235]
v_exp_f32 v86,v86
v_mfma_f32_16x16x32_bf16 v[184:187],a[144:147],v[44:47],v[184:187]
v_exp_f32 v87,v87
v_mfma_f32_16x16x32_bf16 v[188:191],a[148:151],v[44:47],v[188:191]
v_cvt_pk_bf16_f32 v26,v84,v85
v_cvt_pk_bf16_f32 v27,v86,v87
v_mfma_f32_16x16x32_bf16 v[192:195],a[120:123],v[44:47],v[192:195]
v_fma_f32 v93,v93,s36,v15
v_fma_f32 v94,v94,s36,v15
v_smfmac_f32_16x16x64_bf16 v[60:63],a[152:155],v[20:27],v18
v_fma_f32 v95,v95,s36,v15
v_mfma_f32_16x16x32_bf16 v[196:199],a[124:127],v[44:47],v[196:199]
s_waitcnt vmcnt(6) lgkmcnt(0)
v_exp_f32 v92,v92
v_mfma_f32_16x16x32_bf16 v[244:247],a[124:127],v[48:51],v[244:247]
s_barrier
v_mfma_f32_16x16x32_bf16 v[240:243],a[120:123],v[48:51],v[240:243]
ds_read_b128 a[136:139],v0 offset:0
v_fma_f32 v100,v100,s36,v16
v_mfma_f32_16x16x32_bf16 v[144:147],a[120:123],v[52:55],v[144:147]
ds_read_b128 a[140:143],v1 offset:0
v_fma_f32 v101,v101,s36,v16
v_mfma_f32_16x16x32_bf16 v[148:151],a[124:127],v[52:55],v[148:151]
ds_read_b128 a[144:147],v0 offset:128
v_fma_f32 v102,v102,s36,v16
v_mfma_f32_16x16x32_bf16 a[196:199],a[124:127],v[56:59],a[196:199]
ds_read_b128 a[148:151],v1 offset:128
v_fma_f32 v103,v103,s36,v16
v_mfma_f32_16x16x32_bf16 a[192:195],a[120:123],v[56:59],a[192:195]
v_exp_f32 v93,v93
v_mfma_f32_16x16x32_bf16 a[240:243],a[120:123],v[40:43],a[240:243]
buffer_load_dwordx4 v6,s[8:11],s21 offen offset:0 lds
v_mfma_f32_16x16x32_bf16 a[244:247],a[124:127],v[40:43],a[244:247]
ds_read_b128 a[120:123],v0 offset:256
v_cvt_pk_bf16_f32 v30,v92,v93
v_mfma_f32_16x16x32_bf16 a[248:251],a[128:131],v[40:43],a[248:251]
ds_read_b128 a[124:127],v1 offset:256
v_fma_f32 v108,v108,s36,v17
v_mfma_f32_16x16x32_bf16 a[252:255],a[132:135],v[40:43],a[252:255]
v_exp_f32 v94,v94
v_mfma_f32_16x16x32_bf16 a[204:207],a[132:135],v[56:59],a[204:207]
v_exp_f32 v95,v95
v_mfma_f32_16x16x32_bf16 a[200:203],a[128:131],v[56:59],a[200:203]
v_cvt_pk_bf16_f32 v31,v94,v95
v_fma_f32 v109,v109,s36,v17
v_mfma_f32_16x16x32_bf16 v[152:155],a[128:131],v[52:55],v[152:155]
v_exp_f32 v100,v100
v_mfma_f32_16x16x32_bf16 v[156:159],a[132:135],v[52:55],v[156:159]
v_exp_f32 v101,v101
v_mfma_f32_16x16x32_bf16 v[252:255],a[132:135],v[48:51],v[252:255]
v_exp_f32 v102,v102
v_mfma_f32_16x16x32_bf16 v[248:251],a[128:131],v[48:51],v[248:251]
v_exp_f32 v103,v103
v_mfma_f32_16x16x32_bf16 v[200:203],a[128:131],v[44:47],v[200:203]
ds_read_b128 a[128:131],v0 offset:6144
v_cvt_pk_bf16_f32 v34,v100,v101
v_mfma_f32_16x16x32_bf16 v[204:207],a[132:135],v[44:47],v[204:207]
buffer_load_dwordx4 v7,s[8:11],s21 offen offset:1024 lds
s_waitcnt lgkmcnt(1)
v_mfma_f32_16x16x32_bf16 v[72:75],a[136:139],a[0:3],0
ds_read_b128 a[132:135],v1 offset:6144
v_cvt_pk_bf16_f32 v35,v102,v103
v_mfma_f32_16x16x32_bf16 v[72:75],a[140:143],a[4:7],v[72:75]
v_fma_f32 v110,v110,s36,v17
v_fma_f32 v111,v111,s36,v17
v_smfmac_f32_16x16x64_bf16 v[64:67],a[152:155],v[28:35],v18
v_mfma_f32_16x16x32_bf16 v[72:75],a[144:147],a[8:11],v[72:75]
v_exp_f32 v108,v108
v_mfma_f32_16x16x32_bf16 v[72:75],a[148:151],a[12:15],v[72:75]
v_exp_f32 v109,v109
v_mfma_f32_16x16x32_bf16 v[72:75],a[120:123],a[16:19],v[72:75]
v_exp_f32 v110,v110
v_mfma_f32_16x16x32_bf16 v[72:75],a[124:127],a[20:23],v[72:75]
v_exp_f32 v111,v111
v_mfma_f32_16x16x32_bf16 v[80:83],a[124:127],a[44:47],0
v_cvt_pk_bf16_f32 v38,v108,v109
v_cvt_pk_bf16_f32 v39,v110,v111
v_mfma_f32_16x16x32_bf16 v[80:83],a[120:123],a[40:43],v[80:83]
v_mfma_f32_16x16x32_bf16 v[80:83],a[148:151],a[36:39],v[80:83]
v_mfma_f32_16x16x32_bf16 v[80:83],a[144:147],a[32:35],v[80:83]
buffer_load_dwordx4 v8,s[8:11],s21 offen offset:2048 lds
v_mfma_f32_16x16x32_bf16 v[80:83],a[140:143],a[28:31],v[80:83]
s_add_u32 s21,s21,12288
v_fma_f32 v72,v72,s36,v13
v_fma_f32 v73,v73,s36,v13
v_mfma_f32_16x16x32_bf16 v[80:83],a[136:139],a[24:27],v[80:83]
s_add_u32 m0,s22,24576
v_fma_f32 v74,v74,s36,v13
v_fma_f32 v75,v75,s36,v13
v_mfma_f32_16x16x32_bf16 v[88:91],a[136:139],a[48:51],0
v_exp_f32 v72,v72
v_mfma_f32_16x16x32_bf16 v[88:91],a[140:143],a[52:55],v[88:91]
v_exp_f32 v73,v73
v_mfma_f32_16x16x32_bf16 v[88:91],a[144:147],a[56:59],v[88:91]
v_fma_f32 v80,v80,s36,v14
v_fma_f32 v81,v81,s36,v14
v_mfma_f32_16x16x32_bf16 v[88:91],a[148:151],a[60:63],v[88:91]
v_fma_f32 v82,v82,s36,v14
v_fma_f32 v83,v83,s36,v14
v_mfma_f32_16x16x32_bf16 v[88:91],a[120:123],a[64:67],v[88:91]
v_exp_f32 v74,v74
v_mfma_f32_16x16x32_bf16 v[88:91],a[124:127],a[68:71],v[88:91]
v_exp_f32 v75,v75
v_mfma_f32_16x16x32_bf16 v[96:99],a[124:127],a[92:95],0
v_exp_f32 v80,v80
v_mfma_f32_16x16x32_bf16 v[96:99],a[120:123],a[88:91],v[96:99]
v_exp_f32 v81,v81
v_mfma_f32_16x16x32_bf16 v[96:99],a[148:151],a[84:87],v[96:99]
v_exp_f32 v82,v82
v_mfma_f32_16x16x32_bf16 v[96:99],a[144:147],a[80:83],v[96:99]
buffer_load_dwordx4 v6,s[4:7],s20 offen offset:0 lds
v_mfma_f32_16x16x32_bf16 v[96:99],a[140:143],a[76:79],v[96:99]
v_fma_f32 v88,v88,s36,v15
v_fma_f32 v89,v89,s36,v15
v_mfma_f32_16x16x32_bf16 v[96:99],a[136:139],a[72:75],v[96:99]
v_exp_f32 v83,v83
v_mfma_f32_16x16x32_bf16 v[104:107],a[136:139],a[96:99],0
ds_read_b128 a[136:139],v0 offset:6272
v_cvt_pk_bf16_f32 v44,v72,v73
v_mfma_f32_16x16x32_bf16 v[104:107],a[140:143],a[100:103],v[104:107]
ds_read_b128 a[140:143],v1 offset:6272
v_cvt_pk_bf16_f32 v45,v74,v75
v_mfma_f32_16x16x32_bf16 v[104:107],a[144:147],a[104:107],v[104:107]
ds_read_b128 a[144:147],v0 offset:6400
v_cvt_pk_bf16_f32 v48,v80,v81
v_mfma_f32_16x16x32_bf16 v[104:107],a[148:151],a[108:111],v[104:107]
ds_read_b128 a[148:151],v1 offset:6400
v_cvt_pk_bf16_f32 v49,v82,v83
v_mfma_f32_16x16x32_bf16 v[104:107],a[120:123],a[112:115],v[104:107]
v_exp_f32 v88,v88
v_mfma_f32_16x16x32_bf16 v[104:107],a[124:127],a[116:119],v[104:107]
s_waitcnt lgkmcnt(4)
v_exp_f32 v89,v89
v_mfma_f32_16x16x32_bf16 v[76:79],a[128:131],a[0:3],0
v_cvt_pk_bf16_f32 v52,v88,v89
v_mfma_f32_16x16x32_bf16 v[76:79],a[132:135],a[4:7],v[76:79]
s_waitcnt lgkmcnt(3)
v_mfma_f32_16x16x32_bf16 v[76:79],a[136:139],a[8:11],v[76:79]
buffer_load_dwordx4 v7,s[4:7],s20 offen offset:1024 lds
s_waitcnt lgkmcnt(2)
v_mfma_f32_16x16x32_bf16 v[76:79],a[140:143],a[12:15],v[76:79]
s_waitcnt lgkmcnt(1)
v_mfma_f32_16x16x32_bf16 v[76:79],a[144:147],a[16:19],v[76:79]
s_waitcnt lgkmcnt(0)
v_mfma_f32_16x16x32_bf16 v[76:79],a[148:151],a[20:23],v[76:79]
v_mfma_f32_16x16x32_bf16 v[84:87],a[148:151],a[44:47],0
v_mfma_f32_16x16x32_bf16 v[84:87],a[144:147],a[40:43],v[84:87]
v_mfma_f32_16x16x32_bf16 v[84:87],a[140:143],a[36:39],v[84:87]
v_mfma_f32_16x16x32_bf16 v[84:87],a[136:139],a[32:35],v[84:87]
v_mfma_f32_16x16x32_bf16 v[84:87],a[132:135],a[28:31],v[84:87]
v_mfma_f32_16x16x32_bf16 v[84:87],a[128:131],a[24:27],v[84:87]
v_mfma_f32_16x16x32_bf16 v[92:95],a[128:131],a[48:51],0
v_mfma_f32_16x16x32_bf16 v[92:95],a[132:135],a[52:55],v[92:95]
buffer_load_dwordx4 v8,s[4:7],s20 offen offset:2048 lds
v_mfma_f32_16x16x32_bf16 v[92:95],a[136:139],a[56:59],v[92:95]
s_add_u32 s20,s20,12288
v_mfma_f32_16x16x32_bf16 v[92:95],a[140:143],a[60:63],v[92:95]
v_mfma_f32_16x16x32_bf16 v[92:95],a[144:147],a[64:67],v[92:95]
v_mfma_f32_16x16x32_bf16 v[92:95],a[148:151],a[68:71],v[92:95]
v_mfma_f32_16x16x32_bf16 v[100:103],a[148:151],a[92:95],0
v_mfma_f32_16x16x32_bf16 v[100:103],a[144:147],a[88:91],v[100:103]
ds_read_b64_tr_b16 a[120:121],v2 offset:24576
v_mfma_f32_16x16x32_bf16 v[100:103],a[140:143],a[84:87],v[100:103]
ds_read_b64_tr_b16 a[122:123],v2 offset:30720
v_mfma_f32_16x16x32_bf16 v[100:103],a[136:139],a[80:83],v[100:103]
ds_read_b64_tr_b16 a[124:125],v3 offset:24576
v_mfma_f32_16x16x32_bf16 v[100:103],a[132:135],a[76:79],v[100:103]
ds_read_b64_tr_b16 a[126:127],v3 offset:30720
v_mfma_f32_16x16x32_bf16 v[100:103],a[128:131],a[72:75],v[100:103]
v_mfma_f32_16x16x32_bf16 v[108:111],a[128:131],a[96:99],0
ds_read_b64_tr_b16 a[128:129],v4 offset:24576
v_mfma_f32_16x16x32_bf16 v[108:111],a[132:135],a[100:103],v[108:111]
ds_read_b64_tr_b16 a[130:131],v4 offset:30720
v_mfma_f32_16x16x32_bf16 v[108:111],a[136:139],a[104:107],v[108:111]
ds_read_b64_tr_b16 a[132:133],v5 offset:24576
v_mfma_f32_16x16x32_bf16 v[108:111],a[140:143],a[108:111],v[108:111]
ds_read_b64_tr_b16 a[134:135],v5 offset:30720
v_mfma_f32_16x16x32_bf16 v[108:111],a[144:147],a[112:115],v[108:111]
v_mfma_f32_16x16x32_bf16 v[108:111],a[148:151],a[116:119],v[108:111]
s_mov_b32 s38,0
s_branch L_loop5
L_tr44:
s_waitcnt vmcnt(42)
s_waitcnt lgkmcnt(3)
v_mfma_f32_16x16x32_bf16 v[160:163],a[120:123],v[20:23],v[160:163]
s_add_u32 m0,s24,0
ds_read_b128 a[4:7],v12 offset:0
v_fma_f32 v79,v79,s36,v13
v_mfma_f32_16x16x32_bf16 v[164:167],a[124:127],v[20:23],v[164:167]
ds_read_b128 a[12:15],v12 offset:128
v_fma_f32 v100,v100,s36,v16
v_mfma_f32_16x16x32_bf16 v[212:215],a[124:127],v[24:27],v[212:215]
ds_read_b128 a[20:23],v12 offset:256
v_fma_f32 v101,v101,s36,v16
v_mfma_f32_16x16x32_bf16 v[208:211],a[120:123],v[24:27],v[208:211]
ds_read_b128 a[8:11],v11 offset:128
v_fma_f32 v89,v89,s36,v15
v_mfma_f32_16x16x32_bf16 v[112:115],a[120:123],v[28:31],v[112:115]
ds_read_b128 a[0:3],v11 offset:0
v_fma_f32 v76,v76,s36,v13
v_mfma_f32_16x16x32_bf16 v[116:119],a[124:127],v[28:31],v[116:119]
ds_read_b128 a[16:19],v11 offset:256
v_fma_f32 v83,v83,s36,v14
v_mfma_f32_16x16x32_bf16 a[164:167],a[124:127],v[32:35],a[164:167]
ds_read_b64_tr_b16 a[138:139],v2 offset:30848
v_fma_f32 v90,v90,s36,v15
v_mfma_f32_16x16x32_bf16 a[160:163],a[120:123],v[32:35],a[160:163]
s_waitcnt lgkmcnt(6)
ds_read_b64_tr_b16 a[136:137],v2 offset:24704
v_fma_f32 v88,v88,s36,v15
v_mfma_f32_16x16x32_bf16 a[168:171],a[128:131],v[32:35],a[168:171]
ds_read_b64_tr_b16 a[142:143],v3 offset:30848
ds_read_b64_tr_b16 a[140:141],v3 offset:24704
ds_read_b64_tr_b16 a[146:147],v4 offset:30848
ds_read_b64_tr_b16 a[144:145],v4 offset:24704
ds_read_b64_tr_b16 a[150:151],v5 offset:30848
ds_read_b64_tr_b16 a[148:149],v5 offset:24704
ds_read_b128 a[32:35],v11 offset:6272
v_mfma_f32_16x16x32_bf16 a[172:175],a[132:135],v[32:35],a[172:175]
v_fma_f32 v91,v91,s36,v15
ds_read_b128 a[40:43],v11 offset:6400
v_mfma_f32_16x16x32_bf16 v[124:127],a[132:135],v[28:31],v[124:127]
s_waitcnt lgkmcnt(10)
buffer_load_dwordx4 v6,s[12:15],s28 offen offset:0 nt lds
v_mfma_f32_16x16x32_bf16 v[120:123],a[128:131],v[28:31],v[120:123]
ds_read_b64_tr_b16 a[122:123],v2 offset:30976
ds_read_b64_tr_b16 a[120:121],v2 offset:24832
ds_read_b64_tr_b16 a[124:125],v3 offset:24832
ds_read_b64_tr_b16 a[126:127],v3 offset:30976
ds_read_b128 a[44:47],v12 offset:6400
v_mfma_f32_16x16x32_bf16 v[216:219],a[128:131],v[24:27],v[216:219]
v_fma_f32 v93,v93,s36,v15
ds_read_b128 a[28:31],v12 offset:6144
v_mfma_f32_16x16x32_bf16 v[220:223],a[132:135],v[24:27],v[220:223]
v_fma_f32 v98,v98,s36,v16
ds_read_b128 a[36:39],v12 offset:6272
v_mfma_f32_16x16x32_bf16 v[172:175],a[132:135],v[20:23],v[172:175]
buffer_load_dwordx4 v7,s[12:15],s28 offen offset:1024 nt lds
v_mfma_f32_16x16x32_bf16 v[168:171],a[128:131],v[20:23],v[168:171]
s_waitcnt lgkmcnt(7)
ds_read_b64_tr_b16 a[130:131],v4 offset:30976
ds_read_b128 a[24:27],v11 offset:6144
v_mfma_f32_16x16x32_bf16 v[176:179],a[136:139],v[20:23],v[176:179]
v_fma_f32 v82,v82,s36,v14
v_exp_f32 v93,v93
v_mfma_f32_16x16x32_bf16 v[180:183],a[140:143],v[20:23],v[180:183]
ds_read_b64_tr_b16 a[128:129],v4 offset:24832
v_fma_f32 v85,v85,s36,v14
v_mfma_f32_16x16x32_bf16 v[228:231],a[140:143],v[24:27],v[228:231]
ds_read_b64_tr_b16 a[134:135],v5 offset:30976
v_exp_f32 v82,v82
v_mfma_f32_16x16x32_bf16 v[224:227],a[136:139],v[24:27],v[224:227]
ds_read_b64_tr_b16 a[132:133],v5 offset:24832
v_fma_f32 v84,v84,s36,v14
v_mfma_f32_16x16x32_bf16 v[128:131],a[136:139],v[28:31],v[128:131]
v_exp_f32 v84,v84
v_mfma_f32_16x16x32_bf16 v[132:135],a[140:143],v[28:31],v[132:135]
buffer_load_dwordx4 v8,s[12:15],s28 offen offset:2048 nt lds
v_mfma_f32_16x16x32_bf16 a[180:183],a[140:143],v[32:35],a[180:183]
s_add_u32 s28,s28,3072
v_fma_f32 v103,v103,s36,v16
v_exp_f32 v103,v103
v_mfma_f32_16x16x32_bf16 a[176:179],a[136:139],v[32:35],a[176:179]
s_add_u32 m0,s24,3072
v_fma_f32 v87,v87,s36,v14
v_exp_f32 v87,v87
v_mfma_f32_16x16x32_bf16 a[184:187],a[144:147],v[32:35],a[184:187]
v_fma_f32 v77,v77,s36,v13
v_exp_f32 v77,v77
v_mfma_f32_16x16x32_bf16 a[188:191],a[148:151],v[32:35],a[188:191]
v_fma_f32 v97,v97,s36,v16
v_exp_f32 v91,v91
v_mfma_f32_16x16x32_bf16 v[140:143],a[148:151],v[28:31],v[140:143]
v_fma_f32 v102,v102,s36,v16
v_exp_f32 v85,v85
v_mfma_f32_16x16x32_bf16 v[136:139],a[144:147],v[28:31],v[136:139]
v_exp_f32 v89,v89
v_mfma_f32_16x16x32_bf16 v[232:235],a[144:147],v[24:27],v[232:235]
buffer_load_dwordx4 v6,s[12:15],s28 offen offset:0 nt lds
v_mfma_f32_16x16x32_bf16 v[236:239],a[148:151],v[24:27],v[236:239]
v_fma_f32 v92,v92,s36,v15
v_exp_f32 v101,v101
v_mfma_f32_16x16x32_bf16 v[188:191],a[148:151],v[20:23],v[188:191]
v_fma_f32 v94,v94,s36,v15
v_fma_f32 v95,v95,s36,v15
v_mfma_f32_16x16x32_bf16 v[184:187],a[144:147],v[20:23],v[184:187]
s_waitcnt lgkmcnt(0)
v_exp_f32 v95,v95
v_mfma_f32_16x16x32_bf16 v[192:195],a[120:123],v[20:23],v[192:195]
v_fma_f32 v86,v86,s36,v14
v_fma_f32 v78,v78,s36,v13
v_mfma_f32_16x16x32_bf16 v[196:199],a[124:127],v[20:23],v[196:199]
v_exp_f32 v92,v92
v_mfma_f32_16x16x32_bf16 v[244:247],a[124:127],v[24:27],v[244:247]
v_exp_f32 v78,v78
v_mfma_f32_16x16x32_bf16 v[240:243],a[120:123],v[24:27],v[240:243]
buffer_load_dwordx4 v7,s[12:15],s28 offen offset:1024 nt lds
v_mfma_f32_16x16x32_bf16 v[144:147],a[120:123],v[28:31],v[144:147]
v_exp_f32 v94,v94
v_mfma_f32_16x16x32_bf16 v[148:151],a[124:127],v[28:31],v[148:151]
v_exp_f32 v90,v90
v_mfma_f32_16x16x32_bf16 a[196:199],a[124:127],v[32:35],a[196:199]
v_fma_f32 v96,v96,s36,v16
v_exp_f32 v96,v96
v_mfma_f32_16x16x32_bf16 a[192:195],a[120:123],v[32:35],a[192:195]
v_fma_f32 v99,v99,s36,v16
v_exp_f32 v83,v83
v_mfma_f32_16x16x32_bf16 a[200:203],a[128:131],v[32:35],a[200:203]
v_exp_f32 v97,v97
v_mfma_f32_16x16x32_bf16 a[204:207],a[132:135],v[32:35],a[204:207]
v_exp_f32 v88,v88
v_mfma_f32_16x16x32_bf16 v[156:159],a[132:135],v[28:31],v[156:159]
v_exp_f32 v98,v98
v_mfma_f32_16x16x32_bf16 v[152:155],a[128:131],v[28:31],v[152:155]
buffer_load_dwordx4 v8,s[12:15],s28 offen offset:2048 nt lds
s_waitcnt vmcnt(20)
s_barrier
v_mfma_f32_16x16x32_bf16 v[248:251],a[128:131],v[24:27],v[248:251]
s_add_u32 s28,s28,3072
ds_read_b64_tr_b16 a[138:139],v2 offset:6144
v_exp_f32 v79,v79
v_mfma_f32_16x16x32_bf16 v[252:255],a[132:135],v[24:27],v[252:255]
s_add_u32 m0,s22,0
ds_read_b64_tr_b16 a[136:137],v2 offset:0
buffer_load_dwordx4 v6,s[4:7],s25 offen offset:0 lds
v_mfma_f32_16x16x32_bf16 v[204:207],a[132:135],v[20:23],v[204:207]
buffer_load_dwordx4 v7,s[4:7],s25 offen offset:1024 lds
v_mfma_f32_16x16x32_bf16 v[200:203],a[128:131],v[20:23],v[200:203]
buffer_load_dwordx4 v8,s[4:7],s25 offen offset:2048 lds
ds_read_b64_tr_b16 a[142:143],v3 offset:6144
ds_read_b64_tr_b16 a[140:141],v3 offset:0
ds_read_b64_tr_b16 a[144:145],v4 offset:0
ds_read_b64_tr_b16 a[146:147],v4 offset:6144
ds_read_b64_tr_b16 a[148:149],v5 offset:0
ds_read_b64_tr_b16 a[150:151],v5 offset:6144
v_exp_f32 v100,v100
v_cvt_pk_bf16_f32 v47,v78,v79
v_cvt_pk_bf16_f32 v49,v82,v83
v_exp_f32 v76,v76
v_exp_f32 v102,v102
v_exp_f32 v86,v86
v_cvt_pk_bf16_f32 v59,v102,v103
v_exp_f32 v99,v99
v_cvt_pk_bf16_f32 v50,v84,v85
v_cvt_pk_bf16_f32 v57,v98,v99
v_cvt_pk_bf16_f32 v55,v94,v95
v_cvt_pk_bf16_f32 v54,v92,v93
v_cvt_pk_bf16_f32 v58,v100,v101
v_cvt_pk_bf16_f32 v51,v86,v87
v_cvt_pk_bf16_f32 v53,v90,v91
v_cvt_pk_bf16_f32 v46,v76,v77
v_cvt_pk_bf16_f32 v52,v88,v89
v_cvt_pk_bf16_f32 v56,v96,v97
v_smfmac_f32_16x16x64_bf16 v[60:63],a[152:155],v[44:51],v18
v_subrev_u32 v10,18432,v10
v_smfmac_f32_16x16x64_bf16 v[64:67],a[152:155],v[52:59],v18
s_waitcnt lgkmcnt(0)
v_mfma_f32_16x16x32_bf16 v[160:163],a[136:139],v[44:47],v[160:163]
s_add_u32 s87,s42,18432
ds_read_b64_tr_b16 a[120:121],v2 offset:128
v_mbcnt_lo_u32_b32 v39,-1,0
v_mfma_f32_16x16x32_bf16 v[164:167],a[140:143],v[44:47],v[164:167]
ds_read_b64_tr_b16 a[122:123],v2 offset:6272
v_mbcnt_hi_u32_b32 v39,-1,v39
v_mfma_f32_16x16x32_bf16 v[212:215],a[140:143],v[48:51],v[212:215]
ds_read_b64_tr_b16 a[124:125],v3 offset:128
v_and_b32 v38,7,v39
v_mfma_f32_16x16x32_bf16 v[208:211],a[136:139],v[48:51],v[208:211]
ds_read_b64_tr_b16 a[126:127],v3 offset:6272
v_add_f32 v60,v60,v61
v_mfma_f32_16x16x32_bf16 v[112:115],a[136:139],v[52:55],v[112:115]
ds_read_b64_tr_b16 a[128:129],v4 offset:128
v_add_f32 v62,v62,v63
v_mfma_f32_16x16x32_bf16 v[116:119],a[140:143],v[52:55],v[116:119]
ds_read_b64_tr_b16 a[130:131],v4 offset:6272
ds_read_b64_tr_b16 a[132:133],v5 offset:128
ds_read_b64_tr_b16 a[134:135],v5 offset:6272
v_mfma_f32_16x16x32_bf16 a[164:167],a[140:143],v[56:59],a[164:167]
ds_read_b64_tr_b16 a[140:141],v3 offset:256
v_add_f32 v64,v64,v65
v_mfma_f32_16x16x32_bf16 a[160:163],a[136:139],v[56:59],a[160:163]
ds_read_b64_tr_b16 a[136:137],v2 offset:256
v_add_f32 v66,v66,v67
v_mfma_f32_16x16x32_bf16 a[168:171],a[144:147],v[56:59],a[168:171]
ds_read_b64_tr_b16 a[138:139],v2 offset:6400
v_max3_f32 v19,v60,v62,v64
v_mfma_f32_16x16x32_bf16 a[172:175],a[148:151],v[56:59],a[172:175]
ds_read_b64_tr_b16 a[142:143],v3 offset:6400
v_max_f32 v19,v19,v66
v_mfma_f32_16x16x32_bf16 v[124:127],a[148:151],v[52:55],v[124:127]
v_rcp_f32 v66,v66
v_mfma_f32_16x16x32_bf16 v[120:123],a[144:147],v[52:55],v[120:123]
v_accvgpr_read_b32 v80,a164
v_accvgpr_read_b32 v81,a165
v_mfma_f32_16x16x32_bf16 v[216:219],a[144:147],v[48:51],v[216:219]
v_accvgpr_read_b32 v82,a166
v_accvgpr_read_b32 v83,a167
v_mfma_f32_16x16x32_bf16 v[220:223],a[148:151],v[48:51],v[220:223]
v_accvgpr_read_b32 v72,a160
v_accvgpr_read_b32 v73,a161
v_mfma_f32_16x16x32_bf16 v[172:175],a[148:151],v[44:47],v[172:175]
ds_read_b64_tr_b16 a[148:149],v5 offset:256
v_accvgpr_read_b32 v74,a162
v_mfma_f32_16x16x32_bf16 v[168:171],a[144:147],v[44:47],v[168:171]
s_waitcnt lgkmcnt(2)
ds_read_b64_tr_b16 a[144:145],v4 offset:256
v_accvgpr_read_b32 v75,a163
v_mfma_f32_16x16x32_bf16 v[176:179],a[120:123],v[44:47],v[176:179]
ds_read_b64_tr_b16 a[146:147],v4 offset:6400
v_accvgpr_read_b32 v88,a168
v_mfma_f32_16x16x32_bf16 v[180:183],a[124:127],v[44:47],v[180:183]
ds_read_b64_tr_b16 a[150:151],v5 offset:6400
v_accvgpr_read_b32 v89,a169
v_mfma_f32_16x16x32_bf16 v[228:231],a[124:127],v[48:51],v[228:231]
v_accvgpr_read_b32 v90,a170
v_accvgpr_read_b32 v91,a171
v_mfma_f32_16x16x32_bf16 v[224:227],a[120:123],v[48:51],v[224:227]
v_accvgpr_read_b32 v96,a172
v_accvgpr_read_b32 v97,a173
v_mfma_f32_16x16x32_bf16 v[128:131],a[120:123],v[52:55],v[128:131]
v_accvgpr_read_b32 v98,a174
v_accvgpr_read_b32 v99,a175
v_mfma_f32_16x16x32_bf16 v[132:135],a[124:127],v[52:55],v[132:135]
v_cmp_ngt_f32 vcc,s37,v19
v_lshrrev_b32 v19,5,v39
v_mfma_f32_16x16x32_bf16 a[180:183],a[124:127],v[56:59],a[180:183]
v_xor_b32 v38,v38,v19
v_and_b32 v19,15,v39
v_mfma_f32_16x16x32_bf16 a[176:179],a[120:123],v[56:59],a[176:179]
s_cmp_lg_u64 vcc,0
v_lshl_add_u32 v19,v19,7,s24
v_lshl_add_u32 v19,v38,4,v19
v_mfma_f32_16x16x32_bf16 a[184:187],a[128:131],v[56:59],a[184:187]
s_cselect_b32 s62,s32,0
v_bfe_u32 v38,v39,4,1
v_lshl_add_u32 v36,v38,3,v19
v_mfma_f32_16x16x32_bf16 a[188:191],a[132:135],v[56:59],a[188:191]
s_or_b32 s31,s31,s62
v_xor_b32 v37,32,v36
v_bfe_u32 v19,v39,3,1
v_mfma_f32_16x16x32_bf16 v[140:143],a[132:135],v[52:55],v[140:143]
s_lshl_b32 s32,s32,1
v_xor_b32 v38,64,v36
v_xor_b32 v39,96,v36
v_lshlrev_b32 v19,11,v19
v_accvgpr_read_b32 v84,a180
v_accvgpr_read_b32 v85,a181
v_pk_mul_f32 v[72:73],v[72:73],v[66:67] op_sel_hi:[1,0]
v_pk_mul_f32 v[74:75],v[74:75],v[66:67] op_sel_hi:[1,0]
v_pk_mul_f32 v[80:81],v[80:81],v[66:67] op_sel_hi:[1,0]
v_pk_mul_f32 v[82:83],v[82:83],v[66:67] op_sel_hi:[1,0]
v_pk_mul_f32 v[84:85],v[84:85],v[66:67] op_sel_hi:[1,0]
v_accvgpr_read_b32 v86,a182
v_accvgpr_read_b32 v87,a183
v_pk_mul_f32 v[86:87],v[86:87],v[66:67] op_sel_hi:[1,0]
v_accvgpr_read_b32 v76,a176
v_accvgpr_read_b32 v77,a177
v_pk_mul_f32 v[76:77],v[76:77],v[66:67] op_sel_hi:[1,0]
v_accvgpr_read_b32 v78,a178
v_accvgpr_read_b32 v79,a179
v_pk_mul_f32 v[78:79],v[78:79],v[66:67] op_sel_hi:[1,0]
v_accvgpr_read_b32 v92,a184
v_accvgpr_read_b32 v93,a185
v_mfma_f32_16x16x32_bf16 v[136:139],a[128:131],v[52:55],v[136:139]
s_add_u32 m0,s23,0
v_accvgpr_read_b32 v94,a186
v_accvgpr_read_b32 v95,a187
v_accvgpr_read_b32 v100,a188
v_accvgpr_read_b32 v101,a189
v_accvgpr_read_b32 v102,a190
v_pk_mul_f32 v[88:89],v[88:89],v[66:67] op_sel_hi:[1,0]
v_pk_mul_f32 v[90:91],v[90:91],v[66:67] op_sel_hi:[1,0]
v_pk_mul_f32 v[92:93],v[92:93],v[66:67] op_sel_hi:[1,0]
v_pk_mul_f32 v[94:95],v[94:95],v[66:67] op_sel_hi:[1,0]
v_accvgpr_read_b32 v103,a191
v_cvt_pk_bf16_f32 v72,v72,v73
v_mfma_f32_16x16x32_bf16 v[232:235],a[128:131],v[48:51],v[232:235]
v_cvt_pk_bf16_f32 v76,v76,v77
v_cvt_pk_bf16_f32 v80,v80,v81
v_cvt_pk_bf16_f32 v84,v84,v85
v_cvt_pk_bf16_f32 v73,v74,v75
v_cvt_pk_bf16_f32 v77,v78,v79
ds_write2st64_b64 v36,v[72:73],v[76:77] offset0:36 offset1:40
v_pk_mul_f32 v[96:97],v[96:97],v[66:67] op_sel_hi:[1,0]
v_pk_mul_f32 v[98:99],v[98:99],v[66:67] op_sel_hi:[1,0]
v_pk_mul_f32 v[100:101],v[100:101],v[66:67] op_sel_hi:[1,0]
v_pk_mul_f32 v[102:103],v[102:103],v[66:67] op_sel_hi:[1,0]
v_cvt_pk_bf16_f32 v88,v88,v89
v_cvt_pk_bf16_f32 v92,v92,v93
v_mfma_f32_16x16x32_bf16 v[236:239],a[132:135],v[48:51],v[236:239]
v_cvt_pk_bf16_f32 v81,v82,v83
v_cvt_pk_bf16_f32 v85,v86,v87
v_mfma_f32_16x16x32_bf16 v[188:191],a[132:135],v[44:47],v[188:191]
v_cvt_pk_bf16_f32 v96,v96,v97
v_cvt_pk_bf16_f32 v100,v100,v101
v_mfma_f32_16x16x32_bf16 v[184:187],a[128:131],v[44:47],v[184:187]
ds_write2st64_b64 v37,v[80:81],v[84:85] offset0:36 offset1:40
v_mfma_f32_16x16x32_bf16 v[192:195],a[136:139],v[44:47],v[192:195]
s_waitcnt lgkmcnt(1)
v_cvt_pk_bf16_f32 v89,v90,v91
v_cvt_pk_bf16_f32 v93,v94,v95
v_mfma_f32_16x16x32_bf16 v[196:199],a[140:143],v[44:47],v[196:199]
v_cvt_pk_bf16_f32 v97,v98,v99
v_cvt_pk_bf16_f32 v101,v102,v103
v_mfma_f32_16x16x32_bf16 v[244:247],a[140:143],v[48:51],v[244:247]
v_rcp_f32 v62,v62
v_mfma_f32_16x16x32_bf16 v[240:243],a[136:139],v[48:51],v[240:243]
ds_write2st64_b64 v38,v[88:89],v[92:93] offset0:36 offset1:40
v_mfma_f32_16x16x32_bf16 v[144:147],a[136:139],v[52:55],v[144:147]
v_rcp_f32 v64,v64
v_mfma_f32_16x16x32_bf16 v[148:151],a[140:143],v[52:55],v[148:151]
v_rcp_f32 v60,v60
v_mfma_f32_16x16x32_bf16 a[196:199],a[140:143],v[56:59],a[196:199]
v_mfma_f32_16x16x32_bf16 a[192:195],a[136:139],v[56:59],a[192:195]
ds_write2st64_b64 v39,v[96:97],v[100:101] offset0:36 offset1:40
v_mfma_f32_16x16x32_bf16 a[200:203],a[144:147],v[56:59],a[200:203]
v_mfma_f32_16x16x32_bf16 a[204:207],a[148:151],v[56:59],a[204:207]
ds_read_b128 v[104:107],v10 offset:18432
v_mfma_f32_16x16x32_bf16 v[156:159],a[148:151],v[52:55],v[156:159]
s_waitcnt vmcnt(15)
ds_read_b128 a[68:71],v12 offset:12544
v_accvgpr_read_b32 v84,a196
ds_read_b128 a[64:67],v11 offset:12544
v_accvgpr_read_b32 v85,a197
ds_read_b128 a[60:63],v12 offset:12416
v_pk_mul_f32 v[84:85],v[84:85],v[66:67] op_sel_hi:[1,0]
ds_read_b128 a[56:59],v11 offset:12416
v_accvgpr_read_b32 v86,a198
ds_read_b128 a[52:55],v12 offset:12288
v_accvgpr_read_b32 v87,a199
ds_read_b128 a[48:51],v11 offset:12288
v_pk_mul_f32 v[86:87],v[86:87],v[66:67] op_sel_hi:[1,0]
ds_read_b128 v[108:111],v10 offset:19456
s_waitcnt lgkmcnt(7)
buffer_store_dwordx4 v[104:107],v9,s[16:19],s87 offen offset:0 nt
ds_read_b128 v[72:75],v10 offset:20480
v_accvgpr_read_b32 v80,a192
ds_read_b128 v[76:79],v10 offset:21504
v_accvgpr_read_b32 v81,a193
v_pk_mul_f32 v[80:81],v[80:81],v[66:67] op_sel_hi:[1,0]
v_accvgpr_read_b32 v82,a194
v_accvgpr_read_b32 v83,a195
v_pk_mul_f32 v[82:83],v[82:83],v[66:67] op_sel_hi:[1,0]
v_accvgpr_read_b32 v88,a200
v_accvgpr_read_b32 v89,a201
v_mfma_f32_16x16x32_bf16 v[152:155],a[144:147],v[52:55],v[152:155]
v_accvgpr_read_b32 v90,a202
v_accvgpr_read_b32 v91,a203
v_accvgpr_read_b32 v92,a204
v_accvgpr_read_b32 v93,a205
v_accvgpr_read_b32 v94,a206
v_pk_mul_f32 v[88:89],v[88:89],v[66:67] op_sel_hi:[1,0]
v_pk_mul_f32 v[90:91],v[90:91],v[66:67] op_sel_hi:[1,0]
v_accvgpr_read_b32 v95,a207
v_cvt_pk_bf16_f32 v80,v80,v81
v_mfma_f32_16x16x32_bf16 v[248:251],a[144:147],v[48:51],v[248:251]
s_waitcnt lgkmcnt(1)
v_cvt_pk_bf16_f32 v81,v82,v83
ds_write_b64 v36,v[80:81] offset:18432
buffer_store_dwordx4 v[108:111],v9,s[16:19],s87 offen offset:3072 nt
v_pk_mul_f32 v[92:93],v[92:93],v[66:67] op_sel_hi:[1,0]
v_pk_mul_f32 v[94:95],v[94:95],v[66:67] op_sel_hi:[1,0]
v_pk_mul_f32 v[208:209],v[208:209],v[62:63] op_sel_hi:[1,0]
v_pk_mul_f32 v[210:211],v[210:211],v[62:63] op_sel_hi:[1,0]
v_pk_mul_f32 v[224:225],v[224:225],v[62:63] op_sel_hi:[1,0]
v_pk_mul_f32 v[226:227],v[226:227],v[62:63] op_sel_hi:[1,0]
v_pk_mul_f32 v[212:213],v[212:213],v[62:63] op_sel_hi:[1,0]
v_pk_mul_f32 v[214:215],v[214:215],v[62:63] op_sel_hi:[1,0]
v_pk_mul_f32 v[228:229],v[228:229],v[62:63] op_sel_hi:[1,0]
v_pk_mul_f32 v[230:231],v[230:231],v[62:63] op_sel_hi:[1,0]
v_pk_mul_f32 v[216:217],v[216:217],v[62:63] op_sel_hi:[1,0]
buffer_store_dwordx4 v[72:75],v9,s[16:19],s87 offen offset:128 nt
v_pk_mul_f32 v[218:219],v[218:219],v[62:63] op_sel_hi:[1,0]
v_pk_mul_f32 v[232:233],v[232:233],v[62:63] op_sel_hi:[1,0]
v_pk_mul_f32 v[234:235],v[234:235],v[62:63] op_sel_hi:[1,0]
v_pk_mul_f32 v[220:221],v[220:221],v[62:63] op_sel_hi:[1,0]
v_pk_mul_f32 v[222:223],v[222:223],v[62:63] op_sel_hi:[1,0]
v_pk_mul_f32 v[236:237],v[236:237],v[62:63] op_sel_hi:[1,0]
v_pk_mul_f32 v[238:239],v[238:239],v[62:63] op_sel_hi:[1,0]
v_add_u32 v36,v36,v19
v_cvt_pk_bf16_f32 v84,v84,v85
v_mfma_f32_16x16x32_bf16 v[252:255],a[148:151],v[48:51],v[252:255]
v_cvt_pk_bf16_f32 v88,v88,v89
v_cvt_pk_bf16_f32 v85,v86,v87
v_mfma_f32_16x16x32_bf16 v[204:207],a[148:151],v[44:47],v[204:207]
s_waitcnt lgkmcnt(0)
ds_write_b64 v37,v[84:85] offset:18432
buffer_store_dwordx4 v[76:79],v9,s[16:19],s87 offen offset:3200 nt
v_pk_mul_f32 v[240:241],v[240:241],v[62:63] op_sel_hi:[1,0]
v_pk_mul_f32 v[242:243],v[242:243],v[62:63] op_sel_hi:[1,0]
v_pk_mul_f32 v[112:113],v[112:113],v[64:65] op_sel_hi:[1,0]
v_pk_mul_f32 v[114:115],v[114:115],v[64:65] op_sel_hi:[1,0]
v_add_u32 v37,v37,v19
v_cvt_pk_bf16_f32 v92,v92,v93
v_mfma_f32_16x16x32_bf16 v[200:203],a[144:147],v[44:47],v[200:203]
v_cvt_pk_bf16_f32 v89,v90,v91
ds_write_b64 v38,v[88:89] offset:18432
v_add_u32 v38,v38,v19
v_cvt_pk_bf16_f32 v93,v94,v95
v_cvt_pk_bf16_f32 v208,v208,v209
v_cvt_pk_bf16_f32 v224,v224,v225
ds_write_b64 v39,v[92:93] offset:18432
ds_read_b128 v[96:99],v10 offset:18432
v_add_u32 v39,v39,v19
ds_read_b128 v[100:103],v10 offset:19456
v_cvt_pk_bf16_f32 v212,v212,v213
v_cvt_pk_bf16_f32 v228,v228,v229
v_cvt_pk_bf16_f32 v209,v210,v211
v_cvt_pk_bf16_f32 v225,v226,v227
ds_write2st64_b64 v36,v[208:209],v[224:225] offset0:12 offset1:14
v_cvt_pk_bf16_f32 v216,v216,v217
v_cvt_pk_bf16_f32 v232,v232,v233
v_cvt_pk_bf16_f32 v213,v214,v215
v_cvt_pk_bf16_f32 v229,v230,v231
v_cvt_pk_bf16_f32 v220,v220,v221
v_cvt_pk_bf16_f32 v236,v236,v237
v_cvt_pk_bf16_f32 v217,v218,v219
v_cvt_pk_bf16_f32 v233,v234,v235
s_waitcnt vmcnt(4)
s_barrier
s_waitcnt lgkmcnt(2)
buffer_store_dwordx4 v[96:99],v9,s[16:19],s87 offen offset:256 nt
ds_read_b128 a[140:143],v1 offset:256
v_cvt_pk_bf16_f32 v240,v240,v241
ds_read_b128 a[136:139],v0 offset:256
v_cvt_pk_bf16_f32 v112,v112,v113
ds_read_b128 a[132:135],v1 offset:128
v_cvt_pk_bf16_f32 v221,v222,v223
ds_write2st64_b64 v37,v[212:213],v[228:229] offset0:12 offset1:14
v_cvt_pk_bf16_f32 v237,v238,v239
v_cvt_pk_bf16_f32 v241,v242,v243
v_cvt_pk_bf16_f32 v113,v114,v115
buffer_load_dwordx4 v6,s[8:11],s25 offen offset:0 lds
ds_read_b128 a[128:131],v0 offset:128
s_waitcnt lgkmcnt(5)
buffer_store_dwordx4 v[100:103],v9,s[16:19],s87 offen offset:3328 nt
ds_read_b128 a[124:127],v1 offset:0
v_mov_b32 v66,0
ds_read_b128 a[120:123],v0 offset:0
s_waitcnt lgkmcnt(5)
v_mfma_f32_16x16x32_bf16 v[72:75],a[140:143],a[20:23],0
v_mov_b32 v67,0
ds_read_b128 a[144:147],v0 offset:6144
v_mfma_f32_16x16x32_bf16 v[72:75],a[136:139],a[16:19],v[72:75]
ds_write2st64_b64 v38,v[216:217],v[232:233] offset0:12 offset1:14
v_pk_mul_f32 v[244:245],v[244:245],v[62:63] op_sel_hi:[1,0]
v_pk_mul_f32 v[246:247],v[246:247],v[62:63] op_sel_hi:[1,0]
v_pk_mul_f32 v[116:117],v[116:117],v[64:65] op_sel_hi:[1,0]
buffer_load_dwordx4 v7,s[8:11],s25 offen offset:1024 lds
ds_read_b128 a[148:151],v1 offset:6144
v_pk_mul_f32 v[118:119],v[118:119],v[64:65] op_sel_hi:[1,0]
v_cvt_pk_bf16_f32 v244,v244,v245
v_cvt_pk_bf16_f32 v116,v116,v117
s_waitcnt lgkmcnt(4)
v_mfma_f32_16x16x32_bf16 v[72:75],a[132:135],a[12:15],v[72:75]
ds_write2st64_b64 v39,v[220:221],v[236:237] offset0:12 offset1:14
v_mfma_f32_16x16x32_bf16 v[72:75],a[128:131],a[8:11],v[72:75]
v_cvt_pk_bf16_f32 v245,v246,v247
v_cvt_pk_bf16_f32 v117,v118,v119
v_mfma_f32_16x16x32_bf16 v[72:75],a[124:127],a[4:7],v[72:75]
s_waitcnt lgkmcnt(2)
v_mfma_f32_16x16x32_bf16 v[72:75],a[120:123],a[0:3],v[72:75]
ds_write2st64_b64 v36,v[240:241],v[112:113] offset0:16 offset1:24
v_pk_mul_f32 v[248:249],v[248:249],v[62:63] op_sel_hi:[1,0]
v_pk_mul_f32 v[250:251],v[250:251],v[62:63] op_sel_hi:[1,0]
v_pk_mul_f32 v[120:121],v[120:121],v[64:65] op_sel_hi:[1,0]
buffer_load_dwordx4 v8,s[8:11],s25 offen offset:2048 lds
v_pk_mul_f32 v[122:123],v[122:123],v[64:65] op_sel_hi:[1,0]
v_cvt_pk_bf16_f32 v248,v248,v249
v_cvt_pk_bf16_f32 v120,v120,v121
v_mfma_f32_16x16x32_bf16 v[80:83],a[120:123],a[24:27],0
s_waitcnt vmcnt(12)
ds_read_b128 a[72:75],v11 offset:0
v_max3_f32 v44,v72,v73,v74
v_mfma_f32_16x16x32_bf16 v[80:83],a[124:127],a[28:31],v[80:83]
s_mov_b32 s27,s42
ds_read_b128 a[76:79],v12 offset:0
v_cvt_pk_bf16_f32 v249,v250,v251
v_mfma_f32_16x16x32_bf16 v[80:83],a[128:131],a[32:35],v[80:83]
s_mov_b32 s42,s41
ds_read_b128 a[80:83],v11 offset:128
v_cvt_pk_bf16_f32 v121,v122,v123
ds_read_b128 a[84:87],v12 offset:128
v_pk_mul_f32 v[252:253],v[252:253],v[62:63] op_sel_hi:[1,0]
ds_read_b128 a[88:91],v11 offset:256
v_pk_mul_f32 v[254:255],v[254:255],v[62:63] op_sel_hi:[1,0]
ds_read_b128 a[92:95],v12 offset:256
v_pk_mul_f32 v[124:125],v[124:125],v[64:65] op_sel_hi:[1,0]
ds_write2st64_b64 v37,v[244:245],v[116:117] offset0:16 offset1:24
v_pk_mul_f32 v[126:127],v[126:127],v[64:65] op_sel_hi:[1,0]
v_cvt_pk_bf16_f32 v252,v252,v253
v_cvt_pk_bf16_f32 v124,v124,v125
v_mfma_f32_16x16x32_bf16 v[80:83],a[132:135],a[36:39],v[80:83]
s_add_u32 s69,s69,1
v_cvt_pk_bf16_f32 v253,v254,v255
v_cvt_pk_bf16_f32 v125,v126,v127
v_mfma_f32_16x16x32_bf16 v[80:83],a[136:139],a[40:43],v[80:83]
s_lshl_b32 s62,s69,5
v_mov_b32 v62,0
v_mov_b32 v63,0
v_mfma_f32_16x16x32_bf16 v[80:83],a[140:143],a[44:47],v[80:83]
s_add_u32 s62,s62,s34
ds_write2st64_b64 v38,v[248:249],v[120:121] offset0:16 offset1:24
v_pk_mul_f32 v[128:129],v[128:129],v[64:65] op_sel_hi:[1,0]
v_pk_mul_f32 v[130:131],v[130:131],v[64:65] op_sel_hi:[1,0]
v_pk_mul_f32 v[144:145],v[144:145],v[64:65] op_sel_hi:[1,0]
v_pk_mul_f32 v[146:147],v[146:147],v[64:65] op_sel_hi:[1,0]
v_cvt_pk_bf16_f32 v128,v128,v129
v_cvt_pk_bf16_f32 v144,v144,v145
v_mfma_f32_16x16x32_bf16 v[88:91],a[140:143],a[68:71],0
s_mul_i32 s63,s62,171
v_max3_f32 v48,v80,v81,v82
v_cvt_pk_bf16_f32 v129,v130,v131
v_mfma_f32_16x16x32_bf16 v[88:91],a[136:139],a[64:67],v[88:91]
s_lshr_b32 s63,s63,9
v_cvt_pk_bf16_f32 v145,v146,v147
s_mul_i32 s64,s63,3
v_mfma_f32_16x16x32_bf16 v[88:91],a[132:135],a[60:63],v[88:91]
s_sub_u32 s62,s62,s64
ds_write2st64_b64 v39,v[252:253],v[124:125] offset0:16 offset1:24
v_pk_mul_f32 v[132:133],v[132:133],v[64:65] op_sel_hi:[1,0]
v_pk_mul_f32 v[134:135],v[134:135],v[64:65] op_sel_hi:[1,0]
v_pk_mul_f32 v[148:149],v[148:149],v[64:65] op_sel_hi:[1,0]
v_pk_mul_f32 v[150:151],v[150:151],v[64:65] op_sel_hi:[1,0]
v_cvt_pk_bf16_f32 v132,v132,v133
v_cvt_pk_bf16_f32 v148,v148,v149
v_mfma_f32_16x16x32_bf16 v[88:91],a[128:131],a[56:59],v[88:91]
s_add_u32 s63,s63,s33
v_cvt_pk_bf16_f32 v133,v134,v135
v_cvt_pk_bf16_f32 v149,v150,v151
v_mfma_f32_16x16x32_bf16 v[88:91],a[124:127],a[52:55],v[88:91]
s_mul_i32 s30,s63,196608
s_mul_i32 s41,s63,325632
ds_write2st64_b64 v36,v[128:129],v[144:145] offset0:26 offset1:28
v_mfma_f32_16x16x32_bf16 v[88:91],a[120:123],a[48:51],v[88:91]
s_lshl_b32 s63,s3,2
s_add_u32 s64,s63,21
s_cmp_eq_u32 s3,0
s_waitcnt lgkmcnt(2)
v_mfma_f32_16x16x32_bf16 v[96:99],a[120:123],a[72:75],0
s_cselect_b32 s64,20,s64
ds_read_b128 a[120:123],v0 offset:6272
s_cselect_b32 s40,1,0
s_add_u32 s65,s63,37
s_cmp_eq_u32 s62,2
v_max3_f32 v52,v88,v89,v90
ds_write2st64_b64 v37,v[132:133],v[148:149] offset0:26 offset1:28
v_pk_mul_f32 v[136:137],v[136:137],v[64:65] op_sel_hi:[1,0]
v_pk_mul_f32 v[138:139],v[138:139],v[64:65] op_sel_hi:[1,0]
v_pk_mul_f32 v[152:153],v[152:153],v[64:65] op_sel_hi:[1,0]
v_pk_mul_f32 v[154:155],v[154:155],v[64:65] op_sel_hi:[1,0]
v_cvt_pk_bf16_f32 v136,v136,v137
v_cvt_pk_bf16_f32 v152,v152,v153
v_mfma_f32_16x16x32_bf16 v[96:99],a[124:127],a[76:79],v[96:99]
s_cselect_b32 s64,s65,s64
ds_read_b128 a[124:127],v1 offset:6272
v_cvt_pk_bf16_f32 v137,v138,v139
v_mfma_f32_16x16x32_bf16 v[96:99],a[128:131],a[80:83],v[96:99]
s_cselect_b32 s40,0,s40
ds_read_b128 a[128:131],v0 offset:6400
v_cvt_pk_bf16_f32 v153,v154,v155
v_mfma_f32_16x16x32_bf16 v[96:99],a[132:135],a[84:87],v[96:99]
s_add_u32 s65,s63,s3
ds_write2st64_b64 v38,v[136:137],v[152:153] offset0:26 offset1:28
v_pk_mul_f32 v[140:141],v[140:141],v[64:65] op_sel_hi:[1,0]
v_pk_mul_f32 v[142:143],v[142:143],v[64:65] op_sel_hi:[1,0]
v_pk_mul_f32 v[156:157],v[156:157],v[64:65] op_sel_hi:[1,0]
ds_read_b128 a[132:135],v1 offset:6400
v_pk_mul_f32 v[158:159],v[158:159],v[64:65] op_sel_hi:[1,0]
v_cvt_pk_bf16_f32 v140,v140,v141
v_cvt_pk_bf16_f32 v156,v156,v157
v_mfma_f32_16x16x32_bf16 v[96:99],a[136:139],a[88:91],v[96:99]
s_cmp_eq_u32 s62,0
ds_read_b128 a[136:139],v0 offset:12288
v_cvt_pk_bf16_f32 v141,v142,v143
v_mfma_f32_16x16x32_bf16 v[96:99],a[140:143],a[92:95],v[96:99]
s_cselect_b32 s64,s65,s64
ds_read_b128 a[140:143],v1 offset:12288
v_cvt_pk_bf16_f32 v157,v158,v159
v_mfma_f32_16x16x32_bf16 v[76:79],a[144:147],a[0:3],0
s_cselect_b32 s40,1,s40
ds_write2st64_b64 v39,v[140:141],v[156:157] offset0:26 offset1:28
v_pk_mul_f32 v[160:161],v[160:161],v[60:61] op_sel_hi:[1,0]
v_pk_mul_f32 v[162:163],v[162:163],v[60:61] op_sel_hi:[1,0]
v_pk_mul_f32 v[176:177],v[176:177],v[60:61] op_sel_hi:[1,0]
v_pk_mul_f32 v[178:179],v[178:179],v[60:61] op_sel_hi:[1,0]
v_max3_f32 v56,v96,v97,v98
v_cvt_pk_bf16_f32 v160,v160,v161
v_mfma_f32_16x16x32_bf16 v[76:79],a[148:151],a[4:7],v[76:79]
s_mul_i32 s64,s64,6144
v_cvt_pk_bf16_f32 v176,v176,v177
v_cvt_pk_bf16_f32 v161,v162,v163
s_waitcnt lgkmcnt(4)
v_mfma_f32_16x16x32_bf16 v[76:79],a[120:123],a[8:11],v[76:79]
s_add_u32 s41,s41,s64
v_cvt_pk_bf16_f32 v177,v178,v179
v_mov_b32 v64,0
v_mfma_f32_16x16x32_bf16 v[76:79],a[124:127],a[12:15],v[76:79]
s_cmp_ge_u32 s69,6
ds_write2st64_b64 v36,v[160:161],v[176:177] offset0:0 offset1:2
v_pk_mul_f32 v[164:165],v[164:165],v[60:61] op_sel_hi:[1,0]
v_pk_mul_f32 v[166:167],v[166:167],v[60:61] op_sel_hi:[1,0]
v_pk_mul_f32 v[180:181],v[180:181],v[60:61] op_sel_hi:[1,0]
v_pk_mul_f32 v[182:183],v[182:183],v[60:61] op_sel_hi:[1,0]
v_cvt_pk_bf16_f32 v164,v164,v165
v_cvt_pk_bf16_f32 v180,v180,v181
v_mfma_f32_16x16x32_bf16 v[76:79],a[128:131],a[16:19],v[76:79]
s_cselect_b32 s41,166723584,s41
v_cvt_pk_bf16_f32 v165,v166,v167
v_cvt_pk_bf16_f32 v181,v182,v183
s_waitcnt lgkmcnt(1)
v_mfma_f32_16x16x32_bf16 v[76:79],a[132:135],a[20:23],v[76:79]
s_cselect_b32 s30,100663296,s30
v_mov_b32 v65,0
s_add_u32 s25,s30,s22
v_mfma_f32_16x16x32_bf16 v[84:87],a[132:135],a[44:47],0
s_add_u32 s26,s25,12288
ds_write2st64_b64 v37,v[164:165],v[180:181] offset0:0 offset1:2
v_mfma_f32_16x16x32_bf16 v[84:87],a[128:131],a[40:43],v[84:87]
s_add_u32 m0,s23,24576
v_max3_f32 v44,v44,v75,v76
v_max3_f32 v44,v44,v77,v78
v_max_f32 v44,v44,v79
v_mov_b32 v45,v44
s_mov_b32 s28,s41
v_pk_mul_f32 v[168:169],v[168:169],v[60:61] op_sel_hi:[1,0]
v_pk_mul_f32 v[170:171],v[170:171],v[60:61] op_sel_hi:[1,0]
buffer_load_dwordx4 v6,s[8:11],s21 offen offset:0 lds
v_pk_mul_f32 v[184:185],v[184:185],v[60:61] op_sel_hi:[1,0]
v_pk_mul_f32 v[186:187],v[186:187],v[60:61] op_sel_hi:[1,0]
v_permlane32_swap_b32 v45,v44
v_max_f32 v44,v44,v45
v_mfma_f32_16x16x32_bf16 v[84:87],a[124:127],a[36:39],v[84:87]
s_mov_b32 s29,s24
v_mov_b32 v45,v44
v_cvt_pk_bf16_f32 v168,v168,v169
v_mfma_f32_16x16x32_bf16 v[84:87],a[120:123],a[32:35],v[84:87]
v_permlane16_swap_b32 v45,v44
v_mfma_f32_16x16x32_bf16 v[84:87],a[148:151],a[28:31],v[84:87]
v_max_f32 v44,v44,v45
v_mul_f32_e64 v13,-s36,v44
v_fma_f32 v72,v72,s36,v13
v_fma_f32 v73,v73,s36,v13
v_fma_f32 v74,v74,s36,v13
v_pk_mul_f32 v[172:173],v[172:173],v[60:61] op_sel_hi:[1,0]
v_pk_mul_f32 v[174:175],v[174:175],v[60:61] op_sel_hi:[1,0]
v_pk_mul_f32 v[188:189],v[188:189],v[60:61] op_sel_hi:[1,0]
v_pk_mul_f32 v[190:191],v[190:191],v[60:61] op_sel_hi:[1,0]
v_fma_f32 v75,v75,s36,v13
v_exp_f32 v72,v72
v_mfma_f32_16x16x32_bf16 v[84:87],a[144:147],a[24:27],v[84:87]
v_exp_f32 v73,v73
v_mfma_f32_16x16x32_bf16 v[92:95],a[144:147],a[48:51],0
buffer_load_dwordx4 v7,s[8:11],s21 offen offset:1024 lds
v_mfma_f32_16x16x32_bf16 v[92:95],a[148:151],a[52:55],v[92:95]
v_exp_f32 v74,v74
v_exp_f32 v75,v75
v_cvt_pk_bf16_f32 v20,v72,v73
v_pk_mul_f32 v[192:193],v[192:193],v[60:61] op_sel_hi:[1,0]
v_pk_mul_f32 v[194:195],v[194:195],v[60:61] op_sel_hi:[1,0]
v_cvt_pk_bf16_f32 v21,v74,v75
v_max3_f32 v48,v48,v83,v84
v_mfma_f32_16x16x32_bf16 v[92:95],a[120:123],a[56:59],v[92:95]
v_max3_f32 v48,v48,v85,v86
v_max_f32 v48,v48,v87
v_mfma_f32_16x16x32_bf16 v[92:95],a[124:127],a[60:63],v[92:95]
v_mov_b32 v49,v48
v_fma_f32 v76,v76,s36,v13
v_mfma_f32_16x16x32_bf16 v[92:95],a[128:131],a[64:67],v[92:95]
v_permlane32_swap_b32 v49,v48
v_max_f32 v48,v48,v49
v_mov_b32 v49,v48
v_fma_f32 v77,v77,s36,v13
buffer_load_dwordx4 v8,s[8:11],s21 offen offset:2048 lds
v_pk_mul_f32 v[196:197],v[196:197],v[60:61] op_sel_hi:[1,0]
v_pk_mul_f32 v[198:199],v[198:199],v[60:61] op_sel_hi:[1,0]
v_permlane16_swap_b32 v49,v48
v_max_f32 v48,v48,v49
v_mfma_f32_16x16x32_bf16 v[92:95],a[132:135],a[68:71],v[92:95]
s_add_u32 s21,s21,12288
v_mul_f32_e64 v14,-s36,v48
v_fma_f32 v80,v80,s36,v14
v_mfma_f32_16x16x32_bf16 v[100:103],a[132:135],a[92:95],0
s_add_u32 m0,s22,0
ds_read_b128 a[132:135],v1 offset:18432
v_fma_f32 v81,v81,s36,v14
v_mfma_f32_16x16x32_bf16 v[100:103],a[128:131],a[88:91],v[100:103]
ds_read_b128 a[128:131],v0 offset:18432
v_fma_f32 v82,v82,s36,v14
v_mfma_f32_16x16x32_bf16 v[100:103],a[124:127],a[84:87],v[100:103]
ds_read_b128 a[124:127],v1 offset:12544
v_fma_f32 v83,v83,s36,v14
v_exp_f32 v80,v80
v_exp_f32 v81,v81
v_pk_mul_f32 v[200:201],v[200:201],v[60:61] op_sel_hi:[1,0]
v_pk_mul_f32 v[202:203],v[202:203],v[60:61] op_sel_hi:[1,0]
v_exp_f32 v82,v82
v_exp_f32 v83,v83
v_mfma_f32_16x16x32_bf16 v[100:103],a[120:123],a[80:83],v[100:103]
ds_read_b128 a[120:123],v0 offset:12544
v_cvt_pk_bf16_f32 v24,v80,v81
v_mfma_f32_16x16x32_bf16 v[100:103],a[148:151],a[76:79],v[100:103]
ds_read_b128 a[148:151],v1 offset:12416
v_cvt_pk_bf16_f32 v25,v82,v83
v_mfma_f32_16x16x32_bf16 v[100:103],a[144:147],a[72:75],v[100:103]
ds_read_b128 a[144:147],v0 offset:12416
v_max3_f32 v52,v52,v91,v92
v_max3_f32 v52,v52,v93,v94
v_max_f32 v52,v52,v95
v_mov_b32 v53,v52
v_pk_mul_f32 v[204:205],v[204:205],v[60:61] op_sel_hi:[1,0]
v_pk_mul_f32 v[206:207],v[206:207],v[60:61] op_sel_hi:[1,0]
v_permlane32_swap_b32 v53,v52
v_max_f32 v52,v52,v53
s_waitcnt lgkmcnt(3)
v_mfma_f32_16x16x32_bf16 v[72:75],a[124:127],a[20:23],0
v_mov_b32 v53,v52
v_max3_f32 v56,v56,v99,v100
v_max3_f32 v56,v56,v101,v102
v_permlane16_swap_b32 v53,v52
v_max_f32 v52,v52,v53
v_mul_f32_e64 v15,-s36,v52
v_fma_f32 v88,v88,s36,v15
v_fma_f32 v89,v89,s36,v15
v_fma_f32 v90,v90,s36,v15
s_waitcnt lgkmcnt(2)
v_mfma_f32_16x16x32_bf16 v[72:75],a[120:123],a[16:19],v[72:75]
s_waitcnt lgkmcnt(1)
v_fma_f32 v91,v91,s36,v15
v_exp_f32 v88,v88
v_mfma_f32_16x16x32_bf16 v[72:75],a[148:151],a[12:15],v[72:75]
s_waitcnt lgkmcnt(0)
v_exp_f32 v89,v89
v_mfma_f32_16x16x32_bf16 v[72:75],a[144:147],a[8:11],v[72:75]
v_exp_f32 v90,v90
v_mfma_f32_16x16x32_bf16 v[72:75],a[140:143],a[4:7],v[72:75]
v_exp_f32 v91,v91
v_mfma_f32_16x16x32_bf16 v[72:75],a[136:139],a[0:3],v[72:75]
v_cvt_pk_bf16_f32 v28,v88,v89
v_cvt_pk_bf16_f32 v29,v90,v91
v_mfma_f32_16x16x32_bf16 v[80:83],a[136:139],a[24:27],0
v_max_f32 v56,v56,v103
v_mov_b32 v57,v56
v_mfma_f32_16x16x32_bf16 v[80:83],a[140:143],a[28:31],v[80:83]
v_fma_f32 v78,v78,s36,v13
v_permlane32_swap_b32 v57,v56
v_mfma_f32_16x16x32_bf16 v[80:83],a[144:147],a[32:35],v[80:83]
v_max_f32 v56,v56,v57
v_mov_b32 v57,v56
v_mfma_f32_16x16x32_bf16 v[80:83],a[148:151],a[36:39],v[80:83]
v_fma_f32 v79,v79,s36,v13
v_permlane16_swap_b32 v57,v56
v_mfma_f32_16x16x32_bf16 v[80:83],a[120:123],a[40:43],v[80:83]
v_max_f32 v56,v56,v57
v_mul_f32_e64 v16,-s36,v56
v_mfma_f32_16x16x32_bf16 v[80:83],a[124:127],a[44:47],v[80:83]
v_fma_f32 v96,v96,s36,v16
v_fma_f32 v97,v97,s36,v16
v_mfma_f32_16x16x32_bf16 v[88:91],a[124:127],a[68:71],0
v_fma_f32 v98,v98,s36,v16
v_fma_f32 v99,v99,s36,v16
v_mfma_f32_16x16x32_bf16 v[88:91],a[120:123],a[64:67],v[88:91]
v_exp_f32 v96,v96
v_mfma_f32_16x16x32_bf16 v[88:91],a[148:151],a[60:63],v[88:91]
v_exp_f32 v97,v97
v_mfma_f32_16x16x32_bf16 v[88:91],a[144:147],a[56:59],v[88:91]
v_exp_f32 v98,v98
v_mfma_f32_16x16x32_bf16 v[88:91],a[140:143],a[52:55],v[88:91]
v_exp_f32 v99,v99
v_mfma_f32_16x16x32_bf16 v[88:91],a[136:139],a[48:51],v[88:91]
v_cvt_pk_bf16_f32 v32,v96,v97
v_cvt_pk_bf16_f32 v33,v98,v99
v_mfma_f32_16x16x32_bf16 v[96:99],a[136:139],a[72:75],0
ds_read_b128 a[136:139],v0 offset:18560
v_exp_f32 v76,v76
v_mfma_f32_16x16x32_bf16 v[96:99],a[140:143],a[76:79],v[96:99]
ds_read_b128 a[140:143],v1 offset:18560
v_exp_f32 v77,v77
v_mfma_f32_16x16x32_bf16 v[96:99],a[144:147],a[80:83],v[96:99]
ds_read_b128 a[144:147],v0 offset:18688
v_exp_f32 v78,v78
v_mfma_f32_16x16x32_bf16 v[96:99],a[148:151],a[84:87],v[96:99]
ds_read_b128 a[148:151],v1 offset:18688
v_exp_f32 v79,v79
v_mfma_f32_16x16x32_bf16 v[96:99],a[120:123],a[88:91],v[96:99]
v_cvt_pk_bf16_f32 v22,v76,v77
v_cvt_pk_bf16_f32 v23,v78,v79
v_mfma_f32_16x16x32_bf16 v[96:99],a[124:127],a[92:95],v[96:99]
v_fma_f32 v84,v84,s36,v14
v_fma_f32 v85,v85,s36,v14
v_mfma_f32_16x16x32_bf16 v[76:79],a[128:131],a[0:3],0
v_fma_f32 v86,v86,s36,v14
v_fma_f32 v87,v87,s36,v14
v_mfma_f32_16x16x32_bf16 v[76:79],a[132:135],a[4:7],v[76:79]
s_waitcnt lgkmcnt(3)
v_exp_f32 v84,v84
v_mfma_f32_16x16x32_bf16 v[76:79],a[136:139],a[8:11],v[76:79]
s_waitcnt lgkmcnt(2)
v_exp_f32 v85,v85
v_mfma_f32_16x16x32_bf16 v[76:79],a[140:143],a[12:15],v[76:79]
s_waitcnt lgkmcnt(1)
v_exp_f32 v86,v86
v_mfma_f32_16x16x32_bf16 v[76:79],a[144:147],a[16:19],v[76:79]
s_waitcnt lgkmcnt(0)
v_exp_f32 v87,v87
v_mfma_f32_16x16x32_bf16 v[76:79],a[148:151],a[20:23],v[76:79]
v_cvt_pk_bf16_f32 v26,v84,v85
v_cvt_pk_bf16_f32 v27,v86,v87
v_mfma_f32_16x16x32_bf16 v[84:87],a[148:151],a[44:47],0
v_fma_f32 v92,v92,s36,v15
v_fma_f32 v93,v93,s36,v15
v_mfma_f32_16x16x32_bf16 v[84:87],a[144:147],a[40:43],v[84:87]
v_fma_f32 v94,v94,s36,v15
v_fma_f32 v95,v95,s36,v15
v_mfma_f32_16x16x32_bf16 v[84:87],a[140:143],a[36:39],v[84:87]
v_exp_f32 v92,v92
v_mfma_f32_16x16x32_bf16 v[84:87],a[136:139],a[32:35],v[84:87]
v_exp_f32 v93,v93
v_mfma_f32_16x16x32_bf16 v[84:87],a[132:135],a[28:31],v[84:87]
v_exp_f32 v94,v94
v_mfma_f32_16x16x32_bf16 v[84:87],a[128:131],a[24:27],v[84:87]
v_exp_f32 v95,v95
s_waitcnt vmcnt(3)
s_barrier
v_cvt_pk_bf16_f32 v30,v92,v93
buffer_load_dwordx4 v6,s[4:7],s20 offen offset:0 lds
v_cvt_pk_bf16_f32 v31,v94,v95
v_mfma_f32_16x16x32_bf16 v[92:95],a[128:131],a[48:51],0
v_fma_f32 v100,v100,s36,v16
v_fma_f32 v101,v101,s36,v16
v_mfma_f32_16x16x32_bf16 v[92:95],a[132:135],a[52:55],v[92:95]
v_fma_f32 v102,v102,s36,v16
v_fma_f32 v103,v103,s36,v16
v_mfma_f32_16x16x32_bf16 v[92:95],a[136:139],a[56:59],v[92:95]
v_exp_f32 v100,v100
v_mfma_f32_16x16x32_bf16 v[92:95],a[140:143],a[60:63],v[92:95]
v_exp_f32 v101,v101
v_mfma_f32_16x16x32_bf16 v[92:95],a[144:147],a[64:67],v[92:95]
v_exp_f32 v102,v102
v_mfma_f32_16x16x32_bf16 v[92:95],a[148:151],a[68:71],v[92:95]
buffer_load_dwordx4 v7,s[4:7],s20 offen offset:1024 lds
v_exp_f32 v103,v103
v_cvt_pk_bf16_f32 v34,v100,v101
v_cvt_pk_bf16_f32 v35,v102,v103
v_mfma_f32_16x16x32_bf16 v[100:103],a[148:151],a[92:95],0
v_cvt_pk_bf16_f32 v184,v184,v185
v_cvt_pk_bf16_f32 v169,v170,v171
v_smfmac_f32_16x16x64_bf16 v[64:67],a[152:155],v[28:35],v18
ds_read_b64_tr_b16 a[120:121],v2 offset:0
v_mfma_f32_16x16x32_bf16 v[100:103],a[144:147],a[88:91],v[100:103]
ds_read_b64_tr_b16 a[122:123],v2 offset:6144
v_cvt_pk_bf16_f32 v172,v172,v173
v_mfma_f32_16x16x32_bf16 v[100:103],a[140:143],a[84:87],v[100:103]
v_cvt_pk_bf16_f32 v188,v188,v189
v_mov_b32 v60,0
v_mfma_f32_16x16x32_bf16 v[100:103],a[136:139],a[80:83],v[100:103]
buffer_load_dwordx4 v8,s[4:7],s20 offen offset:2048 lds
v_mfma_f32_16x16x32_bf16 v[100:103],a[132:135],a[76:79],v[100:103]
s_add_u32 s20,s20,12288
ds_read_b64_tr_b16 a[124:125],v3 offset:0
v_mov_b32 v61,0
v_mfma_f32_16x16x32_bf16 v[100:103],a[128:131],a[72:75],v[100:103]
ds_read_b64_tr_b16 a[126:127],v3 offset:6144
v_cvt_pk_bf16_f32 v185,v186,v187
v_smfmac_f32_16x16x64_bf16 v[60:63],a[152:155],v[20:27],v18
ds_write2st64_b64 v38,v[168:169],v[184:185] offset0:0 offset1:2
v_cvt_pk_bf16_f32 v192,v192,v193
v_cvt_pk_bf16_f32 v173,v174,v175
v_cvt_pk_bf16_f32 v189,v190,v191
ds_read_b64_tr_b16 a[128:129],v4 offset:0
ds_read_b64_tr_b16 a[130:131],v4 offset:6144
ds_read_b64_tr_b16 a[132:133],v5 offset:0
ds_read_b64_tr_b16 a[134:135],v5 offset:6144
ds_write2st64_b64 v39,v[172:173],v[188:189] offset0:0 offset1:2
v_cvt_pk_bf16_f32 v196,v196,v197
v_fma_f32 v72,v72,s36,v13
v_fma_f32 v73,v73,s36,v13
v_fma_f32 v74,v74,s36,v13
v_fma_f32 v75,v75,s36,v13
v_fma_f32 v80,v80,s36,v14
v_fma_f32 v81,v81,s36,v14
v_cvt_pk_bf16_f32 v193,v194,v195
v_cvt_pk_bf16_f32 v200,v200,v201
v_cvt_pk_bf16_f32 v197,v198,v199
v_exp_f32 v72,v72
ds_write_b64 v36,v[192:193] offset:2048
v_exp_f32 v73,v73
v_exp_f32 v74,v74
ds_write_b64 v37,v[196:197] offset:2048
v_exp_f32 v75,v75
v_exp_f32 v80,v80
v_exp_f32 v81,v81
v_cvt_pk_bf16_f32 v204,v204,v205
v_cvt_pk_bf16_f32 v201,v202,v203
ds_write_b64 v38,v[200:201] offset:2048
v_cvt_pk_bf16_f32 v205,v206,v207
v_cvt_pk_bf16_f32 v44,v72,v73
v_cvt_pk_bf16_f32 v45,v74,v75
v_cvt_pk_bf16_f32 v48,v80,v81
ds_write_b64 v39,v[204:205] offset:2048
s_waitcnt lgkmcnt(3)
v_mfma_f32_16x16x32_bf16 v[160:163],a[120:123],v[20:23],0
s_add_u32 m0,s23,0
ds_read_b64_tr_b16 a[136:137],v2 offset:128
v_fma_f32 v82,v82,s36,v14
v_mfma_f32_16x16x32_bf16 v[164:167],a[124:127],v[20:23],0
ds_read_b64_tr_b16 a[138:139],v2 offset:6272
v_fma_f32 v83,v83,s36,v14
v_mfma_f32_16x16x32_bf16 v[212:215],a[124:127],v[24:27],0
ds_read_b64_tr_b16 a[140:141],v3 offset:128
v_fma_f32 v88,v88,s36,v15
v_mfma_f32_16x16x32_bf16 v[208:211],a[120:123],v[24:27],0
ds_read_b64_tr_b16 a[142:143],v3 offset:6272
v_fma_f32 v89,v89,s36,v15
v_mfma_f32_16x16x32_bf16 v[112:115],a[120:123],v[28:31],0
ds_read_b64_tr_b16 a[144:145],v4 offset:128
v_fma_f32 v90,v90,s36,v15
v_mfma_f32_16x16x32_bf16 v[116:119],a[124:127],v[28:31],0
ds_read_b64_tr_b16 a[146:147],v4 offset:6272
v_fma_f32 v91,v91,s36,v15
v_mfma_f32_16x16x32_bf16 a[164:167],a[124:127],v[32:35],0
ds_read_b64_tr_b16 a[148:149],v5 offset:128
v_fma_f32 v96,v96,s36,v16
v_mfma_f32_16x16x32_bf16 a[160:163],a[120:123],v[32:35],0
ds_read_b64_tr_b16 a[150:151],v5 offset:6272
v_fma_f32 v97,v97,s36,v16
v_mfma_f32_16x16x32_bf16 a[168:171],a[128:131],v[32:35],0
ds_read_b64_tr_b16 a[120:121],v2 offset:256
v_fma_f32 v98,v98,s36,v16
v_mfma_f32_16x16x32_bf16 a[172:175],a[132:135],v[32:35],0
ds_read_b64_tr_b16 a[122:123],v2 offset:6400
v_fma_f32 v99,v99,s36,v16
v_mfma_f32_16x16x32_bf16 v[124:127],a[132:135],v[28:31],0
ds_read_b64_tr_b16 a[124:125],v3 offset:256
v_fma_f32 v76,v76,s36,v13
v_mfma_f32_16x16x32_bf16 v[120:123],a[128:131],v[28:31],0
ds_read_b64_tr_b16 a[126:127],v3 offset:6400
v_fma_f32 v77,v77,s36,v13
v_mfma_f32_16x16x32_bf16 v[216:219],a[128:131],v[24:27],0
v_exp_f32 v82,v82
v_mfma_f32_16x16x32_bf16 v[220:223],a[132:135],v[24:27],0
v_exp_f32 v83,v83
v_mfma_f32_16x16x32_bf16 v[172:175],a[132:135],v[20:23],0
ds_read_b64_tr_b16 a[132:133],v5 offset:256
v_cvt_pk_bf16_f32 v49,v82,v83
v_mfma_f32_16x16x32_bf16 v[168:171],a[128:131],v[20:23],0
s_waitcnt lgkmcnt(4)
ds_read_b64_tr_b16 a[128:129],v4 offset:256
v_fma_f32 v78,v78,s36,v13
v_mfma_f32_16x16x32_bf16 v[176:179],a[136:139],v[20:23],0
ds_read_b64_tr_b16 a[130:131],v4 offset:6400
v_fma_f32 v79,v79,s36,v13
v_mfma_f32_16x16x32_bf16 v[180:183],a[140:143],v[20:23],0
ds_read_b64_tr_b16 a[134:135],v5 offset:6400
v_fma_f32 v84,v84,s36,v14
v_mfma_f32_16x16x32_bf16 v[228:231],a[140:143],v[24:27],0
v_exp_f32 v88,v88
v_mfma_f32_16x16x32_bf16 v[224:227],a[136:139],v[24:27],0
v_exp_f32 v89,v89
v_mfma_f32_16x16x32_bf16 v[128:131],a[136:139],v[28:31],0
v_exp_f32 v90,v90
v_mfma_f32_16x16x32_bf16 v[132:135],a[140:143],v[28:31],0
v_exp_f32 v91,v91
v_mfma_f32_16x16x32_bf16 a[180:183],a[140:143],v[32:35],0
v_cvt_pk_bf16_f32 v52,v88,v89
v_cvt_pk_bf16_f32 v53,v90,v91
v_mfma_f32_16x16x32_bf16 a[176:179],a[136:139],v[32:35],0
v_exp_f32 v96,v96
v_mfma_f32_16x16x32_bf16 a[184:187],a[144:147],v[32:35],0
v_exp_f32 v97,v97
v_mfma_f32_16x16x32_bf16 a[188:191],a[148:151],v[32:35],0
v_exp_f32 v98,v98
v_mfma_f32_16x16x32_bf16 v[140:143],a[148:151],v[28:31],0
v_exp_f32 v99,v99
v_mfma_f32_16x16x32_bf16 v[136:139],a[144:147],v[28:31],0
v_cvt_pk_bf16_f32 v56,v96,v97
v_cvt_pk_bf16_f32 v57,v98,v99
v_mfma_f32_16x16x32_bf16 v[232:235],a[144:147],v[24:27],0
v_exp_f32 v76,v76
v_mfma_f32_16x16x32_bf16 v[236:239],a[148:151],v[24:27],0
v_exp_f32 v77,v77
v_mfma_f32_16x16x32_bf16 v[188:191],a[148:151],v[20:23],0
v_exp_f32 v78,v78
v_mfma_f32_16x16x32_bf16 v[184:187],a[144:147],v[20:23],0
s_waitcnt lgkmcnt(0)
v_exp_f32 v79,v79
v_mfma_f32_16x16x32_bf16 v[192:195],a[120:123],v[20:23],0
v_cvt_pk_bf16_f32 v46,v76,v77
v_cvt_pk_bf16_f32 v47,v78,v79
v_mfma_f32_16x16x32_bf16 v[196:199],a[124:127],v[20:23],0
s_waitcnt vmcnt(24)
v_fma_f32 v85,v85,s36,v14
v_fma_f32 v86,v86,s36,v14
v_mfma_f32_16x16x32_bf16 v[244:247],a[124:127],v[24:27],0
s_barrier
v_mfma_f32_16x16x32_bf16 v[240:243],a[120:123],v[24:27],0
ds_read_b128 a[148:151],v1 offset:24704
v_fma_f32 v87,v87,s36,v14
v_mfma_f32_16x16x32_bf16 v[144:147],a[120:123],v[28:31],0
ds_read_b128 a[144:147],v0 offset:24704
v_fma_f32 v92,v92,s36,v15
v_mfma_f32_16x16x32_bf16 v[148:151],a[124:127],v[28:31],0
ds_read_b128 a[140:143],v1 offset:24576
v_fma_f32 v93,v93,s36,v15
v_mfma_f32_16x16x32_bf16 a[196:199],a[124:127],v[32:35],0
ds_read_b128 a[124:127],v1 offset:24832
v_fma_f32 v94,v94,s36,v15
v_mfma_f32_16x16x32_bf16 a[192:195],a[120:123],v[32:35],0
ds_read_b128 a[120:123],v0 offset:24832
v_fma_f32 v95,v95,s36,v15
v_mfma_f32_16x16x32_bf16 a[200:203],a[128:131],v[32:35],0
buffer_load_dwordx4 v6,s[8:11],s21 offen offset:0 lds
v_mfma_f32_16x16x32_bf16 a[204:207],a[132:135],v[32:35],0
ds_read_b128 a[136:139],v0 offset:24576
v_fma_f32 v100,v100,s36,v16
v_mfma_f32_16x16x32_bf16 v[156:159],a[132:135],v[28:31],0
v_exp_f32 v84,v84
v_mfma_f32_16x16x32_bf16 v[152:155],a[128:131],v[28:31],0
v_exp_f32 v85,v85
v_mfma_f32_16x16x32_bf16 v[248:251],a[128:131],v[24:27],0
v_exp_f32 v86,v86
v_mfma_f32_16x16x32_bf16 v[252:255],a[132:135],v[24:27],0
v_exp_f32 v87,v87
v_mfma_f32_16x16x32_bf16 v[204:207],a[132:135],v[20:23],0
ds_read_b128 a[132:135],v1 offset:30720
v_cvt_pk_bf16_f32 v50,v84,v85
v_mfma_f32_16x16x32_bf16 v[200:203],a[128:131],v[20:23],0
s_waitcnt lgkmcnt(2)
ds_read_b128 a[128:131],v0 offset:30720
v_cvt_pk_bf16_f32 v51,v86,v87
v_mfma_f32_16x16x32_bf16 v[72:75],a[124:127],a[20:23],0
v_exp_f32 v92,v92
v_smfmac_f32_16x16x64_bf16 v[60:63],a[152:155],v[44:51],v18
buffer_load_dwordx4 v7,s[8:11],s21 offen offset:1024 lds
v_mfma_f32_16x16x32_bf16 v[72:75],a[120:123],a[16:19],v[72:75]
v_exp_f32 v93,v93
v_mfma_f32_16x16x32_bf16 v[72:75],a[148:151],a[12:15],v[72:75]
v_exp_f32 v94,v94
v_mfma_f32_16x16x32_bf16 v[72:75],a[144:147],a[8:11],v[72:75]
v_exp_f32 v95,v95
v_mfma_f32_16x16x32_bf16 v[72:75],a[140:143],a[4:7],v[72:75]
s_waitcnt lgkmcnt(1)
v_cvt_pk_bf16_f32 v54,v92,v93
v_cvt_pk_bf16_f32 v55,v94,v95
v_mfma_f32_16x16x32_bf16 v[72:75],a[136:139],a[0:3],v[72:75]
v_fma_f32 v101,v101,s36,v16
v_fma_f32 v102,v102,s36,v16
v_mfma_f32_16x16x32_bf16 v[80:83],a[136:139],a[24:27],0
v_fma_f32 v103,v103,s36,v16
v_mfma_f32_16x16x32_bf16 v[80:83],a[140:143],a[28:31],v[80:83]
v_exp_f32 v100,v100
v_mfma_f32_16x16x32_bf16 v[80:83],a[144:147],a[32:35],v[80:83]
buffer_load_dwordx4 v8,s[8:11],s21 offen offset:2048 lds
v_mfma_f32_16x16x32_bf16 v[80:83],a[148:151],a[36:39],v[80:83]
s_add_u32 s21,s21,12288
v_exp_f32 v101,v101
v_mfma_f32_16x16x32_bf16 v[80:83],a[120:123],a[40:43],v[80:83]
s_add_u32 m0,s22,12288
v_exp_f32 v102,v102
v_mfma_f32_16x16x32_bf16 v[80:83],a[124:127],a[44:47],v[80:83]
v_exp_f32 v103,v103
v_mfma_f32_16x16x32_bf16 v[88:91],a[124:127],a[68:71],0
v_cvt_pk_bf16_f32 v58,v100,v101
v_cvt_pk_bf16_f32 v59,v102,v103
v_mfma_f32_16x16x32_bf16 v[88:91],a[120:123],a[64:67],v[88:91]
v_fma_f32 v72,v72,s36,v13
v_fma_f32 v73,v73,s36,v13
v_smfmac_f32_16x16x64_bf16 v[64:67],a[152:155],v[52:59],v18
v_fma_f32 v74,v74,s36,v13
v_mfma_f32_16x16x32_bf16 v[88:91],a[148:151],a[60:63],v[88:91]
v_fma_f32 v75,v75,s36,v13
v_fma_f32 v80,v80,s36,v14
v_mfma_f32_16x16x32_bf16 v[88:91],a[144:147],a[56:59],v[88:91]
v_fma_f32 v81,v81,s36,v14
v_mfma_f32_16x16x32_bf16 v[88:91],a[140:143],a[52:55],v[88:91]
buffer_load_dwordx4 v6,s[4:7],s20 offen offset:0 lds
v_mfma_f32_16x16x32_bf16 v[88:91],a[136:139],a[48:51],v[88:91]
v_exp_f32 v72,v72
v_mfma_f32_16x16x32_bf16 v[96:99],a[136:139],a[72:75],0
ds_read_b128 a[136:139],v0 offset:30848
v_mfma_f32_16x16x32_bf16 v[96:99],a[140:143],a[76:79],v[96:99]
ds_read_b128 a[140:143],v1 offset:30848
v_mfma_f32_16x16x32_bf16 v[96:99],a[144:147],a[80:83],v[96:99]
ds_read_b128 a[144:147],v0 offset:30976
v_mfma_f32_16x16x32_bf16 v[96:99],a[148:151],a[84:87],v[96:99]
ds_read_b128 a[148:151],v1 offset:30976
v_mfma_f32_16x16x32_bf16 v[96:99],a[120:123],a[88:91],v[96:99]
v_exp_f32 v73,v73
v_mfma_f32_16x16x32_bf16 v[96:99],a[124:127],a[92:95],v[96:99]
s_waitcnt lgkmcnt(4)
v_exp_f32 v74,v74
v_mfma_f32_16x16x32_bf16 v[76:79],a[128:131],a[0:3],0
v_exp_f32 v75,v75
v_mfma_f32_16x16x32_bf16 v[76:79],a[132:135],a[4:7],v[76:79]
buffer_load_dwordx4 v7,s[4:7],s20 offen offset:1024 lds
s_waitcnt lgkmcnt(3)
v_mfma_f32_16x16x32_bf16 v[76:79],a[136:139],a[8:11],v[76:79]
s_waitcnt lgkmcnt(2)
v_exp_f32 v80,v80
v_mfma_f32_16x16x32_bf16 v[76:79],a[140:143],a[12:15],v[76:79]
s_waitcnt lgkmcnt(0)
v_exp_f32 v81,v81
v_mfma_f32_16x16x32_bf16 v[76:79],a[144:147],a[16:19],v[76:79]
v_cvt_pk_bf16_f32 v20,v72,v73
v_cvt_pk_bf16_f32 v21,v74,v75
v_mfma_f32_16x16x32_bf16 v[76:79],a[148:151],a[20:23],v[76:79]
v_cvt_pk_bf16_f32 v24,v80,v81
v_mfma_f32_16x16x32_bf16 v[84:87],a[148:151],a[44:47],0
v_mfma_f32_16x16x32_bf16 v[84:87],a[144:147],a[40:43],v[84:87]
v_mfma_f32_16x16x32_bf16 v[84:87],a[140:143],a[36:39],v[84:87]
v_mfma_f32_16x16x32_bf16 v[84:87],a[136:139],a[32:35],v[84:87]
v_mfma_f32_16x16x32_bf16 v[84:87],a[132:135],a[28:31],v[84:87]
buffer_load_dwordx4 v8,s[4:7],s20 offen offset:2048 lds
v_mfma_f32_16x16x32_bf16 v[84:87],a[128:131],a[24:27],v[84:87]
s_add_u32 s20,s20,12288
v_mfma_f32_16x16x32_bf16 v[92:95],a[128:131],a[48:51],0
ds_read_b64_tr_b16 a[120:121],v2 offset:12288
v_mfma_f32_16x16x32_bf16 v[92:95],a[132:135],a[52:55],v[92:95]
ds_read_b64_tr_b16 a[122:123],v2 offset:18432
v_mfma_f32_16x16x32_bf16 v[92:95],a[136:139],a[56:59],v[92:95]
ds_read_b64_tr_b16 a[124:125],v3 offset:12288
v_mfma_f32_16x16x32_bf16 v[92:95],a[140:143],a[60:63],v[92:95]
ds_read_b64_tr_b16 a[126:127],v3 offset:18432
v_mfma_f32_16x16x32_bf16 v[92:95],a[144:147],a[64:67],v[92:95]
v_mfma_f32_16x16x32_bf16 v[92:95],a[148:151],a[68:71],v[92:95]
v_mfma_f32_16x16x32_bf16 v[100:103],a[148:151],a[92:95],0
v_mfma_f32_16x16x32_bf16 v[100:103],a[144:147],a[88:91],v[100:103]
v_mfma_f32_16x16x32_bf16 v[100:103],a[140:143],a[84:87],v[100:103]
v_mfma_f32_16x16x32_bf16 v[100:103],a[136:139],a[80:83],v[100:103]
v_mfma_f32_16x16x32_bf16 v[100:103],a[132:135],a[76:79],v[100:103]
ds_read_b64_tr_b16 a[132:133],v5 offset:12288
v_mfma_f32_16x16x32_bf16 v[100:103],a[128:131],a[72:75],v[100:103]
s_waitcnt lgkmcnt(1)
ds_read_b64_tr_b16 a[128:129],v4 offset:12288
ds_read_b64_tr_b16 a[130:131],v4 offset:18432
ds_read_b64_tr_b16 a[134:135],v5 offset:18432
v_mfma_f32_16x16x32_bf16 v[160:163],a[120:123],v[44:47],v[160:163]
s_add_u32 m0,s23,12288
ds_read_b64_tr_b16 a[136:137],v2 offset:12416
v_fma_f32 v82,v82,s36,v14
v_mfma_f32_16x16x32_bf16 v[164:167],a[124:127],v[44:47],v[164:167]
ds_read_b64_tr_b16 a[138:139],v2 offset:18560
v_fma_f32 v83,v83,s36,v14
v_mfma_f32_16x16x32_bf16 v[212:215],a[124:127],v[48:51],v[212:215]
ds_read_b64_tr_b16 a[140:141],v3 offset:12416
v_fma_f32 v88,v88,s36,v15
v_mfma_f32_16x16x32_bf16 v[208:211],a[120:123],v[48:51],v[208:211]
ds_read_b64_tr_b16 a[142:143],v3 offset:18560
v_fma_f32 v89,v89,s36,v15
v_mfma_f32_16x16x32_bf16 v[112:115],a[120:123],v[52:55],v[112:115]
ds_read_b64_tr_b16 a[144:145],v4 offset:12416
v_fma_f32 v90,v90,s36,v15
v_mfma_f32_16x16x32_bf16 v[116:119],a[124:127],v[52:55],v[116:119]
ds_read_b64_tr_b16 a[146:147],v4 offset:18560
v_fma_f32 v91,v91,s36,v15
v_mfma_f32_16x16x32_bf16 a[164:167],a[124:127],v[56:59],a[164:167]
ds_read_b64_tr_b16 a[148:149],v5 offset:12416
v_fma_f32 v96,v96,s36,v16
v_mfma_f32_16x16x32_bf16 a[160:163],a[120:123],v[56:59],a[160:163]
s_waitcnt lgkmcnt(6)
ds_read_b64_tr_b16 a[150:151],v5 offset:18560
v_fma_f32 v97,v97,s36,v16
v_mfma_f32_16x16x32_bf16 a[168:171],a[128:131],v[56:59],a[168:171]
ds_read_b64_tr_b16 a[120:121],v2 offset:12544
v_fma_f32 v98,v98,s36,v16
v_mfma_f32_16x16x32_bf16 a[172:175],a[132:135],v[56:59],a[172:175]
ds_read_b64_tr_b16 a[122:123],v2 offset:18688
v_fma_f32 v99,v99,s36,v16
v_mfma_f32_16x16x32_bf16 v[124:127],a[132:135],v[52:55],v[124:127]
ds_read_b64_tr_b16 a[124:125],v3 offset:12544
v_fma_f32 v76,v76,s36,v13
v_mfma_f32_16x16x32_bf16 v[120:123],a[128:131],v[52:55],v[120:123]
ds_read_b64_tr_b16 a[126:127],v3 offset:18688
v_fma_f32 v77,v77,s36,v13
v_mfma_f32_16x16x32_bf16 v[216:219],a[128:131],v[48:51],v[216:219]
v_exp_f32 v82,v82
v_mfma_f32_16x16x32_bf16 v[220:223],a[132:135],v[48:51],v[220:223]
v_exp_f32 v83,v83
v_mfma_f32_16x16x32_bf16 v[172:175],a[132:135],v[44:47],v[172:175]
ds_read_b64_tr_b16 a[132:133],v5 offset:12544
v_cvt_pk_bf16_f32 v25,v82,v83
v_mfma_f32_16x16x32_bf16 v[168:171],a[128:131],v[44:47],v[168:171]
s_waitcnt lgkmcnt(4)
ds_read_b64_tr_b16 a[128:129],v4 offset:12544
v_fma_f32 v78,v78,s36,v13
v_mfma_f32_16x16x32_bf16 v[176:179],a[136:139],v[44:47],v[176:179]
ds_read_b64_tr_b16 a[130:131],v4 offset:18688
v_fma_f32 v79,v79,s36,v13
v_mfma_f32_16x16x32_bf16 v[180:183],a[140:143],v[44:47],v[180:183]
ds_read_b64_tr_b16 a[134:135],v5 offset:18688
v_fma_f32 v84,v84,s36,v14
v_mfma_f32_16x16x32_bf16 v[228:231],a[140:143],v[48:51],v[228:231]
v_exp_f32 v88,v88
v_mfma_f32_16x16x32_bf16 v[224:227],a[136:139],v[48:51],v[224:227]
v_exp_f32 v89,v89
v_mfma_f32_16x16x32_bf16 v[128:131],a[136:139],v[52:55],v[128:131]
v_exp_f32 v90,v90
v_mfma_f32_16x16x32_bf16 v[132:135],a[140:143],v[52:55],v[132:135]
v_exp_f32 v91,v91
v_mfma_f32_16x16x32_bf16 a[180:183],a[140:143],v[56:59],a[180:183]
v_cvt_pk_bf16_f32 v28,v88,v89
v_cvt_pk_bf16_f32 v29,v90,v91
v_mfma_f32_16x16x32_bf16 a[176:179],a[136:139],v[56:59],a[176:179]
v_exp_f32 v96,v96
v_mfma_f32_16x16x32_bf16 a[184:187],a[144:147],v[56:59],a[184:187]
v_exp_f32 v97,v97
v_mfma_f32_16x16x32_bf16 a[188:191],a[148:151],v[56:59],a[188:191]
v_exp_f32 v98,v98
v_mfma_f32_16x16x32_bf16 v[140:143],a[148:151],v[52:55],v[140:143]
v_exp_f32 v99,v99
v_mfma_f32_16x16x32_bf16 v[136:139],a[144:147],v[52:55],v[136:139]
v_cvt_pk_bf16_f32 v32,v96,v97
v_cvt_pk_bf16_f32 v33,v98,v99
v_mfma_f32_16x16x32_bf16 v[232:235],a[144:147],v[48:51],v[232:235]
v_exp_f32 v76,v76
v_mfma_f32_16x16x32_bf16 v[236:239],a[148:151],v[48:51],v[236:239]
v_exp_f32 v77,v77
v_mfma_f32_16x16x32_bf16 v[188:191],a[148:151],v[44:47],v[188:191]
v_exp_f32 v78,v78
v_mfma_f32_16x16x32_bf16 v[184:187],a[144:147],v[44:47],v[184:187]
s_waitcnt lgkmcnt(0)
v_exp_f32 v79,v79
v_mfma_f32_16x16x32_bf16 v[192:195],a[120:123],v[44:47],v[192:195]
v_cvt_pk_bf16_f32 v22,v76,v77
v_cvt_pk_bf16_f32 v23,v78,v79
v_mfma_f32_16x16x32_bf16 v[196:199],a[124:127],v[44:47],v[196:199]
s_waitcnt vmcnt(6)
v_fma_f32 v85,v85,s36,v14
v_fma_f32 v86,v86,s36,v14
v_mfma_f32_16x16x32_bf16 v[244:247],a[124:127],v[48:51],v[244:247]
s_barrier
v_mfma_f32_16x16x32_bf16 v[240:243],a[120:123],v[48:51],v[240:243]
ds_read_b128 a[148:151],v1 offset:128
v_fma_f32 v87,v87,s36,v14
v_mfma_f32_16x16x32_bf16 v[144:147],a[120:123],v[52:55],v[144:147]
ds_read_b128 a[144:147],v0 offset:128
v_fma_f32 v92,v92,s36,v15
v_mfma_f32_16x16x32_bf16 v[148:151],a[124:127],v[52:55],v[148:151]
ds_read_b128 a[140:143],v1 offset:0
v_fma_f32 v93,v93,s36,v15
v_mfma_f32_16x16x32_bf16 a[196:199],a[124:127],v[56:59],a[196:199]
ds_read_b128 a[124:127],v1 offset:256
v_fma_f32 v94,v94,s36,v15
v_mfma_f32_16x16x32_bf16 a[192:195],a[120:123],v[56:59],a[192:195]
ds_read_b128 a[120:123],v0 offset:256
v_fma_f32 v95,v95,s36,v15
v_mfma_f32_16x16x32_bf16 a[200:203],a[128:131],v[56:59],a[200:203]
buffer_load_dwordx4 v6,s[8:11],s21 offen offset:0 lds
v_mfma_f32_16x16x32_bf16 a[204:207],a[132:135],v[56:59],a[204:207]
ds_read_b128 a[136:139],v0 offset:0
v_fma_f32 v100,v100,s36,v16
v_mfma_f32_16x16x32_bf16 v[156:159],a[132:135],v[52:55],v[156:159]
v_exp_f32 v84,v84
v_mfma_f32_16x16x32_bf16 v[152:155],a[128:131],v[52:55],v[152:155]
v_exp_f32 v85,v85
v_mfma_f32_16x16x32_bf16 v[248:251],a[128:131],v[48:51],v[248:251]
v_exp_f32 v86,v86
v_mfma_f32_16x16x32_bf16 v[252:255],a[132:135],v[48:51],v[252:255]
v_exp_f32 v87,v87
v_mfma_f32_16x16x32_bf16 v[204:207],a[132:135],v[44:47],v[204:207]
ds_read_b128 a[132:135],v1 offset:6144
v_cvt_pk_bf16_f32 v26,v84,v85
v_mfma_f32_16x16x32_bf16 v[200:203],a[128:131],v[44:47],v[200:203]
s_waitcnt lgkmcnt(2)
ds_read_b128 a[128:131],v0 offset:6144
v_cvt_pk_bf16_f32 v27,v86,v87
v_mfma_f32_16x16x32_bf16 v[72:75],a[124:127],a[20:23],0
v_exp_f32 v92,v92
v_smfmac_f32_16x16x64_bf16 v[60:63],a[152:155],v[20:27],v18
buffer_load_dwordx4 v7,s[8:11],s21 offen offset:1024 lds
v_mfma_f32_16x16x32_bf16 v[72:75],a[120:123],a[16:19],v[72:75]
v_exp_f32 v93,v93
v_mfma_f32_16x16x32_bf16 v[72:75],a[148:151],a[12:15],v[72:75]
v_exp_f32 v94,v94
v_mfma_f32_16x16x32_bf16 v[72:75],a[144:147],a[8:11],v[72:75]
v_exp_f32 v95,v95
v_mfma_f32_16x16x32_bf16 v[72:75],a[140:143],a[4:7],v[72:75]
s_waitcnt lgkmcnt(1)
v_cvt_pk_bf16_f32 v30,v92,v93
v_cvt_pk_bf16_f32 v31,v94,v95
v_mfma_f32_16x16x32_bf16 v[72:75],a[136:139],a[0:3],v[72:75]
v_fma_f32 v101,v101,s36,v16
v_fma_f32 v102,v102,s36,v16
v_mfma_f32_16x16x32_bf16 v[80:83],a[136:139],a[24:27],0
v_fma_f32 v103,v103,s36,v16
v_mfma_f32_16x16x32_bf16 v[80:83],a[140:143],a[28:31],v[80:83]
v_exp_f32 v100,v100
v_mfma_f32_16x16x32_bf16 v[80:83],a[144:147],a[32:35],v[80:83]
buffer_load_dwordx4 v8,s[8:11],s21 offen offset:2048 lds
v_mfma_f32_16x16x32_bf16 v[80:83],a[148:151],a[36:39],v[80:83]
s_add_u32 s21,s21,12288
v_exp_f32 v101,v101
v_mfma_f32_16x16x32_bf16 v[80:83],a[120:123],a[40:43],v[80:83]
s_add_u32 m0,s22,24576
v_exp_f32 v102,v102
v_mfma_f32_16x16x32_bf16 v[80:83],a[124:127],a[44:47],v[80:83]
v_exp_f32 v103,v103
v_mfma_f32_16x16x32_bf16 v[88:91],a[124:127],a[68:71],0
v_cvt_pk_bf16_f32 v34,v100,v101
v_cvt_pk_bf16_f32 v35,v102,v103
v_mfma_f32_16x16x32_bf16 v[88:91],a[120:123],a[64:67],v[88:91]
v_fma_f32 v72,v72,s36,v13
v_fma_f32 v73,v73,s36,v13
v_smfmac_f32_16x16x64_bf16 v[64:67],a[152:155],v[28:35],v18
v_fma_f32 v74,v74,s36,v13
v_mfma_f32_16x16x32_bf16 v[88:91],a[148:151],a[60:63],v[88:91]
v_fma_f32 v75,v75,s36,v13
v_fma_f32 v80,v80,s36,v14
v_mfma_f32_16x16x32_bf16 v[88:91],a[144:147],a[56:59],v[88:91]
v_fma_f32 v81,v81,s36,v14
v_mfma_f32_16x16x32_bf16 v[88:91],a[140:143],a[52:55],v[88:91]
buffer_load_dwordx4 v6,s[4:7],s20 offen offset:0 lds
v_mfma_f32_16x16x32_bf16 v[88:91],a[136:139],a[48:51],v[88:91]
v_exp_f32 v72,v72
v_mfma_f32_16x16x32_bf16 v[96:99],a[136:139],a[72:75],0
ds_read_b128 a[136:139],v0 offset:6272
v_mfma_f32_16x16x32_bf16 v[96:99],a[140:143],a[76:79],v[96:99]
ds_read_b128 a[140:143],v1 offset:6272
v_mfma_f32_16x16x32_bf16 v[96:99],a[144:147],a[80:83],v[96:99]
ds_read_b128 a[144:147],v0 offset:6400
v_mfma_f32_16x16x32_bf16 v[96:99],a[148:151],a[84:87],v[96:99]
ds_read_b128 a[148:151],v1 offset:6400
v_mfma_f32_16x16x32_bf16 v[96:99],a[120:123],a[88:91],v[96:99]
v_exp_f32 v73,v73
v_mfma_f32_16x16x32_bf16 v[96:99],a[124:127],a[92:95],v[96:99]
s_waitcnt lgkmcnt(4)
v_exp_f32 v74,v74
v_mfma_f32_16x16x32_bf16 v[76:79],a[128:131],a[0:3],0
v_exp_f32 v75,v75
v_mfma_f32_16x16x32_bf16 v[76:79],a[132:135],a[4:7],v[76:79]
buffer_load_dwordx4 v7,s[4:7],s20 offen offset:1024 lds
s_waitcnt lgkmcnt(3)
v_mfma_f32_16x16x32_bf16 v[76:79],a[136:139],a[8:11],v[76:79]
s_waitcnt lgkmcnt(2)
v_exp_f32 v80,v80
v_mfma_f32_16x16x32_bf16 v[76:79],a[140:143],a[12:15],v[76:79]
s_waitcnt lgkmcnt(0)
v_exp_f32 v81,v81
v_mfma_f32_16x16x32_bf16 v[76:79],a[144:147],a[16:19],v[76:79]
v_cvt_pk_bf16_f32 v44,v72,v73
v_cvt_pk_bf16_f32 v45,v74,v75
v_mfma_f32_16x16x32_bf16 v[76:79],a[148:151],a[20:23],v[76:79]
v_cvt_pk_bf16_f32 v48,v80,v81
v_mfma_f32_16x16x32_bf16 v[84:87],a[148:151],a[44:47],0
v_mfma_f32_16x16x32_bf16 v[84:87],a[144:147],a[40:43],v[84:87]
v_mfma_f32_16x16x32_bf16 v[84:87],a[140:143],a[36:39],v[84:87]
v_mfma_f32_16x16x32_bf16 v[84:87],a[136:139],a[32:35],v[84:87]
v_mfma_f32_16x16x32_bf16 v[84:87],a[132:135],a[28:31],v[84:87]
buffer_load_dwordx4 v8,s[4:7],s20 offen offset:2048 lds
v_mfma_f32_16x16x32_bf16 v[84:87],a[128:131],a[24:27],v[84:87]
s_add_u32 s20,s20,12288
v_mfma_f32_16x16x32_bf16 v[92:95],a[128:131],a[48:51],0
ds_read_b64_tr_b16 a[120:121],v2 offset:24576
v_mfma_f32_16x16x32_bf16 v[92:95],a[132:135],a[52:55],v[92:95]
ds_read_b64_tr_b16 a[122:123],v2 offset:30720
v_mfma_f32_16x16x32_bf16 v[92:95],a[136:139],a[56:59],v[92:95]
ds_read_b64_tr_b16 a[124:125],v3 offset:24576
v_mfma_f32_16x16x32_bf16 v[92:95],a[140:143],a[60:63],v[92:95]
ds_read_b64_tr_b16 a[126:127],v3 offset:30720
v_mfma_f32_16x16x32_bf16 v[92:95],a[144:147],a[64:67],v[92:95]
v_mfma_f32_16x16x32_bf16 v[92:95],a[148:151],a[68:71],v[92:95]
v_mfma_f32_16x16x32_bf16 v[100:103],a[148:151],a[92:95],0
v_mfma_f32_16x16x32_bf16 v[100:103],a[144:147],a[88:91],v[100:103]
v_mfma_f32_16x16x32_bf16 v[100:103],a[140:143],a[84:87],v[100:103]
v_mfma_f32_16x16x32_bf16 v[100:103],a[136:139],a[80:83],v[100:103]
v_mfma_f32_16x16x32_bf16 v[100:103],a[132:135],a[76:79],v[100:103]
ds_read_b64_tr_b16 a[132:133],v5 offset:24576
v_mfma_f32_16x16x32_bf16 v[100:103],a[128:131],a[72:75],v[100:103]
ds_read_b64_tr_b16 a[128:129],v4 offset:24576
ds_read_b64_tr_b16 a[130:131],v4 offset:30720
ds_read_b64_tr_b16 a[134:135],v5 offset:30720
s_mov_b32 s38,0
s_branch L_loop4
L_end5:
s_waitcnt lgkmcnt(3)
v_mfma_f32_16x16x32_bf16 v[160:163],a[120:123],v[20:23],v[160:163]
ds_read_b64_tr_b16 a[136:137],v2 offset:24704
v_fma_f32 v90,v90,s36,v15
v_mfma_f32_16x16x32_bf16 v[164:167],a[124:127],v[20:23],v[164:167]
ds_read_b64_tr_b16 a[138:139],v2 offset:30848
v_fma_f32 v91,v91,s36,v15
v_mfma_f32_16x16x32_bf16 v[212:215],a[124:127],v[24:27],v[212:215]
ds_read_b64_tr_b16 a[140:141],v3 offset:24704
v_fma_f32 v96,v96,s36,v16
v_mfma_f32_16x16x32_bf16 v[208:211],a[120:123],v[24:27],v[208:211]
ds_read_b64_tr_b16 a[142:143],v3 offset:30848
v_fma_f32 v97,v97,s36,v16
v_mfma_f32_16x16x32_bf16 v[112:115],a[120:123],v[28:31],v[112:115]
ds_read_b64_tr_b16 a[144:145],v4 offset:24704
v_fma_f32 v98,v98,s36,v16
v_mfma_f32_16x16x32_bf16 v[116:119],a[124:127],v[28:31],v[116:119]
ds_read_b64_tr_b16 a[146:147],v4 offset:30848
ds_read_b64_tr_b16 a[148:149],v5 offset:24704
ds_read_b64_tr_b16 a[150:151],v5 offset:30848
v_mfma_f32_16x16x32_bf16 a[164:167],a[124:127],v[32:35],a[164:167]
v_fma_f32 v99,v99,s36,v16
v_fma_f32 v104,v104,s36,v17
v_mfma_f32_16x16x32_bf16 a[160:163],a[120:123],v[32:35],a[160:163]
v_fma_f32 v105,v105,s36,v17
v_fma_f32 v106,v106,s36,v17
v_mfma_f32_16x16x32_bf16 a[208:211],a[120:123],v[36:39],a[208:211]
ds_read_b64_tr_b16 a[120:121],v2 offset:24832
v_fma_f32 v107,v107,s36,v17
v_mfma_f32_16x16x32_bf16 a[212:215],a[124:127],v[36:39],a[212:215]
s_waitcnt lgkmcnt(6)
ds_read_b64_tr_b16 a[122:123],v2 offset:30976
v_fma_f32 v76,v76,s36,v13
v_mfma_f32_16x16x32_bf16 a[216:219],a[128:131],v[36:39],a[216:219]
ds_read_b64_tr_b16 a[124:125],v3 offset:24832
v_fma_f32 v77,v77,s36,v13
v_mfma_f32_16x16x32_bf16 a[220:223],a[132:135],v[36:39],a[220:223]
ds_read_b64_tr_b16 a[126:127],v3 offset:30976
v_fma_f32 v78,v78,s36,v13
v_mfma_f32_16x16x32_bf16 a[172:175],a[132:135],v[32:35],a[172:175]
v_fma_f32 v79,v79,s36,v13
v_fma_f32 v84,v84,s36,v14
v_mfma_f32_16x16x32_bf16 a[168:171],a[128:131],v[32:35],a[168:171]
v_fma_f32 v85,v85,s36,v14
v_fma_f32 v86,v86,s36,v14
v_mfma_f32_16x16x32_bf16 v[120:123],a[128:131],v[28:31],v[120:123]
v_fma_f32 v87,v87,s36,v14
v_fma_f32 v92,v92,s36,v15
v_mfma_f32_16x16x32_bf16 v[124:127],a[132:135],v[28:31],v[124:127]
v_fma_f32 v93,v93,s36,v15
v_fma_f32 v94,v94,s36,v15
v_mfma_f32_16x16x32_bf16 v[220:223],a[132:135],v[24:27],v[220:223]
v_fma_f32 v95,v95,s36,v15
v_fma_f32 v100,v100,s36,v16
v_mfma_f32_16x16x32_bf16 v[216:219],a[128:131],v[24:27],v[216:219]
v_fma_f32 v101,v101,s36,v16
v_fma_f32 v102,v102,s36,v16
v_mfma_f32_16x16x32_bf16 v[168:171],a[128:131],v[20:23],v[168:171]
ds_read_b64_tr_b16 a[128:129],v4 offset:24832
v_fma_f32 v103,v103,s36,v16
v_mfma_f32_16x16x32_bf16 v[172:175],a[132:135],v[20:23],v[172:175]
ds_read_b64_tr_b16 a[130:131],v4 offset:30976
v_fma_f32 v108,v108,s36,v17
v_mfma_f32_16x16x32_bf16 v[176:179],a[136:139],v[20:23],v[176:179]
s_waitcnt lgkmcnt(2)
ds_read_b64_tr_b16 a[132:133],v5 offset:24832
v_fma_f32 v109,v109,s36,v17
v_mfma_f32_16x16x32_bf16 v[180:183],a[140:143],v[20:23],v[180:183]
ds_read_b64_tr_b16 a[134:135],v5 offset:30976
v_fma_f32 v110,v110,s36,v17
v_mfma_f32_16x16x32_bf16 v[228:231],a[140:143],v[24:27],v[228:231]
v_fma_f32 v111,v111,s36,v17
v_exp_f32 v90,v90
v_mfma_f32_16x16x32_bf16 v[224:227],a[136:139],v[24:27],v[224:227]
v_exp_f32 v91,v91
v_mfma_f32_16x16x32_bf16 v[128:131],a[136:139],v[28:31],v[128:131]
v_exp_f32 v96,v96
v_mfma_f32_16x16x32_bf16 v[132:135],a[140:143],v[28:31],v[132:135]
v_exp_f32 v97,v97
v_mfma_f32_16x16x32_bf16 a[180:183],a[140:143],v[32:35],a[180:183]
v_exp_f32 v98,v98
v_mfma_f32_16x16x32_bf16 a[176:179],a[136:139],v[32:35],a[176:179]
v_exp_f32 v99,v99
v_mfma_f32_16x16x32_bf16 a[224:227],a[136:139],v[36:39],a[224:227]
v_exp_f32 v104,v104
v_mfma_f32_16x16x32_bf16 a[228:231],a[140:143],v[36:39],a[228:231]
v_exp_f32 v105,v105
v_mfma_f32_16x16x32_bf16 a[232:235],a[144:147],v[36:39],a[232:235]
v_exp_f32 v106,v106
v_mfma_f32_16x16x32_bf16 a[236:239],a[148:151],v[36:39],a[236:239]
v_exp_f32 v107,v107
v_mfma_f32_16x16x32_bf16 a[188:191],a[148:151],v[32:35],a[188:191]
v_exp_f32 v76,v76
v_mfma_f32_16x16x32_bf16 a[184:187],a[144:147],v[32:35],a[184:187]
v_exp_f32 v77,v77
v_mfma_f32_16x16x32_bf16 v[136:139],a[144:147],v[28:31],v[136:139]
v_exp_f32 v78,v78
v_mfma_f32_16x16x32_bf16 v[140:143],a[148:151],v[28:31],v[140:143]
v_exp_f32 v79,v79
v_mfma_f32_16x16x32_bf16 v[236:239],a[148:151],v[24:27],v[236:239]
v_exp_f32 v84,v84
v_mfma_f32_16x16x32_bf16 v[232:235],a[144:147],v[24:27],v[232:235]
v_exp_f32 v85,v85
v_mfma_f32_16x16x32_bf16 v[184:187],a[144:147],v[20:23],v[184:187]
v_exp_f32 v86,v86
v_mfma_f32_16x16x32_bf16 v[188:191],a[148:151],v[20:23],v[188:191]
v_exp_f32 v87,v87
v_mfma_f32_16x16x32_bf16 v[192:195],a[120:123],v[20:23],v[192:195]
v_exp_f32 v92,v92
v_mfma_f32_16x16x32_bf16 v[196:199],a[124:127],v[20:23],v[196:199]
v_exp_f32 v93,v93
v_mfma_f32_16x16x32_bf16 v[244:247],a[124:127],v[24:27],v[244:247]
v_exp_f32 v94,v94
v_mfma_f32_16x16x32_bf16 v[240:243],a[120:123],v[24:27],v[240:243]
v_exp_f32 v95,v95
v_mfma_f32_16x16x32_bf16 v[144:147],a[120:123],v[28:31],v[144:147]
v_exp_f32 v100,v100
v_mfma_f32_16x16x32_bf16 v[148:151],a[124:127],v[28:31],v[148:151]
v_exp_f32 v101,v101
v_mfma_f32_16x16x32_bf16 a[196:199],a[124:127],v[32:35],a[196:199]
v_exp_f32 v102,v102
v_mfma_f32_16x16x32_bf16 a[192:195],a[120:123],v[32:35],a[192:195]
v_exp_f32 v103,v103
v_mfma_f32_16x16x32_bf16 a[240:243],a[120:123],v[36:39],a[240:243]
v_exp_f32 v108,v108
s_waitcnt vmcnt(14) lgkmcnt(0)
s_barrier
v_mfma_f32_16x16x32_bf16 a[244:247],a[124:127],v[36:39],a[244:247]
v_exp_f32 v109,v109
v_mfma_f32_16x16x32_bf16 a[248:251],a[128:131],v[36:39],a[248:251]
v_exp_f32 v110,v110
v_mfma_f32_16x16x32_bf16 a[252:255],a[132:135],v[36:39],a[252:255]
v_exp_f32 v111,v111
v_mfma_f32_16x16x32_bf16 a[204:207],a[132:135],v[32:35],a[204:207]
v_cvt_pk_bf16_f32 v53,v90,v91
v_cvt_pk_bf16_f32 v56,v96,v97
v_mfma_f32_16x16x32_bf16 a[200:203],a[128:131],v[32:35],a[200:203]
v_cvt_pk_bf16_f32 v57,v98,v99
v_cvt_pk_bf16_f32 v40,v104,v105
v_mfma_f32_16x16x32_bf16 v[152:155],a[128:131],v[28:31],v[152:155]
v_cvt_pk_bf16_f32 v41,v106,v107
v_cvt_pk_bf16_f32 v46,v76,v77
v_mfma_f32_16x16x32_bf16 v[156:159],a[132:135],v[28:31],v[156:159]
v_cvt_pk_bf16_f32 v47,v78,v79
v_cvt_pk_bf16_f32 v50,v84,v85
v_mfma_f32_16x16x32_bf16 v[252:255],a[132:135],v[24:27],v[252:255]
v_cvt_pk_bf16_f32 v51,v86,v87
v_cvt_pk_bf16_f32 v54,v92,v93
v_mfma_f32_16x16x32_bf16 v[248:251],a[128:131],v[24:27],v[248:251]
v_cvt_pk_bf16_f32 v55,v94,v95
v_cvt_pk_bf16_f32 v58,v100,v101
v_smfmac_f32_16x16x64_bf16 v[60:63],a[152:155],v[44:51],v18
v_cvt_pk_bf16_f32 v59,v102,v103
v_mfma_f32_16x16x32_bf16 v[200:203],a[128:131],v[20:23],v[200:203]
v_cvt_pk_bf16_f32 v42,v108,v109
v_cvt_pk_bf16_f32 v43,v110,v111
v_smfmac_f32_16x16x64_bf16 v[64:67],a[152:155],v[52:59],v18
v_subrev_u32 v10,18432,v10
v_smfmac_f32_16x16x64_bf16 v[68:71],a[152:155],v[36:43],v18
v_mfma_f32_16x16x32_bf16 v[204:207],a[132:135],v[20:23],v[204:207]
ds_read_b64_tr_b16 a[136:137],v2 offset:0
ds_read_b64_tr_b16 a[138:139],v2 offset:6144
ds_read_b64_tr_b16 a[140:141],v3 offset:0
ds_read_b64_tr_b16 a[142:143],v3 offset:6144
ds_read_b64_tr_b16 a[144:145],v4 offset:0
ds_read_b64_tr_b16 a[146:147],v4 offset:6144
ds_read_b64_tr_b16 a[148:149],v5 offset:0
ds_read_b64_tr_b16 a[150:151],v5 offset:6144
s_waitcnt lgkmcnt(6)
v_mfma_f32_16x16x32_bf16 v[160:163],a[136:139],v[44:47],v[160:163]
s_waitcnt vmcnt(6)
ds_read_b64_tr_b16 a[122:123],v2 offset:6272
v_mbcnt_lo_u32_b32 v39,-1,0
s_waitcnt lgkmcnt(5)
v_mfma_f32_16x16x32_bf16 v[164:167],a[140:143],v[44:47],v[164:167]
s_add_u32 s84,s42,0
ds_read_b64_tr_b16 a[120:121],v2 offset:128
v_mbcnt_hi_u32_b32 v39,-1,v39
v_mfma_f32_16x16x32_bf16 v[212:215],a[140:143],v[48:51],v[212:215]
s_add_u32 s85,s42,6144
ds_read_b64_tr_b16 a[126:127],v3 offset:6272
v_and_b32 v38,7,v39
v_mfma_f32_16x16x32_bf16 v[208:211],a[136:139],v[48:51],v[208:211]
s_add_u32 s86,s42,12288
ds_read_b64_tr_b16 a[124:125],v3 offset:128
v_add_f32 v60,v60,v61
v_mfma_f32_16x16x32_bf16 v[112:115],a[136:139],v[52:55],v[112:115]
s_add_u32 s87,s42,18432
ds_read_b64_tr_b16 a[128:129],v4 offset:128
v_add_f32 v64,v64,v65
v_mfma_f32_16x16x32_bf16 v[116:119],a[140:143],v[52:55],v[116:119]
s_add_u32 s66,s42,24576
ds_read_b64_tr_b16 a[130:131],v4 offset:6272
v_add_f32 v62,v62,v63
v_mfma_f32_16x16x32_bf16 a[164:167],a[140:143],v[56:59],a[164:167]
ds_read_b64_tr_b16 a[132:133],v5 offset:128
v_max3_f32 v19,v60,v62,v64
v_mfma_f32_16x16x32_bf16 a[160:163],a[136:139],v[56:59],a[160:163]
ds_read_b64_tr_b16 a[134:135],v5 offset:6272
v_add_f32 v68,v68,v69
v_mfma_f32_16x16x32_bf16 a[208:211],a[136:139],v[40:43],a[208:211]
ds_read_b64_tr_b16 a[136:137],v2 offset:256
v_add_f32 v68,v68,v70
v_mfma_f32_16x16x32_bf16 a[212:215],a[140:143],v[40:43],a[212:215]
s_waitcnt lgkmcnt(6)
ds_read_b64_tr_b16 a[138:139],v2 offset:6400
v_add_f32 v66,v66,v67
v_mfma_f32_16x16x32_bf16 a[216:219],a[144:147],v[40:43],a[216:219]
ds_read_b64_tr_b16 a[140:141],v3 offset:256
v_add_f32 v68,v68,v71
v_mfma_f32_16x16x32_bf16 a[220:223],a[148:151],v[40:43],a[220:223]
ds_read_b64_tr_b16 a[142:143],v3 offset:6400
v_max3_f32 v19,v19,v66,v68
v_rcp_f32 v66,v66
v_rcp_f32 v68,v68
v_accvgpr_read_b32 v74,a162
v_accvgpr_read_b32 v75,a163
v_pk_mul_f32 v[74:75],v[74:75],v[66:67] op_sel_hi:[1,0]
v_accvgpr_read_b32 v79,a211
v_accvgpr_read_b32 v72,a160
v_accvgpr_read_b32 v76,a208
v_accvgpr_read_b32 v73,a161
v_pk_mul_f32 v[72:73],v[72:73],v[66:67] op_sel_hi:[1,0]
v_accvgpr_read_b32 v77,a209
v_pk_mul_f32 v[76:77],v[76:77],v[68:69] op_sel_hi:[1,0]
v_accvgpr_read_b32 v78,a210
v_pk_mul_f32 v[78:79],v[78:79],v[68:69] op_sel_hi:[1,0]
v_accvgpr_read_b32 v84,a212
v_accvgpr_read_b32 v82,a166
v_mfma_f32_16x16x32_bf16 a[172:175],a[148:151],v[56:59],a[172:175]
v_accvgpr_read_b32 v87,a215
v_accvgpr_read_b32 v83,a167
v_accvgpr_read_b32 v80,a164
v_accvgpr_read_b32 v81,a165
v_accvgpr_read_b32 v86,a214
v_pk_mul_f32 v[86:87],v[86:87],v[68:69] op_sel_hi:[1,0]
v_pk_mul_f32 v[80:81],v[80:81],v[66:67] op_sel_hi:[1,0]
v_pk_mul_f32 v[82:83],v[82:83],v[66:67] op_sel_hi:[1,0]
v_accvgpr_read_b32 v85,a213
v_pk_mul_f32 v[84:85],v[84:85],v[68:69] op_sel_hi:[1,0]
v_accvgpr_read_b32 v102,a222
v_accvgpr_read_b32 v96,a172
v_mfma_f32_16x16x32_bf16 a[168:171],a[144:147],v[56:59],a[168:171]
v_accvgpr_read_b32 v103,a223
v_accvgpr_read_b32 v94,a218
v_mfma_f32_16x16x32_bf16 v[120:123],a[144:147],v[52:55],v[120:123]
v_accvgpr_read_b32 v99,a175
v_accvgpr_read_b32 v100,a220
v_mfma_f32_16x16x32_bf16 v[124:127],a[148:151],v[52:55],v[124:127]
v_accvgpr_read_b32 v97,a173
v_accvgpr_read_b32 v95,a219
v_mfma_f32_16x16x32_bf16 v[220:223],a[148:151],v[48:51],v[220:223]
v_accvgpr_read_b32 v90,a170
v_accvgpr_read_b32 v91,a171
v_accvgpr_read_b32 v89,a169
v_accvgpr_read_b32 v88,a168
v_accvgpr_read_b32 v98,a174
v_pk_mul_f32 v[94:95],v[94:95],v[68:69] op_sel_hi:[1,0]
v_pk_mul_f32 v[102:103],v[102:103],v[68:69] op_sel_hi:[1,0]
v_pk_mul_f32 v[88:89],v[88:89],v[66:67] op_sel_hi:[1,0]
v_pk_mul_f32 v[98:99],v[98:99],v[66:67] op_sel_hi:[1,0]
v_pk_mul_f32 v[90:91],v[90:91],v[66:67] op_sel_hi:[1,0]
v_pk_mul_f32 v[96:97],v[96:97],v[66:67] op_sel_hi:[1,0]
v_accvgpr_read_b32 v93,a217
v_accvgpr_read_b32 v92,a216
v_pk_mul_f32 v[92:93],v[92:93],v[68:69] op_sel_hi:[1,0]
v_accvgpr_read_b32 v101,a221
v_pk_mul_f32 v[100:101],v[100:101],v[68:69] op_sel_hi:[1,0]
v_cmp_ngt_f32 vcc,s37,v19
v_lshrrev_b32 v19,5,v39
v_mfma_f32_16x16x32_bf16 v[216:219],a[144:147],v[48:51],v[216:219]
v_xor_b32 v38,v38,v19
v_and_b32 v19,15,v39
v_mfma_f32_16x16x32_bf16 v[168:171],a[144:147],v[44:47],v[168:171]
s_cmp_lg_u64 vcc,0
ds_read_b64_tr_b16 a[144:145],v4 offset:256
v_lshl_add_u32 v19,v19,7,s24
v_mfma_f32_16x16x32_bf16 v[172:175],a[148:151],v[44:47],v[172:175]
s_cselect_b32 s62,s32,0
ds_read_b64_tr_b16 a[146:147],v4 offset:6400
v_lshl_add_u32 v19,v38,4,v19
v_mfma_f32_16x16x32_bf16 v[176:179],a[120:123],v[44:47],v[176:179]
s_or_b32 s31,s31,s62
ds_read_b64_tr_b16 a[148:149],v5 offset:256
v_bfe_u32 v38,v39,4,1
s_waitcnt lgkmcnt(3)
v_mfma_f32_16x16x32_bf16 v[180:183],a[124:127],v[44:47],v[180:183]
s_lshl_b32 s32,s32,1
ds_read_b64_tr_b16 a[150:151],v5 offset:6400
v_lshl_add_u32 v36,v38,3,v19
v_mfma_f32_16x16x32_bf16 v[228:231],a[124:127],v[48:51],v[228:231]
v_xor_b32 v37,32,v36
v_xor_b32 v38,64,v36
v_mfma_f32_16x16x32_bf16 v[224:227],a[120:123],v[48:51],v[224:227]
v_bfe_u32 v19,v39,3,1
v_xor_b32 v39,96,v36
v_mfma_f32_16x16x32_bf16 v[128:131],a[120:123],v[52:55],v[128:131]
v_lshlrev_b32 v19,11,v19
v_cvt_pk_bf16_f32 v72,v72,v73
v_mfma_f32_16x16x32_bf16 v[132:135],a[124:127],v[52:55],v[132:135]
v_cvt_pk_bf16_f32 v76,v76,v77
v_cvt_pk_bf16_f32 v73,v74,v75
v_mfma_f32_16x16x32_bf16 a[180:183],a[124:127],v[56:59],a[180:183]
v_cvt_pk_bf16_f32 v84,v84,v85
v_cvt_pk_bf16_f32 v77,v78,v79
v_mfma_f32_16x16x32_bf16 a[176:179],a[120:123],v[56:59],a[176:179]
ds_write2st64_b64 v36,v[72:73],v[76:77] offset0:36 offset1:40
v_mfma_f32_16x16x32_bf16 a[224:227],a[120:123],v[40:43],a[224:227]
v_cvt_pk_bf16_f32 v85,v86,v87
v_cvt_pk_bf16_f32 v80,v80,v81
v_mfma_f32_16x16x32_bf16 a[228:231],a[124:127],v[40:43],a[228:231]
v_cvt_pk_bf16_f32 v81,v82,v83
v_cvt_pk_bf16_f32 v92,v92,v93
v_mfma_f32_16x16x32_bf16 a[232:235],a[128:131],v[40:43],a[232:235]
v_accvgpr_read_b32 v83,a179
v_accvgpr_read_b32 v82,a178
v_mfma_f32_16x16x32_bf16 a[236:239],a[132:135],v[40:43],a[236:239]
ds_write2st64_b64 v37,v[80:81],v[84:85] offset0:36 offset1:40
v_pk_mul_f32 v[82:83],v[82:83],v[66:67] op_sel_hi:[1,0]
v_accvgpr_read_b32 v84,a224
v_accvgpr_read_b32 v85,a225
v_pk_mul_f32 v[84:85],v[84:85],v[68:69] op_sel_hi:[1,0]
v_accvgpr_read_b32 v81,a177
v_accvgpr_read_b32 v87,a227
v_accvgpr_read_b32 v86,a226
v_pk_mul_f32 v[86:87],v[86:87],v[68:69] op_sel_hi:[1,0]
v_accvgpr_read_b32 v80,a176
v_pk_mul_f32 v[80:81],v[80:81],v[66:67] op_sel_hi:[1,0]
v_cvt_pk_bf16_f32 v93,v94,v95
v_cvt_pk_bf16_f32 v88,v88,v89
v_mfma_f32_16x16x32_bf16 a[188:191],a[132:135],v[56:59],a[188:191]
v_cvt_pk_bf16_f32 v89,v90,v91
ds_write2st64_b64 v38,v[88:89],v[92:93] offset0:36 offset1:40
v_accvgpr_read_b32 v88,a180
v_accvgpr_read_b32 v93,a229
v_accvgpr_read_b32 v90,a182
v_accvgpr_read_b32 v94,a230
v_accvgpr_read_b32 v95,a231
v_pk_mul_f32 v[94:95],v[94:95],v[68:69] op_sel_hi:[1,0]
v_accvgpr_read_b32 v89,a181
v_pk_mul_f32 v[88:89],v[88:89],v[66:67] op_sel_hi:[1,0]
v_accvgpr_read_b32 v92,a228
v_pk_mul_f32 v[92:93],v[92:93],v[68:69] op_sel_hi:[1,0]
v_accvgpr_read_b32 v91,a183
v_pk_mul_f32 v[90:91],v[90:91],v[66:67] op_sel_hi:[1,0]
v_cvt_pk_bf16_f32 v100,v100,v101
v_cvt_pk_bf16_f32 v101,v102,v103
v_mfma_f32_16x16x32_bf16 a[184:187],a[128:131],v[56:59],a[184:187]
v_cvt_pk_bf16_f32 v96,v96,v97
v_cvt_pk_bf16_f32 v97,v98,v99
v_mfma_f32_16x16x32_bf16 v[136:139],a[128:131],v[52:55],v[136:139]
ds_write2st64_b64 v39,v[96:97],v[100:101] offset0:36 offset1:40
v_mfma_f32_16x16x32_bf16 v[140:143],a[132:135],v[52:55],v[140:143]
v_cvt_pk_bf16_f32 v80,v80,v81
v_cvt_pk_bf16_f32 v81,v82,v83
v_mfma_f32_16x16x32_bf16 v[236:239],a[132:135],v[48:51],v[236:239]
ds_read_b128 v[104:107],v10 offset:18432
v_accvgpr_read_b32 v96,a184
ds_read_b128 v[108:111],v10 offset:19456
v_cvt_pk_bf16_f32 v84,v84,v85
ds_read_b128 v[72:75],v10 offset:20480
v_cvt_pk_bf16_f32 v85,v86,v87
ds_read_b128 v[76:79],v10 offset:21504
v_accvgpr_read_b32 v87,a239
ds_write2st64_b64 v36,v[80:81],v[84:85] offset0:36 offset1:40
v_accvgpr_read_b32 v98,a186
v_accvgpr_read_b32 v101,a233
v_accvgpr_read_b32 v100,a232
v_pk_mul_f32 v[100:101],v[100:101],v[68:69] op_sel_hi:[1,0]
v_accvgpr_read_b32 v86,a238
v_pk_mul_f32 v[86:87],v[86:87],v[68:69] op_sel_hi:[1,0]
v_accvgpr_read_b32 v81,a189
s_waitcnt lgkmcnt(4)
buffer_store_dwordx4 v[104:107],v9,s[16:19],s87 offen offset:0 nt
v_accvgpr_read_b32 v80,a188
v_pk_mul_f32 v[80:81],v[80:81],v[66:67] op_sel_hi:[1,0]
v_accvgpr_read_b32 v102,a234
v_accvgpr_read_b32 v83,a191
v_accvgpr_read_b32 v85,a237
v_accvgpr_read_b32 v84,a236
v_pk_mul_f32 v[84:85],v[84:85],v[68:69] op_sel_hi:[1,0]
v_accvgpr_read_b32 v97,a185
v_pk_mul_f32 v[96:97],v[96:97],v[66:67] op_sel_hi:[1,0]
v_accvgpr_read_b32 v82,a190
v_pk_mul_f32 v[82:83],v[82:83],v[66:67] op_sel_hi:[1,0]
s_waitcnt lgkmcnt(1)
buffer_store_dwordx4 v[108:111],v9,s[16:19],s87 offen offset:3072 nt
v_accvgpr_read_b32 v99,a187
v_pk_mul_f32 v[98:99],v[98:99],v[66:67] op_sel_hi:[1,0]
v_accvgpr_read_b32 v103,a235
v_pk_mul_f32 v[102:103],v[102:103],v[68:69] op_sel_hi:[1,0]
v_cvt_pk_bf16_f32 v88,v88,v89
v_cvt_pk_bf16_f32 v89,v90,v91
v_mfma_f32_16x16x32_bf16 v[232:235],a[128:131],v[48:51],v[232:235]
v_cvt_pk_bf16_f32 v92,v92,v93
v_cvt_pk_bf16_f32 v93,v94,v95
v_mfma_f32_16x16x32_bf16 v[184:187],a[128:131],v[44:47],v[184:187]
ds_write2st64_b64 v37,v[88:89],v[92:93] offset0:36 offset1:40
v_mfma_f32_16x16x32_bf16 v[188:191],a[132:135],v[44:47],v[188:191]
v_cvt_pk_bf16_f32 v96,v96,v97
v_cvt_pk_bf16_f32 v97,v98,v99
v_mfma_f32_16x16x32_bf16 v[192:195],a[136:139],v[44:47],v[192:195]
buffer_store_dwordx4 v[72:75],v9,s[16:19],s66 offen offset:0 nt
v_cvt_pk_bf16_f32 v100,v100,v101
v_cvt_pk_bf16_f32 v80,v80,v81
v_cvt_pk_bf16_f32 v101,v102,v103
v_mfma_f32_16x16x32_bf16 v[196:199],a[140:143],v[44:47],v[196:199]
v_cvt_pk_bf16_f32 v81,v82,v83
v_cvt_pk_bf16_f32 v84,v84,v85
v_mfma_f32_16x16x32_bf16 v[244:247],a[140:143],v[48:51],v[244:247]
v_cvt_pk_bf16_f32 v85,v86,v87
v_rcp_f32 v62,v62
v_mfma_f32_16x16x32_bf16 v[240:243],a[136:139],v[48:51],v[240:243]
ds_write2st64_b64 v38,v[96:97],v[100:101] offset0:36 offset1:40
v_mfma_f32_16x16x32_bf16 v[144:147],a[136:139],v[52:55],v[144:147]
v_rcp_f32 v64,v64
v_mfma_f32_16x16x32_bf16 v[148:151],a[140:143],v[52:55],v[148:151]
buffer_store_dwordx4 v[76:79],v9,s[16:19],s66 offen offset:3072 nt
v_rcp_f32 v60,v60
v_mfma_f32_16x16x32_bf16 a[196:199],a[140:143],v[56:59],a[196:199]
v_mfma_f32_16x16x32_bf16 a[192:195],a[136:139],v[56:59],a[192:195]
v_mfma_f32_16x16x32_bf16 a[240:243],a[136:139],v[40:43],a[240:243]
ds_write2st64_b64 v39,v[80:81],v[84:85] offset0:36 offset1:40
v_mfma_f32_16x16x32_bf16 a[244:247],a[140:143],v[40:43],a[244:247]
v_mfma_f32_16x16x32_bf16 a[248:251],a[144:147],v[40:43],a[248:251]
ds_read_b128 v[72:75],v10 offset:18432
v_mfma_f32_16x16x32_bf16 a[252:255],a[148:151],v[40:43],a[252:255]
ds_read_b128 v[76:79],v10 offset:19456
v_accvgpr_read_b32 v98,a198
ds_read_b128 v[88:91],v10 offset:20480
v_accvgpr_read_b32 v107,a195
ds_read_b128 v[92:95],v10 offset:21504
v_accvgpr_read_b32 v104,a192
v_accvgpr_read_b32 v111,a243
v_accvgpr_read_b32 v108,a240
v_accvgpr_read_b32 v106,a194
v_pk_mul_f32 v[106:107],v[106:107],v[66:67] op_sel_hi:[1,0]
v_accvgpr_read_b32 v105,a193
v_pk_mul_f32 v[104:105],v[104:105],v[66:67] op_sel_hi:[1,0]
v_accvgpr_read_b32 v109,a241
v_pk_mul_f32 v[108:109],v[108:109],v[68:69] op_sel_hi:[1,0]
v_accvgpr_read_b32 v110,a242
v_pk_mul_f32 v[110:111],v[110:111],v[68:69] op_sel_hi:[1,0]
v_accvgpr_read_b32 v100,a244
v_accvgpr_read_b32 v97,a197
v_mfma_f32_16x16x32_bf16 a[204:207],a[148:151],v[56:59],a[204:207]
s_waitcnt lgkmcnt(3)
v_accvgpr_read_b32 v102,a246
buffer_store_dwordx4 v[72:75],v9,s[16:19],s87 offen offset:128 nt
v_accvgpr_read_b32 v99,a199
v_pk_mul_f32 v[98:99],v[98:99],v[66:67] op_sel_hi:[1,0]
v_accvgpr_read_b32 v103,a247
v_pk_mul_f32 v[102:103],v[102:103],v[68:69] op_sel_hi:[1,0]
v_accvgpr_read_b32 v101,a245
v_pk_mul_f32 v[100:101],v[100:101],v[68:69] op_sel_hi:[1,0]
v_accvgpr_read_b32 v96,a196
v_pk_mul_f32 v[96:97],v[96:97],v[66:67] op_sel_hi:[1,0]
v_cvt_pk_bf16_f32 v108,v108,v109
v_cvt_pk_bf16_f32 v109,v110,v111
v_mfma_f32_16x16x32_bf16 a[200:203],a[144:147],v[56:59],a[200:203]
v_cvt_pk_bf16_f32 v104,v104,v105
v_accvgpr_read_b32 v86,a250
v_mfma_f32_16x16x32_bf16 v[152:155],a[144:147],v[52:55],v[152:155]
s_waitcnt lgkmcnt(0)
buffer_store_dwordx4 v[76:79],v9,s[16:19],s87 offen offset:3200 nt
v_cvt_pk_bf16_f32 v105,v106,v107
v_accvgpr_read_b32 v84,a248
v_accvgpr_read_b32 v106,a206
v_mfma_f32_16x16x32_bf16 v[156:159],a[148:151],v[52:55],v[156:159]
v_accvgpr_read_b32 v81,a201
v_accvgpr_read_b32 v80,a200
v_mfma_f32_16x16x32_bf16 v[252:255],a[148:151],v[48:51],v[252:255]
v_accvgpr_read_b32 v83,a203
ds_write2st64_b64 v36,v[104:105],v[108:109] offset0:36 offset1:40
v_pk_mul_f32 v[80:81],v[80:81],v[66:67] op_sel_hi:[1,0]
v_pk_mul_f32 v[228:229],v[228:229],v[62:63] op_sel_hi:[1,0]
v_pk_mul_f32 v[112:113],v[112:113],v[64:65] op_sel_hi:[1,0]
buffer_store_dwordx4 v[88:91],v9,s[16:19],s66 offen offset:128 nt
v_pk_mul_f32 v[238:239],v[238:239],v[62:63] op_sel_hi:[1,0]
v_pk_mul_f32 v[208:209],v[208:209],v[62:63] op_sel_hi:[1,0]
v_pk_mul_f32 v[114:115],v[114:115],v[64:65] op_sel_hi:[1,0]
v_pk_mul_f32 v[214:215],v[214:215],v[62:63] op_sel_hi:[1,0]
v_pk_mul_f32 v[220:221],v[220:221],v[62:63] op_sel_hi:[1,0]
v_pk_mul_f32 v[212:213],v[212:213],v[62:63] op_sel_hi:[1,0]
v_pk_mul_f32 v[242:243],v[242:243],v[62:63] op_sel_hi:[1,0]
v_pk_mul_f32 v[232:233],v[232:233],v[62:63] op_sel_hi:[1,0]
v_pk_mul_f32 v[236:237],v[236:237],v[62:63] op_sel_hi:[1,0]
v_pk_mul_f32 v[210:211],v[210:211],v[62:63] op_sel_hi:[1,0]
v_pk_mul_f32 v[218:219],v[218:219],v[62:63] op_sel_hi:[1,0]
buffer_store_dwordx4 v[92:95],v9,s[16:19],s66 offen offset:3200 nt
v_pk_mul_f32 v[240:241],v[240:241],v[62:63] op_sel_hi:[1,0]
v_pk_mul_f32 v[226:227],v[226:227],v[62:63] op_sel_hi:[1,0]
v_pk_mul_f32 v[234:235],v[234:235],v[62:63] op_sel_hi:[1,0]
v_pk_mul_f32 v[222:223],v[222:223],v[62:63] op_sel_hi:[1,0]
v_pk_mul_f32 v[118:119],v[118:119],v[64:65] op_sel_hi:[1,0]
v_pk_mul_f32 v[224:225],v[224:225],v[62:63] op_sel_hi:[1,0]
v_pk_mul_f32 v[116:117],v[116:117],v[64:65] op_sel_hi:[1,0]
v_pk_mul_f32 v[244:245],v[244:245],v[62:63] op_sel_hi:[1,0]
v_pk_mul_f32 v[230:231],v[230:231],v[62:63] op_sel_hi:[1,0]
v_pk_mul_f32 v[246:247],v[246:247],v[62:63] op_sel_hi:[1,0]
v_pk_mul_f32 v[216:217],v[216:217],v[62:63] op_sel_hi:[1,0]
v_add_u32 v36,v36,v19
v_accvgpr_read_b32 v108,a252
v_accvgpr_read_b32 v109,a253
v_pk_mul_f32 v[108:109],v[108:109],v[68:69] op_sel_hi:[1,0]
v_accvgpr_read_b32 v105,a205
v_cvt_pk_bf16_f32 v80,v80,v81
v_accvgpr_read_b32 v104,a204
v_pk_mul_f32 v[104:105],v[104:105],v[66:67] op_sel_hi:[1,0]
v_accvgpr_read_b32 v107,a207
v_pk_mul_f32 v[106:107],v[106:107],v[66:67] op_sel_hi:[1,0]
v_accvgpr_read_b32 v87,a251
v_pk_mul_f32 v[86:87],v[86:87],v[68:69] op_sel_hi:[1,0]
v_accvgpr_read_b32 v82,a202
v_pk_mul_f32 v[82:83],v[82:83],v[66:67] op_sel_hi:[1,0]
v_accvgpr_read_b32 v85,a249
v_pk_mul_f32 v[84:85],v[84:85],v[68:69] op_sel_hi:[1,0]
v_cvt_pk_bf16_f32 v104,v104,v105
v_cvt_pk_bf16_f32 v84,v84,v85
v_cvt_pk_bf16_f32 v85,v86,v87
v_cvt_pk_bf16_f32 v100,v100,v101
v_accvgpr_read_b32 v110,a254
v_cvt_pk_bf16_f32 v81,v82,v83
v_cvt_pk_bf16_f32 v96,v96,v97
v_cvt_pk_bf16_f32 v108,v108,v109
v_cvt_pk_bf16_f32 v101,v102,v103
v_accvgpr_read_b32 v111,a255
v_pk_mul_f32 v[110:111],v[110:111],v[68:69] op_sel_hi:[1,0]
v_cvt_pk_bf16_f32 v97,v98,v99
v_cvt_pk_bf16_f32 v109,v110,v111
v_mfma_f32_16x16x32_bf16 v[248:251],a[144:147],v[48:51],v[248:251]
ds_write2st64_b64 v37,v[96:97],v[100:101] offset0:36 offset1:40
v_mfma_f32_16x16x32_bf16 v[200:203],a[144:147],v[44:47],v[200:203]
v_add_u32 v37,v37,v19
v_cvt_pk_bf16_f32 v105,v106,v107
v_mfma_f32_16x16x32_bf16 v[204:207],a[148:151],v[44:47],v[204:207]
v_cvt_pk_bf16_f32 v224,v224,v225
v_cvt_pk_bf16_f32 v212,v212,v213
v_cvt_pk_bf16_f32 v225,v226,v227
v_cvt_pk_bf16_f32 v208,v208,v209
v_cvt_pk_bf16_f32 v209,v210,v211
ds_write2st64_b64 v38,v[80:81],v[84:85] offset0:36 offset1:40
v_pk_mul_f32 v[120:121],v[120:121],v[64:65] op_sel_hi:[1,0]
v_pk_mul_f32 v[250:251],v[250:251],v[62:63] op_sel_hi:[1,0]
v_pk_mul_f32 v[122:123],v[122:123],v[64:65] op_sel_hi:[1,0]
v_pk_mul_f32 v[252:253],v[252:253],v[62:63] op_sel_hi:[1,0]
v_pk_mul_f32 v[124:125],v[124:125],v[64:65] op_sel_hi:[1,0]
v_pk_mul_f32 v[254:255],v[254:255],v[62:63] op_sel_hi:[1,0]
v_pk_mul_f32 v[248:249],v[248:249],v[62:63] op_sel_hi:[1,0]
v_pk_mul_f32 v[126:127],v[126:127],v[64:65] op_sel_hi:[1,0]
v_pk_mul_f32 v[130:131],v[130:131],v[64:65] op_sel_hi:[1,0]
v_pk_mul_f32 v[132:133],v[132:133],v[64:65] op_sel_hi:[1,0]
v_pk_mul_f32 v[128:129],v[128:129],v[64:65] op_sel_hi:[1,0]
ds_write2st64_b64 v39,v[104:105],v[108:109] offset0:36 offset1:40
v_pk_mul_f32 v[148:149],v[148:149],v[64:65] op_sel_hi:[1,0]
v_pk_mul_f32 v[152:153],v[152:153],v[64:65] op_sel_hi:[1,0]
v_pk_mul_f32 v[146:147],v[146:147],v[64:65] op_sel_hi:[1,0]
ds_read_b128 v[72:75],v10 offset:18432
v_pk_mul_f32 v[144:145],v[144:145],v[64:65] op_sel_hi:[1,0]
ds_read_b128 v[76:79],v10 offset:19456
v_pk_mul_f32 v[136:137],v[136:137],v[64:65] op_sel_hi:[1,0]
ds_read_b128 v[88:91],v10 offset:20480
v_pk_mul_f32 v[154:155],v[154:155],v[64:65] op_sel_hi:[1,0]
ds_read_b128 v[92:95],v10 offset:21504
v_pk_mul_f32 v[156:157],v[156:157],v[64:65] op_sel_hi:[1,0]
ds_write2st64_b64 v36,v[208:209],v[224:225] offset0:12 offset1:14
v_pk_mul_f32 v[138:139],v[138:139],v[64:65] op_sel_hi:[1,0]
v_pk_mul_f32 v[134:135],v[134:135],v[64:65] op_sel_hi:[1,0]
v_pk_mul_f32 v[150:151],v[150:151],v[64:65] op_sel_hi:[1,0]
v_pk_mul_f32 v[142:143],v[142:143],v[64:65] op_sel_hi:[1,0]
v_pk_mul_f32 v[158:159],v[158:159],v[64:65] op_sel_hi:[1,0]
v_pk_mul_f32 v[140:141],v[140:141],v[64:65] op_sel_hi:[1,0]
v_pk_mul_f32 v[160:161],v[160:161],v[60:61] op_sel_hi:[1,0]
s_waitcnt lgkmcnt(4)
buffer_store_dwordx4 v[72:75],v9,s[16:19],s87 offen offset:256 nt
v_pk_mul_f32 v[180:181],v[180:181],v[60:61] op_sel_hi:[1,0]
v_pk_mul_f32 v[178:179],v[178:179],v[60:61] op_sel_hi:[1,0]
v_pk_mul_f32 v[164:165],v[164:165],v[60:61] op_sel_hi:[1,0]
v_pk_mul_f32 v[162:163],v[162:163],v[60:61] op_sel_hi:[1,0]
v_pk_mul_f32 v[176:177],v[176:177],v[60:61] op_sel_hi:[1,0]
v_pk_mul_f32 v[184:185],v[184:185],v[60:61] op_sel_hi:[1,0]
v_pk_mul_f32 v[172:173],v[172:173],v[60:61] op_sel_hi:[1,0]
v_pk_mul_f32 v[190:191],v[190:191],v[60:61] op_sel_hi:[1,0]
v_pk_mul_f32 v[166:167],v[166:167],v[60:61] op_sel_hi:[1,0]
v_pk_mul_f32 v[186:187],v[186:187],v[60:61] op_sel_hi:[1,0]
v_pk_mul_f32 v[182:183],v[182:183],v[60:61] op_sel_hi:[1,0]
s_waitcnt lgkmcnt(1)
buffer_store_dwordx4 v[76:79],v9,s[16:19],s87 offen offset:3328 nt
v_pk_mul_f32 v[168:169],v[168:169],v[60:61] op_sel_hi:[1,0]
v_pk_mul_f32 v[188:189],v[188:189],v[60:61] op_sel_hi:[1,0]
v_pk_mul_f32 v[170:171],v[170:171],v[60:61] op_sel_hi:[1,0]
v_pk_mul_f32 v[174:175],v[174:175],v[60:61] op_sel_hi:[1,0]
v_pk_mul_f32 v[192:193],v[192:193],v[60:61] op_sel_hi:[1,0]
v_pk_mul_f32 v[200:201],v[200:201],v[60:61] op_sel_hi:[1,0]
v_pk_mul_f32 v[194:195],v[194:195],v[60:61] op_sel_hi:[1,0]
v_pk_mul_f32 v[198:199],v[198:199],v[60:61] op_sel_hi:[1,0]
v_pk_mul_f32 v[202:203],v[202:203],v[60:61] op_sel_hi:[1,0]
v_pk_mul_f32 v[196:197],v[196:197],v[60:61] op_sel_hi:[1,0]
v_pk_mul_f32 v[204:205],v[204:205],v[60:61] op_sel_hi:[1,0]
buffer_store_dwordx4 v[88:91],v9,s[16:19],s66 offen offset:256 nt
v_pk_mul_f32 v[206:207],v[206:207],v[60:61] op_sel_hi:[1,0]
v_add_u32 v39,v39,v19
v_add_u32 v38,v38,v19
v_cvt_pk_bf16_f32 v216,v216,v217
v_cvt_pk_bf16_f32 v228,v228,v229
v_cvt_pk_bf16_f32 v220,v220,v221
v_cvt_pk_bf16_f32 v232,v232,v233
v_cvt_pk_bf16_f32 v233,v234,v235
v_cvt_pk_bf16_f32 v217,v218,v219
v_cvt_pk_bf16_f32 v236,v236,v237
v_cvt_pk_bf16_f32 v229,v230,v231
buffer_store_dwordx4 v[92:95],v9,s[16:19],s66 offen offset:3328 nt
v_cvt_pk_bf16_f32 v213,v214,v215
v_cvt_pk_bf16_f32 v221,v222,v223
v_cvt_pk_bf16_f32 v237,v238,v239
v_cvt_pk_bf16_f32 v240,v240,v241
v_cvt_pk_bf16_f32 v241,v242,v243
v_cvt_pk_bf16_f32 v112,v112,v113
v_cvt_pk_bf16_f32 v113,v114,v115
v_cvt_pk_bf16_f32 v124,v124,v125
v_cvt_pk_bf16_f32 v244,v244,v245
ds_write2st64_b64 v37,v[212:213],v[228:229] offset0:12 offset1:14
v_cvt_pk_bf16_f32 v245,v246,v247
v_cvt_pk_bf16_f32 v116,v116,v117
v_cvt_pk_bf16_f32 v252,v252,v253
v_cvt_pk_bf16_f32 v248,v248,v249
v_cvt_pk_bf16_f32 v249,v250,v251
v_cvt_pk_bf16_f32 v253,v254,v255
v_cvt_pk_bf16_f32 v120,v120,v121
v_cvt_pk_bf16_f32 v117,v118,v119
v_cvt_pk_bf16_f32 v121,v122,v123
v_cvt_pk_bf16_f32 v125,v126,v127
v_cvt_pk_bf16_f32 v132,v132,v133
ds_write2st64_b64 v38,v[216:217],v[232:233] offset0:12 offset1:14
v_cvt_pk_bf16_f32 v148,v148,v149
v_cvt_pk_bf16_f32 v144,v144,v145
v_cvt_pk_bf16_f32 v145,v146,v147
v_cvt_pk_bf16_f32 v128,v128,v129
v_cvt_pk_bf16_f32 v129,v130,v131
v_cvt_pk_bf16_f32 v136,v136,v137
v_cvt_pk_bf16_f32 v133,v134,v135
v_cvt_pk_bf16_f32 v149,v150,v151
v_cvt_pk_bf16_f32 v140,v140,v141
v_cvt_pk_bf16_f32 v137,v138,v139
v_cvt_pk_bf16_f32 v152,v152,v153
ds_write2st64_b64 v39,v[220:221],v[236:237] offset0:12 offset1:14
v_cvt_pk_bf16_f32 v141,v142,v143
v_cvt_pk_bf16_f32 v156,v156,v157
v_cvt_pk_bf16_f32 v153,v154,v155
ds_read_b128 v[96:99],v10 offset:6144
v_cvt_pk_bf16_f32 v157,v158,v159
ds_read_b128 v[100:103],v10 offset:9216
v_cvt_pk_bf16_f32 v180,v180,v181
ds_read_b128 v[80:83],v10 offset:7168
v_cvt_pk_bf16_f32 v160,v160,v161
ds_read_b128 v[84:87],v10 offset:10240
v_cvt_pk_bf16_f32 v168,v168,v169
ds_write2st64_b64 v36,v[240:241],v[112:113] offset0:16 offset1:24
v_cvt_pk_bf16_f32 v164,v164,v165
v_cvt_pk_bf16_f32 v165,v166,v167
v_cvt_pk_bf16_f32 v181,v182,v183
v_cvt_pk_bf16_f32 v184,v184,v185
v_cvt_pk_bf16_f32 v176,v176,v177
v_cvt_pk_bf16_f32 v185,v186,v187
v_cvt_pk_bf16_f32 v161,v162,v163
s_waitcnt lgkmcnt(4)
buffer_store_dwordx4 v[96:99],v9,s[16:19],s85 offen offset:0 nt
v_cvt_pk_bf16_f32 v177,v178,v179
v_cvt_pk_bf16_f32 v188,v188,v189
v_cvt_pk_bf16_f32 v189,v190,v191
v_cvt_pk_bf16_f32 v172,v172,v173
v_cvt_pk_bf16_f32 v173,v174,v175
v_cvt_pk_bf16_f32 v169,v170,v171
v_cvt_pk_bf16_f32 v192,v192,v193
v_cvt_pk_bf16_f32 v196,v196,v197
v_cvt_pk_bf16_f32 v193,v194,v195
ds_write2st64_b64 v37,v[244:245],v[116:117] offset0:16 offset1:24
v_cvt_pk_bf16_f32 v197,v198,v199
v_cvt_pk_bf16_f32 v200,v200,v201
v_cvt_pk_bf16_f32 v201,v202,v203
s_waitcnt lgkmcnt(1)
buffer_store_dwordx4 v[100:103],v9,s[16:19],s85 offen offset:3072 nt
v_cvt_pk_bf16_f32 v204,v204,v205
v_cvt_pk_bf16_f32 v205,v206,v207
ds_write2st64_b64 v38,v[248:249],v[120:121] offset0:16 offset1:24
buffer_store_dwordx4 v[80:83],v9,s[16:19],s85 offen offset:128 nt
ds_write2st64_b64 v39,v[252:253],v[124:125] offset0:16 offset1:24
ds_read_b128 v[104:107],v10 offset:8192
buffer_store_dwordx4 v[84:87],v9,s[16:19],s85 offen offset:3200 nt
ds_read_b128 v[108:111],v10 offset:11264
ds_read_b128 v[208:211],v10 offset:12288
ds_read_b128 v[224:227],v10 offset:15360
ds_write2st64_b64 v36,v[128:129],v[144:145] offset0:26 offset1:28
s_waitcnt lgkmcnt(4)
buffer_store_dwordx4 v[104:107],v9,s[16:19],s85 offen offset:256 nt
ds_write2st64_b64 v37,v[132:133],v[148:149] offset0:26 offset1:28
s_waitcnt lgkmcnt(1)
buffer_store_dwordx4 v[108:111],v9,s[16:19],s85 offen offset:3328 nt
ds_write2st64_b64 v38,v[136:137],v[152:153] offset0:26 offset1:28
buffer_store_dwordx4 v[208:211],v9,s[16:19],s86 offen offset:0 nt
ds_write2st64_b64 v39,v[140:141],v[156:157] offset0:26 offset1:28
ds_read_b128 v[72:75],v10 offset:13312
buffer_store_dwordx4 v[224:227],v9,s[16:19],s86 offen offset:3072 nt
ds_read_b128 v[76:79],v10 offset:16384
ds_read_b128 v[88:91],v10 offset:14336
ds_read_b128 v[92:95],v10 offset:17408
ds_write2st64_b64 v36,v[160:161],v[176:177] offset0:0 offset1:2
s_waitcnt lgkmcnt(4)
buffer_store_dwordx4 v[72:75],v9,s[16:19],s86 offen offset:128 nt
ds_write2st64_b64 v37,v[164:165],v[180:181] offset0:0 offset1:2
s_waitcnt lgkmcnt(1)
buffer_store_dwordx4 v[76:79],v9,s[16:19],s86 offen offset:3200 nt
ds_write2st64_b64 v38,v[168:169],v[184:185] offset0:0 offset1:2
buffer_store_dwordx4 v[88:91],v9,s[16:19],s86 offen offset:256 nt
ds_write2st64_b64 v39,v[172:173],v[188:189] offset0:0 offset1:2
ds_read_b128 v[212:215],v10 offset:0
buffer_store_dwordx4 v[92:95],v9,s[16:19],s86 offen offset:3328 nt
ds_read_b128 v[228:231],v10 offset:3072
ds_read_b128 v[216:219],v10 offset:1024
ds_read_b128 v[232:235],v10 offset:4096
ds_write_b64 v36,v[192:193] offset:2048
ds_write_b64 v37,v[196:197] offset:2048
s_waitcnt lgkmcnt(5)
buffer_store_dwordx4 v[212:215],v9,s[16:19],s84 offen offset:0 nt
ds_write_b64 v38,v[200:201] offset:2048
s_waitcnt lgkmcnt(2)
buffer_store_dwordx4 v[228:231],v9,s[16:19],s84 offen offset:3072 nt
ds_write_b64 v39,v[204:205] offset:2048
ds_read_b128 v[220:223],v10 offset:2048
buffer_store_dwordx4 v[216:219],v9,s[16:19],s84 offen offset:128 nt
ds_read_b128 v[236:239],v10 offset:5120
buffer_store_dwordx4 v[232:235],v9,s[16:19],s84 offen offset:3200 nt
s_waitcnt lgkmcnt(1)
buffer_store_dwordx4 v[220:223],v9,s[16:19],s84 offen offset:256 nt
s_waitcnt lgkmcnt(0)
buffer_store_dwordx4 v[236:239],v9,s[16:19],s84 offen offset:3328 nt
s_branch L_fin
L_end4:
s_waitcnt lgkmcnt(3)
v_mfma_f32_16x16x32_bf16 v[160:163],a[120:123],v[20:23],v[160:163]
ds_read_b64_tr_b16 a[136:137],v2 offset:24704
v_fma_f32 v102,v102,s36,v16
v_mfma_f32_16x16x32_bf16 v[164:167],a[124:127],v[20:23],v[164:167]
ds_read_b64_tr_b16 a[138:139],v2 offset:30848
v_fma_f32 v98,v98,s36,v16
v_mfma_f32_16x16x32_bf16 v[212:215],a[124:127],v[24:27],v[212:215]
ds_read_b64_tr_b16 a[140:141],v3 offset:24704
v_fma_f32 v76,v76,s36,v13
v_mfma_f32_16x16x32_bf16 v[208:211],a[120:123],v[24:27],v[208:211]
ds_read_b64_tr_b16 a[142:143],v3 offset:30848
v_fma_f32 v91,v91,s36,v15
v_mfma_f32_16x16x32_bf16 v[112:115],a[120:123],v[28:31],v[112:115]
ds_read_b64_tr_b16 a[144:145],v4 offset:24704
v_fma_f32 v95,v95,s36,v15
v_mfma_f32_16x16x32_bf16 v[116:119],a[124:127],v[28:31],v[116:119]
ds_read_b64_tr_b16 a[146:147],v4 offset:30848
v_fma_f32 v85,v85,s36,v14
v_mfma_f32_16x16x32_bf16 a[164:167],a[124:127],v[32:35],a[164:167]
ds_read_b64_tr_b16 a[148:149],v5 offset:24704
v_exp_f32 v76,v76
v_mfma_f32_16x16x32_bf16 a[160:163],a[120:123],v[32:35],a[160:163]
s_waitcnt lgkmcnt(6)
ds_read_b64_tr_b16 a[150:151],v5 offset:30848
v_fma_f32 v103,v103,s36,v16
v_mfma_f32_16x16x32_bf16 a[168:171],a[128:131],v[32:35],a[168:171]
ds_read_b64_tr_b16 a[120:121],v2 offset:24832
v_fma_f32 v79,v79,s36,v13
v_mfma_f32_16x16x32_bf16 a[172:175],a[132:135],v[32:35],a[172:175]
ds_read_b64_tr_b16 a[122:123],v2 offset:30976
v_fma_f32 v96,v96,s36,v16
v_mfma_f32_16x16x32_bf16 v[124:127],a[132:135],v[28:31],v[124:127]
ds_read_b64_tr_b16 a[124:125],v3 offset:24832
v_exp_f32 v102,v102
v_mfma_f32_16x16x32_bf16 v[120:123],a[128:131],v[28:31],v[120:123]
ds_read_b64_tr_b16 a[126:127],v3 offset:30976
v_fma_f32 v89,v89,s36,v15
v_mfma_f32_16x16x32_bf16 v[216:219],a[128:131],v[24:27],v[216:219]
v_fma_f32 v86,v86,s36,v14
v_fma_f32 v100,v100,s36,v16
v_mfma_f32_16x16x32_bf16 v[220:223],a[132:135],v[24:27],v[220:223]
v_exp_f32 v100,v100
v_mfma_f32_16x16x32_bf16 v[172:175],a[132:135],v[20:23],v[172:175]
ds_read_b64_tr_b16 a[132:133],v5 offset:24832
v_fma_f32 v84,v84,s36,v14
v_mfma_f32_16x16x32_bf16 v[168:171],a[128:131],v[20:23],v[168:171]
s_waitcnt lgkmcnt(4)
ds_read_b64_tr_b16 a[128:129],v4 offset:24832
v_exp_f32 v98,v98
v_mfma_f32_16x16x32_bf16 v[176:179],a[136:139],v[20:23],v[176:179]
ds_read_b64_tr_b16 a[130:131],v4 offset:30976
v_exp_f32 v79,v79
v_mfma_f32_16x16x32_bf16 v[180:183],a[140:143],v[20:23],v[180:183]
ds_read_b64_tr_b16 a[134:135],v5 offset:30976
v_exp_f32 v89,v89
v_mfma_f32_16x16x32_bf16 v[228:231],a[140:143],v[24:27],v[228:231]
v_fma_f32 v82,v82,s36,v14
v_exp_f32 v82,v82
v_mfma_f32_16x16x32_bf16 v[224:227],a[136:139],v[24:27],v[224:227]
v_fma_f32 v77,v77,s36,v13
v_exp_f32 v77,v77
v_mfma_f32_16x16x32_bf16 v[128:131],a[136:139],v[28:31],v[128:131]
v_fma_f32 v87,v87,s36,v14
v_exp_f32 v87,v87
v_mfma_f32_16x16x32_bf16 v[132:135],a[140:143],v[28:31],v[132:135]
v_exp_f32 v96,v96
v_mfma_f32_16x16x32_bf16 a[180:183],a[140:143],v[32:35],a[180:183]
v_fma_f32 v78,v78,s36,v13
v_fma_f32 v83,v83,s36,v14
v_mfma_f32_16x16x32_bf16 a[176:179],a[136:139],v[32:35],a[176:179]
v_fma_f32 v92,v92,s36,v15
v_exp_f32 v92,v92
v_mfma_f32_16x16x32_bf16 a[184:187],a[144:147],v[32:35],a[184:187]
v_fma_f32 v90,v90,s36,v15
v_exp_f32 v90,v90
v_mfma_f32_16x16x32_bf16 a[188:191],a[148:151],v[32:35],a[188:191]
v_fma_f32 v101,v101,s36,v16
v_exp_f32 v101,v101
v_mfma_f32_16x16x32_bf16 v[140:143],a[148:151],v[28:31],v[140:143]
v_fma_f32 v99,v99,s36,v16
v_exp_f32 v99,v99
v_mfma_f32_16x16x32_bf16 v[136:139],a[144:147],v[28:31],v[136:139]
v_exp_f32 v84,v84
v_mfma_f32_16x16x32_bf16 v[232:235],a[144:147],v[24:27],v[232:235]
v_fma_f32 v94,v94,s36,v15
v_fma_f32 v88,v88,s36,v15
v_mfma_f32_16x16x32_bf16 v[236:239],a[148:151],v[24:27],v[236:239]
v_fma_f32 v97,v97,s36,v16
v_exp_f32 v97,v97
v_mfma_f32_16x16x32_bf16 v[188:191],a[148:151],v[20:23],v[188:191]
v_fma_f32 v93,v93,s36,v15
v_exp_f32 v93,v93
v_mfma_f32_16x16x32_bf16 v[184:187],a[144:147],v[20:23],v[184:187]
s_waitcnt lgkmcnt(0)
v_exp_f32 v94,v94
v_mfma_f32_16x16x32_bf16 v[192:195],a[120:123],v[20:23],v[192:195]
v_exp_f32 v83,v83
v_mfma_f32_16x16x32_bf16 v[196:199],a[124:127],v[20:23],v[196:199]
v_exp_f32 v103,v103
v_mfma_f32_16x16x32_bf16 v[244:247],a[124:127],v[24:27],v[244:247]
v_exp_f32 v78,v78
v_mfma_f32_16x16x32_bf16 v[240:243],a[120:123],v[24:27],v[240:243]
v_exp_f32 v95,v95
v_mfma_f32_16x16x32_bf16 v[144:147],a[120:123],v[28:31],v[144:147]
v_cvt_pk_bf16_f32 v55,v94,v95
s_waitcnt vmcnt(14)
s_barrier
v_mfma_f32_16x16x32_bf16 v[148:151],a[124:127],v[28:31],v[148:151]
v_exp_f32 v91,v91
v_mfma_f32_16x16x32_bf16 a[196:199],a[124:127],v[32:35],a[196:199]
v_exp_f32 v85,v85
v_mfma_f32_16x16x32_bf16 a[192:195],a[120:123],v[32:35],a[192:195]
v_exp_f32 v88,v88
v_mfma_f32_16x16x32_bf16 a[200:203],a[128:131],v[32:35],a[200:203]
v_cvt_pk_bf16_f32 v52,v88,v89
v_exp_f32 v86,v86
v_mfma_f32_16x16x32_bf16 a[204:207],a[132:135],v[32:35],a[204:207]
v_cvt_pk_bf16_f32 v46,v76,v77
v_cvt_pk_bf16_f32 v49,v82,v83
v_mfma_f32_16x16x32_bf16 v[156:159],a[132:135],v[28:31],v[156:159]
v_cvt_pk_bf16_f32 v57,v98,v99
v_cvt_pk_bf16_f32 v47,v78,v79
v_mfma_f32_16x16x32_bf16 v[152:155],a[128:131],v[28:31],v[152:155]
v_cvt_pk_bf16_f32 v58,v100,v101
v_cvt_pk_bf16_f32 v59,v102,v103
v_mfma_f32_16x16x32_bf16 v[248:251],a[128:131],v[24:27],v[248:251]
v_cvt_pk_bf16_f32 v54,v92,v93
v_cvt_pk_bf16_f32 v50,v84,v85
v_mfma_f32_16x16x32_bf16 v[252:255],a[132:135],v[24:27],v[252:255]
v_cvt_pk_bf16_f32 v53,v90,v91
v_cvt_pk_bf16_f32 v51,v86,v87
v_mfma_f32_16x16x32_bf16 v[204:207],a[132:135],v[20:23],v[204:207]
v_cvt_pk_bf16_f32 v56,v96,v97
v_subrev_u32 v10,18432,v10
v_smfmac_f32_16x16x64_bf16 v[60:63],a[152:155],v[44:51],v18
ds_read_b64_tr_b16 a[138:139],v2 offset:6144
v_smfmac_f32_16x16x64_bf16 v[64:67],a[152:155],v[52:59],v18
ds_read_b64_tr_b16 a[136:137],v2 offset:0
v_mfma_f32_16x16x32_bf16 v[200:203],a[128:131],v[20:23],v[200:203]
ds_read_b64_tr_b16 a[142:143],v3 offset:6144
ds_read_b64_tr_b16 a[140:141],v3 offset:0
ds_read_b64_tr_b16 a[146:147],v4 offset:6144
ds_read_b64_tr_b16 a[144:145],v4 offset:0
ds_read_b64_tr_b16 a[150:151],v5 offset:6144
ds_read_b64_tr_b16 a[148:149],v5 offset:0
s_waitcnt lgkmcnt(6)
v_mfma_f32_16x16x32_bf16 v[160:163],a[136:139],v[44:47],v[160:163]
s_waitcnt vmcnt(6)
ds_read_b64_tr_b16 a[120:121],v2 offset:128
v_mbcnt_lo_u32_b32 v39,-1,0
s_waitcnt lgkmcnt(5)
v_mfma_f32_16x16x32_bf16 v[164:167],a[140:143],v[44:47],v[164:167]
s_add_u32 s84,s42,0
ds_read_b64_tr_b16 a[122:123],v2 offset:6272
v_mbcnt_hi_u32_b32 v39,-1,v39
v_mfma_f32_16x16x32_bf16 v[212:215],a[140:143],v[48:51],v[212:215]
s_add_u32 s85,s42,6144
ds_read_b64_tr_b16 a[126:127],v3 offset:6272
v_and_b32 v38,7,v39
v_mfma_f32_16x16x32_bf16 v[208:211],a[136:139],v[48:51],v[208:211]
s_add_u32 s86,s42,12288
ds_read_b64_tr_b16 a[124:125],v3 offset:128
v_add_f32 v64,v64,v65
v_mfma_f32_16x16x32_bf16 v[112:115],a[136:139],v[52:55],v[112:115]
s_add_u32 s87,s42,18432
ds_read_b64_tr_b16 a[130:131],v4 offset:6272
v_add_f32 v66,v66,v67
v_mfma_f32_16x16x32_bf16 v[116:119],a[140:143],v[52:55],v[116:119]
ds_read_b64_tr_b16 a[128:129],v4 offset:128
ds_read_b64_tr_b16 a[132:133],v5 offset:128
ds_read_b64_tr_b16 a[134:135],v5 offset:6272
v_mfma_f32_16x16x32_bf16 a[164:167],a[140:143],v[56:59],a[164:167]
ds_read_b64_tr_b16 a[142:143],v3 offset:6400
v_add_f32 v62,v62,v63
v_mfma_f32_16x16x32_bf16 a[160:163],a[136:139],v[56:59],a[160:163]
s_waitcnt lgkmcnt(8)
ds_read_b64_tr_b16 a[136:137],v2 offset:256
v_add_f32 v60,v60,v61
v_mfma_f32_16x16x32_bf16 a[168:171],a[144:147],v[56:59],a[168:171]
ds_read_b64_tr_b16 a[138:139],v2 offset:6400
v_max3_f32 v19,v60,v62,v64
v_mfma_f32_16x16x32_bf16 a[172:175],a[148:151],v[56:59],a[172:175]
ds_read_b64_tr_b16 a[140:141],v3 offset:256
v_max_f32 v19,v19,v66
v_mfma_f32_16x16x32_bf16 v[124:127],a[148:151],v[52:55],v[124:127]
v_accvgpr_read_b32 v82,a166
v_rcp_f32 v66,v66
v_mfma_f32_16x16x32_bf16 v[120:123],a[144:147],v[52:55],v[120:123]
v_accvgpr_read_b32 v81,a165
v_accvgpr_read_b32 v80,a164
v_mfma_f32_16x16x32_bf16 v[216:219],a[144:147],v[48:51],v[216:219]
v_accvgpr_read_b32 v72,a160
v_accvgpr_read_b32 v75,a163
v_mfma_f32_16x16x32_bf16 v[220:223],a[148:151],v[48:51],v[220:223]
v_accvgpr_read_b32 v73,a161
v_accvgpr_read_b32 v74,a162
v_mfma_f32_16x16x32_bf16 v[172:175],a[148:151],v[44:47],v[172:175]
ds_read_b64_tr_b16 a[148:149],v5 offset:256
v_accvgpr_read_b32 v83,a167
v_mfma_f32_16x16x32_bf16 v[168:171],a[144:147],v[44:47],v[168:171]
s_waitcnt lgkmcnt(2)
ds_read_b64_tr_b16 a[144:145],v4 offset:256
v_accvgpr_read_b32 v88,a168
v_mfma_f32_16x16x32_bf16 v[176:179],a[120:123],v[44:47],v[176:179]
ds_read_b64_tr_b16 a[146:147],v4 offset:6400
v_accvgpr_read_b32 v91,a171
v_mfma_f32_16x16x32_bf16 v[180:183],a[124:127],v[44:47],v[180:183]
ds_read_b64_tr_b16 a[150:151],v5 offset:6400
v_accvgpr_read_b32 v90,a170
v_mfma_f32_16x16x32_bf16 v[228:231],a[124:127],v[48:51],v[228:231]
v_accvgpr_read_b32 v89,a169
v_accvgpr_read_b32 v98,a174
v_mfma_f32_16x16x32_bf16 v[224:227],a[120:123],v[48:51],v[224:227]
v_accvgpr_read_b32 v97,a173
v_accvgpr_read_b32 v99,a175
v_mfma_f32_16x16x32_bf16 v[128:131],a[120:123],v[52:55],v[128:131]
v_accvgpr_read_b32 v96,a172
v_cmp_ngt_f32 vcc,s37,v19
v_mfma_f32_16x16x32_bf16 v[132:135],a[124:127],v[52:55],v[132:135]
v_lshrrev_b32 v19,5,v39
v_xor_b32 v38,v38,v19
v_mfma_f32_16x16x32_bf16 a[180:183],a[124:127],v[56:59],a[180:183]
s_cmp_lg_u64 vcc,0
v_and_b32 v19,15,v39
v_lshl_add_u32 v19,v19,7,s24
v_mfma_f32_16x16x32_bf16 a[176:179],a[120:123],v[56:59],a[176:179]
s_cselect_b32 s62,s32,0
v_lshl_add_u32 v19,v38,4,v19
v_bfe_u32 v38,v39,4,1
v_mfma_f32_16x16x32_bf16 a[184:187],a[128:131],v[56:59],a[184:187]
s_or_b32 s31,s31,s62
v_lshl_add_u32 v36,v38,3,v19
v_xor_b32 v37,32,v36
v_mfma_f32_16x16x32_bf16 a[188:191],a[132:135],v[56:59],a[188:191]
s_lshl_b32 s32,s32,1
v_bfe_u32 v19,v39,3,1
v_xor_b32 v39,96,v36
v_mfma_f32_16x16x32_bf16 v[140:143],a[132:135],v[52:55],v[140:143]
v_xor_b32 v38,64,v36
v_lshlrev_b32 v19,11,v19
v_accvgpr_read_b32 v84,a180
v_accvgpr_read_b32 v79,a179
v_accvgpr_read_b32 v78,a178
v_pk_mul_f32 v[82:83],v[82:83],v[66:67] op_sel_hi:[1,0]
v_pk_mul_f32 v[72:73],v[72:73],v[66:67] op_sel_hi:[1,0]
v_pk_mul_f32 v[74:75],v[74:75],v[66:67] op_sel_hi:[1,0]
v_pk_mul_f32 v[80:81],v[80:81],v[66:67] op_sel_hi:[1,0]
v_pk_mul_f32 v[78:79],v[78:79],v[66:67] op_sel_hi:[1,0]
v_accvgpr_read_b32 v77,a177
v_accvgpr_read_b32 v76,a176
v_pk_mul_f32 v[76:77],v[76:77],v[66:67] op_sel_hi:[1,0]
v_accvgpr_read_b32 v85,a181
v_pk_mul_f32 v[84:85],v[84:85],v[66:67] op_sel_hi:[1,0]
v_accvgpr_read_b32 v87,a183
v_accvgpr_read_b32 v86,a182
v_pk_mul_f32 v[86:87],v[86:87],v[66:67] op_sel_hi:[1,0]
v_accvgpr_read_b32 v93,a185
v_accvgpr_read_b32 v95,a187
v_mfma_f32_16x16x32_bf16 v[136:139],a[128:131],v[52:55],v[136:139]
v_accvgpr_read_b32 v94,a186
v_accvgpr_read_b32 v92,a184
v_accvgpr_read_b32 v101,a189
v_accvgpr_read_b32 v103,a191
v_accvgpr_read_b32 v102,a190
v_pk_mul_f32 v[88:89],v[88:89],v[66:67] op_sel_hi:[1,0]
v_pk_mul_f32 v[90:91],v[90:91],v[66:67] op_sel_hi:[1,0]
v_pk_mul_f32 v[92:93],v[92:93],v[66:67] op_sel_hi:[1,0]
v_pk_mul_f32 v[94:95],v[94:95],v[66:67] op_sel_hi:[1,0]
v_accvgpr_read_b32 v100,a188
v_cvt_pk_bf16_f32 v76,v76,v77
v_mfma_f32_16x16x32_bf16 v[232:235],a[128:131],v[48:51],v[232:235]
v_cvt_pk_bf16_f32 v77,v78,v79
v_cvt_pk_bf16_f32 v80,v80,v81
v_cvt_pk_bf16_f32 v84,v84,v85
v_cvt_pk_bf16_f32 v85,v86,v87
v_cvt_pk_bf16_f32 v72,v72,v73
v_pk_mul_f32 v[96:97],v[96:97],v[66:67] op_sel_hi:[1,0]
v_pk_mul_f32 v[98:99],v[98:99],v[66:67] op_sel_hi:[1,0]
v_pk_mul_f32 v[102:103],v[102:103],v[66:67] op_sel_hi:[1,0]
v_pk_mul_f32 v[100:101],v[100:101],v[66:67] op_sel_hi:[1,0]
v_cvt_pk_bf16_f32 v73,v74,v75
v_cvt_pk_bf16_f32 v88,v88,v89
v_mfma_f32_16x16x32_bf16 v[236:239],a[132:135],v[48:51],v[236:239]
ds_write2st64_b64 v36,v[72:73],v[76:77] offset0:36 offset1:40
v_mfma_f32_16x16x32_bf16 v[188:191],a[132:135],v[44:47],v[188:191]
v_cvt_pk_bf16_f32 v92,v92,v93
v_cvt_pk_bf16_f32 v100,v100,v101
v_mfma_f32_16x16x32_bf16 v[184:187],a[128:131],v[44:47],v[184:187]
v_cvt_pk_bf16_f32 v93,v94,v95
v_cvt_pk_bf16_f32 v101,v102,v103
v_mfma_f32_16x16x32_bf16 v[192:195],a[136:139],v[44:47],v[192:195]
s_waitcnt lgkmcnt(1)
v_cvt_pk_bf16_f32 v81,v82,v83
v_cvt_pk_bf16_f32 v89,v90,v91
v_mfma_f32_16x16x32_bf16 v[196:199],a[140:143],v[44:47],v[196:199]
ds_write2st64_b64 v37,v[80:81],v[84:85] offset0:36 offset1:40
v_mfma_f32_16x16x32_bf16 v[244:247],a[140:143],v[48:51],v[244:247]
v_cvt_pk_bf16_f32 v96,v96,v97
v_cvt_pk_bf16_f32 v97,v98,v99
v_mfma_f32_16x16x32_bf16 v[240:243],a[136:139],v[48:51],v[240:243]
v_rcp_f32 v64,v64
v_mfma_f32_16x16x32_bf16 v[144:147],a[136:139],v[52:55],v[144:147]
v_rcp_f32 v62,v62
v_mfma_f32_16x16x32_bf16 v[148:151],a[140:143],v[52:55],v[148:151]
ds_write2st64_b64 v38,v[88:89],v[92:93] offset0:36 offset1:40
v_mfma_f32_16x16x32_bf16 a[196:199],a[140:143],v[56:59],a[196:199]
v_rcp_f32 v60,v60
v_mfma_f32_16x16x32_bf16 a[192:195],a[136:139],v[56:59],a[192:195]
v_mfma_f32_16x16x32_bf16 a[200:203],a[144:147],v[56:59],a[200:203]
v_mfma_f32_16x16x32_bf16 a[204:207],a[148:151],v[56:59],a[204:207]
ds_write2st64_b64 v39,v[96:97],v[100:101] offset0:36 offset1:40
v_mfma_f32_16x16x32_bf16 v[156:159],a[148:151],v[52:55],v[156:159]
ds_read_b128 v[104:107],v10 offset:18432
ds_read_b128 v[108:111],v10 offset:19456
v_accvgpr_read_b32 v87,a199
ds_read_b128 v[72:75],v10 offset:20480
v_accvgpr_read_b32 v83,a195
ds_read_b128 v[76:79],v10 offset:21504
v_accvgpr_read_b32 v80,a192
v_accvgpr_read_b32 v82,a194
v_pk_mul_f32 v[82:83],v[82:83],v[66:67] op_sel_hi:[1,0]
v_accvgpr_read_b32 v85,a197
v_accvgpr_read_b32 v86,a198
v_pk_mul_f32 v[86:87],v[86:87],v[66:67] op_sel_hi:[1,0]
v_accvgpr_read_b32 v84,a196
v_pk_mul_f32 v[84:85],v[84:85],v[66:67] op_sel_hi:[1,0]
v_accvgpr_read_b32 v81,a193
v_pk_mul_f32 v[80:81],v[80:81],v[66:67] op_sel_hi:[1,0]
v_cvt_pk_bf16_f32 v84,v84,v85
v_accvgpr_read_b32 v94,a206
v_mfma_f32_16x16x32_bf16 v[152:155],a[144:147],v[52:55],v[152:155]
s_waitcnt lgkmcnt(3)
v_cvt_pk_bf16_f32 v80,v80,v81
buffer_store_dwordx4 v[104:107],v9,s[16:19],s87 offen offset:0 nt
v_accvgpr_read_b32 v91,a203
v_cvt_pk_bf16_f32 v81,v82,v83
v_accvgpr_read_b32 v90,a202
v_pk_mul_f32 v[90:91],v[90:91],v[66:67] op_sel_hi:[1,0]
v_accvgpr_read_b32 v93,a205
v_accvgpr_read_b32 v89,a201
v_accvgpr_read_b32 v88,a200
v_pk_mul_f32 v[88:89],v[88:89],v[66:67] op_sel_hi:[1,0]
v_cvt_pk_bf16_f32 v85,v86,v87
v_accvgpr_read_b32 v92,a204
v_mfma_f32_16x16x32_bf16 v[248:251],a[144:147],v[48:51],v[248:251]
s_waitcnt lgkmcnt(0)
ds_write_b64 v36,v[80:81] offset:18432
buffer_store_dwordx4 v[108:111],v9,s[16:19],s87 offen offset:3072 nt
v_pk_mul_f32 v[92:93],v[92:93],v[66:67] op_sel_hi:[1,0]
v_pk_mul_f32 v[216:217],v[216:217],v[62:63] op_sel_hi:[1,0]
v_pk_mul_f32 v[218:219],v[218:219],v[62:63] op_sel_hi:[1,0]
v_pk_mul_f32 v[240:241],v[240:241],v[62:63] op_sel_hi:[1,0]
v_pk_mul_f32 v[230:231],v[230:231],v[62:63] op_sel_hi:[1,0]
v_pk_mul_f32 v[226:227],v[226:227],v[62:63] op_sel_hi:[1,0]
v_pk_mul_f32 v[242:243],v[242:243],v[62:63] op_sel_hi:[1,0]
v_pk_mul_f32 v[228:229],v[228:229],v[62:63] op_sel_hi:[1,0]
v_pk_mul_f32 v[112:113],v[112:113],v[64:65] op_sel_hi:[1,0]
ds_write_b64 v37,v[84:85] offset:18432
buffer_store_dwordx4 v[72:75],v9,s[16:19],s87 offen offset:128 nt
v_pk_mul_f32 v[118:119],v[118:119],v[64:65] op_sel_hi:[1,0]
v_pk_mul_f32 v[114:115],v[114:115],v[64:65] op_sel_hi:[1,0]
v_pk_mul_f32 v[220:221],v[220:221],v[62:63] op_sel_hi:[1,0]
v_pk_mul_f32 v[222:223],v[222:223],v[62:63] op_sel_hi:[1,0]
v_pk_mul_f32 v[214:215],v[214:215],v[62:63] op_sel_hi:[1,0]
v_pk_mul_f32 v[244:245],v[244:245],v[62:63] op_sel_hi:[1,0]
v_pk_mul_f32 v[238:239],v[238:239],v[62:63] op_sel_hi:[1,0]
v_pk_mul_f32 v[212:213],v[212:213],v[62:63] op_sel_hi:[1,0]
v_pk_mul_f32 v[246:247],v[246:247],v[62:63] op_sel_hi:[1,0]
v_pk_mul_f32 v[208:209],v[208:209],v[62:63] op_sel_hi:[1,0]
v_pk_mul_f32 v[210:211],v[210:211],v[62:63] op_sel_hi:[1,0]
buffer_store_dwordx4 v[76:79],v9,s[16:19],s87 offen offset:3200 nt
v_pk_mul_f32 v[224:225],v[224:225],v[62:63] op_sel_hi:[1,0]
v_pk_mul_f32 v[236:237],v[236:237],v[62:63] op_sel_hi:[1,0]
v_pk_mul_f32 v[232:233],v[232:233],v[62:63] op_sel_hi:[1,0]
v_pk_mul_f32 v[116:117],v[116:117],v[64:65] op_sel_hi:[1,0]
v_pk_mul_f32 v[234:235],v[234:235],v[62:63] op_sel_hi:[1,0]
v_add_u32 v36,v36,v19
v_add_u32 v37,v37,v19
v_cvt_pk_bf16_f32 v92,v92,v93
v_accvgpr_read_b32 v95,a207
v_pk_mul_f32 v[94:95],v[94:95],v[66:67] op_sel_hi:[1,0]
v_cvt_pk_bf16_f32 v88,v88,v89
v_cvt_pk_bf16_f32 v93,v94,v95
v_mfma_f32_16x16x32_bf16 v[252:255],a[148:151],v[48:51],v[252:255]
v_cvt_pk_bf16_f32 v89,v90,v91
v_cvt_pk_bf16_f32 v208,v208,v209
v_mfma_f32_16x16x32_bf16 v[204:207],a[148:151],v[44:47],v[204:207]
ds_write_b64 v38,v[88:89] offset:18432
v_mfma_f32_16x16x32_bf16 v[200:203],a[144:147],v[44:47],v[200:203]
v_add_u32 v38,v38,v19
v_cvt_pk_bf16_f32 v212,v212,v213
ds_write_b64 v39,v[92:93] offset:18432
ds_read_b128 v[96:99],v10 offset:18432
v_pk_mul_f32 v[252:253],v[252:253],v[62:63] op_sel_hi:[1,0]
ds_read_b128 v[100:103],v10 offset:19456
v_pk_mul_f32 v[124:125],v[124:125],v[64:65] op_sel_hi:[1,0]
v_pk_mul_f32 v[254:255],v[254:255],v[62:63] op_sel_hi:[1,0]
v_pk_mul_f32 v[126:127],v[126:127],v[64:65] op_sel_hi:[1,0]
v_pk_mul_f32 v[248:249],v[248:249],v[62:63] op_sel_hi:[1,0]
v_pk_mul_f32 v[120:121],v[120:121],v[64:65] op_sel_hi:[1,0]
v_pk_mul_f32 v[250:251],v[250:251],v[62:63] op_sel_hi:[1,0]
v_pk_mul_f32 v[122:123],v[122:123],v[64:65] op_sel_hi:[1,0]
v_pk_mul_f32 v[148:149],v[148:149],v[64:65] op_sel_hi:[1,0]
v_pk_mul_f32 v[130:131],v[130:131],v[64:65] op_sel_hi:[1,0]
v_pk_mul_f32 v[128:129],v[128:129],v[64:65] op_sel_hi:[1,0]
v_pk_mul_f32 v[136:137],v[136:137],v[64:65] op_sel_hi:[1,0]
v_pk_mul_f32 v[150:151],v[150:151],v[64:65] op_sel_hi:[1,0]
v_pk_mul_f32 v[152:153],v[152:153],v[64:65] op_sel_hi:[1,0]
v_pk_mul_f32 v[140:141],v[140:141],v[64:65] op_sel_hi:[1,0]
v_pk_mul_f32 v[156:157],v[156:157],v[64:65] op_sel_hi:[1,0]
v_pk_mul_f32 v[144:145],v[144:145],v[64:65] op_sel_hi:[1,0]
v_pk_mul_f32 v[146:147],v[146:147],v[64:65] op_sel_hi:[1,0]
v_pk_mul_f32 v[158:159],v[158:159],v[64:65] op_sel_hi:[1,0]
v_pk_mul_f32 v[132:133],v[132:133],v[64:65] op_sel_hi:[1,0]
v_pk_mul_f32 v[138:139],v[138:139],v[64:65] op_sel_hi:[1,0]
v_pk_mul_f32 v[142:143],v[142:143],v[64:65] op_sel_hi:[1,0]
v_pk_mul_f32 v[134:135],v[134:135],v[64:65] op_sel_hi:[1,0]
v_pk_mul_f32 v[154:155],v[154:155],v[64:65] op_sel_hi:[1,0]
s_waitcnt lgkmcnt(1)
buffer_store_dwordx4 v[96:99],v9,s[16:19],s87 offen offset:256 nt
v_pk_mul_f32 v[178:179],v[178:179],v[60:61] op_sel_hi:[1,0]
v_pk_mul_f32 v[162:163],v[162:163],v[60:61] op_sel_hi:[1,0]
v_pk_mul_f32 v[180:181],v[180:181],v[60:61] op_sel_hi:[1,0]
v_pk_mul_f32 v[168:169],v[168:169],v[60:61] op_sel_hi:[1,0]
v_pk_mul_f32 v[176:177],v[176:177],v[60:61] op_sel_hi:[1,0]
v_pk_mul_f32 v[182:183],v[182:183],v[60:61] op_sel_hi:[1,0]
v_pk_mul_f32 v[188:189],v[188:189],v[60:61] op_sel_hi:[1,0]
v_pk_mul_f32 v[160:161],v[160:161],v[60:61] op_sel_hi:[1,0]
v_pk_mul_f32 v[164:165],v[164:165],v[60:61] op_sel_hi:[1,0]
v_pk_mul_f32 v[174:175],v[174:175],v[60:61] op_sel_hi:[1,0]
v_pk_mul_f32 v[184:185],v[184:185],v[60:61] op_sel_hi:[1,0]
s_waitcnt lgkmcnt(0)
buffer_store_dwordx4 v[100:103],v9,s[16:19],s87 offen offset:3328 nt
v_pk_mul_f32 v[166:167],v[166:167],v[60:61] op_sel_hi:[1,0]
v_pk_mul_f32 v[172:173],v[172:173],v[60:61] op_sel_hi:[1,0]
v_pk_mul_f32 v[186:187],v[186:187],v[60:61] op_sel_hi:[1,0]
v_pk_mul_f32 v[170:171],v[170:171],v[60:61] op_sel_hi:[1,0]
v_pk_mul_f32 v[190:191],v[190:191],v[60:61] op_sel_hi:[1,0]
v_pk_mul_f32 v[196:197],v[196:197],v[60:61] op_sel_hi:[1,0]
v_pk_mul_f32 v[194:195],v[194:195],v[60:61] op_sel_hi:[1,0]
v_pk_mul_f32 v[192:193],v[192:193],v[60:61] op_sel_hi:[1,0]
v_pk_mul_f32 v[200:201],v[200:201],v[60:61] op_sel_hi:[1,0]
v_pk_mul_f32 v[198:199],v[198:199],v[60:61] op_sel_hi:[1,0]
v_pk_mul_f32 v[206:207],v[206:207],v[60:61] op_sel_hi:[1,0]
v_pk_mul_f32 v[202:203],v[202:203],v[60:61] op_sel_hi:[1,0]
v_pk_mul_f32 v[204:205],v[204:205],v[60:61] op_sel_hi:[1,0]
v_add_u32 v39,v39,v19
v_cvt_pk_bf16_f32 v224,v224,v225
v_cvt_pk_bf16_f32 v228,v228,v229
v_cvt_pk_bf16_f32 v209,v210,v211
v_cvt_pk_bf16_f32 v232,v232,v233
v_cvt_pk_bf16_f32 v216,v216,v217
v_cvt_pk_bf16_f32 v236,v236,v237
v_cvt_pk_bf16_f32 v225,v226,v227
ds_write2st64_b64 v36,v[208:209],v[224:225] offset0:12 offset1:14
v_cvt_pk_bf16_f32 v229,v230,v231
v_cvt_pk_bf16_f32 v233,v234,v235
v_cvt_pk_bf16_f32 v213,v214,v215
v_cvt_pk_bf16_f32 v217,v218,v219
v_cvt_pk_bf16_f32 v220,v220,v221
v_cvt_pk_bf16_f32 v221,v222,v223
v_cvt_pk_bf16_f32 v237,v238,v239
v_cvt_pk_bf16_f32 v240,v240,v241
v_cvt_pk_bf16_f32 v241,v242,v243
v_cvt_pk_bf16_f32 v112,v112,v113
v_cvt_pk_bf16_f32 v113,v114,v115
ds_write2st64_b64 v37,v[212:213],v[228:229] offset0:12 offset1:14
v_cvt_pk_bf16_f32 v244,v244,v245
v_cvt_pk_bf16_f32 v248,v248,v249
v_cvt_pk_bf16_f32 v116,v116,v117
v_cvt_pk_bf16_f32 v245,v246,v247
v_cvt_pk_bf16_f32 v124,v124,v125
v_cvt_pk_bf16_f32 v249,v250,v251
v_cvt_pk_bf16_f32 v120,v120,v121
v_cvt_pk_bf16_f32 v121,v122,v123
v_cvt_pk_bf16_f32 v117,v118,v119
v_cvt_pk_bf16_f32 v252,v252,v253
v_cvt_pk_bf16_f32 v253,v254,v255
ds_write2st64_b64 v38,v[216:217],v[232:233] offset0:12 offset1:14
v_cvt_pk_bf16_f32 v125,v126,v127
v_cvt_pk_bf16_f32 v128,v128,v129
v_cvt_pk_bf16_f32 v132,v132,v133
v_cvt_pk_bf16_f32 v144,v144,v145
v_cvt_pk_bf16_f32 v129,v130,v131
v_cvt_pk_bf16_f32 v145,v146,v147
v_cvt_pk_bf16_f32 v133,v134,v135
v_cvt_pk_bf16_f32 v152,v152,v153
v_cvt_pk_bf16_f32 v153,v154,v155
v_cvt_pk_bf16_f32 v136,v136,v137
v_cvt_pk_bf16_f32 v148,v148,v149
ds_write2st64_b64 v39,v[220:221],v[236:237] offset0:12 offset1:14
v_cvt_pk_bf16_f32 v137,v138,v139
v_cvt_pk_bf16_f32 v140,v140,v141
v_cvt_pk_bf16_f32 v141,v142,v143
ds_read_b128 v[80:83],v10 offset:6144
v_cvt_pk_bf16_f32 v156,v156,v157
ds_read_b128 v[72:75],v10 offset:9216
v_cvt_pk_bf16_f32 v149,v150,v151
ds_read_b128 v[76:79],v10 offset:7168
v_cvt_pk_bf16_f32 v157,v158,v159
ds_read_b128 v[84:87],v10 offset:10240
v_cvt_pk_bf16_f32 v164,v164,v165
ds_write2st64_b64 v36,v[240:241],v[112:113] offset0:16 offset1:24
v_cvt_pk_bf16_f32 v165,v166,v167
v_cvt_pk_bf16_f32 v180,v180,v181
v_cvt_pk_bf16_f32 v184,v184,v185
v_cvt_pk_bf16_f32 v176,v176,v177
v_cvt_pk_bf16_f32 v177,v178,v179
v_cvt_pk_bf16_f32 v160,v160,v161
v_cvt_pk_bf16_f32 v161,v162,v163
s_waitcnt lgkmcnt(4)
buffer_store_dwordx4 v[80:83],v9,s[16:19],s85 offen offset:0 nt
v_cvt_pk_bf16_f32 v168,v168,v169
v_cvt_pk_bf16_f32 v169,v170,v171
v_cvt_pk_bf16_f32 v181,v182,v183
v_cvt_pk_bf16_f32 v188,v188,v189
v_cvt_pk_bf16_f32 v185,v186,v187
v_cvt_pk_bf16_f32 v172,v172,v173
v_cvt_pk_bf16_f32 v173,v174,v175
v_cvt_pk_bf16_f32 v189,v190,v191
v_cvt_pk_bf16_f32 v192,v192,v193
ds_write2st64_b64 v37,v[244:245],v[116:117] offset0:16 offset1:24
v_cvt_pk_bf16_f32 v196,v196,v197
v_cvt_pk_bf16_f32 v200,v200,v201
v_cvt_pk_bf16_f32 v193,v194,v195
s_waitcnt lgkmcnt(1)
buffer_store_dwordx4 v[72:75],v9,s[16:19],s85 offen offset:3072 nt
v_cvt_pk_bf16_f32 v201,v202,v203
v_cvt_pk_bf16_f32 v204,v204,v205
v_cvt_pk_bf16_f32 v197,v198,v199
v_cvt_pk_bf16_f32 v205,v206,v207
ds_write2st64_b64 v38,v[248:249],v[120:121] offset0:16 offset1:24
buffer_store_dwordx4 v[76:79],v9,s[16:19],s85 offen offset:128 nt
ds_write2st64_b64 v39,v[252:253],v[124:125] offset0:16 offset1:24
ds_read_b128 v[104:107],v10 offset:8192
buffer_store_dwordx4 v[84:87],v9,s[16:19],s85 offen offset:3200 nt
ds_read_b128 v[108:111],v10 offset:11264
ds_read_b128 v[88:91],v10 offset:12288
ds_read_b128 v[92:95],v10 offset:15360
ds_write2st64_b64 v36,v[128:129],v[144:145] offset0:26 offset1:28
s_waitcnt lgkmcnt(4)
buffer_store_dwordx4 v[104:107],v9,s[16:19],s85 offen offset:256 nt
ds_write2st64_b64 v37,v[132:133],v[148:149] offset0:26 offset1:28
s_waitcnt lgkmcnt(1)
buffer_store_dwordx4 v[108:111],v9,s[16:19],s85 offen offset:3328 nt
ds_write2st64_b64 v38,v[136:137],v[152:153] offset0:26 offset1:28
buffer_store_dwordx4 v[88:91],v9,s[16:19],s86 offen offset:0 nt
ds_write2st64_b64 v39,v[140:141],v[156:157] offset0:26 offset1:28
ds_read_b128 v[208:211],v10 offset:13312
buffer_store_dwordx4 v[92:95],v9,s[16:19],s86 offen offset:3072 nt
ds_read_b128 v[224:227],v10 offset:16384
ds_read_b128 v[96:99],v10 offset:14336
ds_read_b128 v[100:103],v10 offset:17408
ds_write2st64_b64 v36,v[160:161],v[176:177] offset0:0 offset1:2
s_waitcnt lgkmcnt(4)
buffer_store_dwordx4 v[208:211],v9,s[16:19],s86 offen offset:128 nt
ds_write2st64_b64 v37,v[164:165],v[180:181] offset0:0 offset1:2
s_waitcnt lgkmcnt(1)
buffer_store_dwordx4 v[224:227],v9,s[16:19],s86 offen offset:3200 nt
ds_write2st64_b64 v38,v[168:169],v[184:185] offset0:0 offset1:2
buffer_store_dwordx4 v[96:99],v9,s[16:19],s86 offen offset:256 nt
ds_write2st64_b64 v39,v[172:173],v[188:189] offset0:0 offset1:2
ds_read_b128 v[212:215],v10 offset:0
buffer_store_dwordx4 v[100:103],v9,s[16:19],s86 offen offset:3328 nt
ds_read_b128 v[228:231],v10 offset:3072
ds_read_b128 v[216:219],v10 offset:1024
ds_read_b128 v[232:235],v10 offset:4096
ds_write_b64 v36,v[192:193] offset:2048
ds_write_b64 v37,v[196:197] offset:2048
s_waitcnt lgkmcnt(5)
buffer_store_dwordx4 v[212:215],v9,s[16:19],s84 offen offset:0 nt
ds_write_b64 v38,v[200:201] offset:2048
s_waitcnt lgkmcnt(2)
buffer_store_dwordx4 v[228:231],v9,s[16:19],s84 offen offset:3072 nt
ds_write_b64 v39,v[204:205] offset:2048
ds_read_b128 v[220:223],v10 offset:2048
buffer_store_dwordx4 v[216:219],v9,s[16:19],s84 offen offset:128 nt
ds_read_b128 v[236:239],v10 offset:5120
buffer_store_dwordx4 v[232:235],v9,s[16:19],s84 offen offset:3200 nt
s_waitcnt lgkmcnt(1)
buffer_store_dwordx4 v[220:223],v9,s[16:19],s84 offen offset:256 nt
s_waitcnt lgkmcnt(0)
buffer_store_dwordx4 v[236:239],v9,s[16:19],s84 offen offset:3328 nt
s_branch L_fin
L_fin:
s_waitcnt vmcnt(0)
L_stamped:
s_cmp_lg_u32 s31,0
s_cbranch_scc1 L_fix
L_done:
L_end:
s_endpgm
L_fix:
s_sub_u32 s62,s24,36864
v_add_u32 v112,s62,v2
v_add_u32 v113,s62,v3
v_add_u32 v114,s62,v4
v_add_u32 v115,s62,v5
v_mbcnt_lo_u32_b32 v19,-1,0
v_mbcnt_hi_u32_b32 v19,-1,v19
v_and_b32 v81,15,v19
v_mul_u32_u24 v81,384,v81
v_lshrrev_b32 v82,4,v19
v_lshl_add_u32 v83,v82,3,v81
v_lshl_add_u32 v81,v82,4,v81
L_fix_pass:
s_ff1_i32_b32 s50,s31
s_bitset0_b32 s31,s50
s_lshl_b32 s62,s50,5
s_add_u32 s62,s62,s34
s_mul_i32 s63,s62,171
s_lshr_b32 s63,s63,9
s_mul_i32 s64,s63,3
s_sub_u32 s62,s62,s64
s_add_u32 s63,s63,s33
s_mul_i32 s30,s63,196608
s_mul_i32 s41,s63,325632
s_lshl_b32 s63,s3,2
s_add_u32 s64,s63,21
s_cmp_eq_u32 s3,0
s_cselect_b32 s64,20,s64
s_cselect_b32 s40,1,0
s_add_u32 s65,s63,37
s_cmp_eq_u32 s62,2
s_cselect_b32 s64,s65,s64
s_cselect_b32 s40,0,s40
s_add_u32 s65,s63,s3
s_cmp_eq_u32 s62,0
s_cselect_b32 s64,s65,s64
s_cselect_b32 s40,1,s40
s_mul_i32 s64,s64,6144
s_add_u32 s41,s41,s64
s_add_u32 s55,s40,4
s_mov_b32 s51,0
L_fix_tile:
buffer_load_dwordx4 a[0:3],v81,s[12:15],s41 offen offset:0
buffer_load_dwordx4 a[4:7],v81,s[12:15],s41 offen offset:64
buffer_load_dwordx4 a[8:11],v81,s[12:15],s41 offen offset:128
buffer_load_dwordx4 a[12:15],v81,s[12:15],s41 offen offset:192
buffer_load_dwordx4 a[16:19],v81,s[12:15],s41 offen offset:256
buffer_load_dwordx4 a[20:23],v81,s[12:15],s41 offen offset:320
v_mov_b32 v80,0xff800000
s_mov_b32 s53,s30
s_mov_b32 s52,0
L_fix_max:
s_mov_b32 s63,s53
s_add_u32 m0,s24,0
s_nop 0
buffer_load_dwordx4 v6,s[4:7],s63 offen offset:0 lds
buffer_load_dwordx4 v7,s[4:7],s63 offen offset:1024 lds
buffer_load_dwordx4 v8,s[4:7],s63 offen offset:2048 lds
s_add_u32 s63,s63,3072
s_add_u32 m0,s24,3072
s_nop 0
buffer_load_dwordx4 v6,s[4:7],s63 offen offset:0 lds
buffer_load_dwordx4 v7,s[4:7],s63 offen offset:1024 lds
buffer_load_dwordx4 v8,s[4:7],s63 offen offset:2048 lds
s_add_u32 s63,s63,3072
s_add_u32 m0,s24,6144
s_nop 0
buffer_load_dwordx4 v6,s[4:7],s63 offen offset:0 lds
buffer_load_dwordx4 v7,s[4:7],s63 offen offset:1024 lds
buffer_load_dwordx4 v8,s[4:7],s63 offen offset:2048 lds
s_add_u32 s63,s63,3072
s_add_u32 m0,s24,9216
s_nop 0
buffer_load_dwordx4 v6,s[4:7],s63 offen offset:0 lds
buffer_load_dwordx4 v7,s[4:7],s63 offen offset:1024 lds
buffer_load_dwordx4 v8,s[4:7],s63 offen offset:2048 lds
s_add_u32 s63,s63,3072
s_waitcnt vmcnt(0)
ds_read_b128 a[160:163],v11 offset:0
ds_read_b128 a[164:167],v12 offset:0
ds_read_b128 a[168:171],v11 offset:128
ds_read_b128 a[172:175],v12 offset:128
ds_read_b128 a[176:179],v11 offset:256
ds_read_b128 a[180:183],v12 offset:256
ds_read_b128 a[184:187],v11 offset:6144
ds_read_b128 a[188:191],v12 offset:6144
ds_read_b128 a[192:195],v11 offset:6272
ds_read_b128 a[196:199],v12 offset:6272
ds_read_b128 a[200:203],v11 offset:6400
ds_read_b128 a[204:207],v12 offset:6400
s_waitcnt lgkmcnt(0)
v_mfma_f32_16x16x32_bf16 v[72:75],a[160:163],a[0:3],0
v_mfma_f32_16x16x32_bf16 v[72:75],a[164:167],a[4:7],v[72:75]
v_mfma_f32_16x16x32_bf16 v[72:75],a[168:171],a[8:11],v[72:75]
v_mfma_f32_16x16x32_bf16 v[72:75],a[172:175],a[12:15],v[72:75]
v_mfma_f32_16x16x32_bf16 v[72:75],a[176:179],a[16:19],v[72:75]
v_mfma_f32_16x16x32_bf16 v[72:75],a[180:183],a[20:23],v[72:75]
v_mfma_f32_16x16x32_bf16 v[76:79],a[184:187],a[0:3],0
v_mfma_f32_16x16x32_bf16 v[76:79],a[188:191],a[4:7],v[76:79]
v_mfma_f32_16x16x32_bf16 v[76:79],a[192:195],a[8:11],v[76:79]
v_mfma_f32_16x16x32_bf16 v[76:79],a[196:199],a[12:15],v[76:79]
v_mfma_f32_16x16x32_bf16 v[76:79],a[200:203],a[16:19],v[76:79]
v_mfma_f32_16x16x32_bf16 v[76:79],a[204:207],a[20:23],v[76:79]
s_nop 7
v_max3_f32 v80,v80,v72,v73
v_max3_f32 v80,v80,v74,v75
v_max3_f32 v80,v80,v76,v77
v_max3_f32 v80,v80,v78,v79
s_add_u32 s53,s53,12288
s_add_u32 s52,s52,1
s_cmp_lt_u32 s52,16
s_cbranch_scc1 L_fix_max
v_mov_b32 v19,v80
s_nop 1
v_permlane32_swap_b32 v19,v80
v_max_f32 v80,v80,v19
v_mov_b32 v19,v80
s_nop 1
v_permlane16_swap_b32 v19,v80
v_max_f32 v80,v80,v19
v_mul_f32_e64 v13,-s36,v80
v_mov_b32 v160,0
v_mov_b32 v161,0
v_mov_b32 v162,0
v_mov_b32 v163,0
v_mov_b32 v164,0
v_mov_b32 v165,0
v_mov_b32 v166,0
v_mov_b32 v167,0
v_mov_b32 v168,0
v_mov_b32 v169,0
v_mov_b32 v170,0
v_mov_b32 v171,0
v_mov_b32 v172,0
v_mov_b32 v173,0
v_mov_b32 v174,0
v_mov_b32 v175,0
v_mov_b32 v176,0
v_mov_b32 v177,0
v_mov_b32 v178,0
v_mov_b32 v179,0
v_mov_b32 v180,0
v_mov_b32 v181,0
v_mov_b32 v182,0
v_mov_b32 v183,0
v_mov_b32 v184,0
v_mov_b32 v185,0
v_mov_b32 v186,0
v_mov_b32 v187,0
v_mov_b32 v188,0
v_mov_b32 v189,0
v_mov_b32 v190,0
v_mov_b32 v191,0
v_mov_b32 v192,0
v_mov_b32 v193,0
v_mov_b32 v194,0
v_mov_b32 v195,0
v_mov_b32 v196,0
v_mov_b32 v197,0
v_mov_b32 v198,0
v_mov_b32 v199,0
v_mov_b32 v200,0
v_mov_b32 v201,0
v_mov_b32 v202,0
v_mov_b32 v203,0
v_mov_b32 v204,0
v_mov_b32 v205,0
v_mov_b32 v206,0
v_mov_b32 v207,0
v_mov_b32 v60,0
v_mov_b32 v24,0
v_mov_b32 v61,0
v_mov_b32 v25,0
v_mov_b32 v62,0
v_mov_b32 v26,0
v_mov_b32 v63,0
v_mov_b32 v27,0
s_mov_b32 s53,s30
s_mov_b32 s52,0
L_fix_acc:
s_mov_b32 s63,s53
s_add_u32 m0,s24,0
s_nop 0
buffer_load_dwordx4 v6,s[4:7],s63 offen offset:0 lds
buffer_load_dwordx4 v7,s[4:7],s63 offen offset:1024 lds
buffer_load_dwordx4 v8,s[4:7],s63 offen offset:2048 lds
s_add_u32 s63,s63,3072
s_add_u32 m0,s24,3072
s_nop 0
buffer_load_dwordx4 v6,s[4:7],s63 offen offset:0 lds
buffer_load_dwordx4 v7,s[4:7],s63 offen offset:1024 lds
buffer_load_dwordx4 v8,s[4:7],s63 offen offset:2048 lds
s_add_u32 s63,s63,3072
s_add_u32 m0,s24,6144
s_nop 0
buffer_load_dwordx4 v6,s[4:7],s63 offen offset:0 lds
buffer_load_dwordx4 v7,s[4:7],s63 offen offset:1024 lds
buffer_load_dwordx4 v8,s[4:7],s63 offen offset:2048 lds
s_add_u32 s63,s63,3072
s_add_u32 m0,s24,9216
s_nop 0
buffer_load_dwordx4 v6,s[4:7],s63 offen offset:0 lds
buffer_load_dwordx4 v7,s[4:7],s63 offen offset:1024 lds
buffer_load_dwordx4 v8,s[4:7],s63 offen offset:2048 lds
s_add_u32 s63,s63,3072
s_waitcnt vmcnt(0)
ds_read_b128 a[160:163],v11 offset:0
ds_read_b128 a[164:167],v12 offset:0
ds_read_b128 a[168:171],v11 offset:128
ds_read_b128 a[172:175],v12 offset:128
ds_read_b128 a[176:179],v11 offset:256
ds_read_b128 a[180:183],v12 offset:256
ds_read_b128 a[184:187],v11 offset:6144
ds_read_b128 a[188:191],v12 offset:6144
ds_read_b128 a[192:195],v11 offset:6272
ds_read_b128 a[196:199],v12 offset:6272
ds_read_b128 a[200:203],v11 offset:6400
ds_read_b128 a[204:207],v12 offset:6400
s_waitcnt lgkmcnt(0)
v_mfma_f32_16x16x32_bf16 v[72:75],a[160:163],a[0:3],0
v_mfma_f32_16x16x32_bf16 v[72:75],a[164:167],a[4:7],v[72:75]
v_mfma_f32_16x16x32_bf16 v[72:75],a[168:171],a[8:11],v[72:75]
v_mfma_f32_16x16x32_bf16 v[72:75],a[172:175],a[12:15],v[72:75]
v_mfma_f32_16x16x32_bf16 v[72:75],a[176:179],a[16:19],v[72:75]
v_mfma_f32_16x16x32_bf16 v[72:75],a[180:183],a[20:23],v[72:75]
v_mfma_f32_16x16x32_bf16 v[76:79],a[184:187],a[0:3],0
v_mfma_f32_16x16x32_bf16 v[76:79],a[188:191],a[4:7],v[76:79]
v_mfma_f32_16x16x32_bf16 v[76:79],a[192:195],a[8:11],v[76:79]
v_mfma_f32_16x16x32_bf16 v[76:79],a[196:199],a[12:15],v[76:79]
v_mfma_f32_16x16x32_bf16 v[76:79],a[200:203],a[16:19],v[76:79]
v_mfma_f32_16x16x32_bf16 v[76:79],a[204:207],a[20:23],v[76:79]
s_nop 7
v_fma_f32 v72,v72,s36,v13
v_fma_f32 v73,v73,s36,v13
v_exp_f32 v72,v72
v_exp_f32 v73,v73
s_nop 0
v_cvt_pk_bf16_f32 v20,v72,v73
v_fma_f32 v74,v74,s36,v13
v_fma_f32 v75,v75,s36,v13
v_exp_f32 v74,v74
v_exp_f32 v75,v75
s_nop 0
v_cvt_pk_bf16_f32 v21,v74,v75
v_fma_f32 v76,v76,s36,v13
v_fma_f32 v77,v77,s36,v13
v_exp_f32 v76,v76
v_exp_f32 v77,v77
s_nop 0
v_cvt_pk_bf16_f32 v22,v76,v77
v_fma_f32 v78,v78,s36,v13
v_fma_f32 v79,v79,s36,v13
v_exp_f32 v78,v78
v_exp_f32 v79,v79
s_nop 0
v_cvt_pk_bf16_f32 v23,v78,v79
s_nop 1
v_smfmac_f32_16x16x64_bf16 v[60:63],a[152:155],v[20:27],v18
s_mov_b32 s63,s53
s_add_u32 m0,s24,0
s_nop 0
buffer_load_dwordx4 v6,s[8:11],s63 offen offset:0 lds
buffer_load_dwordx4 v7,s[8:11],s63 offen offset:1024 lds
buffer_load_dwordx4 v8,s[8:11],s63 offen offset:2048 lds
s_add_u32 s63,s63,3072
s_add_u32 m0,s24,3072
s_nop 0
buffer_load_dwordx4 v6,s[8:11],s63 offen offset:0 lds
buffer_load_dwordx4 v7,s[8:11],s63 offen offset:1024 lds
buffer_load_dwordx4 v8,s[8:11],s63 offen offset:2048 lds
s_add_u32 s63,s63,3072
s_add_u32 m0,s24,6144
s_nop 0
buffer_load_dwordx4 v6,s[8:11],s63 offen offset:0 lds
buffer_load_dwordx4 v7,s[8:11],s63 offen offset:1024 lds
buffer_load_dwordx4 v8,s[8:11],s63 offen offset:2048 lds
s_add_u32 s63,s63,3072
s_add_u32 m0,s24,9216
s_nop 0
buffer_load_dwordx4 v6,s[8:11],s63 offen offset:0 lds
buffer_load_dwordx4 v7,s[8:11],s63 offen offset:1024 lds
buffer_load_dwordx4 v8,s[8:11],s63 offen offset:2048 lds
s_add_u32 s63,s63,3072
s_waitcnt vmcnt(0)
ds_read_b64_tr_b16 a[160:161],v112 offset:0
ds_read_b64_tr_b16 a[162:163],v112 offset:6144
ds_read_b64_tr_b16 a[164:165],v113 offset:0
ds_read_b64_tr_b16 a[166:167],v113 offset:6144
ds_read_b64_tr_b16 a[168:169],v114 offset:0
ds_read_b64_tr_b16 a[170:171],v114 offset:6144
ds_read_b64_tr_b16 a[172:173],v115 offset:0
ds_read_b64_tr_b16 a[174:175],v115 offset:6144
ds_read_b64_tr_b16 a[176:177],v112 offset:128
ds_read_b64_tr_b16 a[178:179],v112 offset:6272
ds_read_b64_tr_b16 a[180:181],v113 offset:128
ds_read_b64_tr_b16 a[182:183],v113 offset:6272
ds_read_b64_tr_b16 a[184:185],v114 offset:128
ds_read_b64_tr_b16 a[186:187],v114 offset:6272
ds_read_b64_tr_b16 a[188:189],v115 offset:128
ds_read_b64_tr_b16 a[190:191],v115 offset:6272
ds_read_b64_tr_b16 a[192:193],v112 offset:256
ds_read_b64_tr_b16 a[194:195],v112 offset:6400
ds_read_b64_tr_b16 a[196:197],v113 offset:256
ds_read_b64_tr_b16 a[198:199],v113 offset:6400
ds_read_b64_tr_b16 a[200:201],v114 offset:256
ds_read_b64_tr_b16 a[202:203],v114 offset:6400
ds_read_b64_tr_b16 a[204:205],v115 offset:256
ds_read_b64_tr_b16 a[206:207],v115 offset:6400
s_waitcnt lgkmcnt(0)
v_mfma_f32_16x16x32_bf16 v[160:163],a[160:163],v[20:23],v[160:163]
v_mfma_f32_16x16x32_bf16 v[164:167],a[164:167],v[20:23],v[164:167]
v_mfma_f32_16x16x32_bf16 v[168:171],a[168:171],v[20:23],v[168:171]
v_mfma_f32_16x16x32_bf16 v[172:175],a[172:175],v[20:23],v[172:175]
v_mfma_f32_16x16x32_bf16 v[176:179],a[176:179],v[20:23],v[176:179]
v_mfma_f32_16x16x32_bf16 v[180:183],a[180:183],v[20:23],v[180:183]
v_mfma_f32_16x16x32_bf16 v[184:187],a[184:187],v[20:23],v[184:187]
v_mfma_f32_16x16x32_bf16 v[188:191],a[188:191],v[20:23],v[188:191]
v_mfma_f32_16x16x32_bf16 v[192:195],a[192:195],v[20:23],v[192:195]
v_mfma_f32_16x16x32_bf16 v[196:199],a[196:199],v[20:23],v[196:199]
v_mfma_f32_16x16x32_bf16 v[200:203],a[200:203],v[20:23],v[200:203]
v_mfma_f32_16x16x32_bf16 v[204:207],a[204:207],v[20:23],v[204:207]
s_add_u32 s53,s53,12288
s_add_u32 s52,s52,1
s_cmp_lt_u32 s52,16
s_cbranch_scc1 L_fix_acc
s_nop 7
v_add_f32 v19,v60,v61
v_rcp_f32 v19,v19
s_nop 0
v_mul_f32 v160,v160,v19
v_mul_f32 v161,v161,v19
v_mul_f32 v162,v162,v19
v_mul_f32 v163,v163,v19
v_cvt_pk_bf16_f32 v160,v160,v161
v_cvt_pk_bf16_f32 v161,v162,v163
buffer_store_dwordx2 v[160:161],v83,s[16:19],s41 offen offset:0
v_mul_f32 v164,v164,v19
v_mul_f32 v165,v165,v19
v_mul_f32 v166,v166,v19
v_mul_f32 v167,v167,v19
v_cvt_pk_bf16_f32 v164,v164,v165
v_cvt_pk_bf16_f32 v165,v166,v167
buffer_store_dwordx2 v[164:165],v83,s[16:19],s41 offen offset:32
v_mul_f32 v168,v168,v19
v_mul_f32 v169,v169,v19
v_mul_f32 v170,v170,v19
v_mul_f32 v171,v171,v19
v_cvt_pk_bf16_f32 v168,v168,v169
v_cvt_pk_bf16_f32 v169,v170,v171
buffer_store_dwordx2 v[168:169],v83,s[16:19],s41 offen offset:64
v_mul_f32 v172,v172,v19
v_mul_f32 v173,v173,v19
v_mul_f32 v174,v174,v19
v_mul_f32 v175,v175,v19
v_cvt_pk_bf16_f32 v172,v172,v173
v_cvt_pk_bf16_f32 v173,v174,v175
buffer_store_dwordx2 v[172:173],v83,s[16:19],s41 offen offset:96
v_mul_f32 v176,v176,v19
v_mul_f32 v177,v177,v19
v_mul_f32 v178,v178,v19
v_mul_f32 v179,v179,v19
v_cvt_pk_bf16_f32 v176,v176,v177
v_cvt_pk_bf16_f32 v177,v178,v179
buffer_store_dwordx2 v[176:177],v83,s[16:19],s41 offen offset:128
v_mul_f32 v180,v180,v19
v_mul_f32 v181,v181,v19
v_mul_f32 v182,v182,v19
v_mul_f32 v183,v183,v19
v_cvt_pk_bf16_f32 v180,v180,v181
v_cvt_pk_bf16_f32 v181,v182,v183
buffer_store_dwordx2 v[180:181],v83,s[16:19],s41 offen offset:160
v_mul_f32 v184,v184,v19
v_mul_f32 v185,v185,v19
v_mul_f32 v186,v186,v19
v_mul_f32 v187,v187,v19
v_cvt_pk_bf16_f32 v184,v184,v185
v_cvt_pk_bf16_f32 v185,v186,v187
buffer_store_dwordx2 v[184:185],v83,s[16:19],s41 offen offset:192
v_mul_f32 v188,v188,v19
v_mul_f32 v189,v189,v19
v_mul_f32 v190,v190,v19
v_mul_f32 v191,v191,v19
v_cvt_pk_bf16_f32 v188,v188,v189
v_cvt_pk_bf16_f32 v189,v190,v191
buffer_store_dwordx2 v[188:189],v83,s[16:19],s41 offen offset:224
v_mul_f32 v192,v192,v19
v_mul_f32 v193,v193,v19
v_mul_f32 v194,v194,v19
v_mul_f32 v195,v195,v19
v_cvt_pk_bf16_f32 v192,v192,v193
v_cvt_pk_bf16_f32 v193,v194,v195
buffer_store_dwordx2 v[192:193],v83,s[16:19],s41 offen offset:256
v_mul_f32 v196,v196,v19
v_mul_f32 v197,v197,v19
v_mul_f32 v198,v198,v19
v_mul_f32 v199,v199,v19
v_cvt_pk_bf16_f32 v196,v196,v197
v_cvt_pk_bf16_f32 v197,v198,v199
buffer_store_dwordx2 v[196:197],v83,s[16:19],s41 offen offset:288
v_mul_f32 v200,v200,v19
v_mul_f32 v201,v201,v19
v_mul_f32 v202,v202,v19
v_mul_f32 v203,v203,v19
v_cvt_pk_bf16_f32 v200,v200,v201
v_cvt_pk_bf16_f32 v201,v202,v203
buffer_store_dwordx2 v[200:201],v83,s[16:19],s41 offen offset:320
v_mul_f32 v204,v204,v19
v_mul_f32 v205,v205,v19
v_mul_f32 v206,v206,v19
v_mul_f32 v207,v207,v19
v_cvt_pk_bf16_f32 v204,v204,v205
v_cvt_pk_bf16_f32 v205,v206,v207
buffer_store_dwordx2 v[204:205],v83,s[16:19],s41 offen offset:352
s_waitcnt vmcnt(0)
s_add_u32 s41,s41,6144
s_add_u32 s51,s51,1
s_cmp_lt_u32 s51,s55
s_cbranch_scc1 L_fix_tile
s_cmp_lg_u32 s31,0
s_cbranch_scc1 L_fix_pass
s_branch L_done
L_codeend:
.section .rodata,"a"
.p2align 6
.amdhsa_kernel standalone__gqa_softmax__near_ridge_kernel
  .amdhsa_next_free_vgpr 512
  .amdhsa_next_free_sgpr 102
  .amdhsa_accum_offset 256
  .amdhsa_group_segment_fixed_size 0
  .amdhsa_kernarg_size 48
  .amdhsa_user_sgpr_count 2
  .amdhsa_user_sgpr_kernarg_segment_ptr 1
  .amdhsa_system_sgpr_workgroup_id_x 1
.end_amdhsa_kernel
```

```asm
; @launch grid=(256,1,1) block=(256,1,1) lds=163840
.amdgcn_target "amdgcn-amd-amdhsa--gfx950"
.text
.globl standalone__gqa_softmax__near_ridge_kernel
.p2align 8
.type standalone__gqa_softmax__near_ridge_kernel,@function
standalone__gqa_softmax__near_ridge_kernel:
s_cmp_ge_u32 s2,256
s_cbranch_scc1 L_end
s_load_dwordx4 s[84:87],s[0:1],0
s_load_dwordx4 s[88:91],s[0:1],16
v_lshrrev_b32 v80,6,v0
v_and_b32 v19,63,v0
v_readfirstlane_b32 s3,v80
s_lshr_b32 s34,s2,3
v_lshrrev_b32 v80,3,v19
v_and_b32 v82,7,v19
v_add_u32 v81,0,v80
v_mul_u32_u24 v81,43,v81
v_lshrrev_b32 v81,7,v81
v_and_b32 v81,6,v81
v_xor_b32 v81,v81,v82
v_lshlrev_b32 v81,4,v81
v_lshl_add_u32 v6,v80,7,v81
v_add_u32 v81,8,v80
v_mul_u32_u24 v81,43,v81
v_lshrrev_b32 v81,7,v81
v_and_b32 v81,6,v81
v_xor_b32 v81,v81,v82
v_lshlrev_b32 v81,4,v81
v_lshl_add_u32 v7,v80,7,v81
v_add_u32 v81,16,v80
v_mul_u32_u24 v81,43,v81
v_lshrrev_b32 v81,7,v81
v_and_b32 v81,6,v81
v_xor_b32 v81,v81,v82
v_lshlrev_b32 v81,4,v81
v_lshl_add_u32 v8,v80,7,v81
s_mov_b32 s37,0x5d800000
s_mov_b32 s36,0x3dd53b95
s_mov_b32 s31,0
s_mov_b32 s32,1
s_and_b32 s62,s2,7
s_lshl_b32 s33,s62,6
s_mul_i32 s22,s3,3072
s_add_u32 s23,s22,36864
s_mul_i32 s24,s3,22528
s_add_u32 s24,s24,73728
s_mov_b32 s69,0
s_lshl_b32 s62,s69,5
s_add_u32 s62,s62,s34
s_mul_i32 s63,s62,171
s_lshr_b32 s63,s63,9
s_mul_i32 s64,s63,3
s_sub_u32 s62,s62,s64
s_add_u32 s63,s63,s33
s_mul_i32 s30,s63,196608
s_mul_i32 s41,s63,325632
s_lshl_b32 s63,s3,2
s_add_u32 s64,s63,21
s_cmp_eq_u32 s3,0
s_cselect_b32 s64,20,s64
s_cselect_b32 s40,1,0
s_add_u32 s65,s63,37
s_cmp_eq_u32 s62,2
s_cselect_b32 s64,s65,s64
s_cselect_b32 s40,0,s40
s_add_u32 s65,s63,s3
s_cmp_eq_u32 s62,0
s_cselect_b32 s64,s65,s64
s_cselect_b32 s40,1,s40
s_mul_i32 s64,s64,6144
s_add_u32 s41,s41,s64
s_add_u32 s20,s30,s22
s_mov_b32 s21,s20
s_waitcnt lgkmcnt(0)
s_mov_b32 s4,s86
s_and_b32 s5,s87,0xffff
s_mov_b32 s6,100663296
s_mov_b32 s7,0x20000
s_mov_b32 s12,s84
s_and_b32 s13,s85,0xffff
s_mov_b32 s14,166723584
s_mov_b32 s15,0x20000
s_mov_b32 s8,s88
s_and_b32 s9,s89,0xffff
s_mov_b32 s10,100663296
s_mov_b32 s11,0x20000
s_mov_b32 s16,s90
s_and_b32 s17,s91,0xffff
s_mov_b32 s18,166723584
s_mov_b32 s19,0x20000
s_mov_b32 s28,s41
s_add_u32 m0,s22,0
s_nop 0
buffer_load_dwordx4 v6,s[4:7],s20 offen offset:0 lds
buffer_load_dwordx4 v7,s[4:7],s20 offen offset:1024 lds
buffer_load_dwordx4 v8,s[4:7],s20 offen offset:2048 lds
s_add_u32 s20,s20,12288
s_add_u32 m0,s24,0
s_nop 0
buffer_load_dwordx4 v6,s[12:15],s28 offen offset:0 nt lds
buffer_load_dwordx4 v7,s[12:15],s28 offen offset:1024 nt lds
buffer_load_dwordx4 v8,s[12:15],s28 offen offset:2048 nt lds
s_add_u32 s28,s28,3072
s_add_u32 m0,s24,3072
s_nop 0
buffer_load_dwordx4 v6,s[12:15],s28 offen offset:0 nt lds
buffer_load_dwordx4 v7,s[12:15],s28 offen offset:1024 nt lds
buffer_load_dwordx4 v8,s[12:15],s28 offen offset:2048 nt lds
s_add_u32 s28,s28,3072
s_add_u32 m0,s22,12288
s_nop 0
buffer_load_dwordx4 v6,s[4:7],s20 offen offset:0 lds
buffer_load_dwordx4 v7,s[4:7],s20 offen offset:1024 lds
buffer_load_dwordx4 v8,s[4:7],s20 offen offset:2048 lds
s_add_u32 s20,s20,12288
s_add_u32 m0,s24,6144
s_nop 0
buffer_load_dwordx4 v6,s[12:15],s28 offen offset:0 nt lds
buffer_load_dwordx4 v7,s[12:15],s28 offen offset:1024 nt lds
buffer_load_dwordx4 v8,s[12:15],s28 offen offset:2048 nt lds
s_add_u32 s28,s28,3072
s_add_u32 m0,s24,9216
s_nop 0
buffer_load_dwordx4 v6,s[12:15],s28 offen offset:0 nt lds
buffer_load_dwordx4 v7,s[12:15],s28 offen offset:1024 nt lds
buffer_load_dwordx4 v8,s[12:15],s28 offen offset:2048 nt lds
s_add_u32 s28,s28,3072
s_getpc_b64 s[46:47]
s_mul_i32 s62,s34,4096
s_mul_i32 s48,s3,1024
s_add_u32 s48,s48,s62
v_min_u32 v85,31,v19
v_lshlrev_b32 v85,7,v85
v_add_u32 v85,s62,v85
v_min_u32 v85,L_codeend-L_first-4,v85
s_cmp_lg_u32 s3,0
s_cbranch_scc1 L_nopre
global_load_dword v160,v85,s[46:47]
L_nopre:
v_and_b32 v80,15,v19
v_lshrrev_b32 v81,4,v19
v_mul_u32_u24 v0,384,v80
v_and_b32 v83,6,v80
v_xor_b32 v83,v83,v81
v_lshl_add_u32 v0,v83,4,v0
v_xor_b32 v1,64,v0
v_add_u32 v11,s24,v0
v_add_u32 v12,s24,v1
v_lshrrev_b32 v80,2,v19
v_mul_u32_u24 v2,384,v80
v_and_b32 v80,6,v80
v_bfe_u32 v83,v19,1,1
v_xor_b32 v80,v80,v83
v_lshl_add_u32 v2,v80,4,v2
v_and_b32 v83,1,v19
v_lshl_add_u32 v2,v83,3,v2
v_add_u32 v2,36864,v2
v_xor_b32 v3,32,v2
v_xor_b32 v4,64,v2
v_xor_b32 v5,96,v2
v_lshrrev_b32 v80,3,v19
v_and_b32 v81,7,v19
v_xor_b32 v83,v81,v80
v_lshl_add_u32 v10,v80,7,s24
v_lshl_add_u32 v10,v83,4,v10
v_mul_u32_u24 v9,384,v80
v_lshl_add_u32 v9,v81,4,v9
v_lshrrev_b32 v80,4,v19
v_xor_b32 v80,v80,v19
v_bfe_u32 v80,v80,1,1
v_subrev_u32 v80,1,v80
v_and_b32 v80,0x3f803f80,v80
v_accvgpr_write_b32 a152,v80
v_accvgpr_write_b32 a153,v80
v_accvgpr_write_b32 a154,v80
v_accvgpr_write_b32 a155,v80
v_and_b32 v80,1,v19
v_mul_u32_u24 v80,0xaaaa,v80
v_add_u32 v18,0x4444,v80
L_first:
s_waitcnt vmcnt(6)
s_barrier
s_cmp_eq_u32 s40,0
s_cbranch_scc1 L_start4
L_start5:
s_add_u32 m0,s24,12288
s_waitcnt vmcnt(9)
ds_read_b128 a[0:3],v11 offset:0
buffer_load_dwordx4 v6,s[12:15],s28 offen offset:0 nt lds
ds_read_b128 a[4:7],v12 offset:0
buffer_load_dwordx4 v7,s[12:15],s28 offen offset:1024 nt lds
ds_read_b128 a[8:11],v11 offset:128
buffer_load_dwordx4 v8,s[12:15],s28 offen offset:2048 nt lds
s_add_u32 s28,s28,3072
s_add_u32 m0,s24,15360
ds_read_b128 a[12:15],v12 offset:128
buffer_load_dwordx4 v6,s[12:15],s28 offen offset:0 nt lds
ds_read_b128 a[16:19],v11 offset:256
buffer_load_dwordx4 v7,s[12:15],s28 offen offset:1024 nt lds
ds_read_b128 a[20:23],v12 offset:256
buffer_load_dwordx4 v8,s[12:15],s28 offen offset:2048 nt lds
s_add_u32 s28,s28,3072
s_add_u32 m0,s24,0
ds_read_b128 a[120:123],v0 offset:0
v_mov_b32 v60,0
ds_read_b128 a[124:127],v1 offset:0
v_mov_b32 v61,0
ds_read_b128 a[128:131],v0 offset:128
v_mov_b32 v62,0
ds_read_b128 a[132:135],v1 offset:128
v_mov_b32 v63,0
ds_read_b128 a[136:139],v0 offset:256
v_mov_b32 v64,0
ds_read_b128 a[140:143],v1 offset:256
v_mov_b32 v65,0
ds_read_b128 a[144:147],v0 offset:6144
v_mov_b32 v66,0
ds_read_b128 a[148:151],v1 offset:6144
v_mov_b32 v67,0
s_waitcnt lgkmcnt(7)
v_mfma_f32_16x16x32_bf16 v[72:75],a[120:123],a[0:3],0
s_waitcnt lgkmcnt(6)
ds_read_b128 a[120:123],v0 offset:6272
v_mov_b32 v68,0
v_mfma_f32_16x16x32_bf16 v[72:75],a[124:127],a[4:7],v[72:75]
s_waitcnt lgkmcnt(6)
ds_read_b128 a[124:127],v1 offset:6272
v_mov_b32 v69,0
v_mfma_f32_16x16x32_bf16 v[72:75],a[128:131],a[8:11],v[72:75]
s_waitcnt lgkmcnt(6)
ds_read_b128 a[128:131],v0 offset:6400
v_mov_b32 v70,0
v_mfma_f32_16x16x32_bf16 v[72:75],a[132:135],a[12:15],v[72:75]
s_waitcnt lgkmcnt(5)
ds_read_b128 a[132:135],v1 offset:6400
v_mov_b32 v71,0
v_mfma_f32_16x16x32_bf16 v[72:75],a[136:139],a[16:19],v[72:75]
ds_read_b128 a[136:139],v0 offset:0
v_mfma_f32_16x16x32_bf16 v[72:75],a[140:143],a[20:23],v[72:75]
s_waitcnt lgkmcnt(5)
ds_read_b128 a[140:143],v1 offset:0
v_mfma_f32_16x16x32_bf16 v[76:79],a[144:147],a[0:3],0
ds_read_b128 a[144:147],v0 offset:128
v_mfma_f32_16x16x32_bf16 v[76:79],a[148:151],a[4:7],v[76:79]
s_waitcnt lgkmcnt(6)
ds_read_b128 a[148:151],v1 offset:128
v_mfma_f32_16x16x32_bf16 v[76:79],a[120:123],a[8:11],v[76:79]
s_waitcnt lgkmcnt(6)
ds_read_b128 a[120:123],v0 offset:256
v_mfma_f32_16x16x32_bf16 v[76:79],a[124:127],a[12:15],v[76:79]
s_waitcnt lgkmcnt(6)
ds_read_b128 a[124:127],v1 offset:256
v_max3_f32 v44,v72,v73,v74
v_mfma_f32_16x16x32_bf16 v[76:79],a[128:131],a[16:19],v[76:79]
s_waitcnt lgkmcnt(6)
ds_read_b128 a[128:131],v0 offset:6144
v_mfma_f32_16x16x32_bf16 v[76:79],a[132:135],a[20:23],v[76:79]
s_waitcnt vmcnt(6)
ds_read_b128 a[24:27],v11 offset:6144
buffer_load_dwordx4 v6,s[12:15],s28 offen offset:0 nt lds
ds_read_b128 a[28:31],v12 offset:6144
buffer_load_dwordx4 v7,s[12:15],s28 offen offset:1024 nt lds
ds_read_b128 a[32:35],v11 offset:6272
buffer_load_dwordx4 v8,s[12:15],s28 offen offset:2048 nt lds
s_add_u32 s28,s28,3072
s_add_u32 m0,s24,3072
ds_read_b128 a[36:39],v12 offset:6272
buffer_load_dwordx4 v6,s[12:15],s28 offen offset:0 nt lds
ds_read_b128 a[40:43],v11 offset:6400
buffer_load_dwordx4 v7,s[12:15],s28 offen offset:1024 nt lds
ds_read_b128 a[44:47],v12 offset:6400
buffer_load_dwordx4 v8,s[12:15],s28 offen offset:2048 nt lds
s_add_u32 s28,s28,3072
s_add_u32 m0,s24,6144
ds_read_b128 a[132:135],v1 offset:6144
v_max3_f32 v44,v44,v75,v76
s_waitcnt lgkmcnt(6)
v_mfma_f32_16x16x32_bf16 v[80:83],a[136:139],a[24:27],0
s_waitcnt lgkmcnt(5)
ds_read_b128 a[136:139],v0 offset:6272
v_max3_f32 v44,v44,v77,v78
v_mfma_f32_16x16x32_bf16 v[80:83],a[140:143],a[28:31],v[80:83]
s_waitcnt lgkmcnt(5)
ds_read_b128 a[140:143],v1 offset:6272
v_max_f32 v44,v44,v79
v_mfma_f32_16x16x32_bf16 v[80:83],a[144:147],a[32:35],v[80:83]
s_waitcnt lgkmcnt(5)
ds_read_b128 a[144:147],v0 offset:6400
v_mov_b32 v45,v44
v_mfma_f32_16x16x32_bf16 v[80:83],a[148:151],a[36:39],v[80:83]
s_waitcnt lgkmcnt(5)
ds_read_b128 a[148:151],v1 offset:6400
v_permlane32_swap_b32 v45,v44
v_mfma_f32_16x16x32_bf16 v[80:83],a[120:123],a[40:43],v[80:83]
s_waitcnt lgkmcnt(5)
ds_read_b128 a[120:123],v0 offset:12288
v_max_f32 v44,v44,v45
v_mfma_f32_16x16x32_bf16 v[80:83],a[124:127],a[44:47],v[80:83]
ds_read_b128 a[124:127],v1 offset:12288
v_mov_b32 v45,v44
v_mfma_f32_16x16x32_bf16 v[84:87],a[128:131],a[24:27],0
s_waitcnt lgkmcnt(5)
ds_read_b128 a[128:131],v0 offset:12416
v_permlane16_swap_b32 v45,v44
v_mfma_f32_16x16x32_bf16 v[84:87],a[132:135],a[28:31],v[84:87]
ds_read_b128 a[132:135],v1 offset:12416
v_max_f32 v44,v44,v45
v_mfma_f32_16x16x32_bf16 v[84:87],a[136:139],a[32:35],v[84:87]
s_waitcnt lgkmcnt(5)
ds_read_b128 a[136:139],v0 offset:12544
v_mul_f32_e64 v13,-s36,v44
v_mfma_f32_16x16x32_bf16 v[84:87],a[140:143],a[36:39],v[84:87]
ds_read_b128 a[140:143],v1 offset:12544
v_fma_f32 v72,v72,s36,v13
v_mfma_f32_16x16x32_bf16 v[84:87],a[144:147],a[40:43],v[84:87]
s_waitcnt lgkmcnt(5)
ds_read_b128 a[144:147],v0 offset:18432
v_fma_f32 v73,v73,s36,v13
v_mfma_f32_16x16x32_bf16 v[84:87],a[148:151],a[44:47],v[84:87]
ds_read_b128 a[148:151],v1 offset:18432
v_fma_f32 v74,v74,s36,v13
v_fma_f32 v75,v75,s36,v13
v_exp_f32 v72,v72
v_exp_f32 v73,v73
v_exp_f32 v74,v74
v_exp_f32 v75,v75
v_cvt_pk_bf16_f32 v20,v72,v73
v_cvt_pk_bf16_f32 v21,v74,v75
v_mfma_f32_16x16x32_bf16 v[72:75],a[120:123],a[0:3],0
s_waitcnt lgkmcnt(3)
ds_read_b128 a[120:123],v0 offset:18560
v_fma_f32 v76,v76,s36,v13
v_mfma_f32_16x16x32_bf16 v[72:75],a[124:127],a[4:7],v[72:75]
ds_read_b128 a[124:127],v1 offset:18560
v_fma_f32 v77,v77,s36,v13
v_mfma_f32_16x16x32_bf16 v[72:75],a[128:131],a[8:11],v[72:75]
ds_read_b128 a[128:131],v0 offset:18688
v_fma_f32 v78,v78,s36,v13
v_mfma_f32_16x16x32_bf16 v[72:75],a[132:135],a[12:15],v[72:75]
ds_read_b128 a[132:135],v1 offset:18688
v_fma_f32 v79,v79,s36,v13
v_mfma_f32_16x16x32_bf16 v[72:75],a[136:139],a[16:19],v[72:75]
s_waitcnt lgkmcnt(4)
ds_read_b128 a[136:139],v0 offset:0
v_exp_f32 v76,v76
v_mfma_f32_16x16x32_bf16 v[72:75],a[140:143],a[20:23],v[72:75]
ds_read_b128 a[140:143],v1 offset:0
v_exp_f32 v77,v77
v_exp_f32 v78,v78
v_exp_f32 v79,v79
v_cvt_pk_bf16_f32 v22,v76,v77
v_cvt_pk_bf16_f32 v23,v78,v79
v_mfma_f32_16x16x32_bf16 v[76:79],a[144:147],a[0:3],0
ds_read_b128 a[144:147],v0 offset:128
v_max3_f32 v48,v80,v81,v82
v_mfma_f32_16x16x32_bf16 v[76:79],a[148:151],a[4:7],v[76:79]
s_waitcnt lgkmcnt(4)
ds_read_b128 a[148:151],v1 offset:128
v_max3_f32 v48,v48,v83,v84
v_mfma_f32_16x16x32_bf16 v[76:79],a[120:123],a[8:11],v[76:79]
ds_read_b128 a[120:123],v0 offset:256
v_max3_f32 v48,v48,v85,v86
v_mfma_f32_16x16x32_bf16 v[76:79],a[124:127],a[12:15],v[76:79]
ds_read_b128 a[124:127],v1 offset:256
v_max_f32 v48,v48,v87
v_mfma_f32_16x16x32_bf16 v[76:79],a[128:131],a[16:19],v[76:79]
s_waitcnt lgkmcnt(4)
ds_read_b128 a[128:131],v0 offset:6144
v_mov_b32 v49,v48
v_mfma_f32_16x16x32_bf16 v[76:79],a[132:135],a[20:23],v[76:79]
s_waitcnt vmcnt(6)
ds_read_b128 a[48:51],v11 offset:12288
buffer_load_dwordx4 v6,s[12:15],s28 offen offset:0 nt lds
ds_read_b128 a[52:55],v12 offset:12288
buffer_load_dwordx4 v7,s[12:15],s28 offen offset:1024 nt lds
ds_read_b128 a[56:59],v11 offset:12416
buffer_load_dwordx4 v8,s[12:15],s28 offen offset:2048 nt lds
s_add_u32 s28,s28,3072
s_add_u32 m0,s24,9216
ds_read_b128 a[60:63],v12 offset:12416
buffer_load_dwordx4 v6,s[12:15],s28 offen offset:0 nt lds
ds_read_b128 a[64:67],v11 offset:12544
buffer_load_dwordx4 v7,s[12:15],s28 offen offset:1024 nt lds
ds_read_b128 a[68:71],v12 offset:12544
buffer_load_dwordx4 v8,s[12:15],s28 offen offset:2048 nt lds
s_add_u32 s28,s28,3072
s_add_u32 m0,s23,0
ds_read_b128 a[132:135],v1 offset:6144
v_permlane32_swap_b32 v49,v48
s_waitcnt lgkmcnt(6)
v_mfma_f32_16x16x32_bf16 v[88:91],a[136:139],a[48:51],0
s_waitcnt lgkmcnt(5)
ds_read_b128 a[136:139],v0 offset:6272
v_max_f32 v48,v48,v49
v_mfma_f32_16x16x32_bf16 v[88:91],a[140:143],a[52:55],v[88:91]
s_waitcnt lgkmcnt(5)
ds_read_b128 a[140:143],v1 offset:6272
v_mov_b32 v49,v48
v_mfma_f32_16x16x32_bf16 v[88:91],a[144:147],a[56:59],v[88:91]
s_waitcnt lgkmcnt(5)
ds_read_b128 a[144:147],v0 offset:6400
v_permlane16_swap_b32 v49,v48
v_mfma_f32_16x16x32_bf16 v[88:91],a[148:151],a[60:63],v[88:91]
s_waitcnt lgkmcnt(4)
ds_read_b128 a[148:151],v1 offset:6400
v_max_f32 v48,v48,v49
v_mfma_f32_16x16x32_bf16 v[88:91],a[120:123],a[64:67],v[88:91]
ds_read_b128 a[120:123],v0 offset:12288
v_mul_f32_e64 v14,-s36,v48
v_mfma_f32_16x16x32_bf16 v[88:91],a[124:127],a[68:71],v[88:91]
ds_read_b128 a[124:127],v1 offset:12288
v_fma_f32 v80,v80,s36,v14
v_mfma_f32_16x16x32_bf16 v[92:95],a[128:131],a[48:51],0
s_waitcnt lgkmcnt(5)
ds_read_b128 a[128:131],v0 offset:12416
v_fma_f32 v81,v81,s36,v14
v_mfma_f32_16x16x32_bf16 v[92:95],a[132:135],a[52:55],v[92:95]
ds_read_b128 a[132:135],v1 offset:12416
v_fma_f32 v82,v82,s36,v14
v_mfma_f32_16x16x32_bf16 v[92:95],a[136:139],a[56:59],v[92:95]
s_waitcnt lgkmcnt(5)
ds_read_b128 a[136:139],v0 offset:12544
v_fma_f32 v83,v83,s36,v14
v_mfma_f32_16x16x32_bf16 v[92:95],a[140:143],a[60:63],v[92:95]
ds_read_b128 a[140:143],v1 offset:12544
v_exp_f32 v80,v80
v_mfma_f32_16x16x32_bf16 v[92:95],a[144:147],a[64:67],v[92:95]
s_waitcnt lgkmcnt(5)
ds_read_b128 a[144:147],v0 offset:18432
v_exp_f32 v81,v81
v_mfma_f32_16x16x32_bf16 v[92:95],a[148:151],a[68:71],v[92:95]
ds_read_b128 a[148:151],v1 offset:18432
v_exp_f32 v82,v82
v_exp_f32 v83,v83
v_cvt_pk_bf16_f32 v24,v80,v81
v_cvt_pk_bf16_f32 v25,v82,v83
v_mfma_f32_16x16x32_bf16 v[80:83],a[120:123],a[24:27],0
s_waitcnt lgkmcnt(4)
ds_read_b128 a[120:123],v0 offset:18560
v_fma_f32 v84,v84,s36,v14
v_mfma_f32_16x16x32_bf16 v[80:83],a[124:127],a[28:31],v[80:83]
ds_read_b128 a[124:127],v1 offset:18560
v_fma_f32 v85,v85,s36,v14
v_mfma_f32_16x16x32_bf16 v[80:83],a[128:131],a[32:35],v[80:83]
ds_read_b128 a[128:131],v0 offset:18688
v_fma_f32 v86,v86,s36,v14
v_mfma_f32_16x16x32_bf16 v[80:83],a[132:135],a[36:39],v[80:83]
s_waitcnt lgkmcnt(4)
ds_read_b128 a[132:135],v1 offset:18688
v_fma_f32 v87,v87,s36,v14
v_mfma_f32_16x16x32_bf16 v[80:83],a[136:139],a[40:43],v[80:83]
ds_read_b128 a[136:139],v0 offset:0
v_exp_f32 v84,v84
v_mfma_f32_16x16x32_bf16 v[80:83],a[140:143],a[44:47],v[80:83]
ds_read_b128 a[140:143],v1 offset:0
v_exp_f32 v85,v85
v_exp_f32 v86,v86
v_exp_f32 v87,v87
v_cvt_pk_bf16_f32 v26,v84,v85
v_cvt_pk_bf16_f32 v27,v86,v87
v_mfma_f32_16x16x32_bf16 v[84:87],a[144:147],a[24:27],0
ds_read_b128 a[144:147],v0 offset:128
v_max3_f32 v52,v88,v89,v90
v_smfmac_f32_16x16x64_bf16 v[60:63],a[152:155],v[20:27],v18
s_waitcnt lgkmcnt(4)
v_max3_f32 v52,v52,v91,v92
v_mfma_f32_16x16x32_bf16 v[84:87],a[148:151],a[28:31],v[84:87]
ds_read_b128 a[148:151],v1 offset:128
v_max3_f32 v52,v52,v93,v94
v_mfma_f32_16x16x32_bf16 v[84:87],a[120:123],a[32:35],v[84:87]
ds_read_b128 a[120:123],v0 offset:256
v_max_f32 v52,v52,v95
v_mfma_f32_16x16x32_bf16 v[84:87],a[124:127],a[36:39],v[84:87]
ds_read_b128 a[124:127],v1 offset:256
v_mov_b32 v53,v52
v_mfma_f32_16x16x32_bf16 v[84:87],a[128:131],a[40:43],v[84:87]
s_waitcnt lgkmcnt(4)
ds_read_b128 a[128:131],v0 offset:6144
v_permlane32_swap_b32 v53,v52
v_mfma_f32_16x16x32_bf16 v[84:87],a[132:135],a[44:47],v[84:87]
s_waitcnt vmcnt(6)
ds_read_b128 a[72:75],v11 offset:0
buffer_load_dwordx4 v6,s[8:11],s21 offen offset:0 lds
ds_read_b128 a[76:79],v12 offset:0
buffer_load_dwordx4 v7,s[8:11],s21 offen offset:1024 lds
ds_read_b128 a[80:83],v11 offset:128
buffer_load_dwordx4 v8,s[8:11],s21 offen offset:2048 lds
s_add_u32 s21,s21,12288
s_add_u32 m0,s22,24576
ds_read_b128 a[84:87],v12 offset:128
buffer_load_dwordx4 v6,s[4:7],s20 offen offset:0 lds
ds_read_b128 a[88:91],v11 offset:256
buffer_load_dwordx4 v7,s[4:7],s20 offen offset:1024 lds
ds_read_b128 a[92:95],v12 offset:256
buffer_load_dwordx4 v8,s[4:7],s20 offen offset:2048 lds
s_add_u32 s20,s20,12288
s_add_u32 m0,s23,12288
ds_read_b128 a[132:135],v1 offset:6144
v_max_f32 v52,v52,v53
s_waitcnt lgkmcnt(6)
v_mfma_f32_16x16x32_bf16 v[96:99],a[136:139],a[72:75],0
s_waitcnt lgkmcnt(5)
ds_read_b128 a[136:139],v0 offset:6272
v_mov_b32 v53,v52
v_mfma_f32_16x16x32_bf16 v[96:99],a[140:143],a[76:79],v[96:99]
s_waitcnt lgkmcnt(5)
ds_read_b128 a[140:143],v1 offset:6272
v_permlane16_swap_b32 v53,v52
v_mfma_f32_16x16x32_bf16 v[96:99],a[144:147],a[80:83],v[96:99]
s_waitcnt lgkmcnt(5)
ds_read_b128 a[144:147],v0 offset:6400
v_max_f32 v52,v52,v53
v_mul_f32_e64 v15,-s36,v52
v_mfma_f32_16x16x32_bf16 v[96:99],a[148:151],a[84:87],v[96:99]
s_waitcnt lgkmcnt(4)
ds_read_b128 a[148:151],v1 offset:6400
v_fma_f32 v88,v88,s36,v15
v_mfma_f32_16x16x32_bf16 v[96:99],a[120:123],a[88:91],v[96:99]
ds_read_b128 a[120:123],v0 offset:12288
v_fma_f32 v89,v89,s36,v15
v_mfma_f32_16x16x32_bf16 v[96:99],a[124:127],a[92:95],v[96:99]
ds_read_b128 a[124:127],v1 offset:12288
v_fma_f32 v90,v90,s36,v15
v_mfma_f32_16x16x32_bf16 v[100:103],a[128:131],a[72:75],0
s_waitcnt lgkmcnt(5)
ds_read_b128 a[128:131],v0 offset:12416
v_fma_f32 v91,v91,s36,v15
v_mfma_f32_16x16x32_bf16 v[100:103],a[132:135],a[76:79],v[100:103]
ds_read_b128 a[132:135],v1 offset:12416
v_exp_f32 v88,v88
v_mfma_f32_16x16x32_bf16 v[100:103],a[136:139],a[80:83],v[100:103]
s_waitcnt lgkmcnt(5)
ds_read_b128 a[136:139],v0 offset:12544
v_exp_f32 v89,v89
v_mfma_f32_16x16x32_bf16 v[100:103],a[140:143],a[84:87],v[100:103]
ds_read_b128 a[140:143],v1 offset:12544
v_exp_f32 v90,v90
v_mfma_f32_16x16x32_bf16 v[100:103],a[144:147],a[88:91],v[100:103]
s_waitcnt lgkmcnt(5)
ds_read_b128 a[144:147],v0 offset:18432
v_exp_f32 v91,v91
v_mfma_f32_16x16x32_bf16 v[100:103],a[148:151],a[92:95],v[100:103]
ds_read_b128 a[148:151],v1 offset:18432
v_cvt_pk_bf16_f32 v28,v88,v89
v_cvt_pk_bf16_f32 v29,v90,v91
v_mfma_f32_16x16x32_bf16 v[88:91],a[120:123],a[48:51],0
s_waitcnt lgkmcnt(5)
ds_read_b128 a[120:123],v0 offset:18560
v_fma_f32 v92,v92,s36,v15
v_mfma_f32_16x16x32_bf16 v[88:91],a[124:127],a[52:55],v[88:91]
ds_read_b128 a[124:127],v1 offset:18560
v_fma_f32 v93,v93,s36,v15
v_mfma_f32_16x16x32_bf16 v[88:91],a[128:131],a[56:59],v[88:91]
s_waitcnt lgkmcnt(5)
ds_read_b128 a[128:131],v0 offset:18688
v_fma_f32 v94,v94,s36,v15
v_mfma_f32_16x16x32_bf16 v[88:91],a[132:135],a[60:63],v[88:91]
ds_read_b128 a[132:135],v1 offset:18688
v_fma_f32 v95,v95,s36,v15
v_mfma_f32_16x16x32_bf16 v[88:91],a[136:139],a[64:67],v[88:91]
s_waitcnt lgkmcnt(5)
ds_read_b128 a[136:139],v0 offset:0
v_exp_f32 v92,v92
v_mfma_f32_16x16x32_bf16 v[88:91],a[140:143],a[68:71],v[88:91]
ds_read_b128 a[140:143],v1 offset:0
v_exp_f32 v93,v93
v_exp_f32 v94,v94
v_exp_f32 v95,v95
v_cvt_pk_bf16_f32 v30,v92,v93
v_cvt_pk_bf16_f32 v31,v94,v95
v_mfma_f32_16x16x32_bf16 v[92:95],a[144:147],a[48:51],0
s_waitcnt lgkmcnt(4)
ds_read_b128 a[144:147],v0 offset:128
v_max3_f32 v56,v96,v97,v98
v_mfma_f32_16x16x32_bf16 v[92:95],a[148:151],a[52:55],v[92:95]
ds_read_b128 a[148:151],v1 offset:128
v_max3_f32 v56,v56,v99,v100
v_mfma_f32_16x16x32_bf16 v[92:95],a[120:123],a[56:59],v[92:95]
ds_read_b128 a[120:123],v0 offset:256
v_max3_f32 v56,v56,v101,v102
v_mfma_f32_16x16x32_bf16 v[92:95],a[124:127],a[60:63],v[92:95]
s_waitcnt lgkmcnt(4)
ds_read_b128 a[124:127],v1 offset:256
v_max_f32 v56,v56,v103
v_mfma_f32_16x16x32_bf16 v[92:95],a[128:131],a[64:67],v[92:95]
ds_read_b128 a[128:131],v0 offset:6144
v_mov_b32 v57,v56
v_mfma_f32_16x16x32_bf16 v[92:95],a[132:135],a[68:71],v[92:95]
s_waitcnt vmcnt(6)
ds_read_b128 a[96:99],v11 offset:6144
buffer_load_dwordx4 v6,s[8:11],s21 offen offset:0 lds
ds_read_b128 a[100:103],v12 offset:6144
buffer_load_dwordx4 v7,s[8:11],s21 offen offset:1024 lds
ds_read_b128 a[104:107],v11 offset:6272
buffer_load_dwordx4 v8,s[8:11],s21 offen offset:2048 lds
s_add_u32 s21,s21,12288
s_add_u32 m0,s23,24576
ds_read_b128 a[108:111],v12 offset:6272
buffer_load_dwordx4 v6,s[8:11],s21 offen offset:0 lds
ds_read_b128 a[112:115],v11 offset:6400
buffer_load_dwordx4 v7,s[8:11],s21 offen offset:1024 lds
ds_read_b128 a[116:119],v12 offset:6400
buffer_load_dwordx4 v8,s[8:11],s21 offen offset:2048 lds
s_add_u32 s21,s21,12288
ds_read_b128 a[132:135],v1 offset:6144
v_permlane32_swap_b32 v57,v56
s_waitcnt lgkmcnt(6)
v_mfma_f32_16x16x32_bf16 v[104:107],a[136:139],a[96:99],0
s_mov_b32 s27,166723584
ds_read_b128 a[136:139],v0 offset:6272
v_max_f32 v56,v56,v57
s_waitcnt lgkmcnt(6)
v_mfma_f32_16x16x32_bf16 v[104:107],a[140:143],a[100:103],v[104:107]
s_mov_b32 s42,s41
ds_read_b128 a[140:143],v1 offset:6272
v_mov_b32 v57,v56
s_waitcnt lgkmcnt(6)
v_mfma_f32_16x16x32_bf16 v[104:107],a[144:147],a[104:107],v[104:107]
s_add_u32 s69,s69,1
ds_read_b128 a[144:147],v0 offset:6400
v_permlane16_swap_b32 v57,v56
v_max_f32 v56,v56,v57
s_waitcnt lgkmcnt(6)
v_mfma_f32_16x16x32_bf16 v[104:107],a[148:151],a[108:111],v[104:107]
s_lshl_b32 s62,s69,5
ds_read_b128 a[148:151],v1 offset:6400
v_mul_f32_e64 v16,-s36,v56
s_waitcnt lgkmcnt(5)
v_mfma_f32_16x16x32_bf16 v[104:107],a[120:123],a[112:115],v[104:107]
s_add_u32 s62,s62,s34
ds_read_b128 a[120:123],v0 offset:12288
v_fma_f32 v96,v96,s36,v16
v_mfma_f32_16x16x32_bf16 v[104:107],a[124:127],a[116:119],v[104:107]
s_mul_i32 s63,s62,171
ds_read_b128 a[124:127],v1 offset:12288
v_fma_f32 v97,v97,s36,v16
v_mfma_f32_16x16x32_bf16 v[108:111],a[128:131],a[96:99],0
s_lshr_b32 s63,s63,9
ds_read_b128 a[128:131],v0 offset:12416
v_fma_f32 v98,v98,s36,v16
s_waitcnt lgkmcnt(6)
v_mfma_f32_16x16x32_bf16 v[108:111],a[132:135],a[100:103],v[108:111]
s_mul_i32 s64,s63,3
ds_read_b128 a[132:135],v1 offset:12416
v_fma_f32 v99,v99,s36,v16
v_mfma_f32_16x16x32_bf16 v[108:111],a[136:139],a[104:107],v[108:111]
s_sub_u32 s62,s62,s64
ds_read_b128 a[136:139],v0 offset:12544
v_exp_f32 v96,v96
s_waitcnt lgkmcnt(6)
v_mfma_f32_16x16x32_bf16 v[108:111],a[140:143],a[108:111],v[108:111]
s_add_u32 s63,s63,s33
ds_read_b128 a[140:143],v1 offset:12544
v_exp_f32 v97,v97
v_mfma_f32_16x16x32_bf16 v[108:111],a[144:147],a[112:115],v[108:111]
s_mul_i32 s30,s63,196608
ds_read_b128 a[144:147],v0 offset:18432
v_exp_f32 v98,v98
s_waitcnt lgkmcnt(6)
v_mfma_f32_16x16x32_bf16 v[108:111],a[148:151],a[116:119],v[108:111]
s_waitcnt vmcnt(9)
s_barrier
ds_read_b128 a[148:151],v1 offset:18432
v_exp_f32 v99,v99
v_cvt_pk_bf16_f32 v32,v96,v97
v_cvt_pk_bf16_f32 v33,v98,v99
v_mfma_f32_16x16x32_bf16 v[96:99],a[120:123],a[72:75],0
s_mul_i32 s41,s63,325632
ds_read_b128 a[120:123],v0 offset:18560
v_fma_f32 v100,v100,s36,v16
s_waitcnt lgkmcnt(4)
v_mfma_f32_16x16x32_bf16 v[96:99],a[124:127],a[76:79],v[96:99]
s_lshl_b32 s63,s3,2
ds_read_b128 a[124:127],v1 offset:18560
v_fma_f32 v101,v101,s36,v16
v_mfma_f32_16x16x32_bf16 v[96:99],a[128:131],a[80:83],v[96:99]
s_add_u32 s64,s63,21
ds_read_b128 a[128:131],v0 offset:18688
v_fma_f32 v102,v102,s36,v16
v_mfma_f32_16x16x32_bf16 v[96:99],a[132:135],a[84:87],v[96:99]
s_cmp_eq_u32 s3,0
ds_read_b128 a[132:135],v1 offset:18688
v_fma_f32 v103,v103,s36,v16
v_mfma_f32_16x16x32_bf16 v[96:99],a[136:139],a[88:91],v[96:99]
s_cselect_b32 s64,20,s64
ds_read_b128 a[136:139],v0 offset:12288
v_exp_f32 v100,v100
s_waitcnt lgkmcnt(6)
v_mfma_f32_16x16x32_bf16 v[96:99],a[140:143],a[92:95],v[96:99]
s_cselect_b32 s40,1,0
ds_read_b128 a[140:143],v1 offset:12288
v_exp_f32 v101,v101
v_exp_f32 v102,v102
v_exp_f32 v103,v103
v_cvt_pk_bf16_f32 v34,v100,v101
v_cvt_pk_bf16_f32 v35,v102,v103
v_mfma_f32_16x16x32_bf16 v[100:103],a[144:147],a[72:75],0
s_add_u32 s65,s63,37
ds_read_b128 a[144:147],v0 offset:12416
v_max3_f32 v40,v104,v105,v106
v_smfmac_f32_16x16x64_bf16 v[64:67],a[152:155],v[28:35],v18
s_cmp_eq_u32 s62,2
s_cselect_b32 s64,s65,s64
v_max3_f32 v40,v40,v107,v108
s_waitcnt lgkmcnt(4)
v_mfma_f32_16x16x32_bf16 v[100:103],a[148:151],a[76:79],v[100:103]
s_cselect_b32 s40,0,s40
ds_read_b128 a[148:151],v1 offset:12416
v_max3_f32 v40,v40,v109,v110
v_mfma_f32_16x16x32_bf16 v[100:103],a[120:123],a[80:83],v[100:103]
s_add_u32 s65,s63,s3
ds_read_b128 a[120:123],v0 offset:12544
v_max_f32 v40,v40,v111
v_mfma_f32_16x16x32_bf16 v[100:103],a[124:127],a[84:87],v[100:103]
s_cmp_eq_u32 s62,0
ds_read_b128 a[124:127],v1 offset:12544
v_mov_b32 v41,v40
v_mfma_f32_16x16x32_bf16 v[100:103],a[128:131],a[88:91],v[100:103]
s_cselect_b32 s64,s65,s64
ds_read_b128 a[128:131],v0 offset:18432
v_permlane32_swap_b32 v41,v40
s_waitcnt lgkmcnt(5)
v_mfma_f32_16x16x32_bf16 v[100:103],a[132:135],a[92:95],v[100:103]
s_cselect_b32 s40,1,s40
ds_read_b128 a[132:135],v1 offset:18432
v_max_f32 v40,v40,v41
v_mov_b32 v41,v40
v_fma_f32 v72,v72,s36,v13
v_fma_f32 v73,v73,s36,v13
v_permlane16_swap_b32 v41,v40
v_max_f32 v40,v40,v41
v_mul_f32_e64 v17,-s36,v40
v_fma_f32 v104,v104,s36,v17
v_fma_f32 v105,v105,s36,v17
v_fma_f32 v106,v106,s36,v17
v_fma_f32 v107,v107,s36,v17
v_exp_f32 v104,v104
v_exp_f32 v105,v105
v_exp_f32 v106,v106
v_exp_f32 v107,v107
v_cvt_pk_bf16_f32 v36,v104,v105
v_cvt_pk_bf16_f32 v37,v106,v107
v_mfma_f32_16x16x32_bf16 v[104:107],a[136:139],a[96:99],0
s_mul_i32 s64,s64,6144
ds_read_b128 a[136:139],v0 offset:18560
v_fma_f32 v108,v108,s36,v17
v_mfma_f32_16x16x32_bf16 v[104:107],a[140:143],a[100:103],v[104:107]
s_add_u32 s41,s41,s64
ds_read_b128 a[140:143],v1 offset:18560
v_fma_f32 v109,v109,s36,v17
s_waitcnt lgkmcnt(2)
v_mfma_f32_16x16x32_bf16 v[104:107],a[144:147],a[104:107],v[104:107]
s_cmp_ge_u32 s69,6
ds_read_b128 a[144:147],v0 offset:18688
v_fma_f32 v110,v110,s36,v17
v_mfma_f32_16x16x32_bf16 v[104:107],a[148:151],a[108:111],v[104:107]
s_cselect_b32 s41,166723584,s41
ds_read_b128 a[148:151],v1 offset:18688
v_fma_f32 v111,v111,s36,v17
v_mfma_f32_16x16x32_bf16 v[104:107],a[120:123],a[112:115],v[104:107]
s_cselect_b32 s30,100663296,s30
ds_read_b64_tr_b16 a[120:121],v2 offset:0
v_exp_f32 v108,v108
v_mfma_f32_16x16x32_bf16 v[104:107],a[124:127],a[116:119],v[104:107]
s_add_u32 s25,s30,s22
ds_read_b64_tr_b16 a[122:123],v2 offset:6144
ds_read_b64_tr_b16 a[124:125],v3 offset:0
ds_read_b64_tr_b16 a[126:127],v3 offset:6144
v_exp_f32 v109,v109
v_exp_f32 v110,v110
v_exp_f32 v111,v111
v_cvt_pk_bf16_f32 v38,v108,v109
v_cvt_pk_bf16_f32 v39,v110,v111
v_mfma_f32_16x16x32_bf16 v[108:111],a[128:131],a[96:99],0
s_add_u32 s26,s25,12288
ds_read_b64_tr_b16 a[128:129],v4 offset:0
v_fma_f32 v74,v74,s36,v13
v_mfma_f32_16x16x32_bf16 v[108:111],a[132:135],a[100:103],v[108:111]
s_mov_b32 s28,s41
ds_read_b64_tr_b16 a[130:131],v4 offset:6144
v_fma_f32 v75,v75,s36,v13
s_waitcnt lgkmcnt(7)
v_mfma_f32_16x16x32_bf16 v[108:111],a[136:139],a[104:107],v[108:111]
s_mov_b32 s29,s24
ds_read_b64_tr_b16 a[132:133],v5 offset:0
v_fma_f32 v80,v80,s36,v14
v_mfma_f32_16x16x32_bf16 v[108:111],a[140:143],a[108:111],v[108:111]
s_add_u32 m0,s22,0
ds_read_b64_tr_b16 a[134:135],v5 offset:6144
buffer_load_dwordx4 v6,s[4:7],s20 offen offset:0 lds
v_mfma_f32_16x16x32_bf16 v[108:111],a[144:147],a[112:115],v[108:111]
buffer_load_dwordx4 v7,s[4:7],s20 offen offset:1024 lds
s_waitcnt lgkmcnt(4)
v_mfma_f32_16x16x32_bf16 v[108:111],a[148:151],a[116:119],v[108:111]
buffer_load_dwordx4 v8,s[4:7],s20 offen offset:2048 lds
v_fma_f32 v81,v81,s36,v14
v_fma_f32 v82,v82,s36,v14
v_fma_f32 v83,v83,s36,v14
v_fma_f32 v88,v88,s36,v15
v_fma_f32 v89,v89,s36,v15
v_exp_f32 v72,v72
v_exp_f32 v73,v73
v_exp_f32 v74,v74
v_exp_f32 v75,v75
v_exp_f32 v80,v80
v_exp_f32 v81,v81
v_exp_f32 v82,v82
v_exp_f32 v83,v83
v_exp_f32 v88,v88
v_exp_f32 v89,v89
v_cvt_pk_bf16_f32 v44,v72,v73
v_cvt_pk_bf16_f32 v45,v74,v75
v_cvt_pk_bf16_f32 v48,v80,v81
v_cvt_pk_bf16_f32 v49,v82,v83
v_cvt_pk_bf16_f32 v52,v88,v89
s_add_u32 s20,s20,12288
v_mfma_f32_16x16x32_bf16 v[160:163],a[120:123],v[20:23],0
s_add_u32 m0,s23,0
ds_read_b64_tr_b16 a[136:137],v2 offset:128
v_fma_f32 v90,v90,s36,v15
v_mfma_f32_16x16x32_bf16 v[164:167],a[124:127],v[20:23],0
ds_read_b64_tr_b16 a[138:139],v2 offset:6272
v_fma_f32 v91,v91,s36,v15
v_mfma_f32_16x16x32_bf16 v[212:215],a[124:127],v[24:27],0
ds_read_b64_tr_b16 a[140:141],v3 offset:128
v_fma_f32 v96,v96,s36,v16
v_mfma_f32_16x16x32_bf16 v[208:211],a[120:123],v[24:27],0
ds_read_b64_tr_b16 a[142:143],v3 offset:6272
v_fma_f32 v97,v97,s36,v16
v_mfma_f32_16x16x32_bf16 v[112:115],a[120:123],v[28:31],0
ds_read_b64_tr_b16 a[144:145],v4 offset:128
v_fma_f32 v98,v98,s36,v16
v_mfma_f32_16x16x32_bf16 v[116:119],a[124:127],v[28:31],0
ds_read_b64_tr_b16 a[146:147],v4 offset:6272
v_fma_f32 v99,v99,s36,v16
v_mfma_f32_16x16x32_bf16 a[164:167],a[124:127],v[32:35],0
ds_read_b64_tr_b16 a[148:149],v5 offset:128
v_fma_f32 v104,v104,s36,v17
v_mfma_f32_16x16x32_bf16 a[160:163],a[120:123],v[32:35],0
ds_read_b64_tr_b16 a[150:151],v5 offset:6272
v_fma_f32 v105,v105,s36,v17
v_mfma_f32_16x16x32_bf16 a[208:211],a[120:123],v[36:39],0
ds_read_b64_tr_b16 a[120:121],v2 offset:256
v_fma_f32 v106,v106,s36,v17
v_mfma_f32_16x16x32_bf16 a[212:215],a[124:127],v[36:39],0
s_waitcnt lgkmcnt(6)
ds_read_b64_tr_b16 a[122:123],v2 offset:6400
v_fma_f32 v107,v107,s36,v17
v_mfma_f32_16x16x32_bf16 a[216:219],a[128:131],v[36:39],0
ds_read_b64_tr_b16 a[124:125],v3 offset:256
v_fma_f32 v76,v76,s36,v13
v_mfma_f32_16x16x32_bf16 a[220:223],a[132:135],v[36:39],0
ds_read_b64_tr_b16 a[126:127],v3 offset:6400
v_fma_f32 v77,v77,s36,v13
v_mfma_f32_16x16x32_bf16 a[172:175],a[132:135],v[32:35],0
v_exp_f32 v90,v90
v_mfma_f32_16x16x32_bf16 a[168:171],a[128:131],v[32:35],0
v_exp_f32 v91,v91
v_mfma_f32_16x16x32_bf16 v[120:123],a[128:131],v[28:31],0
v_cvt_pk_bf16_f32 v53,v90,v91
v_fma_f32 v78,v78,s36,v13
v_mfma_f32_16x16x32_bf16 v[124:127],a[132:135],v[28:31],0
v_exp_f32 v96,v96
v_mfma_f32_16x16x32_bf16 v[220:223],a[132:135],v[24:27],0
v_exp_f32 v97,v97
v_mfma_f32_16x16x32_bf16 v[216:219],a[128:131],v[24:27],0
v_exp_f32 v98,v98
v_mfma_f32_16x16x32_bf16 v[168:171],a[128:131],v[20:23],0
ds_read_b64_tr_b16 a[128:129],v4 offset:256
v_cvt_pk_bf16_f32 v56,v96,v97
v_mfma_f32_16x16x32_bf16 v[172:175],a[132:135],v[20:23],0
ds_read_b64_tr_b16 a[130:131],v4 offset:6400
v_fma_f32 v79,v79,s36,v13
v_mfma_f32_16x16x32_bf16 v[176:179],a[136:139],v[20:23],0
s_waitcnt lgkmcnt(2)
ds_read_b64_tr_b16 a[132:133],v5 offset:256
v_fma_f32 v84,v84,s36,v14
v_mfma_f32_16x16x32_bf16 v[180:183],a[140:143],v[20:23],0
ds_read_b64_tr_b16 a[134:135],v5 offset:6400
v_fma_f32 v85,v85,s36,v14
v_mfma_f32_16x16x32_bf16 v[228:231],a[140:143],v[24:27],0
v_exp_f32 v99,v99
v_mfma_f32_16x16x32_bf16 v[224:227],a[136:139],v[24:27],0
v_cvt_pk_bf16_f32 v57,v98,v99
v_fma_f32 v86,v86,s36,v14
v_mfma_f32_16x16x32_bf16 v[128:131],a[136:139],v[28:31],0
v_exp_f32 v104,v104
v_mfma_f32_16x16x32_bf16 v[132:135],a[140:143],v[28:31],0
v_exp_f32 v105,v105
v_mfma_f32_16x16x32_bf16 a[180:183],a[140:143],v[32:35],0
v_exp_f32 v106,v106
v_mfma_f32_16x16x32_bf16 a[176:179],a[136:139],v[32:35],0
v_exp_f32 v107,v107
v_mfma_f32_16x16x32_bf16 a[224:227],a[136:139],v[36:39],0
v_cvt_pk_bf16_f32 v40,v104,v105
v_cvt_pk_bf16_f32 v41,v106,v107
v_mfma_f32_16x16x32_bf16 a[228:231],a[140:143],v[36:39],0
v_exp_f32 v76,v76
v_mfma_f32_16x16x32_bf16 a[232:235],a[144:147],v[36:39],0
v_exp_f32 v77,v77
v_mfma_f32_16x16x32_bf16 a[236:239],a[148:151],v[36:39],0
v_exp_f32 v78,v78
v_mfma_f32_16x16x32_bf16 a[188:191],a[148:151],v[32:35],0
v_exp_f32 v79,v79
v_mfma_f32_16x16x32_bf16 a[184:187],a[144:147],v[32:35],0
v_cvt_pk_bf16_f32 v46,v76,v77
v_cvt_pk_bf16_f32 v47,v78,v79
v_mfma_f32_16x16x32_bf16 v[136:139],a[144:147],v[28:31],0
v_fma_f32 v87,v87,s36,v14
v_fma_f32 v92,v92,s36,v15
v_mfma_f32_16x16x32_bf16 v[140:143],a[148:151],v[28:31],0
v_exp_f32 v84,v84
v_mfma_f32_16x16x32_bf16 v[236:239],a[148:151],v[24:27],0
v_exp_f32 v85,v85
v_mfma_f32_16x16x32_bf16 v[232:235],a[144:147],v[24:27],0
v_exp_f32 v86,v86
v_mfma_f32_16x16x32_bf16 v[184:187],a[144:147],v[20:23],0
v_exp_f32 v87,v87
v_mfma_f32_16x16x32_bf16 v[188:191],a[148:151],v[20:23],0
v_cvt_pk_bf16_f32 v50,v84,v85
v_cvt_pk_bf16_f32 v51,v86,v87
v_mfma_f32_16x16x32_bf16 v[192:195],a[120:123],v[20:23],0
v_fma_f32 v93,v93,s36,v15
v_fma_f32 v94,v94,s36,v15
v_smfmac_f32_16x16x64_bf16 v[60:63],a[152:155],v[44:51],v18
v_fma_f32 v95,v95,s36,v15
v_mfma_f32_16x16x32_bf16 v[196:199],a[124:127],v[20:23],0
s_waitcnt vmcnt(6) lgkmcnt(0)
v_exp_f32 v92,v92
v_mfma_f32_16x16x32_bf16 v[244:247],a[124:127],v[24:27],0
s_barrier
v_mfma_f32_16x16x32_bf16 v[240:243],a[120:123],v[24:27],0
ds_read_b128 a[136:139],v0 offset:24576
v_fma_f32 v100,v100,s36,v16
v_mfma_f32_16x16x32_bf16 v[144:147],a[120:123],v[28:31],0
ds_read_b128 a[140:143],v1 offset:24576
v_fma_f32 v101,v101,s36,v16
v_mfma_f32_16x16x32_bf16 v[148:151],a[124:127],v[28:31],0
ds_read_b128 a[144:147],v0 offset:24704
v_fma_f32 v102,v102,s36,v16
v_mfma_f32_16x16x32_bf16 a[196:199],a[124:127],v[32:35],0
ds_read_b128 a[148:151],v1 offset:24704
v_fma_f32 v103,v103,s36,v16
v_mfma_f32_16x16x32_bf16 a[192:195],a[120:123],v[32:35],0
v_exp_f32 v93,v93
v_mfma_f32_16x16x32_bf16 a[240:243],a[120:123],v[36:39],0
buffer_load_dwordx4 v6,s[8:11],s21 offen offset:0 lds
v_mfma_f32_16x16x32_bf16 a[244:247],a[124:127],v[36:39],0
ds_read_b128 a[120:123],v0 offset:24832
v_cvt_pk_bf16_f32 v54,v92,v93
v_mfma_f32_16x16x32_bf16 a[248:251],a[128:131],v[36:39],0
ds_read_b128 a[124:127],v1 offset:24832
v_fma_f32 v108,v108,s36,v17
v_mfma_f32_16x16x32_bf16 a[252:255],a[132:135],v[36:39],0
v_exp_f32 v94,v94
v_mfma_f32_16x16x32_bf16 a[204:207],a[132:135],v[32:35],0
v_exp_f32 v95,v95
v_mfma_f32_16x16x32_bf16 a[200:203],a[128:131],v[32:35],0
v_cvt_pk_bf16_f32 v55,v94,v95
v_fma_f32 v109,v109,s36,v17
v_mfma_f32_16x16x32_bf16 v[152:155],a[128:131],v[28:31],0
v_exp_f32 v100,v100
v_mfma_f32_16x16x32_bf16 v[156:159],a[132:135],v[28:31],0
v_exp_f32 v101,v101
v_mfma_f32_16x16x32_bf16 v[252:255],a[132:135],v[24:27],0
v_exp_f32 v102,v102
v_mfma_f32_16x16x32_bf16 v[248:251],a[128:131],v[24:27],0
v_exp_f32 v103,v103
v_mfma_f32_16x16x32_bf16 v[200:203],a[128:131],v[20:23],0
ds_read_b128 a[128:131],v0 offset:30720
v_cvt_pk_bf16_f32 v58,v100,v101
v_mfma_f32_16x16x32_bf16 v[204:207],a[132:135],v[20:23],0
buffer_load_dwordx4 v7,s[8:11],s21 offen offset:1024 lds
s_waitcnt lgkmcnt(1)
v_mfma_f32_16x16x32_bf16 v[72:75],a[136:139],a[0:3],0
ds_read_b128 a[132:135],v1 offset:30720
v_cvt_pk_bf16_f32 v59,v102,v103
v_mfma_f32_16x16x32_bf16 v[72:75],a[140:143],a[4:7],v[72:75]
v_fma_f32 v110,v110,s36,v17
v_fma_f32 v111,v111,s36,v17
v_smfmac_f32_16x16x64_bf16 v[64:67],a[152:155],v[52:59],v18
v_mfma_f32_16x16x32_bf16 v[72:75],a[144:147],a[8:11],v[72:75]
v_exp_f32 v108,v108
v_mfma_f32_16x16x32_bf16 v[72:75],a[148:151],a[12:15],v[72:75]
v_exp_f32 v109,v109
v_mfma_f32_16x16x32_bf16 v[72:75],a[120:123],a[16:19],v[72:75]
v_exp_f32 v110,v110
v_mfma_f32_16x16x32_bf16 v[72:75],a[124:127],a[20:23],v[72:75]
v_exp_f32 v111,v111
v_mfma_f32_16x16x32_bf16 v[80:83],a[124:127],a[44:47],0
v_cvt_pk_bf16_f32 v42,v108,v109
v_cvt_pk_bf16_f32 v43,v110,v111
v_mfma_f32_16x16x32_bf16 v[80:83],a[120:123],a[40:43],v[80:83]
v_mfma_f32_16x16x32_bf16 v[80:83],a[148:151],a[36:39],v[80:83]
v_smfmac_f32_16x16x64_bf16 v[68:71],a[152:155],v[36:43],v18
buffer_load_dwordx4 v8,s[8:11],s21 offen offset:2048 lds
v_mfma_f32_16x16x32_bf16 v[80:83],a[144:147],a[32:35],v[80:83]
s_add_u32 s21,s21,12288
v_fma_f32 v72,v72,s36,v13
v_fma_f32 v73,v73,s36,v13
v_mfma_f32_16x16x32_bf16 v[80:83],a[140:143],a[28:31],v[80:83]
s_add_u32 m0,s22,12288
v_fma_f32 v74,v74,s36,v13
v_fma_f32 v75,v75,s36,v13
v_mfma_f32_16x16x32_bf16 v[80:83],a[136:139],a[24:27],v[80:83]
v_exp_f32 v72,v72
v_mfma_f32_16x16x32_bf16 v[88:91],a[136:139],a[48:51],0
v_exp_f32 v73,v73
v_mfma_f32_16x16x32_bf16 v[88:91],a[140:143],a[52:55],v[88:91]
v_exp_f32 v74,v74
v_mfma_f32_16x16x32_bf16 v[88:91],a[144:147],a[56:59],v[88:91]
v_exp_f32 v75,v75
v_mfma_f32_16x16x32_bf16 v[88:91],a[148:151],a[60:63],v[88:91]
v_fma_f32 v80,v80,s36,v14
v_fma_f32 v81,v81,s36,v14
v_mfma_f32_16x16x32_bf16 v[88:91],a[120:123],a[64:67],v[88:91]
v_fma_f32 v82,v82,s36,v14
v_fma_f32 v83,v83,s36,v14
v_mfma_f32_16x16x32_bf16 v[88:91],a[124:127],a[68:71],v[88:91]
v_exp_f32 v80,v80
v_mfma_f32_16x16x32_bf16 v[96:99],a[124:127],a[92:95],0
v_exp_f32 v81,v81
v_mfma_f32_16x16x32_bf16 v[96:99],a[120:123],a[88:91],v[96:99]
buffer_load_dwordx4 v6,s[4:7],s20 offen offset:0 lds
v_mfma_f32_16x16x32_bf16 v[96:99],a[148:151],a[84:87],v[96:99]
v_exp_f32 v82,v82
v_mfma_f32_16x16x32_bf16 v[96:99],a[144:147],a[80:83],v[96:99]
v_fma_f32 v88,v88,s36,v15
v_fma_f32 v89,v89,s36,v15
v_mfma_f32_16x16x32_bf16 v[96:99],a[140:143],a[76:79],v[96:99]
v_exp_f32 v83,v83
v_mfma_f32_16x16x32_bf16 v[96:99],a[136:139],a[72:75],v[96:99]
v_exp_f32 v88,v88
v_mfma_f32_16x16x32_bf16 v[104:107],a[136:139],a[96:99],0
ds_read_b128 a[136:139],v0 offset:30848
v_cvt_pk_bf16_f32 v20,v72,v73
v_mfma_f32_16x16x32_bf16 v[104:107],a[140:143],a[100:103],v[104:107]
ds_read_b128 a[140:143],v1 offset:30848
v_cvt_pk_bf16_f32 v21,v74,v75
v_mfma_f32_16x16x32_bf16 v[104:107],a[144:147],a[104:107],v[104:107]
ds_read_b128 a[144:147],v0 offset:30976
v_cvt_pk_bf16_f32 v24,v80,v81
v_mfma_f32_16x16x32_bf16 v[104:107],a[148:151],a[108:111],v[104:107]
ds_read_b128 a[148:151],v1 offset:30976
v_cvt_pk_bf16_f32 v25,v82,v83
v_mfma_f32_16x16x32_bf16 v[104:107],a[120:123],a[112:115],v[104:107]
v_exp_f32 v89,v89
v_mfma_f32_16x16x32_bf16 v[104:107],a[124:127],a[116:119],v[104:107]
s_waitcnt lgkmcnt(4)
v_cvt_pk_bf16_f32 v28,v88,v89
v_mfma_f32_16x16x32_bf16 v[76:79],a[128:131],a[0:3],0
v_mfma_f32_16x16x32_bf16 v[76:79],a[132:135],a[4:7],v[76:79]
buffer_load_dwordx4 v7,s[4:7],s20 offen offset:1024 lds
s_waitcnt lgkmcnt(3)
v_mfma_f32_16x16x32_bf16 v[76:79],a[136:139],a[8:11],v[76:79]
s_waitcnt lgkmcnt(2)
v_mfma_f32_16x16x32_bf16 v[76:79],a[140:143],a[12:15],v[76:79]
s_waitcnt lgkmcnt(1)
v_mfma_f32_16x16x32_bf16 v[76:79],a[144:147],a[16:19],v[76:79]
s_waitcnt lgkmcnt(0)
v_mfma_f32_16x16x32_bf16 v[76:79],a[148:151],a[20:23],v[76:79]
v_mfma_f32_16x16x32_bf16 v[84:87],a[148:151],a[44:47],0
v_mfma_f32_16x16x32_bf16 v[84:87],a[144:147],a[40:43],v[84:87]
v_mfma_f32_16x16x32_bf16 v[84:87],a[140:143],a[36:39],v[84:87]
v_mfma_f32_16x16x32_bf16 v[84:87],a[136:139],a[32:35],v[84:87]
v_mfma_f32_16x16x32_bf16 v[84:87],a[132:135],a[28:31],v[84:87]
v_mfma_f32_16x16x32_bf16 v[84:87],a[128:131],a[24:27],v[84:87]
v_mfma_f32_16x16x32_bf16 v[92:95],a[128:131],a[48:51],0
buffer_load_dwordx4 v8,s[4:7],s20 offen offset:2048 lds
v_mfma_f32_16x16x32_bf16 v[92:95],a[132:135],a[52:55],v[92:95]
s_add_u32 s20,s20,12288
v_mfma_f32_16x16x32_bf16 v[92:95],a[136:139],a[56:59],v[92:95]
v_mfma_f32_16x16x32_bf16 v[92:95],a[140:143],a[60:63],v[92:95]
v_mfma_f32_16x16x32_bf16 v[92:95],a[144:147],a[64:67],v[92:95]
v_mfma_f32_16x16x32_bf16 v[92:95],a[148:151],a[68:71],v[92:95]
ds_read_b64_tr_b16 a[120:121],v2 offset:12288
v_mfma_f32_16x16x32_bf16 v[100:103],a[148:151],a[92:95],0
ds_read_b64_tr_b16 a[122:123],v2 offset:18432
v_mfma_f32_16x16x32_bf16 v[100:103],a[144:147],a[88:91],v[100:103]
v_mfma_f32_16x16x32_bf16 v[100:103],a[140:143],a[84:87],v[100:103]
ds_read_b64_tr_b16 a[124:125],v3 offset:12288
v_mfma_f32_16x16x32_bf16 v[100:103],a[136:139],a[80:83],v[100:103]
ds_read_b64_tr_b16 a[126:127],v3 offset:18432
v_mfma_f32_16x16x32_bf16 v[100:103],a[132:135],a[76:79],v[100:103]
v_mfma_f32_16x16x32_bf16 v[100:103],a[128:131],a[72:75],v[100:103]
v_mfma_f32_16x16x32_bf16 v[108:111],a[128:131],a[96:99],0
ds_read_b64_tr_b16 a[128:129],v4 offset:12288
v_mfma_f32_16x16x32_bf16 v[108:111],a[132:135],a[100:103],v[108:111]
ds_read_b64_tr_b16 a[130:131],v4 offset:18432
v_mfma_f32_16x16x32_bf16 v[108:111],a[136:139],a[104:107],v[108:111]
ds_read_b64_tr_b16 a[132:133],v5 offset:12288
v_mfma_f32_16x16x32_bf16 v[108:111],a[140:143],a[108:111],v[108:111]
ds_read_b64_tr_b16 a[134:135],v5 offset:18432
v_mfma_f32_16x16x32_bf16 v[108:111],a[144:147],a[112:115],v[108:111]
v_mfma_f32_16x16x32_bf16 v[108:111],a[148:151],a[116:119],v[108:111]
s_waitcnt lgkmcnt(4)
v_mfma_f32_16x16x32_bf16 v[160:163],a[120:123],v[44:47],v[160:163]
s_add_u32 m0,s23,12288
ds_read_b64_tr_b16 a[136:137],v2 offset:12416
v_fma_f32 v90,v90,s36,v15
v_mfma_f32_16x16x32_bf16 v[164:167],a[124:127],v[44:47],v[164:167]
ds_read_b64_tr_b16 a[138:139],v2 offset:18560
v_fma_f32 v91,v91,s36,v15
v_mfma_f32_16x16x32_bf16 v[212:215],a[124:127],v[48:51],v[212:215]
ds_read_b64_tr_b16 a[140:141],v3 offset:12416
v_fma_f32 v96,v96,s36,v16
v_mfma_f32_16x16x32_bf16 v[208:211],a[120:123],v[48:51],v[208:211]
ds_read_b64_tr_b16 a[142:143],v3 offset:18560
v_fma_f32 v97,v97,s36,v16
v_mfma_f32_16x16x32_bf16 v[112:115],a[120:123],v[52:55],v[112:115]
ds_read_b64_tr_b16 a[144:145],v4 offset:12416
v_fma_f32 v98,v98,s36,v16
v_mfma_f32_16x16x32_bf16 v[116:119],a[124:127],v[52:55],v[116:119]
ds_read_b64_tr_b16 a[146:147],v4 offset:18560
v_fma_f32 v99,v99,s36,v16
v_mfma_f32_16x16x32_bf16 a[164:167],a[124:127],v[56:59],a[164:167]
ds_read_b64_tr_b16 a[148:149],v5 offset:12416
v_fma_f32 v104,v104,s36,v17
v_mfma_f32_16x16x32_bf16 a[160:163],a[120:123],v[56:59],a[160:163]
ds_read_b64_tr_b16 a[150:151],v5 offset:18560
v_fma_f32 v105,v105,s36,v17
v_mfma_f32_16x16x32_bf16 a[208:211],a[120:123],v[40:43],a[208:211]
ds_read_b64_tr_b16 a[120:121],v2 offset:12544
v_fma_f32 v106,v106,s36,v17
v_mfma_f32_16x16x32_bf16 a[212:215],a[124:127],v[40:43],a[212:215]
s_waitcnt lgkmcnt(6)
ds_read_b64_tr_b16 a[122:123],v2 offset:18688
v_fma_f32 v107,v107,s36,v17
v_mfma_f32_16x16x32_bf16 a[216:219],a[128:131],v[40:43],a[216:219]
ds_read_b64_tr_b16 a[124:125],v3 offset:12544
v_fma_f32 v76,v76,s36,v13
v_mfma_f32_16x16x32_bf16 a[220:223],a[132:135],v[40:43],a[220:223]
ds_read_b64_tr_b16 a[126:127],v3 offset:18688
v_fma_f32 v77,v77,s36,v13
v_mfma_f32_16x16x32_bf16 a[172:175],a[132:135],v[56:59],a[172:175]
v_exp_f32 v90,v90
v_mfma_f32_16x16x32_bf16 a[168:171],a[128:131],v[56:59],a[168:171]
v_exp_f32 v91,v91
v_mfma_f32_16x16x32_bf16 v[120:123],a[128:131],v[52:55],v[120:123]
v_cvt_pk_bf16_f32 v29,v90,v91
v_fma_f32 v78,v78,s36,v13
v_mfma_f32_16x16x32_bf16 v[124:127],a[132:135],v[52:55],v[124:127]
v_exp_f32 v96,v96
v_mfma_f32_16x16x32_bf16 v[220:223],a[132:135],v[48:51],v[220:223]
v_exp_f32 v97,v97
v_mfma_f32_16x16x32_bf16 v[216:219],a[128:131],v[48:51],v[216:219]
v_exp_f32 v98,v98
v_mfma_f32_16x16x32_bf16 v[168:171],a[128:131],v[44:47],v[168:171]
ds_read_b64_tr_b16 a[128:129],v4 offset:12544
v_cvt_pk_bf16_f32 v32,v96,v97
v_mfma_f32_16x16x32_bf16 v[172:175],a[132:135],v[44:47],v[172:175]
ds_read_b64_tr_b16 a[130:131],v4 offset:18688
v_fma_f32 v79,v79,s36,v13
v_mfma_f32_16x16x32_bf16 v[176:179],a[136:139],v[44:47],v[176:179]
s_waitcnt lgkmcnt(2)
ds_read_b64_tr_b16 a[132:133],v5 offset:12544
v_fma_f32 v84,v84,s36,v14
v_mfma_f32_16x16x32_bf16 v[180:183],a[140:143],v[44:47],v[180:183]
ds_read_b64_tr_b16 a[134:135],v5 offset:18688
v_fma_f32 v85,v85,s36,v14
v_mfma_f32_16x16x32_bf16 v[228:231],a[140:143],v[48:51],v[228:231]
v_exp_f32 v99,v99
v_mfma_f32_16x16x32_bf16 v[224:227],a[136:139],v[48:51],v[224:227]
v_cvt_pk_bf16_f32 v33,v98,v99
v_fma_f32 v86,v86,s36,v14
v_mfma_f32_16x16x32_bf16 v[128:131],a[136:139],v[52:55],v[128:131]
v_exp_f32 v104,v104
v_mfma_f32_16x16x32_bf16 v[132:135],a[140:143],v[52:55],v[132:135]
v_exp_f32 v105,v105
v_mfma_f32_16x16x32_bf16 a[180:183],a[140:143],v[56:59],a[180:183]
v_exp_f32 v106,v106
v_mfma_f32_16x16x32_bf16 a[176:179],a[136:139],v[56:59],a[176:179]
v_exp_f32 v107,v107
v_mfma_f32_16x16x32_bf16 a[224:227],a[136:139],v[40:43],a[224:227]
v_cvt_pk_bf16_f32 v36,v104,v105
v_cvt_pk_bf16_f32 v37,v106,v107
v_mfma_f32_16x16x32_bf16 a[228:231],a[140:143],v[40:43],a[228:231]
v_exp_f32 v76,v76
v_mfma_f32_16x16x32_bf16 a[232:235],a[144:147],v[40:43],a[232:235]
v_exp_f32 v77,v77
v_mfma_f32_16x16x32_bf16 a[236:239],a[148:151],v[40:43],a[236:239]
v_exp_f32 v78,v78
v_mfma_f32_16x16x32_bf16 a[188:191],a[148:151],v[56:59],a[188:191]
v_exp_f32 v79,v79
v_mfma_f32_16x16x32_bf16 a[184:187],a[144:147],v[56:59],a[184:187]
v_cvt_pk_bf16_f32 v22,v76,v77
v_cvt_pk_bf16_f32 v23,v78,v79
v_mfma_f32_16x16x32_bf16 v[136:139],a[144:147],v[52:55],v[136:139]
v_fma_f32 v87,v87,s36,v14
v_fma_f32 v92,v92,s36,v15
v_mfma_f32_16x16x32_bf16 v[140:143],a[148:151],v[52:55],v[140:143]
v_exp_f32 v84,v84
v_mfma_f32_16x16x32_bf16 v[236:239],a[148:151],v[48:51],v[236:239]
v_exp_f32 v85,v85
v_mfma_f32_16x16x32_bf16 v[232:235],a[144:147],v[48:51],v[232:235]
v_exp_f32 v86,v86
v_mfma_f32_16x16x32_bf16 v[184:187],a[144:147],v[44:47],v[184:187]
v_exp_f32 v87,v87
v_mfma_f32_16x16x32_bf16 v[188:191],a[148:151],v[44:47],v[188:191]
v_cvt_pk_bf16_f32 v26,v84,v85
v_cvt_pk_bf16_f32 v27,v86,v87
v_mfma_f32_16x16x32_bf16 v[192:195],a[120:123],v[44:47],v[192:195]
v_fma_f32 v93,v93,s36,v15
v_fma_f32 v94,v94,s36,v15
v_smfmac_f32_16x16x64_bf16 v[60:63],a[152:155],v[20:27],v18
v_fma_f32 v95,v95,s36,v15
v_mfma_f32_16x16x32_bf16 v[196:199],a[124:127],v[44:47],v[196:199]
s_waitcnt vmcnt(6) lgkmcnt(0)
v_exp_f32 v92,v92
v_mfma_f32_16x16x32_bf16 v[244:247],a[124:127],v[48:51],v[244:247]
s_barrier
v_mfma_f32_16x16x32_bf16 v[240:243],a[120:123],v[48:51],v[240:243]
ds_read_b128 a[136:139],v0 offset:0
v_fma_f32 v100,v100,s36,v16
v_mfma_f32_16x16x32_bf16 v[144:147],a[120:123],v[52:55],v[144:147]
ds_read_b128 a[140:143],v1 offset:0
v_fma_f32 v101,v101,s36,v16
v_mfma_f32_16x16x32_bf16 v[148:151],a[124:127],v[52:55],v[148:151]
ds_read_b128 a[144:147],v0 offset:128
v_fma_f32 v102,v102,s36,v16
v_mfma_f32_16x16x32_bf16 a[196:199],a[124:127],v[56:59],a[196:199]
ds_read_b128 a[148:151],v1 offset:128
v_fma_f32 v103,v103,s36,v16
v_mfma_f32_16x16x32_bf16 a[192:195],a[120:123],v[56:59],a[192:195]
v_exp_f32 v93,v93
v_mfma_f32_16x16x32_bf16 a[240:243],a[120:123],v[40:43],a[240:243]
buffer_load_dwordx4 v6,s[8:11],s21 offen offset:0 lds
v_mfma_f32_16x16x32_bf16 a[244:247],a[124:127],v[40:43],a[244:247]
ds_read_b128 a[120:123],v0 offset:256
v_cvt_pk_bf16_f32 v30,v92,v93
v_mfma_f32_16x16x32_bf16 a[248:251],a[128:131],v[40:43],a[248:251]
ds_read_b128 a[124:127],v1 offset:256
v_fma_f32 v108,v108,s36,v17
v_mfma_f32_16x16x32_bf16 a[252:255],a[132:135],v[40:43],a[252:255]
v_exp_f32 v94,v94
v_mfma_f32_16x16x32_bf16 a[204:207],a[132:135],v[56:59],a[204:207]
v_exp_f32 v95,v95
v_mfma_f32_16x16x32_bf16 a[200:203],a[128:131],v[56:59],a[200:203]
v_cvt_pk_bf16_f32 v31,v94,v95
v_fma_f32 v109,v109,s36,v17
v_mfma_f32_16x16x32_bf16 v[152:155],a[128:131],v[52:55],v[152:155]
v_exp_f32 v100,v100
v_mfma_f32_16x16x32_bf16 v[156:159],a[132:135],v[52:55],v[156:159]
v_exp_f32 v101,v101
v_mfma_f32_16x16x32_bf16 v[252:255],a[132:135],v[48:51],v[252:255]
v_exp_f32 v102,v102
v_mfma_f32_16x16x32_bf16 v[248:251],a[128:131],v[48:51],v[248:251]
v_exp_f32 v103,v103
v_mfma_f32_16x16x32_bf16 v[200:203],a[128:131],v[44:47],v[200:203]
ds_read_b128 a[128:131],v0 offset:6144
v_cvt_pk_bf16_f32 v34,v100,v101
v_mfma_f32_16x16x32_bf16 v[204:207],a[132:135],v[44:47],v[204:207]
buffer_load_dwordx4 v7,s[8:11],s21 offen offset:1024 lds
s_waitcnt lgkmcnt(1)
v_mfma_f32_16x16x32_bf16 v[72:75],a[136:139],a[0:3],0
ds_read_b128 a[132:135],v1 offset:6144
v_cvt_pk_bf16_f32 v35,v102,v103
v_mfma_f32_16x16x32_bf16 v[72:75],a[140:143],a[4:7],v[72:75]
v_fma_f32 v110,v110,s36,v17
v_fma_f32 v111,v111,s36,v17
v_smfmac_f32_16x16x64_bf16 v[64:67],a[152:155],v[28:35],v18
v_mfma_f32_16x16x32_bf16 v[72:75],a[144:147],a[8:11],v[72:75]
v_exp_f32 v108,v108
v_mfma_f32_16x16x32_bf16 v[72:75],a[148:151],a[12:15],v[72:75]
v_exp_f32 v109,v109
v_mfma_f32_16x16x32_bf16 v[72:75],a[120:123],a[16:19],v[72:75]
v_exp_f32 v110,v110
v_mfma_f32_16x16x32_bf16 v[72:75],a[124:127],a[20:23],v[72:75]
v_exp_f32 v111,v111
v_mfma_f32_16x16x32_bf16 v[80:83],a[124:127],a[44:47],0
v_cvt_pk_bf16_f32 v38,v108,v109
v_cvt_pk_bf16_f32 v39,v110,v111
v_mfma_f32_16x16x32_bf16 v[80:83],a[120:123],a[40:43],v[80:83]
v_mfma_f32_16x16x32_bf16 v[80:83],a[148:151],a[36:39],v[80:83]
v_mfma_f32_16x16x32_bf16 v[80:83],a[144:147],a[32:35],v[80:83]
buffer_load_dwordx4 v8,s[8:11],s21 offen offset:2048 lds
v_mfma_f32_16x16x32_bf16 v[80:83],a[140:143],a[28:31],v[80:83]
s_add_u32 s21,s21,12288
v_fma_f32 v72,v72,s36,v13
v_fma_f32 v73,v73,s36,v13
v_mfma_f32_16x16x32_bf16 v[80:83],a[136:139],a[24:27],v[80:83]
s_add_u32 m0,s22,24576
v_fma_f32 v74,v74,s36,v13
v_fma_f32 v75,v75,s36,v13
v_mfma_f32_16x16x32_bf16 v[88:91],a[136:139],a[48:51],0
v_exp_f32 v72,v72
v_mfma_f32_16x16x32_bf16 v[88:91],a[140:143],a[52:55],v[88:91]
v_exp_f32 v73,v73
v_mfma_f32_16x16x32_bf16 v[88:91],a[144:147],a[56:59],v[88:91]
v_fma_f32 v80,v80,s36,v14
v_fma_f32 v81,v81,s36,v14
v_mfma_f32_16x16x32_bf16 v[88:91],a[148:151],a[60:63],v[88:91]
v_fma_f32 v82,v82,s36,v14
v_fma_f32 v83,v83,s36,v14
v_mfma_f32_16x16x32_bf16 v[88:91],a[120:123],a[64:67],v[88:91]
v_exp_f32 v74,v74
v_mfma_f32_16x16x32_bf16 v[88:91],a[124:127],a[68:71],v[88:91]
v_exp_f32 v75,v75
v_mfma_f32_16x16x32_bf16 v[96:99],a[124:127],a[92:95],0
v_exp_f32 v80,v80
v_mfma_f32_16x16x32_bf16 v[96:99],a[120:123],a[88:91],v[96:99]
v_exp_f32 v81,v81
v_mfma_f32_16x16x32_bf16 v[96:99],a[148:151],a[84:87],v[96:99]
v_exp_f32 v82,v82
v_mfma_f32_16x16x32_bf16 v[96:99],a[144:147],a[80:83],v[96:99]
buffer_load_dwordx4 v6,s[4:7],s20 offen offset:0 lds
v_mfma_f32_16x16x32_bf16 v[96:99],a[140:143],a[76:79],v[96:99]
v_fma_f32 v88,v88,s36,v15
v_fma_f32 v89,v89,s36,v15
v_mfma_f32_16x16x32_bf16 v[96:99],a[136:139],a[72:75],v[96:99]
v_exp_f32 v83,v83
v_mfma_f32_16x16x32_bf16 v[104:107],a[136:139],a[96:99],0
ds_read_b128 a[136:139],v0 offset:6272
v_cvt_pk_bf16_f32 v44,v72,v73
v_mfma_f32_16x16x32_bf16 v[104:107],a[140:143],a[100:103],v[104:107]
ds_read_b128 a[140:143],v1 offset:6272
v_cvt_pk_bf16_f32 v45,v74,v75
v_mfma_f32_16x16x32_bf16 v[104:107],a[144:147],a[104:107],v[104:107]
ds_read_b128 a[144:147],v0 offset:6400
v_cvt_pk_bf16_f32 v48,v80,v81
v_mfma_f32_16x16x32_bf16 v[104:107],a[148:151],a[108:111],v[104:107]
ds_read_b128 a[148:151],v1 offset:6400
v_cvt_pk_bf16_f32 v49,v82,v83
v_mfma_f32_16x16x32_bf16 v[104:107],a[120:123],a[112:115],v[104:107]
v_exp_f32 v88,v88
v_mfma_f32_16x16x32_bf16 v[104:107],a[124:127],a[116:119],v[104:107]
s_waitcnt lgkmcnt(4)
v_exp_f32 v89,v89
v_mfma_f32_16x16x32_bf16 v[76:79],a[128:131],a[0:3],0
v_cvt_pk_bf16_f32 v52,v88,v89
v_mfma_f32_16x16x32_bf16 v[76:79],a[132:135],a[4:7],v[76:79]
s_waitcnt lgkmcnt(3)
v_mfma_f32_16x16x32_bf16 v[76:79],a[136:139],a[8:11],v[76:79]
buffer_load_dwordx4 v7,s[4:7],s20 offen offset:1024 lds
s_waitcnt lgkmcnt(2)
v_mfma_f32_16x16x32_bf16 v[76:79],a[140:143],a[12:15],v[76:79]
s_waitcnt lgkmcnt(1)
v_mfma_f32_16x16x32_bf16 v[76:79],a[144:147],a[16:19],v[76:79]
s_waitcnt lgkmcnt(0)
v_mfma_f32_16x16x32_bf16 v[76:79],a[148:151],a[20:23],v[76:79]
v_mfma_f32_16x16x32_bf16 v[84:87],a[148:151],a[44:47],0
v_mfma_f32_16x16x32_bf16 v[84:87],a[144:147],a[40:43],v[84:87]
v_mfma_f32_16x16x32_bf16 v[84:87],a[140:143],a[36:39],v[84:87]
v_mfma_f32_16x16x32_bf16 v[84:87],a[136:139],a[32:35],v[84:87]
v_mfma_f32_16x16x32_bf16 v[84:87],a[132:135],a[28:31],v[84:87]
v_mfma_f32_16x16x32_bf16 v[84:87],a[128:131],a[24:27],v[84:87]
v_mfma_f32_16x16x32_bf16 v[92:95],a[128:131],a[48:51],0
v_mfma_f32_16x16x32_bf16 v[92:95],a[132:135],a[52:55],v[92:95]
buffer_load_dwordx4 v8,s[4:7],s20 offen offset:2048 lds
v_mfma_f32_16x16x32_bf16 v[92:95],a[136:139],a[56:59],v[92:95]
s_add_u32 s20,s20,12288
v_mfma_f32_16x16x32_bf16 v[92:95],a[140:143],a[60:63],v[92:95]
v_mfma_f32_16x16x32_bf16 v[92:95],a[144:147],a[64:67],v[92:95]
v_mfma_f32_16x16x32_bf16 v[92:95],a[148:151],a[68:71],v[92:95]
v_mfma_f32_16x16x32_bf16 v[100:103],a[148:151],a[92:95],0
v_mfma_f32_16x16x32_bf16 v[100:103],a[144:147],a[88:91],v[100:103]
ds_read_b64_tr_b16 a[120:121],v2 offset:24576
v_mfma_f32_16x16x32_bf16 v[100:103],a[140:143],a[84:87],v[100:103]
ds_read_b64_tr_b16 a[122:123],v2 offset:30720
v_mfma_f32_16x16x32_bf16 v[100:103],a[136:139],a[80:83],v[100:103]
ds_read_b64_tr_b16 a[124:125],v3 offset:24576
v_mfma_f32_16x16x32_bf16 v[100:103],a[132:135],a[76:79],v[100:103]
ds_read_b64_tr_b16 a[126:127],v3 offset:30720
v_mfma_f32_16x16x32_bf16 v[100:103],a[128:131],a[72:75],v[100:103]
v_mfma_f32_16x16x32_bf16 v[108:111],a[128:131],a[96:99],0
ds_read_b64_tr_b16 a[128:129],v4 offset:24576
v_mfma_f32_16x16x32_bf16 v[108:111],a[132:135],a[100:103],v[108:111]
ds_read_b64_tr_b16 a[130:131],v4 offset:30720
v_mfma_f32_16x16x32_bf16 v[108:111],a[136:139],a[104:107],v[108:111]
ds_read_b64_tr_b16 a[132:133],v5 offset:24576
v_mfma_f32_16x16x32_bf16 v[108:111],a[140:143],a[108:111],v[108:111]
ds_read_b64_tr_b16 a[134:135],v5 offset:30720
v_mfma_f32_16x16x32_bf16 v[108:111],a[144:147],a[112:115],v[108:111]
v_mfma_f32_16x16x32_bf16 v[108:111],a[148:151],a[116:119],v[108:111]
s_mov_b32 s38,0
s_branch L_loop5
L_start4:
s_add_u32 m0,s24,12288
s_waitcnt vmcnt(9)
ds_read_b128 a[0:3],v11 offset:0
buffer_load_dwordx4 v6,s[12:15],s28 offen offset:0 nt lds
ds_read_b128 a[4:7],v12 offset:0
buffer_load_dwordx4 v7,s[12:15],s28 offen offset:1024 nt lds
ds_read_b128 a[8:11],v11 offset:128
buffer_load_dwordx4 v8,s[12:15],s28 offen offset:2048 nt lds
s_add_u32 s28,s28,3072
s_add_u32 m0,s24,15360
ds_read_b128 a[12:15],v12 offset:128
buffer_load_dwordx4 v6,s[12:15],s28 offen offset:0 nt lds
ds_read_b128 a[16:19],v11 offset:256
buffer_load_dwordx4 v7,s[12:15],s28 offen offset:1024 nt lds
ds_read_b128 a[20:23],v12 offset:256
buffer_load_dwordx4 v8,s[12:15],s28 offen offset:2048 nt lds
s_add_u32 s28,s28,3072
s_add_u32 m0,s24,0
ds_read_b128 a[120:123],v0 offset:0
v_mov_b32 v60,0
ds_read_b128 a[124:127],v1 offset:0
v_mov_b32 v61,0
ds_read_b128 a[128:131],v0 offset:128
v_mov_b32 v62,0
ds_read_b128 a[132:135],v1 offset:128
v_mov_b32 v63,0
ds_read_b128 a[136:139],v0 offset:256
v_mov_b32 v64,0
ds_read_b128 a[140:143],v1 offset:256
v_mov_b32 v65,0
ds_read_b128 a[144:147],v0 offset:6144
v_mov_b32 v66,0
ds_read_b128 a[148:151],v1 offset:6144
v_mov_b32 v67,0
s_waitcnt lgkmcnt(7)
v_mfma_f32_16x16x32_bf16 v[72:75],a[120:123],a[0:3],0
s_waitcnt lgkmcnt(6)
ds_read_b128 a[120:123],v0 offset:6272
v_mfma_f32_16x16x32_bf16 v[72:75],a[124:127],a[4:7],v[72:75]
s_waitcnt lgkmcnt(6)
ds_read_b128 a[124:127],v1 offset:6272
v_mfma_f32_16x16x32_bf16 v[72:75],a[128:131],a[8:11],v[72:75]
s_waitcnt lgkmcnt(6)
ds_read_b128 a[128:131],v0 offset:6400
v_mfma_f32_16x16x32_bf16 v[72:75],a[132:135],a[12:15],v[72:75]
s_waitcnt lgkmcnt(6)
ds_read_b128 a[132:135],v1 offset:6400
v_mfma_f32_16x16x32_bf16 v[72:75],a[136:139],a[16:19],v[72:75]
s_waitcnt lgkmcnt(6)
ds_read_b128 a[136:139],v0 offset:0
v_mfma_f32_16x16x32_bf16 v[72:75],a[140:143],a[20:23],v[72:75]
s_waitcnt lgkmcnt(6)
ds_read_b128 a[140:143],v1 offset:0
v_mfma_f32_16x16x32_bf16 v[76:79],a[144:147],a[0:3],0
s_waitcnt lgkmcnt(6)
ds_read_b128 a[144:147],v0 offset:128
v_mfma_f32_16x16x32_bf16 v[76:79],a[148:151],a[4:7],v[76:79]
s_waitcnt lgkmcnt(6)
ds_read_b128 a[148:151],v1 offset:128
v_mfma_f32_16x16x32_bf16 v[76:79],a[120:123],a[8:11],v[76:79]
s_waitcnt lgkmcnt(6)
ds_read_b128 a[120:123],v0 offset:256
v_mfma_f32_16x16x32_bf16 v[76:79],a[124:127],a[12:15],v[76:79]
s_waitcnt lgkmcnt(6)
ds_read_b128 a[124:127],v1 offset:256
v_max3_f32 v44,v72,v73,v74
v_mfma_f32_16x16x32_bf16 v[76:79],a[128:131],a[16:19],v[76:79]
s_waitcnt lgkmcnt(6)
ds_read_b128 a[128:131],v0 offset:6144
v_mfma_f32_16x16x32_bf16 v[76:79],a[132:135],a[20:23],v[76:79]
s_waitcnt vmcnt(6)
ds_read_b128 a[24:27],v11 offset:6144
buffer_load_dwordx4 v6,s[12:15],s28 offen offset:0 nt lds
ds_read_b128 a[28:31],v12 offset:6144
buffer_load_dwordx4 v7,s[12:15],s28 offen offset:1024 nt lds
ds_read_b128 a[32:35],v11 offset:6272
buffer_load_dwordx4 v8,s[12:15],s28 offen offset:2048 nt lds
s_add_u32 s28,s28,3072
s_add_u32 m0,s24,3072
ds_read_b128 a[36:39],v12 offset:6272
buffer_load_dwordx4 v6,s[12:15],s28 offen offset:0 nt lds
ds_read_b128 a[40:43],v11 offset:6400
buffer_load_dwordx4 v7,s[12:15],s28 offen offset:1024 nt lds
ds_read_b128 a[44:47],v12 offset:6400
buffer_load_dwordx4 v8,s[12:15],s28 offen offset:2048 nt lds
s_add_u32 s28,s28,3072
s_add_u32 m0,s23,0
ds_read_b128 a[132:135],v1 offset:6144
v_max3_f32 v44,v44,v75,v76
s_waitcnt lgkmcnt(6)
v_mfma_f32_16x16x32_bf16 v[80:83],a[136:139],a[24:27],0
s_waitcnt lgkmcnt(5)
ds_read_b128 a[136:139],v0 offset:6272
v_max3_f32 v44,v44,v77,v78
v_mfma_f32_16x16x32_bf16 v[80:83],a[140:143],a[28:31],v[80:83]
s_waitcnt lgkmcnt(5)
ds_read_b128 a[140:143],v1 offset:6272
v_max_f32 v44,v44,v79
v_mfma_f32_16x16x32_bf16 v[80:83],a[144:147],a[32:35],v[80:83]
s_waitcnt lgkmcnt(5)
ds_read_b128 a[144:147],v0 offset:6400
v_mov_b32 v45,v44
v_mfma_f32_16x16x32_bf16 v[80:83],a[148:151],a[36:39],v[80:83]
s_waitcnt lgkmcnt(5)
ds_read_b128 a[148:151],v1 offset:6400
v_permlane32_swap_b32 v45,v44
v_mfma_f32_16x16x32_bf16 v[80:83],a[120:123],a[40:43],v[80:83]
s_waitcnt lgkmcnt(5)
ds_read_b128 a[120:123],v0 offset:12288
v_max_f32 v44,v44,v45
v_mfma_f32_16x16x32_bf16 v[80:83],a[124:127],a[44:47],v[80:83]
ds_read_b128 a[124:127],v1 offset:12288
v_mov_b32 v45,v44
v_mfma_f32_16x16x32_bf16 v[84:87],a[128:131],a[24:27],0
s_waitcnt lgkmcnt(5)
ds_read_b128 a[128:131],v0 offset:12416
v_permlane16_swap_b32 v45,v44
v_mfma_f32_16x16x32_bf16 v[84:87],a[132:135],a[28:31],v[84:87]
ds_read_b128 a[132:135],v1 offset:12416
v_max_f32 v44,v44,v45
v_mfma_f32_16x16x32_bf16 v[84:87],a[136:139],a[32:35],v[84:87]
s_waitcnt lgkmcnt(5)
ds_read_b128 a[136:139],v0 offset:12544
v_mul_f32_e64 v13,-s36,v44
v_mfma_f32_16x16x32_bf16 v[84:87],a[140:143],a[36:39],v[84:87]
ds_read_b128 a[140:143],v1 offset:12544
v_fma_f32 v72,v72,s36,v13
v_mfma_f32_16x16x32_bf16 v[84:87],a[144:147],a[40:43],v[84:87]
s_waitcnt lgkmcnt(5)
ds_read_b128 a[144:147],v0 offset:18432
v_fma_f32 v73,v73,s36,v13
v_mfma_f32_16x16x32_bf16 v[84:87],a[148:151],a[44:47],v[84:87]
ds_read_b128 a[148:151],v1 offset:18432
v_fma_f32 v74,v74,s36,v13
v_fma_f32 v75,v75,s36,v13
v_exp_f32 v72,v72
v_exp_f32 v73,v73
v_exp_f32 v74,v74
v_exp_f32 v75,v75
v_cvt_pk_bf16_f32 v20,v72,v73
v_cvt_pk_bf16_f32 v21,v74,v75
v_mfma_f32_16x16x32_bf16 v[72:75],a[120:123],a[0:3],0
s_waitcnt lgkmcnt(3)
ds_read_b128 a[120:123],v0 offset:18560
v_fma_f32 v76,v76,s36,v13
v_mfma_f32_16x16x32_bf16 v[72:75],a[124:127],a[4:7],v[72:75]
ds_read_b128 a[124:127],v1 offset:18560
v_fma_f32 v77,v77,s36,v13
v_mfma_f32_16x16x32_bf16 v[72:75],a[128:131],a[8:11],v[72:75]
ds_read_b128 a[128:131],v0 offset:18688
v_fma_f32 v78,v78,s36,v13
v_mfma_f32_16x16x32_bf16 v[72:75],a[132:135],a[12:15],v[72:75]
ds_read_b128 a[132:135],v1 offset:18688
v_fma_f32 v79,v79,s36,v13
v_mfma_f32_16x16x32_bf16 v[72:75],a[136:139],a[16:19],v[72:75]
s_waitcnt lgkmcnt(4)
ds_read_b128 a[136:139],v0 offset:0
v_exp_f32 v76,v76
v_mfma_f32_16x16x32_bf16 v[72:75],a[140:143],a[20:23],v[72:75]
ds_read_b128 a[140:143],v1 offset:0
v_exp_f32 v77,v77
v_exp_f32 v78,v78
v_exp_f32 v79,v79
v_cvt_pk_bf16_f32 v22,v76,v77
v_cvt_pk_bf16_f32 v23,v78,v79
v_mfma_f32_16x16x32_bf16 v[76:79],a[144:147],a[0:3],0
ds_read_b128 a[144:147],v0 offset:128
v_max3_f32 v48,v80,v81,v82
v_mfma_f32_16x16x32_bf16 v[76:79],a[148:151],a[4:7],v[76:79]
s_waitcnt lgkmcnt(4)
ds_read_b128 a[148:151],v1 offset:128
v_max3_f32 v48,v48,v83,v84
v_mfma_f32_16x16x32_bf16 v[76:79],a[120:123],a[8:11],v[76:79]
ds_read_b128 a[120:123],v0 offset:256
v_max3_f32 v48,v48,v85,v86
v_mfma_f32_16x16x32_bf16 v[76:79],a[124:127],a[12:15],v[76:79]
ds_read_b128 a[124:127],v1 offset:256
v_max_f32 v48,v48,v87
v_mfma_f32_16x16x32_bf16 v[76:79],a[128:131],a[16:19],v[76:79]
s_waitcnt lgkmcnt(4)
ds_read_b128 a[128:131],v0 offset:6144
v_mov_b32 v49,v48
v_mfma_f32_16x16x32_bf16 v[76:79],a[132:135],a[20:23],v[76:79]
s_waitcnt vmcnt(6)
ds_read_b128 a[48:51],v11 offset:12288
buffer_load_dwordx4 v6,s[8:11],s21 offen offset:0 lds
ds_read_b128 a[52:55],v12 offset:12288
buffer_load_dwordx4 v7,s[8:11],s21 offen offset:1024 lds
ds_read_b128 a[56:59],v11 offset:12416
buffer_load_dwordx4 v8,s[8:11],s21 offen offset:2048 lds
s_add_u32 s21,s21,12288
s_add_u32 m0,s22,24576
ds_read_b128 a[60:63],v12 offset:12416
buffer_load_dwordx4 v6,s[4:7],s20 offen offset:0 lds
ds_read_b128 a[64:67],v11 offset:12544
buffer_load_dwordx4 v7,s[4:7],s20 offen offset:1024 lds
ds_read_b128 a[68:71],v12 offset:12544
buffer_load_dwordx4 v8,s[4:7],s20 offen offset:2048 lds
s_add_u32 s20,s20,12288
s_add_u32 m0,s23,12288
ds_read_b128 a[132:135],v1 offset:6144
v_permlane32_swap_b32 v49,v48
s_waitcnt lgkmcnt(6)
v_mfma_f32_16x16x32_bf16 v[88:91],a[136:139],a[48:51],0
s_waitcnt lgkmcnt(5)
ds_read_b128 a[136:139],v0 offset:6272
v_max_f32 v48,v48,v49
v_mfma_f32_16x16x32_bf16 v[88:91],a[140:143],a[52:55],v[88:91]
s_waitcnt lgkmcnt(5)
ds_read_b128 a[140:143],v1 offset:6272
v_mov_b32 v49,v48
v_mfma_f32_16x16x32_bf16 v[88:91],a[144:147],a[56:59],v[88:91]
s_waitcnt lgkmcnt(5)
ds_read_b128 a[144:147],v0 offset:6400
v_permlane16_swap_b32 v49,v48
v_mfma_f32_16x16x32_bf16 v[88:91],a[148:151],a[60:63],v[88:91]
s_waitcnt lgkmcnt(4)
ds_read_b128 a[148:151],v1 offset:6400
v_max_f32 v48,v48,v49
v_mfma_f32_16x16x32_bf16 v[88:91],a[120:123],a[64:67],v[88:91]
ds_read_b128 a[120:123],v0 offset:12288
v_mul_f32_e64 v14,-s36,v48
v_mfma_f32_16x16x32_bf16 v[88:91],a[124:127],a[68:71],v[88:91]
ds_read_b128 a[124:127],v1 offset:12288
v_fma_f32 v80,v80,s36,v14
v_mfma_f32_16x16x32_bf16 v[92:95],a[128:131],a[48:51],0
s_waitcnt lgkmcnt(5)
ds_read_b128 a[128:131],v0 offset:12416
v_fma_f32 v81,v81,s36,v14
v_mfma_f32_16x16x32_bf16 v[92:95],a[132:135],a[52:55],v[92:95]
ds_read_b128 a[132:135],v1 offset:12416
v_fma_f32 v82,v82,s36,v14
v_mfma_f32_16x16x32_bf16 v[92:95],a[136:139],a[56:59],v[92:95]
s_waitcnt lgkmcnt(5)
ds_read_b128 a[136:139],v0 offset:12544
v_fma_f32 v83,v83,s36,v14
v_mfma_f32_16x16x32_bf16 v[92:95],a[140:143],a[60:63],v[92:95]
ds_read_b128 a[140:143],v1 offset:12544
v_exp_f32 v80,v80
v_mfma_f32_16x16x32_bf16 v[92:95],a[144:147],a[64:67],v[92:95]
s_waitcnt lgkmcnt(5)
ds_read_b128 a[144:147],v0 offset:18432
v_exp_f32 v81,v81
v_mfma_f32_16x16x32_bf16 v[92:95],a[148:151],a[68:71],v[92:95]
ds_read_b128 a[148:151],v1 offset:18432
v_exp_f32 v82,v82
v_exp_f32 v83,v83
v_cvt_pk_bf16_f32 v24,v80,v81
v_cvt_pk_bf16_f32 v25,v82,v83
v_mfma_f32_16x16x32_bf16 v[80:83],a[120:123],a[24:27],0
s_waitcnt lgkmcnt(4)
ds_read_b128 a[120:123],v0 offset:18560
v_fma_f32 v84,v84,s36,v14
v_mfma_f32_16x16x32_bf16 v[80:83],a[124:127],a[28:31],v[80:83]
ds_read_b128 a[124:127],v1 offset:18560
v_fma_f32 v85,v85,s36,v14
v_mfma_f32_16x16x32_bf16 v[80:83],a[128:131],a[32:35],v[80:83]
ds_read_b128 a[128:131],v0 offset:18688
v_fma_f32 v86,v86,s36,v14
v_mfma_f32_16x16x32_bf16 v[80:83],a[132:135],a[36:39],v[80:83]
s_waitcnt lgkmcnt(4)
ds_read_b128 a[132:135],v1 offset:18688
v_fma_f32 v87,v87,s36,v14
v_mfma_f32_16x16x32_bf16 v[80:83],a[136:139],a[40:43],v[80:83]
ds_read_b128 a[136:139],v0 offset:0
v_exp_f32 v84,v84
v_mfma_f32_16x16x32_bf16 v[80:83],a[140:143],a[44:47],v[80:83]
ds_read_b128 a[140:143],v1 offset:0
v_exp_f32 v85,v85
v_exp_f32 v86,v86
v_exp_f32 v87,v87
v_cvt_pk_bf16_f32 v26,v84,v85
v_cvt_pk_bf16_f32 v27,v86,v87
v_mfma_f32_16x16x32_bf16 v[84:87],a[144:147],a[24:27],0
ds_read_b128 a[144:147],v0 offset:128
v_max3_f32 v52,v88,v89,v90
v_smfmac_f32_16x16x64_bf16 v[60:63],a[152:155],v[20:27],v18
s_waitcnt lgkmcnt(4)
v_max3_f32 v52,v52,v91,v92
v_mfma_f32_16x16x32_bf16 v[84:87],a[148:151],a[28:31],v[84:87]
ds_read_b128 a[148:151],v1 offset:128
v_max3_f32 v52,v52,v93,v94
v_mfma_f32_16x16x32_bf16 v[84:87],a[120:123],a[32:35],v[84:87]
ds_read_b128 a[120:123],v0 offset:256
v_max_f32 v52,v52,v95
v_mfma_f32_16x16x32_bf16 v[84:87],a[124:127],a[36:39],v[84:87]
ds_read_b128 a[124:127],v1 offset:256
v_mov_b32 v53,v52
v_mfma_f32_16x16x32_bf16 v[84:87],a[128:131],a[40:43],v[84:87]
s_waitcnt lgkmcnt(4)
ds_read_b128 a[128:131],v0 offset:6144
v_permlane32_swap_b32 v53,v52
v_mfma_f32_16x16x32_bf16 v[84:87],a[132:135],a[44:47],v[84:87]
s_waitcnt vmcnt(6)
ds_read_b128 a[72:75],v11 offset:0
buffer_load_dwordx4 v6,s[8:11],s21 offen offset:0 lds
ds_read_b128 a[76:79],v12 offset:0
buffer_load_dwordx4 v7,s[8:11],s21 offen offset:1024 lds
ds_read_b128 a[80:83],v11 offset:128
buffer_load_dwordx4 v8,s[8:11],s21 offen offset:2048 lds
s_add_u32 s21,s21,12288
s_add_u32 m0,s23,24576
ds_read_b128 a[84:87],v12 offset:128
buffer_load_dwordx4 v6,s[8:11],s21 offen offset:0 lds
ds_read_b128 a[88:91],v11 offset:256
buffer_load_dwordx4 v7,s[8:11],s21 offen offset:1024 lds
ds_read_b128 a[92:95],v12 offset:256
buffer_load_dwordx4 v8,s[8:11],s21 offen offset:2048 lds
s_add_u32 s21,s21,12288
ds_read_b128 a[132:135],v1 offset:6144
v_max_f32 v52,v52,v53
v_mov_b32 v53,v52
s_waitcnt lgkmcnt(6)
v_mfma_f32_16x16x32_bf16 v[96:99],a[136:139],a[72:75],0
s_mov_b32 s27,166723584
ds_read_b128 a[136:139],v0 offset:6272
v_permlane16_swap_b32 v53,v52
s_waitcnt lgkmcnt(6)
v_mfma_f32_16x16x32_bf16 v[96:99],a[140:143],a[76:79],v[96:99]
s_mov_b32 s42,s41
ds_read_b128 a[140:143],v1 offset:6272
v_max_f32 v52,v52,v53
s_waitcnt lgkmcnt(6)
v_mfma_f32_16x16x32_bf16 v[96:99],a[144:147],a[80:83],v[96:99]
s_add_u32 s69,s69,1
ds_read_b128 a[144:147],v0 offset:6400
v_mul_f32_e64 v15,-s36,v52
v_fma_f32 v88,v88,s36,v15
s_waitcnt lgkmcnt(6)
v_mfma_f32_16x16x32_bf16 v[96:99],a[148:151],a[84:87],v[96:99]
s_lshl_b32 s62,s69,5
ds_read_b128 a[148:151],v1 offset:6400
v_fma_f32 v89,v89,s36,v15
s_waitcnt lgkmcnt(5)
v_mfma_f32_16x16x32_bf16 v[96:99],a[120:123],a[88:91],v[96:99]
s_add_u32 s62,s62,s34
ds_read_b128 a[120:123],v0 offset:12288
v_fma_f32 v90,v90,s36,v15
v_mfma_f32_16x16x32_bf16 v[96:99],a[124:127],a[92:95],v[96:99]
s_mul_i32 s63,s62,171
ds_read_b128 a[124:127],v1 offset:12288
v_fma_f32 v91,v91,s36,v15
v_mfma_f32_16x16x32_bf16 v[100:103],a[128:131],a[72:75],0
s_lshr_b32 s63,s63,9
ds_read_b128 a[128:131],v0 offset:12416
v_exp_f32 v88,v88
s_waitcnt lgkmcnt(6)
v_mfma_f32_16x16x32_bf16 v[100:103],a[132:135],a[76:79],v[100:103]
s_mul_i32 s64,s63,3
ds_read_b128 a[132:135],v1 offset:12416
v_exp_f32 v89,v89
v_mfma_f32_16x16x32_bf16 v[100:103],a[136:139],a[80:83],v[100:103]
s_sub_u32 s62,s62,s64
ds_read_b128 a[136:139],v0 offset:12544
v_exp_f32 v90,v90
s_waitcnt lgkmcnt(6)
v_mfma_f32_16x16x32_bf16 v[100:103],a[140:143],a[84:87],v[100:103]
s_add_u32 s63,s63,s33
ds_read_b128 a[140:143],v1 offset:12544
v_exp_f32 v91,v91
v_mfma_f32_16x16x32_bf16 v[100:103],a[144:147],a[88:91],v[100:103]
s_mul_i32 s30,s63,196608
ds_read_b128 a[144:147],v0 offset:18432
v_cvt_pk_bf16_f32 v28,v88,v89
s_waitcnt lgkmcnt(6)
v_mfma_f32_16x16x32_bf16 v[100:103],a[148:151],a[92:95],v[100:103]
s_waitcnt vmcnt(9)
s_barrier
ds_read_b128 a[148:151],v1 offset:18432
v_cvt_pk_bf16_f32 v29,v90,v91
v_mfma_f32_16x16x32_bf16 v[88:91],a[120:123],a[48:51],0
s_mul_i32 s41,s63,325632
ds_read_b128 a[120:123],v0 offset:18560
v_fma_f32 v92,v92,s36,v15
s_waitcnt lgkmcnt(5)
v_mfma_f32_16x16x32_bf16 v[88:91],a[124:127],a[52:55],v[88:91]
s_lshl_b32 s63,s3,2
ds_read_b128 a[124:127],v1 offset:18560
v_fma_f32 v93,v93,s36,v15
v_mfma_f32_16x16x32_bf16 v[88:91],a[128:131],a[56:59],v[88:91]
s_add_u32 s64,s63,21
ds_read_b128 a[128:131],v0 offset:18688
v_fma_f32 v94,v94,s36,v15
v_mfma_f32_16x16x32_bf16 v[88:91],a[132:135],a[60:63],v[88:91]
s_cmp_eq_u32 s3,0
ds_read_b128 a[132:135],v1 offset:18688
v_fma_f32 v95,v95,s36,v15
s_waitcnt lgkmcnt(6)
v_mfma_f32_16x16x32_bf16 v[88:91],a[136:139],a[64:67],v[88:91]
s_cselect_b32 s64,20,s64
ds_read_b128 a[136:139],v0 offset:12288
v_exp_f32 v92,v92
v_mfma_f32_16x16x32_bf16 v[88:91],a[140:143],a[68:71],v[88:91]
s_cselect_b32 s40,1,0
ds_read_b128 a[140:143],v1 offset:12288
v_exp_f32 v93,v93
v_exp_f32 v94,v94
v_exp_f32 v95,v95
v_cvt_pk_bf16_f32 v30,v92,v93
v_cvt_pk_bf16_f32 v31,v94,v95
s_waitcnt lgkmcnt(5)
v_mfma_f32_16x16x32_bf16 v[92:95],a[144:147],a[48:51],0
s_add_u32 s65,s63,37
ds_read_b128 a[144:147],v0 offset:12416
v_max3_f32 v56,v96,v97,v98
v_mfma_f32_16x16x32_bf16 v[92:95],a[148:151],a[52:55],v[92:95]
s_cmp_eq_u32 s62,2
ds_read_b128 a[148:151],v1 offset:12416
v_max3_f32 v56,v56,v99,v100
v_mfma_f32_16x16x32_bf16 v[92:95],a[120:123],a[56:59],v[92:95]
s_cselect_b32 s64,s65,s64
ds_read_b128 a[120:123],v0 offset:12544
v_max3_f32 v56,v56,v101,v102
s_waitcnt lgkmcnt(5)
v_mfma_f32_16x16x32_bf16 v[92:95],a[124:127],a[60:63],v[92:95]
s_cselect_b32 s40,0,s40
ds_read_b128 a[124:127],v1 offset:12544
v_max_f32 v56,v56,v103
v_mfma_f32_16x16x32_bf16 v[92:95],a[128:131],a[64:67],v[92:95]
s_add_u32 s65,s63,s3
ds_read_b128 a[128:131],v0 offset:18432
v_mov_b32 v57,v56
v_mfma_f32_16x16x32_bf16 v[92:95],a[132:135],a[68:71],v[92:95]
s_cmp_eq_u32 s62,0
ds_read_b128 a[132:135],v1 offset:18432
v_permlane32_swap_b32 v57,v56
v_max_f32 v56,v56,v57
v_mov_b32 v57,v56
v_fma_f32 v72,v72,s36,v13
v_fma_f32 v73,v73,s36,v13
v_permlane16_swap_b32 v57,v56
v_max_f32 v56,v56,v57
v_mul_f32_e64 v16,-s36,v56
v_fma_f32 v96,v96,s36,v16
v_fma_f32 v97,v97,s36,v16
v_fma_f32 v98,v98,s36,v16
v_fma_f32 v99,v99,s36,v16
v_exp_f32 v96,v96
v_exp_f32 v97,v97
v_exp_f32 v98,v98
v_exp_f32 v99,v99
v_cvt_pk_bf16_f32 v32,v96,v97
v_cvt_pk_bf16_f32 v33,v98,v99
s_waitcnt lgkmcnt(2)
v_mfma_f32_16x16x32_bf16 v[96:99],a[136:139],a[72:75],0
s_cselect_b32 s64,s65,s64
ds_read_b128 a[136:139],v0 offset:18560
v_fma_f32 v100,v100,s36,v16
v_mfma_f32_16x16x32_bf16 v[96:99],a[140:143],a[76:79],v[96:99]
s_cselect_b32 s40,1,s40
ds_read_b128 a[140:143],v1 offset:18560
v_fma_f32 v101,v101,s36,v16
v_mfma_f32_16x16x32_bf16 v[96:99],a[144:147],a[80:83],v[96:99]
s_mul_i32 s64,s64,6144
ds_read_b128 a[144:147],v0 offset:18688
v_fma_f32 v102,v102,s36,v16
v_mfma_f32_16x16x32_bf16 v[96:99],a[148:151],a[84:87],v[96:99]
s_add_u32 s41,s41,s64
ds_read_b128 a[148:151],v1 offset:18688
v_fma_f32 v103,v103,s36,v16
v_mfma_f32_16x16x32_bf16 v[96:99],a[120:123],a[88:91],v[96:99]
s_cmp_ge_u32 s69,6
ds_read_b64_tr_b16 a[120:121],v2 offset:0
v_exp_f32 v100,v100
v_mfma_f32_16x16x32_bf16 v[96:99],a[124:127],a[92:95],v[96:99]
s_cselect_b32 s41,166723584,s41
ds_read_b64_tr_b16 a[122:123],v2 offset:6144
ds_read_b64_tr_b16 a[124:125],v3 offset:0
ds_read_b64_tr_b16 a[126:127],v3 offset:6144
v_exp_f32 v101,v101
v_exp_f32 v102,v102
v_exp_f32 v103,v103
v_cvt_pk_bf16_f32 v34,v100,v101
v_cvt_pk_bf16_f32 v35,v102,v103
s_waitcnt lgkmcnt(7)
v_mfma_f32_16x16x32_bf16 v[100:103],a[128:131],a[72:75],0
s_cselect_b32 s30,100663296,s30
ds_read_b64_tr_b16 a[128:129],v4 offset:0
v_fma_f32 v74,v74,s36,v13
v_smfmac_f32_16x16x64_bf16 v[64:67],a[152:155],v[28:35],v18
s_add_u32 s25,s30,s22
s_add_u32 s26,s25,12288
ds_read_b64_tr_b16 a[130:131],v4 offset:6144
v_mfma_f32_16x16x32_bf16 v[100:103],a[132:135],a[76:79],v[100:103]
s_mov_b32 s28,s41
ds_read_b64_tr_b16 a[132:133],v5 offset:0
v_fma_f32 v75,v75,s36,v13
v_mfma_f32_16x16x32_bf16 v[100:103],a[136:139],a[80:83],v[100:103]
s_mov_b32 s29,s24
ds_read_b64_tr_b16 a[134:135],v5 offset:6144
v_fma_f32 v80,v80,s36,v14
s_waitcnt lgkmcnt(7)
v_mfma_f32_16x16x32_bf16 v[100:103],a[140:143],a[84:87],v[100:103]
s_add_u32 m0,s22,0
v_fma_f32 v81,v81,s36,v14
v_exp_f32 v72,v72
v_mfma_f32_16x16x32_bf16 v[100:103],a[144:147],a[88:91],v[100:103]
buffer_load_dwordx4 v6,s[4:7],s20 offen offset:0 lds
v_mfma_f32_16x16x32_bf16 v[100:103],a[148:151],a[92:95],v[100:103]
buffer_load_dwordx4 v7,s[4:7],s20 offen offset:1024 lds
buffer_load_dwordx4 v8,s[4:7],s20 offen offset:2048 lds
v_exp_f32 v73,v73
v_exp_f32 v74,v74
v_exp_f32 v75,v75
v_exp_f32 v80,v80
v_exp_f32 v81,v81
v_cvt_pk_bf16_f32 v44,v72,v73
v_cvt_pk_bf16_f32 v45,v74,v75
v_cvt_pk_bf16_f32 v48,v80,v81
s_add_u32 s20,s20,12288
s_waitcnt lgkmcnt(0)
v_mfma_f32_16x16x32_bf16 v[160:163],a[120:123],v[20:23],0
s_add_u32 m0,s23,0
ds_read_b64_tr_b16 a[136:137],v2 offset:128
v_fma_f32 v82,v82,s36,v14
v_mfma_f32_16x16x32_bf16 v[164:167],a[124:127],v[20:23],0
ds_read_b64_tr_b16 a[138:139],v2 offset:6272
v_fma_f32 v83,v83,s36,v14
v_mfma_f32_16x16x32_bf16 v[212:215],a[124:127],v[24:27],0
ds_read_b64_tr_b16 a[140:141],v3 offset:128
v_fma_f32 v88,v88,s36,v15
v_mfma_f32_16x16x32_bf16 v[208:211],a[120:123],v[24:27],0
ds_read_b64_tr_b16 a[142:143],v3 offset:6272
v_fma_f32 v89,v89,s36,v15
v_mfma_f32_16x16x32_bf16 v[112:115],a[120:123],v[28:31],0
ds_read_b64_tr_b16 a[144:145],v4 offset:128
v_fma_f32 v90,v90,s36,v15
v_mfma_f32_16x16x32_bf16 v[116:119],a[124:127],v[28:31],0
ds_read_b64_tr_b16 a[146:147],v4 offset:6272
v_fma_f32 v91,v91,s36,v15
v_mfma_f32_16x16x32_bf16 a[164:167],a[124:127],v[32:35],0
ds_read_b64_tr_b16 a[148:149],v5 offset:128
v_fma_f32 v96,v96,s36,v16
v_mfma_f32_16x16x32_bf16 a[160:163],a[120:123],v[32:35],0
ds_read_b64_tr_b16 a[150:151],v5 offset:6272
v_fma_f32 v97,v97,s36,v16
v_mfma_f32_16x16x32_bf16 a[168:171],a[128:131],v[32:35],0
ds_read_b64_tr_b16 a[120:121],v2 offset:256
v_fma_f32 v98,v98,s36,v16
v_mfma_f32_16x16x32_bf16 a[172:175],a[132:135],v[32:35],0
ds_read_b64_tr_b16 a[122:123],v2 offset:6400
v_fma_f32 v99,v99,s36,v16
v_mfma_f32_16x16x32_bf16 v[124:127],a[132:135],v[28:31],0
ds_read_b64_tr_b16 a[124:125],v3 offset:256
v_fma_f32 v76,v76,s36,v13
v_mfma_f32_16x16x32_bf16 v[120:123],a[128:131],v[28:31],0
ds_read_b64_tr_b16 a[126:127],v3 offset:6400
v_fma_f32 v77,v77,s36,v13
v_mfma_f32_16x16x32_bf16 v[216:219],a[128:131],v[24:27],0
v_exp_f32 v82,v82
v_mfma_f32_16x16x32_bf16 v[220:223],a[132:135],v[24:27],0
v_exp_f32 v83,v83
v_mfma_f32_16x16x32_bf16 v[172:175],a[132:135],v[20:23],0
ds_read_b64_tr_b16 a[132:133],v5 offset:256
v_cvt_pk_bf16_f32 v49,v82,v83
v_mfma_f32_16x16x32_bf16 v[168:171],a[128:131],v[20:23],0
s_waitcnt lgkmcnt(4)
ds_read_b64_tr_b16 a[128:129],v4 offset:256
v_fma_f32 v78,v78,s36,v13
v_mfma_f32_16x16x32_bf16 v[176:179],a[136:139],v[20:23],0
ds_read_b64_tr_b16 a[130:131],v4 offset:6400
v_fma_f32 v79,v79,s36,v13
v_mfma_f32_16x16x32_bf16 v[180:183],a[140:143],v[20:23],0
ds_read_b64_tr_b16 a[134:135],v5 offset:6400
v_fma_f32 v84,v84,s36,v14
v_mfma_f32_16x16x32_bf16 v[228:231],a[140:143],v[24:27],0
v_exp_f32 v88,v88
v_mfma_f32_16x16x32_bf16 v[224:227],a[136:139],v[24:27],0
v_exp_f32 v89,v89
v_mfma_f32_16x16x32_bf16 v[128:131],a[136:139],v[28:31],0
v_exp_f32 v90,v90
v_mfma_f32_16x16x32_bf16 v[132:135],a[140:143],v[28:31],0
v_exp_f32 v91,v91
v_mfma_f32_16x16x32_bf16 a[180:183],a[140:143],v[32:35],0
v_cvt_pk_bf16_f32 v52,v88,v89
v_cvt_pk_bf16_f32 v53,v90,v91
v_mfma_f32_16x16x32_bf16 a[176:179],a[136:139],v[32:35],0
v_exp_f32 v96,v96
v_mfma_f32_16x16x32_bf16 a[184:187],a[144:147],v[32:35],0
v_exp_f32 v97,v97
v_mfma_f32_16x16x32_bf16 a[188:191],a[148:151],v[32:35],0
v_exp_f32 v98,v98
v_mfma_f32_16x16x32_bf16 v[140:143],a[148:151],v[28:31],0
v_exp_f32 v99,v99
v_mfma_f32_16x16x32_bf16 v[136:139],a[144:147],v[28:31],0
v_cvt_pk_bf16_f32 v56,v96,v97
v_cvt_pk_bf16_f32 v57,v98,v99
v_mfma_f32_16x16x32_bf16 v[232:235],a[144:147],v[24:27],0
v_exp_f32 v76,v76
v_mfma_f32_16x16x32_bf16 v[236:239],a[148:151],v[24:27],0
v_exp_f32 v77,v77
v_mfma_f32_16x16x32_bf16 v[188:191],a[148:151],v[20:23],0
v_exp_f32 v78,v78
v_mfma_f32_16x16x32_bf16 v[184:187],a[144:147],v[20:23],0
s_waitcnt lgkmcnt(0)
v_exp_f32 v79,v79
v_mfma_f32_16x16x32_bf16 v[192:195],a[120:123],v[20:23],0
v_cvt_pk_bf16_f32 v46,v76,v77
v_cvt_pk_bf16_f32 v47,v78,v79
v_mfma_f32_16x16x32_bf16 v[196:199],a[124:127],v[20:23],0
s_waitcnt vmcnt(6)
v_fma_f32 v85,v85,s36,v14
v_fma_f32 v86,v86,s36,v14
v_mfma_f32_16x16x32_bf16 v[244:247],a[124:127],v[24:27],0
s_barrier
v_mfma_f32_16x16x32_bf16 v[240:243],a[120:123],v[24:27],0
ds_read_b128 a[148:151],v1 offset:24704
v_fma_f32 v87,v87,s36,v14
v_mfma_f32_16x16x32_bf16 v[144:147],a[120:123],v[28:31],0
ds_read_b128 a[144:147],v0 offset:24704
v_fma_f32 v92,v92,s36,v15
v_mfma_f32_16x16x32_bf16 v[148:151],a[124:127],v[28:31],0
ds_read_b128 a[140:143],v1 offset:24576
v_fma_f32 v93,v93,s36,v15
v_mfma_f32_16x16x32_bf16 a[196:199],a[124:127],v[32:35],0
ds_read_b128 a[124:127],v1 offset:24832
v_fma_f32 v94,v94,s36,v15
v_mfma_f32_16x16x32_bf16 a[192:195],a[120:123],v[32:35],0
ds_read_b128 a[120:123],v0 offset:24832
v_fma_f32 v95,v95,s36,v15
v_mfma_f32_16x16x32_bf16 a[200:203],a[128:131],v[32:35],0
buffer_load_dwordx4 v6,s[8:11],s21 offen offset:0 lds
v_mfma_f32_16x16x32_bf16 a[204:207],a[132:135],v[32:35],0
ds_read_b128 a[136:139],v0 offset:24576
v_fma_f32 v100,v100,s36,v16
v_mfma_f32_16x16x32_bf16 v[156:159],a[132:135],v[28:31],0
v_exp_f32 v84,v84
v_mfma_f32_16x16x32_bf16 v[152:155],a[128:131],v[28:31],0
v_exp_f32 v85,v85
v_mfma_f32_16x16x32_bf16 v[248:251],a[128:131],v[24:27],0
v_exp_f32 v86,v86
v_mfma_f32_16x16x32_bf16 v[252:255],a[132:135],v[24:27],0
v_exp_f32 v87,v87
v_mfma_f32_16x16x32_bf16 v[204:207],a[132:135],v[20:23],0
ds_read_b128 a[132:135],v1 offset:30720
v_cvt_pk_bf16_f32 v50,v84,v85
v_mfma_f32_16x16x32_bf16 v[200:203],a[128:131],v[20:23],0
s_waitcnt lgkmcnt(2)
ds_read_b128 a[128:131],v0 offset:30720
v_cvt_pk_bf16_f32 v51,v86,v87
v_mfma_f32_16x16x32_bf16 v[72:75],a[124:127],a[20:23],0
v_exp_f32 v92,v92
v_smfmac_f32_16x16x64_bf16 v[60:63],a[152:155],v[44:51],v18
buffer_load_dwordx4 v7,s[8:11],s21 offen offset:1024 lds
v_mfma_f32_16x16x32_bf16 v[72:75],a[120:123],a[16:19],v[72:75]
v_exp_f32 v93,v93
v_mfma_f32_16x16x32_bf16 v[72:75],a[148:151],a[12:15],v[72:75]
v_exp_f32 v94,v94
v_mfma_f32_16x16x32_bf16 v[72:75],a[144:147],a[8:11],v[72:75]
v_exp_f32 v95,v95
v_mfma_f32_16x16x32_bf16 v[72:75],a[140:143],a[4:7],v[72:75]
s_waitcnt lgkmcnt(1)
v_cvt_pk_bf16_f32 v54,v92,v93
v_cvt_pk_bf16_f32 v55,v94,v95
v_mfma_f32_16x16x32_bf16 v[72:75],a[136:139],a[0:3],v[72:75]
v_fma_f32 v101,v101,s36,v16
v_fma_f32 v102,v102,s36,v16
v_mfma_f32_16x16x32_bf16 v[80:83],a[136:139],a[24:27],0
v_fma_f32 v103,v103,s36,v16
v_mfma_f32_16x16x32_bf16 v[80:83],a[140:143],a[28:31],v[80:83]
v_exp_f32 v100,v100
v_mfma_f32_16x16x32_bf16 v[80:83],a[144:147],a[32:35],v[80:83]
buffer_load_dwordx4 v8,s[8:11],s21 offen offset:2048 lds
v_mfma_f32_16x16x32_bf16 v[80:83],a[148:151],a[36:39],v[80:83]
s_add_u32 s21,s21,12288
v_exp_f32 v101,v101
v_mfma_f32_16x16x32_bf16 v[80:83],a[120:123],a[40:43],v[80:83]
s_add_u32 m0,s22,12288
v_exp_f32 v102,v102
v_mfma_f32_16x16x32_bf16 v[80:83],a[124:127],a[44:47],v[80:83]
v_exp_f32 v103,v103
v_mfma_f32_16x16x32_bf16 v[88:91],a[124:127],a[68:71],0
v_cvt_pk_bf16_f32 v58,v100,v101
v_cvt_pk_bf16_f32 v59,v102,v103
v_mfma_f32_16x16x32_bf16 v[88:91],a[120:123],a[64:67],v[88:91]
v_fma_f32 v72,v72,s36,v13
v_fma_f32 v73,v73,s36,v13
v_smfmac_f32_16x16x64_bf16 v[64:67],a[152:155],v[52:59],v18
v_fma_f32 v74,v74,s36,v13
v_mfma_f32_16x16x32_bf16 v[88:91],a[148:151],a[60:63],v[88:91]
v_fma_f32 v75,v75,s36,v13
v_fma_f32 v80,v80,s36,v14
v_mfma_f32_16x16x32_bf16 v[88:91],a[144:147],a[56:59],v[88:91]
v_fma_f32 v81,v81,s36,v14
v_mfma_f32_16x16x32_bf16 v[88:91],a[140:143],a[52:55],v[88:91]
buffer_load_dwordx4 v6,s[4:7],s20 offen offset:0 lds
v_mfma_f32_16x16x32_bf16 v[88:91],a[136:139],a[48:51],v[88:91]
v_exp_f32 v72,v72
v_mfma_f32_16x16x32_bf16 v[96:99],a[136:139],a[72:75],0
ds_read_b128 a[136:139],v0 offset:30848
v_mfma_f32_16x16x32_bf16 v[96:99],a[140:143],a[76:79],v[96:99]
ds_read_b128 a[140:143],v1 offset:30848
v_mfma_f32_16x16x32_bf16 v[96:99],a[144:147],a[80:83],v[96:99]
ds_read_b128 a[144:147],v0 offset:30976
v_mfma_f32_16x16x32_bf16 v[96:99],a[148:151],a[84:87],v[96:99]
ds_read_b128 a[148:151],v1 offset:30976
v_mfma_f32_16x16x32_bf16 v[96:99],a[120:123],a[88:91],v[96:99]
v_exp_f32 v73,v73
v_mfma_f32_16x16x32_bf16 v[96:99],a[124:127],a[92:95],v[96:99]
s_waitcnt lgkmcnt(4)
v_exp_f32 v74,v74
v_mfma_f32_16x16x32_bf16 v[76:79],a[128:131],a[0:3],0
v_exp_f32 v75,v75
v_mfma_f32_16x16x32_bf16 v[76:79],a[132:135],a[4:7],v[76:79]
buffer_load_dwordx4 v7,s[4:7],s20 offen offset:1024 lds
s_waitcnt lgkmcnt(3)
v_mfma_f32_16x16x32_bf16 v[76:79],a[136:139],a[8:11],v[76:79]
s_waitcnt lgkmcnt(2)
v_exp_f32 v80,v80
v_mfma_f32_16x16x32_bf16 v[76:79],a[140:143],a[12:15],v[76:79]
s_waitcnt lgkmcnt(0)
v_exp_f32 v81,v81
v_mfma_f32_16x16x32_bf16 v[76:79],a[144:147],a[16:19],v[76:79]
v_cvt_pk_bf16_f32 v20,v72,v73
v_cvt_pk_bf16_f32 v21,v74,v75
v_mfma_f32_16x16x32_bf16 v[76:79],a[148:151],a[20:23],v[76:79]
v_cvt_pk_bf16_f32 v24,v80,v81
v_mfma_f32_16x16x32_bf16 v[84:87],a[148:151],a[44:47],0
v_mfma_f32_16x16x32_bf16 v[84:87],a[144:147],a[40:43],v[84:87]
v_mfma_f32_16x16x32_bf16 v[84:87],a[140:143],a[36:39],v[84:87]
v_mfma_f32_16x16x32_bf16 v[84:87],a[136:139],a[32:35],v[84:87]
v_mfma_f32_16x16x32_bf16 v[84:87],a[132:135],a[28:31],v[84:87]
buffer_load_dwordx4 v8,s[4:7],s20 offen offset:2048 lds
v_mfma_f32_16x16x32_bf16 v[84:87],a[128:131],a[24:27],v[84:87]
s_add_u32 s20,s20,12288
v_mfma_f32_16x16x32_bf16 v[92:95],a[128:131],a[48:51],0
ds_read_b64_tr_b16 a[120:121],v2 offset:12288
v_mfma_f32_16x16x32_bf16 v[92:95],a[132:135],a[52:55],v[92:95]
ds_read_b64_tr_b16 a[122:123],v2 offset:18432
v_mfma_f32_16x16x32_bf16 v[92:95],a[136:139],a[56:59],v[92:95]
ds_read_b64_tr_b16 a[124:125],v3 offset:12288
v_mfma_f32_16x16x32_bf16 v[92:95],a[140:143],a[60:63],v[92:95]
ds_read_b64_tr_b16 a[126:127],v3 offset:18432
v_mfma_f32_16x16x32_bf16 v[92:95],a[144:147],a[64:67],v[92:95]
v_mfma_f32_16x16x32_bf16 v[92:95],a[148:151],a[68:71],v[92:95]
v_mfma_f32_16x16x32_bf16 v[100:103],a[148:151],a[92:95],0
v_mfma_f32_16x16x32_bf16 v[100:103],a[144:147],a[88:91],v[100:103]
v_mfma_f32_16x16x32_bf16 v[100:103],a[140:143],a[84:87],v[100:103]
v_mfma_f32_16x16x32_bf16 v[100:103],a[136:139],a[80:83],v[100:103]
v_mfma_f32_16x16x32_bf16 v[100:103],a[132:135],a[76:79],v[100:103]
ds_read_b64_tr_b16 a[132:133],v5 offset:12288
v_mfma_f32_16x16x32_bf16 v[100:103],a[128:131],a[72:75],v[100:103]
s_waitcnt lgkmcnt(1)
ds_read_b64_tr_b16 a[128:129],v4 offset:12288
ds_read_b64_tr_b16 a[130:131],v4 offset:18432
ds_read_b64_tr_b16 a[134:135],v5 offset:18432
v_mfma_f32_16x16x32_bf16 v[160:163],a[120:123],v[44:47],v[160:163]
s_add_u32 m0,s23,12288
ds_read_b64_tr_b16 a[136:137],v2 offset:12416
v_fma_f32 v82,v82,s36,v14
v_mfma_f32_16x16x32_bf16 v[164:167],a[124:127],v[44:47],v[164:167]
ds_read_b64_tr_b16 a[138:139],v2 offset:18560
v_fma_f32 v83,v83,s36,v14
v_mfma_f32_16x16x32_bf16 v[212:215],a[124:127],v[48:51],v[212:215]
ds_read_b64_tr_b16 a[140:141],v3 offset:12416
v_fma_f32 v88,v88,s36,v15
v_mfma_f32_16x16x32_bf16 v[208:211],a[120:123],v[48:51],v[208:211]
ds_read_b64_tr_b16 a[142:143],v3 offset:18560
v_fma_f32 v89,v89,s36,v15
v_mfma_f32_16x16x32_bf16 v[112:115],a[120:123],v[52:55],v[112:115]
ds_read_b64_tr_b16 a[144:145],v4 offset:12416
v_fma_f32 v90,v90,s36,v15
v_mfma_f32_16x16x32_bf16 v[116:119],a[124:127],v[52:55],v[116:119]
ds_read_b64_tr_b16 a[146:147],v4 offset:18560
v_fma_f32 v91,v91,s36,v15
v_mfma_f32_16x16x32_bf16 a[164:167],a[124:127],v[56:59],a[164:167]
ds_read_b64_tr_b16 a[148:149],v5 offset:12416
v_fma_f32 v96,v96,s36,v16
v_mfma_f32_16x16x32_bf16 a[160:163],a[120:123],v[56:59],a[160:163]
s_waitcnt lgkmcnt(6)
ds_read_b64_tr_b16 a[150:151],v5 offset:18560
v_fma_f32 v97,v97,s36,v16
v_mfma_f32_16x16x32_bf16 a[168:171],a[128:131],v[56:59],a[168:171]
ds_read_b64_tr_b16 a[120:121],v2 offset:12544
v_fma_f32 v98,v98,s36,v16
v_mfma_f32_16x16x32_bf16 a[172:175],a[132:135],v[56:59],a[172:175]
ds_read_b64_tr_b16 a[122:123],v2 offset:18688
v_fma_f32 v99,v99,s36,v16
v_mfma_f32_16x16x32_bf16 v[124:127],a[132:135],v[52:55],v[124:127]
ds_read_b64_tr_b16 a[124:125],v3 offset:12544
v_fma_f32 v76,v76,s36,v13
v_mfma_f32_16x16x32_bf16 v[120:123],a[128:131],v[52:55],v[120:123]
ds_read_b64_tr_b16 a[126:127],v3 offset:18688
v_fma_f32 v77,v77,s36,v13
v_mfma_f32_16x16x32_bf16 v[216:219],a[128:131],v[48:51],v[216:219]
v_exp_f32 v82,v82
v_mfma_f32_16x16x32_bf16 v[220:223],a[132:135],v[48:51],v[220:223]
v_exp_f32 v83,v83
v_mfma_f32_16x16x32_bf16 v[172:175],a[132:135],v[44:47],v[172:175]
ds_read_b64_tr_b16 a[132:133],v5 offset:12544
v_cvt_pk_bf16_f32 v25,v82,v83
v_mfma_f32_16x16x32_bf16 v[168:171],a[128:131],v[44:47],v[168:171]
s_waitcnt lgkmcnt(4)
ds_read_b64_tr_b16 a[128:129],v4 offset:12544
v_fma_f32 v78,v78,s36,v13
v_mfma_f32_16x16x32_bf16 v[176:179],a[136:139],v[44:47],v[176:179]
ds_read_b64_tr_b16 a[130:131],v4 offset:18688
v_fma_f32 v79,v79,s36,v13
v_mfma_f32_16x16x32_bf16 v[180:183],a[140:143],v[44:47],v[180:183]
ds_read_b64_tr_b16 a[134:135],v5 offset:18688
v_fma_f32 v84,v84,s36,v14
v_mfma_f32_16x16x32_bf16 v[228:231],a[140:143],v[48:51],v[228:231]
v_exp_f32 v88,v88
v_mfma_f32_16x16x32_bf16 v[224:227],a[136:139],v[48:51],v[224:227]
v_exp_f32 v89,v89
v_mfma_f32_16x16x32_bf16 v[128:131],a[136:139],v[52:55],v[128:131]
v_exp_f32 v90,v90
v_mfma_f32_16x16x32_bf16 v[132:135],a[140:143],v[52:55],v[132:135]
v_exp_f32 v91,v91
v_mfma_f32_16x16x32_bf16 a[180:183],a[140:143],v[56:59],a[180:183]
v_cvt_pk_bf16_f32 v28,v88,v89
v_cvt_pk_bf16_f32 v29,v90,v91
v_mfma_f32_16x16x32_bf16 a[176:179],a[136:139],v[56:59],a[176:179]
v_exp_f32 v96,v96
v_mfma_f32_16x16x32_bf16 a[184:187],a[144:147],v[56:59],a[184:187]
v_exp_f32 v97,v97
v_mfma_f32_16x16x32_bf16 a[188:191],a[148:151],v[56:59],a[188:191]
v_exp_f32 v98,v98
v_mfma_f32_16x16x32_bf16 v[140:143],a[148:151],v[52:55],v[140:143]
v_exp_f32 v99,v99
v_mfma_f32_16x16x32_bf16 v[136:139],a[144:147],v[52:55],v[136:139]
v_cvt_pk_bf16_f32 v32,v96,v97
v_cvt_pk_bf16_f32 v33,v98,v99
v_mfma_f32_16x16x32_bf16 v[232:235],a[144:147],v[48:51],v[232:235]
v_exp_f32 v76,v76
v_mfma_f32_16x16x32_bf16 v[236:239],a[148:151],v[48:51],v[236:239]
v_exp_f32 v77,v77
v_mfma_f32_16x16x32_bf16 v[188:191],a[148:151],v[44:47],v[188:191]
v_exp_f32 v78,v78
v_mfma_f32_16x16x32_bf16 v[184:187],a[144:147],v[44:47],v[184:187]
s_waitcnt lgkmcnt(0)
v_exp_f32 v79,v79
v_mfma_f32_16x16x32_bf16 v[192:195],a[120:123],v[44:47],v[192:195]
v_cvt_pk_bf16_f32 v22,v76,v77
v_cvt_pk_bf16_f32 v23,v78,v79
v_mfma_f32_16x16x32_bf16 v[196:199],a[124:127],v[44:47],v[196:199]
s_waitcnt vmcnt(6)
v_fma_f32 v85,v85,s36,v14
v_fma_f32 v86,v86,s36,v14
v_mfma_f32_16x16x32_bf16 v[244:247],a[124:127],v[48:51],v[244:247]
s_barrier
v_mfma_f32_16x16x32_bf16 v[240:243],a[120:123],v[48:51],v[240:243]
ds_read_b128 a[148:151],v1 offset:128
v_fma_f32 v87,v87,s36,v14
v_mfma_f32_16x16x32_bf16 v[144:147],a[120:123],v[52:55],v[144:147]
ds_read_b128 a[144:147],v0 offset:128
v_fma_f32 v92,v92,s36,v15
v_mfma_f32_16x16x32_bf16 v[148:151],a[124:127],v[52:55],v[148:151]
ds_read_b128 a[140:143],v1 offset:0
v_fma_f32 v93,v93,s36,v15
v_mfma_f32_16x16x32_bf16 a[196:199],a[124:127],v[56:59],a[196:199]
ds_read_b128 a[124:127],v1 offset:256
v_fma_f32 v94,v94,s36,v15
v_mfma_f32_16x16x32_bf16 a[192:195],a[120:123],v[56:59],a[192:195]
ds_read_b128 a[120:123],v0 offset:256
v_fma_f32 v95,v95,s36,v15
v_mfma_f32_16x16x32_bf16 a[200:203],a[128:131],v[56:59],a[200:203]
buffer_load_dwordx4 v6,s[8:11],s21 offen offset:0 lds
v_mfma_f32_16x16x32_bf16 a[204:207],a[132:135],v[56:59],a[204:207]
ds_read_b128 a[136:139],v0 offset:0
v_fma_f32 v100,v100,s36,v16
v_mfma_f32_16x16x32_bf16 v[156:159],a[132:135],v[52:55],v[156:159]
v_exp_f32 v84,v84
v_mfma_f32_16x16x32_bf16 v[152:155],a[128:131],v[52:55],v[152:155]
v_exp_f32 v85,v85
v_mfma_f32_16x16x32_bf16 v[248:251],a[128:131],v[48:51],v[248:251]
v_exp_f32 v86,v86
v_mfma_f32_16x16x32_bf16 v[252:255],a[132:135],v[48:51],v[252:255]
v_exp_f32 v87,v87
v_mfma_f32_16x16x32_bf16 v[204:207],a[132:135],v[44:47],v[204:207]
ds_read_b128 a[132:135],v1 offset:6144
v_cvt_pk_bf16_f32 v26,v84,v85
v_mfma_f32_16x16x32_bf16 v[200:203],a[128:131],v[44:47],v[200:203]
s_waitcnt lgkmcnt(2)
ds_read_b128 a[128:131],v0 offset:6144
v_cvt_pk_bf16_f32 v27,v86,v87
v_mfma_f32_16x16x32_bf16 v[72:75],a[124:127],a[20:23],0
v_exp_f32 v92,v92
v_smfmac_f32_16x16x64_bf16 v[60:63],a[152:155],v[20:27],v18
buffer_load_dwordx4 v7,s[8:11],s21 offen offset:1024 lds
v_mfma_f32_16x16x32_bf16 v[72:75],a[120:123],a[16:19],v[72:75]
v_exp_f32 v93,v93
v_mfma_f32_16x16x32_bf16 v[72:75],a[148:151],a[12:15],v[72:75]
v_exp_f32 v94,v94
v_mfma_f32_16x16x32_bf16 v[72:75],a[144:147],a[8:11],v[72:75]
v_exp_f32 v95,v95
v_mfma_f32_16x16x32_bf16 v[72:75],a[140:143],a[4:7],v[72:75]
s_waitcnt lgkmcnt(1)
v_cvt_pk_bf16_f32 v30,v92,v93
v_cvt_pk_bf16_f32 v31,v94,v95
v_mfma_f32_16x16x32_bf16 v[72:75],a[136:139],a[0:3],v[72:75]
v_fma_f32 v101,v101,s36,v16
v_fma_f32 v102,v102,s36,v16
v_mfma_f32_16x16x32_bf16 v[80:83],a[136:139],a[24:27],0
v_fma_f32 v103,v103,s36,v16
v_mfma_f32_16x16x32_bf16 v[80:83],a[140:143],a[28:31],v[80:83]
v_exp_f32 v100,v100
v_mfma_f32_16x16x32_bf16 v[80:83],a[144:147],a[32:35],v[80:83]
buffer_load_dwordx4 v8,s[8:11],s21 offen offset:2048 lds
v_mfma_f32_16x16x32_bf16 v[80:83],a[148:151],a[36:39],v[80:83]
s_add_u32 s21,s21,12288
v_exp_f32 v101,v101
v_mfma_f32_16x16x32_bf16 v[80:83],a[120:123],a[40:43],v[80:83]
s_add_u32 m0,s22,24576
v_exp_f32 v102,v102
v_mfma_f32_16x16x32_bf16 v[80:83],a[124:127],a[44:47],v[80:83]
v_exp_f32 v103,v103
v_mfma_f32_16x16x32_bf16 v[88:91],a[124:127],a[68:71],0
v_cvt_pk_bf16_f32 v34,v100,v101
v_cvt_pk_bf16_f32 v35,v102,v103
v_mfma_f32_16x16x32_bf16 v[88:91],a[120:123],a[64:67],v[88:91]
v_fma_f32 v72,v72,s36,v13
v_fma_f32 v73,v73,s36,v13
v_smfmac_f32_16x16x64_bf16 v[64:67],a[152:155],v[28:35],v18
v_fma_f32 v74,v74,s36,v13
v_mfma_f32_16x16x32_bf16 v[88:91],a[148:151],a[60:63],v[88:91]
v_fma_f32 v75,v75,s36,v13
v_fma_f32 v80,v80,s36,v14
v_mfma_f32_16x16x32_bf16 v[88:91],a[144:147],a[56:59],v[88:91]
v_fma_f32 v81,v81,s36,v14
v_mfma_f32_16x16x32_bf16 v[88:91],a[140:143],a[52:55],v[88:91]
buffer_load_dwordx4 v6,s[4:7],s20 offen offset:0 lds
v_mfma_f32_16x16x32_bf16 v[88:91],a[136:139],a[48:51],v[88:91]
v_exp_f32 v72,v72
v_mfma_f32_16x16x32_bf16 v[96:99],a[136:139],a[72:75],0
ds_read_b128 a[136:139],v0 offset:6272
v_mfma_f32_16x16x32_bf16 v[96:99],a[140:143],a[76:79],v[96:99]
ds_read_b128 a[140:143],v1 offset:6272
v_mfma_f32_16x16x32_bf16 v[96:99],a[144:147],a[80:83],v[96:99]
ds_read_b128 a[144:147],v0 offset:6400
v_mfma_f32_16x16x32_bf16 v[96:99],a[148:151],a[84:87],v[96:99]
ds_read_b128 a[148:151],v1 offset:6400
v_mfma_f32_16x16x32_bf16 v[96:99],a[120:123],a[88:91],v[96:99]
v_exp_f32 v73,v73
v_mfma_f32_16x16x32_bf16 v[96:99],a[124:127],a[92:95],v[96:99]
s_waitcnt lgkmcnt(4)
v_exp_f32 v74,v74
v_mfma_f32_16x16x32_bf16 v[76:79],a[128:131],a[0:3],0
v_exp_f32 v75,v75
v_mfma_f32_16x16x32_bf16 v[76:79],a[132:135],a[4:7],v[76:79]
buffer_load_dwordx4 v7,s[4:7],s20 offen offset:1024 lds
s_waitcnt lgkmcnt(3)
v_mfma_f32_16x16x32_bf16 v[76:79],a[136:139],a[8:11],v[76:79]
s_waitcnt lgkmcnt(2)
v_exp_f32 v80,v80
v_mfma_f32_16x16x32_bf16 v[76:79],a[140:143],a[12:15],v[76:79]
s_waitcnt lgkmcnt(0)
v_exp_f32 v81,v81
v_mfma_f32_16x16x32_bf16 v[76:79],a[144:147],a[16:19],v[76:79]
v_cvt_pk_bf16_f32 v44,v72,v73
v_cvt_pk_bf16_f32 v45,v74,v75
v_mfma_f32_16x16x32_bf16 v[76:79],a[148:151],a[20:23],v[76:79]
v_cvt_pk_bf16_f32 v48,v80,v81
v_mfma_f32_16x16x32_bf16 v[84:87],a[148:151],a[44:47],0
v_mfma_f32_16x16x32_bf16 v[84:87],a[144:147],a[40:43],v[84:87]
v_mfma_f32_16x16x32_bf16 v[84:87],a[140:143],a[36:39],v[84:87]
v_mfma_f32_16x16x32_bf16 v[84:87],a[136:139],a[32:35],v[84:87]
v_mfma_f32_16x16x32_bf16 v[84:87],a[132:135],a[28:31],v[84:87]
buffer_load_dwordx4 v8,s[4:7],s20 offen offset:2048 lds
v_mfma_f32_16x16x32_bf16 v[84:87],a[128:131],a[24:27],v[84:87]
s_add_u32 s20,s20,12288
v_mfma_f32_16x16x32_bf16 v[92:95],a[128:131],a[48:51],0
ds_read_b64_tr_b16 a[120:121],v2 offset:24576
v_mfma_f32_16x16x32_bf16 v[92:95],a[132:135],a[52:55],v[92:95]
ds_read_b64_tr_b16 a[122:123],v2 offset:30720
v_mfma_f32_16x16x32_bf16 v[92:95],a[136:139],a[56:59],v[92:95]
ds_read_b64_tr_b16 a[124:125],v3 offset:24576
v_mfma_f32_16x16x32_bf16 v[92:95],a[140:143],a[60:63],v[92:95]
ds_read_b64_tr_b16 a[126:127],v3 offset:30720
v_mfma_f32_16x16x32_bf16 v[92:95],a[144:147],a[64:67],v[92:95]
v_mfma_f32_16x16x32_bf16 v[92:95],a[148:151],a[68:71],v[92:95]
v_mfma_f32_16x16x32_bf16 v[100:103],a[148:151],a[92:95],0
v_mfma_f32_16x16x32_bf16 v[100:103],a[144:147],a[88:91],v[100:103]
v_mfma_f32_16x16x32_bf16 v[100:103],a[140:143],a[84:87],v[100:103]
v_mfma_f32_16x16x32_bf16 v[100:103],a[136:139],a[80:83],v[100:103]
v_mfma_f32_16x16x32_bf16 v[100:103],a[132:135],a[76:79],v[100:103]
ds_read_b64_tr_b16 a[132:133],v5 offset:24576
v_mfma_f32_16x16x32_bf16 v[100:103],a[128:131],a[72:75],v[100:103]
ds_read_b64_tr_b16 a[128:129],v4 offset:24576
ds_read_b64_tr_b16 a[130:131],v4 offset:30720
ds_read_b64_tr_b16 a[134:135],v5 offset:30720
s_mov_b32 s38,0
s_branch L_loop4
L_loop5:
.p2align 6
L_loop5w0:
s_waitcnt lgkmcnt(3)
v_mfma_f32_16x16x32_bf16 v[160:163],a[120:123],v[20:23],v[160:163]
s_add_u32 m0,s23,24576
ds_read_b64_tr_b16 a[142:143],v3 offset:30848
v_fma_f32 v90,v90,s36,v15
v_mfma_f32_16x16x32_bf16 v[164:167],a[124:127],v[20:23],v[164:167]
ds_read_b64_tr_b16 a[136:137],v2 offset:24704
v_fma_f32 v91,v91,s36,v15
v_mfma_f32_16x16x32_bf16 v[212:215],a[124:127],v[24:27],v[212:215]
ds_read_b64_tr_b16 a[138:139],v2 offset:30848
v_fma_f32 v97,v97,s36,v16
v_mfma_f32_16x16x32_bf16 v[208:211],a[120:123],v[24:27],v[208:211]
ds_read_b64_tr_b16 a[140:141],v3 offset:24704
v_fma_f32 v96,v96,s36,v16
v_mfma_f32_16x16x32_bf16 v[112:115],a[120:123],v[28:31],v[112:115]
ds_read_b64_tr_b16 a[146:147],v4 offset:30848
v_fma_f32 v98,v98,s36,v16
v_mfma_f32_16x16x32_bf16 v[116:119],a[124:127],v[28:31],v[116:119]
ds_read_b64_tr_b16 a[144:145],v4 offset:24704
v_fma_f32 v99,v99,s36,v16
v_mfma_f32_16x16x32_bf16 a[164:167],a[124:127],v[32:35],a[164:167]
ds_read_b64_tr_b16 a[150:151],v5 offset:30848
v_fma_f32 v106,v106,s36,v17
v_mfma_f32_16x16x32_bf16 a[160:163],a[120:123],v[32:35],a[160:163]
ds_read_b64_tr_b16 a[148:149],v5 offset:24704
v_fma_f32 v107,v107,s36,v17
v_mfma_f32_16x16x32_bf16 a[208:211],a[120:123],v[36:39],a[208:211]
ds_read_b64_tr_b16 a[122:123],v2 offset:30976
v_fma_f32 v104,v104,s36,v17
v_mfma_f32_16x16x32_bf16 a[212:215],a[124:127],v[36:39],a[212:215]
s_waitcnt lgkmcnt(6)
ds_read_b64_tr_b16 a[126:127],v3 offset:30976
v_fma_f32 v105,v105,s36,v17
v_mfma_f32_16x16x32_bf16 a[216:219],a[128:131],v[36:39],a[216:219]
ds_read_b64_tr_b16 a[120:121],v2 offset:24832
v_fma_f32 v77,v77,s36,v13
v_mfma_f32_16x16x32_bf16 a[220:223],a[132:135],v[36:39],a[220:223]
ds_read_b64_tr_b16 a[124:125],v3 offset:24832
v_fma_f32 v79,v79,s36,v13
v_mfma_f32_16x16x32_bf16 a[172:175],a[132:135],v[32:35],a[172:175]
v_exp_f32 v91,v91
v_mfma_f32_16x16x32_bf16 a[168:171],a[128:131],v[32:35],a[168:171]
v_exp_f32 v90,v90
v_mfma_f32_16x16x32_bf16 v[120:123],a[128:131],v[28:31],v[120:123]
v_cvt_pk_bf16_f32 v53,v90,v91
v_fma_f32 v76,v76,s36,v13
v_mfma_f32_16x16x32_bf16 v[124:127],a[132:135],v[28:31],v[124:127]
v_exp_f32 v99,v99
v_mfma_f32_16x16x32_bf16 v[220:223],a[132:135],v[24:27],v[220:223]
v_exp_f32 v96,v96
v_mfma_f32_16x16x32_bf16 v[216:219],a[128:131],v[24:27],v[216:219]
v_exp_f32 v98,v98
v_mfma_f32_16x16x32_bf16 v[168:171],a[128:131],v[20:23],v[168:171]
ds_read_b64_tr_b16 a[128:129],v4 offset:24832
v_cvt_pk_bf16_f32 v57,v98,v99
v_mfma_f32_16x16x32_bf16 v[172:175],a[132:135],v[20:23],v[172:175]
ds_read_b64_tr_b16 a[130:131],v4 offset:30976
v_fma_f32 v78,v78,s36,v13
v_mfma_f32_16x16x32_bf16 v[176:179],a[136:139],v[20:23],v[176:179]
s_waitcnt lgkmcnt(2)
ds_read_b64_tr_b16 a[132:133],v5 offset:24832
v_fma_f32 v86,v86,s36,v14
v_mfma_f32_16x16x32_bf16 v[180:183],a[140:143],v[20:23],v[180:183]
ds_read_b64_tr_b16 a[134:135],v5 offset:30976
v_fma_f32 v84,v84,s36,v14
v_mfma_f32_16x16x32_bf16 v[228:231],a[140:143],v[24:27],v[228:231]
v_exp_f32 v97,v97
v_mfma_f32_16x16x32_bf16 v[224:227],a[136:139],v[24:27],v[224:227]
v_cvt_pk_bf16_f32 v56,v96,v97
v_fma_f32 v87,v87,s36,v14
v_mfma_f32_16x16x32_bf16 v[128:131],a[136:139],v[28:31],v[128:131]
v_exp_f32 v104,v104
v_mfma_f32_16x16x32_bf16 v[132:135],a[140:143],v[28:31],v[132:135]
v_exp_f32 v107,v107
v_mfma_f32_16x16x32_bf16 a[180:183],a[140:143],v[32:35],a[180:183]
v_exp_f32 v105,v105
v_mfma_f32_16x16x32_bf16 a[176:179],a[136:139],v[32:35],a[176:179]
v_exp_f32 v106,v106
v_mfma_f32_16x16x32_bf16 a[224:227],a[136:139],v[36:39],a[224:227]
v_cvt_pk_bf16_f32 v41,v106,v107
v_cvt_pk_bf16_f32 v40,v104,v105
v_mfma_f32_16x16x32_bf16 a[228:231],a[140:143],v[36:39],a[228:231]
v_exp_f32 v78,v78
v_mfma_f32_16x16x32_bf16 a[232:235],a[144:147],v[36:39],a[232:235]
v_exp_f32 v79,v79
v_mfma_f32_16x16x32_bf16 a[236:239],a[148:151],v[36:39],a[236:239]
v_exp_f32 v77,v77
v_mfma_f32_16x16x32_bf16 a[188:191],a[148:151],v[32:35],a[188:191]
v_exp_f32 v76,v76
v_mfma_f32_16x16x32_bf16 a[184:187],a[144:147],v[32:35],a[184:187]
v_cvt_pk_bf16_f32 v46,v76,v77
v_cvt_pk_bf16_f32 v47,v78,v79
v_mfma_f32_16x16x32_bf16 v[136:139],a[144:147],v[28:31],v[136:139]
v_exp_f32 v86,v86
v_mfma_f32_16x16x32_bf16 v[140:143],a[148:151],v[28:31],v[140:143]
v_exp_f32 v87,v87
v_mfma_f32_16x16x32_bf16 v[236:239],a[148:151],v[24:27],v[236:239]
v_exp_f32 v84,v84
v_mfma_f32_16x16x32_bf16 v[232:235],a[144:147],v[24:27],v[232:235]
v_fma_f32 v85,v85,s36,v14
v_cvt_pk_bf16_f32 v51,v86,v87
v_mfma_f32_16x16x32_bf16 v[184:187],a[144:147],v[20:23],v[184:187]
v_exp_f32 v85,v85
v_mfma_f32_16x16x32_bf16 v[188:191],a[148:151],v[20:23],v[188:191]
v_cvt_pk_bf16_f32 v50,v84,v85
v_fma_f32 v92,v92,s36,v15
v_mfma_f32_16x16x32_bf16 v[192:195],a[120:123],v[20:23],v[192:195]
v_fma_f32 v94,v94,s36,v15
v_fma_f32 v93,v93,s36,v15
v_smfmac_f32_16x16x64_bf16 v[60:63],a[152:155],v[44:51],v18
v_fma_f32 v95,v95,s36,v15
v_mfma_f32_16x16x32_bf16 v[196:199],a[124:127],v[20:23],v[196:199]
s_waitcnt vmcnt(6) lgkmcnt(0)
v_exp_f32 v94,v94
v_mfma_f32_16x16x32_bf16 v[244:247],a[124:127],v[24:27],v[244:247]
s_barrier
v_mfma_f32_16x16x32_bf16 v[240:243],a[120:123],v[24:27],v[240:243]
ds_read_b128 a[136:139],v0 offset:12288
v_fma_f32 v102,v102,s36,v16
v_mfma_f32_16x16x32_bf16 v[144:147],a[120:123],v[28:31],v[144:147]
ds_read_b128 a[144:147],v0 offset:12416
v_fma_f32 v101,v101,s36,v16
v_mfma_f32_16x16x32_bf16 v[148:151],a[124:127],v[28:31],v[148:151]
ds_read_b128 a[140:143],v1 offset:12288
v_fma_f32 v100,v100,s36,v16
v_mfma_f32_16x16x32_bf16 a[196:199],a[124:127],v[32:35],a[196:199]
ds_read_b128 a[148:151],v1 offset:12416
v_fma_f32 v103,v103,s36,v16
v_mfma_f32_16x16x32_bf16 a[192:195],a[120:123],v[32:35],a[192:195]
ds_read_b128 a[156:159],v10 offset:0
v_fma_f32 v108,v108,s36,v17
v_mfma_f32_16x16x32_bf16 a[240:243],a[120:123],v[36:39],a[240:243]
buffer_load_dwordx4 v6,s[8:11],s21 offen offset:0 lds
v_mfma_f32_16x16x32_bf16 a[244:247],a[124:127],v[36:39],a[244:247]
ds_read_b128 a[120:123],v0 offset:12544
v_fma_f32 v110,v110,s36,v17
v_mfma_f32_16x16x32_bf16 a[248:251],a[128:131],v[36:39],a[248:251]
ds_read_b128 a[124:127],v1 offset:12544
v_fma_f32 v111,v111,s36,v17
v_mfma_f32_16x16x32_bf16 a[252:255],a[132:135],v[36:39],a[252:255]
v_exp_f32 v92,v92
v_mfma_f32_16x16x32_bf16 a[204:207],a[132:135],v[32:35],a[204:207]
v_exp_f32 v95,v95
v_mfma_f32_16x16x32_bf16 a[200:203],a[128:131],v[32:35],a[200:203]
v_cvt_pk_bf16_f32 v55,v94,v95
v_fma_f32 v109,v109,s36,v17
v_mfma_f32_16x16x32_bf16 v[152:155],a[128:131],v[28:31],v[152:155]
v_exp_f32 v93,v93
v_mfma_f32_16x16x32_bf16 v[156:159],a[132:135],v[28:31],v[156:159]
v_cvt_pk_bf16_f32 v54,v92,v93
v_mfma_f32_16x16x32_bf16 v[252:255],a[132:135],v[24:27],v[252:255]
v_exp_f32 v102,v102
v_mfma_f32_16x16x32_bf16 v[248:251],a[128:131],v[24:27],v[248:251]
v_exp_f32 v101,v101
v_mfma_f32_16x16x32_bf16 v[200:203],a[128:131],v[20:23],v[200:203]
ds_read_b128 a[128:131],v0 offset:18432
v_mfma_f32_16x16x32_bf16 v[204:207],a[132:135],v[20:23],v[204:207]
s_waitcnt lgkmcnt(1)
buffer_store_dwordx4 a[156:159],v9,s[16:19],s27 offen offset:0 nt
buffer_load_dwordx4 v7,s[8:11],s21 offen offset:1024 lds
v_mfma_f32_16x16x32_bf16 v[72:75],a[136:139],a[0:3],0
ds_read_b128 a[132:135],v1 offset:18432
v_mfma_f32_16x16x32_bf16 v[72:75],a[140:143],a[4:7],v[72:75]
v_exp_f32 v103,v103
v_mfma_f32_16x16x32_bf16 v[72:75],a[144:147],a[8:11],v[72:75]
v_exp_f32 v100,v100
v_mfma_f32_16x16x32_bf16 v[72:75],a[148:151],a[12:15],v[72:75]
v_cvt_pk_bf16_f32 v59,v102,v103
v_cvt_pk_bf16_f32 v58,v100,v101
v_mfma_f32_16x16x32_bf16 v[72:75],a[120:123],a[16:19],v[72:75]
v_exp_f32 v109,v109
v_smfmac_f32_16x16x64_bf16 v[64:67],a[152:155],v[52:59],v18
ds_read_b128 a[156:159],v10 offset:1024
v_mfma_f32_16x16x32_bf16 v[72:75],a[124:127],a[20:23],v[72:75]
v_exp_f32 v111,v111
v_mfma_f32_16x16x32_bf16 v[80:83],a[124:127],a[44:47],0
v_exp_f32 v108,v108
v_mfma_f32_16x16x32_bf16 v[80:83],a[120:123],a[40:43],v[80:83]
v_exp_f32 v110,v110
v_mfma_f32_16x16x32_bf16 v[80:83],a[148:151],a[36:39],v[80:83]
v_cvt_pk_bf16_f32 v42,v108,v109
v_cvt_pk_bf16_f32 v43,v110,v111
v_mfma_f32_16x16x32_bf16 v[80:83],a[144:147],a[32:35],v[80:83]
buffer_load_dwordx4 v8,s[8:11],s21 offen offset:2048 lds
v_smfmac_f32_16x16x64_bf16 v[68:71],a[152:155],v[36:43],v18
s_add_u32 s21,s21,12288
v_fma_f32 v73,v73,s36,v13
v_mfma_f32_16x16x32_bf16 v[80:83],a[140:143],a[28:31],v[80:83]
s_add_u32 m0,s22,0
v_fma_f32 v72,v72,s36,v13
v_fma_f32 v74,v74,s36,v13
v_mfma_f32_16x16x32_bf16 v[80:83],a[136:139],a[24:27],v[80:83]
v_exp_f32 v73,v73
v_mfma_f32_16x16x32_bf16 v[88:91],a[136:139],a[48:51],0
v_exp_f32 v72,v72
v_mfma_f32_16x16x32_bf16 v[88:91],a[140:143],a[52:55],v[88:91]
v_exp_f32 v74,v74
v_mfma_f32_16x16x32_bf16 v[88:91],a[144:147],a[56:59],v[88:91]
v_fma_f32 v75,v75,s36,v13
v_cvt_pk_bf16_f32 v20,v72,v73
v_mfma_f32_16x16x32_bf16 v[88:91],a[148:151],a[60:63],v[88:91]
v_exp_f32 v75,v75
v_mfma_f32_16x16x32_bf16 v[88:91],a[120:123],a[64:67],v[88:91]
v_fma_f32 v83,v83,s36,v14
v_fma_f32 v81,v81,s36,v14
v_mfma_f32_16x16x32_bf16 v[88:91],a[124:127],a[68:71],v[88:91]
v_exp_f32 v81,v81
v_mfma_f32_16x16x32_bf16 v[96:99],a[124:127],a[92:95],0
v_cvt_pk_bf16_f32 v21,v74,v75
v_fma_f32 v82,v82,s36,v14
v_mfma_f32_16x16x32_bf16 v[96:99],a[120:123],a[88:91],v[96:99]
s_waitcnt lgkmcnt(0)
buffer_store_dwordx4 a[156:159],v9,s[16:19],s27 offen offset:128 nt
buffer_load_dwordx4 v6,s[4:7],s20 offen offset:0 lds
v_mfma_f32_16x16x32_bf16 v[96:99],a[148:151],a[84:87],v[96:99]
v_fma_f32 v88,v88,s36,v15
v_fma_f32 v89,v89,s36,v15
v_mfma_f32_16x16x32_bf16 v[96:99],a[144:147],a[80:83],v[96:99]
v_exp_f32 v89,v89
v_mfma_f32_16x16x32_bf16 v[96:99],a[140:143],a[76:79],v[96:99]
v_exp_f32 v82,v82
v_mfma_f32_16x16x32_bf16 v[96:99],a[136:139],a[72:75],v[96:99]
v_exp_f32 v88,v88
v_mfma_f32_16x16x32_bf16 v[104:107],a[136:139],a[96:99],0
ds_read_b128 a[136:139],v0 offset:18560
v_fma_f32 v80,v80,s36,v14
v_mfma_f32_16x16x32_bf16 v[104:107],a[140:143],a[100:103],v[104:107]
ds_read_b128 a[156:159],v10 offset:2048
v_mfma_f32_16x16x32_bf16 v[104:107],a[144:147],a[104:107],v[104:107]
ds_read_b128 a[140:143],v1 offset:18560
v_mfma_f32_16x16x32_bf16 v[104:107],a[148:151],a[108:111],v[104:107]
ds_read_b128 a[144:147],v0 offset:18688
v_mfma_f32_16x16x32_bf16 v[104:107],a[120:123],a[112:115],v[104:107]
ds_read_b128 a[148:151],v1 offset:18688
v_mfma_f32_16x16x32_bf16 v[104:107],a[124:127],a[116:119],v[104:107]
v_exp_f32 v80,v80
v_mfma_f32_16x16x32_bf16 v[76:79],a[128:131],a[0:3],0
buffer_load_dwordx4 v7,s[4:7],s20 offen offset:1024 lds
v_mfma_f32_16x16x32_bf16 v[76:79],a[132:135],a[4:7],v[76:79]
s_waitcnt lgkmcnt(4)
v_cvt_pk_bf16_f32 v24,v80,v81
v_cvt_pk_bf16_f32 v28,v88,v89
v_mfma_f32_16x16x32_bf16 v[76:79],a[136:139],a[8:11],v[76:79]
s_waitcnt lgkmcnt(2)
v_exp_f32 v83,v83
v_mfma_f32_16x16x32_bf16 v[76:79],a[140:143],a[12:15],v[76:79]
s_waitcnt lgkmcnt(1)
v_cvt_pk_bf16_f32 v25,v82,v83
v_mfma_f32_16x16x32_bf16 v[76:79],a[144:147],a[16:19],v[76:79]
s_waitcnt lgkmcnt(0)
v_mfma_f32_16x16x32_bf16 v[76:79],a[148:151],a[20:23],v[76:79]
v_mfma_f32_16x16x32_bf16 v[84:87],a[148:151],a[44:47],0
v_mfma_f32_16x16x32_bf16 v[84:87],a[144:147],a[40:43],v[84:87]
v_mfma_f32_16x16x32_bf16 v[84:87],a[140:143],a[36:39],v[84:87]
v_mfma_f32_16x16x32_bf16 v[84:87],a[136:139],a[32:35],v[84:87]
v_mfma_f32_16x16x32_bf16 v[84:87],a[132:135],a[28:31],v[84:87]
buffer_store_dwordx4 a[156:159],v9,s[16:19],s27 offen offset:256 nt
buffer_load_dwordx4 v8,s[4:7],s20 offen offset:2048 lds
v_mfma_f32_16x16x32_bf16 v[84:87],a[128:131],a[24:27],v[84:87]
s_add_u32 s20,s20,12288
v_mfma_f32_16x16x32_bf16 v[92:95],a[128:131],a[48:51],0
s_add_u32 s27,s27,3072
v_mfma_f32_16x16x32_bf16 v[92:95],a[132:135],a[52:55],v[92:95]
v_mfma_f32_16x16x32_bf16 v[92:95],a[136:139],a[56:59],v[92:95]
v_mfma_f32_16x16x32_bf16 v[92:95],a[140:143],a[60:63],v[92:95]
ds_read_b64_tr_b16 a[120:121],v2 offset:0
v_mfma_f32_16x16x32_bf16 v[92:95],a[144:147],a[64:67],v[92:95]
ds_read_b64_tr_b16 a[122:123],v2 offset:6144
v_mfma_f32_16x16x32_bf16 v[92:95],a[148:151],a[68:71],v[92:95]
v_mfma_f32_16x16x32_bf16 v[100:103],a[148:151],a[92:95],0
ds_read_b64_tr_b16 a[124:125],v3 offset:0
v_mfma_f32_16x16x32_bf16 v[100:103],a[144:147],a[88:91],v[100:103]
ds_read_b64_tr_b16 a[126:127],v3 offset:6144
v_mfma_f32_16x16x32_bf16 v[100:103],a[140:143],a[84:87],v[100:103]
v_mfma_f32_16x16x32_bf16 v[100:103],a[136:139],a[80:83],v[100:103]
v_mfma_f32_16x16x32_bf16 v[100:103],a[132:135],a[76:79],v[100:103]
v_mfma_f32_16x16x32_bf16 v[100:103],a[128:131],a[72:75],v[100:103]
v_mfma_f32_16x16x32_bf16 v[108:111],a[128:131],a[96:99],0
ds_read_b64_tr_b16 a[130:131],v4 offset:6144
v_mfma_f32_16x16x32_bf16 v[108:111],a[132:135],a[100:103],v[108:111]
ds_read_b64_tr_b16 a[128:129],v4 offset:0
v_mfma_f32_16x16x32_bf16 v[108:111],a[136:139],a[104:107],v[108:111]
ds_read_b64_tr_b16 a[134:135],v5 offset:6144
v_mfma_f32_16x16x32_bf16 v[108:111],a[140:143],a[108:111],v[108:111]
ds_read_b64_tr_b16 a[132:133],v5 offset:0
v_mfma_f32_16x16x32_bf16 v[108:111],a[144:147],a[112:115],v[108:111]
v_mfma_f32_16x16x32_bf16 v[108:111],a[148:151],a[116:119],v[108:111]
s_waitcnt lgkmcnt(4)
v_mfma_f32_16x16x32_bf16 v[160:163],a[120:123],v[44:47],v[160:163]
s_add_u32 m0,s29,0
ds_read_b64_tr_b16 a[136:137],v2 offset:128
v_fma_f32 v90,v90,s36,v15
v_mfma_f32_16x16x32_bf16 v[164:167],a[124:127],v[44:47],v[164:167]
ds_read_b64_tr_b16 a[138:139],v2 offset:6272
v_fma_f32 v91,v91,s36,v15
v_mfma_f32_16x16x32_bf16 v[212:215],a[124:127],v[48:51],v[212:215]
ds_read_b64_tr_b16 a[140:141],v3 offset:128
v_fma_f32 v96,v96,s36,v16
v_mfma_f32_16x16x32_bf16 v[208:211],a[120:123],v[48:51],v[208:211]
ds_read_b64_tr_b16 a[142:143],v3 offset:6272
v_fma_f32 v97,v97,s36,v16
v_mfma_f32_16x16x32_bf16 v[112:115],a[120:123],v[52:55],v[112:115]
ds_read_b64_tr_b16 a[144:145],v4 offset:128
v_fma_f32 v98,v98,s36,v16
v_mfma_f32_16x16x32_bf16 v[116:119],a[124:127],v[52:55],v[116:119]
ds_read_b64_tr_b16 a[146:147],v4 offset:6272
v_fma_f32 v99,v99,s36,v16
v_mfma_f32_16x16x32_bf16 a[164:167],a[124:127],v[56:59],a[164:167]
ds_read_b64_tr_b16 a[148:149],v5 offset:128
v_fma_f32 v104,v104,s36,v17
v_mfma_f32_16x16x32_bf16 a[160:163],a[120:123],v[56:59],a[160:163]
buffer_load_dwordx4 v6,s[12:15],s28 offen offset:0 nt lds
v_mfma_f32_16x16x32_bf16 a[208:211],a[120:123],v[40:43],a[208:211]
ds_read_b64_tr_b16 a[150:151],v5 offset:6272
v_fma_f32 v105,v105,s36,v17
v_mfma_f32_16x16x32_bf16 a[212:215],a[124:127],v[40:43],a[212:215]
s_waitcnt lgkmcnt(5)
ds_read_b64_tr_b16 a[120:121],v2 offset:256
v_fma_f32 v106,v106,s36,v17
v_mfma_f32_16x16x32_bf16 a[216:219],a[128:131],v[40:43],a[216:219]
ds_read_b64_tr_b16 a[122:123],v2 offset:6400
v_fma_f32 v107,v107,s36,v17
v_mfma_f32_16x16x32_bf16 a[220:223],a[132:135],v[40:43],a[220:223]
ds_read_b64_tr_b16 a[124:125],v3 offset:256
v_fma_f32 v76,v76,s36,v13
v_mfma_f32_16x16x32_bf16 a[172:175],a[132:135],v[56:59],a[172:175]
ds_read_b64_tr_b16 a[126:127],v3 offset:6400
v_fma_f32 v77,v77,s36,v13
v_mfma_f32_16x16x32_bf16 a[168:171],a[128:131],v[56:59],a[168:171]
v_exp_f32 v90,v90
v_mfma_f32_16x16x32_bf16 v[120:123],a[128:131],v[52:55],v[120:123]
v_exp_f32 v91,v91
v_mfma_f32_16x16x32_bf16 v[124:127],a[132:135],v[52:55],v[124:127]
v_cvt_pk_bf16_f32 v29,v90,v91
v_fma_f32 v78,v78,s36,v13
v_mfma_f32_16x16x32_bf16 v[220:223],a[132:135],v[48:51],v[220:223]
v_exp_f32 v96,v96
v_mfma_f32_16x16x32_bf16 v[216:219],a[128:131],v[48:51],v[216:219]
buffer_load_dwordx4 v7,s[12:15],s28 offen offset:1024 nt lds
v_mfma_f32_16x16x32_bf16 v[168:171],a[128:131],v[44:47],v[168:171]
ds_read_b64_tr_b16 a[128:129],v4 offset:256
v_fma_f32 v79,v79,s36,v13
v_mfma_f32_16x16x32_bf16 v[172:175],a[132:135],v[44:47],v[172:175]
ds_read_b64_tr_b16 a[130:131],v4 offset:6400
v_fma_f32 v84,v84,s36,v14
v_mfma_f32_16x16x32_bf16 v[176:179],a[136:139],v[44:47],v[176:179]
s_waitcnt lgkmcnt(2)
ds_read_b64_tr_b16 a[132:133],v5 offset:256
v_fma_f32 v85,v85,s36,v14
v_mfma_f32_16x16x32_bf16 v[180:183],a[140:143],v[44:47],v[180:183]
ds_read_b64_tr_b16 a[134:135],v5 offset:6400
v_fma_f32 v86,v86,s36,v14
v_mfma_f32_16x16x32_bf16 v[228:231],a[140:143],v[48:51],v[228:231]
v_exp_f32 v97,v97
v_mfma_f32_16x16x32_bf16 v[224:227],a[136:139],v[48:51],v[224:227]
v_exp_f32 v98,v98
v_mfma_f32_16x16x32_bf16 v[128:131],a[136:139],v[52:55],v[128:131]
v_exp_f32 v99,v99
v_mfma_f32_16x16x32_bf16 v[132:135],a[140:143],v[52:55],v[132:135]
v_cvt_pk_bf16_f32 v32,v96,v97
v_cvt_pk_bf16_f32 v33,v98,v99
v_mfma_f32_16x16x32_bf16 a[180:183],a[140:143],v[56:59],a[180:183]
v_exp_f32 v104,v104
v_mfma_f32_16x16x32_bf16 a[176:179],a[136:139],v[56:59],a[176:179]
buffer_load_dwordx4 v8,s[12:15],s28 offen offset:2048 nt lds
v_mfma_f32_16x16x32_bf16 a[224:227],a[136:139],v[40:43],a[224:227]
s_add_u32 s28,s28,3072
v_exp_f32 v105,v105
v_mfma_f32_16x16x32_bf16 a[228:231],a[140:143],v[40:43],a[228:231]
s_add_u32 s29,s29,3072
v_exp_f32 v106,v106
v_mfma_f32_16x16x32_bf16 a[232:235],a[144:147],v[40:43],a[232:235]
s_add_u32 m0,s23,0
v_exp_f32 v107,v107
v_mfma_f32_16x16x32_bf16 a[236:239],a[148:151],v[40:43],a[236:239]
v_cvt_pk_bf16_f32 v36,v104,v105
v_cvt_pk_bf16_f32 v37,v106,v107
v_mfma_f32_16x16x32_bf16 a[188:191],a[148:151],v[56:59],a[188:191]
v_exp_f32 v76,v76
v_mfma_f32_16x16x32_bf16 a[184:187],a[144:147],v[56:59],a[184:187]
v_exp_f32 v77,v77
v_mfma_f32_16x16x32_bf16 v[136:139],a[144:147],v[52:55],v[136:139]
v_exp_f32 v78,v78
v_mfma_f32_16x16x32_bf16 v[140:143],a[148:151],v[52:55],v[140:143]
v_exp_f32 v79,v79
v_mfma_f32_16x16x32_bf16 v[236:239],a[148:151],v[48:51],v[236:239]
v_cvt_pk_bf16_f32 v22,v76,v77
v_cvt_pk_bf16_f32 v23,v78,v79
v_mfma_f32_16x16x32_bf16 v[232:235],a[144:147],v[48:51],v[232:235]
v_fma_f32 v87,v87,s36,v14
v_fma_f32 v92,v92,s36,v15
v_mfma_f32_16x16x32_bf16 v[184:187],a[144:147],v[44:47],v[184:187]
v_exp_f32 v84,v84
v_mfma_f32_16x16x32_bf16 v[188:191],a[148:151],v[44:47],v[188:191]
v_exp_f32 v85,v85
v_mfma_f32_16x16x32_bf16 v[192:195],a[120:123],v[44:47],v[192:195]
v_exp_f32 v86,v86
v_mfma_f32_16x16x32_bf16 v[196:199],a[124:127],v[44:47],v[196:199]
s_waitcnt vmcnt(12) lgkmcnt(0)
v_exp_f32 v87,v87
v_mfma_f32_16x16x32_bf16 v[244:247],a[124:127],v[48:51],v[244:247]
s_barrier
v_mfma_f32_16x16x32_bf16 v[240:243],a[120:123],v[48:51],v[240:243]
ds_read_b128 a[136:139],v0 offset:24576
v_cvt_pk_bf16_f32 v26,v84,v85
v_mfma_f32_16x16x32_bf16 v[144:147],a[120:123],v[52:55],v[144:147]
ds_read_b128 a[140:143],v1 offset:24576
v_cvt_pk_bf16_f32 v27,v86,v87
v_mfma_f32_16x16x32_bf16 v[148:151],a[124:127],v[52:55],v[148:151]
ds_read_b128 a[144:147],v0 offset:24704
v_fma_f32 v93,v93,s36,v15
v_smfmac_f32_16x16x64_bf16 v[60:63],a[152:155],v[20:27],v18
ds_read_b128 a[148:151],v1 offset:24704
v_mfma_f32_16x16x32_bf16 a[196:199],a[124:127],v[56:59],a[196:199]
v_fma_f32 v94,v94,s36,v15
v_fma_f32 v95,v95,s36,v15
v_mfma_f32_16x16x32_bf16 a[192:195],a[120:123],v[56:59],a[192:195]
buffer_load_dwordx4 v6,s[8:11],s21 offen offset:0 lds
v_mfma_f32_16x16x32_bf16 a[240:243],a[120:123],v[40:43],a[240:243]
ds_read_b128 a[120:123],v0 offset:24832
v_fma_f32 v100,v100,s36,v16
v_mfma_f32_16x16x32_bf16 a[244:247],a[124:127],v[40:43],a[244:247]
ds_read_b128 a[124:127],v1 offset:24832
v_fma_f32 v101,v101,s36,v16
v_mfma_f32_16x16x32_bf16 a[248:251],a[128:131],v[40:43],a[248:251]
v_exp_f32 v92,v92
v_mfma_f32_16x16x32_bf16 a[252:255],a[132:135],v[40:43],a[252:255]
v_exp_f32 v93,v93
v_mfma_f32_16x16x32_bf16 a[204:207],a[132:135],v[56:59],a[204:207]
v_exp_f32 v94,v94
v_mfma_f32_16x16x32_bf16 a[200:203],a[128:131],v[56:59],a[200:203]
v_exp_f32 v95,v95
v_mfma_f32_16x16x32_bf16 v[152:155],a[128:131],v[52:55],v[152:155]
v_cvt_pk_bf16_f32 v30,v92,v93
v_cvt_pk_bf16_f32 v31,v94,v95
v_mfma_f32_16x16x32_bf16 v[156:159],a[132:135],v[52:55],v[156:159]
v_fma_f32 v102,v102,s36,v16
v_fma_f32 v103,v103,s36,v16
v_mfma_f32_16x16x32_bf16 v[252:255],a[132:135],v[48:51],v[252:255]
v_exp_f32 v100,v100
v_mfma_f32_16x16x32_bf16 v[248:251],a[128:131],v[48:51],v[248:251]
v_exp_f32 v101,v101
v_mfma_f32_16x16x32_bf16 v[200:203],a[128:131],v[44:47],v[200:203]
buffer_load_dwordx4 v7,s[8:11],s21 offen offset:1024 lds
v_mfma_f32_16x16x32_bf16 v[204:207],a[132:135],v[44:47],v[204:207]
s_waitcnt lgkmcnt(0)
ds_read_b128 a[128:131],v0 offset:30720
v_cvt_pk_bf16_f32 v34,v100,v101
v_mfma_f32_16x16x32_bf16 v[72:75],a[136:139],a[0:3],0
ds_read_b128 a[132:135],v1 offset:30720
v_fma_f32 v108,v108,s36,v17
v_mfma_f32_16x16x32_bf16 v[72:75],a[140:143],a[4:7],v[72:75]
v_exp_f32 v102,v102
v_mfma_f32_16x16x32_bf16 v[72:75],a[144:147],a[8:11],v[72:75]
v_exp_f32 v103,v103
v_mfma_f32_16x16x32_bf16 v[72:75],a[148:151],a[12:15],v[72:75]
v_cvt_pk_bf16_f32 v35,v102,v103
v_fma_f32 v109,v109,s36,v17
v_mfma_f32_16x16x32_bf16 v[72:75],a[120:123],a[16:19],v[72:75]
v_fma_f32 v110,v110,s36,v17
v_fma_f32 v111,v111,s36,v17
v_smfmac_f32_16x16x64_bf16 v[64:67],a[152:155],v[28:35],v18
v_mfma_f32_16x16x32_bf16 v[72:75],a[124:127],a[20:23],v[72:75]
v_exp_f32 v108,v108
v_mfma_f32_16x16x32_bf16 v[80:83],a[124:127],a[44:47],0
v_exp_f32 v109,v109
v_mfma_f32_16x16x32_bf16 v[80:83],a[120:123],a[40:43],v[80:83]
v_exp_f32 v110,v110
v_mfma_f32_16x16x32_bf16 v[80:83],a[148:151],a[36:39],v[80:83]
v_exp_f32 v111,v111
v_mfma_f32_16x16x32_bf16 v[80:83],a[144:147],a[32:35],v[80:83]
buffer_load_dwordx4 v8,s[8:11],s21 offen offset:2048 lds
v_mfma_f32_16x16x32_bf16 v[80:83],a[140:143],a[28:31],v[80:83]
s_add_u32 s21,s21,12288
v_cvt_pk_bf16_f32 v38,v108,v109
v_cvt_pk_bf16_f32 v39,v110,v111
v_mfma_f32_16x16x32_bf16 v[80:83],a[136:139],a[24:27],v[80:83]
s_add_u32 m0,s22,12288
v_fma_f32 v72,v72,s36,v13
v_fma_f32 v73,v73,s36,v13
v_mfma_f32_16x16x32_bf16 v[88:91],a[136:139],a[48:51],0
v_fma_f32 v74,v74,s36,v13
v_fma_f32 v75,v75,s36,v13
v_mfma_f32_16x16x32_bf16 v[88:91],a[140:143],a[52:55],v[88:91]
v_exp_f32 v72,v72
v_mfma_f32_16x16x32_bf16 v[88:91],a[144:147],a[56:59],v[88:91]
v_fma_f32 v80,v80,s36,v14
v_fma_f32 v81,v81,s36,v14
v_mfma_f32_16x16x32_bf16 v[88:91],a[148:151],a[60:63],v[88:91]
v_fma_f32 v82,v82,s36,v14
v_fma_f32 v83,v83,s36,v14
v_mfma_f32_16x16x32_bf16 v[88:91],a[120:123],a[64:67],v[88:91]
v_exp_f32 v73,v73
v_mfma_f32_16x16x32_bf16 v[88:91],a[124:127],a[68:71],v[88:91]
v_exp_f32 v74,v74
v_mfma_f32_16x16x32_bf16 v[96:99],a[124:127],a[92:95],0
v_exp_f32 v75,v75
v_mfma_f32_16x16x32_bf16 v[96:99],a[120:123],a[88:91],v[96:99]
v_exp_f32 v80,v80
v_mfma_f32_16x16x32_bf16 v[96:99],a[148:151],a[84:87],v[96:99]
buffer_load_dwordx4 v6,s[4:7],s20 offen offset:0 lds
v_mfma_f32_16x16x32_bf16 v[96:99],a[144:147],a[80:83],v[96:99]
v_fma_f32 v88,v88,s36,v15
v_fma_f32 v89,v89,s36,v15
v_mfma_f32_16x16x32_bf16 v[96:99],a[140:143],a[76:79],v[96:99]
v_exp_f32 v81,v81
v_mfma_f32_16x16x32_bf16 v[96:99],a[136:139],a[72:75],v[96:99]
v_exp_f32 v82,v82
v_mfma_f32_16x16x32_bf16 v[104:107],a[136:139],a[96:99],0
ds_read_b128 a[136:139],v0 offset:30848
v_cvt_pk_bf16_f32 v44,v72,v73
v_mfma_f32_16x16x32_bf16 v[104:107],a[140:143],a[100:103],v[104:107]
ds_read_b128 a[140:143],v1 offset:30848
v_cvt_pk_bf16_f32 v45,v74,v75
v_mfma_f32_16x16x32_bf16 v[104:107],a[144:147],a[104:107],v[104:107]
ds_read_b128 a[144:147],v0 offset:30976
v_cvt_pk_bf16_f32 v48,v80,v81
v_mfma_f32_16x16x32_bf16 v[104:107],a[148:151],a[108:111],v[104:107]
ds_read_b128 a[148:151],v1 offset:30976
v_mfma_f32_16x16x32_bf16 v[104:107],a[120:123],a[112:115],v[104:107]
v_exp_f32 v83,v83
v_mfma_f32_16x16x32_bf16 v[104:107],a[124:127],a[116:119],v[104:107]
s_waitcnt lgkmcnt(4)
v_exp_f32 v88,v88
v_mfma_f32_16x16x32_bf16 v[76:79],a[128:131],a[0:3],0
v_exp_f32 v89,v89
v_mfma_f32_16x16x32_bf16 v[76:79],a[132:135],a[4:7],v[76:79]
buffer_load_dwordx4 v7,s[4:7],s20 offen offset:1024 lds
s_waitcnt lgkmcnt(3)
v_mfma_f32_16x16x32_bf16 v[76:79],a[136:139],a[8:11],v[76:79]
s_waitcnt lgkmcnt(2)
v_cvt_pk_bf16_f32 v49,v82,v83
v_cvt_pk_bf16_f32 v52,v88,v89
v_mfma_f32_16x16x32_bf16 v[76:79],a[140:143],a[12:15],v[76:79]
s_waitcnt lgkmcnt(0)
v_mfma_f32_16x16x32_bf16 v[76:79],a[144:147],a[16:19],v[76:79]
v_mfma_f32_16x16x32_bf16 v[76:79],a[148:151],a[20:23],v[76:79]
v_mfma_f32_16x16x32_bf16 v[84:87],a[148:151],a[44:47],0
v_mfma_f32_16x16x32_bf16 v[84:87],a[144:147],a[40:43],v[84:87]
v_mfma_f32_16x16x32_bf16 v[84:87],a[140:143],a[36:39],v[84:87]
v_mfma_f32_16x16x32_bf16 v[84:87],a[136:139],a[32:35],v[84:87]
v_mfma_f32_16x16x32_bf16 v[84:87],a[132:135],a[28:31],v[84:87]
v_mfma_f32_16x16x32_bf16 v[84:87],a[128:131],a[24:27],v[84:87]
v_mfma_f32_16x16x32_bf16 v[92:95],a[128:131],a[48:51],0
v_mfma_f32_16x16x32_bf16 v[92:95],a[132:135],a[52:55],v[92:95]
buffer_load_dwordx4 v8,s[4:7],s20 offen offset:2048 lds
v_mfma_f32_16x16x32_bf16 v[92:95],a[136:139],a[56:59],v[92:95]
s_add_u32 s20,s20,12288
v_mfma_f32_16x16x32_bf16 v[92:95],a[140:143],a[60:63],v[92:95]
v_mfma_f32_16x16x32_bf16 v[92:95],a[144:147],a[64:67],v[92:95]
v_mfma_f32_16x16x32_bf16 v[92:95],a[148:151],a[68:71],v[92:95]
v_mfma_f32_16x16x32_bf16 v[100:103],a[148:151],a[92:95],0
ds_read_b64_tr_b16 a[120:121],v2 offset:12288
v_mfma_f32_16x16x32_bf16 v[100:103],a[144:147],a[88:91],v[100:103]
ds_read_b64_tr_b16 a[122:123],v2 offset:18432
v_mfma_f32_16x16x32_bf16 v[100:103],a[140:143],a[84:87],v[100:103]
v_mfma_f32_16x16x32_bf16 v[100:103],a[136:139],a[80:83],v[100:103]
ds_read_b64_tr_b16 a[124:125],v3 offset:12288
v_mfma_f32_16x16x32_bf16 v[100:103],a[132:135],a[76:79],v[100:103]
ds_read_b64_tr_b16 a[126:127],v3 offset:18432
v_mfma_f32_16x16x32_bf16 v[100:103],a[128:131],a[72:75],v[100:103]
v_mfma_f32_16x16x32_bf16 v[108:111],a[128:131],a[96:99],0
ds_read_b64_tr_b16 a[128:129],v4 offset:12288
v_mfma_f32_16x16x32_bf16 v[108:111],a[132:135],a[100:103],v[108:111]
ds_read_b64_tr_b16 a[130:131],v4 offset:18432
v_mfma_f32_16x16x32_bf16 v[108:111],a[136:139],a[104:107],v[108:111]
ds_read_b64_tr_b16 a[132:133],v5 offset:12288
v_mfma_f32_16x16x32_bf16 v[108:111],a[140:143],a[108:111],v[108:111]
ds_read_b64_tr_b16 a[134:135],v5 offset:18432
v_mfma_f32_16x16x32_bf16 v[108:111],a[144:147],a[112:115],v[108:111]
v_mfma_f32_16x16x32_bf16 v[108:111],a[148:151],a[116:119],v[108:111]
s_waitcnt lgkmcnt(4)
v_mfma_f32_16x16x32_bf16 v[160:163],a[120:123],v[20:23],v[160:163]
s_add_u32 m0,s23,12288
ds_read_b64_tr_b16 a[136:137],v2 offset:12416
v_mbcnt_lo_u32_b32 v19,-1,0
v_mfma_f32_16x16x32_bf16 v[164:167],a[124:127],v[20:23],v[164:167]
ds_read_b64_tr_b16 a[138:139],v2 offset:18560
v_mbcnt_hi_u32_b32 v19,-1,v19
v_mfma_f32_16x16x32_bf16 v[212:215],a[124:127],v[24:27],v[212:215]
ds_read_b64_tr_b16 a[140:141],v3 offset:12416
v_min_u32 v19,7,v19
v_mfma_f32_16x16x32_bf16 v[208:211],a[120:123],v[24:27],v[208:211]
ds_read_b64_tr_b16 a[142:143],v3 offset:18560
v_lshl_add_u32 v19,v19,7,s48
v_mfma_f32_16x16x32_bf16 v[112:115],a[120:123],v[28:31],v[112:115]
ds_read_b64_tr_b16 a[144:145],v4 offset:12416
v_min_u32 v19,L_codeend-L_first-4,v19
v_mfma_f32_16x16x32_bf16 v[116:119],a[124:127],v[28:31],v[116:119]
ds_read_b64_tr_b16 a[146:147],v4 offset:18560
v_fma_f32 v90,v90,s36,v15
v_mfma_f32_16x16x32_bf16 a[164:167],a[124:127],v[32:35],a[164:167]
ds_read_b64_tr_b16 a[148:149],v5 offset:12416
v_fma_f32 v91,v91,s36,v15
v_mfma_f32_16x16x32_bf16 a[160:163],a[120:123],v[32:35],a[160:163]
ds_read_b64_tr_b16 a[150:151],v5 offset:18560
v_fma_f32 v96,v96,s36,v16
v_mfma_f32_16x16x32_bf16 a[208:211],a[120:123],v[36:39],a[208:211]
ds_read_b64_tr_b16 a[120:121],v2 offset:12544
v_fma_f32 v97,v97,s36,v16
v_mfma_f32_16x16x32_bf16 a[212:215],a[124:127],v[36:39],a[212:215]
s_waitcnt lgkmcnt(6)
ds_read_b64_tr_b16 a[122:123],v2 offset:18688
v_fma_f32 v98,v98,s36,v16
v_mfma_f32_16x16x32_bf16 a[216:219],a[128:131],v[36:39],a[216:219]
ds_read_b64_tr_b16 a[124:125],v3 offset:12544
v_fma_f32 v99,v99,s36,v16
v_mfma_f32_16x16x32_bf16 a[220:223],a[132:135],v[36:39],a[220:223]
ds_read_b64_tr_b16 a[126:127],v3 offset:18688
v_fma_f32 v104,v104,s36,v17
v_mfma_f32_16x16x32_bf16 a[172:175],a[132:135],v[32:35],a[172:175]
v_exp_f32 v90,v90
v_mfma_f32_16x16x32_bf16 a[168:171],a[128:131],v[32:35],a[168:171]
v_exp_f32 v91,v91
v_mfma_f32_16x16x32_bf16 v[120:123],a[128:131],v[28:31],v[120:123]
v_cvt_pk_bf16_f32 v53,v90,v91
v_fma_f32 v105,v105,s36,v17
v_mfma_f32_16x16x32_bf16 v[124:127],a[132:135],v[28:31],v[124:127]
v_exp_f32 v96,v96
v_mfma_f32_16x16x32_bf16 v[220:223],a[132:135],v[24:27],v[220:223]
v_exp_f32 v97,v97
v_mfma_f32_16x16x32_bf16 v[216:219],a[128:131],v[24:27],v[216:219]
v_exp_f32 v98,v98
v_mfma_f32_16x16x32_bf16 v[168:171],a[128:131],v[20:23],v[168:171]
global_load_dword v19,v19,s[46:47]
v_mfma_f32_16x16x32_bf16 v[172:175],a[132:135],v[20:23],v[172:175]
ds_read_b64_tr_b16 a[128:129],v4 offset:12544
v_cvt_pk_bf16_f32 v56,v96,v97
v_mfma_f32_16x16x32_bf16 v[176:179],a[136:139],v[20:23],v[176:179]
s_waitcnt lgkmcnt(1)
ds_read_b64_tr_b16 a[130:131],v4 offset:18688
v_fma_f32 v106,v106,s36,v17
v_mfma_f32_16x16x32_bf16 v[180:183],a[140:143],v[20:23],v[180:183]
ds_read_b64_tr_b16 a[132:133],v5 offset:12544
v_fma_f32 v107,v107,s36,v17
v_mfma_f32_16x16x32_bf16 v[228:231],a[140:143],v[24:27],v[228:231]
ds_read_b64_tr_b16 a[134:135],v5 offset:18688
v_fma_f32 v76,v76,s36,v13
v_mfma_f32_16x16x32_bf16 v[224:227],a[136:139],v[24:27],v[224:227]
v_exp_f32 v99,v99
v_mfma_f32_16x16x32_bf16 v[128:131],a[136:139],v[28:31],v[128:131]
v_cvt_pk_bf16_f32 v57,v98,v99
v_fma_f32 v77,v77,s36,v13
v_mfma_f32_16x16x32_bf16 v[132:135],a[140:143],v[28:31],v[132:135]
v_exp_f32 v104,v104
v_mfma_f32_16x16x32_bf16 a[180:183],a[140:143],v[32:35],a[180:183]
v_exp_f32 v105,v105
v_mfma_f32_16x16x32_bf16 a[176:179],a[136:139],v[32:35],a[176:179]
v_exp_f32 v106,v106
v_mfma_f32_16x16x32_bf16 a[224:227],a[136:139],v[36:39],a[224:227]
v_exp_f32 v107,v107
v_mfma_f32_16x16x32_bf16 a[228:231],a[140:143],v[36:39],a[228:231]
v_cvt_pk_bf16_f32 v40,v104,v105
v_cvt_pk_bf16_f32 v41,v106,v107
v_mfma_f32_16x16x32_bf16 a[232:235],a[144:147],v[36:39],a[232:235]
v_fma_f32 v78,v78,s36,v13
v_fma_f32 v79,v79,s36,v13
v_mfma_f32_16x16x32_bf16 a[236:239],a[148:151],v[36:39],a[236:239]
v_exp_f32 v76,v76
v_mfma_f32_16x16x32_bf16 a[188:191],a[148:151],v[32:35],a[188:191]
v_exp_f32 v77,v77
v_mfma_f32_16x16x32_bf16 a[184:187],a[144:147],v[32:35],a[184:187]
v_exp_f32 v78,v78
v_mfma_f32_16x16x32_bf16 v[136:139],a[144:147],v[28:31],v[136:139]
v_exp_f32 v79,v79
v_mfma_f32_16x16x32_bf16 v[140:143],a[148:151],v[28:31],v[140:143]
v_cvt_pk_bf16_f32 v46,v76,v77
v_cvt_pk_bf16_f32 v47,v78,v79
v_mfma_f32_16x16x32_bf16 v[236:239],a[148:151],v[24:27],v[236:239]
v_fma_f32 v84,v84,s36,v14
v_fma_f32 v85,v85,s36,v14
v_mfma_f32_16x16x32_bf16 v[232:235],a[144:147],v[24:27],v[232:235]
v_fma_f32 v86,v86,s36,v14
v_fma_f32 v87,v87,s36,v14
v_mfma_f32_16x16x32_bf16 v[184:187],a[144:147],v[20:23],v[184:187]
v_exp_f32 v84,v84
v_mfma_f32_16x16x32_bf16 v[188:191],a[148:151],v[20:23],v[188:191]
v_exp_f32 v85,v85
v_mfma_f32_16x16x32_bf16 v[192:195],a[120:123],v[20:23],v[192:195]
v_exp_f32 v86,v86
v_mfma_f32_16x16x32_bf16 v[196:199],a[124:127],v[20:23],v[196:199]
s_waitcnt vmcnt(10) lgkmcnt(0)
v_cvt_pk_bf16_f32 v50,v84,v85
v_mfma_f32_16x16x32_bf16 v[244:247],a[124:127],v[24:27],v[244:247]
s_barrier
v_mfma_f32_16x16x32_bf16 v[240:243],a[120:123],v[24:27],v[240:243]
ds_read_b128 a[136:139],v0 offset:0
v_fma_f32 v92,v92,s36,v15
v_mfma_f32_16x16x32_bf16 v[144:147],a[120:123],v[28:31],v[144:147]
ds_read_b128 a[140:143],v1 offset:0
v_fma_f32 v93,v93,s36,v15
v_mfma_f32_16x16x32_bf16 v[148:151],a[124:127],v[28:31],v[148:151]
ds_read_b128 a[144:147],v0 offset:128
v_fma_f32 v94,v94,s36,v15
v_mfma_f32_16x16x32_bf16 a[196:199],a[124:127],v[32:35],a[196:199]
ds_read_b128 a[148:151],v1 offset:128
v_fma_f32 v95,v95,s36,v15
v_mfma_f32_16x16x32_bf16 a[192:195],a[120:123],v[32:35],a[192:195]
ds_read_b128 a[156:159],v10 offset:3072
v_fma_f32 v100,v100,s36,v16
v_mfma_f32_16x16x32_bf16 a[240:243],a[120:123],v[36:39],a[240:243]
buffer_load_dwordx4 v6,s[8:11],s21 offen offset:0 lds
v_mfma_f32_16x16x32_bf16 a[244:247],a[124:127],v[36:39],a[244:247]
ds_read_b128 a[120:123],v0 offset:256
v_fma_f32 v101,v101,s36,v16
v_mfma_f32_16x16x32_bf16 a[248:251],a[128:131],v[36:39],a[248:251]
ds_read_b128 a[124:127],v1 offset:256
v_fma_f32 v102,v102,s36,v16
v_mfma_f32_16x16x32_bf16 a[252:255],a[132:135],v[36:39],a[252:255]
v_exp_f32 v87,v87
v_mfma_f32_16x16x32_bf16 a[204:207],a[132:135],v[32:35],a[204:207]
v_cvt_pk_bf16_f32 v51,v86,v87
v_fma_f32 v103,v103,s36,v16
v_mfma_f32_16x16x32_bf16 a[200:203],a[128:131],v[32:35],a[200:203]
v_exp_f32 v92,v92
v_smfmac_f32_16x16x64_bf16 v[60:63],a[152:155],v[44:51],v18
v_fma_f32 v108,v108,s36,v17
v_mfma_f32_16x16x32_bf16 v[152:155],a[128:131],v[28:31],v[152:155]
v_exp_f32 v93,v93
v_mfma_f32_16x16x32_bf16 v[156:159],a[132:135],v[28:31],v[156:159]
v_exp_f32 v94,v94
v_mfma_f32_16x16x32_bf16 v[252:255],a[132:135],v[24:27],v[252:255]
v_exp_f32 v95,v95
v_mfma_f32_16x16x32_bf16 v[248:251],a[128:131],v[24:27],v[248:251]
v_cvt_pk_bf16_f32 v54,v92,v93
v_cvt_pk_bf16_f32 v55,v94,v95
v_mfma_f32_16x16x32_bf16 v[200:203],a[128:131],v[20:23],v[200:203]
ds_read_b128 a[128:131],v0 offset:6144
v_fma_f32 v109,v109,s36,v17
v_mfma_f32_16x16x32_bf16 v[204:207],a[132:135],v[20:23],v[204:207]
s_waitcnt lgkmcnt(1)
buffer_store_dwordx4 a[156:159],v9,s[16:19],s27 offen offset:0 nt
buffer_load_dwordx4 v7,s[8:11],s21 offen offset:1024 lds
v_mfma_f32_16x16x32_bf16 v[72:75],a[136:139],a[0:3],0
ds_read_b128 a[132:135],v1 offset:6144
v_fma_f32 v110,v110,s36,v17
v_mfma_f32_16x16x32_bf16 v[72:75],a[140:143],a[4:7],v[72:75]
v_exp_f32 v100,v100
v_mfma_f32_16x16x32_bf16 v[72:75],a[144:147],a[8:11],v[72:75]
v_exp_f32 v101,v101
v_mfma_f32_16x16x32_bf16 v[72:75],a[148:151],a[12:15],v[72:75]
v_exp_f32 v102,v102
v_mfma_f32_16x16x32_bf16 v[72:75],a[120:123],a[16:19],v[72:75]
v_exp_f32 v103,v103
v_mfma_f32_16x16x32_bf16 v[72:75],a[124:127],a[20:23],v[72:75]
ds_read_b128 a[156:159],v10 offset:4096
v_cvt_pk_bf16_f32 v58,v100,v101
v_mfma_f32_16x16x32_bf16 v[80:83],a[124:127],a[44:47],0
v_cvt_pk_bf16_f32 v59,v102,v103
v_fma_f32 v111,v111,s36,v17
v_mfma_f32_16x16x32_bf16 v[80:83],a[120:123],a[40:43],v[80:83]
v_exp_f32 v108,v108
v_smfmac_f32_16x16x64_bf16 v[64:67],a[152:155],v[52:59],v18
v_fma_f32 v72,v72,s36,v13
v_mfma_f32_16x16x32_bf16 v[80:83],a[148:151],a[36:39],v[80:83]
buffer_load_dwordx4 v8,s[8:11],s21 offen offset:2048 lds
v_mfma_f32_16x16x32_bf16 v[80:83],a[144:147],a[32:35],v[80:83]
s_add_u32 s21,s21,12288
v_exp_f32 v109,v109
v_mfma_f32_16x16x32_bf16 v[80:83],a[140:143],a[28:31],v[80:83]
s_add_u32 m0,s22,24576
v_exp_f32 v110,v110
v_mfma_f32_16x16x32_bf16 v[80:83],a[136:139],a[24:27],v[80:83]
v_exp_f32 v111,v111
v_mfma_f32_16x16x32_bf16 v[88:91],a[136:139],a[48:51],0
v_cvt_pk_bf16_f32 v42,v108,v109
v_cvt_pk_bf16_f32 v43,v110,v111
v_mfma_f32_16x16x32_bf16 v[88:91],a[140:143],a[52:55],v[88:91]
v_fma_f32 v73,v73,s36,v13
v_fma_f32 v74,v74,s36,v13
v_smfmac_f32_16x16x64_bf16 v[68:71],a[152:155],v[36:43],v18
v_fma_f32 v75,v75,s36,v13
v_mfma_f32_16x16x32_bf16 v[88:91],a[144:147],a[56:59],v[88:91]
v_fma_f32 v80,v80,s36,v14
v_fma_f32 v81,v81,s36,v14
v_mfma_f32_16x16x32_bf16 v[88:91],a[148:151],a[60:63],v[88:91]
v_fma_f32 v82,v82,s36,v14
v_fma_f32 v83,v83,s36,v14
v_mfma_f32_16x16x32_bf16 v[88:91],a[120:123],a[64:67],v[88:91]
v_exp_f32 v72,v72
v_mfma_f32_16x16x32_bf16 v[88:91],a[124:127],a[68:71],v[88:91]
v_exp_f32 v73,v73
v_mfma_f32_16x16x32_bf16 v[96:99],a[124:127],a[92:95],0
v_exp_f32 v74,v74
v_mfma_f32_16x16x32_bf16 v[96:99],a[120:123],a[88:91],v[96:99]
s_waitcnt lgkmcnt(0)
buffer_store_dwordx4 a[156:159],v9,s[16:19],s27 offen offset:128 nt
buffer_load_dwordx4 v6,s[4:7],s20 offen offset:0 lds
v_mfma_f32_16x16x32_bf16 v[96:99],a[148:151],a[84:87],v[96:99]
v_exp_f32 v75,v75
v_mfma_f32_16x16x32_bf16 v[96:99],a[144:147],a[80:83],v[96:99]
v_fma_f32 v88,v88,s36,v15
v_fma_f32 v89,v89,s36,v15
v_mfma_f32_16x16x32_bf16 v[96:99],a[140:143],a[76:79],v[96:99]
v_exp_f32 v80,v80
v_mfma_f32_16x16x32_bf16 v[96:99],a[136:139],a[72:75],v[96:99]
v_exp_f32 v81,v81
v_mfma_f32_16x16x32_bf16 v[104:107],a[136:139],a[96:99],0
ds_read_b128 a[136:139],v0 offset:6272
v_cvt_pk_bf16_f32 v20,v72,v73
v_mfma_f32_16x16x32_bf16 v[104:107],a[140:143],a[100:103],v[104:107]
ds_read_b128 a[156:159],v10 offset:5120
v_cvt_pk_bf16_f32 v21,v74,v75
v_mfma_f32_16x16x32_bf16 v[104:107],a[144:147],a[104:107],v[104:107]
ds_read_b128 a[140:143],v1 offset:6272
v_cvt_pk_bf16_f32 v24,v80,v81
v_mfma_f32_16x16x32_bf16 v[104:107],a[148:151],a[108:111],v[104:107]
ds_read_b128 a[144:147],v0 offset:6400
v_mfma_f32_16x16x32_bf16 v[104:107],a[120:123],a[112:115],v[104:107]
ds_read_b128 a[148:151],v1 offset:6400
v_mfma_f32_16x16x32_bf16 v[104:107],a[124:127],a[116:119],v[104:107]
buffer_load_dwordx4 v7,s[4:7],s20 offen offset:1024 lds
v_mfma_f32_16x16x32_bf16 v[76:79],a[128:131],a[0:3],0
v_exp_f32 v82,v82
v_mfma_f32_16x16x32_bf16 v[76:79],a[132:135],a[4:7],v[76:79]
s_waitcnt lgkmcnt(4)
v_exp_f32 v83,v83
v_mfma_f32_16x16x32_bf16 v[76:79],a[136:139],a[8:11],v[76:79]
s_waitcnt lgkmcnt(2)
v_exp_f32 v88,v88
v_exp_f32 v89,v89
v_mfma_f32_16x16x32_bf16 v[76:79],a[140:143],a[12:15],v[76:79]
s_waitcnt lgkmcnt(1)
v_cvt_pk_bf16_f32 v25,v82,v83
v_cvt_pk_bf16_f32 v28,v88,v89
v_mfma_f32_16x16x32_bf16 v[76:79],a[144:147],a[16:19],v[76:79]
s_waitcnt lgkmcnt(0)
v_mfma_f32_16x16x32_bf16 v[76:79],a[148:151],a[20:23],v[76:79]
v_mfma_f32_16x16x32_bf16 v[84:87],a[148:151],a[44:47],0
v_mfma_f32_16x16x32_bf16 v[84:87],a[144:147],a[40:43],v[84:87]
v_mfma_f32_16x16x32_bf16 v[84:87],a[140:143],a[36:39],v[84:87]
v_mfma_f32_16x16x32_bf16 v[84:87],a[136:139],a[32:35],v[84:87]
v_mfma_f32_16x16x32_bf16 v[84:87],a[132:135],a[28:31],v[84:87]
buffer_store_dwordx4 a[156:159],v9,s[16:19],s27 offen offset:256 nt
buffer_load_dwordx4 v8,s[4:7],s20 offen offset:2048 lds
v_mfma_f32_16x16x32_bf16 v[84:87],a[128:131],a[24:27],v[84:87]
s_add_u32 s20,s20,12288
v_mfma_f32_16x16x32_bf16 v[92:95],a[128:131],a[48:51],0
s_add_u32 s27,s27,3072
v_mfma_f32_16x16x32_bf16 v[92:95],a[132:135],a[52:55],v[92:95]
v_mfma_f32_16x16x32_bf16 v[92:95],a[136:139],a[56:59],v[92:95]
v_mfma_f32_16x16x32_bf16 v[92:95],a[140:143],a[60:63],v[92:95]
ds_read_b64_tr_b16 a[120:121],v2 offset:24576
v_mfma_f32_16x16x32_bf16 v[92:95],a[144:147],a[64:67],v[92:95]
ds_read_b64_tr_b16 a[122:123],v2 offset:30720
v_mfma_f32_16x16x32_bf16 v[92:95],a[148:151],a[68:71],v[92:95]
v_mfma_f32_16x16x32_bf16 v[100:103],a[148:151],a[92:95],0
ds_read_b64_tr_b16 a[124:125],v3 offset:24576
v_mfma_f32_16x16x32_bf16 v[100:103],a[144:147],a[88:91],v[100:103]
ds_read_b64_tr_b16 a[126:127],v3 offset:30720
v_mfma_f32_16x16x32_bf16 v[100:103],a[140:143],a[84:87],v[100:103]
v_mfma_f32_16x16x32_bf16 v[100:103],a[136:139],a[80:83],v[100:103]
v_mfma_f32_16x16x32_bf16 v[100:103],a[132:135],a[76:79],v[100:103]
v_mfma_f32_16x16x32_bf16 v[100:103],a[128:131],a[72:75],v[100:103]
v_mfma_f32_16x16x32_bf16 v[108:111],a[128:131],a[96:99],0
ds_read_b64_tr_b16 a[128:129],v4 offset:24576
v_mfma_f32_16x16x32_bf16 v[108:111],a[132:135],a[100:103],v[108:111]
ds_read_b64_tr_b16 a[130:131],v4 offset:30720
v_mfma_f32_16x16x32_bf16 v[108:111],a[136:139],a[104:107],v[108:111]
ds_read_b64_tr_b16 a[132:133],v5 offset:24576
v_mfma_f32_16x16x32_bf16 v[108:111],a[140:143],a[108:111],v[108:111]
ds_read_b64_tr_b16 a[134:135],v5 offset:30720
v_mfma_f32_16x16x32_bf16 v[108:111],a[144:147],a[112:115],v[108:111]
v_mfma_f32_16x16x32_bf16 v[108:111],a[148:151],a[116:119],v[108:111]
s_waitcnt lgkmcnt(4)
v_mfma_f32_16x16x32_bf16 v[160:163],a[120:123],v[44:47],v[160:163]
s_add_u32 m0,s29,0
ds_read_b64_tr_b16 a[136:137],v2 offset:24704
v_fma_f32 v90,v90,s36,v15
v_mfma_f32_16x16x32_bf16 v[164:167],a[124:127],v[44:47],v[164:167]
ds_read_b64_tr_b16 a[138:139],v2 offset:30848
v_fma_f32 v91,v91,s36,v15
v_mfma_f32_16x16x32_bf16 v[212:215],a[124:127],v[48:51],v[212:215]
ds_read_b64_tr_b16 a[140:141],v3 offset:24704
v_fma_f32 v96,v96,s36,v16
v_mfma_f32_16x16x32_bf16 v[208:211],a[120:123],v[48:51],v[208:211]
ds_read_b64_tr_b16 a[142:143],v3 offset:30848
v_fma_f32 v97,v97,s36,v16
v_mfma_f32_16x16x32_bf16 v[112:115],a[120:123],v[52:55],v[112:115]
ds_read_b64_tr_b16 a[144:145],v4 offset:24704
v_fma_f32 v98,v98,s36,v16
v_mfma_f32_16x16x32_bf16 v[116:119],a[124:127],v[52:55],v[116:119]
ds_read_b64_tr_b16 a[146:147],v4 offset:30848
v_fma_f32 v99,v99,s36,v16
v_mfma_f32_16x16x32_bf16 a[164:167],a[124:127],v[56:59],a[164:167]
ds_read_b64_tr_b16 a[148:149],v5 offset:24704
v_fma_f32 v104,v104,s36,v17
v_mfma_f32_16x16x32_bf16 a[160:163],a[120:123],v[56:59],a[160:163]
buffer_load_dwordx4 v6,s[12:15],s28 offen offset:0 nt lds
v_mfma_f32_16x16x32_bf16 a[208:211],a[120:123],v[40:43],a[208:211]
ds_read_b64_tr_b16 a[150:151],v5 offset:30848
v_fma_f32 v105,v105,s36,v17
v_mfma_f32_16x16x32_bf16 a[212:215],a[124:127],v[40:43],a[212:215]
s_waitcnt lgkmcnt(5)
ds_read_b64_tr_b16 a[120:121],v2 offset:24832
v_fma_f32 v106,v106,s36,v17
v_mfma_f32_16x16x32_bf16 a[216:219],a[128:131],v[40:43],a[216:219]
ds_read_b64_tr_b16 a[122:123],v2 offset:30976
v_fma_f32 v107,v107,s36,v17
v_mfma_f32_16x16x32_bf16 a[220:223],a[132:135],v[40:43],a[220:223]
ds_read_b64_tr_b16 a[124:125],v3 offset:24832
v_fma_f32 v76,v76,s36,v13
v_mfma_f32_16x16x32_bf16 a[172:175],a[132:135],v[56:59],a[172:175]
ds_read_b64_tr_b16 a[126:127],v3 offset:30976
v_fma_f32 v77,v77,s36,v13
v_mfma_f32_16x16x32_bf16 a[168:171],a[128:131],v[56:59],a[168:171]
v_exp_f32 v90,v90
v_mfma_f32_16x16x32_bf16 v[120:123],a[128:131],v[52:55],v[120:123]
v_exp_f32 v91,v91
v_mfma_f32_16x16x32_bf16 v[124:127],a[132:135],v[52:55],v[124:127]
v_cvt_pk_bf16_f32 v29,v90,v91
v_fma_f32 v78,v78,s36,v13
v_mfma_f32_16x16x32_bf16 v[220:223],a[132:135],v[48:51],v[220:223]
v_exp_f32 v96,v96
v_mfma_f32_16x16x32_bf16 v[216:219],a[128:131],v[48:51],v[216:219]
buffer_load_dwordx4 v7,s[12:15],s28 offen offset:1024 nt lds
v_mfma_f32_16x16x32_bf16 v[168:171],a[128:131],v[44:47],v[168:171]
ds_read_b64_tr_b16 a[128:129],v4 offset:24832
v_fma_f32 v79,v79,s36,v13
v_mfma_f32_16x16x32_bf16 v[172:175],a[132:135],v[44:47],v[172:175]
ds_read_b64_tr_b16 a[130:131],v4 offset:30976
v_fma_f32 v84,v84,s36,v14
v_mfma_f32_16x16x32_bf16 v[176:179],a[136:139],v[44:47],v[176:179]
s_waitcnt lgkmcnt(2)
ds_read_b64_tr_b16 a[132:133],v5 offset:24832
v_fma_f32 v85,v85,s36,v14
v_mfma_f32_16x16x32_bf16 v[180:183],a[140:143],v[44:47],v[180:183]
ds_read_b64_tr_b16 a[134:135],v5 offset:30976
v_fma_f32 v86,v86,s36,v14
v_mfma_f32_16x16x32_bf16 v[228:231],a[140:143],v[48:51],v[228:231]
v_exp_f32 v97,v97
v_mfma_f32_16x16x32_bf16 v[224:227],a[136:139],v[48:51],v[224:227]
v_exp_f32 v98,v98
v_mfma_f32_16x16x32_bf16 v[128:131],a[136:139],v[52:55],v[128:131]
v_exp_f32 v99,v99
v_mfma_f32_16x16x32_bf16 v[132:135],a[140:143],v[52:55],v[132:135]
v_cvt_pk_bf16_f32 v32,v96,v97
v_cvt_pk_bf16_f32 v33,v98,v99
v_mfma_f32_16x16x32_bf16 a[180:183],a[140:143],v[56:59],a[180:183]
v_exp_f32 v104,v104
v_mfma_f32_16x16x32_bf16 a[176:179],a[136:139],v[56:59],a[176:179]
buffer_load_dwordx4 v8,s[12:15],s28 offen offset:2048 nt lds
v_mfma_f32_16x16x32_bf16 a[224:227],a[136:139],v[40:43],a[224:227]
s_add_u32 s28,s28,3072
v_exp_f32 v105,v105
v_mfma_f32_16x16x32_bf16 a[228:231],a[140:143],v[40:43],a[228:231]
s_add_u32 s29,s29,3072
v_exp_f32 v106,v106
v_mfma_f32_16x16x32_bf16 a[232:235],a[144:147],v[40:43],a[232:235]
s_add_u32 m0,s23,24576
v_exp_f32 v107,v107
v_mfma_f32_16x16x32_bf16 a[236:239],a[148:151],v[40:43],a[236:239]
v_cvt_pk_bf16_f32 v36,v104,v105
v_cvt_pk_bf16_f32 v37,v106,v107
v_mfma_f32_16x16x32_bf16 a[188:191],a[148:151],v[56:59],a[188:191]
v_exp_f32 v76,v76
v_mfma_f32_16x16x32_bf16 a[184:187],a[144:147],v[56:59],a[184:187]
v_exp_f32 v77,v77
v_mfma_f32_16x16x32_bf16 v[136:139],a[144:147],v[52:55],v[136:139]
v_exp_f32 v78,v78
v_mfma_f32_16x16x32_bf16 v[140:143],a[148:151],v[52:55],v[140:143]
v_exp_f32 v79,v79
v_mfma_f32_16x16x32_bf16 v[236:239],a[148:151],v[48:51],v[236:239]
v_cvt_pk_bf16_f32 v22,v76,v77
v_cvt_pk_bf16_f32 v23,v78,v79
v_mfma_f32_16x16x32_bf16 v[232:235],a[144:147],v[48:51],v[232:235]
v_fma_f32 v87,v87,s36,v14
v_fma_f32 v92,v92,s36,v15
v_mfma_f32_16x16x32_bf16 v[184:187],a[144:147],v[44:47],v[184:187]
v_exp_f32 v84,v84
v_mfma_f32_16x16x32_bf16 v[188:191],a[148:151],v[44:47],v[188:191]
v_exp_f32 v85,v85
v_mfma_f32_16x16x32_bf16 v[192:195],a[120:123],v[44:47],v[192:195]
v_exp_f32 v86,v86
v_mfma_f32_16x16x32_bf16 v[196:199],a[124:127],v[44:47],v[196:199]
s_waitcnt vmcnt(13) lgkmcnt(0)
v_exp_f32 v87,v87
v_mfma_f32_16x16x32_bf16 v[244:247],a[124:127],v[48:51],v[244:247]
s_barrier
v_mfma_f32_16x16x32_bf16 v[240:243],a[120:123],v[48:51],v[240:243]
ds_read_b128 a[136:139],v0 offset:12288
v_cvt_pk_bf16_f32 v26,v84,v85
v_mfma_f32_16x16x32_bf16 v[144:147],a[120:123],v[52:55],v[144:147]
ds_read_b128 a[140:143],v1 offset:12288
v_cvt_pk_bf16_f32 v27,v86,v87
v_mfma_f32_16x16x32_bf16 v[148:151],a[124:127],v[52:55],v[148:151]
ds_read_b128 a[144:147],v0 offset:12416
v_fma_f32 v93,v93,s36,v15
v_smfmac_f32_16x16x64_bf16 v[60:63],a[152:155],v[20:27],v18
ds_read_b128 a[148:151],v1 offset:12416
v_mfma_f32_16x16x32_bf16 a[196:199],a[124:127],v[56:59],a[196:199]
v_fma_f32 v94,v94,s36,v15
v_fma_f32 v95,v95,s36,v15
v_mfma_f32_16x16x32_bf16 a[192:195],a[120:123],v[56:59],a[192:195]
buffer_load_dwordx4 v6,s[8:11],s21 offen offset:0 lds
v_mfma_f32_16x16x32_bf16 a[240:243],a[120:123],v[40:43],a[240:243]
ds_read_b128 a[120:123],v0 offset:12544
v_fma_f32 v100,v100,s36,v16
v_mfma_f32_16x16x32_bf16 a[244:247],a[124:127],v[40:43],a[244:247]
ds_read_b128 a[124:127],v1 offset:12544
v_fma_f32 v101,v101,s36,v16
v_mfma_f32_16x16x32_bf16 a[248:251],a[128:131],v[40:43],a[248:251]
v_exp_f32 v92,v92
v_mfma_f32_16x16x32_bf16 a[252:255],a[132:135],v[40:43],a[252:255]
v_exp_f32 v93,v93
v_mfma_f32_16x16x32_bf16 a[204:207],a[132:135],v[56:59],a[204:207]
v_exp_f32 v94,v94
v_mfma_f32_16x16x32_bf16 a[200:203],a[128:131],v[56:59],a[200:203]
v_exp_f32 v95,v95
v_mfma_f32_16x16x32_bf16 v[152:155],a[128:131],v[52:55],v[152:155]
v_cvt_pk_bf16_f32 v30,v92,v93
v_cvt_pk_bf16_f32 v31,v94,v95
v_mfma_f32_16x16x32_bf16 v[156:159],a[132:135],v[52:55],v[156:159]
v_fma_f32 v102,v102,s36,v16
v_fma_f32 v103,v103,s36,v16
v_mfma_f32_16x16x32_bf16 v[252:255],a[132:135],v[48:51],v[252:255]
v_exp_f32 v100,v100
v_mfma_f32_16x16x32_bf16 v[248:251],a[128:131],v[48:51],v[248:251]
v_exp_f32 v101,v101
v_mfma_f32_16x16x32_bf16 v[200:203],a[128:131],v[44:47],v[200:203]
buffer_load_dwordx4 v7,s[8:11],s21 offen offset:1024 lds
v_mfma_f32_16x16x32_bf16 v[204:207],a[132:135],v[44:47],v[204:207]
s_waitcnt lgkmcnt(0)
ds_read_b128 a[128:131],v0 offset:18432
v_cvt_pk_bf16_f32 v34,v100,v101
v_mfma_f32_16x16x32_bf16 v[72:75],a[136:139],a[0:3],0
ds_read_b128 a[132:135],v1 offset:18432
v_fma_f32 v108,v108,s36,v17
v_mfma_f32_16x16x32_bf16 v[72:75],a[140:143],a[4:7],v[72:75]
v_exp_f32 v102,v102
v_mfma_f32_16x16x32_bf16 v[72:75],a[144:147],a[8:11],v[72:75]
v_exp_f32 v103,v103
v_mfma_f32_16x16x32_bf16 v[72:75],a[148:151],a[12:15],v[72:75]
v_cvt_pk_bf16_f32 v35,v102,v103
v_fma_f32 v109,v109,s36,v17
v_mfma_f32_16x16x32_bf16 v[72:75],a[120:123],a[16:19],v[72:75]
v_fma_f32 v110,v110,s36,v17
v_fma_f32 v111,v111,s36,v17
v_smfmac_f32_16x16x64_bf16 v[64:67],a[152:155],v[28:35],v18
v_mfma_f32_16x16x32_bf16 v[72:75],a[124:127],a[20:23],v[72:75]
v_exp_f32 v108,v108
v_mfma_f32_16x16x32_bf16 v[80:83],a[124:127],a[44:47],0
v_exp_f32 v109,v109
v_mfma_f32_16x16x32_bf16 v[80:83],a[120:123],a[40:43],v[80:83]
v_exp_f32 v110,v110
v_mfma_f32_16x16x32_bf16 v[80:83],a[148:151],a[36:39],v[80:83]
v_exp_f32 v111,v111
v_mfma_f32_16x16x32_bf16 v[80:83],a[144:147],a[32:35],v[80:83]
buffer_load_dwordx4 v8,s[8:11],s21 offen offset:2048 lds
v_mfma_f32_16x16x32_bf16 v[80:83],a[140:143],a[28:31],v[80:83]
s_add_u32 s21,s21,12288
v_cvt_pk_bf16_f32 v38,v108,v109
v_cvt_pk_bf16_f32 v39,v110,v111
v_mfma_f32_16x16x32_bf16 v[80:83],a[136:139],a[24:27],v[80:83]
s_add_u32 m0,s22,0
v_fma_f32 v72,v72,s36,v13
v_fma_f32 v73,v73,s36,v13
v_mfma_f32_16x16x32_bf16 v[88:91],a[136:139],a[48:51],0
v_fma_f32 v74,v74,s36,v13
v_fma_f32 v75,v75,s36,v13
v_mfma_f32_16x16x32_bf16 v[88:91],a[140:143],a[52:55],v[88:91]
v_exp_f32 v72,v72
v_mfma_f32_16x16x32_bf16 v[88:91],a[144:147],a[56:59],v[88:91]
v_fma_f32 v80,v80,s36,v14
v_fma_f32 v81,v81,s36,v14
v_mfma_f32_16x16x32_bf16 v[88:91],a[148:151],a[60:63],v[88:91]
v_fma_f32 v82,v82,s36,v14
v_fma_f32 v83,v83,s36,v14
v_mfma_f32_16x16x32_bf16 v[88:91],a[120:123],a[64:67],v[88:91]
v_exp_f32 v73,v73
v_mfma_f32_16x16x32_bf16 v[88:91],a[124:127],a[68:71],v[88:91]
v_exp_f32 v74,v74
v_mfma_f32_16x16x32_bf16 v[96:99],a[124:127],a[92:95],0
v_exp_f32 v75,v75
v_mfma_f32_16x16x32_bf16 v[96:99],a[120:123],a[88:91],v[96:99]
v_exp_f32 v80,v80
v_mfma_f32_16x16x32_bf16 v[96:99],a[148:151],a[84:87],v[96:99]
buffer_load_dwordx4 v6,s[4:7],s20 offen offset:0 lds
v_mfma_f32_16x16x32_bf16 v[96:99],a[144:147],a[80:83],v[96:99]
v_fma_f32 v88,v88,s36,v15
v_fma_f32 v89,v89,s36,v15
v_mfma_f32_16x16x32_bf16 v[96:99],a[140:143],a[76:79],v[96:99]
v_exp_f32 v81,v81
v_mfma_f32_16x16x32_bf16 v[96:99],a[136:139],a[72:75],v[96:99]
v_exp_f32 v82,v82
v_mfma_f32_16x16x32_bf16 v[104:107],a[136:139],a[96:99],0
ds_read_b128 a[136:139],v0 offset:18560
v_cvt_pk_bf16_f32 v44,v72,v73
v_mfma_f32_16x16x32_bf16 v[104:107],a[140:143],a[100:103],v[104:107]
ds_read_b128 a[140:143],v1 offset:18560
v_cvt_pk_bf16_f32 v45,v74,v75
v_mfma_f32_16x16x32_bf16 v[104:107],a[144:147],a[104:107],v[104:107]
ds_read_b128 a[144:147],v0 offset:18688
v_cvt_pk_bf16_f32 v48,v80,v81
v_mfma_f32_16x16x32_bf16 v[104:107],a[148:151],a[108:111],v[104:107]
ds_read_b128 a[148:151],v1 offset:18688
v_mfma_f32_16x16x32_bf16 v[104:107],a[120:123],a[112:115],v[104:107]
v_exp_f32 v83,v83
v_mfma_f32_16x16x32_bf16 v[104:107],a[124:127],a[116:119],v[104:107]
s_waitcnt lgkmcnt(4)
v_exp_f32 v88,v88
v_mfma_f32_16x16x32_bf16 v[76:79],a[128:131],a[0:3],0
v_exp_f32 v89,v89
v_mfma_f32_16x16x32_bf16 v[76:79],a[132:135],a[4:7],v[76:79]
buffer_load_dwordx4 v7,s[4:7],s20 offen offset:1024 lds
s_waitcnt lgkmcnt(3)
v_mfma_f32_16x16x32_bf16 v[76:79],a[136:139],a[8:11],v[76:79]
s_waitcnt lgkmcnt(2)
v_cvt_pk_bf16_f32 v49,v82,v83
v_cvt_pk_bf16_f32 v52,v88,v89
v_mfma_f32_16x16x32_bf16 v[76:79],a[140:143],a[12:15],v[76:79]
s_waitcnt lgkmcnt(0)
v_mfma_f32_16x16x32_bf16 v[76:79],a[144:147],a[16:19],v[76:79]
v_mfma_f32_16x16x32_bf16 v[76:79],a[148:151],a[20:23],v[76:79]
v_mfma_f32_16x16x32_bf16 v[84:87],a[148:151],a[44:47],0
v_mfma_f32_16x16x32_bf16 v[84:87],a[144:147],a[40:43],v[84:87]
v_mfma_f32_16x16x32_bf16 v[84:87],a[140:143],a[36:39],v[84:87]
v_mfma_f32_16x16x32_bf16 v[84:87],a[136:139],a[32:35],v[84:87]
v_mfma_f32_16x16x32_bf16 v[84:87],a[132:135],a[28:31],v[84:87]
v_mfma_f32_16x16x32_bf16 v[84:87],a[128:131],a[24:27],v[84:87]
v_mfma_f32_16x16x32_bf16 v[92:95],a[128:131],a[48:51],0
v_mfma_f32_16x16x32_bf16 v[92:95],a[132:135],a[52:55],v[92:95]
buffer_load_dwordx4 v8,s[4:7],s20 offen offset:2048 lds
v_mfma_f32_16x16x32_bf16 v[92:95],a[136:139],a[56:59],v[92:95]
s_add_u32 s20,s20,12288
v_mfma_f32_16x16x32_bf16 v[92:95],a[140:143],a[60:63],v[92:95]
v_mfma_f32_16x16x32_bf16 v[92:95],a[144:147],a[64:67],v[92:95]
v_mfma_f32_16x16x32_bf16 v[92:95],a[148:151],a[68:71],v[92:95]
v_mfma_f32_16x16x32_bf16 v[100:103],a[148:151],a[92:95],0
ds_read_b64_tr_b16 a[120:121],v2 offset:0
v_mfma_f32_16x16x32_bf16 v[100:103],a[144:147],a[88:91],v[100:103]
ds_read_b64_tr_b16 a[122:123],v2 offset:6144
v_mfma_f32_16x16x32_bf16 v[100:103],a[140:143],a[84:87],v[100:103]
v_mfma_f32_16x16x32_bf16 v[100:103],a[136:139],a[80:83],v[100:103]
ds_read_b64_tr_b16 a[124:125],v3 offset:0
v_mfma_f32_16x16x32_bf16 v[100:103],a[132:135],a[76:79],v[100:103]
ds_read_b64_tr_b16 a[126:127],v3 offset:6144
v_mfma_f32_16x16x32_bf16 v[100:103],a[128:131],a[72:75],v[100:103]
v_mfma_f32_16x16x32_bf16 v[108:111],a[128:131],a[96:99],0
ds_read_b64_tr_b16 a[128:129],v4 offset:0
v_mfma_f32_16x16x32_bf16 v[108:111],a[132:135],a[100:103],v[108:111]
ds_read_b64_tr_b16 a[130:131],v4 offset:6144
v_mfma_f32_16x16x32_bf16 v[108:111],a[136:139],a[104:107],v[108:111]
ds_read_b64_tr_b16 a[132:133],v5 offset:0
v_mfma_f32_16x16x32_bf16 v[108:111],a[140:143],a[108:111],v[108:111]
ds_read_b64_tr_b16 a[134:135],v5 offset:6144
v_mfma_f32_16x16x32_bf16 v[108:111],a[144:147],a[112:115],v[108:111]
v_mfma_f32_16x16x32_bf16 v[108:111],a[148:151],a[116:119],v[108:111]
s_waitcnt lgkmcnt(4)
v_mfma_f32_16x16x32_bf16 v[160:163],a[120:123],v[20:23],v[160:163]
s_add_u32 m0,s23,0
ds_read_b64_tr_b16 a[136:137],v2 offset:128
v_fma_f32 v91,v91,s36,v15
v_mfma_f32_16x16x32_bf16 v[164:167],a[124:127],v[20:23],v[164:167]
ds_read_b64_tr_b16 a[138:139],v2 offset:6272
v_fma_f32 v90,v90,s36,v15
v_mfma_f32_16x16x32_bf16 v[212:215],a[124:127],v[24:27],v[212:215]
ds_read_b64_tr_b16 a[140:141],v3 offset:128
v_fma_f32 v98,v98,s36,v16
v_mfma_f32_16x16x32_bf16 v[208:211],a[120:123],v[24:27],v[208:211]
ds_read_b64_tr_b16 a[142:143],v3 offset:6272
v_fma_f32 v96,v96,s36,v16
v_mfma_f32_16x16x32_bf16 v[112:115],a[120:123],v[28:31],v[112:115]
ds_read_b64_tr_b16 a[146:147],v4 offset:6272
v_fma_f32 v97,v97,s36,v16
v_mfma_f32_16x16x32_bf16 v[116:119],a[124:127],v[28:31],v[116:119]
ds_read_b64_tr_b16 a[150:151],v5 offset:6272
v_fma_f32 v99,v99,s36,v16
v_mfma_f32_16x16x32_bf16 a[164:167],a[124:127],v[32:35],a[164:167]
ds_read_b64_tr_b16 a[144:145],v4 offset:128
v_fma_f32 v107,v107,s36,v17
v_mfma_f32_16x16x32_bf16 a[160:163],a[120:123],v[32:35],a[160:163]
ds_read_b64_tr_b16 a[148:149],v5 offset:128
v_fma_f32 v104,v104,s36,v17
v_mfma_f32_16x16x32_bf16 a[208:211],a[120:123],v[36:39],a[208:211]
ds_read_b64_tr_b16 a[120:121],v2 offset:256
v_fma_f32 v105,v105,s36,v17
v_mfma_f32_16x16x32_bf16 a[212:215],a[124:127],v[36:39],a[212:215]
s_waitcnt lgkmcnt(6)
ds_read_b64_tr_b16 a[124:125],v3 offset:256
v_fma_f32 v106,v106,s36,v17
v_mfma_f32_16x16x32_bf16 a[216:219],a[128:131],v[36:39],a[216:219]
ds_read_b64_tr_b16 a[122:123],v2 offset:6400
v_fma_f32 v76,v76,s36,v13
v_mfma_f32_16x16x32_bf16 a[220:223],a[132:135],v[36:39],a[220:223]
ds_read_b64_tr_b16 a[126:127],v3 offset:6400
v_fma_f32 v79,v79,s36,v13
v_mfma_f32_16x16x32_bf16 a[172:175],a[132:135],v[32:35],a[172:175]
v_exp_f32 v91,v91
v_mfma_f32_16x16x32_bf16 a[168:171],a[128:131],v[32:35],a[168:171]
v_exp_f32 v90,v90
v_mfma_f32_16x16x32_bf16 v[120:123],a[128:131],v[28:31],v[120:123]
v_cvt_pk_bf16_f32 v53,v90,v91
v_fma_f32 v78,v78,s36,v13
v_mfma_f32_16x16x32_bf16 v[124:127],a[132:135],v[28:31],v[124:127]
v_exp_f32 v96,v96
v_mfma_f32_16x16x32_bf16 v[220:223],a[132:135],v[24:27],v[220:223]
v_exp_f32 v97,v97
v_mfma_f32_16x16x32_bf16 v[216:219],a[128:131],v[24:27],v[216:219]
v_exp_f32 v98,v98
v_mfma_f32_16x16x32_bf16 v[168:171],a[128:131],v[20:23],v[168:171]
ds_read_b64_tr_b16 a[128:129],v4 offset:256
v_cvt_pk_bf16_f32 v56,v96,v97
v_mfma_f32_16x16x32_bf16 v[172:175],a[132:135],v[20:23],v[172:175]
ds_read_b64_tr_b16 a[130:131],v4 offset:6400
v_fma_f32 v77,v77,s36,v13
v_mfma_f32_16x16x32_bf16 v[176:179],a[136:139],v[20:23],v[176:179]
s_waitcnt lgkmcnt(2)
ds_read_b64_tr_b16 a[132:133],v5 offset:256
v_fma_f32 v86,v86,s36,v14
v_mfma_f32_16x16x32_bf16 v[180:183],a[140:143],v[20:23],v[180:183]
ds_read_b64_tr_b16 a[134:135],v5 offset:6400
v_fma_f32 v85,v85,s36,v14
v_mfma_f32_16x16x32_bf16 v[228:231],a[140:143],v[24:27],v[228:231]
v_exp_f32 v99,v99
v_mfma_f32_16x16x32_bf16 v[224:227],a[136:139],v[24:27],v[224:227]
v_cvt_pk_bf16_f32 v57,v98,v99
v_fma_f32 v84,v84,s36,v14
v_mfma_f32_16x16x32_bf16 v[128:131],a[136:139],v[28:31],v[128:131]
v_exp_f32 v104,v104
v_mfma_f32_16x16x32_bf16 v[132:135],a[140:143],v[28:31],v[132:135]
v_exp_f32 v105,v105
v_mfma_f32_16x16x32_bf16 a[180:183],a[140:143],v[32:35],a[180:183]
v_exp_f32 v107,v107
v_mfma_f32_16x16x32_bf16 a[176:179],a[136:139],v[32:35],a[176:179]
v_exp_f32 v106,v106
v_mfma_f32_16x16x32_bf16 a[224:227],a[136:139],v[36:39],a[224:227]
v_cvt_pk_bf16_f32 v41,v106,v107
v_cvt_pk_bf16_f32 v40,v104,v105
v_mfma_f32_16x16x32_bf16 a[228:231],a[140:143],v[36:39],a[228:231]
v_exp_f32 v79,v79
v_mfma_f32_16x16x32_bf16 a[232:235],a[144:147],v[36:39],a[232:235]
v_exp_f32 v76,v76
v_mfma_f32_16x16x32_bf16 a[236:239],a[148:151],v[36:39],a[236:239]
v_exp_f32 v78,v78
v_mfma_f32_16x16x32_bf16 a[188:191],a[148:151],v[32:35],a[188:191]
v_exp_f32 v77,v77
v_mfma_f32_16x16x32_bf16 a[184:187],a[144:147],v[32:35],a[184:187]
v_cvt_pk_bf16_f32 v47,v78,v79
v_cvt_pk_bf16_f32 v46,v76,v77
v_mfma_f32_16x16x32_bf16 v[136:139],a[144:147],v[28:31],v[136:139]
v_exp_f32 v84,v84
v_mfma_f32_16x16x32_bf16 v[140:143],a[148:151],v[28:31],v[140:143]
v_exp_f32 v85,v85
v_mfma_f32_16x16x32_bf16 v[236:239],a[148:151],v[24:27],v[236:239]
v_exp_f32 v86,v86
v_mfma_f32_16x16x32_bf16 v[232:235],a[144:147],v[24:27],v[232:235]
v_fma_f32 v87,v87,s36,v14
v_cvt_pk_bf16_f32 v50,v84,v85
v_mfma_f32_16x16x32_bf16 v[184:187],a[144:147],v[20:23],v[184:187]
v_exp_f32 v87,v87
v_mfma_f32_16x16x32_bf16 v[188:191],a[148:151],v[20:23],v[188:191]
v_cvt_pk_bf16_f32 v51,v86,v87
v_fma_f32 v93,v93,s36,v15
v_mfma_f32_16x16x32_bf16 v[192:195],a[120:123],v[20:23],v[192:195]
v_exp_f32 v93,v93
v_smfmac_f32_16x16x64_bf16 v[60:63],a[152:155],v[44:51],v18
v_fma_f32 v94,v94,s36,v15
v_mfma_f32_16x16x32_bf16 v[196:199],a[124:127],v[20:23],v[196:199]
s_waitcnt vmcnt(9) lgkmcnt(0)
v_exp_f32 v94,v94
v_mfma_f32_16x16x32_bf16 v[244:247],a[124:127],v[24:27],v[244:247]
s_barrier
v_mfma_f32_16x16x32_bf16 v[240:243],a[120:123],v[24:27],v[240:243]
ds_read_b128 a[136:139],v0 offset:24576
v_fma_f32 v92,v92,s36,v15
v_mfma_f32_16x16x32_bf16 v[144:147],a[120:123],v[28:31],v[144:147]
ds_read_b128 a[140:143],v1 offset:24576
v_fma_f32 v95,v95,s36,v15
v_mfma_f32_16x16x32_bf16 v[148:151],a[124:127],v[28:31],v[148:151]
ds_read_b128 a[144:147],v0 offset:24704
v_fma_f32 v102,v102,s36,v16
v_mfma_f32_16x16x32_bf16 a[196:199],a[124:127],v[32:35],a[196:199]
ds_read_b128 a[148:151],v1 offset:24704
v_fma_f32 v103,v103,s36,v16
v_mfma_f32_16x16x32_bf16 a[192:195],a[120:123],v[32:35],a[192:195]
ds_read_b128 a[156:159],v10 offset:6144
v_fma_f32 v101,v101,s36,v16
v_mfma_f32_16x16x32_bf16 a[240:243],a[120:123],v[36:39],a[240:243]
buffer_load_dwordx4 v6,s[8:11],s21 offen offset:0 lds
v_mfma_f32_16x16x32_bf16 a[244:247],a[124:127],v[36:39],a[244:247]
ds_read_b128 a[120:123],v0 offset:24832
v_fma_f32 v100,v100,s36,v16
v_mfma_f32_16x16x32_bf16 a[248:251],a[128:131],v[36:39],a[248:251]
ds_read_b128 a[124:127],v1 offset:24832
v_fma_f32 v110,v110,s36,v17
v_mfma_f32_16x16x32_bf16 a[252:255],a[132:135],v[36:39],a[252:255]
v_exp_f32 v95,v95
v_mfma_f32_16x16x32_bf16 a[204:207],a[132:135],v[32:35],a[204:207]
v_exp_f32 v92,v92
v_mfma_f32_16x16x32_bf16 a[200:203],a[128:131],v[32:35],a[200:203]
v_cvt_pk_bf16_f32 v55,v94,v95
v_cvt_pk_bf16_f32 v54,v92,v93
v_mfma_f32_16x16x32_bf16 v[152:155],a[128:131],v[28:31],v[152:155]
v_exp_f32 v100,v100
v_mfma_f32_16x16x32_bf16 v[156:159],a[132:135],v[28:31],v[156:159]
v_exp_f32 v102,v102
v_mfma_f32_16x16x32_bf16 v[252:255],a[132:135],v[24:27],v[252:255]
v_exp_f32 v103,v103
v_mfma_f32_16x16x32_bf16 v[248:251],a[128:131],v[24:27],v[248:251]
v_exp_f32 v101,v101
v_mfma_f32_16x16x32_bf16 v[200:203],a[128:131],v[20:23],v[200:203]
ds_read_b128 a[128:131],v0 offset:30720
v_cvt_pk_bf16_f32 v59,v102,v103
v_mfma_f32_16x16x32_bf16 v[204:207],a[132:135],v[20:23],v[204:207]
s_waitcnt lgkmcnt(1)
buffer_store_dwordx4 a[156:159],v9,s[16:19],s27 offen offset:0 nt
buffer_load_dwordx4 v7,s[8:11],s21 offen offset:1024 lds
v_mfma_f32_16x16x32_bf16 v[72:75],a[136:139],a[0:3],0
ds_read_b128 a[132:135],v1 offset:30720
v_cvt_pk_bf16_f32 v58,v100,v101
v_mfma_f32_16x16x32_bf16 v[72:75],a[140:143],a[4:7],v[72:75]
v_exp_f32 v110,v110
v_smfmac_f32_16x16x64_bf16 v[64:67],a[152:155],v[52:59],v18
v_fma_f32 v111,v111,s36,v17
v_mfma_f32_16x16x32_bf16 v[72:75],a[144:147],a[8:11],v[72:75]
v_exp_f32 v111,v111
v_mfma_f32_16x16x32_bf16 v[72:75],a[148:151],a[12:15],v[72:75]
v_fma_f32 v108,v108,s36,v17
v_cvt_pk_bf16_f32 v43,v110,v111
v_mfma_f32_16x16x32_bf16 v[72:75],a[120:123],a[16:19],v[72:75]
ds_read_b128 a[156:159],v10 offset:7168
v_fma_f32 v109,v109,s36,v17
v_mfma_f32_16x16x32_bf16 v[72:75],a[124:127],a[20:23],v[72:75]
v_exp_f32 v108,v108
v_mfma_f32_16x16x32_bf16 v[80:83],a[124:127],a[44:47],0
v_exp_f32 v109,v109
v_mfma_f32_16x16x32_bf16 v[80:83],a[120:123],a[40:43],v[80:83]
v_cvt_pk_bf16_f32 v42,v108,v109
v_mfma_f32_16x16x32_bf16 v[80:83],a[148:151],a[36:39],v[80:83]
v_mfma_f32_16x16x32_bf16 v[80:83],a[144:147],a[32:35],v[80:83]
buffer_load_dwordx4 v8,s[8:11],s21 offen offset:2048 lds
v_smfmac_f32_16x16x64_bf16 v[68:71],a[152:155],v[36:43],v18
s_add_u32 s21,s21,12288
v_fma_f32 v75,v75,s36,v13
v_mfma_f32_16x16x32_bf16 v[80:83],a[140:143],a[28:31],v[80:83]
s_cmp_eq_u32 s38,1
v_exp_f32 v75,v75
v_mfma_f32_16x16x32_bf16 v[80:83],a[136:139],a[24:27],v[80:83]
s_cselect_b32 s20,s26,s20
v_fma_f32 v73,v73,s36,v13
v_fma_f32 v74,v74,s36,v13
v_mfma_f32_16x16x32_bf16 v[88:91],a[136:139],a[48:51],0
s_add_u32 m0,s22,12288
v_exp_f32 v73,v73
v_mfma_f32_16x16x32_bf16 v[88:91],a[140:143],a[52:55],v[88:91]
v_exp_f32 v74,v74
v_mfma_f32_16x16x32_bf16 v[88:91],a[144:147],a[56:59],v[88:91]
v_fma_f32 v82,v82,s36,v14
v_fma_f32 v81,v81,s36,v14
v_mfma_f32_16x16x32_bf16 v[88:91],a[148:151],a[60:63],v[88:91]
v_exp_f32 v81,v81
v_mfma_f32_16x16x32_bf16 v[88:91],a[120:123],a[64:67],v[88:91]
v_exp_f32 v82,v82
v_mfma_f32_16x16x32_bf16 v[88:91],a[124:127],a[68:71],v[88:91]
v_fma_f32 v72,v72,s36,v13
v_fma_f32 v80,v80,s36,v14
v_mfma_f32_16x16x32_bf16 v[96:99],a[124:127],a[92:95],0
v_exp_f32 v72,v72
v_mfma_f32_16x16x32_bf16 v[96:99],a[120:123],a[88:91],v[96:99]
s_waitcnt lgkmcnt(0)
buffer_store_dwordx4 a[156:159],v9,s[16:19],s27 offen offset:128 nt
buffer_load_dwordx4 v6,s[4:7],s20 offen offset:0 lds
v_mfma_f32_16x16x32_bf16 v[96:99],a[148:151],a[84:87],v[96:99]
v_exp_f32 v80,v80
v_mfma_f32_16x16x32_bf16 v[96:99],a[144:147],a[80:83],v[96:99]
v_fma_f32 v89,v89,s36,v15
v_fma_f32 v88,v88,s36,v15
v_mfma_f32_16x16x32_bf16 v[96:99],a[140:143],a[76:79],v[96:99]
v_exp_f32 v89,v89
v_mfma_f32_16x16x32_bf16 v[96:99],a[136:139],a[72:75],v[96:99]
v_exp_f32 v88,v88
v_mfma_f32_16x16x32_bf16 v[104:107],a[136:139],a[96:99],0
ds_read_b128 a[136:139],v0 offset:30848
v_fma_f32 v83,v83,s36,v14
v_mfma_f32_16x16x32_bf16 v[104:107],a[140:143],a[100:103],v[104:107]
ds_read_b128 a[156:159],v10 offset:8192
v_mfma_f32_16x16x32_bf16 v[104:107],a[144:147],a[104:107],v[104:107]
ds_read_b128 a[140:143],v1 offset:30848
v_mfma_f32_16x16x32_bf16 v[104:107],a[148:151],a[108:111],v[104:107]
ds_read_b128 a[144:147],v0 offset:30976
v_mfma_f32_16x16x32_bf16 v[104:107],a[120:123],a[112:115],v[104:107]
ds_read_b128 a[148:151],v1 offset:30976
v_mfma_f32_16x16x32_bf16 v[104:107],a[124:127],a[116:119],v[104:107]
v_exp_f32 v83,v83
v_mfma_f32_16x16x32_bf16 v[76:79],a[128:131],a[0:3],0
buffer_load_dwordx4 v7,s[4:7],s20 offen offset:1024 lds
v_mfma_f32_16x16x32_bf16 v[76:79],a[132:135],a[4:7],v[76:79]
s_waitcnt lgkmcnt(4)
v_cvt_pk_bf16_f32 v25,v82,v83
v_cvt_pk_bf16_f32 v20,v72,v73
v_mfma_f32_16x16x32_bf16 v[76:79],a[136:139],a[8:11],v[76:79]
s_waitcnt lgkmcnt(2)
v_cvt_pk_bf16_f32 v21,v74,v75
v_cvt_pk_bf16_f32 v24,v80,v81
v_cvt_pk_bf16_f32 v28,v88,v89
v_mfma_f32_16x16x32_bf16 v[76:79],a[140:143],a[12:15],v[76:79]
s_waitcnt lgkmcnt(1)
v_mfma_f32_16x16x32_bf16 v[76:79],a[144:147],a[16:19],v[76:79]
s_waitcnt lgkmcnt(0)
v_mfma_f32_16x16x32_bf16 v[76:79],a[148:151],a[20:23],v[76:79]
v_mfma_f32_16x16x32_bf16 v[84:87],a[148:151],a[44:47],0
v_mfma_f32_16x16x32_bf16 v[84:87],a[144:147],a[40:43],v[84:87]
v_mfma_f32_16x16x32_bf16 v[84:87],a[140:143],a[36:39],v[84:87]
v_mfma_f32_16x16x32_bf16 v[84:87],a[136:139],a[32:35],v[84:87]
v_mfma_f32_16x16x32_bf16 v[84:87],a[132:135],a[28:31],v[84:87]
buffer_store_dwordx4 a[156:159],v9,s[16:19],s27 offen offset:256 nt
buffer_load_dwordx4 v8,s[4:7],s20 offen offset:2048 lds
v_mfma_f32_16x16x32_bf16 v[84:87],a[128:131],a[24:27],v[84:87]
s_add_u32 s20,s20,12288
v_mfma_f32_16x16x32_bf16 v[92:95],a[128:131],a[48:51],0
s_add_u32 s27,s27,3072
v_mfma_f32_16x16x32_bf16 v[92:95],a[132:135],a[52:55],v[92:95]
v_mfma_f32_16x16x32_bf16 v[92:95],a[136:139],a[56:59],v[92:95]
v_mfma_f32_16x16x32_bf16 v[92:95],a[140:143],a[60:63],v[92:95]
ds_read_b64_tr_b16 a[120:121],v2 offset:12288
v_mfma_f32_16x16x32_bf16 v[92:95],a[144:147],a[64:67],v[92:95]
ds_read_b64_tr_b16 a[122:123],v2 offset:18432
v_mfma_f32_16x16x32_bf16 v[92:95],a[148:151],a[68:71],v[92:95]
v_mfma_f32_16x16x32_bf16 v[100:103],a[148:151],a[92:95],0
ds_read_b64_tr_b16 a[126:127],v3 offset:18432
v_mfma_f32_16x16x32_bf16 v[100:103],a[144:147],a[88:91],v[100:103]
ds_read_b64_tr_b16 a[124:125],v3 offset:12288
v_mfma_f32_16x16x32_bf16 v[100:103],a[140:143],a[84:87],v[100:103]
v_mfma_f32_16x16x32_bf16 v[100:103],a[136:139],a[80:83],v[100:103]
v_mfma_f32_16x16x32_bf16 v[100:103],a[132:135],a[76:79],v[100:103]
v_mfma_f32_16x16x32_bf16 v[100:103],a[128:131],a[72:75],v[100:103]
v_mfma_f32_16x16x32_bf16 v[108:111],a[128:131],a[96:99],0
ds_read_b64_tr_b16 a[130:131],v4 offset:18432
v_mfma_f32_16x16x32_bf16 v[108:111],a[132:135],a[100:103],v[108:111]
ds_read_b64_tr_b16 a[128:129],v4 offset:12288
v_mfma_f32_16x16x32_bf16 v[108:111],a[136:139],a[104:107],v[108:111]
ds_read_b64_tr_b16 a[132:133],v5 offset:12288
v_mfma_f32_16x16x32_bf16 v[108:111],a[140:143],a[108:111],v[108:111]
ds_read_b64_tr_b16 a[134:135],v5 offset:18432
v_mfma_f32_16x16x32_bf16 v[108:111],a[144:147],a[112:115],v[108:111]
v_mfma_f32_16x16x32_bf16 v[108:111],a[148:151],a[116:119],v[108:111]
s_waitcnt lgkmcnt(4)
v_mfma_f32_16x16x32_bf16 v[160:163],a[120:123],v[44:47],v[160:163]
s_add_u32 m0,s29,0
ds_read_b64_tr_b16 a[136:137],v2 offset:12416
v_fma_f32 v90,v90,s36,v15
v_mfma_f32_16x16x32_bf16 v[164:167],a[124:127],v[44:47],v[164:167]
ds_read_b64_tr_b16 a[138:139],v2 offset:18560
v_fma_f32 v91,v91,s36,v15
v_mfma_f32_16x16x32_bf16 v[212:215],a[124:127],v[48:51],v[212:215]
ds_read_b64_tr_b16 a[140:141],v3 offset:12416
v_fma_f32 v96,v96,s36,v16
v_mfma_f32_16x16x32_bf16 v[208:211],a[120:123],v[48:51],v[208:211]
ds_read_b64_tr_b16 a[142:143],v3 offset:18560
v_fma_f32 v97,v97,s36,v16
v_mfma_f32_16x16x32_bf16 v[112:115],a[120:123],v[52:55],v[112:115]
ds_read_b64_tr_b16 a[144:145],v4 offset:12416
v_fma_f32 v98,v98,s36,v16
v_mfma_f32_16x16x32_bf16 v[116:119],a[124:127],v[52:55],v[116:119]
ds_read_b64_tr_b16 a[146:147],v4 offset:18560
v_fma_f32 v99,v99,s36,v16
v_mfma_f32_16x16x32_bf16 a[164:167],a[124:127],v[56:59],a[164:167]
ds_read_b64_tr_b16 a[148:149],v5 offset:12416
v_fma_f32 v104,v104,s36,v17
v_mfma_f32_16x16x32_bf16 a[160:163],a[120:123],v[56:59],a[160:163]
buffer_load_dwordx4 v6,s[12:15],s28 offen offset:0 nt lds
v_mfma_f32_16x16x32_bf16 a[208:211],a[120:123],v[40:43],a[208:211]
ds_read_b64_tr_b16 a[150:151],v5 offset:18560
v_fma_f32 v105,v105,s36,v17
v_mfma_f32_16x16x32_bf16 a[212:215],a[124:127],v[40:43],a[212:215]
s_waitcnt lgkmcnt(5)
ds_read_b64_tr_b16 a[120:121],v2 offset:12544
v_fma_f32 v106,v106,s36,v17
v_mfma_f32_16x16x32_bf16 a[216:219],a[128:131],v[40:43],a[216:219]
ds_read_b64_tr_b16 a[122:123],v2 offset:18688
v_fma_f32 v107,v107,s36,v17
v_mfma_f32_16x16x32_bf16 a[220:223],a[132:135],v[40:43],a[220:223]
ds_read_b64_tr_b16 a[124:125],v3 offset:12544
v_fma_f32 v76,v76,s36,v13
v_mfma_f32_16x16x32_bf16 a[172:175],a[132:135],v[56:59],a[172:175]
ds_read_b64_tr_b16 a[126:127],v3 offset:18688
v_fma_f32 v77,v77,s36,v13
v_mfma_f32_16x16x32_bf16 a[168:171],a[128:131],v[56:59],a[168:171]
v_exp_f32 v90,v90
v_mfma_f32_16x16x32_bf16 v[120:123],a[128:131],v[52:55],v[120:123]
v_exp_f32 v91,v91
v_mfma_f32_16x16x32_bf16 v[124:127],a[132:135],v[52:55],v[124:127]
v_cvt_pk_bf16_f32 v29,v90,v91
v_fma_f32 v78,v78,s36,v13
v_mfma_f32_16x16x32_bf16 v[220:223],a[132:135],v[48:51],v[220:223]
v_exp_f32 v96,v96
v_mfma_f32_16x16x32_bf16 v[216:219],a[128:131],v[48:51],v[216:219]
buffer_load_dwordx4 v7,s[12:15],s28 offen offset:1024 nt lds
v_mfma_f32_16x16x32_bf16 v[168:171],a[128:131],v[44:47],v[168:171]
ds_read_b64_tr_b16 a[128:129],v4 offset:12544
v_fma_f32 v79,v79,s36,v13
v_mfma_f32_16x16x32_bf16 v[172:175],a[132:135],v[44:47],v[172:175]
ds_read_b64_tr_b16 a[130:131],v4 offset:18688
v_fma_f32 v84,v84,s36,v14
v_mfma_f32_16x16x32_bf16 v[176:179],a[136:139],v[44:47],v[176:179]
s_waitcnt lgkmcnt(2)
ds_read_b64_tr_b16 a[132:133],v5 offset:12544
v_fma_f32 v85,v85,s36,v14
v_mfma_f32_16x16x32_bf16 v[180:183],a[140:143],v[44:47],v[180:183]
ds_read_b64_tr_b16 a[134:135],v5 offset:18688
v_fma_f32 v86,v86,s36,v14
v_mfma_f32_16x16x32_bf16 v[228:231],a[140:143],v[48:51],v[228:231]
v_exp_f32 v97,v97
v_mfma_f32_16x16x32_bf16 v[224:227],a[136:139],v[48:51],v[224:227]
v_exp_f32 v98,v98
v_mfma_f32_16x16x32_bf16 v[128:131],a[136:139],v[52:55],v[128:131]
v_exp_f32 v99,v99
v_mfma_f32_16x16x32_bf16 v[132:135],a[140:143],v[52:55],v[132:135]
v_cvt_pk_bf16_f32 v32,v96,v97
v_cvt_pk_bf16_f32 v33,v98,v99
v_mfma_f32_16x16x32_bf16 a[180:183],a[140:143],v[56:59],a[180:183]
v_exp_f32 v104,v104
v_mfma_f32_16x16x32_bf16 a[176:179],a[136:139],v[56:59],a[176:179]
buffer_load_dwordx4 v8,s[12:15],s28 offen offset:2048 nt lds
v_mfma_f32_16x16x32_bf16 a[224:227],a[136:139],v[40:43],a[224:227]
s_add_u32 s28,s28,3072
v_exp_f32 v105,v105
v_mfma_f32_16x16x32_bf16 a[228:231],a[140:143],v[40:43],a[228:231]
s_add_u32 s29,s29,3072
v_exp_f32 v106,v106
v_mfma_f32_16x16x32_bf16 a[232:235],a[144:147],v[40:43],a[232:235]
s_cmp_eq_u32 s38,1
v_exp_f32 v107,v107
v_mfma_f32_16x16x32_bf16 a[236:239],a[148:151],v[40:43],a[236:239]
s_cselect_b32 s21,s26,s21
v_cvt_pk_bf16_f32 v36,v104,v105
v_cvt_pk_bf16_f32 v37,v106,v107
v_mfma_f32_16x16x32_bf16 a[188:191],a[148:151],v[56:59],a[188:191]
s_add_u32 m0,s23,12288
v_exp_f32 v76,v76
v_mfma_f32_16x16x32_bf16 a[184:187],a[144:147],v[56:59],a[184:187]
v_exp_f32 v77,v77
v_mfma_f32_16x16x32_bf16 v[136:139],a[144:147],v[52:55],v[136:139]
v_exp_f32 v78,v78
v_mfma_f32_16x16x32_bf16 v[140:143],a[148:151],v[52:55],v[140:143]
v_exp_f32 v79,v79
v_mfma_f32_16x16x32_bf16 v[236:239],a[148:151],v[48:51],v[236:239]
v_cvt_pk_bf16_f32 v22,v76,v77
v_cvt_pk_bf16_f32 v23,v78,v79
v_mfma_f32_16x16x32_bf16 v[232:235],a[144:147],v[48:51],v[232:235]
v_fma_f32 v87,v87,s36,v14
v_fma_f32 v92,v92,s36,v15
v_mfma_f32_16x16x32_bf16 v[184:187],a[144:147],v[44:47],v[184:187]
v_exp_f32 v84,v84
v_mfma_f32_16x16x32_bf16 v[188:191],a[148:151],v[44:47],v[188:191]
v_exp_f32 v85,v85
v_mfma_f32_16x16x32_bf16 v[192:195],a[120:123],v[44:47],v[192:195]
v_exp_f32 v86,v86
v_mfma_f32_16x16x32_bf16 v[196:199],a[124:127],v[44:47],v[196:199]
s_waitcnt vmcnt(12) lgkmcnt(0)
v_exp_f32 v87,v87
v_mfma_f32_16x16x32_bf16 v[244:247],a[124:127],v[48:51],v[244:247]
s_barrier
v_mfma_f32_16x16x32_bf16 v[240:243],a[120:123],v[48:51],v[240:243]
ds_read_b128 a[136:139],v0 offset:0
v_cvt_pk_bf16_f32 v26,v84,v85
v_mfma_f32_16x16x32_bf16 v[144:147],a[120:123],v[52:55],v[144:147]
ds_read_b128 a[140:143],v1 offset:0
v_cvt_pk_bf16_f32 v27,v86,v87
v_mfma_f32_16x16x32_bf16 v[148:151],a[124:127],v[52:55],v[148:151]
ds_read_b128 a[144:147],v0 offset:128
v_fma_f32 v93,v93,s36,v15
v_smfmac_f32_16x16x64_bf16 v[60:63],a[152:155],v[20:27],v18
ds_read_b128 a[148:151],v1 offset:128
v_mfma_f32_16x16x32_bf16 a[196:199],a[124:127],v[56:59],a[196:199]
v_fma_f32 v94,v94,s36,v15
v_fma_f32 v95,v95,s36,v15
v_mfma_f32_16x16x32_bf16 a[192:195],a[120:123],v[56:59],a[192:195]
buffer_load_dwordx4 v6,s[8:11],s21 offen offset:0 lds
v_mfma_f32_16x16x32_bf16 a[240:243],a[120:123],v[40:43],a[240:243]
ds_read_b128 a[120:123],v0 offset:256
v_fma_f32 v100,v100,s36,v16
v_mfma_f32_16x16x32_bf16 a[244:247],a[124:127],v[40:43],a[244:247]
ds_read_b128 a[124:127],v1 offset:256
v_fma_f32 v101,v101,s36,v16
v_mfma_f32_16x16x32_bf16 a[248:251],a[128:131],v[40:43],a[248:251]
v_exp_f32 v92,v92
v_mfma_f32_16x16x32_bf16 a[252:255],a[132:135],v[40:43],a[252:255]
v_exp_f32 v93,v93
v_mfma_f32_16x16x32_bf16 a[204:207],a[132:135],v[56:59],a[204:207]
v_exp_f32 v94,v94
v_mfma_f32_16x16x32_bf16 a[200:203],a[128:131],v[56:59],a[200:203]
v_exp_f32 v95,v95
v_mfma_f32_16x16x32_bf16 v[152:155],a[128:131],v[52:55],v[152:155]
v_cvt_pk_bf16_f32 v30,v92,v93
v_cvt_pk_bf16_f32 v31,v94,v95
v_mfma_f32_16x16x32_bf16 v[156:159],a[132:135],v[52:55],v[156:159]
v_fma_f32 v102,v102,s36,v16
v_fma_f32 v103,v103,s36,v16
v_mfma_f32_16x16x32_bf16 v[252:255],a[132:135],v[48:51],v[252:255]
v_exp_f32 v100,v100
v_mfma_f32_16x16x32_bf16 v[248:251],a[128:131],v[48:51],v[248:251]
v_exp_f32 v101,v101
v_mfma_f32_16x16x32_bf16 v[200:203],a[128:131],v[44:47],v[200:203]
buffer_load_dwordx4 v7,s[8:11],s21 offen offset:1024 lds
v_mfma_f32_16x16x32_bf16 v[204:207],a[132:135],v[44:47],v[204:207]
s_waitcnt lgkmcnt(0)
ds_read_b128 a[128:131],v0 offset:6144
v_cvt_pk_bf16_f32 v34,v100,v101
v_mfma_f32_16x16x32_bf16 v[72:75],a[136:139],a[0:3],0
ds_read_b128 a[132:135],v1 offset:6144
v_fma_f32 v108,v108,s36,v17
v_mfma_f32_16x16x32_bf16 v[72:75],a[140:143],a[4:7],v[72:75]
v_exp_f32 v102,v102
v_mfma_f32_16x16x32_bf16 v[72:75],a[144:147],a[8:11],v[72:75]
v_exp_f32 v103,v103
v_mfma_f32_16x16x32_bf16 v[72:75],a[148:151],a[12:15],v[72:75]
v_cvt_pk_bf16_f32 v35,v102,v103
v_fma_f32 v109,v109,s36,v17
v_mfma_f32_16x16x32_bf16 v[72:75],a[120:123],a[16:19],v[72:75]
v_fma_f32 v110,v110,s36,v17
v_fma_f32 v111,v111,s36,v17
v_smfmac_f32_16x16x64_bf16 v[64:67],a[152:155],v[28:35],v18
v_add_u32 v10,9216,v10
v_mfma_f32_16x16x32_bf16 v[72:75],a[124:127],a[20:23],v[72:75]
v_exp_f32 v108,v108
v_mfma_f32_16x16x32_bf16 v[80:83],a[124:127],a[44:47],0
v_exp_f32 v109,v109
v_mfma_f32_16x16x32_bf16 v[80:83],a[120:123],a[40:43],v[80:83]
v_exp_f32 v110,v110
v_mfma_f32_16x16x32_bf16 v[80:83],a[148:151],a[36:39],v[80:83]
v_exp_f32 v111,v111
v_mfma_f32_16x16x32_bf16 v[80:83],a[144:147],a[32:35],v[80:83]
buffer_load_dwordx4 v8,s[8:11],s21 offen offset:2048 lds
v_mfma_f32_16x16x32_bf16 v[80:83],a[140:143],a[28:31],v[80:83]
s_add_u32 s21,s21,12288
v_cvt_pk_bf16_f32 v38,v108,v109
v_cvt_pk_bf16_f32 v39,v110,v111
v_mfma_f32_16x16x32_bf16 v[80:83],a[136:139],a[24:27],v[80:83]
s_add_u32 m0,s22,24576
v_fma_f32 v72,v72,s36,v13
v_fma_f32 v73,v73,s36,v13
v_mfma_f32_16x16x32_bf16 v[88:91],a[136:139],a[48:51],0
v_fma_f32 v74,v74,s36,v13
v_fma_f32 v75,v75,s36,v13
v_mfma_f32_16x16x32_bf16 v[88:91],a[140:143],a[52:55],v[88:91]
v_exp_f32 v72,v72
v_mfma_f32_16x16x32_bf16 v[88:91],a[144:147],a[56:59],v[88:91]
v_fma_f32 v80,v80,s36,v14
v_fma_f32 v81,v81,s36,v14
v_mfma_f32_16x16x32_bf16 v[88:91],a[148:151],a[60:63],v[88:91]
v_fma_f32 v82,v82,s36,v14
v_fma_f32 v83,v83,s36,v14
v_mfma_f32_16x16x32_bf16 v[88:91],a[120:123],a[64:67],v[88:91]
v_exp_f32 v73,v73
v_mfma_f32_16x16x32_bf16 v[88:91],a[124:127],a[68:71],v[88:91]
v_exp_f32 v74,v74
v_mfma_f32_16x16x32_bf16 v[96:99],a[124:127],a[92:95],0
v_exp_f32 v75,v75
v_mfma_f32_16x16x32_bf16 v[96:99],a[120:123],a[88:91],v[96:99]
v_exp_f32 v80,v80
v_mfma_f32_16x16x32_bf16 v[96:99],a[148:151],a[84:87],v[96:99]
buffer_load_dwordx4 v6,s[4:7],s20 offen offset:0 lds
v_mfma_f32_16x16x32_bf16 v[96:99],a[144:147],a[80:83],v[96:99]
v_fma_f32 v88,v88,s36,v15
v_fma_f32 v89,v89,s36,v15
v_mfma_f32_16x16x32_bf16 v[96:99],a[140:143],a[76:79],v[96:99]
v_exp_f32 v81,v81
v_mfma_f32_16x16x32_bf16 v[96:99],a[136:139],a[72:75],v[96:99]
v_exp_f32 v82,v82
v_mfma_f32_16x16x32_bf16 v[104:107],a[136:139],a[96:99],0
ds_read_b128 a[136:139],v0 offset:6272
v_cvt_pk_bf16_f32 v44,v72,v73
v_mfma_f32_16x16x32_bf16 v[104:107],a[140:143],a[100:103],v[104:107]
ds_read_b128 a[140:143],v1 offset:6272
v_cvt_pk_bf16_f32 v45,v74,v75
v_mfma_f32_16x16x32_bf16 v[104:107],a[144:147],a[104:107],v[104:107]
ds_read_b128 a[144:147],v0 offset:6400
v_cvt_pk_bf16_f32 v48,v80,v81
v_mfma_f32_16x16x32_bf16 v[104:107],a[148:151],a[108:111],v[104:107]
ds_read_b128 a[148:151],v1 offset:6400
v_mfma_f32_16x16x32_bf16 v[104:107],a[120:123],a[112:115],v[104:107]
v_exp_f32 v83,v83
v_mfma_f32_16x16x32_bf16 v[104:107],a[124:127],a[116:119],v[104:107]
s_waitcnt lgkmcnt(4)
v_exp_f32 v88,v88
v_mfma_f32_16x16x32_bf16 v[76:79],a[128:131],a[0:3],0
v_exp_f32 v89,v89
v_mfma_f32_16x16x32_bf16 v[76:79],a[132:135],a[4:7],v[76:79]
buffer_load_dwordx4 v7,s[4:7],s20 offen offset:1024 lds
s_waitcnt lgkmcnt(3)
v_mfma_f32_16x16x32_bf16 v[76:79],a[136:139],a[8:11],v[76:79]
s_waitcnt lgkmcnt(2)
v_cvt_pk_bf16_f32 v49,v82,v83
v_cvt_pk_bf16_f32 v52,v88,v89
v_mfma_f32_16x16x32_bf16 v[76:79],a[140:143],a[12:15],v[76:79]
s_waitcnt lgkmcnt(0)
v_mfma_f32_16x16x32_bf16 v[76:79],a[144:147],a[16:19],v[76:79]
v_mfma_f32_16x16x32_bf16 v[76:79],a[148:151],a[20:23],v[76:79]
v_mfma_f32_16x16x32_bf16 v[84:87],a[148:151],a[44:47],0
v_mfma_f32_16x16x32_bf16 v[84:87],a[144:147],a[40:43],v[84:87]
v_mfma_f32_16x16x32_bf16 v[84:87],a[140:143],a[36:39],v[84:87]
v_mfma_f32_16x16x32_bf16 v[84:87],a[136:139],a[32:35],v[84:87]
v_mfma_f32_16x16x32_bf16 v[84:87],a[132:135],a[28:31],v[84:87]
v_mfma_f32_16x16x32_bf16 v[84:87],a[128:131],a[24:27],v[84:87]
v_mfma_f32_16x16x32_bf16 v[92:95],a[128:131],a[48:51],0
v_mfma_f32_16x16x32_bf16 v[92:95],a[132:135],a[52:55],v[92:95]
buffer_load_dwordx4 v8,s[4:7],s20 offen offset:2048 lds
v_mfma_f32_16x16x32_bf16 v[92:95],a[136:139],a[56:59],v[92:95]
s_add_u32 s20,s20,12288
s_add_u32 s38,s38,1
s_cmp_lt_u32 s38,2
v_mfma_f32_16x16x32_bf16 v[92:95],a[140:143],a[60:63],v[92:95]
v_mfma_f32_16x16x32_bf16 v[92:95],a[144:147],a[64:67],v[92:95]
v_mfma_f32_16x16x32_bf16 v[92:95],a[148:151],a[68:71],v[92:95]
v_mfma_f32_16x16x32_bf16 v[100:103],a[148:151],a[92:95],0
ds_read_b64_tr_b16 a[120:121],v2 offset:24576
v_mfma_f32_16x16x32_bf16 v[100:103],a[144:147],a[88:91],v[100:103]
ds_read_b64_tr_b16 a[122:123],v2 offset:30720
v_mfma_f32_16x16x32_bf16 v[100:103],a[140:143],a[84:87],v[100:103]
v_mfma_f32_16x16x32_bf16 v[100:103],a[136:139],a[80:83],v[100:103]
ds_read_b64_tr_b16 a[124:125],v3 offset:24576
v_mfma_f32_16x16x32_bf16 v[100:103],a[132:135],a[76:79],v[100:103]
ds_read_b64_tr_b16 a[126:127],v3 offset:30720
v_mfma_f32_16x16x32_bf16 v[100:103],a[128:131],a[72:75],v[100:103]
v_mfma_f32_16x16x32_bf16 v[108:111],a[128:131],a[96:99],0
ds_read_b64_tr_b16 a[128:129],v4 offset:24576
v_mfma_f32_16x16x32_bf16 v[108:111],a[132:135],a[100:103],v[108:111]
ds_read_b64_tr_b16 a[130:131],v4 offset:30720
v_mfma_f32_16x16x32_bf16 v[108:111],a[136:139],a[104:107],v[108:111]
ds_read_b64_tr_b16 a[132:133],v5 offset:24576
v_mfma_f32_16x16x32_bf16 v[108:111],a[140:143],a[108:111],v[108:111]
ds_read_b64_tr_b16 a[134:135],v5 offset:30720
v_mfma_f32_16x16x32_bf16 v[108:111],a[144:147],a[112:115],v[108:111]
v_mfma_f32_16x16x32_bf16 v[108:111],a[148:151],a[116:119],v[108:111]
s_cbranch_scc1 L_loop5w0
s_cmp_ge_u32 s69,6
s_cbranch_scc1 L_end5
s_cmp_eq_u32 s40,0
s_cbranch_scc1 L_tr54
s_branch L_tr55
L_tr54:
s_waitcnt vmcnt(43)
s_waitcnt lgkmcnt(3)
v_mfma_f32_16x16x32_bf16 v[160:163],a[120:123],v[20:23],v[160:163]
s_add_u32 m0,s24,0
ds_read_b128 a[12:15],v12 offset:128
v_fma_f32 v101,v101,s36,v16
v_mfma_f32_16x16x32_bf16 v[164:167],a[124:127],v[20:23],v[164:167]
ds_read_b128 a[20:23],v12 offset:256
v_fma_f32 v103,v103,s36,v16
v_mfma_f32_16x16x32_bf16 v[212:215],a[124:127],v[24:27],v[212:215]
ds_read_b128 a[4:7],v12 offset:0
v_fma_f32 v87,v87,s36,v14
v_mfma_f32_16x16x32_bf16 v[208:211],a[120:123],v[24:27],v[208:211]
ds_read_b128 a[16:19],v11 offset:256
v_fma_f32 v106,v106,s36,v17
v_mfma_f32_16x16x32_bf16 v[112:115],a[120:123],v[28:31],v[112:115]
ds_read_b128 a[0:3],v11 offset:0
v_fma_f32 v99,v99,s36,v16
v_mfma_f32_16x16x32_bf16 v[116:119],a[124:127],v[28:31],v[116:119]
ds_read_b128 a[8:11],v11 offset:128
v_fma_f32 v96,v96,s36,v16
v_mfma_f32_16x16x32_bf16 a[164:167],a[124:127],v[32:35],a[164:167]
ds_read_b64_tr_b16 a[136:137],v2 offset:24704
v_fma_f32 v77,v77,s36,v13
v_mfma_f32_16x16x32_bf16 a[160:163],a[120:123],v[32:35],a[160:163]
ds_read_b64_tr_b16 a[138:139],v2 offset:30848
v_fma_f32 v85,v85,s36,v14
v_mfma_f32_16x16x32_bf16 a[208:211],a[120:123],v[36:39],a[208:211]
ds_read_b64_tr_b16 a[140:141],v3 offset:24704
ds_read_b64_tr_b16 a[142:143],v3 offset:30848
ds_read_b64_tr_b16 a[144:145],v4 offset:24704
ds_read_b64_tr_b16 a[146:147],v4 offset:30848
ds_read_b64_tr_b16 a[150:151],v5 offset:30848
ds_read_b64_tr_b16 a[148:149],v5 offset:24704
ds_read_b128 a[40:43],v11 offset:6400
v_mfma_f32_16x16x32_bf16 a[212:215],a[124:127],v[36:39],a[212:215]
s_waitcnt lgkmcnt(11)
v_fma_f32 v84,v84,s36,v14
ds_read_b128 a[32:35],v11 offset:6272
v_mfma_f32_16x16x32_bf16 a[216:219],a[128:131],v[36:39],a[216:219]
s_waitcnt lgkmcnt(10)
buffer_load_dwordx4 v6,s[12:15],s28 offen offset:0 nt lds
v_mfma_f32_16x16x32_bf16 a[220:223],a[132:135],v[36:39],a[220:223]
ds_read_b64_tr_b16 a[122:123],v2 offset:30976
ds_read_b128 a[44:47],v12 offset:6400
v_mfma_f32_16x16x32_bf16 a[172:175],a[132:135],v[32:35],a[172:175]
v_exp_f32 v101,v101
ds_read_b64_tr_b16 a[120:121],v2 offset:24832
ds_read_b128 a[24:27],v11 offset:6144
v_mfma_f32_16x16x32_bf16 a[168:171],a[128:131],v[32:35],a[168:171]
v_exp_f32 v77,v77
ds_read_b128 a[28:31],v12 offset:6144
v_mfma_f32_16x16x32_bf16 v[120:123],a[128:131],v[28:31],v[120:123]
v_fma_f32 v111,v111,s36,v17
ds_read_b64_tr_b16 a[126:127],v3 offset:30976
ds_read_b64_tr_b16 a[124:125],v3 offset:24832
ds_read_b128 a[36:39],v12 offset:6272
v_mfma_f32_16x16x32_bf16 v[124:127],a[132:135],v[28:31],v[124:127]
buffer_load_dwordx4 v7,s[12:15],s28 offen offset:1024 nt lds
v_mfma_f32_16x16x32_bf16 v[220:223],a[132:135],v[24:27],v[220:223]
v_fma_f32 v95,v95,s36,v15
v_fma_f32 v100,v100,s36,v16
v_mfma_f32_16x16x32_bf16 v[216:219],a[128:131],v[24:27],v[216:219]
v_exp_f32 v106,v106
v_mfma_f32_16x16x32_bf16 v[168:171],a[128:131],v[20:23],v[168:171]
ds_read_b64_tr_b16 a[130:131],v4 offset:30976
v_fma_f32 v93,v93,s36,v15
v_mfma_f32_16x16x32_bf16 v[172:175],a[132:135],v[20:23],v[172:175]
s_waitcnt lgkmcnt(4)
ds_read_b64_tr_b16 a[128:129],v4 offset:24832
v_exp_f32 v111,v111
v_mfma_f32_16x16x32_bf16 v[176:179],a[136:139],v[20:23],v[176:179]
ds_read_b64_tr_b16 a[132:133],v5 offset:24832
buffer_load_dwordx4 v8,s[12:15],s28 offen offset:2048 nt lds
v_mfma_f32_16x16x32_bf16 v[180:183],a[140:143],v[20:23],v[180:183]
s_add_u32 s28,s28,3072
ds_read_b64_tr_b16 a[134:135],v5 offset:30976
v_fma_f32 v107,v107,s36,v17
v_mfma_f32_16x16x32_bf16 v[228:231],a[140:143],v[24:27],v[228:231]
s_add_u32 m0,s24,3072
v_fma_f32 v92,v92,s36,v15
v_exp_f32 v92,v92
v_mfma_f32_16x16x32_bf16 v[224:227],a[136:139],v[24:27],v[224:227]
v_fma_f32 v109,v109,s36,v17
v_exp_f32 v109,v109
v_mfma_f32_16x16x32_bf16 v[128:131],a[136:139],v[28:31],v[128:131]
v_fma_f32 v97,v97,s36,v16
v_exp_f32 v84,v84
v_mfma_f32_16x16x32_bf16 v[132:135],a[140:143],v[28:31],v[132:135]
v_fma_f32 v94,v94,s36,v15
v_exp_f32 v94,v94
v_mfma_f32_16x16x32_bf16 a[180:183],a[140:143],v[32:35],a[180:183]
v_fma_f32 v104,v104,s36,v17
v_fma_f32 v90,v90,s36,v15
v_mfma_f32_16x16x32_bf16 a[176:179],a[136:139],v[32:35],a[176:179]
buffer_load_dwordx4 v6,s[12:15],s28 offen offset:0 nt lds
v_mfma_f32_16x16x32_bf16 a[224:227],a[136:139],v[36:39],a[224:227]
v_exp_f32 v93,v93
v_mfma_f32_16x16x32_bf16 a[228:231],a[140:143],v[36:39],a[228:231]
v_exp_f32 v104,v104
v_mfma_f32_16x16x32_bf16 a[232:235],a[144:147],v[36:39],a[232:235]
v_exp_f32 v96,v96
v_mfma_f32_16x16x32_bf16 a[236:239],a[148:151],v[36:39],a[236:239]
v_fma_f32 v78,v78,s36,v13
v_exp_f32 v78,v78
v_mfma_f32_16x16x32_bf16 a[188:191],a[148:151],v[32:35],a[188:191]
v_fma_f32 v110,v110,s36,v17
v_exp_f32 v110,v110
v_mfma_f32_16x16x32_bf16 a[184:187],a[144:147],v[32:35],a[184:187]
v_exp_f32 v97,v97
v_mfma_f32_16x16x32_bf16 v[136:139],a[144:147],v[28:31],v[136:139]
v_exp_f32 v100,v100
v_mfma_f32_16x16x32_bf16 v[140:143],a[148:151],v[28:31],v[140:143]
buffer_load_dwordx4 v7,s[12:15],s28 offen offset:1024 nt lds
v_mfma_f32_16x16x32_bf16 v[236:239],a[148:151],v[24:27],v[236:239]
v_fma_f32 v102,v102,s36,v16
v_exp_f32 v102,v102
v_mfma_f32_16x16x32_bf16 v[232:235],a[144:147],v[24:27],v[232:235]
v_fma_f32 v79,v79,s36,v13
v_exp_f32 v79,v79
v_mfma_f32_16x16x32_bf16 v[184:187],a[144:147],v[20:23],v[184:187]
v_exp_f32 v85,v85
v_mfma_f32_16x16x32_bf16 v[188:191],a[148:151],v[20:23],v[188:191]
v_fma_f32 v108,v108,s36,v17
v_exp_f32 v108,v108
v_mfma_f32_16x16x32_bf16 v[192:195],a[120:123],v[20:23],v[192:195]
s_waitcnt lgkmcnt(0)
v_fma_f32 v98,v98,s36,v16
v_exp_f32 v87,v87
v_mfma_f32_16x16x32_bf16 v[196:199],a[124:127],v[20:23],v[196:199]
v_fma_f32 v76,v76,s36,v13
v_exp_f32 v76,v76
v_mfma_f32_16x16x32_bf16 v[244:247],a[124:127],v[24:27],v[244:247]
buffer_load_dwordx4 v8,s[12:15],s28 offen offset:2048 nt lds
s_waitcnt vmcnt(20)
s_barrier
v_mfma_f32_16x16x32_bf16 v[240:243],a[120:123],v[24:27],v[240:243]
s_add_u32 s28,s28,3072
v_fma_f32 v105,v105,s36,v17
v_exp_f32 v107,v107
v_mfma_f32_16x16x32_bf16 v[144:147],a[120:123],v[28:31],v[144:147]
s_add_u32 m0,s22,0
v_fma_f32 v91,v91,s36,v15
v_exp_f32 v91,v91
v_mfma_f32_16x16x32_bf16 v[148:151],a[124:127],v[28:31],v[148:151]
buffer_load_dwordx4 v6,s[4:7],s25 offen offset:0 lds
v_mfma_f32_16x16x32_bf16 a[196:199],a[124:127],v[32:35],a[196:199]
buffer_load_dwordx4 v7,s[4:7],s25 offen offset:1024 lds
v_mfma_f32_16x16x32_bf16 a[192:195],a[120:123],v[32:35],a[192:195]
buffer_load_dwordx4 v8,s[4:7],s25 offen offset:2048 lds
v_mfma_f32_16x16x32_bf16 a[240:243],a[120:123],v[36:39],a[240:243]
v_fma_f32 v86,v86,s36,v14
v_exp_f32 v86,v86
v_mfma_f32_16x16x32_bf16 a[244:247],a[124:127],v[36:39],a[244:247]
v_exp_f32 v95,v95
v_mfma_f32_16x16x32_bf16 a[248:251],a[128:131],v[36:39],a[248:251]
v_exp_f32 v103,v103
v_mfma_f32_16x16x32_bf16 a[252:255],a[132:135],v[36:39],a[252:255]
ds_read_b64_tr_b16 a[136:137],v2 offset:0
v_cvt_pk_bf16_f32 v41,v106,v107
v_mfma_f32_16x16x32_bf16 a[204:207],a[132:135],v[32:35],a[204:207]
ds_read_b64_tr_b16 a[138:139],v2 offset:6144
v_exp_f32 v99,v99
v_mfma_f32_16x16x32_bf16 a[200:203],a[128:131],v[32:35],a[200:203]
ds_read_b64_tr_b16 a[140:141],v3 offset:0
v_cvt_pk_bf16_f32 v42,v108,v109
v_mfma_f32_16x16x32_bf16 v[152:155],a[128:131],v[28:31],v[152:155]
ds_read_b64_tr_b16 a[142:143],v3 offset:6144
v_cvt_pk_bf16_f32 v50,v84,v85
v_mfma_f32_16x16x32_bf16 v[156:159],a[132:135],v[28:31],v[156:159]
ds_read_b64_tr_b16 a[144:145],v4 offset:0
v_exp_f32 v90,v90
v_mfma_f32_16x16x32_bf16 v[252:255],a[132:135],v[24:27],v[252:255]
ds_read_b64_tr_b16 a[146:147],v4 offset:6144
v_exp_f32 v105,v105
v_mfma_f32_16x16x32_bf16 v[248:251],a[128:131],v[24:27],v[248:251]
ds_read_b64_tr_b16 a[148:149],v5 offset:0
v_cvt_pk_bf16_f32 v55,v94,v95
v_mfma_f32_16x16x32_bf16 v[200:203],a[128:131],v[20:23],v[200:203]
ds_read_b64_tr_b16 a[150:151],v5 offset:6144
v_cvt_pk_bf16_f32 v51,v86,v87
v_mfma_f32_16x16x32_bf16 v[204:207],a[132:135],v[20:23],v[204:207]
v_cvt_pk_bf16_f32 v59,v102,v103
v_exp_f32 v98,v98
v_cvt_pk_bf16_f32 v54,v92,v93
v_cvt_pk_bf16_f32 v56,v96,v97
v_cvt_pk_bf16_f32 v53,v90,v91
v_cvt_pk_bf16_f32 v47,v78,v79
v_cvt_pk_bf16_f32 v43,v110,v111
v_cvt_pk_bf16_f32 v58,v100,v101
v_cvt_pk_bf16_f32 v46,v76,v77
v_cvt_pk_bf16_f32 v57,v98,v99
v_cvt_pk_bf16_f32 v40,v104,v105
v_smfmac_f32_16x16x64_bf16 v[60:63],a[152:155],v[44:51],v18
v_subrev_u32 v10,18432,v10
v_smfmac_f32_16x16x64_bf16 v[64:67],a[152:155],v[52:59],v18
v_smfmac_f32_16x16x64_bf16 v[68:71],a[152:155],v[36:43],v18
s_waitcnt lgkmcnt(1)
v_mfma_f32_16x16x32_bf16 v[160:163],a[136:139],v[44:47],v[160:163]
s_add_u32 s87,s42,18432
ds_read_b64_tr_b16 a[122:123],v2 offset:6272
v_mbcnt_lo_u32_b32 v39,-1,0
v_mfma_f32_16x16x32_bf16 v[164:167],a[140:143],v[44:47],v[164:167]
s_add_u32 s66,s42,24576
ds_read_b64_tr_b16 a[120:121],v2 offset:128
v_mbcnt_hi_u32_b32 v39,-1,v39
v_mfma_f32_16x16x32_bf16 v[212:215],a[140:143],v[48:51],v[212:215]
ds_read_b64_tr_b16 a[124:125],v3 offset:128
v_and_b32 v38,7,v39
v_mfma_f32_16x16x32_bf16 v[208:211],a[136:139],v[48:51],v[208:211]
ds_read_b64_tr_b16 a[126:127],v3 offset:6272
v_add_f32 v68,v68,v69
v_mfma_f32_16x16x32_bf16 v[112:115],a[136:139],v[52:55],v[112:115]
ds_read_b64_tr_b16 a[128:129],v4 offset:128
v_add_f32 v68,v68,v70
v_mfma_f32_16x16x32_bf16 v[116:119],a[140:143],v[52:55],v[116:119]
ds_read_b64_tr_b16 a[130:131],v4 offset:6272
v_add_f32 v62,v62,v63
v_mfma_f32_16x16x32_bf16 a[164:167],a[140:143],v[56:59],a[164:167]
ds_read_b64_tr_b16 a[132:133],v5 offset:128
v_add_f32 v66,v66,v67
v_mfma_f32_16x16x32_bf16 a[160:163],a[136:139],v[56:59],a[160:163]
ds_read_b64_tr_b16 a[134:135],v5 offset:6272
v_add_f32 v60,v60,v61
v_mfma_f32_16x16x32_bf16 a[208:211],a[136:139],v[40:43],a[208:211]
ds_read_b64_tr_b16 a[136:137],v2 offset:256
v_add_f32 v64,v64,v65
v_mfma_f32_16x16x32_bf16 a[212:215],a[140:143],v[40:43],a[212:215]
ds_read_b64_tr_b16 a[138:139],v2 offset:6400
v_add_f32 v68,v68,v71
v_mfma_f32_16x16x32_bf16 a[216:219],a[144:147],v[40:43],a[216:219]
s_waitcnt lgkmcnt(6)
ds_read_b64_tr_b16 a[142:143],v3 offset:6400
v_max3_f32 v19,v60,v62,v64
v_mfma_f32_16x16x32_bf16 a[220:223],a[148:151],v[40:43],a[220:223]
ds_read_b64_tr_b16 a[140:141],v3 offset:256
v_max3_f32 v19,v19,v66,v68
v_rcp_f32 v68,v68
v_rcp_f32 v66,v66
v_accvgpr_read_b32 v72,a160
v_accvgpr_read_b32 v77,a209
v_accvgpr_read_b32 v75,a163
v_accvgpr_read_b32 v73,a161
v_pk_mul_f32 v[72:73],v[72:73],v[66:67] op_sel_hi:[1,0]
v_accvgpr_read_b32 v74,a162
v_pk_mul_f32 v[74:75],v[74:75],v[66:67] op_sel_hi:[1,0]
v_accvgpr_read_b32 v76,a208
v_pk_mul_f32 v[76:77],v[76:77],v[68:69] op_sel_hi:[1,0]
v_accvgpr_read_b32 v79,a211
v_accvgpr_read_b32 v78,a210
v_pk_mul_f32 v[78:79],v[78:79],v[68:69] op_sel_hi:[1,0]
v_accvgpr_read_b32 v80,a164
v_accvgpr_read_b32 v83,a167
v_mfma_f32_16x16x32_bf16 a[172:175],a[148:151],v[56:59],a[172:175]
v_accvgpr_read_b32 v84,a212
v_accvgpr_read_b32 v82,a166
v_accvgpr_read_b32 v87,a215
v_accvgpr_read_b32 v81,a165
v_accvgpr_read_b32 v86,a214
v_pk_mul_f32 v[80:81],v[80:81],v[66:67] op_sel_hi:[1,0]
v_pk_mul_f32 v[86:87],v[86:87],v[68:69] op_sel_hi:[1,0]
v_pk_mul_f32 v[82:83],v[82:83],v[66:67] op_sel_hi:[1,0]
v_accvgpr_read_b32 v85,a213
v_pk_mul_f32 v[84:85],v[84:85],v[68:69] op_sel_hi:[1,0]
v_accvgpr_read_b32 v95,a219
v_accvgpr_read_b32 v92,a216
v_mfma_f32_16x16x32_bf16 a[168:171],a[144:147],v[56:59],a[168:171]
v_accvgpr_read_b32 v93,a217
v_accvgpr_read_b32 v94,a218
v_mfma_f32_16x16x32_bf16 v[120:123],a[144:147],v[52:55],v[120:123]
v_accvgpr_read_b32 v97,a173
v_accvgpr_read_b32 v100,a220
v_mfma_f32_16x16x32_bf16 v[124:127],a[148:151],v[52:55],v[124:127]
v_accvgpr_read_b32 v102,a222
v_accvgpr_read_b32 v96,a172
v_mfma_f32_16x16x32_bf16 v[220:223],a[148:151],v[48:51],v[220:223]
v_accvgpr_read_b32 v89,a169
v_accvgpr_read_b32 v90,a170
v_accvgpr_read_b32 v91,a171
v_accvgpr_read_b32 v88,a168
v_accvgpr_read_b32 v103,a223
v_pk_mul_f32 v[92:93],v[92:93],v[68:69] op_sel_hi:[1,0]
v_pk_mul_f32 v[88:89],v[88:89],v[66:67] op_sel_hi:[1,0]
v_pk_mul_f32 v[94:95],v[94:95],v[68:69] op_sel_hi:[1,0]
v_pk_mul_f32 v[90:91],v[90:91],v[66:67] op_sel_hi:[1,0]
v_accvgpr_read_b32 v99,a175
v_accvgpr_read_b32 v98,a174
v_mfma_f32_16x16x32_bf16 v[216:219],a[144:147],v[48:51],v[216:219]
v_accvgpr_read_b32 v101,a221
v_cmp_ngt_f32 vcc,s37,v19
v_lshrrev_b32 v19,5,v39
v_xor_b32 v38,v38,v19
v_and_b32 v19,15,v39
v_pk_mul_f32 v[102:103],v[102:103],v[68:69] op_sel_hi:[1,0]
v_pk_mul_f32 v[100:101],v[100:101],v[68:69] op_sel_hi:[1,0]
v_pk_mul_f32 v[98:99],v[98:99],v[66:67] op_sel_hi:[1,0]
v_pk_mul_f32 v[96:97],v[96:97],v[66:67] op_sel_hi:[1,0]
v_lshl_add_u32 v19,v19,7,s24
v_lshl_add_u32 v19,v38,4,v19
v_mfma_f32_16x16x32_bf16 v[168:171],a[144:147],v[44:47],v[168:171]
s_cmp_lg_u64 vcc,0
ds_read_b64_tr_b16 a[144:145],v4 offset:256
v_bfe_u32 v38,v39,4,1
v_mfma_f32_16x16x32_bf16 v[172:175],a[148:151],v[44:47],v[172:175]
s_cselect_b32 s62,s32,0
ds_read_b64_tr_b16 a[146:147],v4 offset:6400
v_lshl_add_u32 v36,v38,3,v19
v_mfma_f32_16x16x32_bf16 v[176:179],a[120:123],v[44:47],v[176:179]
s_or_b32 s31,s31,s62
ds_read_b64_tr_b16 a[148:149],v5 offset:256
v_xor_b32 v37,32,v36
v_mfma_f32_16x16x32_bf16 v[180:183],a[124:127],v[44:47],v[180:183]
s_lshl_b32 s32,s32,1
ds_read_b64_tr_b16 a[150:151],v5 offset:6400
v_xor_b32 v38,64,v36
v_mfma_f32_16x16x32_bf16 v[228:231],a[124:127],v[48:51],v[228:231]
s_add_u32 m0,s23,0
v_bfe_u32 v19,v39,3,1
v_xor_b32 v39,96,v36
v_mfma_f32_16x16x32_bf16 v[224:227],a[120:123],v[48:51],v[224:227]
v_lshlrev_b32 v19,11,v19
v_cvt_pk_bf16_f32 v76,v76,v77
v_mfma_f32_16x16x32_bf16 v[128:131],a[120:123],v[52:55],v[128:131]
v_cvt_pk_bf16_f32 v77,v78,v79
v_cvt_pk_bf16_f32 v84,v84,v85
v_mfma_f32_16x16x32_bf16 v[132:135],a[124:127],v[52:55],v[132:135]
v_cvt_pk_bf16_f32 v85,v86,v87
v_cvt_pk_bf16_f32 v72,v72,v73
v_mfma_f32_16x16x32_bf16 a[180:183],a[124:127],v[56:59],a[180:183]
v_cvt_pk_bf16_f32 v80,v80,v81
v_cvt_pk_bf16_f32 v73,v74,v75
v_mfma_f32_16x16x32_bf16 a[176:179],a[120:123],v[56:59],a[176:179]
ds_write2st64_b64 v36,v[72:73],v[76:77] offset0:36 offset1:40
v_mfma_f32_16x16x32_bf16 a[224:227],a[120:123],v[40:43],a[224:227]
v_cvt_pk_bf16_f32 v81,v82,v83
v_cvt_pk_bf16_f32 v92,v92,v93
v_mfma_f32_16x16x32_bf16 a[228:231],a[124:127],v[40:43],a[228:231]
s_waitcnt lgkmcnt(1)
v_cvt_pk_bf16_f32 v88,v88,v89
v_cvt_pk_bf16_f32 v93,v94,v95
v_mfma_f32_16x16x32_bf16 a[232:235],a[128:131],v[40:43],a[232:235]
v_accvgpr_read_b32 v83,a179
v_accvgpr_read_b32 v82,a178
v_mfma_f32_16x16x32_bf16 a[236:239],a[132:135],v[40:43],a[236:239]
ds_write2st64_b64 v37,v[80:81],v[84:85] offset0:36 offset1:40
v_pk_mul_f32 v[82:83],v[82:83],v[66:67] op_sel_hi:[1,0]
v_accvgpr_read_b32 v81,a177
v_accvgpr_read_b32 v84,a224
v_accvgpr_read_b32 v86,a226
v_accvgpr_read_b32 v87,a227
v_pk_mul_f32 v[86:87],v[86:87],v[68:69] op_sel_hi:[1,0]
v_accvgpr_read_b32 v80,a176
v_pk_mul_f32 v[80:81],v[80:81],v[66:67] op_sel_hi:[1,0]
v_accvgpr_read_b32 v85,a225
v_pk_mul_f32 v[84:85],v[84:85],v[68:69] op_sel_hi:[1,0]
v_accvgpr_read_b32 v94,a230
v_cvt_pk_bf16_f32 v89,v90,v91
v_mfma_f32_16x16x32_bf16 a[188:191],a[132:135],v[56:59],a[188:191]
ds_write2st64_b64 v38,v[88:89],v[92:93] offset0:36 offset1:40
v_accvgpr_read_b32 v89,a181
v_accvgpr_read_b32 v91,a183
v_accvgpr_read_b32 v92,a228
v_accvgpr_read_b32 v93,a229
v_pk_mul_f32 v[92:93],v[92:93],v[68:69] op_sel_hi:[1,0]
v_accvgpr_read_b32 v95,a231
v_pk_mul_f32 v[94:95],v[94:95],v[68:69] op_sel_hi:[1,0]
v_accvgpr_read_b32 v88,a180
v_pk_mul_f32 v[88:89],v[88:89],v[66:67] op_sel_hi:[1,0]
v_accvgpr_read_b32 v90,a182
v_pk_mul_f32 v[90:91],v[90:91],v[66:67] op_sel_hi:[1,0]
v_cvt_pk_bf16_f32 v100,v100,v101
v_cvt_pk_bf16_f32 v101,v102,v103
v_mfma_f32_16x16x32_bf16 a[184:187],a[128:131],v[56:59],a[184:187]
v_cvt_pk_bf16_f32 v96,v96,v97
v_cvt_pk_bf16_f32 v97,v98,v99
v_mfma_f32_16x16x32_bf16 v[136:139],a[128:131],v[52:55],v[136:139]
ds_write2st64_b64 v39,v[96:97],v[100:101] offset0:36 offset1:40
v_mfma_f32_16x16x32_bf16 v[140:143],a[132:135],v[52:55],v[140:143]
v_cvt_pk_bf16_f32 v84,v84,v85
v_cvt_pk_bf16_f32 v80,v80,v81
v_mfma_f32_16x16x32_bf16 v[236:239],a[132:135],v[48:51],v[236:239]
s_waitcnt vmcnt(15)
ds_read_b128 a[68:71],v12 offset:12544
v_cvt_pk_bf16_f32 v81,v82,v83
ds_read_b128 a[64:67],v11 offset:12544
v_accvgpr_read_b32 v83,a191
ds_read_b128 a[60:63],v12 offset:12416
v_cvt_pk_bf16_f32 v85,v86,v87
ds_read_b128 a[56:59],v11 offset:12416
v_accvgpr_read_b32 v100,a232
ds_read_b128 a[52:55],v12 offset:12288
v_accvgpr_read_b32 v82,a190
ds_read_b128 a[48:51],v11 offset:12288
v_pk_mul_f32 v[82:83],v[82:83],v[66:67] op_sel_hi:[1,0]
ds_read_b128 v[104:107],v10 offset:18432
v_accvgpr_read_b32 v103,a235
ds_read_b128 v[108:111],v10 offset:19456
v_accvgpr_read_b32 v98,a186
ds_read_b128 v[72:75],v10 offset:20480
v_accvgpr_read_b32 v97,a185
ds_read_b128 v[76:79],v10 offset:21504
v_accvgpr_read_b32 v102,a234
ds_write2st64_b64 v36,v[80:81],v[84:85] offset0:36 offset1:40
v_pk_mul_f32 v[102:103],v[102:103],v[68:69] op_sel_hi:[1,0]
v_accvgpr_read_b32 v85,a237
v_accvgpr_read_b32 v101,a233
v_pk_mul_f32 v[100:101],v[100:101],v[68:69] op_sel_hi:[1,0]
v_accvgpr_read_b32 v80,a188
v_accvgpr_read_b32 v96,a184
v_pk_mul_f32 v[96:97],v[96:97],v[66:67] op_sel_hi:[1,0]
s_waitcnt lgkmcnt(4)
buffer_store_dwordx4 v[104:107],v9,s[16:19],s87 offen offset:0 nt
v_accvgpr_read_b32 v87,a239
v_accvgpr_read_b32 v86,a238
v_pk_mul_f32 v[86:87],v[86:87],v[68:69] op_sel_hi:[1,0]
v_accvgpr_read_b32 v99,a187
v_pk_mul_f32 v[98:99],v[98:99],v[66:67] op_sel_hi:[1,0]
v_accvgpr_read_b32 v81,a189
v_pk_mul_f32 v[80:81],v[80:81],v[66:67] op_sel_hi:[1,0]
v_accvgpr_read_b32 v84,a236
v_pk_mul_f32 v[84:85],v[84:85],v[68:69] op_sel_hi:[1,0]
v_cvt_pk_bf16_f32 v100,v100,v101
v_cvt_pk_bf16_f32 v96,v96,v97
v_mfma_f32_16x16x32_bf16 v[232:235],a[128:131],v[48:51],v[232:235]
s_waitcnt lgkmcnt(1)
buffer_store_dwordx4 v[108:111],v9,s[16:19],s87 offen offset:3072 nt
v_cvt_pk_bf16_f32 v88,v88,v89
v_cvt_pk_bf16_f32 v92,v92,v93
v_cvt_pk_bf16_f32 v80,v80,v81
v_mfma_f32_16x16x32_bf16 v[184:187],a[128:131],v[44:47],v[184:187]
v_cvt_pk_bf16_f32 v89,v90,v91
v_cvt_pk_bf16_f32 v93,v94,v95
v_mfma_f32_16x16x32_bf16 v[188:191],a[132:135],v[44:47],v[188:191]
v_cvt_pk_bf16_f32 v84,v84,v85
v_cvt_pk_bf16_f32 v97,v98,v99
v_mfma_f32_16x16x32_bf16 v[192:195],a[136:139],v[44:47],v[192:195]
ds_write2st64_b64 v37,v[88:89],v[92:93] offset0:36 offset1:40
v_mfma_f32_16x16x32_bf16 v[196:199],a[140:143],v[44:47],v[196:199]
v_cvt_pk_bf16_f32 v101,v102,v103
v_cvt_pk_bf16_f32 v81,v82,v83
v_mfma_f32_16x16x32_bf16 v[244:247],a[140:143],v[48:51],v[244:247]
buffer_store_dwordx4 v[72:75],v9,s[16:19],s66 offen offset:0 nt
v_cvt_pk_bf16_f32 v85,v86,v87
v_rcp_f32 v62,v62
v_mfma_f32_16x16x32_bf16 v[240:243],a[136:139],v[48:51],v[240:243]
v_rcp_f32 v64,v64
v_mfma_f32_16x16x32_bf16 v[144:147],a[136:139],v[52:55],v[144:147]
v_rcp_f32 v60,v60
v_mfma_f32_16x16x32_bf16 v[148:151],a[140:143],v[52:55],v[148:151]
ds_write2st64_b64 v38,v[96:97],v[100:101] offset0:36 offset1:40
v_mfma_f32_16x16x32_bf16 a[196:199],a[140:143],v[56:59],a[196:199]
v_mfma_f32_16x16x32_bf16 a[192:195],a[136:139],v[56:59],a[192:195]
buffer_store_dwordx4 v[76:79],v9,s[16:19],s66 offen offset:3072 nt
v_mfma_f32_16x16x32_bf16 a[240:243],a[136:139],v[40:43],a[240:243]
v_mfma_f32_16x16x32_bf16 a[244:247],a[140:143],v[40:43],a[244:247]
v_mfma_f32_16x16x32_bf16 a[248:251],a[144:147],v[40:43],a[248:251]
ds_write2st64_b64 v39,v[80:81],v[84:85] offset0:36 offset1:40
v_mfma_f32_16x16x32_bf16 a[252:255],a[148:151],v[40:43],a[252:255]
ds_read_b128 v[72:75],v10 offset:18432
s_waitcnt vmcnt(4)
s_barrier
ds_read_b128 v[76:79],v10 offset:19456
v_accvgpr_read_b32 v104,a192
ds_read_b128 v[88:91],v10 offset:20480
v_accvgpr_read_b32 v109,a241
ds_read_b128 v[92:95],v10 offset:21504
v_accvgpr_read_b32 v107,a195
ds_read_b128 a[140:143],v1 offset:256
v_accvgpr_read_b32 v106,a194
ds_read_b128 a[136:139],v0 offset:256
buffer_load_dwordx4 v6,s[8:11],s25 offen offset:0 lds
s_waitcnt lgkmcnt(5)
buffer_store_dwordx4 v[72:75],v9,s[16:19],s87 offen offset:128 nt
ds_read_b128 a[132:135],v1 offset:128
v_pk_mul_f32 v[106:107],v[106:107],v[66:67] op_sel_hi:[1,0]
ds_read_b128 a[128:131],v0 offset:128
v_accvgpr_read_b32 v111,a243
ds_read_b128 a[124:127],v1 offset:0
v_accvgpr_read_b32 v110,a242
ds_read_b128 a[120:123],v0 offset:0
s_waitcnt lgkmcnt(7)
buffer_store_dwordx4 v[76:79],v9,s[16:19],s87 offen offset:3200 nt
v_pk_mul_f32 v[110:111],v[110:111],v[68:69] op_sel_hi:[1,0]
v_accvgpr_read_b32 v108,a240
v_pk_mul_f32 v[108:109],v[108:109],v[68:69] op_sel_hi:[1,0]
v_accvgpr_read_b32 v105,a193
v_pk_mul_f32 v[104:105],v[104:105],v[66:67] op_sel_hi:[1,0]
v_accvgpr_read_b32 v103,a247
v_accvgpr_read_b32 v100,a244
v_mfma_f32_16x16x32_bf16 a[204:207],a[148:151],v[56:59],a[204:207]
v_accvgpr_read_b32 v98,a198
buffer_load_dwordx4 v7,s[8:11],s25 offen offset:1024 lds
buffer_store_dwordx4 v[88:91],v9,s[16:19],s66 offen offset:128 nt
v_accvgpr_read_b32 v97,a197
v_accvgpr_read_b32 v99,a199
v_pk_mul_f32 v[98:99],v[98:99],v[66:67] op_sel_hi:[1,0]
v_accvgpr_read_b32 v101,a245
v_pk_mul_f32 v[100:101],v[100:101],v[68:69] op_sel_hi:[1,0]
v_accvgpr_read_b32 v96,a196
v_pk_mul_f32 v[96:97],v[96:97],v[66:67] op_sel_hi:[1,0]
v_accvgpr_read_b32 v102,a246
v_pk_mul_f32 v[102:103],v[102:103],v[68:69] op_sel_hi:[1,0]
v_accvgpr_read_b32 v85,a249
v_cvt_pk_bf16_f32 v104,v104,v105
v_mfma_f32_16x16x32_bf16 a[200:203],a[144:147],v[56:59],a[200:203]
s_waitcnt lgkmcnt(0)
buffer_store_dwordx4 v[92:95],v9,s[16:19],s66 offen offset:3200 nt
v_cvt_pk_bf16_f32 v108,v108,v109
v_cvt_pk_bf16_f32 v96,v96,v97
v_cvt_pk_bf16_f32 v100,v100,v101
v_mfma_f32_16x16x32_bf16 v[152:155],a[144:147],v[52:55],v[152:155]
v_accvgpr_read_b32 v86,a250
v_cvt_pk_bf16_f32 v109,v110,v111
v_mfma_f32_16x16x32_bf16 v[156:159],a[148:151],v[52:55],v[156:159]
v_accvgpr_read_b32 v81,a201
v_accvgpr_read_b32 v83,a203
v_mfma_f32_16x16x32_bf16 v[252:255],a[148:151],v[48:51],v[252:255]
buffer_load_dwordx4 v8,s[8:11],s25 offen offset:2048 lds
v_accvgpr_read_b32 v82,a202
v_cvt_pk_bf16_f32 v105,v106,v107
ds_write2st64_b64 v36,v[104:105],v[108:109] offset0:36 offset1:40
v_pk_mul_f32 v[82:83],v[82:83],v[66:67] op_sel_hi:[1,0]
v_pk_mul_f32 v[232:233],v[232:233],v[62:63] op_sel_hi:[1,0]
v_pk_mul_f32 v[238:239],v[238:239],v[62:63] op_sel_hi:[1,0]
v_pk_mul_f32 v[210:211],v[210:211],v[62:63] op_sel_hi:[1,0]
v_pk_mul_f32 v[212:213],v[212:213],v[62:63] op_sel_hi:[1,0]
v_pk_mul_f32 v[236:237],v[236:237],v[62:63] op_sel_hi:[1,0]
v_pk_mul_f32 v[214:215],v[214:215],v[62:63] op_sel_hi:[1,0]
v_pk_mul_f32 v[228:229],v[228:229],v[62:63] op_sel_hi:[1,0]
v_pk_mul_f32 v[220:221],v[220:221],v[62:63] op_sel_hi:[1,0]
v_pk_mul_f32 v[224:225],v[224:225],v[62:63] op_sel_hi:[1,0]
v_pk_mul_f32 v[218:219],v[218:219],v[62:63] op_sel_hi:[1,0]
v_pk_mul_f32 v[222:223],v[222:223],v[62:63] op_sel_hi:[1,0]
v_pk_mul_f32 v[226:227],v[226:227],v[62:63] op_sel_hi:[1,0]
v_pk_mul_f32 v[230:231],v[230:231],v[62:63] op_sel_hi:[1,0]
v_pk_mul_f32 v[234:235],v[234:235],v[62:63] op_sel_hi:[1,0]
v_pk_mul_f32 v[208:209],v[208:209],v[62:63] op_sel_hi:[1,0]
v_pk_mul_f32 v[216:217],v[216:217],v[62:63] op_sel_hi:[1,0]
v_add_u32 v36,v36,v19
v_accvgpr_read_b32 v108,a252
v_accvgpr_read_b32 v109,a253
v_pk_mul_f32 v[108:109],v[108:109],v[68:69] op_sel_hi:[1,0]
v_accvgpr_read_b32 v104,a204
v_accvgpr_read_b32 v106,a206
v_cvt_pk_bf16_f32 v97,v98,v99
v_cvt_pk_bf16_f32 v101,v102,v103
ds_write2st64_b64 v37,v[96:97],v[100:101] offset0:36 offset1:40
v_add_u32 v37,v37,v19
v_accvgpr_read_b32 v87,a251
v_pk_mul_f32 v[86:87],v[86:87],v[68:69] op_sel_hi:[1,0]
v_accvgpr_read_b32 v105,a205
v_pk_mul_f32 v[104:105],v[104:105],v[66:67] op_sel_hi:[1,0]
v_accvgpr_read_b32 v110,a254
v_accvgpr_read_b32 v80,a200
v_pk_mul_f32 v[80:81],v[80:81],v[66:67] op_sel_hi:[1,0]
v_cvt_pk_bf16_f32 v104,v104,v105
v_accvgpr_read_b32 v84,a248
v_pk_mul_f32 v[84:85],v[84:85],v[68:69] op_sel_hi:[1,0]
v_accvgpr_read_b32 v107,a207
v_pk_mul_f32 v[106:107],v[106:107],v[66:67] op_sel_hi:[1,0]
v_cvt_pk_bf16_f32 v80,v80,v81
v_cvt_pk_bf16_f32 v81,v82,v83
v_cvt_pk_bf16_f32 v108,v108,v109
v_cvt_pk_bf16_f32 v84,v84,v85
v_cvt_pk_bf16_f32 v85,v86,v87
ds_write2st64_b64 v38,v[80:81],v[84:85] offset0:36 offset1:40
v_add_u32 v38,v38,v19
v_accvgpr_read_b32 v111,a255
v_pk_mul_f32 v[110:111],v[110:111],v[68:69] op_sel_hi:[1,0]
v_cvt_pk_bf16_f32 v105,v106,v107
v_cvt_pk_bf16_f32 v109,v110,v111
v_mfma_f32_16x16x32_bf16 v[248:251],a[144:147],v[48:51],v[248:251]
s_waitcnt vmcnt(14)
ds_read_b128 a[72:75],v11 offset:0
v_cvt_pk_bf16_f32 v224,v224,v225
v_mfma_f32_16x16x32_bf16 v[200:203],a[144:147],v[44:47],v[200:203]
s_mov_b32 s27,s42
ds_read_b128 a[76:79],v12 offset:0
v_cvt_pk_bf16_f32 v212,v212,v213
v_mfma_f32_16x16x32_bf16 v[204:207],a[148:151],v[44:47],v[204:207]
s_mov_b32 s42,s41
ds_read_b128 a[80:83],v11 offset:128
v_cvt_pk_bf16_f32 v228,v228,v229
ds_read_b128 a[84:87],v12 offset:128
v_pk_mul_f32 v[112:113],v[112:113],v[64:65] op_sel_hi:[1,0]
ds_read_b128 a[88:91],v11 offset:256
v_pk_mul_f32 v[240:241],v[240:241],v[62:63] op_sel_hi:[1,0]
ds_read_b128 a[92:95],v12 offset:256
v_pk_mul_f32 v[114:115],v[114:115],v[64:65] op_sel_hi:[1,0]
ds_write2st64_b64 v39,v[104:105],v[108:109] offset0:36 offset1:40
v_pk_mul_f32 v[242:243],v[242:243],v[62:63] op_sel_hi:[1,0]
v_add_u32 v39,v39,v19
v_cvt_pk_bf16_f32 v229,v230,v231
ds_read_b128 v[72:75],v10 offset:18432
v_cvt_pk_bf16_f32 v225,v226,v227
ds_read_b128 v[76:79],v10 offset:19456
v_cvt_pk_bf16_f32 v236,v236,v237
ds_read_b128 v[88:91],v10 offset:20480
v_cvt_pk_bf16_f32 v208,v208,v209
ds_read_b128 v[92:95],v10 offset:21504
v_cvt_pk_bf16_f32 v209,v210,v211
ds_write2st64_b64 v36,v[208:209],v[224:225] offset0:12 offset1:14
v_cvt_pk_bf16_f32 v220,v220,v221
v_cvt_pk_bf16_f32 v216,v216,v217
v_cvt_pk_bf16_f32 v213,v214,v215
ds_read_b128 a[144:147],v0 offset:6144
v_cvt_pk_bf16_f32 v221,v222,v223
s_waitcnt lgkmcnt(5)
buffer_store_dwordx4 v[72:75],v9,s[16:19],s87 offen offset:256 nt
ds_read_b128 a[148:151],v1 offset:6144
v_cvt_pk_bf16_f32 v232,v232,v233
v_cvt_pk_bf16_f32 v233,v234,v235
v_mfma_f32_16x16x32_bf16 v[72:75],a[140:143],a[20:23],0
s_add_u32 s69,s69,1
v_cvt_pk_bf16_f32 v112,v112,v113
v_cvt_pk_bf16_f32 v217,v218,v219
v_mfma_f32_16x16x32_bf16 v[72:75],a[136:139],a[16:19],v[72:75]
s_lshl_b32 s62,s69,5
v_cvt_pk_bf16_f32 v237,v238,v239
v_cvt_pk_bf16_f32 v240,v240,v241
v_mfma_f32_16x16x32_bf16 v[72:75],a[132:135],a[12:15],v[72:75]
s_add_u32 s62,s62,s34
s_waitcnt lgkmcnt(2)
buffer_store_dwordx4 v[76:79],v9,s[16:19],s87 offen offset:3328 nt
v_cvt_pk_bf16_f32 v241,v242,v243
v_cvt_pk_bf16_f32 v113,v114,v115
v_pk_mul_f32 v[118:119],v[118:119],v[64:65] op_sel_hi:[1,0]
v_pk_mul_f32 v[116:117],v[116:117],v[64:65] op_sel_hi:[1,0]
v_pk_mul_f32 v[244:245],v[244:245],v[62:63] op_sel_hi:[1,0]
v_pk_mul_f32 v[246:247],v[246:247],v[62:63] op_sel_hi:[1,0]
v_cvt_pk_bf16_f32 v244,v244,v245
v_cvt_pk_bf16_f32 v116,v116,v117
v_mfma_f32_16x16x32_bf16 v[72:75],a[128:131],a[8:11],v[72:75]
s_mul_i32 s63,s62,171
v_cvt_pk_bf16_f32 v245,v246,v247
v_cvt_pk_bf16_f32 v117,v118,v119
v_mfma_f32_16x16x32_bf16 v[72:75],a[124:127],a[4:7],v[72:75]
s_lshr_b32 s63,s63,9
ds_write2st64_b64 v37,v[212:213],v[228:229] offset0:12 offset1:14
v_mfma_f32_16x16x32_bf16 v[72:75],a[120:123],a[0:3],v[72:75]
s_mul_i32 s64,s63,3
v_mov_b32 v66,0
buffer_store_dwordx4 v[88:91],v9,s[16:19],s66 offen offset:256 nt
v_pk_mul_f32 v[250:251],v[250:251],v[62:63] op_sel_hi:[1,0]
v_pk_mul_f32 v[120:121],v[120:121],v[64:65] op_sel_hi:[1,0]
v_pk_mul_f32 v[248:249],v[248:249],v[62:63] op_sel_hi:[1,0]
v_pk_mul_f32 v[122:123],v[122:123],v[64:65] op_sel_hi:[1,0]
v_cvt_pk_bf16_f32 v248,v248,v249
v_max3_f32 v44,v72,v73,v74
v_mfma_f32_16x16x32_bf16 v[80:83],a[120:123],a[24:27],0
s_sub_u32 s62,s62,s64
v_cvt_pk_bf16_f32 v249,v250,v251
v_cvt_pk_bf16_f32 v120,v120,v121
v_mfma_f32_16x16x32_bf16 v[80:83],a[124:127],a[28:31],v[80:83]
s_add_u32 s63,s63,s33
ds_write2st64_b64 v38,v[216:217],v[232:233] offset0:12 offset1:14
v_mfma_f32_16x16x32_bf16 v[80:83],a[128:131],a[32:35],v[80:83]
s_mul_i32 s30,s63,196608
v_cvt_pk_bf16_f32 v121,v122,v123
buffer_store_dwordx4 v[92:95],v9,s[16:19],s66 offen offset:3328 nt
v_pk_mul_f32 v[254:255],v[254:255],v[62:63] op_sel_hi:[1,0]
v_pk_mul_f32 v[126:127],v[126:127],v[64:65] op_sel_hi:[1,0]
v_pk_mul_f32 v[124:125],v[124:125],v[64:65] op_sel_hi:[1,0]
v_pk_mul_f32 v[252:253],v[252:253],v[62:63] op_sel_hi:[1,0]
v_cvt_pk_bf16_f32 v124,v124,v125
v_cvt_pk_bf16_f32 v252,v252,v253
v_mfma_f32_16x16x32_bf16 v[80:83],a[132:135],a[36:39],v[80:83]
s_mul_i32 s41,s63,325632
v_cvt_pk_bf16_f32 v253,v254,v255
v_cvt_pk_bf16_f32 v125,v126,v127
v_mfma_f32_16x16x32_bf16 v[80:83],a[136:139],a[40:43],v[80:83]
s_lshl_b32 s63,s3,2
ds_write2st64_b64 v39,v[220:221],v[236:237] offset0:12 offset1:14
v_mfma_f32_16x16x32_bf16 v[80:83],a[140:143],a[44:47],v[80:83]
s_add_u32 s64,s63,21
v_mov_b32 v63,0
v_mov_b32 v62,0
v_mfma_f32_16x16x32_bf16 v[88:91],a[140:143],a[68:71],0
s_cmp_eq_u32 s3,0
v_mov_b32 v67,0
s_cselect_b32 s64,20,s64
s_cselect_b32 s40,1,0
s_add_u32 s65,s63,37
v_max3_f32 v48,v80,v81,v82
ds_write2st64_b64 v36,v[240:241],v[112:113] offset0:16 offset1:24
v_pk_mul_f32 v[130:131],v[130:131],v[64:65] op_sel_hi:[1,0]
v_pk_mul_f32 v[146:147],v[146:147],v[64:65] op_sel_hi:[1,0]
v_pk_mul_f32 v[128:129],v[128:129],v[64:65] op_sel_hi:[1,0]
v_pk_mul_f32 v[144:145],v[144:145],v[64:65] op_sel_hi:[1,0]
v_cvt_pk_bf16_f32 v128,v128,v129
v_cvt_pk_bf16_f32 v129,v130,v131
v_mfma_f32_16x16x32_bf16 v[88:91],a[136:139],a[64:67],v[88:91]
s_cmp_eq_u32 s62,2
v_cvt_pk_bf16_f32 v144,v144,v145
v_cvt_pk_bf16_f32 v145,v146,v147
v_mfma_f32_16x16x32_bf16 v[88:91],a[132:135],a[60:63],v[88:91]
s_cselect_b32 s64,s65,s64
s_cselect_b32 s40,0,s40
ds_write2st64_b64 v37,v[244:245],v[116:117] offset0:16 offset1:24
v_mfma_f32_16x16x32_bf16 v[88:91],a[128:131],a[56:59],v[88:91]
s_add_u32 s65,s63,s3
s_cmp_eq_u32 s62,0
s_cselect_b32 s64,s65,s64
s_cselect_b32 s40,1,s40
s_mul_i32 s64,s64,6144
s_add_u32 s41,s41,s64
v_pk_mul_f32 v[132:133],v[132:133],v[64:65] op_sel_hi:[1,0]
v_pk_mul_f32 v[148:149],v[148:149],v[64:65] op_sel_hi:[1,0]
v_pk_mul_f32 v[134:135],v[134:135],v[64:65] op_sel_hi:[1,0]
v_pk_mul_f32 v[150:151],v[150:151],v[64:65] op_sel_hi:[1,0]
v_cvt_pk_bf16_f32 v132,v132,v133
v_cvt_pk_bf16_f32 v148,v148,v149
v_mfma_f32_16x16x32_bf16 v[88:91],a[124:127],a[52:55],v[88:91]
s_cmp_ge_u32 s69,6
ds_write2st64_b64 v38,v[248:249],v[120:121] offset0:16 offset1:24
v_mfma_f32_16x16x32_bf16 v[88:91],a[120:123],a[48:51],v[88:91]
s_cselect_b32 s41,166723584,s41
v_cvt_pk_bf16_f32 v133,v134,v135
v_cvt_pk_bf16_f32 v149,v150,v151
v_mfma_f32_16x16x32_bf16 v[96:99],a[120:123],a[72:75],0
s_cselect_b32 s30,100663296,s30
ds_read_b128 a[120:123],v0 offset:6272
s_add_u32 s25,s30,s22
s_add_u32 s26,s25,12288
s_add_u32 m0,s23,24576
v_max3_f32 v52,v88,v89,v90
ds_write2st64_b64 v39,v[252:253],v[124:125] offset0:16 offset1:24
v_pk_mul_f32 v[154:155],v[154:155],v[64:65] op_sel_hi:[1,0]
v_pk_mul_f32 v[152:153],v[152:153],v[64:65] op_sel_hi:[1,0]
v_pk_mul_f32 v[138:139],v[138:139],v[64:65] op_sel_hi:[1,0]
v_pk_mul_f32 v[136:137],v[136:137],v[64:65] op_sel_hi:[1,0]
v_cvt_pk_bf16_f32 v152,v152,v153
v_cvt_pk_bf16_f32 v136,v136,v137
v_mfma_f32_16x16x32_bf16 v[96:99],a[124:127],a[76:79],v[96:99]
s_mov_b32 s28,s41
ds_read_b128 a[124:127],v1 offset:6272
v_cvt_pk_bf16_f32 v137,v138,v139
v_mfma_f32_16x16x32_bf16 v[96:99],a[128:131],a[80:83],v[96:99]
s_mov_b32 s29,s24
ds_read_b128 a[128:131],v0 offset:6400
v_cvt_pk_bf16_f32 v153,v154,v155
v_mfma_f32_16x16x32_bf16 v[96:99],a[132:135],a[84:87],v[96:99]
ds_write2st64_b64 v36,v[128:129],v[144:145] offset0:26 offset1:28
v_pk_mul_f32 v[156:157],v[156:157],v[64:65] op_sel_hi:[1,0]
v_pk_mul_f32 v[142:143],v[142:143],v[64:65] op_sel_hi:[1,0]
v_pk_mul_f32 v[158:159],v[158:159],v[64:65] op_sel_hi:[1,0]
ds_read_b128 a[132:135],v1 offset:6400
v_pk_mul_f32 v[140:141],v[140:141],v[64:65] op_sel_hi:[1,0]
v_cvt_pk_bf16_f32 v156,v156,v157
v_cvt_pk_bf16_f32 v140,v140,v141
v_mfma_f32_16x16x32_bf16 v[96:99],a[136:139],a[88:91],v[96:99]
ds_read_b128 a[136:139],v0 offset:12288
v_cvt_pk_bf16_f32 v141,v142,v143
v_mfma_f32_16x16x32_bf16 v[96:99],a[140:143],a[92:95],v[96:99]
s_waitcnt lgkmcnt(4)
ds_write2st64_b64 v37,v[132:133],v[148:149] offset0:26 offset1:28
v_mfma_f32_16x16x32_bf16 v[76:79],a[144:147],a[0:3],0
v_cvt_pk_bf16_f32 v157,v158,v159
ds_read_b128 a[140:143],v1 offset:12288
v_mov_b32 v65,0
v_pk_mul_f32 v[162:163],v[162:163],v[60:61] op_sel_hi:[1,0]
v_pk_mul_f32 v[176:177],v[176:177],v[60:61] op_sel_hi:[1,0]
v_pk_mul_f32 v[160:161],v[160:161],v[60:61] op_sel_hi:[1,0]
v_pk_mul_f32 v[178:179],v[178:179],v[60:61] op_sel_hi:[1,0]
v_max3_f32 v56,v96,v97,v98
v_cvt_pk_bf16_f32 v160,v160,v161
v_mfma_f32_16x16x32_bf16 v[76:79],a[148:151],a[4:7],v[76:79]
ds_write2st64_b64 v38,v[136:137],v[152:153] offset0:26 offset1:28
v_mfma_f32_16x16x32_bf16 v[76:79],a[120:123],a[8:11],v[76:79]
v_cvt_pk_bf16_f32 v161,v162,v163
v_cvt_pk_bf16_f32 v176,v176,v177
v_mfma_f32_16x16x32_bf16 v[76:79],a[124:127],a[12:15],v[76:79]
s_waitcnt lgkmcnt(2)
v_cvt_pk_bf16_f32 v177,v178,v179
v_mov_b32 v64,0
v_mfma_f32_16x16x32_bf16 v[76:79],a[128:131],a[16:19],v[76:79]
ds_write2st64_b64 v39,v[140:141],v[156:157] offset0:26 offset1:28
v_pk_mul_f32 v[180:181],v[180:181],v[60:61] op_sel_hi:[1,0]
v_pk_mul_f32 v[164:165],v[164:165],v[60:61] op_sel_hi:[1,0]
v_pk_mul_f32 v[166:167],v[166:167],v[60:61] op_sel_hi:[1,0]
v_pk_mul_f32 v[182:183],v[182:183],v[60:61] op_sel_hi:[1,0]
v_cvt_pk_bf16_f32 v164,v164,v165
v_cvt_pk_bf16_f32 v180,v180,v181
v_mfma_f32_16x16x32_bf16 v[76:79],a[132:135],a[20:23],v[76:79]
v_cvt_pk_bf16_f32 v181,v182,v183
v_cvt_pk_bf16_f32 v165,v166,v167
v_mfma_f32_16x16x32_bf16 v[84:87],a[132:135],a[44:47],0
buffer_load_dwordx4 v6,s[8:11],s21 offen offset:0 lds
v_mfma_f32_16x16x32_bf16 v[84:87],a[128:131],a[40:43],v[84:87]
ds_write2st64_b64 v36,v[160:161],v[176:177] offset0:0 offset1:2
v_pk_mul_f32 v[186:187],v[186:187],v[60:61] op_sel_hi:[1,0]
v_pk_mul_f32 v[170:171],v[170:171],v[60:61] op_sel_hi:[1,0]
v_pk_mul_f32 v[168:169],v[168:169],v[60:61] op_sel_hi:[1,0]
v_pk_mul_f32 v[184:185],v[184:185],v[60:61] op_sel_hi:[1,0]
v_max3_f32 v44,v44,v75,v76
v_max3_f32 v44,v44,v77,v78
v_mfma_f32_16x16x32_bf16 v[84:87],a[124:127],a[36:39],v[84:87]
v_max_f32 v44,v44,v79
v_mov_b32 v45,v44
v_mfma_f32_16x16x32_bf16 v[84:87],a[120:123],a[32:35],v[84:87]
v_cvt_pk_bf16_f32 v168,v168,v169
v_permlane32_swap_b32 v45,v44
v_mfma_f32_16x16x32_bf16 v[84:87],a[148:151],a[28:31],v[84:87]
ds_write2st64_b64 v37,v[164:165],v[180:181] offset0:0 offset1:2
v_pk_mul_f32 v[174:175],v[174:175],v[60:61] op_sel_hi:[1,0]
v_pk_mul_f32 v[190:191],v[190:191],v[60:61] op_sel_hi:[1,0]
v_pk_mul_f32 v[188:189],v[188:189],v[60:61] op_sel_hi:[1,0]
buffer_load_dwordx4 v7,s[8:11],s21 offen offset:1024 lds
v_pk_mul_f32 v[172:173],v[172:173],v[60:61] op_sel_hi:[1,0]
v_max_f32 v44,v44,v45
v_mov_b32 v45,v44
v_mfma_f32_16x16x32_bf16 v[84:87],a[144:147],a[24:27],v[84:87]
v_cvt_pk_bf16_f32 v169,v170,v171
v_permlane16_swap_b32 v45,v44
v_mfma_f32_16x16x32_bf16 v[92:95],a[144:147],a[48:51],0
v_max_f32 v44,v44,v45
v_mul_f32_e64 v13,-s36,v44
v_mfma_f32_16x16x32_bf16 v[92:95],a[148:151],a[52:55],v[92:95]
v_fma_f32 v72,v72,s36,v13
v_fma_f32 v74,v74,s36,v13
v_fma_f32 v75,v75,s36,v13
v_exp_f32 v74,v74
v_pk_mul_f32 v[194:195],v[194:195],v[60:61] op_sel_hi:[1,0]
v_pk_mul_f32 v[192:193],v[192:193],v[60:61] op_sel_hi:[1,0]
v_exp_f32 v72,v72
v_exp_f32 v75,v75
v_mfma_f32_16x16x32_bf16 v[92:95],a[120:123],a[56:59],v[92:95]
buffer_load_dwordx4 v8,s[8:11],s21 offen offset:2048 lds
v_mfma_f32_16x16x32_bf16 v[92:95],a[124:127],a[60:63],v[92:95]
s_add_u32 s21,s21,12288
v_fma_f32 v73,v73,s36,v13
v_exp_f32 v73,v73
v_mfma_f32_16x16x32_bf16 v[92:95],a[128:131],a[64:67],v[92:95]
s_add_u32 m0,s22,0
v_cvt_pk_bf16_f32 v21,v74,v75
v_cvt_pk_bf16_f32 v20,v72,v73
v_mfma_f32_16x16x32_bf16 v[92:95],a[132:135],a[68:71],v[92:95]
v_max3_f32 v48,v48,v83,v84
v_max3_f32 v48,v48,v85,v86
v_max_f32 v48,v48,v87
v_mov_b32 v49,v48
v_fma_f32 v78,v78,s36,v13
v_pk_mul_f32 v[198:199],v[198:199],v[60:61] op_sel_hi:[1,0]
v_pk_mul_f32 v[196:197],v[196:197],v[60:61] op_sel_hi:[1,0]
v_permlane32_swap_b32 v49,v48
v_max_f32 v48,v48,v49
v_mfma_f32_16x16x32_bf16 v[100:103],a[132:135],a[92:95],0
ds_read_b128 a[132:135],v1 offset:18432
v_mov_b32 v49,v48
v_mfma_f32_16x16x32_bf16 v[100:103],a[128:131],a[88:91],v[100:103]
ds_read_b128 a[128:131],v0 offset:18432
v_permlane16_swap_b32 v49,v48
v_mfma_f32_16x16x32_bf16 v[100:103],a[124:127],a[84:87],v[100:103]
ds_read_b128 a[124:127],v1 offset:12544
v_max_f32 v48,v48,v49
v_mul_f32_e64 v14,-s36,v48
v_fma_f32 v82,v82,s36,v14
v_fma_f32 v80,v80,s36,v14
v_pk_mul_f32 v[200:201],v[200:201],v[60:61] op_sel_hi:[1,0]
v_pk_mul_f32 v[202:203],v[202:203],v[60:61] op_sel_hi:[1,0]
v_exp_f32 v80,v80
v_exp_f32 v82,v82
v_mfma_f32_16x16x32_bf16 v[100:103],a[120:123],a[80:83],v[100:103]
ds_read_b128 a[120:123],v0 offset:12544
v_fma_f32 v83,v83,s36,v14
v_mfma_f32_16x16x32_bf16 v[100:103],a[148:151],a[76:79],v[100:103]
ds_read_b128 a[148:151],v1 offset:12416
v_exp_f32 v83,v83
v_mfma_f32_16x16x32_bf16 v[100:103],a[144:147],a[72:75],v[100:103]
ds_read_b128 a[144:147],v0 offset:12416
v_fma_f32 v81,v81,s36,v14
v_exp_f32 v81,v81
v_cvt_pk_bf16_f32 v25,v82,v83
v_pk_mul_f32 v[206:207],v[206:207],v[60:61] op_sel_hi:[1,0]
v_pk_mul_f32 v[204:205],v[204:205],v[60:61] op_sel_hi:[1,0]
v_cvt_pk_bf16_f32 v24,v80,v81
v_max3_f32 v52,v52,v91,v92
s_waitcnt lgkmcnt(3)
v_mfma_f32_16x16x32_bf16 v[72:75],a[124:127],a[20:23],0
v_max3_f32 v52,v52,v93,v94
v_max_f32 v52,v52,v95
v_mov_b32 v53,v52
v_max3_f32 v56,v56,v99,v100
v_max3_f32 v56,v56,v101,v102
v_permlane32_swap_b32 v53,v52
v_max_f32 v52,v52,v53
v_mov_b32 v53,v52
v_max_f32 v56,v56,v103
s_waitcnt lgkmcnt(2)
v_mfma_f32_16x16x32_bf16 v[72:75],a[120:123],a[16:19],v[72:75]
s_waitcnt lgkmcnt(1)
v_permlane16_swap_b32 v53,v52
v_mfma_f32_16x16x32_bf16 v[72:75],a[148:151],a[12:15],v[72:75]
s_waitcnt lgkmcnt(0)
v_max_f32 v52,v52,v53
v_mul_f32_e64 v15,-s36,v52
v_fma_f32 v91,v91,s36,v15
v_mfma_f32_16x16x32_bf16 v[72:75],a[144:147],a[8:11],v[72:75]
v_fma_f32 v88,v88,s36,v15
v_exp_f32 v88,v88
v_mfma_f32_16x16x32_bf16 v[72:75],a[140:143],a[4:7],v[72:75]
v_fma_f32 v89,v89,s36,v15
v_exp_f32 v89,v89
v_mfma_f32_16x16x32_bf16 v[72:75],a[136:139],a[0:3],v[72:75]
v_fma_f32 v90,v90,s36,v15
v_exp_f32 v90,v90
v_mfma_f32_16x16x32_bf16 v[80:83],a[136:139],a[24:27],0
v_exp_f32 v91,v91
v_mfma_f32_16x16x32_bf16 v[80:83],a[140:143],a[28:31],v[80:83]
v_cvt_pk_bf16_f32 v28,v88,v89
v_cvt_pk_bf16_f32 v29,v90,v91
v_mfma_f32_16x16x32_bf16 v[80:83],a[144:147],a[32:35],v[80:83]
v_mov_b32 v57,v56
v_fma_f32 v79,v79,s36,v13
v_mfma_f32_16x16x32_bf16 v[80:83],a[148:151],a[36:39],v[80:83]
v_permlane32_swap_b32 v57,v56
v_mfma_f32_16x16x32_bf16 v[80:83],a[120:123],a[40:43],v[80:83]
v_max_f32 v56,v56,v57
v_mov_b32 v57,v56
v_mfma_f32_16x16x32_bf16 v[80:83],a[124:127],a[44:47],v[80:83]
v_fma_f32 v76,v76,s36,v13
v_permlane16_swap_b32 v57,v56
v_mfma_f32_16x16x32_bf16 v[88:91],a[124:127],a[68:71],0
v_max_f32 v56,v56,v57
v_mul_f32_e64 v16,-s36,v56
v_mfma_f32_16x16x32_bf16 v[88:91],a[120:123],a[64:67],v[88:91]
v_fma_f32 v96,v96,s36,v16
v_fma_f32 v98,v98,s36,v16
v_mfma_f32_16x16x32_bf16 v[88:91],a[148:151],a[60:63],v[88:91]
v_exp_f32 v98,v98
v_mfma_f32_16x16x32_bf16 v[88:91],a[144:147],a[56:59],v[88:91]
v_fma_f32 v97,v97,s36,v16
v_fma_f32 v99,v99,s36,v16
v_mfma_f32_16x16x32_bf16 v[88:91],a[140:143],a[52:55],v[88:91]
v_exp_f32 v96,v96
v_mfma_f32_16x16x32_bf16 v[88:91],a[136:139],a[48:51],v[88:91]
v_exp_f32 v99,v99
v_exp_f32 v97,v97
v_cvt_pk_bf16_f32 v33,v98,v99
v_cvt_pk_bf16_f32 v32,v96,v97
v_mfma_f32_16x16x32_bf16 v[96:99],a[136:139],a[72:75],0
ds_read_b128 a[136:139],v0 offset:18560
v_exp_f32 v78,v78
v_mfma_f32_16x16x32_bf16 v[96:99],a[140:143],a[76:79],v[96:99]
ds_read_b128 a[140:143],v1 offset:18560
v_exp_f32 v76,v76
v_mfma_f32_16x16x32_bf16 v[96:99],a[144:147],a[80:83],v[96:99]
ds_read_b128 a[144:147],v0 offset:18688
v_fma_f32 v77,v77,s36,v13
v_mfma_f32_16x16x32_bf16 v[96:99],a[148:151],a[84:87],v[96:99]
ds_read_b128 a[148:151],v1 offset:18688
v_exp_f32 v77,v77
v_mfma_f32_16x16x32_bf16 v[96:99],a[120:123],a[88:91],v[96:99]
v_exp_f32 v79,v79
v_mfma_f32_16x16x32_bf16 v[96:99],a[124:127],a[92:95],v[96:99]
v_cvt_pk_bf16_f32 v23,v78,v79
v_cvt_pk_bf16_f32 v22,v76,v77
v_mfma_f32_16x16x32_bf16 v[76:79],a[128:131],a[0:3],0
v_fma_f32 v84,v84,s36,v14
v_fma_f32 v87,v87,s36,v14
v_mfma_f32_16x16x32_bf16 v[76:79],a[132:135],a[4:7],v[76:79]
s_waitcnt lgkmcnt(3)
v_fma_f32 v86,v86,s36,v14
v_exp_f32 v84,v84
v_mfma_f32_16x16x32_bf16 v[76:79],a[136:139],a[8:11],v[76:79]
s_waitcnt lgkmcnt(2)
v_exp_f32 v87,v87
v_mfma_f32_16x16x32_bf16 v[76:79],a[140:143],a[12:15],v[76:79]
s_waitcnt lgkmcnt(0)
v_fma_f32 v85,v85,s36,v14
v_exp_f32 v85,v85
v_mfma_f32_16x16x32_bf16 v[76:79],a[144:147],a[16:19],v[76:79]
v_cvt_pk_bf16_f32 v26,v84,v85
v_exp_f32 v86,v86
v_mfma_f32_16x16x32_bf16 v[76:79],a[148:151],a[20:23],v[76:79]
v_cvt_pk_bf16_f32 v27,v86,v87
v_fma_f32 v94,v94,s36,v15
v_mfma_f32_16x16x32_bf16 v[84:87],a[148:151],a[44:47],0
v_fma_f32 v92,v92,s36,v15
v_exp_f32 v92,v92
s_waitcnt vmcnt(7)
s_barrier
v_mfma_f32_16x16x32_bf16 v[84:87],a[144:147],a[40:43],v[84:87]
buffer_load_dwordx4 v6,s[4:7],s20 offen offset:0 lds
v_mfma_f32_16x16x32_bf16 v[84:87],a[140:143],a[36:39],v[84:87]
v_fma_f32 v93,v93,s36,v15
v_exp_f32 v93,v93
v_mfma_f32_16x16x32_bf16 v[84:87],a[136:139],a[32:35],v[84:87]
v_fma_f32 v95,v95,s36,v15
v_exp_f32 v94,v94
v_mfma_f32_16x16x32_bf16 v[84:87],a[132:135],a[28:31],v[84:87]
v_exp_f32 v95,v95
v_mfma_f32_16x16x32_bf16 v[84:87],a[128:131],a[24:27],v[84:87]
v_cvt_pk_bf16_f32 v31,v94,v95
v_cvt_pk_bf16_f32 v30,v92,v93
v_mfma_f32_16x16x32_bf16 v[92:95],a[128:131],a[48:51],0
v_fma_f32 v100,v100,s36,v16
v_fma_f32 v103,v103,s36,v16
v_mfma_f32_16x16x32_bf16 v[92:95],a[132:135],a[52:55],v[92:95]
buffer_load_dwordx4 v7,s[4:7],s20 offen offset:1024 lds
v_mfma_f32_16x16x32_bf16 v[92:95],a[136:139],a[56:59],v[92:95]
v_exp_f32 v100,v100
v_mfma_f32_16x16x32_bf16 v[92:95],a[140:143],a[60:63],v[92:95]
v_fma_f32 v101,v101,s36,v16
v_exp_f32 v103,v103
v_mfma_f32_16x16x32_bf16 v[92:95],a[144:147],a[64:67],v[92:95]
ds_read_b64_tr_b16 a[122:123],v2 offset:6144
v_exp_f32 v101,v101
v_mfma_f32_16x16x32_bf16 v[92:95],a[148:151],a[68:71],v[92:95]
ds_read_b64_tr_b16 a[120:121],v2 offset:0
buffer_load_dwordx4 v8,s[4:7],s20 offen offset:2048 lds
ds_read_b64_tr_b16 a[124:125],v3 offset:0
ds_read_b64_tr_b16 a[126:127],v3 offset:6144
v_fma_f32 v102,v102,s36,v16
v_exp_f32 v102,v102
v_cvt_pk_bf16_f32 v34,v100,v101
v_cvt_pk_bf16_f32 v35,v102,v103
v_mfma_f32_16x16x32_bf16 v[100:103],a[148:151],a[92:95],0
s_add_u32 s20,s20,12288
v_cvt_pk_bf16_f32 v184,v184,v185
v_cvt_pk_bf16_f32 v188,v188,v189
v_smfmac_f32_16x16x64_bf16 v[64:67],a[152:155],v[28:35],v18
v_mov_b32 v61,0
v_mfma_f32_16x16x32_bf16 v[100:103],a[144:147],a[88:91],v[100:103]
v_mov_b32 v60,0
v_cvt_pk_bf16_f32 v192,v192,v193
v_mfma_f32_16x16x32_bf16 v[100:103],a[140:143],a[84:87],v[100:103]
v_cvt_pk_bf16_f32 v185,v186,v187
v_cvt_pk_bf16_f32 v189,v190,v191
v_smfmac_f32_16x16x64_bf16 v[60:63],a[152:155],v[20:27],v18
ds_write2st64_b64 v38,v[168:169],v[184:185] offset0:0 offset1:2
v_mfma_f32_16x16x32_bf16 v[100:103],a[136:139],a[80:83],v[100:103]
v_fma_f32 v75,v75,s36,v13
v_fma_f32 v73,v73,s36,v13
v_mfma_f32_16x16x32_bf16 v[100:103],a[132:135],a[76:79],v[100:103]
ds_read_b64_tr_b16 a[134:135],v5 offset:6144
v_fma_f32 v74,v74,s36,v13
v_mfma_f32_16x16x32_bf16 v[100:103],a[128:131],a[72:75],v[100:103]
ds_read_b64_tr_b16 a[130:131],v4 offset:6144
ds_read_b64_tr_b16 a[128:129],v4 offset:0
ds_read_b64_tr_b16 a[132:133],v5 offset:0
v_cvt_pk_bf16_f32 v172,v172,v173
v_cvt_pk_bf16_f32 v173,v174,v175
ds_write2st64_b64 v39,v[172:173],v[188:189] offset0:0 offset1:2
v_fma_f32 v81,v81,s36,v14
v_fma_f32 v80,v80,s36,v14
v_exp_f32 v80,v80
v_fma_f32 v72,v72,s36,v13
v_exp_f32 v72,v72
v_exp_f32 v74,v74
v_cvt_pk_bf16_f32 v193,v194,v195
v_exp_f32 v81,v81
ds_write_b64 v36,v[192:193] offset:2048
v_exp_f32 v73,v73
v_cvt_pk_bf16_f32 v196,v196,v197
v_cvt_pk_bf16_f32 v197,v198,v199
ds_write_b64 v37,v[196:197] offset:2048
v_cvt_pk_bf16_f32 v204,v204,v205
v_cvt_pk_bf16_f32 v205,v206,v207
v_cvt_pk_bf16_f32 v200,v200,v201
v_exp_f32 v75,v75
v_cvt_pk_bf16_f32 v44,v72,v73
v_cvt_pk_bf16_f32 v48,v80,v81
v_cvt_pk_bf16_f32 v201,v202,v203
ds_write_b64 v38,v[200:201] offset:2048
v_cvt_pk_bf16_f32 v45,v74,v75
ds_write_b64 v39,v[204:205] offset:2048
s_waitcnt lgkmcnt(3)
v_mfma_f32_16x16x32_bf16 v[160:163],a[120:123],v[20:23],0
s_add_u32 m0,s23,0
ds_read_b64_tr_b16 a[136:137],v2 offset:128
v_fma_f32 v82,v82,s36,v14
v_mfma_f32_16x16x32_bf16 v[164:167],a[124:127],v[20:23],0
ds_read_b64_tr_b16 a[138:139],v2 offset:6272
v_fma_f32 v83,v83,s36,v14
v_mfma_f32_16x16x32_bf16 v[212:215],a[124:127],v[24:27],0
ds_read_b64_tr_b16 a[140:141],v3 offset:128
v_fma_f32 v88,v88,s36,v15
v_mfma_f32_16x16x32_bf16 v[208:211],a[120:123],v[24:27],0
ds_read_b64_tr_b16 a[142:143],v3 offset:6272
v_fma_f32 v89,v89,s36,v15
v_mfma_f32_16x16x32_bf16 v[112:115],a[120:123],v[28:31],0
ds_read_b64_tr_b16 a[144:145],v4 offset:128
v_fma_f32 v90,v90,s36,v15
v_mfma_f32_16x16x32_bf16 v[116:119],a[124:127],v[28:31],0
ds_read_b64_tr_b16 a[146:147],v4 offset:6272
v_fma_f32 v91,v91,s36,v15
v_mfma_f32_16x16x32_bf16 a[164:167],a[124:127],v[32:35],0
ds_read_b64_tr_b16 a[148:149],v5 offset:128
v_fma_f32 v96,v96,s36,v16
v_mfma_f32_16x16x32_bf16 a[160:163],a[120:123],v[32:35],0
ds_read_b64_tr_b16 a[150:151],v5 offset:6272
v_fma_f32 v97,v97,s36,v16
v_mfma_f32_16x16x32_bf16 a[168:171],a[128:131],v[32:35],0
ds_read_b64_tr_b16 a[120:121],v2 offset:256
v_fma_f32 v98,v98,s36,v16
v_mfma_f32_16x16x32_bf16 a[172:175],a[132:135],v[32:35],0
ds_read_b64_tr_b16 a[122:123],v2 offset:6400
v_fma_f32 v99,v99,s36,v16
v_mfma_f32_16x16x32_bf16 v[124:127],a[132:135],v[28:31],0
ds_read_b64_tr_b16 a[124:125],v3 offset:256
v_fma_f32 v76,v76,s36,v13
v_mfma_f32_16x16x32_bf16 v[120:123],a[128:131],v[28:31],0
ds_read_b64_tr_b16 a[126:127],v3 offset:6400
v_fma_f32 v77,v77,s36,v13
v_mfma_f32_16x16x32_bf16 v[216:219],a[128:131],v[24:27],0
v_exp_f32 v82,v82
v_mfma_f32_16x16x32_bf16 v[220:223],a[132:135],v[24:27],0
v_exp_f32 v83,v83
v_mfma_f32_16x16x32_bf16 v[172:175],a[132:135],v[20:23],0
ds_read_b64_tr_b16 a[132:133],v5 offset:256
v_cvt_pk_bf16_f32 v49,v82,v83
v_mfma_f32_16x16x32_bf16 v[168:171],a[128:131],v[20:23],0
s_waitcnt lgkmcnt(4)
ds_read_b64_tr_b16 a[128:129],v4 offset:256
v_fma_f32 v78,v78,s36,v13
v_mfma_f32_16x16x32_bf16 v[176:179],a[136:139],v[20:23],0
ds_read_b64_tr_b16 a[130:131],v4 offset:6400
v_fma_f32 v79,v79,s36,v13
v_mfma_f32_16x16x32_bf16 v[180:183],a[140:143],v[20:23],0
ds_read_b64_tr_b16 a[134:135],v5 offset:6400
v_fma_f32 v84,v84,s36,v14
v_mfma_f32_16x16x32_bf16 v[228:231],a[140:143],v[24:27],0
v_exp_f32 v88,v88
v_mfma_f32_16x16x32_bf16 v[224:227],a[136:139],v[24:27],0
v_exp_f32 v89,v89
v_mfma_f32_16x16x32_bf16 v[128:131],a[136:139],v[28:31],0
v_exp_f32 v90,v90
v_mfma_f32_16x16x32_bf16 v[132:135],a[140:143],v[28:31],0
v_exp_f32 v91,v91
v_mfma_f32_16x16x32_bf16 a[180:183],a[140:143],v[32:35],0
v_cvt_pk_bf16_f32 v52,v88,v89
v_cvt_pk_bf16_f32 v53,v90,v91
v_mfma_f32_16x16x32_bf16 a[176:179],a[136:139],v[32:35],0
v_exp_f32 v96,v96
v_mfma_f32_16x16x32_bf16 a[184:187],a[144:147],v[32:35],0
v_exp_f32 v97,v97
v_mfma_f32_16x16x32_bf16 a[188:191],a[148:151],v[32:35],0
v_exp_f32 v98,v98
v_mfma_f32_16x16x32_bf16 v[140:143],a[148:151],v[28:31],0
v_exp_f32 v99,v99
v_mfma_f32_16x16x32_bf16 v[136:139],a[144:147],v[28:31],0
v_cvt_pk_bf16_f32 v56,v96,v97
v_cvt_pk_bf16_f32 v57,v98,v99
v_mfma_f32_16x16x32_bf16 v[232:235],a[144:147],v[24:27],0
v_exp_f32 v76,v76
v_mfma_f32_16x16x32_bf16 v[236:239],a[148:151],v[24:27],0
v_exp_f32 v77,v77
v_mfma_f32_16x16x32_bf16 v[188:191],a[148:151],v[20:23],0
v_exp_f32 v78,v78
v_mfma_f32_16x16x32_bf16 v[184:187],a[144:147],v[20:23],0
s_waitcnt lgkmcnt(0)
v_exp_f32 v79,v79
v_mfma_f32_16x16x32_bf16 v[192:195],a[120:123],v[20:23],0
v_cvt_pk_bf16_f32 v46,v76,v77
v_cvt_pk_bf16_f32 v47,v78,v79
v_mfma_f32_16x16x32_bf16 v[196:199],a[124:127],v[20:23],0
s_waitcnt vmcnt(30)
v_fma_f32 v85,v85,s36,v14
v_fma_f32 v86,v86,s36,v14
v_mfma_f32_16x16x32_bf16 v[244:247],a[124:127],v[24:27],0
s_barrier
v_mfma_f32_16x16x32_bf16 v[240:243],a[120:123],v[24:27],0
ds_read_b128 a[148:151],v1 offset:24704
v_fma_f32 v87,v87,s36,v14
v_mfma_f32_16x16x32_bf16 v[144:147],a[120:123],v[28:31],0
ds_read_b128 a[144:147],v0 offset:24704
v_fma_f32 v92,v92,s36,v15
v_mfma_f32_16x16x32_bf16 v[148:151],a[124:127],v[28:31],0
ds_read_b128 a[140:143],v1 offset:24576
v_fma_f32 v93,v93,s36,v15
v_mfma_f32_16x16x32_bf16 a[196:199],a[124:127],v[32:35],0
ds_read_b128 a[124:127],v1 offset:24832
v_fma_f32 v94,v94,s36,v15
v_mfma_f32_16x16x32_bf16 a[192:195],a[120:123],v[32:35],0
ds_read_b128 a[120:123],v0 offset:24832
v_fma_f32 v95,v95,s36,v15
v_mfma_f32_16x16x32_bf16 a[200:203],a[128:131],v[32:35],0
buffer_load_dwordx4 v6,s[8:11],s21 offen offset:0 lds
v_mfma_f32_16x16x32_bf16 a[204:207],a[132:135],v[32:35],0
ds_read_b128 a[136:139],v0 offset:24576
v_fma_f32 v100,v100,s36,v16
v_mfma_f32_16x16x32_bf16 v[156:159],a[132:135],v[28:31],0
v_exp_f32 v84,v84
v_mfma_f32_16x16x32_bf16 v[152:155],a[128:131],v[28:31],0
v_exp_f32 v85,v85
v_mfma_f32_16x16x32_bf16 v[248:251],a[128:131],v[24:27],0
v_exp_f32 v86,v86
v_mfma_f32_16x16x32_bf16 v[252:255],a[132:135],v[24:27],0
v_exp_f32 v87,v87
v_mfma_f32_16x16x32_bf16 v[204:207],a[132:135],v[20:23],0
ds_read_b128 a[132:135],v1 offset:30720
v_cvt_pk_bf16_f32 v50,v84,v85
v_mfma_f32_16x16x32_bf16 v[200:203],a[128:131],v[20:23],0
s_waitcnt lgkmcnt(2)
ds_read_b128 a[128:131],v0 offset:30720
v_cvt_pk_bf16_f32 v51,v86,v87
v_mfma_f32_16x16x32_bf16 v[72:75],a[124:127],a[20:23],0
v_exp_f32 v92,v92
v_smfmac_f32_16x16x64_bf16 v[60:63],a[152:155],v[44:51],v18
buffer_load_dwordx4 v7,s[8:11],s21 offen offset:1024 lds
v_mfma_f32_16x16x32_bf16 v[72:75],a[120:123],a[16:19],v[72:75]
v_exp_f32 v93,v93
v_mfma_f32_16x16x32_bf16 v[72:75],a[148:151],a[12:15],v[72:75]
v_exp_f32 v94,v94
v_mfma_f32_16x16x32_bf16 v[72:75],a[144:147],a[8:11],v[72:75]
v_exp_f32 v95,v95
v_mfma_f32_16x16x32_bf16 v[72:75],a[140:143],a[4:7],v[72:75]
s_waitcnt lgkmcnt(1)
v_cvt_pk_bf16_f32 v54,v92,v93
v_cvt_pk_bf16_f32 v55,v94,v95
v_mfma_f32_16x16x32_bf16 v[72:75],a[136:139],a[0:3],v[72:75]
v_fma_f32 v101,v101,s36,v16
v_fma_f32 v102,v102,s36,v16
v_mfma_f32_16x16x32_bf16 v[80:83],a[136:139],a[24:27],0
v_fma_f32 v103,v103,s36,v16
v_mfma_f32_16x16x32_bf16 v[80:83],a[140:143],a[28:31],v[80:83]
v_exp_f32 v100,v100
v_mfma_f32_16x16x32_bf16 v[80:83],a[144:147],a[32:35],v[80:83]
buffer_load_dwordx4 v8,s[8:11],s21 offen offset:2048 lds
v_mfma_f32_16x16x32_bf16 v[80:83],a[148:151],a[36:39],v[80:83]
s_add_u32 s21,s21,12288
v_exp_f32 v101,v101
v_mfma_f32_16x16x32_bf16 v[80:83],a[120:123],a[40:43],v[80:83]
s_add_u32 m0,s22,12288
v_exp_f32 v102,v102
v_mfma_f32_16x16x32_bf16 v[80:83],a[124:127],a[44:47],v[80:83]
v_exp_f32 v103,v103
v_mfma_f32_16x16x32_bf16 v[88:91],a[124:127],a[68:71],0
v_cvt_pk_bf16_f32 v58,v100,v101
v_cvt_pk_bf16_f32 v59,v102,v103
v_mfma_f32_16x16x32_bf16 v[88:91],a[120:123],a[64:67],v[88:91]
v_fma_f32 v72,v72,s36,v13
v_fma_f32 v73,v73,s36,v13
v_smfmac_f32_16x16x64_bf16 v[64:67],a[152:155],v[52:59],v18
v_fma_f32 v74,v74,s36,v13
v_mfma_f32_16x16x32_bf16 v[88:91],a[148:151],a[60:63],v[88:91]
v_fma_f32 v75,v75,s36,v13
v_fma_f32 v80,v80,s36,v14
v_mfma_f32_16x16x32_bf16 v[88:91],a[144:147],a[56:59],v[88:91]
v_fma_f32 v81,v81,s36,v14
v_mfma_f32_16x16x32_bf16 v[88:91],a[140:143],a[52:55],v[88:91]
buffer_load_dwordx4 v6,s[4:7],s20 offen offset:0 lds
v_mfma_f32_16x16x32_bf16 v[88:91],a[136:139],a[48:51],v[88:91]
v_exp_f32 v72,v72
v_mfma_f32_16x16x32_bf16 v[96:99],a[136:139],a[72:75],0
ds_read_b128 a[136:139],v0 offset:30848
v_mfma_f32_16x16x32_bf16 v[96:99],a[140:143],a[76:79],v[96:99]
ds_read_b128 a[140:143],v1 offset:30848
v_mfma_f32_16x16x32_bf16 v[96:99],a[144:147],a[80:83],v[96:99]
ds_read_b128 a[144:147],v0 offset:30976
v_mfma_f32_16x16x32_bf16 v[96:99],a[148:151],a[84:87],v[96:99]
ds_read_b128 a[148:151],v1 offset:30976
v_mfma_f32_16x16x32_bf16 v[96:99],a[120:123],a[88:91],v[96:99]
v_exp_f32 v73,v73
v_mfma_f32_16x16x32_bf16 v[96:99],a[124:127],a[92:95],v[96:99]
s_waitcnt lgkmcnt(4)
v_exp_f32 v74,v74
v_mfma_f32_16x16x32_bf16 v[76:79],a[128:131],a[0:3],0
v_exp_f32 v75,v75
v_mfma_f32_16x16x32_bf16 v[76:79],a[132:135],a[4:7],v[76:79]
buffer_load_dwordx4 v7,s[4:7],s20 offen offset:1024 lds
s_waitcnt lgkmcnt(3)
v_mfma_f32_16x16x32_bf16 v[76:79],a[136:139],a[8:11],v[76:79]
s_waitcnt lgkmcnt(2)
v_exp_f32 v80,v80
v_mfma_f32_16x16x32_bf16 v[76:79],a[140:143],a[12:15],v[76:79]
s_waitcnt lgkmcnt(0)
v_exp_f32 v81,v81
v_mfma_f32_16x16x32_bf16 v[76:79],a[144:147],a[16:19],v[76:79]
v_cvt_pk_bf16_f32 v20,v72,v73
v_cvt_pk_bf16_f32 v21,v74,v75
v_mfma_f32_16x16x32_bf16 v[76:79],a[148:151],a[20:23],v[76:79]
v_cvt_pk_bf16_f32 v24,v80,v81
v_mfma_f32_16x16x32_bf16 v[84:87],a[148:151],a[44:47],0
v_mfma_f32_16x16x32_bf16 v[84:87],a[144:147],a[40:43],v[84:87]
v_mfma_f32_16x16x32_bf16 v[84:87],a[140:143],a[36:39],v[84:87]
v_mfma_f32_16x16x32_bf16 v[84:87],a[136:139],a[32:35],v[84:87]
v_mfma_f32_16x16x32_bf16 v[84:87],a[132:135],a[28:31],v[84:87]
buffer_load_dwordx4 v8,s[4:7],s20 offen offset:2048 lds
v_mfma_f32_16x16x32_bf16 v[84:87],a[128:131],a[24:27],v[84:87]
s_add_u32 s20,s20,12288
v_mfma_f32_16x16x32_bf16 v[92:95],a[128:131],a[48:51],0
ds_read_b64_tr_b16 a[120:121],v2 offset:12288
v_mfma_f32_16x16x32_bf16 v[92:95],a[132:135],a[52:55],v[92:95]
ds_read_b64_tr_b16 a[122:123],v2 offset:18432
v_mfma_f32_16x16x32_bf16 v[92:95],a[136:139],a[56:59],v[92:95]
ds_read_b64_tr_b16 a[124:125],v3 offset:12288
v_mfma_f32_16x16x32_bf16 v[92:95],a[140:143],a[60:63],v[92:95]
ds_read_b64_tr_b16 a[126:127],v3 offset:18432
v_mfma_f32_16x16x32_bf16 v[92:95],a[144:147],a[64:67],v[92:95]
v_mfma_f32_16x16x32_bf16 v[92:95],a[148:151],a[68:71],v[92:95]
v_mfma_f32_16x16x32_bf16 v[100:103],a[148:151],a[92:95],0
v_mfma_f32_16x16x32_bf16 v[100:103],a[144:147],a[88:91],v[100:103]
v_mfma_f32_16x16x32_bf16 v[100:103],a[140:143],a[84:87],v[100:103]
v_mfma_f32_16x16x32_bf16 v[100:103],a[136:139],a[80:83],v[100:103]
v_mfma_f32_16x16x32_bf16 v[100:103],a[132:135],a[76:79],v[100:103]
ds_read_b64_tr_b16 a[132:133],v5 offset:12288
v_mfma_f32_16x16x32_bf16 v[100:103],a[128:131],a[72:75],v[100:103]
s_waitcnt lgkmcnt(1)
ds_read_b64_tr_b16 a[128:129],v4 offset:12288
ds_read_b64_tr_b16 a[130:131],v4 offset:18432
ds_read_b64_tr_b16 a[134:135],v5 offset:18432
v_mfma_f32_16x16x32_bf16 v[160:163],a[120:123],v[44:47],v[160:163]
s_add_u32 m0,s23,12288
ds_read_b64_tr_b16 a[136:137],v2 offset:12416
v_fma_f32 v82,v82,s36,v14
v_mfma_f32_16x16x32_bf16 v[164:167],a[124:127],v[44:47],v[164:167]
ds_read_b64_tr_b16 a[138:139],v2 offset:18560
v_fma_f32 v83,v83,s36,v14
v_mfma_f32_16x16x32_bf16 v[212:215],a[124:127],v[48:51],v[212:215]
ds_read_b64_tr_b16 a[140:141],v3 offset:12416
v_fma_f32 v88,v88,s36,v15
v_mfma_f32_16x16x32_bf16 v[208:211],a[120:123],v[48:51],v[208:211]
ds_read_b64_tr_b16 a[142:143],v3 offset:18560
v_fma_f32 v89,v89,s36,v15
v_mfma_f32_16x16x32_bf16 v[112:115],a[120:123],v[52:55],v[112:115]
ds_read_b64_tr_b16 a[144:145],v4 offset:12416
v_fma_f32 v90,v90,s36,v15
v_mfma_f32_16x16x32_bf16 v[116:119],a[124:127],v[52:55],v[116:119]
ds_read_b64_tr_b16 a[146:147],v4 offset:18560
v_fma_f32 v91,v91,s36,v15
v_mfma_f32_16x16x32_bf16 a[164:167],a[124:127],v[56:59],a[164:167]
ds_read_b64_tr_b16 a[148:149],v5 offset:12416
v_fma_f32 v96,v96,s36,v16
v_mfma_f32_16x16x32_bf16 a[160:163],a[120:123],v[56:59],a[160:163]
s_waitcnt lgkmcnt(6)
ds_read_b64_tr_b16 a[150:151],v5 offset:18560
v_fma_f32 v97,v97,s36,v16
v_mfma_f32_16x16x32_bf16 a[168:171],a[128:131],v[56:59],a[168:171]
ds_read_b64_tr_b16 a[120:121],v2 offset:12544
v_fma_f32 v98,v98,s36,v16
v_mfma_f32_16x16x32_bf16 a[172:175],a[132:135],v[56:59],a[172:175]
ds_read_b64_tr_b16 a[122:123],v2 offset:18688
v_fma_f32 v99,v99,s36,v16
v_mfma_f32_16x16x32_bf16 v[124:127],a[132:135],v[52:55],v[124:127]
ds_read_b64_tr_b16 a[124:125],v3 offset:12544
v_fma_f32 v76,v76,s36,v13
v_mfma_f32_16x16x32_bf16 v[120:123],a[128:131],v[52:55],v[120:123]
ds_read_b64_tr_b16 a[126:127],v3 offset:18688
v_fma_f32 v77,v77,s36,v13
v_mfma_f32_16x16x32_bf16 v[216:219],a[128:131],v[48:51],v[216:219]
v_exp_f32 v82,v82
v_mfma_f32_16x16x32_bf16 v[220:223],a[132:135],v[48:51],v[220:223]
v_exp_f32 v83,v83
v_mfma_f32_16x16x32_bf16 v[172:175],a[132:135],v[44:47],v[172:175]
ds_read_b64_tr_b16 a[132:133],v5 offset:12544
v_cvt_pk_bf16_f32 v25,v82,v83
v_mfma_f32_16x16x32_bf16 v[168:171],a[128:131],v[44:47],v[168:171]
s_waitcnt lgkmcnt(4)
ds_read_b64_tr_b16 a[128:129],v4 offset:12544
v_fma_f32 v78,v78,s36,v13
v_mfma_f32_16x16x32_bf16 v[176:179],a[136:139],v[44:47],v[176:179]
ds_read_b64_tr_b16 a[130:131],v4 offset:18688
v_fma_f32 v79,v79,s36,v13
v_mfma_f32_16x16x32_bf16 v[180:183],a[140:143],v[44:47],v[180:183]
ds_read_b64_tr_b16 a[134:135],v5 offset:18688
v_fma_f32 v84,v84,s36,v14
v_mfma_f32_16x16x32_bf16 v[228:231],a[140:143],v[48:51],v[228:231]
v_exp_f32 v88,v88
v_mfma_f32_16x16x32_bf16 v[224:227],a[136:139],v[48:51],v[224:227]
v_exp_f32 v89,v89
v_mfma_f32_16x16x32_bf16 v[128:131],a[136:139],v[52:55],v[128:131]
v_exp_f32 v90,v90
v_mfma_f32_16x16x32_bf16 v[132:135],a[140:143],v[52:55],v[132:135]
v_exp_f32 v91,v91
v_mfma_f32_16x16x32_bf16 a[180:183],a[140:143],v[56:59],a[180:183]
v_cvt_pk_bf16_f32 v28,v88,v89
v_cvt_pk_bf16_f32 v29,v90,v91
v_mfma_f32_16x16x32_bf16 a[176:179],a[136:139],v[56:59],a[176:179]
v_exp_f32 v96,v96
v_mfma_f32_16x16x32_bf16 a[184:187],a[144:147],v[56:59],a[184:187]
v_exp_f32 v97,v97
v_mfma_f32_16x16x32_bf16 a[188:191],a[148:151],v[56:59],a[188:191]
v_exp_f32 v98,v98
v_mfma_f32_16x16x32_bf16 v[140:143],a[148:151],v[52:55],v[140:143]
v_exp_f32 v99,v99
v_mfma_f32_16x16x32_bf16 v[136:139],a[144:147],v[52:55],v[136:139]
v_cvt_pk_bf16_f32 v32,v96,v97
v_cvt_pk_bf16_f32 v33,v98,v99
v_mfma_f32_16x16x32_bf16 v[232:235],a[144:147],v[48:51],v[232:235]
v_exp_f32 v76,v76
v_mfma_f32_16x16x32_bf16 v[236:239],a[148:151],v[48:51],v[236:239]
v_exp_f32 v77,v77
v_mfma_f32_16x16x32_bf16 v[188:191],a[148:151],v[44:47],v[188:191]
v_exp_f32 v78,v78
v_mfma_f32_16x16x32_bf16 v[184:187],a[144:147],v[44:47],v[184:187]
s_waitcnt lgkmcnt(0)
v_exp_f32 v79,v79
v_mfma_f32_16x16x32_bf16 v[192:195],a[120:123],v[44:47],v[192:195]
v_cvt_pk_bf16_f32 v22,v76,v77
v_cvt_pk_bf16_f32 v23,v78,v79
v_mfma_f32_16x16x32_bf16 v[196:199],a[124:127],v[44:47],v[196:199]
s_waitcnt vmcnt(6)
v_fma_f32 v85,v85,s36,v14
v_fma_f32 v86,v86,s36,v14
v_mfma_f32_16x16x32_bf16 v[244:247],a[124:127],v[48:51],v[244:247]
s_barrier
v_mfma_f32_16x16x32_bf16 v[240:243],a[120:123],v[48:51],v[240:243]
ds_read_b128 a[148:151],v1 offset:128
v_fma_f32 v87,v87,s36,v14
v_mfma_f32_16x16x32_bf16 v[144:147],a[120:123],v[52:55],v[144:147]
ds_read_b128 a[144:147],v0 offset:128
v_fma_f32 v92,v92,s36,v15
v_mfma_f32_16x16x32_bf16 v[148:151],a[124:127],v[52:55],v[148:151]
ds_read_b128 a[140:143],v1 offset:0
v_fma_f32 v93,v93,s36,v15
v_mfma_f32_16x16x32_bf16 a[196:199],a[124:127],v[56:59],a[196:199]
ds_read_b128 a[124:127],v1 offset:256
v_fma_f32 v94,v94,s36,v15
v_mfma_f32_16x16x32_bf16 a[192:195],a[120:123],v[56:59],a[192:195]
ds_read_b128 a[120:123],v0 offset:256
v_fma_f32 v95,v95,s36,v15
v_mfma_f32_16x16x32_bf16 a[200:203],a[128:131],v[56:59],a[200:203]
buffer_load_dwordx4 v6,s[8:11],s21 offen offset:0 lds
v_mfma_f32_16x16x32_bf16 a[204:207],a[132:135],v[56:59],a[204:207]
ds_read_b128 a[136:139],v0 offset:0
v_fma_f32 v100,v100,s36,v16
v_mfma_f32_16x16x32_bf16 v[156:159],a[132:135],v[52:55],v[156:159]
v_exp_f32 v84,v84
v_mfma_f32_16x16x32_bf16 v[152:155],a[128:131],v[52:55],v[152:155]
v_exp_f32 v85,v85
v_mfma_f32_16x16x32_bf16 v[248:251],a[128:131],v[48:51],v[248:251]
v_exp_f32 v86,v86
v_mfma_f32_16x16x32_bf16 v[252:255],a[132:135],v[48:51],v[252:255]
v_exp_f32 v87,v87
v_mfma_f32_16x16x32_bf16 v[204:207],a[132:135],v[44:47],v[204:207]
ds_read_b128 a[132:135],v1 offset:6144
v_cvt_pk_bf16_f32 v26,v84,v85
v_mfma_f32_16x16x32_bf16 v[200:203],a[128:131],v[44:47],v[200:203]
s_waitcnt lgkmcnt(2)
ds_read_b128 a[128:131],v0 offset:6144
v_cvt_pk_bf16_f32 v27,v86,v87
v_mfma_f32_16x16x32_bf16 v[72:75],a[124:127],a[20:23],0
v_exp_f32 v92,v92
v_smfmac_f32_16x16x64_bf16 v[60:63],a[152:155],v[20:27],v18
buffer_load_dwordx4 v7,s[8:11],s21 offen offset:1024 lds
v_mfma_f32_16x16x32_bf16 v[72:75],a[120:123],a[16:19],v[72:75]
v_exp_f32 v93,v93
v_mfma_f32_16x16x32_bf16 v[72:75],a[148:151],a[12:15],v[72:75]
v_exp_f32 v94,v94
v_mfma_f32_16x16x32_bf16 v[72:75],a[144:147],a[8:11],v[72:75]
v_exp_f32 v95,v95
v_mfma_f32_16x16x32_bf16 v[72:75],a[140:143],a[4:7],v[72:75]
s_waitcnt lgkmcnt(1)
v_cvt_pk_bf16_f32 v30,v92,v93
v_cvt_pk_bf16_f32 v31,v94,v95
v_mfma_f32_16x16x32_bf16 v[72:75],a[136:139],a[0:3],v[72:75]
v_fma_f32 v101,v101,s36,v16
v_fma_f32 v102,v102,s36,v16
v_mfma_f32_16x16x32_bf16 v[80:83],a[136:139],a[24:27],0
v_fma_f32 v103,v103,s36,v16
v_mfma_f32_16x16x32_bf16 v[80:83],a[140:143],a[28:31],v[80:83]
v_exp_f32 v100,v100
v_mfma_f32_16x16x32_bf16 v[80:83],a[144:147],a[32:35],v[80:83]
buffer_load_dwordx4 v8,s[8:11],s21 offen offset:2048 lds
v_mfma_f32_16x16x32_bf16 v[80:83],a[148:151],a[36:39],v[80:83]
s_add_u32 s21,s21,12288
v_exp_f32 v101,v101
v_mfma_f32_16x16x32_bf16 v[80:83],a[120:123],a[40:43],v[80:83]
s_add_u32 m0,s22,24576
v_exp_f32 v102,v102
v_mfma_f32_16x16x32_bf16 v[80:83],a[124:127],a[44:47],v[80:83]
v_exp_f32 v103,v103
v_mfma_f32_16x16x32_bf16 v[88:91],a[124:127],a[68:71],0
v_cvt_pk_bf16_f32 v34,v100,v101
v_cvt_pk_bf16_f32 v35,v102,v103
v_mfma_f32_16x16x32_bf16 v[88:91],a[120:123],a[64:67],v[88:91]
v_fma_f32 v72,v72,s36,v13
v_fma_f32 v73,v73,s36,v13
v_smfmac_f32_16x16x64_bf16 v[64:67],a[152:155],v[28:35],v18
v_fma_f32 v74,v74,s36,v13
v_mfma_f32_16x16x32_bf16 v[88:91],a[148:151],a[60:63],v[88:91]
v_fma_f32 v75,v75,s36,v13
v_fma_f32 v80,v80,s36,v14
v_mfma_f32_16x16x32_bf16 v[88:91],a[144:147],a[56:59],v[88:91]
v_fma_f32 v81,v81,s36,v14
v_mfma_f32_16x16x32_bf16 v[88:91],a[140:143],a[52:55],v[88:91]
buffer_load_dwordx4 v6,s[4:7],s20 offen offset:0 lds
v_mfma_f32_16x16x32_bf16 v[88:91],a[136:139],a[48:51],v[88:91]
v_exp_f32 v72,v72
v_mfma_f32_16x16x32_bf16 v[96:99],a[136:139],a[72:75],0
ds_read_b128 a[136:139],v0 offset:6272
v_mfma_f32_16x16x32_bf16 v[96:99],a[140:143],a[76:79],v[96:99]
ds_read_b128 a[140:143],v1 offset:6272
v_mfma_f32_16x16x32_bf16 v[96:99],a[144:147],a[80:83],v[96:99]
ds_read_b128 a[144:147],v0 offset:6400
v_mfma_f32_16x16x32_bf16 v[96:99],a[148:151],a[84:87],v[96:99]
ds_read_b128 a[148:151],v1 offset:6400
v_mfma_f32_16x16x32_bf16 v[96:99],a[120:123],a[88:91],v[96:99]
v_exp_f32 v73,v73
v_mfma_f32_16x16x32_bf16 v[96:99],a[124:127],a[92:95],v[96:99]
s_waitcnt lgkmcnt(4)
v_exp_f32 v74,v74
v_mfma_f32_16x16x32_bf16 v[76:79],a[128:131],a[0:3],0
v_exp_f32 v75,v75
v_mfma_f32_16x16x32_bf16 v[76:79],a[132:135],a[4:7],v[76:79]
buffer_load_dwordx4 v7,s[4:7],s20 offen offset:1024 lds
s_waitcnt lgkmcnt(3)
v_mfma_f32_16x16x32_bf16 v[76:79],a[136:139],a[8:11],v[76:79]
s_waitcnt lgkmcnt(2)
v_exp_f32 v80,v80
v_mfma_f32_16x16x32_bf16 v[76:79],a[140:143],a[12:15],v[76:79]
s_waitcnt lgkmcnt(0)
v_exp_f32 v81,v81
v_mfma_f32_16x16x32_bf16 v[76:79],a[144:147],a[16:19],v[76:79]
v_cvt_pk_bf16_f32 v44,v72,v73
v_cvt_pk_bf16_f32 v45,v74,v75
v_mfma_f32_16x16x32_bf16 v[76:79],a[148:151],a[20:23],v[76:79]
v_cvt_pk_bf16_f32 v48,v80,v81
v_mfma_f32_16x16x32_bf16 v[84:87],a[148:151],a[44:47],0
v_mfma_f32_16x16x32_bf16 v[84:87],a[144:147],a[40:43],v[84:87]
v_mfma_f32_16x16x32_bf16 v[84:87],a[140:143],a[36:39],v[84:87]
v_mfma_f32_16x16x32_bf16 v[84:87],a[136:139],a[32:35],v[84:87]
v_mfma_f32_16x16x32_bf16 v[84:87],a[132:135],a[28:31],v[84:87]
buffer_load_dwordx4 v8,s[4:7],s20 offen offset:2048 lds
v_mfma_f32_16x16x32_bf16 v[84:87],a[128:131],a[24:27],v[84:87]
s_add_u32 s20,s20,12288
v_mfma_f32_16x16x32_bf16 v[92:95],a[128:131],a[48:51],0
ds_read_b64_tr_b16 a[120:121],v2 offset:24576
v_mfma_f32_16x16x32_bf16 v[92:95],a[132:135],a[52:55],v[92:95]
ds_read_b64_tr_b16 a[122:123],v2 offset:30720
v_mfma_f32_16x16x32_bf16 v[92:95],a[136:139],a[56:59],v[92:95]
ds_read_b64_tr_b16 a[124:125],v3 offset:24576
v_mfma_f32_16x16x32_bf16 v[92:95],a[140:143],a[60:63],v[92:95]
ds_read_b64_tr_b16 a[126:127],v3 offset:30720
v_mfma_f32_16x16x32_bf16 v[92:95],a[144:147],a[64:67],v[92:95]
v_mfma_f32_16x16x32_bf16 v[92:95],a[148:151],a[68:71],v[92:95]
v_mfma_f32_16x16x32_bf16 v[100:103],a[148:151],a[92:95],0
v_mfma_f32_16x16x32_bf16 v[100:103],a[144:147],a[88:91],v[100:103]
v_mfma_f32_16x16x32_bf16 v[100:103],a[140:143],a[84:87],v[100:103]
v_mfma_f32_16x16x32_bf16 v[100:103],a[136:139],a[80:83],v[100:103]
v_mfma_f32_16x16x32_bf16 v[100:103],a[132:135],a[76:79],v[100:103]
ds_read_b64_tr_b16 a[132:133],v5 offset:24576
v_mfma_f32_16x16x32_bf16 v[100:103],a[128:131],a[72:75],v[100:103]
ds_read_b64_tr_b16 a[128:129],v4 offset:24576
ds_read_b64_tr_b16 a[130:131],v4 offset:30720
ds_read_b64_tr_b16 a[134:135],v5 offset:30720
s_mov_b32 s38,0
s_branch L_loop4
L_tr55:
s_waitcnt vmcnt(43)
s_waitcnt lgkmcnt(3)
v_mfma_f32_16x16x32_bf16 v[160:163],a[120:123],v[20:23],v[160:163]
s_add_u32 m0,s24,0
ds_read_b128 a[12:15],v12 offset:128
v_fma_f32 v101,v101,s36,v16
v_mfma_f32_16x16x32_bf16 v[164:167],a[124:127],v[20:23],v[164:167]
ds_read_b128 a[20:23],v12 offset:256
v_fma_f32 v103,v103,s36,v16
v_mfma_f32_16x16x32_bf16 v[212:215],a[124:127],v[24:27],v[212:215]
ds_read_b128 a[4:7],v12 offset:0
v_fma_f32 v87,v87,s36,v14
v_mfma_f32_16x16x32_bf16 v[208:211],a[120:123],v[24:27],v[208:211]
ds_read_b128 a[16:19],v11 offset:256
v_fma_f32 v106,v106,s36,v17
v_mfma_f32_16x16x32_bf16 v[112:115],a[120:123],v[28:31],v[112:115]
ds_read_b128 a[0:3],v11 offset:0
v_fma_f32 v99,v99,s36,v16
v_mfma_f32_16x16x32_bf16 v[116:119],a[124:127],v[28:31],v[116:119]
ds_read_b128 a[8:11],v11 offset:128
v_fma_f32 v96,v96,s36,v16
v_mfma_f32_16x16x32_bf16 a[164:167],a[124:127],v[32:35],a[164:167]
ds_read_b64_tr_b16 a[136:137],v2 offset:24704
v_fma_f32 v77,v77,s36,v13
v_mfma_f32_16x16x32_bf16 a[160:163],a[120:123],v[32:35],a[160:163]
ds_read_b64_tr_b16 a[138:139],v2 offset:30848
v_fma_f32 v85,v85,s36,v14
v_mfma_f32_16x16x32_bf16 a[208:211],a[120:123],v[36:39],a[208:211]
ds_read_b64_tr_b16 a[140:141],v3 offset:24704
ds_read_b64_tr_b16 a[142:143],v3 offset:30848
ds_read_b64_tr_b16 a[144:145],v4 offset:24704
ds_read_b64_tr_b16 a[146:147],v4 offset:30848
ds_read_b64_tr_b16 a[150:151],v5 offset:30848
ds_read_b64_tr_b16 a[148:149],v5 offset:24704
ds_read_b128 a[40:43],v11 offset:6400
v_mfma_f32_16x16x32_bf16 a[212:215],a[124:127],v[36:39],a[212:215]
s_waitcnt lgkmcnt(11)
v_fma_f32 v84,v84,s36,v14
ds_read_b128 a[32:35],v11 offset:6272
v_mfma_f32_16x16x32_bf16 a[216:219],a[128:131],v[36:39],a[216:219]
s_waitcnt lgkmcnt(10)
buffer_load_dwordx4 v6,s[12:15],s28 offen offset:0 nt lds
v_mfma_f32_16x16x32_bf16 a[220:223],a[132:135],v[36:39],a[220:223]
ds_read_b64_tr_b16 a[122:123],v2 offset:30976
ds_read_b128 a[44:47],v12 offset:6400
v_mfma_f32_16x16x32_bf16 a[172:175],a[132:135],v[32:35],a[172:175]
v_exp_f32 v101,v101
ds_read_b64_tr_b16 a[120:121],v2 offset:24832
ds_read_b128 a[24:27],v11 offset:6144
v_mfma_f32_16x16x32_bf16 a[168:171],a[128:131],v[32:35],a[168:171]
v_exp_f32 v77,v77
ds_read_b128 a[28:31],v12 offset:6144
v_mfma_f32_16x16x32_bf16 v[120:123],a[128:131],v[28:31],v[120:123]
v_fma_f32 v111,v111,s36,v17
ds_read_b64_tr_b16 a[126:127],v3 offset:30976
ds_read_b64_tr_b16 a[124:125],v3 offset:24832
ds_read_b128 a[36:39],v12 offset:6272
v_mfma_f32_16x16x32_bf16 v[124:127],a[132:135],v[28:31],v[124:127]
buffer_load_dwordx4 v7,s[12:15],s28 offen offset:1024 nt lds
v_mfma_f32_16x16x32_bf16 v[220:223],a[132:135],v[24:27],v[220:223]
v_fma_f32 v95,v95,s36,v15
v_fma_f32 v100,v100,s36,v16
v_mfma_f32_16x16x32_bf16 v[216:219],a[128:131],v[24:27],v[216:219]
v_exp_f32 v106,v106
v_mfma_f32_16x16x32_bf16 v[168:171],a[128:131],v[20:23],v[168:171]
ds_read_b64_tr_b16 a[130:131],v4 offset:30976
v_fma_f32 v93,v93,s36,v15
v_mfma_f32_16x16x32_bf16 v[172:175],a[132:135],v[20:23],v[172:175]
s_waitcnt lgkmcnt(4)
ds_read_b64_tr_b16 a[128:129],v4 offset:24832
v_exp_f32 v111,v111
v_mfma_f32_16x16x32_bf16 v[176:179],a[136:139],v[20:23],v[176:179]
ds_read_b64_tr_b16 a[132:133],v5 offset:24832
buffer_load_dwordx4 v8,s[12:15],s28 offen offset:2048 nt lds
v_mfma_f32_16x16x32_bf16 v[180:183],a[140:143],v[20:23],v[180:183]
s_add_u32 s28,s28,3072
ds_read_b64_tr_b16 a[134:135],v5 offset:30976
v_fma_f32 v107,v107,s36,v17
v_mfma_f32_16x16x32_bf16 v[228:231],a[140:143],v[24:27],v[228:231]
s_add_u32 m0,s24,3072
v_fma_f32 v92,v92,s36,v15
v_exp_f32 v92,v92
v_mfma_f32_16x16x32_bf16 v[224:227],a[136:139],v[24:27],v[224:227]
v_fma_f32 v109,v109,s36,v17
v_exp_f32 v109,v109
v_mfma_f32_16x16x32_bf16 v[128:131],a[136:139],v[28:31],v[128:131]
v_fma_f32 v97,v97,s36,v16
v_exp_f32 v84,v84
v_mfma_f32_16x16x32_bf16 v[132:135],a[140:143],v[28:31],v[132:135]
v_fma_f32 v94,v94,s36,v15
v_exp_f32 v94,v94
v_mfma_f32_16x16x32_bf16 a[180:183],a[140:143],v[32:35],a[180:183]
v_fma_f32 v104,v104,s36,v17
v_fma_f32 v90,v90,s36,v15
v_mfma_f32_16x16x32_bf16 a[176:179],a[136:139],v[32:35],a[176:179]
buffer_load_dwordx4 v6,s[12:15],s28 offen offset:0 nt lds
v_mfma_f32_16x16x32_bf16 a[224:227],a[136:139],v[36:39],a[224:227]
v_exp_f32 v93,v93
v_mfma_f32_16x16x32_bf16 a[228:231],a[140:143],v[36:39],a[228:231]
v_exp_f32 v104,v104
v_mfma_f32_16x16x32_bf16 a[232:235],a[144:147],v[36:39],a[232:235]
v_exp_f32 v96,v96
v_mfma_f32_16x16x32_bf16 a[236:239],a[148:151],v[36:39],a[236:239]
v_fma_f32 v78,v78,s36,v13
v_exp_f32 v78,v78
v_mfma_f32_16x16x32_bf16 a[188:191],a[148:151],v[32:35],a[188:191]
v_fma_f32 v110,v110,s36,v17
v_exp_f32 v110,v110
v_mfma_f32_16x16x32_bf16 a[184:187],a[144:147],v[32:35],a[184:187]
v_exp_f32 v97,v97
v_mfma_f32_16x16x32_bf16 v[136:139],a[144:147],v[28:31],v[136:139]
v_exp_f32 v100,v100
v_mfma_f32_16x16x32_bf16 v[140:143],a[148:151],v[28:31],v[140:143]
buffer_load_dwordx4 v7,s[12:15],s28 offen offset:1024 nt lds
v_mfma_f32_16x16x32_bf16 v[236:239],a[148:151],v[24:27],v[236:239]
v_fma_f32 v102,v102,s36,v16
v_exp_f32 v102,v102
v_mfma_f32_16x16x32_bf16 v[232:235],a[144:147],v[24:27],v[232:235]
v_fma_f32 v79,v79,s36,v13
v_exp_f32 v79,v79
v_mfma_f32_16x16x32_bf16 v[184:187],a[144:147],v[20:23],v[184:187]
v_exp_f32 v85,v85
v_mfma_f32_16x16x32_bf16 v[188:191],a[148:151],v[20:23],v[188:191]
v_fma_f32 v108,v108,s36,v17
v_exp_f32 v108,v108
v_mfma_f32_16x16x32_bf16 v[192:195],a[120:123],v[20:23],v[192:195]
s_waitcnt lgkmcnt(0)
v_fma_f32 v98,v98,s36,v16
v_exp_f32 v87,v87
v_mfma_f32_16x16x32_bf16 v[196:199],a[124:127],v[20:23],v[196:199]
v_fma_f32 v76,v76,s36,v13
v_exp_f32 v76,v76
v_mfma_f32_16x16x32_bf16 v[244:247],a[124:127],v[24:27],v[244:247]
buffer_load_dwordx4 v8,s[12:15],s28 offen offset:2048 nt lds
s_waitcnt vmcnt(20)
s_barrier
v_mfma_f32_16x16x32_bf16 v[240:243],a[120:123],v[24:27],v[240:243]
s_add_u32 s28,s28,3072
v_fma_f32 v105,v105,s36,v17
v_exp_f32 v107,v107
v_mfma_f32_16x16x32_bf16 v[144:147],a[120:123],v[28:31],v[144:147]
s_add_u32 m0,s22,0
v_fma_f32 v91,v91,s36,v15
v_exp_f32 v91,v91
v_mfma_f32_16x16x32_bf16 v[148:151],a[124:127],v[28:31],v[148:151]
buffer_load_dwordx4 v6,s[4:7],s25 offen offset:0 lds
v_mfma_f32_16x16x32_bf16 a[196:199],a[124:127],v[32:35],a[196:199]
buffer_load_dwordx4 v7,s[4:7],s25 offen offset:1024 lds
v_mfma_f32_16x16x32_bf16 a[192:195],a[120:123],v[32:35],a[192:195]
buffer_load_dwordx4 v8,s[4:7],s25 offen offset:2048 lds
v_mfma_f32_16x16x32_bf16 a[240:243],a[120:123],v[36:39],a[240:243]
v_fma_f32 v86,v86,s36,v14
v_exp_f32 v86,v86
v_mfma_f32_16x16x32_bf16 a[244:247],a[124:127],v[36:39],a[244:247]
v_exp_f32 v95,v95
v_mfma_f32_16x16x32_bf16 a[248:251],a[128:131],v[36:39],a[248:251]
v_exp_f32 v103,v103
v_mfma_f32_16x16x32_bf16 a[252:255],a[132:135],v[36:39],a[252:255]
ds_read_b64_tr_b16 a[136:137],v2 offset:0
v_cvt_pk_bf16_f32 v41,v106,v107
v_mfma_f32_16x16x32_bf16 a[204:207],a[132:135],v[32:35],a[204:207]
ds_read_b64_tr_b16 a[138:139],v2 offset:6144
v_exp_f32 v99,v99
v_mfma_f32_16x16x32_bf16 a[200:203],a[128:131],v[32:35],a[200:203]
ds_read_b64_tr_b16 a[140:141],v3 offset:0
v_cvt_pk_bf16_f32 v42,v108,v109
v_mfma_f32_16x16x32_bf16 v[152:155],a[128:131],v[28:31],v[152:155]
ds_read_b64_tr_b16 a[142:143],v3 offset:6144
v_cvt_pk_bf16_f32 v50,v84,v85
v_mfma_f32_16x16x32_bf16 v[156:159],a[132:135],v[28:31],v[156:159]
ds_read_b64_tr_b16 a[144:145],v4 offset:0
v_exp_f32 v90,v90
v_mfma_f32_16x16x32_bf16 v[252:255],a[132:135],v[24:27],v[252:255]
ds_read_b64_tr_b16 a[146:147],v4 offset:6144
v_exp_f32 v105,v105
v_mfma_f32_16x16x32_bf16 v[248:251],a[128:131],v[24:27],v[248:251]
ds_read_b64_tr_b16 a[148:149],v5 offset:0
v_cvt_pk_bf16_f32 v55,v94,v95
v_mfma_f32_16x16x32_bf16 v[200:203],a[128:131],v[20:23],v[200:203]
ds_read_b64_tr_b16 a[150:151],v5 offset:6144
v_cvt_pk_bf16_f32 v51,v86,v87
v_mfma_f32_16x16x32_bf16 v[204:207],a[132:135],v[20:23],v[204:207]
v_cvt_pk_bf16_f32 v59,v102,v103
v_exp_f32 v98,v98
v_cvt_pk_bf16_f32 v54,v92,v93
v_cvt_pk_bf16_f32 v56,v96,v97
v_cvt_pk_bf16_f32 v53,v90,v91
v_cvt_pk_bf16_f32 v47,v78,v79
v_cvt_pk_bf16_f32 v43,v110,v111
v_cvt_pk_bf16_f32 v58,v100,v101
v_cvt_pk_bf16_f32 v46,v76,v77
v_cvt_pk_bf16_f32 v57,v98,v99
v_cvt_pk_bf16_f32 v40,v104,v105
v_smfmac_f32_16x16x64_bf16 v[60:63],a[152:155],v[44:51],v18
v_subrev_u32 v10,18432,v10
v_smfmac_f32_16x16x64_bf16 v[64:67],a[152:155],v[52:59],v18
v_smfmac_f32_16x16x64_bf16 v[68:71],a[152:155],v[36:43],v18
s_waitcnt lgkmcnt(1)
v_mfma_f32_16x16x32_bf16 v[160:163],a[136:139],v[44:47],v[160:163]
s_add_u32 s87,s42,18432
ds_read_b64_tr_b16 a[120:121],v2 offset:128
v_mbcnt_lo_u32_b32 v39,-1,0
v_mfma_f32_16x16x32_bf16 v[164:167],a[140:143],v[44:47],v[164:167]
s_add_u32 s66,s42,24576
ds_read_b64_tr_b16 a[122:123],v2 offset:6272
v_mbcnt_hi_u32_b32 v39,-1,v39
v_mfma_f32_16x16x32_bf16 v[212:215],a[140:143],v[48:51],v[212:215]
ds_read_b64_tr_b16 a[124:125],v3 offset:128
v_and_b32 v38,7,v39
v_mfma_f32_16x16x32_bf16 v[208:211],a[136:139],v[48:51],v[208:211]
ds_read_b64_tr_b16 a[126:127],v3 offset:6272
v_add_f32 v68,v68,v69
v_mfma_f32_16x16x32_bf16 v[112:115],a[136:139],v[52:55],v[112:115]
ds_read_b64_tr_b16 a[128:129],v4 offset:128
v_add_f32 v60,v60,v61
v_mfma_f32_16x16x32_bf16 v[116:119],a[140:143],v[52:55],v[116:119]
ds_read_b64_tr_b16 a[130:131],v4 offset:6272
ds_read_b64_tr_b16 a[132:133],v5 offset:128
ds_read_b64_tr_b16 a[134:135],v5 offset:6272
v_mfma_f32_16x16x32_bf16 a[164:167],a[140:143],v[56:59],a[164:167]
v_add_f32 v62,v62,v63
v_add_f32 v64,v64,v65
v_mfma_f32_16x16x32_bf16 a[160:163],a[136:139],v[56:59],a[160:163]
v_add_f32 v68,v68,v70
v_add_f32 v66,v66,v67
v_mfma_f32_16x16x32_bf16 a[208:211],a[136:139],v[40:43],a[208:211]
ds_read_b64_tr_b16 a[136:137],v2 offset:256
v_max3_f32 v19,v60,v62,v64
v_mfma_f32_16x16x32_bf16 a[212:215],a[140:143],v[40:43],a[212:215]
ds_read_b64_tr_b16 a[138:139],v2 offset:6400
v_add_f32 v68,v68,v71
v_mfma_f32_16x16x32_bf16 a[216:219],a[144:147],v[40:43],a[216:219]
s_waitcnt lgkmcnt(6)
ds_read_b64_tr_b16 a[140:141],v3 offset:256
v_max3_f32 v19,v19,v66,v68
v_mfma_f32_16x16x32_bf16 a[220:223],a[148:151],v[40:43],a[220:223]
ds_read_b64_tr_b16 a[142:143],v3 offset:6400
v_rcp_f32 v66,v66
v_rcp_f32 v68,v68
v_accvgpr_read_b32 v72,a160
v_accvgpr_read_b32 v73,a161
v_pk_mul_f32 v[72:73],v[72:73],v[66:67] op_sel_hi:[1,0]
v_accvgpr_read_b32 v74,a162
v_accvgpr_read_b32 v75,a163
v_pk_mul_f32 v[74:75],v[74:75],v[66:67] op_sel_hi:[1,0]
v_accvgpr_read_b32 v76,a208
v_accvgpr_read_b32 v77,a209
v_pk_mul_f32 v[76:77],v[76:77],v[68:69] op_sel_hi:[1,0]
v_accvgpr_read_b32 v78,a210
v_accvgpr_read_b32 v79,a211
v_pk_mul_f32 v[78:79],v[78:79],v[68:69] op_sel_hi:[1,0]
v_accvgpr_read_b32 v80,a164
v_accvgpr_read_b32 v81,a165
v_mfma_f32_16x16x32_bf16 a[172:175],a[148:151],v[56:59],a[172:175]
v_accvgpr_read_b32 v82,a166
v_accvgpr_read_b32 v83,a167
v_accvgpr_read_b32 v84,a212
v_accvgpr_read_b32 v85,a213
v_accvgpr_read_b32 v86,a214
v_pk_mul_f32 v[80:81],v[80:81],v[66:67] op_sel_hi:[1,0]
v_pk_mul_f32 v[82:83],v[82:83],v[66:67] op_sel_hi:[1,0]
v_pk_mul_f32 v[84:85],v[84:85],v[68:69] op_sel_hi:[1,0]
v_accvgpr_read_b32 v87,a215
v_pk_mul_f32 v[86:87],v[86:87],v[68:69] op_sel_hi:[1,0]
v_accvgpr_read_b32 v92,a216
v_accvgpr_read_b32 v93,a217
v_mfma_f32_16x16x32_bf16 a[168:171],a[144:147],v[56:59],a[168:171]
v_accvgpr_read_b32 v94,a218
v_accvgpr_read_b32 v95,a219
v_mfma_f32_16x16x32_bf16 v[120:123],a[144:147],v[52:55],v[120:123]
v_accvgpr_read_b32 v100,a220
v_accvgpr_read_b32 v101,a221
v_mfma_f32_16x16x32_bf16 v[124:127],a[148:151],v[52:55],v[124:127]
v_accvgpr_read_b32 v102,a222
v_accvgpr_read_b32 v103,a223
v_mfma_f32_16x16x32_bf16 v[220:223],a[148:151],v[48:51],v[220:223]
v_accvgpr_read_b32 v88,a168
v_accvgpr_read_b32 v89,a169
v_accvgpr_read_b32 v90,a170
v_accvgpr_read_b32 v91,a171
v_accvgpr_read_b32 v96,a172
v_pk_mul_f32 v[92:93],v[92:93],v[68:69] op_sel_hi:[1,0]
v_pk_mul_f32 v[94:95],v[94:95],v[68:69] op_sel_hi:[1,0]
v_pk_mul_f32 v[88:89],v[88:89],v[66:67] op_sel_hi:[1,0]
v_pk_mul_f32 v[90:91],v[90:91],v[66:67] op_sel_hi:[1,0]
v_accvgpr_read_b32 v97,a173
v_accvgpr_read_b32 v98,a174
v_mfma_f32_16x16x32_bf16 v[216:219],a[144:147],v[48:51],v[216:219]
v_accvgpr_read_b32 v99,a175
v_cmp_ngt_f32 vcc,s37,v19
v_mfma_f32_16x16x32_bf16 v[168:171],a[144:147],v[44:47],v[168:171]
ds_read_b64_tr_b16 a[144:145],v4 offset:256
ds_read_b64_tr_b16 a[146:147],v4 offset:6400
v_lshrrev_b32 v19,5,v39
v_xor_b32 v38,v38,v19
v_pk_mul_f32 v[96:97],v[96:97],v[66:67] op_sel_hi:[1,0]
v_pk_mul_f32 v[98:99],v[98:99],v[66:67] op_sel_hi:[1,0]
v_pk_mul_f32 v[100:101],v[100:101],v[68:69] op_sel_hi:[1,0]
v_pk_mul_f32 v[102:103],v[102:103],v[68:69] op_sel_hi:[1,0]
v_and_b32 v19,15,v39
v_lshl_add_u32 v19,v19,7,s24
v_mfma_f32_16x16x32_bf16 v[172:175],a[148:151],v[44:47],v[172:175]
s_cmp_lg_u64 vcc,0
ds_read_b64_tr_b16 a[148:149],v5 offset:256
v_lshl_add_u32 v19,v38,4,v19
v_mfma_f32_16x16x32_bf16 v[176:179],a[120:123],v[44:47],v[176:179]
s_cselect_b32 s62,s32,0
ds_read_b64_tr_b16 a[150:151],v5 offset:6400
v_bfe_u32 v38,v39,4,1
v_mfma_f32_16x16x32_bf16 v[180:183],a[124:127],v[44:47],v[180:183]
s_or_b32 s31,s31,s62
v_lshl_add_u32 v36,v38,3,v19
v_xor_b32 v37,32,v36
v_mfma_f32_16x16x32_bf16 v[228:231],a[124:127],v[48:51],v[228:231]
s_lshl_b32 s32,s32,1
v_xor_b32 v38,64,v36
v_bfe_u32 v19,v39,3,1
v_mfma_f32_16x16x32_bf16 v[224:227],a[120:123],v[48:51],v[224:227]
s_add_u32 m0,s24,6144
v_xor_b32 v39,96,v36
v_lshlrev_b32 v19,11,v19
v_mfma_f32_16x16x32_bf16 v[128:131],a[120:123],v[52:55],v[128:131]
buffer_load_dwordx4 v6,s[12:15],s28 offen offset:0 nt lds
v_mfma_f32_16x16x32_bf16 v[132:135],a[124:127],v[52:55],v[132:135]
buffer_load_dwordx4 v7,s[12:15],s28 offen offset:1024 nt lds
v_mfma_f32_16x16x32_bf16 a[180:183],a[124:127],v[56:59],a[180:183]
buffer_load_dwordx4 v8,s[12:15],s28 offen offset:2048 nt lds
v_mfma_f32_16x16x32_bf16 a[176:179],a[120:123],v[56:59],a[176:179]
s_add_u32 s28,s28,3072
v_cvt_pk_bf16_f32 v72,v72,v73
v_cvt_pk_bf16_f32 v76,v76,v77
v_mfma_f32_16x16x32_bf16 a[224:227],a[120:123],v[40:43],a[224:227]
s_add_u32 m0,s24,9216
v_cvt_pk_bf16_f32 v80,v80,v81
v_cvt_pk_bf16_f32 v84,v84,v85
v_mfma_f32_16x16x32_bf16 a[228:231],a[124:127],v[40:43],a[228:231]
buffer_load_dwordx4 v6,s[12:15],s28 offen offset:0 nt lds
s_waitcnt lgkmcnt(0)
v_mfma_f32_16x16x32_bf16 a[232:235],a[128:131],v[40:43],a[232:235]
buffer_load_dwordx4 v7,s[12:15],s28 offen offset:1024 nt lds
v_mfma_f32_16x16x32_bf16 a[236:239],a[132:135],v[40:43],a[236:239]
buffer_load_dwordx4 v8,s[12:15],s28 offen offset:2048 nt lds
v_cvt_pk_bf16_f32 v73,v74,v75
v_cvt_pk_bf16_f32 v77,v78,v79
ds_write2st64_b64 v36,v[72:73],v[76:77] offset0:36 offset1:40
v_cvt_pk_bf16_f32 v81,v82,v83
v_cvt_pk_bf16_f32 v85,v86,v87
v_accvgpr_read_b32 v82,a178
v_accvgpr_read_b32 v83,a179
v_pk_mul_f32 v[82:83],v[82:83],v[66:67] op_sel_hi:[1,0]
v_accvgpr_read_b32 v86,a226
v_accvgpr_read_b32 v87,a227
v_pk_mul_f32 v[86:87],v[86:87],v[68:69] op_sel_hi:[1,0]
v_cvt_pk_bf16_f32 v92,v92,v93
v_cvt_pk_bf16_f32 v88,v88,v89
v_cvt_pk_bf16_f32 v93,v94,v95
ds_write2st64_b64 v37,v[80:81],v[84:85] offset0:36 offset1:40
v_accvgpr_read_b32 v80,a176
v_accvgpr_read_b32 v81,a177
v_pk_mul_f32 v[80:81],v[80:81],v[66:67] op_sel_hi:[1,0]
v_accvgpr_read_b32 v84,a224
v_accvgpr_read_b32 v85,a225
v_pk_mul_f32 v[84:85],v[84:85],v[68:69] op_sel_hi:[1,0]
v_cvt_pk_bf16_f32 v89,v90,v91
v_accvgpr_read_b32 v94,a230
v_mfma_f32_16x16x32_bf16 a[188:191],a[132:135],v[56:59],a[188:191]
s_add_u32 s28,s28,3072
v_accvgpr_read_b32 v95,a231
ds_write2st64_b64 v38,v[88:89],v[92:93] offset0:36 offset1:40
v_pk_mul_f32 v[94:95],v[94:95],v[68:69] op_sel_hi:[1,0]
v_accvgpr_read_b32 v90,a182
v_accvgpr_read_b32 v91,a183
v_pk_mul_f32 v[90:91],v[90:91],v[66:67] op_sel_hi:[1,0]
v_accvgpr_read_b32 v88,a180
v_accvgpr_read_b32 v89,a181
v_pk_mul_f32 v[88:89],v[88:89],v[66:67] op_sel_hi:[1,0]
v_accvgpr_read_b32 v92,a228
v_accvgpr_read_b32 v93,a229
v_pk_mul_f32 v[92:93],v[92:93],v[68:69] op_sel_hi:[1,0]
v_cvt_pk_bf16_f32 v96,v96,v97
v_cvt_pk_bf16_f32 v100,v100,v101
v_mfma_f32_16x16x32_bf16 a[184:187],a[128:131],v[56:59],a[184:187]
s_waitcnt vmcnt(21)
ds_read_b128 a[48:51],v11 offset:12288
v_cvt_pk_bf16_f32 v97,v98,v99
v_mfma_f32_16x16x32_bf16 v[136:139],a[128:131],v[52:55],v[136:139]
s_add_u32 m0,s23,0
ds_read_b128 a[52:55],v12 offset:12288
v_cvt_pk_bf16_f32 v101,v102,v103
v_mfma_f32_16x16x32_bf16 v[140:143],a[132:135],v[52:55],v[140:143]
ds_read_b128 a[56:59],v11 offset:12416
v_cvt_pk_bf16_f32 v80,v80,v81
v_mfma_f32_16x16x32_bf16 v[236:239],a[132:135],v[48:51],v[236:239]
ds_read_b128 a[60:63],v12 offset:12416
v_cvt_pk_bf16_f32 v84,v84,v85
ds_read_b128 a[64:67],v11 offset:12544
v_cvt_pk_bf16_f32 v81,v82,v83
ds_read_b128 a[68:71],v12 offset:12544
v_cvt_pk_bf16_f32 v85,v86,v87
ds_write2st64_b64 v39,v[96:97],v[100:101] offset0:36 offset1:40
v_accvgpr_read_b32 v98,a186
v_accvgpr_read_b32 v99,a187
v_pk_mul_f32 v[98:99],v[98:99],v[66:67] op_sel_hi:[1,0]
ds_read_b128 v[104:107],v10 offset:18432
v_accvgpr_read_b32 v102,a234
ds_read_b128 v[108:111],v10 offset:19456
v_accvgpr_read_b32 v103,a235
ds_read_b128 v[72:75],v10 offset:20480
v_pk_mul_f32 v[102:103],v[102:103],v[68:69] op_sel_hi:[1,0]
ds_read_b128 v[76:79],v10 offset:21504
v_accvgpr_read_b32 v82,a190
ds_write2st64_b64 v36,v[80:81],v[84:85] offset0:36 offset1:40
v_accvgpr_read_b32 v83,a191
v_pk_mul_f32 v[82:83],v[82:83],v[66:67] op_sel_hi:[1,0]
v_accvgpr_read_b32 v86,a238
v_accvgpr_read_b32 v87,a239
v_pk_mul_f32 v[86:87],v[86:87],v[68:69] op_sel_hi:[1,0]
v_accvgpr_read_b32 v96,a184
v_accvgpr_read_b32 v97,a185
s_waitcnt lgkmcnt(4)
buffer_store_dwordx4 v[104:107],v9,s[16:19],s87 offen offset:0 nt
v_pk_mul_f32 v[96:97],v[96:97],v[66:67] op_sel_hi:[1,0]
v_accvgpr_read_b32 v100,a232
v_accvgpr_read_b32 v101,a233
v_pk_mul_f32 v[100:101],v[100:101],v[68:69] op_sel_hi:[1,0]
v_accvgpr_read_b32 v80,a188
v_accvgpr_read_b32 v81,a189
v_pk_mul_f32 v[80:81],v[80:81],v[66:67] op_sel_hi:[1,0]
v_accvgpr_read_b32 v84,a236
v_accvgpr_read_b32 v85,a237
v_pk_mul_f32 v[84:85],v[84:85],v[68:69] op_sel_hi:[1,0]
v_cvt_pk_bf16_f32 v88,v88,v89
v_cvt_pk_bf16_f32 v92,v92,v93
v_mfma_f32_16x16x32_bf16 v[232:235],a[128:131],v[48:51],v[232:235]
s_waitcnt lgkmcnt(0)
buffer_store_dwordx4 v[108:111],v9,s[16:19],s87 offen offset:3072 nt
v_cvt_pk_bf16_f32 v96,v96,v97
v_cvt_pk_bf16_f32 v100,v100,v101
v_cvt_pk_bf16_f32 v89,v90,v91
v_mfma_f32_16x16x32_bf16 v[184:187],a[128:131],v[44:47],v[184:187]
v_cvt_pk_bf16_f32 v93,v94,v95
v_cvt_pk_bf16_f32 v80,v80,v81
v_mfma_f32_16x16x32_bf16 v[188:191],a[132:135],v[44:47],v[188:191]
v_cvt_pk_bf16_f32 v84,v84,v85
v_cvt_pk_bf16_f32 v97,v98,v99
v_mfma_f32_16x16x32_bf16 v[192:195],a[136:139],v[44:47],v[192:195]
ds_write2st64_b64 v37,v[88:89],v[92:93] offset0:36 offset1:40
v_mfma_f32_16x16x32_bf16 v[196:199],a[140:143],v[44:47],v[196:199]
v_cvt_pk_bf16_f32 v101,v102,v103
v_cvt_pk_bf16_f32 v81,v82,v83
v_mfma_f32_16x16x32_bf16 v[244:247],a[140:143],v[48:51],v[244:247]
buffer_store_dwordx4 v[72:75],v9,s[16:19],s66 offen offset:0 nt
v_cvt_pk_bf16_f32 v85,v86,v87
v_rcp_f32 v64,v64
v_mfma_f32_16x16x32_bf16 v[240:243],a[136:139],v[48:51],v[240:243]
v_rcp_f32 v60,v60
v_mfma_f32_16x16x32_bf16 v[144:147],a[136:139],v[52:55],v[144:147]
v_rcp_f32 v62,v62
v_mfma_f32_16x16x32_bf16 v[148:151],a[140:143],v[52:55],v[148:151]
ds_write2st64_b64 v38,v[96:97],v[100:101] offset0:36 offset1:40
v_mfma_f32_16x16x32_bf16 a[196:199],a[140:143],v[56:59],a[196:199]
v_mov_b32 v70,0
v_mov_b32 v71,0
v_mfma_f32_16x16x32_bf16 a[192:195],a[136:139],v[56:59],a[192:195]
buffer_store_dwordx4 v[76:79],v9,s[16:19],s66 offen offset:3072 nt
s_waitcnt vmcnt(10)
s_barrier
v_mfma_f32_16x16x32_bf16 a[240:243],a[136:139],v[40:43],a[240:243]
ds_read_b128 a[120:123],v0 offset:0
v_accvgpr_read_b32 v96,a196
v_mfma_f32_16x16x32_bf16 a[244:247],a[140:143],v[40:43],a[244:247]
ds_write2st64_b64 v39,v[80:81],v[84:85] offset0:36 offset1:40
v_mfma_f32_16x16x32_bf16 a[248:251],a[144:147],v[40:43],a[248:251]
v_accvgpr_read_b32 v104,a192
v_accvgpr_read_b32 v105,a193
v_mfma_f32_16x16x32_bf16 a[252:255],a[148:151],v[40:43],a[252:255]
ds_read_b128 v[72:75],v10 offset:18432
buffer_load_dwordx4 v6,s[8:11],s25 offen offset:0 lds
ds_read_b128 v[76:79],v10 offset:19456
v_pk_mul_f32 v[104:105],v[104:105],v[66:67] op_sel_hi:[1,0]
ds_read_b128 v[88:91],v10 offset:20480
v_accvgpr_read_b32 v106,a194
ds_read_b128 v[92:95],v10 offset:21504
v_accvgpr_read_b32 v107,a195
ds_read_b128 a[124:127],v1 offset:0
v_pk_mul_f32 v[106:107],v[106:107],v[66:67] op_sel_hi:[1,0]
ds_read_b128 a[128:131],v0 offset:128
v_accvgpr_read_b32 v108,a240
ds_read_b128 a[132:135],v1 offset:128
v_accvgpr_read_b32 v109,a241
ds_read_b128 a[136:139],v0 offset:256
s_waitcnt lgkmcnt(7)
buffer_store_dwordx4 v[72:75],v9,s[16:19],s87 offen offset:128 nt
ds_read_b128 a[140:143],v1 offset:256
v_pk_mul_f32 v[108:109],v[108:109],v[68:69] op_sel_hi:[1,0]
v_accvgpr_read_b32 v110,a242
v_accvgpr_read_b32 v111,a243
v_pk_mul_f32 v[110:111],v[110:111],v[68:69] op_sel_hi:[1,0]
v_accvgpr_read_b32 v97,a197
v_accvgpr_read_b32 v98,a198
v_mfma_f32_16x16x32_bf16 a[204:207],a[148:151],v[56:59],a[204:207]
v_accvgpr_read_b32 v99,a199
buffer_load_dwordx4 v7,s[8:11],s25 offen offset:1024 lds
s_waitcnt lgkmcnt(4)
buffer_store_dwordx4 v[76:79],v9,s[16:19],s87 offen offset:3200 nt
v_pk_mul_f32 v[96:97],v[96:97],v[66:67] op_sel_hi:[1,0]
v_pk_mul_f32 v[98:99],v[98:99],v[66:67] op_sel_hi:[1,0]
v_accvgpr_read_b32 v100,a244
v_accvgpr_read_b32 v101,a245
v_pk_mul_f32 v[100:101],v[100:101],v[68:69] op_sel_hi:[1,0]
v_accvgpr_read_b32 v102,a246
v_accvgpr_read_b32 v103,a247
v_pk_mul_f32 v[102:103],v[102:103],v[68:69] op_sel_hi:[1,0]
v_cvt_pk_bf16_f32 v104,v104,v105
v_cvt_pk_bf16_f32 v108,v108,v109
v_mfma_f32_16x16x32_bf16 a[200:203],a[144:147],v[56:59],a[200:203]
v_cvt_pk_bf16_f32 v105,v106,v107
v_cvt_pk_bf16_f32 v109,v110,v111
v_mfma_f32_16x16x32_bf16 v[152:155],a[144:147],v[52:55],v[152:155]
ds_write2st64_b64 v36,v[104:105],v[108:109] offset0:36 offset1:40
v_mfma_f32_16x16x32_bf16 v[156:159],a[148:151],v[52:55],v[156:159]
v_add_u32 v36,v36,v19
v_accvgpr_read_b32 v84,a248
v_mfma_f32_16x16x32_bf16 v[252:255],a[148:151],v[48:51],v[252:255]
buffer_load_dwordx4 v8,s[8:11],s25 offen offset:2048 lds
buffer_store_dwordx4 v[88:91],v9,s[16:19],s66 offen offset:128 nt
v_pk_mul_f32 v[112:113],v[112:113],v[64:65] op_sel_hi:[1,0]
v_pk_mul_f32 v[114:115],v[114:115],v[64:65] op_sel_hi:[1,0]
v_pk_mul_f32 v[128:129],v[128:129],v[64:65] op_sel_hi:[1,0]
v_pk_mul_f32 v[130:131],v[130:131],v[64:65] op_sel_hi:[1,0]
v_pk_mul_f32 v[116:117],v[116:117],v[64:65] op_sel_hi:[1,0]
v_pk_mul_f32 v[118:119],v[118:119],v[64:65] op_sel_hi:[1,0]
v_pk_mul_f32 v[132:133],v[132:133],v[64:65] op_sel_hi:[1,0]
v_pk_mul_f32 v[134:135],v[134:135],v[64:65] op_sel_hi:[1,0]
v_accvgpr_read_b32 v85,a249
v_pk_mul_f32 v[84:85],v[84:85],v[68:69] op_sel_hi:[1,0]
v_accvgpr_read_b32 v86,a250
buffer_store_dwordx4 v[92:95],v9,s[16:19],s66 offen offset:3200 nt
v_accvgpr_read_b32 v87,a251
v_pk_mul_f32 v[86:87],v[86:87],v[68:69] op_sel_hi:[1,0]
v_accvgpr_read_b32 v80,a200
v_accvgpr_read_b32 v81,a201
v_pk_mul_f32 v[80:81],v[80:81],v[66:67] op_sel_hi:[1,0]
v_accvgpr_read_b32 v82,a202
v_accvgpr_read_b32 v83,a203
v_pk_mul_f32 v[82:83],v[82:83],v[66:67] op_sel_hi:[1,0]
v_accvgpr_read_b32 v106,a206
v_accvgpr_read_b32 v107,a207
v_pk_mul_f32 v[106:107],v[106:107],v[66:67] op_sel_hi:[1,0]
v_accvgpr_read_b32 v110,a254
v_accvgpr_read_b32 v111,a255
v_pk_mul_f32 v[110:111],v[110:111],v[68:69] op_sel_hi:[1,0]
v_accvgpr_read_b32 v104,a204
v_accvgpr_read_b32 v105,a205
v_pk_mul_f32 v[104:105],v[104:105],v[66:67] op_sel_hi:[1,0]
v_accvgpr_read_b32 v108,a252
v_accvgpr_read_b32 v109,a253
v_pk_mul_f32 v[108:109],v[108:109],v[68:69] op_sel_hi:[1,0]
v_cvt_pk_bf16_f32 v96,v96,v97
v_cvt_pk_bf16_f32 v100,v100,v101
v_mfma_f32_16x16x32_bf16 v[248:251],a[144:147],v[48:51],v[248:251]
s_waitcnt vmcnt(20)
ds_read_b128 a[92:95],v12 offset:256
v_cvt_pk_bf16_f32 v84,v84,v85
v_mfma_f32_16x16x32_bf16 v[200:203],a[144:147],v[44:47],v[200:203]
s_mov_b32 s27,s42
ds_read_b128 a[88:91],v11 offset:256
v_cvt_pk_bf16_f32 v80,v80,v81
ds_read_b128 a[84:87],v12 offset:128
v_pk_mul_f32 v[120:121],v[120:121],v[64:65] op_sel_hi:[1,0]
ds_read_b128 a[80:83],v11 offset:128
v_pk_mul_f32 v[122:123],v[122:123],v[64:65] op_sel_hi:[1,0]
ds_read_b128 a[76:79],v12 offset:0
v_pk_mul_f32 v[136:137],v[136:137],v[64:65] op_sel_hi:[1,0]
ds_read_b128 a[72:75],v11 offset:0
v_pk_mul_f32 v[138:139],v[138:139],v[64:65] op_sel_hi:[1,0]
v_cvt_pk_bf16_f32 v97,v98,v99
v_cvt_pk_bf16_f32 v101,v102,v103
v_mfma_f32_16x16x32_bf16 v[204:207],a[148:151],v[44:47],v[204:207]
s_mov_b32 s42,s41
ds_write2st64_b64 v37,v[96:97],v[100:101] offset0:36 offset1:40
v_mfma_f32_16x16x32_bf16 v[72:75],a[120:123],a[0:3],0
s_add_u32 s69,s69,1
v_add_u32 v37,v37,v19
ds_read_b128 a[144:147],v0 offset:6144
v_mfma_f32_16x16x32_bf16 v[72:75],a[124:127],a[4:7],v[72:75]
s_lshl_b32 s62,s69,5
ds_read_b128 a[148:151],v1 offset:6144
v_cvt_pk_bf16_f32 v104,v104,v105
v_cvt_pk_bf16_f32 v108,v108,v109
v_cvt_pk_bf16_f32 v85,v86,v87
v_pk_mul_f32 v[124:125],v[124:125],v[64:65] op_sel_hi:[1,0]
v_pk_mul_f32 v[126:127],v[126:127],v[64:65] op_sel_hi:[1,0]
v_pk_mul_f32 v[140:141],v[140:141],v[64:65] op_sel_hi:[1,0]
v_pk_mul_f32 v[142:143],v[142:143],v[64:65] op_sel_hi:[1,0]
v_cvt_pk_bf16_f32 v81,v82,v83
v_cvt_pk_bf16_f32 v105,v106,v107
s_waitcnt lgkmcnt(3)
v_mfma_f32_16x16x32_bf16 v[72:75],a[128:131],a[8:11],v[72:75]
s_add_u32 s62,s62,s34
ds_write2st64_b64 v38,v[80:81],v[84:85] offset0:36 offset1:40
v_mfma_f32_16x16x32_bf16 v[72:75],a[132:135],a[12:15],v[72:75]
s_waitcnt vmcnt(11)
v_add_u32 v38,v38,v19
v_cvt_pk_bf16_f32 v109,v110,v111
v_mfma_f32_16x16x32_bf16 v[72:75],a[136:139],a[16:19],v[72:75]
s_mul_i32 s63,s62,171
ds_read_b128 a[96:99],v11 offset:6144
v_cvt_pk_bf16_f32 v112,v112,v113
v_mfma_f32_16x16x32_bf16 v[72:75],a[140:143],a[20:23],v[72:75]
s_lshr_b32 s63,s63,9
ds_read_b128 a[100:103],v12 offset:6144
v_cvt_pk_bf16_f32 v128,v128,v129
ds_read_b128 a[104:107],v11 offset:6272
v_pk_mul_f32 v[144:145],v[144:145],v[64:65] op_sel_hi:[1,0]
ds_read_b128 a[108:111],v12 offset:6272
v_pk_mul_f32 v[146:147],v[146:147],v[64:65] op_sel_hi:[1,0]
ds_read_b128 a[112:115],v11 offset:6400
v_pk_mul_f32 v[160:161],v[160:161],v[60:61] op_sel_hi:[1,0]
ds_read_b128 a[116:119],v12 offset:6400
v_pk_mul_f32 v[162:163],v[162:163],v[60:61] op_sel_hi:[1,0]
v_max3_f32 v44,v72,v73,v74
v_cvt_pk_bf16_f32 v116,v116,v117
v_mfma_f32_16x16x32_bf16 v[80:83],a[140:143],a[44:47],0
s_mul_i32 s64,s63,3
ds_write2st64_b64 v39,v[104:105],v[108:109] offset0:36 offset1:40
v_mfma_f32_16x16x32_bf16 v[80:83],a[136:139],a[40:43],v[80:83]
s_sub_u32 s62,s62,s64
v_add_u32 v39,v39,v19
v_cvt_pk_bf16_f32 v132,v132,v133
v_mfma_f32_16x16x32_bf16 v[80:83],a[132:135],a[36:39],v[80:83]
s_add_u32 s63,s63,s33
ds_read_b128 v[76:79],v10 offset:18432
v_cvt_pk_bf16_f32 v113,v114,v115
ds_read_b128 v[88:91],v10 offset:19456
v_pk_mul_f32 v[148:149],v[148:149],v[64:65] op_sel_hi:[1,0]
ds_read_b128 v[92:95],v10 offset:20480
v_pk_mul_f32 v[150:151],v[150:151],v[64:65] op_sel_hi:[1,0]
ds_read_b128 v[96:99],v10 offset:21504
v_pk_mul_f32 v[164:165],v[164:165],v[60:61] op_sel_hi:[1,0]
v_pk_mul_f32 v[166:167],v[166:167],v[60:61] op_sel_hi:[1,0]
v_cvt_pk_bf16_f32 v129,v130,v131
v_cvt_pk_bf16_f32 v120,v120,v121
v_mfma_f32_16x16x32_bf16 v[80:83],a[128:131],a[32:35],v[80:83]
s_mul_i32 s30,s63,196608
ds_write2st64_b64 v36,v[112:113],v[128:129] offset0:24 offset1:26
v_mfma_f32_16x16x32_bf16 v[80:83],a[124:127],a[28:31],v[80:83]
s_mul_i32 s41,s63,325632
v_cvt_pk_bf16_f32 v136,v136,v137
v_cvt_pk_bf16_f32 v117,v118,v119
v_mfma_f32_16x16x32_bf16 v[80:83],a[120:123],a[24:27],v[80:83]
s_lshl_b32 s63,s3,2
s_waitcnt lgkmcnt(4)
buffer_store_dwordx4 v[76:79],v9,s[16:19],s87 offen offset:256 nt
v_cvt_pk_bf16_f32 v133,v134,v135
v_cvt_pk_bf16_f32 v124,v124,v125
v_cvt_pk_bf16_f32 v140,v140,v141
v_cvt_pk_bf16_f32 v121,v122,v123
v_cvt_pk_bf16_f32 v137,v138,v139
v_cvt_pk_bf16_f32 v144,v144,v145
v_max3_f32 v48,v80,v81,v82
v_cvt_pk_bf16_f32 v160,v160,v161
v_cvt_pk_bf16_f32 v125,v126,v127
ds_write2st64_b64 v37,v[116:117],v[132:133] offset0:24 offset1:26
v_cvt_pk_bf16_f32 v141,v142,v143
v_cvt_pk_bf16_f32 v148,v148,v149
v_cvt_pk_bf16_f32 v164,v164,v165
s_waitcnt lgkmcnt(1)
buffer_store_dwordx4 v[88:91],v9,s[16:19],s87 offen offset:3328 nt
v_cvt_pk_bf16_f32 v145,v146,v147
v_cvt_pk_bf16_f32 v161,v162,v163
v_cvt_pk_bf16_f32 v149,v150,v151
v_mfma_f32_16x16x32_bf16 v[88:91],a[120:123],a[48:51],0
s_add_u32 s64,s63,21
v_cvt_pk_bf16_f32 v165,v166,v167
v_mov_b32 v66,0
v_mov_b32 v67,0
v_mov_b32 v68,0
ds_write2st64_b64 v38,v[120:121],v[136:137] offset0:24 offset1:26
v_pk_mul_f32 v[152:153],v[152:153],v[64:65] op_sel_hi:[1,0]
v_pk_mul_f32 v[154:155],v[154:155],v[64:65] op_sel_hi:[1,0]
v_pk_mul_f32 v[168:169],v[168:169],v[60:61] op_sel_hi:[1,0]
buffer_store_dwordx4 v[92:95],v9,s[16:19],s66 offen offset:256 nt
v_pk_mul_f32 v[170:171],v[170:171],v[60:61] op_sel_hi:[1,0]
v_cvt_pk_bf16_f32 v152,v152,v153
v_cvt_pk_bf16_f32 v168,v168,v169
v_mfma_f32_16x16x32_bf16 v[88:91],a[124:127],a[52:55],v[88:91]
s_cmp_eq_u32 s3,0
v_cvt_pk_bf16_f32 v153,v154,v155
v_cvt_pk_bf16_f32 v169,v170,v171
v_mfma_f32_16x16x32_bf16 v[88:91],a[128:131],a[56:59],v[88:91]
s_cselect_b32 s64,20,s64
v_mov_b32 v69,0
s_cselect_b32 s40,1,0
v_mfma_f32_16x16x32_bf16 v[88:91],a[132:135],a[60:63],v[88:91]
s_add_u32 s65,s63,37
ds_write2st64_b64 v39,v[124:125],v[140:141] offset0:24 offset1:26
v_mfma_f32_16x16x32_bf16 v[88:91],a[136:139],a[64:67],v[88:91]
s_cmp_eq_u32 s62,2
s_cselect_b32 s64,s65,s64
buffer_store_dwordx4 v[96:99],v9,s[16:19],s66 offen offset:3328 nt
v_pk_mul_f32 v[156:157],v[156:157],v[64:65] op_sel_hi:[1,0]
v_pk_mul_f32 v[158:159],v[158:159],v[64:65] op_sel_hi:[1,0]
v_pk_mul_f32 v[172:173],v[172:173],v[60:61] op_sel_hi:[1,0]
v_pk_mul_f32 v[174:175],v[174:175],v[60:61] op_sel_hi:[1,0]
v_cvt_pk_bf16_f32 v156,v156,v157
v_cvt_pk_bf16_f32 v172,v172,v173
v_mfma_f32_16x16x32_bf16 v[88:91],a[140:143],a[68:71],v[88:91]
s_cselect_b32 s40,0,s40
v_cvt_pk_bf16_f32 v157,v158,v159
v_cvt_pk_bf16_f32 v173,v174,v175
v_mfma_f32_16x16x32_bf16 v[96:99],a[140:143],a[92:95],0
s_add_u32 s65,s63,s3
ds_write2st64_b64 v36,v[144:145],v[160:161] offset0:28 offset1:0
v_mfma_f32_16x16x32_bf16 v[96:99],a[136:139],a[88:91],v[96:99]
s_cmp_eq_u32 s62,0
v_max3_f32 v52,v88,v89,v90
v_mov_b32 v64,0
v_mov_b32 v65,0
s_cselect_b32 s64,s65,s64
s_cselect_b32 s40,1,s40
v_pk_mul_f32 v[176:177],v[176:177],v[60:61] op_sel_hi:[1,0]
v_pk_mul_f32 v[178:179],v[178:179],v[60:61] op_sel_hi:[1,0]
v_pk_mul_f32 v[192:193],v[192:193],v[60:61] op_sel_hi:[1,0]
v_pk_mul_f32 v[194:195],v[194:195],v[60:61] op_sel_hi:[1,0]
v_cvt_pk_bf16_f32 v176,v176,v177
v_cvt_pk_bf16_f32 v192,v192,v193
v_mfma_f32_16x16x32_bf16 v[96:99],a[132:135],a[84:87],v[96:99]
s_mul_i32 s64,s64,6144
ds_write2st64_b64 v37,v[148:149],v[164:165] offset0:28 offset1:0
v_mfma_f32_16x16x32_bf16 v[96:99],a[128:131],a[80:83],v[96:99]
s_add_u32 s41,s41,s64
v_cvt_pk_bf16_f32 v177,v178,v179
v_cvt_pk_bf16_f32 v193,v194,v195
v_mfma_f32_16x16x32_bf16 v[96:99],a[124:127],a[76:79],v[96:99]
s_cmp_ge_u32 s69,6
s_cselect_b32 s41,166723584,s41
s_cselect_b32 s30,100663296,s30
v_mfma_f32_16x16x32_bf16 v[96:99],a[120:123],a[72:75],v[96:99]
s_add_u32 s25,s30,s22
s_add_u32 s26,s25,12288
ds_write2st64_b64 v38,v[152:153],v[168:169] offset0:28 offset1:0
v_pk_mul_f32 v[180:181],v[180:181],v[60:61] op_sel_hi:[1,0]
v_pk_mul_f32 v[182:183],v[182:183],v[60:61] op_sel_hi:[1,0]
v_pk_mul_f32 v[196:197],v[196:197],v[60:61] op_sel_hi:[1,0]
v_pk_mul_f32 v[198:199],v[198:199],v[60:61] op_sel_hi:[1,0]
v_cvt_pk_bf16_f32 v180,v180,v181
v_max3_f32 v56,v96,v97,v98
v_mfma_f32_16x16x32_bf16 v[104:107],a[120:123],a[96:99],0
s_add_u32 m0,s23,24576
ds_read_b128 a[120:123],v0 offset:6272
v_cvt_pk_bf16_f32 v196,v196,v197
v_mfma_f32_16x16x32_bf16 v[104:107],a[124:127],a[100:103],v[104:107]
s_mov_b32 s28,s41
ds_read_b128 a[124:127],v1 offset:6272
v_cvt_pk_bf16_f32 v181,v182,v183
v_mfma_f32_16x16x32_bf16 v[104:107],a[128:131],a[104:107],v[104:107]
s_mov_b32 s29,s24
ds_write2st64_b64 v39,v[156:157],v[172:173] offset0:28 offset1:0
v_pk_mul_f32 v[184:185],v[184:185],v[60:61] op_sel_hi:[1,0]
v_pk_mul_f32 v[186:187],v[186:187],v[60:61] op_sel_hi:[1,0]
v_pk_mul_f32 v[200:201],v[200:201],v[60:61] op_sel_hi:[1,0]
ds_read_b128 a[128:131],v0 offset:6400
v_pk_mul_f32 v[202:203],v[202:203],v[60:61] op_sel_hi:[1,0]
v_cvt_pk_bf16_f32 v197,v198,v199
v_cvt_pk_bf16_f32 v184,v184,v185
v_mfma_f32_16x16x32_bf16 v[104:107],a[132:135],a[108:111],v[104:107]
ds_read_b128 a[132:135],v1 offset:6400
v_cvt_pk_bf16_f32 v200,v200,v201
v_mfma_f32_16x16x32_bf16 v[104:107],a[136:139],a[112:115],v[104:107]
ds_read_b128 a[136:139],v0 offset:12288
v_cvt_pk_bf16_f32 v185,v186,v187
v_mfma_f32_16x16x32_bf16 v[104:107],a[140:143],a[116:119],v[104:107]
ds_read_b128 a[140:143],v1 offset:12288
v_cvt_pk_bf16_f32 v201,v202,v203
v_mfma_f32_16x16x32_bf16 v[76:79],a[144:147],a[0:3],0
ds_write2st64_b64 v36,v[176:177],v[192:193] offset0:2 offset1:4
v_pk_mul_f32 v[188:189],v[188:189],v[60:61] op_sel_hi:[1,0]
v_pk_mul_f32 v[190:191],v[190:191],v[60:61] op_sel_hi:[1,0]
v_pk_mul_f32 v[204:205],v[204:205],v[60:61] op_sel_hi:[1,0]
v_pk_mul_f32 v[206:207],v[206:207],v[60:61] op_sel_hi:[1,0]
v_max3_f32 v40,v104,v105,v106
v_cvt_pk_bf16_f32 v188,v188,v189
v_mfma_f32_16x16x32_bf16 v[76:79],a[148:151],a[4:7],v[76:79]
s_waitcnt lgkmcnt(4)
v_cvt_pk_bf16_f32 v204,v204,v205
v_cvt_pk_bf16_f32 v189,v190,v191
v_mfma_f32_16x16x32_bf16 v[76:79],a[120:123],a[8:11],v[76:79]
v_cvt_pk_bf16_f32 v205,v206,v207
v_mov_b32 v60,0
v_mfma_f32_16x16x32_bf16 v[76:79],a[124:127],a[12:15],v[76:79]
ds_write2st64_b64 v37,v[180:181],v[196:197] offset0:2 offset1:4
v_mfma_f32_16x16x32_bf16 v[76:79],a[128:131],a[16:19],v[76:79]
v_mov_b32 v61,0
v_pk_mul_f32 v[208:209],v[208:209],v[62:63] op_sel_hi:[1,0]
buffer_load_dwordx4 v6,s[8:11],s21 offen offset:0 lds
ds_write2st64_b64 v38,v[184:185],v[200:201] offset0:2 offset1:4
v_pk_mul_f32 v[210:211],v[210:211],v[62:63] op_sel_hi:[1,0]
v_pk_mul_f32 v[224:225],v[224:225],v[62:63] op_sel_hi:[1,0]
v_pk_mul_f32 v[226:227],v[226:227],v[62:63] op_sel_hi:[1,0]
v_cvt_pk_bf16_f32 v208,v208,v209
v_cvt_pk_bf16_f32 v224,v224,v225
s_waitcnt lgkmcnt(2)
v_mfma_f32_16x16x32_bf16 v[76:79],a[132:135],a[20:23],v[76:79]
v_cvt_pk_bf16_f32 v209,v210,v211
v_cvt_pk_bf16_f32 v225,v226,v227
v_mfma_f32_16x16x32_bf16 v[84:87],a[132:135],a[44:47],0
v_mfma_f32_16x16x32_bf16 v[84:87],a[128:131],a[40:43],v[84:87]
ds_write2st64_b64 v39,v[188:189],v[204:205] offset0:2 offset1:4
v_pk_mul_f32 v[212:213],v[212:213],v[62:63] op_sel_hi:[1,0]
v_pk_mul_f32 v[214:215],v[214:215],v[62:63] op_sel_hi:[1,0]
v_pk_mul_f32 v[228:229],v[228:229],v[62:63] op_sel_hi:[1,0]
v_pk_mul_f32 v[230:231],v[230:231],v[62:63] op_sel_hi:[1,0]
v_max3_f32 v44,v44,v75,v76
v_max3_f32 v44,v44,v77,v78
v_mfma_f32_16x16x32_bf16 v[84:87],a[124:127],a[36:39],v[84:87]
buffer_load_dwordx4 v7,s[8:11],s21 offen offset:1024 lds
v_mfma_f32_16x16x32_bf16 v[84:87],a[120:123],a[32:35],v[84:87]
ds_write2st64_b64 v36,v[208:209],v[224:225] offset0:12 offset1:14
v_mfma_f32_16x16x32_bf16 v[84:87],a[148:151],a[28:31],v[84:87]
v_max_f32 v44,v44,v79
v_mov_b32 v45,v44
v_mfma_f32_16x16x32_bf16 v[84:87],a[144:147],a[24:27],v[84:87]
v_cvt_pk_bf16_f32 v212,v212,v213
v_permlane32_swap_b32 v45,v44
v_max_f32 v44,v44,v45
v_mov_b32 v45,v44
v_pk_mul_f32 v[216:217],v[216:217],v[62:63] op_sel_hi:[1,0]
v_pk_mul_f32 v[218:219],v[218:219],v[62:63] op_sel_hi:[1,0]
v_pk_mul_f32 v[232:233],v[232:233],v[62:63] op_sel_hi:[1,0]
v_pk_mul_f32 v[234:235],v[234:235],v[62:63] op_sel_hi:[1,0]
v_permlane16_swap_b32 v45,v44
v_max_f32 v44,v44,v45
v_mfma_f32_16x16x32_bf16 v[92:95],a[144:147],a[48:51],0
v_mul_f32_e64 v13,-s36,v44
v_fma_f32 v72,v72,s36,v13
v_mfma_f32_16x16x32_bf16 v[92:95],a[148:151],a[52:55],v[92:95]
buffer_load_dwordx4 v8,s[8:11],s21 offen offset:2048 lds
v_mfma_f32_16x16x32_bf16 v[92:95],a[120:123],a[56:59],v[92:95]
s_add_u32 s21,s21,12288
v_fma_f32 v73,v73,s36,v13
v_fma_f32 v74,v74,s36,v13
v_mfma_f32_16x16x32_bf16 v[92:95],a[124:127],a[60:63],v[92:95]
s_add_u32 m0,s22,0
v_fma_f32 v75,v75,s36,v13
v_exp_f32 v72,v72
v_exp_f32 v73,v73
v_pk_mul_f32 v[220:221],v[220:221],v[62:63] op_sel_hi:[1,0]
v_pk_mul_f32 v[222:223],v[222:223],v[62:63] op_sel_hi:[1,0]
v_pk_mul_f32 v[236:237],v[236:237],v[62:63] op_sel_hi:[1,0]
v_pk_mul_f32 v[238:239],v[238:239],v[62:63] op_sel_hi:[1,0]
v_exp_f32 v74,v74
v_exp_f32 v75,v75
v_mfma_f32_16x16x32_bf16 v[92:95],a[128:131],a[64:67],v[92:95]
v_cvt_pk_bf16_f32 v20,v72,v73
v_cvt_pk_bf16_f32 v21,v74,v75
v_mfma_f32_16x16x32_bf16 v[92:95],a[132:135],a[68:71],v[92:95]
v_max3_f32 v48,v48,v83,v84
v_max3_f32 v48,v48,v85,v86
v_mfma_f32_16x16x32_bf16 v[100:103],a[132:135],a[92:95],0
v_max_f32 v48,v48,v87
v_mov_b32 v49,v48
v_cvt_pk_bf16_f32 v228,v228,v229
v_cvt_pk_bf16_f32 v213,v214,v215
v_permlane32_swap_b32 v49,v48
v_pk_mul_f32 v[240:241],v[240:241],v[62:63] op_sel_hi:[1,0]
v_pk_mul_f32 v[242:243],v[242:243],v[62:63] op_sel_hi:[1,0]
v_max_f32 v48,v48,v49
v_mov_b32 v49,v48
v_mfma_f32_16x16x32_bf16 v[100:103],a[128:131],a[88:91],v[100:103]
v_max3_f32 v52,v52,v91,v92
v_permlane16_swap_b32 v49,v48
v_mfma_f32_16x16x32_bf16 v[100:103],a[124:127],a[84:87],v[100:103]
v_max_f32 v48,v48,v49
v_mul_f32_e64 v14,-s36,v48
v_mfma_f32_16x16x32_bf16 v[100:103],a[120:123],a[80:83],v[100:103]
v_fma_f32 v80,v80,s36,v14
v_fma_f32 v81,v81,s36,v14
v_mfma_f32_16x16x32_bf16 v[100:103],a[148:151],a[76:79],v[100:103]
v_fma_f32 v82,v82,s36,v14
v_fma_f32 v83,v83,s36,v14
v_exp_f32 v80,v80
v_exp_f32 v81,v81
v_pk_mul_f32 v[244:245],v[244:245],v[62:63] op_sel_hi:[1,0]
v_pk_mul_f32 v[246:247],v[246:247],v[62:63] op_sel_hi:[1,0]
v_exp_f32 v82,v82
v_exp_f32 v83,v83
v_mfma_f32_16x16x32_bf16 v[100:103],a[144:147],a[72:75],v[100:103]
v_cvt_pk_bf16_f32 v24,v80,v81
v_cvt_pk_bf16_f32 v25,v82,v83
v_mfma_f32_16x16x32_bf16 v[108:111],a[144:147],a[96:99],0
ds_read_b128 a[144:147],v0 offset:12416
v_max3_f32 v52,v52,v93,v94
v_mfma_f32_16x16x32_bf16 v[108:111],a[148:151],a[100:103],v[108:111]
ds_read_b128 a[148:151],v1 offset:12416
v_max_f32 v52,v52,v95
v_mov_b32 v53,v52
v_max3_f32 v56,v56,v99,v100
v_max3_f32 v56,v56,v101,v102
v_pk_mul_f32 v[248:249],v[248:249],v[62:63] op_sel_hi:[1,0]
v_pk_mul_f32 v[250:251],v[250:251],v[62:63] op_sel_hi:[1,0]
v_permlane32_swap_b32 v53,v52
v_max_f32 v52,v52,v53
v_mfma_f32_16x16x32_bf16 v[108:111],a[120:123],a[104:107],v[108:111]
ds_read_b128 a[120:123],v0 offset:12544
v_mov_b32 v53,v52
v_mfma_f32_16x16x32_bf16 v[108:111],a[124:127],a[108:111],v[108:111]
ds_read_b128 a[124:127],v1 offset:12544
v_permlane16_swap_b32 v53,v52
v_mfma_f32_16x16x32_bf16 v[108:111],a[128:131],a[112:115],v[108:111]
ds_read_b128 a[128:131],v0 offset:18432
v_max_f32 v52,v52,v53
v_mfma_f32_16x16x32_bf16 v[108:111],a[132:135],a[116:119],v[108:111]
ds_read_b128 a[132:135],v1 offset:18432
v_mul_f32_e64 v15,-s36,v52
v_fma_f32 v88,v88,s36,v15
v_fma_f32 v89,v89,s36,v15
v_fma_f32 v90,v90,s36,v15
v_pk_mul_f32 v[252:253],v[252:253],v[62:63] op_sel_hi:[1,0]
v_pk_mul_f32 v[254:255],v[254:255],v[62:63] op_sel_hi:[1,0]
v_fma_f32 v91,v91,s36,v15
v_exp_f32 v88,v88
v_mfma_f32_16x16x32_bf16 v[72:75],a[136:139],a[0:3],0
v_exp_f32 v89,v89
v_mfma_f32_16x16x32_bf16 v[72:75],a[140:143],a[4:7],v[72:75]
s_waitcnt lgkmcnt(3)
v_exp_f32 v90,v90
v_mfma_f32_16x16x32_bf16 v[72:75],a[144:147],a[8:11],v[72:75]
v_exp_f32 v91,v91
v_mfma_f32_16x16x32_bf16 v[72:75],a[148:151],a[12:15],v[72:75]
v_cvt_pk_bf16_f32 v28,v88,v89
v_cvt_pk_bf16_f32 v29,v90,v91
v_mfma_f32_16x16x32_bf16 v[72:75],a[120:123],a[16:19],v[72:75]
s_waitcnt lgkmcnt(0)
v_max_f32 v56,v56,v103
v_mov_b32 v57,v56
v_mfma_f32_16x16x32_bf16 v[72:75],a[124:127],a[20:23],v[72:75]
v_max3_f32 v40,v40,v107,v108
v_permlane32_swap_b32 v57,v56
v_mfma_f32_16x16x32_bf16 v[80:83],a[124:127],a[44:47],0
v_max_f32 v56,v56,v57
v_mov_b32 v57,v56
v_mfma_f32_16x16x32_bf16 v[80:83],a[120:123],a[40:43],v[80:83]
v_max3_f32 v40,v40,v109,v110
v_permlane16_swap_b32 v57,v56
v_mfma_f32_16x16x32_bf16 v[80:83],a[148:151],a[36:39],v[80:83]
v_max_f32 v56,v56,v57
v_mul_f32_e64 v16,-s36,v56
v_mfma_f32_16x16x32_bf16 v[80:83],a[144:147],a[32:35],v[80:83]
v_fma_f32 v96,v96,s36,v16
v_fma_f32 v97,v97,s36,v16
v_mfma_f32_16x16x32_bf16 v[80:83],a[140:143],a[28:31],v[80:83]
v_fma_f32 v98,v98,s36,v16
v_fma_f32 v99,v99,s36,v16
v_mfma_f32_16x16x32_bf16 v[80:83],a[136:139],a[24:27],v[80:83]
v_exp_f32 v96,v96
v_mfma_f32_16x16x32_bf16 v[88:91],a[136:139],a[48:51],0
v_exp_f32 v97,v97
v_mfma_f32_16x16x32_bf16 v[88:91],a[140:143],a[52:55],v[88:91]
v_exp_f32 v98,v98
v_mfma_f32_16x16x32_bf16 v[88:91],a[144:147],a[56:59],v[88:91]
v_exp_f32 v99,v99
v_mfma_f32_16x16x32_bf16 v[88:91],a[148:151],a[60:63],v[88:91]
v_cvt_pk_bf16_f32 v32,v96,v97
v_cvt_pk_bf16_f32 v33,v98,v99
v_mfma_f32_16x16x32_bf16 v[88:91],a[120:123],a[64:67],v[88:91]
v_max_f32 v40,v40,v111
v_mov_b32 v41,v40
v_mfma_f32_16x16x32_bf16 v[88:91],a[124:127],a[68:71],v[88:91]
v_cvt_pk_bf16_f32 v216,v216,v217
v_permlane32_swap_b32 v41,v40
v_mfma_f32_16x16x32_bf16 v[96:99],a[124:127],a[92:95],0
v_max_f32 v40,v40,v41
v_mov_b32 v41,v40
v_mfma_f32_16x16x32_bf16 v[96:99],a[120:123],a[88:91],v[96:99]
v_cvt_pk_bf16_f32 v232,v232,v233
v_permlane16_swap_b32 v41,v40
v_mfma_f32_16x16x32_bf16 v[96:99],a[148:151],a[84:87],v[96:99]
v_cvt_pk_bf16_f32 v229,v230,v231
v_max_f32 v40,v40,v41
v_mfma_f32_16x16x32_bf16 v[96:99],a[144:147],a[80:83],v[96:99]
ds_write2st64_b64 v37,v[212:213],v[228:229] offset0:12 offset1:14
v_mfma_f32_16x16x32_bf16 v[96:99],a[140:143],a[76:79],v[96:99]
v_cvt_pk_bf16_f32 v220,v220,v221
v_cvt_pk_bf16_f32 v236,v236,v237
v_mfma_f32_16x16x32_bf16 v[96:99],a[136:139],a[72:75],v[96:99]
v_cvt_pk_bf16_f32 v217,v218,v219
v_cvt_pk_bf16_f32 v233,v234,v235
v_mul_f32_e64 v17,-s36,v40
v_cvt_pk_bf16_f32 v240,v240,v241
v_cvt_pk_bf16_f32 v221,v222,v223
ds_write2st64_b64 v38,v[216:217],v[232:233] offset0:12 offset1:14
v_cvt_pk_bf16_f32 v237,v238,v239
v_fma_f32 v104,v104,s36,v17
v_fma_f32 v105,v105,s36,v17
v_fma_f32 v106,v106,s36,v17
v_fma_f32 v107,v107,s36,v17
v_cvt_pk_bf16_f32 v244,v244,v245
v_cvt_pk_bf16_f32 v241,v242,v243
v_exp_f32 v104,v104
v_exp_f32 v105,v105
ds_write2st64_b64 v39,v[220:221],v[236:237] offset0:12 offset1:14
v_exp_f32 v106,v106
v_exp_f32 v107,v107
v_cvt_pk_bf16_f32 v245,v246,v247
v_fma_f32 v76,v76,s36,v13
v_fma_f32 v77,v77,s36,v13
v_fma_f32 v78,v78,s36,v13
v_fma_f32 v79,v79,s36,v13
v_exp_f32 v76,v76
ds_write_b64 v36,v[240:241] offset:8192
v_cvt_pk_bf16_f32 v36,v104,v105
v_exp_f32 v77,v77
v_exp_f32 v78,v78
ds_write_b64 v37,v[244:245] offset:8192
v_cvt_pk_bf16_f32 v37,v106,v107
v_mfma_f32_16x16x32_bf16 v[104:107],a[136:139],a[96:99],0
ds_read_b128 a[136:139],v0 offset:18560
v_exp_f32 v79,v79
v_mfma_f32_16x16x32_bf16 v[104:107],a[140:143],a[100:103],v[104:107]
ds_read_b128 a[140:143],v1 offset:18560
v_cvt_pk_bf16_f32 v22,v76,v77
v_mfma_f32_16x16x32_bf16 v[104:107],a[144:147],a[104:107],v[104:107]
ds_read_b128 a[144:147],v0 offset:18688
v_cvt_pk_bf16_f32 v23,v78,v79
v_mfma_f32_16x16x32_bf16 v[104:107],a[148:151],a[108:111],v[104:107]
ds_read_b128 a[148:151],v1 offset:18688
v_fma_f32 v84,v84,s36,v14
v_mfma_f32_16x16x32_bf16 v[104:107],a[120:123],a[112:115],v[104:107]
v_fma_f32 v85,v85,s36,v14
v_fma_f32 v86,v86,s36,v14
v_mfma_f32_16x16x32_bf16 v[104:107],a[124:127],a[116:119],v[104:107]
v_fma_f32 v87,v87,s36,v14
v_exp_f32 v84,v84
v_mfma_f32_16x16x32_bf16 v[76:79],a[128:131],a[0:3],0
v_exp_f32 v85,v85
v_mfma_f32_16x16x32_bf16 v[76:79],a[132:135],a[4:7],v[76:79]
v_exp_f32 v86,v86
s_waitcnt vmcnt(9)
s_barrier
s_waitcnt lgkmcnt(2)
v_mfma_f32_16x16x32_bf16 v[76:79],a[136:139],a[8:11],v[76:79]
v_exp_f32 v87,v87
v_mfma_f32_16x16x32_bf16 v[76:79],a[140:143],a[12:15],v[76:79]
buffer_load_dwordx4 v6,s[4:7],s20 offen offset:0 lds
s_waitcnt lgkmcnt(0)
v_mfma_f32_16x16x32_bf16 v[76:79],a[144:147],a[16:19],v[76:79]
v_cvt_pk_bf16_f32 v26,v84,v85
v_cvt_pk_bf16_f32 v27,v86,v87
v_mfma_f32_16x16x32_bf16 v[76:79],a[148:151],a[20:23],v[76:79]
v_fma_f32 v92,v92,s36,v15
v_fma_f32 v93,v93,s36,v15
v_mfma_f32_16x16x32_bf16 v[84:87],a[148:151],a[44:47],0
v_fma_f32 v94,v94,s36,v15
v_fma_f32 v95,v95,s36,v15
v_mfma_f32_16x16x32_bf16 v[84:87],a[144:147],a[40:43],v[84:87]
v_exp_f32 v92,v92
v_mfma_f32_16x16x32_bf16 v[84:87],a[140:143],a[36:39],v[84:87]
buffer_load_dwordx4 v7,s[4:7],s20 offen offset:1024 lds
v_mfma_f32_16x16x32_bf16 v[84:87],a[136:139],a[32:35],v[84:87]
v_exp_f32 v93,v93
v_mfma_f32_16x16x32_bf16 v[84:87],a[132:135],a[28:31],v[84:87]
v_exp_f32 v94,v94
v_mfma_f32_16x16x32_bf16 v[84:87],a[128:131],a[24:27],v[84:87]
v_exp_f32 v95,v95
ds_read_b64_tr_b16 a[120:121],v2 offset:0
ds_read_b64_tr_b16 a[122:123],v2 offset:6144
v_cvt_pk_bf16_f32 v30,v92,v93
v_cvt_pk_bf16_f32 v31,v94,v95
v_mfma_f32_16x16x32_bf16 v[92:95],a[128:131],a[48:51],0
buffer_load_dwordx4 v8,s[4:7],s20 offen offset:2048 lds
v_mfma_f32_16x16x32_bf16 v[92:95],a[132:135],a[52:55],v[92:95]
s_add_u32 s20,s20,12288
ds_read_b64_tr_b16 a[124:125],v3 offset:0
v_fma_f32 v100,v100,s36,v16
v_mfma_f32_16x16x32_bf16 v[92:95],a[136:139],a[56:59],v[92:95]
ds_read_b64_tr_b16 a[126:127],v3 offset:6144
v_fma_f32 v101,v101,s36,v16
v_mfma_f32_16x16x32_bf16 v[92:95],a[140:143],a[60:63],v[92:95]
v_fma_f32 v102,v102,s36,v16
v_fma_f32 v103,v103,s36,v16
v_mfma_f32_16x16x32_bf16 v[92:95],a[144:147],a[64:67],v[92:95]
v_exp_f32 v100,v100
v_mfma_f32_16x16x32_bf16 v[92:95],a[148:151],a[68:71],v[92:95]
v_exp_f32 v101,v101
v_exp_f32 v102,v102
v_exp_f32 v103,v103
v_cvt_pk_bf16_f32 v34,v100,v101
v_cvt_pk_bf16_f32 v35,v102,v103
v_mfma_f32_16x16x32_bf16 v[100:103],a[148:151],a[92:95],0
v_cvt_pk_bf16_f32 v248,v248,v249
v_fma_f32 v108,v108,s36,v17
v_smfmac_f32_16x16x64_bf16 v[64:67],a[152:155],v[28:35],v18
v_fma_f32 v109,v109,s36,v17
v_mfma_f32_16x16x32_bf16 v[100:103],a[144:147],a[88:91],v[100:103]
v_fma_f32 v110,v110,s36,v17
v_fma_f32 v111,v111,s36,v17
v_mfma_f32_16x16x32_bf16 v[100:103],a[140:143],a[84:87],v[100:103]
v_cvt_pk_bf16_f32 v252,v252,v253
v_cvt_pk_bf16_f32 v249,v250,v251
v_mfma_f32_16x16x32_bf16 v[100:103],a[136:139],a[80:83],v[100:103]
ds_write_b64 v38,v[248:249] offset:8192
v_mfma_f32_16x16x32_bf16 v[100:103],a[132:135],a[76:79],v[100:103]
v_exp_f32 v108,v108
v_mfma_f32_16x16x32_bf16 v[100:103],a[128:131],a[72:75],v[100:103]
v_exp_f32 v109,v109
v_exp_f32 v110,v110
v_exp_f32 v111,v111
v_cvt_pk_bf16_f32 v253,v254,v255
ds_write_b64 v39,v[252:253] offset:8192
v_cvt_pk_bf16_f32 v38,v108,v109
v_cvt_pk_bf16_f32 v39,v110,v111
v_mfma_f32_16x16x32_bf16 v[108:111],a[128:131],a[96:99],0
ds_read_b64_tr_b16 a[128:129],v4 offset:0
v_mov_b32 v62,0
v_mfma_f32_16x16x32_bf16 v[108:111],a[132:135],a[100:103],v[108:111]
ds_read_b64_tr_b16 a[130:131],v4 offset:6144
v_mov_b32 v63,0
v_mfma_f32_16x16x32_bf16 v[108:111],a[136:139],a[104:107],v[108:111]
ds_read_b64_tr_b16 a[132:133],v5 offset:0
v_fma_f32 v72,v72,s36,v13
v_smfmac_f32_16x16x64_bf16 v[60:63],a[152:155],v[20:27],v18
ds_read_b64_tr_b16 a[134:135],v5 offset:6144
v_mfma_f32_16x16x32_bf16 v[108:111],a[140:143],a[108:111],v[108:111]
v_fma_f32 v73,v73,s36,v13
v_fma_f32 v74,v74,s36,v13
v_mfma_f32_16x16x32_bf16 v[108:111],a[144:147],a[112:115],v[108:111]
v_fma_f32 v75,v75,s36,v13
v_fma_f32 v80,v80,s36,v14
v_mfma_f32_16x16x32_bf16 v[108:111],a[148:151],a[116:119],v[108:111]
v_fma_f32 v81,v81,s36,v14
v_fma_f32 v82,v82,s36,v14
v_fma_f32 v83,v83,s36,v14
v_fma_f32 v88,v88,s36,v15
v_fma_f32 v89,v89,s36,v15
v_exp_f32 v72,v72
v_exp_f32 v73,v73
v_exp_f32 v74,v74
v_exp_f32 v75,v75
v_exp_f32 v80,v80
v_exp_f32 v81,v81
v_exp_f32 v82,v82
v_exp_f32 v83,v83
v_exp_f32 v88,v88
v_exp_f32 v89,v89
v_cvt_pk_bf16_f32 v44,v72,v73
v_cvt_pk_bf16_f32 v45,v74,v75
v_cvt_pk_bf16_f32 v48,v80,v81
v_cvt_pk_bf16_f32 v49,v82,v83
v_cvt_pk_bf16_f32 v52,v88,v89
s_waitcnt lgkmcnt(0)
v_mfma_f32_16x16x32_bf16 v[160:163],a[120:123],v[20:23],0
s_add_u32 m0,s23,0
ds_read_b64_tr_b16 a[136:137],v2 offset:128
v_fma_f32 v90,v90,s36,v15
v_mfma_f32_16x16x32_bf16 v[164:167],a[124:127],v[20:23],0
ds_read_b64_tr_b16 a[138:139],v2 offset:6272
v_fma_f32 v91,v91,s36,v15
v_mfma_f32_16x16x32_bf16 v[212:215],a[124:127],v[24:27],0
ds_read_b64_tr_b16 a[140:141],v3 offset:128
v_fma_f32 v96,v96,s36,v16
v_mfma_f32_16x16x32_bf16 v[208:211],a[120:123],v[24:27],0
ds_read_b64_tr_b16 a[142:143],v3 offset:6272
v_fma_f32 v97,v97,s36,v16
v_mfma_f32_16x16x32_bf16 v[112:115],a[120:123],v[28:31],0
ds_read_b64_tr_b16 a[144:145],v4 offset:128
v_fma_f32 v98,v98,s36,v16
v_mfma_f32_16x16x32_bf16 v[116:119],a[124:127],v[28:31],0
ds_read_b64_tr_b16 a[146:147],v4 offset:6272
v_fma_f32 v99,v99,s36,v16
v_mfma_f32_16x16x32_bf16 a[164:167],a[124:127],v[32:35],0
ds_read_b64_tr_b16 a[148:149],v5 offset:128
v_fma_f32 v104,v104,s36,v17
v_mfma_f32_16x16x32_bf16 a[160:163],a[120:123],v[32:35],0
ds_read_b64_tr_b16 a[150:151],v5 offset:6272
v_fma_f32 v105,v105,s36,v17
v_mfma_f32_16x16x32_bf16 a[208:211],a[120:123],v[36:39],0
ds_read_b64_tr_b16 a[120:121],v2 offset:256
v_fma_f32 v106,v106,s36,v17
v_mfma_f32_16x16x32_bf16 a[212:215],a[124:127],v[36:39],0
ds_read_b64_tr_b16 a[122:123],v2 offset:6400
v_fma_f32 v107,v107,s36,v17
v_mfma_f32_16x16x32_bf16 a[216:219],a[128:131],v[36:39],0
ds_read_b64_tr_b16 a[124:125],v3 offset:256
v_fma_f32 v76,v76,s36,v13
v_mfma_f32_16x16x32_bf16 a[220:223],a[132:135],v[36:39],0
ds_read_b64_tr_b16 a[126:127],v3 offset:6400
v_fma_f32 v77,v77,s36,v13
v_mfma_f32_16x16x32_bf16 a[172:175],a[132:135],v[32:35],0
v_exp_f32 v90,v90
v_mfma_f32_16x16x32_bf16 a[168:171],a[128:131],v[32:35],0
v_exp_f32 v91,v91
v_mfma_f32_16x16x32_bf16 v[120:123],a[128:131],v[28:31],0
v_cvt_pk_bf16_f32 v53,v90,v91
v_fma_f32 v78,v78,s36,v13
v_mfma_f32_16x16x32_bf16 v[124:127],a[132:135],v[28:31],0
v_exp_f32 v96,v96
v_mfma_f32_16x16x32_bf16 v[220:223],a[132:135],v[24:27],0
v_exp_f32 v97,v97
v_mfma_f32_16x16x32_bf16 v[216:219],a[128:131],v[24:27],0
v_exp_f32 v98,v98
v_mfma_f32_16x16x32_bf16 v[168:171],a[128:131],v[20:23],0
ds_read_b64_tr_b16 a[128:129],v4 offset:256
v_cvt_pk_bf16_f32 v56,v96,v97
v_mfma_f32_16x16x32_bf16 v[172:175],a[132:135],v[20:23],0
s_waitcnt lgkmcnt(1)
ds_read_b64_tr_b16 a[130:131],v4 offset:6400
v_fma_f32 v79,v79,s36,v13
v_mfma_f32_16x16x32_bf16 v[176:179],a[136:139],v[20:23],0
ds_read_b64_tr_b16 a[132:133],v5 offset:256
v_fma_f32 v84,v84,s36,v14
v_mfma_f32_16x16x32_bf16 v[180:183],a[140:143],v[20:23],0
ds_read_b64_tr_b16 a[134:135],v5 offset:6400
v_fma_f32 v85,v85,s36,v14
v_mfma_f32_16x16x32_bf16 v[228:231],a[140:143],v[24:27],0
v_exp_f32 v99,v99
v_mfma_f32_16x16x32_bf16 v[224:227],a[136:139],v[24:27],0
v_cvt_pk_bf16_f32 v57,v98,v99
v_fma_f32 v86,v86,s36,v14
v_mfma_f32_16x16x32_bf16 v[128:131],a[136:139],v[28:31],0
v_exp_f32 v104,v104
v_mfma_f32_16x16x32_bf16 v[132:135],a[140:143],v[28:31],0
v_exp_f32 v105,v105
v_mfma_f32_16x16x32_bf16 a[180:183],a[140:143],v[32:35],0
v_exp_f32 v106,v106
v_mfma_f32_16x16x32_bf16 a[176:179],a[136:139],v[32:35],0
v_exp_f32 v107,v107
v_mfma_f32_16x16x32_bf16 a[224:227],a[136:139],v[36:39],0
v_cvt_pk_bf16_f32 v40,v104,v105
v_cvt_pk_bf16_f32 v41,v106,v107
v_mfma_f32_16x16x32_bf16 a[228:231],a[140:143],v[36:39],0
v_exp_f32 v76,v76
v_mfma_f32_16x16x32_bf16 a[232:235],a[144:147],v[36:39],0
v_exp_f32 v77,v77
v_mfma_f32_16x16x32_bf16 a[236:239],a[148:151],v[36:39],0
v_exp_f32 v78,v78
v_mfma_f32_16x16x32_bf16 a[188:191],a[148:151],v[32:35],0
v_exp_f32 v79,v79
v_mfma_f32_16x16x32_bf16 a[184:187],a[144:147],v[32:35],0
v_cvt_pk_bf16_f32 v46,v76,v77
v_cvt_pk_bf16_f32 v47,v78,v79
v_mfma_f32_16x16x32_bf16 v[136:139],a[144:147],v[28:31],0
v_fma_f32 v87,v87,s36,v14
v_fma_f32 v92,v92,s36,v15
v_mfma_f32_16x16x32_bf16 v[140:143],a[148:151],v[28:31],0
v_exp_f32 v84,v84
v_mfma_f32_16x16x32_bf16 v[236:239],a[148:151],v[24:27],0
v_exp_f32 v85,v85
v_mfma_f32_16x16x32_bf16 v[232:235],a[144:147],v[24:27],0
v_exp_f32 v86,v86
v_mfma_f32_16x16x32_bf16 v[184:187],a[144:147],v[20:23],0
v_exp_f32 v87,v87
v_mfma_f32_16x16x32_bf16 v[188:191],a[148:151],v[20:23],0
v_cvt_pk_bf16_f32 v50,v84,v85
v_cvt_pk_bf16_f32 v51,v86,v87
v_mfma_f32_16x16x32_bf16 v[192:195],a[120:123],v[20:23],0
v_fma_f32 v93,v93,s36,v15
v_fma_f32 v94,v94,s36,v15
v_smfmac_f32_16x16x64_bf16 v[60:63],a[152:155],v[44:51],v18
v_fma_f32 v95,v95,s36,v15
v_mfma_f32_16x16x32_bf16 v[196:199],a[124:127],v[20:23],0
s_waitcnt vmcnt(36) lgkmcnt(0)
v_exp_f32 v92,v92
v_mfma_f32_16x16x32_bf16 v[244:247],a[124:127],v[24:27],0
s_barrier
v_mfma_f32_16x16x32_bf16 v[240:243],a[120:123],v[24:27],0
ds_read_b128 a[136:139],v0 offset:24576
v_fma_f32 v100,v100,s36,v16
v_mfma_f32_16x16x32_bf16 v[144:147],a[120:123],v[28:31],0
ds_read_b128 a[140:143],v1 offset:24576
v_fma_f32 v101,v101,s36,v16
v_mfma_f32_16x16x32_bf16 v[148:151],a[124:127],v[28:31],0
ds_read_b128 a[144:147],v0 offset:24704
v_fma_f32 v102,v102,s36,v16
v_mfma_f32_16x16x32_bf16 a[196:199],a[124:127],v[32:35],0
ds_read_b128 a[148:151],v1 offset:24704
v_fma_f32 v103,v103,s36,v16
v_mfma_f32_16x16x32_bf16 a[192:195],a[120:123],v[32:35],0
v_exp_f32 v93,v93
v_mfma_f32_16x16x32_bf16 a[240:243],a[120:123],v[36:39],0
buffer_load_dwordx4 v6,s[8:11],s21 offen offset:0 lds
v_mfma_f32_16x16x32_bf16 a[244:247],a[124:127],v[36:39],0
ds_read_b128 a[120:123],v0 offset:24832
v_cvt_pk_bf16_f32 v54,v92,v93
v_mfma_f32_16x16x32_bf16 a[248:251],a[128:131],v[36:39],0
ds_read_b128 a[124:127],v1 offset:24832
v_fma_f32 v108,v108,s36,v17
v_mfma_f32_16x16x32_bf16 a[252:255],a[132:135],v[36:39],0
v_exp_f32 v94,v94
v_mfma_f32_16x16x32_bf16 a[204:207],a[132:135],v[32:35],0
v_exp_f32 v95,v95
v_mfma_f32_16x16x32_bf16 a[200:203],a[128:131],v[32:35],0
v_cvt_pk_bf16_f32 v55,v94,v95
v_fma_f32 v109,v109,s36,v17
v_mfma_f32_16x16x32_bf16 v[152:155],a[128:131],v[28:31],0
v_exp_f32 v100,v100
v_mfma_f32_16x16x32_bf16 v[156:159],a[132:135],v[28:31],0
v_exp_f32 v101,v101
v_mfma_f32_16x16x32_bf16 v[252:255],a[132:135],v[24:27],0
v_exp_f32 v102,v102
v_mfma_f32_16x16x32_bf16 v[248:251],a[128:131],v[24:27],0
v_exp_f32 v103,v103
v_mfma_f32_16x16x32_bf16 v[200:203],a[128:131],v[20:23],0
ds_read_b128 a[128:131],v0 offset:30720
v_cvt_pk_bf16_f32 v58,v100,v101
v_mfma_f32_16x16x32_bf16 v[204:207],a[132:135],v[20:23],0
buffer_load_dwordx4 v7,s[8:11],s21 offen offset:1024 lds
s_waitcnt lgkmcnt(1)
v_mfma_f32_16x16x32_bf16 v[72:75],a[136:139],a[0:3],0
ds_read_b128 a[132:135],v1 offset:30720
v_cvt_pk_bf16_f32 v59,v102,v103
v_mfma_f32_16x16x32_bf16 v[72:75],a[140:143],a[4:7],v[72:75]
v_fma_f32 v110,v110,s36,v17
v_fma_f32 v111,v111,s36,v17
v_smfmac_f32_16x16x64_bf16 v[64:67],a[152:155],v[52:59],v18
v_mfma_f32_16x16x32_bf16 v[72:75],a[144:147],a[8:11],v[72:75]
v_exp_f32 v108,v108
v_mfma_f32_16x16x32_bf16 v[72:75],a[148:151],a[12:15],v[72:75]
v_exp_f32 v109,v109
v_mfma_f32_16x16x32_bf16 v[72:75],a[120:123],a[16:19],v[72:75]
v_exp_f32 v110,v110
v_mfma_f32_16x16x32_bf16 v[72:75],a[124:127],a[20:23],v[72:75]
v_exp_f32 v111,v111
v_mfma_f32_16x16x32_bf16 v[80:83],a[124:127],a[44:47],0
v_cvt_pk_bf16_f32 v42,v108,v109
v_cvt_pk_bf16_f32 v43,v110,v111
v_mfma_f32_16x16x32_bf16 v[80:83],a[120:123],a[40:43],v[80:83]
v_mfma_f32_16x16x32_bf16 v[80:83],a[148:151],a[36:39],v[80:83]
v_smfmac_f32_16x16x64_bf16 v[68:71],a[152:155],v[36:43],v18
buffer_load_dwordx4 v8,s[8:11],s21 offen offset:2048 lds
v_mfma_f32_16x16x32_bf16 v[80:83],a[144:147],a[32:35],v[80:83]
s_add_u32 s21,s21,12288
v_fma_f32 v72,v72,s36,v13
v_fma_f32 v73,v73,s36,v13
v_mfma_f32_16x16x32_bf16 v[80:83],a[140:143],a[28:31],v[80:83]
s_add_u32 m0,s22,12288
v_fma_f32 v74,v74,s36,v13
v_fma_f32 v75,v75,s36,v13
v_mfma_f32_16x16x32_bf16 v[80:83],a[136:139],a[24:27],v[80:83]
v_exp_f32 v72,v72
v_mfma_f32_16x16x32_bf16 v[88:91],a[136:139],a[48:51],0
v_exp_f32 v73,v73
v_mfma_f32_16x16x32_bf16 v[88:91],a[140:143],a[52:55],v[88:91]
v_exp_f32 v74,v74
v_mfma_f32_16x16x32_bf16 v[88:91],a[144:147],a[56:59],v[88:91]
v_exp_f32 v75,v75
v_mfma_f32_16x16x32_bf16 v[88:91],a[148:151],a[60:63],v[88:91]
v_fma_f32 v80,v80,s36,v14
v_fma_f32 v81,v81,s36,v14
v_mfma_f32_16x16x32_bf16 v[88:91],a[120:123],a[64:67],v[88:91]
v_fma_f32 v82,v82,s36,v14
v_fma_f32 v83,v83,s36,v14
v_mfma_f32_16x16x32_bf16 v[88:91],a[124:127],a[68:71],v[88:91]
v_exp_f32 v80,v80
v_mfma_f32_16x16x32_bf16 v[96:99],a[124:127],a[92:95],0
v_exp_f32 v81,v81
v_mfma_f32_16x16x32_bf16 v[96:99],a[120:123],a[88:91],v[96:99]
buffer_load_dwordx4 v6,s[4:7],s20 offen offset:0 lds
v_mfma_f32_16x16x32_bf16 v[96:99],a[148:151],a[84:87],v[96:99]
v_exp_f32 v82,v82
v_mfma_f32_16x16x32_bf16 v[96:99],a[144:147],a[80:83],v[96:99]
v_fma_f32 v88,v88,s36,v15
v_fma_f32 v89,v89,s36,v15
v_mfma_f32_16x16x32_bf16 v[96:99],a[140:143],a[76:79],v[96:99]
v_exp_f32 v83,v83
v_mfma_f32_16x16x32_bf16 v[96:99],a[136:139],a[72:75],v[96:99]
v_exp_f32 v88,v88
v_mfma_f32_16x16x32_bf16 v[104:107],a[136:139],a[96:99],0
ds_read_b128 a[136:139],v0 offset:30848
v_cvt_pk_bf16_f32 v20,v72,v73
v_mfma_f32_16x16x32_bf16 v[104:107],a[140:143],a[100:103],v[104:107]
ds_read_b128 a[140:143],v1 offset:30848
v_cvt_pk_bf16_f32 v21,v74,v75
v_mfma_f32_16x16x32_bf16 v[104:107],a[144:147],a[104:107],v[104:107]
ds_read_b128 a[144:147],v0 offset:30976
v_cvt_pk_bf16_f32 v24,v80,v81
v_mfma_f32_16x16x32_bf16 v[104:107],a[148:151],a[108:111],v[104:107]
ds_read_b128 a[148:151],v1 offset:30976
v_cvt_pk_bf16_f32 v25,v82,v83
v_mfma_f32_16x16x32_bf16 v[104:107],a[120:123],a[112:115],v[104:107]
v_exp_f32 v89,v89
v_mfma_f32_16x16x32_bf16 v[104:107],a[124:127],a[116:119],v[104:107]
s_waitcnt lgkmcnt(4)
v_cvt_pk_bf16_f32 v28,v88,v89
v_mfma_f32_16x16x32_bf16 v[76:79],a[128:131],a[0:3],0
v_mfma_f32_16x16x32_bf16 v[76:79],a[132:135],a[4:7],v[76:79]
buffer_load_dwordx4 v7,s[4:7],s20 offen offset:1024 lds
s_waitcnt lgkmcnt(3)
v_mfma_f32_16x16x32_bf16 v[76:79],a[136:139],a[8:11],v[76:79]
s_waitcnt lgkmcnt(2)
v_mfma_f32_16x16x32_bf16 v[76:79],a[140:143],a[12:15],v[76:79]
s_waitcnt lgkmcnt(1)
v_mfma_f32_16x16x32_bf16 v[76:79],a[144:147],a[16:19],v[76:79]
s_waitcnt lgkmcnt(0)
v_mfma_f32_16x16x32_bf16 v[76:79],a[148:151],a[20:23],v[76:79]
v_mfma_f32_16x16x32_bf16 v[84:87],a[148:151],a[44:47],0
v_mfma_f32_16x16x32_bf16 v[84:87],a[144:147],a[40:43],v[84:87]
v_mfma_f32_16x16x32_bf16 v[84:87],a[140:143],a[36:39],v[84:87]
v_mfma_f32_16x16x32_bf16 v[84:87],a[136:139],a[32:35],v[84:87]
v_mfma_f32_16x16x32_bf16 v[84:87],a[132:135],a[28:31],v[84:87]
v_mfma_f32_16x16x32_bf16 v[84:87],a[128:131],a[24:27],v[84:87]
v_mfma_f32_16x16x32_bf16 v[92:95],a[128:131],a[48:51],0
buffer_load_dwordx4 v8,s[4:7],s20 offen offset:2048 lds
v_mfma_f32_16x16x32_bf16 v[92:95],a[132:135],a[52:55],v[92:95]
s_add_u32 s20,s20,12288
v_mfma_f32_16x16x32_bf16 v[92:95],a[136:139],a[56:59],v[92:95]
v_mfma_f32_16x16x32_bf16 v[92:95],a[140:143],a[60:63],v[92:95]
v_mfma_f32_16x16x32_bf16 v[92:95],a[144:147],a[64:67],v[92:95]
v_mfma_f32_16x16x32_bf16 v[92:95],a[148:151],a[68:71],v[92:95]
ds_read_b64_tr_b16 a[120:121],v2 offset:12288
v_mfma_f32_16x16x32_bf16 v[100:103],a[148:151],a[92:95],0
ds_read_b64_tr_b16 a[122:123],v2 offset:18432
v_mfma_f32_16x16x32_bf16 v[100:103],a[144:147],a[88:91],v[100:103]
v_mfma_f32_16x16x32_bf16 v[100:103],a[140:143],a[84:87],v[100:103]
ds_read_b64_tr_b16 a[124:125],v3 offset:12288
v_mfma_f32_16x16x32_bf16 v[100:103],a[136:139],a[80:83],v[100:103]
ds_read_b64_tr_b16 a[126:127],v3 offset:18432
v_mfma_f32_16x16x32_bf16 v[100:103],a[132:135],a[76:79],v[100:103]
v_mfma_f32_16x16x32_bf16 v[100:103],a[128:131],a[72:75],v[100:103]
v_mfma_f32_16x16x32_bf16 v[108:111],a[128:131],a[96:99],0
ds_read_b64_tr_b16 a[128:129],v4 offset:12288
v_mfma_f32_16x16x32_bf16 v[108:111],a[132:135],a[100:103],v[108:111]
ds_read_b64_tr_b16 a[130:131],v4 offset:18432
v_mfma_f32_16x16x32_bf16 v[108:111],a[136:139],a[104:107],v[108:111]
ds_read_b64_tr_b16 a[132:133],v5 offset:12288
v_mfma_f32_16x16x32_bf16 v[108:111],a[140:143],a[108:111],v[108:111]
ds_read_b64_tr_b16 a[134:135],v5 offset:18432
v_mfma_f32_16x16x32_bf16 v[108:111],a[144:147],a[112:115],v[108:111]
v_mfma_f32_16x16x32_bf16 v[108:111],a[148:151],a[116:119],v[108:111]
s_waitcnt lgkmcnt(4)
v_mfma_f32_16x16x32_bf16 v[160:163],a[120:123],v[44:47],v[160:163]
s_add_u32 m0,s23,12288
ds_read_b64_tr_b16 a[136:137],v2 offset:12416
v_fma_f32 v90,v90,s36,v15
v_mfma_f32_16x16x32_bf16 v[164:167],a[124:127],v[44:47],v[164:167]
ds_read_b64_tr_b16 a[138:139],v2 offset:18560
v_fma_f32 v91,v91,s36,v15
v_mfma_f32_16x16x32_bf16 v[212:215],a[124:127],v[48:51],v[212:215]
ds_read_b64_tr_b16 a[140:141],v3 offset:12416
v_fma_f32 v96,v96,s36,v16
v_mfma_f32_16x16x32_bf16 v[208:211],a[120:123],v[48:51],v[208:211]
ds_read_b64_tr_b16 a[142:143],v3 offset:18560
v_fma_f32 v97,v97,s36,v16
v_mfma_f32_16x16x32_bf16 v[112:115],a[120:123],v[52:55],v[112:115]
ds_read_b64_tr_b16 a[144:145],v4 offset:12416
v_fma_f32 v98,v98,s36,v16
v_mfma_f32_16x16x32_bf16 v[116:119],a[124:127],v[52:55],v[116:119]
ds_read_b64_tr_b16 a[146:147],v4 offset:18560
v_fma_f32 v99,v99,s36,v16
v_mfma_f32_16x16x32_bf16 a[164:167],a[124:127],v[56:59],a[164:167]
ds_read_b64_tr_b16 a[148:149],v5 offset:12416
v_fma_f32 v104,v104,s36,v17
v_mfma_f32_16x16x32_bf16 a[160:163],a[120:123],v[56:59],a[160:163]
ds_read_b64_tr_b16 a[150:151],v5 offset:18560
v_fma_f32 v105,v105,s36,v17
v_mfma_f32_16x16x32_bf16 a[208:211],a[120:123],v[40:43],a[208:211]
ds_read_b64_tr_b16 a[120:121],v2 offset:12544
v_fma_f32 v106,v106,s36,v17
v_mfma_f32_16x16x32_bf16 a[212:215],a[124:127],v[40:43],a[212:215]
s_waitcnt lgkmcnt(6)
ds_read_b64_tr_b16 a[122:123],v2 offset:18688
v_fma_f32 v107,v107,s36,v17
v_mfma_f32_16x16x32_bf16 a[216:219],a[128:131],v[40:43],a[216:219]
ds_read_b64_tr_b16 a[124:125],v3 offset:12544
v_fma_f32 v76,v76,s36,v13
v_mfma_f32_16x16x32_bf16 a[220:223],a[132:135],v[40:43],a[220:223]
ds_read_b64_tr_b16 a[126:127],v3 offset:18688
v_fma_f32 v77,v77,s36,v13
v_mfma_f32_16x16x32_bf16 a[172:175],a[132:135],v[56:59],a[172:175]
v_exp_f32 v90,v90
v_mfma_f32_16x16x32_bf16 a[168:171],a[128:131],v[56:59],a[168:171]
v_exp_f32 v91,v91
v_mfma_f32_16x16x32_bf16 v[120:123],a[128:131],v[52:55],v[120:123]
v_cvt_pk_bf16_f32 v29,v90,v91
v_fma_f32 v78,v78,s36,v13
v_mfma_f32_16x16x32_bf16 v[124:127],a[132:135],v[52:55],v[124:127]
v_exp_f32 v96,v96
v_mfma_f32_16x16x32_bf16 v[220:223],a[132:135],v[48:51],v[220:223]
v_exp_f32 v97,v97
v_mfma_f32_16x16x32_bf16 v[216:219],a[128:131],v[48:51],v[216:219]
v_exp_f32 v98,v98
v_mfma_f32_16x16x32_bf16 v[168:171],a[128:131],v[44:47],v[168:171]
ds_read_b64_tr_b16 a[128:129],v4 offset:12544
v_cvt_pk_bf16_f32 v32,v96,v97
v_mfma_f32_16x16x32_bf16 v[172:175],a[132:135],v[44:47],v[172:175]
ds_read_b64_tr_b16 a[130:131],v4 offset:18688
v_fma_f32 v79,v79,s36,v13
v_mfma_f32_16x16x32_bf16 v[176:179],a[136:139],v[44:47],v[176:179]
s_waitcnt lgkmcnt(2)
ds_read_b64_tr_b16 a[132:133],v5 offset:12544
v_fma_f32 v84,v84,s36,v14
v_mfma_f32_16x16x32_bf16 v[180:183],a[140:143],v[44:47],v[180:183]
ds_read_b64_tr_b16 a[134:135],v5 offset:18688
v_fma_f32 v85,v85,s36,v14
v_mfma_f32_16x16x32_bf16 v[228:231],a[140:143],v[48:51],v[228:231]
v_exp_f32 v99,v99
v_mfma_f32_16x16x32_bf16 v[224:227],a[136:139],v[48:51],v[224:227]
v_cvt_pk_bf16_f32 v33,v98,v99
v_fma_f32 v86,v86,s36,v14
v_mfma_f32_16x16x32_bf16 v[128:131],a[136:139],v[52:55],v[128:131]
v_exp_f32 v104,v104
v_mfma_f32_16x16x32_bf16 v[132:135],a[140:143],v[52:55],v[132:135]
v_exp_f32 v105,v105
v_mfma_f32_16x16x32_bf16 a[180:183],a[140:143],v[56:59],a[180:183]
v_exp_f32 v106,v106
v_mfma_f32_16x16x32_bf16 a[176:179],a[136:139],v[56:59],a[176:179]
v_exp_f32 v107,v107
v_mfma_f32_16x16x32_bf16 a[224:227],a[136:139],v[40:43],a[224:227]
v_cvt_pk_bf16_f32 v36,v104,v105
v_cvt_pk_bf16_f32 v37,v106,v107
v_mfma_f32_16x16x32_bf16 a[228:231],a[140:143],v[40:43],a[228:231]
v_exp_f32 v76,v76
v_mfma_f32_16x16x32_bf16 a[232:235],a[144:147],v[40:43],a[232:235]
v_exp_f32 v77,v77
v_mfma_f32_16x16x32_bf16 a[236:239],a[148:151],v[40:43],a[236:239]
v_exp_f32 v78,v78
v_mfma_f32_16x16x32_bf16 a[188:191],a[148:151],v[56:59],a[188:191]
v_exp_f32 v79,v79
v_mfma_f32_16x16x32_bf16 a[184:187],a[144:147],v[56:59],a[184:187]
v_cvt_pk_bf16_f32 v22,v76,v77
v_cvt_pk_bf16_f32 v23,v78,v79
v_mfma_f32_16x16x32_bf16 v[136:139],a[144:147],v[52:55],v[136:139]
v_fma_f32 v87,v87,s36,v14
v_fma_f32 v92,v92,s36,v15
v_mfma_f32_16x16x32_bf16 v[140:143],a[148:151],v[52:55],v[140:143]
v_exp_f32 v84,v84
v_mfma_f32_16x16x32_bf16 v[236:239],a[148:151],v[48:51],v[236:239]
v_exp_f32 v85,v85
v_mfma_f32_16x16x32_bf16 v[232:235],a[144:147],v[48:51],v[232:235]
v_exp_f32 v86,v86
v_mfma_f32_16x16x32_bf16 v[184:187],a[144:147],v[44:47],v[184:187]
v_exp_f32 v87,v87
v_mfma_f32_16x16x32_bf16 v[188:191],a[148:151],v[44:47],v[188:191]
v_cvt_pk_bf16_f32 v26,v84,v85
v_cvt_pk_bf16_f32 v27,v86,v87
v_mfma_f32_16x16x32_bf16 v[192:195],a[120:123],v[44:47],v[192:195]
v_fma_f32 v93,v93,s36,v15
v_fma_f32 v94,v94,s36,v15
v_smfmac_f32_16x16x64_bf16 v[60:63],a[152:155],v[20:27],v18
v_fma_f32 v95,v95,s36,v15
v_mfma_f32_16x16x32_bf16 v[196:199],a[124:127],v[44:47],v[196:199]
s_waitcnt vmcnt(6) lgkmcnt(0)
v_exp_f32 v92,v92
v_mfma_f32_16x16x32_bf16 v[244:247],a[124:127],v[48:51],v[244:247]
s_barrier
v_mfma_f32_16x16x32_bf16 v[240:243],a[120:123],v[48:51],v[240:243]
ds_read_b128 a[136:139],v0 offset:0
v_fma_f32 v100,v100,s36,v16
v_mfma_f32_16x16x32_bf16 v[144:147],a[120:123],v[52:55],v[144:147]
ds_read_b128 a[140:143],v1 offset:0
v_fma_f32 v101,v101,s36,v16
v_mfma_f32_16x16x32_bf16 v[148:151],a[124:127],v[52:55],v[148:151]
ds_read_b128 a[144:147],v0 offset:128
v_fma_f32 v102,v102,s36,v16
v_mfma_f32_16x16x32_bf16 a[196:199],a[124:127],v[56:59],a[196:199]
ds_read_b128 a[148:151],v1 offset:128
v_fma_f32 v103,v103,s36,v16
v_mfma_f32_16x16x32_bf16 a[192:195],a[120:123],v[56:59],a[192:195]
v_exp_f32 v93,v93
v_mfma_f32_16x16x32_bf16 a[240:243],a[120:123],v[40:43],a[240:243]
buffer_load_dwordx4 v6,s[8:11],s21 offen offset:0 lds
v_mfma_f32_16x16x32_bf16 a[244:247],a[124:127],v[40:43],a[244:247]
ds_read_b128 a[120:123],v0 offset:256
v_cvt_pk_bf16_f32 v30,v92,v93
v_mfma_f32_16x16x32_bf16 a[248:251],a[128:131],v[40:43],a[248:251]
ds_read_b128 a[124:127],v1 offset:256
v_fma_f32 v108,v108,s36,v17
v_mfma_f32_16x16x32_bf16 a[252:255],a[132:135],v[40:43],a[252:255]
v_exp_f32 v94,v94
v_mfma_f32_16x16x32_bf16 a[204:207],a[132:135],v[56:59],a[204:207]
v_exp_f32 v95,v95
v_mfma_f32_16x16x32_bf16 a[200:203],a[128:131],v[56:59],a[200:203]
v_cvt_pk_bf16_f32 v31,v94,v95
v_fma_f32 v109,v109,s36,v17
v_mfma_f32_16x16x32_bf16 v[152:155],a[128:131],v[52:55],v[152:155]
v_exp_f32 v100,v100
v_mfma_f32_16x16x32_bf16 v[156:159],a[132:135],v[52:55],v[156:159]
v_exp_f32 v101,v101
v_mfma_f32_16x16x32_bf16 v[252:255],a[132:135],v[48:51],v[252:255]
v_exp_f32 v102,v102
v_mfma_f32_16x16x32_bf16 v[248:251],a[128:131],v[48:51],v[248:251]
v_exp_f32 v103,v103
v_mfma_f32_16x16x32_bf16 v[200:203],a[128:131],v[44:47],v[200:203]
ds_read_b128 a[128:131],v0 offset:6144
v_cvt_pk_bf16_f32 v34,v100,v101
v_mfma_f32_16x16x32_bf16 v[204:207],a[132:135],v[44:47],v[204:207]
buffer_load_dwordx4 v7,s[8:11],s21 offen offset:1024 lds
s_waitcnt lgkmcnt(1)
v_mfma_f32_16x16x32_bf16 v[72:75],a[136:139],a[0:3],0
ds_read_b128 a[132:135],v1 offset:6144
v_cvt_pk_bf16_f32 v35,v102,v103
v_mfma_f32_16x16x32_bf16 v[72:75],a[140:143],a[4:7],v[72:75]
v_fma_f32 v110,v110,s36,v17
v_fma_f32 v111,v111,s36,v17
v_smfmac_f32_16x16x64_bf16 v[64:67],a[152:155],v[28:35],v18
v_mfma_f32_16x16x32_bf16 v[72:75],a[144:147],a[8:11],v[72:75]
v_exp_f32 v108,v108
v_mfma_f32_16x16x32_bf16 v[72:75],a[148:151],a[12:15],v[72:75]
v_exp_f32 v109,v109
v_mfma_f32_16x16x32_bf16 v[72:75],a[120:123],a[16:19],v[72:75]
v_exp_f32 v110,v110
v_mfma_f32_16x16x32_bf16 v[72:75],a[124:127],a[20:23],v[72:75]
v_exp_f32 v111,v111
v_mfma_f32_16x16x32_bf16 v[80:83],a[124:127],a[44:47],0
v_cvt_pk_bf16_f32 v38,v108,v109
v_cvt_pk_bf16_f32 v39,v110,v111
v_mfma_f32_16x16x32_bf16 v[80:83],a[120:123],a[40:43],v[80:83]
v_mfma_f32_16x16x32_bf16 v[80:83],a[148:151],a[36:39],v[80:83]
v_mfma_f32_16x16x32_bf16 v[80:83],a[144:147],a[32:35],v[80:83]
buffer_load_dwordx4 v8,s[8:11],s21 offen offset:2048 lds
v_mfma_f32_16x16x32_bf16 v[80:83],a[140:143],a[28:31],v[80:83]
s_add_u32 s21,s21,12288
v_fma_f32 v72,v72,s36,v13
v_fma_f32 v73,v73,s36,v13
v_mfma_f32_16x16x32_bf16 v[80:83],a[136:139],a[24:27],v[80:83]
s_add_u32 m0,s22,24576
v_fma_f32 v74,v74,s36,v13
v_fma_f32 v75,v75,s36,v13
v_mfma_f32_16x16x32_bf16 v[88:91],a[136:139],a[48:51],0
v_exp_f32 v72,v72
v_mfma_f32_16x16x32_bf16 v[88:91],a[140:143],a[52:55],v[88:91]
v_exp_f32 v73,v73
v_mfma_f32_16x16x32_bf16 v[88:91],a[144:147],a[56:59],v[88:91]
v_fma_f32 v80,v80,s36,v14
v_fma_f32 v81,v81,s36,v14
v_mfma_f32_16x16x32_bf16 v[88:91],a[148:151],a[60:63],v[88:91]
v_fma_f32 v82,v82,s36,v14
v_fma_f32 v83,v83,s36,v14
v_mfma_f32_16x16x32_bf16 v[88:91],a[120:123],a[64:67],v[88:91]
v_exp_f32 v74,v74
v_mfma_f32_16x16x32_bf16 v[88:91],a[124:127],a[68:71],v[88:91]
v_exp_f32 v75,v75
v_mfma_f32_16x16x32_bf16 v[96:99],a[124:127],a[92:95],0
v_exp_f32 v80,v80
v_mfma_f32_16x16x32_bf16 v[96:99],a[120:123],a[88:91],v[96:99]
v_exp_f32 v81,v81
v_mfma_f32_16x16x32_bf16 v[96:99],a[148:151],a[84:87],v[96:99]
v_exp_f32 v82,v82
v_mfma_f32_16x16x32_bf16 v[96:99],a[144:147],a[80:83],v[96:99]
buffer_load_dwordx4 v6,s[4:7],s20 offen offset:0 lds
v_mfma_f32_16x16x32_bf16 v[96:99],a[140:143],a[76:79],v[96:99]
v_fma_f32 v88,v88,s36,v15
v_fma_f32 v89,v89,s36,v15
v_mfma_f32_16x16x32_bf16 v[96:99],a[136:139],a[72:75],v[96:99]
v_exp_f32 v83,v83
v_mfma_f32_16x16x32_bf16 v[104:107],a[136:139],a[96:99],0
ds_read_b128 a[136:139],v0 offset:6272
v_cvt_pk_bf16_f32 v44,v72,v73
v_mfma_f32_16x16x32_bf16 v[104:107],a[140:143],a[100:103],v[104:107]
ds_read_b128 a[140:143],v1 offset:6272
v_cvt_pk_bf16_f32 v45,v74,v75
v_mfma_f32_16x16x32_bf16 v[104:107],a[144:147],a[104:107],v[104:107]
ds_read_b128 a[144:147],v0 offset:6400
v_cvt_pk_bf16_f32 v48,v80,v81
v_mfma_f32_16x16x32_bf16 v[104:107],a[148:151],a[108:111],v[104:107]
ds_read_b128 a[148:151],v1 offset:6400
v_cvt_pk_bf16_f32 v49,v82,v83
v_mfma_f32_16x16x32_bf16 v[104:107],a[120:123],a[112:115],v[104:107]
v_exp_f32 v88,v88
v_mfma_f32_16x16x32_bf16 v[104:107],a[124:127],a[116:119],v[104:107]
s_waitcnt lgkmcnt(4)
v_exp_f32 v89,v89
v_mfma_f32_16x16x32_bf16 v[76:79],a[128:131],a[0:3],0
v_cvt_pk_bf16_f32 v52,v88,v89
v_mfma_f32_16x16x32_bf16 v[76:79],a[132:135],a[4:7],v[76:79]
s_waitcnt lgkmcnt(3)
v_mfma_f32_16x16x32_bf16 v[76:79],a[136:139],a[8:11],v[76:79]
buffer_load_dwordx4 v7,s[4:7],s20 offen offset:1024 lds
s_waitcnt lgkmcnt(2)
v_mfma_f32_16x16x32_bf16 v[76:79],a[140:143],a[12:15],v[76:79]
s_waitcnt lgkmcnt(1)
v_mfma_f32_16x16x32_bf16 v[76:79],a[144:147],a[16:19],v[76:79]
s_waitcnt lgkmcnt(0)
v_mfma_f32_16x16x32_bf16 v[76:79],a[148:151],a[20:23],v[76:79]
v_mfma_f32_16x16x32_bf16 v[84:87],a[148:151],a[44:47],0
v_mfma_f32_16x16x32_bf16 v[84:87],a[144:147],a[40:43],v[84:87]
v_mfma_f32_16x16x32_bf16 v[84:87],a[140:143],a[36:39],v[84:87]
v_mfma_f32_16x16x32_bf16 v[84:87],a[136:139],a[32:35],v[84:87]
v_mfma_f32_16x16x32_bf16 v[84:87],a[132:135],a[28:31],v[84:87]
v_mfma_f32_16x16x32_bf16 v[84:87],a[128:131],a[24:27],v[84:87]
v_mfma_f32_16x16x32_bf16 v[92:95],a[128:131],a[48:51],0
v_mfma_f32_16x16x32_bf16 v[92:95],a[132:135],a[52:55],v[92:95]
buffer_load_dwordx4 v8,s[4:7],s20 offen offset:2048 lds
v_mfma_f32_16x16x32_bf16 v[92:95],a[136:139],a[56:59],v[92:95]
s_add_u32 s20,s20,12288
v_mfma_f32_16x16x32_bf16 v[92:95],a[140:143],a[60:63],v[92:95]
v_mfma_f32_16x16x32_bf16 v[92:95],a[144:147],a[64:67],v[92:95]
v_mfma_f32_16x16x32_bf16 v[92:95],a[148:151],a[68:71],v[92:95]
v_mfma_f32_16x16x32_bf16 v[100:103],a[148:151],a[92:95],0
v_mfma_f32_16x16x32_bf16 v[100:103],a[144:147],a[88:91],v[100:103]
ds_read_b64_tr_b16 a[120:121],v2 offset:24576
v_mfma_f32_16x16x32_bf16 v[100:103],a[140:143],a[84:87],v[100:103]
ds_read_b64_tr_b16 a[122:123],v2 offset:30720
v_mfma_f32_16x16x32_bf16 v[100:103],a[136:139],a[80:83],v[100:103]
ds_read_b64_tr_b16 a[124:125],v3 offset:24576
v_mfma_f32_16x16x32_bf16 v[100:103],a[132:135],a[76:79],v[100:103]
ds_read_b64_tr_b16 a[126:127],v3 offset:30720
v_mfma_f32_16x16x32_bf16 v[100:103],a[128:131],a[72:75],v[100:103]
v_mfma_f32_16x16x32_bf16 v[108:111],a[128:131],a[96:99],0
ds_read_b64_tr_b16 a[128:129],v4 offset:24576
v_mfma_f32_16x16x32_bf16 v[108:111],a[132:135],a[100:103],v[108:111]
ds_read_b64_tr_b16 a[130:131],v4 offset:30720
v_mfma_f32_16x16x32_bf16 v[108:111],a[136:139],a[104:107],v[108:111]
ds_read_b64_tr_b16 a[132:133],v5 offset:24576
v_mfma_f32_16x16x32_bf16 v[108:111],a[140:143],a[108:111],v[108:111]
ds_read_b64_tr_b16 a[134:135],v5 offset:30720
v_mfma_f32_16x16x32_bf16 v[108:111],a[144:147],a[112:115],v[108:111]
v_mfma_f32_16x16x32_bf16 v[108:111],a[148:151],a[116:119],v[108:111]
s_mov_b32 s38,0
s_branch L_loop5
L_loop4:
.p2align 6
L_loop4w0:
s_waitcnt lgkmcnt(3)
v_mfma_f32_16x16x32_bf16 v[160:163],a[120:123],v[20:23],v[160:163]
s_add_u32 m0,s23,24576
ds_read_b64_tr_b16 a[142:143],v3 offset:30848
v_fma_f32 v83,v83,s36,v14
v_mfma_f32_16x16x32_bf16 v[164:167],a[124:127],v[20:23],v[164:167]
ds_read_b64_tr_b16 a[138:139],v2 offset:30848
v_fma_f32 v82,v82,s36,v14
v_mfma_f32_16x16x32_bf16 v[212:215],a[124:127],v[24:27],v[212:215]
ds_read_b64_tr_b16 a[136:137],v2 offset:24704
v_fma_f32 v88,v88,s36,v15
v_mfma_f32_16x16x32_bf16 v[208:211],a[120:123],v[24:27],v[208:211]
ds_read_b64_tr_b16 a[140:141],v3 offset:24704
v_fma_f32 v91,v91,s36,v15
v_mfma_f32_16x16x32_bf16 v[112:115],a[120:123],v[28:31],v[112:115]
ds_read_b64_tr_b16 a[146:147],v4 offset:30848
v_fma_f32 v89,v89,s36,v15
v_mfma_f32_16x16x32_bf16 v[116:119],a[124:127],v[28:31],v[116:119]
ds_read_b64_tr_b16 a[150:151],v5 offset:30848
v_fma_f32 v90,v90,s36,v15
v_mfma_f32_16x16x32_bf16 a[164:167],a[124:127],v[32:35],a[164:167]
ds_read_b64_tr_b16 a[144:145],v4 offset:24704
v_fma_f32 v96,v96,s36,v16
v_mfma_f32_16x16x32_bf16 a[160:163],a[120:123],v[32:35],a[160:163]
s_waitcnt lgkmcnt(6)
ds_read_b64_tr_b16 a[148:149],v5 offset:24704
v_fma_f32 v98,v98,s36,v16
v_mfma_f32_16x16x32_bf16 a[168:171],a[128:131],v[32:35],a[168:171]
ds_read_b64_tr_b16 a[120:121],v2 offset:24832
v_fma_f32 v99,v99,s36,v16
v_mfma_f32_16x16x32_bf16 a[172:175],a[132:135],v[32:35],a[172:175]
ds_read_b64_tr_b16 a[126:127],v3 offset:30976
v_fma_f32 v97,v97,s36,v16
v_mfma_f32_16x16x32_bf16 v[124:127],a[132:135],v[28:31],v[124:127]
ds_read_b64_tr_b16 a[122:123],v2 offset:30976
v_fma_f32 v79,v79,s36,v13
v_mfma_f32_16x16x32_bf16 v[120:123],a[128:131],v[28:31],v[120:123]
ds_read_b64_tr_b16 a[124:125],v3 offset:24832
v_fma_f32 v77,v77,s36,v13
v_mfma_f32_16x16x32_bf16 v[216:219],a[128:131],v[24:27],v[216:219]
v_exp_f32 v82,v82
v_mfma_f32_16x16x32_bf16 v[220:223],a[132:135],v[24:27],v[220:223]
v_exp_f32 v83,v83
v_mfma_f32_16x16x32_bf16 v[172:175],a[132:135],v[20:23],v[172:175]
ds_read_b64_tr_b16 a[132:133],v5 offset:24832
v_cvt_pk_bf16_f32 v49,v82,v83
v_mfma_f32_16x16x32_bf16 v[168:171],a[128:131],v[20:23],v[168:171]
s_waitcnt lgkmcnt(4)
ds_read_b64_tr_b16 a[134:135],v5 offset:30976
v_fma_f32 v76,v76,s36,v13
v_mfma_f32_16x16x32_bf16 v[176:179],a[136:139],v[20:23],v[176:179]
ds_read_b64_tr_b16 a[128:129],v4 offset:24832
v_fma_f32 v78,v78,s36,v13
v_mfma_f32_16x16x32_bf16 v[180:183],a[140:143],v[20:23],v[180:183]
ds_read_b64_tr_b16 a[130:131],v4 offset:30976
v_fma_f32 v86,v86,s36,v14
v_mfma_f32_16x16x32_bf16 v[228:231],a[140:143],v[24:27],v[228:231]
v_exp_f32 v90,v90
v_mfma_f32_16x16x32_bf16 v[224:227],a[136:139],v[24:27],v[224:227]
v_exp_f32 v88,v88
v_mfma_f32_16x16x32_bf16 v[128:131],a[136:139],v[28:31],v[128:131]
v_exp_f32 v89,v89
v_mfma_f32_16x16x32_bf16 v[132:135],a[140:143],v[28:31],v[132:135]
v_cvt_pk_bf16_f32 v52,v88,v89
v_fma_f32 v84,v84,s36,v14
v_mfma_f32_16x16x32_bf16 a[180:183],a[140:143],v[32:35],a[180:183]
v_exp_f32 v91,v91
v_mfma_f32_16x16x32_bf16 a[176:179],a[136:139],v[32:35],a[176:179]
v_cvt_pk_bf16_f32 v53,v90,v91
v_fma_f32 v85,v85,s36,v14
v_mfma_f32_16x16x32_bf16 a[184:187],a[144:147],v[32:35],a[184:187]
v_exp_f32 v99,v99
v_mfma_f32_16x16x32_bf16 a[188:191],a[148:151],v[32:35],a[188:191]
v_exp_f32 v97,v97
v_mfma_f32_16x16x32_bf16 v[140:143],a[148:151],v[28:31],v[140:143]
v_exp_f32 v96,v96
v_mfma_f32_16x16x32_bf16 v[136:139],a[144:147],v[28:31],v[136:139]
v_cvt_pk_bf16_f32 v56,v96,v97
v_fma_f32 v87,v87,s36,v14
v_mfma_f32_16x16x32_bf16 v[232:235],a[144:147],v[24:27],v[232:235]
v_exp_f32 v98,v98
v_mfma_f32_16x16x32_bf16 v[236:239],a[148:151],v[24:27],v[236:239]
v_cvt_pk_bf16_f32 v57,v98,v99
v_fma_f32 v94,v94,s36,v15
v_mfma_f32_16x16x32_bf16 v[188:191],a[148:151],v[20:23],v[188:191]
v_exp_f32 v76,v76
v_mfma_f32_16x16x32_bf16 v[184:187],a[144:147],v[20:23],v[184:187]
s_waitcnt lgkmcnt(0)
v_exp_f32 v79,v79
v_mfma_f32_16x16x32_bf16 v[192:195],a[120:123],v[20:23],v[192:195]
v_exp_f32 v78,v78
v_mfma_f32_16x16x32_bf16 v[196:199],a[124:127],v[20:23],v[196:199]
s_waitcnt vmcnt(6)
ds_read_b128 a[156:159],v10 offset:0
v_cvt_pk_bf16_f32 v47,v78,v79
v_mfma_f32_16x16x32_bf16 v[244:247],a[124:127],v[24:27],v[244:247]
s_barrier
v_mfma_f32_16x16x32_bf16 v[240:243],a[120:123],v[24:27],v[240:243]
ds_read_b128 a[148:151],v1 offset:12416
v_fma_f32 v92,v92,s36,v15
v_mfma_f32_16x16x32_bf16 v[144:147],a[120:123],v[28:31],v[144:147]
ds_read_b128 a[144:147],v0 offset:12416
v_fma_f32 v93,v93,s36,v15
v_mfma_f32_16x16x32_bf16 v[148:151],a[124:127],v[28:31],v[148:151]
ds_read_b128 a[140:143],v1 offset:12288
v_fma_f32 v95,v95,s36,v15
v_mfma_f32_16x16x32_bf16 a[196:199],a[124:127],v[32:35],a[196:199]
ds_read_b128 a[124:127],v1 offset:12544
v_fma_f32 v102,v102,s36,v16
v_mfma_f32_16x16x32_bf16 a[192:195],a[120:123],v[32:35],a[192:195]
ds_read_b128 a[120:123],v0 offset:12544
v_fma_f32 v100,v100,s36,v16
v_mfma_f32_16x16x32_bf16 a[200:203],a[128:131],v[32:35],a[200:203]
buffer_load_dwordx4 v6,s[8:11],s21 offen offset:0 lds
v_mfma_f32_16x16x32_bf16 a[204:207],a[132:135],v[32:35],a[204:207]
ds_read_b128 a[136:139],v0 offset:12288
v_fma_f32 v101,v101,s36,v16
v_mfma_f32_16x16x32_bf16 v[156:159],a[132:135],v[28:31],v[156:159]
v_exp_f32 v77,v77
v_mfma_f32_16x16x32_bf16 v[152:155],a[128:131],v[28:31],v[152:155]
v_cvt_pk_bf16_f32 v46,v76,v77
v_fma_f32 v103,v103,s36,v16
v_mfma_f32_16x16x32_bf16 v[248:251],a[128:131],v[24:27],v[248:251]
v_exp_f32 v86,v86
v_mfma_f32_16x16x32_bf16 v[252:255],a[132:135],v[24:27],v[252:255]
v_exp_f32 v87,v87
v_mfma_f32_16x16x32_bf16 v[204:207],a[132:135],v[20:23],v[204:207]
ds_read_b128 a[132:135],v1 offset:18432
v_cvt_pk_bf16_f32 v51,v86,v87
v_mfma_f32_16x16x32_bf16 v[200:203],a[128:131],v[20:23],v[200:203]
s_waitcnt lgkmcnt(2)
ds_read_b128 a[128:131],v0 offset:18432
v_mfma_f32_16x16x32_bf16 v[72:75],a[124:127],a[20:23],0
v_exp_f32 v85,v85
v_mfma_f32_16x16x32_bf16 v[72:75],a[120:123],a[16:19],v[72:75]
buffer_store_dwordx4 a[156:159],v9,s[16:19],s27 offen offset:0 nt
buffer_load_dwordx4 v7,s[8:11],s21 offen offset:1024 lds
v_mfma_f32_16x16x32_bf16 v[72:75],a[148:151],a[12:15],v[72:75]
ds_read_b128 a[156:159],v10 offset:1024
v_mfma_f32_16x16x32_bf16 v[72:75],a[144:147],a[8:11],v[72:75]
v_exp_f32 v84,v84
v_mfma_f32_16x16x32_bf16 v[72:75],a[140:143],a[4:7],v[72:75]
s_waitcnt lgkmcnt(3)
v_cvt_pk_bf16_f32 v50,v84,v85
v_mfma_f32_16x16x32_bf16 v[72:75],a[136:139],a[0:3],v[72:75]
v_exp_f32 v93,v93
v_smfmac_f32_16x16x64_bf16 v[60:63],a[152:155],v[44:51],v18
v_mfma_f32_16x16x32_bf16 v[80:83],a[136:139],a[24:27],0
v_exp_f32 v94,v94
v_mfma_f32_16x16x32_bf16 v[80:83],a[140:143],a[28:31],v[80:83]
v_exp_f32 v92,v92
v_mfma_f32_16x16x32_bf16 v[80:83],a[144:147],a[32:35],v[80:83]
buffer_load_dwordx4 v8,s[8:11],s21 offen offset:2048 lds
v_mfma_f32_16x16x32_bf16 v[80:83],a[148:151],a[36:39],v[80:83]
s_add_u32 s21,s21,12288
v_cvt_pk_bf16_f32 v54,v92,v93
v_fma_f32 v72,v72,s36,v13
v_mfma_f32_16x16x32_bf16 v[80:83],a[120:123],a[40:43],v[80:83]
s_add_u32 m0,s22,0
v_exp_f32 v95,v95
v_mfma_f32_16x16x32_bf16 v[80:83],a[124:127],a[44:47],v[80:83]
v_cvt_pk_bf16_f32 v55,v94,v95
v_fma_f32 v75,v75,s36,v13
v_mfma_f32_16x16x32_bf16 v[88:91],a[124:127],a[68:71],0
v_exp_f32 v103,v103
v_mfma_f32_16x16x32_bf16 v[88:91],a[120:123],a[64:67],v[88:91]
v_exp_f32 v100,v100
v_mfma_f32_16x16x32_bf16 v[88:91],a[148:151],a[60:63],v[88:91]
v_exp_f32 v102,v102
v_mfma_f32_16x16x32_bf16 v[88:91],a[144:147],a[56:59],v[88:91]
v_cvt_pk_bf16_f32 v59,v102,v103
v_fma_f32 v80,v80,s36,v14
v_mfma_f32_16x16x32_bf16 v[88:91],a[140:143],a[52:55],v[88:91]
v_exp_f32 v101,v101
v_mfma_f32_16x16x32_bf16 v[88:91],a[136:139],a[48:51],v[88:91]
s_waitcnt lgkmcnt(0)
buffer_store_dwordx4 a[156:159],v9,s[16:19],s27 offen offset:128 nt
buffer_load_dwordx4 v6,s[4:7],s20 offen offset:0 lds
v_mfma_f32_16x16x32_bf16 v[96:99],a[136:139],a[72:75],0
ds_read_b128 a[156:159],v10 offset:2048
v_cvt_pk_bf16_f32 v58,v100,v101
v_mfma_f32_16x16x32_bf16 v[96:99],a[140:143],a[76:79],v[96:99]
ds_read_b128 a[136:139],v0 offset:18560
v_fma_f32 v81,v81,s36,v14
v_smfmac_f32_16x16x64_bf16 v[64:67],a[152:155],v[52:59],v18
ds_read_b128 a[140:143],v1 offset:18560
v_mfma_f32_16x16x32_bf16 v[96:99],a[144:147],a[80:83],v[96:99]
ds_read_b128 a[144:147],v0 offset:18688
v_mfma_f32_16x16x32_bf16 v[96:99],a[148:151],a[84:87],v[96:99]
ds_read_b128 a[148:151],v1 offset:18688
v_mfma_f32_16x16x32_bf16 v[96:99],a[120:123],a[88:91],v[96:99]
v_fma_f32 v73,v73,s36,v13
v_fma_f32 v74,v74,s36,v13
v_mfma_f32_16x16x32_bf16 v[96:99],a[124:127],a[92:95],v[96:99]
v_exp_f32 v74,v74
v_mfma_f32_16x16x32_bf16 v[76:79],a[128:131],a[0:3],0
buffer_load_dwordx4 v7,s[4:7],s20 offen offset:1024 lds
v_mfma_f32_16x16x32_bf16 v[76:79],a[132:135],a[4:7],v[76:79]
s_waitcnt lgkmcnt(3)
v_exp_f32 v75,v75
v_mfma_f32_16x16x32_bf16 v[76:79],a[136:139],a[8:11],v[76:79]
s_waitcnt lgkmcnt(2)
v_cvt_pk_bf16_f32 v21,v74,v75
v_mfma_f32_16x16x32_bf16 v[76:79],a[140:143],a[12:15],v[76:79]
s_waitcnt lgkmcnt(1)
v_exp_f32 v73,v73
v_mfma_f32_16x16x32_bf16 v[76:79],a[144:147],a[16:19],v[76:79]
s_waitcnt lgkmcnt(0)
v_exp_f32 v80,v80
v_mfma_f32_16x16x32_bf16 v[76:79],a[148:151],a[20:23],v[76:79]
v_exp_f32 v81,v81
v_mfma_f32_16x16x32_bf16 v[84:87],a[148:151],a[44:47],0
v_cvt_pk_bf16_f32 v24,v80,v81
v_mfma_f32_16x16x32_bf16 v[84:87],a[144:147],a[40:43],v[84:87]
v_exp_f32 v72,v72
v_mfma_f32_16x16x32_bf16 v[84:87],a[140:143],a[36:39],v[84:87]
v_cvt_pk_bf16_f32 v20,v72,v73
v_mfma_f32_16x16x32_bf16 v[84:87],a[136:139],a[32:35],v[84:87]
buffer_store_dwordx4 a[156:159],v9,s[16:19],s27 offen offset:256 nt
buffer_load_dwordx4 v8,s[4:7],s20 offen offset:2048 lds
v_mfma_f32_16x16x32_bf16 v[84:87],a[132:135],a[28:31],v[84:87]
s_add_u32 s20,s20,12288
ds_read_b64_tr_b16 a[122:123],v2 offset:6144
v_mfma_f32_16x16x32_bf16 v[84:87],a[128:131],a[24:27],v[84:87]
s_add_u32 s27,s27,3072
ds_read_b64_tr_b16 a[120:121],v2 offset:0
v_mfma_f32_16x16x32_bf16 v[92:95],a[128:131],a[48:51],0
ds_read_b64_tr_b16 a[124:125],v3 offset:0
v_mfma_f32_16x16x32_bf16 v[92:95],a[132:135],a[52:55],v[92:95]
ds_read_b64_tr_b16 a[126:127],v3 offset:6144
v_mfma_f32_16x16x32_bf16 v[92:95],a[136:139],a[56:59],v[92:95]
v_mfma_f32_16x16x32_bf16 v[92:95],a[140:143],a[60:63],v[92:95]
v_mfma_f32_16x16x32_bf16 v[92:95],a[144:147],a[64:67],v[92:95]
v_mfma_f32_16x16x32_bf16 v[92:95],a[148:151],a[68:71],v[92:95]
v_mfma_f32_16x16x32_bf16 v[100:103],a[148:151],a[92:95],0
v_mfma_f32_16x16x32_bf16 v[100:103],a[144:147],a[88:91],v[100:103]
v_mfma_f32_16x16x32_bf16 v[100:103],a[140:143],a[84:87],v[100:103]
v_mfma_f32_16x16x32_bf16 v[100:103],a[136:139],a[80:83],v[100:103]
v_mfma_f32_16x16x32_bf16 v[100:103],a[132:135],a[76:79],v[100:103]
ds_read_b64_tr_b16 a[134:135],v5 offset:6144
v_mfma_f32_16x16x32_bf16 v[100:103],a[128:131],a[72:75],v[100:103]
s_waitcnt lgkmcnt(1)
ds_read_b64_tr_b16 a[128:129],v4 offset:0
ds_read_b64_tr_b16 a[130:131],v4 offset:6144
ds_read_b64_tr_b16 a[132:133],v5 offset:0
v_mfma_f32_16x16x32_bf16 v[160:163],a[120:123],v[44:47],v[160:163]
s_add_u32 m0,s29,0
ds_read_b64_tr_b16 a[136:137],v2 offset:128
v_fma_f32 v82,v82,s36,v14
v_mfma_f32_16x16x32_bf16 v[164:167],a[124:127],v[44:47],v[164:167]
ds_read_b64_tr_b16 a[138:139],v2 offset:6272
v_fma_f32 v83,v83,s36,v14
v_mfma_f32_16x16x32_bf16 v[212:215],a[124:127],v[48:51],v[212:215]
ds_read_b64_tr_b16 a[140:141],v3 offset:128
v_fma_f32 v88,v88,s36,v15
v_mfma_f32_16x16x32_bf16 v[208:211],a[120:123],v[48:51],v[208:211]
ds_read_b64_tr_b16 a[142:143],v3 offset:6272
v_fma_f32 v89,v89,s36,v15
v_mfma_f32_16x16x32_bf16 v[112:115],a[120:123],v[52:55],v[112:115]
ds_read_b64_tr_b16 a[144:145],v4 offset:128
v_fma_f32 v90,v90,s36,v15
v_mfma_f32_16x16x32_bf16 v[116:119],a[124:127],v[52:55],v[116:119]
ds_read_b64_tr_b16 a[146:147],v4 offset:6272
v_fma_f32 v91,v91,s36,v15
v_mfma_f32_16x16x32_bf16 a[164:167],a[124:127],v[56:59],a[164:167]
buffer_load_dwordx4 v6,s[12:15],s28 offen offset:0 nt lds
v_mfma_f32_16x16x32_bf16 a[160:163],a[120:123],v[56:59],a[160:163]
s_waitcnt lgkmcnt(5)
ds_read_b64_tr_b16 a[148:149],v5 offset:128
v_fma_f32 v96,v96,s36,v16
v_mfma_f32_16x16x32_bf16 a[168:171],a[128:131],v[56:59],a[168:171]
ds_read_b64_tr_b16 a[150:151],v5 offset:6272
v_fma_f32 v97,v97,s36,v16
v_mfma_f32_16x16x32_bf16 a[172:175],a[132:135],v[56:59],a[172:175]
ds_read_b64_tr_b16 a[120:121],v2 offset:256
v_fma_f32 v98,v98,s36,v16
v_mfma_f32_16x16x32_bf16 v[124:127],a[132:135],v[52:55],v[124:127]
ds_read_b64_tr_b16 a[122:123],v2 offset:6400
v_fma_f32 v99,v99,s36,v16
v_mfma_f32_16x16x32_bf16 v[120:123],a[128:131],v[52:55],v[120:123]
ds_read_b64_tr_b16 a[124:125],v3 offset:256
v_fma_f32 v76,v76,s36,v13
v_mfma_f32_16x16x32_bf16 v[216:219],a[128:131],v[48:51],v[216:219]
ds_read_b64_tr_b16 a[126:127],v3 offset:6400
v_fma_f32 v77,v77,s36,v13
v_mfma_f32_16x16x32_bf16 v[220:223],a[132:135],v[48:51],v[220:223]
buffer_load_dwordx4 v7,s[12:15],s28 offen offset:1024 nt lds
v_mfma_f32_16x16x32_bf16 v[172:175],a[132:135],v[44:47],v[172:175]
ds_read_b64_tr_b16 a[132:133],v5 offset:256
v_fma_f32 v78,v78,s36,v13
v_mfma_f32_16x16x32_bf16 v[168:171],a[128:131],v[44:47],v[168:171]
s_waitcnt lgkmcnt(5)
ds_read_b64_tr_b16 a[128:129],v4 offset:256
v_fma_f32 v79,v79,s36,v13
v_mfma_f32_16x16x32_bf16 v[176:179],a[136:139],v[44:47],v[176:179]
ds_read_b64_tr_b16 a[130:131],v4 offset:6400
v_fma_f32 v84,v84,s36,v14
v_mfma_f32_16x16x32_bf16 v[180:183],a[140:143],v[44:47],v[180:183]
ds_read_b64_tr_b16 a[134:135],v5 offset:6400
v_fma_f32 v85,v85,s36,v14
v_mfma_f32_16x16x32_bf16 v[228:231],a[140:143],v[48:51],v[228:231]
v_exp_f32 v82,v82
v_mfma_f32_16x16x32_bf16 v[224:227],a[136:139],v[48:51],v[224:227]
v_exp_f32 v83,v83
v_mfma_f32_16x16x32_bf16 v[128:131],a[136:139],v[52:55],v[128:131]
v_cvt_pk_bf16_f32 v25,v82,v83
v_fma_f32 v86,v86,s36,v14
v_mfma_f32_16x16x32_bf16 v[132:135],a[140:143],v[52:55],v[132:135]
buffer_load_dwordx4 v8,s[12:15],s28 offen offset:2048 nt lds
v_mfma_f32_16x16x32_bf16 a[180:183],a[140:143],v[56:59],a[180:183]
s_add_u32 s28,s28,3072
v_exp_f32 v88,v88
v_mfma_f32_16x16x32_bf16 a[176:179],a[136:139],v[56:59],a[176:179]
s_add_u32 s29,s29,3072
v_exp_f32 v89,v89
v_mfma_f32_16x16x32_bf16 a[184:187],a[144:147],v[56:59],a[184:187]
s_add_u32 m0,s23,0
v_exp_f32 v90,v90
v_mfma_f32_16x16x32_bf16 a[188:191],a[148:151],v[56:59],a[188:191]
v_exp_f32 v91,v91
v_mfma_f32_16x16x32_bf16 v[140:143],a[148:151],v[52:55],v[140:143]
v_cvt_pk_bf16_f32 v28,v88,v89
v_cvt_pk_bf16_f32 v29,v90,v91
v_mfma_f32_16x16x32_bf16 v[136:139],a[144:147],v[52:55],v[136:139]
v_exp_f32 v96,v96
v_mfma_f32_16x16x32_bf16 v[232:235],a[144:147],v[48:51],v[232:235]
v_exp_f32 v97,v97
v_mfma_f32_16x16x32_bf16 v[236:239],a[148:151],v[48:51],v[236:239]
v_exp_f32 v98,v98
v_mfma_f32_16x16x32_bf16 v[188:191],a[148:151],v[44:47],v[188:191]
v_exp_f32 v99,v99
v_mfma_f32_16x16x32_bf16 v[184:187],a[144:147],v[44:47],v[184:187]
s_waitcnt lgkmcnt(0)
v_cvt_pk_bf16_f32 v32,v96,v97
v_cvt_pk_bf16_f32 v33,v98,v99
v_mfma_f32_16x16x32_bf16 v[192:195],a[120:123],v[44:47],v[192:195]
s_waitcnt vmcnt(12)
v_exp_f32 v76,v76
v_mfma_f32_16x16x32_bf16 v[196:199],a[124:127],v[44:47],v[196:199]
s_barrier
v_mfma_f32_16x16x32_bf16 v[244:247],a[124:127],v[48:51],v[244:247]
ds_read_b128 a[148:151],v1 offset:24704
v_fma_f32 v87,v87,s36,v14
v_mfma_f32_16x16x32_bf16 v[240:243],a[120:123],v[48:51],v[240:243]
ds_read_b128 a[144:147],v0 offset:24704
v_fma_f32 v92,v92,s36,v15
v_mfma_f32_16x16x32_bf16 v[144:147],a[120:123],v[52:55],v[144:147]
ds_read_b128 a[140:143],v1 offset:24576
v_fma_f32 v93,v93,s36,v15
v_mfma_f32_16x16x32_bf16 v[148:151],a[124:127],v[52:55],v[148:151]
ds_read_b128 a[136:139],v0 offset:24576
v_fma_f32 v94,v94,s36,v15
v_mfma_f32_16x16x32_bf16 a[196:199],a[124:127],v[56:59],a[196:199]
ds_read_b128 a[124:127],v1 offset:24832
v_fma_f32 v95,v95,s36,v15
v_mfma_f32_16x16x32_bf16 a[192:195],a[120:123],v[56:59],a[192:195]
buffer_load_dwordx4 v6,s[8:11],s21 offen offset:0 lds
v_mfma_f32_16x16x32_bf16 a[200:203],a[128:131],v[56:59],a[200:203]
ds_read_b128 a[120:123],v0 offset:24832
v_fma_f32 v100,v100,s36,v16
v_mfma_f32_16x16x32_bf16 a[204:207],a[132:135],v[56:59],a[204:207]
v_exp_f32 v77,v77
v_mfma_f32_16x16x32_bf16 v[156:159],a[132:135],v[52:55],v[156:159]
v_exp_f32 v78,v78
v_mfma_f32_16x16x32_bf16 v[152:155],a[128:131],v[52:55],v[152:155]
v_exp_f32 v79,v79
v_mfma_f32_16x16x32_bf16 v[248:251],a[128:131],v[48:51],v[248:251]
v_cvt_pk_bf16_f32 v22,v76,v77
v_cvt_pk_bf16_f32 v23,v78,v79
v_mfma_f32_16x16x32_bf16 v[252:255],a[132:135],v[48:51],v[252:255]
v_exp_f32 v84,v84
v_mfma_f32_16x16x32_bf16 v[204:207],a[132:135],v[44:47],v[204:207]
ds_read_b128 a[132:135],v1 offset:30720
v_fma_f32 v101,v101,s36,v16
v_mfma_f32_16x16x32_bf16 v[200:203],a[128:131],v[44:47],v[200:203]
s_waitcnt lgkmcnt(1)
ds_read_b128 a[128:131],v0 offset:30720
v_fma_f32 v102,v102,s36,v16
v_mfma_f32_16x16x32_bf16 v[72:75],a[124:127],a[20:23],0
buffer_load_dwordx4 v7,s[8:11],s21 offen offset:1024 lds
v_mfma_f32_16x16x32_bf16 v[72:75],a[120:123],a[16:19],v[72:75]
v_exp_f32 v85,v85
v_mfma_f32_16x16x32_bf16 v[72:75],a[148:151],a[12:15],v[72:75]
v_exp_f32 v86,v86
v_mfma_f32_16x16x32_bf16 v[72:75],a[144:147],a[8:11],v[72:75]
v_exp_f32 v87,v87
v_mfma_f32_16x16x32_bf16 v[72:75],a[140:143],a[4:7],v[72:75]
v_cvt_pk_bf16_f32 v26,v84,v85
v_cvt_pk_bf16_f32 v27,v86,v87
v_mfma_f32_16x16x32_bf16 v[72:75],a[136:139],a[0:3],v[72:75]
v_exp_f32 v92,v92
v_smfmac_f32_16x16x64_bf16 v[60:63],a[152:155],v[20:27],v18
v_fma_f32 v103,v103,s36,v16
v_mfma_f32_16x16x32_bf16 v[80:83],a[136:139],a[24:27],0
v_exp_f32 v93,v93
v_mfma_f32_16x16x32_bf16 v[80:83],a[140:143],a[28:31],v[80:83]
buffer_load_dwordx4 v8,s[8:11],s21 offen offset:2048 lds
v_mfma_f32_16x16x32_bf16 v[80:83],a[144:147],a[32:35],v[80:83]
s_add_u32 s21,s21,12288
v_exp_f32 v94,v94
v_mfma_f32_16x16x32_bf16 v[80:83],a[148:151],a[36:39],v[80:83]
s_add_u32 m0,s22,12288
v_exp_f32 v95,v95
v_mfma_f32_16x16x32_bf16 v[80:83],a[120:123],a[40:43],v[80:83]
v_cvt_pk_bf16_f32 v30,v92,v93
v_cvt_pk_bf16_f32 v31,v94,v95
v_mfma_f32_16x16x32_bf16 v[80:83],a[124:127],a[44:47],v[80:83]
v_exp_f32 v100,v100
v_mfma_f32_16x16x32_bf16 v[88:91],a[124:127],a[68:71],0
v_exp_f32 v101,v101
v_mfma_f32_16x16x32_bf16 v[88:91],a[120:123],a[64:67],v[88:91]
v_exp_f32 v102,v102
v_mfma_f32_16x16x32_bf16 v[88:91],a[148:151],a[60:63],v[88:91]
v_exp_f32 v103,v103
v_mfma_f32_16x16x32_bf16 v[88:91],a[144:147],a[56:59],v[88:91]
v_cvt_pk_bf16_f32 v34,v100,v101
v_cvt_pk_bf16_f32 v35,v102,v103
v_mfma_f32_16x16x32_bf16 v[88:91],a[140:143],a[52:55],v[88:91]
buffer_load_dwordx4 v6,s[4:7],s20 offen offset:0 lds
v_smfmac_f32_16x16x64_bf16 v[64:67],a[152:155],v[28:35],v18
v_fma_f32 v72,v72,s36,v13
v_mfma_f32_16x16x32_bf16 v[88:91],a[136:139],a[48:51],v[88:91]
v_fma_f32 v73,v73,s36,v13
v_fma_f32 v74,v74,s36,v13
v_mfma_f32_16x16x32_bf16 v[96:99],a[136:139],a[72:75],0
ds_read_b128 a[136:139],v0 offset:30848
v_fma_f32 v75,v75,s36,v13
v_mfma_f32_16x16x32_bf16 v[96:99],a[140:143],a[76:79],v[96:99]
ds_read_b128 a[140:143],v1 offset:30848
v_fma_f32 v80,v80,s36,v14
v_mfma_f32_16x16x32_bf16 v[96:99],a[144:147],a[80:83],v[96:99]
ds_read_b128 a[144:147],v0 offset:30976
v_fma_f32 v81,v81,s36,v14
v_mfma_f32_16x16x32_bf16 v[96:99],a[148:151],a[84:87],v[96:99]
ds_read_b128 a[148:151],v1 offset:30976
v_mfma_f32_16x16x32_bf16 v[96:99],a[120:123],a[88:91],v[96:99]
v_exp_f32 v72,v72
v_mfma_f32_16x16x32_bf16 v[96:99],a[124:127],a[92:95],v[96:99]
s_waitcnt lgkmcnt(4)
v_exp_f32 v73,v73
v_mfma_f32_16x16x32_bf16 v[76:79],a[128:131],a[0:3],0
buffer_load_dwordx4 v7,s[4:7],s20 offen offset:1024 lds
v_mfma_f32_16x16x32_bf16 v[76:79],a[132:135],a[4:7],v[76:79]
s_waitcnt lgkmcnt(3)
v_exp_f32 v74,v74
v_mfma_f32_16x16x32_bf16 v[76:79],a[136:139],a[8:11],v[76:79]
s_waitcnt lgkmcnt(2)
v_exp_f32 v75,v75
v_mfma_f32_16x16x32_bf16 v[76:79],a[140:143],a[12:15],v[76:79]
s_waitcnt lgkmcnt(0)
v_exp_f32 v80,v80
v_mfma_f32_16x16x32_bf16 v[76:79],a[144:147],a[16:19],v[76:79]
v_exp_f32 v81,v81
v_mfma_f32_16x16x32_bf16 v[76:79],a[148:151],a[20:23],v[76:79]
v_cvt_pk_bf16_f32 v44,v72,v73
v_cvt_pk_bf16_f32 v45,v74,v75
v_mfma_f32_16x16x32_bf16 v[84:87],a[148:151],a[44:47],0
v_cvt_pk_bf16_f32 v48,v80,v81
v_mfma_f32_16x16x32_bf16 v[84:87],a[144:147],a[40:43],v[84:87]
v_mfma_f32_16x16x32_bf16 v[84:87],a[140:143],a[36:39],v[84:87]
v_mfma_f32_16x16x32_bf16 v[84:87],a[136:139],a[32:35],v[84:87]
buffer_load_dwordx4 v8,s[4:7],s20 offen offset:2048 lds
v_mfma_f32_16x16x32_bf16 v[84:87],a[132:135],a[28:31],v[84:87]
s_add_u32 s20,s20,12288
v_mfma_f32_16x16x32_bf16 v[84:87],a[128:131],a[24:27],v[84:87]
ds_read_b64_tr_b16 a[120:121],v2 offset:12288
v_mfma_f32_16x16x32_bf16 v[92:95],a[128:131],a[48:51],0
ds_read_b64_tr_b16 a[122:123],v2 offset:18432
v_mfma_f32_16x16x32_bf16 v[92:95],a[132:135],a[52:55],v[92:95]
ds_read_b64_tr_b16 a[124:125],v3 offset:12288
v_mfma_f32_16x16x32_bf16 v[92:95],a[136:139],a[56:59],v[92:95]
ds_read_b64_tr_b16 a[126:127],v3 offset:18432
v_mfma_f32_16x16x32_bf16 v[92:95],a[140:143],a[60:63],v[92:95]
v_mfma_f32_16x16x32_bf16 v[92:95],a[144:147],a[64:67],v[92:95]
v_mfma_f32_16x16x32_bf16 v[92:95],a[148:151],a[68:71],v[92:95]
v_mfma_f32_16x16x32_bf16 v[100:103],a[148:151],a[92:95],0
v_mfma_f32_16x16x32_bf16 v[100:103],a[144:147],a[88:91],v[100:103]
v_mfma_f32_16x16x32_bf16 v[100:103],a[140:143],a[84:87],v[100:103]
v_mfma_f32_16x16x32_bf16 v[100:103],a[136:139],a[80:83],v[100:103]
v_mfma_f32_16x16x32_bf16 v[100:103],a[132:135],a[76:79],v[100:103]
ds_read_b64_tr_b16 a[132:133],v5 offset:12288
v_mfma_f32_16x16x32_bf16 v[100:103],a[128:131],a[72:75],v[100:103]
s_waitcnt lgkmcnt(1)
ds_read_b64_tr_b16 a[128:129],v4 offset:12288
ds_read_b64_tr_b16 a[130:131],v4 offset:18432
ds_read_b64_tr_b16 a[134:135],v5 offset:18432
v_mfma_f32_16x16x32_bf16 v[160:163],a[120:123],v[20:23],v[160:163]
s_add_u32 m0,s23,12288
ds_read_b64_tr_b16 a[138:139],v2 offset:18560
v_mbcnt_lo_u32_b32 v19,-1,0
v_mfma_f32_16x16x32_bf16 v[164:167],a[124:127],v[20:23],v[164:167]
ds_read_b64_tr_b16 a[136:137],v2 offset:12416
v_mbcnt_hi_u32_b32 v19,-1,v19
v_mfma_f32_16x16x32_bf16 v[212:215],a[124:127],v[24:27],v[212:215]
ds_read_b64_tr_b16 a[140:141],v3 offset:12416
v_min_u32 v19,7,v19
v_mfma_f32_16x16x32_bf16 v[208:211],a[120:123],v[24:27],v[208:211]
ds_read_b64_tr_b16 a[142:143],v3 offset:18560
v_lshl_add_u32 v19,v19,7,s48
v_mfma_f32_16x16x32_bf16 v[112:115],a[120:123],v[28:31],v[112:115]
ds_read_b64_tr_b16 a[146:147],v4 offset:18560
v_min_u32 v19,L_codeend-L_first-4,v19
v_mfma_f32_16x16x32_bf16 v[116:119],a[124:127],v[28:31],v[116:119]
ds_read_b64_tr_b16 a[148:149],v5 offset:12416
v_fma_f32 v83,v83,s36,v14
v_mfma_f32_16x16x32_bf16 a[164:167],a[124:127],v[32:35],a[164:167]
ds_read_b64_tr_b16 a[144:145],v4 offset:12416
v_fma_f32 v82,v82,s36,v14
v_mfma_f32_16x16x32_bf16 a[160:163],a[120:123],v[32:35],a[160:163]
s_waitcnt lgkmcnt(6)
ds_read_b64_tr_b16 a[150:151],v5 offset:18560
v_fma_f32 v91,v91,s36,v15
v_mfma_f32_16x16x32_bf16 a[168:171],a[128:131],v[32:35],a[168:171]
ds_read_b64_tr_b16 a[120:121],v2 offset:12544
v_fma_f32 v89,v89,s36,v15
v_mfma_f32_16x16x32_bf16 a[172:175],a[132:135],v[32:35],a[172:175]
ds_read_b64_tr_b16 a[122:123],v2 offset:18688
v_fma_f32 v88,v88,s36,v15
v_mfma_f32_16x16x32_bf16 v[124:127],a[132:135],v[28:31],v[124:127]
ds_read_b64_tr_b16 a[124:125],v3 offset:12544
v_fma_f32 v90,v90,s36,v15
v_mfma_f32_16x16x32_bf16 v[120:123],a[128:131],v[28:31],v[120:123]
ds_read_b64_tr_b16 a[126:127],v3 offset:18688
v_fma_f32 v96,v96,s36,v16
v_mfma_f32_16x16x32_bf16 v[216:219],a[128:131],v[24:27],v[216:219]
v_exp_f32 v82,v82
v_mfma_f32_16x16x32_bf16 v[220:223],a[132:135],v[24:27],v[220:223]
v_exp_f32 v83,v83
v_mfma_f32_16x16x32_bf16 v[172:175],a[132:135],v[20:23],v[172:175]
ds_read_b64_tr_b16 a[132:133],v5 offset:12544
v_cvt_pk_bf16_f32 v49,v82,v83
v_mfma_f32_16x16x32_bf16 v[168:171],a[128:131],v[20:23],v[168:171]
global_load_dword v19,v19,s[46:47]
s_waitcnt lgkmcnt(4)
v_mfma_f32_16x16x32_bf16 v[176:179],a[136:139],v[20:23],v[176:179]
ds_read_b64_tr_b16 a[128:129],v4 offset:12544
v_fma_f32 v99,v99,s36,v16
v_mfma_f32_16x16x32_bf16 v[180:183],a[140:143],v[20:23],v[180:183]
ds_read_b64_tr_b16 a[130:131],v4 offset:18688
v_fma_f32 v98,v98,s36,v16
v_mfma_f32_16x16x32_bf16 v[228:231],a[140:143],v[24:27],v[228:231]
ds_read_b64_tr_b16 a[134:135],v5 offset:18688
v_fma_f32 v97,v97,s36,v16
v_mfma_f32_16x16x32_bf16 v[224:227],a[136:139],v[24:27],v[224:227]
v_exp_f32 v90,v90
v_mfma_f32_16x16x32_bf16 v[128:131],a[136:139],v[28:31],v[128:131]
v_exp_f32 v89,v89
v_mfma_f32_16x16x32_bf16 v[132:135],a[140:143],v[28:31],v[132:135]
v_exp_f32 v91,v91
v_mfma_f32_16x16x32_bf16 a[180:183],a[140:143],v[32:35],a[180:183]
v_exp_f32 v88,v88
v_mfma_f32_16x16x32_bf16 a[176:179],a[136:139],v[32:35],a[176:179]
v_cvt_pk_bf16_f32 v52,v88,v89
v_cvt_pk_bf16_f32 v53,v90,v91
v_mfma_f32_16x16x32_bf16 a[184:187],a[144:147],v[32:35],a[184:187]
v_exp_f32 v99,v99
v_mfma_f32_16x16x32_bf16 a[188:191],a[148:151],v[32:35],a[188:191]
v_exp_f32 v97,v97
v_mfma_f32_16x16x32_bf16 v[140:143],a[148:151],v[28:31],v[140:143]
v_exp_f32 v98,v98
v_mfma_f32_16x16x32_bf16 v[136:139],a[144:147],v[28:31],v[136:139]
v_exp_f32 v96,v96
v_mfma_f32_16x16x32_bf16 v[232:235],a[144:147],v[24:27],v[232:235]
v_cvt_pk_bf16_f32 v56,v96,v97
v_cvt_pk_bf16_f32 v57,v98,v99
v_mfma_f32_16x16x32_bf16 v[236:239],a[148:151],v[24:27],v[236:239]
v_fma_f32 v79,v79,s36,v13
v_fma_f32 v77,v77,s36,v13
v_mfma_f32_16x16x32_bf16 v[188:191],a[148:151],v[20:23],v[188:191]
v_exp_f32 v77,v77
v_mfma_f32_16x16x32_bf16 v[184:187],a[144:147],v[20:23],v[184:187]
s_waitcnt lgkmcnt(0)
v_exp_f32 v79,v79
v_mfma_f32_16x16x32_bf16 v[192:195],a[120:123],v[20:23],v[192:195]
s_waitcnt vmcnt(10)
v_mfma_f32_16x16x32_bf16 v[196:199],a[124:127],v[20:23],v[196:199]
s_barrier
v_mfma_f32_16x16x32_bf16 v[244:247],a[124:127],v[24:27],v[244:247]
ds_read_b128 a[148:151],v1 offset:128
v_fma_f32 v76,v76,s36,v13
v_mfma_f32_16x16x32_bf16 v[240:243],a[120:123],v[24:27],v[240:243]
ds_read_b128 a[144:147],v0 offset:128
v_fma_f32 v78,v78,s36,v13
v_mfma_f32_16x16x32_bf16 v[144:147],a[120:123],v[28:31],v[144:147]
ds_read_b128 a[140:143],v1 offset:0
v_fma_f32 v86,v86,s36,v14
v_mfma_f32_16x16x32_bf16 v[148:151],a[124:127],v[28:31],v[148:151]
ds_read_b128 a[136:139],v0 offset:0
v_fma_f32 v87,v87,s36,v14
v_mfma_f32_16x16x32_bf16 a[196:199],a[124:127],v[32:35],a[196:199]
ds_read_b128 a[124:127],v1 offset:256
v_fma_f32 v85,v85,s36,v14
v_mfma_f32_16x16x32_bf16 a[192:195],a[120:123],v[32:35],a[192:195]
buffer_load_dwordx4 v6,s[8:11],s21 offen offset:0 lds
v_mfma_f32_16x16x32_bf16 a[200:203],a[128:131],v[32:35],a[200:203]
ds_read_b128 a[120:123],v0 offset:256
v_fma_f32 v84,v84,s36,v14
v_mfma_f32_16x16x32_bf16 a[204:207],a[132:135],v[32:35],a[204:207]
ds_read_b128 a[156:159],v10 offset:3072
v_fma_f32 v95,v95,s36,v15
v_mfma_f32_16x16x32_bf16 v[156:159],a[132:135],v[28:31],v[156:159]
v_exp_f32 v76,v76
v_mfma_f32_16x16x32_bf16 v[152:155],a[128:131],v[28:31],v[152:155]
v_exp_f32 v78,v78
v_mfma_f32_16x16x32_bf16 v[248:251],a[128:131],v[24:27],v[248:251]
v_cvt_pk_bf16_f32 v47,v78,v79
v_cvt_pk_bf16_f32 v46,v76,v77
v_mfma_f32_16x16x32_bf16 v[252:255],a[132:135],v[24:27],v[252:255]
v_exp_f32 v86,v86
v_mfma_f32_16x16x32_bf16 v[204:207],a[132:135],v[20:23],v[204:207]
ds_read_b128 a[132:135],v1 offset:6144
v_fma_f32 v92,v92,s36,v15
v_mfma_f32_16x16x32_bf16 v[200:203],a[128:131],v[20:23],v[200:203]
s_waitcnt lgkmcnt(2)
ds_read_b128 a[128:131],v0 offset:6144
v_fma_f32 v94,v94,s36,v15
v_mfma_f32_16x16x32_bf16 v[72:75],a[124:127],a[20:23],0
v_exp_f32 v84,v84
v_mfma_f32_16x16x32_bf16 v[72:75],a[120:123],a[16:19],v[72:75]
s_waitcnt lgkmcnt(2)
buffer_store_dwordx4 a[156:159],v9,s[16:19],s27 offen offset:0 nt
buffer_load_dwordx4 v7,s[8:11],s21 offen offset:1024 lds
v_mfma_f32_16x16x32_bf16 v[72:75],a[148:151],a[12:15],v[72:75]
ds_read_b128 a[156:159],v10 offset:4096
v_fma_f32 v93,v93,s36,v15
v_mfma_f32_16x16x32_bf16 v[72:75],a[144:147],a[8:11],v[72:75]
v_exp_f32 v87,v87
v_mfma_f32_16x16x32_bf16 v[72:75],a[140:143],a[4:7],v[72:75]
v_exp_f32 v85,v85
v_mfma_f32_16x16x32_bf16 v[72:75],a[136:139],a[0:3],v[72:75]
v_cvt_pk_bf16_f32 v51,v86,v87
v_cvt_pk_bf16_f32 v50,v84,v85
v_mfma_f32_16x16x32_bf16 v[80:83],a[136:139],a[24:27],0
v_exp_f32 v92,v92
v_smfmac_f32_16x16x64_bf16 v[60:63],a[152:155],v[44:51],v18
v_fma_f32 v103,v103,s36,v16
v_mfma_f32_16x16x32_bf16 v[80:83],a[140:143],a[28:31],v[80:83]
buffer_load_dwordx4 v8,s[8:11],s21 offen offset:2048 lds
v_mfma_f32_16x16x32_bf16 v[80:83],a[144:147],a[32:35],v[80:83]
s_add_u32 s21,s21,12288
v_exp_f32 v93,v93
v_mfma_f32_16x16x32_bf16 v[80:83],a[148:151],a[36:39],v[80:83]
s_add_u32 m0,s22,24576
v_exp_f32 v94,v94
v_mfma_f32_16x16x32_bf16 v[80:83],a[120:123],a[40:43],v[80:83]
v_exp_f32 v95,v95
v_mfma_f32_16x16x32_bf16 v[80:83],a[124:127],a[44:47],v[80:83]
v_cvt_pk_bf16_f32 v55,v94,v95
v_cvt_pk_bf16_f32 v54,v92,v93
v_mfma_f32_16x16x32_bf16 v[88:91],a[124:127],a[68:71],0
v_exp_f32 v103,v103
v_mfma_f32_16x16x32_bf16 v[88:91],a[120:123],a[64:67],v[88:91]
v_fma_f32 v101,v101,s36,v16
v_fma_f32 v100,v100,s36,v16
v_mfma_f32_16x16x32_bf16 v[88:91],a[148:151],a[60:63],v[88:91]
v_exp_f32 v100,v100
v_mfma_f32_16x16x32_bf16 v[88:91],a[144:147],a[56:59],v[88:91]
v_exp_f32 v101,v101
v_mfma_f32_16x16x32_bf16 v[88:91],a[140:143],a[52:55],v[88:91]
s_waitcnt lgkmcnt(0)
buffer_store_dwordx4 a[156:159],v9,s[16:19],s27 offen offset:128 nt
buffer_load_dwordx4 v6,s[4:7],s20 offen offset:0 lds
v_mfma_f32_16x16x32_bf16 v[88:91],a[136:139],a[48:51],v[88:91]
ds_read_b128 a[156:159],v10 offset:5120
v_mfma_f32_16x16x32_bf16 v[96:99],a[136:139],a[72:75],0
ds_read_b128 a[136:139],v0 offset:6272
v_mfma_f32_16x16x32_bf16 v[96:99],a[140:143],a[76:79],v[96:99]
ds_read_b128 a[140:143],v1 offset:6272
v_mfma_f32_16x16x32_bf16 v[96:99],a[144:147],a[80:83],v[96:99]
ds_read_b128 a[144:147],v0 offset:6400
v_mfma_f32_16x16x32_bf16 v[96:99],a[148:151],a[84:87],v[96:99]
ds_read_b128 a[148:151],v1 offset:6400
v_mfma_f32_16x16x32_bf16 v[96:99],a[120:123],a[88:91],v[96:99]
v_fma_f32 v102,v102,s36,v16
v_cvt_pk_bf16_f32 v58,v100,v101
v_mfma_f32_16x16x32_bf16 v[96:99],a[124:127],a[92:95],v[96:99]
v_exp_f32 v102,v102
v_mfma_f32_16x16x32_bf16 v[76:79],a[128:131],a[0:3],0
buffer_load_dwordx4 v7,s[4:7],s20 offen offset:1024 lds
v_mfma_f32_16x16x32_bf16 v[76:79],a[132:135],a[4:7],v[76:79]
s_waitcnt lgkmcnt(3)
v_cvt_pk_bf16_f32 v59,v102,v103
v_fma_f32 v80,v80,s36,v14
v_mfma_f32_16x16x32_bf16 v[76:79],a[136:139],a[8:11],v[76:79]
v_exp_f32 v80,v80
v_smfmac_f32_16x16x64_bf16 v[64:67],a[152:155],v[52:59],v18
s_waitcnt lgkmcnt(1)
v_fma_f32 v81,v81,s36,v14
v_mfma_f32_16x16x32_bf16 v[76:79],a[140:143],a[12:15],v[76:79]
v_exp_f32 v81,v81
v_mfma_f32_16x16x32_bf16 v[76:79],a[144:147],a[16:19],v[76:79]
s_waitcnt lgkmcnt(0)
v_fma_f32 v75,v75,s36,v13
v_fma_f32 v72,v72,s36,v13
v_mfma_f32_16x16x32_bf16 v[76:79],a[148:151],a[20:23],v[76:79]
v_exp_f32 v72,v72
v_mfma_f32_16x16x32_bf16 v[84:87],a[148:151],a[44:47],0
v_exp_f32 v75,v75
v_mfma_f32_16x16x32_bf16 v[84:87],a[144:147],a[40:43],v[84:87]
v_fma_f32 v74,v74,s36,v13
v_fma_f32 v73,v73,s36,v13
v_mfma_f32_16x16x32_bf16 v[84:87],a[140:143],a[36:39],v[84:87]
buffer_store_dwordx4 a[156:159],v9,s[16:19],s27 offen offset:256 nt
buffer_load_dwordx4 v8,s[4:7],s20 offen offset:2048 lds
v_mfma_f32_16x16x32_bf16 v[84:87],a[136:139],a[32:35],v[84:87]
s_add_u32 s20,s20,12288
ds_read_b64_tr_b16 a[120:121],v2 offset:24576
v_mfma_f32_16x16x32_bf16 v[84:87],a[132:135],a[28:31],v[84:87]
s_add_u32 s27,s27,3072
ds_read_b64_tr_b16 a[122:123],v2 offset:30720
v_cvt_pk_bf16_f32 v24,v80,v81
v_mfma_f32_16x16x32_bf16 v[84:87],a[128:131],a[24:27],v[84:87]
ds_read_b64_tr_b16 a[124:125],v3 offset:24576
v_mfma_f32_16x16x32_bf16 v[92:95],a[128:131],a[48:51],0
ds_read_b64_tr_b16 a[126:127],v3 offset:30720
v_mfma_f32_16x16x32_bf16 v[92:95],a[132:135],a[52:55],v[92:95]
v_exp_f32 v74,v74
v_mfma_f32_16x16x32_bf16 v[92:95],a[136:139],a[56:59],v[92:95]
v_exp_f32 v73,v73
v_mfma_f32_16x16x32_bf16 v[92:95],a[140:143],a[60:63],v[92:95]
v_cvt_pk_bf16_f32 v21,v74,v75
v_cvt_pk_bf16_f32 v20,v72,v73
v_mfma_f32_16x16x32_bf16 v[92:95],a[144:147],a[64:67],v[92:95]
v_mfma_f32_16x16x32_bf16 v[92:95],a[148:151],a[68:71],v[92:95]
v_mfma_f32_16x16x32_bf16 v[100:103],a[148:151],a[92:95],0
v_mfma_f32_16x16x32_bf16 v[100:103],a[144:147],a[88:91],v[100:103]
v_mfma_f32_16x16x32_bf16 v[100:103],a[140:143],a[84:87],v[100:103]
v_mfma_f32_16x16x32_bf16 v[100:103],a[136:139],a[80:83],v[100:103]
v_mfma_f32_16x16x32_bf16 v[100:103],a[132:135],a[76:79],v[100:103]
ds_read_b64_tr_b16 a[134:135],v5 offset:30720
v_mfma_f32_16x16x32_bf16 v[100:103],a[128:131],a[72:75],v[100:103]
s_waitcnt lgkmcnt(1)
ds_read_b64_tr_b16 a[130:131],v4 offset:30720
ds_read_b64_tr_b16 a[128:129],v4 offset:24576
ds_read_b64_tr_b16 a[132:133],v5 offset:24576
v_mfma_f32_16x16x32_bf16 v[160:163],a[120:123],v[44:47],v[160:163]
s_add_u32 m0,s29,0
ds_read_b64_tr_b16 a[136:137],v2 offset:24704
v_fma_f32 v82,v82,s36,v14
v_mfma_f32_16x16x32_bf16 v[164:167],a[124:127],v[44:47],v[164:167]
ds_read_b64_tr_b16 a[138:139],v2 offset:30848
v_fma_f32 v83,v83,s36,v14
v_mfma_f32_16x16x32_bf16 v[212:215],a[124:127],v[48:51],v[212:215]
ds_read_b64_tr_b16 a[140:141],v3 offset:24704
v_fma_f32 v88,v88,s36,v15
v_mfma_f32_16x16x32_bf16 v[208:211],a[120:123],v[48:51],v[208:211]
ds_read_b64_tr_b16 a[142:143],v3 offset:30848
v_fma_f32 v89,v89,s36,v15
v_mfma_f32_16x16x32_bf16 v[112:115],a[120:123],v[52:55],v[112:115]
ds_read_b64_tr_b16 a[144:145],v4 offset:24704
v_fma_f32 v90,v90,s36,v15
v_mfma_f32_16x16x32_bf16 v[116:119],a[124:127],v[52:55],v[116:119]
ds_read_b64_tr_b16 a[146:147],v4 offset:30848
v_fma_f32 v91,v91,s36,v15
v_mfma_f32_16x16x32_bf16 a[164:167],a[124:127],v[56:59],a[164:167]
buffer_load_dwordx4 v6,s[12:15],s28 offen offset:0 nt lds
v_mfma_f32_16x16x32_bf16 a[160:163],a[120:123],v[56:59],a[160:163]
s_waitcnt lgkmcnt(5)
ds_read_b64_tr_b16 a[148:149],v5 offset:24704
v_fma_f32 v96,v96,s36,v16
v_mfma_f32_16x16x32_bf16 a[168:171],a[128:131],v[56:59],a[168:171]
ds_read_b64_tr_b16 a[150:151],v5 offset:30848
v_fma_f32 v97,v97,s36,v16
v_mfma_f32_16x16x32_bf16 a[172:175],a[132:135],v[56:59],a[172:175]
ds_read_b64_tr_b16 a[120:121],v2 offset:24832
v_fma_f32 v98,v98,s36,v16
v_mfma_f32_16x16x32_bf16 v[124:127],a[132:135],v[52:55],v[124:127]
ds_read_b64_tr_b16 a[122:123],v2 offset:30976
v_fma_f32 v99,v99,s36,v16
v_mfma_f32_16x16x32_bf16 v[120:123],a[128:131],v[52:55],v[120:123]
ds_read_b64_tr_b16 a[124:125],v3 offset:24832
v_fma_f32 v76,v76,s36,v13
v_mfma_f32_16x16x32_bf16 v[216:219],a[128:131],v[48:51],v[216:219]
ds_read_b64_tr_b16 a[126:127],v3 offset:30976
v_fma_f32 v77,v77,s36,v13
v_mfma_f32_16x16x32_bf16 v[220:223],a[132:135],v[48:51],v[220:223]
buffer_load_dwordx4 v7,s[12:15],s28 offen offset:1024 nt lds
v_mfma_f32_16x16x32_bf16 v[172:175],a[132:135],v[44:47],v[172:175]
ds_read_b64_tr_b16 a[132:133],v5 offset:24832
v_fma_f32 v78,v78,s36,v13
v_mfma_f32_16x16x32_bf16 v[168:171],a[128:131],v[44:47],v[168:171]
s_waitcnt lgkmcnt(5)
ds_read_b64_tr_b16 a[128:129],v4 offset:24832
v_fma_f32 v79,v79,s36,v13
v_mfma_f32_16x16x32_bf16 v[176:179],a[136:139],v[44:47],v[176:179]
ds_read_b64_tr_b16 a[130:131],v4 offset:30976
v_fma_f32 v84,v84,s36,v14
v_mfma_f32_16x16x32_bf16 v[180:183],a[140:143],v[44:47],v[180:183]
ds_read_b64_tr_b16 a[134:135],v5 offset:30976
v_fma_f32 v85,v85,s36,v14
v_mfma_f32_16x16x32_bf16 v[228:231],a[140:143],v[48:51],v[228:231]
v_exp_f32 v82,v82
v_mfma_f32_16x16x32_bf16 v[224:227],a[136:139],v[48:51],v[224:227]
v_exp_f32 v83,v83
v_mfma_f32_16x16x32_bf16 v[128:131],a[136:139],v[52:55],v[128:131]
v_cvt_pk_bf16_f32 v25,v82,v83
v_fma_f32 v86,v86,s36,v14
v_mfma_f32_16x16x32_bf16 v[132:135],a[140:143],v[52:55],v[132:135]
buffer_load_dwordx4 v8,s[12:15],s28 offen offset:2048 nt lds
v_mfma_f32_16x16x32_bf16 a[180:183],a[140:143],v[56:59],a[180:183]
s_add_u32 s28,s28,3072
v_exp_f32 v88,v88
v_mfma_f32_16x16x32_bf16 a[176:179],a[136:139],v[56:59],a[176:179]
s_add_u32 s29,s29,3072
v_exp_f32 v89,v89
v_mfma_f32_16x16x32_bf16 a[184:187],a[144:147],v[56:59],a[184:187]
s_add_u32 m0,s23,24576
v_exp_f32 v90,v90
v_mfma_f32_16x16x32_bf16 a[188:191],a[148:151],v[56:59],a[188:191]
v_exp_f32 v91,v91
v_mfma_f32_16x16x32_bf16 v[140:143],a[148:151],v[52:55],v[140:143]
v_cvt_pk_bf16_f32 v28,v88,v89
v_cvt_pk_bf16_f32 v29,v90,v91
v_mfma_f32_16x16x32_bf16 v[136:139],a[144:147],v[52:55],v[136:139]
v_exp_f32 v96,v96
v_mfma_f32_16x16x32_bf16 v[232:235],a[144:147],v[48:51],v[232:235]
v_exp_f32 v97,v97
v_mfma_f32_16x16x32_bf16 v[236:239],a[148:151],v[48:51],v[236:239]
v_exp_f32 v98,v98
v_mfma_f32_16x16x32_bf16 v[188:191],a[148:151],v[44:47],v[188:191]
v_exp_f32 v99,v99
v_mfma_f32_16x16x32_bf16 v[184:187],a[144:147],v[44:47],v[184:187]
s_waitcnt lgkmcnt(0)
v_cvt_pk_bf16_f32 v32,v96,v97
v_cvt_pk_bf16_f32 v33,v98,v99
v_mfma_f32_16x16x32_bf16 v[192:195],a[120:123],v[44:47],v[192:195]
s_waitcnt vmcnt(13)
v_exp_f32 v76,v76
v_mfma_f32_16x16x32_bf16 v[196:199],a[124:127],v[44:47],v[196:199]
s_barrier
v_mfma_f32_16x16x32_bf16 v[244:247],a[124:127],v[48:51],v[244:247]
ds_read_b128 a[148:151],v1 offset:12416
v_fma_f32 v87,v87,s36,v14
v_mfma_f32_16x16x32_bf16 v[240:243],a[120:123],v[48:51],v[240:243]
ds_read_b128 a[144:147],v0 offset:12416
v_fma_f32 v92,v92,s36,v15
v_mfma_f32_16x16x32_bf16 v[144:147],a[120:123],v[52:55],v[144:147]
ds_read_b128 a[140:143],v1 offset:12288
v_fma_f32 v93,v93,s36,v15
v_mfma_f32_16x16x32_bf16 v[148:151],a[124:127],v[52:55],v[148:151]
ds_read_b128 a[136:139],v0 offset:12288
v_fma_f32 v94,v94,s36,v15
v_mfma_f32_16x16x32_bf16 a[196:199],a[124:127],v[56:59],a[196:199]
ds_read_b128 a[124:127],v1 offset:12544
v_fma_f32 v95,v95,s36,v15
v_mfma_f32_16x16x32_bf16 a[192:195],a[120:123],v[56:59],a[192:195]
buffer_load_dwordx4 v6,s[8:11],s21 offen offset:0 lds
v_mfma_f32_16x16x32_bf16 a[200:203],a[128:131],v[56:59],a[200:203]
ds_read_b128 a[120:123],v0 offset:12544
v_fma_f32 v100,v100,s36,v16
v_mfma_f32_16x16x32_bf16 a[204:207],a[132:135],v[56:59],a[204:207]
v_exp_f32 v77,v77
v_mfma_f32_16x16x32_bf16 v[156:159],a[132:135],v[52:55],v[156:159]
v_exp_f32 v78,v78
v_mfma_f32_16x16x32_bf16 v[152:155],a[128:131],v[52:55],v[152:155]
v_exp_f32 v79,v79
v_mfma_f32_16x16x32_bf16 v[248:251],a[128:131],v[48:51],v[248:251]
v_cvt_pk_bf16_f32 v22,v76,v77
v_cvt_pk_bf16_f32 v23,v78,v79
v_mfma_f32_16x16x32_bf16 v[252:255],a[132:135],v[48:51],v[252:255]
v_exp_f32 v84,v84
v_mfma_f32_16x16x32_bf16 v[204:207],a[132:135],v[44:47],v[204:207]
ds_read_b128 a[132:135],v1 offset:18432
v_fma_f32 v101,v101,s36,v16
v_mfma_f32_16x16x32_bf16 v[200:203],a[128:131],v[44:47],v[200:203]
s_waitcnt lgkmcnt(1)
ds_read_b128 a[128:131],v0 offset:18432
v_fma_f32 v102,v102,s36,v16
v_mfma_f32_16x16x32_bf16 v[72:75],a[124:127],a[20:23],0
buffer_load_dwordx4 v7,s[8:11],s21 offen offset:1024 lds
v_mfma_f32_16x16x32_bf16 v[72:75],a[120:123],a[16:19],v[72:75]
v_exp_f32 v85,v85
v_mfma_f32_16x16x32_bf16 v[72:75],a[148:151],a[12:15],v[72:75]
v_exp_f32 v86,v86
v_mfma_f32_16x16x32_bf16 v[72:75],a[144:147],a[8:11],v[72:75]
v_exp_f32 v87,v87
v_mfma_f32_16x16x32_bf16 v[72:75],a[140:143],a[4:7],v[72:75]
v_cvt_pk_bf16_f32 v26,v84,v85
v_cvt_pk_bf16_f32 v27,v86,v87
v_mfma_f32_16x16x32_bf16 v[72:75],a[136:139],a[0:3],v[72:75]
v_exp_f32 v92,v92
v_smfmac_f32_16x16x64_bf16 v[60:63],a[152:155],v[20:27],v18
v_fma_f32 v103,v103,s36,v16
v_mfma_f32_16x16x32_bf16 v[80:83],a[136:139],a[24:27],0
v_exp_f32 v93,v93
v_mfma_f32_16x16x32_bf16 v[80:83],a[140:143],a[28:31],v[80:83]
buffer_load_dwordx4 v8,s[8:11],s21 offen offset:2048 lds
v_mfma_f32_16x16x32_bf16 v[80:83],a[144:147],a[32:35],v[80:83]
s_add_u32 s21,s21,12288
v_exp_f32 v94,v94
v_mfma_f32_16x16x32_bf16 v[80:83],a[148:151],a[36:39],v[80:83]
s_add_u32 m0,s22,0
v_exp_f32 v95,v95
v_mfma_f32_16x16x32_bf16 v[80:83],a[120:123],a[40:43],v[80:83]
v_cvt_pk_bf16_f32 v30,v92,v93
v_cvt_pk_bf16_f32 v31,v94,v95
v_mfma_f32_16x16x32_bf16 v[80:83],a[124:127],a[44:47],v[80:83]
v_exp_f32 v100,v100
v_mfma_f32_16x16x32_bf16 v[88:91],a[124:127],a[68:71],0
v_exp_f32 v101,v101
v_mfma_f32_16x16x32_bf16 v[88:91],a[120:123],a[64:67],v[88:91]
v_exp_f32 v102,v102
v_mfma_f32_16x16x32_bf16 v[88:91],a[148:151],a[60:63],v[88:91]
v_exp_f32 v103,v103
v_mfma_f32_16x16x32_bf16 v[88:91],a[144:147],a[56:59],v[88:91]
v_cvt_pk_bf16_f32 v34,v100,v101
v_cvt_pk_bf16_f32 v35,v102,v103
v_mfma_f32_16x16x32_bf16 v[88:91],a[140:143],a[52:55],v[88:91]
buffer_load_dwordx4 v6,s[4:7],s20 offen offset:0 lds
v_smfmac_f32_16x16x64_bf16 v[64:67],a[152:155],v[28:35],v18
v_fma_f32 v72,v72,s36,v13
v_mfma_f32_16x16x32_bf16 v[88:91],a[136:139],a[48:51],v[88:91]
v_fma_f32 v73,v73,s36,v13
v_fma_f32 v74,v74,s36,v13
v_mfma_f32_16x16x32_bf16 v[96:99],a[136:139],a[72:75],0
ds_read_b128 a[136:139],v0 offset:18560
v_fma_f32 v75,v75,s36,v13
v_mfma_f32_16x16x32_bf16 v[96:99],a[140:143],a[76:79],v[96:99]
ds_read_b128 a[140:143],v1 offset:18560
v_fma_f32 v80,v80,s36,v14
v_mfma_f32_16x16x32_bf16 v[96:99],a[144:147],a[80:83],v[96:99]
ds_read_b128 a[144:147],v0 offset:18688
v_fma_f32 v81,v81,s36,v14
v_mfma_f32_16x16x32_bf16 v[96:99],a[148:151],a[84:87],v[96:99]
ds_read_b128 a[148:151],v1 offset:18688
v_mfma_f32_16x16x32_bf16 v[96:99],a[120:123],a[88:91],v[96:99]
v_exp_f32 v72,v72
v_mfma_f32_16x16x32_bf16 v[96:99],a[124:127],a[92:95],v[96:99]
s_waitcnt lgkmcnt(4)
v_exp_f32 v73,v73
v_mfma_f32_16x16x32_bf16 v[76:79],a[128:131],a[0:3],0
buffer_load_dwordx4 v7,s[4:7],s20 offen offset:1024 lds
v_mfma_f32_16x16x32_bf16 v[76:79],a[132:135],a[4:7],v[76:79]
s_waitcnt lgkmcnt(3)
v_exp_f32 v74,v74
v_mfma_f32_16x16x32_bf16 v[76:79],a[136:139],a[8:11],v[76:79]
s_waitcnt lgkmcnt(2)
v_exp_f32 v75,v75
v_mfma_f32_16x16x32_bf16 v[76:79],a[140:143],a[12:15],v[76:79]
s_waitcnt lgkmcnt(0)
v_exp_f32 v80,v80
v_mfma_f32_16x16x32_bf16 v[76:79],a[144:147],a[16:19],v[76:79]
v_exp_f32 v81,v81
v_mfma_f32_16x16x32_bf16 v[76:79],a[148:151],a[20:23],v[76:79]
v_cvt_pk_bf16_f32 v44,v72,v73
v_cvt_pk_bf16_f32 v45,v74,v75
v_mfma_f32_16x16x32_bf16 v[84:87],a[148:151],a[44:47],0
v_cvt_pk_bf16_f32 v48,v80,v81
v_mfma_f32_16x16x32_bf16 v[84:87],a[144:147],a[40:43],v[84:87]
v_mfma_f32_16x16x32_bf16 v[84:87],a[140:143],a[36:39],v[84:87]
v_mfma_f32_16x16x32_bf16 v[84:87],a[136:139],a[32:35],v[84:87]
buffer_load_dwordx4 v8,s[4:7],s20 offen offset:2048 lds
v_mfma_f32_16x16x32_bf16 v[84:87],a[132:135],a[28:31],v[84:87]
s_add_u32 s20,s20,12288
v_mfma_f32_16x16x32_bf16 v[84:87],a[128:131],a[24:27],v[84:87]
ds_read_b64_tr_b16 a[120:121],v2 offset:0
v_mfma_f32_16x16x32_bf16 v[92:95],a[128:131],a[48:51],0
ds_read_b64_tr_b16 a[122:123],v2 offset:6144
v_mfma_f32_16x16x32_bf16 v[92:95],a[132:135],a[52:55],v[92:95]
ds_read_b64_tr_b16 a[124:125],v3 offset:0
v_mfma_f32_16x16x32_bf16 v[92:95],a[136:139],a[56:59],v[92:95]
ds_read_b64_tr_b16 a[126:127],v3 offset:6144
v_mfma_f32_16x16x32_bf16 v[92:95],a[140:143],a[60:63],v[92:95]
v_mfma_f32_16x16x32_bf16 v[92:95],a[144:147],a[64:67],v[92:95]
v_mfma_f32_16x16x32_bf16 v[92:95],a[148:151],a[68:71],v[92:95]
v_mfma_f32_16x16x32_bf16 v[100:103],a[148:151],a[92:95],0
v_mfma_f32_16x16x32_bf16 v[100:103],a[144:147],a[88:91],v[100:103]
v_mfma_f32_16x16x32_bf16 v[100:103],a[140:143],a[84:87],v[100:103]
v_mfma_f32_16x16x32_bf16 v[100:103],a[136:139],a[80:83],v[100:103]
v_mfma_f32_16x16x32_bf16 v[100:103],a[132:135],a[76:79],v[100:103]
ds_read_b64_tr_b16 a[132:133],v5 offset:0
v_mfma_f32_16x16x32_bf16 v[100:103],a[128:131],a[72:75],v[100:103]
s_waitcnt lgkmcnt(1)
ds_read_b64_tr_b16 a[128:129],v4 offset:0
ds_read_b64_tr_b16 a[130:131],v4 offset:6144
ds_read_b64_tr_b16 a[134:135],v5 offset:6144
v_mfma_f32_16x16x32_bf16 v[160:163],a[120:123],v[20:23],v[160:163]
s_add_u32 m0,s23,0
ds_read_b64_tr_b16 a[142:143],v3 offset:6272
v_fma_f32 v83,v83,s36,v14
v_mfma_f32_16x16x32_bf16 v[164:167],a[124:127],v[20:23],v[164:167]
ds_read_b64_tr_b16 a[138:139],v2 offset:6272
v_fma_f32 v82,v82,s36,v14
v_mfma_f32_16x16x32_bf16 v[212:215],a[124:127],v[24:27],v[212:215]
ds_read_b64_tr_b16 a[136:137],v2 offset:128
v_fma_f32 v88,v88,s36,v15
v_mfma_f32_16x16x32_bf16 v[208:211],a[120:123],v[24:27],v[208:211]
ds_read_b64_tr_b16 a[140:141],v3 offset:128
v_fma_f32 v91,v91,s36,v15
v_mfma_f32_16x16x32_bf16 v[112:115],a[120:123],v[28:31],v[112:115]
ds_read_b64_tr_b16 a[146:147],v4 offset:6272
v_fma_f32 v89,v89,s36,v15
v_mfma_f32_16x16x32_bf16 v[116:119],a[124:127],v[28:31],v[116:119]
ds_read_b64_tr_b16 a[150:151],v5 offset:6272
v_fma_f32 v90,v90,s36,v15
v_mfma_f32_16x16x32_bf16 a[164:167],a[124:127],v[32:35],a[164:167]
ds_read_b64_tr_b16 a[144:145],v4 offset:128
v_fma_f32 v96,v96,s36,v16
v_mfma_f32_16x16x32_bf16 a[160:163],a[120:123],v[32:35],a[160:163]
s_waitcnt lgkmcnt(6)
ds_read_b64_tr_b16 a[148:149],v5 offset:128
v_fma_f32 v98,v98,s36,v16
v_mfma_f32_16x16x32_bf16 a[168:171],a[128:131],v[32:35],a[168:171]
ds_read_b64_tr_b16 a[120:121],v2 offset:256
v_fma_f32 v99,v99,s36,v16
v_mfma_f32_16x16x32_bf16 a[172:175],a[132:135],v[32:35],a[172:175]
ds_read_b64_tr_b16 a[126:127],v3 offset:6400
v_fma_f32 v97,v97,s36,v16
v_mfma_f32_16x16x32_bf16 v[124:127],a[132:135],v[28:31],v[124:127]
ds_read_b64_tr_b16 a[122:123],v2 offset:6400
v_fma_f32 v79,v79,s36,v13
v_mfma_f32_16x16x32_bf16 v[120:123],a[128:131],v[28:31],v[120:123]
ds_read_b64_tr_b16 a[124:125],v3 offset:256
v_fma_f32 v77,v77,s36,v13
v_mfma_f32_16x16x32_bf16 v[216:219],a[128:131],v[24:27],v[216:219]
v_exp_f32 v82,v82
v_mfma_f32_16x16x32_bf16 v[220:223],a[132:135],v[24:27],v[220:223]
v_exp_f32 v83,v83
v_mfma_f32_16x16x32_bf16 v[172:175],a[132:135],v[20:23],v[172:175]
ds_read_b64_tr_b16 a[132:133],v5 offset:256
v_cvt_pk_bf16_f32 v49,v82,v83
v_mfma_f32_16x16x32_bf16 v[168:171],a[128:131],v[20:23],v[168:171]
s_waitcnt lgkmcnt(4)
ds_read_b64_tr_b16 a[134:135],v5 offset:6400
v_fma_f32 v76,v76,s36,v13
v_mfma_f32_16x16x32_bf16 v[176:179],a[136:139],v[20:23],v[176:179]
ds_read_b64_tr_b16 a[128:129],v4 offset:256
v_fma_f32 v78,v78,s36,v13
v_mfma_f32_16x16x32_bf16 v[180:183],a[140:143],v[20:23],v[180:183]
ds_read_b64_tr_b16 a[130:131],v4 offset:6400
v_fma_f32 v86,v86,s36,v14
v_mfma_f32_16x16x32_bf16 v[228:231],a[140:143],v[24:27],v[228:231]
v_exp_f32 v90,v90
v_mfma_f32_16x16x32_bf16 v[224:227],a[136:139],v[24:27],v[224:227]
v_exp_f32 v88,v88
v_mfma_f32_16x16x32_bf16 v[128:131],a[136:139],v[28:31],v[128:131]
v_exp_f32 v89,v89
v_mfma_f32_16x16x32_bf16 v[132:135],a[140:143],v[28:31],v[132:135]
v_cvt_pk_bf16_f32 v52,v88,v89
v_fma_f32 v84,v84,s36,v14
v_mfma_f32_16x16x32_bf16 a[180:183],a[140:143],v[32:35],a[180:183]
v_exp_f32 v91,v91
v_mfma_f32_16x16x32_bf16 a[176:179],a[136:139],v[32:35],a[176:179]
v_cvt_pk_bf16_f32 v53,v90,v91
v_fma_f32 v85,v85,s36,v14
v_mfma_f32_16x16x32_bf16 a[184:187],a[144:147],v[32:35],a[184:187]
v_exp_f32 v99,v99
v_mfma_f32_16x16x32_bf16 a[188:191],a[148:151],v[32:35],a[188:191]
v_exp_f32 v97,v97
v_mfma_f32_16x16x32_bf16 v[140:143],a[148:151],v[28:31],v[140:143]
v_exp_f32 v96,v96
v_mfma_f32_16x16x32_bf16 v[136:139],a[144:147],v[28:31],v[136:139]
v_cvt_pk_bf16_f32 v56,v96,v97
v_fma_f32 v87,v87,s36,v14
v_mfma_f32_16x16x32_bf16 v[232:235],a[144:147],v[24:27],v[232:235]
v_exp_f32 v98,v98
v_mfma_f32_16x16x32_bf16 v[236:239],a[148:151],v[24:27],v[236:239]
v_cvt_pk_bf16_f32 v57,v98,v99
v_fma_f32 v94,v94,s36,v15
v_mfma_f32_16x16x32_bf16 v[188:191],a[148:151],v[20:23],v[188:191]
v_exp_f32 v76,v76
v_mfma_f32_16x16x32_bf16 v[184:187],a[144:147],v[20:23],v[184:187]
s_waitcnt lgkmcnt(0)
v_exp_f32 v79,v79
v_mfma_f32_16x16x32_bf16 v[192:195],a[120:123],v[20:23],v[192:195]
v_exp_f32 v78,v78
v_mfma_f32_16x16x32_bf16 v[196:199],a[124:127],v[20:23],v[196:199]
s_waitcnt vmcnt(9)
ds_read_b128 a[156:159],v10 offset:6144
v_cvt_pk_bf16_f32 v47,v78,v79
v_mfma_f32_16x16x32_bf16 v[244:247],a[124:127],v[24:27],v[244:247]
s_barrier
v_mfma_f32_16x16x32_bf16 v[240:243],a[120:123],v[24:27],v[240:243]
ds_read_b128 a[148:151],v1 offset:24704
v_fma_f32 v92,v92,s36,v15
v_mfma_f32_16x16x32_bf16 v[144:147],a[120:123],v[28:31],v[144:147]
ds_read_b128 a[144:147],v0 offset:24704
v_fma_f32 v93,v93,s36,v15
v_mfma_f32_16x16x32_bf16 v[148:151],a[124:127],v[28:31],v[148:151]
ds_read_b128 a[140:143],v1 offset:24576
v_fma_f32 v95,v95,s36,v15
v_mfma_f32_16x16x32_bf16 a[196:199],a[124:127],v[32:35],a[196:199]
ds_read_b128 a[124:127],v1 offset:24832
v_fma_f32 v102,v102,s36,v16
v_mfma_f32_16x16x32_bf16 a[192:195],a[120:123],v[32:35],a[192:195]
ds_read_b128 a[120:123],v0 offset:24832
v_fma_f32 v100,v100,s36,v16
v_mfma_f32_16x16x32_bf16 a[200:203],a[128:131],v[32:35],a[200:203]
buffer_load_dwordx4 v6,s[8:11],s21 offen offset:0 lds
v_mfma_f32_16x16x32_bf16 a[204:207],a[132:135],v[32:35],a[204:207]
ds_read_b128 a[136:139],v0 offset:24576
v_fma_f32 v101,v101,s36,v16
v_mfma_f32_16x16x32_bf16 v[156:159],a[132:135],v[28:31],v[156:159]
v_exp_f32 v77,v77
v_mfma_f32_16x16x32_bf16 v[152:155],a[128:131],v[28:31],v[152:155]
v_cvt_pk_bf16_f32 v46,v76,v77
v_fma_f32 v103,v103,s36,v16
v_mfma_f32_16x16x32_bf16 v[248:251],a[128:131],v[24:27],v[248:251]
v_exp_f32 v86,v86
v_mfma_f32_16x16x32_bf16 v[252:255],a[132:135],v[24:27],v[252:255]
v_exp_f32 v87,v87
v_mfma_f32_16x16x32_bf16 v[204:207],a[132:135],v[20:23],v[204:207]
ds_read_b128 a[132:135],v1 offset:30720
v_cvt_pk_bf16_f32 v51,v86,v87
v_mfma_f32_16x16x32_bf16 v[200:203],a[128:131],v[20:23],v[200:203]
s_waitcnt lgkmcnt(2)
ds_read_b128 a[128:131],v0 offset:30720
v_mfma_f32_16x16x32_bf16 v[72:75],a[124:127],a[20:23],0
v_exp_f32 v85,v85
v_mfma_f32_16x16x32_bf16 v[72:75],a[120:123],a[16:19],v[72:75]
buffer_store_dwordx4 a[156:159],v9,s[16:19],s27 offen offset:0 nt
buffer_load_dwordx4 v7,s[8:11],s21 offen offset:1024 lds
v_mfma_f32_16x16x32_bf16 v[72:75],a[148:151],a[12:15],v[72:75]
ds_read_b128 a[156:159],v10 offset:7168
v_mfma_f32_16x16x32_bf16 v[72:75],a[144:147],a[8:11],v[72:75]
v_exp_f32 v84,v84
v_mfma_f32_16x16x32_bf16 v[72:75],a[140:143],a[4:7],v[72:75]
s_waitcnt lgkmcnt(3)
v_cvt_pk_bf16_f32 v50,v84,v85
v_mfma_f32_16x16x32_bf16 v[72:75],a[136:139],a[0:3],v[72:75]
v_exp_f32 v93,v93
v_smfmac_f32_16x16x64_bf16 v[60:63],a[152:155],v[44:51],v18
v_mfma_f32_16x16x32_bf16 v[80:83],a[136:139],a[24:27],0
v_exp_f32 v94,v94
v_mfma_f32_16x16x32_bf16 v[80:83],a[140:143],a[28:31],v[80:83]
v_exp_f32 v92,v92
v_mfma_f32_16x16x32_bf16 v[80:83],a[144:147],a[32:35],v[80:83]
buffer_load_dwordx4 v8,s[8:11],s21 offen offset:2048 lds
v_mfma_f32_16x16x32_bf16 v[80:83],a[148:151],a[36:39],v[80:83]
s_add_u32 s21,s21,12288
v_cvt_pk_bf16_f32 v54,v92,v93
v_fma_f32 v74,v74,s36,v13
v_mfma_f32_16x16x32_bf16 v[80:83],a[120:123],a[40:43],v[80:83]
s_cmp_eq_u32 s38,1
v_exp_f32 v95,v95
v_mfma_f32_16x16x32_bf16 v[80:83],a[124:127],a[44:47],v[80:83]
s_cselect_b32 s20,s26,s20
v_cvt_pk_bf16_f32 v55,v94,v95
v_fma_f32 v75,v75,s36,v13
v_mfma_f32_16x16x32_bf16 v[88:91],a[124:127],a[68:71],0
s_add_u32 m0,s22,12288
v_exp_f32 v103,v103
v_mfma_f32_16x16x32_bf16 v[88:91],a[120:123],a[64:67],v[88:91]
v_exp_f32 v100,v100
v_mfma_f32_16x16x32_bf16 v[88:91],a[148:151],a[60:63],v[88:91]
v_exp_f32 v102,v102
v_mfma_f32_16x16x32_bf16 v[88:91],a[144:147],a[56:59],v[88:91]
v_cvt_pk_bf16_f32 v59,v102,v103
v_fma_f32 v73,v73,s36,v13
v_mfma_f32_16x16x32_bf16 v[88:91],a[140:143],a[52:55],v[88:91]
v_exp_f32 v101,v101
v_mfma_f32_16x16x32_bf16 v[88:91],a[136:139],a[48:51],v[88:91]
s_waitcnt lgkmcnt(0)
buffer_store_dwordx4 a[156:159],v9,s[16:19],s27 offen offset:128 nt
buffer_load_dwordx4 v6,s[4:7],s20 offen offset:0 lds
v_mfma_f32_16x16x32_bf16 v[96:99],a[136:139],a[72:75],0
ds_read_b128 a[156:159],v10 offset:8192
v_cvt_pk_bf16_f32 v58,v100,v101
v_mfma_f32_16x16x32_bf16 v[96:99],a[140:143],a[76:79],v[96:99]
ds_read_b128 a[136:139],v0 offset:30848
v_fma_f32 v80,v80,s36,v14
v_smfmac_f32_16x16x64_bf16 v[64:67],a[152:155],v[52:59],v18
ds_read_b128 a[140:143],v1 offset:30848
v_mfma_f32_16x16x32_bf16 v[96:99],a[144:147],a[80:83],v[96:99]
ds_read_b128 a[144:147],v0 offset:30976
v_mfma_f32_16x16x32_bf16 v[96:99],a[148:151],a[84:87],v[96:99]
ds_read_b128 a[148:151],v1 offset:30976
v_mfma_f32_16x16x32_bf16 v[96:99],a[120:123],a[88:91],v[96:99]
v_fma_f32 v81,v81,s36,v14
v_fma_f32 v72,v72,s36,v13
v_mfma_f32_16x16x32_bf16 v[96:99],a[124:127],a[92:95],v[96:99]
v_exp_f32 v80,v80
v_mfma_f32_16x16x32_bf16 v[76:79],a[128:131],a[0:3],0
buffer_load_dwordx4 v7,s[4:7],s20 offen offset:1024 lds
v_mfma_f32_16x16x32_bf16 v[76:79],a[132:135],a[4:7],v[76:79]
s_waitcnt lgkmcnt(3)
v_exp_f32 v74,v74
v_mfma_f32_16x16x32_bf16 v[76:79],a[136:139],a[8:11],v[76:79]
s_waitcnt lgkmcnt(2)
v_exp_f32 v75,v75
v_mfma_f32_16x16x32_bf16 v[76:79],a[140:143],a[12:15],v[76:79]
s_waitcnt lgkmcnt(1)
v_cvt_pk_bf16_f32 v21,v74,v75
v_mfma_f32_16x16x32_bf16 v[76:79],a[144:147],a[16:19],v[76:79]
s_waitcnt lgkmcnt(0)
v_exp_f32 v72,v72
v_mfma_f32_16x16x32_bf16 v[76:79],a[148:151],a[20:23],v[76:79]
v_exp_f32 v81,v81
v_mfma_f32_16x16x32_bf16 v[84:87],a[148:151],a[44:47],0
v_cvt_pk_bf16_f32 v24,v80,v81
v_mfma_f32_16x16x32_bf16 v[84:87],a[144:147],a[40:43],v[84:87]
v_exp_f32 v73,v73
v_mfma_f32_16x16x32_bf16 v[84:87],a[140:143],a[36:39],v[84:87]
v_cvt_pk_bf16_f32 v20,v72,v73
v_mfma_f32_16x16x32_bf16 v[84:87],a[136:139],a[32:35],v[84:87]
buffer_store_dwordx4 a[156:159],v9,s[16:19],s27 offen offset:256 nt
buffer_load_dwordx4 v8,s[4:7],s20 offen offset:2048 lds
v_mfma_f32_16x16x32_bf16 v[84:87],a[132:135],a[28:31],v[84:87]
s_add_u32 s20,s20,12288
ds_read_b64_tr_b16 a[120:121],v2 offset:12288
v_mfma_f32_16x16x32_bf16 v[84:87],a[128:131],a[24:27],v[84:87]
s_add_u32 s27,s27,3072
ds_read_b64_tr_b16 a[122:123],v2 offset:18432
v_mfma_f32_16x16x32_bf16 v[92:95],a[128:131],a[48:51],0
ds_read_b64_tr_b16 a[124:125],v3 offset:12288
v_mfma_f32_16x16x32_bf16 v[92:95],a[132:135],a[52:55],v[92:95]
ds_read_b64_tr_b16 a[126:127],v3 offset:18432
v_mfma_f32_16x16x32_bf16 v[92:95],a[136:139],a[56:59],v[92:95]
v_mfma_f32_16x16x32_bf16 v[92:95],a[140:143],a[60:63],v[92:95]
v_mfma_f32_16x16x32_bf16 v[92:95],a[144:147],a[64:67],v[92:95]
v_mfma_f32_16x16x32_bf16 v[92:95],a[148:151],a[68:71],v[92:95]
v_mfma_f32_16x16x32_bf16 v[100:103],a[148:151],a[92:95],0
v_mfma_f32_16x16x32_bf16 v[100:103],a[144:147],a[88:91],v[100:103]
v_mfma_f32_16x16x32_bf16 v[100:103],a[140:143],a[84:87],v[100:103]
v_mfma_f32_16x16x32_bf16 v[100:103],a[136:139],a[80:83],v[100:103]
v_mfma_f32_16x16x32_bf16 v[100:103],a[132:135],a[76:79],v[100:103]
ds_read_b64_tr_b16 a[134:135],v5 offset:18432
v_mfma_f32_16x16x32_bf16 v[100:103],a[128:131],a[72:75],v[100:103]
s_waitcnt lgkmcnt(1)
ds_read_b64_tr_b16 a[130:131],v4 offset:18432
ds_read_b64_tr_b16 a[128:129],v4 offset:12288
ds_read_b64_tr_b16 a[132:133],v5 offset:12288
v_mfma_f32_16x16x32_bf16 v[160:163],a[120:123],v[44:47],v[160:163]
s_add_u32 m0,s29,0
ds_read_b64_tr_b16 a[136:137],v2 offset:12416
v_fma_f32 v82,v82,s36,v14
v_mfma_f32_16x16x32_bf16 v[164:167],a[124:127],v[44:47],v[164:167]
ds_read_b64_tr_b16 a[138:139],v2 offset:18560
v_fma_f32 v83,v83,s36,v14
v_mfma_f32_16x16x32_bf16 v[212:215],a[124:127],v[48:51],v[212:215]
ds_read_b64_tr_b16 a[140:141],v3 offset:12416
v_fma_f32 v88,v88,s36,v15
v_mfma_f32_16x16x32_bf16 v[208:211],a[120:123],v[48:51],v[208:211]
ds_read_b64_tr_b16 a[142:143],v3 offset:18560
v_fma_f32 v89,v89,s36,v15
v_mfma_f32_16x16x32_bf16 v[112:115],a[120:123],v[52:55],v[112:115]
ds_read_b64_tr_b16 a[144:145],v4 offset:12416
v_fma_f32 v90,v90,s36,v15
v_mfma_f32_16x16x32_bf16 v[116:119],a[124:127],v[52:55],v[116:119]
ds_read_b64_tr_b16 a[146:147],v4 offset:18560
v_fma_f32 v91,v91,s36,v15
v_mfma_f32_16x16x32_bf16 a[164:167],a[124:127],v[56:59],a[164:167]
buffer_load_dwordx4 v6,s[12:15],s28 offen offset:0 nt lds
v_mfma_f32_16x16x32_bf16 a[160:163],a[120:123],v[56:59],a[160:163]
s_waitcnt lgkmcnt(5)
ds_read_b64_tr_b16 a[148:149],v5 offset:12416
v_fma_f32 v96,v96,s36,v16
v_mfma_f32_16x16x32_bf16 a[168:171],a[128:131],v[56:59],a[168:171]
ds_read_b64_tr_b16 a[150:151],v5 offset:18560
v_fma_f32 v97,v97,s36,v16
v_mfma_f32_16x16x32_bf16 a[172:175],a[132:135],v[56:59],a[172:175]
ds_read_b64_tr_b16 a[120:121],v2 offset:12544
v_fma_f32 v98,v98,s36,v16
v_mfma_f32_16x16x32_bf16 v[124:127],a[132:135],v[52:55],v[124:127]
ds_read_b64_tr_b16 a[122:123],v2 offset:18688
v_fma_f32 v99,v99,s36,v16
v_mfma_f32_16x16x32_bf16 v[120:123],a[128:131],v[52:55],v[120:123]
ds_read_b64_tr_b16 a[124:125],v3 offset:12544
v_fma_f32 v76,v76,s36,v13
v_mfma_f32_16x16x32_bf16 v[216:219],a[128:131],v[48:51],v[216:219]
ds_read_b64_tr_b16 a[126:127],v3 offset:18688
v_fma_f32 v77,v77,s36,v13
v_mfma_f32_16x16x32_bf16 v[220:223],a[132:135],v[48:51],v[220:223]
buffer_load_dwordx4 v7,s[12:15],s28 offen offset:1024 nt lds
v_mfma_f32_16x16x32_bf16 v[172:175],a[132:135],v[44:47],v[172:175]
ds_read_b64_tr_b16 a[132:133],v5 offset:12544
v_fma_f32 v78,v78,s36,v13
v_mfma_f32_16x16x32_bf16 v[168:171],a[128:131],v[44:47],v[168:171]
s_waitcnt lgkmcnt(5)
ds_read_b64_tr_b16 a[128:129],v4 offset:12544
v_fma_f32 v79,v79,s36,v13
v_mfma_f32_16x16x32_bf16 v[176:179],a[136:139],v[44:47],v[176:179]
ds_read_b64_tr_b16 a[130:131],v4 offset:18688
v_fma_f32 v84,v84,s36,v14
v_mfma_f32_16x16x32_bf16 v[180:183],a[140:143],v[44:47],v[180:183]
ds_read_b64_tr_b16 a[134:135],v5 offset:18688
v_fma_f32 v85,v85,s36,v14
v_mfma_f32_16x16x32_bf16 v[228:231],a[140:143],v[48:51],v[228:231]
v_exp_f32 v82,v82
v_mfma_f32_16x16x32_bf16 v[224:227],a[136:139],v[48:51],v[224:227]
v_exp_f32 v83,v83
v_mfma_f32_16x16x32_bf16 v[128:131],a[136:139],v[52:55],v[128:131]
v_cvt_pk_bf16_f32 v25,v82,v83
v_fma_f32 v86,v86,s36,v14
v_mfma_f32_16x16x32_bf16 v[132:135],a[140:143],v[52:55],v[132:135]
buffer_load_dwordx4 v8,s[12:15],s28 offen offset:2048 nt lds
v_mfma_f32_16x16x32_bf16 a[180:183],a[140:143],v[56:59],a[180:183]
s_add_u32 s28,s28,3072
v_exp_f32 v88,v88
v_mfma_f32_16x16x32_bf16 a[176:179],a[136:139],v[56:59],a[176:179]
s_add_u32 s29,s29,3072
v_exp_f32 v89,v89
v_mfma_f32_16x16x32_bf16 a[184:187],a[144:147],v[56:59],a[184:187]
s_cmp_eq_u32 s38,1
v_exp_f32 v90,v90
v_mfma_f32_16x16x32_bf16 a[188:191],a[148:151],v[56:59],a[188:191]
s_cselect_b32 s21,s26,s21
v_exp_f32 v91,v91
v_mfma_f32_16x16x32_bf16 v[140:143],a[148:151],v[52:55],v[140:143]
s_add_u32 m0,s23,12288
v_cvt_pk_bf16_f32 v28,v88,v89
v_cvt_pk_bf16_f32 v29,v90,v91
v_mfma_f32_16x16x32_bf16 v[136:139],a[144:147],v[52:55],v[136:139]
v_exp_f32 v96,v96
v_mfma_f32_16x16x32_bf16 v[232:235],a[144:147],v[48:51],v[232:235]
v_exp_f32 v97,v97
v_mfma_f32_16x16x32_bf16 v[236:239],a[148:151],v[48:51],v[236:239]
v_exp_f32 v98,v98
v_mfma_f32_16x16x32_bf16 v[188:191],a[148:151],v[44:47],v[188:191]
v_exp_f32 v99,v99
v_mfma_f32_16x16x32_bf16 v[184:187],a[144:147],v[44:47],v[184:187]
s_waitcnt lgkmcnt(0)
v_cvt_pk_bf16_f32 v32,v96,v97
v_cvt_pk_bf16_f32 v33,v98,v99
v_mfma_f32_16x16x32_bf16 v[192:195],a[120:123],v[44:47],v[192:195]
s_waitcnt vmcnt(12)
v_exp_f32 v76,v76
v_mfma_f32_16x16x32_bf16 v[196:199],a[124:127],v[44:47],v[196:199]
s_barrier
v_mfma_f32_16x16x32_bf16 v[244:247],a[124:127],v[48:51],v[244:247]
ds_read_b128 a[148:151],v1 offset:128
v_fma_f32 v87,v87,s36,v14
v_mfma_f32_16x16x32_bf16 v[240:243],a[120:123],v[48:51],v[240:243]
ds_read_b128 a[144:147],v0 offset:128
v_fma_f32 v92,v92,s36,v15
v_mfma_f32_16x16x32_bf16 v[144:147],a[120:123],v[52:55],v[144:147]
ds_read_b128 a[140:143],v1 offset:0
v_fma_f32 v93,v93,s36,v15
v_mfma_f32_16x16x32_bf16 v[148:151],a[124:127],v[52:55],v[148:151]
ds_read_b128 a[136:139],v0 offset:0
v_fma_f32 v94,v94,s36,v15
v_mfma_f32_16x16x32_bf16 a[196:199],a[124:127],v[56:59],a[196:199]
ds_read_b128 a[124:127],v1 offset:256
v_fma_f32 v95,v95,s36,v15
v_mfma_f32_16x16x32_bf16 a[192:195],a[120:123],v[56:59],a[192:195]
buffer_load_dwordx4 v6,s[8:11],s21 offen offset:0 lds
v_mfma_f32_16x16x32_bf16 a[200:203],a[128:131],v[56:59],a[200:203]
ds_read_b128 a[120:123],v0 offset:256
v_fma_f32 v100,v100,s36,v16
v_mfma_f32_16x16x32_bf16 a[204:207],a[132:135],v[56:59],a[204:207]
v_exp_f32 v77,v77
v_mfma_f32_16x16x32_bf16 v[156:159],a[132:135],v[52:55],v[156:159]
v_exp_f32 v78,v78
v_mfma_f32_16x16x32_bf16 v[152:155],a[128:131],v[52:55],v[152:155]
v_exp_f32 v79,v79
v_mfma_f32_16x16x32_bf16 v[248:251],a[128:131],v[48:51],v[248:251]
v_cvt_pk_bf16_f32 v22,v76,v77
v_cvt_pk_bf16_f32 v23,v78,v79
v_mfma_f32_16x16x32_bf16 v[252:255],a[132:135],v[48:51],v[252:255]
v_exp_f32 v84,v84
v_mfma_f32_16x16x32_bf16 v[204:207],a[132:135],v[44:47],v[204:207]
ds_read_b128 a[132:135],v1 offset:6144
v_fma_f32 v101,v101,s36,v16
v_mfma_f32_16x16x32_bf16 v[200:203],a[128:131],v[44:47],v[200:203]
s_waitcnt lgkmcnt(1)
ds_read_b128 a[128:131],v0 offset:6144
v_fma_f32 v102,v102,s36,v16
v_mfma_f32_16x16x32_bf16 v[72:75],a[124:127],a[20:23],0
buffer_load_dwordx4 v7,s[8:11],s21 offen offset:1024 lds
v_mfma_f32_16x16x32_bf16 v[72:75],a[120:123],a[16:19],v[72:75]
v_exp_f32 v85,v85
v_mfma_f32_16x16x32_bf16 v[72:75],a[148:151],a[12:15],v[72:75]
v_exp_f32 v86,v86
v_mfma_f32_16x16x32_bf16 v[72:75],a[144:147],a[8:11],v[72:75]
v_exp_f32 v87,v87
v_mfma_f32_16x16x32_bf16 v[72:75],a[140:143],a[4:7],v[72:75]
v_cvt_pk_bf16_f32 v26,v84,v85
v_cvt_pk_bf16_f32 v27,v86,v87
v_mfma_f32_16x16x32_bf16 v[72:75],a[136:139],a[0:3],v[72:75]
v_exp_f32 v92,v92
v_smfmac_f32_16x16x64_bf16 v[60:63],a[152:155],v[20:27],v18
v_fma_f32 v103,v103,s36,v16
v_mfma_f32_16x16x32_bf16 v[80:83],a[136:139],a[24:27],0
v_exp_f32 v93,v93
v_mfma_f32_16x16x32_bf16 v[80:83],a[140:143],a[28:31],v[80:83]
buffer_load_dwordx4 v8,s[8:11],s21 offen offset:2048 lds
v_mfma_f32_16x16x32_bf16 v[80:83],a[144:147],a[32:35],v[80:83]
s_add_u32 s21,s21,12288
v_exp_f32 v94,v94
v_mfma_f32_16x16x32_bf16 v[80:83],a[148:151],a[36:39],v[80:83]
s_add_u32 m0,s22,24576
v_exp_f32 v95,v95
v_mfma_f32_16x16x32_bf16 v[80:83],a[120:123],a[40:43],v[80:83]
v_cvt_pk_bf16_f32 v30,v92,v93
v_cvt_pk_bf16_f32 v31,v94,v95
v_mfma_f32_16x16x32_bf16 v[80:83],a[124:127],a[44:47],v[80:83]
v_exp_f32 v100,v100
v_mfma_f32_16x16x32_bf16 v[88:91],a[124:127],a[68:71],0
v_exp_f32 v101,v101
v_mfma_f32_16x16x32_bf16 v[88:91],a[120:123],a[64:67],v[88:91]
v_exp_f32 v102,v102
v_mfma_f32_16x16x32_bf16 v[88:91],a[148:151],a[60:63],v[88:91]
v_exp_f32 v103,v103
v_mfma_f32_16x16x32_bf16 v[88:91],a[144:147],a[56:59],v[88:91]
v_cvt_pk_bf16_f32 v34,v100,v101
v_cvt_pk_bf16_f32 v35,v102,v103
v_mfma_f32_16x16x32_bf16 v[88:91],a[140:143],a[52:55],v[88:91]
buffer_load_dwordx4 v6,s[4:7],s20 offen offset:0 lds
v_smfmac_f32_16x16x64_bf16 v[64:67],a[152:155],v[28:35],v18
v_fma_f32 v72,v72,s36,v13
v_mfma_f32_16x16x32_bf16 v[88:91],a[136:139],a[48:51],v[88:91]
v_fma_f32 v73,v73,s36,v13
v_fma_f32 v74,v74,s36,v13
v_mfma_f32_16x16x32_bf16 v[96:99],a[136:139],a[72:75],0
ds_read_b128 a[136:139],v0 offset:6272
v_fma_f32 v75,v75,s36,v13
v_mfma_f32_16x16x32_bf16 v[96:99],a[140:143],a[76:79],v[96:99]
ds_read_b128 a[140:143],v1 offset:6272
v_fma_f32 v80,v80,s36,v14
v_mfma_f32_16x16x32_bf16 v[96:99],a[144:147],a[80:83],v[96:99]
ds_read_b128 a[144:147],v0 offset:6400
v_fma_f32 v81,v81,s36,v14
v_mfma_f32_16x16x32_bf16 v[96:99],a[148:151],a[84:87],v[96:99]
ds_read_b128 a[148:151],v1 offset:6400
v_add_u32 v10,9216,v10
v_mfma_f32_16x16x32_bf16 v[96:99],a[120:123],a[88:91],v[96:99]
v_exp_f32 v72,v72
v_mfma_f32_16x16x32_bf16 v[96:99],a[124:127],a[92:95],v[96:99]
s_waitcnt lgkmcnt(4)
v_exp_f32 v73,v73
v_mfma_f32_16x16x32_bf16 v[76:79],a[128:131],a[0:3],0
buffer_load_dwordx4 v7,s[4:7],s20 offen offset:1024 lds
v_mfma_f32_16x16x32_bf16 v[76:79],a[132:135],a[4:7],v[76:79]
s_waitcnt lgkmcnt(3)
v_exp_f32 v74,v74
v_mfma_f32_16x16x32_bf16 v[76:79],a[136:139],a[8:11],v[76:79]
s_waitcnt lgkmcnt(2)
v_exp_f32 v75,v75
v_mfma_f32_16x16x32_bf16 v[76:79],a[140:143],a[12:15],v[76:79]
s_waitcnt lgkmcnt(0)
v_exp_f32 v80,v80
v_mfma_f32_16x16x32_bf16 v[76:79],a[144:147],a[16:19],v[76:79]
v_exp_f32 v81,v81
v_mfma_f32_16x16x32_bf16 v[76:79],a[148:151],a[20:23],v[76:79]
v_cvt_pk_bf16_f32 v44,v72,v73
v_cvt_pk_bf16_f32 v45,v74,v75
v_mfma_f32_16x16x32_bf16 v[84:87],a[148:151],a[44:47],0
v_cvt_pk_bf16_f32 v48,v80,v81
v_mfma_f32_16x16x32_bf16 v[84:87],a[144:147],a[40:43],v[84:87]
v_mfma_f32_16x16x32_bf16 v[84:87],a[140:143],a[36:39],v[84:87]
v_mfma_f32_16x16x32_bf16 v[84:87],a[136:139],a[32:35],v[84:87]
buffer_load_dwordx4 v8,s[4:7],s20 offen offset:2048 lds
v_mfma_f32_16x16x32_bf16 v[84:87],a[132:135],a[28:31],v[84:87]
s_add_u32 s20,s20,12288
s_add_u32 s38,s38,1
s_cmp_lt_u32 s38,2
v_mfma_f32_16x16x32_bf16 v[84:87],a[128:131],a[24:27],v[84:87]
ds_read_b64_tr_b16 a[120:121],v2 offset:24576
v_mfma_f32_16x16x32_bf16 v[92:95],a[128:131],a[48:51],0
ds_read_b64_tr_b16 a[122:123],v2 offset:30720
v_mfma_f32_16x16x32_bf16 v[92:95],a[132:135],a[52:55],v[92:95]
ds_read_b64_tr_b16 a[124:125],v3 offset:24576
v_mfma_f32_16x16x32_bf16 v[92:95],a[136:139],a[56:59],v[92:95]
ds_read_b64_tr_b16 a[126:127],v3 offset:30720
v_mfma_f32_16x16x32_bf16 v[92:95],a[140:143],a[60:63],v[92:95]
v_mfma_f32_16x16x32_bf16 v[92:95],a[144:147],a[64:67],v[92:95]
v_mfma_f32_16x16x32_bf16 v[92:95],a[148:151],a[68:71],v[92:95]
v_mfma_f32_16x16x32_bf16 v[100:103],a[148:151],a[92:95],0
v_mfma_f32_16x16x32_bf16 v[100:103],a[144:147],a[88:91],v[100:103]
v_mfma_f32_16x16x32_bf16 v[100:103],a[140:143],a[84:87],v[100:103]
v_mfma_f32_16x16x32_bf16 v[100:103],a[136:139],a[80:83],v[100:103]
v_mfma_f32_16x16x32_bf16 v[100:103],a[132:135],a[76:79],v[100:103]
ds_read_b64_tr_b16 a[132:133],v5 offset:24576
v_mfma_f32_16x16x32_bf16 v[100:103],a[128:131],a[72:75],v[100:103]
ds_read_b64_tr_b16 a[128:129],v4 offset:24576
ds_read_b64_tr_b16 a[130:131],v4 offset:30720
ds_read_b64_tr_b16 a[134:135],v5 offset:30720
s_cbranch_scc1 L_loop4w0
s_cmp_ge_u32 s69,6
s_cbranch_scc1 L_end4
s_cmp_eq_u32 s40,0
s_cbranch_scc1 L_tr44
s_branch L_tr45
L_tr45:
s_waitcnt vmcnt(43)
s_waitcnt lgkmcnt(3)
v_mfma_f32_16x16x32_bf16 v[160:163],a[120:123],v[20:23],v[160:163]
s_add_u32 m0,s24,0
ds_read_b128 a[4:7],v12 offset:0
v_fma_f32 v79,v79,s36,v13
v_mfma_f32_16x16x32_bf16 v[164:167],a[124:127],v[20:23],v[164:167]
ds_read_b128 a[12:15],v12 offset:128
v_fma_f32 v100,v100,s36,v16
v_mfma_f32_16x16x32_bf16 v[212:215],a[124:127],v[24:27],v[212:215]
ds_read_b128 a[20:23],v12 offset:256
v_fma_f32 v101,v101,s36,v16
v_mfma_f32_16x16x32_bf16 v[208:211],a[120:123],v[24:27],v[208:211]
ds_read_b128 a[8:11],v11 offset:128
v_fma_f32 v89,v89,s36,v15
v_mfma_f32_16x16x32_bf16 v[112:115],a[120:123],v[28:31],v[112:115]
ds_read_b128 a[0:3],v11 offset:0
v_fma_f32 v76,v76,s36,v13
v_mfma_f32_16x16x32_bf16 v[116:119],a[124:127],v[28:31],v[116:119]
ds_read_b128 a[16:19],v11 offset:256
v_fma_f32 v83,v83,s36,v14
v_mfma_f32_16x16x32_bf16 a[164:167],a[124:127],v[32:35],a[164:167]
ds_read_b64_tr_b16 a[138:139],v2 offset:30848
v_fma_f32 v90,v90,s36,v15
v_mfma_f32_16x16x32_bf16 a[160:163],a[120:123],v[32:35],a[160:163]
s_waitcnt lgkmcnt(6)
ds_read_b64_tr_b16 a[136:137],v2 offset:24704
v_fma_f32 v88,v88,s36,v15
v_mfma_f32_16x16x32_bf16 a[168:171],a[128:131],v[32:35],a[168:171]
ds_read_b64_tr_b16 a[142:143],v3 offset:30848
ds_read_b64_tr_b16 a[140:141],v3 offset:24704
ds_read_b64_tr_b16 a[146:147],v4 offset:30848
ds_read_b64_tr_b16 a[144:145],v4 offset:24704
ds_read_b64_tr_b16 a[150:151],v5 offset:30848
ds_read_b64_tr_b16 a[148:149],v5 offset:24704
ds_read_b128 a[32:35],v11 offset:6272
v_mfma_f32_16x16x32_bf16 a[172:175],a[132:135],v[32:35],a[172:175]
v_fma_f32 v91,v91,s36,v15
ds_read_b128 a[40:43],v11 offset:6400
v_mfma_f32_16x16x32_bf16 v[124:127],a[132:135],v[28:31],v[124:127]
s_waitcnt lgkmcnt(10)
buffer_load_dwordx4 v6,s[12:15],s28 offen offset:0 nt lds
v_mfma_f32_16x16x32_bf16 v[120:123],a[128:131],v[28:31],v[120:123]
ds_read_b64_tr_b16 a[122:123],v2 offset:30976
ds_read_b64_tr_b16 a[120:121],v2 offset:24832
ds_read_b64_tr_b16 a[124:125],v3 offset:24832
ds_read_b64_tr_b16 a[126:127],v3 offset:30976
ds_read_b128 a[44:47],v12 offset:6400
v_mfma_f32_16x16x32_bf16 v[216:219],a[128:131],v[24:27],v[216:219]
v_fma_f32 v93,v93,s36,v15
ds_read_b128 a[28:31],v12 offset:6144
v_mfma_f32_16x16x32_bf16 v[220:223],a[132:135],v[24:27],v[220:223]
v_fma_f32 v98,v98,s36,v16
ds_read_b128 a[36:39],v12 offset:6272
v_mfma_f32_16x16x32_bf16 v[172:175],a[132:135],v[20:23],v[172:175]
buffer_load_dwordx4 v7,s[12:15],s28 offen offset:1024 nt lds
v_mfma_f32_16x16x32_bf16 v[168:171],a[128:131],v[20:23],v[168:171]
s_waitcnt lgkmcnt(7)
ds_read_b64_tr_b16 a[130:131],v4 offset:30976
ds_read_b128 a[24:27],v11 offset:6144
v_mfma_f32_16x16x32_bf16 v[176:179],a[136:139],v[20:23],v[176:179]
v_fma_f32 v82,v82,s36,v14
v_exp_f32 v93,v93
v_mfma_f32_16x16x32_bf16 v[180:183],a[140:143],v[20:23],v[180:183]
ds_read_b64_tr_b16 a[128:129],v4 offset:24832
v_fma_f32 v85,v85,s36,v14
v_mfma_f32_16x16x32_bf16 v[228:231],a[140:143],v[24:27],v[228:231]
ds_read_b64_tr_b16 a[134:135],v5 offset:30976
v_exp_f32 v82,v82
v_mfma_f32_16x16x32_bf16 v[224:227],a[136:139],v[24:27],v[224:227]
ds_read_b64_tr_b16 a[132:133],v5 offset:24832
v_fma_f32 v84,v84,s36,v14
v_mfma_f32_16x16x32_bf16 v[128:131],a[136:139],v[28:31],v[128:131]
v_exp_f32 v84,v84
v_mfma_f32_16x16x32_bf16 v[132:135],a[140:143],v[28:31],v[132:135]
buffer_load_dwordx4 v8,s[12:15],s28 offen offset:2048 nt lds
v_mfma_f32_16x16x32_bf16 a[180:183],a[140:143],v[32:35],a[180:183]
s_add_u32 s28,s28,3072
v_fma_f32 v103,v103,s36,v16
v_exp_f32 v103,v103
v_mfma_f32_16x16x32_bf16 a[176:179],a[136:139],v[32:35],a[176:179]
s_add_u32 m0,s24,3072
v_fma_f32 v87,v87,s36,v14
v_exp_f32 v87,v87
v_mfma_f32_16x16x32_bf16 a[184:187],a[144:147],v[32:35],a[184:187]
v_fma_f32 v77,v77,s36,v13
v_exp_f32 v77,v77
v_mfma_f32_16x16x32_bf16 a[188:191],a[148:151],v[32:35],a[188:191]
v_fma_f32 v97,v97,s36,v16
v_exp_f32 v91,v91
v_mfma_f32_16x16x32_bf16 v[140:143],a[148:151],v[28:31],v[140:143]
v_fma_f32 v102,v102,s36,v16
v_exp_f32 v85,v85
v_mfma_f32_16x16x32_bf16 v[136:139],a[144:147],v[28:31],v[136:139]
v_exp_f32 v89,v89
v_mfma_f32_16x16x32_bf16 v[232:235],a[144:147],v[24:27],v[232:235]
buffer_load_dwordx4 v6,s[12:15],s28 offen offset:0 nt lds
v_mfma_f32_16x16x32_bf16 v[236:239],a[148:151],v[24:27],v[236:239]
v_fma_f32 v92,v92,s36,v15
v_exp_f32 v101,v101
v_mfma_f32_16x16x32_bf16 v[188:191],a[148:151],v[20:23],v[188:191]
v_fma_f32 v94,v94,s36,v15
v_fma_f32 v95,v95,s36,v15
v_mfma_f32_16x16x32_bf16 v[184:187],a[144:147],v[20:23],v[184:187]
s_waitcnt lgkmcnt(0)
v_exp_f32 v95,v95
v_mfma_f32_16x16x32_bf16 v[192:195],a[120:123],v[20:23],v[192:195]
v_fma_f32 v86,v86,s36,v14
v_fma_f32 v78,v78,s36,v13
v_mfma_f32_16x16x32_bf16 v[196:199],a[124:127],v[20:23],v[196:199]
v_exp_f32 v92,v92
v_mfma_f32_16x16x32_bf16 v[244:247],a[124:127],v[24:27],v[244:247]
v_exp_f32 v78,v78
v_mfma_f32_16x16x32_bf16 v[240:243],a[120:123],v[24:27],v[240:243]
buffer_load_dwordx4 v7,s[12:15],s28 offen offset:1024 nt lds
v_mfma_f32_16x16x32_bf16 v[144:147],a[120:123],v[28:31],v[144:147]
v_exp_f32 v94,v94
v_mfma_f32_16x16x32_bf16 v[148:151],a[124:127],v[28:31],v[148:151]
v_exp_f32 v90,v90
v_mfma_f32_16x16x32_bf16 a[196:199],a[124:127],v[32:35],a[196:199]
v_fma_f32 v96,v96,s36,v16
v_exp_f32 v96,v96
v_mfma_f32_16x16x32_bf16 a[192:195],a[120:123],v[32:35],a[192:195]
v_fma_f32 v99,v99,s36,v16
v_exp_f32 v83,v83
v_mfma_f32_16x16x32_bf16 a[200:203],a[128:131],v[32:35],a[200:203]
v_exp_f32 v97,v97
v_mfma_f32_16x16x32_bf16 a[204:207],a[132:135],v[32:35],a[204:207]
v_exp_f32 v88,v88
v_mfma_f32_16x16x32_bf16 v[156:159],a[132:135],v[28:31],v[156:159]
v_exp_f32 v98,v98
v_mfma_f32_16x16x32_bf16 v[152:155],a[128:131],v[28:31],v[152:155]
buffer_load_dwordx4 v8,s[12:15],s28 offen offset:2048 nt lds
s_waitcnt vmcnt(20)
s_barrier
v_mfma_f32_16x16x32_bf16 v[248:251],a[128:131],v[24:27],v[248:251]
s_add_u32 s28,s28,3072
ds_read_b64_tr_b16 a[138:139],v2 offset:6144
v_exp_f32 v79,v79
v_mfma_f32_16x16x32_bf16 v[252:255],a[132:135],v[24:27],v[252:255]
s_add_u32 m0,s22,0
ds_read_b64_tr_b16 a[136:137],v2 offset:0
buffer_load_dwordx4 v6,s[4:7],s25 offen offset:0 lds
v_mfma_f32_16x16x32_bf16 v[204:207],a[132:135],v[20:23],v[204:207]
buffer_load_dwordx4 v7,s[4:7],s25 offen offset:1024 lds
v_mfma_f32_16x16x32_bf16 v[200:203],a[128:131],v[20:23],v[200:203]
buffer_load_dwordx4 v8,s[4:7],s25 offen offset:2048 lds
ds_read_b64_tr_b16 a[142:143],v3 offset:6144
ds_read_b64_tr_b16 a[140:141],v3 offset:0
ds_read_b64_tr_b16 a[144:145],v4 offset:0
ds_read_b64_tr_b16 a[146:147],v4 offset:6144
ds_read_b64_tr_b16 a[148:149],v5 offset:0
ds_read_b64_tr_b16 a[150:151],v5 offset:6144
v_exp_f32 v100,v100
v_cvt_pk_bf16_f32 v47,v78,v79
v_cvt_pk_bf16_f32 v49,v82,v83
v_exp_f32 v76,v76
v_exp_f32 v102,v102
v_exp_f32 v86,v86
v_cvt_pk_bf16_f32 v59,v102,v103
v_exp_f32 v99,v99
v_cvt_pk_bf16_f32 v50,v84,v85
v_cvt_pk_bf16_f32 v57,v98,v99
v_cvt_pk_bf16_f32 v55,v94,v95
v_cvt_pk_bf16_f32 v54,v92,v93
v_cvt_pk_bf16_f32 v58,v100,v101
v_cvt_pk_bf16_f32 v51,v86,v87
v_cvt_pk_bf16_f32 v53,v90,v91
v_cvt_pk_bf16_f32 v46,v76,v77
v_cvt_pk_bf16_f32 v52,v88,v89
v_cvt_pk_bf16_f32 v56,v96,v97
v_smfmac_f32_16x16x64_bf16 v[60:63],a[152:155],v[44:51],v18
v_subrev_u32 v10,18432,v10
v_smfmac_f32_16x16x64_bf16 v[64:67],a[152:155],v[52:59],v18
s_waitcnt lgkmcnt(0)
v_mfma_f32_16x16x32_bf16 v[160:163],a[136:139],v[44:47],v[160:163]
s_add_u32 s87,s42,18432
ds_read_b64_tr_b16 a[122:123],v2 offset:6272
v_mbcnt_lo_u32_b32 v39,-1,0
v_mfma_f32_16x16x32_bf16 v[164:167],a[140:143],v[44:47],v[164:167]
ds_read_b64_tr_b16 a[120:121],v2 offset:128
v_mbcnt_hi_u32_b32 v39,-1,v39
v_mfma_f32_16x16x32_bf16 v[212:215],a[140:143],v[48:51],v[212:215]
ds_read_b64_tr_b16 a[124:125],v3 offset:128
v_and_b32 v38,7,v39
v_mfma_f32_16x16x32_bf16 v[208:211],a[136:139],v[48:51],v[208:211]
ds_read_b64_tr_b16 a[126:127],v3 offset:6272
v_add_f32 v64,v64,v65
v_mfma_f32_16x16x32_bf16 v[112:115],a[136:139],v[52:55],v[112:115]
ds_read_b64_tr_b16 a[130:131],v4 offset:6272
v_add_f32 v60,v60,v61
v_mfma_f32_16x16x32_bf16 v[116:119],a[140:143],v[52:55],v[116:119]
ds_read_b64_tr_b16 a[128:129],v4 offset:128
v_add_f32 v62,v62,v63
v_mfma_f32_16x16x32_bf16 a[164:167],a[140:143],v[56:59],a[164:167]
ds_read_b64_tr_b16 a[134:135],v5 offset:6272
v_max3_f32 v19,v60,v62,v64
v_mfma_f32_16x16x32_bf16 a[160:163],a[136:139],v[56:59],a[160:163]
ds_read_b64_tr_b16 a[132:133],v5 offset:128
v_add_f32 v66,v66,v67
v_mfma_f32_16x16x32_bf16 a[168:171],a[144:147],v[56:59],a[168:171]
ds_read_b64_tr_b16 a[138:139],v2 offset:6400
v_max_f32 v19,v19,v66
v_mfma_f32_16x16x32_bf16 a[172:175],a[148:151],v[56:59],a[172:175]
ds_read_b64_tr_b16 a[136:137],v2 offset:256
v_accvgpr_read_b32 v80,a164
v_mfma_f32_16x16x32_bf16 v[124:127],a[148:151],v[52:55],v[124:127]
ds_read_b64_tr_b16 a[140:141],v3 offset:256
v_accvgpr_read_b32 v75,a163
v_mfma_f32_16x16x32_bf16 v[120:123],a[144:147],v[52:55],v[120:123]
ds_read_b64_tr_b16 a[142:143],v3 offset:6400
v_accvgpr_read_b32 v81,a165
v_mfma_f32_16x16x32_bf16 v[216:219],a[144:147],v[48:51],v[216:219]
v_accvgpr_read_b32 v72,a160
v_accvgpr_read_b32 v83,a167
v_mfma_f32_16x16x32_bf16 v[220:223],a[148:151],v[48:51],v[220:223]
v_rcp_f32 v66,v66
v_mfma_f32_16x16x32_bf16 v[172:175],a[148:151],v[44:47],v[172:175]
ds_read_b64_tr_b16 a[150:151],v5 offset:6400
v_accvgpr_read_b32 v74,a162
v_mfma_f32_16x16x32_bf16 v[168:171],a[144:147],v[44:47],v[168:171]
s_waitcnt lgkmcnt(4)
ds_read_b64_tr_b16 a[146:147],v4 offset:6400
v_accvgpr_read_b32 v73,a161
v_mfma_f32_16x16x32_bf16 v[176:179],a[120:123],v[44:47],v[176:179]
ds_read_b64_tr_b16 a[144:145],v4 offset:256
v_accvgpr_read_b32 v82,a166
v_mfma_f32_16x16x32_bf16 v[180:183],a[124:127],v[44:47],v[180:183]
ds_read_b64_tr_b16 a[148:149],v5 offset:256
v_accvgpr_read_b32 v89,a169
v_mfma_f32_16x16x32_bf16 v[228:231],a[124:127],v[48:51],v[228:231]
v_accvgpr_read_b32 v90,a170
v_accvgpr_read_b32 v88,a168
v_mfma_f32_16x16x32_bf16 v[224:227],a[120:123],v[48:51],v[224:227]
v_accvgpr_read_b32 v91,a171
v_accvgpr_read_b32 v98,a174
v_mfma_f32_16x16x32_bf16 v[128:131],a[120:123],v[52:55],v[128:131]
v_accvgpr_read_b32 v97,a173
v_accvgpr_read_b32 v96,a172
v_mfma_f32_16x16x32_bf16 v[132:135],a[124:127],v[52:55],v[132:135]
v_accvgpr_read_b32 v99,a175
v_cmp_ngt_f32 vcc,s37,v19
v_mfma_f32_16x16x32_bf16 a[180:183],a[124:127],v[56:59],a[180:183]
v_lshrrev_b32 v19,5,v39
v_xor_b32 v38,v38,v19
v_mfma_f32_16x16x32_bf16 a[176:179],a[120:123],v[56:59],a[176:179]
s_cmp_lg_u64 vcc,0
v_and_b32 v19,15,v39
v_lshl_add_u32 v19,v19,7,s24
v_mfma_f32_16x16x32_bf16 a[184:187],a[128:131],v[56:59],a[184:187]
s_cselect_b32 s62,s32,0
v_lshl_add_u32 v19,v38,4,v19
v_bfe_u32 v38,v39,4,1
v_mfma_f32_16x16x32_bf16 a[188:191],a[132:135],v[56:59],a[188:191]
s_or_b32 s31,s31,s62
v_lshl_add_u32 v36,v38,3,v19
v_xor_b32 v38,64,v36
v_mfma_f32_16x16x32_bf16 v[140:143],a[132:135],v[52:55],v[140:143]
s_lshl_b32 s32,s32,1
v_xor_b32 v37,32,v36
v_bfe_u32 v19,v39,3,1
v_xor_b32 v39,96,v36
v_lshlrev_b32 v19,11,v19
v_accvgpr_read_b32 v86,a182
v_pk_mul_f32 v[82:83],v[82:83],v[66:67] op_sel_hi:[1,0]
v_pk_mul_f32 v[80:81],v[80:81],v[66:67] op_sel_hi:[1,0]
v_pk_mul_f32 v[74:75],v[74:75],v[66:67] op_sel_hi:[1,0]
v_pk_mul_f32 v[72:73],v[72:73],v[66:67] op_sel_hi:[1,0]
v_accvgpr_read_b32 v79,a179
v_accvgpr_read_b32 v78,a178
v_pk_mul_f32 v[78:79],v[78:79],v[66:67] op_sel_hi:[1,0]
v_accvgpr_read_b32 v77,a177
v_accvgpr_read_b32 v84,a180
v_accvgpr_read_b32 v87,a183
v_pk_mul_f32 v[86:87],v[86:87],v[66:67] op_sel_hi:[1,0]
v_accvgpr_read_b32 v85,a181
v_pk_mul_f32 v[84:85],v[84:85],v[66:67] op_sel_hi:[1,0]
v_accvgpr_read_b32 v76,a176
v_pk_mul_f32 v[76:77],v[76:77],v[66:67] op_sel_hi:[1,0]
v_accvgpr_read_b32 v94,a186
v_accvgpr_read_b32 v95,a187
v_mfma_f32_16x16x32_bf16 v[136:139],a[128:131],v[52:55],v[136:139]
s_add_u32 m0,s24,6144
v_accvgpr_read_b32 v92,a184
v_accvgpr_read_b32 v93,a185
v_accvgpr_read_b32 v103,a191
v_accvgpr_read_b32 v102,a190
buffer_load_dwordx4 v6,s[12:15],s28 offen offset:0 nt lds
buffer_load_dwordx4 v7,s[12:15],s28 offen offset:1024 nt lds
buffer_load_dwordx4 v8,s[12:15],s28 offen offset:2048 nt lds
v_pk_mul_f32 v[92:93],v[92:93],v[66:67] op_sel_hi:[1,0]
v_pk_mul_f32 v[88:89],v[88:89],v[66:67] op_sel_hi:[1,0]
v_pk_mul_f32 v[94:95],v[94:95],v[66:67] op_sel_hi:[1,0]
v_pk_mul_f32 v[90:91],v[90:91],v[66:67] op_sel_hi:[1,0]
v_accvgpr_read_b32 v101,a189
v_accvgpr_read_b32 v100,a188
v_mfma_f32_16x16x32_bf16 v[232:235],a[128:131],v[48:51],v[232:235]
s_add_u32 s28,s28,3072
v_cvt_pk_bf16_f32 v84,v84,v85
v_cvt_pk_bf16_f32 v85,v86,v87
v_cvt_pk_bf16_f32 v76,v76,v77
v_cvt_pk_bf16_f32 v77,v78,v79
v_cvt_pk_bf16_f32 v80,v80,v81
v_pk_mul_f32 v[96:97],v[96:97],v[66:67] op_sel_hi:[1,0]
v_pk_mul_f32 v[98:99],v[98:99],v[66:67] op_sel_hi:[1,0]
v_pk_mul_f32 v[100:101],v[100:101],v[66:67] op_sel_hi:[1,0]
v_pk_mul_f32 v[102:103],v[102:103],v[66:67] op_sel_hi:[1,0]
v_cvt_pk_bf16_f32 v88,v88,v89
v_cvt_pk_bf16_f32 v72,v72,v73
v_mfma_f32_16x16x32_bf16 v[236:239],a[132:135],v[48:51],v[236:239]
s_add_u32 m0,s24,9216
v_cvt_pk_bf16_f32 v89,v90,v91
v_cvt_pk_bf16_f32 v73,v74,v75
v_mfma_f32_16x16x32_bf16 v[188:191],a[132:135],v[44:47],v[188:191]
buffer_load_dwordx4 v6,s[12:15],s28 offen offset:0 nt lds
v_mfma_f32_16x16x32_bf16 v[184:187],a[128:131],v[44:47],v[184:187]
buffer_load_dwordx4 v7,s[12:15],s28 offen offset:1024 nt lds
s_waitcnt lgkmcnt(0)
v_mfma_f32_16x16x32_bf16 v[192:195],a[136:139],v[44:47],v[192:195]
buffer_load_dwordx4 v8,s[12:15],s28 offen offset:2048 nt lds
v_mfma_f32_16x16x32_bf16 v[196:199],a[140:143],v[44:47],v[196:199]
s_add_u32 s28,s28,3072
ds_write2st64_b64 v36,v[72:73],v[76:77] offset0:36 offset1:40
v_mfma_f32_16x16x32_bf16 v[244:247],a[140:143],v[48:51],v[244:247]
s_add_u32 m0,s23,0
v_cvt_pk_bf16_f32 v100,v100,v101
v_cvt_pk_bf16_f32 v81,v82,v83
v_mfma_f32_16x16x32_bf16 v[240:243],a[136:139],v[48:51],v[240:243]
v_cvt_pk_bf16_f32 v92,v92,v93
v_cvt_pk_bf16_f32 v93,v94,v95
v_mfma_f32_16x16x32_bf16 v[144:147],a[136:139],v[52:55],v[144:147]
v_cvt_pk_bf16_f32 v96,v96,v97
v_cvt_pk_bf16_f32 v101,v102,v103
v_mfma_f32_16x16x32_bf16 v[148:151],a[140:143],v[52:55],v[148:151]
ds_write2st64_b64 v37,v[80:81],v[84:85] offset0:36 offset1:40
v_mfma_f32_16x16x32_bf16 a[196:199],a[140:143],v[56:59],a[196:199]
v_cvt_pk_bf16_f32 v97,v98,v99
v_rcp_f32 v64,v64
v_mfma_f32_16x16x32_bf16 a[192:195],a[136:139],v[56:59],a[192:195]
v_rcp_f32 v60,v60
v_mfma_f32_16x16x32_bf16 a[200:203],a[144:147],v[56:59],a[200:203]
v_rcp_f32 v62,v62
v_mfma_f32_16x16x32_bf16 a[204:207],a[148:151],v[56:59],a[204:207]
ds_write2st64_b64 v38,v[88:89],v[92:93] offset0:36 offset1:40
v_mfma_f32_16x16x32_bf16 v[156:159],a[148:151],v[52:55],v[156:159]
s_waitcnt vmcnt(21)
v_accvgpr_read_b32 v86,a198
v_accvgpr_read_b32 v83,a195
v_accvgpr_read_b32 v85,a197
v_accvgpr_read_b32 v87,a199
ds_read_b128 a[48:51],v11 offset:12288
v_pk_mul_f32 v[86:87],v[86:87],v[66:67] op_sel_hi:[1,0]
ds_read_b128 a[52:55],v12 offset:12288
v_accvgpr_read_b32 v81,a193
ds_read_b128 a[56:59],v11 offset:12416
v_accvgpr_read_b32 v82,a194
ds_read_b128 a[60:63],v12 offset:12416
v_pk_mul_f32 v[82:83],v[82:83],v[66:67] op_sel_hi:[1,0]
ds_read_b128 a[64:67],v11 offset:12544
v_accvgpr_read_b32 v80,a192
ds_read_b128 a[68:71],v12 offset:12544
v_pk_mul_f32 v[80:81],v[80:81],v[66:67] op_sel_hi:[1,0]
ds_write2st64_b64 v39,v[96:97],v[100:101] offset0:36 offset1:40
v_accvgpr_read_b32 v84,a196
v_pk_mul_f32 v[84:85],v[84:85],v[66:67] op_sel_hi:[1,0]
v_accvgpr_read_b32 v90,a202
v_accvgpr_read_b32 v89,a201
v_mfma_f32_16x16x32_bf16 v[152:155],a[144:147],v[52:55],v[152:155]
ds_read_b128 v[104:107],v10 offset:18432
v_accvgpr_read_b32 v88,a200
v_accvgpr_read_b32 v91,a203
v_accvgpr_read_b32 v92,a204
v_accvgpr_read_b32 v95,a207
ds_read_b128 v[108:111],v10 offset:19456
v_pk_mul_f32 v[90:91],v[90:91],v[66:67] op_sel_hi:[1,0]
v_pk_mul_f32 v[88:89],v[88:89],v[66:67] op_sel_hi:[1,0]
v_accvgpr_read_b32 v93,a205
v_accvgpr_read_b32 v94,a206
v_mfma_f32_16x16x32_bf16 v[248:251],a[144:147],v[48:51],v[248:251]
ds_read_b128 v[72:75],v10 offset:20480
v_cvt_pk_bf16_f32 v80,v80,v81
v_cvt_pk_bf16_f32 v81,v82,v83
v_cvt_pk_bf16_f32 v84,v84,v85
v_cvt_pk_bf16_f32 v88,v88,v89
ds_read_b128 v[76:79],v10 offset:21504
v_pk_mul_f32 v[116:117],v[116:117],v[64:65] op_sel_hi:[1,0]
v_pk_mul_f32 v[130:131],v[130:131],v[64:65] op_sel_hi:[1,0]
v_pk_mul_f32 v[132:133],v[132:133],v[64:65] op_sel_hi:[1,0]
v_pk_mul_f32 v[136:137],v[136:137],v[64:65] op_sel_hi:[1,0]
ds_write_b64 v36,v[80:81] offset:18432
v_pk_mul_f32 v[92:93],v[92:93],v[66:67] op_sel_hi:[1,0]
v_pk_mul_f32 v[118:119],v[118:119],v[64:65] op_sel_hi:[1,0]
v_pk_mul_f32 v[134:135],v[134:135],v[64:65] op_sel_hi:[1,0]
s_waitcnt lgkmcnt(4)
buffer_store_dwordx4 v[104:107],v9,s[16:19],s87 offen offset:0 nt
v_pk_mul_f32 v[128:129],v[128:129],v[64:65] op_sel_hi:[1,0]
v_pk_mul_f32 v[120:121],v[120:121],v[64:65] op_sel_hi:[1,0]
v_pk_mul_f32 v[94:95],v[94:95],v[66:67] op_sel_hi:[1,0]
v_pk_mul_f32 v[122:123],v[122:123],v[64:65] op_sel_hi:[1,0]
v_pk_mul_f32 v[138:139],v[138:139],v[64:65] op_sel_hi:[1,0]
v_pk_mul_f32 v[114:115],v[114:115],v[64:65] op_sel_hi:[1,0]
v_pk_mul_f32 v[112:113],v[112:113],v[64:65] op_sel_hi:[1,0]
v_add_u32 v36,v36,v19
v_cvt_pk_bf16_f32 v92,v92,v93
v_mfma_f32_16x16x32_bf16 v[252:255],a[148:151],v[48:51],v[252:255]
v_cvt_pk_bf16_f32 v89,v90,v91
v_cvt_pk_bf16_f32 v85,v86,v87
v_mfma_f32_16x16x32_bf16 v[204:207],a[148:151],v[44:47],v[204:207]
ds_write_b64 v37,v[84:85] offset:18432
v_mfma_f32_16x16x32_bf16 v[200:203],a[144:147],v[44:47],v[200:203]
s_waitcnt lgkmcnt(1)
buffer_store_dwordx4 v[108:111],v9,s[16:19],s87 offen offset:3072 nt
v_add_u32 v37,v37,v19
v_cvt_pk_bf16_f32 v93,v94,v95
v_cvt_pk_bf16_f32 v128,v128,v129
v_cvt_pk_bf16_f32 v112,v112,v113
v_cvt_pk_bf16_f32 v113,v114,v115
v_cvt_pk_bf16_f32 v116,v116,v117
v_cvt_pk_bf16_f32 v129,v130,v131
v_cvt_pk_bf16_f32 v132,v132,v133
v_cvt_pk_bf16_f32 v136,v136,v137
v_cvt_pk_bf16_f32 v120,v120,v121
v_cvt_pk_bf16_f32 v133,v134,v135
v_cvt_pk_bf16_f32 v137,v138,v139
ds_write_b64 v38,v[88:89] offset:18432
buffer_store_dwordx4 v[72:75],v9,s[16:19],s87 offen offset:128 nt
v_add_u32 v38,v38,v19
v_cvt_pk_bf16_f32 v117,v118,v119
v_cvt_pk_bf16_f32 v121,v122,v123
v_mov_b32 v67,0
v_mov_b32 v66,0
v_mov_b32 v71,0
v_mov_b32 v70,0
v_mov_b32 v68,0
v_mov_b32 v69,0
ds_write_b64 v39,v[92:93] offset:18432
v_add_u32 v39,v39,v19
ds_read_b128 v[96:99],v10 offset:18432
buffer_store_dwordx4 v[76:79],v9,s[16:19],s87 offen offset:3200 nt
ds_read_b128 v[100:103],v10 offset:19456
s_waitcnt vmcnt(10)
s_barrier
ds_read_b128 a[120:123],v0 offset:0
ds_write2st64_b64 v36,v[112:113],v[128:129] offset0:24 offset1:26
ds_read_b128 a[124:127],v1 offset:0
ds_read_b128 a[128:131],v0 offset:128
buffer_load_dwordx4 v6,s[8:11],s25 offen offset:0 lds
ds_write2st64_b64 v37,v[116:117],v[132:133] offset0:24 offset1:26
s_waitcnt lgkmcnt(4)
v_mfma_f32_16x16x32_bf16 v[72:75],a[120:123],a[0:3],0
ds_read_b128 a[132:135],v1 offset:128
buffer_store_dwordx4 v[96:99],v9,s[16:19],s87 offen offset:256 nt
ds_read_b128 a[136:139],v0 offset:256
v_pk_mul_f32 v[126:127],v[126:127],v[64:65] op_sel_hi:[1,0]
ds_read_b128 a[140:143],v1 offset:256
v_pk_mul_f32 v[142:143],v[142:143],v[64:65] op_sel_hi:[1,0]
ds_read_b128 a[144:147],v0 offset:6144
v_pk_mul_f32 v[124:125],v[124:125],v[64:65] op_sel_hi:[1,0]
ds_read_b128 a[148:151],v1 offset:6144
buffer_store_dwordx4 v[100:103],v9,s[16:19],s87 offen offset:3328 nt
v_pk_mul_f32 v[140:141],v[140:141],v[64:65] op_sel_hi:[1,0]
v_cvt_pk_bf16_f32 v124,v124,v125
v_cvt_pk_bf16_f32 v140,v140,v141
s_waitcnt lgkmcnt(5)
v_mfma_f32_16x16x32_bf16 v[72:75],a[124:127],a[4:7],v[72:75]
v_cvt_pk_bf16_f32 v141,v142,v143
v_cvt_pk_bf16_f32 v125,v126,v127
v_mfma_f32_16x16x32_bf16 v[72:75],a[128:131],a[8:11],v[72:75]
s_waitcnt lgkmcnt(4)
v_mfma_f32_16x16x32_bf16 v[72:75],a[132:135],a[12:15],v[72:75]
buffer_load_dwordx4 v7,s[8:11],s25 offen offset:1024 lds
ds_write2st64_b64 v38,v[120:121],v[136:137] offset0:24 offset1:26
v_pk_mul_f32 v[162:163],v[162:163],v[60:61] op_sel_hi:[1,0]
v_pk_mul_f32 v[146:147],v[146:147],v[64:65] op_sel_hi:[1,0]
v_pk_mul_f32 v[144:145],v[144:145],v[64:65] op_sel_hi:[1,0]
v_pk_mul_f32 v[160:161],v[160:161],v[60:61] op_sel_hi:[1,0]
v_cvt_pk_bf16_f32 v144,v144,v145
v_cvt_pk_bf16_f32 v160,v160,v161
s_waitcnt lgkmcnt(1)
v_mfma_f32_16x16x32_bf16 v[72:75],a[136:139],a[16:19],v[72:75]
v_cvt_pk_bf16_f32 v161,v162,v163
v_cvt_pk_bf16_f32 v145,v146,v147
v_mfma_f32_16x16x32_bf16 v[72:75],a[140:143],a[20:23],v[72:75]
ds_write2st64_b64 v39,v[124:125],v[140:141] offset0:24 offset1:26
v_mfma_f32_16x16x32_bf16 v[80:83],a[140:143],a[44:47],0
v_mfma_f32_16x16x32_bf16 v[80:83],a[136:139],a[40:43],v[80:83]
buffer_load_dwordx4 v8,s[8:11],s25 offen offset:2048 lds
s_waitcnt vmcnt(18)
ds_read_b128 a[92:95],v12 offset:256
v_pk_mul_f32 v[166:167],v[166:167],v[60:61] op_sel_hi:[1,0]
v_pk_mul_f32 v[164:165],v[164:165],v[60:61] op_sel_hi:[1,0]
v_pk_mul_f32 v[150:151],v[150:151],v[64:65] op_sel_hi:[1,0]
v_pk_mul_f32 v[148:149],v[148:149],v[64:65] op_sel_hi:[1,0]
v_max3_f32 v44,v72,v73,v74
v_cvt_pk_bf16_f32 v164,v164,v165
v_mfma_f32_16x16x32_bf16 v[80:83],a[132:135],a[36:39],v[80:83]
s_mov_b32 s27,s42
ds_read_b128 a[88:91],v11 offset:256
v_cvt_pk_bf16_f32 v148,v148,v149
v_mfma_f32_16x16x32_bf16 v[80:83],a[128:131],a[32:35],v[80:83]
s_mov_b32 s42,s41
ds_read_b128 a[84:87],v12 offset:128
v_cvt_pk_bf16_f32 v165,v166,v167
v_mfma_f32_16x16x32_bf16 v[80:83],a[124:127],a[28:31],v[80:83]
s_add_u32 s69,s69,1
ds_read_b128 a[80:83],v11 offset:128
v_cvt_pk_bf16_f32 v149,v150,v151
v_mfma_f32_16x16x32_bf16 v[80:83],a[120:123],a[24:27],v[80:83]
s_lshl_b32 s62,s69,5
ds_read_b128 a[76:79],v12 offset:0
s_add_u32 s62,s62,s34
ds_read_b128 a[72:75],v11 offset:0
v_pk_mul_f32 v[170:171],v[170:171],v[60:61] op_sel_hi:[1,0]
v_pk_mul_f32 v[168:169],v[168:169],v[60:61] op_sel_hi:[1,0]
v_pk_mul_f32 v[154:155],v[154:155],v[64:65] op_sel_hi:[1,0]
v_pk_mul_f32 v[152:153],v[152:153],v[64:65] op_sel_hi:[1,0]
v_max3_f32 v48,v80,v81,v82
v_cvt_pk_bf16_f32 v152,v152,v153
v_mfma_f32_16x16x32_bf16 v[88:91],a[120:123],a[48:51],0
s_mul_i32 s63,s62,171
ds_write2st64_b64 v36,v[144:145],v[160:161] offset0:28 offset1:0
v_mfma_f32_16x16x32_bf16 v[88:91],a[124:127],a[52:55],v[88:91]
s_lshr_b32 s63,s63,9
v_cvt_pk_bf16_f32 v168,v168,v169
v_cvt_pk_bf16_f32 v169,v170,v171
v_mfma_f32_16x16x32_bf16 v[88:91],a[128:131],a[56:59],v[88:91]
s_mul_i32 s64,s63,3
v_cvt_pk_bf16_f32 v153,v154,v155
s_sub_u32 s62,s62,s64
v_mfma_f32_16x16x32_bf16 v[88:91],a[132:135],a[60:63],v[88:91]
s_add_u32 s63,s63,s33
s_mul_i32 s30,s63,196608
s_mul_i32 s41,s63,325632
s_lshl_b32 s63,s3,2
ds_write2st64_b64 v37,v[148:149],v[164:165] offset0:28 offset1:0
v_pk_mul_f32 v[174:175],v[174:175],v[60:61] op_sel_hi:[1,0]
v_pk_mul_f32 v[172:173],v[172:173],v[60:61] op_sel_hi:[1,0]
v_pk_mul_f32 v[156:157],v[156:157],v[64:65] op_sel_hi:[1,0]
v_pk_mul_f32 v[158:159],v[158:159],v[64:65] op_sel_hi:[1,0]
v_cvt_pk_bf16_f32 v172,v172,v173
v_cvt_pk_bf16_f32 v156,v156,v157
v_mfma_f32_16x16x32_bf16 v[88:91],a[136:139],a[64:67],v[88:91]
s_add_u32 s64,s63,21
v_cvt_pk_bf16_f32 v157,v158,v159
v_cvt_pk_bf16_f32 v173,v174,v175
v_mfma_f32_16x16x32_bf16 v[88:91],a[140:143],a[68:71],v[88:91]
s_cmp_eq_u32 s3,0
v_mov_b32 v65,0
v_mov_b32 v64,0
s_waitcnt lgkmcnt(1)
v_mfma_f32_16x16x32_bf16 v[96:99],a[140:143],a[92:95],0
s_cselect_b32 s64,20,s64
ds_write2st64_b64 v38,v[152:153],v[168:169] offset0:28 offset1:0
v_pk_mul_f32 v[176:177],v[176:177],v[60:61] op_sel_hi:[1,0]
v_pk_mul_f32 v[194:195],v[194:195],v[60:61] op_sel_hi:[1,0]
v_pk_mul_f32 v[192:193],v[192:193],v[60:61] op_sel_hi:[1,0]
v_pk_mul_f32 v[178:179],v[178:179],v[60:61] op_sel_hi:[1,0]
v_max3_f32 v52,v88,v89,v90
v_cvt_pk_bf16_f32 v176,v176,v177
v_mfma_f32_16x16x32_bf16 v[96:99],a[136:139],a[88:91],v[96:99]
s_cselect_b32 s40,1,0
v_cvt_pk_bf16_f32 v192,v192,v193
v_cvt_pk_bf16_f32 v177,v178,v179
v_mfma_f32_16x16x32_bf16 v[96:99],a[132:135],a[84:87],v[96:99]
s_add_u32 s65,s63,37
v_cvt_pk_bf16_f32 v193,v194,v195
s_cmp_eq_u32 s62,2
v_mfma_f32_16x16x32_bf16 v[96:99],a[128:131],a[80:83],v[96:99]
s_cselect_b32 s64,s65,s64
ds_write2st64_b64 v39,v[156:157],v[172:173] offset0:28 offset1:0
v_mfma_f32_16x16x32_bf16 v[96:99],a[124:127],a[76:79],v[96:99]
s_waitcnt vmcnt(9)
s_cselect_b32 s40,0,s40
s_add_u32 s65,s63,s3
s_cmp_eq_u32 s62,0
ds_read_b128 a[96:99],v11 offset:6144
s_cselect_b32 s64,s65,s64
ds_read_b128 a[100:103],v12 offset:6144
v_pk_mul_f32 v[198:199],v[198:199],v[60:61] op_sel_hi:[1,0]
ds_read_b128 a[104:107],v11 offset:6272
v_pk_mul_f32 v[196:197],v[196:197],v[60:61] op_sel_hi:[1,0]
ds_read_b128 a[108:111],v12 offset:6272
v_pk_mul_f32 v[180:181],v[180:181],v[60:61] op_sel_hi:[1,0]
ds_read_b128 a[112:115],v11 offset:6400
v_pk_mul_f32 v[182:183],v[182:183],v[60:61] op_sel_hi:[1,0]
v_cvt_pk_bf16_f32 v180,v180,v181
v_cvt_pk_bf16_f32 v196,v196,v197
v_mfma_f32_16x16x32_bf16 v[96:99],a[120:123],a[72:75],v[96:99]
s_cselect_b32 s40,1,s40
ds_read_b128 a[116:119],v12 offset:6400
v_cvt_pk_bf16_f32 v181,v182,v183
ds_write2st64_b64 v36,v[176:177],v[192:193] offset0:2 offset1:4
s_waitcnt lgkmcnt(6)
v_mfma_f32_16x16x32_bf16 v[104:107],a[120:123],a[96:99],0
s_mul_i32 s64,s64,6144
v_cvt_pk_bf16_f32 v197,v198,v199
s_add_u32 s41,s41,s64
s_waitcnt lgkmcnt(5)
v_mfma_f32_16x16x32_bf16 v[104:107],a[124:127],a[100:103],v[104:107]
s_cmp_ge_u32 s69,6
ds_read_b128 a[120:123],v0 offset:6272
v_max3_f32 v56,v96,v97,v98
s_waitcnt lgkmcnt(5)
v_mfma_f32_16x16x32_bf16 v[104:107],a[128:131],a[104:107],v[104:107]
s_cselect_b32 s41,166723584,s41
ds_read_b128 a[124:127],v1 offset:6272
s_cselect_b32 s30,100663296,s30
s_add_u32 s25,s30,s22
s_add_u32 s26,s25,12288
ds_write2st64_b64 v37,v[180:181],v[196:197] offset0:2 offset1:4
v_pk_mul_f32 v[184:185],v[184:185],v[60:61] op_sel_hi:[1,0]
v_pk_mul_f32 v[200:201],v[200:201],v[60:61] op_sel_hi:[1,0]
v_pk_mul_f32 v[202:203],v[202:203],v[60:61] op_sel_hi:[1,0]
ds_read_b128 a[128:131],v0 offset:6400
v_pk_mul_f32 v[186:187],v[186:187],v[60:61] op_sel_hi:[1,0]
v_cvt_pk_bf16_f32 v200,v200,v201
v_cvt_pk_bf16_f32 v184,v184,v185
s_waitcnt lgkmcnt(4)
v_mfma_f32_16x16x32_bf16 v[104:107],a[132:135],a[108:111],v[104:107]
s_add_u32 m0,s23,24576
ds_read_b128 a[132:135],v1 offset:6400
v_cvt_pk_bf16_f32 v185,v186,v187
v_mfma_f32_16x16x32_bf16 v[104:107],a[136:139],a[112:115],v[104:107]
s_mov_b32 s28,s41
ds_read_b128 a[136:139],v0 offset:12288
v_cvt_pk_bf16_f32 v201,v202,v203
v_mfma_f32_16x16x32_bf16 v[104:107],a[140:143],a[116:119],v[104:107]
s_mov_b32 s29,s24
ds_read_b128 a[140:143],v1 offset:12288
ds_write2st64_b64 v38,v[184:185],v[200:201] offset0:2 offset1:4
v_pk_mul_f32 v[206:207],v[206:207],v[60:61] op_sel_hi:[1,0]
v_pk_mul_f32 v[190:191],v[190:191],v[60:61] op_sel_hi:[1,0]
v_pk_mul_f32 v[204:205],v[204:205],v[60:61] op_sel_hi:[1,0]
v_pk_mul_f32 v[188:189],v[188:189],v[60:61] op_sel_hi:[1,0]
v_cvt_pk_bf16_f32 v204,v204,v205
v_max3_f32 v40,v104,v105,v106
v_mfma_f32_16x16x32_bf16 v[76:79],a[144:147],a[0:3],0
v_cvt_pk_bf16_f32 v188,v188,v189
v_cvt_pk_bf16_f32 v205,v206,v207
v_mfma_f32_16x16x32_bf16 v[76:79],a[148:151],a[4:7],v[76:79]
s_waitcnt lgkmcnt(4)
v_cvt_pk_bf16_f32 v189,v190,v191
v_mov_b32 v61,0
v_mfma_f32_16x16x32_bf16 v[76:79],a[120:123],a[8:11],v[76:79]
ds_write2st64_b64 v39,v[188:189],v[204:205] offset0:2 offset1:4
v_mfma_f32_16x16x32_bf16 v[76:79],a[124:127],a[12:15],v[76:79]
v_mov_b32 v60,0
buffer_load_dwordx4 v6,s[8:11],s21 offen offset:0 lds
v_pk_mul_f32 v[210:211],v[210:211],v[62:63] op_sel_hi:[1,0]
v_pk_mul_f32 v[208:209],v[208:209],v[62:63] op_sel_hi:[1,0]
v_pk_mul_f32 v[224:225],v[224:225],v[62:63] op_sel_hi:[1,0]
v_pk_mul_f32 v[226:227],v[226:227],v[62:63] op_sel_hi:[1,0]
v_cvt_pk_bf16_f32 v224,v224,v225
v_cvt_pk_bf16_f32 v225,v226,v227
v_mfma_f32_16x16x32_bf16 v[76:79],a[128:131],a[16:19],v[76:79]
s_waitcnt lgkmcnt(1)
v_cvt_pk_bf16_f32 v208,v208,v209
v_cvt_pk_bf16_f32 v209,v210,v211
v_mfma_f32_16x16x32_bf16 v[76:79],a[132:135],a[20:23],v[76:79]
ds_write2st64_b64 v36,v[208:209],v[224:225] offset0:12 offset1:14
v_mfma_f32_16x16x32_bf16 v[84:87],a[132:135],a[44:47],0
v_mfma_f32_16x16x32_bf16 v[84:87],a[128:131],a[40:43],v[84:87]
buffer_load_dwordx4 v7,s[8:11],s21 offen offset:1024 lds
v_pk_mul_f32 v[214:215],v[214:215],v[62:63] op_sel_hi:[1,0]
v_pk_mul_f32 v[230:231],v[230:231],v[62:63] op_sel_hi:[1,0]
v_pk_mul_f32 v[228:229],v[228:229],v[62:63] op_sel_hi:[1,0]
v_pk_mul_f32 v[212:213],v[212:213],v[62:63] op_sel_hi:[1,0]
v_max3_f32 v44,v44,v75,v76
v_max3_f32 v44,v44,v77,v78
v_mfma_f32_16x16x32_bf16 v[84:87],a[124:127],a[36:39],v[84:87]
v_max_f32 v44,v44,v79
v_mov_b32 v45,v44
v_mfma_f32_16x16x32_bf16 v[84:87],a[120:123],a[32:35],v[84:87]
v_cvt_pk_bf16_f32 v212,v212,v213
v_permlane32_swap_b32 v45,v44
v_mfma_f32_16x16x32_bf16 v[84:87],a[148:151],a[28:31],v[84:87]
v_max_f32 v44,v44,v45
v_mov_b32 v45,v44
v_cvt_pk_bf16_f32 v213,v214,v215
v_cvt_pk_bf16_f32 v228,v228,v229
v_permlane16_swap_b32 v45,v44
v_pk_mul_f32 v[234:235],v[234:235],v[62:63] op_sel_hi:[1,0]
v_pk_mul_f32 v[218:219],v[218:219],v[62:63] op_sel_hi:[1,0]
v_pk_mul_f32 v[232:233],v[232:233],v[62:63] op_sel_hi:[1,0]
v_pk_mul_f32 v[216:217],v[216:217],v[62:63] op_sel_hi:[1,0]
v_max_f32 v44,v44,v45
v_mul_f32_e64 v13,-s36,v44
v_mfma_f32_16x16x32_bf16 v[84:87],a[144:147],a[24:27],v[84:87]
buffer_load_dwordx4 v8,s[8:11],s21 offen offset:2048 lds
v_mfma_f32_16x16x32_bf16 v[92:95],a[144:147],a[48:51],0
s_add_u32 s21,s21,12288
v_fma_f32 v72,v72,s36,v13
v_fma_f32 v74,v74,s36,v13
v_mfma_f32_16x16x32_bf16 v[92:95],a[148:151],a[52:55],v[92:95]
s_add_u32 m0,s22,0
v_exp_f32 v74,v74
v_mfma_f32_16x16x32_bf16 v[92:95],a[120:123],a[56:59],v[92:95]
v_fma_f32 v75,v75,s36,v13
v_exp_f32 v75,v75
v_exp_f32 v72,v72
v_pk_mul_f32 v[236:237],v[236:237],v[62:63] op_sel_hi:[1,0]
v_pk_mul_f32 v[238:239],v[238:239],v[62:63] op_sel_hi:[1,0]
v_pk_mul_f32 v[220:221],v[220:221],v[62:63] op_sel_hi:[1,0]
v_pk_mul_f32 v[222:223],v[222:223],v[62:63] op_sel_hi:[1,0]
v_fma_f32 v73,v73,s36,v13
v_exp_f32 v73,v73
v_mfma_f32_16x16x32_bf16 v[92:95],a[124:127],a[60:63],v[92:95]
v_cvt_pk_bf16_f32 v20,v72,v73
v_cvt_pk_bf16_f32 v21,v74,v75
v_mfma_f32_16x16x32_bf16 v[92:95],a[128:131],a[64:67],v[92:95]
v_max3_f32 v48,v48,v83,v84
v_max3_f32 v48,v48,v85,v86
v_mfma_f32_16x16x32_bf16 v[92:95],a[132:135],a[68:71],v[92:95]
v_max_f32 v48,v48,v87
v_mov_b32 v49,v48
v_mfma_f32_16x16x32_bf16 v[100:103],a[132:135],a[92:95],0
v_cvt_pk_bf16_f32 v236,v236,v237
v_permlane32_swap_b32 v49,v48
v_max_f32 v48,v48,v49
v_mov_b32 v49,v48
v_pk_mul_f32 v[242:243],v[242:243],v[62:63] op_sel_hi:[1,0]
v_pk_mul_f32 v[240:241],v[240:241],v[62:63] op_sel_hi:[1,0]
v_permlane16_swap_b32 v49,v48
v_max_f32 v48,v48,v49
v_mfma_f32_16x16x32_bf16 v[100:103],a[128:131],a[88:91],v[100:103]
v_mul_f32_e64 v14,-s36,v48
v_fma_f32 v81,v81,s36,v14
v_mfma_f32_16x16x32_bf16 v[100:103],a[124:127],a[84:87],v[100:103]
v_fma_f32 v83,v83,s36,v14
v_fma_f32 v80,v80,s36,v14
v_mfma_f32_16x16x32_bf16 v[100:103],a[120:123],a[80:83],v[100:103]
v_exp_f32 v81,v81
v_mfma_f32_16x16x32_bf16 v[100:103],a[148:151],a[76:79],v[100:103]
v_exp_f32 v80,v80
v_fma_f32 v82,v82,s36,v14
v_exp_f32 v82,v82
v_pk_mul_f32 v[246:247],v[246:247],v[62:63] op_sel_hi:[1,0]
v_pk_mul_f32 v[244:245],v[244:245],v[62:63] op_sel_hi:[1,0]
v_exp_f32 v83,v83
v_cvt_pk_bf16_f32 v24,v80,v81
v_mfma_f32_16x16x32_bf16 v[100:103],a[144:147],a[72:75],v[100:103]
v_cvt_pk_bf16_f32 v25,v82,v83
v_max3_f32 v52,v52,v91,v92
v_mfma_f32_16x16x32_bf16 v[108:111],a[144:147],a[96:99],0
ds_read_b128 a[144:147],v0 offset:12416
v_max3_f32 v52,v52,v93,v94
v_mfma_f32_16x16x32_bf16 v[108:111],a[148:151],a[100:103],v[108:111]
ds_read_b128 a[148:151],v1 offset:12416
v_max_f32 v52,v52,v95
v_mov_b32 v53,v52
v_max3_f32 v56,v56,v99,v100
v_max3_f32 v56,v56,v101,v102
v_pk_mul_f32 v[248:249],v[248:249],v[62:63] op_sel_hi:[1,0]
v_pk_mul_f32 v[250:251],v[250:251],v[62:63] op_sel_hi:[1,0]
v_permlane32_swap_b32 v53,v52
v_max_f32 v52,v52,v53
v_mfma_f32_16x16x32_bf16 v[108:111],a[120:123],a[104:107],v[108:111]
ds_read_b128 a[120:123],v0 offset:12544
v_mov_b32 v53,v52
v_mfma_f32_16x16x32_bf16 v[108:111],a[124:127],a[108:111],v[108:111]
ds_read_b128 a[124:127],v1 offset:12544
v_permlane16_swap_b32 v53,v52
v_mfma_f32_16x16x32_bf16 v[108:111],a[128:131],a[112:115],v[108:111]
ds_read_b128 a[128:131],v0 offset:18432
v_max_f32 v52,v52,v53
v_mfma_f32_16x16x32_bf16 v[108:111],a[132:135],a[116:119],v[108:111]
ds_read_b128 a[132:135],v1 offset:18432
v_mul_f32_e64 v15,-s36,v52
v_fma_f32 v88,v88,s36,v15
v_fma_f32 v89,v89,s36,v15
v_fma_f32 v91,v91,s36,v15
v_pk_mul_f32 v[252:253],v[252:253],v[62:63] op_sel_hi:[1,0]
v_pk_mul_f32 v[254:255],v[254:255],v[62:63] op_sel_hi:[1,0]
v_fma_f32 v90,v90,s36,v15
v_exp_f32 v90,v90
v_mfma_f32_16x16x32_bf16 v[72:75],a[136:139],a[0:3],0
v_exp_f32 v91,v91
v_mfma_f32_16x16x32_bf16 v[72:75],a[140:143],a[4:7],v[72:75]
s_waitcnt lgkmcnt(3)
v_exp_f32 v89,v89
v_mfma_f32_16x16x32_bf16 v[72:75],a[144:147],a[8:11],v[72:75]
v_exp_f32 v88,v88
v_mfma_f32_16x16x32_bf16 v[72:75],a[148:151],a[12:15],v[72:75]
v_cvt_pk_bf16_f32 v29,v90,v91
v_cvt_pk_bf16_f32 v28,v88,v89
v_mfma_f32_16x16x32_bf16 v[72:75],a[120:123],a[16:19],v[72:75]
s_waitcnt lgkmcnt(0)
v_max_f32 v56,v56,v103
v_mov_b32 v57,v56
v_mfma_f32_16x16x32_bf16 v[72:75],a[124:127],a[20:23],v[72:75]
v_max3_f32 v40,v40,v107,v108
v_permlane32_swap_b32 v57,v56
v_mfma_f32_16x16x32_bf16 v[80:83],a[124:127],a[44:47],0
v_max_f32 v56,v56,v57
v_mov_b32 v57,v56
v_mfma_f32_16x16x32_bf16 v[80:83],a[120:123],a[40:43],v[80:83]
v_max3_f32 v40,v40,v109,v110
v_permlane16_swap_b32 v57,v56
v_mfma_f32_16x16x32_bf16 v[80:83],a[148:151],a[36:39],v[80:83]
v_max_f32 v56,v56,v57
v_mul_f32_e64 v16,-s36,v56
v_mfma_f32_16x16x32_bf16 v[80:83],a[144:147],a[32:35],v[80:83]
v_fma_f32 v97,v97,s36,v16
v_fma_f32 v98,v98,s36,v16
v_mfma_f32_16x16x32_bf16 v[80:83],a[140:143],a[28:31],v[80:83]
v_fma_f32 v99,v99,s36,v16
v_exp_f32 v99,v99
v_mfma_f32_16x16x32_bf16 v[80:83],a[136:139],a[24:27],v[80:83]
v_exp_f32 v97,v97
v_mfma_f32_16x16x32_bf16 v[88:91],a[136:139],a[48:51],0
v_fma_f32 v96,v96,s36,v16
v_exp_f32 v96,v96
v_mfma_f32_16x16x32_bf16 v[88:91],a[140:143],a[52:55],v[88:91]
v_exp_f32 v98,v98
v_mfma_f32_16x16x32_bf16 v[88:91],a[144:147],a[56:59],v[88:91]
v_cvt_pk_bf16_f32 v33,v98,v99
v_cvt_pk_bf16_f32 v32,v96,v97
v_mfma_f32_16x16x32_bf16 v[88:91],a[148:151],a[60:63],v[88:91]
v_max_f32 v40,v40,v111
v_mov_b32 v41,v40
v_mfma_f32_16x16x32_bf16 v[88:91],a[120:123],a[64:67],v[88:91]
v_cvt_pk_bf16_f32 v232,v232,v233
v_permlane32_swap_b32 v41,v40
v_mfma_f32_16x16x32_bf16 v[88:91],a[124:127],a[68:71],v[88:91]
v_max_f32 v40,v40,v41
v_mov_b32 v41,v40
v_mfma_f32_16x16x32_bf16 v[96:99],a[124:127],a[92:95],0
v_cvt_pk_bf16_f32 v216,v216,v217
v_cvt_pk_bf16_f32 v217,v218,v219
v_mfma_f32_16x16x32_bf16 v[96:99],a[120:123],a[88:91],v[96:99]
v_permlane16_swap_b32 v41,v40
v_mfma_f32_16x16x32_bf16 v[96:99],a[148:151],a[84:87],v[96:99]
v_cvt_pk_bf16_f32 v240,v240,v241
v_cvt_pk_bf16_f32 v237,v238,v239
v_mfma_f32_16x16x32_bf16 v[96:99],a[144:147],a[80:83],v[96:99]
v_max_f32 v40,v40,v41
v_cvt_pk_bf16_f32 v233,v234,v235
v_mfma_f32_16x16x32_bf16 v[96:99],a[140:143],a[76:79],v[96:99]
v_cvt_pk_bf16_f32 v229,v230,v231
v_cvt_pk_bf16_f32 v220,v220,v221
v_mfma_f32_16x16x32_bf16 v[96:99],a[136:139],a[72:75],v[96:99]
ds_write2st64_b64 v37,v[212:213],v[228:229] offset0:12 offset1:14
v_cvt_pk_bf16_f32 v221,v222,v223
v_mul_f32_e64 v17,-s36,v40
v_fma_f32 v105,v105,s36,v17
v_fma_f32 v104,v104,s36,v17
v_fma_f32 v107,v107,s36,v17
v_exp_f32 v107,v107
v_exp_f32 v104,v104
v_cvt_pk_bf16_f32 v241,v242,v243
v_fma_f32 v106,v106,s36,v17
v_exp_f32 v105,v105
v_exp_f32 v106,v106
ds_write2st64_b64 v38,v[216:217],v[232:233] offset0:12 offset1:14
v_cvt_pk_bf16_f32 v244,v244,v245
v_cvt_pk_bf16_f32 v245,v246,v247
v_fma_f32 v78,v78,s36,v13
v_fma_f32 v77,v77,s36,v13
v_exp_f32 v78,v78
v_fma_f32 v76,v76,s36,v13
v_exp_f32 v77,v77
v_fma_f32 v79,v79,s36,v13
v_exp_f32 v79,v79
v_exp_f32 v76,v76
v_cvt_pk_bf16_f32 v23,v78,v79
ds_write2st64_b64 v39,v[220:221],v[236:237] offset0:12 offset1:14
v_cvt_pk_bf16_f32 v22,v76,v77
v_fma_f32 v84,v84,s36,v14
v_exp_f32 v84,v84
v_fma_f32 v85,v85,s36,v14
v_fma_f32 v86,v86,s36,v14
v_fma_f32 v87,v87,s36,v14
v_exp_f32 v87,v87
v_exp_f32 v86,v86
v_exp_f32 v85,v85
v_cvt_pk_bf16_f32 v27,v86,v87
ds_write_b64 v36,v[240:241] offset:8192
v_cvt_pk_bf16_f32 v36,v104,v105
v_cvt_pk_bf16_f32 v26,v84,v85
v_fma_f32 v93,v93,s36,v15
v_fma_f32 v92,v92,s36,v15
v_fma_f32 v95,v95,s36,v15
v_exp_f32 v95,v95
ds_write_b64 v37,v[244:245] offset:8192
v_cvt_pk_bf16_f32 v37,v106,v107
v_mfma_f32_16x16x32_bf16 v[104:107],a[136:139],a[96:99],0
ds_read_b128 a[136:139],v0 offset:18560
v_fma_f32 v94,v94,s36,v15
v_mfma_f32_16x16x32_bf16 v[104:107],a[140:143],a[100:103],v[104:107]
ds_read_b128 a[140:143],v1 offset:18560
v_exp_f32 v93,v93
v_mfma_f32_16x16x32_bf16 v[104:107],a[144:147],a[104:107],v[104:107]
s_waitcnt vmcnt(3)
s_barrier
v_mfma_f32_16x16x32_bf16 v[104:107],a[148:151],a[108:111],v[104:107]
ds_read_b128 a[144:147],v0 offset:18688
buffer_load_dwordx4 v6,s[4:7],s20 offen offset:0 lds
v_mfma_f32_16x16x32_bf16 v[104:107],a[120:123],a[112:115],v[104:107]
ds_read_b128 a[148:151],v1 offset:18688
v_exp_f32 v94,v94
v_mfma_f32_16x16x32_bf16 v[104:107],a[124:127],a[116:119],v[104:107]
v_exp_f32 v92,v92
v_mfma_f32_16x16x32_bf16 v[76:79],a[128:131],a[0:3],0
v_cvt_pk_bf16_f32 v31,v94,v95
v_cvt_pk_bf16_f32 v30,v92,v93
v_mfma_f32_16x16x32_bf16 v[76:79],a[132:135],a[4:7],v[76:79]
s_waitcnt lgkmcnt(2)
v_fma_f32 v100,v100,s36,v16
v_fma_f32 v103,v103,s36,v16
v_mfma_f32_16x16x32_bf16 v[76:79],a[136:139],a[8:11],v[76:79]
v_fma_f32 v101,v101,s36,v16
v_exp_f32 v100,v100
v_mfma_f32_16x16x32_bf16 v[76:79],a[140:143],a[12:15],v[76:79]
buffer_load_dwordx4 v7,s[4:7],s20 offen offset:1024 lds
s_waitcnt lgkmcnt(1)
v_mfma_f32_16x16x32_bf16 v[76:79],a[144:147],a[16:19],v[76:79]
s_waitcnt lgkmcnt(0)
v_exp_f32 v103,v103
v_fma_f32 v102,v102,s36,v16
v_mfma_f32_16x16x32_bf16 v[76:79],a[148:151],a[20:23],v[76:79]
v_exp_f32 v101,v101
v_mfma_f32_16x16x32_bf16 v[84:87],a[148:151],a[44:47],0
ds_read_b64_tr_b16 a[120:121],v2 offset:0
v_exp_f32 v102,v102
v_mfma_f32_16x16x32_bf16 v[84:87],a[144:147],a[40:43],v[84:87]
ds_read_b64_tr_b16 a[122:123],v2 offset:6144
v_cvt_pk_bf16_f32 v35,v102,v103
v_mfma_f32_16x16x32_bf16 v[84:87],a[140:143],a[36:39],v[84:87]
buffer_load_dwordx4 v8,s[4:7],s20 offen offset:2048 lds
v_mfma_f32_16x16x32_bf16 v[84:87],a[136:139],a[32:35],v[84:87]
s_add_u32 s20,s20,12288
ds_read_b64_tr_b16 a[126:127],v3 offset:6144
v_cvt_pk_bf16_f32 v34,v100,v101
v_mfma_f32_16x16x32_bf16 v[84:87],a[132:135],a[28:31],v[84:87]
ds_read_b64_tr_b16 a[124:125],v3 offset:0
v_fma_f32 v111,v111,s36,v17
v_smfmac_f32_16x16x64_bf16 v[64:67],a[152:155],v[28:35],v18
v_fma_f32 v109,v109,s36,v17
v_mfma_f32_16x16x32_bf16 v[84:87],a[128:131],a[24:27],v[84:87]
v_cvt_pk_bf16_f32 v252,v252,v253
v_fma_f32 v110,v110,s36,v17
v_mfma_f32_16x16x32_bf16 v[92:95],a[128:131],a[48:51],0
v_exp_f32 v110,v110
v_mfma_f32_16x16x32_bf16 v[92:95],a[132:135],a[52:55],v[92:95]
v_cvt_pk_bf16_f32 v248,v248,v249
v_cvt_pk_bf16_f32 v249,v250,v251
v_mfma_f32_16x16x32_bf16 v[92:95],a[136:139],a[56:59],v[92:95]
ds_write_b64 v38,v[248:249] offset:8192
v_mfma_f32_16x16x32_bf16 v[92:95],a[140:143],a[60:63],v[92:95]
v_fma_f32 v108,v108,s36,v17
v_exp_f32 v111,v111
v_mfma_f32_16x16x32_bf16 v[92:95],a[144:147],a[64:67],v[92:95]
v_exp_f32 v109,v109
v_mfma_f32_16x16x32_bf16 v[92:95],a[148:151],a[68:71],v[92:95]
v_exp_f32 v108,v108
v_mfma_f32_16x16x32_bf16 v[100:103],a[148:151],a[92:95],0
v_cvt_pk_bf16_f32 v253,v254,v255
v_cvt_pk_bf16_f32 v38,v108,v109
v_mfma_f32_16x16x32_bf16 v[100:103],a[144:147],a[88:91],v[100:103]
ds_write_b64 v39,v[252:253] offset:8192
v_mfma_f32_16x16x32_bf16 v[100:103],a[140:143],a[84:87],v[100:103]
v_cvt_pk_bf16_f32 v39,v110,v111
v_mov_b32 v62,0
v_mfma_f32_16x16x32_bf16 v[100:103],a[136:139],a[80:83],v[100:103]
v_fma_f32 v80,v80,s36,v14
v_fma_f32 v88,v88,s36,v15
v_mfma_f32_16x16x32_bf16 v[100:103],a[132:135],a[76:79],v[100:103]
v_fma_f32 v81,v81,s36,v14
v_fma_f32 v75,v75,s36,v13
v_mfma_f32_16x16x32_bf16 v[100:103],a[128:131],a[72:75],v[100:103]
v_fma_f32 v83,v83,s36,v14
v_mov_b32 v63,0
v_mfma_f32_16x16x32_bf16 v[108:111],a[128:131],a[96:99],0
ds_read_b64_tr_b16 a[128:129],v4 offset:0
v_fma_f32 v82,v82,s36,v14
v_smfmac_f32_16x16x64_bf16 v[60:63],a[152:155],v[20:27],v18
ds_read_b64_tr_b16 a[130:131],v4 offset:6144
v_mfma_f32_16x16x32_bf16 v[108:111],a[132:135],a[100:103],v[108:111]
ds_read_b64_tr_b16 a[134:135],v5 offset:6144
v_fma_f32 v74,v74,s36,v13
v_mfma_f32_16x16x32_bf16 v[108:111],a[136:139],a[104:107],v[108:111]
ds_read_b64_tr_b16 a[132:133],v5 offset:0
v_exp_f32 v88,v88
v_mfma_f32_16x16x32_bf16 v[108:111],a[140:143],a[108:111],v[108:111]
v_exp_f32 v80,v80
v_mfma_f32_16x16x32_bf16 v[108:111],a[144:147],a[112:115],v[108:111]
v_exp_f32 v75,v75
v_mfma_f32_16x16x32_bf16 v[108:111],a[148:151],a[116:119],v[108:111]
v_fma_f32 v89,v89,s36,v15
v_exp_f32 v89,v89
v_fma_f32 v72,v72,s36,v13
v_exp_f32 v72,v72
v_fma_f32 v73,v73,s36,v13
v_exp_f32 v83,v83
v_exp_f32 v81,v81
v_exp_f32 v82,v82
v_exp_f32 v73,v73
v_cvt_pk_bf16_f32 v52,v88,v89
v_exp_f32 v74,v74
v_cvt_pk_bf16_f32 v49,v82,v83
v_cvt_pk_bf16_f32 v44,v72,v73
v_cvt_pk_bf16_f32 v45,v74,v75
v_cvt_pk_bf16_f32 v48,v80,v81
s_waitcnt lgkmcnt(0)
v_mfma_f32_16x16x32_bf16 v[160:163],a[120:123],v[20:23],0
s_add_u32 m0,s23,0
ds_read_b64_tr_b16 a[136:137],v2 offset:128
v_fma_f32 v90,v90,s36,v15
v_mfma_f32_16x16x32_bf16 v[164:167],a[124:127],v[20:23],0
ds_read_b64_tr_b16 a[138:139],v2 offset:6272
v_fma_f32 v91,v91,s36,v15
v_mfma_f32_16x16x32_bf16 v[212:215],a[124:127],v[24:27],0
ds_read_b64_tr_b16 a[140:141],v3 offset:128
v_fma_f32 v96,v96,s36,v16
v_mfma_f32_16x16x32_bf16 v[208:211],a[120:123],v[24:27],0
ds_read_b64_tr_b16 a[142:143],v3 offset:6272
v_fma_f32 v97,v97,s36,v16
v_mfma_f32_16x16x32_bf16 v[112:115],a[120:123],v[28:31],0
ds_read_b64_tr_b16 a[144:145],v4 offset:128
v_fma_f32 v98,v98,s36,v16
v_mfma_f32_16x16x32_bf16 v[116:119],a[124:127],v[28:31],0
ds_read_b64_tr_b16 a[146:147],v4 offset:6272
v_fma_f32 v99,v99,s36,v16
v_mfma_f32_16x16x32_bf16 a[164:167],a[124:127],v[32:35],0
ds_read_b64_tr_b16 a[148:149],v5 offset:128
v_fma_f32 v104,v104,s36,v17
v_mfma_f32_16x16x32_bf16 a[160:163],a[120:123],v[32:35],0
ds_read_b64_tr_b16 a[150:151],v5 offset:6272
v_fma_f32 v105,v105,s36,v17
v_mfma_f32_16x16x32_bf16 a[208:211],a[120:123],v[36:39],0
ds_read_b64_tr_b16 a[120:121],v2 offset:256
v_fma_f32 v106,v106,s36,v17
v_mfma_f32_16x16x32_bf16 a[212:215],a[124:127],v[36:39],0
ds_read_b64_tr_b16 a[122:123],v2 offset:6400
v_fma_f32 v107,v107,s36,v17
v_mfma_f32_16x16x32_bf16 a[216:219],a[128:131],v[36:39],0
ds_read_b64_tr_b16 a[124:125],v3 offset:256
v_fma_f32 v76,v76,s36,v13
v_mfma_f32_16x16x32_bf16 a[220:223],a[132:135],v[36:39],0
ds_read_b64_tr_b16 a[126:127],v3 offset:6400
v_fma_f32 v77,v77,s36,v13
v_mfma_f32_16x16x32_bf16 a[172:175],a[132:135],v[32:35],0
v_exp_f32 v90,v90
v_mfma_f32_16x16x32_bf16 a[168:171],a[128:131],v[32:35],0
v_exp_f32 v91,v91
v_mfma_f32_16x16x32_bf16 v[120:123],a[128:131],v[28:31],0
v_cvt_pk_bf16_f32 v53,v90,v91
v_fma_f32 v78,v78,s36,v13
v_mfma_f32_16x16x32_bf16 v[124:127],a[132:135],v[28:31],0
v_exp_f32 v96,v96
v_mfma_f32_16x16x32_bf16 v[220:223],a[132:135],v[24:27],0
v_exp_f32 v97,v97
v_mfma_f32_16x16x32_bf16 v[216:219],a[128:131],v[24:27],0
v_exp_f32 v98,v98
v_mfma_f32_16x16x32_bf16 v[168:171],a[128:131],v[20:23],0
ds_read_b64_tr_b16 a[128:129],v4 offset:256
v_cvt_pk_bf16_f32 v56,v96,v97
v_mfma_f32_16x16x32_bf16 v[172:175],a[132:135],v[20:23],0
s_waitcnt lgkmcnt(1)
ds_read_b64_tr_b16 a[130:131],v4 offset:6400
v_fma_f32 v79,v79,s36,v13
v_mfma_f32_16x16x32_bf16 v[176:179],a[136:139],v[20:23],0
ds_read_b64_tr_b16 a[132:133],v5 offset:256
v_fma_f32 v84,v84,s36,v14
v_mfma_f32_16x16x32_bf16 v[180:183],a[140:143],v[20:23],0
ds_read_b64_tr_b16 a[134:135],v5 offset:6400
v_fma_f32 v85,v85,s36,v14
v_mfma_f32_16x16x32_bf16 v[228:231],a[140:143],v[24:27],0
v_exp_f32 v99,v99
v_mfma_f32_16x16x32_bf16 v[224:227],a[136:139],v[24:27],0
v_cvt_pk_bf16_f32 v57,v98,v99
v_fma_f32 v86,v86,s36,v14
v_mfma_f32_16x16x32_bf16 v[128:131],a[136:139],v[28:31],0
v_exp_f32 v104,v104
v_mfma_f32_16x16x32_bf16 v[132:135],a[140:143],v[28:31],0
v_exp_f32 v105,v105
v_mfma_f32_16x16x32_bf16 a[180:183],a[140:143],v[32:35],0
v_exp_f32 v106,v106
v_mfma_f32_16x16x32_bf16 a[176:179],a[136:139],v[32:35],0
v_exp_f32 v107,v107
v_mfma_f32_16x16x32_bf16 a[224:227],a[136:139],v[36:39],0
v_cvt_pk_bf16_f32 v40,v104,v105
v_cvt_pk_bf16_f32 v41,v106,v107
v_mfma_f32_16x16x32_bf16 a[228:231],a[140:143],v[36:39],0
v_exp_f32 v76,v76
v_mfma_f32_16x16x32_bf16 a[232:235],a[144:147],v[36:39],0
v_exp_f32 v77,v77
v_mfma_f32_16x16x32_bf16 a[236:239],a[148:151],v[36:39],0
v_exp_f32 v78,v78
v_mfma_f32_16x16x32_bf16 a[188:191],a[148:151],v[32:35],0
v_exp_f32 v79,v79
v_mfma_f32_16x16x32_bf16 a[184:187],a[144:147],v[32:35],0
v_cvt_pk_bf16_f32 v46,v76,v77
v_cvt_pk_bf16_f32 v47,v78,v79
v_mfma_f32_16x16x32_bf16 v[136:139],a[144:147],v[28:31],0
v_fma_f32 v87,v87,s36,v14
v_fma_f32 v92,v92,s36,v15
v_mfma_f32_16x16x32_bf16 v[140:143],a[148:151],v[28:31],0
v_exp_f32 v84,v84
v_mfma_f32_16x16x32_bf16 v[236:239],a[148:151],v[24:27],0
v_exp_f32 v85,v85
v_mfma_f32_16x16x32_bf16 v[232:235],a[144:147],v[24:27],0
v_exp_f32 v86,v86
v_mfma_f32_16x16x32_bf16 v[184:187],a[144:147],v[20:23],0
v_exp_f32 v87,v87
v_mfma_f32_16x16x32_bf16 v[188:191],a[148:151],v[20:23],0
v_cvt_pk_bf16_f32 v50,v84,v85
v_cvt_pk_bf16_f32 v51,v86,v87
v_mfma_f32_16x16x32_bf16 v[192:195],a[120:123],v[20:23],0
v_fma_f32 v93,v93,s36,v15
v_fma_f32 v94,v94,s36,v15
v_smfmac_f32_16x16x64_bf16 v[60:63],a[152:155],v[44:51],v18
v_fma_f32 v95,v95,s36,v15
v_mfma_f32_16x16x32_bf16 v[196:199],a[124:127],v[20:23],0
s_waitcnt vmcnt(30) lgkmcnt(0)
v_exp_f32 v92,v92
v_mfma_f32_16x16x32_bf16 v[244:247],a[124:127],v[24:27],0
s_barrier
v_mfma_f32_16x16x32_bf16 v[240:243],a[120:123],v[24:27],0
ds_read_b128 a[136:139],v0 offset:24576
v_fma_f32 v100,v100,s36,v16
v_mfma_f32_16x16x32_bf16 v[144:147],a[120:123],v[28:31],0
ds_read_b128 a[140:143],v1 offset:24576
v_fma_f32 v101,v101,s36,v16
v_mfma_f32_16x16x32_bf16 v[148:151],a[124:127],v[28:31],0
ds_read_b128 a[144:147],v0 offset:24704
v_fma_f32 v102,v102,s36,v16
v_mfma_f32_16x16x32_bf16 a[196:199],a[124:127],v[32:35],0
ds_read_b128 a[148:151],v1 offset:24704
v_fma_f32 v103,v103,s36,v16
v_mfma_f32_16x16x32_bf16 a[192:195],a[120:123],v[32:35],0
v_exp_f32 v93,v93
v_mfma_f32_16x16x32_bf16 a[240:243],a[120:123],v[36:39],0
buffer_load_dwordx4 v6,s[8:11],s21 offen offset:0 lds
v_mfma_f32_16x16x32_bf16 a[244:247],a[124:127],v[36:39],0
ds_read_b128 a[120:123],v0 offset:24832
v_cvt_pk_bf16_f32 v54,v92,v93
v_mfma_f32_16x16x32_bf16 a[248:251],a[128:131],v[36:39],0
ds_read_b128 a[124:127],v1 offset:24832
v_fma_f32 v108,v108,s36,v17
v_mfma_f32_16x16x32_bf16 a[252:255],a[132:135],v[36:39],0
v_exp_f32 v94,v94
v_mfma_f32_16x16x32_bf16 a[204:207],a[132:135],v[32:35],0
v_exp_f32 v95,v95
v_mfma_f32_16x16x32_bf16 a[200:203],a[128:131],v[32:35],0
v_cvt_pk_bf16_f32 v55,v94,v95
v_fma_f32 v109,v109,s36,v17
v_mfma_f32_16x16x32_bf16 v[152:155],a[128:131],v[28:31],0
v_exp_f32 v100,v100
v_mfma_f32_16x16x32_bf16 v[156:159],a[132:135],v[28:31],0
v_exp_f32 v101,v101
v_mfma_f32_16x16x32_bf16 v[252:255],a[132:135],v[24:27],0
v_exp_f32 v102,v102
v_mfma_f32_16x16x32_bf16 v[248:251],a[128:131],v[24:27],0
v_exp_f32 v103,v103
v_mfma_f32_16x16x32_bf16 v[200:203],a[128:131],v[20:23],0
ds_read_b128 a[128:131],v0 offset:30720
v_cvt_pk_bf16_f32 v58,v100,v101
v_mfma_f32_16x16x32_bf16 v[204:207],a[132:135],v[20:23],0
buffer_load_dwordx4 v7,s[8:11],s21 offen offset:1024 lds
s_waitcnt lgkmcnt(1)
v_mfma_f32_16x16x32_bf16 v[72:75],a[136:139],a[0:3],0
ds_read_b128 a[132:135],v1 offset:30720
v_cvt_pk_bf16_f32 v59,v102,v103
v_mfma_f32_16x16x32_bf16 v[72:75],a[140:143],a[4:7],v[72:75]
v_fma_f32 v110,v110,s36,v17
v_fma_f32 v111,v111,s36,v17
v_smfmac_f32_16x16x64_bf16 v[64:67],a[152:155],v[52:59],v18
v_mfma_f32_16x16x32_bf16 v[72:75],a[144:147],a[8:11],v[72:75]
v_exp_f32 v108,v108
v_mfma_f32_16x16x32_bf16 v[72:75],a[148:151],a[12:15],v[72:75]
v_exp_f32 v109,v109
v_mfma_f32_16x16x32_bf16 v[72:75],a[120:123],a[16:19],v[72:75]
v_exp_f32 v110,v110
v_mfma_f32_16x16x32_bf16 v[72:75],a[124:127],a[20:23],v[72:75]
v_exp_f32 v111,v111
v_mfma_f32_16x16x32_bf16 v[80:83],a[124:127],a[44:47],0
v_cvt_pk_bf16_f32 v42,v108,v109
v_cvt_pk_bf16_f32 v43,v110,v111
v_mfma_f32_16x16x32_bf16 v[80:83],a[120:123],a[40:43],v[80:83]
v_mfma_f32_16x16x32_bf16 v[80:83],a[148:151],a[36:39],v[80:83]
v_smfmac_f32_16x16x64_bf16 v[68:71],a[152:155],v[36:43],v18
buffer_load_dwordx4 v8,s[8:11],s21 offen offset:2048 lds
v_mfma_f32_16x16x32_bf16 v[80:83],a[144:147],a[32:35],v[80:83]
s_add_u32 s21,s21,12288
v_fma_f32 v72,v72,s36,v13
v_fma_f32 v73,v73,s36,v13
v_mfma_f32_16x16x32_bf16 v[80:83],a[140:143],a[28:31],v[80:83]
s_add_u32 m0,s22,12288
v_fma_f32 v74,v74,s36,v13
v_fma_f32 v75,v75,s36,v13
v_mfma_f32_16x16x32_bf16 v[80:83],a[136:139],a[24:27],v[80:83]
v_exp_f32 v72,v72
v_mfma_f32_16x16x32_bf16 v[88:91],a[136:139],a[48:51],0
v_exp_f32 v73,v73
v_mfma_f32_16x16x32_bf16 v[88:91],a[140:143],a[52:55],v[88:91]
v_exp_f32 v74,v74
v_mfma_f32_16x16x32_bf16 v[88:91],a[144:147],a[56:59],v[88:91]
v_exp_f32 v75,v75
v_mfma_f32_16x16x32_bf16 v[88:91],a[148:151],a[60:63],v[88:91]
v_fma_f32 v80,v80,s36,v14
v_fma_f32 v81,v81,s36,v14
v_mfma_f32_16x16x32_bf16 v[88:91],a[120:123],a[64:67],v[88:91]
v_fma_f32 v82,v82,s36,v14
v_fma_f32 v83,v83,s36,v14
v_mfma_f32_16x16x32_bf16 v[88:91],a[124:127],a[68:71],v[88:91]
v_exp_f32 v80,v80
v_mfma_f32_16x16x32_bf16 v[96:99],a[124:127],a[92:95],0
v_exp_f32 v81,v81
v_mfma_f32_16x16x32_bf16 v[96:99],a[120:123],a[88:91],v[96:99]
buffer_load_dwordx4 v6,s[4:7],s20 offen offset:0 lds
v_mfma_f32_16x16x32_bf16 v[96:99],a[148:151],a[84:87],v[96:99]
v_exp_f32 v82,v82
v_mfma_f32_16x16x32_bf16 v[96:99],a[144:147],a[80:83],v[96:99]
v_fma_f32 v88,v88,s36,v15
v_fma_f32 v89,v89,s36,v15
v_mfma_f32_16x16x32_bf16 v[96:99],a[140:143],a[76:79],v[96:99]
v_exp_f32 v83,v83
v_mfma_f32_16x16x32_bf16 v[96:99],a[136:139],a[72:75],v[96:99]
v_exp_f32 v88,v88
v_mfma_f32_16x16x32_bf16 v[104:107],a[136:139],a[96:99],0
ds_read_b128 a[136:139],v0 offset:30848
v_cvt_pk_bf16_f32 v20,v72,v73
v_mfma_f32_16x16x32_bf16 v[104:107],a[140:143],a[100:103],v[104:107]
ds_read_b128 a[140:143],v1 offset:30848
v_cvt_pk_bf16_f32 v21,v74,v75
v_mfma_f32_16x16x32_bf16 v[104:107],a[144:147],a[104:107],v[104:107]
ds_read_b128 a[144:147],v0 offset:30976
v_cvt_pk_bf16_f32 v24,v80,v81
v_mfma_f32_16x16x32_bf16 v[104:107],a[148:151],a[108:111],v[104:107]
ds_read_b128 a[148:151],v1 offset:30976
v_cvt_pk_bf16_f32 v25,v82,v83
v_mfma_f32_16x16x32_bf16 v[104:107],a[120:123],a[112:115],v[104:107]
v_exp_f32 v89,v89
v_mfma_f32_16x16x32_bf16 v[104:107],a[124:127],a[116:119],v[104:107]
s_waitcnt lgkmcnt(4)
v_cvt_pk_bf16_f32 v28,v88,v89
v_mfma_f32_16x16x32_bf16 v[76:79],a[128:131],a[0:3],0
v_mfma_f32_16x16x32_bf16 v[76:79],a[132:135],a[4:7],v[76:79]
buffer_load_dwordx4 v7,s[4:7],s20 offen offset:1024 lds
s_waitcnt lgkmcnt(3)
v_mfma_f32_16x16x32_bf16 v[76:79],a[136:139],a[8:11],v[76:79]
s_waitcnt lgkmcnt(2)
v_mfma_f32_16x16x32_bf16 v[76:79],a[140:143],a[12:15],v[76:79]
s_waitcnt lgkmcnt(1)
v_mfma_f32_16x16x32_bf16 v[76:79],a[144:147],a[16:19],v[76:79]
s_waitcnt lgkmcnt(0)
v_mfma_f32_16x16x32_bf16 v[76:79],a[148:151],a[20:23],v[76:79]
v_mfma_f32_16x16x32_bf16 v[84:87],a[148:151],a[44:47],0
v_mfma_f32_16x16x32_bf16 v[84:87],a[144:147],a[40:43],v[84:87]
v_mfma_f32_16x16x32_bf16 v[84:87],a[140:143],a[36:39],v[84:87]
v_mfma_f32_16x16x32_bf16 v[84:87],a[136:139],a[32:35],v[84:87]
v_mfma_f32_16x16x32_bf16 v[84:87],a[132:135],a[28:31],v[84:87]
v_mfma_f32_16x16x32_bf16 v[84:87],a[128:131],a[24:27],v[84:87]
v_mfma_f32_16x16x32_bf16 v[92:95],a[128:131],a[48:51],0
buffer_load_dwordx4 v8,s[4:7],s20 offen offset:2048 lds
v_mfma_f32_16x16x32_bf16 v[92:95],a[132:135],a[52:55],v[92:95]
s_add_u32 s20,s20,12288
v_mfma_f32_16x16x32_bf16 v[92:95],a[136:139],a[56:59],v[92:95]
v_mfma_f32_16x16x32_bf16 v[92:95],a[140:143],a[60:63],v[92:95]
v_mfma_f32_16x16x32_bf16 v[92:95],a[144:147],a[64:67],v[92:95]
v_mfma_f32_16x16x32_bf16 v[92:95],a[148:151],a[68:71],v[92:95]
ds_read_b64_tr_b16 a[120:121],v2 offset:12288
v_mfma_f32_16x16x32_bf16 v[100:103],a[148:151],a[92:95],0
ds_read_b64_tr_b16 a[122:123],v2 offset:18432
v_mfma_f32_16x16x32_bf16 v[100:103],a[144:147],a[88:91],v[100:103]
v_mfma_f32_16x16x32_bf16 v[100:103],a[140:143],a[84:87],v[100:103]
ds_read_b64_tr_b16 a[124:125],v3 offset:12288
v_mfma_f32_16x16x32_bf16 v[100:103],a[136:139],a[80:83],v[100:103]
ds_read_b64_tr_b16 a[126:127],v3 offset:18432
v_mfma_f32_16x16x32_bf16 v[100:103],a[132:135],a[76:79],v[100:103]
v_mfma_f32_16x16x32_bf16 v[100:103],a[128:131],a[72:75],v[100:103]
v_mfma_f32_16x16x32_bf16 v[108:111],a[128:131],a[96:99],0
ds_read_b64_tr_b16 a[128:129],v4 offset:12288
v_mfma_f32_16x16x32_bf16 v[108:111],a[132:135],a[100:103],v[108:111]
ds_read_b64_tr_b16 a[130:131],v4 offset:18432
v_mfma_f32_16x16x32_bf16 v[108:111],a[136:139],a[104:107],v[108:111]
ds_read_b64_tr_b16 a[132:133],v5 offset:12288
v_mfma_f32_16x16x32_bf16 v[108:111],a[140:143],a[108:111],v[108:111]
ds_read_b64_tr_b16 a[134:135],v5 offset:18432
v_mfma_f32_16x16x32_bf16 v[108:111],a[144:147],a[112:115],v[108:111]
v_mfma_f32_16x16x32_bf16 v[108:111],a[148:151],a[116:119],v[108:111]
s_waitcnt lgkmcnt(4)
v_mfma_f32_16x16x32_bf16 v[160:163],a[120:123],v[44:47],v[160:163]
s_add_u32 m0,s23,12288
ds_read_b64_tr_b16 a[136:137],v2 offset:12416
v_fma_f32 v90,v90,s36,v15
v_mfma_f32_16x16x32_bf16 v[164:167],a[124:127],v[44:47],v[164:167]
ds_read_b64_tr_b16 a[138:139],v2 offset:18560
v_fma_f32 v91,v91,s36,v15
v_mfma_f32_16x16x32_bf16 v[212:215],a[124:127],v[48:51],v[212:215]
ds_read_b64_tr_b16 a[140:141],v3 offset:12416
v_fma_f32 v96,v96,s36,v16
v_mfma_f32_16x16x32_bf16 v[208:211],a[120:123],v[48:51],v[208:211]
ds_read_b64_tr_b16 a[142:143],v3 offset:18560
v_fma_f32 v97,v97,s36,v16
v_mfma_f32_16x16x32_bf16 v[112:115],a[120:123],v[52:55],v[112:115]
ds_read_b64_tr_b16 a[144:145],v4 offset:12416
v_fma_f32 v98,v98,s36,v16
v_mfma_f32_16x16x32_bf16 v[116:119],a[124:127],v[52:55],v[116:119]
ds_read_b64_tr_b16 a[146:147],v4 offset:18560
v_fma_f32 v99,v99,s36,v16
v_mfma_f32_16x16x32_bf16 a[164:167],a[124:127],v[56:59],a[164:167]
ds_read_b64_tr_b16 a[148:149],v5 offset:12416
v_fma_f32 v104,v104,s36,v17
v_mfma_f32_16x16x32_bf16 a[160:163],a[120:123],v[56:59],a[160:163]
ds_read_b64_tr_b16 a[150:151],v5 offset:18560
v_fma_f32 v105,v105,s36,v17
v_mfma_f32_16x16x32_bf16 a[208:211],a[120:123],v[40:43],a[208:211]
ds_read_b64_tr_b16 a[120:121],v2 offset:12544
v_fma_f32 v106,v106,s36,v17
v_mfma_f32_16x16x32_bf16 a[212:215],a[124:127],v[40:43],a[212:215]
s_waitcnt lgkmcnt(6)
ds_read_b64_tr_b16 a[122:123],v2 offset:18688
v_fma_f32 v107,v107,s36,v17
v_mfma_f32_16x16x32_bf16 a[216:219],a[128:131],v[40:43],a[216:219]
ds_read_b64_tr_b16 a[124:125],v3 offset:12544
v_fma_f32 v76,v76,s36,v13
v_mfma_f32_16x16x32_bf16 a[220:223],a[132:135],v[40:43],a[220:223]
ds_read_b64_tr_b16 a[126:127],v3 offset:18688
v_fma_f32 v77,v77,s36,v13
v_mfma_f32_16x16x32_bf16 a[172:175],a[132:135],v[56:59],a[172:175]
v_exp_f32 v90,v90
v_mfma_f32_16x16x32_bf16 a[168:171],a[128:131],v[56:59],a[168:171]
v_exp_f32 v91,v91
v_mfma_f32_16x16x32_bf16 v[120:123],a[128:131],v[52:55],v[120:123]
v_cvt_pk_bf16_f32 v29,v90,v91
v_fma_f32 v78,v78,s36,v13
v_mfma_f32_16x16x32_bf16 v[124:127],a[132:135],v[52:55],v[124:127]
v_exp_f32 v96,v96
v_mfma_f32_16x16x32_bf16 v[220:223],a[132:135],v[48:51],v[220:223]
v_exp_f32 v97,v97
v_mfma_f32_16x16x32_bf16 v[216:219],a[128:131],v[48:51],v[216:219]
v_exp_f32 v98,v98
v_mfma_f32_16x16x32_bf16 v[168:171],a[128:131],v[44:47],v[168:171]
ds_read_b64_tr_b16 a[128:129],v4 offset:12544
v_cvt_pk_bf16_f32 v32,v96,v97
v_mfma_f32_16x16x32_bf16 v[172:175],a[132:135],v[44:47],v[172:175]
ds_read_b64_tr_b16 a[130:131],v4 offset:18688
v_fma_f32 v79,v79,s36,v13
v_mfma_f32_16x16x32_bf16 v[176:179],a[136:139],v[44:47],v[176:179]
s_waitcnt lgkmcnt(2)
ds_read_b64_tr_b16 a[132:133],v5 offset:12544
v_fma_f32 v84,v84,s36,v14
v_mfma_f32_16x16x32_bf16 v[180:183],a[140:143],v[44:47],v[180:183]
ds_read_b64_tr_b16 a[134:135],v5 offset:18688
v_fma_f32 v85,v85,s36,v14
v_mfma_f32_16x16x32_bf16 v[228:231],a[140:143],v[48:51],v[228:231]
v_exp_f32 v99,v99
v_mfma_f32_16x16x32_bf16 v[224:227],a[136:139],v[48:51],v[224:227]
v_cvt_pk_bf16_f32 v33,v98,v99
v_fma_f32 v86,v86,s36,v14
v_mfma_f32_16x16x32_bf16 v[128:131],a[136:139],v[52:55],v[128:131]
v_exp_f32 v104,v104
v_mfma_f32_16x16x32_bf16 v[132:135],a[140:143],v[52:55],v[132:135]
v_exp_f32 v105,v105
v_mfma_f32_16x16x32_bf16 a[180:183],a[140:143],v[56:59],a[180:183]
v_exp_f32 v106,v106
v_mfma_f32_16x16x32_bf16 a[176:179],a[136:139],v[56:59],a[176:179]
v_exp_f32 v107,v107
v_mfma_f32_16x16x32_bf16 a[224:227],a[136:139],v[40:43],a[224:227]
v_cvt_pk_bf16_f32 v36,v104,v105
v_cvt_pk_bf16_f32 v37,v106,v107
v_mfma_f32_16x16x32_bf16 a[228:231],a[140:143],v[40:43],a[228:231]
v_exp_f32 v76,v76
v_mfma_f32_16x16x32_bf16 a[232:235],a[144:147],v[40:43],a[232:235]
v_exp_f32 v77,v77
v_mfma_f32_16x16x32_bf16 a[236:239],a[148:151],v[40:43],a[236:239]
v_exp_f32 v78,v78
v_mfma_f32_16x16x32_bf16 a[188:191],a[148:151],v[56:59],a[188:191]
v_exp_f32 v79,v79
v_mfma_f32_16x16x32_bf16 a[184:187],a[144:147],v[56:59],a[184:187]
v_cvt_pk_bf16_f32 v22,v76,v77
v_cvt_pk_bf16_f32 v23,v78,v79
v_mfma_f32_16x16x32_bf16 v[136:139],a[144:147],v[52:55],v[136:139]
v_fma_f32 v87,v87,s36,v14
v_fma_f32 v92,v92,s36,v15
v_mfma_f32_16x16x32_bf16 v[140:143],a[148:151],v[52:55],v[140:143]
v_exp_f32 v84,v84
v_mfma_f32_16x16x32_bf16 v[236:239],a[148:151],v[48:51],v[236:239]
v_exp_f32 v85,v85
v_mfma_f32_16x16x32_bf16 v[232:235],a[144:147],v[48:51],v[232:235]
v_exp_f32 v86,v86
v_mfma_f32_16x16x32_bf16 v[184:187],a[144:147],v[44:47],v[184:187]
v_exp_f32 v87,v87
v_mfma_f32_16x16x32_bf16 v[188:191],a[148:151],v[44:47],v[188:191]
v_cvt_pk_bf16_f32 v26,v84,v85
v_cvt_pk_bf16_f32 v27,v86,v87
v_mfma_f32_16x16x32_bf16 v[192:195],a[120:123],v[44:47],v[192:195]
v_fma_f32 v93,v93,s36,v15
v_fma_f32 v94,v94,s36,v15
v_smfmac_f32_16x16x64_bf16 v[60:63],a[152:155],v[20:27],v18
v_fma_f32 v95,v95,s36,v15
v_mfma_f32_16x16x32_bf16 v[196:199],a[124:127],v[44:47],v[196:199]
s_waitcnt vmcnt(6) lgkmcnt(0)
v_exp_f32 v92,v92
v_mfma_f32_16x16x32_bf16 v[244:247],a[124:127],v[48:51],v[244:247]
s_barrier
v_mfma_f32_16x16x32_bf16 v[240:243],a[120:123],v[48:51],v[240:243]
ds_read_b128 a[136:139],v0 offset:0
v_fma_f32 v100,v100,s36,v16
v_mfma_f32_16x16x32_bf16 v[144:147],a[120:123],v[52:55],v[144:147]
ds_read_b128 a[140:143],v1 offset:0
v_fma_f32 v101,v101,s36,v16
v_mfma_f32_16x16x32_bf16 v[148:151],a[124:127],v[52:55],v[148:151]
ds_read_b128 a[144:147],v0 offset:128
v_fma_f32 v102,v102,s36,v16
v_mfma_f32_16x16x32_bf16 a[196:199],a[124:127],v[56:59],a[196:199]
ds_read_b128 a[148:151],v1 offset:128
v_fma_f32 v103,v103,s36,v16
v_mfma_f32_16x16x32_bf16 a[192:195],a[120:123],v[56:59],a[192:195]
v_exp_f32 v93,v93
v_mfma_f32_16x16x32_bf16 a[240:243],a[120:123],v[40:43],a[240:243]
buffer_load_dwordx4 v6,s[8:11],s21 offen offset:0 lds
v_mfma_f32_16x16x32_bf16 a[244:247],a[124:127],v[40:43],a[244:247]
ds_read_b128 a[120:123],v0 offset:256
v_cvt_pk_bf16_f32 v30,v92,v93
v_mfma_f32_16x16x32_bf16 a[248:251],a[128:131],v[40:43],a[248:251]
ds_read_b128 a[124:127],v1 offset:256
v_fma_f32 v108,v108,s36,v17
v_mfma_f32_16x16x32_bf16 a[252:255],a[132:135],v[40:43],a[252:255]
v_exp_f32 v94,v94
v_mfma_f32_16x16x32_bf16 a[204:207],a[132:135],v[56:59],a[204:207]
v_exp_f32 v95,v95
v_mfma_f32_16x16x32_bf16 a[200:203],a[128:131],v[56:59],a[200:203]
v_cvt_pk_bf16_f32 v31,v94,v95
v_fma_f32 v109,v109,s36,v17
v_mfma_f32_16x16x32_bf16 v[152:155],a[128:131],v[52:55],v[152:155]
v_exp_f32 v100,v100
v_mfma_f32_16x16x32_bf16 v[156:159],a[132:135],v[52:55],v[156:159]
v_exp_f32 v101,v101
v_mfma_f32_16x16x32_bf16 v[252:255],a[132:135],v[48:51],v[252:255]
v_exp_f32 v102,v102
v_mfma_f32_16x16x32_bf16 v[248:251],a[128:131],v[48:51],v[248:251]
v_exp_f32 v103,v103
v_mfma_f32_16x16x32_bf16 v[200:203],a[128:131],v[44:47],v[200:203]
ds_read_b128 a[128:131],v0 offset:6144
v_cvt_pk_bf16_f32 v34,v100,v101
v_mfma_f32_16x16x32_bf16 v[204:207],a[132:135],v[44:47],v[204:207]
buffer_load_dwordx4 v7,s[8:11],s21 offen offset:1024 lds
s_waitcnt lgkmcnt(1)
v_mfma_f32_16x16x32_bf16 v[72:75],a[136:139],a[0:3],0
ds_read_b128 a[132:135],v1 offset:6144
v_cvt_pk_bf16_f32 v35,v102,v103
v_mfma_f32_16x16x32_bf16 v[72:75],a[140:143],a[4:7],v[72:75]
v_fma_f32 v110,v110,s36,v17
v_fma_f32 v111,v111,s36,v17
v_smfmac_f32_16x16x64_bf16 v[64:67],a[152:155],v[28:35],v18
v_mfma_f32_16x16x32_bf16 v[72:75],a[144:147],a[8:11],v[72:75]
v_exp_f32 v108,v108
v_mfma_f32_16x16x32_bf16 v[72:75],a[148:151],a[12:15],v[72:75]
v_exp_f32 v109,v109
v_mfma_f32_16x16x32_bf16 v[72:75],a[120:123],a[16:19],v[72:75]
v_exp_f32 v110,v110
v_mfma_f32_16x16x32_bf16 v[72:75],a[124:127],a[20:23],v[72:75]
v_exp_f32 v111,v111
v_mfma_f32_16x16x32_bf16 v[80:83],a[124:127],a[44:47],0
v_cvt_pk_bf16_f32 v38,v108,v109
v_cvt_pk_bf16_f32 v39,v110,v111
v_mfma_f32_16x16x32_bf16 v[80:83],a[120:123],a[40:43],v[80:83]
v_mfma_f32_16x16x32_bf16 v[80:83],a[148:151],a[36:39],v[80:83]
v_mfma_f32_16x16x32_bf16 v[80:83],a[144:147],a[32:35],v[80:83]
buffer_load_dwordx4 v8,s[8:11],s21 offen offset:2048 lds
v_mfma_f32_16x16x32_bf16 v[80:83],a[140:143],a[28:31],v[80:83]
s_add_u32 s21,s21,12288
v_fma_f32 v72,v72,s36,v13
v_fma_f32 v73,v73,s36,v13
v_mfma_f32_16x16x32_bf16 v[80:83],a[136:139],a[24:27],v[80:83]
s_add_u32 m0,s22,24576
v_fma_f32 v74,v74,s36,v13
v_fma_f32 v75,v75,s36,v13
v_mfma_f32_16x16x32_bf16 v[88:91],a[136:139],a[48:51],0
v_exp_f32 v72,v72
v_mfma_f32_16x16x32_bf16 v[88:91],a[140:143],a[52:55],v[88:91]
v_exp_f32 v73,v73
v_mfma_f32_16x16x32_bf16 v[88:91],a[144:147],a[56:59],v[88:91]
v_fma_f32 v80,v80,s36,v14
v_fma_f32 v81,v81,s36,v14
v_mfma_f32_16x16x32_bf16 v[88:91],a[148:151],a[60:63],v[88:91]
v_fma_f32 v82,v82,s36,v14
v_fma_f32 v83,v83,s36,v14
v_mfma_f32_16x16x32_bf16 v[88:91],a[120:123],a[64:67],v[88:91]
v_exp_f32 v74,v74
v_mfma_f32_16x16x32_bf16 v[88:91],a[124:127],a[68:71],v[88:91]
v_exp_f32 v75,v75
v_mfma_f32_16x16x32_bf16 v[96:99],a[124:127],a[92:95],0
v_exp_f32 v80,v80
v_mfma_f32_16x16x32_bf16 v[96:99],a[120:123],a[88:91],v[96:99]
v_exp_f32 v81,v81
v_mfma_f32_16x16x32_bf16 v[96:99],a[148:151],a[84:87],v[96:99]
v_exp_f32 v82,v82
v_mfma_f32_16x16x32_bf16 v[96:99],a[144:147],a[80:83],v[96:99]
buffer_load_dwordx4 v6,s[4:7],s20 offen offset:0 lds
v_mfma_f32_16x16x32_bf16 v[96:99],a[140:143],a[76:79],v[96:99]
v_fma_f32 v88,v88,s36,v15
v_fma_f32 v89,v89,s36,v15
v_mfma_f32_16x16x32_bf16 v[96:99],a[136:139],a[72:75],v[96:99]
v_exp_f32 v83,v83
v_mfma_f32_16x16x32_bf16 v[104:107],a[136:139],a[96:99],0
ds_read_b128 a[136:139],v0 offset:6272
v_cvt_pk_bf16_f32 v44,v72,v73
v_mfma_f32_16x16x32_bf16 v[104:107],a[140:143],a[100:103],v[104:107]
ds_read_b128 a[140:143],v1 offset:6272
v_cvt_pk_bf16_f32 v45,v74,v75
v_mfma_f32_16x16x32_bf16 v[104:107],a[144:147],a[104:107],v[104:107]
ds_read_b128 a[144:147],v0 offset:6400
v_cvt_pk_bf16_f32 v48,v80,v81
v_mfma_f32_16x16x32_bf16 v[104:107],a[148:151],a[108:111],v[104:107]
ds_read_b128 a[148:151],v1 offset:6400
v_cvt_pk_bf16_f32 v49,v82,v83
v_mfma_f32_16x16x32_bf16 v[104:107],a[120:123],a[112:115],v[104:107]
v_exp_f32 v88,v88
v_mfma_f32_16x16x32_bf16 v[104:107],a[124:127],a[116:119],v[104:107]
s_waitcnt lgkmcnt(4)
v_exp_f32 v89,v89
v_mfma_f32_16x16x32_bf16 v[76:79],a[128:131],a[0:3],0
v_cvt_pk_bf16_f32 v52,v88,v89
v_mfma_f32_16x16x32_bf16 v[76:79],a[132:135],a[4:7],v[76:79]
s_waitcnt lgkmcnt(3)
v_mfma_f32_16x16x32_bf16 v[76:79],a[136:139],a[8:11],v[76:79]
buffer_load_dwordx4 v7,s[4:7],s20 offen offset:1024 lds
s_waitcnt lgkmcnt(2)
v_mfma_f32_16x16x32_bf16 v[76:79],a[140:143],a[12:15],v[76:79]
s_waitcnt lgkmcnt(1)
v_mfma_f32_16x16x32_bf16 v[76:79],a[144:147],a[16:19],v[76:79]
s_waitcnt lgkmcnt(0)
v_mfma_f32_16x16x32_bf16 v[76:79],a[148:151],a[20:23],v[76:79]
v_mfma_f32_16x16x32_bf16 v[84:87],a[148:151],a[44:47],0
v_mfma_f32_16x16x32_bf16 v[84:87],a[144:147],a[40:43],v[84:87]
v_mfma_f32_16x16x32_bf16 v[84:87],a[140:143],a[36:39],v[84:87]
v_mfma_f32_16x16x32_bf16 v[84:87],a[136:139],a[32:35],v[84:87]
v_mfma_f32_16x16x32_bf16 v[84:87],a[132:135],a[28:31],v[84:87]
v_mfma_f32_16x16x32_bf16 v[84:87],a[128:131],a[24:27],v[84:87]
v_mfma_f32_16x16x32_bf16 v[92:95],a[128:131],a[48:51],0
v_mfma_f32_16x16x32_bf16 v[92:95],a[132:135],a[52:55],v[92:95]
buffer_load_dwordx4 v8,s[4:7],s20 offen offset:2048 lds
v_mfma_f32_16x16x32_bf16 v[92:95],a[136:139],a[56:59],v[92:95]
s_add_u32 s20,s20,12288
v_mfma_f32_16x16x32_bf16 v[92:95],a[140:143],a[60:63],v[92:95]
v_mfma_f32_16x16x32_bf16 v[92:95],a[144:147],a[64:67],v[92:95]
v_mfma_f32_16x16x32_bf16 v[92:95],a[148:151],a[68:71],v[92:95]
v_mfma_f32_16x16x32_bf16 v[100:103],a[148:151],a[92:95],0
v_mfma_f32_16x16x32_bf16 v[100:103],a[144:147],a[88:91],v[100:103]
ds_read_b64_tr_b16 a[120:121],v2 offset:24576
v_mfma_f32_16x16x32_bf16 v[100:103],a[140:143],a[84:87],v[100:103]
ds_read_b64_tr_b16 a[122:123],v2 offset:30720
v_mfma_f32_16x16x32_bf16 v[100:103],a[136:139],a[80:83],v[100:103]
ds_read_b64_tr_b16 a[124:125],v3 offset:24576
v_mfma_f32_16x16x32_bf16 v[100:103],a[132:135],a[76:79],v[100:103]
ds_read_b64_tr_b16 a[126:127],v3 offset:30720
v_mfma_f32_16x16x32_bf16 v[100:103],a[128:131],a[72:75],v[100:103]
v_mfma_f32_16x16x32_bf16 v[108:111],a[128:131],a[96:99],0
ds_read_b64_tr_b16 a[128:129],v4 offset:24576
v_mfma_f32_16x16x32_bf16 v[108:111],a[132:135],a[100:103],v[108:111]
ds_read_b64_tr_b16 a[130:131],v4 offset:30720
v_mfma_f32_16x16x32_bf16 v[108:111],a[136:139],a[104:107],v[108:111]
ds_read_b64_tr_b16 a[132:133],v5 offset:24576
v_mfma_f32_16x16x32_bf16 v[108:111],a[140:143],a[108:111],v[108:111]
ds_read_b64_tr_b16 a[134:135],v5 offset:30720
v_mfma_f32_16x16x32_bf16 v[108:111],a[144:147],a[112:115],v[108:111]
v_mfma_f32_16x16x32_bf16 v[108:111],a[148:151],a[116:119],v[108:111]
s_mov_b32 s38,0
s_branch L_loop5
L_tr44:
s_waitcnt vmcnt(43)
s_waitcnt lgkmcnt(3)
v_mfma_f32_16x16x32_bf16 v[160:163],a[120:123],v[20:23],v[160:163]
s_add_u32 m0,s24,0
ds_read_b128 a[4:7],v12 offset:0
v_fma_f32 v79,v79,s36,v13
v_mfma_f32_16x16x32_bf16 v[164:167],a[124:127],v[20:23],v[164:167]
ds_read_b128 a[12:15],v12 offset:128
v_fma_f32 v100,v100,s36,v16
v_mfma_f32_16x16x32_bf16 v[212:215],a[124:127],v[24:27],v[212:215]
ds_read_b128 a[20:23],v12 offset:256
v_fma_f32 v101,v101,s36,v16
v_mfma_f32_16x16x32_bf16 v[208:211],a[120:123],v[24:27],v[208:211]
ds_read_b128 a[8:11],v11 offset:128
v_fma_f32 v89,v89,s36,v15
v_mfma_f32_16x16x32_bf16 v[112:115],a[120:123],v[28:31],v[112:115]
ds_read_b128 a[0:3],v11 offset:0
v_fma_f32 v76,v76,s36,v13
v_mfma_f32_16x16x32_bf16 v[116:119],a[124:127],v[28:31],v[116:119]
ds_read_b128 a[16:19],v11 offset:256
v_fma_f32 v83,v83,s36,v14
v_mfma_f32_16x16x32_bf16 a[164:167],a[124:127],v[32:35],a[164:167]
ds_read_b64_tr_b16 a[138:139],v2 offset:30848
v_fma_f32 v90,v90,s36,v15
v_mfma_f32_16x16x32_bf16 a[160:163],a[120:123],v[32:35],a[160:163]
s_waitcnt lgkmcnt(6)
ds_read_b64_tr_b16 a[136:137],v2 offset:24704
v_fma_f32 v88,v88,s36,v15
v_mfma_f32_16x16x32_bf16 a[168:171],a[128:131],v[32:35],a[168:171]
ds_read_b64_tr_b16 a[142:143],v3 offset:30848
ds_read_b64_tr_b16 a[140:141],v3 offset:24704
ds_read_b64_tr_b16 a[146:147],v4 offset:30848
ds_read_b64_tr_b16 a[144:145],v4 offset:24704
ds_read_b64_tr_b16 a[150:151],v5 offset:30848
ds_read_b64_tr_b16 a[148:149],v5 offset:24704
ds_read_b128 a[32:35],v11 offset:6272
v_mfma_f32_16x16x32_bf16 a[172:175],a[132:135],v[32:35],a[172:175]
v_fma_f32 v91,v91,s36,v15
ds_read_b128 a[40:43],v11 offset:6400
v_mfma_f32_16x16x32_bf16 v[124:127],a[132:135],v[28:31],v[124:127]
s_waitcnt lgkmcnt(10)
buffer_load_dwordx4 v6,s[12:15],s28 offen offset:0 nt lds
v_mfma_f32_16x16x32_bf16 v[120:123],a[128:131],v[28:31],v[120:123]
ds_read_b64_tr_b16 a[122:123],v2 offset:30976
ds_read_b64_tr_b16 a[120:121],v2 offset:24832
ds_read_b64_tr_b16 a[124:125],v3 offset:24832
ds_read_b64_tr_b16 a[126:127],v3 offset:30976
ds_read_b128 a[44:47],v12 offset:6400
v_mfma_f32_16x16x32_bf16 v[216:219],a[128:131],v[24:27],v[216:219]
v_fma_f32 v93,v93,s36,v15
ds_read_b128 a[28:31],v12 offset:6144
v_mfma_f32_16x16x32_bf16 v[220:223],a[132:135],v[24:27],v[220:223]
v_fma_f32 v98,v98,s36,v16
ds_read_b128 a[36:39],v12 offset:6272
v_mfma_f32_16x16x32_bf16 v[172:175],a[132:135],v[20:23],v[172:175]
buffer_load_dwordx4 v7,s[12:15],s28 offen offset:1024 nt lds
v_mfma_f32_16x16x32_bf16 v[168:171],a[128:131],v[20:23],v[168:171]
s_waitcnt lgkmcnt(7)
ds_read_b64_tr_b16 a[130:131],v4 offset:30976
ds_read_b128 a[24:27],v11 offset:6144
v_mfma_f32_16x16x32_bf16 v[176:179],a[136:139],v[20:23],v[176:179]
v_fma_f32 v82,v82,s36,v14
v_exp_f32 v93,v93
v_mfma_f32_16x16x32_bf16 v[180:183],a[140:143],v[20:23],v[180:183]
ds_read_b64_tr_b16 a[128:129],v4 offset:24832
v_fma_f32 v85,v85,s36,v14
v_mfma_f32_16x16x32_bf16 v[228:231],a[140:143],v[24:27],v[228:231]
ds_read_b64_tr_b16 a[134:135],v5 offset:30976
v_exp_f32 v82,v82
v_mfma_f32_16x16x32_bf16 v[224:227],a[136:139],v[24:27],v[224:227]
ds_read_b64_tr_b16 a[132:133],v5 offset:24832
v_fma_f32 v84,v84,s36,v14
v_mfma_f32_16x16x32_bf16 v[128:131],a[136:139],v[28:31],v[128:131]
v_exp_f32 v84,v84
v_mfma_f32_16x16x32_bf16 v[132:135],a[140:143],v[28:31],v[132:135]
buffer_load_dwordx4 v8,s[12:15],s28 offen offset:2048 nt lds
v_mfma_f32_16x16x32_bf16 a[180:183],a[140:143],v[32:35],a[180:183]
s_add_u32 s28,s28,3072
v_fma_f32 v103,v103,s36,v16
v_exp_f32 v103,v103
v_mfma_f32_16x16x32_bf16 a[176:179],a[136:139],v[32:35],a[176:179]
s_add_u32 m0,s24,3072
v_fma_f32 v87,v87,s36,v14
v_exp_f32 v87,v87
v_mfma_f32_16x16x32_bf16 a[184:187],a[144:147],v[32:35],a[184:187]
v_fma_f32 v77,v77,s36,v13
v_exp_f32 v77,v77
v_mfma_f32_16x16x32_bf16 a[188:191],a[148:151],v[32:35],a[188:191]
v_fma_f32 v97,v97,s36,v16
v_exp_f32 v91,v91
v_mfma_f32_16x16x32_bf16 v[140:143],a[148:151],v[28:31],v[140:143]
v_fma_f32 v102,v102,s36,v16
v_exp_f32 v85,v85
v_mfma_f32_16x16x32_bf16 v[136:139],a[144:147],v[28:31],v[136:139]
v_exp_f32 v89,v89
v_mfma_f32_16x16x32_bf16 v[232:235],a[144:147],v[24:27],v[232:235]
buffer_load_dwordx4 v6,s[12:15],s28 offen offset:0 nt lds
v_mfma_f32_16x16x32_bf16 v[236:239],a[148:151],v[24:27],v[236:239]
v_fma_f32 v92,v92,s36,v15
v_exp_f32 v101,v101
v_mfma_f32_16x16x32_bf16 v[188:191],a[148:151],v[20:23],v[188:191]
v_fma_f32 v94,v94,s36,v15
v_fma_f32 v95,v95,s36,v15
v_mfma_f32_16x16x32_bf16 v[184:187],a[144:147],v[20:23],v[184:187]
s_waitcnt lgkmcnt(0)
v_exp_f32 v95,v95
v_mfma_f32_16x16x32_bf16 v[192:195],a[120:123],v[20:23],v[192:195]
v_fma_f32 v86,v86,s36,v14
v_fma_f32 v78,v78,s36,v13
v_mfma_f32_16x16x32_bf16 v[196:199],a[124:127],v[20:23],v[196:199]
v_exp_f32 v92,v92
v_mfma_f32_16x16x32_bf16 v[244:247],a[124:127],v[24:27],v[244:247]
v_exp_f32 v78,v78
v_mfma_f32_16x16x32_bf16 v[240:243],a[120:123],v[24:27],v[240:243]
buffer_load_dwordx4 v7,s[12:15],s28 offen offset:1024 nt lds
v_mfma_f32_16x16x32_bf16 v[144:147],a[120:123],v[28:31],v[144:147]
v_exp_f32 v94,v94
v_mfma_f32_16x16x32_bf16 v[148:151],a[124:127],v[28:31],v[148:151]
v_exp_f32 v90,v90
v_mfma_f32_16x16x32_bf16 a[196:199],a[124:127],v[32:35],a[196:199]
v_fma_f32 v96,v96,s36,v16
v_exp_f32 v96,v96
v_mfma_f32_16x16x32_bf16 a[192:195],a[120:123],v[32:35],a[192:195]
v_fma_f32 v99,v99,s36,v16
v_exp_f32 v83,v83
v_mfma_f32_16x16x32_bf16 a[200:203],a[128:131],v[32:35],a[200:203]
v_exp_f32 v97,v97
v_mfma_f32_16x16x32_bf16 a[204:207],a[132:135],v[32:35],a[204:207]
v_exp_f32 v88,v88
v_mfma_f32_16x16x32_bf16 v[156:159],a[132:135],v[28:31],v[156:159]
v_exp_f32 v98,v98
v_mfma_f32_16x16x32_bf16 v[152:155],a[128:131],v[28:31],v[152:155]
buffer_load_dwordx4 v8,s[12:15],s28 offen offset:2048 nt lds
s_waitcnt vmcnt(20)
s_barrier
v_mfma_f32_16x16x32_bf16 v[248:251],a[128:131],v[24:27],v[248:251]
s_add_u32 s28,s28,3072
ds_read_b64_tr_b16 a[138:139],v2 offset:6144
v_exp_f32 v79,v79
v_mfma_f32_16x16x32_bf16 v[252:255],a[132:135],v[24:27],v[252:255]
s_add_u32 m0,s22,0
ds_read_b64_tr_b16 a[136:137],v2 offset:0
buffer_load_dwordx4 v6,s[4:7],s25 offen offset:0 lds
v_mfma_f32_16x16x32_bf16 v[204:207],a[132:135],v[20:23],v[204:207]
buffer_load_dwordx4 v7,s[4:7],s25 offen offset:1024 lds
v_mfma_f32_16x16x32_bf16 v[200:203],a[128:131],v[20:23],v[200:203]
buffer_load_dwordx4 v8,s[4:7],s25 offen offset:2048 lds
ds_read_b64_tr_b16 a[142:143],v3 offset:6144
ds_read_b64_tr_b16 a[140:141],v3 offset:0
ds_read_b64_tr_b16 a[144:145],v4 offset:0
ds_read_b64_tr_b16 a[146:147],v4 offset:6144
ds_read_b64_tr_b16 a[148:149],v5 offset:0
ds_read_b64_tr_b16 a[150:151],v5 offset:6144
v_exp_f32 v100,v100
v_cvt_pk_bf16_f32 v47,v78,v79
v_cvt_pk_bf16_f32 v49,v82,v83
v_exp_f32 v76,v76
v_exp_f32 v102,v102
v_exp_f32 v86,v86
v_cvt_pk_bf16_f32 v59,v102,v103
v_exp_f32 v99,v99
v_cvt_pk_bf16_f32 v50,v84,v85
v_cvt_pk_bf16_f32 v57,v98,v99
v_cvt_pk_bf16_f32 v55,v94,v95
v_cvt_pk_bf16_f32 v54,v92,v93
v_cvt_pk_bf16_f32 v58,v100,v101
v_cvt_pk_bf16_f32 v51,v86,v87
v_cvt_pk_bf16_f32 v53,v90,v91
v_cvt_pk_bf16_f32 v46,v76,v77
v_cvt_pk_bf16_f32 v52,v88,v89
v_cvt_pk_bf16_f32 v56,v96,v97
v_smfmac_f32_16x16x64_bf16 v[60:63],a[152:155],v[44:51],v18
v_subrev_u32 v10,18432,v10
v_smfmac_f32_16x16x64_bf16 v[64:67],a[152:155],v[52:59],v18
s_waitcnt lgkmcnt(0)
v_mfma_f32_16x16x32_bf16 v[160:163],a[136:139],v[44:47],v[160:163]
s_add_u32 s87,s42,18432
ds_read_b64_tr_b16 a[120:121],v2 offset:128
v_mbcnt_lo_u32_b32 v39,-1,0
v_mfma_f32_16x16x32_bf16 v[164:167],a[140:143],v[44:47],v[164:167]
ds_read_b64_tr_b16 a[122:123],v2 offset:6272
v_mbcnt_hi_u32_b32 v39,-1,v39
v_mfma_f32_16x16x32_bf16 v[212:215],a[140:143],v[48:51],v[212:215]
ds_read_b64_tr_b16 a[124:125],v3 offset:128
v_and_b32 v38,7,v39
v_mfma_f32_16x16x32_bf16 v[208:211],a[136:139],v[48:51],v[208:211]
ds_read_b64_tr_b16 a[126:127],v3 offset:6272
v_add_f32 v60,v60,v61
v_mfma_f32_16x16x32_bf16 v[112:115],a[136:139],v[52:55],v[112:115]
ds_read_b64_tr_b16 a[128:129],v4 offset:128
v_add_f32 v62,v62,v63
v_mfma_f32_16x16x32_bf16 v[116:119],a[140:143],v[52:55],v[116:119]
ds_read_b64_tr_b16 a[130:131],v4 offset:6272
ds_read_b64_tr_b16 a[132:133],v5 offset:128
ds_read_b64_tr_b16 a[134:135],v5 offset:6272
v_mfma_f32_16x16x32_bf16 a[164:167],a[140:143],v[56:59],a[164:167]
ds_read_b64_tr_b16 a[140:141],v3 offset:256
v_add_f32 v64,v64,v65
v_mfma_f32_16x16x32_bf16 a[160:163],a[136:139],v[56:59],a[160:163]
ds_read_b64_tr_b16 a[136:137],v2 offset:256
v_add_f32 v66,v66,v67
v_mfma_f32_16x16x32_bf16 a[168:171],a[144:147],v[56:59],a[168:171]
ds_read_b64_tr_b16 a[138:139],v2 offset:6400
v_max3_f32 v19,v60,v62,v64
v_mfma_f32_16x16x32_bf16 a[172:175],a[148:151],v[56:59],a[172:175]
ds_read_b64_tr_b16 a[142:143],v3 offset:6400
v_max_f32 v19,v19,v66
v_mfma_f32_16x16x32_bf16 v[124:127],a[148:151],v[52:55],v[124:127]
v_rcp_f32 v66,v66
v_mfma_f32_16x16x32_bf16 v[120:123],a[144:147],v[52:55],v[120:123]
v_accvgpr_read_b32 v80,a164
v_accvgpr_read_b32 v81,a165
v_mfma_f32_16x16x32_bf16 v[216:219],a[144:147],v[48:51],v[216:219]
v_accvgpr_read_b32 v82,a166
v_accvgpr_read_b32 v83,a167
v_mfma_f32_16x16x32_bf16 v[220:223],a[148:151],v[48:51],v[220:223]
v_accvgpr_read_b32 v72,a160
v_accvgpr_read_b32 v73,a161
v_mfma_f32_16x16x32_bf16 v[172:175],a[148:151],v[44:47],v[172:175]
ds_read_b64_tr_b16 a[148:149],v5 offset:256
v_accvgpr_read_b32 v74,a162
v_mfma_f32_16x16x32_bf16 v[168:171],a[144:147],v[44:47],v[168:171]
s_waitcnt lgkmcnt(2)
ds_read_b64_tr_b16 a[144:145],v4 offset:256
v_accvgpr_read_b32 v75,a163
v_mfma_f32_16x16x32_bf16 v[176:179],a[120:123],v[44:47],v[176:179]
ds_read_b64_tr_b16 a[146:147],v4 offset:6400
v_accvgpr_read_b32 v88,a168
v_mfma_f32_16x16x32_bf16 v[180:183],a[124:127],v[44:47],v[180:183]
ds_read_b64_tr_b16 a[150:151],v5 offset:6400
v_accvgpr_read_b32 v89,a169
v_mfma_f32_16x16x32_bf16 v[228:231],a[124:127],v[48:51],v[228:231]
v_accvgpr_read_b32 v90,a170
v_accvgpr_read_b32 v91,a171
v_mfma_f32_16x16x32_bf16 v[224:227],a[120:123],v[48:51],v[224:227]
v_accvgpr_read_b32 v96,a172
v_accvgpr_read_b32 v97,a173
v_mfma_f32_16x16x32_bf16 v[128:131],a[120:123],v[52:55],v[128:131]
v_accvgpr_read_b32 v98,a174
v_accvgpr_read_b32 v99,a175
v_mfma_f32_16x16x32_bf16 v[132:135],a[124:127],v[52:55],v[132:135]
v_cmp_ngt_f32 vcc,s37,v19
v_lshrrev_b32 v19,5,v39
v_mfma_f32_16x16x32_bf16 a[180:183],a[124:127],v[56:59],a[180:183]
v_xor_b32 v38,v38,v19
v_and_b32 v19,15,v39
v_mfma_f32_16x16x32_bf16 a[176:179],a[120:123],v[56:59],a[176:179]
s_cmp_lg_u64 vcc,0
v_lshl_add_u32 v19,v19,7,s24
v_lshl_add_u32 v19,v38,4,v19
v_mfma_f32_16x16x32_bf16 a[184:187],a[128:131],v[56:59],a[184:187]
s_cselect_b32 s62,s32,0
v_bfe_u32 v38,v39,4,1
v_lshl_add_u32 v36,v38,3,v19
v_mfma_f32_16x16x32_bf16 a[188:191],a[132:135],v[56:59],a[188:191]
s_or_b32 s31,s31,s62
v_xor_b32 v37,32,v36
v_bfe_u32 v19,v39,3,1
v_mfma_f32_16x16x32_bf16 v[140:143],a[132:135],v[52:55],v[140:143]
s_lshl_b32 s32,s32,1
v_xor_b32 v38,64,v36
v_xor_b32 v39,96,v36
v_lshlrev_b32 v19,11,v19
v_accvgpr_read_b32 v84,a180
v_accvgpr_read_b32 v85,a181
v_pk_mul_f32 v[72:73],v[72:73],v[66:67] op_sel_hi:[1,0]
v_pk_mul_f32 v[74:75],v[74:75],v[66:67] op_sel_hi:[1,0]
v_pk_mul_f32 v[80:81],v[80:81],v[66:67] op_sel_hi:[1,0]
v_pk_mul_f32 v[82:83],v[82:83],v[66:67] op_sel_hi:[1,0]
v_pk_mul_f32 v[84:85],v[84:85],v[66:67] op_sel_hi:[1,0]
v_accvgpr_read_b32 v86,a182
v_accvgpr_read_b32 v87,a183
v_pk_mul_f32 v[86:87],v[86:87],v[66:67] op_sel_hi:[1,0]
v_accvgpr_read_b32 v76,a176
v_accvgpr_read_b32 v77,a177
v_pk_mul_f32 v[76:77],v[76:77],v[66:67] op_sel_hi:[1,0]
v_accvgpr_read_b32 v78,a178
v_accvgpr_read_b32 v79,a179
v_pk_mul_f32 v[78:79],v[78:79],v[66:67] op_sel_hi:[1,0]
v_accvgpr_read_b32 v92,a184
v_accvgpr_read_b32 v93,a185
v_mfma_f32_16x16x32_bf16 v[136:139],a[128:131],v[52:55],v[136:139]
s_add_u32 m0,s23,0
v_accvgpr_read_b32 v94,a186
v_accvgpr_read_b32 v95,a187
v_accvgpr_read_b32 v100,a188
v_accvgpr_read_b32 v101,a189
v_accvgpr_read_b32 v102,a190
v_pk_mul_f32 v[88:89],v[88:89],v[66:67] op_sel_hi:[1,0]
v_pk_mul_f32 v[90:91],v[90:91],v[66:67] op_sel_hi:[1,0]
v_pk_mul_f32 v[92:93],v[92:93],v[66:67] op_sel_hi:[1,0]
v_pk_mul_f32 v[94:95],v[94:95],v[66:67] op_sel_hi:[1,0]
v_accvgpr_read_b32 v103,a191
v_cvt_pk_bf16_f32 v72,v72,v73
v_mfma_f32_16x16x32_bf16 v[232:235],a[128:131],v[48:51],v[232:235]
v_cvt_pk_bf16_f32 v76,v76,v77
v_cvt_pk_bf16_f32 v80,v80,v81
v_cvt_pk_bf16_f32 v84,v84,v85
v_cvt_pk_bf16_f32 v73,v74,v75
v_cvt_pk_bf16_f32 v77,v78,v79
ds_write2st64_b64 v36,v[72:73],v[76:77] offset0:36 offset1:40
v_pk_mul_f32 v[96:97],v[96:97],v[66:67] op_sel_hi:[1,0]
v_pk_mul_f32 v[98:99],v[98:99],v[66:67] op_sel_hi:[1,0]
v_pk_mul_f32 v[100:101],v[100:101],v[66:67] op_sel_hi:[1,0]
v_pk_mul_f32 v[102:103],v[102:103],v[66:67] op_sel_hi:[1,0]
v_cvt_pk_bf16_f32 v88,v88,v89
v_cvt_pk_bf16_f32 v92,v92,v93
v_mfma_f32_16x16x32_bf16 v[236:239],a[132:135],v[48:51],v[236:239]
v_cvt_pk_bf16_f32 v81,v82,v83
v_cvt_pk_bf16_f32 v85,v86,v87
v_mfma_f32_16x16x32_bf16 v[188:191],a[132:135],v[44:47],v[188:191]
v_cvt_pk_bf16_f32 v96,v96,v97
v_cvt_pk_bf16_f32 v100,v100,v101
v_mfma_f32_16x16x32_bf16 v[184:187],a[128:131],v[44:47],v[184:187]
ds_write2st64_b64 v37,v[80:81],v[84:85] offset0:36 offset1:40
v_mfma_f32_16x16x32_bf16 v[192:195],a[136:139],v[44:47],v[192:195]
s_waitcnt lgkmcnt(1)
v_cvt_pk_bf16_f32 v89,v90,v91
v_cvt_pk_bf16_f32 v93,v94,v95
v_mfma_f32_16x16x32_bf16 v[196:199],a[140:143],v[44:47],v[196:199]
v_cvt_pk_bf16_f32 v97,v98,v99
v_cvt_pk_bf16_f32 v101,v102,v103
v_mfma_f32_16x16x32_bf16 v[244:247],a[140:143],v[48:51],v[244:247]
v_rcp_f32 v62,v62
v_mfma_f32_16x16x32_bf16 v[240:243],a[136:139],v[48:51],v[240:243]
ds_write2st64_b64 v38,v[88:89],v[92:93] offset0:36 offset1:40
v_mfma_f32_16x16x32_bf16 v[144:147],a[136:139],v[52:55],v[144:147]
v_rcp_f32 v64,v64
v_mfma_f32_16x16x32_bf16 v[148:151],a[140:143],v[52:55],v[148:151]
v_rcp_f32 v60,v60
v_mfma_f32_16x16x32_bf16 a[196:199],a[140:143],v[56:59],a[196:199]
v_mfma_f32_16x16x32_bf16 a[192:195],a[136:139],v[56:59],a[192:195]
ds_write2st64_b64 v39,v[96:97],v[100:101] offset0:36 offset1:40
v_mfma_f32_16x16x32_bf16 a[200:203],a[144:147],v[56:59],a[200:203]
v_mfma_f32_16x16x32_bf16 a[204:207],a[148:151],v[56:59],a[204:207]
ds_read_b128 v[104:107],v10 offset:18432
v_mfma_f32_16x16x32_bf16 v[156:159],a[148:151],v[52:55],v[156:159]
s_waitcnt vmcnt(15)
ds_read_b128 a[68:71],v12 offset:12544
v_accvgpr_read_b32 v84,a196
ds_read_b128 a[64:67],v11 offset:12544
v_accvgpr_read_b32 v85,a197
ds_read_b128 a[60:63],v12 offset:12416
v_pk_mul_f32 v[84:85],v[84:85],v[66:67] op_sel_hi:[1,0]
ds_read_b128 a[56:59],v11 offset:12416
v_accvgpr_read_b32 v86,a198
ds_read_b128 a[52:55],v12 offset:12288
v_accvgpr_read_b32 v87,a199
ds_read_b128 a[48:51],v11 offset:12288
v_pk_mul_f32 v[86:87],v[86:87],v[66:67] op_sel_hi:[1,0]
ds_read_b128 v[108:111],v10 offset:19456
s_waitcnt lgkmcnt(7)
buffer_store_dwordx4 v[104:107],v9,s[16:19],s87 offen offset:0 nt
ds_read_b128 v[72:75],v10 offset:20480
v_accvgpr_read_b32 v80,a192
ds_read_b128 v[76:79],v10 offset:21504
v_accvgpr_read_b32 v81,a193
v_pk_mul_f32 v[80:81],v[80:81],v[66:67] op_sel_hi:[1,0]
v_accvgpr_read_b32 v82,a194
v_accvgpr_read_b32 v83,a195
v_pk_mul_f32 v[82:83],v[82:83],v[66:67] op_sel_hi:[1,0]
v_accvgpr_read_b32 v88,a200
v_accvgpr_read_b32 v89,a201
v_mfma_f32_16x16x32_bf16 v[152:155],a[144:147],v[52:55],v[152:155]
v_accvgpr_read_b32 v90,a202
v_accvgpr_read_b32 v91,a203
v_accvgpr_read_b32 v92,a204
v_accvgpr_read_b32 v93,a205
v_accvgpr_read_b32 v94,a206
v_pk_mul_f32 v[88:89],v[88:89],v[66:67] op_sel_hi:[1,0]
v_pk_mul_f32 v[90:91],v[90:91],v[66:67] op_sel_hi:[1,0]
v_accvgpr_read_b32 v95,a207
v_cvt_pk_bf16_f32 v80,v80,v81
v_mfma_f32_16x16x32_bf16 v[248:251],a[144:147],v[48:51],v[248:251]
s_waitcnt lgkmcnt(1)
v_cvt_pk_bf16_f32 v81,v82,v83
ds_write_b64 v36,v[80:81] offset:18432
buffer_store_dwordx4 v[108:111],v9,s[16:19],s87 offen offset:3072 nt
v_pk_mul_f32 v[92:93],v[92:93],v[66:67] op_sel_hi:[1,0]
v_pk_mul_f32 v[94:95],v[94:95],v[66:67] op_sel_hi:[1,0]
v_pk_mul_f32 v[208:209],v[208:209],v[62:63] op_sel_hi:[1,0]
v_pk_mul_f32 v[210:211],v[210:211],v[62:63] op_sel_hi:[1,0]
v_pk_mul_f32 v[224:225],v[224:225],v[62:63] op_sel_hi:[1,0]
v_pk_mul_f32 v[226:227],v[226:227],v[62:63] op_sel_hi:[1,0]
v_pk_mul_f32 v[212:213],v[212:213],v[62:63] op_sel_hi:[1,0]
v_pk_mul_f32 v[214:215],v[214:215],v[62:63] op_sel_hi:[1,0]
v_pk_mul_f32 v[228:229],v[228:229],v[62:63] op_sel_hi:[1,0]
v_pk_mul_f32 v[230:231],v[230:231],v[62:63] op_sel_hi:[1,0]
v_pk_mul_f32 v[216:217],v[216:217],v[62:63] op_sel_hi:[1,0]
buffer_store_dwordx4 v[72:75],v9,s[16:19],s87 offen offset:128 nt
v_pk_mul_f32 v[218:219],v[218:219],v[62:63] op_sel_hi:[1,0]
v_pk_mul_f32 v[232:233],v[232:233],v[62:63] op_sel_hi:[1,0]
v_pk_mul_f32 v[234:235],v[234:235],v[62:63] op_sel_hi:[1,0]
v_pk_mul_f32 v[220:221],v[220:221],v[62:63] op_sel_hi:[1,0]
v_pk_mul_f32 v[222:223],v[222:223],v[62:63] op_sel_hi:[1,0]
v_pk_mul_f32 v[236:237],v[236:237],v[62:63] op_sel_hi:[1,0]
v_pk_mul_f32 v[238:239],v[238:239],v[62:63] op_sel_hi:[1,0]
v_add_u32 v36,v36,v19
v_cvt_pk_bf16_f32 v84,v84,v85
v_mfma_f32_16x16x32_bf16 v[252:255],a[148:151],v[48:51],v[252:255]
v_cvt_pk_bf16_f32 v88,v88,v89
v_cvt_pk_bf16_f32 v85,v86,v87
v_mfma_f32_16x16x32_bf16 v[204:207],a[148:151],v[44:47],v[204:207]
s_waitcnt lgkmcnt(0)
ds_write_b64 v37,v[84:85] offset:18432
buffer_store_dwordx4 v[76:79],v9,s[16:19],s87 offen offset:3200 nt
v_pk_mul_f32 v[240:241],v[240:241],v[62:63] op_sel_hi:[1,0]
v_pk_mul_f32 v[242:243],v[242:243],v[62:63] op_sel_hi:[1,0]
v_pk_mul_f32 v[112:113],v[112:113],v[64:65] op_sel_hi:[1,0]
v_pk_mul_f32 v[114:115],v[114:115],v[64:65] op_sel_hi:[1,0]
v_add_u32 v37,v37,v19
v_cvt_pk_bf16_f32 v92,v92,v93
v_mfma_f32_16x16x32_bf16 v[200:203],a[144:147],v[44:47],v[200:203]
v_cvt_pk_bf16_f32 v89,v90,v91
ds_write_b64 v38,v[88:89] offset:18432
v_add_u32 v38,v38,v19
v_cvt_pk_bf16_f32 v93,v94,v95
v_cvt_pk_bf16_f32 v208,v208,v209
v_cvt_pk_bf16_f32 v224,v224,v225
ds_write_b64 v39,v[92:93] offset:18432
ds_read_b128 v[96:99],v10 offset:18432
v_add_u32 v39,v39,v19
ds_read_b128 v[100:103],v10 offset:19456
v_cvt_pk_bf16_f32 v212,v212,v213
v_cvt_pk_bf16_f32 v228,v228,v229
v_cvt_pk_bf16_f32 v209,v210,v211
v_cvt_pk_bf16_f32 v225,v226,v227
ds_write2st64_b64 v36,v[208:209],v[224:225] offset0:12 offset1:14
v_cvt_pk_bf16_f32 v216,v216,v217
v_cvt_pk_bf16_f32 v232,v232,v233
v_cvt_pk_bf16_f32 v213,v214,v215
v_cvt_pk_bf16_f32 v229,v230,v231
v_cvt_pk_bf16_f32 v220,v220,v221
v_cvt_pk_bf16_f32 v236,v236,v237
v_cvt_pk_bf16_f32 v217,v218,v219
v_cvt_pk_bf16_f32 v233,v234,v235
s_waitcnt vmcnt(4)
s_barrier
s_waitcnt lgkmcnt(2)
buffer_store_dwordx4 v[96:99],v9,s[16:19],s87 offen offset:256 nt
ds_read_b128 a[140:143],v1 offset:256
v_cvt_pk_bf16_f32 v240,v240,v241
ds_read_b128 a[136:139],v0 offset:256
v_cvt_pk_bf16_f32 v112,v112,v113
ds_read_b128 a[132:135],v1 offset:128
v_cvt_pk_bf16_f32 v221,v222,v223
ds_write2st64_b64 v37,v[212:213],v[228:229] offset0:12 offset1:14
v_cvt_pk_bf16_f32 v237,v238,v239
v_cvt_pk_bf16_f32 v241,v242,v243
v_cvt_pk_bf16_f32 v113,v114,v115
buffer_load_dwordx4 v6,s[8:11],s25 offen offset:0 lds
ds_read_b128 a[128:131],v0 offset:128
s_waitcnt lgkmcnt(5)
buffer_store_dwordx4 v[100:103],v9,s[16:19],s87 offen offset:3328 nt
ds_read_b128 a[124:127],v1 offset:0
v_mov_b32 v66,0
ds_read_b128 a[120:123],v0 offset:0
s_waitcnt lgkmcnt(5)
v_mfma_f32_16x16x32_bf16 v[72:75],a[140:143],a[20:23],0
v_mov_b32 v67,0
ds_read_b128 a[144:147],v0 offset:6144
v_mfma_f32_16x16x32_bf16 v[72:75],a[136:139],a[16:19],v[72:75]
ds_write2st64_b64 v38,v[216:217],v[232:233] offset0:12 offset1:14
v_pk_mul_f32 v[244:245],v[244:245],v[62:63] op_sel_hi:[1,0]
v_pk_mul_f32 v[246:247],v[246:247],v[62:63] op_sel_hi:[1,0]
v_pk_mul_f32 v[116:117],v[116:117],v[64:65] op_sel_hi:[1,0]
buffer_load_dwordx4 v7,s[8:11],s25 offen offset:1024 lds
ds_read_b128 a[148:151],v1 offset:6144
v_pk_mul_f32 v[118:119],v[118:119],v[64:65] op_sel_hi:[1,0]
v_cvt_pk_bf16_f32 v244,v244,v245
v_cvt_pk_bf16_f32 v116,v116,v117
s_waitcnt lgkmcnt(4)
v_mfma_f32_16x16x32_bf16 v[72:75],a[132:135],a[12:15],v[72:75]
ds_write2st64_b64 v39,v[220:221],v[236:237] offset0:12 offset1:14
v_mfma_f32_16x16x32_bf16 v[72:75],a[128:131],a[8:11],v[72:75]
v_cvt_pk_bf16_f32 v245,v246,v247
v_cvt_pk_bf16_f32 v117,v118,v119
v_mfma_f32_16x16x32_bf16 v[72:75],a[124:127],a[4:7],v[72:75]
s_waitcnt lgkmcnt(2)
v_mfma_f32_16x16x32_bf16 v[72:75],a[120:123],a[0:3],v[72:75]
ds_write2st64_b64 v36,v[240:241],v[112:113] offset0:16 offset1:24
v_pk_mul_f32 v[248:249],v[248:249],v[62:63] op_sel_hi:[1,0]
v_pk_mul_f32 v[250:251],v[250:251],v[62:63] op_sel_hi:[1,0]
v_pk_mul_f32 v[120:121],v[120:121],v[64:65] op_sel_hi:[1,0]
buffer_load_dwordx4 v8,s[8:11],s25 offen offset:2048 lds
v_pk_mul_f32 v[122:123],v[122:123],v[64:65] op_sel_hi:[1,0]
v_cvt_pk_bf16_f32 v248,v248,v249
v_cvt_pk_bf16_f32 v120,v120,v121
v_mfma_f32_16x16x32_bf16 v[80:83],a[120:123],a[24:27],0
s_waitcnt vmcnt(12)
ds_read_b128 a[72:75],v11 offset:0
v_max3_f32 v44,v72,v73,v74
v_mfma_f32_16x16x32_bf16 v[80:83],a[124:127],a[28:31],v[80:83]
s_mov_b32 s27,s42
ds_read_b128 a[76:79],v12 offset:0
v_cvt_pk_bf16_f32 v249,v250,v251
v_mfma_f32_16x16x32_bf16 v[80:83],a[128:131],a[32:35],v[80:83]
s_mov_b32 s42,s41
ds_read_b128 a[80:83],v11 offset:128
v_cvt_pk_bf16_f32 v121,v122,v123
ds_read_b128 a[84:87],v12 offset:128
v_pk_mul_f32 v[252:253],v[252:253],v[62:63] op_sel_hi:[1,0]
ds_read_b128 a[88:91],v11 offset:256
v_pk_mul_f32 v[254:255],v[254:255],v[62:63] op_sel_hi:[1,0]
ds_read_b128 a[92:95],v12 offset:256
v_pk_mul_f32 v[124:125],v[124:125],v[64:65] op_sel_hi:[1,0]
ds_write2st64_b64 v37,v[244:245],v[116:117] offset0:16 offset1:24
v_pk_mul_f32 v[126:127],v[126:127],v[64:65] op_sel_hi:[1,0]
v_cvt_pk_bf16_f32 v252,v252,v253
v_cvt_pk_bf16_f32 v124,v124,v125
v_mfma_f32_16x16x32_bf16 v[80:83],a[132:135],a[36:39],v[80:83]
s_add_u32 s69,s69,1
v_cvt_pk_bf16_f32 v253,v254,v255
v_cvt_pk_bf16_f32 v125,v126,v127
v_mfma_f32_16x16x32_bf16 v[80:83],a[136:139],a[40:43],v[80:83]
s_lshl_b32 s62,s69,5
v_mov_b32 v62,0
v_mov_b32 v63,0
v_mfma_f32_16x16x32_bf16 v[80:83],a[140:143],a[44:47],v[80:83]
s_add_u32 s62,s62,s34
ds_write2st64_b64 v38,v[248:249],v[120:121] offset0:16 offset1:24
v_pk_mul_f32 v[128:129],v[128:129],v[64:65] op_sel_hi:[1,0]
v_pk_mul_f32 v[130:131],v[130:131],v[64:65] op_sel_hi:[1,0]
v_pk_mul_f32 v[144:145],v[144:145],v[64:65] op_sel_hi:[1,0]
v_pk_mul_f32 v[146:147],v[146:147],v[64:65] op_sel_hi:[1,0]
v_cvt_pk_bf16_f32 v128,v128,v129
v_cvt_pk_bf16_f32 v144,v144,v145
v_mfma_f32_16x16x32_bf16 v[88:91],a[140:143],a[68:71],0
s_mul_i32 s63,s62,171
v_max3_f32 v48,v80,v81,v82
v_cvt_pk_bf16_f32 v129,v130,v131
v_mfma_f32_16x16x32_bf16 v[88:91],a[136:139],a[64:67],v[88:91]
s_lshr_b32 s63,s63,9
v_cvt_pk_bf16_f32 v145,v146,v147
s_mul_i32 s64,s63,3
v_mfma_f32_16x16x32_bf16 v[88:91],a[132:135],a[60:63],v[88:91]
s_sub_u32 s62,s62,s64
ds_write2st64_b64 v39,v[252:253],v[124:125] offset0:16 offset1:24
v_pk_mul_f32 v[132:133],v[132:133],v[64:65] op_sel_hi:[1,0]
v_pk_mul_f32 v[134:135],v[134:135],v[64:65] op_sel_hi:[1,0]
v_pk_mul_f32 v[148:149],v[148:149],v[64:65] op_sel_hi:[1,0]
v_pk_mul_f32 v[150:151],v[150:151],v[64:65] op_sel_hi:[1,0]
v_cvt_pk_bf16_f32 v132,v132,v133
v_cvt_pk_bf16_f32 v148,v148,v149
v_mfma_f32_16x16x32_bf16 v[88:91],a[128:131],a[56:59],v[88:91]
s_add_u32 s63,s63,s33
v_cvt_pk_bf16_f32 v133,v134,v135
v_cvt_pk_bf16_f32 v149,v150,v151
v_mfma_f32_16x16x32_bf16 v[88:91],a[124:127],a[52:55],v[88:91]
s_mul_i32 s30,s63,196608
s_mul_i32 s41,s63,325632
ds_write2st64_b64 v36,v[128:129],v[144:145] offset0:26 offset1:28
v_mfma_f32_16x16x32_bf16 v[88:91],a[120:123],a[48:51],v[88:91]
s_lshl_b32 s63,s3,2
s_add_u32 s64,s63,21
s_cmp_eq_u32 s3,0
s_waitcnt lgkmcnt(2)
v_mfma_f32_16x16x32_bf16 v[96:99],a[120:123],a[72:75],0
s_cselect_b32 s64,20,s64
ds_read_b128 a[120:123],v0 offset:6272
s_cselect_b32 s40,1,0
s_add_u32 s65,s63,37
s_cmp_eq_u32 s62,2
v_max3_f32 v52,v88,v89,v90
ds_write2st64_b64 v37,v[132:133],v[148:149] offset0:26 offset1:28
v_pk_mul_f32 v[136:137],v[136:137],v[64:65] op_sel_hi:[1,0]
v_pk_mul_f32 v[138:139],v[138:139],v[64:65] op_sel_hi:[1,0]
v_pk_mul_f32 v[152:153],v[152:153],v[64:65] op_sel_hi:[1,0]
v_pk_mul_f32 v[154:155],v[154:155],v[64:65] op_sel_hi:[1,0]
v_cvt_pk_bf16_f32 v136,v136,v137
v_cvt_pk_bf16_f32 v152,v152,v153
v_mfma_f32_16x16x32_bf16 v[96:99],a[124:127],a[76:79],v[96:99]
s_cselect_b32 s64,s65,s64
ds_read_b128 a[124:127],v1 offset:6272
v_cvt_pk_bf16_f32 v137,v138,v139
v_mfma_f32_16x16x32_bf16 v[96:99],a[128:131],a[80:83],v[96:99]
s_cselect_b32 s40,0,s40
ds_read_b128 a[128:131],v0 offset:6400
v_cvt_pk_bf16_f32 v153,v154,v155
v_mfma_f32_16x16x32_bf16 v[96:99],a[132:135],a[84:87],v[96:99]
s_add_u32 s65,s63,s3
ds_write2st64_b64 v38,v[136:137],v[152:153] offset0:26 offset1:28
v_pk_mul_f32 v[140:141],v[140:141],v[64:65] op_sel_hi:[1,0]
v_pk_mul_f32 v[142:143],v[142:143],v[64:65] op_sel_hi:[1,0]
v_pk_mul_f32 v[156:157],v[156:157],v[64:65] op_sel_hi:[1,0]
ds_read_b128 a[132:135],v1 offset:6400
v_pk_mul_f32 v[158:159],v[158:159],v[64:65] op_sel_hi:[1,0]
v_cvt_pk_bf16_f32 v140,v140,v141
v_cvt_pk_bf16_f32 v156,v156,v157
v_mfma_f32_16x16x32_bf16 v[96:99],a[136:139],a[88:91],v[96:99]
s_cmp_eq_u32 s62,0
ds_read_b128 a[136:139],v0 offset:12288
v_cvt_pk_bf16_f32 v141,v142,v143
v_mfma_f32_16x16x32_bf16 v[96:99],a[140:143],a[92:95],v[96:99]
s_cselect_b32 s64,s65,s64
ds_read_b128 a[140:143],v1 offset:12288
v_cvt_pk_bf16_f32 v157,v158,v159
v_mfma_f32_16x16x32_bf16 v[76:79],a[144:147],a[0:3],0
s_cselect_b32 s40,1,s40
ds_write2st64_b64 v39,v[140:141],v[156:157] offset0:26 offset1:28
v_pk_mul_f32 v[160:161],v[160:161],v[60:61] op_sel_hi:[1,0]
v_pk_mul_f32 v[162:163],v[162:163],v[60:61] op_sel_hi:[1,0]
v_pk_mul_f32 v[176:177],v[176:177],v[60:61] op_sel_hi:[1,0]
v_pk_mul_f32 v[178:179],v[178:179],v[60:61] op_sel_hi:[1,0]
v_max3_f32 v56,v96,v97,v98
v_cvt_pk_bf16_f32 v160,v160,v161
v_mfma_f32_16x16x32_bf16 v[76:79],a[148:151],a[4:7],v[76:79]
s_mul_i32 s64,s64,6144
v_cvt_pk_bf16_f32 v176,v176,v177
v_cvt_pk_bf16_f32 v161,v162,v163
s_waitcnt lgkmcnt(4)
v_mfma_f32_16x16x32_bf16 v[76:79],a[120:123],a[8:11],v[76:79]
s_add_u32 s41,s41,s64
v_cvt_pk_bf16_f32 v177,v178,v179
v_mov_b32 v64,0
v_mfma_f32_16x16x32_bf16 v[76:79],a[124:127],a[12:15],v[76:79]
s_cmp_ge_u32 s69,6
ds_write2st64_b64 v36,v[160:161],v[176:177] offset0:0 offset1:2
v_pk_mul_f32 v[164:165],v[164:165],v[60:61] op_sel_hi:[1,0]
v_pk_mul_f32 v[166:167],v[166:167],v[60:61] op_sel_hi:[1,0]
v_pk_mul_f32 v[180:181],v[180:181],v[60:61] op_sel_hi:[1,0]
v_pk_mul_f32 v[182:183],v[182:183],v[60:61] op_sel_hi:[1,0]
v_cvt_pk_bf16_f32 v164,v164,v165
v_cvt_pk_bf16_f32 v180,v180,v181
v_mfma_f32_16x16x32_bf16 v[76:79],a[128:131],a[16:19],v[76:79]
s_cselect_b32 s41,166723584,s41
v_cvt_pk_bf16_f32 v165,v166,v167
v_cvt_pk_bf16_f32 v181,v182,v183
s_waitcnt lgkmcnt(1)
v_mfma_f32_16x16x32_bf16 v[76:79],a[132:135],a[20:23],v[76:79]
s_cselect_b32 s30,100663296,s30
v_mov_b32 v65,0
s_add_u32 s25,s30,s22
v_mfma_f32_16x16x32_bf16 v[84:87],a[132:135],a[44:47],0
s_add_u32 s26,s25,12288
ds_write2st64_b64 v37,v[164:165],v[180:181] offset0:0 offset1:2
v_mfma_f32_16x16x32_bf16 v[84:87],a[128:131],a[40:43],v[84:87]
s_add_u32 m0,s23,24576
v_max3_f32 v44,v44,v75,v76
v_max3_f32 v44,v44,v77,v78
v_max_f32 v44,v44,v79
v_mov_b32 v45,v44
s_mov_b32 s28,s41
v_pk_mul_f32 v[168:169],v[168:169],v[60:61] op_sel_hi:[1,0]
v_pk_mul_f32 v[170:171],v[170:171],v[60:61] op_sel_hi:[1,0]
buffer_load_dwordx4 v6,s[8:11],s21 offen offset:0 lds
v_pk_mul_f32 v[184:185],v[184:185],v[60:61] op_sel_hi:[1,0]
v_pk_mul_f32 v[186:187],v[186:187],v[60:61] op_sel_hi:[1,0]
v_permlane32_swap_b32 v45,v44
v_max_f32 v44,v44,v45
v_mfma_f32_16x16x32_bf16 v[84:87],a[124:127],a[36:39],v[84:87]
s_mov_b32 s29,s24
v_mov_b32 v45,v44
v_cvt_pk_bf16_f32 v168,v168,v169
v_mfma_f32_16x16x32_bf16 v[84:87],a[120:123],a[32:35],v[84:87]
v_permlane16_swap_b32 v45,v44
v_mfma_f32_16x16x32_bf16 v[84:87],a[148:151],a[28:31],v[84:87]
v_max_f32 v44,v44,v45
v_mul_f32_e64 v13,-s36,v44
v_fma_f32 v72,v72,s36,v13
v_fma_f32 v73,v73,s36,v13
v_fma_f32 v74,v74,s36,v13
v_pk_mul_f32 v[172:173],v[172:173],v[60:61] op_sel_hi:[1,0]
v_pk_mul_f32 v[174:175],v[174:175],v[60:61] op_sel_hi:[1,0]
v_pk_mul_f32 v[188:189],v[188:189],v[60:61] op_sel_hi:[1,0]
v_pk_mul_f32 v[190:191],v[190:191],v[60:61] op_sel_hi:[1,0]
v_fma_f32 v75,v75,s36,v13
v_exp_f32 v72,v72
v_mfma_f32_16x16x32_bf16 v[84:87],a[144:147],a[24:27],v[84:87]
v_exp_f32 v73,v73
v_mfma_f32_16x16x32_bf16 v[92:95],a[144:147],a[48:51],0
buffer_load_dwordx4 v7,s[8:11],s21 offen offset:1024 lds
v_mfma_f32_16x16x32_bf16 v[92:95],a[148:151],a[52:55],v[92:95]
v_exp_f32 v74,v74
v_exp_f32 v75,v75
v_cvt_pk_bf16_f32 v20,v72,v73
v_pk_mul_f32 v[192:193],v[192:193],v[60:61] op_sel_hi:[1,0]
v_pk_mul_f32 v[194:195],v[194:195],v[60:61] op_sel_hi:[1,0]
v_cvt_pk_bf16_f32 v21,v74,v75
v_max3_f32 v48,v48,v83,v84
v_mfma_f32_16x16x32_bf16 v[92:95],a[120:123],a[56:59],v[92:95]
v_max3_f32 v48,v48,v85,v86
v_max_f32 v48,v48,v87
v_mfma_f32_16x16x32_bf16 v[92:95],a[124:127],a[60:63],v[92:95]
v_mov_b32 v49,v48
v_fma_f32 v76,v76,s36,v13
v_mfma_f32_16x16x32_bf16 v[92:95],a[128:131],a[64:67],v[92:95]
v_permlane32_swap_b32 v49,v48
v_max_f32 v48,v48,v49
v_mov_b32 v49,v48
v_fma_f32 v77,v77,s36,v13
buffer_load_dwordx4 v8,s[8:11],s21 offen offset:2048 lds
v_pk_mul_f32 v[196:197],v[196:197],v[60:61] op_sel_hi:[1,0]
v_pk_mul_f32 v[198:199],v[198:199],v[60:61] op_sel_hi:[1,0]
v_permlane16_swap_b32 v49,v48
v_max_f32 v48,v48,v49
v_mfma_f32_16x16x32_bf16 v[92:95],a[132:135],a[68:71],v[92:95]
s_add_u32 s21,s21,12288
v_mul_f32_e64 v14,-s36,v48
v_fma_f32 v80,v80,s36,v14
v_mfma_f32_16x16x32_bf16 v[100:103],a[132:135],a[92:95],0
s_add_u32 m0,s22,0
ds_read_b128 a[132:135],v1 offset:18432
v_fma_f32 v81,v81,s36,v14
v_mfma_f32_16x16x32_bf16 v[100:103],a[128:131],a[88:91],v[100:103]
ds_read_b128 a[128:131],v0 offset:18432
v_fma_f32 v82,v82,s36,v14
v_mfma_f32_16x16x32_bf16 v[100:103],a[124:127],a[84:87],v[100:103]
ds_read_b128 a[124:127],v1 offset:12544
v_fma_f32 v83,v83,s36,v14
v_exp_f32 v80,v80
v_exp_f32 v81,v81
v_pk_mul_f32 v[200:201],v[200:201],v[60:61] op_sel_hi:[1,0]
v_pk_mul_f32 v[202:203],v[202:203],v[60:61] op_sel_hi:[1,0]
v_exp_f32 v82,v82
v_exp_f32 v83,v83
v_mfma_f32_16x16x32_bf16 v[100:103],a[120:123],a[80:83],v[100:103]
ds_read_b128 a[120:123],v0 offset:12544
v_cvt_pk_bf16_f32 v24,v80,v81
v_mfma_f32_16x16x32_bf16 v[100:103],a[148:151],a[76:79],v[100:103]
ds_read_b128 a[148:151],v1 offset:12416
v_cvt_pk_bf16_f32 v25,v82,v83
v_mfma_f32_16x16x32_bf16 v[100:103],a[144:147],a[72:75],v[100:103]
ds_read_b128 a[144:147],v0 offset:12416
v_max3_f32 v52,v52,v91,v92
v_max3_f32 v52,v52,v93,v94
v_max_f32 v52,v52,v95
v_mov_b32 v53,v52
v_pk_mul_f32 v[204:205],v[204:205],v[60:61] op_sel_hi:[1,0]
v_pk_mul_f32 v[206:207],v[206:207],v[60:61] op_sel_hi:[1,0]
v_permlane32_swap_b32 v53,v52
v_max_f32 v52,v52,v53
s_waitcnt lgkmcnt(3)
v_mfma_f32_16x16x32_bf16 v[72:75],a[124:127],a[20:23],0
v_mov_b32 v53,v52
v_max3_f32 v56,v56,v99,v100
v_max3_f32 v56,v56,v101,v102
v_permlane16_swap_b32 v53,v52
v_max_f32 v52,v52,v53
v_mul_f32_e64 v15,-s36,v52
v_fma_f32 v88,v88,s36,v15
v_fma_f32 v89,v89,s36,v15
v_fma_f32 v90,v90,s36,v15
s_waitcnt lgkmcnt(2)
v_mfma_f32_16x16x32_bf16 v[72:75],a[120:123],a[16:19],v[72:75]
s_waitcnt lgkmcnt(1)
v_fma_f32 v91,v91,s36,v15
v_exp_f32 v88,v88
v_mfma_f32_16x16x32_bf16 v[72:75],a[148:151],a[12:15],v[72:75]
s_waitcnt lgkmcnt(0)
v_exp_f32 v89,v89
v_mfma_f32_16x16x32_bf16 v[72:75],a[144:147],a[8:11],v[72:75]
v_exp_f32 v90,v90
v_mfma_f32_16x16x32_bf16 v[72:75],a[140:143],a[4:7],v[72:75]
v_exp_f32 v91,v91
v_mfma_f32_16x16x32_bf16 v[72:75],a[136:139],a[0:3],v[72:75]
v_cvt_pk_bf16_f32 v28,v88,v89
v_cvt_pk_bf16_f32 v29,v90,v91
v_mfma_f32_16x16x32_bf16 v[80:83],a[136:139],a[24:27],0
v_max_f32 v56,v56,v103
v_mov_b32 v57,v56
v_mfma_f32_16x16x32_bf16 v[80:83],a[140:143],a[28:31],v[80:83]
v_fma_f32 v78,v78,s36,v13
v_permlane32_swap_b32 v57,v56
v_mfma_f32_16x16x32_bf16 v[80:83],a[144:147],a[32:35],v[80:83]
v_max_f32 v56,v56,v57
v_mov_b32 v57,v56
v_mfma_f32_16x16x32_bf16 v[80:83],a[148:151],a[36:39],v[80:83]
v_fma_f32 v79,v79,s36,v13
v_permlane16_swap_b32 v57,v56
v_mfma_f32_16x16x32_bf16 v[80:83],a[120:123],a[40:43],v[80:83]
v_max_f32 v56,v56,v57
v_mul_f32_e64 v16,-s36,v56
v_mfma_f32_16x16x32_bf16 v[80:83],a[124:127],a[44:47],v[80:83]
v_fma_f32 v96,v96,s36,v16
v_fma_f32 v97,v97,s36,v16
v_mfma_f32_16x16x32_bf16 v[88:91],a[124:127],a[68:71],0
v_fma_f32 v98,v98,s36,v16
v_fma_f32 v99,v99,s36,v16
v_mfma_f32_16x16x32_bf16 v[88:91],a[120:123],a[64:67],v[88:91]
v_exp_f32 v96,v96
v_mfma_f32_16x16x32_bf16 v[88:91],a[148:151],a[60:63],v[88:91]
v_exp_f32 v97,v97
v_mfma_f32_16x16x32_bf16 v[88:91],a[144:147],a[56:59],v[88:91]
v_exp_f32 v98,v98
v_mfma_f32_16x16x32_bf16 v[88:91],a[140:143],a[52:55],v[88:91]
v_exp_f32 v99,v99
v_mfma_f32_16x16x32_bf16 v[88:91],a[136:139],a[48:51],v[88:91]
v_cvt_pk_bf16_f32 v32,v96,v97
v_cvt_pk_bf16_f32 v33,v98,v99
v_mfma_f32_16x16x32_bf16 v[96:99],a[136:139],a[72:75],0
ds_read_b128 a[136:139],v0 offset:18560
v_exp_f32 v76,v76
v_mfma_f32_16x16x32_bf16 v[96:99],a[140:143],a[76:79],v[96:99]
ds_read_b128 a[140:143],v1 offset:18560
v_exp_f32 v77,v77
v_mfma_f32_16x16x32_bf16 v[96:99],a[144:147],a[80:83],v[96:99]
ds_read_b128 a[144:147],v0 offset:18688
v_exp_f32 v78,v78
v_mfma_f32_16x16x32_bf16 v[96:99],a[148:151],a[84:87],v[96:99]
ds_read_b128 a[148:151],v1 offset:18688
v_exp_f32 v79,v79
v_mfma_f32_16x16x32_bf16 v[96:99],a[120:123],a[88:91],v[96:99]
v_cvt_pk_bf16_f32 v22,v76,v77
v_cvt_pk_bf16_f32 v23,v78,v79
v_mfma_f32_16x16x32_bf16 v[96:99],a[124:127],a[92:95],v[96:99]
v_fma_f32 v84,v84,s36,v14
v_fma_f32 v85,v85,s36,v14
v_mfma_f32_16x16x32_bf16 v[76:79],a[128:131],a[0:3],0
v_fma_f32 v86,v86,s36,v14
v_fma_f32 v87,v87,s36,v14
v_mfma_f32_16x16x32_bf16 v[76:79],a[132:135],a[4:7],v[76:79]
s_waitcnt lgkmcnt(3)
v_exp_f32 v84,v84
v_mfma_f32_16x16x32_bf16 v[76:79],a[136:139],a[8:11],v[76:79]
s_waitcnt lgkmcnt(2)
v_exp_f32 v85,v85
v_mfma_f32_16x16x32_bf16 v[76:79],a[140:143],a[12:15],v[76:79]
s_waitcnt lgkmcnt(1)
v_exp_f32 v86,v86
v_mfma_f32_16x16x32_bf16 v[76:79],a[144:147],a[16:19],v[76:79]
s_waitcnt lgkmcnt(0)
v_exp_f32 v87,v87
v_mfma_f32_16x16x32_bf16 v[76:79],a[148:151],a[20:23],v[76:79]
v_cvt_pk_bf16_f32 v26,v84,v85
v_cvt_pk_bf16_f32 v27,v86,v87
v_mfma_f32_16x16x32_bf16 v[84:87],a[148:151],a[44:47],0
v_fma_f32 v92,v92,s36,v15
v_fma_f32 v93,v93,s36,v15
v_mfma_f32_16x16x32_bf16 v[84:87],a[144:147],a[40:43],v[84:87]
v_fma_f32 v94,v94,s36,v15
v_fma_f32 v95,v95,s36,v15
v_mfma_f32_16x16x32_bf16 v[84:87],a[140:143],a[36:39],v[84:87]
v_exp_f32 v92,v92
v_mfma_f32_16x16x32_bf16 v[84:87],a[136:139],a[32:35],v[84:87]
v_exp_f32 v93,v93
v_mfma_f32_16x16x32_bf16 v[84:87],a[132:135],a[28:31],v[84:87]
v_exp_f32 v94,v94
v_mfma_f32_16x16x32_bf16 v[84:87],a[128:131],a[24:27],v[84:87]
v_exp_f32 v95,v95
s_waitcnt vmcnt(3)
s_barrier
v_cvt_pk_bf16_f32 v30,v92,v93
buffer_load_dwordx4 v6,s[4:7],s20 offen offset:0 lds
v_cvt_pk_bf16_f32 v31,v94,v95
v_mfma_f32_16x16x32_bf16 v[92:95],a[128:131],a[48:51],0
v_fma_f32 v100,v100,s36,v16
v_fma_f32 v101,v101,s36,v16
v_mfma_f32_16x16x32_bf16 v[92:95],a[132:135],a[52:55],v[92:95]
v_fma_f32 v102,v102,s36,v16
v_fma_f32 v103,v103,s36,v16
v_mfma_f32_16x16x32_bf16 v[92:95],a[136:139],a[56:59],v[92:95]
v_exp_f32 v100,v100
v_mfma_f32_16x16x32_bf16 v[92:95],a[140:143],a[60:63],v[92:95]
v_exp_f32 v101,v101
v_mfma_f32_16x16x32_bf16 v[92:95],a[144:147],a[64:67],v[92:95]
v_exp_f32 v102,v102
v_mfma_f32_16x16x32_bf16 v[92:95],a[148:151],a[68:71],v[92:95]
buffer_load_dwordx4 v7,s[4:7],s20 offen offset:1024 lds
v_exp_f32 v103,v103
v_cvt_pk_bf16_f32 v34,v100,v101
v_cvt_pk_bf16_f32 v35,v102,v103
v_mfma_f32_16x16x32_bf16 v[100:103],a[148:151],a[92:95],0
v_cvt_pk_bf16_f32 v184,v184,v185
v_cvt_pk_bf16_f32 v169,v170,v171
v_smfmac_f32_16x16x64_bf16 v[64:67],a[152:155],v[28:35],v18
ds_read_b64_tr_b16 a[120:121],v2 offset:0
v_mfma_f32_16x16x32_bf16 v[100:103],a[144:147],a[88:91],v[100:103]
ds_read_b64_tr_b16 a[122:123],v2 offset:6144
v_cvt_pk_bf16_f32 v172,v172,v173
v_mfma_f32_16x16x32_bf16 v[100:103],a[140:143],a[84:87],v[100:103]
v_cvt_pk_bf16_f32 v188,v188,v189
v_mov_b32 v60,0
v_mfma_f32_16x16x32_bf16 v[100:103],a[136:139],a[80:83],v[100:103]
buffer_load_dwordx4 v8,s[4:7],s20 offen offset:2048 lds
v_mfma_f32_16x16x32_bf16 v[100:103],a[132:135],a[76:79],v[100:103]
s_add_u32 s20,s20,12288
ds_read_b64_tr_b16 a[124:125],v3 offset:0
v_mov_b32 v61,0
v_mfma_f32_16x16x32_bf16 v[100:103],a[128:131],a[72:75],v[100:103]
ds_read_b64_tr_b16 a[126:127],v3 offset:6144
v_cvt_pk_bf16_f32 v185,v186,v187
v_smfmac_f32_16x16x64_bf16 v[60:63],a[152:155],v[20:27],v18
ds_write2st64_b64 v38,v[168:169],v[184:185] offset0:0 offset1:2
v_cvt_pk_bf16_f32 v192,v192,v193
v_cvt_pk_bf16_f32 v173,v174,v175
v_cvt_pk_bf16_f32 v189,v190,v191
ds_read_b64_tr_b16 a[128:129],v4 offset:0
ds_read_b64_tr_b16 a[130:131],v4 offset:6144
ds_read_b64_tr_b16 a[132:133],v5 offset:0
ds_read_b64_tr_b16 a[134:135],v5 offset:6144
ds_write2st64_b64 v39,v[172:173],v[188:189] offset0:0 offset1:2
v_cvt_pk_bf16_f32 v196,v196,v197
v_fma_f32 v72,v72,s36,v13
v_fma_f32 v73,v73,s36,v13
v_fma_f32 v74,v74,s36,v13
v_fma_f32 v75,v75,s36,v13
v_fma_f32 v80,v80,s36,v14
v_fma_f32 v81,v81,s36,v14
v_cvt_pk_bf16_f32 v193,v194,v195
v_cvt_pk_bf16_f32 v200,v200,v201
v_cvt_pk_bf16_f32 v197,v198,v199
v_exp_f32 v72,v72
ds_write_b64 v36,v[192:193] offset:2048
v_exp_f32 v73,v73
v_exp_f32 v74,v74
ds_write_b64 v37,v[196:197] offset:2048
v_exp_f32 v75,v75
v_exp_f32 v80,v80
v_exp_f32 v81,v81
v_cvt_pk_bf16_f32 v204,v204,v205
v_cvt_pk_bf16_f32 v201,v202,v203
ds_write_b64 v38,v[200:201] offset:2048
v_cvt_pk_bf16_f32 v205,v206,v207
v_cvt_pk_bf16_f32 v44,v72,v73
v_cvt_pk_bf16_f32 v45,v74,v75
v_cvt_pk_bf16_f32 v48,v80,v81
ds_write_b64 v39,v[204:205] offset:2048
s_waitcnt lgkmcnt(3)
v_mfma_f32_16x16x32_bf16 v[160:163],a[120:123],v[20:23],0
s_add_u32 m0,s23,0
ds_read_b64_tr_b16 a[136:137],v2 offset:128
v_fma_f32 v82,v82,s36,v14
v_mfma_f32_16x16x32_bf16 v[164:167],a[124:127],v[20:23],0
ds_read_b64_tr_b16 a[138:139],v2 offset:6272
v_fma_f32 v83,v83,s36,v14
v_mfma_f32_16x16x32_bf16 v[212:215],a[124:127],v[24:27],0
ds_read_b64_tr_b16 a[140:141],v3 offset:128
v_fma_f32 v88,v88,s36,v15
v_mfma_f32_16x16x32_bf16 v[208:211],a[120:123],v[24:27],0
ds_read_b64_tr_b16 a[142:143],v3 offset:6272
v_fma_f32 v89,v89,s36,v15
v_mfma_f32_16x16x32_bf16 v[112:115],a[120:123],v[28:31],0
ds_read_b64_tr_b16 a[144:145],v4 offset:128
v_fma_f32 v90,v90,s36,v15
v_mfma_f32_16x16x32_bf16 v[116:119],a[124:127],v[28:31],0
ds_read_b64_tr_b16 a[146:147],v4 offset:6272
v_fma_f32 v91,v91,s36,v15
v_mfma_f32_16x16x32_bf16 a[164:167],a[124:127],v[32:35],0
ds_read_b64_tr_b16 a[148:149],v5 offset:128
v_fma_f32 v96,v96,s36,v16
v_mfma_f32_16x16x32_bf16 a[160:163],a[120:123],v[32:35],0
ds_read_b64_tr_b16 a[150:151],v5 offset:6272
v_fma_f32 v97,v97,s36,v16
v_mfma_f32_16x16x32_bf16 a[168:171],a[128:131],v[32:35],0
ds_read_b64_tr_b16 a[120:121],v2 offset:256
v_fma_f32 v98,v98,s36,v16
v_mfma_f32_16x16x32_bf16 a[172:175],a[132:135],v[32:35],0
ds_read_b64_tr_b16 a[122:123],v2 offset:6400
v_fma_f32 v99,v99,s36,v16
v_mfma_f32_16x16x32_bf16 v[124:127],a[132:135],v[28:31],0
ds_read_b64_tr_b16 a[124:125],v3 offset:256
v_fma_f32 v76,v76,s36,v13
v_mfma_f32_16x16x32_bf16 v[120:123],a[128:131],v[28:31],0
ds_read_b64_tr_b16 a[126:127],v3 offset:6400
v_fma_f32 v77,v77,s36,v13
v_mfma_f32_16x16x32_bf16 v[216:219],a[128:131],v[24:27],0
v_exp_f32 v82,v82
v_mfma_f32_16x16x32_bf16 v[220:223],a[132:135],v[24:27],0
v_exp_f32 v83,v83
v_mfma_f32_16x16x32_bf16 v[172:175],a[132:135],v[20:23],0
ds_read_b64_tr_b16 a[132:133],v5 offset:256
v_cvt_pk_bf16_f32 v49,v82,v83
v_mfma_f32_16x16x32_bf16 v[168:171],a[128:131],v[20:23],0
s_waitcnt lgkmcnt(4)
ds_read_b64_tr_b16 a[128:129],v4 offset:256
v_fma_f32 v78,v78,s36,v13
v_mfma_f32_16x16x32_bf16 v[176:179],a[136:139],v[20:23],0
ds_read_b64_tr_b16 a[130:131],v4 offset:6400
v_fma_f32 v79,v79,s36,v13
v_mfma_f32_16x16x32_bf16 v[180:183],a[140:143],v[20:23],0
ds_read_b64_tr_b16 a[134:135],v5 offset:6400
v_fma_f32 v84,v84,s36,v14
v_mfma_f32_16x16x32_bf16 v[228:231],a[140:143],v[24:27],0
v_exp_f32 v88,v88
v_mfma_f32_16x16x32_bf16 v[224:227],a[136:139],v[24:27],0
v_exp_f32 v89,v89
v_mfma_f32_16x16x32_bf16 v[128:131],a[136:139],v[28:31],0
v_exp_f32 v90,v90
v_mfma_f32_16x16x32_bf16 v[132:135],a[140:143],v[28:31],0
v_exp_f32 v91,v91
v_mfma_f32_16x16x32_bf16 a[180:183],a[140:143],v[32:35],0
v_cvt_pk_bf16_f32 v52,v88,v89
v_cvt_pk_bf16_f32 v53,v90,v91
v_mfma_f32_16x16x32_bf16 a[176:179],a[136:139],v[32:35],0
v_exp_f32 v96,v96
v_mfma_f32_16x16x32_bf16 a[184:187],a[144:147],v[32:35],0
v_exp_f32 v97,v97
v_mfma_f32_16x16x32_bf16 a[188:191],a[148:151],v[32:35],0
v_exp_f32 v98,v98
v_mfma_f32_16x16x32_bf16 v[140:143],a[148:151],v[28:31],0
v_exp_f32 v99,v99
v_mfma_f32_16x16x32_bf16 v[136:139],a[144:147],v[28:31],0
v_cvt_pk_bf16_f32 v56,v96,v97
v_cvt_pk_bf16_f32 v57,v98,v99
v_mfma_f32_16x16x32_bf16 v[232:235],a[144:147],v[24:27],0
v_exp_f32 v76,v76
v_mfma_f32_16x16x32_bf16 v[236:239],a[148:151],v[24:27],0
v_exp_f32 v77,v77
v_mfma_f32_16x16x32_bf16 v[188:191],a[148:151],v[20:23],0
v_exp_f32 v78,v78
v_mfma_f32_16x16x32_bf16 v[184:187],a[144:147],v[20:23],0
s_waitcnt lgkmcnt(0)
v_exp_f32 v79,v79
v_mfma_f32_16x16x32_bf16 v[192:195],a[120:123],v[20:23],0
v_cvt_pk_bf16_f32 v46,v76,v77
v_cvt_pk_bf16_f32 v47,v78,v79
v_mfma_f32_16x16x32_bf16 v[196:199],a[124:127],v[20:23],0
s_waitcnt vmcnt(24)
v_fma_f32 v85,v85,s36,v14
v_fma_f32 v86,v86,s36,v14
v_mfma_f32_16x16x32_bf16 v[244:247],a[124:127],v[24:27],0
s_barrier
v_mfma_f32_16x16x32_bf16 v[240:243],a[120:123],v[24:27],0
ds_read_b128 a[148:151],v1 offset:24704
v_fma_f32 v87,v87,s36,v14
v_mfma_f32_16x16x32_bf16 v[144:147],a[120:123],v[28:31],0
ds_read_b128 a[144:147],v0 offset:24704
v_fma_f32 v92,v92,s36,v15
v_mfma_f32_16x16x32_bf16 v[148:151],a[124:127],v[28:31],0
ds_read_b128 a[140:143],v1 offset:24576
v_fma_f32 v93,v93,s36,v15
v_mfma_f32_16x16x32_bf16 a[196:199],a[124:127],v[32:35],0
ds_read_b128 a[124:127],v1 offset:24832
v_fma_f32 v94,v94,s36,v15
v_mfma_f32_16x16x32_bf16 a[192:195],a[120:123],v[32:35],0
ds_read_b128 a[120:123],v0 offset:24832
v_fma_f32 v95,v95,s36,v15
v_mfma_f32_16x16x32_bf16 a[200:203],a[128:131],v[32:35],0
buffer_load_dwordx4 v6,s[8:11],s21 offen offset:0 lds
v_mfma_f32_16x16x32_bf16 a[204:207],a[132:135],v[32:35],0
ds_read_b128 a[136:139],v0 offset:24576
v_fma_f32 v100,v100,s36,v16
v_mfma_f32_16x16x32_bf16 v[156:159],a[132:135],v[28:31],0
v_exp_f32 v84,v84
v_mfma_f32_16x16x32_bf16 v[152:155],a[128:131],v[28:31],0
v_exp_f32 v85,v85
v_mfma_f32_16x16x32_bf16 v[248:251],a[128:131],v[24:27],0
v_exp_f32 v86,v86
v_mfma_f32_16x16x32_bf16 v[252:255],a[132:135],v[24:27],0
v_exp_f32 v87,v87
v_mfma_f32_16x16x32_bf16 v[204:207],a[132:135],v[20:23],0
ds_read_b128 a[132:135],v1 offset:30720
v_cvt_pk_bf16_f32 v50,v84,v85
v_mfma_f32_16x16x32_bf16 v[200:203],a[128:131],v[20:23],0
s_waitcnt lgkmcnt(2)
ds_read_b128 a[128:131],v0 offset:30720
v_cvt_pk_bf16_f32 v51,v86,v87
v_mfma_f32_16x16x32_bf16 v[72:75],a[124:127],a[20:23],0
v_exp_f32 v92,v92
v_smfmac_f32_16x16x64_bf16 v[60:63],a[152:155],v[44:51],v18
buffer_load_dwordx4 v7,s[8:11],s21 offen offset:1024 lds
v_mfma_f32_16x16x32_bf16 v[72:75],a[120:123],a[16:19],v[72:75]
v_exp_f32 v93,v93
v_mfma_f32_16x16x32_bf16 v[72:75],a[148:151],a[12:15],v[72:75]
v_exp_f32 v94,v94
v_mfma_f32_16x16x32_bf16 v[72:75],a[144:147],a[8:11],v[72:75]
v_exp_f32 v95,v95
v_mfma_f32_16x16x32_bf16 v[72:75],a[140:143],a[4:7],v[72:75]
s_waitcnt lgkmcnt(1)
v_cvt_pk_bf16_f32 v54,v92,v93
v_cvt_pk_bf16_f32 v55,v94,v95
v_mfma_f32_16x16x32_bf16 v[72:75],a[136:139],a[0:3],v[72:75]
v_fma_f32 v101,v101,s36,v16
v_fma_f32 v102,v102,s36,v16
v_mfma_f32_16x16x32_bf16 v[80:83],a[136:139],a[24:27],0
v_fma_f32 v103,v103,s36,v16
v_mfma_f32_16x16x32_bf16 v[80:83],a[140:143],a[28:31],v[80:83]
v_exp_f32 v100,v100
v_mfma_f32_16x16x32_bf16 v[80:83],a[144:147],a[32:35],v[80:83]
buffer_load_dwordx4 v8,s[8:11],s21 offen offset:2048 lds
v_mfma_f32_16x16x32_bf16 v[80:83],a[148:151],a[36:39],v[80:83]
s_add_u32 s21,s21,12288
v_exp_f32 v101,v101
v_mfma_f32_16x16x32_bf16 v[80:83],a[120:123],a[40:43],v[80:83]
s_add_u32 m0,s22,12288
v_exp_f32 v102,v102
v_mfma_f32_16x16x32_bf16 v[80:83],a[124:127],a[44:47],v[80:83]
v_exp_f32 v103,v103
v_mfma_f32_16x16x32_bf16 v[88:91],a[124:127],a[68:71],0
v_cvt_pk_bf16_f32 v58,v100,v101
v_cvt_pk_bf16_f32 v59,v102,v103
v_mfma_f32_16x16x32_bf16 v[88:91],a[120:123],a[64:67],v[88:91]
v_fma_f32 v72,v72,s36,v13
v_fma_f32 v73,v73,s36,v13
v_smfmac_f32_16x16x64_bf16 v[64:67],a[152:155],v[52:59],v18
v_fma_f32 v74,v74,s36,v13
v_mfma_f32_16x16x32_bf16 v[88:91],a[148:151],a[60:63],v[88:91]
v_fma_f32 v75,v75,s36,v13
v_fma_f32 v80,v80,s36,v14
v_mfma_f32_16x16x32_bf16 v[88:91],a[144:147],a[56:59],v[88:91]
v_fma_f32 v81,v81,s36,v14
v_mfma_f32_16x16x32_bf16 v[88:91],a[140:143],a[52:55],v[88:91]
buffer_load_dwordx4 v6,s[4:7],s20 offen offset:0 lds
v_mfma_f32_16x16x32_bf16 v[88:91],a[136:139],a[48:51],v[88:91]
v_exp_f32 v72,v72
v_mfma_f32_16x16x32_bf16 v[96:99],a[136:139],a[72:75],0
ds_read_b128 a[136:139],v0 offset:30848
v_mfma_f32_16x16x32_bf16 v[96:99],a[140:143],a[76:79],v[96:99]
ds_read_b128 a[140:143],v1 offset:30848
v_mfma_f32_16x16x32_bf16 v[96:99],a[144:147],a[80:83],v[96:99]
ds_read_b128 a[144:147],v0 offset:30976
v_mfma_f32_16x16x32_bf16 v[96:99],a[148:151],a[84:87],v[96:99]
ds_read_b128 a[148:151],v1 offset:30976
v_mfma_f32_16x16x32_bf16 v[96:99],a[120:123],a[88:91],v[96:99]
v_exp_f32 v73,v73
v_mfma_f32_16x16x32_bf16 v[96:99],a[124:127],a[92:95],v[96:99]
s_waitcnt lgkmcnt(4)
v_exp_f32 v74,v74
v_mfma_f32_16x16x32_bf16 v[76:79],a[128:131],a[0:3],0
v_exp_f32 v75,v75
v_mfma_f32_16x16x32_bf16 v[76:79],a[132:135],a[4:7],v[76:79]
buffer_load_dwordx4 v7,s[4:7],s20 offen offset:1024 lds
s_waitcnt lgkmcnt(3)
v_mfma_f32_16x16x32_bf16 v[76:79],a[136:139],a[8:11],v[76:79]
s_waitcnt lgkmcnt(2)
v_exp_f32 v80,v80
v_mfma_f32_16x16x32_bf16 v[76:79],a[140:143],a[12:15],v[76:79]
s_waitcnt lgkmcnt(0)
v_exp_f32 v81,v81
v_mfma_f32_16x16x32_bf16 v[76:79],a[144:147],a[16:19],v[76:79]
v_cvt_pk_bf16_f32 v20,v72,v73
v_cvt_pk_bf16_f32 v21,v74,v75
v_mfma_f32_16x16x32_bf16 v[76:79],a[148:151],a[20:23],v[76:79]
v_cvt_pk_bf16_f32 v24,v80,v81
v_mfma_f32_16x16x32_bf16 v[84:87],a[148:151],a[44:47],0
v_mfma_f32_16x16x32_bf16 v[84:87],a[144:147],a[40:43],v[84:87]
v_mfma_f32_16x16x32_bf16 v[84:87],a[140:143],a[36:39],v[84:87]
v_mfma_f32_16x16x32_bf16 v[84:87],a[136:139],a[32:35],v[84:87]
v_mfma_f32_16x16x32_bf16 v[84:87],a[132:135],a[28:31],v[84:87]
buffer_load_dwordx4 v8,s[4:7],s20 offen offset:2048 lds
v_mfma_f32_16x16x32_bf16 v[84:87],a[128:131],a[24:27],v[84:87]
s_add_u32 s20,s20,12288
v_mfma_f32_16x16x32_bf16 v[92:95],a[128:131],a[48:51],0
ds_read_b64_tr_b16 a[120:121],v2 offset:12288
v_mfma_f32_16x16x32_bf16 v[92:95],a[132:135],a[52:55],v[92:95]
ds_read_b64_tr_b16 a[122:123],v2 offset:18432
v_mfma_f32_16x16x32_bf16 v[92:95],a[136:139],a[56:59],v[92:95]
ds_read_b64_tr_b16 a[124:125],v3 offset:12288
v_mfma_f32_16x16x32_bf16 v[92:95],a[140:143],a[60:63],v[92:95]
ds_read_b64_tr_b16 a[126:127],v3 offset:18432
v_mfma_f32_16x16x32_bf16 v[92:95],a[144:147],a[64:67],v[92:95]
v_mfma_f32_16x16x32_bf16 v[92:95],a[148:151],a[68:71],v[92:95]
v_mfma_f32_16x16x32_bf16 v[100:103],a[148:151],a[92:95],0
v_mfma_f32_16x16x32_bf16 v[100:103],a[144:147],a[88:91],v[100:103]
v_mfma_f32_16x16x32_bf16 v[100:103],a[140:143],a[84:87],v[100:103]
v_mfma_f32_16x16x32_bf16 v[100:103],a[136:139],a[80:83],v[100:103]
v_mfma_f32_16x16x32_bf16 v[100:103],a[132:135],a[76:79],v[100:103]
ds_read_b64_tr_b16 a[132:133],v5 offset:12288
v_mfma_f32_16x16x32_bf16 v[100:103],a[128:131],a[72:75],v[100:103]
s_waitcnt lgkmcnt(1)
ds_read_b64_tr_b16 a[128:129],v4 offset:12288
ds_read_b64_tr_b16 a[130:131],v4 offset:18432
ds_read_b64_tr_b16 a[134:135],v5 offset:18432
v_mfma_f32_16x16x32_bf16 v[160:163],a[120:123],v[44:47],v[160:163]
s_add_u32 m0,s23,12288
ds_read_b64_tr_b16 a[136:137],v2 offset:12416
v_fma_f32 v82,v82,s36,v14
v_mfma_f32_16x16x32_bf16 v[164:167],a[124:127],v[44:47],v[164:167]
ds_read_b64_tr_b16 a[138:139],v2 offset:18560
v_fma_f32 v83,v83,s36,v14
v_mfma_f32_16x16x32_bf16 v[212:215],a[124:127],v[48:51],v[212:215]
ds_read_b64_tr_b16 a[140:141],v3 offset:12416
v_fma_f32 v88,v88,s36,v15
v_mfma_f32_16x16x32_bf16 v[208:211],a[120:123],v[48:51],v[208:211]
ds_read_b64_tr_b16 a[142:143],v3 offset:18560
v_fma_f32 v89,v89,s36,v15
v_mfma_f32_16x16x32_bf16 v[112:115],a[120:123],v[52:55],v[112:115]
ds_read_b64_tr_b16 a[144:145],v4 offset:12416
v_fma_f32 v90,v90,s36,v15
v_mfma_f32_16x16x32_bf16 v[116:119],a[124:127],v[52:55],v[116:119]
ds_read_b64_tr_b16 a[146:147],v4 offset:18560
v_fma_f32 v91,v91,s36,v15
v_mfma_f32_16x16x32_bf16 a[164:167],a[124:127],v[56:59],a[164:167]
ds_read_b64_tr_b16 a[148:149],v5 offset:12416
v_fma_f32 v96,v96,s36,v16
v_mfma_f32_16x16x32_bf16 a[160:163],a[120:123],v[56:59],a[160:163]
s_waitcnt lgkmcnt(6)
ds_read_b64_tr_b16 a[150:151],v5 offset:18560
v_fma_f32 v97,v97,s36,v16
v_mfma_f32_16x16x32_bf16 a[168:171],a[128:131],v[56:59],a[168:171]
ds_read_b64_tr_b16 a[120:121],v2 offset:12544
v_fma_f32 v98,v98,s36,v16
v_mfma_f32_16x16x32_bf16 a[172:175],a[132:135],v[56:59],a[172:175]
ds_read_b64_tr_b16 a[122:123],v2 offset:18688
v_fma_f32 v99,v99,s36,v16
v_mfma_f32_16x16x32_bf16 v[124:127],a[132:135],v[52:55],v[124:127]
ds_read_b64_tr_b16 a[124:125],v3 offset:12544
v_fma_f32 v76,v76,s36,v13
v_mfma_f32_16x16x32_bf16 v[120:123],a[128:131],v[52:55],v[120:123]
ds_read_b64_tr_b16 a[126:127],v3 offset:18688
v_fma_f32 v77,v77,s36,v13
v_mfma_f32_16x16x32_bf16 v[216:219],a[128:131],v[48:51],v[216:219]
v_exp_f32 v82,v82
v_mfma_f32_16x16x32_bf16 v[220:223],a[132:135],v[48:51],v[220:223]
v_exp_f32 v83,v83
v_mfma_f32_16x16x32_bf16 v[172:175],a[132:135],v[44:47],v[172:175]
ds_read_b64_tr_b16 a[132:133],v5 offset:12544
v_cvt_pk_bf16_f32 v25,v82,v83
v_mfma_f32_16x16x32_bf16 v[168:171],a[128:131],v[44:47],v[168:171]
s_waitcnt lgkmcnt(4)
ds_read_b64_tr_b16 a[128:129],v4 offset:12544
v_fma_f32 v78,v78,s36,v13
v_mfma_f32_16x16x32_bf16 v[176:179],a[136:139],v[44:47],v[176:179]
ds_read_b64_tr_b16 a[130:131],v4 offset:18688
v_fma_f32 v79,v79,s36,v13
v_mfma_f32_16x16x32_bf16 v[180:183],a[140:143],v[44:47],v[180:183]
ds_read_b64_tr_b16 a[134:135],v5 offset:18688
v_fma_f32 v84,v84,s36,v14
v_mfma_f32_16x16x32_bf16 v[228:231],a[140:143],v[48:51],v[228:231]
v_exp_f32 v88,v88
v_mfma_f32_16x16x32_bf16 v[224:227],a[136:139],v[48:51],v[224:227]
v_exp_f32 v89,v89
v_mfma_f32_16x16x32_bf16 v[128:131],a[136:139],v[52:55],v[128:131]
v_exp_f32 v90,v90
v_mfma_f32_16x16x32_bf16 v[132:135],a[140:143],v[52:55],v[132:135]
v_exp_f32 v91,v91
v_mfma_f32_16x16x32_bf16 a[180:183],a[140:143],v[56:59],a[180:183]
v_cvt_pk_bf16_f32 v28,v88,v89
v_cvt_pk_bf16_f32 v29,v90,v91
v_mfma_f32_16x16x32_bf16 a[176:179],a[136:139],v[56:59],a[176:179]
v_exp_f32 v96,v96
v_mfma_f32_16x16x32_bf16 a[184:187],a[144:147],v[56:59],a[184:187]
v_exp_f32 v97,v97
v_mfma_f32_16x16x32_bf16 a[188:191],a[148:151],v[56:59],a[188:191]
v_exp_f32 v98,v98
v_mfma_f32_16x16x32_bf16 v[140:143],a[148:151],v[52:55],v[140:143]
v_exp_f32 v99,v99
v_mfma_f32_16x16x32_bf16 v[136:139],a[144:147],v[52:55],v[136:139]
v_cvt_pk_bf16_f32 v32,v96,v97
v_cvt_pk_bf16_f32 v33,v98,v99
v_mfma_f32_16x16x32_bf16 v[232:235],a[144:147],v[48:51],v[232:235]
v_exp_f32 v76,v76
v_mfma_f32_16x16x32_bf16 v[236:239],a[148:151],v[48:51],v[236:239]
v_exp_f32 v77,v77
v_mfma_f32_16x16x32_bf16 v[188:191],a[148:151],v[44:47],v[188:191]
v_exp_f32 v78,v78
v_mfma_f32_16x16x32_bf16 v[184:187],a[144:147],v[44:47],v[184:187]
s_waitcnt lgkmcnt(0)
v_exp_f32 v79,v79
v_mfma_f32_16x16x32_bf16 v[192:195],a[120:123],v[44:47],v[192:195]
v_cvt_pk_bf16_f32 v22,v76,v77
v_cvt_pk_bf16_f32 v23,v78,v79
v_mfma_f32_16x16x32_bf16 v[196:199],a[124:127],v[44:47],v[196:199]
s_waitcnt vmcnt(6)
v_fma_f32 v85,v85,s36,v14
v_fma_f32 v86,v86,s36,v14
v_mfma_f32_16x16x32_bf16 v[244:247],a[124:127],v[48:51],v[244:247]
s_barrier
v_mfma_f32_16x16x32_bf16 v[240:243],a[120:123],v[48:51],v[240:243]
ds_read_b128 a[148:151],v1 offset:128
v_fma_f32 v87,v87,s36,v14
v_mfma_f32_16x16x32_bf16 v[144:147],a[120:123],v[52:55],v[144:147]
ds_read_b128 a[144:147],v0 offset:128
v_fma_f32 v92,v92,s36,v15
v_mfma_f32_16x16x32_bf16 v[148:151],a[124:127],v[52:55],v[148:151]
ds_read_b128 a[140:143],v1 offset:0
v_fma_f32 v93,v93,s36,v15
v_mfma_f32_16x16x32_bf16 a[196:199],a[124:127],v[56:59],a[196:199]
ds_read_b128 a[124:127],v1 offset:256
v_fma_f32 v94,v94,s36,v15
v_mfma_f32_16x16x32_bf16 a[192:195],a[120:123],v[56:59],a[192:195]
ds_read_b128 a[120:123],v0 offset:256
v_fma_f32 v95,v95,s36,v15
v_mfma_f32_16x16x32_bf16 a[200:203],a[128:131],v[56:59],a[200:203]
buffer_load_dwordx4 v6,s[8:11],s21 offen offset:0 lds
v_mfma_f32_16x16x32_bf16 a[204:207],a[132:135],v[56:59],a[204:207]
ds_read_b128 a[136:139],v0 offset:0
v_fma_f32 v100,v100,s36,v16
v_mfma_f32_16x16x32_bf16 v[156:159],a[132:135],v[52:55],v[156:159]
v_exp_f32 v84,v84
v_mfma_f32_16x16x32_bf16 v[152:155],a[128:131],v[52:55],v[152:155]
v_exp_f32 v85,v85
v_mfma_f32_16x16x32_bf16 v[248:251],a[128:131],v[48:51],v[248:251]
v_exp_f32 v86,v86
v_mfma_f32_16x16x32_bf16 v[252:255],a[132:135],v[48:51],v[252:255]
v_exp_f32 v87,v87
v_mfma_f32_16x16x32_bf16 v[204:207],a[132:135],v[44:47],v[204:207]
ds_read_b128 a[132:135],v1 offset:6144
v_cvt_pk_bf16_f32 v26,v84,v85
v_mfma_f32_16x16x32_bf16 v[200:203],a[128:131],v[44:47],v[200:203]
s_waitcnt lgkmcnt(2)
ds_read_b128 a[128:131],v0 offset:6144
v_cvt_pk_bf16_f32 v27,v86,v87
v_mfma_f32_16x16x32_bf16 v[72:75],a[124:127],a[20:23],0
v_exp_f32 v92,v92
v_smfmac_f32_16x16x64_bf16 v[60:63],a[152:155],v[20:27],v18
buffer_load_dwordx4 v7,s[8:11],s21 offen offset:1024 lds
v_mfma_f32_16x16x32_bf16 v[72:75],a[120:123],a[16:19],v[72:75]
v_exp_f32 v93,v93
v_mfma_f32_16x16x32_bf16 v[72:75],a[148:151],a[12:15],v[72:75]
v_exp_f32 v94,v94
v_mfma_f32_16x16x32_bf16 v[72:75],a[144:147],a[8:11],v[72:75]
v_exp_f32 v95,v95
v_mfma_f32_16x16x32_bf16 v[72:75],a[140:143],a[4:7],v[72:75]
s_waitcnt lgkmcnt(1)
v_cvt_pk_bf16_f32 v30,v92,v93
v_cvt_pk_bf16_f32 v31,v94,v95
v_mfma_f32_16x16x32_bf16 v[72:75],a[136:139],a[0:3],v[72:75]
v_fma_f32 v101,v101,s36,v16
v_fma_f32 v102,v102,s36,v16
v_mfma_f32_16x16x32_bf16 v[80:83],a[136:139],a[24:27],0
v_fma_f32 v103,v103,s36,v16
v_mfma_f32_16x16x32_bf16 v[80:83],a[140:143],a[28:31],v[80:83]
v_exp_f32 v100,v100
v_mfma_f32_16x16x32_bf16 v[80:83],a[144:147],a[32:35],v[80:83]
buffer_load_dwordx4 v8,s[8:11],s21 offen offset:2048 lds
v_mfma_f32_16x16x32_bf16 v[80:83],a[148:151],a[36:39],v[80:83]
s_add_u32 s21,s21,12288
v_exp_f32 v101,v101
v_mfma_f32_16x16x32_bf16 v[80:83],a[120:123],a[40:43],v[80:83]
s_add_u32 m0,s22,24576
v_exp_f32 v102,v102
v_mfma_f32_16x16x32_bf16 v[80:83],a[124:127],a[44:47],v[80:83]
v_exp_f32 v103,v103
v_mfma_f32_16x16x32_bf16 v[88:91],a[124:127],a[68:71],0
v_cvt_pk_bf16_f32 v34,v100,v101
v_cvt_pk_bf16_f32 v35,v102,v103
v_mfma_f32_16x16x32_bf16 v[88:91],a[120:123],a[64:67],v[88:91]
v_fma_f32 v72,v72,s36,v13
v_fma_f32 v73,v73,s36,v13
v_smfmac_f32_16x16x64_bf16 v[64:67],a[152:155],v[28:35],v18
v_fma_f32 v74,v74,s36,v13
v_mfma_f32_16x16x32_bf16 v[88:91],a[148:151],a[60:63],v[88:91]
v_fma_f32 v75,v75,s36,v13
v_fma_f32 v80,v80,s36,v14
v_mfma_f32_16x16x32_bf16 v[88:91],a[144:147],a[56:59],v[88:91]
v_fma_f32 v81,v81,s36,v14
v_mfma_f32_16x16x32_bf16 v[88:91],a[140:143],a[52:55],v[88:91]
buffer_load_dwordx4 v6,s[4:7],s20 offen offset:0 lds
v_mfma_f32_16x16x32_bf16 v[88:91],a[136:139],a[48:51],v[88:91]
v_exp_f32 v72,v72
v_mfma_f32_16x16x32_bf16 v[96:99],a[136:139],a[72:75],0
ds_read_b128 a[136:139],v0 offset:6272
v_mfma_f32_16x16x32_bf16 v[96:99],a[140:143],a[76:79],v[96:99]
ds_read_b128 a[140:143],v1 offset:6272
v_mfma_f32_16x16x32_bf16 v[96:99],a[144:147],a[80:83],v[96:99]
ds_read_b128 a[144:147],v0 offset:6400
v_mfma_f32_16x16x32_bf16 v[96:99],a[148:151],a[84:87],v[96:99]
ds_read_b128 a[148:151],v1 offset:6400
v_mfma_f32_16x16x32_bf16 v[96:99],a[120:123],a[88:91],v[96:99]
v_exp_f32 v73,v73
v_mfma_f32_16x16x32_bf16 v[96:99],a[124:127],a[92:95],v[96:99]
s_waitcnt lgkmcnt(4)
v_exp_f32 v74,v74
v_mfma_f32_16x16x32_bf16 v[76:79],a[128:131],a[0:3],0
v_exp_f32 v75,v75
v_mfma_f32_16x16x32_bf16 v[76:79],a[132:135],a[4:7],v[76:79]
buffer_load_dwordx4 v7,s[4:7],s20 offen offset:1024 lds
s_waitcnt lgkmcnt(3)
v_mfma_f32_16x16x32_bf16 v[76:79],a[136:139],a[8:11],v[76:79]
s_waitcnt lgkmcnt(2)
v_exp_f32 v80,v80
v_mfma_f32_16x16x32_bf16 v[76:79],a[140:143],a[12:15],v[76:79]
s_waitcnt lgkmcnt(0)
v_exp_f32 v81,v81
v_mfma_f32_16x16x32_bf16 v[76:79],a[144:147],a[16:19],v[76:79]
v_cvt_pk_bf16_f32 v44,v72,v73
v_cvt_pk_bf16_f32 v45,v74,v75
v_mfma_f32_16x16x32_bf16 v[76:79],a[148:151],a[20:23],v[76:79]
v_cvt_pk_bf16_f32 v48,v80,v81
v_mfma_f32_16x16x32_bf16 v[84:87],a[148:151],a[44:47],0
v_mfma_f32_16x16x32_bf16 v[84:87],a[144:147],a[40:43],v[84:87]
v_mfma_f32_16x16x32_bf16 v[84:87],a[140:143],a[36:39],v[84:87]
v_mfma_f32_16x16x32_bf16 v[84:87],a[136:139],a[32:35],v[84:87]
v_mfma_f32_16x16x32_bf16 v[84:87],a[132:135],a[28:31],v[84:87]
buffer_load_dwordx4 v8,s[4:7],s20 offen offset:2048 lds
v_mfma_f32_16x16x32_bf16 v[84:87],a[128:131],a[24:27],v[84:87]
s_add_u32 s20,s20,12288
v_mfma_f32_16x16x32_bf16 v[92:95],a[128:131],a[48:51],0
ds_read_b64_tr_b16 a[120:121],v2 offset:24576
v_mfma_f32_16x16x32_bf16 v[92:95],a[132:135],a[52:55],v[92:95]
ds_read_b64_tr_b16 a[122:123],v2 offset:30720
v_mfma_f32_16x16x32_bf16 v[92:95],a[136:139],a[56:59],v[92:95]
ds_read_b64_tr_b16 a[124:125],v3 offset:24576
v_mfma_f32_16x16x32_bf16 v[92:95],a[140:143],a[60:63],v[92:95]
ds_read_b64_tr_b16 a[126:127],v3 offset:30720
v_mfma_f32_16x16x32_bf16 v[92:95],a[144:147],a[64:67],v[92:95]
v_mfma_f32_16x16x32_bf16 v[92:95],a[148:151],a[68:71],v[92:95]
v_mfma_f32_16x16x32_bf16 v[100:103],a[148:151],a[92:95],0
v_mfma_f32_16x16x32_bf16 v[100:103],a[144:147],a[88:91],v[100:103]
v_mfma_f32_16x16x32_bf16 v[100:103],a[140:143],a[84:87],v[100:103]
v_mfma_f32_16x16x32_bf16 v[100:103],a[136:139],a[80:83],v[100:103]
v_mfma_f32_16x16x32_bf16 v[100:103],a[132:135],a[76:79],v[100:103]
ds_read_b64_tr_b16 a[132:133],v5 offset:24576
v_mfma_f32_16x16x32_bf16 v[100:103],a[128:131],a[72:75],v[100:103]
ds_read_b64_tr_b16 a[128:129],v4 offset:24576
ds_read_b64_tr_b16 a[130:131],v4 offset:30720
ds_read_b64_tr_b16 a[134:135],v5 offset:30720
s_mov_b32 s38,0
s_branch L_loop4
L_end5:
s_waitcnt lgkmcnt(3)
v_mfma_f32_16x16x32_bf16 v[160:163],a[120:123],v[20:23],v[160:163]
ds_read_b64_tr_b16 a[136:137],v2 offset:24704
v_fma_f32 v90,v90,s36,v15
v_mfma_f32_16x16x32_bf16 v[164:167],a[124:127],v[20:23],v[164:167]
ds_read_b64_tr_b16 a[138:139],v2 offset:30848
v_fma_f32 v91,v91,s36,v15
v_mfma_f32_16x16x32_bf16 v[212:215],a[124:127],v[24:27],v[212:215]
ds_read_b64_tr_b16 a[140:141],v3 offset:24704
v_fma_f32 v96,v96,s36,v16
v_mfma_f32_16x16x32_bf16 v[208:211],a[120:123],v[24:27],v[208:211]
ds_read_b64_tr_b16 a[142:143],v3 offset:30848
v_fma_f32 v97,v97,s36,v16
v_mfma_f32_16x16x32_bf16 v[112:115],a[120:123],v[28:31],v[112:115]
ds_read_b64_tr_b16 a[144:145],v4 offset:24704
v_fma_f32 v98,v98,s36,v16
v_mfma_f32_16x16x32_bf16 v[116:119],a[124:127],v[28:31],v[116:119]
ds_read_b64_tr_b16 a[146:147],v4 offset:30848
ds_read_b64_tr_b16 a[148:149],v5 offset:24704
ds_read_b64_tr_b16 a[150:151],v5 offset:30848
v_mfma_f32_16x16x32_bf16 a[164:167],a[124:127],v[32:35],a[164:167]
v_fma_f32 v99,v99,s36,v16
v_fma_f32 v104,v104,s36,v17
v_mfma_f32_16x16x32_bf16 a[160:163],a[120:123],v[32:35],a[160:163]
v_fma_f32 v105,v105,s36,v17
v_fma_f32 v106,v106,s36,v17
v_mfma_f32_16x16x32_bf16 a[208:211],a[120:123],v[36:39],a[208:211]
ds_read_b64_tr_b16 a[120:121],v2 offset:24832
v_fma_f32 v107,v107,s36,v17
v_mfma_f32_16x16x32_bf16 a[212:215],a[124:127],v[36:39],a[212:215]
s_waitcnt lgkmcnt(6)
ds_read_b64_tr_b16 a[122:123],v2 offset:30976
v_fma_f32 v76,v76,s36,v13
v_mfma_f32_16x16x32_bf16 a[216:219],a[128:131],v[36:39],a[216:219]
ds_read_b64_tr_b16 a[124:125],v3 offset:24832
v_fma_f32 v77,v77,s36,v13
v_mfma_f32_16x16x32_bf16 a[220:223],a[132:135],v[36:39],a[220:223]
ds_read_b64_tr_b16 a[126:127],v3 offset:30976
v_fma_f32 v78,v78,s36,v13
v_mfma_f32_16x16x32_bf16 a[172:175],a[132:135],v[32:35],a[172:175]
v_fma_f32 v79,v79,s36,v13
v_fma_f32 v84,v84,s36,v14
v_mfma_f32_16x16x32_bf16 a[168:171],a[128:131],v[32:35],a[168:171]
v_fma_f32 v85,v85,s36,v14
v_fma_f32 v86,v86,s36,v14
v_mfma_f32_16x16x32_bf16 v[120:123],a[128:131],v[28:31],v[120:123]
v_fma_f32 v87,v87,s36,v14
v_fma_f32 v92,v92,s36,v15
v_mfma_f32_16x16x32_bf16 v[124:127],a[132:135],v[28:31],v[124:127]
v_fma_f32 v93,v93,s36,v15
v_fma_f32 v94,v94,s36,v15
v_mfma_f32_16x16x32_bf16 v[220:223],a[132:135],v[24:27],v[220:223]
v_fma_f32 v95,v95,s36,v15
v_fma_f32 v100,v100,s36,v16
v_mfma_f32_16x16x32_bf16 v[216:219],a[128:131],v[24:27],v[216:219]
v_fma_f32 v101,v101,s36,v16
v_fma_f32 v102,v102,s36,v16
v_mfma_f32_16x16x32_bf16 v[168:171],a[128:131],v[20:23],v[168:171]
ds_read_b64_tr_b16 a[128:129],v4 offset:24832
v_fma_f32 v103,v103,s36,v16
v_mfma_f32_16x16x32_bf16 v[172:175],a[132:135],v[20:23],v[172:175]
ds_read_b64_tr_b16 a[130:131],v4 offset:30976
v_fma_f32 v108,v108,s36,v17
v_mfma_f32_16x16x32_bf16 v[176:179],a[136:139],v[20:23],v[176:179]
s_waitcnt lgkmcnt(2)
ds_read_b64_tr_b16 a[132:133],v5 offset:24832
v_fma_f32 v109,v109,s36,v17
v_mfma_f32_16x16x32_bf16 v[180:183],a[140:143],v[20:23],v[180:183]
ds_read_b64_tr_b16 a[134:135],v5 offset:30976
v_fma_f32 v110,v110,s36,v17
v_mfma_f32_16x16x32_bf16 v[228:231],a[140:143],v[24:27],v[228:231]
v_fma_f32 v111,v111,s36,v17
v_exp_f32 v90,v90
v_mfma_f32_16x16x32_bf16 v[224:227],a[136:139],v[24:27],v[224:227]
v_exp_f32 v91,v91
v_mfma_f32_16x16x32_bf16 v[128:131],a[136:139],v[28:31],v[128:131]
v_exp_f32 v96,v96
v_mfma_f32_16x16x32_bf16 v[132:135],a[140:143],v[28:31],v[132:135]
v_exp_f32 v97,v97
v_mfma_f32_16x16x32_bf16 a[180:183],a[140:143],v[32:35],a[180:183]
v_exp_f32 v98,v98
v_mfma_f32_16x16x32_bf16 a[176:179],a[136:139],v[32:35],a[176:179]
v_exp_f32 v99,v99
v_mfma_f32_16x16x32_bf16 a[224:227],a[136:139],v[36:39],a[224:227]
v_exp_f32 v104,v104
v_mfma_f32_16x16x32_bf16 a[228:231],a[140:143],v[36:39],a[228:231]
v_exp_f32 v105,v105
v_mfma_f32_16x16x32_bf16 a[232:235],a[144:147],v[36:39],a[232:235]
v_exp_f32 v106,v106
v_mfma_f32_16x16x32_bf16 a[236:239],a[148:151],v[36:39],a[236:239]
v_exp_f32 v107,v107
v_mfma_f32_16x16x32_bf16 a[188:191],a[148:151],v[32:35],a[188:191]
v_exp_f32 v76,v76
v_mfma_f32_16x16x32_bf16 a[184:187],a[144:147],v[32:35],a[184:187]
v_exp_f32 v77,v77
v_mfma_f32_16x16x32_bf16 v[136:139],a[144:147],v[28:31],v[136:139]
v_exp_f32 v78,v78
v_mfma_f32_16x16x32_bf16 v[140:143],a[148:151],v[28:31],v[140:143]
v_exp_f32 v79,v79
v_mfma_f32_16x16x32_bf16 v[236:239],a[148:151],v[24:27],v[236:239]
v_exp_f32 v84,v84
v_mfma_f32_16x16x32_bf16 v[232:235],a[144:147],v[24:27],v[232:235]
v_exp_f32 v85,v85
v_mfma_f32_16x16x32_bf16 v[184:187],a[144:147],v[20:23],v[184:187]
v_exp_f32 v86,v86
v_mfma_f32_16x16x32_bf16 v[188:191],a[148:151],v[20:23],v[188:191]
v_exp_f32 v87,v87
v_mfma_f32_16x16x32_bf16 v[192:195],a[120:123],v[20:23],v[192:195]
v_exp_f32 v92,v92
v_mfma_f32_16x16x32_bf16 v[196:199],a[124:127],v[20:23],v[196:199]
v_exp_f32 v93,v93
v_mfma_f32_16x16x32_bf16 v[244:247],a[124:127],v[24:27],v[244:247]
v_exp_f32 v94,v94
v_mfma_f32_16x16x32_bf16 v[240:243],a[120:123],v[24:27],v[240:243]
v_exp_f32 v95,v95
v_mfma_f32_16x16x32_bf16 v[144:147],a[120:123],v[28:31],v[144:147]
v_exp_f32 v100,v100
v_mfma_f32_16x16x32_bf16 v[148:151],a[124:127],v[28:31],v[148:151]
v_exp_f32 v101,v101
v_mfma_f32_16x16x32_bf16 a[196:199],a[124:127],v[32:35],a[196:199]
v_exp_f32 v102,v102
v_mfma_f32_16x16x32_bf16 a[192:195],a[120:123],v[32:35],a[192:195]
v_exp_f32 v103,v103
v_mfma_f32_16x16x32_bf16 a[240:243],a[120:123],v[36:39],a[240:243]
v_exp_f32 v108,v108
s_waitcnt vmcnt(14) lgkmcnt(0)
s_barrier
v_mfma_f32_16x16x32_bf16 a[244:247],a[124:127],v[36:39],a[244:247]
v_exp_f32 v109,v109
v_mfma_f32_16x16x32_bf16 a[248:251],a[128:131],v[36:39],a[248:251]
v_exp_f32 v110,v110
v_mfma_f32_16x16x32_bf16 a[252:255],a[132:135],v[36:39],a[252:255]
v_exp_f32 v111,v111
v_mfma_f32_16x16x32_bf16 a[204:207],a[132:135],v[32:35],a[204:207]
v_cvt_pk_bf16_f32 v53,v90,v91
v_cvt_pk_bf16_f32 v56,v96,v97
v_mfma_f32_16x16x32_bf16 a[200:203],a[128:131],v[32:35],a[200:203]
v_cvt_pk_bf16_f32 v57,v98,v99
v_cvt_pk_bf16_f32 v40,v104,v105
v_mfma_f32_16x16x32_bf16 v[152:155],a[128:131],v[28:31],v[152:155]
v_cvt_pk_bf16_f32 v41,v106,v107
v_cvt_pk_bf16_f32 v46,v76,v77
v_mfma_f32_16x16x32_bf16 v[156:159],a[132:135],v[28:31],v[156:159]
v_cvt_pk_bf16_f32 v47,v78,v79
v_cvt_pk_bf16_f32 v50,v84,v85
v_mfma_f32_16x16x32_bf16 v[252:255],a[132:135],v[24:27],v[252:255]
v_cvt_pk_bf16_f32 v51,v86,v87
v_cvt_pk_bf16_f32 v54,v92,v93
v_mfma_f32_16x16x32_bf16 v[248:251],a[128:131],v[24:27],v[248:251]
v_cvt_pk_bf16_f32 v55,v94,v95
v_cvt_pk_bf16_f32 v58,v100,v101
v_smfmac_f32_16x16x64_bf16 v[60:63],a[152:155],v[44:51],v18
v_cvt_pk_bf16_f32 v59,v102,v103
v_mfma_f32_16x16x32_bf16 v[200:203],a[128:131],v[20:23],v[200:203]
v_cvt_pk_bf16_f32 v42,v108,v109
v_cvt_pk_bf16_f32 v43,v110,v111
v_smfmac_f32_16x16x64_bf16 v[64:67],a[152:155],v[52:59],v18
v_subrev_u32 v10,18432,v10
v_smfmac_f32_16x16x64_bf16 v[68:71],a[152:155],v[36:43],v18
v_mfma_f32_16x16x32_bf16 v[204:207],a[132:135],v[20:23],v[204:207]
ds_read_b64_tr_b16 a[136:137],v2 offset:0
ds_read_b64_tr_b16 a[138:139],v2 offset:6144
ds_read_b64_tr_b16 a[140:141],v3 offset:0
ds_read_b64_tr_b16 a[142:143],v3 offset:6144
ds_read_b64_tr_b16 a[144:145],v4 offset:0
ds_read_b64_tr_b16 a[146:147],v4 offset:6144
ds_read_b64_tr_b16 a[148:149],v5 offset:0
ds_read_b64_tr_b16 a[150:151],v5 offset:6144
s_waitcnt lgkmcnt(6)
v_mfma_f32_16x16x32_bf16 v[160:163],a[136:139],v[44:47],v[160:163]
s_waitcnt vmcnt(6)
ds_read_b64_tr_b16 a[122:123],v2 offset:6272
v_mbcnt_lo_u32_b32 v39,-1,0
s_waitcnt lgkmcnt(5)
v_mfma_f32_16x16x32_bf16 v[164:167],a[140:143],v[44:47],v[164:167]
s_add_u32 s84,s42,0
ds_read_b64_tr_b16 a[120:121],v2 offset:128
v_mbcnt_hi_u32_b32 v39,-1,v39
v_mfma_f32_16x16x32_bf16 v[212:215],a[140:143],v[48:51],v[212:215]
s_add_u32 s85,s42,6144
ds_read_b64_tr_b16 a[126:127],v3 offset:6272
v_and_b32 v38,7,v39
v_mfma_f32_16x16x32_bf16 v[208:211],a[136:139],v[48:51],v[208:211]
s_add_u32 s86,s42,12288
ds_read_b64_tr_b16 a[124:125],v3 offset:128
v_add_f32 v60,v60,v61
v_mfma_f32_16x16x32_bf16 v[112:115],a[136:139],v[52:55],v[112:115]
s_add_u32 s87,s42,18432
ds_read_b64_tr_b16 a[128:129],v4 offset:128
v_add_f32 v64,v64,v65
v_mfma_f32_16x16x32_bf16 v[116:119],a[140:143],v[52:55],v[116:119]
s_add_u32 s66,s42,24576
ds_read_b64_tr_b16 a[130:131],v4 offset:6272
v_add_f32 v62,v62,v63
v_mfma_f32_16x16x32_bf16 a[164:167],a[140:143],v[56:59],a[164:167]
ds_read_b64_tr_b16 a[132:133],v5 offset:128
v_max3_f32 v19,v60,v62,v64
v_mfma_f32_16x16x32_bf16 a[160:163],a[136:139],v[56:59],a[160:163]
ds_read_b64_tr_b16 a[134:135],v5 offset:6272
v_add_f32 v68,v68,v69
v_mfma_f32_16x16x32_bf16 a[208:211],a[136:139],v[40:43],a[208:211]
ds_read_b64_tr_b16 a[136:137],v2 offset:256
v_add_f32 v68,v68,v70
v_mfma_f32_16x16x32_bf16 a[212:215],a[140:143],v[40:43],a[212:215]
s_waitcnt lgkmcnt(6)
ds_read_b64_tr_b16 a[138:139],v2 offset:6400
v_add_f32 v66,v66,v67
v_mfma_f32_16x16x32_bf16 a[216:219],a[144:147],v[40:43],a[216:219]
ds_read_b64_tr_b16 a[140:141],v3 offset:256
v_add_f32 v68,v68,v71
v_mfma_f32_16x16x32_bf16 a[220:223],a[148:151],v[40:43],a[220:223]
ds_read_b64_tr_b16 a[142:143],v3 offset:6400
v_max3_f32 v19,v19,v66,v68
v_rcp_f32 v66,v66
v_rcp_f32 v68,v68
v_accvgpr_read_b32 v74,a162
v_accvgpr_read_b32 v75,a163
v_pk_mul_f32 v[74:75],v[74:75],v[66:67] op_sel_hi:[1,0]
v_accvgpr_read_b32 v79,a211
v_accvgpr_read_b32 v72,a160
v_accvgpr_read_b32 v76,a208
v_accvgpr_read_b32 v73,a161
v_pk_mul_f32 v[72:73],v[72:73],v[66:67] op_sel_hi:[1,0]
v_accvgpr_read_b32 v77,a209
v_pk_mul_f32 v[76:77],v[76:77],v[68:69] op_sel_hi:[1,0]
v_accvgpr_read_b32 v78,a210
v_pk_mul_f32 v[78:79],v[78:79],v[68:69] op_sel_hi:[1,0]
v_accvgpr_read_b32 v84,a212
v_accvgpr_read_b32 v82,a166
v_mfma_f32_16x16x32_bf16 a[172:175],a[148:151],v[56:59],a[172:175]
v_accvgpr_read_b32 v87,a215
v_accvgpr_read_b32 v83,a167
v_accvgpr_read_b32 v80,a164
v_accvgpr_read_b32 v81,a165
v_accvgpr_read_b32 v86,a214
v_pk_mul_f32 v[86:87],v[86:87],v[68:69] op_sel_hi:[1,0]
v_pk_mul_f32 v[80:81],v[80:81],v[66:67] op_sel_hi:[1,0]
v_pk_mul_f32 v[82:83],v[82:83],v[66:67] op_sel_hi:[1,0]
v_accvgpr_read_b32 v85,a213
v_pk_mul_f32 v[84:85],v[84:85],v[68:69] op_sel_hi:[1,0]
v_accvgpr_read_b32 v102,a222
v_accvgpr_read_b32 v96,a172
v_mfma_f32_16x16x32_bf16 a[168:171],a[144:147],v[56:59],a[168:171]
v_accvgpr_read_b32 v103,a223
v_accvgpr_read_b32 v94,a218
v_mfma_f32_16x16x32_bf16 v[120:123],a[144:147],v[52:55],v[120:123]
v_accvgpr_read_b32 v99,a175
v_accvgpr_read_b32 v100,a220
v_mfma_f32_16x16x32_bf16 v[124:127],a[148:151],v[52:55],v[124:127]
v_accvgpr_read_b32 v97,a173
v_accvgpr_read_b32 v95,a219
v_mfma_f32_16x16x32_bf16 v[220:223],a[148:151],v[48:51],v[220:223]
v_accvgpr_read_b32 v90,a170
v_accvgpr_read_b32 v91,a171
v_accvgpr_read_b32 v89,a169
v_accvgpr_read_b32 v88,a168
v_accvgpr_read_b32 v98,a174
v_pk_mul_f32 v[94:95],v[94:95],v[68:69] op_sel_hi:[1,0]
v_pk_mul_f32 v[102:103],v[102:103],v[68:69] op_sel_hi:[1,0]
v_pk_mul_f32 v[88:89],v[88:89],v[66:67] op_sel_hi:[1,0]
v_pk_mul_f32 v[98:99],v[98:99],v[66:67] op_sel_hi:[1,0]
v_pk_mul_f32 v[90:91],v[90:91],v[66:67] op_sel_hi:[1,0]
v_pk_mul_f32 v[96:97],v[96:97],v[66:67] op_sel_hi:[1,0]
v_accvgpr_read_b32 v93,a217
v_accvgpr_read_b32 v92,a216
v_pk_mul_f32 v[92:93],v[92:93],v[68:69] op_sel_hi:[1,0]
v_accvgpr_read_b32 v101,a221
v_pk_mul_f32 v[100:101],v[100:101],v[68:69] op_sel_hi:[1,0]
v_cmp_ngt_f32 vcc,s37,v19
v_lshrrev_b32 v19,5,v39
v_mfma_f32_16x16x32_bf16 v[216:219],a[144:147],v[48:51],v[216:219]
v_xor_b32 v38,v38,v19
v_and_b32 v19,15,v39
v_mfma_f32_16x16x32_bf16 v[168:171],a[144:147],v[44:47],v[168:171]
s_cmp_lg_u64 vcc,0
ds_read_b64_tr_b16 a[144:145],v4 offset:256
v_lshl_add_u32 v19,v19,7,s24
v_mfma_f32_16x16x32_bf16 v[172:175],a[148:151],v[44:47],v[172:175]
s_cselect_b32 s62,s32,0
ds_read_b64_tr_b16 a[146:147],v4 offset:6400
v_lshl_add_u32 v19,v38,4,v19
v_mfma_f32_16x16x32_bf16 v[176:179],a[120:123],v[44:47],v[176:179]
s_or_b32 s31,s31,s62
ds_read_b64_tr_b16 a[148:149],v5 offset:256
v_bfe_u32 v38,v39,4,1
s_waitcnt lgkmcnt(3)
v_mfma_f32_16x16x32_bf16 v[180:183],a[124:127],v[44:47],v[180:183]
s_lshl_b32 s32,s32,1
ds_read_b64_tr_b16 a[150:151],v5 offset:6400
v_lshl_add_u32 v36,v38,3,v19
v_mfma_f32_16x16x32_bf16 v[228:231],a[124:127],v[48:51],v[228:231]
v_xor_b32 v37,32,v36
v_xor_b32 v38,64,v36
v_mfma_f32_16x16x32_bf16 v[224:227],a[120:123],v[48:51],v[224:227]
v_bfe_u32 v19,v39,3,1
v_xor_b32 v39,96,v36
v_mfma_f32_16x16x32_bf16 v[128:131],a[120:123],v[52:55],v[128:131]
v_lshlrev_b32 v19,11,v19
v_cvt_pk_bf16_f32 v72,v72,v73
v_mfma_f32_16x16x32_bf16 v[132:135],a[124:127],v[52:55],v[132:135]
v_cvt_pk_bf16_f32 v76,v76,v77
v_cvt_pk_bf16_f32 v73,v74,v75
v_mfma_f32_16x16x32_bf16 a[180:183],a[124:127],v[56:59],a[180:183]
v_cvt_pk_bf16_f32 v84,v84,v85
v_cvt_pk_bf16_f32 v77,v78,v79
v_mfma_f32_16x16x32_bf16 a[176:179],a[120:123],v[56:59],a[176:179]
ds_write2st64_b64 v36,v[72:73],v[76:77] offset0:36 offset1:40
v_mfma_f32_16x16x32_bf16 a[224:227],a[120:123],v[40:43],a[224:227]
v_cvt_pk_bf16_f32 v85,v86,v87
v_cvt_pk_bf16_f32 v80,v80,v81
v_mfma_f32_16x16x32_bf16 a[228:231],a[124:127],v[40:43],a[228:231]
v_cvt_pk_bf16_f32 v81,v82,v83
v_cvt_pk_bf16_f32 v92,v92,v93
v_mfma_f32_16x16x32_bf16 a[232:235],a[128:131],v[40:43],a[232:235]
v_accvgpr_read_b32 v83,a179
v_accvgpr_read_b32 v82,a178
v_mfma_f32_16x16x32_bf16 a[236:239],a[132:135],v[40:43],a[236:239]
ds_write2st64_b64 v37,v[80:81],v[84:85] offset0:36 offset1:40
v_pk_mul_f32 v[82:83],v[82:83],v[66:67] op_sel_hi:[1,0]
v_accvgpr_read_b32 v84,a224
v_accvgpr_read_b32 v85,a225
v_pk_mul_f32 v[84:85],v[84:85],v[68:69] op_sel_hi:[1,0]
v_accvgpr_read_b32 v81,a177
v_accvgpr_read_b32 v87,a227
v_accvgpr_read_b32 v86,a226
v_pk_mul_f32 v[86:87],v[86:87],v[68:69] op_sel_hi:[1,0]
v_accvgpr_read_b32 v80,a176
v_pk_mul_f32 v[80:81],v[80:81],v[66:67] op_sel_hi:[1,0]
v_cvt_pk_bf16_f32 v93,v94,v95
v_cvt_pk_bf16_f32 v88,v88,v89
v_mfma_f32_16x16x32_bf16 a[188:191],a[132:135],v[56:59],a[188:191]
v_cvt_pk_bf16_f32 v89,v90,v91
ds_write2st64_b64 v38,v[88:89],v[92:93] offset0:36 offset1:40
v_accvgpr_read_b32 v88,a180
v_accvgpr_read_b32 v93,a229
v_accvgpr_read_b32 v90,a182
v_accvgpr_read_b32 v94,a230
v_accvgpr_read_b32 v95,a231
v_pk_mul_f32 v[94:95],v[94:95],v[68:69] op_sel_hi:[1,0]
v_accvgpr_read_b32 v89,a181
v_pk_mul_f32 v[88:89],v[88:89],v[66:67] op_sel_hi:[1,0]
v_accvgpr_read_b32 v92,a228
v_pk_mul_f32 v[92:93],v[92:93],v[68:69] op_sel_hi:[1,0]
v_accvgpr_read_b32 v91,a183
v_pk_mul_f32 v[90:91],v[90:91],v[66:67] op_sel_hi:[1,0]
v_cvt_pk_bf16_f32 v100,v100,v101
v_cvt_pk_bf16_f32 v101,v102,v103
v_mfma_f32_16x16x32_bf16 a[184:187],a[128:131],v[56:59],a[184:187]
v_cvt_pk_bf16_f32 v96,v96,v97
v_cvt_pk_bf16_f32 v97,v98,v99
v_mfma_f32_16x16x32_bf16 v[136:139],a[128:131],v[52:55],v[136:139]
ds_write2st64_b64 v39,v[96:97],v[100:101] offset0:36 offset1:40
v_mfma_f32_16x16x32_bf16 v[140:143],a[132:135],v[52:55],v[140:143]
v_cvt_pk_bf16_f32 v80,v80,v81
v_cvt_pk_bf16_f32 v81,v82,v83
v_mfma_f32_16x16x32_bf16 v[236:239],a[132:135],v[48:51],v[236:239]
ds_read_b128 v[104:107],v10 offset:18432
v_accvgpr_read_b32 v96,a184
ds_read_b128 v[108:111],v10 offset:19456
v_cvt_pk_bf16_f32 v84,v84,v85
ds_read_b128 v[72:75],v10 offset:20480
v_cvt_pk_bf16_f32 v85,v86,v87
ds_read_b128 v[76:79],v10 offset:21504
v_accvgpr_read_b32 v87,a239
ds_write2st64_b64 v36,v[80:81],v[84:85] offset0:36 offset1:40
v_accvgpr_read_b32 v98,a186
v_accvgpr_read_b32 v101,a233
v_accvgpr_read_b32 v100,a232
v_pk_mul_f32 v[100:101],v[100:101],v[68:69] op_sel_hi:[1,0]
v_accvgpr_read_b32 v86,a238
v_pk_mul_f32 v[86:87],v[86:87],v[68:69] op_sel_hi:[1,0]
v_accvgpr_read_b32 v81,a189
s_waitcnt lgkmcnt(4)
buffer_store_dwordx4 v[104:107],v9,s[16:19],s87 offen offset:0 nt
v_accvgpr_read_b32 v80,a188
v_pk_mul_f32 v[80:81],v[80:81],v[66:67] op_sel_hi:[1,0]
v_accvgpr_read_b32 v102,a234
v_accvgpr_read_b32 v83,a191
v_accvgpr_read_b32 v85,a237
v_accvgpr_read_b32 v84,a236
v_pk_mul_f32 v[84:85],v[84:85],v[68:69] op_sel_hi:[1,0]
v_accvgpr_read_b32 v97,a185
v_pk_mul_f32 v[96:97],v[96:97],v[66:67] op_sel_hi:[1,0]
v_accvgpr_read_b32 v82,a190
v_pk_mul_f32 v[82:83],v[82:83],v[66:67] op_sel_hi:[1,0]
s_waitcnt lgkmcnt(1)
buffer_store_dwordx4 v[108:111],v9,s[16:19],s87 offen offset:3072 nt
v_accvgpr_read_b32 v99,a187
v_pk_mul_f32 v[98:99],v[98:99],v[66:67] op_sel_hi:[1,0]
v_accvgpr_read_b32 v103,a235
v_pk_mul_f32 v[102:103],v[102:103],v[68:69] op_sel_hi:[1,0]
v_cvt_pk_bf16_f32 v88,v88,v89
v_cvt_pk_bf16_f32 v89,v90,v91
v_mfma_f32_16x16x32_bf16 v[232:235],a[128:131],v[48:51],v[232:235]
v_cvt_pk_bf16_f32 v92,v92,v93
v_cvt_pk_bf16_f32 v93,v94,v95
v_mfma_f32_16x16x32_bf16 v[184:187],a[128:131],v[44:47],v[184:187]
ds_write2st64_b64 v37,v[88:89],v[92:93] offset0:36 offset1:40
v_mfma_f32_16x16x32_bf16 v[188:191],a[132:135],v[44:47],v[188:191]
v_cvt_pk_bf16_f32 v96,v96,v97
v_cvt_pk_bf16_f32 v97,v98,v99
v_mfma_f32_16x16x32_bf16 v[192:195],a[136:139],v[44:47],v[192:195]
buffer_store_dwordx4 v[72:75],v9,s[16:19],s66 offen offset:0 nt
v_cvt_pk_bf16_f32 v100,v100,v101
v_cvt_pk_bf16_f32 v80,v80,v81
v_cvt_pk_bf16_f32 v101,v102,v103
v_mfma_f32_16x16x32_bf16 v[196:199],a[140:143],v[44:47],v[196:199]
v_cvt_pk_bf16_f32 v81,v82,v83
v_cvt_pk_bf16_f32 v84,v84,v85
v_mfma_f32_16x16x32_bf16 v[244:247],a[140:143],v[48:51],v[244:247]
v_cvt_pk_bf16_f32 v85,v86,v87
v_rcp_f32 v62,v62
v_mfma_f32_16x16x32_bf16 v[240:243],a[136:139],v[48:51],v[240:243]
ds_write2st64_b64 v38,v[96:97],v[100:101] offset0:36 offset1:40
v_mfma_f32_16x16x32_bf16 v[144:147],a[136:139],v[52:55],v[144:147]
v_rcp_f32 v64,v64
v_mfma_f32_16x16x32_bf16 v[148:151],a[140:143],v[52:55],v[148:151]
buffer_store_dwordx4 v[76:79],v9,s[16:19],s66 offen offset:3072 nt
v_rcp_f32 v60,v60
v_mfma_f32_16x16x32_bf16 a[196:199],a[140:143],v[56:59],a[196:199]
v_mfma_f32_16x16x32_bf16 a[192:195],a[136:139],v[56:59],a[192:195]
v_mfma_f32_16x16x32_bf16 a[240:243],a[136:139],v[40:43],a[240:243]
ds_write2st64_b64 v39,v[80:81],v[84:85] offset0:36 offset1:40
v_mfma_f32_16x16x32_bf16 a[244:247],a[140:143],v[40:43],a[244:247]
v_mfma_f32_16x16x32_bf16 a[248:251],a[144:147],v[40:43],a[248:251]
ds_read_b128 v[72:75],v10 offset:18432
v_mfma_f32_16x16x32_bf16 a[252:255],a[148:151],v[40:43],a[252:255]
ds_read_b128 v[76:79],v10 offset:19456
v_accvgpr_read_b32 v98,a198
ds_read_b128 v[88:91],v10 offset:20480
v_accvgpr_read_b32 v107,a195
ds_read_b128 v[92:95],v10 offset:21504
v_accvgpr_read_b32 v104,a192
v_accvgpr_read_b32 v111,a243
v_accvgpr_read_b32 v108,a240
v_accvgpr_read_b32 v106,a194
v_pk_mul_f32 v[106:107],v[106:107],v[66:67] op_sel_hi:[1,0]
v_accvgpr_read_b32 v105,a193
v_pk_mul_f32 v[104:105],v[104:105],v[66:67] op_sel_hi:[1,0]
v_accvgpr_read_b32 v109,a241
v_pk_mul_f32 v[108:109],v[108:109],v[68:69] op_sel_hi:[1,0]
v_accvgpr_read_b32 v110,a242
v_pk_mul_f32 v[110:111],v[110:111],v[68:69] op_sel_hi:[1,0]
v_accvgpr_read_b32 v100,a244
v_accvgpr_read_b32 v97,a197
v_mfma_f32_16x16x32_bf16 a[204:207],a[148:151],v[56:59],a[204:207]
s_waitcnt lgkmcnt(3)
v_accvgpr_read_b32 v102,a246
buffer_store_dwordx4 v[72:75],v9,s[16:19],s87 offen offset:128 nt
v_accvgpr_read_b32 v99,a199
v_pk_mul_f32 v[98:99],v[98:99],v[66:67] op_sel_hi:[1,0]
v_accvgpr_read_b32 v103,a247
v_pk_mul_f32 v[102:103],v[102:103],v[68:69] op_sel_hi:[1,0]
v_accvgpr_read_b32 v101,a245
v_pk_mul_f32 v[100:101],v[100:101],v[68:69] op_sel_hi:[1,0]
v_accvgpr_read_b32 v96,a196
v_pk_mul_f32 v[96:97],v[96:97],v[66:67] op_sel_hi:[1,0]
v_cvt_pk_bf16_f32 v108,v108,v109
v_cvt_pk_bf16_f32 v109,v110,v111
v_mfma_f32_16x16x32_bf16 a[200:203],a[144:147],v[56:59],a[200:203]
v_cvt_pk_bf16_f32 v104,v104,v105
v_accvgpr_read_b32 v86,a250
v_mfma_f32_16x16x32_bf16 v[152:155],a[144:147],v[52:55],v[152:155]
s_waitcnt lgkmcnt(0)
buffer_store_dwordx4 v[76:79],v9,s[16:19],s87 offen offset:3200 nt
v_cvt_pk_bf16_f32 v105,v106,v107
v_accvgpr_read_b32 v84,a248
v_accvgpr_read_b32 v106,a206
v_mfma_f32_16x16x32_bf16 v[156:159],a[148:151],v[52:55],v[156:159]
v_accvgpr_read_b32 v81,a201
v_accvgpr_read_b32 v80,a200
v_mfma_f32_16x16x32_bf16 v[252:255],a[148:151],v[48:51],v[252:255]
v_accvgpr_read_b32 v83,a203
ds_write2st64_b64 v36,v[104:105],v[108:109] offset0:36 offset1:40
v_pk_mul_f32 v[80:81],v[80:81],v[66:67] op_sel_hi:[1,0]
v_pk_mul_f32 v[228:229],v[228:229],v[62:63] op_sel_hi:[1,0]
v_pk_mul_f32 v[112:113],v[112:113],v[64:65] op_sel_hi:[1,0]
buffer_store_dwordx4 v[88:91],v9,s[16:19],s66 offen offset:128 nt
v_pk_mul_f32 v[238:239],v[238:239],v[62:63] op_sel_hi:[1,0]
v_pk_mul_f32 v[208:209],v[208:209],v[62:63] op_sel_hi:[1,0]
v_pk_mul_f32 v[114:115],v[114:115],v[64:65] op_sel_hi:[1,0]
v_pk_mul_f32 v[214:215],v[214:215],v[62:63] op_sel_hi:[1,0]
v_pk_mul_f32 v[220:221],v[220:221],v[62:63] op_sel_hi:[1,0]
v_pk_mul_f32 v[212:213],v[212:213],v[62:63] op_sel_hi:[1,0]
v_pk_mul_f32 v[242:243],v[242:243],v[62:63] op_sel_hi:[1,0]
v_pk_mul_f32 v[232:233],v[232:233],v[62:63] op_sel_hi:[1,0]
v_pk_mul_f32 v[236:237],v[236:237],v[62:63] op_sel_hi:[1,0]
v_pk_mul_f32 v[210:211],v[210:211],v[62:63] op_sel_hi:[1,0]
v_pk_mul_f32 v[218:219],v[218:219],v[62:63] op_sel_hi:[1,0]
buffer_store_dwordx4 v[92:95],v9,s[16:19],s66 offen offset:3200 nt
v_pk_mul_f32 v[240:241],v[240:241],v[62:63] op_sel_hi:[1,0]
v_pk_mul_f32 v[226:227],v[226:227],v[62:63] op_sel_hi:[1,0]
v_pk_mul_f32 v[234:235],v[234:235],v[62:63] op_sel_hi:[1,0]
v_pk_mul_f32 v[222:223],v[222:223],v[62:63] op_sel_hi:[1,0]
v_pk_mul_f32 v[118:119],v[118:119],v[64:65] op_sel_hi:[1,0]
v_pk_mul_f32 v[224:225],v[224:225],v[62:63] op_sel_hi:[1,0]
v_pk_mul_f32 v[116:117],v[116:117],v[64:65] op_sel_hi:[1,0]
v_pk_mul_f32 v[244:245],v[244:245],v[62:63] op_sel_hi:[1,0]
v_pk_mul_f32 v[230:231],v[230:231],v[62:63] op_sel_hi:[1,0]
v_pk_mul_f32 v[246:247],v[246:247],v[62:63] op_sel_hi:[1,0]
v_pk_mul_f32 v[216:217],v[216:217],v[62:63] op_sel_hi:[1,0]
v_add_u32 v36,v36,v19
v_accvgpr_read_b32 v108,a252
v_accvgpr_read_b32 v109,a253
v_pk_mul_f32 v[108:109],v[108:109],v[68:69] op_sel_hi:[1,0]
v_accvgpr_read_b32 v105,a205
v_cvt_pk_bf16_f32 v80,v80,v81
v_accvgpr_read_b32 v104,a204
v_pk_mul_f32 v[104:105],v[104:105],v[66:67] op_sel_hi:[1,0]
v_accvgpr_read_b32 v107,a207
v_pk_mul_f32 v[106:107],v[106:107],v[66:67] op_sel_hi:[1,0]
v_accvgpr_read_b32 v87,a251
v_pk_mul_f32 v[86:87],v[86:87],v[68:69] op_sel_hi:[1,0]
v_accvgpr_read_b32 v82,a202
v_pk_mul_f32 v[82:83],v[82:83],v[66:67] op_sel_hi:[1,0]
v_accvgpr_read_b32 v85,a249
v_pk_mul_f32 v[84:85],v[84:85],v[68:69] op_sel_hi:[1,0]
v_cvt_pk_bf16_f32 v104,v104,v105
v_cvt_pk_bf16_f32 v84,v84,v85
v_cvt_pk_bf16_f32 v85,v86,v87
v_cvt_pk_bf16_f32 v100,v100,v101
v_accvgpr_read_b32 v110,a254
v_cvt_pk_bf16_f32 v81,v82,v83
v_cvt_pk_bf16_f32 v96,v96,v97
v_cvt_pk_bf16_f32 v108,v108,v109
v_cvt_pk_bf16_f32 v101,v102,v103
v_accvgpr_read_b32 v111,a255
v_pk_mul_f32 v[110:111],v[110:111],v[68:69] op_sel_hi:[1,0]
v_cvt_pk_bf16_f32 v97,v98,v99
v_cvt_pk_bf16_f32 v109,v110,v111
v_mfma_f32_16x16x32_bf16 v[248:251],a[144:147],v[48:51],v[248:251]
ds_write2st64_b64 v37,v[96:97],v[100:101] offset0:36 offset1:40
v_mfma_f32_16x16x32_bf16 v[200:203],a[144:147],v[44:47],v[200:203]
v_add_u32 v37,v37,v19
v_cvt_pk_bf16_f32 v105,v106,v107
v_mfma_f32_16x16x32_bf16 v[204:207],a[148:151],v[44:47],v[204:207]
v_cvt_pk_bf16_f32 v224,v224,v225
v_cvt_pk_bf16_f32 v212,v212,v213
v_cvt_pk_bf16_f32 v225,v226,v227
v_cvt_pk_bf16_f32 v208,v208,v209
v_cvt_pk_bf16_f32 v209,v210,v211
ds_write2st64_b64 v38,v[80:81],v[84:85] offset0:36 offset1:40
v_pk_mul_f32 v[120:121],v[120:121],v[64:65] op_sel_hi:[1,0]
v_pk_mul_f32 v[250:251],v[250:251],v[62:63] op_sel_hi:[1,0]
v_pk_mul_f32 v[122:123],v[122:123],v[64:65] op_sel_hi:[1,0]
v_pk_mul_f32 v[252:253],v[252:253],v[62:63] op_sel_hi:[1,0]
v_pk_mul_f32 v[124:125],v[124:125],v[64:65] op_sel_hi:[1,0]
v_pk_mul_f32 v[254:255],v[254:255],v[62:63] op_sel_hi:[1,0]
v_pk_mul_f32 v[248:249],v[248:249],v[62:63] op_sel_hi:[1,0]
v_pk_mul_f32 v[126:127],v[126:127],v[64:65] op_sel_hi:[1,0]
v_pk_mul_f32 v[130:131],v[130:131],v[64:65] op_sel_hi:[1,0]
v_pk_mul_f32 v[132:133],v[132:133],v[64:65] op_sel_hi:[1,0]
v_pk_mul_f32 v[128:129],v[128:129],v[64:65] op_sel_hi:[1,0]
ds_write2st64_b64 v39,v[104:105],v[108:109] offset0:36 offset1:40
v_pk_mul_f32 v[148:149],v[148:149],v[64:65] op_sel_hi:[1,0]
v_pk_mul_f32 v[152:153],v[152:153],v[64:65] op_sel_hi:[1,0]
v_pk_mul_f32 v[146:147],v[146:147],v[64:65] op_sel_hi:[1,0]
ds_read_b128 v[72:75],v10 offset:18432
v_pk_mul_f32 v[144:145],v[144:145],v[64:65] op_sel_hi:[1,0]
ds_read_b128 v[76:79],v10 offset:19456
v_pk_mul_f32 v[136:137],v[136:137],v[64:65] op_sel_hi:[1,0]
ds_read_b128 v[88:91],v10 offset:20480
v_pk_mul_f32 v[154:155],v[154:155],v[64:65] op_sel_hi:[1,0]
ds_read_b128 v[92:95],v10 offset:21504
v_pk_mul_f32 v[156:157],v[156:157],v[64:65] op_sel_hi:[1,0]
ds_write2st64_b64 v36,v[208:209],v[224:225] offset0:12 offset1:14
v_pk_mul_f32 v[138:139],v[138:139],v[64:65] op_sel_hi:[1,0]
v_pk_mul_f32 v[134:135],v[134:135],v[64:65] op_sel_hi:[1,0]
v_pk_mul_f32 v[150:151],v[150:151],v[64:65] op_sel_hi:[1,0]
v_pk_mul_f32 v[142:143],v[142:143],v[64:65] op_sel_hi:[1,0]
v_pk_mul_f32 v[158:159],v[158:159],v[64:65] op_sel_hi:[1,0]
v_pk_mul_f32 v[140:141],v[140:141],v[64:65] op_sel_hi:[1,0]
v_pk_mul_f32 v[160:161],v[160:161],v[60:61] op_sel_hi:[1,0]
s_waitcnt lgkmcnt(4)
buffer_store_dwordx4 v[72:75],v9,s[16:19],s87 offen offset:256 nt
v_pk_mul_f32 v[180:181],v[180:181],v[60:61] op_sel_hi:[1,0]
v_pk_mul_f32 v[178:179],v[178:179],v[60:61] op_sel_hi:[1,0]
v_pk_mul_f32 v[164:165],v[164:165],v[60:61] op_sel_hi:[1,0]
v_pk_mul_f32 v[162:163],v[162:163],v[60:61] op_sel_hi:[1,0]
v_pk_mul_f32 v[176:177],v[176:177],v[60:61] op_sel_hi:[1,0]
v_pk_mul_f32 v[184:185],v[184:185],v[60:61] op_sel_hi:[1,0]
v_pk_mul_f32 v[172:173],v[172:173],v[60:61] op_sel_hi:[1,0]
v_pk_mul_f32 v[190:191],v[190:191],v[60:61] op_sel_hi:[1,0]
v_pk_mul_f32 v[166:167],v[166:167],v[60:61] op_sel_hi:[1,0]
v_pk_mul_f32 v[186:187],v[186:187],v[60:61] op_sel_hi:[1,0]
v_pk_mul_f32 v[182:183],v[182:183],v[60:61] op_sel_hi:[1,0]
s_waitcnt lgkmcnt(1)
buffer_store_dwordx4 v[76:79],v9,s[16:19],s87 offen offset:3328 nt
v_pk_mul_f32 v[168:169],v[168:169],v[60:61] op_sel_hi:[1,0]
v_pk_mul_f32 v[188:189],v[188:189],v[60:61] op_sel_hi:[1,0]
v_pk_mul_f32 v[170:171],v[170:171],v[60:61] op_sel_hi:[1,0]
v_pk_mul_f32 v[174:175],v[174:175],v[60:61] op_sel_hi:[1,0]
v_pk_mul_f32 v[192:193],v[192:193],v[60:61] op_sel_hi:[1,0]
v_pk_mul_f32 v[200:201],v[200:201],v[60:61] op_sel_hi:[1,0]
v_pk_mul_f32 v[194:195],v[194:195],v[60:61] op_sel_hi:[1,0]
v_pk_mul_f32 v[198:199],v[198:199],v[60:61] op_sel_hi:[1,0]
v_pk_mul_f32 v[202:203],v[202:203],v[60:61] op_sel_hi:[1,0]
v_pk_mul_f32 v[196:197],v[196:197],v[60:61] op_sel_hi:[1,0]
v_pk_mul_f32 v[204:205],v[204:205],v[60:61] op_sel_hi:[1,0]
buffer_store_dwordx4 v[88:91],v9,s[16:19],s66 offen offset:256 nt
v_pk_mul_f32 v[206:207],v[206:207],v[60:61] op_sel_hi:[1,0]
v_add_u32 v39,v39,v19
v_add_u32 v38,v38,v19
v_cvt_pk_bf16_f32 v216,v216,v217
v_cvt_pk_bf16_f32 v228,v228,v229
v_cvt_pk_bf16_f32 v220,v220,v221
v_cvt_pk_bf16_f32 v232,v232,v233
v_cvt_pk_bf16_f32 v233,v234,v235
v_cvt_pk_bf16_f32 v217,v218,v219
v_cvt_pk_bf16_f32 v236,v236,v237
v_cvt_pk_bf16_f32 v229,v230,v231
buffer_store_dwordx4 v[92:95],v9,s[16:19],s66 offen offset:3328 nt
v_cvt_pk_bf16_f32 v213,v214,v215
v_cvt_pk_bf16_f32 v221,v222,v223
v_cvt_pk_bf16_f32 v237,v238,v239
v_cvt_pk_bf16_f32 v240,v240,v241
v_cvt_pk_bf16_f32 v241,v242,v243
v_cvt_pk_bf16_f32 v112,v112,v113
v_cvt_pk_bf16_f32 v113,v114,v115
v_cvt_pk_bf16_f32 v124,v124,v125
v_cvt_pk_bf16_f32 v244,v244,v245
ds_write2st64_b64 v37,v[212:213],v[228:229] offset0:12 offset1:14
v_cvt_pk_bf16_f32 v245,v246,v247
v_cvt_pk_bf16_f32 v116,v116,v117
v_cvt_pk_bf16_f32 v252,v252,v253
v_cvt_pk_bf16_f32 v248,v248,v249
v_cvt_pk_bf16_f32 v249,v250,v251
v_cvt_pk_bf16_f32 v253,v254,v255
v_cvt_pk_bf16_f32 v120,v120,v121
v_cvt_pk_bf16_f32 v117,v118,v119
v_cvt_pk_bf16_f32 v121,v122,v123
v_cvt_pk_bf16_f32 v125,v126,v127
v_cvt_pk_bf16_f32 v132,v132,v133
ds_write2st64_b64 v38,v[216:217],v[232:233] offset0:12 offset1:14
v_cvt_pk_bf16_f32 v148,v148,v149
v_cvt_pk_bf16_f32 v144,v144,v145
v_cvt_pk_bf16_f32 v145,v146,v147
v_cvt_pk_bf16_f32 v128,v128,v129
v_cvt_pk_bf16_f32 v129,v130,v131
v_cvt_pk_bf16_f32 v136,v136,v137
v_cvt_pk_bf16_f32 v133,v134,v135
v_cvt_pk_bf16_f32 v149,v150,v151
v_cvt_pk_bf16_f32 v140,v140,v141
v_cvt_pk_bf16_f32 v137,v138,v139
v_cvt_pk_bf16_f32 v152,v152,v153
ds_write2st64_b64 v39,v[220:221],v[236:237] offset0:12 offset1:14
v_cvt_pk_bf16_f32 v141,v142,v143
v_cvt_pk_bf16_f32 v156,v156,v157
v_cvt_pk_bf16_f32 v153,v154,v155
ds_read_b128 v[96:99],v10 offset:6144
v_cvt_pk_bf16_f32 v157,v158,v159
ds_read_b128 v[100:103],v10 offset:9216
v_cvt_pk_bf16_f32 v180,v180,v181
ds_read_b128 v[80:83],v10 offset:7168
v_cvt_pk_bf16_f32 v160,v160,v161
ds_read_b128 v[84:87],v10 offset:10240
v_cvt_pk_bf16_f32 v168,v168,v169
ds_write2st64_b64 v36,v[240:241],v[112:113] offset0:16 offset1:24
v_cvt_pk_bf16_f32 v164,v164,v165
v_cvt_pk_bf16_f32 v165,v166,v167
v_cvt_pk_bf16_f32 v181,v182,v183
v_cvt_pk_bf16_f32 v184,v184,v185
v_cvt_pk_bf16_f32 v176,v176,v177
v_cvt_pk_bf16_f32 v185,v186,v187
v_cvt_pk_bf16_f32 v161,v162,v163
s_waitcnt lgkmcnt(4)
buffer_store_dwordx4 v[96:99],v9,s[16:19],s85 offen offset:0 nt
v_cvt_pk_bf16_f32 v177,v178,v179
v_cvt_pk_bf16_f32 v188,v188,v189
v_cvt_pk_bf16_f32 v189,v190,v191
v_cvt_pk_bf16_f32 v172,v172,v173
v_cvt_pk_bf16_f32 v173,v174,v175
v_cvt_pk_bf16_f32 v169,v170,v171
v_cvt_pk_bf16_f32 v192,v192,v193
v_cvt_pk_bf16_f32 v196,v196,v197
v_cvt_pk_bf16_f32 v193,v194,v195
ds_write2st64_b64 v37,v[244:245],v[116:117] offset0:16 offset1:24
v_cvt_pk_bf16_f32 v197,v198,v199
v_cvt_pk_bf16_f32 v200,v200,v201
v_cvt_pk_bf16_f32 v201,v202,v203
s_waitcnt lgkmcnt(1)
buffer_store_dwordx4 v[100:103],v9,s[16:19],s85 offen offset:3072 nt
v_cvt_pk_bf16_f32 v204,v204,v205
v_cvt_pk_bf16_f32 v205,v206,v207
ds_write2st64_b64 v38,v[248:249],v[120:121] offset0:16 offset1:24
buffer_store_dwordx4 v[80:83],v9,s[16:19],s85 offen offset:128 nt
ds_write2st64_b64 v39,v[252:253],v[124:125] offset0:16 offset1:24
ds_read_b128 v[104:107],v10 offset:8192
buffer_store_dwordx4 v[84:87],v9,s[16:19],s85 offen offset:3200 nt
ds_read_b128 v[108:111],v10 offset:11264
ds_read_b128 v[208:211],v10 offset:12288
ds_read_b128 v[224:227],v10 offset:15360
ds_write2st64_b64 v36,v[128:129],v[144:145] offset0:26 offset1:28
s_waitcnt lgkmcnt(4)
buffer_store_dwordx4 v[104:107],v9,s[16:19],s85 offen offset:256 nt
ds_write2st64_b64 v37,v[132:133],v[148:149] offset0:26 offset1:28
s_waitcnt lgkmcnt(1)
buffer_store_dwordx4 v[108:111],v9,s[16:19],s85 offen offset:3328 nt
ds_write2st64_b64 v38,v[136:137],v[152:153] offset0:26 offset1:28
buffer_store_dwordx4 v[208:211],v9,s[16:19],s86 offen offset:0 nt
ds_write2st64_b64 v39,v[140:141],v[156:157] offset0:26 offset1:28
ds_read_b128 v[72:75],v10 offset:13312
buffer_store_dwordx4 v[224:227],v9,s[16:19],s86 offen offset:3072 nt
ds_read_b128 v[76:79],v10 offset:16384
ds_read_b128 v[88:91],v10 offset:14336
ds_read_b128 v[92:95],v10 offset:17408
ds_write2st64_b64 v36,v[160:161],v[176:177] offset0:0 offset1:2
s_waitcnt lgkmcnt(4)
buffer_store_dwordx4 v[72:75],v9,s[16:19],s86 offen offset:128 nt
ds_write2st64_b64 v37,v[164:165],v[180:181] offset0:0 offset1:2
s_waitcnt lgkmcnt(1)
buffer_store_dwordx4 v[76:79],v9,s[16:19],s86 offen offset:3200 nt
ds_write2st64_b64 v38,v[168:169],v[184:185] offset0:0 offset1:2
buffer_store_dwordx4 v[88:91],v9,s[16:19],s86 offen offset:256 nt
ds_write2st64_b64 v39,v[172:173],v[188:189] offset0:0 offset1:2
ds_read_b128 v[212:215],v10 offset:0
buffer_store_dwordx4 v[92:95],v9,s[16:19],s86 offen offset:3328 nt
ds_read_b128 v[228:231],v10 offset:3072
ds_read_b128 v[216:219],v10 offset:1024
ds_read_b128 v[232:235],v10 offset:4096
ds_write_b64 v36,v[192:193] offset:2048
ds_write_b64 v37,v[196:197] offset:2048
s_waitcnt lgkmcnt(5)
buffer_store_dwordx4 v[212:215],v9,s[16:19],s84 offen offset:0 nt
ds_write_b64 v38,v[200:201] offset:2048
s_waitcnt lgkmcnt(2)
buffer_store_dwordx4 v[228:231],v9,s[16:19],s84 offen offset:3072 nt
ds_write_b64 v39,v[204:205] offset:2048
ds_read_b128 v[220:223],v10 offset:2048
buffer_store_dwordx4 v[216:219],v9,s[16:19],s84 offen offset:128 nt
ds_read_b128 v[236:239],v10 offset:5120
buffer_store_dwordx4 v[232:235],v9,s[16:19],s84 offen offset:3200 nt
s_waitcnt lgkmcnt(1)
buffer_store_dwordx4 v[220:223],v9,s[16:19],s84 offen offset:256 nt
s_waitcnt lgkmcnt(0)
buffer_store_dwordx4 v[236:239],v9,s[16:19],s84 offen offset:3328 nt
s_branch L_fin
L_end4:
s_waitcnt lgkmcnt(3)
v_mfma_f32_16x16x32_bf16 v[160:163],a[120:123],v[20:23],v[160:163]
ds_read_b64_tr_b16 a[136:137],v2 offset:24704
v_fma_f32 v102,v102,s36,v16
v_mfma_f32_16x16x32_bf16 v[164:167],a[124:127],v[20:23],v[164:167]
ds_read_b64_tr_b16 a[138:139],v2 offset:30848
v_fma_f32 v98,v98,s36,v16
v_mfma_f32_16x16x32_bf16 v[212:215],a[124:127],v[24:27],v[212:215]
ds_read_b64_tr_b16 a[140:141],v3 offset:24704
v_fma_f32 v76,v76,s36,v13
v_mfma_f32_16x16x32_bf16 v[208:211],a[120:123],v[24:27],v[208:211]
ds_read_b64_tr_b16 a[142:143],v3 offset:30848
v_fma_f32 v91,v91,s36,v15
v_mfma_f32_16x16x32_bf16 v[112:115],a[120:123],v[28:31],v[112:115]
ds_read_b64_tr_b16 a[144:145],v4 offset:24704
v_fma_f32 v95,v95,s36,v15
v_mfma_f32_16x16x32_bf16 v[116:119],a[124:127],v[28:31],v[116:119]
ds_read_b64_tr_b16 a[146:147],v4 offset:30848
v_fma_f32 v85,v85,s36,v14
v_mfma_f32_16x16x32_bf16 a[164:167],a[124:127],v[32:35],a[164:167]
ds_read_b64_tr_b16 a[148:149],v5 offset:24704
v_exp_f32 v76,v76
v_mfma_f32_16x16x32_bf16 a[160:163],a[120:123],v[32:35],a[160:163]
s_waitcnt lgkmcnt(6)
ds_read_b64_tr_b16 a[150:151],v5 offset:30848
v_fma_f32 v103,v103,s36,v16
v_mfma_f32_16x16x32_bf16 a[168:171],a[128:131],v[32:35],a[168:171]
ds_read_b64_tr_b16 a[120:121],v2 offset:24832
v_fma_f32 v79,v79,s36,v13
v_mfma_f32_16x16x32_bf16 a[172:175],a[132:135],v[32:35],a[172:175]
ds_read_b64_tr_b16 a[122:123],v2 offset:30976
v_fma_f32 v96,v96,s36,v16
v_mfma_f32_16x16x32_bf16 v[124:127],a[132:135],v[28:31],v[124:127]
ds_read_b64_tr_b16 a[124:125],v3 offset:24832
v_exp_f32 v102,v102
v_mfma_f32_16x16x32_bf16 v[120:123],a[128:131],v[28:31],v[120:123]
ds_read_b64_tr_b16 a[126:127],v3 offset:30976
v_fma_f32 v89,v89,s36,v15
v_mfma_f32_16x16x32_bf16 v[216:219],a[128:131],v[24:27],v[216:219]
v_fma_f32 v86,v86,s36,v14
v_fma_f32 v100,v100,s36,v16
v_mfma_f32_16x16x32_bf16 v[220:223],a[132:135],v[24:27],v[220:223]
v_exp_f32 v100,v100
v_mfma_f32_16x16x32_bf16 v[172:175],a[132:135],v[20:23],v[172:175]
ds_read_b64_tr_b16 a[132:133],v5 offset:24832
v_fma_f32 v84,v84,s36,v14
v_mfma_f32_16x16x32_bf16 v[168:171],a[128:131],v[20:23],v[168:171]
s_waitcnt lgkmcnt(4)
ds_read_b64_tr_b16 a[128:129],v4 offset:24832
v_exp_f32 v98,v98
v_mfma_f32_16x16x32_bf16 v[176:179],a[136:139],v[20:23],v[176:179]
ds_read_b64_tr_b16 a[130:131],v4 offset:30976
v_exp_f32 v79,v79
v_mfma_f32_16x16x32_bf16 v[180:183],a[140:143],v[20:23],v[180:183]
ds_read_b64_tr_b16 a[134:135],v5 offset:30976
v_exp_f32 v89,v89
v_mfma_f32_16x16x32_bf16 v[228:231],a[140:143],v[24:27],v[228:231]
v_fma_f32 v82,v82,s36,v14
v_exp_f32 v82,v82
v_mfma_f32_16x16x32_bf16 v[224:227],a[136:139],v[24:27],v[224:227]
v_fma_f32 v77,v77,s36,v13
v_exp_f32 v77,v77
v_mfma_f32_16x16x32_bf16 v[128:131],a[136:139],v[28:31],v[128:131]
v_fma_f32 v87,v87,s36,v14
v_exp_f32 v87,v87
v_mfma_f32_16x16x32_bf16 v[132:135],a[140:143],v[28:31],v[132:135]
v_exp_f32 v96,v96
v_mfma_f32_16x16x32_bf16 a[180:183],a[140:143],v[32:35],a[180:183]
v_fma_f32 v78,v78,s36,v13
v_fma_f32 v83,v83,s36,v14
v_mfma_f32_16x16x32_bf16 a[176:179],a[136:139],v[32:35],a[176:179]
v_fma_f32 v92,v92,s36,v15
v_exp_f32 v92,v92
v_mfma_f32_16x16x32_bf16 a[184:187],a[144:147],v[32:35],a[184:187]
v_fma_f32 v90,v90,s36,v15
v_exp_f32 v90,v90
v_mfma_f32_16x16x32_bf16 a[188:191],a[148:151],v[32:35],a[188:191]
v_fma_f32 v101,v101,s36,v16
v_exp_f32 v101,v101
v_mfma_f32_16x16x32_bf16 v[140:143],a[148:151],v[28:31],v[140:143]
v_fma_f32 v99,v99,s36,v16
v_exp_f32 v99,v99
v_mfma_f32_16x16x32_bf16 v[136:139],a[144:147],v[28:31],v[136:139]
v_exp_f32 v84,v84
v_mfma_f32_16x16x32_bf16 v[232:235],a[144:147],v[24:27],v[232:235]
v_fma_f32 v94,v94,s36,v15
v_fma_f32 v88,v88,s36,v15
v_mfma_f32_16x16x32_bf16 v[236:239],a[148:151],v[24:27],v[236:239]
v_fma_f32 v97,v97,s36,v16
v_exp_f32 v97,v97
v_mfma_f32_16x16x32_bf16 v[188:191],a[148:151],v[20:23],v[188:191]
v_fma_f32 v93,v93,s36,v15
v_exp_f32 v93,v93
v_mfma_f32_16x16x32_bf16 v[184:187],a[144:147],v[20:23],v[184:187]
s_waitcnt lgkmcnt(0)
v_exp_f32 v94,v94
v_mfma_f32_16x16x32_bf16 v[192:195],a[120:123],v[20:23],v[192:195]
v_exp_f32 v83,v83
v_mfma_f32_16x16x32_bf16 v[196:199],a[124:127],v[20:23],v[196:199]
v_exp_f32 v103,v103
v_mfma_f32_16x16x32_bf16 v[244:247],a[124:127],v[24:27],v[244:247]
v_exp_f32 v78,v78
v_mfma_f32_16x16x32_bf16 v[240:243],a[120:123],v[24:27],v[240:243]
v_exp_f32 v95,v95
v_mfma_f32_16x16x32_bf16 v[144:147],a[120:123],v[28:31],v[144:147]
v_cvt_pk_bf16_f32 v55,v94,v95
s_waitcnt vmcnt(14)
s_barrier
v_mfma_f32_16x16x32_bf16 v[148:151],a[124:127],v[28:31],v[148:151]
v_exp_f32 v91,v91
v_mfma_f32_16x16x32_bf16 a[196:199],a[124:127],v[32:35],a[196:199]
v_exp_f32 v85,v85
v_mfma_f32_16x16x32_bf16 a[192:195],a[120:123],v[32:35],a[192:195]
v_exp_f32 v88,v88
v_mfma_f32_16x16x32_bf16 a[200:203],a[128:131],v[32:35],a[200:203]
v_cvt_pk_bf16_f32 v52,v88,v89
v_exp_f32 v86,v86
v_mfma_f32_16x16x32_bf16 a[204:207],a[132:135],v[32:35],a[204:207]
v_cvt_pk_bf16_f32 v46,v76,v77
v_cvt_pk_bf16_f32 v49,v82,v83
v_mfma_f32_16x16x32_bf16 v[156:159],a[132:135],v[28:31],v[156:159]
v_cvt_pk_bf16_f32 v57,v98,v99
v_cvt_pk_bf16_f32 v47,v78,v79
v_mfma_f32_16x16x32_bf16 v[152:155],a[128:131],v[28:31],v[152:155]
v_cvt_pk_bf16_f32 v58,v100,v101
v_cvt_pk_bf16_f32 v59,v102,v103
v_mfma_f32_16x16x32_bf16 v[248:251],a[128:131],v[24:27],v[248:251]
v_cvt_pk_bf16_f32 v54,v92,v93
v_cvt_pk_bf16_f32 v50,v84,v85
v_mfma_f32_16x16x32_bf16 v[252:255],a[132:135],v[24:27],v[252:255]
v_cvt_pk_bf16_f32 v53,v90,v91
v_cvt_pk_bf16_f32 v51,v86,v87
v_mfma_f32_16x16x32_bf16 v[204:207],a[132:135],v[20:23],v[204:207]
v_cvt_pk_bf16_f32 v56,v96,v97
v_subrev_u32 v10,18432,v10
v_smfmac_f32_16x16x64_bf16 v[60:63],a[152:155],v[44:51],v18
ds_read_b64_tr_b16 a[138:139],v2 offset:6144
v_smfmac_f32_16x16x64_bf16 v[64:67],a[152:155],v[52:59],v18
ds_read_b64_tr_b16 a[136:137],v2 offset:0
v_mfma_f32_16x16x32_bf16 v[200:203],a[128:131],v[20:23],v[200:203]
ds_read_b64_tr_b16 a[142:143],v3 offset:6144
ds_read_b64_tr_b16 a[140:141],v3 offset:0
ds_read_b64_tr_b16 a[146:147],v4 offset:6144
ds_read_b64_tr_b16 a[144:145],v4 offset:0
ds_read_b64_tr_b16 a[150:151],v5 offset:6144
ds_read_b64_tr_b16 a[148:149],v5 offset:0
s_waitcnt lgkmcnt(6)
v_mfma_f32_16x16x32_bf16 v[160:163],a[136:139],v[44:47],v[160:163]
s_waitcnt vmcnt(6)
ds_read_b64_tr_b16 a[120:121],v2 offset:128
v_mbcnt_lo_u32_b32 v39,-1,0
s_waitcnt lgkmcnt(5)
v_mfma_f32_16x16x32_bf16 v[164:167],a[140:143],v[44:47],v[164:167]
s_add_u32 s84,s42,0
ds_read_b64_tr_b16 a[122:123],v2 offset:6272
v_mbcnt_hi_u32_b32 v39,-1,v39
v_mfma_f32_16x16x32_bf16 v[212:215],a[140:143],v[48:51],v[212:215]
s_add_u32 s85,s42,6144
ds_read_b64_tr_b16 a[126:127],v3 offset:6272
v_and_b32 v38,7,v39
v_mfma_f32_16x16x32_bf16 v[208:211],a[136:139],v[48:51],v[208:211]
s_add_u32 s86,s42,12288
ds_read_b64_tr_b16 a[124:125],v3 offset:128
v_add_f32 v64,v64,v65
v_mfma_f32_16x16x32_bf16 v[112:115],a[136:139],v[52:55],v[112:115]
s_add_u32 s87,s42,18432
ds_read_b64_tr_b16 a[130:131],v4 offset:6272
v_add_f32 v66,v66,v67
v_mfma_f32_16x16x32_bf16 v[116:119],a[140:143],v[52:55],v[116:119]
ds_read_b64_tr_b16 a[128:129],v4 offset:128
ds_read_b64_tr_b16 a[132:133],v5 offset:128
ds_read_b64_tr_b16 a[134:135],v5 offset:6272
v_mfma_f32_16x16x32_bf16 a[164:167],a[140:143],v[56:59],a[164:167]
ds_read_b64_tr_b16 a[142:143],v3 offset:6400
v_add_f32 v62,v62,v63
v_mfma_f32_16x16x32_bf16 a[160:163],a[136:139],v[56:59],a[160:163]
s_waitcnt lgkmcnt(8)
ds_read_b64_tr_b16 a[136:137],v2 offset:256
v_add_f32 v60,v60,v61
v_mfma_f32_16x16x32_bf16 a[168:171],a[144:147],v[56:59],a[168:171]
ds_read_b64_tr_b16 a[138:139],v2 offset:6400
v_max3_f32 v19,v60,v62,v64
v_mfma_f32_16x16x32_bf16 a[172:175],a[148:151],v[56:59],a[172:175]
ds_read_b64_tr_b16 a[140:141],v3 offset:256
v_max_f32 v19,v19,v66
v_mfma_f32_16x16x32_bf16 v[124:127],a[148:151],v[52:55],v[124:127]
v_accvgpr_read_b32 v82,a166
v_rcp_f32 v66,v66
v_mfma_f32_16x16x32_bf16 v[120:123],a[144:147],v[52:55],v[120:123]
v_accvgpr_read_b32 v81,a165
v_accvgpr_read_b32 v80,a164
v_mfma_f32_16x16x32_bf16 v[216:219],a[144:147],v[48:51],v[216:219]
v_accvgpr_read_b32 v72,a160
v_accvgpr_read_b32 v75,a163
v_mfma_f32_16x16x32_bf16 v[220:223],a[148:151],v[48:51],v[220:223]
v_accvgpr_read_b32 v73,a161
v_accvgpr_read_b32 v74,a162
v_mfma_f32_16x16x32_bf16 v[172:175],a[148:151],v[44:47],v[172:175]
ds_read_b64_tr_b16 a[148:149],v5 offset:256
v_accvgpr_read_b32 v83,a167
v_mfma_f32_16x16x32_bf16 v[168:171],a[144:147],v[44:47],v[168:171]
s_waitcnt lgkmcnt(2)
ds_read_b64_tr_b16 a[144:145],v4 offset:256
v_accvgpr_read_b32 v88,a168
v_mfma_f32_16x16x32_bf16 v[176:179],a[120:123],v[44:47],v[176:179]
ds_read_b64_tr_b16 a[146:147],v4 offset:6400
v_accvgpr_read_b32 v91,a171
v_mfma_f32_16x16x32_bf16 v[180:183],a[124:127],v[44:47],v[180:183]
ds_read_b64_tr_b16 a[150:151],v5 offset:6400
v_accvgpr_read_b32 v90,a170
v_mfma_f32_16x16x32_bf16 v[228:231],a[124:127],v[48:51],v[228:231]
v_accvgpr_read_b32 v89,a169
v_accvgpr_read_b32 v98,a174
v_mfma_f32_16x16x32_bf16 v[224:227],a[120:123],v[48:51],v[224:227]
v_accvgpr_read_b32 v97,a173
v_accvgpr_read_b32 v99,a175
v_mfma_f32_16x16x32_bf16 v[128:131],a[120:123],v[52:55],v[128:131]
v_accvgpr_read_b32 v96,a172
v_cmp_ngt_f32 vcc,s37,v19
v_mfma_f32_16x16x32_bf16 v[132:135],a[124:127],v[52:55],v[132:135]
v_lshrrev_b32 v19,5,v39
v_xor_b32 v38,v38,v19
v_mfma_f32_16x16x32_bf16 a[180:183],a[124:127],v[56:59],a[180:183]
s_cmp_lg_u64 vcc,0
v_and_b32 v19,15,v39
v_lshl_add_u32 v19,v19,7,s24
v_mfma_f32_16x16x32_bf16 a[176:179],a[120:123],v[56:59],a[176:179]
s_cselect_b32 s62,s32,0
v_lshl_add_u32 v19,v38,4,v19
v_bfe_u32 v38,v39,4,1
v_mfma_f32_16x16x32_bf16 a[184:187],a[128:131],v[56:59],a[184:187]
s_or_b32 s31,s31,s62
v_lshl_add_u32 v36,v38,3,v19
v_xor_b32 v37,32,v36
v_mfma_f32_16x16x32_bf16 a[188:191],a[132:135],v[56:59],a[188:191]
s_lshl_b32 s32,s32,1
v_bfe_u32 v19,v39,3,1
v_xor_b32 v39,96,v36
v_mfma_f32_16x16x32_bf16 v[140:143],a[132:135],v[52:55],v[140:143]
v_xor_b32 v38,64,v36
v_lshlrev_b32 v19,11,v19
v_accvgpr_read_b32 v84,a180
v_accvgpr_read_b32 v79,a179
v_accvgpr_read_b32 v78,a178
v_pk_mul_f32 v[82:83],v[82:83],v[66:67] op_sel_hi:[1,0]
v_pk_mul_f32 v[72:73],v[72:73],v[66:67] op_sel_hi:[1,0]
v_pk_mul_f32 v[74:75],v[74:75],v[66:67] op_sel_hi:[1,0]
v_pk_mul_f32 v[80:81],v[80:81],v[66:67] op_sel_hi:[1,0]
v_pk_mul_f32 v[78:79],v[78:79],v[66:67] op_sel_hi:[1,0]
v_accvgpr_read_b32 v77,a177
v_accvgpr_read_b32 v76,a176
v_pk_mul_f32 v[76:77],v[76:77],v[66:67] op_sel_hi:[1,0]
v_accvgpr_read_b32 v85,a181
v_pk_mul_f32 v[84:85],v[84:85],v[66:67] op_sel_hi:[1,0]
v_accvgpr_read_b32 v87,a183
v_accvgpr_read_b32 v86,a182
v_pk_mul_f32 v[86:87],v[86:87],v[66:67] op_sel_hi:[1,0]
v_accvgpr_read_b32 v93,a185
v_accvgpr_read_b32 v95,a187
v_mfma_f32_16x16x32_bf16 v[136:139],a[128:131],v[52:55],v[136:139]
v_accvgpr_read_b32 v94,a186
v_accvgpr_read_b32 v92,a184
v_accvgpr_read_b32 v101,a189
v_accvgpr_read_b32 v103,a191
v_accvgpr_read_b32 v102,a190
v_pk_mul_f32 v[88:89],v[88:89],v[66:67] op_sel_hi:[1,0]
v_pk_mul_f32 v[90:91],v[90:91],v[66:67] op_sel_hi:[1,0]
v_pk_mul_f32 v[92:93],v[92:93],v[66:67] op_sel_hi:[1,0]
v_pk_mul_f32 v[94:95],v[94:95],v[66:67] op_sel_hi:[1,0]
v_accvgpr_read_b32 v100,a188
v_cvt_pk_bf16_f32 v76,v76,v77
v_mfma_f32_16x16x32_bf16 v[232:235],a[128:131],v[48:51],v[232:235]
v_cvt_pk_bf16_f32 v77,v78,v79
v_cvt_pk_bf16_f32 v80,v80,v81
v_cvt_pk_bf16_f32 v84,v84,v85
v_cvt_pk_bf16_f32 v85,v86,v87
v_cvt_pk_bf16_f32 v72,v72,v73
v_pk_mul_f32 v[96:97],v[96:97],v[66:67] op_sel_hi:[1,0]
v_pk_mul_f32 v[98:99],v[98:99],v[66:67] op_sel_hi:[1,0]
v_pk_mul_f32 v[102:103],v[102:103],v[66:67] op_sel_hi:[1,0]
v_pk_mul_f32 v[100:101],v[100:101],v[66:67] op_sel_hi:[1,0]
v_cvt_pk_bf16_f32 v73,v74,v75
v_cvt_pk_bf16_f32 v88,v88,v89
v_mfma_f32_16x16x32_bf16 v[236:239],a[132:135],v[48:51],v[236:239]
ds_write2st64_b64 v36,v[72:73],v[76:77] offset0:36 offset1:40
v_mfma_f32_16x16x32_bf16 v[188:191],a[132:135],v[44:47],v[188:191]
v_cvt_pk_bf16_f32 v92,v92,v93
v_cvt_pk_bf16_f32 v100,v100,v101
v_mfma_f32_16x16x32_bf16 v[184:187],a[128:131],v[44:47],v[184:187]
v_cvt_pk_bf16_f32 v93,v94,v95
v_cvt_pk_bf16_f32 v101,v102,v103
v_mfma_f32_16x16x32_bf16 v[192:195],a[136:139],v[44:47],v[192:195]
s_waitcnt lgkmcnt(1)
v_cvt_pk_bf16_f32 v81,v82,v83
v_cvt_pk_bf16_f32 v89,v90,v91
v_mfma_f32_16x16x32_bf16 v[196:199],a[140:143],v[44:47],v[196:199]
ds_write2st64_b64 v37,v[80:81],v[84:85] offset0:36 offset1:40
v_mfma_f32_16x16x32_bf16 v[244:247],a[140:143],v[48:51],v[244:247]
v_cvt_pk_bf16_f32 v96,v96,v97
v_cvt_pk_bf16_f32 v97,v98,v99
v_mfma_f32_16x16x32_bf16 v[240:243],a[136:139],v[48:51],v[240:243]
v_rcp_f32 v64,v64
v_mfma_f32_16x16x32_bf16 v[144:147],a[136:139],v[52:55],v[144:147]
v_rcp_f32 v62,v62
v_mfma_f32_16x16x32_bf16 v[148:151],a[140:143],v[52:55],v[148:151]
ds_write2st64_b64 v38,v[88:89],v[92:93] offset0:36 offset1:40
v_mfma_f32_16x16x32_bf16 a[196:199],a[140:143],v[56:59],a[196:199]
v_rcp_f32 v60,v60
v_mfma_f32_16x16x32_bf16 a[192:195],a[136:139],v[56:59],a[192:195]
v_mfma_f32_16x16x32_bf16 a[200:203],a[144:147],v[56:59],a[200:203]
v_mfma_f32_16x16x32_bf16 a[204:207],a[148:151],v[56:59],a[204:207]
ds_write2st64_b64 v39,v[96:97],v[100:101] offset0:36 offset1:40
v_mfma_f32_16x16x32_bf16 v[156:159],a[148:151],v[52:55],v[156:159]
ds_read_b128 v[104:107],v10 offset:18432
ds_read_b128 v[108:111],v10 offset:19456
v_accvgpr_read_b32 v87,a199
ds_read_b128 v[72:75],v10 offset:20480
v_accvgpr_read_b32 v83,a195
ds_read_b128 v[76:79],v10 offset:21504
v_accvgpr_read_b32 v80,a192
v_accvgpr_read_b32 v82,a194
v_pk_mul_f32 v[82:83],v[82:83],v[66:67] op_sel_hi:[1,0]
v_accvgpr_read_b32 v85,a197
v_accvgpr_read_b32 v86,a198
v_pk_mul_f32 v[86:87],v[86:87],v[66:67] op_sel_hi:[1,0]
v_accvgpr_read_b32 v84,a196
v_pk_mul_f32 v[84:85],v[84:85],v[66:67] op_sel_hi:[1,0]
v_accvgpr_read_b32 v81,a193
v_pk_mul_f32 v[80:81],v[80:81],v[66:67] op_sel_hi:[1,0]
v_cvt_pk_bf16_f32 v84,v84,v85
v_accvgpr_read_b32 v94,a206
v_mfma_f32_16x16x32_bf16 v[152:155],a[144:147],v[52:55],v[152:155]
s_waitcnt lgkmcnt(3)
v_cvt_pk_bf16_f32 v80,v80,v81
buffer_store_dwordx4 v[104:107],v9,s[16:19],s87 offen offset:0 nt
v_accvgpr_read_b32 v91,a203
v_cvt_pk_bf16_f32 v81,v82,v83
v_accvgpr_read_b32 v90,a202
v_pk_mul_f32 v[90:91],v[90:91],v[66:67] op_sel_hi:[1,0]
v_accvgpr_read_b32 v93,a205
v_accvgpr_read_b32 v89,a201
v_accvgpr_read_b32 v88,a200
v_pk_mul_f32 v[88:89],v[88:89],v[66:67] op_sel_hi:[1,0]
v_cvt_pk_bf16_f32 v85,v86,v87
v_accvgpr_read_b32 v92,a204
v_mfma_f32_16x16x32_bf16 v[248:251],a[144:147],v[48:51],v[248:251]
s_waitcnt lgkmcnt(0)
ds_write_b64 v36,v[80:81] offset:18432
buffer_store_dwordx4 v[108:111],v9,s[16:19],s87 offen offset:3072 nt
v_pk_mul_f32 v[92:93],v[92:93],v[66:67] op_sel_hi:[1,0]
v_pk_mul_f32 v[216:217],v[216:217],v[62:63] op_sel_hi:[1,0]
v_pk_mul_f32 v[218:219],v[218:219],v[62:63] op_sel_hi:[1,0]
v_pk_mul_f32 v[240:241],v[240:241],v[62:63] op_sel_hi:[1,0]
v_pk_mul_f32 v[230:231],v[230:231],v[62:63] op_sel_hi:[1,0]
v_pk_mul_f32 v[226:227],v[226:227],v[62:63] op_sel_hi:[1,0]
v_pk_mul_f32 v[242:243],v[242:243],v[62:63] op_sel_hi:[1,0]
v_pk_mul_f32 v[228:229],v[228:229],v[62:63] op_sel_hi:[1,0]
v_pk_mul_f32 v[112:113],v[112:113],v[64:65] op_sel_hi:[1,0]
ds_write_b64 v37,v[84:85] offset:18432
buffer_store_dwordx4 v[72:75],v9,s[16:19],s87 offen offset:128 nt
v_pk_mul_f32 v[118:119],v[118:119],v[64:65] op_sel_hi:[1,0]
v_pk_mul_f32 v[114:115],v[114:115],v[64:65] op_sel_hi:[1,0]
v_pk_mul_f32 v[220:221],v[220:221],v[62:63] op_sel_hi:[1,0]
v_pk_mul_f32 v[222:223],v[222:223],v[62:63] op_sel_hi:[1,0]
v_pk_mul_f32 v[214:215],v[214:215],v[62:63] op_sel_hi:[1,0]
v_pk_mul_f32 v[244:245],v[244:245],v[62:63] op_sel_hi:[1,0]
v_pk_mul_f32 v[238:239],v[238:239],v[62:63] op_sel_hi:[1,0]
v_pk_mul_f32 v[212:213],v[212:213],v[62:63] op_sel_hi:[1,0]
v_pk_mul_f32 v[246:247],v[246:247],v[62:63] op_sel_hi:[1,0]
v_pk_mul_f32 v[208:209],v[208:209],v[62:63] op_sel_hi:[1,0]
v_pk_mul_f32 v[210:211],v[210:211],v[62:63] op_sel_hi:[1,0]
buffer_store_dwordx4 v[76:79],v9,s[16:19],s87 offen offset:3200 nt
v_pk_mul_f32 v[224:225],v[224:225],v[62:63] op_sel_hi:[1,0]
v_pk_mul_f32 v[236:237],v[236:237],v[62:63] op_sel_hi:[1,0]
v_pk_mul_f32 v[232:233],v[232:233],v[62:63] op_sel_hi:[1,0]
v_pk_mul_f32 v[116:117],v[116:117],v[64:65] op_sel_hi:[1,0]
v_pk_mul_f32 v[234:235],v[234:235],v[62:63] op_sel_hi:[1,0]
v_add_u32 v36,v36,v19
v_add_u32 v37,v37,v19
v_cvt_pk_bf16_f32 v92,v92,v93
v_accvgpr_read_b32 v95,a207
v_pk_mul_f32 v[94:95],v[94:95],v[66:67] op_sel_hi:[1,0]
v_cvt_pk_bf16_f32 v88,v88,v89
v_cvt_pk_bf16_f32 v93,v94,v95
v_mfma_f32_16x16x32_bf16 v[252:255],a[148:151],v[48:51],v[252:255]
v_cvt_pk_bf16_f32 v89,v90,v91
v_cvt_pk_bf16_f32 v208,v208,v209
v_mfma_f32_16x16x32_bf16 v[204:207],a[148:151],v[44:47],v[204:207]
ds_write_b64 v38,v[88:89] offset:18432
v_mfma_f32_16x16x32_bf16 v[200:203],a[144:147],v[44:47],v[200:203]
v_add_u32 v38,v38,v19
v_cvt_pk_bf16_f32 v212,v212,v213
ds_write_b64 v39,v[92:93] offset:18432
ds_read_b128 v[96:99],v10 offset:18432
v_pk_mul_f32 v[252:253],v[252:253],v[62:63] op_sel_hi:[1,0]
ds_read_b128 v[100:103],v10 offset:19456
v_pk_mul_f32 v[124:125],v[124:125],v[64:65] op_sel_hi:[1,0]
v_pk_mul_f32 v[254:255],v[254:255],v[62:63] op_sel_hi:[1,0]
v_pk_mul_f32 v[126:127],v[126:127],v[64:65] op_sel_hi:[1,0]
v_pk_mul_f32 v[248:249],v[248:249],v[62:63] op_sel_hi:[1,0]
v_pk_mul_f32 v[120:121],v[120:121],v[64:65] op_sel_hi:[1,0]
v_pk_mul_f32 v[250:251],v[250:251],v[62:63] op_sel_hi:[1,0]
v_pk_mul_f32 v[122:123],v[122:123],v[64:65] op_sel_hi:[1,0]
v_pk_mul_f32 v[148:149],v[148:149],v[64:65] op_sel_hi:[1,0]
v_pk_mul_f32 v[130:131],v[130:131],v[64:65] op_sel_hi:[1,0]
v_pk_mul_f32 v[128:129],v[128:129],v[64:65] op_sel_hi:[1,0]
v_pk_mul_f32 v[136:137],v[136:137],v[64:65] op_sel_hi:[1,0]
v_pk_mul_f32 v[150:151],v[150:151],v[64:65] op_sel_hi:[1,0]
v_pk_mul_f32 v[152:153],v[152:153],v[64:65] op_sel_hi:[1,0]
v_pk_mul_f32 v[140:141],v[140:141],v[64:65] op_sel_hi:[1,0]
v_pk_mul_f32 v[156:157],v[156:157],v[64:65] op_sel_hi:[1,0]
v_pk_mul_f32 v[144:145],v[144:145],v[64:65] op_sel_hi:[1,0]
v_pk_mul_f32 v[146:147],v[146:147],v[64:65] op_sel_hi:[1,0]
v_pk_mul_f32 v[158:159],v[158:159],v[64:65] op_sel_hi:[1,0]
v_pk_mul_f32 v[132:133],v[132:133],v[64:65] op_sel_hi:[1,0]
v_pk_mul_f32 v[138:139],v[138:139],v[64:65] op_sel_hi:[1,0]
v_pk_mul_f32 v[142:143],v[142:143],v[64:65] op_sel_hi:[1,0]
v_pk_mul_f32 v[134:135],v[134:135],v[64:65] op_sel_hi:[1,0]
v_pk_mul_f32 v[154:155],v[154:155],v[64:65] op_sel_hi:[1,0]
s_waitcnt lgkmcnt(1)
buffer_store_dwordx4 v[96:99],v9,s[16:19],s87 offen offset:256 nt
v_pk_mul_f32 v[178:179],v[178:179],v[60:61] op_sel_hi:[1,0]
v_pk_mul_f32 v[162:163],v[162:163],v[60:61] op_sel_hi:[1,0]
v_pk_mul_f32 v[180:181],v[180:181],v[60:61] op_sel_hi:[1,0]
v_pk_mul_f32 v[168:169],v[168:169],v[60:61] op_sel_hi:[1,0]
v_pk_mul_f32 v[176:177],v[176:177],v[60:61] op_sel_hi:[1,0]
v_pk_mul_f32 v[182:183],v[182:183],v[60:61] op_sel_hi:[1,0]
v_pk_mul_f32 v[188:189],v[188:189],v[60:61] op_sel_hi:[1,0]
v_pk_mul_f32 v[160:161],v[160:161],v[60:61] op_sel_hi:[1,0]
v_pk_mul_f32 v[164:165],v[164:165],v[60:61] op_sel_hi:[1,0]
v_pk_mul_f32 v[174:175],v[174:175],v[60:61] op_sel_hi:[1,0]
v_pk_mul_f32 v[184:185],v[184:185],v[60:61] op_sel_hi:[1,0]
s_waitcnt lgkmcnt(0)
buffer_store_dwordx4 v[100:103],v9,s[16:19],s87 offen offset:3328 nt
v_pk_mul_f32 v[166:167],v[166:167],v[60:61] op_sel_hi:[1,0]
v_pk_mul_f32 v[172:173],v[172:173],v[60:61] op_sel_hi:[1,0]
v_pk_mul_f32 v[186:187],v[186:187],v[60:61] op_sel_hi:[1,0]
v_pk_mul_f32 v[170:171],v[170:171],v[60:61] op_sel_hi:[1,0]
v_pk_mul_f32 v[190:191],v[190:191],v[60:61] op_sel_hi:[1,0]
v_pk_mul_f32 v[196:197],v[196:197],v[60:61] op_sel_hi:[1,0]
v_pk_mul_f32 v[194:195],v[194:195],v[60:61] op_sel_hi:[1,0]
v_pk_mul_f32 v[192:193],v[192:193],v[60:61] op_sel_hi:[1,0]
v_pk_mul_f32 v[200:201],v[200:201],v[60:61] op_sel_hi:[1,0]
v_pk_mul_f32 v[198:199],v[198:199],v[60:61] op_sel_hi:[1,0]
v_pk_mul_f32 v[206:207],v[206:207],v[60:61] op_sel_hi:[1,0]
v_pk_mul_f32 v[202:203],v[202:203],v[60:61] op_sel_hi:[1,0]
v_pk_mul_f32 v[204:205],v[204:205],v[60:61] op_sel_hi:[1,0]
v_add_u32 v39,v39,v19
v_cvt_pk_bf16_f32 v224,v224,v225
v_cvt_pk_bf16_f32 v228,v228,v229
v_cvt_pk_bf16_f32 v209,v210,v211
v_cvt_pk_bf16_f32 v232,v232,v233
v_cvt_pk_bf16_f32 v216,v216,v217
v_cvt_pk_bf16_f32 v236,v236,v237
v_cvt_pk_bf16_f32 v225,v226,v227
ds_write2st64_b64 v36,v[208:209],v[224:225] offset0:12 offset1:14
v_cvt_pk_bf16_f32 v229,v230,v231
v_cvt_pk_bf16_f32 v233,v234,v235
v_cvt_pk_bf16_f32 v213,v214,v215
v_cvt_pk_bf16_f32 v217,v218,v219
v_cvt_pk_bf16_f32 v220,v220,v221
v_cvt_pk_bf16_f32 v221,v222,v223
v_cvt_pk_bf16_f32 v237,v238,v239
v_cvt_pk_bf16_f32 v240,v240,v241
v_cvt_pk_bf16_f32 v241,v242,v243
v_cvt_pk_bf16_f32 v112,v112,v113
v_cvt_pk_bf16_f32 v113,v114,v115
ds_write2st64_b64 v37,v[212:213],v[228:229] offset0:12 offset1:14
v_cvt_pk_bf16_f32 v244,v244,v245
v_cvt_pk_bf16_f32 v248,v248,v249
v_cvt_pk_bf16_f32 v116,v116,v117
v_cvt_pk_bf16_f32 v245,v246,v247
v_cvt_pk_bf16_f32 v124,v124,v125
v_cvt_pk_bf16_f32 v249,v250,v251
v_cvt_pk_bf16_f32 v120,v120,v121
v_cvt_pk_bf16_f32 v121,v122,v123
v_cvt_pk_bf16_f32 v117,v118,v119
v_cvt_pk_bf16_f32 v252,v252,v253
v_cvt_pk_bf16_f32 v253,v254,v255
ds_write2st64_b64 v38,v[216:217],v[232:233] offset0:12 offset1:14
v_cvt_pk_bf16_f32 v125,v126,v127
v_cvt_pk_bf16_f32 v128,v128,v129
v_cvt_pk_bf16_f32 v132,v132,v133
v_cvt_pk_bf16_f32 v144,v144,v145
v_cvt_pk_bf16_f32 v129,v130,v131
v_cvt_pk_bf16_f32 v145,v146,v147
v_cvt_pk_bf16_f32 v133,v134,v135
v_cvt_pk_bf16_f32 v152,v152,v153
v_cvt_pk_bf16_f32 v153,v154,v155
v_cvt_pk_bf16_f32 v136,v136,v137
v_cvt_pk_bf16_f32 v148,v148,v149
ds_write2st64_b64 v39,v[220:221],v[236:237] offset0:12 offset1:14
v_cvt_pk_bf16_f32 v137,v138,v139
v_cvt_pk_bf16_f32 v140,v140,v141
v_cvt_pk_bf16_f32 v141,v142,v143
ds_read_b128 v[80:83],v10 offset:6144
v_cvt_pk_bf16_f32 v156,v156,v157
ds_read_b128 v[72:75],v10 offset:9216
v_cvt_pk_bf16_f32 v149,v150,v151
ds_read_b128 v[76:79],v10 offset:7168
v_cvt_pk_bf16_f32 v157,v158,v159
ds_read_b128 v[84:87],v10 offset:10240
v_cvt_pk_bf16_f32 v164,v164,v165
ds_write2st64_b64 v36,v[240:241],v[112:113] offset0:16 offset1:24
v_cvt_pk_bf16_f32 v165,v166,v167
v_cvt_pk_bf16_f32 v180,v180,v181
v_cvt_pk_bf16_f32 v184,v184,v185
v_cvt_pk_bf16_f32 v176,v176,v177
v_cvt_pk_bf16_f32 v177,v178,v179
v_cvt_pk_bf16_f32 v160,v160,v161
v_cvt_pk_bf16_f32 v161,v162,v163
s_waitcnt lgkmcnt(4)
buffer_store_dwordx4 v[80:83],v9,s[16:19],s85 offen offset:0 nt
v_cvt_pk_bf16_f32 v168,v168,v169
v_cvt_pk_bf16_f32 v169,v170,v171
v_cvt_pk_bf16_f32 v181,v182,v183
v_cvt_pk_bf16_f32 v188,v188,v189
v_cvt_pk_bf16_f32 v185,v186,v187
v_cvt_pk_bf16_f32 v172,v172,v173
v_cvt_pk_bf16_f32 v173,v174,v175
v_cvt_pk_bf16_f32 v189,v190,v191
v_cvt_pk_bf16_f32 v192,v192,v193
ds_write2st64_b64 v37,v[244:245],v[116:117] offset0:16 offset1:24
v_cvt_pk_bf16_f32 v196,v196,v197
v_cvt_pk_bf16_f32 v200,v200,v201
v_cvt_pk_bf16_f32 v193,v194,v195
s_waitcnt lgkmcnt(1)
buffer_store_dwordx4 v[72:75],v9,s[16:19],s85 offen offset:3072 nt
v_cvt_pk_bf16_f32 v201,v202,v203
v_cvt_pk_bf16_f32 v204,v204,v205
v_cvt_pk_bf16_f32 v197,v198,v199
v_cvt_pk_bf16_f32 v205,v206,v207
ds_write2st64_b64 v38,v[248:249],v[120:121] offset0:16 offset1:24
buffer_store_dwordx4 v[76:79],v9,s[16:19],s85 offen offset:128 nt
ds_write2st64_b64 v39,v[252:253],v[124:125] offset0:16 offset1:24
ds_read_b128 v[104:107],v10 offset:8192
buffer_store_dwordx4 v[84:87],v9,s[16:19],s85 offen offset:3200 nt
ds_read_b128 v[108:111],v10 offset:11264
ds_read_b128 v[88:91],v10 offset:12288
ds_read_b128 v[92:95],v10 offset:15360
ds_write2st64_b64 v36,v[128:129],v[144:145] offset0:26 offset1:28
s_waitcnt lgkmcnt(4)
buffer_store_dwordx4 v[104:107],v9,s[16:19],s85 offen offset:256 nt
ds_write2st64_b64 v37,v[132:133],v[148:149] offset0:26 offset1:28
s_waitcnt lgkmcnt(1)
buffer_store_dwordx4 v[108:111],v9,s[16:19],s85 offen offset:3328 nt
ds_write2st64_b64 v38,v[136:137],v[152:153] offset0:26 offset1:28
buffer_store_dwordx4 v[88:91],v9,s[16:19],s86 offen offset:0 nt
ds_write2st64_b64 v39,v[140:141],v[156:157] offset0:26 offset1:28
ds_read_b128 v[208:211],v10 offset:13312
buffer_store_dwordx4 v[92:95],v9,s[16:19],s86 offen offset:3072 nt
ds_read_b128 v[224:227],v10 offset:16384
ds_read_b128 v[96:99],v10 offset:14336
ds_read_b128 v[100:103],v10 offset:17408
ds_write2st64_b64 v36,v[160:161],v[176:177] offset0:0 offset1:2
s_waitcnt lgkmcnt(4)
buffer_store_dwordx4 v[208:211],v9,s[16:19],s86 offen offset:128 nt
ds_write2st64_b64 v37,v[164:165],v[180:181] offset0:0 offset1:2
s_waitcnt lgkmcnt(1)
buffer_store_dwordx4 v[224:227],v9,s[16:19],s86 offen offset:3200 nt
ds_write2st64_b64 v38,v[168:169],v[184:185] offset0:0 offset1:2
buffer_store_dwordx4 v[96:99],v9,s[16:19],s86 offen offset:256 nt
ds_write2st64_b64 v39,v[172:173],v[188:189] offset0:0 offset1:2
ds_read_b128 v[212:215],v10 offset:0
buffer_store_dwordx4 v[100:103],v9,s[16:19],s86 offen offset:3328 nt
ds_read_b128 v[228:231],v10 offset:3072
ds_read_b128 v[216:219],v10 offset:1024
ds_read_b128 v[232:235],v10 offset:4096
ds_write_b64 v36,v[192:193] offset:2048
ds_write_b64 v37,v[196:197] offset:2048
s_waitcnt lgkmcnt(5)
buffer_store_dwordx4 v[212:215],v9,s[16:19],s84 offen offset:0 nt
ds_write_b64 v38,v[200:201] offset:2048
s_waitcnt lgkmcnt(2)
buffer_store_dwordx4 v[228:231],v9,s[16:19],s84 offen offset:3072 nt
ds_write_b64 v39,v[204:205] offset:2048
ds_read_b128 v[220:223],v10 offset:2048
buffer_store_dwordx4 v[216:219],v9,s[16:19],s84 offen offset:128 nt
ds_read_b128 v[236:239],v10 offset:5120
buffer_store_dwordx4 v[232:235],v9,s[16:19],s84 offen offset:3200 nt
s_waitcnt lgkmcnt(1)
buffer_store_dwordx4 v[220:223],v9,s[16:19],s84 offen offset:256 nt
s_waitcnt lgkmcnt(0)
buffer_store_dwordx4 v[236:239],v9,s[16:19],s84 offen offset:3328 nt
s_branch L_fin
L_fin:
s_waitcnt vmcnt(0)
L_stamped:
s_cmp_lg_u32 s31,0
s_cbranch_scc1 L_fix
L_done:
L_end:
s_endpgm
L_fix:
s_sub_u32 s62,s24,36864
v_add_u32 v112,s62,v2
v_add_u32 v113,s62,v3
v_add_u32 v114,s62,v4
v_add_u32 v115,s62,v5
v_mbcnt_lo_u32_b32 v19,-1,0
v_mbcnt_hi_u32_b32 v19,-1,v19
v_and_b32 v81,15,v19
v_mul_u32_u24 v81,384,v81
v_lshrrev_b32 v82,4,v19
v_lshl_add_u32 v83,v82,3,v81
v_lshl_add_u32 v81,v82,4,v81
L_fix_pass:
s_ff1_i32_b32 s50,s31
s_bitset0_b32 s31,s50
s_lshl_b32 s62,s50,5
s_add_u32 s62,s62,s34
s_mul_i32 s63,s62,171
s_lshr_b32 s63,s63,9
s_mul_i32 s64,s63,3
s_sub_u32 s62,s62,s64
s_add_u32 s63,s63,s33
s_mul_i32 s30,s63,196608
s_mul_i32 s41,s63,325632
s_lshl_b32 s63,s3,2
s_add_u32 s64,s63,21
s_cmp_eq_u32 s3,0
s_cselect_b32 s64,20,s64
s_cselect_b32 s40,1,0
s_add_u32 s65,s63,37
s_cmp_eq_u32 s62,2
s_cselect_b32 s64,s65,s64
s_cselect_b32 s40,0,s40
s_add_u32 s65,s63,s3
s_cmp_eq_u32 s62,0
s_cselect_b32 s64,s65,s64
s_cselect_b32 s40,1,s40
s_mul_i32 s64,s64,6144
s_add_u32 s41,s41,s64
s_add_u32 s55,s40,4
s_mov_b32 s51,0
L_fix_tile:
buffer_load_dwordx4 a[0:3],v81,s[12:15],s41 offen offset:0
buffer_load_dwordx4 a[4:7],v81,s[12:15],s41 offen offset:64
buffer_load_dwordx4 a[8:11],v81,s[12:15],s41 offen offset:128
buffer_load_dwordx4 a[12:15],v81,s[12:15],s41 offen offset:192
buffer_load_dwordx4 a[16:19],v81,s[12:15],s41 offen offset:256
buffer_load_dwordx4 a[20:23],v81,s[12:15],s41 offen offset:320
v_mov_b32 v80,0xff800000
s_mov_b32 s53,s30
s_mov_b32 s52,0
L_fix_max:
s_mov_b32 s63,s53
s_add_u32 m0,s24,0
s_nop 0
buffer_load_dwordx4 v6,s[4:7],s63 offen offset:0 lds
buffer_load_dwordx4 v7,s[4:7],s63 offen offset:1024 lds
buffer_load_dwordx4 v8,s[4:7],s63 offen offset:2048 lds
s_add_u32 s63,s63,3072
s_add_u32 m0,s24,3072
s_nop 0
buffer_load_dwordx4 v6,s[4:7],s63 offen offset:0 lds
buffer_load_dwordx4 v7,s[4:7],s63 offen offset:1024 lds
buffer_load_dwordx4 v8,s[4:7],s63 offen offset:2048 lds
s_add_u32 s63,s63,3072
s_add_u32 m0,s24,6144
s_nop 0
buffer_load_dwordx4 v6,s[4:7],s63 offen offset:0 lds
buffer_load_dwordx4 v7,s[4:7],s63 offen offset:1024 lds
buffer_load_dwordx4 v8,s[4:7],s63 offen offset:2048 lds
s_add_u32 s63,s63,3072
s_add_u32 m0,s24,9216
s_nop 0
buffer_load_dwordx4 v6,s[4:7],s63 offen offset:0 lds
buffer_load_dwordx4 v7,s[4:7],s63 offen offset:1024 lds
buffer_load_dwordx4 v8,s[4:7],s63 offen offset:2048 lds
s_add_u32 s63,s63,3072
s_waitcnt vmcnt(0)
ds_read_b128 a[160:163],v11 offset:0
ds_read_b128 a[164:167],v12 offset:0
ds_read_b128 a[168:171],v11 offset:128
ds_read_b128 a[172:175],v12 offset:128
ds_read_b128 a[176:179],v11 offset:256
ds_read_b128 a[180:183],v12 offset:256
ds_read_b128 a[184:187],v11 offset:6144
ds_read_b128 a[188:191],v12 offset:6144
ds_read_b128 a[192:195],v11 offset:6272
ds_read_b128 a[196:199],v12 offset:6272
ds_read_b128 a[200:203],v11 offset:6400
ds_read_b128 a[204:207],v12 offset:6400
s_waitcnt lgkmcnt(0)
v_mfma_f32_16x16x32_bf16 v[72:75],a[160:163],a[0:3],0
v_mfma_f32_16x16x32_bf16 v[72:75],a[164:167],a[4:7],v[72:75]
v_mfma_f32_16x16x32_bf16 v[72:75],a[168:171],a[8:11],v[72:75]
v_mfma_f32_16x16x32_bf16 v[72:75],a[172:175],a[12:15],v[72:75]
v_mfma_f32_16x16x32_bf16 v[72:75],a[176:179],a[16:19],v[72:75]
v_mfma_f32_16x16x32_bf16 v[72:75],a[180:183],a[20:23],v[72:75]
v_mfma_f32_16x16x32_bf16 v[76:79],a[184:187],a[0:3],0
v_mfma_f32_16x16x32_bf16 v[76:79],a[188:191],a[4:7],v[76:79]
v_mfma_f32_16x16x32_bf16 v[76:79],a[192:195],a[8:11],v[76:79]
v_mfma_f32_16x16x32_bf16 v[76:79],a[196:199],a[12:15],v[76:79]
v_mfma_f32_16x16x32_bf16 v[76:79],a[200:203],a[16:19],v[76:79]
v_mfma_f32_16x16x32_bf16 v[76:79],a[204:207],a[20:23],v[76:79]
s_nop 7
v_max3_f32 v80,v80,v72,v73
v_max3_f32 v80,v80,v74,v75
v_max3_f32 v80,v80,v76,v77
v_max3_f32 v80,v80,v78,v79
s_add_u32 s53,s53,12288
s_add_u32 s52,s52,1
s_cmp_lt_u32 s52,16
s_cbranch_scc1 L_fix_max
v_mov_b32 v19,v80
s_nop 1
v_permlane32_swap_b32 v19,v80
v_max_f32 v80,v80,v19
v_mov_b32 v19,v80
s_nop 1
v_permlane16_swap_b32 v19,v80
v_max_f32 v80,v80,v19
v_mul_f32_e64 v13,-s36,v80
v_mov_b32 v160,0
v_mov_b32 v161,0
v_mov_b32 v162,0
v_mov_b32 v163,0
v_mov_b32 v164,0
v_mov_b32 v165,0
v_mov_b32 v166,0
v_mov_b32 v167,0
v_mov_b32 v168,0
v_mov_b32 v169,0
v_mov_b32 v170,0
v_mov_b32 v171,0
v_mov_b32 v172,0
v_mov_b32 v173,0
v_mov_b32 v174,0
v_mov_b32 v175,0
v_mov_b32 v176,0
v_mov_b32 v177,0
v_mov_b32 v178,0
v_mov_b32 v179,0
v_mov_b32 v180,0
v_mov_b32 v181,0
v_mov_b32 v182,0
v_mov_b32 v183,0
v_mov_b32 v184,0
v_mov_b32 v185,0
v_mov_b32 v186,0
v_mov_b32 v187,0
v_mov_b32 v188,0
v_mov_b32 v189,0
v_mov_b32 v190,0
v_mov_b32 v191,0
v_mov_b32 v192,0
v_mov_b32 v193,0
v_mov_b32 v194,0
v_mov_b32 v195,0
v_mov_b32 v196,0
v_mov_b32 v197,0
v_mov_b32 v198,0
v_mov_b32 v199,0
v_mov_b32 v200,0
v_mov_b32 v201,0
v_mov_b32 v202,0
v_mov_b32 v203,0
v_mov_b32 v204,0
v_mov_b32 v205,0
v_mov_b32 v206,0
v_mov_b32 v207,0
v_mov_b32 v60,0
v_mov_b32 v24,0
v_mov_b32 v61,0
v_mov_b32 v25,0
v_mov_b32 v62,0
v_mov_b32 v26,0
v_mov_b32 v63,0
v_mov_b32 v27,0
s_mov_b32 s53,s30
s_mov_b32 s52,0
L_fix_acc:
s_mov_b32 s63,s53
s_add_u32 m0,s24,0
s_nop 0
buffer_load_dwordx4 v6,s[4:7],s63 offen offset:0 lds
buffer_load_dwordx4 v7,s[4:7],s63 offen offset:1024 lds
buffer_load_dwordx4 v8,s[4:7],s63 offen offset:2048 lds
s_add_u32 s63,s63,3072
s_add_u32 m0,s24,3072
s_nop 0
buffer_load_dwordx4 v6,s[4:7],s63 offen offset:0 lds
buffer_load_dwordx4 v7,s[4:7],s63 offen offset:1024 lds
buffer_load_dwordx4 v8,s[4:7],s63 offen offset:2048 lds
s_add_u32 s63,s63,3072
s_add_u32 m0,s24,6144
s_nop 0
buffer_load_dwordx4 v6,s[4:7],s63 offen offset:0 lds
buffer_load_dwordx4 v7,s[4:7],s63 offen offset:1024 lds
buffer_load_dwordx4 v8,s[4:7],s63 offen offset:2048 lds
s_add_u32 s63,s63,3072
s_add_u32 m0,s24,9216
s_nop 0
buffer_load_dwordx4 v6,s[4:7],s63 offen offset:0 lds
buffer_load_dwordx4 v7,s[4:7],s63 offen offset:1024 lds
buffer_load_dwordx4 v8,s[4:7],s63 offen offset:2048 lds
s_add_u32 s63,s63,3072
s_waitcnt vmcnt(0)
ds_read_b128 a[160:163],v11 offset:0
ds_read_b128 a[164:167],v12 offset:0
ds_read_b128 a[168:171],v11 offset:128
ds_read_b128 a[172:175],v12 offset:128
ds_read_b128 a[176:179],v11 offset:256
ds_read_b128 a[180:183],v12 offset:256
ds_read_b128 a[184:187],v11 offset:6144
ds_read_b128 a[188:191],v12 offset:6144
ds_read_b128 a[192:195],v11 offset:6272
ds_read_b128 a[196:199],v12 offset:6272
ds_read_b128 a[200:203],v11 offset:6400
ds_read_b128 a[204:207],v12 offset:6400
s_waitcnt lgkmcnt(0)
v_mfma_f32_16x16x32_bf16 v[72:75],a[160:163],a[0:3],0
v_mfma_f32_16x16x32_bf16 v[72:75],a[164:167],a[4:7],v[72:75]
v_mfma_f32_16x16x32_bf16 v[72:75],a[168:171],a[8:11],v[72:75]
v_mfma_f32_16x16x32_bf16 v[72:75],a[172:175],a[12:15],v[72:75]
v_mfma_f32_16x16x32_bf16 v[72:75],a[176:179],a[16:19],v[72:75]
v_mfma_f32_16x16x32_bf16 v[72:75],a[180:183],a[20:23],v[72:75]
v_mfma_f32_16x16x32_bf16 v[76:79],a[184:187],a[0:3],0
v_mfma_f32_16x16x32_bf16 v[76:79],a[188:191],a[4:7],v[76:79]
v_mfma_f32_16x16x32_bf16 v[76:79],a[192:195],a[8:11],v[76:79]
v_mfma_f32_16x16x32_bf16 v[76:79],a[196:199],a[12:15],v[76:79]
v_mfma_f32_16x16x32_bf16 v[76:79],a[200:203],a[16:19],v[76:79]
v_mfma_f32_16x16x32_bf16 v[76:79],a[204:207],a[20:23],v[76:79]
s_nop 7
v_fma_f32 v72,v72,s36,v13
v_fma_f32 v73,v73,s36,v13
v_exp_f32 v72,v72
v_exp_f32 v73,v73
s_nop 0
v_cvt_pk_bf16_f32 v20,v72,v73
v_fma_f32 v74,v74,s36,v13
v_fma_f32 v75,v75,s36,v13
v_exp_f32 v74,v74
v_exp_f32 v75,v75
s_nop 0
v_cvt_pk_bf16_f32 v21,v74,v75
v_fma_f32 v76,v76,s36,v13
v_fma_f32 v77,v77,s36,v13
v_exp_f32 v76,v76
v_exp_f32 v77,v77
s_nop 0
v_cvt_pk_bf16_f32 v22,v76,v77
v_fma_f32 v78,v78,s36,v13
v_fma_f32 v79,v79,s36,v13
v_exp_f32 v78,v78
v_exp_f32 v79,v79
s_nop 0
v_cvt_pk_bf16_f32 v23,v78,v79
s_nop 1
v_smfmac_f32_16x16x64_bf16 v[60:63],a[152:155],v[20:27],v18
s_mov_b32 s63,s53
s_add_u32 m0,s24,0
s_nop 0
buffer_load_dwordx4 v6,s[8:11],s63 offen offset:0 lds
buffer_load_dwordx4 v7,s[8:11],s63 offen offset:1024 lds
buffer_load_dwordx4 v8,s[8:11],s63 offen offset:2048 lds
s_add_u32 s63,s63,3072
s_add_u32 m0,s24,3072
s_nop 0
buffer_load_dwordx4 v6,s[8:11],s63 offen offset:0 lds
buffer_load_dwordx4 v7,s[8:11],s63 offen offset:1024 lds
buffer_load_dwordx4 v8,s[8:11],s63 offen offset:2048 lds
s_add_u32 s63,s63,3072
s_add_u32 m0,s24,6144
s_nop 0
buffer_load_dwordx4 v6,s[8:11],s63 offen offset:0 lds
buffer_load_dwordx4 v7,s[8:11],s63 offen offset:1024 lds
buffer_load_dwordx4 v8,s[8:11],s63 offen offset:2048 lds
s_add_u32 s63,s63,3072
s_add_u32 m0,s24,9216
s_nop 0
buffer_load_dwordx4 v6,s[8:11],s63 offen offset:0 lds
buffer_load_dwordx4 v7,s[8:11],s63 offen offset:1024 lds
buffer_load_dwordx4 v8,s[8:11],s63 offen offset:2048 lds
s_add_u32 s63,s63,3072
s_waitcnt vmcnt(0)
ds_read_b64_tr_b16 a[160:161],v112 offset:0
ds_read_b64_tr_b16 a[162:163],v112 offset:6144
ds_read_b64_tr_b16 a[164:165],v113 offset:0
ds_read_b64_tr_b16 a[166:167],v113 offset:6144
ds_read_b64_tr_b16 a[168:169],v114 offset:0
ds_read_b64_tr_b16 a[170:171],v114 offset:6144
ds_read_b64_tr_b16 a[172:173],v115 offset:0
ds_read_b64_tr_b16 a[174:175],v115 offset:6144
ds_read_b64_tr_b16 a[176:177],v112 offset:128
ds_read_b64_tr_b16 a[178:179],v112 offset:6272
ds_read_b64_tr_b16 a[180:181],v113 offset:128
ds_read_b64_tr_b16 a[182:183],v113 offset:6272
ds_read_b64_tr_b16 a[184:185],v114 offset:128
ds_read_b64_tr_b16 a[186:187],v114 offset:6272
ds_read_b64_tr_b16 a[188:189],v115 offset:128
ds_read_b64_tr_b16 a[190:191],v115 offset:6272
ds_read_b64_tr_b16 a[192:193],v112 offset:256
ds_read_b64_tr_b16 a[194:195],v112 offset:6400
ds_read_b64_tr_b16 a[196:197],v113 offset:256
ds_read_b64_tr_b16 a[198:199],v113 offset:6400
ds_read_b64_tr_b16 a[200:201],v114 offset:256
ds_read_b64_tr_b16 a[202:203],v114 offset:6400
ds_read_b64_tr_b16 a[204:205],v115 offset:256
ds_read_b64_tr_b16 a[206:207],v115 offset:6400
s_waitcnt lgkmcnt(0)
v_mfma_f32_16x16x32_bf16 v[160:163],a[160:163],v[20:23],v[160:163]
v_mfma_f32_16x16x32_bf16 v[164:167],a[164:167],v[20:23],v[164:167]
v_mfma_f32_16x16x32_bf16 v[168:171],a[168:171],v[20:23],v[168:171]
v_mfma_f32_16x16x32_bf16 v[172:175],a[172:175],v[20:23],v[172:175]
v_mfma_f32_16x16x32_bf16 v[176:179],a[176:179],v[20:23],v[176:179]
v_mfma_f32_16x16x32_bf16 v[180:183],a[180:183],v[20:23],v[180:183]
v_mfma_f32_16x16x32_bf16 v[184:187],a[184:187],v[20:23],v[184:187]
v_mfma_f32_16x16x32_bf16 v[188:191],a[188:191],v[20:23],v[188:191]
v_mfma_f32_16x16x32_bf16 v[192:195],a[192:195],v[20:23],v[192:195]
v_mfma_f32_16x16x32_bf16 v[196:199],a[196:199],v[20:23],v[196:199]
v_mfma_f32_16x16x32_bf16 v[200:203],a[200:203],v[20:23],v[200:203]
v_mfma_f32_16x16x32_bf16 v[204:207],a[204:207],v[20:23],v[204:207]
s_add_u32 s53,s53,12288
s_add_u32 s52,s52,1
s_cmp_lt_u32 s52,16
s_cbranch_scc1 L_fix_acc
s_nop 7
v_add_f32 v19,v60,v61
v_rcp_f32 v19,v19
s_nop 0
v_mul_f32 v160,v160,v19
v_mul_f32 v161,v161,v19
v_mul_f32 v162,v162,v19
v_mul_f32 v163,v163,v19
v_cvt_pk_bf16_f32 v160,v160,v161
v_cvt_pk_bf16_f32 v161,v162,v163
buffer_store_dwordx2 v[160:161],v83,s[16:19],s41 offen offset:0
v_mul_f32 v164,v164,v19
v_mul_f32 v165,v165,v19
v_mul_f32 v166,v166,v19
v_mul_f32 v167,v167,v19
v_cvt_pk_bf16_f32 v164,v164,v165
v_cvt_pk_bf16_f32 v165,v166,v167
buffer_store_dwordx2 v[164:165],v83,s[16:19],s41 offen offset:32
v_mul_f32 v168,v168,v19
v_mul_f32 v169,v169,v19
v_mul_f32 v170,v170,v19
v_mul_f32 v171,v171,v19
v_cvt_pk_bf16_f32 v168,v168,v169
v_cvt_pk_bf16_f32 v169,v170,v171
buffer_store_dwordx2 v[168:169],v83,s[16:19],s41 offen offset:64
v_mul_f32 v172,v172,v19
v_mul_f32 v173,v173,v19
v_mul_f32 v174,v174,v19
v_mul_f32 v175,v175,v19
v_cvt_pk_bf16_f32 v172,v172,v173
v_cvt_pk_bf16_f32 v173,v174,v175
buffer_store_dwordx2 v[172:173],v83,s[16:19],s41 offen offset:96
v_mul_f32 v176,v176,v19
v_mul_f32 v177,v177,v19
v_mul_f32 v178,v178,v19
v_mul_f32 v179,v179,v19
v_cvt_pk_bf16_f32 v176,v176,v177
v_cvt_pk_bf16_f32 v177,v178,v179
buffer_store_dwordx2 v[176:177],v83,s[16:19],s41 offen offset:128
v_mul_f32 v180,v180,v19
v_mul_f32 v181,v181,v19
v_mul_f32 v182,v182,v19
v_mul_f32 v183,v183,v19
v_cvt_pk_bf16_f32 v180,v180,v181
v_cvt_pk_bf16_f32 v181,v182,v183
buffer_store_dwordx2 v[180:181],v83,s[16:19],s41 offen offset:160
v_mul_f32 v184,v184,v19
v_mul_f32 v185,v185,v19
v_mul_f32 v186,v186,v19
v_mul_f32 v187,v187,v19
v_cvt_pk_bf16_f32 v184,v184,v185
v_cvt_pk_bf16_f32 v185,v186,v187
buffer_store_dwordx2 v[184:185],v83,s[16:19],s41 offen offset:192
v_mul_f32 v188,v188,v19
v_mul_f32 v189,v189,v19
v_mul_f32 v190,v190,v19
v_mul_f32 v191,v191,v19
v_cvt_pk_bf16_f32 v188,v188,v189
v_cvt_pk_bf16_f32 v189,v190,v191
buffer_store_dwordx2 v[188:189],v83,s[16:19],s41 offen offset:224
v_mul_f32 v192,v192,v19
v_mul_f32 v193,v193,v19
v_mul_f32 v194,v194,v19
v_mul_f32 v195,v195,v19
v_cvt_pk_bf16_f32 v192,v192,v193
v_cvt_pk_bf16_f32 v193,v194,v195
buffer_store_dwordx2 v[192:193],v83,s[16:19],s41 offen offset:256
v_mul_f32 v196,v196,v19
v_mul_f32 v197,v197,v19
v_mul_f32 v198,v198,v19
v_mul_f32 v199,v199,v19
v_cvt_pk_bf16_f32 v196,v196,v197
v_cvt_pk_bf16_f32 v197,v198,v199
buffer_store_dwordx2 v[196:197],v83,s[16:19],s41 offen offset:288
v_mul_f32 v200,v200,v19
v_mul_f32 v201,v201,v19
v_mul_f32 v202,v202,v19
v_mul_f32 v203,v203,v19
v_cvt_pk_bf16_f32 v200,v200,v201
v_cvt_pk_bf16_f32 v201,v202,v203
buffer_store_dwordx2 v[200:201],v83,s[16:19],s41 offen offset:320
v_mul_f32 v204,v204,v19
v_mul_f32 v205,v205,v19
v_mul_f32 v206,v206,v19
v_mul_f32 v207,v207,v19
v_cvt_pk_bf16_f32 v204,v204,v205
v_cvt_pk_bf16_f32 v205,v206,v207
buffer_store_dwordx2 v[204:205],v83,s[16:19],s41 offen offset:352
s_waitcnt vmcnt(0)
s_add_u32 s41,s41,6144
s_add_u32 s51,s51,1
s_cmp_lt_u32 s51,s55
s_cbranch_scc1 L_fix_tile
s_cmp_lg_u32 s31,0
s_cbranch_scc1 L_fix_pass
s_branch L_done
L_codeend:
.section .rodata,"a"
.p2align 6
.amdhsa_kernel standalone__gqa_softmax__near_ridge_kernel
  .amdhsa_next_free_vgpr 512
  .amdhsa_next_free_sgpr 102
  .amdhsa_accum_offset 256
  .amdhsa_group_segment_fixed_size 0
  .amdhsa_kernarg_size 48
  .amdhsa_user_sgpr_count 2
  .amdhsa_user_sgpr_kernarg_segment_ptr 1
  .amdhsa_system_sgpr_workgroup_id_x 1
.end_amdhsa_kernel
```

```asm
; @launch grid=(256,1,1) block=(256,1,1) lds=163840
.amdgcn_target "amdgcn-amd-amdhsa--gfx950"
.text
.globl standalone__gqa_softmax__near_ridge_kernel
.p2align 8
.type standalone__gqa_softmax__near_ridge_kernel,@function
standalone__gqa_softmax__near_ridge_kernel:
s_cmp_ge_u32 s2,256
s_cbranch_scc1 L_end
s_load_dwordx4 s[84:87],s[0:1],0
s_load_dwordx4 s[88:91],s[0:1],16
v_lshrrev_b32 v80,6,v0
v_and_b32 v19,63,v0
v_readfirstlane_b32 s3,v80
s_lshr_b32 s34,s2,3
v_lshrrev_b32 v80,3,v19
v_and_b32 v82,7,v19
v_add_u32 v81,0,v80
v_mul_u32_u24 v81,43,v81
v_lshrrev_b32 v81,7,v81
v_and_b32 v81,6,v81
v_xor_b32 v81,v81,v82
v_lshlrev_b32 v81,4,v81
v_lshl_add_u32 v6,v80,7,v81
v_add_u32 v81,8,v80
v_mul_u32_u24 v81,43,v81
v_lshrrev_b32 v81,7,v81
v_and_b32 v81,6,v81
v_xor_b32 v81,v81,v82
v_lshlrev_b32 v81,4,v81
v_lshl_add_u32 v7,v80,7,v81
v_add_u32 v81,16,v80
v_mul_u32_u24 v81,43,v81
v_lshrrev_b32 v81,7,v81
v_and_b32 v81,6,v81
v_xor_b32 v81,v81,v82
v_lshlrev_b32 v81,4,v81
v_lshl_add_u32 v8,v80,7,v81
s_mov_b32 s37,0x5d800000
s_mov_b32 s36,0x3dd53b95
s_mov_b32 s31,0
s_mov_b32 s32,1
s_and_b32 s62,s2,7
s_lshl_b32 s33,s62,6
s_mul_i32 s22,s3,3072
s_add_u32 s23,s22,36864
s_mul_i32 s24,s3,22528
s_add_u32 s24,s24,73728
s_mov_b32 s69,0
s_lshl_b32 s62,s69,5
s_add_u32 s62,s62,s34
s_mul_i32 s63,s62,171
s_lshr_b32 s63,s63,9
s_mul_i32 s64,s63,3
s_sub_u32 s62,s62,s64
s_add_u32 s63,s63,s33
s_mul_i32 s30,s63,196608
s_mul_i32 s41,s63,325632
s_lshl_b32 s63,s3,2
s_add_u32 s64,s63,21
s_cmp_eq_u32 s3,0
s_cselect_b32 s64,20,s64
s_cselect_b32 s40,1,0
s_add_u32 s65,s63,37
s_cmp_eq_u32 s62,2
s_cselect_b32 s64,s65,s64
s_cselect_b32 s40,0,s40
s_add_u32 s65,s63,s3
s_cmp_eq_u32 s62,0
s_cselect_b32 s64,s65,s64
s_cselect_b32 s40,1,s40
s_mul_i32 s64,s64,6144
s_add_u32 s41,s41,s64
s_add_u32 s20,s30,s22
s_mov_b32 s21,s20
s_waitcnt lgkmcnt(0)
s_mov_b32 s4,s86
s_and_b32 s5,s87,0xffff
s_mov_b32 s6,100663296
s_mov_b32 s7,0x20000
s_mov_b32 s12,s84
s_and_b32 s13,s85,0xffff
s_mov_b32 s14,166723584
s_mov_b32 s15,0x20000
s_mov_b32 s8,s88
s_and_b32 s9,s89,0xffff
s_mov_b32 s10,100663296
s_mov_b32 s11,0x20000
s_mov_b32 s16,s90
s_and_b32 s17,s91,0xffff
s_mov_b32 s18,166723584
s_mov_b32 s19,0x20000
s_mov_b32 s28,s41
s_add_u32 m0,s22,0
s_nop 0
buffer_load_dwordx4 v6,s[4:7],s20 offen offset:0 lds
buffer_load_dwordx4 v7,s[4:7],s20 offen offset:1024 lds
buffer_load_dwordx4 v8,s[4:7],s20 offen offset:2048 lds
s_add_u32 s20,s20,12288
s_add_u32 m0,s24,0
s_nop 0
buffer_load_dwordx4 v6,s[12:15],s28 offen offset:0 nt lds
buffer_load_dwordx4 v7,s[12:15],s28 offen offset:1024 nt lds
buffer_load_dwordx4 v8,s[12:15],s28 offen offset:2048 nt lds
s_add_u32 s28,s28,3072
s_add_u32 m0,s24,3072
s_nop 0
buffer_load_dwordx4 v6,s[12:15],s28 offen offset:0 nt lds
buffer_load_dwordx4 v7,s[12:15],s28 offen offset:1024 nt lds
buffer_load_dwordx4 v8,s[12:15],s28 offen offset:2048 nt lds
s_add_u32 s28,s28,3072
s_add_u32 m0,s22,12288
s_nop 0
buffer_load_dwordx4 v6,s[4:7],s20 offen offset:0 lds
buffer_load_dwordx4 v7,s[4:7],s20 offen offset:1024 lds
buffer_load_dwordx4 v8,s[4:7],s20 offen offset:2048 lds
s_add_u32 s20,s20,12288
s_add_u32 m0,s22,24576
s_nop 0
buffer_load_dwordx4 v6,s[4:7],s20 offen offset:0 lds
buffer_load_dwordx4 v7,s[4:7],s20 offen offset:1024 lds
buffer_load_dwordx4 v8,s[4:7],s20 offen offset:2048 lds
s_add_u32 s20,s20,12288
s_add_u32 m0,s23,0
s_nop 0
buffer_load_dwordx4 v6,s[8:11],s21 offen offset:0 lds
buffer_load_dwordx4 v7,s[8:11],s21 offen offset:1024 lds
buffer_load_dwordx4 v8,s[8:11],s21 offen offset:2048 lds
s_add_u32 s21,s21,12288
s_add_u32 m0,s24,6144
s_nop 0
buffer_load_dwordx4 v6,s[12:15],s28 offen offset:0 nt lds
buffer_load_dwordx4 v7,s[12:15],s28 offen offset:1024 nt lds
buffer_load_dwordx4 v8,s[12:15],s28 offen offset:2048 nt lds
s_add_u32 s28,s28,3072
s_add_u32 m0,s24,9216
s_nop 0
buffer_load_dwordx4 v6,s[12:15],s28 offen offset:0 nt lds
buffer_load_dwordx4 v7,s[12:15],s28 offen offset:1024 nt lds
buffer_load_dwordx4 v8,s[12:15],s28 offen offset:2048 nt lds
s_add_u32 s28,s28,3072
s_getpc_b64 s[46:47]
s_mul_i32 s62,s34,4096
s_mul_i32 s48,s3,1024
s_add_u32 s48,s48,s62
v_min_u32 v85,31,v19
v_lshlrev_b32 v85,7,v85
v_add_u32 v85,s62,v85
v_min_u32 v85,L_codeend-L_first-4,v85
s_cmp_lg_u32 s3,0
s_cbranch_scc1 L_nopre
global_load_dword v112,v85,s[46:47]
L_nopre:
v_and_b32 v80,15,v19
v_lshrrev_b32 v81,4,v19
v_mul_u32_u24 v0,384,v80
v_and_b32 v83,6,v80
v_xor_b32 v83,v83,v81
v_lshl_add_u32 v0,v83,4,v0
v_xor_b32 v1,64,v0
v_add_u32 v11,s24,v0
v_add_u32 v12,s24,v1
v_lshrrev_b32 v80,2,v19
v_mul_u32_u24 v2,384,v80
v_and_b32 v80,6,v80
v_bfe_u32 v83,v19,1,1
v_xor_b32 v80,v80,v83
v_lshl_add_u32 v2,v80,4,v2
v_and_b32 v83,1,v19
v_lshl_add_u32 v2,v83,3,v2
v_add_u32 v2,36864,v2
v_xor_b32 v3,32,v2
v_xor_b32 v4,64,v2
v_xor_b32 v5,96,v2
v_lshrrev_b32 v80,3,v19
v_and_b32 v81,7,v19
v_xor_b32 v83,v81,v80
v_lshl_add_u32 v10,v80,7,s24
v_lshl_add_u32 v10,v83,4,v10
v_mul_u32_u24 v9,384,v80
v_lshl_add_u32 v9,v81,4,v9
v_lshrrev_b32 v80,4,v19
v_xor_b32 v80,v80,v19
v_bfe_u32 v80,v80,1,1
v_subrev_u32 v80,1,v80
v_and_b32 v80,0x3f803f80,v80
v_accvgpr_write_b32 a152,v80
v_accvgpr_write_b32 a153,v80
v_accvgpr_write_b32 a154,v80
v_accvgpr_write_b32 a155,v80
v_and_b32 v80,1,v19
v_mul_u32_u24 v80,0xaaaa,v80
v_add_u32 v18,0x4444,v80
L_first:
s_waitcnt vmcnt(12)
s_barrier
s_cmp_eq_u32 s40,0
s_cbranch_scc1 L_start4
L_start5:
s_add_u32 m0,s24,12288
s_waitcnt vmcnt(15)
ds_read_b128 a[4:7],v12 offset:0
buffer_load_dwordx4 v6,s[12:15],s28 offen offset:0 nt lds
ds_read_b128 a[12:15],v12 offset:128
buffer_load_dwordx4 v7,s[12:15],s28 offen offset:1024 nt lds
ds_read_b128 a[0:3],v11 offset:0
buffer_load_dwordx4 v8,s[12:15],s28 offen offset:2048 nt lds
s_add_u32 s28,s28,3072
s_add_u32 m0,s24,15360
ds_read_b128 a[8:11],v11 offset:128
buffer_load_dwordx4 v6,s[12:15],s28 offen offset:0 nt lds
ds_read_b128 a[16:19],v11 offset:256
buffer_load_dwordx4 v7,s[12:15],s28 offen offset:1024 nt lds
ds_read_b128 a[20:23],v12 offset:256
buffer_load_dwordx4 v8,s[12:15],s28 offen offset:2048 nt lds
s_add_u32 s28,s28,3072
s_add_u32 m0,s24,0
ds_read_b128 a[124:127],v1 offset:0
v_mov_b32 v62,0
ds_read_b128 a[120:123],v0 offset:0
v_mov_b32 v63,0
ds_read_b128 a[132:135],v1 offset:128
v_mov_b32 v66,0
ds_read_b128 a[128:131],v0 offset:128
v_mov_b32 v64,0
ds_read_b128 a[136:139],v0 offset:256
v_mov_b32 v61,0
ds_read_b128 a[140:143],v1 offset:256
v_mov_b32 v70,0
ds_read_b128 a[144:147],v0 offset:6144
v_mov_b32 v65,0
ds_read_b128 a[148:151],v1 offset:6144
v_mov_b32 v67,0
v_mov_b32 v68,0
v_mov_b32 v60,0
v_mov_b32 v71,0
v_mov_b32 v69,0
s_waitcnt lgkmcnt(6)
v_mfma_f32_16x16x32_bf16 v[72:75],a[120:123],a[0:3],0
ds_read_b128 a[120:123],v0 offset:6272
v_mfma_f32_16x16x32_bf16 v[72:75],a[124:127],a[4:7],v[72:75]
s_waitcnt lgkmcnt(5)
ds_read_b128 a[124:127],v1 offset:6272
v_mfma_f32_16x16x32_bf16 v[72:75],a[128:131],a[8:11],v[72:75]
ds_read_b128 a[128:131],v0 offset:6400
v_mfma_f32_16x16x32_bf16 v[72:75],a[132:135],a[12:15],v[72:75]
s_waitcnt lgkmcnt(5)
ds_read_b128 a[132:135],v1 offset:6400
v_mfma_f32_16x16x32_bf16 v[72:75],a[136:139],a[16:19],v[72:75]
ds_read_b128 a[136:139],v0 offset:12288
v_mfma_f32_16x16x32_bf16 v[72:75],a[140:143],a[20:23],v[72:75]
s_waitcnt lgkmcnt(5)
ds_read_b128 a[140:143],v1 offset:12288
v_mfma_f32_16x16x32_bf16 v[76:79],a[144:147],a[0:3],0
ds_read_b128 a[144:147],v0 offset:12416
v_mfma_f32_16x16x32_bf16 v[76:79],a[148:151],a[4:7],v[76:79]
s_waitcnt lgkmcnt(6)
ds_read_b128 a[148:151],v1 offset:12416
v_mfma_f32_16x16x32_bf16 v[76:79],a[120:123],a[8:11],v[76:79]
s_waitcnt lgkmcnt(6)
ds_read_b128 a[120:123],v0 offset:12544
v_mfma_f32_16x16x32_bf16 v[76:79],a[124:127],a[12:15],v[76:79]
s_waitcnt lgkmcnt(6)
ds_read_b128 a[124:127],v1 offset:12544
v_max3_f32 v44,v72,v73,v74
v_mfma_f32_16x16x32_bf16 v[76:79],a[128:131],a[16:19],v[76:79]
s_waitcnt lgkmcnt(6)
ds_read_b128 a[128:131],v0 offset:18432
v_mfma_f32_16x16x32_bf16 v[76:79],a[132:135],a[20:23],v[76:79]
ds_read_b128 a[132:135],v1 offset:18432
s_nop 6
v_max3_f32 v44,v44,v75,v76
v_max3_f32 v44,v44,v77,v78
v_max_f32 v44,v44,v79
v_mov_b32 v45,v44
s_nop 1
v_permlane32_swap_b32 v45,v44
v_max_f32 v44,v44,v45
v_mov_b32 v45,v44
s_nop 1
v_permlane16_swap_b32 v45,v44
v_max_f32 v44,v44,v45
v_mul_f32_e64 v13,-s36,v44
v_fma_f32 v73,v73,s36,v13
v_exp_f32 v73,v73
v_fma_f32 v75,v75,s36,v13
v_exp_f32 v75,v75
v_fma_f32 v74,v74,s36,v13
v_exp_f32 v74,v74
v_fma_f32 v72,v72,s36,v13
v_exp_f32 v72,v72
v_cvt_pk_bf16_f32 v21,v74,v75
v_cvt_pk_bf16_f32 v20,v72,v73
s_waitcnt lgkmcnt(0)
v_mfma_f32_16x16x32_bf16 v[72:75],a[136:139],a[0:3],0
ds_read_b128 a[136:139],v0 offset:18560
v_fma_f32 v77,v77,s36,v13
v_mfma_f32_16x16x32_bf16 v[72:75],a[140:143],a[4:7],v[72:75]
ds_read_b128 a[140:143],v1 offset:18560
v_exp_f32 v77,v77
v_mfma_f32_16x16x32_bf16 v[72:75],a[144:147],a[8:11],v[72:75]
ds_read_b128 a[144:147],v0 offset:18688
v_fma_f32 v76,v76,s36,v13
v_mfma_f32_16x16x32_bf16 v[72:75],a[148:151],a[12:15],v[72:75]
ds_read_b128 a[148:151],v1 offset:18688
v_exp_f32 v76,v76
v_mfma_f32_16x16x32_bf16 v[72:75],a[120:123],a[16:19],v[72:75]
v_fma_f32 v79,v79,s36,v13
v_exp_f32 v79,v79
v_mfma_f32_16x16x32_bf16 v[72:75],a[124:127],a[20:23],v[72:75]
v_fma_f32 v78,v78,s36,v13
v_exp_f32 v78,v78
v_cvt_pk_bf16_f32 v22,v76,v77
v_cvt_pk_bf16_f32 v23,v78,v79
v_mfma_f32_16x16x32_bf16 v[76:79],a[128:131],a[0:3],0
v_mfma_f32_16x16x32_bf16 v[76:79],a[132:135],a[4:7],v[76:79]
s_waitcnt lgkmcnt(2)
v_mfma_f32_16x16x32_bf16 v[76:79],a[136:139],a[8:11],v[76:79]
v_mfma_f32_16x16x32_bf16 v[76:79],a[140:143],a[12:15],v[76:79]
s_waitcnt lgkmcnt(0)
v_fma_f32 v73,v73,s36,v13
v_fma_f32 v74,v74,s36,v13
v_mfma_f32_16x16x32_bf16 v[76:79],a[144:147],a[16:19],v[76:79]
v_exp_f32 v74,v74
v_mfma_f32_16x16x32_bf16 v[76:79],a[148:151],a[20:23],v[76:79]
s_waitcnt vmcnt(12)
s_barrier
ds_read_b64_tr_b16 a[120:121],v2 offset:0
ds_read_b64_tr_b16 a[122:123],v2 offset:6144
ds_read_b64_tr_b16 a[126:127],v3 offset:6144
ds_read_b64_tr_b16 a[124:125],v3 offset:0
ds_read_b64_tr_b16 a[136:137],v2 offset:128
ds_read_b64_tr_b16 a[132:133],v5 offset:0
ds_read_b64_tr_b16 a[130:131],v4 offset:6144
ds_read_b64_tr_b16 a[140:141],v3 offset:128
ds_read_b64_tr_b16 a[138:139],v2 offset:6272
ds_read_b64_tr_b16 a[134:135],v5 offset:6144
ds_read_b64_tr_b16 a[144:145],v4 offset:128
ds_read_b64_tr_b16 a[128:129],v4 offset:0
ds_read_b64_tr_b16 a[148:149],v5 offset:128
ds_read_b64_tr_b16 a[146:147],v4 offset:6272
ds_read_b64_tr_b16 a[142:143],v3 offset:6272
ds_read_b64_tr_b16 a[150:151],v5 offset:6272
v_fma_f32 v75,v75,s36,v13
s_waitcnt lgkmcnt(14)
v_mfma_f32_16x16x32_bf16 v[160:163],a[120:123],v[20:23],0
s_waitcnt lgkmcnt(12)
ds_read_b64_tr_b16 a[122:123],v2 offset:6400
v_exp_f32 v75,v75
v_mfma_f32_16x16x32_bf16 v[164:167],a[124:127],v[20:23],0
ds_read_b64_tr_b16 a[126:127],v3 offset:6400
ds_read_b64_tr_b16 a[120:121],v2 offset:256
ds_read_b64_tr_b16 a[124:125],v3 offset:256
v_fma_f32 v72,v72,s36,v13
v_exp_f32 v72,v72
v_exp_f32 v73,v73
v_cvt_pk_bf16_f32 v45,v74,v75
v_cvt_pk_bf16_f32 v44,v72,v73
v_fma_f32 v76,v76,s36,v13
s_waitcnt lgkmcnt(8)
v_mfma_f32_16x16x32_bf16 v[168:171],a[128:131],v[20:23],0
ds_read_b64_tr_b16 a[128:129],v4 offset:256
v_fma_f32 v79,v79,s36,v13
v_mfma_f32_16x16x32_bf16 v[172:175],a[132:135],v[20:23],0
ds_read_b64_tr_b16 a[132:133],v5 offset:256
v_exp_f32 v79,v79
v_mfma_f32_16x16x32_bf16 v[176:179],a[136:139],v[20:23],0
s_waitcnt lgkmcnt(5)
ds_read_b64_tr_b16 a[130:131],v4 offset:6400
v_fma_f32 v78,v78,s36,v13
v_mfma_f32_16x16x32_bf16 v[180:183],a[140:143],v[20:23],0
ds_read_b128 a[140:143],v1 offset:24576
v_exp_f32 v78,v78
v_mfma_f32_16x16x32_bf16 v[184:187],a[144:147],v[20:23],0
ds_read_b64_tr_b16 a[134:135],v5 offset:6400
v_cvt_pk_bf16_f32 v47,v78,v79
v_mfma_f32_16x16x32_bf16 v[188:191],a[148:151],v[20:23],0
s_waitcnt lgkmcnt(5)
ds_read_b128 a[136:139],v0 offset:24576
v_fma_f32 v77,v77,s36,v13
v_mfma_f32_16x16x32_bf16 v[192:195],a[120:123],v[20:23],0
ds_read_b128 a[120:123],v0 offset:24832
v_exp_f32 v77,v77
v_mfma_f32_16x16x32_bf16 v[196:199],a[124:127],v[20:23],0
ds_read_b128 a[144:147],v0 offset:24704
v_exp_f32 v76,v76
ds_read_b128 a[148:151],v1 offset:24704
v_cvt_pk_bf16_f32 v46,v76,v77
s_waitcnt lgkmcnt(6)
v_mfma_f32_16x16x32_bf16 v[200:203],a[128:131],v[20:23],0
s_waitcnt lgkmcnt(4)
ds_read_b128 a[128:131],v0 offset:30720
ds_read_b128 a[124:127],v1 offset:24832
v_mfma_f32_16x16x32_bf16 v[204:207],a[132:135],v[20:23],0
s_waitcnt lgkmcnt(5)
ds_read_b128 a[132:135],v1 offset:30720
v_mfma_f32_16x16x32_bf16 v[72:75],a[136:139],a[0:3],0
ds_read_b128 a[136:139],v0 offset:30848
v_mfma_f32_16x16x32_bf16 v[72:75],a[140:143],a[4:7],v[72:75]
s_waitcnt lgkmcnt(5)
ds_read_b128 a[140:143],v1 offset:30848
v_mfma_f32_16x16x32_bf16 v[72:75],a[144:147],a[8:11],v[72:75]
s_waitcnt lgkmcnt(5)
ds_read_b128 a[144:147],v0 offset:30976
v_mfma_f32_16x16x32_bf16 v[72:75],a[148:151],a[12:15],v[72:75]
ds_read_b128 a[148:151],v1 offset:30976
v_mfma_f32_16x16x32_bf16 v[72:75],a[120:123],a[16:19],v[72:75]
s_waitcnt lgkmcnt(5)
ds_read_b128 a[120:123],v0 offset:0
v_mfma_f32_16x16x32_bf16 v[72:75],a[124:127],a[20:23],v[72:75]
ds_read_b128 a[124:127],v1 offset:0
v_mfma_f32_16x16x32_bf16 v[76:79],a[128:131],a[0:3],0
s_waitcnt lgkmcnt(6)
ds_read_b128 a[128:131],v0 offset:128
v_mfma_f32_16x16x32_bf16 v[76:79],a[132:135],a[4:7],v[76:79]
s_waitcnt lgkmcnt(6)
ds_read_b128 a[132:135],v1 offset:128
v_mfma_f32_16x16x32_bf16 v[76:79],a[136:139],a[8:11],v[76:79]
s_waitcnt lgkmcnt(6)
ds_read_b128 a[136:139],v0 offset:256
v_mfma_f32_16x16x32_bf16 v[76:79],a[140:143],a[12:15],v[76:79]
s_waitcnt lgkmcnt(6)
ds_read_b128 a[140:143],v1 offset:256
v_fma_f32 v72,v72,s36,v13
v_mfma_f32_16x16x32_bf16 v[76:79],a[144:147],a[16:19],v[76:79]
s_waitcnt lgkmcnt(6)
ds_read_b128 a[144:147],v0 offset:6144
v_exp_f32 v72,v72
v_mfma_f32_16x16x32_bf16 v[76:79],a[148:151],a[20:23],v[76:79]
s_waitcnt vmcnt(6)
ds_read_b128 a[28:31],v12 offset:6144
buffer_load_dwordx4 v6,s[12:15],s28 offen offset:0 nt lds
ds_read_b128 a[24:27],v11 offset:6144
buffer_load_dwordx4 v7,s[12:15],s28 offen offset:1024 nt lds
ds_read_b128 a[32:35],v11 offset:6272
buffer_load_dwordx4 v8,s[12:15],s28 offen offset:2048 nt lds
s_add_u32 s28,s28,3072
s_add_u32 m0,s24,3072
ds_read_b128 a[40:43],v11 offset:6400
buffer_load_dwordx4 v6,s[12:15],s28 offen offset:0 nt lds
ds_read_b128 a[36:39],v12 offset:6272
buffer_load_dwordx4 v7,s[12:15],s28 offen offset:1024 nt lds
ds_read_b128 a[44:47],v12 offset:6400
buffer_load_dwordx4 v8,s[12:15],s28 offen offset:2048 nt lds
s_add_u32 s28,s28,3072
s_add_u32 m0,s24,6144
ds_read_b128 a[148:151],v1 offset:6144
v_fma_f32 v75,v75,s36,v13
v_exp_f32 v75,v75
v_fma_f32 v74,v74,s36,v13
v_exp_f32 v74,v74
s_waitcnt lgkmcnt(5)
v_mfma_f32_16x16x32_bf16 v[80:83],a[120:123],a[24:27],0
ds_read_b128 a[120:123],v0 offset:6272
v_fma_f32 v73,v73,s36,v13
v_mfma_f32_16x16x32_bf16 v[80:83],a[124:127],a[28:31],v[80:83]
s_waitcnt lgkmcnt(4)
ds_read_b128 a[124:127],v1 offset:6272
v_exp_f32 v73,v73
v_mfma_f32_16x16x32_bf16 v[80:83],a[128:131],a[32:35],v[80:83]
s_waitcnt lgkmcnt(4)
ds_read_b128 a[128:131],v0 offset:6400
v_mfma_f32_16x16x32_bf16 v[80:83],a[132:135],a[36:39],v[80:83]
ds_read_b128 a[132:135],v1 offset:6400
v_mfma_f32_16x16x32_bf16 v[80:83],a[136:139],a[40:43],v[80:83]
s_waitcnt lgkmcnt(4)
ds_read_b128 a[136:139],v0 offset:12288
v_mfma_f32_16x16x32_bf16 v[80:83],a[140:143],a[44:47],v[80:83]
ds_read_b128 a[140:143],v1 offset:12288
v_mfma_f32_16x16x32_bf16 v[84:87],a[144:147],a[24:27],0
ds_read_b128 a[144:147],v0 offset:12416
v_mfma_f32_16x16x32_bf16 v[84:87],a[148:151],a[28:31],v[84:87]
s_waitcnt lgkmcnt(6)
ds_read_b128 a[148:151],v1 offset:12416
v_mfma_f32_16x16x32_bf16 v[84:87],a[120:123],a[32:35],v[84:87]
s_waitcnt lgkmcnt(6)
ds_read_b128 a[120:123],v0 offset:12544
v_mfma_f32_16x16x32_bf16 v[84:87],a[124:127],a[36:39],v[84:87]
s_waitcnt lgkmcnt(6)
ds_read_b128 a[124:127],v1 offset:12544
v_max3_f32 v48,v80,v81,v82
v_mfma_f32_16x16x32_bf16 v[84:87],a[128:131],a[40:43],v[84:87]
s_waitcnt lgkmcnt(6)
ds_read_b128 a[128:131],v0 offset:18432
v_mfma_f32_16x16x32_bf16 v[84:87],a[132:135],a[44:47],v[84:87]
ds_read_b128 a[132:135],v1 offset:18432
s_nop 6
v_max3_f32 v48,v48,v83,v84
v_max3_f32 v48,v48,v85,v86
v_max_f32 v48,v48,v87
v_mov_b32 v49,v48
s_nop 1
v_permlane32_swap_b32 v49,v48
v_max_f32 v48,v48,v49
v_mov_b32 v49,v48
s_nop 1
v_permlane16_swap_b32 v49,v48
v_max_f32 v48,v48,v49
v_mul_f32_e64 v14,-s36,v48
v_fma_f32 v80,v80,s36,v14
v_fma_f32 v83,v83,s36,v14
v_fma_f32 v82,v82,s36,v14
v_fma_f32 v81,v81,s36,v14
v_exp_f32 v81,v81
v_exp_f32 v80,v80
v_exp_f32 v83,v83
v_exp_f32 v82,v82
v_fma_f32 v87,v87,s36,v14
v_cvt_pk_bf16_f32 v25,v82,v83
v_cvt_pk_bf16_f32 v24,v80,v81
s_waitcnt lgkmcnt(0)
v_mfma_f32_16x16x32_bf16 v[80:83],a[136:139],a[24:27],0
ds_read_b128 a[136:139],v0 offset:18560
v_fma_f32 v86,v86,s36,v14
v_mfma_f32_16x16x32_bf16 v[80:83],a[140:143],a[28:31],v[80:83]
ds_read_b128 a[140:143],v1 offset:18560
v_exp_f32 v86,v86
v_mfma_f32_16x16x32_bf16 v[80:83],a[144:147],a[32:35],v[80:83]
ds_read_b128 a[144:147],v0 offset:18688
v_fma_f32 v84,v84,s36,v14
v_mfma_f32_16x16x32_bf16 v[80:83],a[148:151],a[36:39],v[80:83]
ds_read_b128 a[148:151],v1 offset:18688
v_exp_f32 v87,v87
v_mfma_f32_16x16x32_bf16 v[80:83],a[120:123],a[40:43],v[80:83]
ds_read_b64_tr_b16 a[120:121],v2 offset:0
v_cvt_pk_bf16_f32 v27,v86,v87
v_mfma_f32_16x16x32_bf16 v[80:83],a[124:127],a[44:47],v[80:83]
ds_read_b64_tr_b16 a[126:127],v3 offset:6144
ds_read_b64_tr_b16 a[124:125],v3 offset:0
ds_read_b64_tr_b16 a[122:123],v2 offset:6144
v_exp_f32 v84,v84
v_fma_f32 v85,v85,s36,v14
v_exp_f32 v85,v85
s_nop 0
v_cvt_pk_bf16_f32 v26,v84,v85
v_mfma_f32_16x16x32_bf16 v[84:87],a[128:131],a[24:27],0
ds_read_b64_tr_b16 a[128:129],v4 offset:0
v_fma_f32 v80,v80,s36,v14
v_smfmac_f32_16x16x64_bf16 v[60:63],a[152:155],v[20:27],v18
ds_read_b64_tr_b16 a[130:131],v4 offset:6144
v_mfma_f32_16x16x32_bf16 v[84:87],a[132:135],a[28:31],v[84:87]
s_waitcnt lgkmcnt(6)
ds_read_b64_tr_b16 a[134:135],v5 offset:6144
v_fma_f32 v81,v81,s36,v14
v_mfma_f32_16x16x32_bf16 v[84:87],a[136:139],a[32:35],v[84:87]
ds_read_b64_tr_b16 a[138:139],v2 offset:6272
v_exp_f32 v81,v81
v_mfma_f32_16x16x32_bf16 v[84:87],a[140:143],a[36:39],v[84:87]
ds_read_b64_tr_b16 a[132:133],v5 offset:0
v_exp_f32 v80,v80
v_mfma_f32_16x16x32_bf16 v[84:87],a[144:147],a[40:43],v[84:87]
ds_read_b64_tr_b16 a[136:137],v2 offset:128
v_cvt_pk_bf16_f32 v48,v80,v81
v_mfma_f32_16x16x32_bf16 v[84:87],a[148:151],a[44:47],v[84:87]
s_waitcnt lgkmcnt(6)
ds_read_b64_tr_b16 a[150:151],v5 offset:6272
v_fma_f32 v82,v82,s36,v14
v_mfma_f32_16x16x32_bf16 v[208:211],a[120:123],v[24:27],0
ds_read_b64_tr_b16 a[142:143],v3 offset:6272
v_exp_f32 v82,v82
v_mfma_f32_16x16x32_bf16 v[212:215],a[124:127],v[24:27],0
s_waitcnt lgkmcnt(5)
ds_read_b64_tr_b16 a[120:121],v2 offset:256
v_fma_f32 v83,v83,s36,v14
v_mfma_f32_16x16x32_bf16 v[216:219],a[128:131],v[24:27],0
ds_read_b64_tr_b16 a[146:147],v4 offset:6272
ds_read_b64_tr_b16 a[148:149],v5 offset:128
ds_read_b64_tr_b16 a[140:141],v3 offset:128
ds_read_b64_tr_b16 a[144:145],v4 offset:128
v_exp_f32 v83,v83
s_waitcnt lgkmcnt(8)
v_mfma_f32_16x16x32_bf16 v[220:223],a[132:135],v[24:27],0
s_waitcnt lgkmcnt(7)
ds_read_b64_tr_b16 a[122:123],v2 offset:6400
v_cvt_pk_bf16_f32 v49,v82,v83
v_mfma_f32_16x16x32_bf16 v[224:227],a[136:139],v[24:27],0
ds_read_b64_tr_b16 a[132:133],v5 offset:256
ds_read_b64_tr_b16 a[134:135],v5 offset:6400
ds_read_b64_tr_b16 a[126:127],v3 offset:6400
ds_read_b64_tr_b16 a[130:131],v4 offset:6400
ds_read_b64_tr_b16 a[124:125],v3 offset:256
ds_read_b64_tr_b16 a[128:129],v4 offset:256
ds_read_b128 a[136:139],v0 offset:24576
v_fma_f32 v86,v86,s36,v14
v_fma_f32 v87,v87,s36,v14
v_exp_f32 v87,v87
v_fma_f32 v85,v85,s36,v14
v_exp_f32 v85,v85
s_waitcnt lgkmcnt(9)
v_mfma_f32_16x16x32_bf16 v[228:231],a[140:143],v[24:27],0
s_waitcnt lgkmcnt(8)
ds_read_b128 a[140:143],v1 offset:24576
v_fma_f32 v84,v84,s36,v14
v_mfma_f32_16x16x32_bf16 v[232:235],a[144:147],v[24:27],0
ds_read_b128 a[144:147],v0 offset:24704
v_exp_f32 v84,v84
v_mfma_f32_16x16x32_bf16 v[236:239],a[148:151],v[24:27],0
s_waitcnt lgkmcnt(9)
ds_read_b128 a[148:151],v1 offset:24704
v_cvt_pk_bf16_f32 v50,v84,v85
v_mfma_f32_16x16x32_bf16 v[240:243],a[120:123],v[24:27],0
s_waitcnt lgkmcnt(4)
ds_read_b128 a[120:123],v0 offset:24832
v_exp_f32 v86,v86
v_mfma_f32_16x16x32_bf16 v[244:247],a[124:127],v[24:27],0
ds_read_b128 a[124:127],v1 offset:24832
v_cvt_pk_bf16_f32 v51,v86,v87
v_mfma_f32_16x16x32_bf16 v[248:251],a[128:131],v[24:27],0
ds_read_b128 a[128:131],v0 offset:30720
v_cvt_pk_bf16_f32 v20,v72,v73
v_smfmac_f32_16x16x64_bf16 v[60:63],a[152:155],v[44:51],v18
v_cvt_pk_bf16_f32 v21,v74,v75
v_mfma_f32_16x16x32_bf16 v[252:255],a[132:135],v[24:27],0
s_waitcnt lgkmcnt(4)
ds_read_b128 a[132:135],v1 offset:30720
v_mfma_f32_16x16x32_bf16 v[80:83],a[136:139],a[24:27],0
ds_read_b128 a[136:139],v0 offset:30848
v_mfma_f32_16x16x32_bf16 v[80:83],a[140:143],a[28:31],v[80:83]
ds_read_b128 a[140:143],v1 offset:30848
v_mfma_f32_16x16x32_bf16 v[80:83],a[144:147],a[32:35],v[80:83]
s_waitcnt lgkmcnt(5)
ds_read_b128 a[144:147],v0 offset:30976
v_mfma_f32_16x16x32_bf16 v[80:83],a[148:151],a[36:39],v[80:83]
ds_read_b128 a[148:151],v1 offset:30976
v_mfma_f32_16x16x32_bf16 v[80:83],a[120:123],a[40:43],v[80:83]
s_waitcnt lgkmcnt(5)
ds_read_b128 a[120:123],v0 offset:0
v_mfma_f32_16x16x32_bf16 v[80:83],a[124:127],a[44:47],v[80:83]
ds_read_b128 a[124:127],v1 offset:0
v_mfma_f32_16x16x32_bf16 v[84:87],a[128:131],a[24:27],0
s_waitcnt lgkmcnt(6)
ds_read_b128 a[128:131],v0 offset:128
v_mfma_f32_16x16x32_bf16 v[84:87],a[132:135],a[28:31],v[84:87]
s_waitcnt lgkmcnt(6)
ds_read_b128 a[132:135],v1 offset:128
v_mfma_f32_16x16x32_bf16 v[84:87],a[136:139],a[32:35],v[84:87]
s_waitcnt lgkmcnt(6)
ds_read_b128 a[136:139],v0 offset:256
v_mfma_f32_16x16x32_bf16 v[84:87],a[140:143],a[36:39],v[84:87]
s_waitcnt lgkmcnt(6)
ds_read_b128 a[140:143],v1 offset:256
v_fma_f32 v82,v82,s36,v14
v_mfma_f32_16x16x32_bf16 v[84:87],a[144:147],a[40:43],v[84:87]
s_waitcnt lgkmcnt(6)
ds_read_b128 a[144:147],v0 offset:6144
v_fma_f32 v81,v81,s36,v14
v_mfma_f32_16x16x32_bf16 v[84:87],a[148:151],a[44:47],v[84:87]
s_waitcnt vmcnt(6)
ds_read_b128 a[48:51],v11 offset:12288
buffer_load_dwordx4 v6,s[12:15],s28 offen offset:0 nt lds
ds_read_b128 a[64:67],v11 offset:12544
buffer_load_dwordx4 v7,s[12:15],s28 offen offset:1024 nt lds
ds_read_b128 a[60:63],v12 offset:12416
buffer_load_dwordx4 v8,s[12:15],s28 offen offset:2048 nt lds
s_add_u32 s28,s28,3072
s_add_u32 m0,s24,9216
ds_read_b128 a[52:55],v12 offset:12288
buffer_load_dwordx4 v6,s[12:15],s28 offen offset:0 nt lds
ds_read_b128 a[68:71],v12 offset:12544
buffer_load_dwordx4 v7,s[12:15],s28 offen offset:1024 nt lds
ds_read_b128 a[56:59],v11 offset:12416
buffer_load_dwordx4 v8,s[12:15],s28 offen offset:2048 nt lds
s_add_u32 s28,s28,3072
s_add_u32 m0,s23,12288
ds_read_b128 a[148:151],v1 offset:6144
v_exp_f32 v82,v82
s_waitcnt lgkmcnt(6)
v_mfma_f32_16x16x32_bf16 v[88:91],a[120:123],a[48:51],0
ds_read_b128 a[120:123],v0 offset:6272
v_fma_f32 v80,v80,s36,v14
v_exp_f32 v81,v81
v_exp_f32 v80,v80
v_fma_f32 v83,v83,s36,v14
v_exp_f32 v83,v83
v_cvt_pk_bf16_f32 v24,v80,v81
v_cvt_pk_bf16_f32 v25,v82,v83
s_waitcnt lgkmcnt(4)
v_mfma_f32_16x16x32_bf16 v[88:91],a[124:127],a[52:55],v[88:91]
s_waitcnt lgkmcnt(2)
ds_read_b128 a[124:127],v1 offset:6272
v_mfma_f32_16x16x32_bf16 v[88:91],a[128:131],a[56:59],v[88:91]
ds_read_b128 a[128:131],v0 offset:6400
v_mfma_f32_16x16x32_bf16 v[88:91],a[132:135],a[60:63],v[88:91]
ds_read_b128 a[132:135],v1 offset:6400
v_mfma_f32_16x16x32_bf16 v[88:91],a[136:139],a[64:67],v[88:91]
ds_read_b128 a[136:139],v0 offset:12288
v_mfma_f32_16x16x32_bf16 v[88:91],a[140:143],a[68:71],v[88:91]
ds_read_b128 a[140:143],v1 offset:12288
v_mfma_f32_16x16x32_bf16 v[92:95],a[144:147],a[48:51],0
s_waitcnt lgkmcnt(5)
ds_read_b128 a[144:147],v0 offset:12416
v_mfma_f32_16x16x32_bf16 v[92:95],a[148:151],a[52:55],v[92:95]
ds_read_b128 a[148:151],v1 offset:12416
v_mfma_f32_16x16x32_bf16 v[92:95],a[120:123],a[56:59],v[92:95]
s_waitcnt lgkmcnt(6)
ds_read_b128 a[120:123],v0 offset:12544
v_mfma_f32_16x16x32_bf16 v[92:95],a[124:127],a[60:63],v[92:95]
s_waitcnt lgkmcnt(6)
ds_read_b128 a[124:127],v1 offset:12544
v_max3_f32 v52,v88,v89,v90
v_mfma_f32_16x16x32_bf16 v[92:95],a[128:131],a[64:67],v[92:95]
s_waitcnt lgkmcnt(6)
ds_read_b128 a[128:131],v0 offset:18432
v_mfma_f32_16x16x32_bf16 v[92:95],a[132:135],a[68:71],v[92:95]
ds_read_b128 a[132:135],v1 offset:18432
s_nop 6
v_max3_f32 v52,v52,v91,v92
v_max3_f32 v52,v52,v93,v94
v_max_f32 v52,v52,v95
v_mov_b32 v53,v52
s_nop 1
v_permlane32_swap_b32 v53,v52
v_max_f32 v52,v52,v53
v_mov_b32 v53,v52
s_nop 1
v_permlane16_swap_b32 v53,v52
v_max_f32 v52,v52,v53
v_mul_f32_e64 v15,-s36,v52
v_fma_f32 v89,v89,s36,v15
v_fma_f32 v88,v88,s36,v15
v_exp_f32 v88,v88
v_exp_f32 v89,v89
v_fma_f32 v90,v90,s36,v15
v_exp_f32 v90,v90
v_cvt_pk_bf16_f32 v28,v88,v89
v_fma_f32 v91,v91,s36,v15
v_exp_f32 v91,v91
v_fma_f32 v95,v95,s36,v15
v_cvt_pk_bf16_f32 v29,v90,v91
s_waitcnt lgkmcnt(0)
v_mfma_f32_16x16x32_bf16 v[88:91],a[136:139],a[48:51],0
ds_read_b128 a[136:139],v0 offset:18560
v_fma_f32 v93,v93,s36,v15
v_mfma_f32_16x16x32_bf16 v[88:91],a[140:143],a[52:55],v[88:91]
ds_read_b128 a[140:143],v1 offset:18560
v_exp_f32 v93,v93
v_mfma_f32_16x16x32_bf16 v[88:91],a[144:147],a[56:59],v[88:91]
ds_read_b128 a[144:147],v0 offset:18688
v_fma_f32 v92,v92,s36,v15
v_mfma_f32_16x16x32_bf16 v[88:91],a[148:151],a[60:63],v[88:91]
ds_read_b128 a[148:151],v1 offset:18688
v_fma_f32 v94,v94,s36,v15
v_mfma_f32_16x16x32_bf16 v[88:91],a[120:123],a[64:67],v[88:91]
ds_read_b64_tr_b16 a[120:121],v2 offset:0
v_exp_f32 v94,v94
v_mfma_f32_16x16x32_bf16 v[88:91],a[124:127],a[68:71],v[88:91]
ds_read_b64_tr_b16 a[124:125],v3 offset:0
ds_read_b64_tr_b16 a[126:127],v3 offset:6144
ds_read_b64_tr_b16 a[122:123],v2 offset:6144
v_exp_f32 v92,v92
v_exp_f32 v95,v95
v_cvt_pk_bf16_f32 v30,v92,v93
v_cvt_pk_bf16_f32 v31,v94,v95
v_mfma_f32_16x16x32_bf16 v[92:95],a[128:131],a[48:51],0
ds_read_b64_tr_b16 a[130:131],v4 offset:6144
v_fma_f32 v90,v90,s36,v15
v_mfma_f32_16x16x32_bf16 v[92:95],a[132:135],a[52:55],v[92:95]
s_waitcnt lgkmcnt(6)
ds_read_b64_tr_b16 a[128:129],v4 offset:0
v_exp_f32 v90,v90
v_mfma_f32_16x16x32_bf16 v[92:95],a[136:139],a[56:59],v[92:95]
ds_read_b64_tr_b16 a[132:133],v5 offset:0
v_fma_f32 v89,v89,s36,v15
v_mfma_f32_16x16x32_bf16 v[92:95],a[140:143],a[60:63],v[92:95]
ds_read_b64_tr_b16 a[140:141],v3 offset:128
v_exp_f32 v89,v89
v_mfma_f32_16x16x32_bf16 v[92:95],a[144:147],a[64:67],v[92:95]
s_waitcnt lgkmcnt(4)
ds_read_b64_tr_b16 a[138:139],v2 offset:6272
v_fma_f32 v88,v88,s36,v15
v_mfma_f32_16x16x32_bf16 v[92:95],a[148:151],a[68:71],v[92:95]
ds_read_b64_tr_b16 a[134:135],v5 offset:6144
v_exp_f32 v88,v88
v_mfma_f32_16x16x32_bf16 v[112:115],a[120:123],v[28:31],0
ds_read_b64_tr_b16 a[150:151],v5 offset:6272
v_cvt_pk_bf16_f32 v52,v88,v89
v_mfma_f32_16x16x32_bf16 v[116:119],a[124:127],v[28:31],0
s_waitcnt lgkmcnt(5)
ds_read_b64_tr_b16 a[146:147],v4 offset:6272
ds_read_b64_tr_b16 a[136:137],v2 offset:128
ds_read_b64_tr_b16 a[142:143],v3 offset:6272
v_mfma_f32_16x16x32_bf16 v[120:123],a[128:131],v[28:31],0
ds_read_b64_tr_b16 a[148:149],v5 offset:128
ds_read_b64_tr_b16 a[126:127],v3 offset:6400
ds_read_b64_tr_b16 a[144:145],v4 offset:128
ds_read_b64_tr_b16 a[122:123],v2 offset:6400
ds_read_b64_tr_b16 a[128:129],v4 offset:256
ds_read_b64_tr_b16 a[130:131],v4 offset:6400
ds_read_b64_tr_b16 a[120:121],v2 offset:256
v_fma_f32 v91,v91,s36,v15
ds_read_b64_tr_b16 a[124:125],v3 offset:256
s_waitcnt lgkmcnt(12)
v_mfma_f32_16x16x32_bf16 v[124:127],a[132:135],v[28:31],0
ds_read_b64_tr_b16 a[134:135],v5 offset:6400
ds_read_b64_tr_b16 a[132:133],v5 offset:256
v_exp_f32 v91,v91
v_fma_f32 v94,v94,s36,v15
s_waitcnt lgkmcnt(11)
v_mfma_f32_16x16x32_bf16 v[128:131],a[136:139],v[28:31],0
s_waitcnt lgkmcnt(10)
ds_read_b128 a[136:139],v0 offset:24576
v_cvt_pk_bf16_f32 v53,v90,v91
v_mfma_f32_16x16x32_bf16 v[132:135],a[140:143],v[28:31],0
s_waitcnt lgkmcnt(8)
ds_read_b128 a[140:143],v1 offset:24576
v_exp_f32 v94,v94
v_mfma_f32_16x16x32_bf16 v[136:139],a[144:147],v[28:31],0
ds_read_b128 a[144:147],v0 offset:24704
v_fma_f32 v93,v93,s36,v15
v_mfma_f32_16x16x32_bf16 v[140:143],a[148:151],v[28:31],0
s_waitcnt lgkmcnt(5)
ds_read_b128 a[148:151],v1 offset:24704
v_exp_f32 v93,v93
v_mfma_f32_16x16x32_bf16 v[144:147],a[120:123],v[28:31],0
ds_read_b128 a[120:123],v0 offset:24832
v_fma_f32 v95,v95,s36,v15
v_mfma_f32_16x16x32_bf16 v[148:151],a[124:127],v[28:31],0
ds_read_b128 a[124:127],v1 offset:24832
v_exp_f32 v95,v95
v_mfma_f32_16x16x32_bf16 v[152:155],a[128:131],v[28:31],0
s_waitcnt lgkmcnt(5)
ds_read_b128 a[128:131],v0 offset:30720
v_fma_f32 v92,v92,s36,v15
v_mfma_f32_16x16x32_bf16 v[156:159],a[132:135],v[28:31],0
ds_read_b128 a[132:135],v1 offset:30720
v_exp_f32 v92,v92
v_mfma_f32_16x16x32_bf16 v[88:91],a[136:139],a[48:51],0
s_waitcnt lgkmcnt(5)
ds_read_b128 a[136:139],v0 offset:30848
v_cvt_pk_bf16_f32 v54,v92,v93
v_mfma_f32_16x16x32_bf16 v[88:91],a[140:143],a[52:55],v[88:91]
ds_read_b128 a[140:143],v1 offset:30848
v_cvt_pk_bf16_f32 v55,v94,v95
v_mfma_f32_16x16x32_bf16 v[88:91],a[144:147],a[56:59],v[88:91]
s_waitcnt lgkmcnt(5)
ds_read_b128 a[144:147],v0 offset:30976
v_mfma_f32_16x16x32_bf16 v[88:91],a[148:151],a[60:63],v[88:91]
ds_read_b128 a[148:151],v1 offset:30976
v_mfma_f32_16x16x32_bf16 v[88:91],a[120:123],a[64:67],v[88:91]
s_waitcnt lgkmcnt(6)
ds_read_b128 a[120:123],v0 offset:0
v_mfma_f32_16x16x32_bf16 v[88:91],a[124:127],a[68:71],v[88:91]
s_waitcnt lgkmcnt(6)
ds_read_b128 a[124:127],v1 offset:0
v_mfma_f32_16x16x32_bf16 v[92:95],a[128:131],a[48:51],0
s_waitcnt lgkmcnt(6)
ds_read_b128 a[128:131],v0 offset:128
v_mfma_f32_16x16x32_bf16 v[92:95],a[132:135],a[52:55],v[92:95]
s_waitcnt lgkmcnt(6)
ds_read_b128 a[132:135],v1 offset:128
v_mfma_f32_16x16x32_bf16 v[92:95],a[136:139],a[56:59],v[92:95]
s_waitcnt lgkmcnt(6)
ds_read_b128 a[136:139],v0 offset:256
v_mfma_f32_16x16x32_bf16 v[92:95],a[140:143],a[60:63],v[92:95]
s_waitcnt lgkmcnt(6)
ds_read_b128 a[140:143],v1 offset:256
v_fma_f32 v88,v88,s36,v15
v_mfma_f32_16x16x32_bf16 v[92:95],a[144:147],a[64:67],v[92:95]
s_waitcnt lgkmcnt(6)
ds_read_b128 a[144:147],v0 offset:6144
v_exp_f32 v88,v88
v_mfma_f32_16x16x32_bf16 v[92:95],a[148:151],a[68:71],v[92:95]
s_waitcnt vmcnt(6)
ds_read_b128 a[80:83],v11 offset:128
buffer_load_dwordx4 v6,s[8:11],s21 offen offset:0 lds
ds_read_b128 a[72:75],v11 offset:0
buffer_load_dwordx4 v7,s[8:11],s21 offen offset:1024 lds
ds_read_b128 a[84:87],v12 offset:128
buffer_load_dwordx4 v8,s[8:11],s21 offen offset:2048 lds
s_add_u32 s21,s21,12288
s_add_u32 m0,s23,24576
ds_read_b128 a[76:79],v12 offset:0
v_fma_f32 v89,v89,s36,v15
ds_read_b128 a[88:91],v11 offset:256
v_exp_f32 v89,v89
ds_read_b128 a[92:95],v12 offset:256
ds_read_b128 a[148:151],v1 offset:6144
s_waitcnt lgkmcnt(5)
v_mfma_f32_16x16x32_bf16 v[96:99],a[120:123],a[72:75],0
s_waitcnt lgkmcnt(3)
ds_read_b128 a[120:123],v0 offset:6272
v_mfma_f32_16x16x32_bf16 v[96:99],a[124:127],a[76:79],v[96:99]
ds_read_b128 a[124:127],v1 offset:6272
v_mfma_f32_16x16x32_bf16 v[96:99],a[128:131],a[80:83],v[96:99]
ds_read_b128 a[128:131],v0 offset:6400
v_mfma_f32_16x16x32_bf16 v[96:99],a[132:135],a[84:87],v[96:99]
s_waitcnt lgkmcnt(5)
ds_read_b128 a[132:135],v1 offset:6400
v_mfma_f32_16x16x32_bf16 v[96:99],a[136:139],a[88:91],v[96:99]
s_waitcnt lgkmcnt(5)
ds_read_b128 a[136:139],v0 offset:12288
v_mfma_f32_16x16x32_bf16 v[96:99],a[140:143],a[92:95],v[96:99]
ds_read_b128 a[140:143],v1 offset:12288
v_mfma_f32_16x16x32_bf16 v[100:103],a[144:147],a[72:75],0
s_waitcnt lgkmcnt(6)
ds_read_b128 a[144:147],v0 offset:12416
v_mfma_f32_16x16x32_bf16 v[100:103],a[148:151],a[76:79],v[100:103]
s_waitcnt lgkmcnt(6)
ds_read_b128 a[148:151],v1 offset:12416
v_mfma_f32_16x16x32_bf16 v[100:103],a[120:123],a[80:83],v[100:103]
s_waitcnt lgkmcnt(6)
ds_read_b128 a[120:123],v0 offset:12544
v_mfma_f32_16x16x32_bf16 v[100:103],a[124:127],a[84:87],v[100:103]
s_waitcnt lgkmcnt(6)
ds_read_b128 a[124:127],v1 offset:12544
v_max3_f32 v56,v96,v97,v98
v_mfma_f32_16x16x32_bf16 v[100:103],a[128:131],a[88:91],v[100:103]
s_waitcnt lgkmcnt(6)
ds_read_b128 a[128:131],v0 offset:18432
v_mfma_f32_16x16x32_bf16 v[100:103],a[132:135],a[92:95],v[100:103]
ds_read_b128 a[132:135],v1 offset:18432
s_nop 6
v_max3_f32 v56,v56,v99,v100
v_max3_f32 v56,v56,v101,v102
v_max_f32 v56,v56,v103
v_mov_b32 v57,v56
s_nop 1
v_permlane32_swap_b32 v57,v56
v_max_f32 v56,v56,v57
v_mov_b32 v57,v56
s_nop 1
v_permlane16_swap_b32 v57,v56
v_max_f32 v56,v56,v57
v_mul_f32_e64 v16,-s36,v56
v_fma_f32 v99,v99,s36,v16
v_exp_f32 v99,v99
v_fma_f32 v97,v97,s36,v16
v_exp_f32 v97,v97
v_fma_f32 v96,v96,s36,v16
v_exp_f32 v96,v96
v_fma_f32 v98,v98,s36,v16
v_exp_f32 v98,v98
v_fma_f32 v103,v103,s36,v16
v_cvt_pk_bf16_f32 v33,v98,v99
v_exp_f32 v103,v103
v_cvt_pk_bf16_f32 v32,v96,v97
s_waitcnt lgkmcnt(0)
v_mfma_f32_16x16x32_bf16 v[96:99],a[136:139],a[72:75],0
ds_read_b128 a[136:139],v0 offset:18560
v_fma_f32 v101,v101,s36,v16
v_mfma_f32_16x16x32_bf16 v[96:99],a[140:143],a[76:79],v[96:99]
ds_read_b128 a[140:143],v1 offset:18560
v_fma_f32 v102,v102,s36,v16
v_mfma_f32_16x16x32_bf16 v[96:99],a[144:147],a[80:83],v[96:99]
ds_read_b128 a[144:147],v0 offset:18688
v_exp_f32 v102,v102
v_mfma_f32_16x16x32_bf16 v[96:99],a[148:151],a[84:87],v[96:99]
ds_read_b128 a[148:151],v1 offset:18688
v_cvt_pk_bf16_f32 v35,v102,v103
v_mfma_f32_16x16x32_bf16 v[96:99],a[120:123],a[88:91],v[96:99]
ds_read_b64_tr_b16 a[122:123],v2 offset:6144
v_exp_f32 v101,v101
v_mfma_f32_16x16x32_bf16 v[96:99],a[124:127],a[92:95],v[96:99]
ds_read_b64_tr_b16 a[120:121],v2 offset:0
ds_read_b64_tr_b16 a[126:127],v3 offset:6144
ds_read_b64_tr_b16 a[124:125],v3 offset:0
v_fma_f32 v100,v100,s36,v16
v_exp_f32 v100,v100
s_nop 0
v_cvt_pk_bf16_f32 v34,v100,v101
v_mfma_f32_16x16x32_bf16 v[100:103],a[128:131],a[72:75],0
ds_read_b64_tr_b16 a[128:129],v4 offset:0
v_fma_f32 v97,v97,s36,v16
v_smfmac_f32_16x16x64_bf16 v[64:67],a[152:155],v[28:35],v18
ds_read_b64_tr_b16 a[130:131],v4 offset:6144
v_mfma_f32_16x16x32_bf16 v[100:103],a[132:135],a[76:79],v[100:103]
s_waitcnt lgkmcnt(7)
ds_read_b64_tr_b16 a[132:133],v5 offset:0
v_fma_f32 v98,v98,s36,v16
v_mfma_f32_16x16x32_bf16 v[100:103],a[136:139],a[80:83],v[100:103]
ds_read_b64_tr_b16 a[138:139],v2 offset:6272
v_exp_f32 v98,v98
v_mfma_f32_16x16x32_bf16 v[100:103],a[140:143],a[84:87],v[100:103]
ds_read_b64_tr_b16 a[136:137],v2 offset:128
v_fma_f32 v96,v96,s36,v16
v_mfma_f32_16x16x32_bf16 v[100:103],a[144:147],a[88:91],v[100:103]
s_waitcnt lgkmcnt(5)
ds_read_b64_tr_b16 a[142:143],v3 offset:6272
v_exp_f32 v96,v96
v_mfma_f32_16x16x32_bf16 v[100:103],a[148:151],a[92:95],v[100:103]
ds_read_b64_tr_b16 a[134:135],v5 offset:6144
v_exp_f32 v97,v97
v_mfma_f32_16x16x32_bf16 a[160:163],a[120:123],v[32:35],0
ds_read_b64_tr_b16 a[146:147],v4 offset:6272
v_cvt_pk_bf16_f32 v56,v96,v97
v_mfma_f32_16x16x32_bf16 a[164:167],a[124:127],v[32:35],0
s_waitcnt lgkmcnt(5)
ds_read_b64_tr_b16 a[120:121],v2 offset:256
v_fma_f32 v99,v99,s36,v16
v_mfma_f32_16x16x32_bf16 a[168:171],a[128:131],v[32:35],0
ds_read_b64_tr_b16 a[150:151],v5 offset:6272
ds_read_b64_tr_b16 a[144:145],v4 offset:128
ds_read_b64_tr_b16 a[148:149],v5 offset:128
ds_read_b64_tr_b16 a[126:127],v3 offset:6400
ds_read_b64_tr_b16 a[124:125],v3 offset:256
ds_read_b64_tr_b16 a[128:129],v4 offset:256
ds_read_b64_tr_b16 a[140:141],v3 offset:128
ds_read_b64_tr_b16 a[122:123],v2 offset:6400
v_exp_f32 v99,v99
s_waitcnt lgkmcnt(10)
v_mfma_f32_16x16x32_bf16 a[172:175],a[132:135],v[32:35],0
ds_read_b64_tr_b16 a[134:135],v5 offset:6400
v_cvt_pk_bf16_f32 v57,v98,v99
ds_read_b64_tr_b16 a[130:131],v4 offset:6400
v_mfma_f32_16x16x32_bf16 a[176:179],a[136:139],v[32:35],0
ds_read_b128 a[136:139],v0 offset:24576
v_fma_f32 v102,v102,s36,v16
ds_read_b64_tr_b16 a[132:133],v5 offset:256
v_fma_f32 v103,v103,s36,v16
v_exp_f32 v103,v103
v_exp_f32 v102,v102
v_fma_f32 v101,v101,s36,v16
v_exp_f32 v101,v101
v_cvt_pk_bf16_f32 v59,v102,v103
v_fma_f32 v100,v100,s36,v16
v_exp_f32 v100,v100
s_waitcnt lgkmcnt(4)
v_mfma_f32_16x16x32_bf16 a[180:183],a[140:143],v[32:35],0
ds_read_b128 a[140:143],v1 offset:24576
v_cvt_pk_bf16_f32 v58,v100,v101
v_mfma_f32_16x16x32_bf16 a[184:187],a[144:147],v[32:35],0
ds_read_b128 a[144:147],v0 offset:24704
v_cvt_pk_bf16_f32 v28,v88,v89
v_smfmac_f32_16x16x64_bf16 v[64:67],a[152:155],v[52:59],v18
v_mfma_f32_16x16x32_bf16 a[188:191],a[148:151],v[32:35],0
ds_read_b128 a[148:151],v1 offset:24704
v_mfma_f32_16x16x32_bf16 a[192:195],a[120:123],v[32:35],0
ds_read_b128 a[120:123],v0 offset:24832
v_mfma_f32_16x16x32_bf16 a[196:199],a[124:127],v[32:35],0
s_waitcnt lgkmcnt(4)
ds_read_b128 a[124:127],v1 offset:24832
v_mfma_f32_16x16x32_bf16 a[200:203],a[128:131],v[32:35],0
ds_read_b128 a[128:131],v0 offset:30720
v_mfma_f32_16x16x32_bf16 a[204:207],a[132:135],v[32:35],0
ds_read_b128 a[132:135],v1 offset:30720
v_mfma_f32_16x16x32_bf16 v[96:99],a[136:139],a[72:75],0
s_waitcnt lgkmcnt(5)
ds_read_b128 a[136:139],v0 offset:30848
v_mfma_f32_16x16x32_bf16 v[96:99],a[140:143],a[76:79],v[96:99]
ds_read_b128 a[140:143],v1 offset:30848
v_mfma_f32_16x16x32_bf16 v[96:99],a[144:147],a[80:83],v[96:99]
s_waitcnt lgkmcnt(6)
ds_read_b128 a[144:147],v0 offset:30976
v_mfma_f32_16x16x32_bf16 v[96:99],a[148:151],a[84:87],v[96:99]
s_waitcnt lgkmcnt(6)
ds_read_b128 a[148:151],v1 offset:30976
v_mfma_f32_16x16x32_bf16 v[96:99],a[120:123],a[88:91],v[96:99]
s_waitcnt lgkmcnt(6)
ds_read_b128 a[120:123],v0 offset:0
v_mfma_f32_16x16x32_bf16 v[96:99],a[124:127],a[92:95],v[96:99]
s_waitcnt lgkmcnt(6)
ds_read_b128 a[124:127],v1 offset:0
v_mfma_f32_16x16x32_bf16 v[100:103],a[128:131],a[72:75],0
s_waitcnt lgkmcnt(6)
ds_read_b128 a[128:131],v0 offset:128
v_mfma_f32_16x16x32_bf16 v[100:103],a[132:135],a[76:79],v[100:103]
s_waitcnt lgkmcnt(6)
ds_read_b128 a[132:135],v1 offset:128
v_mfma_f32_16x16x32_bf16 v[100:103],a[136:139],a[80:83],v[100:103]
s_waitcnt lgkmcnt(6)
ds_read_b128 a[136:139],v0 offset:256
v_mfma_f32_16x16x32_bf16 v[100:103],a[140:143],a[84:87],v[100:103]
s_waitcnt lgkmcnt(6)
ds_read_b128 a[140:143],v1 offset:256
v_mfma_f32_16x16x32_bf16 v[100:103],a[144:147],a[88:91],v[100:103]
s_waitcnt lgkmcnt(6)
ds_read_b128 a[144:147],v0 offset:6144
v_mfma_f32_16x16x32_bf16 v[100:103],a[148:151],a[92:95],v[100:103]
s_waitcnt vmcnt(3)
ds_read_b128 a[96:99],v11 offset:6144
buffer_load_dwordx4 v6,s[8:11],s21 offen offset:0 lds
ds_read_b128 a[108:111],v12 offset:6272
buffer_load_dwordx4 v7,s[8:11],s21 offen offset:1024 lds
ds_read_b128 a[104:107],v11 offset:6272
buffer_load_dwordx4 v8,s[8:11],s21 offen offset:2048 lds
s_add_u32 s21,s21,12288
ds_read_b128 a[100:103],v12 offset:6144
s_add_u32 m0,s22,0
ds_read_b128 a[112:115],v11 offset:6400
ds_read_b128 a[116:119],v12 offset:6400
ds_read_b128 a[148:151],v1 offset:6144
s_waitcnt lgkmcnt(6)
v_mfma_f32_16x16x32_bf16 v[104:107],a[120:123],a[96:99],0
s_waitcnt lgkmcnt(3)
ds_read_b128 a[120:123],v0 offset:6272
v_mfma_f32_16x16x32_bf16 v[104:107],a[124:127],a[100:103],v[104:107]
ds_read_b128 a[124:127],v1 offset:6272
v_mfma_f32_16x16x32_bf16 v[104:107],a[128:131],a[104:107],v[104:107]
ds_read_b128 a[128:131],v0 offset:6400
v_mfma_f32_16x16x32_bf16 v[104:107],a[132:135],a[108:111],v[104:107]
ds_read_b128 a[132:135],v1 offset:6400
s_waitcnt vmcnt(3)
s_waitcnt lgkmcnt(6)
v_mfma_f32_16x16x32_bf16 v[104:107],a[136:139],a[112:115],v[104:107]
s_waitcnt lgkmcnt(5)
v_mfma_f32_16x16x32_bf16 v[104:107],a[140:143],a[116:119],v[104:107]
v_mfma_f32_16x16x32_bf16 v[108:111],a[144:147],a[96:99],0
s_waitcnt lgkmcnt(4)
v_mfma_f32_16x16x32_bf16 v[108:111],a[148:151],a[100:103],v[108:111]
s_waitcnt lgkmcnt(3)
v_mfma_f32_16x16x32_bf16 v[108:111],a[120:123],a[104:107],v[108:111]
s_waitcnt lgkmcnt(2)
v_mfma_f32_16x16x32_bf16 v[108:111],a[124:127],a[108:111],v[108:111]
s_waitcnt lgkmcnt(1)
v_mfma_f32_16x16x32_bf16 v[108:111],a[128:131],a[112:115],v[108:111]
s_waitcnt lgkmcnt(0)
v_mfma_f32_16x16x32_bf16 v[108:111],a[132:135],a[116:119],v[108:111]
s_barrier
buffer_load_dwordx4 v6,s[4:7],s20 offen offset:0 lds
buffer_load_dwordx4 v7,s[4:7],s20 offen offset:1024 lds
buffer_load_dwordx4 v8,s[4:7],s20 offen offset:2048 lds
ds_read_b128 a[148:151],v1 offset:12416
v_max3_f32 v40,v104,v105,v106
ds_read_b128 a[140:143],v1 offset:12288
s_add_u32 s20,s20,12288
ds_read_b128 a[124:127],v1 offset:12544
v_max3_f32 v40,v40,v107,v108
ds_read_b128 a[136:139],v0 offset:12288
v_max3_f32 v40,v40,v109,v110
ds_read_b128 a[144:147],v0 offset:12416
v_max_f32 v40,v40,v111
ds_read_b128 a[120:123],v0 offset:12544
v_mov_b32 v41,v40
ds_read_b128 a[132:135],v1 offset:18432
s_mov_b32 s27,166723584
ds_read_b128 a[128:131],v0 offset:18432
v_permlane32_swap_b32 v41,v40
v_max_f32 v40,v40,v41
v_mov_b32 v41,v40
s_mov_b32 s42,s41
s_add_u32 s69,s69,1
v_permlane16_swap_b32 v41,v40
v_max_f32 v40,v40,v41
v_mul_f32_e64 v17,-s36,v40
v_fma_f32 v105,v105,s36,v17
v_fma_f32 v104,v104,s36,v17
v_fma_f32 v106,v106,s36,v17
v_fma_f32 v107,v107,s36,v17
v_exp_f32 v105,v105
v_exp_f32 v107,v107
v_exp_f32 v104,v104
v_exp_f32 v106,v106
v_cvt_pk_bf16_f32 v36,v104,v105
v_fma_f32 v110,v110,s36,v17
v_cvt_pk_bf16_f32 v37,v106,v107
s_waitcnt lgkmcnt(2)
v_mfma_f32_16x16x32_bf16 v[104:107],a[136:139],a[96:99],0
s_lshl_b32 s62,s69,5
ds_read_b128 a[136:139],v0 offset:18560
v_fma_f32 v109,v109,s36,v17
v_mfma_f32_16x16x32_bf16 v[104:107],a[140:143],a[100:103],v[104:107]
s_add_u32 s62,s62,s34
ds_read_b128 a[140:143],v1 offset:18560
v_exp_f32 v109,v109
v_mfma_f32_16x16x32_bf16 v[104:107],a[144:147],a[104:107],v[104:107]
s_mul_i32 s63,s62,171
ds_read_b128 a[144:147],v0 offset:18688
v_exp_f32 v110,v110
v_mfma_f32_16x16x32_bf16 v[104:107],a[148:151],a[108:111],v[104:107]
s_lshr_b32 s63,s63,9
ds_read_b128 a[148:151],v1 offset:18688
v_fma_f32 v108,v108,s36,v17
v_mfma_f32_16x16x32_bf16 v[104:107],a[120:123],a[112:115],v[104:107]
s_mul_i32 s64,s63,3
ds_read_b64_tr_b16 a[122:123],v2 offset:6144
v_exp_f32 v108,v108
v_mfma_f32_16x16x32_bf16 v[104:107],a[124:127],a[116:119],v[104:107]
s_sub_u32 s62,s62,s64
ds_read_b64_tr_b16 a[120:121],v2 offset:0
ds_read_b64_tr_b16 a[126:127],v3 offset:6144
ds_read_b64_tr_b16 a[124:125],v3 offset:0
v_cvt_pk_bf16_f32 v38,v108,v109
v_fma_f32 v111,v111,s36,v17
v_exp_f32 v111,v111
s_add_u32 s63,s63,s33
v_cvt_pk_bf16_f32 v39,v110,v111
s_waitcnt lgkmcnt(7)
v_mfma_f32_16x16x32_bf16 v[108:111],a[128:131],a[96:99],0
s_mul_i32 s30,s63,196608
ds_read_b64_tr_b16 a[130:131],v4 offset:6144
v_fma_f32 v107,v107,s36,v17
v_mfma_f32_16x16x32_bf16 v[108:111],a[132:135],a[100:103],v[108:111]
s_mul_i32 s41,s63,325632
ds_read_b64_tr_b16 a[134:135],v5 offset:6144
v_exp_f32 v107,v107
v_mfma_f32_16x16x32_bf16 v[108:111],a[136:139],a[104:107],v[108:111]
s_lshl_b32 s63,s3,2
ds_read_b64_tr_b16 a[132:133],v5 offset:0
v_fma_f32 v104,v104,s36,v17
s_waitcnt lgkmcnt(7)
v_mfma_f32_16x16x32_bf16 v[108:111],a[140:143],a[108:111],v[108:111]
s_add_u32 s64,s63,21
ds_read_b64_tr_b16 a[128:129],v4 offset:0
v_fma_f32 v105,v105,s36,v17
v_mfma_f32_16x16x32_bf16 v[108:111],a[144:147],a[112:115],v[108:111]
s_cmp_eq_u32 s3,0
ds_read_b64_tr_b16 a[142:143],v3 offset:6272
v_exp_f32 v105,v105
v_mfma_f32_16x16x32_bf16 v[108:111],a[148:151],a[116:119],v[108:111]
s_cselect_b32 s64,20,s64
ds_read_b64_tr_b16 a[146:147],v4 offset:6272
v_fma_f32 v106,v106,s36,v17
s_waitcnt lgkmcnt(6)
v_mfma_f32_16x16x32_bf16 a[208:211],a[120:123],v[36:39],0
s_cselect_b32 s40,1,0
ds_read_b64_tr_b16 a[138:139],v2 offset:6272
v_exp_f32 v104,v104
v_mfma_f32_16x16x32_bf16 a[212:215],a[124:127],v[36:39],0
s_add_u32 s65,s63,37
ds_read_b64_tr_b16 a[124:125],v3 offset:256
ds_read_b64_tr_b16 a[136:137],v2 offset:128
ds_read_b64_tr_b16 a[144:145],v4 offset:128
ds_read_b64_tr_b16 a[122:123],v2 offset:6400
ds_read_b64_tr_b16 a[148:149],v5 offset:128
ds_read_b64_tr_b16 a[140:141],v3 offset:128
v_cvt_pk_bf16_f32 v40,v104,v105
ds_read_b64_tr_b16 a[150:151],v5 offset:6272
s_waitcnt lgkmcnt(10)
v_mfma_f32_16x16x32_bf16 a[216:219],a[128:131],v[36:39],0
s_cmp_eq_u32 s62,2
ds_read_b64_tr_b16 a[128:129],v4 offset:256
ds_read_b64_tr_b16 a[120:121],v2 offset:256
v_mfma_f32_16x16x32_bf16 a[220:223],a[132:135],v[36:39],0
s_cselect_b32 s64,s65,s64
ds_read_b64_tr_b16 a[134:135],v5 offset:6400
ds_read_b64_tr_b16 a[132:133],v5 offset:256
ds_read_b64_tr_b16 a[126:127],v3 offset:6400
ds_read_b64_tr_b16 a[130:131],v4 offset:6400
s_waitcnt vmcnt(6)
v_exp_f32 v106,v106
s_waitcnt lgkmcnt(11)
v_mfma_f32_16x16x32_bf16 a[224:227],a[136:139],v[36:39],0
s_cselect_b32 s40,0,s40
v_cvt_pk_bf16_f32 v41,v106,v107
v_fma_f32 v108,v108,s36,v17
v_exp_f32 v108,v108
v_fma_f32 v110,v110,s36,v17
v_exp_f32 v110,v110
s_waitcnt lgkmcnt(7)
v_mfma_f32_16x16x32_bf16 a[228:231],a[140:143],v[36:39],0
s_add_u32 s65,s63,s3
v_fma_f32 v111,v111,s36,v17
v_exp_f32 v111,v111
v_mfma_f32_16x16x32_bf16 a[232:235],a[144:147],v[36:39],0
s_cmp_eq_u32 s62,0
v_fma_f32 v109,v109,s36,v17
v_exp_f32 v109,v109
s_waitcnt lgkmcnt(4)
v_mfma_f32_16x16x32_bf16 a[236:239],a[148:151],v[36:39],0
s_cselect_b32 s64,s65,s64
v_cvt_pk_bf16_f32 v42,v108,v109
v_cvt_pk_bf16_f32 v43,v110,v111
v_mfma_f32_16x16x32_bf16 a[240:243],a[120:123],v[36:39],0
s_cselect_b32 s40,1,s40
s_mul_i32 s64,s64,6144
s_waitcnt lgkmcnt(0)
s_barrier
v_smfmac_f32_16x16x64_bf16 v[68:71],a[152:155],v[36:43],v18
s_add_u32 s41,s41,s64
s_cmp_ge_u32 s69,6
ds_read_b128 a[144:147],v0 offset:24704
v_mfma_f32_16x16x32_bf16 a[244:247],a[124:127],v[36:39],0
s_cselect_b32 s41,166723584,s41
s_cselect_b32 s30,100663296,s30
ds_read_b128 a[136:139],v0 offset:24576
v_mfma_f32_16x16x32_bf16 a[248:251],a[128:131],v[36:39],0
s_add_u32 s25,s30,s22
s_add_u32 s26,s25,12288
ds_read_b128 a[120:123],v0 offset:24832
v_mfma_f32_16x16x32_bf16 a[252:255],a[132:135],v[36:39],0
s_mov_b32 s28,s41
ds_read_b128 a[124:127],v1 offset:24832
s_mov_b32 s29,s24
ds_read_b128 a[140:143],v1 offset:24576
s_add_u32 m0,s23,0
ds_read_b128 a[148:151],v1 offset:24704
buffer_load_dwordx4 v6,s[8:11],s21 offen offset:0 lds
buffer_load_dwordx4 v7,s[8:11],s21 offen offset:1024 lds
buffer_load_dwordx4 v8,s[8:11],s21 offen offset:2048 lds
ds_read_b128 a[128:131],v0 offset:30720
s_add_u32 s21,s21,12288
ds_read_b128 a[132:135],v1 offset:30720
s_waitcnt lgkmcnt(6)
v_mfma_f32_16x16x32_bf16 v[104:107],a[136:139],a[96:99],0
s_add_u32 m0,s22,12288
ds_read_b128 a[136:139],v0 offset:30848
buffer_load_dwordx4 v6,s[4:7],s20 offen offset:0 lds
buffer_load_dwordx4 v7,s[4:7],s20 offen offset:1024 lds
buffer_load_dwordx4 v8,s[4:7],s20 offen offset:2048 lds
s_waitcnt lgkmcnt(4)
v_mfma_f32_16x16x32_bf16 v[104:107],a[140:143],a[100:103],v[104:107]
s_add_u32 s20,s20,12288
ds_read_b128 a[140:143],v1 offset:30848
v_mfma_f32_16x16x32_bf16 v[104:107],a[144:147],a[104:107],v[104:107]
s_waitcnt lgkmcnt(4)
ds_read_b128 a[144:147],v0 offset:30976
v_mfma_f32_16x16x32_bf16 v[104:107],a[148:151],a[108:111],v[104:107]
ds_read_b128 a[148:151],v1 offset:30976
v_mfma_f32_16x16x32_bf16 v[104:107],a[120:123],a[112:115],v[104:107]
ds_read_b64_tr_b16 a[120:121],v2 offset:12288
v_mfma_f32_16x16x32_bf16 v[104:107],a[124:127],a[116:119],v[104:107]
s_waitcnt lgkmcnt(4)
ds_read_b64_tr_b16 a[124:125],v3 offset:12288
v_mfma_f32_16x16x32_bf16 v[108:111],a[128:131],a[96:99],0
ds_read_b64_tr_b16 a[126:127],v3 offset:18432
v_mfma_f32_16x16x32_bf16 v[108:111],a[132:135],a[100:103],v[108:111]
ds_read_b64_tr_b16 a[122:123],v2 offset:18432
v_mfma_f32_16x16x32_bf16 v[108:111],a[136:139],a[104:107],v[108:111]
s_waitcnt lgkmcnt(6)
ds_read_b64_tr_b16 a[128:129],v4 offset:12288
v_mfma_f32_16x16x32_bf16 v[108:111],a[140:143],a[108:111],v[108:111]
s_waitcnt lgkmcnt(6)
ds_read_b64_tr_b16 a[130:131],v4 offset:18432
v_mfma_f32_16x16x32_bf16 v[108:111],a[144:147],a[112:115],v[108:111]
s_waitcnt lgkmcnt(6)
ds_read_b64_tr_b16 a[132:133],v5 offset:12288
v_mfma_f32_16x16x32_bf16 v[108:111],a[148:151],a[116:119],v[108:111]
s_waitcnt lgkmcnt(3)
ds_read_b64_tr_b16 a[134:135],v5 offset:18432
v_mfma_f32_16x16x32_bf16 v[160:163],a[120:123],v[44:47],v[160:163]
s_add_u32 m0,s23,12288
ds_read_b64_tr_b16 a[136:137],v2 offset:12416
v_fma_f32 v90,v90,s36,v15
v_mfma_f32_16x16x32_bf16 v[164:167],a[124:127],v[44:47],v[164:167]
ds_read_b64_tr_b16 a[138:139],v2 offset:18560
v_fma_f32 v91,v91,s36,v15
v_mfma_f32_16x16x32_bf16 v[212:215],a[124:127],v[48:51],v[212:215]
ds_read_b64_tr_b16 a[140:141],v3 offset:12416
v_fma_f32 v96,v96,s36,v16
v_mfma_f32_16x16x32_bf16 v[208:211],a[120:123],v[48:51],v[208:211]
ds_read_b64_tr_b16 a[142:143],v3 offset:18560
v_fma_f32 v97,v97,s36,v16
v_mfma_f32_16x16x32_bf16 v[112:115],a[120:123],v[52:55],v[112:115]
ds_read_b64_tr_b16 a[144:145],v4 offset:12416
v_fma_f32 v98,v98,s36,v16
v_mfma_f32_16x16x32_bf16 v[116:119],a[124:127],v[52:55],v[116:119]
ds_read_b64_tr_b16 a[146:147],v4 offset:18560
v_fma_f32 v99,v99,s36,v16
v_mfma_f32_16x16x32_bf16 a[164:167],a[124:127],v[56:59],a[164:167]
ds_read_b64_tr_b16 a[148:149],v5 offset:12416
v_fma_f32 v104,v104,s36,v17
v_mfma_f32_16x16x32_bf16 a[160:163],a[120:123],v[56:59],a[160:163]
ds_read_b64_tr_b16 a[150:151],v5 offset:18560
v_fma_f32 v105,v105,s36,v17
v_mfma_f32_16x16x32_bf16 a[208:211],a[120:123],v[40:43],a[208:211]
ds_read_b64_tr_b16 a[120:121],v2 offset:12544
v_fma_f32 v106,v106,s36,v17
v_mfma_f32_16x16x32_bf16 a[212:215],a[124:127],v[40:43],a[212:215]
s_waitcnt lgkmcnt(6)
ds_read_b64_tr_b16 a[122:123],v2 offset:18688
v_fma_f32 v107,v107,s36,v17
v_mfma_f32_16x16x32_bf16 a[216:219],a[128:131],v[40:43],a[216:219]
ds_read_b64_tr_b16 a[124:125],v3 offset:12544
v_fma_f32 v76,v76,s36,v13
v_mfma_f32_16x16x32_bf16 a[220:223],a[132:135],v[40:43],a[220:223]
ds_read_b64_tr_b16 a[126:127],v3 offset:18688
v_fma_f32 v77,v77,s36,v13
v_mfma_f32_16x16x32_bf16 a[172:175],a[132:135],v[56:59],a[172:175]
v_exp_f32 v90,v90
v_mfma_f32_16x16x32_bf16 a[168:171],a[128:131],v[56:59],a[168:171]
v_exp_f32 v91,v91
v_mfma_f32_16x16x32_bf16 v[120:123],a[128:131],v[52:55],v[120:123]
v_cvt_pk_bf16_f32 v29,v90,v91
v_fma_f32 v78,v78,s36,v13
v_mfma_f32_16x16x32_bf16 v[124:127],a[132:135],v[52:55],v[124:127]
v_exp_f32 v96,v96
v_mfma_f32_16x16x32_bf16 v[220:223],a[132:135],v[48:51],v[220:223]
v_exp_f32 v97,v97
v_mfma_f32_16x16x32_bf16 v[216:219],a[128:131],v[48:51],v[216:219]
v_exp_f32 v98,v98
v_mfma_f32_16x16x32_bf16 v[168:171],a[128:131],v[44:47],v[168:171]
ds_read_b64_tr_b16 a[128:129],v4 offset:12544
v_cvt_pk_bf16_f32 v32,v96,v97
v_mfma_f32_16x16x32_bf16 v[172:175],a[132:135],v[44:47],v[172:175]
ds_read_b64_tr_b16 a[130:131],v4 offset:18688
v_fma_f32 v79,v79,s36,v13
v_mfma_f32_16x16x32_bf16 v[176:179],a[136:139],v[44:47],v[176:179]
s_waitcnt lgkmcnt(2)
ds_read_b64_tr_b16 a[132:133],v5 offset:12544
v_fma_f32 v84,v84,s36,v14
v_mfma_f32_16x16x32_bf16 v[180:183],a[140:143],v[44:47],v[180:183]
ds_read_b64_tr_b16 a[134:135],v5 offset:18688
v_fma_f32 v85,v85,s36,v14
v_mfma_f32_16x16x32_bf16 v[228:231],a[140:143],v[48:51],v[228:231]
v_exp_f32 v99,v99
v_mfma_f32_16x16x32_bf16 v[224:227],a[136:139],v[48:51],v[224:227]
v_cvt_pk_bf16_f32 v33,v98,v99
v_fma_f32 v86,v86,s36,v14
v_mfma_f32_16x16x32_bf16 v[128:131],a[136:139],v[52:55],v[128:131]
v_exp_f32 v104,v104
v_mfma_f32_16x16x32_bf16 v[132:135],a[140:143],v[52:55],v[132:135]
v_exp_f32 v105,v105
v_mfma_f32_16x16x32_bf16 a[180:183],a[140:143],v[56:59],a[180:183]
v_exp_f32 v106,v106
v_mfma_f32_16x16x32_bf16 a[176:179],a[136:139],v[56:59],a[176:179]
v_exp_f32 v107,v107
v_mfma_f32_16x16x32_bf16 a[224:227],a[136:139],v[40:43],a[224:227]
v_cvt_pk_bf16_f32 v36,v104,v105
v_cvt_pk_bf16_f32 v37,v106,v107
v_mfma_f32_16x16x32_bf16 a[228:231],a[140:143],v[40:43],a[228:231]
v_exp_f32 v76,v76
v_mfma_f32_16x16x32_bf16 a[232:235],a[144:147],v[40:43],a[232:235]
v_exp_f32 v77,v77
v_mfma_f32_16x16x32_bf16 a[236:239],a[148:151],v[40:43],a[236:239]
v_exp_f32 v78,v78
v_mfma_f32_16x16x32_bf16 a[188:191],a[148:151],v[56:59],a[188:191]
v_exp_f32 v79,v79
v_mfma_f32_16x16x32_bf16 a[184:187],a[144:147],v[56:59],a[184:187]
v_cvt_pk_bf16_f32 v22,v76,v77
v_cvt_pk_bf16_f32 v23,v78,v79
v_mfma_f32_16x16x32_bf16 v[136:139],a[144:147],v[52:55],v[136:139]
v_fma_f32 v87,v87,s36,v14
v_fma_f32 v92,v92,s36,v15
v_mfma_f32_16x16x32_bf16 v[140:143],a[148:151],v[52:55],v[140:143]
v_exp_f32 v84,v84
v_mfma_f32_16x16x32_bf16 v[236:239],a[148:151],v[48:51],v[236:239]
v_exp_f32 v85,v85
v_mfma_f32_16x16x32_bf16 v[232:235],a[144:147],v[48:51],v[232:235]
v_exp_f32 v86,v86
v_mfma_f32_16x16x32_bf16 v[184:187],a[144:147],v[44:47],v[184:187]
v_exp_f32 v87,v87
v_mfma_f32_16x16x32_bf16 v[188:191],a[148:151],v[44:47],v[188:191]
v_cvt_pk_bf16_f32 v26,v84,v85
v_cvt_pk_bf16_f32 v27,v86,v87
v_mfma_f32_16x16x32_bf16 v[192:195],a[120:123],v[44:47],v[192:195]
v_fma_f32 v93,v93,s36,v15
v_fma_f32 v94,v94,s36,v15
v_smfmac_f32_16x16x64_bf16 v[60:63],a[152:155],v[20:27],v18
v_fma_f32 v95,v95,s36,v15
v_mfma_f32_16x16x32_bf16 v[196:199],a[124:127],v[44:47],v[196:199]
s_waitcnt vmcnt(6) lgkmcnt(0)
v_exp_f32 v92,v92
v_mfma_f32_16x16x32_bf16 v[244:247],a[124:127],v[48:51],v[244:247]
s_barrier
v_mfma_f32_16x16x32_bf16 v[240:243],a[120:123],v[48:51],v[240:243]
ds_read_b128 a[136:139],v0 offset:0
v_fma_f32 v100,v100,s36,v16
v_mfma_f32_16x16x32_bf16 v[144:147],a[120:123],v[52:55],v[144:147]
ds_read_b128 a[140:143],v1 offset:0
v_fma_f32 v101,v101,s36,v16
v_mfma_f32_16x16x32_bf16 v[148:151],a[124:127],v[52:55],v[148:151]
ds_read_b128 a[144:147],v0 offset:128
v_fma_f32 v102,v102,s36,v16
v_mfma_f32_16x16x32_bf16 a[196:199],a[124:127],v[56:59],a[196:199]
ds_read_b128 a[148:151],v1 offset:128
v_fma_f32 v103,v103,s36,v16
v_mfma_f32_16x16x32_bf16 a[192:195],a[120:123],v[56:59],a[192:195]
v_exp_f32 v93,v93
v_mfma_f32_16x16x32_bf16 a[240:243],a[120:123],v[40:43],a[240:243]
buffer_load_dwordx4 v6,s[8:11],s21 offen offset:0 lds
v_mfma_f32_16x16x32_bf16 a[244:247],a[124:127],v[40:43],a[244:247]
ds_read_b128 a[120:123],v0 offset:256
v_cvt_pk_bf16_f32 v30,v92,v93
v_mfma_f32_16x16x32_bf16 a[248:251],a[128:131],v[40:43],a[248:251]
ds_read_b128 a[124:127],v1 offset:256
v_fma_f32 v108,v108,s36,v17
v_mfma_f32_16x16x32_bf16 a[252:255],a[132:135],v[40:43],a[252:255]
v_exp_f32 v94,v94
v_mfma_f32_16x16x32_bf16 a[204:207],a[132:135],v[56:59],a[204:207]
v_exp_f32 v95,v95
v_mfma_f32_16x16x32_bf16 a[200:203],a[128:131],v[56:59],a[200:203]
v_cvt_pk_bf16_f32 v31,v94,v95
v_fma_f32 v109,v109,s36,v17
v_mfma_f32_16x16x32_bf16 v[152:155],a[128:131],v[52:55],v[152:155]
v_exp_f32 v100,v100
v_mfma_f32_16x16x32_bf16 v[156:159],a[132:135],v[52:55],v[156:159]
v_exp_f32 v101,v101
v_mfma_f32_16x16x32_bf16 v[252:255],a[132:135],v[48:51],v[252:255]
v_exp_f32 v102,v102
v_mfma_f32_16x16x32_bf16 v[248:251],a[128:131],v[48:51],v[248:251]
v_exp_f32 v103,v103
v_mfma_f32_16x16x32_bf16 v[200:203],a[128:131],v[44:47],v[200:203]
ds_read_b128 a[128:131],v0 offset:6144
v_cvt_pk_bf16_f32 v34,v100,v101
v_mfma_f32_16x16x32_bf16 v[204:207],a[132:135],v[44:47],v[204:207]
buffer_load_dwordx4 v7,s[8:11],s21 offen offset:1024 lds
s_waitcnt lgkmcnt(1)
v_mfma_f32_16x16x32_bf16 v[72:75],a[136:139],a[0:3],0
ds_read_b128 a[132:135],v1 offset:6144
v_cvt_pk_bf16_f32 v35,v102,v103
v_mfma_f32_16x16x32_bf16 v[72:75],a[140:143],a[4:7],v[72:75]
v_fma_f32 v110,v110,s36,v17
v_fma_f32 v111,v111,s36,v17
v_smfmac_f32_16x16x64_bf16 v[64:67],a[152:155],v[28:35],v18
v_mfma_f32_16x16x32_bf16 v[72:75],a[144:147],a[8:11],v[72:75]
v_exp_f32 v108,v108
v_mfma_f32_16x16x32_bf16 v[72:75],a[148:151],a[12:15],v[72:75]
v_exp_f32 v109,v109
v_mfma_f32_16x16x32_bf16 v[72:75],a[120:123],a[16:19],v[72:75]
v_exp_f32 v110,v110
v_mfma_f32_16x16x32_bf16 v[72:75],a[124:127],a[20:23],v[72:75]
v_exp_f32 v111,v111
v_mfma_f32_16x16x32_bf16 v[80:83],a[124:127],a[44:47],0
v_cvt_pk_bf16_f32 v38,v108,v109
v_cvt_pk_bf16_f32 v39,v110,v111
v_mfma_f32_16x16x32_bf16 v[80:83],a[120:123],a[40:43],v[80:83]
v_mfma_f32_16x16x32_bf16 v[80:83],a[148:151],a[36:39],v[80:83]
v_mfma_f32_16x16x32_bf16 v[80:83],a[144:147],a[32:35],v[80:83]
buffer_load_dwordx4 v8,s[8:11],s21 offen offset:2048 lds
v_mfma_f32_16x16x32_bf16 v[80:83],a[140:143],a[28:31],v[80:83]
s_add_u32 s21,s21,12288
v_fma_f32 v72,v72,s36,v13
v_fma_f32 v73,v73,s36,v13
v_mfma_f32_16x16x32_bf16 v[80:83],a[136:139],a[24:27],v[80:83]
s_add_u32 m0,s22,24576
v_fma_f32 v74,v74,s36,v13
v_fma_f32 v75,v75,s36,v13
v_mfma_f32_16x16x32_bf16 v[88:91],a[136:139],a[48:51],0
v_exp_f32 v72,v72
v_mfma_f32_16x16x32_bf16 v[88:91],a[140:143],a[52:55],v[88:91]
v_exp_f32 v73,v73
v_mfma_f32_16x16x32_bf16 v[88:91],a[144:147],a[56:59],v[88:91]
v_fma_f32 v80,v80,s36,v14
v_fma_f32 v81,v81,s36,v14
v_mfma_f32_16x16x32_bf16 v[88:91],a[148:151],a[60:63],v[88:91]
v_fma_f32 v82,v82,s36,v14
v_fma_f32 v83,v83,s36,v14
v_mfma_f32_16x16x32_bf16 v[88:91],a[120:123],a[64:67],v[88:91]
v_exp_f32 v74,v74
v_mfma_f32_16x16x32_bf16 v[88:91],a[124:127],a[68:71],v[88:91]
v_exp_f32 v75,v75
v_mfma_f32_16x16x32_bf16 v[96:99],a[124:127],a[92:95],0
v_exp_f32 v80,v80
v_mfma_f32_16x16x32_bf16 v[96:99],a[120:123],a[88:91],v[96:99]
v_exp_f32 v81,v81
v_mfma_f32_16x16x32_bf16 v[96:99],a[148:151],a[84:87],v[96:99]
v_exp_f32 v82,v82
v_mfma_f32_16x16x32_bf16 v[96:99],a[144:147],a[80:83],v[96:99]
buffer_load_dwordx4 v6,s[4:7],s20 offen offset:0 lds
v_mfma_f32_16x16x32_bf16 v[96:99],a[140:143],a[76:79],v[96:99]
v_fma_f32 v88,v88,s36,v15
v_fma_f32 v89,v89,s36,v15
v_mfma_f32_16x16x32_bf16 v[96:99],a[136:139],a[72:75],v[96:99]
v_exp_f32 v83,v83
v_mfma_f32_16x16x32_bf16 v[104:107],a[136:139],a[96:99],0
ds_read_b128 a[136:139],v0 offset:6272
v_cvt_pk_bf16_f32 v44,v72,v73
v_mfma_f32_16x16x32_bf16 v[104:107],a[140:143],a[100:103],v[104:107]
ds_read_b128 a[140:143],v1 offset:6272
v_cvt_pk_bf16_f32 v45,v74,v75
v_mfma_f32_16x16x32_bf16 v[104:107],a[144:147],a[104:107],v[104:107]
ds_read_b128 a[144:147],v0 offset:6400
v_cvt_pk_bf16_f32 v48,v80,v81
v_mfma_f32_16x16x32_bf16 v[104:107],a[148:151],a[108:111],v[104:107]
ds_read_b128 a[148:151],v1 offset:6400
v_cvt_pk_bf16_f32 v49,v82,v83
v_mfma_f32_16x16x32_bf16 v[104:107],a[120:123],a[112:115],v[104:107]
v_exp_f32 v88,v88
v_mfma_f32_16x16x32_bf16 v[104:107],a[124:127],a[116:119],v[104:107]
s_waitcnt lgkmcnt(4)
v_exp_f32 v89,v89
v_mfma_f32_16x16x32_bf16 v[76:79],a[128:131],a[0:3],0
v_cvt_pk_bf16_f32 v52,v88,v89
v_mfma_f32_16x16x32_bf16 v[76:79],a[132:135],a[4:7],v[76:79]
s_waitcnt lgkmcnt(3)
v_mfma_f32_16x16x32_bf16 v[76:79],a[136:139],a[8:11],v[76:79]
buffer_load_dwordx4 v7,s[4:7],s20 offen offset:1024 lds
s_waitcnt lgkmcnt(2)
v_mfma_f32_16x16x32_bf16 v[76:79],a[140:143],a[12:15],v[76:79]
s_waitcnt lgkmcnt(1)
v_mfma_f32_16x16x32_bf16 v[76:79],a[144:147],a[16:19],v[76:79]
s_waitcnt lgkmcnt(0)
v_mfma_f32_16x16x32_bf16 v[76:79],a[148:151],a[20:23],v[76:79]
v_mfma_f32_16x16x32_bf16 v[84:87],a[148:151],a[44:47],0
v_mfma_f32_16x16x32_bf16 v[84:87],a[144:147],a[40:43],v[84:87]
v_mfma_f32_16x16x32_bf16 v[84:87],a[140:143],a[36:39],v[84:87]
v_mfma_f32_16x16x32_bf16 v[84:87],a[136:139],a[32:35],v[84:87]
v_mfma_f32_16x16x32_bf16 v[84:87],a[132:135],a[28:31],v[84:87]
v_mfma_f32_16x16x32_bf16 v[84:87],a[128:131],a[24:27],v[84:87]
v_mfma_f32_16x16x32_bf16 v[92:95],a[128:131],a[48:51],0
v_mfma_f32_16x16x32_bf16 v[92:95],a[132:135],a[52:55],v[92:95]
buffer_load_dwordx4 v8,s[4:7],s20 offen offset:2048 lds
v_mfma_f32_16x16x32_bf16 v[92:95],a[136:139],a[56:59],v[92:95]
s_add_u32 s20,s20,12288
v_mfma_f32_16x16x32_bf16 v[92:95],a[140:143],a[60:63],v[92:95]
v_mfma_f32_16x16x32_bf16 v[92:95],a[144:147],a[64:67],v[92:95]
v_mfma_f32_16x16x32_bf16 v[92:95],a[148:151],a[68:71],v[92:95]
v_mfma_f32_16x16x32_bf16 v[100:103],a[148:151],a[92:95],0
v_mfma_f32_16x16x32_bf16 v[100:103],a[144:147],a[88:91],v[100:103]
ds_read_b64_tr_b16 a[120:121],v2 offset:24576
v_mfma_f32_16x16x32_bf16 v[100:103],a[140:143],a[84:87],v[100:103]
ds_read_b64_tr_b16 a[122:123],v2 offset:30720
v_mfma_f32_16x16x32_bf16 v[100:103],a[136:139],a[80:83],v[100:103]
ds_read_b64_tr_b16 a[124:125],v3 offset:24576
v_mfma_f32_16x16x32_bf16 v[100:103],a[132:135],a[76:79],v[100:103]
ds_read_b64_tr_b16 a[126:127],v3 offset:30720
v_mfma_f32_16x16x32_bf16 v[100:103],a[128:131],a[72:75],v[100:103]
v_mfma_f32_16x16x32_bf16 v[108:111],a[128:131],a[96:99],0
ds_read_b64_tr_b16 a[128:129],v4 offset:24576
v_mfma_f32_16x16x32_bf16 v[108:111],a[132:135],a[100:103],v[108:111]
ds_read_b64_tr_b16 a[130:131],v4 offset:30720
v_mfma_f32_16x16x32_bf16 v[108:111],a[136:139],a[104:107],v[108:111]
ds_read_b64_tr_b16 a[132:133],v5 offset:24576
v_mfma_f32_16x16x32_bf16 v[108:111],a[140:143],a[108:111],v[108:111]
ds_read_b64_tr_b16 a[134:135],v5 offset:30720
v_mfma_f32_16x16x32_bf16 v[108:111],a[144:147],a[112:115],v[108:111]
v_mfma_f32_16x16x32_bf16 v[108:111],a[148:151],a[116:119],v[108:111]
s_mov_b32 s38,0
s_branch L_loop5
L_start4:
s_add_u32 m0,s24,12288
s_waitcnt vmcnt(15)
ds_read_b128 a[0:3],v11 offset:0
buffer_load_dwordx4 v6,s[12:15],s28 offen offset:0 nt lds
ds_read_b128 a[4:7],v12 offset:0
buffer_load_dwordx4 v7,s[12:15],s28 offen offset:1024 nt lds
ds_read_b128 a[16:19],v11 offset:256
buffer_load_dwordx4 v8,s[12:15],s28 offen offset:2048 nt lds
s_add_u32 s28,s28,3072
s_add_u32 m0,s24,15360
ds_read_b128 a[20:23],v12 offset:256
buffer_load_dwordx4 v6,s[12:15],s28 offen offset:0 nt lds
ds_read_b128 a[8:11],v11 offset:128
buffer_load_dwordx4 v7,s[12:15],s28 offen offset:1024 nt lds
ds_read_b128 a[12:15],v12 offset:128
buffer_load_dwordx4 v8,s[12:15],s28 offen offset:2048 nt lds
s_add_u32 s28,s28,3072
s_add_u32 m0,s24,0
ds_read_b128 a[124:127],v1 offset:0
v_mov_b32 v60,0
ds_read_b128 a[120:123],v0 offset:0
v_mov_b32 v67,0
ds_read_b128 a[132:135],v1 offset:128
v_mov_b32 v65,0
ds_read_b128 a[136:139],v0 offset:256
v_mov_b32 v64,0
ds_read_b128 a[128:131],v0 offset:128
v_mov_b32 v66,0
ds_read_b128 a[140:143],v1 offset:256
v_mov_b32 v63,0
ds_read_b128 a[148:151],v1 offset:6144
v_mov_b32 v61,0
ds_read_b128 a[144:147],v0 offset:6144
v_mov_b32 v62,0
s_waitcnt lgkmcnt(6)
v_mfma_f32_16x16x32_bf16 v[72:75],a[120:123],a[0:3],0
ds_read_b128 a[120:123],v0 offset:6272
v_mfma_f32_16x16x32_bf16 v[72:75],a[124:127],a[4:7],v[72:75]
s_waitcnt lgkmcnt(4)
ds_read_b128 a[124:127],v1 offset:6272
v_mfma_f32_16x16x32_bf16 v[72:75],a[128:131],a[8:11],v[72:75]
ds_read_b128 a[128:131],v0 offset:6400
v_mfma_f32_16x16x32_bf16 v[72:75],a[132:135],a[12:15],v[72:75]
ds_read_b128 a[132:135],v1 offset:6400
v_mfma_f32_16x16x32_bf16 v[72:75],a[136:139],a[16:19],v[72:75]
s_waitcnt lgkmcnt(6)
ds_read_b128 a[136:139],v0 offset:12288
v_mfma_f32_16x16x32_bf16 v[72:75],a[140:143],a[20:23],v[72:75]
s_waitcnt lgkmcnt(5)
ds_read_b128 a[140:143],v1 offset:12288
v_mfma_f32_16x16x32_bf16 v[76:79],a[144:147],a[0:3],0
ds_read_b128 a[144:147],v0 offset:12416
v_mfma_f32_16x16x32_bf16 v[76:79],a[148:151],a[4:7],v[76:79]
s_waitcnt lgkmcnt(6)
ds_read_b128 a[148:151],v1 offset:12416
v_mfma_f32_16x16x32_bf16 v[76:79],a[120:123],a[8:11],v[76:79]
s_waitcnt lgkmcnt(6)
ds_read_b128 a[120:123],v0 offset:12544
v_mfma_f32_16x16x32_bf16 v[76:79],a[124:127],a[12:15],v[76:79]
s_waitcnt lgkmcnt(6)
ds_read_b128 a[124:127],v1 offset:12544
v_max3_f32 v44,v72,v73,v74
v_mfma_f32_16x16x32_bf16 v[76:79],a[128:131],a[16:19],v[76:79]
s_waitcnt lgkmcnt(6)
ds_read_b128 a[128:131],v0 offset:18432
v_mfma_f32_16x16x32_bf16 v[76:79],a[132:135],a[20:23],v[76:79]
ds_read_b128 a[132:135],v1 offset:18432
s_nop 6
v_max3_f32 v44,v44,v75,v76
v_max3_f32 v44,v44,v77,v78
v_max_f32 v44,v44,v79
v_mov_b32 v45,v44
s_nop 1
v_permlane32_swap_b32 v45,v44
v_max_f32 v44,v44,v45
v_mov_b32 v45,v44
s_nop 1
v_permlane16_swap_b32 v45,v44
v_max_f32 v44,v44,v45
v_mul_f32_e64 v13,-s36,v44
v_fma_f32 v74,v74,s36,v13
v_exp_f32 v74,v74
v_fma_f32 v75,v75,s36,v13
v_exp_f32 v75,v75
v_fma_f32 v73,v73,s36,v13
v_exp_f32 v73,v73
v_cvt_pk_bf16_f32 v21,v74,v75
v_fma_f32 v72,v72,s36,v13
v_exp_f32 v72,v72
v_fma_f32 v78,v78,s36,v13
v_cvt_pk_bf16_f32 v20,v72,v73
s_waitcnt lgkmcnt(0)
v_mfma_f32_16x16x32_bf16 v[72:75],a[136:139],a[0:3],0
ds_read_b128 a[136:139],v0 offset:18560
v_fma_f32 v76,v76,s36,v13
v_mfma_f32_16x16x32_bf16 v[72:75],a[140:143],a[4:7],v[72:75]
ds_read_b128 a[140:143],v1 offset:18560
v_exp_f32 v76,v76
v_mfma_f32_16x16x32_bf16 v[72:75],a[144:147],a[8:11],v[72:75]
ds_read_b128 a[144:147],v0 offset:18688
v_fma_f32 v79,v79,s36,v13
v_mfma_f32_16x16x32_bf16 v[72:75],a[148:151],a[12:15],v[72:75]
ds_read_b128 a[148:151],v1 offset:18688
v_exp_f32 v79,v79
v_mfma_f32_16x16x32_bf16 v[72:75],a[120:123],a[16:19],v[72:75]
v_fma_f32 v77,v77,s36,v13
v_exp_f32 v78,v78
v_mfma_f32_16x16x32_bf16 v[72:75],a[124:127],a[20:23],v[72:75]
v_cvt_pk_bf16_f32 v23,v78,v79
v_exp_f32 v77,v77
s_nop 0
v_cvt_pk_bf16_f32 v22,v76,v77
v_mfma_f32_16x16x32_bf16 v[76:79],a[128:131],a[0:3],0
v_mfma_f32_16x16x32_bf16 v[76:79],a[132:135],a[4:7],v[76:79]
s_waitcnt lgkmcnt(2)
v_mfma_f32_16x16x32_bf16 v[76:79],a[136:139],a[8:11],v[76:79]
v_mfma_f32_16x16x32_bf16 v[76:79],a[140:143],a[12:15],v[76:79]
s_waitcnt lgkmcnt(0)
v_fma_f32 v73,v73,s36,v13
v_exp_f32 v73,v73
v_mfma_f32_16x16x32_bf16 v[76:79],a[144:147],a[16:19],v[76:79]
v_fma_f32 v75,v75,s36,v13
v_exp_f32 v75,v75
v_mfma_f32_16x16x32_bf16 v[76:79],a[148:151],a[20:23],v[76:79]
s_waitcnt vmcnt(12)
s_barrier
ds_read_b64_tr_b16 a[122:123],v2 offset:6144
ds_read_b64_tr_b16 a[130:131],v4 offset:6144
ds_read_b64_tr_b16 a[120:121],v2 offset:0
ds_read_b64_tr_b16 a[126:127],v3 offset:6144
ds_read_b64_tr_b16 a[128:129],v4 offset:0
ds_read_b64_tr_b16 a[124:125],v3 offset:0
ds_read_b64_tr_b16 a[136:137],v2 offset:128
ds_read_b64_tr_b16 a[140:141],v3 offset:128
ds_read_b64_tr_b16 a[146:147],v4 offset:6272
ds_read_b64_tr_b16 a[132:133],v5 offset:0
ds_read_b64_tr_b16 a[148:149],v5 offset:128
ds_read_b64_tr_b16 a[138:139],v2 offset:6272
ds_read_b64_tr_b16 a[134:135],v5 offset:6144
ds_read_b64_tr_b16 a[144:145],v4 offset:128
ds_read_b64_tr_b16 a[142:143],v3 offset:6272
ds_read_b64_tr_b16 a[150:151],v5 offset:6272
v_fma_f32 v72,v72,s36,v13
v_exp_f32 v72,v72
s_waitcnt lgkmcnt(13)
v_mfma_f32_16x16x32_bf16 v[160:163],a[120:123],v[20:23],0
ds_read_b64_tr_b16 a[122:123],v2 offset:6400
v_cvt_pk_bf16_f32 v44,v72,v73
v_fma_f32 v74,v74,s36,v13
v_exp_f32 v74,v74
s_waitcnt lgkmcnt(11)
v_mfma_f32_16x16x32_bf16 v[164:167],a[124:127],v[20:23],0
ds_read_b64_tr_b16 a[124:125],v3 offset:256
v_cvt_pk_bf16_f32 v45,v74,v75
v_mfma_f32_16x16x32_bf16 v[168:171],a[128:131],v[20:23],0
ds_read_b64_tr_b16 a[130:131],v4 offset:6400
ds_read_b64_tr_b16 a[120:121],v2 offset:256
v_fma_f32 v78,v78,s36,v13
v_fma_f32 v76,v76,s36,v13
v_fma_f32 v77,v77,s36,v13
v_exp_f32 v77,v77
s_waitcnt lgkmcnt(7)
v_mfma_f32_16x16x32_bf16 v[172:175],a[132:135],v[20:23],0
ds_read_b64_tr_b16 a[132:133],v5 offset:256
v_fma_f32 v79,v79,s36,v13
v_mfma_f32_16x16x32_bf16 v[176:179],a[136:139],v[20:23],0
s_waitcnt lgkmcnt(5)
ds_read_b64_tr_b16 a[126:127],v3 offset:6400
v_exp_f32 v79,v79
v_mfma_f32_16x16x32_bf16 v[180:183],a[140:143],v[20:23],0
ds_read_b64_tr_b16 a[134:135],v5 offset:6400
v_exp_f32 v78,v78
ds_read_b64_tr_b16 a[128:129],v4 offset:256
v_mfma_f32_16x16x32_bf16 v[184:187],a[144:147],v[20:23],0
ds_read_b128 a[140:143],v1 offset:24576
v_cvt_pk_bf16_f32 v47,v78,v79
v_mfma_f32_16x16x32_bf16 v[188:191],a[148:151],v[20:23],0
s_waitcnt lgkmcnt(5)
ds_read_b128 a[148:151],v1 offset:24704
v_exp_f32 v76,v76
v_mfma_f32_16x16x32_bf16 v[192:195],a[120:123],v[20:23],0
s_waitcnt lgkmcnt(4)
ds_read_b128 a[136:139],v0 offset:24576
v_cvt_pk_bf16_f32 v46,v76,v77
ds_read_b128 a[120:123],v0 offset:24832
v_mfma_f32_16x16x32_bf16 v[196:199],a[124:127],v[20:23],0
s_waitcnt lgkmcnt(4)
ds_read_b128 a[144:147],v0 offset:24704
ds_read_b128 a[124:127],v1 offset:24832
v_mfma_f32_16x16x32_bf16 v[200:203],a[128:131],v[20:23],0
ds_read_b128 a[128:131],v0 offset:30720
v_mfma_f32_16x16x32_bf16 v[204:207],a[132:135],v[20:23],0
s_waitcnt lgkmcnt(4)
ds_read_b128 a[132:135],v1 offset:30720
v_mfma_f32_16x16x32_bf16 v[72:75],a[136:139],a[0:3],0
ds_read_b128 a[136:139],v0 offset:30848
v_mfma_f32_16x16x32_bf16 v[72:75],a[140:143],a[4:7],v[72:75]
s_waitcnt lgkmcnt(4)
ds_read_b128 a[140:143],v1 offset:30848
v_mfma_f32_16x16x32_bf16 v[72:75],a[144:147],a[8:11],v[72:75]
ds_read_b128 a[144:147],v0 offset:30976
v_mfma_f32_16x16x32_bf16 v[72:75],a[148:151],a[12:15],v[72:75]
ds_read_b128 a[148:151],v1 offset:30976
v_mfma_f32_16x16x32_bf16 v[72:75],a[120:123],a[16:19],v[72:75]
s_waitcnt lgkmcnt(6)
ds_read_b128 a[120:123],v0 offset:0
v_mfma_f32_16x16x32_bf16 v[72:75],a[124:127],a[20:23],v[72:75]
s_waitcnt lgkmcnt(6)
ds_read_b128 a[124:127],v1 offset:0
v_mfma_f32_16x16x32_bf16 v[76:79],a[128:131],a[0:3],0
s_waitcnt lgkmcnt(6)
ds_read_b128 a[128:131],v0 offset:128
v_mfma_f32_16x16x32_bf16 v[76:79],a[132:135],a[4:7],v[76:79]
s_waitcnt lgkmcnt(6)
ds_read_b128 a[132:135],v1 offset:128
v_mfma_f32_16x16x32_bf16 v[76:79],a[136:139],a[8:11],v[76:79]
s_waitcnt lgkmcnt(6)
ds_read_b128 a[136:139],v0 offset:256
v_mfma_f32_16x16x32_bf16 v[76:79],a[140:143],a[12:15],v[76:79]
s_waitcnt lgkmcnt(6)
ds_read_b128 a[140:143],v1 offset:256
v_fma_f32 v73,v73,s36,v13
v_mfma_f32_16x16x32_bf16 v[76:79],a[144:147],a[16:19],v[76:79]
s_waitcnt lgkmcnt(6)
ds_read_b128 a[144:147],v0 offset:6144
v_fma_f32 v75,v75,s36,v13
v_mfma_f32_16x16x32_bf16 v[76:79],a[148:151],a[20:23],v[76:79]
s_waitcnt vmcnt(6)
ds_read_b128 a[40:43],v11 offset:6400
buffer_load_dwordx4 v6,s[12:15],s28 offen offset:0 nt lds
ds_read_b128 a[24:27],v11 offset:6144
buffer_load_dwordx4 v7,s[12:15],s28 offen offset:1024 nt lds
ds_read_b128 a[28:31],v12 offset:6144
buffer_load_dwordx4 v8,s[12:15],s28 offen offset:2048 nt lds
s_add_u32 s28,s28,3072
s_add_u32 m0,s24,3072
ds_read_b128 a[36:39],v12 offset:6272
buffer_load_dwordx4 v6,s[12:15],s28 offen offset:0 nt lds
ds_read_b128 a[32:35],v11 offset:6272
buffer_load_dwordx4 v7,s[12:15],s28 offen offset:1024 nt lds
ds_read_b128 a[44:47],v12 offset:6400
buffer_load_dwordx4 v8,s[12:15],s28 offen offset:2048 nt lds
s_add_u32 s28,s28,3072
s_add_u32 m0,s23,12288
ds_read_b128 a[148:151],v1 offset:6144
v_exp_f32 v75,v75
v_fma_f32 v72,v72,s36,v13
v_exp_f32 v72,v72
s_waitcnt lgkmcnt(5)
v_mfma_f32_16x16x32_bf16 v[80:83],a[120:123],a[24:27],0
s_waitcnt lgkmcnt(4)
ds_read_b128 a[120:123],v0 offset:6272
v_exp_f32 v73,v73
v_mfma_f32_16x16x32_bf16 v[80:83],a[124:127],a[28:31],v[80:83]
s_waitcnt lgkmcnt(3)
ds_read_b128 a[124:127],v1 offset:6272
v_fma_f32 v74,v74,s36,v13
v_exp_f32 v74,v74
v_mfma_f32_16x16x32_bf16 v[80:83],a[128:131],a[32:35],v[80:83]
ds_read_b128 a[128:131],v0 offset:6400
v_mfma_f32_16x16x32_bf16 v[80:83],a[132:135],a[36:39],v[80:83]
ds_read_b128 a[132:135],v1 offset:6400
v_mfma_f32_16x16x32_bf16 v[80:83],a[136:139],a[40:43],v[80:83]
s_waitcnt lgkmcnt(4)
ds_read_b128 a[136:139],v0 offset:12288
v_mfma_f32_16x16x32_bf16 v[80:83],a[140:143],a[44:47],v[80:83]
ds_read_b128 a[140:143],v1 offset:12288
v_mfma_f32_16x16x32_bf16 v[84:87],a[144:147],a[24:27],0
ds_read_b128 a[144:147],v0 offset:12416
v_mfma_f32_16x16x32_bf16 v[84:87],a[148:151],a[28:31],v[84:87]
s_waitcnt lgkmcnt(6)
ds_read_b128 a[148:151],v1 offset:12416
v_mfma_f32_16x16x32_bf16 v[84:87],a[120:123],a[32:35],v[84:87]
s_waitcnt lgkmcnt(6)
ds_read_b128 a[120:123],v0 offset:12544
v_mfma_f32_16x16x32_bf16 v[84:87],a[124:127],a[36:39],v[84:87]
s_waitcnt lgkmcnt(6)
ds_read_b128 a[124:127],v1 offset:12544
v_max3_f32 v48,v80,v81,v82
v_mfma_f32_16x16x32_bf16 v[84:87],a[128:131],a[40:43],v[84:87]
s_waitcnt lgkmcnt(6)
ds_read_b128 a[128:131],v0 offset:18432
v_mfma_f32_16x16x32_bf16 v[84:87],a[132:135],a[44:47],v[84:87]
ds_read_b128 a[132:135],v1 offset:18432
s_nop 6
v_max3_f32 v48,v48,v83,v84
v_max3_f32 v48,v48,v85,v86
v_max_f32 v48,v48,v87
v_mov_b32 v49,v48
s_nop 1
v_permlane32_swap_b32 v49,v48
v_max_f32 v48,v48,v49
v_mov_b32 v49,v48
s_nop 1
v_permlane16_swap_b32 v49,v48
v_max_f32 v48,v48,v49
v_mul_f32_e64 v14,-s36,v48
v_fma_f32 v81,v81,s36,v14
v_exp_f32 v81,v81
v_fma_f32 v82,v82,s36,v14
v_fma_f32 v83,v83,s36,v14
v_exp_f32 v83,v83
v_exp_f32 v82,v82
v_fma_f32 v80,v80,s36,v14
v_exp_f32 v80,v80
v_cvt_pk_bf16_f32 v25,v82,v83
v_cvt_pk_bf16_f32 v24,v80,v81
s_waitcnt lgkmcnt(0)
v_mfma_f32_16x16x32_bf16 v[80:83],a[136:139],a[24:27],0
ds_read_b128 a[136:139],v0 offset:18560
v_fma_f32 v85,v85,s36,v14
v_mfma_f32_16x16x32_bf16 v[80:83],a[140:143],a[28:31],v[80:83]
ds_read_b128 a[140:143],v1 offset:18560
v_fma_f32 v87,v87,s36,v14
v_mfma_f32_16x16x32_bf16 v[80:83],a[144:147],a[32:35],v[80:83]
ds_read_b128 a[144:147],v0 offset:18688
v_exp_f32 v87,v87
v_mfma_f32_16x16x32_bf16 v[80:83],a[148:151],a[36:39],v[80:83]
ds_read_b128 a[148:151],v1 offset:18688
v_fma_f32 v86,v86,s36,v14
v_mfma_f32_16x16x32_bf16 v[80:83],a[120:123],a[40:43],v[80:83]
ds_read_b64_tr_b16 a[120:121],v2 offset:0
v_fma_f32 v84,v84,s36,v14
v_mfma_f32_16x16x32_bf16 v[80:83],a[124:127],a[44:47],v[80:83]
ds_read_b64_tr_b16 a[124:125],v3 offset:0
ds_read_b64_tr_b16 a[126:127],v3 offset:6144
ds_read_b64_tr_b16 a[122:123],v2 offset:6144
v_exp_f32 v84,v84
v_exp_f32 v85,v85
v_exp_f32 v86,v86
v_cvt_pk_bf16_f32 v26,v84,v85
v_cvt_pk_bf16_f32 v27,v86,v87
v_mfma_f32_16x16x32_bf16 v[84:87],a[128:131],a[24:27],0
ds_read_b64_tr_b16 a[130:131],v4 offset:6144
v_fma_f32 v81,v81,s36,v14
v_smfmac_f32_16x16x64_bf16 v[60:63],a[152:155],v[20:27],v18
ds_read_b64_tr_b16 a[128:129],v4 offset:0
v_mfma_f32_16x16x32_bf16 v[84:87],a[132:135],a[28:31],v[84:87]
s_waitcnt lgkmcnt(6)
ds_read_b64_tr_b16 a[132:133],v5 offset:0
v_fma_f32 v80,v80,s36,v14
v_mfma_f32_16x16x32_bf16 v[84:87],a[136:139],a[32:35],v[84:87]
ds_read_b64_tr_b16 a[134:135],v5 offset:6144
v_exp_f32 v80,v80
v_mfma_f32_16x16x32_bf16 v[84:87],a[140:143],a[36:39],v[84:87]
ds_read_b64_tr_b16 a[140:141],v3 offset:128
v_exp_f32 v81,v81
v_mfma_f32_16x16x32_bf16 v[84:87],a[144:147],a[40:43],v[84:87]
ds_read_b64_tr_b16 a[146:147],v4 offset:6272
v_fma_f32 v82,v82,s36,v14
v_mfma_f32_16x16x32_bf16 v[84:87],a[148:151],a[44:47],v[84:87]
s_waitcnt lgkmcnt(5)
ds_read_b64_tr_b16 a[148:149],v5 offset:128
v_exp_f32 v82,v82
v_mfma_f32_16x16x32_bf16 v[208:211],a[120:123],v[24:27],0
ds_read_b64_tr_b16 a[122:123],v2 offset:6400
v_cvt_pk_bf16_f32 v48,v80,v81
ds_read_b64_tr_b16 a[136:137],v2 offset:128
ds_read_b64_tr_b16 a[138:139],v2 offset:6272
ds_read_b64_tr_b16 a[142:143],v3 offset:6272
v_mfma_f32_16x16x32_bf16 v[212:215],a[124:127],v[24:27],0
s_waitcnt lgkmcnt(7)
ds_read_b64_tr_b16 a[150:151],v5 offset:6272
ds_read_b64_tr_b16 a[144:145],v4 offset:128
v_mfma_f32_16x16x32_bf16 v[216:219],a[128:131],v[24:27],0
ds_read_b64_tr_b16 a[128:129],v4 offset:256
v_fma_f32 v83,v83,s36,v14
v_mfma_f32_16x16x32_bf16 v[220:223],a[132:135],v[24:27],0
ds_read_b64_tr_b16 a[132:133],v5 offset:256
ds_read_b64_tr_b16 a[134:135],v5 offset:6400
ds_read_b64_tr_b16 a[120:121],v2 offset:256
ds_read_b64_tr_b16 a[126:127],v3 offset:6400
ds_read_b64_tr_b16 a[124:125],v3 offset:256
ds_read_b64_tr_b16 a[130:131],v4 offset:6400
v_exp_f32 v83,v83
v_fma_f32 v87,v87,s36,v14
v_cvt_pk_bf16_f32 v49,v82,v83
v_fma_f32 v85,v85,s36,v14
s_waitcnt lgkmcnt(10)
v_mfma_f32_16x16x32_bf16 v[224:227],a[136:139],v[24:27],0
s_waitcnt lgkmcnt(9)
ds_read_b128 a[136:139],v0 offset:24576
v_exp_f32 v85,v85
v_mfma_f32_16x16x32_bf16 v[228:231],a[140:143],v[24:27],0
s_waitcnt lgkmcnt(8)
ds_read_b128 a[140:143],v1 offset:24576
v_exp_f32 v87,v87
v_mfma_f32_16x16x32_bf16 v[232:235],a[144:147],v[24:27],0
ds_read_b128 a[144:147],v0 offset:24704
v_fma_f32 v86,v86,s36,v14
v_mfma_f32_16x16x32_bf16 v[236:239],a[148:151],v[24:27],0
s_waitcnt lgkmcnt(5)
ds_read_b128 a[148:151],v1 offset:24704
v_exp_f32 v86,v86
v_mfma_f32_16x16x32_bf16 v[240:243],a[120:123],v[24:27],0
s_waitcnt lgkmcnt(4)
ds_read_b128 a[120:123],v0 offset:24832
v_cvt_pk_bf16_f32 v51,v86,v87
v_mfma_f32_16x16x32_bf16 v[244:247],a[124:127],v[24:27],0
ds_read_b128 a[124:127],v1 offset:24832
v_fma_f32 v84,v84,s36,v14
v_mfma_f32_16x16x32_bf16 v[248:251],a[128:131],v[24:27],0
ds_read_b128 a[128:131],v0 offset:30720
v_exp_f32 v84,v84
v_mfma_f32_16x16x32_bf16 v[252:255],a[132:135],v[24:27],0
s_waitcnt lgkmcnt(5)
ds_read_b128 a[132:135],v1 offset:30720
v_cvt_pk_bf16_f32 v50,v84,v85
v_mfma_f32_16x16x32_bf16 v[80:83],a[136:139],a[24:27],0
ds_read_b128 a[136:139],v0 offset:30848
v_cvt_pk_bf16_f32 v21,v74,v75
v_smfmac_f32_16x16x64_bf16 v[60:63],a[152:155],v[44:51],v18
v_cvt_pk_bf16_f32 v20,v72,v73
v_mfma_f32_16x16x32_bf16 v[80:83],a[140:143],a[28:31],v[80:83]
s_waitcnt lgkmcnt(5)
ds_read_b128 a[140:143],v1 offset:30848
v_mfma_f32_16x16x32_bf16 v[80:83],a[144:147],a[32:35],v[80:83]
ds_read_b128 a[144:147],v0 offset:30976
v_mfma_f32_16x16x32_bf16 v[80:83],a[148:151],a[36:39],v[80:83]
s_waitcnt lgkmcnt(5)
ds_read_b128 a[148:151],v1 offset:30976
v_mfma_f32_16x16x32_bf16 v[80:83],a[120:123],a[40:43],v[80:83]
ds_read_b128 a[120:123],v0 offset:0
v_mfma_f32_16x16x32_bf16 v[80:83],a[124:127],a[44:47],v[80:83]
s_waitcnt lgkmcnt(5)
ds_read_b128 a[124:127],v1 offset:0
v_mfma_f32_16x16x32_bf16 v[84:87],a[128:131],a[24:27],0
ds_read_b128 a[128:131],v0 offset:128
v_mfma_f32_16x16x32_bf16 v[84:87],a[132:135],a[28:31],v[84:87]
s_waitcnt lgkmcnt(6)
ds_read_b128 a[132:135],v1 offset:128
v_mfma_f32_16x16x32_bf16 v[84:87],a[136:139],a[32:35],v[84:87]
s_waitcnt lgkmcnt(6)
ds_read_b128 a[136:139],v0 offset:256
v_mfma_f32_16x16x32_bf16 v[84:87],a[140:143],a[36:39],v[84:87]
s_waitcnt lgkmcnt(6)
ds_read_b128 a[140:143],v1 offset:256
v_fma_f32 v80,v80,s36,v14
v_mfma_f32_16x16x32_bf16 v[84:87],a[144:147],a[40:43],v[84:87]
s_waitcnt lgkmcnt(6)
ds_read_b128 a[144:147],v0 offset:6144
v_exp_f32 v80,v80
v_mfma_f32_16x16x32_bf16 v[84:87],a[148:151],a[44:47],v[84:87]
s_waitcnt vmcnt(6)
ds_read_b128 a[52:55],v12 offset:12288
buffer_load_dwordx4 v6,s[8:11],s21 offen offset:0 lds
ds_read_b128 a[64:67],v11 offset:12544
buffer_load_dwordx4 v7,s[8:11],s21 offen offset:1024 lds
ds_read_b128 a[60:63],v12 offset:12416
buffer_load_dwordx4 v8,s[8:11],s21 offen offset:2048 lds
s_add_u32 s21,s21,12288
s_add_u32 m0,s23,24576
ds_read_b128 a[48:51],v11 offset:12288
v_fma_f32 v81,v81,s36,v14
ds_read_b128 a[56:59],v11 offset:12416
v_exp_f32 v81,v81
ds_read_b128 a[68:71],v12 offset:12544
v_cvt_pk_bf16_f32 v24,v80,v81
ds_read_b128 a[148:151],v1 offset:6144
s_waitcnt lgkmcnt(3)
v_mfma_f32_16x16x32_bf16 v[88:91],a[120:123],a[48:51],0
ds_read_b128 a[120:123],v0 offset:6272
v_mfma_f32_16x16x32_bf16 v[88:91],a[124:127],a[52:55],v[88:91]
s_waitcnt lgkmcnt(3)
ds_read_b128 a[124:127],v1 offset:6272
v_mfma_f32_16x16x32_bf16 v[88:91],a[128:131],a[56:59],v[88:91]
ds_read_b128 a[128:131],v0 offset:6400
v_mfma_f32_16x16x32_bf16 v[88:91],a[132:135],a[60:63],v[88:91]
ds_read_b128 a[132:135],v1 offset:6400
v_mfma_f32_16x16x32_bf16 v[88:91],a[136:139],a[64:67],v[88:91]
s_waitcnt lgkmcnt(5)
ds_read_b128 a[136:139],v0 offset:12288
v_mfma_f32_16x16x32_bf16 v[88:91],a[140:143],a[68:71],v[88:91]
ds_read_b128 a[140:143],v1 offset:12288
v_mfma_f32_16x16x32_bf16 v[92:95],a[144:147],a[48:51],0
s_waitcnt lgkmcnt(6)
ds_read_b128 a[144:147],v0 offset:12416
v_mfma_f32_16x16x32_bf16 v[92:95],a[148:151],a[52:55],v[92:95]
s_waitcnt lgkmcnt(6)
ds_read_b128 a[148:151],v1 offset:12416
v_mfma_f32_16x16x32_bf16 v[92:95],a[120:123],a[56:59],v[92:95]
s_waitcnt lgkmcnt(6)
ds_read_b128 a[120:123],v0 offset:12544
v_mfma_f32_16x16x32_bf16 v[92:95],a[124:127],a[60:63],v[92:95]
s_waitcnt lgkmcnt(6)
ds_read_b128 a[124:127],v1 offset:12544
v_max3_f32 v52,v88,v89,v90
v_mfma_f32_16x16x32_bf16 v[92:95],a[128:131],a[64:67],v[92:95]
s_waitcnt lgkmcnt(6)
ds_read_b128 a[128:131],v0 offset:18432
v_mfma_f32_16x16x32_bf16 v[92:95],a[132:135],a[68:71],v[92:95]
ds_read_b128 a[132:135],v1 offset:18432
s_nop 6
v_max3_f32 v52,v52,v91,v92
v_max3_f32 v52,v52,v93,v94
v_max_f32 v52,v52,v95
v_mov_b32 v53,v52
s_nop 1
v_permlane32_swap_b32 v53,v52
v_max_f32 v52,v52,v53
v_mov_b32 v53,v52
s_nop 1
v_permlane16_swap_b32 v53,v52
v_max_f32 v52,v52,v53
v_mul_f32_e64 v15,-s36,v52
v_fma_f32 v89,v89,s36,v15
v_exp_f32 v89,v89
v_fma_f32 v91,v91,s36,v15
v_fma_f32 v88,v88,s36,v15
v_exp_f32 v88,v88
v_exp_f32 v91,v91
v_cvt_pk_bf16_f32 v28,v88,v89
v_fma_f32 v90,v90,s36,v15
v_exp_f32 v90,v90
v_fma_f32 v94,v94,s36,v15
v_cvt_pk_bf16_f32 v29,v90,v91
s_waitcnt lgkmcnt(0)
v_mfma_f32_16x16x32_bf16 v[88:91],a[136:139],a[48:51],0
ds_read_b128 a[136:139],v0 offset:18560
v_exp_f32 v94,v94
v_mfma_f32_16x16x32_bf16 v[88:91],a[140:143],a[52:55],v[88:91]
ds_read_b128 a[140:143],v1 offset:18560
v_fma_f32 v92,v92,s36,v15
v_mfma_f32_16x16x32_bf16 v[88:91],a[144:147],a[56:59],v[88:91]
ds_read_b128 a[144:147],v0 offset:18688
v_fma_f32 v93,v93,s36,v15
v_mfma_f32_16x16x32_bf16 v[88:91],a[148:151],a[60:63],v[88:91]
ds_read_b128 a[148:151],v1 offset:18688
v_fma_f32 v95,v95,s36,v15
v_mfma_f32_16x16x32_bf16 v[88:91],a[120:123],a[64:67],v[88:91]
ds_read_b64_tr_b16 a[122:123],v2 offset:6144
v_exp_f32 v93,v93
v_mfma_f32_16x16x32_bf16 v[88:91],a[124:127],a[68:71],v[88:91]
ds_read_b64_tr_b16 a[124:125],v3 offset:0
ds_read_b64_tr_b16 a[120:121],v2 offset:0
ds_read_b64_tr_b16 a[126:127],v3 offset:6144
v_exp_f32 v95,v95
v_exp_f32 v92,v92
v_cvt_pk_bf16_f32 v31,v94,v95
v_cvt_pk_bf16_f32 v30,v92,v93
v_mfma_f32_16x16x32_bf16 v[92:95],a[128:131],a[48:51],0
ds_read_b64_tr_b16 a[130:131],v4 offset:6144
v_fma_f32 v89,v89,s36,v15
v_mfma_f32_16x16x32_bf16 v[92:95],a[132:135],a[52:55],v[92:95]
s_waitcnt lgkmcnt(6)
ds_read_b64_tr_b16 a[134:135],v5 offset:6144
v_fma_f32 v90,v90,s36,v15
v_mfma_f32_16x16x32_bf16 v[92:95],a[136:139],a[56:59],v[92:95]
ds_read_b64_tr_b16 a[128:129],v4 offset:0
v_exp_f32 v90,v90
v_mfma_f32_16x16x32_bf16 v[92:95],a[140:143],a[60:63],v[92:95]
ds_read_b64_tr_b16 a[136:137],v2 offset:128
v_fma_f32 v91,v91,s36,v15
v_mfma_f32_16x16x32_bf16 v[92:95],a[144:147],a[64:67],v[92:95]
s_waitcnt lgkmcnt(4)
ds_read_b64_tr_b16 a[132:133],v5 offset:0
v_exp_f32 v91,v91
v_mfma_f32_16x16x32_bf16 v[92:95],a[148:151],a[68:71],v[92:95]
ds_read_b64_tr_b16 a[142:143],v3 offset:6272
v_cvt_pk_bf16_f32 v53,v90,v91
v_mfma_f32_16x16x32_bf16 v[112:115],a[120:123],v[28:31],0
ds_read_b64_tr_b16 a[140:141],v3 offset:128
v_exp_f32 v89,v89
ds_read_b64_tr_b16 a[138:139],v2 offset:6272
v_mfma_f32_16x16x32_bf16 v[116:119],a[124:127],v[28:31],0
ds_read_b64_tr_b16 a[148:149],v5 offset:128
v_fma_f32 v88,v88,s36,v15
v_exp_f32 v88,v88
ds_read_b64_tr_b16 a[146:147],v4 offset:6272
ds_read_b64_tr_b16 a[144:145],v4 offset:128
ds_read_b64_tr_b16 a[150:151],v5 offset:6272
s_waitcnt lgkmcnt(8)
v_mfma_f32_16x16x32_bf16 v[120:123],a[128:131],v[28:31],0
s_waitcnt lgkmcnt(7)
ds_read_b64_tr_b16 a[122:123],v2 offset:6400
ds_read_b64_tr_b16 a[120:121],v2 offset:256
v_mfma_f32_16x16x32_bf16 v[124:127],a[132:135],v[28:31],0
ds_read_b64_tr_b16 a[124:125],v3 offset:256
ds_read_b64_tr_b16 a[126:127],v3 offset:6400
ds_read_b64_tr_b16 a[130:131],v4 offset:6400
v_cvt_pk_bf16_f32 v52,v88,v89
v_fma_f32 v92,v92,s36,v15
v_fma_f32 v95,v95,s36,v15
v_fma_f32 v93,v93,s36,v15
s_waitcnt lgkmcnt(9)
v_mfma_f32_16x16x32_bf16 v[128:131],a[136:139],v[28:31],0
ds_read_b128 a[136:139],v0 offset:24576
v_fma_f32 v94,v94,s36,v15
v_mfma_f32_16x16x32_bf16 v[132:135],a[140:143],v[28:31],0
ds_read_b128 a[140:143],v1 offset:24576
v_exp_f32 v94,v94
ds_read_b64_tr_b16 a[128:129],v4 offset:256
ds_read_b64_tr_b16 a[134:135],v5 offset:6400
ds_read_b64_tr_b16 a[132:133],v5 offset:256
s_waitcnt lgkmcnt(10)
v_mfma_f32_16x16x32_bf16 v[136:139],a[144:147],v[28:31],0
ds_read_b128 a[144:147],v0 offset:24704
v_exp_f32 v95,v95
v_mfma_f32_16x16x32_bf16 v[140:143],a[148:151],v[28:31],0
s_waitcnt lgkmcnt(6)
ds_read_b128 a[148:151],v1 offset:24704
v_exp_f32 v92,v92
v_mfma_f32_16x16x32_bf16 v[144:147],a[120:123],v[28:31],0
ds_read_b128 a[120:123],v0 offset:24832
v_cvt_pk_bf16_f32 v55,v94,v95
v_mfma_f32_16x16x32_bf16 v[148:151],a[124:127],v[28:31],0
s_waitcnt lgkmcnt(5)
ds_read_b128 a[124:127],v1 offset:24832
v_exp_f32 v93,v93
v_mfma_f32_16x16x32_bf16 v[152:155],a[128:131],v[28:31],0
s_waitcnt lgkmcnt(4)
ds_read_b128 a[128:131],v0 offset:30720
v_cvt_pk_bf16_f32 v54,v92,v93
v_mfma_f32_16x16x32_bf16 v[156:159],a[132:135],v[28:31],0
ds_read_b128 a[132:135],v1 offset:30720
v_mfma_f32_16x16x32_bf16 v[88:91],a[136:139],a[48:51],0
ds_read_b128 a[136:139],v0 offset:30848
v_mfma_f32_16x16x32_bf16 v[88:91],a[140:143],a[52:55],v[88:91]
s_waitcnt lgkmcnt(5)
ds_read_b128 a[140:143],v1 offset:30848
v_mfma_f32_16x16x32_bf16 v[88:91],a[144:147],a[56:59],v[88:91]
ds_read_b128 a[144:147],v0 offset:30976
v_mfma_f32_16x16x32_bf16 v[88:91],a[148:151],a[60:63],v[88:91]
s_waitcnt lgkmcnt(6)
ds_read_b128 a[148:151],v1 offset:30976
v_mfma_f32_16x16x32_bf16 v[88:91],a[120:123],a[64:67],v[88:91]
s_waitcnt lgkmcnt(6)
ds_read_b128 a[120:123],v0 offset:0
v_mfma_f32_16x16x32_bf16 v[88:91],a[124:127],a[68:71],v[88:91]
s_waitcnt lgkmcnt(6)
ds_read_b128 a[124:127],v1 offset:0
v_mfma_f32_16x16x32_bf16 v[92:95],a[128:131],a[48:51],0
s_waitcnt lgkmcnt(6)
ds_read_b128 a[128:131],v0 offset:128
v_mfma_f32_16x16x32_bf16 v[92:95],a[132:135],a[52:55],v[92:95]
s_waitcnt lgkmcnt(6)
ds_read_b128 a[132:135],v1 offset:128
v_mfma_f32_16x16x32_bf16 v[92:95],a[136:139],a[56:59],v[92:95]
s_waitcnt lgkmcnt(6)
ds_read_b128 a[136:139],v0 offset:256
v_mfma_f32_16x16x32_bf16 v[92:95],a[140:143],a[60:63],v[92:95]
s_waitcnt lgkmcnt(6)
ds_read_b128 a[140:143],v1 offset:256
v_mfma_f32_16x16x32_bf16 v[92:95],a[144:147],a[64:67],v[92:95]
s_waitcnt lgkmcnt(6)
ds_read_b128 a[144:147],v0 offset:6144
v_mfma_f32_16x16x32_bf16 v[92:95],a[148:151],a[68:71],v[92:95]
s_waitcnt vmcnt(3)
ds_read_b128 a[72:75],v11 offset:0
buffer_load_dwordx4 v6,s[8:11],s21 offen offset:0 lds
ds_read_b128 a[76:79],v12 offset:0
buffer_load_dwordx4 v7,s[8:11],s21 offen offset:1024 lds
ds_read_b128 a[92:95],v12 offset:256
buffer_load_dwordx4 v8,s[8:11],s21 offen offset:2048 lds
s_add_u32 s21,s21,12288
ds_read_b128 a[80:83],v11 offset:128
s_add_u32 m0,s22,0
ds_read_b128 a[88:91],v11 offset:256
ds_read_b128 a[84:87],v12 offset:128
ds_read_b128 a[148:151],v1 offset:6144
s_waitcnt lgkmcnt(6)
v_mfma_f32_16x16x32_bf16 v[96:99],a[120:123],a[72:75],0
s_waitcnt lgkmcnt(5)
ds_read_b128 a[120:123],v0 offset:6272
v_mfma_f32_16x16x32_bf16 v[96:99],a[124:127],a[76:79],v[96:99]
s_waitcnt lgkmcnt(4)
ds_read_b128 a[124:127],v1 offset:6272
v_mfma_f32_16x16x32_bf16 v[96:99],a[128:131],a[80:83],v[96:99]
s_waitcnt lgkmcnt(3)
ds_read_b128 a[128:131],v0 offset:6400
v_mfma_f32_16x16x32_bf16 v[96:99],a[132:135],a[84:87],v[96:99]
ds_read_b128 a[132:135],v1 offset:6400
s_waitcnt vmcnt(3)
v_mfma_f32_16x16x32_bf16 v[96:99],a[136:139],a[88:91],v[96:99]
v_mfma_f32_16x16x32_bf16 v[96:99],a[140:143],a[92:95],v[96:99]
v_mfma_f32_16x16x32_bf16 v[100:103],a[144:147],a[72:75],0
s_waitcnt lgkmcnt(4)
v_mfma_f32_16x16x32_bf16 v[100:103],a[148:151],a[76:79],v[100:103]
s_waitcnt lgkmcnt(3)
v_mfma_f32_16x16x32_bf16 v[100:103],a[120:123],a[80:83],v[100:103]
s_waitcnt lgkmcnt(2)
v_mfma_f32_16x16x32_bf16 v[100:103],a[124:127],a[84:87],v[100:103]
s_waitcnt lgkmcnt(1)
v_mfma_f32_16x16x32_bf16 v[100:103],a[128:131],a[88:91],v[100:103]
s_waitcnt lgkmcnt(0)
v_mfma_f32_16x16x32_bf16 v[100:103],a[132:135],a[92:95],v[100:103]
s_barrier
buffer_load_dwordx4 v6,s[4:7],s20 offen offset:0 lds
buffer_load_dwordx4 v7,s[4:7],s20 offen offset:1024 lds
buffer_load_dwordx4 v8,s[4:7],s20 offen offset:2048 lds
ds_read_b128 a[136:139],v0 offset:12288
v_max3_f32 v56,v96,v97,v98
ds_read_b128 a[144:147],v0 offset:12416
s_add_u32 s20,s20,12288
ds_read_b128 a[120:123],v0 offset:12544
v_max3_f32 v56,v56,v99,v100
ds_read_b128 a[124:127],v1 offset:12544
v_max3_f32 v56,v56,v101,v102
ds_read_b128 a[140:143],v1 offset:12288
v_max_f32 v56,v56,v103
ds_read_b128 a[148:151],v1 offset:12416
v_mov_b32 v57,v56
ds_read_b128 a[132:135],v1 offset:18432
s_mov_b32 s27,166723584
ds_read_b128 a[128:131],v0 offset:18432
v_permlane32_swap_b32 v57,v56
v_max_f32 v56,v56,v57
v_mov_b32 v57,v56
s_mov_b32 s42,s41
s_add_u32 s69,s69,1
v_permlane16_swap_b32 v57,v56
v_max_f32 v56,v56,v57
v_mul_f32_e64 v16,-s36,v56
v_fma_f32 v99,v99,s36,v16
v_fma_f32 v96,v96,s36,v16
v_exp_f32 v99,v99
v_fma_f32 v98,v98,s36,v16
v_exp_f32 v98,v98
v_fma_f32 v97,v97,s36,v16
v_exp_f32 v97,v97
v_fma_f32 v100,v100,s36,v16
v_cvt_pk_bf16_f32 v33,v98,v99
v_exp_f32 v96,v96
v_fma_f32 v102,v102,s36,v16
v_cvt_pk_bf16_f32 v32,v96,v97
s_waitcnt lgkmcnt(2)
v_mfma_f32_16x16x32_bf16 v[96:99],a[136:139],a[72:75],0
s_lshl_b32 s62,s69,5
ds_read_b128 a[136:139],v0 offset:18560
v_exp_f32 v102,v102
v_mfma_f32_16x16x32_bf16 v[96:99],a[140:143],a[76:79],v[96:99]
s_add_u32 s62,s62,s34
ds_read_b128 a[140:143],v1 offset:18560
v_fma_f32 v103,v103,s36,v16
v_mfma_f32_16x16x32_bf16 v[96:99],a[144:147],a[80:83],v[96:99]
s_mul_i32 s63,s62,171
ds_read_b128 a[144:147],v0 offset:18688
v_exp_f32 v103,v103
v_mfma_f32_16x16x32_bf16 v[96:99],a[148:151],a[84:87],v[96:99]
s_lshr_b32 s63,s63,9
ds_read_b128 a[148:151],v1 offset:18688
v_fma_f32 v101,v101,s36,v16
v_mfma_f32_16x16x32_bf16 v[96:99],a[120:123],a[88:91],v[96:99]
s_mul_i32 s64,s63,3
ds_read_b64_tr_b16 a[120:121],v2 offset:0
v_cvt_pk_bf16_f32 v35,v102,v103
v_mfma_f32_16x16x32_bf16 v[96:99],a[124:127],a[92:95],v[96:99]
s_sub_u32 s62,s62,s64
ds_read_b64_tr_b16 a[124:125],v3 offset:0
ds_read_b64_tr_b16 a[126:127],v3 offset:6144
ds_read_b64_tr_b16 a[122:123],v2 offset:6144
v_exp_f32 v100,v100
v_exp_f32 v101,v101
s_add_u32 s63,s63,s33
v_cvt_pk_bf16_f32 v34,v100,v101
s_waitcnt lgkmcnt(7)
v_mfma_f32_16x16x32_bf16 v[100:103],a[128:131],a[72:75],0
s_mul_i32 s30,s63,196608
ds_read_b64_tr_b16 a[128:129],v4 offset:0
v_fma_f32 v97,v97,s36,v16
v_smfmac_f32_16x16x64_bf16 v[64:67],a[152:155],v[28:35],v18
s_mul_i32 s41,s63,325632
s_lshl_b32 s63,s3,2
ds_read_b64_tr_b16 a[130:131],v4 offset:6144
v_mfma_f32_16x16x32_bf16 v[100:103],a[132:135],a[76:79],v[100:103]
s_add_u32 s64,s63,21
ds_read_b64_tr_b16 a[132:133],v5 offset:0
v_fma_f32 v96,v96,s36,v16
v_mfma_f32_16x16x32_bf16 v[100:103],a[136:139],a[80:83],v[100:103]
s_cmp_eq_u32 s3,0
ds_read_b64_tr_b16 a[134:135],v5 offset:6144
v_fma_f32 v99,v99,s36,v16
s_waitcnt lgkmcnt(7)
v_mfma_f32_16x16x32_bf16 v[100:103],a[140:143],a[84:87],v[100:103]
s_cselect_b32 s64,20,s64
ds_read_b64_tr_b16 a[140:141],v3 offset:128
v_exp_f32 v97,v97
v_mfma_f32_16x16x32_bf16 v[100:103],a[144:147],a[88:91],v[100:103]
s_cselect_b32 s40,1,0
ds_read_b64_tr_b16 a[136:137],v2 offset:128
v_fma_f32 v98,v98,s36,v16
v_mfma_f32_16x16x32_bf16 v[100:103],a[148:151],a[92:95],v[100:103]
s_add_u32 s65,s63,37
ds_read_b64_tr_b16 a[148:149],v5 offset:128
v_exp_f32 v98,v98
s_waitcnt lgkmcnt(7)
v_mfma_f32_16x16x32_bf16 a[160:163],a[120:123],v[32:35],0
s_cmp_eq_u32 s62,2
ds_read_b64_tr_b16 a[122:123],v2 offset:6400
v_exp_f32 v99,v99
ds_read_b64_tr_b16 a[138:139],v2 offset:6272
v_mfma_f32_16x16x32_bf16 a[164:167],a[124:127],v[32:35],0
s_cselect_b32 s64,s65,s64
ds_read_b64_tr_b16 a[120:121],v2 offset:256
ds_read_b64_tr_b16 a[142:143],v3 offset:6272
s_waitcnt lgkmcnt(7)
v_mfma_f32_16x16x32_bf16 a[168:171],a[128:131],v[32:35],0
s_cselect_b32 s40,0,s40
ds_read_b64_tr_b16 a[126:127],v3 offset:6400
ds_read_b64_tr_b16 a[146:147],v4 offset:6272
ds_read_b64_tr_b16 a[144:145],v4 offset:128
ds_read_b64_tr_b16 a[150:151],v5 offset:6272
v_mfma_f32_16x16x32_bf16 a[172:175],a[132:135],v[32:35],0
s_add_u32 s65,s63,s3
ds_read_b64_tr_b16 a[128:129],v4 offset:256
ds_read_b64_tr_b16 a[130:131],v4 offset:6400
ds_read_b64_tr_b16 a[134:135],v5 offset:6400
ds_read_b64_tr_b16 a[124:125],v3 offset:256
ds_read_b64_tr_b16 a[132:133],v5 offset:256
s_waitcnt vmcnt(6)
v_cvt_pk_bf16_f32 v57,v98,v99
v_exp_f32 v96,v96
s_waitcnt lgkmcnt(11)
v_mfma_f32_16x16x32_bf16 a[176:179],a[136:139],v[32:35],0
s_cmp_eq_u32 s62,0
v_cvt_pk_bf16_f32 v56,v96,v97
v_fma_f32 v102,v102,s36,v16
v_exp_f32 v102,v102
s_waitcnt lgkmcnt(9)
v_mfma_f32_16x16x32_bf16 a[180:183],a[140:143],v[32:35],0
s_cselect_b32 s64,s65,s64
v_fma_f32 v100,v100,s36,v16
v_fma_f32 v101,v101,s36,v16
v_fma_f32 v103,v103,s36,v16
v_exp_f32 v103,v103
s_waitcnt lgkmcnt(6)
v_mfma_f32_16x16x32_bf16 a[184:187],a[144:147],v[32:35],0
s_cselect_b32 s40,1,s40
v_cvt_pk_bf16_f32 v59,v102,v103
v_exp_f32 v100,v100
s_waitcnt lgkmcnt(4)
v_mfma_f32_16x16x32_bf16 a[188:191],a[148:151],v[32:35],0
s_mul_i32 s64,s64,6144
v_exp_f32 v101,v101
v_mfma_f32_16x16x32_bf16 a[192:195],a[120:123],v[32:35],0
s_add_u32 s41,s41,s64
v_cvt_pk_bf16_f32 v58,v100,v101
s_waitcnt lgkmcnt(0)
s_barrier
v_mfma_f32_16x16x32_bf16 a[196:199],a[124:127],v[32:35],0
s_cmp_ge_u32 s69,6
ds_read_b128 a[136:139],v0 offset:24576
s_cselect_b32 s41,166723584,s41
v_smfmac_f32_16x16x64_bf16 v[64:67],a[152:155],v[52:59],v18
s_cselect_b32 s30,100663296,s30
s_add_u32 s25,s30,s22
ds_read_b128 a[120:123],v0 offset:24832
v_mfma_f32_16x16x32_bf16 a[200:203],a[128:131],v[32:35],0
s_add_u32 s26,s25,12288
s_mov_b32 s28,s41
ds_read_b128 a[140:143],v1 offset:24576
v_mfma_f32_16x16x32_bf16 a[204:207],a[132:135],v[32:35],0
s_mov_b32 s29,s24
ds_read_b128 a[148:151],v1 offset:24704
s_add_u32 m0,s23,0
ds_read_b128 a[124:127],v1 offset:24832
buffer_load_dwordx4 v6,s[8:11],s21 offen offset:0 lds
buffer_load_dwordx4 v7,s[8:11],s21 offen offset:1024 lds
buffer_load_dwordx4 v8,s[8:11],s21 offen offset:2048 lds
ds_read_b128 a[144:147],v0 offset:24704
s_add_u32 s21,s21,12288
ds_read_b128 a[128:131],v0 offset:30720
s_waitcnt lgkmcnt(6)
v_mfma_f32_16x16x32_bf16 v[96:99],a[136:139],a[72:75],0
s_add_u32 m0,s22,12288
ds_read_b128 a[132:135],v1 offset:30720
buffer_load_dwordx4 v6,s[4:7],s20 offen offset:0 lds
s_waitcnt lgkmcnt(5)
v_mfma_f32_16x16x32_bf16 v[96:99],a[140:143],a[76:79],v[96:99]
buffer_load_dwordx4 v7,s[4:7],s20 offen offset:1024 lds
buffer_load_dwordx4 v8,s[4:7],s20 offen offset:2048 lds
ds_read_b128 a[140:143],v1 offset:30848
s_add_u32 s20,s20,12288
ds_read_b128 a[136:139],v0 offset:30848
s_waitcnt lgkmcnt(4)
v_mfma_f32_16x16x32_bf16 v[96:99],a[144:147],a[80:83],v[96:99]
ds_read_b128 a[144:147],v0 offset:30976
v_mfma_f32_16x16x32_bf16 v[96:99],a[148:151],a[84:87],v[96:99]
ds_read_b128 a[148:151],v1 offset:30976
v_mfma_f32_16x16x32_bf16 v[96:99],a[120:123],a[88:91],v[96:99]
ds_read_b64_tr_b16 a[122:123],v2 offset:18432
v_mfma_f32_16x16x32_bf16 v[96:99],a[124:127],a[92:95],v[96:99]
s_waitcnt lgkmcnt(5)
ds_read_b64_tr_b16 a[126:127],v3 offset:18432
v_mfma_f32_16x16x32_bf16 v[100:103],a[128:131],a[72:75],0
ds_read_b64_tr_b16 a[120:121],v2 offset:12288
v_mfma_f32_16x16x32_bf16 v[100:103],a[132:135],a[76:79],v[100:103]
s_waitcnt lgkmcnt(5)
ds_read_b64_tr_b16 a[124:125],v3 offset:12288
v_mfma_f32_16x16x32_bf16 v[100:103],a[136:139],a[80:83],v[100:103]
ds_read_b64_tr_b16 a[128:129],v4 offset:12288
v_mfma_f32_16x16x32_bf16 v[100:103],a[140:143],a[84:87],v[100:103]
s_waitcnt lgkmcnt(6)
ds_read_b64_tr_b16 a[132:133],v5 offset:12288
v_mfma_f32_16x16x32_bf16 v[100:103],a[144:147],a[88:91],v[100:103]
s_waitcnt lgkmcnt(6)
ds_read_b64_tr_b16 a[130:131],v4 offset:18432
v_mfma_f32_16x16x32_bf16 v[100:103],a[148:151],a[92:95],v[100:103]
s_waitcnt lgkmcnt(4)
ds_read_b64_tr_b16 a[134:135],v5 offset:18432
v_mfma_f32_16x16x32_bf16 v[160:163],a[120:123],v[44:47],v[160:163]
s_add_u32 m0,s23,12288
ds_read_b64_tr_b16 a[136:137],v2 offset:12416
v_fma_f32 v82,v82,s36,v14
s_waitcnt lgkmcnt(5)
v_mfma_f32_16x16x32_bf16 v[164:167],a[124:127],v[44:47],v[164:167]
ds_read_b64_tr_b16 a[138:139],v2 offset:18560
v_fma_f32 v83,v83,s36,v14
v_mfma_f32_16x16x32_bf16 v[212:215],a[124:127],v[48:51],v[212:215]
ds_read_b64_tr_b16 a[140:141],v3 offset:12416
v_fma_f32 v88,v88,s36,v15
v_mfma_f32_16x16x32_bf16 v[208:211],a[120:123],v[48:51],v[208:211]
ds_read_b64_tr_b16 a[142:143],v3 offset:18560
v_fma_f32 v89,v89,s36,v15
v_mfma_f32_16x16x32_bf16 v[112:115],a[120:123],v[52:55],v[112:115]
ds_read_b64_tr_b16 a[144:145],v4 offset:12416
v_fma_f32 v90,v90,s36,v15
v_mfma_f32_16x16x32_bf16 v[116:119],a[124:127],v[52:55],v[116:119]
ds_read_b64_tr_b16 a[146:147],v4 offset:18560
v_fma_f32 v91,v91,s36,v15
v_mfma_f32_16x16x32_bf16 a[164:167],a[124:127],v[56:59],a[164:167]
ds_read_b64_tr_b16 a[148:149],v5 offset:12416
v_fma_f32 v96,v96,s36,v16
v_mfma_f32_16x16x32_bf16 a[160:163],a[120:123],v[56:59],a[160:163]
s_waitcnt lgkmcnt(6)
ds_read_b64_tr_b16 a[150:151],v5 offset:18560
v_fma_f32 v97,v97,s36,v16
v_mfma_f32_16x16x32_bf16 a[168:171],a[128:131],v[56:59],a[168:171]
ds_read_b64_tr_b16 a[120:121],v2 offset:12544
v_fma_f32 v98,v98,s36,v16
v_mfma_f32_16x16x32_bf16 a[172:175],a[132:135],v[56:59],a[172:175]
ds_read_b64_tr_b16 a[122:123],v2 offset:18688
v_fma_f32 v99,v99,s36,v16
v_mfma_f32_16x16x32_bf16 v[124:127],a[132:135],v[52:55],v[124:127]
ds_read_b64_tr_b16 a[124:125],v3 offset:12544
v_fma_f32 v76,v76,s36,v13
v_mfma_f32_16x16x32_bf16 v[120:123],a[128:131],v[52:55],v[120:123]
ds_read_b64_tr_b16 a[126:127],v3 offset:18688
v_fma_f32 v77,v77,s36,v13
v_mfma_f32_16x16x32_bf16 v[216:219],a[128:131],v[48:51],v[216:219]
v_exp_f32 v82,v82
v_mfma_f32_16x16x32_bf16 v[220:223],a[132:135],v[48:51],v[220:223]
v_exp_f32 v83,v83
v_mfma_f32_16x16x32_bf16 v[172:175],a[132:135],v[44:47],v[172:175]
ds_read_b64_tr_b16 a[132:133],v5 offset:12544
v_cvt_pk_bf16_f32 v25,v82,v83
v_mfma_f32_16x16x32_bf16 v[168:171],a[128:131],v[44:47],v[168:171]
s_waitcnt lgkmcnt(4)
ds_read_b64_tr_b16 a[128:129],v4 offset:12544
v_fma_f32 v78,v78,s36,v13
v_mfma_f32_16x16x32_bf16 v[176:179],a[136:139],v[44:47],v[176:179]
ds_read_b64_tr_b16 a[130:131],v4 offset:18688
v_fma_f32 v79,v79,s36,v13
v_mfma_f32_16x16x32_bf16 v[180:183],a[140:143],v[44:47],v[180:183]
ds_read_b64_tr_b16 a[134:135],v5 offset:18688
v_fma_f32 v84,v84,s36,v14
v_mfma_f32_16x16x32_bf16 v[228:231],a[140:143],v[48:51],v[228:231]
v_exp_f32 v88,v88
v_mfma_f32_16x16x32_bf16 v[224:227],a[136:139],v[48:51],v[224:227]
v_exp_f32 v89,v89
v_mfma_f32_16x16x32_bf16 v[128:131],a[136:139],v[52:55],v[128:131]
v_exp_f32 v90,v90
v_mfma_f32_16x16x32_bf16 v[132:135],a[140:143],v[52:55],v[132:135]
v_exp_f32 v91,v91
v_mfma_f32_16x16x32_bf16 a[180:183],a[140:143],v[56:59],a[180:183]
v_cvt_pk_bf16_f32 v28,v88,v89
v_cvt_pk_bf16_f32 v29,v90,v91
v_mfma_f32_16x16x32_bf16 a[176:179],a[136:139],v[56:59],a[176:179]
v_exp_f32 v96,v96
v_mfma_f32_16x16x32_bf16 a[184:187],a[144:147],v[56:59],a[184:187]
v_exp_f32 v97,v97
v_mfma_f32_16x16x32_bf16 a[188:191],a[148:151],v[56:59],a[188:191]
v_exp_f32 v98,v98
v_mfma_f32_16x16x32_bf16 v[140:143],a[148:151],v[52:55],v[140:143]
v_exp_f32 v99,v99
v_mfma_f32_16x16x32_bf16 v[136:139],a[144:147],v[52:55],v[136:139]
v_cvt_pk_bf16_f32 v32,v96,v97
v_cvt_pk_bf16_f32 v33,v98,v99
v_mfma_f32_16x16x32_bf16 v[232:235],a[144:147],v[48:51],v[232:235]
v_exp_f32 v76,v76
v_mfma_f32_16x16x32_bf16 v[236:239],a[148:151],v[48:51],v[236:239]
v_exp_f32 v77,v77
v_mfma_f32_16x16x32_bf16 v[188:191],a[148:151],v[44:47],v[188:191]
v_exp_f32 v78,v78
v_mfma_f32_16x16x32_bf16 v[184:187],a[144:147],v[44:47],v[184:187]
s_waitcnt lgkmcnt(0)
v_exp_f32 v79,v79
v_mfma_f32_16x16x32_bf16 v[192:195],a[120:123],v[44:47],v[192:195]
v_cvt_pk_bf16_f32 v22,v76,v77
v_cvt_pk_bf16_f32 v23,v78,v79
v_mfma_f32_16x16x32_bf16 v[196:199],a[124:127],v[44:47],v[196:199]
s_waitcnt vmcnt(6)
v_fma_f32 v85,v85,s36,v14
v_fma_f32 v86,v86,s36,v14
v_mfma_f32_16x16x32_bf16 v[244:247],a[124:127],v[48:51],v[244:247]
s_barrier
v_mfma_f32_16x16x32_bf16 v[240:243],a[120:123],v[48:51],v[240:243]
ds_read_b128 a[148:151],v1 offset:128
v_fma_f32 v87,v87,s36,v14
v_mfma_f32_16x16x32_bf16 v[144:147],a[120:123],v[52:55],v[144:147]
ds_read_b128 a[144:147],v0 offset:128
v_fma_f32 v92,v92,s36,v15
v_mfma_f32_16x16x32_bf16 v[148:151],a[124:127],v[52:55],v[148:151]
ds_read_b128 a[140:143],v1 offset:0
v_fma_f32 v93,v93,s36,v15
v_mfma_f32_16x16x32_bf16 a[196:199],a[124:127],v[56:59],a[196:199]
ds_read_b128 a[124:127],v1 offset:256
v_fma_f32 v94,v94,s36,v15
v_mfma_f32_16x16x32_bf16 a[192:195],a[120:123],v[56:59],a[192:195]
ds_read_b128 a[120:123],v0 offset:256
v_fma_f32 v95,v95,s36,v15
v_mfma_f32_16x16x32_bf16 a[200:203],a[128:131],v[56:59],a[200:203]
buffer_load_dwordx4 v6,s[8:11],s21 offen offset:0 lds
v_mfma_f32_16x16x32_bf16 a[204:207],a[132:135],v[56:59],a[204:207]
ds_read_b128 a[136:139],v0 offset:0
v_fma_f32 v100,v100,s36,v16
v_mfma_f32_16x16x32_bf16 v[156:159],a[132:135],v[52:55],v[156:159]
v_exp_f32 v84,v84
v_mfma_f32_16x16x32_bf16 v[152:155],a[128:131],v[52:55],v[152:155]
v_exp_f32 v85,v85
v_mfma_f32_16x16x32_bf16 v[248:251],a[128:131],v[48:51],v[248:251]
v_exp_f32 v86,v86
v_mfma_f32_16x16x32_bf16 v[252:255],a[132:135],v[48:51],v[252:255]
v_exp_f32 v87,v87
v_mfma_f32_16x16x32_bf16 v[204:207],a[132:135],v[44:47],v[204:207]
ds_read_b128 a[132:135],v1 offset:6144
v_cvt_pk_bf16_f32 v26,v84,v85
v_mfma_f32_16x16x32_bf16 v[200:203],a[128:131],v[44:47],v[200:203]
s_waitcnt lgkmcnt(2)
ds_read_b128 a[128:131],v0 offset:6144
v_cvt_pk_bf16_f32 v27,v86,v87
v_mfma_f32_16x16x32_bf16 v[72:75],a[124:127],a[20:23],0
v_exp_f32 v92,v92
v_smfmac_f32_16x16x64_bf16 v[60:63],a[152:155],v[20:27],v18
buffer_load_dwordx4 v7,s[8:11],s21 offen offset:1024 lds
v_mfma_f32_16x16x32_bf16 v[72:75],a[120:123],a[16:19],v[72:75]
v_exp_f32 v93,v93
v_mfma_f32_16x16x32_bf16 v[72:75],a[148:151],a[12:15],v[72:75]
v_exp_f32 v94,v94
v_mfma_f32_16x16x32_bf16 v[72:75],a[144:147],a[8:11],v[72:75]
v_exp_f32 v95,v95
v_mfma_f32_16x16x32_bf16 v[72:75],a[140:143],a[4:7],v[72:75]
s_waitcnt lgkmcnt(1)
v_cvt_pk_bf16_f32 v30,v92,v93
v_cvt_pk_bf16_f32 v31,v94,v95
v_mfma_f32_16x16x32_bf16 v[72:75],a[136:139],a[0:3],v[72:75]
v_fma_f32 v101,v101,s36,v16
v_fma_f32 v102,v102,s36,v16
v_mfma_f32_16x16x32_bf16 v[80:83],a[136:139],a[24:27],0
v_fma_f32 v103,v103,s36,v16
v_mfma_f32_16x16x32_bf16 v[80:83],a[140:143],a[28:31],v[80:83]
v_exp_f32 v100,v100
v_mfma_f32_16x16x32_bf16 v[80:83],a[144:147],a[32:35],v[80:83]
buffer_load_dwordx4 v8,s[8:11],s21 offen offset:2048 lds
v_mfma_f32_16x16x32_bf16 v[80:83],a[148:151],a[36:39],v[80:83]
s_add_u32 s21,s21,12288
v_exp_f32 v101,v101
v_mfma_f32_16x16x32_bf16 v[80:83],a[120:123],a[40:43],v[80:83]
s_add_u32 m0,s22,24576
v_exp_f32 v102,v102
v_mfma_f32_16x16x32_bf16 v[80:83],a[124:127],a[44:47],v[80:83]
v_exp_f32 v103,v103
v_mfma_f32_16x16x32_bf16 v[88:91],a[124:127],a[68:71],0
v_cvt_pk_bf16_f32 v34,v100,v101
v_cvt_pk_bf16_f32 v35,v102,v103
v_mfma_f32_16x16x32_bf16 v[88:91],a[120:123],a[64:67],v[88:91]
v_fma_f32 v72,v72,s36,v13
v_fma_f32 v73,v73,s36,v13
v_smfmac_f32_16x16x64_bf16 v[64:67],a[152:155],v[28:35],v18
v_fma_f32 v74,v74,s36,v13
v_mfma_f32_16x16x32_bf16 v[88:91],a[148:151],a[60:63],v[88:91]
v_fma_f32 v75,v75,s36,v13
v_fma_f32 v80,v80,s36,v14
v_mfma_f32_16x16x32_bf16 v[88:91],a[144:147],a[56:59],v[88:91]
v_fma_f32 v81,v81,s36,v14
v_mfma_f32_16x16x32_bf16 v[88:91],a[140:143],a[52:55],v[88:91]
buffer_load_dwordx4 v6,s[4:7],s20 offen offset:0 lds
v_mfma_f32_16x16x32_bf16 v[88:91],a[136:139],a[48:51],v[88:91]
v_exp_f32 v72,v72
v_mfma_f32_16x16x32_bf16 v[96:99],a[136:139],a[72:75],0
ds_read_b128 a[136:139],v0 offset:6272
v_mfma_f32_16x16x32_bf16 v[96:99],a[140:143],a[76:79],v[96:99]
ds_read_b128 a[140:143],v1 offset:6272
v_mfma_f32_16x16x32_bf16 v[96:99],a[144:147],a[80:83],v[96:99]
ds_read_b128 a[144:147],v0 offset:6400
v_mfma_f32_16x16x32_bf16 v[96:99],a[148:151],a[84:87],v[96:99]
ds_read_b128 a[148:151],v1 offset:6400
v_mfma_f32_16x16x32_bf16 v[96:99],a[120:123],a[88:91],v[96:99]
v_exp_f32 v73,v73
v_mfma_f32_16x16x32_bf16 v[96:99],a[124:127],a[92:95],v[96:99]
s_waitcnt lgkmcnt(4)
v_exp_f32 v74,v74
v_mfma_f32_16x16x32_bf16 v[76:79],a[128:131],a[0:3],0
v_exp_f32 v75,v75
v_mfma_f32_16x16x32_bf16 v[76:79],a[132:135],a[4:7],v[76:79]
buffer_load_dwordx4 v7,s[4:7],s20 offen offset:1024 lds
s_waitcnt lgkmcnt(3)
v_mfma_f32_16x16x32_bf16 v[76:79],a[136:139],a[8:11],v[76:79]
s_waitcnt lgkmcnt(2)
v_exp_f32 v80,v80
v_mfma_f32_16x16x32_bf16 v[76:79],a[140:143],a[12:15],v[76:79]
s_waitcnt lgkmcnt(0)
v_exp_f32 v81,v81
v_mfma_f32_16x16x32_bf16 v[76:79],a[144:147],a[16:19],v[76:79]
v_cvt_pk_bf16_f32 v44,v72,v73
v_cvt_pk_bf16_f32 v45,v74,v75
v_mfma_f32_16x16x32_bf16 v[76:79],a[148:151],a[20:23],v[76:79]
v_cvt_pk_bf16_f32 v48,v80,v81
v_mfma_f32_16x16x32_bf16 v[84:87],a[148:151],a[44:47],0
v_mfma_f32_16x16x32_bf16 v[84:87],a[144:147],a[40:43],v[84:87]
v_mfma_f32_16x16x32_bf16 v[84:87],a[140:143],a[36:39],v[84:87]
v_mfma_f32_16x16x32_bf16 v[84:87],a[136:139],a[32:35],v[84:87]
v_mfma_f32_16x16x32_bf16 v[84:87],a[132:135],a[28:31],v[84:87]
buffer_load_dwordx4 v8,s[4:7],s20 offen offset:2048 lds
v_mfma_f32_16x16x32_bf16 v[84:87],a[128:131],a[24:27],v[84:87]
s_add_u32 s20,s20,12288
v_mfma_f32_16x16x32_bf16 v[92:95],a[128:131],a[48:51],0
ds_read_b64_tr_b16 a[120:121],v2 offset:24576
v_mfma_f32_16x16x32_bf16 v[92:95],a[132:135],a[52:55],v[92:95]
ds_read_b64_tr_b16 a[122:123],v2 offset:30720
v_mfma_f32_16x16x32_bf16 v[92:95],a[136:139],a[56:59],v[92:95]
ds_read_b64_tr_b16 a[124:125],v3 offset:24576
v_mfma_f32_16x16x32_bf16 v[92:95],a[140:143],a[60:63],v[92:95]
ds_read_b64_tr_b16 a[126:127],v3 offset:30720
v_mfma_f32_16x16x32_bf16 v[92:95],a[144:147],a[64:67],v[92:95]
v_mfma_f32_16x16x32_bf16 v[92:95],a[148:151],a[68:71],v[92:95]
v_mfma_f32_16x16x32_bf16 v[100:103],a[148:151],a[92:95],0
v_mfma_f32_16x16x32_bf16 v[100:103],a[144:147],a[88:91],v[100:103]
v_mfma_f32_16x16x32_bf16 v[100:103],a[140:143],a[84:87],v[100:103]
v_mfma_f32_16x16x32_bf16 v[100:103],a[136:139],a[80:83],v[100:103]
v_mfma_f32_16x16x32_bf16 v[100:103],a[132:135],a[76:79],v[100:103]
ds_read_b64_tr_b16 a[132:133],v5 offset:24576
v_mfma_f32_16x16x32_bf16 v[100:103],a[128:131],a[72:75],v[100:103]
ds_read_b64_tr_b16 a[128:129],v4 offset:24576
ds_read_b64_tr_b16 a[130:131],v4 offset:30720
ds_read_b64_tr_b16 a[134:135],v5 offset:30720
s_mov_b32 s38,0
s_branch L_loop4
L_loop5:
.p2align 6
L_loop5w0:
s_waitcnt lgkmcnt(3)
v_mfma_f32_16x16x32_bf16 v[160:163],a[120:123],v[20:23],v[160:163]
s_add_u32 m0,s23,24576
ds_read_b64_tr_b16 a[142:143],v3 offset:30848
v_fma_f32 v90,v90,s36,v15
v_mfma_f32_16x16x32_bf16 v[164:167],a[124:127],v[20:23],v[164:167]
ds_read_b64_tr_b16 a[136:137],v2 offset:24704
v_fma_f32 v91,v91,s36,v15
v_mfma_f32_16x16x32_bf16 v[212:215],a[124:127],v[24:27],v[212:215]
ds_read_b64_tr_b16 a[138:139],v2 offset:30848
v_fma_f32 v97,v97,s36,v16
v_mfma_f32_16x16x32_bf16 v[208:211],a[120:123],v[24:27],v[208:211]
ds_read_b64_tr_b16 a[140:141],v3 offset:24704
v_fma_f32 v96,v96,s36,v16
v_mfma_f32_16x16x32_bf16 v[112:115],a[120:123],v[28:31],v[112:115]
ds_read_b64_tr_b16 a[146:147],v4 offset:30848
v_fma_f32 v98,v98,s36,v16
v_mfma_f32_16x16x32_bf16 v[116:119],a[124:127],v[28:31],v[116:119]
ds_read_b64_tr_b16 a[144:145],v4 offset:24704
v_fma_f32 v99,v99,s36,v16
v_mfma_f32_16x16x32_bf16 a[164:167],a[124:127],v[32:35],a[164:167]
ds_read_b64_tr_b16 a[150:151],v5 offset:30848
v_fma_f32 v106,v106,s36,v17
v_mfma_f32_16x16x32_bf16 a[160:163],a[120:123],v[32:35],a[160:163]
ds_read_b64_tr_b16 a[148:149],v5 offset:24704
v_fma_f32 v107,v107,s36,v17
v_mfma_f32_16x16x32_bf16 a[208:211],a[120:123],v[36:39],a[208:211]
ds_read_b64_tr_b16 a[122:123],v2 offset:30976
v_fma_f32 v104,v104,s36,v17
v_mfma_f32_16x16x32_bf16 a[212:215],a[124:127],v[36:39],a[212:215]
s_waitcnt lgkmcnt(6)
ds_read_b64_tr_b16 a[126:127],v3 offset:30976
v_fma_f32 v105,v105,s36,v17
v_mfma_f32_16x16x32_bf16 a[216:219],a[128:131],v[36:39],a[216:219]
ds_read_b64_tr_b16 a[120:121],v2 offset:24832
v_fma_f32 v77,v77,s36,v13
v_mfma_f32_16x16x32_bf16 a[220:223],a[132:135],v[36:39],a[220:223]
ds_read_b64_tr_b16 a[124:125],v3 offset:24832
v_fma_f32 v79,v79,s36,v13
v_mfma_f32_16x16x32_bf16 a[172:175],a[132:135],v[32:35],a[172:175]
v_exp_f32 v91,v91
v_mfma_f32_16x16x32_bf16 a[168:171],a[128:131],v[32:35],a[168:171]
v_exp_f32 v90,v90
v_mfma_f32_16x16x32_bf16 v[120:123],a[128:131],v[28:31],v[120:123]
v_cvt_pk_bf16_f32 v53,v90,v91
v_fma_f32 v76,v76,s36,v13
v_mfma_f32_16x16x32_bf16 v[124:127],a[132:135],v[28:31],v[124:127]
v_exp_f32 v99,v99
v_mfma_f32_16x16x32_bf16 v[220:223],a[132:135],v[24:27],v[220:223]
v_exp_f32 v96,v96
v_mfma_f32_16x16x32_bf16 v[216:219],a[128:131],v[24:27],v[216:219]
v_exp_f32 v98,v98
v_mfma_f32_16x16x32_bf16 v[168:171],a[128:131],v[20:23],v[168:171]
ds_read_b64_tr_b16 a[128:129],v4 offset:24832
v_cvt_pk_bf16_f32 v57,v98,v99
v_mfma_f32_16x16x32_bf16 v[172:175],a[132:135],v[20:23],v[172:175]
ds_read_b64_tr_b16 a[130:131],v4 offset:30976
v_fma_f32 v78,v78,s36,v13
v_mfma_f32_16x16x32_bf16 v[176:179],a[136:139],v[20:23],v[176:179]
s_waitcnt lgkmcnt(2)
ds_read_b64_tr_b16 a[132:133],v5 offset:24832
v_fma_f32 v86,v86,s36,v14
v_mfma_f32_16x16x32_bf16 v[180:183],a[140:143],v[20:23],v[180:183]
ds_read_b64_tr_b16 a[134:135],v5 offset:30976
v_fma_f32 v84,v84,s36,v14
v_mfma_f32_16x16x32_bf16 v[228:231],a[140:143],v[24:27],v[228:231]
v_exp_f32 v97,v97
v_mfma_f32_16x16x32_bf16 v[224:227],a[136:139],v[24:27],v[224:227]
v_cvt_pk_bf16_f32 v56,v96,v97
v_fma_f32 v87,v87,s36,v14
v_mfma_f32_16x16x32_bf16 v[128:131],a[136:139],v[28:31],v[128:131]
v_exp_f32 v104,v104
v_mfma_f32_16x16x32_bf16 v[132:135],a[140:143],v[28:31],v[132:135]
v_exp_f32 v107,v107
v_mfma_f32_16x16x32_bf16 a[180:183],a[140:143],v[32:35],a[180:183]
v_exp_f32 v105,v105
v_mfma_f32_16x16x32_bf16 a[176:179],a[136:139],v[32:35],a[176:179]
v_exp_f32 v106,v106
v_mfma_f32_16x16x32_bf16 a[224:227],a[136:139],v[36:39],a[224:227]
v_cvt_pk_bf16_f32 v41,v106,v107
v_cvt_pk_bf16_f32 v40,v104,v105
v_mfma_f32_16x16x32_bf16 a[228:231],a[140:143],v[36:39],a[228:231]
v_exp_f32 v78,v78
v_mfma_f32_16x16x32_bf16 a[232:235],a[144:147],v[36:39],a[232:235]
v_exp_f32 v79,v79
v_mfma_f32_16x16x32_bf16 a[236:239],a[148:151],v[36:39],a[236:239]
v_exp_f32 v77,v77
v_mfma_f32_16x16x32_bf16 a[188:191],a[148:151],v[32:35],a[188:191]
v_exp_f32 v76,v76
v_mfma_f32_16x16x32_bf16 a[184:187],a[144:147],v[32:35],a[184:187]
v_cvt_pk_bf16_f32 v46,v76,v77
v_cvt_pk_bf16_f32 v47,v78,v79
v_mfma_f32_16x16x32_bf16 v[136:139],a[144:147],v[28:31],v[136:139]
v_exp_f32 v86,v86
v_mfma_f32_16x16x32_bf16 v[140:143],a[148:151],v[28:31],v[140:143]
v_exp_f32 v87,v87
v_mfma_f32_16x16x32_bf16 v[236:239],a[148:151],v[24:27],v[236:239]
v_exp_f32 v84,v84
v_mfma_f32_16x16x32_bf16 v[232:235],a[144:147],v[24:27],v[232:235]
v_fma_f32 v85,v85,s36,v14
v_cvt_pk_bf16_f32 v51,v86,v87
v_mfma_f32_16x16x32_bf16 v[184:187],a[144:147],v[20:23],v[184:187]
v_exp_f32 v85,v85
v_mfma_f32_16x16x32_bf16 v[188:191],a[148:151],v[20:23],v[188:191]
v_cvt_pk_bf16_f32 v50,v84,v85
v_fma_f32 v92,v92,s36,v15
v_mfma_f32_16x16x32_bf16 v[192:195],a[120:123],v[20:23],v[192:195]
v_fma_f32 v94,v94,s36,v15
v_fma_f32 v93,v93,s36,v15
v_smfmac_f32_16x16x64_bf16 v[60:63],a[152:155],v[44:51],v18
v_fma_f32 v95,v95,s36,v15
v_mfma_f32_16x16x32_bf16 v[196:199],a[124:127],v[20:23],v[196:199]
s_waitcnt vmcnt(6) lgkmcnt(0)
v_exp_f32 v94,v94
v_mfma_f32_16x16x32_bf16 v[244:247],a[124:127],v[24:27],v[244:247]
s_barrier
v_mfma_f32_16x16x32_bf16 v[240:243],a[120:123],v[24:27],v[240:243]
ds_read_b128 a[136:139],v0 offset:12288
v_fma_f32 v102,v102,s36,v16
v_mfma_f32_16x16x32_bf16 v[144:147],a[120:123],v[28:31],v[144:147]
ds_read_b128 a[144:147],v0 offset:12416
v_fma_f32 v101,v101,s36,v16
v_mfma_f32_16x16x32_bf16 v[148:151],a[124:127],v[28:31],v[148:151]
ds_read_b128 a[140:143],v1 offset:12288
v_fma_f32 v100,v100,s36,v16
v_mfma_f32_16x16x32_bf16 a[196:199],a[124:127],v[32:35],a[196:199]
ds_read_b128 a[148:151],v1 offset:12416
v_fma_f32 v103,v103,s36,v16
v_mfma_f32_16x16x32_bf16 a[192:195],a[120:123],v[32:35],a[192:195]
ds_read_b128 a[156:159],v10 offset:0
v_fma_f32 v108,v108,s36,v17
v_mfma_f32_16x16x32_bf16 a[240:243],a[120:123],v[36:39],a[240:243]
buffer_load_dwordx4 v6,s[8:11],s21 offen offset:0 lds
v_mfma_f32_16x16x32_bf16 a[244:247],a[124:127],v[36:39],a[244:247]
ds_read_b128 a[120:123],v0 offset:12544
v_fma_f32 v110,v110,s36,v17
v_mfma_f32_16x16x32_bf16 a[248:251],a[128:131],v[36:39],a[248:251]
ds_read_b128 a[124:127],v1 offset:12544
v_fma_f32 v111,v111,s36,v17
v_mfma_f32_16x16x32_bf16 a[252:255],a[132:135],v[36:39],a[252:255]
v_exp_f32 v92,v92
v_mfma_f32_16x16x32_bf16 a[204:207],a[132:135],v[32:35],a[204:207]
v_exp_f32 v95,v95
v_mfma_f32_16x16x32_bf16 a[200:203],a[128:131],v[32:35],a[200:203]
v_cvt_pk_bf16_f32 v55,v94,v95
v_fma_f32 v109,v109,s36,v17
v_mfma_f32_16x16x32_bf16 v[152:155],a[128:131],v[28:31],v[152:155]
v_exp_f32 v93,v93
v_mfma_f32_16x16x32_bf16 v[156:159],a[132:135],v[28:31],v[156:159]
v_cvt_pk_bf16_f32 v54,v92,v93
v_mfma_f32_16x16x32_bf16 v[252:255],a[132:135],v[24:27],v[252:255]
v_exp_f32 v102,v102
v_mfma_f32_16x16x32_bf16 v[248:251],a[128:131],v[24:27],v[248:251]
v_exp_f32 v101,v101
v_mfma_f32_16x16x32_bf16 v[200:203],a[128:131],v[20:23],v[200:203]
ds_read_b128 a[128:131],v0 offset:18432
v_mfma_f32_16x16x32_bf16 v[204:207],a[132:135],v[20:23],v[204:207]
s_waitcnt lgkmcnt(1)
buffer_store_dwordx4 a[156:159],v9,s[16:19],s27 offen offset:0 nt
buffer_load_dwordx4 v7,s[8:11],s21 offen offset:1024 lds
v_mfma_f32_16x16x32_bf16 v[72:75],a[136:139],a[0:3],0
ds_read_b128 a[132:135],v1 offset:18432
v_mfma_f32_16x16x32_bf16 v[72:75],a[140:143],a[4:7],v[72:75]
v_exp_f32 v103,v103
v_mfma_f32_16x16x32_bf16 v[72:75],a[144:147],a[8:11],v[72:75]
v_exp_f32 v100,v100
v_mfma_f32_16x16x32_bf16 v[72:75],a[148:151],a[12:15],v[72:75]
v_cvt_pk_bf16_f32 v59,v102,v103
v_cvt_pk_bf16_f32 v58,v100,v101
v_mfma_f32_16x16x32_bf16 v[72:75],a[120:123],a[16:19],v[72:75]
v_exp_f32 v109,v109
v_smfmac_f32_16x16x64_bf16 v[64:67],a[152:155],v[52:59],v18
ds_read_b128 a[156:159],v10 offset:1024
v_mfma_f32_16x16x32_bf16 v[72:75],a[124:127],a[20:23],v[72:75]
v_exp_f32 v111,v111
v_mfma_f32_16x16x32_bf16 v[80:83],a[124:127],a[44:47],0
v_exp_f32 v108,v108
v_mfma_f32_16x16x32_bf16 v[80:83],a[120:123],a[40:43],v[80:83]
v_exp_f32 v110,v110
v_mfma_f32_16x16x32_bf16 v[80:83],a[148:151],a[36:39],v[80:83]
v_cvt_pk_bf16_f32 v42,v108,v109
v_cvt_pk_bf16_f32 v43,v110,v111
v_mfma_f32_16x16x32_bf16 v[80:83],a[144:147],a[32:35],v[80:83]
buffer_load_dwordx4 v8,s[8:11],s21 offen offset:2048 lds
v_smfmac_f32_16x16x64_bf16 v[68:71],a[152:155],v[36:43],v18
s_add_u32 s21,s21,12288
v_fma_f32 v73,v73,s36,v13
v_mfma_f32_16x16x32_bf16 v[80:83],a[140:143],a[28:31],v[80:83]
s_add_u32 m0,s22,0
v_fma_f32 v72,v72,s36,v13
v_fma_f32 v74,v74,s36,v13
v_mfma_f32_16x16x32_bf16 v[80:83],a[136:139],a[24:27],v[80:83]
v_exp_f32 v73,v73
v_mfma_f32_16x16x32_bf16 v[88:91],a[136:139],a[48:51],0
v_exp_f32 v72,v72
v_mfma_f32_16x16x32_bf16 v[88:91],a[140:143],a[52:55],v[88:91]
v_exp_f32 v74,v74
v_mfma_f32_16x16x32_bf16 v[88:91],a[144:147],a[56:59],v[88:91]
v_fma_f32 v75,v75,s36,v13
v_cvt_pk_bf16_f32 v20,v72,v73
v_mfma_f32_16x16x32_bf16 v[88:91],a[148:151],a[60:63],v[88:91]
v_exp_f32 v75,v75
v_mfma_f32_16x16x32_bf16 v[88:91],a[120:123],a[64:67],v[88:91]
v_fma_f32 v83,v83,s36,v14
v_fma_f32 v81,v81,s36,v14
v_mfma_f32_16x16x32_bf16 v[88:91],a[124:127],a[68:71],v[88:91]
v_exp_f32 v81,v81
v_mfma_f32_16x16x32_bf16 v[96:99],a[124:127],a[92:95],0
v_cvt_pk_bf16_f32 v21,v74,v75
v_fma_f32 v82,v82,s36,v14
v_mfma_f32_16x16x32_bf16 v[96:99],a[120:123],a[88:91],v[96:99]
s_waitcnt lgkmcnt(0)
buffer_store_dwordx4 a[156:159],v9,s[16:19],s27 offen offset:128 nt
buffer_load_dwordx4 v6,s[4:7],s20 offen offset:0 lds
v_mfma_f32_16x16x32_bf16 v[96:99],a[148:151],a[84:87],v[96:99]
v_fma_f32 v88,v88,s36,v15
v_fma_f32 v89,v89,s36,v15
v_mfma_f32_16x16x32_bf16 v[96:99],a[144:147],a[80:83],v[96:99]
v_exp_f32 v89,v89
v_mfma_f32_16x16x32_bf16 v[96:99],a[140:143],a[76:79],v[96:99]
v_exp_f32 v82,v82
v_mfma_f32_16x16x32_bf16 v[96:99],a[136:139],a[72:75],v[96:99]
v_exp_f32 v88,v88
v_mfma_f32_16x16x32_bf16 v[104:107],a[136:139],a[96:99],0
ds_read_b128 a[136:139],v0 offset:18560
v_fma_f32 v80,v80,s36,v14
v_mfma_f32_16x16x32_bf16 v[104:107],a[140:143],a[100:103],v[104:107]
ds_read_b128 a[156:159],v10 offset:2048
v_mfma_f32_16x16x32_bf16 v[104:107],a[144:147],a[104:107],v[104:107]
ds_read_b128 a[140:143],v1 offset:18560
v_mfma_f32_16x16x32_bf16 v[104:107],a[148:151],a[108:111],v[104:107]
ds_read_b128 a[144:147],v0 offset:18688
v_mfma_f32_16x16x32_bf16 v[104:107],a[120:123],a[112:115],v[104:107]
ds_read_b128 a[148:151],v1 offset:18688
v_mfma_f32_16x16x32_bf16 v[104:107],a[124:127],a[116:119],v[104:107]
v_exp_f32 v80,v80
v_mfma_f32_16x16x32_bf16 v[76:79],a[128:131],a[0:3],0
buffer_load_dwordx4 v7,s[4:7],s20 offen offset:1024 lds
v_mfma_f32_16x16x32_bf16 v[76:79],a[132:135],a[4:7],v[76:79]
s_waitcnt lgkmcnt(4)
v_cvt_pk_bf16_f32 v24,v80,v81
v_cvt_pk_bf16_f32 v28,v88,v89
v_mfma_f32_16x16x32_bf16 v[76:79],a[136:139],a[8:11],v[76:79]
s_waitcnt lgkmcnt(2)
v_exp_f32 v83,v83
v_mfma_f32_16x16x32_bf16 v[76:79],a[140:143],a[12:15],v[76:79]
s_waitcnt lgkmcnt(1)
v_cvt_pk_bf16_f32 v25,v82,v83
v_mfma_f32_16x16x32_bf16 v[76:79],a[144:147],a[16:19],v[76:79]
s_waitcnt lgkmcnt(0)
v_mfma_f32_16x16x32_bf16 v[76:79],a[148:151],a[20:23],v[76:79]
v_mfma_f32_16x16x32_bf16 v[84:87],a[148:151],a[44:47],0
v_mfma_f32_16x16x32_bf16 v[84:87],a[144:147],a[40:43],v[84:87]
v_mfma_f32_16x16x32_bf16 v[84:87],a[140:143],a[36:39],v[84:87]
v_mfma_f32_16x16x32_bf16 v[84:87],a[136:139],a[32:35],v[84:87]
v_mfma_f32_16x16x32_bf16 v[84:87],a[132:135],a[28:31],v[84:87]
buffer_store_dwordx4 a[156:159],v9,s[16:19],s27 offen offset:256 nt
buffer_load_dwordx4 v8,s[4:7],s20 offen offset:2048 lds
v_mfma_f32_16x16x32_bf16 v[84:87],a[128:131],a[24:27],v[84:87]
s_add_u32 s20,s20,12288
v_mfma_f32_16x16x32_bf16 v[92:95],a[128:131],a[48:51],0
s_add_u32 s27,s27,3072
v_mfma_f32_16x16x32_bf16 v[92:95],a[132:135],a[52:55],v[92:95]
v_mfma_f32_16x16x32_bf16 v[92:95],a[136:139],a[56:59],v[92:95]
v_mfma_f32_16x16x32_bf16 v[92:95],a[140:143],a[60:63],v[92:95]
ds_read_b64_tr_b16 a[120:121],v2 offset:0
v_mfma_f32_16x16x32_bf16 v[92:95],a[144:147],a[64:67],v[92:95]
ds_read_b64_tr_b16 a[122:123],v2 offset:6144
v_mfma_f32_16x16x32_bf16 v[92:95],a[148:151],a[68:71],v[92:95]
v_mfma_f32_16x16x32_bf16 v[100:103],a[148:151],a[92:95],0
ds_read_b64_tr_b16 a[124:125],v3 offset:0
v_mfma_f32_16x16x32_bf16 v[100:103],a[144:147],a[88:91],v[100:103]
ds_read_b64_tr_b16 a[126:127],v3 offset:6144
v_mfma_f32_16x16x32_bf16 v[100:103],a[140:143],a[84:87],v[100:103]
v_mfma_f32_16x16x32_bf16 v[100:103],a[136:139],a[80:83],v[100:103]
v_mfma_f32_16x16x32_bf16 v[100:103],a[132:135],a[76:79],v[100:103]
v_mfma_f32_16x16x32_bf16 v[100:103],a[128:131],a[72:75],v[100:103]
v_mfma_f32_16x16x32_bf16 v[108:111],a[128:131],a[96:99],0
ds_read_b64_tr_b16 a[130:131],v4 offset:6144
v_mfma_f32_16x16x32_bf16 v[108:111],a[132:135],a[100:103],v[108:111]
ds_read_b64_tr_b16 a[128:129],v4 offset:0
v_mfma_f32_16x16x32_bf16 v[108:111],a[136:139],a[104:107],v[108:111]
ds_read_b64_tr_b16 a[134:135],v5 offset:6144
v_mfma_f32_16x16x32_bf16 v[108:111],a[140:143],a[108:111],v[108:111]
ds_read_b64_tr_b16 a[132:133],v5 offset:0
v_mfma_f32_16x16x32_bf16 v[108:111],a[144:147],a[112:115],v[108:111]
v_mfma_f32_16x16x32_bf16 v[108:111],a[148:151],a[116:119],v[108:111]
s_waitcnt lgkmcnt(4)
v_mfma_f32_16x16x32_bf16 v[160:163],a[120:123],v[44:47],v[160:163]
s_add_u32 m0,s29,0
ds_read_b64_tr_b16 a[136:137],v2 offset:128
v_fma_f32 v90,v90,s36,v15
v_mfma_f32_16x16x32_bf16 v[164:167],a[124:127],v[44:47],v[164:167]
ds_read_b64_tr_b16 a[138:139],v2 offset:6272
v_fma_f32 v91,v91,s36,v15
v_mfma_f32_16x16x32_bf16 v[212:215],a[124:127],v[48:51],v[212:215]
ds_read_b64_tr_b16 a[140:141],v3 offset:128
v_fma_f32 v96,v96,s36,v16
v_mfma_f32_16x16x32_bf16 v[208:211],a[120:123],v[48:51],v[208:211]
ds_read_b64_tr_b16 a[142:143],v3 offset:6272
v_fma_f32 v97,v97,s36,v16
v_mfma_f32_16x16x32_bf16 v[112:115],a[120:123],v[52:55],v[112:115]
ds_read_b64_tr_b16 a[144:145],v4 offset:128
v_fma_f32 v98,v98,s36,v16
v_mfma_f32_16x16x32_bf16 v[116:119],a[124:127],v[52:55],v[116:119]
ds_read_b64_tr_b16 a[146:147],v4 offset:6272
v_fma_f32 v99,v99,s36,v16
v_mfma_f32_16x16x32_bf16 a[164:167],a[124:127],v[56:59],a[164:167]
ds_read_b64_tr_b16 a[148:149],v5 offset:128
v_fma_f32 v104,v104,s36,v17
v_mfma_f32_16x16x32_bf16 a[160:163],a[120:123],v[56:59],a[160:163]
buffer_load_dwordx4 v6,s[12:15],s28 offen offset:0 nt lds
v_mfma_f32_16x16x32_bf16 a[208:211],a[120:123],v[40:43],a[208:211]
ds_read_b64_tr_b16 a[150:151],v5 offset:6272
v_fma_f32 v105,v105,s36,v17
v_mfma_f32_16x16x32_bf16 a[212:215],a[124:127],v[40:43],a[212:215]
s_waitcnt lgkmcnt(5)
ds_read_b64_tr_b16 a[120:121],v2 offset:256
v_fma_f32 v106,v106,s36,v17
v_mfma_f32_16x16x32_bf16 a[216:219],a[128:131],v[40:43],a[216:219]
ds_read_b64_tr_b16 a[122:123],v2 offset:6400
v_fma_f32 v107,v107,s36,v17
v_mfma_f32_16x16x32_bf16 a[220:223],a[132:135],v[40:43],a[220:223]
ds_read_b64_tr_b16 a[124:125],v3 offset:256
v_fma_f32 v76,v76,s36,v13
v_mfma_f32_16x16x32_bf16 a[172:175],a[132:135],v[56:59],a[172:175]
ds_read_b64_tr_b16 a[126:127],v3 offset:6400
v_fma_f32 v77,v77,s36,v13
v_mfma_f32_16x16x32_bf16 a[168:171],a[128:131],v[56:59],a[168:171]
v_exp_f32 v90,v90
v_mfma_f32_16x16x32_bf16 v[120:123],a[128:131],v[52:55],v[120:123]
v_exp_f32 v91,v91
v_mfma_f32_16x16x32_bf16 v[124:127],a[132:135],v[52:55],v[124:127]
v_cvt_pk_bf16_f32 v29,v90,v91
v_fma_f32 v78,v78,s36,v13
v_mfma_f32_16x16x32_bf16 v[220:223],a[132:135],v[48:51],v[220:223]
v_exp_f32 v96,v96
v_mfma_f32_16x16x32_bf16 v[216:219],a[128:131],v[48:51],v[216:219]
buffer_load_dwordx4 v7,s[12:15],s28 offen offset:1024 nt lds
v_mfma_f32_16x16x32_bf16 v[168:171],a[128:131],v[44:47],v[168:171]
ds_read_b64_tr_b16 a[128:129],v4 offset:256
v_fma_f32 v79,v79,s36,v13
v_mfma_f32_16x16x32_bf16 v[172:175],a[132:135],v[44:47],v[172:175]
ds_read_b64_tr_b16 a[130:131],v4 offset:6400
v_fma_f32 v84,v84,s36,v14
v_mfma_f32_16x16x32_bf16 v[176:179],a[136:139],v[44:47],v[176:179]
s_waitcnt lgkmcnt(2)
ds_read_b64_tr_b16 a[132:133],v5 offset:256
v_fma_f32 v85,v85,s36,v14
v_mfma_f32_16x16x32_bf16 v[180:183],a[140:143],v[44:47],v[180:183]
ds_read_b64_tr_b16 a[134:135],v5 offset:6400
v_fma_f32 v86,v86,s36,v14
v_mfma_f32_16x16x32_bf16 v[228:231],a[140:143],v[48:51],v[228:231]
v_exp_f32 v97,v97
v_mfma_f32_16x16x32_bf16 v[224:227],a[136:139],v[48:51],v[224:227]
v_exp_f32 v98,v98
v_mfma_f32_16x16x32_bf16 v[128:131],a[136:139],v[52:55],v[128:131]
v_exp_f32 v99,v99
v_mfma_f32_16x16x32_bf16 v[132:135],a[140:143],v[52:55],v[132:135]
v_cvt_pk_bf16_f32 v32,v96,v97
v_cvt_pk_bf16_f32 v33,v98,v99
v_mfma_f32_16x16x32_bf16 a[180:183],a[140:143],v[56:59],a[180:183]
v_exp_f32 v104,v104
v_mfma_f32_16x16x32_bf16 a[176:179],a[136:139],v[56:59],a[176:179]
buffer_load_dwordx4 v8,s[12:15],s28 offen offset:2048 nt lds
v_mfma_f32_16x16x32_bf16 a[224:227],a[136:139],v[40:43],a[224:227]
s_add_u32 s28,s28,3072
v_exp_f32 v105,v105
v_mfma_f32_16x16x32_bf16 a[228:231],a[140:143],v[40:43],a[228:231]
s_add_u32 s29,s29,3072
v_exp_f32 v106,v106
v_mfma_f32_16x16x32_bf16 a[232:235],a[144:147],v[40:43],a[232:235]
s_add_u32 m0,s23,0
v_exp_f32 v107,v107
v_mfma_f32_16x16x32_bf16 a[236:239],a[148:151],v[40:43],a[236:239]
v_cvt_pk_bf16_f32 v36,v104,v105
v_cvt_pk_bf16_f32 v37,v106,v107
v_mfma_f32_16x16x32_bf16 a[188:191],a[148:151],v[56:59],a[188:191]
v_exp_f32 v76,v76
v_mfma_f32_16x16x32_bf16 a[184:187],a[144:147],v[56:59],a[184:187]
v_exp_f32 v77,v77
v_mfma_f32_16x16x32_bf16 v[136:139],a[144:147],v[52:55],v[136:139]
v_exp_f32 v78,v78
v_mfma_f32_16x16x32_bf16 v[140:143],a[148:151],v[52:55],v[140:143]
v_exp_f32 v79,v79
v_mfma_f32_16x16x32_bf16 v[236:239],a[148:151],v[48:51],v[236:239]
v_cvt_pk_bf16_f32 v22,v76,v77
v_cvt_pk_bf16_f32 v23,v78,v79
v_mfma_f32_16x16x32_bf16 v[232:235],a[144:147],v[48:51],v[232:235]
v_fma_f32 v87,v87,s36,v14
v_fma_f32 v92,v92,s36,v15
v_mfma_f32_16x16x32_bf16 v[184:187],a[144:147],v[44:47],v[184:187]
v_exp_f32 v84,v84
v_mfma_f32_16x16x32_bf16 v[188:191],a[148:151],v[44:47],v[188:191]
v_exp_f32 v85,v85
v_mfma_f32_16x16x32_bf16 v[192:195],a[120:123],v[44:47],v[192:195]
v_exp_f32 v86,v86
v_mfma_f32_16x16x32_bf16 v[196:199],a[124:127],v[44:47],v[196:199]
s_waitcnt vmcnt(12) lgkmcnt(0)
v_exp_f32 v87,v87
v_mfma_f32_16x16x32_bf16 v[244:247],a[124:127],v[48:51],v[244:247]
s_barrier
v_mfma_f32_16x16x32_bf16 v[240:243],a[120:123],v[48:51],v[240:243]
ds_read_b128 a[136:139],v0 offset:24576
v_cvt_pk_bf16_f32 v26,v84,v85
v_mfma_f32_16x16x32_bf16 v[144:147],a[120:123],v[52:55],v[144:147]
ds_read_b128 a[140:143],v1 offset:24576
v_cvt_pk_bf16_f32 v27,v86,v87
v_mfma_f32_16x16x32_bf16 v[148:151],a[124:127],v[52:55],v[148:151]
ds_read_b128 a[144:147],v0 offset:24704
v_fma_f32 v93,v93,s36,v15
v_smfmac_f32_16x16x64_bf16 v[60:63],a[152:155],v[20:27],v18
ds_read_b128 a[148:151],v1 offset:24704
v_mfma_f32_16x16x32_bf16 a[196:199],a[124:127],v[56:59],a[196:199]
v_fma_f32 v94,v94,s36,v15
v_fma_f32 v95,v95,s36,v15
v_mfma_f32_16x16x32_bf16 a[192:195],a[120:123],v[56:59],a[192:195]
buffer_load_dwordx4 v6,s[8:11],s21 offen offset:0 lds
v_mfma_f32_16x16x32_bf16 a[240:243],a[120:123],v[40:43],a[240:243]
ds_read_b128 a[120:123],v0 offset:24832
v_fma_f32 v100,v100,s36,v16
v_mfma_f32_16x16x32_bf16 a[244:247],a[124:127],v[40:43],a[244:247]
ds_read_b128 a[124:127],v1 offset:24832
v_fma_f32 v101,v101,s36,v16
v_mfma_f32_16x16x32_bf16 a[248:251],a[128:131],v[40:43],a[248:251]
v_exp_f32 v92,v92
v_mfma_f32_16x16x32_bf16 a[252:255],a[132:135],v[40:43],a[252:255]
v_exp_f32 v93,v93
v_mfma_f32_16x16x32_bf16 a[204:207],a[132:135],v[56:59],a[204:207]
v_exp_f32 v94,v94
v_mfma_f32_16x16x32_bf16 a[200:203],a[128:131],v[56:59],a[200:203]
v_exp_f32 v95,v95
v_mfma_f32_16x16x32_bf16 v[152:155],a[128:131],v[52:55],v[152:155]
v_cvt_pk_bf16_f32 v30,v92,v93
v_cvt_pk_bf16_f32 v31,v94,v95
v_mfma_f32_16x16x32_bf16 v[156:159],a[132:135],v[52:55],v[156:159]
v_fma_f32 v102,v102,s36,v16
v_fma_f32 v103,v103,s36,v16
v_mfma_f32_16x16x32_bf16 v[252:255],a[132:135],v[48:51],v[252:255]
v_exp_f32 v100,v100
v_mfma_f32_16x16x32_bf16 v[248:251],a[128:131],v[48:51],v[248:251]
v_exp_f32 v101,v101
v_mfma_f32_16x16x32_bf16 v[200:203],a[128:131],v[44:47],v[200:203]
buffer_load_dwordx4 v7,s[8:11],s21 offen offset:1024 lds
v_mfma_f32_16x16x32_bf16 v[204:207],a[132:135],v[44:47],v[204:207]
s_waitcnt lgkmcnt(0)
ds_read_b128 a[128:131],v0 offset:30720
v_cvt_pk_bf16_f32 v34,v100,v101
v_mfma_f32_16x16x32_bf16 v[72:75],a[136:139],a[0:3],0
ds_read_b128 a[132:135],v1 offset:30720
v_fma_f32 v108,v108,s36,v17
v_mfma_f32_16x16x32_bf16 v[72:75],a[140:143],a[4:7],v[72:75]
v_exp_f32 v102,v102
v_mfma_f32_16x16x32_bf16 v[72:75],a[144:147],a[8:11],v[72:75]
v_exp_f32 v103,v103
v_mfma_f32_16x16x32_bf16 v[72:75],a[148:151],a[12:15],v[72:75]
v_cvt_pk_bf16_f32 v35,v102,v103
v_fma_f32 v109,v109,s36,v17
v_mfma_f32_16x16x32_bf16 v[72:75],a[120:123],a[16:19],v[72:75]
v_fma_f32 v110,v110,s36,v17
v_fma_f32 v111,v111,s36,v17
v_smfmac_f32_16x16x64_bf16 v[64:67],a[152:155],v[28:35],v18
v_mfma_f32_16x16x32_bf16 v[72:75],a[124:127],a[20:23],v[72:75]
v_exp_f32 v108,v108
v_mfma_f32_16x16x32_bf16 v[80:83],a[124:127],a[44:47],0
v_exp_f32 v109,v109
v_mfma_f32_16x16x32_bf16 v[80:83],a[120:123],a[40:43],v[80:83]
v_exp_f32 v110,v110
v_mfma_f32_16x16x32_bf16 v[80:83],a[148:151],a[36:39],v[80:83]
v_exp_f32 v111,v111
v_mfma_f32_16x16x32_bf16 v[80:83],a[144:147],a[32:35],v[80:83]
buffer_load_dwordx4 v8,s[8:11],s21 offen offset:2048 lds
v_mfma_f32_16x16x32_bf16 v[80:83],a[140:143],a[28:31],v[80:83]
s_add_u32 s21,s21,12288
v_cvt_pk_bf16_f32 v38,v108,v109
v_cvt_pk_bf16_f32 v39,v110,v111
v_mfma_f32_16x16x32_bf16 v[80:83],a[136:139],a[24:27],v[80:83]
s_add_u32 m0,s22,12288
v_fma_f32 v72,v72,s36,v13
v_fma_f32 v73,v73,s36,v13
v_mfma_f32_16x16x32_bf16 v[88:91],a[136:139],a[48:51],0
v_fma_f32 v74,v74,s36,v13
v_fma_f32 v75,v75,s36,v13
v_mfma_f32_16x16x32_bf16 v[88:91],a[140:143],a[52:55],v[88:91]
v_exp_f32 v72,v72
v_mfma_f32_16x16x32_bf16 v[88:91],a[144:147],a[56:59],v[88:91]
v_fma_f32 v80,v80,s36,v14
v_fma_f32 v81,v81,s36,v14
v_mfma_f32_16x16x32_bf16 v[88:91],a[148:151],a[60:63],v[88:91]
v_fma_f32 v82,v82,s36,v14
v_fma_f32 v83,v83,s36,v14
v_mfma_f32_16x16x32_bf16 v[88:91],a[120:123],a[64:67],v[88:91]
v_exp_f32 v73,v73
v_mfma_f32_16x16x32_bf16 v[88:91],a[124:127],a[68:71],v[88:91]
v_exp_f32 v74,v74
v_mfma_f32_16x16x32_bf16 v[96:99],a[124:127],a[92:95],0
v_exp_f32 v75,v75
v_mfma_f32_16x16x32_bf16 v[96:99],a[120:123],a[88:91],v[96:99]
v_exp_f32 v80,v80
v_mfma_f32_16x16x32_bf16 v[96:99],a[148:151],a[84:87],v[96:99]
buffer_load_dwordx4 v6,s[4:7],s20 offen offset:0 lds
v_mfma_f32_16x16x32_bf16 v[96:99],a[144:147],a[80:83],v[96:99]
v_fma_f32 v88,v88,s36,v15
v_fma_f32 v89,v89,s36,v15
v_mfma_f32_16x16x32_bf16 v[96:99],a[140:143],a[76:79],v[96:99]
v_exp_f32 v81,v81
v_mfma_f32_16x16x32_bf16 v[96:99],a[136:139],a[72:75],v[96:99]
v_exp_f32 v82,v82
v_mfma_f32_16x16x32_bf16 v[104:107],a[136:139],a[96:99],0
ds_read_b128 a[136:139],v0 offset:30848
v_cvt_pk_bf16_f32 v44,v72,v73
v_mfma_f32_16x16x32_bf16 v[104:107],a[140:143],a[100:103],v[104:107]
ds_read_b128 a[140:143],v1 offset:30848
v_cvt_pk_bf16_f32 v45,v74,v75
v_mfma_f32_16x16x32_bf16 v[104:107],a[144:147],a[104:107],v[104:107]
ds_read_b128 a[144:147],v0 offset:30976
v_cvt_pk_bf16_f32 v48,v80,v81
v_mfma_f32_16x16x32_bf16 v[104:107],a[148:151],a[108:111],v[104:107]
ds_read_b128 a[148:151],v1 offset:30976
v_mfma_f32_16x16x32_bf16 v[104:107],a[120:123],a[112:115],v[104:107]
v_exp_f32 v83,v83
v_mfma_f32_16x16x32_bf16 v[104:107],a[124:127],a[116:119],v[104:107]
s_waitcnt lgkmcnt(4)
v_exp_f32 v88,v88
v_mfma_f32_16x16x32_bf16 v[76:79],a[128:131],a[0:3],0
v_exp_f32 v89,v89
v_mfma_f32_16x16x32_bf16 v[76:79],a[132:135],a[4:7],v[76:79]
buffer_load_dwordx4 v7,s[4:7],s20 offen offset:1024 lds
s_waitcnt lgkmcnt(3)
v_mfma_f32_16x16x32_bf16 v[76:79],a[136:139],a[8:11],v[76:79]
s_waitcnt lgkmcnt(2)
v_cvt_pk_bf16_f32 v49,v82,v83
v_cvt_pk_bf16_f32 v52,v88,v89
v_mfma_f32_16x16x32_bf16 v[76:79],a[140:143],a[12:15],v[76:79]
s_waitcnt lgkmcnt(0)
v_mfma_f32_16x16x32_bf16 v[76:79],a[144:147],a[16:19],v[76:79]
v_mfma_f32_16x16x32_bf16 v[76:79],a[148:151],a[20:23],v[76:79]
v_mfma_f32_16x16x32_bf16 v[84:87],a[148:151],a[44:47],0
v_mfma_f32_16x16x32_bf16 v[84:87],a[144:147],a[40:43],v[84:87]
v_mfma_f32_16x16x32_bf16 v[84:87],a[140:143],a[36:39],v[84:87]
v_mfma_f32_16x16x32_bf16 v[84:87],a[136:139],a[32:35],v[84:87]
v_mfma_f32_16x16x32_bf16 v[84:87],a[132:135],a[28:31],v[84:87]
v_mfma_f32_16x16x32_bf16 v[84:87],a[128:131],a[24:27],v[84:87]
v_mfma_f32_16x16x32_bf16 v[92:95],a[128:131],a[48:51],0
v_mfma_f32_16x16x32_bf16 v[92:95],a[132:135],a[52:55],v[92:95]
buffer_load_dwordx4 v8,s[4:7],s20 offen offset:2048 lds
v_mfma_f32_16x16x32_bf16 v[92:95],a[136:139],a[56:59],v[92:95]
s_add_u32 s20,s20,12288
v_mfma_f32_16x16x32_bf16 v[92:95],a[140:143],a[60:63],v[92:95]
v_mfma_f32_16x16x32_bf16 v[92:95],a[144:147],a[64:67],v[92:95]
v_mfma_f32_16x16x32_bf16 v[92:95],a[148:151],a[68:71],v[92:95]
v_mfma_f32_16x16x32_bf16 v[100:103],a[148:151],a[92:95],0
ds_read_b64_tr_b16 a[120:121],v2 offset:12288
v_mfma_f32_16x16x32_bf16 v[100:103],a[144:147],a[88:91],v[100:103]
ds_read_b64_tr_b16 a[122:123],v2 offset:18432
v_mfma_f32_16x16x32_bf16 v[100:103],a[140:143],a[84:87],v[100:103]
v_mfma_f32_16x16x32_bf16 v[100:103],a[136:139],a[80:83],v[100:103]
ds_read_b64_tr_b16 a[124:125],v3 offset:12288
v_mfma_f32_16x16x32_bf16 v[100:103],a[132:135],a[76:79],v[100:103]
ds_read_b64_tr_b16 a[126:127],v3 offset:18432
v_mfma_f32_16x16x32_bf16 v[100:103],a[128:131],a[72:75],v[100:103]
v_mfma_f32_16x16x32_bf16 v[108:111],a[128:131],a[96:99],0
ds_read_b64_tr_b16 a[128:129],v4 offset:12288
v_mfma_f32_16x16x32_bf16 v[108:111],a[132:135],a[100:103],v[108:111]
ds_read_b64_tr_b16 a[130:131],v4 offset:18432
v_mfma_f32_16x16x32_bf16 v[108:111],a[136:139],a[104:107],v[108:111]
ds_read_b64_tr_b16 a[132:133],v5 offset:12288
v_mfma_f32_16x16x32_bf16 v[108:111],a[140:143],a[108:111],v[108:111]
ds_read_b64_tr_b16 a[134:135],v5 offset:18432
v_mfma_f32_16x16x32_bf16 v[108:111],a[144:147],a[112:115],v[108:111]
v_mfma_f32_16x16x32_bf16 v[108:111],a[148:151],a[116:119],v[108:111]
s_waitcnt lgkmcnt(4)
v_mfma_f32_16x16x32_bf16 v[160:163],a[120:123],v[20:23],v[160:163]
s_add_u32 m0,s23,12288
ds_read_b64_tr_b16 a[136:137],v2 offset:12416
v_mbcnt_lo_u32_b32 v19,-1,0
v_mfma_f32_16x16x32_bf16 v[164:167],a[124:127],v[20:23],v[164:167]
ds_read_b64_tr_b16 a[138:139],v2 offset:18560
v_mbcnt_hi_u32_b32 v19,-1,v19
v_mfma_f32_16x16x32_bf16 v[212:215],a[124:127],v[24:27],v[212:215]
ds_read_b64_tr_b16 a[140:141],v3 offset:12416
v_min_u32 v19,7,v19
v_mfma_f32_16x16x32_bf16 v[208:211],a[120:123],v[24:27],v[208:211]
ds_read_b64_tr_b16 a[142:143],v3 offset:18560
v_lshl_add_u32 v19,v19,7,s48
v_mfma_f32_16x16x32_bf16 v[112:115],a[120:123],v[28:31],v[112:115]
ds_read_b64_tr_b16 a[144:145],v4 offset:12416
v_min_u32 v19,L_codeend-L_first-4,v19
v_mfma_f32_16x16x32_bf16 v[116:119],a[124:127],v[28:31],v[116:119]
ds_read_b64_tr_b16 a[146:147],v4 offset:18560
v_fma_f32 v90,v90,s36,v15
v_mfma_f32_16x16x32_bf16 a[164:167],a[124:127],v[32:35],a[164:167]
ds_read_b64_tr_b16 a[148:149],v5 offset:12416
v_fma_f32 v91,v91,s36,v15
v_mfma_f32_16x16x32_bf16 a[160:163],a[120:123],v[32:35],a[160:163]
ds_read_b64_tr_b16 a[150:151],v5 offset:18560
v_fma_f32 v96,v96,s36,v16
v_mfma_f32_16x16x32_bf16 a[208:211],a[120:123],v[36:39],a[208:211]
ds_read_b64_tr_b16 a[120:121],v2 offset:12544
v_fma_f32 v97,v97,s36,v16
v_mfma_f32_16x16x32_bf16 a[212:215],a[124:127],v[36:39],a[212:215]
s_waitcnt lgkmcnt(6)
ds_read_b64_tr_b16 a[122:123],v2 offset:18688
v_fma_f32 v98,v98,s36,v16
v_mfma_f32_16x16x32_bf16 a[216:219],a[128:131],v[36:39],a[216:219]
ds_read_b64_tr_b16 a[124:125],v3 offset:12544
v_fma_f32 v99,v99,s36,v16
v_mfma_f32_16x16x32_bf16 a[220:223],a[132:135],v[36:39],a[220:223]
ds_read_b64_tr_b16 a[126:127],v3 offset:18688
v_fma_f32 v104,v104,s36,v17
v_mfma_f32_16x16x32_bf16 a[172:175],a[132:135],v[32:35],a[172:175]
v_exp_f32 v90,v90
v_mfma_f32_16x16x32_bf16 a[168:171],a[128:131],v[32:35],a[168:171]
v_exp_f32 v91,v91
v_mfma_f32_16x16x32_bf16 v[120:123],a[128:131],v[28:31],v[120:123]
v_cvt_pk_bf16_f32 v53,v90,v91
v_fma_f32 v105,v105,s36,v17
v_mfma_f32_16x16x32_bf16 v[124:127],a[132:135],v[28:31],v[124:127]
v_exp_f32 v96,v96
v_mfma_f32_16x16x32_bf16 v[220:223],a[132:135],v[24:27],v[220:223]
v_exp_f32 v97,v97
v_mfma_f32_16x16x32_bf16 v[216:219],a[128:131],v[24:27],v[216:219]
v_exp_f32 v98,v98
v_mfma_f32_16x16x32_bf16 v[168:171],a[128:131],v[20:23],v[168:171]
global_load_dword v19,v19,s[46:47]
v_mfma_f32_16x16x32_bf16 v[172:175],a[132:135],v[20:23],v[172:175]
ds_read_b64_tr_b16 a[128:129],v4 offset:12544
v_cvt_pk_bf16_f32 v56,v96,v97
v_mfma_f32_16x16x32_bf16 v[176:179],a[136:139],v[20:23],v[176:179]
s_waitcnt lgkmcnt(1)
ds_read_b64_tr_b16 a[130:131],v4 offset:18688
v_fma_f32 v106,v106,s36,v17
v_mfma_f32_16x16x32_bf16 v[180:183],a[140:143],v[20:23],v[180:183]
ds_read_b64_tr_b16 a[132:133],v5 offset:12544
v_fma_f32 v107,v107,s36,v17
v_mfma_f32_16x16x32_bf16 v[228:231],a[140:143],v[24:27],v[228:231]
ds_read_b64_tr_b16 a[134:135],v5 offset:18688
v_fma_f32 v76,v76,s36,v13
v_mfma_f32_16x16x32_bf16 v[224:227],a[136:139],v[24:27],v[224:227]
v_exp_f32 v99,v99
v_mfma_f32_16x16x32_bf16 v[128:131],a[136:139],v[28:31],v[128:131]
v_cvt_pk_bf16_f32 v57,v98,v99
v_fma_f32 v77,v77,s36,v13
v_mfma_f32_16x16x32_bf16 v[132:135],a[140:143],v[28:31],v[132:135]
v_exp_f32 v104,v104
v_mfma_f32_16x16x32_bf16 a[180:183],a[140:143],v[32:35],a[180:183]
v_exp_f32 v105,v105
v_mfma_f32_16x16x32_bf16 a[176:179],a[136:139],v[32:35],a[176:179]
v_exp_f32 v106,v106
v_mfma_f32_16x16x32_bf16 a[224:227],a[136:139],v[36:39],a[224:227]
v_exp_f32 v107,v107
v_mfma_f32_16x16x32_bf16 a[228:231],a[140:143],v[36:39],a[228:231]
v_cvt_pk_bf16_f32 v40,v104,v105
v_cvt_pk_bf16_f32 v41,v106,v107
v_mfma_f32_16x16x32_bf16 a[232:235],a[144:147],v[36:39],a[232:235]
v_fma_f32 v78,v78,s36,v13
v_fma_f32 v79,v79,s36,v13
v_mfma_f32_16x16x32_bf16 a[236:239],a[148:151],v[36:39],a[236:239]
v_exp_f32 v76,v76
v_mfma_f32_16x16x32_bf16 a[188:191],a[148:151],v[32:35],a[188:191]
v_exp_f32 v77,v77
v_mfma_f32_16x16x32_bf16 a[184:187],a[144:147],v[32:35],a[184:187]
v_exp_f32 v78,v78
v_mfma_f32_16x16x32_bf16 v[136:139],a[144:147],v[28:31],v[136:139]
v_exp_f32 v79,v79
v_mfma_f32_16x16x32_bf16 v[140:143],a[148:151],v[28:31],v[140:143]
v_cvt_pk_bf16_f32 v46,v76,v77
v_cvt_pk_bf16_f32 v47,v78,v79
v_mfma_f32_16x16x32_bf16 v[236:239],a[148:151],v[24:27],v[236:239]
v_fma_f32 v84,v84,s36,v14
v_fma_f32 v85,v85,s36,v14
v_mfma_f32_16x16x32_bf16 v[232:235],a[144:147],v[24:27],v[232:235]
v_fma_f32 v86,v86,s36,v14
v_fma_f32 v87,v87,s36,v14
v_mfma_f32_16x16x32_bf16 v[184:187],a[144:147],v[20:23],v[184:187]
v_exp_f32 v84,v84
v_mfma_f32_16x16x32_bf16 v[188:191],a[148:151],v[20:23],v[188:191]
v_exp_f32 v85,v85
v_mfma_f32_16x16x32_bf16 v[192:195],a[120:123],v[20:23],v[192:195]
v_exp_f32 v86,v86
v_mfma_f32_16x16x32_bf16 v[196:199],a[124:127],v[20:23],v[196:199]
s_waitcnt vmcnt(10) lgkmcnt(0)
v_cvt_pk_bf16_f32 v50,v84,v85
v_mfma_f32_16x16x32_bf16 v[244:247],a[124:127],v[24:27],v[244:247]
s_barrier
v_mfma_f32_16x16x32_bf16 v[240:243],a[120:123],v[24:27],v[240:243]
ds_read_b128 a[136:139],v0 offset:0
v_fma_f32 v92,v92,s36,v15
v_mfma_f32_16x16x32_bf16 v[144:147],a[120:123],v[28:31],v[144:147]
ds_read_b128 a[140:143],v1 offset:0
v_fma_f32 v93,v93,s36,v15
v_mfma_f32_16x16x32_bf16 v[148:151],a[124:127],v[28:31],v[148:151]
ds_read_b128 a[144:147],v0 offset:128
v_fma_f32 v94,v94,s36,v15
v_mfma_f32_16x16x32_bf16 a[196:199],a[124:127],v[32:35],a[196:199]
ds_read_b128 a[148:151],v1 offset:128
v_fma_f32 v95,v95,s36,v15
v_mfma_f32_16x16x32_bf16 a[192:195],a[120:123],v[32:35],a[192:195]
ds_read_b128 a[156:159],v10 offset:3072
v_fma_f32 v100,v100,s36,v16
v_mfma_f32_16x16x32_bf16 a[240:243],a[120:123],v[36:39],a[240:243]
buffer_load_dwordx4 v6,s[8:11],s21 offen offset:0 lds
v_mfma_f32_16x16x32_bf16 a[244:247],a[124:127],v[36:39],a[244:247]
ds_read_b128 a[120:123],v0 offset:256
v_fma_f32 v101,v101,s36,v16
v_mfma_f32_16x16x32_bf16 a[248:251],a[128:131],v[36:39],a[248:251]
ds_read_b128 a[124:127],v1 offset:256
v_fma_f32 v102,v102,s36,v16
v_mfma_f32_16x16x32_bf16 a[252:255],a[132:135],v[36:39],a[252:255]
v_exp_f32 v87,v87
v_mfma_f32_16x16x32_bf16 a[204:207],a[132:135],v[32:35],a[204:207]
v_cvt_pk_bf16_f32 v51,v86,v87
v_fma_f32 v103,v103,s36,v16
v_mfma_f32_16x16x32_bf16 a[200:203],a[128:131],v[32:35],a[200:203]
v_exp_f32 v92,v92
v_smfmac_f32_16x16x64_bf16 v[60:63],a[152:155],v[44:51],v18
v_fma_f32 v108,v108,s36,v17
v_mfma_f32_16x16x32_bf16 v[152:155],a[128:131],v[28:31],v[152:155]
v_exp_f32 v93,v93
v_mfma_f32_16x16x32_bf16 v[156:159],a[132:135],v[28:31],v[156:159]
v_exp_f32 v94,v94
v_mfma_f32_16x16x32_bf16 v[252:255],a[132:135],v[24:27],v[252:255]
v_exp_f32 v95,v95
v_mfma_f32_16x16x32_bf16 v[248:251],a[128:131],v[24:27],v[248:251]
v_cvt_pk_bf16_f32 v54,v92,v93
v_cvt_pk_bf16_f32 v55,v94,v95
v_mfma_f32_16x16x32_bf16 v[200:203],a[128:131],v[20:23],v[200:203]
ds_read_b128 a[128:131],v0 offset:6144
v_fma_f32 v109,v109,s36,v17
v_mfma_f32_16x16x32_bf16 v[204:207],a[132:135],v[20:23],v[204:207]
s_waitcnt lgkmcnt(1)
buffer_store_dwordx4 a[156:159],v9,s[16:19],s27 offen offset:0 nt
buffer_load_dwordx4 v7,s[8:11],s21 offen offset:1024 lds
v_mfma_f32_16x16x32_bf16 v[72:75],a[136:139],a[0:3],0
ds_read_b128 a[132:135],v1 offset:6144
v_fma_f32 v110,v110,s36,v17
v_mfma_f32_16x16x32_bf16 v[72:75],a[140:143],a[4:7],v[72:75]
v_exp_f32 v100,v100
v_mfma_f32_16x16x32_bf16 v[72:75],a[144:147],a[8:11],v[72:75]
v_exp_f32 v101,v101
v_mfma_f32_16x16x32_bf16 v[72:75],a[148:151],a[12:15],v[72:75]
v_exp_f32 v102,v102
v_mfma_f32_16x16x32_bf16 v[72:75],a[120:123],a[16:19],v[72:75]
v_exp_f32 v103,v103
v_mfma_f32_16x16x32_bf16 v[72:75],a[124:127],a[20:23],v[72:75]
ds_read_b128 a[156:159],v10 offset:4096
v_cvt_pk_bf16_f32 v58,v100,v101
v_mfma_f32_16x16x32_bf16 v[80:83],a[124:127],a[44:47],0
v_cvt_pk_bf16_f32 v59,v102,v103
v_fma_f32 v111,v111,s36,v17
v_mfma_f32_16x16x32_bf16 v[80:83],a[120:123],a[40:43],v[80:83]
v_exp_f32 v108,v108
v_smfmac_f32_16x16x64_bf16 v[64:67],a[152:155],v[52:59],v18
v_fma_f32 v72,v72,s36,v13
v_mfma_f32_16x16x32_bf16 v[80:83],a[148:151],a[36:39],v[80:83]
buffer_load_dwordx4 v8,s[8:11],s21 offen offset:2048 lds
v_mfma_f32_16x16x32_bf16 v[80:83],a[144:147],a[32:35],v[80:83]
s_add_u32 s21,s21,12288
v_exp_f32 v109,v109
v_mfma_f32_16x16x32_bf16 v[80:83],a[140:143],a[28:31],v[80:83]
s_add_u32 m0,s22,24576
v_exp_f32 v110,v110
v_mfma_f32_16x16x32_bf16 v[80:83],a[136:139],a[24:27],v[80:83]
v_exp_f32 v111,v111
v_mfma_f32_16x16x32_bf16 v[88:91],a[136:139],a[48:51],0
v_cvt_pk_bf16_f32 v42,v108,v109
v_cvt_pk_bf16_f32 v43,v110,v111
v_mfma_f32_16x16x32_bf16 v[88:91],a[140:143],a[52:55],v[88:91]
v_fma_f32 v73,v73,s36,v13
v_fma_f32 v74,v74,s36,v13
v_smfmac_f32_16x16x64_bf16 v[68:71],a[152:155],v[36:43],v18
v_fma_f32 v75,v75,s36,v13
v_mfma_f32_16x16x32_bf16 v[88:91],a[144:147],a[56:59],v[88:91]
v_fma_f32 v80,v80,s36,v14
v_fma_f32 v81,v81,s36,v14
v_mfma_f32_16x16x32_bf16 v[88:91],a[148:151],a[60:63],v[88:91]
v_fma_f32 v82,v82,s36,v14
v_fma_f32 v83,v83,s36,v14
v_mfma_f32_16x16x32_bf16 v[88:91],a[120:123],a[64:67],v[88:91]
v_exp_f32 v72,v72
v_mfma_f32_16x16x32_bf16 v[88:91],a[124:127],a[68:71],v[88:91]
v_exp_f32 v73,v73
v_mfma_f32_16x16x32_bf16 v[96:99],a[124:127],a[92:95],0
v_exp_f32 v74,v74
v_mfma_f32_16x16x32_bf16 v[96:99],a[120:123],a[88:91],v[96:99]
s_waitcnt lgkmcnt(0)
buffer_store_dwordx4 a[156:159],v9,s[16:19],s27 offen offset:128 nt
buffer_load_dwordx4 v6,s[4:7],s20 offen offset:0 lds
v_mfma_f32_16x16x32_bf16 v[96:99],a[148:151],a[84:87],v[96:99]
v_exp_f32 v75,v75
v_mfma_f32_16x16x32_bf16 v[96:99],a[144:147],a[80:83],v[96:99]
v_fma_f32 v88,v88,s36,v15
v_fma_f32 v89,v89,s36,v15
v_mfma_f32_16x16x32_bf16 v[96:99],a[140:143],a[76:79],v[96:99]
v_exp_f32 v80,v80
v_mfma_f32_16x16x32_bf16 v[96:99],a[136:139],a[72:75],v[96:99]
v_exp_f32 v81,v81
v_mfma_f32_16x16x32_bf16 v[104:107],a[136:139],a[96:99],0
ds_read_b128 a[136:139],v0 offset:6272
v_cvt_pk_bf16_f32 v20,v72,v73
v_mfma_f32_16x16x32_bf16 v[104:107],a[140:143],a[100:103],v[104:107]
ds_read_b128 a[156:159],v10 offset:5120
v_cvt_pk_bf16_f32 v21,v74,v75
v_mfma_f32_16x16x32_bf16 v[104:107],a[144:147],a[104:107],v[104:107]
ds_read_b128 a[140:143],v1 offset:6272
v_cvt_pk_bf16_f32 v24,v80,v81
v_mfma_f32_16x16x32_bf16 v[104:107],a[148:151],a[108:111],v[104:107]
ds_read_b128 a[144:147],v0 offset:6400
v_mfma_f32_16x16x32_bf16 v[104:107],a[120:123],a[112:115],v[104:107]
ds_read_b128 a[148:151],v1 offset:6400
v_mfma_f32_16x16x32_bf16 v[104:107],a[124:127],a[116:119],v[104:107]
buffer_load_dwordx4 v7,s[4:7],s20 offen offset:1024 lds
v_mfma_f32_16x16x32_bf16 v[76:79],a[128:131],a[0:3],0
v_exp_f32 v82,v82
v_mfma_f32_16x16x32_bf16 v[76:79],a[132:135],a[4:7],v[76:79]
s_waitcnt lgkmcnt(4)
v_exp_f32 v83,v83
v_mfma_f32_16x16x32_bf16 v[76:79],a[136:139],a[8:11],v[76:79]
s_waitcnt lgkmcnt(2)
v_exp_f32 v88,v88
v_exp_f32 v89,v89
v_mfma_f32_16x16x32_bf16 v[76:79],a[140:143],a[12:15],v[76:79]
s_waitcnt lgkmcnt(1)
v_cvt_pk_bf16_f32 v25,v82,v83
v_cvt_pk_bf16_f32 v28,v88,v89
v_mfma_f32_16x16x32_bf16 v[76:79],a[144:147],a[16:19],v[76:79]
s_waitcnt lgkmcnt(0)
v_mfma_f32_16x16x32_bf16 v[76:79],a[148:151],a[20:23],v[76:79]
v_mfma_f32_16x16x32_bf16 v[84:87],a[148:151],a[44:47],0
v_mfma_f32_16x16x32_bf16 v[84:87],a[144:147],a[40:43],v[84:87]
v_mfma_f32_16x16x32_bf16 v[84:87],a[140:143],a[36:39],v[84:87]
v_mfma_f32_16x16x32_bf16 v[84:87],a[136:139],a[32:35],v[84:87]
v_mfma_f32_16x16x32_bf16 v[84:87],a[132:135],a[28:31],v[84:87]
buffer_store_dwordx4 a[156:159],v9,s[16:19],s27 offen offset:256 nt
buffer_load_dwordx4 v8,s[4:7],s20 offen offset:2048 lds
v_mfma_f32_16x16x32_bf16 v[84:87],a[128:131],a[24:27],v[84:87]
s_add_u32 s20,s20,12288
v_mfma_f32_16x16x32_bf16 v[92:95],a[128:131],a[48:51],0
s_add_u32 s27,s27,3072
v_mfma_f32_16x16x32_bf16 v[92:95],a[132:135],a[52:55],v[92:95]
v_mfma_f32_16x16x32_bf16 v[92:95],a[136:139],a[56:59],v[92:95]
v_mfma_f32_16x16x32_bf16 v[92:95],a[140:143],a[60:63],v[92:95]
ds_read_b64_tr_b16 a[120:121],v2 offset:24576
v_mfma_f32_16x16x32_bf16 v[92:95],a[144:147],a[64:67],v[92:95]
ds_read_b64_tr_b16 a[122:123],v2 offset:30720
v_mfma_f32_16x16x32_bf16 v[92:95],a[148:151],a[68:71],v[92:95]
v_mfma_f32_16x16x32_bf16 v[100:103],a[148:151],a[92:95],0
ds_read_b64_tr_b16 a[124:125],v3 offset:24576
v_mfma_f32_16x16x32_bf16 v[100:103],a[144:147],a[88:91],v[100:103]
ds_read_b64_tr_b16 a[126:127],v3 offset:30720
v_mfma_f32_16x16x32_bf16 v[100:103],a[140:143],a[84:87],v[100:103]
v_mfma_f32_16x16x32_bf16 v[100:103],a[136:139],a[80:83],v[100:103]
v_mfma_f32_16x16x32_bf16 v[100:103],a[132:135],a[76:79],v[100:103]
v_mfma_f32_16x16x32_bf16 v[100:103],a[128:131],a[72:75],v[100:103]
v_mfma_f32_16x16x32_bf16 v[108:111],a[128:131],a[96:99],0
ds_read_b64_tr_b16 a[128:129],v4 offset:24576
v_mfma_f32_16x16x32_bf16 v[108:111],a[132:135],a[100:103],v[108:111]
ds_read_b64_tr_b16 a[130:131],v4 offset:30720
v_mfma_f32_16x16x32_bf16 v[108:111],a[136:139],a[104:107],v[108:111]
ds_read_b64_tr_b16 a[132:133],v5 offset:24576
v_mfma_f32_16x16x32_bf16 v[108:111],a[140:143],a[108:111],v[108:111]
ds_read_b64_tr_b16 a[134:135],v5 offset:30720
v_mfma_f32_16x16x32_bf16 v[108:111],a[144:147],a[112:115],v[108:111]
v_mfma_f32_16x16x32_bf16 v[108:111],a[148:151],a[116:119],v[108:111]
s_waitcnt lgkmcnt(4)
v_mfma_f32_16x16x32_bf16 v[160:163],a[120:123],v[44:47],v[160:163]
s_add_u32 m0,s29,0
ds_read_b64_tr_b16 a[136:137],v2 offset:24704
v_fma_f32 v90,v90,s36,v15
v_mfma_f32_16x16x32_bf16 v[164:167],a[124:127],v[44:47],v[164:167]
ds_read_b64_tr_b16 a[138:139],v2 offset:30848
v_fma_f32 v91,v91,s36,v15
v_mfma_f32_16x16x32_bf16 v[212:215],a[124:127],v[48:51],v[212:215]
ds_read_b64_tr_b16 a[140:141],v3 offset:24704
v_fma_f32 v96,v96,s36,v16
v_mfma_f32_16x16x32_bf16 v[208:211],a[120:123],v[48:51],v[208:211]
ds_read_b64_tr_b16 a[142:143],v3 offset:30848
v_fma_f32 v97,v97,s36,v16
v_mfma_f32_16x16x32_bf16 v[112:115],a[120:123],v[52:55],v[112:115]
ds_read_b64_tr_b16 a[144:145],v4 offset:24704
v_fma_f32 v98,v98,s36,v16
v_mfma_f32_16x16x32_bf16 v[116:119],a[124:127],v[52:55],v[116:119]
ds_read_b64_tr_b16 a[146:147],v4 offset:30848
v_fma_f32 v99,v99,s36,v16
v_mfma_f32_16x16x32_bf16 a[164:167],a[124:127],v[56:59],a[164:167]
ds_read_b64_tr_b16 a[148:149],v5 offset:24704
v_fma_f32 v104,v104,s36,v17
v_mfma_f32_16x16x32_bf16 a[160:163],a[120:123],v[56:59],a[160:163]
buffer_load_dwordx4 v6,s[12:15],s28 offen offset:0 nt lds
v_mfma_f32_16x16x32_bf16 a[208:211],a[120:123],v[40:43],a[208:211]
ds_read_b64_tr_b16 a[150:151],v5 offset:30848
v_fma_f32 v105,v105,s36,v17
v_mfma_f32_16x16x32_bf16 a[212:215],a[124:127],v[40:43],a[212:215]
s_waitcnt lgkmcnt(5)
ds_read_b64_tr_b16 a[120:121],v2 offset:24832
v_fma_f32 v106,v106,s36,v17
v_mfma_f32_16x16x32_bf16 a[216:219],a[128:131],v[40:43],a[216:219]
ds_read_b64_tr_b16 a[122:123],v2 offset:30976
v_fma_f32 v107,v107,s36,v17
v_mfma_f32_16x16x32_bf16 a[220:223],a[132:135],v[40:43],a[220:223]
ds_read_b64_tr_b16 a[124:125],v3 offset:24832
v_fma_f32 v76,v76,s36,v13
v_mfma_f32_16x16x32_bf16 a[172:175],a[132:135],v[56:59],a[172:175]
ds_read_b64_tr_b16 a[126:127],v3 offset:30976
v_fma_f32 v77,v77,s36,v13
v_mfma_f32_16x16x32_bf16 a[168:171],a[128:131],v[56:59],a[168:171]
v_exp_f32 v90,v90
v_mfma_f32_16x16x32_bf16 v[120:123],a[128:131],v[52:55],v[120:123]
v_exp_f32 v91,v91
v_mfma_f32_16x16x32_bf16 v[124:127],a[132:135],v[52:55],v[124:127]
v_cvt_pk_bf16_f32 v29,v90,v91
v_fma_f32 v78,v78,s36,v13
v_mfma_f32_16x16x32_bf16 v[220:223],a[132:135],v[48:51],v[220:223]
v_exp_f32 v96,v96
v_mfma_f32_16x16x32_bf16 v[216:219],a[128:131],v[48:51],v[216:219]
buffer_load_dwordx4 v7,s[12:15],s28 offen offset:1024 nt lds
v_mfma_f32_16x16x32_bf16 v[168:171],a[128:131],v[44:47],v[168:171]
ds_read_b64_tr_b16 a[128:129],v4 offset:24832
v_fma_f32 v79,v79,s36,v13
v_mfma_f32_16x16x32_bf16 v[172:175],a[132:135],v[44:47],v[172:175]
ds_read_b64_tr_b16 a[130:131],v4 offset:30976
v_fma_f32 v84,v84,s36,v14
v_mfma_f32_16x16x32_bf16 v[176:179],a[136:139],v[44:47],v[176:179]
s_waitcnt lgkmcnt(2)
ds_read_b64_tr_b16 a[132:133],v5 offset:24832
v_fma_f32 v85,v85,s36,v14
v_mfma_f32_16x16x32_bf16 v[180:183],a[140:143],v[44:47],v[180:183]
ds_read_b64_tr_b16 a[134:135],v5 offset:30976
v_fma_f32 v86,v86,s36,v14
v_mfma_f32_16x16x32_bf16 v[228:231],a[140:143],v[48:51],v[228:231]
v_exp_f32 v97,v97
v_mfma_f32_16x16x32_bf16 v[224:227],a[136:139],v[48:51],v[224:227]
v_exp_f32 v98,v98
v_mfma_f32_16x16x32_bf16 v[128:131],a[136:139],v[52:55],v[128:131]
v_exp_f32 v99,v99
v_mfma_f32_16x16x32_bf16 v[132:135],a[140:143],v[52:55],v[132:135]
v_cvt_pk_bf16_f32 v32,v96,v97
v_cvt_pk_bf16_f32 v33,v98,v99
v_mfma_f32_16x16x32_bf16 a[180:183],a[140:143],v[56:59],a[180:183]
v_exp_f32 v104,v104
v_mfma_f32_16x16x32_bf16 a[176:179],a[136:139],v[56:59],a[176:179]
buffer_load_dwordx4 v8,s[12:15],s28 offen offset:2048 nt lds
v_mfma_f32_16x16x32_bf16 a[224:227],a[136:139],v[40:43],a[224:227]
s_add_u32 s28,s28,3072
v_exp_f32 v105,v105
v_mfma_f32_16x16x32_bf16 a[228:231],a[140:143],v[40:43],a[228:231]
s_add_u32 s29,s29,3072
v_exp_f32 v106,v106
v_mfma_f32_16x16x32_bf16 a[232:235],a[144:147],v[40:43],a[232:235]
s_add_u32 m0,s23,24576
v_exp_f32 v107,v107
v_mfma_f32_16x16x32_bf16 a[236:239],a[148:151],v[40:43],a[236:239]
v_cvt_pk_bf16_f32 v36,v104,v105
v_cvt_pk_bf16_f32 v37,v106,v107
v_mfma_f32_16x16x32_bf16 a[188:191],a[148:151],v[56:59],a[188:191]
v_exp_f32 v76,v76
v_mfma_f32_16x16x32_bf16 a[184:187],a[144:147],v[56:59],a[184:187]
v_exp_f32 v77,v77
v_mfma_f32_16x16x32_bf16 v[136:139],a[144:147],v[52:55],v[136:139]
v_exp_f32 v78,v78
v_mfma_f32_16x16x32_bf16 v[140:143],a[148:151],v[52:55],v[140:143]
v_exp_f32 v79,v79
v_mfma_f32_16x16x32_bf16 v[236:239],a[148:151],v[48:51],v[236:239]
v_cvt_pk_bf16_f32 v22,v76,v77
v_cvt_pk_bf16_f32 v23,v78,v79
v_mfma_f32_16x16x32_bf16 v[232:235],a[144:147],v[48:51],v[232:235]
v_fma_f32 v87,v87,s36,v14
v_fma_f32 v92,v92,s36,v15
v_mfma_f32_16x16x32_bf16 v[184:187],a[144:147],v[44:47],v[184:187]
v_exp_f32 v84,v84
v_mfma_f32_16x16x32_bf16 v[188:191],a[148:151],v[44:47],v[188:191]
v_exp_f32 v85,v85
v_mfma_f32_16x16x32_bf16 v[192:195],a[120:123],v[44:47],v[192:195]
v_exp_f32 v86,v86
v_mfma_f32_16x16x32_bf16 v[196:199],a[124:127],v[44:47],v[196:199]
s_waitcnt vmcnt(13) lgkmcnt(0)
v_exp_f32 v87,v87
v_mfma_f32_16x16x32_bf16 v[244:247],a[124:127],v[48:51],v[244:247]
s_barrier
v_mfma_f32_16x16x32_bf16 v[240:243],a[120:123],v[48:51],v[240:243]
ds_read_b128 a[136:139],v0 offset:12288
v_cvt_pk_bf16_f32 v26,v84,v85
v_mfma_f32_16x16x32_bf16 v[144:147],a[120:123],v[52:55],v[144:147]
ds_read_b128 a[140:143],v1 offset:12288
v_cvt_pk_bf16_f32 v27,v86,v87
v_mfma_f32_16x16x32_bf16 v[148:151],a[124:127],v[52:55],v[148:151]
ds_read_b128 a[144:147],v0 offset:12416
v_fma_f32 v93,v93,s36,v15
v_smfmac_f32_16x16x64_bf16 v[60:63],a[152:155],v[20:27],v18
ds_read_b128 a[148:151],v1 offset:12416
v_mfma_f32_16x16x32_bf16 a[196:199],a[124:127],v[56:59],a[196:199]
v_fma_f32 v94,v94,s36,v15
v_fma_f32 v95,v95,s36,v15
v_mfma_f32_16x16x32_bf16 a[192:195],a[120:123],v[56:59],a[192:195]
buffer_load_dwordx4 v6,s[8:11],s21 offen offset:0 lds
v_mfma_f32_16x16x32_bf16 a[240:243],a[120:123],v[40:43],a[240:243]
ds_read_b128 a[120:123],v0 offset:12544
v_fma_f32 v100,v100,s36,v16
v_mfma_f32_16x16x32_bf16 a[244:247],a[124:127],v[40:43],a[244:247]
ds_read_b128 a[124:127],v1 offset:12544
v_fma_f32 v101,v101,s36,v16
v_mfma_f32_16x16x32_bf16 a[248:251],a[128:131],v[40:43],a[248:251]
v_exp_f32 v92,v92
v_mfma_f32_16x16x32_bf16 a[252:255],a[132:135],v[40:43],a[252:255]
v_exp_f32 v93,v93
v_mfma_f32_16x16x32_bf16 a[204:207],a[132:135],v[56:59],a[204:207]
v_exp_f32 v94,v94
v_mfma_f32_16x16x32_bf16 a[200:203],a[128:131],v[56:59],a[200:203]
v_exp_f32 v95,v95
v_mfma_f32_16x16x32_bf16 v[152:155],a[128:131],v[52:55],v[152:155]
v_cvt_pk_bf16_f32 v30,v92,v93
v_cvt_pk_bf16_f32 v31,v94,v95
v_mfma_f32_16x16x32_bf16 v[156:159],a[132:135],v[52:55],v[156:159]
v_fma_f32 v102,v102,s36,v16
v_fma_f32 v103,v103,s36,v16
v_mfma_f32_16x16x32_bf16 v[252:255],a[132:135],v[48:51],v[252:255]
v_exp_f32 v100,v100
v_mfma_f32_16x16x32_bf16 v[248:251],a[128:131],v[48:51],v[248:251]
v_exp_f32 v101,v101
v_mfma_f32_16x16x32_bf16 v[200:203],a[128:131],v[44:47],v[200:203]
buffer_load_dwordx4 v7,s[8:11],s21 offen offset:1024 lds
v_mfma_f32_16x16x32_bf16 v[204:207],a[132:135],v[44:47],v[204:207]
s_waitcnt lgkmcnt(0)
ds_read_b128 a[128:131],v0 offset:18432
v_cvt_pk_bf16_f32 v34,v100,v101
v_mfma_f32_16x16x32_bf16 v[72:75],a[136:139],a[0:3],0
ds_read_b128 a[132:135],v1 offset:18432
v_fma_f32 v108,v108,s36,v17
v_mfma_f32_16x16x32_bf16 v[72:75],a[140:143],a[4:7],v[72:75]
v_exp_f32 v102,v102
v_mfma_f32_16x16x32_bf16 v[72:75],a[144:147],a[8:11],v[72:75]
v_exp_f32 v103,v103
v_mfma_f32_16x16x32_bf16 v[72:75],a[148:151],a[12:15],v[72:75]
v_cvt_pk_bf16_f32 v35,v102,v103
v_fma_f32 v109,v109,s36,v17
v_mfma_f32_16x16x32_bf16 v[72:75],a[120:123],a[16:19],v[72:75]
v_fma_f32 v110,v110,s36,v17
v_fma_f32 v111,v111,s36,v17
v_smfmac_f32_16x16x64_bf16 v[64:67],a[152:155],v[28:35],v18
v_mfma_f32_16x16x32_bf16 v[72:75],a[124:127],a[20:23],v[72:75]
v_exp_f32 v108,v108
v_mfma_f32_16x16x32_bf16 v[80:83],a[124:127],a[44:47],0
v_exp_f32 v109,v109
v_mfma_f32_16x16x32_bf16 v[80:83],a[120:123],a[40:43],v[80:83]
v_exp_f32 v110,v110
v_mfma_f32_16x16x32_bf16 v[80:83],a[148:151],a[36:39],v[80:83]
v_exp_f32 v111,v111
v_mfma_f32_16x16x32_bf16 v[80:83],a[144:147],a[32:35],v[80:83]
buffer_load_dwordx4 v8,s[8:11],s21 offen offset:2048 lds
v_mfma_f32_16x16x32_bf16 v[80:83],a[140:143],a[28:31],v[80:83]
s_add_u32 s21,s21,12288
v_cvt_pk_bf16_f32 v38,v108,v109
v_cvt_pk_bf16_f32 v39,v110,v111
v_mfma_f32_16x16x32_bf16 v[80:83],a[136:139],a[24:27],v[80:83]
s_add_u32 m0,s22,0
v_fma_f32 v72,v72,s36,v13
v_fma_f32 v73,v73,s36,v13
v_mfma_f32_16x16x32_bf16 v[88:91],a[136:139],a[48:51],0
v_fma_f32 v74,v74,s36,v13
v_fma_f32 v75,v75,s36,v13
v_mfma_f32_16x16x32_bf16 v[88:91],a[140:143],a[52:55],v[88:91]
v_exp_f32 v72,v72
v_mfma_f32_16x16x32_bf16 v[88:91],a[144:147],a[56:59],v[88:91]
v_fma_f32 v80,v80,s36,v14
v_fma_f32 v81,v81,s36,v14
v_mfma_f32_16x16x32_bf16 v[88:91],a[148:151],a[60:63],v[88:91]
v_fma_f32 v82,v82,s36,v14
v_fma_f32 v83,v83,s36,v14
v_mfma_f32_16x16x32_bf16 v[88:91],a[120:123],a[64:67],v[88:91]
v_exp_f32 v73,v73
v_mfma_f32_16x16x32_bf16 v[88:91],a[124:127],a[68:71],v[88:91]
v_exp_f32 v74,v74
v_mfma_f32_16x16x32_bf16 v[96:99],a[124:127],a[92:95],0
v_exp_f32 v75,v75
v_mfma_f32_16x16x32_bf16 v[96:99],a[120:123],a[88:91],v[96:99]
v_exp_f32 v80,v80
v_mfma_f32_16x16x32_bf16 v[96:99],a[148:151],a[84:87],v[96:99]
buffer_load_dwordx4 v6,s[4:7],s20 offen offset:0 lds
v_mfma_f32_16x16x32_bf16 v[96:99],a[144:147],a[80:83],v[96:99]
v_fma_f32 v88,v88,s36,v15
v_fma_f32 v89,v89,s36,v15
v_mfma_f32_16x16x32_bf16 v[96:99],a[140:143],a[76:79],v[96:99]
v_exp_f32 v81,v81
v_mfma_f32_16x16x32_bf16 v[96:99],a[136:139],a[72:75],v[96:99]
v_exp_f32 v82,v82
v_mfma_f32_16x16x32_bf16 v[104:107],a[136:139],a[96:99],0
ds_read_b128 a[136:139],v0 offset:18560
v_cvt_pk_bf16_f32 v44,v72,v73
v_mfma_f32_16x16x32_bf16 v[104:107],a[140:143],a[100:103],v[104:107]
ds_read_b128 a[140:143],v1 offset:18560
v_cvt_pk_bf16_f32 v45,v74,v75
v_mfma_f32_16x16x32_bf16 v[104:107],a[144:147],a[104:107],v[104:107]
ds_read_b128 a[144:147],v0 offset:18688
v_cvt_pk_bf16_f32 v48,v80,v81
v_mfma_f32_16x16x32_bf16 v[104:107],a[148:151],a[108:111],v[104:107]
ds_read_b128 a[148:151],v1 offset:18688
v_mfma_f32_16x16x32_bf16 v[104:107],a[120:123],a[112:115],v[104:107]
v_exp_f32 v83,v83
v_mfma_f32_16x16x32_bf16 v[104:107],a[124:127],a[116:119],v[104:107]
s_waitcnt lgkmcnt(4)
v_exp_f32 v88,v88
v_mfma_f32_16x16x32_bf16 v[76:79],a[128:131],a[0:3],0
v_exp_f32 v89,v89
v_mfma_f32_16x16x32_bf16 v[76:79],a[132:135],a[4:7],v[76:79]
buffer_load_dwordx4 v7,s[4:7],s20 offen offset:1024 lds
s_waitcnt lgkmcnt(3)
v_mfma_f32_16x16x32_bf16 v[76:79],a[136:139],a[8:11],v[76:79]
s_waitcnt lgkmcnt(2)
v_cvt_pk_bf16_f32 v49,v82,v83
v_cvt_pk_bf16_f32 v52,v88,v89
v_mfma_f32_16x16x32_bf16 v[76:79],a[140:143],a[12:15],v[76:79]
s_waitcnt lgkmcnt(0)
v_mfma_f32_16x16x32_bf16 v[76:79],a[144:147],a[16:19],v[76:79]
v_mfma_f32_16x16x32_bf16 v[76:79],a[148:151],a[20:23],v[76:79]
v_mfma_f32_16x16x32_bf16 v[84:87],a[148:151],a[44:47],0
v_mfma_f32_16x16x32_bf16 v[84:87],a[144:147],a[40:43],v[84:87]
v_mfma_f32_16x16x32_bf16 v[84:87],a[140:143],a[36:39],v[84:87]
v_mfma_f32_16x16x32_bf16 v[84:87],a[136:139],a[32:35],v[84:87]
v_mfma_f32_16x16x32_bf16 v[84:87],a[132:135],a[28:31],v[84:87]
v_mfma_f32_16x16x32_bf16 v[84:87],a[128:131],a[24:27],v[84:87]
v_mfma_f32_16x16x32_bf16 v[92:95],a[128:131],a[48:51],0
v_mfma_f32_16x16x32_bf16 v[92:95],a[132:135],a[52:55],v[92:95]
buffer_load_dwordx4 v8,s[4:7],s20 offen offset:2048 lds
v_mfma_f32_16x16x32_bf16 v[92:95],a[136:139],a[56:59],v[92:95]
s_add_u32 s20,s20,12288
v_mfma_f32_16x16x32_bf16 v[92:95],a[140:143],a[60:63],v[92:95]
v_mfma_f32_16x16x32_bf16 v[92:95],a[144:147],a[64:67],v[92:95]
v_mfma_f32_16x16x32_bf16 v[92:95],a[148:151],a[68:71],v[92:95]
v_mfma_f32_16x16x32_bf16 v[100:103],a[148:151],a[92:95],0
ds_read_b64_tr_b16 a[120:121],v2 offset:0
v_mfma_f32_16x16x32_bf16 v[100:103],a[144:147],a[88:91],v[100:103]
ds_read_b64_tr_b16 a[122:123],v2 offset:6144
v_mfma_f32_16x16x32_bf16 v[100:103],a[140:143],a[84:87],v[100:103]
v_mfma_f32_16x16x32_bf16 v[100:103],a[136:139],a[80:83],v[100:103]
ds_read_b64_tr_b16 a[124:125],v3 offset:0
v_mfma_f32_16x16x32_bf16 v[100:103],a[132:135],a[76:79],v[100:103]
ds_read_b64_tr_b16 a[126:127],v3 offset:6144
v_mfma_f32_16x16x32_bf16 v[100:103],a[128:131],a[72:75],v[100:103]
v_mfma_f32_16x16x32_bf16 v[108:111],a[128:131],a[96:99],0
ds_read_b64_tr_b16 a[128:129],v4 offset:0
v_mfma_f32_16x16x32_bf16 v[108:111],a[132:135],a[100:103],v[108:111]
ds_read_b64_tr_b16 a[130:131],v4 offset:6144
v_mfma_f32_16x16x32_bf16 v[108:111],a[136:139],a[104:107],v[108:111]
ds_read_b64_tr_b16 a[132:133],v5 offset:0
v_mfma_f32_16x16x32_bf16 v[108:111],a[140:143],a[108:111],v[108:111]
ds_read_b64_tr_b16 a[134:135],v5 offset:6144
v_mfma_f32_16x16x32_bf16 v[108:111],a[144:147],a[112:115],v[108:111]
v_mfma_f32_16x16x32_bf16 v[108:111],a[148:151],a[116:119],v[108:111]
s_waitcnt lgkmcnt(4)
v_mfma_f32_16x16x32_bf16 v[160:163],a[120:123],v[20:23],v[160:163]
s_add_u32 m0,s23,0
ds_read_b64_tr_b16 a[136:137],v2 offset:128
v_fma_f32 v91,v91,s36,v15
v_mfma_f32_16x16x32_bf16 v[164:167],a[124:127],v[20:23],v[164:167]
ds_read_b64_tr_b16 a[138:139],v2 offset:6272
v_fma_f32 v90,v90,s36,v15
v_mfma_f32_16x16x32_bf16 v[212:215],a[124:127],v[24:27],v[212:215]
ds_read_b64_tr_b16 a[140:141],v3 offset:128
v_fma_f32 v98,v98,s36,v16
v_mfma_f32_16x16x32_bf16 v[208:211],a[120:123],v[24:27],v[208:211]
ds_read_b64_tr_b16 a[142:143],v3 offset:6272
v_fma_f32 v96,v96,s36,v16
v_mfma_f32_16x16x32_bf16 v[112:115],a[120:123],v[28:31],v[112:115]
ds_read_b64_tr_b16 a[146:147],v4 offset:6272
v_fma_f32 v97,v97,s36,v16
v_mfma_f32_16x16x32_bf16 v[116:119],a[124:127],v[28:31],v[116:119]
ds_read_b64_tr_b16 a[150:151],v5 offset:6272
v_fma_f32 v99,v99,s36,v16
v_mfma_f32_16x16x32_bf16 a[164:167],a[124:127],v[32:35],a[164:167]
ds_read_b64_tr_b16 a[144:145],v4 offset:128
v_fma_f32 v107,v107,s36,v17
v_mfma_f32_16x16x32_bf16 a[160:163],a[120:123],v[32:35],a[160:163]
ds_read_b64_tr_b16 a[148:149],v5 offset:128
v_fma_f32 v104,v104,s36,v17
v_mfma_f32_16x16x32_bf16 a[208:211],a[120:123],v[36:39],a[208:211]
ds_read_b64_tr_b16 a[120:121],v2 offset:256
v_fma_f32 v105,v105,s36,v17
v_mfma_f32_16x16x32_bf16 a[212:215],a[124:127],v[36:39],a[212:215]
s_waitcnt lgkmcnt(6)
ds_read_b64_tr_b16 a[124:125],v3 offset:256
v_fma_f32 v106,v106,s36,v17
v_mfma_f32_16x16x32_bf16 a[216:219],a[128:131],v[36:39],a[216:219]
ds_read_b64_tr_b16 a[122:123],v2 offset:6400
v_fma_f32 v76,v76,s36,v13
v_mfma_f32_16x16x32_bf16 a[220:223],a[132:135],v[36:39],a[220:223]
ds_read_b64_tr_b16 a[126:127],v3 offset:6400
v_fma_f32 v79,v79,s36,v13
v_mfma_f32_16x16x32_bf16 a[172:175],a[132:135],v[32:35],a[172:175]
v_exp_f32 v91,v91
v_mfma_f32_16x16x32_bf16 a[168:171],a[128:131],v[32:35],a[168:171]
v_exp_f32 v90,v90
v_mfma_f32_16x16x32_bf16 v[120:123],a[128:131],v[28:31],v[120:123]
v_cvt_pk_bf16_f32 v53,v90,v91
v_fma_f32 v78,v78,s36,v13
v_mfma_f32_16x16x32_bf16 v[124:127],a[132:135],v[28:31],v[124:127]
v_exp_f32 v96,v96
v_mfma_f32_16x16x32_bf16 v[220:223],a[132:135],v[24:27],v[220:223]
v_exp_f32 v97,v97
v_mfma_f32_16x16x32_bf16 v[216:219],a[128:131],v[24:27],v[216:219]
v_exp_f32 v98,v98
v_mfma_f32_16x16x32_bf16 v[168:171],a[128:131],v[20:23],v[168:171]
ds_read_b64_tr_b16 a[128:129],v4 offset:256
v_cvt_pk_bf16_f32 v56,v96,v97
v_mfma_f32_16x16x32_bf16 v[172:175],a[132:135],v[20:23],v[172:175]
ds_read_b64_tr_b16 a[130:131],v4 offset:6400
v_fma_f32 v77,v77,s36,v13
v_mfma_f32_16x16x32_bf16 v[176:179],a[136:139],v[20:23],v[176:179]
s_waitcnt lgkmcnt(2)
ds_read_b64_tr_b16 a[132:133],v5 offset:256
v_fma_f32 v86,v86,s36,v14
v_mfma_f32_16x16x32_bf16 v[180:183],a[140:143],v[20:23],v[180:183]
ds_read_b64_tr_b16 a[134:135],v5 offset:6400
v_fma_f32 v85,v85,s36,v14
v_mfma_f32_16x16x32_bf16 v[228:231],a[140:143],v[24:27],v[228:231]
v_exp_f32 v99,v99
v_mfma_f32_16x16x32_bf16 v[224:227],a[136:139],v[24:27],v[224:227]
v_cvt_pk_bf16_f32 v57,v98,v99
v_fma_f32 v84,v84,s36,v14
v_mfma_f32_16x16x32_bf16 v[128:131],a[136:139],v[28:31],v[128:131]
v_exp_f32 v104,v104
v_mfma_f32_16x16x32_bf16 v[132:135],a[140:143],v[28:31],v[132:135]
v_exp_f32 v105,v105
v_mfma_f32_16x16x32_bf16 a[180:183],a[140:143],v[32:35],a[180:183]
v_exp_f32 v107,v107
v_mfma_f32_16x16x32_bf16 a[176:179],a[136:139],v[32:35],a[176:179]
v_exp_f32 v106,v106
v_mfma_f32_16x16x32_bf16 a[224:227],a[136:139],v[36:39],a[224:227]
v_cvt_pk_bf16_f32 v41,v106,v107
v_cvt_pk_bf16_f32 v40,v104,v105
v_mfma_f32_16x16x32_bf16 a[228:231],a[140:143],v[36:39],a[228:231]
v_exp_f32 v79,v79
v_mfma_f32_16x16x32_bf16 a[232:235],a[144:147],v[36:39],a[232:235]
v_exp_f32 v76,v76
v_mfma_f32_16x16x32_bf16 a[236:239],a[148:151],v[36:39],a[236:239]
v_exp_f32 v78,v78
v_mfma_f32_16x16x32_bf16 a[188:191],a[148:151],v[32:35],a[188:191]
v_exp_f32 v77,v77
v_mfma_f32_16x16x32_bf16 a[184:187],a[144:147],v[32:35],a[184:187]
v_cvt_pk_bf16_f32 v47,v78,v79
v_cvt_pk_bf16_f32 v46,v76,v77
v_mfma_f32_16x16x32_bf16 v[136:139],a[144:147],v[28:31],v[136:139]
v_exp_f32 v84,v84
v_mfma_f32_16x16x32_bf16 v[140:143],a[148:151],v[28:31],v[140:143]
v_exp_f32 v85,v85
v_mfma_f32_16x16x32_bf16 v[236:239],a[148:151],v[24:27],v[236:239]
v_exp_f32 v86,v86
v_mfma_f32_16x16x32_bf16 v[232:235],a[144:147],v[24:27],v[232:235]
v_fma_f32 v87,v87,s36,v14
v_cvt_pk_bf16_f32 v50,v84,v85
v_mfma_f32_16x16x32_bf16 v[184:187],a[144:147],v[20:23],v[184:187]
v_exp_f32 v87,v87
v_mfma_f32_16x16x32_bf16 v[188:191],a[148:151],v[20:23],v[188:191]
v_cvt_pk_bf16_f32 v51,v86,v87
v_fma_f32 v93,v93,s36,v15
v_mfma_f32_16x16x32_bf16 v[192:195],a[120:123],v[20:23],v[192:195]
v_exp_f32 v93,v93
v_smfmac_f32_16x16x64_bf16 v[60:63],a[152:155],v[44:51],v18
v_fma_f32 v94,v94,s36,v15
v_mfma_f32_16x16x32_bf16 v[196:199],a[124:127],v[20:23],v[196:199]
s_waitcnt vmcnt(9) lgkmcnt(0)
v_exp_f32 v94,v94
v_mfma_f32_16x16x32_bf16 v[244:247],a[124:127],v[24:27],v[244:247]
s_barrier
v_mfma_f32_16x16x32_bf16 v[240:243],a[120:123],v[24:27],v[240:243]
ds_read_b128 a[136:139],v0 offset:24576
v_fma_f32 v92,v92,s36,v15
v_mfma_f32_16x16x32_bf16 v[144:147],a[120:123],v[28:31],v[144:147]
ds_read_b128 a[140:143],v1 offset:24576
v_fma_f32 v95,v95,s36,v15
v_mfma_f32_16x16x32_bf16 v[148:151],a[124:127],v[28:31],v[148:151]
ds_read_b128 a[144:147],v0 offset:24704
v_fma_f32 v102,v102,s36,v16
v_mfma_f32_16x16x32_bf16 a[196:199],a[124:127],v[32:35],a[196:199]
ds_read_b128 a[148:151],v1 offset:24704
v_fma_f32 v103,v103,s36,v16
v_mfma_f32_16x16x32_bf16 a[192:195],a[120:123],v[32:35],a[192:195]
ds_read_b128 a[156:159],v10 offset:6144
v_fma_f32 v101,v101,s36,v16
v_mfma_f32_16x16x32_bf16 a[240:243],a[120:123],v[36:39],a[240:243]
buffer_load_dwordx4 v6,s[8:11],s21 offen offset:0 lds
v_mfma_f32_16x16x32_bf16 a[244:247],a[124:127],v[36:39],a[244:247]
ds_read_b128 a[120:123],v0 offset:24832
v_fma_f32 v100,v100,s36,v16
v_mfma_f32_16x16x32_bf16 a[248:251],a[128:131],v[36:39],a[248:251]
ds_read_b128 a[124:127],v1 offset:24832
v_fma_f32 v110,v110,s36,v17
v_mfma_f32_16x16x32_bf16 a[252:255],a[132:135],v[36:39],a[252:255]
v_exp_f32 v95,v95
v_mfma_f32_16x16x32_bf16 a[204:207],a[132:135],v[32:35],a[204:207]
v_exp_f32 v92,v92
v_mfma_f32_16x16x32_bf16 a[200:203],a[128:131],v[32:35],a[200:203]
v_cvt_pk_bf16_f32 v55,v94,v95
v_cvt_pk_bf16_f32 v54,v92,v93
v_mfma_f32_16x16x32_bf16 v[152:155],a[128:131],v[28:31],v[152:155]
v_exp_f32 v100,v100
v_mfma_f32_16x16x32_bf16 v[156:159],a[132:135],v[28:31],v[156:159]
v_exp_f32 v102,v102
v_mfma_f32_16x16x32_bf16 v[252:255],a[132:135],v[24:27],v[252:255]
v_exp_f32 v103,v103
v_mfma_f32_16x16x32_bf16 v[248:251],a[128:131],v[24:27],v[248:251]
v_exp_f32 v101,v101
v_mfma_f32_16x16x32_bf16 v[200:203],a[128:131],v[20:23],v[200:203]
ds_read_b128 a[128:131],v0 offset:30720
v_cvt_pk_bf16_f32 v59,v102,v103
v_mfma_f32_16x16x32_bf16 v[204:207],a[132:135],v[20:23],v[204:207]
s_waitcnt lgkmcnt(1)
buffer_store_dwordx4 a[156:159],v9,s[16:19],s27 offen offset:0 nt
buffer_load_dwordx4 v7,s[8:11],s21 offen offset:1024 lds
v_mfma_f32_16x16x32_bf16 v[72:75],a[136:139],a[0:3],0
ds_read_b128 a[132:135],v1 offset:30720
v_cvt_pk_bf16_f32 v58,v100,v101
v_mfma_f32_16x16x32_bf16 v[72:75],a[140:143],a[4:7],v[72:75]
v_exp_f32 v110,v110
v_smfmac_f32_16x16x64_bf16 v[64:67],a[152:155],v[52:59],v18
v_fma_f32 v111,v111,s36,v17
v_mfma_f32_16x16x32_bf16 v[72:75],a[144:147],a[8:11],v[72:75]
v_exp_f32 v111,v111
v_mfma_f32_16x16x32_bf16 v[72:75],a[148:151],a[12:15],v[72:75]
v_fma_f32 v108,v108,s36,v17
v_cvt_pk_bf16_f32 v43,v110,v111
v_mfma_f32_16x16x32_bf16 v[72:75],a[120:123],a[16:19],v[72:75]
ds_read_b128 a[156:159],v10 offset:7168
v_fma_f32 v109,v109,s36,v17
v_mfma_f32_16x16x32_bf16 v[72:75],a[124:127],a[20:23],v[72:75]
v_exp_f32 v108,v108
v_mfma_f32_16x16x32_bf16 v[80:83],a[124:127],a[44:47],0
v_exp_f32 v109,v109
v_mfma_f32_16x16x32_bf16 v[80:83],a[120:123],a[40:43],v[80:83]
v_cvt_pk_bf16_f32 v42,v108,v109
v_mfma_f32_16x16x32_bf16 v[80:83],a[148:151],a[36:39],v[80:83]
v_mfma_f32_16x16x32_bf16 v[80:83],a[144:147],a[32:35],v[80:83]
buffer_load_dwordx4 v8,s[8:11],s21 offen offset:2048 lds
v_smfmac_f32_16x16x64_bf16 v[68:71],a[152:155],v[36:43],v18
s_add_u32 s21,s21,12288
v_fma_f32 v75,v75,s36,v13
v_mfma_f32_16x16x32_bf16 v[80:83],a[140:143],a[28:31],v[80:83]
s_cmp_eq_u32 s38,1
v_exp_f32 v75,v75
v_mfma_f32_16x16x32_bf16 v[80:83],a[136:139],a[24:27],v[80:83]
s_cselect_b32 s20,s26,s20
v_fma_f32 v73,v73,s36,v13
v_fma_f32 v74,v74,s36,v13
v_mfma_f32_16x16x32_bf16 v[88:91],a[136:139],a[48:51],0
s_add_u32 m0,s22,12288
v_exp_f32 v73,v73
v_mfma_f32_16x16x32_bf16 v[88:91],a[140:143],a[52:55],v[88:91]
v_exp_f32 v74,v74
v_mfma_f32_16x16x32_bf16 v[88:91],a[144:147],a[56:59],v[88:91]
v_fma_f32 v82,v82,s36,v14
v_fma_f32 v81,v81,s36,v14
v_mfma_f32_16x16x32_bf16 v[88:91],a[148:151],a[60:63],v[88:91]
v_exp_f32 v81,v81
v_mfma_f32_16x16x32_bf16 v[88:91],a[120:123],a[64:67],v[88:91]
v_exp_f32 v82,v82
v_mfma_f32_16x16x32_bf16 v[88:91],a[124:127],a[68:71],v[88:91]
v_fma_f32 v72,v72,s36,v13
v_fma_f32 v80,v80,s36,v14
v_mfma_f32_16x16x32_bf16 v[96:99],a[124:127],a[92:95],0
v_exp_f32 v72,v72
v_mfma_f32_16x16x32_bf16 v[96:99],a[120:123],a[88:91],v[96:99]
s_waitcnt lgkmcnt(0)
buffer_store_dwordx4 a[156:159],v9,s[16:19],s27 offen offset:128 nt
buffer_load_dwordx4 v6,s[4:7],s20 offen offset:0 lds
v_mfma_f32_16x16x32_bf16 v[96:99],a[148:151],a[84:87],v[96:99]
v_exp_f32 v80,v80
v_mfma_f32_16x16x32_bf16 v[96:99],a[144:147],a[80:83],v[96:99]
v_fma_f32 v89,v89,s36,v15
v_fma_f32 v88,v88,s36,v15
v_mfma_f32_16x16x32_bf16 v[96:99],a[140:143],a[76:79],v[96:99]
v_exp_f32 v89,v89
v_mfma_f32_16x16x32_bf16 v[96:99],a[136:139],a[72:75],v[96:99]
v_exp_f32 v88,v88
v_mfma_f32_16x16x32_bf16 v[104:107],a[136:139],a[96:99],0
ds_read_b128 a[136:139],v0 offset:30848
v_fma_f32 v83,v83,s36,v14
v_mfma_f32_16x16x32_bf16 v[104:107],a[140:143],a[100:103],v[104:107]
ds_read_b128 a[156:159],v10 offset:8192
v_mfma_f32_16x16x32_bf16 v[104:107],a[144:147],a[104:107],v[104:107]
ds_read_b128 a[140:143],v1 offset:30848
v_mfma_f32_16x16x32_bf16 v[104:107],a[148:151],a[108:111],v[104:107]
ds_read_b128 a[144:147],v0 offset:30976
v_mfma_f32_16x16x32_bf16 v[104:107],a[120:123],a[112:115],v[104:107]
ds_read_b128 a[148:151],v1 offset:30976
v_mfma_f32_16x16x32_bf16 v[104:107],a[124:127],a[116:119],v[104:107]
v_exp_f32 v83,v83
v_mfma_f32_16x16x32_bf16 v[76:79],a[128:131],a[0:3],0
buffer_load_dwordx4 v7,s[4:7],s20 offen offset:1024 lds
v_mfma_f32_16x16x32_bf16 v[76:79],a[132:135],a[4:7],v[76:79]
s_waitcnt lgkmcnt(4)
v_cvt_pk_bf16_f32 v25,v82,v83
v_cvt_pk_bf16_f32 v20,v72,v73
v_mfma_f32_16x16x32_bf16 v[76:79],a[136:139],a[8:11],v[76:79]
s_waitcnt lgkmcnt(2)
v_cvt_pk_bf16_f32 v21,v74,v75
v_cvt_pk_bf16_f32 v24,v80,v81
v_cvt_pk_bf16_f32 v28,v88,v89
v_mfma_f32_16x16x32_bf16 v[76:79],a[140:143],a[12:15],v[76:79]
s_waitcnt lgkmcnt(1)
v_mfma_f32_16x16x32_bf16 v[76:79],a[144:147],a[16:19],v[76:79]
s_waitcnt lgkmcnt(0)
v_mfma_f32_16x16x32_bf16 v[76:79],a[148:151],a[20:23],v[76:79]
v_mfma_f32_16x16x32_bf16 v[84:87],a[148:151],a[44:47],0
v_mfma_f32_16x16x32_bf16 v[84:87],a[144:147],a[40:43],v[84:87]
v_mfma_f32_16x16x32_bf16 v[84:87],a[140:143],a[36:39],v[84:87]
v_mfma_f32_16x16x32_bf16 v[84:87],a[136:139],a[32:35],v[84:87]
v_mfma_f32_16x16x32_bf16 v[84:87],a[132:135],a[28:31],v[84:87]
buffer_store_dwordx4 a[156:159],v9,s[16:19],s27 offen offset:256 nt
buffer_load_dwordx4 v8,s[4:7],s20 offen offset:2048 lds
v_mfma_f32_16x16x32_bf16 v[84:87],a[128:131],a[24:27],v[84:87]
s_add_u32 s20,s20,12288
v_mfma_f32_16x16x32_bf16 v[92:95],a[128:131],a[48:51],0
s_add_u32 s27,s27,3072
v_mfma_f32_16x16x32_bf16 v[92:95],a[132:135],a[52:55],v[92:95]
v_mfma_f32_16x16x32_bf16 v[92:95],a[136:139],a[56:59],v[92:95]
v_mfma_f32_16x16x32_bf16 v[92:95],a[140:143],a[60:63],v[92:95]
ds_read_b64_tr_b16 a[120:121],v2 offset:12288
v_mfma_f32_16x16x32_bf16 v[92:95],a[144:147],a[64:67],v[92:95]
ds_read_b64_tr_b16 a[122:123],v2 offset:18432
v_mfma_f32_16x16x32_bf16 v[92:95],a[148:151],a[68:71],v[92:95]
v_mfma_f32_16x16x32_bf16 v[100:103],a[148:151],a[92:95],0
ds_read_b64_tr_b16 a[126:127],v3 offset:18432
v_mfma_f32_16x16x32_bf16 v[100:103],a[144:147],a[88:91],v[100:103]
ds_read_b64_tr_b16 a[124:125],v3 offset:12288
v_mfma_f32_16x16x32_bf16 v[100:103],a[140:143],a[84:87],v[100:103]
v_mfma_f32_16x16x32_bf16 v[100:103],a[136:139],a[80:83],v[100:103]
v_mfma_f32_16x16x32_bf16 v[100:103],a[132:135],a[76:79],v[100:103]
v_mfma_f32_16x16x32_bf16 v[100:103],a[128:131],a[72:75],v[100:103]
v_mfma_f32_16x16x32_bf16 v[108:111],a[128:131],a[96:99],0
ds_read_b64_tr_b16 a[130:131],v4 offset:18432
v_mfma_f32_16x16x32_bf16 v[108:111],a[132:135],a[100:103],v[108:111]
ds_read_b64_tr_b16 a[128:129],v4 offset:12288
v_mfma_f32_16x16x32_bf16 v[108:111],a[136:139],a[104:107],v[108:111]
ds_read_b64_tr_b16 a[132:133],v5 offset:12288
v_mfma_f32_16x16x32_bf16 v[108:111],a[140:143],a[108:111],v[108:111]
ds_read_b64_tr_b16 a[134:135],v5 offset:18432
v_mfma_f32_16x16x32_bf16 v[108:111],a[144:147],a[112:115],v[108:111]
v_mfma_f32_16x16x32_bf16 v[108:111],a[148:151],a[116:119],v[108:111]
s_waitcnt lgkmcnt(4)
v_mfma_f32_16x16x32_bf16 v[160:163],a[120:123],v[44:47],v[160:163]
s_add_u32 m0,s29,0
ds_read_b64_tr_b16 a[136:137],v2 offset:12416
v_fma_f32 v90,v90,s36,v15
v_mfma_f32_16x16x32_bf16 v[164:167],a[124:127],v[44:47],v[164:167]
ds_read_b64_tr_b16 a[138:139],v2 offset:18560
v_fma_f32 v91,v91,s36,v15
v_mfma_f32_16x16x32_bf16 v[212:215],a[124:127],v[48:51],v[212:215]
ds_read_b64_tr_b16 a[140:141],v3 offset:12416
v_fma_f32 v96,v96,s36,v16
v_mfma_f32_16x16x32_bf16 v[208:211],a[120:123],v[48:51],v[208:211]
ds_read_b64_tr_b16 a[142:143],v3 offset:18560
v_fma_f32 v97,v97,s36,v16
v_mfma_f32_16x16x32_bf16 v[112:115],a[120:123],v[52:55],v[112:115]
ds_read_b64_tr_b16 a[144:145],v4 offset:12416
v_fma_f32 v98,v98,s36,v16
v_mfma_f32_16x16x32_bf16 v[116:119],a[124:127],v[52:55],v[116:119]
ds_read_b64_tr_b16 a[146:147],v4 offset:18560
v_fma_f32 v99,v99,s36,v16
v_mfma_f32_16x16x32_bf16 a[164:167],a[124:127],v[56:59],a[164:167]
ds_read_b64_tr_b16 a[148:149],v5 offset:12416
v_fma_f32 v104,v104,s36,v17
v_mfma_f32_16x16x32_bf16 a[160:163],a[120:123],v[56:59],a[160:163]
buffer_load_dwordx4 v6,s[12:15],s28 offen offset:0 nt lds
v_mfma_f32_16x16x32_bf16 a[208:211],a[120:123],v[40:43],a[208:211]
ds_read_b64_tr_b16 a[150:151],v5 offset:18560
v_fma_f32 v105,v105,s36,v17
v_mfma_f32_16x16x32_bf16 a[212:215],a[124:127],v[40:43],a[212:215]
s_waitcnt lgkmcnt(5)
ds_read_b64_tr_b16 a[120:121],v2 offset:12544
v_fma_f32 v106,v106,s36,v17
v_mfma_f32_16x16x32_bf16 a[216:219],a[128:131],v[40:43],a[216:219]
ds_read_b64_tr_b16 a[122:123],v2 offset:18688
v_fma_f32 v107,v107,s36,v17
v_mfma_f32_16x16x32_bf16 a[220:223],a[132:135],v[40:43],a[220:223]
ds_read_b64_tr_b16 a[124:125],v3 offset:12544
v_fma_f32 v76,v76,s36,v13
v_mfma_f32_16x16x32_bf16 a[172:175],a[132:135],v[56:59],a[172:175]
ds_read_b64_tr_b16 a[126:127],v3 offset:18688
v_fma_f32 v77,v77,s36,v13
v_mfma_f32_16x16x32_bf16 a[168:171],a[128:131],v[56:59],a[168:171]
v_exp_f32 v90,v90
v_mfma_f32_16x16x32_bf16 v[120:123],a[128:131],v[52:55],v[120:123]
v_exp_f32 v91,v91
v_mfma_f32_16x16x32_bf16 v[124:127],a[132:135],v[52:55],v[124:127]
v_cvt_pk_bf16_f32 v29,v90,v91
v_fma_f32 v78,v78,s36,v13
v_mfma_f32_16x16x32_bf16 v[220:223],a[132:135],v[48:51],v[220:223]
v_exp_f32 v96,v96
v_mfma_f32_16x16x32_bf16 v[216:219],a[128:131],v[48:51],v[216:219]
buffer_load_dwordx4 v7,s[12:15],s28 offen offset:1024 nt lds
v_mfma_f32_16x16x32_bf16 v[168:171],a[128:131],v[44:47],v[168:171]
ds_read_b64_tr_b16 a[128:129],v4 offset:12544
v_fma_f32 v79,v79,s36,v13
v_mfma_f32_16x16x32_bf16 v[172:175],a[132:135],v[44:47],v[172:175]
ds_read_b64_tr_b16 a[130:131],v4 offset:18688
v_fma_f32 v84,v84,s36,v14
v_mfma_f32_16x16x32_bf16 v[176:179],a[136:139],v[44:47],v[176:179]
s_waitcnt lgkmcnt(2)
ds_read_b64_tr_b16 a[132:133],v5 offset:12544
v_fma_f32 v85,v85,s36,v14
v_mfma_f32_16x16x32_bf16 v[180:183],a[140:143],v[44:47],v[180:183]
ds_read_b64_tr_b16 a[134:135],v5 offset:18688
v_fma_f32 v86,v86,s36,v14
v_mfma_f32_16x16x32_bf16 v[228:231],a[140:143],v[48:51],v[228:231]
v_exp_f32 v97,v97
v_mfma_f32_16x16x32_bf16 v[224:227],a[136:139],v[48:51],v[224:227]
v_exp_f32 v98,v98
v_mfma_f32_16x16x32_bf16 v[128:131],a[136:139],v[52:55],v[128:131]
v_exp_f32 v99,v99
v_mfma_f32_16x16x32_bf16 v[132:135],a[140:143],v[52:55],v[132:135]
v_cvt_pk_bf16_f32 v32,v96,v97
v_cvt_pk_bf16_f32 v33,v98,v99
v_mfma_f32_16x16x32_bf16 a[180:183],a[140:143],v[56:59],a[180:183]
v_exp_f32 v104,v104
v_mfma_f32_16x16x32_bf16 a[176:179],a[136:139],v[56:59],a[176:179]
buffer_load_dwordx4 v8,s[12:15],s28 offen offset:2048 nt lds
v_mfma_f32_16x16x32_bf16 a[224:227],a[136:139],v[40:43],a[224:227]
s_add_u32 s28,s28,3072
v_exp_f32 v105,v105
v_mfma_f32_16x16x32_bf16 a[228:231],a[140:143],v[40:43],a[228:231]
s_add_u32 s29,s29,3072
v_exp_f32 v106,v106
v_mfma_f32_16x16x32_bf16 a[232:235],a[144:147],v[40:43],a[232:235]
s_cmp_eq_u32 s38,1
v_exp_f32 v107,v107
v_mfma_f32_16x16x32_bf16 a[236:239],a[148:151],v[40:43],a[236:239]
s_cselect_b32 s21,s26,s21
v_cvt_pk_bf16_f32 v36,v104,v105
v_cvt_pk_bf16_f32 v37,v106,v107
v_mfma_f32_16x16x32_bf16 a[188:191],a[148:151],v[56:59],a[188:191]
s_add_u32 m0,s23,12288
v_exp_f32 v76,v76
v_mfma_f32_16x16x32_bf16 a[184:187],a[144:147],v[56:59],a[184:187]
v_exp_f32 v77,v77
v_mfma_f32_16x16x32_bf16 v[136:139],a[144:147],v[52:55],v[136:139]
v_exp_f32 v78,v78
v_mfma_f32_16x16x32_bf16 v[140:143],a[148:151],v[52:55],v[140:143]
v_exp_f32 v79,v79
v_mfma_f32_16x16x32_bf16 v[236:239],a[148:151],v[48:51],v[236:239]
v_cvt_pk_bf16_f32 v22,v76,v77
v_cvt_pk_bf16_f32 v23,v78,v79
v_mfma_f32_16x16x32_bf16 v[232:235],a[144:147],v[48:51],v[232:235]
v_fma_f32 v87,v87,s36,v14
v_fma_f32 v92,v92,s36,v15
v_mfma_f32_16x16x32_bf16 v[184:187],a[144:147],v[44:47],v[184:187]
v_exp_f32 v84,v84
v_mfma_f32_16x16x32_bf16 v[188:191],a[148:151],v[44:47],v[188:191]
v_exp_f32 v85,v85
v_mfma_f32_16x16x32_bf16 v[192:195],a[120:123],v[44:47],v[192:195]
v_exp_f32 v86,v86
v_mfma_f32_16x16x32_bf16 v[196:199],a[124:127],v[44:47],v[196:199]
s_waitcnt vmcnt(12) lgkmcnt(0)
v_exp_f32 v87,v87
v_mfma_f32_16x16x32_bf16 v[244:247],a[124:127],v[48:51],v[244:247]
s_barrier
v_mfma_f32_16x16x32_bf16 v[240:243],a[120:123],v[48:51],v[240:243]
ds_read_b128 a[136:139],v0 offset:0
v_cvt_pk_bf16_f32 v26,v84,v85
v_mfma_f32_16x16x32_bf16 v[144:147],a[120:123],v[52:55],v[144:147]
ds_read_b128 a[140:143],v1 offset:0
v_cvt_pk_bf16_f32 v27,v86,v87
v_mfma_f32_16x16x32_bf16 v[148:151],a[124:127],v[52:55],v[148:151]
ds_read_b128 a[144:147],v0 offset:128
v_fma_f32 v93,v93,s36,v15
v_smfmac_f32_16x16x64_bf16 v[60:63],a[152:155],v[20:27],v18
ds_read_b128 a[148:151],v1 offset:128
v_mfma_f32_16x16x32_bf16 a[196:199],a[124:127],v[56:59],a[196:199]
v_fma_f32 v94,v94,s36,v15
v_fma_f32 v95,v95,s36,v15
v_mfma_f32_16x16x32_bf16 a[192:195],a[120:123],v[56:59],a[192:195]
buffer_load_dwordx4 v6,s[8:11],s21 offen offset:0 lds
v_mfma_f32_16x16x32_bf16 a[240:243],a[120:123],v[40:43],a[240:243]
ds_read_b128 a[120:123],v0 offset:256
v_fma_f32 v100,v100,s36,v16
v_mfma_f32_16x16x32_bf16 a[244:247],a[124:127],v[40:43],a[244:247]
ds_read_b128 a[124:127],v1 offset:256
v_fma_f32 v101,v101,s36,v16
v_mfma_f32_16x16x32_bf16 a[248:251],a[128:131],v[40:43],a[248:251]
v_exp_f32 v92,v92
v_mfma_f32_16x16x32_bf16 a[252:255],a[132:135],v[40:43],a[252:255]
v_exp_f32 v93,v93
v_mfma_f32_16x16x32_bf16 a[204:207],a[132:135],v[56:59],a[204:207]
v_exp_f32 v94,v94
v_mfma_f32_16x16x32_bf16 a[200:203],a[128:131],v[56:59],a[200:203]
v_exp_f32 v95,v95
v_mfma_f32_16x16x32_bf16 v[152:155],a[128:131],v[52:55],v[152:155]
v_cvt_pk_bf16_f32 v30,v92,v93
v_cvt_pk_bf16_f32 v31,v94,v95
v_mfma_f32_16x16x32_bf16 v[156:159],a[132:135],v[52:55],v[156:159]
v_fma_f32 v102,v102,s36,v16
v_fma_f32 v103,v103,s36,v16
v_mfma_f32_16x16x32_bf16 v[252:255],a[132:135],v[48:51],v[252:255]
v_exp_f32 v100,v100
v_mfma_f32_16x16x32_bf16 v[248:251],a[128:131],v[48:51],v[248:251]
v_exp_f32 v101,v101
v_mfma_f32_16x16x32_bf16 v[200:203],a[128:131],v[44:47],v[200:203]
buffer_load_dwordx4 v7,s[8:11],s21 offen offset:1024 lds
v_mfma_f32_16x16x32_bf16 v[204:207],a[132:135],v[44:47],v[204:207]
s_waitcnt lgkmcnt(0)
ds_read_b128 a[128:131],v0 offset:6144
v_cvt_pk_bf16_f32 v34,v100,v101
v_mfma_f32_16x16x32_bf16 v[72:75],a[136:139],a[0:3],0
ds_read_b128 a[132:135],v1 offset:6144
v_fma_f32 v108,v108,s36,v17
v_mfma_f32_16x16x32_bf16 v[72:75],a[140:143],a[4:7],v[72:75]
v_exp_f32 v102,v102
v_mfma_f32_16x16x32_bf16 v[72:75],a[144:147],a[8:11],v[72:75]
v_exp_f32 v103,v103
v_mfma_f32_16x16x32_bf16 v[72:75],a[148:151],a[12:15],v[72:75]
v_cvt_pk_bf16_f32 v35,v102,v103
v_fma_f32 v109,v109,s36,v17
v_mfma_f32_16x16x32_bf16 v[72:75],a[120:123],a[16:19],v[72:75]
v_fma_f32 v110,v110,s36,v17
v_fma_f32 v111,v111,s36,v17
v_smfmac_f32_16x16x64_bf16 v[64:67],a[152:155],v[28:35],v18
v_add_u32 v10,9216,v10
v_mfma_f32_16x16x32_bf16 v[72:75],a[124:127],a[20:23],v[72:75]
v_exp_f32 v108,v108
v_mfma_f32_16x16x32_bf16 v[80:83],a[124:127],a[44:47],0
v_exp_f32 v109,v109
v_mfma_f32_16x16x32_bf16 v[80:83],a[120:123],a[40:43],v[80:83]
v_exp_f32 v110,v110
v_mfma_f32_16x16x32_bf16 v[80:83],a[148:151],a[36:39],v[80:83]
v_exp_f32 v111,v111
v_mfma_f32_16x16x32_bf16 v[80:83],a[144:147],a[32:35],v[80:83]
buffer_load_dwordx4 v8,s[8:11],s21 offen offset:2048 lds
v_mfma_f32_16x16x32_bf16 v[80:83],a[140:143],a[28:31],v[80:83]
s_add_u32 s21,s21,12288
v_cvt_pk_bf16_f32 v38,v108,v109
v_cvt_pk_bf16_f32 v39,v110,v111
v_mfma_f32_16x16x32_bf16 v[80:83],a[136:139],a[24:27],v[80:83]
s_add_u32 m0,s22,24576
v_fma_f32 v72,v72,s36,v13
v_fma_f32 v73,v73,s36,v13
v_mfma_f32_16x16x32_bf16 v[88:91],a[136:139],a[48:51],0
v_fma_f32 v74,v74,s36,v13
v_fma_f32 v75,v75,s36,v13
v_mfma_f32_16x16x32_bf16 v[88:91],a[140:143],a[52:55],v[88:91]
v_exp_f32 v72,v72
v_mfma_f32_16x16x32_bf16 v[88:91],a[144:147],a[56:59],v[88:91]
v_fma_f32 v80,v80,s36,v14
v_fma_f32 v81,v81,s36,v14
v_mfma_f32_16x16x32_bf16 v[88:91],a[148:151],a[60:63],v[88:91]
v_fma_f32 v82,v82,s36,v14
v_fma_f32 v83,v83,s36,v14
v_mfma_f32_16x16x32_bf16 v[88:91],a[120:123],a[64:67],v[88:91]
v_exp_f32 v73,v73
v_mfma_f32_16x16x32_bf16 v[88:91],a[124:127],a[68:71],v[88:91]
v_exp_f32 v74,v74
v_mfma_f32_16x16x32_bf16 v[96:99],a[124:127],a[92:95],0
v_exp_f32 v75,v75
v_mfma_f32_16x16x32_bf16 v[96:99],a[120:123],a[88:91],v[96:99]
v_exp_f32 v80,v80
v_mfma_f32_16x16x32_bf16 v[96:99],a[148:151],a[84:87],v[96:99]
buffer_load_dwordx4 v6,s[4:7],s20 offen offset:0 lds
v_mfma_f32_16x16x32_bf16 v[96:99],a[144:147],a[80:83],v[96:99]
v_fma_f32 v88,v88,s36,v15
v_fma_f32 v89,v89,s36,v15
v_mfma_f32_16x16x32_bf16 v[96:99],a[140:143],a[76:79],v[96:99]
v_exp_f32 v81,v81
v_mfma_f32_16x16x32_bf16 v[96:99],a[136:139],a[72:75],v[96:99]
v_exp_f32 v82,v82
v_mfma_f32_16x16x32_bf16 v[104:107],a[136:139],a[96:99],0
ds_read_b128 a[136:139],v0 offset:6272
v_cvt_pk_bf16_f32 v44,v72,v73
v_mfma_f32_16x16x32_bf16 v[104:107],a[140:143],a[100:103],v[104:107]
ds_read_b128 a[140:143],v1 offset:6272
v_cvt_pk_bf16_f32 v45,v74,v75
v_mfma_f32_16x16x32_bf16 v[104:107],a[144:147],a[104:107],v[104:107]
ds_read_b128 a[144:147],v0 offset:6400
v_cvt_pk_bf16_f32 v48,v80,v81
v_mfma_f32_16x16x32_bf16 v[104:107],a[148:151],a[108:111],v[104:107]
ds_read_b128 a[148:151],v1 offset:6400
v_mfma_f32_16x16x32_bf16 v[104:107],a[120:123],a[112:115],v[104:107]
v_exp_f32 v83,v83
v_mfma_f32_16x16x32_bf16 v[104:107],a[124:127],a[116:119],v[104:107]
s_waitcnt lgkmcnt(4)
v_exp_f32 v88,v88
v_mfma_f32_16x16x32_bf16 v[76:79],a[128:131],a[0:3],0
v_exp_f32 v89,v89
v_mfma_f32_16x16x32_bf16 v[76:79],a[132:135],a[4:7],v[76:79]
buffer_load_dwordx4 v7,s[4:7],s20 offen offset:1024 lds
s_waitcnt lgkmcnt(3)
v_mfma_f32_16x16x32_bf16 v[76:79],a[136:139],a[8:11],v[76:79]
s_waitcnt lgkmcnt(2)
v_cvt_pk_bf16_f32 v49,v82,v83
v_cvt_pk_bf16_f32 v52,v88,v89
v_mfma_f32_16x16x32_bf16 v[76:79],a[140:143],a[12:15],v[76:79]
s_waitcnt lgkmcnt(0)
v_mfma_f32_16x16x32_bf16 v[76:79],a[144:147],a[16:19],v[76:79]
v_mfma_f32_16x16x32_bf16 v[76:79],a[148:151],a[20:23],v[76:79]
v_mfma_f32_16x16x32_bf16 v[84:87],a[148:151],a[44:47],0
v_mfma_f32_16x16x32_bf16 v[84:87],a[144:147],a[40:43],v[84:87]
v_mfma_f32_16x16x32_bf16 v[84:87],a[140:143],a[36:39],v[84:87]
v_mfma_f32_16x16x32_bf16 v[84:87],a[136:139],a[32:35],v[84:87]
v_mfma_f32_16x16x32_bf16 v[84:87],a[132:135],a[28:31],v[84:87]
v_mfma_f32_16x16x32_bf16 v[84:87],a[128:131],a[24:27],v[84:87]
v_mfma_f32_16x16x32_bf16 v[92:95],a[128:131],a[48:51],0
v_mfma_f32_16x16x32_bf16 v[92:95],a[132:135],a[52:55],v[92:95]
buffer_load_dwordx4 v8,s[4:7],s20 offen offset:2048 lds
v_mfma_f32_16x16x32_bf16 v[92:95],a[136:139],a[56:59],v[92:95]
s_add_u32 s20,s20,12288
s_add_u32 s38,s38,1
s_cmp_lt_u32 s38,2
v_mfma_f32_16x16x32_bf16 v[92:95],a[140:143],a[60:63],v[92:95]
v_mfma_f32_16x16x32_bf16 v[92:95],a[144:147],a[64:67],v[92:95]
v_mfma_f32_16x16x32_bf16 v[92:95],a[148:151],a[68:71],v[92:95]
v_mfma_f32_16x16x32_bf16 v[100:103],a[148:151],a[92:95],0
ds_read_b64_tr_b16 a[120:121],v2 offset:24576
v_mfma_f32_16x16x32_bf16 v[100:103],a[144:147],a[88:91],v[100:103]
ds_read_b64_tr_b16 a[122:123],v2 offset:30720
v_mfma_f32_16x16x32_bf16 v[100:103],a[140:143],a[84:87],v[100:103]
v_mfma_f32_16x16x32_bf16 v[100:103],a[136:139],a[80:83],v[100:103]
ds_read_b64_tr_b16 a[124:125],v3 offset:24576
v_mfma_f32_16x16x32_bf16 v[100:103],a[132:135],a[76:79],v[100:103]
ds_read_b64_tr_b16 a[126:127],v3 offset:30720
v_mfma_f32_16x16x32_bf16 v[100:103],a[128:131],a[72:75],v[100:103]
v_mfma_f32_16x16x32_bf16 v[108:111],a[128:131],a[96:99],0
ds_read_b64_tr_b16 a[128:129],v4 offset:24576
v_mfma_f32_16x16x32_bf16 v[108:111],a[132:135],a[100:103],v[108:111]
ds_read_b64_tr_b16 a[130:131],v4 offset:30720
v_mfma_f32_16x16x32_bf16 v[108:111],a[136:139],a[104:107],v[108:111]
ds_read_b64_tr_b16 a[132:133],v5 offset:24576
v_mfma_f32_16x16x32_bf16 v[108:111],a[140:143],a[108:111],v[108:111]
ds_read_b64_tr_b16 a[134:135],v5 offset:30720
v_mfma_f32_16x16x32_bf16 v[108:111],a[144:147],a[112:115],v[108:111]
v_mfma_f32_16x16x32_bf16 v[108:111],a[148:151],a[116:119],v[108:111]
s_cbranch_scc1 L_loop5w0
s_cmp_ge_u32 s69,6
s_cbranch_scc1 L_end5
s_cmp_eq_u32 s40,0
s_cbranch_scc1 L_tr54
s_branch L_tr55
L_tr54:
s_waitcnt vmcnt(43)
s_waitcnt lgkmcnt(3)
v_mfma_f32_16x16x32_bf16 v[160:163],a[120:123],v[20:23],v[160:163]
s_add_u32 m0,s24,0
ds_read_b128 a[12:15],v12 offset:128
v_fma_f32 v101,v101,s36,v16
v_mfma_f32_16x16x32_bf16 v[164:167],a[124:127],v[20:23],v[164:167]
ds_read_b128 a[20:23],v12 offset:256
v_fma_f32 v103,v103,s36,v16
v_mfma_f32_16x16x32_bf16 v[212:215],a[124:127],v[24:27],v[212:215]
ds_read_b128 a[4:7],v12 offset:0
v_fma_f32 v87,v87,s36,v14
v_mfma_f32_16x16x32_bf16 v[208:211],a[120:123],v[24:27],v[208:211]
ds_read_b128 a[16:19],v11 offset:256
v_fma_f32 v106,v106,s36,v17
v_mfma_f32_16x16x32_bf16 v[112:115],a[120:123],v[28:31],v[112:115]
ds_read_b128 a[0:3],v11 offset:0
v_fma_f32 v99,v99,s36,v16
v_mfma_f32_16x16x32_bf16 v[116:119],a[124:127],v[28:31],v[116:119]
ds_read_b128 a[8:11],v11 offset:128
v_fma_f32 v96,v96,s36,v16
v_mfma_f32_16x16x32_bf16 a[164:167],a[124:127],v[32:35],a[164:167]
ds_read_b64_tr_b16 a[136:137],v2 offset:24704
v_fma_f32 v77,v77,s36,v13
v_mfma_f32_16x16x32_bf16 a[160:163],a[120:123],v[32:35],a[160:163]
ds_read_b64_tr_b16 a[138:139],v2 offset:30848
v_fma_f32 v85,v85,s36,v14
v_mfma_f32_16x16x32_bf16 a[208:211],a[120:123],v[36:39],a[208:211]
ds_read_b64_tr_b16 a[140:141],v3 offset:24704
ds_read_b64_tr_b16 a[142:143],v3 offset:30848
ds_read_b64_tr_b16 a[144:145],v4 offset:24704
ds_read_b64_tr_b16 a[146:147],v4 offset:30848
ds_read_b64_tr_b16 a[150:151],v5 offset:30848
ds_read_b64_tr_b16 a[148:149],v5 offset:24704
ds_read_b128 a[40:43],v11 offset:6400
v_mfma_f32_16x16x32_bf16 a[212:215],a[124:127],v[36:39],a[212:215]
s_waitcnt lgkmcnt(11)
v_fma_f32 v84,v84,s36,v14
ds_read_b128 a[32:35],v11 offset:6272
v_mfma_f32_16x16x32_bf16 a[216:219],a[128:131],v[36:39],a[216:219]
s_waitcnt lgkmcnt(10)
buffer_load_dwordx4 v6,s[12:15],s28 offen offset:0 nt lds
v_mfma_f32_16x16x32_bf16 a[220:223],a[132:135],v[36:39],a[220:223]
ds_read_b64_tr_b16 a[122:123],v2 offset:30976
ds_read_b128 a[44:47],v12 offset:6400
v_mfma_f32_16x16x32_bf16 a[172:175],a[132:135],v[32:35],a[172:175]
v_exp_f32 v101,v101
ds_read_b64_tr_b16 a[120:121],v2 offset:24832
ds_read_b128 a[24:27],v11 offset:6144
v_mfma_f32_16x16x32_bf16 a[168:171],a[128:131],v[32:35],a[168:171]
v_exp_f32 v77,v77
ds_read_b128 a[28:31],v12 offset:6144
v_mfma_f32_16x16x32_bf16 v[120:123],a[128:131],v[28:31],v[120:123]
v_fma_f32 v111,v111,s36,v17
ds_read_b64_tr_b16 a[126:127],v3 offset:30976
ds_read_b64_tr_b16 a[124:125],v3 offset:24832
ds_read_b128 a[36:39],v12 offset:6272
v_mfma_f32_16x16x32_bf16 v[124:127],a[132:135],v[28:31],v[124:127]
buffer_load_dwordx4 v7,s[12:15],s28 offen offset:1024 nt lds
v_mfma_f32_16x16x32_bf16 v[220:223],a[132:135],v[24:27],v[220:223]
v_fma_f32 v95,v95,s36,v15
v_fma_f32 v100,v100,s36,v16
v_mfma_f32_16x16x32_bf16 v[216:219],a[128:131],v[24:27],v[216:219]
v_exp_f32 v106,v106
v_mfma_f32_16x16x32_bf16 v[168:171],a[128:131],v[20:23],v[168:171]
ds_read_b64_tr_b16 a[130:131],v4 offset:30976
v_fma_f32 v93,v93,s36,v15
v_mfma_f32_16x16x32_bf16 v[172:175],a[132:135],v[20:23],v[172:175]
s_waitcnt lgkmcnt(4)
ds_read_b64_tr_b16 a[128:129],v4 offset:24832
v_exp_f32 v111,v111
v_mfma_f32_16x16x32_bf16 v[176:179],a[136:139],v[20:23],v[176:179]
ds_read_b64_tr_b16 a[132:133],v5 offset:24832
buffer_load_dwordx4 v8,s[12:15],s28 offen offset:2048 nt lds
v_mfma_f32_16x16x32_bf16 v[180:183],a[140:143],v[20:23],v[180:183]
s_add_u32 s28,s28,3072
ds_read_b64_tr_b16 a[134:135],v5 offset:30976
v_fma_f32 v107,v107,s36,v17
v_mfma_f32_16x16x32_bf16 v[228:231],a[140:143],v[24:27],v[228:231]
s_add_u32 m0,s24,3072
v_fma_f32 v92,v92,s36,v15
v_exp_f32 v92,v92
v_mfma_f32_16x16x32_bf16 v[224:227],a[136:139],v[24:27],v[224:227]
v_fma_f32 v109,v109,s36,v17
v_exp_f32 v109,v109
v_mfma_f32_16x16x32_bf16 v[128:131],a[136:139],v[28:31],v[128:131]
v_fma_f32 v97,v97,s36,v16
v_exp_f32 v84,v84
v_mfma_f32_16x16x32_bf16 v[132:135],a[140:143],v[28:31],v[132:135]
v_fma_f32 v94,v94,s36,v15
v_exp_f32 v94,v94
v_mfma_f32_16x16x32_bf16 a[180:183],a[140:143],v[32:35],a[180:183]
v_fma_f32 v104,v104,s36,v17
v_fma_f32 v90,v90,s36,v15
v_mfma_f32_16x16x32_bf16 a[176:179],a[136:139],v[32:35],a[176:179]
buffer_load_dwordx4 v6,s[12:15],s28 offen offset:0 nt lds
v_mfma_f32_16x16x32_bf16 a[224:227],a[136:139],v[36:39],a[224:227]
v_exp_f32 v93,v93
v_mfma_f32_16x16x32_bf16 a[228:231],a[140:143],v[36:39],a[228:231]
v_exp_f32 v104,v104
v_mfma_f32_16x16x32_bf16 a[232:235],a[144:147],v[36:39],a[232:235]
v_exp_f32 v96,v96
v_mfma_f32_16x16x32_bf16 a[236:239],a[148:151],v[36:39],a[236:239]
v_fma_f32 v78,v78,s36,v13
v_exp_f32 v78,v78
v_mfma_f32_16x16x32_bf16 a[188:191],a[148:151],v[32:35],a[188:191]
v_fma_f32 v110,v110,s36,v17
v_exp_f32 v110,v110
v_mfma_f32_16x16x32_bf16 a[184:187],a[144:147],v[32:35],a[184:187]
v_exp_f32 v97,v97
v_mfma_f32_16x16x32_bf16 v[136:139],a[144:147],v[28:31],v[136:139]
v_exp_f32 v100,v100
v_mfma_f32_16x16x32_bf16 v[140:143],a[148:151],v[28:31],v[140:143]
buffer_load_dwordx4 v7,s[12:15],s28 offen offset:1024 nt lds
v_mfma_f32_16x16x32_bf16 v[236:239],a[148:151],v[24:27],v[236:239]
v_fma_f32 v102,v102,s36,v16
v_exp_f32 v102,v102
v_mfma_f32_16x16x32_bf16 v[232:235],a[144:147],v[24:27],v[232:235]
v_fma_f32 v79,v79,s36,v13
v_exp_f32 v79,v79
v_mfma_f32_16x16x32_bf16 v[184:187],a[144:147],v[20:23],v[184:187]
v_exp_f32 v85,v85
v_mfma_f32_16x16x32_bf16 v[188:191],a[148:151],v[20:23],v[188:191]
v_fma_f32 v108,v108,s36,v17
v_exp_f32 v108,v108
v_mfma_f32_16x16x32_bf16 v[192:195],a[120:123],v[20:23],v[192:195]
s_waitcnt lgkmcnt(0)
v_fma_f32 v98,v98,s36,v16
v_exp_f32 v87,v87
v_mfma_f32_16x16x32_bf16 v[196:199],a[124:127],v[20:23],v[196:199]
v_fma_f32 v76,v76,s36,v13
v_exp_f32 v76,v76
v_mfma_f32_16x16x32_bf16 v[244:247],a[124:127],v[24:27],v[244:247]
buffer_load_dwordx4 v8,s[12:15],s28 offen offset:2048 nt lds
s_waitcnt vmcnt(20)
s_barrier
v_mfma_f32_16x16x32_bf16 v[240:243],a[120:123],v[24:27],v[240:243]
s_add_u32 s28,s28,3072
v_fma_f32 v105,v105,s36,v17
v_exp_f32 v107,v107
v_mfma_f32_16x16x32_bf16 v[144:147],a[120:123],v[28:31],v[144:147]
s_add_u32 m0,s22,0
v_fma_f32 v91,v91,s36,v15
v_exp_f32 v91,v91
v_mfma_f32_16x16x32_bf16 v[148:151],a[124:127],v[28:31],v[148:151]
buffer_load_dwordx4 v6,s[4:7],s25 offen offset:0 lds
v_mfma_f32_16x16x32_bf16 a[196:199],a[124:127],v[32:35],a[196:199]
buffer_load_dwordx4 v7,s[4:7],s25 offen offset:1024 lds
v_mfma_f32_16x16x32_bf16 a[192:195],a[120:123],v[32:35],a[192:195]
buffer_load_dwordx4 v8,s[4:7],s25 offen offset:2048 lds
v_mfma_f32_16x16x32_bf16 a[240:243],a[120:123],v[36:39],a[240:243]
v_fma_f32 v86,v86,s36,v14
v_exp_f32 v86,v86
v_mfma_f32_16x16x32_bf16 a[244:247],a[124:127],v[36:39],a[244:247]
v_exp_f32 v95,v95
v_mfma_f32_16x16x32_bf16 a[248:251],a[128:131],v[36:39],a[248:251]
v_exp_f32 v103,v103
v_mfma_f32_16x16x32_bf16 a[252:255],a[132:135],v[36:39],a[252:255]
ds_read_b64_tr_b16 a[136:137],v2 offset:0
v_cvt_pk_bf16_f32 v41,v106,v107
v_mfma_f32_16x16x32_bf16 a[204:207],a[132:135],v[32:35],a[204:207]
ds_read_b64_tr_b16 a[138:139],v2 offset:6144
v_exp_f32 v99,v99
v_mfma_f32_16x16x32_bf16 a[200:203],a[128:131],v[32:35],a[200:203]
ds_read_b64_tr_b16 a[140:141],v3 offset:0
v_cvt_pk_bf16_f32 v42,v108,v109
v_mfma_f32_16x16x32_bf16 v[152:155],a[128:131],v[28:31],v[152:155]
ds_read_b64_tr_b16 a[142:143],v3 offset:6144
v_cvt_pk_bf16_f32 v50,v84,v85
v_mfma_f32_16x16x32_bf16 v[156:159],a[132:135],v[28:31],v[156:159]
ds_read_b64_tr_b16 a[144:145],v4 offset:0
v_exp_f32 v90,v90
v_mfma_f32_16x16x32_bf16 v[252:255],a[132:135],v[24:27],v[252:255]
ds_read_b64_tr_b16 a[146:147],v4 offset:6144
v_exp_f32 v105,v105
v_mfma_f32_16x16x32_bf16 v[248:251],a[128:131],v[24:27],v[248:251]
ds_read_b64_tr_b16 a[148:149],v5 offset:0
v_cvt_pk_bf16_f32 v55,v94,v95
v_mfma_f32_16x16x32_bf16 v[200:203],a[128:131],v[20:23],v[200:203]
ds_read_b64_tr_b16 a[150:151],v5 offset:6144
v_cvt_pk_bf16_f32 v51,v86,v87
v_mfma_f32_16x16x32_bf16 v[204:207],a[132:135],v[20:23],v[204:207]
v_cvt_pk_bf16_f32 v59,v102,v103
v_exp_f32 v98,v98
v_cvt_pk_bf16_f32 v54,v92,v93
v_cvt_pk_bf16_f32 v56,v96,v97
v_cvt_pk_bf16_f32 v53,v90,v91
v_cvt_pk_bf16_f32 v47,v78,v79
v_cvt_pk_bf16_f32 v43,v110,v111
v_cvt_pk_bf16_f32 v58,v100,v101
v_cvt_pk_bf16_f32 v46,v76,v77
v_cvt_pk_bf16_f32 v57,v98,v99
v_cvt_pk_bf16_f32 v40,v104,v105
v_smfmac_f32_16x16x64_bf16 v[60:63],a[152:155],v[44:51],v18
v_subrev_u32 v10,18432,v10
v_smfmac_f32_16x16x64_bf16 v[64:67],a[152:155],v[52:59],v18
v_smfmac_f32_16x16x64_bf16 v[68:71],a[152:155],v[36:43],v18
s_waitcnt lgkmcnt(1)
v_mfma_f32_16x16x32_bf16 v[160:163],a[136:139],v[44:47],v[160:163]
s_add_u32 s87,s42,18432
ds_read_b64_tr_b16 a[122:123],v2 offset:6272
v_mbcnt_lo_u32_b32 v39,-1,0
v_mfma_f32_16x16x32_bf16 v[164:167],a[140:143],v[44:47],v[164:167]
s_add_u32 s66,s42,24576
ds_read_b64_tr_b16 a[120:121],v2 offset:128
v_mbcnt_hi_u32_b32 v39,-1,v39
v_mfma_f32_16x16x32_bf16 v[212:215],a[140:143],v[48:51],v[212:215]
ds_read_b64_tr_b16 a[124:125],v3 offset:128
v_and_b32 v38,7,v39
v_mfma_f32_16x16x32_bf16 v[208:211],a[136:139],v[48:51],v[208:211]
ds_read_b64_tr_b16 a[126:127],v3 offset:6272
v_add_f32 v68,v68,v69
v_mfma_f32_16x16x32_bf16 v[112:115],a[136:139],v[52:55],v[112:115]
ds_read_b64_tr_b16 a[128:129],v4 offset:128
v_add_f32 v68,v68,v70
v_mfma_f32_16x16x32_bf16 v[116:119],a[140:143],v[52:55],v[116:119]
ds_read_b64_tr_b16 a[130:131],v4 offset:6272
v_add_f32 v62,v62,v63
v_mfma_f32_16x16x32_bf16 a[164:167],a[140:143],v[56:59],a[164:167]
ds_read_b64_tr_b16 a[132:133],v5 offset:128
v_add_f32 v66,v66,v67
v_mfma_f32_16x16x32_bf16 a[160:163],a[136:139],v[56:59],a[160:163]
ds_read_b64_tr_b16 a[134:135],v5 offset:6272
v_add_f32 v60,v60,v61
v_mfma_f32_16x16x32_bf16 a[208:211],a[136:139],v[40:43],a[208:211]
ds_read_b64_tr_b16 a[136:137],v2 offset:256
v_add_f32 v64,v64,v65
v_mfma_f32_16x16x32_bf16 a[212:215],a[140:143],v[40:43],a[212:215]
ds_read_b64_tr_b16 a[138:139],v2 offset:6400
v_add_f32 v68,v68,v71
v_mfma_f32_16x16x32_bf16 a[216:219],a[144:147],v[40:43],a[216:219]
s_waitcnt lgkmcnt(6)
ds_read_b64_tr_b16 a[142:143],v3 offset:6400
v_max3_f32 v19,v60,v62,v64
v_mfma_f32_16x16x32_bf16 a[220:223],a[148:151],v[40:43],a[220:223]
ds_read_b64_tr_b16 a[140:141],v3 offset:256
v_max3_f32 v19,v19,v66,v68
v_rcp_f32 v68,v68
v_rcp_f32 v66,v66
v_accvgpr_read_b32 v72,a160
v_accvgpr_read_b32 v77,a209
v_accvgpr_read_b32 v75,a163
v_accvgpr_read_b32 v73,a161
v_pk_mul_f32 v[72:73],v[72:73],v[66:67] op_sel_hi:[1,0]
v_accvgpr_read_b32 v74,a162
v_pk_mul_f32 v[74:75],v[74:75],v[66:67] op_sel_hi:[1,0]
v_accvgpr_read_b32 v76,a208
v_pk_mul_f32 v[76:77],v[76:77],v[68:69] op_sel_hi:[1,0]
v_accvgpr_read_b32 v79,a211
v_accvgpr_read_b32 v78,a210
v_pk_mul_f32 v[78:79],v[78:79],v[68:69] op_sel_hi:[1,0]
v_accvgpr_read_b32 v80,a164
v_accvgpr_read_b32 v83,a167
v_mfma_f32_16x16x32_bf16 a[172:175],a[148:151],v[56:59],a[172:175]
v_accvgpr_read_b32 v84,a212
v_accvgpr_read_b32 v82,a166
v_accvgpr_read_b32 v87,a215
v_accvgpr_read_b32 v81,a165
v_accvgpr_read_b32 v86,a214
v_pk_mul_f32 v[80:81],v[80:81],v[66:67] op_sel_hi:[1,0]
v_pk_mul_f32 v[86:87],v[86:87],v[68:69] op_sel_hi:[1,0]
v_pk_mul_f32 v[82:83],v[82:83],v[66:67] op_sel_hi:[1,0]
v_accvgpr_read_b32 v85,a213
v_pk_mul_f32 v[84:85],v[84:85],v[68:69] op_sel_hi:[1,0]
v_accvgpr_read_b32 v95,a219
v_accvgpr_read_b32 v92,a216
v_mfma_f32_16x16x32_bf16 a[168:171],a[144:147],v[56:59],a[168:171]
v_accvgpr_read_b32 v93,a217
v_accvgpr_read_b32 v94,a218
v_mfma_f32_16x16x32_bf16 v[120:123],a[144:147],v[52:55],v[120:123]
v_accvgpr_read_b32 v97,a173
v_accvgpr_read_b32 v100,a220
v_mfma_f32_16x16x32_bf16 v[124:127],a[148:151],v[52:55],v[124:127]
v_accvgpr_read_b32 v102,a222
v_accvgpr_read_b32 v96,a172
v_mfma_f32_16x16x32_bf16 v[220:223],a[148:151],v[48:51],v[220:223]
v_accvgpr_read_b32 v89,a169
v_accvgpr_read_b32 v90,a170
v_accvgpr_read_b32 v91,a171
v_accvgpr_read_b32 v88,a168
v_accvgpr_read_b32 v103,a223
v_pk_mul_f32 v[92:93],v[92:93],v[68:69] op_sel_hi:[1,0]
v_pk_mul_f32 v[88:89],v[88:89],v[66:67] op_sel_hi:[1,0]
v_pk_mul_f32 v[94:95],v[94:95],v[68:69] op_sel_hi:[1,0]
v_pk_mul_f32 v[90:91],v[90:91],v[66:67] op_sel_hi:[1,0]
v_accvgpr_read_b32 v99,a175
v_accvgpr_read_b32 v98,a174
v_mfma_f32_16x16x32_bf16 v[216:219],a[144:147],v[48:51],v[216:219]
v_accvgpr_read_b32 v101,a221
v_cmp_ngt_f32 vcc,s37,v19
v_lshrrev_b32 v19,5,v39
v_xor_b32 v38,v38,v19
v_and_b32 v19,15,v39
v_pk_mul_f32 v[102:103],v[102:103],v[68:69] op_sel_hi:[1,0]
v_pk_mul_f32 v[100:101],v[100:101],v[68:69] op_sel_hi:[1,0]
v_pk_mul_f32 v[98:99],v[98:99],v[66:67] op_sel_hi:[1,0]
v_pk_mul_f32 v[96:97],v[96:97],v[66:67] op_sel_hi:[1,0]
v_lshl_add_u32 v19,v19,7,s24
v_lshl_add_u32 v19,v38,4,v19
v_mfma_f32_16x16x32_bf16 v[168:171],a[144:147],v[44:47],v[168:171]
s_cmp_lg_u64 vcc,0
ds_read_b64_tr_b16 a[144:145],v4 offset:256
v_bfe_u32 v38,v39,4,1
v_mfma_f32_16x16x32_bf16 v[172:175],a[148:151],v[44:47],v[172:175]
s_cselect_b32 s62,s32,0
ds_read_b64_tr_b16 a[146:147],v4 offset:6400
v_lshl_add_u32 v36,v38,3,v19
v_mfma_f32_16x16x32_bf16 v[176:179],a[120:123],v[44:47],v[176:179]
s_or_b32 s31,s31,s62
ds_read_b64_tr_b16 a[148:149],v5 offset:256
v_xor_b32 v37,32,v36
v_mfma_f32_16x16x32_bf16 v[180:183],a[124:127],v[44:47],v[180:183]
s_lshl_b32 s32,s32,1
ds_read_b64_tr_b16 a[150:151],v5 offset:6400
v_xor_b32 v38,64,v36
v_mfma_f32_16x16x32_bf16 v[228:231],a[124:127],v[48:51],v[228:231]
s_add_u32 m0,s23,0
v_bfe_u32 v19,v39,3,1
v_xor_b32 v39,96,v36
v_mfma_f32_16x16x32_bf16 v[224:227],a[120:123],v[48:51],v[224:227]
v_lshlrev_b32 v19,11,v19
v_cvt_pk_bf16_f32 v76,v76,v77
v_mfma_f32_16x16x32_bf16 v[128:131],a[120:123],v[52:55],v[128:131]
v_cvt_pk_bf16_f32 v77,v78,v79
v_cvt_pk_bf16_f32 v84,v84,v85
v_mfma_f32_16x16x32_bf16 v[132:135],a[124:127],v[52:55],v[132:135]
v_cvt_pk_bf16_f32 v85,v86,v87
v_cvt_pk_bf16_f32 v72,v72,v73
v_mfma_f32_16x16x32_bf16 a[180:183],a[124:127],v[56:59],a[180:183]
v_cvt_pk_bf16_f32 v80,v80,v81
v_cvt_pk_bf16_f32 v73,v74,v75
v_mfma_f32_16x16x32_bf16 a[176:179],a[120:123],v[56:59],a[176:179]
ds_write2st64_b64 v36,v[72:73],v[76:77] offset0:36 offset1:40
v_mfma_f32_16x16x32_bf16 a[224:227],a[120:123],v[40:43],a[224:227]
v_cvt_pk_bf16_f32 v81,v82,v83
v_cvt_pk_bf16_f32 v92,v92,v93
v_mfma_f32_16x16x32_bf16 a[228:231],a[124:127],v[40:43],a[228:231]
s_waitcnt lgkmcnt(1)
v_cvt_pk_bf16_f32 v88,v88,v89
v_cvt_pk_bf16_f32 v93,v94,v95
v_mfma_f32_16x16x32_bf16 a[232:235],a[128:131],v[40:43],a[232:235]
v_accvgpr_read_b32 v83,a179
v_accvgpr_read_b32 v82,a178
v_mfma_f32_16x16x32_bf16 a[236:239],a[132:135],v[40:43],a[236:239]
ds_write2st64_b64 v37,v[80:81],v[84:85] offset0:36 offset1:40
v_pk_mul_f32 v[82:83],v[82:83],v[66:67] op_sel_hi:[1,0]
v_accvgpr_read_b32 v81,a177
v_accvgpr_read_b32 v84,a224
v_accvgpr_read_b32 v86,a226
v_accvgpr_read_b32 v87,a227
v_pk_mul_f32 v[86:87],v[86:87],v[68:69] op_sel_hi:[1,0]
v_accvgpr_read_b32 v80,a176
v_pk_mul_f32 v[80:81],v[80:81],v[66:67] op_sel_hi:[1,0]
v_accvgpr_read_b32 v85,a225
v_pk_mul_f32 v[84:85],v[84:85],v[68:69] op_sel_hi:[1,0]
v_accvgpr_read_b32 v94,a230
v_cvt_pk_bf16_f32 v89,v90,v91
v_mfma_f32_16x16x32_bf16 a[188:191],a[132:135],v[56:59],a[188:191]
ds_write2st64_b64 v38,v[88:89],v[92:93] offset0:36 offset1:40
v_accvgpr_read_b32 v89,a181
v_accvgpr_read_b32 v91,a183
v_accvgpr_read_b32 v92,a228
v_accvgpr_read_b32 v93,a229
v_pk_mul_f32 v[92:93],v[92:93],v[68:69] op_sel_hi:[1,0]
v_accvgpr_read_b32 v95,a231
v_pk_mul_f32 v[94:95],v[94:95],v[68:69] op_sel_hi:[1,0]
v_accvgpr_read_b32 v88,a180
v_pk_mul_f32 v[88:89],v[88:89],v[66:67] op_sel_hi:[1,0]
v_accvgpr_read_b32 v90,a182
v_pk_mul_f32 v[90:91],v[90:91],v[66:67] op_sel_hi:[1,0]
v_cvt_pk_bf16_f32 v100,v100,v101
v_cvt_pk_bf16_f32 v101,v102,v103
v_mfma_f32_16x16x32_bf16 a[184:187],a[128:131],v[56:59],a[184:187]
v_cvt_pk_bf16_f32 v96,v96,v97
v_cvt_pk_bf16_f32 v97,v98,v99
v_mfma_f32_16x16x32_bf16 v[136:139],a[128:131],v[52:55],v[136:139]
ds_write2st64_b64 v39,v[96:97],v[100:101] offset0:36 offset1:40
v_mfma_f32_16x16x32_bf16 v[140:143],a[132:135],v[52:55],v[140:143]
v_cvt_pk_bf16_f32 v84,v84,v85
v_cvt_pk_bf16_f32 v80,v80,v81
v_mfma_f32_16x16x32_bf16 v[236:239],a[132:135],v[48:51],v[236:239]
s_waitcnt vmcnt(15)
ds_read_b128 a[68:71],v12 offset:12544
v_cvt_pk_bf16_f32 v81,v82,v83
ds_read_b128 a[64:67],v11 offset:12544
v_accvgpr_read_b32 v83,a191
ds_read_b128 a[60:63],v12 offset:12416
v_cvt_pk_bf16_f32 v85,v86,v87
ds_read_b128 a[56:59],v11 offset:12416
v_accvgpr_read_b32 v100,a232
ds_read_b128 a[52:55],v12 offset:12288
v_accvgpr_read_b32 v82,a190
ds_read_b128 a[48:51],v11 offset:12288
v_pk_mul_f32 v[82:83],v[82:83],v[66:67] op_sel_hi:[1,0]
ds_read_b128 v[104:107],v10 offset:18432
v_accvgpr_read_b32 v103,a235
ds_read_b128 v[108:111],v10 offset:19456
v_accvgpr_read_b32 v98,a186
ds_read_b128 v[72:75],v10 offset:20480
v_accvgpr_read_b32 v97,a185
ds_read_b128 v[76:79],v10 offset:21504
v_accvgpr_read_b32 v102,a234
ds_write2st64_b64 v36,v[80:81],v[84:85] offset0:36 offset1:40
v_pk_mul_f32 v[102:103],v[102:103],v[68:69] op_sel_hi:[1,0]
v_accvgpr_read_b32 v85,a237
v_accvgpr_read_b32 v101,a233
v_pk_mul_f32 v[100:101],v[100:101],v[68:69] op_sel_hi:[1,0]
v_accvgpr_read_b32 v80,a188
v_accvgpr_read_b32 v96,a184
v_pk_mul_f32 v[96:97],v[96:97],v[66:67] op_sel_hi:[1,0]
s_waitcnt lgkmcnt(4)
buffer_store_dwordx4 v[104:107],v9,s[16:19],s87 offen offset:0 nt
v_accvgpr_read_b32 v87,a239
v_accvgpr_read_b32 v86,a238
v_pk_mul_f32 v[86:87],v[86:87],v[68:69] op_sel_hi:[1,0]
v_accvgpr_read_b32 v99,a187
v_pk_mul_f32 v[98:99],v[98:99],v[66:67] op_sel_hi:[1,0]
v_accvgpr_read_b32 v81,a189
v_pk_mul_f32 v[80:81],v[80:81],v[66:67] op_sel_hi:[1,0]
v_accvgpr_read_b32 v84,a236
v_pk_mul_f32 v[84:85],v[84:85],v[68:69] op_sel_hi:[1,0]
v_cvt_pk_bf16_f32 v100,v100,v101
v_cvt_pk_bf16_f32 v96,v96,v97
v_mfma_f32_16x16x32_bf16 v[232:235],a[128:131],v[48:51],v[232:235]
s_waitcnt lgkmcnt(1)
buffer_store_dwordx4 v[108:111],v9,s[16:19],s87 offen offset:3072 nt
v_cvt_pk_bf16_f32 v88,v88,v89
v_cvt_pk_bf16_f32 v92,v92,v93
v_cvt_pk_bf16_f32 v80,v80,v81
v_mfma_f32_16x16x32_bf16 v[184:187],a[128:131],v[44:47],v[184:187]
v_cvt_pk_bf16_f32 v89,v90,v91
v_cvt_pk_bf16_f32 v93,v94,v95
v_mfma_f32_16x16x32_bf16 v[188:191],a[132:135],v[44:47],v[188:191]
v_cvt_pk_bf16_f32 v84,v84,v85
v_cvt_pk_bf16_f32 v97,v98,v99
v_mfma_f32_16x16x32_bf16 v[192:195],a[136:139],v[44:47],v[192:195]
ds_write2st64_b64 v37,v[88:89],v[92:93] offset0:36 offset1:40
v_mfma_f32_16x16x32_bf16 v[196:199],a[140:143],v[44:47],v[196:199]
v_cvt_pk_bf16_f32 v101,v102,v103
v_cvt_pk_bf16_f32 v81,v82,v83
v_mfma_f32_16x16x32_bf16 v[244:247],a[140:143],v[48:51],v[244:247]
buffer_store_dwordx4 v[72:75],v9,s[16:19],s66 offen offset:0 nt
v_cvt_pk_bf16_f32 v85,v86,v87
v_rcp_f32 v62,v62
v_mfma_f32_16x16x32_bf16 v[240:243],a[136:139],v[48:51],v[240:243]
v_rcp_f32 v64,v64
v_mfma_f32_16x16x32_bf16 v[144:147],a[136:139],v[52:55],v[144:147]
v_rcp_f32 v60,v60
v_mfma_f32_16x16x32_bf16 v[148:151],a[140:143],v[52:55],v[148:151]
ds_write2st64_b64 v38,v[96:97],v[100:101] offset0:36 offset1:40
v_mfma_f32_16x16x32_bf16 a[196:199],a[140:143],v[56:59],a[196:199]
v_mfma_f32_16x16x32_bf16 a[192:195],a[136:139],v[56:59],a[192:195]
buffer_store_dwordx4 v[76:79],v9,s[16:19],s66 offen offset:3072 nt
v_mfma_f32_16x16x32_bf16 a[240:243],a[136:139],v[40:43],a[240:243]
v_mfma_f32_16x16x32_bf16 a[244:247],a[140:143],v[40:43],a[244:247]
v_mfma_f32_16x16x32_bf16 a[248:251],a[144:147],v[40:43],a[248:251]
ds_write2st64_b64 v39,v[80:81],v[84:85] offset0:36 offset1:40
v_mfma_f32_16x16x32_bf16 a[252:255],a[148:151],v[40:43],a[252:255]
ds_read_b128 v[72:75],v10 offset:18432
s_waitcnt vmcnt(4)
s_barrier
ds_read_b128 v[76:79],v10 offset:19456
v_accvgpr_read_b32 v104,a192
ds_read_b128 v[88:91],v10 offset:20480
v_accvgpr_read_b32 v109,a241
ds_read_b128 v[92:95],v10 offset:21504
v_accvgpr_read_b32 v107,a195
ds_read_b128 a[140:143],v1 offset:256
v_accvgpr_read_b32 v106,a194
ds_read_b128 a[136:139],v0 offset:256
buffer_load_dwordx4 v6,s[8:11],s25 offen offset:0 lds
s_waitcnt lgkmcnt(5)
buffer_store_dwordx4 v[72:75],v9,s[16:19],s87 offen offset:128 nt
ds_read_b128 a[132:135],v1 offset:128
v_pk_mul_f32 v[106:107],v[106:107],v[66:67] op_sel_hi:[1,0]
ds_read_b128 a[128:131],v0 offset:128
v_accvgpr_read_b32 v111,a243
ds_read_b128 a[124:127],v1 offset:0
v_accvgpr_read_b32 v110,a242
ds_read_b128 a[120:123],v0 offset:0
s_waitcnt lgkmcnt(7)
buffer_store_dwordx4 v[76:79],v9,s[16:19],s87 offen offset:3200 nt
v_pk_mul_f32 v[110:111],v[110:111],v[68:69] op_sel_hi:[1,0]
v_accvgpr_read_b32 v108,a240
v_pk_mul_f32 v[108:109],v[108:109],v[68:69] op_sel_hi:[1,0]
v_accvgpr_read_b32 v105,a193
v_pk_mul_f32 v[104:105],v[104:105],v[66:67] op_sel_hi:[1,0]
v_accvgpr_read_b32 v103,a247
v_accvgpr_read_b32 v100,a244
v_mfma_f32_16x16x32_bf16 a[204:207],a[148:151],v[56:59],a[204:207]
v_accvgpr_read_b32 v98,a198
buffer_load_dwordx4 v7,s[8:11],s25 offen offset:1024 lds
buffer_store_dwordx4 v[88:91],v9,s[16:19],s66 offen offset:128 nt
v_accvgpr_read_b32 v97,a197
v_accvgpr_read_b32 v99,a199
v_pk_mul_f32 v[98:99],v[98:99],v[66:67] op_sel_hi:[1,0]
v_accvgpr_read_b32 v101,a245
v_pk_mul_f32 v[100:101],v[100:101],v[68:69] op_sel_hi:[1,0]
v_accvgpr_read_b32 v96,a196
v_pk_mul_f32 v[96:97],v[96:97],v[66:67] op_sel_hi:[1,0]
v_accvgpr_read_b32 v102,a246
v_pk_mul_f32 v[102:103],v[102:103],v[68:69] op_sel_hi:[1,0]
v_accvgpr_read_b32 v85,a249
v_cvt_pk_bf16_f32 v104,v104,v105
v_mfma_f32_16x16x32_bf16 a[200:203],a[144:147],v[56:59],a[200:203]
s_waitcnt lgkmcnt(0)
buffer_store_dwordx4 v[92:95],v9,s[16:19],s66 offen offset:3200 nt
v_cvt_pk_bf16_f32 v108,v108,v109
v_cvt_pk_bf16_f32 v96,v96,v97
v_cvt_pk_bf16_f32 v100,v100,v101
v_mfma_f32_16x16x32_bf16 v[152:155],a[144:147],v[52:55],v[152:155]
v_accvgpr_read_b32 v86,a250
v_cvt_pk_bf16_f32 v109,v110,v111
v_mfma_f32_16x16x32_bf16 v[156:159],a[148:151],v[52:55],v[156:159]
v_accvgpr_read_b32 v81,a201
v_accvgpr_read_b32 v83,a203
v_mfma_f32_16x16x32_bf16 v[252:255],a[148:151],v[48:51],v[252:255]
buffer_load_dwordx4 v8,s[8:11],s25 offen offset:2048 lds
v_accvgpr_read_b32 v82,a202
v_cvt_pk_bf16_f32 v105,v106,v107
ds_write2st64_b64 v36,v[104:105],v[108:109] offset0:36 offset1:40
v_pk_mul_f32 v[82:83],v[82:83],v[66:67] op_sel_hi:[1,0]
v_pk_mul_f32 v[232:233],v[232:233],v[62:63] op_sel_hi:[1,0]
v_pk_mul_f32 v[238:239],v[238:239],v[62:63] op_sel_hi:[1,0]
v_pk_mul_f32 v[210:211],v[210:211],v[62:63] op_sel_hi:[1,0]
v_pk_mul_f32 v[212:213],v[212:213],v[62:63] op_sel_hi:[1,0]
v_pk_mul_f32 v[236:237],v[236:237],v[62:63] op_sel_hi:[1,0]
v_pk_mul_f32 v[214:215],v[214:215],v[62:63] op_sel_hi:[1,0]
v_pk_mul_f32 v[228:229],v[228:229],v[62:63] op_sel_hi:[1,0]
v_pk_mul_f32 v[220:221],v[220:221],v[62:63] op_sel_hi:[1,0]
v_pk_mul_f32 v[224:225],v[224:225],v[62:63] op_sel_hi:[1,0]
v_pk_mul_f32 v[218:219],v[218:219],v[62:63] op_sel_hi:[1,0]
v_pk_mul_f32 v[222:223],v[222:223],v[62:63] op_sel_hi:[1,0]
v_pk_mul_f32 v[226:227],v[226:227],v[62:63] op_sel_hi:[1,0]
v_pk_mul_f32 v[230:231],v[230:231],v[62:63] op_sel_hi:[1,0]
v_pk_mul_f32 v[234:235],v[234:235],v[62:63] op_sel_hi:[1,0]
v_pk_mul_f32 v[208:209],v[208:209],v[62:63] op_sel_hi:[1,0]
v_pk_mul_f32 v[216:217],v[216:217],v[62:63] op_sel_hi:[1,0]
v_add_u32 v36,v36,v19
v_accvgpr_read_b32 v108,a252
v_accvgpr_read_b32 v109,a253
v_pk_mul_f32 v[108:109],v[108:109],v[68:69] op_sel_hi:[1,0]
v_accvgpr_read_b32 v104,a204
v_accvgpr_read_b32 v106,a206
v_cvt_pk_bf16_f32 v97,v98,v99
v_cvt_pk_bf16_f32 v101,v102,v103
ds_write2st64_b64 v37,v[96:97],v[100:101] offset0:36 offset1:40
v_add_u32 v37,v37,v19
v_accvgpr_read_b32 v87,a251
v_pk_mul_f32 v[86:87],v[86:87],v[68:69] op_sel_hi:[1,0]
v_accvgpr_read_b32 v105,a205
v_pk_mul_f32 v[104:105],v[104:105],v[66:67] op_sel_hi:[1,0]
v_accvgpr_read_b32 v110,a254
v_accvgpr_read_b32 v80,a200
v_pk_mul_f32 v[80:81],v[80:81],v[66:67] op_sel_hi:[1,0]
v_cvt_pk_bf16_f32 v104,v104,v105
v_accvgpr_read_b32 v84,a248
v_pk_mul_f32 v[84:85],v[84:85],v[68:69] op_sel_hi:[1,0]
v_accvgpr_read_b32 v107,a207
v_pk_mul_f32 v[106:107],v[106:107],v[66:67] op_sel_hi:[1,0]
v_cvt_pk_bf16_f32 v80,v80,v81
v_cvt_pk_bf16_f32 v81,v82,v83
v_cvt_pk_bf16_f32 v108,v108,v109
v_cvt_pk_bf16_f32 v84,v84,v85
v_cvt_pk_bf16_f32 v85,v86,v87
ds_write2st64_b64 v38,v[80:81],v[84:85] offset0:36 offset1:40
v_add_u32 v38,v38,v19
v_accvgpr_read_b32 v111,a255
v_pk_mul_f32 v[110:111],v[110:111],v[68:69] op_sel_hi:[1,0]
v_cvt_pk_bf16_f32 v105,v106,v107
v_cvt_pk_bf16_f32 v109,v110,v111
v_mfma_f32_16x16x32_bf16 v[248:251],a[144:147],v[48:51],v[248:251]
s_waitcnt vmcnt(14)
ds_read_b128 a[72:75],v11 offset:0
v_cvt_pk_bf16_f32 v224,v224,v225
v_mfma_f32_16x16x32_bf16 v[200:203],a[144:147],v[44:47],v[200:203]
s_mov_b32 s27,s42
ds_read_b128 a[76:79],v12 offset:0
v_cvt_pk_bf16_f32 v212,v212,v213
v_mfma_f32_16x16x32_bf16 v[204:207],a[148:151],v[44:47],v[204:207]
s_mov_b32 s42,s41
ds_read_b128 a[80:83],v11 offset:128
v_cvt_pk_bf16_f32 v228,v228,v229
ds_read_b128 a[84:87],v12 offset:128
v_pk_mul_f32 v[112:113],v[112:113],v[64:65] op_sel_hi:[1,0]
ds_read_b128 a[88:91],v11 offset:256
v_pk_mul_f32 v[240:241],v[240:241],v[62:63] op_sel_hi:[1,0]
ds_read_b128 a[92:95],v12 offset:256
v_pk_mul_f32 v[114:115],v[114:115],v[64:65] op_sel_hi:[1,0]
ds_write2st64_b64 v39,v[104:105],v[108:109] offset0:36 offset1:40
v_pk_mul_f32 v[242:243],v[242:243],v[62:63] op_sel_hi:[1,0]
v_add_u32 v39,v39,v19
v_cvt_pk_bf16_f32 v229,v230,v231
ds_read_b128 v[72:75],v10 offset:18432
v_cvt_pk_bf16_f32 v225,v226,v227
ds_read_b128 v[76:79],v10 offset:19456
v_cvt_pk_bf16_f32 v236,v236,v237
ds_read_b128 v[88:91],v10 offset:20480
v_cvt_pk_bf16_f32 v208,v208,v209
ds_read_b128 v[92:95],v10 offset:21504
v_cvt_pk_bf16_f32 v209,v210,v211
ds_write2st64_b64 v36,v[208:209],v[224:225] offset0:12 offset1:14
v_cvt_pk_bf16_f32 v220,v220,v221
v_cvt_pk_bf16_f32 v216,v216,v217
v_cvt_pk_bf16_f32 v213,v214,v215
ds_read_b128 a[144:147],v0 offset:6144
v_cvt_pk_bf16_f32 v221,v222,v223
s_waitcnt lgkmcnt(5)
buffer_store_dwordx4 v[72:75],v9,s[16:19],s87 offen offset:256 nt
ds_read_b128 a[148:151],v1 offset:6144
v_cvt_pk_bf16_f32 v232,v232,v233
v_cvt_pk_bf16_f32 v233,v234,v235
v_mfma_f32_16x16x32_bf16 v[72:75],a[140:143],a[20:23],0
s_add_u32 s69,s69,1
v_cvt_pk_bf16_f32 v112,v112,v113
v_cvt_pk_bf16_f32 v217,v218,v219
v_mfma_f32_16x16x32_bf16 v[72:75],a[136:139],a[16:19],v[72:75]
s_lshl_b32 s62,s69,5
v_cvt_pk_bf16_f32 v237,v238,v239
v_cvt_pk_bf16_f32 v240,v240,v241
v_mfma_f32_16x16x32_bf16 v[72:75],a[132:135],a[12:15],v[72:75]
s_add_u32 s62,s62,s34
s_waitcnt lgkmcnt(2)
buffer_store_dwordx4 v[76:79],v9,s[16:19],s87 offen offset:3328 nt
v_cvt_pk_bf16_f32 v241,v242,v243
v_cvt_pk_bf16_f32 v113,v114,v115
v_pk_mul_f32 v[118:119],v[118:119],v[64:65] op_sel_hi:[1,0]
v_pk_mul_f32 v[116:117],v[116:117],v[64:65] op_sel_hi:[1,0]
v_pk_mul_f32 v[244:245],v[244:245],v[62:63] op_sel_hi:[1,0]
v_pk_mul_f32 v[246:247],v[246:247],v[62:63] op_sel_hi:[1,0]
v_cvt_pk_bf16_f32 v244,v244,v245
v_cvt_pk_bf16_f32 v116,v116,v117
v_mfma_f32_16x16x32_bf16 v[72:75],a[128:131],a[8:11],v[72:75]
s_mul_i32 s63,s62,171
v_cvt_pk_bf16_f32 v245,v246,v247
v_cvt_pk_bf16_f32 v117,v118,v119
v_mfma_f32_16x16x32_bf16 v[72:75],a[124:127],a[4:7],v[72:75]
s_lshr_b32 s63,s63,9
ds_write2st64_b64 v37,v[212:213],v[228:229] offset0:12 offset1:14
v_mfma_f32_16x16x32_bf16 v[72:75],a[120:123],a[0:3],v[72:75]
s_mul_i32 s64,s63,3
v_mov_b32 v66,0
buffer_store_dwordx4 v[88:91],v9,s[16:19],s66 offen offset:256 nt
v_pk_mul_f32 v[250:251],v[250:251],v[62:63] op_sel_hi:[1,0]
v_pk_mul_f32 v[120:121],v[120:121],v[64:65] op_sel_hi:[1,0]
v_pk_mul_f32 v[248:249],v[248:249],v[62:63] op_sel_hi:[1,0]
v_pk_mul_f32 v[122:123],v[122:123],v[64:65] op_sel_hi:[1,0]
v_cvt_pk_bf16_f32 v248,v248,v249
v_max3_f32 v44,v72,v73,v74
v_mfma_f32_16x16x32_bf16 v[80:83],a[120:123],a[24:27],0
s_sub_u32 s62,s62,s64
v_cvt_pk_bf16_f32 v249,v250,v251
v_cvt_pk_bf16_f32 v120,v120,v121
v_mfma_f32_16x16x32_bf16 v[80:83],a[124:127],a[28:31],v[80:83]
s_add_u32 s63,s63,s33
ds_write2st64_b64 v38,v[216:217],v[232:233] offset0:12 offset1:14
v_mfma_f32_16x16x32_bf16 v[80:83],a[128:131],a[32:35],v[80:83]
s_mul_i32 s30,s63,196608
v_cvt_pk_bf16_f32 v121,v122,v123
buffer_store_dwordx4 v[92:95],v9,s[16:19],s66 offen offset:3328 nt
v_pk_mul_f32 v[254:255],v[254:255],v[62:63] op_sel_hi:[1,0]
v_pk_mul_f32 v[126:127],v[126:127],v[64:65] op_sel_hi:[1,0]
v_pk_mul_f32 v[124:125],v[124:125],v[64:65] op_sel_hi:[1,0]
v_pk_mul_f32 v[252:253],v[252:253],v[62:63] op_sel_hi:[1,0]
v_cvt_pk_bf16_f32 v124,v124,v125
v_cvt_pk_bf16_f32 v252,v252,v253
v_mfma_f32_16x16x32_bf16 v[80:83],a[132:135],a[36:39],v[80:83]
s_mul_i32 s41,s63,325632
v_cvt_pk_bf16_f32 v253,v254,v255
v_cvt_pk_bf16_f32 v125,v126,v127
v_mfma_f32_16x16x32_bf16 v[80:83],a[136:139],a[40:43],v[80:83]
s_lshl_b32 s63,s3,2
ds_write2st64_b64 v39,v[220:221],v[236:237] offset0:12 offset1:14
v_mfma_f32_16x16x32_bf16 v[80:83],a[140:143],a[44:47],v[80:83]
s_add_u32 s64,s63,21
v_mov_b32 v63,0
v_mov_b32 v62,0
v_mfma_f32_16x16x32_bf16 v[88:91],a[140:143],a[68:71],0
s_cmp_eq_u32 s3,0
v_mov_b32 v67,0
s_cselect_b32 s64,20,s64
s_cselect_b32 s40,1,0
s_add_u32 s65,s63,37
v_max3_f32 v48,v80,v81,v82
ds_write2st64_b64 v36,v[240:241],v[112:113] offset0:16 offset1:24
v_pk_mul_f32 v[130:131],v[130:131],v[64:65] op_sel_hi:[1,0]
v_pk_mul_f32 v[146:147],v[146:147],v[64:65] op_sel_hi:[1,0]
v_pk_mul_f32 v[128:129],v[128:129],v[64:65] op_sel_hi:[1,0]
v_pk_mul_f32 v[144:145],v[144:145],v[64:65] op_sel_hi:[1,0]
v_cvt_pk_bf16_f32 v128,v128,v129
v_cvt_pk_bf16_f32 v129,v130,v131
v_mfma_f32_16x16x32_bf16 v[88:91],a[136:139],a[64:67],v[88:91]
s_cmp_eq_u32 s62,2
v_cvt_pk_bf16_f32 v144,v144,v145
v_cvt_pk_bf16_f32 v145,v146,v147
v_mfma_f32_16x16x32_bf16 v[88:91],a[132:135],a[60:63],v[88:91]
s_cselect_b32 s64,s65,s64
s_cselect_b32 s40,0,s40
ds_write2st64_b64 v37,v[244:245],v[116:117] offset0:16 offset1:24
v_mfma_f32_16x16x32_bf16 v[88:91],a[128:131],a[56:59],v[88:91]
s_add_u32 s65,s63,s3
s_cmp_eq_u32 s62,0
s_cselect_b32 s64,s65,s64
s_cselect_b32 s40,1,s40
s_mul_i32 s64,s64,6144
s_add_u32 s41,s41,s64
v_pk_mul_f32 v[132:133],v[132:133],v[64:65] op_sel_hi:[1,0]
v_pk_mul_f32 v[148:149],v[148:149],v[64:65] op_sel_hi:[1,0]
v_pk_mul_f32 v[134:135],v[134:135],v[64:65] op_sel_hi:[1,0]
v_pk_mul_f32 v[150:151],v[150:151],v[64:65] op_sel_hi:[1,0]
v_cvt_pk_bf16_f32 v132,v132,v133
v_cvt_pk_bf16_f32 v148,v148,v149
v_mfma_f32_16x16x32_bf16 v[88:91],a[124:127],a[52:55],v[88:91]
s_cmp_ge_u32 s69,6
ds_write2st64_b64 v38,v[248:249],v[120:121] offset0:16 offset1:24
v_mfma_f32_16x16x32_bf16 v[88:91],a[120:123],a[48:51],v[88:91]
s_cselect_b32 s41,166723584,s41
v_cvt_pk_bf16_f32 v133,v134,v135
v_cvt_pk_bf16_f32 v149,v150,v151
v_mfma_f32_16x16x32_bf16 v[96:99],a[120:123],a[72:75],0
s_cselect_b32 s30,100663296,s30
ds_read_b128 a[120:123],v0 offset:6272
s_add_u32 s25,s30,s22
s_add_u32 s26,s25,12288
s_add_u32 m0,s23,24576
v_max3_f32 v52,v88,v89,v90
ds_write2st64_b64 v39,v[252:253],v[124:125] offset0:16 offset1:24
v_pk_mul_f32 v[154:155],v[154:155],v[64:65] op_sel_hi:[1,0]
v_pk_mul_f32 v[152:153],v[152:153],v[64:65] op_sel_hi:[1,0]
v_pk_mul_f32 v[138:139],v[138:139],v[64:65] op_sel_hi:[1,0]
v_pk_mul_f32 v[136:137],v[136:137],v[64:65] op_sel_hi:[1,0]
v_cvt_pk_bf16_f32 v152,v152,v153
v_cvt_pk_bf16_f32 v136,v136,v137
v_mfma_f32_16x16x32_bf16 v[96:99],a[124:127],a[76:79],v[96:99]
s_mov_b32 s28,s41
ds_read_b128 a[124:127],v1 offset:6272
v_cvt_pk_bf16_f32 v137,v138,v139
v_mfma_f32_16x16x32_bf16 v[96:99],a[128:131],a[80:83],v[96:99]
s_mov_b32 s29,s24
ds_read_b128 a[128:131],v0 offset:6400
v_cvt_pk_bf16_f32 v153,v154,v155
v_mfma_f32_16x16x32_bf16 v[96:99],a[132:135],a[84:87],v[96:99]
ds_write2st64_b64 v36,v[128:129],v[144:145] offset0:26 offset1:28
v_pk_mul_f32 v[156:157],v[156:157],v[64:65] op_sel_hi:[1,0]
v_pk_mul_f32 v[142:143],v[142:143],v[64:65] op_sel_hi:[1,0]
v_pk_mul_f32 v[158:159],v[158:159],v[64:65] op_sel_hi:[1,0]
ds_read_b128 a[132:135],v1 offset:6400
v_pk_mul_f32 v[140:141],v[140:141],v[64:65] op_sel_hi:[1,0]
v_cvt_pk_bf16_f32 v156,v156,v157
v_cvt_pk_bf16_f32 v140,v140,v141
v_mfma_f32_16x16x32_bf16 v[96:99],a[136:139],a[88:91],v[96:99]
ds_read_b128 a[136:139],v0 offset:12288
v_cvt_pk_bf16_f32 v141,v142,v143
v_mfma_f32_16x16x32_bf16 v[96:99],a[140:143],a[92:95],v[96:99]
s_waitcnt lgkmcnt(4)
ds_write2st64_b64 v37,v[132:133],v[148:149] offset0:26 offset1:28
v_mfma_f32_16x16x32_bf16 v[76:79],a[144:147],a[0:3],0
v_cvt_pk_bf16_f32 v157,v158,v159
ds_read_b128 a[140:143],v1 offset:12288
v_mov_b32 v65,0
v_pk_mul_f32 v[162:163],v[162:163],v[60:61] op_sel_hi:[1,0]
v_pk_mul_f32 v[176:177],v[176:177],v[60:61] op_sel_hi:[1,0]
v_pk_mul_f32 v[160:161],v[160:161],v[60:61] op_sel_hi:[1,0]
v_pk_mul_f32 v[178:179],v[178:179],v[60:61] op_sel_hi:[1,0]
v_max3_f32 v56,v96,v97,v98
v_cvt_pk_bf16_f32 v160,v160,v161
v_mfma_f32_16x16x32_bf16 v[76:79],a[148:151],a[4:7],v[76:79]
ds_write2st64_b64 v38,v[136:137],v[152:153] offset0:26 offset1:28
v_mfma_f32_16x16x32_bf16 v[76:79],a[120:123],a[8:11],v[76:79]
v_cvt_pk_bf16_f32 v161,v162,v163
v_cvt_pk_bf16_f32 v176,v176,v177
v_mfma_f32_16x16x32_bf16 v[76:79],a[124:127],a[12:15],v[76:79]
s_waitcnt lgkmcnt(2)
v_cvt_pk_bf16_f32 v177,v178,v179
v_mov_b32 v64,0
v_mfma_f32_16x16x32_bf16 v[76:79],a[128:131],a[16:19],v[76:79]
ds_write2st64_b64 v39,v[140:141],v[156:157] offset0:26 offset1:28
v_pk_mul_f32 v[180:181],v[180:181],v[60:61] op_sel_hi:[1,0]
v_pk_mul_f32 v[164:165],v[164:165],v[60:61] op_sel_hi:[1,0]
v_pk_mul_f32 v[166:167],v[166:167],v[60:61] op_sel_hi:[1,0]
v_pk_mul_f32 v[182:183],v[182:183],v[60:61] op_sel_hi:[1,0]
v_cvt_pk_bf16_f32 v164,v164,v165
v_cvt_pk_bf16_f32 v180,v180,v181
v_mfma_f32_16x16x32_bf16 v[76:79],a[132:135],a[20:23],v[76:79]
v_cvt_pk_bf16_f32 v181,v182,v183
v_cvt_pk_bf16_f32 v165,v166,v167
v_mfma_f32_16x16x32_bf16 v[84:87],a[132:135],a[44:47],0
buffer_load_dwordx4 v6,s[8:11],s21 offen offset:0 lds
v_mfma_f32_16x16x32_bf16 v[84:87],a[128:131],a[40:43],v[84:87]
ds_write2st64_b64 v36,v[160:161],v[176:177] offset0:0 offset1:2
v_pk_mul_f32 v[186:187],v[186:187],v[60:61] op_sel_hi:[1,0]
v_pk_mul_f32 v[170:171],v[170:171],v[60:61] op_sel_hi:[1,0]
v_pk_mul_f32 v[168:169],v[168:169],v[60:61] op_sel_hi:[1,0]
v_pk_mul_f32 v[184:185],v[184:185],v[60:61] op_sel_hi:[1,0]
v_max3_f32 v44,v44,v75,v76
v_max3_f32 v44,v44,v77,v78
v_mfma_f32_16x16x32_bf16 v[84:87],a[124:127],a[36:39],v[84:87]
v_max_f32 v44,v44,v79
v_mov_b32 v45,v44
v_mfma_f32_16x16x32_bf16 v[84:87],a[120:123],a[32:35],v[84:87]
v_cvt_pk_bf16_f32 v168,v168,v169
v_permlane32_swap_b32 v45,v44
v_mfma_f32_16x16x32_bf16 v[84:87],a[148:151],a[28:31],v[84:87]
ds_write2st64_b64 v37,v[164:165],v[180:181] offset0:0 offset1:2
v_pk_mul_f32 v[174:175],v[174:175],v[60:61] op_sel_hi:[1,0]
v_pk_mul_f32 v[190:191],v[190:191],v[60:61] op_sel_hi:[1,0]
v_pk_mul_f32 v[188:189],v[188:189],v[60:61] op_sel_hi:[1,0]
buffer_load_dwordx4 v7,s[8:11],s21 offen offset:1024 lds
v_pk_mul_f32 v[172:173],v[172:173],v[60:61] op_sel_hi:[1,0]
v_max_f32 v44,v44,v45
v_mov_b32 v45,v44
v_mfma_f32_16x16x32_bf16 v[84:87],a[144:147],a[24:27],v[84:87]
v_cvt_pk_bf16_f32 v169,v170,v171
v_permlane16_swap_b32 v45,v44
v_mfma_f32_16x16x32_bf16 v[92:95],a[144:147],a[48:51],0
v_max_f32 v44,v44,v45
v_mul_f32_e64 v13,-s36,v44
v_mfma_f32_16x16x32_bf16 v[92:95],a[148:151],a[52:55],v[92:95]
v_fma_f32 v72,v72,s36,v13
v_fma_f32 v74,v74,s36,v13
v_fma_f32 v75,v75,s36,v13
v_exp_f32 v74,v74
v_pk_mul_f32 v[194:195],v[194:195],v[60:61] op_sel_hi:[1,0]
v_pk_mul_f32 v[192:193],v[192:193],v[60:61] op_sel_hi:[1,0]
v_exp_f32 v72,v72
v_exp_f32 v75,v75
v_mfma_f32_16x16x32_bf16 v[92:95],a[120:123],a[56:59],v[92:95]
buffer_load_dwordx4 v8,s[8:11],s21 offen offset:2048 lds
v_mfma_f32_16x16x32_bf16 v[92:95],a[124:127],a[60:63],v[92:95]
s_add_u32 s21,s21,12288
v_fma_f32 v73,v73,s36,v13
v_exp_f32 v73,v73
v_mfma_f32_16x16x32_bf16 v[92:95],a[128:131],a[64:67],v[92:95]
s_add_u32 m0,s22,0
v_cvt_pk_bf16_f32 v21,v74,v75
v_cvt_pk_bf16_f32 v20,v72,v73
v_mfma_f32_16x16x32_bf16 v[92:95],a[132:135],a[68:71],v[92:95]
v_max3_f32 v48,v48,v83,v84
v_max3_f32 v48,v48,v85,v86
v_max_f32 v48,v48,v87
v_mov_b32 v49,v48
v_fma_f32 v78,v78,s36,v13
v_pk_mul_f32 v[198:199],v[198:199],v[60:61] op_sel_hi:[1,0]
v_pk_mul_f32 v[196:197],v[196:197],v[60:61] op_sel_hi:[1,0]
v_permlane32_swap_b32 v49,v48
v_max_f32 v48,v48,v49
v_mfma_f32_16x16x32_bf16 v[100:103],a[132:135],a[92:95],0
ds_read_b128 a[132:135],v1 offset:18432
v_mov_b32 v49,v48
v_mfma_f32_16x16x32_bf16 v[100:103],a[128:131],a[88:91],v[100:103]
ds_read_b128 a[128:131],v0 offset:18432
v_permlane16_swap_b32 v49,v48
v_mfma_f32_16x16x32_bf16 v[100:103],a[124:127],a[84:87],v[100:103]
ds_read_b128 a[124:127],v1 offset:12544
v_max_f32 v48,v48,v49
v_mul_f32_e64 v14,-s36,v48
v_fma_f32 v82,v82,s36,v14
v_fma_f32 v80,v80,s36,v14
v_pk_mul_f32 v[200:201],v[200:201],v[60:61] op_sel_hi:[1,0]
v_pk_mul_f32 v[202:203],v[202:203],v[60:61] op_sel_hi:[1,0]
v_exp_f32 v80,v80
v_exp_f32 v82,v82
v_mfma_f32_16x16x32_bf16 v[100:103],a[120:123],a[80:83],v[100:103]
ds_read_b128 a[120:123],v0 offset:12544
v_fma_f32 v83,v83,s36,v14
v_mfma_f32_16x16x32_bf16 v[100:103],a[148:151],a[76:79],v[100:103]
ds_read_b128 a[148:151],v1 offset:12416
v_exp_f32 v83,v83
v_mfma_f32_16x16x32_bf16 v[100:103],a[144:147],a[72:75],v[100:103]
ds_read_b128 a[144:147],v0 offset:12416
v_fma_f32 v81,v81,s36,v14
v_exp_f32 v81,v81
v_cvt_pk_bf16_f32 v25,v82,v83
v_pk_mul_f32 v[206:207],v[206:207],v[60:61] op_sel_hi:[1,0]
v_pk_mul_f32 v[204:205],v[204:205],v[60:61] op_sel_hi:[1,0]
v_cvt_pk_bf16_f32 v24,v80,v81
v_max3_f32 v52,v52,v91,v92
s_waitcnt lgkmcnt(3)
v_mfma_f32_16x16x32_bf16 v[72:75],a[124:127],a[20:23],0
v_max3_f32 v52,v52,v93,v94
v_max_f32 v52,v52,v95
v_mov_b32 v53,v52
v_max3_f32 v56,v56,v99,v100
v_max3_f32 v56,v56,v101,v102
v_permlane32_swap_b32 v53,v52
v_max_f32 v52,v52,v53
v_mov_b32 v53,v52
v_max_f32 v56,v56,v103
s_waitcnt lgkmcnt(2)
v_mfma_f32_16x16x32_bf16 v[72:75],a[120:123],a[16:19],v[72:75]
s_waitcnt lgkmcnt(1)
v_permlane16_swap_b32 v53,v52
v_mfma_f32_16x16x32_bf16 v[72:75],a[148:151],a[12:15],v[72:75]
s_waitcnt lgkmcnt(0)
v_max_f32 v52,v52,v53
v_mul_f32_e64 v15,-s36,v52
v_fma_f32 v91,v91,s36,v15
v_mfma_f32_16x16x32_bf16 v[72:75],a[144:147],a[8:11],v[72:75]
v_fma_f32 v88,v88,s36,v15
v_exp_f32 v88,v88
v_mfma_f32_16x16x32_bf16 v[72:75],a[140:143],a[4:7],v[72:75]
v_fma_f32 v89,v89,s36,v15
v_exp_f32 v89,v89
v_mfma_f32_16x16x32_bf16 v[72:75],a[136:139],a[0:3],v[72:75]
v_fma_f32 v90,v90,s36,v15
v_exp_f32 v90,v90
v_mfma_f32_16x16x32_bf16 v[80:83],a[136:139],a[24:27],0
v_exp_f32 v91,v91
v_mfma_f32_16x16x32_bf16 v[80:83],a[140:143],a[28:31],v[80:83]
v_cvt_pk_bf16_f32 v28,v88,v89
v_cvt_pk_bf16_f32 v29,v90,v91
v_mfma_f32_16x16x32_bf16 v[80:83],a[144:147],a[32:35],v[80:83]
v_mov_b32 v57,v56
v_fma_f32 v79,v79,s36,v13
v_mfma_f32_16x16x32_bf16 v[80:83],a[148:151],a[36:39],v[80:83]
v_permlane32_swap_b32 v57,v56
v_mfma_f32_16x16x32_bf16 v[80:83],a[120:123],a[40:43],v[80:83]
v_max_f32 v56,v56,v57
v_mov_b32 v57,v56
v_mfma_f32_16x16x32_bf16 v[80:83],a[124:127],a[44:47],v[80:83]
v_fma_f32 v76,v76,s36,v13
v_permlane16_swap_b32 v57,v56
v_mfma_f32_16x16x32_bf16 v[88:91],a[124:127],a[68:71],0
v_max_f32 v56,v56,v57
v_mul_f32_e64 v16,-s36,v56
v_mfma_f32_16x16x32_bf16 v[88:91],a[120:123],a[64:67],v[88:91]
v_fma_f32 v96,v96,s36,v16
v_fma_f32 v98,v98,s36,v16
v_mfma_f32_16x16x32_bf16 v[88:91],a[148:151],a[60:63],v[88:91]
v_exp_f32 v98,v98
v_mfma_f32_16x16x32_bf16 v[88:91],a[144:147],a[56:59],v[88:91]
v_fma_f32 v97,v97,s36,v16
v_fma_f32 v99,v99,s36,v16
v_mfma_f32_16x16x32_bf16 v[88:91],a[140:143],a[52:55],v[88:91]
v_exp_f32 v96,v96
v_mfma_f32_16x16x32_bf16 v[88:91],a[136:139],a[48:51],v[88:91]
v_exp_f32 v99,v99
v_exp_f32 v97,v97
v_cvt_pk_bf16_f32 v33,v98,v99
v_cvt_pk_bf16_f32 v32,v96,v97
v_mfma_f32_16x16x32_bf16 v[96:99],a[136:139],a[72:75],0
ds_read_b128 a[136:139],v0 offset:18560
v_exp_f32 v78,v78
v_mfma_f32_16x16x32_bf16 v[96:99],a[140:143],a[76:79],v[96:99]
ds_read_b128 a[140:143],v1 offset:18560
v_exp_f32 v76,v76
v_mfma_f32_16x16x32_bf16 v[96:99],a[144:147],a[80:83],v[96:99]
ds_read_b128 a[144:147],v0 offset:18688
v_fma_f32 v77,v77,s36,v13
v_mfma_f32_16x16x32_bf16 v[96:99],a[148:151],a[84:87],v[96:99]
ds_read_b128 a[148:151],v1 offset:18688
v_exp_f32 v77,v77
v_mfma_f32_16x16x32_bf16 v[96:99],a[120:123],a[88:91],v[96:99]
v_exp_f32 v79,v79
v_mfma_f32_16x16x32_bf16 v[96:99],a[124:127],a[92:95],v[96:99]
v_cvt_pk_bf16_f32 v23,v78,v79
v_cvt_pk_bf16_f32 v22,v76,v77
v_mfma_f32_16x16x32_bf16 v[76:79],a[128:131],a[0:3],0
v_fma_f32 v84,v84,s36,v14
v_fma_f32 v87,v87,s36,v14
v_mfma_f32_16x16x32_bf16 v[76:79],a[132:135],a[4:7],v[76:79]
s_waitcnt lgkmcnt(3)
v_fma_f32 v86,v86,s36,v14
v_exp_f32 v84,v84
v_mfma_f32_16x16x32_bf16 v[76:79],a[136:139],a[8:11],v[76:79]
s_waitcnt lgkmcnt(2)
v_exp_f32 v87,v87
v_mfma_f32_16x16x32_bf16 v[76:79],a[140:143],a[12:15],v[76:79]
s_waitcnt lgkmcnt(0)
v_fma_f32 v85,v85,s36,v14
v_exp_f32 v85,v85
v_mfma_f32_16x16x32_bf16 v[76:79],a[144:147],a[16:19],v[76:79]
v_cvt_pk_bf16_f32 v26,v84,v85
v_exp_f32 v86,v86
v_mfma_f32_16x16x32_bf16 v[76:79],a[148:151],a[20:23],v[76:79]
v_cvt_pk_bf16_f32 v27,v86,v87
v_fma_f32 v94,v94,s36,v15
v_mfma_f32_16x16x32_bf16 v[84:87],a[148:151],a[44:47],0
v_fma_f32 v92,v92,s36,v15
v_exp_f32 v92,v92
s_waitcnt vmcnt(7)
s_barrier
v_mfma_f32_16x16x32_bf16 v[84:87],a[144:147],a[40:43],v[84:87]
buffer_load_dwordx4 v6,s[4:7],s20 offen offset:0 lds
v_mfma_f32_16x16x32_bf16 v[84:87],a[140:143],a[36:39],v[84:87]
v_fma_f32 v93,v93,s36,v15
v_exp_f32 v93,v93
v_mfma_f32_16x16x32_bf16 v[84:87],a[136:139],a[32:35],v[84:87]
v_fma_f32 v95,v95,s36,v15
v_exp_f32 v94,v94
v_mfma_f32_16x16x32_bf16 v[84:87],a[132:135],a[28:31],v[84:87]
v_exp_f32 v95,v95
v_mfma_f32_16x16x32_bf16 v[84:87],a[128:131],a[24:27],v[84:87]
v_cvt_pk_bf16_f32 v31,v94,v95
v_cvt_pk_bf16_f32 v30,v92,v93
v_mfma_f32_16x16x32_bf16 v[92:95],a[128:131],a[48:51],0
v_fma_f32 v100,v100,s36,v16
v_fma_f32 v103,v103,s36,v16
v_mfma_f32_16x16x32_bf16 v[92:95],a[132:135],a[52:55],v[92:95]
buffer_load_dwordx4 v7,s[4:7],s20 offen offset:1024 lds
v_mfma_f32_16x16x32_bf16 v[92:95],a[136:139],a[56:59],v[92:95]
v_exp_f32 v100,v100
v_mfma_f32_16x16x32_bf16 v[92:95],a[140:143],a[60:63],v[92:95]
v_fma_f32 v101,v101,s36,v16
v_exp_f32 v103,v103
v_mfma_f32_16x16x32_bf16 v[92:95],a[144:147],a[64:67],v[92:95]
ds_read_b64_tr_b16 a[122:123],v2 offset:6144
v_exp_f32 v101,v101
v_mfma_f32_16x16x32_bf16 v[92:95],a[148:151],a[68:71],v[92:95]
ds_read_b64_tr_b16 a[120:121],v2 offset:0
buffer_load_dwordx4 v8,s[4:7],s20 offen offset:2048 lds
ds_read_b64_tr_b16 a[124:125],v3 offset:0
ds_read_b64_tr_b16 a[126:127],v3 offset:6144
v_fma_f32 v102,v102,s36,v16
v_exp_f32 v102,v102
v_cvt_pk_bf16_f32 v34,v100,v101
v_cvt_pk_bf16_f32 v35,v102,v103
v_mfma_f32_16x16x32_bf16 v[100:103],a[148:151],a[92:95],0
s_add_u32 s20,s20,12288
v_cvt_pk_bf16_f32 v184,v184,v185
v_cvt_pk_bf16_f32 v188,v188,v189
v_smfmac_f32_16x16x64_bf16 v[64:67],a[152:155],v[28:35],v18
v_mov_b32 v61,0
v_mfma_f32_16x16x32_bf16 v[100:103],a[144:147],a[88:91],v[100:103]
v_mov_b32 v60,0
v_cvt_pk_bf16_f32 v192,v192,v193
v_mfma_f32_16x16x32_bf16 v[100:103],a[140:143],a[84:87],v[100:103]
v_cvt_pk_bf16_f32 v185,v186,v187
v_cvt_pk_bf16_f32 v189,v190,v191
v_smfmac_f32_16x16x64_bf16 v[60:63],a[152:155],v[20:27],v18
ds_write2st64_b64 v38,v[168:169],v[184:185] offset0:0 offset1:2
v_mfma_f32_16x16x32_bf16 v[100:103],a[136:139],a[80:83],v[100:103]
v_fma_f32 v75,v75,s36,v13
v_fma_f32 v73,v73,s36,v13
v_mfma_f32_16x16x32_bf16 v[100:103],a[132:135],a[76:79],v[100:103]
ds_read_b64_tr_b16 a[134:135],v5 offset:6144
v_fma_f32 v74,v74,s36,v13
v_mfma_f32_16x16x32_bf16 v[100:103],a[128:131],a[72:75],v[100:103]
ds_read_b64_tr_b16 a[130:131],v4 offset:6144
ds_read_b64_tr_b16 a[128:129],v4 offset:0
ds_read_b64_tr_b16 a[132:133],v5 offset:0
v_cvt_pk_bf16_f32 v172,v172,v173
v_cvt_pk_bf16_f32 v173,v174,v175
ds_write2st64_b64 v39,v[172:173],v[188:189] offset0:0 offset1:2
v_fma_f32 v81,v81,s36,v14
v_fma_f32 v80,v80,s36,v14
v_exp_f32 v80,v80
v_fma_f32 v72,v72,s36,v13
v_exp_f32 v72,v72
v_exp_f32 v74,v74
v_cvt_pk_bf16_f32 v193,v194,v195
v_exp_f32 v81,v81
ds_write_b64 v36,v[192:193] offset:2048
v_exp_f32 v73,v73
v_cvt_pk_bf16_f32 v196,v196,v197
v_cvt_pk_bf16_f32 v197,v198,v199
ds_write_b64 v37,v[196:197] offset:2048
v_cvt_pk_bf16_f32 v204,v204,v205
v_cvt_pk_bf16_f32 v205,v206,v207
v_cvt_pk_bf16_f32 v200,v200,v201
v_exp_f32 v75,v75
v_cvt_pk_bf16_f32 v44,v72,v73
v_cvt_pk_bf16_f32 v48,v80,v81
v_cvt_pk_bf16_f32 v201,v202,v203
ds_write_b64 v38,v[200:201] offset:2048
v_cvt_pk_bf16_f32 v45,v74,v75
ds_write_b64 v39,v[204:205] offset:2048
s_waitcnt lgkmcnt(3)
v_mfma_f32_16x16x32_bf16 v[160:163],a[120:123],v[20:23],0
s_add_u32 m0,s23,0
ds_read_b64_tr_b16 a[136:137],v2 offset:128
v_fma_f32 v82,v82,s36,v14
v_mfma_f32_16x16x32_bf16 v[164:167],a[124:127],v[20:23],0
ds_read_b64_tr_b16 a[138:139],v2 offset:6272
v_fma_f32 v83,v83,s36,v14
v_mfma_f32_16x16x32_bf16 v[212:215],a[124:127],v[24:27],0
ds_read_b64_tr_b16 a[140:141],v3 offset:128
v_fma_f32 v88,v88,s36,v15
v_mfma_f32_16x16x32_bf16 v[208:211],a[120:123],v[24:27],0
ds_read_b64_tr_b16 a[142:143],v3 offset:6272
v_fma_f32 v89,v89,s36,v15
v_mfma_f32_16x16x32_bf16 v[112:115],a[120:123],v[28:31],0
ds_read_b64_tr_b16 a[144:145],v4 offset:128
v_fma_f32 v90,v90,s36,v15
v_mfma_f32_16x16x32_bf16 v[116:119],a[124:127],v[28:31],0
ds_read_b64_tr_b16 a[146:147],v4 offset:6272
v_fma_f32 v91,v91,s36,v15
v_mfma_f32_16x16x32_bf16 a[164:167],a[124:127],v[32:35],0
ds_read_b64_tr_b16 a[148:149],v5 offset:128
v_fma_f32 v96,v96,s36,v16
v_mfma_f32_16x16x32_bf16 a[160:163],a[120:123],v[32:35],0
ds_read_b64_tr_b16 a[150:151],v5 offset:6272
v_fma_f32 v97,v97,s36,v16
v_mfma_f32_16x16x32_bf16 a[168:171],a[128:131],v[32:35],0
ds_read_b64_tr_b16 a[120:121],v2 offset:256
v_fma_f32 v98,v98,s36,v16
v_mfma_f32_16x16x32_bf16 a[172:175],a[132:135],v[32:35],0
ds_read_b64_tr_b16 a[122:123],v2 offset:6400
v_fma_f32 v99,v99,s36,v16
v_mfma_f32_16x16x32_bf16 v[124:127],a[132:135],v[28:31],0
ds_read_b64_tr_b16 a[124:125],v3 offset:256
v_fma_f32 v76,v76,s36,v13
v_mfma_f32_16x16x32_bf16 v[120:123],a[128:131],v[28:31],0
ds_read_b64_tr_b16 a[126:127],v3 offset:6400
v_fma_f32 v77,v77,s36,v13
v_mfma_f32_16x16x32_bf16 v[216:219],a[128:131],v[24:27],0
v_exp_f32 v82,v82
v_mfma_f32_16x16x32_bf16 v[220:223],a[132:135],v[24:27],0
v_exp_f32 v83,v83
v_mfma_f32_16x16x32_bf16 v[172:175],a[132:135],v[20:23],0
ds_read_b64_tr_b16 a[132:133],v5 offset:256
v_cvt_pk_bf16_f32 v49,v82,v83
v_mfma_f32_16x16x32_bf16 v[168:171],a[128:131],v[20:23],0
s_waitcnt lgkmcnt(4)
ds_read_b64_tr_b16 a[128:129],v4 offset:256
v_fma_f32 v78,v78,s36,v13
v_mfma_f32_16x16x32_bf16 v[176:179],a[136:139],v[20:23],0
ds_read_b64_tr_b16 a[130:131],v4 offset:6400
v_fma_f32 v79,v79,s36,v13
v_mfma_f32_16x16x32_bf16 v[180:183],a[140:143],v[20:23],0
ds_read_b64_tr_b16 a[134:135],v5 offset:6400
v_fma_f32 v84,v84,s36,v14
v_mfma_f32_16x16x32_bf16 v[228:231],a[140:143],v[24:27],0
v_exp_f32 v88,v88
v_mfma_f32_16x16x32_bf16 v[224:227],a[136:139],v[24:27],0
v_exp_f32 v89,v89
v_mfma_f32_16x16x32_bf16 v[128:131],a[136:139],v[28:31],0
v_exp_f32 v90,v90
v_mfma_f32_16x16x32_bf16 v[132:135],a[140:143],v[28:31],0
v_exp_f32 v91,v91
v_mfma_f32_16x16x32_bf16 a[180:183],a[140:143],v[32:35],0
v_cvt_pk_bf16_f32 v52,v88,v89
v_cvt_pk_bf16_f32 v53,v90,v91
v_mfma_f32_16x16x32_bf16 a[176:179],a[136:139],v[32:35],0
v_exp_f32 v96,v96
v_mfma_f32_16x16x32_bf16 a[184:187],a[144:147],v[32:35],0
v_exp_f32 v97,v97
v_mfma_f32_16x16x32_bf16 a[188:191],a[148:151],v[32:35],0
v_exp_f32 v98,v98
v_mfma_f32_16x16x32_bf16 v[140:143],a[148:151],v[28:31],0
v_exp_f32 v99,v99
v_mfma_f32_16x16x32_bf16 v[136:139],a[144:147],v[28:31],0
v_cvt_pk_bf16_f32 v56,v96,v97
v_cvt_pk_bf16_f32 v57,v98,v99
v_mfma_f32_16x16x32_bf16 v[232:235],a[144:147],v[24:27],0
v_exp_f32 v76,v76
v_mfma_f32_16x16x32_bf16 v[236:239],a[148:151],v[24:27],0
v_exp_f32 v77,v77
v_mfma_f32_16x16x32_bf16 v[188:191],a[148:151],v[20:23],0
v_exp_f32 v78,v78
v_mfma_f32_16x16x32_bf16 v[184:187],a[144:147],v[20:23],0
s_waitcnt lgkmcnt(0)
v_exp_f32 v79,v79
v_mfma_f32_16x16x32_bf16 v[192:195],a[120:123],v[20:23],0
v_cvt_pk_bf16_f32 v46,v76,v77
v_cvt_pk_bf16_f32 v47,v78,v79
v_mfma_f32_16x16x32_bf16 v[196:199],a[124:127],v[20:23],0
s_waitcnt vmcnt(30)
v_fma_f32 v85,v85,s36,v14
v_fma_f32 v86,v86,s36,v14
v_mfma_f32_16x16x32_bf16 v[244:247],a[124:127],v[24:27],0
s_barrier
v_mfma_f32_16x16x32_bf16 v[240:243],a[120:123],v[24:27],0
ds_read_b128 a[148:151],v1 offset:24704
v_fma_f32 v87,v87,s36,v14
v_mfma_f32_16x16x32_bf16 v[144:147],a[120:123],v[28:31],0
ds_read_b128 a[144:147],v0 offset:24704
v_fma_f32 v92,v92,s36,v15
v_mfma_f32_16x16x32_bf16 v[148:151],a[124:127],v[28:31],0
ds_read_b128 a[140:143],v1 offset:24576
v_fma_f32 v93,v93,s36,v15
v_mfma_f32_16x16x32_bf16 a[196:199],a[124:127],v[32:35],0
ds_read_b128 a[124:127],v1 offset:24832
v_fma_f32 v94,v94,s36,v15
v_mfma_f32_16x16x32_bf16 a[192:195],a[120:123],v[32:35],0
ds_read_b128 a[120:123],v0 offset:24832
v_fma_f32 v95,v95,s36,v15
v_mfma_f32_16x16x32_bf16 a[200:203],a[128:131],v[32:35],0
buffer_load_dwordx4 v6,s[8:11],s21 offen offset:0 lds
v_mfma_f32_16x16x32_bf16 a[204:207],a[132:135],v[32:35],0
ds_read_b128 a[136:139],v0 offset:24576
v_fma_f32 v100,v100,s36,v16
v_mfma_f32_16x16x32_bf16 v[156:159],a[132:135],v[28:31],0
v_exp_f32 v84,v84
v_mfma_f32_16x16x32_bf16 v[152:155],a[128:131],v[28:31],0
v_exp_f32 v85,v85
v_mfma_f32_16x16x32_bf16 v[248:251],a[128:131],v[24:27],0
v_exp_f32 v86,v86
v_mfma_f32_16x16x32_bf16 v[252:255],a[132:135],v[24:27],0
v_exp_f32 v87,v87
v_mfma_f32_16x16x32_bf16 v[204:207],a[132:135],v[20:23],0
ds_read_b128 a[132:135],v1 offset:30720
v_cvt_pk_bf16_f32 v50,v84,v85
v_mfma_f32_16x16x32_bf16 v[200:203],a[128:131],v[20:23],0
s_waitcnt lgkmcnt(2)
ds_read_b128 a[128:131],v0 offset:30720
v_cvt_pk_bf16_f32 v51,v86,v87
v_mfma_f32_16x16x32_bf16 v[72:75],a[124:127],a[20:23],0
v_exp_f32 v92,v92
v_smfmac_f32_16x16x64_bf16 v[60:63],a[152:155],v[44:51],v18
buffer_load_dwordx4 v7,s[8:11],s21 offen offset:1024 lds
v_mfma_f32_16x16x32_bf16 v[72:75],a[120:123],a[16:19],v[72:75]
v_exp_f32 v93,v93
v_mfma_f32_16x16x32_bf16 v[72:75],a[148:151],a[12:15],v[72:75]
v_exp_f32 v94,v94
v_mfma_f32_16x16x32_bf16 v[72:75],a[144:147],a[8:11],v[72:75]
v_exp_f32 v95,v95
v_mfma_f32_16x16x32_bf16 v[72:75],a[140:143],a[4:7],v[72:75]
s_waitcnt lgkmcnt(1)
v_cvt_pk_bf16_f32 v54,v92,v93
v_cvt_pk_bf16_f32 v55,v94,v95
v_mfma_f32_16x16x32_bf16 v[72:75],a[136:139],a[0:3],v[72:75]
v_fma_f32 v101,v101,s36,v16
v_fma_f32 v102,v102,s36,v16
v_mfma_f32_16x16x32_bf16 v[80:83],a[136:139],a[24:27],0
v_fma_f32 v103,v103,s36,v16
v_mfma_f32_16x16x32_bf16 v[80:83],a[140:143],a[28:31],v[80:83]
v_exp_f32 v100,v100
v_mfma_f32_16x16x32_bf16 v[80:83],a[144:147],a[32:35],v[80:83]
buffer_load_dwordx4 v8,s[8:11],s21 offen offset:2048 lds
v_mfma_f32_16x16x32_bf16 v[80:83],a[148:151],a[36:39],v[80:83]
s_add_u32 s21,s21,12288
v_exp_f32 v101,v101
v_mfma_f32_16x16x32_bf16 v[80:83],a[120:123],a[40:43],v[80:83]
s_add_u32 m0,s22,12288
v_exp_f32 v102,v102
v_mfma_f32_16x16x32_bf16 v[80:83],a[124:127],a[44:47],v[80:83]
v_exp_f32 v103,v103
v_mfma_f32_16x16x32_bf16 v[88:91],a[124:127],a[68:71],0
v_cvt_pk_bf16_f32 v58,v100,v101
v_cvt_pk_bf16_f32 v59,v102,v103
v_mfma_f32_16x16x32_bf16 v[88:91],a[120:123],a[64:67],v[88:91]
v_fma_f32 v72,v72,s36,v13
v_fma_f32 v73,v73,s36,v13
v_smfmac_f32_16x16x64_bf16 v[64:67],a[152:155],v[52:59],v18
v_fma_f32 v74,v74,s36,v13
v_mfma_f32_16x16x32_bf16 v[88:91],a[148:151],a[60:63],v[88:91]
v_fma_f32 v75,v75,s36,v13
v_fma_f32 v80,v80,s36,v14
v_mfma_f32_16x16x32_bf16 v[88:91],a[144:147],a[56:59],v[88:91]
v_fma_f32 v81,v81,s36,v14
v_mfma_f32_16x16x32_bf16 v[88:91],a[140:143],a[52:55],v[88:91]
buffer_load_dwordx4 v6,s[4:7],s20 offen offset:0 lds
v_mfma_f32_16x16x32_bf16 v[88:91],a[136:139],a[48:51],v[88:91]
v_exp_f32 v72,v72
v_mfma_f32_16x16x32_bf16 v[96:99],a[136:139],a[72:75],0
ds_read_b128 a[136:139],v0 offset:30848
v_mfma_f32_16x16x32_bf16 v[96:99],a[140:143],a[76:79],v[96:99]
ds_read_b128 a[140:143],v1 offset:30848
v_mfma_f32_16x16x32_bf16 v[96:99],a[144:147],a[80:83],v[96:99]
ds_read_b128 a[144:147],v0 offset:30976
v_mfma_f32_16x16x32_bf16 v[96:99],a[148:151],a[84:87],v[96:99]
ds_read_b128 a[148:151],v1 offset:30976
v_mfma_f32_16x16x32_bf16 v[96:99],a[120:123],a[88:91],v[96:99]
v_exp_f32 v73,v73
v_mfma_f32_16x16x32_bf16 v[96:99],a[124:127],a[92:95],v[96:99]
s_waitcnt lgkmcnt(4)
v_exp_f32 v74,v74
v_mfma_f32_16x16x32_bf16 v[76:79],a[128:131],a[0:3],0
v_exp_f32 v75,v75
v_mfma_f32_16x16x32_bf16 v[76:79],a[132:135],a[4:7],v[76:79]
buffer_load_dwordx4 v7,s[4:7],s20 offen offset:1024 lds
s_waitcnt lgkmcnt(3)
v_mfma_f32_16x16x32_bf16 v[76:79],a[136:139],a[8:11],v[76:79]
s_waitcnt lgkmcnt(2)
v_exp_f32 v80,v80
v_mfma_f32_16x16x32_bf16 v[76:79],a[140:143],a[12:15],v[76:79]
s_waitcnt lgkmcnt(0)
v_exp_f32 v81,v81
v_mfma_f32_16x16x32_bf16 v[76:79],a[144:147],a[16:19],v[76:79]
v_cvt_pk_bf16_f32 v20,v72,v73
v_cvt_pk_bf16_f32 v21,v74,v75
v_mfma_f32_16x16x32_bf16 v[76:79],a[148:151],a[20:23],v[76:79]
v_cvt_pk_bf16_f32 v24,v80,v81
v_mfma_f32_16x16x32_bf16 v[84:87],a[148:151],a[44:47],0
v_mfma_f32_16x16x32_bf16 v[84:87],a[144:147],a[40:43],v[84:87]
v_mfma_f32_16x16x32_bf16 v[84:87],a[140:143],a[36:39],v[84:87]
v_mfma_f32_16x16x32_bf16 v[84:87],a[136:139],a[32:35],v[84:87]
v_mfma_f32_16x16x32_bf16 v[84:87],a[132:135],a[28:31],v[84:87]
buffer_load_dwordx4 v8,s[4:7],s20 offen offset:2048 lds
v_mfma_f32_16x16x32_bf16 v[84:87],a[128:131],a[24:27],v[84:87]
s_add_u32 s20,s20,12288
v_mfma_f32_16x16x32_bf16 v[92:95],a[128:131],a[48:51],0
ds_read_b64_tr_b16 a[120:121],v2 offset:12288
v_mfma_f32_16x16x32_bf16 v[92:95],a[132:135],a[52:55],v[92:95]
ds_read_b64_tr_b16 a[122:123],v2 offset:18432
v_mfma_f32_16x16x32_bf16 v[92:95],a[136:139],a[56:59],v[92:95]
ds_read_b64_tr_b16 a[124:125],v3 offset:12288
v_mfma_f32_16x16x32_bf16 v[92:95],a[140:143],a[60:63],v[92:95]
ds_read_b64_tr_b16 a[126:127],v3 offset:18432
v_mfma_f32_16x16x32_bf16 v[92:95],a[144:147],a[64:67],v[92:95]
v_mfma_f32_16x16x32_bf16 v[92:95],a[148:151],a[68:71],v[92:95]
v_mfma_f32_16x16x32_bf16 v[100:103],a[148:151],a[92:95],0
v_mfma_f32_16x16x32_bf16 v[100:103],a[144:147],a[88:91],v[100:103]
v_mfma_f32_16x16x32_bf16 v[100:103],a[140:143],a[84:87],v[100:103]
v_mfma_f32_16x16x32_bf16 v[100:103],a[136:139],a[80:83],v[100:103]
v_mfma_f32_16x16x32_bf16 v[100:103],a[132:135],a[76:79],v[100:103]
ds_read_b64_tr_b16 a[132:133],v5 offset:12288
v_mfma_f32_16x16x32_bf16 v[100:103],a[128:131],a[72:75],v[100:103]
s_waitcnt lgkmcnt(1)
ds_read_b64_tr_b16 a[128:129],v4 offset:12288
ds_read_b64_tr_b16 a[130:131],v4 offset:18432
ds_read_b64_tr_b16 a[134:135],v5 offset:18432
v_mfma_f32_16x16x32_bf16 v[160:163],a[120:123],v[44:47],v[160:163]
s_add_u32 m0,s23,12288
ds_read_b64_tr_b16 a[136:137],v2 offset:12416
v_fma_f32 v82,v82,s36,v14
v_mfma_f32_16x16x32_bf16 v[164:167],a[124:127],v[44:47],v[164:167]
ds_read_b64_tr_b16 a[138:139],v2 offset:18560
v_fma_f32 v83,v83,s36,v14
v_mfma_f32_16x16x32_bf16 v[212:215],a[124:127],v[48:51],v[212:215]
ds_read_b64_tr_b16 a[140:141],v3 offset:12416
v_fma_f32 v88,v88,s36,v15
v_mfma_f32_16x16x32_bf16 v[208:211],a[120:123],v[48:51],v[208:211]
ds_read_b64_tr_b16 a[142:143],v3 offset:18560
v_fma_f32 v89,v89,s36,v15
v_mfma_f32_16x16x32_bf16 v[112:115],a[120:123],v[52:55],v[112:115]
ds_read_b64_tr_b16 a[144:145],v4 offset:12416
v_fma_f32 v90,v90,s36,v15
v_mfma_f32_16x16x32_bf16 v[116:119],a[124:127],v[52:55],v[116:119]
ds_read_b64_tr_b16 a[146:147],v4 offset:18560
v_fma_f32 v91,v91,s36,v15
v_mfma_f32_16x16x32_bf16 a[164:167],a[124:127],v[56:59],a[164:167]
ds_read_b64_tr_b16 a[148:149],v5 offset:12416
v_fma_f32 v96,v96,s36,v16
v_mfma_f32_16x16x32_bf16 a[160:163],a[120:123],v[56:59],a[160:163]
s_waitcnt lgkmcnt(6)
ds_read_b64_tr_b16 a[150:151],v5 offset:18560
v_fma_f32 v97,v97,s36,v16
v_mfma_f32_16x16x32_bf16 a[168:171],a[128:131],v[56:59],a[168:171]
ds_read_b64_tr_b16 a[120:121],v2 offset:12544
v_fma_f32 v98,v98,s36,v16
v_mfma_f32_16x16x32_bf16 a[172:175],a[132:135],v[56:59],a[172:175]
ds_read_b64_tr_b16 a[122:123],v2 offset:18688
v_fma_f32 v99,v99,s36,v16
v_mfma_f32_16x16x32_bf16 v[124:127],a[132:135],v[52:55],v[124:127]
ds_read_b64_tr_b16 a[124:125],v3 offset:12544
v_fma_f32 v76,v76,s36,v13
v_mfma_f32_16x16x32_bf16 v[120:123],a[128:131],v[52:55],v[120:123]
ds_read_b64_tr_b16 a[126:127],v3 offset:18688
v_fma_f32 v77,v77,s36,v13
v_mfma_f32_16x16x32_bf16 v[216:219],a[128:131],v[48:51],v[216:219]
v_exp_f32 v82,v82
v_mfma_f32_16x16x32_bf16 v[220:223],a[132:135],v[48:51],v[220:223]
v_exp_f32 v83,v83
v_mfma_f32_16x16x32_bf16 v[172:175],a[132:135],v[44:47],v[172:175]
ds_read_b64_tr_b16 a[132:133],v5 offset:12544
v_cvt_pk_bf16_f32 v25,v82,v83
v_mfma_f32_16x16x32_bf16 v[168:171],a[128:131],v[44:47],v[168:171]
s_waitcnt lgkmcnt(4)
ds_read_b64_tr_b16 a[128:129],v4 offset:12544
v_fma_f32 v78,v78,s36,v13
v_mfma_f32_16x16x32_bf16 v[176:179],a[136:139],v[44:47],v[176:179]
ds_read_b64_tr_b16 a[130:131],v4 offset:18688
v_fma_f32 v79,v79,s36,v13
v_mfma_f32_16x16x32_bf16 v[180:183],a[140:143],v[44:47],v[180:183]
ds_read_b64_tr_b16 a[134:135],v5 offset:18688
v_fma_f32 v84,v84,s36,v14
v_mfma_f32_16x16x32_bf16 v[228:231],a[140:143],v[48:51],v[228:231]
v_exp_f32 v88,v88
v_mfma_f32_16x16x32_bf16 v[224:227],a[136:139],v[48:51],v[224:227]
v_exp_f32 v89,v89
v_mfma_f32_16x16x32_bf16 v[128:131],a[136:139],v[52:55],v[128:131]
v_exp_f32 v90,v90
v_mfma_f32_16x16x32_bf16 v[132:135],a[140:143],v[52:55],v[132:135]
v_exp_f32 v91,v91
v_mfma_f32_16x16x32_bf16 a[180:183],a[140:143],v[56:59],a[180:183]
v_cvt_pk_bf16_f32 v28,v88,v89
v_cvt_pk_bf16_f32 v29,v90,v91
v_mfma_f32_16x16x32_bf16 a[176:179],a[136:139],v[56:59],a[176:179]
v_exp_f32 v96,v96
v_mfma_f32_16x16x32_bf16 a[184:187],a[144:147],v[56:59],a[184:187]
v_exp_f32 v97,v97
v_mfma_f32_16x16x32_bf16 a[188:191],a[148:151],v[56:59],a[188:191]
v_exp_f32 v98,v98
v_mfma_f32_16x16x32_bf16 v[140:143],a[148:151],v[52:55],v[140:143]
v_exp_f32 v99,v99
v_mfma_f32_16x16x32_bf16 v[136:139],a[144:147],v[52:55],v[136:139]
v_cvt_pk_bf16_f32 v32,v96,v97
v_cvt_pk_bf16_f32 v33,v98,v99
v_mfma_f32_16x16x32_bf16 v[232:235],a[144:147],v[48:51],v[232:235]
v_exp_f32 v76,v76
v_mfma_f32_16x16x32_bf16 v[236:239],a[148:151],v[48:51],v[236:239]
v_exp_f32 v77,v77
v_mfma_f32_16x16x32_bf16 v[188:191],a[148:151],v[44:47],v[188:191]
v_exp_f32 v78,v78
v_mfma_f32_16x16x32_bf16 v[184:187],a[144:147],v[44:47],v[184:187]
s_waitcnt lgkmcnt(0)
v_exp_f32 v79,v79
v_mfma_f32_16x16x32_bf16 v[192:195],a[120:123],v[44:47],v[192:195]
v_cvt_pk_bf16_f32 v22,v76,v77
v_cvt_pk_bf16_f32 v23,v78,v79
v_mfma_f32_16x16x32_bf16 v[196:199],a[124:127],v[44:47],v[196:199]
s_waitcnt vmcnt(6)
v_fma_f32 v85,v85,s36,v14
v_fma_f32 v86,v86,s36,v14
v_mfma_f32_16x16x32_bf16 v[244:247],a[124:127],v[48:51],v[244:247]
s_barrier
v_mfma_f32_16x16x32_bf16 v[240:243],a[120:123],v[48:51],v[240:243]
ds_read_b128 a[148:151],v1 offset:128
v_fma_f32 v87,v87,s36,v14
v_mfma_f32_16x16x32_bf16 v[144:147],a[120:123],v[52:55],v[144:147]
ds_read_b128 a[144:147],v0 offset:128
v_fma_f32 v92,v92,s36,v15
v_mfma_f32_16x16x32_bf16 v[148:151],a[124:127],v[52:55],v[148:151]
ds_read_b128 a[140:143],v1 offset:0
v_fma_f32 v93,v93,s36,v15
v_mfma_f32_16x16x32_bf16 a[196:199],a[124:127],v[56:59],a[196:199]
ds_read_b128 a[124:127],v1 offset:256
v_fma_f32 v94,v94,s36,v15
v_mfma_f32_16x16x32_bf16 a[192:195],a[120:123],v[56:59],a[192:195]
ds_read_b128 a[120:123],v0 offset:256
v_fma_f32 v95,v95,s36,v15
v_mfma_f32_16x16x32_bf16 a[200:203],a[128:131],v[56:59],a[200:203]
buffer_load_dwordx4 v6,s[8:11],s21 offen offset:0 lds
v_mfma_f32_16x16x32_bf16 a[204:207],a[132:135],v[56:59],a[204:207]
ds_read_b128 a[136:139],v0 offset:0
v_fma_f32 v100,v100,s36,v16
v_mfma_f32_16x16x32_bf16 v[156:159],a[132:135],v[52:55],v[156:159]
v_exp_f32 v84,v84
v_mfma_f32_16x16x32_bf16 v[152:155],a[128:131],v[52:55],v[152:155]
v_exp_f32 v85,v85
v_mfma_f32_16x16x32_bf16 v[248:251],a[128:131],v[48:51],v[248:251]
v_exp_f32 v86,v86
v_mfma_f32_16x16x32_bf16 v[252:255],a[132:135],v[48:51],v[252:255]
v_exp_f32 v87,v87
v_mfma_f32_16x16x32_bf16 v[204:207],a[132:135],v[44:47],v[204:207]
ds_read_b128 a[132:135],v1 offset:6144
v_cvt_pk_bf16_f32 v26,v84,v85
v_mfma_f32_16x16x32_bf16 v[200:203],a[128:131],v[44:47],v[200:203]
s_waitcnt lgkmcnt(2)
ds_read_b128 a[128:131],v0 offset:6144
v_cvt_pk_bf16_f32 v27,v86,v87
v_mfma_f32_16x16x32_bf16 v[72:75],a[124:127],a[20:23],0
v_exp_f32 v92,v92
v_smfmac_f32_16x16x64_bf16 v[60:63],a[152:155],v[20:27],v18
buffer_load_dwordx4 v7,s[8:11],s21 offen offset:1024 lds
v_mfma_f32_16x16x32_bf16 v[72:75],a[120:123],a[16:19],v[72:75]
v_exp_f32 v93,v93
v_mfma_f32_16x16x32_bf16 v[72:75],a[148:151],a[12:15],v[72:75]
v_exp_f32 v94,v94
v_mfma_f32_16x16x32_bf16 v[72:75],a[144:147],a[8:11],v[72:75]
v_exp_f32 v95,v95
v_mfma_f32_16x16x32_bf16 v[72:75],a[140:143],a[4:7],v[72:75]
s_waitcnt lgkmcnt(1)
v_cvt_pk_bf16_f32 v30,v92,v93
v_cvt_pk_bf16_f32 v31,v94,v95
v_mfma_f32_16x16x32_bf16 v[72:75],a[136:139],a[0:3],v[72:75]
v_fma_f32 v101,v101,s36,v16
v_fma_f32 v102,v102,s36,v16
v_mfma_f32_16x16x32_bf16 v[80:83],a[136:139],a[24:27],0
v_fma_f32 v103,v103,s36,v16
v_mfma_f32_16x16x32_bf16 v[80:83],a[140:143],a[28:31],v[80:83]
v_exp_f32 v100,v100
v_mfma_f32_16x16x32_bf16 v[80:83],a[144:147],a[32:35],v[80:83]
buffer_load_dwordx4 v8,s[8:11],s21 offen offset:2048 lds
v_mfma_f32_16x16x32_bf16 v[80:83],a[148:151],a[36:39],v[80:83]
s_add_u32 s21,s21,12288
v_exp_f32 v101,v101
v_mfma_f32_16x16x32_bf16 v[80:83],a[120:123],a[40:43],v[80:83]
s_add_u32 m0,s22,24576
v_exp_f32 v102,v102
v_mfma_f32_16x16x32_bf16 v[80:83],a[124:127],a[44:47],v[80:83]
v_exp_f32 v103,v103
v_mfma_f32_16x16x32_bf16 v[88:91],a[124:127],a[68:71],0
v_cvt_pk_bf16_f32 v34,v100,v101
v_cvt_pk_bf16_f32 v35,v102,v103
v_mfma_f32_16x16x32_bf16 v[88:91],a[120:123],a[64:67],v[88:91]
v_fma_f32 v72,v72,s36,v13
v_fma_f32 v73,v73,s36,v13
v_smfmac_f32_16x16x64_bf16 v[64:67],a[152:155],v[28:35],v18
v_fma_f32 v74,v74,s36,v13
v_mfma_f32_16x16x32_bf16 v[88:91],a[148:151],a[60:63],v[88:91]
v_fma_f32 v75,v75,s36,v13
v_fma_f32 v80,v80,s36,v14
v_mfma_f32_16x16x32_bf16 v[88:91],a[144:147],a[56:59],v[88:91]
v_fma_f32 v81,v81,s36,v14
v_mfma_f32_16x16x32_bf16 v[88:91],a[140:143],a[52:55],v[88:91]
buffer_load_dwordx4 v6,s[4:7],s20 offen offset:0 lds
v_mfma_f32_16x16x32_bf16 v[88:91],a[136:139],a[48:51],v[88:91]
v_exp_f32 v72,v72
v_mfma_f32_16x16x32_bf16 v[96:99],a[136:139],a[72:75],0
ds_read_b128 a[136:139],v0 offset:6272
v_mfma_f32_16x16x32_bf16 v[96:99],a[140:143],a[76:79],v[96:99]
ds_read_b128 a[140:143],v1 offset:6272
v_mfma_f32_16x16x32_bf16 v[96:99],a[144:147],a[80:83],v[96:99]
ds_read_b128 a[144:147],v0 offset:6400
v_mfma_f32_16x16x32_bf16 v[96:99],a[148:151],a[84:87],v[96:99]
ds_read_b128 a[148:151],v1 offset:6400
v_mfma_f32_16x16x32_bf16 v[96:99],a[120:123],a[88:91],v[96:99]
v_exp_f32 v73,v73
v_mfma_f32_16x16x32_bf16 v[96:99],a[124:127],a[92:95],v[96:99]
s_waitcnt lgkmcnt(4)
v_exp_f32 v74,v74
v_mfma_f32_16x16x32_bf16 v[76:79],a[128:131],a[0:3],0
v_exp_f32 v75,v75
v_mfma_f32_16x16x32_bf16 v[76:79],a[132:135],a[4:7],v[76:79]
buffer_load_dwordx4 v7,s[4:7],s20 offen offset:1024 lds
s_waitcnt lgkmcnt(3)
v_mfma_f32_16x16x32_bf16 v[76:79],a[136:139],a[8:11],v[76:79]
s_waitcnt lgkmcnt(2)
v_exp_f32 v80,v80
v_mfma_f32_16x16x32_bf16 v[76:79],a[140:143],a[12:15],v[76:79]
s_waitcnt lgkmcnt(0)
v_exp_f32 v81,v81
v_mfma_f32_16x16x32_bf16 v[76:79],a[144:147],a[16:19],v[76:79]
v_cvt_pk_bf16_f32 v44,v72,v73
v_cvt_pk_bf16_f32 v45,v74,v75
v_mfma_f32_16x16x32_bf16 v[76:79],a[148:151],a[20:23],v[76:79]
v_cvt_pk_bf16_f32 v48,v80,v81
v_mfma_f32_16x16x32_bf16 v[84:87],a[148:151],a[44:47],0
v_mfma_f32_16x16x32_bf16 v[84:87],a[144:147],a[40:43],v[84:87]
v_mfma_f32_16x16x32_bf16 v[84:87],a[140:143],a[36:39],v[84:87]
v_mfma_f32_16x16x32_bf16 v[84:87],a[136:139],a[32:35],v[84:87]
v_mfma_f32_16x16x32_bf16 v[84:87],a[132:135],a[28:31],v[84:87]
buffer_load_dwordx4 v8,s[4:7],s20 offen offset:2048 lds
v_mfma_f32_16x16x32_bf16 v[84:87],a[128:131],a[24:27],v[84:87]
s_add_u32 s20,s20,12288
v_mfma_f32_16x16x32_bf16 v[92:95],a[128:131],a[48:51],0
ds_read_b64_tr_b16 a[120:121],v2 offset:24576
v_mfma_f32_16x16x32_bf16 v[92:95],a[132:135],a[52:55],v[92:95]
ds_read_b64_tr_b16 a[122:123],v2 offset:30720
v_mfma_f32_16x16x32_bf16 v[92:95],a[136:139],a[56:59],v[92:95]
ds_read_b64_tr_b16 a[124:125],v3 offset:24576
v_mfma_f32_16x16x32_bf16 v[92:95],a[140:143],a[60:63],v[92:95]
ds_read_b64_tr_b16 a[126:127],v3 offset:30720
v_mfma_f32_16x16x32_bf16 v[92:95],a[144:147],a[64:67],v[92:95]
v_mfma_f32_16x16x32_bf16 v[92:95],a[148:151],a[68:71],v[92:95]
v_mfma_f32_16x16x32_bf16 v[100:103],a[148:151],a[92:95],0
v_mfma_f32_16x16x32_bf16 v[100:103],a[144:147],a[88:91],v[100:103]
v_mfma_f32_16x16x32_bf16 v[100:103],a[140:143],a[84:87],v[100:103]
v_mfma_f32_16x16x32_bf16 v[100:103],a[136:139],a[80:83],v[100:103]
v_mfma_f32_16x16x32_bf16 v[100:103],a[132:135],a[76:79],v[100:103]
ds_read_b64_tr_b16 a[132:133],v5 offset:24576
v_mfma_f32_16x16x32_bf16 v[100:103],a[128:131],a[72:75],v[100:103]
ds_read_b64_tr_b16 a[128:129],v4 offset:24576
ds_read_b64_tr_b16 a[130:131],v4 offset:30720
ds_read_b64_tr_b16 a[134:135],v5 offset:30720
s_mov_b32 s38,0
s_branch L_loop4
L_tr55:
s_waitcnt vmcnt(43)
s_waitcnt lgkmcnt(3)
v_mfma_f32_16x16x32_bf16 v[160:163],a[120:123],v[20:23],v[160:163]
s_add_u32 m0,s24,0
ds_read_b128 a[12:15],v12 offset:128
v_fma_f32 v101,v101,s36,v16
v_mfma_f32_16x16x32_bf16 v[164:167],a[124:127],v[20:23],v[164:167]
ds_read_b128 a[20:23],v12 offset:256
v_fma_f32 v103,v103,s36,v16
v_mfma_f32_16x16x32_bf16 v[212:215],a[124:127],v[24:27],v[212:215]
ds_read_b128 a[4:7],v12 offset:0
v_fma_f32 v87,v87,s36,v14
v_mfma_f32_16x16x32_bf16 v[208:211],a[120:123],v[24:27],v[208:211]
ds_read_b128 a[16:19],v11 offset:256
v_fma_f32 v106,v106,s36,v17
v_mfma_f32_16x16x32_bf16 v[112:115],a[120:123],v[28:31],v[112:115]
ds_read_b128 a[0:3],v11 offset:0
v_fma_f32 v99,v99,s36,v16
v_mfma_f32_16x16x32_bf16 v[116:119],a[124:127],v[28:31],v[116:119]
ds_read_b128 a[8:11],v11 offset:128
v_fma_f32 v96,v96,s36,v16
v_mfma_f32_16x16x32_bf16 a[164:167],a[124:127],v[32:35],a[164:167]
ds_read_b64_tr_b16 a[136:137],v2 offset:24704
v_fma_f32 v77,v77,s36,v13
v_mfma_f32_16x16x32_bf16 a[160:163],a[120:123],v[32:35],a[160:163]
ds_read_b64_tr_b16 a[138:139],v2 offset:30848
v_fma_f32 v85,v85,s36,v14
v_mfma_f32_16x16x32_bf16 a[208:211],a[120:123],v[36:39],a[208:211]
ds_read_b64_tr_b16 a[140:141],v3 offset:24704
ds_read_b64_tr_b16 a[142:143],v3 offset:30848
ds_read_b64_tr_b16 a[144:145],v4 offset:24704
ds_read_b64_tr_b16 a[146:147],v4 offset:30848
ds_read_b64_tr_b16 a[150:151],v5 offset:30848
ds_read_b64_tr_b16 a[148:149],v5 offset:24704
ds_read_b128 a[40:43],v11 offset:6400
v_mfma_f32_16x16x32_bf16 a[212:215],a[124:127],v[36:39],a[212:215]
s_waitcnt lgkmcnt(11)
v_fma_f32 v84,v84,s36,v14
ds_read_b128 a[32:35],v11 offset:6272
v_mfma_f32_16x16x32_bf16 a[216:219],a[128:131],v[36:39],a[216:219]
s_waitcnt lgkmcnt(10)
buffer_load_dwordx4 v6,s[12:15],s28 offen offset:0 nt lds
v_mfma_f32_16x16x32_bf16 a[220:223],a[132:135],v[36:39],a[220:223]
ds_read_b64_tr_b16 a[122:123],v2 offset:30976
ds_read_b128 a[44:47],v12 offset:6400
v_mfma_f32_16x16x32_bf16 a[172:175],a[132:135],v[32:35],a[172:175]
v_exp_f32 v101,v101
ds_read_b64_tr_b16 a[120:121],v2 offset:24832
ds_read_b128 a[24:27],v11 offset:6144
v_mfma_f32_16x16x32_bf16 a[168:171],a[128:131],v[32:35],a[168:171]
v_exp_f32 v77,v77
ds_read_b128 a[28:31],v12 offset:6144
v_mfma_f32_16x16x32_bf16 v[120:123],a[128:131],v[28:31],v[120:123]
v_fma_f32 v111,v111,s36,v17
ds_read_b64_tr_b16 a[126:127],v3 offset:30976
ds_read_b64_tr_b16 a[124:125],v3 offset:24832
ds_read_b128 a[36:39],v12 offset:6272
v_mfma_f32_16x16x32_bf16 v[124:127],a[132:135],v[28:31],v[124:127]
buffer_load_dwordx4 v7,s[12:15],s28 offen offset:1024 nt lds
v_mfma_f32_16x16x32_bf16 v[220:223],a[132:135],v[24:27],v[220:223]
v_fma_f32 v95,v95,s36,v15
v_fma_f32 v100,v100,s36,v16
v_mfma_f32_16x16x32_bf16 v[216:219],a[128:131],v[24:27],v[216:219]
v_exp_f32 v106,v106
v_mfma_f32_16x16x32_bf16 v[168:171],a[128:131],v[20:23],v[168:171]
ds_read_b64_tr_b16 a[130:131],v4 offset:30976
v_fma_f32 v93,v93,s36,v15
v_mfma_f32_16x16x32_bf16 v[172:175],a[132:135],v[20:23],v[172:175]
s_waitcnt lgkmcnt(4)
ds_read_b64_tr_b16 a[128:129],v4 offset:24832
v_exp_f32 v111,v111
v_mfma_f32_16x16x32_bf16 v[176:179],a[136:139],v[20:23],v[176:179]
ds_read_b64_tr_b16 a[132:133],v5 offset:24832
buffer_load_dwordx4 v8,s[12:15],s28 offen offset:2048 nt lds
v_mfma_f32_16x16x32_bf16 v[180:183],a[140:143],v[20:23],v[180:183]
s_add_u32 s28,s28,3072
ds_read_b64_tr_b16 a[134:135],v5 offset:30976
v_fma_f32 v107,v107,s36,v17
v_mfma_f32_16x16x32_bf16 v[228:231],a[140:143],v[24:27],v[228:231]
s_add_u32 m0,s24,3072
v_fma_f32 v92,v92,s36,v15
v_exp_f32 v92,v92
v_mfma_f32_16x16x32_bf16 v[224:227],a[136:139],v[24:27],v[224:227]
v_fma_f32 v109,v109,s36,v17
v_exp_f32 v109,v109
v_mfma_f32_16x16x32_bf16 v[128:131],a[136:139],v[28:31],v[128:131]
v_fma_f32 v97,v97,s36,v16
v_exp_f32 v84,v84
v_mfma_f32_16x16x32_bf16 v[132:135],a[140:143],v[28:31],v[132:135]
v_fma_f32 v94,v94,s36,v15
v_exp_f32 v94,v94
v_mfma_f32_16x16x32_bf16 a[180:183],a[140:143],v[32:35],a[180:183]
v_fma_f32 v104,v104,s36,v17
v_fma_f32 v90,v90,s36,v15
v_mfma_f32_16x16x32_bf16 a[176:179],a[136:139],v[32:35],a[176:179]
buffer_load_dwordx4 v6,s[12:15],s28 offen offset:0 nt lds
v_mfma_f32_16x16x32_bf16 a[224:227],a[136:139],v[36:39],a[224:227]
v_exp_f32 v93,v93
v_mfma_f32_16x16x32_bf16 a[228:231],a[140:143],v[36:39],a[228:231]
v_exp_f32 v104,v104
v_mfma_f32_16x16x32_bf16 a[232:235],a[144:147],v[36:39],a[232:235]
v_exp_f32 v96,v96
v_mfma_f32_16x16x32_bf16 a[236:239],a[148:151],v[36:39],a[236:239]
v_fma_f32 v78,v78,s36,v13
v_exp_f32 v78,v78
v_mfma_f32_16x16x32_bf16 a[188:191],a[148:151],v[32:35],a[188:191]
v_fma_f32 v110,v110,s36,v17
v_exp_f32 v110,v110
v_mfma_f32_16x16x32_bf16 a[184:187],a[144:147],v[32:35],a[184:187]
v_exp_f32 v97,v97
v_mfma_f32_16x16x32_bf16 v[136:139],a[144:147],v[28:31],v[136:139]
v_exp_f32 v100,v100
v_mfma_f32_16x16x32_bf16 v[140:143],a[148:151],v[28:31],v[140:143]
buffer_load_dwordx4 v7,s[12:15],s28 offen offset:1024 nt lds
v_mfma_f32_16x16x32_bf16 v[236:239],a[148:151],v[24:27],v[236:239]
v_fma_f32 v102,v102,s36,v16
v_exp_f32 v102,v102
v_mfma_f32_16x16x32_bf16 v[232:235],a[144:147],v[24:27],v[232:235]
v_fma_f32 v79,v79,s36,v13
v_exp_f32 v79,v79
v_mfma_f32_16x16x32_bf16 v[184:187],a[144:147],v[20:23],v[184:187]
v_exp_f32 v85,v85
v_mfma_f32_16x16x32_bf16 v[188:191],a[148:151],v[20:23],v[188:191]
v_fma_f32 v108,v108,s36,v17
v_exp_f32 v108,v108
v_mfma_f32_16x16x32_bf16 v[192:195],a[120:123],v[20:23],v[192:195]
s_waitcnt lgkmcnt(0)
v_fma_f32 v98,v98,s36,v16
v_exp_f32 v87,v87
v_mfma_f32_16x16x32_bf16 v[196:199],a[124:127],v[20:23],v[196:199]
v_fma_f32 v76,v76,s36,v13
v_exp_f32 v76,v76
v_mfma_f32_16x16x32_bf16 v[244:247],a[124:127],v[24:27],v[244:247]
buffer_load_dwordx4 v8,s[12:15],s28 offen offset:2048 nt lds
s_waitcnt vmcnt(20)
s_barrier
v_mfma_f32_16x16x32_bf16 v[240:243],a[120:123],v[24:27],v[240:243]
s_add_u32 s28,s28,3072
v_fma_f32 v105,v105,s36,v17
v_exp_f32 v107,v107
v_mfma_f32_16x16x32_bf16 v[144:147],a[120:123],v[28:31],v[144:147]
s_add_u32 m0,s22,0
v_fma_f32 v91,v91,s36,v15
v_exp_f32 v91,v91
v_mfma_f32_16x16x32_bf16 v[148:151],a[124:127],v[28:31],v[148:151]
buffer_load_dwordx4 v6,s[4:7],s25 offen offset:0 lds
v_mfma_f32_16x16x32_bf16 a[196:199],a[124:127],v[32:35],a[196:199]
buffer_load_dwordx4 v7,s[4:7],s25 offen offset:1024 lds
v_mfma_f32_16x16x32_bf16 a[192:195],a[120:123],v[32:35],a[192:195]
buffer_load_dwordx4 v8,s[4:7],s25 offen offset:2048 lds
v_mfma_f32_16x16x32_bf16 a[240:243],a[120:123],v[36:39],a[240:243]
v_fma_f32 v86,v86,s36,v14
v_exp_f32 v86,v86
v_mfma_f32_16x16x32_bf16 a[244:247],a[124:127],v[36:39],a[244:247]
v_exp_f32 v95,v95
v_mfma_f32_16x16x32_bf16 a[248:251],a[128:131],v[36:39],a[248:251]
v_exp_f32 v103,v103
v_mfma_f32_16x16x32_bf16 a[252:255],a[132:135],v[36:39],a[252:255]
ds_read_b64_tr_b16 a[136:137],v2 offset:0
v_cvt_pk_bf16_f32 v41,v106,v107
v_mfma_f32_16x16x32_bf16 a[204:207],a[132:135],v[32:35],a[204:207]
ds_read_b64_tr_b16 a[138:139],v2 offset:6144
v_exp_f32 v99,v99
v_mfma_f32_16x16x32_bf16 a[200:203],a[128:131],v[32:35],a[200:203]
ds_read_b64_tr_b16 a[140:141],v3 offset:0
v_cvt_pk_bf16_f32 v42,v108,v109
v_mfma_f32_16x16x32_bf16 v[152:155],a[128:131],v[28:31],v[152:155]
ds_read_b64_tr_b16 a[142:143],v3 offset:6144
v_cvt_pk_bf16_f32 v50,v84,v85
v_mfma_f32_16x16x32_bf16 v[156:159],a[132:135],v[28:31],v[156:159]
ds_read_b64_tr_b16 a[144:145],v4 offset:0
v_exp_f32 v90,v90
v_mfma_f32_16x16x32_bf16 v[252:255],a[132:135],v[24:27],v[252:255]
ds_read_b64_tr_b16 a[146:147],v4 offset:6144
v_exp_f32 v105,v105
v_mfma_f32_16x16x32_bf16 v[248:251],a[128:131],v[24:27],v[248:251]
ds_read_b64_tr_b16 a[148:149],v5 offset:0
v_cvt_pk_bf16_f32 v55,v94,v95
v_mfma_f32_16x16x32_bf16 v[200:203],a[128:131],v[20:23],v[200:203]
ds_read_b64_tr_b16 a[150:151],v5 offset:6144
v_cvt_pk_bf16_f32 v51,v86,v87
v_mfma_f32_16x16x32_bf16 v[204:207],a[132:135],v[20:23],v[204:207]
v_cvt_pk_bf16_f32 v59,v102,v103
v_exp_f32 v98,v98
v_cvt_pk_bf16_f32 v54,v92,v93
v_cvt_pk_bf16_f32 v56,v96,v97
v_cvt_pk_bf16_f32 v53,v90,v91
v_cvt_pk_bf16_f32 v47,v78,v79
v_cvt_pk_bf16_f32 v43,v110,v111
v_cvt_pk_bf16_f32 v58,v100,v101
v_cvt_pk_bf16_f32 v46,v76,v77
v_cvt_pk_bf16_f32 v57,v98,v99
v_cvt_pk_bf16_f32 v40,v104,v105
v_smfmac_f32_16x16x64_bf16 v[60:63],a[152:155],v[44:51],v18
v_subrev_u32 v10,18432,v10
v_smfmac_f32_16x16x64_bf16 v[64:67],a[152:155],v[52:59],v18
v_smfmac_f32_16x16x64_bf16 v[68:71],a[152:155],v[36:43],v18
s_waitcnt lgkmcnt(1)
v_mfma_f32_16x16x32_bf16 v[160:163],a[136:139],v[44:47],v[160:163]
s_add_u32 s87,s42,18432
ds_read_b64_tr_b16 a[120:121],v2 offset:128
v_mbcnt_lo_u32_b32 v39,-1,0
v_mfma_f32_16x16x32_bf16 v[164:167],a[140:143],v[44:47],v[164:167]
s_add_u32 s66,s42,24576
ds_read_b64_tr_b16 a[122:123],v2 offset:6272
v_mbcnt_hi_u32_b32 v39,-1,v39
v_mfma_f32_16x16x32_bf16 v[212:215],a[140:143],v[48:51],v[212:215]
ds_read_b64_tr_b16 a[124:125],v3 offset:128
v_and_b32 v38,7,v39
v_mfma_f32_16x16x32_bf16 v[208:211],a[136:139],v[48:51],v[208:211]
ds_read_b64_tr_b16 a[126:127],v3 offset:6272
v_add_f32 v68,v68,v69
v_mfma_f32_16x16x32_bf16 v[112:115],a[136:139],v[52:55],v[112:115]
ds_read_b64_tr_b16 a[128:129],v4 offset:128
v_add_f32 v60,v60,v61
v_mfma_f32_16x16x32_bf16 v[116:119],a[140:143],v[52:55],v[116:119]
ds_read_b64_tr_b16 a[130:131],v4 offset:6272
ds_read_b64_tr_b16 a[132:133],v5 offset:128
ds_read_b64_tr_b16 a[134:135],v5 offset:6272
v_mfma_f32_16x16x32_bf16 a[164:167],a[140:143],v[56:59],a[164:167]
v_add_f32 v62,v62,v63
v_add_f32 v64,v64,v65
v_mfma_f32_16x16x32_bf16 a[160:163],a[136:139],v[56:59],a[160:163]
v_add_f32 v68,v68,v70
v_add_f32 v66,v66,v67
v_mfma_f32_16x16x32_bf16 a[208:211],a[136:139],v[40:43],a[208:211]
ds_read_b64_tr_b16 a[136:137],v2 offset:256
v_max3_f32 v19,v60,v62,v64
v_mfma_f32_16x16x32_bf16 a[212:215],a[140:143],v[40:43],a[212:215]
ds_read_b64_tr_b16 a[138:139],v2 offset:6400
v_add_f32 v68,v68,v71
v_mfma_f32_16x16x32_bf16 a[216:219],a[144:147],v[40:43],a[216:219]
s_waitcnt lgkmcnt(6)
ds_read_b64_tr_b16 a[140:141],v3 offset:256
v_max3_f32 v19,v19,v66,v68
v_mfma_f32_16x16x32_bf16 a[220:223],a[148:151],v[40:43],a[220:223]
ds_read_b64_tr_b16 a[142:143],v3 offset:6400
v_rcp_f32 v66,v66
v_rcp_f32 v68,v68
v_accvgpr_read_b32 v72,a160
v_accvgpr_read_b32 v73,a161
v_pk_mul_f32 v[72:73],v[72:73],v[66:67] op_sel_hi:[1,0]
v_accvgpr_read_b32 v74,a162
v_accvgpr_read_b32 v75,a163
v_pk_mul_f32 v[74:75],v[74:75],v[66:67] op_sel_hi:[1,0]
v_accvgpr_read_b32 v76,a208
v_accvgpr_read_b32 v77,a209
v_pk_mul_f32 v[76:77],v[76:77],v[68:69] op_sel_hi:[1,0]
v_accvgpr_read_b32 v78,a210
v_accvgpr_read_b32 v79,a211
v_pk_mul_f32 v[78:79],v[78:79],v[68:69] op_sel_hi:[1,0]
v_accvgpr_read_b32 v80,a164
v_accvgpr_read_b32 v81,a165
v_mfma_f32_16x16x32_bf16 a[172:175],a[148:151],v[56:59],a[172:175]
v_accvgpr_read_b32 v82,a166
v_accvgpr_read_b32 v83,a167
v_accvgpr_read_b32 v84,a212
v_accvgpr_read_b32 v85,a213
v_accvgpr_read_b32 v86,a214
v_pk_mul_f32 v[80:81],v[80:81],v[66:67] op_sel_hi:[1,0]
v_pk_mul_f32 v[82:83],v[82:83],v[66:67] op_sel_hi:[1,0]
v_pk_mul_f32 v[84:85],v[84:85],v[68:69] op_sel_hi:[1,0]
v_accvgpr_read_b32 v87,a215
v_pk_mul_f32 v[86:87],v[86:87],v[68:69] op_sel_hi:[1,0]
v_accvgpr_read_b32 v92,a216
v_accvgpr_read_b32 v93,a217
v_mfma_f32_16x16x32_bf16 a[168:171],a[144:147],v[56:59],a[168:171]
v_accvgpr_read_b32 v94,a218
v_accvgpr_read_b32 v95,a219
v_mfma_f32_16x16x32_bf16 v[120:123],a[144:147],v[52:55],v[120:123]
v_accvgpr_read_b32 v100,a220
v_accvgpr_read_b32 v101,a221
v_mfma_f32_16x16x32_bf16 v[124:127],a[148:151],v[52:55],v[124:127]
v_accvgpr_read_b32 v102,a222
v_accvgpr_read_b32 v103,a223
v_mfma_f32_16x16x32_bf16 v[220:223],a[148:151],v[48:51],v[220:223]
v_accvgpr_read_b32 v88,a168
v_accvgpr_read_b32 v89,a169
v_accvgpr_read_b32 v90,a170
v_accvgpr_read_b32 v91,a171
v_accvgpr_read_b32 v96,a172
v_pk_mul_f32 v[92:93],v[92:93],v[68:69] op_sel_hi:[1,0]
v_pk_mul_f32 v[94:95],v[94:95],v[68:69] op_sel_hi:[1,0]
v_pk_mul_f32 v[88:89],v[88:89],v[66:67] op_sel_hi:[1,0]
v_pk_mul_f32 v[90:91],v[90:91],v[66:67] op_sel_hi:[1,0]
v_accvgpr_read_b32 v97,a173
v_accvgpr_read_b32 v98,a174
v_mfma_f32_16x16x32_bf16 v[216:219],a[144:147],v[48:51],v[216:219]
v_accvgpr_read_b32 v99,a175
v_cmp_ngt_f32 vcc,s37,v19
v_mfma_f32_16x16x32_bf16 v[168:171],a[144:147],v[44:47],v[168:171]
ds_read_b64_tr_b16 a[144:145],v4 offset:256
ds_read_b64_tr_b16 a[146:147],v4 offset:6400
v_lshrrev_b32 v19,5,v39
v_xor_b32 v38,v38,v19
v_pk_mul_f32 v[96:97],v[96:97],v[66:67] op_sel_hi:[1,0]
v_pk_mul_f32 v[98:99],v[98:99],v[66:67] op_sel_hi:[1,0]
v_pk_mul_f32 v[100:101],v[100:101],v[68:69] op_sel_hi:[1,0]
v_pk_mul_f32 v[102:103],v[102:103],v[68:69] op_sel_hi:[1,0]
v_and_b32 v19,15,v39
v_lshl_add_u32 v19,v19,7,s24
v_mfma_f32_16x16x32_bf16 v[172:175],a[148:151],v[44:47],v[172:175]
s_cmp_lg_u64 vcc,0
ds_read_b64_tr_b16 a[148:149],v5 offset:256
v_lshl_add_u32 v19,v38,4,v19
v_mfma_f32_16x16x32_bf16 v[176:179],a[120:123],v[44:47],v[176:179]
s_cselect_b32 s62,s32,0
ds_read_b64_tr_b16 a[150:151],v5 offset:6400
v_bfe_u32 v38,v39,4,1
v_mfma_f32_16x16x32_bf16 v[180:183],a[124:127],v[44:47],v[180:183]
s_or_b32 s31,s31,s62
v_lshl_add_u32 v36,v38,3,v19
v_xor_b32 v37,32,v36
v_mfma_f32_16x16x32_bf16 v[228:231],a[124:127],v[48:51],v[228:231]
s_lshl_b32 s32,s32,1
v_xor_b32 v38,64,v36
v_bfe_u32 v19,v39,3,1
v_mfma_f32_16x16x32_bf16 v[224:227],a[120:123],v[48:51],v[224:227]
s_add_u32 m0,s24,6144
v_xor_b32 v39,96,v36
v_lshlrev_b32 v19,11,v19
v_mfma_f32_16x16x32_bf16 v[128:131],a[120:123],v[52:55],v[128:131]
buffer_load_dwordx4 v6,s[12:15],s28 offen offset:0 nt lds
v_mfma_f32_16x16x32_bf16 v[132:135],a[124:127],v[52:55],v[132:135]
buffer_load_dwordx4 v7,s[12:15],s28 offen offset:1024 nt lds
v_mfma_f32_16x16x32_bf16 a[180:183],a[124:127],v[56:59],a[180:183]
buffer_load_dwordx4 v8,s[12:15],s28 offen offset:2048 nt lds
v_mfma_f32_16x16x32_bf16 a[176:179],a[120:123],v[56:59],a[176:179]
s_add_u32 s28,s28,3072
v_cvt_pk_bf16_f32 v72,v72,v73
v_cvt_pk_bf16_f32 v76,v76,v77
v_mfma_f32_16x16x32_bf16 a[224:227],a[120:123],v[40:43],a[224:227]
s_add_u32 m0,s24,9216
v_cvt_pk_bf16_f32 v80,v80,v81
v_cvt_pk_bf16_f32 v84,v84,v85
v_mfma_f32_16x16x32_bf16 a[228:231],a[124:127],v[40:43],a[228:231]
buffer_load_dwordx4 v6,s[12:15],s28 offen offset:0 nt lds
s_waitcnt lgkmcnt(0)
v_mfma_f32_16x16x32_bf16 a[232:235],a[128:131],v[40:43],a[232:235]
buffer_load_dwordx4 v7,s[12:15],s28 offen offset:1024 nt lds
v_mfma_f32_16x16x32_bf16 a[236:239],a[132:135],v[40:43],a[236:239]
buffer_load_dwordx4 v8,s[12:15],s28 offen offset:2048 nt lds
v_cvt_pk_bf16_f32 v73,v74,v75
v_cvt_pk_bf16_f32 v77,v78,v79
ds_write2st64_b64 v36,v[72:73],v[76:77] offset0:36 offset1:40
v_cvt_pk_bf16_f32 v81,v82,v83
v_cvt_pk_bf16_f32 v85,v86,v87
v_accvgpr_read_b32 v82,a178
v_accvgpr_read_b32 v83,a179
v_pk_mul_f32 v[82:83],v[82:83],v[66:67] op_sel_hi:[1,0]
v_accvgpr_read_b32 v86,a226
v_accvgpr_read_b32 v87,a227
v_pk_mul_f32 v[86:87],v[86:87],v[68:69] op_sel_hi:[1,0]
v_cvt_pk_bf16_f32 v92,v92,v93
v_cvt_pk_bf16_f32 v88,v88,v89
v_cvt_pk_bf16_f32 v93,v94,v95
ds_write2st64_b64 v37,v[80:81],v[84:85] offset0:36 offset1:40
v_accvgpr_read_b32 v80,a176
v_accvgpr_read_b32 v81,a177
v_pk_mul_f32 v[80:81],v[80:81],v[66:67] op_sel_hi:[1,0]
v_accvgpr_read_b32 v84,a224
v_accvgpr_read_b32 v85,a225
v_pk_mul_f32 v[84:85],v[84:85],v[68:69] op_sel_hi:[1,0]
v_cvt_pk_bf16_f32 v89,v90,v91
v_accvgpr_read_b32 v94,a230
v_mfma_f32_16x16x32_bf16 a[188:191],a[132:135],v[56:59],a[188:191]
s_add_u32 s28,s28,3072
v_accvgpr_read_b32 v95,a231
ds_write2st64_b64 v38,v[88:89],v[92:93] offset0:36 offset1:40
v_pk_mul_f32 v[94:95],v[94:95],v[68:69] op_sel_hi:[1,0]
v_accvgpr_read_b32 v90,a182
v_accvgpr_read_b32 v91,a183
v_pk_mul_f32 v[90:91],v[90:91],v[66:67] op_sel_hi:[1,0]
v_accvgpr_read_b32 v88,a180
v_accvgpr_read_b32 v89,a181
v_pk_mul_f32 v[88:89],v[88:89],v[66:67] op_sel_hi:[1,0]
v_accvgpr_read_b32 v92,a228
v_accvgpr_read_b32 v93,a229
v_pk_mul_f32 v[92:93],v[92:93],v[68:69] op_sel_hi:[1,0]
v_cvt_pk_bf16_f32 v96,v96,v97
v_cvt_pk_bf16_f32 v100,v100,v101
v_mfma_f32_16x16x32_bf16 a[184:187],a[128:131],v[56:59],a[184:187]
s_waitcnt vmcnt(21)
ds_read_b128 a[48:51],v11 offset:12288
v_cvt_pk_bf16_f32 v97,v98,v99
v_mfma_f32_16x16x32_bf16 v[136:139],a[128:131],v[52:55],v[136:139]
s_add_u32 m0,s23,0
ds_read_b128 a[52:55],v12 offset:12288
v_cvt_pk_bf16_f32 v101,v102,v103
v_mfma_f32_16x16x32_bf16 v[140:143],a[132:135],v[52:55],v[140:143]
ds_read_b128 a[56:59],v11 offset:12416
v_cvt_pk_bf16_f32 v80,v80,v81
v_mfma_f32_16x16x32_bf16 v[236:239],a[132:135],v[48:51],v[236:239]
ds_read_b128 a[60:63],v12 offset:12416
v_cvt_pk_bf16_f32 v84,v84,v85
ds_read_b128 a[64:67],v11 offset:12544
v_cvt_pk_bf16_f32 v81,v82,v83
ds_read_b128 a[68:71],v12 offset:12544
v_cvt_pk_bf16_f32 v85,v86,v87
ds_write2st64_b64 v39,v[96:97],v[100:101] offset0:36 offset1:40
v_accvgpr_read_b32 v98,a186
v_accvgpr_read_b32 v99,a187
v_pk_mul_f32 v[98:99],v[98:99],v[66:67] op_sel_hi:[1,0]
ds_read_b128 v[104:107],v10 offset:18432
v_accvgpr_read_b32 v102,a234
ds_read_b128 v[108:111],v10 offset:19456
v_accvgpr_read_b32 v103,a235
ds_read_b128 v[72:75],v10 offset:20480
v_pk_mul_f32 v[102:103],v[102:103],v[68:69] op_sel_hi:[1,0]
ds_read_b128 v[76:79],v10 offset:21504
v_accvgpr_read_b32 v82,a190
ds_write2st64_b64 v36,v[80:81],v[84:85] offset0:36 offset1:40
v_accvgpr_read_b32 v83,a191
v_pk_mul_f32 v[82:83],v[82:83],v[66:67] op_sel_hi:[1,0]
v_accvgpr_read_b32 v86,a238
v_accvgpr_read_b32 v87,a239
v_pk_mul_f32 v[86:87],v[86:87],v[68:69] op_sel_hi:[1,0]
v_accvgpr_read_b32 v96,a184
v_accvgpr_read_b32 v97,a185
s_waitcnt lgkmcnt(4)
buffer_store_dwordx4 v[104:107],v9,s[16:19],s87 offen offset:0 nt
v_pk_mul_f32 v[96:97],v[96:97],v[66:67] op_sel_hi:[1,0]
v_accvgpr_read_b32 v100,a232
v_accvgpr_read_b32 v101,a233
v_pk_mul_f32 v[100:101],v[100:101],v[68:69] op_sel_hi:[1,0]
v_accvgpr_read_b32 v80,a188
v_accvgpr_read_b32 v81,a189
v_pk_mul_f32 v[80:81],v[80:81],v[66:67] op_sel_hi:[1,0]
v_accvgpr_read_b32 v84,a236
v_accvgpr_read_b32 v85,a237
v_pk_mul_f32 v[84:85],v[84:85],v[68:69] op_sel_hi:[1,0]
v_cvt_pk_bf16_f32 v88,v88,v89
v_cvt_pk_bf16_f32 v92,v92,v93
v_mfma_f32_16x16x32_bf16 v[232:235],a[128:131],v[48:51],v[232:235]
s_waitcnt lgkmcnt(0)
buffer_store_dwordx4 v[108:111],v9,s[16:19],s87 offen offset:3072 nt
v_cvt_pk_bf16_f32 v96,v96,v97
v_cvt_pk_bf16_f32 v100,v100,v101
v_cvt_pk_bf16_f32 v89,v90,v91
v_mfma_f32_16x16x32_bf16 v[184:187],a[128:131],v[44:47],v[184:187]
v_cvt_pk_bf16_f32 v93,v94,v95
v_cvt_pk_bf16_f32 v80,v80,v81
v_mfma_f32_16x16x32_bf16 v[188:191],a[132:135],v[44:47],v[188:191]
v_cvt_pk_bf16_f32 v84,v84,v85
v_cvt_pk_bf16_f32 v97,v98,v99
v_mfma_f32_16x16x32_bf16 v[192:195],a[136:139],v[44:47],v[192:195]
ds_write2st64_b64 v37,v[88:89],v[92:93] offset0:36 offset1:40
v_mfma_f32_16x16x32_bf16 v[196:199],a[140:143],v[44:47],v[196:199]
v_cvt_pk_bf16_f32 v101,v102,v103
v_cvt_pk_bf16_f32 v81,v82,v83
v_mfma_f32_16x16x32_bf16 v[244:247],a[140:143],v[48:51],v[244:247]
buffer_store_dwordx4 v[72:75],v9,s[16:19],s66 offen offset:0 nt
v_cvt_pk_bf16_f32 v85,v86,v87
v_rcp_f32 v64,v64
v_mfma_f32_16x16x32_bf16 v[240:243],a[136:139],v[48:51],v[240:243]
v_rcp_f32 v60,v60
v_mfma_f32_16x16x32_bf16 v[144:147],a[136:139],v[52:55],v[144:147]
v_rcp_f32 v62,v62
v_mfma_f32_16x16x32_bf16 v[148:151],a[140:143],v[52:55],v[148:151]
ds_write2st64_b64 v38,v[96:97],v[100:101] offset0:36 offset1:40
v_mfma_f32_16x16x32_bf16 a[196:199],a[140:143],v[56:59],a[196:199]
v_mov_b32 v70,0
v_mov_b32 v71,0
v_mfma_f32_16x16x32_bf16 a[192:195],a[136:139],v[56:59],a[192:195]
buffer_store_dwordx4 v[76:79],v9,s[16:19],s66 offen offset:3072 nt
s_waitcnt vmcnt(10)
s_barrier
v_mfma_f32_16x16x32_bf16 a[240:243],a[136:139],v[40:43],a[240:243]
ds_read_b128 a[120:123],v0 offset:0
v_accvgpr_read_b32 v96,a196
v_mfma_f32_16x16x32_bf16 a[244:247],a[140:143],v[40:43],a[244:247]
ds_write2st64_b64 v39,v[80:81],v[84:85] offset0:36 offset1:40
v_mfma_f32_16x16x32_bf16 a[248:251],a[144:147],v[40:43],a[248:251]
v_accvgpr_read_b32 v104,a192
v_accvgpr_read_b32 v105,a193
v_mfma_f32_16x16x32_bf16 a[252:255],a[148:151],v[40:43],a[252:255]
ds_read_b128 v[72:75],v10 offset:18432
buffer_load_dwordx4 v6,s[8:11],s25 offen offset:0 lds
ds_read_b128 v[76:79],v10 offset:19456
v_pk_mul_f32 v[104:105],v[104:105],v[66:67] op_sel_hi:[1,0]
ds_read_b128 v[88:91],v10 offset:20480
v_accvgpr_read_b32 v106,a194
ds_read_b128 v[92:95],v10 offset:21504
v_accvgpr_read_b32 v107,a195
ds_read_b128 a[124:127],v1 offset:0
v_pk_mul_f32 v[106:107],v[106:107],v[66:67] op_sel_hi:[1,0]
ds_read_b128 a[128:131],v0 offset:128
v_accvgpr_read_b32 v108,a240
ds_read_b128 a[132:135],v1 offset:128
v_accvgpr_read_b32 v109,a241
ds_read_b128 a[136:139],v0 offset:256
s_waitcnt lgkmcnt(7)
buffer_store_dwordx4 v[72:75],v9,s[16:19],s87 offen offset:128 nt
ds_read_b128 a[140:143],v1 offset:256
v_pk_mul_f32 v[108:109],v[108:109],v[68:69] op_sel_hi:[1,0]
v_accvgpr_read_b32 v110,a242
v_accvgpr_read_b32 v111,a243
v_pk_mul_f32 v[110:111],v[110:111],v[68:69] op_sel_hi:[1,0]
v_accvgpr_read_b32 v97,a197
v_accvgpr_read_b32 v98,a198
v_mfma_f32_16x16x32_bf16 a[204:207],a[148:151],v[56:59],a[204:207]
v_accvgpr_read_b32 v99,a199
buffer_load_dwordx4 v7,s[8:11],s25 offen offset:1024 lds
s_waitcnt lgkmcnt(4)
buffer_store_dwordx4 v[76:79],v9,s[16:19],s87 offen offset:3200 nt
v_pk_mul_f32 v[96:97],v[96:97],v[66:67] op_sel_hi:[1,0]
v_pk_mul_f32 v[98:99],v[98:99],v[66:67] op_sel_hi:[1,0]
v_accvgpr_read_b32 v100,a244
v_accvgpr_read_b32 v101,a245
v_pk_mul_f32 v[100:101],v[100:101],v[68:69] op_sel_hi:[1,0]
v_accvgpr_read_b32 v102,a246
v_accvgpr_read_b32 v103,a247
v_pk_mul_f32 v[102:103],v[102:103],v[68:69] op_sel_hi:[1,0]
v_cvt_pk_bf16_f32 v104,v104,v105
v_cvt_pk_bf16_f32 v108,v108,v109
v_mfma_f32_16x16x32_bf16 a[200:203],a[144:147],v[56:59],a[200:203]
v_cvt_pk_bf16_f32 v105,v106,v107
v_cvt_pk_bf16_f32 v109,v110,v111
v_mfma_f32_16x16x32_bf16 v[152:155],a[144:147],v[52:55],v[152:155]
ds_write2st64_b64 v36,v[104:105],v[108:109] offset0:36 offset1:40
v_mfma_f32_16x16x32_bf16 v[156:159],a[148:151],v[52:55],v[156:159]
v_add_u32 v36,v36,v19
v_accvgpr_read_b32 v84,a248
v_mfma_f32_16x16x32_bf16 v[252:255],a[148:151],v[48:51],v[252:255]
buffer_load_dwordx4 v8,s[8:11],s25 offen offset:2048 lds
buffer_store_dwordx4 v[88:91],v9,s[16:19],s66 offen offset:128 nt
v_pk_mul_f32 v[112:113],v[112:113],v[64:65] op_sel_hi:[1,0]
v_pk_mul_f32 v[114:115],v[114:115],v[64:65] op_sel_hi:[1,0]
v_pk_mul_f32 v[128:129],v[128:129],v[64:65] op_sel_hi:[1,0]
v_pk_mul_f32 v[130:131],v[130:131],v[64:65] op_sel_hi:[1,0]
v_pk_mul_f32 v[116:117],v[116:117],v[64:65] op_sel_hi:[1,0]
v_pk_mul_f32 v[118:119],v[118:119],v[64:65] op_sel_hi:[1,0]
v_pk_mul_f32 v[132:133],v[132:133],v[64:65] op_sel_hi:[1,0]
v_pk_mul_f32 v[134:135],v[134:135],v[64:65] op_sel_hi:[1,0]
v_accvgpr_read_b32 v85,a249
v_pk_mul_f32 v[84:85],v[84:85],v[68:69] op_sel_hi:[1,0]
v_accvgpr_read_b32 v86,a250
buffer_store_dwordx4 v[92:95],v9,s[16:19],s66 offen offset:3200 nt
v_accvgpr_read_b32 v87,a251
v_pk_mul_f32 v[86:87],v[86:87],v[68:69] op_sel_hi:[1,0]
v_accvgpr_read_b32 v80,a200
v_accvgpr_read_b32 v81,a201
v_pk_mul_f32 v[80:81],v[80:81],v[66:67] op_sel_hi:[1,0]
v_accvgpr_read_b32 v82,a202
v_accvgpr_read_b32 v83,a203
v_pk_mul_f32 v[82:83],v[82:83],v[66:67] op_sel_hi:[1,0]
v_accvgpr_read_b32 v106,a206
v_accvgpr_read_b32 v107,a207
v_pk_mul_f32 v[106:107],v[106:107],v[66:67] op_sel_hi:[1,0]
v_accvgpr_read_b32 v110,a254
v_accvgpr_read_b32 v111,a255
v_pk_mul_f32 v[110:111],v[110:111],v[68:69] op_sel_hi:[1,0]
v_accvgpr_read_b32 v104,a204
v_accvgpr_read_b32 v105,a205
v_pk_mul_f32 v[104:105],v[104:105],v[66:67] op_sel_hi:[1,0]
v_accvgpr_read_b32 v108,a252
v_accvgpr_read_b32 v109,a253
v_pk_mul_f32 v[108:109],v[108:109],v[68:69] op_sel_hi:[1,0]
v_cvt_pk_bf16_f32 v96,v96,v97
v_cvt_pk_bf16_f32 v100,v100,v101
v_mfma_f32_16x16x32_bf16 v[248:251],a[144:147],v[48:51],v[248:251]
s_waitcnt vmcnt(20)
ds_read_b128 a[92:95],v12 offset:256
v_cvt_pk_bf16_f32 v84,v84,v85
v_mfma_f32_16x16x32_bf16 v[200:203],a[144:147],v[44:47],v[200:203]
s_mov_b32 s27,s42
ds_read_b128 a[88:91],v11 offset:256
v_cvt_pk_bf16_f32 v80,v80,v81
ds_read_b128 a[84:87],v12 offset:128
v_pk_mul_f32 v[120:121],v[120:121],v[64:65] op_sel_hi:[1,0]
ds_read_b128 a[80:83],v11 offset:128
v_pk_mul_f32 v[122:123],v[122:123],v[64:65] op_sel_hi:[1,0]
ds_read_b128 a[76:79],v12 offset:0
v_pk_mul_f32 v[136:137],v[136:137],v[64:65] op_sel_hi:[1,0]
ds_read_b128 a[72:75],v11 offset:0
v_pk_mul_f32 v[138:139],v[138:139],v[64:65] op_sel_hi:[1,0]
v_cvt_pk_bf16_f32 v97,v98,v99
v_cvt_pk_bf16_f32 v101,v102,v103
v_mfma_f32_16x16x32_bf16 v[204:207],a[148:151],v[44:47],v[204:207]
s_mov_b32 s42,s41
ds_write2st64_b64 v37,v[96:97],v[100:101] offset0:36 offset1:40
v_mfma_f32_16x16x32_bf16 v[72:75],a[120:123],a[0:3],0
s_add_u32 s69,s69,1
v_add_u32 v37,v37,v19
ds_read_b128 a[144:147],v0 offset:6144
v_mfma_f32_16x16x32_bf16 v[72:75],a[124:127],a[4:7],v[72:75]
s_lshl_b32 s62,s69,5
ds_read_b128 a[148:151],v1 offset:6144
v_cvt_pk_bf16_f32 v104,v104,v105
v_cvt_pk_bf16_f32 v108,v108,v109
v_cvt_pk_bf16_f32 v85,v86,v87
v_pk_mul_f32 v[124:125],v[124:125],v[64:65] op_sel_hi:[1,0]
v_pk_mul_f32 v[126:127],v[126:127],v[64:65] op_sel_hi:[1,0]
v_pk_mul_f32 v[140:141],v[140:141],v[64:65] op_sel_hi:[1,0]
v_pk_mul_f32 v[142:143],v[142:143],v[64:65] op_sel_hi:[1,0]
v_cvt_pk_bf16_f32 v81,v82,v83
v_cvt_pk_bf16_f32 v105,v106,v107
s_waitcnt lgkmcnt(3)
v_mfma_f32_16x16x32_bf16 v[72:75],a[128:131],a[8:11],v[72:75]
s_add_u32 s62,s62,s34
ds_write2st64_b64 v38,v[80:81],v[84:85] offset0:36 offset1:40
v_mfma_f32_16x16x32_bf16 v[72:75],a[132:135],a[12:15],v[72:75]
s_waitcnt vmcnt(11)
v_add_u32 v38,v38,v19
v_cvt_pk_bf16_f32 v109,v110,v111
v_mfma_f32_16x16x32_bf16 v[72:75],a[136:139],a[16:19],v[72:75]
s_mul_i32 s63,s62,171
ds_read_b128 a[96:99],v11 offset:6144
v_cvt_pk_bf16_f32 v112,v112,v113
v_mfma_f32_16x16x32_bf16 v[72:75],a[140:143],a[20:23],v[72:75]
s_lshr_b32 s63,s63,9
ds_read_b128 a[100:103],v12 offset:6144
v_cvt_pk_bf16_f32 v128,v128,v129
ds_read_b128 a[104:107],v11 offset:6272
v_pk_mul_f32 v[144:145],v[144:145],v[64:65] op_sel_hi:[1,0]
ds_read_b128 a[108:111],v12 offset:6272
v_pk_mul_f32 v[146:147],v[146:147],v[64:65] op_sel_hi:[1,0]
ds_read_b128 a[112:115],v11 offset:6400
v_pk_mul_f32 v[160:161],v[160:161],v[60:61] op_sel_hi:[1,0]
ds_read_b128 a[116:119],v12 offset:6400
v_pk_mul_f32 v[162:163],v[162:163],v[60:61] op_sel_hi:[1,0]
v_max3_f32 v44,v72,v73,v74
v_cvt_pk_bf16_f32 v116,v116,v117
v_mfma_f32_16x16x32_bf16 v[80:83],a[140:143],a[44:47],0
s_mul_i32 s64,s63,3
ds_write2st64_b64 v39,v[104:105],v[108:109] offset0:36 offset1:40
v_mfma_f32_16x16x32_bf16 v[80:83],a[136:139],a[40:43],v[80:83]
s_sub_u32 s62,s62,s64
v_add_u32 v39,v39,v19
v_cvt_pk_bf16_f32 v132,v132,v133
v_mfma_f32_16x16x32_bf16 v[80:83],a[132:135],a[36:39],v[80:83]
s_add_u32 s63,s63,s33
ds_read_b128 v[76:79],v10 offset:18432
v_cvt_pk_bf16_f32 v113,v114,v115
ds_read_b128 v[88:91],v10 offset:19456
v_pk_mul_f32 v[148:149],v[148:149],v[64:65] op_sel_hi:[1,0]
ds_read_b128 v[92:95],v10 offset:20480
v_pk_mul_f32 v[150:151],v[150:151],v[64:65] op_sel_hi:[1,0]
ds_read_b128 v[96:99],v10 offset:21504
v_pk_mul_f32 v[164:165],v[164:165],v[60:61] op_sel_hi:[1,0]
v_pk_mul_f32 v[166:167],v[166:167],v[60:61] op_sel_hi:[1,0]
v_cvt_pk_bf16_f32 v129,v130,v131
v_cvt_pk_bf16_f32 v120,v120,v121
v_mfma_f32_16x16x32_bf16 v[80:83],a[128:131],a[32:35],v[80:83]
s_mul_i32 s30,s63,196608
ds_write2st64_b64 v36,v[112:113],v[128:129] offset0:24 offset1:26
v_mfma_f32_16x16x32_bf16 v[80:83],a[124:127],a[28:31],v[80:83]
s_mul_i32 s41,s63,325632
v_cvt_pk_bf16_f32 v136,v136,v137
v_cvt_pk_bf16_f32 v117,v118,v119
v_mfma_f32_16x16x32_bf16 v[80:83],a[120:123],a[24:27],v[80:83]
s_lshl_b32 s63,s3,2
s_waitcnt lgkmcnt(4)
buffer_store_dwordx4 v[76:79],v9,s[16:19],s87 offen offset:256 nt
v_cvt_pk_bf16_f32 v133,v134,v135
v_cvt_pk_bf16_f32 v124,v124,v125
v_cvt_pk_bf16_f32 v140,v140,v141
v_cvt_pk_bf16_f32 v121,v122,v123
v_cvt_pk_bf16_f32 v137,v138,v139
v_cvt_pk_bf16_f32 v144,v144,v145
v_max3_f32 v48,v80,v81,v82
v_cvt_pk_bf16_f32 v160,v160,v161
v_cvt_pk_bf16_f32 v125,v126,v127
ds_write2st64_b64 v37,v[116:117],v[132:133] offset0:24 offset1:26
v_cvt_pk_bf16_f32 v141,v142,v143
v_cvt_pk_bf16_f32 v148,v148,v149
v_cvt_pk_bf16_f32 v164,v164,v165
s_waitcnt lgkmcnt(1)
buffer_store_dwordx4 v[88:91],v9,s[16:19],s87 offen offset:3328 nt
v_cvt_pk_bf16_f32 v145,v146,v147
v_cvt_pk_bf16_f32 v161,v162,v163
v_cvt_pk_bf16_f32 v149,v150,v151
v_mfma_f32_16x16x32_bf16 v[88:91],a[120:123],a[48:51],0
s_add_u32 s64,s63,21
v_cvt_pk_bf16_f32 v165,v166,v167
v_mov_b32 v66,0
v_mov_b32 v67,0
v_mov_b32 v68,0
ds_write2st64_b64 v38,v[120:121],v[136:137] offset0:24 offset1:26
v_pk_mul_f32 v[152:153],v[152:153],v[64:65] op_sel_hi:[1,0]
v_pk_mul_f32 v[154:155],v[154:155],v[64:65] op_sel_hi:[1,0]
v_pk_mul_f32 v[168:169],v[168:169],v[60:61] op_sel_hi:[1,0]
buffer_store_dwordx4 v[92:95],v9,s[16:19],s66 offen offset:256 nt
v_pk_mul_f32 v[170:171],v[170:171],v[60:61] op_sel_hi:[1,0]
v_cvt_pk_bf16_f32 v152,v152,v153
v_cvt_pk_bf16_f32 v168,v168,v169
v_mfma_f32_16x16x32_bf16 v[88:91],a[124:127],a[52:55],v[88:91]
s_cmp_eq_u32 s3,0
v_cvt_pk_bf16_f32 v153,v154,v155
v_cvt_pk_bf16_f32 v169,v170,v171
v_mfma_f32_16x16x32_bf16 v[88:91],a[128:131],a[56:59],v[88:91]
s_cselect_b32 s64,20,s64
v_mov_b32 v69,0
s_cselect_b32 s40,1,0
v_mfma_f32_16x16x32_bf16 v[88:91],a[132:135],a[60:63],v[88:91]
s_add_u32 s65,s63,37
ds_write2st64_b64 v39,v[124:125],v[140:141] offset0:24 offset1:26
v_mfma_f32_16x16x32_bf16 v[88:91],a[136:139],a[64:67],v[88:91]
s_cmp_eq_u32 s62,2
s_cselect_b32 s64,s65,s64
buffer_store_dwordx4 v[96:99],v9,s[16:19],s66 offen offset:3328 nt
v_pk_mul_f32 v[156:157],v[156:157],v[64:65] op_sel_hi:[1,0]
v_pk_mul_f32 v[158:159],v[158:159],v[64:65] op_sel_hi:[1,0]
v_pk_mul_f32 v[172:173],v[172:173],v[60:61] op_sel_hi:[1,0]
v_pk_mul_f32 v[174:175],v[174:175],v[60:61] op_sel_hi:[1,0]
v_cvt_pk_bf16_f32 v156,v156,v157
v_cvt_pk_bf16_f32 v172,v172,v173
v_mfma_f32_16x16x32_bf16 v[88:91],a[140:143],a[68:71],v[88:91]
s_cselect_b32 s40,0,s40
v_cvt_pk_bf16_f32 v157,v158,v159
v_cvt_pk_bf16_f32 v173,v174,v175
v_mfma_f32_16x16x32_bf16 v[96:99],a[140:143],a[92:95],0
s_add_u32 s65,s63,s3
ds_write2st64_b64 v36,v[144:145],v[160:161] offset0:28 offset1:0
v_mfma_f32_16x16x32_bf16 v[96:99],a[136:139],a[88:91],v[96:99]
s_cmp_eq_u32 s62,0
v_max3_f32 v52,v88,v89,v90
v_mov_b32 v64,0
v_mov_b32 v65,0
s_cselect_b32 s64,s65,s64
s_cselect_b32 s40,1,s40
v_pk_mul_f32 v[176:177],v[176:177],v[60:61] op_sel_hi:[1,0]
v_pk_mul_f32 v[178:179],v[178:179],v[60:61] op_sel_hi:[1,0]
v_pk_mul_f32 v[192:193],v[192:193],v[60:61] op_sel_hi:[1,0]
v_pk_mul_f32 v[194:195],v[194:195],v[60:61] op_sel_hi:[1,0]
v_cvt_pk_bf16_f32 v176,v176,v177
v_cvt_pk_bf16_f32 v192,v192,v193
v_mfma_f32_16x16x32_bf16 v[96:99],a[132:135],a[84:87],v[96:99]
s_mul_i32 s64,s64,6144
ds_write2st64_b64 v37,v[148:149],v[164:165] offset0:28 offset1:0
v_mfma_f32_16x16x32_bf16 v[96:99],a[128:131],a[80:83],v[96:99]
s_add_u32 s41,s41,s64
v_cvt_pk_bf16_f32 v177,v178,v179
v_cvt_pk_bf16_f32 v193,v194,v195
v_mfma_f32_16x16x32_bf16 v[96:99],a[124:127],a[76:79],v[96:99]
s_cmp_ge_u32 s69,6
s_cselect_b32 s41,166723584,s41
s_cselect_b32 s30,100663296,s30
v_mfma_f32_16x16x32_bf16 v[96:99],a[120:123],a[72:75],v[96:99]
s_add_u32 s25,s30,s22
s_add_u32 s26,s25,12288
ds_write2st64_b64 v38,v[152:153],v[168:169] offset0:28 offset1:0
v_pk_mul_f32 v[180:181],v[180:181],v[60:61] op_sel_hi:[1,0]
v_pk_mul_f32 v[182:183],v[182:183],v[60:61] op_sel_hi:[1,0]
v_pk_mul_f32 v[196:197],v[196:197],v[60:61] op_sel_hi:[1,0]
v_pk_mul_f32 v[198:199],v[198:199],v[60:61] op_sel_hi:[1,0]
v_cvt_pk_bf16_f32 v180,v180,v181
v_max3_f32 v56,v96,v97,v98
v_mfma_f32_16x16x32_bf16 v[104:107],a[120:123],a[96:99],0
s_add_u32 m0,s23,24576
ds_read_b128 a[120:123],v0 offset:6272
v_cvt_pk_bf16_f32 v196,v196,v197
v_mfma_f32_16x16x32_bf16 v[104:107],a[124:127],a[100:103],v[104:107]
s_mov_b32 s28,s41
ds_read_b128 a[124:127],v1 offset:6272
v_cvt_pk_bf16_f32 v181,v182,v183
v_mfma_f32_16x16x32_bf16 v[104:107],a[128:131],a[104:107],v[104:107]
s_mov_b32 s29,s24
ds_write2st64_b64 v39,v[156:157],v[172:173] offset0:28 offset1:0
v_pk_mul_f32 v[184:185],v[184:185],v[60:61] op_sel_hi:[1,0]
v_pk_mul_f32 v[186:187],v[186:187],v[60:61] op_sel_hi:[1,0]
v_pk_mul_f32 v[200:201],v[200:201],v[60:61] op_sel_hi:[1,0]
ds_read_b128 a[128:131],v0 offset:6400
v_pk_mul_f32 v[202:203],v[202:203],v[60:61] op_sel_hi:[1,0]
v_cvt_pk_bf16_f32 v197,v198,v199
v_cvt_pk_bf16_f32 v184,v184,v185
v_mfma_f32_16x16x32_bf16 v[104:107],a[132:135],a[108:111],v[104:107]
ds_read_b128 a[132:135],v1 offset:6400
v_cvt_pk_bf16_f32 v200,v200,v201
v_mfma_f32_16x16x32_bf16 v[104:107],a[136:139],a[112:115],v[104:107]
ds_read_b128 a[136:139],v0 offset:12288
v_cvt_pk_bf16_f32 v185,v186,v187
v_mfma_f32_16x16x32_bf16 v[104:107],a[140:143],a[116:119],v[104:107]
ds_read_b128 a[140:143],v1 offset:12288
v_cvt_pk_bf16_f32 v201,v202,v203
v_mfma_f32_16x16x32_bf16 v[76:79],a[144:147],a[0:3],0
ds_write2st64_b64 v36,v[176:177],v[192:193] offset0:2 offset1:4
v_pk_mul_f32 v[188:189],v[188:189],v[60:61] op_sel_hi:[1,0]
v_pk_mul_f32 v[190:191],v[190:191],v[60:61] op_sel_hi:[1,0]
v_pk_mul_f32 v[204:205],v[204:205],v[60:61] op_sel_hi:[1,0]
v_pk_mul_f32 v[206:207],v[206:207],v[60:61] op_sel_hi:[1,0]
v_max3_f32 v40,v104,v105,v106
v_cvt_pk_bf16_f32 v188,v188,v189
v_mfma_f32_16x16x32_bf16 v[76:79],a[148:151],a[4:7],v[76:79]
s_waitcnt lgkmcnt(4)
v_cvt_pk_bf16_f32 v204,v204,v205
v_cvt_pk_bf16_f32 v189,v190,v191
v_mfma_f32_16x16x32_bf16 v[76:79],a[120:123],a[8:11],v[76:79]
v_cvt_pk_bf16_f32 v205,v206,v207
v_mov_b32 v60,0
v_mfma_f32_16x16x32_bf16 v[76:79],a[124:127],a[12:15],v[76:79]
ds_write2st64_b64 v37,v[180:181],v[196:197] offset0:2 offset1:4
v_mfma_f32_16x16x32_bf16 v[76:79],a[128:131],a[16:19],v[76:79]
v_mov_b32 v61,0
v_pk_mul_f32 v[208:209],v[208:209],v[62:63] op_sel_hi:[1,0]
buffer_load_dwordx4 v6,s[8:11],s21 offen offset:0 lds
ds_write2st64_b64 v38,v[184:185],v[200:201] offset0:2 offset1:4
v_pk_mul_f32 v[210:211],v[210:211],v[62:63] op_sel_hi:[1,0]
v_pk_mul_f32 v[224:225],v[224:225],v[62:63] op_sel_hi:[1,0]
v_pk_mul_f32 v[226:227],v[226:227],v[62:63] op_sel_hi:[1,0]
v_cvt_pk_bf16_f32 v208,v208,v209
v_cvt_pk_bf16_f32 v224,v224,v225
s_waitcnt lgkmcnt(2)
v_mfma_f32_16x16x32_bf16 v[76:79],a[132:135],a[20:23],v[76:79]
v_cvt_pk_bf16_f32 v209,v210,v211
v_cvt_pk_bf16_f32 v225,v226,v227
v_mfma_f32_16x16x32_bf16 v[84:87],a[132:135],a[44:47],0
v_mfma_f32_16x16x32_bf16 v[84:87],a[128:131],a[40:43],v[84:87]
ds_write2st64_b64 v39,v[188:189],v[204:205] offset0:2 offset1:4
v_pk_mul_f32 v[212:213],v[212:213],v[62:63] op_sel_hi:[1,0]
v_pk_mul_f32 v[214:215],v[214:215],v[62:63] op_sel_hi:[1,0]
v_pk_mul_f32 v[228:229],v[228:229],v[62:63] op_sel_hi:[1,0]
v_pk_mul_f32 v[230:231],v[230:231],v[62:63] op_sel_hi:[1,0]
v_max3_f32 v44,v44,v75,v76
v_max3_f32 v44,v44,v77,v78
v_mfma_f32_16x16x32_bf16 v[84:87],a[124:127],a[36:39],v[84:87]
buffer_load_dwordx4 v7,s[8:11],s21 offen offset:1024 lds
v_mfma_f32_16x16x32_bf16 v[84:87],a[120:123],a[32:35],v[84:87]
ds_write2st64_b64 v36,v[208:209],v[224:225] offset0:12 offset1:14
v_mfma_f32_16x16x32_bf16 v[84:87],a[148:151],a[28:31],v[84:87]
v_max_f32 v44,v44,v79
v_mov_b32 v45,v44
v_mfma_f32_16x16x32_bf16 v[84:87],a[144:147],a[24:27],v[84:87]
v_cvt_pk_bf16_f32 v212,v212,v213
v_permlane32_swap_b32 v45,v44
v_max_f32 v44,v44,v45
v_mov_b32 v45,v44
v_pk_mul_f32 v[216:217],v[216:217],v[62:63] op_sel_hi:[1,0]
v_pk_mul_f32 v[218:219],v[218:219],v[62:63] op_sel_hi:[1,0]
v_pk_mul_f32 v[232:233],v[232:233],v[62:63] op_sel_hi:[1,0]
v_pk_mul_f32 v[234:235],v[234:235],v[62:63] op_sel_hi:[1,0]
v_permlane16_swap_b32 v45,v44
v_max_f32 v44,v44,v45
v_mfma_f32_16x16x32_bf16 v[92:95],a[144:147],a[48:51],0
v_mul_f32_e64 v13,-s36,v44
v_fma_f32 v72,v72,s36,v13
v_mfma_f32_16x16x32_bf16 v[92:95],a[148:151],a[52:55],v[92:95]
buffer_load_dwordx4 v8,s[8:11],s21 offen offset:2048 lds
v_mfma_f32_16x16x32_bf16 v[92:95],a[120:123],a[56:59],v[92:95]
s_add_u32 s21,s21,12288
v_fma_f32 v73,v73,s36,v13
v_fma_f32 v74,v74,s36,v13
v_mfma_f32_16x16x32_bf16 v[92:95],a[124:127],a[60:63],v[92:95]
s_add_u32 m0,s22,0
v_fma_f32 v75,v75,s36,v13
v_exp_f32 v72,v72
v_exp_f32 v73,v73
v_pk_mul_f32 v[220:221],v[220:221],v[62:63] op_sel_hi:[1,0]
v_pk_mul_f32 v[222:223],v[222:223],v[62:63] op_sel_hi:[1,0]
v_pk_mul_f32 v[236:237],v[236:237],v[62:63] op_sel_hi:[1,0]
v_pk_mul_f32 v[238:239],v[238:239],v[62:63] op_sel_hi:[1,0]
v_exp_f32 v74,v74
v_exp_f32 v75,v75
v_mfma_f32_16x16x32_bf16 v[92:95],a[128:131],a[64:67],v[92:95]
v_cvt_pk_bf16_f32 v20,v72,v73
v_cvt_pk_bf16_f32 v21,v74,v75
v_mfma_f32_16x16x32_bf16 v[92:95],a[132:135],a[68:71],v[92:95]
v_max3_f32 v48,v48,v83,v84
v_max3_f32 v48,v48,v85,v86
v_mfma_f32_16x16x32_bf16 v[100:103],a[132:135],a[92:95],0
v_max_f32 v48,v48,v87
v_mov_b32 v49,v48
v_cvt_pk_bf16_f32 v228,v228,v229
v_cvt_pk_bf16_f32 v213,v214,v215
v_permlane32_swap_b32 v49,v48
v_pk_mul_f32 v[240:241],v[240:241],v[62:63] op_sel_hi:[1,0]
v_pk_mul_f32 v[242:243],v[242:243],v[62:63] op_sel_hi:[1,0]
v_max_f32 v48,v48,v49
v_mov_b32 v49,v48
v_mfma_f32_16x16x32_bf16 v[100:103],a[128:131],a[88:91],v[100:103]
v_max3_f32 v52,v52,v91,v92
v_permlane16_swap_b32 v49,v48
v_mfma_f32_16x16x32_bf16 v[100:103],a[124:127],a[84:87],v[100:103]
v_max_f32 v48,v48,v49
v_mul_f32_e64 v14,-s36,v48
v_mfma_f32_16x16x32_bf16 v[100:103],a[120:123],a[80:83],v[100:103]
v_fma_f32 v80,v80,s36,v14
v_fma_f32 v81,v81,s36,v14
v_mfma_f32_16x16x32_bf16 v[100:103],a[148:151],a[76:79],v[100:103]
v_fma_f32 v82,v82,s36,v14
v_fma_f32 v83,v83,s36,v14
v_exp_f32 v80,v80
v_exp_f32 v81,v81
v_pk_mul_f32 v[244:245],v[244:245],v[62:63] op_sel_hi:[1,0]
v_pk_mul_f32 v[246:247],v[246:247],v[62:63] op_sel_hi:[1,0]
v_exp_f32 v82,v82
v_exp_f32 v83,v83
v_mfma_f32_16x16x32_bf16 v[100:103],a[144:147],a[72:75],v[100:103]
v_cvt_pk_bf16_f32 v24,v80,v81
v_cvt_pk_bf16_f32 v25,v82,v83
v_mfma_f32_16x16x32_bf16 v[108:111],a[144:147],a[96:99],0
ds_read_b128 a[144:147],v0 offset:12416
v_max3_f32 v52,v52,v93,v94
v_mfma_f32_16x16x32_bf16 v[108:111],a[148:151],a[100:103],v[108:111]
ds_read_b128 a[148:151],v1 offset:12416
v_max_f32 v52,v52,v95
v_mov_b32 v53,v52
v_max3_f32 v56,v56,v99,v100
v_max3_f32 v56,v56,v101,v102
v_pk_mul_f32 v[248:249],v[248:249],v[62:63] op_sel_hi:[1,0]
v_pk_mul_f32 v[250:251],v[250:251],v[62:63] op_sel_hi:[1,0]
v_permlane32_swap_b32 v53,v52
v_max_f32 v52,v52,v53
v_mfma_f32_16x16x32_bf16 v[108:111],a[120:123],a[104:107],v[108:111]
ds_read_b128 a[120:123],v0 offset:12544
v_mov_b32 v53,v52
v_mfma_f32_16x16x32_bf16 v[108:111],a[124:127],a[108:111],v[108:111]
ds_read_b128 a[124:127],v1 offset:12544
v_permlane16_swap_b32 v53,v52
v_mfma_f32_16x16x32_bf16 v[108:111],a[128:131],a[112:115],v[108:111]
ds_read_b128 a[128:131],v0 offset:18432
v_max_f32 v52,v52,v53
v_mfma_f32_16x16x32_bf16 v[108:111],a[132:135],a[116:119],v[108:111]
ds_read_b128 a[132:135],v1 offset:18432
v_mul_f32_e64 v15,-s36,v52
v_fma_f32 v88,v88,s36,v15
v_fma_f32 v89,v89,s36,v15
v_fma_f32 v90,v90,s36,v15
v_pk_mul_f32 v[252:253],v[252:253],v[62:63] op_sel_hi:[1,0]
v_pk_mul_f32 v[254:255],v[254:255],v[62:63] op_sel_hi:[1,0]
v_fma_f32 v91,v91,s36,v15
v_exp_f32 v88,v88
v_mfma_f32_16x16x32_bf16 v[72:75],a[136:139],a[0:3],0
v_exp_f32 v89,v89
v_mfma_f32_16x16x32_bf16 v[72:75],a[140:143],a[4:7],v[72:75]
s_waitcnt lgkmcnt(3)
v_exp_f32 v90,v90
v_mfma_f32_16x16x32_bf16 v[72:75],a[144:147],a[8:11],v[72:75]
v_exp_f32 v91,v91
v_mfma_f32_16x16x32_bf16 v[72:75],a[148:151],a[12:15],v[72:75]
v_cvt_pk_bf16_f32 v28,v88,v89
v_cvt_pk_bf16_f32 v29,v90,v91
v_mfma_f32_16x16x32_bf16 v[72:75],a[120:123],a[16:19],v[72:75]
s_waitcnt lgkmcnt(0)
v_max_f32 v56,v56,v103
v_mov_b32 v57,v56
v_mfma_f32_16x16x32_bf16 v[72:75],a[124:127],a[20:23],v[72:75]
v_max3_f32 v40,v40,v107,v108
v_permlane32_swap_b32 v57,v56
v_mfma_f32_16x16x32_bf16 v[80:83],a[124:127],a[44:47],0
v_max_f32 v56,v56,v57
v_mov_b32 v57,v56
v_mfma_f32_16x16x32_bf16 v[80:83],a[120:123],a[40:43],v[80:83]
v_max3_f32 v40,v40,v109,v110
v_permlane16_swap_b32 v57,v56
v_mfma_f32_16x16x32_bf16 v[80:83],a[148:151],a[36:39],v[80:83]
v_max_f32 v56,v56,v57
v_mul_f32_e64 v16,-s36,v56
v_mfma_f32_16x16x32_bf16 v[80:83],a[144:147],a[32:35],v[80:83]
v_fma_f32 v96,v96,s36,v16
v_fma_f32 v97,v97,s36,v16
v_mfma_f32_16x16x32_bf16 v[80:83],a[140:143],a[28:31],v[80:83]
v_fma_f32 v98,v98,s36,v16
v_fma_f32 v99,v99,s36,v16
v_mfma_f32_16x16x32_bf16 v[80:83],a[136:139],a[24:27],v[80:83]
v_exp_f32 v96,v96
v_mfma_f32_16x16x32_bf16 v[88:91],a[136:139],a[48:51],0
v_exp_f32 v97,v97
v_mfma_f32_16x16x32_bf16 v[88:91],a[140:143],a[52:55],v[88:91]
v_exp_f32 v98,v98
v_mfma_f32_16x16x32_bf16 v[88:91],a[144:147],a[56:59],v[88:91]
v_exp_f32 v99,v99
v_mfma_f32_16x16x32_bf16 v[88:91],a[148:151],a[60:63],v[88:91]
v_cvt_pk_bf16_f32 v32,v96,v97
v_cvt_pk_bf16_f32 v33,v98,v99
v_mfma_f32_16x16x32_bf16 v[88:91],a[120:123],a[64:67],v[88:91]
v_max_f32 v40,v40,v111
v_mov_b32 v41,v40
v_mfma_f32_16x16x32_bf16 v[88:91],a[124:127],a[68:71],v[88:91]
v_cvt_pk_bf16_f32 v216,v216,v217
v_permlane32_swap_b32 v41,v40
v_mfma_f32_16x16x32_bf16 v[96:99],a[124:127],a[92:95],0
v_max_f32 v40,v40,v41
v_mov_b32 v41,v40
v_mfma_f32_16x16x32_bf16 v[96:99],a[120:123],a[88:91],v[96:99]
v_cvt_pk_bf16_f32 v232,v232,v233
v_permlane16_swap_b32 v41,v40
v_mfma_f32_16x16x32_bf16 v[96:99],a[148:151],a[84:87],v[96:99]
v_cvt_pk_bf16_f32 v229,v230,v231
v_max_f32 v40,v40,v41
v_mfma_f32_16x16x32_bf16 v[96:99],a[144:147],a[80:83],v[96:99]
ds_write2st64_b64 v37,v[212:213],v[228:229] offset0:12 offset1:14
v_mfma_f32_16x16x32_bf16 v[96:99],a[140:143],a[76:79],v[96:99]
v_cvt_pk_bf16_f32 v220,v220,v221
v_cvt_pk_bf16_f32 v236,v236,v237
v_mfma_f32_16x16x32_bf16 v[96:99],a[136:139],a[72:75],v[96:99]
v_cvt_pk_bf16_f32 v217,v218,v219
v_cvt_pk_bf16_f32 v233,v234,v235
v_mul_f32_e64 v17,-s36,v40
v_cvt_pk_bf16_f32 v240,v240,v241
v_cvt_pk_bf16_f32 v221,v222,v223
ds_write2st64_b64 v38,v[216:217],v[232:233] offset0:12 offset1:14
v_cvt_pk_bf16_f32 v237,v238,v239
v_fma_f32 v104,v104,s36,v17
v_fma_f32 v105,v105,s36,v17
v_fma_f32 v106,v106,s36,v17
v_fma_f32 v107,v107,s36,v17
v_cvt_pk_bf16_f32 v244,v244,v245
v_cvt_pk_bf16_f32 v241,v242,v243
v_exp_f32 v104,v104
v_exp_f32 v105,v105
ds_write2st64_b64 v39,v[220:221],v[236:237] offset0:12 offset1:14
v_exp_f32 v106,v106
v_exp_f32 v107,v107
v_cvt_pk_bf16_f32 v245,v246,v247
v_fma_f32 v76,v76,s36,v13
v_fma_f32 v77,v77,s36,v13
v_fma_f32 v78,v78,s36,v13
v_fma_f32 v79,v79,s36,v13
v_exp_f32 v76,v76
ds_write_b64 v36,v[240:241] offset:8192
v_cvt_pk_bf16_f32 v36,v104,v105
v_exp_f32 v77,v77
v_exp_f32 v78,v78
ds_write_b64 v37,v[244:245] offset:8192
v_cvt_pk_bf16_f32 v37,v106,v107
v_mfma_f32_16x16x32_bf16 v[104:107],a[136:139],a[96:99],0
ds_read_b128 a[136:139],v0 offset:18560
v_exp_f32 v79,v79
v_mfma_f32_16x16x32_bf16 v[104:107],a[140:143],a[100:103],v[104:107]
ds_read_b128 a[140:143],v1 offset:18560
v_cvt_pk_bf16_f32 v22,v76,v77
v_mfma_f32_16x16x32_bf16 v[104:107],a[144:147],a[104:107],v[104:107]
ds_read_b128 a[144:147],v0 offset:18688
v_cvt_pk_bf16_f32 v23,v78,v79
v_mfma_f32_16x16x32_bf16 v[104:107],a[148:151],a[108:111],v[104:107]
ds_read_b128 a[148:151],v1 offset:18688
v_fma_f32 v84,v84,s36,v14
v_mfma_f32_16x16x32_bf16 v[104:107],a[120:123],a[112:115],v[104:107]
v_fma_f32 v85,v85,s36,v14
v_fma_f32 v86,v86,s36,v14
v_mfma_f32_16x16x32_bf16 v[104:107],a[124:127],a[116:119],v[104:107]
v_fma_f32 v87,v87,s36,v14
v_exp_f32 v84,v84
v_mfma_f32_16x16x32_bf16 v[76:79],a[128:131],a[0:3],0
v_exp_f32 v85,v85
v_mfma_f32_16x16x32_bf16 v[76:79],a[132:135],a[4:7],v[76:79]
v_exp_f32 v86,v86
s_waitcnt vmcnt(9)
s_barrier
s_waitcnt lgkmcnt(2)
v_mfma_f32_16x16x32_bf16 v[76:79],a[136:139],a[8:11],v[76:79]
v_exp_f32 v87,v87
v_mfma_f32_16x16x32_bf16 v[76:79],a[140:143],a[12:15],v[76:79]
buffer_load_dwordx4 v6,s[4:7],s20 offen offset:0 lds
s_waitcnt lgkmcnt(0)
v_mfma_f32_16x16x32_bf16 v[76:79],a[144:147],a[16:19],v[76:79]
v_cvt_pk_bf16_f32 v26,v84,v85
v_cvt_pk_bf16_f32 v27,v86,v87
v_mfma_f32_16x16x32_bf16 v[76:79],a[148:151],a[20:23],v[76:79]
v_fma_f32 v92,v92,s36,v15
v_fma_f32 v93,v93,s36,v15
v_mfma_f32_16x16x32_bf16 v[84:87],a[148:151],a[44:47],0
v_fma_f32 v94,v94,s36,v15
v_fma_f32 v95,v95,s36,v15
v_mfma_f32_16x16x32_bf16 v[84:87],a[144:147],a[40:43],v[84:87]
v_exp_f32 v92,v92
v_mfma_f32_16x16x32_bf16 v[84:87],a[140:143],a[36:39],v[84:87]
buffer_load_dwordx4 v7,s[4:7],s20 offen offset:1024 lds
v_mfma_f32_16x16x32_bf16 v[84:87],a[136:139],a[32:35],v[84:87]
v_exp_f32 v93,v93
v_mfma_f32_16x16x32_bf16 v[84:87],a[132:135],a[28:31],v[84:87]
v_exp_f32 v94,v94
v_mfma_f32_16x16x32_bf16 v[84:87],a[128:131],a[24:27],v[84:87]
v_exp_f32 v95,v95
ds_read_b64_tr_b16 a[120:121],v2 offset:0
ds_read_b64_tr_b16 a[122:123],v2 offset:6144
v_cvt_pk_bf16_f32 v30,v92,v93
v_cvt_pk_bf16_f32 v31,v94,v95
v_mfma_f32_16x16x32_bf16 v[92:95],a[128:131],a[48:51],0
buffer_load_dwordx4 v8,s[4:7],s20 offen offset:2048 lds
v_mfma_f32_16x16x32_bf16 v[92:95],a[132:135],a[52:55],v[92:95]
s_add_u32 s20,s20,12288
ds_read_b64_tr_b16 a[124:125],v3 offset:0
v_fma_f32 v100,v100,s36,v16
v_mfma_f32_16x16x32_bf16 v[92:95],a[136:139],a[56:59],v[92:95]
ds_read_b64_tr_b16 a[126:127],v3 offset:6144
v_fma_f32 v101,v101,s36,v16
v_mfma_f32_16x16x32_bf16 v[92:95],a[140:143],a[60:63],v[92:95]
v_fma_f32 v102,v102,s36,v16
v_fma_f32 v103,v103,s36,v16
v_mfma_f32_16x16x32_bf16 v[92:95],a[144:147],a[64:67],v[92:95]
v_exp_f32 v100,v100
v_mfma_f32_16x16x32_bf16 v[92:95],a[148:151],a[68:71],v[92:95]
v_exp_f32 v101,v101
v_exp_f32 v102,v102
v_exp_f32 v103,v103
v_cvt_pk_bf16_f32 v34,v100,v101
v_cvt_pk_bf16_f32 v35,v102,v103
v_mfma_f32_16x16x32_bf16 v[100:103],a[148:151],a[92:95],0
v_cvt_pk_bf16_f32 v248,v248,v249
v_fma_f32 v108,v108,s36,v17
v_smfmac_f32_16x16x64_bf16 v[64:67],a[152:155],v[28:35],v18
v_fma_f32 v109,v109,s36,v17
v_mfma_f32_16x16x32_bf16 v[100:103],a[144:147],a[88:91],v[100:103]
v_fma_f32 v110,v110,s36,v17
v_fma_f32 v111,v111,s36,v17
v_mfma_f32_16x16x32_bf16 v[100:103],a[140:143],a[84:87],v[100:103]
v_cvt_pk_bf16_f32 v252,v252,v253
v_cvt_pk_bf16_f32 v249,v250,v251
v_mfma_f32_16x16x32_bf16 v[100:103],a[136:139],a[80:83],v[100:103]
ds_write_b64 v38,v[248:249] offset:8192
v_mfma_f32_16x16x32_bf16 v[100:103],a[132:135],a[76:79],v[100:103]
v_exp_f32 v108,v108
v_mfma_f32_16x16x32_bf16 v[100:103],a[128:131],a[72:75],v[100:103]
v_exp_f32 v109,v109
v_exp_f32 v110,v110
v_exp_f32 v111,v111
v_cvt_pk_bf16_f32 v253,v254,v255
ds_write_b64 v39,v[252:253] offset:8192
v_cvt_pk_bf16_f32 v38,v108,v109
v_cvt_pk_bf16_f32 v39,v110,v111
v_mfma_f32_16x16x32_bf16 v[108:111],a[128:131],a[96:99],0
ds_read_b64_tr_b16 a[128:129],v4 offset:0
v_mov_b32 v62,0
v_mfma_f32_16x16x32_bf16 v[108:111],a[132:135],a[100:103],v[108:111]
ds_read_b64_tr_b16 a[130:131],v4 offset:6144
v_mov_b32 v63,0
v_mfma_f32_16x16x32_bf16 v[108:111],a[136:139],a[104:107],v[108:111]
ds_read_b64_tr_b16 a[132:133],v5 offset:0
v_fma_f32 v72,v72,s36,v13
v_smfmac_f32_16x16x64_bf16 v[60:63],a[152:155],v[20:27],v18
ds_read_b64_tr_b16 a[134:135],v5 offset:6144
v_mfma_f32_16x16x32_bf16 v[108:111],a[140:143],a[108:111],v[108:111]
v_fma_f32 v73,v73,s36,v13
v_fma_f32 v74,v74,s36,v13
v_mfma_f32_16x16x32_bf16 v[108:111],a[144:147],a[112:115],v[108:111]
v_fma_f32 v75,v75,s36,v13
v_fma_f32 v80,v80,s36,v14
v_mfma_f32_16x16x32_bf16 v[108:111],a[148:151],a[116:119],v[108:111]
v_fma_f32 v81,v81,s36,v14
v_fma_f32 v82,v82,s36,v14
v_fma_f32 v83,v83,s36,v14
v_fma_f32 v88,v88,s36,v15
v_fma_f32 v89,v89,s36,v15
v_exp_f32 v72,v72
v_exp_f32 v73,v73
v_exp_f32 v74,v74
v_exp_f32 v75,v75
v_exp_f32 v80,v80
v_exp_f32 v81,v81
v_exp_f32 v82,v82
v_exp_f32 v83,v83
v_exp_f32 v88,v88
v_exp_f32 v89,v89
v_cvt_pk_bf16_f32 v44,v72,v73
v_cvt_pk_bf16_f32 v45,v74,v75
v_cvt_pk_bf16_f32 v48,v80,v81
v_cvt_pk_bf16_f32 v49,v82,v83
v_cvt_pk_bf16_f32 v52,v88,v89
s_waitcnt lgkmcnt(0)
v_mfma_f32_16x16x32_bf16 v[160:163],a[120:123],v[20:23],0
s_add_u32 m0,s23,0
ds_read_b64_tr_b16 a[136:137],v2 offset:128
v_fma_f32 v90,v90,s36,v15
v_mfma_f32_16x16x32_bf16 v[164:167],a[124:127],v[20:23],0
ds_read_b64_tr_b16 a[138:139],v2 offset:6272
v_fma_f32 v91,v91,s36,v15
v_mfma_f32_16x16x32_bf16 v[212:215],a[124:127],v[24:27],0
ds_read_b64_tr_b16 a[140:141],v3 offset:128
v_fma_f32 v96,v96,s36,v16
v_mfma_f32_16x16x32_bf16 v[208:211],a[120:123],v[24:27],0
ds_read_b64_tr_b16 a[142:143],v3 offset:6272
v_fma_f32 v97,v97,s36,v16
v_mfma_f32_16x16x32_bf16 v[112:115],a[120:123],v[28:31],0
ds_read_b64_tr_b16 a[144:145],v4 offset:128
v_fma_f32 v98,v98,s36,v16
v_mfma_f32_16x16x32_bf16 v[116:119],a[124:127],v[28:31],0
ds_read_b64_tr_b16 a[146:147],v4 offset:6272
v_fma_f32 v99,v99,s36,v16
v_mfma_f32_16x16x32_bf16 a[164:167],a[124:127],v[32:35],0
ds_read_b64_tr_b16 a[148:149],v5 offset:128
v_fma_f32 v104,v104,s36,v17
v_mfma_f32_16x16x32_bf16 a[160:163],a[120:123],v[32:35],0
ds_read_b64_tr_b16 a[150:151],v5 offset:6272
v_fma_f32 v105,v105,s36,v17
v_mfma_f32_16x16x32_bf16 a[208:211],a[120:123],v[36:39],0
ds_read_b64_tr_b16 a[120:121],v2 offset:256
v_fma_f32 v106,v106,s36,v17
v_mfma_f32_16x16x32_bf16 a[212:215],a[124:127],v[36:39],0
ds_read_b64_tr_b16 a[122:123],v2 offset:6400
v_fma_f32 v107,v107,s36,v17
v_mfma_f32_16x16x32_bf16 a[216:219],a[128:131],v[36:39],0
ds_read_b64_tr_b16 a[124:125],v3 offset:256
v_fma_f32 v76,v76,s36,v13
v_mfma_f32_16x16x32_bf16 a[220:223],a[132:135],v[36:39],0
ds_read_b64_tr_b16 a[126:127],v3 offset:6400
v_fma_f32 v77,v77,s36,v13
v_mfma_f32_16x16x32_bf16 a[172:175],a[132:135],v[32:35],0
v_exp_f32 v90,v90
v_mfma_f32_16x16x32_bf16 a[168:171],a[128:131],v[32:35],0
v_exp_f32 v91,v91
v_mfma_f32_16x16x32_bf16 v[120:123],a[128:131],v[28:31],0
v_cvt_pk_bf16_f32 v53,v90,v91
v_fma_f32 v78,v78,s36,v13
v_mfma_f32_16x16x32_bf16 v[124:127],a[132:135],v[28:31],0
v_exp_f32 v96,v96
v_mfma_f32_16x16x32_bf16 v[220:223],a[132:135],v[24:27],0
v_exp_f32 v97,v97
v_mfma_f32_16x16x32_bf16 v[216:219],a[128:131],v[24:27],0
v_exp_f32 v98,v98
v_mfma_f32_16x16x32_bf16 v[168:171],a[128:131],v[20:23],0
ds_read_b64_tr_b16 a[128:129],v4 offset:256
v_cvt_pk_bf16_f32 v56,v96,v97
v_mfma_f32_16x16x32_bf16 v[172:175],a[132:135],v[20:23],0
s_waitcnt lgkmcnt(1)
ds_read_b64_tr_b16 a[130:131],v4 offset:6400
v_fma_f32 v79,v79,s36,v13
v_mfma_f32_16x16x32_bf16 v[176:179],a[136:139],v[20:23],0
ds_read_b64_tr_b16 a[132:133],v5 offset:256
v_fma_f32 v84,v84,s36,v14
v_mfma_f32_16x16x32_bf16 v[180:183],a[140:143],v[20:23],0
ds_read_b64_tr_b16 a[134:135],v5 offset:6400
v_fma_f32 v85,v85,s36,v14
v_mfma_f32_16x16x32_bf16 v[228:231],a[140:143],v[24:27],0
v_exp_f32 v99,v99
v_mfma_f32_16x16x32_bf16 v[224:227],a[136:139],v[24:27],0
v_cvt_pk_bf16_f32 v57,v98,v99
v_fma_f32 v86,v86,s36,v14
v_mfma_f32_16x16x32_bf16 v[128:131],a[136:139],v[28:31],0
v_exp_f32 v104,v104
v_mfma_f32_16x16x32_bf16 v[132:135],a[140:143],v[28:31],0
v_exp_f32 v105,v105
v_mfma_f32_16x16x32_bf16 a[180:183],a[140:143],v[32:35],0
v_exp_f32 v106,v106
v_mfma_f32_16x16x32_bf16 a[176:179],a[136:139],v[32:35],0
v_exp_f32 v107,v107
v_mfma_f32_16x16x32_bf16 a[224:227],a[136:139],v[36:39],0
v_cvt_pk_bf16_f32 v40,v104,v105
v_cvt_pk_bf16_f32 v41,v106,v107
v_mfma_f32_16x16x32_bf16 a[228:231],a[140:143],v[36:39],0
v_exp_f32 v76,v76
v_mfma_f32_16x16x32_bf16 a[232:235],a[144:147],v[36:39],0
v_exp_f32 v77,v77
v_mfma_f32_16x16x32_bf16 a[236:239],a[148:151],v[36:39],0
v_exp_f32 v78,v78
v_mfma_f32_16x16x32_bf16 a[188:191],a[148:151],v[32:35],0
v_exp_f32 v79,v79
v_mfma_f32_16x16x32_bf16 a[184:187],a[144:147],v[32:35],0
v_cvt_pk_bf16_f32 v46,v76,v77
v_cvt_pk_bf16_f32 v47,v78,v79
v_mfma_f32_16x16x32_bf16 v[136:139],a[144:147],v[28:31],0
v_fma_f32 v87,v87,s36,v14
v_fma_f32 v92,v92,s36,v15
v_mfma_f32_16x16x32_bf16 v[140:143],a[148:151],v[28:31],0
v_exp_f32 v84,v84
v_mfma_f32_16x16x32_bf16 v[236:239],a[148:151],v[24:27],0
v_exp_f32 v85,v85
v_mfma_f32_16x16x32_bf16 v[232:235],a[144:147],v[24:27],0
v_exp_f32 v86,v86
v_mfma_f32_16x16x32_bf16 v[184:187],a[144:147],v[20:23],0
v_exp_f32 v87,v87
v_mfma_f32_16x16x32_bf16 v[188:191],a[148:151],v[20:23],0
v_cvt_pk_bf16_f32 v50,v84,v85
v_cvt_pk_bf16_f32 v51,v86,v87
v_mfma_f32_16x16x32_bf16 v[192:195],a[120:123],v[20:23],0
v_fma_f32 v93,v93,s36,v15
v_fma_f32 v94,v94,s36,v15
v_smfmac_f32_16x16x64_bf16 v[60:63],a[152:155],v[44:51],v18
v_fma_f32 v95,v95,s36,v15
v_mfma_f32_16x16x32_bf16 v[196:199],a[124:127],v[20:23],0
s_waitcnt vmcnt(36) lgkmcnt(0)
v_exp_f32 v92,v92
v_mfma_f32_16x16x32_bf16 v[244:247],a[124:127],v[24:27],0
s_barrier
v_mfma_f32_16x16x32_bf16 v[240:243],a[120:123],v[24:27],0
ds_read_b128 a[136:139],v0 offset:24576
v_fma_f32 v100,v100,s36,v16
v_mfma_f32_16x16x32_bf16 v[144:147],a[120:123],v[28:31],0
ds_read_b128 a[140:143],v1 offset:24576
v_fma_f32 v101,v101,s36,v16
v_mfma_f32_16x16x32_bf16 v[148:151],a[124:127],v[28:31],0
ds_read_b128 a[144:147],v0 offset:24704
v_fma_f32 v102,v102,s36,v16
v_mfma_f32_16x16x32_bf16 a[196:199],a[124:127],v[32:35],0
ds_read_b128 a[148:151],v1 offset:24704
v_fma_f32 v103,v103,s36,v16
v_mfma_f32_16x16x32_bf16 a[192:195],a[120:123],v[32:35],0
v_exp_f32 v93,v93
v_mfma_f32_16x16x32_bf16 a[240:243],a[120:123],v[36:39],0
buffer_load_dwordx4 v6,s[8:11],s21 offen offset:0 lds
v_mfma_f32_16x16x32_bf16 a[244:247],a[124:127],v[36:39],0
ds_read_b128 a[120:123],v0 offset:24832
v_cvt_pk_bf16_f32 v54,v92,v93
v_mfma_f32_16x16x32_bf16 a[248:251],a[128:131],v[36:39],0
ds_read_b128 a[124:127],v1 offset:24832
v_fma_f32 v108,v108,s36,v17
v_mfma_f32_16x16x32_bf16 a[252:255],a[132:135],v[36:39],0
v_exp_f32 v94,v94
v_mfma_f32_16x16x32_bf16 a[204:207],a[132:135],v[32:35],0
v_exp_f32 v95,v95
v_mfma_f32_16x16x32_bf16 a[200:203],a[128:131],v[32:35],0
v_cvt_pk_bf16_f32 v55,v94,v95
v_fma_f32 v109,v109,s36,v17
v_mfma_f32_16x16x32_bf16 v[152:155],a[128:131],v[28:31],0
v_exp_f32 v100,v100
v_mfma_f32_16x16x32_bf16 v[156:159],a[132:135],v[28:31],0
v_exp_f32 v101,v101
v_mfma_f32_16x16x32_bf16 v[252:255],a[132:135],v[24:27],0
v_exp_f32 v102,v102
v_mfma_f32_16x16x32_bf16 v[248:251],a[128:131],v[24:27],0
v_exp_f32 v103,v103
v_mfma_f32_16x16x32_bf16 v[200:203],a[128:131],v[20:23],0
ds_read_b128 a[128:131],v0 offset:30720
v_cvt_pk_bf16_f32 v58,v100,v101
v_mfma_f32_16x16x32_bf16 v[204:207],a[132:135],v[20:23],0
buffer_load_dwordx4 v7,s[8:11],s21 offen offset:1024 lds
s_waitcnt lgkmcnt(1)
v_mfma_f32_16x16x32_bf16 v[72:75],a[136:139],a[0:3],0
ds_read_b128 a[132:135],v1 offset:30720
v_cvt_pk_bf16_f32 v59,v102,v103
v_mfma_f32_16x16x32_bf16 v[72:75],a[140:143],a[4:7],v[72:75]
v_fma_f32 v110,v110,s36,v17
v_fma_f32 v111,v111,s36,v17
v_smfmac_f32_16x16x64_bf16 v[64:67],a[152:155],v[52:59],v18
v_mfma_f32_16x16x32_bf16 v[72:75],a[144:147],a[8:11],v[72:75]
v_exp_f32 v108,v108
v_mfma_f32_16x16x32_bf16 v[72:75],a[148:151],a[12:15],v[72:75]
v_exp_f32 v109,v109
v_mfma_f32_16x16x32_bf16 v[72:75],a[120:123],a[16:19],v[72:75]
v_exp_f32 v110,v110
v_mfma_f32_16x16x32_bf16 v[72:75],a[124:127],a[20:23],v[72:75]
v_exp_f32 v111,v111
v_mfma_f32_16x16x32_bf16 v[80:83],a[124:127],a[44:47],0
v_cvt_pk_bf16_f32 v42,v108,v109
v_cvt_pk_bf16_f32 v43,v110,v111
v_mfma_f32_16x16x32_bf16 v[80:83],a[120:123],a[40:43],v[80:83]
v_mfma_f32_16x16x32_bf16 v[80:83],a[148:151],a[36:39],v[80:83]
v_smfmac_f32_16x16x64_bf16 v[68:71],a[152:155],v[36:43],v18
buffer_load_dwordx4 v8,s[8:11],s21 offen offset:2048 lds
v_mfma_f32_16x16x32_bf16 v[80:83],a[144:147],a[32:35],v[80:83]
s_add_u32 s21,s21,12288
v_fma_f32 v72,v72,s36,v13
v_fma_f32 v73,v73,s36,v13
v_mfma_f32_16x16x32_bf16 v[80:83],a[140:143],a[28:31],v[80:83]
s_add_u32 m0,s22,12288
v_fma_f32 v74,v74,s36,v13
v_fma_f32 v75,v75,s36,v13
v_mfma_f32_16x16x32_bf16 v[80:83],a[136:139],a[24:27],v[80:83]
v_exp_f32 v72,v72
v_mfma_f32_16x16x32_bf16 v[88:91],a[136:139],a[48:51],0
v_exp_f32 v73,v73
v_mfma_f32_16x16x32_bf16 v[88:91],a[140:143],a[52:55],v[88:91]
v_exp_f32 v74,v74
v_mfma_f32_16x16x32_bf16 v[88:91],a[144:147],a[56:59],v[88:91]
v_exp_f32 v75,v75
v_mfma_f32_16x16x32_bf16 v[88:91],a[148:151],a[60:63],v[88:91]
v_fma_f32 v80,v80,s36,v14
v_fma_f32 v81,v81,s36,v14
v_mfma_f32_16x16x32_bf16 v[88:91],a[120:123],a[64:67],v[88:91]
v_fma_f32 v82,v82,s36,v14
v_fma_f32 v83,v83,s36,v14
v_mfma_f32_16x16x32_bf16 v[88:91],a[124:127],a[68:71],v[88:91]
v_exp_f32 v80,v80
v_mfma_f32_16x16x32_bf16 v[96:99],a[124:127],a[92:95],0
v_exp_f32 v81,v81
v_mfma_f32_16x16x32_bf16 v[96:99],a[120:123],a[88:91],v[96:99]
buffer_load_dwordx4 v6,s[4:7],s20 offen offset:0 lds
v_mfma_f32_16x16x32_bf16 v[96:99],a[148:151],a[84:87],v[96:99]
v_exp_f32 v82,v82
v_mfma_f32_16x16x32_bf16 v[96:99],a[144:147],a[80:83],v[96:99]
v_fma_f32 v88,v88,s36,v15
v_fma_f32 v89,v89,s36,v15
v_mfma_f32_16x16x32_bf16 v[96:99],a[140:143],a[76:79],v[96:99]
v_exp_f32 v83,v83
v_mfma_f32_16x16x32_bf16 v[96:99],a[136:139],a[72:75],v[96:99]
v_exp_f32 v88,v88
v_mfma_f32_16x16x32_bf16 v[104:107],a[136:139],a[96:99],0
ds_read_b128 a[136:139],v0 offset:30848
v_cvt_pk_bf16_f32 v20,v72,v73
v_mfma_f32_16x16x32_bf16 v[104:107],a[140:143],a[100:103],v[104:107]
ds_read_b128 a[140:143],v1 offset:30848
v_cvt_pk_bf16_f32 v21,v74,v75
v_mfma_f32_16x16x32_bf16 v[104:107],a[144:147],a[104:107],v[104:107]
ds_read_b128 a[144:147],v0 offset:30976
v_cvt_pk_bf16_f32 v24,v80,v81
v_mfma_f32_16x16x32_bf16 v[104:107],a[148:151],a[108:111],v[104:107]
ds_read_b128 a[148:151],v1 offset:30976
v_cvt_pk_bf16_f32 v25,v82,v83
v_mfma_f32_16x16x32_bf16 v[104:107],a[120:123],a[112:115],v[104:107]
v_exp_f32 v89,v89
v_mfma_f32_16x16x32_bf16 v[104:107],a[124:127],a[116:119],v[104:107]
s_waitcnt lgkmcnt(4)
v_cvt_pk_bf16_f32 v28,v88,v89
v_mfma_f32_16x16x32_bf16 v[76:79],a[128:131],a[0:3],0
v_mfma_f32_16x16x32_bf16 v[76:79],a[132:135],a[4:7],v[76:79]
buffer_load_dwordx4 v7,s[4:7],s20 offen offset:1024 lds
s_waitcnt lgkmcnt(3)
v_mfma_f32_16x16x32_bf16 v[76:79],a[136:139],a[8:11],v[76:79]
s_waitcnt lgkmcnt(2)
v_mfma_f32_16x16x32_bf16 v[76:79],a[140:143],a[12:15],v[76:79]
s_waitcnt lgkmcnt(1)
v_mfma_f32_16x16x32_bf16 v[76:79],a[144:147],a[16:19],v[76:79]
s_waitcnt lgkmcnt(0)
v_mfma_f32_16x16x32_bf16 v[76:79],a[148:151],a[20:23],v[76:79]
v_mfma_f32_16x16x32_bf16 v[84:87],a[148:151],a[44:47],0
v_mfma_f32_16x16x32_bf16 v[84:87],a[144:147],a[40:43],v[84:87]
v_mfma_f32_16x16x32_bf16 v[84:87],a[140:143],a[36:39],v[84:87]
v_mfma_f32_16x16x32_bf16 v[84:87],a[136:139],a[32:35],v[84:87]
v_mfma_f32_16x16x32_bf16 v[84:87],a[132:135],a[28:31],v[84:87]
v_mfma_f32_16x16x32_bf16 v[84:87],a[128:131],a[24:27],v[84:87]
v_mfma_f32_16x16x32_bf16 v[92:95],a[128:131],a[48:51],0
buffer_load_dwordx4 v8,s[4:7],s20 offen offset:2048 lds
v_mfma_f32_16x16x32_bf16 v[92:95],a[132:135],a[52:55],v[92:95]
s_add_u32 s20,s20,12288
v_mfma_f32_16x16x32_bf16 v[92:95],a[136:139],a[56:59],v[92:95]
v_mfma_f32_16x16x32_bf16 v[92:95],a[140:143],a[60:63],v[92:95]
v_mfma_f32_16x16x32_bf16 v[92:95],a[144:147],a[64:67],v[92:95]
v_mfma_f32_16x16x32_bf16 v[92:95],a[148:151],a[68:71],v[92:95]
ds_read_b64_tr_b16 a[120:121],v2 offset:12288
v_mfma_f32_16x16x32_bf16 v[100:103],a[148:151],a[92:95],0
ds_read_b64_tr_b16 a[122:123],v2 offset:18432
v_mfma_f32_16x16x32_bf16 v[100:103],a[144:147],a[88:91],v[100:103]
v_mfma_f32_16x16x32_bf16 v[100:103],a[140:143],a[84:87],v[100:103]
ds_read_b64_tr_b16 a[124:125],v3 offset:12288
v_mfma_f32_16x16x32_bf16 v[100:103],a[136:139],a[80:83],v[100:103]
ds_read_b64_tr_b16 a[126:127],v3 offset:18432
v_mfma_f32_16x16x32_bf16 v[100:103],a[132:135],a[76:79],v[100:103]
v_mfma_f32_16x16x32_bf16 v[100:103],a[128:131],a[72:75],v[100:103]
v_mfma_f32_16x16x32_bf16 v[108:111],a[128:131],a[96:99],0
ds_read_b64_tr_b16 a[128:129],v4 offset:12288
v_mfma_f32_16x16x32_bf16 v[108:111],a[132:135],a[100:103],v[108:111]
ds_read_b64_tr_b16 a[130:131],v4 offset:18432
v_mfma_f32_16x16x32_bf16 v[108:111],a[136:139],a[104:107],v[108:111]
ds_read_b64_tr_b16 a[132:133],v5 offset:12288
v_mfma_f32_16x16x32_bf16 v[108:111],a[140:143],a[108:111],v[108:111]
ds_read_b64_tr_b16 a[134:135],v5 offset:18432
v_mfma_f32_16x16x32_bf16 v[108:111],a[144:147],a[112:115],v[108:111]
v_mfma_f32_16x16x32_bf16 v[108:111],a[148:151],a[116:119],v[108:111]
s_waitcnt lgkmcnt(4)
v_mfma_f32_16x16x32_bf16 v[160:163],a[120:123],v[44:47],v[160:163]
s_add_u32 m0,s23,12288
ds_read_b64_tr_b16 a[136:137],v2 offset:12416
v_fma_f32 v90,v90,s36,v15
v_mfma_f32_16x16x32_bf16 v[164:167],a[124:127],v[44:47],v[164:167]
ds_read_b64_tr_b16 a[138:139],v2 offset:18560
v_fma_f32 v91,v91,s36,v15
v_mfma_f32_16x16x32_bf16 v[212:215],a[124:127],v[48:51],v[212:215]
ds_read_b64_tr_b16 a[140:141],v3 offset:12416
v_fma_f32 v96,v96,s36,v16
v_mfma_f32_16x16x32_bf16 v[208:211],a[120:123],v[48:51],v[208:211]
ds_read_b64_tr_b16 a[142:143],v3 offset:18560
v_fma_f32 v97,v97,s36,v16
v_mfma_f32_16x16x32_bf16 v[112:115],a[120:123],v[52:55],v[112:115]
ds_read_b64_tr_b16 a[144:145],v4 offset:12416
v_fma_f32 v98,v98,s36,v16
v_mfma_f32_16x16x32_bf16 v[116:119],a[124:127],v[52:55],v[116:119]
ds_read_b64_tr_b16 a[146:147],v4 offset:18560
v_fma_f32 v99,v99,s36,v16
v_mfma_f32_16x16x32_bf16 a[164:167],a[124:127],v[56:59],a[164:167]
ds_read_b64_tr_b16 a[148:149],v5 offset:12416
v_fma_f32 v104,v104,s36,v17
v_mfma_f32_16x16x32_bf16 a[160:163],a[120:123],v[56:59],a[160:163]
ds_read_b64_tr_b16 a[150:151],v5 offset:18560
v_fma_f32 v105,v105,s36,v17
v_mfma_f32_16x16x32_bf16 a[208:211],a[120:123],v[40:43],a[208:211]
ds_read_b64_tr_b16 a[120:121],v2 offset:12544
v_fma_f32 v106,v106,s36,v17
v_mfma_f32_16x16x32_bf16 a[212:215],a[124:127],v[40:43],a[212:215]
s_waitcnt lgkmcnt(6)
ds_read_b64_tr_b16 a[122:123],v2 offset:18688
v_fma_f32 v107,v107,s36,v17
v_mfma_f32_16x16x32_bf16 a[216:219],a[128:131],v[40:43],a[216:219]
ds_read_b64_tr_b16 a[124:125],v3 offset:12544
v_fma_f32 v76,v76,s36,v13
v_mfma_f32_16x16x32_bf16 a[220:223],a[132:135],v[40:43],a[220:223]
ds_read_b64_tr_b16 a[126:127],v3 offset:18688
v_fma_f32 v77,v77,s36,v13
v_mfma_f32_16x16x32_bf16 a[172:175],a[132:135],v[56:59],a[172:175]
v_exp_f32 v90,v90
v_mfma_f32_16x16x32_bf16 a[168:171],a[128:131],v[56:59],a[168:171]
v_exp_f32 v91,v91
v_mfma_f32_16x16x32_bf16 v[120:123],a[128:131],v[52:55],v[120:123]
v_cvt_pk_bf16_f32 v29,v90,v91
v_fma_f32 v78,v78,s36,v13
v_mfma_f32_16x16x32_bf16 v[124:127],a[132:135],v[52:55],v[124:127]
v_exp_f32 v96,v96
v_mfma_f32_16x16x32_bf16 v[220:223],a[132:135],v[48:51],v[220:223]
v_exp_f32 v97,v97
v_mfma_f32_16x16x32_bf16 v[216:219],a[128:131],v[48:51],v[216:219]
v_exp_f32 v98,v98
v_mfma_f32_16x16x32_bf16 v[168:171],a[128:131],v[44:47],v[168:171]
ds_read_b64_tr_b16 a[128:129],v4 offset:12544
v_cvt_pk_bf16_f32 v32,v96,v97
v_mfma_f32_16x16x32_bf16 v[172:175],a[132:135],v[44:47],v[172:175]
ds_read_b64_tr_b16 a[130:131],v4 offset:18688
v_fma_f32 v79,v79,s36,v13
v_mfma_f32_16x16x32_bf16 v[176:179],a[136:139],v[44:47],v[176:179]
s_waitcnt lgkmcnt(2)
ds_read_b64_tr_b16 a[132:133],v5 offset:12544
v_fma_f32 v84,v84,s36,v14
v_mfma_f32_16x16x32_bf16 v[180:183],a[140:143],v[44:47],v[180:183]
ds_read_b64_tr_b16 a[134:135],v5 offset:18688
v_fma_f32 v85,v85,s36,v14
v_mfma_f32_16x16x32_bf16 v[228:231],a[140:143],v[48:51],v[228:231]
v_exp_f32 v99,v99
v_mfma_f32_16x16x32_bf16 v[224:227],a[136:139],v[48:51],v[224:227]
v_cvt_pk_bf16_f32 v33,v98,v99
v_fma_f32 v86,v86,s36,v14
v_mfma_f32_16x16x32_bf16 v[128:131],a[136:139],v[52:55],v[128:131]
v_exp_f32 v104,v104
v_mfma_f32_16x16x32_bf16 v[132:135],a[140:143],v[52:55],v[132:135]
v_exp_f32 v105,v105
v_mfma_f32_16x16x32_bf16 a[180:183],a[140:143],v[56:59],a[180:183]
v_exp_f32 v106,v106
v_mfma_f32_16x16x32_bf16 a[176:179],a[136:139],v[56:59],a[176:179]
v_exp_f32 v107,v107
v_mfma_f32_16x16x32_bf16 a[224:227],a[136:139],v[40:43],a[224:227]
v_cvt_pk_bf16_f32 v36,v104,v105
v_cvt_pk_bf16_f32 v37,v106,v107
v_mfma_f32_16x16x32_bf16 a[228:231],a[140:143],v[40:43],a[228:231]
v_exp_f32 v76,v76
v_mfma_f32_16x16x32_bf16 a[232:235],a[144:147],v[40:43],a[232:235]
v_exp_f32 v77,v77
v_mfma_f32_16x16x32_bf16 a[236:239],a[148:151],v[40:43],a[236:239]
v_exp_f32 v78,v78
v_mfma_f32_16x16x32_bf16 a[188:191],a[148:151],v[56:59],a[188:191]
v_exp_f32 v79,v79
v_mfma_f32_16x16x32_bf16 a[184:187],a[144:147],v[56:59],a[184:187]
v_cvt_pk_bf16_f32 v22,v76,v77
v_cvt_pk_bf16_f32 v23,v78,v79
v_mfma_f32_16x16x32_bf16 v[136:139],a[144:147],v[52:55],v[136:139]
v_fma_f32 v87,v87,s36,v14
v_fma_f32 v92,v92,s36,v15
v_mfma_f32_16x16x32_bf16 v[140:143],a[148:151],v[52:55],v[140:143]
v_exp_f32 v84,v84
v_mfma_f32_16x16x32_bf16 v[236:239],a[148:151],v[48:51],v[236:239]
v_exp_f32 v85,v85
v_mfma_f32_16x16x32_bf16 v[232:235],a[144:147],v[48:51],v[232:235]
v_exp_f32 v86,v86
v_mfma_f32_16x16x32_bf16 v[184:187],a[144:147],v[44:47],v[184:187]
v_exp_f32 v87,v87
v_mfma_f32_16x16x32_bf16 v[188:191],a[148:151],v[44:47],v[188:191]
v_cvt_pk_bf16_f32 v26,v84,v85
v_cvt_pk_bf16_f32 v27,v86,v87
v_mfma_f32_16x16x32_bf16 v[192:195],a[120:123],v[44:47],v[192:195]
v_fma_f32 v93,v93,s36,v15
v_fma_f32 v94,v94,s36,v15
v_smfmac_f32_16x16x64_bf16 v[60:63],a[152:155],v[20:27],v18
v_fma_f32 v95,v95,s36,v15
v_mfma_f32_16x16x32_bf16 v[196:199],a[124:127],v[44:47],v[196:199]
s_waitcnt vmcnt(6) lgkmcnt(0)
v_exp_f32 v92,v92
v_mfma_f32_16x16x32_bf16 v[244:247],a[124:127],v[48:51],v[244:247]
s_barrier
v_mfma_f32_16x16x32_bf16 v[240:243],a[120:123],v[48:51],v[240:243]
ds_read_b128 a[136:139],v0 offset:0
v_fma_f32 v100,v100,s36,v16
v_mfma_f32_16x16x32_bf16 v[144:147],a[120:123],v[52:55],v[144:147]
ds_read_b128 a[140:143],v1 offset:0
v_fma_f32 v101,v101,s36,v16
v_mfma_f32_16x16x32_bf16 v[148:151],a[124:127],v[52:55],v[148:151]
ds_read_b128 a[144:147],v0 offset:128
v_fma_f32 v102,v102,s36,v16
v_mfma_f32_16x16x32_bf16 a[196:199],a[124:127],v[56:59],a[196:199]
ds_read_b128 a[148:151],v1 offset:128
v_fma_f32 v103,v103,s36,v16
v_mfma_f32_16x16x32_bf16 a[192:195],a[120:123],v[56:59],a[192:195]
v_exp_f32 v93,v93
v_mfma_f32_16x16x32_bf16 a[240:243],a[120:123],v[40:43],a[240:243]
buffer_load_dwordx4 v6,s[8:11],s21 offen offset:0 lds
v_mfma_f32_16x16x32_bf16 a[244:247],a[124:127],v[40:43],a[244:247]
ds_read_b128 a[120:123],v0 offset:256
v_cvt_pk_bf16_f32 v30,v92,v93
v_mfma_f32_16x16x32_bf16 a[248:251],a[128:131],v[40:43],a[248:251]
ds_read_b128 a[124:127],v1 offset:256
v_fma_f32 v108,v108,s36,v17
v_mfma_f32_16x16x32_bf16 a[252:255],a[132:135],v[40:43],a[252:255]
v_exp_f32 v94,v94
v_mfma_f32_16x16x32_bf16 a[204:207],a[132:135],v[56:59],a[204:207]
v_exp_f32 v95,v95
v_mfma_f32_16x16x32_bf16 a[200:203],a[128:131],v[56:59],a[200:203]
v_cvt_pk_bf16_f32 v31,v94,v95
v_fma_f32 v109,v109,s36,v17
v_mfma_f32_16x16x32_bf16 v[152:155],a[128:131],v[52:55],v[152:155]
v_exp_f32 v100,v100
v_mfma_f32_16x16x32_bf16 v[156:159],a[132:135],v[52:55],v[156:159]
v_exp_f32 v101,v101
v_mfma_f32_16x16x32_bf16 v[252:255],a[132:135],v[48:51],v[252:255]
v_exp_f32 v102,v102
v_mfma_f32_16x16x32_bf16 v[248:251],a[128:131],v[48:51],v[248:251]
v_exp_f32 v103,v103
v_mfma_f32_16x16x32_bf16 v[200:203],a[128:131],v[44:47],v[200:203]
ds_read_b128 a[128:131],v0 offset:6144
v_cvt_pk_bf16_f32 v34,v100,v101
v_mfma_f32_16x16x32_bf16 v[204:207],a[132:135],v[44:47],v[204:207]
buffer_load_dwordx4 v7,s[8:11],s21 offen offset:1024 lds
s_waitcnt lgkmcnt(1)
v_mfma_f32_16x16x32_bf16 v[72:75],a[136:139],a[0:3],0
ds_read_b128 a[132:135],v1 offset:6144
v_cvt_pk_bf16_f32 v35,v102,v103
v_mfma_f32_16x16x32_bf16 v[72:75],a[140:143],a[4:7],v[72:75]
v_fma_f32 v110,v110,s36,v17
v_fma_f32 v111,v111,s36,v17
v_smfmac_f32_16x16x64_bf16 v[64:67],a[152:155],v[28:35],v18
v_mfma_f32_16x16x32_bf16 v[72:75],a[144:147],a[8:11],v[72:75]
v_exp_f32 v108,v108
v_mfma_f32_16x16x32_bf16 v[72:75],a[148:151],a[12:15],v[72:75]
v_exp_f32 v109,v109
v_mfma_f32_16x16x32_bf16 v[72:75],a[120:123],a[16:19],v[72:75]
v_exp_f32 v110,v110
v_mfma_f32_16x16x32_bf16 v[72:75],a[124:127],a[20:23],v[72:75]
v_exp_f32 v111,v111
v_mfma_f32_16x16x32_bf16 v[80:83],a[124:127],a[44:47],0
v_cvt_pk_bf16_f32 v38,v108,v109
v_cvt_pk_bf16_f32 v39,v110,v111
v_mfma_f32_16x16x32_bf16 v[80:83],a[120:123],a[40:43],v[80:83]
v_mfma_f32_16x16x32_bf16 v[80:83],a[148:151],a[36:39],v[80:83]
v_mfma_f32_16x16x32_bf16 v[80:83],a[144:147],a[32:35],v[80:83]
buffer_load_dwordx4 v8,s[8:11],s21 offen offset:2048 lds
v_mfma_f32_16x16x32_bf16 v[80:83],a[140:143],a[28:31],v[80:83]
s_add_u32 s21,s21,12288
v_fma_f32 v72,v72,s36,v13
v_fma_f32 v73,v73,s36,v13
v_mfma_f32_16x16x32_bf16 v[80:83],a[136:139],a[24:27],v[80:83]
s_add_u32 m0,s22,24576
v_fma_f32 v74,v74,s36,v13
v_fma_f32 v75,v75,s36,v13
v_mfma_f32_16x16x32_bf16 v[88:91],a[136:139],a[48:51],0
v_exp_f32 v72,v72
v_mfma_f32_16x16x32_bf16 v[88:91],a[140:143],a[52:55],v[88:91]
v_exp_f32 v73,v73
v_mfma_f32_16x16x32_bf16 v[88:91],a[144:147],a[56:59],v[88:91]
v_fma_f32 v80,v80,s36,v14
v_fma_f32 v81,v81,s36,v14
v_mfma_f32_16x16x32_bf16 v[88:91],a[148:151],a[60:63],v[88:91]
v_fma_f32 v82,v82,s36,v14
v_fma_f32 v83,v83,s36,v14
v_mfma_f32_16x16x32_bf16 v[88:91],a[120:123],a[64:67],v[88:91]
v_exp_f32 v74,v74
v_mfma_f32_16x16x32_bf16 v[88:91],a[124:127],a[68:71],v[88:91]
v_exp_f32 v75,v75
v_mfma_f32_16x16x32_bf16 v[96:99],a[124:127],a[92:95],0
v_exp_f32 v80,v80
v_mfma_f32_16x16x32_bf16 v[96:99],a[120:123],a[88:91],v[96:99]
v_exp_f32 v81,v81
v_mfma_f32_16x16x32_bf16 v[96:99],a[148:151],a[84:87],v[96:99]
v_exp_f32 v82,v82
v_mfma_f32_16x16x32_bf16 v[96:99],a[144:147],a[80:83],v[96:99]
buffer_load_dwordx4 v6,s[4:7],s20 offen offset:0 lds
v_mfma_f32_16x16x32_bf16 v[96:99],a[140:143],a[76:79],v[96:99]
v_fma_f32 v88,v88,s36,v15
v_fma_f32 v89,v89,s36,v15
v_mfma_f32_16x16x32_bf16 v[96:99],a[136:139],a[72:75],v[96:99]
v_exp_f32 v83,v83
v_mfma_f32_16x16x32_bf16 v[104:107],a[136:139],a[96:99],0
ds_read_b128 a[136:139],v0 offset:6272
v_cvt_pk_bf16_f32 v44,v72,v73
v_mfma_f32_16x16x32_bf16 v[104:107],a[140:143],a[100:103],v[104:107]
ds_read_b128 a[140:143],v1 offset:6272
v_cvt_pk_bf16_f32 v45,v74,v75
v_mfma_f32_16x16x32_bf16 v[104:107],a[144:147],a[104:107],v[104:107]
ds_read_b128 a[144:147],v0 offset:6400
v_cvt_pk_bf16_f32 v48,v80,v81
v_mfma_f32_16x16x32_bf16 v[104:107],a[148:151],a[108:111],v[104:107]
ds_read_b128 a[148:151],v1 offset:6400
v_cvt_pk_bf16_f32 v49,v82,v83
v_mfma_f32_16x16x32_bf16 v[104:107],a[120:123],a[112:115],v[104:107]
v_exp_f32 v88,v88
v_mfma_f32_16x16x32_bf16 v[104:107],a[124:127],a[116:119],v[104:107]
s_waitcnt lgkmcnt(4)
v_exp_f32 v89,v89
v_mfma_f32_16x16x32_bf16 v[76:79],a[128:131],a[0:3],0
v_cvt_pk_bf16_f32 v52,v88,v89
v_mfma_f32_16x16x32_bf16 v[76:79],a[132:135],a[4:7],v[76:79]
s_waitcnt lgkmcnt(3)
v_mfma_f32_16x16x32_bf16 v[76:79],a[136:139],a[8:11],v[76:79]
buffer_load_dwordx4 v7,s[4:7],s20 offen offset:1024 lds
s_waitcnt lgkmcnt(2)
v_mfma_f32_16x16x32_bf16 v[76:79],a[140:143],a[12:15],v[76:79]
s_waitcnt lgkmcnt(1)
v_mfma_f32_16x16x32_bf16 v[76:79],a[144:147],a[16:19],v[76:79]
s_waitcnt lgkmcnt(0)
v_mfma_f32_16x16x32_bf16 v[76:79],a[148:151],a[20:23],v[76:79]
v_mfma_f32_16x16x32_bf16 v[84:87],a[148:151],a[44:47],0
v_mfma_f32_16x16x32_bf16 v[84:87],a[144:147],a[40:43],v[84:87]
v_mfma_f32_16x16x32_bf16 v[84:87],a[140:143],a[36:39],v[84:87]
v_mfma_f32_16x16x32_bf16 v[84:87],a[136:139],a[32:35],v[84:87]
v_mfma_f32_16x16x32_bf16 v[84:87],a[132:135],a[28:31],v[84:87]
v_mfma_f32_16x16x32_bf16 v[84:87],a[128:131],a[24:27],v[84:87]
v_mfma_f32_16x16x32_bf16 v[92:95],a[128:131],a[48:51],0
v_mfma_f32_16x16x32_bf16 v[92:95],a[132:135],a[52:55],v[92:95]
buffer_load_dwordx4 v8,s[4:7],s20 offen offset:2048 lds
v_mfma_f32_16x16x32_bf16 v[92:95],a[136:139],a[56:59],v[92:95]
s_add_u32 s20,s20,12288
v_mfma_f32_16x16x32_bf16 v[92:95],a[140:143],a[60:63],v[92:95]
v_mfma_f32_16x16x32_bf16 v[92:95],a[144:147],a[64:67],v[92:95]
v_mfma_f32_16x16x32_bf16 v[92:95],a[148:151],a[68:71],v[92:95]
v_mfma_f32_16x16x32_bf16 v[100:103],a[148:151],a[92:95],0
v_mfma_f32_16x16x32_bf16 v[100:103],a[144:147],a[88:91],v[100:103]
ds_read_b64_tr_b16 a[120:121],v2 offset:24576
v_mfma_f32_16x16x32_bf16 v[100:103],a[140:143],a[84:87],v[100:103]
ds_read_b64_tr_b16 a[122:123],v2 offset:30720
v_mfma_f32_16x16x32_bf16 v[100:103],a[136:139],a[80:83],v[100:103]
ds_read_b64_tr_b16 a[124:125],v3 offset:24576
v_mfma_f32_16x16x32_bf16 v[100:103],a[132:135],a[76:79],v[100:103]
ds_read_b64_tr_b16 a[126:127],v3 offset:30720
v_mfma_f32_16x16x32_bf16 v[100:103],a[128:131],a[72:75],v[100:103]
v_mfma_f32_16x16x32_bf16 v[108:111],a[128:131],a[96:99],0
ds_read_b64_tr_b16 a[128:129],v4 offset:24576
v_mfma_f32_16x16x32_bf16 v[108:111],a[132:135],a[100:103],v[108:111]
ds_read_b64_tr_b16 a[130:131],v4 offset:30720
v_mfma_f32_16x16x32_bf16 v[108:111],a[136:139],a[104:107],v[108:111]
ds_read_b64_tr_b16 a[132:133],v5 offset:24576
v_mfma_f32_16x16x32_bf16 v[108:111],a[140:143],a[108:111],v[108:111]
ds_read_b64_tr_b16 a[134:135],v5 offset:30720
v_mfma_f32_16x16x32_bf16 v[108:111],a[144:147],a[112:115],v[108:111]
v_mfma_f32_16x16x32_bf16 v[108:111],a[148:151],a[116:119],v[108:111]
s_mov_b32 s38,0
s_branch L_loop5
L_loop4:
.p2align 6
L_loop4w0:
s_waitcnt lgkmcnt(3)
v_mfma_f32_16x16x32_bf16 v[160:163],a[120:123],v[20:23],v[160:163]
s_add_u32 m0,s23,24576
ds_read_b64_tr_b16 a[142:143],v3 offset:30848
v_fma_f32 v83,v83,s36,v14
v_mfma_f32_16x16x32_bf16 v[164:167],a[124:127],v[20:23],v[164:167]
ds_read_b64_tr_b16 a[138:139],v2 offset:30848
v_fma_f32 v82,v82,s36,v14
v_mfma_f32_16x16x32_bf16 v[212:215],a[124:127],v[24:27],v[212:215]
ds_read_b64_tr_b16 a[136:137],v2 offset:24704
v_fma_f32 v88,v88,s36,v15
v_mfma_f32_16x16x32_bf16 v[208:211],a[120:123],v[24:27],v[208:211]
ds_read_b64_tr_b16 a[140:141],v3 offset:24704
v_fma_f32 v91,v91,s36,v15
v_mfma_f32_16x16x32_bf16 v[112:115],a[120:123],v[28:31],v[112:115]
ds_read_b64_tr_b16 a[146:147],v4 offset:30848
v_fma_f32 v89,v89,s36,v15
v_mfma_f32_16x16x32_bf16 v[116:119],a[124:127],v[28:31],v[116:119]
ds_read_b64_tr_b16 a[150:151],v5 offset:30848
v_fma_f32 v90,v90,s36,v15
v_mfma_f32_16x16x32_bf16 a[164:167],a[124:127],v[32:35],a[164:167]
ds_read_b64_tr_b16 a[144:145],v4 offset:24704
v_fma_f32 v96,v96,s36,v16
v_mfma_f32_16x16x32_bf16 a[160:163],a[120:123],v[32:35],a[160:163]
s_waitcnt lgkmcnt(6)
ds_read_b64_tr_b16 a[148:149],v5 offset:24704
v_fma_f32 v98,v98,s36,v16
v_mfma_f32_16x16x32_bf16 a[168:171],a[128:131],v[32:35],a[168:171]
ds_read_b64_tr_b16 a[120:121],v2 offset:24832
v_fma_f32 v99,v99,s36,v16
v_mfma_f32_16x16x32_bf16 a[172:175],a[132:135],v[32:35],a[172:175]
ds_read_b64_tr_b16 a[126:127],v3 offset:30976
v_fma_f32 v97,v97,s36,v16
v_mfma_f32_16x16x32_bf16 v[124:127],a[132:135],v[28:31],v[124:127]
ds_read_b64_tr_b16 a[122:123],v2 offset:30976
v_fma_f32 v79,v79,s36,v13
v_mfma_f32_16x16x32_bf16 v[120:123],a[128:131],v[28:31],v[120:123]
ds_read_b64_tr_b16 a[124:125],v3 offset:24832
v_fma_f32 v77,v77,s36,v13
v_mfma_f32_16x16x32_bf16 v[216:219],a[128:131],v[24:27],v[216:219]
v_exp_f32 v82,v82
v_mfma_f32_16x16x32_bf16 v[220:223],a[132:135],v[24:27],v[220:223]
v_exp_f32 v83,v83
v_mfma_f32_16x16x32_bf16 v[172:175],a[132:135],v[20:23],v[172:175]
ds_read_b64_tr_b16 a[132:133],v5 offset:24832
v_cvt_pk_bf16_f32 v49,v82,v83
v_mfma_f32_16x16x32_bf16 v[168:171],a[128:131],v[20:23],v[168:171]
s_waitcnt lgkmcnt(4)
ds_read_b64_tr_b16 a[134:135],v5 offset:30976
v_fma_f32 v76,v76,s36,v13
v_mfma_f32_16x16x32_bf16 v[176:179],a[136:139],v[20:23],v[176:179]
ds_read_b64_tr_b16 a[128:129],v4 offset:24832
v_fma_f32 v78,v78,s36,v13
v_mfma_f32_16x16x32_bf16 v[180:183],a[140:143],v[20:23],v[180:183]
ds_read_b64_tr_b16 a[130:131],v4 offset:30976
v_fma_f32 v86,v86,s36,v14
v_mfma_f32_16x16x32_bf16 v[228:231],a[140:143],v[24:27],v[228:231]
v_exp_f32 v90,v90
v_mfma_f32_16x16x32_bf16 v[224:227],a[136:139],v[24:27],v[224:227]
v_exp_f32 v88,v88
v_mfma_f32_16x16x32_bf16 v[128:131],a[136:139],v[28:31],v[128:131]
v_exp_f32 v89,v89
v_mfma_f32_16x16x32_bf16 v[132:135],a[140:143],v[28:31],v[132:135]
v_cvt_pk_bf16_f32 v52,v88,v89
v_fma_f32 v84,v84,s36,v14
v_mfma_f32_16x16x32_bf16 a[180:183],a[140:143],v[32:35],a[180:183]
v_exp_f32 v91,v91
v_mfma_f32_16x16x32_bf16 a[176:179],a[136:139],v[32:35],a[176:179]
v_cvt_pk_bf16_f32 v53,v90,v91
v_fma_f32 v85,v85,s36,v14
v_mfma_f32_16x16x32_bf16 a[184:187],a[144:147],v[32:35],a[184:187]
v_exp_f32 v99,v99
v_mfma_f32_16x16x32_bf16 a[188:191],a[148:151],v[32:35],a[188:191]
v_exp_f32 v97,v97
v_mfma_f32_16x16x32_bf16 v[140:143],a[148:151],v[28:31],v[140:143]
v_exp_f32 v96,v96
v_mfma_f32_16x16x32_bf16 v[136:139],a[144:147],v[28:31],v[136:139]
v_cvt_pk_bf16_f32 v56,v96,v97
v_fma_f32 v87,v87,s36,v14
v_mfma_f32_16x16x32_bf16 v[232:235],a[144:147],v[24:27],v[232:235]
v_exp_f32 v98,v98
v_mfma_f32_16x16x32_bf16 v[236:239],a[148:151],v[24:27],v[236:239]
v_cvt_pk_bf16_f32 v57,v98,v99
v_fma_f32 v94,v94,s36,v15
v_mfma_f32_16x16x32_bf16 v[188:191],a[148:151],v[20:23],v[188:191]
v_exp_f32 v76,v76
v_mfma_f32_16x16x32_bf16 v[184:187],a[144:147],v[20:23],v[184:187]
s_waitcnt lgkmcnt(0)
v_exp_f32 v79,v79
v_mfma_f32_16x16x32_bf16 v[192:195],a[120:123],v[20:23],v[192:195]
v_exp_f32 v78,v78
v_mfma_f32_16x16x32_bf16 v[196:199],a[124:127],v[20:23],v[196:199]
s_waitcnt vmcnt(6)
ds_read_b128 a[156:159],v10 offset:0
v_cvt_pk_bf16_f32 v47,v78,v79
v_mfma_f32_16x16x32_bf16 v[244:247],a[124:127],v[24:27],v[244:247]
s_barrier
v_mfma_f32_16x16x32_bf16 v[240:243],a[120:123],v[24:27],v[240:243]
ds_read_b128 a[148:151],v1 offset:12416
v_fma_f32 v92,v92,s36,v15
v_mfma_f32_16x16x32_bf16 v[144:147],a[120:123],v[28:31],v[144:147]
ds_read_b128 a[144:147],v0 offset:12416
v_fma_f32 v93,v93,s36,v15
v_mfma_f32_16x16x32_bf16 v[148:151],a[124:127],v[28:31],v[148:151]
ds_read_b128 a[140:143],v1 offset:12288
v_fma_f32 v95,v95,s36,v15
v_mfma_f32_16x16x32_bf16 a[196:199],a[124:127],v[32:35],a[196:199]
ds_read_b128 a[124:127],v1 offset:12544
v_fma_f32 v102,v102,s36,v16
v_mfma_f32_16x16x32_bf16 a[192:195],a[120:123],v[32:35],a[192:195]
ds_read_b128 a[120:123],v0 offset:12544
v_fma_f32 v100,v100,s36,v16
v_mfma_f32_16x16x32_bf16 a[200:203],a[128:131],v[32:35],a[200:203]
buffer_load_dwordx4 v6,s[8:11],s21 offen offset:0 lds
v_mfma_f32_16x16x32_bf16 a[204:207],a[132:135],v[32:35],a[204:207]
ds_read_b128 a[136:139],v0 offset:12288
v_fma_f32 v101,v101,s36,v16
v_mfma_f32_16x16x32_bf16 v[156:159],a[132:135],v[28:31],v[156:159]
v_exp_f32 v77,v77
v_mfma_f32_16x16x32_bf16 v[152:155],a[128:131],v[28:31],v[152:155]
v_cvt_pk_bf16_f32 v46,v76,v77
v_fma_f32 v103,v103,s36,v16
v_mfma_f32_16x16x32_bf16 v[248:251],a[128:131],v[24:27],v[248:251]
v_exp_f32 v86,v86
v_mfma_f32_16x16x32_bf16 v[252:255],a[132:135],v[24:27],v[252:255]
v_exp_f32 v87,v87
v_mfma_f32_16x16x32_bf16 v[204:207],a[132:135],v[20:23],v[204:207]
ds_read_b128 a[132:135],v1 offset:18432
v_cvt_pk_bf16_f32 v51,v86,v87
v_mfma_f32_16x16x32_bf16 v[200:203],a[128:131],v[20:23],v[200:203]
s_waitcnt lgkmcnt(2)
ds_read_b128 a[128:131],v0 offset:18432
v_mfma_f32_16x16x32_bf16 v[72:75],a[124:127],a[20:23],0
v_exp_f32 v85,v85
v_mfma_f32_16x16x32_bf16 v[72:75],a[120:123],a[16:19],v[72:75]
buffer_store_dwordx4 a[156:159],v9,s[16:19],s27 offen offset:0 nt
buffer_load_dwordx4 v7,s[8:11],s21 offen offset:1024 lds
v_mfma_f32_16x16x32_bf16 v[72:75],a[148:151],a[12:15],v[72:75]
ds_read_b128 a[156:159],v10 offset:1024
v_mfma_f32_16x16x32_bf16 v[72:75],a[144:147],a[8:11],v[72:75]
v_exp_f32 v84,v84
v_mfma_f32_16x16x32_bf16 v[72:75],a[140:143],a[4:7],v[72:75]
s_waitcnt lgkmcnt(3)
v_cvt_pk_bf16_f32 v50,v84,v85
v_mfma_f32_16x16x32_bf16 v[72:75],a[136:139],a[0:3],v[72:75]
v_exp_f32 v93,v93
v_smfmac_f32_16x16x64_bf16 v[60:63],a[152:155],v[44:51],v18
v_mfma_f32_16x16x32_bf16 v[80:83],a[136:139],a[24:27],0
v_exp_f32 v94,v94
v_mfma_f32_16x16x32_bf16 v[80:83],a[140:143],a[28:31],v[80:83]
v_exp_f32 v92,v92
v_mfma_f32_16x16x32_bf16 v[80:83],a[144:147],a[32:35],v[80:83]
buffer_load_dwordx4 v8,s[8:11],s21 offen offset:2048 lds
v_mfma_f32_16x16x32_bf16 v[80:83],a[148:151],a[36:39],v[80:83]
s_add_u32 s21,s21,12288
v_cvt_pk_bf16_f32 v54,v92,v93
v_fma_f32 v72,v72,s36,v13
v_mfma_f32_16x16x32_bf16 v[80:83],a[120:123],a[40:43],v[80:83]
s_add_u32 m0,s22,0
v_exp_f32 v95,v95
v_mfma_f32_16x16x32_bf16 v[80:83],a[124:127],a[44:47],v[80:83]
v_cvt_pk_bf16_f32 v55,v94,v95
v_fma_f32 v75,v75,s36,v13
v_mfma_f32_16x16x32_bf16 v[88:91],a[124:127],a[68:71],0
v_exp_f32 v103,v103
v_mfma_f32_16x16x32_bf16 v[88:91],a[120:123],a[64:67],v[88:91]
v_exp_f32 v100,v100
v_mfma_f32_16x16x32_bf16 v[88:91],a[148:151],a[60:63],v[88:91]
v_exp_f32 v102,v102
v_mfma_f32_16x16x32_bf16 v[88:91],a[144:147],a[56:59],v[88:91]
v_cvt_pk_bf16_f32 v59,v102,v103
v_fma_f32 v80,v80,s36,v14
v_mfma_f32_16x16x32_bf16 v[88:91],a[140:143],a[52:55],v[88:91]
v_exp_f32 v101,v101
v_mfma_f32_16x16x32_bf16 v[88:91],a[136:139],a[48:51],v[88:91]
s_waitcnt lgkmcnt(0)
buffer_store_dwordx4 a[156:159],v9,s[16:19],s27 offen offset:128 nt
buffer_load_dwordx4 v6,s[4:7],s20 offen offset:0 lds
v_mfma_f32_16x16x32_bf16 v[96:99],a[136:139],a[72:75],0
ds_read_b128 a[156:159],v10 offset:2048
v_cvt_pk_bf16_f32 v58,v100,v101
v_mfma_f32_16x16x32_bf16 v[96:99],a[140:143],a[76:79],v[96:99]
ds_read_b128 a[136:139],v0 offset:18560
v_fma_f32 v81,v81,s36,v14
v_smfmac_f32_16x16x64_bf16 v[64:67],a[152:155],v[52:59],v18
ds_read_b128 a[140:143],v1 offset:18560
v_mfma_f32_16x16x32_bf16 v[96:99],a[144:147],a[80:83],v[96:99]
ds_read_b128 a[144:147],v0 offset:18688
v_mfma_f32_16x16x32_bf16 v[96:99],a[148:151],a[84:87],v[96:99]
ds_read_b128 a[148:151],v1 offset:18688
v_mfma_f32_16x16x32_bf16 v[96:99],a[120:123],a[88:91],v[96:99]
v_fma_f32 v73,v73,s36,v13
v_fma_f32 v74,v74,s36,v13
v_mfma_f32_16x16x32_bf16 v[96:99],a[124:127],a[92:95],v[96:99]
v_exp_f32 v74,v74
v_mfma_f32_16x16x32_bf16 v[76:79],a[128:131],a[0:3],0
buffer_load_dwordx4 v7,s[4:7],s20 offen offset:1024 lds
v_mfma_f32_16x16x32_bf16 v[76:79],a[132:135],a[4:7],v[76:79]
s_waitcnt lgkmcnt(3)
v_exp_f32 v75,v75
v_mfma_f32_16x16x32_bf16 v[76:79],a[136:139],a[8:11],v[76:79]
s_waitcnt lgkmcnt(2)
v_cvt_pk_bf16_f32 v21,v74,v75
v_mfma_f32_16x16x32_bf16 v[76:79],a[140:143],a[12:15],v[76:79]
s_waitcnt lgkmcnt(1)
v_exp_f32 v73,v73
v_mfma_f32_16x16x32_bf16 v[76:79],a[144:147],a[16:19],v[76:79]
s_waitcnt lgkmcnt(0)
v_exp_f32 v80,v80
v_mfma_f32_16x16x32_bf16 v[76:79],a[148:151],a[20:23],v[76:79]
v_exp_f32 v81,v81
v_mfma_f32_16x16x32_bf16 v[84:87],a[148:151],a[44:47],0
v_cvt_pk_bf16_f32 v24,v80,v81
v_mfma_f32_16x16x32_bf16 v[84:87],a[144:147],a[40:43],v[84:87]
v_exp_f32 v72,v72
v_mfma_f32_16x16x32_bf16 v[84:87],a[140:143],a[36:39],v[84:87]
v_cvt_pk_bf16_f32 v20,v72,v73
v_mfma_f32_16x16x32_bf16 v[84:87],a[136:139],a[32:35],v[84:87]
buffer_store_dwordx4 a[156:159],v9,s[16:19],s27 offen offset:256 nt
buffer_load_dwordx4 v8,s[4:7],s20 offen offset:2048 lds
v_mfma_f32_16x16x32_bf16 v[84:87],a[132:135],a[28:31],v[84:87]
s_add_u32 s20,s20,12288
ds_read_b64_tr_b16 a[122:123],v2 offset:6144
v_mfma_f32_16x16x32_bf16 v[84:87],a[128:131],a[24:27],v[84:87]
s_add_u32 s27,s27,3072
ds_read_b64_tr_b16 a[120:121],v2 offset:0
v_mfma_f32_16x16x32_bf16 v[92:95],a[128:131],a[48:51],0
ds_read_b64_tr_b16 a[124:125],v3 offset:0
v_mfma_f32_16x16x32_bf16 v[92:95],a[132:135],a[52:55],v[92:95]
ds_read_b64_tr_b16 a[126:127],v3 offset:6144
v_mfma_f32_16x16x32_bf16 v[92:95],a[136:139],a[56:59],v[92:95]
v_mfma_f32_16x16x32_bf16 v[92:95],a[140:143],a[60:63],v[92:95]
v_mfma_f32_16x16x32_bf16 v[92:95],a[144:147],a[64:67],v[92:95]
v_mfma_f32_16x16x32_bf16 v[92:95],a[148:151],a[68:71],v[92:95]
v_mfma_f32_16x16x32_bf16 v[100:103],a[148:151],a[92:95],0
v_mfma_f32_16x16x32_bf16 v[100:103],a[144:147],a[88:91],v[100:103]
v_mfma_f32_16x16x32_bf16 v[100:103],a[140:143],a[84:87],v[100:103]
v_mfma_f32_16x16x32_bf16 v[100:103],a[136:139],a[80:83],v[100:103]
v_mfma_f32_16x16x32_bf16 v[100:103],a[132:135],a[76:79],v[100:103]
ds_read_b64_tr_b16 a[134:135],v5 offset:6144
v_mfma_f32_16x16x32_bf16 v[100:103],a[128:131],a[72:75],v[100:103]
s_waitcnt lgkmcnt(1)
ds_read_b64_tr_b16 a[128:129],v4 offset:0
ds_read_b64_tr_b16 a[130:131],v4 offset:6144
ds_read_b64_tr_b16 a[132:133],v5 offset:0
v_mfma_f32_16x16x32_bf16 v[160:163],a[120:123],v[44:47],v[160:163]
s_add_u32 m0,s29,0
ds_read_b64_tr_b16 a[136:137],v2 offset:128
v_fma_f32 v82,v82,s36,v14
v_mfma_f32_16x16x32_bf16 v[164:167],a[124:127],v[44:47],v[164:167]
ds_read_b64_tr_b16 a[138:139],v2 offset:6272
v_fma_f32 v83,v83,s36,v14
v_mfma_f32_16x16x32_bf16 v[212:215],a[124:127],v[48:51],v[212:215]
ds_read_b64_tr_b16 a[140:141],v3 offset:128
v_fma_f32 v88,v88,s36,v15
v_mfma_f32_16x16x32_bf16 v[208:211],a[120:123],v[48:51],v[208:211]
ds_read_b64_tr_b16 a[142:143],v3 offset:6272
v_fma_f32 v89,v89,s36,v15
v_mfma_f32_16x16x32_bf16 v[112:115],a[120:123],v[52:55],v[112:115]
ds_read_b64_tr_b16 a[144:145],v4 offset:128
v_fma_f32 v90,v90,s36,v15
v_mfma_f32_16x16x32_bf16 v[116:119],a[124:127],v[52:55],v[116:119]
ds_read_b64_tr_b16 a[146:147],v4 offset:6272
v_fma_f32 v91,v91,s36,v15
v_mfma_f32_16x16x32_bf16 a[164:167],a[124:127],v[56:59],a[164:167]
buffer_load_dwordx4 v6,s[12:15],s28 offen offset:0 nt lds
v_mfma_f32_16x16x32_bf16 a[160:163],a[120:123],v[56:59],a[160:163]
s_waitcnt lgkmcnt(5)
ds_read_b64_tr_b16 a[148:149],v5 offset:128
v_fma_f32 v96,v96,s36,v16
v_mfma_f32_16x16x32_bf16 a[168:171],a[128:131],v[56:59],a[168:171]
ds_read_b64_tr_b16 a[150:151],v5 offset:6272
v_fma_f32 v97,v97,s36,v16
v_mfma_f32_16x16x32_bf16 a[172:175],a[132:135],v[56:59],a[172:175]
ds_read_b64_tr_b16 a[120:121],v2 offset:256
v_fma_f32 v98,v98,s36,v16
v_mfma_f32_16x16x32_bf16 v[124:127],a[132:135],v[52:55],v[124:127]
ds_read_b64_tr_b16 a[122:123],v2 offset:6400
v_fma_f32 v99,v99,s36,v16
v_mfma_f32_16x16x32_bf16 v[120:123],a[128:131],v[52:55],v[120:123]
ds_read_b64_tr_b16 a[124:125],v3 offset:256
v_fma_f32 v76,v76,s36,v13
v_mfma_f32_16x16x32_bf16 v[216:219],a[128:131],v[48:51],v[216:219]
ds_read_b64_tr_b16 a[126:127],v3 offset:6400
v_fma_f32 v77,v77,s36,v13
v_mfma_f32_16x16x32_bf16 v[220:223],a[132:135],v[48:51],v[220:223]
buffer_load_dwordx4 v7,s[12:15],s28 offen offset:1024 nt lds
v_mfma_f32_16x16x32_bf16 v[172:175],a[132:135],v[44:47],v[172:175]
ds_read_b64_tr_b16 a[132:133],v5 offset:256
v_fma_f32 v78,v78,s36,v13
v_mfma_f32_16x16x32_bf16 v[168:171],a[128:131],v[44:47],v[168:171]
s_waitcnt lgkmcnt(5)
ds_read_b64_tr_b16 a[128:129],v4 offset:256
v_fma_f32 v79,v79,s36,v13
v_mfma_f32_16x16x32_bf16 v[176:179],a[136:139],v[44:47],v[176:179]
ds_read_b64_tr_b16 a[130:131],v4 offset:6400
v_fma_f32 v84,v84,s36,v14
v_mfma_f32_16x16x32_bf16 v[180:183],a[140:143],v[44:47],v[180:183]
ds_read_b64_tr_b16 a[134:135],v5 offset:6400
v_fma_f32 v85,v85,s36,v14
v_mfma_f32_16x16x32_bf16 v[228:231],a[140:143],v[48:51],v[228:231]
v_exp_f32 v82,v82
v_mfma_f32_16x16x32_bf16 v[224:227],a[136:139],v[48:51],v[224:227]
v_exp_f32 v83,v83
v_mfma_f32_16x16x32_bf16 v[128:131],a[136:139],v[52:55],v[128:131]
v_cvt_pk_bf16_f32 v25,v82,v83
v_fma_f32 v86,v86,s36,v14
v_mfma_f32_16x16x32_bf16 v[132:135],a[140:143],v[52:55],v[132:135]
buffer_load_dwordx4 v8,s[12:15],s28 offen offset:2048 nt lds
v_mfma_f32_16x16x32_bf16 a[180:183],a[140:143],v[56:59],a[180:183]
s_add_u32 s28,s28,3072
v_exp_f32 v88,v88
v_mfma_f32_16x16x32_bf16 a[176:179],a[136:139],v[56:59],a[176:179]
s_add_u32 s29,s29,3072
v_exp_f32 v89,v89
v_mfma_f32_16x16x32_bf16 a[184:187],a[144:147],v[56:59],a[184:187]
s_add_u32 m0,s23,0
v_exp_f32 v90,v90
v_mfma_f32_16x16x32_bf16 a[188:191],a[148:151],v[56:59],a[188:191]
v_exp_f32 v91,v91
v_mfma_f32_16x16x32_bf16 v[140:143],a[148:151],v[52:55],v[140:143]
v_cvt_pk_bf16_f32 v28,v88,v89
v_cvt_pk_bf16_f32 v29,v90,v91
v_mfma_f32_16x16x32_bf16 v[136:139],a[144:147],v[52:55],v[136:139]
v_exp_f32 v96,v96
v_mfma_f32_16x16x32_bf16 v[232:235],a[144:147],v[48:51],v[232:235]
v_exp_f32 v97,v97
v_mfma_f32_16x16x32_bf16 v[236:239],a[148:151],v[48:51],v[236:239]
v_exp_f32 v98,v98
v_mfma_f32_16x16x32_bf16 v[188:191],a[148:151],v[44:47],v[188:191]
v_exp_f32 v99,v99
v_mfma_f32_16x16x32_bf16 v[184:187],a[144:147],v[44:47],v[184:187]
s_waitcnt lgkmcnt(0)
v_cvt_pk_bf16_f32 v32,v96,v97
v_cvt_pk_bf16_f32 v33,v98,v99
v_mfma_f32_16x16x32_bf16 v[192:195],a[120:123],v[44:47],v[192:195]
s_waitcnt vmcnt(12)
v_exp_f32 v76,v76
v_mfma_f32_16x16x32_bf16 v[196:199],a[124:127],v[44:47],v[196:199]
s_barrier
v_mfma_f32_16x16x32_bf16 v[244:247],a[124:127],v[48:51],v[244:247]
ds_read_b128 a[148:151],v1 offset:24704
v_fma_f32 v87,v87,s36,v14
v_mfma_f32_16x16x32_bf16 v[240:243],a[120:123],v[48:51],v[240:243]
ds_read_b128 a[144:147],v0 offset:24704
v_fma_f32 v92,v92,s36,v15
v_mfma_f32_16x16x32_bf16 v[144:147],a[120:123],v[52:55],v[144:147]
ds_read_b128 a[140:143],v1 offset:24576
v_fma_f32 v93,v93,s36,v15
v_mfma_f32_16x16x32_bf16 v[148:151],a[124:127],v[52:55],v[148:151]
ds_read_b128 a[136:139],v0 offset:24576
v_fma_f32 v94,v94,s36,v15
v_mfma_f32_16x16x32_bf16 a[196:199],a[124:127],v[56:59],a[196:199]
ds_read_b128 a[124:127],v1 offset:24832
v_fma_f32 v95,v95,s36,v15
v_mfma_f32_16x16x32_bf16 a[192:195],a[120:123],v[56:59],a[192:195]
buffer_load_dwordx4 v6,s[8:11],s21 offen offset:0 lds
v_mfma_f32_16x16x32_bf16 a[200:203],a[128:131],v[56:59],a[200:203]
ds_read_b128 a[120:123],v0 offset:24832
v_fma_f32 v100,v100,s36,v16
v_mfma_f32_16x16x32_bf16 a[204:207],a[132:135],v[56:59],a[204:207]
v_exp_f32 v77,v77
v_mfma_f32_16x16x32_bf16 v[156:159],a[132:135],v[52:55],v[156:159]
v_exp_f32 v78,v78
v_mfma_f32_16x16x32_bf16 v[152:155],a[128:131],v[52:55],v[152:155]
v_exp_f32 v79,v79
v_mfma_f32_16x16x32_bf16 v[248:251],a[128:131],v[48:51],v[248:251]
v_cvt_pk_bf16_f32 v22,v76,v77
v_cvt_pk_bf16_f32 v23,v78,v79
v_mfma_f32_16x16x32_bf16 v[252:255],a[132:135],v[48:51],v[252:255]
v_exp_f32 v84,v84
v_mfma_f32_16x16x32_bf16 v[204:207],a[132:135],v[44:47],v[204:207]
ds_read_b128 a[132:135],v1 offset:30720
v_fma_f32 v101,v101,s36,v16
v_mfma_f32_16x16x32_bf16 v[200:203],a[128:131],v[44:47],v[200:203]
s_waitcnt lgkmcnt(1)
ds_read_b128 a[128:131],v0 offset:30720
v_fma_f32 v102,v102,s36,v16
v_mfma_f32_16x16x32_bf16 v[72:75],a[124:127],a[20:23],0
buffer_load_dwordx4 v7,s[8:11],s21 offen offset:1024 lds
v_mfma_f32_16x16x32_bf16 v[72:75],a[120:123],a[16:19],v[72:75]
v_exp_f32 v85,v85
v_mfma_f32_16x16x32_bf16 v[72:75],a[148:151],a[12:15],v[72:75]
v_exp_f32 v86,v86
v_mfma_f32_16x16x32_bf16 v[72:75],a[144:147],a[8:11],v[72:75]
v_exp_f32 v87,v87
v_mfma_f32_16x16x32_bf16 v[72:75],a[140:143],a[4:7],v[72:75]
v_cvt_pk_bf16_f32 v26,v84,v85
v_cvt_pk_bf16_f32 v27,v86,v87
v_mfma_f32_16x16x32_bf16 v[72:75],a[136:139],a[0:3],v[72:75]
v_exp_f32 v92,v92
v_smfmac_f32_16x16x64_bf16 v[60:63],a[152:155],v[20:27],v18
v_fma_f32 v103,v103,s36,v16
v_mfma_f32_16x16x32_bf16 v[80:83],a[136:139],a[24:27],0
v_exp_f32 v93,v93
v_mfma_f32_16x16x32_bf16 v[80:83],a[140:143],a[28:31],v[80:83]
buffer_load_dwordx4 v8,s[8:11],s21 offen offset:2048 lds
v_mfma_f32_16x16x32_bf16 v[80:83],a[144:147],a[32:35],v[80:83]
s_add_u32 s21,s21,12288
v_exp_f32 v94,v94
v_mfma_f32_16x16x32_bf16 v[80:83],a[148:151],a[36:39],v[80:83]
s_add_u32 m0,s22,12288
v_exp_f32 v95,v95
v_mfma_f32_16x16x32_bf16 v[80:83],a[120:123],a[40:43],v[80:83]
v_cvt_pk_bf16_f32 v30,v92,v93
v_cvt_pk_bf16_f32 v31,v94,v95
v_mfma_f32_16x16x32_bf16 v[80:83],a[124:127],a[44:47],v[80:83]
v_exp_f32 v100,v100
v_mfma_f32_16x16x32_bf16 v[88:91],a[124:127],a[68:71],0
v_exp_f32 v101,v101
v_mfma_f32_16x16x32_bf16 v[88:91],a[120:123],a[64:67],v[88:91]
v_exp_f32 v102,v102
v_mfma_f32_16x16x32_bf16 v[88:91],a[148:151],a[60:63],v[88:91]
v_exp_f32 v103,v103
v_mfma_f32_16x16x32_bf16 v[88:91],a[144:147],a[56:59],v[88:91]
v_cvt_pk_bf16_f32 v34,v100,v101
v_cvt_pk_bf16_f32 v35,v102,v103
v_mfma_f32_16x16x32_bf16 v[88:91],a[140:143],a[52:55],v[88:91]
buffer_load_dwordx4 v6,s[4:7],s20 offen offset:0 lds
v_smfmac_f32_16x16x64_bf16 v[64:67],a[152:155],v[28:35],v18
v_fma_f32 v72,v72,s36,v13
v_mfma_f32_16x16x32_bf16 v[88:91],a[136:139],a[48:51],v[88:91]
v_fma_f32 v73,v73,s36,v13
v_fma_f32 v74,v74,s36,v13
v_mfma_f32_16x16x32_bf16 v[96:99],a[136:139],a[72:75],0
ds_read_b128 a[136:139],v0 offset:30848
v_fma_f32 v75,v75,s36,v13
v_mfma_f32_16x16x32_bf16 v[96:99],a[140:143],a[76:79],v[96:99]
ds_read_b128 a[140:143],v1 offset:30848
v_fma_f32 v80,v80,s36,v14
v_mfma_f32_16x16x32_bf16 v[96:99],a[144:147],a[80:83],v[96:99]
ds_read_b128 a[144:147],v0 offset:30976
v_fma_f32 v81,v81,s36,v14
v_mfma_f32_16x16x32_bf16 v[96:99],a[148:151],a[84:87],v[96:99]
ds_read_b128 a[148:151],v1 offset:30976
v_mfma_f32_16x16x32_bf16 v[96:99],a[120:123],a[88:91],v[96:99]
v_exp_f32 v72,v72
v_mfma_f32_16x16x32_bf16 v[96:99],a[124:127],a[92:95],v[96:99]
s_waitcnt lgkmcnt(4)
v_exp_f32 v73,v73
v_mfma_f32_16x16x32_bf16 v[76:79],a[128:131],a[0:3],0
buffer_load_dwordx4 v7,s[4:7],s20 offen offset:1024 lds
v_mfma_f32_16x16x32_bf16 v[76:79],a[132:135],a[4:7],v[76:79]
s_waitcnt lgkmcnt(3)
v_exp_f32 v74,v74
v_mfma_f32_16x16x32_bf16 v[76:79],a[136:139],a[8:11],v[76:79]
s_waitcnt lgkmcnt(2)
v_exp_f32 v75,v75
v_mfma_f32_16x16x32_bf16 v[76:79],a[140:143],a[12:15],v[76:79]
s_waitcnt lgkmcnt(0)
v_exp_f32 v80,v80
v_mfma_f32_16x16x32_bf16 v[76:79],a[144:147],a[16:19],v[76:79]
v_exp_f32 v81,v81
v_mfma_f32_16x16x32_bf16 v[76:79],a[148:151],a[20:23],v[76:79]
v_cvt_pk_bf16_f32 v44,v72,v73
v_cvt_pk_bf16_f32 v45,v74,v75
v_mfma_f32_16x16x32_bf16 v[84:87],a[148:151],a[44:47],0
v_cvt_pk_bf16_f32 v48,v80,v81
v_mfma_f32_16x16x32_bf16 v[84:87],a[144:147],a[40:43],v[84:87]
v_mfma_f32_16x16x32_bf16 v[84:87],a[140:143],a[36:39],v[84:87]
v_mfma_f32_16x16x32_bf16 v[84:87],a[136:139],a[32:35],v[84:87]
buffer_load_dwordx4 v8,s[4:7],s20 offen offset:2048 lds
v_mfma_f32_16x16x32_bf16 v[84:87],a[132:135],a[28:31],v[84:87]
s_add_u32 s20,s20,12288
v_mfma_f32_16x16x32_bf16 v[84:87],a[128:131],a[24:27],v[84:87]
ds_read_b64_tr_b16 a[120:121],v2 offset:12288
v_mfma_f32_16x16x32_bf16 v[92:95],a[128:131],a[48:51],0
ds_read_b64_tr_b16 a[122:123],v2 offset:18432
v_mfma_f32_16x16x32_bf16 v[92:95],a[132:135],a[52:55],v[92:95]
ds_read_b64_tr_b16 a[124:125],v3 offset:12288
v_mfma_f32_16x16x32_bf16 v[92:95],a[136:139],a[56:59],v[92:95]
ds_read_b64_tr_b16 a[126:127],v3 offset:18432
v_mfma_f32_16x16x32_bf16 v[92:95],a[140:143],a[60:63],v[92:95]
v_mfma_f32_16x16x32_bf16 v[92:95],a[144:147],a[64:67],v[92:95]
v_mfma_f32_16x16x32_bf16 v[92:95],a[148:151],a[68:71],v[92:95]
v_mfma_f32_16x16x32_bf16 v[100:103],a[148:151],a[92:95],0
v_mfma_f32_16x16x32_bf16 v[100:103],a[144:147],a[88:91],v[100:103]
v_mfma_f32_16x16x32_bf16 v[100:103],a[140:143],a[84:87],v[100:103]
v_mfma_f32_16x16x32_bf16 v[100:103],a[136:139],a[80:83],v[100:103]
v_mfma_f32_16x16x32_bf16 v[100:103],a[132:135],a[76:79],v[100:103]
ds_read_b64_tr_b16 a[132:133],v5 offset:12288
v_mfma_f32_16x16x32_bf16 v[100:103],a[128:131],a[72:75],v[100:103]
s_waitcnt lgkmcnt(1)
ds_read_b64_tr_b16 a[128:129],v4 offset:12288
ds_read_b64_tr_b16 a[130:131],v4 offset:18432
ds_read_b64_tr_b16 a[134:135],v5 offset:18432
v_mfma_f32_16x16x32_bf16 v[160:163],a[120:123],v[20:23],v[160:163]
s_add_u32 m0,s23,12288
ds_read_b64_tr_b16 a[138:139],v2 offset:18560
v_mbcnt_lo_u32_b32 v19,-1,0
v_mfma_f32_16x16x32_bf16 v[164:167],a[124:127],v[20:23],v[164:167]
ds_read_b64_tr_b16 a[136:137],v2 offset:12416
v_mbcnt_hi_u32_b32 v19,-1,v19
v_mfma_f32_16x16x32_bf16 v[212:215],a[124:127],v[24:27],v[212:215]
ds_read_b64_tr_b16 a[140:141],v3 offset:12416
v_min_u32 v19,7,v19
v_mfma_f32_16x16x32_bf16 v[208:211],a[120:123],v[24:27],v[208:211]
ds_read_b64_tr_b16 a[142:143],v3 offset:18560
v_lshl_add_u32 v19,v19,7,s48
v_mfma_f32_16x16x32_bf16 v[112:115],a[120:123],v[28:31],v[112:115]
ds_read_b64_tr_b16 a[146:147],v4 offset:18560
v_min_u32 v19,L_codeend-L_first-4,v19
v_mfma_f32_16x16x32_bf16 v[116:119],a[124:127],v[28:31],v[116:119]
ds_read_b64_tr_b16 a[148:149],v5 offset:12416
v_fma_f32 v83,v83,s36,v14
v_mfma_f32_16x16x32_bf16 a[164:167],a[124:127],v[32:35],a[164:167]
ds_read_b64_tr_b16 a[144:145],v4 offset:12416
v_fma_f32 v82,v82,s36,v14
v_mfma_f32_16x16x32_bf16 a[160:163],a[120:123],v[32:35],a[160:163]
s_waitcnt lgkmcnt(6)
ds_read_b64_tr_b16 a[150:151],v5 offset:18560
v_fma_f32 v91,v91,s36,v15
v_mfma_f32_16x16x32_bf16 a[168:171],a[128:131],v[32:35],a[168:171]
ds_read_b64_tr_b16 a[120:121],v2 offset:12544
v_fma_f32 v89,v89,s36,v15
v_mfma_f32_16x16x32_bf16 a[172:175],a[132:135],v[32:35],a[172:175]
ds_read_b64_tr_b16 a[122:123],v2 offset:18688
v_fma_f32 v88,v88,s36,v15
v_mfma_f32_16x16x32_bf16 v[124:127],a[132:135],v[28:31],v[124:127]
ds_read_b64_tr_b16 a[124:125],v3 offset:12544
v_fma_f32 v90,v90,s36,v15
v_mfma_f32_16x16x32_bf16 v[120:123],a[128:131],v[28:31],v[120:123]
ds_read_b64_tr_b16 a[126:127],v3 offset:18688
v_fma_f32 v96,v96,s36,v16
v_mfma_f32_16x16x32_bf16 v[216:219],a[128:131],v[24:27],v[216:219]
v_exp_f32 v82,v82
v_mfma_f32_16x16x32_bf16 v[220:223],a[132:135],v[24:27],v[220:223]
v_exp_f32 v83,v83
v_mfma_f32_16x16x32_bf16 v[172:175],a[132:135],v[20:23],v[172:175]
ds_read_b64_tr_b16 a[132:133],v5 offset:12544
v_cvt_pk_bf16_f32 v49,v82,v83
v_mfma_f32_16x16x32_bf16 v[168:171],a[128:131],v[20:23],v[168:171]
global_load_dword v19,v19,s[46:47]
s_waitcnt lgkmcnt(4)
v_mfma_f32_16x16x32_bf16 v[176:179],a[136:139],v[20:23],v[176:179]
ds_read_b64_tr_b16 a[128:129],v4 offset:12544
v_fma_f32 v99,v99,s36,v16
v_mfma_f32_16x16x32_bf16 v[180:183],a[140:143],v[20:23],v[180:183]
ds_read_b64_tr_b16 a[130:131],v4 offset:18688
v_fma_f32 v98,v98,s36,v16
v_mfma_f32_16x16x32_bf16 v[228:231],a[140:143],v[24:27],v[228:231]
ds_read_b64_tr_b16 a[134:135],v5 offset:18688
v_fma_f32 v97,v97,s36,v16
v_mfma_f32_16x16x32_bf16 v[224:227],a[136:139],v[24:27],v[224:227]
v_exp_f32 v90,v90
v_mfma_f32_16x16x32_bf16 v[128:131],a[136:139],v[28:31],v[128:131]
v_exp_f32 v89,v89
v_mfma_f32_16x16x32_bf16 v[132:135],a[140:143],v[28:31],v[132:135]
v_exp_f32 v91,v91
v_mfma_f32_16x16x32_bf16 a[180:183],a[140:143],v[32:35],a[180:183]
v_exp_f32 v88,v88
v_mfma_f32_16x16x32_bf16 a[176:179],a[136:139],v[32:35],a[176:179]
v_cvt_pk_bf16_f32 v52,v88,v89
v_cvt_pk_bf16_f32 v53,v90,v91
v_mfma_f32_16x16x32_bf16 a[184:187],a[144:147],v[32:35],a[184:187]
v_exp_f32 v99,v99
v_mfma_f32_16x16x32_bf16 a[188:191],a[148:151],v[32:35],a[188:191]
v_exp_f32 v97,v97
v_mfma_f32_16x16x32_bf16 v[140:143],a[148:151],v[28:31],v[140:143]
v_exp_f32 v98,v98
v_mfma_f32_16x16x32_bf16 v[136:139],a[144:147],v[28:31],v[136:139]
v_exp_f32 v96,v96
v_mfma_f32_16x16x32_bf16 v[232:235],a[144:147],v[24:27],v[232:235]
v_cvt_pk_bf16_f32 v56,v96,v97
v_cvt_pk_bf16_f32 v57,v98,v99
v_mfma_f32_16x16x32_bf16 v[236:239],a[148:151],v[24:27],v[236:239]
v_fma_f32 v79,v79,s36,v13
v_fma_f32 v77,v77,s36,v13
v_mfma_f32_16x16x32_bf16 v[188:191],a[148:151],v[20:23],v[188:191]
v_exp_f32 v77,v77
v_mfma_f32_16x16x32_bf16 v[184:187],a[144:147],v[20:23],v[184:187]
s_waitcnt lgkmcnt(0)
v_exp_f32 v79,v79
v_mfma_f32_16x16x32_bf16 v[192:195],a[120:123],v[20:23],v[192:195]
s_waitcnt vmcnt(10)
v_mfma_f32_16x16x32_bf16 v[196:199],a[124:127],v[20:23],v[196:199]
s_barrier
v_mfma_f32_16x16x32_bf16 v[244:247],a[124:127],v[24:27],v[244:247]
ds_read_b128 a[148:151],v1 offset:128
v_fma_f32 v76,v76,s36,v13
v_mfma_f32_16x16x32_bf16 v[240:243],a[120:123],v[24:27],v[240:243]
ds_read_b128 a[144:147],v0 offset:128
v_fma_f32 v78,v78,s36,v13
v_mfma_f32_16x16x32_bf16 v[144:147],a[120:123],v[28:31],v[144:147]
ds_read_b128 a[140:143],v1 offset:0
v_fma_f32 v86,v86,s36,v14
v_mfma_f32_16x16x32_bf16 v[148:151],a[124:127],v[28:31],v[148:151]
ds_read_b128 a[136:139],v0 offset:0
v_fma_f32 v87,v87,s36,v14
v_mfma_f32_16x16x32_bf16 a[196:199],a[124:127],v[32:35],a[196:199]
ds_read_b128 a[124:127],v1 offset:256
v_fma_f32 v85,v85,s36,v14
v_mfma_f32_16x16x32_bf16 a[192:195],a[120:123],v[32:35],a[192:195]
buffer_load_dwordx4 v6,s[8:11],s21 offen offset:0 lds
v_mfma_f32_16x16x32_bf16 a[200:203],a[128:131],v[32:35],a[200:203]
ds_read_b128 a[120:123],v0 offset:256
v_fma_f32 v84,v84,s36,v14
v_mfma_f32_16x16x32_bf16 a[204:207],a[132:135],v[32:35],a[204:207]
ds_read_b128 a[156:159],v10 offset:3072
v_fma_f32 v95,v95,s36,v15
v_mfma_f32_16x16x32_bf16 v[156:159],a[132:135],v[28:31],v[156:159]
v_exp_f32 v76,v76
v_mfma_f32_16x16x32_bf16 v[152:155],a[128:131],v[28:31],v[152:155]
v_exp_f32 v78,v78
v_mfma_f32_16x16x32_bf16 v[248:251],a[128:131],v[24:27],v[248:251]
v_cvt_pk_bf16_f32 v47,v78,v79
v_cvt_pk_bf16_f32 v46,v76,v77
v_mfma_f32_16x16x32_bf16 v[252:255],a[132:135],v[24:27],v[252:255]
v_exp_f32 v86,v86
v_mfma_f32_16x16x32_bf16 v[204:207],a[132:135],v[20:23],v[204:207]
ds_read_b128 a[132:135],v1 offset:6144
v_fma_f32 v92,v92,s36,v15
v_mfma_f32_16x16x32_bf16 v[200:203],a[128:131],v[20:23],v[200:203]
s_waitcnt lgkmcnt(2)
ds_read_b128 a[128:131],v0 offset:6144
v_fma_f32 v94,v94,s36,v15
v_mfma_f32_16x16x32_bf16 v[72:75],a[124:127],a[20:23],0
v_exp_f32 v84,v84
v_mfma_f32_16x16x32_bf16 v[72:75],a[120:123],a[16:19],v[72:75]
s_waitcnt lgkmcnt(2)
buffer_store_dwordx4 a[156:159],v9,s[16:19],s27 offen offset:0 nt
buffer_load_dwordx4 v7,s[8:11],s21 offen offset:1024 lds
v_mfma_f32_16x16x32_bf16 v[72:75],a[148:151],a[12:15],v[72:75]
ds_read_b128 a[156:159],v10 offset:4096
v_fma_f32 v93,v93,s36,v15
v_mfma_f32_16x16x32_bf16 v[72:75],a[144:147],a[8:11],v[72:75]
v_exp_f32 v87,v87
v_mfma_f32_16x16x32_bf16 v[72:75],a[140:143],a[4:7],v[72:75]
v_exp_f32 v85,v85
v_mfma_f32_16x16x32_bf16 v[72:75],a[136:139],a[0:3],v[72:75]
v_cvt_pk_bf16_f32 v51,v86,v87
v_cvt_pk_bf16_f32 v50,v84,v85
v_mfma_f32_16x16x32_bf16 v[80:83],a[136:139],a[24:27],0
v_exp_f32 v92,v92
v_smfmac_f32_16x16x64_bf16 v[60:63],a[152:155],v[44:51],v18
v_fma_f32 v103,v103,s36,v16
v_mfma_f32_16x16x32_bf16 v[80:83],a[140:143],a[28:31],v[80:83]
buffer_load_dwordx4 v8,s[8:11],s21 offen offset:2048 lds
v_mfma_f32_16x16x32_bf16 v[80:83],a[144:147],a[32:35],v[80:83]
s_add_u32 s21,s21,12288
v_exp_f32 v93,v93
v_mfma_f32_16x16x32_bf16 v[80:83],a[148:151],a[36:39],v[80:83]
s_add_u32 m0,s22,24576
v_exp_f32 v94,v94
v_mfma_f32_16x16x32_bf16 v[80:83],a[120:123],a[40:43],v[80:83]
v_exp_f32 v95,v95
v_mfma_f32_16x16x32_bf16 v[80:83],a[124:127],a[44:47],v[80:83]
v_cvt_pk_bf16_f32 v55,v94,v95
v_cvt_pk_bf16_f32 v54,v92,v93
v_mfma_f32_16x16x32_bf16 v[88:91],a[124:127],a[68:71],0
v_exp_f32 v103,v103
v_mfma_f32_16x16x32_bf16 v[88:91],a[120:123],a[64:67],v[88:91]
v_fma_f32 v101,v101,s36,v16
v_fma_f32 v100,v100,s36,v16
v_mfma_f32_16x16x32_bf16 v[88:91],a[148:151],a[60:63],v[88:91]
v_exp_f32 v100,v100
v_mfma_f32_16x16x32_bf16 v[88:91],a[144:147],a[56:59],v[88:91]
v_exp_f32 v101,v101
v_mfma_f32_16x16x32_bf16 v[88:91],a[140:143],a[52:55],v[88:91]
s_waitcnt lgkmcnt(0)
buffer_store_dwordx4 a[156:159],v9,s[16:19],s27 offen offset:128 nt
buffer_load_dwordx4 v6,s[4:7],s20 offen offset:0 lds
v_mfma_f32_16x16x32_bf16 v[88:91],a[136:139],a[48:51],v[88:91]
ds_read_b128 a[156:159],v10 offset:5120
v_mfma_f32_16x16x32_bf16 v[96:99],a[136:139],a[72:75],0
ds_read_b128 a[136:139],v0 offset:6272
v_mfma_f32_16x16x32_bf16 v[96:99],a[140:143],a[76:79],v[96:99]
ds_read_b128 a[140:143],v1 offset:6272
v_mfma_f32_16x16x32_bf16 v[96:99],a[144:147],a[80:83],v[96:99]
ds_read_b128 a[144:147],v0 offset:6400
v_mfma_f32_16x16x32_bf16 v[96:99],a[148:151],a[84:87],v[96:99]
ds_read_b128 a[148:151],v1 offset:6400
v_mfma_f32_16x16x32_bf16 v[96:99],a[120:123],a[88:91],v[96:99]
v_fma_f32 v102,v102,s36,v16
v_cvt_pk_bf16_f32 v58,v100,v101
v_mfma_f32_16x16x32_bf16 v[96:99],a[124:127],a[92:95],v[96:99]
v_exp_f32 v102,v102
v_mfma_f32_16x16x32_bf16 v[76:79],a[128:131],a[0:3],0
buffer_load_dwordx4 v7,s[4:7],s20 offen offset:1024 lds
v_mfma_f32_16x16x32_bf16 v[76:79],a[132:135],a[4:7],v[76:79]
s_waitcnt lgkmcnt(3)
v_cvt_pk_bf16_f32 v59,v102,v103
v_fma_f32 v80,v80,s36,v14
v_mfma_f32_16x16x32_bf16 v[76:79],a[136:139],a[8:11],v[76:79]
v_exp_f32 v80,v80
v_smfmac_f32_16x16x64_bf16 v[64:67],a[152:155],v[52:59],v18
s_waitcnt lgkmcnt(1)
v_fma_f32 v81,v81,s36,v14
v_mfma_f32_16x16x32_bf16 v[76:79],a[140:143],a[12:15],v[76:79]
v_exp_f32 v81,v81
v_mfma_f32_16x16x32_bf16 v[76:79],a[144:147],a[16:19],v[76:79]
s_waitcnt lgkmcnt(0)
v_fma_f32 v75,v75,s36,v13
v_fma_f32 v72,v72,s36,v13
v_mfma_f32_16x16x32_bf16 v[76:79],a[148:151],a[20:23],v[76:79]
v_exp_f32 v72,v72
v_mfma_f32_16x16x32_bf16 v[84:87],a[148:151],a[44:47],0
v_exp_f32 v75,v75
v_mfma_f32_16x16x32_bf16 v[84:87],a[144:147],a[40:43],v[84:87]
v_fma_f32 v74,v74,s36,v13
v_fma_f32 v73,v73,s36,v13
v_mfma_f32_16x16x32_bf16 v[84:87],a[140:143],a[36:39],v[84:87]
buffer_store_dwordx4 a[156:159],v9,s[16:19],s27 offen offset:256 nt
buffer_load_dwordx4 v8,s[4:7],s20 offen offset:2048 lds
v_mfma_f32_16x16x32_bf16 v[84:87],a[136:139],a[32:35],v[84:87]
s_add_u32 s20,s20,12288
ds_read_b64_tr_b16 a[120:121],v2 offset:24576
v_mfma_f32_16x16x32_bf16 v[84:87],a[132:135],a[28:31],v[84:87]
s_add_u32 s27,s27,3072
ds_read_b64_tr_b16 a[122:123],v2 offset:30720
v_cvt_pk_bf16_f32 v24,v80,v81
v_mfma_f32_16x16x32_bf16 v[84:87],a[128:131],a[24:27],v[84:87]
ds_read_b64_tr_b16 a[124:125],v3 offset:24576
v_mfma_f32_16x16x32_bf16 v[92:95],a[128:131],a[48:51],0
ds_read_b64_tr_b16 a[126:127],v3 offset:30720
v_mfma_f32_16x16x32_bf16 v[92:95],a[132:135],a[52:55],v[92:95]
v_exp_f32 v74,v74
v_mfma_f32_16x16x32_bf16 v[92:95],a[136:139],a[56:59],v[92:95]
v_exp_f32 v73,v73
v_mfma_f32_16x16x32_bf16 v[92:95],a[140:143],a[60:63],v[92:95]
v_cvt_pk_bf16_f32 v21,v74,v75
v_cvt_pk_bf16_f32 v20,v72,v73
v_mfma_f32_16x16x32_bf16 v[92:95],a[144:147],a[64:67],v[92:95]
v_mfma_f32_16x16x32_bf16 v[92:95],a[148:151],a[68:71],v[92:95]
v_mfma_f32_16x16x32_bf16 v[100:103],a[148:151],a[92:95],0
v_mfma_f32_16x16x32_bf16 v[100:103],a[144:147],a[88:91],v[100:103]
v_mfma_f32_16x16x32_bf16 v[100:103],a[140:143],a[84:87],v[100:103]
v_mfma_f32_16x16x32_bf16 v[100:103],a[136:139],a[80:83],v[100:103]
v_mfma_f32_16x16x32_bf16 v[100:103],a[132:135],a[76:79],v[100:103]
ds_read_b64_tr_b16 a[134:135],v5 offset:30720
v_mfma_f32_16x16x32_bf16 v[100:103],a[128:131],a[72:75],v[100:103]
s_waitcnt lgkmcnt(1)
ds_read_b64_tr_b16 a[130:131],v4 offset:30720
ds_read_b64_tr_b16 a[128:129],v4 offset:24576
ds_read_b64_tr_b16 a[132:133],v5 offset:24576
v_mfma_f32_16x16x32_bf16 v[160:163],a[120:123],v[44:47],v[160:163]
s_add_u32 m0,s29,0
ds_read_b64_tr_b16 a[136:137],v2 offset:24704
v_fma_f32 v82,v82,s36,v14
v_mfma_f32_16x16x32_bf16 v[164:167],a[124:127],v[44:47],v[164:167]
ds_read_b64_tr_b16 a[138:139],v2 offset:30848
v_fma_f32 v83,v83,s36,v14
v_mfma_f32_16x16x32_bf16 v[212:215],a[124:127],v[48:51],v[212:215]
ds_read_b64_tr_b16 a[140:141],v3 offset:24704
v_fma_f32 v88,v88,s36,v15
v_mfma_f32_16x16x32_bf16 v[208:211],a[120:123],v[48:51],v[208:211]
ds_read_b64_tr_b16 a[142:143],v3 offset:30848
v_fma_f32 v89,v89,s36,v15
v_mfma_f32_16x16x32_bf16 v[112:115],a[120:123],v[52:55],v[112:115]
ds_read_b64_tr_b16 a[144:145],v4 offset:24704
v_fma_f32 v90,v90,s36,v15
v_mfma_f32_16x16x32_bf16 v[116:119],a[124:127],v[52:55],v[116:119]
ds_read_b64_tr_b16 a[146:147],v4 offset:30848
v_fma_f32 v91,v91,s36,v15
v_mfma_f32_16x16x32_bf16 a[164:167],a[124:127],v[56:59],a[164:167]
buffer_load_dwordx4 v6,s[12:15],s28 offen offset:0 nt lds
v_mfma_f32_16x16x32_bf16 a[160:163],a[120:123],v[56:59],a[160:163]
s_waitcnt lgkmcnt(5)
ds_read_b64_tr_b16 a[148:149],v5 offset:24704
v_fma_f32 v96,v96,s36,v16
v_mfma_f32_16x16x32_bf16 a[168:171],a[128:131],v[56:59],a[168:171]
ds_read_b64_tr_b16 a[150:151],v5 offset:30848
v_fma_f32 v97,v97,s36,v16
v_mfma_f32_16x16x32_bf16 a[172:175],a[132:135],v[56:59],a[172:175]
ds_read_b64_tr_b16 a[120:121],v2 offset:24832
v_fma_f32 v98,v98,s36,v16
v_mfma_f32_16x16x32_bf16 v[124:127],a[132:135],v[52:55],v[124:127]
ds_read_b64_tr_b16 a[122:123],v2 offset:30976
v_fma_f32 v99,v99,s36,v16
v_mfma_f32_16x16x32_bf16 v[120:123],a[128:131],v[52:55],v[120:123]
ds_read_b64_tr_b16 a[124:125],v3 offset:24832
v_fma_f32 v76,v76,s36,v13
v_mfma_f32_16x16x32_bf16 v[216:219],a[128:131],v[48:51],v[216:219]
ds_read_b64_tr_b16 a[126:127],v3 offset:30976
v_fma_f32 v77,v77,s36,v13
v_mfma_f32_16x16x32_bf16 v[220:223],a[132:135],v[48:51],v[220:223]
buffer_load_dwordx4 v7,s[12:15],s28 offen offset:1024 nt lds
v_mfma_f32_16x16x32_bf16 v[172:175],a[132:135],v[44:47],v[172:175]
ds_read_b64_tr_b16 a[132:133],v5 offset:24832
v_fma_f32 v78,v78,s36,v13
v_mfma_f32_16x16x32_bf16 v[168:171],a[128:131],v[44:47],v[168:171]
s_waitcnt lgkmcnt(5)
ds_read_b64_tr_b16 a[128:129],v4 offset:24832
v_fma_f32 v79,v79,s36,v13
v_mfma_f32_16x16x32_bf16 v[176:179],a[136:139],v[44:47],v[176:179]
ds_read_b64_tr_b16 a[130:131],v4 offset:30976
v_fma_f32 v84,v84,s36,v14
v_mfma_f32_16x16x32_bf16 v[180:183],a[140:143],v[44:47],v[180:183]
ds_read_b64_tr_b16 a[134:135],v5 offset:30976
v_fma_f32 v85,v85,s36,v14
v_mfma_f32_16x16x32_bf16 v[228:231],a[140:143],v[48:51],v[228:231]
v_exp_f32 v82,v82
v_mfma_f32_16x16x32_bf16 v[224:227],a[136:139],v[48:51],v[224:227]
v_exp_f32 v83,v83
v_mfma_f32_16x16x32_bf16 v[128:131],a[136:139],v[52:55],v[128:131]
v_cvt_pk_bf16_f32 v25,v82,v83
v_fma_f32 v86,v86,s36,v14
v_mfma_f32_16x16x32_bf16 v[132:135],a[140:143],v[52:55],v[132:135]
buffer_load_dwordx4 v8,s[12:15],s28 offen offset:2048 nt lds
v_mfma_f32_16x16x32_bf16 a[180:183],a[140:143],v[56:59],a[180:183]
s_add_u32 s28,s28,3072
v_exp_f32 v88,v88
v_mfma_f32_16x16x32_bf16 a[176:179],a[136:139],v[56:59],a[176:179]
s_add_u32 s29,s29,3072
v_exp_f32 v89,v89
v_mfma_f32_16x16x32_bf16 a[184:187],a[144:147],v[56:59],a[184:187]
s_add_u32 m0,s23,24576
v_exp_f32 v90,v90
v_mfma_f32_16x16x32_bf16 a[188:191],a[148:151],v[56:59],a[188:191]
v_exp_f32 v91,v91
v_mfma_f32_16x16x32_bf16 v[140:143],a[148:151],v[52:55],v[140:143]
v_cvt_pk_bf16_f32 v28,v88,v89
v_cvt_pk_bf16_f32 v29,v90,v91
v_mfma_f32_16x16x32_bf16 v[136:139],a[144:147],v[52:55],v[136:139]
v_exp_f32 v96,v96
v_mfma_f32_16x16x32_bf16 v[232:235],a[144:147],v[48:51],v[232:235]
v_exp_f32 v97,v97
v_mfma_f32_16x16x32_bf16 v[236:239],a[148:151],v[48:51],v[236:239]
v_exp_f32 v98,v98
v_mfma_f32_16x16x32_bf16 v[188:191],a[148:151],v[44:47],v[188:191]
v_exp_f32 v99,v99
v_mfma_f32_16x16x32_bf16 v[184:187],a[144:147],v[44:47],v[184:187]
s_waitcnt lgkmcnt(0)
v_cvt_pk_bf16_f32 v32,v96,v97
v_cvt_pk_bf16_f32 v33,v98,v99
v_mfma_f32_16x16x32_bf16 v[192:195],a[120:123],v[44:47],v[192:195]
s_waitcnt vmcnt(13)
v_exp_f32 v76,v76
v_mfma_f32_16x16x32_bf16 v[196:199],a[124:127],v[44:47],v[196:199]
s_barrier
v_mfma_f32_16x16x32_bf16 v[244:247],a[124:127],v[48:51],v[244:247]
ds_read_b128 a[148:151],v1 offset:12416
v_fma_f32 v87,v87,s36,v14
v_mfma_f32_16x16x32_bf16 v[240:243],a[120:123],v[48:51],v[240:243]
ds_read_b128 a[144:147],v0 offset:12416
v_fma_f32 v92,v92,s36,v15
v_mfma_f32_16x16x32_bf16 v[144:147],a[120:123],v[52:55],v[144:147]
ds_read_b128 a[140:143],v1 offset:12288
v_fma_f32 v93,v93,s36,v15
v_mfma_f32_16x16x32_bf16 v[148:151],a[124:127],v[52:55],v[148:151]
ds_read_b128 a[136:139],v0 offset:12288
v_fma_f32 v94,v94,s36,v15
v_mfma_f32_16x16x32_bf16 a[196:199],a[124:127],v[56:59],a[196:199]
ds_read_b128 a[124:127],v1 offset:12544
v_fma_f32 v95,v95,s36,v15
v_mfma_f32_16x16x32_bf16 a[192:195],a[120:123],v[56:59],a[192:195]
buffer_load_dwordx4 v6,s[8:11],s21 offen offset:0 lds
v_mfma_f32_16x16x32_bf16 a[200:203],a[128:131],v[56:59],a[200:203]
ds_read_b128 a[120:123],v0 offset:12544
v_fma_f32 v100,v100,s36,v16
v_mfma_f32_16x16x32_bf16 a[204:207],a[132:135],v[56:59],a[204:207]
v_exp_f32 v77,v77
v_mfma_f32_16x16x32_bf16 v[156:159],a[132:135],v[52:55],v[156:159]
v_exp_f32 v78,v78
v_mfma_f32_16x16x32_bf16 v[152:155],a[128:131],v[52:55],v[152:155]
v_exp_f32 v79,v79
v_mfma_f32_16x16x32_bf16 v[248:251],a[128:131],v[48:51],v[248:251]
v_cvt_pk_bf16_f32 v22,v76,v77
v_cvt_pk_bf16_f32 v23,v78,v79
v_mfma_f32_16x16x32_bf16 v[252:255],a[132:135],v[48:51],v[252:255]
v_exp_f32 v84,v84
v_mfma_f32_16x16x32_bf16 v[204:207],a[132:135],v[44:47],v[204:207]
ds_read_b128 a[132:135],v1 offset:18432
v_fma_f32 v101,v101,s36,v16
v_mfma_f32_16x16x32_bf16 v[200:203],a[128:131],v[44:47],v[200:203]
s_waitcnt lgkmcnt(1)
ds_read_b128 a[128:131],v0 offset:18432
v_fma_f32 v102,v102,s36,v16
v_mfma_f32_16x16x32_bf16 v[72:75],a[124:127],a[20:23],0
buffer_load_dwordx4 v7,s[8:11],s21 offen offset:1024 lds
v_mfma_f32_16x16x32_bf16 v[72:75],a[120:123],a[16:19],v[72:75]
v_exp_f32 v85,v85
v_mfma_f32_16x16x32_bf16 v[72:75],a[148:151],a[12:15],v[72:75]
v_exp_f32 v86,v86
v_mfma_f32_16x16x32_bf16 v[72:75],a[144:147],a[8:11],v[72:75]
v_exp_f32 v87,v87
v_mfma_f32_16x16x32_bf16 v[72:75],a[140:143],a[4:7],v[72:75]
v_cvt_pk_bf16_f32 v26,v84,v85
v_cvt_pk_bf16_f32 v27,v86,v87
v_mfma_f32_16x16x32_bf16 v[72:75],a[136:139],a[0:3],v[72:75]
v_exp_f32 v92,v92
v_smfmac_f32_16x16x64_bf16 v[60:63],a[152:155],v[20:27],v18
v_fma_f32 v103,v103,s36,v16
v_mfma_f32_16x16x32_bf16 v[80:83],a[136:139],a[24:27],0
v_exp_f32 v93,v93
v_mfma_f32_16x16x32_bf16 v[80:83],a[140:143],a[28:31],v[80:83]
buffer_load_dwordx4 v8,s[8:11],s21 offen offset:2048 lds
v_mfma_f32_16x16x32_bf16 v[80:83],a[144:147],a[32:35],v[80:83]
s_add_u32 s21,s21,12288
v_exp_f32 v94,v94
v_mfma_f32_16x16x32_bf16 v[80:83],a[148:151],a[36:39],v[80:83]
s_add_u32 m0,s22,0
v_exp_f32 v95,v95
v_mfma_f32_16x16x32_bf16 v[80:83],a[120:123],a[40:43],v[80:83]
v_cvt_pk_bf16_f32 v30,v92,v93
v_cvt_pk_bf16_f32 v31,v94,v95
v_mfma_f32_16x16x32_bf16 v[80:83],a[124:127],a[44:47],v[80:83]
v_exp_f32 v100,v100
v_mfma_f32_16x16x32_bf16 v[88:91],a[124:127],a[68:71],0
v_exp_f32 v101,v101
v_mfma_f32_16x16x32_bf16 v[88:91],a[120:123],a[64:67],v[88:91]
v_exp_f32 v102,v102
v_mfma_f32_16x16x32_bf16 v[88:91],a[148:151],a[60:63],v[88:91]
v_exp_f32 v103,v103
v_mfma_f32_16x16x32_bf16 v[88:91],a[144:147],a[56:59],v[88:91]
v_cvt_pk_bf16_f32 v34,v100,v101
v_cvt_pk_bf16_f32 v35,v102,v103
v_mfma_f32_16x16x32_bf16 v[88:91],a[140:143],a[52:55],v[88:91]
buffer_load_dwordx4 v6,s[4:7],s20 offen offset:0 lds
v_smfmac_f32_16x16x64_bf16 v[64:67],a[152:155],v[28:35],v18
v_fma_f32 v72,v72,s36,v13
v_mfma_f32_16x16x32_bf16 v[88:91],a[136:139],a[48:51],v[88:91]
v_fma_f32 v73,v73,s36,v13
v_fma_f32 v74,v74,s36,v13
v_mfma_f32_16x16x32_bf16 v[96:99],a[136:139],a[72:75],0
ds_read_b128 a[136:139],v0 offset:18560
v_fma_f32 v75,v75,s36,v13
v_mfma_f32_16x16x32_bf16 v[96:99],a[140:143],a[76:79],v[96:99]
ds_read_b128 a[140:143],v1 offset:18560
v_fma_f32 v80,v80,s36,v14
v_mfma_f32_16x16x32_bf16 v[96:99],a[144:147],a[80:83],v[96:99]
ds_read_b128 a[144:147],v0 offset:18688
v_fma_f32 v81,v81,s36,v14
v_mfma_f32_16x16x32_bf16 v[96:99],a[148:151],a[84:87],v[96:99]
ds_read_b128 a[148:151],v1 offset:18688
v_mfma_f32_16x16x32_bf16 v[96:99],a[120:123],a[88:91],v[96:99]
v_exp_f32 v72,v72
v_mfma_f32_16x16x32_bf16 v[96:99],a[124:127],a[92:95],v[96:99]
s_waitcnt lgkmcnt(4)
v_exp_f32 v73,v73
v_mfma_f32_16x16x32_bf16 v[76:79],a[128:131],a[0:3],0
buffer_load_dwordx4 v7,s[4:7],s20 offen offset:1024 lds
v_mfma_f32_16x16x32_bf16 v[76:79],a[132:135],a[4:7],v[76:79]
s_waitcnt lgkmcnt(3)
v_exp_f32 v74,v74
v_mfma_f32_16x16x32_bf16 v[76:79],a[136:139],a[8:11],v[76:79]
s_waitcnt lgkmcnt(2)
v_exp_f32 v75,v75
v_mfma_f32_16x16x32_bf16 v[76:79],a[140:143],a[12:15],v[76:79]
s_waitcnt lgkmcnt(0)
v_exp_f32 v80,v80
v_mfma_f32_16x16x32_bf16 v[76:79],a[144:147],a[16:19],v[76:79]
v_exp_f32 v81,v81
v_mfma_f32_16x16x32_bf16 v[76:79],a[148:151],a[20:23],v[76:79]
v_cvt_pk_bf16_f32 v44,v72,v73
v_cvt_pk_bf16_f32 v45,v74,v75
v_mfma_f32_16x16x32_bf16 v[84:87],a[148:151],a[44:47],0
v_cvt_pk_bf16_f32 v48,v80,v81
v_mfma_f32_16x16x32_bf16 v[84:87],a[144:147],a[40:43],v[84:87]
v_mfma_f32_16x16x32_bf16 v[84:87],a[140:143],a[36:39],v[84:87]
v_mfma_f32_16x16x32_bf16 v[84:87],a[136:139],a[32:35],v[84:87]
buffer_load_dwordx4 v8,s[4:7],s20 offen offset:2048 lds
v_mfma_f32_16x16x32_bf16 v[84:87],a[132:135],a[28:31],v[84:87]
s_add_u32 s20,s20,12288
v_mfma_f32_16x16x32_bf16 v[84:87],a[128:131],a[24:27],v[84:87]
ds_read_b64_tr_b16 a[120:121],v2 offset:0
v_mfma_f32_16x16x32_bf16 v[92:95],a[128:131],a[48:51],0
ds_read_b64_tr_b16 a[122:123],v2 offset:6144
v_mfma_f32_16x16x32_bf16 v[92:95],a[132:135],a[52:55],v[92:95]
ds_read_b64_tr_b16 a[124:125],v3 offset:0
v_mfma_f32_16x16x32_bf16 v[92:95],a[136:139],a[56:59],v[92:95]
ds_read_b64_tr_b16 a[126:127],v3 offset:6144
v_mfma_f32_16x16x32_bf16 v[92:95],a[140:143],a[60:63],v[92:95]
v_mfma_f32_16x16x32_bf16 v[92:95],a[144:147],a[64:67],v[92:95]
v_mfma_f32_16x16x32_bf16 v[92:95],a[148:151],a[68:71],v[92:95]
v_mfma_f32_16x16x32_bf16 v[100:103],a[148:151],a[92:95],0
v_mfma_f32_16x16x32_bf16 v[100:103],a[144:147],a[88:91],v[100:103]
v_mfma_f32_16x16x32_bf16 v[100:103],a[140:143],a[84:87],v[100:103]
v_mfma_f32_16x16x32_bf16 v[100:103],a[136:139],a[80:83],v[100:103]
v_mfma_f32_16x16x32_bf16 v[100:103],a[132:135],a[76:79],v[100:103]
ds_read_b64_tr_b16 a[132:133],v5 offset:0
v_mfma_f32_16x16x32_bf16 v[100:103],a[128:131],a[72:75],v[100:103]
s_waitcnt lgkmcnt(1)
ds_read_b64_tr_b16 a[128:129],v4 offset:0
ds_read_b64_tr_b16 a[130:131],v4 offset:6144
ds_read_b64_tr_b16 a[134:135],v5 offset:6144
v_mfma_f32_16x16x32_bf16 v[160:163],a[120:123],v[20:23],v[160:163]
s_add_u32 m0,s23,0
ds_read_b64_tr_b16 a[142:143],v3 offset:6272
v_fma_f32 v83,v83,s36,v14
v_mfma_f32_16x16x32_bf16 v[164:167],a[124:127],v[20:23],v[164:167]
ds_read_b64_tr_b16 a[138:139],v2 offset:6272
v_fma_f32 v82,v82,s36,v14
v_mfma_f32_16x16x32_bf16 v[212:215],a[124:127],v[24:27],v[212:215]
ds_read_b64_tr_b16 a[136:137],v2 offset:128
v_fma_f32 v88,v88,s36,v15
v_mfma_f32_16x16x32_bf16 v[208:211],a[120:123],v[24:27],v[208:211]
ds_read_b64_tr_b16 a[140:141],v3 offset:128
v_fma_f32 v91,v91,s36,v15
v_mfma_f32_16x16x32_bf16 v[112:115],a[120:123],v[28:31],v[112:115]
ds_read_b64_tr_b16 a[146:147],v4 offset:6272
v_fma_f32 v89,v89,s36,v15
v_mfma_f32_16x16x32_bf16 v[116:119],a[124:127],v[28:31],v[116:119]
ds_read_b64_tr_b16 a[150:151],v5 offset:6272
v_fma_f32 v90,v90,s36,v15
v_mfma_f32_16x16x32_bf16 a[164:167],a[124:127],v[32:35],a[164:167]
ds_read_b64_tr_b16 a[144:145],v4 offset:128
v_fma_f32 v96,v96,s36,v16
v_mfma_f32_16x16x32_bf16 a[160:163],a[120:123],v[32:35],a[160:163]
s_waitcnt lgkmcnt(6)
ds_read_b64_tr_b16 a[148:149],v5 offset:128
v_fma_f32 v98,v98,s36,v16
v_mfma_f32_16x16x32_bf16 a[168:171],a[128:131],v[32:35],a[168:171]
ds_read_b64_tr_b16 a[120:121],v2 offset:256
v_fma_f32 v99,v99,s36,v16
v_mfma_f32_16x16x32_bf16 a[172:175],a[132:135],v[32:35],a[172:175]
ds_read_b64_tr_b16 a[126:127],v3 offset:6400
v_fma_f32 v97,v97,s36,v16
v_mfma_f32_16x16x32_bf16 v[124:127],a[132:135],v[28:31],v[124:127]
ds_read_b64_tr_b16 a[122:123],v2 offset:6400
v_fma_f32 v79,v79,s36,v13
v_mfma_f32_16x16x32_bf16 v[120:123],a[128:131],v[28:31],v[120:123]
ds_read_b64_tr_b16 a[124:125],v3 offset:256
v_fma_f32 v77,v77,s36,v13
v_mfma_f32_16x16x32_bf16 v[216:219],a[128:131],v[24:27],v[216:219]
v_exp_f32 v82,v82
v_mfma_f32_16x16x32_bf16 v[220:223],a[132:135],v[24:27],v[220:223]
v_exp_f32 v83,v83
v_mfma_f32_16x16x32_bf16 v[172:175],a[132:135],v[20:23],v[172:175]
ds_read_b64_tr_b16 a[132:133],v5 offset:256
v_cvt_pk_bf16_f32 v49,v82,v83
v_mfma_f32_16x16x32_bf16 v[168:171],a[128:131],v[20:23],v[168:171]
s_waitcnt lgkmcnt(4)
ds_read_b64_tr_b16 a[134:135],v5 offset:6400
v_fma_f32 v76,v76,s36,v13
v_mfma_f32_16x16x32_bf16 v[176:179],a[136:139],v[20:23],v[176:179]
ds_read_b64_tr_b16 a[128:129],v4 offset:256
v_fma_f32 v78,v78,s36,v13
v_mfma_f32_16x16x32_bf16 v[180:183],a[140:143],v[20:23],v[180:183]
ds_read_b64_tr_b16 a[130:131],v4 offset:6400
v_fma_f32 v86,v86,s36,v14
v_mfma_f32_16x16x32_bf16 v[228:231],a[140:143],v[24:27],v[228:231]
v_exp_f32 v90,v90
v_mfma_f32_16x16x32_bf16 v[224:227],a[136:139],v[24:27],v[224:227]
v_exp_f32 v88,v88
v_mfma_f32_16x16x32_bf16 v[128:131],a[136:139],v[28:31],v[128:131]
v_exp_f32 v89,v89
v_mfma_f32_16x16x32_bf16 v[132:135],a[140:143],v[28:31],v[132:135]
v_cvt_pk_bf16_f32 v52,v88,v89
v_fma_f32 v84,v84,s36,v14
v_mfma_f32_16x16x32_bf16 a[180:183],a[140:143],v[32:35],a[180:183]
v_exp_f32 v91,v91
v_mfma_f32_16x16x32_bf16 a[176:179],a[136:139],v[32:35],a[176:179]
v_cvt_pk_bf16_f32 v53,v90,v91
v_fma_f32 v85,v85,s36,v14
v_mfma_f32_16x16x32_bf16 a[184:187],a[144:147],v[32:35],a[184:187]
v_exp_f32 v99,v99
v_mfma_f32_16x16x32_bf16 a[188:191],a[148:151],v[32:35],a[188:191]
v_exp_f32 v97,v97
v_mfma_f32_16x16x32_bf16 v[140:143],a[148:151],v[28:31],v[140:143]
v_exp_f32 v96,v96
v_mfma_f32_16x16x32_bf16 v[136:139],a[144:147],v[28:31],v[136:139]
v_cvt_pk_bf16_f32 v56,v96,v97
v_fma_f32 v87,v87,s36,v14
v_mfma_f32_16x16x32_bf16 v[232:235],a[144:147],v[24:27],v[232:235]
v_exp_f32 v98,v98
v_mfma_f32_16x16x32_bf16 v[236:239],a[148:151],v[24:27],v[236:239]
v_cvt_pk_bf16_f32 v57,v98,v99
v_fma_f32 v94,v94,s36,v15
v_mfma_f32_16x16x32_bf16 v[188:191],a[148:151],v[20:23],v[188:191]
v_exp_f32 v76,v76
v_mfma_f32_16x16x32_bf16 v[184:187],a[144:147],v[20:23],v[184:187]
s_waitcnt lgkmcnt(0)
v_exp_f32 v79,v79
v_mfma_f32_16x16x32_bf16 v[192:195],a[120:123],v[20:23],v[192:195]
v_exp_f32 v78,v78
v_mfma_f32_16x16x32_bf16 v[196:199],a[124:127],v[20:23],v[196:199]
s_waitcnt vmcnt(9)
ds_read_b128 a[156:159],v10 offset:6144
v_cvt_pk_bf16_f32 v47,v78,v79
v_mfma_f32_16x16x32_bf16 v[244:247],a[124:127],v[24:27],v[244:247]
s_barrier
v_mfma_f32_16x16x32_bf16 v[240:243],a[120:123],v[24:27],v[240:243]
ds_read_b128 a[148:151],v1 offset:24704
v_fma_f32 v92,v92,s36,v15
v_mfma_f32_16x16x32_bf16 v[144:147],a[120:123],v[28:31],v[144:147]
ds_read_b128 a[144:147],v0 offset:24704
v_fma_f32 v93,v93,s36,v15
v_mfma_f32_16x16x32_bf16 v[148:151],a[124:127],v[28:31],v[148:151]
ds_read_b128 a[140:143],v1 offset:24576
v_fma_f32 v95,v95,s36,v15
v_mfma_f32_16x16x32_bf16 a[196:199],a[124:127],v[32:35],a[196:199]
ds_read_b128 a[124:127],v1 offset:24832
v_fma_f32 v102,v102,s36,v16
v_mfma_f32_16x16x32_bf16 a[192:195],a[120:123],v[32:35],a[192:195]
ds_read_b128 a[120:123],v0 offset:24832
v_fma_f32 v100,v100,s36,v16
v_mfma_f32_16x16x32_bf16 a[200:203],a[128:131],v[32:35],a[200:203]
buffer_load_dwordx4 v6,s[8:11],s21 offen offset:0 lds
v_mfma_f32_16x16x32_bf16 a[204:207],a[132:135],v[32:35],a[204:207]
ds_read_b128 a[136:139],v0 offset:24576
v_fma_f32 v101,v101,s36,v16
v_mfma_f32_16x16x32_bf16 v[156:159],a[132:135],v[28:31],v[156:159]
v_exp_f32 v77,v77
v_mfma_f32_16x16x32_bf16 v[152:155],a[128:131],v[28:31],v[152:155]
v_cvt_pk_bf16_f32 v46,v76,v77
v_fma_f32 v103,v103,s36,v16
v_mfma_f32_16x16x32_bf16 v[248:251],a[128:131],v[24:27],v[248:251]
v_exp_f32 v86,v86
v_mfma_f32_16x16x32_bf16 v[252:255],a[132:135],v[24:27],v[252:255]
v_exp_f32 v87,v87
v_mfma_f32_16x16x32_bf16 v[204:207],a[132:135],v[20:23],v[204:207]
ds_read_b128 a[132:135],v1 offset:30720
v_cvt_pk_bf16_f32 v51,v86,v87
v_mfma_f32_16x16x32_bf16 v[200:203],a[128:131],v[20:23],v[200:203]
s_waitcnt lgkmcnt(2)
ds_read_b128 a[128:131],v0 offset:30720
v_mfma_f32_16x16x32_bf16 v[72:75],a[124:127],a[20:23],0
v_exp_f32 v85,v85
v_mfma_f32_16x16x32_bf16 v[72:75],a[120:123],a[16:19],v[72:75]
buffer_store_dwordx4 a[156:159],v9,s[16:19],s27 offen offset:0 nt
buffer_load_dwordx4 v7,s[8:11],s21 offen offset:1024 lds
v_mfma_f32_16x16x32_bf16 v[72:75],a[148:151],a[12:15],v[72:75]
ds_read_b128 a[156:159],v10 offset:7168
v_mfma_f32_16x16x32_bf16 v[72:75],a[144:147],a[8:11],v[72:75]
v_exp_f32 v84,v84
v_mfma_f32_16x16x32_bf16 v[72:75],a[140:143],a[4:7],v[72:75]
s_waitcnt lgkmcnt(3)
v_cvt_pk_bf16_f32 v50,v84,v85
v_mfma_f32_16x16x32_bf16 v[72:75],a[136:139],a[0:3],v[72:75]
v_exp_f32 v93,v93
v_smfmac_f32_16x16x64_bf16 v[60:63],a[152:155],v[44:51],v18
v_mfma_f32_16x16x32_bf16 v[80:83],a[136:139],a[24:27],0
v_exp_f32 v94,v94
v_mfma_f32_16x16x32_bf16 v[80:83],a[140:143],a[28:31],v[80:83]
v_exp_f32 v92,v92
v_mfma_f32_16x16x32_bf16 v[80:83],a[144:147],a[32:35],v[80:83]
buffer_load_dwordx4 v8,s[8:11],s21 offen offset:2048 lds
v_mfma_f32_16x16x32_bf16 v[80:83],a[148:151],a[36:39],v[80:83]
s_add_u32 s21,s21,12288
v_cvt_pk_bf16_f32 v54,v92,v93
v_fma_f32 v74,v74,s36,v13
v_mfma_f32_16x16x32_bf16 v[80:83],a[120:123],a[40:43],v[80:83]
s_cmp_eq_u32 s38,1
v_exp_f32 v95,v95
v_mfma_f32_16x16x32_bf16 v[80:83],a[124:127],a[44:47],v[80:83]
s_cselect_b32 s20,s26,s20
v_cvt_pk_bf16_f32 v55,v94,v95
v_fma_f32 v75,v75,s36,v13
v_mfma_f32_16x16x32_bf16 v[88:91],a[124:127],a[68:71],0
s_add_u32 m0,s22,12288
v_exp_f32 v103,v103
v_mfma_f32_16x16x32_bf16 v[88:91],a[120:123],a[64:67],v[88:91]
v_exp_f32 v100,v100
v_mfma_f32_16x16x32_bf16 v[88:91],a[148:151],a[60:63],v[88:91]
v_exp_f32 v102,v102
v_mfma_f32_16x16x32_bf16 v[88:91],a[144:147],a[56:59],v[88:91]
v_cvt_pk_bf16_f32 v59,v102,v103
v_fma_f32 v73,v73,s36,v13
v_mfma_f32_16x16x32_bf16 v[88:91],a[140:143],a[52:55],v[88:91]
v_exp_f32 v101,v101
v_mfma_f32_16x16x32_bf16 v[88:91],a[136:139],a[48:51],v[88:91]
s_waitcnt lgkmcnt(0)
buffer_store_dwordx4 a[156:159],v9,s[16:19],s27 offen offset:128 nt
buffer_load_dwordx4 v6,s[4:7],s20 offen offset:0 lds
v_mfma_f32_16x16x32_bf16 v[96:99],a[136:139],a[72:75],0
ds_read_b128 a[156:159],v10 offset:8192
v_cvt_pk_bf16_f32 v58,v100,v101
v_mfma_f32_16x16x32_bf16 v[96:99],a[140:143],a[76:79],v[96:99]
ds_read_b128 a[136:139],v0 offset:30848
v_fma_f32 v80,v80,s36,v14
v_smfmac_f32_16x16x64_bf16 v[64:67],a[152:155],v[52:59],v18
ds_read_b128 a[140:143],v1 offset:30848
v_mfma_f32_16x16x32_bf16 v[96:99],a[144:147],a[80:83],v[96:99]
ds_read_b128 a[144:147],v0 offset:30976
v_mfma_f32_16x16x32_bf16 v[96:99],a[148:151],a[84:87],v[96:99]
ds_read_b128 a[148:151],v1 offset:30976
v_mfma_f32_16x16x32_bf16 v[96:99],a[120:123],a[88:91],v[96:99]
v_fma_f32 v81,v81,s36,v14
v_fma_f32 v72,v72,s36,v13
v_mfma_f32_16x16x32_bf16 v[96:99],a[124:127],a[92:95],v[96:99]
v_exp_f32 v80,v80
v_mfma_f32_16x16x32_bf16 v[76:79],a[128:131],a[0:3],0
buffer_load_dwordx4 v7,s[4:7],s20 offen offset:1024 lds
v_mfma_f32_16x16x32_bf16 v[76:79],a[132:135],a[4:7],v[76:79]
s_waitcnt lgkmcnt(3)
v_exp_f32 v74,v74
v_mfma_f32_16x16x32_bf16 v[76:79],a[136:139],a[8:11],v[76:79]
s_waitcnt lgkmcnt(2)
v_exp_f32 v75,v75
v_mfma_f32_16x16x32_bf16 v[76:79],a[140:143],a[12:15],v[76:79]
s_waitcnt lgkmcnt(1)
v_cvt_pk_bf16_f32 v21,v74,v75
v_mfma_f32_16x16x32_bf16 v[76:79],a[144:147],a[16:19],v[76:79]
s_waitcnt lgkmcnt(0)
v_exp_f32 v72,v72
v_mfma_f32_16x16x32_bf16 v[76:79],a[148:151],a[20:23],v[76:79]
v_exp_f32 v81,v81
v_mfma_f32_16x16x32_bf16 v[84:87],a[148:151],a[44:47],0
v_cvt_pk_bf16_f32 v24,v80,v81
v_mfma_f32_16x16x32_bf16 v[84:87],a[144:147],a[40:43],v[84:87]
v_exp_f32 v73,v73
v_mfma_f32_16x16x32_bf16 v[84:87],a[140:143],a[36:39],v[84:87]
v_cvt_pk_bf16_f32 v20,v72,v73
v_mfma_f32_16x16x32_bf16 v[84:87],a[136:139],a[32:35],v[84:87]
buffer_store_dwordx4 a[156:159],v9,s[16:19],s27 offen offset:256 nt
buffer_load_dwordx4 v8,s[4:7],s20 offen offset:2048 lds
v_mfma_f32_16x16x32_bf16 v[84:87],a[132:135],a[28:31],v[84:87]
s_add_u32 s20,s20,12288
ds_read_b64_tr_b16 a[120:121],v2 offset:12288
v_mfma_f32_16x16x32_bf16 v[84:87],a[128:131],a[24:27],v[84:87]
s_add_u32 s27,s27,3072
ds_read_b64_tr_b16 a[122:123],v2 offset:18432
v_mfma_f32_16x16x32_bf16 v[92:95],a[128:131],a[48:51],0
ds_read_b64_tr_b16 a[124:125],v3 offset:12288
v_mfma_f32_16x16x32_bf16 v[92:95],a[132:135],a[52:55],v[92:95]
ds_read_b64_tr_b16 a[126:127],v3 offset:18432
v_mfma_f32_16x16x32_bf16 v[92:95],a[136:139],a[56:59],v[92:95]
v_mfma_f32_16x16x32_bf16 v[92:95],a[140:143],a[60:63],v[92:95]
v_mfma_f32_16x16x32_bf16 v[92:95],a[144:147],a[64:67],v[92:95]
v_mfma_f32_16x16x32_bf16 v[92:95],a[148:151],a[68:71],v[92:95]
v_mfma_f32_16x16x32_bf16 v[100:103],a[148:151],a[92:95],0
v_mfma_f32_16x16x32_bf16 v[100:103],a[144:147],a[88:91],v[100:103]
v_mfma_f32_16x16x32_bf16 v[100:103],a[140:143],a[84:87],v[100:103]
v_mfma_f32_16x16x32_bf16 v[100:103],a[136:139],a[80:83],v[100:103]
v_mfma_f32_16x16x32_bf16 v[100:103],a[132:135],a[76:79],v[100:103]
ds_read_b64_tr_b16 a[134:135],v5 offset:18432
v_mfma_f32_16x16x32_bf16 v[100:103],a[128:131],a[72:75],v[100:103]
s_waitcnt lgkmcnt(1)
ds_read_b64_tr_b16 a[130:131],v4 offset:18432
ds_read_b64_tr_b16 a[128:129],v4 offset:12288
ds_read_b64_tr_b16 a[132:133],v5 offset:12288
v_mfma_f32_16x16x32_bf16 v[160:163],a[120:123],v[44:47],v[160:163]
s_add_u32 m0,s29,0
ds_read_b64_tr_b16 a[136:137],v2 offset:12416
v_fma_f32 v82,v82,s36,v14
v_mfma_f32_16x16x32_bf16 v[164:167],a[124:127],v[44:47],v[164:167]
ds_read_b64_tr_b16 a[138:139],v2 offset:18560
v_fma_f32 v83,v83,s36,v14
v_mfma_f32_16x16x32_bf16 v[212:215],a[124:127],v[48:51],v[212:215]
ds_read_b64_tr_b16 a[140:141],v3 offset:12416
v_fma_f32 v88,v88,s36,v15
v_mfma_f32_16x16x32_bf16 v[208:211],a[120:123],v[48:51],v[208:211]
ds_read_b64_tr_b16 a[142:143],v3 offset:18560
v_fma_f32 v89,v89,s36,v15
v_mfma_f32_16x16x32_bf16 v[112:115],a[120:123],v[52:55],v[112:115]
ds_read_b64_tr_b16 a[144:145],v4 offset:12416
v_fma_f32 v90,v90,s36,v15
v_mfma_f32_16x16x32_bf16 v[116:119],a[124:127],v[52:55],v[116:119]
ds_read_b64_tr_b16 a[146:147],v4 offset:18560
v_fma_f32 v91,v91,s36,v15
v_mfma_f32_16x16x32_bf16 a[164:167],a[124:127],v[56:59],a[164:167]
buffer_load_dwordx4 v6,s[12:15],s28 offen offset:0 nt lds
v_mfma_f32_16x16x32_bf16 a[160:163],a[120:123],v[56:59],a[160:163]
s_waitcnt lgkmcnt(5)
ds_read_b64_tr_b16 a[148:149],v5 offset:12416
v_fma_f32 v96,v96,s36,v16
v_mfma_f32_16x16x32_bf16 a[168:171],a[128:131],v[56:59],a[168:171]
ds_read_b64_tr_b16 a[150:151],v5 offset:18560
v_fma_f32 v97,v97,s36,v16
v_mfma_f32_16x16x32_bf16 a[172:175],a[132:135],v[56:59],a[172:175]
ds_read_b64_tr_b16 a[120:121],v2 offset:12544
v_fma_f32 v98,v98,s36,v16
v_mfma_f32_16x16x32_bf16 v[124:127],a[132:135],v[52:55],v[124:127]
ds_read_b64_tr_b16 a[122:123],v2 offset:18688
v_fma_f32 v99,v99,s36,v16
v_mfma_f32_16x16x32_bf16 v[120:123],a[128:131],v[52:55],v[120:123]
ds_read_b64_tr_b16 a[124:125],v3 offset:12544
v_fma_f32 v76,v76,s36,v13
v_mfma_f32_16x16x32_bf16 v[216:219],a[128:131],v[48:51],v[216:219]
ds_read_b64_tr_b16 a[126:127],v3 offset:18688
v_fma_f32 v77,v77,s36,v13
v_mfma_f32_16x16x32_bf16 v[220:223],a[132:135],v[48:51],v[220:223]
buffer_load_dwordx4 v7,s[12:15],s28 offen offset:1024 nt lds
v_mfma_f32_16x16x32_bf16 v[172:175],a[132:135],v[44:47],v[172:175]
ds_read_b64_tr_b16 a[132:133],v5 offset:12544
v_fma_f32 v78,v78,s36,v13
v_mfma_f32_16x16x32_bf16 v[168:171],a[128:131],v[44:47],v[168:171]
s_waitcnt lgkmcnt(5)
ds_read_b64_tr_b16 a[128:129],v4 offset:12544
v_fma_f32 v79,v79,s36,v13
v_mfma_f32_16x16x32_bf16 v[176:179],a[136:139],v[44:47],v[176:179]
ds_read_b64_tr_b16 a[130:131],v4 offset:18688
v_fma_f32 v84,v84,s36,v14
v_mfma_f32_16x16x32_bf16 v[180:183],a[140:143],v[44:47],v[180:183]
ds_read_b64_tr_b16 a[134:135],v5 offset:18688
v_fma_f32 v85,v85,s36,v14
v_mfma_f32_16x16x32_bf16 v[228:231],a[140:143],v[48:51],v[228:231]
v_exp_f32 v82,v82
v_mfma_f32_16x16x32_bf16 v[224:227],a[136:139],v[48:51],v[224:227]
v_exp_f32 v83,v83
v_mfma_f32_16x16x32_bf16 v[128:131],a[136:139],v[52:55],v[128:131]
v_cvt_pk_bf16_f32 v25,v82,v83
v_fma_f32 v86,v86,s36,v14
v_mfma_f32_16x16x32_bf16 v[132:135],a[140:143],v[52:55],v[132:135]
buffer_load_dwordx4 v8,s[12:15],s28 offen offset:2048 nt lds
v_mfma_f32_16x16x32_bf16 a[180:183],a[140:143],v[56:59],a[180:183]
s_add_u32 s28,s28,3072
v_exp_f32 v88,v88
v_mfma_f32_16x16x32_bf16 a[176:179],a[136:139],v[56:59],a[176:179]
s_add_u32 s29,s29,3072
v_exp_f32 v89,v89
v_mfma_f32_16x16x32_bf16 a[184:187],a[144:147],v[56:59],a[184:187]
s_cmp_eq_u32 s38,1
v_exp_f32 v90,v90
v_mfma_f32_16x16x32_bf16 a[188:191],a[148:151],v[56:59],a[188:191]
s_cselect_b32 s21,s26,s21
v_exp_f32 v91,v91
v_mfma_f32_16x16x32_bf16 v[140:143],a[148:151],v[52:55],v[140:143]
s_add_u32 m0,s23,12288
v_cvt_pk_bf16_f32 v28,v88,v89
v_cvt_pk_bf16_f32 v29,v90,v91
v_mfma_f32_16x16x32_bf16 v[136:139],a[144:147],v[52:55],v[136:139]
v_exp_f32 v96,v96
v_mfma_f32_16x16x32_bf16 v[232:235],a[144:147],v[48:51],v[232:235]
v_exp_f32 v97,v97
v_mfma_f32_16x16x32_bf16 v[236:239],a[148:151],v[48:51],v[236:239]
v_exp_f32 v98,v98
v_mfma_f32_16x16x32_bf16 v[188:191],a[148:151],v[44:47],v[188:191]
v_exp_f32 v99,v99
v_mfma_f32_16x16x32_bf16 v[184:187],a[144:147],v[44:47],v[184:187]
s_waitcnt lgkmcnt(0)
v_cvt_pk_bf16_f32 v32,v96,v97
v_cvt_pk_bf16_f32 v33,v98,v99
v_mfma_f32_16x16x32_bf16 v[192:195],a[120:123],v[44:47],v[192:195]
s_waitcnt vmcnt(12)
v_exp_f32 v76,v76
v_mfma_f32_16x16x32_bf16 v[196:199],a[124:127],v[44:47],v[196:199]
s_barrier
v_mfma_f32_16x16x32_bf16 v[244:247],a[124:127],v[48:51],v[244:247]
ds_read_b128 a[148:151],v1 offset:128
v_fma_f32 v87,v87,s36,v14
v_mfma_f32_16x16x32_bf16 v[240:243],a[120:123],v[48:51],v[240:243]
ds_read_b128 a[144:147],v0 offset:128
v_fma_f32 v92,v92,s36,v15
v_mfma_f32_16x16x32_bf16 v[144:147],a[120:123],v[52:55],v[144:147]
ds_read_b128 a[140:143],v1 offset:0
v_fma_f32 v93,v93,s36,v15
v_mfma_f32_16x16x32_bf16 v[148:151],a[124:127],v[52:55],v[148:151]
ds_read_b128 a[136:139],v0 offset:0
v_fma_f32 v94,v94,s36,v15
v_mfma_f32_16x16x32_bf16 a[196:199],a[124:127],v[56:59],a[196:199]
ds_read_b128 a[124:127],v1 offset:256
v_fma_f32 v95,v95,s36,v15
v_mfma_f32_16x16x32_bf16 a[192:195],a[120:123],v[56:59],a[192:195]
buffer_load_dwordx4 v6,s[8:11],s21 offen offset:0 lds
v_mfma_f32_16x16x32_bf16 a[200:203],a[128:131],v[56:59],a[200:203]
ds_read_b128 a[120:123],v0 offset:256
v_fma_f32 v100,v100,s36,v16
v_mfma_f32_16x16x32_bf16 a[204:207],a[132:135],v[56:59],a[204:207]
v_exp_f32 v77,v77
v_mfma_f32_16x16x32_bf16 v[156:159],a[132:135],v[52:55],v[156:159]
v_exp_f32 v78,v78
v_mfma_f32_16x16x32_bf16 v[152:155],a[128:131],v[52:55],v[152:155]
v_exp_f32 v79,v79
v_mfma_f32_16x16x32_bf16 v[248:251],a[128:131],v[48:51],v[248:251]
v_cvt_pk_bf16_f32 v22,v76,v77
v_cvt_pk_bf16_f32 v23,v78,v79
v_mfma_f32_16x16x32_bf16 v[252:255],a[132:135],v[48:51],v[252:255]
v_exp_f32 v84,v84
v_mfma_f32_16x16x32_bf16 v[204:207],a[132:135],v[44:47],v[204:207]
ds_read_b128 a[132:135],v1 offset:6144
v_fma_f32 v101,v101,s36,v16
v_mfma_f32_16x16x32_bf16 v[200:203],a[128:131],v[44:47],v[200:203]
s_waitcnt lgkmcnt(1)
ds_read_b128 a[128:131],v0 offset:6144
v_fma_f32 v102,v102,s36,v16
v_mfma_f32_16x16x32_bf16 v[72:75],a[124:127],a[20:23],0
buffer_load_dwordx4 v7,s[8:11],s21 offen offset:1024 lds
v_mfma_f32_16x16x32_bf16 v[72:75],a[120:123],a[16:19],v[72:75]
v_exp_f32 v85,v85
v_mfma_f32_16x16x32_bf16 v[72:75],a[148:151],a[12:15],v[72:75]
v_exp_f32 v86,v86
v_mfma_f32_16x16x32_bf16 v[72:75],a[144:147],a[8:11],v[72:75]
v_exp_f32 v87,v87
v_mfma_f32_16x16x32_bf16 v[72:75],a[140:143],a[4:7],v[72:75]
v_cvt_pk_bf16_f32 v26,v84,v85
v_cvt_pk_bf16_f32 v27,v86,v87
v_mfma_f32_16x16x32_bf16 v[72:75],a[136:139],a[0:3],v[72:75]
v_exp_f32 v92,v92
v_smfmac_f32_16x16x64_bf16 v[60:63],a[152:155],v[20:27],v18
v_fma_f32 v103,v103,s36,v16
v_mfma_f32_16x16x32_bf16 v[80:83],a[136:139],a[24:27],0
v_exp_f32 v93,v93
v_mfma_f32_16x16x32_bf16 v[80:83],a[140:143],a[28:31],v[80:83]
buffer_load_dwordx4 v8,s[8:11],s21 offen offset:2048 lds
v_mfma_f32_16x16x32_bf16 v[80:83],a[144:147],a[32:35],v[80:83]
s_add_u32 s21,s21,12288
v_exp_f32 v94,v94
v_mfma_f32_16x16x32_bf16 v[80:83],a[148:151],a[36:39],v[80:83]
s_add_u32 m0,s22,24576
v_exp_f32 v95,v95
v_mfma_f32_16x16x32_bf16 v[80:83],a[120:123],a[40:43],v[80:83]
v_cvt_pk_bf16_f32 v30,v92,v93
v_cvt_pk_bf16_f32 v31,v94,v95
v_mfma_f32_16x16x32_bf16 v[80:83],a[124:127],a[44:47],v[80:83]
v_exp_f32 v100,v100
v_mfma_f32_16x16x32_bf16 v[88:91],a[124:127],a[68:71],0
v_exp_f32 v101,v101
v_mfma_f32_16x16x32_bf16 v[88:91],a[120:123],a[64:67],v[88:91]
v_exp_f32 v102,v102
v_mfma_f32_16x16x32_bf16 v[88:91],a[148:151],a[60:63],v[88:91]
v_exp_f32 v103,v103
v_mfma_f32_16x16x32_bf16 v[88:91],a[144:147],a[56:59],v[88:91]
v_cvt_pk_bf16_f32 v34,v100,v101
v_cvt_pk_bf16_f32 v35,v102,v103
v_mfma_f32_16x16x32_bf16 v[88:91],a[140:143],a[52:55],v[88:91]
buffer_load_dwordx4 v6,s[4:7],s20 offen offset:0 lds
v_smfmac_f32_16x16x64_bf16 v[64:67],a[152:155],v[28:35],v18
v_fma_f32 v72,v72,s36,v13
v_mfma_f32_16x16x32_bf16 v[88:91],a[136:139],a[48:51],v[88:91]
v_fma_f32 v73,v73,s36,v13
v_fma_f32 v74,v74,s36,v13
v_mfma_f32_16x16x32_bf16 v[96:99],a[136:139],a[72:75],0
ds_read_b128 a[136:139],v0 offset:6272
v_fma_f32 v75,v75,s36,v13
v_mfma_f32_16x16x32_bf16 v[96:99],a[140:143],a[76:79],v[96:99]
ds_read_b128 a[140:143],v1 offset:6272
v_fma_f32 v80,v80,s36,v14
v_mfma_f32_16x16x32_bf16 v[96:99],a[144:147],a[80:83],v[96:99]
ds_read_b128 a[144:147],v0 offset:6400
v_fma_f32 v81,v81,s36,v14
v_mfma_f32_16x16x32_bf16 v[96:99],a[148:151],a[84:87],v[96:99]
ds_read_b128 a[148:151],v1 offset:6400
v_add_u32 v10,9216,v10
v_mfma_f32_16x16x32_bf16 v[96:99],a[120:123],a[88:91],v[96:99]
v_exp_f32 v72,v72
v_mfma_f32_16x16x32_bf16 v[96:99],a[124:127],a[92:95],v[96:99]
s_waitcnt lgkmcnt(4)
v_exp_f32 v73,v73
v_mfma_f32_16x16x32_bf16 v[76:79],a[128:131],a[0:3],0
buffer_load_dwordx4 v7,s[4:7],s20 offen offset:1024 lds
v_mfma_f32_16x16x32_bf16 v[76:79],a[132:135],a[4:7],v[76:79]
s_waitcnt lgkmcnt(3)
v_exp_f32 v74,v74
v_mfma_f32_16x16x32_bf16 v[76:79],a[136:139],a[8:11],v[76:79]
s_waitcnt lgkmcnt(2)
v_exp_f32 v75,v75
v_mfma_f32_16x16x32_bf16 v[76:79],a[140:143],a[12:15],v[76:79]
s_waitcnt lgkmcnt(0)
v_exp_f32 v80,v80
v_mfma_f32_16x16x32_bf16 v[76:79],a[144:147],a[16:19],v[76:79]
v_exp_f32 v81,v81
v_mfma_f32_16x16x32_bf16 v[76:79],a[148:151],a[20:23],v[76:79]
v_cvt_pk_bf16_f32 v44,v72,v73
v_cvt_pk_bf16_f32 v45,v74,v75
v_mfma_f32_16x16x32_bf16 v[84:87],a[148:151],a[44:47],0
v_cvt_pk_bf16_f32 v48,v80,v81
v_mfma_f32_16x16x32_bf16 v[84:87],a[144:147],a[40:43],v[84:87]
v_mfma_f32_16x16x32_bf16 v[84:87],a[140:143],a[36:39],v[84:87]
v_mfma_f32_16x16x32_bf16 v[84:87],a[136:139],a[32:35],v[84:87]
buffer_load_dwordx4 v8,s[4:7],s20 offen offset:2048 lds
v_mfma_f32_16x16x32_bf16 v[84:87],a[132:135],a[28:31],v[84:87]
s_add_u32 s20,s20,12288
s_add_u32 s38,s38,1
s_cmp_lt_u32 s38,2
v_mfma_f32_16x16x32_bf16 v[84:87],a[128:131],a[24:27],v[84:87]
ds_read_b64_tr_b16 a[120:121],v2 offset:24576
v_mfma_f32_16x16x32_bf16 v[92:95],a[128:131],a[48:51],0
ds_read_b64_tr_b16 a[122:123],v2 offset:30720
v_mfma_f32_16x16x32_bf16 v[92:95],a[132:135],a[52:55],v[92:95]
ds_read_b64_tr_b16 a[124:125],v3 offset:24576
v_mfma_f32_16x16x32_bf16 v[92:95],a[136:139],a[56:59],v[92:95]
ds_read_b64_tr_b16 a[126:127],v3 offset:30720
v_mfma_f32_16x16x32_bf16 v[92:95],a[140:143],a[60:63],v[92:95]
v_mfma_f32_16x16x32_bf16 v[92:95],a[144:147],a[64:67],v[92:95]
v_mfma_f32_16x16x32_bf16 v[92:95],a[148:151],a[68:71],v[92:95]
v_mfma_f32_16x16x32_bf16 v[100:103],a[148:151],a[92:95],0
v_mfma_f32_16x16x32_bf16 v[100:103],a[144:147],a[88:91],v[100:103]
v_mfma_f32_16x16x32_bf16 v[100:103],a[140:143],a[84:87],v[100:103]
v_mfma_f32_16x16x32_bf16 v[100:103],a[136:139],a[80:83],v[100:103]
v_mfma_f32_16x16x32_bf16 v[100:103],a[132:135],a[76:79],v[100:103]
ds_read_b64_tr_b16 a[132:133],v5 offset:24576
v_mfma_f32_16x16x32_bf16 v[100:103],a[128:131],a[72:75],v[100:103]
ds_read_b64_tr_b16 a[128:129],v4 offset:24576
ds_read_b64_tr_b16 a[130:131],v4 offset:30720
ds_read_b64_tr_b16 a[134:135],v5 offset:30720
s_cbranch_scc1 L_loop4w0
s_cmp_ge_u32 s69,6
s_cbranch_scc1 L_end4
s_cmp_eq_u32 s40,0
s_cbranch_scc1 L_tr44
s_branch L_tr45
L_tr45:
s_waitcnt vmcnt(43)
s_waitcnt lgkmcnt(3)
v_mfma_f32_16x16x32_bf16 v[160:163],a[120:123],v[20:23],v[160:163]
s_add_u32 m0,s24,0
ds_read_b128 a[4:7],v12 offset:0
v_fma_f32 v79,v79,s36,v13
v_mfma_f32_16x16x32_bf16 v[164:167],a[124:127],v[20:23],v[164:167]
ds_read_b128 a[12:15],v12 offset:128
v_fma_f32 v100,v100,s36,v16
v_mfma_f32_16x16x32_bf16 v[212:215],a[124:127],v[24:27],v[212:215]
ds_read_b128 a[20:23],v12 offset:256
v_fma_f32 v101,v101,s36,v16
v_mfma_f32_16x16x32_bf16 v[208:211],a[120:123],v[24:27],v[208:211]
ds_read_b128 a[8:11],v11 offset:128
v_fma_f32 v89,v89,s36,v15
v_mfma_f32_16x16x32_bf16 v[112:115],a[120:123],v[28:31],v[112:115]
ds_read_b128 a[0:3],v11 offset:0
v_fma_f32 v76,v76,s36,v13
v_mfma_f32_16x16x32_bf16 v[116:119],a[124:127],v[28:31],v[116:119]
ds_read_b128 a[16:19],v11 offset:256
v_fma_f32 v83,v83,s36,v14
v_mfma_f32_16x16x32_bf16 a[164:167],a[124:127],v[32:35],a[164:167]
ds_read_b64_tr_b16 a[138:139],v2 offset:30848
v_fma_f32 v90,v90,s36,v15
v_mfma_f32_16x16x32_bf16 a[160:163],a[120:123],v[32:35],a[160:163]
s_waitcnt lgkmcnt(6)
ds_read_b64_tr_b16 a[136:137],v2 offset:24704
v_fma_f32 v88,v88,s36,v15
v_mfma_f32_16x16x32_bf16 a[168:171],a[128:131],v[32:35],a[168:171]
ds_read_b64_tr_b16 a[142:143],v3 offset:30848
ds_read_b64_tr_b16 a[140:141],v3 offset:24704
ds_read_b64_tr_b16 a[146:147],v4 offset:30848
ds_read_b64_tr_b16 a[144:145],v4 offset:24704
ds_read_b64_tr_b16 a[150:151],v5 offset:30848
ds_read_b64_tr_b16 a[148:149],v5 offset:24704
ds_read_b128 a[32:35],v11 offset:6272
v_mfma_f32_16x16x32_bf16 a[172:175],a[132:135],v[32:35],a[172:175]
v_fma_f32 v91,v91,s36,v15
ds_read_b128 a[40:43],v11 offset:6400
v_mfma_f32_16x16x32_bf16 v[124:127],a[132:135],v[28:31],v[124:127]
s_waitcnt lgkmcnt(10)
buffer_load_dwordx4 v6,s[12:15],s28 offen offset:0 nt lds
v_mfma_f32_16x16x32_bf16 v[120:123],a[128:131],v[28:31],v[120:123]
ds_read_b64_tr_b16 a[122:123],v2 offset:30976
ds_read_b64_tr_b16 a[120:121],v2 offset:24832
ds_read_b64_tr_b16 a[124:125],v3 offset:24832
ds_read_b64_tr_b16 a[126:127],v3 offset:30976
ds_read_b128 a[44:47],v12 offset:6400
v_mfma_f32_16x16x32_bf16 v[216:219],a[128:131],v[24:27],v[216:219]
v_fma_f32 v93,v93,s36,v15
ds_read_b128 a[28:31],v12 offset:6144
v_mfma_f32_16x16x32_bf16 v[220:223],a[132:135],v[24:27],v[220:223]
v_fma_f32 v98,v98,s36,v16
ds_read_b128 a[36:39],v12 offset:6272
v_mfma_f32_16x16x32_bf16 v[172:175],a[132:135],v[20:23],v[172:175]
buffer_load_dwordx4 v7,s[12:15],s28 offen offset:1024 nt lds
v_mfma_f32_16x16x32_bf16 v[168:171],a[128:131],v[20:23],v[168:171]
s_waitcnt lgkmcnt(7)
ds_read_b64_tr_b16 a[130:131],v4 offset:30976
ds_read_b128 a[24:27],v11 offset:6144
v_mfma_f32_16x16x32_bf16 v[176:179],a[136:139],v[20:23],v[176:179]
v_fma_f32 v82,v82,s36,v14
v_exp_f32 v93,v93
v_mfma_f32_16x16x32_bf16 v[180:183],a[140:143],v[20:23],v[180:183]
ds_read_b64_tr_b16 a[128:129],v4 offset:24832
v_fma_f32 v85,v85,s36,v14
v_mfma_f32_16x16x32_bf16 v[228:231],a[140:143],v[24:27],v[228:231]
ds_read_b64_tr_b16 a[134:135],v5 offset:30976
v_exp_f32 v82,v82
v_mfma_f32_16x16x32_bf16 v[224:227],a[136:139],v[24:27],v[224:227]
ds_read_b64_tr_b16 a[132:133],v5 offset:24832
v_fma_f32 v84,v84,s36,v14
v_mfma_f32_16x16x32_bf16 v[128:131],a[136:139],v[28:31],v[128:131]
v_exp_f32 v84,v84
v_mfma_f32_16x16x32_bf16 v[132:135],a[140:143],v[28:31],v[132:135]
buffer_load_dwordx4 v8,s[12:15],s28 offen offset:2048 nt lds
v_mfma_f32_16x16x32_bf16 a[180:183],a[140:143],v[32:35],a[180:183]
s_add_u32 s28,s28,3072
v_fma_f32 v103,v103,s36,v16
v_exp_f32 v103,v103
v_mfma_f32_16x16x32_bf16 a[176:179],a[136:139],v[32:35],a[176:179]
s_add_u32 m0,s24,3072
v_fma_f32 v87,v87,s36,v14
v_exp_f32 v87,v87
v_mfma_f32_16x16x32_bf16 a[184:187],a[144:147],v[32:35],a[184:187]
v_fma_f32 v77,v77,s36,v13
v_exp_f32 v77,v77
v_mfma_f32_16x16x32_bf16 a[188:191],a[148:151],v[32:35],a[188:191]
v_fma_f32 v97,v97,s36,v16
v_exp_f32 v91,v91
v_mfma_f32_16x16x32_bf16 v[140:143],a[148:151],v[28:31],v[140:143]
v_fma_f32 v102,v102,s36,v16
v_exp_f32 v85,v85
v_mfma_f32_16x16x32_bf16 v[136:139],a[144:147],v[28:31],v[136:139]
v_exp_f32 v89,v89
v_mfma_f32_16x16x32_bf16 v[232:235],a[144:147],v[24:27],v[232:235]
buffer_load_dwordx4 v6,s[12:15],s28 offen offset:0 nt lds
v_mfma_f32_16x16x32_bf16 v[236:239],a[148:151],v[24:27],v[236:239]
v_fma_f32 v92,v92,s36,v15
v_exp_f32 v101,v101
v_mfma_f32_16x16x32_bf16 v[188:191],a[148:151],v[20:23],v[188:191]
v_fma_f32 v94,v94,s36,v15
v_fma_f32 v95,v95,s36,v15
v_mfma_f32_16x16x32_bf16 v[184:187],a[144:147],v[20:23],v[184:187]
s_waitcnt lgkmcnt(0)
v_exp_f32 v95,v95
v_mfma_f32_16x16x32_bf16 v[192:195],a[120:123],v[20:23],v[192:195]
v_fma_f32 v86,v86,s36,v14
v_fma_f32 v78,v78,s36,v13
v_mfma_f32_16x16x32_bf16 v[196:199],a[124:127],v[20:23],v[196:199]
v_exp_f32 v92,v92
v_mfma_f32_16x16x32_bf16 v[244:247],a[124:127],v[24:27],v[244:247]
v_exp_f32 v78,v78
v_mfma_f32_16x16x32_bf16 v[240:243],a[120:123],v[24:27],v[240:243]
buffer_load_dwordx4 v7,s[12:15],s28 offen offset:1024 nt lds
v_mfma_f32_16x16x32_bf16 v[144:147],a[120:123],v[28:31],v[144:147]
v_exp_f32 v94,v94
v_mfma_f32_16x16x32_bf16 v[148:151],a[124:127],v[28:31],v[148:151]
v_exp_f32 v90,v90
v_mfma_f32_16x16x32_bf16 a[196:199],a[124:127],v[32:35],a[196:199]
v_fma_f32 v96,v96,s36,v16
v_exp_f32 v96,v96
v_mfma_f32_16x16x32_bf16 a[192:195],a[120:123],v[32:35],a[192:195]
v_fma_f32 v99,v99,s36,v16
v_exp_f32 v83,v83
v_mfma_f32_16x16x32_bf16 a[200:203],a[128:131],v[32:35],a[200:203]
v_exp_f32 v97,v97
v_mfma_f32_16x16x32_bf16 a[204:207],a[132:135],v[32:35],a[204:207]
v_exp_f32 v88,v88
v_mfma_f32_16x16x32_bf16 v[156:159],a[132:135],v[28:31],v[156:159]
v_exp_f32 v98,v98
v_mfma_f32_16x16x32_bf16 v[152:155],a[128:131],v[28:31],v[152:155]
buffer_load_dwordx4 v8,s[12:15],s28 offen offset:2048 nt lds
s_waitcnt vmcnt(20)
s_barrier
v_mfma_f32_16x16x32_bf16 v[248:251],a[128:131],v[24:27],v[248:251]
s_add_u32 s28,s28,3072
ds_read_b64_tr_b16 a[138:139],v2 offset:6144
v_exp_f32 v79,v79
v_mfma_f32_16x16x32_bf16 v[252:255],a[132:135],v[24:27],v[252:255]
s_add_u32 m0,s22,0
ds_read_b64_tr_b16 a[136:137],v2 offset:0
buffer_load_dwordx4 v6,s[4:7],s25 offen offset:0 lds
v_mfma_f32_16x16x32_bf16 v[204:207],a[132:135],v[20:23],v[204:207]
buffer_load_dwordx4 v7,s[4:7],s25 offen offset:1024 lds
v_mfma_f32_16x16x32_bf16 v[200:203],a[128:131],v[20:23],v[200:203]
buffer_load_dwordx4 v8,s[4:7],s25 offen offset:2048 lds
ds_read_b64_tr_b16 a[142:143],v3 offset:6144
ds_read_b64_tr_b16 a[140:141],v3 offset:0
ds_read_b64_tr_b16 a[144:145],v4 offset:0
ds_read_b64_tr_b16 a[146:147],v4 offset:6144
ds_read_b64_tr_b16 a[148:149],v5 offset:0
ds_read_b64_tr_b16 a[150:151],v5 offset:6144
v_exp_f32 v100,v100
v_cvt_pk_bf16_f32 v47,v78,v79
v_cvt_pk_bf16_f32 v49,v82,v83
v_exp_f32 v76,v76
v_exp_f32 v102,v102
v_exp_f32 v86,v86
v_cvt_pk_bf16_f32 v59,v102,v103
v_exp_f32 v99,v99
v_cvt_pk_bf16_f32 v50,v84,v85
v_cvt_pk_bf16_f32 v57,v98,v99
v_cvt_pk_bf16_f32 v55,v94,v95
v_cvt_pk_bf16_f32 v54,v92,v93
v_cvt_pk_bf16_f32 v58,v100,v101
v_cvt_pk_bf16_f32 v51,v86,v87
v_cvt_pk_bf16_f32 v53,v90,v91
v_cvt_pk_bf16_f32 v46,v76,v77
v_cvt_pk_bf16_f32 v52,v88,v89
v_cvt_pk_bf16_f32 v56,v96,v97
v_smfmac_f32_16x16x64_bf16 v[60:63],a[152:155],v[44:51],v18
v_subrev_u32 v10,18432,v10
v_smfmac_f32_16x16x64_bf16 v[64:67],a[152:155],v[52:59],v18
s_waitcnt lgkmcnt(0)
v_mfma_f32_16x16x32_bf16 v[160:163],a[136:139],v[44:47],v[160:163]
s_add_u32 s87,s42,18432
ds_read_b64_tr_b16 a[122:123],v2 offset:6272
v_mbcnt_lo_u32_b32 v39,-1,0
v_mfma_f32_16x16x32_bf16 v[164:167],a[140:143],v[44:47],v[164:167]
ds_read_b64_tr_b16 a[120:121],v2 offset:128
v_mbcnt_hi_u32_b32 v39,-1,v39
v_mfma_f32_16x16x32_bf16 v[212:215],a[140:143],v[48:51],v[212:215]
ds_read_b64_tr_b16 a[124:125],v3 offset:128
v_and_b32 v38,7,v39
v_mfma_f32_16x16x32_bf16 v[208:211],a[136:139],v[48:51],v[208:211]
ds_read_b64_tr_b16 a[126:127],v3 offset:6272
v_add_f32 v64,v64,v65
v_mfma_f32_16x16x32_bf16 v[112:115],a[136:139],v[52:55],v[112:115]
ds_read_b64_tr_b16 a[130:131],v4 offset:6272
v_add_f32 v60,v60,v61
v_mfma_f32_16x16x32_bf16 v[116:119],a[140:143],v[52:55],v[116:119]
ds_read_b64_tr_b16 a[128:129],v4 offset:128
v_add_f32 v62,v62,v63
v_mfma_f32_16x16x32_bf16 a[164:167],a[140:143],v[56:59],a[164:167]
ds_read_b64_tr_b16 a[134:135],v5 offset:6272
v_max3_f32 v19,v60,v62,v64
v_mfma_f32_16x16x32_bf16 a[160:163],a[136:139],v[56:59],a[160:163]
ds_read_b64_tr_b16 a[132:133],v5 offset:128
v_add_f32 v66,v66,v67
v_mfma_f32_16x16x32_bf16 a[168:171],a[144:147],v[56:59],a[168:171]
ds_read_b64_tr_b16 a[138:139],v2 offset:6400
v_max_f32 v19,v19,v66
v_mfma_f32_16x16x32_bf16 a[172:175],a[148:151],v[56:59],a[172:175]
ds_read_b64_tr_b16 a[136:137],v2 offset:256
v_accvgpr_read_b32 v80,a164
v_mfma_f32_16x16x32_bf16 v[124:127],a[148:151],v[52:55],v[124:127]
ds_read_b64_tr_b16 a[140:141],v3 offset:256
v_accvgpr_read_b32 v75,a163
v_mfma_f32_16x16x32_bf16 v[120:123],a[144:147],v[52:55],v[120:123]
ds_read_b64_tr_b16 a[142:143],v3 offset:6400
v_accvgpr_read_b32 v81,a165
v_mfma_f32_16x16x32_bf16 v[216:219],a[144:147],v[48:51],v[216:219]
v_accvgpr_read_b32 v72,a160
v_accvgpr_read_b32 v83,a167
v_mfma_f32_16x16x32_bf16 v[220:223],a[148:151],v[48:51],v[220:223]
v_rcp_f32 v66,v66
v_mfma_f32_16x16x32_bf16 v[172:175],a[148:151],v[44:47],v[172:175]
ds_read_b64_tr_b16 a[150:151],v5 offset:6400
v_accvgpr_read_b32 v74,a162
v_mfma_f32_16x16x32_bf16 v[168:171],a[144:147],v[44:47],v[168:171]
s_waitcnt lgkmcnt(4)
ds_read_b64_tr_b16 a[146:147],v4 offset:6400
v_accvgpr_read_b32 v73,a161
v_mfma_f32_16x16x32_bf16 v[176:179],a[120:123],v[44:47],v[176:179]
ds_read_b64_tr_b16 a[144:145],v4 offset:256
v_accvgpr_read_b32 v82,a166
v_mfma_f32_16x16x32_bf16 v[180:183],a[124:127],v[44:47],v[180:183]
ds_read_b64_tr_b16 a[148:149],v5 offset:256
v_accvgpr_read_b32 v89,a169
v_mfma_f32_16x16x32_bf16 v[228:231],a[124:127],v[48:51],v[228:231]
v_accvgpr_read_b32 v90,a170
v_accvgpr_read_b32 v88,a168
v_mfma_f32_16x16x32_bf16 v[224:227],a[120:123],v[48:51],v[224:227]
v_accvgpr_read_b32 v91,a171
v_accvgpr_read_b32 v98,a174
v_mfma_f32_16x16x32_bf16 v[128:131],a[120:123],v[52:55],v[128:131]
v_accvgpr_read_b32 v97,a173
v_accvgpr_read_b32 v96,a172
v_mfma_f32_16x16x32_bf16 v[132:135],a[124:127],v[52:55],v[132:135]
v_accvgpr_read_b32 v99,a175
v_cmp_ngt_f32 vcc,s37,v19
v_mfma_f32_16x16x32_bf16 a[180:183],a[124:127],v[56:59],a[180:183]
v_lshrrev_b32 v19,5,v39
v_xor_b32 v38,v38,v19
v_mfma_f32_16x16x32_bf16 a[176:179],a[120:123],v[56:59],a[176:179]
s_cmp_lg_u64 vcc,0
v_and_b32 v19,15,v39
v_lshl_add_u32 v19,v19,7,s24
v_mfma_f32_16x16x32_bf16 a[184:187],a[128:131],v[56:59],a[184:187]
s_cselect_b32 s62,s32,0
v_lshl_add_u32 v19,v38,4,v19
v_bfe_u32 v38,v39,4,1
v_mfma_f32_16x16x32_bf16 a[188:191],a[132:135],v[56:59],a[188:191]
s_or_b32 s31,s31,s62
v_lshl_add_u32 v36,v38,3,v19
v_xor_b32 v38,64,v36
v_mfma_f32_16x16x32_bf16 v[140:143],a[132:135],v[52:55],v[140:143]
s_lshl_b32 s32,s32,1
v_xor_b32 v37,32,v36
v_bfe_u32 v19,v39,3,1
v_xor_b32 v39,96,v36
v_lshlrev_b32 v19,11,v19
v_accvgpr_read_b32 v86,a182
v_pk_mul_f32 v[82:83],v[82:83],v[66:67] op_sel_hi:[1,0]
v_pk_mul_f32 v[80:81],v[80:81],v[66:67] op_sel_hi:[1,0]
v_pk_mul_f32 v[74:75],v[74:75],v[66:67] op_sel_hi:[1,0]
v_pk_mul_f32 v[72:73],v[72:73],v[66:67] op_sel_hi:[1,0]
v_accvgpr_read_b32 v79,a179
v_accvgpr_read_b32 v78,a178
v_pk_mul_f32 v[78:79],v[78:79],v[66:67] op_sel_hi:[1,0]
v_accvgpr_read_b32 v77,a177
v_accvgpr_read_b32 v84,a180
v_accvgpr_read_b32 v87,a183
v_pk_mul_f32 v[86:87],v[86:87],v[66:67] op_sel_hi:[1,0]
v_accvgpr_read_b32 v85,a181
v_pk_mul_f32 v[84:85],v[84:85],v[66:67] op_sel_hi:[1,0]
v_accvgpr_read_b32 v76,a176
v_pk_mul_f32 v[76:77],v[76:77],v[66:67] op_sel_hi:[1,0]
v_accvgpr_read_b32 v94,a186
v_accvgpr_read_b32 v95,a187
v_mfma_f32_16x16x32_bf16 v[136:139],a[128:131],v[52:55],v[136:139]
s_add_u32 m0,s24,6144
v_accvgpr_read_b32 v92,a184
v_accvgpr_read_b32 v93,a185
v_accvgpr_read_b32 v103,a191
v_accvgpr_read_b32 v102,a190
buffer_load_dwordx4 v6,s[12:15],s28 offen offset:0 nt lds
buffer_load_dwordx4 v7,s[12:15],s28 offen offset:1024 nt lds
buffer_load_dwordx4 v8,s[12:15],s28 offen offset:2048 nt lds
v_pk_mul_f32 v[92:93],v[92:93],v[66:67] op_sel_hi:[1,0]
v_pk_mul_f32 v[88:89],v[88:89],v[66:67] op_sel_hi:[1,0]
v_pk_mul_f32 v[94:95],v[94:95],v[66:67] op_sel_hi:[1,0]
v_pk_mul_f32 v[90:91],v[90:91],v[66:67] op_sel_hi:[1,0]
v_accvgpr_read_b32 v101,a189
v_accvgpr_read_b32 v100,a188
v_mfma_f32_16x16x32_bf16 v[232:235],a[128:131],v[48:51],v[232:235]
s_add_u32 s28,s28,3072
v_cvt_pk_bf16_f32 v84,v84,v85
v_cvt_pk_bf16_f32 v85,v86,v87
v_cvt_pk_bf16_f32 v76,v76,v77
v_cvt_pk_bf16_f32 v77,v78,v79
v_cvt_pk_bf16_f32 v80,v80,v81
v_pk_mul_f32 v[96:97],v[96:97],v[66:67] op_sel_hi:[1,0]
v_pk_mul_f32 v[98:99],v[98:99],v[66:67] op_sel_hi:[1,0]
v_pk_mul_f32 v[100:101],v[100:101],v[66:67] op_sel_hi:[1,0]
v_pk_mul_f32 v[102:103],v[102:103],v[66:67] op_sel_hi:[1,0]
v_cvt_pk_bf16_f32 v88,v88,v89
v_cvt_pk_bf16_f32 v72,v72,v73
v_mfma_f32_16x16x32_bf16 v[236:239],a[132:135],v[48:51],v[236:239]
s_add_u32 m0,s24,9216
v_cvt_pk_bf16_f32 v89,v90,v91
v_cvt_pk_bf16_f32 v73,v74,v75
v_mfma_f32_16x16x32_bf16 v[188:191],a[132:135],v[44:47],v[188:191]
buffer_load_dwordx4 v6,s[12:15],s28 offen offset:0 nt lds
v_mfma_f32_16x16x32_bf16 v[184:187],a[128:131],v[44:47],v[184:187]
buffer_load_dwordx4 v7,s[12:15],s28 offen offset:1024 nt lds
s_waitcnt lgkmcnt(0)
v_mfma_f32_16x16x32_bf16 v[192:195],a[136:139],v[44:47],v[192:195]
buffer_load_dwordx4 v8,s[12:15],s28 offen offset:2048 nt lds
v_mfma_f32_16x16x32_bf16 v[196:199],a[140:143],v[44:47],v[196:199]
s_add_u32 s28,s28,3072
ds_write2st64_b64 v36,v[72:73],v[76:77] offset0:36 offset1:40
v_mfma_f32_16x16x32_bf16 v[244:247],a[140:143],v[48:51],v[244:247]
s_add_u32 m0,s23,0
v_cvt_pk_bf16_f32 v100,v100,v101
v_cvt_pk_bf16_f32 v81,v82,v83
v_mfma_f32_16x16x32_bf16 v[240:243],a[136:139],v[48:51],v[240:243]
v_cvt_pk_bf16_f32 v92,v92,v93
v_cvt_pk_bf16_f32 v93,v94,v95
v_mfma_f32_16x16x32_bf16 v[144:147],a[136:139],v[52:55],v[144:147]
v_cvt_pk_bf16_f32 v96,v96,v97
v_cvt_pk_bf16_f32 v101,v102,v103
v_mfma_f32_16x16x32_bf16 v[148:151],a[140:143],v[52:55],v[148:151]
ds_write2st64_b64 v37,v[80:81],v[84:85] offset0:36 offset1:40
v_mfma_f32_16x16x32_bf16 a[196:199],a[140:143],v[56:59],a[196:199]
v_cvt_pk_bf16_f32 v97,v98,v99
v_rcp_f32 v64,v64
v_mfma_f32_16x16x32_bf16 a[192:195],a[136:139],v[56:59],a[192:195]
v_rcp_f32 v60,v60
v_mfma_f32_16x16x32_bf16 a[200:203],a[144:147],v[56:59],a[200:203]
v_rcp_f32 v62,v62
v_mfma_f32_16x16x32_bf16 a[204:207],a[148:151],v[56:59],a[204:207]
ds_write2st64_b64 v38,v[88:89],v[92:93] offset0:36 offset1:40
v_mfma_f32_16x16x32_bf16 v[156:159],a[148:151],v[52:55],v[156:159]
s_waitcnt vmcnt(21)
v_accvgpr_read_b32 v86,a198
v_accvgpr_read_b32 v83,a195
v_accvgpr_read_b32 v85,a197
v_accvgpr_read_b32 v87,a199
ds_read_b128 a[48:51],v11 offset:12288
v_pk_mul_f32 v[86:87],v[86:87],v[66:67] op_sel_hi:[1,0]
ds_read_b128 a[52:55],v12 offset:12288
v_accvgpr_read_b32 v81,a193
ds_read_b128 a[56:59],v11 offset:12416
v_accvgpr_read_b32 v82,a194
ds_read_b128 a[60:63],v12 offset:12416
v_pk_mul_f32 v[82:83],v[82:83],v[66:67] op_sel_hi:[1,0]
ds_read_b128 a[64:67],v11 offset:12544
v_accvgpr_read_b32 v80,a192
ds_read_b128 a[68:71],v12 offset:12544
v_pk_mul_f32 v[80:81],v[80:81],v[66:67] op_sel_hi:[1,0]
ds_write2st64_b64 v39,v[96:97],v[100:101] offset0:36 offset1:40
v_accvgpr_read_b32 v84,a196
v_pk_mul_f32 v[84:85],v[84:85],v[66:67] op_sel_hi:[1,0]
v_accvgpr_read_b32 v90,a202
v_accvgpr_read_b32 v89,a201
v_mfma_f32_16x16x32_bf16 v[152:155],a[144:147],v[52:55],v[152:155]
ds_read_b128 v[104:107],v10 offset:18432
v_accvgpr_read_b32 v88,a200
v_accvgpr_read_b32 v91,a203
v_accvgpr_read_b32 v92,a204
v_accvgpr_read_b32 v95,a207
ds_read_b128 v[108:111],v10 offset:19456
v_pk_mul_f32 v[90:91],v[90:91],v[66:67] op_sel_hi:[1,0]
v_pk_mul_f32 v[88:89],v[88:89],v[66:67] op_sel_hi:[1,0]
v_accvgpr_read_b32 v93,a205
v_accvgpr_read_b32 v94,a206
v_mfma_f32_16x16x32_bf16 v[248:251],a[144:147],v[48:51],v[248:251]
ds_read_b128 v[72:75],v10 offset:20480
v_cvt_pk_bf16_f32 v80,v80,v81
v_cvt_pk_bf16_f32 v81,v82,v83
v_cvt_pk_bf16_f32 v84,v84,v85
v_cvt_pk_bf16_f32 v88,v88,v89
ds_read_b128 v[76:79],v10 offset:21504
v_pk_mul_f32 v[116:117],v[116:117],v[64:65] op_sel_hi:[1,0]
v_pk_mul_f32 v[130:131],v[130:131],v[64:65] op_sel_hi:[1,0]
v_pk_mul_f32 v[132:133],v[132:133],v[64:65] op_sel_hi:[1,0]
v_pk_mul_f32 v[136:137],v[136:137],v[64:65] op_sel_hi:[1,0]
ds_write_b64 v36,v[80:81] offset:18432
v_pk_mul_f32 v[92:93],v[92:93],v[66:67] op_sel_hi:[1,0]
v_pk_mul_f32 v[118:119],v[118:119],v[64:65] op_sel_hi:[1,0]
v_pk_mul_f32 v[134:135],v[134:135],v[64:65] op_sel_hi:[1,0]
s_waitcnt lgkmcnt(4)
buffer_store_dwordx4 v[104:107],v9,s[16:19],s87 offen offset:0 nt
v_pk_mul_f32 v[128:129],v[128:129],v[64:65] op_sel_hi:[1,0]
v_pk_mul_f32 v[120:121],v[120:121],v[64:65] op_sel_hi:[1,0]
v_pk_mul_f32 v[94:95],v[94:95],v[66:67] op_sel_hi:[1,0]
v_pk_mul_f32 v[122:123],v[122:123],v[64:65] op_sel_hi:[1,0]
v_pk_mul_f32 v[138:139],v[138:139],v[64:65] op_sel_hi:[1,0]
v_pk_mul_f32 v[114:115],v[114:115],v[64:65] op_sel_hi:[1,0]
v_pk_mul_f32 v[112:113],v[112:113],v[64:65] op_sel_hi:[1,0]
v_add_u32 v36,v36,v19
v_cvt_pk_bf16_f32 v92,v92,v93
v_mfma_f32_16x16x32_bf16 v[252:255],a[148:151],v[48:51],v[252:255]
v_cvt_pk_bf16_f32 v89,v90,v91
v_cvt_pk_bf16_f32 v85,v86,v87
v_mfma_f32_16x16x32_bf16 v[204:207],a[148:151],v[44:47],v[204:207]
ds_write_b64 v37,v[84:85] offset:18432
v_mfma_f32_16x16x32_bf16 v[200:203],a[144:147],v[44:47],v[200:203]
s_waitcnt lgkmcnt(1)
buffer_store_dwordx4 v[108:111],v9,s[16:19],s87 offen offset:3072 nt
v_add_u32 v37,v37,v19
v_cvt_pk_bf16_f32 v93,v94,v95
v_cvt_pk_bf16_f32 v128,v128,v129
v_cvt_pk_bf16_f32 v112,v112,v113
v_cvt_pk_bf16_f32 v113,v114,v115
v_cvt_pk_bf16_f32 v116,v116,v117
v_cvt_pk_bf16_f32 v129,v130,v131
v_cvt_pk_bf16_f32 v132,v132,v133
v_cvt_pk_bf16_f32 v136,v136,v137
v_cvt_pk_bf16_f32 v120,v120,v121
v_cvt_pk_bf16_f32 v133,v134,v135
v_cvt_pk_bf16_f32 v137,v138,v139
ds_write_b64 v38,v[88:89] offset:18432
buffer_store_dwordx4 v[72:75],v9,s[16:19],s87 offen offset:128 nt
v_add_u32 v38,v38,v19
v_cvt_pk_bf16_f32 v117,v118,v119
v_cvt_pk_bf16_f32 v121,v122,v123
v_mov_b32 v67,0
v_mov_b32 v66,0
v_mov_b32 v71,0
v_mov_b32 v70,0
v_mov_b32 v68,0
v_mov_b32 v69,0
ds_write_b64 v39,v[92:93] offset:18432
v_add_u32 v39,v39,v19
ds_read_b128 v[96:99],v10 offset:18432
buffer_store_dwordx4 v[76:79],v9,s[16:19],s87 offen offset:3200 nt
ds_read_b128 v[100:103],v10 offset:19456
s_waitcnt vmcnt(10)
s_barrier
ds_read_b128 a[120:123],v0 offset:0
ds_write2st64_b64 v36,v[112:113],v[128:129] offset0:24 offset1:26
ds_read_b128 a[124:127],v1 offset:0
ds_read_b128 a[128:131],v0 offset:128
buffer_load_dwordx4 v6,s[8:11],s25 offen offset:0 lds
ds_write2st64_b64 v37,v[116:117],v[132:133] offset0:24 offset1:26
s_waitcnt lgkmcnt(4)
v_mfma_f32_16x16x32_bf16 v[72:75],a[120:123],a[0:3],0
ds_read_b128 a[132:135],v1 offset:128
buffer_store_dwordx4 v[96:99],v9,s[16:19],s87 offen offset:256 nt
ds_read_b128 a[136:139],v0 offset:256
v_pk_mul_f32 v[126:127],v[126:127],v[64:65] op_sel_hi:[1,0]
ds_read_b128 a[140:143],v1 offset:256
v_pk_mul_f32 v[142:143],v[142:143],v[64:65] op_sel_hi:[1,0]
ds_read_b128 a[144:147],v0 offset:6144
v_pk_mul_f32 v[124:125],v[124:125],v[64:65] op_sel_hi:[1,0]
ds_read_b128 a[148:151],v1 offset:6144
buffer_store_dwordx4 v[100:103],v9,s[16:19],s87 offen offset:3328 nt
v_pk_mul_f32 v[140:141],v[140:141],v[64:65] op_sel_hi:[1,0]
v_cvt_pk_bf16_f32 v124,v124,v125
v_cvt_pk_bf16_f32 v140,v140,v141
s_waitcnt lgkmcnt(5)
v_mfma_f32_16x16x32_bf16 v[72:75],a[124:127],a[4:7],v[72:75]
v_cvt_pk_bf16_f32 v141,v142,v143
v_cvt_pk_bf16_f32 v125,v126,v127
v_mfma_f32_16x16x32_bf16 v[72:75],a[128:131],a[8:11],v[72:75]
s_waitcnt lgkmcnt(4)
v_mfma_f32_16x16x32_bf16 v[72:75],a[132:135],a[12:15],v[72:75]
buffer_load_dwordx4 v7,s[8:11],s25 offen offset:1024 lds
ds_write2st64_b64 v38,v[120:121],v[136:137] offset0:24 offset1:26
v_pk_mul_f32 v[162:163],v[162:163],v[60:61] op_sel_hi:[1,0]
v_pk_mul_f32 v[146:147],v[146:147],v[64:65] op_sel_hi:[1,0]
v_pk_mul_f32 v[144:145],v[144:145],v[64:65] op_sel_hi:[1,0]
v_pk_mul_f32 v[160:161],v[160:161],v[60:61] op_sel_hi:[1,0]
v_cvt_pk_bf16_f32 v144,v144,v145
v_cvt_pk_bf16_f32 v160,v160,v161
s_waitcnt lgkmcnt(1)
v_mfma_f32_16x16x32_bf16 v[72:75],a[136:139],a[16:19],v[72:75]
v_cvt_pk_bf16_f32 v161,v162,v163
v_cvt_pk_bf16_f32 v145,v146,v147
v_mfma_f32_16x16x32_bf16 v[72:75],a[140:143],a[20:23],v[72:75]
ds_write2st64_b64 v39,v[124:125],v[140:141] offset0:24 offset1:26
v_mfma_f32_16x16x32_bf16 v[80:83],a[140:143],a[44:47],0
v_mfma_f32_16x16x32_bf16 v[80:83],a[136:139],a[40:43],v[80:83]
buffer_load_dwordx4 v8,s[8:11],s25 offen offset:2048 lds
s_waitcnt vmcnt(18)
ds_read_b128 a[92:95],v12 offset:256
v_pk_mul_f32 v[166:167],v[166:167],v[60:61] op_sel_hi:[1,0]
v_pk_mul_f32 v[164:165],v[164:165],v[60:61] op_sel_hi:[1,0]
v_pk_mul_f32 v[150:151],v[150:151],v[64:65] op_sel_hi:[1,0]
v_pk_mul_f32 v[148:149],v[148:149],v[64:65] op_sel_hi:[1,0]
v_max3_f32 v44,v72,v73,v74
v_cvt_pk_bf16_f32 v164,v164,v165
v_mfma_f32_16x16x32_bf16 v[80:83],a[132:135],a[36:39],v[80:83]
s_mov_b32 s27,s42
ds_read_b128 a[88:91],v11 offset:256
v_cvt_pk_bf16_f32 v148,v148,v149
v_mfma_f32_16x16x32_bf16 v[80:83],a[128:131],a[32:35],v[80:83]
s_mov_b32 s42,s41
ds_read_b128 a[84:87],v12 offset:128
v_cvt_pk_bf16_f32 v165,v166,v167
v_mfma_f32_16x16x32_bf16 v[80:83],a[124:127],a[28:31],v[80:83]
s_add_u32 s69,s69,1
ds_read_b128 a[80:83],v11 offset:128
v_cvt_pk_bf16_f32 v149,v150,v151
v_mfma_f32_16x16x32_bf16 v[80:83],a[120:123],a[24:27],v[80:83]
s_lshl_b32 s62,s69,5
ds_read_b128 a[76:79],v12 offset:0
s_add_u32 s62,s62,s34
ds_read_b128 a[72:75],v11 offset:0
v_pk_mul_f32 v[170:171],v[170:171],v[60:61] op_sel_hi:[1,0]
v_pk_mul_f32 v[168:169],v[168:169],v[60:61] op_sel_hi:[1,0]
v_pk_mul_f32 v[154:155],v[154:155],v[64:65] op_sel_hi:[1,0]
v_pk_mul_f32 v[152:153],v[152:153],v[64:65] op_sel_hi:[1,0]
v_max3_f32 v48,v80,v81,v82
v_cvt_pk_bf16_f32 v152,v152,v153
v_mfma_f32_16x16x32_bf16 v[88:91],a[120:123],a[48:51],0
s_mul_i32 s63,s62,171
ds_write2st64_b64 v36,v[144:145],v[160:161] offset0:28 offset1:0
v_mfma_f32_16x16x32_bf16 v[88:91],a[124:127],a[52:55],v[88:91]
s_lshr_b32 s63,s63,9
v_cvt_pk_bf16_f32 v168,v168,v169
v_cvt_pk_bf16_f32 v169,v170,v171
v_mfma_f32_16x16x32_bf16 v[88:91],a[128:131],a[56:59],v[88:91]
s_mul_i32 s64,s63,3
v_cvt_pk_bf16_f32 v153,v154,v155
s_sub_u32 s62,s62,s64
v_mfma_f32_16x16x32_bf16 v[88:91],a[132:135],a[60:63],v[88:91]
s_add_u32 s63,s63,s33
s_mul_i32 s30,s63,196608
s_mul_i32 s41,s63,325632
s_lshl_b32 s63,s3,2
ds_write2st64_b64 v37,v[148:149],v[164:165] offset0:28 offset1:0
v_pk_mul_f32 v[174:175],v[174:175],v[60:61] op_sel_hi:[1,0]
v_pk_mul_f32 v[172:173],v[172:173],v[60:61] op_sel_hi:[1,0]
v_pk_mul_f32 v[156:157],v[156:157],v[64:65] op_sel_hi:[1,0]
v_pk_mul_f32 v[158:159],v[158:159],v[64:65] op_sel_hi:[1,0]
v_cvt_pk_bf16_f32 v172,v172,v173
v_cvt_pk_bf16_f32 v156,v156,v157
v_mfma_f32_16x16x32_bf16 v[88:91],a[136:139],a[64:67],v[88:91]
s_add_u32 s64,s63,21
v_cvt_pk_bf16_f32 v157,v158,v159
v_cvt_pk_bf16_f32 v173,v174,v175
v_mfma_f32_16x16x32_bf16 v[88:91],a[140:143],a[68:71],v[88:91]
s_cmp_eq_u32 s3,0
v_mov_b32 v65,0
v_mov_b32 v64,0
s_waitcnt lgkmcnt(1)
v_mfma_f32_16x16x32_bf16 v[96:99],a[140:143],a[92:95],0
s_cselect_b32 s64,20,s64
ds_write2st64_b64 v38,v[152:153],v[168:169] offset0:28 offset1:0
v_pk_mul_f32 v[176:177],v[176:177],v[60:61] op_sel_hi:[1,0]
v_pk_mul_f32 v[194:195],v[194:195],v[60:61] op_sel_hi:[1,0]
v_pk_mul_f32 v[192:193],v[192:193],v[60:61] op_sel_hi:[1,0]
v_pk_mul_f32 v[178:179],v[178:179],v[60:61] op_sel_hi:[1,0]
v_max3_f32 v52,v88,v89,v90
v_cvt_pk_bf16_f32 v176,v176,v177
v_mfma_f32_16x16x32_bf16 v[96:99],a[136:139],a[88:91],v[96:99]
s_cselect_b32 s40,1,0
v_cvt_pk_bf16_f32 v192,v192,v193
v_cvt_pk_bf16_f32 v177,v178,v179
v_mfma_f32_16x16x32_bf16 v[96:99],a[132:135],a[84:87],v[96:99]
s_add_u32 s65,s63,37
v_cvt_pk_bf16_f32 v193,v194,v195
s_cmp_eq_u32 s62,2
v_mfma_f32_16x16x32_bf16 v[96:99],a[128:131],a[80:83],v[96:99]
s_cselect_b32 s64,s65,s64
ds_write2st64_b64 v39,v[156:157],v[172:173] offset0:28 offset1:0
v_mfma_f32_16x16x32_bf16 v[96:99],a[124:127],a[76:79],v[96:99]
s_waitcnt vmcnt(9)
s_cselect_b32 s40,0,s40
s_add_u32 s65,s63,s3
s_cmp_eq_u32 s62,0
ds_read_b128 a[96:99],v11 offset:6144
s_cselect_b32 s64,s65,s64
ds_read_b128 a[100:103],v12 offset:6144
v_pk_mul_f32 v[198:199],v[198:199],v[60:61] op_sel_hi:[1,0]
ds_read_b128 a[104:107],v11 offset:6272
v_pk_mul_f32 v[196:197],v[196:197],v[60:61] op_sel_hi:[1,0]
ds_read_b128 a[108:111],v12 offset:6272
v_pk_mul_f32 v[180:181],v[180:181],v[60:61] op_sel_hi:[1,0]
ds_read_b128 a[112:115],v11 offset:6400
v_pk_mul_f32 v[182:183],v[182:183],v[60:61] op_sel_hi:[1,0]
v_cvt_pk_bf16_f32 v180,v180,v181
v_cvt_pk_bf16_f32 v196,v196,v197
v_mfma_f32_16x16x32_bf16 v[96:99],a[120:123],a[72:75],v[96:99]
s_cselect_b32 s40,1,s40
ds_read_b128 a[116:119],v12 offset:6400
v_cvt_pk_bf16_f32 v181,v182,v183
ds_write2st64_b64 v36,v[176:177],v[192:193] offset0:2 offset1:4
s_waitcnt lgkmcnt(6)
v_mfma_f32_16x16x32_bf16 v[104:107],a[120:123],a[96:99],0
s_mul_i32 s64,s64,6144
v_cvt_pk_bf16_f32 v197,v198,v199
s_add_u32 s41,s41,s64
s_waitcnt lgkmcnt(5)
v_mfma_f32_16x16x32_bf16 v[104:107],a[124:127],a[100:103],v[104:107]
s_cmp_ge_u32 s69,6
ds_read_b128 a[120:123],v0 offset:6272
v_max3_f32 v56,v96,v97,v98
s_waitcnt lgkmcnt(5)
v_mfma_f32_16x16x32_bf16 v[104:107],a[128:131],a[104:107],v[104:107]
s_cselect_b32 s41,166723584,s41
ds_read_b128 a[124:127],v1 offset:6272
s_cselect_b32 s30,100663296,s30
s_add_u32 s25,s30,s22
s_add_u32 s26,s25,12288
ds_write2st64_b64 v37,v[180:181],v[196:197] offset0:2 offset1:4
v_pk_mul_f32 v[184:185],v[184:185],v[60:61] op_sel_hi:[1,0]
v_pk_mul_f32 v[200:201],v[200:201],v[60:61] op_sel_hi:[1,0]
v_pk_mul_f32 v[202:203],v[202:203],v[60:61] op_sel_hi:[1,0]
ds_read_b128 a[128:131],v0 offset:6400
v_pk_mul_f32 v[186:187],v[186:187],v[60:61] op_sel_hi:[1,0]
v_cvt_pk_bf16_f32 v200,v200,v201
v_cvt_pk_bf16_f32 v184,v184,v185
s_waitcnt lgkmcnt(4)
v_mfma_f32_16x16x32_bf16 v[104:107],a[132:135],a[108:111],v[104:107]
s_add_u32 m0,s23,24576
ds_read_b128 a[132:135],v1 offset:6400
v_cvt_pk_bf16_f32 v185,v186,v187
v_mfma_f32_16x16x32_bf16 v[104:107],a[136:139],a[112:115],v[104:107]
s_mov_b32 s28,s41
ds_read_b128 a[136:139],v0 offset:12288
v_cvt_pk_bf16_f32 v201,v202,v203
v_mfma_f32_16x16x32_bf16 v[104:107],a[140:143],a[116:119],v[104:107]
s_mov_b32 s29,s24
ds_read_b128 a[140:143],v1 offset:12288
ds_write2st64_b64 v38,v[184:185],v[200:201] offset0:2 offset1:4
v_pk_mul_f32 v[206:207],v[206:207],v[60:61] op_sel_hi:[1,0]
v_pk_mul_f32 v[190:191],v[190:191],v[60:61] op_sel_hi:[1,0]
v_pk_mul_f32 v[204:205],v[204:205],v[60:61] op_sel_hi:[1,0]
v_pk_mul_f32 v[188:189],v[188:189],v[60:61] op_sel_hi:[1,0]
v_cvt_pk_bf16_f32 v204,v204,v205
v_max3_f32 v40,v104,v105,v106
v_mfma_f32_16x16x32_bf16 v[76:79],a[144:147],a[0:3],0
v_cvt_pk_bf16_f32 v188,v188,v189
v_cvt_pk_bf16_f32 v205,v206,v207
v_mfma_f32_16x16x32_bf16 v[76:79],a[148:151],a[4:7],v[76:79]
s_waitcnt lgkmcnt(4)
v_cvt_pk_bf16_f32 v189,v190,v191
v_mov_b32 v61,0
v_mfma_f32_16x16x32_bf16 v[76:79],a[120:123],a[8:11],v[76:79]
ds_write2st64_b64 v39,v[188:189],v[204:205] offset0:2 offset1:4
v_mfma_f32_16x16x32_bf16 v[76:79],a[124:127],a[12:15],v[76:79]
v_mov_b32 v60,0
buffer_load_dwordx4 v6,s[8:11],s21 offen offset:0 lds
v_pk_mul_f32 v[210:211],v[210:211],v[62:63] op_sel_hi:[1,0]
v_pk_mul_f32 v[208:209],v[208:209],v[62:63] op_sel_hi:[1,0]
v_pk_mul_f32 v[224:225],v[224:225],v[62:63] op_sel_hi:[1,0]
v_pk_mul_f32 v[226:227],v[226:227],v[62:63] op_sel_hi:[1,0]
v_cvt_pk_bf16_f32 v224,v224,v225
v_cvt_pk_bf16_f32 v225,v226,v227
v_mfma_f32_16x16x32_bf16 v[76:79],a[128:131],a[16:19],v[76:79]
s_waitcnt lgkmcnt(1)
v_cvt_pk_bf16_f32 v208,v208,v209
v_cvt_pk_bf16_f32 v209,v210,v211
v_mfma_f32_16x16x32_bf16 v[76:79],a[132:135],a[20:23],v[76:79]
ds_write2st64_b64 v36,v[208:209],v[224:225] offset0:12 offset1:14
v_mfma_f32_16x16x32_bf16 v[84:87],a[132:135],a[44:47],0
v_mfma_f32_16x16x32_bf16 v[84:87],a[128:131],a[40:43],v[84:87]
buffer_load_dwordx4 v7,s[8:11],s21 offen offset:1024 lds
v_pk_mul_f32 v[214:215],v[214:215],v[62:63] op_sel_hi:[1,0]
v_pk_mul_f32 v[230:231],v[230:231],v[62:63] op_sel_hi:[1,0]
v_pk_mul_f32 v[228:229],v[228:229],v[62:63] op_sel_hi:[1,0]
v_pk_mul_f32 v[212:213],v[212:213],v[62:63] op_sel_hi:[1,0]
v_max3_f32 v44,v44,v75,v76
v_max3_f32 v44,v44,v77,v78
v_mfma_f32_16x16x32_bf16 v[84:87],a[124:127],a[36:39],v[84:87]
v_max_f32 v44,v44,v79
v_mov_b32 v45,v44
v_mfma_f32_16x16x32_bf16 v[84:87],a[120:123],a[32:35],v[84:87]
v_cvt_pk_bf16_f32 v212,v212,v213
v_permlane32_swap_b32 v45,v44
v_mfma_f32_16x16x32_bf16 v[84:87],a[148:151],a[28:31],v[84:87]
v_max_f32 v44,v44,v45
v_mov_b32 v45,v44
v_cvt_pk_bf16_f32 v213,v214,v215
v_cvt_pk_bf16_f32 v228,v228,v229
v_permlane16_swap_b32 v45,v44
v_pk_mul_f32 v[234:235],v[234:235],v[62:63] op_sel_hi:[1,0]
v_pk_mul_f32 v[218:219],v[218:219],v[62:63] op_sel_hi:[1,0]
v_pk_mul_f32 v[232:233],v[232:233],v[62:63] op_sel_hi:[1,0]
v_pk_mul_f32 v[216:217],v[216:217],v[62:63] op_sel_hi:[1,0]
v_max_f32 v44,v44,v45
v_mul_f32_e64 v13,-s36,v44
v_mfma_f32_16x16x32_bf16 v[84:87],a[144:147],a[24:27],v[84:87]
buffer_load_dwordx4 v8,s[8:11],s21 offen offset:2048 lds
v_mfma_f32_16x16x32_bf16 v[92:95],a[144:147],a[48:51],0
s_add_u32 s21,s21,12288
v_fma_f32 v72,v72,s36,v13
v_fma_f32 v74,v74,s36,v13
v_mfma_f32_16x16x32_bf16 v[92:95],a[148:151],a[52:55],v[92:95]
s_add_u32 m0,s22,0
v_exp_f32 v74,v74
v_mfma_f32_16x16x32_bf16 v[92:95],a[120:123],a[56:59],v[92:95]
v_fma_f32 v75,v75,s36,v13
v_exp_f32 v75,v75
v_exp_f32 v72,v72
v_pk_mul_f32 v[236:237],v[236:237],v[62:63] op_sel_hi:[1,0]
v_pk_mul_f32 v[238:239],v[238:239],v[62:63] op_sel_hi:[1,0]
v_pk_mul_f32 v[220:221],v[220:221],v[62:63] op_sel_hi:[1,0]
v_pk_mul_f32 v[222:223],v[222:223],v[62:63] op_sel_hi:[1,0]
v_fma_f32 v73,v73,s36,v13
v_exp_f32 v73,v73
v_mfma_f32_16x16x32_bf16 v[92:95],a[124:127],a[60:63],v[92:95]
v_cvt_pk_bf16_f32 v20,v72,v73
v_cvt_pk_bf16_f32 v21,v74,v75
v_mfma_f32_16x16x32_bf16 v[92:95],a[128:131],a[64:67],v[92:95]
v_max3_f32 v48,v48,v83,v84
v_max3_f32 v48,v48,v85,v86
v_mfma_f32_16x16x32_bf16 v[92:95],a[132:135],a[68:71],v[92:95]
v_max_f32 v48,v48,v87
v_mov_b32 v49,v48
v_mfma_f32_16x16x32_bf16 v[100:103],a[132:135],a[92:95],0
v_cvt_pk_bf16_f32 v236,v236,v237
v_permlane32_swap_b32 v49,v48
v_max_f32 v48,v48,v49
v_mov_b32 v49,v48
v_pk_mul_f32 v[242:243],v[242:243],v[62:63] op_sel_hi:[1,0]
v_pk_mul_f32 v[240:241],v[240:241],v[62:63] op_sel_hi:[1,0]
v_permlane16_swap_b32 v49,v48
v_max_f32 v48,v48,v49
v_mfma_f32_16x16x32_bf16 v[100:103],a[128:131],a[88:91],v[100:103]
v_mul_f32_e64 v14,-s36,v48
v_fma_f32 v81,v81,s36,v14
v_mfma_f32_16x16x32_bf16 v[100:103],a[124:127],a[84:87],v[100:103]
v_fma_f32 v83,v83,s36,v14
v_fma_f32 v80,v80,s36,v14
v_mfma_f32_16x16x32_bf16 v[100:103],a[120:123],a[80:83],v[100:103]
v_exp_f32 v81,v81
v_mfma_f32_16x16x32_bf16 v[100:103],a[148:151],a[76:79],v[100:103]
v_exp_f32 v80,v80
v_fma_f32 v82,v82,s36,v14
v_exp_f32 v82,v82
v_pk_mul_f32 v[246:247],v[246:247],v[62:63] op_sel_hi:[1,0]
v_pk_mul_f32 v[244:245],v[244:245],v[62:63] op_sel_hi:[1,0]
v_exp_f32 v83,v83
v_cvt_pk_bf16_f32 v24,v80,v81
v_mfma_f32_16x16x32_bf16 v[100:103],a[144:147],a[72:75],v[100:103]
v_cvt_pk_bf16_f32 v25,v82,v83
v_max3_f32 v52,v52,v91,v92
v_mfma_f32_16x16x32_bf16 v[108:111],a[144:147],a[96:99],0
ds_read_b128 a[144:147],v0 offset:12416
v_max3_f32 v52,v52,v93,v94
v_mfma_f32_16x16x32_bf16 v[108:111],a[148:151],a[100:103],v[108:111]
ds_read_b128 a[148:151],v1 offset:12416
v_max_f32 v52,v52,v95
v_mov_b32 v53,v52
v_max3_f32 v56,v56,v99,v100
v_max3_f32 v56,v56,v101,v102
v_pk_mul_f32 v[248:249],v[248:249],v[62:63] op_sel_hi:[1,0]
v_pk_mul_f32 v[250:251],v[250:251],v[62:63] op_sel_hi:[1,0]
v_permlane32_swap_b32 v53,v52
v_max_f32 v52,v52,v53
v_mfma_f32_16x16x32_bf16 v[108:111],a[120:123],a[104:107],v[108:111]
ds_read_b128 a[120:123],v0 offset:12544
v_mov_b32 v53,v52
v_mfma_f32_16x16x32_bf16 v[108:111],a[124:127],a[108:111],v[108:111]
ds_read_b128 a[124:127],v1 offset:12544
v_permlane16_swap_b32 v53,v52
v_mfma_f32_16x16x32_bf16 v[108:111],a[128:131],a[112:115],v[108:111]
ds_read_b128 a[128:131],v0 offset:18432
v_max_f32 v52,v52,v53
v_mfma_f32_16x16x32_bf16 v[108:111],a[132:135],a[116:119],v[108:111]
ds_read_b128 a[132:135],v1 offset:18432
v_mul_f32_e64 v15,-s36,v52
v_fma_f32 v88,v88,s36,v15
v_fma_f32 v89,v89,s36,v15
v_fma_f32 v91,v91,s36,v15
v_pk_mul_f32 v[252:253],v[252:253],v[62:63] op_sel_hi:[1,0]
v_pk_mul_f32 v[254:255],v[254:255],v[62:63] op_sel_hi:[1,0]
v_fma_f32 v90,v90,s36,v15
v_exp_f32 v90,v90
v_mfma_f32_16x16x32_bf16 v[72:75],a[136:139],a[0:3],0
v_exp_f32 v91,v91
v_mfma_f32_16x16x32_bf16 v[72:75],a[140:143],a[4:7],v[72:75]
s_waitcnt lgkmcnt(3)
v_exp_f32 v89,v89
v_mfma_f32_16x16x32_bf16 v[72:75],a[144:147],a[8:11],v[72:75]
v_exp_f32 v88,v88
v_mfma_f32_16x16x32_bf16 v[72:75],a[148:151],a[12:15],v[72:75]
v_cvt_pk_bf16_f32 v29,v90,v91
v_cvt_pk_bf16_f32 v28,v88,v89
v_mfma_f32_16x16x32_bf16 v[72:75],a[120:123],a[16:19],v[72:75]
s_waitcnt lgkmcnt(0)
v_max_f32 v56,v56,v103
v_mov_b32 v57,v56
v_mfma_f32_16x16x32_bf16 v[72:75],a[124:127],a[20:23],v[72:75]
v_max3_f32 v40,v40,v107,v108
v_permlane32_swap_b32 v57,v56
v_mfma_f32_16x16x32_bf16 v[80:83],a[124:127],a[44:47],0
v_max_f32 v56,v56,v57
v_mov_b32 v57,v56
v_mfma_f32_16x16x32_bf16 v[80:83],a[120:123],a[40:43],v[80:83]
v_max3_f32 v40,v40,v109,v110
v_permlane16_swap_b32 v57,v56
v_mfma_f32_16x16x32_bf16 v[80:83],a[148:151],a[36:39],v[80:83]
v_max_f32 v56,v56,v57
v_mul_f32_e64 v16,-s36,v56
v_mfma_f32_16x16x32_bf16 v[80:83],a[144:147],a[32:35],v[80:83]
v_fma_f32 v97,v97,s36,v16
v_fma_f32 v98,v98,s36,v16
v_mfma_f32_16x16x32_bf16 v[80:83],a[140:143],a[28:31],v[80:83]
v_fma_f32 v99,v99,s36,v16
v_exp_f32 v99,v99
v_mfma_f32_16x16x32_bf16 v[80:83],a[136:139],a[24:27],v[80:83]
v_exp_f32 v97,v97
v_mfma_f32_16x16x32_bf16 v[88:91],a[136:139],a[48:51],0
v_fma_f32 v96,v96,s36,v16
v_exp_f32 v96,v96
v_mfma_f32_16x16x32_bf16 v[88:91],a[140:143],a[52:55],v[88:91]
v_exp_f32 v98,v98
v_mfma_f32_16x16x32_bf16 v[88:91],a[144:147],a[56:59],v[88:91]
v_cvt_pk_bf16_f32 v33,v98,v99
v_cvt_pk_bf16_f32 v32,v96,v97
v_mfma_f32_16x16x32_bf16 v[88:91],a[148:151],a[60:63],v[88:91]
v_max_f32 v40,v40,v111
v_mov_b32 v41,v40
v_mfma_f32_16x16x32_bf16 v[88:91],a[120:123],a[64:67],v[88:91]
v_cvt_pk_bf16_f32 v232,v232,v233
v_permlane32_swap_b32 v41,v40
v_mfma_f32_16x16x32_bf16 v[88:91],a[124:127],a[68:71],v[88:91]
v_max_f32 v40,v40,v41
v_mov_b32 v41,v40
v_mfma_f32_16x16x32_bf16 v[96:99],a[124:127],a[92:95],0
v_cvt_pk_bf16_f32 v216,v216,v217
v_cvt_pk_bf16_f32 v217,v218,v219
v_mfma_f32_16x16x32_bf16 v[96:99],a[120:123],a[88:91],v[96:99]
v_permlane16_swap_b32 v41,v40
v_mfma_f32_16x16x32_bf16 v[96:99],a[148:151],a[84:87],v[96:99]
v_cvt_pk_bf16_f32 v240,v240,v241
v_cvt_pk_bf16_f32 v237,v238,v239
v_mfma_f32_16x16x32_bf16 v[96:99],a[144:147],a[80:83],v[96:99]
v_max_f32 v40,v40,v41
v_cvt_pk_bf16_f32 v233,v234,v235
v_mfma_f32_16x16x32_bf16 v[96:99],a[140:143],a[76:79],v[96:99]
v_cvt_pk_bf16_f32 v229,v230,v231
v_cvt_pk_bf16_f32 v220,v220,v221
v_mfma_f32_16x16x32_bf16 v[96:99],a[136:139],a[72:75],v[96:99]
ds_write2st64_b64 v37,v[212:213],v[228:229] offset0:12 offset1:14
v_cvt_pk_bf16_f32 v221,v222,v223
v_mul_f32_e64 v17,-s36,v40
v_fma_f32 v105,v105,s36,v17
v_fma_f32 v104,v104,s36,v17
v_fma_f32 v107,v107,s36,v17
v_exp_f32 v107,v107
v_exp_f32 v104,v104
v_cvt_pk_bf16_f32 v241,v242,v243
v_fma_f32 v106,v106,s36,v17
v_exp_f32 v105,v105
v_exp_f32 v106,v106
ds_write2st64_b64 v38,v[216:217],v[232:233] offset0:12 offset1:14
v_cvt_pk_bf16_f32 v244,v244,v245
v_cvt_pk_bf16_f32 v245,v246,v247
v_fma_f32 v78,v78,s36,v13
v_fma_f32 v77,v77,s36,v13
v_exp_f32 v78,v78
v_fma_f32 v76,v76,s36,v13
v_exp_f32 v77,v77
v_fma_f32 v79,v79,s36,v13
v_exp_f32 v79,v79
v_exp_f32 v76,v76
v_cvt_pk_bf16_f32 v23,v78,v79
ds_write2st64_b64 v39,v[220:221],v[236:237] offset0:12 offset1:14
v_cvt_pk_bf16_f32 v22,v76,v77
v_fma_f32 v84,v84,s36,v14
v_exp_f32 v84,v84
v_fma_f32 v85,v85,s36,v14
v_fma_f32 v86,v86,s36,v14
v_fma_f32 v87,v87,s36,v14
v_exp_f32 v87,v87
v_exp_f32 v86,v86
v_exp_f32 v85,v85
v_cvt_pk_bf16_f32 v27,v86,v87
ds_write_b64 v36,v[240:241] offset:8192
v_cvt_pk_bf16_f32 v36,v104,v105
v_cvt_pk_bf16_f32 v26,v84,v85
v_fma_f32 v93,v93,s36,v15
v_fma_f32 v92,v92,s36,v15
v_fma_f32 v95,v95,s36,v15
v_exp_f32 v95,v95
ds_write_b64 v37,v[244:245] offset:8192
v_cvt_pk_bf16_f32 v37,v106,v107
v_mfma_f32_16x16x32_bf16 v[104:107],a[136:139],a[96:99],0
ds_read_b128 a[136:139],v0 offset:18560
v_fma_f32 v94,v94,s36,v15
v_mfma_f32_16x16x32_bf16 v[104:107],a[140:143],a[100:103],v[104:107]
ds_read_b128 a[140:143],v1 offset:18560
v_exp_f32 v93,v93
v_mfma_f32_16x16x32_bf16 v[104:107],a[144:147],a[104:107],v[104:107]
s_waitcnt vmcnt(3)
s_barrier
v_mfma_f32_16x16x32_bf16 v[104:107],a[148:151],a[108:111],v[104:107]
ds_read_b128 a[144:147],v0 offset:18688
buffer_load_dwordx4 v6,s[4:7],s20 offen offset:0 lds
v_mfma_f32_16x16x32_bf16 v[104:107],a[120:123],a[112:115],v[104:107]
ds_read_b128 a[148:151],v1 offset:18688
v_exp_f32 v94,v94
v_mfma_f32_16x16x32_bf16 v[104:107],a[124:127],a[116:119],v[104:107]
v_exp_f32 v92,v92
v_mfma_f32_16x16x32_bf16 v[76:79],a[128:131],a[0:3],0
v_cvt_pk_bf16_f32 v31,v94,v95
v_cvt_pk_bf16_f32 v30,v92,v93
v_mfma_f32_16x16x32_bf16 v[76:79],a[132:135],a[4:7],v[76:79]
s_waitcnt lgkmcnt(2)
v_fma_f32 v100,v100,s36,v16
v_fma_f32 v103,v103,s36,v16
v_mfma_f32_16x16x32_bf16 v[76:79],a[136:139],a[8:11],v[76:79]
v_fma_f32 v101,v101,s36,v16
v_exp_f32 v100,v100
v_mfma_f32_16x16x32_bf16 v[76:79],a[140:143],a[12:15],v[76:79]
buffer_load_dwordx4 v7,s[4:7],s20 offen offset:1024 lds
s_waitcnt lgkmcnt(1)
v_mfma_f32_16x16x32_bf16 v[76:79],a[144:147],a[16:19],v[76:79]
s_waitcnt lgkmcnt(0)
v_exp_f32 v103,v103
v_fma_f32 v102,v102,s36,v16
v_mfma_f32_16x16x32_bf16 v[76:79],a[148:151],a[20:23],v[76:79]
v_exp_f32 v101,v101
v_mfma_f32_16x16x32_bf16 v[84:87],a[148:151],a[44:47],0
ds_read_b64_tr_b16 a[120:121],v2 offset:0
v_exp_f32 v102,v102
v_mfma_f32_16x16x32_bf16 v[84:87],a[144:147],a[40:43],v[84:87]
ds_read_b64_tr_b16 a[122:123],v2 offset:6144
v_cvt_pk_bf16_f32 v35,v102,v103
v_mfma_f32_16x16x32_bf16 v[84:87],a[140:143],a[36:39],v[84:87]
buffer_load_dwordx4 v8,s[4:7],s20 offen offset:2048 lds
v_mfma_f32_16x16x32_bf16 v[84:87],a[136:139],a[32:35],v[84:87]
s_add_u32 s20,s20,12288
ds_read_b64_tr_b16 a[126:127],v3 offset:6144
v_cvt_pk_bf16_f32 v34,v100,v101
v_mfma_f32_16x16x32_bf16 v[84:87],a[132:135],a[28:31],v[84:87]
ds_read_b64_tr_b16 a[124:125],v3 offset:0
v_fma_f32 v111,v111,s36,v17
v_smfmac_f32_16x16x64_bf16 v[64:67],a[152:155],v[28:35],v18
v_fma_f32 v109,v109,s36,v17
v_mfma_f32_16x16x32_bf16 v[84:87],a[128:131],a[24:27],v[84:87]
v_cvt_pk_bf16_f32 v252,v252,v253
v_fma_f32 v110,v110,s36,v17
v_mfma_f32_16x16x32_bf16 v[92:95],a[128:131],a[48:51],0
v_exp_f32 v110,v110
v_mfma_f32_16x16x32_bf16 v[92:95],a[132:135],a[52:55],v[92:95]
v_cvt_pk_bf16_f32 v248,v248,v249
v_cvt_pk_bf16_f32 v249,v250,v251
v_mfma_f32_16x16x32_bf16 v[92:95],a[136:139],a[56:59],v[92:95]
ds_write_b64 v38,v[248:249] offset:8192
v_mfma_f32_16x16x32_bf16 v[92:95],a[140:143],a[60:63],v[92:95]
v_fma_f32 v108,v108,s36,v17
v_exp_f32 v111,v111
v_mfma_f32_16x16x32_bf16 v[92:95],a[144:147],a[64:67],v[92:95]
v_exp_f32 v109,v109
v_mfma_f32_16x16x32_bf16 v[92:95],a[148:151],a[68:71],v[92:95]
v_exp_f32 v108,v108
v_mfma_f32_16x16x32_bf16 v[100:103],a[148:151],a[92:95],0
v_cvt_pk_bf16_f32 v253,v254,v255
v_cvt_pk_bf16_f32 v38,v108,v109
v_mfma_f32_16x16x32_bf16 v[100:103],a[144:147],a[88:91],v[100:103]
ds_write_b64 v39,v[252:253] offset:8192
v_mfma_f32_16x16x32_bf16 v[100:103],a[140:143],a[84:87],v[100:103]
v_cvt_pk_bf16_f32 v39,v110,v111
v_mov_b32 v62,0
v_mfma_f32_16x16x32_bf16 v[100:103],a[136:139],a[80:83],v[100:103]
v_fma_f32 v80,v80,s36,v14
v_fma_f32 v88,v88,s36,v15
v_mfma_f32_16x16x32_bf16 v[100:103],a[132:135],a[76:79],v[100:103]
v_fma_f32 v81,v81,s36,v14
v_fma_f32 v75,v75,s36,v13
v_mfma_f32_16x16x32_bf16 v[100:103],a[128:131],a[72:75],v[100:103]
v_fma_f32 v83,v83,s36,v14
v_mov_b32 v63,0
v_mfma_f32_16x16x32_bf16 v[108:111],a[128:131],a[96:99],0
ds_read_b64_tr_b16 a[128:129],v4 offset:0
v_fma_f32 v82,v82,s36,v14
v_smfmac_f32_16x16x64_bf16 v[60:63],a[152:155],v[20:27],v18
ds_read_b64_tr_b16 a[130:131],v4 offset:6144
v_mfma_f32_16x16x32_bf16 v[108:111],a[132:135],a[100:103],v[108:111]
ds_read_b64_tr_b16 a[134:135],v5 offset:6144
v_fma_f32 v74,v74,s36,v13
v_mfma_f32_16x16x32_bf16 v[108:111],a[136:139],a[104:107],v[108:111]
ds_read_b64_tr_b16 a[132:133],v5 offset:0
v_exp_f32 v88,v88
v_mfma_f32_16x16x32_bf16 v[108:111],a[140:143],a[108:111],v[108:111]
v_exp_f32 v80,v80
v_mfma_f32_16x16x32_bf16 v[108:111],a[144:147],a[112:115],v[108:111]
v_exp_f32 v75,v75
v_mfma_f32_16x16x32_bf16 v[108:111],a[148:151],a[116:119],v[108:111]
v_fma_f32 v89,v89,s36,v15
v_exp_f32 v89,v89
v_fma_f32 v72,v72,s36,v13
v_exp_f32 v72,v72
v_fma_f32 v73,v73,s36,v13
v_exp_f32 v83,v83
v_exp_f32 v81,v81
v_exp_f32 v82,v82
v_exp_f32 v73,v73
v_cvt_pk_bf16_f32 v52,v88,v89
v_exp_f32 v74,v74
v_cvt_pk_bf16_f32 v49,v82,v83
v_cvt_pk_bf16_f32 v44,v72,v73
v_cvt_pk_bf16_f32 v45,v74,v75
v_cvt_pk_bf16_f32 v48,v80,v81
s_waitcnt lgkmcnt(0)
v_mfma_f32_16x16x32_bf16 v[160:163],a[120:123],v[20:23],0
s_add_u32 m0,s23,0
ds_read_b64_tr_b16 a[136:137],v2 offset:128
v_fma_f32 v90,v90,s36,v15
v_mfma_f32_16x16x32_bf16 v[164:167],a[124:127],v[20:23],0
ds_read_b64_tr_b16 a[138:139],v2 offset:6272
v_fma_f32 v91,v91,s36,v15
v_mfma_f32_16x16x32_bf16 v[212:215],a[124:127],v[24:27],0
ds_read_b64_tr_b16 a[140:141],v3 offset:128
v_fma_f32 v96,v96,s36,v16
v_mfma_f32_16x16x32_bf16 v[208:211],a[120:123],v[24:27],0
ds_read_b64_tr_b16 a[142:143],v3 offset:6272
v_fma_f32 v97,v97,s36,v16
v_mfma_f32_16x16x32_bf16 v[112:115],a[120:123],v[28:31],0
ds_read_b64_tr_b16 a[144:145],v4 offset:128
v_fma_f32 v98,v98,s36,v16
v_mfma_f32_16x16x32_bf16 v[116:119],a[124:127],v[28:31],0
ds_read_b64_tr_b16 a[146:147],v4 offset:6272
v_fma_f32 v99,v99,s36,v16
v_mfma_f32_16x16x32_bf16 a[164:167],a[124:127],v[32:35],0
ds_read_b64_tr_b16 a[148:149],v5 offset:128
v_fma_f32 v104,v104,s36,v17
v_mfma_f32_16x16x32_bf16 a[160:163],a[120:123],v[32:35],0
ds_read_b64_tr_b16 a[150:151],v5 offset:6272
v_fma_f32 v105,v105,s36,v17
v_mfma_f32_16x16x32_bf16 a[208:211],a[120:123],v[36:39],0
ds_read_b64_tr_b16 a[120:121],v2 offset:256
v_fma_f32 v106,v106,s36,v17
v_mfma_f32_16x16x32_bf16 a[212:215],a[124:127],v[36:39],0
ds_read_b64_tr_b16 a[122:123],v2 offset:6400
v_fma_f32 v107,v107,s36,v17
v_mfma_f32_16x16x32_bf16 a[216:219],a[128:131],v[36:39],0
ds_read_b64_tr_b16 a[124:125],v3 offset:256
v_fma_f32 v76,v76,s36,v13
v_mfma_f32_16x16x32_bf16 a[220:223],a[132:135],v[36:39],0
ds_read_b64_tr_b16 a[126:127],v3 offset:6400
v_fma_f32 v77,v77,s36,v13
v_mfma_f32_16x16x32_bf16 a[172:175],a[132:135],v[32:35],0
v_exp_f32 v90,v90
v_mfma_f32_16x16x32_bf16 a[168:171],a[128:131],v[32:35],0
v_exp_f32 v91,v91
v_mfma_f32_16x16x32_bf16 v[120:123],a[128:131],v[28:31],0
v_cvt_pk_bf16_f32 v53,v90,v91
v_fma_f32 v78,v78,s36,v13
v_mfma_f32_16x16x32_bf16 v[124:127],a[132:135],v[28:31],0
v_exp_f32 v96,v96
v_mfma_f32_16x16x32_bf16 v[220:223],a[132:135],v[24:27],0
v_exp_f32 v97,v97
v_mfma_f32_16x16x32_bf16 v[216:219],a[128:131],v[24:27],0
v_exp_f32 v98,v98
v_mfma_f32_16x16x32_bf16 v[168:171],a[128:131],v[20:23],0
ds_read_b64_tr_b16 a[128:129],v4 offset:256
v_cvt_pk_bf16_f32 v56,v96,v97
v_mfma_f32_16x16x32_bf16 v[172:175],a[132:135],v[20:23],0
s_waitcnt lgkmcnt(1)
ds_read_b64_tr_b16 a[130:131],v4 offset:6400
v_fma_f32 v79,v79,s36,v13
v_mfma_f32_16x16x32_bf16 v[176:179],a[136:139],v[20:23],0
ds_read_b64_tr_b16 a[132:133],v5 offset:256
v_fma_f32 v84,v84,s36,v14
v_mfma_f32_16x16x32_bf16 v[180:183],a[140:143],v[20:23],0
ds_read_b64_tr_b16 a[134:135],v5 offset:6400
v_fma_f32 v85,v85,s36,v14
v_mfma_f32_16x16x32_bf16 v[228:231],a[140:143],v[24:27],0
v_exp_f32 v99,v99
v_mfma_f32_16x16x32_bf16 v[224:227],a[136:139],v[24:27],0
v_cvt_pk_bf16_f32 v57,v98,v99
v_fma_f32 v86,v86,s36,v14
v_mfma_f32_16x16x32_bf16 v[128:131],a[136:139],v[28:31],0
v_exp_f32 v104,v104
v_mfma_f32_16x16x32_bf16 v[132:135],a[140:143],v[28:31],0
v_exp_f32 v105,v105
v_mfma_f32_16x16x32_bf16 a[180:183],a[140:143],v[32:35],0
v_exp_f32 v106,v106
v_mfma_f32_16x16x32_bf16 a[176:179],a[136:139],v[32:35],0
v_exp_f32 v107,v107
v_mfma_f32_16x16x32_bf16 a[224:227],a[136:139],v[36:39],0
v_cvt_pk_bf16_f32 v40,v104,v105
v_cvt_pk_bf16_f32 v41,v106,v107
v_mfma_f32_16x16x32_bf16 a[228:231],a[140:143],v[36:39],0
v_exp_f32 v76,v76
v_mfma_f32_16x16x32_bf16 a[232:235],a[144:147],v[36:39],0
v_exp_f32 v77,v77
v_mfma_f32_16x16x32_bf16 a[236:239],a[148:151],v[36:39],0
v_exp_f32 v78,v78
v_mfma_f32_16x16x32_bf16 a[188:191],a[148:151],v[32:35],0
v_exp_f32 v79,v79
v_mfma_f32_16x16x32_bf16 a[184:187],a[144:147],v[32:35],0
v_cvt_pk_bf16_f32 v46,v76,v77
v_cvt_pk_bf16_f32 v47,v78,v79
v_mfma_f32_16x16x32_bf16 v[136:139],a[144:147],v[28:31],0
v_fma_f32 v87,v87,s36,v14
v_fma_f32 v92,v92,s36,v15
v_mfma_f32_16x16x32_bf16 v[140:143],a[148:151],v[28:31],0
v_exp_f32 v84,v84
v_mfma_f32_16x16x32_bf16 v[236:239],a[148:151],v[24:27],0
v_exp_f32 v85,v85
v_mfma_f32_16x16x32_bf16 v[232:235],a[144:147],v[24:27],0
v_exp_f32 v86,v86
v_mfma_f32_16x16x32_bf16 v[184:187],a[144:147],v[20:23],0
v_exp_f32 v87,v87
v_mfma_f32_16x16x32_bf16 v[188:191],a[148:151],v[20:23],0
v_cvt_pk_bf16_f32 v50,v84,v85
v_cvt_pk_bf16_f32 v51,v86,v87
v_mfma_f32_16x16x32_bf16 v[192:195],a[120:123],v[20:23],0
v_fma_f32 v93,v93,s36,v15
v_fma_f32 v94,v94,s36,v15
v_smfmac_f32_16x16x64_bf16 v[60:63],a[152:155],v[44:51],v18
v_fma_f32 v95,v95,s36,v15
v_mfma_f32_16x16x32_bf16 v[196:199],a[124:127],v[20:23],0
s_waitcnt vmcnt(30) lgkmcnt(0)
v_exp_f32 v92,v92
v_mfma_f32_16x16x32_bf16 v[244:247],a[124:127],v[24:27],0
s_barrier
v_mfma_f32_16x16x32_bf16 v[240:243],a[120:123],v[24:27],0
ds_read_b128 a[136:139],v0 offset:24576
v_fma_f32 v100,v100,s36,v16
v_mfma_f32_16x16x32_bf16 v[144:147],a[120:123],v[28:31],0
ds_read_b128 a[140:143],v1 offset:24576
v_fma_f32 v101,v101,s36,v16
v_mfma_f32_16x16x32_bf16 v[148:151],a[124:127],v[28:31],0
ds_read_b128 a[144:147],v0 offset:24704
v_fma_f32 v102,v102,s36,v16
v_mfma_f32_16x16x32_bf16 a[196:199],a[124:127],v[32:35],0
ds_read_b128 a[148:151],v1 offset:24704
v_fma_f32 v103,v103,s36,v16
v_mfma_f32_16x16x32_bf16 a[192:195],a[120:123],v[32:35],0
v_exp_f32 v93,v93
v_mfma_f32_16x16x32_bf16 a[240:243],a[120:123],v[36:39],0
buffer_load_dwordx4 v6,s[8:11],s21 offen offset:0 lds
v_mfma_f32_16x16x32_bf16 a[244:247],a[124:127],v[36:39],0
ds_read_b128 a[120:123],v0 offset:24832
v_cvt_pk_bf16_f32 v54,v92,v93
v_mfma_f32_16x16x32_bf16 a[248:251],a[128:131],v[36:39],0
ds_read_b128 a[124:127],v1 offset:24832
v_fma_f32 v108,v108,s36,v17
v_mfma_f32_16x16x32_bf16 a[252:255],a[132:135],v[36:39],0
v_exp_f32 v94,v94
v_mfma_f32_16x16x32_bf16 a[204:207],a[132:135],v[32:35],0
v_exp_f32 v95,v95
v_mfma_f32_16x16x32_bf16 a[200:203],a[128:131],v[32:35],0
v_cvt_pk_bf16_f32 v55,v94,v95
v_fma_f32 v109,v109,s36,v17
v_mfma_f32_16x16x32_bf16 v[152:155],a[128:131],v[28:31],0
v_exp_f32 v100,v100
v_mfma_f32_16x16x32_bf16 v[156:159],a[132:135],v[28:31],0
v_exp_f32 v101,v101
v_mfma_f32_16x16x32_bf16 v[252:255],a[132:135],v[24:27],0
v_exp_f32 v102,v102
v_mfma_f32_16x16x32_bf16 v[248:251],a[128:131],v[24:27],0
v_exp_f32 v103,v103
v_mfma_f32_16x16x32_bf16 v[200:203],a[128:131],v[20:23],0
ds_read_b128 a[128:131],v0 offset:30720
v_cvt_pk_bf16_f32 v58,v100,v101
v_mfma_f32_16x16x32_bf16 v[204:207],a[132:135],v[20:23],0
buffer_load_dwordx4 v7,s[8:11],s21 offen offset:1024 lds
s_waitcnt lgkmcnt(1)
v_mfma_f32_16x16x32_bf16 v[72:75],a[136:139],a[0:3],0
ds_read_b128 a[132:135],v1 offset:30720
v_cvt_pk_bf16_f32 v59,v102,v103
v_mfma_f32_16x16x32_bf16 v[72:75],a[140:143],a[4:7],v[72:75]
v_fma_f32 v110,v110,s36,v17
v_fma_f32 v111,v111,s36,v17
v_smfmac_f32_16x16x64_bf16 v[64:67],a[152:155],v[52:59],v18
v_mfma_f32_16x16x32_bf16 v[72:75],a[144:147],a[8:11],v[72:75]
v_exp_f32 v108,v108
v_mfma_f32_16x16x32_bf16 v[72:75],a[148:151],a[12:15],v[72:75]
v_exp_f32 v109,v109
v_mfma_f32_16x16x32_bf16 v[72:75],a[120:123],a[16:19],v[72:75]
v_exp_f32 v110,v110
v_mfma_f32_16x16x32_bf16 v[72:75],a[124:127],a[20:23],v[72:75]
v_exp_f32 v111,v111
v_mfma_f32_16x16x32_bf16 v[80:83],a[124:127],a[44:47],0
v_cvt_pk_bf16_f32 v42,v108,v109
v_cvt_pk_bf16_f32 v43,v110,v111
v_mfma_f32_16x16x32_bf16 v[80:83],a[120:123],a[40:43],v[80:83]
v_mfma_f32_16x16x32_bf16 v[80:83],a[148:151],a[36:39],v[80:83]
v_smfmac_f32_16x16x64_bf16 v[68:71],a[152:155],v[36:43],v18
buffer_load_dwordx4 v8,s[8:11],s21 offen offset:2048 lds
v_mfma_f32_16x16x32_bf16 v[80:83],a[144:147],a[32:35],v[80:83]
s_add_u32 s21,s21,12288
v_fma_f32 v72,v72,s36,v13
v_fma_f32 v73,v73,s36,v13
v_mfma_f32_16x16x32_bf16 v[80:83],a[140:143],a[28:31],v[80:83]
s_add_u32 m0,s22,12288
v_fma_f32 v74,v74,s36,v13
v_fma_f32 v75,v75,s36,v13
v_mfma_f32_16x16x32_bf16 v[80:83],a[136:139],a[24:27],v[80:83]
v_exp_f32 v72,v72
v_mfma_f32_16x16x32_bf16 v[88:91],a[136:139],a[48:51],0
v_exp_f32 v73,v73
v_mfma_f32_16x16x32_bf16 v[88:91],a[140:143],a[52:55],v[88:91]
v_exp_f32 v74,v74
v_mfma_f32_16x16x32_bf16 v[88:91],a[144:147],a[56:59],v[88:91]
v_exp_f32 v75,v75
v_mfma_f32_16x16x32_bf16 v[88:91],a[148:151],a[60:63],v[88:91]
v_fma_f32 v80,v80,s36,v14
v_fma_f32 v81,v81,s36,v14
v_mfma_f32_16x16x32_bf16 v[88:91],a[120:123],a[64:67],v[88:91]
v_fma_f32 v82,v82,s36,v14
v_fma_f32 v83,v83,s36,v14
v_mfma_f32_16x16x32_bf16 v[88:91],a[124:127],a[68:71],v[88:91]
v_exp_f32 v80,v80
v_mfma_f32_16x16x32_bf16 v[96:99],a[124:127],a[92:95],0
v_exp_f32 v81,v81
v_mfma_f32_16x16x32_bf16 v[96:99],a[120:123],a[88:91],v[96:99]
buffer_load_dwordx4 v6,s[4:7],s20 offen offset:0 lds
v_mfma_f32_16x16x32_bf16 v[96:99],a[148:151],a[84:87],v[96:99]
v_exp_f32 v82,v82
v_mfma_f32_16x16x32_bf16 v[96:99],a[144:147],a[80:83],v[96:99]
v_fma_f32 v88,v88,s36,v15
v_fma_f32 v89,v89,s36,v15
v_mfma_f32_16x16x32_bf16 v[96:99],a[140:143],a[76:79],v[96:99]
v_exp_f32 v83,v83
v_mfma_f32_16x16x32_bf16 v[96:99],a[136:139],a[72:75],v[96:99]
v_exp_f32 v88,v88
v_mfma_f32_16x16x32_bf16 v[104:107],a[136:139],a[96:99],0
ds_read_b128 a[136:139],v0 offset:30848
v_cvt_pk_bf16_f32 v20,v72,v73
v_mfma_f32_16x16x32_bf16 v[104:107],a[140:143],a[100:103],v[104:107]
ds_read_b128 a[140:143],v1 offset:30848
v_cvt_pk_bf16_f32 v21,v74,v75
v_mfma_f32_16x16x32_bf16 v[104:107],a[144:147],a[104:107],v[104:107]
ds_read_b128 a[144:147],v0 offset:30976
v_cvt_pk_bf16_f32 v24,v80,v81
v_mfma_f32_16x16x32_bf16 v[104:107],a[148:151],a[108:111],v[104:107]
ds_read_b128 a[148:151],v1 offset:30976
v_cvt_pk_bf16_f32 v25,v82,v83
v_mfma_f32_16x16x32_bf16 v[104:107],a[120:123],a[112:115],v[104:107]
v_exp_f32 v89,v89
v_mfma_f32_16x16x32_bf16 v[104:107],a[124:127],a[116:119],v[104:107]
s_waitcnt lgkmcnt(4)
v_cvt_pk_bf16_f32 v28,v88,v89
v_mfma_f32_16x16x32_bf16 v[76:79],a[128:131],a[0:3],0
v_mfma_f32_16x16x32_bf16 v[76:79],a[132:135],a[4:7],v[76:79]
buffer_load_dwordx4 v7,s[4:7],s20 offen offset:1024 lds
s_waitcnt lgkmcnt(3)
v_mfma_f32_16x16x32_bf16 v[76:79],a[136:139],a[8:11],v[76:79]
s_waitcnt lgkmcnt(2)
v_mfma_f32_16x16x32_bf16 v[76:79],a[140:143],a[12:15],v[76:79]
s_waitcnt lgkmcnt(1)
v_mfma_f32_16x16x32_bf16 v[76:79],a[144:147],a[16:19],v[76:79]
s_waitcnt lgkmcnt(0)
v_mfma_f32_16x16x32_bf16 v[76:79],a[148:151],a[20:23],v[76:79]
v_mfma_f32_16x16x32_bf16 v[84:87],a[148:151],a[44:47],0
v_mfma_f32_16x16x32_bf16 v[84:87],a[144:147],a[40:43],v[84:87]
v_mfma_f32_16x16x32_bf16 v[84:87],a[140:143],a[36:39],v[84:87]
v_mfma_f32_16x16x32_bf16 v[84:87],a[136:139],a[32:35],v[84:87]
v_mfma_f32_16x16x32_bf16 v[84:87],a[132:135],a[28:31],v[84:87]
v_mfma_f32_16x16x32_bf16 v[84:87],a[128:131],a[24:27],v[84:87]
v_mfma_f32_16x16x32_bf16 v[92:95],a[128:131],a[48:51],0
buffer_load_dwordx4 v8,s[4:7],s20 offen offset:2048 lds
v_mfma_f32_16x16x32_bf16 v[92:95],a[132:135],a[52:55],v[92:95]
s_add_u32 s20,s20,12288
v_mfma_f32_16x16x32_bf16 v[92:95],a[136:139],a[56:59],v[92:95]
v_mfma_f32_16x16x32_bf16 v[92:95],a[140:143],a[60:63],v[92:95]
v_mfma_f32_16x16x32_bf16 v[92:95],a[144:147],a[64:67],v[92:95]
v_mfma_f32_16x16x32_bf16 v[92:95],a[148:151],a[68:71],v[92:95]
ds_read_b64_tr_b16 a[120:121],v2 offset:12288
v_mfma_f32_16x16x32_bf16 v[100:103],a[148:151],a[92:95],0
ds_read_b64_tr_b16 a[122:123],v2 offset:18432
v_mfma_f32_16x16x32_bf16 v[100:103],a[144:147],a[88:91],v[100:103]
v_mfma_f32_16x16x32_bf16 v[100:103],a[140:143],a[84:87],v[100:103]
ds_read_b64_tr_b16 a[124:125],v3 offset:12288
v_mfma_f32_16x16x32_bf16 v[100:103],a[136:139],a[80:83],v[100:103]
ds_read_b64_tr_b16 a[126:127],v3 offset:18432
v_mfma_f32_16x16x32_bf16 v[100:103],a[132:135],a[76:79],v[100:103]
v_mfma_f32_16x16x32_bf16 v[100:103],a[128:131],a[72:75],v[100:103]
v_mfma_f32_16x16x32_bf16 v[108:111],a[128:131],a[96:99],0
ds_read_b64_tr_b16 a[128:129],v4 offset:12288
v_mfma_f32_16x16x32_bf16 v[108:111],a[132:135],a[100:103],v[108:111]
ds_read_b64_tr_b16 a[130:131],v4 offset:18432
v_mfma_f32_16x16x32_bf16 v[108:111],a[136:139],a[104:107],v[108:111]
ds_read_b64_tr_b16 a[132:133],v5 offset:12288
v_mfma_f32_16x16x32_bf16 v[108:111],a[140:143],a[108:111],v[108:111]
ds_read_b64_tr_b16 a[134:135],v5 offset:18432
v_mfma_f32_16x16x32_bf16 v[108:111],a[144:147],a[112:115],v[108:111]
v_mfma_f32_16x16x32_bf16 v[108:111],a[148:151],a[116:119],v[108:111]
s_waitcnt lgkmcnt(4)
v_mfma_f32_16x16x32_bf16 v[160:163],a[120:123],v[44:47],v[160:163]
s_add_u32 m0,s23,12288
ds_read_b64_tr_b16 a[136:137],v2 offset:12416
v_fma_f32 v90,v90,s36,v15
v_mfma_f32_16x16x32_bf16 v[164:167],a[124:127],v[44:47],v[164:167]
ds_read_b64_tr_b16 a[138:139],v2 offset:18560
v_fma_f32 v91,v91,s36,v15
v_mfma_f32_16x16x32_bf16 v[212:215],a[124:127],v[48:51],v[212:215]
ds_read_b64_tr_b16 a[140:141],v3 offset:12416
v_fma_f32 v96,v96,s36,v16
v_mfma_f32_16x16x32_bf16 v[208:211],a[120:123],v[48:51],v[208:211]
ds_read_b64_tr_b16 a[142:143],v3 offset:18560
v_fma_f32 v97,v97,s36,v16
v_mfma_f32_16x16x32_bf16 v[112:115],a[120:123],v[52:55],v[112:115]
ds_read_b64_tr_b16 a[144:145],v4 offset:12416
v_fma_f32 v98,v98,s36,v16
v_mfma_f32_16x16x32_bf16 v[116:119],a[124:127],v[52:55],v[116:119]
ds_read_b64_tr_b16 a[146:147],v4 offset:18560
v_fma_f32 v99,v99,s36,v16
v_mfma_f32_16x16x32_bf16 a[164:167],a[124:127],v[56:59],a[164:167]
ds_read_b64_tr_b16 a[148:149],v5 offset:12416
v_fma_f32 v104,v104,s36,v17
v_mfma_f32_16x16x32_bf16 a[160:163],a[120:123],v[56:59],a[160:163]
ds_read_b64_tr_b16 a[150:151],v5 offset:18560
v_fma_f32 v105,v105,s36,v17
v_mfma_f32_16x16x32_bf16 a[208:211],a[120:123],v[40:43],a[208:211]
ds_read_b64_tr_b16 a[120:121],v2 offset:12544
v_fma_f32 v106,v106,s36,v17
v_mfma_f32_16x16x32_bf16 a[212:215],a[124:127],v[40:43],a[212:215]
s_waitcnt lgkmcnt(6)
ds_read_b64_tr_b16 a[122:123],v2 offset:18688
v_fma_f32 v107,v107,s36,v17
v_mfma_f32_16x16x32_bf16 a[216:219],a[128:131],v[40:43],a[216:219]
ds_read_b64_tr_b16 a[124:125],v3 offset:12544
v_fma_f32 v76,v76,s36,v13
v_mfma_f32_16x16x32_bf16 a[220:223],a[132:135],v[40:43],a[220:223]
ds_read_b64_tr_b16 a[126:127],v3 offset:18688
v_fma_f32 v77,v77,s36,v13
v_mfma_f32_16x16x32_bf16 a[172:175],a[132:135],v[56:59],a[172:175]
v_exp_f32 v90,v90
v_mfma_f32_16x16x32_bf16 a[168:171],a[128:131],v[56:59],a[168:171]
v_exp_f32 v91,v91
v_mfma_f32_16x16x32_bf16 v[120:123],a[128:131],v[52:55],v[120:123]
v_cvt_pk_bf16_f32 v29,v90,v91
v_fma_f32 v78,v78,s36,v13
v_mfma_f32_16x16x32_bf16 v[124:127],a[132:135],v[52:55],v[124:127]
v_exp_f32 v96,v96
v_mfma_f32_16x16x32_bf16 v[220:223],a[132:135],v[48:51],v[220:223]
v_exp_f32 v97,v97
v_mfma_f32_16x16x32_bf16 v[216:219],a[128:131],v[48:51],v[216:219]
v_exp_f32 v98,v98
v_mfma_f32_16x16x32_bf16 v[168:171],a[128:131],v[44:47],v[168:171]
ds_read_b64_tr_b16 a[128:129],v4 offset:12544
v_cvt_pk_bf16_f32 v32,v96,v97
v_mfma_f32_16x16x32_bf16 v[172:175],a[132:135],v[44:47],v[172:175]
ds_read_b64_tr_b16 a[130:131],v4 offset:18688
v_fma_f32 v79,v79,s36,v13
v_mfma_f32_16x16x32_bf16 v[176:179],a[136:139],v[44:47],v[176:179]
s_waitcnt lgkmcnt(2)
ds_read_b64_tr_b16 a[132:133],v5 offset:12544
v_fma_f32 v84,v84,s36,v14
v_mfma_f32_16x16x32_bf16 v[180:183],a[140:143],v[44:47],v[180:183]
ds_read_b64_tr_b16 a[134:135],v5 offset:18688
v_fma_f32 v85,v85,s36,v14
v_mfma_f32_16x16x32_bf16 v[228:231],a[140:143],v[48:51],v[228:231]
v_exp_f32 v99,v99
v_mfma_f32_16x16x32_bf16 v[224:227],a[136:139],v[48:51],v[224:227]
v_cvt_pk_bf16_f32 v33,v98,v99
v_fma_f32 v86,v86,s36,v14
v_mfma_f32_16x16x32_bf16 v[128:131],a[136:139],v[52:55],v[128:131]
v_exp_f32 v104,v104
v_mfma_f32_16x16x32_bf16 v[132:135],a[140:143],v[52:55],v[132:135]
v_exp_f32 v105,v105
v_mfma_f32_16x16x32_bf16 a[180:183],a[140:143],v[56:59],a[180:183]
v_exp_f32 v106,v106
v_mfma_f32_16x16x32_bf16 a[176:179],a[136:139],v[56:59],a[176:179]
v_exp_f32 v107,v107
v_mfma_f32_16x16x32_bf16 a[224:227],a[136:139],v[40:43],a[224:227]
v_cvt_pk_bf16_f32 v36,v104,v105
v_cvt_pk_bf16_f32 v37,v106,v107
v_mfma_f32_16x16x32_bf16 a[228:231],a[140:143],v[40:43],a[228:231]
v_exp_f32 v76,v76
v_mfma_f32_16x16x32_bf16 a[232:235],a[144:147],v[40:43],a[232:235]
v_exp_f32 v77,v77
v_mfma_f32_16x16x32_bf16 a[236:239],a[148:151],v[40:43],a[236:239]
v_exp_f32 v78,v78
v_mfma_f32_16x16x32_bf16 a[188:191],a[148:151],v[56:59],a[188:191]
v_exp_f32 v79,v79
v_mfma_f32_16x16x32_bf16 a[184:187],a[144:147],v[56:59],a[184:187]
v_cvt_pk_bf16_f32 v22,v76,v77
v_cvt_pk_bf16_f32 v23,v78,v79
v_mfma_f32_16x16x32_bf16 v[136:139],a[144:147],v[52:55],v[136:139]
v_fma_f32 v87,v87,s36,v14
v_fma_f32 v92,v92,s36,v15
v_mfma_f32_16x16x32_bf16 v[140:143],a[148:151],v[52:55],v[140:143]
v_exp_f32 v84,v84
v_mfma_f32_16x16x32_bf16 v[236:239],a[148:151],v[48:51],v[236:239]
v_exp_f32 v85,v85
v_mfma_f32_16x16x32_bf16 v[232:235],a[144:147],v[48:51],v[232:235]
v_exp_f32 v86,v86
v_mfma_f32_16x16x32_bf16 v[184:187],a[144:147],v[44:47],v[184:187]
v_exp_f32 v87,v87
v_mfma_f32_16x16x32_bf16 v[188:191],a[148:151],v[44:47],v[188:191]
v_cvt_pk_bf16_f32 v26,v84,v85
v_cvt_pk_bf16_f32 v27,v86,v87
v_mfma_f32_16x16x32_bf16 v[192:195],a[120:123],v[44:47],v[192:195]
v_fma_f32 v93,v93,s36,v15
v_fma_f32 v94,v94,s36,v15
v_smfmac_f32_16x16x64_bf16 v[60:63],a[152:155],v[20:27],v18
v_fma_f32 v95,v95,s36,v15
v_mfma_f32_16x16x32_bf16 v[196:199],a[124:127],v[44:47],v[196:199]
s_waitcnt vmcnt(6) lgkmcnt(0)
v_exp_f32 v92,v92
v_mfma_f32_16x16x32_bf16 v[244:247],a[124:127],v[48:51],v[244:247]
s_barrier
v_mfma_f32_16x16x32_bf16 v[240:243],a[120:123],v[48:51],v[240:243]
ds_read_b128 a[136:139],v0 offset:0
v_fma_f32 v100,v100,s36,v16
v_mfma_f32_16x16x32_bf16 v[144:147],a[120:123],v[52:55],v[144:147]
ds_read_b128 a[140:143],v1 offset:0
v_fma_f32 v101,v101,s36,v16
v_mfma_f32_16x16x32_bf16 v[148:151],a[124:127],v[52:55],v[148:151]
ds_read_b128 a[144:147],v0 offset:128
v_fma_f32 v102,v102,s36,v16
v_mfma_f32_16x16x32_bf16 a[196:199],a[124:127],v[56:59],a[196:199]
ds_read_b128 a[148:151],v1 offset:128
v_fma_f32 v103,v103,s36,v16
v_mfma_f32_16x16x32_bf16 a[192:195],a[120:123],v[56:59],a[192:195]
v_exp_f32 v93,v93
v_mfma_f32_16x16x32_bf16 a[240:243],a[120:123],v[40:43],a[240:243]
buffer_load_dwordx4 v6,s[8:11],s21 offen offset:0 lds
v_mfma_f32_16x16x32_bf16 a[244:247],a[124:127],v[40:43],a[244:247]
ds_read_b128 a[120:123],v0 offset:256
v_cvt_pk_bf16_f32 v30,v92,v93
v_mfma_f32_16x16x32_bf16 a[248:251],a[128:131],v[40:43],a[248:251]
ds_read_b128 a[124:127],v1 offset:256
v_fma_f32 v108,v108,s36,v17
v_mfma_f32_16x16x32_bf16 a[252:255],a[132:135],v[40:43],a[252:255]
v_exp_f32 v94,v94
v_mfma_f32_16x16x32_bf16 a[204:207],a[132:135],v[56:59],a[204:207]
v_exp_f32 v95,v95
v_mfma_f32_16x16x32_bf16 a[200:203],a[128:131],v[56:59],a[200:203]
v_cvt_pk_bf16_f32 v31,v94,v95
v_fma_f32 v109,v109,s36,v17
v_mfma_f32_16x16x32_bf16 v[152:155],a[128:131],v[52:55],v[152:155]
v_exp_f32 v100,v100
v_mfma_f32_16x16x32_bf16 v[156:159],a[132:135],v[52:55],v[156:159]
v_exp_f32 v101,v101
v_mfma_f32_16x16x32_bf16 v[252:255],a[132:135],v[48:51],v[252:255]
v_exp_f32 v102,v102
v_mfma_f32_16x16x32_bf16 v[248:251],a[128:131],v[48:51],v[248:251]
v_exp_f32 v103,v103
v_mfma_f32_16x16x32_bf16 v[200:203],a[128:131],v[44:47],v[200:203]
ds_read_b128 a[128:131],v0 offset:6144
v_cvt_pk_bf16_f32 v34,v100,v101
v_mfma_f32_16x16x32_bf16 v[204:207],a[132:135],v[44:47],v[204:207]
buffer_load_dwordx4 v7,s[8:11],s21 offen offset:1024 lds
s_waitcnt lgkmcnt(1)
v_mfma_f32_16x16x32_bf16 v[72:75],a[136:139],a[0:3],0
ds_read_b128 a[132:135],v1 offset:6144
v_cvt_pk_bf16_f32 v35,v102,v103
v_mfma_f32_16x16x32_bf16 v[72:75],a[140:143],a[4:7],v[72:75]
v_fma_f32 v110,v110,s36,v17
v_fma_f32 v111,v111,s36,v17
v_smfmac_f32_16x16x64_bf16 v[64:67],a[152:155],v[28:35],v18
v_mfma_f32_16x16x32_bf16 v[72:75],a[144:147],a[8:11],v[72:75]
v_exp_f32 v108,v108
v_mfma_f32_16x16x32_bf16 v[72:75],a[148:151],a[12:15],v[72:75]
v_exp_f32 v109,v109
v_mfma_f32_16x16x32_bf16 v[72:75],a[120:123],a[16:19],v[72:75]
v_exp_f32 v110,v110
v_mfma_f32_16x16x32_bf16 v[72:75],a[124:127],a[20:23],v[72:75]
v_exp_f32 v111,v111
v_mfma_f32_16x16x32_bf16 v[80:83],a[124:127],a[44:47],0
v_cvt_pk_bf16_f32 v38,v108,v109
v_cvt_pk_bf16_f32 v39,v110,v111
v_mfma_f32_16x16x32_bf16 v[80:83],a[120:123],a[40:43],v[80:83]
v_mfma_f32_16x16x32_bf16 v[80:83],a[148:151],a[36:39],v[80:83]
v_mfma_f32_16x16x32_bf16 v[80:83],a[144:147],a[32:35],v[80:83]
buffer_load_dwordx4 v8,s[8:11],s21 offen offset:2048 lds
v_mfma_f32_16x16x32_bf16 v[80:83],a[140:143],a[28:31],v[80:83]
s_add_u32 s21,s21,12288
v_fma_f32 v72,v72,s36,v13
v_fma_f32 v73,v73,s36,v13
v_mfma_f32_16x16x32_bf16 v[80:83],a[136:139],a[24:27],v[80:83]
s_add_u32 m0,s22,24576
v_fma_f32 v74,v74,s36,v13
v_fma_f32 v75,v75,s36,v13
v_mfma_f32_16x16x32_bf16 v[88:91],a[136:139],a[48:51],0
v_exp_f32 v72,v72
v_mfma_f32_16x16x32_bf16 v[88:91],a[140:143],a[52:55],v[88:91]
v_exp_f32 v73,v73
v_mfma_f32_16x16x32_bf16 v[88:91],a[144:147],a[56:59],v[88:91]
v_fma_f32 v80,v80,s36,v14
v_fma_f32 v81,v81,s36,v14
v_mfma_f32_16x16x32_bf16 v[88:91],a[148:151],a[60:63],v[88:91]
v_fma_f32 v82,v82,s36,v14
v_fma_f32 v83,v83,s36,v14
v_mfma_f32_16x16x32_bf16 v[88:91],a[120:123],a[64:67],v[88:91]
v_exp_f32 v74,v74
v_mfma_f32_16x16x32_bf16 v[88:91],a[124:127],a[68:71],v[88:91]
v_exp_f32 v75,v75
v_mfma_f32_16x16x32_bf16 v[96:99],a[124:127],a[92:95],0
v_exp_f32 v80,v80
v_mfma_f32_16x16x32_bf16 v[96:99],a[120:123],a[88:91],v[96:99]
v_exp_f32 v81,v81
v_mfma_f32_16x16x32_bf16 v[96:99],a[148:151],a[84:87],v[96:99]
v_exp_f32 v82,v82
v_mfma_f32_16x16x32_bf16 v[96:99],a[144:147],a[80:83],v[96:99]
buffer_load_dwordx4 v6,s[4:7],s20 offen offset:0 lds
v_mfma_f32_16x16x32_bf16 v[96:99],a[140:143],a[76:79],v[96:99]
v_fma_f32 v88,v88,s36,v15
v_fma_f32 v89,v89,s36,v15
v_mfma_f32_16x16x32_bf16 v[96:99],a[136:139],a[72:75],v[96:99]
v_exp_f32 v83,v83
v_mfma_f32_16x16x32_bf16 v[104:107],a[136:139],a[96:99],0
ds_read_b128 a[136:139],v0 offset:6272
v_cvt_pk_bf16_f32 v44,v72,v73
v_mfma_f32_16x16x32_bf16 v[104:107],a[140:143],a[100:103],v[104:107]
ds_read_b128 a[140:143],v1 offset:6272
v_cvt_pk_bf16_f32 v45,v74,v75
v_mfma_f32_16x16x32_bf16 v[104:107],a[144:147],a[104:107],v[104:107]
ds_read_b128 a[144:147],v0 offset:6400
v_cvt_pk_bf16_f32 v48,v80,v81
v_mfma_f32_16x16x32_bf16 v[104:107],a[148:151],a[108:111],v[104:107]
ds_read_b128 a[148:151],v1 offset:6400
v_cvt_pk_bf16_f32 v49,v82,v83
v_mfma_f32_16x16x32_bf16 v[104:107],a[120:123],a[112:115],v[104:107]
v_exp_f32 v88,v88
v_mfma_f32_16x16x32_bf16 v[104:107],a[124:127],a[116:119],v[104:107]
s_waitcnt lgkmcnt(4)
v_exp_f32 v89,v89
v_mfma_f32_16x16x32_bf16 v[76:79],a[128:131],a[0:3],0
v_cvt_pk_bf16_f32 v52,v88,v89
v_mfma_f32_16x16x32_bf16 v[76:79],a[132:135],a[4:7],v[76:79]
s_waitcnt lgkmcnt(3)
v_mfma_f32_16x16x32_bf16 v[76:79],a[136:139],a[8:11],v[76:79]
buffer_load_dwordx4 v7,s[4:7],s20 offen offset:1024 lds
s_waitcnt lgkmcnt(2)
v_mfma_f32_16x16x32_bf16 v[76:79],a[140:143],a[12:15],v[76:79]
s_waitcnt lgkmcnt(1)
v_mfma_f32_16x16x32_bf16 v[76:79],a[144:147],a[16:19],v[76:79]
s_waitcnt lgkmcnt(0)
v_mfma_f32_16x16x32_bf16 v[76:79],a[148:151],a[20:23],v[76:79]
v_mfma_f32_16x16x32_bf16 v[84:87],a[148:151],a[44:47],0
v_mfma_f32_16x16x32_bf16 v[84:87],a[144:147],a[40:43],v[84:87]
v_mfma_f32_16x16x32_bf16 v[84:87],a[140:143],a[36:39],v[84:87]
v_mfma_f32_16x16x32_bf16 v[84:87],a[136:139],a[32:35],v[84:87]
v_mfma_f32_16x16x32_bf16 v[84:87],a[132:135],a[28:31],v[84:87]
v_mfma_f32_16x16x32_bf16 v[84:87],a[128:131],a[24:27],v[84:87]
v_mfma_f32_16x16x32_bf16 v[92:95],a[128:131],a[48:51],0
v_mfma_f32_16x16x32_bf16 v[92:95],a[132:135],a[52:55],v[92:95]
buffer_load_dwordx4 v8,s[4:7],s20 offen offset:2048 lds
v_mfma_f32_16x16x32_bf16 v[92:95],a[136:139],a[56:59],v[92:95]
s_add_u32 s20,s20,12288
v_mfma_f32_16x16x32_bf16 v[92:95],a[140:143],a[60:63],v[92:95]
v_mfma_f32_16x16x32_bf16 v[92:95],a[144:147],a[64:67],v[92:95]
v_mfma_f32_16x16x32_bf16 v[92:95],a[148:151],a[68:71],v[92:95]
v_mfma_f32_16x16x32_bf16 v[100:103],a[148:151],a[92:95],0
v_mfma_f32_16x16x32_bf16 v[100:103],a[144:147],a[88:91],v[100:103]
ds_read_b64_tr_b16 a[120:121],v2 offset:24576
v_mfma_f32_16x16x32_bf16 v[100:103],a[140:143],a[84:87],v[100:103]
ds_read_b64_tr_b16 a[122:123],v2 offset:30720
v_mfma_f32_16x16x32_bf16 v[100:103],a[136:139],a[80:83],v[100:103]
ds_read_b64_tr_b16 a[124:125],v3 offset:24576
v_mfma_f32_16x16x32_bf16 v[100:103],a[132:135],a[76:79],v[100:103]
ds_read_b64_tr_b16 a[126:127],v3 offset:30720
v_mfma_f32_16x16x32_bf16 v[100:103],a[128:131],a[72:75],v[100:103]
v_mfma_f32_16x16x32_bf16 v[108:111],a[128:131],a[96:99],0
ds_read_b64_tr_b16 a[128:129],v4 offset:24576
v_mfma_f32_16x16x32_bf16 v[108:111],a[132:135],a[100:103],v[108:111]
ds_read_b64_tr_b16 a[130:131],v4 offset:30720
v_mfma_f32_16x16x32_bf16 v[108:111],a[136:139],a[104:107],v[108:111]
ds_read_b64_tr_b16 a[132:133],v5 offset:24576
v_mfma_f32_16x16x32_bf16 v[108:111],a[140:143],a[108:111],v[108:111]
ds_read_b64_tr_b16 a[134:135],v5 offset:30720
v_mfma_f32_16x16x32_bf16 v[108:111],a[144:147],a[112:115],v[108:111]
v_mfma_f32_16x16x32_bf16 v[108:111],a[148:151],a[116:119],v[108:111]
s_mov_b32 s38,0
s_branch L_loop5
L_tr44:
s_waitcnt vmcnt(43)
s_waitcnt lgkmcnt(3)
v_mfma_f32_16x16x32_bf16 v[160:163],a[120:123],v[20:23],v[160:163]
s_add_u32 m0,s24,0
ds_read_b128 a[4:7],v12 offset:0
v_fma_f32 v79,v79,s36,v13
v_mfma_f32_16x16x32_bf16 v[164:167],a[124:127],v[20:23],v[164:167]
ds_read_b128 a[12:15],v12 offset:128
v_fma_f32 v100,v100,s36,v16
v_mfma_f32_16x16x32_bf16 v[212:215],a[124:127],v[24:27],v[212:215]
ds_read_b128 a[20:23],v12 offset:256
v_fma_f32 v101,v101,s36,v16
v_mfma_f32_16x16x32_bf16 v[208:211],a[120:123],v[24:27],v[208:211]
ds_read_b128 a[8:11],v11 offset:128
v_fma_f32 v89,v89,s36,v15
v_mfma_f32_16x16x32_bf16 v[112:115],a[120:123],v[28:31],v[112:115]
ds_read_b128 a[0:3],v11 offset:0
v_fma_f32 v76,v76,s36,v13
v_mfma_f32_16x16x32_bf16 v[116:119],a[124:127],v[28:31],v[116:119]
ds_read_b128 a[16:19],v11 offset:256
v_fma_f32 v83,v83,s36,v14
v_mfma_f32_16x16x32_bf16 a[164:167],a[124:127],v[32:35],a[164:167]
ds_read_b64_tr_b16 a[138:139],v2 offset:30848
v_fma_f32 v90,v90,s36,v15
v_mfma_f32_16x16x32_bf16 a[160:163],a[120:123],v[32:35],a[160:163]
s_waitcnt lgkmcnt(6)
ds_read_b64_tr_b16 a[136:137],v2 offset:24704
v_fma_f32 v88,v88,s36,v15
v_mfma_f32_16x16x32_bf16 a[168:171],a[128:131],v[32:35],a[168:171]
ds_read_b64_tr_b16 a[142:143],v3 offset:30848
ds_read_b64_tr_b16 a[140:141],v3 offset:24704
ds_read_b64_tr_b16 a[146:147],v4 offset:30848
ds_read_b64_tr_b16 a[144:145],v4 offset:24704
ds_read_b64_tr_b16 a[150:151],v5 offset:30848
ds_read_b64_tr_b16 a[148:149],v5 offset:24704
ds_read_b128 a[32:35],v11 offset:6272
v_mfma_f32_16x16x32_bf16 a[172:175],a[132:135],v[32:35],a[172:175]
v_fma_f32 v91,v91,s36,v15
ds_read_b128 a[40:43],v11 offset:6400
v_mfma_f32_16x16x32_bf16 v[124:127],a[132:135],v[28:31],v[124:127]
s_waitcnt lgkmcnt(10)
buffer_load_dwordx4 v6,s[12:15],s28 offen offset:0 nt lds
v_mfma_f32_16x16x32_bf16 v[120:123],a[128:131],v[28:31],v[120:123]
ds_read_b64_tr_b16 a[122:123],v2 offset:30976
ds_read_b64_tr_b16 a[120:121],v2 offset:24832
ds_read_b64_tr_b16 a[124:125],v3 offset:24832
ds_read_b64_tr_b16 a[126:127],v3 offset:30976
ds_read_b128 a[44:47],v12 offset:6400
v_mfma_f32_16x16x32_bf16 v[216:219],a[128:131],v[24:27],v[216:219]
v_fma_f32 v93,v93,s36,v15
ds_read_b128 a[28:31],v12 offset:6144
v_mfma_f32_16x16x32_bf16 v[220:223],a[132:135],v[24:27],v[220:223]
v_fma_f32 v98,v98,s36,v16
ds_read_b128 a[36:39],v12 offset:6272
v_mfma_f32_16x16x32_bf16 v[172:175],a[132:135],v[20:23],v[172:175]
buffer_load_dwordx4 v7,s[12:15],s28 offen offset:1024 nt lds
v_mfma_f32_16x16x32_bf16 v[168:171],a[128:131],v[20:23],v[168:171]
s_waitcnt lgkmcnt(7)
ds_read_b64_tr_b16 a[130:131],v4 offset:30976
ds_read_b128 a[24:27],v11 offset:6144
v_mfma_f32_16x16x32_bf16 v[176:179],a[136:139],v[20:23],v[176:179]
v_fma_f32 v82,v82,s36,v14
v_exp_f32 v93,v93
v_mfma_f32_16x16x32_bf16 v[180:183],a[140:143],v[20:23],v[180:183]
ds_read_b64_tr_b16 a[128:129],v4 offset:24832
v_fma_f32 v85,v85,s36,v14
v_mfma_f32_16x16x32_bf16 v[228:231],a[140:143],v[24:27],v[228:231]
ds_read_b64_tr_b16 a[134:135],v5 offset:30976
v_exp_f32 v82,v82
v_mfma_f32_16x16x32_bf16 v[224:227],a[136:139],v[24:27],v[224:227]
ds_read_b64_tr_b16 a[132:133],v5 offset:24832
v_fma_f32 v84,v84,s36,v14
v_mfma_f32_16x16x32_bf16 v[128:131],a[136:139],v[28:31],v[128:131]
v_exp_f32 v84,v84
v_mfma_f32_16x16x32_bf16 v[132:135],a[140:143],v[28:31],v[132:135]
buffer_load_dwordx4 v8,s[12:15],s28 offen offset:2048 nt lds
v_mfma_f32_16x16x32_bf16 a[180:183],a[140:143],v[32:35],a[180:183]
s_add_u32 s28,s28,3072
v_fma_f32 v103,v103,s36,v16
v_exp_f32 v103,v103
v_mfma_f32_16x16x32_bf16 a[176:179],a[136:139],v[32:35],a[176:179]
s_add_u32 m0,s24,3072
v_fma_f32 v87,v87,s36,v14
v_exp_f32 v87,v87
v_mfma_f32_16x16x32_bf16 a[184:187],a[144:147],v[32:35],a[184:187]
v_fma_f32 v77,v77,s36,v13
v_exp_f32 v77,v77
v_mfma_f32_16x16x32_bf16 a[188:191],a[148:151],v[32:35],a[188:191]
v_fma_f32 v97,v97,s36,v16
v_exp_f32 v91,v91
v_mfma_f32_16x16x32_bf16 v[140:143],a[148:151],v[28:31],v[140:143]
v_fma_f32 v102,v102,s36,v16
v_exp_f32 v85,v85
v_mfma_f32_16x16x32_bf16 v[136:139],a[144:147],v[28:31],v[136:139]
v_exp_f32 v89,v89
v_mfma_f32_16x16x32_bf16 v[232:235],a[144:147],v[24:27],v[232:235]
buffer_load_dwordx4 v6,s[12:15],s28 offen offset:0 nt lds
v_mfma_f32_16x16x32_bf16 v[236:239],a[148:151],v[24:27],v[236:239]
v_fma_f32 v92,v92,s36,v15
v_exp_f32 v101,v101
v_mfma_f32_16x16x32_bf16 v[188:191],a[148:151],v[20:23],v[188:191]
v_fma_f32 v94,v94,s36,v15
v_fma_f32 v95,v95,s36,v15
v_mfma_f32_16x16x32_bf16 v[184:187],a[144:147],v[20:23],v[184:187]
s_waitcnt lgkmcnt(0)
v_exp_f32 v95,v95
v_mfma_f32_16x16x32_bf16 v[192:195],a[120:123],v[20:23],v[192:195]
v_fma_f32 v86,v86,s36,v14
v_fma_f32 v78,v78,s36,v13
v_mfma_f32_16x16x32_bf16 v[196:199],a[124:127],v[20:23],v[196:199]
v_exp_f32 v92,v92
v_mfma_f32_16x16x32_bf16 v[244:247],a[124:127],v[24:27],v[244:247]
v_exp_f32 v78,v78
v_mfma_f32_16x16x32_bf16 v[240:243],a[120:123],v[24:27],v[240:243]
buffer_load_dwordx4 v7,s[12:15],s28 offen offset:1024 nt lds
v_mfma_f32_16x16x32_bf16 v[144:147],a[120:123],v[28:31],v[144:147]
v_exp_f32 v94,v94
v_mfma_f32_16x16x32_bf16 v[148:151],a[124:127],v[28:31],v[148:151]
v_exp_f32 v90,v90
v_mfma_f32_16x16x32_bf16 a[196:199],a[124:127],v[32:35],a[196:199]
v_fma_f32 v96,v96,s36,v16
v_exp_f32 v96,v96
v_mfma_f32_16x16x32_bf16 a[192:195],a[120:123],v[32:35],a[192:195]
v_fma_f32 v99,v99,s36,v16
v_exp_f32 v83,v83
v_mfma_f32_16x16x32_bf16 a[200:203],a[128:131],v[32:35],a[200:203]
v_exp_f32 v97,v97
v_mfma_f32_16x16x32_bf16 a[204:207],a[132:135],v[32:35],a[204:207]
v_exp_f32 v88,v88
v_mfma_f32_16x16x32_bf16 v[156:159],a[132:135],v[28:31],v[156:159]
v_exp_f32 v98,v98
v_mfma_f32_16x16x32_bf16 v[152:155],a[128:131],v[28:31],v[152:155]
buffer_load_dwordx4 v8,s[12:15],s28 offen offset:2048 nt lds
s_waitcnt vmcnt(20)
s_barrier
v_mfma_f32_16x16x32_bf16 v[248:251],a[128:131],v[24:27],v[248:251]
s_add_u32 s28,s28,3072
ds_read_b64_tr_b16 a[138:139],v2 offset:6144
v_exp_f32 v79,v79
v_mfma_f32_16x16x32_bf16 v[252:255],a[132:135],v[24:27],v[252:255]
s_add_u32 m0,s22,0
ds_read_b64_tr_b16 a[136:137],v2 offset:0
buffer_load_dwordx4 v6,s[4:7],s25 offen offset:0 lds
v_mfma_f32_16x16x32_bf16 v[204:207],a[132:135],v[20:23],v[204:207]
buffer_load_dwordx4 v7,s[4:7],s25 offen offset:1024 lds
v_mfma_f32_16x16x32_bf16 v[200:203],a[128:131],v[20:23],v[200:203]
buffer_load_dwordx4 v8,s[4:7],s25 offen offset:2048 lds
ds_read_b64_tr_b16 a[142:143],v3 offset:6144
ds_read_b64_tr_b16 a[140:141],v3 offset:0
ds_read_b64_tr_b16 a[144:145],v4 offset:0
ds_read_b64_tr_b16 a[146:147],v4 offset:6144
ds_read_b64_tr_b16 a[148:149],v5 offset:0
ds_read_b64_tr_b16 a[150:151],v5 offset:6144
v_exp_f32 v100,v100
v_cvt_pk_bf16_f32 v47,v78,v79
v_cvt_pk_bf16_f32 v49,v82,v83
v_exp_f32 v76,v76
v_exp_f32 v102,v102
v_exp_f32 v86,v86
v_cvt_pk_bf16_f32 v59,v102,v103
v_exp_f32 v99,v99
v_cvt_pk_bf16_f32 v50,v84,v85
v_cvt_pk_bf16_f32 v57,v98,v99
v_cvt_pk_bf16_f32 v55,v94,v95
v_cvt_pk_bf16_f32 v54,v92,v93
v_cvt_pk_bf16_f32 v58,v100,v101
v_cvt_pk_bf16_f32 v51,v86,v87
v_cvt_pk_bf16_f32 v53,v90,v91
v_cvt_pk_bf16_f32 v46,v76,v77
v_cvt_pk_bf16_f32 v52,v88,v89
v_cvt_pk_bf16_f32 v56,v96,v97
v_smfmac_f32_16x16x64_bf16 v[60:63],a[152:155],v[44:51],v18
v_subrev_u32 v10,18432,v10
v_smfmac_f32_16x16x64_bf16 v[64:67],a[152:155],v[52:59],v18
s_waitcnt lgkmcnt(0)
v_mfma_f32_16x16x32_bf16 v[160:163],a[136:139],v[44:47],v[160:163]
s_add_u32 s87,s42,18432
ds_read_b64_tr_b16 a[120:121],v2 offset:128
v_mbcnt_lo_u32_b32 v39,-1,0
v_mfma_f32_16x16x32_bf16 v[164:167],a[140:143],v[44:47],v[164:167]
ds_read_b64_tr_b16 a[122:123],v2 offset:6272
v_mbcnt_hi_u32_b32 v39,-1,v39
v_mfma_f32_16x16x32_bf16 v[212:215],a[140:143],v[48:51],v[212:215]
ds_read_b64_tr_b16 a[124:125],v3 offset:128
v_and_b32 v38,7,v39
v_mfma_f32_16x16x32_bf16 v[208:211],a[136:139],v[48:51],v[208:211]
ds_read_b64_tr_b16 a[126:127],v3 offset:6272
v_add_f32 v60,v60,v61
v_mfma_f32_16x16x32_bf16 v[112:115],a[136:139],v[52:55],v[112:115]
ds_read_b64_tr_b16 a[128:129],v4 offset:128
v_add_f32 v62,v62,v63
v_mfma_f32_16x16x32_bf16 v[116:119],a[140:143],v[52:55],v[116:119]
ds_read_b64_tr_b16 a[130:131],v4 offset:6272
ds_read_b64_tr_b16 a[132:133],v5 offset:128
ds_read_b64_tr_b16 a[134:135],v5 offset:6272
v_mfma_f32_16x16x32_bf16 a[164:167],a[140:143],v[56:59],a[164:167]
ds_read_b64_tr_b16 a[140:141],v3 offset:256
v_add_f32 v64,v64,v65
v_mfma_f32_16x16x32_bf16 a[160:163],a[136:139],v[56:59],a[160:163]
ds_read_b64_tr_b16 a[136:137],v2 offset:256
v_add_f32 v66,v66,v67
v_mfma_f32_16x16x32_bf16 a[168:171],a[144:147],v[56:59],a[168:171]
ds_read_b64_tr_b16 a[138:139],v2 offset:6400
v_max3_f32 v19,v60,v62,v64
v_mfma_f32_16x16x32_bf16 a[172:175],a[148:151],v[56:59],a[172:175]
ds_read_b64_tr_b16 a[142:143],v3 offset:6400
v_max_f32 v19,v19,v66
v_mfma_f32_16x16x32_bf16 v[124:127],a[148:151],v[52:55],v[124:127]
v_rcp_f32 v66,v66
v_mfma_f32_16x16x32_bf16 v[120:123],a[144:147],v[52:55],v[120:123]
v_accvgpr_read_b32 v80,a164
v_accvgpr_read_b32 v81,a165
v_mfma_f32_16x16x32_bf16 v[216:219],a[144:147],v[48:51],v[216:219]
v_accvgpr_read_b32 v82,a166
v_accvgpr_read_b32 v83,a167
v_mfma_f32_16x16x32_bf16 v[220:223],a[148:151],v[48:51],v[220:223]
v_accvgpr_read_b32 v72,a160
v_accvgpr_read_b32 v73,a161
v_mfma_f32_16x16x32_bf16 v[172:175],a[148:151],v[44:47],v[172:175]
ds_read_b64_tr_b16 a[148:149],v5 offset:256
v_accvgpr_read_b32 v74,a162
v_mfma_f32_16x16x32_bf16 v[168:171],a[144:147],v[44:47],v[168:171]
s_waitcnt lgkmcnt(2)
ds_read_b64_tr_b16 a[144:145],v4 offset:256
v_accvgpr_read_b32 v75,a163
v_mfma_f32_16x16x32_bf16 v[176:179],a[120:123],v[44:47],v[176:179]
ds_read_b64_tr_b16 a[146:147],v4 offset:6400
v_accvgpr_read_b32 v88,a168
v_mfma_f32_16x16x32_bf16 v[180:183],a[124:127],v[44:47],v[180:183]
ds_read_b64_tr_b16 a[150:151],v5 offset:6400
v_accvgpr_read_b32 v89,a169
v_mfma_f32_16x16x32_bf16 v[228:231],a[124:127],v[48:51],v[228:231]
v_accvgpr_read_b32 v90,a170
v_accvgpr_read_b32 v91,a171
v_mfma_f32_16x16x32_bf16 v[224:227],a[120:123],v[48:51],v[224:227]
v_accvgpr_read_b32 v96,a172
v_accvgpr_read_b32 v97,a173
v_mfma_f32_16x16x32_bf16 v[128:131],a[120:123],v[52:55],v[128:131]
v_accvgpr_read_b32 v98,a174
v_accvgpr_read_b32 v99,a175
v_mfma_f32_16x16x32_bf16 v[132:135],a[124:127],v[52:55],v[132:135]
v_cmp_ngt_f32 vcc,s37,v19
v_lshrrev_b32 v19,5,v39
v_mfma_f32_16x16x32_bf16 a[180:183],a[124:127],v[56:59],a[180:183]
v_xor_b32 v38,v38,v19
v_and_b32 v19,15,v39
v_mfma_f32_16x16x32_bf16 a[176:179],a[120:123],v[56:59],a[176:179]
s_cmp_lg_u64 vcc,0
v_lshl_add_u32 v19,v19,7,s24
v_lshl_add_u32 v19,v38,4,v19
v_mfma_f32_16x16x32_bf16 a[184:187],a[128:131],v[56:59],a[184:187]
s_cselect_b32 s62,s32,0
v_bfe_u32 v38,v39,4,1
v_lshl_add_u32 v36,v38,3,v19
v_mfma_f32_16x16x32_bf16 a[188:191],a[132:135],v[56:59],a[188:191]
s_or_b32 s31,s31,s62
v_xor_b32 v37,32,v36
v_bfe_u32 v19,v39,3,1
v_mfma_f32_16x16x32_bf16 v[140:143],a[132:135],v[52:55],v[140:143]
s_lshl_b32 s32,s32,1
v_xor_b32 v38,64,v36
v_xor_b32 v39,96,v36
v_lshlrev_b32 v19,11,v19
v_accvgpr_read_b32 v84,a180
v_accvgpr_read_b32 v85,a181
v_pk_mul_f32 v[72:73],v[72:73],v[66:67] op_sel_hi:[1,0]
v_pk_mul_f32 v[74:75],v[74:75],v[66:67] op_sel_hi:[1,0]
v_pk_mul_f32 v[80:81],v[80:81],v[66:67] op_sel_hi:[1,0]
v_pk_mul_f32 v[82:83],v[82:83],v[66:67] op_sel_hi:[1,0]
v_pk_mul_f32 v[84:85],v[84:85],v[66:67] op_sel_hi:[1,0]
v_accvgpr_read_b32 v86,a182
v_accvgpr_read_b32 v87,a183
v_pk_mul_f32 v[86:87],v[86:87],v[66:67] op_sel_hi:[1,0]
v_accvgpr_read_b32 v76,a176
v_accvgpr_read_b32 v77,a177
v_pk_mul_f32 v[76:77],v[76:77],v[66:67] op_sel_hi:[1,0]
v_accvgpr_read_b32 v78,a178
v_accvgpr_read_b32 v79,a179
v_pk_mul_f32 v[78:79],v[78:79],v[66:67] op_sel_hi:[1,0]
v_accvgpr_read_b32 v92,a184
v_accvgpr_read_b32 v93,a185
v_mfma_f32_16x16x32_bf16 v[136:139],a[128:131],v[52:55],v[136:139]
s_add_u32 m0,s23,0
v_accvgpr_read_b32 v94,a186
v_accvgpr_read_b32 v95,a187
v_accvgpr_read_b32 v100,a188
v_accvgpr_read_b32 v101,a189
v_accvgpr_read_b32 v102,a190
v_pk_mul_f32 v[88:89],v[88:89],v[66:67] op_sel_hi:[1,0]
v_pk_mul_f32 v[90:91],v[90:91],v[66:67] op_sel_hi:[1,0]
v_pk_mul_f32 v[92:93],v[92:93],v[66:67] op_sel_hi:[1,0]
v_pk_mul_f32 v[94:95],v[94:95],v[66:67] op_sel_hi:[1,0]
v_accvgpr_read_b32 v103,a191
v_cvt_pk_bf16_f32 v72,v72,v73
v_mfma_f32_16x16x32_bf16 v[232:235],a[128:131],v[48:51],v[232:235]
v_cvt_pk_bf16_f32 v76,v76,v77
v_cvt_pk_bf16_f32 v80,v80,v81
v_cvt_pk_bf16_f32 v84,v84,v85
v_cvt_pk_bf16_f32 v73,v74,v75
v_cvt_pk_bf16_f32 v77,v78,v79
ds_write2st64_b64 v36,v[72:73],v[76:77] offset0:36 offset1:40
v_pk_mul_f32 v[96:97],v[96:97],v[66:67] op_sel_hi:[1,0]
v_pk_mul_f32 v[98:99],v[98:99],v[66:67] op_sel_hi:[1,0]
v_pk_mul_f32 v[100:101],v[100:101],v[66:67] op_sel_hi:[1,0]
v_pk_mul_f32 v[102:103],v[102:103],v[66:67] op_sel_hi:[1,0]
v_cvt_pk_bf16_f32 v88,v88,v89
v_cvt_pk_bf16_f32 v92,v92,v93
v_mfma_f32_16x16x32_bf16 v[236:239],a[132:135],v[48:51],v[236:239]
v_cvt_pk_bf16_f32 v81,v82,v83
v_cvt_pk_bf16_f32 v85,v86,v87
v_mfma_f32_16x16x32_bf16 v[188:191],a[132:135],v[44:47],v[188:191]
v_cvt_pk_bf16_f32 v96,v96,v97
v_cvt_pk_bf16_f32 v100,v100,v101
v_mfma_f32_16x16x32_bf16 v[184:187],a[128:131],v[44:47],v[184:187]
ds_write2st64_b64 v37,v[80:81],v[84:85] offset0:36 offset1:40
v_mfma_f32_16x16x32_bf16 v[192:195],a[136:139],v[44:47],v[192:195]
s_waitcnt lgkmcnt(1)
v_cvt_pk_bf16_f32 v89,v90,v91
v_cvt_pk_bf16_f32 v93,v94,v95
v_mfma_f32_16x16x32_bf16 v[196:199],a[140:143],v[44:47],v[196:199]
v_cvt_pk_bf16_f32 v97,v98,v99
v_cvt_pk_bf16_f32 v101,v102,v103
v_mfma_f32_16x16x32_bf16 v[244:247],a[140:143],v[48:51],v[244:247]
v_rcp_f32 v62,v62
v_mfma_f32_16x16x32_bf16 v[240:243],a[136:139],v[48:51],v[240:243]
ds_write2st64_b64 v38,v[88:89],v[92:93] offset0:36 offset1:40
v_mfma_f32_16x16x32_bf16 v[144:147],a[136:139],v[52:55],v[144:147]
v_rcp_f32 v64,v64
v_mfma_f32_16x16x32_bf16 v[148:151],a[140:143],v[52:55],v[148:151]
v_rcp_f32 v60,v60
v_mfma_f32_16x16x32_bf16 a[196:199],a[140:143],v[56:59],a[196:199]
v_mfma_f32_16x16x32_bf16 a[192:195],a[136:139],v[56:59],a[192:195]
ds_write2st64_b64 v39,v[96:97],v[100:101] offset0:36 offset1:40
v_mfma_f32_16x16x32_bf16 a[200:203],a[144:147],v[56:59],a[200:203]
v_mfma_f32_16x16x32_bf16 a[204:207],a[148:151],v[56:59],a[204:207]
ds_read_b128 v[104:107],v10 offset:18432
v_mfma_f32_16x16x32_bf16 v[156:159],a[148:151],v[52:55],v[156:159]
s_waitcnt vmcnt(15)
ds_read_b128 a[68:71],v12 offset:12544
v_accvgpr_read_b32 v84,a196
ds_read_b128 a[64:67],v11 offset:12544
v_accvgpr_read_b32 v85,a197
ds_read_b128 a[60:63],v12 offset:12416
v_pk_mul_f32 v[84:85],v[84:85],v[66:67] op_sel_hi:[1,0]
ds_read_b128 a[56:59],v11 offset:12416
v_accvgpr_read_b32 v86,a198
ds_read_b128 a[52:55],v12 offset:12288
v_accvgpr_read_b32 v87,a199
ds_read_b128 a[48:51],v11 offset:12288
v_pk_mul_f32 v[86:87],v[86:87],v[66:67] op_sel_hi:[1,0]
ds_read_b128 v[108:111],v10 offset:19456
s_waitcnt lgkmcnt(7)
buffer_store_dwordx4 v[104:107],v9,s[16:19],s87 offen offset:0 nt
ds_read_b128 v[72:75],v10 offset:20480
v_accvgpr_read_b32 v80,a192
ds_read_b128 v[76:79],v10 offset:21504
v_accvgpr_read_b32 v81,a193
v_pk_mul_f32 v[80:81],v[80:81],v[66:67] op_sel_hi:[1,0]
v_accvgpr_read_b32 v82,a194
v_accvgpr_read_b32 v83,a195
v_pk_mul_f32 v[82:83],v[82:83],v[66:67] op_sel_hi:[1,0]
v_accvgpr_read_b32 v88,a200
v_accvgpr_read_b32 v89,a201
v_mfma_f32_16x16x32_bf16 v[152:155],a[144:147],v[52:55],v[152:155]
v_accvgpr_read_b32 v90,a202
v_accvgpr_read_b32 v91,a203
v_accvgpr_read_b32 v92,a204
v_accvgpr_read_b32 v93,a205
v_accvgpr_read_b32 v94,a206
v_pk_mul_f32 v[88:89],v[88:89],v[66:67] op_sel_hi:[1,0]
v_pk_mul_f32 v[90:91],v[90:91],v[66:67] op_sel_hi:[1,0]
v_accvgpr_read_b32 v95,a207
v_cvt_pk_bf16_f32 v80,v80,v81
v_mfma_f32_16x16x32_bf16 v[248:251],a[144:147],v[48:51],v[248:251]
s_waitcnt lgkmcnt(1)
v_cvt_pk_bf16_f32 v81,v82,v83
ds_write_b64 v36,v[80:81] offset:18432
buffer_store_dwordx4 v[108:111],v9,s[16:19],s87 offen offset:3072 nt
v_pk_mul_f32 v[92:93],v[92:93],v[66:67] op_sel_hi:[1,0]
v_pk_mul_f32 v[94:95],v[94:95],v[66:67] op_sel_hi:[1,0]
v_pk_mul_f32 v[208:209],v[208:209],v[62:63] op_sel_hi:[1,0]
v_pk_mul_f32 v[210:211],v[210:211],v[62:63] op_sel_hi:[1,0]
v_pk_mul_f32 v[224:225],v[224:225],v[62:63] op_sel_hi:[1,0]
v_pk_mul_f32 v[226:227],v[226:227],v[62:63] op_sel_hi:[1,0]
v_pk_mul_f32 v[212:213],v[212:213],v[62:63] op_sel_hi:[1,0]
v_pk_mul_f32 v[214:215],v[214:215],v[62:63] op_sel_hi:[1,0]
v_pk_mul_f32 v[228:229],v[228:229],v[62:63] op_sel_hi:[1,0]
v_pk_mul_f32 v[230:231],v[230:231],v[62:63] op_sel_hi:[1,0]
v_pk_mul_f32 v[216:217],v[216:217],v[62:63] op_sel_hi:[1,0]
buffer_store_dwordx4 v[72:75],v9,s[16:19],s87 offen offset:128 nt
v_pk_mul_f32 v[218:219],v[218:219],v[62:63] op_sel_hi:[1,0]
v_pk_mul_f32 v[232:233],v[232:233],v[62:63] op_sel_hi:[1,0]
v_pk_mul_f32 v[234:235],v[234:235],v[62:63] op_sel_hi:[1,0]
v_pk_mul_f32 v[220:221],v[220:221],v[62:63] op_sel_hi:[1,0]
v_pk_mul_f32 v[222:223],v[222:223],v[62:63] op_sel_hi:[1,0]
v_pk_mul_f32 v[236:237],v[236:237],v[62:63] op_sel_hi:[1,0]
v_pk_mul_f32 v[238:239],v[238:239],v[62:63] op_sel_hi:[1,0]
v_add_u32 v36,v36,v19
v_cvt_pk_bf16_f32 v84,v84,v85
v_mfma_f32_16x16x32_bf16 v[252:255],a[148:151],v[48:51],v[252:255]
v_cvt_pk_bf16_f32 v88,v88,v89
v_cvt_pk_bf16_f32 v85,v86,v87
v_mfma_f32_16x16x32_bf16 v[204:207],a[148:151],v[44:47],v[204:207]
s_waitcnt lgkmcnt(0)
ds_write_b64 v37,v[84:85] offset:18432
buffer_store_dwordx4 v[76:79],v9,s[16:19],s87 offen offset:3200 nt
v_pk_mul_f32 v[240:241],v[240:241],v[62:63] op_sel_hi:[1,0]
v_pk_mul_f32 v[242:243],v[242:243],v[62:63] op_sel_hi:[1,0]
v_pk_mul_f32 v[112:113],v[112:113],v[64:65] op_sel_hi:[1,0]
v_pk_mul_f32 v[114:115],v[114:115],v[64:65] op_sel_hi:[1,0]
v_add_u32 v37,v37,v19
v_cvt_pk_bf16_f32 v92,v92,v93
v_mfma_f32_16x16x32_bf16 v[200:203],a[144:147],v[44:47],v[200:203]
v_cvt_pk_bf16_f32 v89,v90,v91
ds_write_b64 v38,v[88:89] offset:18432
v_add_u32 v38,v38,v19
v_cvt_pk_bf16_f32 v93,v94,v95
v_cvt_pk_bf16_f32 v208,v208,v209
v_cvt_pk_bf16_f32 v224,v224,v225
ds_write_b64 v39,v[92:93] offset:18432
ds_read_b128 v[96:99],v10 offset:18432
v_add_u32 v39,v39,v19
ds_read_b128 v[100:103],v10 offset:19456
v_cvt_pk_bf16_f32 v212,v212,v213
v_cvt_pk_bf16_f32 v228,v228,v229
v_cvt_pk_bf16_f32 v209,v210,v211
v_cvt_pk_bf16_f32 v225,v226,v227
ds_write2st64_b64 v36,v[208:209],v[224:225] offset0:12 offset1:14
v_cvt_pk_bf16_f32 v216,v216,v217
v_cvt_pk_bf16_f32 v232,v232,v233
v_cvt_pk_bf16_f32 v213,v214,v215
v_cvt_pk_bf16_f32 v229,v230,v231
v_cvt_pk_bf16_f32 v220,v220,v221
v_cvt_pk_bf16_f32 v236,v236,v237
v_cvt_pk_bf16_f32 v217,v218,v219
v_cvt_pk_bf16_f32 v233,v234,v235
s_waitcnt vmcnt(4)
s_barrier
s_waitcnt lgkmcnt(2)
buffer_store_dwordx4 v[96:99],v9,s[16:19],s87 offen offset:256 nt
ds_read_b128 a[140:143],v1 offset:256
v_cvt_pk_bf16_f32 v240,v240,v241
ds_read_b128 a[136:139],v0 offset:256
v_cvt_pk_bf16_f32 v112,v112,v113
ds_read_b128 a[132:135],v1 offset:128
v_cvt_pk_bf16_f32 v221,v222,v223
ds_write2st64_b64 v37,v[212:213],v[228:229] offset0:12 offset1:14
v_cvt_pk_bf16_f32 v237,v238,v239
v_cvt_pk_bf16_f32 v241,v242,v243
v_cvt_pk_bf16_f32 v113,v114,v115
buffer_load_dwordx4 v6,s[8:11],s25 offen offset:0 lds
ds_read_b128 a[128:131],v0 offset:128
s_waitcnt lgkmcnt(5)
buffer_store_dwordx4 v[100:103],v9,s[16:19],s87 offen offset:3328 nt
ds_read_b128 a[124:127],v1 offset:0
v_mov_b32 v66,0
ds_read_b128 a[120:123],v0 offset:0
s_waitcnt lgkmcnt(5)
v_mfma_f32_16x16x32_bf16 v[72:75],a[140:143],a[20:23],0
v_mov_b32 v67,0
ds_read_b128 a[144:147],v0 offset:6144
v_mfma_f32_16x16x32_bf16 v[72:75],a[136:139],a[16:19],v[72:75]
ds_write2st64_b64 v38,v[216:217],v[232:233] offset0:12 offset1:14
v_pk_mul_f32 v[244:245],v[244:245],v[62:63] op_sel_hi:[1,0]
v_pk_mul_f32 v[246:247],v[246:247],v[62:63] op_sel_hi:[1,0]
v_pk_mul_f32 v[116:117],v[116:117],v[64:65] op_sel_hi:[1,0]
buffer_load_dwordx4 v7,s[8:11],s25 offen offset:1024 lds
ds_read_b128 a[148:151],v1 offset:6144
v_pk_mul_f32 v[118:119],v[118:119],v[64:65] op_sel_hi:[1,0]
v_cvt_pk_bf16_f32 v244,v244,v245
v_cvt_pk_bf16_f32 v116,v116,v117
s_waitcnt lgkmcnt(4)
v_mfma_f32_16x16x32_bf16 v[72:75],a[132:135],a[12:15],v[72:75]
ds_write2st64_b64 v39,v[220:221],v[236:237] offset0:12 offset1:14
v_mfma_f32_16x16x32_bf16 v[72:75],a[128:131],a[8:11],v[72:75]
v_cvt_pk_bf16_f32 v245,v246,v247
v_cvt_pk_bf16_f32 v117,v118,v119
v_mfma_f32_16x16x32_bf16 v[72:75],a[124:127],a[4:7],v[72:75]
s_waitcnt lgkmcnt(2)
v_mfma_f32_16x16x32_bf16 v[72:75],a[120:123],a[0:3],v[72:75]
ds_write2st64_b64 v36,v[240:241],v[112:113] offset0:16 offset1:24
v_pk_mul_f32 v[248:249],v[248:249],v[62:63] op_sel_hi:[1,0]
v_pk_mul_f32 v[250:251],v[250:251],v[62:63] op_sel_hi:[1,0]
v_pk_mul_f32 v[120:121],v[120:121],v[64:65] op_sel_hi:[1,0]
buffer_load_dwordx4 v8,s[8:11],s25 offen offset:2048 lds
v_pk_mul_f32 v[122:123],v[122:123],v[64:65] op_sel_hi:[1,0]
v_cvt_pk_bf16_f32 v248,v248,v249
v_cvt_pk_bf16_f32 v120,v120,v121
v_mfma_f32_16x16x32_bf16 v[80:83],a[120:123],a[24:27],0
s_waitcnt vmcnt(12)
ds_read_b128 a[72:75],v11 offset:0
v_max3_f32 v44,v72,v73,v74
v_mfma_f32_16x16x32_bf16 v[80:83],a[124:127],a[28:31],v[80:83]
s_mov_b32 s27,s42
ds_read_b128 a[76:79],v12 offset:0
v_cvt_pk_bf16_f32 v249,v250,v251
v_mfma_f32_16x16x32_bf16 v[80:83],a[128:131],a[32:35],v[80:83]
s_mov_b32 s42,s41
ds_read_b128 a[80:83],v11 offset:128
v_cvt_pk_bf16_f32 v121,v122,v123
ds_read_b128 a[84:87],v12 offset:128
v_pk_mul_f32 v[252:253],v[252:253],v[62:63] op_sel_hi:[1,0]
ds_read_b128 a[88:91],v11 offset:256
v_pk_mul_f32 v[254:255],v[254:255],v[62:63] op_sel_hi:[1,0]
ds_read_b128 a[92:95],v12 offset:256
v_pk_mul_f32 v[124:125],v[124:125],v[64:65] op_sel_hi:[1,0]
ds_write2st64_b64 v37,v[244:245],v[116:117] offset0:16 offset1:24
v_pk_mul_f32 v[126:127],v[126:127],v[64:65] op_sel_hi:[1,0]
v_cvt_pk_bf16_f32 v252,v252,v253
v_cvt_pk_bf16_f32 v124,v124,v125
v_mfma_f32_16x16x32_bf16 v[80:83],a[132:135],a[36:39],v[80:83]
s_add_u32 s69,s69,1
v_cvt_pk_bf16_f32 v253,v254,v255
v_cvt_pk_bf16_f32 v125,v126,v127
v_mfma_f32_16x16x32_bf16 v[80:83],a[136:139],a[40:43],v[80:83]
s_lshl_b32 s62,s69,5
v_mov_b32 v62,0
v_mov_b32 v63,0
v_mfma_f32_16x16x32_bf16 v[80:83],a[140:143],a[44:47],v[80:83]
s_add_u32 s62,s62,s34
ds_write2st64_b64 v38,v[248:249],v[120:121] offset0:16 offset1:24
v_pk_mul_f32 v[128:129],v[128:129],v[64:65] op_sel_hi:[1,0]
v_pk_mul_f32 v[130:131],v[130:131],v[64:65] op_sel_hi:[1,0]
v_pk_mul_f32 v[144:145],v[144:145],v[64:65] op_sel_hi:[1,0]
v_pk_mul_f32 v[146:147],v[146:147],v[64:65] op_sel_hi:[1,0]
v_cvt_pk_bf16_f32 v128,v128,v129
v_cvt_pk_bf16_f32 v144,v144,v145
v_mfma_f32_16x16x32_bf16 v[88:91],a[140:143],a[68:71],0
s_mul_i32 s63,s62,171
v_max3_f32 v48,v80,v81,v82
v_cvt_pk_bf16_f32 v129,v130,v131
v_mfma_f32_16x16x32_bf16 v[88:91],a[136:139],a[64:67],v[88:91]
s_lshr_b32 s63,s63,9
v_cvt_pk_bf16_f32 v145,v146,v147
s_mul_i32 s64,s63,3
v_mfma_f32_16x16x32_bf16 v[88:91],a[132:135],a[60:63],v[88:91]
s_sub_u32 s62,s62,s64
ds_write2st64_b64 v39,v[252:253],v[124:125] offset0:16 offset1:24
v_pk_mul_f32 v[132:133],v[132:133],v[64:65] op_sel_hi:[1,0]
v_pk_mul_f32 v[134:135],v[134:135],v[64:65] op_sel_hi:[1,0]
v_pk_mul_f32 v[148:149],v[148:149],v[64:65] op_sel_hi:[1,0]
v_pk_mul_f32 v[150:151],v[150:151],v[64:65] op_sel_hi:[1,0]
v_cvt_pk_bf16_f32 v132,v132,v133
v_cvt_pk_bf16_f32 v148,v148,v149
v_mfma_f32_16x16x32_bf16 v[88:91],a[128:131],a[56:59],v[88:91]
s_add_u32 s63,s63,s33
v_cvt_pk_bf16_f32 v133,v134,v135
v_cvt_pk_bf16_f32 v149,v150,v151
v_mfma_f32_16x16x32_bf16 v[88:91],a[124:127],a[52:55],v[88:91]
s_mul_i32 s30,s63,196608
s_mul_i32 s41,s63,325632
ds_write2st64_b64 v36,v[128:129],v[144:145] offset0:26 offset1:28
v_mfma_f32_16x16x32_bf16 v[88:91],a[120:123],a[48:51],v[88:91]
s_lshl_b32 s63,s3,2
s_add_u32 s64,s63,21
s_cmp_eq_u32 s3,0
s_waitcnt lgkmcnt(2)
v_mfma_f32_16x16x32_bf16 v[96:99],a[120:123],a[72:75],0
s_cselect_b32 s64,20,s64
ds_read_b128 a[120:123],v0 offset:6272
s_cselect_b32 s40,1,0
s_add_u32 s65,s63,37
s_cmp_eq_u32 s62,2
v_max3_f32 v52,v88,v89,v90
ds_write2st64_b64 v37,v[132:133],v[148:149] offset0:26 offset1:28
v_pk_mul_f32 v[136:137],v[136:137],v[64:65] op_sel_hi:[1,0]
v_pk_mul_f32 v[138:139],v[138:139],v[64:65] op_sel_hi:[1,0]
v_pk_mul_f32 v[152:153],v[152:153],v[64:65] op_sel_hi:[1,0]
v_pk_mul_f32 v[154:155],v[154:155],v[64:65] op_sel_hi:[1,0]
v_cvt_pk_bf16_f32 v136,v136,v137
v_cvt_pk_bf16_f32 v152,v152,v153
v_mfma_f32_16x16x32_bf16 v[96:99],a[124:127],a[76:79],v[96:99]
s_cselect_b32 s64,s65,s64
ds_read_b128 a[124:127],v1 offset:6272
v_cvt_pk_bf16_f32 v137,v138,v139
v_mfma_f32_16x16x32_bf16 v[96:99],a[128:131],a[80:83],v[96:99]
s_cselect_b32 s40,0,s40
ds_read_b128 a[128:131],v0 offset:6400
v_cvt_pk_bf16_f32 v153,v154,v155
v_mfma_f32_16x16x32_bf16 v[96:99],a[132:135],a[84:87],v[96:99]
s_add_u32 s65,s63,s3
ds_write2st64_b64 v38,v[136:137],v[152:153] offset0:26 offset1:28
v_pk_mul_f32 v[140:141],v[140:141],v[64:65] op_sel_hi:[1,0]
v_pk_mul_f32 v[142:143],v[142:143],v[64:65] op_sel_hi:[1,0]
v_pk_mul_f32 v[156:157],v[156:157],v[64:65] op_sel_hi:[1,0]
ds_read_b128 a[132:135],v1 offset:6400
v_pk_mul_f32 v[158:159],v[158:159],v[64:65] op_sel_hi:[1,0]
v_cvt_pk_bf16_f32 v140,v140,v141
v_cvt_pk_bf16_f32 v156,v156,v157
v_mfma_f32_16x16x32_bf16 v[96:99],a[136:139],a[88:91],v[96:99]
s_cmp_eq_u32 s62,0
ds_read_b128 a[136:139],v0 offset:12288
v_cvt_pk_bf16_f32 v141,v142,v143
v_mfma_f32_16x16x32_bf16 v[96:99],a[140:143],a[92:95],v[96:99]
s_cselect_b32 s64,s65,s64
ds_read_b128 a[140:143],v1 offset:12288
v_cvt_pk_bf16_f32 v157,v158,v159
v_mfma_f32_16x16x32_bf16 v[76:79],a[144:147],a[0:3],0
s_cselect_b32 s40,1,s40
ds_write2st64_b64 v39,v[140:141],v[156:157] offset0:26 offset1:28
v_pk_mul_f32 v[160:161],v[160:161],v[60:61] op_sel_hi:[1,0]
v_pk_mul_f32 v[162:163],v[162:163],v[60:61] op_sel_hi:[1,0]
v_pk_mul_f32 v[176:177],v[176:177],v[60:61] op_sel_hi:[1,0]
v_pk_mul_f32 v[178:179],v[178:179],v[60:61] op_sel_hi:[1,0]
v_max3_f32 v56,v96,v97,v98
v_cvt_pk_bf16_f32 v160,v160,v161
v_mfma_f32_16x16x32_bf16 v[76:79],a[148:151],a[4:7],v[76:79]
s_mul_i32 s64,s64,6144
v_cvt_pk_bf16_f32 v176,v176,v177
v_cvt_pk_bf16_f32 v161,v162,v163
s_waitcnt lgkmcnt(4)
v_mfma_f32_16x16x32_bf16 v[76:79],a[120:123],a[8:11],v[76:79]
s_add_u32 s41,s41,s64
v_cvt_pk_bf16_f32 v177,v178,v179
v_mov_b32 v64,0
v_mfma_f32_16x16x32_bf16 v[76:79],a[124:127],a[12:15],v[76:79]
s_cmp_ge_u32 s69,6
ds_write2st64_b64 v36,v[160:161],v[176:177] offset0:0 offset1:2
v_pk_mul_f32 v[164:165],v[164:165],v[60:61] op_sel_hi:[1,0]
v_pk_mul_f32 v[166:167],v[166:167],v[60:61] op_sel_hi:[1,0]
v_pk_mul_f32 v[180:181],v[180:181],v[60:61] op_sel_hi:[1,0]
v_pk_mul_f32 v[182:183],v[182:183],v[60:61] op_sel_hi:[1,0]
v_cvt_pk_bf16_f32 v164,v164,v165
v_cvt_pk_bf16_f32 v180,v180,v181
v_mfma_f32_16x16x32_bf16 v[76:79],a[128:131],a[16:19],v[76:79]
s_cselect_b32 s41,166723584,s41
v_cvt_pk_bf16_f32 v165,v166,v167
v_cvt_pk_bf16_f32 v181,v182,v183
s_waitcnt lgkmcnt(1)
v_mfma_f32_16x16x32_bf16 v[76:79],a[132:135],a[20:23],v[76:79]
s_cselect_b32 s30,100663296,s30
v_mov_b32 v65,0
s_add_u32 s25,s30,s22
v_mfma_f32_16x16x32_bf16 v[84:87],a[132:135],a[44:47],0
s_add_u32 s26,s25,12288
ds_write2st64_b64 v37,v[164:165],v[180:181] offset0:0 offset1:2
v_mfma_f32_16x16x32_bf16 v[84:87],a[128:131],a[40:43],v[84:87]
s_add_u32 m0,s23,24576
v_max3_f32 v44,v44,v75,v76
v_max3_f32 v44,v44,v77,v78
v_max_f32 v44,v44,v79
v_mov_b32 v45,v44
s_mov_b32 s28,s41
v_pk_mul_f32 v[168:169],v[168:169],v[60:61] op_sel_hi:[1,0]
v_pk_mul_f32 v[170:171],v[170:171],v[60:61] op_sel_hi:[1,0]
buffer_load_dwordx4 v6,s[8:11],s21 offen offset:0 lds
v_pk_mul_f32 v[184:185],v[184:185],v[60:61] op_sel_hi:[1,0]
v_pk_mul_f32 v[186:187],v[186:187],v[60:61] op_sel_hi:[1,0]
v_permlane32_swap_b32 v45,v44
v_max_f32 v44,v44,v45
v_mfma_f32_16x16x32_bf16 v[84:87],a[124:127],a[36:39],v[84:87]
s_mov_b32 s29,s24
v_mov_b32 v45,v44
v_cvt_pk_bf16_f32 v168,v168,v169
v_mfma_f32_16x16x32_bf16 v[84:87],a[120:123],a[32:35],v[84:87]
v_permlane16_swap_b32 v45,v44
v_mfma_f32_16x16x32_bf16 v[84:87],a[148:151],a[28:31],v[84:87]
v_max_f32 v44,v44,v45
v_mul_f32_e64 v13,-s36,v44
v_fma_f32 v72,v72,s36,v13
v_fma_f32 v73,v73,s36,v13
v_fma_f32 v74,v74,s36,v13
v_pk_mul_f32 v[172:173],v[172:173],v[60:61] op_sel_hi:[1,0]
v_pk_mul_f32 v[174:175],v[174:175],v[60:61] op_sel_hi:[1,0]
v_pk_mul_f32 v[188:189],v[188:189],v[60:61] op_sel_hi:[1,0]
v_pk_mul_f32 v[190:191],v[190:191],v[60:61] op_sel_hi:[1,0]
v_fma_f32 v75,v75,s36,v13
v_exp_f32 v72,v72
v_mfma_f32_16x16x32_bf16 v[84:87],a[144:147],a[24:27],v[84:87]
v_exp_f32 v73,v73
v_mfma_f32_16x16x32_bf16 v[92:95],a[144:147],a[48:51],0
buffer_load_dwordx4 v7,s[8:11],s21 offen offset:1024 lds
v_mfma_f32_16x16x32_bf16 v[92:95],a[148:151],a[52:55],v[92:95]
v_exp_f32 v74,v74
v_exp_f32 v75,v75
v_cvt_pk_bf16_f32 v20,v72,v73
v_pk_mul_f32 v[192:193],v[192:193],v[60:61] op_sel_hi:[1,0]
v_pk_mul_f32 v[194:195],v[194:195],v[60:61] op_sel_hi:[1,0]
v_cvt_pk_bf16_f32 v21,v74,v75
v_max3_f32 v48,v48,v83,v84
v_mfma_f32_16x16x32_bf16 v[92:95],a[120:123],a[56:59],v[92:95]
v_max3_f32 v48,v48,v85,v86
v_max_f32 v48,v48,v87
v_mfma_f32_16x16x32_bf16 v[92:95],a[124:127],a[60:63],v[92:95]
v_mov_b32 v49,v48
v_fma_f32 v76,v76,s36,v13
v_mfma_f32_16x16x32_bf16 v[92:95],a[128:131],a[64:67],v[92:95]
v_permlane32_swap_b32 v49,v48
v_max_f32 v48,v48,v49
v_mov_b32 v49,v48
v_fma_f32 v77,v77,s36,v13
buffer_load_dwordx4 v8,s[8:11],s21 offen offset:2048 lds
v_pk_mul_f32 v[196:197],v[196:197],v[60:61] op_sel_hi:[1,0]
v_pk_mul_f32 v[198:199],v[198:199],v[60:61] op_sel_hi:[1,0]
v_permlane16_swap_b32 v49,v48
v_max_f32 v48,v48,v49
v_mfma_f32_16x16x32_bf16 v[92:95],a[132:135],a[68:71],v[92:95]
s_add_u32 s21,s21,12288
v_mul_f32_e64 v14,-s36,v48
v_fma_f32 v80,v80,s36,v14
v_mfma_f32_16x16x32_bf16 v[100:103],a[132:135],a[92:95],0
s_add_u32 m0,s22,0
ds_read_b128 a[132:135],v1 offset:18432
v_fma_f32 v81,v81,s36,v14
v_mfma_f32_16x16x32_bf16 v[100:103],a[128:131],a[88:91],v[100:103]
ds_read_b128 a[128:131],v0 offset:18432
v_fma_f32 v82,v82,s36,v14
v_mfma_f32_16x16x32_bf16 v[100:103],a[124:127],a[84:87],v[100:103]
ds_read_b128 a[124:127],v1 offset:12544
v_fma_f32 v83,v83,s36,v14
v_exp_f32 v80,v80
v_exp_f32 v81,v81
v_pk_mul_f32 v[200:201],v[200:201],v[60:61] op_sel_hi:[1,0]
v_pk_mul_f32 v[202:203],v[202:203],v[60:61] op_sel_hi:[1,0]
v_exp_f32 v82,v82
v_exp_f32 v83,v83
v_mfma_f32_16x16x32_bf16 v[100:103],a[120:123],a[80:83],v[100:103]
ds_read_b128 a[120:123],v0 offset:12544
v_cvt_pk_bf16_f32 v24,v80,v81
v_mfma_f32_16x16x32_bf16 v[100:103],a[148:151],a[76:79],v[100:103]
ds_read_b128 a[148:151],v1 offset:12416
v_cvt_pk_bf16_f32 v25,v82,v83
v_mfma_f32_16x16x32_bf16 v[100:103],a[144:147],a[72:75],v[100:103]
ds_read_b128 a[144:147],v0 offset:12416
v_max3_f32 v52,v52,v91,v92
v_max3_f32 v52,v52,v93,v94
v_max_f32 v52,v52,v95
v_mov_b32 v53,v52
v_pk_mul_f32 v[204:205],v[204:205],v[60:61] op_sel_hi:[1,0]
v_pk_mul_f32 v[206:207],v[206:207],v[60:61] op_sel_hi:[1,0]
v_permlane32_swap_b32 v53,v52
v_max_f32 v52,v52,v53
s_waitcnt lgkmcnt(3)
v_mfma_f32_16x16x32_bf16 v[72:75],a[124:127],a[20:23],0
v_mov_b32 v53,v52
v_max3_f32 v56,v56,v99,v100
v_max3_f32 v56,v56,v101,v102
v_permlane16_swap_b32 v53,v52
v_max_f32 v52,v52,v53
v_mul_f32_e64 v15,-s36,v52
v_fma_f32 v88,v88,s36,v15
v_fma_f32 v89,v89,s36,v15
v_fma_f32 v90,v90,s36,v15
s_waitcnt lgkmcnt(2)
v_mfma_f32_16x16x32_bf16 v[72:75],a[120:123],a[16:19],v[72:75]
s_waitcnt lgkmcnt(1)
v_fma_f32 v91,v91,s36,v15
v_exp_f32 v88,v88
v_mfma_f32_16x16x32_bf16 v[72:75],a[148:151],a[12:15],v[72:75]
s_waitcnt lgkmcnt(0)
v_exp_f32 v89,v89
v_mfma_f32_16x16x32_bf16 v[72:75],a[144:147],a[8:11],v[72:75]
v_exp_f32 v90,v90
v_mfma_f32_16x16x32_bf16 v[72:75],a[140:143],a[4:7],v[72:75]
v_exp_f32 v91,v91
v_mfma_f32_16x16x32_bf16 v[72:75],a[136:139],a[0:3],v[72:75]
v_cvt_pk_bf16_f32 v28,v88,v89
v_cvt_pk_bf16_f32 v29,v90,v91
v_mfma_f32_16x16x32_bf16 v[80:83],a[136:139],a[24:27],0
v_max_f32 v56,v56,v103
v_mov_b32 v57,v56
v_mfma_f32_16x16x32_bf16 v[80:83],a[140:143],a[28:31],v[80:83]
v_fma_f32 v78,v78,s36,v13
v_permlane32_swap_b32 v57,v56
v_mfma_f32_16x16x32_bf16 v[80:83],a[144:147],a[32:35],v[80:83]
v_max_f32 v56,v56,v57
v_mov_b32 v57,v56
v_mfma_f32_16x16x32_bf16 v[80:83],a[148:151],a[36:39],v[80:83]
v_fma_f32 v79,v79,s36,v13
v_permlane16_swap_b32 v57,v56
v_mfma_f32_16x16x32_bf16 v[80:83],a[120:123],a[40:43],v[80:83]
v_max_f32 v56,v56,v57
v_mul_f32_e64 v16,-s36,v56
v_mfma_f32_16x16x32_bf16 v[80:83],a[124:127],a[44:47],v[80:83]
v_fma_f32 v96,v96,s36,v16
v_fma_f32 v97,v97,s36,v16
v_mfma_f32_16x16x32_bf16 v[88:91],a[124:127],a[68:71],0
v_fma_f32 v98,v98,s36,v16
v_fma_f32 v99,v99,s36,v16
v_mfma_f32_16x16x32_bf16 v[88:91],a[120:123],a[64:67],v[88:91]
v_exp_f32 v96,v96
v_mfma_f32_16x16x32_bf16 v[88:91],a[148:151],a[60:63],v[88:91]
v_exp_f32 v97,v97
v_mfma_f32_16x16x32_bf16 v[88:91],a[144:147],a[56:59],v[88:91]
v_exp_f32 v98,v98
v_mfma_f32_16x16x32_bf16 v[88:91],a[140:143],a[52:55],v[88:91]
v_exp_f32 v99,v99
v_mfma_f32_16x16x32_bf16 v[88:91],a[136:139],a[48:51],v[88:91]
v_cvt_pk_bf16_f32 v32,v96,v97
v_cvt_pk_bf16_f32 v33,v98,v99
v_mfma_f32_16x16x32_bf16 v[96:99],a[136:139],a[72:75],0
ds_read_b128 a[136:139],v0 offset:18560
v_exp_f32 v76,v76
v_mfma_f32_16x16x32_bf16 v[96:99],a[140:143],a[76:79],v[96:99]
ds_read_b128 a[140:143],v1 offset:18560
v_exp_f32 v77,v77
v_mfma_f32_16x16x32_bf16 v[96:99],a[144:147],a[80:83],v[96:99]
ds_read_b128 a[144:147],v0 offset:18688
v_exp_f32 v78,v78
v_mfma_f32_16x16x32_bf16 v[96:99],a[148:151],a[84:87],v[96:99]
ds_read_b128 a[148:151],v1 offset:18688
v_exp_f32 v79,v79
v_mfma_f32_16x16x32_bf16 v[96:99],a[120:123],a[88:91],v[96:99]
v_cvt_pk_bf16_f32 v22,v76,v77
v_cvt_pk_bf16_f32 v23,v78,v79
v_mfma_f32_16x16x32_bf16 v[96:99],a[124:127],a[92:95],v[96:99]
v_fma_f32 v84,v84,s36,v14
v_fma_f32 v85,v85,s36,v14
v_mfma_f32_16x16x32_bf16 v[76:79],a[128:131],a[0:3],0
v_fma_f32 v86,v86,s36,v14
v_fma_f32 v87,v87,s36,v14
v_mfma_f32_16x16x32_bf16 v[76:79],a[132:135],a[4:7],v[76:79]
s_waitcnt lgkmcnt(3)
v_exp_f32 v84,v84
v_mfma_f32_16x16x32_bf16 v[76:79],a[136:139],a[8:11],v[76:79]
s_waitcnt lgkmcnt(2)
v_exp_f32 v85,v85
v_mfma_f32_16x16x32_bf16 v[76:79],a[140:143],a[12:15],v[76:79]
s_waitcnt lgkmcnt(1)
v_exp_f32 v86,v86
v_mfma_f32_16x16x32_bf16 v[76:79],a[144:147],a[16:19],v[76:79]
s_waitcnt lgkmcnt(0)
v_exp_f32 v87,v87
v_mfma_f32_16x16x32_bf16 v[76:79],a[148:151],a[20:23],v[76:79]
v_cvt_pk_bf16_f32 v26,v84,v85
v_cvt_pk_bf16_f32 v27,v86,v87
v_mfma_f32_16x16x32_bf16 v[84:87],a[148:151],a[44:47],0
v_fma_f32 v92,v92,s36,v15
v_fma_f32 v93,v93,s36,v15
v_mfma_f32_16x16x32_bf16 v[84:87],a[144:147],a[40:43],v[84:87]
v_fma_f32 v94,v94,s36,v15
v_fma_f32 v95,v95,s36,v15
v_mfma_f32_16x16x32_bf16 v[84:87],a[140:143],a[36:39],v[84:87]
v_exp_f32 v92,v92
v_mfma_f32_16x16x32_bf16 v[84:87],a[136:139],a[32:35],v[84:87]
v_exp_f32 v93,v93
v_mfma_f32_16x16x32_bf16 v[84:87],a[132:135],a[28:31],v[84:87]
v_exp_f32 v94,v94
v_mfma_f32_16x16x32_bf16 v[84:87],a[128:131],a[24:27],v[84:87]
v_exp_f32 v95,v95
s_waitcnt vmcnt(3)
s_barrier
v_cvt_pk_bf16_f32 v30,v92,v93
buffer_load_dwordx4 v6,s[4:7],s20 offen offset:0 lds
v_cvt_pk_bf16_f32 v31,v94,v95
v_mfma_f32_16x16x32_bf16 v[92:95],a[128:131],a[48:51],0
v_fma_f32 v100,v100,s36,v16
v_fma_f32 v101,v101,s36,v16
v_mfma_f32_16x16x32_bf16 v[92:95],a[132:135],a[52:55],v[92:95]
v_fma_f32 v102,v102,s36,v16
v_fma_f32 v103,v103,s36,v16
v_mfma_f32_16x16x32_bf16 v[92:95],a[136:139],a[56:59],v[92:95]
v_exp_f32 v100,v100
v_mfma_f32_16x16x32_bf16 v[92:95],a[140:143],a[60:63],v[92:95]
v_exp_f32 v101,v101
v_mfma_f32_16x16x32_bf16 v[92:95],a[144:147],a[64:67],v[92:95]
v_exp_f32 v102,v102
v_mfma_f32_16x16x32_bf16 v[92:95],a[148:151],a[68:71],v[92:95]
buffer_load_dwordx4 v7,s[4:7],s20 offen offset:1024 lds
v_exp_f32 v103,v103
v_cvt_pk_bf16_f32 v34,v100,v101
v_cvt_pk_bf16_f32 v35,v102,v103
v_mfma_f32_16x16x32_bf16 v[100:103],a[148:151],a[92:95],0
v_cvt_pk_bf16_f32 v184,v184,v185
v_cvt_pk_bf16_f32 v169,v170,v171
v_smfmac_f32_16x16x64_bf16 v[64:67],a[152:155],v[28:35],v18
ds_read_b64_tr_b16 a[120:121],v2 offset:0
v_mfma_f32_16x16x32_bf16 v[100:103],a[144:147],a[88:91],v[100:103]
ds_read_b64_tr_b16 a[122:123],v2 offset:6144
v_cvt_pk_bf16_f32 v172,v172,v173
v_mfma_f32_16x16x32_bf16 v[100:103],a[140:143],a[84:87],v[100:103]
v_cvt_pk_bf16_f32 v188,v188,v189
v_mov_b32 v60,0
v_mfma_f32_16x16x32_bf16 v[100:103],a[136:139],a[80:83],v[100:103]
buffer_load_dwordx4 v8,s[4:7],s20 offen offset:2048 lds
v_mfma_f32_16x16x32_bf16 v[100:103],a[132:135],a[76:79],v[100:103]
s_add_u32 s20,s20,12288
ds_read_b64_tr_b16 a[124:125],v3 offset:0
v_mov_b32 v61,0
v_mfma_f32_16x16x32_bf16 v[100:103],a[128:131],a[72:75],v[100:103]
ds_read_b64_tr_b16 a[126:127],v3 offset:6144
v_cvt_pk_bf16_f32 v185,v186,v187
v_smfmac_f32_16x16x64_bf16 v[60:63],a[152:155],v[20:27],v18
ds_write2st64_b64 v38,v[168:169],v[184:185] offset0:0 offset1:2
v_cvt_pk_bf16_f32 v192,v192,v193
v_cvt_pk_bf16_f32 v173,v174,v175
v_cvt_pk_bf16_f32 v189,v190,v191
ds_read_b64_tr_b16 a[128:129],v4 offset:0
ds_read_b64_tr_b16 a[130:131],v4 offset:6144
ds_read_b64_tr_b16 a[132:133],v5 offset:0
ds_read_b64_tr_b16 a[134:135],v5 offset:6144
ds_write2st64_b64 v39,v[172:173],v[188:189] offset0:0 offset1:2
v_cvt_pk_bf16_f32 v196,v196,v197
v_fma_f32 v72,v72,s36,v13
v_fma_f32 v73,v73,s36,v13
v_fma_f32 v74,v74,s36,v13
v_fma_f32 v75,v75,s36,v13
v_fma_f32 v80,v80,s36,v14
v_fma_f32 v81,v81,s36,v14
v_cvt_pk_bf16_f32 v193,v194,v195
v_cvt_pk_bf16_f32 v200,v200,v201
v_cvt_pk_bf16_f32 v197,v198,v199
v_exp_f32 v72,v72
ds_write_b64 v36,v[192:193] offset:2048
v_exp_f32 v73,v73
v_exp_f32 v74,v74
ds_write_b64 v37,v[196:197] offset:2048
v_exp_f32 v75,v75
v_exp_f32 v80,v80
v_exp_f32 v81,v81
v_cvt_pk_bf16_f32 v204,v204,v205
v_cvt_pk_bf16_f32 v201,v202,v203
ds_write_b64 v38,v[200:201] offset:2048
v_cvt_pk_bf16_f32 v205,v206,v207
v_cvt_pk_bf16_f32 v44,v72,v73
v_cvt_pk_bf16_f32 v45,v74,v75
v_cvt_pk_bf16_f32 v48,v80,v81
ds_write_b64 v39,v[204:205] offset:2048
s_waitcnt lgkmcnt(3)
v_mfma_f32_16x16x32_bf16 v[160:163],a[120:123],v[20:23],0
s_add_u32 m0,s23,0
ds_read_b64_tr_b16 a[136:137],v2 offset:128
v_fma_f32 v82,v82,s36,v14
v_mfma_f32_16x16x32_bf16 v[164:167],a[124:127],v[20:23],0
ds_read_b64_tr_b16 a[138:139],v2 offset:6272
v_fma_f32 v83,v83,s36,v14
v_mfma_f32_16x16x32_bf16 v[212:215],a[124:127],v[24:27],0
ds_read_b64_tr_b16 a[140:141],v3 offset:128
v_fma_f32 v88,v88,s36,v15
v_mfma_f32_16x16x32_bf16 v[208:211],a[120:123],v[24:27],0
ds_read_b64_tr_b16 a[142:143],v3 offset:6272
v_fma_f32 v89,v89,s36,v15
v_mfma_f32_16x16x32_bf16 v[112:115],a[120:123],v[28:31],0
ds_read_b64_tr_b16 a[144:145],v4 offset:128
v_fma_f32 v90,v90,s36,v15
v_mfma_f32_16x16x32_bf16 v[116:119],a[124:127],v[28:31],0
ds_read_b64_tr_b16 a[146:147],v4 offset:6272
v_fma_f32 v91,v91,s36,v15
v_mfma_f32_16x16x32_bf16 a[164:167],a[124:127],v[32:35],0
ds_read_b64_tr_b16 a[148:149],v5 offset:128
v_fma_f32 v96,v96,s36,v16
v_mfma_f32_16x16x32_bf16 a[160:163],a[120:123],v[32:35],0
ds_read_b64_tr_b16 a[150:151],v5 offset:6272
v_fma_f32 v97,v97,s36,v16
v_mfma_f32_16x16x32_bf16 a[168:171],a[128:131],v[32:35],0
ds_read_b64_tr_b16 a[120:121],v2 offset:256
v_fma_f32 v98,v98,s36,v16
v_mfma_f32_16x16x32_bf16 a[172:175],a[132:135],v[32:35],0
ds_read_b64_tr_b16 a[122:123],v2 offset:6400
v_fma_f32 v99,v99,s36,v16
v_mfma_f32_16x16x32_bf16 v[124:127],a[132:135],v[28:31],0
ds_read_b64_tr_b16 a[124:125],v3 offset:256
v_fma_f32 v76,v76,s36,v13
v_mfma_f32_16x16x32_bf16 v[120:123],a[128:131],v[28:31],0
ds_read_b64_tr_b16 a[126:127],v3 offset:6400
v_fma_f32 v77,v77,s36,v13
v_mfma_f32_16x16x32_bf16 v[216:219],a[128:131],v[24:27],0
v_exp_f32 v82,v82
v_mfma_f32_16x16x32_bf16 v[220:223],a[132:135],v[24:27],0
v_exp_f32 v83,v83
v_mfma_f32_16x16x32_bf16 v[172:175],a[132:135],v[20:23],0
ds_read_b64_tr_b16 a[132:133],v5 offset:256
v_cvt_pk_bf16_f32 v49,v82,v83
v_mfma_f32_16x16x32_bf16 v[168:171],a[128:131],v[20:23],0
s_waitcnt lgkmcnt(4)
ds_read_b64_tr_b16 a[128:129],v4 offset:256
v_fma_f32 v78,v78,s36,v13
v_mfma_f32_16x16x32_bf16 v[176:179],a[136:139],v[20:23],0
ds_read_b64_tr_b16 a[130:131],v4 offset:6400
v_fma_f32 v79,v79,s36,v13
v_mfma_f32_16x16x32_bf16 v[180:183],a[140:143],v[20:23],0
ds_read_b64_tr_b16 a[134:135],v5 offset:6400
v_fma_f32 v84,v84,s36,v14
v_mfma_f32_16x16x32_bf16 v[228:231],a[140:143],v[24:27],0
v_exp_f32 v88,v88
v_mfma_f32_16x16x32_bf16 v[224:227],a[136:139],v[24:27],0
v_exp_f32 v89,v89
v_mfma_f32_16x16x32_bf16 v[128:131],a[136:139],v[28:31],0
v_exp_f32 v90,v90
v_mfma_f32_16x16x32_bf16 v[132:135],a[140:143],v[28:31],0
v_exp_f32 v91,v91
v_mfma_f32_16x16x32_bf16 a[180:183],a[140:143],v[32:35],0
v_cvt_pk_bf16_f32 v52,v88,v89
v_cvt_pk_bf16_f32 v53,v90,v91
v_mfma_f32_16x16x32_bf16 a[176:179],a[136:139],v[32:35],0
v_exp_f32 v96,v96
v_mfma_f32_16x16x32_bf16 a[184:187],a[144:147],v[32:35],0
v_exp_f32 v97,v97
v_mfma_f32_16x16x32_bf16 a[188:191],a[148:151],v[32:35],0
v_exp_f32 v98,v98
v_mfma_f32_16x16x32_bf16 v[140:143],a[148:151],v[28:31],0
v_exp_f32 v99,v99
v_mfma_f32_16x16x32_bf16 v[136:139],a[144:147],v[28:31],0
v_cvt_pk_bf16_f32 v56,v96,v97
v_cvt_pk_bf16_f32 v57,v98,v99
v_mfma_f32_16x16x32_bf16 v[232:235],a[144:147],v[24:27],0
v_exp_f32 v76,v76
v_mfma_f32_16x16x32_bf16 v[236:239],a[148:151],v[24:27],0
v_exp_f32 v77,v77
v_mfma_f32_16x16x32_bf16 v[188:191],a[148:151],v[20:23],0
v_exp_f32 v78,v78
v_mfma_f32_16x16x32_bf16 v[184:187],a[144:147],v[20:23],0
s_waitcnt lgkmcnt(0)
v_exp_f32 v79,v79
v_mfma_f32_16x16x32_bf16 v[192:195],a[120:123],v[20:23],0
v_cvt_pk_bf16_f32 v46,v76,v77
v_cvt_pk_bf16_f32 v47,v78,v79
v_mfma_f32_16x16x32_bf16 v[196:199],a[124:127],v[20:23],0
s_waitcnt vmcnt(24)
v_fma_f32 v85,v85,s36,v14
v_fma_f32 v86,v86,s36,v14
v_mfma_f32_16x16x32_bf16 v[244:247],a[124:127],v[24:27],0
s_barrier
v_mfma_f32_16x16x32_bf16 v[240:243],a[120:123],v[24:27],0
ds_read_b128 a[148:151],v1 offset:24704
v_fma_f32 v87,v87,s36,v14
v_mfma_f32_16x16x32_bf16 v[144:147],a[120:123],v[28:31],0
ds_read_b128 a[144:147],v0 offset:24704
v_fma_f32 v92,v92,s36,v15
v_mfma_f32_16x16x32_bf16 v[148:151],a[124:127],v[28:31],0
ds_read_b128 a[140:143],v1 offset:24576
v_fma_f32 v93,v93,s36,v15
v_mfma_f32_16x16x32_bf16 a[196:199],a[124:127],v[32:35],0
ds_read_b128 a[124:127],v1 offset:24832
v_fma_f32 v94,v94,s36,v15
v_mfma_f32_16x16x32_bf16 a[192:195],a[120:123],v[32:35],0
ds_read_b128 a[120:123],v0 offset:24832
v_fma_f32 v95,v95,s36,v15
v_mfma_f32_16x16x32_bf16 a[200:203],a[128:131],v[32:35],0
buffer_load_dwordx4 v6,s[8:11],s21 offen offset:0 lds
v_mfma_f32_16x16x32_bf16 a[204:207],a[132:135],v[32:35],0
ds_read_b128 a[136:139],v0 offset:24576
v_fma_f32 v100,v100,s36,v16
v_mfma_f32_16x16x32_bf16 v[156:159],a[132:135],v[28:31],0
v_exp_f32 v84,v84
v_mfma_f32_16x16x32_bf16 v[152:155],a[128:131],v[28:31],0
v_exp_f32 v85,v85
v_mfma_f32_16x16x32_bf16 v[248:251],a[128:131],v[24:27],0
v_exp_f32 v86,v86
v_mfma_f32_16x16x32_bf16 v[252:255],a[132:135],v[24:27],0
v_exp_f32 v87,v87
v_mfma_f32_16x16x32_bf16 v[204:207],a[132:135],v[20:23],0
ds_read_b128 a[132:135],v1 offset:30720
v_cvt_pk_bf16_f32 v50,v84,v85
v_mfma_f32_16x16x32_bf16 v[200:203],a[128:131],v[20:23],0
s_waitcnt lgkmcnt(2)
ds_read_b128 a[128:131],v0 offset:30720
v_cvt_pk_bf16_f32 v51,v86,v87
v_mfma_f32_16x16x32_bf16 v[72:75],a[124:127],a[20:23],0
v_exp_f32 v92,v92
v_smfmac_f32_16x16x64_bf16 v[60:63],a[152:155],v[44:51],v18
buffer_load_dwordx4 v7,s[8:11],s21 offen offset:1024 lds
v_mfma_f32_16x16x32_bf16 v[72:75],a[120:123],a[16:19],v[72:75]
v_exp_f32 v93,v93
v_mfma_f32_16x16x32_bf16 v[72:75],a[148:151],a[12:15],v[72:75]
v_exp_f32 v94,v94
v_mfma_f32_16x16x32_bf16 v[72:75],a[144:147],a[8:11],v[72:75]
v_exp_f32 v95,v95
v_mfma_f32_16x16x32_bf16 v[72:75],a[140:143],a[4:7],v[72:75]
s_waitcnt lgkmcnt(1)
v_cvt_pk_bf16_f32 v54,v92,v93
v_cvt_pk_bf16_f32 v55,v94,v95
v_mfma_f32_16x16x32_bf16 v[72:75],a[136:139],a[0:3],v[72:75]
v_fma_f32 v101,v101,s36,v16
v_fma_f32 v102,v102,s36,v16
v_mfma_f32_16x16x32_bf16 v[80:83],a[136:139],a[24:27],0
v_fma_f32 v103,v103,s36,v16
v_mfma_f32_16x16x32_bf16 v[80:83],a[140:143],a[28:31],v[80:83]
v_exp_f32 v100,v100
v_mfma_f32_16x16x32_bf16 v[80:83],a[144:147],a[32:35],v[80:83]
buffer_load_dwordx4 v8,s[8:11],s21 offen offset:2048 lds
v_mfma_f32_16x16x32_bf16 v[80:83],a[148:151],a[36:39],v[80:83]
s_add_u32 s21,s21,12288
v_exp_f32 v101,v101
v_mfma_f32_16x16x32_bf16 v[80:83],a[120:123],a[40:43],v[80:83]
s_add_u32 m0,s22,12288
v_exp_f32 v102,v102
v_mfma_f32_16x16x32_bf16 v[80:83],a[124:127],a[44:47],v[80:83]
v_exp_f32 v103,v103
v_mfma_f32_16x16x32_bf16 v[88:91],a[124:127],a[68:71],0
v_cvt_pk_bf16_f32 v58,v100,v101
v_cvt_pk_bf16_f32 v59,v102,v103
v_mfma_f32_16x16x32_bf16 v[88:91],a[120:123],a[64:67],v[88:91]
v_fma_f32 v72,v72,s36,v13
v_fma_f32 v73,v73,s36,v13
v_smfmac_f32_16x16x64_bf16 v[64:67],a[152:155],v[52:59],v18
v_fma_f32 v74,v74,s36,v13
v_mfma_f32_16x16x32_bf16 v[88:91],a[148:151],a[60:63],v[88:91]
v_fma_f32 v75,v75,s36,v13
v_fma_f32 v80,v80,s36,v14
v_mfma_f32_16x16x32_bf16 v[88:91],a[144:147],a[56:59],v[88:91]
v_fma_f32 v81,v81,s36,v14
v_mfma_f32_16x16x32_bf16 v[88:91],a[140:143],a[52:55],v[88:91]
buffer_load_dwordx4 v6,s[4:7],s20 offen offset:0 lds
v_mfma_f32_16x16x32_bf16 v[88:91],a[136:139],a[48:51],v[88:91]
v_exp_f32 v72,v72
v_mfma_f32_16x16x32_bf16 v[96:99],a[136:139],a[72:75],0
ds_read_b128 a[136:139],v0 offset:30848
v_mfma_f32_16x16x32_bf16 v[96:99],a[140:143],a[76:79],v[96:99]
ds_read_b128 a[140:143],v1 offset:30848
v_mfma_f32_16x16x32_bf16 v[96:99],a[144:147],a[80:83],v[96:99]
ds_read_b128 a[144:147],v0 offset:30976
v_mfma_f32_16x16x32_bf16 v[96:99],a[148:151],a[84:87],v[96:99]
ds_read_b128 a[148:151],v1 offset:30976
v_mfma_f32_16x16x32_bf16 v[96:99],a[120:123],a[88:91],v[96:99]
v_exp_f32 v73,v73
v_mfma_f32_16x16x32_bf16 v[96:99],a[124:127],a[92:95],v[96:99]
s_waitcnt lgkmcnt(4)
v_exp_f32 v74,v74
v_mfma_f32_16x16x32_bf16 v[76:79],a[128:131],a[0:3],0
v_exp_f32 v75,v75
v_mfma_f32_16x16x32_bf16 v[76:79],a[132:135],a[4:7],v[76:79]
buffer_load_dwordx4 v7,s[4:7],s20 offen offset:1024 lds
s_waitcnt lgkmcnt(3)
v_mfma_f32_16x16x32_bf16 v[76:79],a[136:139],a[8:11],v[76:79]
s_waitcnt lgkmcnt(2)
v_exp_f32 v80,v80
v_mfma_f32_16x16x32_bf16 v[76:79],a[140:143],a[12:15],v[76:79]
s_waitcnt lgkmcnt(0)
v_exp_f32 v81,v81
v_mfma_f32_16x16x32_bf16 v[76:79],a[144:147],a[16:19],v[76:79]
v_cvt_pk_bf16_f32 v20,v72,v73
v_cvt_pk_bf16_f32 v21,v74,v75
v_mfma_f32_16x16x32_bf16 v[76:79],a[148:151],a[20:23],v[76:79]
v_cvt_pk_bf16_f32 v24,v80,v81
v_mfma_f32_16x16x32_bf16 v[84:87],a[148:151],a[44:47],0
v_mfma_f32_16x16x32_bf16 v[84:87],a[144:147],a[40:43],v[84:87]
v_mfma_f32_16x16x32_bf16 v[84:87],a[140:143],a[36:39],v[84:87]
v_mfma_f32_16x16x32_bf16 v[84:87],a[136:139],a[32:35],v[84:87]
v_mfma_f32_16x16x32_bf16 v[84:87],a[132:135],a[28:31],v[84:87]
buffer_load_dwordx4 v8,s[4:7],s20 offen offset:2048 lds
v_mfma_f32_16x16x32_bf16 v[84:87],a[128:131],a[24:27],v[84:87]
s_add_u32 s20,s20,12288
v_mfma_f32_16x16x32_bf16 v[92:95],a[128:131],a[48:51],0
ds_read_b64_tr_b16 a[120:121],v2 offset:12288
v_mfma_f32_16x16x32_bf16 v[92:95],a[132:135],a[52:55],v[92:95]
ds_read_b64_tr_b16 a[122:123],v2 offset:18432
v_mfma_f32_16x16x32_bf16 v[92:95],a[136:139],a[56:59],v[92:95]
ds_read_b64_tr_b16 a[124:125],v3 offset:12288
v_mfma_f32_16x16x32_bf16 v[92:95],a[140:143],a[60:63],v[92:95]
ds_read_b64_tr_b16 a[126:127],v3 offset:18432
v_mfma_f32_16x16x32_bf16 v[92:95],a[144:147],a[64:67],v[92:95]
v_mfma_f32_16x16x32_bf16 v[92:95],a[148:151],a[68:71],v[92:95]
v_mfma_f32_16x16x32_bf16 v[100:103],a[148:151],a[92:95],0
v_mfma_f32_16x16x32_bf16 v[100:103],a[144:147],a[88:91],v[100:103]
v_mfma_f32_16x16x32_bf16 v[100:103],a[140:143],a[84:87],v[100:103]
v_mfma_f32_16x16x32_bf16 v[100:103],a[136:139],a[80:83],v[100:103]
v_mfma_f32_16x16x32_bf16 v[100:103],a[132:135],a[76:79],v[100:103]
ds_read_b64_tr_b16 a[132:133],v5 offset:12288
v_mfma_f32_16x16x32_bf16 v[100:103],a[128:131],a[72:75],v[100:103]
s_waitcnt lgkmcnt(1)
ds_read_b64_tr_b16 a[128:129],v4 offset:12288
ds_read_b64_tr_b16 a[130:131],v4 offset:18432
ds_read_b64_tr_b16 a[134:135],v5 offset:18432
v_mfma_f32_16x16x32_bf16 v[160:163],a[120:123],v[44:47],v[160:163]
s_add_u32 m0,s23,12288
ds_read_b64_tr_b16 a[136:137],v2 offset:12416
v_fma_f32 v82,v82,s36,v14
v_mfma_f32_16x16x32_bf16 v[164:167],a[124:127],v[44:47],v[164:167]
ds_read_b64_tr_b16 a[138:139],v2 offset:18560
v_fma_f32 v83,v83,s36,v14
v_mfma_f32_16x16x32_bf16 v[212:215],a[124:127],v[48:51],v[212:215]
ds_read_b64_tr_b16 a[140:141],v3 offset:12416
v_fma_f32 v88,v88,s36,v15
v_mfma_f32_16x16x32_bf16 v[208:211],a[120:123],v[48:51],v[208:211]
ds_read_b64_tr_b16 a[142:143],v3 offset:18560
v_fma_f32 v89,v89,s36,v15
v_mfma_f32_16x16x32_bf16 v[112:115],a[120:123],v[52:55],v[112:115]
ds_read_b64_tr_b16 a[144:145],v4 offset:12416
v_fma_f32 v90,v90,s36,v15
v_mfma_f32_16x16x32_bf16 v[116:119],a[124:127],v[52:55],v[116:119]
ds_read_b64_tr_b16 a[146:147],v4 offset:18560
v_fma_f32 v91,v91,s36,v15
v_mfma_f32_16x16x32_bf16 a[164:167],a[124:127],v[56:59],a[164:167]
ds_read_b64_tr_b16 a[148:149],v5 offset:12416
v_fma_f32 v96,v96,s36,v16
v_mfma_f32_16x16x32_bf16 a[160:163],a[120:123],v[56:59],a[160:163]
s_waitcnt lgkmcnt(6)
ds_read_b64_tr_b16 a[150:151],v5 offset:18560
v_fma_f32 v97,v97,s36,v16
v_mfma_f32_16x16x32_bf16 a[168:171],a[128:131],v[56:59],a[168:171]
ds_read_b64_tr_b16 a[120:121],v2 offset:12544
v_fma_f32 v98,v98,s36,v16
v_mfma_f32_16x16x32_bf16 a[172:175],a[132:135],v[56:59],a[172:175]
ds_read_b64_tr_b16 a[122:123],v2 offset:18688
v_fma_f32 v99,v99,s36,v16
v_mfma_f32_16x16x32_bf16 v[124:127],a[132:135],v[52:55],v[124:127]
ds_read_b64_tr_b16 a[124:125],v3 offset:12544
v_fma_f32 v76,v76,s36,v13
v_mfma_f32_16x16x32_bf16 v[120:123],a[128:131],v[52:55],v[120:123]
ds_read_b64_tr_b16 a[126:127],v3 offset:18688
v_fma_f32 v77,v77,s36,v13
v_mfma_f32_16x16x32_bf16 v[216:219],a[128:131],v[48:51],v[216:219]
v_exp_f32 v82,v82
v_mfma_f32_16x16x32_bf16 v[220:223],a[132:135],v[48:51],v[220:223]
v_exp_f32 v83,v83
v_mfma_f32_16x16x32_bf16 v[172:175],a[132:135],v[44:47],v[172:175]
ds_read_b64_tr_b16 a[132:133],v5 offset:12544
v_cvt_pk_bf16_f32 v25,v82,v83
v_mfma_f32_16x16x32_bf16 v[168:171],a[128:131],v[44:47],v[168:171]
s_waitcnt lgkmcnt(4)
ds_read_b64_tr_b16 a[128:129],v4 offset:12544
v_fma_f32 v78,v78,s36,v13
v_mfma_f32_16x16x32_bf16 v[176:179],a[136:139],v[44:47],v[176:179]
ds_read_b64_tr_b16 a[130:131],v4 offset:18688
v_fma_f32 v79,v79,s36,v13
v_mfma_f32_16x16x32_bf16 v[180:183],a[140:143],v[44:47],v[180:183]
ds_read_b64_tr_b16 a[134:135],v5 offset:18688
v_fma_f32 v84,v84,s36,v14
v_mfma_f32_16x16x32_bf16 v[228:231],a[140:143],v[48:51],v[228:231]
v_exp_f32 v88,v88
v_mfma_f32_16x16x32_bf16 v[224:227],a[136:139],v[48:51],v[224:227]
v_exp_f32 v89,v89
v_mfma_f32_16x16x32_bf16 v[128:131],a[136:139],v[52:55],v[128:131]
v_exp_f32 v90,v90
v_mfma_f32_16x16x32_bf16 v[132:135],a[140:143],v[52:55],v[132:135]
v_exp_f32 v91,v91
v_mfma_f32_16x16x32_bf16 a[180:183],a[140:143],v[56:59],a[180:183]
v_cvt_pk_bf16_f32 v28,v88,v89
v_cvt_pk_bf16_f32 v29,v90,v91
v_mfma_f32_16x16x32_bf16 a[176:179],a[136:139],v[56:59],a[176:179]
v_exp_f32 v96,v96
v_mfma_f32_16x16x32_bf16 a[184:187],a[144:147],v[56:59],a[184:187]
v_exp_f32 v97,v97
v_mfma_f32_16x16x32_bf16 a[188:191],a[148:151],v[56:59],a[188:191]
v_exp_f32 v98,v98
v_mfma_f32_16x16x32_bf16 v[140:143],a[148:151],v[52:55],v[140:143]
v_exp_f32 v99,v99
v_mfma_f32_16x16x32_bf16 v[136:139],a[144:147],v[52:55],v[136:139]
v_cvt_pk_bf16_f32 v32,v96,v97
v_cvt_pk_bf16_f32 v33,v98,v99
v_mfma_f32_16x16x32_bf16 v[232:235],a[144:147],v[48:51],v[232:235]
v_exp_f32 v76,v76
v_mfma_f32_16x16x32_bf16 v[236:239],a[148:151],v[48:51],v[236:239]
v_exp_f32 v77,v77
v_mfma_f32_16x16x32_bf16 v[188:191],a[148:151],v[44:47],v[188:191]
v_exp_f32 v78,v78
v_mfma_f32_16x16x32_bf16 v[184:187],a[144:147],v[44:47],v[184:187]
s_waitcnt lgkmcnt(0)
v_exp_f32 v79,v79
v_mfma_f32_16x16x32_bf16 v[192:195],a[120:123],v[44:47],v[192:195]
v_cvt_pk_bf16_f32 v22,v76,v77
v_cvt_pk_bf16_f32 v23,v78,v79
v_mfma_f32_16x16x32_bf16 v[196:199],a[124:127],v[44:47],v[196:199]
s_waitcnt vmcnt(6)
v_fma_f32 v85,v85,s36,v14
v_fma_f32 v86,v86,s36,v14
v_mfma_f32_16x16x32_bf16 v[244:247],a[124:127],v[48:51],v[244:247]
s_barrier
v_mfma_f32_16x16x32_bf16 v[240:243],a[120:123],v[48:51],v[240:243]
ds_read_b128 a[148:151],v1 offset:128
v_fma_f32 v87,v87,s36,v14
v_mfma_f32_16x16x32_bf16 v[144:147],a[120:123],v[52:55],v[144:147]
ds_read_b128 a[144:147],v0 offset:128
v_fma_f32 v92,v92,s36,v15
v_mfma_f32_16x16x32_bf16 v[148:151],a[124:127],v[52:55],v[148:151]
ds_read_b128 a[140:143],v1 offset:0
v_fma_f32 v93,v93,s36,v15
v_mfma_f32_16x16x32_bf16 a[196:199],a[124:127],v[56:59],a[196:199]
ds_read_b128 a[124:127],v1 offset:256
v_fma_f32 v94,v94,s36,v15
v_mfma_f32_16x16x32_bf16 a[192:195],a[120:123],v[56:59],a[192:195]
ds_read_b128 a[120:123],v0 offset:256
v_fma_f32 v95,v95,s36,v15
v_mfma_f32_16x16x32_bf16 a[200:203],a[128:131],v[56:59],a[200:203]
buffer_load_dwordx4 v6,s[8:11],s21 offen offset:0 lds
v_mfma_f32_16x16x32_bf16 a[204:207],a[132:135],v[56:59],a[204:207]
ds_read_b128 a[136:139],v0 offset:0
v_fma_f32 v100,v100,s36,v16
v_mfma_f32_16x16x32_bf16 v[156:159],a[132:135],v[52:55],v[156:159]
v_exp_f32 v84,v84
v_mfma_f32_16x16x32_bf16 v[152:155],a[128:131],v[52:55],v[152:155]
v_exp_f32 v85,v85
v_mfma_f32_16x16x32_bf16 v[248:251],a[128:131],v[48:51],v[248:251]
v_exp_f32 v86,v86
v_mfma_f32_16x16x32_bf16 v[252:255],a[132:135],v[48:51],v[252:255]
v_exp_f32 v87,v87
v_mfma_f32_16x16x32_bf16 v[204:207],a[132:135],v[44:47],v[204:207]
ds_read_b128 a[132:135],v1 offset:6144
v_cvt_pk_bf16_f32 v26,v84,v85
v_mfma_f32_16x16x32_bf16 v[200:203],a[128:131],v[44:47],v[200:203]
s_waitcnt lgkmcnt(2)
ds_read_b128 a[128:131],v0 offset:6144
v_cvt_pk_bf16_f32 v27,v86,v87
v_mfma_f32_16x16x32_bf16 v[72:75],a[124:127],a[20:23],0
v_exp_f32 v92,v92
v_smfmac_f32_16x16x64_bf16 v[60:63],a[152:155],v[20:27],v18
buffer_load_dwordx4 v7,s[8:11],s21 offen offset:1024 lds
v_mfma_f32_16x16x32_bf16 v[72:75],a[120:123],a[16:19],v[72:75]
v_exp_f32 v93,v93
v_mfma_f32_16x16x32_bf16 v[72:75],a[148:151],a[12:15],v[72:75]
v_exp_f32 v94,v94
v_mfma_f32_16x16x32_bf16 v[72:75],a[144:147],a[8:11],v[72:75]
v_exp_f32 v95,v95
v_mfma_f32_16x16x32_bf16 v[72:75],a[140:143],a[4:7],v[72:75]
s_waitcnt lgkmcnt(1)
v_cvt_pk_bf16_f32 v30,v92,v93
v_cvt_pk_bf16_f32 v31,v94,v95
v_mfma_f32_16x16x32_bf16 v[72:75],a[136:139],a[0:3],v[72:75]
v_fma_f32 v101,v101,s36,v16
v_fma_f32 v102,v102,s36,v16
v_mfma_f32_16x16x32_bf16 v[80:83],a[136:139],a[24:27],0
v_fma_f32 v103,v103,s36,v16
v_mfma_f32_16x16x32_bf16 v[80:83],a[140:143],a[28:31],v[80:83]
v_exp_f32 v100,v100
v_mfma_f32_16x16x32_bf16 v[80:83],a[144:147],a[32:35],v[80:83]
buffer_load_dwordx4 v8,s[8:11],s21 offen offset:2048 lds
v_mfma_f32_16x16x32_bf16 v[80:83],a[148:151],a[36:39],v[80:83]
s_add_u32 s21,s21,12288
v_exp_f32 v101,v101
v_mfma_f32_16x16x32_bf16 v[80:83],a[120:123],a[40:43],v[80:83]
s_add_u32 m0,s22,24576
v_exp_f32 v102,v102
v_mfma_f32_16x16x32_bf16 v[80:83],a[124:127],a[44:47],v[80:83]
v_exp_f32 v103,v103
v_mfma_f32_16x16x32_bf16 v[88:91],a[124:127],a[68:71],0
v_cvt_pk_bf16_f32 v34,v100,v101
v_cvt_pk_bf16_f32 v35,v102,v103
v_mfma_f32_16x16x32_bf16 v[88:91],a[120:123],a[64:67],v[88:91]
v_fma_f32 v72,v72,s36,v13
v_fma_f32 v73,v73,s36,v13
v_smfmac_f32_16x16x64_bf16 v[64:67],a[152:155],v[28:35],v18
v_fma_f32 v74,v74,s36,v13
v_mfma_f32_16x16x32_bf16 v[88:91],a[148:151],a[60:63],v[88:91]
v_fma_f32 v75,v75,s36,v13
v_fma_f32 v80,v80,s36,v14
v_mfma_f32_16x16x32_bf16 v[88:91],a[144:147],a[56:59],v[88:91]
v_fma_f32 v81,v81,s36,v14
v_mfma_f32_16x16x32_bf16 v[88:91],a[140:143],a[52:55],v[88:91]
buffer_load_dwordx4 v6,s[4:7],s20 offen offset:0 lds
v_mfma_f32_16x16x32_bf16 v[88:91],a[136:139],a[48:51],v[88:91]
v_exp_f32 v72,v72
v_mfma_f32_16x16x32_bf16 v[96:99],a[136:139],a[72:75],0
ds_read_b128 a[136:139],v0 offset:6272
v_mfma_f32_16x16x32_bf16 v[96:99],a[140:143],a[76:79],v[96:99]
ds_read_b128 a[140:143],v1 offset:6272
v_mfma_f32_16x16x32_bf16 v[96:99],a[144:147],a[80:83],v[96:99]
ds_read_b128 a[144:147],v0 offset:6400
v_mfma_f32_16x16x32_bf16 v[96:99],a[148:151],a[84:87],v[96:99]
ds_read_b128 a[148:151],v1 offset:6400
v_mfma_f32_16x16x32_bf16 v[96:99],a[120:123],a[88:91],v[96:99]
v_exp_f32 v73,v73
v_mfma_f32_16x16x32_bf16 v[96:99],a[124:127],a[92:95],v[96:99]
s_waitcnt lgkmcnt(4)
v_exp_f32 v74,v74
v_mfma_f32_16x16x32_bf16 v[76:79],a[128:131],a[0:3],0
v_exp_f32 v75,v75
v_mfma_f32_16x16x32_bf16 v[76:79],a[132:135],a[4:7],v[76:79]
buffer_load_dwordx4 v7,s[4:7],s20 offen offset:1024 lds
s_waitcnt lgkmcnt(3)
v_mfma_f32_16x16x32_bf16 v[76:79],a[136:139],a[8:11],v[76:79]
s_waitcnt lgkmcnt(2)
v_exp_f32 v80,v80
v_mfma_f32_16x16x32_bf16 v[76:79],a[140:143],a[12:15],v[76:79]
s_waitcnt lgkmcnt(0)
v_exp_f32 v81,v81
v_mfma_f32_16x16x32_bf16 v[76:79],a[144:147],a[16:19],v[76:79]
v_cvt_pk_bf16_f32 v44,v72,v73
v_cvt_pk_bf16_f32 v45,v74,v75
v_mfma_f32_16x16x32_bf16 v[76:79],a[148:151],a[20:23],v[76:79]
v_cvt_pk_bf16_f32 v48,v80,v81
v_mfma_f32_16x16x32_bf16 v[84:87],a[148:151],a[44:47],0
v_mfma_f32_16x16x32_bf16 v[84:87],a[144:147],a[40:43],v[84:87]
v_mfma_f32_16x16x32_bf16 v[84:87],a[140:143],a[36:39],v[84:87]
v_mfma_f32_16x16x32_bf16 v[84:87],a[136:139],a[32:35],v[84:87]
v_mfma_f32_16x16x32_bf16 v[84:87],a[132:135],a[28:31],v[84:87]
buffer_load_dwordx4 v8,s[4:7],s20 offen offset:2048 lds
v_mfma_f32_16x16x32_bf16 v[84:87],a[128:131],a[24:27],v[84:87]
s_add_u32 s20,s20,12288
v_mfma_f32_16x16x32_bf16 v[92:95],a[128:131],a[48:51],0
ds_read_b64_tr_b16 a[120:121],v2 offset:24576
v_mfma_f32_16x16x32_bf16 v[92:95],a[132:135],a[52:55],v[92:95]
ds_read_b64_tr_b16 a[122:123],v2 offset:30720
v_mfma_f32_16x16x32_bf16 v[92:95],a[136:139],a[56:59],v[92:95]
ds_read_b64_tr_b16 a[124:125],v3 offset:24576
v_mfma_f32_16x16x32_bf16 v[92:95],a[140:143],a[60:63],v[92:95]
ds_read_b64_tr_b16 a[126:127],v3 offset:30720
v_mfma_f32_16x16x32_bf16 v[92:95],a[144:147],a[64:67],v[92:95]
v_mfma_f32_16x16x32_bf16 v[92:95],a[148:151],a[68:71],v[92:95]
v_mfma_f32_16x16x32_bf16 v[100:103],a[148:151],a[92:95],0
v_mfma_f32_16x16x32_bf16 v[100:103],a[144:147],a[88:91],v[100:103]
v_mfma_f32_16x16x32_bf16 v[100:103],a[140:143],a[84:87],v[100:103]
v_mfma_f32_16x16x32_bf16 v[100:103],a[136:139],a[80:83],v[100:103]
v_mfma_f32_16x16x32_bf16 v[100:103],a[132:135],a[76:79],v[100:103]
ds_read_b64_tr_b16 a[132:133],v5 offset:24576
v_mfma_f32_16x16x32_bf16 v[100:103],a[128:131],a[72:75],v[100:103]
ds_read_b64_tr_b16 a[128:129],v4 offset:24576
ds_read_b64_tr_b16 a[130:131],v4 offset:30720
ds_read_b64_tr_b16 a[134:135],v5 offset:30720
s_mov_b32 s38,0
s_branch L_loop4
L_end5:
s_waitcnt lgkmcnt(3)
v_mfma_f32_16x16x32_bf16 v[160:163],a[120:123],v[20:23],v[160:163]
ds_read_b64_tr_b16 a[136:137],v2 offset:24704
v_fma_f32 v90,v90,s36,v15
v_mfma_f32_16x16x32_bf16 v[164:167],a[124:127],v[20:23],v[164:167]
ds_read_b64_tr_b16 a[138:139],v2 offset:30848
v_fma_f32 v91,v91,s36,v15
v_mfma_f32_16x16x32_bf16 v[212:215],a[124:127],v[24:27],v[212:215]
ds_read_b64_tr_b16 a[140:141],v3 offset:24704
v_fma_f32 v96,v96,s36,v16
v_mfma_f32_16x16x32_bf16 v[208:211],a[120:123],v[24:27],v[208:211]
ds_read_b64_tr_b16 a[142:143],v3 offset:30848
v_fma_f32 v97,v97,s36,v16
v_mfma_f32_16x16x32_bf16 v[112:115],a[120:123],v[28:31],v[112:115]
ds_read_b64_tr_b16 a[144:145],v4 offset:24704
v_fma_f32 v98,v98,s36,v16
v_mfma_f32_16x16x32_bf16 v[116:119],a[124:127],v[28:31],v[116:119]
ds_read_b64_tr_b16 a[146:147],v4 offset:30848
ds_read_b64_tr_b16 a[148:149],v5 offset:24704
ds_read_b64_tr_b16 a[150:151],v5 offset:30848
v_mfma_f32_16x16x32_bf16 a[164:167],a[124:127],v[32:35],a[164:167]
v_fma_f32 v99,v99,s36,v16
v_fma_f32 v104,v104,s36,v17
v_mfma_f32_16x16x32_bf16 a[160:163],a[120:123],v[32:35],a[160:163]
v_fma_f32 v105,v105,s36,v17
v_fma_f32 v106,v106,s36,v17
v_mfma_f32_16x16x32_bf16 a[208:211],a[120:123],v[36:39],a[208:211]
ds_read_b64_tr_b16 a[120:121],v2 offset:24832
v_fma_f32 v107,v107,s36,v17
v_mfma_f32_16x16x32_bf16 a[212:215],a[124:127],v[36:39],a[212:215]
s_waitcnt lgkmcnt(6)
ds_read_b64_tr_b16 a[122:123],v2 offset:30976
v_fma_f32 v76,v76,s36,v13
v_mfma_f32_16x16x32_bf16 a[216:219],a[128:131],v[36:39],a[216:219]
ds_read_b64_tr_b16 a[124:125],v3 offset:24832
v_fma_f32 v77,v77,s36,v13
v_mfma_f32_16x16x32_bf16 a[220:223],a[132:135],v[36:39],a[220:223]
ds_read_b64_tr_b16 a[126:127],v3 offset:30976
v_fma_f32 v78,v78,s36,v13
v_mfma_f32_16x16x32_bf16 a[172:175],a[132:135],v[32:35],a[172:175]
v_fma_f32 v79,v79,s36,v13
v_fma_f32 v84,v84,s36,v14
v_mfma_f32_16x16x32_bf16 a[168:171],a[128:131],v[32:35],a[168:171]
v_fma_f32 v85,v85,s36,v14
v_fma_f32 v86,v86,s36,v14
v_mfma_f32_16x16x32_bf16 v[120:123],a[128:131],v[28:31],v[120:123]
v_fma_f32 v87,v87,s36,v14
v_fma_f32 v92,v92,s36,v15
v_mfma_f32_16x16x32_bf16 v[124:127],a[132:135],v[28:31],v[124:127]
v_fma_f32 v93,v93,s36,v15
v_fma_f32 v94,v94,s36,v15
v_mfma_f32_16x16x32_bf16 v[220:223],a[132:135],v[24:27],v[220:223]
v_fma_f32 v95,v95,s36,v15
v_fma_f32 v100,v100,s36,v16
v_mfma_f32_16x16x32_bf16 v[216:219],a[128:131],v[24:27],v[216:219]
v_fma_f32 v101,v101,s36,v16
v_fma_f32 v102,v102,s36,v16
v_mfma_f32_16x16x32_bf16 v[168:171],a[128:131],v[20:23],v[168:171]
ds_read_b64_tr_b16 a[128:129],v4 offset:24832
v_fma_f32 v103,v103,s36,v16
v_mfma_f32_16x16x32_bf16 v[172:175],a[132:135],v[20:23],v[172:175]
ds_read_b64_tr_b16 a[130:131],v4 offset:30976
v_fma_f32 v108,v108,s36,v17
v_mfma_f32_16x16x32_bf16 v[176:179],a[136:139],v[20:23],v[176:179]
s_waitcnt lgkmcnt(2)
ds_read_b64_tr_b16 a[132:133],v5 offset:24832
v_fma_f32 v109,v109,s36,v17
v_mfma_f32_16x16x32_bf16 v[180:183],a[140:143],v[20:23],v[180:183]
ds_read_b64_tr_b16 a[134:135],v5 offset:30976
v_fma_f32 v110,v110,s36,v17
v_mfma_f32_16x16x32_bf16 v[228:231],a[140:143],v[24:27],v[228:231]
v_fma_f32 v111,v111,s36,v17
v_exp_f32 v90,v90
v_mfma_f32_16x16x32_bf16 v[224:227],a[136:139],v[24:27],v[224:227]
v_exp_f32 v91,v91
v_mfma_f32_16x16x32_bf16 v[128:131],a[136:139],v[28:31],v[128:131]
v_exp_f32 v96,v96
v_mfma_f32_16x16x32_bf16 v[132:135],a[140:143],v[28:31],v[132:135]
v_exp_f32 v97,v97
v_mfma_f32_16x16x32_bf16 a[180:183],a[140:143],v[32:35],a[180:183]
v_exp_f32 v98,v98
v_mfma_f32_16x16x32_bf16 a[176:179],a[136:139],v[32:35],a[176:179]
v_exp_f32 v99,v99
v_mfma_f32_16x16x32_bf16 a[224:227],a[136:139],v[36:39],a[224:227]
v_exp_f32 v104,v104
v_mfma_f32_16x16x32_bf16 a[228:231],a[140:143],v[36:39],a[228:231]
v_exp_f32 v105,v105
v_mfma_f32_16x16x32_bf16 a[232:235],a[144:147],v[36:39],a[232:235]
v_exp_f32 v106,v106
v_mfma_f32_16x16x32_bf16 a[236:239],a[148:151],v[36:39],a[236:239]
v_exp_f32 v107,v107
v_mfma_f32_16x16x32_bf16 a[188:191],a[148:151],v[32:35],a[188:191]
v_exp_f32 v76,v76
v_mfma_f32_16x16x32_bf16 a[184:187],a[144:147],v[32:35],a[184:187]
v_exp_f32 v77,v77
v_mfma_f32_16x16x32_bf16 v[136:139],a[144:147],v[28:31],v[136:139]
v_exp_f32 v78,v78
v_mfma_f32_16x16x32_bf16 v[140:143],a[148:151],v[28:31],v[140:143]
v_exp_f32 v79,v79
v_mfma_f32_16x16x32_bf16 v[236:239],a[148:151],v[24:27],v[236:239]
v_exp_f32 v84,v84
v_mfma_f32_16x16x32_bf16 v[232:235],a[144:147],v[24:27],v[232:235]
v_exp_f32 v85,v85
v_mfma_f32_16x16x32_bf16 v[184:187],a[144:147],v[20:23],v[184:187]
v_exp_f32 v86,v86
v_mfma_f32_16x16x32_bf16 v[188:191],a[148:151],v[20:23],v[188:191]
v_exp_f32 v87,v87
v_mfma_f32_16x16x32_bf16 v[192:195],a[120:123],v[20:23],v[192:195]
v_exp_f32 v92,v92
v_mfma_f32_16x16x32_bf16 v[196:199],a[124:127],v[20:23],v[196:199]
v_exp_f32 v93,v93
v_mfma_f32_16x16x32_bf16 v[244:247],a[124:127],v[24:27],v[244:247]
v_exp_f32 v94,v94
v_mfma_f32_16x16x32_bf16 v[240:243],a[120:123],v[24:27],v[240:243]
v_exp_f32 v95,v95
v_mfma_f32_16x16x32_bf16 v[144:147],a[120:123],v[28:31],v[144:147]
v_exp_f32 v100,v100
v_mfma_f32_16x16x32_bf16 v[148:151],a[124:127],v[28:31],v[148:151]
v_exp_f32 v101,v101
v_mfma_f32_16x16x32_bf16 a[196:199],a[124:127],v[32:35],a[196:199]
v_exp_f32 v102,v102
v_mfma_f32_16x16x32_bf16 a[192:195],a[120:123],v[32:35],a[192:195]
v_exp_f32 v103,v103
v_mfma_f32_16x16x32_bf16 a[240:243],a[120:123],v[36:39],a[240:243]
v_exp_f32 v108,v108
s_waitcnt vmcnt(14) lgkmcnt(0)
s_barrier
v_mfma_f32_16x16x32_bf16 a[244:247],a[124:127],v[36:39],a[244:247]
v_exp_f32 v109,v109
v_mfma_f32_16x16x32_bf16 a[248:251],a[128:131],v[36:39],a[248:251]
v_exp_f32 v110,v110
v_mfma_f32_16x16x32_bf16 a[252:255],a[132:135],v[36:39],a[252:255]
v_exp_f32 v111,v111
v_mfma_f32_16x16x32_bf16 a[204:207],a[132:135],v[32:35],a[204:207]
v_cvt_pk_bf16_f32 v53,v90,v91
v_cvt_pk_bf16_f32 v56,v96,v97
v_mfma_f32_16x16x32_bf16 a[200:203],a[128:131],v[32:35],a[200:203]
v_cvt_pk_bf16_f32 v57,v98,v99
v_cvt_pk_bf16_f32 v40,v104,v105
v_mfma_f32_16x16x32_bf16 v[152:155],a[128:131],v[28:31],v[152:155]
v_cvt_pk_bf16_f32 v41,v106,v107
v_cvt_pk_bf16_f32 v46,v76,v77
v_mfma_f32_16x16x32_bf16 v[156:159],a[132:135],v[28:31],v[156:159]
v_cvt_pk_bf16_f32 v47,v78,v79
v_cvt_pk_bf16_f32 v50,v84,v85
v_mfma_f32_16x16x32_bf16 v[252:255],a[132:135],v[24:27],v[252:255]
v_cvt_pk_bf16_f32 v51,v86,v87
v_cvt_pk_bf16_f32 v54,v92,v93
v_mfma_f32_16x16x32_bf16 v[248:251],a[128:131],v[24:27],v[248:251]
v_cvt_pk_bf16_f32 v55,v94,v95
v_cvt_pk_bf16_f32 v58,v100,v101
v_smfmac_f32_16x16x64_bf16 v[60:63],a[152:155],v[44:51],v18
v_cvt_pk_bf16_f32 v59,v102,v103
v_mfma_f32_16x16x32_bf16 v[200:203],a[128:131],v[20:23],v[200:203]
v_cvt_pk_bf16_f32 v42,v108,v109
v_cvt_pk_bf16_f32 v43,v110,v111
v_smfmac_f32_16x16x64_bf16 v[64:67],a[152:155],v[52:59],v18
v_subrev_u32 v10,18432,v10
v_smfmac_f32_16x16x64_bf16 v[68:71],a[152:155],v[36:43],v18
v_mfma_f32_16x16x32_bf16 v[204:207],a[132:135],v[20:23],v[204:207]
ds_read_b64_tr_b16 a[136:137],v2 offset:0
ds_read_b64_tr_b16 a[138:139],v2 offset:6144
ds_read_b64_tr_b16 a[140:141],v3 offset:0
ds_read_b64_tr_b16 a[142:143],v3 offset:6144
ds_read_b64_tr_b16 a[144:145],v4 offset:0
ds_read_b64_tr_b16 a[146:147],v4 offset:6144
ds_read_b64_tr_b16 a[148:149],v5 offset:0
ds_read_b64_tr_b16 a[150:151],v5 offset:6144
s_waitcnt lgkmcnt(6)
v_mfma_f32_16x16x32_bf16 v[160:163],a[136:139],v[44:47],v[160:163]
s_waitcnt vmcnt(6)
ds_read_b64_tr_b16 a[122:123],v2 offset:6272
v_mbcnt_lo_u32_b32 v39,-1,0
s_waitcnt lgkmcnt(5)
v_mfma_f32_16x16x32_bf16 v[164:167],a[140:143],v[44:47],v[164:167]
s_add_u32 s84,s42,0
ds_read_b64_tr_b16 a[120:121],v2 offset:128
v_mbcnt_hi_u32_b32 v39,-1,v39
v_mfma_f32_16x16x32_bf16 v[212:215],a[140:143],v[48:51],v[212:215]
s_add_u32 s85,s42,6144
ds_read_b64_tr_b16 a[126:127],v3 offset:6272
v_and_b32 v38,7,v39
v_mfma_f32_16x16x32_bf16 v[208:211],a[136:139],v[48:51],v[208:211]
s_add_u32 s86,s42,12288
ds_read_b64_tr_b16 a[124:125],v3 offset:128
v_add_f32 v60,v60,v61
v_mfma_f32_16x16x32_bf16 v[112:115],a[136:139],v[52:55],v[112:115]
s_add_u32 s87,s42,18432
ds_read_b64_tr_b16 a[128:129],v4 offset:128
v_add_f32 v64,v64,v65
v_mfma_f32_16x16x32_bf16 v[116:119],a[140:143],v[52:55],v[116:119]
s_add_u32 s66,s42,24576
ds_read_b64_tr_b16 a[130:131],v4 offset:6272
v_add_f32 v62,v62,v63
v_mfma_f32_16x16x32_bf16 a[164:167],a[140:143],v[56:59],a[164:167]
ds_read_b64_tr_b16 a[132:133],v5 offset:128
v_max3_f32 v19,v60,v62,v64
v_mfma_f32_16x16x32_bf16 a[160:163],a[136:139],v[56:59],a[160:163]
ds_read_b64_tr_b16 a[134:135],v5 offset:6272
v_add_f32 v68,v68,v69
v_mfma_f32_16x16x32_bf16 a[208:211],a[136:139],v[40:43],a[208:211]
ds_read_b64_tr_b16 a[136:137],v2 offset:256
v_add_f32 v68,v68,v70
v_mfma_f32_16x16x32_bf16 a[212:215],a[140:143],v[40:43],a[212:215]
s_waitcnt lgkmcnt(6)
ds_read_b64_tr_b16 a[138:139],v2 offset:6400
v_add_f32 v66,v66,v67
v_mfma_f32_16x16x32_bf16 a[216:219],a[144:147],v[40:43],a[216:219]
ds_read_b64_tr_b16 a[140:141],v3 offset:256
v_add_f32 v68,v68,v71
v_mfma_f32_16x16x32_bf16 a[220:223],a[148:151],v[40:43],a[220:223]
ds_read_b64_tr_b16 a[142:143],v3 offset:6400
v_max3_f32 v19,v19,v66,v68
v_rcp_f32 v66,v66
v_rcp_f32 v68,v68
v_accvgpr_read_b32 v74,a162
v_accvgpr_read_b32 v75,a163
v_pk_mul_f32 v[74:75],v[74:75],v[66:67] op_sel_hi:[1,0]
v_accvgpr_read_b32 v79,a211
v_accvgpr_read_b32 v72,a160
v_accvgpr_read_b32 v76,a208
v_accvgpr_read_b32 v73,a161
v_pk_mul_f32 v[72:73],v[72:73],v[66:67] op_sel_hi:[1,0]
v_accvgpr_read_b32 v77,a209
v_pk_mul_f32 v[76:77],v[76:77],v[68:69] op_sel_hi:[1,0]
v_accvgpr_read_b32 v78,a210
v_pk_mul_f32 v[78:79],v[78:79],v[68:69] op_sel_hi:[1,0]
v_accvgpr_read_b32 v84,a212
v_accvgpr_read_b32 v82,a166
v_mfma_f32_16x16x32_bf16 a[172:175],a[148:151],v[56:59],a[172:175]
v_accvgpr_read_b32 v87,a215
v_accvgpr_read_b32 v83,a167
v_accvgpr_read_b32 v80,a164
v_accvgpr_read_b32 v81,a165
v_accvgpr_read_b32 v86,a214
v_pk_mul_f32 v[86:87],v[86:87],v[68:69] op_sel_hi:[1,0]
v_pk_mul_f32 v[80:81],v[80:81],v[66:67] op_sel_hi:[1,0]
v_pk_mul_f32 v[82:83],v[82:83],v[66:67] op_sel_hi:[1,0]
v_accvgpr_read_b32 v85,a213
v_pk_mul_f32 v[84:85],v[84:85],v[68:69] op_sel_hi:[1,0]
v_accvgpr_read_b32 v102,a222
v_accvgpr_read_b32 v96,a172
v_mfma_f32_16x16x32_bf16 a[168:171],a[144:147],v[56:59],a[168:171]
v_accvgpr_read_b32 v103,a223
v_accvgpr_read_b32 v94,a218
v_mfma_f32_16x16x32_bf16 v[120:123],a[144:147],v[52:55],v[120:123]
v_accvgpr_read_b32 v99,a175
v_accvgpr_read_b32 v100,a220
v_mfma_f32_16x16x32_bf16 v[124:127],a[148:151],v[52:55],v[124:127]
v_accvgpr_read_b32 v97,a173
v_accvgpr_read_b32 v95,a219
v_mfma_f32_16x16x32_bf16 v[220:223],a[148:151],v[48:51],v[220:223]
v_accvgpr_read_b32 v90,a170
v_accvgpr_read_b32 v91,a171
v_accvgpr_read_b32 v89,a169
v_accvgpr_read_b32 v88,a168
v_accvgpr_read_b32 v98,a174
v_pk_mul_f32 v[94:95],v[94:95],v[68:69] op_sel_hi:[1,0]
v_pk_mul_f32 v[102:103],v[102:103],v[68:69] op_sel_hi:[1,0]
v_pk_mul_f32 v[88:89],v[88:89],v[66:67] op_sel_hi:[1,0]
v_pk_mul_f32 v[98:99],v[98:99],v[66:67] op_sel_hi:[1,0]
v_pk_mul_f32 v[90:91],v[90:91],v[66:67] op_sel_hi:[1,0]
v_pk_mul_f32 v[96:97],v[96:97],v[66:67] op_sel_hi:[1,0]
v_accvgpr_read_b32 v93,a217
v_accvgpr_read_b32 v92,a216
v_pk_mul_f32 v[92:93],v[92:93],v[68:69] op_sel_hi:[1,0]
v_accvgpr_read_b32 v101,a221
v_pk_mul_f32 v[100:101],v[100:101],v[68:69] op_sel_hi:[1,0]
v_cmp_ngt_f32 vcc,s37,v19
v_lshrrev_b32 v19,5,v39
v_mfma_f32_16x16x32_bf16 v[216:219],a[144:147],v[48:51],v[216:219]
v_xor_b32 v38,v38,v19
v_and_b32 v19,15,v39
v_mfma_f32_16x16x32_bf16 v[168:171],a[144:147],v[44:47],v[168:171]
s_cmp_lg_u64 vcc,0
ds_read_b64_tr_b16 a[144:145],v4 offset:256
v_lshl_add_u32 v19,v19,7,s24
v_mfma_f32_16x16x32_bf16 v[172:175],a[148:151],v[44:47],v[172:175]
s_cselect_b32 s62,s32,0
ds_read_b64_tr_b16 a[146:147],v4 offset:6400
v_lshl_add_u32 v19,v38,4,v19
v_mfma_f32_16x16x32_bf16 v[176:179],a[120:123],v[44:47],v[176:179]
s_or_b32 s31,s31,s62
ds_read_b64_tr_b16 a[148:149],v5 offset:256
v_bfe_u32 v38,v39,4,1
s_waitcnt lgkmcnt(3)
v_mfma_f32_16x16x32_bf16 v[180:183],a[124:127],v[44:47],v[180:183]
s_lshl_b32 s32,s32,1
ds_read_b64_tr_b16 a[150:151],v5 offset:6400
v_lshl_add_u32 v36,v38,3,v19
v_mfma_f32_16x16x32_bf16 v[228:231],a[124:127],v[48:51],v[228:231]
v_xor_b32 v37,32,v36
v_xor_b32 v38,64,v36
v_mfma_f32_16x16x32_bf16 v[224:227],a[120:123],v[48:51],v[224:227]
v_bfe_u32 v19,v39,3,1
v_xor_b32 v39,96,v36
v_mfma_f32_16x16x32_bf16 v[128:131],a[120:123],v[52:55],v[128:131]
v_lshlrev_b32 v19,11,v19
v_cvt_pk_bf16_f32 v72,v72,v73
v_mfma_f32_16x16x32_bf16 v[132:135],a[124:127],v[52:55],v[132:135]
v_cvt_pk_bf16_f32 v76,v76,v77
v_cvt_pk_bf16_f32 v73,v74,v75
v_mfma_f32_16x16x32_bf16 a[180:183],a[124:127],v[56:59],a[180:183]
v_cvt_pk_bf16_f32 v84,v84,v85
v_cvt_pk_bf16_f32 v77,v78,v79
v_mfma_f32_16x16x32_bf16 a[176:179],a[120:123],v[56:59],a[176:179]
ds_write2st64_b64 v36,v[72:73],v[76:77] offset0:36 offset1:40
v_mfma_f32_16x16x32_bf16 a[224:227],a[120:123],v[40:43],a[224:227]
v_cvt_pk_bf16_f32 v85,v86,v87
v_cvt_pk_bf16_f32 v80,v80,v81
v_mfma_f32_16x16x32_bf16 a[228:231],a[124:127],v[40:43],a[228:231]
v_cvt_pk_bf16_f32 v81,v82,v83
v_cvt_pk_bf16_f32 v92,v92,v93
v_mfma_f32_16x16x32_bf16 a[232:235],a[128:131],v[40:43],a[232:235]
v_accvgpr_read_b32 v83,a179
v_accvgpr_read_b32 v82,a178
v_mfma_f32_16x16x32_bf16 a[236:239],a[132:135],v[40:43],a[236:239]
ds_write2st64_b64 v37,v[80:81],v[84:85] offset0:36 offset1:40
v_pk_mul_f32 v[82:83],v[82:83],v[66:67] op_sel_hi:[1,0]
v_accvgpr_read_b32 v84,a224
v_accvgpr_read_b32 v85,a225
v_pk_mul_f32 v[84:85],v[84:85],v[68:69] op_sel_hi:[1,0]
v_accvgpr_read_b32 v81,a177
v_accvgpr_read_b32 v87,a227
v_accvgpr_read_b32 v86,a226
v_pk_mul_f32 v[86:87],v[86:87],v[68:69] op_sel_hi:[1,0]
v_accvgpr_read_b32 v80,a176
v_pk_mul_f32 v[80:81],v[80:81],v[66:67] op_sel_hi:[1,0]
v_cvt_pk_bf16_f32 v93,v94,v95
v_cvt_pk_bf16_f32 v88,v88,v89
v_mfma_f32_16x16x32_bf16 a[188:191],a[132:135],v[56:59],a[188:191]
v_cvt_pk_bf16_f32 v89,v90,v91
ds_write2st64_b64 v38,v[88:89],v[92:93] offset0:36 offset1:40
v_accvgpr_read_b32 v88,a180
v_accvgpr_read_b32 v93,a229
v_accvgpr_read_b32 v90,a182
v_accvgpr_read_b32 v94,a230
v_accvgpr_read_b32 v95,a231
v_pk_mul_f32 v[94:95],v[94:95],v[68:69] op_sel_hi:[1,0]
v_accvgpr_read_b32 v89,a181
v_pk_mul_f32 v[88:89],v[88:89],v[66:67] op_sel_hi:[1,0]
v_accvgpr_read_b32 v92,a228
v_pk_mul_f32 v[92:93],v[92:93],v[68:69] op_sel_hi:[1,0]
v_accvgpr_read_b32 v91,a183
v_pk_mul_f32 v[90:91],v[90:91],v[66:67] op_sel_hi:[1,0]
v_cvt_pk_bf16_f32 v100,v100,v101
v_cvt_pk_bf16_f32 v101,v102,v103
v_mfma_f32_16x16x32_bf16 a[184:187],a[128:131],v[56:59],a[184:187]
v_cvt_pk_bf16_f32 v96,v96,v97
v_cvt_pk_bf16_f32 v97,v98,v99
v_mfma_f32_16x16x32_bf16 v[136:139],a[128:131],v[52:55],v[136:139]
ds_write2st64_b64 v39,v[96:97],v[100:101] offset0:36 offset1:40
v_mfma_f32_16x16x32_bf16 v[140:143],a[132:135],v[52:55],v[140:143]
v_cvt_pk_bf16_f32 v80,v80,v81
v_cvt_pk_bf16_f32 v81,v82,v83
v_mfma_f32_16x16x32_bf16 v[236:239],a[132:135],v[48:51],v[236:239]
ds_read_b128 v[104:107],v10 offset:18432
v_accvgpr_read_b32 v96,a184
ds_read_b128 v[108:111],v10 offset:19456
v_cvt_pk_bf16_f32 v84,v84,v85
ds_read_b128 v[72:75],v10 offset:20480
v_cvt_pk_bf16_f32 v85,v86,v87
ds_read_b128 v[76:79],v10 offset:21504
v_accvgpr_read_b32 v87,a239
ds_write2st64_b64 v36,v[80:81],v[84:85] offset0:36 offset1:40
v_accvgpr_read_b32 v98,a186
v_accvgpr_read_b32 v101,a233
v_accvgpr_read_b32 v100,a232
v_pk_mul_f32 v[100:101],v[100:101],v[68:69] op_sel_hi:[1,0]
v_accvgpr_read_b32 v86,a238
v_pk_mul_f32 v[86:87],v[86:87],v[68:69] op_sel_hi:[1,0]
v_accvgpr_read_b32 v81,a189
s_waitcnt lgkmcnt(4)
buffer_store_dwordx4 v[104:107],v9,s[16:19],s87 offen offset:0 nt
v_accvgpr_read_b32 v80,a188
v_pk_mul_f32 v[80:81],v[80:81],v[66:67] op_sel_hi:[1,0]
v_accvgpr_read_b32 v102,a234
v_accvgpr_read_b32 v83,a191
v_accvgpr_read_b32 v85,a237
v_accvgpr_read_b32 v84,a236
v_pk_mul_f32 v[84:85],v[84:85],v[68:69] op_sel_hi:[1,0]
v_accvgpr_read_b32 v97,a185
v_pk_mul_f32 v[96:97],v[96:97],v[66:67] op_sel_hi:[1,0]
v_accvgpr_read_b32 v82,a190
v_pk_mul_f32 v[82:83],v[82:83],v[66:67] op_sel_hi:[1,0]
s_waitcnt lgkmcnt(1)
buffer_store_dwordx4 v[108:111],v9,s[16:19],s87 offen offset:3072 nt
v_accvgpr_read_b32 v99,a187
v_pk_mul_f32 v[98:99],v[98:99],v[66:67] op_sel_hi:[1,0]
v_accvgpr_read_b32 v103,a235
v_pk_mul_f32 v[102:103],v[102:103],v[68:69] op_sel_hi:[1,0]
v_cvt_pk_bf16_f32 v88,v88,v89
v_cvt_pk_bf16_f32 v89,v90,v91
v_mfma_f32_16x16x32_bf16 v[232:235],a[128:131],v[48:51],v[232:235]
v_cvt_pk_bf16_f32 v92,v92,v93
v_cvt_pk_bf16_f32 v93,v94,v95
v_mfma_f32_16x16x32_bf16 v[184:187],a[128:131],v[44:47],v[184:187]
ds_write2st64_b64 v37,v[88:89],v[92:93] offset0:36 offset1:40
v_mfma_f32_16x16x32_bf16 v[188:191],a[132:135],v[44:47],v[188:191]
v_cvt_pk_bf16_f32 v96,v96,v97
v_cvt_pk_bf16_f32 v97,v98,v99
v_mfma_f32_16x16x32_bf16 v[192:195],a[136:139],v[44:47],v[192:195]
buffer_store_dwordx4 v[72:75],v9,s[16:19],s66 offen offset:0 nt
v_cvt_pk_bf16_f32 v100,v100,v101
v_cvt_pk_bf16_f32 v80,v80,v81
v_cvt_pk_bf16_f32 v101,v102,v103
v_mfma_f32_16x16x32_bf16 v[196:199],a[140:143],v[44:47],v[196:199]
v_cvt_pk_bf16_f32 v81,v82,v83
v_cvt_pk_bf16_f32 v84,v84,v85
v_mfma_f32_16x16x32_bf16 v[244:247],a[140:143],v[48:51],v[244:247]
v_cvt_pk_bf16_f32 v85,v86,v87
v_rcp_f32 v62,v62
v_mfma_f32_16x16x32_bf16 v[240:243],a[136:139],v[48:51],v[240:243]
ds_write2st64_b64 v38,v[96:97],v[100:101] offset0:36 offset1:40
v_mfma_f32_16x16x32_bf16 v[144:147],a[136:139],v[52:55],v[144:147]
v_rcp_f32 v64,v64
v_mfma_f32_16x16x32_bf16 v[148:151],a[140:143],v[52:55],v[148:151]
buffer_store_dwordx4 v[76:79],v9,s[16:19],s66 offen offset:3072 nt
v_rcp_f32 v60,v60
v_mfma_f32_16x16x32_bf16 a[196:199],a[140:143],v[56:59],a[196:199]
v_mfma_f32_16x16x32_bf16 a[192:195],a[136:139],v[56:59],a[192:195]
v_mfma_f32_16x16x32_bf16 a[240:243],a[136:139],v[40:43],a[240:243]
ds_write2st64_b64 v39,v[80:81],v[84:85] offset0:36 offset1:40
v_mfma_f32_16x16x32_bf16 a[244:247],a[140:143],v[40:43],a[244:247]
v_mfma_f32_16x16x32_bf16 a[248:251],a[144:147],v[40:43],a[248:251]
ds_read_b128 v[72:75],v10 offset:18432
v_mfma_f32_16x16x32_bf16 a[252:255],a[148:151],v[40:43],a[252:255]
ds_read_b128 v[76:79],v10 offset:19456
v_accvgpr_read_b32 v98,a198
ds_read_b128 v[88:91],v10 offset:20480
v_accvgpr_read_b32 v107,a195
ds_read_b128 v[92:95],v10 offset:21504
v_accvgpr_read_b32 v104,a192
v_accvgpr_read_b32 v111,a243
v_accvgpr_read_b32 v108,a240
v_accvgpr_read_b32 v106,a194
v_pk_mul_f32 v[106:107],v[106:107],v[66:67] op_sel_hi:[1,0]
v_accvgpr_read_b32 v105,a193
v_pk_mul_f32 v[104:105],v[104:105],v[66:67] op_sel_hi:[1,0]
v_accvgpr_read_b32 v109,a241
v_pk_mul_f32 v[108:109],v[108:109],v[68:69] op_sel_hi:[1,0]
v_accvgpr_read_b32 v110,a242
v_pk_mul_f32 v[110:111],v[110:111],v[68:69] op_sel_hi:[1,0]
v_accvgpr_read_b32 v100,a244
v_accvgpr_read_b32 v97,a197
v_mfma_f32_16x16x32_bf16 a[204:207],a[148:151],v[56:59],a[204:207]
s_waitcnt lgkmcnt(3)
v_accvgpr_read_b32 v102,a246
buffer_store_dwordx4 v[72:75],v9,s[16:19],s87 offen offset:128 nt
v_accvgpr_read_b32 v99,a199
v_pk_mul_f32 v[98:99],v[98:99],v[66:67] op_sel_hi:[1,0]
v_accvgpr_read_b32 v103,a247
v_pk_mul_f32 v[102:103],v[102:103],v[68:69] op_sel_hi:[1,0]
v_accvgpr_read_b32 v101,a245
v_pk_mul_f32 v[100:101],v[100:101],v[68:69] op_sel_hi:[1,0]
v_accvgpr_read_b32 v96,a196
v_pk_mul_f32 v[96:97],v[96:97],v[66:67] op_sel_hi:[1,0]
v_cvt_pk_bf16_f32 v108,v108,v109
v_cvt_pk_bf16_f32 v109,v110,v111
v_mfma_f32_16x16x32_bf16 a[200:203],a[144:147],v[56:59],a[200:203]
v_cvt_pk_bf16_f32 v104,v104,v105
v_accvgpr_read_b32 v86,a250
v_mfma_f32_16x16x32_bf16 v[152:155],a[144:147],v[52:55],v[152:155]
s_waitcnt lgkmcnt(0)
buffer_store_dwordx4 v[76:79],v9,s[16:19],s87 offen offset:3200 nt
v_cvt_pk_bf16_f32 v105,v106,v107
v_accvgpr_read_b32 v84,a248
v_accvgpr_read_b32 v106,a206
v_mfma_f32_16x16x32_bf16 v[156:159],a[148:151],v[52:55],v[156:159]
v_accvgpr_read_b32 v81,a201
v_accvgpr_read_b32 v80,a200
v_mfma_f32_16x16x32_bf16 v[252:255],a[148:151],v[48:51],v[252:255]
v_accvgpr_read_b32 v83,a203
ds_write2st64_b64 v36,v[104:105],v[108:109] offset0:36 offset1:40
v_pk_mul_f32 v[80:81],v[80:81],v[66:67] op_sel_hi:[1,0]
v_pk_mul_f32 v[228:229],v[228:229],v[62:63] op_sel_hi:[1,0]
v_pk_mul_f32 v[112:113],v[112:113],v[64:65] op_sel_hi:[1,0]
buffer_store_dwordx4 v[88:91],v9,s[16:19],s66 offen offset:128 nt
v_pk_mul_f32 v[238:239],v[238:239],v[62:63] op_sel_hi:[1,0]
v_pk_mul_f32 v[208:209],v[208:209],v[62:63] op_sel_hi:[1,0]
v_pk_mul_f32 v[114:115],v[114:115],v[64:65] op_sel_hi:[1,0]
v_pk_mul_f32 v[214:215],v[214:215],v[62:63] op_sel_hi:[1,0]
v_pk_mul_f32 v[220:221],v[220:221],v[62:63] op_sel_hi:[1,0]
v_pk_mul_f32 v[212:213],v[212:213],v[62:63] op_sel_hi:[1,0]
v_pk_mul_f32 v[242:243],v[242:243],v[62:63] op_sel_hi:[1,0]
v_pk_mul_f32 v[232:233],v[232:233],v[62:63] op_sel_hi:[1,0]
v_pk_mul_f32 v[236:237],v[236:237],v[62:63] op_sel_hi:[1,0]
v_pk_mul_f32 v[210:211],v[210:211],v[62:63] op_sel_hi:[1,0]
v_pk_mul_f32 v[218:219],v[218:219],v[62:63] op_sel_hi:[1,0]
buffer_store_dwordx4 v[92:95],v9,s[16:19],s66 offen offset:3200 nt
v_pk_mul_f32 v[240:241],v[240:241],v[62:63] op_sel_hi:[1,0]
v_pk_mul_f32 v[226:227],v[226:227],v[62:63] op_sel_hi:[1,0]
v_pk_mul_f32 v[234:235],v[234:235],v[62:63] op_sel_hi:[1,0]
v_pk_mul_f32 v[222:223],v[222:223],v[62:63] op_sel_hi:[1,0]
v_pk_mul_f32 v[118:119],v[118:119],v[64:65] op_sel_hi:[1,0]
v_pk_mul_f32 v[224:225],v[224:225],v[62:63] op_sel_hi:[1,0]
v_pk_mul_f32 v[116:117],v[116:117],v[64:65] op_sel_hi:[1,0]
v_pk_mul_f32 v[244:245],v[244:245],v[62:63] op_sel_hi:[1,0]
v_pk_mul_f32 v[230:231],v[230:231],v[62:63] op_sel_hi:[1,0]
v_pk_mul_f32 v[246:247],v[246:247],v[62:63] op_sel_hi:[1,0]
v_pk_mul_f32 v[216:217],v[216:217],v[62:63] op_sel_hi:[1,0]
v_add_u32 v36,v36,v19
v_accvgpr_read_b32 v108,a252
v_accvgpr_read_b32 v109,a253
v_pk_mul_f32 v[108:109],v[108:109],v[68:69] op_sel_hi:[1,0]
v_accvgpr_read_b32 v105,a205
v_cvt_pk_bf16_f32 v80,v80,v81
v_accvgpr_read_b32 v104,a204
v_pk_mul_f32 v[104:105],v[104:105],v[66:67] op_sel_hi:[1,0]
v_accvgpr_read_b32 v107,a207
v_pk_mul_f32 v[106:107],v[106:107],v[66:67] op_sel_hi:[1,0]
v_accvgpr_read_b32 v87,a251
v_pk_mul_f32 v[86:87],v[86:87],v[68:69] op_sel_hi:[1,0]
v_accvgpr_read_b32 v82,a202
v_pk_mul_f32 v[82:83],v[82:83],v[66:67] op_sel_hi:[1,0]
v_accvgpr_read_b32 v85,a249
v_pk_mul_f32 v[84:85],v[84:85],v[68:69] op_sel_hi:[1,0]
v_cvt_pk_bf16_f32 v104,v104,v105
v_cvt_pk_bf16_f32 v84,v84,v85
v_cvt_pk_bf16_f32 v85,v86,v87
v_cvt_pk_bf16_f32 v100,v100,v101
v_accvgpr_read_b32 v110,a254
v_cvt_pk_bf16_f32 v81,v82,v83
v_cvt_pk_bf16_f32 v96,v96,v97
v_cvt_pk_bf16_f32 v108,v108,v109
v_cvt_pk_bf16_f32 v101,v102,v103
v_accvgpr_read_b32 v111,a255
v_pk_mul_f32 v[110:111],v[110:111],v[68:69] op_sel_hi:[1,0]
v_cvt_pk_bf16_f32 v97,v98,v99
v_cvt_pk_bf16_f32 v109,v110,v111
v_mfma_f32_16x16x32_bf16 v[248:251],a[144:147],v[48:51],v[248:251]
ds_write2st64_b64 v37,v[96:97],v[100:101] offset0:36 offset1:40
v_mfma_f32_16x16x32_bf16 v[200:203],a[144:147],v[44:47],v[200:203]
v_add_u32 v37,v37,v19
v_cvt_pk_bf16_f32 v105,v106,v107
v_mfma_f32_16x16x32_bf16 v[204:207],a[148:151],v[44:47],v[204:207]
v_cvt_pk_bf16_f32 v224,v224,v225
v_cvt_pk_bf16_f32 v212,v212,v213
v_cvt_pk_bf16_f32 v225,v226,v227
v_cvt_pk_bf16_f32 v208,v208,v209
v_cvt_pk_bf16_f32 v209,v210,v211
ds_write2st64_b64 v38,v[80:81],v[84:85] offset0:36 offset1:40
v_pk_mul_f32 v[120:121],v[120:121],v[64:65] op_sel_hi:[1,0]
v_pk_mul_f32 v[250:251],v[250:251],v[62:63] op_sel_hi:[1,0]
v_pk_mul_f32 v[122:123],v[122:123],v[64:65] op_sel_hi:[1,0]
v_pk_mul_f32 v[252:253],v[252:253],v[62:63] op_sel_hi:[1,0]
v_pk_mul_f32 v[124:125],v[124:125],v[64:65] op_sel_hi:[1,0]
v_pk_mul_f32 v[254:255],v[254:255],v[62:63] op_sel_hi:[1,0]
v_pk_mul_f32 v[248:249],v[248:249],v[62:63] op_sel_hi:[1,0]
v_pk_mul_f32 v[126:127],v[126:127],v[64:65] op_sel_hi:[1,0]
v_pk_mul_f32 v[130:131],v[130:131],v[64:65] op_sel_hi:[1,0]
v_pk_mul_f32 v[132:133],v[132:133],v[64:65] op_sel_hi:[1,0]
v_pk_mul_f32 v[128:129],v[128:129],v[64:65] op_sel_hi:[1,0]
ds_write2st64_b64 v39,v[104:105],v[108:109] offset0:36 offset1:40
v_pk_mul_f32 v[148:149],v[148:149],v[64:65] op_sel_hi:[1,0]
v_pk_mul_f32 v[152:153],v[152:153],v[64:65] op_sel_hi:[1,0]
v_pk_mul_f32 v[146:147],v[146:147],v[64:65] op_sel_hi:[1,0]
ds_read_b128 v[72:75],v10 offset:18432
v_pk_mul_f32 v[144:145],v[144:145],v[64:65] op_sel_hi:[1,0]
ds_read_b128 v[76:79],v10 offset:19456
v_pk_mul_f32 v[136:137],v[136:137],v[64:65] op_sel_hi:[1,0]
ds_read_b128 v[88:91],v10 offset:20480
v_pk_mul_f32 v[154:155],v[154:155],v[64:65] op_sel_hi:[1,0]
ds_read_b128 v[92:95],v10 offset:21504
v_pk_mul_f32 v[156:157],v[156:157],v[64:65] op_sel_hi:[1,0]
ds_write2st64_b64 v36,v[208:209],v[224:225] offset0:12 offset1:14
v_pk_mul_f32 v[138:139],v[138:139],v[64:65] op_sel_hi:[1,0]
v_pk_mul_f32 v[134:135],v[134:135],v[64:65] op_sel_hi:[1,0]
v_pk_mul_f32 v[150:151],v[150:151],v[64:65] op_sel_hi:[1,0]
v_pk_mul_f32 v[142:143],v[142:143],v[64:65] op_sel_hi:[1,0]
v_pk_mul_f32 v[158:159],v[158:159],v[64:65] op_sel_hi:[1,0]
v_pk_mul_f32 v[140:141],v[140:141],v[64:65] op_sel_hi:[1,0]
v_pk_mul_f32 v[160:161],v[160:161],v[60:61] op_sel_hi:[1,0]
s_waitcnt lgkmcnt(4)
buffer_store_dwordx4 v[72:75],v9,s[16:19],s87 offen offset:256 nt
v_pk_mul_f32 v[180:181],v[180:181],v[60:61] op_sel_hi:[1,0]
v_pk_mul_f32 v[178:179],v[178:179],v[60:61] op_sel_hi:[1,0]
v_pk_mul_f32 v[164:165],v[164:165],v[60:61] op_sel_hi:[1,0]
v_pk_mul_f32 v[162:163],v[162:163],v[60:61] op_sel_hi:[1,0]
v_pk_mul_f32 v[176:177],v[176:177],v[60:61] op_sel_hi:[1,0]
v_pk_mul_f32 v[184:185],v[184:185],v[60:61] op_sel_hi:[1,0]
v_pk_mul_f32 v[172:173],v[172:173],v[60:61] op_sel_hi:[1,0]
v_pk_mul_f32 v[190:191],v[190:191],v[60:61] op_sel_hi:[1,0]
v_pk_mul_f32 v[166:167],v[166:167],v[60:61] op_sel_hi:[1,0]
v_pk_mul_f32 v[186:187],v[186:187],v[60:61] op_sel_hi:[1,0]
v_pk_mul_f32 v[182:183],v[182:183],v[60:61] op_sel_hi:[1,0]
s_waitcnt lgkmcnt(1)
buffer_store_dwordx4 v[76:79],v9,s[16:19],s87 offen offset:3328 nt
v_pk_mul_f32 v[168:169],v[168:169],v[60:61] op_sel_hi:[1,0]
v_pk_mul_f32 v[188:189],v[188:189],v[60:61] op_sel_hi:[1,0]
v_pk_mul_f32 v[170:171],v[170:171],v[60:61] op_sel_hi:[1,0]
v_pk_mul_f32 v[174:175],v[174:175],v[60:61] op_sel_hi:[1,0]
v_pk_mul_f32 v[192:193],v[192:193],v[60:61] op_sel_hi:[1,0]
v_pk_mul_f32 v[200:201],v[200:201],v[60:61] op_sel_hi:[1,0]
v_pk_mul_f32 v[194:195],v[194:195],v[60:61] op_sel_hi:[1,0]
v_pk_mul_f32 v[198:199],v[198:199],v[60:61] op_sel_hi:[1,0]
v_pk_mul_f32 v[202:203],v[202:203],v[60:61] op_sel_hi:[1,0]
v_pk_mul_f32 v[196:197],v[196:197],v[60:61] op_sel_hi:[1,0]
v_pk_mul_f32 v[204:205],v[204:205],v[60:61] op_sel_hi:[1,0]
buffer_store_dwordx4 v[88:91],v9,s[16:19],s66 offen offset:256 nt
v_pk_mul_f32 v[206:207],v[206:207],v[60:61] op_sel_hi:[1,0]
v_add_u32 v39,v39,v19
v_add_u32 v38,v38,v19
v_cvt_pk_bf16_f32 v216,v216,v217
v_cvt_pk_bf16_f32 v228,v228,v229
v_cvt_pk_bf16_f32 v220,v220,v221
v_cvt_pk_bf16_f32 v232,v232,v233
v_cvt_pk_bf16_f32 v233,v234,v235
v_cvt_pk_bf16_f32 v217,v218,v219
v_cvt_pk_bf16_f32 v236,v236,v237
v_cvt_pk_bf16_f32 v229,v230,v231
buffer_store_dwordx4 v[92:95],v9,s[16:19],s66 offen offset:3328 nt
v_cvt_pk_bf16_f32 v213,v214,v215
v_cvt_pk_bf16_f32 v221,v222,v223
v_cvt_pk_bf16_f32 v237,v238,v239
v_cvt_pk_bf16_f32 v240,v240,v241
v_cvt_pk_bf16_f32 v241,v242,v243
v_cvt_pk_bf16_f32 v112,v112,v113
v_cvt_pk_bf16_f32 v113,v114,v115
v_cvt_pk_bf16_f32 v124,v124,v125
v_cvt_pk_bf16_f32 v244,v244,v245
ds_write2st64_b64 v37,v[212:213],v[228:229] offset0:12 offset1:14
v_cvt_pk_bf16_f32 v245,v246,v247
v_cvt_pk_bf16_f32 v116,v116,v117
v_cvt_pk_bf16_f32 v252,v252,v253
v_cvt_pk_bf16_f32 v248,v248,v249
v_cvt_pk_bf16_f32 v249,v250,v251
v_cvt_pk_bf16_f32 v253,v254,v255
v_cvt_pk_bf16_f32 v120,v120,v121
v_cvt_pk_bf16_f32 v117,v118,v119
v_cvt_pk_bf16_f32 v121,v122,v123
v_cvt_pk_bf16_f32 v125,v126,v127
v_cvt_pk_bf16_f32 v132,v132,v133
ds_write2st64_b64 v38,v[216:217],v[232:233] offset0:12 offset1:14
v_cvt_pk_bf16_f32 v148,v148,v149
v_cvt_pk_bf16_f32 v144,v144,v145
v_cvt_pk_bf16_f32 v145,v146,v147
v_cvt_pk_bf16_f32 v128,v128,v129
v_cvt_pk_bf16_f32 v129,v130,v131
v_cvt_pk_bf16_f32 v136,v136,v137
v_cvt_pk_bf16_f32 v133,v134,v135
v_cvt_pk_bf16_f32 v149,v150,v151
v_cvt_pk_bf16_f32 v140,v140,v141
v_cvt_pk_bf16_f32 v137,v138,v139
v_cvt_pk_bf16_f32 v152,v152,v153
ds_write2st64_b64 v39,v[220:221],v[236:237] offset0:12 offset1:14
v_cvt_pk_bf16_f32 v141,v142,v143
v_cvt_pk_bf16_f32 v156,v156,v157
v_cvt_pk_bf16_f32 v153,v154,v155
ds_read_b128 v[96:99],v10 offset:6144
v_cvt_pk_bf16_f32 v157,v158,v159
ds_read_b128 v[100:103],v10 offset:9216
v_cvt_pk_bf16_f32 v180,v180,v181
ds_read_b128 v[80:83],v10 offset:7168
v_cvt_pk_bf16_f32 v160,v160,v161
ds_read_b128 v[84:87],v10 offset:10240
v_cvt_pk_bf16_f32 v168,v168,v169
ds_write2st64_b64 v36,v[240:241],v[112:113] offset0:16 offset1:24
v_cvt_pk_bf16_f32 v164,v164,v165
v_cvt_pk_bf16_f32 v165,v166,v167
v_cvt_pk_bf16_f32 v181,v182,v183
v_cvt_pk_bf16_f32 v184,v184,v185
v_cvt_pk_bf16_f32 v176,v176,v177
v_cvt_pk_bf16_f32 v185,v186,v187
v_cvt_pk_bf16_f32 v161,v162,v163
s_waitcnt lgkmcnt(4)
buffer_store_dwordx4 v[96:99],v9,s[16:19],s85 offen offset:0 nt
v_cvt_pk_bf16_f32 v177,v178,v179
v_cvt_pk_bf16_f32 v188,v188,v189
v_cvt_pk_bf16_f32 v189,v190,v191
v_cvt_pk_bf16_f32 v172,v172,v173
v_cvt_pk_bf16_f32 v173,v174,v175
v_cvt_pk_bf16_f32 v169,v170,v171
v_cvt_pk_bf16_f32 v192,v192,v193
v_cvt_pk_bf16_f32 v196,v196,v197
v_cvt_pk_bf16_f32 v193,v194,v195
ds_write2st64_b64 v37,v[244:245],v[116:117] offset0:16 offset1:24
v_cvt_pk_bf16_f32 v197,v198,v199
v_cvt_pk_bf16_f32 v200,v200,v201
v_cvt_pk_bf16_f32 v201,v202,v203
s_waitcnt lgkmcnt(1)
buffer_store_dwordx4 v[100:103],v9,s[16:19],s85 offen offset:3072 nt
v_cvt_pk_bf16_f32 v204,v204,v205
v_cvt_pk_bf16_f32 v205,v206,v207
ds_write2st64_b64 v38,v[248:249],v[120:121] offset0:16 offset1:24
buffer_store_dwordx4 v[80:83],v9,s[16:19],s85 offen offset:128 nt
ds_write2st64_b64 v39,v[252:253],v[124:125] offset0:16 offset1:24
ds_read_b128 v[104:107],v10 offset:8192
buffer_store_dwordx4 v[84:87],v9,s[16:19],s85 offen offset:3200 nt
ds_read_b128 v[108:111],v10 offset:11264
ds_read_b128 v[208:211],v10 offset:12288
ds_read_b128 v[224:227],v10 offset:15360
ds_write2st64_b64 v36,v[128:129],v[144:145] offset0:26 offset1:28
s_waitcnt lgkmcnt(4)
buffer_store_dwordx4 v[104:107],v9,s[16:19],s85 offen offset:256 nt
ds_write2st64_b64 v37,v[132:133],v[148:149] offset0:26 offset1:28
s_waitcnt lgkmcnt(1)
buffer_store_dwordx4 v[108:111],v9,s[16:19],s85 offen offset:3328 nt
ds_write2st64_b64 v38,v[136:137],v[152:153] offset0:26 offset1:28
buffer_store_dwordx4 v[208:211],v9,s[16:19],s86 offen offset:0 nt
ds_write2st64_b64 v39,v[140:141],v[156:157] offset0:26 offset1:28
ds_read_b128 v[72:75],v10 offset:13312
buffer_store_dwordx4 v[224:227],v9,s[16:19],s86 offen offset:3072 nt
ds_read_b128 v[76:79],v10 offset:16384
ds_read_b128 v[88:91],v10 offset:14336
ds_read_b128 v[92:95],v10 offset:17408
ds_write2st64_b64 v36,v[160:161],v[176:177] offset0:0 offset1:2
s_waitcnt lgkmcnt(4)
buffer_store_dwordx4 v[72:75],v9,s[16:19],s86 offen offset:128 nt
ds_write2st64_b64 v37,v[164:165],v[180:181] offset0:0 offset1:2
s_waitcnt lgkmcnt(1)
buffer_store_dwordx4 v[76:79],v9,s[16:19],s86 offen offset:3200 nt
ds_write2st64_b64 v38,v[168:169],v[184:185] offset0:0 offset1:2
buffer_store_dwordx4 v[88:91],v9,s[16:19],s86 offen offset:256 nt
ds_write2st64_b64 v39,v[172:173],v[188:189] offset0:0 offset1:2
ds_read_b128 v[212:215],v10 offset:0
buffer_store_dwordx4 v[92:95],v9,s[16:19],s86 offen offset:3328 nt
ds_read_b128 v[228:231],v10 offset:3072
ds_read_b128 v[216:219],v10 offset:1024
ds_read_b128 v[232:235],v10 offset:4096
ds_write_b64 v36,v[192:193] offset:2048
ds_write_b64 v37,v[196:197] offset:2048
s_waitcnt lgkmcnt(5)
buffer_store_dwordx4 v[212:215],v9,s[16:19],s84 offen offset:0 nt
ds_write_b64 v38,v[200:201] offset:2048
s_waitcnt lgkmcnt(2)
buffer_store_dwordx4 v[228:231],v9,s[16:19],s84 offen offset:3072 nt
ds_write_b64 v39,v[204:205] offset:2048
ds_read_b128 v[220:223],v10 offset:2048
buffer_store_dwordx4 v[216:219],v9,s[16:19],s84 offen offset:128 nt
ds_read_b128 v[236:239],v10 offset:5120
buffer_store_dwordx4 v[232:235],v9,s[16:19],s84 offen offset:3200 nt
s_waitcnt lgkmcnt(1)
buffer_store_dwordx4 v[220:223],v9,s[16:19],s84 offen offset:256 nt
s_waitcnt lgkmcnt(0)
buffer_store_dwordx4 v[236:239],v9,s[16:19],s84 offen offset:3328 nt
s_branch L_fin
L_end4:
s_waitcnt lgkmcnt(3)
v_mfma_f32_16x16x32_bf16 v[160:163],a[120:123],v[20:23],v[160:163]
ds_read_b64_tr_b16 a[136:137],v2 offset:24704
v_fma_f32 v102,v102,s36,v16
v_mfma_f32_16x16x32_bf16 v[164:167],a[124:127],v[20:23],v[164:167]
ds_read_b64_tr_b16 a[138:139],v2 offset:30848
v_fma_f32 v98,v98,s36,v16
v_mfma_f32_16x16x32_bf16 v[212:215],a[124:127],v[24:27],v[212:215]
ds_read_b64_tr_b16 a[140:141],v3 offset:24704
v_fma_f32 v76,v76,s36,v13
v_mfma_f32_16x16x32_bf16 v[208:211],a[120:123],v[24:27],v[208:211]
ds_read_b64_tr_b16 a[142:143],v3 offset:30848
v_fma_f32 v91,v91,s36,v15
v_mfma_f32_16x16x32_bf16 v[112:115],a[120:123],v[28:31],v[112:115]
ds_read_b64_tr_b16 a[144:145],v4 offset:24704
v_fma_f32 v95,v95,s36,v15
v_mfma_f32_16x16x32_bf16 v[116:119],a[124:127],v[28:31],v[116:119]
ds_read_b64_tr_b16 a[146:147],v4 offset:30848
v_fma_f32 v85,v85,s36,v14
v_mfma_f32_16x16x32_bf16 a[164:167],a[124:127],v[32:35],a[164:167]
ds_read_b64_tr_b16 a[148:149],v5 offset:24704
v_exp_f32 v76,v76
v_mfma_f32_16x16x32_bf16 a[160:163],a[120:123],v[32:35],a[160:163]
s_waitcnt lgkmcnt(6)
ds_read_b64_tr_b16 a[150:151],v5 offset:30848
v_fma_f32 v103,v103,s36,v16
v_mfma_f32_16x16x32_bf16 a[168:171],a[128:131],v[32:35],a[168:171]
ds_read_b64_tr_b16 a[120:121],v2 offset:24832
v_fma_f32 v79,v79,s36,v13
v_mfma_f32_16x16x32_bf16 a[172:175],a[132:135],v[32:35],a[172:175]
ds_read_b64_tr_b16 a[122:123],v2 offset:30976
v_fma_f32 v96,v96,s36,v16
v_mfma_f32_16x16x32_bf16 v[124:127],a[132:135],v[28:31],v[124:127]
ds_read_b64_tr_b16 a[124:125],v3 offset:24832
v_exp_f32 v102,v102
v_mfma_f32_16x16x32_bf16 v[120:123],a[128:131],v[28:31],v[120:123]
ds_read_b64_tr_b16 a[126:127],v3 offset:30976
v_fma_f32 v89,v89,s36,v15
v_mfma_f32_16x16x32_bf16 v[216:219],a[128:131],v[24:27],v[216:219]
v_fma_f32 v86,v86,s36,v14
v_fma_f32 v100,v100,s36,v16
v_mfma_f32_16x16x32_bf16 v[220:223],a[132:135],v[24:27],v[220:223]
v_exp_f32 v100,v100
v_mfma_f32_16x16x32_bf16 v[172:175],a[132:135],v[20:23],v[172:175]
ds_read_b64_tr_b16 a[132:133],v5 offset:24832
v_fma_f32 v84,v84,s36,v14
v_mfma_f32_16x16x32_bf16 v[168:171],a[128:131],v[20:23],v[168:171]
s_waitcnt lgkmcnt(4)
ds_read_b64_tr_b16 a[128:129],v4 offset:24832
v_exp_f32 v98,v98
v_mfma_f32_16x16x32_bf16 v[176:179],a[136:139],v[20:23],v[176:179]
ds_read_b64_tr_b16 a[130:131],v4 offset:30976
v_exp_f32 v79,v79
v_mfma_f32_16x16x32_bf16 v[180:183],a[140:143],v[20:23],v[180:183]
ds_read_b64_tr_b16 a[134:135],v5 offset:30976
v_exp_f32 v89,v89
v_mfma_f32_16x16x32_bf16 v[228:231],a[140:143],v[24:27],v[228:231]
v_fma_f32 v82,v82,s36,v14
v_exp_f32 v82,v82
v_mfma_f32_16x16x32_bf16 v[224:227],a[136:139],v[24:27],v[224:227]
v_fma_f32 v77,v77,s36,v13
v_exp_f32 v77,v77
v_mfma_f32_16x16x32_bf16 v[128:131],a[136:139],v[28:31],v[128:131]
v_fma_f32 v87,v87,s36,v14
v_exp_f32 v87,v87
v_mfma_f32_16x16x32_bf16 v[132:135],a[140:143],v[28:31],v[132:135]
v_exp_f32 v96,v96
v_mfma_f32_16x16x32_bf16 a[180:183],a[140:143],v[32:35],a[180:183]
v_fma_f32 v78,v78,s36,v13
v_fma_f32 v83,v83,s36,v14
v_mfma_f32_16x16x32_bf16 a[176:179],a[136:139],v[32:35],a[176:179]
v_fma_f32 v92,v92,s36,v15
v_exp_f32 v92,v92
v_mfma_f32_16x16x32_bf16 a[184:187],a[144:147],v[32:35],a[184:187]
v_fma_f32 v90,v90,s36,v15
v_exp_f32 v90,v90
v_mfma_f32_16x16x32_bf16 a[188:191],a[148:151],v[32:35],a[188:191]
v_fma_f32 v101,v101,s36,v16
v_exp_f32 v101,v101
v_mfma_f32_16x16x32_bf16 v[140:143],a[148:151],v[28:31],v[140:143]
v_fma_f32 v99,v99,s36,v16
v_exp_f32 v99,v99
v_mfma_f32_16x16x32_bf16 v[136:139],a[144:147],v[28:31],v[136:139]
v_exp_f32 v84,v84
v_mfma_f32_16x16x32_bf16 v[232:235],a[144:147],v[24:27],v[232:235]
v_fma_f32 v94,v94,s36,v15
v_fma_f32 v88,v88,s36,v15
v_mfma_f32_16x16x32_bf16 v[236:239],a[148:151],v[24:27],v[236:239]
v_fma_f32 v97,v97,s36,v16
v_exp_f32 v97,v97
v_mfma_f32_16x16x32_bf16 v[188:191],a[148:151],v[20:23],v[188:191]
v_fma_f32 v93,v93,s36,v15
v_exp_f32 v93,v93
v_mfma_f32_16x16x32_bf16 v[184:187],a[144:147],v[20:23],v[184:187]
s_waitcnt lgkmcnt(0)
v_exp_f32 v94,v94
v_mfma_f32_16x16x32_bf16 v[192:195],a[120:123],v[20:23],v[192:195]
v_exp_f32 v83,v83
v_mfma_f32_16x16x32_bf16 v[196:199],a[124:127],v[20:23],v[196:199]
v_exp_f32 v103,v103
v_mfma_f32_16x16x32_bf16 v[244:247],a[124:127],v[24:27],v[244:247]
v_exp_f32 v78,v78
v_mfma_f32_16x16x32_bf16 v[240:243],a[120:123],v[24:27],v[240:243]
v_exp_f32 v95,v95
v_mfma_f32_16x16x32_bf16 v[144:147],a[120:123],v[28:31],v[144:147]
v_cvt_pk_bf16_f32 v55,v94,v95
s_waitcnt vmcnt(14)
s_barrier
v_mfma_f32_16x16x32_bf16 v[148:151],a[124:127],v[28:31],v[148:151]
v_exp_f32 v91,v91
v_mfma_f32_16x16x32_bf16 a[196:199],a[124:127],v[32:35],a[196:199]
v_exp_f32 v85,v85
v_mfma_f32_16x16x32_bf16 a[192:195],a[120:123],v[32:35],a[192:195]
v_exp_f32 v88,v88
v_mfma_f32_16x16x32_bf16 a[200:203],a[128:131],v[32:35],a[200:203]
v_cvt_pk_bf16_f32 v52,v88,v89
v_exp_f32 v86,v86
v_mfma_f32_16x16x32_bf16 a[204:207],a[132:135],v[32:35],a[204:207]
v_cvt_pk_bf16_f32 v46,v76,v77
v_cvt_pk_bf16_f32 v49,v82,v83
v_mfma_f32_16x16x32_bf16 v[156:159],a[132:135],v[28:31],v[156:159]
v_cvt_pk_bf16_f32 v57,v98,v99
v_cvt_pk_bf16_f32 v47,v78,v79
v_mfma_f32_16x16x32_bf16 v[152:155],a[128:131],v[28:31],v[152:155]
v_cvt_pk_bf16_f32 v58,v100,v101
v_cvt_pk_bf16_f32 v59,v102,v103
v_mfma_f32_16x16x32_bf16 v[248:251],a[128:131],v[24:27],v[248:251]
v_cvt_pk_bf16_f32 v54,v92,v93
v_cvt_pk_bf16_f32 v50,v84,v85
v_mfma_f32_16x16x32_bf16 v[252:255],a[132:135],v[24:27],v[252:255]
v_cvt_pk_bf16_f32 v53,v90,v91
v_cvt_pk_bf16_f32 v51,v86,v87
v_mfma_f32_16x16x32_bf16 v[204:207],a[132:135],v[20:23],v[204:207]
v_cvt_pk_bf16_f32 v56,v96,v97
v_subrev_u32 v10,18432,v10
v_smfmac_f32_16x16x64_bf16 v[60:63],a[152:155],v[44:51],v18
ds_read_b64_tr_b16 a[138:139],v2 offset:6144
v_smfmac_f32_16x16x64_bf16 v[64:67],a[152:155],v[52:59],v18
ds_read_b64_tr_b16 a[136:137],v2 offset:0
v_mfma_f32_16x16x32_bf16 v[200:203],a[128:131],v[20:23],v[200:203]
ds_read_b64_tr_b16 a[142:143],v3 offset:6144
ds_read_b64_tr_b16 a[140:141],v3 offset:0
ds_read_b64_tr_b16 a[146:147],v4 offset:6144
ds_read_b64_tr_b16 a[144:145],v4 offset:0
ds_read_b64_tr_b16 a[150:151],v5 offset:6144
ds_read_b64_tr_b16 a[148:149],v5 offset:0
s_waitcnt lgkmcnt(6)
v_mfma_f32_16x16x32_bf16 v[160:163],a[136:139],v[44:47],v[160:163]
s_waitcnt vmcnt(6)
ds_read_b64_tr_b16 a[120:121],v2 offset:128
v_mbcnt_lo_u32_b32 v39,-1,0
s_waitcnt lgkmcnt(5)
v_mfma_f32_16x16x32_bf16 v[164:167],a[140:143],v[44:47],v[164:167]
s_add_u32 s84,s42,0
ds_read_b64_tr_b16 a[122:123],v2 offset:6272
v_mbcnt_hi_u32_b32 v39,-1,v39
v_mfma_f32_16x16x32_bf16 v[212:215],a[140:143],v[48:51],v[212:215]
s_add_u32 s85,s42,6144
ds_read_b64_tr_b16 a[126:127],v3 offset:6272
v_and_b32 v38,7,v39
v_mfma_f32_16x16x32_bf16 v[208:211],a[136:139],v[48:51],v[208:211]
s_add_u32 s86,s42,12288
ds_read_b64_tr_b16 a[124:125],v3 offset:128
v_add_f32 v64,v64,v65
v_mfma_f32_16x16x32_bf16 v[112:115],a[136:139],v[52:55],v[112:115]
s_add_u32 s87,s42,18432
ds_read_b64_tr_b16 a[130:131],v4 offset:6272
v_add_f32 v66,v66,v67
v_mfma_f32_16x16x32_bf16 v[116:119],a[140:143],v[52:55],v[116:119]
ds_read_b64_tr_b16 a[128:129],v4 offset:128
ds_read_b64_tr_b16 a[132:133],v5 offset:128
ds_read_b64_tr_b16 a[134:135],v5 offset:6272
v_mfma_f32_16x16x32_bf16 a[164:167],a[140:143],v[56:59],a[164:167]
ds_read_b64_tr_b16 a[142:143],v3 offset:6400
v_add_f32 v62,v62,v63
v_mfma_f32_16x16x32_bf16 a[160:163],a[136:139],v[56:59],a[160:163]
s_waitcnt lgkmcnt(8)
ds_read_b64_tr_b16 a[136:137],v2 offset:256
v_add_f32 v60,v60,v61
v_mfma_f32_16x16x32_bf16 a[168:171],a[144:147],v[56:59],a[168:171]
ds_read_b64_tr_b16 a[138:139],v2 offset:6400
v_max3_f32 v19,v60,v62,v64
v_mfma_f32_16x16x32_bf16 a[172:175],a[148:151],v[56:59],a[172:175]
ds_read_b64_tr_b16 a[140:141],v3 offset:256
v_max_f32 v19,v19,v66
v_mfma_f32_16x16x32_bf16 v[124:127],a[148:151],v[52:55],v[124:127]
v_accvgpr_read_b32 v82,a166
v_rcp_f32 v66,v66
v_mfma_f32_16x16x32_bf16 v[120:123],a[144:147],v[52:55],v[120:123]
v_accvgpr_read_b32 v81,a165
v_accvgpr_read_b32 v80,a164
v_mfma_f32_16x16x32_bf16 v[216:219],a[144:147],v[48:51],v[216:219]
v_accvgpr_read_b32 v72,a160
v_accvgpr_read_b32 v75,a163
v_mfma_f32_16x16x32_bf16 v[220:223],a[148:151],v[48:51],v[220:223]
v_accvgpr_read_b32 v73,a161
v_accvgpr_read_b32 v74,a162
v_mfma_f32_16x16x32_bf16 v[172:175],a[148:151],v[44:47],v[172:175]
ds_read_b64_tr_b16 a[148:149],v5 offset:256
v_accvgpr_read_b32 v83,a167
v_mfma_f32_16x16x32_bf16 v[168:171],a[144:147],v[44:47],v[168:171]
s_waitcnt lgkmcnt(2)
ds_read_b64_tr_b16 a[144:145],v4 offset:256
v_accvgpr_read_b32 v88,a168
v_mfma_f32_16x16x32_bf16 v[176:179],a[120:123],v[44:47],v[176:179]
ds_read_b64_tr_b16 a[146:147],v4 offset:6400
v_accvgpr_read_b32 v91,a171
v_mfma_f32_16x16x32_bf16 v[180:183],a[124:127],v[44:47],v[180:183]
ds_read_b64_tr_b16 a[150:151],v5 offset:6400
v_accvgpr_read_b32 v90,a170
v_mfma_f32_16x16x32_bf16 v[228:231],a[124:127],v[48:51],v[228:231]
v_accvgpr_read_b32 v89,a169
v_accvgpr_read_b32 v98,a174
v_mfma_f32_16x16x32_bf16 v[224:227],a[120:123],v[48:51],v[224:227]
v_accvgpr_read_b32 v97,a173
v_accvgpr_read_b32 v99,a175
v_mfma_f32_16x16x32_bf16 v[128:131],a[120:123],v[52:55],v[128:131]
v_accvgpr_read_b32 v96,a172
v_cmp_ngt_f32 vcc,s37,v19
v_mfma_f32_16x16x32_bf16 v[132:135],a[124:127],v[52:55],v[132:135]
v_lshrrev_b32 v19,5,v39
v_xor_b32 v38,v38,v19
v_mfma_f32_16x16x32_bf16 a[180:183],a[124:127],v[56:59],a[180:183]
s_cmp_lg_u64 vcc,0
v_and_b32 v19,15,v39
v_lshl_add_u32 v19,v19,7,s24
v_mfma_f32_16x16x32_bf16 a[176:179],a[120:123],v[56:59],a[176:179]
s_cselect_b32 s62,s32,0
v_lshl_add_u32 v19,v38,4,v19
v_bfe_u32 v38,v39,4,1
v_mfma_f32_16x16x32_bf16 a[184:187],a[128:131],v[56:59],a[184:187]
s_or_b32 s31,s31,s62
v_lshl_add_u32 v36,v38,3,v19
v_xor_b32 v37,32,v36
v_mfma_f32_16x16x32_bf16 a[188:191],a[132:135],v[56:59],a[188:191]
s_lshl_b32 s32,s32,1
v_bfe_u32 v19,v39,3,1
v_xor_b32 v39,96,v36
v_mfma_f32_16x16x32_bf16 v[140:143],a[132:135],v[52:55],v[140:143]
v_xor_b32 v38,64,v36
v_lshlrev_b32 v19,11,v19
v_accvgpr_read_b32 v84,a180
v_accvgpr_read_b32 v79,a179
v_accvgpr_read_b32 v78,a178
v_pk_mul_f32 v[82:83],v[82:83],v[66:67] op_sel_hi:[1,0]
v_pk_mul_f32 v[72:73],v[72:73],v[66:67] op_sel_hi:[1,0]
v_pk_mul_f32 v[74:75],v[74:75],v[66:67] op_sel_hi:[1,0]
v_pk_mul_f32 v[80:81],v[80:81],v[66:67] op_sel_hi:[1,0]
v_pk_mul_f32 v[78:79],v[78:79],v[66:67] op_sel_hi:[1,0]
v_accvgpr_read_b32 v77,a177
v_accvgpr_read_b32 v76,a176
v_pk_mul_f32 v[76:77],v[76:77],v[66:67] op_sel_hi:[1,0]
v_accvgpr_read_b32 v85,a181
v_pk_mul_f32 v[84:85],v[84:85],v[66:67] op_sel_hi:[1,0]
v_accvgpr_read_b32 v87,a183
v_accvgpr_read_b32 v86,a182
v_pk_mul_f32 v[86:87],v[86:87],v[66:67] op_sel_hi:[1,0]
v_accvgpr_read_b32 v93,a185
v_accvgpr_read_b32 v95,a187
v_mfma_f32_16x16x32_bf16 v[136:139],a[128:131],v[52:55],v[136:139]
v_accvgpr_read_b32 v94,a186
v_accvgpr_read_b32 v92,a184
v_accvgpr_read_b32 v101,a189
v_accvgpr_read_b32 v103,a191
v_accvgpr_read_b32 v102,a190
v_pk_mul_f32 v[88:89],v[88:89],v[66:67] op_sel_hi:[1,0]
v_pk_mul_f32 v[90:91],v[90:91],v[66:67] op_sel_hi:[1,0]
v_pk_mul_f32 v[92:93],v[92:93],v[66:67] op_sel_hi:[1,0]
v_pk_mul_f32 v[94:95],v[94:95],v[66:67] op_sel_hi:[1,0]
v_accvgpr_read_b32 v100,a188
v_cvt_pk_bf16_f32 v76,v76,v77
v_mfma_f32_16x16x32_bf16 v[232:235],a[128:131],v[48:51],v[232:235]
v_cvt_pk_bf16_f32 v77,v78,v79
v_cvt_pk_bf16_f32 v80,v80,v81
v_cvt_pk_bf16_f32 v84,v84,v85
v_cvt_pk_bf16_f32 v85,v86,v87
v_cvt_pk_bf16_f32 v72,v72,v73
v_pk_mul_f32 v[96:97],v[96:97],v[66:67] op_sel_hi:[1,0]
v_pk_mul_f32 v[98:99],v[98:99],v[66:67] op_sel_hi:[1,0]
v_pk_mul_f32 v[102:103],v[102:103],v[66:67] op_sel_hi:[1,0]
v_pk_mul_f32 v[100:101],v[100:101],v[66:67] op_sel_hi:[1,0]
v_cvt_pk_bf16_f32 v73,v74,v75
v_cvt_pk_bf16_f32 v88,v88,v89
v_mfma_f32_16x16x32_bf16 v[236:239],a[132:135],v[48:51],v[236:239]
ds_write2st64_b64 v36,v[72:73],v[76:77] offset0:36 offset1:40
v_mfma_f32_16x16x32_bf16 v[188:191],a[132:135],v[44:47],v[188:191]
v_cvt_pk_bf16_f32 v92,v92,v93
v_cvt_pk_bf16_f32 v100,v100,v101
v_mfma_f32_16x16x32_bf16 v[184:187],a[128:131],v[44:47],v[184:187]
v_cvt_pk_bf16_f32 v93,v94,v95
v_cvt_pk_bf16_f32 v101,v102,v103
v_mfma_f32_16x16x32_bf16 v[192:195],a[136:139],v[44:47],v[192:195]
s_waitcnt lgkmcnt(1)
v_cvt_pk_bf16_f32 v81,v82,v83
v_cvt_pk_bf16_f32 v89,v90,v91
v_mfma_f32_16x16x32_bf16 v[196:199],a[140:143],v[44:47],v[196:199]
ds_write2st64_b64 v37,v[80:81],v[84:85] offset0:36 offset1:40
v_mfma_f32_16x16x32_bf16 v[244:247],a[140:143],v[48:51],v[244:247]
v_cvt_pk_bf16_f32 v96,v96,v97
v_cvt_pk_bf16_f32 v97,v98,v99
v_mfma_f32_16x16x32_bf16 v[240:243],a[136:139],v[48:51],v[240:243]
v_rcp_f32 v64,v64
v_mfma_f32_16x16x32_bf16 v[144:147],a[136:139],v[52:55],v[144:147]
v_rcp_f32 v62,v62
v_mfma_f32_16x16x32_bf16 v[148:151],a[140:143],v[52:55],v[148:151]
ds_write2st64_b64 v38,v[88:89],v[92:93] offset0:36 offset1:40
v_mfma_f32_16x16x32_bf16 a[196:199],a[140:143],v[56:59],a[196:199]
v_rcp_f32 v60,v60
v_mfma_f32_16x16x32_bf16 a[192:195],a[136:139],v[56:59],a[192:195]
v_mfma_f32_16x16x32_bf16 a[200:203],a[144:147],v[56:59],a[200:203]
v_mfma_f32_16x16x32_bf16 a[204:207],a[148:151],v[56:59],a[204:207]
ds_write2st64_b64 v39,v[96:97],v[100:101] offset0:36 offset1:40
v_mfma_f32_16x16x32_bf16 v[156:159],a[148:151],v[52:55],v[156:159]
ds_read_b128 v[104:107],v10 offset:18432
ds_read_b128 v[108:111],v10 offset:19456
v_accvgpr_read_b32 v87,a199
ds_read_b128 v[72:75],v10 offset:20480
v_accvgpr_read_b32 v83,a195
ds_read_b128 v[76:79],v10 offset:21504
v_accvgpr_read_b32 v80,a192
v_accvgpr_read_b32 v82,a194
v_pk_mul_f32 v[82:83],v[82:83],v[66:67] op_sel_hi:[1,0]
v_accvgpr_read_b32 v85,a197
v_accvgpr_read_b32 v86,a198
v_pk_mul_f32 v[86:87],v[86:87],v[66:67] op_sel_hi:[1,0]
v_accvgpr_read_b32 v84,a196
v_pk_mul_f32 v[84:85],v[84:85],v[66:67] op_sel_hi:[1,0]
v_accvgpr_read_b32 v81,a193
v_pk_mul_f32 v[80:81],v[80:81],v[66:67] op_sel_hi:[1,0]
v_cvt_pk_bf16_f32 v84,v84,v85
v_accvgpr_read_b32 v94,a206
v_mfma_f32_16x16x32_bf16 v[152:155],a[144:147],v[52:55],v[152:155]
s_waitcnt lgkmcnt(3)
v_cvt_pk_bf16_f32 v80,v80,v81
buffer_store_dwordx4 v[104:107],v9,s[16:19],s87 offen offset:0 nt
v_accvgpr_read_b32 v91,a203
v_cvt_pk_bf16_f32 v81,v82,v83
v_accvgpr_read_b32 v90,a202
v_pk_mul_f32 v[90:91],v[90:91],v[66:67] op_sel_hi:[1,0]
v_accvgpr_read_b32 v93,a205
v_accvgpr_read_b32 v89,a201
v_accvgpr_read_b32 v88,a200
v_pk_mul_f32 v[88:89],v[88:89],v[66:67] op_sel_hi:[1,0]
v_cvt_pk_bf16_f32 v85,v86,v87
v_accvgpr_read_b32 v92,a204
v_mfma_f32_16x16x32_bf16 v[248:251],a[144:147],v[48:51],v[248:251]
s_waitcnt lgkmcnt(0)
ds_write_b64 v36,v[80:81] offset:18432
buffer_store_dwordx4 v[108:111],v9,s[16:19],s87 offen offset:3072 nt
v_pk_mul_f32 v[92:93],v[92:93],v[66:67] op_sel_hi:[1,0]
v_pk_mul_f32 v[216:217],v[216:217],v[62:63] op_sel_hi:[1,0]
v_pk_mul_f32 v[218:219],v[218:219],v[62:63] op_sel_hi:[1,0]
v_pk_mul_f32 v[240:241],v[240:241],v[62:63] op_sel_hi:[1,0]
v_pk_mul_f32 v[230:231],v[230:231],v[62:63] op_sel_hi:[1,0]
v_pk_mul_f32 v[226:227],v[226:227],v[62:63] op_sel_hi:[1,0]
v_pk_mul_f32 v[242:243],v[242:243],v[62:63] op_sel_hi:[1,0]
v_pk_mul_f32 v[228:229],v[228:229],v[62:63] op_sel_hi:[1,0]
v_pk_mul_f32 v[112:113],v[112:113],v[64:65] op_sel_hi:[1,0]
ds_write_b64 v37,v[84:85] offset:18432
buffer_store_dwordx4 v[72:75],v9,s[16:19],s87 offen offset:128 nt
v_pk_mul_f32 v[118:119],v[118:119],v[64:65] op_sel_hi:[1,0]
v_pk_mul_f32 v[114:115],v[114:115],v[64:65] op_sel_hi:[1,0]
v_pk_mul_f32 v[220:221],v[220:221],v[62:63] op_sel_hi:[1,0]
v_pk_mul_f32 v[222:223],v[222:223],v[62:63] op_sel_hi:[1,0]
v_pk_mul_f32 v[214:215],v[214:215],v[62:63] op_sel_hi:[1,0]
v_pk_mul_f32 v[244:245],v[244:245],v[62:63] op_sel_hi:[1,0]
v_pk_mul_f32 v[238:239],v[238:239],v[62:63] op_sel_hi:[1,0]
v_pk_mul_f32 v[212:213],v[212:213],v[62:63] op_sel_hi:[1,0]
v_pk_mul_f32 v[246:247],v[246:247],v[62:63] op_sel_hi:[1,0]
v_pk_mul_f32 v[208:209],v[208:209],v[62:63] op_sel_hi:[1,0]
v_pk_mul_f32 v[210:211],v[210:211],v[62:63] op_sel_hi:[1,0]
buffer_store_dwordx4 v[76:79],v9,s[16:19],s87 offen offset:3200 nt
v_pk_mul_f32 v[224:225],v[224:225],v[62:63] op_sel_hi:[1,0]
v_pk_mul_f32 v[236:237],v[236:237],v[62:63] op_sel_hi:[1,0]
v_pk_mul_f32 v[232:233],v[232:233],v[62:63] op_sel_hi:[1,0]
v_pk_mul_f32 v[116:117],v[116:117],v[64:65] op_sel_hi:[1,0]
v_pk_mul_f32 v[234:235],v[234:235],v[62:63] op_sel_hi:[1,0]
v_add_u32 v36,v36,v19
v_add_u32 v37,v37,v19
v_cvt_pk_bf16_f32 v92,v92,v93
v_accvgpr_read_b32 v95,a207
v_pk_mul_f32 v[94:95],v[94:95],v[66:67] op_sel_hi:[1,0]
v_cvt_pk_bf16_f32 v88,v88,v89
v_cvt_pk_bf16_f32 v93,v94,v95
v_mfma_f32_16x16x32_bf16 v[252:255],a[148:151],v[48:51],v[252:255]
v_cvt_pk_bf16_f32 v89,v90,v91
v_cvt_pk_bf16_f32 v208,v208,v209
v_mfma_f32_16x16x32_bf16 v[204:207],a[148:151],v[44:47],v[204:207]
ds_write_b64 v38,v[88:89] offset:18432
v_mfma_f32_16x16x32_bf16 v[200:203],a[144:147],v[44:47],v[200:203]
v_add_u32 v38,v38,v19
v_cvt_pk_bf16_f32 v212,v212,v213
ds_write_b64 v39,v[92:93] offset:18432
ds_read_b128 v[96:99],v10 offset:18432
v_pk_mul_f32 v[252:253],v[252:253],v[62:63] op_sel_hi:[1,0]
ds_read_b128 v[100:103],v10 offset:19456
v_pk_mul_f32 v[124:125],v[124:125],v[64:65] op_sel_hi:[1,0]
v_pk_mul_f32 v[254:255],v[254:255],v[62:63] op_sel_hi:[1,0]
v_pk_mul_f32 v[126:127],v[126:127],v[64:65] op_sel_hi:[1,0]
v_pk_mul_f32 v[248:249],v[248:249],v[62:63] op_sel_hi:[1,0]
v_pk_mul_f32 v[120:121],v[120:121],v[64:65] op_sel_hi:[1,0]
v_pk_mul_f32 v[250:251],v[250:251],v[62:63] op_sel_hi:[1,0]
v_pk_mul_f32 v[122:123],v[122:123],v[64:65] op_sel_hi:[1,0]
v_pk_mul_f32 v[148:149],v[148:149],v[64:65] op_sel_hi:[1,0]
v_pk_mul_f32 v[130:131],v[130:131],v[64:65] op_sel_hi:[1,0]
v_pk_mul_f32 v[128:129],v[128:129],v[64:65] op_sel_hi:[1,0]
v_pk_mul_f32 v[136:137],v[136:137],v[64:65] op_sel_hi:[1,0]
v_pk_mul_f32 v[150:151],v[150:151],v[64:65] op_sel_hi:[1,0]
v_pk_mul_f32 v[152:153],v[152:153],v[64:65] op_sel_hi:[1,0]
v_pk_mul_f32 v[140:141],v[140:141],v[64:65] op_sel_hi:[1,0]
v_pk_mul_f32 v[156:157],v[156:157],v[64:65] op_sel_hi:[1,0]
v_pk_mul_f32 v[144:145],v[144:145],v[64:65] op_sel_hi:[1,0]
v_pk_mul_f32 v[146:147],v[146:147],v[64:65] op_sel_hi:[1,0]
v_pk_mul_f32 v[158:159],v[158:159],v[64:65] op_sel_hi:[1,0]
v_pk_mul_f32 v[132:133],v[132:133],v[64:65] op_sel_hi:[1,0]
v_pk_mul_f32 v[138:139],v[138:139],v[64:65] op_sel_hi:[1,0]
v_pk_mul_f32 v[142:143],v[142:143],v[64:65] op_sel_hi:[1,0]
v_pk_mul_f32 v[134:135],v[134:135],v[64:65] op_sel_hi:[1,0]
v_pk_mul_f32 v[154:155],v[154:155],v[64:65] op_sel_hi:[1,0]
s_waitcnt lgkmcnt(1)
buffer_store_dwordx4 v[96:99],v9,s[16:19],s87 offen offset:256 nt
v_pk_mul_f32 v[178:179],v[178:179],v[60:61] op_sel_hi:[1,0]
v_pk_mul_f32 v[162:163],v[162:163],v[60:61] op_sel_hi:[1,0]
v_pk_mul_f32 v[180:181],v[180:181],v[60:61] op_sel_hi:[1,0]
v_pk_mul_f32 v[168:169],v[168:169],v[60:61] op_sel_hi:[1,0]
v_pk_mul_f32 v[176:177],v[176:177],v[60:61] op_sel_hi:[1,0]
v_pk_mul_f32 v[182:183],v[182:183],v[60:61] op_sel_hi:[1,0]
v_pk_mul_f32 v[188:189],v[188:189],v[60:61] op_sel_hi:[1,0]
v_pk_mul_f32 v[160:161],v[160:161],v[60:61] op_sel_hi:[1,0]
v_pk_mul_f32 v[164:165],v[164:165],v[60:61] op_sel_hi:[1,0]
v_pk_mul_f32 v[174:175],v[174:175],v[60:61] op_sel_hi:[1,0]
v_pk_mul_f32 v[184:185],v[184:185],v[60:61] op_sel_hi:[1,0]
s_waitcnt lgkmcnt(0)
buffer_store_dwordx4 v[100:103],v9,s[16:19],s87 offen offset:3328 nt
v_pk_mul_f32 v[166:167],v[166:167],v[60:61] op_sel_hi:[1,0]
v_pk_mul_f32 v[172:173],v[172:173],v[60:61] op_sel_hi:[1,0]
v_pk_mul_f32 v[186:187],v[186:187],v[60:61] op_sel_hi:[1,0]
v_pk_mul_f32 v[170:171],v[170:171],v[60:61] op_sel_hi:[1,0]
v_pk_mul_f32 v[190:191],v[190:191],v[60:61] op_sel_hi:[1,0]
v_pk_mul_f32 v[196:197],v[196:197],v[60:61] op_sel_hi:[1,0]
v_pk_mul_f32 v[194:195],v[194:195],v[60:61] op_sel_hi:[1,0]
v_pk_mul_f32 v[192:193],v[192:193],v[60:61] op_sel_hi:[1,0]
v_pk_mul_f32 v[200:201],v[200:201],v[60:61] op_sel_hi:[1,0]
v_pk_mul_f32 v[198:199],v[198:199],v[60:61] op_sel_hi:[1,0]
v_pk_mul_f32 v[206:207],v[206:207],v[60:61] op_sel_hi:[1,0]
v_pk_mul_f32 v[202:203],v[202:203],v[60:61] op_sel_hi:[1,0]
v_pk_mul_f32 v[204:205],v[204:205],v[60:61] op_sel_hi:[1,0]
v_add_u32 v39,v39,v19
v_cvt_pk_bf16_f32 v224,v224,v225
v_cvt_pk_bf16_f32 v228,v228,v229
v_cvt_pk_bf16_f32 v209,v210,v211
v_cvt_pk_bf16_f32 v232,v232,v233
v_cvt_pk_bf16_f32 v216,v216,v217
v_cvt_pk_bf16_f32 v236,v236,v237
v_cvt_pk_bf16_f32 v225,v226,v227
ds_write2st64_b64 v36,v[208:209],v[224:225] offset0:12 offset1:14
v_cvt_pk_bf16_f32 v229,v230,v231
v_cvt_pk_bf16_f32 v233,v234,v235
v_cvt_pk_bf16_f32 v213,v214,v215
v_cvt_pk_bf16_f32 v217,v218,v219
v_cvt_pk_bf16_f32 v220,v220,v221
v_cvt_pk_bf16_f32 v221,v222,v223
v_cvt_pk_bf16_f32 v237,v238,v239
v_cvt_pk_bf16_f32 v240,v240,v241
v_cvt_pk_bf16_f32 v241,v242,v243
v_cvt_pk_bf16_f32 v112,v112,v113
v_cvt_pk_bf16_f32 v113,v114,v115
ds_write2st64_b64 v37,v[212:213],v[228:229] offset0:12 offset1:14
v_cvt_pk_bf16_f32 v244,v244,v245
v_cvt_pk_bf16_f32 v248,v248,v249
v_cvt_pk_bf16_f32 v116,v116,v117
v_cvt_pk_bf16_f32 v245,v246,v247
v_cvt_pk_bf16_f32 v124,v124,v125
v_cvt_pk_bf16_f32 v249,v250,v251
v_cvt_pk_bf16_f32 v120,v120,v121
v_cvt_pk_bf16_f32 v121,v122,v123
v_cvt_pk_bf16_f32 v117,v118,v119
v_cvt_pk_bf16_f32 v252,v252,v253
v_cvt_pk_bf16_f32 v253,v254,v255
ds_write2st64_b64 v38,v[216:217],v[232:233] offset0:12 offset1:14
v_cvt_pk_bf16_f32 v125,v126,v127
v_cvt_pk_bf16_f32 v128,v128,v129
v_cvt_pk_bf16_f32 v132,v132,v133
v_cvt_pk_bf16_f32 v144,v144,v145
v_cvt_pk_bf16_f32 v129,v130,v131
v_cvt_pk_bf16_f32 v145,v146,v147
v_cvt_pk_bf16_f32 v133,v134,v135
v_cvt_pk_bf16_f32 v152,v152,v153
v_cvt_pk_bf16_f32 v153,v154,v155
v_cvt_pk_bf16_f32 v136,v136,v137
v_cvt_pk_bf16_f32 v148,v148,v149
ds_write2st64_b64 v39,v[220:221],v[236:237] offset0:12 offset1:14
v_cvt_pk_bf16_f32 v137,v138,v139
v_cvt_pk_bf16_f32 v140,v140,v141
v_cvt_pk_bf16_f32 v141,v142,v143
ds_read_b128 v[80:83],v10 offset:6144
v_cvt_pk_bf16_f32 v156,v156,v157
ds_read_b128 v[72:75],v10 offset:9216
v_cvt_pk_bf16_f32 v149,v150,v151
ds_read_b128 v[76:79],v10 offset:7168
v_cvt_pk_bf16_f32 v157,v158,v159
ds_read_b128 v[84:87],v10 offset:10240
v_cvt_pk_bf16_f32 v164,v164,v165
ds_write2st64_b64 v36,v[240:241],v[112:113] offset0:16 offset1:24
v_cvt_pk_bf16_f32 v165,v166,v167
v_cvt_pk_bf16_f32 v180,v180,v181
v_cvt_pk_bf16_f32 v184,v184,v185
v_cvt_pk_bf16_f32 v176,v176,v177
v_cvt_pk_bf16_f32 v177,v178,v179
v_cvt_pk_bf16_f32 v160,v160,v161
v_cvt_pk_bf16_f32 v161,v162,v163
s_waitcnt lgkmcnt(4)
buffer_store_dwordx4 v[80:83],v9,s[16:19],s85 offen offset:0 nt
v_cvt_pk_bf16_f32 v168,v168,v169
v_cvt_pk_bf16_f32 v169,v170,v171
v_cvt_pk_bf16_f32 v181,v182,v183
v_cvt_pk_bf16_f32 v188,v188,v189
v_cvt_pk_bf16_f32 v185,v186,v187
v_cvt_pk_bf16_f32 v172,v172,v173
v_cvt_pk_bf16_f32 v173,v174,v175
v_cvt_pk_bf16_f32 v189,v190,v191
v_cvt_pk_bf16_f32 v192,v192,v193
ds_write2st64_b64 v37,v[244:245],v[116:117] offset0:16 offset1:24
v_cvt_pk_bf16_f32 v196,v196,v197
v_cvt_pk_bf16_f32 v200,v200,v201
v_cvt_pk_bf16_f32 v193,v194,v195
s_waitcnt lgkmcnt(1)
buffer_store_dwordx4 v[72:75],v9,s[16:19],s85 offen offset:3072 nt
v_cvt_pk_bf16_f32 v201,v202,v203
v_cvt_pk_bf16_f32 v204,v204,v205
v_cvt_pk_bf16_f32 v197,v198,v199
v_cvt_pk_bf16_f32 v205,v206,v207
ds_write2st64_b64 v38,v[248:249],v[120:121] offset0:16 offset1:24
buffer_store_dwordx4 v[76:79],v9,s[16:19],s85 offen offset:128 nt
ds_write2st64_b64 v39,v[252:253],v[124:125] offset0:16 offset1:24
ds_read_b128 v[104:107],v10 offset:8192
buffer_store_dwordx4 v[84:87],v9,s[16:19],s85 offen offset:3200 nt
ds_read_b128 v[108:111],v10 offset:11264
ds_read_b128 v[88:91],v10 offset:12288
ds_read_b128 v[92:95],v10 offset:15360
ds_write2st64_b64 v36,v[128:129],v[144:145] offset0:26 offset1:28
s_waitcnt lgkmcnt(4)
buffer_store_dwordx4 v[104:107],v9,s[16:19],s85 offen offset:256 nt
ds_write2st64_b64 v37,v[132:133],v[148:149] offset0:26 offset1:28
s_waitcnt lgkmcnt(1)
buffer_store_dwordx4 v[108:111],v9,s[16:19],s85 offen offset:3328 nt
ds_write2st64_b64 v38,v[136:137],v[152:153] offset0:26 offset1:28
buffer_store_dwordx4 v[88:91],v9,s[16:19],s86 offen offset:0 nt
ds_write2st64_b64 v39,v[140:141],v[156:157] offset0:26 offset1:28
ds_read_b128 v[208:211],v10 offset:13312
buffer_store_dwordx4 v[92:95],v9,s[16:19],s86 offen offset:3072 nt
ds_read_b128 v[224:227],v10 offset:16384
ds_read_b128 v[96:99],v10 offset:14336
ds_read_b128 v[100:103],v10 offset:17408
ds_write2st64_b64 v36,v[160:161],v[176:177] offset0:0 offset1:2
s_waitcnt lgkmcnt(4)
buffer_store_dwordx4 v[208:211],v9,s[16:19],s86 offen offset:128 nt
ds_write2st64_b64 v37,v[164:165],v[180:181] offset0:0 offset1:2
s_waitcnt lgkmcnt(1)
buffer_store_dwordx4 v[224:227],v9,s[16:19],s86 offen offset:3200 nt
ds_write2st64_b64 v38,v[168:169],v[184:185] offset0:0 offset1:2
buffer_store_dwordx4 v[96:99],v9,s[16:19],s86 offen offset:256 nt
ds_write2st64_b64 v39,v[172:173],v[188:189] offset0:0 offset1:2
ds_read_b128 v[212:215],v10 offset:0
buffer_store_dwordx4 v[100:103],v9,s[16:19],s86 offen offset:3328 nt
ds_read_b128 v[228:231],v10 offset:3072
ds_read_b128 v[216:219],v10 offset:1024
ds_read_b128 v[232:235],v10 offset:4096
ds_write_b64 v36,v[192:193] offset:2048
ds_write_b64 v37,v[196:197] offset:2048
s_waitcnt lgkmcnt(5)
buffer_store_dwordx4 v[212:215],v9,s[16:19],s84 offen offset:0 nt
ds_write_b64 v38,v[200:201] offset:2048
s_waitcnt lgkmcnt(2)
buffer_store_dwordx4 v[228:231],v9,s[16:19],s84 offen offset:3072 nt
ds_write_b64 v39,v[204:205] offset:2048
ds_read_b128 v[220:223],v10 offset:2048
buffer_store_dwordx4 v[216:219],v9,s[16:19],s84 offen offset:128 nt
ds_read_b128 v[236:239],v10 offset:5120
buffer_store_dwordx4 v[232:235],v9,s[16:19],s84 offen offset:3200 nt
s_waitcnt lgkmcnt(1)
buffer_store_dwordx4 v[220:223],v9,s[16:19],s84 offen offset:256 nt
s_waitcnt lgkmcnt(0)
buffer_store_dwordx4 v[236:239],v9,s[16:19],s84 offen offset:3328 nt
s_branch L_fin
L_fin:
s_waitcnt vmcnt(0)
L_stamped:
s_cmp_lg_u32 s31,0
s_cbranch_scc1 L_fix
L_done:
L_end:
s_endpgm
L_fix:
s_sub_u32 s62,s24,36864
v_add_u32 v112,s62,v2
v_add_u32 v113,s62,v3
v_add_u32 v114,s62,v4
v_add_u32 v115,s62,v5
v_mbcnt_lo_u32_b32 v19,-1,0
v_mbcnt_hi_u32_b32 v19,-1,v19
v_and_b32 v81,15,v19
v_mul_u32_u24 v81,384,v81
v_lshrrev_b32 v82,4,v19
v_lshl_add_u32 v83,v82,3,v81
v_lshl_add_u32 v81,v82,4,v81
L_fix_pass:
s_ff1_i32_b32 s50,s31
s_bitset0_b32 s31,s50
s_lshl_b32 s62,s50,5
s_add_u32 s62,s62,s34
s_mul_i32 s63,s62,171
s_lshr_b32 s63,s63,9
s_mul_i32 s64,s63,3
s_sub_u32 s62,s62,s64
s_add_u32 s63,s63,s33
s_mul_i32 s30,s63,196608
s_mul_i32 s41,s63,325632
s_lshl_b32 s63,s3,2
s_add_u32 s64,s63,21
s_cmp_eq_u32 s3,0
s_cselect_b32 s64,20,s64
s_cselect_b32 s40,1,0
s_add_u32 s65,s63,37
s_cmp_eq_u32 s62,2
s_cselect_b32 s64,s65,s64
s_cselect_b32 s40,0,s40
s_add_u32 s65,s63,s3
s_cmp_eq_u32 s62,0
s_cselect_b32 s64,s65,s64
s_cselect_b32 s40,1,s40
s_mul_i32 s64,s64,6144
s_add_u32 s41,s41,s64
s_add_u32 s55,s40,4
s_mov_b32 s51,0
L_fix_tile:
buffer_load_dwordx4 a[0:3],v81,s[12:15],s41 offen offset:0
buffer_load_dwordx4 a[4:7],v81,s[12:15],s41 offen offset:64
buffer_load_dwordx4 a[8:11],v81,s[12:15],s41 offen offset:128
buffer_load_dwordx4 a[12:15],v81,s[12:15],s41 offen offset:192
buffer_load_dwordx4 a[16:19],v81,s[12:15],s41 offen offset:256
buffer_load_dwordx4 a[20:23],v81,s[12:15],s41 offen offset:320
v_mov_b32 v80,0xff800000
s_mov_b32 s53,s30
s_mov_b32 s52,0
L_fix_max:
s_mov_b32 s63,s53
s_add_u32 m0,s24,0
s_nop 0
buffer_load_dwordx4 v6,s[4:7],s63 offen offset:0 lds
buffer_load_dwordx4 v7,s[4:7],s63 offen offset:1024 lds
buffer_load_dwordx4 v8,s[4:7],s63 offen offset:2048 lds
s_add_u32 s63,s63,3072
s_add_u32 m0,s24,3072
s_nop 0
buffer_load_dwordx4 v6,s[4:7],s63 offen offset:0 lds
buffer_load_dwordx4 v7,s[4:7],s63 offen offset:1024 lds
buffer_load_dwordx4 v8,s[4:7],s63 offen offset:2048 lds
s_add_u32 s63,s63,3072
s_add_u32 m0,s24,6144
s_nop 0
buffer_load_dwordx4 v6,s[4:7],s63 offen offset:0 lds
buffer_load_dwordx4 v7,s[4:7],s63 offen offset:1024 lds
buffer_load_dwordx4 v8,s[4:7],s63 offen offset:2048 lds
s_add_u32 s63,s63,3072
s_add_u32 m0,s24,9216
s_nop 0
buffer_load_dwordx4 v6,s[4:7],s63 offen offset:0 lds
buffer_load_dwordx4 v7,s[4:7],s63 offen offset:1024 lds
buffer_load_dwordx4 v8,s[4:7],s63 offen offset:2048 lds
s_add_u32 s63,s63,3072
s_waitcnt vmcnt(0)
ds_read_b128 a[160:163],v11 offset:0
ds_read_b128 a[164:167],v12 offset:0
ds_read_b128 a[168:171],v11 offset:128
ds_read_b128 a[172:175],v12 offset:128
ds_read_b128 a[176:179],v11 offset:256
ds_read_b128 a[180:183],v12 offset:256
ds_read_b128 a[184:187],v11 offset:6144
ds_read_b128 a[188:191],v12 offset:6144
ds_read_b128 a[192:195],v11 offset:6272
ds_read_b128 a[196:199],v12 offset:6272
ds_read_b128 a[200:203],v11 offset:6400
ds_read_b128 a[204:207],v12 offset:6400
s_waitcnt lgkmcnt(0)
v_mfma_f32_16x16x32_bf16 v[72:75],a[160:163],a[0:3],0
v_mfma_f32_16x16x32_bf16 v[72:75],a[164:167],a[4:7],v[72:75]
v_mfma_f32_16x16x32_bf16 v[72:75],a[168:171],a[8:11],v[72:75]
v_mfma_f32_16x16x32_bf16 v[72:75],a[172:175],a[12:15],v[72:75]
v_mfma_f32_16x16x32_bf16 v[72:75],a[176:179],a[16:19],v[72:75]
v_mfma_f32_16x16x32_bf16 v[72:75],a[180:183],a[20:23],v[72:75]
v_mfma_f32_16x16x32_bf16 v[76:79],a[184:187],a[0:3],0
v_mfma_f32_16x16x32_bf16 v[76:79],a[188:191],a[4:7],v[76:79]
v_mfma_f32_16x16x32_bf16 v[76:79],a[192:195],a[8:11],v[76:79]
v_mfma_f32_16x16x32_bf16 v[76:79],a[196:199],a[12:15],v[76:79]
v_mfma_f32_16x16x32_bf16 v[76:79],a[200:203],a[16:19],v[76:79]
v_mfma_f32_16x16x32_bf16 v[76:79],a[204:207],a[20:23],v[76:79]
s_nop 7
v_max3_f32 v80,v80,v72,v73
v_max3_f32 v80,v80,v74,v75
v_max3_f32 v80,v80,v76,v77
v_max3_f32 v80,v80,v78,v79
s_add_u32 s53,s53,12288
s_add_u32 s52,s52,1
s_cmp_lt_u32 s52,16
s_cbranch_scc1 L_fix_max
v_mov_b32 v19,v80
s_nop 1
v_permlane32_swap_b32 v19,v80
v_max_f32 v80,v80,v19
v_mov_b32 v19,v80
s_nop 1
v_permlane16_swap_b32 v19,v80
v_max_f32 v80,v80,v19
v_mul_f32_e64 v13,-s36,v80
v_mov_b32 v160,0
v_mov_b32 v161,0
v_mov_b32 v162,0
v_mov_b32 v163,0
v_mov_b32 v164,0
v_mov_b32 v165,0
v_mov_b32 v166,0
v_mov_b32 v167,0
v_mov_b32 v168,0
v_mov_b32 v169,0
v_mov_b32 v170,0
v_mov_b32 v171,0
v_mov_b32 v172,0
v_mov_b32 v173,0
v_mov_b32 v174,0
v_mov_b32 v175,0
v_mov_b32 v176,0
v_mov_b32 v177,0
v_mov_b32 v178,0
v_mov_b32 v179,0
v_mov_b32 v180,0
v_mov_b32 v181,0
v_mov_b32 v182,0
v_mov_b32 v183,0
v_mov_b32 v184,0
v_mov_b32 v185,0
v_mov_b32 v186,0
v_mov_b32 v187,0
v_mov_b32 v188,0
v_mov_b32 v189,0
v_mov_b32 v190,0
v_mov_b32 v191,0
v_mov_b32 v192,0
v_mov_b32 v193,0
v_mov_b32 v194,0
v_mov_b32 v195,0
v_mov_b32 v196,0
v_mov_b32 v197,0
v_mov_b32 v198,0
v_mov_b32 v199,0
v_mov_b32 v200,0
v_mov_b32 v201,0
v_mov_b32 v202,0
v_mov_b32 v203,0
v_mov_b32 v204,0
v_mov_b32 v205,0
v_mov_b32 v206,0
v_mov_b32 v207,0
v_mov_b32 v60,0
v_mov_b32 v24,0
v_mov_b32 v61,0
v_mov_b32 v25,0
v_mov_b32 v62,0
v_mov_b32 v26,0
v_mov_b32 v63,0
v_mov_b32 v27,0
s_mov_b32 s53,s30
s_mov_b32 s52,0
L_fix_acc:
s_mov_b32 s63,s53
s_add_u32 m0,s24,0
s_nop 0
buffer_load_dwordx4 v6,s[4:7],s63 offen offset:0 lds
buffer_load_dwordx4 v7,s[4:7],s63 offen offset:1024 lds
buffer_load_dwordx4 v8,s[4:7],s63 offen offset:2048 lds
s_add_u32 s63,s63,3072
s_add_u32 m0,s24,3072
s_nop 0
buffer_load_dwordx4 v6,s[4:7],s63 offen offset:0 lds
buffer_load_dwordx4 v7,s[4:7],s63 offen offset:1024 lds
buffer_load_dwordx4 v8,s[4:7],s63 offen offset:2048 lds
s_add_u32 s63,s63,3072
s_add_u32 m0,s24,6144
s_nop 0
buffer_load_dwordx4 v6,s[4:7],s63 offen offset:0 lds
buffer_load_dwordx4 v7,s[4:7],s63 offen offset:1024 lds
buffer_load_dwordx4 v8,s[4:7],s63 offen offset:2048 lds
s_add_u32 s63,s63,3072
s_add_u32 m0,s24,9216
s_nop 0
buffer_load_dwordx4 v6,s[4:7],s63 offen offset:0 lds
buffer_load_dwordx4 v7,s[4:7],s63 offen offset:1024 lds
buffer_load_dwordx4 v8,s[4:7],s63 offen offset:2048 lds
s_add_u32 s63,s63,3072
s_waitcnt vmcnt(0)
ds_read_b128 a[160:163],v11 offset:0
ds_read_b128 a[164:167],v12 offset:0
ds_read_b128 a[168:171],v11 offset:128
ds_read_b128 a[172:175],v12 offset:128
ds_read_b128 a[176:179],v11 offset:256
ds_read_b128 a[180:183],v12 offset:256
ds_read_b128 a[184:187],v11 offset:6144
ds_read_b128 a[188:191],v12 offset:6144
ds_read_b128 a[192:195],v11 offset:6272
ds_read_b128 a[196:199],v12 offset:6272
ds_read_b128 a[200:203],v11 offset:6400
ds_read_b128 a[204:207],v12 offset:6400
s_waitcnt lgkmcnt(0)
v_mfma_f32_16x16x32_bf16 v[72:75],a[160:163],a[0:3],0
v_mfma_f32_16x16x32_bf16 v[72:75],a[164:167],a[4:7],v[72:75]
v_mfma_f32_16x16x32_bf16 v[72:75],a[168:171],a[8:11],v[72:75]
v_mfma_f32_16x16x32_bf16 v[72:75],a[172:175],a[12:15],v[72:75]
v_mfma_f32_16x16x32_bf16 v[72:75],a[176:179],a[16:19],v[72:75]
v_mfma_f32_16x16x32_bf16 v[72:75],a[180:183],a[20:23],v[72:75]
v_mfma_f32_16x16x32_bf16 v[76:79],a[184:187],a[0:3],0
v_mfma_f32_16x16x32_bf16 v[76:79],a[188:191],a[4:7],v[76:79]
v_mfma_f32_16x16x32_bf16 v[76:79],a[192:195],a[8:11],v[76:79]
v_mfma_f32_16x16x32_bf16 v[76:79],a[196:199],a[12:15],v[76:79]
v_mfma_f32_16x16x32_bf16 v[76:79],a[200:203],a[16:19],v[76:79]
v_mfma_f32_16x16x32_bf16 v[76:79],a[204:207],a[20:23],v[76:79]
s_nop 7
v_fma_f32 v72,v72,s36,v13
v_fma_f32 v73,v73,s36,v13
v_exp_f32 v72,v72
v_exp_f32 v73,v73
s_nop 0
v_cvt_pk_bf16_f32 v20,v72,v73
v_fma_f32 v74,v74,s36,v13
v_fma_f32 v75,v75,s36,v13
v_exp_f32 v74,v74
v_exp_f32 v75,v75
s_nop 0
v_cvt_pk_bf16_f32 v21,v74,v75
v_fma_f32 v76,v76,s36,v13
v_fma_f32 v77,v77,s36,v13
v_exp_f32 v76,v76
v_exp_f32 v77,v77
s_nop 0
v_cvt_pk_bf16_f32 v22,v76,v77
v_fma_f32 v78,v78,s36,v13
v_fma_f32 v79,v79,s36,v13
v_exp_f32 v78,v78
v_exp_f32 v79,v79
s_nop 0
v_cvt_pk_bf16_f32 v23,v78,v79
s_nop 1
v_smfmac_f32_16x16x64_bf16 v[60:63],a[152:155],v[20:27],v18
s_mov_b32 s63,s53
s_add_u32 m0,s24,0
s_nop 0
buffer_load_dwordx4 v6,s[8:11],s63 offen offset:0 lds
buffer_load_dwordx4 v7,s[8:11],s63 offen offset:1024 lds
buffer_load_dwordx4 v8,s[8:11],s63 offen offset:2048 lds
s_add_u32 s63,s63,3072
s_add_u32 m0,s24,3072
s_nop 0
buffer_load_dwordx4 v6,s[8:11],s63 offen offset:0 lds
buffer_load_dwordx4 v7,s[8:11],s63 offen offset:1024 lds
buffer_load_dwordx4 v8,s[8:11],s63 offen offset:2048 lds
s_add_u32 s63,s63,3072
s_add_u32 m0,s24,6144
s_nop 0
buffer_load_dwordx4 v6,s[8:11],s63 offen offset:0 lds
buffer_load_dwordx4 v7,s[8:11],s63 offen offset:1024 lds
buffer_load_dwordx4 v8,s[8:11],s63 offen offset:2048 lds
s_add_u32 s63,s63,3072
s_add_u32 m0,s24,9216
s_nop 0
buffer_load_dwordx4 v6,s[8:11],s63 offen offset:0 lds
buffer_load_dwordx4 v7,s[8:11],s63 offen offset:1024 lds
buffer_load_dwordx4 v8,s[8:11],s63 offen offset:2048 lds
s_add_u32 s63,s63,3072
s_waitcnt vmcnt(0)
ds_read_b64_tr_b16 a[160:161],v112 offset:0
ds_read_b64_tr_b16 a[162:163],v112 offset:6144
ds_read_b64_tr_b16 a[164:165],v113 offset:0
ds_read_b64_tr_b16 a[166:167],v113 offset:6144
ds_read_b64_tr_b16 a[168:169],v114 offset:0
ds_read_b64_tr_b16 a[170:171],v114 offset:6144
ds_read_b64_tr_b16 a[172:173],v115 offset:0
ds_read_b64_tr_b16 a[174:175],v115 offset:6144
ds_read_b64_tr_b16 a[176:177],v112 offset:128
ds_read_b64_tr_b16 a[178:179],v112 offset:6272
ds_read_b64_tr_b16 a[180:181],v113 offset:128
ds_read_b64_tr_b16 a[182:183],v113 offset:6272
ds_read_b64_tr_b16 a[184:185],v114 offset:128
ds_read_b64_tr_b16 a[186:187],v114 offset:6272
ds_read_b64_tr_b16 a[188:189],v115 offset:128
ds_read_b64_tr_b16 a[190:191],v115 offset:6272
ds_read_b64_tr_b16 a[192:193],v112 offset:256
ds_read_b64_tr_b16 a[194:195],v112 offset:6400
ds_read_b64_tr_b16 a[196:197],v113 offset:256
ds_read_b64_tr_b16 a[198:199],v113 offset:6400
ds_read_b64_tr_b16 a[200:201],v114 offset:256
ds_read_b64_tr_b16 a[202:203],v114 offset:6400
ds_read_b64_tr_b16 a[204:205],v115 offset:256
ds_read_b64_tr_b16 a[206:207],v115 offset:6400
s_waitcnt lgkmcnt(0)
v_mfma_f32_16x16x32_bf16 v[160:163],a[160:163],v[20:23],v[160:163]
v_mfma_f32_16x16x32_bf16 v[164:167],a[164:167],v[20:23],v[164:167]
v_mfma_f32_16x16x32_bf16 v[168:171],a[168:171],v[20:23],v[168:171]
v_mfma_f32_16x16x32_bf16 v[172:175],a[172:175],v[20:23],v[172:175]
v_mfma_f32_16x16x32_bf16 v[176:179],a[176:179],v[20:23],v[176:179]
v_mfma_f32_16x16x32_bf16 v[180:183],a[180:183],v[20:23],v[180:183]
v_mfma_f32_16x16x32_bf16 v[184:187],a[184:187],v[20:23],v[184:187]
v_mfma_f32_16x16x32_bf16 v[188:191],a[188:191],v[20:23],v[188:191]
v_mfma_f32_16x16x32_bf16 v[192:195],a[192:195],v[20:23],v[192:195]
v_mfma_f32_16x16x32_bf16 v[196:199],a[196:199],v[20:23],v[196:199]
v_mfma_f32_16x16x32_bf16 v[200:203],a[200:203],v[20:23],v[200:203]
v_mfma_f32_16x16x32_bf16 v[204:207],a[204:207],v[20:23],v[204:207]
s_add_u32 s53,s53,12288
s_add_u32 s52,s52,1
s_cmp_lt_u32 s52,16
s_cbranch_scc1 L_fix_acc
s_nop 7
v_add_f32 v19,v60,v61
v_rcp_f32 v19,v19
s_nop 0
v_mul_f32 v160,v160,v19
v_mul_f32 v161,v161,v19
v_mul_f32 v162,v162,v19
v_mul_f32 v163,v163,v19
v_cvt_pk_bf16_f32 v160,v160,v161
v_cvt_pk_bf16_f32 v161,v162,v163
buffer_store_dwordx2 v[160:161],v83,s[16:19],s41 offen offset:0
v_mul_f32 v164,v164,v19
v_mul_f32 v165,v165,v19
v_mul_f32 v166,v166,v19
v_mul_f32 v167,v167,v19
v_cvt_pk_bf16_f32 v164,v164,v165
v_cvt_pk_bf16_f32 v165,v166,v167
buffer_store_dwordx2 v[164:165],v83,s[16:19],s41 offen offset:32
v_mul_f32 v168,v168,v19
v_mul_f32 v169,v169,v19
v_mul_f32 v170,v170,v19
v_mul_f32 v171,v171,v19
v_cvt_pk_bf16_f32 v168,v168,v169
v_cvt_pk_bf16_f32 v169,v170,v171
buffer_store_dwordx2 v[168:169],v83,s[16:19],s41 offen offset:64
v_mul_f32 v172,v172,v19
v_mul_f32 v173,v173,v19
v_mul_f32 v174,v174,v19
v_mul_f32 v175,v175,v19
v_cvt_pk_bf16_f32 v172,v172,v173
v_cvt_pk_bf16_f32 v173,v174,v175
buffer_store_dwordx2 v[172:173],v83,s[16:19],s41 offen offset:96
v_mul_f32 v176,v176,v19
v_mul_f32 v177,v177,v19
v_mul_f32 v178,v178,v19
v_mul_f32 v179,v179,v19
v_cvt_pk_bf16_f32 v176,v176,v177
v_cvt_pk_bf16_f32 v177,v178,v179
buffer_store_dwordx2 v[176:177],v83,s[16:19],s41 offen offset:128
v_mul_f32 v180,v180,v19
v_mul_f32 v181,v181,v19
v_mul_f32 v182,v182,v19
v_mul_f32 v183,v183,v19
v_cvt_pk_bf16_f32 v180,v180,v181
v_cvt_pk_bf16_f32 v181,v182,v183
buffer_store_dwordx2 v[180:181],v83,s[16:19],s41 offen offset:160
v_mul_f32 v184,v184,v19
v_mul_f32 v185,v185,v19
v_mul_f32 v186,v186,v19
v_mul_f32 v187,v187,v19
v_cvt_pk_bf16_f32 v184,v184,v185
v_cvt_pk_bf16_f32 v185,v186,v187
buffer_store_dwordx2 v[184:185],v83,s[16:19],s41 offen offset:192
v_mul_f32 v188,v188,v19
v_mul_f32 v189,v189,v19
v_mul_f32 v190,v190,v19
v_mul_f32 v191,v191,v19
v_cvt_pk_bf16_f32 v188,v188,v189
v_cvt_pk_bf16_f32 v189,v190,v191
buffer_store_dwordx2 v[188:189],v83,s[16:19],s41 offen offset:224
v_mul_f32 v192,v192,v19
v_mul_f32 v193,v193,v19
v_mul_f32 v194,v194,v19
v_mul_f32 v195,v195,v19
v_cvt_pk_bf16_f32 v192,v192,v193
v_cvt_pk_bf16_f32 v193,v194,v195
buffer_store_dwordx2 v[192:193],v83,s[16:19],s41 offen offset:256
v_mul_f32 v196,v196,v19
v_mul_f32 v197,v197,v19
v_mul_f32 v198,v198,v19
v_mul_f32 v199,v199,v19
v_cvt_pk_bf16_f32 v196,v196,v197
v_cvt_pk_bf16_f32 v197,v198,v199
buffer_store_dwordx2 v[196:197],v83,s[16:19],s41 offen offset:288
v_mul_f32 v200,v200,v19
v_mul_f32 v201,v201,v19
v_mul_f32 v202,v202,v19
v_mul_f32 v203,v203,v19
v_cvt_pk_bf16_f32 v200,v200,v201
v_cvt_pk_bf16_f32 v201,v202,v203
buffer_store_dwordx2 v[200:201],v83,s[16:19],s41 offen offset:320
v_mul_f32 v204,v204,v19
v_mul_f32 v205,v205,v19
v_mul_f32 v206,v206,v19
v_mul_f32 v207,v207,v19
v_cvt_pk_bf16_f32 v204,v204,v205
v_cvt_pk_bf16_f32 v205,v206,v207
buffer_store_dwordx2 v[204:205],v83,s[16:19],s41 offen offset:352
s_waitcnt vmcnt(0)
s_add_u32 s41,s41,6144
s_add_u32 s51,s51,1
s_cmp_lt_u32 s51,s55
s_cbranch_scc1 L_fix_tile
s_cmp_lg_u32 s31,0
s_cbranch_scc1 L_fix_pass
s_branch L_done
L_codeend:
.section .rodata,"a"
.p2align 6
.amdhsa_kernel standalone__gqa_softmax__near_ridge_kernel
  .amdhsa_next_free_vgpr 512
  .amdhsa_next_free_sgpr 102
  .amdhsa_accum_offset 256
  .amdhsa_group_segment_fixed_size 0
  .amdhsa_kernarg_size 48
  .amdhsa_user_sgpr_count 2
  .amdhsa_user_sgpr_kernarg_segment_ptr 1
  .amdhsa_system_sgpr_workgroup_id_x 1
.end_amdhsa_kernel
```

```asm
; @launch grid=(256,1,1) block=(256,1,1) lds=163840
.amdgcn_target "amdgcn-amd-amdhsa--gfx950"
.text
.globl standalone__gqa_softmax__near_ridge_kernel
.p2align 8
.type standalone__gqa_softmax__near_ridge_kernel,@function
standalone__gqa_softmax__near_ridge_kernel:
s_cmp_ge_u32 s2,256
s_cbranch_scc1 L_end
s_load_dwordx4 s[84:87],s[0:1],0
s_load_dwordx4 s[88:91],s[0:1],16
v_lshrrev_b32 v80,6,v0
v_and_b32 v19,63,v0
v_readfirstlane_b32 s3,v80
s_lshr_b32 s34,s2,3
v_lshrrev_b32 v80,3,v19
v_and_b32 v82,7,v19
v_add_u32 v81,0,v80
v_mul_u32_u24 v81,43,v81
v_lshrrev_b32 v81,7,v81
v_and_b32 v81,6,v81
v_xor_b32 v81,v81,v82
v_lshlrev_b32 v81,4,v81
v_lshl_add_u32 v6,v80,7,v81
v_add_u32 v81,8,v80
v_mul_u32_u24 v81,43,v81
v_lshrrev_b32 v81,7,v81
v_and_b32 v81,6,v81
v_xor_b32 v81,v81,v82
v_lshlrev_b32 v81,4,v81
v_lshl_add_u32 v7,v80,7,v81
v_add_u32 v81,16,v80
v_mul_u32_u24 v81,43,v81
v_lshrrev_b32 v81,7,v81
v_and_b32 v81,6,v81
v_xor_b32 v81,v81,v82
v_lshlrev_b32 v81,4,v81
v_lshl_add_u32 v8,v80,7,v81
s_mov_b32 s37,0x21800000
s_mov_b32 s36,0x3dd53b95
s_mov_b32 s31,0
s_mov_b32 s32,1
s_and_b32 s62,s2,7
s_lshl_b32 s33,s62,6
s_mul_i32 s22,s3,3072
s_add_u32 s23,s22,36864
s_mul_i32 s24,s3,22528
s_add_u32 s24,s24,73728
s_mov_b32 s69,0
s_lshl_b32 s62,s69,5
s_add_u32 s62,s62,s34
s_mul_i32 s63,s62,171
s_lshr_b32 s63,s63,9
s_mul_i32 s64,s63,3
s_sub_u32 s62,s62,s64
s_add_u32 s63,s63,s33
s_mul_i32 s30,s63,196608
s_mul_i32 s41,s63,325632
s_lshl_b32 s63,s3,2
s_add_u32 s64,s63,21
s_cmp_eq_u32 s3,0
s_cselect_b32 s64,20,s64
s_cselect_b32 s40,1,0
s_add_u32 s65,s63,37
s_cmp_eq_u32 s62,2
s_cselect_b32 s64,s65,s64
s_cselect_b32 s40,0,s40
s_add_u32 s65,s63,s3
s_cmp_eq_u32 s62,0
s_cselect_b32 s64,s65,s64
s_cselect_b32 s40,1,s40
s_mul_i32 s64,s64,6144
s_add_u32 s41,s41,s64
s_add_u32 s20,s30,s22
s_mov_b32 s21,s20
s_waitcnt lgkmcnt(0)
s_mov_b32 s4,s86
s_and_b32 s5,s87,0xffff
s_mov_b32 s6,100663296
s_mov_b32 s7,0x20000
s_mov_b32 s12,s84
s_and_b32 s13,s85,0xffff
s_mov_b32 s14,166723584
s_mov_b32 s15,0x20000
s_mov_b32 s8,s88
s_and_b32 s9,s89,0xffff
s_mov_b32 s10,100663296
s_mov_b32 s11,0x20000
s_mov_b32 s16,s90
s_and_b32 s17,s91,0xffff
s_mov_b32 s18,166723584
s_mov_b32 s19,0x20000
s_mov_b32 s28,s41
s_add_u32 m0,s22,0
s_nop 0
buffer_load_dwordx4 v6,s[4:7],s20 offen offset:0 lds
buffer_load_dwordx4 v7,s[4:7],s20 offen offset:1024 lds
buffer_load_dwordx4 v8,s[4:7],s20 offen offset:2048 lds
s_add_u32 s20,s20,12288
s_add_u32 m0,s24,0
s_nop 0
buffer_load_dwordx4 v6,s[12:15],s28 offen offset:0 nt lds
buffer_load_dwordx4 v7,s[12:15],s28 offen offset:1024 nt lds
buffer_load_dwordx4 v8,s[12:15],s28 offen offset:2048 nt lds
s_add_u32 s28,s28,3072
s_add_u32 m0,s24,3072
s_nop 0
buffer_load_dwordx4 v6,s[12:15],s28 offen offset:0 nt lds
buffer_load_dwordx4 v7,s[12:15],s28 offen offset:1024 nt lds
buffer_load_dwordx4 v8,s[12:15],s28 offen offset:2048 nt lds
s_add_u32 s28,s28,3072
s_add_u32 m0,s22,12288
s_nop 0
buffer_load_dwordx4 v6,s[4:7],s20 offen offset:0 lds
buffer_load_dwordx4 v7,s[4:7],s20 offen offset:1024 lds
buffer_load_dwordx4 v8,s[4:7],s20 offen offset:2048 lds
s_add_u32 s20,s20,12288
s_add_u32 m0,s22,24576
s_nop 0
buffer_load_dwordx4 v6,s[4:7],s20 offen offset:0 lds
buffer_load_dwordx4 v7,s[4:7],s20 offen offset:1024 lds
buffer_load_dwordx4 v8,s[4:7],s20 offen offset:2048 lds
s_add_u32 s20,s20,12288
s_add_u32 m0,s23,0
s_nop 0
buffer_load_dwordx4 v6,s[8:11],s21 offen offset:0 lds
buffer_load_dwordx4 v7,s[8:11],s21 offen offset:1024 lds
buffer_load_dwordx4 v8,s[8:11],s21 offen offset:2048 lds
s_add_u32 s21,s21,12288
s_add_u32 m0,s24,6144
s_nop 0
buffer_load_dwordx4 v6,s[12:15],s28 offen offset:0 nt lds
buffer_load_dwordx4 v7,s[12:15],s28 offen offset:1024 nt lds
buffer_load_dwordx4 v8,s[12:15],s28 offen offset:2048 nt lds
s_add_u32 s28,s28,3072
s_add_u32 m0,s24,9216
s_nop 0
buffer_load_dwordx4 v6,s[12:15],s28 offen offset:0 nt lds
buffer_load_dwordx4 v7,s[12:15],s28 offen offset:1024 nt lds
buffer_load_dwordx4 v8,s[12:15],s28 offen offset:2048 nt lds
s_add_u32 s28,s28,3072
s_getpc_b64 s[46:47]
s_mul_i32 s62,s34,4096
s_mul_i32 s48,s3,1024
s_add_u32 s48,s48,s62
v_min_u32 v85,31,v19
v_lshlrev_b32 v85,7,v85
v_add_u32 v85,s62,v85
v_min_u32 v85,L_codeend-L_first-4,v85
s_cmp_lg_u32 s3,0
s_cbranch_scc1 L_nopre
global_load_dword v112,v85,s[46:47]
L_nopre:
v_and_b32 v80,15,v19
v_lshrrev_b32 v81,4,v19
v_mul_u32_u24 v0,384,v80
v_and_b32 v83,6,v80
v_xor_b32 v83,v83,v81
v_lshl_add_u32 v0,v83,4,v0
v_xor_b32 v1,64,v0
v_add_u32 v11,s24,v0
v_add_u32 v12,s24,v1
v_lshrrev_b32 v80,2,v19
v_mul_u32_u24 v2,384,v80
v_and_b32 v80,6,v80
v_bfe_u32 v83,v19,1,1
v_xor_b32 v80,v80,v83
v_lshl_add_u32 v2,v80,4,v2
v_and_b32 v83,1,v19
v_lshl_add_u32 v2,v83,3,v2
v_add_u32 v2,36864,v2
v_xor_b32 v3,32,v2
v_xor_b32 v4,64,v2
v_xor_b32 v5,96,v2
v_lshrrev_b32 v80,3,v19
v_and_b32 v81,7,v19
v_xor_b32 v83,v81,v80
v_lshl_add_u32 v10,v80,7,s24
v_lshl_add_u32 v10,v83,4,v10
v_mul_u32_u24 v9,384,v80
v_lshl_add_u32 v9,v81,4,v9
v_lshrrev_b32 v80,4,v19
v_xor_b32 v80,v80,v19
v_bfe_u32 v80,v80,1,1
v_subrev_u32 v80,1,v80
v_and_b32 v80,0x3f803f80,v80
v_accvgpr_write_b32 a152,v80
v_accvgpr_write_b32 a153,v80
v_accvgpr_write_b32 a154,v80
v_accvgpr_write_b32 a155,v80
v_and_b32 v80,1,v19
v_mul_u32_u24 v80,0xaaaa,v80
v_add_u32 v18,0x4444,v80
L_first:
s_waitcnt vmcnt(12)
s_barrier
s_cmp_eq_u32 s40,0
s_cbranch_scc1 L_start4
L_start5:
s_add_u32 m0,s24,12288
s_waitcnt vmcnt(15)
ds_read_b128 a[4:7],v12 offset:0
buffer_load_dwordx4 v6,s[12:15],s28 offen offset:0 nt lds
ds_read_b128 a[12:15],v12 offset:128
buffer_load_dwordx4 v7,s[12:15],s28 offen offset:1024 nt lds
ds_read_b128 a[0:3],v11 offset:0
buffer_load_dwordx4 v8,s[12:15],s28 offen offset:2048 nt lds
s_add_u32 s28,s28,3072
s_add_u32 m0,s24,15360
ds_read_b128 a[8:11],v11 offset:128
buffer_load_dwordx4 v6,s[12:15],s28 offen offset:0 nt lds
ds_read_b128 a[16:19],v11 offset:256
buffer_load_dwordx4 v7,s[12:15],s28 offen offset:1024 nt lds
ds_read_b128 a[20:23],v12 offset:256
buffer_load_dwordx4 v8,s[12:15],s28 offen offset:2048 nt lds
s_add_u32 s28,s28,3072
s_add_u32 m0,s24,0
ds_read_b128 a[124:127],v1 offset:0
v_mov_b32 v62,0
ds_read_b128 a[120:123],v0 offset:0
v_mov_b32 v63,0
ds_read_b128 a[132:135],v1 offset:128
v_mov_b32 v66,0
ds_read_b128 a[128:131],v0 offset:128
v_mov_b32 v64,0
ds_read_b128 a[136:139],v0 offset:256
v_mov_b32 v61,0
ds_read_b128 a[140:143],v1 offset:256
v_mov_b32 v70,0
ds_read_b128 a[144:147],v0 offset:6144
v_mov_b32 v65,0
ds_read_b128 a[148:151],v1 offset:6144
v_mov_b32 v67,0
v_mov_b32 v68,0
v_mov_b32 v60,0
v_mov_b32 v71,0
v_mov_b32 v69,0
s_waitcnt lgkmcnt(6)
v_mfma_f32_16x16x32_bf16 v[72:75],a[120:123],a[0:3],0
ds_read_b128 a[120:123],v0 offset:6272
v_mfma_f32_16x16x32_bf16 v[72:75],a[124:127],a[4:7],v[72:75]
s_waitcnt lgkmcnt(5)
ds_read_b128 a[124:127],v1 offset:6272
v_mfma_f32_16x16x32_bf16 v[72:75],a[128:131],a[8:11],v[72:75]
ds_read_b128 a[128:131],v0 offset:6400
v_mfma_f32_16x16x32_bf16 v[72:75],a[132:135],a[12:15],v[72:75]
s_waitcnt lgkmcnt(5)
ds_read_b128 a[132:135],v1 offset:6400
v_mfma_f32_16x16x32_bf16 v[72:75],a[136:139],a[16:19],v[72:75]
ds_read_b128 a[136:139],v0 offset:12288
v_mfma_f32_16x16x32_bf16 v[72:75],a[140:143],a[20:23],v[72:75]
s_waitcnt lgkmcnt(5)
ds_read_b128 a[140:143],v1 offset:12288
v_mfma_f32_16x16x32_bf16 v[76:79],a[144:147],a[0:3],0
ds_read_b128 a[144:147],v0 offset:12416
v_mfma_f32_16x16x32_bf16 v[76:79],a[148:151],a[4:7],v[76:79]
s_waitcnt lgkmcnt(6)
ds_read_b128 a[148:151],v1 offset:12416
v_mfma_f32_16x16x32_bf16 v[76:79],a[120:123],a[8:11],v[76:79]
s_waitcnt lgkmcnt(6)
ds_read_b128 a[120:123],v0 offset:12544
v_mfma_f32_16x16x32_bf16 v[76:79],a[124:127],a[12:15],v[76:79]
s_waitcnt lgkmcnt(6)
ds_read_b128 a[124:127],v1 offset:12544
v_max3_f32 v44,v72,v73,v74
v_mfma_f32_16x16x32_bf16 v[76:79],a[128:131],a[16:19],v[76:79]
s_waitcnt lgkmcnt(6)
ds_read_b128 a[128:131],v0 offset:18432
v_mfma_f32_16x16x32_bf16 v[76:79],a[132:135],a[20:23],v[76:79]
ds_read_b128 a[132:135],v1 offset:18432
s_nop 6
v_max3_f32 v44,v44,v75,v76
v_max3_f32 v44,v44,v77,v78
v_max_f32 v44,v44,v79
v_mov_b32 v45,v44
s_nop 1
v_permlane32_swap_b32 v45,v44
v_max_f32 v44,v44,v45
v_mov_b32 v45,v44
s_nop 1
v_permlane16_swap_b32 v45,v44
v_max_f32 v44,v44,v45
v_mul_f32_e64 v13,-s36,v44
v_fma_f32 v73,v73,s36,v13
v_exp_f32 v73,v73
v_fma_f32 v75,v75,s36,v13
v_exp_f32 v75,v75
v_fma_f32 v74,v74,s36,v13
v_exp_f32 v74,v74
v_fma_f32 v72,v72,s36,v13
v_exp_f32 v72,v72
v_cvt_pk_bf16_f32 v21,v74,v75
v_cvt_pk_bf16_f32 v20,v72,v73
s_waitcnt lgkmcnt(0)
v_mfma_f32_16x16x32_bf16 v[72:75],a[136:139],a[0:3],0
ds_read_b128 a[136:139],v0 offset:18560
v_fma_f32 v77,v77,s36,v13
v_mfma_f32_16x16x32_bf16 v[72:75],a[140:143],a[4:7],v[72:75]
ds_read_b128 a[140:143],v1 offset:18560
v_exp_f32 v77,v77
v_mfma_f32_16x16x32_bf16 v[72:75],a[144:147],a[8:11],v[72:75]
ds_read_b128 a[144:147],v0 offset:18688
v_fma_f32 v76,v76,s36,v13
v_mfma_f32_16x16x32_bf16 v[72:75],a[148:151],a[12:15],v[72:75]
ds_read_b128 a[148:151],v1 offset:18688
v_exp_f32 v76,v76
v_mfma_f32_16x16x32_bf16 v[72:75],a[120:123],a[16:19],v[72:75]
v_fma_f32 v79,v79,s36,v13
v_exp_f32 v79,v79
v_mfma_f32_16x16x32_bf16 v[72:75],a[124:127],a[20:23],v[72:75]
v_fma_f32 v78,v78,s36,v13
v_exp_f32 v78,v78
v_cvt_pk_bf16_f32 v22,v76,v77
v_cvt_pk_bf16_f32 v23,v78,v79
v_mfma_f32_16x16x32_bf16 v[76:79],a[128:131],a[0:3],0
v_mfma_f32_16x16x32_bf16 v[76:79],a[132:135],a[4:7],v[76:79]
s_waitcnt lgkmcnt(2)
v_mfma_f32_16x16x32_bf16 v[76:79],a[136:139],a[8:11],v[76:79]
v_mfma_f32_16x16x32_bf16 v[76:79],a[140:143],a[12:15],v[76:79]
s_waitcnt lgkmcnt(0)
v_fma_f32 v73,v73,s36,v13
v_fma_f32 v74,v74,s36,v13
v_mfma_f32_16x16x32_bf16 v[76:79],a[144:147],a[16:19],v[76:79]
v_exp_f32 v74,v74
v_mfma_f32_16x16x32_bf16 v[76:79],a[148:151],a[20:23],v[76:79]
s_waitcnt vmcnt(12)
s_barrier
ds_read_b64_tr_b16 a[120:121],v2 offset:0
ds_read_b64_tr_b16 a[122:123],v2 offset:6144
ds_read_b64_tr_b16 a[126:127],v3 offset:6144
ds_read_b64_tr_b16 a[124:125],v3 offset:0
ds_read_b64_tr_b16 a[136:137],v2 offset:128
ds_read_b64_tr_b16 a[132:133],v5 offset:0
ds_read_b64_tr_b16 a[130:131],v4 offset:6144
ds_read_b64_tr_b16 a[140:141],v3 offset:128
ds_read_b64_tr_b16 a[138:139],v2 offset:6272
ds_read_b64_tr_b16 a[134:135],v5 offset:6144
ds_read_b64_tr_b16 a[144:145],v4 offset:128
ds_read_b64_tr_b16 a[128:129],v4 offset:0
ds_read_b64_tr_b16 a[148:149],v5 offset:128
ds_read_b64_tr_b16 a[146:147],v4 offset:6272
ds_read_b64_tr_b16 a[142:143],v3 offset:6272
ds_read_b64_tr_b16 a[150:151],v5 offset:6272
v_fma_f32 v75,v75,s36,v13
s_waitcnt lgkmcnt(14)
v_mfma_f32_16x16x32_bf16 v[160:163],a[120:123],v[20:23],0
s_waitcnt lgkmcnt(12)
ds_read_b64_tr_b16 a[122:123],v2 offset:6400
v_exp_f32 v75,v75
v_mfma_f32_16x16x32_bf16 v[164:167],a[124:127],v[20:23],0
ds_read_b64_tr_b16 a[126:127],v3 offset:6400
ds_read_b64_tr_b16 a[120:121],v2 offset:256
ds_read_b64_tr_b16 a[124:125],v3 offset:256
v_fma_f32 v72,v72,s36,v13
v_exp_f32 v72,v72
v_exp_f32 v73,v73
v_cvt_pk_bf16_f32 v45,v74,v75
v_cvt_pk_bf16_f32 v44,v72,v73
v_fma_f32 v76,v76,s36,v13
s_waitcnt lgkmcnt(8)
v_mfma_f32_16x16x32_bf16 v[168:171],a[128:131],v[20:23],0
ds_read_b64_tr_b16 a[128:129],v4 offset:256
v_fma_f32 v79,v79,s36,v13
v_mfma_f32_16x16x32_bf16 v[172:175],a[132:135],v[20:23],0
ds_read_b64_tr_b16 a[132:133],v5 offset:256
v_exp_f32 v79,v79
v_mfma_f32_16x16x32_bf16 v[176:179],a[136:139],v[20:23],0
s_waitcnt lgkmcnt(5)
ds_read_b64_tr_b16 a[130:131],v4 offset:6400
v_fma_f32 v78,v78,s36,v13
v_mfma_f32_16x16x32_bf16 v[180:183],a[140:143],v[20:23],0
ds_read_b128 a[140:143],v1 offset:24576
v_exp_f32 v78,v78
v_mfma_f32_16x16x32_bf16 v[184:187],a[144:147],v[20:23],0
ds_read_b64_tr_b16 a[134:135],v5 offset:6400
v_cvt_pk_bf16_f32 v47,v78,v79
v_mfma_f32_16x16x32_bf16 v[188:191],a[148:151],v[20:23],0
s_waitcnt lgkmcnt(5)
ds_read_b128 a[136:139],v0 offset:24576
v_fma_f32 v77,v77,s36,v13
v_mfma_f32_16x16x32_bf16 v[192:195],a[120:123],v[20:23],0
ds_read_b128 a[120:123],v0 offset:24832
v_exp_f32 v77,v77
v_mfma_f32_16x16x32_bf16 v[196:199],a[124:127],v[20:23],0
ds_read_b128 a[144:147],v0 offset:24704
v_exp_f32 v76,v76
ds_read_b128 a[148:151],v1 offset:24704
v_cvt_pk_bf16_f32 v46,v76,v77
s_waitcnt lgkmcnt(6)
v_mfma_f32_16x16x32_bf16 v[200:203],a[128:131],v[20:23],0
s_waitcnt lgkmcnt(4)
ds_read_b128 a[128:131],v0 offset:30720
ds_read_b128 a[124:127],v1 offset:24832
v_mfma_f32_16x16x32_bf16 v[204:207],a[132:135],v[20:23],0
s_waitcnt lgkmcnt(5)
ds_read_b128 a[132:135],v1 offset:30720
v_mfma_f32_16x16x32_bf16 v[72:75],a[136:139],a[0:3],0
ds_read_b128 a[136:139],v0 offset:30848
v_mfma_f32_16x16x32_bf16 v[72:75],a[140:143],a[4:7],v[72:75]
s_waitcnt lgkmcnt(5)
ds_read_b128 a[140:143],v1 offset:30848
v_mfma_f32_16x16x32_bf16 v[72:75],a[144:147],a[8:11],v[72:75]
s_waitcnt lgkmcnt(5)
ds_read_b128 a[144:147],v0 offset:30976
v_mfma_f32_16x16x32_bf16 v[72:75],a[148:151],a[12:15],v[72:75]
ds_read_b128 a[148:151],v1 offset:30976
v_mfma_f32_16x16x32_bf16 v[72:75],a[120:123],a[16:19],v[72:75]
s_waitcnt lgkmcnt(5)
ds_read_b128 a[120:123],v0 offset:0
v_mfma_f32_16x16x32_bf16 v[72:75],a[124:127],a[20:23],v[72:75]
ds_read_b128 a[124:127],v1 offset:0
v_mfma_f32_16x16x32_bf16 v[76:79],a[128:131],a[0:3],0
s_waitcnt lgkmcnt(6)
ds_read_b128 a[128:131],v0 offset:128
v_mfma_f32_16x16x32_bf16 v[76:79],a[132:135],a[4:7],v[76:79]
s_waitcnt lgkmcnt(6)
ds_read_b128 a[132:135],v1 offset:128
v_mfma_f32_16x16x32_bf16 v[76:79],a[136:139],a[8:11],v[76:79]
s_waitcnt lgkmcnt(6)
ds_read_b128 a[136:139],v0 offset:256
v_mfma_f32_16x16x32_bf16 v[76:79],a[140:143],a[12:15],v[76:79]
s_waitcnt lgkmcnt(6)
ds_read_b128 a[140:143],v1 offset:256
v_fma_f32 v72,v72,s36,v13
v_mfma_f32_16x16x32_bf16 v[76:79],a[144:147],a[16:19],v[76:79]
s_waitcnt lgkmcnt(6)
ds_read_b128 a[144:147],v0 offset:6144
v_exp_f32 v72,v72
v_mfma_f32_16x16x32_bf16 v[76:79],a[148:151],a[20:23],v[76:79]
s_waitcnt vmcnt(6)
ds_read_b128 a[28:31],v12 offset:6144
buffer_load_dwordx4 v6,s[12:15],s28 offen offset:0 nt lds
ds_read_b128 a[24:27],v11 offset:6144
buffer_load_dwordx4 v7,s[12:15],s28 offen offset:1024 nt lds
ds_read_b128 a[32:35],v11 offset:6272
buffer_load_dwordx4 v8,s[12:15],s28 offen offset:2048 nt lds
s_add_u32 s28,s28,3072
s_add_u32 m0,s24,3072
ds_read_b128 a[40:43],v11 offset:6400
buffer_load_dwordx4 v6,s[12:15],s28 offen offset:0 nt lds
ds_read_b128 a[36:39],v12 offset:6272
buffer_load_dwordx4 v7,s[12:15],s28 offen offset:1024 nt lds
ds_read_b128 a[44:47],v12 offset:6400
buffer_load_dwordx4 v8,s[12:15],s28 offen offset:2048 nt lds
s_add_u32 s28,s28,3072
s_add_u32 m0,s24,6144
ds_read_b128 a[148:151],v1 offset:6144
v_fma_f32 v75,v75,s36,v13
v_exp_f32 v75,v75
v_fma_f32 v74,v74,s36,v13
v_exp_f32 v74,v74
s_waitcnt lgkmcnt(5)
v_mfma_f32_16x16x32_bf16 v[80:83],a[120:123],a[24:27],0
ds_read_b128 a[120:123],v0 offset:6272
v_fma_f32 v73,v73,s36,v13
v_mfma_f32_16x16x32_bf16 v[80:83],a[124:127],a[28:31],v[80:83]
s_waitcnt lgkmcnt(4)
ds_read_b128 a[124:127],v1 offset:6272
v_exp_f32 v73,v73
v_mfma_f32_16x16x32_bf16 v[80:83],a[128:131],a[32:35],v[80:83]
s_waitcnt lgkmcnt(4)
ds_read_b128 a[128:131],v0 offset:6400
v_mfma_f32_16x16x32_bf16 v[80:83],a[132:135],a[36:39],v[80:83]
ds_read_b128 a[132:135],v1 offset:6400
v_mfma_f32_16x16x32_bf16 v[80:83],a[136:139],a[40:43],v[80:83]
s_waitcnt lgkmcnt(4)
ds_read_b128 a[136:139],v0 offset:12288
v_mfma_f32_16x16x32_bf16 v[80:83],a[140:143],a[44:47],v[80:83]
ds_read_b128 a[140:143],v1 offset:12288
v_mfma_f32_16x16x32_bf16 v[84:87],a[144:147],a[24:27],0
ds_read_b128 a[144:147],v0 offset:12416
v_mfma_f32_16x16x32_bf16 v[84:87],a[148:151],a[28:31],v[84:87]
s_waitcnt lgkmcnt(6)
ds_read_b128 a[148:151],v1 offset:12416
v_mfma_f32_16x16x32_bf16 v[84:87],a[120:123],a[32:35],v[84:87]
s_waitcnt lgkmcnt(6)
ds_read_b128 a[120:123],v0 offset:12544
v_mfma_f32_16x16x32_bf16 v[84:87],a[124:127],a[36:39],v[84:87]
s_waitcnt lgkmcnt(6)
ds_read_b128 a[124:127],v1 offset:12544
v_max3_f32 v48,v80,v81,v82
v_mfma_f32_16x16x32_bf16 v[84:87],a[128:131],a[40:43],v[84:87]
s_waitcnt lgkmcnt(6)
ds_read_b128 a[128:131],v0 offset:18432
v_mfma_f32_16x16x32_bf16 v[84:87],a[132:135],a[44:47],v[84:87]
ds_read_b128 a[132:135],v1 offset:18432
s_nop 6
v_max3_f32 v48,v48,v83,v84
v_max3_f32 v48,v48,v85,v86
v_max_f32 v48,v48,v87
v_mov_b32 v49,v48
s_nop 1
v_permlane32_swap_b32 v49,v48
v_max_f32 v48,v48,v49
v_mov_b32 v49,v48
s_nop 1
v_permlane16_swap_b32 v49,v48
v_max_f32 v48,v48,v49
v_mul_f32_e64 v14,-s36,v48
v_fma_f32 v80,v80,s36,v14
v_fma_f32 v83,v83,s36,v14
v_fma_f32 v82,v82,s36,v14
v_fma_f32 v81,v81,s36,v14
v_exp_f32 v81,v81
v_exp_f32 v80,v80
v_exp_f32 v83,v83
v_exp_f32 v82,v82
v_fma_f32 v87,v87,s36,v14
v_cvt_pk_bf16_f32 v25,v82,v83
v_cvt_pk_bf16_f32 v24,v80,v81
s_waitcnt lgkmcnt(0)
v_mfma_f32_16x16x32_bf16 v[80:83],a[136:139],a[24:27],0
ds_read_b128 a[136:139],v0 offset:18560
v_fma_f32 v86,v86,s36,v14
v_mfma_f32_16x16x32_bf16 v[80:83],a[140:143],a[28:31],v[80:83]
ds_read_b128 a[140:143],v1 offset:18560
v_exp_f32 v86,v86
v_mfma_f32_16x16x32_bf16 v[80:83],a[144:147],a[32:35],v[80:83]
ds_read_b128 a[144:147],v0 offset:18688
v_fma_f32 v84,v84,s36,v14
v_mfma_f32_16x16x32_bf16 v[80:83],a[148:151],a[36:39],v[80:83]
ds_read_b128 a[148:151],v1 offset:18688
v_exp_f32 v87,v87
v_mfma_f32_16x16x32_bf16 v[80:83],a[120:123],a[40:43],v[80:83]
ds_read_b64_tr_b16 a[120:121],v2 offset:0
v_cvt_pk_bf16_f32 v27,v86,v87
v_mfma_f32_16x16x32_bf16 v[80:83],a[124:127],a[44:47],v[80:83]
ds_read_b64_tr_b16 a[126:127],v3 offset:6144
ds_read_b64_tr_b16 a[124:125],v3 offset:0
ds_read_b64_tr_b16 a[122:123],v2 offset:6144
v_exp_f32 v84,v84
v_fma_f32 v85,v85,s36,v14
v_exp_f32 v85,v85
s_nop 0
v_cvt_pk_bf16_f32 v26,v84,v85
v_mfma_f32_16x16x32_bf16 v[84:87],a[128:131],a[24:27],0
ds_read_b64_tr_b16 a[128:129],v4 offset:0
v_fma_f32 v80,v80,s36,v14
v_smfmac_f32_16x16x64_bf16 v[60:63],a[152:155],v[20:27],v18
ds_read_b64_tr_b16 a[130:131],v4 offset:6144
v_mfma_f32_16x16x32_bf16 v[84:87],a[132:135],a[28:31],v[84:87]
s_waitcnt lgkmcnt(6)
ds_read_b64_tr_b16 a[134:135],v5 offset:6144
v_fma_f32 v81,v81,s36,v14
v_mfma_f32_16x16x32_bf16 v[84:87],a[136:139],a[32:35],v[84:87]
ds_read_b64_tr_b16 a[138:139],v2 offset:6272
v_exp_f32 v81,v81
v_mfma_f32_16x16x32_bf16 v[84:87],a[140:143],a[36:39],v[84:87]
ds_read_b64_tr_b16 a[132:133],v5 offset:0
v_exp_f32 v80,v80
v_mfma_f32_16x16x32_bf16 v[84:87],a[144:147],a[40:43],v[84:87]
ds_read_b64_tr_b16 a[136:137],v2 offset:128
v_cvt_pk_bf16_f32 v48,v80,v81
v_mfma_f32_16x16x32_bf16 v[84:87],a[148:151],a[44:47],v[84:87]
s_waitcnt lgkmcnt(6)
ds_read_b64_tr_b16 a[150:151],v5 offset:6272
v_fma_f32 v82,v82,s36,v14
v_mfma_f32_16x16x32_bf16 v[208:211],a[120:123],v[24:27],0
ds_read_b64_tr_b16 a[142:143],v3 offset:6272
v_exp_f32 v82,v82
v_mfma_f32_16x16x32_bf16 v[212:215],a[124:127],v[24:27],0
s_waitcnt lgkmcnt(5)
ds_read_b64_tr_b16 a[120:121],v2 offset:256
v_fma_f32 v83,v83,s36,v14
v_mfma_f32_16x16x32_bf16 v[216:219],a[128:131],v[24:27],0
ds_read_b64_tr_b16 a[146:147],v4 offset:6272
ds_read_b64_tr_b16 a[148:149],v5 offset:128
ds_read_b64_tr_b16 a[140:141],v3 offset:128
ds_read_b64_tr_b16 a[144:145],v4 offset:128
v_exp_f32 v83,v83
s_waitcnt lgkmcnt(8)
v_mfma_f32_16x16x32_bf16 v[220:223],a[132:135],v[24:27],0
s_waitcnt lgkmcnt(7)
ds_read_b64_tr_b16 a[122:123],v2 offset:6400
v_cvt_pk_bf16_f32 v49,v82,v83
v_mfma_f32_16x16x32_bf16 v[224:227],a[136:139],v[24:27],0
ds_read_b64_tr_b16 a[132:133],v5 offset:256
ds_read_b64_tr_b16 a[134:135],v5 offset:6400
ds_read_b64_tr_b16 a[126:127],v3 offset:6400
ds_read_b64_tr_b16 a[130:131],v4 offset:6400
ds_read_b64_tr_b16 a[124:125],v3 offset:256
ds_read_b64_tr_b16 a[128:129],v4 offset:256
ds_read_b128 a[136:139],v0 offset:24576
v_fma_f32 v86,v86,s36,v14
v_fma_f32 v87,v87,s36,v14
v_exp_f32 v87,v87
v_fma_f32 v85,v85,s36,v14
v_exp_f32 v85,v85
s_waitcnt lgkmcnt(9)
v_mfma_f32_16x16x32_bf16 v[228:231],a[140:143],v[24:27],0
s_waitcnt lgkmcnt(8)
ds_read_b128 a[140:143],v1 offset:24576
v_fma_f32 v84,v84,s36,v14
v_mfma_f32_16x16x32_bf16 v[232:235],a[144:147],v[24:27],0
ds_read_b128 a[144:147],v0 offset:24704
v_exp_f32 v84,v84
v_mfma_f32_16x16x32_bf16 v[236:239],a[148:151],v[24:27],0
s_waitcnt lgkmcnt(9)
ds_read_b128 a[148:151],v1 offset:24704
v_cvt_pk_bf16_f32 v50,v84,v85
v_mfma_f32_16x16x32_bf16 v[240:243],a[120:123],v[24:27],0
s_waitcnt lgkmcnt(4)
ds_read_b128 a[120:123],v0 offset:24832
v_exp_f32 v86,v86
v_mfma_f32_16x16x32_bf16 v[244:247],a[124:127],v[24:27],0
ds_read_b128 a[124:127],v1 offset:24832
v_cvt_pk_bf16_f32 v51,v86,v87
v_mfma_f32_16x16x32_bf16 v[248:251],a[128:131],v[24:27],0
ds_read_b128 a[128:131],v0 offset:30720
v_cvt_pk_bf16_f32 v20,v72,v73
v_smfmac_f32_16x16x64_bf16 v[60:63],a[152:155],v[44:51],v18
v_cvt_pk_bf16_f32 v21,v74,v75
v_mfma_f32_16x16x32_bf16 v[252:255],a[132:135],v[24:27],0
s_waitcnt lgkmcnt(4)
ds_read_b128 a[132:135],v1 offset:30720
v_mfma_f32_16x16x32_bf16 v[80:83],a[136:139],a[24:27],0
ds_read_b128 a[136:139],v0 offset:30848
v_mfma_f32_16x16x32_bf16 v[80:83],a[140:143],a[28:31],v[80:83]
ds_read_b128 a[140:143],v1 offset:30848
v_mfma_f32_16x16x32_bf16 v[80:83],a[144:147],a[32:35],v[80:83]
s_waitcnt lgkmcnt(5)
ds_read_b128 a[144:147],v0 offset:30976
v_mfma_f32_16x16x32_bf16 v[80:83],a[148:151],a[36:39],v[80:83]
ds_read_b128 a[148:151],v1 offset:30976
v_mfma_f32_16x16x32_bf16 v[80:83],a[120:123],a[40:43],v[80:83]
s_waitcnt lgkmcnt(5)
ds_read_b128 a[120:123],v0 offset:0
v_mfma_f32_16x16x32_bf16 v[80:83],a[124:127],a[44:47],v[80:83]
ds_read_b128 a[124:127],v1 offset:0
v_mfma_f32_16x16x32_bf16 v[84:87],a[128:131],a[24:27],0
s_waitcnt lgkmcnt(6)
ds_read_b128 a[128:131],v0 offset:128
v_mfma_f32_16x16x32_bf16 v[84:87],a[132:135],a[28:31],v[84:87]
s_waitcnt lgkmcnt(6)
ds_read_b128 a[132:135],v1 offset:128
v_mfma_f32_16x16x32_bf16 v[84:87],a[136:139],a[32:35],v[84:87]
s_waitcnt lgkmcnt(6)
ds_read_b128 a[136:139],v0 offset:256
v_mfma_f32_16x16x32_bf16 v[84:87],a[140:143],a[36:39],v[84:87]
s_waitcnt lgkmcnt(6)
ds_read_b128 a[140:143],v1 offset:256
v_fma_f32 v82,v82,s36,v14
v_mfma_f32_16x16x32_bf16 v[84:87],a[144:147],a[40:43],v[84:87]
s_waitcnt lgkmcnt(6)
ds_read_b128 a[144:147],v0 offset:6144
v_fma_f32 v81,v81,s36,v14
v_mfma_f32_16x16x32_bf16 v[84:87],a[148:151],a[44:47],v[84:87]
s_waitcnt vmcnt(6)
ds_read_b128 a[48:51],v11 offset:12288
buffer_load_dwordx4 v6,s[12:15],s28 offen offset:0 nt lds
ds_read_b128 a[64:67],v11 offset:12544
buffer_load_dwordx4 v7,s[12:15],s28 offen offset:1024 nt lds
ds_read_b128 a[60:63],v12 offset:12416
buffer_load_dwordx4 v8,s[12:15],s28 offen offset:2048 nt lds
s_add_u32 s28,s28,3072
s_add_u32 m0,s24,9216
ds_read_b128 a[52:55],v12 offset:12288
buffer_load_dwordx4 v6,s[12:15],s28 offen offset:0 nt lds
ds_read_b128 a[68:71],v12 offset:12544
buffer_load_dwordx4 v7,s[12:15],s28 offen offset:1024 nt lds
ds_read_b128 a[56:59],v11 offset:12416
buffer_load_dwordx4 v8,s[12:15],s28 offen offset:2048 nt lds
s_add_u32 s28,s28,3072
s_add_u32 m0,s23,12288
ds_read_b128 a[148:151],v1 offset:6144
v_exp_f32 v82,v82
s_waitcnt lgkmcnt(6)
v_mfma_f32_16x16x32_bf16 v[88:91],a[120:123],a[48:51],0
ds_read_b128 a[120:123],v0 offset:6272
v_fma_f32 v80,v80,s36,v14
v_exp_f32 v81,v81
v_exp_f32 v80,v80
v_fma_f32 v83,v83,s36,v14
v_exp_f32 v83,v83
v_cvt_pk_bf16_f32 v24,v80,v81
v_cvt_pk_bf16_f32 v25,v82,v83
s_waitcnt lgkmcnt(4)
v_mfma_f32_16x16x32_bf16 v[88:91],a[124:127],a[52:55],v[88:91]
s_waitcnt lgkmcnt(2)
ds_read_b128 a[124:127],v1 offset:6272
v_mfma_f32_16x16x32_bf16 v[88:91],a[128:131],a[56:59],v[88:91]
ds_read_b128 a[128:131],v0 offset:6400
v_mfma_f32_16x16x32_bf16 v[88:91],a[132:135],a[60:63],v[88:91]
ds_read_b128 a[132:135],v1 offset:6400
v_mfma_f32_16x16x32_bf16 v[88:91],a[136:139],a[64:67],v[88:91]
ds_read_b128 a[136:139],v0 offset:12288
v_mfma_f32_16x16x32_bf16 v[88:91],a[140:143],a[68:71],v[88:91]
ds_read_b128 a[140:143],v1 offset:12288
v_mfma_f32_16x16x32_bf16 v[92:95],a[144:147],a[48:51],0
s_waitcnt lgkmcnt(5)
ds_read_b128 a[144:147],v0 offset:12416
v_mfma_f32_16x16x32_bf16 v[92:95],a[148:151],a[52:55],v[92:95]
ds_read_b128 a[148:151],v1 offset:12416
v_mfma_f32_16x16x32_bf16 v[92:95],a[120:123],a[56:59],v[92:95]
s_waitcnt lgkmcnt(6)
ds_read_b128 a[120:123],v0 offset:12544
v_mfma_f32_16x16x32_bf16 v[92:95],a[124:127],a[60:63],v[92:95]
s_waitcnt lgkmcnt(6)
ds_read_b128 a[124:127],v1 offset:12544
v_max3_f32 v52,v88,v89,v90
v_mfma_f32_16x16x32_bf16 v[92:95],a[128:131],a[64:67],v[92:95]
s_waitcnt lgkmcnt(6)
ds_read_b128 a[128:131],v0 offset:18432
v_mfma_f32_16x16x32_bf16 v[92:95],a[132:135],a[68:71],v[92:95]
ds_read_b128 a[132:135],v1 offset:18432
s_nop 6
v_max3_f32 v52,v52,v91,v92
v_max3_f32 v52,v52,v93,v94
v_max_f32 v52,v52,v95
v_mov_b32 v53,v52
s_nop 1
v_permlane32_swap_b32 v53,v52
v_max_f32 v52,v52,v53
v_mov_b32 v53,v52
s_nop 1
v_permlane16_swap_b32 v53,v52
v_max_f32 v52,v52,v53
v_mul_f32_e64 v15,-s36,v52
v_fma_f32 v89,v89,s36,v15
v_fma_f32 v88,v88,s36,v15
v_exp_f32 v88,v88
v_exp_f32 v89,v89
v_fma_f32 v90,v90,s36,v15
v_exp_f32 v90,v90
v_cvt_pk_bf16_f32 v28,v88,v89
v_fma_f32 v91,v91,s36,v15
v_exp_f32 v91,v91
v_fma_f32 v95,v95,s36,v15
v_cvt_pk_bf16_f32 v29,v90,v91
s_waitcnt lgkmcnt(0)
v_mfma_f32_16x16x32_bf16 v[88:91],a[136:139],a[48:51],0
ds_read_b128 a[136:139],v0 offset:18560
v_fma_f32 v93,v93,s36,v15
v_mfma_f32_16x16x32_bf16 v[88:91],a[140:143],a[52:55],v[88:91]
ds_read_b128 a[140:143],v1 offset:18560
v_exp_f32 v93,v93
v_mfma_f32_16x16x32_bf16 v[88:91],a[144:147],a[56:59],v[88:91]
ds_read_b128 a[144:147],v0 offset:18688
v_fma_f32 v92,v92,s36,v15
v_mfma_f32_16x16x32_bf16 v[88:91],a[148:151],a[60:63],v[88:91]
ds_read_b128 a[148:151],v1 offset:18688
v_fma_f32 v94,v94,s36,v15
v_mfma_f32_16x16x32_bf16 v[88:91],a[120:123],a[64:67],v[88:91]
ds_read_b64_tr_b16 a[120:121],v2 offset:0
v_exp_f32 v94,v94
v_mfma_f32_16x16x32_bf16 v[88:91],a[124:127],a[68:71],v[88:91]
ds_read_b64_tr_b16 a[124:125],v3 offset:0
ds_read_b64_tr_b16 a[126:127],v3 offset:6144
ds_read_b64_tr_b16 a[122:123],v2 offset:6144
v_exp_f32 v92,v92
v_exp_f32 v95,v95
v_cvt_pk_bf16_f32 v30,v92,v93
v_cvt_pk_bf16_f32 v31,v94,v95
v_mfma_f32_16x16x32_bf16 v[92:95],a[128:131],a[48:51],0
ds_read_b64_tr_b16 a[130:131],v4 offset:6144
v_fma_f32 v90,v90,s36,v15
v_mfma_f32_16x16x32_bf16 v[92:95],a[132:135],a[52:55],v[92:95]
s_waitcnt lgkmcnt(6)
ds_read_b64_tr_b16 a[128:129],v4 offset:0
v_exp_f32 v90,v90
v_mfma_f32_16x16x32_bf16 v[92:95],a[136:139],a[56:59],v[92:95]
ds_read_b64_tr_b16 a[132:133],v5 offset:0
v_fma_f32 v89,v89,s36,v15
v_mfma_f32_16x16x32_bf16 v[92:95],a[140:143],a[60:63],v[92:95]
ds_read_b64_tr_b16 a[140:141],v3 offset:128
v_exp_f32 v89,v89
v_mfma_f32_16x16x32_bf16 v[92:95],a[144:147],a[64:67],v[92:95]
s_waitcnt lgkmcnt(4)
ds_read_b64_tr_b16 a[138:139],v2 offset:6272
v_fma_f32 v88,v88,s36,v15
v_mfma_f32_16x16x32_bf16 v[92:95],a[148:151],a[68:71],v[92:95]
ds_read_b64_tr_b16 a[134:135],v5 offset:6144
v_exp_f32 v88,v88
v_mfma_f32_16x16x32_bf16 v[112:115],a[120:123],v[28:31],0
ds_read_b64_tr_b16 a[150:151],v5 offset:6272
v_cvt_pk_bf16_f32 v52,v88,v89
v_mfma_f32_16x16x32_bf16 v[116:119],a[124:127],v[28:31],0
s_waitcnt lgkmcnt(5)
ds_read_b64_tr_b16 a[146:147],v4 offset:6272
ds_read_b64_tr_b16 a[136:137],v2 offset:128
ds_read_b64_tr_b16 a[142:143],v3 offset:6272
v_mfma_f32_16x16x32_bf16 v[120:123],a[128:131],v[28:31],0
ds_read_b64_tr_b16 a[148:149],v5 offset:128
ds_read_b64_tr_b16 a[126:127],v3 offset:6400
ds_read_b64_tr_b16 a[144:145],v4 offset:128
ds_read_b64_tr_b16 a[122:123],v2 offset:6400
ds_read_b64_tr_b16 a[128:129],v4 offset:256
ds_read_b64_tr_b16 a[130:131],v4 offset:6400
ds_read_b64_tr_b16 a[120:121],v2 offset:256
v_fma_f32 v91,v91,s36,v15
ds_read_b64_tr_b16 a[124:125],v3 offset:256
s_waitcnt lgkmcnt(12)
v_mfma_f32_16x16x32_bf16 v[124:127],a[132:135],v[28:31],0
ds_read_b64_tr_b16 a[134:135],v5 offset:6400
ds_read_b64_tr_b16 a[132:133],v5 offset:256
v_exp_f32 v91,v91
v_fma_f32 v94,v94,s36,v15
s_waitcnt lgkmcnt(11)
v_mfma_f32_16x16x32_bf16 v[128:131],a[136:139],v[28:31],0
s_waitcnt lgkmcnt(10)
ds_read_b128 a[136:139],v0 offset:24576
v_cvt_pk_bf16_f32 v53,v90,v91
v_mfma_f32_16x16x32_bf16 v[132:135],a[140:143],v[28:31],0
s_waitcnt lgkmcnt(8)
ds_read_b128 a[140:143],v1 offset:24576
v_exp_f32 v94,v94
v_mfma_f32_16x16x32_bf16 v[136:139],a[144:147],v[28:31],0
ds_read_b128 a[144:147],v0 offset:24704
v_fma_f32 v93,v93,s36,v15
v_mfma_f32_16x16x32_bf16 v[140:143],a[148:151],v[28:31],0
s_waitcnt lgkmcnt(5)
ds_read_b128 a[148:151],v1 offset:24704
v_exp_f32 v93,v93
v_mfma_f32_16x16x32_bf16 v[144:147],a[120:123],v[28:31],0
ds_read_b128 a[120:123],v0 offset:24832
v_fma_f32 v95,v95,s36,v15
v_mfma_f32_16x16x32_bf16 v[148:151],a[124:127],v[28:31],0
ds_read_b128 a[124:127],v1 offset:24832
v_exp_f32 v95,v95
v_mfma_f32_16x16x32_bf16 v[152:155],a[128:131],v[28:31],0
s_waitcnt lgkmcnt(5)
ds_read_b128 a[128:131],v0 offset:30720
v_fma_f32 v92,v92,s36,v15
v_mfma_f32_16x16x32_bf16 v[156:159],a[132:135],v[28:31],0
ds_read_b128 a[132:135],v1 offset:30720
v_exp_f32 v92,v92
v_mfma_f32_16x16x32_bf16 v[88:91],a[136:139],a[48:51],0
s_waitcnt lgkmcnt(5)
ds_read_b128 a[136:139],v0 offset:30848
v_cvt_pk_bf16_f32 v54,v92,v93
v_mfma_f32_16x16x32_bf16 v[88:91],a[140:143],a[52:55],v[88:91]
ds_read_b128 a[140:143],v1 offset:30848
v_cvt_pk_bf16_f32 v55,v94,v95
v_mfma_f32_16x16x32_bf16 v[88:91],a[144:147],a[56:59],v[88:91]
s_waitcnt lgkmcnt(5)
ds_read_b128 a[144:147],v0 offset:30976
v_mfma_f32_16x16x32_bf16 v[88:91],a[148:151],a[60:63],v[88:91]
ds_read_b128 a[148:151],v1 offset:30976
v_mfma_f32_16x16x32_bf16 v[88:91],a[120:123],a[64:67],v[88:91]
s_waitcnt lgkmcnt(6)
ds_read_b128 a[120:123],v0 offset:0
v_mfma_f32_16x16x32_bf16 v[88:91],a[124:127],a[68:71],v[88:91]
s_waitcnt lgkmcnt(6)
ds_read_b128 a[124:127],v1 offset:0
v_mfma_f32_16x16x32_bf16 v[92:95],a[128:131],a[48:51],0
s_waitcnt lgkmcnt(6)
ds_read_b128 a[128:131],v0 offset:128
v_mfma_f32_16x16x32_bf16 v[92:95],a[132:135],a[52:55],v[92:95]
s_waitcnt lgkmcnt(6)
ds_read_b128 a[132:135],v1 offset:128
v_mfma_f32_16x16x32_bf16 v[92:95],a[136:139],a[56:59],v[92:95]
s_waitcnt lgkmcnt(6)
ds_read_b128 a[136:139],v0 offset:256
v_mfma_f32_16x16x32_bf16 v[92:95],a[140:143],a[60:63],v[92:95]
s_waitcnt lgkmcnt(6)
ds_read_b128 a[140:143],v1 offset:256
v_fma_f32 v88,v88,s36,v15
v_mfma_f32_16x16x32_bf16 v[92:95],a[144:147],a[64:67],v[92:95]
s_waitcnt lgkmcnt(6)
ds_read_b128 a[144:147],v0 offset:6144
v_exp_f32 v88,v88
v_mfma_f32_16x16x32_bf16 v[92:95],a[148:151],a[68:71],v[92:95]
s_waitcnt vmcnt(6)
ds_read_b128 a[80:83],v11 offset:128
buffer_load_dwordx4 v6,s[8:11],s21 offen offset:0 lds
ds_read_b128 a[72:75],v11 offset:0
buffer_load_dwordx4 v7,s[8:11],s21 offen offset:1024 lds
ds_read_b128 a[84:87],v12 offset:128
buffer_load_dwordx4 v8,s[8:11],s21 offen offset:2048 lds
s_add_u32 s21,s21,12288
s_add_u32 m0,s23,24576
ds_read_b128 a[76:79],v12 offset:0
v_fma_f32 v89,v89,s36,v15
ds_read_b128 a[88:91],v11 offset:256
v_exp_f32 v89,v89
ds_read_b128 a[92:95],v12 offset:256
ds_read_b128 a[148:151],v1 offset:6144
s_waitcnt lgkmcnt(5)
v_mfma_f32_16x16x32_bf16 v[96:99],a[120:123],a[72:75],0
s_waitcnt lgkmcnt(3)
ds_read_b128 a[120:123],v0 offset:6272
v_mfma_f32_16x16x32_bf16 v[96:99],a[124:127],a[76:79],v[96:99]
ds_read_b128 a[124:127],v1 offset:6272
v_mfma_f32_16x16x32_bf16 v[96:99],a[128:131],a[80:83],v[96:99]
ds_read_b128 a[128:131],v0 offset:6400
v_mfma_f32_16x16x32_bf16 v[96:99],a[132:135],a[84:87],v[96:99]
s_waitcnt lgkmcnt(5)
ds_read_b128 a[132:135],v1 offset:6400
v_mfma_f32_16x16x32_bf16 v[96:99],a[136:139],a[88:91],v[96:99]
s_waitcnt lgkmcnt(5)
ds_read_b128 a[136:139],v0 offset:12288
v_mfma_f32_16x16x32_bf16 v[96:99],a[140:143],a[92:95],v[96:99]
ds_read_b128 a[140:143],v1 offset:12288
v_mfma_f32_16x16x32_bf16 v[100:103],a[144:147],a[72:75],0
s_waitcnt lgkmcnt(6)
ds_read_b128 a[144:147],v0 offset:12416
v_mfma_f32_16x16x32_bf16 v[100:103],a[148:151],a[76:79],v[100:103]
s_waitcnt lgkmcnt(6)
ds_read_b128 a[148:151],v1 offset:12416
v_mfma_f32_16x16x32_bf16 v[100:103],a[120:123],a[80:83],v[100:103]
s_waitcnt lgkmcnt(6)
ds_read_b128 a[120:123],v0 offset:12544
v_mfma_f32_16x16x32_bf16 v[100:103],a[124:127],a[84:87],v[100:103]
s_waitcnt lgkmcnt(6)
ds_read_b128 a[124:127],v1 offset:12544
v_max3_f32 v56,v96,v97,v98
v_mfma_f32_16x16x32_bf16 v[100:103],a[128:131],a[88:91],v[100:103]
s_waitcnt lgkmcnt(6)
ds_read_b128 a[128:131],v0 offset:18432
v_mfma_f32_16x16x32_bf16 v[100:103],a[132:135],a[92:95],v[100:103]
ds_read_b128 a[132:135],v1 offset:18432
s_nop 6
v_max3_f32 v56,v56,v99,v100
v_max3_f32 v56,v56,v101,v102
v_max_f32 v56,v56,v103
v_mov_b32 v57,v56
s_nop 1
v_permlane32_swap_b32 v57,v56
v_max_f32 v56,v56,v57
v_mov_b32 v57,v56
s_nop 1
v_permlane16_swap_b32 v57,v56
v_max_f32 v56,v56,v57
v_mul_f32_e64 v16,-s36,v56
v_fma_f32 v99,v99,s36,v16
v_exp_f32 v99,v99
v_fma_f32 v97,v97,s36,v16
v_exp_f32 v97,v97
v_fma_f32 v96,v96,s36,v16
v_exp_f32 v96,v96
v_fma_f32 v98,v98,s36,v16
v_exp_f32 v98,v98
v_fma_f32 v103,v103,s36,v16
v_cvt_pk_bf16_f32 v33,v98,v99
v_exp_f32 v103,v103
v_cvt_pk_bf16_f32 v32,v96,v97
s_waitcnt lgkmcnt(0)
v_mfma_f32_16x16x32_bf16 v[96:99],a[136:139],a[72:75],0
ds_read_b128 a[136:139],v0 offset:18560
v_fma_f32 v101,v101,s36,v16
v_mfma_f32_16x16x32_bf16 v[96:99],a[140:143],a[76:79],v[96:99]
ds_read_b128 a[140:143],v1 offset:18560
v_fma_f32 v102,v102,s36,v16
v_mfma_f32_16x16x32_bf16 v[96:99],a[144:147],a[80:83],v[96:99]
ds_read_b128 a[144:147],v0 offset:18688
v_exp_f32 v102,v102
v_mfma_f32_16x16x32_bf16 v[96:99],a[148:151],a[84:87],v[96:99]
ds_read_b128 a[148:151],v1 offset:18688
v_cvt_pk_bf16_f32 v35,v102,v103
v_mfma_f32_16x16x32_bf16 v[96:99],a[120:123],a[88:91],v[96:99]
ds_read_b64_tr_b16 a[122:123],v2 offset:6144
v_exp_f32 v101,v101
v_mfma_f32_16x16x32_bf16 v[96:99],a[124:127],a[92:95],v[96:99]
ds_read_b64_tr_b16 a[120:121],v2 offset:0
ds_read_b64_tr_b16 a[126:127],v3 offset:6144
ds_read_b64_tr_b16 a[124:125],v3 offset:0
v_fma_f32 v100,v100,s36,v16
v_exp_f32 v100,v100
s_nop 0
v_cvt_pk_bf16_f32 v34,v100,v101
v_mfma_f32_16x16x32_bf16 v[100:103],a[128:131],a[72:75],0
ds_read_b64_tr_b16 a[128:129],v4 offset:0
v_fma_f32 v97,v97,s36,v16
v_smfmac_f32_16x16x64_bf16 v[64:67],a[152:155],v[28:35],v18
ds_read_b64_tr_b16 a[130:131],v4 offset:6144
v_mfma_f32_16x16x32_bf16 v[100:103],a[132:135],a[76:79],v[100:103]
s_waitcnt lgkmcnt(7)
ds_read_b64_tr_b16 a[132:133],v5 offset:0
v_fma_f32 v98,v98,s36,v16
v_mfma_f32_16x16x32_bf16 v[100:103],a[136:139],a[80:83],v[100:103]
ds_read_b64_tr_b16 a[138:139],v2 offset:6272
v_exp_f32 v98,v98
v_mfma_f32_16x16x32_bf16 v[100:103],a[140:143],a[84:87],v[100:103]
ds_read_b64_tr_b16 a[136:137],v2 offset:128
v_fma_f32 v96,v96,s36,v16
v_mfma_f32_16x16x32_bf16 v[100:103],a[144:147],a[88:91],v[100:103]
s_waitcnt lgkmcnt(5)
ds_read_b64_tr_b16 a[142:143],v3 offset:6272
v_exp_f32 v96,v96
v_mfma_f32_16x16x32_bf16 v[100:103],a[148:151],a[92:95],v[100:103]
ds_read_b64_tr_b16 a[134:135],v5 offset:6144
v_exp_f32 v97,v97
v_mfma_f32_16x16x32_bf16 a[160:163],a[120:123],v[32:35],0
ds_read_b64_tr_b16 a[146:147],v4 offset:6272
v_cvt_pk_bf16_f32 v56,v96,v97
v_mfma_f32_16x16x32_bf16 a[164:167],a[124:127],v[32:35],0
s_waitcnt lgkmcnt(5)
ds_read_b64_tr_b16 a[120:121],v2 offset:256
v_fma_f32 v99,v99,s36,v16
v_mfma_f32_16x16x32_bf16 a[168:171],a[128:131],v[32:35],0
ds_read_b64_tr_b16 a[150:151],v5 offset:6272
ds_read_b64_tr_b16 a[144:145],v4 offset:128
ds_read_b64_tr_b16 a[148:149],v5 offset:128
ds_read_b64_tr_b16 a[126:127],v3 offset:6400
ds_read_b64_tr_b16 a[124:125],v3 offset:256
ds_read_b64_tr_b16 a[128:129],v4 offset:256
ds_read_b64_tr_b16 a[140:141],v3 offset:128
ds_read_b64_tr_b16 a[122:123],v2 offset:6400
v_exp_f32 v99,v99
s_waitcnt lgkmcnt(10)
v_mfma_f32_16x16x32_bf16 a[172:175],a[132:135],v[32:35],0
ds_read_b64_tr_b16 a[134:135],v5 offset:6400
v_cvt_pk_bf16_f32 v57,v98,v99
ds_read_b64_tr_b16 a[130:131],v4 offset:6400
v_mfma_f32_16x16x32_bf16 a[176:179],a[136:139],v[32:35],0
ds_read_b128 a[136:139],v0 offset:24576
v_fma_f32 v102,v102,s36,v16
ds_read_b64_tr_b16 a[132:133],v5 offset:256
v_fma_f32 v103,v103,s36,v16
v_exp_f32 v103,v103
v_exp_f32 v102,v102
v_fma_f32 v101,v101,s36,v16
v_exp_f32 v101,v101
v_cvt_pk_bf16_f32 v59,v102,v103
v_fma_f32 v100,v100,s36,v16
v_exp_f32 v100,v100
s_waitcnt lgkmcnt(4)
v_mfma_f32_16x16x32_bf16 a[180:183],a[140:143],v[32:35],0
ds_read_b128 a[140:143],v1 offset:24576
v_cvt_pk_bf16_f32 v58,v100,v101
v_mfma_f32_16x16x32_bf16 a[184:187],a[144:147],v[32:35],0
ds_read_b128 a[144:147],v0 offset:24704
v_cvt_pk_bf16_f32 v28,v88,v89
v_smfmac_f32_16x16x64_bf16 v[64:67],a[152:155],v[52:59],v18
v_mfma_f32_16x16x32_bf16 a[188:191],a[148:151],v[32:35],0
ds_read_b128 a[148:151],v1 offset:24704
v_mfma_f32_16x16x32_bf16 a[192:195],a[120:123],v[32:35],0
ds_read_b128 a[120:123],v0 offset:24832
v_mfma_f32_16x16x32_bf16 a[196:199],a[124:127],v[32:35],0
s_waitcnt lgkmcnt(4)
ds_read_b128 a[124:127],v1 offset:24832
v_mfma_f32_16x16x32_bf16 a[200:203],a[128:131],v[32:35],0
ds_read_b128 a[128:131],v0 offset:30720
v_mfma_f32_16x16x32_bf16 a[204:207],a[132:135],v[32:35],0
ds_read_b128 a[132:135],v1 offset:30720
v_mfma_f32_16x16x32_bf16 v[96:99],a[136:139],a[72:75],0
s_waitcnt lgkmcnt(5)
ds_read_b128 a[136:139],v0 offset:30848
v_mfma_f32_16x16x32_bf16 v[96:99],a[140:143],a[76:79],v[96:99]
ds_read_b128 a[140:143],v1 offset:30848
v_mfma_f32_16x16x32_bf16 v[96:99],a[144:147],a[80:83],v[96:99]
s_waitcnt lgkmcnt(6)
ds_read_b128 a[144:147],v0 offset:30976
v_mfma_f32_16x16x32_bf16 v[96:99],a[148:151],a[84:87],v[96:99]
s_waitcnt lgkmcnt(6)
ds_read_b128 a[148:151],v1 offset:30976
v_mfma_f32_16x16x32_bf16 v[96:99],a[120:123],a[88:91],v[96:99]
s_waitcnt lgkmcnt(6)
ds_read_b128 a[120:123],v0 offset:0
v_mfma_f32_16x16x32_bf16 v[96:99],a[124:127],a[92:95],v[96:99]
s_waitcnt lgkmcnt(6)
ds_read_b128 a[124:127],v1 offset:0
v_mfma_f32_16x16x32_bf16 v[100:103],a[128:131],a[72:75],0
s_waitcnt lgkmcnt(6)
ds_read_b128 a[128:131],v0 offset:128
v_mfma_f32_16x16x32_bf16 v[100:103],a[132:135],a[76:79],v[100:103]
s_waitcnt lgkmcnt(6)
ds_read_b128 a[132:135],v1 offset:128
v_mfma_f32_16x16x32_bf16 v[100:103],a[136:139],a[80:83],v[100:103]
s_waitcnt lgkmcnt(6)
ds_read_b128 a[136:139],v0 offset:256
v_mfma_f32_16x16x32_bf16 v[100:103],a[140:143],a[84:87],v[100:103]
s_waitcnt lgkmcnt(6)
ds_read_b128 a[140:143],v1 offset:256
v_mfma_f32_16x16x32_bf16 v[100:103],a[144:147],a[88:91],v[100:103]
s_waitcnt lgkmcnt(6)
ds_read_b128 a[144:147],v0 offset:6144
v_mfma_f32_16x16x32_bf16 v[100:103],a[148:151],a[92:95],v[100:103]
s_waitcnt vmcnt(3)
ds_read_b128 a[96:99],v11 offset:6144
buffer_load_dwordx4 v6,s[8:11],s21 offen offset:0 lds
ds_read_b128 a[108:111],v12 offset:6272
buffer_load_dwordx4 v7,s[8:11],s21 offen offset:1024 lds
ds_read_b128 a[104:107],v11 offset:6272
buffer_load_dwordx4 v8,s[8:11],s21 offen offset:2048 lds
s_add_u32 s21,s21,12288
ds_read_b128 a[100:103],v12 offset:6144
s_add_u32 m0,s22,0
ds_read_b128 a[112:115],v11 offset:6400
ds_read_b128 a[116:119],v12 offset:6400
ds_read_b128 a[148:151],v1 offset:6144
s_waitcnt lgkmcnt(6)
v_mfma_f32_16x16x32_bf16 v[104:107],a[120:123],a[96:99],0
s_waitcnt lgkmcnt(3)
ds_read_b128 a[120:123],v0 offset:6272
v_mfma_f32_16x16x32_bf16 v[104:107],a[124:127],a[100:103],v[104:107]
ds_read_b128 a[124:127],v1 offset:6272
v_mfma_f32_16x16x32_bf16 v[104:107],a[128:131],a[104:107],v[104:107]
ds_read_b128 a[128:131],v0 offset:6400
v_mfma_f32_16x16x32_bf16 v[104:107],a[132:135],a[108:111],v[104:107]
ds_read_b128 a[132:135],v1 offset:6400
s_waitcnt vmcnt(3)
s_waitcnt lgkmcnt(6)
v_mfma_f32_16x16x32_bf16 v[104:107],a[136:139],a[112:115],v[104:107]
s_waitcnt lgkmcnt(5)
v_mfma_f32_16x16x32_bf16 v[104:107],a[140:143],a[116:119],v[104:107]
v_mfma_f32_16x16x32_bf16 v[108:111],a[144:147],a[96:99],0
s_waitcnt lgkmcnt(4)
v_mfma_f32_16x16x32_bf16 v[108:111],a[148:151],a[100:103],v[108:111]
s_waitcnt lgkmcnt(3)
v_mfma_f32_16x16x32_bf16 v[108:111],a[120:123],a[104:107],v[108:111]
s_waitcnt lgkmcnt(2)
v_mfma_f32_16x16x32_bf16 v[108:111],a[124:127],a[108:111],v[108:111]
s_waitcnt lgkmcnt(1)
v_mfma_f32_16x16x32_bf16 v[108:111],a[128:131],a[112:115],v[108:111]
s_waitcnt lgkmcnt(0)
v_mfma_f32_16x16x32_bf16 v[108:111],a[132:135],a[116:119],v[108:111]
s_barrier
buffer_load_dwordx4 v6,s[4:7],s20 offen offset:0 lds
buffer_load_dwordx4 v7,s[4:7],s20 offen offset:1024 lds
buffer_load_dwordx4 v8,s[4:7],s20 offen offset:2048 lds
ds_read_b128 a[148:151],v1 offset:12416
v_max3_f32 v40,v104,v105,v106
ds_read_b128 a[140:143],v1 offset:12288
s_add_u32 s20,s20,12288
ds_read_b128 a[124:127],v1 offset:12544
v_max3_f32 v40,v40,v107,v108
ds_read_b128 a[136:139],v0 offset:12288
v_max3_f32 v40,v40,v109,v110
ds_read_b128 a[144:147],v0 offset:12416
v_max_f32 v40,v40,v111
ds_read_b128 a[120:123],v0 offset:12544
v_mov_b32 v41,v40
ds_read_b128 a[132:135],v1 offset:18432
s_mov_b32 s27,166723584
ds_read_b128 a[128:131],v0 offset:18432
v_permlane32_swap_b32 v41,v40
v_max_f32 v40,v40,v41
v_mov_b32 v41,v40
s_mov_b32 s42,s41
s_add_u32 s69,s69,1
v_permlane16_swap_b32 v41,v40
v_max_f32 v40,v40,v41
v_mul_f32_e64 v17,-s36,v40
v_fma_f32 v105,v105,s36,v17
v_fma_f32 v104,v104,s36,v17
v_fma_f32 v106,v106,s36,v17
v_fma_f32 v107,v107,s36,v17
v_exp_f32 v105,v105
v_exp_f32 v107,v107
v_exp_f32 v104,v104
v_exp_f32 v106,v106
v_cvt_pk_bf16_f32 v36,v104,v105
v_fma_f32 v110,v110,s36,v17
v_cvt_pk_bf16_f32 v37,v106,v107
s_waitcnt lgkmcnt(2)
v_mfma_f32_16x16x32_bf16 v[104:107],a[136:139],a[96:99],0
s_lshl_b32 s62,s69,5
ds_read_b128 a[136:139],v0 offset:18560
v_fma_f32 v109,v109,s36,v17
v_mfma_f32_16x16x32_bf16 v[104:107],a[140:143],a[100:103],v[104:107]
s_add_u32 s62,s62,s34
ds_read_b128 a[140:143],v1 offset:18560
v_exp_f32 v109,v109
v_mfma_f32_16x16x32_bf16 v[104:107],a[144:147],a[104:107],v[104:107]
s_mul_i32 s63,s62,171
ds_read_b128 a[144:147],v0 offset:18688
v_exp_f32 v110,v110
v_mfma_f32_16x16x32_bf16 v[104:107],a[148:151],a[108:111],v[104:107]
s_lshr_b32 s63,s63,9
ds_read_b128 a[148:151],v1 offset:18688
v_fma_f32 v108,v108,s36,v17
v_mfma_f32_16x16x32_bf16 v[104:107],a[120:123],a[112:115],v[104:107]
s_mul_i32 s64,s63,3
ds_read_b64_tr_b16 a[122:123],v2 offset:6144
v_exp_f32 v108,v108
v_mfma_f32_16x16x32_bf16 v[104:107],a[124:127],a[116:119],v[104:107]
s_sub_u32 s62,s62,s64
ds_read_b64_tr_b16 a[120:121],v2 offset:0
ds_read_b64_tr_b16 a[126:127],v3 offset:6144
ds_read_b64_tr_b16 a[124:125],v3 offset:0
v_cvt_pk_bf16_f32 v38,v108,v109
v_fma_f32 v111,v111,s36,v17
v_exp_f32 v111,v111
s_add_u32 s63,s63,s33
v_cvt_pk_bf16_f32 v39,v110,v111
s_waitcnt lgkmcnt(7)
v_mfma_f32_16x16x32_bf16 v[108:111],a[128:131],a[96:99],0
s_mul_i32 s30,s63,196608
ds_read_b64_tr_b16 a[130:131],v4 offset:6144
v_fma_f32 v107,v107,s36,v17
v_mfma_f32_16x16x32_bf16 v[108:111],a[132:135],a[100:103],v[108:111]
s_mul_i32 s41,s63,325632
ds_read_b64_tr_b16 a[134:135],v5 offset:6144
v_exp_f32 v107,v107
v_mfma_f32_16x16x32_bf16 v[108:111],a[136:139],a[104:107],v[108:111]
s_lshl_b32 s63,s3,2
ds_read_b64_tr_b16 a[132:133],v5 offset:0
v_fma_f32 v104,v104,s36,v17
s_waitcnt lgkmcnt(7)
v_mfma_f32_16x16x32_bf16 v[108:111],a[140:143],a[108:111],v[108:111]
s_add_u32 s64,s63,21
ds_read_b64_tr_b16 a[128:129],v4 offset:0
v_fma_f32 v105,v105,s36,v17
v_mfma_f32_16x16x32_bf16 v[108:111],a[144:147],a[112:115],v[108:111]
s_cmp_eq_u32 s3,0
ds_read_b64_tr_b16 a[142:143],v3 offset:6272
v_exp_f32 v105,v105
v_mfma_f32_16x16x32_bf16 v[108:111],a[148:151],a[116:119],v[108:111]
s_cselect_b32 s64,20,s64
ds_read_b64_tr_b16 a[146:147],v4 offset:6272
v_fma_f32 v106,v106,s36,v17
s_waitcnt lgkmcnt(6)
v_mfma_f32_16x16x32_bf16 a[208:211],a[120:123],v[36:39],0
s_cselect_b32 s40,1,0
ds_read_b64_tr_b16 a[138:139],v2 offset:6272
v_exp_f32 v104,v104
v_mfma_f32_16x16x32_bf16 a[212:215],a[124:127],v[36:39],0
s_add_u32 s65,s63,37
ds_read_b64_tr_b16 a[124:125],v3 offset:256
ds_read_b64_tr_b16 a[136:137],v2 offset:128
ds_read_b64_tr_b16 a[144:145],v4 offset:128
ds_read_b64_tr_b16 a[122:123],v2 offset:6400
ds_read_b64_tr_b16 a[148:149],v5 offset:128
ds_read_b64_tr_b16 a[140:141],v3 offset:128
v_cvt_pk_bf16_f32 v40,v104,v105
ds_read_b64_tr_b16 a[150:151],v5 offset:6272
s_waitcnt lgkmcnt(10)
v_mfma_f32_16x16x32_bf16 a[216:219],a[128:131],v[36:39],0
s_cmp_eq_u32 s62,2
ds_read_b64_tr_b16 a[128:129],v4 offset:256
ds_read_b64_tr_b16 a[120:121],v2 offset:256
v_mfma_f32_16x16x32_bf16 a[220:223],a[132:135],v[36:39],0
s_cselect_b32 s64,s65,s64
ds_read_b64_tr_b16 a[134:135],v5 offset:6400
ds_read_b64_tr_b16 a[132:133],v5 offset:256
ds_read_b64_tr_b16 a[126:127],v3 offset:6400
ds_read_b64_tr_b16 a[130:131],v4 offset:6400
s_waitcnt vmcnt(6)
v_exp_f32 v106,v106
s_waitcnt lgkmcnt(11)
v_mfma_f32_16x16x32_bf16 a[224:227],a[136:139],v[36:39],0
s_cselect_b32 s40,0,s40
v_cvt_pk_bf16_f32 v41,v106,v107
v_fma_f32 v108,v108,s36,v17
v_exp_f32 v108,v108
v_fma_f32 v110,v110,s36,v17
v_exp_f32 v110,v110
s_waitcnt lgkmcnt(7)
v_mfma_f32_16x16x32_bf16 a[228:231],a[140:143],v[36:39],0
s_add_u32 s65,s63,s3
v_fma_f32 v111,v111,s36,v17
v_exp_f32 v111,v111
v_mfma_f32_16x16x32_bf16 a[232:235],a[144:147],v[36:39],0
s_cmp_eq_u32 s62,0
v_fma_f32 v109,v109,s36,v17
v_exp_f32 v109,v109
s_waitcnt lgkmcnt(4)
v_mfma_f32_16x16x32_bf16 a[236:239],a[148:151],v[36:39],0
s_cselect_b32 s64,s65,s64
v_cvt_pk_bf16_f32 v42,v108,v109
v_cvt_pk_bf16_f32 v43,v110,v111
v_mfma_f32_16x16x32_bf16 a[240:243],a[120:123],v[36:39],0
s_cselect_b32 s40,1,s40
s_mul_i32 s64,s64,6144
s_waitcnt lgkmcnt(0)
s_barrier
v_smfmac_f32_16x16x64_bf16 v[68:71],a[152:155],v[36:43],v18
s_add_u32 s41,s41,s64
s_cmp_ge_u32 s69,6
ds_read_b128 a[144:147],v0 offset:24704
v_mfma_f32_16x16x32_bf16 a[244:247],a[124:127],v[36:39],0
s_cselect_b32 s41,166723584,s41
s_cselect_b32 s30,100663296,s30
ds_read_b128 a[136:139],v0 offset:24576
v_mfma_f32_16x16x32_bf16 a[248:251],a[128:131],v[36:39],0
s_add_u32 s25,s30,s22
s_add_u32 s26,s25,12288
ds_read_b128 a[120:123],v0 offset:24832
v_mfma_f32_16x16x32_bf16 a[252:255],a[132:135],v[36:39],0
s_mov_b32 s28,s41
ds_read_b128 a[124:127],v1 offset:24832
s_mov_b32 s29,s24
ds_read_b128 a[140:143],v1 offset:24576
s_add_u32 m0,s23,0
ds_read_b128 a[148:151],v1 offset:24704
buffer_load_dwordx4 v6,s[8:11],s21 offen offset:0 lds
buffer_load_dwordx4 v7,s[8:11],s21 offen offset:1024 lds
buffer_load_dwordx4 v8,s[8:11],s21 offen offset:2048 lds
ds_read_b128 a[128:131],v0 offset:30720
s_add_u32 s21,s21,12288
ds_read_b128 a[132:135],v1 offset:30720
s_waitcnt lgkmcnt(6)
v_mfma_f32_16x16x32_bf16 v[104:107],a[136:139],a[96:99],0
s_add_u32 m0,s22,12288
ds_read_b128 a[136:139],v0 offset:30848
buffer_load_dwordx4 v6,s[4:7],s20 offen offset:0 lds
buffer_load_dwordx4 v7,s[4:7],s20 offen offset:1024 lds
buffer_load_dwordx4 v8,s[4:7],s20 offen offset:2048 lds
s_waitcnt lgkmcnt(4)
v_mfma_f32_16x16x32_bf16 v[104:107],a[140:143],a[100:103],v[104:107]
s_add_u32 s20,s20,12288
ds_read_b128 a[140:143],v1 offset:30848
v_mfma_f32_16x16x32_bf16 v[104:107],a[144:147],a[104:107],v[104:107]
s_waitcnt lgkmcnt(4)
ds_read_b128 a[144:147],v0 offset:30976
v_mfma_f32_16x16x32_bf16 v[104:107],a[148:151],a[108:111],v[104:107]
ds_read_b128 a[148:151],v1 offset:30976
v_mfma_f32_16x16x32_bf16 v[104:107],a[120:123],a[112:115],v[104:107]
ds_read_b64_tr_b16 a[120:121],v2 offset:12288
v_mfma_f32_16x16x32_bf16 v[104:107],a[124:127],a[116:119],v[104:107]
s_waitcnt lgkmcnt(4)
ds_read_b64_tr_b16 a[124:125],v3 offset:12288
v_mfma_f32_16x16x32_bf16 v[108:111],a[128:131],a[96:99],0
ds_read_b64_tr_b16 a[126:127],v3 offset:18432
v_mfma_f32_16x16x32_bf16 v[108:111],a[132:135],a[100:103],v[108:111]
ds_read_b64_tr_b16 a[122:123],v2 offset:18432
v_mfma_f32_16x16x32_bf16 v[108:111],a[136:139],a[104:107],v[108:111]
s_waitcnt lgkmcnt(6)
ds_read_b64_tr_b16 a[128:129],v4 offset:12288
v_mfma_f32_16x16x32_bf16 v[108:111],a[140:143],a[108:111],v[108:111]
s_waitcnt lgkmcnt(6)
ds_read_b64_tr_b16 a[130:131],v4 offset:18432
v_mfma_f32_16x16x32_bf16 v[108:111],a[144:147],a[112:115],v[108:111]
s_waitcnt lgkmcnt(6)
ds_read_b64_tr_b16 a[132:133],v5 offset:12288
v_mfma_f32_16x16x32_bf16 v[108:111],a[148:151],a[116:119],v[108:111]
s_waitcnt lgkmcnt(3)
ds_read_b64_tr_b16 a[134:135],v5 offset:18432
v_mfma_f32_16x16x32_bf16 v[160:163],a[120:123],v[44:47],v[160:163]
s_add_u32 m0,s23,12288
ds_read_b64_tr_b16 a[136:137],v2 offset:12416
v_fma_f32 v90,v90,s36,v15
v_mfma_f32_16x16x32_bf16 v[164:167],a[124:127],v[44:47],v[164:167]
ds_read_b64_tr_b16 a[138:139],v2 offset:18560
v_fma_f32 v91,v91,s36,v15
v_mfma_f32_16x16x32_bf16 v[212:215],a[124:127],v[48:51],v[212:215]
ds_read_b64_tr_b16 a[140:141],v3 offset:12416
v_fma_f32 v96,v96,s36,v16
v_mfma_f32_16x16x32_bf16 v[208:211],a[120:123],v[48:51],v[208:211]
ds_read_b64_tr_b16 a[142:143],v3 offset:18560
v_fma_f32 v97,v97,s36,v16
v_mfma_f32_16x16x32_bf16 v[112:115],a[120:123],v[52:55],v[112:115]
ds_read_b64_tr_b16 a[144:145],v4 offset:12416
v_fma_f32 v98,v98,s36,v16
v_mfma_f32_16x16x32_bf16 v[116:119],a[124:127],v[52:55],v[116:119]
ds_read_b64_tr_b16 a[146:147],v4 offset:18560
v_fma_f32 v99,v99,s36,v16
v_mfma_f32_16x16x32_bf16 a[164:167],a[124:127],v[56:59],a[164:167]
ds_read_b64_tr_b16 a[148:149],v5 offset:12416
v_fma_f32 v104,v104,s36,v17
v_mfma_f32_16x16x32_bf16 a[160:163],a[120:123],v[56:59],a[160:163]
ds_read_b64_tr_b16 a[150:151],v5 offset:18560
v_fma_f32 v105,v105,s36,v17
v_mfma_f32_16x16x32_bf16 a[208:211],a[120:123],v[40:43],a[208:211]
ds_read_b64_tr_b16 a[120:121],v2 offset:12544
v_fma_f32 v106,v106,s36,v17
v_mfma_f32_16x16x32_bf16 a[212:215],a[124:127],v[40:43],a[212:215]
s_waitcnt lgkmcnt(6)
ds_read_b64_tr_b16 a[122:123],v2 offset:18688
v_fma_f32 v107,v107,s36,v17
v_mfma_f32_16x16x32_bf16 a[216:219],a[128:131],v[40:43],a[216:219]
ds_read_b64_tr_b16 a[124:125],v3 offset:12544
v_fma_f32 v76,v76,s36,v13
v_mfma_f32_16x16x32_bf16 a[220:223],a[132:135],v[40:43],a[220:223]
ds_read_b64_tr_b16 a[126:127],v3 offset:18688
v_fma_f32 v77,v77,s36,v13
v_mfma_f32_16x16x32_bf16 a[172:175],a[132:135],v[56:59],a[172:175]
v_exp_f32 v90,v90
v_mfma_f32_16x16x32_bf16 a[168:171],a[128:131],v[56:59],a[168:171]
v_exp_f32 v91,v91
v_mfma_f32_16x16x32_bf16 v[120:123],a[128:131],v[52:55],v[120:123]
v_cvt_pk_bf16_f32 v29,v90,v91
v_fma_f32 v78,v78,s36,v13
v_mfma_f32_16x16x32_bf16 v[124:127],a[132:135],v[52:55],v[124:127]
v_exp_f32 v96,v96
v_mfma_f32_16x16x32_bf16 v[220:223],a[132:135],v[48:51],v[220:223]
v_exp_f32 v97,v97
v_mfma_f32_16x16x32_bf16 v[216:219],a[128:131],v[48:51],v[216:219]
v_exp_f32 v98,v98
v_mfma_f32_16x16x32_bf16 v[168:171],a[128:131],v[44:47],v[168:171]
ds_read_b64_tr_b16 a[128:129],v4 offset:12544
v_cvt_pk_bf16_f32 v32,v96,v97
v_mfma_f32_16x16x32_bf16 v[172:175],a[132:135],v[44:47],v[172:175]
ds_read_b64_tr_b16 a[130:131],v4 offset:18688
v_fma_f32 v79,v79,s36,v13
v_mfma_f32_16x16x32_bf16 v[176:179],a[136:139],v[44:47],v[176:179]
s_waitcnt lgkmcnt(2)
ds_read_b64_tr_b16 a[132:133],v5 offset:12544
v_fma_f32 v84,v84,s36,v14
v_mfma_f32_16x16x32_bf16 v[180:183],a[140:143],v[44:47],v[180:183]
ds_read_b64_tr_b16 a[134:135],v5 offset:18688
v_fma_f32 v85,v85,s36,v14
v_mfma_f32_16x16x32_bf16 v[228:231],a[140:143],v[48:51],v[228:231]
v_exp_f32 v99,v99
v_mfma_f32_16x16x32_bf16 v[224:227],a[136:139],v[48:51],v[224:227]
v_cvt_pk_bf16_f32 v33,v98,v99
v_fma_f32 v86,v86,s36,v14
v_mfma_f32_16x16x32_bf16 v[128:131],a[136:139],v[52:55],v[128:131]
v_exp_f32 v104,v104
v_mfma_f32_16x16x32_bf16 v[132:135],a[140:143],v[52:55],v[132:135]
v_exp_f32 v105,v105
v_mfma_f32_16x16x32_bf16 a[180:183],a[140:143],v[56:59],a[180:183]
v_exp_f32 v106,v106
v_mfma_f32_16x16x32_bf16 a[176:179],a[136:139],v[56:59],a[176:179]
v_exp_f32 v107,v107
v_mfma_f32_16x16x32_bf16 a[224:227],a[136:139],v[40:43],a[224:227]
v_cvt_pk_bf16_f32 v36,v104,v105
v_cvt_pk_bf16_f32 v37,v106,v107
v_mfma_f32_16x16x32_bf16 a[228:231],a[140:143],v[40:43],a[228:231]
v_exp_f32 v76,v76
v_mfma_f32_16x16x32_bf16 a[232:235],a[144:147],v[40:43],a[232:235]
v_exp_f32 v77,v77
v_mfma_f32_16x16x32_bf16 a[236:239],a[148:151],v[40:43],a[236:239]
v_exp_f32 v78,v78
v_mfma_f32_16x16x32_bf16 a[188:191],a[148:151],v[56:59],a[188:191]
v_exp_f32 v79,v79
v_mfma_f32_16x16x32_bf16 a[184:187],a[144:147],v[56:59],a[184:187]
v_cvt_pk_bf16_f32 v22,v76,v77
v_cvt_pk_bf16_f32 v23,v78,v79
v_mfma_f32_16x16x32_bf16 v[136:139],a[144:147],v[52:55],v[136:139]
v_fma_f32 v87,v87,s36,v14
v_fma_f32 v92,v92,s36,v15
v_mfma_f32_16x16x32_bf16 v[140:143],a[148:151],v[52:55],v[140:143]
v_exp_f32 v84,v84
v_mfma_f32_16x16x32_bf16 v[236:239],a[148:151],v[48:51],v[236:239]
v_exp_f32 v85,v85
v_mfma_f32_16x16x32_bf16 v[232:235],a[144:147],v[48:51],v[232:235]
v_exp_f32 v86,v86
v_mfma_f32_16x16x32_bf16 v[184:187],a[144:147],v[44:47],v[184:187]
v_exp_f32 v87,v87
v_mfma_f32_16x16x32_bf16 v[188:191],a[148:151],v[44:47],v[188:191]
v_cvt_pk_bf16_f32 v26,v84,v85
v_cvt_pk_bf16_f32 v27,v86,v87
v_mfma_f32_16x16x32_bf16 v[192:195],a[120:123],v[44:47],v[192:195]
v_fma_f32 v93,v93,s36,v15
v_fma_f32 v94,v94,s36,v15
v_smfmac_f32_16x16x64_bf16 v[60:63],a[152:155],v[20:27],v18
v_fma_f32 v95,v95,s36,v15
v_mfma_f32_16x16x32_bf16 v[196:199],a[124:127],v[44:47],v[196:199]
s_waitcnt vmcnt(6) lgkmcnt(0)
v_exp_f32 v92,v92
v_mfma_f32_16x16x32_bf16 v[244:247],a[124:127],v[48:51],v[244:247]
s_barrier
v_mfma_f32_16x16x32_bf16 v[240:243],a[120:123],v[48:51],v[240:243]
ds_read_b128 a[136:139],v0 offset:0
v_fma_f32 v100,v100,s36,v16
v_mfma_f32_16x16x32_bf16 v[144:147],a[120:123],v[52:55],v[144:147]
ds_read_b128 a[140:143],v1 offset:0
v_fma_f32 v101,v101,s36,v16
v_mfma_f32_16x16x32_bf16 v[148:151],a[124:127],v[52:55],v[148:151]
ds_read_b128 a[144:147],v0 offset:128
v_fma_f32 v102,v102,s36,v16
v_mfma_f32_16x16x32_bf16 a[196:199],a[124:127],v[56:59],a[196:199]
ds_read_b128 a[148:151],v1 offset:128
v_fma_f32 v103,v103,s36,v16
v_mfma_f32_16x16x32_bf16 a[192:195],a[120:123],v[56:59],a[192:195]
v_exp_f32 v93,v93
v_mfma_f32_16x16x32_bf16 a[240:243],a[120:123],v[40:43],a[240:243]
buffer_load_dwordx4 v6,s[8:11],s21 offen offset:0 lds
v_mfma_f32_16x16x32_bf16 a[244:247],a[124:127],v[40:43],a[244:247]
ds_read_b128 a[120:123],v0 offset:256
v_cvt_pk_bf16_f32 v30,v92,v93
v_mfma_f32_16x16x32_bf16 a[248:251],a[128:131],v[40:43],a[248:251]
ds_read_b128 a[124:127],v1 offset:256
v_fma_f32 v108,v108,s36,v17
v_mfma_f32_16x16x32_bf16 a[252:255],a[132:135],v[40:43],a[252:255]
v_exp_f32 v94,v94
v_mfma_f32_16x16x32_bf16 a[204:207],a[132:135],v[56:59],a[204:207]
v_exp_f32 v95,v95
v_mfma_f32_16x16x32_bf16 a[200:203],a[128:131],v[56:59],a[200:203]
v_cvt_pk_bf16_f32 v31,v94,v95
v_fma_f32 v109,v109,s36,v17
v_mfma_f32_16x16x32_bf16 v[152:155],a[128:131],v[52:55],v[152:155]
v_exp_f32 v100,v100
v_mfma_f32_16x16x32_bf16 v[156:159],a[132:135],v[52:55],v[156:159]
v_exp_f32 v101,v101
v_mfma_f32_16x16x32_bf16 v[252:255],a[132:135],v[48:51],v[252:255]
v_exp_f32 v102,v102
v_mfma_f32_16x16x32_bf16 v[248:251],a[128:131],v[48:51],v[248:251]
v_exp_f32 v103,v103
v_mfma_f32_16x16x32_bf16 v[200:203],a[128:131],v[44:47],v[200:203]
ds_read_b128 a[128:131],v0 offset:6144
v_cvt_pk_bf16_f32 v34,v100,v101
v_mfma_f32_16x16x32_bf16 v[204:207],a[132:135],v[44:47],v[204:207]
buffer_load_dwordx4 v7,s[8:11],s21 offen offset:1024 lds
s_waitcnt lgkmcnt(1)
v_mfma_f32_16x16x32_bf16 v[72:75],a[136:139],a[0:3],0
ds_read_b128 a[132:135],v1 offset:6144
v_cvt_pk_bf16_f32 v35,v102,v103
v_mfma_f32_16x16x32_bf16 v[72:75],a[140:143],a[4:7],v[72:75]
v_fma_f32 v110,v110,s36,v17
v_fma_f32 v111,v111,s36,v17
v_smfmac_f32_16x16x64_bf16 v[64:67],a[152:155],v[28:35],v18
v_mfma_f32_16x16x32_bf16 v[72:75],a[144:147],a[8:11],v[72:75]
v_exp_f32 v108,v108
v_mfma_f32_16x16x32_bf16 v[72:75],a[148:151],a[12:15],v[72:75]
v_exp_f32 v109,v109
v_mfma_f32_16x16x32_bf16 v[72:75],a[120:123],a[16:19],v[72:75]
v_exp_f32 v110,v110
v_mfma_f32_16x16x32_bf16 v[72:75],a[124:127],a[20:23],v[72:75]
v_exp_f32 v111,v111
v_mfma_f32_16x16x32_bf16 v[80:83],a[124:127],a[44:47],0
v_cvt_pk_bf16_f32 v38,v108,v109
v_cvt_pk_bf16_f32 v39,v110,v111
v_mfma_f32_16x16x32_bf16 v[80:83],a[120:123],a[40:43],v[80:83]
v_mfma_f32_16x16x32_bf16 v[80:83],a[148:151],a[36:39],v[80:83]
v_mfma_f32_16x16x32_bf16 v[80:83],a[144:147],a[32:35],v[80:83]
buffer_load_dwordx4 v8,s[8:11],s21 offen offset:2048 lds
v_mfma_f32_16x16x32_bf16 v[80:83],a[140:143],a[28:31],v[80:83]
s_add_u32 s21,s21,12288
v_fma_f32 v72,v72,s36,v13
v_fma_f32 v73,v73,s36,v13
v_mfma_f32_16x16x32_bf16 v[80:83],a[136:139],a[24:27],v[80:83]
s_add_u32 m0,s22,24576
v_fma_f32 v74,v74,s36,v13
v_fma_f32 v75,v75,s36,v13
v_mfma_f32_16x16x32_bf16 v[88:91],a[136:139],a[48:51],0
v_exp_f32 v72,v72
v_mfma_f32_16x16x32_bf16 v[88:91],a[140:143],a[52:55],v[88:91]
v_exp_f32 v73,v73
v_mfma_f32_16x16x32_bf16 v[88:91],a[144:147],a[56:59],v[88:91]
v_fma_f32 v80,v80,s36,v14
v_fma_f32 v81,v81,s36,v14
v_mfma_f32_16x16x32_bf16 v[88:91],a[148:151],a[60:63],v[88:91]
v_fma_f32 v82,v82,s36,v14
v_fma_f32 v83,v83,s36,v14
v_mfma_f32_16x16x32_bf16 v[88:91],a[120:123],a[64:67],v[88:91]
v_exp_f32 v74,v74
v_mfma_f32_16x16x32_bf16 v[88:91],a[124:127],a[68:71],v[88:91]
v_exp_f32 v75,v75
v_mfma_f32_16x16x32_bf16 v[96:99],a[124:127],a[92:95],0
v_exp_f32 v80,v80
v_mfma_f32_16x16x32_bf16 v[96:99],a[120:123],a[88:91],v[96:99]
v_exp_f32 v81,v81
v_mfma_f32_16x16x32_bf16 v[96:99],a[148:151],a[84:87],v[96:99]
v_exp_f32 v82,v82
v_mfma_f32_16x16x32_bf16 v[96:99],a[144:147],a[80:83],v[96:99]
buffer_load_dwordx4 v6,s[4:7],s20 offen offset:0 lds
v_mfma_f32_16x16x32_bf16 v[96:99],a[140:143],a[76:79],v[96:99]
v_fma_f32 v88,v88,s36,v15
v_fma_f32 v89,v89,s36,v15
v_mfma_f32_16x16x32_bf16 v[96:99],a[136:139],a[72:75],v[96:99]
v_exp_f32 v83,v83
v_mfma_f32_16x16x32_bf16 v[104:107],a[136:139],a[96:99],0
ds_read_b128 a[136:139],v0 offset:6272
v_cvt_pk_bf16_f32 v44,v72,v73
v_mfma_f32_16x16x32_bf16 v[104:107],a[140:143],a[100:103],v[104:107]
ds_read_b128 a[140:143],v1 offset:6272
v_cvt_pk_bf16_f32 v45,v74,v75
v_mfma_f32_16x16x32_bf16 v[104:107],a[144:147],a[104:107],v[104:107]
ds_read_b128 a[144:147],v0 offset:6400
v_cvt_pk_bf16_f32 v48,v80,v81
v_mfma_f32_16x16x32_bf16 v[104:107],a[148:151],a[108:111],v[104:107]
ds_read_b128 a[148:151],v1 offset:6400
v_cvt_pk_bf16_f32 v49,v82,v83
v_mfma_f32_16x16x32_bf16 v[104:107],a[120:123],a[112:115],v[104:107]
v_exp_f32 v88,v88
v_mfma_f32_16x16x32_bf16 v[104:107],a[124:127],a[116:119],v[104:107]
s_waitcnt lgkmcnt(4)
v_exp_f32 v89,v89
v_mfma_f32_16x16x32_bf16 v[76:79],a[128:131],a[0:3],0
v_cvt_pk_bf16_f32 v52,v88,v89
v_mfma_f32_16x16x32_bf16 v[76:79],a[132:135],a[4:7],v[76:79]
s_waitcnt lgkmcnt(3)
v_mfma_f32_16x16x32_bf16 v[76:79],a[136:139],a[8:11],v[76:79]
buffer_load_dwordx4 v7,s[4:7],s20 offen offset:1024 lds
s_waitcnt lgkmcnt(2)
v_mfma_f32_16x16x32_bf16 v[76:79],a[140:143],a[12:15],v[76:79]
s_waitcnt lgkmcnt(1)
v_mfma_f32_16x16x32_bf16 v[76:79],a[144:147],a[16:19],v[76:79]
s_waitcnt lgkmcnt(0)
v_mfma_f32_16x16x32_bf16 v[76:79],a[148:151],a[20:23],v[76:79]
v_mfma_f32_16x16x32_bf16 v[84:87],a[148:151],a[44:47],0
v_mfma_f32_16x16x32_bf16 v[84:87],a[144:147],a[40:43],v[84:87]
v_mfma_f32_16x16x32_bf16 v[84:87],a[140:143],a[36:39],v[84:87]
v_mfma_f32_16x16x32_bf16 v[84:87],a[136:139],a[32:35],v[84:87]
v_mfma_f32_16x16x32_bf16 v[84:87],a[132:135],a[28:31],v[84:87]
v_mfma_f32_16x16x32_bf16 v[84:87],a[128:131],a[24:27],v[84:87]
v_mfma_f32_16x16x32_bf16 v[92:95],a[128:131],a[48:51],0
v_mfma_f32_16x16x32_bf16 v[92:95],a[132:135],a[52:55],v[92:95]
buffer_load_dwordx4 v8,s[4:7],s20 offen offset:2048 lds
v_mfma_f32_16x16x32_bf16 v[92:95],a[136:139],a[56:59],v[92:95]
s_add_u32 s20,s20,12288
v_mfma_f32_16x16x32_bf16 v[92:95],a[140:143],a[60:63],v[92:95]
v_mfma_f32_16x16x32_bf16 v[92:95],a[144:147],a[64:67],v[92:95]
v_mfma_f32_16x16x32_bf16 v[92:95],a[148:151],a[68:71],v[92:95]
v_mfma_f32_16x16x32_bf16 v[100:103],a[148:151],a[92:95],0
v_mfma_f32_16x16x32_bf16 v[100:103],a[144:147],a[88:91],v[100:103]
ds_read_b64_tr_b16 a[120:121],v2 offset:24576
v_mfma_f32_16x16x32_bf16 v[100:103],a[140:143],a[84:87],v[100:103]
ds_read_b64_tr_b16 a[122:123],v2 offset:30720
v_mfma_f32_16x16x32_bf16 v[100:103],a[136:139],a[80:83],v[100:103]
ds_read_b64_tr_b16 a[124:125],v3 offset:24576
v_mfma_f32_16x16x32_bf16 v[100:103],a[132:135],a[76:79],v[100:103]
ds_read_b64_tr_b16 a[126:127],v3 offset:30720
v_mfma_f32_16x16x32_bf16 v[100:103],a[128:131],a[72:75],v[100:103]
v_mfma_f32_16x16x32_bf16 v[108:111],a[128:131],a[96:99],0
ds_read_b64_tr_b16 a[128:129],v4 offset:24576
v_mfma_f32_16x16x32_bf16 v[108:111],a[132:135],a[100:103],v[108:111]
ds_read_b64_tr_b16 a[130:131],v4 offset:30720
v_mfma_f32_16x16x32_bf16 v[108:111],a[136:139],a[104:107],v[108:111]
ds_read_b64_tr_b16 a[132:133],v5 offset:24576
v_mfma_f32_16x16x32_bf16 v[108:111],a[140:143],a[108:111],v[108:111]
ds_read_b64_tr_b16 a[134:135],v5 offset:30720
v_mfma_f32_16x16x32_bf16 v[108:111],a[144:147],a[112:115],v[108:111]
v_mfma_f32_16x16x32_bf16 v[108:111],a[148:151],a[116:119],v[108:111]
s_mov_b32 s38,0
s_branch L_loop5
L_start4:
s_add_u32 m0,s24,12288
s_waitcnt vmcnt(15)
ds_read_b128 a[0:3],v11 offset:0
buffer_load_dwordx4 v6,s[12:15],s28 offen offset:0 nt lds
ds_read_b128 a[4:7],v12 offset:0
buffer_load_dwordx4 v7,s[12:15],s28 offen offset:1024 nt lds
ds_read_b128 a[16:19],v11 offset:256
buffer_load_dwordx4 v8,s[12:15],s28 offen offset:2048 nt lds
s_add_u32 s28,s28,3072
s_add_u32 m0,s24,15360
ds_read_b128 a[20:23],v12 offset:256
buffer_load_dwordx4 v6,s[12:15],s28 offen offset:0 nt lds
ds_read_b128 a[8:11],v11 offset:128
buffer_load_dwordx4 v7,s[12:15],s28 offen offset:1024 nt lds
ds_read_b128 a[12:15],v12 offset:128
buffer_load_dwordx4 v8,s[12:15],s28 offen offset:2048 nt lds
s_add_u32 s28,s28,3072
s_add_u32 m0,s24,0
ds_read_b128 a[124:127],v1 offset:0
v_mov_b32 v60,0
ds_read_b128 a[120:123],v0 offset:0
v_mov_b32 v67,0
ds_read_b128 a[132:135],v1 offset:128
v_mov_b32 v65,0
ds_read_b128 a[136:139],v0 offset:256
v_mov_b32 v64,0
ds_read_b128 a[128:131],v0 offset:128
v_mov_b32 v66,0
ds_read_b128 a[140:143],v1 offset:256
v_mov_b32 v63,0
ds_read_b128 a[148:151],v1 offset:6144
v_mov_b32 v61,0
ds_read_b128 a[144:147],v0 offset:6144
v_mov_b32 v62,0
s_waitcnt lgkmcnt(6)
v_mfma_f32_16x16x32_bf16 v[72:75],a[120:123],a[0:3],0
ds_read_b128 a[120:123],v0 offset:6272
v_mfma_f32_16x16x32_bf16 v[72:75],a[124:127],a[4:7],v[72:75]
s_waitcnt lgkmcnt(4)
ds_read_b128 a[124:127],v1 offset:6272
v_mfma_f32_16x16x32_bf16 v[72:75],a[128:131],a[8:11],v[72:75]
ds_read_b128 a[128:131],v0 offset:6400
v_mfma_f32_16x16x32_bf16 v[72:75],a[132:135],a[12:15],v[72:75]
ds_read_b128 a[132:135],v1 offset:6400
v_mfma_f32_16x16x32_bf16 v[72:75],a[136:139],a[16:19],v[72:75]
s_waitcnt lgkmcnt(6)
ds_read_b128 a[136:139],v0 offset:12288
v_mfma_f32_16x16x32_bf16 v[72:75],a[140:143],a[20:23],v[72:75]
s_waitcnt lgkmcnt(5)
ds_read_b128 a[140:143],v1 offset:12288
v_mfma_f32_16x16x32_bf16 v[76:79],a[144:147],a[0:3],0
ds_read_b128 a[144:147],v0 offset:12416
v_mfma_f32_16x16x32_bf16 v[76:79],a[148:151],a[4:7],v[76:79]
s_waitcnt lgkmcnt(6)
ds_read_b128 a[148:151],v1 offset:12416
v_mfma_f32_16x16x32_bf16 v[76:79],a[120:123],a[8:11],v[76:79]
s_waitcnt lgkmcnt(6)
ds_read_b128 a[120:123],v0 offset:12544
v_mfma_f32_16x16x32_bf16 v[76:79],a[124:127],a[12:15],v[76:79]
s_waitcnt lgkmcnt(6)
ds_read_b128 a[124:127],v1 offset:12544
v_max3_f32 v44,v72,v73,v74
v_mfma_f32_16x16x32_bf16 v[76:79],a[128:131],a[16:19],v[76:79]
s_waitcnt lgkmcnt(6)
ds_read_b128 a[128:131],v0 offset:18432
v_mfma_f32_16x16x32_bf16 v[76:79],a[132:135],a[20:23],v[76:79]
ds_read_b128 a[132:135],v1 offset:18432
s_nop 6
v_max3_f32 v44,v44,v75,v76
v_max3_f32 v44,v44,v77,v78
v_max_f32 v44,v44,v79
v_mov_b32 v45,v44
s_nop 1
v_permlane32_swap_b32 v45,v44
v_max_f32 v44,v44,v45
v_mov_b32 v45,v44
s_nop 1
v_permlane16_swap_b32 v45,v44
v_max_f32 v44,v44,v45
v_mul_f32_e64 v13,-s36,v44
v_fma_f32 v74,v74,s36,v13
v_exp_f32 v74,v74
v_fma_f32 v75,v75,s36,v13
v_exp_f32 v75,v75
v_fma_f32 v73,v73,s36,v13
v_exp_f32 v73,v73
v_cvt_pk_bf16_f32 v21,v74,v75
v_fma_f32 v72,v72,s36,v13
v_exp_f32 v72,v72
v_fma_f32 v78,v78,s36,v13
v_cvt_pk_bf16_f32 v20,v72,v73
s_waitcnt lgkmcnt(0)
v_mfma_f32_16x16x32_bf16 v[72:75],a[136:139],a[0:3],0
ds_read_b128 a[136:139],v0 offset:18560
v_fma_f32 v76,v76,s36,v13
v_mfma_f32_16x16x32_bf16 v[72:75],a[140:143],a[4:7],v[72:75]
ds_read_b128 a[140:143],v1 offset:18560
v_exp_f32 v76,v76
v_mfma_f32_16x16x32_bf16 v[72:75],a[144:147],a[8:11],v[72:75]
ds_read_b128 a[144:147],v0 offset:18688
v_fma_f32 v79,v79,s36,v13
v_mfma_f32_16x16x32_bf16 v[72:75],a[148:151],a[12:15],v[72:75]
ds_read_b128 a[148:151],v1 offset:18688
v_exp_f32 v79,v79
v_mfma_f32_16x16x32_bf16 v[72:75],a[120:123],a[16:19],v[72:75]
v_fma_f32 v77,v77,s36,v13
v_exp_f32 v78,v78
v_mfma_f32_16x16x32_bf16 v[72:75],a[124:127],a[20:23],v[72:75]
v_cvt_pk_bf16_f32 v23,v78,v79
v_exp_f32 v77,v77
s_nop 0
v_cvt_pk_bf16_f32 v22,v76,v77
v_mfma_f32_16x16x32_bf16 v[76:79],a[128:131],a[0:3],0
v_mfma_f32_16x16x32_bf16 v[76:79],a[132:135],a[4:7],v[76:79]
s_waitcnt lgkmcnt(2)
v_mfma_f32_16x16x32_bf16 v[76:79],a[136:139],a[8:11],v[76:79]
v_mfma_f32_16x16x32_bf16 v[76:79],a[140:143],a[12:15],v[76:79]
s_waitcnt lgkmcnt(0)
v_fma_f32 v73,v73,s36,v13
v_exp_f32 v73,v73
v_mfma_f32_16x16x32_bf16 v[76:79],a[144:147],a[16:19],v[76:79]
v_fma_f32 v75,v75,s36,v13
v_exp_f32 v75,v75
v_mfma_f32_16x16x32_bf16 v[76:79],a[148:151],a[20:23],v[76:79]
s_waitcnt vmcnt(12)
s_barrier
ds_read_b64_tr_b16 a[122:123],v2 offset:6144
ds_read_b64_tr_b16 a[130:131],v4 offset:6144
ds_read_b64_tr_b16 a[120:121],v2 offset:0
ds_read_b64_tr_b16 a[126:127],v3 offset:6144
ds_read_b64_tr_b16 a[128:129],v4 offset:0
ds_read_b64_tr_b16 a[124:125],v3 offset:0
ds_read_b64_tr_b16 a[136:137],v2 offset:128
ds_read_b64_tr_b16 a[140:141],v3 offset:128
ds_read_b64_tr_b16 a[146:147],v4 offset:6272
ds_read_b64_tr_b16 a[132:133],v5 offset:0
ds_read_b64_tr_b16 a[148:149],v5 offset:128
ds_read_b64_tr_b16 a[138:139],v2 offset:6272
ds_read_b64_tr_b16 a[134:135],v5 offset:6144
ds_read_b64_tr_b16 a[144:145],v4 offset:128
ds_read_b64_tr_b16 a[142:143],v3 offset:6272
ds_read_b64_tr_b16 a[150:151],v5 offset:6272
v_fma_f32 v72,v72,s36,v13
v_exp_f32 v72,v72
s_waitcnt lgkmcnt(13)
v_mfma_f32_16x16x32_bf16 v[160:163],a[120:123],v[20:23],0
ds_read_b64_tr_b16 a[122:123],v2 offset:6400
v_cvt_pk_bf16_f32 v44,v72,v73
v_fma_f32 v74,v74,s36,v13
v_exp_f32 v74,v74
s_waitcnt lgkmcnt(11)
v_mfma_f32_16x16x32_bf16 v[164:167],a[124:127],v[20:23],0
ds_read_b64_tr_b16 a[124:125],v3 offset:256
v_cvt_pk_bf16_f32 v45,v74,v75
v_mfma_f32_16x16x32_bf16 v[168:171],a[128:131],v[20:23],0
ds_read_b64_tr_b16 a[130:131],v4 offset:6400
ds_read_b64_tr_b16 a[120:121],v2 offset:256
v_fma_f32 v78,v78,s36,v13
v_fma_f32 v76,v76,s36,v13
v_fma_f32 v77,v77,s36,v13
v_exp_f32 v77,v77
s_waitcnt lgkmcnt(7)
v_mfma_f32_16x16x32_bf16 v[172:175],a[132:135],v[20:23],0
ds_read_b64_tr_b16 a[132:133],v5 offset:256
v_fma_f32 v79,v79,s36,v13
v_mfma_f32_16x16x32_bf16 v[176:179],a[136:139],v[20:23],0
s_waitcnt lgkmcnt(5)
ds_read_b64_tr_b16 a[126:127],v3 offset:6400
v_exp_f32 v79,v79
v_mfma_f32_16x16x32_bf16 v[180:183],a[140:143],v[20:23],0
ds_read_b64_tr_b16 a[134:135],v5 offset:6400
v_exp_f32 v78,v78
ds_read_b64_tr_b16 a[128:129],v4 offset:256
v_mfma_f32_16x16x32_bf16 v[184:187],a[144:147],v[20:23],0
ds_read_b128 a[140:143],v1 offset:24576
v_cvt_pk_bf16_f32 v47,v78,v79
v_mfma_f32_16x16x32_bf16 v[188:191],a[148:151],v[20:23],0
s_waitcnt lgkmcnt(5)
ds_read_b128 a[148:151],v1 offset:24704
v_exp_f32 v76,v76
v_mfma_f32_16x16x32_bf16 v[192:195],a[120:123],v[20:23],0
s_waitcnt lgkmcnt(4)
ds_read_b128 a[136:139],v0 offset:24576
v_cvt_pk_bf16_f32 v46,v76,v77
ds_read_b128 a[120:123],v0 offset:24832
v_mfma_f32_16x16x32_bf16 v[196:199],a[124:127],v[20:23],0
s_waitcnt lgkmcnt(4)
ds_read_b128 a[144:147],v0 offset:24704
ds_read_b128 a[124:127],v1 offset:24832
v_mfma_f32_16x16x32_bf16 v[200:203],a[128:131],v[20:23],0
ds_read_b128 a[128:131],v0 offset:30720
v_mfma_f32_16x16x32_bf16 v[204:207],a[132:135],v[20:23],0
s_waitcnt lgkmcnt(4)
ds_read_b128 a[132:135],v1 offset:30720
v_mfma_f32_16x16x32_bf16 v[72:75],a[136:139],a[0:3],0
ds_read_b128 a[136:139],v0 offset:30848
v_mfma_f32_16x16x32_bf16 v[72:75],a[140:143],a[4:7],v[72:75]
s_waitcnt lgkmcnt(4)
ds_read_b128 a[140:143],v1 offset:30848
v_mfma_f32_16x16x32_bf16 v[72:75],a[144:147],a[8:11],v[72:75]
ds_read_b128 a[144:147],v0 offset:30976
v_mfma_f32_16x16x32_bf16 v[72:75],a[148:151],a[12:15],v[72:75]
ds_read_b128 a[148:151],v1 offset:30976
v_mfma_f32_16x16x32_bf16 v[72:75],a[120:123],a[16:19],v[72:75]
s_waitcnt lgkmcnt(6)
ds_read_b128 a[120:123],v0 offset:0
v_mfma_f32_16x16x32_bf16 v[72:75],a[124:127],a[20:23],v[72:75]
s_waitcnt lgkmcnt(6)
ds_read_b128 a[124:127],v1 offset:0
v_mfma_f32_16x16x32_bf16 v[76:79],a[128:131],a[0:3],0
s_waitcnt lgkmcnt(6)
ds_read_b128 a[128:131],v0 offset:128
v_mfma_f32_16x16x32_bf16 v[76:79],a[132:135],a[4:7],v[76:79]
s_waitcnt lgkmcnt(6)
ds_read_b128 a[132:135],v1 offset:128
v_mfma_f32_16x16x32_bf16 v[76:79],a[136:139],a[8:11],v[76:79]
s_waitcnt lgkmcnt(6)
ds_read_b128 a[136:139],v0 offset:256
v_mfma_f32_16x16x32_bf16 v[76:79],a[140:143],a[12:15],v[76:79]
s_waitcnt lgkmcnt(6)
ds_read_b128 a[140:143],v1 offset:256
v_fma_f32 v73,v73,s36,v13
v_mfma_f32_16x16x32_bf16 v[76:79],a[144:147],a[16:19],v[76:79]
s_waitcnt lgkmcnt(6)
ds_read_b128 a[144:147],v0 offset:6144
v_fma_f32 v75,v75,s36,v13
v_mfma_f32_16x16x32_bf16 v[76:79],a[148:151],a[20:23],v[76:79]
s_waitcnt vmcnt(6)
ds_read_b128 a[40:43],v11 offset:6400
buffer_load_dwordx4 v6,s[12:15],s28 offen offset:0 nt lds
ds_read_b128 a[24:27],v11 offset:6144
buffer_load_dwordx4 v7,s[12:15],s28 offen offset:1024 nt lds
ds_read_b128 a[28:31],v12 offset:6144
buffer_load_dwordx4 v8,s[12:15],s28 offen offset:2048 nt lds
s_add_u32 s28,s28,3072
s_add_u32 m0,s24,3072
ds_read_b128 a[36:39],v12 offset:6272
buffer_load_dwordx4 v6,s[12:15],s28 offen offset:0 nt lds
ds_read_b128 a[32:35],v11 offset:6272
buffer_load_dwordx4 v7,s[12:15],s28 offen offset:1024 nt lds
ds_read_b128 a[44:47],v12 offset:6400
buffer_load_dwordx4 v8,s[12:15],s28 offen offset:2048 nt lds
s_add_u32 s28,s28,3072
s_add_u32 m0,s23,12288
ds_read_b128 a[148:151],v1 offset:6144
v_exp_f32 v75,v75
v_fma_f32 v72,v72,s36,v13
v_exp_f32 v72,v72
s_waitcnt lgkmcnt(5)
v_mfma_f32_16x16x32_bf16 v[80:83],a[120:123],a[24:27],0
s_waitcnt lgkmcnt(4)
ds_read_b128 a[120:123],v0 offset:6272
v_exp_f32 v73,v73
v_mfma_f32_16x16x32_bf16 v[80:83],a[124:127],a[28:31],v[80:83]
s_waitcnt lgkmcnt(3)
ds_read_b128 a[124:127],v1 offset:6272
v_fma_f32 v74,v74,s36,v13
v_exp_f32 v74,v74
v_mfma_f32_16x16x32_bf16 v[80:83],a[128:131],a[32:35],v[80:83]
ds_read_b128 a[128:131],v0 offset:6400
v_mfma_f32_16x16x32_bf16 v[80:83],a[132:135],a[36:39],v[80:83]
ds_read_b128 a[132:135],v1 offset:6400
v_mfma_f32_16x16x32_bf16 v[80:83],a[136:139],a[40:43],v[80:83]
s_waitcnt lgkmcnt(4)
ds_read_b128 a[136:139],v0 offset:12288
v_mfma_f32_16x16x32_bf16 v[80:83],a[140:143],a[44:47],v[80:83]
ds_read_b128 a[140:143],v1 offset:12288
v_mfma_f32_16x16x32_bf16 v[84:87],a[144:147],a[24:27],0
ds_read_b128 a[144:147],v0 offset:12416
v_mfma_f32_16x16x32_bf16 v[84:87],a[148:151],a[28:31],v[84:87]
s_waitcnt lgkmcnt(6)
ds_read_b128 a[148:151],v1 offset:12416
v_mfma_f32_16x16x32_bf16 v[84:87],a[120:123],a[32:35],v[84:87]
s_waitcnt lgkmcnt(6)
ds_read_b128 a[120:123],v0 offset:12544
v_mfma_f32_16x16x32_bf16 v[84:87],a[124:127],a[36:39],v[84:87]
s_waitcnt lgkmcnt(6)
ds_read_b128 a[124:127],v1 offset:12544
v_max3_f32 v48,v80,v81,v82
v_mfma_f32_16x16x32_bf16 v[84:87],a[128:131],a[40:43],v[84:87]
s_waitcnt lgkmcnt(6)
ds_read_b128 a[128:131],v0 offset:18432
v_mfma_f32_16x16x32_bf16 v[84:87],a[132:135],a[44:47],v[84:87]
ds_read_b128 a[132:135],v1 offset:18432
s_nop 6
v_max3_f32 v48,v48,v83,v84
v_max3_f32 v48,v48,v85,v86
v_max_f32 v48,v48,v87
v_mov_b32 v49,v48
s_nop 1
v_permlane32_swap_b32 v49,v48
v_max_f32 v48,v48,v49
v_mov_b32 v49,v48
s_nop 1
v_permlane16_swap_b32 v49,v48
v_max_f32 v48,v48,v49
v_mul_f32_e64 v14,-s36,v48
v_fma_f32 v81,v81,s36,v14
v_exp_f32 v81,v81
v_fma_f32 v82,v82,s36,v14
v_fma_f32 v83,v83,s36,v14
v_exp_f32 v83,v83
v_exp_f32 v82,v82
v_fma_f32 v80,v80,s36,v14
v_exp_f32 v80,v80
v_cvt_pk_bf16_f32 v25,v82,v83
v_cvt_pk_bf16_f32 v24,v80,v81
s_waitcnt lgkmcnt(0)
v_mfma_f32_16x16x32_bf16 v[80:83],a[136:139],a[24:27],0
ds_read_b128 a[136:139],v0 offset:18560
v_fma_f32 v85,v85,s36,v14
v_mfma_f32_16x16x32_bf16 v[80:83],a[140:143],a[28:31],v[80:83]
ds_read_b128 a[140:143],v1 offset:18560
v_fma_f32 v87,v87,s36,v14
v_mfma_f32_16x16x32_bf16 v[80:83],a[144:147],a[32:35],v[80:83]
ds_read_b128 a[144:147],v0 offset:18688
v_exp_f32 v87,v87
v_mfma_f32_16x16x32_bf16 v[80:83],a[148:151],a[36:39],v[80:83]
ds_read_b128 a[148:151],v1 offset:18688
v_fma_f32 v86,v86,s36,v14
v_mfma_f32_16x16x32_bf16 v[80:83],a[120:123],a[40:43],v[80:83]
ds_read_b64_tr_b16 a[120:121],v2 offset:0
v_fma_f32 v84,v84,s36,v14
v_mfma_f32_16x16x32_bf16 v[80:83],a[124:127],a[44:47],v[80:83]
ds_read_b64_tr_b16 a[124:125],v3 offset:0
ds_read_b64_tr_b16 a[126:127],v3 offset:6144
ds_read_b64_tr_b16 a[122:123],v2 offset:6144
v_exp_f32 v84,v84
v_exp_f32 v85,v85
v_exp_f32 v86,v86
v_cvt_pk_bf16_f32 v26,v84,v85
v_cvt_pk_bf16_f32 v27,v86,v87
v_mfma_f32_16x16x32_bf16 v[84:87],a[128:131],a[24:27],0
ds_read_b64_tr_b16 a[130:131],v4 offset:6144
v_fma_f32 v81,v81,s36,v14
v_smfmac_f32_16x16x64_bf16 v[60:63],a[152:155],v[20:27],v18
ds_read_b64_tr_b16 a[128:129],v4 offset:0
v_mfma_f32_16x16x32_bf16 v[84:87],a[132:135],a[28:31],v[84:87]
s_waitcnt lgkmcnt(6)
ds_read_b64_tr_b16 a[132:133],v5 offset:0
v_fma_f32 v80,v80,s36,v14
v_mfma_f32_16x16x32_bf16 v[84:87],a[136:139],a[32:35],v[84:87]
ds_read_b64_tr_b16 a[134:135],v5 offset:6144
v_exp_f32 v80,v80
v_mfma_f32_16x16x32_bf16 v[84:87],a[140:143],a[36:39],v[84:87]
ds_read_b64_tr_b16 a[140:141],v3 offset:128
v_exp_f32 v81,v81
v_mfma_f32_16x16x32_bf16 v[84:87],a[144:147],a[40:43],v[84:87]
ds_read_b64_tr_b16 a[146:147],v4 offset:6272
v_fma_f32 v82,v82,s36,v14
v_mfma_f32_16x16x32_bf16 v[84:87],a[148:151],a[44:47],v[84:87]
s_waitcnt lgkmcnt(5)
ds_read_b64_tr_b16 a[148:149],v5 offset:128
v_exp_f32 v82,v82
v_mfma_f32_16x16x32_bf16 v[208:211],a[120:123],v[24:27],0
ds_read_b64_tr_b16 a[122:123],v2 offset:6400
v_cvt_pk_bf16_f32 v48,v80,v81
ds_read_b64_tr_b16 a[136:137],v2 offset:128
ds_read_b64_tr_b16 a[138:139],v2 offset:6272
ds_read_b64_tr_b16 a[142:143],v3 offset:6272
v_mfma_f32_16x16x32_bf16 v[212:215],a[124:127],v[24:27],0
s_waitcnt lgkmcnt(7)
ds_read_b64_tr_b16 a[150:151],v5 offset:6272
ds_read_b64_tr_b16 a[144:145],v4 offset:128
v_mfma_f32_16x16x32_bf16 v[216:219],a[128:131],v[24:27],0
ds_read_b64_tr_b16 a[128:129],v4 offset:256
v_fma_f32 v83,v83,s36,v14
v_mfma_f32_16x16x32_bf16 v[220:223],a[132:135],v[24:27],0
ds_read_b64_tr_b16 a[132:133],v5 offset:256
ds_read_b64_tr_b16 a[134:135],v5 offset:6400
ds_read_b64_tr_b16 a[120:121],v2 offset:256
ds_read_b64_tr_b16 a[126:127],v3 offset:6400
ds_read_b64_tr_b16 a[124:125],v3 offset:256
ds_read_b64_tr_b16 a[130:131],v4 offset:6400
v_exp_f32 v83,v83
v_fma_f32 v87,v87,s36,v14
v_cvt_pk_bf16_f32 v49,v82,v83
v_fma_f32 v85,v85,s36,v14
s_waitcnt lgkmcnt(10)
v_mfma_f32_16x16x32_bf16 v[224:227],a[136:139],v[24:27],0
s_waitcnt lgkmcnt(9)
ds_read_b128 a[136:139],v0 offset:24576
v_exp_f32 v85,v85
v_mfma_f32_16x16x32_bf16 v[228:231],a[140:143],v[24:27],0
s_waitcnt lgkmcnt(8)
ds_read_b128 a[140:143],v1 offset:24576
v_exp_f32 v87,v87
v_mfma_f32_16x16x32_bf16 v[232:235],a[144:147],v[24:27],0
ds_read_b128 a[144:147],v0 offset:24704
v_fma_f32 v86,v86,s36,v14
v_mfma_f32_16x16x32_bf16 v[236:239],a[148:151],v[24:27],0
s_waitcnt lgkmcnt(5)
ds_read_b128 a[148:151],v1 offset:24704
v_exp_f32 v86,v86
v_mfma_f32_16x16x32_bf16 v[240:243],a[120:123],v[24:27],0
s_waitcnt lgkmcnt(4)
ds_read_b128 a[120:123],v0 offset:24832
v_cvt_pk_bf16_f32 v51,v86,v87
v_mfma_f32_16x16x32_bf16 v[244:247],a[124:127],v[24:27],0
ds_read_b128 a[124:127],v1 offset:24832
v_fma_f32 v84,v84,s36,v14
v_mfma_f32_16x16x32_bf16 v[248:251],a[128:131],v[24:27],0
ds_read_b128 a[128:131],v0 offset:30720
v_exp_f32 v84,v84
v_mfma_f32_16x16x32_bf16 v[252:255],a[132:135],v[24:27],0
s_waitcnt lgkmcnt(5)
ds_read_b128 a[132:135],v1 offset:30720
v_cvt_pk_bf16_f32 v50,v84,v85
v_mfma_f32_16x16x32_bf16 v[80:83],a[136:139],a[24:27],0
ds_read_b128 a[136:139],v0 offset:30848
v_cvt_pk_bf16_f32 v21,v74,v75
v_smfmac_f32_16x16x64_bf16 v[60:63],a[152:155],v[44:51],v18
v_cvt_pk_bf16_f32 v20,v72,v73
v_mfma_f32_16x16x32_bf16 v[80:83],a[140:143],a[28:31],v[80:83]
s_waitcnt lgkmcnt(5)
ds_read_b128 a[140:143],v1 offset:30848
v_mfma_f32_16x16x32_bf16 v[80:83],a[144:147],a[32:35],v[80:83]
ds_read_b128 a[144:147],v0 offset:30976
v_mfma_f32_16x16x32_bf16 v[80:83],a[148:151],a[36:39],v[80:83]
s_waitcnt lgkmcnt(5)
ds_read_b128 a[148:151],v1 offset:30976
v_mfma_f32_16x16x32_bf16 v[80:83],a[120:123],a[40:43],v[80:83]
ds_read_b128 a[120:123],v0 offset:0
v_mfma_f32_16x16x32_bf16 v[80:83],a[124:127],a[44:47],v[80:83]
s_waitcnt lgkmcnt(5)
ds_read_b128 a[124:127],v1 offset:0
v_mfma_f32_16x16x32_bf16 v[84:87],a[128:131],a[24:27],0
ds_read_b128 a[128:131],v0 offset:128
v_mfma_f32_16x16x32_bf16 v[84:87],a[132:135],a[28:31],v[84:87]
s_waitcnt lgkmcnt(6)
ds_read_b128 a[132:135],v1 offset:128
v_mfma_f32_16x16x32_bf16 v[84:87],a[136:139],a[32:35],v[84:87]
s_waitcnt lgkmcnt(6)
ds_read_b128 a[136:139],v0 offset:256
v_mfma_f32_16x16x32_bf16 v[84:87],a[140:143],a[36:39],v[84:87]
s_waitcnt lgkmcnt(6)
ds_read_b128 a[140:143],v1 offset:256
v_fma_f32 v80,v80,s36,v14
v_mfma_f32_16x16x32_bf16 v[84:87],a[144:147],a[40:43],v[84:87]
s_waitcnt lgkmcnt(6)
ds_read_b128 a[144:147],v0 offset:6144
v_exp_f32 v80,v80
v_mfma_f32_16x16x32_bf16 v[84:87],a[148:151],a[44:47],v[84:87]
s_waitcnt vmcnt(6)
ds_read_b128 a[52:55],v12 offset:12288
buffer_load_dwordx4 v6,s[8:11],s21 offen offset:0 lds
ds_read_b128 a[64:67],v11 offset:12544
buffer_load_dwordx4 v7,s[8:11],s21 offen offset:1024 lds
ds_read_b128 a[60:63],v12 offset:12416
buffer_load_dwordx4 v8,s[8:11],s21 offen offset:2048 lds
s_add_u32 s21,s21,12288
s_add_u32 m0,s23,24576
ds_read_b128 a[48:51],v11 offset:12288
v_fma_f32 v81,v81,s36,v14
ds_read_b128 a[56:59],v11 offset:12416
v_exp_f32 v81,v81
ds_read_b128 a[68:71],v12 offset:12544
v_cvt_pk_bf16_f32 v24,v80,v81
ds_read_b128 a[148:151],v1 offset:6144
s_waitcnt lgkmcnt(3)
v_mfma_f32_16x16x32_bf16 v[88:91],a[120:123],a[48:51],0
ds_read_b128 a[120:123],v0 offset:6272
v_mfma_f32_16x16x32_bf16 v[88:91],a[124:127],a[52:55],v[88:91]
s_waitcnt lgkmcnt(3)
ds_read_b128 a[124:127],v1 offset:6272
v_mfma_f32_16x16x32_bf16 v[88:91],a[128:131],a[56:59],v[88:91]
ds_read_b128 a[128:131],v0 offset:6400
v_mfma_f32_16x16x32_bf16 v[88:91],a[132:135],a[60:63],v[88:91]
ds_read_b128 a[132:135],v1 offset:6400
v_mfma_f32_16x16x32_bf16 v[88:91],a[136:139],a[64:67],v[88:91]
s_waitcnt lgkmcnt(5)
ds_read_b128 a[136:139],v0 offset:12288
v_mfma_f32_16x16x32_bf16 v[88:91],a[140:143],a[68:71],v[88:91]
ds_read_b128 a[140:143],v1 offset:12288
v_mfma_f32_16x16x32_bf16 v[92:95],a[144:147],a[48:51],0
s_waitcnt lgkmcnt(6)
ds_read_b128 a[144:147],v0 offset:12416
v_mfma_f32_16x16x32_bf16 v[92:95],a[148:151],a[52:55],v[92:95]
s_waitcnt lgkmcnt(6)
ds_read_b128 a[148:151],v1 offset:12416
v_mfma_f32_16x16x32_bf16 v[92:95],a[120:123],a[56:59],v[92:95]
s_waitcnt lgkmcnt(6)
ds_read_b128 a[120:123],v0 offset:12544
v_mfma_f32_16x16x32_bf16 v[92:95],a[124:127],a[60:63],v[92:95]
s_waitcnt lgkmcnt(6)
ds_read_b128 a[124:127],v1 offset:12544
v_max3_f32 v52,v88,v89,v90
v_mfma_f32_16x16x32_bf16 v[92:95],a[128:131],a[64:67],v[92:95]
s_waitcnt lgkmcnt(6)
ds_read_b128 a[128:131],v0 offset:18432
v_mfma_f32_16x16x32_bf16 v[92:95],a[132:135],a[68:71],v[92:95]
ds_read_b128 a[132:135],v1 offset:18432
s_nop 6
v_max3_f32 v52,v52,v91,v92
v_max3_f32 v52,v52,v93,v94
v_max_f32 v52,v52,v95
v_mov_b32 v53,v52
s_nop 1
v_permlane32_swap_b32 v53,v52
v_max_f32 v52,v52,v53
v_mov_b32 v53,v52
s_nop 1
v_permlane16_swap_b32 v53,v52
v_max_f32 v52,v52,v53
v_mul_f32_e64 v15,-s36,v52
v_fma_f32 v89,v89,s36,v15
v_exp_f32 v89,v89
v_fma_f32 v91,v91,s36,v15
v_fma_f32 v88,v88,s36,v15
v_exp_f32 v88,v88
v_exp_f32 v91,v91
v_cvt_pk_bf16_f32 v28,v88,v89
v_fma_f32 v90,v90,s36,v15
v_exp_f32 v90,v90
v_fma_f32 v94,v94,s36,v15
v_cvt_pk_bf16_f32 v29,v90,v91
s_waitcnt lgkmcnt(0)
v_mfma_f32_16x16x32_bf16 v[88:91],a[136:139],a[48:51],0
ds_read_b128 a[136:139],v0 offset:18560
v_exp_f32 v94,v94
v_mfma_f32_16x16x32_bf16 v[88:91],a[140:143],a[52:55],v[88:91]
ds_read_b128 a[140:143],v1 offset:18560
v_fma_f32 v92,v92,s36,v15
v_mfma_f32_16x16x32_bf16 v[88:91],a[144:147],a[56:59],v[88:91]
ds_read_b128 a[144:147],v0 offset:18688
v_fma_f32 v93,v93,s36,v15
v_mfma_f32_16x16x32_bf16 v[88:91],a[148:151],a[60:63],v[88:91]
ds_read_b128 a[148:151],v1 offset:18688
v_fma_f32 v95,v95,s36,v15
v_mfma_f32_16x16x32_bf16 v[88:91],a[120:123],a[64:67],v[88:91]
ds_read_b64_tr_b16 a[122:123],v2 offset:6144
v_exp_f32 v93,v93
v_mfma_f32_16x16x32_bf16 v[88:91],a[124:127],a[68:71],v[88:91]
ds_read_b64_tr_b16 a[124:125],v3 offset:0
ds_read_b64_tr_b16 a[120:121],v2 offset:0
ds_read_b64_tr_b16 a[126:127],v3 offset:6144
v_exp_f32 v95,v95
v_exp_f32 v92,v92
v_cvt_pk_bf16_f32 v31,v94,v95
v_cvt_pk_bf16_f32 v30,v92,v93
v_mfma_f32_16x16x32_bf16 v[92:95],a[128:131],a[48:51],0
ds_read_b64_tr_b16 a[130:131],v4 offset:6144
v_fma_f32 v89,v89,s36,v15
v_mfma_f32_16x16x32_bf16 v[92:95],a[132:135],a[52:55],v[92:95]
s_waitcnt lgkmcnt(6)
ds_read_b64_tr_b16 a[134:135],v5 offset:6144
v_fma_f32 v90,v90,s36,v15
v_mfma_f32_16x16x32_bf16 v[92:95],a[136:139],a[56:59],v[92:95]
ds_read_b64_tr_b16 a[128:129],v4 offset:0
v_exp_f32 v90,v90
v_mfma_f32_16x16x32_bf16 v[92:95],a[140:143],a[60:63],v[92:95]
ds_read_b64_tr_b16 a[136:137],v2 offset:128
v_fma_f32 v91,v91,s36,v15
v_mfma_f32_16x16x32_bf16 v[92:95],a[144:147],a[64:67],v[92:95]
s_waitcnt lgkmcnt(4)
ds_read_b64_tr_b16 a[132:133],v5 offset:0
v_exp_f32 v91,v91
v_mfma_f32_16x16x32_bf16 v[92:95],a[148:151],a[68:71],v[92:95]
ds_read_b64_tr_b16 a[142:143],v3 offset:6272
v_cvt_pk_bf16_f32 v53,v90,v91
v_mfma_f32_16x16x32_bf16 v[112:115],a[120:123],v[28:31],0
ds_read_b64_tr_b16 a[140:141],v3 offset:128
v_exp_f32 v89,v89
ds_read_b64_tr_b16 a[138:139],v2 offset:6272
v_mfma_f32_16x16x32_bf16 v[116:119],a[124:127],v[28:31],0
ds_read_b64_tr_b16 a[148:149],v5 offset:128
v_fma_f32 v88,v88,s36,v15
v_exp_f32 v88,v88
ds_read_b64_tr_b16 a[146:147],v4 offset:6272
ds_read_b64_tr_b16 a[144:145],v4 offset:128
ds_read_b64_tr_b16 a[150:151],v5 offset:6272
s_waitcnt lgkmcnt(8)
v_mfma_f32_16x16x32_bf16 v[120:123],a[128:131],v[28:31],0
s_waitcnt lgkmcnt(7)
ds_read_b64_tr_b16 a[122:123],v2 offset:6400
ds_read_b64_tr_b16 a[120:121],v2 offset:256
v_mfma_f32_16x16x32_bf16 v[124:127],a[132:135],v[28:31],0
ds_read_b64_tr_b16 a[124:125],v3 offset:256
ds_read_b64_tr_b16 a[126:127],v3 offset:6400
ds_read_b64_tr_b16 a[130:131],v4 offset:6400
v_cvt_pk_bf16_f32 v52,v88,v89
v_fma_f32 v92,v92,s36,v15
v_fma_f32 v95,v95,s36,v15
v_fma_f32 v93,v93,s36,v15
s_waitcnt lgkmcnt(9)
v_mfma_f32_16x16x32_bf16 v[128:131],a[136:139],v[28:31],0
ds_read_b128 a[136:139],v0 offset:24576
v_fma_f32 v94,v94,s36,v15
v_mfma_f32_16x16x32_bf16 v[132:135],a[140:143],v[28:31],0
ds_read_b128 a[140:143],v1 offset:24576
v_exp_f32 v94,v94
ds_read_b64_tr_b16 a[128:129],v4 offset:256
ds_read_b64_tr_b16 a[134:135],v5 offset:6400
ds_read_b64_tr_b16 a[132:133],v5 offset:256
s_waitcnt lgkmcnt(10)
v_mfma_f32_16x16x32_bf16 v[136:139],a[144:147],v[28:31],0
ds_read_b128 a[144:147],v0 offset:24704
v_exp_f32 v95,v95
v_mfma_f32_16x16x32_bf16 v[140:143],a[148:151],v[28:31],0
s_waitcnt lgkmcnt(6)
ds_read_b128 a[148:151],v1 offset:24704
v_exp_f32 v92,v92
v_mfma_f32_16x16x32_bf16 v[144:147],a[120:123],v[28:31],0
ds_read_b128 a[120:123],v0 offset:24832
v_cvt_pk_bf16_f32 v55,v94,v95
v_mfma_f32_16x16x32_bf16 v[148:151],a[124:127],v[28:31],0
s_waitcnt lgkmcnt(5)
ds_read_b128 a[124:127],v1 offset:24832
v_exp_f32 v93,v93
v_mfma_f32_16x16x32_bf16 v[152:155],a[128:131],v[28:31],0
s_waitcnt lgkmcnt(4)
ds_read_b128 a[128:131],v0 offset:30720
v_cvt_pk_bf16_f32 v54,v92,v93
v_mfma_f32_16x16x32_bf16 v[156:159],a[132:135],v[28:31],0
ds_read_b128 a[132:135],v1 offset:30720
v_mfma_f32_16x16x32_bf16 v[88:91],a[136:139],a[48:51],0
ds_read_b128 a[136:139],v0 offset:30848
v_mfma_f32_16x16x32_bf16 v[88:91],a[140:143],a[52:55],v[88:91]
s_waitcnt lgkmcnt(5)
ds_read_b128 a[140:143],v1 offset:30848
v_mfma_f32_16x16x32_bf16 v[88:91],a[144:147],a[56:59],v[88:91]
ds_read_b128 a[144:147],v0 offset:30976
v_mfma_f32_16x16x32_bf16 v[88:91],a[148:151],a[60:63],v[88:91]
s_waitcnt lgkmcnt(6)
ds_read_b128 a[148:151],v1 offset:30976
v_mfma_f32_16x16x32_bf16 v[88:91],a[120:123],a[64:67],v[88:91]
s_waitcnt lgkmcnt(6)
ds_read_b128 a[120:123],v0 offset:0
v_mfma_f32_16x16x32_bf16 v[88:91],a[124:127],a[68:71],v[88:91]
s_waitcnt lgkmcnt(6)
ds_read_b128 a[124:127],v1 offset:0
v_mfma_f32_16x16x32_bf16 v[92:95],a[128:131],a[48:51],0
s_waitcnt lgkmcnt(6)
ds_read_b128 a[128:131],v0 offset:128
v_mfma_f32_16x16x32_bf16 v[92:95],a[132:135],a[52:55],v[92:95]
s_waitcnt lgkmcnt(6)
ds_read_b128 a[132:135],v1 offset:128
v_mfma_f32_16x16x32_bf16 v[92:95],a[136:139],a[56:59],v[92:95]
s_waitcnt lgkmcnt(6)
ds_read_b128 a[136:139],v0 offset:256
v_mfma_f32_16x16x32_bf16 v[92:95],a[140:143],a[60:63],v[92:95]
s_waitcnt lgkmcnt(6)
ds_read_b128 a[140:143],v1 offset:256
v_mfma_f32_16x16x32_bf16 v[92:95],a[144:147],a[64:67],v[92:95]
s_waitcnt lgkmcnt(6)
ds_read_b128 a[144:147],v0 offset:6144
v_mfma_f32_16x16x32_bf16 v[92:95],a[148:151],a[68:71],v[92:95]
s_waitcnt vmcnt(3)
ds_read_b128 a[72:75],v11 offset:0
buffer_load_dwordx4 v6,s[8:11],s21 offen offset:0 lds
ds_read_b128 a[76:79],v12 offset:0
buffer_load_dwordx4 v7,s[8:11],s21 offen offset:1024 lds
ds_read_b128 a[92:95],v12 offset:256
buffer_load_dwordx4 v8,s[8:11],s21 offen offset:2048 lds
s_add_u32 s21,s21,12288
ds_read_b128 a[80:83],v11 offset:128
s_add_u32 m0,s22,0
ds_read_b128 a[88:91],v11 offset:256
ds_read_b128 a[84:87],v12 offset:128
ds_read_b128 a[148:151],v1 offset:6144
s_waitcnt lgkmcnt(6)
v_mfma_f32_16x16x32_bf16 v[96:99],a[120:123],a[72:75],0
s_waitcnt lgkmcnt(5)
ds_read_b128 a[120:123],v0 offset:6272
v_mfma_f32_16x16x32_bf16 v[96:99],a[124:127],a[76:79],v[96:99]
s_waitcnt lgkmcnt(4)
ds_read_b128 a[124:127],v1 offset:6272
v_mfma_f32_16x16x32_bf16 v[96:99],a[128:131],a[80:83],v[96:99]
s_waitcnt lgkmcnt(3)
ds_read_b128 a[128:131],v0 offset:6400
v_mfma_f32_16x16x32_bf16 v[96:99],a[132:135],a[84:87],v[96:99]
ds_read_b128 a[132:135],v1 offset:6400
s_waitcnt vmcnt(3)
v_mfma_f32_16x16x32_bf16 v[96:99],a[136:139],a[88:91],v[96:99]
v_mfma_f32_16x16x32_bf16 v[96:99],a[140:143],a[92:95],v[96:99]
v_mfma_f32_16x16x32_bf16 v[100:103],a[144:147],a[72:75],0
s_waitcnt lgkmcnt(4)
v_mfma_f32_16x16x32_bf16 v[100:103],a[148:151],a[76:79],v[100:103]
s_waitcnt lgkmcnt(3)
v_mfma_f32_16x16x32_bf16 v[100:103],a[120:123],a[80:83],v[100:103]
s_waitcnt lgkmcnt(2)
v_mfma_f32_16x16x32_bf16 v[100:103],a[124:127],a[84:87],v[100:103]
s_waitcnt lgkmcnt(1)
v_mfma_f32_16x16x32_bf16 v[100:103],a[128:131],a[88:91],v[100:103]
s_waitcnt lgkmcnt(0)
v_mfma_f32_16x16x32_bf16 v[100:103],a[132:135],a[92:95],v[100:103]
s_barrier
buffer_load_dwordx4 v6,s[4:7],s20 offen offset:0 lds
buffer_load_dwordx4 v7,s[4:7],s20 offen offset:1024 lds
buffer_load_dwordx4 v8,s[4:7],s20 offen offset:2048 lds
ds_read_b128 a[136:139],v0 offset:12288
v_max3_f32 v56,v96,v97,v98
ds_read_b128 a[144:147],v0 offset:12416
s_add_u32 s20,s20,12288
ds_read_b128 a[120:123],v0 offset:12544
v_max3_f32 v56,v56,v99,v100
ds_read_b128 a[124:127],v1 offset:12544
v_max3_f32 v56,v56,v101,v102
ds_read_b128 a[140:143],v1 offset:12288
v_max_f32 v56,v56,v103
ds_read_b128 a[148:151],v1 offset:12416
v_mov_b32 v57,v56
ds_read_b128 a[132:135],v1 offset:18432
s_mov_b32 s27,166723584
ds_read_b128 a[128:131],v0 offset:18432
v_permlane32_swap_b32 v57,v56
v_max_f32 v56,v56,v57
v_mov_b32 v57,v56
s_mov_b32 s42,s41
s_add_u32 s69,s69,1
v_permlane16_swap_b32 v57,v56
v_max_f32 v56,v56,v57
v_mul_f32_e64 v16,-s36,v56
v_fma_f32 v99,v99,s36,v16
v_fma_f32 v96,v96,s36,v16
v_exp_f32 v99,v99
v_fma_f32 v98,v98,s36,v16
v_exp_f32 v98,v98
v_fma_f32 v97,v97,s36,v16
v_exp_f32 v97,v97
v_fma_f32 v100,v100,s36,v16
v_cvt_pk_bf16_f32 v33,v98,v99
v_exp_f32 v96,v96
v_fma_f32 v102,v102,s36,v16
v_cvt_pk_bf16_f32 v32,v96,v97
s_waitcnt lgkmcnt(2)
v_mfma_f32_16x16x32_bf16 v[96:99],a[136:139],a[72:75],0
s_lshl_b32 s62,s69,5
ds_read_b128 a[136:139],v0 offset:18560
v_exp_f32 v102,v102
v_mfma_f32_16x16x32_bf16 v[96:99],a[140:143],a[76:79],v[96:99]
s_add_u32 s62,s62,s34
ds_read_b128 a[140:143],v1 offset:18560
v_fma_f32 v103,v103,s36,v16
v_mfma_f32_16x16x32_bf16 v[96:99],a[144:147],a[80:83],v[96:99]
s_mul_i32 s63,s62,171
ds_read_b128 a[144:147],v0 offset:18688
v_exp_f32 v103,v103
v_mfma_f32_16x16x32_bf16 v[96:99],a[148:151],a[84:87],v[96:99]
s_lshr_b32 s63,s63,9
ds_read_b128 a[148:151],v1 offset:18688
v_fma_f32 v101,v101,s36,v16
v_mfma_f32_16x16x32_bf16 v[96:99],a[120:123],a[88:91],v[96:99]
s_mul_i32 s64,s63,3
ds_read_b64_tr_b16 a[120:121],v2 offset:0
v_cvt_pk_bf16_f32 v35,v102,v103
v_mfma_f32_16x16x32_bf16 v[96:99],a[124:127],a[92:95],v[96:99]
s_sub_u32 s62,s62,s64
ds_read_b64_tr_b16 a[124:125],v3 offset:0
ds_read_b64_tr_b16 a[126:127],v3 offset:6144
ds_read_b64_tr_b16 a[122:123],v2 offset:6144
v_exp_f32 v100,v100
v_exp_f32 v101,v101
s_add_u32 s63,s63,s33
v_cvt_pk_bf16_f32 v34,v100,v101
s_waitcnt lgkmcnt(7)
v_mfma_f32_16x16x32_bf16 v[100:103],a[128:131],a[72:75],0
s_mul_i32 s30,s63,196608
ds_read_b64_tr_b16 a[128:129],v4 offset:0
v_fma_f32 v97,v97,s36,v16
v_smfmac_f32_16x16x64_bf16 v[64:67],a[152:155],v[28:35],v18
s_mul_i32 s41,s63,325632
s_lshl_b32 s63,s3,2
ds_read_b64_tr_b16 a[130:131],v4 offset:6144
v_mfma_f32_16x16x32_bf16 v[100:103],a[132:135],a[76:79],v[100:103]
s_add_u32 s64,s63,21
ds_read_b64_tr_b16 a[132:133],v5 offset:0
v_fma_f32 v96,v96,s36,v16
v_mfma_f32_16x16x32_bf16 v[100:103],a[136:139],a[80:83],v[100:103]
s_cmp_eq_u32 s3,0
ds_read_b64_tr_b16 a[134:135],v5 offset:6144
v_fma_f32 v99,v99,s36,v16
s_waitcnt lgkmcnt(7)
v_mfma_f32_16x16x32_bf16 v[100:103],a[140:143],a[84:87],v[100:103]
s_cselect_b32 s64,20,s64
ds_read_b64_tr_b16 a[140:141],v3 offset:128
v_exp_f32 v97,v97
v_mfma_f32_16x16x32_bf16 v[100:103],a[144:147],a[88:91],v[100:103]
s_cselect_b32 s40,1,0
ds_read_b64_tr_b16 a[136:137],v2 offset:128
v_fma_f32 v98,v98,s36,v16
v_mfma_f32_16x16x32_bf16 v[100:103],a[148:151],a[92:95],v[100:103]
s_add_u32 s65,s63,37
ds_read_b64_tr_b16 a[148:149],v5 offset:128
v_exp_f32 v98,v98
s_waitcnt lgkmcnt(7)
v_mfma_f32_16x16x32_bf16 a[160:163],a[120:123],v[32:35],0
s_cmp_eq_u32 s62,2
ds_read_b64_tr_b16 a[122:123],v2 offset:6400
v_exp_f32 v99,v99
ds_read_b64_tr_b16 a[138:139],v2 offset:6272
v_mfma_f32_16x16x32_bf16 a[164:167],a[124:127],v[32:35],0
s_cselect_b32 s64,s65,s64
ds_read_b64_tr_b16 a[120:121],v2 offset:256
ds_read_b64_tr_b16 a[142:143],v3 offset:6272
s_waitcnt lgkmcnt(7)
v_mfma_f32_16x16x32_bf16 a[168:171],a[128:131],v[32:35],0
s_cselect_b32 s40,0,s40
ds_read_b64_tr_b16 a[126:127],v3 offset:6400
ds_read_b64_tr_b16 a[146:147],v4 offset:6272
ds_read_b64_tr_b16 a[144:145],v4 offset:128
ds_read_b64_tr_b16 a[150:151],v5 offset:6272
v_mfma_f32_16x16x32_bf16 a[172:175],a[132:135],v[32:35],0
s_add_u32 s65,s63,s3
ds_read_b64_tr_b16 a[128:129],v4 offset:256
ds_read_b64_tr_b16 a[130:131],v4 offset:6400
ds_read_b64_tr_b16 a[134:135],v5 offset:6400
ds_read_b64_tr_b16 a[124:125],v3 offset:256
ds_read_b64_tr_b16 a[132:133],v5 offset:256
s_waitcnt vmcnt(6)
v_cvt_pk_bf16_f32 v57,v98,v99
v_exp_f32 v96,v96
s_waitcnt lgkmcnt(11)
v_mfma_f32_16x16x32_bf16 a[176:179],a[136:139],v[32:35],0
s_cmp_eq_u32 s62,0
v_cvt_pk_bf16_f32 v56,v96,v97
v_fma_f32 v102,v102,s36,v16
v_exp_f32 v102,v102
s_waitcnt lgkmcnt(9)
v_mfma_f32_16x16x32_bf16 a[180:183],a[140:143],v[32:35],0
s_cselect_b32 s64,s65,s64
v_fma_f32 v100,v100,s36,v16
v_fma_f32 v101,v101,s36,v16
v_fma_f32 v103,v103,s36,v16
v_exp_f32 v103,v103
s_waitcnt lgkmcnt(6)
v_mfma_f32_16x16x32_bf16 a[184:187],a[144:147],v[32:35],0
s_cselect_b32 s40,1,s40
v_cvt_pk_bf16_f32 v59,v102,v103
v_exp_f32 v100,v100
s_waitcnt lgkmcnt(4)
v_mfma_f32_16x16x32_bf16 a[188:191],a[148:151],v[32:35],0
s_mul_i32 s64,s64,6144
v_exp_f32 v101,v101
v_mfma_f32_16x16x32_bf16 a[192:195],a[120:123],v[32:35],0
s_add_u32 s41,s41,s64
v_cvt_pk_bf16_f32 v58,v100,v101
s_waitcnt lgkmcnt(0)
s_barrier
v_mfma_f32_16x16x32_bf16 a[196:199],a[124:127],v[32:35],0
s_cmp_ge_u32 s69,6
ds_read_b128 a[136:139],v0 offset:24576
s_cselect_b32 s41,166723584,s41
v_smfmac_f32_16x16x64_bf16 v[64:67],a[152:155],v[52:59],v18
s_cselect_b32 s30,100663296,s30
s_add_u32 s25,s30,s22
ds_read_b128 a[120:123],v0 offset:24832
v_mfma_f32_16x16x32_bf16 a[200:203],a[128:131],v[32:35],0
s_add_u32 s26,s25,12288
s_mov_b32 s28,s41
ds_read_b128 a[140:143],v1 offset:24576
v_mfma_f32_16x16x32_bf16 a[204:207],a[132:135],v[32:35],0
s_mov_b32 s29,s24
ds_read_b128 a[148:151],v1 offset:24704
s_add_u32 m0,s23,0
ds_read_b128 a[124:127],v1 offset:24832
buffer_load_dwordx4 v6,s[8:11],s21 offen offset:0 lds
buffer_load_dwordx4 v7,s[8:11],s21 offen offset:1024 lds
buffer_load_dwordx4 v8,s[8:11],s21 offen offset:2048 lds
ds_read_b128 a[144:147],v0 offset:24704
s_add_u32 s21,s21,12288
ds_read_b128 a[128:131],v0 offset:30720
s_waitcnt lgkmcnt(6)
v_mfma_f32_16x16x32_bf16 v[96:99],a[136:139],a[72:75],0
s_add_u32 m0,s22,12288
ds_read_b128 a[132:135],v1 offset:30720
buffer_load_dwordx4 v6,s[4:7],s20 offen offset:0 lds
s_waitcnt lgkmcnt(5)
v_mfma_f32_16x16x32_bf16 v[96:99],a[140:143],a[76:79],v[96:99]
buffer_load_dwordx4 v7,s[4:7],s20 offen offset:1024 lds
buffer_load_dwordx4 v8,s[4:7],s20 offen offset:2048 lds
ds_read_b128 a[140:143],v1 offset:30848
s_add_u32 s20,s20,12288
ds_read_b128 a[136:139],v0 offset:30848
s_waitcnt lgkmcnt(4)
v_mfma_f32_16x16x32_bf16 v[96:99],a[144:147],a[80:83],v[96:99]
ds_read_b128 a[144:147],v0 offset:30976
v_mfma_f32_16x16x32_bf16 v[96:99],a[148:151],a[84:87],v[96:99]
ds_read_b128 a[148:151],v1 offset:30976
v_mfma_f32_16x16x32_bf16 v[96:99],a[120:123],a[88:91],v[96:99]
ds_read_b64_tr_b16 a[122:123],v2 offset:18432
v_mfma_f32_16x16x32_bf16 v[96:99],a[124:127],a[92:95],v[96:99]
s_waitcnt lgkmcnt(5)
ds_read_b64_tr_b16 a[126:127],v3 offset:18432
v_mfma_f32_16x16x32_bf16 v[100:103],a[128:131],a[72:75],0
ds_read_b64_tr_b16 a[120:121],v2 offset:12288
v_mfma_f32_16x16x32_bf16 v[100:103],a[132:135],a[76:79],v[100:103]
s_waitcnt lgkmcnt(5)
ds_read_b64_tr_b16 a[124:125],v3 offset:12288
v_mfma_f32_16x16x32_bf16 v[100:103],a[136:139],a[80:83],v[100:103]
ds_read_b64_tr_b16 a[128:129],v4 offset:12288
v_mfma_f32_16x16x32_bf16 v[100:103],a[140:143],a[84:87],v[100:103]
s_waitcnt lgkmcnt(6)
ds_read_b64_tr_b16 a[132:133],v5 offset:12288
v_mfma_f32_16x16x32_bf16 v[100:103],a[144:147],a[88:91],v[100:103]
s_waitcnt lgkmcnt(6)
ds_read_b64_tr_b16 a[130:131],v4 offset:18432
v_mfma_f32_16x16x32_bf16 v[100:103],a[148:151],a[92:95],v[100:103]
s_waitcnt lgkmcnt(4)
ds_read_b64_tr_b16 a[134:135],v5 offset:18432
v_mfma_f32_16x16x32_bf16 v[160:163],a[120:123],v[44:47],v[160:163]
s_add_u32 m0,s23,12288
ds_read_b64_tr_b16 a[136:137],v2 offset:12416
v_fma_f32 v82,v82,s36,v14
s_waitcnt lgkmcnt(5)
v_mfma_f32_16x16x32_bf16 v[164:167],a[124:127],v[44:47],v[164:167]
ds_read_b64_tr_b16 a[138:139],v2 offset:18560
v_fma_f32 v83,v83,s36,v14
v_mfma_f32_16x16x32_bf16 v[212:215],a[124:127],v[48:51],v[212:215]
ds_read_b64_tr_b16 a[140:141],v3 offset:12416
v_fma_f32 v88,v88,s36,v15
v_mfma_f32_16x16x32_bf16 v[208:211],a[120:123],v[48:51],v[208:211]
ds_read_b64_tr_b16 a[142:143],v3 offset:18560
v_fma_f32 v89,v89,s36,v15
v_mfma_f32_16x16x32_bf16 v[112:115],a[120:123],v[52:55],v[112:115]
ds_read_b64_tr_b16 a[144:145],v4 offset:12416
v_fma_f32 v90,v90,s36,v15
v_mfma_f32_16x16x32_bf16 v[116:119],a[124:127],v[52:55],v[116:119]
ds_read_b64_tr_b16 a[146:147],v4 offset:18560
v_fma_f32 v91,v91,s36,v15
v_mfma_f32_16x16x32_bf16 a[164:167],a[124:127],v[56:59],a[164:167]
ds_read_b64_tr_b16 a[148:149],v5 offset:12416
v_fma_f32 v96,v96,s36,v16
v_mfma_f32_16x16x32_bf16 a[160:163],a[120:123],v[56:59],a[160:163]
s_waitcnt lgkmcnt(6)
ds_read_b64_tr_b16 a[150:151],v5 offset:18560
v_fma_f32 v97,v97,s36,v16
v_mfma_f32_16x16x32_bf16 a[168:171],a[128:131],v[56:59],a[168:171]
ds_read_b64_tr_b16 a[120:121],v2 offset:12544
v_fma_f32 v98,v98,s36,v16
v_mfma_f32_16x16x32_bf16 a[172:175],a[132:135],v[56:59],a[172:175]
ds_read_b64_tr_b16 a[122:123],v2 offset:18688
v_fma_f32 v99,v99,s36,v16
v_mfma_f32_16x16x32_bf16 v[124:127],a[132:135],v[52:55],v[124:127]
ds_read_b64_tr_b16 a[124:125],v3 offset:12544
v_fma_f32 v76,v76,s36,v13
v_mfma_f32_16x16x32_bf16 v[120:123],a[128:131],v[52:55],v[120:123]
ds_read_b64_tr_b16 a[126:127],v3 offset:18688
v_fma_f32 v77,v77,s36,v13
v_mfma_f32_16x16x32_bf16 v[216:219],a[128:131],v[48:51],v[216:219]
v_exp_f32 v82,v82
v_mfma_f32_16x16x32_bf16 v[220:223],a[132:135],v[48:51],v[220:223]
v_exp_f32 v83,v83
v_mfma_f32_16x16x32_bf16 v[172:175],a[132:135],v[44:47],v[172:175]
ds_read_b64_tr_b16 a[132:133],v5 offset:12544
v_cvt_pk_bf16_f32 v25,v82,v83
v_mfma_f32_16x16x32_bf16 v[168:171],a[128:131],v[44:47],v[168:171]
s_waitcnt lgkmcnt(4)
ds_read_b64_tr_b16 a[128:129],v4 offset:12544
v_fma_f32 v78,v78,s36,v13
v_mfma_f32_16x16x32_bf16 v[176:179],a[136:139],v[44:47],v[176:179]
ds_read_b64_tr_b16 a[130:131],v4 offset:18688
v_fma_f32 v79,v79,s36,v13
v_mfma_f32_16x16x32_bf16 v[180:183],a[140:143],v[44:47],v[180:183]
ds_read_b64_tr_b16 a[134:135],v5 offset:18688
v_fma_f32 v84,v84,s36,v14
v_mfma_f32_16x16x32_bf16 v[228:231],a[140:143],v[48:51],v[228:231]
v_exp_f32 v88,v88
v_mfma_f32_16x16x32_bf16 v[224:227],a[136:139],v[48:51],v[224:227]
v_exp_f32 v89,v89
v_mfma_f32_16x16x32_bf16 v[128:131],a[136:139],v[52:55],v[128:131]
v_exp_f32 v90,v90
v_mfma_f32_16x16x32_bf16 v[132:135],a[140:143],v[52:55],v[132:135]
v_exp_f32 v91,v91
v_mfma_f32_16x16x32_bf16 a[180:183],a[140:143],v[56:59],a[180:183]
v_cvt_pk_bf16_f32 v28,v88,v89
v_cvt_pk_bf16_f32 v29,v90,v91
v_mfma_f32_16x16x32_bf16 a[176:179],a[136:139],v[56:59],a[176:179]
v_exp_f32 v96,v96
v_mfma_f32_16x16x32_bf16 a[184:187],a[144:147],v[56:59],a[184:187]
v_exp_f32 v97,v97
v_mfma_f32_16x16x32_bf16 a[188:191],a[148:151],v[56:59],a[188:191]
v_exp_f32 v98,v98
v_mfma_f32_16x16x32_bf16 v[140:143],a[148:151],v[52:55],v[140:143]
v_exp_f32 v99,v99
v_mfma_f32_16x16x32_bf16 v[136:139],a[144:147],v[52:55],v[136:139]
v_cvt_pk_bf16_f32 v32,v96,v97
v_cvt_pk_bf16_f32 v33,v98,v99
v_mfma_f32_16x16x32_bf16 v[232:235],a[144:147],v[48:51],v[232:235]
v_exp_f32 v76,v76
v_mfma_f32_16x16x32_bf16 v[236:239],a[148:151],v[48:51],v[236:239]
v_exp_f32 v77,v77
v_mfma_f32_16x16x32_bf16 v[188:191],a[148:151],v[44:47],v[188:191]
v_exp_f32 v78,v78
v_mfma_f32_16x16x32_bf16 v[184:187],a[144:147],v[44:47],v[184:187]
s_waitcnt lgkmcnt(0)
v_exp_f32 v79,v79
v_mfma_f32_16x16x32_bf16 v[192:195],a[120:123],v[44:47],v[192:195]
v_cvt_pk_bf16_f32 v22,v76,v77
v_cvt_pk_bf16_f32 v23,v78,v79
v_mfma_f32_16x16x32_bf16 v[196:199],a[124:127],v[44:47],v[196:199]
s_waitcnt vmcnt(6)
v_fma_f32 v85,v85,s36,v14
v_fma_f32 v86,v86,s36,v14
v_mfma_f32_16x16x32_bf16 v[244:247],a[124:127],v[48:51],v[244:247]
s_barrier
v_mfma_f32_16x16x32_bf16 v[240:243],a[120:123],v[48:51],v[240:243]
ds_read_b128 a[148:151],v1 offset:128
v_fma_f32 v87,v87,s36,v14
v_mfma_f32_16x16x32_bf16 v[144:147],a[120:123],v[52:55],v[144:147]
ds_read_b128 a[144:147],v0 offset:128
v_fma_f32 v92,v92,s36,v15
v_mfma_f32_16x16x32_bf16 v[148:151],a[124:127],v[52:55],v[148:151]
ds_read_b128 a[140:143],v1 offset:0
v_fma_f32 v93,v93,s36,v15
v_mfma_f32_16x16x32_bf16 a[196:199],a[124:127],v[56:59],a[196:199]
ds_read_b128 a[124:127],v1 offset:256
v_fma_f32 v94,v94,s36,v15
v_mfma_f32_16x16x32_bf16 a[192:195],a[120:123],v[56:59],a[192:195]
ds_read_b128 a[120:123],v0 offset:256
v_fma_f32 v95,v95,s36,v15
v_mfma_f32_16x16x32_bf16 a[200:203],a[128:131],v[56:59],a[200:203]
buffer_load_dwordx4 v6,s[8:11],s21 offen offset:0 lds
v_mfma_f32_16x16x32_bf16 a[204:207],a[132:135],v[56:59],a[204:207]
ds_read_b128 a[136:139],v0 offset:0
v_fma_f32 v100,v100,s36,v16
v_mfma_f32_16x16x32_bf16 v[156:159],a[132:135],v[52:55],v[156:159]
v_exp_f32 v84,v84
v_mfma_f32_16x16x32_bf16 v[152:155],a[128:131],v[52:55],v[152:155]
v_exp_f32 v85,v85
v_mfma_f32_16x16x32_bf16 v[248:251],a[128:131],v[48:51],v[248:251]
v_exp_f32 v86,v86
v_mfma_f32_16x16x32_bf16 v[252:255],a[132:135],v[48:51],v[252:255]
v_exp_f32 v87,v87
v_mfma_f32_16x16x32_bf16 v[204:207],a[132:135],v[44:47],v[204:207]
ds_read_b128 a[132:135],v1 offset:6144
v_cvt_pk_bf16_f32 v26,v84,v85
v_mfma_f32_16x16x32_bf16 v[200:203],a[128:131],v[44:47],v[200:203]
s_waitcnt lgkmcnt(2)
ds_read_b128 a[128:131],v0 offset:6144
v_cvt_pk_bf16_f32 v27,v86,v87
v_mfma_f32_16x16x32_bf16 v[72:75],a[124:127],a[20:23],0
v_exp_f32 v92,v92
v_smfmac_f32_16x16x64_bf16 v[60:63],a[152:155],v[20:27],v18
buffer_load_dwordx4 v7,s[8:11],s21 offen offset:1024 lds
v_mfma_f32_16x16x32_bf16 v[72:75],a[120:123],a[16:19],v[72:75]
v_exp_f32 v93,v93
v_mfma_f32_16x16x32_bf16 v[72:75],a[148:151],a[12:15],v[72:75]
v_exp_f32 v94,v94
v_mfma_f32_16x16x32_bf16 v[72:75],a[144:147],a[8:11],v[72:75]
v_exp_f32 v95,v95
v_mfma_f32_16x16x32_bf16 v[72:75],a[140:143],a[4:7],v[72:75]
s_waitcnt lgkmcnt(1)
v_cvt_pk_bf16_f32 v30,v92,v93
v_cvt_pk_bf16_f32 v31,v94,v95
v_mfma_f32_16x16x32_bf16 v[72:75],a[136:139],a[0:3],v[72:75]
v_fma_f32 v101,v101,s36,v16
v_fma_f32 v102,v102,s36,v16
v_mfma_f32_16x16x32_bf16 v[80:83],a[136:139],a[24:27],0
v_fma_f32 v103,v103,s36,v16
v_mfma_f32_16x16x32_bf16 v[80:83],a[140:143],a[28:31],v[80:83]
v_exp_f32 v100,v100
v_mfma_f32_16x16x32_bf16 v[80:83],a[144:147],a[32:35],v[80:83]
buffer_load_dwordx4 v8,s[8:11],s21 offen offset:2048 lds
v_mfma_f32_16x16x32_bf16 v[80:83],a[148:151],a[36:39],v[80:83]
s_add_u32 s21,s21,12288
v_exp_f32 v101,v101
v_mfma_f32_16x16x32_bf16 v[80:83],a[120:123],a[40:43],v[80:83]
s_add_u32 m0,s22,24576
v_exp_f32 v102,v102
v_mfma_f32_16x16x32_bf16 v[80:83],a[124:127],a[44:47],v[80:83]
v_exp_f32 v103,v103
v_mfma_f32_16x16x32_bf16 v[88:91],a[124:127],a[68:71],0
v_cvt_pk_bf16_f32 v34,v100,v101
v_cvt_pk_bf16_f32 v35,v102,v103
v_mfma_f32_16x16x32_bf16 v[88:91],a[120:123],a[64:67],v[88:91]
v_fma_f32 v72,v72,s36,v13
v_fma_f32 v73,v73,s36,v13
v_smfmac_f32_16x16x64_bf16 v[64:67],a[152:155],v[28:35],v18
v_fma_f32 v74,v74,s36,v13
v_mfma_f32_16x16x32_bf16 v[88:91],a[148:151],a[60:63],v[88:91]
v_fma_f32 v75,v75,s36,v13
v_fma_f32 v80,v80,s36,v14
v_mfma_f32_16x16x32_bf16 v[88:91],a[144:147],a[56:59],v[88:91]
v_fma_f32 v81,v81,s36,v14
v_mfma_f32_16x16x32_bf16 v[88:91],a[140:143],a[52:55],v[88:91]
buffer_load_dwordx4 v6,s[4:7],s20 offen offset:0 lds
v_mfma_f32_16x16x32_bf16 v[88:91],a[136:139],a[48:51],v[88:91]
v_exp_f32 v72,v72
v_mfma_f32_16x16x32_bf16 v[96:99],a[136:139],a[72:75],0
ds_read_b128 a[136:139],v0 offset:6272
v_mfma_f32_16x16x32_bf16 v[96:99],a[140:143],a[76:79],v[96:99]
ds_read_b128 a[140:143],v1 offset:6272
v_mfma_f32_16x16x32_bf16 v[96:99],a[144:147],a[80:83],v[96:99]
ds_read_b128 a[144:147],v0 offset:6400
v_mfma_f32_16x16x32_bf16 v[96:99],a[148:151],a[84:87],v[96:99]
ds_read_b128 a[148:151],v1 offset:6400
v_mfma_f32_16x16x32_bf16 v[96:99],a[120:123],a[88:91],v[96:99]
v_exp_f32 v73,v73
v_mfma_f32_16x16x32_bf16 v[96:99],a[124:127],a[92:95],v[96:99]
s_waitcnt lgkmcnt(4)
v_exp_f32 v74,v74
v_mfma_f32_16x16x32_bf16 v[76:79],a[128:131],a[0:3],0
v_exp_f32 v75,v75
v_mfma_f32_16x16x32_bf16 v[76:79],a[132:135],a[4:7],v[76:79]
buffer_load_dwordx4 v7,s[4:7],s20 offen offset:1024 lds
s_waitcnt lgkmcnt(3)
v_mfma_f32_16x16x32_bf16 v[76:79],a[136:139],a[8:11],v[76:79]
s_waitcnt lgkmcnt(2)
v_exp_f32 v80,v80
v_mfma_f32_16x16x32_bf16 v[76:79],a[140:143],a[12:15],v[76:79]
s_waitcnt lgkmcnt(0)
v_exp_f32 v81,v81
v_mfma_f32_16x16x32_bf16 v[76:79],a[144:147],a[16:19],v[76:79]
v_cvt_pk_bf16_f32 v44,v72,v73
v_cvt_pk_bf16_f32 v45,v74,v75
v_mfma_f32_16x16x32_bf16 v[76:79],a[148:151],a[20:23],v[76:79]
v_cvt_pk_bf16_f32 v48,v80,v81
v_mfma_f32_16x16x32_bf16 v[84:87],a[148:151],a[44:47],0
v_mfma_f32_16x16x32_bf16 v[84:87],a[144:147],a[40:43],v[84:87]
v_mfma_f32_16x16x32_bf16 v[84:87],a[140:143],a[36:39],v[84:87]
v_mfma_f32_16x16x32_bf16 v[84:87],a[136:139],a[32:35],v[84:87]
v_mfma_f32_16x16x32_bf16 v[84:87],a[132:135],a[28:31],v[84:87]
buffer_load_dwordx4 v8,s[4:7],s20 offen offset:2048 lds
v_mfma_f32_16x16x32_bf16 v[84:87],a[128:131],a[24:27],v[84:87]
s_add_u32 s20,s20,12288
v_mfma_f32_16x16x32_bf16 v[92:95],a[128:131],a[48:51],0
ds_read_b64_tr_b16 a[120:121],v2 offset:24576
v_mfma_f32_16x16x32_bf16 v[92:95],a[132:135],a[52:55],v[92:95]
ds_read_b64_tr_b16 a[122:123],v2 offset:30720
v_mfma_f32_16x16x32_bf16 v[92:95],a[136:139],a[56:59],v[92:95]
ds_read_b64_tr_b16 a[124:125],v3 offset:24576
v_mfma_f32_16x16x32_bf16 v[92:95],a[140:143],a[60:63],v[92:95]
ds_read_b64_tr_b16 a[126:127],v3 offset:30720
v_mfma_f32_16x16x32_bf16 v[92:95],a[144:147],a[64:67],v[92:95]
v_mfma_f32_16x16x32_bf16 v[92:95],a[148:151],a[68:71],v[92:95]
v_mfma_f32_16x16x32_bf16 v[100:103],a[148:151],a[92:95],0
v_mfma_f32_16x16x32_bf16 v[100:103],a[144:147],a[88:91],v[100:103]
v_mfma_f32_16x16x32_bf16 v[100:103],a[140:143],a[84:87],v[100:103]
v_mfma_f32_16x16x32_bf16 v[100:103],a[136:139],a[80:83],v[100:103]
v_mfma_f32_16x16x32_bf16 v[100:103],a[132:135],a[76:79],v[100:103]
ds_read_b64_tr_b16 a[132:133],v5 offset:24576
v_mfma_f32_16x16x32_bf16 v[100:103],a[128:131],a[72:75],v[100:103]
ds_read_b64_tr_b16 a[128:129],v4 offset:24576
ds_read_b64_tr_b16 a[130:131],v4 offset:30720
ds_read_b64_tr_b16 a[134:135],v5 offset:30720
s_mov_b32 s38,0
s_branch L_loop4
L_loop5:
.p2align 6
L_loop5w0:
s_waitcnt lgkmcnt(3)
v_mfma_f32_16x16x32_bf16 v[160:163],a[120:123],v[20:23],v[160:163]
s_add_u32 m0,s23,24576
ds_read_b64_tr_b16 a[142:143],v3 offset:30848
v_fma_f32 v90,v90,s36,v15
v_mfma_f32_16x16x32_bf16 v[164:167],a[124:127],v[20:23],v[164:167]
ds_read_b64_tr_b16 a[136:137],v2 offset:24704
v_fma_f32 v91,v91,s36,v15
v_mfma_f32_16x16x32_bf16 v[212:215],a[124:127],v[24:27],v[212:215]
ds_read_b64_tr_b16 a[138:139],v2 offset:30848
v_fma_f32 v97,v97,s36,v16
v_mfma_f32_16x16x32_bf16 v[208:211],a[120:123],v[24:27],v[208:211]
ds_read_b64_tr_b16 a[140:141],v3 offset:24704
v_fma_f32 v96,v96,s36,v16
v_mfma_f32_16x16x32_bf16 v[112:115],a[120:123],v[28:31],v[112:115]
ds_read_b64_tr_b16 a[146:147],v4 offset:30848
v_fma_f32 v98,v98,s36,v16
v_mfma_f32_16x16x32_bf16 v[116:119],a[124:127],v[28:31],v[116:119]
ds_read_b64_tr_b16 a[144:145],v4 offset:24704
v_fma_f32 v99,v99,s36,v16
v_mfma_f32_16x16x32_bf16 a[164:167],a[124:127],v[32:35],a[164:167]
ds_read_b64_tr_b16 a[150:151],v5 offset:30848
v_fma_f32 v106,v106,s36,v17
v_mfma_f32_16x16x32_bf16 a[160:163],a[120:123],v[32:35],a[160:163]
ds_read_b64_tr_b16 a[148:149],v5 offset:24704
v_fma_f32 v107,v107,s36,v17
v_mfma_f32_16x16x32_bf16 a[208:211],a[120:123],v[36:39],a[208:211]
ds_read_b64_tr_b16 a[122:123],v2 offset:30976
v_fma_f32 v104,v104,s36,v17
v_mfma_f32_16x16x32_bf16 a[212:215],a[124:127],v[36:39],a[212:215]
s_waitcnt lgkmcnt(6)
ds_read_b64_tr_b16 a[126:127],v3 offset:30976
v_fma_f32 v105,v105,s36,v17
v_mfma_f32_16x16x32_bf16 a[216:219],a[128:131],v[36:39],a[216:219]
ds_read_b64_tr_b16 a[120:121],v2 offset:24832
v_fma_f32 v77,v77,s36,v13
v_mfma_f32_16x16x32_bf16 a[220:223],a[132:135],v[36:39],a[220:223]
ds_read_b64_tr_b16 a[124:125],v3 offset:24832
v_fma_f32 v79,v79,s36,v13
v_mfma_f32_16x16x32_bf16 a[172:175],a[132:135],v[32:35],a[172:175]
v_exp_f32 v91,v91
v_mfma_f32_16x16x32_bf16 a[168:171],a[128:131],v[32:35],a[168:171]
v_exp_f32 v90,v90
v_mfma_f32_16x16x32_bf16 v[120:123],a[128:131],v[28:31],v[120:123]
v_cvt_pk_bf16_f32 v53,v90,v91
v_fma_f32 v76,v76,s36,v13
v_mfma_f32_16x16x32_bf16 v[124:127],a[132:135],v[28:31],v[124:127]
v_exp_f32 v99,v99
v_mfma_f32_16x16x32_bf16 v[220:223],a[132:135],v[24:27],v[220:223]
v_exp_f32 v96,v96
v_mfma_f32_16x16x32_bf16 v[216:219],a[128:131],v[24:27],v[216:219]
v_exp_f32 v98,v98
v_mfma_f32_16x16x32_bf16 v[168:171],a[128:131],v[20:23],v[168:171]
ds_read_b64_tr_b16 a[128:129],v4 offset:24832
v_cvt_pk_bf16_f32 v57,v98,v99
v_mfma_f32_16x16x32_bf16 v[172:175],a[132:135],v[20:23],v[172:175]
ds_read_b64_tr_b16 a[130:131],v4 offset:30976
v_fma_f32 v78,v78,s36,v13
v_mfma_f32_16x16x32_bf16 v[176:179],a[136:139],v[20:23],v[176:179]
s_waitcnt lgkmcnt(2)
ds_read_b64_tr_b16 a[132:133],v5 offset:24832
v_fma_f32 v86,v86,s36,v14
v_mfma_f32_16x16x32_bf16 v[180:183],a[140:143],v[20:23],v[180:183]
ds_read_b64_tr_b16 a[134:135],v5 offset:30976
v_fma_f32 v84,v84,s36,v14
v_mfma_f32_16x16x32_bf16 v[228:231],a[140:143],v[24:27],v[228:231]
v_exp_f32 v97,v97
v_mfma_f32_16x16x32_bf16 v[224:227],a[136:139],v[24:27],v[224:227]
v_cvt_pk_bf16_f32 v56,v96,v97
v_fma_f32 v87,v87,s36,v14
v_mfma_f32_16x16x32_bf16 v[128:131],a[136:139],v[28:31],v[128:131]
v_exp_f32 v104,v104
v_mfma_f32_16x16x32_bf16 v[132:135],a[140:143],v[28:31],v[132:135]
v_exp_f32 v107,v107
v_mfma_f32_16x16x32_bf16 a[180:183],a[140:143],v[32:35],a[180:183]
v_exp_f32 v105,v105
v_mfma_f32_16x16x32_bf16 a[176:179],a[136:139],v[32:35],a[176:179]
v_exp_f32 v106,v106
v_mfma_f32_16x16x32_bf16 a[224:227],a[136:139],v[36:39],a[224:227]
v_cvt_pk_bf16_f32 v41,v106,v107
v_cvt_pk_bf16_f32 v40,v104,v105
v_mfma_f32_16x16x32_bf16 a[228:231],a[140:143],v[36:39],a[228:231]
v_exp_f32 v78,v78
v_mfma_f32_16x16x32_bf16 a[232:235],a[144:147],v[36:39],a[232:235]
v_exp_f32 v79,v79
v_mfma_f32_16x16x32_bf16 a[236:239],a[148:151],v[36:39],a[236:239]
v_exp_f32 v77,v77
v_mfma_f32_16x16x32_bf16 a[188:191],a[148:151],v[32:35],a[188:191]
v_exp_f32 v76,v76
v_mfma_f32_16x16x32_bf16 a[184:187],a[144:147],v[32:35],a[184:187]
v_cvt_pk_bf16_f32 v46,v76,v77
v_cvt_pk_bf16_f32 v47,v78,v79
v_mfma_f32_16x16x32_bf16 v[136:139],a[144:147],v[28:31],v[136:139]
v_exp_f32 v86,v86
v_mfma_f32_16x16x32_bf16 v[140:143],a[148:151],v[28:31],v[140:143]
v_exp_f32 v87,v87
v_mfma_f32_16x16x32_bf16 v[236:239],a[148:151],v[24:27],v[236:239]
v_exp_f32 v84,v84
v_mfma_f32_16x16x32_bf16 v[232:235],a[144:147],v[24:27],v[232:235]
v_fma_f32 v85,v85,s36,v14
v_cvt_pk_bf16_f32 v51,v86,v87
v_mfma_f32_16x16x32_bf16 v[184:187],a[144:147],v[20:23],v[184:187]
v_exp_f32 v85,v85
v_mfma_f32_16x16x32_bf16 v[188:191],a[148:151],v[20:23],v[188:191]
v_cvt_pk_bf16_f32 v50,v84,v85
v_fma_f32 v92,v92,s36,v15
v_mfma_f32_16x16x32_bf16 v[192:195],a[120:123],v[20:23],v[192:195]
v_fma_f32 v94,v94,s36,v15
v_fma_f32 v93,v93,s36,v15
v_smfmac_f32_16x16x64_bf16 v[60:63],a[152:155],v[44:51],v18
v_fma_f32 v95,v95,s36,v15
v_mfma_f32_16x16x32_bf16 v[196:199],a[124:127],v[20:23],v[196:199]
s_waitcnt vmcnt(6) lgkmcnt(0)
v_exp_f32 v94,v94
v_mfma_f32_16x16x32_bf16 v[244:247],a[124:127],v[24:27],v[244:247]
s_barrier
v_mfma_f32_16x16x32_bf16 v[240:243],a[120:123],v[24:27],v[240:243]
ds_read_b128 a[136:139],v0 offset:12288
v_fma_f32 v102,v102,s36,v16
v_mfma_f32_16x16x32_bf16 v[144:147],a[120:123],v[28:31],v[144:147]
ds_read_b128 a[144:147],v0 offset:12416
v_fma_f32 v101,v101,s36,v16
v_mfma_f32_16x16x32_bf16 v[148:151],a[124:127],v[28:31],v[148:151]
ds_read_b128 a[140:143],v1 offset:12288
v_fma_f32 v100,v100,s36,v16
v_mfma_f32_16x16x32_bf16 a[196:199],a[124:127],v[32:35],a[196:199]
ds_read_b128 a[148:151],v1 offset:12416
v_fma_f32 v103,v103,s36,v16
v_mfma_f32_16x16x32_bf16 a[192:195],a[120:123],v[32:35],a[192:195]
ds_read_b128 a[156:159],v10 offset:0
v_fma_f32 v108,v108,s36,v17
v_mfma_f32_16x16x32_bf16 a[240:243],a[120:123],v[36:39],a[240:243]
buffer_load_dwordx4 v6,s[8:11],s21 offen offset:0 lds
v_mfma_f32_16x16x32_bf16 a[244:247],a[124:127],v[36:39],a[244:247]
ds_read_b128 a[120:123],v0 offset:12544
v_fma_f32 v110,v110,s36,v17
v_mfma_f32_16x16x32_bf16 a[248:251],a[128:131],v[36:39],a[248:251]
ds_read_b128 a[124:127],v1 offset:12544
v_fma_f32 v111,v111,s36,v17
v_mfma_f32_16x16x32_bf16 a[252:255],a[132:135],v[36:39],a[252:255]
v_exp_f32 v92,v92
v_mfma_f32_16x16x32_bf16 a[204:207],a[132:135],v[32:35],a[204:207]
v_exp_f32 v95,v95
v_mfma_f32_16x16x32_bf16 a[200:203],a[128:131],v[32:35],a[200:203]
v_cvt_pk_bf16_f32 v55,v94,v95
v_fma_f32 v109,v109,s36,v17
v_mfma_f32_16x16x32_bf16 v[152:155],a[128:131],v[28:31],v[152:155]
v_exp_f32 v93,v93
v_mfma_f32_16x16x32_bf16 v[156:159],a[132:135],v[28:31],v[156:159]
v_cvt_pk_bf16_f32 v54,v92,v93
v_mfma_f32_16x16x32_bf16 v[252:255],a[132:135],v[24:27],v[252:255]
v_exp_f32 v102,v102
v_mfma_f32_16x16x32_bf16 v[248:251],a[128:131],v[24:27],v[248:251]
v_exp_f32 v101,v101
v_mfma_f32_16x16x32_bf16 v[200:203],a[128:131],v[20:23],v[200:203]
ds_read_b128 a[128:131],v0 offset:18432
v_mfma_f32_16x16x32_bf16 v[204:207],a[132:135],v[20:23],v[204:207]
s_waitcnt lgkmcnt(1)
buffer_store_dwordx4 a[156:159],v9,s[16:19],s27 offen offset:0 nt
buffer_load_dwordx4 v7,s[8:11],s21 offen offset:1024 lds
v_mfma_f32_16x16x32_bf16 v[72:75],a[136:139],a[0:3],0
ds_read_b128 a[132:135],v1 offset:18432
v_mfma_f32_16x16x32_bf16 v[72:75],a[140:143],a[4:7],v[72:75]
v_exp_f32 v103,v103
v_mfma_f32_16x16x32_bf16 v[72:75],a[144:147],a[8:11],v[72:75]
v_exp_f32 v100,v100
v_mfma_f32_16x16x32_bf16 v[72:75],a[148:151],a[12:15],v[72:75]
v_cvt_pk_bf16_f32 v59,v102,v103
v_cvt_pk_bf16_f32 v58,v100,v101
v_mfma_f32_16x16x32_bf16 v[72:75],a[120:123],a[16:19],v[72:75]
v_exp_f32 v109,v109
v_smfmac_f32_16x16x64_bf16 v[64:67],a[152:155],v[52:59],v18
ds_read_b128 a[156:159],v10 offset:1024
v_mfma_f32_16x16x32_bf16 v[72:75],a[124:127],a[20:23],v[72:75]
v_exp_f32 v111,v111
v_mfma_f32_16x16x32_bf16 v[80:83],a[124:127],a[44:47],0
v_exp_f32 v108,v108
v_mfma_f32_16x16x32_bf16 v[80:83],a[120:123],a[40:43],v[80:83]
v_exp_f32 v110,v110
v_mfma_f32_16x16x32_bf16 v[80:83],a[148:151],a[36:39],v[80:83]
v_cvt_pk_bf16_f32 v42,v108,v109
v_cvt_pk_bf16_f32 v43,v110,v111
v_mfma_f32_16x16x32_bf16 v[80:83],a[144:147],a[32:35],v[80:83]
buffer_load_dwordx4 v8,s[8:11],s21 offen offset:2048 lds
v_smfmac_f32_16x16x64_bf16 v[68:71],a[152:155],v[36:43],v18
s_add_u32 s21,s21,12288
v_fma_f32 v73,v73,s36,v13
v_mfma_f32_16x16x32_bf16 v[80:83],a[140:143],a[28:31],v[80:83]
s_add_u32 m0,s22,0
v_fma_f32 v72,v72,s36,v13
v_fma_f32 v74,v74,s36,v13
v_mfma_f32_16x16x32_bf16 v[80:83],a[136:139],a[24:27],v[80:83]
v_exp_f32 v73,v73
v_mfma_f32_16x16x32_bf16 v[88:91],a[136:139],a[48:51],0
v_exp_f32 v72,v72
v_mfma_f32_16x16x32_bf16 v[88:91],a[140:143],a[52:55],v[88:91]
v_exp_f32 v74,v74
v_mfma_f32_16x16x32_bf16 v[88:91],a[144:147],a[56:59],v[88:91]
v_fma_f32 v75,v75,s36,v13
v_cvt_pk_bf16_f32 v20,v72,v73
v_mfma_f32_16x16x32_bf16 v[88:91],a[148:151],a[60:63],v[88:91]
v_exp_f32 v75,v75
v_mfma_f32_16x16x32_bf16 v[88:91],a[120:123],a[64:67],v[88:91]
v_fma_f32 v83,v83,s36,v14
v_fma_f32 v81,v81,s36,v14
v_mfma_f32_16x16x32_bf16 v[88:91],a[124:127],a[68:71],v[88:91]
v_exp_f32 v81,v81
v_mfma_f32_16x16x32_bf16 v[96:99],a[124:127],a[92:95],0
v_cvt_pk_bf16_f32 v21,v74,v75
v_fma_f32 v82,v82,s36,v14
v_mfma_f32_16x16x32_bf16 v[96:99],a[120:123],a[88:91],v[96:99]
s_waitcnt lgkmcnt(0)
buffer_store_dwordx4 a[156:159],v9,s[16:19],s27 offen offset:128 nt
buffer_load_dwordx4 v6,s[4:7],s20 offen offset:0 lds
v_mfma_f32_16x16x32_bf16 v[96:99],a[148:151],a[84:87],v[96:99]
v_fma_f32 v88,v88,s36,v15
v_fma_f32 v89,v89,s36,v15
v_mfma_f32_16x16x32_bf16 v[96:99],a[144:147],a[80:83],v[96:99]
v_exp_f32 v89,v89
v_mfma_f32_16x16x32_bf16 v[96:99],a[140:143],a[76:79],v[96:99]
v_exp_f32 v82,v82
v_mfma_f32_16x16x32_bf16 v[96:99],a[136:139],a[72:75],v[96:99]
v_exp_f32 v88,v88
v_mfma_f32_16x16x32_bf16 v[104:107],a[136:139],a[96:99],0
ds_read_b128 a[136:139],v0 offset:18560
v_fma_f32 v80,v80,s36,v14
v_mfma_f32_16x16x32_bf16 v[104:107],a[140:143],a[100:103],v[104:107]
ds_read_b128 a[156:159],v10 offset:2048
v_mfma_f32_16x16x32_bf16 v[104:107],a[144:147],a[104:107],v[104:107]
ds_read_b128 a[140:143],v1 offset:18560
v_mfma_f32_16x16x32_bf16 v[104:107],a[148:151],a[108:111],v[104:107]
ds_read_b128 a[144:147],v0 offset:18688
v_mfma_f32_16x16x32_bf16 v[104:107],a[120:123],a[112:115],v[104:107]
ds_read_b128 a[148:151],v1 offset:18688
v_mfma_f32_16x16x32_bf16 v[104:107],a[124:127],a[116:119],v[104:107]
v_exp_f32 v80,v80
v_mfma_f32_16x16x32_bf16 v[76:79],a[128:131],a[0:3],0
buffer_load_dwordx4 v7,s[4:7],s20 offen offset:1024 lds
v_mfma_f32_16x16x32_bf16 v[76:79],a[132:135],a[4:7],v[76:79]
s_waitcnt lgkmcnt(4)
v_cvt_pk_bf16_f32 v24,v80,v81
v_cvt_pk_bf16_f32 v28,v88,v89
v_mfma_f32_16x16x32_bf16 v[76:79],a[136:139],a[8:11],v[76:79]
s_waitcnt lgkmcnt(2)
v_exp_f32 v83,v83
v_mfma_f32_16x16x32_bf16 v[76:79],a[140:143],a[12:15],v[76:79]
s_waitcnt lgkmcnt(1)
v_cvt_pk_bf16_f32 v25,v82,v83
v_mfma_f32_16x16x32_bf16 v[76:79],a[144:147],a[16:19],v[76:79]
s_waitcnt lgkmcnt(0)
v_mfma_f32_16x16x32_bf16 v[76:79],a[148:151],a[20:23],v[76:79]
v_mfma_f32_16x16x32_bf16 v[84:87],a[148:151],a[44:47],0
v_mfma_f32_16x16x32_bf16 v[84:87],a[144:147],a[40:43],v[84:87]
v_mfma_f32_16x16x32_bf16 v[84:87],a[140:143],a[36:39],v[84:87]
v_mfma_f32_16x16x32_bf16 v[84:87],a[136:139],a[32:35],v[84:87]
v_mfma_f32_16x16x32_bf16 v[84:87],a[132:135],a[28:31],v[84:87]
buffer_store_dwordx4 a[156:159],v9,s[16:19],s27 offen offset:256 nt
buffer_load_dwordx4 v8,s[4:7],s20 offen offset:2048 lds
v_mfma_f32_16x16x32_bf16 v[84:87],a[128:131],a[24:27],v[84:87]
s_add_u32 s20,s20,12288
v_mfma_f32_16x16x32_bf16 v[92:95],a[128:131],a[48:51],0
s_add_u32 s27,s27,3072
v_mfma_f32_16x16x32_bf16 v[92:95],a[132:135],a[52:55],v[92:95]
v_mfma_f32_16x16x32_bf16 v[92:95],a[136:139],a[56:59],v[92:95]
v_mfma_f32_16x16x32_bf16 v[92:95],a[140:143],a[60:63],v[92:95]
ds_read_b64_tr_b16 a[120:121],v2 offset:0
v_mfma_f32_16x16x32_bf16 v[92:95],a[144:147],a[64:67],v[92:95]
ds_read_b64_tr_b16 a[122:123],v2 offset:6144
v_mfma_f32_16x16x32_bf16 v[92:95],a[148:151],a[68:71],v[92:95]
v_mfma_f32_16x16x32_bf16 v[100:103],a[148:151],a[92:95],0
ds_read_b64_tr_b16 a[124:125],v3 offset:0
v_mfma_f32_16x16x32_bf16 v[100:103],a[144:147],a[88:91],v[100:103]
ds_read_b64_tr_b16 a[126:127],v3 offset:6144
v_mfma_f32_16x16x32_bf16 v[100:103],a[140:143],a[84:87],v[100:103]
v_mfma_f32_16x16x32_bf16 v[100:103],a[136:139],a[80:83],v[100:103]
v_mfma_f32_16x16x32_bf16 v[100:103],a[132:135],a[76:79],v[100:103]
v_mfma_f32_16x16x32_bf16 v[100:103],a[128:131],a[72:75],v[100:103]
v_mfma_f32_16x16x32_bf16 v[108:111],a[128:131],a[96:99],0
ds_read_b64_tr_b16 a[130:131],v4 offset:6144
v_mfma_f32_16x16x32_bf16 v[108:111],a[132:135],a[100:103],v[108:111]
ds_read_b64_tr_b16 a[128:129],v4 offset:0
v_mfma_f32_16x16x32_bf16 v[108:111],a[136:139],a[104:107],v[108:111]
ds_read_b64_tr_b16 a[134:135],v5 offset:6144
v_mfma_f32_16x16x32_bf16 v[108:111],a[140:143],a[108:111],v[108:111]
ds_read_b64_tr_b16 a[132:133],v5 offset:0
v_mfma_f32_16x16x32_bf16 v[108:111],a[144:147],a[112:115],v[108:111]
v_mfma_f32_16x16x32_bf16 v[108:111],a[148:151],a[116:119],v[108:111]
s_waitcnt lgkmcnt(4)
v_mfma_f32_16x16x32_bf16 v[160:163],a[120:123],v[44:47],v[160:163]
s_add_u32 m0,s29,0
ds_read_b64_tr_b16 a[136:137],v2 offset:128
v_fma_f32 v90,v90,s36,v15
v_mfma_f32_16x16x32_bf16 v[164:167],a[124:127],v[44:47],v[164:167]
ds_read_b64_tr_b16 a[138:139],v2 offset:6272
v_fma_f32 v91,v91,s36,v15
v_mfma_f32_16x16x32_bf16 v[212:215],a[124:127],v[48:51],v[212:215]
ds_read_b64_tr_b16 a[140:141],v3 offset:128
v_fma_f32 v96,v96,s36,v16
v_mfma_f32_16x16x32_bf16 v[208:211],a[120:123],v[48:51],v[208:211]
ds_read_b64_tr_b16 a[142:143],v3 offset:6272
v_fma_f32 v97,v97,s36,v16
v_mfma_f32_16x16x32_bf16 v[112:115],a[120:123],v[52:55],v[112:115]
ds_read_b64_tr_b16 a[144:145],v4 offset:128
v_fma_f32 v98,v98,s36,v16
v_mfma_f32_16x16x32_bf16 v[116:119],a[124:127],v[52:55],v[116:119]
ds_read_b64_tr_b16 a[146:147],v4 offset:6272
v_fma_f32 v99,v99,s36,v16
v_mfma_f32_16x16x32_bf16 a[164:167],a[124:127],v[56:59],a[164:167]
ds_read_b64_tr_b16 a[148:149],v5 offset:128
v_fma_f32 v104,v104,s36,v17
v_mfma_f32_16x16x32_bf16 a[160:163],a[120:123],v[56:59],a[160:163]
buffer_load_dwordx4 v6,s[12:15],s28 offen offset:0 nt lds
v_mfma_f32_16x16x32_bf16 a[208:211],a[120:123],v[40:43],a[208:211]
ds_read_b64_tr_b16 a[150:151],v5 offset:6272
v_fma_f32 v105,v105,s36,v17
v_mfma_f32_16x16x32_bf16 a[212:215],a[124:127],v[40:43],a[212:215]
s_waitcnt lgkmcnt(5)
ds_read_b64_tr_b16 a[120:121],v2 offset:256
v_fma_f32 v106,v106,s36,v17
v_mfma_f32_16x16x32_bf16 a[216:219],a[128:131],v[40:43],a[216:219]
ds_read_b64_tr_b16 a[122:123],v2 offset:6400
v_fma_f32 v107,v107,s36,v17
v_mfma_f32_16x16x32_bf16 a[220:223],a[132:135],v[40:43],a[220:223]
ds_read_b64_tr_b16 a[124:125],v3 offset:256
v_fma_f32 v76,v76,s36,v13
v_mfma_f32_16x16x32_bf16 a[172:175],a[132:135],v[56:59],a[172:175]
ds_read_b64_tr_b16 a[126:127],v3 offset:6400
v_fma_f32 v77,v77,s36,v13
v_mfma_f32_16x16x32_bf16 a[168:171],a[128:131],v[56:59],a[168:171]
v_exp_f32 v90,v90
v_mfma_f32_16x16x32_bf16 v[120:123],a[128:131],v[52:55],v[120:123]
v_exp_f32 v91,v91
v_mfma_f32_16x16x32_bf16 v[124:127],a[132:135],v[52:55],v[124:127]
v_cvt_pk_bf16_f32 v29,v90,v91
v_fma_f32 v78,v78,s36,v13
v_mfma_f32_16x16x32_bf16 v[220:223],a[132:135],v[48:51],v[220:223]
v_exp_f32 v96,v96
v_mfma_f32_16x16x32_bf16 v[216:219],a[128:131],v[48:51],v[216:219]
buffer_load_dwordx4 v7,s[12:15],s28 offen offset:1024 nt lds
v_mfma_f32_16x16x32_bf16 v[168:171],a[128:131],v[44:47],v[168:171]
ds_read_b64_tr_b16 a[128:129],v4 offset:256
v_fma_f32 v79,v79,s36,v13
v_mfma_f32_16x16x32_bf16 v[172:175],a[132:135],v[44:47],v[172:175]
ds_read_b64_tr_b16 a[130:131],v4 offset:6400
v_fma_f32 v84,v84,s36,v14
v_mfma_f32_16x16x32_bf16 v[176:179],a[136:139],v[44:47],v[176:179]
s_waitcnt lgkmcnt(2)
ds_read_b64_tr_b16 a[132:133],v5 offset:256
v_fma_f32 v85,v85,s36,v14
v_mfma_f32_16x16x32_bf16 v[180:183],a[140:143],v[44:47],v[180:183]
ds_read_b64_tr_b16 a[134:135],v5 offset:6400
v_fma_f32 v86,v86,s36,v14
v_mfma_f32_16x16x32_bf16 v[228:231],a[140:143],v[48:51],v[228:231]
v_exp_f32 v97,v97
v_mfma_f32_16x16x32_bf16 v[224:227],a[136:139],v[48:51],v[224:227]
v_exp_f32 v98,v98
v_mfma_f32_16x16x32_bf16 v[128:131],a[136:139],v[52:55],v[128:131]
v_exp_f32 v99,v99
v_mfma_f32_16x16x32_bf16 v[132:135],a[140:143],v[52:55],v[132:135]
v_cvt_pk_bf16_f32 v32,v96,v97
v_cvt_pk_bf16_f32 v33,v98,v99
v_mfma_f32_16x16x32_bf16 a[180:183],a[140:143],v[56:59],a[180:183]
v_exp_f32 v104,v104
v_mfma_f32_16x16x32_bf16 a[176:179],a[136:139],v[56:59],a[176:179]
buffer_load_dwordx4 v8,s[12:15],s28 offen offset:2048 nt lds
v_mfma_f32_16x16x32_bf16 a[224:227],a[136:139],v[40:43],a[224:227]
s_add_u32 s28,s28,3072
v_exp_f32 v105,v105
v_mfma_f32_16x16x32_bf16 a[228:231],a[140:143],v[40:43],a[228:231]
s_add_u32 s29,s29,3072
v_exp_f32 v106,v106
v_mfma_f32_16x16x32_bf16 a[232:235],a[144:147],v[40:43],a[232:235]
s_add_u32 m0,s23,0
v_exp_f32 v107,v107
v_mfma_f32_16x16x32_bf16 a[236:239],a[148:151],v[40:43],a[236:239]
v_cvt_pk_bf16_f32 v36,v104,v105
v_cvt_pk_bf16_f32 v37,v106,v107
v_mfma_f32_16x16x32_bf16 a[188:191],a[148:151],v[56:59],a[188:191]
v_exp_f32 v76,v76
v_mfma_f32_16x16x32_bf16 a[184:187],a[144:147],v[56:59],a[184:187]
v_exp_f32 v77,v77
v_mfma_f32_16x16x32_bf16 v[136:139],a[144:147],v[52:55],v[136:139]
v_exp_f32 v78,v78
v_mfma_f32_16x16x32_bf16 v[140:143],a[148:151],v[52:55],v[140:143]
v_exp_f32 v79,v79
v_mfma_f32_16x16x32_bf16 v[236:239],a[148:151],v[48:51],v[236:239]
v_cvt_pk_bf16_f32 v22,v76,v77
v_cvt_pk_bf16_f32 v23,v78,v79
v_mfma_f32_16x16x32_bf16 v[232:235],a[144:147],v[48:51],v[232:235]
v_fma_f32 v87,v87,s36,v14
v_fma_f32 v92,v92,s36,v15
v_mfma_f32_16x16x32_bf16 v[184:187],a[144:147],v[44:47],v[184:187]
v_exp_f32 v84,v84
v_mfma_f32_16x16x32_bf16 v[188:191],a[148:151],v[44:47],v[188:191]
v_exp_f32 v85,v85
v_mfma_f32_16x16x32_bf16 v[192:195],a[120:123],v[44:47],v[192:195]
v_exp_f32 v86,v86
v_mfma_f32_16x16x32_bf16 v[196:199],a[124:127],v[44:47],v[196:199]
s_waitcnt vmcnt(12) lgkmcnt(0)
v_exp_f32 v87,v87
v_mfma_f32_16x16x32_bf16 v[244:247],a[124:127],v[48:51],v[244:247]
s_barrier
v_mfma_f32_16x16x32_bf16 v[240:243],a[120:123],v[48:51],v[240:243]
ds_read_b128 a[136:139],v0 offset:24576
v_cvt_pk_bf16_f32 v26,v84,v85
v_mfma_f32_16x16x32_bf16 v[144:147],a[120:123],v[52:55],v[144:147]
ds_read_b128 a[140:143],v1 offset:24576
v_cvt_pk_bf16_f32 v27,v86,v87
v_mfma_f32_16x16x32_bf16 v[148:151],a[124:127],v[52:55],v[148:151]
ds_read_b128 a[144:147],v0 offset:24704
v_fma_f32 v93,v93,s36,v15
v_smfmac_f32_16x16x64_bf16 v[60:63],a[152:155],v[20:27],v18
ds_read_b128 a[148:151],v1 offset:24704
v_mfma_f32_16x16x32_bf16 a[196:199],a[124:127],v[56:59],a[196:199]
v_fma_f32 v94,v94,s36,v15
v_fma_f32 v95,v95,s36,v15
v_mfma_f32_16x16x32_bf16 a[192:195],a[120:123],v[56:59],a[192:195]
buffer_load_dwordx4 v6,s[8:11],s21 offen offset:0 lds
v_mfma_f32_16x16x32_bf16 a[240:243],a[120:123],v[40:43],a[240:243]
ds_read_b128 a[120:123],v0 offset:24832
v_fma_f32 v100,v100,s36,v16
v_mfma_f32_16x16x32_bf16 a[244:247],a[124:127],v[40:43],a[244:247]
ds_read_b128 a[124:127],v1 offset:24832
v_fma_f32 v101,v101,s36,v16
v_mfma_f32_16x16x32_bf16 a[248:251],a[128:131],v[40:43],a[248:251]
v_exp_f32 v92,v92
v_mfma_f32_16x16x32_bf16 a[252:255],a[132:135],v[40:43],a[252:255]
v_exp_f32 v93,v93
v_mfma_f32_16x16x32_bf16 a[204:207],a[132:135],v[56:59],a[204:207]
v_exp_f32 v94,v94
v_mfma_f32_16x16x32_bf16 a[200:203],a[128:131],v[56:59],a[200:203]
v_exp_f32 v95,v95
v_mfma_f32_16x16x32_bf16 v[152:155],a[128:131],v[52:55],v[152:155]
v_cvt_pk_bf16_f32 v30,v92,v93
v_cvt_pk_bf16_f32 v31,v94,v95
v_mfma_f32_16x16x32_bf16 v[156:159],a[132:135],v[52:55],v[156:159]
v_fma_f32 v102,v102,s36,v16
v_fma_f32 v103,v103,s36,v16
v_mfma_f32_16x16x32_bf16 v[252:255],a[132:135],v[48:51],v[252:255]
v_exp_f32 v100,v100
v_mfma_f32_16x16x32_bf16 v[248:251],a[128:131],v[48:51],v[248:251]
v_exp_f32 v101,v101
v_mfma_f32_16x16x32_bf16 v[200:203],a[128:131],v[44:47],v[200:203]
buffer_load_dwordx4 v7,s[8:11],s21 offen offset:1024 lds
v_mfma_f32_16x16x32_bf16 v[204:207],a[132:135],v[44:47],v[204:207]
s_waitcnt lgkmcnt(0)
ds_read_b128 a[128:131],v0 offset:30720
v_cvt_pk_bf16_f32 v34,v100,v101
v_mfma_f32_16x16x32_bf16 v[72:75],a[136:139],a[0:3],0
ds_read_b128 a[132:135],v1 offset:30720
v_fma_f32 v108,v108,s36,v17
v_mfma_f32_16x16x32_bf16 v[72:75],a[140:143],a[4:7],v[72:75]
v_exp_f32 v102,v102
v_mfma_f32_16x16x32_bf16 v[72:75],a[144:147],a[8:11],v[72:75]
v_exp_f32 v103,v103
v_mfma_f32_16x16x32_bf16 v[72:75],a[148:151],a[12:15],v[72:75]
v_cvt_pk_bf16_f32 v35,v102,v103
v_fma_f32 v109,v109,s36,v17
v_mfma_f32_16x16x32_bf16 v[72:75],a[120:123],a[16:19],v[72:75]
v_fma_f32 v110,v110,s36,v17
v_fma_f32 v111,v111,s36,v17
v_smfmac_f32_16x16x64_bf16 v[64:67],a[152:155],v[28:35],v18
v_mfma_f32_16x16x32_bf16 v[72:75],a[124:127],a[20:23],v[72:75]
v_exp_f32 v108,v108
v_mfma_f32_16x16x32_bf16 v[80:83],a[124:127],a[44:47],0
v_exp_f32 v109,v109
v_mfma_f32_16x16x32_bf16 v[80:83],a[120:123],a[40:43],v[80:83]
v_exp_f32 v110,v110
v_mfma_f32_16x16x32_bf16 v[80:83],a[148:151],a[36:39],v[80:83]
v_exp_f32 v111,v111
v_mfma_f32_16x16x32_bf16 v[80:83],a[144:147],a[32:35],v[80:83]
buffer_load_dwordx4 v8,s[8:11],s21 offen offset:2048 lds
v_mfma_f32_16x16x32_bf16 v[80:83],a[140:143],a[28:31],v[80:83]
s_add_u32 s21,s21,12288
v_cvt_pk_bf16_f32 v38,v108,v109
v_cvt_pk_bf16_f32 v39,v110,v111
v_mfma_f32_16x16x32_bf16 v[80:83],a[136:139],a[24:27],v[80:83]
s_add_u32 m0,s22,12288
v_fma_f32 v72,v72,s36,v13
v_fma_f32 v73,v73,s36,v13
v_mfma_f32_16x16x32_bf16 v[88:91],a[136:139],a[48:51],0
v_fma_f32 v74,v74,s36,v13
v_fma_f32 v75,v75,s36,v13
v_mfma_f32_16x16x32_bf16 v[88:91],a[140:143],a[52:55],v[88:91]
v_exp_f32 v72,v72
v_mfma_f32_16x16x32_bf16 v[88:91],a[144:147],a[56:59],v[88:91]
v_fma_f32 v80,v80,s36,v14
v_fma_f32 v81,v81,s36,v14
v_mfma_f32_16x16x32_bf16 v[88:91],a[148:151],a[60:63],v[88:91]
v_fma_f32 v82,v82,s36,v14
v_fma_f32 v83,v83,s36,v14
v_mfma_f32_16x16x32_bf16 v[88:91],a[120:123],a[64:67],v[88:91]
v_exp_f32 v73,v73
v_mfma_f32_16x16x32_bf16 v[88:91],a[124:127],a[68:71],v[88:91]
v_exp_f32 v74,v74
v_mfma_f32_16x16x32_bf16 v[96:99],a[124:127],a[92:95],0
v_exp_f32 v75,v75
v_mfma_f32_16x16x32_bf16 v[96:99],a[120:123],a[88:91],v[96:99]
v_exp_f32 v80,v80
v_mfma_f32_16x16x32_bf16 v[96:99],a[148:151],a[84:87],v[96:99]
buffer_load_dwordx4 v6,s[4:7],s20 offen offset:0 lds
v_mfma_f32_16x16x32_bf16 v[96:99],a[144:147],a[80:83],v[96:99]
v_fma_f32 v88,v88,s36,v15
v_fma_f32 v89,v89,s36,v15
v_mfma_f32_16x16x32_bf16 v[96:99],a[140:143],a[76:79],v[96:99]
v_exp_f32 v81,v81
v_mfma_f32_16x16x32_bf16 v[96:99],a[136:139],a[72:75],v[96:99]
v_exp_f32 v82,v82
v_mfma_f32_16x16x32_bf16 v[104:107],a[136:139],a[96:99],0
ds_read_b128 a[136:139],v0 offset:30848
v_cvt_pk_bf16_f32 v44,v72,v73
v_mfma_f32_16x16x32_bf16 v[104:107],a[140:143],a[100:103],v[104:107]
ds_read_b128 a[140:143],v1 offset:30848
v_cvt_pk_bf16_f32 v45,v74,v75
v_mfma_f32_16x16x32_bf16 v[104:107],a[144:147],a[104:107],v[104:107]
ds_read_b128 a[144:147],v0 offset:30976
v_cvt_pk_bf16_f32 v48,v80,v81
v_mfma_f32_16x16x32_bf16 v[104:107],a[148:151],a[108:111],v[104:107]
ds_read_b128 a[148:151],v1 offset:30976
v_mfma_f32_16x16x32_bf16 v[104:107],a[120:123],a[112:115],v[104:107]
v_exp_f32 v83,v83
v_mfma_f32_16x16x32_bf16 v[104:107],a[124:127],a[116:119],v[104:107]
s_waitcnt lgkmcnt(4)
v_exp_f32 v88,v88
v_mfma_f32_16x16x32_bf16 v[76:79],a[128:131],a[0:3],0
v_exp_f32 v89,v89
v_mfma_f32_16x16x32_bf16 v[76:79],a[132:135],a[4:7],v[76:79]
buffer_load_dwordx4 v7,s[4:7],s20 offen offset:1024 lds
s_waitcnt lgkmcnt(3)
v_mfma_f32_16x16x32_bf16 v[76:79],a[136:139],a[8:11],v[76:79]
s_waitcnt lgkmcnt(2)
v_cvt_pk_bf16_f32 v49,v82,v83
v_cvt_pk_bf16_f32 v52,v88,v89
v_mfma_f32_16x16x32_bf16 v[76:79],a[140:143],a[12:15],v[76:79]
s_waitcnt lgkmcnt(0)
v_mfma_f32_16x16x32_bf16 v[76:79],a[144:147],a[16:19],v[76:79]
v_mfma_f32_16x16x32_bf16 v[76:79],a[148:151],a[20:23],v[76:79]
v_mfma_f32_16x16x32_bf16 v[84:87],a[148:151],a[44:47],0
v_mfma_f32_16x16x32_bf16 v[84:87],a[144:147],a[40:43],v[84:87]
v_mfma_f32_16x16x32_bf16 v[84:87],a[140:143],a[36:39],v[84:87]
v_mfma_f32_16x16x32_bf16 v[84:87],a[136:139],a[32:35],v[84:87]
v_mfma_f32_16x16x32_bf16 v[84:87],a[132:135],a[28:31],v[84:87]
v_mfma_f32_16x16x32_bf16 v[84:87],a[128:131],a[24:27],v[84:87]
v_mfma_f32_16x16x32_bf16 v[92:95],a[128:131],a[48:51],0
v_mfma_f32_16x16x32_bf16 v[92:95],a[132:135],a[52:55],v[92:95]
buffer_load_dwordx4 v8,s[4:7],s20 offen offset:2048 lds
v_mfma_f32_16x16x32_bf16 v[92:95],a[136:139],a[56:59],v[92:95]
s_add_u32 s20,s20,12288
v_mfma_f32_16x16x32_bf16 v[92:95],a[140:143],a[60:63],v[92:95]
v_mfma_f32_16x16x32_bf16 v[92:95],a[144:147],a[64:67],v[92:95]
v_mfma_f32_16x16x32_bf16 v[92:95],a[148:151],a[68:71],v[92:95]
v_mfma_f32_16x16x32_bf16 v[100:103],a[148:151],a[92:95],0
ds_read_b64_tr_b16 a[120:121],v2 offset:12288
v_mfma_f32_16x16x32_bf16 v[100:103],a[144:147],a[88:91],v[100:103]
ds_read_b64_tr_b16 a[122:123],v2 offset:18432
v_mfma_f32_16x16x32_bf16 v[100:103],a[140:143],a[84:87],v[100:103]
v_mfma_f32_16x16x32_bf16 v[100:103],a[136:139],a[80:83],v[100:103]
ds_read_b64_tr_b16 a[124:125],v3 offset:12288
v_mfma_f32_16x16x32_bf16 v[100:103],a[132:135],a[76:79],v[100:103]
ds_read_b64_tr_b16 a[126:127],v3 offset:18432
v_mfma_f32_16x16x32_bf16 v[100:103],a[128:131],a[72:75],v[100:103]
v_mfma_f32_16x16x32_bf16 v[108:111],a[128:131],a[96:99],0
ds_read_b64_tr_b16 a[128:129],v4 offset:12288
v_mfma_f32_16x16x32_bf16 v[108:111],a[132:135],a[100:103],v[108:111]
ds_read_b64_tr_b16 a[130:131],v4 offset:18432
v_mfma_f32_16x16x32_bf16 v[108:111],a[136:139],a[104:107],v[108:111]
ds_read_b64_tr_b16 a[132:133],v5 offset:12288
v_mfma_f32_16x16x32_bf16 v[108:111],a[140:143],a[108:111],v[108:111]
ds_read_b64_tr_b16 a[134:135],v5 offset:18432
v_mfma_f32_16x16x32_bf16 v[108:111],a[144:147],a[112:115],v[108:111]
v_mfma_f32_16x16x32_bf16 v[108:111],a[148:151],a[116:119],v[108:111]
s_waitcnt lgkmcnt(4)
v_mfma_f32_16x16x32_bf16 v[160:163],a[120:123],v[20:23],v[160:163]
s_add_u32 m0,s23,12288
ds_read_b64_tr_b16 a[136:137],v2 offset:12416
v_mbcnt_lo_u32_b32 v19,-1,0
v_mfma_f32_16x16x32_bf16 v[164:167],a[124:127],v[20:23],v[164:167]
ds_read_b64_tr_b16 a[138:139],v2 offset:18560
v_mbcnt_hi_u32_b32 v19,-1,v19
v_mfma_f32_16x16x32_bf16 v[212:215],a[124:127],v[24:27],v[212:215]
ds_read_b64_tr_b16 a[140:141],v3 offset:12416
v_min_u32 v19,7,v19
v_mfma_f32_16x16x32_bf16 v[208:211],a[120:123],v[24:27],v[208:211]
ds_read_b64_tr_b16 a[142:143],v3 offset:18560
v_lshl_add_u32 v19,v19,7,s48
v_mfma_f32_16x16x32_bf16 v[112:115],a[120:123],v[28:31],v[112:115]
ds_read_b64_tr_b16 a[144:145],v4 offset:12416
v_min_u32 v19,L_codeend-L_first-4,v19
v_mfma_f32_16x16x32_bf16 v[116:119],a[124:127],v[28:31],v[116:119]
ds_read_b64_tr_b16 a[146:147],v4 offset:18560
v_fma_f32 v90,v90,s36,v15
v_mfma_f32_16x16x32_bf16 a[164:167],a[124:127],v[32:35],a[164:167]
ds_read_b64_tr_b16 a[148:149],v5 offset:12416
v_fma_f32 v91,v91,s36,v15
v_mfma_f32_16x16x32_bf16 a[160:163],a[120:123],v[32:35],a[160:163]
ds_read_b64_tr_b16 a[150:151],v5 offset:18560
v_fma_f32 v96,v96,s36,v16
v_mfma_f32_16x16x32_bf16 a[208:211],a[120:123],v[36:39],a[208:211]
ds_read_b64_tr_b16 a[120:121],v2 offset:12544
v_fma_f32 v97,v97,s36,v16
v_mfma_f32_16x16x32_bf16 a[212:215],a[124:127],v[36:39],a[212:215]
s_waitcnt lgkmcnt(6)
ds_read_b64_tr_b16 a[122:123],v2 offset:18688
v_fma_f32 v98,v98,s36,v16
v_mfma_f32_16x16x32_bf16 a[216:219],a[128:131],v[36:39],a[216:219]
ds_read_b64_tr_b16 a[124:125],v3 offset:12544
v_fma_f32 v99,v99,s36,v16
v_mfma_f32_16x16x32_bf16 a[220:223],a[132:135],v[36:39],a[220:223]
ds_read_b64_tr_b16 a[126:127],v3 offset:18688
v_fma_f32 v104,v104,s36,v17
v_mfma_f32_16x16x32_bf16 a[172:175],a[132:135],v[32:35],a[172:175]
v_exp_f32 v90,v90
v_mfma_f32_16x16x32_bf16 a[168:171],a[128:131],v[32:35],a[168:171]
v_exp_f32 v91,v91
v_mfma_f32_16x16x32_bf16 v[120:123],a[128:131],v[28:31],v[120:123]
v_cvt_pk_bf16_f32 v53,v90,v91
v_fma_f32 v105,v105,s36,v17
v_mfma_f32_16x16x32_bf16 v[124:127],a[132:135],v[28:31],v[124:127]
v_exp_f32 v96,v96
v_mfma_f32_16x16x32_bf16 v[220:223],a[132:135],v[24:27],v[220:223]
v_exp_f32 v97,v97
v_mfma_f32_16x16x32_bf16 v[216:219],a[128:131],v[24:27],v[216:219]
v_exp_f32 v98,v98
v_mfma_f32_16x16x32_bf16 v[168:171],a[128:131],v[20:23],v[168:171]
global_load_dword v19,v19,s[46:47]
v_mfma_f32_16x16x32_bf16 v[172:175],a[132:135],v[20:23],v[172:175]
ds_read_b64_tr_b16 a[128:129],v4 offset:12544
v_cvt_pk_bf16_f32 v56,v96,v97
v_mfma_f32_16x16x32_bf16 v[176:179],a[136:139],v[20:23],v[176:179]
s_waitcnt lgkmcnt(1)
ds_read_b64_tr_b16 a[130:131],v4 offset:18688
v_fma_f32 v106,v106,s36,v17
v_mfma_f32_16x16x32_bf16 v[180:183],a[140:143],v[20:23],v[180:183]
ds_read_b64_tr_b16 a[132:133],v5 offset:12544
v_fma_f32 v107,v107,s36,v17
v_mfma_f32_16x16x32_bf16 v[228:231],a[140:143],v[24:27],v[228:231]
ds_read_b64_tr_b16 a[134:135],v5 offset:18688
v_fma_f32 v76,v76,s36,v13
v_mfma_f32_16x16x32_bf16 v[224:227],a[136:139],v[24:27],v[224:227]
v_exp_f32 v99,v99
v_mfma_f32_16x16x32_bf16 v[128:131],a[136:139],v[28:31],v[128:131]
v_cvt_pk_bf16_f32 v57,v98,v99
v_fma_f32 v77,v77,s36,v13
v_mfma_f32_16x16x32_bf16 v[132:135],a[140:143],v[28:31],v[132:135]
v_exp_f32 v104,v104
v_mfma_f32_16x16x32_bf16 a[180:183],a[140:143],v[32:35],a[180:183]
v_exp_f32 v105,v105
v_mfma_f32_16x16x32_bf16 a[176:179],a[136:139],v[32:35],a[176:179]
v_exp_f32 v106,v106
v_mfma_f32_16x16x32_bf16 a[224:227],a[136:139],v[36:39],a[224:227]
v_exp_f32 v107,v107
v_mfma_f32_16x16x32_bf16 a[228:231],a[140:143],v[36:39],a[228:231]
v_cvt_pk_bf16_f32 v40,v104,v105
v_cvt_pk_bf16_f32 v41,v106,v107
v_mfma_f32_16x16x32_bf16 a[232:235],a[144:147],v[36:39],a[232:235]
v_fma_f32 v78,v78,s36,v13
v_fma_f32 v79,v79,s36,v13
v_mfma_f32_16x16x32_bf16 a[236:239],a[148:151],v[36:39],a[236:239]
v_exp_f32 v76,v76
v_mfma_f32_16x16x32_bf16 a[188:191],a[148:151],v[32:35],a[188:191]
v_exp_f32 v77,v77
v_mfma_f32_16x16x32_bf16 a[184:187],a[144:147],v[32:35],a[184:187]
v_exp_f32 v78,v78
v_mfma_f32_16x16x32_bf16 v[136:139],a[144:147],v[28:31],v[136:139]
v_exp_f32 v79,v79
v_mfma_f32_16x16x32_bf16 v[140:143],a[148:151],v[28:31],v[140:143]
v_cvt_pk_bf16_f32 v46,v76,v77
v_cvt_pk_bf16_f32 v47,v78,v79
v_mfma_f32_16x16x32_bf16 v[236:239],a[148:151],v[24:27],v[236:239]
v_fma_f32 v84,v84,s36,v14
v_fma_f32 v85,v85,s36,v14
v_mfma_f32_16x16x32_bf16 v[232:235],a[144:147],v[24:27],v[232:235]
v_fma_f32 v86,v86,s36,v14
v_fma_f32 v87,v87,s36,v14
v_mfma_f32_16x16x32_bf16 v[184:187],a[144:147],v[20:23],v[184:187]
v_exp_f32 v84,v84
v_mfma_f32_16x16x32_bf16 v[188:191],a[148:151],v[20:23],v[188:191]
v_exp_f32 v85,v85
v_mfma_f32_16x16x32_bf16 v[192:195],a[120:123],v[20:23],v[192:195]
v_exp_f32 v86,v86
v_mfma_f32_16x16x32_bf16 v[196:199],a[124:127],v[20:23],v[196:199]
s_waitcnt vmcnt(10) lgkmcnt(0)
v_cvt_pk_bf16_f32 v50,v84,v85
v_mfma_f32_16x16x32_bf16 v[244:247],a[124:127],v[24:27],v[244:247]
s_barrier
v_mfma_f32_16x16x32_bf16 v[240:243],a[120:123],v[24:27],v[240:243]
ds_read_b128 a[136:139],v0 offset:0
v_fma_f32 v92,v92,s36,v15
v_mfma_f32_16x16x32_bf16 v[144:147],a[120:123],v[28:31],v[144:147]
ds_read_b128 a[140:143],v1 offset:0
v_fma_f32 v93,v93,s36,v15
v_mfma_f32_16x16x32_bf16 v[148:151],a[124:127],v[28:31],v[148:151]
ds_read_b128 a[144:147],v0 offset:128
v_fma_f32 v94,v94,s36,v15
v_mfma_f32_16x16x32_bf16 a[196:199],a[124:127],v[32:35],a[196:199]
ds_read_b128 a[148:151],v1 offset:128
v_fma_f32 v95,v95,s36,v15
v_mfma_f32_16x16x32_bf16 a[192:195],a[120:123],v[32:35],a[192:195]
ds_read_b128 a[156:159],v10 offset:3072
v_fma_f32 v100,v100,s36,v16
v_mfma_f32_16x16x32_bf16 a[240:243],a[120:123],v[36:39],a[240:243]
buffer_load_dwordx4 v6,s[8:11],s21 offen offset:0 lds
v_mfma_f32_16x16x32_bf16 a[244:247],a[124:127],v[36:39],a[244:247]
ds_read_b128 a[120:123],v0 offset:256
v_fma_f32 v101,v101,s36,v16
v_mfma_f32_16x16x32_bf16 a[248:251],a[128:131],v[36:39],a[248:251]
ds_read_b128 a[124:127],v1 offset:256
v_fma_f32 v102,v102,s36,v16
v_mfma_f32_16x16x32_bf16 a[252:255],a[132:135],v[36:39],a[252:255]
v_exp_f32 v87,v87
v_mfma_f32_16x16x32_bf16 a[204:207],a[132:135],v[32:35],a[204:207]
v_cvt_pk_bf16_f32 v51,v86,v87
v_fma_f32 v103,v103,s36,v16
v_mfma_f32_16x16x32_bf16 a[200:203],a[128:131],v[32:35],a[200:203]
v_exp_f32 v92,v92
v_smfmac_f32_16x16x64_bf16 v[60:63],a[152:155],v[44:51],v18
v_fma_f32 v108,v108,s36,v17
v_mfma_f32_16x16x32_bf16 v[152:155],a[128:131],v[28:31],v[152:155]
v_exp_f32 v93,v93
v_mfma_f32_16x16x32_bf16 v[156:159],a[132:135],v[28:31],v[156:159]
v_exp_f32 v94,v94
v_mfma_f32_16x16x32_bf16 v[252:255],a[132:135],v[24:27],v[252:255]
v_exp_f32 v95,v95
v_mfma_f32_16x16x32_bf16 v[248:251],a[128:131],v[24:27],v[248:251]
v_cvt_pk_bf16_f32 v54,v92,v93
v_cvt_pk_bf16_f32 v55,v94,v95
v_mfma_f32_16x16x32_bf16 v[200:203],a[128:131],v[20:23],v[200:203]
ds_read_b128 a[128:131],v0 offset:6144
v_fma_f32 v109,v109,s36,v17
v_mfma_f32_16x16x32_bf16 v[204:207],a[132:135],v[20:23],v[204:207]
s_waitcnt lgkmcnt(1)
buffer_store_dwordx4 a[156:159],v9,s[16:19],s27 offen offset:0 nt
buffer_load_dwordx4 v7,s[8:11],s21 offen offset:1024 lds
v_mfma_f32_16x16x32_bf16 v[72:75],a[136:139],a[0:3],0
ds_read_b128 a[132:135],v1 offset:6144
v_fma_f32 v110,v110,s36,v17
v_mfma_f32_16x16x32_bf16 v[72:75],a[140:143],a[4:7],v[72:75]
v_exp_f32 v100,v100
v_mfma_f32_16x16x32_bf16 v[72:75],a[144:147],a[8:11],v[72:75]
v_exp_f32 v101,v101
v_mfma_f32_16x16x32_bf16 v[72:75],a[148:151],a[12:15],v[72:75]
v_exp_f32 v102,v102
v_mfma_f32_16x16x32_bf16 v[72:75],a[120:123],a[16:19],v[72:75]
v_exp_f32 v103,v103
v_mfma_f32_16x16x32_bf16 v[72:75],a[124:127],a[20:23],v[72:75]
ds_read_b128 a[156:159],v10 offset:4096
v_cvt_pk_bf16_f32 v58,v100,v101
v_mfma_f32_16x16x32_bf16 v[80:83],a[124:127],a[44:47],0
v_cvt_pk_bf16_f32 v59,v102,v103
v_fma_f32 v111,v111,s36,v17
v_mfma_f32_16x16x32_bf16 v[80:83],a[120:123],a[40:43],v[80:83]
v_exp_f32 v108,v108
v_smfmac_f32_16x16x64_bf16 v[64:67],a[152:155],v[52:59],v18
v_fma_f32 v72,v72,s36,v13
v_mfma_f32_16x16x32_bf16 v[80:83],a[148:151],a[36:39],v[80:83]
buffer_load_dwordx4 v8,s[8:11],s21 offen offset:2048 lds
v_mfma_f32_16x16x32_bf16 v[80:83],a[144:147],a[32:35],v[80:83]
s_add_u32 s21,s21,12288
v_exp_f32 v109,v109
v_mfma_f32_16x16x32_bf16 v[80:83],a[140:143],a[28:31],v[80:83]
s_add_u32 m0,s22,24576
v_exp_f32 v110,v110
v_mfma_f32_16x16x32_bf16 v[80:83],a[136:139],a[24:27],v[80:83]
v_exp_f32 v111,v111
v_mfma_f32_16x16x32_bf16 v[88:91],a[136:139],a[48:51],0
v_cvt_pk_bf16_f32 v42,v108,v109
v_cvt_pk_bf16_f32 v43,v110,v111
v_mfma_f32_16x16x32_bf16 v[88:91],a[140:143],a[52:55],v[88:91]
v_fma_f32 v73,v73,s36,v13
v_fma_f32 v74,v74,s36,v13
v_smfmac_f32_16x16x64_bf16 v[68:71],a[152:155],v[36:43],v18
v_fma_f32 v75,v75,s36,v13
v_mfma_f32_16x16x32_bf16 v[88:91],a[144:147],a[56:59],v[88:91]
v_fma_f32 v80,v80,s36,v14
v_fma_f32 v81,v81,s36,v14
v_mfma_f32_16x16x32_bf16 v[88:91],a[148:151],a[60:63],v[88:91]
v_fma_f32 v82,v82,s36,v14
v_fma_f32 v83,v83,s36,v14
v_mfma_f32_16x16x32_bf16 v[88:91],a[120:123],a[64:67],v[88:91]
v_exp_f32 v72,v72
v_mfma_f32_16x16x32_bf16 v[88:91],a[124:127],a[68:71],v[88:91]
v_exp_f32 v73,v73
v_mfma_f32_16x16x32_bf16 v[96:99],a[124:127],a[92:95],0
v_exp_f32 v74,v74
v_mfma_f32_16x16x32_bf16 v[96:99],a[120:123],a[88:91],v[96:99]
s_waitcnt lgkmcnt(0)
buffer_store_dwordx4 a[156:159],v9,s[16:19],s27 offen offset:128 nt
buffer_load_dwordx4 v6,s[4:7],s20 offen offset:0 lds
v_mfma_f32_16x16x32_bf16 v[96:99],a[148:151],a[84:87],v[96:99]
v_exp_f32 v75,v75
v_mfma_f32_16x16x32_bf16 v[96:99],a[144:147],a[80:83],v[96:99]
v_fma_f32 v88,v88,s36,v15
v_fma_f32 v89,v89,s36,v15
v_mfma_f32_16x16x32_bf16 v[96:99],a[140:143],a[76:79],v[96:99]
v_exp_f32 v80,v80
v_mfma_f32_16x16x32_bf16 v[96:99],a[136:139],a[72:75],v[96:99]
v_exp_f32 v81,v81
v_mfma_f32_16x16x32_bf16 v[104:107],a[136:139],a[96:99],0
ds_read_b128 a[136:139],v0 offset:6272
v_cvt_pk_bf16_f32 v20,v72,v73
v_mfma_f32_16x16x32_bf16 v[104:107],a[140:143],a[100:103],v[104:107]
ds_read_b128 a[156:159],v10 offset:5120
v_cvt_pk_bf16_f32 v21,v74,v75
v_mfma_f32_16x16x32_bf16 v[104:107],a[144:147],a[104:107],v[104:107]
ds_read_b128 a[140:143],v1 offset:6272
v_cvt_pk_bf16_f32 v24,v80,v81
v_mfma_f32_16x16x32_bf16 v[104:107],a[148:151],a[108:111],v[104:107]
ds_read_b128 a[144:147],v0 offset:6400
v_mfma_f32_16x16x32_bf16 v[104:107],a[120:123],a[112:115],v[104:107]
ds_read_b128 a[148:151],v1 offset:6400
v_mfma_f32_16x16x32_bf16 v[104:107],a[124:127],a[116:119],v[104:107]
buffer_load_dwordx4 v7,s[4:7],s20 offen offset:1024 lds
v_mfma_f32_16x16x32_bf16 v[76:79],a[128:131],a[0:3],0
v_exp_f32 v82,v82
v_mfma_f32_16x16x32_bf16 v[76:79],a[132:135],a[4:7],v[76:79]
s_waitcnt lgkmcnt(4)
v_exp_f32 v83,v83
v_mfma_f32_16x16x32_bf16 v[76:79],a[136:139],a[8:11],v[76:79]
s_waitcnt lgkmcnt(2)
v_exp_f32 v88,v88
v_exp_f32 v89,v89
v_mfma_f32_16x16x32_bf16 v[76:79],a[140:143],a[12:15],v[76:79]
s_waitcnt lgkmcnt(1)
v_cvt_pk_bf16_f32 v25,v82,v83
v_cvt_pk_bf16_f32 v28,v88,v89
v_mfma_f32_16x16x32_bf16 v[76:79],a[144:147],a[16:19],v[76:79]
s_waitcnt lgkmcnt(0)
v_mfma_f32_16x16x32_bf16 v[76:79],a[148:151],a[20:23],v[76:79]
v_mfma_f32_16x16x32_bf16 v[84:87],a[148:151],a[44:47],0
v_mfma_f32_16x16x32_bf16 v[84:87],a[144:147],a[40:43],v[84:87]
v_mfma_f32_16x16x32_bf16 v[84:87],a[140:143],a[36:39],v[84:87]
v_mfma_f32_16x16x32_bf16 v[84:87],a[136:139],a[32:35],v[84:87]
v_mfma_f32_16x16x32_bf16 v[84:87],a[132:135],a[28:31],v[84:87]
buffer_store_dwordx4 a[156:159],v9,s[16:19],s27 offen offset:256 nt
buffer_load_dwordx4 v8,s[4:7],s20 offen offset:2048 lds
v_mfma_f32_16x16x32_bf16 v[84:87],a[128:131],a[24:27],v[84:87]
s_add_u32 s20,s20,12288
v_mfma_f32_16x16x32_bf16 v[92:95],a[128:131],a[48:51],0
s_add_u32 s27,s27,3072
v_mfma_f32_16x16x32_bf16 v[92:95],a[132:135],a[52:55],v[92:95]
v_mfma_f32_16x16x32_bf16 v[92:95],a[136:139],a[56:59],v[92:95]
v_mfma_f32_16x16x32_bf16 v[92:95],a[140:143],a[60:63],v[92:95]
ds_read_b64_tr_b16 a[120:121],v2 offset:24576
v_mfma_f32_16x16x32_bf16 v[92:95],a[144:147],a[64:67],v[92:95]
ds_read_b64_tr_b16 a[122:123],v2 offset:30720
v_mfma_f32_16x16x32_bf16 v[92:95],a[148:151],a[68:71],v[92:95]
v_mfma_f32_16x16x32_bf16 v[100:103],a[148:151],a[92:95],0
ds_read_b64_tr_b16 a[124:125],v3 offset:24576
v_mfma_f32_16x16x32_bf16 v[100:103],a[144:147],a[88:91],v[100:103]
ds_read_b64_tr_b16 a[126:127],v3 offset:30720
v_mfma_f32_16x16x32_bf16 v[100:103],a[140:143],a[84:87],v[100:103]
v_mfma_f32_16x16x32_bf16 v[100:103],a[136:139],a[80:83],v[100:103]
v_mfma_f32_16x16x32_bf16 v[100:103],a[132:135],a[76:79],v[100:103]
v_mfma_f32_16x16x32_bf16 v[100:103],a[128:131],a[72:75],v[100:103]
v_mfma_f32_16x16x32_bf16 v[108:111],a[128:131],a[96:99],0
ds_read_b64_tr_b16 a[128:129],v4 offset:24576
v_mfma_f32_16x16x32_bf16 v[108:111],a[132:135],a[100:103],v[108:111]
ds_read_b64_tr_b16 a[130:131],v4 offset:30720
v_mfma_f32_16x16x32_bf16 v[108:111],a[136:139],a[104:107],v[108:111]
ds_read_b64_tr_b16 a[132:133],v5 offset:24576
v_mfma_f32_16x16x32_bf16 v[108:111],a[140:143],a[108:111],v[108:111]
ds_read_b64_tr_b16 a[134:135],v5 offset:30720
v_mfma_f32_16x16x32_bf16 v[108:111],a[144:147],a[112:115],v[108:111]
v_mfma_f32_16x16x32_bf16 v[108:111],a[148:151],a[116:119],v[108:111]
s_waitcnt lgkmcnt(4)
v_mfma_f32_16x16x32_bf16 v[160:163],a[120:123],v[44:47],v[160:163]
s_add_u32 m0,s29,0
ds_read_b64_tr_b16 a[136:137],v2 offset:24704
v_fma_f32 v90,v90,s36,v15
v_mfma_f32_16x16x32_bf16 v[164:167],a[124:127],v[44:47],v[164:167]
ds_read_b64_tr_b16 a[138:139],v2 offset:30848
v_fma_f32 v91,v91,s36,v15
v_mfma_f32_16x16x32_bf16 v[212:215],a[124:127],v[48:51],v[212:215]
ds_read_b64_tr_b16 a[140:141],v3 offset:24704
v_fma_f32 v96,v96,s36,v16
v_mfma_f32_16x16x32_bf16 v[208:211],a[120:123],v[48:51],v[208:211]
ds_read_b64_tr_b16 a[142:143],v3 offset:30848
v_fma_f32 v97,v97,s36,v16
v_mfma_f32_16x16x32_bf16 v[112:115],a[120:123],v[52:55],v[112:115]
ds_read_b64_tr_b16 a[144:145],v4 offset:24704
v_fma_f32 v98,v98,s36,v16
v_mfma_f32_16x16x32_bf16 v[116:119],a[124:127],v[52:55],v[116:119]
ds_read_b64_tr_b16 a[146:147],v4 offset:30848
v_fma_f32 v99,v99,s36,v16
v_mfma_f32_16x16x32_bf16 a[164:167],a[124:127],v[56:59],a[164:167]
ds_read_b64_tr_b16 a[148:149],v5 offset:24704
v_fma_f32 v104,v104,s36,v17
v_mfma_f32_16x16x32_bf16 a[160:163],a[120:123],v[56:59],a[160:163]
buffer_load_dwordx4 v6,s[12:15],s28 offen offset:0 nt lds
v_mfma_f32_16x16x32_bf16 a[208:211],a[120:123],v[40:43],a[208:211]
ds_read_b64_tr_b16 a[150:151],v5 offset:30848
v_fma_f32 v105,v105,s36,v17
v_mfma_f32_16x16x32_bf16 a[212:215],a[124:127],v[40:43],a[212:215]
s_waitcnt lgkmcnt(5)
ds_read_b64_tr_b16 a[120:121],v2 offset:24832
v_fma_f32 v106,v106,s36,v17
v_mfma_f32_16x16x32_bf16 a[216:219],a[128:131],v[40:43],a[216:219]
ds_read_b64_tr_b16 a[122:123],v2 offset:30976
v_fma_f32 v107,v107,s36,v17
v_mfma_f32_16x16x32_bf16 a[220:223],a[132:135],v[40:43],a[220:223]
ds_read_b64_tr_b16 a[124:125],v3 offset:24832
v_fma_f32 v76,v76,s36,v13
v_mfma_f32_16x16x32_bf16 a[172:175],a[132:135],v[56:59],a[172:175]
ds_read_b64_tr_b16 a[126:127],v3 offset:30976
v_fma_f32 v77,v77,s36,v13
v_mfma_f32_16x16x32_bf16 a[168:171],a[128:131],v[56:59],a[168:171]
v_exp_f32 v90,v90
v_mfma_f32_16x16x32_bf16 v[120:123],a[128:131],v[52:55],v[120:123]
v_exp_f32 v91,v91
v_mfma_f32_16x16x32_bf16 v[124:127],a[132:135],v[52:55],v[124:127]
v_cvt_pk_bf16_f32 v29,v90,v91
v_fma_f32 v78,v78,s36,v13
v_mfma_f32_16x16x32_bf16 v[220:223],a[132:135],v[48:51],v[220:223]
v_exp_f32 v96,v96
v_mfma_f32_16x16x32_bf16 v[216:219],a[128:131],v[48:51],v[216:219]
buffer_load_dwordx4 v7,s[12:15],s28 offen offset:1024 nt lds
v_mfma_f32_16x16x32_bf16 v[168:171],a[128:131],v[44:47],v[168:171]
ds_read_b64_tr_b16 a[128:129],v4 offset:24832
v_fma_f32 v79,v79,s36,v13
v_mfma_f32_16x16x32_bf16 v[172:175],a[132:135],v[44:47],v[172:175]
ds_read_b64_tr_b16 a[130:131],v4 offset:30976
v_fma_f32 v84,v84,s36,v14
v_mfma_f32_16x16x32_bf16 v[176:179],a[136:139],v[44:47],v[176:179]
s_waitcnt lgkmcnt(2)
ds_read_b64_tr_b16 a[132:133],v5 offset:24832
v_fma_f32 v85,v85,s36,v14
v_mfma_f32_16x16x32_bf16 v[180:183],a[140:143],v[44:47],v[180:183]
ds_read_b64_tr_b16 a[134:135],v5 offset:30976
v_fma_f32 v86,v86,s36,v14
v_mfma_f32_16x16x32_bf16 v[228:231],a[140:143],v[48:51],v[228:231]
v_exp_f32 v97,v97
v_mfma_f32_16x16x32_bf16 v[224:227],a[136:139],v[48:51],v[224:227]
v_exp_f32 v98,v98
v_mfma_f32_16x16x32_bf16 v[128:131],a[136:139],v[52:55],v[128:131]
v_exp_f32 v99,v99
v_mfma_f32_16x16x32_bf16 v[132:135],a[140:143],v[52:55],v[132:135]
v_cvt_pk_bf16_f32 v32,v96,v97
v_cvt_pk_bf16_f32 v33,v98,v99
v_mfma_f32_16x16x32_bf16 a[180:183],a[140:143],v[56:59],a[180:183]
v_exp_f32 v104,v104
v_mfma_f32_16x16x32_bf16 a[176:179],a[136:139],v[56:59],a[176:179]
buffer_load_dwordx4 v8,s[12:15],s28 offen offset:2048 nt lds
v_mfma_f32_16x16x32_bf16 a[224:227],a[136:139],v[40:43],a[224:227]
s_add_u32 s28,s28,3072
v_exp_f32 v105,v105
v_mfma_f32_16x16x32_bf16 a[228:231],a[140:143],v[40:43],a[228:231]
s_add_u32 s29,s29,3072
v_exp_f32 v106,v106
v_mfma_f32_16x16x32_bf16 a[232:235],a[144:147],v[40:43],a[232:235]
s_add_u32 m0,s23,24576
v_exp_f32 v107,v107
v_mfma_f32_16x16x32_bf16 a[236:239],a[148:151],v[40:43],a[236:239]
v_cvt_pk_bf16_f32 v36,v104,v105
v_cvt_pk_bf16_f32 v37,v106,v107
v_mfma_f32_16x16x32_bf16 a[188:191],a[148:151],v[56:59],a[188:191]
v_exp_f32 v76,v76
v_mfma_f32_16x16x32_bf16 a[184:187],a[144:147],v[56:59],a[184:187]
v_exp_f32 v77,v77
v_mfma_f32_16x16x32_bf16 v[136:139],a[144:147],v[52:55],v[136:139]
v_exp_f32 v78,v78
v_mfma_f32_16x16x32_bf16 v[140:143],a[148:151],v[52:55],v[140:143]
v_exp_f32 v79,v79
v_mfma_f32_16x16x32_bf16 v[236:239],a[148:151],v[48:51],v[236:239]
v_cvt_pk_bf16_f32 v22,v76,v77
v_cvt_pk_bf16_f32 v23,v78,v79
v_mfma_f32_16x16x32_bf16 v[232:235],a[144:147],v[48:51],v[232:235]
v_fma_f32 v87,v87,s36,v14
v_fma_f32 v92,v92,s36,v15
v_mfma_f32_16x16x32_bf16 v[184:187],a[144:147],v[44:47],v[184:187]
v_exp_f32 v84,v84
v_mfma_f32_16x16x32_bf16 v[188:191],a[148:151],v[44:47],v[188:191]
v_exp_f32 v85,v85
v_mfma_f32_16x16x32_bf16 v[192:195],a[120:123],v[44:47],v[192:195]
v_exp_f32 v86,v86
v_mfma_f32_16x16x32_bf16 v[196:199],a[124:127],v[44:47],v[196:199]
s_waitcnt vmcnt(13) lgkmcnt(0)
v_exp_f32 v87,v87
v_mfma_f32_16x16x32_bf16 v[244:247],a[124:127],v[48:51],v[244:247]
s_barrier
v_mfma_f32_16x16x32_bf16 v[240:243],a[120:123],v[48:51],v[240:243]
ds_read_b128 a[136:139],v0 offset:12288
v_cvt_pk_bf16_f32 v26,v84,v85
v_mfma_f32_16x16x32_bf16 v[144:147],a[120:123],v[52:55],v[144:147]
ds_read_b128 a[140:143],v1 offset:12288
v_cvt_pk_bf16_f32 v27,v86,v87
v_mfma_f32_16x16x32_bf16 v[148:151],a[124:127],v[52:55],v[148:151]
ds_read_b128 a[144:147],v0 offset:12416
v_fma_f32 v93,v93,s36,v15
v_smfmac_f32_16x16x64_bf16 v[60:63],a[152:155],v[20:27],v18
ds_read_b128 a[148:151],v1 offset:12416
v_mfma_f32_16x16x32_bf16 a[196:199],a[124:127],v[56:59],a[196:199]
v_fma_f32 v94,v94,s36,v15
v_fma_f32 v95,v95,s36,v15
v_mfma_f32_16x16x32_bf16 a[192:195],a[120:123],v[56:59],a[192:195]
buffer_load_dwordx4 v6,s[8:11],s21 offen offset:0 lds
v_mfma_f32_16x16x32_bf16 a[240:243],a[120:123],v[40:43],a[240:243]
ds_read_b128 a[120:123],v0 offset:12544
v_fma_f32 v100,v100,s36,v16
v_mfma_f32_16x16x32_bf16 a[244:247],a[124:127],v[40:43],a[244:247]
ds_read_b128 a[124:127],v1 offset:12544
v_fma_f32 v101,v101,s36,v16
v_mfma_f32_16x16x32_bf16 a[248:251],a[128:131],v[40:43],a[248:251]
v_exp_f32 v92,v92
v_mfma_f32_16x16x32_bf16 a[252:255],a[132:135],v[40:43],a[252:255]
v_exp_f32 v93,v93
v_mfma_f32_16x16x32_bf16 a[204:207],a[132:135],v[56:59],a[204:207]
v_exp_f32 v94,v94
v_mfma_f32_16x16x32_bf16 a[200:203],a[128:131],v[56:59],a[200:203]
v_exp_f32 v95,v95
v_mfma_f32_16x16x32_bf16 v[152:155],a[128:131],v[52:55],v[152:155]
v_cvt_pk_bf16_f32 v30,v92,v93
v_cvt_pk_bf16_f32 v31,v94,v95
v_mfma_f32_16x16x32_bf16 v[156:159],a[132:135],v[52:55],v[156:159]
v_fma_f32 v102,v102,s36,v16
v_fma_f32 v103,v103,s36,v16
v_mfma_f32_16x16x32_bf16 v[252:255],a[132:135],v[48:51],v[252:255]
v_exp_f32 v100,v100
v_mfma_f32_16x16x32_bf16 v[248:251],a[128:131],v[48:51],v[248:251]
v_exp_f32 v101,v101
v_mfma_f32_16x16x32_bf16 v[200:203],a[128:131],v[44:47],v[200:203]
buffer_load_dwordx4 v7,s[8:11],s21 offen offset:1024 lds
v_mfma_f32_16x16x32_bf16 v[204:207],a[132:135],v[44:47],v[204:207]
s_waitcnt lgkmcnt(0)
ds_read_b128 a[128:131],v0 offset:18432
v_cvt_pk_bf16_f32 v34,v100,v101
v_mfma_f32_16x16x32_bf16 v[72:75],a[136:139],a[0:3],0
ds_read_b128 a[132:135],v1 offset:18432
v_fma_f32 v108,v108,s36,v17
v_mfma_f32_16x16x32_bf16 v[72:75],a[140:143],a[4:7],v[72:75]
v_exp_f32 v102,v102
v_mfma_f32_16x16x32_bf16 v[72:75],a[144:147],a[8:11],v[72:75]
v_exp_f32 v103,v103
v_mfma_f32_16x16x32_bf16 v[72:75],a[148:151],a[12:15],v[72:75]
v_cvt_pk_bf16_f32 v35,v102,v103
v_fma_f32 v109,v109,s36,v17
v_mfma_f32_16x16x32_bf16 v[72:75],a[120:123],a[16:19],v[72:75]
v_fma_f32 v110,v110,s36,v17
v_fma_f32 v111,v111,s36,v17
v_smfmac_f32_16x16x64_bf16 v[64:67],a[152:155],v[28:35],v18
v_mfma_f32_16x16x32_bf16 v[72:75],a[124:127],a[20:23],v[72:75]
v_exp_f32 v108,v108
v_mfma_f32_16x16x32_bf16 v[80:83],a[124:127],a[44:47],0
v_exp_f32 v109,v109
v_mfma_f32_16x16x32_bf16 v[80:83],a[120:123],a[40:43],v[80:83]
v_exp_f32 v110,v110
v_mfma_f32_16x16x32_bf16 v[80:83],a[148:151],a[36:39],v[80:83]
v_exp_f32 v111,v111
v_mfma_f32_16x16x32_bf16 v[80:83],a[144:147],a[32:35],v[80:83]
buffer_load_dwordx4 v8,s[8:11],s21 offen offset:2048 lds
v_mfma_f32_16x16x32_bf16 v[80:83],a[140:143],a[28:31],v[80:83]
s_add_u32 s21,s21,12288
v_cvt_pk_bf16_f32 v38,v108,v109
v_cvt_pk_bf16_f32 v39,v110,v111
v_mfma_f32_16x16x32_bf16 v[80:83],a[136:139],a[24:27],v[80:83]
s_add_u32 m0,s22,0
v_fma_f32 v72,v72,s36,v13
v_fma_f32 v73,v73,s36,v13
v_mfma_f32_16x16x32_bf16 v[88:91],a[136:139],a[48:51],0
v_fma_f32 v74,v74,s36,v13
v_fma_f32 v75,v75,s36,v13
v_mfma_f32_16x16x32_bf16 v[88:91],a[140:143],a[52:55],v[88:91]
v_exp_f32 v72,v72
v_mfma_f32_16x16x32_bf16 v[88:91],a[144:147],a[56:59],v[88:91]
v_fma_f32 v80,v80,s36,v14
v_fma_f32 v81,v81,s36,v14
v_mfma_f32_16x16x32_bf16 v[88:91],a[148:151],a[60:63],v[88:91]
v_fma_f32 v82,v82,s36,v14
v_fma_f32 v83,v83,s36,v14
v_mfma_f32_16x16x32_bf16 v[88:91],a[120:123],a[64:67],v[88:91]
v_exp_f32 v73,v73
v_mfma_f32_16x16x32_bf16 v[88:91],a[124:127],a[68:71],v[88:91]
v_exp_f32 v74,v74
v_mfma_f32_16x16x32_bf16 v[96:99],a[124:127],a[92:95],0
v_exp_f32 v75,v75
v_mfma_f32_16x16x32_bf16 v[96:99],a[120:123],a[88:91],v[96:99]
v_exp_f32 v80,v80
v_mfma_f32_16x16x32_bf16 v[96:99],a[148:151],a[84:87],v[96:99]
buffer_load_dwordx4 v6,s[4:7],s20 offen offset:0 lds
v_mfma_f32_16x16x32_bf16 v[96:99],a[144:147],a[80:83],v[96:99]
v_fma_f32 v88,v88,s36,v15
v_fma_f32 v89,v89,s36,v15
v_mfma_f32_16x16x32_bf16 v[96:99],a[140:143],a[76:79],v[96:99]
v_exp_f32 v81,v81
v_mfma_f32_16x16x32_bf16 v[96:99],a[136:139],a[72:75],v[96:99]
v_exp_f32 v82,v82
v_mfma_f32_16x16x32_bf16 v[104:107],a[136:139],a[96:99],0
ds_read_b128 a[136:139],v0 offset:18560
v_cvt_pk_bf16_f32 v44,v72,v73
v_mfma_f32_16x16x32_bf16 v[104:107],a[140:143],a[100:103],v[104:107]
ds_read_b128 a[140:143],v1 offset:18560
v_cvt_pk_bf16_f32 v45,v74,v75
v_mfma_f32_16x16x32_bf16 v[104:107],a[144:147],a[104:107],v[104:107]
ds_read_b128 a[144:147],v0 offset:18688
v_cvt_pk_bf16_f32 v48,v80,v81
v_mfma_f32_16x16x32_bf16 v[104:107],a[148:151],a[108:111],v[104:107]
ds_read_b128 a[148:151],v1 offset:18688
v_mfma_f32_16x16x32_bf16 v[104:107],a[120:123],a[112:115],v[104:107]
v_exp_f32 v83,v83
v_mfma_f32_16x16x32_bf16 v[104:107],a[124:127],a[116:119],v[104:107]
s_waitcnt lgkmcnt(4)
v_exp_f32 v88,v88
v_mfma_f32_16x16x32_bf16 v[76:79],a[128:131],a[0:3],0
v_exp_f32 v89,v89
v_mfma_f32_16x16x32_bf16 v[76:79],a[132:135],a[4:7],v[76:79]
buffer_load_dwordx4 v7,s[4:7],s20 offen offset:1024 lds
s_waitcnt lgkmcnt(3)
v_mfma_f32_16x16x32_bf16 v[76:79],a[136:139],a[8:11],v[76:79]
s_waitcnt lgkmcnt(2)
v_cvt_pk_bf16_f32 v49,v82,v83
v_cvt_pk_bf16_f32 v52,v88,v89
v_mfma_f32_16x16x32_bf16 v[76:79],a[140:143],a[12:15],v[76:79]
s_waitcnt lgkmcnt(0)
v_mfma_f32_16x16x32_bf16 v[76:79],a[144:147],a[16:19],v[76:79]
v_mfma_f32_16x16x32_bf16 v[76:79],a[148:151],a[20:23],v[76:79]
v_mfma_f32_16x16x32_bf16 v[84:87],a[148:151],a[44:47],0
v_mfma_f32_16x16x32_bf16 v[84:87],a[144:147],a[40:43],v[84:87]
v_mfma_f32_16x16x32_bf16 v[84:87],a[140:143],a[36:39],v[84:87]
v_mfma_f32_16x16x32_bf16 v[84:87],a[136:139],a[32:35],v[84:87]
v_mfma_f32_16x16x32_bf16 v[84:87],a[132:135],a[28:31],v[84:87]
v_mfma_f32_16x16x32_bf16 v[84:87],a[128:131],a[24:27],v[84:87]
v_mfma_f32_16x16x32_bf16 v[92:95],a[128:131],a[48:51],0
v_mfma_f32_16x16x32_bf16 v[92:95],a[132:135],a[52:55],v[92:95]
buffer_load_dwordx4 v8,s[4:7],s20 offen offset:2048 lds
v_mfma_f32_16x16x32_bf16 v[92:95],a[136:139],a[56:59],v[92:95]
s_add_u32 s20,s20,12288
v_mfma_f32_16x16x32_bf16 v[92:95],a[140:143],a[60:63],v[92:95]
v_mfma_f32_16x16x32_bf16 v[92:95],a[144:147],a[64:67],v[92:95]
v_mfma_f32_16x16x32_bf16 v[92:95],a[148:151],a[68:71],v[92:95]
v_mfma_f32_16x16x32_bf16 v[100:103],a[148:151],a[92:95],0
ds_read_b64_tr_b16 a[120:121],v2 offset:0
v_mfma_f32_16x16x32_bf16 v[100:103],a[144:147],a[88:91],v[100:103]
ds_read_b64_tr_b16 a[122:123],v2 offset:6144
v_mfma_f32_16x16x32_bf16 v[100:103],a[140:143],a[84:87],v[100:103]
v_mfma_f32_16x16x32_bf16 v[100:103],a[136:139],a[80:83],v[100:103]
ds_read_b64_tr_b16 a[124:125],v3 offset:0
v_mfma_f32_16x16x32_bf16 v[100:103],a[132:135],a[76:79],v[100:103]
ds_read_b64_tr_b16 a[126:127],v3 offset:6144
v_mfma_f32_16x16x32_bf16 v[100:103],a[128:131],a[72:75],v[100:103]
v_mfma_f32_16x16x32_bf16 v[108:111],a[128:131],a[96:99],0
ds_read_b64_tr_b16 a[128:129],v4 offset:0
v_mfma_f32_16x16x32_bf16 v[108:111],a[132:135],a[100:103],v[108:111]
ds_read_b64_tr_b16 a[130:131],v4 offset:6144
v_mfma_f32_16x16x32_bf16 v[108:111],a[136:139],a[104:107],v[108:111]
ds_read_b64_tr_b16 a[132:133],v5 offset:0
v_mfma_f32_16x16x32_bf16 v[108:111],a[140:143],a[108:111],v[108:111]
ds_read_b64_tr_b16 a[134:135],v5 offset:6144
v_mfma_f32_16x16x32_bf16 v[108:111],a[144:147],a[112:115],v[108:111]
v_mfma_f32_16x16x32_bf16 v[108:111],a[148:151],a[116:119],v[108:111]
s_waitcnt lgkmcnt(4)
v_mfma_f32_16x16x32_bf16 v[160:163],a[120:123],v[20:23],v[160:163]
s_add_u32 m0,s23,0
ds_read_b64_tr_b16 a[136:137],v2 offset:128
v_fma_f32 v91,v91,s36,v15
v_mfma_f32_16x16x32_bf16 v[164:167],a[124:127],v[20:23],v[164:167]
ds_read_b64_tr_b16 a[138:139],v2 offset:6272
v_fma_f32 v90,v90,s36,v15
v_mfma_f32_16x16x32_bf16 v[212:215],a[124:127],v[24:27],v[212:215]
ds_read_b64_tr_b16 a[140:141],v3 offset:128
v_fma_f32 v98,v98,s36,v16
v_mfma_f32_16x16x32_bf16 v[208:211],a[120:123],v[24:27],v[208:211]
ds_read_b64_tr_b16 a[142:143],v3 offset:6272
v_fma_f32 v96,v96,s36,v16
v_mfma_f32_16x16x32_bf16 v[112:115],a[120:123],v[28:31],v[112:115]
ds_read_b64_tr_b16 a[146:147],v4 offset:6272
v_fma_f32 v97,v97,s36,v16
v_mfma_f32_16x16x32_bf16 v[116:119],a[124:127],v[28:31],v[116:119]
ds_read_b64_tr_b16 a[150:151],v5 offset:6272
v_fma_f32 v99,v99,s36,v16
v_mfma_f32_16x16x32_bf16 a[164:167],a[124:127],v[32:35],a[164:167]
ds_read_b64_tr_b16 a[144:145],v4 offset:128
v_fma_f32 v107,v107,s36,v17
v_mfma_f32_16x16x32_bf16 a[160:163],a[120:123],v[32:35],a[160:163]
ds_read_b64_tr_b16 a[148:149],v5 offset:128
v_fma_f32 v104,v104,s36,v17
v_mfma_f32_16x16x32_bf16 a[208:211],a[120:123],v[36:39],a[208:211]
ds_read_b64_tr_b16 a[120:121],v2 offset:256
v_fma_f32 v105,v105,s36,v17
v_mfma_f32_16x16x32_bf16 a[212:215],a[124:127],v[36:39],a[212:215]
s_waitcnt lgkmcnt(6)
ds_read_b64_tr_b16 a[124:125],v3 offset:256
v_fma_f32 v106,v106,s36,v17
v_mfma_f32_16x16x32_bf16 a[216:219],a[128:131],v[36:39],a[216:219]
ds_read_b64_tr_b16 a[122:123],v2 offset:6400
v_fma_f32 v76,v76,s36,v13
v_mfma_f32_16x16x32_bf16 a[220:223],a[132:135],v[36:39],a[220:223]
ds_read_b64_tr_b16 a[126:127],v3 offset:6400
v_fma_f32 v79,v79,s36,v13
v_mfma_f32_16x16x32_bf16 a[172:175],a[132:135],v[32:35],a[172:175]
v_exp_f32 v91,v91
v_mfma_f32_16x16x32_bf16 a[168:171],a[128:131],v[32:35],a[168:171]
v_exp_f32 v90,v90
v_mfma_f32_16x16x32_bf16 v[120:123],a[128:131],v[28:31],v[120:123]
v_cvt_pk_bf16_f32 v53,v90,v91
v_fma_f32 v78,v78,s36,v13
v_mfma_f32_16x16x32_bf16 v[124:127],a[132:135],v[28:31],v[124:127]
v_exp_f32 v96,v96
v_mfma_f32_16x16x32_bf16 v[220:223],a[132:135],v[24:27],v[220:223]
v_exp_f32 v97,v97
v_mfma_f32_16x16x32_bf16 v[216:219],a[128:131],v[24:27],v[216:219]
v_exp_f32 v98,v98
v_mfma_f32_16x16x32_bf16 v[168:171],a[128:131],v[20:23],v[168:171]
ds_read_b64_tr_b16 a[128:129],v4 offset:256
v_cvt_pk_bf16_f32 v56,v96,v97
v_mfma_f32_16x16x32_bf16 v[172:175],a[132:135],v[20:23],v[172:175]
ds_read_b64_tr_b16 a[130:131],v4 offset:6400
v_fma_f32 v77,v77,s36,v13
v_mfma_f32_16x16x32_bf16 v[176:179],a[136:139],v[20:23],v[176:179]
s_waitcnt lgkmcnt(2)
ds_read_b64_tr_b16 a[132:133],v5 offset:256
v_fma_f32 v86,v86,s36,v14
v_mfma_f32_16x16x32_bf16 v[180:183],a[140:143],v[20:23],v[180:183]
ds_read_b64_tr_b16 a[134:135],v5 offset:6400
v_fma_f32 v85,v85,s36,v14
v_mfma_f32_16x16x32_bf16 v[228:231],a[140:143],v[24:27],v[228:231]
v_exp_f32 v99,v99
v_mfma_f32_16x16x32_bf16 v[224:227],a[136:139],v[24:27],v[224:227]
v_cvt_pk_bf16_f32 v57,v98,v99
v_fma_f32 v84,v84,s36,v14
v_mfma_f32_16x16x32_bf16 v[128:131],a[136:139],v[28:31],v[128:131]
v_exp_f32 v104,v104
v_mfma_f32_16x16x32_bf16 v[132:135],a[140:143],v[28:31],v[132:135]
v_exp_f32 v105,v105
v_mfma_f32_16x16x32_bf16 a[180:183],a[140:143],v[32:35],a[180:183]
v_exp_f32 v107,v107
v_mfma_f32_16x16x32_bf16 a[176:179],a[136:139],v[32:35],a[176:179]
v_exp_f32 v106,v106
v_mfma_f32_16x16x32_bf16 a[224:227],a[136:139],v[36:39],a[224:227]
v_cvt_pk_bf16_f32 v41,v106,v107
v_cvt_pk_bf16_f32 v40,v104,v105
v_mfma_f32_16x16x32_bf16 a[228:231],a[140:143],v[36:39],a[228:231]
v_exp_f32 v79,v79
v_mfma_f32_16x16x32_bf16 a[232:235],a[144:147],v[36:39],a[232:235]
v_exp_f32 v76,v76
v_mfma_f32_16x16x32_bf16 a[236:239],a[148:151],v[36:39],a[236:239]
v_exp_f32 v78,v78
v_mfma_f32_16x16x32_bf16 a[188:191],a[148:151],v[32:35],a[188:191]
v_exp_f32 v77,v77
v_mfma_f32_16x16x32_bf16 a[184:187],a[144:147],v[32:35],a[184:187]
v_cvt_pk_bf16_f32 v47,v78,v79
v_cvt_pk_bf16_f32 v46,v76,v77
v_mfma_f32_16x16x32_bf16 v[136:139],a[144:147],v[28:31],v[136:139]
v_exp_f32 v84,v84
v_mfma_f32_16x16x32_bf16 v[140:143],a[148:151],v[28:31],v[140:143]
v_exp_f32 v85,v85
v_mfma_f32_16x16x32_bf16 v[236:239],a[148:151],v[24:27],v[236:239]
v_exp_f32 v86,v86
v_mfma_f32_16x16x32_bf16 v[232:235],a[144:147],v[24:27],v[232:235]
v_fma_f32 v87,v87,s36,v14
v_cvt_pk_bf16_f32 v50,v84,v85
v_mfma_f32_16x16x32_bf16 v[184:187],a[144:147],v[20:23],v[184:187]
v_exp_f32 v87,v87
v_mfma_f32_16x16x32_bf16 v[188:191],a[148:151],v[20:23],v[188:191]
v_cvt_pk_bf16_f32 v51,v86,v87
v_fma_f32 v93,v93,s36,v15
v_mfma_f32_16x16x32_bf16 v[192:195],a[120:123],v[20:23],v[192:195]
v_exp_f32 v93,v93
v_smfmac_f32_16x16x64_bf16 v[60:63],a[152:155],v[44:51],v18
v_fma_f32 v94,v94,s36,v15
v_mfma_f32_16x16x32_bf16 v[196:199],a[124:127],v[20:23],v[196:199]
s_waitcnt vmcnt(9) lgkmcnt(0)
v_exp_f32 v94,v94
v_mfma_f32_16x16x32_bf16 v[244:247],a[124:127],v[24:27],v[244:247]
s_barrier
v_mfma_f32_16x16x32_bf16 v[240:243],a[120:123],v[24:27],v[240:243]
ds_read_b128 a[136:139],v0 offset:24576
v_fma_f32 v92,v92,s36,v15
v_mfma_f32_16x16x32_bf16 v[144:147],a[120:123],v[28:31],v[144:147]
ds_read_b128 a[140:143],v1 offset:24576
v_fma_f32 v95,v95,s36,v15
v_mfma_f32_16x16x32_bf16 v[148:151],a[124:127],v[28:31],v[148:151]
ds_read_b128 a[144:147],v0 offset:24704
v_fma_f32 v102,v102,s36,v16
v_mfma_f32_16x16x32_bf16 a[196:199],a[124:127],v[32:35],a[196:199]
ds_read_b128 a[148:151],v1 offset:24704
v_fma_f32 v103,v103,s36,v16
v_mfma_f32_16x16x32_bf16 a[192:195],a[120:123],v[32:35],a[192:195]
ds_read_b128 a[156:159],v10 offset:6144
v_fma_f32 v101,v101,s36,v16
v_mfma_f32_16x16x32_bf16 a[240:243],a[120:123],v[36:39],a[240:243]
buffer_load_dwordx4 v6,s[8:11],s21 offen offset:0 lds
v_mfma_f32_16x16x32_bf16 a[244:247],a[124:127],v[36:39],a[244:247]
ds_read_b128 a[120:123],v0 offset:24832
v_fma_f32 v100,v100,s36,v16
v_mfma_f32_16x16x32_bf16 a[248:251],a[128:131],v[36:39],a[248:251]
ds_read_b128 a[124:127],v1 offset:24832
v_fma_f32 v110,v110,s36,v17
v_mfma_f32_16x16x32_bf16 a[252:255],a[132:135],v[36:39],a[252:255]
v_exp_f32 v95,v95
v_mfma_f32_16x16x32_bf16 a[204:207],a[132:135],v[32:35],a[204:207]
v_exp_f32 v92,v92
v_mfma_f32_16x16x32_bf16 a[200:203],a[128:131],v[32:35],a[200:203]
v_cvt_pk_bf16_f32 v55,v94,v95
v_cvt_pk_bf16_f32 v54,v92,v93
v_mfma_f32_16x16x32_bf16 v[152:155],a[128:131],v[28:31],v[152:155]
v_exp_f32 v100,v100
v_mfma_f32_16x16x32_bf16 v[156:159],a[132:135],v[28:31],v[156:159]
v_exp_f32 v102,v102
v_mfma_f32_16x16x32_bf16 v[252:255],a[132:135],v[24:27],v[252:255]
v_exp_f32 v103,v103
v_mfma_f32_16x16x32_bf16 v[248:251],a[128:131],v[24:27],v[248:251]
v_exp_f32 v101,v101
v_mfma_f32_16x16x32_bf16 v[200:203],a[128:131],v[20:23],v[200:203]
ds_read_b128 a[128:131],v0 offset:30720
v_cvt_pk_bf16_f32 v59,v102,v103
v_mfma_f32_16x16x32_bf16 v[204:207],a[132:135],v[20:23],v[204:207]
s_waitcnt lgkmcnt(1)
buffer_store_dwordx4 a[156:159],v9,s[16:19],s27 offen offset:0 nt
buffer_load_dwordx4 v7,s[8:11],s21 offen offset:1024 lds
v_mfma_f32_16x16x32_bf16 v[72:75],a[136:139],a[0:3],0
ds_read_b128 a[132:135],v1 offset:30720
v_cvt_pk_bf16_f32 v58,v100,v101
v_mfma_f32_16x16x32_bf16 v[72:75],a[140:143],a[4:7],v[72:75]
v_exp_f32 v110,v110
v_smfmac_f32_16x16x64_bf16 v[64:67],a[152:155],v[52:59],v18
v_fma_f32 v111,v111,s36,v17
v_mfma_f32_16x16x32_bf16 v[72:75],a[144:147],a[8:11],v[72:75]
v_exp_f32 v111,v111
v_mfma_f32_16x16x32_bf16 v[72:75],a[148:151],a[12:15],v[72:75]
v_fma_f32 v108,v108,s36,v17
v_cvt_pk_bf16_f32 v43,v110,v111
v_mfma_f32_16x16x32_bf16 v[72:75],a[120:123],a[16:19],v[72:75]
ds_read_b128 a[156:159],v10 offset:7168
v_fma_f32 v109,v109,s36,v17
v_mfma_f32_16x16x32_bf16 v[72:75],a[124:127],a[20:23],v[72:75]
v_exp_f32 v108,v108
v_mfma_f32_16x16x32_bf16 v[80:83],a[124:127],a[44:47],0
v_exp_f32 v109,v109
v_mfma_f32_16x16x32_bf16 v[80:83],a[120:123],a[40:43],v[80:83]
v_cvt_pk_bf16_f32 v42,v108,v109
v_mfma_f32_16x16x32_bf16 v[80:83],a[148:151],a[36:39],v[80:83]
v_mfma_f32_16x16x32_bf16 v[80:83],a[144:147],a[32:35],v[80:83]
buffer_load_dwordx4 v8,s[8:11],s21 offen offset:2048 lds
v_smfmac_f32_16x16x64_bf16 v[68:71],a[152:155],v[36:43],v18
s_add_u32 s21,s21,12288
v_fma_f32 v75,v75,s36,v13
v_mfma_f32_16x16x32_bf16 v[80:83],a[140:143],a[28:31],v[80:83]
s_cmp_eq_u32 s38,1
v_exp_f32 v75,v75
v_mfma_f32_16x16x32_bf16 v[80:83],a[136:139],a[24:27],v[80:83]
s_cselect_b32 s20,s26,s20
v_fma_f32 v73,v73,s36,v13
v_fma_f32 v74,v74,s36,v13
v_mfma_f32_16x16x32_bf16 v[88:91],a[136:139],a[48:51],0
s_add_u32 m0,s22,12288
v_exp_f32 v73,v73
v_mfma_f32_16x16x32_bf16 v[88:91],a[140:143],a[52:55],v[88:91]
v_exp_f32 v74,v74
v_mfma_f32_16x16x32_bf16 v[88:91],a[144:147],a[56:59],v[88:91]
v_fma_f32 v82,v82,s36,v14
v_fma_f32 v81,v81,s36,v14
v_mfma_f32_16x16x32_bf16 v[88:91],a[148:151],a[60:63],v[88:91]
v_exp_f32 v81,v81
v_mfma_f32_16x16x32_bf16 v[88:91],a[120:123],a[64:67],v[88:91]
v_exp_f32 v82,v82
v_mfma_f32_16x16x32_bf16 v[88:91],a[124:127],a[68:71],v[88:91]
v_fma_f32 v72,v72,s36,v13
v_fma_f32 v80,v80,s36,v14
v_mfma_f32_16x16x32_bf16 v[96:99],a[124:127],a[92:95],0
v_exp_f32 v72,v72
v_mfma_f32_16x16x32_bf16 v[96:99],a[120:123],a[88:91],v[96:99]
s_waitcnt lgkmcnt(0)
buffer_store_dwordx4 a[156:159],v9,s[16:19],s27 offen offset:128 nt
buffer_load_dwordx4 v6,s[4:7],s20 offen offset:0 lds
v_mfma_f32_16x16x32_bf16 v[96:99],a[148:151],a[84:87],v[96:99]
v_exp_f32 v80,v80
v_mfma_f32_16x16x32_bf16 v[96:99],a[144:147],a[80:83],v[96:99]
v_fma_f32 v89,v89,s36,v15
v_fma_f32 v88,v88,s36,v15
v_mfma_f32_16x16x32_bf16 v[96:99],a[140:143],a[76:79],v[96:99]
v_exp_f32 v89,v89
v_mfma_f32_16x16x32_bf16 v[96:99],a[136:139],a[72:75],v[96:99]
v_exp_f32 v88,v88
v_mfma_f32_16x16x32_bf16 v[104:107],a[136:139],a[96:99],0
ds_read_b128 a[136:139],v0 offset:30848
v_fma_f32 v83,v83,s36,v14
v_mfma_f32_16x16x32_bf16 v[104:107],a[140:143],a[100:103],v[104:107]
ds_read_b128 a[156:159],v10 offset:8192
v_mfma_f32_16x16x32_bf16 v[104:107],a[144:147],a[104:107],v[104:107]
ds_read_b128 a[140:143],v1 offset:30848
v_mfma_f32_16x16x32_bf16 v[104:107],a[148:151],a[108:111],v[104:107]
ds_read_b128 a[144:147],v0 offset:30976
v_mfma_f32_16x16x32_bf16 v[104:107],a[120:123],a[112:115],v[104:107]
ds_read_b128 a[148:151],v1 offset:30976
v_mfma_f32_16x16x32_bf16 v[104:107],a[124:127],a[116:119],v[104:107]
v_exp_f32 v83,v83
v_mfma_f32_16x16x32_bf16 v[76:79],a[128:131],a[0:3],0
buffer_load_dwordx4 v7,s[4:7],s20 offen offset:1024 lds
v_mfma_f32_16x16x32_bf16 v[76:79],a[132:135],a[4:7],v[76:79]
s_waitcnt lgkmcnt(4)
v_cvt_pk_bf16_f32 v25,v82,v83
v_cvt_pk_bf16_f32 v20,v72,v73
v_mfma_f32_16x16x32_bf16 v[76:79],a[136:139],a[8:11],v[76:79]
s_waitcnt lgkmcnt(2)
v_cvt_pk_bf16_f32 v21,v74,v75
v_cvt_pk_bf16_f32 v24,v80,v81
v_cvt_pk_bf16_f32 v28,v88,v89
v_mfma_f32_16x16x32_bf16 v[76:79],a[140:143],a[12:15],v[76:79]
s_waitcnt lgkmcnt(1)
v_mfma_f32_16x16x32_bf16 v[76:79],a[144:147],a[16:19],v[76:79]
s_waitcnt lgkmcnt(0)
v_mfma_f32_16x16x32_bf16 v[76:79],a[148:151],a[20:23],v[76:79]
v_mfma_f32_16x16x32_bf16 v[84:87],a[148:151],a[44:47],0
v_mfma_f32_16x16x32_bf16 v[84:87],a[144:147],a[40:43],v[84:87]
v_mfma_f32_16x16x32_bf16 v[84:87],a[140:143],a[36:39],v[84:87]
v_mfma_f32_16x16x32_bf16 v[84:87],a[136:139],a[32:35],v[84:87]
v_mfma_f32_16x16x32_bf16 v[84:87],a[132:135],a[28:31],v[84:87]
buffer_store_dwordx4 a[156:159],v9,s[16:19],s27 offen offset:256 nt
buffer_load_dwordx4 v8,s[4:7],s20 offen offset:2048 lds
v_mfma_f32_16x16x32_bf16 v[84:87],a[128:131],a[24:27],v[84:87]
s_add_u32 s20,s20,12288
v_mfma_f32_16x16x32_bf16 v[92:95],a[128:131],a[48:51],0
s_add_u32 s27,s27,3072
v_mfma_f32_16x16x32_bf16 v[92:95],a[132:135],a[52:55],v[92:95]
v_mfma_f32_16x16x32_bf16 v[92:95],a[136:139],a[56:59],v[92:95]
v_mfma_f32_16x16x32_bf16 v[92:95],a[140:143],a[60:63],v[92:95]
ds_read_b64_tr_b16 a[120:121],v2 offset:12288
v_mfma_f32_16x16x32_bf16 v[92:95],a[144:147],a[64:67],v[92:95]
ds_read_b64_tr_b16 a[122:123],v2 offset:18432
v_mfma_f32_16x16x32_bf16 v[92:95],a[148:151],a[68:71],v[92:95]
v_mfma_f32_16x16x32_bf16 v[100:103],a[148:151],a[92:95],0
ds_read_b64_tr_b16 a[126:127],v3 offset:18432
v_mfma_f32_16x16x32_bf16 v[100:103],a[144:147],a[88:91],v[100:103]
ds_read_b64_tr_b16 a[124:125],v3 offset:12288
v_mfma_f32_16x16x32_bf16 v[100:103],a[140:143],a[84:87],v[100:103]
v_mfma_f32_16x16x32_bf16 v[100:103],a[136:139],a[80:83],v[100:103]
v_mfma_f32_16x16x32_bf16 v[100:103],a[132:135],a[76:79],v[100:103]
v_mfma_f32_16x16x32_bf16 v[100:103],a[128:131],a[72:75],v[100:103]
v_mfma_f32_16x16x32_bf16 v[108:111],a[128:131],a[96:99],0
ds_read_b64_tr_b16 a[130:131],v4 offset:18432
v_mfma_f32_16x16x32_bf16 v[108:111],a[132:135],a[100:103],v[108:111]
ds_read_b64_tr_b16 a[128:129],v4 offset:12288
v_mfma_f32_16x16x32_bf16 v[108:111],a[136:139],a[104:107],v[108:111]
ds_read_b64_tr_b16 a[132:133],v5 offset:12288
v_mfma_f32_16x16x32_bf16 v[108:111],a[140:143],a[108:111],v[108:111]
ds_read_b64_tr_b16 a[134:135],v5 offset:18432
v_mfma_f32_16x16x32_bf16 v[108:111],a[144:147],a[112:115],v[108:111]
v_mfma_f32_16x16x32_bf16 v[108:111],a[148:151],a[116:119],v[108:111]
s_waitcnt lgkmcnt(4)
v_mfma_f32_16x16x32_bf16 v[160:163],a[120:123],v[44:47],v[160:163]
s_add_u32 m0,s29,0
ds_read_b64_tr_b16 a[136:137],v2 offset:12416
v_fma_f32 v90,v90,s36,v15
v_mfma_f32_16x16x32_bf16 v[164:167],a[124:127],v[44:47],v[164:167]
ds_read_b64_tr_b16 a[138:139],v2 offset:18560
v_fma_f32 v91,v91,s36,v15
v_mfma_f32_16x16x32_bf16 v[212:215],a[124:127],v[48:51],v[212:215]
ds_read_b64_tr_b16 a[140:141],v3 offset:12416
v_fma_f32 v96,v96,s36,v16
v_mfma_f32_16x16x32_bf16 v[208:211],a[120:123],v[48:51],v[208:211]
ds_read_b64_tr_b16 a[142:143],v3 offset:18560
v_fma_f32 v97,v97,s36,v16
v_mfma_f32_16x16x32_bf16 v[112:115],a[120:123],v[52:55],v[112:115]
ds_read_b64_tr_b16 a[144:145],v4 offset:12416
v_fma_f32 v98,v98,s36,v16
v_mfma_f32_16x16x32_bf16 v[116:119],a[124:127],v[52:55],v[116:119]
ds_read_b64_tr_b16 a[146:147],v4 offset:18560
v_fma_f32 v99,v99,s36,v16
v_mfma_f32_16x16x32_bf16 a[164:167],a[124:127],v[56:59],a[164:167]
ds_read_b64_tr_b16 a[148:149],v5 offset:12416
v_fma_f32 v104,v104,s36,v17
v_mfma_f32_16x16x32_bf16 a[160:163],a[120:123],v[56:59],a[160:163]
buffer_load_dwordx4 v6,s[12:15],s28 offen offset:0 nt lds
v_mfma_f32_16x16x32_bf16 a[208:211],a[120:123],v[40:43],a[208:211]
ds_read_b64_tr_b16 a[150:151],v5 offset:18560
v_fma_f32 v105,v105,s36,v17
v_mfma_f32_16x16x32_bf16 a[212:215],a[124:127],v[40:43],a[212:215]
s_waitcnt lgkmcnt(5)
ds_read_b64_tr_b16 a[120:121],v2 offset:12544
v_fma_f32 v106,v106,s36,v17
v_mfma_f32_16x16x32_bf16 a[216:219],a[128:131],v[40:43],a[216:219]
ds_read_b64_tr_b16 a[122:123],v2 offset:18688
v_fma_f32 v107,v107,s36,v17
v_mfma_f32_16x16x32_bf16 a[220:223],a[132:135],v[40:43],a[220:223]
ds_read_b64_tr_b16 a[124:125],v3 offset:12544
v_fma_f32 v76,v76,s36,v13
v_mfma_f32_16x16x32_bf16 a[172:175],a[132:135],v[56:59],a[172:175]
ds_read_b64_tr_b16 a[126:127],v3 offset:18688
v_fma_f32 v77,v77,s36,v13
v_mfma_f32_16x16x32_bf16 a[168:171],a[128:131],v[56:59],a[168:171]
v_exp_f32 v90,v90
v_mfma_f32_16x16x32_bf16 v[120:123],a[128:131],v[52:55],v[120:123]
v_exp_f32 v91,v91
v_mfma_f32_16x16x32_bf16 v[124:127],a[132:135],v[52:55],v[124:127]
v_cvt_pk_bf16_f32 v29,v90,v91
v_fma_f32 v78,v78,s36,v13
v_mfma_f32_16x16x32_bf16 v[220:223],a[132:135],v[48:51],v[220:223]
v_exp_f32 v96,v96
v_mfma_f32_16x16x32_bf16 v[216:219],a[128:131],v[48:51],v[216:219]
buffer_load_dwordx4 v7,s[12:15],s28 offen offset:1024 nt lds
v_mfma_f32_16x16x32_bf16 v[168:171],a[128:131],v[44:47],v[168:171]
ds_read_b64_tr_b16 a[128:129],v4 offset:12544
v_fma_f32 v79,v79,s36,v13
v_mfma_f32_16x16x32_bf16 v[172:175],a[132:135],v[44:47],v[172:175]
ds_read_b64_tr_b16 a[130:131],v4 offset:18688
v_fma_f32 v84,v84,s36,v14
v_mfma_f32_16x16x32_bf16 v[176:179],a[136:139],v[44:47],v[176:179]
s_waitcnt lgkmcnt(2)
ds_read_b64_tr_b16 a[132:133],v5 offset:12544
v_fma_f32 v85,v85,s36,v14
v_mfma_f32_16x16x32_bf16 v[180:183],a[140:143],v[44:47],v[180:183]
ds_read_b64_tr_b16 a[134:135],v5 offset:18688
v_fma_f32 v86,v86,s36,v14
v_mfma_f32_16x16x32_bf16 v[228:231],a[140:143],v[48:51],v[228:231]
v_exp_f32 v97,v97
v_mfma_f32_16x16x32_bf16 v[224:227],a[136:139],v[48:51],v[224:227]
v_exp_f32 v98,v98
v_mfma_f32_16x16x32_bf16 v[128:131],a[136:139],v[52:55],v[128:131]
v_exp_f32 v99,v99
v_mfma_f32_16x16x32_bf16 v[132:135],a[140:143],v[52:55],v[132:135]
v_cvt_pk_bf16_f32 v32,v96,v97
v_cvt_pk_bf16_f32 v33,v98,v99
v_mfma_f32_16x16x32_bf16 a[180:183],a[140:143],v[56:59],a[180:183]
v_exp_f32 v104,v104
v_mfma_f32_16x16x32_bf16 a[176:179],a[136:139],v[56:59],a[176:179]
buffer_load_dwordx4 v8,s[12:15],s28 offen offset:2048 nt lds
v_mfma_f32_16x16x32_bf16 a[224:227],a[136:139],v[40:43],a[224:227]
s_add_u32 s28,s28,3072
v_exp_f32 v105,v105
v_mfma_f32_16x16x32_bf16 a[228:231],a[140:143],v[40:43],a[228:231]
s_add_u32 s29,s29,3072
v_exp_f32 v106,v106
v_mfma_f32_16x16x32_bf16 a[232:235],a[144:147],v[40:43],a[232:235]
s_cmp_eq_u32 s38,1
v_exp_f32 v107,v107
v_mfma_f32_16x16x32_bf16 a[236:239],a[148:151],v[40:43],a[236:239]
s_cselect_b32 s21,s26,s21
v_cvt_pk_bf16_f32 v36,v104,v105
v_cvt_pk_bf16_f32 v37,v106,v107
v_mfma_f32_16x16x32_bf16 a[188:191],a[148:151],v[56:59],a[188:191]
s_add_u32 m0,s23,12288
v_exp_f32 v76,v76
v_mfma_f32_16x16x32_bf16 a[184:187],a[144:147],v[56:59],a[184:187]
v_exp_f32 v77,v77
v_mfma_f32_16x16x32_bf16 v[136:139],a[144:147],v[52:55],v[136:139]
v_exp_f32 v78,v78
v_mfma_f32_16x16x32_bf16 v[140:143],a[148:151],v[52:55],v[140:143]
v_exp_f32 v79,v79
v_mfma_f32_16x16x32_bf16 v[236:239],a[148:151],v[48:51],v[236:239]
v_cvt_pk_bf16_f32 v22,v76,v77
v_cvt_pk_bf16_f32 v23,v78,v79
v_mfma_f32_16x16x32_bf16 v[232:235],a[144:147],v[48:51],v[232:235]
v_fma_f32 v87,v87,s36,v14
v_fma_f32 v92,v92,s36,v15
v_mfma_f32_16x16x32_bf16 v[184:187],a[144:147],v[44:47],v[184:187]
v_exp_f32 v84,v84
v_mfma_f32_16x16x32_bf16 v[188:191],a[148:151],v[44:47],v[188:191]
v_exp_f32 v85,v85
v_mfma_f32_16x16x32_bf16 v[192:195],a[120:123],v[44:47],v[192:195]
v_exp_f32 v86,v86
v_mfma_f32_16x16x32_bf16 v[196:199],a[124:127],v[44:47],v[196:199]
s_waitcnt vmcnt(12) lgkmcnt(0)
v_exp_f32 v87,v87
v_mfma_f32_16x16x32_bf16 v[244:247],a[124:127],v[48:51],v[244:247]
s_barrier
v_mfma_f32_16x16x32_bf16 v[240:243],a[120:123],v[48:51],v[240:243]
ds_read_b128 a[136:139],v0 offset:0
v_cvt_pk_bf16_f32 v26,v84,v85
v_mfma_f32_16x16x32_bf16 v[144:147],a[120:123],v[52:55],v[144:147]
ds_read_b128 a[140:143],v1 offset:0
v_cvt_pk_bf16_f32 v27,v86,v87
v_mfma_f32_16x16x32_bf16 v[148:151],a[124:127],v[52:55],v[148:151]
ds_read_b128 a[144:147],v0 offset:128
v_fma_f32 v93,v93,s36,v15
v_smfmac_f32_16x16x64_bf16 v[60:63],a[152:155],v[20:27],v18
ds_read_b128 a[148:151],v1 offset:128
v_mfma_f32_16x16x32_bf16 a[196:199],a[124:127],v[56:59],a[196:199]
v_fma_f32 v94,v94,s36,v15
v_fma_f32 v95,v95,s36,v15
v_mfma_f32_16x16x32_bf16 a[192:195],a[120:123],v[56:59],a[192:195]
buffer_load_dwordx4 v6,s[8:11],s21 offen offset:0 lds
v_mfma_f32_16x16x32_bf16 a[240:243],a[120:123],v[40:43],a[240:243]
ds_read_b128 a[120:123],v0 offset:256
v_fma_f32 v100,v100,s36,v16
v_mfma_f32_16x16x32_bf16 a[244:247],a[124:127],v[40:43],a[244:247]
ds_read_b128 a[124:127],v1 offset:256
v_fma_f32 v101,v101,s36,v16
v_mfma_f32_16x16x32_bf16 a[248:251],a[128:131],v[40:43],a[248:251]
v_exp_f32 v92,v92
v_mfma_f32_16x16x32_bf16 a[252:255],a[132:135],v[40:43],a[252:255]
v_exp_f32 v93,v93
v_mfma_f32_16x16x32_bf16 a[204:207],a[132:135],v[56:59],a[204:207]
v_exp_f32 v94,v94
v_mfma_f32_16x16x32_bf16 a[200:203],a[128:131],v[56:59],a[200:203]
v_exp_f32 v95,v95
v_mfma_f32_16x16x32_bf16 v[152:155],a[128:131],v[52:55],v[152:155]
v_cvt_pk_bf16_f32 v30,v92,v93
v_cvt_pk_bf16_f32 v31,v94,v95
v_mfma_f32_16x16x32_bf16 v[156:159],a[132:135],v[52:55],v[156:159]
v_fma_f32 v102,v102,s36,v16
v_fma_f32 v103,v103,s36,v16
v_mfma_f32_16x16x32_bf16 v[252:255],a[132:135],v[48:51],v[252:255]
v_exp_f32 v100,v100
v_mfma_f32_16x16x32_bf16 v[248:251],a[128:131],v[48:51],v[248:251]
v_exp_f32 v101,v101
v_mfma_f32_16x16x32_bf16 v[200:203],a[128:131],v[44:47],v[200:203]
buffer_load_dwordx4 v7,s[8:11],s21 offen offset:1024 lds
v_mfma_f32_16x16x32_bf16 v[204:207],a[132:135],v[44:47],v[204:207]
s_waitcnt lgkmcnt(0)
ds_read_b128 a[128:131],v0 offset:6144
v_cvt_pk_bf16_f32 v34,v100,v101
v_mfma_f32_16x16x32_bf16 v[72:75],a[136:139],a[0:3],0
ds_read_b128 a[132:135],v1 offset:6144
v_fma_f32 v108,v108,s36,v17
v_mfma_f32_16x16x32_bf16 v[72:75],a[140:143],a[4:7],v[72:75]
v_exp_f32 v102,v102
v_mfma_f32_16x16x32_bf16 v[72:75],a[144:147],a[8:11],v[72:75]
v_exp_f32 v103,v103
v_mfma_f32_16x16x32_bf16 v[72:75],a[148:151],a[12:15],v[72:75]
v_cvt_pk_bf16_f32 v35,v102,v103
v_fma_f32 v109,v109,s36,v17
v_mfma_f32_16x16x32_bf16 v[72:75],a[120:123],a[16:19],v[72:75]
v_fma_f32 v110,v110,s36,v17
v_fma_f32 v111,v111,s36,v17
v_smfmac_f32_16x16x64_bf16 v[64:67],a[152:155],v[28:35],v18
v_add_u32 v10,9216,v10
v_mfma_f32_16x16x32_bf16 v[72:75],a[124:127],a[20:23],v[72:75]
v_exp_f32 v108,v108
v_mfma_f32_16x16x32_bf16 v[80:83],a[124:127],a[44:47],0
v_exp_f32 v109,v109
v_mfma_f32_16x16x32_bf16 v[80:83],a[120:123],a[40:43],v[80:83]
v_exp_f32 v110,v110
v_mfma_f32_16x16x32_bf16 v[80:83],a[148:151],a[36:39],v[80:83]
v_exp_f32 v111,v111
v_mfma_f32_16x16x32_bf16 v[80:83],a[144:147],a[32:35],v[80:83]
buffer_load_dwordx4 v8,s[8:11],s21 offen offset:2048 lds
v_mfma_f32_16x16x32_bf16 v[80:83],a[140:143],a[28:31],v[80:83]
s_add_u32 s21,s21,12288
v_cvt_pk_bf16_f32 v38,v108,v109
v_cvt_pk_bf16_f32 v39,v110,v111
v_mfma_f32_16x16x32_bf16 v[80:83],a[136:139],a[24:27],v[80:83]
s_add_u32 m0,s22,24576
v_fma_f32 v72,v72,s36,v13
v_fma_f32 v73,v73,s36,v13
v_mfma_f32_16x16x32_bf16 v[88:91],a[136:139],a[48:51],0
v_fma_f32 v74,v74,s36,v13
v_fma_f32 v75,v75,s36,v13
v_mfma_f32_16x16x32_bf16 v[88:91],a[140:143],a[52:55],v[88:91]
v_exp_f32 v72,v72
v_mfma_f32_16x16x32_bf16 v[88:91],a[144:147],a[56:59],v[88:91]
v_fma_f32 v80,v80,s36,v14
v_fma_f32 v81,v81,s36,v14
v_mfma_f32_16x16x32_bf16 v[88:91],a[148:151],a[60:63],v[88:91]
v_fma_f32 v82,v82,s36,v14
v_fma_f32 v83,v83,s36,v14
v_mfma_f32_16x16x32_bf16 v[88:91],a[120:123],a[64:67],v[88:91]
v_exp_f32 v73,v73
v_mfma_f32_16x16x32_bf16 v[88:91],a[124:127],a[68:71],v[88:91]
v_exp_f32 v74,v74
v_mfma_f32_16x16x32_bf16 v[96:99],a[124:127],a[92:95],0
v_exp_f32 v75,v75
v_mfma_f32_16x16x32_bf16 v[96:99],a[120:123],a[88:91],v[96:99]
v_exp_f32 v80,v80
v_mfma_f32_16x16x32_bf16 v[96:99],a[148:151],a[84:87],v[96:99]
buffer_load_dwordx4 v6,s[4:7],s20 offen offset:0 lds
v_mfma_f32_16x16x32_bf16 v[96:99],a[144:147],a[80:83],v[96:99]
v_fma_f32 v88,v88,s36,v15
v_fma_f32 v89,v89,s36,v15
v_mfma_f32_16x16x32_bf16 v[96:99],a[140:143],a[76:79],v[96:99]
v_exp_f32 v81,v81
v_mfma_f32_16x16x32_bf16 v[96:99],a[136:139],a[72:75],v[96:99]
v_exp_f32 v82,v82
v_mfma_f32_16x16x32_bf16 v[104:107],a[136:139],a[96:99],0
ds_read_b128 a[136:139],v0 offset:6272
v_cvt_pk_bf16_f32 v44,v72,v73
v_mfma_f32_16x16x32_bf16 v[104:107],a[140:143],a[100:103],v[104:107]
ds_read_b128 a[140:143],v1 offset:6272
v_cvt_pk_bf16_f32 v45,v74,v75
v_mfma_f32_16x16x32_bf16 v[104:107],a[144:147],a[104:107],v[104:107]
ds_read_b128 a[144:147],v0 offset:6400
v_cvt_pk_bf16_f32 v48,v80,v81
v_mfma_f32_16x16x32_bf16 v[104:107],a[148:151],a[108:111],v[104:107]
ds_read_b128 a[148:151],v1 offset:6400
v_mfma_f32_16x16x32_bf16 v[104:107],a[120:123],a[112:115],v[104:107]
v_exp_f32 v83,v83
v_mfma_f32_16x16x32_bf16 v[104:107],a[124:127],a[116:119],v[104:107]
s_waitcnt lgkmcnt(4)
v_exp_f32 v88,v88
v_mfma_f32_16x16x32_bf16 v[76:79],a[128:131],a[0:3],0
v_exp_f32 v89,v89
v_mfma_f32_16x16x32_bf16 v[76:79],a[132:135],a[4:7],v[76:79]
buffer_load_dwordx4 v7,s[4:7],s20 offen offset:1024 lds
s_waitcnt lgkmcnt(3)
v_mfma_f32_16x16x32_bf16 v[76:79],a[136:139],a[8:11],v[76:79]
s_waitcnt lgkmcnt(2)
v_cvt_pk_bf16_f32 v49,v82,v83
v_cvt_pk_bf16_f32 v52,v88,v89
v_mfma_f32_16x16x32_bf16 v[76:79],a[140:143],a[12:15],v[76:79]
s_waitcnt lgkmcnt(0)
v_mfma_f32_16x16x32_bf16 v[76:79],a[144:147],a[16:19],v[76:79]
v_mfma_f32_16x16x32_bf16 v[76:79],a[148:151],a[20:23],v[76:79]
v_mfma_f32_16x16x32_bf16 v[84:87],a[148:151],a[44:47],0
v_mfma_f32_16x16x32_bf16 v[84:87],a[144:147],a[40:43],v[84:87]
v_mfma_f32_16x16x32_bf16 v[84:87],a[140:143],a[36:39],v[84:87]
v_mfma_f32_16x16x32_bf16 v[84:87],a[136:139],a[32:35],v[84:87]
v_mfma_f32_16x16x32_bf16 v[84:87],a[132:135],a[28:31],v[84:87]
v_mfma_f32_16x16x32_bf16 v[84:87],a[128:131],a[24:27],v[84:87]
v_mfma_f32_16x16x32_bf16 v[92:95],a[128:131],a[48:51],0
v_mfma_f32_16x16x32_bf16 v[92:95],a[132:135],a[52:55],v[92:95]
buffer_load_dwordx4 v8,s[4:7],s20 offen offset:2048 lds
v_mfma_f32_16x16x32_bf16 v[92:95],a[136:139],a[56:59],v[92:95]
s_add_u32 s20,s20,12288
s_add_u32 s38,s38,1
s_cmp_lt_u32 s38,2
v_mfma_f32_16x16x32_bf16 v[92:95],a[140:143],a[60:63],v[92:95]
v_mfma_f32_16x16x32_bf16 v[92:95],a[144:147],a[64:67],v[92:95]
v_mfma_f32_16x16x32_bf16 v[92:95],a[148:151],a[68:71],v[92:95]
v_mfma_f32_16x16x32_bf16 v[100:103],a[148:151],a[92:95],0
ds_read_b64_tr_b16 a[120:121],v2 offset:24576
v_mfma_f32_16x16x32_bf16 v[100:103],a[144:147],a[88:91],v[100:103]
ds_read_b64_tr_b16 a[122:123],v2 offset:30720
v_mfma_f32_16x16x32_bf16 v[100:103],a[140:143],a[84:87],v[100:103]
v_mfma_f32_16x16x32_bf16 v[100:103],a[136:139],a[80:83],v[100:103]
ds_read_b64_tr_b16 a[124:125],v3 offset:24576
v_mfma_f32_16x16x32_bf16 v[100:103],a[132:135],a[76:79],v[100:103]
ds_read_b64_tr_b16 a[126:127],v3 offset:30720
v_mfma_f32_16x16x32_bf16 v[100:103],a[128:131],a[72:75],v[100:103]
v_mfma_f32_16x16x32_bf16 v[108:111],a[128:131],a[96:99],0
ds_read_b64_tr_b16 a[128:129],v4 offset:24576
v_mfma_f32_16x16x32_bf16 v[108:111],a[132:135],a[100:103],v[108:111]
ds_read_b64_tr_b16 a[130:131],v4 offset:30720
v_mfma_f32_16x16x32_bf16 v[108:111],a[136:139],a[104:107],v[108:111]
ds_read_b64_tr_b16 a[132:133],v5 offset:24576
v_mfma_f32_16x16x32_bf16 v[108:111],a[140:143],a[108:111],v[108:111]
ds_read_b64_tr_b16 a[134:135],v5 offset:30720
v_mfma_f32_16x16x32_bf16 v[108:111],a[144:147],a[112:115],v[108:111]
v_mfma_f32_16x16x32_bf16 v[108:111],a[148:151],a[116:119],v[108:111]
s_cbranch_scc1 L_loop5w0
s_cmp_ge_u32 s69,6
s_cbranch_scc1 L_end5
s_cmp_eq_u32 s40,0
s_cbranch_scc1 L_tr54
s_branch L_tr55
L_tr54:
s_waitcnt vmcnt(43)
s_waitcnt lgkmcnt(3)
v_mfma_f32_16x16x32_bf16 v[160:163],a[120:123],v[20:23],v[160:163]
s_add_u32 m0,s24,0
ds_read_b128 a[12:15],v12 offset:128
v_fma_f32 v101,v101,s36,v16
v_mfma_f32_16x16x32_bf16 v[164:167],a[124:127],v[20:23],v[164:167]
ds_read_b128 a[20:23],v12 offset:256
v_fma_f32 v103,v103,s36,v16
v_mfma_f32_16x16x32_bf16 v[212:215],a[124:127],v[24:27],v[212:215]
ds_read_b128 a[4:7],v12 offset:0
v_fma_f32 v87,v87,s36,v14
v_mfma_f32_16x16x32_bf16 v[208:211],a[120:123],v[24:27],v[208:211]
ds_read_b128 a[16:19],v11 offset:256
v_fma_f32 v106,v106,s36,v17
v_mfma_f32_16x16x32_bf16 v[112:115],a[120:123],v[28:31],v[112:115]
ds_read_b128 a[0:3],v11 offset:0
v_fma_f32 v99,v99,s36,v16
v_mfma_f32_16x16x32_bf16 v[116:119],a[124:127],v[28:31],v[116:119]
ds_read_b128 a[8:11],v11 offset:128
v_fma_f32 v96,v96,s36,v16
v_mfma_f32_16x16x32_bf16 a[164:167],a[124:127],v[32:35],a[164:167]
ds_read_b64_tr_b16 a[136:137],v2 offset:24704
v_fma_f32 v77,v77,s36,v13
v_mfma_f32_16x16x32_bf16 a[160:163],a[120:123],v[32:35],a[160:163]
ds_read_b64_tr_b16 a[138:139],v2 offset:30848
v_fma_f32 v85,v85,s36,v14
v_mfma_f32_16x16x32_bf16 a[208:211],a[120:123],v[36:39],a[208:211]
ds_read_b64_tr_b16 a[140:141],v3 offset:24704
ds_read_b64_tr_b16 a[142:143],v3 offset:30848
ds_read_b64_tr_b16 a[144:145],v4 offset:24704
ds_read_b64_tr_b16 a[146:147],v4 offset:30848
ds_read_b64_tr_b16 a[150:151],v5 offset:30848
ds_read_b64_tr_b16 a[148:149],v5 offset:24704
ds_read_b128 a[40:43],v11 offset:6400
v_mfma_f32_16x16x32_bf16 a[212:215],a[124:127],v[36:39],a[212:215]
s_waitcnt lgkmcnt(11)
v_fma_f32 v84,v84,s36,v14
ds_read_b128 a[32:35],v11 offset:6272
v_mfma_f32_16x16x32_bf16 a[216:219],a[128:131],v[36:39],a[216:219]
s_waitcnt lgkmcnt(10)
buffer_load_dwordx4 v6,s[12:15],s28 offen offset:0 nt lds
v_mfma_f32_16x16x32_bf16 a[220:223],a[132:135],v[36:39],a[220:223]
ds_read_b64_tr_b16 a[122:123],v2 offset:30976
ds_read_b128 a[44:47],v12 offset:6400
v_mfma_f32_16x16x32_bf16 a[172:175],a[132:135],v[32:35],a[172:175]
v_exp_f32 v101,v101
ds_read_b64_tr_b16 a[120:121],v2 offset:24832
ds_read_b128 a[24:27],v11 offset:6144
v_mfma_f32_16x16x32_bf16 a[168:171],a[128:131],v[32:35],a[168:171]
v_exp_f32 v77,v77
ds_read_b128 a[28:31],v12 offset:6144
v_mfma_f32_16x16x32_bf16 v[120:123],a[128:131],v[28:31],v[120:123]
v_fma_f32 v111,v111,s36,v17
ds_read_b64_tr_b16 a[126:127],v3 offset:30976
ds_read_b64_tr_b16 a[124:125],v3 offset:24832
ds_read_b128 a[36:39],v12 offset:6272
v_mfma_f32_16x16x32_bf16 v[124:127],a[132:135],v[28:31],v[124:127]
buffer_load_dwordx4 v7,s[12:15],s28 offen offset:1024 nt lds
v_mfma_f32_16x16x32_bf16 v[220:223],a[132:135],v[24:27],v[220:223]
v_fma_f32 v95,v95,s36,v15
v_fma_f32 v100,v100,s36,v16
v_mfma_f32_16x16x32_bf16 v[216:219],a[128:131],v[24:27],v[216:219]
v_exp_f32 v106,v106
v_mfma_f32_16x16x32_bf16 v[168:171],a[128:131],v[20:23],v[168:171]
ds_read_b64_tr_b16 a[130:131],v4 offset:30976
v_fma_f32 v93,v93,s36,v15
v_mfma_f32_16x16x32_bf16 v[172:175],a[132:135],v[20:23],v[172:175]
s_waitcnt lgkmcnt(4)
ds_read_b64_tr_b16 a[128:129],v4 offset:24832
v_exp_f32 v111,v111
v_mfma_f32_16x16x32_bf16 v[176:179],a[136:139],v[20:23],v[176:179]
ds_read_b64_tr_b16 a[132:133],v5 offset:24832
buffer_load_dwordx4 v8,s[12:15],s28 offen offset:2048 nt lds
v_mfma_f32_16x16x32_bf16 v[180:183],a[140:143],v[20:23],v[180:183]
s_add_u32 s28,s28,3072
ds_read_b64_tr_b16 a[134:135],v5 offset:30976
v_fma_f32 v107,v107,s36,v17
v_mfma_f32_16x16x32_bf16 v[228:231],a[140:143],v[24:27],v[228:231]
s_add_u32 m0,s24,3072
v_fma_f32 v92,v92,s36,v15
v_exp_f32 v92,v92
v_mfma_f32_16x16x32_bf16 v[224:227],a[136:139],v[24:27],v[224:227]
v_fma_f32 v109,v109,s36,v17
v_exp_f32 v109,v109
v_mfma_f32_16x16x32_bf16 v[128:131],a[136:139],v[28:31],v[128:131]
v_fma_f32 v97,v97,s36,v16
v_exp_f32 v84,v84
v_mfma_f32_16x16x32_bf16 v[132:135],a[140:143],v[28:31],v[132:135]
v_fma_f32 v94,v94,s36,v15
v_exp_f32 v94,v94
v_mfma_f32_16x16x32_bf16 a[180:183],a[140:143],v[32:35],a[180:183]
v_fma_f32 v104,v104,s36,v17
v_fma_f32 v90,v90,s36,v15
v_mfma_f32_16x16x32_bf16 a[176:179],a[136:139],v[32:35],a[176:179]
buffer_load_dwordx4 v6,s[12:15],s28 offen offset:0 nt lds
v_mfma_f32_16x16x32_bf16 a[224:227],a[136:139],v[36:39],a[224:227]
v_exp_f32 v93,v93
v_mfma_f32_16x16x32_bf16 a[228:231],a[140:143],v[36:39],a[228:231]
v_exp_f32 v104,v104
v_mfma_f32_16x16x32_bf16 a[232:235],a[144:147],v[36:39],a[232:235]
v_exp_f32 v96,v96
v_mfma_f32_16x16x32_bf16 a[236:239],a[148:151],v[36:39],a[236:239]
v_fma_f32 v78,v78,s36,v13
v_exp_f32 v78,v78
v_mfma_f32_16x16x32_bf16 a[188:191],a[148:151],v[32:35],a[188:191]
v_fma_f32 v110,v110,s36,v17
v_exp_f32 v110,v110
v_mfma_f32_16x16x32_bf16 a[184:187],a[144:147],v[32:35],a[184:187]
v_exp_f32 v97,v97
v_mfma_f32_16x16x32_bf16 v[136:139],a[144:147],v[28:31],v[136:139]
v_exp_f32 v100,v100
v_mfma_f32_16x16x32_bf16 v[140:143],a[148:151],v[28:31],v[140:143]
buffer_load_dwordx4 v7,s[12:15],s28 offen offset:1024 nt lds
v_mfma_f32_16x16x32_bf16 v[236:239],a[148:151],v[24:27],v[236:239]
v_fma_f32 v102,v102,s36,v16
v_exp_f32 v102,v102
v_mfma_f32_16x16x32_bf16 v[232:235],a[144:147],v[24:27],v[232:235]
v_fma_f32 v79,v79,s36,v13
v_exp_f32 v79,v79
v_mfma_f32_16x16x32_bf16 v[184:187],a[144:147],v[20:23],v[184:187]
v_exp_f32 v85,v85
v_mfma_f32_16x16x32_bf16 v[188:191],a[148:151],v[20:23],v[188:191]
v_fma_f32 v108,v108,s36,v17
v_exp_f32 v108,v108
v_mfma_f32_16x16x32_bf16 v[192:195],a[120:123],v[20:23],v[192:195]
s_waitcnt lgkmcnt(0)
v_fma_f32 v98,v98,s36,v16
v_exp_f32 v87,v87
v_mfma_f32_16x16x32_bf16 v[196:199],a[124:127],v[20:23],v[196:199]
v_fma_f32 v76,v76,s36,v13
v_exp_f32 v76,v76
v_mfma_f32_16x16x32_bf16 v[244:247],a[124:127],v[24:27],v[244:247]
buffer_load_dwordx4 v8,s[12:15],s28 offen offset:2048 nt lds
s_waitcnt vmcnt(20)
s_barrier
v_mfma_f32_16x16x32_bf16 v[240:243],a[120:123],v[24:27],v[240:243]
s_add_u32 s28,s28,3072
v_fma_f32 v105,v105,s36,v17
v_exp_f32 v107,v107
v_mfma_f32_16x16x32_bf16 v[144:147],a[120:123],v[28:31],v[144:147]
s_add_u32 m0,s22,0
v_fma_f32 v91,v91,s36,v15
v_exp_f32 v91,v91
v_mfma_f32_16x16x32_bf16 v[148:151],a[124:127],v[28:31],v[148:151]
buffer_load_dwordx4 v6,s[4:7],s25 offen offset:0 lds
v_mfma_f32_16x16x32_bf16 a[196:199],a[124:127],v[32:35],a[196:199]
buffer_load_dwordx4 v7,s[4:7],s25 offen offset:1024 lds
v_mfma_f32_16x16x32_bf16 a[192:195],a[120:123],v[32:35],a[192:195]
buffer_load_dwordx4 v8,s[4:7],s25 offen offset:2048 lds
v_mfma_f32_16x16x32_bf16 a[240:243],a[120:123],v[36:39],a[240:243]
v_fma_f32 v86,v86,s36,v14
v_exp_f32 v86,v86
v_mfma_f32_16x16x32_bf16 a[244:247],a[124:127],v[36:39],a[244:247]
v_exp_f32 v95,v95
v_mfma_f32_16x16x32_bf16 a[248:251],a[128:131],v[36:39],a[248:251]
v_exp_f32 v103,v103
v_mfma_f32_16x16x32_bf16 a[252:255],a[132:135],v[36:39],a[252:255]
ds_read_b64_tr_b16 a[136:137],v2 offset:0
v_cvt_pk_bf16_f32 v41,v106,v107
v_mfma_f32_16x16x32_bf16 a[204:207],a[132:135],v[32:35],a[204:207]
ds_read_b64_tr_b16 a[138:139],v2 offset:6144
v_exp_f32 v99,v99
v_mfma_f32_16x16x32_bf16 a[200:203],a[128:131],v[32:35],a[200:203]
ds_read_b64_tr_b16 a[140:141],v3 offset:0
v_cvt_pk_bf16_f32 v42,v108,v109
v_mfma_f32_16x16x32_bf16 v[152:155],a[128:131],v[28:31],v[152:155]
ds_read_b64_tr_b16 a[142:143],v3 offset:6144
v_cvt_pk_bf16_f32 v50,v84,v85
v_mfma_f32_16x16x32_bf16 v[156:159],a[132:135],v[28:31],v[156:159]
ds_read_b64_tr_b16 a[144:145],v4 offset:0
v_exp_f32 v90,v90
v_mfma_f32_16x16x32_bf16 v[252:255],a[132:135],v[24:27],v[252:255]
ds_read_b64_tr_b16 a[146:147],v4 offset:6144
v_exp_f32 v105,v105
v_mfma_f32_16x16x32_bf16 v[248:251],a[128:131],v[24:27],v[248:251]
ds_read_b64_tr_b16 a[148:149],v5 offset:0
v_cvt_pk_bf16_f32 v55,v94,v95
v_mfma_f32_16x16x32_bf16 v[200:203],a[128:131],v[20:23],v[200:203]
ds_read_b64_tr_b16 a[150:151],v5 offset:6144
v_cvt_pk_bf16_f32 v51,v86,v87
v_mfma_f32_16x16x32_bf16 v[204:207],a[132:135],v[20:23],v[204:207]
v_cvt_pk_bf16_f32 v59,v102,v103
v_exp_f32 v98,v98
v_cvt_pk_bf16_f32 v54,v92,v93
v_cvt_pk_bf16_f32 v56,v96,v97
v_cvt_pk_bf16_f32 v53,v90,v91
v_cvt_pk_bf16_f32 v47,v78,v79
v_cvt_pk_bf16_f32 v43,v110,v111
v_cvt_pk_bf16_f32 v58,v100,v101
v_cvt_pk_bf16_f32 v46,v76,v77
v_cvt_pk_bf16_f32 v57,v98,v99
v_cvt_pk_bf16_f32 v40,v104,v105
v_smfmac_f32_16x16x64_bf16 v[60:63],a[152:155],v[44:51],v18
v_subrev_u32 v10,18432,v10
v_smfmac_f32_16x16x64_bf16 v[64:67],a[152:155],v[52:59],v18
v_smfmac_f32_16x16x64_bf16 v[68:71],a[152:155],v[36:43],v18
s_waitcnt lgkmcnt(1)
v_mfma_f32_16x16x32_bf16 v[160:163],a[136:139],v[44:47],v[160:163]
s_add_u32 s87,s42,18432
ds_read_b64_tr_b16 a[120:121],v2 offset:128
v_mbcnt_lo_u32_b32 v39,-1,0
v_mfma_f32_16x16x32_bf16 v[164:167],a[140:143],v[44:47],v[164:167]
s_add_u32 s66,s42,24576
ds_read_b64_tr_b16 a[122:123],v2 offset:6272
v_mbcnt_hi_u32_b32 v39,-1,v39
v_mfma_f32_16x16x32_bf16 v[212:215],a[140:143],v[48:51],v[212:215]
ds_read_b64_tr_b16 a[124:125],v3 offset:128
v_and_b32 v38,7,v39
v_mfma_f32_16x16x32_bf16 v[208:211],a[136:139],v[48:51],v[208:211]
ds_read_b64_tr_b16 a[126:127],v3 offset:6272
v_lshrrev_b32 v19,5,v39
v_mfma_f32_16x16x32_bf16 v[112:115],a[136:139],v[52:55],v[112:115]
ds_read_b64_tr_b16 a[128:129],v4 offset:128
v_xor_b32 v38,v38,v19
v_mfma_f32_16x16x32_bf16 v[116:119],a[140:143],v[52:55],v[116:119]
ds_read_b64_tr_b16 a[130:131],v4 offset:6272
ds_read_b64_tr_b16 a[132:133],v5 offset:128
ds_read_b64_tr_b16 a[134:135],v5 offset:6272
v_mfma_f32_16x16x32_bf16 a[164:167],a[140:143],v[56:59],a[164:167]
v_and_b32 v19,15,v39
v_lshl_add_u32 v19,v19,7,s24
v_mfma_f32_16x16x32_bf16 a[160:163],a[136:139],v[56:59],a[160:163]
v_lshl_add_u32 v19,v38,4,v19
v_bfe_u32 v38,v39,4,1
v_mfma_f32_16x16x32_bf16 a[208:211],a[136:139],v[40:43],a[208:211]
ds_read_b64_tr_b16 a[136:137],v2 offset:256
v_lshl_add_u32 v36,v38,3,v19
v_mfma_f32_16x16x32_bf16 a[212:215],a[140:143],v[40:43],a[212:215]
ds_read_b64_tr_b16 a[138:139],v2 offset:6400
v_xor_b32 v37,32,v36
v_mfma_f32_16x16x32_bf16 a[216:219],a[144:147],v[40:43],a[216:219]
s_waitcnt lgkmcnt(6)
ds_read_b64_tr_b16 a[140:141],v3 offset:256
v_xor_b32 v38,64,v36
v_mfma_f32_16x16x32_bf16 a[220:223],a[148:151],v[40:43],a[220:223]
ds_read_b64_tr_b16 a[142:143],v3 offset:6400
v_bfe_u32 v19,v39,3,1
v_xor_b32 v39,96,v36
v_lshlrev_b32 v19,11,v19
v_add_f32 v68,v68,v69
v_add_f32 v68,v68,v70
v_add_f32 v66,v66,v67
v_add_f32 v68,v68,v71
v_rcp_f32 v66,v66
v_rcp_f32 v68,v68
v_accvgpr_read_b32 v72,a160
v_accvgpr_read_b32 v73,a161
v_pk_mul_f32 v[72:73],v[72:73],v[66:67] op_sel_hi:[1,0]
v_accvgpr_read_b32 v74,a162
v_accvgpr_read_b32 v75,a163
v_pk_mul_f32 v[74:75],v[74:75],v[66:67] op_sel_hi:[1,0]
v_accvgpr_read_b32 v76,a208
v_accvgpr_read_b32 v77,a209
v_pk_mul_f32 v[76:77],v[76:77],v[68:69] op_sel_hi:[1,0]
v_accvgpr_read_b32 v78,a210
v_accvgpr_read_b32 v79,a211
v_pk_mul_f32 v[78:79],v[78:79],v[68:69] op_sel_hi:[1,0]
v_accvgpr_read_b32 v80,a164
v_accvgpr_read_b32 v81,a165
v_mfma_f32_16x16x32_bf16 a[172:175],a[148:151],v[56:59],a[172:175]
v_accvgpr_read_b32 v82,a166
v_accvgpr_read_b32 v83,a167
v_accvgpr_read_b32 v84,a212
v_accvgpr_read_b32 v85,a213
v_accvgpr_read_b32 v86,a214
v_pk_mul_f32 v[80:81],v[80:81],v[66:67] op_sel_hi:[1,0]
v_pk_mul_f32 v[82:83],v[82:83],v[66:67] op_sel_hi:[1,0]
v_pk_mul_f32 v[84:85],v[84:85],v[68:69] op_sel_hi:[1,0]
v_accvgpr_read_b32 v87,a215
v_pk_mul_f32 v[86:87],v[86:87],v[68:69] op_sel_hi:[1,0]
v_accvgpr_read_b32 v92,a216
v_accvgpr_read_b32 v93,a217
v_mfma_f32_16x16x32_bf16 a[168:171],a[144:147],v[56:59],a[168:171]
v_accvgpr_read_b32 v94,a218
v_accvgpr_read_b32 v95,a219
v_mfma_f32_16x16x32_bf16 v[120:123],a[144:147],v[52:55],v[120:123]
v_accvgpr_read_b32 v100,a220
v_accvgpr_read_b32 v101,a221
v_mfma_f32_16x16x32_bf16 v[124:127],a[148:151],v[52:55],v[124:127]
v_accvgpr_read_b32 v102,a222
v_accvgpr_read_b32 v103,a223
v_mfma_f32_16x16x32_bf16 v[220:223],a[148:151],v[48:51],v[220:223]
v_accvgpr_read_b32 v88,a168
v_accvgpr_read_b32 v89,a169
v_accvgpr_read_b32 v90,a170
v_accvgpr_read_b32 v91,a171
v_accvgpr_read_b32 v96,a172
v_pk_mul_f32 v[92:93],v[92:93],v[68:69] op_sel_hi:[1,0]
v_pk_mul_f32 v[94:95],v[94:95],v[68:69] op_sel_hi:[1,0]
v_pk_mul_f32 v[88:89],v[88:89],v[66:67] op_sel_hi:[1,0]
v_pk_mul_f32 v[90:91],v[90:91],v[66:67] op_sel_hi:[1,0]
v_accvgpr_read_b32 v97,a173
v_accvgpr_read_b32 v98,a174
v_mfma_f32_16x16x32_bf16 v[216:219],a[144:147],v[48:51],v[216:219]
v_accvgpr_read_b32 v99,a175
v_cvt_pk_bf16_f32 v72,v72,v73
v_cvt_pk_bf16_f32 v76,v76,v77
v_cvt_pk_bf16_f32 v80,v80,v81
v_cvt_pk_bf16_f32 v84,v84,v85
v_pk_mul_f32 v[96:97],v[96:97],v[66:67] op_sel_hi:[1,0]
v_pk_mul_f32 v[100:101],v[100:101],v[68:69] op_sel_hi:[1,0]
v_pk_mul_f32 v[102:103],v[102:103],v[68:69] op_sel_hi:[1,0]
v_pk_mul_f32 v[98:99],v[98:99],v[66:67] op_sel_hi:[1,0]
v_cvt_pk_bf16_f32 v73,v74,v75
v_cvt_pk_bf16_f32 v77,v78,v79
v_mfma_f32_16x16x32_bf16 v[168:171],a[144:147],v[44:47],v[168:171]
ds_read_b64_tr_b16 a[144:145],v4 offset:256
v_cvt_pk_bf16_f32 v81,v82,v83
v_mfma_f32_16x16x32_bf16 v[172:175],a[148:151],v[44:47],v[172:175]
ds_read_b64_tr_b16 a[146:147],v4 offset:6400
v_cvt_pk_bf16_f32 v85,v86,v87
v_mfma_f32_16x16x32_bf16 v[176:179],a[120:123],v[44:47],v[176:179]
ds_read_b64_tr_b16 a[148:149],v5 offset:256
v_cvt_pk_bf16_f32 v92,v92,v93
v_mfma_f32_16x16x32_bf16 v[180:183],a[124:127],v[44:47],v[180:183]
ds_read_b64_tr_b16 a[150:151],v5 offset:6400
v_cvt_pk_bf16_f32 v88,v88,v89
v_mfma_f32_16x16x32_bf16 v[228:231],a[124:127],v[48:51],v[228:231]
ds_write2st64_b64 v36,v[72:73],v[76:77] offset0:36 offset1:40
v_mfma_f32_16x16x32_bf16 v[224:227],a[120:123],v[48:51],v[224:227]
v_cvt_pk_bf16_f32 v93,v94,v95
v_cvt_pk_bf16_f32 v89,v90,v91
v_mfma_f32_16x16x32_bf16 v[128:131],a[120:123],v[52:55],v[128:131]
v_cvt_pk_bf16_f32 v96,v96,v97
v_cvt_pk_bf16_f32 v100,v100,v101
v_mfma_f32_16x16x32_bf16 v[132:135],a[124:127],v[52:55],v[132:135]
v_cvt_pk_bf16_f32 v97,v98,v99
v_cvt_pk_bf16_f32 v101,v102,v103
v_mfma_f32_16x16x32_bf16 a[180:183],a[124:127],v[56:59],a[180:183]
ds_write2st64_b64 v37,v[80:81],v[84:85] offset0:36 offset1:40
v_mfma_f32_16x16x32_bf16 a[176:179],a[120:123],v[56:59],a[176:179]
v_add_f32 v62,v62,v63
v_rcp_f32 v62,v62
v_mfma_f32_16x16x32_bf16 a[224:227],a[120:123],v[40:43],a[224:227]
v_add_f32 v64,v64,v65
v_rcp_f32 v64,v64
v_mfma_f32_16x16x32_bf16 a[228:231],a[124:127],v[40:43],a[228:231]
s_waitcnt lgkmcnt(1)
v_accvgpr_read_b32 v90,a182
v_accvgpr_read_b32 v91,a183
v_mfma_f32_16x16x32_bf16 a[232:235],a[128:131],v[40:43],a[232:235]
ds_write2st64_b64 v38,v[88:89],v[92:93] offset0:36 offset1:40
v_mfma_f32_16x16x32_bf16 a[236:239],a[132:135],v[40:43],a[236:239]
v_accvgpr_read_b32 v80,a176
v_accvgpr_read_b32 v81,a177
v_accvgpr_read_b32 v82,a178
v_accvgpr_read_b32 v83,a179
v_accvgpr_read_b32 v84,a224
v_pk_mul_f32 v[80:81],v[80:81],v[66:67] op_sel_hi:[1,0]
v_pk_mul_f32 v[82:83],v[82:83],v[66:67] op_sel_hi:[1,0]
v_accvgpr_read_b32 v85,a225
v_pk_mul_f32 v[84:85],v[84:85],v[68:69] op_sel_hi:[1,0]
ds_write2st64_b64 v39,v[96:97],v[100:101] offset0:36 offset1:40
v_accvgpr_read_b32 v86,a226
v_accvgpr_read_b32 v87,a227
v_pk_mul_f32 v[86:87],v[86:87],v[68:69] op_sel_hi:[1,0]
v_accvgpr_read_b32 v94,a230
v_accvgpr_read_b32 v95,a231
v_mfma_f32_16x16x32_bf16 a[188:191],a[132:135],v[56:59],a[188:191]
ds_read_b128 v[104:107],v10 offset:18432
v_accvgpr_read_b32 v88,a180
ds_read_b128 v[108:111],v10 offset:19456
v_pk_mul_f32 v[90:91],v[90:91],v[66:67] op_sel_hi:[1,0]
ds_read_b128 v[72:75],v10 offset:20480
v_pk_mul_f32 v[94:95],v[94:95],v[68:69] op_sel_hi:[1,0]
ds_read_b128 v[76:79],v10 offset:21504
v_accvgpr_read_b32 v89,a181
v_pk_mul_f32 v[88:89],v[88:89],v[66:67] op_sel_hi:[1,0]
v_accvgpr_read_b32 v92,a228
v_accvgpr_read_b32 v93,a229
v_pk_mul_f32 v[92:93],v[92:93],v[68:69] op_sel_hi:[1,0]
v_cvt_pk_bf16_f32 v80,v80,v81
v_cvt_pk_bf16_f32 v84,v84,v85
v_mfma_f32_16x16x32_bf16 a[184:187],a[128:131],v[56:59],a[184:187]
s_waitcnt vmcnt(15)
ds_read_b128 a[68:71],v12 offset:12544
v_cvt_pk_bf16_f32 v81,v82,v83
v_mfma_f32_16x16x32_bf16 v[136:139],a[128:131],v[52:55],v[136:139]
ds_read_b128 a[64:67],v11 offset:12544
v_cvt_pk_bf16_f32 v85,v86,v87
v_mfma_f32_16x16x32_bf16 v[140:143],a[132:135],v[52:55],v[140:143]
s_waitcnt lgkmcnt(5)
ds_read_b128 a[60:63],v12 offset:12416
buffer_store_dwordx4 v[104:107],v9,s[16:19],s87 offen offset:0 nt
v_accvgpr_read_b32 v102,a234
v_accvgpr_read_b32 v103,a235
v_accvgpr_read_b32 v100,a232
v_mfma_f32_16x16x32_bf16 v[236:239],a[132:135],v[48:51],v[236:239]
ds_read_b128 a[56:59],v11 offset:12416
v_accvgpr_read_b32 v101,a233
ds_read_b128 a[52:55],v12 offset:12288
v_pk_mul_f32 v[102:103],v[102:103],v[68:69] op_sel_hi:[1,0]
ds_read_b128 a[48:51],v11 offset:12288
s_waitcnt lgkmcnt(6)
buffer_store_dwordx4 v[108:111],v9,s[16:19],s87 offen offset:3072 nt
v_pk_mul_f32 v[100:101],v[100:101],v[68:69] op_sel_hi:[1,0]
v_accvgpr_read_b32 v96,a184
v_accvgpr_read_b32 v97,a185
v_pk_mul_f32 v[96:97],v[96:97],v[66:67] op_sel_hi:[1,0]
v_accvgpr_read_b32 v98,a186
v_accvgpr_read_b32 v99,a187
v_pk_mul_f32 v[98:99],v[98:99],v[66:67] op_sel_hi:[1,0]
v_accvgpr_read_b32 v82,a190
v_accvgpr_read_b32 v83,a191
ds_write2st64_b64 v36,v[80:81],v[84:85] offset0:36 offset1:40
v_pk_mul_f32 v[82:83],v[82:83],v[66:67] op_sel_hi:[1,0]
v_accvgpr_read_b32 v86,a238
v_accvgpr_read_b32 v87,a239
buffer_store_dwordx4 v[72:75],v9,s[16:19],s66 offen offset:0 nt
v_pk_mul_f32 v[86:87],v[86:87],v[68:69] op_sel_hi:[1,0]
v_accvgpr_read_b32 v80,a188
v_accvgpr_read_b32 v81,a189
v_pk_mul_f32 v[80:81],v[80:81],v[66:67] op_sel_hi:[1,0]
v_accvgpr_read_b32 v84,a236
v_accvgpr_read_b32 v85,a237
v_pk_mul_f32 v[84:85],v[84:85],v[68:69] op_sel_hi:[1,0]
v_cvt_pk_bf16_f32 v88,v88,v89
v_cvt_pk_bf16_f32 v92,v92,v93
v_mfma_f32_16x16x32_bf16 v[232:235],a[128:131],v[48:51],v[232:235]
v_cvt_pk_bf16_f32 v100,v100,v101
v_cvt_pk_bf16_f32 v96,v96,v97
v_mfma_f32_16x16x32_bf16 v[184:187],a[128:131],v[44:47],v[184:187]
buffer_store_dwordx4 v[76:79],v9,s[16:19],s66 offen offset:3072 nt
v_cvt_pk_bf16_f32 v89,v90,v91
v_cvt_pk_bf16_f32 v93,v94,v95
v_cvt_pk_bf16_f32 v80,v80,v81
v_mfma_f32_16x16x32_bf16 v[188:191],a[132:135],v[44:47],v[188:191]
v_cvt_pk_bf16_f32 v84,v84,v85
v_cvt_pk_bf16_f32 v101,v102,v103
v_mfma_f32_16x16x32_bf16 v[192:195],a[136:139],v[44:47],v[192:195]
v_cvt_pk_bf16_f32 v97,v98,v99
v_cvt_pk_bf16_f32 v81,v82,v83
v_mfma_f32_16x16x32_bf16 v[196:199],a[140:143],v[44:47],v[196:199]
ds_write2st64_b64 v37,v[88:89],v[92:93] offset0:36 offset1:40
v_mfma_f32_16x16x32_bf16 v[244:247],a[140:143],v[48:51],v[244:247]
v_cvt_pk_bf16_f32 v85,v86,v87
v_add_f32 v60,v60,v61
v_mfma_f32_16x16x32_bf16 v[240:243],a[136:139],v[48:51],v[240:243]
v_rcp_f32 v60,v60
v_mfma_f32_16x16x32_bf16 v[144:147],a[136:139],v[52:55],v[144:147]
v_min3_f32 v61,v60,v62,v64
v_min3_f32 v61,v61,v66,v68
v_mfma_f32_16x16x32_bf16 v[148:151],a[140:143],v[52:55],v[148:151]
ds_write2st64_b64 v38,v[96:97],v[100:101] offset0:36 offset1:40
v_mfma_f32_16x16x32_bf16 a[196:199],a[140:143],v[56:59],a[196:199]
v_cmp_nlt_f32 vcc,s37,v61
v_mov_b32 v67,0
v_mfma_f32_16x16x32_bf16 a[192:195],a[136:139],v[56:59],a[192:195]
v_mov_b32 v63,0
v_mov_b32 v65,0
v_mfma_f32_16x16x32_bf16 a[240:243],a[136:139],v[40:43],a[240:243]
s_cmp_lg_u64 vcc,0
v_mov_b32 v61,0
v_accvgpr_read_b32 v96,a196
v_mfma_f32_16x16x32_bf16 a[244:247],a[140:143],v[40:43],a[244:247]
s_cselect_b32 s62,s32,0
ds_write2st64_b64 v39,v[80:81],v[84:85] offset0:36 offset1:40
v_mfma_f32_16x16x32_bf16 a[248:251],a[144:147],v[40:43],a[248:251]
s_or_b32 s31,s31,s62
v_accvgpr_read_b32 v104,a192
v_accvgpr_read_b32 v105,a193
v_mfma_f32_16x16x32_bf16 a[252:255],a[148:151],v[40:43],a[252:255]
s_lshl_b32 s32,s32,1
ds_read_b128 v[72:75],v10 offset:18432
v_accvgpr_read_b32 v106,a194
ds_read_b128 v[76:79],v10 offset:19456
v_pk_mul_f32 v[104:105],v[104:105],v[66:67] op_sel_hi:[1,0]
ds_read_b128 v[88:91],v10 offset:20480
s_waitcnt vmcnt(4)
s_barrier
ds_read_b128 v[92:95],v10 offset:21504
v_accvgpr_read_b32 v107,a195
ds_read_b128 a[140:143],v1 offset:256
v_pk_mul_f32 v[106:107],v[106:107],v[66:67] op_sel_hi:[1,0]
ds_read_b128 a[136:139],v0 offset:256
v_accvgpr_read_b32 v108,a240
ds_read_b128 a[132:135],v1 offset:128
v_accvgpr_read_b32 v109,a241
s_waitcnt lgkmcnt(6)
buffer_store_dwordx4 v[72:75],v9,s[16:19],s87 offen offset:128 nt
ds_read_b128 a[128:131],v0 offset:128
v_pk_mul_f32 v[108:109],v[108:109],v[68:69] op_sel_hi:[1,0]
ds_read_b128 a[124:127],v1 offset:0
v_accvgpr_read_b32 v110,a242
ds_read_b128 a[120:123],v0 offset:0
v_accvgpr_read_b32 v111,a243
v_pk_mul_f32 v[110:111],v[110:111],v[68:69] op_sel_hi:[1,0]
v_accvgpr_read_b32 v97,a197
v_accvgpr_read_b32 v98,a198
v_mfma_f32_16x16x32_bf16 a[204:207],a[148:151],v[56:59],a[204:207]
s_add_u32 m0,s23,0
s_waitcnt lgkmcnt(5)
buffer_store_dwordx4 v[76:79],v9,s[16:19],s87 offen offset:3200 nt
buffer_load_dwordx4 v6,s[8:11],s25 offen offset:0 lds
v_pk_mul_f32 v[96:97],v[96:97],v[66:67] op_sel_hi:[1,0]
v_accvgpr_read_b32 v99,a199
v_pk_mul_f32 v[98:99],v[98:99],v[66:67] op_sel_hi:[1,0]
v_accvgpr_read_b32 v100,a244
v_accvgpr_read_b32 v101,a245
v_pk_mul_f32 v[100:101],v[100:101],v[68:69] op_sel_hi:[1,0]
v_accvgpr_read_b32 v102,a246
v_accvgpr_read_b32 v103,a247
buffer_store_dwordx4 v[88:91],v9,s[16:19],s66 offen offset:128 nt
v_pk_mul_f32 v[102:103],v[102:103],v[68:69] op_sel_hi:[1,0]
v_cvt_pk_bf16_f32 v104,v104,v105
v_cvt_pk_bf16_f32 v108,v108,v109
v_mfma_f32_16x16x32_bf16 a[200:203],a[144:147],v[56:59],a[200:203]
v_cvt_pk_bf16_f32 v105,v106,v107
v_cvt_pk_bf16_f32 v109,v110,v111
v_mfma_f32_16x16x32_bf16 v[152:155],a[144:147],v[52:55],v[152:155]
v_accvgpr_read_b32 v84,a248
v_accvgpr_read_b32 v85,a249
v_mfma_f32_16x16x32_bf16 v[156:159],a[148:151],v[52:55],v[156:159]
buffer_load_dwordx4 v7,s[8:11],s25 offen offset:1024 lds
v_mfma_f32_16x16x32_bf16 v[252:255],a[148:151],v[48:51],v[252:255]
ds_write2st64_b64 v36,v[104:105],v[108:109] offset0:36 offset1:40
v_pk_mul_f32 v[84:85],v[84:85],v[68:69] op_sel_hi:[1,0]
v_pk_mul_f32 v[208:209],v[208:209],v[62:63] op_sel_hi:[1,0]
v_pk_mul_f32 v[210:211],v[210:211],v[62:63] op_sel_hi:[1,0]
buffer_store_dwordx4 v[92:95],v9,s[16:19],s66 offen offset:3200 nt
v_pk_mul_f32 v[224:225],v[224:225],v[62:63] op_sel_hi:[1,0]
v_pk_mul_f32 v[226:227],v[226:227],v[62:63] op_sel_hi:[1,0]
v_pk_mul_f32 v[212:213],v[212:213],v[62:63] op_sel_hi:[1,0]
v_pk_mul_f32 v[214:215],v[214:215],v[62:63] op_sel_hi:[1,0]
v_pk_mul_f32 v[228:229],v[228:229],v[62:63] op_sel_hi:[1,0]
v_pk_mul_f32 v[230:231],v[230:231],v[62:63] op_sel_hi:[1,0]
v_pk_mul_f32 v[216:217],v[216:217],v[62:63] op_sel_hi:[1,0]
v_pk_mul_f32 v[218:219],v[218:219],v[62:63] op_sel_hi:[1,0]
v_pk_mul_f32 v[232:233],v[232:233],v[62:63] op_sel_hi:[1,0]
buffer_load_dwordx4 v8,s[8:11],s25 offen offset:2048 lds
v_pk_mul_f32 v[234:235],v[234:235],v[62:63] op_sel_hi:[1,0]
v_pk_mul_f32 v[220:221],v[220:221],v[62:63] op_sel_hi:[1,0]
v_pk_mul_f32 v[222:223],v[222:223],v[62:63] op_sel_hi:[1,0]
v_pk_mul_f32 v[236:237],v[236:237],v[62:63] op_sel_hi:[1,0]
v_pk_mul_f32 v[238:239],v[238:239],v[62:63] op_sel_hi:[1,0]
v_add_u32 v36,v36,v19
v_accvgpr_read_b32 v80,a200
v_accvgpr_read_b32 v81,a201
v_pk_mul_f32 v[80:81],v[80:81],v[66:67] op_sel_hi:[1,0]
v_accvgpr_read_b32 v86,a250
v_accvgpr_read_b32 v87,a251
v_pk_mul_f32 v[86:87],v[86:87],v[68:69] op_sel_hi:[1,0]
v_cvt_pk_bf16_f32 v96,v96,v97
v_cvt_pk_bf16_f32 v100,v100,v101
v_accvgpr_read_b32 v82,a202
v_accvgpr_read_b32 v83,a203
v_pk_mul_f32 v[82:83],v[82:83],v[66:67] op_sel_hi:[1,0]
v_accvgpr_read_b32 v104,a204
v_accvgpr_read_b32 v105,a205
v_pk_mul_f32 v[104:105],v[104:105],v[66:67] op_sel_hi:[1,0]
v_accvgpr_read_b32 v108,a252
v_accvgpr_read_b32 v109,a253
v_pk_mul_f32 v[108:109],v[108:109],v[68:69] op_sel_hi:[1,0]
v_accvgpr_read_b32 v106,a206
v_accvgpr_read_b32 v107,a207
v_pk_mul_f32 v[106:107],v[106:107],v[66:67] op_sel_hi:[1,0]
v_accvgpr_read_b32 v110,a254
v_accvgpr_read_b32 v111,a255
v_pk_mul_f32 v[110:111],v[110:111],v[68:69] op_sel_hi:[1,0]
v_cvt_pk_bf16_f32 v84,v84,v85
v_cvt_pk_bf16_f32 v80,v80,v81
v_mfma_f32_16x16x32_bf16 v[248:251],a[144:147],v[48:51],v[248:251]
s_waitcnt vmcnt(14)
ds_read_b128 a[72:75],v11 offset:0
v_cvt_pk_bf16_f32 v97,v98,v99
v_mfma_f32_16x16x32_bf16 v[200:203],a[144:147],v[44:47],v[200:203]
s_mov_b32 s27,s42
ds_read_b128 a[76:79],v12 offset:0
v_cvt_pk_bf16_f32 v101,v102,v103
v_mfma_f32_16x16x32_bf16 v[204:207],a[148:151],v[44:47],v[204:207]
s_mov_b32 s42,s41
ds_read_b128 a[80:83],v11 offset:128
v_cvt_pk_bf16_f32 v104,v104,v105
ds_read_b128 a[84:87],v12 offset:128
v_pk_mul_f32 v[240:241],v[240:241],v[62:63] op_sel_hi:[1,0]
ds_read_b128 a[88:91],v11 offset:256
v_pk_mul_f32 v[242:243],v[242:243],v[62:63] op_sel_hi:[1,0]
ds_read_b128 a[92:95],v12 offset:256
v_pk_mul_f32 v[112:113],v[112:113],v[64:65] op_sel_hi:[1,0]
ds_write2st64_b64 v37,v[96:97],v[100:101] offset0:36 offset1:40
v_pk_mul_f32 v[114:115],v[114:115],v[64:65] op_sel_hi:[1,0]
v_add_u32 v37,v37,v19
v_cvt_pk_bf16_f32 v108,v108,v109
ds_read_b128 a[144:147],v0 offset:6144
v_cvt_pk_bf16_f32 v85,v86,v87
ds_read_b128 a[148:151],v1 offset:6144
v_cvt_pk_bf16_f32 v81,v82,v83
ds_write2st64_b64 v38,v[80:81],v[84:85] offset0:36 offset1:40
v_add_u32 v38,v38,v19
v_cvt_pk_bf16_f32 v105,v106,v107
v_cvt_pk_bf16_f32 v109,v110,v111
v_cvt_pk_bf16_f32 v208,v208,v209
v_cvt_pk_bf16_f32 v224,v224,v225
v_cvt_pk_bf16_f32 v212,v212,v213
v_cvt_pk_bf16_f32 v228,v228,v229
v_cvt_pk_bf16_f32 v209,v210,v211
v_cvt_pk_bf16_f32 v225,v226,v227
v_cvt_pk_bf16_f32 v216,v216,v217
v_cvt_pk_bf16_f32 v232,v232,v233
ds_write2st64_b64 v39,v[104:105],v[108:109] offset0:36 offset1:40
v_add_u32 v39,v39,v19
v_cvt_pk_bf16_f32 v213,v214,v215
v_cvt_pk_bf16_f32 v229,v230,v231
ds_read_b128 v[72:75],v10 offset:18432
v_cvt_pk_bf16_f32 v220,v220,v221
ds_read_b128 v[76:79],v10 offset:19456
v_cvt_pk_bf16_f32 v236,v236,v237
ds_read_b128 v[88:91],v10 offset:20480
v_cvt_pk_bf16_f32 v217,v218,v219
ds_read_b128 v[92:95],v10 offset:21504
v_cvt_pk_bf16_f32 v233,v234,v235
ds_write2st64_b64 v36,v[208:209],v[224:225] offset0:12 offset1:14
v_cvt_pk_bf16_f32 v240,v240,v241
v_cvt_pk_bf16_f32 v112,v112,v113
v_cvt_pk_bf16_f32 v221,v222,v223
v_cvt_pk_bf16_f32 v237,v238,v239
v_cvt_pk_bf16_f32 v241,v242,v243
v_cvt_pk_bf16_f32 v113,v114,v115
v_mov_b32 v66,0
s_waitcnt lgkmcnt(4)
buffer_store_dwordx4 v[72:75],v9,s[16:19],s87 offen offset:256 nt
s_add_u32 s69,s69,1
s_lshl_b32 s62,s69,5
s_add_u32 s62,s62,s34
v_mfma_f32_16x16x32_bf16 v[72:75],a[140:143],a[20:23],0
s_mul_i32 s63,s62,171
s_lshr_b32 s63,s63,9
s_mul_i32 s64,s63,3
v_mfma_f32_16x16x32_bf16 v[72:75],a[136:139],a[16:19],v[72:75]
s_sub_u32 s62,s62,s64
s_add_u32 s63,s63,s33
s_mul_i32 s30,s63,196608
v_mfma_f32_16x16x32_bf16 v[72:75],a[132:135],a[12:15],v[72:75]
s_mul_i32 s41,s63,325632
s_waitcnt lgkmcnt(0)
buffer_store_dwordx4 v[76:79],v9,s[16:19],s87 offen offset:3328 nt
s_lshl_b32 s63,s3,2
s_add_u32 s64,s63,21
v_pk_mul_f32 v[244:245],v[244:245],v[62:63] op_sel_hi:[1,0]
v_pk_mul_f32 v[246:247],v[246:247],v[62:63] op_sel_hi:[1,0]
v_pk_mul_f32 v[116:117],v[116:117],v[64:65] op_sel_hi:[1,0]
v_pk_mul_f32 v[118:119],v[118:119],v[64:65] op_sel_hi:[1,0]
v_cvt_pk_bf16_f32 v244,v244,v245
v_cvt_pk_bf16_f32 v116,v116,v117
v_mfma_f32_16x16x32_bf16 v[72:75],a[128:131],a[8:11],v[72:75]
s_cmp_eq_u32 s3,0
v_cvt_pk_bf16_f32 v245,v246,v247
v_cvt_pk_bf16_f32 v117,v118,v119
v_mfma_f32_16x16x32_bf16 v[72:75],a[124:127],a[4:7],v[72:75]
s_cselect_b32 s64,20,s64
ds_write2st64_b64 v37,v[212:213],v[228:229] offset0:12 offset1:14
v_mfma_f32_16x16x32_bf16 v[72:75],a[120:123],a[0:3],v[72:75]
s_cselect_b32 s40,1,0
s_add_u32 s65,s63,37
buffer_store_dwordx4 v[88:91],v9,s[16:19],s66 offen offset:256 nt
v_pk_mul_f32 v[248:249],v[248:249],v[62:63] op_sel_hi:[1,0]
v_pk_mul_f32 v[250:251],v[250:251],v[62:63] op_sel_hi:[1,0]
v_pk_mul_f32 v[120:121],v[120:121],v[64:65] op_sel_hi:[1,0]
v_pk_mul_f32 v[122:123],v[122:123],v[64:65] op_sel_hi:[1,0]
v_cvt_pk_bf16_f32 v248,v248,v249
v_max3_f32 v44,v72,v73,v74
v_mfma_f32_16x16x32_bf16 v[80:83],a[120:123],a[24:27],0
s_cmp_eq_u32 s62,2
v_cvt_pk_bf16_f32 v120,v120,v121
v_cvt_pk_bf16_f32 v249,v250,v251
v_mfma_f32_16x16x32_bf16 v[80:83],a[124:127],a[28:31],v[80:83]
s_cselect_b32 s64,s65,s64
ds_write2st64_b64 v38,v[216:217],v[232:233] offset0:12 offset1:14
v_mfma_f32_16x16x32_bf16 v[80:83],a[128:131],a[32:35],v[80:83]
s_cselect_b32 s40,0,s40
v_cvt_pk_bf16_f32 v121,v122,v123
buffer_store_dwordx4 v[92:95],v9,s[16:19],s66 offen offset:3328 nt
v_pk_mul_f32 v[252:253],v[252:253],v[62:63] op_sel_hi:[1,0]
v_pk_mul_f32 v[254:255],v[254:255],v[62:63] op_sel_hi:[1,0]
v_pk_mul_f32 v[124:125],v[124:125],v[64:65] op_sel_hi:[1,0]
v_pk_mul_f32 v[126:127],v[126:127],v[64:65] op_sel_hi:[1,0]
v_cvt_pk_bf16_f32 v252,v252,v253
v_cvt_pk_bf16_f32 v124,v124,v125
v_mfma_f32_16x16x32_bf16 v[80:83],a[132:135],a[36:39],v[80:83]
s_add_u32 s65,s63,s3
v_cvt_pk_bf16_f32 v253,v254,v255
v_cvt_pk_bf16_f32 v125,v126,v127
v_mfma_f32_16x16x32_bf16 v[80:83],a[136:139],a[40:43],v[80:83]
s_cmp_eq_u32 s62,0
ds_write2st64_b64 v39,v[220:221],v[236:237] offset0:12 offset1:14
v_mfma_f32_16x16x32_bf16 v[80:83],a[140:143],a[44:47],v[80:83]
s_cselect_b32 s64,s65,s64
v_mov_b32 v62,0
s_cselect_b32 s40,1,s40
v_mfma_f32_16x16x32_bf16 v[88:91],a[140:143],a[68:71],0
s_mul_i32 s64,s64,6144
s_add_u32 s41,s41,s64
s_cmp_ge_u32 s69,6
s_cselect_b32 s41,166723584,s41
s_cselect_b32 s30,100663296,s30
v_max3_f32 v48,v80,v81,v82
ds_write2st64_b64 v36,v[240:241],v[112:113] offset0:16 offset1:24
v_pk_mul_f32 v[128:129],v[128:129],v[64:65] op_sel_hi:[1,0]
v_pk_mul_f32 v[130:131],v[130:131],v[64:65] op_sel_hi:[1,0]
v_pk_mul_f32 v[144:145],v[144:145],v[64:65] op_sel_hi:[1,0]
v_pk_mul_f32 v[146:147],v[146:147],v[64:65] op_sel_hi:[1,0]
v_cvt_pk_bf16_f32 v128,v128,v129
v_cvt_pk_bf16_f32 v144,v144,v145
v_mfma_f32_16x16x32_bf16 v[88:91],a[136:139],a[64:67],v[88:91]
s_add_u32 s25,s30,s22
v_cvt_pk_bf16_f32 v129,v130,v131
v_cvt_pk_bf16_f32 v145,v146,v147
v_mfma_f32_16x16x32_bf16 v[88:91],a[132:135],a[60:63],v[88:91]
s_add_u32 s26,s25,12288
s_add_u32 m0,s23,24576
ds_write2st64_b64 v37,v[244:245],v[116:117] offset0:16 offset1:24
v_mfma_f32_16x16x32_bf16 v[88:91],a[128:131],a[56:59],v[88:91]
s_mov_b32 s28,s41
s_mov_b32 s29,s24
v_pk_mul_f32 v[132:133],v[132:133],v[64:65] op_sel_hi:[1,0]
v_pk_mul_f32 v[134:135],v[134:135],v[64:65] op_sel_hi:[1,0]
v_pk_mul_f32 v[148:149],v[148:149],v[64:65] op_sel_hi:[1,0]
v_pk_mul_f32 v[150:151],v[150:151],v[64:65] op_sel_hi:[1,0]
v_cvt_pk_bf16_f32 v132,v132,v133
v_cvt_pk_bf16_f32 v148,v148,v149
v_mfma_f32_16x16x32_bf16 v[88:91],a[124:127],a[52:55],v[88:91]
ds_write2st64_b64 v38,v[248:249],v[120:121] offset0:16 offset1:24
v_mfma_f32_16x16x32_bf16 v[88:91],a[120:123],a[48:51],v[88:91]
v_cvt_pk_bf16_f32 v133,v134,v135
v_cvt_pk_bf16_f32 v149,v150,v151
v_mfma_f32_16x16x32_bf16 v[96:99],a[120:123],a[72:75],0
ds_read_b128 a[120:123],v0 offset:6272
v_pk_mul_f32 v[136:137],v[136:137],v[64:65] op_sel_hi:[1,0]
ds_write2st64_b64 v39,v[252:253],v[124:125] offset0:16 offset1:24
v_pk_mul_f32 v[138:139],v[138:139],v[64:65] op_sel_hi:[1,0]
v_pk_mul_f32 v[152:153],v[152:153],v[64:65] op_sel_hi:[1,0]
v_pk_mul_f32 v[154:155],v[154:155],v[64:65] op_sel_hi:[1,0]
v_max3_f32 v52,v88,v89,v90
v_cvt_pk_bf16_f32 v136,v136,v137
v_mfma_f32_16x16x32_bf16 v[96:99],a[124:127],a[76:79],v[96:99]
ds_read_b128 a[124:127],v1 offset:6272
v_cvt_pk_bf16_f32 v152,v152,v153
v_mfma_f32_16x16x32_bf16 v[96:99],a[128:131],a[80:83],v[96:99]
ds_read_b128 a[128:131],v0 offset:6400
v_cvt_pk_bf16_f32 v137,v138,v139
v_mfma_f32_16x16x32_bf16 v[96:99],a[132:135],a[84:87],v[96:99]
ds_write2st64_b64 v36,v[128:129],v[144:145] offset0:26 offset1:28
v_pk_mul_f32 v[140:141],v[140:141],v[64:65] op_sel_hi:[1,0]
v_pk_mul_f32 v[142:143],v[142:143],v[64:65] op_sel_hi:[1,0]
v_pk_mul_f32 v[156:157],v[156:157],v[64:65] op_sel_hi:[1,0]
ds_read_b128 a[132:135],v1 offset:6400
v_pk_mul_f32 v[158:159],v[158:159],v[64:65] op_sel_hi:[1,0]
v_cvt_pk_bf16_f32 v153,v154,v155
v_cvt_pk_bf16_f32 v140,v140,v141
v_mfma_f32_16x16x32_bf16 v[96:99],a[136:139],a[88:91],v[96:99]
ds_read_b128 a[136:139],v0 offset:12288
v_cvt_pk_bf16_f32 v156,v156,v157
v_mfma_f32_16x16x32_bf16 v[96:99],a[140:143],a[92:95],v[96:99]
ds_write2st64_b64 v37,v[132:133],v[148:149] offset0:26 offset1:28
v_mfma_f32_16x16x32_bf16 v[76:79],a[144:147],a[0:3],0
v_cvt_pk_bf16_f32 v141,v142,v143
ds_read_b128 a[140:143],v1 offset:12288
v_cvt_pk_bf16_f32 v157,v158,v159
v_pk_mul_f32 v[160:161],v[160:161],v[60:61] op_sel_hi:[1,0]
v_pk_mul_f32 v[162:163],v[162:163],v[60:61] op_sel_hi:[1,0]
v_pk_mul_f32 v[176:177],v[176:177],v[60:61] op_sel_hi:[1,0]
v_pk_mul_f32 v[178:179],v[178:179],v[60:61] op_sel_hi:[1,0]
v_max3_f32 v56,v96,v97,v98
v_cvt_pk_bf16_f32 v160,v160,v161
v_mfma_f32_16x16x32_bf16 v[76:79],a[148:151],a[4:7],v[76:79]
s_waitcnt lgkmcnt(3)
ds_write2st64_b64 v38,v[136:137],v[152:153] offset0:26 offset1:28
v_mfma_f32_16x16x32_bf16 v[76:79],a[120:123],a[8:11],v[76:79]
v_cvt_pk_bf16_f32 v176,v176,v177
v_cvt_pk_bf16_f32 v161,v162,v163
v_mfma_f32_16x16x32_bf16 v[76:79],a[124:127],a[12:15],v[76:79]
v_cvt_pk_bf16_f32 v177,v178,v179
v_mov_b32 v64,0
v_mfma_f32_16x16x32_bf16 v[76:79],a[128:131],a[16:19],v[76:79]
ds_write2st64_b64 v39,v[140:141],v[156:157] offset0:26 offset1:28
v_pk_mul_f32 v[164:165],v[164:165],v[60:61] op_sel_hi:[1,0]
v_pk_mul_f32 v[166:167],v[166:167],v[60:61] op_sel_hi:[1,0]
v_pk_mul_f32 v[180:181],v[180:181],v[60:61] op_sel_hi:[1,0]
v_pk_mul_f32 v[182:183],v[182:183],v[60:61] op_sel_hi:[1,0]
v_cvt_pk_bf16_f32 v164,v164,v165
v_cvt_pk_bf16_f32 v180,v180,v181
v_mfma_f32_16x16x32_bf16 v[76:79],a[132:135],a[20:23],v[76:79]
v_cvt_pk_bf16_f32 v165,v166,v167
v_cvt_pk_bf16_f32 v181,v182,v183
v_mfma_f32_16x16x32_bf16 v[84:87],a[132:135],a[44:47],0
buffer_load_dwordx4 v6,s[8:11],s21 offen offset:0 lds
v_mfma_f32_16x16x32_bf16 v[84:87],a[128:131],a[40:43],v[84:87]
ds_write2st64_b64 v36,v[160:161],v[176:177] offset0:0 offset1:2
v_pk_mul_f32 v[168:169],v[168:169],v[60:61] op_sel_hi:[1,0]
v_pk_mul_f32 v[170:171],v[170:171],v[60:61] op_sel_hi:[1,0]
v_pk_mul_f32 v[184:185],v[184:185],v[60:61] op_sel_hi:[1,0]
v_pk_mul_f32 v[186:187],v[186:187],v[60:61] op_sel_hi:[1,0]
v_max3_f32 v44,v44,v75,v76
v_max3_f32 v44,v44,v77,v78
v_mfma_f32_16x16x32_bf16 v[84:87],a[124:127],a[36:39],v[84:87]
v_max_f32 v44,v44,v79
v_mov_b32 v45,v44
v_mfma_f32_16x16x32_bf16 v[84:87],a[120:123],a[32:35],v[84:87]
v_cvt_pk_bf16_f32 v168,v168,v169
v_permlane32_swap_b32 v45,v44
v_mfma_f32_16x16x32_bf16 v[84:87],a[148:151],a[28:31],v[84:87]
ds_write2st64_b64 v37,v[164:165],v[180:181] offset0:0 offset1:2
v_pk_mul_f32 v[172:173],v[172:173],v[60:61] op_sel_hi:[1,0]
v_pk_mul_f32 v[174:175],v[174:175],v[60:61] op_sel_hi:[1,0]
v_pk_mul_f32 v[188:189],v[188:189],v[60:61] op_sel_hi:[1,0]
buffer_load_dwordx4 v7,s[8:11],s21 offen offset:1024 lds
v_pk_mul_f32 v[190:191],v[190:191],v[60:61] op_sel_hi:[1,0]
v_max_f32 v44,v44,v45
v_mov_b32 v45,v44
v_mfma_f32_16x16x32_bf16 v[84:87],a[144:147],a[24:27],v[84:87]
v_cvt_pk_bf16_f32 v184,v184,v185
v_permlane16_swap_b32 v45,v44
v_mfma_f32_16x16x32_bf16 v[92:95],a[144:147],a[48:51],0
v_max_f32 v44,v44,v45
v_mul_f32_e64 v13,-s36,v44
v_mfma_f32_16x16x32_bf16 v[92:95],a[148:151],a[52:55],v[92:95]
v_fma_f32 v72,v72,s36,v13
v_fma_f32 v73,v73,s36,v13
v_fma_f32 v74,v74,s36,v13
v_fma_f32 v75,v75,s36,v13
v_exp_f32 v72,v72
v_pk_mul_f32 v[192:193],v[192:193],v[60:61] op_sel_hi:[1,0]
v_pk_mul_f32 v[194:195],v[194:195],v[60:61] op_sel_hi:[1,0]
v_exp_f32 v73,v73
v_exp_f32 v74,v74
v_mfma_f32_16x16x32_bf16 v[92:95],a[120:123],a[56:59],v[92:95]
buffer_load_dwordx4 v8,s[8:11],s21 offen offset:2048 lds
v_mfma_f32_16x16x32_bf16 v[92:95],a[124:127],a[60:63],v[92:95]
s_add_u32 s21,s21,12288
v_exp_f32 v75,v75
v_mfma_f32_16x16x32_bf16 v[92:95],a[128:131],a[64:67],v[92:95]
s_add_u32 m0,s22,0
v_cvt_pk_bf16_f32 v20,v72,v73
v_cvt_pk_bf16_f32 v21,v74,v75
v_mfma_f32_16x16x32_bf16 v[92:95],a[132:135],a[68:71],v[92:95]
v_max3_f32 v48,v48,v83,v84
v_max3_f32 v48,v48,v85,v86
v_max_f32 v48,v48,v87
v_mov_b32 v49,v48
v_fma_f32 v76,v76,s36,v13
v_pk_mul_f32 v[196:197],v[196:197],v[60:61] op_sel_hi:[1,0]
v_pk_mul_f32 v[198:199],v[198:199],v[60:61] op_sel_hi:[1,0]
v_permlane32_swap_b32 v49,v48
v_max_f32 v48,v48,v49
v_mfma_f32_16x16x32_bf16 v[100:103],a[132:135],a[92:95],0
ds_read_b128 a[132:135],v1 offset:18432
v_mov_b32 v49,v48
v_mfma_f32_16x16x32_bf16 v[100:103],a[128:131],a[88:91],v[100:103]
ds_read_b128 a[128:131],v0 offset:18432
v_permlane16_swap_b32 v49,v48
v_mfma_f32_16x16x32_bf16 v[100:103],a[124:127],a[84:87],v[100:103]
ds_read_b128 a[124:127],v1 offset:12544
v_max_f32 v48,v48,v49
v_mul_f32_e64 v14,-s36,v48
v_fma_f32 v80,v80,s36,v14
v_fma_f32 v81,v81,s36,v14
v_pk_mul_f32 v[200:201],v[200:201],v[60:61] op_sel_hi:[1,0]
v_pk_mul_f32 v[202:203],v[202:203],v[60:61] op_sel_hi:[1,0]
v_fma_f32 v82,v82,s36,v14
v_fma_f32 v83,v83,s36,v14
v_mfma_f32_16x16x32_bf16 v[100:103],a[120:123],a[80:83],v[100:103]
ds_read_b128 a[120:123],v0 offset:12544
v_exp_f32 v80,v80
v_mfma_f32_16x16x32_bf16 v[100:103],a[148:151],a[76:79],v[100:103]
ds_read_b128 a[148:151],v1 offset:12416
v_exp_f32 v81,v81
v_mfma_f32_16x16x32_bf16 v[100:103],a[144:147],a[72:75],v[100:103]
ds_read_b128 a[144:147],v0 offset:12416
v_exp_f32 v82,v82
v_exp_f32 v83,v83
v_pk_mul_f32 v[204:205],v[204:205],v[60:61] op_sel_hi:[1,0]
v_pk_mul_f32 v[206:207],v[206:207],v[60:61] op_sel_hi:[1,0]
v_cvt_pk_bf16_f32 v24,v80,v81
v_cvt_pk_bf16_f32 v25,v82,v83
s_waitcnt lgkmcnt(3)
v_mfma_f32_16x16x32_bf16 v[72:75],a[124:127],a[20:23],0
v_max3_f32 v52,v52,v91,v92
v_max3_f32 v52,v52,v93,v94
v_max_f32 v52,v52,v95
v_mov_b32 v53,v52
v_max3_f32 v56,v56,v99,v100
v_max3_f32 v56,v56,v101,v102
v_permlane32_swap_b32 v53,v52
v_max_f32 v52,v52,v53
s_waitcnt lgkmcnt(2)
v_mfma_f32_16x16x32_bf16 v[72:75],a[120:123],a[16:19],v[72:75]
s_waitcnt lgkmcnt(1)
v_mov_b32 v53,v52
v_max_f32 v56,v56,v103
v_mov_b32 v57,v56
v_mfma_f32_16x16x32_bf16 v[72:75],a[148:151],a[12:15],v[72:75]
s_waitcnt lgkmcnt(0)
v_permlane16_swap_b32 v53,v52
v_max_f32 v52,v52,v53
v_mfma_f32_16x16x32_bf16 v[72:75],a[144:147],a[8:11],v[72:75]
v_mul_f32_e64 v15,-s36,v52
v_fma_f32 v88,v88,s36,v15
v_mfma_f32_16x16x32_bf16 v[72:75],a[140:143],a[4:7],v[72:75]
v_fma_f32 v89,v89,s36,v15
v_fma_f32 v90,v90,s36,v15
v_mfma_f32_16x16x32_bf16 v[72:75],a[136:139],a[0:3],v[72:75]
v_fma_f32 v91,v91,s36,v15
v_exp_f32 v88,v88
v_mfma_f32_16x16x32_bf16 v[80:83],a[136:139],a[24:27],0
v_exp_f32 v89,v89
v_mfma_f32_16x16x32_bf16 v[80:83],a[140:143],a[28:31],v[80:83]
v_exp_f32 v90,v90
v_mfma_f32_16x16x32_bf16 v[80:83],a[144:147],a[32:35],v[80:83]
v_exp_f32 v91,v91
v_mfma_f32_16x16x32_bf16 v[80:83],a[148:151],a[36:39],v[80:83]
v_cvt_pk_bf16_f32 v28,v88,v89
v_cvt_pk_bf16_f32 v29,v90,v91
v_mfma_f32_16x16x32_bf16 v[80:83],a[120:123],a[40:43],v[80:83]
v_permlane32_swap_b32 v57,v56
v_mfma_f32_16x16x32_bf16 v[80:83],a[124:127],a[44:47],v[80:83]
v_max_f32 v56,v56,v57
v_mov_b32 v57,v56
v_mfma_f32_16x16x32_bf16 v[88:91],a[124:127],a[68:71],0
v_fma_f32 v77,v77,s36,v13
v_permlane16_swap_b32 v57,v56
v_mfma_f32_16x16x32_bf16 v[88:91],a[120:123],a[64:67],v[88:91]
v_max_f32 v56,v56,v57
v_mul_f32_e64 v16,-s36,v56
v_mfma_f32_16x16x32_bf16 v[88:91],a[148:151],a[60:63],v[88:91]
v_fma_f32 v96,v96,s36,v16
v_fma_f32 v97,v97,s36,v16
v_mfma_f32_16x16x32_bf16 v[88:91],a[144:147],a[56:59],v[88:91]
v_fma_f32 v98,v98,s36,v16
v_fma_f32 v99,v99,s36,v16
v_mfma_f32_16x16x32_bf16 v[88:91],a[140:143],a[52:55],v[88:91]
v_exp_f32 v96,v96
v_mfma_f32_16x16x32_bf16 v[88:91],a[136:139],a[48:51],v[88:91]
v_exp_f32 v97,v97
v_exp_f32 v98,v98
v_exp_f32 v99,v99
v_cvt_pk_bf16_f32 v32,v96,v97
v_cvt_pk_bf16_f32 v33,v98,v99
v_mfma_f32_16x16x32_bf16 v[96:99],a[136:139],a[72:75],0
ds_read_b128 a[136:139],v0 offset:18560
v_fma_f32 v78,v78,s36,v13
v_mfma_f32_16x16x32_bf16 v[96:99],a[140:143],a[76:79],v[96:99]
ds_read_b128 a[140:143],v1 offset:18560
v_fma_f32 v79,v79,s36,v13
v_mfma_f32_16x16x32_bf16 v[96:99],a[144:147],a[80:83],v[96:99]
ds_read_b128 a[144:147],v0 offset:18688
v_exp_f32 v76,v76
v_mfma_f32_16x16x32_bf16 v[96:99],a[148:151],a[84:87],v[96:99]
ds_read_b128 a[148:151],v1 offset:18688
v_exp_f32 v77,v77
v_mfma_f32_16x16x32_bf16 v[96:99],a[120:123],a[88:91],v[96:99]
v_exp_f32 v78,v78
v_mfma_f32_16x16x32_bf16 v[96:99],a[124:127],a[92:95],v[96:99]
v_exp_f32 v79,v79
v_cvt_pk_bf16_f32 v22,v76,v77
v_cvt_pk_bf16_f32 v23,v78,v79
v_mfma_f32_16x16x32_bf16 v[76:79],a[128:131],a[0:3],0
v_fma_f32 v84,v84,s36,v14
v_fma_f32 v85,v85,s36,v14
v_mfma_f32_16x16x32_bf16 v[76:79],a[132:135],a[4:7],v[76:79]
s_waitcnt lgkmcnt(2)
v_fma_f32 v86,v86,s36,v14
v_fma_f32 v87,v87,s36,v14
v_mfma_f32_16x16x32_bf16 v[76:79],a[136:139],a[8:11],v[76:79]
v_exp_f32 v84,v84
v_mfma_f32_16x16x32_bf16 v[76:79],a[140:143],a[12:15],v[76:79]
s_waitcnt lgkmcnt(0)
v_exp_f32 v85,v85
v_mfma_f32_16x16x32_bf16 v[76:79],a[144:147],a[16:19],v[76:79]
v_exp_f32 v86,v86
v_mfma_f32_16x16x32_bf16 v[76:79],a[148:151],a[20:23],v[76:79]
v_exp_f32 v87,v87
v_cvt_pk_bf16_f32 v26,v84,v85
v_cvt_pk_bf16_f32 v27,v86,v87
v_mfma_f32_16x16x32_bf16 v[84:87],a[148:151],a[44:47],0
v_fma_f32 v92,v92,s36,v15
v_fma_f32 v93,v93,s36,v15
v_mfma_f32_16x16x32_bf16 v[84:87],a[144:147],a[40:43],v[84:87]
s_waitcnt vmcnt(7)
s_barrier
v_mfma_f32_16x16x32_bf16 v[84:87],a[140:143],a[36:39],v[84:87]
v_fma_f32 v94,v94,s36,v15
v_fma_f32 v95,v95,s36,v15
v_mfma_f32_16x16x32_bf16 v[84:87],a[136:139],a[32:35],v[84:87]
buffer_load_dwordx4 v6,s[4:7],s20 offen offset:0 lds
v_mfma_f32_16x16x32_bf16 v[84:87],a[132:135],a[28:31],v[84:87]
v_exp_f32 v92,v92
v_mfma_f32_16x16x32_bf16 v[84:87],a[128:131],a[24:27],v[84:87]
v_exp_f32 v93,v93
v_exp_f32 v94,v94
v_exp_f32 v95,v95
v_cvt_pk_bf16_f32 v30,v92,v93
v_cvt_pk_bf16_f32 v31,v94,v95
v_mfma_f32_16x16x32_bf16 v[92:95],a[128:131],a[48:51],0
v_fma_f32 v100,v100,s36,v16
v_fma_f32 v101,v101,s36,v16
v_mfma_f32_16x16x32_bf16 v[92:95],a[132:135],a[52:55],v[92:95]
buffer_load_dwordx4 v7,s[4:7],s20 offen offset:1024 lds
v_mfma_f32_16x16x32_bf16 v[92:95],a[136:139],a[56:59],v[92:95]
v_fma_f32 v102,v102,s36,v16
v_fma_f32 v103,v103,s36,v16
v_mfma_f32_16x16x32_bf16 v[92:95],a[140:143],a[60:63],v[92:95]
v_exp_f32 v100,v100
v_mfma_f32_16x16x32_bf16 v[92:95],a[144:147],a[64:67],v[92:95]
v_exp_f32 v101,v101
v_mfma_f32_16x16x32_bf16 v[92:95],a[148:151],a[68:71],v[92:95]
ds_read_b64_tr_b16 a[120:121],v2 offset:0
ds_read_b64_tr_b16 a[122:123],v2 offset:6144
buffer_load_dwordx4 v8,s[4:7],s20 offen offset:2048 lds
ds_read_b64_tr_b16 a[124:125],v3 offset:0
ds_read_b64_tr_b16 a[126:127],v3 offset:6144
v_exp_f32 v102,v102
v_exp_f32 v103,v103
v_cvt_pk_bf16_f32 v34,v100,v101
v_cvt_pk_bf16_f32 v35,v102,v103
v_mfma_f32_16x16x32_bf16 v[100:103],a[148:151],a[92:95],0
s_add_u32 s20,s20,12288
v_cvt_pk_bf16_f32 v169,v170,v171
v_cvt_pk_bf16_f32 v172,v172,v173
v_smfmac_f32_16x16x64_bf16 v[64:67],a[152:155],v[28:35],v18
v_cvt_pk_bf16_f32 v188,v188,v189
v_mfma_f32_16x16x32_bf16 v[100:103],a[144:147],a[88:91],v[100:103]
v_cvt_pk_bf16_f32 v185,v186,v187
v_mov_b32 v60,0
v_mfma_f32_16x16x32_bf16 v[100:103],a[140:143],a[84:87],v[100:103]
ds_write2st64_b64 v38,v[168:169],v[184:185] offset0:0 offset1:2
v_smfmac_f32_16x16x64_bf16 v[60:63],a[152:155],v[20:27],v18
v_cvt_pk_bf16_f32 v192,v192,v193
v_mfma_f32_16x16x32_bf16 v[100:103],a[136:139],a[80:83],v[100:103]
v_cvt_pk_bf16_f32 v173,v174,v175
v_cvt_pk_bf16_f32 v189,v190,v191
v_mfma_f32_16x16x32_bf16 v[100:103],a[132:135],a[76:79],v[100:103]
ds_read_b64_tr_b16 a[132:133],v5 offset:0
v_cvt_pk_bf16_f32 v196,v196,v197
v_mfma_f32_16x16x32_bf16 v[100:103],a[128:131],a[72:75],v[100:103]
ds_write2st64_b64 v39,v[172:173],v[188:189] offset0:0 offset1:2
v_fma_f32 v72,v72,s36,v13
v_fma_f32 v73,v73,s36,v13
v_fma_f32 v74,v74,s36,v13
ds_read_b64_tr_b16 a[128:129],v4 offset:0
ds_read_b64_tr_b16 a[130:131],v4 offset:6144
ds_read_b64_tr_b16 a[134:135],v5 offset:6144
v_fma_f32 v75,v75,s36,v13
v_fma_f32 v80,v80,s36,v14
v_fma_f32 v81,v81,s36,v14
v_cvt_pk_bf16_f32 v193,v194,v195
ds_write_b64 v36,v[192:193] offset:2048
v_cvt_pk_bf16_f32 v200,v200,v201
v_cvt_pk_bf16_f32 v197,v198,v199
v_exp_f32 v72,v72
ds_write_b64 v37,v[196:197] offset:2048
v_exp_f32 v73,v73
v_exp_f32 v74,v74
v_exp_f32 v75,v75
v_exp_f32 v80,v80
v_exp_f32 v81,v81
v_cvt_pk_bf16_f32 v204,v204,v205
v_cvt_pk_bf16_f32 v201,v202,v203
ds_write_b64 v38,v[200:201] offset:2048
v_cvt_pk_bf16_f32 v205,v206,v207
v_cvt_pk_bf16_f32 v44,v72,v73
v_cvt_pk_bf16_f32 v45,v74,v75
v_cvt_pk_bf16_f32 v48,v80,v81
ds_write_b64 v39,v[204:205] offset:2048
s_waitcnt lgkmcnt(3)
v_mfma_f32_16x16x32_bf16 v[160:163],a[120:123],v[20:23],0
s_add_u32 m0,s23,0
ds_read_b64_tr_b16 a[136:137],v2 offset:128
v_fma_f32 v82,v82,s36,v14
v_mfma_f32_16x16x32_bf16 v[164:167],a[124:127],v[20:23],0
ds_read_b64_tr_b16 a[138:139],v2 offset:6272
v_fma_f32 v83,v83,s36,v14
v_mfma_f32_16x16x32_bf16 v[212:215],a[124:127],v[24:27],0
ds_read_b64_tr_b16 a[140:141],v3 offset:128
v_fma_f32 v88,v88,s36,v15
v_mfma_f32_16x16x32_bf16 v[208:211],a[120:123],v[24:27],0
ds_read_b64_tr_b16 a[142:143],v3 offset:6272
v_fma_f32 v89,v89,s36,v15
v_mfma_f32_16x16x32_bf16 v[112:115],a[120:123],v[28:31],0
ds_read_b64_tr_b16 a[144:145],v4 offset:128
v_fma_f32 v90,v90,s36,v15
v_mfma_f32_16x16x32_bf16 v[116:119],a[124:127],v[28:31],0
ds_read_b64_tr_b16 a[146:147],v4 offset:6272
v_fma_f32 v91,v91,s36,v15
v_mfma_f32_16x16x32_bf16 a[164:167],a[124:127],v[32:35],0
ds_read_b64_tr_b16 a[148:149],v5 offset:128
v_fma_f32 v96,v96,s36,v16
v_mfma_f32_16x16x32_bf16 a[160:163],a[120:123],v[32:35],0
ds_read_b64_tr_b16 a[150:151],v5 offset:6272
v_fma_f32 v97,v97,s36,v16
v_mfma_f32_16x16x32_bf16 a[168:171],a[128:131],v[32:35],0
ds_read_b64_tr_b16 a[120:121],v2 offset:256
v_fma_f32 v98,v98,s36,v16
v_mfma_f32_16x16x32_bf16 a[172:175],a[132:135],v[32:35],0
ds_read_b64_tr_b16 a[122:123],v2 offset:6400
v_fma_f32 v99,v99,s36,v16
v_mfma_f32_16x16x32_bf16 v[124:127],a[132:135],v[28:31],0
ds_read_b64_tr_b16 a[124:125],v3 offset:256
v_fma_f32 v76,v76,s36,v13
v_mfma_f32_16x16x32_bf16 v[120:123],a[128:131],v[28:31],0
ds_read_b64_tr_b16 a[126:127],v3 offset:6400
v_fma_f32 v77,v77,s36,v13
v_mfma_f32_16x16x32_bf16 v[216:219],a[128:131],v[24:27],0
v_exp_f32 v82,v82
v_mfma_f32_16x16x32_bf16 v[220:223],a[132:135],v[24:27],0
v_exp_f32 v83,v83
v_mfma_f32_16x16x32_bf16 v[172:175],a[132:135],v[20:23],0
ds_read_b64_tr_b16 a[132:133],v5 offset:256
v_cvt_pk_bf16_f32 v49,v82,v83
v_mfma_f32_16x16x32_bf16 v[168:171],a[128:131],v[20:23],0
s_waitcnt lgkmcnt(4)
ds_read_b64_tr_b16 a[128:129],v4 offset:256
v_fma_f32 v78,v78,s36,v13
v_mfma_f32_16x16x32_bf16 v[176:179],a[136:139],v[20:23],0
ds_read_b64_tr_b16 a[130:131],v4 offset:6400
v_fma_f32 v79,v79,s36,v13
v_mfma_f32_16x16x32_bf16 v[180:183],a[140:143],v[20:23],0
ds_read_b64_tr_b16 a[134:135],v5 offset:6400
v_fma_f32 v84,v84,s36,v14
v_mfma_f32_16x16x32_bf16 v[228:231],a[140:143],v[24:27],0
v_exp_f32 v88,v88
v_mfma_f32_16x16x32_bf16 v[224:227],a[136:139],v[24:27],0
v_exp_f32 v89,v89
v_mfma_f32_16x16x32_bf16 v[128:131],a[136:139],v[28:31],0
v_exp_f32 v90,v90
v_mfma_f32_16x16x32_bf16 v[132:135],a[140:143],v[28:31],0
v_exp_f32 v91,v91
v_mfma_f32_16x16x32_bf16 a[180:183],a[140:143],v[32:35],0
v_cvt_pk_bf16_f32 v52,v88,v89
v_cvt_pk_bf16_f32 v53,v90,v91
v_mfma_f32_16x16x32_bf16 a[176:179],a[136:139],v[32:35],0
v_exp_f32 v96,v96
v_mfma_f32_16x16x32_bf16 a[184:187],a[144:147],v[32:35],0
v_exp_f32 v97,v97
v_mfma_f32_16x16x32_bf16 a[188:191],a[148:151],v[32:35],0
v_exp_f32 v98,v98
v_mfma_f32_16x16x32_bf16 v[140:143],a[148:151],v[28:31],0
v_exp_f32 v99,v99
v_mfma_f32_16x16x32_bf16 v[136:139],a[144:147],v[28:31],0
v_cvt_pk_bf16_f32 v56,v96,v97
v_cvt_pk_bf16_f32 v57,v98,v99
v_mfma_f32_16x16x32_bf16 v[232:235],a[144:147],v[24:27],0
v_exp_f32 v76,v76
v_mfma_f32_16x16x32_bf16 v[236:239],a[148:151],v[24:27],0
v_exp_f32 v77,v77
v_mfma_f32_16x16x32_bf16 v[188:191],a[148:151],v[20:23],0
v_exp_f32 v78,v78
v_mfma_f32_16x16x32_bf16 v[184:187],a[144:147],v[20:23],0
s_waitcnt lgkmcnt(0)
v_exp_f32 v79,v79
v_mfma_f32_16x16x32_bf16 v[192:195],a[120:123],v[20:23],0
v_cvt_pk_bf16_f32 v46,v76,v77
v_cvt_pk_bf16_f32 v47,v78,v79
v_mfma_f32_16x16x32_bf16 v[196:199],a[124:127],v[20:23],0
s_waitcnt vmcnt(30)
v_fma_f32 v85,v85,s36,v14
v_fma_f32 v86,v86,s36,v14
v_mfma_f32_16x16x32_bf16 v[244:247],a[124:127],v[24:27],0
s_barrier
v_mfma_f32_16x16x32_bf16 v[240:243],a[120:123],v[24:27],0
ds_read_b128 a[148:151],v1 offset:24704
v_fma_f32 v87,v87,s36,v14
v_mfma_f32_16x16x32_bf16 v[144:147],a[120:123],v[28:31],0
ds_read_b128 a[144:147],v0 offset:24704
v_fma_f32 v92,v92,s36,v15
v_mfma_f32_16x16x32_bf16 v[148:151],a[124:127],v[28:31],0
ds_read_b128 a[140:143],v1 offset:24576
v_fma_f32 v93,v93,s36,v15
v_mfma_f32_16x16x32_bf16 a[196:199],a[124:127],v[32:35],0
ds_read_b128 a[124:127],v1 offset:24832
v_fma_f32 v94,v94,s36,v15
v_mfma_f32_16x16x32_bf16 a[192:195],a[120:123],v[32:35],0
ds_read_b128 a[120:123],v0 offset:24832
v_fma_f32 v95,v95,s36,v15
v_mfma_f32_16x16x32_bf16 a[200:203],a[128:131],v[32:35],0
buffer_load_dwordx4 v6,s[8:11],s21 offen offset:0 lds
v_mfma_f32_16x16x32_bf16 a[204:207],a[132:135],v[32:35],0
ds_read_b128 a[136:139],v0 offset:24576
v_fma_f32 v100,v100,s36,v16
v_mfma_f32_16x16x32_bf16 v[156:159],a[132:135],v[28:31],0
v_exp_f32 v84,v84
v_mfma_f32_16x16x32_bf16 v[152:155],a[128:131],v[28:31],0
v_exp_f32 v85,v85
v_mfma_f32_16x16x32_bf16 v[248:251],a[128:131],v[24:27],0
v_exp_f32 v86,v86
v_mfma_f32_16x16x32_bf16 v[252:255],a[132:135],v[24:27],0
v_exp_f32 v87,v87
v_mfma_f32_16x16x32_bf16 v[204:207],a[132:135],v[20:23],0
ds_read_b128 a[132:135],v1 offset:30720
v_cvt_pk_bf16_f32 v50,v84,v85
v_mfma_f32_16x16x32_bf16 v[200:203],a[128:131],v[20:23],0
s_waitcnt lgkmcnt(2)
ds_read_b128 a[128:131],v0 offset:30720
v_cvt_pk_bf16_f32 v51,v86,v87
v_mfma_f32_16x16x32_bf16 v[72:75],a[124:127],a[20:23],0
v_exp_f32 v92,v92
v_smfmac_f32_16x16x64_bf16 v[60:63],a[152:155],v[44:51],v18
buffer_load_dwordx4 v7,s[8:11],s21 offen offset:1024 lds
v_mfma_f32_16x16x32_bf16 v[72:75],a[120:123],a[16:19],v[72:75]
v_exp_f32 v93,v93
v_mfma_f32_16x16x32_bf16 v[72:75],a[148:151],a[12:15],v[72:75]
v_exp_f32 v94,v94
v_mfma_f32_16x16x32_bf16 v[72:75],a[144:147],a[8:11],v[72:75]
v_exp_f32 v95,v95
v_mfma_f32_16x16x32_bf16 v[72:75],a[140:143],a[4:7],v[72:75]
s_waitcnt lgkmcnt(1)
v_cvt_pk_bf16_f32 v54,v92,v93
v_cvt_pk_bf16_f32 v55,v94,v95
v_mfma_f32_16x16x32_bf16 v[72:75],a[136:139],a[0:3],v[72:75]
v_fma_f32 v101,v101,s36,v16
v_fma_f32 v102,v102,s36,v16
v_mfma_f32_16x16x32_bf16 v[80:83],a[136:139],a[24:27],0
v_fma_f32 v103,v103,s36,v16
v_mfma_f32_16x16x32_bf16 v[80:83],a[140:143],a[28:31],v[80:83]
v_exp_f32 v100,v100
v_mfma_f32_16x16x32_bf16 v[80:83],a[144:147],a[32:35],v[80:83]
buffer_load_dwordx4 v8,s[8:11],s21 offen offset:2048 lds
v_mfma_f32_16x16x32_bf16 v[80:83],a[148:151],a[36:39],v[80:83]
s_add_u32 s21,s21,12288
v_exp_f32 v101,v101
v_mfma_f32_16x16x32_bf16 v[80:83],a[120:123],a[40:43],v[80:83]
s_add_u32 m0,s22,12288
v_exp_f32 v102,v102
v_mfma_f32_16x16x32_bf16 v[80:83],a[124:127],a[44:47],v[80:83]
v_exp_f32 v103,v103
v_mfma_f32_16x16x32_bf16 v[88:91],a[124:127],a[68:71],0
v_cvt_pk_bf16_f32 v58,v100,v101
v_cvt_pk_bf16_f32 v59,v102,v103
v_mfma_f32_16x16x32_bf16 v[88:91],a[120:123],a[64:67],v[88:91]
v_fma_f32 v72,v72,s36,v13
v_fma_f32 v73,v73,s36,v13
v_smfmac_f32_16x16x64_bf16 v[64:67],a[152:155],v[52:59],v18
v_fma_f32 v74,v74,s36,v13
v_mfma_f32_16x16x32_bf16 v[88:91],a[148:151],a[60:63],v[88:91]
v_fma_f32 v75,v75,s36,v13
v_fma_f32 v80,v80,s36,v14
v_mfma_f32_16x16x32_bf16 v[88:91],a[144:147],a[56:59],v[88:91]
v_fma_f32 v81,v81,s36,v14
v_mfma_f32_16x16x32_bf16 v[88:91],a[140:143],a[52:55],v[88:91]
buffer_load_dwordx4 v6,s[4:7],s20 offen offset:0 lds
v_mfma_f32_16x16x32_bf16 v[88:91],a[136:139],a[48:51],v[88:91]
v_exp_f32 v72,v72
v_mfma_f32_16x16x32_bf16 v[96:99],a[136:139],a[72:75],0
ds_read_b128 a[136:139],v0 offset:30848
v_mfma_f32_16x16x32_bf16 v[96:99],a[140:143],a[76:79],v[96:99]
ds_read_b128 a[140:143],v1 offset:30848
v_mfma_f32_16x16x32_bf16 v[96:99],a[144:147],a[80:83],v[96:99]
ds_read_b128 a[144:147],v0 offset:30976
v_mfma_f32_16x16x32_bf16 v[96:99],a[148:151],a[84:87],v[96:99]
ds_read_b128 a[148:151],v1 offset:30976
v_mfma_f32_16x16x32_bf16 v[96:99],a[120:123],a[88:91],v[96:99]
v_exp_f32 v73,v73
v_mfma_f32_16x16x32_bf16 v[96:99],a[124:127],a[92:95],v[96:99]
s_waitcnt lgkmcnt(4)
v_exp_f32 v74,v74
v_mfma_f32_16x16x32_bf16 v[76:79],a[128:131],a[0:3],0
v_exp_f32 v75,v75
v_mfma_f32_16x16x32_bf16 v[76:79],a[132:135],a[4:7],v[76:79]
buffer_load_dwordx4 v7,s[4:7],s20 offen offset:1024 lds
s_waitcnt lgkmcnt(3)
v_mfma_f32_16x16x32_bf16 v[76:79],a[136:139],a[8:11],v[76:79]
s_waitcnt lgkmcnt(2)
v_exp_f32 v80,v80
v_mfma_f32_16x16x32_bf16 v[76:79],a[140:143],a[12:15],v[76:79]
s_waitcnt lgkmcnt(0)
v_exp_f32 v81,v81
v_mfma_f32_16x16x32_bf16 v[76:79],a[144:147],a[16:19],v[76:79]
v_cvt_pk_bf16_f32 v20,v72,v73
v_cvt_pk_bf16_f32 v21,v74,v75
v_mfma_f32_16x16x32_bf16 v[76:79],a[148:151],a[20:23],v[76:79]
v_cvt_pk_bf16_f32 v24,v80,v81
v_mfma_f32_16x16x32_bf16 v[84:87],a[148:151],a[44:47],0
v_mfma_f32_16x16x32_bf16 v[84:87],a[144:147],a[40:43],v[84:87]
v_mfma_f32_16x16x32_bf16 v[84:87],a[140:143],a[36:39],v[84:87]
v_mfma_f32_16x16x32_bf16 v[84:87],a[136:139],a[32:35],v[84:87]
v_mfma_f32_16x16x32_bf16 v[84:87],a[132:135],a[28:31],v[84:87]
buffer_load_dwordx4 v8,s[4:7],s20 offen offset:2048 lds
v_mfma_f32_16x16x32_bf16 v[84:87],a[128:131],a[24:27],v[84:87]
s_add_u32 s20,s20,12288
v_mfma_f32_16x16x32_bf16 v[92:95],a[128:131],a[48:51],0
ds_read_b64_tr_b16 a[120:121],v2 offset:12288
v_mfma_f32_16x16x32_bf16 v[92:95],a[132:135],a[52:55],v[92:95]
ds_read_b64_tr_b16 a[122:123],v2 offset:18432
v_mfma_f32_16x16x32_bf16 v[92:95],a[136:139],a[56:59],v[92:95]
ds_read_b64_tr_b16 a[124:125],v3 offset:12288
v_mfma_f32_16x16x32_bf16 v[92:95],a[140:143],a[60:63],v[92:95]
ds_read_b64_tr_b16 a[126:127],v3 offset:18432
v_mfma_f32_16x16x32_bf16 v[92:95],a[144:147],a[64:67],v[92:95]
v_mfma_f32_16x16x32_bf16 v[92:95],a[148:151],a[68:71],v[92:95]
v_mfma_f32_16x16x32_bf16 v[100:103],a[148:151],a[92:95],0
v_mfma_f32_16x16x32_bf16 v[100:103],a[144:147],a[88:91],v[100:103]
v_mfma_f32_16x16x32_bf16 v[100:103],a[140:143],a[84:87],v[100:103]
v_mfma_f32_16x16x32_bf16 v[100:103],a[136:139],a[80:83],v[100:103]
v_mfma_f32_16x16x32_bf16 v[100:103],a[132:135],a[76:79],v[100:103]
ds_read_b64_tr_b16 a[132:133],v5 offset:12288
v_mfma_f32_16x16x32_bf16 v[100:103],a[128:131],a[72:75],v[100:103]
s_waitcnt lgkmcnt(1)
ds_read_b64_tr_b16 a[128:129],v4 offset:12288
ds_read_b64_tr_b16 a[130:131],v4 offset:18432
ds_read_b64_tr_b16 a[134:135],v5 offset:18432
v_mfma_f32_16x16x32_bf16 v[160:163],a[120:123],v[44:47],v[160:163]
s_add_u32 m0,s23,12288
ds_read_b64_tr_b16 a[136:137],v2 offset:12416
v_fma_f32 v82,v82,s36,v14
v_mfma_f32_16x16x32_bf16 v[164:167],a[124:127],v[44:47],v[164:167]
ds_read_b64_tr_b16 a[138:139],v2 offset:18560
v_fma_f32 v83,v83,s36,v14
v_mfma_f32_16x16x32_bf16 v[212:215],a[124:127],v[48:51],v[212:215]
ds_read_b64_tr_b16 a[140:141],v3 offset:12416
v_fma_f32 v88,v88,s36,v15
v_mfma_f32_16x16x32_bf16 v[208:211],a[120:123],v[48:51],v[208:211]
ds_read_b64_tr_b16 a[142:143],v3 offset:18560
v_fma_f32 v89,v89,s36,v15
v_mfma_f32_16x16x32_bf16 v[112:115],a[120:123],v[52:55],v[112:115]
ds_read_b64_tr_b16 a[144:145],v4 offset:12416
v_fma_f32 v90,v90,s36,v15
v_mfma_f32_16x16x32_bf16 v[116:119],a[124:127],v[52:55],v[116:119]
ds_read_b64_tr_b16 a[146:147],v4 offset:18560
v_fma_f32 v91,v91,s36,v15
v_mfma_f32_16x16x32_bf16 a[164:167],a[124:127],v[56:59],a[164:167]
ds_read_b64_tr_b16 a[148:149],v5 offset:12416
v_fma_f32 v96,v96,s36,v16
v_mfma_f32_16x16x32_bf16 a[160:163],a[120:123],v[56:59],a[160:163]
s_waitcnt lgkmcnt(6)
ds_read_b64_tr_b16 a[150:151],v5 offset:18560
v_fma_f32 v97,v97,s36,v16
v_mfma_f32_16x16x32_bf16 a[168:171],a[128:131],v[56:59],a[168:171]
ds_read_b64_tr_b16 a[120:121],v2 offset:12544
v_fma_f32 v98,v98,s36,v16
v_mfma_f32_16x16x32_bf16 a[172:175],a[132:135],v[56:59],a[172:175]
ds_read_b64_tr_b16 a[122:123],v2 offset:18688
v_fma_f32 v99,v99,s36,v16
v_mfma_f32_16x16x32_bf16 v[124:127],a[132:135],v[52:55],v[124:127]
ds_read_b64_tr_b16 a[124:125],v3 offset:12544
v_fma_f32 v76,v76,s36,v13
v_mfma_f32_16x16x32_bf16 v[120:123],a[128:131],v[52:55],v[120:123]
ds_read_b64_tr_b16 a[126:127],v3 offset:18688
v_fma_f32 v77,v77,s36,v13
v_mfma_f32_16x16x32_bf16 v[216:219],a[128:131],v[48:51],v[216:219]
v_exp_f32 v82,v82
v_mfma_f32_16x16x32_bf16 v[220:223],a[132:135],v[48:51],v[220:223]
v_exp_f32 v83,v83
v_mfma_f32_16x16x32_bf16 v[172:175],a[132:135],v[44:47],v[172:175]
ds_read_b64_tr_b16 a[132:133],v5 offset:12544
v_cvt_pk_bf16_f32 v25,v82,v83
v_mfma_f32_16x16x32_bf16 v[168:171],a[128:131],v[44:47],v[168:171]
s_waitcnt lgkmcnt(4)
ds_read_b64_tr_b16 a[128:129],v4 offset:12544
v_fma_f32 v78,v78,s36,v13
v_mfma_f32_16x16x32_bf16 v[176:179],a[136:139],v[44:47],v[176:179]
ds_read_b64_tr_b16 a[130:131],v4 offset:18688
v_fma_f32 v79,v79,s36,v13
v_mfma_f32_16x16x32_bf16 v[180:183],a[140:143],v[44:47],v[180:183]
ds_read_b64_tr_b16 a[134:135],v5 offset:18688
v_fma_f32 v84,v84,s36,v14
v_mfma_f32_16x16x32_bf16 v[228:231],a[140:143],v[48:51],v[228:231]
v_exp_f32 v88,v88
v_mfma_f32_16x16x32_bf16 v[224:227],a[136:139],v[48:51],v[224:227]
v_exp_f32 v89,v89
v_mfma_f32_16x16x32_bf16 v[128:131],a[136:139],v[52:55],v[128:131]
v_exp_f32 v90,v90
v_mfma_f32_16x16x32_bf16 v[132:135],a[140:143],v[52:55],v[132:135]
v_exp_f32 v91,v91
v_mfma_f32_16x16x32_bf16 a[180:183],a[140:143],v[56:59],a[180:183]
v_cvt_pk_bf16_f32 v28,v88,v89
v_cvt_pk_bf16_f32 v29,v90,v91
v_mfma_f32_16x16x32_bf16 a[176:179],a[136:139],v[56:59],a[176:179]
v_exp_f32 v96,v96
v_mfma_f32_16x16x32_bf16 a[184:187],a[144:147],v[56:59],a[184:187]
v_exp_f32 v97,v97
v_mfma_f32_16x16x32_bf16 a[188:191],a[148:151],v[56:59],a[188:191]
v_exp_f32 v98,v98
v_mfma_f32_16x16x32_bf16 v[140:143],a[148:151],v[52:55],v[140:143]
v_exp_f32 v99,v99
v_mfma_f32_16x16x32_bf16 v[136:139],a[144:147],v[52:55],v[136:139]
v_cvt_pk_bf16_f32 v32,v96,v97
v_cvt_pk_bf16_f32 v33,v98,v99
v_mfma_f32_16x16x32_bf16 v[232:235],a[144:147],v[48:51],v[232:235]
v_exp_f32 v76,v76
v_mfma_f32_16x16x32_bf16 v[236:239],a[148:151],v[48:51],v[236:239]
v_exp_f32 v77,v77
v_mfma_f32_16x16x32_bf16 v[188:191],a[148:151],v[44:47],v[188:191]
v_exp_f32 v78,v78
v_mfma_f32_16x16x32_bf16 v[184:187],a[144:147],v[44:47],v[184:187]
s_waitcnt lgkmcnt(0)
v_exp_f32 v79,v79
v_mfma_f32_16x16x32_bf16 v[192:195],a[120:123],v[44:47],v[192:195]
v_cvt_pk_bf16_f32 v22,v76,v77
v_cvt_pk_bf16_f32 v23,v78,v79
v_mfma_f32_16x16x32_bf16 v[196:199],a[124:127],v[44:47],v[196:199]
s_waitcnt vmcnt(6)
v_fma_f32 v85,v85,s36,v14
v_fma_f32 v86,v86,s36,v14
v_mfma_f32_16x16x32_bf16 v[244:247],a[124:127],v[48:51],v[244:247]
s_barrier
v_mfma_f32_16x16x32_bf16 v[240:243],a[120:123],v[48:51],v[240:243]
ds_read_b128 a[148:151],v1 offset:128
v_fma_f32 v87,v87,s36,v14
v_mfma_f32_16x16x32_bf16 v[144:147],a[120:123],v[52:55],v[144:147]
ds_read_b128 a[144:147],v0 offset:128
v_fma_f32 v92,v92,s36,v15
v_mfma_f32_16x16x32_bf16 v[148:151],a[124:127],v[52:55],v[148:151]
ds_read_b128 a[140:143],v1 offset:0
v_fma_f32 v93,v93,s36,v15
v_mfma_f32_16x16x32_bf16 a[196:199],a[124:127],v[56:59],a[196:199]
ds_read_b128 a[124:127],v1 offset:256
v_fma_f32 v94,v94,s36,v15
v_mfma_f32_16x16x32_bf16 a[192:195],a[120:123],v[56:59],a[192:195]
ds_read_b128 a[120:123],v0 offset:256
v_fma_f32 v95,v95,s36,v15
v_mfma_f32_16x16x32_bf16 a[200:203],a[128:131],v[56:59],a[200:203]
buffer_load_dwordx4 v6,s[8:11],s21 offen offset:0 lds
v_mfma_f32_16x16x32_bf16 a[204:207],a[132:135],v[56:59],a[204:207]
ds_read_b128 a[136:139],v0 offset:0
v_fma_f32 v100,v100,s36,v16
v_mfma_f32_16x16x32_bf16 v[156:159],a[132:135],v[52:55],v[156:159]
v_exp_f32 v84,v84
v_mfma_f32_16x16x32_bf16 v[152:155],a[128:131],v[52:55],v[152:155]
v_exp_f32 v85,v85
v_mfma_f32_16x16x32_bf16 v[248:251],a[128:131],v[48:51],v[248:251]
v_exp_f32 v86,v86
v_mfma_f32_16x16x32_bf16 v[252:255],a[132:135],v[48:51],v[252:255]
v_exp_f32 v87,v87
v_mfma_f32_16x16x32_bf16 v[204:207],a[132:135],v[44:47],v[204:207]
ds_read_b128 a[132:135],v1 offset:6144
v_cvt_pk_bf16_f32 v26,v84,v85
v_mfma_f32_16x16x32_bf16 v[200:203],a[128:131],v[44:47],v[200:203]
s_waitcnt lgkmcnt(2)
ds_read_b128 a[128:131],v0 offset:6144
v_cvt_pk_bf16_f32 v27,v86,v87
v_mfma_f32_16x16x32_bf16 v[72:75],a[124:127],a[20:23],0
v_exp_f32 v92,v92
v_smfmac_f32_16x16x64_bf16 v[60:63],a[152:155],v[20:27],v18
buffer_load_dwordx4 v7,s[8:11],s21 offen offset:1024 lds
v_mfma_f32_16x16x32_bf16 v[72:75],a[120:123],a[16:19],v[72:75]
v_exp_f32 v93,v93
v_mfma_f32_16x16x32_bf16 v[72:75],a[148:151],a[12:15],v[72:75]
v_exp_f32 v94,v94
v_mfma_f32_16x16x32_bf16 v[72:75],a[144:147],a[8:11],v[72:75]
v_exp_f32 v95,v95
v_mfma_f32_16x16x32_bf16 v[72:75],a[140:143],a[4:7],v[72:75]
s_waitcnt lgkmcnt(1)
v_cvt_pk_bf16_f32 v30,v92,v93
v_cvt_pk_bf16_f32 v31,v94,v95
v_mfma_f32_16x16x32_bf16 v[72:75],a[136:139],a[0:3],v[72:75]
v_fma_f32 v101,v101,s36,v16
v_fma_f32 v102,v102,s36,v16
v_mfma_f32_16x16x32_bf16 v[80:83],a[136:139],a[24:27],0
v_fma_f32 v103,v103,s36,v16
v_mfma_f32_16x16x32_bf16 v[80:83],a[140:143],a[28:31],v[80:83]
v_exp_f32 v100,v100
v_mfma_f32_16x16x32_bf16 v[80:83],a[144:147],a[32:35],v[80:83]
buffer_load_dwordx4 v8,s[8:11],s21 offen offset:2048 lds
v_mfma_f32_16x16x32_bf16 v[80:83],a[148:151],a[36:39],v[80:83]
s_add_u32 s21,s21,12288
v_exp_f32 v101,v101
v_mfma_f32_16x16x32_bf16 v[80:83],a[120:123],a[40:43],v[80:83]
s_add_u32 m0,s22,24576
v_exp_f32 v102,v102
v_mfma_f32_16x16x32_bf16 v[80:83],a[124:127],a[44:47],v[80:83]
v_exp_f32 v103,v103
v_mfma_f32_16x16x32_bf16 v[88:91],a[124:127],a[68:71],0
v_cvt_pk_bf16_f32 v34,v100,v101
v_cvt_pk_bf16_f32 v35,v102,v103
v_mfma_f32_16x16x32_bf16 v[88:91],a[120:123],a[64:67],v[88:91]
v_fma_f32 v72,v72,s36,v13
v_fma_f32 v73,v73,s36,v13
v_smfmac_f32_16x16x64_bf16 v[64:67],a[152:155],v[28:35],v18
v_fma_f32 v74,v74,s36,v13
v_mfma_f32_16x16x32_bf16 v[88:91],a[148:151],a[60:63],v[88:91]
v_fma_f32 v75,v75,s36,v13
v_fma_f32 v80,v80,s36,v14
v_mfma_f32_16x16x32_bf16 v[88:91],a[144:147],a[56:59],v[88:91]
v_fma_f32 v81,v81,s36,v14
v_mfma_f32_16x16x32_bf16 v[88:91],a[140:143],a[52:55],v[88:91]
buffer_load_dwordx4 v6,s[4:7],s20 offen offset:0 lds
v_mfma_f32_16x16x32_bf16 v[88:91],a[136:139],a[48:51],v[88:91]
v_exp_f32 v72,v72
v_mfma_f32_16x16x32_bf16 v[96:99],a[136:139],a[72:75],0
ds_read_b128 a[136:139],v0 offset:6272
v_mfma_f32_16x16x32_bf16 v[96:99],a[140:143],a[76:79],v[96:99]
ds_read_b128 a[140:143],v1 offset:6272
v_mfma_f32_16x16x32_bf16 v[96:99],a[144:147],a[80:83],v[96:99]
ds_read_b128 a[144:147],v0 offset:6400
v_mfma_f32_16x16x32_bf16 v[96:99],a[148:151],a[84:87],v[96:99]
ds_read_b128 a[148:151],v1 offset:6400
v_mfma_f32_16x16x32_bf16 v[96:99],a[120:123],a[88:91],v[96:99]
v_exp_f32 v73,v73
v_mfma_f32_16x16x32_bf16 v[96:99],a[124:127],a[92:95],v[96:99]
s_waitcnt lgkmcnt(4)
v_exp_f32 v74,v74
v_mfma_f32_16x16x32_bf16 v[76:79],a[128:131],a[0:3],0
v_exp_f32 v75,v75
v_mfma_f32_16x16x32_bf16 v[76:79],a[132:135],a[4:7],v[76:79]
buffer_load_dwordx4 v7,s[4:7],s20 offen offset:1024 lds
s_waitcnt lgkmcnt(3)
v_mfma_f32_16x16x32_bf16 v[76:79],a[136:139],a[8:11],v[76:79]
s_waitcnt lgkmcnt(2)
v_exp_f32 v80,v80
v_mfma_f32_16x16x32_bf16 v[76:79],a[140:143],a[12:15],v[76:79]
s_waitcnt lgkmcnt(0)
v_exp_f32 v81,v81
v_mfma_f32_16x16x32_bf16 v[76:79],a[144:147],a[16:19],v[76:79]
v_cvt_pk_bf16_f32 v44,v72,v73
v_cvt_pk_bf16_f32 v45,v74,v75
v_mfma_f32_16x16x32_bf16 v[76:79],a[148:151],a[20:23],v[76:79]
v_cvt_pk_bf16_f32 v48,v80,v81
v_mfma_f32_16x16x32_bf16 v[84:87],a[148:151],a[44:47],0
v_mfma_f32_16x16x32_bf16 v[84:87],a[144:147],a[40:43],v[84:87]
v_mfma_f32_16x16x32_bf16 v[84:87],a[140:143],a[36:39],v[84:87]
v_mfma_f32_16x16x32_bf16 v[84:87],a[136:139],a[32:35],v[84:87]
v_mfma_f32_16x16x32_bf16 v[84:87],a[132:135],a[28:31],v[84:87]
buffer_load_dwordx4 v8,s[4:7],s20 offen offset:2048 lds
v_mfma_f32_16x16x32_bf16 v[84:87],a[128:131],a[24:27],v[84:87]
s_add_u32 s20,s20,12288
v_mfma_f32_16x16x32_bf16 v[92:95],a[128:131],a[48:51],0
ds_read_b64_tr_b16 a[120:121],v2 offset:24576
v_mfma_f32_16x16x32_bf16 v[92:95],a[132:135],a[52:55],v[92:95]
ds_read_b64_tr_b16 a[122:123],v2 offset:30720
v_mfma_f32_16x16x32_bf16 v[92:95],a[136:139],a[56:59],v[92:95]
ds_read_b64_tr_b16 a[124:125],v3 offset:24576
v_mfma_f32_16x16x32_bf16 v[92:95],a[140:143],a[60:63],v[92:95]
ds_read_b64_tr_b16 a[126:127],v3 offset:30720
v_mfma_f32_16x16x32_bf16 v[92:95],a[144:147],a[64:67],v[92:95]
v_mfma_f32_16x16x32_bf16 v[92:95],a[148:151],a[68:71],v[92:95]
v_mfma_f32_16x16x32_bf16 v[100:103],a[148:151],a[92:95],0
v_mfma_f32_16x16x32_bf16 v[100:103],a[144:147],a[88:91],v[100:103]
v_mfma_f32_16x16x32_bf16 v[100:103],a[140:143],a[84:87],v[100:103]
v_mfma_f32_16x16x32_bf16 v[100:103],a[136:139],a[80:83],v[100:103]
v_mfma_f32_16x16x32_bf16 v[100:103],a[132:135],a[76:79],v[100:103]
ds_read_b64_tr_b16 a[132:133],v5 offset:24576
v_mfma_f32_16x16x32_bf16 v[100:103],a[128:131],a[72:75],v[100:103]
ds_read_b64_tr_b16 a[128:129],v4 offset:24576
ds_read_b64_tr_b16 a[130:131],v4 offset:30720
ds_read_b64_tr_b16 a[134:135],v5 offset:30720
s_mov_b32 s38,0
s_branch L_loop4
L_tr55:
s_waitcnt vmcnt(43)
s_waitcnt lgkmcnt(3)
v_mfma_f32_16x16x32_bf16 v[160:163],a[120:123],v[20:23],v[160:163]
s_add_u32 m0,s24,0
ds_read_b128 a[12:15],v12 offset:128
v_fma_f32 v101,v101,s36,v16
v_mfma_f32_16x16x32_bf16 v[164:167],a[124:127],v[20:23],v[164:167]
ds_read_b128 a[20:23],v12 offset:256
v_fma_f32 v103,v103,s36,v16
v_mfma_f32_16x16x32_bf16 v[212:215],a[124:127],v[24:27],v[212:215]
ds_read_b128 a[4:7],v12 offset:0
v_fma_f32 v87,v87,s36,v14
v_mfma_f32_16x16x32_bf16 v[208:211],a[120:123],v[24:27],v[208:211]
ds_read_b128 a[16:19],v11 offset:256
v_fma_f32 v106,v106,s36,v17
v_mfma_f32_16x16x32_bf16 v[112:115],a[120:123],v[28:31],v[112:115]
ds_read_b128 a[0:3],v11 offset:0
v_fma_f32 v99,v99,s36,v16
v_mfma_f32_16x16x32_bf16 v[116:119],a[124:127],v[28:31],v[116:119]
ds_read_b128 a[8:11],v11 offset:128
v_fma_f32 v96,v96,s36,v16
v_mfma_f32_16x16x32_bf16 a[164:167],a[124:127],v[32:35],a[164:167]
ds_read_b64_tr_b16 a[136:137],v2 offset:24704
v_fma_f32 v77,v77,s36,v13
v_mfma_f32_16x16x32_bf16 a[160:163],a[120:123],v[32:35],a[160:163]
ds_read_b64_tr_b16 a[138:139],v2 offset:30848
v_fma_f32 v85,v85,s36,v14
v_mfma_f32_16x16x32_bf16 a[208:211],a[120:123],v[36:39],a[208:211]
ds_read_b64_tr_b16 a[140:141],v3 offset:24704
ds_read_b64_tr_b16 a[142:143],v3 offset:30848
ds_read_b64_tr_b16 a[144:145],v4 offset:24704
ds_read_b64_tr_b16 a[146:147],v4 offset:30848
ds_read_b64_tr_b16 a[150:151],v5 offset:30848
ds_read_b64_tr_b16 a[148:149],v5 offset:24704
ds_read_b128 a[40:43],v11 offset:6400
v_mfma_f32_16x16x32_bf16 a[212:215],a[124:127],v[36:39],a[212:215]
s_waitcnt lgkmcnt(11)
v_fma_f32 v84,v84,s36,v14
ds_read_b128 a[32:35],v11 offset:6272
v_mfma_f32_16x16x32_bf16 a[216:219],a[128:131],v[36:39],a[216:219]
s_waitcnt lgkmcnt(10)
buffer_load_dwordx4 v6,s[12:15],s28 offen offset:0 nt lds
v_mfma_f32_16x16x32_bf16 a[220:223],a[132:135],v[36:39],a[220:223]
ds_read_b64_tr_b16 a[122:123],v2 offset:30976
ds_read_b128 a[44:47],v12 offset:6400
v_mfma_f32_16x16x32_bf16 a[172:175],a[132:135],v[32:35],a[172:175]
v_exp_f32 v101,v101
ds_read_b64_tr_b16 a[120:121],v2 offset:24832
ds_read_b128 a[24:27],v11 offset:6144
v_mfma_f32_16x16x32_bf16 a[168:171],a[128:131],v[32:35],a[168:171]
v_exp_f32 v77,v77
ds_read_b128 a[28:31],v12 offset:6144
v_mfma_f32_16x16x32_bf16 v[120:123],a[128:131],v[28:31],v[120:123]
v_fma_f32 v111,v111,s36,v17
ds_read_b64_tr_b16 a[126:127],v3 offset:30976
ds_read_b64_tr_b16 a[124:125],v3 offset:24832
ds_read_b128 a[36:39],v12 offset:6272
v_mfma_f32_16x16x32_bf16 v[124:127],a[132:135],v[28:31],v[124:127]
buffer_load_dwordx4 v7,s[12:15],s28 offen offset:1024 nt lds
v_mfma_f32_16x16x32_bf16 v[220:223],a[132:135],v[24:27],v[220:223]
v_fma_f32 v95,v95,s36,v15
v_fma_f32 v100,v100,s36,v16
v_mfma_f32_16x16x32_bf16 v[216:219],a[128:131],v[24:27],v[216:219]
v_exp_f32 v106,v106
v_mfma_f32_16x16x32_bf16 v[168:171],a[128:131],v[20:23],v[168:171]
ds_read_b64_tr_b16 a[130:131],v4 offset:30976
v_fma_f32 v93,v93,s36,v15
v_mfma_f32_16x16x32_bf16 v[172:175],a[132:135],v[20:23],v[172:175]
s_waitcnt lgkmcnt(4)
ds_read_b64_tr_b16 a[128:129],v4 offset:24832
v_exp_f32 v111,v111
v_mfma_f32_16x16x32_bf16 v[176:179],a[136:139],v[20:23],v[176:179]
ds_read_b64_tr_b16 a[132:133],v5 offset:24832
buffer_load_dwordx4 v8,s[12:15],s28 offen offset:2048 nt lds
v_mfma_f32_16x16x32_bf16 v[180:183],a[140:143],v[20:23],v[180:183]
s_add_u32 s28,s28,3072
ds_read_b64_tr_b16 a[134:135],v5 offset:30976
v_fma_f32 v107,v107,s36,v17
v_mfma_f32_16x16x32_bf16 v[228:231],a[140:143],v[24:27],v[228:231]
s_add_u32 m0,s24,3072
v_fma_f32 v92,v92,s36,v15
v_exp_f32 v92,v92
v_mfma_f32_16x16x32_bf16 v[224:227],a[136:139],v[24:27],v[224:227]
v_fma_f32 v109,v109,s36,v17
v_exp_f32 v109,v109
v_mfma_f32_16x16x32_bf16 v[128:131],a[136:139],v[28:31],v[128:131]
v_fma_f32 v97,v97,s36,v16
v_exp_f32 v84,v84
v_mfma_f32_16x16x32_bf16 v[132:135],a[140:143],v[28:31],v[132:135]
v_fma_f32 v94,v94,s36,v15
v_exp_f32 v94,v94
v_mfma_f32_16x16x32_bf16 a[180:183],a[140:143],v[32:35],a[180:183]
v_fma_f32 v104,v104,s36,v17
v_fma_f32 v90,v90,s36,v15
v_mfma_f32_16x16x32_bf16 a[176:179],a[136:139],v[32:35],a[176:179]
buffer_load_dwordx4 v6,s[12:15],s28 offen offset:0 nt lds
v_mfma_f32_16x16x32_bf16 a[224:227],a[136:139],v[36:39],a[224:227]
v_exp_f32 v93,v93
v_mfma_f32_16x16x32_bf16 a[228:231],a[140:143],v[36:39],a[228:231]
v_exp_f32 v104,v104
v_mfma_f32_16x16x32_bf16 a[232:235],a[144:147],v[36:39],a[232:235]
v_exp_f32 v96,v96
v_mfma_f32_16x16x32_bf16 a[236:239],a[148:151],v[36:39],a[236:239]
v_fma_f32 v78,v78,s36,v13
v_exp_f32 v78,v78
v_mfma_f32_16x16x32_bf16 a[188:191],a[148:151],v[32:35],a[188:191]
v_fma_f32 v110,v110,s36,v17
v_exp_f32 v110,v110
v_mfma_f32_16x16x32_bf16 a[184:187],a[144:147],v[32:35],a[184:187]
v_exp_f32 v97,v97
v_mfma_f32_16x16x32_bf16 v[136:139],a[144:147],v[28:31],v[136:139]
v_exp_f32 v100,v100
v_mfma_f32_16x16x32_bf16 v[140:143],a[148:151],v[28:31],v[140:143]
buffer_load_dwordx4 v7,s[12:15],s28 offen offset:1024 nt lds
v_mfma_f32_16x16x32_bf16 v[236:239],a[148:151],v[24:27],v[236:239]
v_fma_f32 v102,v102,s36,v16
v_exp_f32 v102,v102
v_mfma_f32_16x16x32_bf16 v[232:235],a[144:147],v[24:27],v[232:235]
v_fma_f32 v79,v79,s36,v13
v_exp_f32 v79,v79
v_mfma_f32_16x16x32_bf16 v[184:187],a[144:147],v[20:23],v[184:187]
v_exp_f32 v85,v85
v_mfma_f32_16x16x32_bf16 v[188:191],a[148:151],v[20:23],v[188:191]
v_fma_f32 v108,v108,s36,v17
v_exp_f32 v108,v108
v_mfma_f32_16x16x32_bf16 v[192:195],a[120:123],v[20:23],v[192:195]
s_waitcnt lgkmcnt(0)
v_fma_f32 v98,v98,s36,v16
v_exp_f32 v87,v87
v_mfma_f32_16x16x32_bf16 v[196:199],a[124:127],v[20:23],v[196:199]
v_fma_f32 v76,v76,s36,v13
v_exp_f32 v76,v76
v_mfma_f32_16x16x32_bf16 v[244:247],a[124:127],v[24:27],v[244:247]
buffer_load_dwordx4 v8,s[12:15],s28 offen offset:2048 nt lds
s_waitcnt vmcnt(20)
s_barrier
v_mfma_f32_16x16x32_bf16 v[240:243],a[120:123],v[24:27],v[240:243]
s_add_u32 s28,s28,3072
v_fma_f32 v105,v105,s36,v17
v_exp_f32 v107,v107
v_mfma_f32_16x16x32_bf16 v[144:147],a[120:123],v[28:31],v[144:147]
s_add_u32 m0,s22,0
v_fma_f32 v91,v91,s36,v15
v_exp_f32 v91,v91
v_mfma_f32_16x16x32_bf16 v[148:151],a[124:127],v[28:31],v[148:151]
buffer_load_dwordx4 v6,s[4:7],s25 offen offset:0 lds
v_mfma_f32_16x16x32_bf16 a[196:199],a[124:127],v[32:35],a[196:199]
buffer_load_dwordx4 v7,s[4:7],s25 offen offset:1024 lds
v_mfma_f32_16x16x32_bf16 a[192:195],a[120:123],v[32:35],a[192:195]
buffer_load_dwordx4 v8,s[4:7],s25 offen offset:2048 lds
v_mfma_f32_16x16x32_bf16 a[240:243],a[120:123],v[36:39],a[240:243]
v_fma_f32 v86,v86,s36,v14
v_exp_f32 v86,v86
v_mfma_f32_16x16x32_bf16 a[244:247],a[124:127],v[36:39],a[244:247]
v_exp_f32 v95,v95
v_mfma_f32_16x16x32_bf16 a[248:251],a[128:131],v[36:39],a[248:251]
v_exp_f32 v103,v103
v_mfma_f32_16x16x32_bf16 a[252:255],a[132:135],v[36:39],a[252:255]
ds_read_b64_tr_b16 a[136:137],v2 offset:0
v_cvt_pk_bf16_f32 v41,v106,v107
v_mfma_f32_16x16x32_bf16 a[204:207],a[132:135],v[32:35],a[204:207]
ds_read_b64_tr_b16 a[138:139],v2 offset:6144
v_exp_f32 v99,v99
v_mfma_f32_16x16x32_bf16 a[200:203],a[128:131],v[32:35],a[200:203]
ds_read_b64_tr_b16 a[140:141],v3 offset:0
v_cvt_pk_bf16_f32 v42,v108,v109
v_mfma_f32_16x16x32_bf16 v[152:155],a[128:131],v[28:31],v[152:155]
ds_read_b64_tr_b16 a[142:143],v3 offset:6144
v_cvt_pk_bf16_f32 v50,v84,v85
v_mfma_f32_16x16x32_bf16 v[156:159],a[132:135],v[28:31],v[156:159]
ds_read_b64_tr_b16 a[144:145],v4 offset:0
v_exp_f32 v90,v90
v_mfma_f32_16x16x32_bf16 v[252:255],a[132:135],v[24:27],v[252:255]
ds_read_b64_tr_b16 a[146:147],v4 offset:6144
v_exp_f32 v105,v105
v_mfma_f32_16x16x32_bf16 v[248:251],a[128:131],v[24:27],v[248:251]
ds_read_b64_tr_b16 a[148:149],v5 offset:0
v_cvt_pk_bf16_f32 v55,v94,v95
v_mfma_f32_16x16x32_bf16 v[200:203],a[128:131],v[20:23],v[200:203]
ds_read_b64_tr_b16 a[150:151],v5 offset:6144
v_cvt_pk_bf16_f32 v51,v86,v87
v_mfma_f32_16x16x32_bf16 v[204:207],a[132:135],v[20:23],v[204:207]
v_cvt_pk_bf16_f32 v59,v102,v103
v_exp_f32 v98,v98
v_cvt_pk_bf16_f32 v54,v92,v93
v_cvt_pk_bf16_f32 v56,v96,v97
v_cvt_pk_bf16_f32 v53,v90,v91
v_cvt_pk_bf16_f32 v47,v78,v79
v_cvt_pk_bf16_f32 v43,v110,v111
v_cvt_pk_bf16_f32 v58,v100,v101
v_cvt_pk_bf16_f32 v46,v76,v77
v_cvt_pk_bf16_f32 v57,v98,v99
v_cvt_pk_bf16_f32 v40,v104,v105
v_smfmac_f32_16x16x64_bf16 v[60:63],a[152:155],v[44:51],v18
v_subrev_u32 v10,18432,v10
v_smfmac_f32_16x16x64_bf16 v[64:67],a[152:155],v[52:59],v18
v_smfmac_f32_16x16x64_bf16 v[68:71],a[152:155],v[36:43],v18
s_waitcnt lgkmcnt(1)
v_mfma_f32_16x16x32_bf16 v[160:163],a[136:139],v[44:47],v[160:163]
s_add_u32 s87,s42,18432
ds_read_b64_tr_b16 a[120:121],v2 offset:128
v_mbcnt_lo_u32_b32 v39,-1,0
v_mfma_f32_16x16x32_bf16 v[164:167],a[140:143],v[44:47],v[164:167]
s_add_u32 s66,s42,24576
ds_read_b64_tr_b16 a[122:123],v2 offset:6272
v_mbcnt_hi_u32_b32 v39,-1,v39
v_mfma_f32_16x16x32_bf16 v[212:215],a[140:143],v[48:51],v[212:215]
ds_read_b64_tr_b16 a[124:125],v3 offset:128
v_and_b32 v38,7,v39
v_mfma_f32_16x16x32_bf16 v[208:211],a[136:139],v[48:51],v[208:211]
ds_read_b64_tr_b16 a[126:127],v3 offset:6272
v_lshrrev_b32 v19,5,v39
v_mfma_f32_16x16x32_bf16 v[112:115],a[136:139],v[52:55],v[112:115]
ds_read_b64_tr_b16 a[128:129],v4 offset:128
v_xor_b32 v38,v38,v19
v_mfma_f32_16x16x32_bf16 v[116:119],a[140:143],v[52:55],v[116:119]
ds_read_b64_tr_b16 a[130:131],v4 offset:6272
ds_read_b64_tr_b16 a[132:133],v5 offset:128
ds_read_b64_tr_b16 a[134:135],v5 offset:6272
v_mfma_f32_16x16x32_bf16 a[164:167],a[140:143],v[56:59],a[164:167]
v_and_b32 v19,15,v39
v_lshl_add_u32 v19,v19,7,s24
v_mfma_f32_16x16x32_bf16 a[160:163],a[136:139],v[56:59],a[160:163]
v_lshl_add_u32 v19,v38,4,v19
v_bfe_u32 v38,v39,4,1
v_mfma_f32_16x16x32_bf16 a[208:211],a[136:139],v[40:43],a[208:211]
ds_read_b64_tr_b16 a[136:137],v2 offset:256
v_lshl_add_u32 v36,v38,3,v19
v_mfma_f32_16x16x32_bf16 a[212:215],a[140:143],v[40:43],a[212:215]
ds_read_b64_tr_b16 a[138:139],v2 offset:6400
v_xor_b32 v37,32,v36
v_mfma_f32_16x16x32_bf16 a[216:219],a[144:147],v[40:43],a[216:219]
s_waitcnt lgkmcnt(6)
ds_read_b64_tr_b16 a[140:141],v3 offset:256
v_xor_b32 v38,64,v36
v_mfma_f32_16x16x32_bf16 a[220:223],a[148:151],v[40:43],a[220:223]
ds_read_b64_tr_b16 a[142:143],v3 offset:6400
v_bfe_u32 v19,v39,3,1
v_xor_b32 v39,96,v36
v_lshlrev_b32 v19,11,v19
v_add_f32 v68,v68,v69
v_add_f32 v68,v68,v70
v_add_f32 v66,v66,v67
v_add_f32 v68,v68,v71
v_rcp_f32 v66,v66
v_rcp_f32 v68,v68
v_accvgpr_read_b32 v72,a160
v_accvgpr_read_b32 v73,a161
v_pk_mul_f32 v[72:73],v[72:73],v[66:67] op_sel_hi:[1,0]
v_accvgpr_read_b32 v74,a162
v_accvgpr_read_b32 v75,a163
v_pk_mul_f32 v[74:75],v[74:75],v[66:67] op_sel_hi:[1,0]
v_accvgpr_read_b32 v76,a208
v_accvgpr_read_b32 v77,a209
v_pk_mul_f32 v[76:77],v[76:77],v[68:69] op_sel_hi:[1,0]
v_accvgpr_read_b32 v78,a210
v_accvgpr_read_b32 v79,a211
v_pk_mul_f32 v[78:79],v[78:79],v[68:69] op_sel_hi:[1,0]
v_accvgpr_read_b32 v80,a164
v_accvgpr_read_b32 v81,a165
v_mfma_f32_16x16x32_bf16 a[172:175],a[148:151],v[56:59],a[172:175]
v_accvgpr_read_b32 v82,a166
v_accvgpr_read_b32 v83,a167
v_accvgpr_read_b32 v84,a212
v_accvgpr_read_b32 v85,a213
v_accvgpr_read_b32 v86,a214
v_pk_mul_f32 v[80:81],v[80:81],v[66:67] op_sel_hi:[1,0]
v_pk_mul_f32 v[82:83],v[82:83],v[66:67] op_sel_hi:[1,0]
v_pk_mul_f32 v[84:85],v[84:85],v[68:69] op_sel_hi:[1,0]
v_accvgpr_read_b32 v87,a215
v_pk_mul_f32 v[86:87],v[86:87],v[68:69] op_sel_hi:[1,0]
v_accvgpr_read_b32 v92,a216
v_accvgpr_read_b32 v93,a217
v_mfma_f32_16x16x32_bf16 a[168:171],a[144:147],v[56:59],a[168:171]
v_accvgpr_read_b32 v94,a218
v_accvgpr_read_b32 v95,a219
v_mfma_f32_16x16x32_bf16 v[120:123],a[144:147],v[52:55],v[120:123]
v_accvgpr_read_b32 v100,a220
v_accvgpr_read_b32 v101,a221
v_mfma_f32_16x16x32_bf16 v[124:127],a[148:151],v[52:55],v[124:127]
v_accvgpr_read_b32 v102,a222
v_accvgpr_read_b32 v103,a223
v_mfma_f32_16x16x32_bf16 v[220:223],a[148:151],v[48:51],v[220:223]
v_accvgpr_read_b32 v88,a168
v_accvgpr_read_b32 v89,a169
v_accvgpr_read_b32 v90,a170
v_accvgpr_read_b32 v91,a171
v_accvgpr_read_b32 v96,a172
v_pk_mul_f32 v[92:93],v[92:93],v[68:69] op_sel_hi:[1,0]
v_pk_mul_f32 v[94:95],v[94:95],v[68:69] op_sel_hi:[1,0]
v_pk_mul_f32 v[88:89],v[88:89],v[66:67] op_sel_hi:[1,0]
v_pk_mul_f32 v[90:91],v[90:91],v[66:67] op_sel_hi:[1,0]
v_accvgpr_read_b32 v97,a173
v_accvgpr_read_b32 v98,a174
v_mfma_f32_16x16x32_bf16 v[216:219],a[144:147],v[48:51],v[216:219]
v_accvgpr_read_b32 v99,a175
v_cvt_pk_bf16_f32 v72,v72,v73
v_mfma_f32_16x16x32_bf16 v[168:171],a[144:147],v[44:47],v[168:171]
ds_read_b64_tr_b16 a[144:145],v4 offset:256
ds_read_b64_tr_b16 a[146:147],v4 offset:6400
v_cvt_pk_bf16_f32 v76,v76,v77
v_cvt_pk_bf16_f32 v80,v80,v81
v_pk_mul_f32 v[96:97],v[96:97],v[66:67] op_sel_hi:[1,0]
v_pk_mul_f32 v[98:99],v[98:99],v[66:67] op_sel_hi:[1,0]
v_pk_mul_f32 v[100:101],v[100:101],v[68:69] op_sel_hi:[1,0]
v_pk_mul_f32 v[102:103],v[102:103],v[68:69] op_sel_hi:[1,0]
v_cvt_pk_bf16_f32 v84,v84,v85
v_cvt_pk_bf16_f32 v73,v74,v75
v_mfma_f32_16x16x32_bf16 v[172:175],a[148:151],v[44:47],v[172:175]
ds_read_b64_tr_b16 a[148:149],v5 offset:256
v_cvt_pk_bf16_f32 v77,v78,v79
v_mfma_f32_16x16x32_bf16 v[176:179],a[120:123],v[44:47],v[176:179]
ds_read_b64_tr_b16 a[150:151],v5 offset:6400
v_cvt_pk_bf16_f32 v81,v82,v83
v_mfma_f32_16x16x32_bf16 v[180:183],a[124:127],v[44:47],v[180:183]
ds_write2st64_b64 v36,v[72:73],v[76:77] offset0:36 offset1:40
v_mfma_f32_16x16x32_bf16 v[228:231],a[124:127],v[48:51],v[228:231]
v_cvt_pk_bf16_f32 v85,v86,v87
v_cvt_pk_bf16_f32 v92,v92,v93
v_mfma_f32_16x16x32_bf16 v[224:227],a[120:123],v[48:51],v[224:227]
v_cvt_pk_bf16_f32 v88,v88,v89
v_cvt_pk_bf16_f32 v93,v94,v95
v_mfma_f32_16x16x32_bf16 v[128:131],a[120:123],v[52:55],v[128:131]
v_cvt_pk_bf16_f32 v89,v90,v91
v_cvt_pk_bf16_f32 v96,v96,v97
v_mfma_f32_16x16x32_bf16 v[132:135],a[124:127],v[52:55],v[132:135]
ds_write2st64_b64 v37,v[80:81],v[84:85] offset0:36 offset1:40
v_mfma_f32_16x16x32_bf16 a[180:183],a[124:127],v[56:59],a[180:183]
v_cvt_pk_bf16_f32 v100,v100,v101
v_cvt_pk_bf16_f32 v97,v98,v99
v_mfma_f32_16x16x32_bf16 a[176:179],a[120:123],v[56:59],a[176:179]
v_cvt_pk_bf16_f32 v101,v102,v103
v_add_f32 v60,v60,v61
v_mfma_f32_16x16x32_bf16 a[224:227],a[120:123],v[40:43],a[224:227]
v_add_f32 v62,v62,v63
v_add_f32 v64,v64,v65
v_mfma_f32_16x16x32_bf16 a[228:231],a[124:127],v[40:43],a[228:231]
s_waitcnt lgkmcnt(1)
ds_write2st64_b64 v38,v[88:89],v[92:93] offset0:36 offset1:40
v_mfma_f32_16x16x32_bf16 a[232:235],a[128:131],v[40:43],a[232:235]
v_accvgpr_read_b32 v80,a176
v_accvgpr_read_b32 v81,a177
v_mfma_f32_16x16x32_bf16 a[236:239],a[132:135],v[40:43],a[236:239]
v_accvgpr_read_b32 v82,a178
v_accvgpr_read_b32 v83,a179
v_accvgpr_read_b32 v84,a224
v_accvgpr_read_b32 v85,a225
v_accvgpr_read_b32 v86,a226
ds_write2st64_b64 v39,v[96:97],v[100:101] offset0:36 offset1:40
v_pk_mul_f32 v[80:81],v[80:81],v[66:67] op_sel_hi:[1,0]
v_pk_mul_f32 v[82:83],v[82:83],v[66:67] op_sel_hi:[1,0]
v_pk_mul_f32 v[84:85],v[84:85],v[68:69] op_sel_hi:[1,0]
ds_read_b128 v[104:107],v10 offset:18432
v_accvgpr_read_b32 v87,a227
ds_read_b128 v[108:111],v10 offset:19456
v_pk_mul_f32 v[86:87],v[86:87],v[68:69] op_sel_hi:[1,0]
v_accvgpr_read_b32 v90,a182
v_accvgpr_read_b32 v91,a183
v_mfma_f32_16x16x32_bf16 a[188:191],a[132:135],v[56:59],a[188:191]
ds_read_b128 v[72:75],v10 offset:20480
v_accvgpr_read_b32 v94,a230
ds_read_b128 v[76:79],v10 offset:21504
v_pk_mul_f32 v[90:91],v[90:91],v[66:67] op_sel_hi:[1,0]
v_accvgpr_read_b32 v95,a231
v_pk_mul_f32 v[94:95],v[94:95],v[68:69] op_sel_hi:[1,0]
v_accvgpr_read_b32 v88,a180
v_accvgpr_read_b32 v89,a181
v_pk_mul_f32 v[88:89],v[88:89],v[66:67] op_sel_hi:[1,0]
v_accvgpr_read_b32 v92,a228
v_accvgpr_read_b32 v93,a229
v_pk_mul_f32 v[92:93],v[92:93],v[68:69] op_sel_hi:[1,0]
v_cvt_pk_bf16_f32 v80,v80,v81
v_cvt_pk_bf16_f32 v84,v84,v85
v_mfma_f32_16x16x32_bf16 a[184:187],a[128:131],v[56:59],a[184:187]
v_cvt_pk_bf16_f32 v81,v82,v83
v_cvt_pk_bf16_f32 v85,v86,v87
v_mfma_f32_16x16x32_bf16 v[136:139],a[128:131],v[52:55],v[136:139]
ds_write2st64_b64 v36,v[80:81],v[84:85] offset0:36 offset1:40
v_mfma_f32_16x16x32_bf16 v[140:143],a[132:135],v[52:55],v[140:143]
v_accvgpr_read_b32 v102,a234
v_accvgpr_read_b32 v103,a235
v_mfma_f32_16x16x32_bf16 v[236:239],a[132:135],v[48:51],v[236:239]
s_waitcnt lgkmcnt(2)
buffer_store_dwordx4 v[104:107],v9,s[16:19],s87 offen offset:0 nt
v_accvgpr_read_b32 v100,a232
v_accvgpr_read_b32 v101,a233
v_accvgpr_read_b32 v96,a184
v_pk_mul_f32 v[102:103],v[102:103],v[68:69] op_sel_hi:[1,0]
v_pk_mul_f32 v[100:101],v[100:101],v[68:69] op_sel_hi:[1,0]
v_accvgpr_read_b32 v97,a185
v_pk_mul_f32 v[96:97],v[96:97],v[66:67] op_sel_hi:[1,0]
v_accvgpr_read_b32 v98,a186
v_accvgpr_read_b32 v99,a187
v_pk_mul_f32 v[98:99],v[98:99],v[66:67] op_sel_hi:[1,0]
v_accvgpr_read_b32 v82,a190
buffer_store_dwordx4 v[108:111],v9,s[16:19],s87 offen offset:3072 nt
v_accvgpr_read_b32 v83,a191
v_pk_mul_f32 v[82:83],v[82:83],v[66:67] op_sel_hi:[1,0]
v_accvgpr_read_b32 v86,a238
v_accvgpr_read_b32 v87,a239
v_pk_mul_f32 v[86:87],v[86:87],v[68:69] op_sel_hi:[1,0]
v_accvgpr_read_b32 v80,a188
v_accvgpr_read_b32 v81,a189
v_pk_mul_f32 v[80:81],v[80:81],v[66:67] op_sel_hi:[1,0]
v_accvgpr_read_b32 v84,a236
v_accvgpr_read_b32 v85,a237
v_pk_mul_f32 v[84:85],v[84:85],v[68:69] op_sel_hi:[1,0]
v_rcp_f32 v60,v60
v_rcp_f32 v62,v62
v_mfma_f32_16x16x32_bf16 v[232:235],a[128:131],v[48:51],v[232:235]
buffer_store_dwordx4 v[72:75],v9,s[16:19],s66 offen offset:0 nt
v_rcp_f32 v64,v64
v_cvt_pk_bf16_f32 v88,v88,v89
v_mfma_f32_16x16x32_bf16 v[184:187],a[128:131],v[44:47],v[184:187]
v_min3_f32 v61,v60,v62,v64
v_min3_f32 v61,v61,v66,v68
v_mfma_f32_16x16x32_bf16 v[188:191],a[132:135],v[44:47],v[188:191]
v_cmp_nlt_f32 vcc,s37,v61
v_cvt_pk_bf16_f32 v92,v92,v93
v_mfma_f32_16x16x32_bf16 v[192:195],a[136:139],v[44:47],v[192:195]
s_waitcnt lgkmcnt(0)
buffer_store_dwordx4 v[76:79],v9,s[16:19],s66 offen offset:3072 nt
v_cvt_pk_bf16_f32 v100,v100,v101
v_cvt_pk_bf16_f32 v96,v96,v97
v_cvt_pk_bf16_f32 v89,v90,v91
v_mfma_f32_16x16x32_bf16 v[196:199],a[140:143],v[44:47],v[196:199]
s_cmp_lg_u64 vcc,0
v_cvt_pk_bf16_f32 v93,v94,v95
v_cvt_pk_bf16_f32 v80,v80,v81
v_mfma_f32_16x16x32_bf16 v[244:247],a[140:143],v[48:51],v[244:247]
s_cselect_b32 s62,s32,0
v_cvt_pk_bf16_f32 v84,v84,v85
v_cvt_pk_bf16_f32 v101,v102,v103
v_mfma_f32_16x16x32_bf16 v[240:243],a[136:139],v[48:51],v[240:243]
s_or_b32 s31,s31,s62
ds_write2st64_b64 v37,v[88:89],v[92:93] offset0:36 offset1:40
v_mfma_f32_16x16x32_bf16 v[144:147],a[136:139],v[52:55],v[144:147]
s_lshl_b32 s32,s32,1
v_cvt_pk_bf16_f32 v97,v98,v99
v_cvt_pk_bf16_f32 v81,v82,v83
v_mfma_f32_16x16x32_bf16 v[148:151],a[140:143],v[52:55],v[148:151]
s_add_u32 m0,s24,6144
v_cvt_pk_bf16_f32 v85,v86,v87
v_mov_b32 v67,0
v_mfma_f32_16x16x32_bf16 a[196:199],a[140:143],v[56:59],a[196:199]
buffer_load_dwordx4 v6,s[12:15],s28 offen offset:0 nt lds
v_mfma_f32_16x16x32_bf16 a[192:195],a[136:139],v[56:59],a[192:195]
buffer_load_dwordx4 v7,s[12:15],s28 offen offset:1024 nt lds
v_mfma_f32_16x16x32_bf16 a[240:243],a[136:139],v[40:43],a[240:243]
buffer_load_dwordx4 v8,s[12:15],s28 offen offset:2048 nt lds
v_mfma_f32_16x16x32_bf16 a[244:247],a[140:143],v[40:43],a[244:247]
s_add_u32 s28,s28,3072
ds_write2st64_b64 v38,v[96:97],v[100:101] offset0:36 offset1:40
v_mfma_f32_16x16x32_bf16 a[248:251],a[144:147],v[40:43],a[248:251]
s_add_u32 m0,s24,9216
v_accvgpr_read_b32 v104,a192
v_accvgpr_read_b32 v105,a193
v_mfma_f32_16x16x32_bf16 a[252:255],a[148:151],v[40:43],a[252:255]
buffer_load_dwordx4 v6,s[12:15],s28 offen offset:0 nt lds
buffer_load_dwordx4 v7,s[12:15],s28 offen offset:1024 nt lds
ds_write2st64_b64 v39,v[80:81],v[84:85] offset0:36 offset1:40
v_pk_mul_f32 v[104:105],v[104:105],v[66:67] op_sel_hi:[1,0]
v_accvgpr_read_b32 v106,a194
v_accvgpr_read_b32 v107,a195
buffer_load_dwordx4 v8,s[12:15],s28 offen offset:2048 nt lds
ds_read_b128 v[72:75],v10 offset:18432
v_pk_mul_f32 v[106:107],v[106:107],v[66:67] op_sel_hi:[1,0]
ds_read_b128 v[76:79],v10 offset:19456
v_accvgpr_read_b32 v108,a240
ds_read_b128 v[88:91],v10 offset:20480
v_accvgpr_read_b32 v109,a241
ds_read_b128 v[92:95],v10 offset:21504
v_pk_mul_f32 v[108:109],v[108:109],v[68:69] op_sel_hi:[1,0]
v_accvgpr_read_b32 v110,a242
v_accvgpr_read_b32 v111,a243
v_pk_mul_f32 v[110:111],v[110:111],v[68:69] op_sel_hi:[1,0]
v_accvgpr_read_b32 v98,a198
v_accvgpr_read_b32 v99,a199
v_mfma_f32_16x16x32_bf16 a[204:207],a[148:151],v[56:59],a[204:207]
s_waitcnt vmcnt(25)
s_waitcnt vmcnt(10)
s_barrier
ds_read_b128 a[48:51],v11 offset:12288
v_pk_mul_f32 v[98:99],v[98:99],v[66:67] op_sel_hi:[1,0]
ds_read_b128 a[52:55],v12 offset:12288
s_waitcnt lgkmcnt(5)
buffer_store_dwordx4 v[72:75],v9,s[16:19],s87 offen offset:128 nt
ds_read_b128 a[56:59],v11 offset:12416
v_accvgpr_read_b32 v102,a246
ds_read_b128 a[60:63],v12 offset:12416
v_accvgpr_read_b32 v103,a247
ds_read_b128 a[64:67],v11 offset:12544
v_pk_mul_f32 v[102:103],v[102:103],v[68:69] op_sel_hi:[1,0]
ds_read_b128 a[68:71],v12 offset:12544
s_waitcnt lgkmcnt(6)
buffer_store_dwordx4 v[76:79],v9,s[16:19],s87 offen offset:3200 nt
ds_read_b128 a[120:123],v0 offset:0
v_accvgpr_read_b32 v96,a196
ds_read_b128 a[124:127],v1 offset:0
v_accvgpr_read_b32 v97,a197
ds_read_b128 a[128:131],v0 offset:128
v_pk_mul_f32 v[96:97],v[96:97],v[66:67] op_sel_hi:[1,0]
ds_read_b128 a[132:135],v1 offset:128
buffer_store_dwordx4 v[88:91],v9,s[16:19],s66 offen offset:128 nt
ds_read_b128 a[136:139],v0 offset:256
v_accvgpr_read_b32 v100,a244
ds_read_b128 a[140:143],v1 offset:256
v_accvgpr_read_b32 v101,a245
v_pk_mul_f32 v[100:101],v[100:101],v[68:69] op_sel_hi:[1,0]
v_cvt_pk_bf16_f32 v104,v104,v105
v_cvt_pk_bf16_f32 v108,v108,v109
v_mfma_f32_16x16x32_bf16 a[200:203],a[144:147],v[56:59],a[200:203]
s_add_u32 s28,s28,3072
v_cvt_pk_bf16_f32 v105,v106,v107
v_cvt_pk_bf16_f32 v109,v110,v111
v_mfma_f32_16x16x32_bf16 v[152:155],a[144:147],v[52:55],v[152:155]
s_add_u32 m0,s23,0
ds_write2st64_b64 v36,v[104:105],v[108:109] offset0:36 offset1:40
v_mfma_f32_16x16x32_bf16 v[156:159],a[148:151],v[52:55],v[156:159]
v_add_u32 v36,v36,v19
v_accvgpr_read_b32 v86,a250
v_mfma_f32_16x16x32_bf16 v[252:255],a[148:151],v[48:51],v[252:255]
buffer_load_dwordx4 v6,s[8:11],s25 offen offset:0 lds
buffer_load_dwordx4 v7,s[8:11],s25 offen offset:1024 lds
buffer_load_dwordx4 v8,s[8:11],s25 offen offset:2048 lds
buffer_store_dwordx4 v[92:95],v9,s[16:19],s66 offen offset:3200 nt
v_pk_mul_f32 v[112:113],v[112:113],v[64:65] op_sel_hi:[1,0]
v_pk_mul_f32 v[114:115],v[114:115],v[64:65] op_sel_hi:[1,0]
v_pk_mul_f32 v[128:129],v[128:129],v[64:65] op_sel_hi:[1,0]
v_pk_mul_f32 v[130:131],v[130:131],v[64:65] op_sel_hi:[1,0]
v_pk_mul_f32 v[116:117],v[116:117],v[64:65] op_sel_hi:[1,0]
v_pk_mul_f32 v[118:119],v[118:119],v[64:65] op_sel_hi:[1,0]
v_pk_mul_f32 v[132:133],v[132:133],v[64:65] op_sel_hi:[1,0]
v_pk_mul_f32 v[134:135],v[134:135],v[64:65] op_sel_hi:[1,0]
v_accvgpr_read_b32 v87,a251
v_pk_mul_f32 v[86:87],v[86:87],v[68:69] op_sel_hi:[1,0]
v_accvgpr_read_b32 v84,a248
v_accvgpr_read_b32 v85,a249
v_pk_mul_f32 v[84:85],v[84:85],v[68:69] op_sel_hi:[1,0]
v_accvgpr_read_b32 v80,a200
v_accvgpr_read_b32 v81,a201
v_pk_mul_f32 v[80:81],v[80:81],v[66:67] op_sel_hi:[1,0]
v_accvgpr_read_b32 v82,a202
v_accvgpr_read_b32 v83,a203
v_pk_mul_f32 v[82:83],v[82:83],v[66:67] op_sel_hi:[1,0]
v_accvgpr_read_b32 v106,a206
v_accvgpr_read_b32 v107,a207
v_pk_mul_f32 v[106:107],v[106:107],v[66:67] op_sel_hi:[1,0]
v_accvgpr_read_b32 v110,a254
v_accvgpr_read_b32 v111,a255
v_pk_mul_f32 v[110:111],v[110:111],v[68:69] op_sel_hi:[1,0]
v_accvgpr_read_b32 v104,a204
v_accvgpr_read_b32 v105,a205
v_pk_mul_f32 v[104:105],v[104:105],v[66:67] op_sel_hi:[1,0]
v_accvgpr_read_b32 v108,a252
v_accvgpr_read_b32 v109,a253
v_pk_mul_f32 v[108:109],v[108:109],v[68:69] op_sel_hi:[1,0]
v_cvt_pk_bf16_f32 v96,v96,v97
v_cvt_pk_bf16_f32 v100,v100,v101
v_mfma_f32_16x16x32_bf16 v[248:251],a[144:147],v[48:51],v[248:251]
s_waitcnt vmcnt(20)
ds_read_b128 a[92:95],v12 offset:256
v_cvt_pk_bf16_f32 v84,v84,v85
v_mfma_f32_16x16x32_bf16 v[200:203],a[144:147],v[44:47],v[200:203]
s_mov_b32 s27,s42
ds_read_b128 a[88:91],v11 offset:256
v_cvt_pk_bf16_f32 v80,v80,v81
ds_read_b128 a[84:87],v12 offset:128
v_pk_mul_f32 v[120:121],v[120:121],v[64:65] op_sel_hi:[1,0]
ds_read_b128 a[80:83],v11 offset:128
v_pk_mul_f32 v[122:123],v[122:123],v[64:65] op_sel_hi:[1,0]
ds_read_b128 a[76:79],v12 offset:0
v_pk_mul_f32 v[136:137],v[136:137],v[64:65] op_sel_hi:[1,0]
ds_read_b128 a[72:75],v11 offset:0
v_pk_mul_f32 v[138:139],v[138:139],v[64:65] op_sel_hi:[1,0]
v_cvt_pk_bf16_f32 v97,v98,v99
v_cvt_pk_bf16_f32 v101,v102,v103
v_mfma_f32_16x16x32_bf16 v[204:207],a[148:151],v[44:47],v[204:207]
s_mov_b32 s42,s41
ds_write2st64_b64 v37,v[96:97],v[100:101] offset0:36 offset1:40
s_waitcnt lgkmcnt(6)
v_mfma_f32_16x16x32_bf16 v[72:75],a[120:123],a[0:3],0
s_add_u32 s69,s69,1
v_add_u32 v37,v37,v19
ds_read_b128 a[144:147],v0 offset:6144
v_mfma_f32_16x16x32_bf16 v[72:75],a[124:127],a[4:7],v[72:75]
s_lshl_b32 s62,s69,5
ds_read_b128 a[148:151],v1 offset:6144
v_cvt_pk_bf16_f32 v104,v104,v105
v_cvt_pk_bf16_f32 v108,v108,v109
v_cvt_pk_bf16_f32 v85,v86,v87
v_pk_mul_f32 v[124:125],v[124:125],v[64:65] op_sel_hi:[1,0]
v_pk_mul_f32 v[126:127],v[126:127],v[64:65] op_sel_hi:[1,0]
v_pk_mul_f32 v[140:141],v[140:141],v[64:65] op_sel_hi:[1,0]
v_pk_mul_f32 v[142:143],v[142:143],v[64:65] op_sel_hi:[1,0]
v_cvt_pk_bf16_f32 v81,v82,v83
v_cvt_pk_bf16_f32 v105,v106,v107
v_mfma_f32_16x16x32_bf16 v[72:75],a[128:131],a[8:11],v[72:75]
s_add_u32 s62,s62,s34
ds_write2st64_b64 v38,v[80:81],v[84:85] offset0:36 offset1:40
v_mfma_f32_16x16x32_bf16 v[72:75],a[132:135],a[12:15],v[72:75]
s_mul_i32 s63,s62,171
v_add_u32 v38,v38,v19
v_cvt_pk_bf16_f32 v109,v110,v111
v_mfma_f32_16x16x32_bf16 v[72:75],a[136:139],a[16:19],v[72:75]
s_waitcnt vmcnt(7)
ds_read_b128 a[96:99],v11 offset:6144
v_cvt_pk_bf16_f32 v112,v112,v113
v_mfma_f32_16x16x32_bf16 v[72:75],a[140:143],a[20:23],v[72:75]
s_lshr_b32 s63,s63,9
ds_read_b128 a[100:103],v12 offset:6144
v_cvt_pk_bf16_f32 v128,v128,v129
ds_read_b128 a[104:107],v11 offset:6272
v_pk_mul_f32 v[144:145],v[144:145],v[64:65] op_sel_hi:[1,0]
ds_read_b128 a[108:111],v12 offset:6272
v_pk_mul_f32 v[146:147],v[146:147],v[64:65] op_sel_hi:[1,0]
ds_read_b128 a[112:115],v11 offset:6400
v_pk_mul_f32 v[160:161],v[160:161],v[60:61] op_sel_hi:[1,0]
ds_read_b128 a[116:119],v12 offset:6400
v_pk_mul_f32 v[162:163],v[162:163],v[60:61] op_sel_hi:[1,0]
v_max3_f32 v44,v72,v73,v74
v_cvt_pk_bf16_f32 v116,v116,v117
v_mfma_f32_16x16x32_bf16 v[80:83],a[140:143],a[44:47],0
s_mul_i32 s64,s63,3
ds_write2st64_b64 v39,v[104:105],v[108:109] offset0:36 offset1:40
v_mfma_f32_16x16x32_bf16 v[80:83],a[136:139],a[40:43],v[80:83]
s_sub_u32 s62,s62,s64
v_add_u32 v39,v39,v19
v_cvt_pk_bf16_f32 v132,v132,v133
v_mfma_f32_16x16x32_bf16 v[80:83],a[132:135],a[36:39],v[80:83]
s_add_u32 s63,s63,s33
ds_read_b128 v[76:79],v10 offset:18432
v_cvt_pk_bf16_f32 v113,v114,v115
ds_read_b128 v[88:91],v10 offset:19456
v_pk_mul_f32 v[148:149],v[148:149],v[64:65] op_sel_hi:[1,0]
ds_read_b128 v[92:95],v10 offset:20480
v_pk_mul_f32 v[150:151],v[150:151],v[64:65] op_sel_hi:[1,0]
ds_read_b128 v[96:99],v10 offset:21504
v_pk_mul_f32 v[164:165],v[164:165],v[60:61] op_sel_hi:[1,0]
v_pk_mul_f32 v[166:167],v[166:167],v[60:61] op_sel_hi:[1,0]
v_cvt_pk_bf16_f32 v129,v130,v131
v_cvt_pk_bf16_f32 v120,v120,v121
v_mfma_f32_16x16x32_bf16 v[80:83],a[128:131],a[32:35],v[80:83]
s_mul_i32 s30,s63,196608
ds_write2st64_b64 v36,v[112:113],v[128:129] offset0:24 offset1:26
v_mfma_f32_16x16x32_bf16 v[80:83],a[124:127],a[28:31],v[80:83]
s_mul_i32 s41,s63,325632
v_cvt_pk_bf16_f32 v136,v136,v137
v_cvt_pk_bf16_f32 v117,v118,v119
v_mfma_f32_16x16x32_bf16 v[80:83],a[120:123],a[24:27],v[80:83]
s_lshl_b32 s63,s3,2
s_waitcnt lgkmcnt(4)
buffer_store_dwordx4 v[76:79],v9,s[16:19],s87 offen offset:256 nt
v_cvt_pk_bf16_f32 v133,v134,v135
v_cvt_pk_bf16_f32 v124,v124,v125
v_cvt_pk_bf16_f32 v140,v140,v141
v_cvt_pk_bf16_f32 v121,v122,v123
v_cvt_pk_bf16_f32 v137,v138,v139
v_cvt_pk_bf16_f32 v144,v144,v145
v_max3_f32 v48,v80,v81,v82
v_cvt_pk_bf16_f32 v160,v160,v161
v_cvt_pk_bf16_f32 v125,v126,v127
ds_write2st64_b64 v37,v[116:117],v[132:133] offset0:24 offset1:26
v_cvt_pk_bf16_f32 v141,v142,v143
v_cvt_pk_bf16_f32 v148,v148,v149
v_cvt_pk_bf16_f32 v164,v164,v165
s_waitcnt lgkmcnt(1)
buffer_store_dwordx4 v[88:91],v9,s[16:19],s87 offen offset:3328 nt
v_cvt_pk_bf16_f32 v145,v146,v147
v_cvt_pk_bf16_f32 v161,v162,v163
v_cvt_pk_bf16_f32 v149,v150,v151
v_mfma_f32_16x16x32_bf16 v[88:91],a[120:123],a[48:51],0
s_add_u32 s64,s63,21
v_cvt_pk_bf16_f32 v165,v166,v167
v_mov_b32 v63,0
v_mov_b32 v65,0
v_mov_b32 v61,0
ds_write2st64_b64 v38,v[120:121],v[136:137] offset0:24 offset1:26
v_pk_mul_f32 v[152:153],v[152:153],v[64:65] op_sel_hi:[1,0]
v_pk_mul_f32 v[154:155],v[154:155],v[64:65] op_sel_hi:[1,0]
v_pk_mul_f32 v[168:169],v[168:169],v[60:61] op_sel_hi:[1,0]
buffer_store_dwordx4 v[92:95],v9,s[16:19],s66 offen offset:256 nt
v_pk_mul_f32 v[170:171],v[170:171],v[60:61] op_sel_hi:[1,0]
v_cvt_pk_bf16_f32 v152,v152,v153
v_cvt_pk_bf16_f32 v168,v168,v169
v_mfma_f32_16x16x32_bf16 v[88:91],a[124:127],a[52:55],v[88:91]
s_cmp_eq_u32 s3,0
v_cvt_pk_bf16_f32 v153,v154,v155
v_cvt_pk_bf16_f32 v169,v170,v171
v_mfma_f32_16x16x32_bf16 v[88:91],a[128:131],a[56:59],v[88:91]
s_cselect_b32 s64,20,s64
v_mov_b32 v66,0
v_mov_b32 v69,0
v_mfma_f32_16x16x32_bf16 v[88:91],a[132:135],a[60:63],v[88:91]
s_cselect_b32 s40,1,0
ds_write2st64_b64 v39,v[124:125],v[140:141] offset0:24 offset1:26
v_mfma_f32_16x16x32_bf16 v[88:91],a[136:139],a[64:67],v[88:91]
s_add_u32 s65,s63,37
v_mov_b32 v70,0
buffer_store_dwordx4 v[96:99],v9,s[16:19],s66 offen offset:3328 nt
v_pk_mul_f32 v[156:157],v[156:157],v[64:65] op_sel_hi:[1,0]
v_pk_mul_f32 v[158:159],v[158:159],v[64:65] op_sel_hi:[1,0]
v_pk_mul_f32 v[172:173],v[172:173],v[60:61] op_sel_hi:[1,0]
v_pk_mul_f32 v[174:175],v[174:175],v[60:61] op_sel_hi:[1,0]
v_cvt_pk_bf16_f32 v156,v156,v157
v_cvt_pk_bf16_f32 v172,v172,v173
v_mfma_f32_16x16x32_bf16 v[88:91],a[140:143],a[68:71],v[88:91]
s_cmp_eq_u32 s62,2
v_cvt_pk_bf16_f32 v157,v158,v159
v_cvt_pk_bf16_f32 v173,v174,v175
v_mfma_f32_16x16x32_bf16 v[96:99],a[140:143],a[92:95],0
s_cselect_b32 s64,s65,s64
ds_write2st64_b64 v36,v[144:145],v[160:161] offset0:28 offset1:0
v_mfma_f32_16x16x32_bf16 v[96:99],a[136:139],a[88:91],v[96:99]
s_cselect_b32 s40,0,s40
v_max3_f32 v52,v88,v89,v90
v_mov_b32 v64,0
v_mov_b32 v71,0
v_mov_b32 v68,0
s_add_u32 s65,s63,s3
v_pk_mul_f32 v[176:177],v[176:177],v[60:61] op_sel_hi:[1,0]
v_pk_mul_f32 v[178:179],v[178:179],v[60:61] op_sel_hi:[1,0]
v_pk_mul_f32 v[192:193],v[192:193],v[60:61] op_sel_hi:[1,0]
v_pk_mul_f32 v[194:195],v[194:195],v[60:61] op_sel_hi:[1,0]
v_cvt_pk_bf16_f32 v176,v176,v177
v_cvt_pk_bf16_f32 v192,v192,v193
v_mfma_f32_16x16x32_bf16 v[96:99],a[132:135],a[84:87],v[96:99]
s_cmp_eq_u32 s62,0
ds_write2st64_b64 v37,v[148:149],v[164:165] offset0:28 offset1:0
v_mfma_f32_16x16x32_bf16 v[96:99],a[128:131],a[80:83],v[96:99]
s_cselect_b32 s64,s65,s64
v_cvt_pk_bf16_f32 v177,v178,v179
v_cvt_pk_bf16_f32 v193,v194,v195
v_mfma_f32_16x16x32_bf16 v[96:99],a[124:127],a[76:79],v[96:99]
s_cselect_b32 s40,1,s40
s_mul_i32 s64,s64,6144
s_add_u32 s41,s41,s64
v_mfma_f32_16x16x32_bf16 v[96:99],a[120:123],a[72:75],v[96:99]
s_cmp_ge_u32 s69,6
s_cselect_b32 s41,166723584,s41
ds_write2st64_b64 v38,v[152:153],v[168:169] offset0:28 offset1:0
v_pk_mul_f32 v[180:181],v[180:181],v[60:61] op_sel_hi:[1,0]
v_pk_mul_f32 v[182:183],v[182:183],v[60:61] op_sel_hi:[1,0]
v_pk_mul_f32 v[196:197],v[196:197],v[60:61] op_sel_hi:[1,0]
v_pk_mul_f32 v[198:199],v[198:199],v[60:61] op_sel_hi:[1,0]
v_cvt_pk_bf16_f32 v180,v180,v181
v_max3_f32 v56,v96,v97,v98
v_mfma_f32_16x16x32_bf16 v[104:107],a[120:123],a[96:99],0
s_cselect_b32 s30,100663296,s30
ds_read_b128 a[120:123],v0 offset:6272
v_cvt_pk_bf16_f32 v196,v196,v197
v_mfma_f32_16x16x32_bf16 v[104:107],a[124:127],a[100:103],v[104:107]
s_add_u32 s25,s30,s22
ds_read_b128 a[124:127],v1 offset:6272
v_cvt_pk_bf16_f32 v181,v182,v183
v_mfma_f32_16x16x32_bf16 v[104:107],a[128:131],a[104:107],v[104:107]
s_add_u32 s26,s25,12288
ds_write2st64_b64 v39,v[156:157],v[172:173] offset0:28 offset1:0
v_pk_mul_f32 v[184:185],v[184:185],v[60:61] op_sel_hi:[1,0]
v_pk_mul_f32 v[186:187],v[186:187],v[60:61] op_sel_hi:[1,0]
v_pk_mul_f32 v[200:201],v[200:201],v[60:61] op_sel_hi:[1,0]
ds_read_b128 a[128:131],v0 offset:6400
v_pk_mul_f32 v[202:203],v[202:203],v[60:61] op_sel_hi:[1,0]
v_cvt_pk_bf16_f32 v197,v198,v199
v_cvt_pk_bf16_f32 v184,v184,v185
v_mfma_f32_16x16x32_bf16 v[104:107],a[132:135],a[108:111],v[104:107]
s_add_u32 m0,s23,24576
ds_read_b128 a[132:135],v1 offset:6400
v_cvt_pk_bf16_f32 v200,v200,v201
v_mfma_f32_16x16x32_bf16 v[104:107],a[136:139],a[112:115],v[104:107]
s_mov_b32 s28,s41
ds_read_b128 a[136:139],v0 offset:12288
v_cvt_pk_bf16_f32 v185,v186,v187
v_mfma_f32_16x16x32_bf16 v[104:107],a[140:143],a[116:119],v[104:107]
s_mov_b32 s29,s24
ds_read_b128 a[140:143],v1 offset:12288
v_cvt_pk_bf16_f32 v201,v202,v203
v_mfma_f32_16x16x32_bf16 v[76:79],a[144:147],a[0:3],0
ds_write2st64_b64 v36,v[176:177],v[192:193] offset0:2 offset1:4
v_pk_mul_f32 v[188:189],v[188:189],v[60:61] op_sel_hi:[1,0]
v_pk_mul_f32 v[190:191],v[190:191],v[60:61] op_sel_hi:[1,0]
v_pk_mul_f32 v[204:205],v[204:205],v[60:61] op_sel_hi:[1,0]
v_pk_mul_f32 v[206:207],v[206:207],v[60:61] op_sel_hi:[1,0]
v_max3_f32 v40,v104,v105,v106
v_cvt_pk_bf16_f32 v188,v188,v189
v_mfma_f32_16x16x32_bf16 v[76:79],a[148:151],a[4:7],v[76:79]
s_waitcnt lgkmcnt(4)
v_cvt_pk_bf16_f32 v204,v204,v205
v_cvt_pk_bf16_f32 v189,v190,v191
v_mfma_f32_16x16x32_bf16 v[76:79],a[120:123],a[8:11],v[76:79]
v_cvt_pk_bf16_f32 v205,v206,v207
v_mov_b32 v60,0
v_mfma_f32_16x16x32_bf16 v[76:79],a[124:127],a[12:15],v[76:79]
ds_write2st64_b64 v37,v[180:181],v[196:197] offset0:2 offset1:4
v_mfma_f32_16x16x32_bf16 v[76:79],a[128:131],a[16:19],v[76:79]
v_pk_mul_f32 v[208:209],v[208:209],v[62:63] op_sel_hi:[1,0]
v_pk_mul_f32 v[210:211],v[210:211],v[62:63] op_sel_hi:[1,0]
v_pk_mul_f32 v[224:225],v[224:225],v[62:63] op_sel_hi:[1,0]
v_pk_mul_f32 v[226:227],v[226:227],v[62:63] op_sel_hi:[1,0]
v_cvt_pk_bf16_f32 v208,v208,v209
v_cvt_pk_bf16_f32 v224,v224,v225
s_waitcnt lgkmcnt(1)
v_mfma_f32_16x16x32_bf16 v[76:79],a[132:135],a[20:23],v[76:79]
ds_write2st64_b64 v38,v[184:185],v[200:201] offset0:2 offset1:4
v_mfma_f32_16x16x32_bf16 v[84:87],a[132:135],a[44:47],0
v_cvt_pk_bf16_f32 v209,v210,v211
v_cvt_pk_bf16_f32 v225,v226,v227
v_mfma_f32_16x16x32_bf16 v[84:87],a[128:131],a[40:43],v[84:87]
buffer_load_dwordx4 v6,s[8:11],s21 offen offset:0 lds
v_pk_mul_f32 v[212:213],v[212:213],v[62:63] op_sel_hi:[1,0]
ds_write2st64_b64 v39,v[188:189],v[204:205] offset0:2 offset1:4
v_pk_mul_f32 v[214:215],v[214:215],v[62:63] op_sel_hi:[1,0]
v_pk_mul_f32 v[228:229],v[228:229],v[62:63] op_sel_hi:[1,0]
v_pk_mul_f32 v[230:231],v[230:231],v[62:63] op_sel_hi:[1,0]
v_max3_f32 v44,v44,v75,v76
v_max3_f32 v44,v44,v77,v78
v_mfma_f32_16x16x32_bf16 v[84:87],a[124:127],a[36:39],v[84:87]
v_max_f32 v44,v44,v79
v_mov_b32 v45,v44
v_mfma_f32_16x16x32_bf16 v[84:87],a[120:123],a[32:35],v[84:87]
buffer_load_dwordx4 v7,s[8:11],s21 offen offset:1024 lds
v_mfma_f32_16x16x32_bf16 v[84:87],a[148:151],a[28:31],v[84:87]
ds_write2st64_b64 v36,v[208:209],v[224:225] offset0:12 offset1:14
v_mfma_f32_16x16x32_bf16 v[84:87],a[144:147],a[24:27],v[84:87]
v_permlane32_swap_b32 v45,v44
v_max_f32 v44,v44,v45
v_mov_b32 v45,v44
v_cvt_pk_bf16_f32 v212,v212,v213
v_pk_mul_f32 v[216:217],v[216:217],v[62:63] op_sel_hi:[1,0]
v_pk_mul_f32 v[218:219],v[218:219],v[62:63] op_sel_hi:[1,0]
v_pk_mul_f32 v[232:233],v[232:233],v[62:63] op_sel_hi:[1,0]
v_pk_mul_f32 v[234:235],v[234:235],v[62:63] op_sel_hi:[1,0]
v_permlane16_swap_b32 v45,v44
v_max_f32 v44,v44,v45
v_mfma_f32_16x16x32_bf16 v[92:95],a[144:147],a[48:51],0
v_mul_f32_e64 v13,-s36,v44
v_fma_f32 v72,v72,s36,v13
v_mfma_f32_16x16x32_bf16 v[92:95],a[148:151],a[52:55],v[92:95]
v_fma_f32 v73,v73,s36,v13
v_fma_f32 v74,v74,s36,v13
v_mfma_f32_16x16x32_bf16 v[92:95],a[120:123],a[56:59],v[92:95]
buffer_load_dwordx4 v8,s[8:11],s21 offen offset:2048 lds
v_mfma_f32_16x16x32_bf16 v[92:95],a[124:127],a[60:63],v[92:95]
s_add_u32 s21,s21,12288
v_fma_f32 v75,v75,s36,v13
v_exp_f32 v72,v72
v_exp_f32 v73,v73
v_pk_mul_f32 v[220:221],v[220:221],v[62:63] op_sel_hi:[1,0]
v_pk_mul_f32 v[222:223],v[222:223],v[62:63] op_sel_hi:[1,0]
v_pk_mul_f32 v[236:237],v[236:237],v[62:63] op_sel_hi:[1,0]
v_pk_mul_f32 v[238:239],v[238:239],v[62:63] op_sel_hi:[1,0]
v_exp_f32 v74,v74
v_exp_f32 v75,v75
v_mfma_f32_16x16x32_bf16 v[92:95],a[128:131],a[64:67],v[92:95]
s_add_u32 m0,s22,0
v_cvt_pk_bf16_f32 v20,v72,v73
v_cvt_pk_bf16_f32 v21,v74,v75
v_mfma_f32_16x16x32_bf16 v[92:95],a[132:135],a[68:71],v[92:95]
v_max3_f32 v48,v48,v83,v84
v_max3_f32 v48,v48,v85,v86
v_mfma_f32_16x16x32_bf16 v[100:103],a[132:135],a[92:95],0
v_max_f32 v48,v48,v87
v_mov_b32 v49,v48
v_cvt_pk_bf16_f32 v228,v228,v229
v_cvt_pk_bf16_f32 v213,v214,v215
v_permlane32_swap_b32 v49,v48
v_pk_mul_f32 v[240:241],v[240:241],v[62:63] op_sel_hi:[1,0]
v_pk_mul_f32 v[242:243],v[242:243],v[62:63] op_sel_hi:[1,0]
v_max_f32 v48,v48,v49
v_mov_b32 v49,v48
v_mfma_f32_16x16x32_bf16 v[100:103],a[128:131],a[88:91],v[100:103]
v_max3_f32 v52,v52,v91,v92
v_permlane16_swap_b32 v49,v48
v_mfma_f32_16x16x32_bf16 v[100:103],a[124:127],a[84:87],v[100:103]
v_max_f32 v48,v48,v49
v_mul_f32_e64 v14,-s36,v48
v_mfma_f32_16x16x32_bf16 v[100:103],a[120:123],a[80:83],v[100:103]
v_fma_f32 v80,v80,s36,v14
v_fma_f32 v81,v81,s36,v14
v_mfma_f32_16x16x32_bf16 v[100:103],a[148:151],a[76:79],v[100:103]
v_fma_f32 v82,v82,s36,v14
v_fma_f32 v83,v83,s36,v14
v_exp_f32 v80,v80
v_exp_f32 v81,v81
v_pk_mul_f32 v[244:245],v[244:245],v[62:63] op_sel_hi:[1,0]
v_pk_mul_f32 v[246:247],v[246:247],v[62:63] op_sel_hi:[1,0]
v_exp_f32 v82,v82
v_exp_f32 v83,v83
v_mfma_f32_16x16x32_bf16 v[100:103],a[144:147],a[72:75],v[100:103]
v_cvt_pk_bf16_f32 v24,v80,v81
v_cvt_pk_bf16_f32 v25,v82,v83
v_mfma_f32_16x16x32_bf16 v[108:111],a[144:147],a[96:99],0
ds_read_b128 a[144:147],v0 offset:12416
v_max3_f32 v52,v52,v93,v94
v_mfma_f32_16x16x32_bf16 v[108:111],a[148:151],a[100:103],v[108:111]
ds_read_b128 a[148:151],v1 offset:12416
v_max_f32 v52,v52,v95
v_mov_b32 v53,v52
v_max3_f32 v56,v56,v99,v100
v_max3_f32 v56,v56,v101,v102
v_pk_mul_f32 v[248:249],v[248:249],v[62:63] op_sel_hi:[1,0]
v_pk_mul_f32 v[250:251],v[250:251],v[62:63] op_sel_hi:[1,0]
v_permlane32_swap_b32 v53,v52
v_max_f32 v52,v52,v53
v_mfma_f32_16x16x32_bf16 v[108:111],a[120:123],a[104:107],v[108:111]
ds_read_b128 a[120:123],v0 offset:12544
v_mov_b32 v53,v52
v_mfma_f32_16x16x32_bf16 v[108:111],a[124:127],a[108:111],v[108:111]
ds_read_b128 a[124:127],v1 offset:12544
v_permlane16_swap_b32 v53,v52
v_mfma_f32_16x16x32_bf16 v[108:111],a[128:131],a[112:115],v[108:111]
ds_read_b128 a[128:131],v0 offset:18432
v_max_f32 v52,v52,v53
v_mfma_f32_16x16x32_bf16 v[108:111],a[132:135],a[116:119],v[108:111]
ds_read_b128 a[132:135],v1 offset:18432
v_mul_f32_e64 v15,-s36,v52
v_fma_f32 v88,v88,s36,v15
v_fma_f32 v89,v89,s36,v15
v_fma_f32 v90,v90,s36,v15
v_pk_mul_f32 v[252:253],v[252:253],v[62:63] op_sel_hi:[1,0]
v_pk_mul_f32 v[254:255],v[254:255],v[62:63] op_sel_hi:[1,0]
v_fma_f32 v91,v91,s36,v15
v_exp_f32 v88,v88
v_mfma_f32_16x16x32_bf16 v[72:75],a[136:139],a[0:3],0
v_exp_f32 v89,v89
v_mfma_f32_16x16x32_bf16 v[72:75],a[140:143],a[4:7],v[72:75]
s_waitcnt lgkmcnt(3)
v_exp_f32 v90,v90
v_mfma_f32_16x16x32_bf16 v[72:75],a[144:147],a[8:11],v[72:75]
v_exp_f32 v91,v91
v_mfma_f32_16x16x32_bf16 v[72:75],a[148:151],a[12:15],v[72:75]
v_cvt_pk_bf16_f32 v28,v88,v89
v_cvt_pk_bf16_f32 v29,v90,v91
v_mfma_f32_16x16x32_bf16 v[72:75],a[120:123],a[16:19],v[72:75]
s_waitcnt lgkmcnt(0)
v_max_f32 v56,v56,v103
v_mov_b32 v57,v56
v_mfma_f32_16x16x32_bf16 v[72:75],a[124:127],a[20:23],v[72:75]
v_max3_f32 v40,v40,v107,v108
v_permlane32_swap_b32 v57,v56
v_mfma_f32_16x16x32_bf16 v[80:83],a[124:127],a[44:47],0
v_max_f32 v56,v56,v57
v_mov_b32 v57,v56
v_mfma_f32_16x16x32_bf16 v[80:83],a[120:123],a[40:43],v[80:83]
v_max3_f32 v40,v40,v109,v110
v_permlane16_swap_b32 v57,v56
v_mfma_f32_16x16x32_bf16 v[80:83],a[148:151],a[36:39],v[80:83]
v_max_f32 v56,v56,v57
v_mul_f32_e64 v16,-s36,v56
v_mfma_f32_16x16x32_bf16 v[80:83],a[144:147],a[32:35],v[80:83]
v_fma_f32 v96,v96,s36,v16
v_fma_f32 v97,v97,s36,v16
v_mfma_f32_16x16x32_bf16 v[80:83],a[140:143],a[28:31],v[80:83]
v_fma_f32 v98,v98,s36,v16
v_fma_f32 v99,v99,s36,v16
v_mfma_f32_16x16x32_bf16 v[80:83],a[136:139],a[24:27],v[80:83]
v_exp_f32 v96,v96
v_mfma_f32_16x16x32_bf16 v[88:91],a[136:139],a[48:51],0
v_exp_f32 v97,v97
v_mfma_f32_16x16x32_bf16 v[88:91],a[140:143],a[52:55],v[88:91]
v_exp_f32 v98,v98
v_mfma_f32_16x16x32_bf16 v[88:91],a[144:147],a[56:59],v[88:91]
v_exp_f32 v99,v99
v_mfma_f32_16x16x32_bf16 v[88:91],a[148:151],a[60:63],v[88:91]
v_cvt_pk_bf16_f32 v32,v96,v97
v_cvt_pk_bf16_f32 v33,v98,v99
v_mfma_f32_16x16x32_bf16 v[88:91],a[120:123],a[64:67],v[88:91]
v_max_f32 v40,v40,v111
v_mov_b32 v41,v40
v_mfma_f32_16x16x32_bf16 v[88:91],a[124:127],a[68:71],v[88:91]
v_cvt_pk_bf16_f32 v216,v216,v217
v_permlane32_swap_b32 v41,v40
v_mfma_f32_16x16x32_bf16 v[96:99],a[124:127],a[92:95],0
v_max_f32 v40,v40,v41
v_mov_b32 v41,v40
v_mfma_f32_16x16x32_bf16 v[96:99],a[120:123],a[88:91],v[96:99]
v_cvt_pk_bf16_f32 v232,v232,v233
v_permlane16_swap_b32 v41,v40
v_mfma_f32_16x16x32_bf16 v[96:99],a[148:151],a[84:87],v[96:99]
v_cvt_pk_bf16_f32 v229,v230,v231
v_max_f32 v40,v40,v41
v_mfma_f32_16x16x32_bf16 v[96:99],a[144:147],a[80:83],v[96:99]
ds_write2st64_b64 v37,v[212:213],v[228:229] offset0:12 offset1:14
v_mfma_f32_16x16x32_bf16 v[96:99],a[140:143],a[76:79],v[96:99]
v_cvt_pk_bf16_f32 v220,v220,v221
v_cvt_pk_bf16_f32 v236,v236,v237
v_mfma_f32_16x16x32_bf16 v[96:99],a[136:139],a[72:75],v[96:99]
v_cvt_pk_bf16_f32 v217,v218,v219
v_cvt_pk_bf16_f32 v233,v234,v235
v_mul_f32_e64 v17,-s36,v40
v_cvt_pk_bf16_f32 v240,v240,v241
v_cvt_pk_bf16_f32 v221,v222,v223
ds_write2st64_b64 v38,v[216:217],v[232:233] offset0:12 offset1:14
v_cvt_pk_bf16_f32 v237,v238,v239
v_fma_f32 v104,v104,s36,v17
v_fma_f32 v105,v105,s36,v17
v_fma_f32 v106,v106,s36,v17
v_fma_f32 v107,v107,s36,v17
v_cvt_pk_bf16_f32 v244,v244,v245
v_cvt_pk_bf16_f32 v241,v242,v243
v_exp_f32 v104,v104
v_exp_f32 v105,v105
ds_write2st64_b64 v39,v[220:221],v[236:237] offset0:12 offset1:14
v_exp_f32 v106,v106
v_exp_f32 v107,v107
v_cvt_pk_bf16_f32 v245,v246,v247
v_fma_f32 v76,v76,s36,v13
v_fma_f32 v77,v77,s36,v13
v_fma_f32 v78,v78,s36,v13
v_fma_f32 v79,v79,s36,v13
v_exp_f32 v76,v76
ds_write_b64 v36,v[240:241] offset:8192
v_cvt_pk_bf16_f32 v36,v104,v105
v_exp_f32 v77,v77
v_exp_f32 v78,v78
ds_write_b64 v37,v[244:245] offset:8192
v_cvt_pk_bf16_f32 v37,v106,v107
v_mfma_f32_16x16x32_bf16 v[104:107],a[136:139],a[96:99],0
ds_read_b128 a[136:139],v0 offset:18560
v_exp_f32 v79,v79
v_mfma_f32_16x16x32_bf16 v[104:107],a[140:143],a[100:103],v[104:107]
ds_read_b128 a[140:143],v1 offset:18560
v_cvt_pk_bf16_f32 v22,v76,v77
v_mfma_f32_16x16x32_bf16 v[104:107],a[144:147],a[104:107],v[104:107]
ds_read_b128 a[144:147],v0 offset:18688
v_cvt_pk_bf16_f32 v23,v78,v79
v_mfma_f32_16x16x32_bf16 v[104:107],a[148:151],a[108:111],v[104:107]
ds_read_b128 a[148:151],v1 offset:18688
v_fma_f32 v84,v84,s36,v14
v_mfma_f32_16x16x32_bf16 v[104:107],a[120:123],a[112:115],v[104:107]
v_fma_f32 v85,v85,s36,v14
v_fma_f32 v86,v86,s36,v14
v_mfma_f32_16x16x32_bf16 v[104:107],a[124:127],a[116:119],v[104:107]
v_fma_f32 v87,v87,s36,v14
v_exp_f32 v84,v84
v_mfma_f32_16x16x32_bf16 v[76:79],a[128:131],a[0:3],0
v_exp_f32 v85,v85
v_mfma_f32_16x16x32_bf16 v[76:79],a[132:135],a[4:7],v[76:79]
s_waitcnt lgkmcnt(3)
v_exp_f32 v86,v86
v_mfma_f32_16x16x32_bf16 v[76:79],a[136:139],a[8:11],v[76:79]
s_waitcnt lgkmcnt(2)
v_exp_f32 v87,v87
v_mfma_f32_16x16x32_bf16 v[76:79],a[140:143],a[12:15],v[76:79]
v_cvt_pk_bf16_f32 v26,v84,v85
s_waitcnt vmcnt(8)
s_barrier
s_waitcnt lgkmcnt(0)
v_mfma_f32_16x16x32_bf16 v[76:79],a[144:147],a[16:19],v[76:79]
buffer_load_dwordx4 v6,s[4:7],s20 offen offset:0 lds
v_mfma_f32_16x16x32_bf16 v[76:79],a[148:151],a[20:23],v[76:79]
v_cvt_pk_bf16_f32 v27,v86,v87
v_fma_f32 v92,v92,s36,v15
v_mfma_f32_16x16x32_bf16 v[84:87],a[148:151],a[44:47],0
v_fma_f32 v93,v93,s36,v15
v_fma_f32 v94,v94,s36,v15
v_mfma_f32_16x16x32_bf16 v[84:87],a[144:147],a[40:43],v[84:87]
v_fma_f32 v95,v95,s36,v15
v_exp_f32 v92,v92
v_mfma_f32_16x16x32_bf16 v[84:87],a[140:143],a[36:39],v[84:87]
v_exp_f32 v93,v93
v_mfma_f32_16x16x32_bf16 v[84:87],a[136:139],a[32:35],v[84:87]
v_exp_f32 v94,v94
v_mfma_f32_16x16x32_bf16 v[84:87],a[132:135],a[28:31],v[84:87]
buffer_load_dwordx4 v7,s[4:7],s20 offen offset:1024 lds
v_mfma_f32_16x16x32_bf16 v[84:87],a[128:131],a[24:27],v[84:87]
v_exp_f32 v95,v95
v_cvt_pk_bf16_f32 v30,v92,v93
v_cvt_pk_bf16_f32 v31,v94,v95
v_mfma_f32_16x16x32_bf16 v[92:95],a[128:131],a[48:51],0
v_fma_f32 v100,v100,s36,v16
v_fma_f32 v101,v101,s36,v16
v_mfma_f32_16x16x32_bf16 v[92:95],a[132:135],a[52:55],v[92:95]
ds_read_b64_tr_b16 a[120:121],v2 offset:0
v_fma_f32 v102,v102,s36,v16
v_mfma_f32_16x16x32_bf16 v[92:95],a[136:139],a[56:59],v[92:95]
ds_read_b64_tr_b16 a[122:123],v2 offset:6144
v_fma_f32 v103,v103,s36,v16
v_mfma_f32_16x16x32_bf16 v[92:95],a[140:143],a[60:63],v[92:95]
buffer_load_dwordx4 v8,s[4:7],s20 offen offset:2048 lds
v_mfma_f32_16x16x32_bf16 v[92:95],a[144:147],a[64:67],v[92:95]
s_add_u32 s20,s20,12288
ds_read_b64_tr_b16 a[124:125],v3 offset:0
v_exp_f32 v100,v100
v_mfma_f32_16x16x32_bf16 v[92:95],a[148:151],a[68:71],v[92:95]
ds_read_b64_tr_b16 a[126:127],v3 offset:6144
v_exp_f32 v101,v101
v_exp_f32 v102,v102
v_exp_f32 v103,v103
v_cvt_pk_bf16_f32 v34,v100,v101
v_cvt_pk_bf16_f32 v35,v102,v103
v_mfma_f32_16x16x32_bf16 v[100:103],a[148:151],a[92:95],0
v_cvt_pk_bf16_f32 v248,v248,v249
v_fma_f32 v108,v108,s36,v17
v_smfmac_f32_16x16x64_bf16 v[64:67],a[152:155],v[28:35],v18
v_fma_f32 v109,v109,s36,v17
v_mfma_f32_16x16x32_bf16 v[100:103],a[144:147],a[88:91],v[100:103]
v_fma_f32 v110,v110,s36,v17
v_fma_f32 v111,v111,s36,v17
v_mfma_f32_16x16x32_bf16 v[100:103],a[140:143],a[84:87],v[100:103]
v_cvt_pk_bf16_f32 v252,v252,v253
v_cvt_pk_bf16_f32 v249,v250,v251
v_mfma_f32_16x16x32_bf16 v[100:103],a[136:139],a[80:83],v[100:103]
ds_write_b64 v38,v[248:249] offset:8192
v_mfma_f32_16x16x32_bf16 v[100:103],a[132:135],a[76:79],v[100:103]
v_exp_f32 v108,v108
v_mfma_f32_16x16x32_bf16 v[100:103],a[128:131],a[72:75],v[100:103]
v_exp_f32 v109,v109
v_exp_f32 v110,v110
v_exp_f32 v111,v111
v_cvt_pk_bf16_f32 v253,v254,v255
ds_write_b64 v39,v[252:253] offset:8192
v_cvt_pk_bf16_f32 v38,v108,v109
v_cvt_pk_bf16_f32 v39,v110,v111
v_mfma_f32_16x16x32_bf16 v[108:111],a[128:131],a[96:99],0
ds_read_b64_tr_b16 a[128:129],v4 offset:0
v_mov_b32 v62,0
v_mfma_f32_16x16x32_bf16 v[108:111],a[132:135],a[100:103],v[108:111]
ds_read_b64_tr_b16 a[130:131],v4 offset:6144
v_fma_f32 v72,v72,s36,v13
v_smfmac_f32_16x16x64_bf16 v[60:63],a[152:155],v[20:27],v18
ds_read_b64_tr_b16 a[132:133],v5 offset:0
v_mfma_f32_16x16x32_bf16 v[108:111],a[136:139],a[104:107],v[108:111]
ds_read_b64_tr_b16 a[134:135],v5 offset:6144
v_fma_f32 v73,v73,s36,v13
v_mfma_f32_16x16x32_bf16 v[108:111],a[140:143],a[108:111],v[108:111]
v_fma_f32 v74,v74,s36,v13
v_fma_f32 v75,v75,s36,v13
v_mfma_f32_16x16x32_bf16 v[108:111],a[144:147],a[112:115],v[108:111]
v_fma_f32 v80,v80,s36,v14
v_fma_f32 v81,v81,s36,v14
v_mfma_f32_16x16x32_bf16 v[108:111],a[148:151],a[116:119],v[108:111]
v_fma_f32 v82,v82,s36,v14
v_fma_f32 v83,v83,s36,v14
v_fma_f32 v88,v88,s36,v15
v_fma_f32 v89,v89,s36,v15
v_exp_f32 v72,v72
v_exp_f32 v73,v73
v_exp_f32 v74,v74
v_exp_f32 v75,v75
v_exp_f32 v80,v80
v_exp_f32 v81,v81
v_exp_f32 v82,v82
v_exp_f32 v83,v83
v_exp_f32 v88,v88
v_exp_f32 v89,v89
v_cvt_pk_bf16_f32 v44,v72,v73
v_cvt_pk_bf16_f32 v45,v74,v75
v_cvt_pk_bf16_f32 v48,v80,v81
v_cvt_pk_bf16_f32 v49,v82,v83
v_cvt_pk_bf16_f32 v52,v88,v89
s_waitcnt lgkmcnt(0)
v_mfma_f32_16x16x32_bf16 v[160:163],a[120:123],v[20:23],0
s_add_u32 m0,s23,0
ds_read_b64_tr_b16 a[136:137],v2 offset:128
v_fma_f32 v90,v90,s36,v15
v_mfma_f32_16x16x32_bf16 v[164:167],a[124:127],v[20:23],0
ds_read_b64_tr_b16 a[138:139],v2 offset:6272
v_fma_f32 v91,v91,s36,v15
v_mfma_f32_16x16x32_bf16 v[212:215],a[124:127],v[24:27],0
ds_read_b64_tr_b16 a[140:141],v3 offset:128
v_fma_f32 v96,v96,s36,v16
v_mfma_f32_16x16x32_bf16 v[208:211],a[120:123],v[24:27],0
ds_read_b64_tr_b16 a[142:143],v3 offset:6272
v_fma_f32 v97,v97,s36,v16
v_mfma_f32_16x16x32_bf16 v[112:115],a[120:123],v[28:31],0
ds_read_b64_tr_b16 a[144:145],v4 offset:128
v_fma_f32 v98,v98,s36,v16
v_mfma_f32_16x16x32_bf16 v[116:119],a[124:127],v[28:31],0
ds_read_b64_tr_b16 a[146:147],v4 offset:6272
v_fma_f32 v99,v99,s36,v16
v_mfma_f32_16x16x32_bf16 a[164:167],a[124:127],v[32:35],0
ds_read_b64_tr_b16 a[148:149],v5 offset:128
v_fma_f32 v104,v104,s36,v17
v_mfma_f32_16x16x32_bf16 a[160:163],a[120:123],v[32:35],0
ds_read_b64_tr_b16 a[150:151],v5 offset:6272
v_fma_f32 v105,v105,s36,v17
v_mfma_f32_16x16x32_bf16 a[208:211],a[120:123],v[36:39],0
ds_read_b64_tr_b16 a[120:121],v2 offset:256
v_fma_f32 v106,v106,s36,v17
v_mfma_f32_16x16x32_bf16 a[212:215],a[124:127],v[36:39],0
ds_read_b64_tr_b16 a[122:123],v2 offset:6400
v_fma_f32 v107,v107,s36,v17
v_mfma_f32_16x16x32_bf16 a[216:219],a[128:131],v[36:39],0
ds_read_b64_tr_b16 a[124:125],v3 offset:256
v_fma_f32 v76,v76,s36,v13
v_mfma_f32_16x16x32_bf16 a[220:223],a[132:135],v[36:39],0
ds_read_b64_tr_b16 a[126:127],v3 offset:6400
v_fma_f32 v77,v77,s36,v13
v_mfma_f32_16x16x32_bf16 a[172:175],a[132:135],v[32:35],0
v_exp_f32 v90,v90
v_mfma_f32_16x16x32_bf16 a[168:171],a[128:131],v[32:35],0
v_exp_f32 v91,v91
v_mfma_f32_16x16x32_bf16 v[120:123],a[128:131],v[28:31],0
v_cvt_pk_bf16_f32 v53,v90,v91
v_fma_f32 v78,v78,s36,v13
v_mfma_f32_16x16x32_bf16 v[124:127],a[132:135],v[28:31],0
v_exp_f32 v96,v96
v_mfma_f32_16x16x32_bf16 v[220:223],a[132:135],v[24:27],0
v_exp_f32 v97,v97
v_mfma_f32_16x16x32_bf16 v[216:219],a[128:131],v[24:27],0
v_exp_f32 v98,v98
v_mfma_f32_16x16x32_bf16 v[168:171],a[128:131],v[20:23],0
ds_read_b64_tr_b16 a[128:129],v4 offset:256
v_cvt_pk_bf16_f32 v56,v96,v97
v_mfma_f32_16x16x32_bf16 v[172:175],a[132:135],v[20:23],0
s_waitcnt lgkmcnt(1)
ds_read_b64_tr_b16 a[130:131],v4 offset:6400
v_fma_f32 v79,v79,s36,v13
v_mfma_f32_16x16x32_bf16 v[176:179],a[136:139],v[20:23],0
ds_read_b64_tr_b16 a[132:133],v5 offset:256
v_fma_f32 v84,v84,s36,v14
v_mfma_f32_16x16x32_bf16 v[180:183],a[140:143],v[20:23],0
ds_read_b64_tr_b16 a[134:135],v5 offset:6400
v_fma_f32 v85,v85,s36,v14
v_mfma_f32_16x16x32_bf16 v[228:231],a[140:143],v[24:27],0
v_exp_f32 v99,v99
v_mfma_f32_16x16x32_bf16 v[224:227],a[136:139],v[24:27],0
v_cvt_pk_bf16_f32 v57,v98,v99
v_fma_f32 v86,v86,s36,v14
v_mfma_f32_16x16x32_bf16 v[128:131],a[136:139],v[28:31],0
v_exp_f32 v104,v104
v_mfma_f32_16x16x32_bf16 v[132:135],a[140:143],v[28:31],0
v_exp_f32 v105,v105
v_mfma_f32_16x16x32_bf16 a[180:183],a[140:143],v[32:35],0
v_exp_f32 v106,v106
v_mfma_f32_16x16x32_bf16 a[176:179],a[136:139],v[32:35],0
v_exp_f32 v107,v107
v_mfma_f32_16x16x32_bf16 a[224:227],a[136:139],v[36:39],0
v_cvt_pk_bf16_f32 v40,v104,v105
v_cvt_pk_bf16_f32 v41,v106,v107
v_mfma_f32_16x16x32_bf16 a[228:231],a[140:143],v[36:39],0
v_exp_f32 v76,v76
v_mfma_f32_16x16x32_bf16 a[232:235],a[144:147],v[36:39],0
v_exp_f32 v77,v77
v_mfma_f32_16x16x32_bf16 a[236:239],a[148:151],v[36:39],0
v_exp_f32 v78,v78
v_mfma_f32_16x16x32_bf16 a[188:191],a[148:151],v[32:35],0
v_exp_f32 v79,v79
v_mfma_f32_16x16x32_bf16 a[184:187],a[144:147],v[32:35],0
v_cvt_pk_bf16_f32 v46,v76,v77
v_cvt_pk_bf16_f32 v47,v78,v79
v_mfma_f32_16x16x32_bf16 v[136:139],a[144:147],v[28:31],0
v_fma_f32 v87,v87,s36,v14
v_fma_f32 v92,v92,s36,v15
v_mfma_f32_16x16x32_bf16 v[140:143],a[148:151],v[28:31],0
v_exp_f32 v84,v84
v_mfma_f32_16x16x32_bf16 v[236:239],a[148:151],v[24:27],0
v_exp_f32 v85,v85
v_mfma_f32_16x16x32_bf16 v[232:235],a[144:147],v[24:27],0
v_exp_f32 v86,v86
v_mfma_f32_16x16x32_bf16 v[184:187],a[144:147],v[20:23],0
v_exp_f32 v87,v87
v_mfma_f32_16x16x32_bf16 v[188:191],a[148:151],v[20:23],0
v_cvt_pk_bf16_f32 v50,v84,v85
v_cvt_pk_bf16_f32 v51,v86,v87
v_mfma_f32_16x16x32_bf16 v[192:195],a[120:123],v[20:23],0
v_fma_f32 v93,v93,s36,v15
v_fma_f32 v94,v94,s36,v15
v_smfmac_f32_16x16x64_bf16 v[60:63],a[152:155],v[44:51],v18
v_fma_f32 v95,v95,s36,v15
v_mfma_f32_16x16x32_bf16 v[196:199],a[124:127],v[20:23],0
s_waitcnt vmcnt(36) lgkmcnt(0)
v_exp_f32 v92,v92
v_mfma_f32_16x16x32_bf16 v[244:247],a[124:127],v[24:27],0
s_barrier
v_mfma_f32_16x16x32_bf16 v[240:243],a[120:123],v[24:27],0
ds_read_b128 a[136:139],v0 offset:24576
v_fma_f32 v100,v100,s36,v16
v_mfma_f32_16x16x32_bf16 v[144:147],a[120:123],v[28:31],0
ds_read_b128 a[140:143],v1 offset:24576
v_fma_f32 v101,v101,s36,v16
v_mfma_f32_16x16x32_bf16 v[148:151],a[124:127],v[28:31],0
ds_read_b128 a[144:147],v0 offset:24704
v_fma_f32 v102,v102,s36,v16
v_mfma_f32_16x16x32_bf16 a[196:199],a[124:127],v[32:35],0
ds_read_b128 a[148:151],v1 offset:24704
v_fma_f32 v103,v103,s36,v16
v_mfma_f32_16x16x32_bf16 a[192:195],a[120:123],v[32:35],0
v_exp_f32 v93,v93
v_mfma_f32_16x16x32_bf16 a[240:243],a[120:123],v[36:39],0
buffer_load_dwordx4 v6,s[8:11],s21 offen offset:0 lds
v_mfma_f32_16x16x32_bf16 a[244:247],a[124:127],v[36:39],0
ds_read_b128 a[120:123],v0 offset:24832
v_cvt_pk_bf16_f32 v54,v92,v93
v_mfma_f32_16x16x32_bf16 a[248:251],a[128:131],v[36:39],0
ds_read_b128 a[124:127],v1 offset:24832
v_fma_f32 v108,v108,s36,v17
v_mfma_f32_16x16x32_bf16 a[252:255],a[132:135],v[36:39],0
v_exp_f32 v94,v94
v_mfma_f32_16x16x32_bf16 a[204:207],a[132:135],v[32:35],0
v_exp_f32 v95,v95
v_mfma_f32_16x16x32_bf16 a[200:203],a[128:131],v[32:35],0
v_cvt_pk_bf16_f32 v55,v94,v95
v_fma_f32 v109,v109,s36,v17
v_mfma_f32_16x16x32_bf16 v[152:155],a[128:131],v[28:31],0
v_exp_f32 v100,v100
v_mfma_f32_16x16x32_bf16 v[156:159],a[132:135],v[28:31],0
v_exp_f32 v101,v101
v_mfma_f32_16x16x32_bf16 v[252:255],a[132:135],v[24:27],0
v_exp_f32 v102,v102
v_mfma_f32_16x16x32_bf16 v[248:251],a[128:131],v[24:27],0
v_exp_f32 v103,v103
v_mfma_f32_16x16x32_bf16 v[200:203],a[128:131],v[20:23],0
ds_read_b128 a[128:131],v0 offset:30720
v_cvt_pk_bf16_f32 v58,v100,v101
v_mfma_f32_16x16x32_bf16 v[204:207],a[132:135],v[20:23],0
buffer_load_dwordx4 v7,s[8:11],s21 offen offset:1024 lds
s_waitcnt lgkmcnt(1)
v_mfma_f32_16x16x32_bf16 v[72:75],a[136:139],a[0:3],0
ds_read_b128 a[132:135],v1 offset:30720
v_cvt_pk_bf16_f32 v59,v102,v103
v_mfma_f32_16x16x32_bf16 v[72:75],a[140:143],a[4:7],v[72:75]
v_fma_f32 v110,v110,s36,v17
v_fma_f32 v111,v111,s36,v17
v_smfmac_f32_16x16x64_bf16 v[64:67],a[152:155],v[52:59],v18
v_mfma_f32_16x16x32_bf16 v[72:75],a[144:147],a[8:11],v[72:75]
v_exp_f32 v108,v108
v_mfma_f32_16x16x32_bf16 v[72:75],a[148:151],a[12:15],v[72:75]
v_exp_f32 v109,v109
v_mfma_f32_16x16x32_bf16 v[72:75],a[120:123],a[16:19],v[72:75]
v_exp_f32 v110,v110
v_mfma_f32_16x16x32_bf16 v[72:75],a[124:127],a[20:23],v[72:75]
v_exp_f32 v111,v111
v_mfma_f32_16x16x32_bf16 v[80:83],a[124:127],a[44:47],0
v_cvt_pk_bf16_f32 v42,v108,v109
v_cvt_pk_bf16_f32 v43,v110,v111
v_mfma_f32_16x16x32_bf16 v[80:83],a[120:123],a[40:43],v[80:83]
v_mfma_f32_16x16x32_bf16 v[80:83],a[148:151],a[36:39],v[80:83]
v_smfmac_f32_16x16x64_bf16 v[68:71],a[152:155],v[36:43],v18
buffer_load_dwordx4 v8,s[8:11],s21 offen offset:2048 lds
v_mfma_f32_16x16x32_bf16 v[80:83],a[144:147],a[32:35],v[80:83]
s_add_u32 s21,s21,12288
v_fma_f32 v72,v72,s36,v13
v_fma_f32 v73,v73,s36,v13
v_mfma_f32_16x16x32_bf16 v[80:83],a[140:143],a[28:31],v[80:83]
s_add_u32 m0,s22,12288
v_fma_f32 v74,v74,s36,v13
v_fma_f32 v75,v75,s36,v13
v_mfma_f32_16x16x32_bf16 v[80:83],a[136:139],a[24:27],v[80:83]
v_exp_f32 v72,v72
v_mfma_f32_16x16x32_bf16 v[88:91],a[136:139],a[48:51],0
v_exp_f32 v73,v73
v_mfma_f32_16x16x32_bf16 v[88:91],a[140:143],a[52:55],v[88:91]
v_exp_f32 v74,v74
v_mfma_f32_16x16x32_bf16 v[88:91],a[144:147],a[56:59],v[88:91]
v_exp_f32 v75,v75
v_mfma_f32_16x16x32_bf16 v[88:91],a[148:151],a[60:63],v[88:91]
v_fma_f32 v80,v80,s36,v14
v_fma_f32 v81,v81,s36,v14
v_mfma_f32_16x16x32_bf16 v[88:91],a[120:123],a[64:67],v[88:91]
v_fma_f32 v82,v82,s36,v14
v_fma_f32 v83,v83,s36,v14
v_mfma_f32_16x16x32_bf16 v[88:91],a[124:127],a[68:71],v[88:91]
v_exp_f32 v80,v80
v_mfma_f32_16x16x32_bf16 v[96:99],a[124:127],a[92:95],0
v_exp_f32 v81,v81
v_mfma_f32_16x16x32_bf16 v[96:99],a[120:123],a[88:91],v[96:99]
buffer_load_dwordx4 v6,s[4:7],s20 offen offset:0 lds
v_mfma_f32_16x16x32_bf16 v[96:99],a[148:151],a[84:87],v[96:99]
v_exp_f32 v82,v82
v_mfma_f32_16x16x32_bf16 v[96:99],a[144:147],a[80:83],v[96:99]
v_fma_f32 v88,v88,s36,v15
v_fma_f32 v89,v89,s36,v15
v_mfma_f32_16x16x32_bf16 v[96:99],a[140:143],a[76:79],v[96:99]
v_exp_f32 v83,v83
v_mfma_f32_16x16x32_bf16 v[96:99],a[136:139],a[72:75],v[96:99]
v_exp_f32 v88,v88
v_mfma_f32_16x16x32_bf16 v[104:107],a[136:139],a[96:99],0
ds_read_b128 a[136:139],v0 offset:30848
v_cvt_pk_bf16_f32 v20,v72,v73
v_mfma_f32_16x16x32_bf16 v[104:107],a[140:143],a[100:103],v[104:107]
ds_read_b128 a[140:143],v1 offset:30848
v_cvt_pk_bf16_f32 v21,v74,v75
v_mfma_f32_16x16x32_bf16 v[104:107],a[144:147],a[104:107],v[104:107]
ds_read_b128 a[144:147],v0 offset:30976
v_cvt_pk_bf16_f32 v24,v80,v81
v_mfma_f32_16x16x32_bf16 v[104:107],a[148:151],a[108:111],v[104:107]
ds_read_b128 a[148:151],v1 offset:30976
v_cvt_pk_bf16_f32 v25,v82,v83
v_mfma_f32_16x16x32_bf16 v[104:107],a[120:123],a[112:115],v[104:107]
v_exp_f32 v89,v89
v_mfma_f32_16x16x32_bf16 v[104:107],a[124:127],a[116:119],v[104:107]
s_waitcnt lgkmcnt(4)
v_cvt_pk_bf16_f32 v28,v88,v89
v_mfma_f32_16x16x32_bf16 v[76:79],a[128:131],a[0:3],0
v_mfma_f32_16x16x32_bf16 v[76:79],a[132:135],a[4:7],v[76:79]
buffer_load_dwordx4 v7,s[4:7],s20 offen offset:1024 lds
s_waitcnt lgkmcnt(3)
v_mfma_f32_16x16x32_bf16 v[76:79],a[136:139],a[8:11],v[76:79]
s_waitcnt lgkmcnt(2)
v_mfma_f32_16x16x32_bf16 v[76:79],a[140:143],a[12:15],v[76:79]
s_waitcnt lgkmcnt(1)
v_mfma_f32_16x16x32_bf16 v[76:79],a[144:147],a[16:19],v[76:79]
s_waitcnt lgkmcnt(0)
v_mfma_f32_16x16x32_bf16 v[76:79],a[148:151],a[20:23],v[76:79]
v_mfma_f32_16x16x32_bf16 v[84:87],a[148:151],a[44:47],0
v_mfma_f32_16x16x32_bf16 v[84:87],a[144:147],a[40:43],v[84:87]
v_mfma_f32_16x16x32_bf16 v[84:87],a[140:143],a[36:39],v[84:87]
v_mfma_f32_16x16x32_bf16 v[84:87],a[136:139],a[32:35],v[84:87]
v_mfma_f32_16x16x32_bf16 v[84:87],a[132:135],a[28:31],v[84:87]
v_mfma_f32_16x16x32_bf16 v[84:87],a[128:131],a[24:27],v[84:87]
v_mfma_f32_16x16x32_bf16 v[92:95],a[128:131],a[48:51],0
buffer_load_dwordx4 v8,s[4:7],s20 offen offset:2048 lds
v_mfma_f32_16x16x32_bf16 v[92:95],a[132:135],a[52:55],v[92:95]
s_add_u32 s20,s20,12288
v_mfma_f32_16x16x32_bf16 v[92:95],a[136:139],a[56:59],v[92:95]
v_mfma_f32_16x16x32_bf16 v[92:95],a[140:143],a[60:63],v[92:95]
v_mfma_f32_16x16x32_bf16 v[92:95],a[144:147],a[64:67],v[92:95]
v_mfma_f32_16x16x32_bf16 v[92:95],a[148:151],a[68:71],v[92:95]
ds_read_b64_tr_b16 a[120:121],v2 offset:12288
v_mfma_f32_16x16x32_bf16 v[100:103],a[148:151],a[92:95],0
ds_read_b64_tr_b16 a[122:123],v2 offset:18432
v_mfma_f32_16x16x32_bf16 v[100:103],a[144:147],a[88:91],v[100:103]
v_mfma_f32_16x16x32_bf16 v[100:103],a[140:143],a[84:87],v[100:103]
ds_read_b64_tr_b16 a[124:125],v3 offset:12288
v_mfma_f32_16x16x32_bf16 v[100:103],a[136:139],a[80:83],v[100:103]
ds_read_b64_tr_b16 a[126:127],v3 offset:18432
v_mfma_f32_16x16x32_bf16 v[100:103],a[132:135],a[76:79],v[100:103]
v_mfma_f32_16x16x32_bf16 v[100:103],a[128:131],a[72:75],v[100:103]
v_mfma_f32_16x16x32_bf16 v[108:111],a[128:131],a[96:99],0
ds_read_b64_tr_b16 a[128:129],v4 offset:12288
v_mfma_f32_16x16x32_bf16 v[108:111],a[132:135],a[100:103],v[108:111]
ds_read_b64_tr_b16 a[130:131],v4 offset:18432
v_mfma_f32_16x16x32_bf16 v[108:111],a[136:139],a[104:107],v[108:111]
ds_read_b64_tr_b16 a[132:133],v5 offset:12288
v_mfma_f32_16x16x32_bf16 v[108:111],a[140:143],a[108:111],v[108:111]
ds_read_b64_tr_b16 a[134:135],v5 offset:18432
v_mfma_f32_16x16x32_bf16 v[108:111],a[144:147],a[112:115],v[108:111]
v_mfma_f32_16x16x32_bf16 v[108:111],a[148:151],a[116:119],v[108:111]
s_waitcnt lgkmcnt(4)
v_mfma_f32_16x16x32_bf16 v[160:163],a[120:123],v[44:47],v[160:163]
s_add_u32 m0,s23,12288
ds_read_b64_tr_b16 a[136:137],v2 offset:12416
v_fma_f32 v90,v90,s36,v15
v_mfma_f32_16x16x32_bf16 v[164:167],a[124:127],v[44:47],v[164:167]
ds_read_b64_tr_b16 a[138:139],v2 offset:18560
v_fma_f32 v91,v91,s36,v15
v_mfma_f32_16x16x32_bf16 v[212:215],a[124:127],v[48:51],v[212:215]
ds_read_b64_tr_b16 a[140:141],v3 offset:12416
v_fma_f32 v96,v96,s36,v16
v_mfma_f32_16x16x32_bf16 v[208:211],a[120:123],v[48:51],v[208:211]
ds_read_b64_tr_b16 a[142:143],v3 offset:18560
v_fma_f32 v97,v97,s36,v16
v_mfma_f32_16x16x32_bf16 v[112:115],a[120:123],v[52:55],v[112:115]
ds_read_b64_tr_b16 a[144:145],v4 offset:12416
v_fma_f32 v98,v98,s36,v16
v_mfma_f32_16x16x32_bf16 v[116:119],a[124:127],v[52:55],v[116:119]
ds_read_b64_tr_b16 a[146:147],v4 offset:18560
v_fma_f32 v99,v99,s36,v16
v_mfma_f32_16x16x32_bf16 a[164:167],a[124:127],v[56:59],a[164:167]
ds_read_b64_tr_b16 a[148:149],v5 offset:12416
v_fma_f32 v104,v104,s36,v17
v_mfma_f32_16x16x32_bf16 a[160:163],a[120:123],v[56:59],a[160:163]
ds_read_b64_tr_b16 a[150:151],v5 offset:18560
v_fma_f32 v105,v105,s36,v17
v_mfma_f32_16x16x32_bf16 a[208:211],a[120:123],v[40:43],a[208:211]
ds_read_b64_tr_b16 a[120:121],v2 offset:12544
v_fma_f32 v106,v106,s36,v17
v_mfma_f32_16x16x32_bf16 a[212:215],a[124:127],v[40:43],a[212:215]
s_waitcnt lgkmcnt(6)
ds_read_b64_tr_b16 a[122:123],v2 offset:18688
v_fma_f32 v107,v107,s36,v17
v_mfma_f32_16x16x32_bf16 a[216:219],a[128:131],v[40:43],a[216:219]
ds_read_b64_tr_b16 a[124:125],v3 offset:12544
v_fma_f32 v76,v76,s36,v13
v_mfma_f32_16x16x32_bf16 a[220:223],a[132:135],v[40:43],a[220:223]
ds_read_b64_tr_b16 a[126:127],v3 offset:18688
v_fma_f32 v77,v77,s36,v13
v_mfma_f32_16x16x32_bf16 a[172:175],a[132:135],v[56:59],a[172:175]
v_exp_f32 v90,v90
v_mfma_f32_16x16x32_bf16 a[168:171],a[128:131],v[56:59],a[168:171]
v_exp_f32 v91,v91
v_mfma_f32_16x16x32_bf16 v[120:123],a[128:131],v[52:55],v[120:123]
v_cvt_pk_bf16_f32 v29,v90,v91
v_fma_f32 v78,v78,s36,v13
v_mfma_f32_16x16x32_bf16 v[124:127],a[132:135],v[52:55],v[124:127]
v_exp_f32 v96,v96
v_mfma_f32_16x16x32_bf16 v[220:223],a[132:135],v[48:51],v[220:223]
v_exp_f32 v97,v97
v_mfma_f32_16x16x32_bf16 v[216:219],a[128:131],v[48:51],v[216:219]
v_exp_f32 v98,v98
v_mfma_f32_16x16x32_bf16 v[168:171],a[128:131],v[44:47],v[168:171]
ds_read_b64_tr_b16 a[128:129],v4 offset:12544
v_cvt_pk_bf16_f32 v32,v96,v97
v_mfma_f32_16x16x32_bf16 v[172:175],a[132:135],v[44:47],v[172:175]
ds_read_b64_tr_b16 a[130:131],v4 offset:18688
v_fma_f32 v79,v79,s36,v13
v_mfma_f32_16x16x32_bf16 v[176:179],a[136:139],v[44:47],v[176:179]
s_waitcnt lgkmcnt(2)
ds_read_b64_tr_b16 a[132:133],v5 offset:12544
v_fma_f32 v84,v84,s36,v14
v_mfma_f32_16x16x32_bf16 v[180:183],a[140:143],v[44:47],v[180:183]
ds_read_b64_tr_b16 a[134:135],v5 offset:18688
v_fma_f32 v85,v85,s36,v14
v_mfma_f32_16x16x32_bf16 v[228:231],a[140:143],v[48:51],v[228:231]
v_exp_f32 v99,v99
v_mfma_f32_16x16x32_bf16 v[224:227],a[136:139],v[48:51],v[224:227]
v_cvt_pk_bf16_f32 v33,v98,v99
v_fma_f32 v86,v86,s36,v14
v_mfma_f32_16x16x32_bf16 v[128:131],a[136:139],v[52:55],v[128:131]
v_exp_f32 v104,v104
v_mfma_f32_16x16x32_bf16 v[132:135],a[140:143],v[52:55],v[132:135]
v_exp_f32 v105,v105
v_mfma_f32_16x16x32_bf16 a[180:183],a[140:143],v[56:59],a[180:183]
v_exp_f32 v106,v106
v_mfma_f32_16x16x32_bf16 a[176:179],a[136:139],v[56:59],a[176:179]
v_exp_f32 v107,v107
v_mfma_f32_16x16x32_bf16 a[224:227],a[136:139],v[40:43],a[224:227]
v_cvt_pk_bf16_f32 v36,v104,v105
v_cvt_pk_bf16_f32 v37,v106,v107
v_mfma_f32_16x16x32_bf16 a[228:231],a[140:143],v[40:43],a[228:231]
v_exp_f32 v76,v76
v_mfma_f32_16x16x32_bf16 a[232:235],a[144:147],v[40:43],a[232:235]
v_exp_f32 v77,v77
v_mfma_f32_16x16x32_bf16 a[236:239],a[148:151],v[40:43],a[236:239]
v_exp_f32 v78,v78
v_mfma_f32_16x16x32_bf16 a[188:191],a[148:151],v[56:59],a[188:191]
v_exp_f32 v79,v79
v_mfma_f32_16x16x32_bf16 a[184:187],a[144:147],v[56:59],a[184:187]
v_cvt_pk_bf16_f32 v22,v76,v77
v_cvt_pk_bf16_f32 v23,v78,v79
v_mfma_f32_16x16x32_bf16 v[136:139],a[144:147],v[52:55],v[136:139]
v_fma_f32 v87,v87,s36,v14
v_fma_f32 v92,v92,s36,v15
v_mfma_f32_16x16x32_bf16 v[140:143],a[148:151],v[52:55],v[140:143]
v_exp_f32 v84,v84
v_mfma_f32_16x16x32_bf16 v[236:239],a[148:151],v[48:51],v[236:239]
v_exp_f32 v85,v85
v_mfma_f32_16x16x32_bf16 v[232:235],a[144:147],v[48:51],v[232:235]
v_exp_f32 v86,v86
v_mfma_f32_16x16x32_bf16 v[184:187],a[144:147],v[44:47],v[184:187]
v_exp_f32 v87,v87
v_mfma_f32_16x16x32_bf16 v[188:191],a[148:151],v[44:47],v[188:191]
v_cvt_pk_bf16_f32 v26,v84,v85
v_cvt_pk_bf16_f32 v27,v86,v87
v_mfma_f32_16x16x32_bf16 v[192:195],a[120:123],v[44:47],v[192:195]
v_fma_f32 v93,v93,s36,v15
v_fma_f32 v94,v94,s36,v15
v_smfmac_f32_16x16x64_bf16 v[60:63],a[152:155],v[20:27],v18
v_fma_f32 v95,v95,s36,v15
v_mfma_f32_16x16x32_bf16 v[196:199],a[124:127],v[44:47],v[196:199]
s_waitcnt vmcnt(6) lgkmcnt(0)
v_exp_f32 v92,v92
v_mfma_f32_16x16x32_bf16 v[244:247],a[124:127],v[48:51],v[244:247]
s_barrier
v_mfma_f32_16x16x32_bf16 v[240:243],a[120:123],v[48:51],v[240:243]
ds_read_b128 a[136:139],v0 offset:0
v_fma_f32 v100,v100,s36,v16
v_mfma_f32_16x16x32_bf16 v[144:147],a[120:123],v[52:55],v[144:147]
ds_read_b128 a[140:143],v1 offset:0
v_fma_f32 v101,v101,s36,v16
v_mfma_f32_16x16x32_bf16 v[148:151],a[124:127],v[52:55],v[148:151]
ds_read_b128 a[144:147],v0 offset:128
v_fma_f32 v102,v102,s36,v16
v_mfma_f32_16x16x32_bf16 a[196:199],a[124:127],v[56:59],a[196:199]
ds_read_b128 a[148:151],v1 offset:128
v_fma_f32 v103,v103,s36,v16
v_mfma_f32_16x16x32_bf16 a[192:195],a[120:123],v[56:59],a[192:195]
v_exp_f32 v93,v93
v_mfma_f32_16x16x32_bf16 a[240:243],a[120:123],v[40:43],a[240:243]
buffer_load_dwordx4 v6,s[8:11],s21 offen offset:0 lds
v_mfma_f32_16x16x32_bf16 a[244:247],a[124:127],v[40:43],a[244:247]
ds_read_b128 a[120:123],v0 offset:256
v_cvt_pk_bf16_f32 v30,v92,v93
v_mfma_f32_16x16x32_bf16 a[248:251],a[128:131],v[40:43],a[248:251]
ds_read_b128 a[124:127],v1 offset:256
v_fma_f32 v108,v108,s36,v17
v_mfma_f32_16x16x32_bf16 a[252:255],a[132:135],v[40:43],a[252:255]
v_exp_f32 v94,v94
v_mfma_f32_16x16x32_bf16 a[204:207],a[132:135],v[56:59],a[204:207]
v_exp_f32 v95,v95
v_mfma_f32_16x16x32_bf16 a[200:203],a[128:131],v[56:59],a[200:203]
v_cvt_pk_bf16_f32 v31,v94,v95
v_fma_f32 v109,v109,s36,v17
v_mfma_f32_16x16x32_bf16 v[152:155],a[128:131],v[52:55],v[152:155]
v_exp_f32 v100,v100
v_mfma_f32_16x16x32_bf16 v[156:159],a[132:135],v[52:55],v[156:159]
v_exp_f32 v101,v101
v_mfma_f32_16x16x32_bf16 v[252:255],a[132:135],v[48:51],v[252:255]
v_exp_f32 v102,v102
v_mfma_f32_16x16x32_bf16 v[248:251],a[128:131],v[48:51],v[248:251]
v_exp_f32 v103,v103
v_mfma_f32_16x16x32_bf16 v[200:203],a[128:131],v[44:47],v[200:203]
ds_read_b128 a[128:131],v0 offset:6144
v_cvt_pk_bf16_f32 v34,v100,v101
v_mfma_f32_16x16x32_bf16 v[204:207],a[132:135],v[44:47],v[204:207]
buffer_load_dwordx4 v7,s[8:11],s21 offen offset:1024 lds
s_waitcnt lgkmcnt(1)
v_mfma_f32_16x16x32_bf16 v[72:75],a[136:139],a[0:3],0
ds_read_b128 a[132:135],v1 offset:6144
v_cvt_pk_bf16_f32 v35,v102,v103
v_mfma_f32_16x16x32_bf16 v[72:75],a[140:143],a[4:7],v[72:75]
v_fma_f32 v110,v110,s36,v17
v_fma_f32 v111,v111,s36,v17
v_smfmac_f32_16x16x64_bf16 v[64:67],a[152:155],v[28:35],v18
v_mfma_f32_16x16x32_bf16 v[72:75],a[144:147],a[8:11],v[72:75]
v_exp_f32 v108,v108
v_mfma_f32_16x16x32_bf16 v[72:75],a[148:151],a[12:15],v[72:75]
v_exp_f32 v109,v109
v_mfma_f32_16x16x32_bf16 v[72:75],a[120:123],a[16:19],v[72:75]
v_exp_f32 v110,v110
v_mfma_f32_16x16x32_bf16 v[72:75],a[124:127],a[20:23],v[72:75]
v_exp_f32 v111,v111
v_mfma_f32_16x16x32_bf16 v[80:83],a[124:127],a[44:47],0
v_cvt_pk_bf16_f32 v38,v108,v109
v_cvt_pk_bf16_f32 v39,v110,v111
v_mfma_f32_16x16x32_bf16 v[80:83],a[120:123],a[40:43],v[80:83]
v_mfma_f32_16x16x32_bf16 v[80:83],a[148:151],a[36:39],v[80:83]
v_mfma_f32_16x16x32_bf16 v[80:83],a[144:147],a[32:35],v[80:83]
buffer_load_dwordx4 v8,s[8:11],s21 offen offset:2048 lds
v_mfma_f32_16x16x32_bf16 v[80:83],a[140:143],a[28:31],v[80:83]
s_add_u32 s21,s21,12288
v_fma_f32 v72,v72,s36,v13
v_fma_f32 v73,v73,s36,v13
v_mfma_f32_16x16x32_bf16 v[80:83],a[136:139],a[24:27],v[80:83]
s_add_u32 m0,s22,24576
v_fma_f32 v74,v74,s36,v13
v_fma_f32 v75,v75,s36,v13
v_mfma_f32_16x16x32_bf16 v[88:91],a[136:139],a[48:51],0
v_exp_f32 v72,v72
v_mfma_f32_16x16x32_bf16 v[88:91],a[140:143],a[52:55],v[88:91]
v_exp_f32 v73,v73
v_mfma_f32_16x16x32_bf16 v[88:91],a[144:147],a[56:59],v[88:91]
v_fma_f32 v80,v80,s36,v14
v_fma_f32 v81,v81,s36,v14
v_mfma_f32_16x16x32_bf16 v[88:91],a[148:151],a[60:63],v[88:91]
v_fma_f32 v82,v82,s36,v14
v_fma_f32 v83,v83,s36,v14
v_mfma_f32_16x16x32_bf16 v[88:91],a[120:123],a[64:67],v[88:91]
v_exp_f32 v74,v74
v_mfma_f32_16x16x32_bf16 v[88:91],a[124:127],a[68:71],v[88:91]
v_exp_f32 v75,v75
v_mfma_f32_16x16x32_bf16 v[96:99],a[124:127],a[92:95],0
v_exp_f32 v80,v80
v_mfma_f32_16x16x32_bf16 v[96:99],a[120:123],a[88:91],v[96:99]
v_exp_f32 v81,v81
v_mfma_f32_16x16x32_bf16 v[96:99],a[148:151],a[84:87],v[96:99]
v_exp_f32 v82,v82
v_mfma_f32_16x16x32_bf16 v[96:99],a[144:147],a[80:83],v[96:99]
buffer_load_dwordx4 v6,s[4:7],s20 offen offset:0 lds
v_mfma_f32_16x16x32_bf16 v[96:99],a[140:143],a[76:79],v[96:99]
v_fma_f32 v88,v88,s36,v15
v_fma_f32 v89,v89,s36,v15
v_mfma_f32_16x16x32_bf16 v[96:99],a[136:139],a[72:75],v[96:99]
v_exp_f32 v83,v83
v_mfma_f32_16x16x32_bf16 v[104:107],a[136:139],a[96:99],0
ds_read_b128 a[136:139],v0 offset:6272
v_cvt_pk_bf16_f32 v44,v72,v73
v_mfma_f32_16x16x32_bf16 v[104:107],a[140:143],a[100:103],v[104:107]
ds_read_b128 a[140:143],v1 offset:6272
v_cvt_pk_bf16_f32 v45,v74,v75
v_mfma_f32_16x16x32_bf16 v[104:107],a[144:147],a[104:107],v[104:107]
ds_read_b128 a[144:147],v0 offset:6400
v_cvt_pk_bf16_f32 v48,v80,v81
v_mfma_f32_16x16x32_bf16 v[104:107],a[148:151],a[108:111],v[104:107]
ds_read_b128 a[148:151],v1 offset:6400
v_cvt_pk_bf16_f32 v49,v82,v83
v_mfma_f32_16x16x32_bf16 v[104:107],a[120:123],a[112:115],v[104:107]
v_exp_f32 v88,v88
v_mfma_f32_16x16x32_bf16 v[104:107],a[124:127],a[116:119],v[104:107]
s_waitcnt lgkmcnt(4)
v_exp_f32 v89,v89
v_mfma_f32_16x16x32_bf16 v[76:79],a[128:131],a[0:3],0
v_cvt_pk_bf16_f32 v52,v88,v89
v_mfma_f32_16x16x32_bf16 v[76:79],a[132:135],a[4:7],v[76:79]
s_waitcnt lgkmcnt(3)
v_mfma_f32_16x16x32_bf16 v[76:79],a[136:139],a[8:11],v[76:79]
buffer_load_dwordx4 v7,s[4:7],s20 offen offset:1024 lds
s_waitcnt lgkmcnt(2)
v_mfma_f32_16x16x32_bf16 v[76:79],a[140:143],a[12:15],v[76:79]
s_waitcnt lgkmcnt(1)
v_mfma_f32_16x16x32_bf16 v[76:79],a[144:147],a[16:19],v[76:79]
s_waitcnt lgkmcnt(0)
v_mfma_f32_16x16x32_bf16 v[76:79],a[148:151],a[20:23],v[76:79]
v_mfma_f32_16x16x32_bf16 v[84:87],a[148:151],a[44:47],0
v_mfma_f32_16x16x32_bf16 v[84:87],a[144:147],a[40:43],v[84:87]
v_mfma_f32_16x16x32_bf16 v[84:87],a[140:143],a[36:39],v[84:87]
v_mfma_f32_16x16x32_bf16 v[84:87],a[136:139],a[32:35],v[84:87]
v_mfma_f32_16x16x32_bf16 v[84:87],a[132:135],a[28:31],v[84:87]
v_mfma_f32_16x16x32_bf16 v[84:87],a[128:131],a[24:27],v[84:87]
v_mfma_f32_16x16x32_bf16 v[92:95],a[128:131],a[48:51],0
v_mfma_f32_16x16x32_bf16 v[92:95],a[132:135],a[52:55],v[92:95]
buffer_load_dwordx4 v8,s[4:7],s20 offen offset:2048 lds
v_mfma_f32_16x16x32_bf16 v[92:95],a[136:139],a[56:59],v[92:95]
s_add_u32 s20,s20,12288
v_mfma_f32_16x16x32_bf16 v[92:95],a[140:143],a[60:63],v[92:95]
v_mfma_f32_16x16x32_bf16 v[92:95],a[144:147],a[64:67],v[92:95]
v_mfma_f32_16x16x32_bf16 v[92:95],a[148:151],a[68:71],v[92:95]
v_mfma_f32_16x16x32_bf16 v[100:103],a[148:151],a[92:95],0
v_mfma_f32_16x16x32_bf16 v[100:103],a[144:147],a[88:91],v[100:103]
ds_read_b64_tr_b16 a[120:121],v2 offset:24576
v_mfma_f32_16x16x32_bf16 v[100:103],a[140:143],a[84:87],v[100:103]
ds_read_b64_tr_b16 a[122:123],v2 offset:30720
v_mfma_f32_16x16x32_bf16 v[100:103],a[136:139],a[80:83],v[100:103]
ds_read_b64_tr_b16 a[124:125],v3 offset:24576
v_mfma_f32_16x16x32_bf16 v[100:103],a[132:135],a[76:79],v[100:103]
ds_read_b64_tr_b16 a[126:127],v3 offset:30720
v_mfma_f32_16x16x32_bf16 v[100:103],a[128:131],a[72:75],v[100:103]
v_mfma_f32_16x16x32_bf16 v[108:111],a[128:131],a[96:99],0
ds_read_b64_tr_b16 a[128:129],v4 offset:24576
v_mfma_f32_16x16x32_bf16 v[108:111],a[132:135],a[100:103],v[108:111]
ds_read_b64_tr_b16 a[130:131],v4 offset:30720
v_mfma_f32_16x16x32_bf16 v[108:111],a[136:139],a[104:107],v[108:111]
ds_read_b64_tr_b16 a[132:133],v5 offset:24576
v_mfma_f32_16x16x32_bf16 v[108:111],a[140:143],a[108:111],v[108:111]
ds_read_b64_tr_b16 a[134:135],v5 offset:30720
v_mfma_f32_16x16x32_bf16 v[108:111],a[144:147],a[112:115],v[108:111]
v_mfma_f32_16x16x32_bf16 v[108:111],a[148:151],a[116:119],v[108:111]
s_mov_b32 s38,0
s_branch L_loop5
L_loop4:
.p2align 6
L_loop4w0:
s_waitcnt lgkmcnt(3)
v_mfma_f32_16x16x32_bf16 v[160:163],a[120:123],v[20:23],v[160:163]
s_add_u32 m0,s23,24576
ds_read_b64_tr_b16 a[142:143],v3 offset:30848
v_fma_f32 v83,v83,s36,v14
v_mfma_f32_16x16x32_bf16 v[164:167],a[124:127],v[20:23],v[164:167]
ds_read_b64_tr_b16 a[138:139],v2 offset:30848
v_fma_f32 v82,v82,s36,v14
v_mfma_f32_16x16x32_bf16 v[212:215],a[124:127],v[24:27],v[212:215]
ds_read_b64_tr_b16 a[136:137],v2 offset:24704
v_fma_f32 v88,v88,s36,v15
v_mfma_f32_16x16x32_bf16 v[208:211],a[120:123],v[24:27],v[208:211]
ds_read_b64_tr_b16 a[140:141],v3 offset:24704
v_fma_f32 v91,v91,s36,v15
v_mfma_f32_16x16x32_bf16 v[112:115],a[120:123],v[28:31],v[112:115]
ds_read_b64_tr_b16 a[146:147],v4 offset:30848
v_fma_f32 v89,v89,s36,v15
v_mfma_f32_16x16x32_bf16 v[116:119],a[124:127],v[28:31],v[116:119]
ds_read_b64_tr_b16 a[150:151],v5 offset:30848
v_fma_f32 v90,v90,s36,v15
v_mfma_f32_16x16x32_bf16 a[164:167],a[124:127],v[32:35],a[164:167]
ds_read_b64_tr_b16 a[144:145],v4 offset:24704
v_fma_f32 v96,v96,s36,v16
v_mfma_f32_16x16x32_bf16 a[160:163],a[120:123],v[32:35],a[160:163]
s_waitcnt lgkmcnt(6)
ds_read_b64_tr_b16 a[148:149],v5 offset:24704
v_fma_f32 v98,v98,s36,v16
v_mfma_f32_16x16x32_bf16 a[168:171],a[128:131],v[32:35],a[168:171]
ds_read_b64_tr_b16 a[120:121],v2 offset:24832
v_fma_f32 v99,v99,s36,v16
v_mfma_f32_16x16x32_bf16 a[172:175],a[132:135],v[32:35],a[172:175]
ds_read_b64_tr_b16 a[126:127],v3 offset:30976
v_fma_f32 v97,v97,s36,v16
v_mfma_f32_16x16x32_bf16 v[124:127],a[132:135],v[28:31],v[124:127]
ds_read_b64_tr_b16 a[122:123],v2 offset:30976
v_fma_f32 v79,v79,s36,v13
v_mfma_f32_16x16x32_bf16 v[120:123],a[128:131],v[28:31],v[120:123]
ds_read_b64_tr_b16 a[124:125],v3 offset:24832
v_fma_f32 v77,v77,s36,v13
v_mfma_f32_16x16x32_bf16 v[216:219],a[128:131],v[24:27],v[216:219]
v_exp_f32 v82,v82
v_mfma_f32_16x16x32_bf16 v[220:223],a[132:135],v[24:27],v[220:223]
v_exp_f32 v83,v83
v_mfma_f32_16x16x32_bf16 v[172:175],a[132:135],v[20:23],v[172:175]
ds_read_b64_tr_b16 a[132:133],v5 offset:24832
v_cvt_pk_bf16_f32 v49,v82,v83
v_mfma_f32_16x16x32_bf16 v[168:171],a[128:131],v[20:23],v[168:171]
s_waitcnt lgkmcnt(4)
ds_read_b64_tr_b16 a[134:135],v5 offset:30976
v_fma_f32 v76,v76,s36,v13
v_mfma_f32_16x16x32_bf16 v[176:179],a[136:139],v[20:23],v[176:179]
ds_read_b64_tr_b16 a[128:129],v4 offset:24832
v_fma_f32 v78,v78,s36,v13
v_mfma_f32_16x16x32_bf16 v[180:183],a[140:143],v[20:23],v[180:183]
ds_read_b64_tr_b16 a[130:131],v4 offset:30976
v_fma_f32 v86,v86,s36,v14
v_mfma_f32_16x16x32_bf16 v[228:231],a[140:143],v[24:27],v[228:231]
v_exp_f32 v90,v90
v_mfma_f32_16x16x32_bf16 v[224:227],a[136:139],v[24:27],v[224:227]
v_exp_f32 v88,v88
v_mfma_f32_16x16x32_bf16 v[128:131],a[136:139],v[28:31],v[128:131]
v_exp_f32 v89,v89
v_mfma_f32_16x16x32_bf16 v[132:135],a[140:143],v[28:31],v[132:135]
v_cvt_pk_bf16_f32 v52,v88,v89
v_fma_f32 v84,v84,s36,v14
v_mfma_f32_16x16x32_bf16 a[180:183],a[140:143],v[32:35],a[180:183]
v_exp_f32 v91,v91
v_mfma_f32_16x16x32_bf16 a[176:179],a[136:139],v[32:35],a[176:179]
v_cvt_pk_bf16_f32 v53,v90,v91
v_fma_f32 v85,v85,s36,v14
v_mfma_f32_16x16x32_bf16 a[184:187],a[144:147],v[32:35],a[184:187]
v_exp_f32 v99,v99
v_mfma_f32_16x16x32_bf16 a[188:191],a[148:151],v[32:35],a[188:191]
v_exp_f32 v97,v97
v_mfma_f32_16x16x32_bf16 v[140:143],a[148:151],v[28:31],v[140:143]
v_exp_f32 v96,v96
v_mfma_f32_16x16x32_bf16 v[136:139],a[144:147],v[28:31],v[136:139]
v_cvt_pk_bf16_f32 v56,v96,v97
v_fma_f32 v87,v87,s36,v14
v_mfma_f32_16x16x32_bf16 v[232:235],a[144:147],v[24:27],v[232:235]
v_exp_f32 v98,v98
v_mfma_f32_16x16x32_bf16 v[236:239],a[148:151],v[24:27],v[236:239]
v_cvt_pk_bf16_f32 v57,v98,v99
v_fma_f32 v94,v94,s36,v15
v_mfma_f32_16x16x32_bf16 v[188:191],a[148:151],v[20:23],v[188:191]
v_exp_f32 v76,v76
v_mfma_f32_16x16x32_bf16 v[184:187],a[144:147],v[20:23],v[184:187]
s_waitcnt lgkmcnt(0)
v_exp_f32 v79,v79
v_mfma_f32_16x16x32_bf16 v[192:195],a[120:123],v[20:23],v[192:195]
v_exp_f32 v78,v78
v_mfma_f32_16x16x32_bf16 v[196:199],a[124:127],v[20:23],v[196:199]
s_waitcnt vmcnt(6)
ds_read_b128 a[156:159],v10 offset:0
v_cvt_pk_bf16_f32 v47,v78,v79
v_mfma_f32_16x16x32_bf16 v[244:247],a[124:127],v[24:27],v[244:247]
s_barrier
v_mfma_f32_16x16x32_bf16 v[240:243],a[120:123],v[24:27],v[240:243]
ds_read_b128 a[148:151],v1 offset:12416
v_fma_f32 v92,v92,s36,v15
v_mfma_f32_16x16x32_bf16 v[144:147],a[120:123],v[28:31],v[144:147]
ds_read_b128 a[144:147],v0 offset:12416
v_fma_f32 v93,v93,s36,v15
v_mfma_f32_16x16x32_bf16 v[148:151],a[124:127],v[28:31],v[148:151]
ds_read_b128 a[140:143],v1 offset:12288
v_fma_f32 v95,v95,s36,v15
v_mfma_f32_16x16x32_bf16 a[196:199],a[124:127],v[32:35],a[196:199]
ds_read_b128 a[124:127],v1 offset:12544
v_fma_f32 v102,v102,s36,v16
v_mfma_f32_16x16x32_bf16 a[192:195],a[120:123],v[32:35],a[192:195]
ds_read_b128 a[120:123],v0 offset:12544
v_fma_f32 v100,v100,s36,v16
v_mfma_f32_16x16x32_bf16 a[200:203],a[128:131],v[32:35],a[200:203]
buffer_load_dwordx4 v6,s[8:11],s21 offen offset:0 lds
v_mfma_f32_16x16x32_bf16 a[204:207],a[132:135],v[32:35],a[204:207]
ds_read_b128 a[136:139],v0 offset:12288
v_fma_f32 v101,v101,s36,v16
v_mfma_f32_16x16x32_bf16 v[156:159],a[132:135],v[28:31],v[156:159]
v_exp_f32 v77,v77
v_mfma_f32_16x16x32_bf16 v[152:155],a[128:131],v[28:31],v[152:155]
v_cvt_pk_bf16_f32 v46,v76,v77
v_fma_f32 v103,v103,s36,v16
v_mfma_f32_16x16x32_bf16 v[248:251],a[128:131],v[24:27],v[248:251]
v_exp_f32 v86,v86
v_mfma_f32_16x16x32_bf16 v[252:255],a[132:135],v[24:27],v[252:255]
v_exp_f32 v87,v87
v_mfma_f32_16x16x32_bf16 v[204:207],a[132:135],v[20:23],v[204:207]
ds_read_b128 a[132:135],v1 offset:18432
v_cvt_pk_bf16_f32 v51,v86,v87
v_mfma_f32_16x16x32_bf16 v[200:203],a[128:131],v[20:23],v[200:203]
s_waitcnt lgkmcnt(2)
ds_read_b128 a[128:131],v0 offset:18432
v_mfma_f32_16x16x32_bf16 v[72:75],a[124:127],a[20:23],0
v_exp_f32 v85,v85
v_mfma_f32_16x16x32_bf16 v[72:75],a[120:123],a[16:19],v[72:75]
buffer_store_dwordx4 a[156:159],v9,s[16:19],s27 offen offset:0 nt
buffer_load_dwordx4 v7,s[8:11],s21 offen offset:1024 lds
v_mfma_f32_16x16x32_bf16 v[72:75],a[148:151],a[12:15],v[72:75]
ds_read_b128 a[156:159],v10 offset:1024
v_mfma_f32_16x16x32_bf16 v[72:75],a[144:147],a[8:11],v[72:75]
v_exp_f32 v84,v84
v_mfma_f32_16x16x32_bf16 v[72:75],a[140:143],a[4:7],v[72:75]
s_waitcnt lgkmcnt(3)
v_cvt_pk_bf16_f32 v50,v84,v85
v_mfma_f32_16x16x32_bf16 v[72:75],a[136:139],a[0:3],v[72:75]
v_exp_f32 v93,v93
v_smfmac_f32_16x16x64_bf16 v[60:63],a[152:155],v[44:51],v18
v_mfma_f32_16x16x32_bf16 v[80:83],a[136:139],a[24:27],0
v_exp_f32 v94,v94
v_mfma_f32_16x16x32_bf16 v[80:83],a[140:143],a[28:31],v[80:83]
v_exp_f32 v92,v92
v_mfma_f32_16x16x32_bf16 v[80:83],a[144:147],a[32:35],v[80:83]
buffer_load_dwordx4 v8,s[8:11],s21 offen offset:2048 lds
v_mfma_f32_16x16x32_bf16 v[80:83],a[148:151],a[36:39],v[80:83]
s_add_u32 s21,s21,12288
v_cvt_pk_bf16_f32 v54,v92,v93
v_fma_f32 v72,v72,s36,v13
v_mfma_f32_16x16x32_bf16 v[80:83],a[120:123],a[40:43],v[80:83]
s_add_u32 m0,s22,0
v_exp_f32 v95,v95
v_mfma_f32_16x16x32_bf16 v[80:83],a[124:127],a[44:47],v[80:83]
v_cvt_pk_bf16_f32 v55,v94,v95
v_fma_f32 v75,v75,s36,v13
v_mfma_f32_16x16x32_bf16 v[88:91],a[124:127],a[68:71],0
v_exp_f32 v103,v103
v_mfma_f32_16x16x32_bf16 v[88:91],a[120:123],a[64:67],v[88:91]
v_exp_f32 v100,v100
v_mfma_f32_16x16x32_bf16 v[88:91],a[148:151],a[60:63],v[88:91]
v_exp_f32 v102,v102
v_mfma_f32_16x16x32_bf16 v[88:91],a[144:147],a[56:59],v[88:91]
v_cvt_pk_bf16_f32 v59,v102,v103
v_fma_f32 v80,v80,s36,v14
v_mfma_f32_16x16x32_bf16 v[88:91],a[140:143],a[52:55],v[88:91]
v_exp_f32 v101,v101
v_mfma_f32_16x16x32_bf16 v[88:91],a[136:139],a[48:51],v[88:91]
s_waitcnt lgkmcnt(0)
buffer_store_dwordx4 a[156:159],v9,s[16:19],s27 offen offset:128 nt
buffer_load_dwordx4 v6,s[4:7],s20 offen offset:0 lds
v_mfma_f32_16x16x32_bf16 v[96:99],a[136:139],a[72:75],0
ds_read_b128 a[156:159],v10 offset:2048
v_cvt_pk_bf16_f32 v58,v100,v101
v_mfma_f32_16x16x32_bf16 v[96:99],a[140:143],a[76:79],v[96:99]
ds_read_b128 a[136:139],v0 offset:18560
v_fma_f32 v81,v81,s36,v14
v_smfmac_f32_16x16x64_bf16 v[64:67],a[152:155],v[52:59],v18
ds_read_b128 a[140:143],v1 offset:18560
v_mfma_f32_16x16x32_bf16 v[96:99],a[144:147],a[80:83],v[96:99]
ds_read_b128 a[144:147],v0 offset:18688
v_mfma_f32_16x16x32_bf16 v[96:99],a[148:151],a[84:87],v[96:99]
ds_read_b128 a[148:151],v1 offset:18688
v_mfma_f32_16x16x32_bf16 v[96:99],a[120:123],a[88:91],v[96:99]
v_fma_f32 v73,v73,s36,v13
v_fma_f32 v74,v74,s36,v13
v_mfma_f32_16x16x32_bf16 v[96:99],a[124:127],a[92:95],v[96:99]
v_exp_f32 v74,v74
v_mfma_f32_16x16x32_bf16 v[76:79],a[128:131],a[0:3],0
buffer_load_dwordx4 v7,s[4:7],s20 offen offset:1024 lds
v_mfma_f32_16x16x32_bf16 v[76:79],a[132:135],a[4:7],v[76:79]
s_waitcnt lgkmcnt(3)
v_exp_f32 v75,v75
v_mfma_f32_16x16x32_bf16 v[76:79],a[136:139],a[8:11],v[76:79]
s_waitcnt lgkmcnt(2)
v_cvt_pk_bf16_f32 v21,v74,v75
v_mfma_f32_16x16x32_bf16 v[76:79],a[140:143],a[12:15],v[76:79]
s_waitcnt lgkmcnt(1)
v_exp_f32 v73,v73
v_mfma_f32_16x16x32_bf16 v[76:79],a[144:147],a[16:19],v[76:79]
s_waitcnt lgkmcnt(0)
v_exp_f32 v80,v80
v_mfma_f32_16x16x32_bf16 v[76:79],a[148:151],a[20:23],v[76:79]
v_exp_f32 v81,v81
v_mfma_f32_16x16x32_bf16 v[84:87],a[148:151],a[44:47],0
v_cvt_pk_bf16_f32 v24,v80,v81
v_mfma_f32_16x16x32_bf16 v[84:87],a[144:147],a[40:43],v[84:87]
v_exp_f32 v72,v72
v_mfma_f32_16x16x32_bf16 v[84:87],a[140:143],a[36:39],v[84:87]
v_cvt_pk_bf16_f32 v20,v72,v73
v_mfma_f32_16x16x32_bf16 v[84:87],a[136:139],a[32:35],v[84:87]
buffer_store_dwordx4 a[156:159],v9,s[16:19],s27 offen offset:256 nt
buffer_load_dwordx4 v8,s[4:7],s20 offen offset:2048 lds
v_mfma_f32_16x16x32_bf16 v[84:87],a[132:135],a[28:31],v[84:87]
s_add_u32 s20,s20,12288
ds_read_b64_tr_b16 a[122:123],v2 offset:6144
v_mfma_f32_16x16x32_bf16 v[84:87],a[128:131],a[24:27],v[84:87]
s_add_u32 s27,s27,3072
ds_read_b64_tr_b16 a[120:121],v2 offset:0
v_mfma_f32_16x16x32_bf16 v[92:95],a[128:131],a[48:51],0
ds_read_b64_tr_b16 a[124:125],v3 offset:0
v_mfma_f32_16x16x32_bf16 v[92:95],a[132:135],a[52:55],v[92:95]
ds_read_b64_tr_b16 a[126:127],v3 offset:6144
v_mfma_f32_16x16x32_bf16 v[92:95],a[136:139],a[56:59],v[92:95]
v_mfma_f32_16x16x32_bf16 v[92:95],a[140:143],a[60:63],v[92:95]
v_mfma_f32_16x16x32_bf16 v[92:95],a[144:147],a[64:67],v[92:95]
v_mfma_f32_16x16x32_bf16 v[92:95],a[148:151],a[68:71],v[92:95]
v_mfma_f32_16x16x32_bf16 v[100:103],a[148:151],a[92:95],0
v_mfma_f32_16x16x32_bf16 v[100:103],a[144:147],a[88:91],v[100:103]
v_mfma_f32_16x16x32_bf16 v[100:103],a[140:143],a[84:87],v[100:103]
v_mfma_f32_16x16x32_bf16 v[100:103],a[136:139],a[80:83],v[100:103]
v_mfma_f32_16x16x32_bf16 v[100:103],a[132:135],a[76:79],v[100:103]
ds_read_b64_tr_b16 a[134:135],v5 offset:6144
v_mfma_f32_16x16x32_bf16 v[100:103],a[128:131],a[72:75],v[100:103]
s_waitcnt lgkmcnt(1)
ds_read_b64_tr_b16 a[128:129],v4 offset:0
ds_read_b64_tr_b16 a[130:131],v4 offset:6144
ds_read_b64_tr_b16 a[132:133],v5 offset:0
v_mfma_f32_16x16x32_bf16 v[160:163],a[120:123],v[44:47],v[160:163]
s_add_u32 m0,s29,0
ds_read_b64_tr_b16 a[136:137],v2 offset:128
v_fma_f32 v82,v82,s36,v14
v_mfma_f32_16x16x32_bf16 v[164:167],a[124:127],v[44:47],v[164:167]
ds_read_b64_tr_b16 a[138:139],v2 offset:6272
v_fma_f32 v83,v83,s36,v14
v_mfma_f32_16x16x32_bf16 v[212:215],a[124:127],v[48:51],v[212:215]
ds_read_b64_tr_b16 a[140:141],v3 offset:128
v_fma_f32 v88,v88,s36,v15
v_mfma_f32_16x16x32_bf16 v[208:211],a[120:123],v[48:51],v[208:211]
ds_read_b64_tr_b16 a[142:143],v3 offset:6272
v_fma_f32 v89,v89,s36,v15
v_mfma_f32_16x16x32_bf16 v[112:115],a[120:123],v[52:55],v[112:115]
ds_read_b64_tr_b16 a[144:145],v4 offset:128
v_fma_f32 v90,v90,s36,v15
v_mfma_f32_16x16x32_bf16 v[116:119],a[124:127],v[52:55],v[116:119]
ds_read_b64_tr_b16 a[146:147],v4 offset:6272
v_fma_f32 v91,v91,s36,v15
v_mfma_f32_16x16x32_bf16 a[164:167],a[124:127],v[56:59],a[164:167]
buffer_load_dwordx4 v6,s[12:15],s28 offen offset:0 nt lds
v_mfma_f32_16x16x32_bf16 a[160:163],a[120:123],v[56:59],a[160:163]
s_waitcnt lgkmcnt(5)
ds_read_b64_tr_b16 a[148:149],v5 offset:128
v_fma_f32 v96,v96,s36,v16
v_mfma_f32_16x16x32_bf16 a[168:171],a[128:131],v[56:59],a[168:171]
ds_read_b64_tr_b16 a[150:151],v5 offset:6272
v_fma_f32 v97,v97,s36,v16
v_mfma_f32_16x16x32_bf16 a[172:175],a[132:135],v[56:59],a[172:175]
ds_read_b64_tr_b16 a[120:121],v2 offset:256
v_fma_f32 v98,v98,s36,v16
v_mfma_f32_16x16x32_bf16 v[124:127],a[132:135],v[52:55],v[124:127]
ds_read_b64_tr_b16 a[122:123],v2 offset:6400
v_fma_f32 v99,v99,s36,v16
v_mfma_f32_16x16x32_bf16 v[120:123],a[128:131],v[52:55],v[120:123]
ds_read_b64_tr_b16 a[124:125],v3 offset:256
v_fma_f32 v76,v76,s36,v13
v_mfma_f32_16x16x32_bf16 v[216:219],a[128:131],v[48:51],v[216:219]
ds_read_b64_tr_b16 a[126:127],v3 offset:6400
v_fma_f32 v77,v77,s36,v13
v_mfma_f32_16x16x32_bf16 v[220:223],a[132:135],v[48:51],v[220:223]
buffer_load_dwordx4 v7,s[12:15],s28 offen offset:1024 nt lds
v_mfma_f32_16x16x32_bf16 v[172:175],a[132:135],v[44:47],v[172:175]
ds_read_b64_tr_b16 a[132:133],v5 offset:256
v_fma_f32 v78,v78,s36,v13
v_mfma_f32_16x16x32_bf16 v[168:171],a[128:131],v[44:47],v[168:171]
s_waitcnt lgkmcnt(5)
ds_read_b64_tr_b16 a[128:129],v4 offset:256
v_fma_f32 v79,v79,s36,v13
v_mfma_f32_16x16x32_bf16 v[176:179],a[136:139],v[44:47],v[176:179]
ds_read_b64_tr_b16 a[130:131],v4 offset:6400
v_fma_f32 v84,v84,s36,v14
v_mfma_f32_16x16x32_bf16 v[180:183],a[140:143],v[44:47],v[180:183]
ds_read_b64_tr_b16 a[134:135],v5 offset:6400
v_fma_f32 v85,v85,s36,v14
v_mfma_f32_16x16x32_bf16 v[228:231],a[140:143],v[48:51],v[228:231]
v_exp_f32 v82,v82
v_mfma_f32_16x16x32_bf16 v[224:227],a[136:139],v[48:51],v[224:227]
v_exp_f32 v83,v83
v_mfma_f32_16x16x32_bf16 v[128:131],a[136:139],v[52:55],v[128:131]
v_cvt_pk_bf16_f32 v25,v82,v83
v_fma_f32 v86,v86,s36,v14
v_mfma_f32_16x16x32_bf16 v[132:135],a[140:143],v[52:55],v[132:135]
buffer_load_dwordx4 v8,s[12:15],s28 offen offset:2048 nt lds
v_mfma_f32_16x16x32_bf16 a[180:183],a[140:143],v[56:59],a[180:183]
s_add_u32 s28,s28,3072
v_exp_f32 v88,v88
v_mfma_f32_16x16x32_bf16 a[176:179],a[136:139],v[56:59],a[176:179]
s_add_u32 s29,s29,3072
v_exp_f32 v89,v89
v_mfma_f32_16x16x32_bf16 a[184:187],a[144:147],v[56:59],a[184:187]
s_add_u32 m0,s23,0
v_exp_f32 v90,v90
v_mfma_f32_16x16x32_bf16 a[188:191],a[148:151],v[56:59],a[188:191]
v_exp_f32 v91,v91
v_mfma_f32_16x16x32_bf16 v[140:143],a[148:151],v[52:55],v[140:143]
v_cvt_pk_bf16_f32 v28,v88,v89
v_cvt_pk_bf16_f32 v29,v90,v91
v_mfma_f32_16x16x32_bf16 v[136:139],a[144:147],v[52:55],v[136:139]
v_exp_f32 v96,v96
v_mfma_f32_16x16x32_bf16 v[232:235],a[144:147],v[48:51],v[232:235]
v_exp_f32 v97,v97
v_mfma_f32_16x16x32_bf16 v[236:239],a[148:151],v[48:51],v[236:239]
v_exp_f32 v98,v98
v_mfma_f32_16x16x32_bf16 v[188:191],a[148:151],v[44:47],v[188:191]
v_exp_f32 v99,v99
v_mfma_f32_16x16x32_bf16 v[184:187],a[144:147],v[44:47],v[184:187]
s_waitcnt lgkmcnt(0)
v_cvt_pk_bf16_f32 v32,v96,v97
v_cvt_pk_bf16_f32 v33,v98,v99
v_mfma_f32_16x16x32_bf16 v[192:195],a[120:123],v[44:47],v[192:195]
s_waitcnt vmcnt(12)
v_exp_f32 v76,v76
v_mfma_f32_16x16x32_bf16 v[196:199],a[124:127],v[44:47],v[196:199]
s_barrier
v_mfma_f32_16x16x32_bf16 v[244:247],a[124:127],v[48:51],v[244:247]
ds_read_b128 a[148:151],v1 offset:24704
v_fma_f32 v87,v87,s36,v14
v_mfma_f32_16x16x32_bf16 v[240:243],a[120:123],v[48:51],v[240:243]
ds_read_b128 a[144:147],v0 offset:24704
v_fma_f32 v92,v92,s36,v15
v_mfma_f32_16x16x32_bf16 v[144:147],a[120:123],v[52:55],v[144:147]
ds_read_b128 a[140:143],v1 offset:24576
v_fma_f32 v93,v93,s36,v15
v_mfma_f32_16x16x32_bf16 v[148:151],a[124:127],v[52:55],v[148:151]
ds_read_b128 a[136:139],v0 offset:24576
v_fma_f32 v94,v94,s36,v15
v_mfma_f32_16x16x32_bf16 a[196:199],a[124:127],v[56:59],a[196:199]
ds_read_b128 a[124:127],v1 offset:24832
v_fma_f32 v95,v95,s36,v15
v_mfma_f32_16x16x32_bf16 a[192:195],a[120:123],v[56:59],a[192:195]
buffer_load_dwordx4 v6,s[8:11],s21 offen offset:0 lds
v_mfma_f32_16x16x32_bf16 a[200:203],a[128:131],v[56:59],a[200:203]
ds_read_b128 a[120:123],v0 offset:24832
v_fma_f32 v100,v100,s36,v16
v_mfma_f32_16x16x32_bf16 a[204:207],a[132:135],v[56:59],a[204:207]
v_exp_f32 v77,v77
v_mfma_f32_16x16x32_bf16 v[156:159],a[132:135],v[52:55],v[156:159]
v_exp_f32 v78,v78
v_mfma_f32_16x16x32_bf16 v[152:155],a[128:131],v[52:55],v[152:155]
v_exp_f32 v79,v79
v_mfma_f32_16x16x32_bf16 v[248:251],a[128:131],v[48:51],v[248:251]
v_cvt_pk_bf16_f32 v22,v76,v77
v_cvt_pk_bf16_f32 v23,v78,v79
v_mfma_f32_16x16x32_bf16 v[252:255],a[132:135],v[48:51],v[252:255]
v_exp_f32 v84,v84
v_mfma_f32_16x16x32_bf16 v[204:207],a[132:135],v[44:47],v[204:207]
ds_read_b128 a[132:135],v1 offset:30720
v_fma_f32 v101,v101,s36,v16
v_mfma_f32_16x16x32_bf16 v[200:203],a[128:131],v[44:47],v[200:203]
s_waitcnt lgkmcnt(1)
ds_read_b128 a[128:131],v0 offset:30720
v_fma_f32 v102,v102,s36,v16
v_mfma_f32_16x16x32_bf16 v[72:75],a[124:127],a[20:23],0
buffer_load_dwordx4 v7,s[8:11],s21 offen offset:1024 lds
v_mfma_f32_16x16x32_bf16 v[72:75],a[120:123],a[16:19],v[72:75]
v_exp_f32 v85,v85
v_mfma_f32_16x16x32_bf16 v[72:75],a[148:151],a[12:15],v[72:75]
v_exp_f32 v86,v86
v_mfma_f32_16x16x32_bf16 v[72:75],a[144:147],a[8:11],v[72:75]
v_exp_f32 v87,v87
v_mfma_f32_16x16x32_bf16 v[72:75],a[140:143],a[4:7],v[72:75]
v_cvt_pk_bf16_f32 v26,v84,v85
v_cvt_pk_bf16_f32 v27,v86,v87
v_mfma_f32_16x16x32_bf16 v[72:75],a[136:139],a[0:3],v[72:75]
v_exp_f32 v92,v92
v_smfmac_f32_16x16x64_bf16 v[60:63],a[152:155],v[20:27],v18
v_fma_f32 v103,v103,s36,v16
v_mfma_f32_16x16x32_bf16 v[80:83],a[136:139],a[24:27],0
v_exp_f32 v93,v93
v_mfma_f32_16x16x32_bf16 v[80:83],a[140:143],a[28:31],v[80:83]
buffer_load_dwordx4 v8,s[8:11],s21 offen offset:2048 lds
v_mfma_f32_16x16x32_bf16 v[80:83],a[144:147],a[32:35],v[80:83]
s_add_u32 s21,s21,12288
v_exp_f32 v94,v94
v_mfma_f32_16x16x32_bf16 v[80:83],a[148:151],a[36:39],v[80:83]
s_add_u32 m0,s22,12288
v_exp_f32 v95,v95
v_mfma_f32_16x16x32_bf16 v[80:83],a[120:123],a[40:43],v[80:83]
v_cvt_pk_bf16_f32 v30,v92,v93
v_cvt_pk_bf16_f32 v31,v94,v95
v_mfma_f32_16x16x32_bf16 v[80:83],a[124:127],a[44:47],v[80:83]
v_exp_f32 v100,v100
v_mfma_f32_16x16x32_bf16 v[88:91],a[124:127],a[68:71],0
v_exp_f32 v101,v101
v_mfma_f32_16x16x32_bf16 v[88:91],a[120:123],a[64:67],v[88:91]
v_exp_f32 v102,v102
v_mfma_f32_16x16x32_bf16 v[88:91],a[148:151],a[60:63],v[88:91]
v_exp_f32 v103,v103
v_mfma_f32_16x16x32_bf16 v[88:91],a[144:147],a[56:59],v[88:91]
v_cvt_pk_bf16_f32 v34,v100,v101
v_cvt_pk_bf16_f32 v35,v102,v103
v_mfma_f32_16x16x32_bf16 v[88:91],a[140:143],a[52:55],v[88:91]
buffer_load_dwordx4 v6,s[4:7],s20 offen offset:0 lds
v_smfmac_f32_16x16x64_bf16 v[64:67],a[152:155],v[28:35],v18
v_fma_f32 v72,v72,s36,v13
v_mfma_f32_16x16x32_bf16 v[88:91],a[136:139],a[48:51],v[88:91]
v_fma_f32 v73,v73,s36,v13
v_fma_f32 v74,v74,s36,v13
v_mfma_f32_16x16x32_bf16 v[96:99],a[136:139],a[72:75],0
ds_read_b128 a[136:139],v0 offset:30848
v_fma_f32 v75,v75,s36,v13
v_mfma_f32_16x16x32_bf16 v[96:99],a[140:143],a[76:79],v[96:99]
ds_read_b128 a[140:143],v1 offset:30848
v_fma_f32 v80,v80,s36,v14
v_mfma_f32_16x16x32_bf16 v[96:99],a[144:147],a[80:83],v[96:99]
ds_read_b128 a[144:147],v0 offset:30976
v_fma_f32 v81,v81,s36,v14
v_mfma_f32_16x16x32_bf16 v[96:99],a[148:151],a[84:87],v[96:99]
ds_read_b128 a[148:151],v1 offset:30976
v_mfma_f32_16x16x32_bf16 v[96:99],a[120:123],a[88:91],v[96:99]
v_exp_f32 v72,v72
v_mfma_f32_16x16x32_bf16 v[96:99],a[124:127],a[92:95],v[96:99]
s_waitcnt lgkmcnt(4)
v_exp_f32 v73,v73
v_mfma_f32_16x16x32_bf16 v[76:79],a[128:131],a[0:3],0
buffer_load_dwordx4 v7,s[4:7],s20 offen offset:1024 lds
v_mfma_f32_16x16x32_bf16 v[76:79],a[132:135],a[4:7],v[76:79]
s_waitcnt lgkmcnt(3)
v_exp_f32 v74,v74
v_mfma_f32_16x16x32_bf16 v[76:79],a[136:139],a[8:11],v[76:79]
s_waitcnt lgkmcnt(2)
v_exp_f32 v75,v75
v_mfma_f32_16x16x32_bf16 v[76:79],a[140:143],a[12:15],v[76:79]
s_waitcnt lgkmcnt(0)
v_exp_f32 v80,v80
v_mfma_f32_16x16x32_bf16 v[76:79],a[144:147],a[16:19],v[76:79]
v_exp_f32 v81,v81
v_mfma_f32_16x16x32_bf16 v[76:79],a[148:151],a[20:23],v[76:79]
v_cvt_pk_bf16_f32 v44,v72,v73
v_cvt_pk_bf16_f32 v45,v74,v75
v_mfma_f32_16x16x32_bf16 v[84:87],a[148:151],a[44:47],0
v_cvt_pk_bf16_f32 v48,v80,v81
v_mfma_f32_16x16x32_bf16 v[84:87],a[144:147],a[40:43],v[84:87]
v_mfma_f32_16x16x32_bf16 v[84:87],a[140:143],a[36:39],v[84:87]
v_mfma_f32_16x16x32_bf16 v[84:87],a[136:139],a[32:35],v[84:87]
buffer_load_dwordx4 v8,s[4:7],s20 offen offset:2048 lds
v_mfma_f32_16x16x32_bf16 v[84:87],a[132:135],a[28:31],v[84:87]
s_add_u32 s20,s20,12288
v_mfma_f32_16x16x32_bf16 v[84:87],a[128:131],a[24:27],v[84:87]
ds_read_b64_tr_b16 a[120:121],v2 offset:12288
v_mfma_f32_16x16x32_bf16 v[92:95],a[128:131],a[48:51],0
ds_read_b64_tr_b16 a[122:123],v2 offset:18432
v_mfma_f32_16x16x32_bf16 v[92:95],a[132:135],a[52:55],v[92:95]
ds_read_b64_tr_b16 a[124:125],v3 offset:12288
v_mfma_f32_16x16x32_bf16 v[92:95],a[136:139],a[56:59],v[92:95]
ds_read_b64_tr_b16 a[126:127],v3 offset:18432
v_mfma_f32_16x16x32_bf16 v[92:95],a[140:143],a[60:63],v[92:95]
v_mfma_f32_16x16x32_bf16 v[92:95],a[144:147],a[64:67],v[92:95]
v_mfma_f32_16x16x32_bf16 v[92:95],a[148:151],a[68:71],v[92:95]
v_mfma_f32_16x16x32_bf16 v[100:103],a[148:151],a[92:95],0
v_mfma_f32_16x16x32_bf16 v[100:103],a[144:147],a[88:91],v[100:103]
v_mfma_f32_16x16x32_bf16 v[100:103],a[140:143],a[84:87],v[100:103]
v_mfma_f32_16x16x32_bf16 v[100:103],a[136:139],a[80:83],v[100:103]
v_mfma_f32_16x16x32_bf16 v[100:103],a[132:135],a[76:79],v[100:103]
ds_read_b64_tr_b16 a[132:133],v5 offset:12288
v_mfma_f32_16x16x32_bf16 v[100:103],a[128:131],a[72:75],v[100:103]
s_waitcnt lgkmcnt(1)
ds_read_b64_tr_b16 a[128:129],v4 offset:12288
ds_read_b64_tr_b16 a[130:131],v4 offset:18432
ds_read_b64_tr_b16 a[134:135],v5 offset:18432
v_mfma_f32_16x16x32_bf16 v[160:163],a[120:123],v[20:23],v[160:163]
s_add_u32 m0,s23,12288
ds_read_b64_tr_b16 a[138:139],v2 offset:18560
v_mbcnt_lo_u32_b32 v19,-1,0
v_mfma_f32_16x16x32_bf16 v[164:167],a[124:127],v[20:23],v[164:167]
ds_read_b64_tr_b16 a[136:137],v2 offset:12416
v_mbcnt_hi_u32_b32 v19,-1,v19
v_mfma_f32_16x16x32_bf16 v[212:215],a[124:127],v[24:27],v[212:215]
ds_read_b64_tr_b16 a[140:141],v3 offset:12416
v_min_u32 v19,7,v19
v_mfma_f32_16x16x32_bf16 v[208:211],a[120:123],v[24:27],v[208:211]
ds_read_b64_tr_b16 a[142:143],v3 offset:18560
v_lshl_add_u32 v19,v19,7,s48
v_mfma_f32_16x16x32_bf16 v[112:115],a[120:123],v[28:31],v[112:115]
ds_read_b64_tr_b16 a[146:147],v4 offset:18560
v_min_u32 v19,L_codeend-L_first-4,v19
v_mfma_f32_16x16x32_bf16 v[116:119],a[124:127],v[28:31],v[116:119]
ds_read_b64_tr_b16 a[148:149],v5 offset:12416
v_fma_f32 v83,v83,s36,v14
v_mfma_f32_16x16x32_bf16 a[164:167],a[124:127],v[32:35],a[164:167]
ds_read_b64_tr_b16 a[144:145],v4 offset:12416
v_fma_f32 v82,v82,s36,v14
v_mfma_f32_16x16x32_bf16 a[160:163],a[120:123],v[32:35],a[160:163]
s_waitcnt lgkmcnt(6)
ds_read_b64_tr_b16 a[150:151],v5 offset:18560
v_fma_f32 v91,v91,s36,v15
v_mfma_f32_16x16x32_bf16 a[168:171],a[128:131],v[32:35],a[168:171]
ds_read_b64_tr_b16 a[120:121],v2 offset:12544
v_fma_f32 v89,v89,s36,v15
v_mfma_f32_16x16x32_bf16 a[172:175],a[132:135],v[32:35],a[172:175]
ds_read_b64_tr_b16 a[122:123],v2 offset:18688
v_fma_f32 v88,v88,s36,v15
v_mfma_f32_16x16x32_bf16 v[124:127],a[132:135],v[28:31],v[124:127]
ds_read_b64_tr_b16 a[124:125],v3 offset:12544
v_fma_f32 v90,v90,s36,v15
v_mfma_f32_16x16x32_bf16 v[120:123],a[128:131],v[28:31],v[120:123]
ds_read_b64_tr_b16 a[126:127],v3 offset:18688
v_fma_f32 v96,v96,s36,v16
v_mfma_f32_16x16x32_bf16 v[216:219],a[128:131],v[24:27],v[216:219]
v_exp_f32 v82,v82
v_mfma_f32_16x16x32_bf16 v[220:223],a[132:135],v[24:27],v[220:223]
v_exp_f32 v83,v83
v_mfma_f32_16x16x32_bf16 v[172:175],a[132:135],v[20:23],v[172:175]
ds_read_b64_tr_b16 a[132:133],v5 offset:12544
v_cvt_pk_bf16_f32 v49,v82,v83
v_mfma_f32_16x16x32_bf16 v[168:171],a[128:131],v[20:23],v[168:171]
global_load_dword v19,v19,s[46:47]
s_waitcnt lgkmcnt(4)
v_mfma_f32_16x16x32_bf16 v[176:179],a[136:139],v[20:23],v[176:179]
ds_read_b64_tr_b16 a[128:129],v4 offset:12544
v_fma_f32 v99,v99,s36,v16
v_mfma_f32_16x16x32_bf16 v[180:183],a[140:143],v[20:23],v[180:183]
ds_read_b64_tr_b16 a[130:131],v4 offset:18688
v_fma_f32 v98,v98,s36,v16
v_mfma_f32_16x16x32_bf16 v[228:231],a[140:143],v[24:27],v[228:231]
ds_read_b64_tr_b16 a[134:135],v5 offset:18688
v_fma_f32 v97,v97,s36,v16
v_mfma_f32_16x16x32_bf16 v[224:227],a[136:139],v[24:27],v[224:227]
v_exp_f32 v90,v90
v_mfma_f32_16x16x32_bf16 v[128:131],a[136:139],v[28:31],v[128:131]
v_exp_f32 v89,v89
v_mfma_f32_16x16x32_bf16 v[132:135],a[140:143],v[28:31],v[132:135]
v_exp_f32 v91,v91
v_mfma_f32_16x16x32_bf16 a[180:183],a[140:143],v[32:35],a[180:183]
v_exp_f32 v88,v88
v_mfma_f32_16x16x32_bf16 a[176:179],a[136:139],v[32:35],a[176:179]
v_cvt_pk_bf16_f32 v52,v88,v89
v_cvt_pk_bf16_f32 v53,v90,v91
v_mfma_f32_16x16x32_bf16 a[184:187],a[144:147],v[32:35],a[184:187]
v_exp_f32 v99,v99
v_mfma_f32_16x16x32_bf16 a[188:191],a[148:151],v[32:35],a[188:191]
v_exp_f32 v97,v97
v_mfma_f32_16x16x32_bf16 v[140:143],a[148:151],v[28:31],v[140:143]
v_exp_f32 v98,v98
v_mfma_f32_16x16x32_bf16 v[136:139],a[144:147],v[28:31],v[136:139]
v_exp_f32 v96,v96
v_mfma_f32_16x16x32_bf16 v[232:235],a[144:147],v[24:27],v[232:235]
v_cvt_pk_bf16_f32 v56,v96,v97
v_cvt_pk_bf16_f32 v57,v98,v99
v_mfma_f32_16x16x32_bf16 v[236:239],a[148:151],v[24:27],v[236:239]
v_fma_f32 v79,v79,s36,v13
v_fma_f32 v77,v77,s36,v13
v_mfma_f32_16x16x32_bf16 v[188:191],a[148:151],v[20:23],v[188:191]
v_exp_f32 v77,v77
v_mfma_f32_16x16x32_bf16 v[184:187],a[144:147],v[20:23],v[184:187]
s_waitcnt lgkmcnt(0)
v_exp_f32 v79,v79
v_mfma_f32_16x16x32_bf16 v[192:195],a[120:123],v[20:23],v[192:195]
s_waitcnt vmcnt(10)
v_mfma_f32_16x16x32_bf16 v[196:199],a[124:127],v[20:23],v[196:199]
s_barrier
v_mfma_f32_16x16x32_bf16 v[244:247],a[124:127],v[24:27],v[244:247]
ds_read_b128 a[148:151],v1 offset:128
v_fma_f32 v76,v76,s36,v13
v_mfma_f32_16x16x32_bf16 v[240:243],a[120:123],v[24:27],v[240:243]
ds_read_b128 a[144:147],v0 offset:128
v_fma_f32 v78,v78,s36,v13
v_mfma_f32_16x16x32_bf16 v[144:147],a[120:123],v[28:31],v[144:147]
ds_read_b128 a[140:143],v1 offset:0
v_fma_f32 v86,v86,s36,v14
v_mfma_f32_16x16x32_bf16 v[148:151],a[124:127],v[28:31],v[148:151]
ds_read_b128 a[136:139],v0 offset:0
v_fma_f32 v87,v87,s36,v14
v_mfma_f32_16x16x32_bf16 a[196:199],a[124:127],v[32:35],a[196:199]
ds_read_b128 a[124:127],v1 offset:256
v_fma_f32 v85,v85,s36,v14
v_mfma_f32_16x16x32_bf16 a[192:195],a[120:123],v[32:35],a[192:195]
buffer_load_dwordx4 v6,s[8:11],s21 offen offset:0 lds
v_mfma_f32_16x16x32_bf16 a[200:203],a[128:131],v[32:35],a[200:203]
ds_read_b128 a[120:123],v0 offset:256
v_fma_f32 v84,v84,s36,v14
v_mfma_f32_16x16x32_bf16 a[204:207],a[132:135],v[32:35],a[204:207]
ds_read_b128 a[156:159],v10 offset:3072
v_fma_f32 v95,v95,s36,v15
v_mfma_f32_16x16x32_bf16 v[156:159],a[132:135],v[28:31],v[156:159]
v_exp_f32 v76,v76
v_mfma_f32_16x16x32_bf16 v[152:155],a[128:131],v[28:31],v[152:155]
v_exp_f32 v78,v78
v_mfma_f32_16x16x32_bf16 v[248:251],a[128:131],v[24:27],v[248:251]
v_cvt_pk_bf16_f32 v47,v78,v79
v_cvt_pk_bf16_f32 v46,v76,v77
v_mfma_f32_16x16x32_bf16 v[252:255],a[132:135],v[24:27],v[252:255]
v_exp_f32 v86,v86
v_mfma_f32_16x16x32_bf16 v[204:207],a[132:135],v[20:23],v[204:207]
ds_read_b128 a[132:135],v1 offset:6144
v_fma_f32 v92,v92,s36,v15
v_mfma_f32_16x16x32_bf16 v[200:203],a[128:131],v[20:23],v[200:203]
s_waitcnt lgkmcnt(2)
ds_read_b128 a[128:131],v0 offset:6144
v_fma_f32 v94,v94,s36,v15
v_mfma_f32_16x16x32_bf16 v[72:75],a[124:127],a[20:23],0
v_exp_f32 v84,v84
v_mfma_f32_16x16x32_bf16 v[72:75],a[120:123],a[16:19],v[72:75]
s_waitcnt lgkmcnt(2)
buffer_store_dwordx4 a[156:159],v9,s[16:19],s27 offen offset:0 nt
buffer_load_dwordx4 v7,s[8:11],s21 offen offset:1024 lds
v_mfma_f32_16x16x32_bf16 v[72:75],a[148:151],a[12:15],v[72:75]
ds_read_b128 a[156:159],v10 offset:4096
v_fma_f32 v93,v93,s36,v15
v_mfma_f32_16x16x32_bf16 v[72:75],a[144:147],a[8:11],v[72:75]
v_exp_f32 v87,v87
v_mfma_f32_16x16x32_bf16 v[72:75],a[140:143],a[4:7],v[72:75]
v_exp_f32 v85,v85
v_mfma_f32_16x16x32_bf16 v[72:75],a[136:139],a[0:3],v[72:75]
v_cvt_pk_bf16_f32 v51,v86,v87
v_cvt_pk_bf16_f32 v50,v84,v85
v_mfma_f32_16x16x32_bf16 v[80:83],a[136:139],a[24:27],0
v_exp_f32 v92,v92
v_smfmac_f32_16x16x64_bf16 v[60:63],a[152:155],v[44:51],v18
v_fma_f32 v103,v103,s36,v16
v_mfma_f32_16x16x32_bf16 v[80:83],a[140:143],a[28:31],v[80:83]
buffer_load_dwordx4 v8,s[8:11],s21 offen offset:2048 lds
v_mfma_f32_16x16x32_bf16 v[80:83],a[144:147],a[32:35],v[80:83]
s_add_u32 s21,s21,12288
v_exp_f32 v93,v93
v_mfma_f32_16x16x32_bf16 v[80:83],a[148:151],a[36:39],v[80:83]
s_add_u32 m0,s22,24576
v_exp_f32 v94,v94
v_mfma_f32_16x16x32_bf16 v[80:83],a[120:123],a[40:43],v[80:83]
v_exp_f32 v95,v95
v_mfma_f32_16x16x32_bf16 v[80:83],a[124:127],a[44:47],v[80:83]
v_cvt_pk_bf16_f32 v55,v94,v95
v_cvt_pk_bf16_f32 v54,v92,v93
v_mfma_f32_16x16x32_bf16 v[88:91],a[124:127],a[68:71],0
v_exp_f32 v103,v103
v_mfma_f32_16x16x32_bf16 v[88:91],a[120:123],a[64:67],v[88:91]
v_fma_f32 v101,v101,s36,v16
v_fma_f32 v100,v100,s36,v16
v_mfma_f32_16x16x32_bf16 v[88:91],a[148:151],a[60:63],v[88:91]
v_exp_f32 v100,v100
v_mfma_f32_16x16x32_bf16 v[88:91],a[144:147],a[56:59],v[88:91]
v_exp_f32 v101,v101
v_mfma_f32_16x16x32_bf16 v[88:91],a[140:143],a[52:55],v[88:91]
s_waitcnt lgkmcnt(0)
buffer_store_dwordx4 a[156:159],v9,s[16:19],s27 offen offset:128 nt
buffer_load_dwordx4 v6,s[4:7],s20 offen offset:0 lds
v_mfma_f32_16x16x32_bf16 v[88:91],a[136:139],a[48:51],v[88:91]
ds_read_b128 a[156:159],v10 offset:5120
v_mfma_f32_16x16x32_bf16 v[96:99],a[136:139],a[72:75],0
ds_read_b128 a[136:139],v0 offset:6272
v_mfma_f32_16x16x32_bf16 v[96:99],a[140:143],a[76:79],v[96:99]
ds_read_b128 a[140:143],v1 offset:6272
v_mfma_f32_16x16x32_bf16 v[96:99],a[144:147],a[80:83],v[96:99]
ds_read_b128 a[144:147],v0 offset:6400
v_mfma_f32_16x16x32_bf16 v[96:99],a[148:151],a[84:87],v[96:99]
ds_read_b128 a[148:151],v1 offset:6400
v_mfma_f32_16x16x32_bf16 v[96:99],a[120:123],a[88:91],v[96:99]
v_fma_f32 v102,v102,s36,v16
v_cvt_pk_bf16_f32 v58,v100,v101
v_mfma_f32_16x16x32_bf16 v[96:99],a[124:127],a[92:95],v[96:99]
v_exp_f32 v102,v102
v_mfma_f32_16x16x32_bf16 v[76:79],a[128:131],a[0:3],0
buffer_load_dwordx4 v7,s[4:7],s20 offen offset:1024 lds
v_mfma_f32_16x16x32_bf16 v[76:79],a[132:135],a[4:7],v[76:79]
s_waitcnt lgkmcnt(3)
v_cvt_pk_bf16_f32 v59,v102,v103
v_fma_f32 v80,v80,s36,v14
v_mfma_f32_16x16x32_bf16 v[76:79],a[136:139],a[8:11],v[76:79]
v_exp_f32 v80,v80
v_smfmac_f32_16x16x64_bf16 v[64:67],a[152:155],v[52:59],v18
s_waitcnt lgkmcnt(1)
v_fma_f32 v81,v81,s36,v14
v_mfma_f32_16x16x32_bf16 v[76:79],a[140:143],a[12:15],v[76:79]
v_exp_f32 v81,v81
v_mfma_f32_16x16x32_bf16 v[76:79],a[144:147],a[16:19],v[76:79]
s_waitcnt lgkmcnt(0)
v_fma_f32 v75,v75,s36,v13
v_fma_f32 v72,v72,s36,v13
v_mfma_f32_16x16x32_bf16 v[76:79],a[148:151],a[20:23],v[76:79]
v_exp_f32 v72,v72
v_mfma_f32_16x16x32_bf16 v[84:87],a[148:151],a[44:47],0
v_exp_f32 v75,v75
v_mfma_f32_16x16x32_bf16 v[84:87],a[144:147],a[40:43],v[84:87]
v_fma_f32 v74,v74,s36,v13
v_fma_f32 v73,v73,s36,v13
v_mfma_f32_16x16x32_bf16 v[84:87],a[140:143],a[36:39],v[84:87]
buffer_store_dwordx4 a[156:159],v9,s[16:19],s27 offen offset:256 nt
buffer_load_dwordx4 v8,s[4:7],s20 offen offset:2048 lds
v_mfma_f32_16x16x32_bf16 v[84:87],a[136:139],a[32:35],v[84:87]
s_add_u32 s20,s20,12288
ds_read_b64_tr_b16 a[120:121],v2 offset:24576
v_mfma_f32_16x16x32_bf16 v[84:87],a[132:135],a[28:31],v[84:87]
s_add_u32 s27,s27,3072
ds_read_b64_tr_b16 a[122:123],v2 offset:30720
v_cvt_pk_bf16_f32 v24,v80,v81
v_mfma_f32_16x16x32_bf16 v[84:87],a[128:131],a[24:27],v[84:87]
ds_read_b64_tr_b16 a[124:125],v3 offset:24576
v_mfma_f32_16x16x32_bf16 v[92:95],a[128:131],a[48:51],0
ds_read_b64_tr_b16 a[126:127],v3 offset:30720
v_mfma_f32_16x16x32_bf16 v[92:95],a[132:135],a[52:55],v[92:95]
v_exp_f32 v74,v74
v_mfma_f32_16x16x32_bf16 v[92:95],a[136:139],a[56:59],v[92:95]
v_exp_f32 v73,v73
v_mfma_f32_16x16x32_bf16 v[92:95],a[140:143],a[60:63],v[92:95]
v_cvt_pk_bf16_f32 v21,v74,v75
v_cvt_pk_bf16_f32 v20,v72,v73
v_mfma_f32_16x16x32_bf16 v[92:95],a[144:147],a[64:67],v[92:95]
v_mfma_f32_16x16x32_bf16 v[92:95],a[148:151],a[68:71],v[92:95]
v_mfma_f32_16x16x32_bf16 v[100:103],a[148:151],a[92:95],0
v_mfma_f32_16x16x32_bf16 v[100:103],a[144:147],a[88:91],v[100:103]
v_mfma_f32_16x16x32_bf16 v[100:103],a[140:143],a[84:87],v[100:103]
v_mfma_f32_16x16x32_bf16 v[100:103],a[136:139],a[80:83],v[100:103]
v_mfma_f32_16x16x32_bf16 v[100:103],a[132:135],a[76:79],v[100:103]
ds_read_b64_tr_b16 a[134:135],v5 offset:30720
v_mfma_f32_16x16x32_bf16 v[100:103],a[128:131],a[72:75],v[100:103]
s_waitcnt lgkmcnt(1)
ds_read_b64_tr_b16 a[130:131],v4 offset:30720
ds_read_b64_tr_b16 a[128:129],v4 offset:24576
ds_read_b64_tr_b16 a[132:133],v5 offset:24576
v_mfma_f32_16x16x32_bf16 v[160:163],a[120:123],v[44:47],v[160:163]
s_add_u32 m0,s29,0
ds_read_b64_tr_b16 a[136:137],v2 offset:24704
v_fma_f32 v82,v82,s36,v14
v_mfma_f32_16x16x32_bf16 v[164:167],a[124:127],v[44:47],v[164:167]
ds_read_b64_tr_b16 a[138:139],v2 offset:30848
v_fma_f32 v83,v83,s36,v14
v_mfma_f32_16x16x32_bf16 v[212:215],a[124:127],v[48:51],v[212:215]
ds_read_b64_tr_b16 a[140:141],v3 offset:24704
v_fma_f32 v88,v88,s36,v15
v_mfma_f32_16x16x32_bf16 v[208:211],a[120:123],v[48:51],v[208:211]
ds_read_b64_tr_b16 a[142:143],v3 offset:30848
v_fma_f32 v89,v89,s36,v15
v_mfma_f32_16x16x32_bf16 v[112:115],a[120:123],v[52:55],v[112:115]
ds_read_b64_tr_b16 a[144:145],v4 offset:24704
v_fma_f32 v90,v90,s36,v15
v_mfma_f32_16x16x32_bf16 v[116:119],a[124:127],v[52:55],v[116:119]
ds_read_b64_tr_b16 a[146:147],v4 offset:30848
v_fma_f32 v91,v91,s36,v15
v_mfma_f32_16x16x32_bf16 a[164:167],a[124:127],v[56:59],a[164:167]
buffer_load_dwordx4 v6,s[12:15],s28 offen offset:0 nt lds
v_mfma_f32_16x16x32_bf16 a[160:163],a[120:123],v[56:59],a[160:163]
s_waitcnt lgkmcnt(5)
ds_read_b64_tr_b16 a[148:149],v5 offset:24704
v_fma_f32 v96,v96,s36,v16
v_mfma_f32_16x16x32_bf16 a[168:171],a[128:131],v[56:59],a[168:171]
ds_read_b64_tr_b16 a[150:151],v5 offset:30848
v_fma_f32 v97,v97,s36,v16
v_mfma_f32_16x16x32_bf16 a[172:175],a[132:135],v[56:59],a[172:175]
ds_read_b64_tr_b16 a[120:121],v2 offset:24832
v_fma_f32 v98,v98,s36,v16
v_mfma_f32_16x16x32_bf16 v[124:127],a[132:135],v[52:55],v[124:127]
ds_read_b64_tr_b16 a[122:123],v2 offset:30976
v_fma_f32 v99,v99,s36,v16
v_mfma_f32_16x16x32_bf16 v[120:123],a[128:131],v[52:55],v[120:123]
ds_read_b64_tr_b16 a[124:125],v3 offset:24832
v_fma_f32 v76,v76,s36,v13
v_mfma_f32_16x16x32_bf16 v[216:219],a[128:131],v[48:51],v[216:219]
ds_read_b64_tr_b16 a[126:127],v3 offset:30976
v_fma_f32 v77,v77,s36,v13
v_mfma_f32_16x16x32_bf16 v[220:223],a[132:135],v[48:51],v[220:223]
buffer_load_dwordx4 v7,s[12:15],s28 offen offset:1024 nt lds
v_mfma_f32_16x16x32_bf16 v[172:175],a[132:135],v[44:47],v[172:175]
ds_read_b64_tr_b16 a[132:133],v5 offset:24832
v_fma_f32 v78,v78,s36,v13
v_mfma_f32_16x16x32_bf16 v[168:171],a[128:131],v[44:47],v[168:171]
s_waitcnt lgkmcnt(5)
ds_read_b64_tr_b16 a[128:129],v4 offset:24832
v_fma_f32 v79,v79,s36,v13
v_mfma_f32_16x16x32_bf16 v[176:179],a[136:139],v[44:47],v[176:179]
ds_read_b64_tr_b16 a[130:131],v4 offset:30976
v_fma_f32 v84,v84,s36,v14
v_mfma_f32_16x16x32_bf16 v[180:183],a[140:143],v[44:47],v[180:183]
ds_read_b64_tr_b16 a[134:135],v5 offset:30976
v_fma_f32 v85,v85,s36,v14
v_mfma_f32_16x16x32_bf16 v[228:231],a[140:143],v[48:51],v[228:231]
v_exp_f32 v82,v82
v_mfma_f32_16x16x32_bf16 v[224:227],a[136:139],v[48:51],v[224:227]
v_exp_f32 v83,v83
v_mfma_f32_16x16x32_bf16 v[128:131],a[136:139],v[52:55],v[128:131]
v_cvt_pk_bf16_f32 v25,v82,v83
v_fma_f32 v86,v86,s36,v14
v_mfma_f32_16x16x32_bf16 v[132:135],a[140:143],v[52:55],v[132:135]
buffer_load_dwordx4 v8,s[12:15],s28 offen offset:2048 nt lds
v_mfma_f32_16x16x32_bf16 a[180:183],a[140:143],v[56:59],a[180:183]
s_add_u32 s28,s28,3072
v_exp_f32 v88,v88
v_mfma_f32_16x16x32_bf16 a[176:179],a[136:139],v[56:59],a[176:179]
s_add_u32 s29,s29,3072
v_exp_f32 v89,v89
v_mfma_f32_16x16x32_bf16 a[184:187],a[144:147],v[56:59],a[184:187]
s_add_u32 m0,s23,24576
v_exp_f32 v90,v90
v_mfma_f32_16x16x32_bf16 a[188:191],a[148:151],v[56:59],a[188:191]
v_exp_f32 v91,v91
v_mfma_f32_16x16x32_bf16 v[140:143],a[148:151],v[52:55],v[140:143]
v_cvt_pk_bf16_f32 v28,v88,v89
v_cvt_pk_bf16_f32 v29,v90,v91
v_mfma_f32_16x16x32_bf16 v[136:139],a[144:147],v[52:55],v[136:139]
v_exp_f32 v96,v96
v_mfma_f32_16x16x32_bf16 v[232:235],a[144:147],v[48:51],v[232:235]
v_exp_f32 v97,v97
v_mfma_f32_16x16x32_bf16 v[236:239],a[148:151],v[48:51],v[236:239]
v_exp_f32 v98,v98
v_mfma_f32_16x16x32_bf16 v[188:191],a[148:151],v[44:47],v[188:191]
v_exp_f32 v99,v99
v_mfma_f32_16x16x32_bf16 v[184:187],a[144:147],v[44:47],v[184:187]
s_waitcnt lgkmcnt(0)
v_cvt_pk_bf16_f32 v32,v96,v97
v_cvt_pk_bf16_f32 v33,v98,v99
v_mfma_f32_16x16x32_bf16 v[192:195],a[120:123],v[44:47],v[192:195]
s_waitcnt vmcnt(13)
v_exp_f32 v76,v76
v_mfma_f32_16x16x32_bf16 v[196:199],a[124:127],v[44:47],v[196:199]
s_barrier
v_mfma_f32_16x16x32_bf16 v[244:247],a[124:127],v[48:51],v[244:247]
ds_read_b128 a[148:151],v1 offset:12416
v_fma_f32 v87,v87,s36,v14
v_mfma_f32_16x16x32_bf16 v[240:243],a[120:123],v[48:51],v[240:243]
ds_read_b128 a[144:147],v0 offset:12416
v_fma_f32 v92,v92,s36,v15
v_mfma_f32_16x16x32_bf16 v[144:147],a[120:123],v[52:55],v[144:147]
ds_read_b128 a[140:143],v1 offset:12288
v_fma_f32 v93,v93,s36,v15
v_mfma_f32_16x16x32_bf16 v[148:151],a[124:127],v[52:55],v[148:151]
ds_read_b128 a[136:139],v0 offset:12288
v_fma_f32 v94,v94,s36,v15
v_mfma_f32_16x16x32_bf16 a[196:199],a[124:127],v[56:59],a[196:199]
ds_read_b128 a[124:127],v1 offset:12544
v_fma_f32 v95,v95,s36,v15
v_mfma_f32_16x16x32_bf16 a[192:195],a[120:123],v[56:59],a[192:195]
buffer_load_dwordx4 v6,s[8:11],s21 offen offset:0 lds
v_mfma_f32_16x16x32_bf16 a[200:203],a[128:131],v[56:59],a[200:203]
ds_read_b128 a[120:123],v0 offset:12544
v_fma_f32 v100,v100,s36,v16
v_mfma_f32_16x16x32_bf16 a[204:207],a[132:135],v[56:59],a[204:207]
v_exp_f32 v77,v77
v_mfma_f32_16x16x32_bf16 v[156:159],a[132:135],v[52:55],v[156:159]
v_exp_f32 v78,v78
v_mfma_f32_16x16x32_bf16 v[152:155],a[128:131],v[52:55],v[152:155]
v_exp_f32 v79,v79
v_mfma_f32_16x16x32_bf16 v[248:251],a[128:131],v[48:51],v[248:251]
v_cvt_pk_bf16_f32 v22,v76,v77
v_cvt_pk_bf16_f32 v23,v78,v79
v_mfma_f32_16x16x32_bf16 v[252:255],a[132:135],v[48:51],v[252:255]
v_exp_f32 v84,v84
v_mfma_f32_16x16x32_bf16 v[204:207],a[132:135],v[44:47],v[204:207]
ds_read_b128 a[132:135],v1 offset:18432
v_fma_f32 v101,v101,s36,v16
v_mfma_f32_16x16x32_bf16 v[200:203],a[128:131],v[44:47],v[200:203]
s_waitcnt lgkmcnt(1)
ds_read_b128 a[128:131],v0 offset:18432
v_fma_f32 v102,v102,s36,v16
v_mfma_f32_16x16x32_bf16 v[72:75],a[124:127],a[20:23],0
buffer_load_dwordx4 v7,s[8:11],s21 offen offset:1024 lds
v_mfma_f32_16x16x32_bf16 v[72:75],a[120:123],a[16:19],v[72:75]
v_exp_f32 v85,v85
v_mfma_f32_16x16x32_bf16 v[72:75],a[148:151],a[12:15],v[72:75]
v_exp_f32 v86,v86
v_mfma_f32_16x16x32_bf16 v[72:75],a[144:147],a[8:11],v[72:75]
v_exp_f32 v87,v87
v_mfma_f32_16x16x32_bf16 v[72:75],a[140:143],a[4:7],v[72:75]
v_cvt_pk_bf16_f32 v26,v84,v85
v_cvt_pk_bf16_f32 v27,v86,v87
v_mfma_f32_16x16x32_bf16 v[72:75],a[136:139],a[0:3],v[72:75]
v_exp_f32 v92,v92
v_smfmac_f32_16x16x64_bf16 v[60:63],a[152:155],v[20:27],v18
v_fma_f32 v103,v103,s36,v16
v_mfma_f32_16x16x32_bf16 v[80:83],a[136:139],a[24:27],0
v_exp_f32 v93,v93
v_mfma_f32_16x16x32_bf16 v[80:83],a[140:143],a[28:31],v[80:83]
buffer_load_dwordx4 v8,s[8:11],s21 offen offset:2048 lds
v_mfma_f32_16x16x32_bf16 v[80:83],a[144:147],a[32:35],v[80:83]
s_add_u32 s21,s21,12288
v_exp_f32 v94,v94
v_mfma_f32_16x16x32_bf16 v[80:83],a[148:151],a[36:39],v[80:83]
s_add_u32 m0,s22,0
v_exp_f32 v95,v95
v_mfma_f32_16x16x32_bf16 v[80:83],a[120:123],a[40:43],v[80:83]
v_cvt_pk_bf16_f32 v30,v92,v93
v_cvt_pk_bf16_f32 v31,v94,v95
v_mfma_f32_16x16x32_bf16 v[80:83],a[124:127],a[44:47],v[80:83]
v_exp_f32 v100,v100
v_mfma_f32_16x16x32_bf16 v[88:91],a[124:127],a[68:71],0
v_exp_f32 v101,v101
v_mfma_f32_16x16x32_bf16 v[88:91],a[120:123],a[64:67],v[88:91]
v_exp_f32 v102,v102
v_mfma_f32_16x16x32_bf16 v[88:91],a[148:151],a[60:63],v[88:91]
v_exp_f32 v103,v103
v_mfma_f32_16x16x32_bf16 v[88:91],a[144:147],a[56:59],v[88:91]
v_cvt_pk_bf16_f32 v34,v100,v101
v_cvt_pk_bf16_f32 v35,v102,v103
v_mfma_f32_16x16x32_bf16 v[88:91],a[140:143],a[52:55],v[88:91]
buffer_load_dwordx4 v6,s[4:7],s20 offen offset:0 lds
v_smfmac_f32_16x16x64_bf16 v[64:67],a[152:155],v[28:35],v18
v_fma_f32 v72,v72,s36,v13
v_mfma_f32_16x16x32_bf16 v[88:91],a[136:139],a[48:51],v[88:91]
v_fma_f32 v73,v73,s36,v13
v_fma_f32 v74,v74,s36,v13
v_mfma_f32_16x16x32_bf16 v[96:99],a[136:139],a[72:75],0
ds_read_b128 a[136:139],v0 offset:18560
v_fma_f32 v75,v75,s36,v13
v_mfma_f32_16x16x32_bf16 v[96:99],a[140:143],a[76:79],v[96:99]
ds_read_b128 a[140:143],v1 offset:18560
v_fma_f32 v80,v80,s36,v14
v_mfma_f32_16x16x32_bf16 v[96:99],a[144:147],a[80:83],v[96:99]
ds_read_b128 a[144:147],v0 offset:18688
v_fma_f32 v81,v81,s36,v14
v_mfma_f32_16x16x32_bf16 v[96:99],a[148:151],a[84:87],v[96:99]
ds_read_b128 a[148:151],v1 offset:18688
v_mfma_f32_16x16x32_bf16 v[96:99],a[120:123],a[88:91],v[96:99]
v_exp_f32 v72,v72
v_mfma_f32_16x16x32_bf16 v[96:99],a[124:127],a[92:95],v[96:99]
s_waitcnt lgkmcnt(4)
v_exp_f32 v73,v73
v_mfma_f32_16x16x32_bf16 v[76:79],a[128:131],a[0:3],0
buffer_load_dwordx4 v7,s[4:7],s20 offen offset:1024 lds
v_mfma_f32_16x16x32_bf16 v[76:79],a[132:135],a[4:7],v[76:79]
s_waitcnt lgkmcnt(3)
v_exp_f32 v74,v74
v_mfma_f32_16x16x32_bf16 v[76:79],a[136:139],a[8:11],v[76:79]
s_waitcnt lgkmcnt(2)
v_exp_f32 v75,v75
v_mfma_f32_16x16x32_bf16 v[76:79],a[140:143],a[12:15],v[76:79]
s_waitcnt lgkmcnt(0)
v_exp_f32 v80,v80
v_mfma_f32_16x16x32_bf16 v[76:79],a[144:147],a[16:19],v[76:79]
v_exp_f32 v81,v81
v_mfma_f32_16x16x32_bf16 v[76:79],a[148:151],a[20:23],v[76:79]
v_cvt_pk_bf16_f32 v44,v72,v73
v_cvt_pk_bf16_f32 v45,v74,v75
v_mfma_f32_16x16x32_bf16 v[84:87],a[148:151],a[44:47],0
v_cvt_pk_bf16_f32 v48,v80,v81
v_mfma_f32_16x16x32_bf16 v[84:87],a[144:147],a[40:43],v[84:87]
v_mfma_f32_16x16x32_bf16 v[84:87],a[140:143],a[36:39],v[84:87]
v_mfma_f32_16x16x32_bf16 v[84:87],a[136:139],a[32:35],v[84:87]
buffer_load_dwordx4 v8,s[4:7],s20 offen offset:2048 lds
v_mfma_f32_16x16x32_bf16 v[84:87],a[132:135],a[28:31],v[84:87]
s_add_u32 s20,s20,12288
v_mfma_f32_16x16x32_bf16 v[84:87],a[128:131],a[24:27],v[84:87]
ds_read_b64_tr_b16 a[120:121],v2 offset:0
v_mfma_f32_16x16x32_bf16 v[92:95],a[128:131],a[48:51],0
ds_read_b64_tr_b16 a[122:123],v2 offset:6144
v_mfma_f32_16x16x32_bf16 v[92:95],a[132:135],a[52:55],v[92:95]
ds_read_b64_tr_b16 a[124:125],v3 offset:0
v_mfma_f32_16x16x32_bf16 v[92:95],a[136:139],a[56:59],v[92:95]
ds_read_b64_tr_b16 a[126:127],v3 offset:6144
v_mfma_f32_16x16x32_bf16 v[92:95],a[140:143],a[60:63],v[92:95]
v_mfma_f32_16x16x32_bf16 v[92:95],a[144:147],a[64:67],v[92:95]
v_mfma_f32_16x16x32_bf16 v[92:95],a[148:151],a[68:71],v[92:95]
v_mfma_f32_16x16x32_bf16 v[100:103],a[148:151],a[92:95],0
v_mfma_f32_16x16x32_bf16 v[100:103],a[144:147],a[88:91],v[100:103]
v_mfma_f32_16x16x32_bf16 v[100:103],a[140:143],a[84:87],v[100:103]
v_mfma_f32_16x16x32_bf16 v[100:103],a[136:139],a[80:83],v[100:103]
v_mfma_f32_16x16x32_bf16 v[100:103],a[132:135],a[76:79],v[100:103]
ds_read_b64_tr_b16 a[132:133],v5 offset:0
v_mfma_f32_16x16x32_bf16 v[100:103],a[128:131],a[72:75],v[100:103]
s_waitcnt lgkmcnt(1)
ds_read_b64_tr_b16 a[128:129],v4 offset:0
ds_read_b64_tr_b16 a[130:131],v4 offset:6144
ds_read_b64_tr_b16 a[134:135],v5 offset:6144
v_mfma_f32_16x16x32_bf16 v[160:163],a[120:123],v[20:23],v[160:163]
s_add_u32 m0,s23,0
ds_read_b64_tr_b16 a[142:143],v3 offset:6272
v_fma_f32 v83,v83,s36,v14
v_mfma_f32_16x16x32_bf16 v[164:167],a[124:127],v[20:23],v[164:167]
ds_read_b64_tr_b16 a[138:139],v2 offset:6272
v_fma_f32 v82,v82,s36,v14
v_mfma_f32_16x16x32_bf16 v[212:215],a[124:127],v[24:27],v[212:215]
ds_read_b64_tr_b16 a[136:137],v2 offset:128
v_fma_f32 v88,v88,s36,v15
v_mfma_f32_16x16x32_bf16 v[208:211],a[120:123],v[24:27],v[208:211]
ds_read_b64_tr_b16 a[140:141],v3 offset:128
v_fma_f32 v91,v91,s36,v15
v_mfma_f32_16x16x32_bf16 v[112:115],a[120:123],v[28:31],v[112:115]
ds_read_b64_tr_b16 a[146:147],v4 offset:6272
v_fma_f32 v89,v89,s36,v15
v_mfma_f32_16x16x32_bf16 v[116:119],a[124:127],v[28:31],v[116:119]
ds_read_b64_tr_b16 a[150:151],v5 offset:6272
v_fma_f32 v90,v90,s36,v15
v_mfma_f32_16x16x32_bf16 a[164:167],a[124:127],v[32:35],a[164:167]
ds_read_b64_tr_b16 a[144:145],v4 offset:128
v_fma_f32 v96,v96,s36,v16
v_mfma_f32_16x16x32_bf16 a[160:163],a[120:123],v[32:35],a[160:163]
s_waitcnt lgkmcnt(6)
ds_read_b64_tr_b16 a[148:149],v5 offset:128
v_fma_f32 v98,v98,s36,v16
v_mfma_f32_16x16x32_bf16 a[168:171],a[128:131],v[32:35],a[168:171]
ds_read_b64_tr_b16 a[120:121],v2 offset:256
v_fma_f32 v99,v99,s36,v16
v_mfma_f32_16x16x32_bf16 a[172:175],a[132:135],v[32:35],a[172:175]
ds_read_b64_tr_b16 a[126:127],v3 offset:6400
v_fma_f32 v97,v97,s36,v16
v_mfma_f32_16x16x32_bf16 v[124:127],a[132:135],v[28:31],v[124:127]
ds_read_b64_tr_b16 a[122:123],v2 offset:6400
v_fma_f32 v79,v79,s36,v13
v_mfma_f32_16x16x32_bf16 v[120:123],a[128:131],v[28:31],v[120:123]
ds_read_b64_tr_b16 a[124:125],v3 offset:256
v_fma_f32 v77,v77,s36,v13
v_mfma_f32_16x16x32_bf16 v[216:219],a[128:131],v[24:27],v[216:219]
v_exp_f32 v82,v82
v_mfma_f32_16x16x32_bf16 v[220:223],a[132:135],v[24:27],v[220:223]
v_exp_f32 v83,v83
v_mfma_f32_16x16x32_bf16 v[172:175],a[132:135],v[20:23],v[172:175]
ds_read_b64_tr_b16 a[132:133],v5 offset:256
v_cvt_pk_bf16_f32 v49,v82,v83
v_mfma_f32_16x16x32_bf16 v[168:171],a[128:131],v[20:23],v[168:171]
s_waitcnt lgkmcnt(4)
ds_read_b64_tr_b16 a[134:135],v5 offset:6400
v_fma_f32 v76,v76,s36,v13
v_mfma_f32_16x16x32_bf16 v[176:179],a[136:139],v[20:23],v[176:179]
ds_read_b64_tr_b16 a[128:129],v4 offset:256
v_fma_f32 v78,v78,s36,v13
v_mfma_f32_16x16x32_bf16 v[180:183],a[140:143],v[20:23],v[180:183]
ds_read_b64_tr_b16 a[130:131],v4 offset:6400
v_fma_f32 v86,v86,s36,v14
v_mfma_f32_16x16x32_bf16 v[228:231],a[140:143],v[24:27],v[228:231]
v_exp_f32 v90,v90
v_mfma_f32_16x16x32_bf16 v[224:227],a[136:139],v[24:27],v[224:227]
v_exp_f32 v88,v88
v_mfma_f32_16x16x32_bf16 v[128:131],a[136:139],v[28:31],v[128:131]
v_exp_f32 v89,v89
v_mfma_f32_16x16x32_bf16 v[132:135],a[140:143],v[28:31],v[132:135]
v_cvt_pk_bf16_f32 v52,v88,v89
v_fma_f32 v84,v84,s36,v14
v_mfma_f32_16x16x32_bf16 a[180:183],a[140:143],v[32:35],a[180:183]
v_exp_f32 v91,v91
v_mfma_f32_16x16x32_bf16 a[176:179],a[136:139],v[32:35],a[176:179]
v_cvt_pk_bf16_f32 v53,v90,v91
v_fma_f32 v85,v85,s36,v14
v_mfma_f32_16x16x32_bf16 a[184:187],a[144:147],v[32:35],a[184:187]
v_exp_f32 v99,v99
v_mfma_f32_16x16x32_bf16 a[188:191],a[148:151],v[32:35],a[188:191]
v_exp_f32 v97,v97
v_mfma_f32_16x16x32_bf16 v[140:143],a[148:151],v[28:31],v[140:143]
v_exp_f32 v96,v96
v_mfma_f32_16x16x32_bf16 v[136:139],a[144:147],v[28:31],v[136:139]
v_cvt_pk_bf16_f32 v56,v96,v97
v_fma_f32 v87,v87,s36,v14
v_mfma_f32_16x16x32_bf16 v[232:235],a[144:147],v[24:27],v[232:235]
v_exp_f32 v98,v98
v_mfma_f32_16x16x32_bf16 v[236:239],a[148:151],v[24:27],v[236:239]
v_cvt_pk_bf16_f32 v57,v98,v99
v_fma_f32 v94,v94,s36,v15
v_mfma_f32_16x16x32_bf16 v[188:191],a[148:151],v[20:23],v[188:191]
v_exp_f32 v76,v76
v_mfma_f32_16x16x32_bf16 v[184:187],a[144:147],v[20:23],v[184:187]
s_waitcnt lgkmcnt(0)
v_exp_f32 v79,v79
v_mfma_f32_16x16x32_bf16 v[192:195],a[120:123],v[20:23],v[192:195]
v_exp_f32 v78,v78
v_mfma_f32_16x16x32_bf16 v[196:199],a[124:127],v[20:23],v[196:199]
s_waitcnt vmcnt(9)
ds_read_b128 a[156:159],v10 offset:6144
v_cvt_pk_bf16_f32 v47,v78,v79
v_mfma_f32_16x16x32_bf16 v[244:247],a[124:127],v[24:27],v[244:247]
s_barrier
v_mfma_f32_16x16x32_bf16 v[240:243],a[120:123],v[24:27],v[240:243]
ds_read_b128 a[148:151],v1 offset:24704
v_fma_f32 v92,v92,s36,v15
v_mfma_f32_16x16x32_bf16 v[144:147],a[120:123],v[28:31],v[144:147]
ds_read_b128 a[144:147],v0 offset:24704
v_fma_f32 v93,v93,s36,v15
v_mfma_f32_16x16x32_bf16 v[148:151],a[124:127],v[28:31],v[148:151]
ds_read_b128 a[140:143],v1 offset:24576
v_fma_f32 v95,v95,s36,v15
v_mfma_f32_16x16x32_bf16 a[196:199],a[124:127],v[32:35],a[196:199]
ds_read_b128 a[124:127],v1 offset:24832
v_fma_f32 v102,v102,s36,v16
v_mfma_f32_16x16x32_bf16 a[192:195],a[120:123],v[32:35],a[192:195]
ds_read_b128 a[120:123],v0 offset:24832
v_fma_f32 v100,v100,s36,v16
v_mfma_f32_16x16x32_bf16 a[200:203],a[128:131],v[32:35],a[200:203]
buffer_load_dwordx4 v6,s[8:11],s21 offen offset:0 lds
v_mfma_f32_16x16x32_bf16 a[204:207],a[132:135],v[32:35],a[204:207]
ds_read_b128 a[136:139],v0 offset:24576
v_fma_f32 v101,v101,s36,v16
v_mfma_f32_16x16x32_bf16 v[156:159],a[132:135],v[28:31],v[156:159]
v_exp_f32 v77,v77
v_mfma_f32_16x16x32_bf16 v[152:155],a[128:131],v[28:31],v[152:155]
v_cvt_pk_bf16_f32 v46,v76,v77
v_fma_f32 v103,v103,s36,v16
v_mfma_f32_16x16x32_bf16 v[248:251],a[128:131],v[24:27],v[248:251]
v_exp_f32 v86,v86
v_mfma_f32_16x16x32_bf16 v[252:255],a[132:135],v[24:27],v[252:255]
v_exp_f32 v87,v87
v_mfma_f32_16x16x32_bf16 v[204:207],a[132:135],v[20:23],v[204:207]
ds_read_b128 a[132:135],v1 offset:30720
v_cvt_pk_bf16_f32 v51,v86,v87
v_mfma_f32_16x16x32_bf16 v[200:203],a[128:131],v[20:23],v[200:203]
s_waitcnt lgkmcnt(2)
ds_read_b128 a[128:131],v0 offset:30720
v_mfma_f32_16x16x32_bf16 v[72:75],a[124:127],a[20:23],0
v_exp_f32 v85,v85
v_mfma_f32_16x16x32_bf16 v[72:75],a[120:123],a[16:19],v[72:75]
buffer_store_dwordx4 a[156:159],v9,s[16:19],s27 offen offset:0 nt
buffer_load_dwordx4 v7,s[8:11],s21 offen offset:1024 lds
v_mfma_f32_16x16x32_bf16 v[72:75],a[148:151],a[12:15],v[72:75]
ds_read_b128 a[156:159],v10 offset:7168
v_mfma_f32_16x16x32_bf16 v[72:75],a[144:147],a[8:11],v[72:75]
v_exp_f32 v84,v84
v_mfma_f32_16x16x32_bf16 v[72:75],a[140:143],a[4:7],v[72:75]
s_waitcnt lgkmcnt(3)
v_cvt_pk_bf16_f32 v50,v84,v85
v_mfma_f32_16x16x32_bf16 v[72:75],a[136:139],a[0:3],v[72:75]
v_exp_f32 v93,v93
v_smfmac_f32_16x16x64_bf16 v[60:63],a[152:155],v[44:51],v18
v_mfma_f32_16x16x32_bf16 v[80:83],a[136:139],a[24:27],0
v_exp_f32 v94,v94
v_mfma_f32_16x16x32_bf16 v[80:83],a[140:143],a[28:31],v[80:83]
v_exp_f32 v92,v92
v_mfma_f32_16x16x32_bf16 v[80:83],a[144:147],a[32:35],v[80:83]
buffer_load_dwordx4 v8,s[8:11],s21 offen offset:2048 lds
v_mfma_f32_16x16x32_bf16 v[80:83],a[148:151],a[36:39],v[80:83]
s_add_u32 s21,s21,12288
v_cvt_pk_bf16_f32 v54,v92,v93
v_fma_f32 v74,v74,s36,v13
v_mfma_f32_16x16x32_bf16 v[80:83],a[120:123],a[40:43],v[80:83]
s_cmp_eq_u32 s38,1
v_exp_f32 v95,v95
v_mfma_f32_16x16x32_bf16 v[80:83],a[124:127],a[44:47],v[80:83]
s_cselect_b32 s20,s26,s20
v_cvt_pk_bf16_f32 v55,v94,v95
v_fma_f32 v75,v75,s36,v13
v_mfma_f32_16x16x32_bf16 v[88:91],a[124:127],a[68:71],0
s_add_u32 m0,s22,12288
v_exp_f32 v103,v103
v_mfma_f32_16x16x32_bf16 v[88:91],a[120:123],a[64:67],v[88:91]
v_exp_f32 v100,v100
v_mfma_f32_16x16x32_bf16 v[88:91],a[148:151],a[60:63],v[88:91]
v_exp_f32 v102,v102
v_mfma_f32_16x16x32_bf16 v[88:91],a[144:147],a[56:59],v[88:91]
v_cvt_pk_bf16_f32 v59,v102,v103
v_fma_f32 v73,v73,s36,v13
v_mfma_f32_16x16x32_bf16 v[88:91],a[140:143],a[52:55],v[88:91]
v_exp_f32 v101,v101
v_mfma_f32_16x16x32_bf16 v[88:91],a[136:139],a[48:51],v[88:91]
s_waitcnt lgkmcnt(0)
buffer_store_dwordx4 a[156:159],v9,s[16:19],s27 offen offset:128 nt
buffer_load_dwordx4 v6,s[4:7],s20 offen offset:0 lds
v_mfma_f32_16x16x32_bf16 v[96:99],a[136:139],a[72:75],0
ds_read_b128 a[156:159],v10 offset:8192
v_cvt_pk_bf16_f32 v58,v100,v101
v_mfma_f32_16x16x32_bf16 v[96:99],a[140:143],a[76:79],v[96:99]
ds_read_b128 a[136:139],v0 offset:30848
v_fma_f32 v80,v80,s36,v14
v_smfmac_f32_16x16x64_bf16 v[64:67],a[152:155],v[52:59],v18
ds_read_b128 a[140:143],v1 offset:30848
v_mfma_f32_16x16x32_bf16 v[96:99],a[144:147],a[80:83],v[96:99]
ds_read_b128 a[144:147],v0 offset:30976
v_mfma_f32_16x16x32_bf16 v[96:99],a[148:151],a[84:87],v[96:99]
ds_read_b128 a[148:151],v1 offset:30976
v_mfma_f32_16x16x32_bf16 v[96:99],a[120:123],a[88:91],v[96:99]
v_fma_f32 v81,v81,s36,v14
v_fma_f32 v72,v72,s36,v13
v_mfma_f32_16x16x32_bf16 v[96:99],a[124:127],a[92:95],v[96:99]
v_exp_f32 v80,v80
v_mfma_f32_16x16x32_bf16 v[76:79],a[128:131],a[0:3],0
buffer_load_dwordx4 v7,s[4:7],s20 offen offset:1024 lds
v_mfma_f32_16x16x32_bf16 v[76:79],a[132:135],a[4:7],v[76:79]
s_waitcnt lgkmcnt(3)
v_exp_f32 v74,v74
v_mfma_f32_16x16x32_bf16 v[76:79],a[136:139],a[8:11],v[76:79]
s_waitcnt lgkmcnt(2)
v_exp_f32 v75,v75
v_mfma_f32_16x16x32_bf16 v[76:79],a[140:143],a[12:15],v[76:79]
s_waitcnt lgkmcnt(1)
v_cvt_pk_bf16_f32 v21,v74,v75
v_mfma_f32_16x16x32_bf16 v[76:79],a[144:147],a[16:19],v[76:79]
s_waitcnt lgkmcnt(0)
v_exp_f32 v72,v72
v_mfma_f32_16x16x32_bf16 v[76:79],a[148:151],a[20:23],v[76:79]
v_exp_f32 v81,v81
v_mfma_f32_16x16x32_bf16 v[84:87],a[148:151],a[44:47],0
v_cvt_pk_bf16_f32 v24,v80,v81
v_mfma_f32_16x16x32_bf16 v[84:87],a[144:147],a[40:43],v[84:87]
v_exp_f32 v73,v73
v_mfma_f32_16x16x32_bf16 v[84:87],a[140:143],a[36:39],v[84:87]
v_cvt_pk_bf16_f32 v20,v72,v73
v_mfma_f32_16x16x32_bf16 v[84:87],a[136:139],a[32:35],v[84:87]
buffer_store_dwordx4 a[156:159],v9,s[16:19],s27 offen offset:256 nt
buffer_load_dwordx4 v8,s[4:7],s20 offen offset:2048 lds
v_mfma_f32_16x16x32_bf16 v[84:87],a[132:135],a[28:31],v[84:87]
s_add_u32 s20,s20,12288
ds_read_b64_tr_b16 a[120:121],v2 offset:12288
v_mfma_f32_16x16x32_bf16 v[84:87],a[128:131],a[24:27],v[84:87]
s_add_u32 s27,s27,3072
ds_read_b64_tr_b16 a[122:123],v2 offset:18432
v_mfma_f32_16x16x32_bf16 v[92:95],a[128:131],a[48:51],0
ds_read_b64_tr_b16 a[124:125],v3 offset:12288
v_mfma_f32_16x16x32_bf16 v[92:95],a[132:135],a[52:55],v[92:95]
ds_read_b64_tr_b16 a[126:127],v3 offset:18432
v_mfma_f32_16x16x32_bf16 v[92:95],a[136:139],a[56:59],v[92:95]
v_mfma_f32_16x16x32_bf16 v[92:95],a[140:143],a[60:63],v[92:95]
v_mfma_f32_16x16x32_bf16 v[92:95],a[144:147],a[64:67],v[92:95]
v_mfma_f32_16x16x32_bf16 v[92:95],a[148:151],a[68:71],v[92:95]
v_mfma_f32_16x16x32_bf16 v[100:103],a[148:151],a[92:95],0
v_mfma_f32_16x16x32_bf16 v[100:103],a[144:147],a[88:91],v[100:103]
v_mfma_f32_16x16x32_bf16 v[100:103],a[140:143],a[84:87],v[100:103]
v_mfma_f32_16x16x32_bf16 v[100:103],a[136:139],a[80:83],v[100:103]
v_mfma_f32_16x16x32_bf16 v[100:103],a[132:135],a[76:79],v[100:103]
ds_read_b64_tr_b16 a[134:135],v5 offset:18432
v_mfma_f32_16x16x32_bf16 v[100:103],a[128:131],a[72:75],v[100:103]
s_waitcnt lgkmcnt(1)
ds_read_b64_tr_b16 a[130:131],v4 offset:18432
ds_read_b64_tr_b16 a[128:129],v4 offset:12288
ds_read_b64_tr_b16 a[132:133],v5 offset:12288
v_mfma_f32_16x16x32_bf16 v[160:163],a[120:123],v[44:47],v[160:163]
s_add_u32 m0,s29,0
ds_read_b64_tr_b16 a[136:137],v2 offset:12416
v_fma_f32 v82,v82,s36,v14
v_mfma_f32_16x16x32_bf16 v[164:167],a[124:127],v[44:47],v[164:167]
ds_read_b64_tr_b16 a[138:139],v2 offset:18560
v_fma_f32 v83,v83,s36,v14
v_mfma_f32_16x16x32_bf16 v[212:215],a[124:127],v[48:51],v[212:215]
ds_read_b64_tr_b16 a[140:141],v3 offset:12416
v_fma_f32 v88,v88,s36,v15
v_mfma_f32_16x16x32_bf16 v[208:211],a[120:123],v[48:51],v[208:211]
ds_read_b64_tr_b16 a[142:143],v3 offset:18560
v_fma_f32 v89,v89,s36,v15
v_mfma_f32_16x16x32_bf16 v[112:115],a[120:123],v[52:55],v[112:115]
ds_read_b64_tr_b16 a[144:145],v4 offset:12416
v_fma_f32 v90,v90,s36,v15
v_mfma_f32_16x16x32_bf16 v[116:119],a[124:127],v[52:55],v[116:119]
ds_read_b64_tr_b16 a[146:147],v4 offset:18560
v_fma_f32 v91,v91,s36,v15
v_mfma_f32_16x16x32_bf16 a[164:167],a[124:127],v[56:59],a[164:167]
buffer_load_dwordx4 v6,s[12:15],s28 offen offset:0 nt lds
v_mfma_f32_16x16x32_bf16 a[160:163],a[120:123],v[56:59],a[160:163]
s_waitcnt lgkmcnt(5)
ds_read_b64_tr_b16 a[148:149],v5 offset:12416
v_fma_f32 v96,v96,s36,v16
v_mfma_f32_16x16x32_bf16 a[168:171],a[128:131],v[56:59],a[168:171]
ds_read_b64_tr_b16 a[150:151],v5 offset:18560
v_fma_f32 v97,v97,s36,v16
v_mfma_f32_16x16x32_bf16 a[172:175],a[132:135],v[56:59],a[172:175]
ds_read_b64_tr_b16 a[120:121],v2 offset:12544
v_fma_f32 v98,v98,s36,v16
v_mfma_f32_16x16x32_bf16 v[124:127],a[132:135],v[52:55],v[124:127]
ds_read_b64_tr_b16 a[122:123],v2 offset:18688
v_fma_f32 v99,v99,s36,v16
v_mfma_f32_16x16x32_bf16 v[120:123],a[128:131],v[52:55],v[120:123]
ds_read_b64_tr_b16 a[124:125],v3 offset:12544
v_fma_f32 v76,v76,s36,v13
v_mfma_f32_16x16x32_bf16 v[216:219],a[128:131],v[48:51],v[216:219]
ds_read_b64_tr_b16 a[126:127],v3 offset:18688
v_fma_f32 v77,v77,s36,v13
v_mfma_f32_16x16x32_bf16 v[220:223],a[132:135],v[48:51],v[220:223]
buffer_load_dwordx4 v7,s[12:15],s28 offen offset:1024 nt lds
v_mfma_f32_16x16x32_bf16 v[172:175],a[132:135],v[44:47],v[172:175]
ds_read_b64_tr_b16 a[132:133],v5 offset:12544
v_fma_f32 v78,v78,s36,v13
v_mfma_f32_16x16x32_bf16 v[168:171],a[128:131],v[44:47],v[168:171]
s_waitcnt lgkmcnt(5)
ds_read_b64_tr_b16 a[128:129],v4 offset:12544
v_fma_f32 v79,v79,s36,v13
v_mfma_f32_16x16x32_bf16 v[176:179],a[136:139],v[44:47],v[176:179]
ds_read_b64_tr_b16 a[130:131],v4 offset:18688
v_fma_f32 v84,v84,s36,v14
v_mfma_f32_16x16x32_bf16 v[180:183],a[140:143],v[44:47],v[180:183]
ds_read_b64_tr_b16 a[134:135],v5 offset:18688
v_fma_f32 v85,v85,s36,v14
v_mfma_f32_16x16x32_bf16 v[228:231],a[140:143],v[48:51],v[228:231]
v_exp_f32 v82,v82
v_mfma_f32_16x16x32_bf16 v[224:227],a[136:139],v[48:51],v[224:227]
v_exp_f32 v83,v83
v_mfma_f32_16x16x32_bf16 v[128:131],a[136:139],v[52:55],v[128:131]
v_cvt_pk_bf16_f32 v25,v82,v83
v_fma_f32 v86,v86,s36,v14
v_mfma_f32_16x16x32_bf16 v[132:135],a[140:143],v[52:55],v[132:135]
buffer_load_dwordx4 v8,s[12:15],s28 offen offset:2048 nt lds
v_mfma_f32_16x16x32_bf16 a[180:183],a[140:143],v[56:59],a[180:183]
s_add_u32 s28,s28,3072
v_exp_f32 v88,v88
v_mfma_f32_16x16x32_bf16 a[176:179],a[136:139],v[56:59],a[176:179]
s_add_u32 s29,s29,3072
v_exp_f32 v89,v89
v_mfma_f32_16x16x32_bf16 a[184:187],a[144:147],v[56:59],a[184:187]
s_cmp_eq_u32 s38,1
v_exp_f32 v90,v90
v_mfma_f32_16x16x32_bf16 a[188:191],a[148:151],v[56:59],a[188:191]
s_cselect_b32 s21,s26,s21
v_exp_f32 v91,v91
v_mfma_f32_16x16x32_bf16 v[140:143],a[148:151],v[52:55],v[140:143]
s_add_u32 m0,s23,12288
v_cvt_pk_bf16_f32 v28,v88,v89
v_cvt_pk_bf16_f32 v29,v90,v91
v_mfma_f32_16x16x32_bf16 v[136:139],a[144:147],v[52:55],v[136:139]
v_exp_f32 v96,v96
v_mfma_f32_16x16x32_bf16 v[232:235],a[144:147],v[48:51],v[232:235]
v_exp_f32 v97,v97
v_mfma_f32_16x16x32_bf16 v[236:239],a[148:151],v[48:51],v[236:239]
v_exp_f32 v98,v98
v_mfma_f32_16x16x32_bf16 v[188:191],a[148:151],v[44:47],v[188:191]
v_exp_f32 v99,v99
v_mfma_f32_16x16x32_bf16 v[184:187],a[144:147],v[44:47],v[184:187]
s_waitcnt lgkmcnt(0)
v_cvt_pk_bf16_f32 v32,v96,v97
v_cvt_pk_bf16_f32 v33,v98,v99
v_mfma_f32_16x16x32_bf16 v[192:195],a[120:123],v[44:47],v[192:195]
s_waitcnt vmcnt(12)
v_exp_f32 v76,v76
v_mfma_f32_16x16x32_bf16 v[196:199],a[124:127],v[44:47],v[196:199]
s_barrier
v_mfma_f32_16x16x32_bf16 v[244:247],a[124:127],v[48:51],v[244:247]
ds_read_b128 a[148:151],v1 offset:128
v_fma_f32 v87,v87,s36,v14
v_mfma_f32_16x16x32_bf16 v[240:243],a[120:123],v[48:51],v[240:243]
ds_read_b128 a[144:147],v0 offset:128
v_fma_f32 v92,v92,s36,v15
v_mfma_f32_16x16x32_bf16 v[144:147],a[120:123],v[52:55],v[144:147]
ds_read_b128 a[140:143],v1 offset:0
v_fma_f32 v93,v93,s36,v15
v_mfma_f32_16x16x32_bf16 v[148:151],a[124:127],v[52:55],v[148:151]
ds_read_b128 a[136:139],v0 offset:0
v_fma_f32 v94,v94,s36,v15
v_mfma_f32_16x16x32_bf16 a[196:199],a[124:127],v[56:59],a[196:199]
ds_read_b128 a[124:127],v1 offset:256
v_fma_f32 v95,v95,s36,v15
v_mfma_f32_16x16x32_bf16 a[192:195],a[120:123],v[56:59],a[192:195]
buffer_load_dwordx4 v6,s[8:11],s21 offen offset:0 lds
v_mfma_f32_16x16x32_bf16 a[200:203],a[128:131],v[56:59],a[200:203]
ds_read_b128 a[120:123],v0 offset:256
v_fma_f32 v100,v100,s36,v16
v_mfma_f32_16x16x32_bf16 a[204:207],a[132:135],v[56:59],a[204:207]
v_exp_f32 v77,v77
v_mfma_f32_16x16x32_bf16 v[156:159],a[132:135],v[52:55],v[156:159]
v_exp_f32 v78,v78
v_mfma_f32_16x16x32_bf16 v[152:155],a[128:131],v[52:55],v[152:155]
v_exp_f32 v79,v79
v_mfma_f32_16x16x32_bf16 v[248:251],a[128:131],v[48:51],v[248:251]
v_cvt_pk_bf16_f32 v22,v76,v77
v_cvt_pk_bf16_f32 v23,v78,v79
v_mfma_f32_16x16x32_bf16 v[252:255],a[132:135],v[48:51],v[252:255]
v_exp_f32 v84,v84
v_mfma_f32_16x16x32_bf16 v[204:207],a[132:135],v[44:47],v[204:207]
ds_read_b128 a[132:135],v1 offset:6144
v_fma_f32 v101,v101,s36,v16
v_mfma_f32_16x16x32_bf16 v[200:203],a[128:131],v[44:47],v[200:203]
s_waitcnt lgkmcnt(1)
ds_read_b128 a[128:131],v0 offset:6144
v_fma_f32 v102,v102,s36,v16
v_mfma_f32_16x16x32_bf16 v[72:75],a[124:127],a[20:23],0
buffer_load_dwordx4 v7,s[8:11],s21 offen offset:1024 lds
v_mfma_f32_16x16x32_bf16 v[72:75],a[120:123],a[16:19],v[72:75]
v_exp_f32 v85,v85
v_mfma_f32_16x16x32_bf16 v[72:75],a[148:151],a[12:15],v[72:75]
v_exp_f32 v86,v86
v_mfma_f32_16x16x32_bf16 v[72:75],a[144:147],a[8:11],v[72:75]
v_exp_f32 v87,v87
v_mfma_f32_16x16x32_bf16 v[72:75],a[140:143],a[4:7],v[72:75]
v_cvt_pk_bf16_f32 v26,v84,v85
v_cvt_pk_bf16_f32 v27,v86,v87
v_mfma_f32_16x16x32_bf16 v[72:75],a[136:139],a[0:3],v[72:75]
v_exp_f32 v92,v92
v_smfmac_f32_16x16x64_bf16 v[60:63],a[152:155],v[20:27],v18
v_fma_f32 v103,v103,s36,v16
v_mfma_f32_16x16x32_bf16 v[80:83],a[136:139],a[24:27],0
v_exp_f32 v93,v93
v_mfma_f32_16x16x32_bf16 v[80:83],a[140:143],a[28:31],v[80:83]
buffer_load_dwordx4 v8,s[8:11],s21 offen offset:2048 lds
v_mfma_f32_16x16x32_bf16 v[80:83],a[144:147],a[32:35],v[80:83]
s_add_u32 s21,s21,12288
v_exp_f32 v94,v94
v_mfma_f32_16x16x32_bf16 v[80:83],a[148:151],a[36:39],v[80:83]
s_add_u32 m0,s22,24576
v_exp_f32 v95,v95
v_mfma_f32_16x16x32_bf16 v[80:83],a[120:123],a[40:43],v[80:83]
v_cvt_pk_bf16_f32 v30,v92,v93
v_cvt_pk_bf16_f32 v31,v94,v95
v_mfma_f32_16x16x32_bf16 v[80:83],a[124:127],a[44:47],v[80:83]
v_exp_f32 v100,v100
v_mfma_f32_16x16x32_bf16 v[88:91],a[124:127],a[68:71],0
v_exp_f32 v101,v101
v_mfma_f32_16x16x32_bf16 v[88:91],a[120:123],a[64:67],v[88:91]
v_exp_f32 v102,v102
v_mfma_f32_16x16x32_bf16 v[88:91],a[148:151],a[60:63],v[88:91]
v_exp_f32 v103,v103
v_mfma_f32_16x16x32_bf16 v[88:91],a[144:147],a[56:59],v[88:91]
v_cvt_pk_bf16_f32 v34,v100,v101
v_cvt_pk_bf16_f32 v35,v102,v103
v_mfma_f32_16x16x32_bf16 v[88:91],a[140:143],a[52:55],v[88:91]
buffer_load_dwordx4 v6,s[4:7],s20 offen offset:0 lds
v_smfmac_f32_16x16x64_bf16 v[64:67],a[152:155],v[28:35],v18
v_fma_f32 v72,v72,s36,v13
v_mfma_f32_16x16x32_bf16 v[88:91],a[136:139],a[48:51],v[88:91]
v_fma_f32 v73,v73,s36,v13
v_fma_f32 v74,v74,s36,v13
v_mfma_f32_16x16x32_bf16 v[96:99],a[136:139],a[72:75],0
ds_read_b128 a[136:139],v0 offset:6272
v_fma_f32 v75,v75,s36,v13
v_mfma_f32_16x16x32_bf16 v[96:99],a[140:143],a[76:79],v[96:99]
ds_read_b128 a[140:143],v1 offset:6272
v_fma_f32 v80,v80,s36,v14
v_mfma_f32_16x16x32_bf16 v[96:99],a[144:147],a[80:83],v[96:99]
ds_read_b128 a[144:147],v0 offset:6400
v_fma_f32 v81,v81,s36,v14
v_mfma_f32_16x16x32_bf16 v[96:99],a[148:151],a[84:87],v[96:99]
ds_read_b128 a[148:151],v1 offset:6400
v_add_u32 v10,9216,v10
v_mfma_f32_16x16x32_bf16 v[96:99],a[120:123],a[88:91],v[96:99]
v_exp_f32 v72,v72
v_mfma_f32_16x16x32_bf16 v[96:99],a[124:127],a[92:95],v[96:99]
s_waitcnt lgkmcnt(4)
v_exp_f32 v73,v73
v_mfma_f32_16x16x32_bf16 v[76:79],a[128:131],a[0:3],0
buffer_load_dwordx4 v7,s[4:7],s20 offen offset:1024 lds
v_mfma_f32_16x16x32_bf16 v[76:79],a[132:135],a[4:7],v[76:79]
s_waitcnt lgkmcnt(3)
v_exp_f32 v74,v74
v_mfma_f32_16x16x32_bf16 v[76:79],a[136:139],a[8:11],v[76:79]
s_waitcnt lgkmcnt(2)
v_exp_f32 v75,v75
v_mfma_f32_16x16x32_bf16 v[76:79],a[140:143],a[12:15],v[76:79]
s_waitcnt lgkmcnt(0)
v_exp_f32 v80,v80
v_mfma_f32_16x16x32_bf16 v[76:79],a[144:147],a[16:19],v[76:79]
v_exp_f32 v81,v81
v_mfma_f32_16x16x32_bf16 v[76:79],a[148:151],a[20:23],v[76:79]
v_cvt_pk_bf16_f32 v44,v72,v73
v_cvt_pk_bf16_f32 v45,v74,v75
v_mfma_f32_16x16x32_bf16 v[84:87],a[148:151],a[44:47],0
v_cvt_pk_bf16_f32 v48,v80,v81
v_mfma_f32_16x16x32_bf16 v[84:87],a[144:147],a[40:43],v[84:87]
v_mfma_f32_16x16x32_bf16 v[84:87],a[140:143],a[36:39],v[84:87]
v_mfma_f32_16x16x32_bf16 v[84:87],a[136:139],a[32:35],v[84:87]
buffer_load_dwordx4 v8,s[4:7],s20 offen offset:2048 lds
v_mfma_f32_16x16x32_bf16 v[84:87],a[132:135],a[28:31],v[84:87]
s_add_u32 s20,s20,12288
s_add_u32 s38,s38,1
s_cmp_lt_u32 s38,2
v_mfma_f32_16x16x32_bf16 v[84:87],a[128:131],a[24:27],v[84:87]
ds_read_b64_tr_b16 a[120:121],v2 offset:24576
v_mfma_f32_16x16x32_bf16 v[92:95],a[128:131],a[48:51],0
ds_read_b64_tr_b16 a[122:123],v2 offset:30720
v_mfma_f32_16x16x32_bf16 v[92:95],a[132:135],a[52:55],v[92:95]
ds_read_b64_tr_b16 a[124:125],v3 offset:24576
v_mfma_f32_16x16x32_bf16 v[92:95],a[136:139],a[56:59],v[92:95]
ds_read_b64_tr_b16 a[126:127],v3 offset:30720
v_mfma_f32_16x16x32_bf16 v[92:95],a[140:143],a[60:63],v[92:95]
v_mfma_f32_16x16x32_bf16 v[92:95],a[144:147],a[64:67],v[92:95]
v_mfma_f32_16x16x32_bf16 v[92:95],a[148:151],a[68:71],v[92:95]
v_mfma_f32_16x16x32_bf16 v[100:103],a[148:151],a[92:95],0
v_mfma_f32_16x16x32_bf16 v[100:103],a[144:147],a[88:91],v[100:103]
v_mfma_f32_16x16x32_bf16 v[100:103],a[140:143],a[84:87],v[100:103]
v_mfma_f32_16x16x32_bf16 v[100:103],a[136:139],a[80:83],v[100:103]
v_mfma_f32_16x16x32_bf16 v[100:103],a[132:135],a[76:79],v[100:103]
ds_read_b64_tr_b16 a[132:133],v5 offset:24576
v_mfma_f32_16x16x32_bf16 v[100:103],a[128:131],a[72:75],v[100:103]
ds_read_b64_tr_b16 a[128:129],v4 offset:24576
ds_read_b64_tr_b16 a[130:131],v4 offset:30720
ds_read_b64_tr_b16 a[134:135],v5 offset:30720
s_cbranch_scc1 L_loop4w0
s_cmp_ge_u32 s69,6
s_cbranch_scc1 L_end4
s_cmp_eq_u32 s40,0
s_cbranch_scc1 L_tr44
s_branch L_tr45
L_tr45:
s_waitcnt vmcnt(43)
s_waitcnt lgkmcnt(3)
v_mfma_f32_16x16x32_bf16 v[160:163],a[120:123],v[20:23],v[160:163]
s_add_u32 m0,s24,0
ds_read_b128 a[4:7],v12 offset:0
v_fma_f32 v79,v79,s36,v13
v_mfma_f32_16x16x32_bf16 v[164:167],a[124:127],v[20:23],v[164:167]
ds_read_b128 a[12:15],v12 offset:128
v_fma_f32 v100,v100,s36,v16
v_mfma_f32_16x16x32_bf16 v[212:215],a[124:127],v[24:27],v[212:215]
ds_read_b128 a[20:23],v12 offset:256
v_fma_f32 v101,v101,s36,v16
v_mfma_f32_16x16x32_bf16 v[208:211],a[120:123],v[24:27],v[208:211]
ds_read_b128 a[8:11],v11 offset:128
v_fma_f32 v89,v89,s36,v15
v_mfma_f32_16x16x32_bf16 v[112:115],a[120:123],v[28:31],v[112:115]
ds_read_b128 a[0:3],v11 offset:0
v_fma_f32 v76,v76,s36,v13
v_mfma_f32_16x16x32_bf16 v[116:119],a[124:127],v[28:31],v[116:119]
ds_read_b128 a[16:19],v11 offset:256
v_fma_f32 v83,v83,s36,v14
v_mfma_f32_16x16x32_bf16 a[164:167],a[124:127],v[32:35],a[164:167]
ds_read_b64_tr_b16 a[138:139],v2 offset:30848
v_fma_f32 v90,v90,s36,v15
v_mfma_f32_16x16x32_bf16 a[160:163],a[120:123],v[32:35],a[160:163]
s_waitcnt lgkmcnt(6)
ds_read_b64_tr_b16 a[136:137],v2 offset:24704
v_fma_f32 v88,v88,s36,v15
v_mfma_f32_16x16x32_bf16 a[168:171],a[128:131],v[32:35],a[168:171]
ds_read_b64_tr_b16 a[142:143],v3 offset:30848
ds_read_b64_tr_b16 a[140:141],v3 offset:24704
ds_read_b64_tr_b16 a[146:147],v4 offset:30848
ds_read_b64_tr_b16 a[144:145],v4 offset:24704
ds_read_b64_tr_b16 a[150:151],v5 offset:30848
ds_read_b64_tr_b16 a[148:149],v5 offset:24704
ds_read_b128 a[32:35],v11 offset:6272
v_mfma_f32_16x16x32_bf16 a[172:175],a[132:135],v[32:35],a[172:175]
v_fma_f32 v91,v91,s36,v15
ds_read_b128 a[40:43],v11 offset:6400
v_mfma_f32_16x16x32_bf16 v[124:127],a[132:135],v[28:31],v[124:127]
s_waitcnt lgkmcnt(10)
buffer_load_dwordx4 v6,s[12:15],s28 offen offset:0 nt lds
v_mfma_f32_16x16x32_bf16 v[120:123],a[128:131],v[28:31],v[120:123]
ds_read_b64_tr_b16 a[122:123],v2 offset:30976
ds_read_b64_tr_b16 a[120:121],v2 offset:24832
ds_read_b64_tr_b16 a[124:125],v3 offset:24832
ds_read_b64_tr_b16 a[126:127],v3 offset:30976
ds_read_b128 a[44:47],v12 offset:6400
v_mfma_f32_16x16x32_bf16 v[216:219],a[128:131],v[24:27],v[216:219]
v_fma_f32 v93,v93,s36,v15
ds_read_b128 a[28:31],v12 offset:6144
v_mfma_f32_16x16x32_bf16 v[220:223],a[132:135],v[24:27],v[220:223]
v_fma_f32 v98,v98,s36,v16
ds_read_b128 a[36:39],v12 offset:6272
v_mfma_f32_16x16x32_bf16 v[172:175],a[132:135],v[20:23],v[172:175]
buffer_load_dwordx4 v7,s[12:15],s28 offen offset:1024 nt lds
v_mfma_f32_16x16x32_bf16 v[168:171],a[128:131],v[20:23],v[168:171]
s_waitcnt lgkmcnt(7)
ds_read_b64_tr_b16 a[130:131],v4 offset:30976
ds_read_b128 a[24:27],v11 offset:6144
v_mfma_f32_16x16x32_bf16 v[176:179],a[136:139],v[20:23],v[176:179]
v_fma_f32 v82,v82,s36,v14
v_exp_f32 v93,v93
v_mfma_f32_16x16x32_bf16 v[180:183],a[140:143],v[20:23],v[180:183]
ds_read_b64_tr_b16 a[128:129],v4 offset:24832
v_fma_f32 v85,v85,s36,v14
v_mfma_f32_16x16x32_bf16 v[228:231],a[140:143],v[24:27],v[228:231]
ds_read_b64_tr_b16 a[134:135],v5 offset:30976
v_exp_f32 v82,v82
v_mfma_f32_16x16x32_bf16 v[224:227],a[136:139],v[24:27],v[224:227]
ds_read_b64_tr_b16 a[132:133],v5 offset:24832
v_fma_f32 v84,v84,s36,v14
v_mfma_f32_16x16x32_bf16 v[128:131],a[136:139],v[28:31],v[128:131]
v_exp_f32 v84,v84
v_mfma_f32_16x16x32_bf16 v[132:135],a[140:143],v[28:31],v[132:135]
buffer_load_dwordx4 v8,s[12:15],s28 offen offset:2048 nt lds
v_mfma_f32_16x16x32_bf16 a[180:183],a[140:143],v[32:35],a[180:183]
s_add_u32 s28,s28,3072
v_fma_f32 v103,v103,s36,v16
v_exp_f32 v103,v103
v_mfma_f32_16x16x32_bf16 a[176:179],a[136:139],v[32:35],a[176:179]
s_add_u32 m0,s24,3072
v_fma_f32 v87,v87,s36,v14
v_exp_f32 v87,v87
v_mfma_f32_16x16x32_bf16 a[184:187],a[144:147],v[32:35],a[184:187]
v_fma_f32 v77,v77,s36,v13
v_exp_f32 v77,v77
v_mfma_f32_16x16x32_bf16 a[188:191],a[148:151],v[32:35],a[188:191]
v_fma_f32 v97,v97,s36,v16
v_exp_f32 v91,v91
v_mfma_f32_16x16x32_bf16 v[140:143],a[148:151],v[28:31],v[140:143]
v_fma_f32 v102,v102,s36,v16
v_exp_f32 v85,v85
v_mfma_f32_16x16x32_bf16 v[136:139],a[144:147],v[28:31],v[136:139]
v_exp_f32 v89,v89
v_mfma_f32_16x16x32_bf16 v[232:235],a[144:147],v[24:27],v[232:235]
buffer_load_dwordx4 v6,s[12:15],s28 offen offset:0 nt lds
v_mfma_f32_16x16x32_bf16 v[236:239],a[148:151],v[24:27],v[236:239]
v_fma_f32 v92,v92,s36,v15
v_exp_f32 v101,v101
v_mfma_f32_16x16x32_bf16 v[188:191],a[148:151],v[20:23],v[188:191]
v_fma_f32 v94,v94,s36,v15
v_fma_f32 v95,v95,s36,v15
v_mfma_f32_16x16x32_bf16 v[184:187],a[144:147],v[20:23],v[184:187]
s_waitcnt lgkmcnt(0)
v_exp_f32 v95,v95
v_mfma_f32_16x16x32_bf16 v[192:195],a[120:123],v[20:23],v[192:195]
v_fma_f32 v86,v86,s36,v14
v_fma_f32 v78,v78,s36,v13
v_mfma_f32_16x16x32_bf16 v[196:199],a[124:127],v[20:23],v[196:199]
v_exp_f32 v92,v92
v_mfma_f32_16x16x32_bf16 v[244:247],a[124:127],v[24:27],v[244:247]
v_exp_f32 v78,v78
v_mfma_f32_16x16x32_bf16 v[240:243],a[120:123],v[24:27],v[240:243]
buffer_load_dwordx4 v7,s[12:15],s28 offen offset:1024 nt lds
v_mfma_f32_16x16x32_bf16 v[144:147],a[120:123],v[28:31],v[144:147]
v_exp_f32 v94,v94
v_mfma_f32_16x16x32_bf16 v[148:151],a[124:127],v[28:31],v[148:151]
v_exp_f32 v90,v90
v_mfma_f32_16x16x32_bf16 a[196:199],a[124:127],v[32:35],a[196:199]
v_fma_f32 v96,v96,s36,v16
v_exp_f32 v96,v96
v_mfma_f32_16x16x32_bf16 a[192:195],a[120:123],v[32:35],a[192:195]
v_fma_f32 v99,v99,s36,v16
v_exp_f32 v83,v83
v_mfma_f32_16x16x32_bf16 a[200:203],a[128:131],v[32:35],a[200:203]
v_exp_f32 v97,v97
v_mfma_f32_16x16x32_bf16 a[204:207],a[132:135],v[32:35],a[204:207]
v_exp_f32 v88,v88
v_mfma_f32_16x16x32_bf16 v[156:159],a[132:135],v[28:31],v[156:159]
v_exp_f32 v98,v98
v_mfma_f32_16x16x32_bf16 v[152:155],a[128:131],v[28:31],v[152:155]
buffer_load_dwordx4 v8,s[12:15],s28 offen offset:2048 nt lds
s_waitcnt vmcnt(20)
s_barrier
v_mfma_f32_16x16x32_bf16 v[248:251],a[128:131],v[24:27],v[248:251]
s_add_u32 s28,s28,3072
ds_read_b64_tr_b16 a[138:139],v2 offset:6144
v_exp_f32 v79,v79
v_mfma_f32_16x16x32_bf16 v[252:255],a[132:135],v[24:27],v[252:255]
s_add_u32 m0,s22,0
ds_read_b64_tr_b16 a[136:137],v2 offset:0
buffer_load_dwordx4 v6,s[4:7],s25 offen offset:0 lds
v_mfma_f32_16x16x32_bf16 v[204:207],a[132:135],v[20:23],v[204:207]
buffer_load_dwordx4 v7,s[4:7],s25 offen offset:1024 lds
v_mfma_f32_16x16x32_bf16 v[200:203],a[128:131],v[20:23],v[200:203]
buffer_load_dwordx4 v8,s[4:7],s25 offen offset:2048 lds
ds_read_b64_tr_b16 a[142:143],v3 offset:6144
ds_read_b64_tr_b16 a[140:141],v3 offset:0
ds_read_b64_tr_b16 a[144:145],v4 offset:0
ds_read_b64_tr_b16 a[146:147],v4 offset:6144
ds_read_b64_tr_b16 a[148:149],v5 offset:0
ds_read_b64_tr_b16 a[150:151],v5 offset:6144
v_exp_f32 v100,v100
v_cvt_pk_bf16_f32 v47,v78,v79
v_cvt_pk_bf16_f32 v49,v82,v83
v_exp_f32 v76,v76
v_exp_f32 v102,v102
v_exp_f32 v86,v86
v_cvt_pk_bf16_f32 v59,v102,v103
v_exp_f32 v99,v99
v_cvt_pk_bf16_f32 v50,v84,v85
v_cvt_pk_bf16_f32 v57,v98,v99
v_cvt_pk_bf16_f32 v55,v94,v95
v_cvt_pk_bf16_f32 v54,v92,v93
v_cvt_pk_bf16_f32 v58,v100,v101
v_cvt_pk_bf16_f32 v51,v86,v87
v_cvt_pk_bf16_f32 v53,v90,v91
v_cvt_pk_bf16_f32 v46,v76,v77
v_cvt_pk_bf16_f32 v52,v88,v89
v_cvt_pk_bf16_f32 v56,v96,v97
v_smfmac_f32_16x16x64_bf16 v[60:63],a[152:155],v[44:51],v18
v_subrev_u32 v10,18432,v10
v_smfmac_f32_16x16x64_bf16 v[64:67],a[152:155],v[52:59],v18
s_waitcnt lgkmcnt(0)
v_mfma_f32_16x16x32_bf16 v[160:163],a[136:139],v[44:47],v[160:163]
s_add_u32 s87,s42,18432
ds_read_b64_tr_b16 a[120:121],v2 offset:128
v_mbcnt_lo_u32_b32 v39,-1,0
v_mfma_f32_16x16x32_bf16 v[164:167],a[140:143],v[44:47],v[164:167]
ds_read_b64_tr_b16 a[122:123],v2 offset:6272
v_mbcnt_hi_u32_b32 v39,-1,v39
v_mfma_f32_16x16x32_bf16 v[212:215],a[140:143],v[48:51],v[212:215]
ds_read_b64_tr_b16 a[124:125],v3 offset:128
v_lshrrev_b32 v19,5,v39
v_mfma_f32_16x16x32_bf16 v[208:211],a[136:139],v[48:51],v[208:211]
ds_read_b64_tr_b16 a[126:127],v3 offset:6272
v_and_b32 v38,7,v39
v_mfma_f32_16x16x32_bf16 v[112:115],a[136:139],v[52:55],v[112:115]
ds_read_b64_tr_b16 a[128:129],v4 offset:128
v_xor_b32 v38,v38,v19
v_mfma_f32_16x16x32_bf16 v[116:119],a[140:143],v[52:55],v[116:119]
ds_read_b64_tr_b16 a[130:131],v4 offset:6272
v_and_b32 v19,15,v39
v_mfma_f32_16x16x32_bf16 a[164:167],a[140:143],v[56:59],a[164:167]
ds_read_b64_tr_b16 a[134:135],v5 offset:6272
v_lshl_add_u32 v19,v19,7,s24
v_mfma_f32_16x16x32_bf16 a[160:163],a[136:139],v[56:59],a[160:163]
ds_read_b64_tr_b16 a[132:133],v5 offset:128
v_lshl_add_u32 v19,v38,4,v19
v_mfma_f32_16x16x32_bf16 a[168:171],a[144:147],v[56:59],a[168:171]
ds_read_b64_tr_b16 a[136:137],v2 offset:256
v_bfe_u32 v38,v39,4,1
v_mfma_f32_16x16x32_bf16 a[172:175],a[148:151],v[56:59],a[172:175]
ds_read_b64_tr_b16 a[138:139],v2 offset:6400
v_lshl_add_u32 v36,v38,3,v19
v_mfma_f32_16x16x32_bf16 v[124:127],a[148:151],v[52:55],v[124:127]
ds_read_b64_tr_b16 a[142:143],v3 offset:6400
v_xor_b32 v38,64,v36
v_mfma_f32_16x16x32_bf16 v[120:123],a[144:147],v[52:55],v[120:123]
ds_read_b64_tr_b16 a[140:141],v3 offset:256
v_xor_b32 v37,32,v36
v_mfma_f32_16x16x32_bf16 v[216:219],a[144:147],v[48:51],v[216:219]
v_bfe_u32 v19,v39,3,1
v_xor_b32 v39,96,v36
v_mfma_f32_16x16x32_bf16 v[220:223],a[148:151],v[48:51],v[220:223]
v_lshlrev_b32 v19,11,v19
v_add_f32 v66,v66,v67
v_mfma_f32_16x16x32_bf16 v[172:175],a[148:151],v[44:47],v[172:175]
ds_read_b64_tr_b16 a[148:149],v5 offset:256
v_accvgpr_read_b32 v75,a163
v_mfma_f32_16x16x32_bf16 v[168:171],a[144:147],v[44:47],v[168:171]
s_waitcnt lgkmcnt(4)
ds_read_b64_tr_b16 a[150:151],v5 offset:6400
v_accvgpr_read_b32 v80,a164
v_mfma_f32_16x16x32_bf16 v[176:179],a[120:123],v[44:47],v[176:179]
ds_read_b64_tr_b16 a[144:145],v4 offset:256
v_accvgpr_read_b32 v81,a165
v_mfma_f32_16x16x32_bf16 v[180:183],a[124:127],v[44:47],v[180:183]
ds_read_b64_tr_b16 a[146:147],v4 offset:6400
v_accvgpr_read_b32 v72,a160
v_mfma_f32_16x16x32_bf16 v[228:231],a[124:127],v[48:51],v[228:231]
v_accvgpr_read_b32 v83,a167
v_rcp_f32 v66,v66
v_mfma_f32_16x16x32_bf16 v[224:227],a[120:123],v[48:51],v[224:227]
v_accvgpr_read_b32 v74,a162
v_accvgpr_read_b32 v73,a161
v_mfma_f32_16x16x32_bf16 v[128:131],a[120:123],v[52:55],v[128:131]
v_accvgpr_read_b32 v82,a166
v_accvgpr_read_b32 v89,a169
v_mfma_f32_16x16x32_bf16 v[132:135],a[124:127],v[52:55],v[132:135]
v_accvgpr_read_b32 v90,a170
v_accvgpr_read_b32 v88,a168
v_mfma_f32_16x16x32_bf16 a[180:183],a[124:127],v[56:59],a[180:183]
v_accvgpr_read_b32 v91,a171
v_accvgpr_read_b32 v98,a174
v_mfma_f32_16x16x32_bf16 a[176:179],a[120:123],v[56:59],a[176:179]
v_accvgpr_read_b32 v97,a173
v_accvgpr_read_b32 v96,a172
v_mfma_f32_16x16x32_bf16 a[184:187],a[128:131],v[56:59],a[184:187]
v_accvgpr_read_b32 v99,a175
v_add_f32 v64,v64,v65
v_mfma_f32_16x16x32_bf16 a[188:191],a[132:135],v[56:59],a[188:191]
v_accvgpr_read_b32 v86,a182
v_accvgpr_read_b32 v84,a180
v_mfma_f32_16x16x32_bf16 v[140:143],a[132:135],v[52:55],v[140:143]
v_accvgpr_read_b32 v79,a179
v_accvgpr_read_b32 v78,a178
v_accvgpr_read_b32 v77,a177
v_accvgpr_read_b32 v87,a183
v_accvgpr_read_b32 v85,a181
v_pk_mul_f32 v[78:79],v[78:79],v[66:67] op_sel_hi:[1,0]
v_pk_mul_f32 v[86:87],v[86:87],v[66:67] op_sel_hi:[1,0]
v_pk_mul_f32 v[82:83],v[82:83],v[66:67] op_sel_hi:[1,0]
v_pk_mul_f32 v[80:81],v[80:81],v[66:67] op_sel_hi:[1,0]
v_pk_mul_f32 v[74:75],v[74:75],v[66:67] op_sel_hi:[1,0]
v_pk_mul_f32 v[72:73],v[72:73],v[66:67] op_sel_hi:[1,0]
v_pk_mul_f32 v[84:85],v[84:85],v[66:67] op_sel_hi:[1,0]
v_accvgpr_read_b32 v76,a176
v_pk_mul_f32 v[76:77],v[76:77],v[66:67] op_sel_hi:[1,0]
v_accvgpr_read_b32 v94,a186
v_accvgpr_read_b32 v95,a187
v_mfma_f32_16x16x32_bf16 v[136:139],a[128:131],v[52:55],v[136:139]
v_accvgpr_read_b32 v92,a184
v_accvgpr_read_b32 v93,a185
v_accvgpr_read_b32 v103,a191
v_accvgpr_read_b32 v102,a190
v_accvgpr_read_b32 v101,a189
v_pk_mul_f32 v[92:93],v[92:93],v[66:67] op_sel_hi:[1,0]
v_pk_mul_f32 v[88:89],v[88:89],v[66:67] op_sel_hi:[1,0]
v_pk_mul_f32 v[94:95],v[94:95],v[66:67] op_sel_hi:[1,0]
v_pk_mul_f32 v[90:91],v[90:91],v[66:67] op_sel_hi:[1,0]
v_accvgpr_read_b32 v100,a188
v_add_f32 v60,v60,v61
v_mfma_f32_16x16x32_bf16 v[232:235],a[128:131],v[48:51],v[232:235]
v_rcp_f32 v60,v60
v_add_f32 v62,v62,v63
v_rcp_f32 v64,v64
v_pk_mul_f32 v[96:97],v[96:97],v[66:67] op_sel_hi:[1,0]
v_pk_mul_f32 v[98:99],v[98:99],v[66:67] op_sel_hi:[1,0]
v_pk_mul_f32 v[100:101],v[100:101],v[66:67] op_sel_hi:[1,0]
v_pk_mul_f32 v[102:103],v[102:103],v[66:67] op_sel_hi:[1,0]
v_rcp_f32 v62,v62
v_cvt_pk_bf16_f32 v84,v84,v85
v_mfma_f32_16x16x32_bf16 v[236:239],a[132:135],v[48:51],v[236:239]
v_min3_f32 v61,v60,v62,v64
v_min_f32 v61,v61,v66
v_mfma_f32_16x16x32_bf16 v[188:191],a[132:135],v[44:47],v[188:191]
v_cmp_nlt_f32 vcc,s37,v61
v_cvt_pk_bf16_f32 v85,v86,v87
v_mfma_f32_16x16x32_bf16 v[184:187],a[128:131],v[44:47],v[184:187]
s_waitcnt lgkmcnt(0)
v_cvt_pk_bf16_f32 v76,v76,v77
v_cvt_pk_bf16_f32 v77,v78,v79
v_mfma_f32_16x16x32_bf16 v[192:195],a[136:139],v[44:47],v[192:195]
s_cmp_lg_u64 vcc,0
v_cvt_pk_bf16_f32 v80,v80,v81
v_cvt_pk_bf16_f32 v88,v88,v89
v_mfma_f32_16x16x32_bf16 v[196:199],a[140:143],v[44:47],v[196:199]
s_cselect_b32 s62,s32,0
v_cvt_pk_bf16_f32 v72,v72,v73
v_cvt_pk_bf16_f32 v89,v90,v91
v_mfma_f32_16x16x32_bf16 v[244:247],a[140:143],v[48:51],v[244:247]
s_or_b32 s31,s31,s62
v_cvt_pk_bf16_f32 v73,v74,v75
v_cvt_pk_bf16_f32 v100,v100,v101
v_mfma_f32_16x16x32_bf16 v[240:243],a[136:139],v[48:51],v[240:243]
s_lshl_b32 s32,s32,1
ds_write2st64_b64 v36,v[72:73],v[76:77] offset0:36 offset1:40
v_mfma_f32_16x16x32_bf16 v[144:147],a[136:139],v[52:55],v[144:147]
s_add_u32 m0,s24,6144
v_cvt_pk_bf16_f32 v81,v82,v83
v_cvt_pk_bf16_f32 v92,v92,v93
v_mfma_f32_16x16x32_bf16 v[148:151],a[140:143],v[52:55],v[148:151]
buffer_load_dwordx4 v6,s[12:15],s28 offen offset:0 nt lds
v_mfma_f32_16x16x32_bf16 a[196:199],a[140:143],v[56:59],a[196:199]
buffer_load_dwordx4 v7,s[12:15],s28 offen offset:1024 nt lds
v_mfma_f32_16x16x32_bf16 a[192:195],a[136:139],v[56:59],a[192:195]
buffer_load_dwordx4 v8,s[12:15],s28 offen offset:2048 nt lds
v_mfma_f32_16x16x32_bf16 a[200:203],a[144:147],v[56:59],a[200:203]
s_add_u32 s28,s28,3072
ds_write2st64_b64 v37,v[80:81],v[84:85] offset0:36 offset1:40
v_mfma_f32_16x16x32_bf16 a[204:207],a[148:151],v[56:59],a[204:207]
s_add_u32 m0,s24,9216
v_cvt_pk_bf16_f32 v93,v94,v95
v_cvt_pk_bf16_f32 v96,v96,v97
v_mfma_f32_16x16x32_bf16 v[156:159],a[148:151],v[52:55],v[156:159]
buffer_load_dwordx4 v6,s[12:15],s28 offen offset:0 nt lds
buffer_load_dwordx4 v7,s[12:15],s28 offen offset:1024 nt lds
buffer_load_dwordx4 v8,s[12:15],s28 offen offset:2048 nt lds
ds_write2st64_b64 v38,v[88:89],v[92:93] offset0:36 offset1:40
v_cvt_pk_bf16_f32 v101,v102,v103
v_cvt_pk_bf16_f32 v97,v98,v99
v_accvgpr_read_b32 v86,a198
v_accvgpr_read_b32 v83,a195
v_accvgpr_read_b32 v85,a197
v_accvgpr_read_b32 v87,a199
v_pk_mul_f32 v[86:87],v[86:87],v[66:67] op_sel_hi:[1,0]
v_accvgpr_read_b32 v81,a193
v_accvgpr_read_b32 v82,a194
v_pk_mul_f32 v[82:83],v[82:83],v[66:67] op_sel_hi:[1,0]
v_accvgpr_read_b32 v80,a192
v_pk_mul_f32 v[80:81],v[80:81],v[66:67] op_sel_hi:[1,0]
v_accvgpr_read_b32 v84,a196
v_pk_mul_f32 v[84:85],v[84:85],v[66:67] op_sel_hi:[1,0]
v_accvgpr_read_b32 v90,a202
v_accvgpr_read_b32 v89,a201
v_mfma_f32_16x16x32_bf16 v[152:155],a[144:147],v[52:55],v[152:155]
s_waitcnt vmcnt(21)
ds_read_b128 a[48:51],v11 offset:12288
v_accvgpr_read_b32 v88,a200
ds_write2st64_b64 v39,v[96:97],v[100:101] offset0:36 offset1:40
v_pk_mul_f32 v[88:89],v[88:89],v[66:67] op_sel_hi:[1,0]
v_accvgpr_read_b32 v91,a203
v_pk_mul_f32 v[90:91],v[90:91],v[66:67] op_sel_hi:[1,0]
v_accvgpr_read_b32 v92,a204
v_accvgpr_read_b32 v95,a207
v_mfma_f32_16x16x32_bf16 v[248:251],a[144:147],v[48:51],v[248:251]
s_add_u32 s28,s28,3072
ds_read_b128 a[52:55],v12 offset:12288
v_accvgpr_read_b32 v93,a205
ds_read_b128 a[56:59],v11 offset:12416
v_pk_mul_f32 v[116:117],v[116:117],v[64:65] op_sel_hi:[1,0]
ds_read_b128 a[60:63],v12 offset:12416
v_pk_mul_f32 v[130:131],v[130:131],v[64:65] op_sel_hi:[1,0]
ds_read_b128 a[64:67],v11 offset:12544
v_pk_mul_f32 v[132:133],v[132:133],v[64:65] op_sel_hi:[1,0]
ds_read_b128 a[68:71],v12 offset:12544
v_pk_mul_f32 v[136:137],v[136:137],v[64:65] op_sel_hi:[1,0]
ds_read_b128 v[104:107],v10 offset:18432
v_pk_mul_f32 v[92:93],v[92:93],v[66:67] op_sel_hi:[1,0]
v_pk_mul_f32 v[118:119],v[118:119],v[64:65] op_sel_hi:[1,0]
v_pk_mul_f32 v[134:135],v[134:135],v[64:65] op_sel_hi:[1,0]
v_pk_mul_f32 v[128:129],v[128:129],v[64:65] op_sel_hi:[1,0]
ds_read_b128 v[108:111],v10 offset:19456
v_pk_mul_f32 v[120:121],v[120:121],v[64:65] op_sel_hi:[1,0]
v_pk_mul_f32 v[122:123],v[122:123],v[64:65] op_sel_hi:[1,0]
v_pk_mul_f32 v[138:139],v[138:139],v[64:65] op_sel_hi:[1,0]
v_pk_mul_f32 v[114:115],v[114:115],v[64:65] op_sel_hi:[1,0]
ds_read_b128 v[72:75],v10 offset:20480
v_pk_mul_f32 v[112:113],v[112:113],v[64:65] op_sel_hi:[1,0]
v_accvgpr_read_b32 v94,a206
v_pk_mul_f32 v[94:95],v[94:95],v[66:67] op_sel_hi:[1,0]
v_cvt_pk_bf16_f32 v80,v80,v81
v_cvt_pk_bf16_f32 v81,v82,v83
v_mfma_f32_16x16x32_bf16 v[252:255],a[148:151],v[48:51],v[252:255]
s_add_u32 m0,s23,0
ds_read_b128 v[76:79],v10 offset:21504
v_cvt_pk_bf16_f32 v84,v84,v85
v_mfma_f32_16x16x32_bf16 v[204:207],a[148:151],v[44:47],v[204:207]
ds_write_b64 v36,v[80:81] offset:18432
v_mfma_f32_16x16x32_bf16 v[200:203],a[144:147],v[44:47],v[200:203]
s_waitcnt lgkmcnt(4)
buffer_store_dwordx4 v[104:107],v9,s[16:19],s87 offen offset:0 nt
v_add_u32 v36,v36,v19
v_cvt_pk_bf16_f32 v92,v92,v93
v_cvt_pk_bf16_f32 v88,v88,v89
v_cvt_pk_bf16_f32 v89,v90,v91
v_cvt_pk_bf16_f32 v85,v86,v87
v_cvt_pk_bf16_f32 v93,v94,v95
v_cvt_pk_bf16_f32 v128,v128,v129
v_cvt_pk_bf16_f32 v112,v112,v113
v_cvt_pk_bf16_f32 v113,v114,v115
v_cvt_pk_bf16_f32 v116,v116,v117
v_cvt_pk_bf16_f32 v129,v130,v131
v_cvt_pk_bf16_f32 v132,v132,v133
ds_write_b64 v37,v[84:85] offset:18432
s_waitcnt lgkmcnt(2)
buffer_store_dwordx4 v[108:111],v9,s[16:19],s87 offen offset:3072 nt
v_add_u32 v37,v37,v19
v_cvt_pk_bf16_f32 v136,v136,v137
v_cvt_pk_bf16_f32 v120,v120,v121
v_cvt_pk_bf16_f32 v133,v134,v135
v_cvt_pk_bf16_f32 v137,v138,v139
v_cvt_pk_bf16_f32 v117,v118,v119
v_cvt_pk_bf16_f32 v121,v122,v123
v_mov_b32 v65,0
v_mov_b32 v67,0
v_mov_b32 v66,0
v_mov_b32 v61,0
v_mov_b32 v63,0
ds_write_b64 v38,v[88:89] offset:18432
buffer_store_dwordx4 v[72:75],v9,s[16:19],s87 offen offset:128 nt
v_add_u32 v38,v38,v19
v_mov_b32 v71,0
v_mov_b32 v70,0
v_mov_b32 v68,0
v_mov_b32 v69,0
ds_write_b64 v39,v[92:93] offset:18432
v_add_u32 v39,v39,v19
ds_read_b128 v[96:99],v10 offset:18432
buffer_store_dwordx4 v[76:79],v9,s[16:19],s87 offen offset:3200 nt
s_waitcnt vmcnt(10)
s_barrier
ds_read_b128 v[100:103],v10 offset:19456
ds_read_b128 a[120:123],v0 offset:0
ds_write2st64_b64 v36,v[112:113],v[128:129] offset0:24 offset1:26
ds_read_b128 a[124:127],v1 offset:0
buffer_load_dwordx4 v6,s[8:11],s25 offen offset:0 lds
ds_read_b128 a[128:131],v0 offset:128
s_waitcnt lgkmcnt(5)
buffer_store_dwordx4 v[96:99],v9,s[16:19],s87 offen offset:256 nt
ds_read_b128 a[132:135],v1 offset:128
ds_read_b128 a[136:139],v0 offset:256
s_waitcnt lgkmcnt(5)
v_mfma_f32_16x16x32_bf16 v[72:75],a[120:123],a[0:3],0
ds_write2st64_b64 v37,v[116:117],v[132:133] offset0:24 offset1:26
v_pk_mul_f32 v[126:127],v[126:127],v[64:65] op_sel_hi:[1,0]
v_pk_mul_f32 v[142:143],v[142:143],v[64:65] op_sel_hi:[1,0]
v_pk_mul_f32 v[124:125],v[124:125],v[64:65] op_sel_hi:[1,0]
ds_read_b128 a[140:143],v1 offset:256
buffer_store_dwordx4 v[100:103],v9,s[16:19],s87 offen offset:3328 nt
ds_read_b128 a[144:147],v0 offset:6144
v_pk_mul_f32 v[140:141],v[140:141],v[64:65] op_sel_hi:[1,0]
v_cvt_pk_bf16_f32 v124,v124,v125
v_cvt_pk_bf16_f32 v140,v140,v141
s_waitcnt lgkmcnt(5)
v_mfma_f32_16x16x32_bf16 v[72:75],a[124:127],a[4:7],v[72:75]
ds_read_b128 a[148:151],v1 offset:6144
v_cvt_pk_bf16_f32 v141,v142,v143
v_mfma_f32_16x16x32_bf16 v[72:75],a[128:131],a[8:11],v[72:75]
buffer_load_dwordx4 v7,s[8:11],s25 offen offset:1024 lds
s_waitcnt lgkmcnt(4)
v_mfma_f32_16x16x32_bf16 v[72:75],a[132:135],a[12:15],v[72:75]
ds_write2st64_b64 v38,v[120:121],v[136:137] offset0:24 offset1:26
v_pk_mul_f32 v[162:163],v[162:163],v[60:61] op_sel_hi:[1,0]
v_pk_mul_f32 v[146:147],v[146:147],v[64:65] op_sel_hi:[1,0]
v_pk_mul_f32 v[144:145],v[144:145],v[64:65] op_sel_hi:[1,0]
v_pk_mul_f32 v[160:161],v[160:161],v[60:61] op_sel_hi:[1,0]
v_cvt_pk_bf16_f32 v125,v126,v127
v_cvt_pk_bf16_f32 v160,v160,v161
v_mfma_f32_16x16x32_bf16 v[72:75],a[136:139],a[16:19],v[72:75]
s_waitcnt lgkmcnt(2)
v_cvt_pk_bf16_f32 v144,v144,v145
v_cvt_pk_bf16_f32 v161,v162,v163
v_mfma_f32_16x16x32_bf16 v[72:75],a[140:143],a[20:23],v[72:75]
v_cvt_pk_bf16_f32 v145,v146,v147
v_mfma_f32_16x16x32_bf16 v[80:83],a[140:143],a[44:47],0
buffer_load_dwordx4 v8,s[8:11],s25 offen offset:2048 lds
v_mfma_f32_16x16x32_bf16 v[80:83],a[136:139],a[40:43],v[80:83]
s_waitcnt vmcnt(18)
ds_read_b128 a[92:95],v12 offset:256
s_mov_b32 s27,s42
ds_write2st64_b64 v39,v[124:125],v[140:141] offset0:24 offset1:26
v_pk_mul_f32 v[166:167],v[166:167],v[60:61] op_sel_hi:[1,0]
v_pk_mul_f32 v[164:165],v[164:165],v[60:61] op_sel_hi:[1,0]
v_pk_mul_f32 v[150:151],v[150:151],v[64:65] op_sel_hi:[1,0]
ds_read_b128 a[88:91],v11 offset:256
v_pk_mul_f32 v[148:149],v[148:149],v[64:65] op_sel_hi:[1,0]
v_max3_f32 v44,v72,v73,v74
v_cvt_pk_bf16_f32 v164,v164,v165
v_mfma_f32_16x16x32_bf16 v[80:83],a[132:135],a[36:39],v[80:83]
s_mov_b32 s42,s41
ds_read_b128 a[84:87],v12 offset:128
v_cvt_pk_bf16_f32 v148,v148,v149
v_mfma_f32_16x16x32_bf16 v[80:83],a[128:131],a[32:35],v[80:83]
s_add_u32 s69,s69,1
ds_read_b128 a[80:83],v11 offset:128
v_cvt_pk_bf16_f32 v165,v166,v167
v_mfma_f32_16x16x32_bf16 v[80:83],a[124:127],a[28:31],v[80:83]
s_lshl_b32 s62,s69,5
ds_read_b128 a[76:79],v12 offset:0
v_cvt_pk_bf16_f32 v149,v150,v151
v_mfma_f32_16x16x32_bf16 v[80:83],a[120:123],a[24:27],v[80:83]
s_add_u32 s62,s62,s34
ds_read_b128 a[72:75],v11 offset:0
s_mul_i32 s63,s62,171
s_lshr_b32 s63,s63,9
s_mul_i32 s64,s63,3
ds_write2st64_b64 v36,v[144:145],v[160:161] offset0:28 offset1:0
v_pk_mul_f32 v[170:171],v[170:171],v[60:61] op_sel_hi:[1,0]
v_pk_mul_f32 v[168:169],v[168:169],v[60:61] op_sel_hi:[1,0]
v_pk_mul_f32 v[154:155],v[154:155],v[64:65] op_sel_hi:[1,0]
v_pk_mul_f32 v[152:153],v[152:153],v[64:65] op_sel_hi:[1,0]
v_max3_f32 v48,v80,v81,v82
v_cvt_pk_bf16_f32 v152,v152,v153
v_mfma_f32_16x16x32_bf16 v[88:91],a[120:123],a[48:51],0
s_sub_u32 s62,s62,s64
v_cvt_pk_bf16_f32 v168,v168,v169
v_cvt_pk_bf16_f32 v169,v170,v171
v_mfma_f32_16x16x32_bf16 v[88:91],a[124:127],a[52:55],v[88:91]
s_add_u32 s63,s63,s33
v_cvt_pk_bf16_f32 v153,v154,v155
s_mul_i32 s30,s63,196608
v_mfma_f32_16x16x32_bf16 v[88:91],a[128:131],a[56:59],v[88:91]
s_mul_i32 s41,s63,325632
ds_write2st64_b64 v37,v[148:149],v[164:165] offset0:28 offset1:0
v_mfma_f32_16x16x32_bf16 v[88:91],a[132:135],a[60:63],v[88:91]
s_lshl_b32 s63,s3,2
s_add_u32 s64,s63,21
s_cmp_eq_u32 s3,0
s_cselect_b32 s64,20,s64
s_cselect_b32 s40,1,0
s_add_u32 s65,s63,37
v_pk_mul_f32 v[174:175],v[174:175],v[60:61] op_sel_hi:[1,0]
v_pk_mul_f32 v[172:173],v[172:173],v[60:61] op_sel_hi:[1,0]
v_pk_mul_f32 v[156:157],v[156:157],v[64:65] op_sel_hi:[1,0]
v_pk_mul_f32 v[158:159],v[158:159],v[64:65] op_sel_hi:[1,0]
v_cvt_pk_bf16_f32 v172,v172,v173
v_cvt_pk_bf16_f32 v156,v156,v157
v_mfma_f32_16x16x32_bf16 v[88:91],a[136:139],a[64:67],v[88:91]
s_cmp_eq_u32 s62,2
ds_write2st64_b64 v38,v[152:153],v[168:169] offset0:28 offset1:0
v_mfma_f32_16x16x32_bf16 v[88:91],a[140:143],a[68:71],v[88:91]
s_cselect_b32 s64,s65,s64
v_cvt_pk_bf16_f32 v157,v158,v159
v_cvt_pk_bf16_f32 v173,v174,v175
s_waitcnt lgkmcnt(2)
v_mfma_f32_16x16x32_bf16 v[96:99],a[140:143],a[92:95],0
s_cselect_b32 s40,0,s40
v_mov_b32 v64,0
s_add_u32 s65,s63,s3
s_cmp_eq_u32 s62,0
s_cselect_b32 s64,s65,s64
v_max3_f32 v52,v88,v89,v90
v_pk_mul_f32 v[176:177],v[176:177],v[60:61] op_sel_hi:[1,0]
v_pk_mul_f32 v[194:195],v[194:195],v[60:61] op_sel_hi:[1,0]
v_pk_mul_f32 v[192:193],v[192:193],v[60:61] op_sel_hi:[1,0]
ds_write2st64_b64 v39,v[156:157],v[172:173] offset0:28 offset1:0
v_pk_mul_f32 v[178:179],v[178:179],v[60:61] op_sel_hi:[1,0]
v_cvt_pk_bf16_f32 v176,v176,v177
v_cvt_pk_bf16_f32 v192,v192,v193
v_mfma_f32_16x16x32_bf16 v[96:99],a[136:139],a[88:91],v[96:99]
s_waitcnt vmcnt(9)
ds_read_b128 a[96:99],v11 offset:6144
v_cvt_pk_bf16_f32 v177,v178,v179
v_mfma_f32_16x16x32_bf16 v[96:99],a[132:135],a[84:87],v[96:99]
s_cselect_b32 s40,1,s40
ds_read_b128 a[100:103],v12 offset:6144
v_cvt_pk_bf16_f32 v193,v194,v195
v_mfma_f32_16x16x32_bf16 v[96:99],a[128:131],a[80:83],v[96:99]
s_mul_i32 s64,s64,6144
ds_read_b128 a[104:107],v11 offset:6272
s_add_u32 s41,s41,s64
v_mfma_f32_16x16x32_bf16 v[96:99],a[124:127],a[76:79],v[96:99]
s_cmp_ge_u32 s69,6
ds_read_b128 a[108:111],v12 offset:6272
s_cselect_b32 s41,166723584,s41
ds_read_b128 a[112:115],v11 offset:6400
v_pk_mul_f32 v[198:199],v[198:199],v[60:61] op_sel_hi:[1,0]
ds_read_b128 a[116:119],v12 offset:6400
v_pk_mul_f32 v[196:197],v[196:197],v[60:61] op_sel_hi:[1,0]
ds_write2st64_b64 v36,v[176:177],v[192:193] offset0:2 offset1:4
v_pk_mul_f32 v[180:181],v[180:181],v[60:61] op_sel_hi:[1,0]
v_pk_mul_f32 v[182:183],v[182:183],v[60:61] op_sel_hi:[1,0]
v_cvt_pk_bf16_f32 v180,v180,v181
v_cvt_pk_bf16_f32 v196,v196,v197
v_mfma_f32_16x16x32_bf16 v[96:99],a[120:123],a[72:75],v[96:99]
s_cselect_b32 s30,100663296,s30
v_cvt_pk_bf16_f32 v181,v182,v183
v_cvt_pk_bf16_f32 v197,v198,v199
s_waitcnt lgkmcnt(5)
v_mfma_f32_16x16x32_bf16 v[104:107],a[120:123],a[96:99],0
s_add_u32 s25,s30,s22
ds_read_b128 a[120:123],v0 offset:6272
s_add_u32 s26,s25,12288
v_mfma_f32_16x16x32_bf16 v[104:107],a[124:127],a[100:103],v[104:107]
s_add_u32 m0,s23,24576
ds_write2st64_b64 v37,v[180:181],v[196:197] offset0:2 offset1:4
s_waitcnt lgkmcnt(4)
v_mfma_f32_16x16x32_bf16 v[104:107],a[128:131],a[104:107],v[104:107]
s_mov_b32 s28,s41
v_max3_f32 v56,v96,v97,v98
s_mov_b32 s29,s24
ds_read_b128 a[124:127],v1 offset:6272
v_pk_mul_f32 v[184:185],v[184:185],v[60:61] op_sel_hi:[1,0]
ds_read_b128 a[128:131],v0 offset:6400
v_pk_mul_f32 v[200:201],v[200:201],v[60:61] op_sel_hi:[1,0]
v_pk_mul_f32 v[202:203],v[202:203],v[60:61] op_sel_hi:[1,0]
v_pk_mul_f32 v[186:187],v[186:187],v[60:61] op_sel_hi:[1,0]
v_cvt_pk_bf16_f32 v200,v200,v201
v_cvt_pk_bf16_f32 v184,v184,v185
v_mfma_f32_16x16x32_bf16 v[104:107],a[132:135],a[108:111],v[104:107]
ds_read_b128 a[132:135],v1 offset:6400
v_cvt_pk_bf16_f32 v185,v186,v187
v_mfma_f32_16x16x32_bf16 v[104:107],a[136:139],a[112:115],v[104:107]
s_waitcnt lgkmcnt(3)
ds_read_b128 a[136:139],v0 offset:12288
v_cvt_pk_bf16_f32 v201,v202,v203
v_mfma_f32_16x16x32_bf16 v[104:107],a[140:143],a[116:119],v[104:107]
ds_read_b128 a[140:143],v1 offset:12288
ds_write2st64_b64 v38,v[184:185],v[200:201] offset0:2 offset1:4
v_pk_mul_f32 v[206:207],v[206:207],v[60:61] op_sel_hi:[1,0]
v_pk_mul_f32 v[190:191],v[190:191],v[60:61] op_sel_hi:[1,0]
v_pk_mul_f32 v[204:205],v[204:205],v[60:61] op_sel_hi:[1,0]
v_pk_mul_f32 v[188:189],v[188:189],v[60:61] op_sel_hi:[1,0]
v_cvt_pk_bf16_f32 v204,v204,v205
v_cvt_pk_bf16_f32 v188,v188,v189
v_mfma_f32_16x16x32_bf16 v[76:79],a[144:147],a[0:3],0
v_max3_f32 v40,v104,v105,v106
v_cvt_pk_bf16_f32 v205,v206,v207
v_mfma_f32_16x16x32_bf16 v[76:79],a[148:151],a[4:7],v[76:79]
v_cvt_pk_bf16_f32 v189,v190,v191
v_mov_b32 v60,0
v_mfma_f32_16x16x32_bf16 v[76:79],a[120:123],a[8:11],v[76:79]
s_waitcnt lgkmcnt(2)
ds_write2st64_b64 v39,v[188:189],v[204:205] offset0:2 offset1:4
v_mfma_f32_16x16x32_bf16 v[76:79],a[124:127],a[12:15],v[76:79]
buffer_load_dwordx4 v6,s[8:11],s21 offen offset:0 lds
v_pk_mul_f32 v[210:211],v[210:211],v[62:63] op_sel_hi:[1,0]
v_pk_mul_f32 v[208:209],v[208:209],v[62:63] op_sel_hi:[1,0]
v_pk_mul_f32 v[224:225],v[224:225],v[62:63] op_sel_hi:[1,0]
v_pk_mul_f32 v[226:227],v[226:227],v[62:63] op_sel_hi:[1,0]
v_cvt_pk_bf16_f32 v224,v224,v225
v_cvt_pk_bf16_f32 v225,v226,v227
v_mfma_f32_16x16x32_bf16 v[76:79],a[128:131],a[16:19],v[76:79]
v_cvt_pk_bf16_f32 v208,v208,v209
v_cvt_pk_bf16_f32 v209,v210,v211
v_mfma_f32_16x16x32_bf16 v[76:79],a[132:135],a[20:23],v[76:79]
ds_write2st64_b64 v36,v[208:209],v[224:225] offset0:12 offset1:14
v_mfma_f32_16x16x32_bf16 v[84:87],a[132:135],a[44:47],0
v_mfma_f32_16x16x32_bf16 v[84:87],a[128:131],a[40:43],v[84:87]
buffer_load_dwordx4 v7,s[8:11],s21 offen offset:1024 lds
v_pk_mul_f32 v[214:215],v[214:215],v[62:63] op_sel_hi:[1,0]
v_pk_mul_f32 v[230:231],v[230:231],v[62:63] op_sel_hi:[1,0]
v_pk_mul_f32 v[228:229],v[228:229],v[62:63] op_sel_hi:[1,0]
v_pk_mul_f32 v[212:213],v[212:213],v[62:63] op_sel_hi:[1,0]
v_max3_f32 v44,v44,v75,v76
v_max3_f32 v44,v44,v77,v78
v_mfma_f32_16x16x32_bf16 v[84:87],a[124:127],a[36:39],v[84:87]
v_max_f32 v44,v44,v79
v_mov_b32 v45,v44
v_mfma_f32_16x16x32_bf16 v[84:87],a[120:123],a[32:35],v[84:87]
v_cvt_pk_bf16_f32 v212,v212,v213
v_permlane32_swap_b32 v45,v44
v_mfma_f32_16x16x32_bf16 v[84:87],a[148:151],a[28:31],v[84:87]
v_max_f32 v44,v44,v45
v_mov_b32 v45,v44
v_cvt_pk_bf16_f32 v213,v214,v215
v_cvt_pk_bf16_f32 v228,v228,v229
v_permlane16_swap_b32 v45,v44
v_pk_mul_f32 v[234:235],v[234:235],v[62:63] op_sel_hi:[1,0]
v_pk_mul_f32 v[218:219],v[218:219],v[62:63] op_sel_hi:[1,0]
v_pk_mul_f32 v[232:233],v[232:233],v[62:63] op_sel_hi:[1,0]
v_pk_mul_f32 v[216:217],v[216:217],v[62:63] op_sel_hi:[1,0]
v_max_f32 v44,v44,v45
v_mul_f32_e64 v13,-s36,v44
v_mfma_f32_16x16x32_bf16 v[84:87],a[144:147],a[24:27],v[84:87]
buffer_load_dwordx4 v8,s[8:11],s21 offen offset:2048 lds
v_mfma_f32_16x16x32_bf16 v[92:95],a[144:147],a[48:51],0
s_add_u32 s21,s21,12288
v_fma_f32 v72,v72,s36,v13
v_fma_f32 v74,v74,s36,v13
v_mfma_f32_16x16x32_bf16 v[92:95],a[148:151],a[52:55],v[92:95]
s_add_u32 m0,s22,0
v_exp_f32 v74,v74
v_mfma_f32_16x16x32_bf16 v[92:95],a[120:123],a[56:59],v[92:95]
v_fma_f32 v75,v75,s36,v13
v_exp_f32 v75,v75
v_exp_f32 v72,v72
v_pk_mul_f32 v[236:237],v[236:237],v[62:63] op_sel_hi:[1,0]
v_pk_mul_f32 v[238:239],v[238:239],v[62:63] op_sel_hi:[1,0]
v_pk_mul_f32 v[220:221],v[220:221],v[62:63] op_sel_hi:[1,0]
v_pk_mul_f32 v[222:223],v[222:223],v[62:63] op_sel_hi:[1,0]
v_fma_f32 v73,v73,s36,v13
v_exp_f32 v73,v73
v_mfma_f32_16x16x32_bf16 v[92:95],a[124:127],a[60:63],v[92:95]
v_cvt_pk_bf16_f32 v20,v72,v73
v_cvt_pk_bf16_f32 v21,v74,v75
v_mfma_f32_16x16x32_bf16 v[92:95],a[128:131],a[64:67],v[92:95]
v_max3_f32 v48,v48,v83,v84
v_max3_f32 v48,v48,v85,v86
v_mfma_f32_16x16x32_bf16 v[92:95],a[132:135],a[68:71],v[92:95]
v_max_f32 v48,v48,v87
v_mov_b32 v49,v48
v_mfma_f32_16x16x32_bf16 v[100:103],a[132:135],a[92:95],0
v_cvt_pk_bf16_f32 v236,v236,v237
v_permlane32_swap_b32 v49,v48
v_max_f32 v48,v48,v49
v_mov_b32 v49,v48
v_pk_mul_f32 v[242:243],v[242:243],v[62:63] op_sel_hi:[1,0]
v_pk_mul_f32 v[240:241],v[240:241],v[62:63] op_sel_hi:[1,0]
v_permlane16_swap_b32 v49,v48
v_max_f32 v48,v48,v49
v_mfma_f32_16x16x32_bf16 v[100:103],a[128:131],a[88:91],v[100:103]
v_mul_f32_e64 v14,-s36,v48
v_fma_f32 v81,v81,s36,v14
v_mfma_f32_16x16x32_bf16 v[100:103],a[124:127],a[84:87],v[100:103]
v_fma_f32 v83,v83,s36,v14
v_fma_f32 v80,v80,s36,v14
v_mfma_f32_16x16x32_bf16 v[100:103],a[120:123],a[80:83],v[100:103]
v_exp_f32 v81,v81
v_mfma_f32_16x16x32_bf16 v[100:103],a[148:151],a[76:79],v[100:103]
v_exp_f32 v80,v80
v_fma_f32 v82,v82,s36,v14
v_exp_f32 v82,v82
v_pk_mul_f32 v[246:247],v[246:247],v[62:63] op_sel_hi:[1,0]
v_pk_mul_f32 v[244:245],v[244:245],v[62:63] op_sel_hi:[1,0]
v_exp_f32 v83,v83
v_cvt_pk_bf16_f32 v24,v80,v81
v_mfma_f32_16x16x32_bf16 v[100:103],a[144:147],a[72:75],v[100:103]
v_cvt_pk_bf16_f32 v25,v82,v83
v_max3_f32 v52,v52,v91,v92
v_mfma_f32_16x16x32_bf16 v[108:111],a[144:147],a[96:99],0
ds_read_b128 a[144:147],v0 offset:12416
v_max3_f32 v52,v52,v93,v94
v_mfma_f32_16x16x32_bf16 v[108:111],a[148:151],a[100:103],v[108:111]
ds_read_b128 a[148:151],v1 offset:12416
v_max_f32 v52,v52,v95
v_mov_b32 v53,v52
v_max3_f32 v56,v56,v99,v100
v_max3_f32 v56,v56,v101,v102
v_pk_mul_f32 v[248:249],v[248:249],v[62:63] op_sel_hi:[1,0]
v_pk_mul_f32 v[250:251],v[250:251],v[62:63] op_sel_hi:[1,0]
v_permlane32_swap_b32 v53,v52
v_max_f32 v52,v52,v53
v_mfma_f32_16x16x32_bf16 v[108:111],a[120:123],a[104:107],v[108:111]
ds_read_b128 a[120:123],v0 offset:12544
v_mov_b32 v53,v52
v_mfma_f32_16x16x32_bf16 v[108:111],a[124:127],a[108:111],v[108:111]
ds_read_b128 a[124:127],v1 offset:12544
v_permlane16_swap_b32 v53,v52
v_mfma_f32_16x16x32_bf16 v[108:111],a[128:131],a[112:115],v[108:111]
ds_read_b128 a[128:131],v0 offset:18432
v_max_f32 v52,v52,v53
v_mfma_f32_16x16x32_bf16 v[108:111],a[132:135],a[116:119],v[108:111]
ds_read_b128 a[132:135],v1 offset:18432
v_mul_f32_e64 v15,-s36,v52
v_fma_f32 v88,v88,s36,v15
v_fma_f32 v89,v89,s36,v15
v_fma_f32 v91,v91,s36,v15
v_pk_mul_f32 v[252:253],v[252:253],v[62:63] op_sel_hi:[1,0]
v_pk_mul_f32 v[254:255],v[254:255],v[62:63] op_sel_hi:[1,0]
v_fma_f32 v90,v90,s36,v15
v_exp_f32 v90,v90
v_mfma_f32_16x16x32_bf16 v[72:75],a[136:139],a[0:3],0
s_waitcnt lgkmcnt(4)
v_exp_f32 v91,v91
v_mfma_f32_16x16x32_bf16 v[72:75],a[140:143],a[4:7],v[72:75]
v_exp_f32 v89,v89
v_mfma_f32_16x16x32_bf16 v[72:75],a[144:147],a[8:11],v[72:75]
v_exp_f32 v88,v88
v_mfma_f32_16x16x32_bf16 v[72:75],a[148:151],a[12:15],v[72:75]
s_waitcnt lgkmcnt(1)
v_cvt_pk_bf16_f32 v29,v90,v91
v_cvt_pk_bf16_f32 v28,v88,v89
v_mfma_f32_16x16x32_bf16 v[72:75],a[120:123],a[16:19],v[72:75]
v_max_f32 v56,v56,v103
v_mov_b32 v57,v56
v_mfma_f32_16x16x32_bf16 v[72:75],a[124:127],a[20:23],v[72:75]
v_max3_f32 v40,v40,v107,v108
v_permlane32_swap_b32 v57,v56
v_mfma_f32_16x16x32_bf16 v[80:83],a[124:127],a[44:47],0
v_max_f32 v56,v56,v57
v_mov_b32 v57,v56
v_mfma_f32_16x16x32_bf16 v[80:83],a[120:123],a[40:43],v[80:83]
v_max3_f32 v40,v40,v109,v110
v_permlane16_swap_b32 v57,v56
v_mfma_f32_16x16x32_bf16 v[80:83],a[148:151],a[36:39],v[80:83]
v_max_f32 v56,v56,v57
v_mul_f32_e64 v16,-s36,v56
v_mfma_f32_16x16x32_bf16 v[80:83],a[144:147],a[32:35],v[80:83]
v_fma_f32 v97,v97,s36,v16
v_fma_f32 v98,v98,s36,v16
v_mfma_f32_16x16x32_bf16 v[80:83],a[140:143],a[28:31],v[80:83]
v_fma_f32 v99,v99,s36,v16
v_exp_f32 v99,v99
v_mfma_f32_16x16x32_bf16 v[80:83],a[136:139],a[24:27],v[80:83]
v_exp_f32 v97,v97
v_mfma_f32_16x16x32_bf16 v[88:91],a[136:139],a[48:51],0
v_fma_f32 v96,v96,s36,v16
v_exp_f32 v96,v96
v_mfma_f32_16x16x32_bf16 v[88:91],a[140:143],a[52:55],v[88:91]
v_exp_f32 v98,v98
v_mfma_f32_16x16x32_bf16 v[88:91],a[144:147],a[56:59],v[88:91]
v_cvt_pk_bf16_f32 v33,v98,v99
v_cvt_pk_bf16_f32 v32,v96,v97
v_mfma_f32_16x16x32_bf16 v[88:91],a[148:151],a[60:63],v[88:91]
v_max_f32 v40,v40,v111
v_mov_b32 v41,v40
v_mfma_f32_16x16x32_bf16 v[88:91],a[120:123],a[64:67],v[88:91]
v_cvt_pk_bf16_f32 v232,v232,v233
v_permlane32_swap_b32 v41,v40
v_mfma_f32_16x16x32_bf16 v[88:91],a[124:127],a[68:71],v[88:91]
v_max_f32 v40,v40,v41
v_mov_b32 v41,v40
v_mfma_f32_16x16x32_bf16 v[96:99],a[124:127],a[92:95],0
v_cvt_pk_bf16_f32 v216,v216,v217
v_cvt_pk_bf16_f32 v217,v218,v219
v_mfma_f32_16x16x32_bf16 v[96:99],a[120:123],a[88:91],v[96:99]
v_permlane16_swap_b32 v41,v40
v_mfma_f32_16x16x32_bf16 v[96:99],a[148:151],a[84:87],v[96:99]
v_cvt_pk_bf16_f32 v240,v240,v241
v_cvt_pk_bf16_f32 v237,v238,v239
v_mfma_f32_16x16x32_bf16 v[96:99],a[144:147],a[80:83],v[96:99]
v_max_f32 v40,v40,v41
v_cvt_pk_bf16_f32 v233,v234,v235
v_mfma_f32_16x16x32_bf16 v[96:99],a[140:143],a[76:79],v[96:99]
v_cvt_pk_bf16_f32 v229,v230,v231
v_cvt_pk_bf16_f32 v220,v220,v221
v_mfma_f32_16x16x32_bf16 v[96:99],a[136:139],a[72:75],v[96:99]
ds_write2st64_b64 v37,v[212:213],v[228:229] offset0:12 offset1:14
v_cvt_pk_bf16_f32 v221,v222,v223
v_mul_f32_e64 v17,-s36,v40
v_fma_f32 v105,v105,s36,v17
v_fma_f32 v104,v104,s36,v17
v_fma_f32 v107,v107,s36,v17
v_exp_f32 v107,v107
v_exp_f32 v104,v104
v_cvt_pk_bf16_f32 v241,v242,v243
v_fma_f32 v106,v106,s36,v17
v_exp_f32 v105,v105
v_exp_f32 v106,v106
ds_write2st64_b64 v38,v[216:217],v[232:233] offset0:12 offset1:14
v_cvt_pk_bf16_f32 v244,v244,v245
v_cvt_pk_bf16_f32 v245,v246,v247
v_fma_f32 v78,v78,s36,v13
v_fma_f32 v77,v77,s36,v13
v_exp_f32 v78,v78
v_fma_f32 v76,v76,s36,v13
v_exp_f32 v77,v77
v_fma_f32 v79,v79,s36,v13
v_exp_f32 v79,v79
v_exp_f32 v76,v76
v_cvt_pk_bf16_f32 v23,v78,v79
ds_write2st64_b64 v39,v[220:221],v[236:237] offset0:12 offset1:14
v_cvt_pk_bf16_f32 v22,v76,v77
v_fma_f32 v84,v84,s36,v14
v_exp_f32 v84,v84
v_fma_f32 v85,v85,s36,v14
v_fma_f32 v86,v86,s36,v14
v_fma_f32 v87,v87,s36,v14
v_exp_f32 v87,v87
v_exp_f32 v86,v86
v_exp_f32 v85,v85
v_cvt_pk_bf16_f32 v27,v86,v87
ds_write_b64 v36,v[240:241] offset:8192
v_cvt_pk_bf16_f32 v36,v104,v105
v_cvt_pk_bf16_f32 v26,v84,v85
v_fma_f32 v93,v93,s36,v15
v_fma_f32 v92,v92,s36,v15
v_fma_f32 v95,v95,s36,v15
v_exp_f32 v95,v95
ds_write_b64 v37,v[244:245] offset:8192
v_cvt_pk_bf16_f32 v37,v106,v107
v_mfma_f32_16x16x32_bf16 v[104:107],a[136:139],a[96:99],0
ds_read_b128 a[136:139],v0 offset:18560
v_fma_f32 v94,v94,s36,v15
v_mfma_f32_16x16x32_bf16 v[104:107],a[140:143],a[100:103],v[104:107]
ds_read_b128 a[140:143],v1 offset:18560
v_exp_f32 v93,v93
v_mfma_f32_16x16x32_bf16 v[104:107],a[144:147],a[104:107],v[104:107]
s_waitcnt vmcnt(3)
s_barrier
v_mfma_f32_16x16x32_bf16 v[104:107],a[148:151],a[108:111],v[104:107]
ds_read_b128 a[144:147],v0 offset:18688
buffer_load_dwordx4 v6,s[4:7],s20 offen offset:0 lds
v_mfma_f32_16x16x32_bf16 v[104:107],a[120:123],a[112:115],v[104:107]
ds_read_b128 a[148:151],v1 offset:18688
v_exp_f32 v94,v94
v_mfma_f32_16x16x32_bf16 v[104:107],a[124:127],a[116:119],v[104:107]
v_exp_f32 v92,v92
v_mfma_f32_16x16x32_bf16 v[76:79],a[128:131],a[0:3],0
s_waitcnt lgkmcnt(3)
v_cvt_pk_bf16_f32 v31,v94,v95
v_cvt_pk_bf16_f32 v30,v92,v93
v_mfma_f32_16x16x32_bf16 v[76:79],a[132:135],a[4:7],v[76:79]
v_fma_f32 v100,v100,s36,v16
v_fma_f32 v103,v103,s36,v16
v_mfma_f32_16x16x32_bf16 v[76:79],a[136:139],a[8:11],v[76:79]
s_waitcnt lgkmcnt(2)
v_fma_f32 v101,v101,s36,v16
v_exp_f32 v100,v100
v_mfma_f32_16x16x32_bf16 v[76:79],a[140:143],a[12:15],v[76:79]
buffer_load_dwordx4 v7,s[4:7],s20 offen offset:1024 lds
s_waitcnt lgkmcnt(1)
v_mfma_f32_16x16x32_bf16 v[76:79],a[144:147],a[16:19],v[76:79]
s_waitcnt lgkmcnt(0)
v_exp_f32 v103,v103
v_fma_f32 v102,v102,s36,v16
v_mfma_f32_16x16x32_bf16 v[76:79],a[148:151],a[20:23],v[76:79]
v_exp_f32 v101,v101
v_mfma_f32_16x16x32_bf16 v[84:87],a[148:151],a[44:47],0
ds_read_b64_tr_b16 a[120:121],v2 offset:0
v_exp_f32 v102,v102
v_mfma_f32_16x16x32_bf16 v[84:87],a[144:147],a[40:43],v[84:87]
ds_read_b64_tr_b16 a[122:123],v2 offset:6144
v_cvt_pk_bf16_f32 v35,v102,v103
v_mfma_f32_16x16x32_bf16 v[84:87],a[140:143],a[36:39],v[84:87]
buffer_load_dwordx4 v8,s[4:7],s20 offen offset:2048 lds
v_mfma_f32_16x16x32_bf16 v[84:87],a[136:139],a[32:35],v[84:87]
s_add_u32 s20,s20,12288
ds_read_b64_tr_b16 a[126:127],v3 offset:6144
v_cvt_pk_bf16_f32 v34,v100,v101
v_mfma_f32_16x16x32_bf16 v[84:87],a[132:135],a[28:31],v[84:87]
ds_read_b64_tr_b16 a[124:125],v3 offset:0
v_fma_f32 v111,v111,s36,v17
v_smfmac_f32_16x16x64_bf16 v[64:67],a[152:155],v[28:35],v18
v_fma_f32 v109,v109,s36,v17
v_mfma_f32_16x16x32_bf16 v[84:87],a[128:131],a[24:27],v[84:87]
v_cvt_pk_bf16_f32 v252,v252,v253
v_fma_f32 v110,v110,s36,v17
v_mfma_f32_16x16x32_bf16 v[92:95],a[128:131],a[48:51],0
v_exp_f32 v110,v110
v_mfma_f32_16x16x32_bf16 v[92:95],a[132:135],a[52:55],v[92:95]
v_cvt_pk_bf16_f32 v248,v248,v249
v_cvt_pk_bf16_f32 v249,v250,v251
v_mfma_f32_16x16x32_bf16 v[92:95],a[136:139],a[56:59],v[92:95]
ds_write_b64 v38,v[248:249] offset:8192
v_mfma_f32_16x16x32_bf16 v[92:95],a[140:143],a[60:63],v[92:95]
v_fma_f32 v108,v108,s36,v17
v_exp_f32 v111,v111
v_mfma_f32_16x16x32_bf16 v[92:95],a[144:147],a[64:67],v[92:95]
v_exp_f32 v109,v109
v_mfma_f32_16x16x32_bf16 v[92:95],a[148:151],a[68:71],v[92:95]
v_exp_f32 v108,v108
v_mfma_f32_16x16x32_bf16 v[100:103],a[148:151],a[92:95],0
v_cvt_pk_bf16_f32 v253,v254,v255
v_cvt_pk_bf16_f32 v38,v108,v109
v_mfma_f32_16x16x32_bf16 v[100:103],a[144:147],a[88:91],v[100:103]
ds_write_b64 v39,v[252:253] offset:8192
v_mfma_f32_16x16x32_bf16 v[100:103],a[140:143],a[84:87],v[100:103]
v_cvt_pk_bf16_f32 v39,v110,v111
v_mov_b32 v62,0
v_mfma_f32_16x16x32_bf16 v[100:103],a[136:139],a[80:83],v[100:103]
v_fma_f32 v80,v80,s36,v14
v_fma_f32 v88,v88,s36,v15
v_smfmac_f32_16x16x64_bf16 v[60:63],a[152:155],v[20:27],v18
v_fma_f32 v81,v81,s36,v14
v_mfma_f32_16x16x32_bf16 v[100:103],a[132:135],a[76:79],v[100:103]
v_fma_f32 v75,v75,s36,v13
v_fma_f32 v83,v83,s36,v14
v_mfma_f32_16x16x32_bf16 v[100:103],a[128:131],a[72:75],v[100:103]
v_fma_f32 v82,v82,s36,v14
v_fma_f32 v74,v74,s36,v13
v_mfma_f32_16x16x32_bf16 v[108:111],a[128:131],a[96:99],0
ds_read_b64_tr_b16 a[128:129],v4 offset:0
v_exp_f32 v88,v88
v_mfma_f32_16x16x32_bf16 v[108:111],a[132:135],a[100:103],v[108:111]
ds_read_b64_tr_b16 a[130:131],v4 offset:6144
v_exp_f32 v80,v80
v_mfma_f32_16x16x32_bf16 v[108:111],a[136:139],a[104:107],v[108:111]
ds_read_b64_tr_b16 a[134:135],v5 offset:6144
v_exp_f32 v75,v75
v_mfma_f32_16x16x32_bf16 v[108:111],a[140:143],a[108:111],v[108:111]
ds_read_b64_tr_b16 a[132:133],v5 offset:0
v_fma_f32 v89,v89,s36,v15
v_mfma_f32_16x16x32_bf16 v[108:111],a[144:147],a[112:115],v[108:111]
v_exp_f32 v89,v89
v_mfma_f32_16x16x32_bf16 v[108:111],a[148:151],a[116:119],v[108:111]
v_fma_f32 v72,v72,s36,v13
v_exp_f32 v72,v72
v_fma_f32 v73,v73,s36,v13
v_exp_f32 v83,v83
v_exp_f32 v81,v81
v_exp_f32 v82,v82
v_exp_f32 v73,v73
v_cvt_pk_bf16_f32 v52,v88,v89
v_exp_f32 v74,v74
v_cvt_pk_bf16_f32 v49,v82,v83
v_cvt_pk_bf16_f32 v44,v72,v73
v_cvt_pk_bf16_f32 v45,v74,v75
v_cvt_pk_bf16_f32 v48,v80,v81
s_waitcnt lgkmcnt(1)
v_mfma_f32_16x16x32_bf16 v[160:163],a[120:123],v[20:23],0
s_add_u32 m0,s23,0
ds_read_b64_tr_b16 a[136:137],v2 offset:128
v_fma_f32 v90,v90,s36,v15
v_mfma_f32_16x16x32_bf16 v[164:167],a[124:127],v[20:23],0
ds_read_b64_tr_b16 a[138:139],v2 offset:6272
v_fma_f32 v91,v91,s36,v15
v_mfma_f32_16x16x32_bf16 v[212:215],a[124:127],v[24:27],0
ds_read_b64_tr_b16 a[140:141],v3 offset:128
v_fma_f32 v96,v96,s36,v16
v_mfma_f32_16x16x32_bf16 v[208:211],a[120:123],v[24:27],0
ds_read_b64_tr_b16 a[142:143],v3 offset:6272
v_fma_f32 v97,v97,s36,v16
v_mfma_f32_16x16x32_bf16 v[112:115],a[120:123],v[28:31],0
ds_read_b64_tr_b16 a[144:145],v4 offset:128
v_fma_f32 v98,v98,s36,v16
v_mfma_f32_16x16x32_bf16 v[116:119],a[124:127],v[28:31],0
ds_read_b64_tr_b16 a[146:147],v4 offset:6272
v_fma_f32 v99,v99,s36,v16
v_mfma_f32_16x16x32_bf16 a[164:167],a[124:127],v[32:35],0
ds_read_b64_tr_b16 a[148:149],v5 offset:128
v_fma_f32 v104,v104,s36,v17
v_mfma_f32_16x16x32_bf16 a[160:163],a[120:123],v[32:35],0
ds_read_b64_tr_b16 a[150:151],v5 offset:6272
v_fma_f32 v105,v105,s36,v17
v_mfma_f32_16x16x32_bf16 a[208:211],a[120:123],v[36:39],0
ds_read_b64_tr_b16 a[120:121],v2 offset:256
v_fma_f32 v106,v106,s36,v17
v_mfma_f32_16x16x32_bf16 a[212:215],a[124:127],v[36:39],0
ds_read_b64_tr_b16 a[122:123],v2 offset:6400
v_fma_f32 v107,v107,s36,v17
v_mfma_f32_16x16x32_bf16 a[216:219],a[128:131],v[36:39],0
s_waitcnt lgkmcnt(6)
ds_read_b64_tr_b16 a[124:125],v3 offset:256
v_fma_f32 v76,v76,s36,v13
v_mfma_f32_16x16x32_bf16 a[220:223],a[132:135],v[36:39],0
ds_read_b64_tr_b16 a[126:127],v3 offset:6400
v_fma_f32 v77,v77,s36,v13
v_mfma_f32_16x16x32_bf16 a[172:175],a[132:135],v[32:35],0
v_exp_f32 v90,v90
v_mfma_f32_16x16x32_bf16 a[168:171],a[128:131],v[32:35],0
v_exp_f32 v91,v91
v_mfma_f32_16x16x32_bf16 v[120:123],a[128:131],v[28:31],0
v_cvt_pk_bf16_f32 v53,v90,v91
v_fma_f32 v78,v78,s36,v13
v_mfma_f32_16x16x32_bf16 v[124:127],a[132:135],v[28:31],0
v_exp_f32 v96,v96
v_mfma_f32_16x16x32_bf16 v[220:223],a[132:135],v[24:27],0
v_exp_f32 v97,v97
v_mfma_f32_16x16x32_bf16 v[216:219],a[128:131],v[24:27],0
v_exp_f32 v98,v98
v_mfma_f32_16x16x32_bf16 v[168:171],a[128:131],v[20:23],0
ds_read_b64_tr_b16 a[128:129],v4 offset:256
v_cvt_pk_bf16_f32 v56,v96,v97
v_mfma_f32_16x16x32_bf16 v[172:175],a[132:135],v[20:23],0
ds_read_b64_tr_b16 a[130:131],v4 offset:6400
v_fma_f32 v79,v79,s36,v13
v_mfma_f32_16x16x32_bf16 v[176:179],a[136:139],v[20:23],0
ds_read_b64_tr_b16 a[132:133],v5 offset:256
v_fma_f32 v84,v84,s36,v14
v_mfma_f32_16x16x32_bf16 v[180:183],a[140:143],v[20:23],0
ds_read_b64_tr_b16 a[134:135],v5 offset:6400
v_fma_f32 v85,v85,s36,v14
v_mfma_f32_16x16x32_bf16 v[228:231],a[140:143],v[24:27],0
v_exp_f32 v99,v99
v_mfma_f32_16x16x32_bf16 v[224:227],a[136:139],v[24:27],0
v_cvt_pk_bf16_f32 v57,v98,v99
v_fma_f32 v86,v86,s36,v14
v_mfma_f32_16x16x32_bf16 v[128:131],a[136:139],v[28:31],0
v_exp_f32 v104,v104
v_mfma_f32_16x16x32_bf16 v[132:135],a[140:143],v[28:31],0
v_exp_f32 v105,v105
v_mfma_f32_16x16x32_bf16 a[180:183],a[140:143],v[32:35],0
v_exp_f32 v106,v106
v_mfma_f32_16x16x32_bf16 a[176:179],a[136:139],v[32:35],0
v_exp_f32 v107,v107
v_mfma_f32_16x16x32_bf16 a[224:227],a[136:139],v[36:39],0
v_cvt_pk_bf16_f32 v40,v104,v105
v_cvt_pk_bf16_f32 v41,v106,v107
v_mfma_f32_16x16x32_bf16 a[228:231],a[140:143],v[36:39],0
s_waitcnt lgkmcnt(0)
v_exp_f32 v76,v76
v_mfma_f32_16x16x32_bf16 a[232:235],a[144:147],v[36:39],0
v_exp_f32 v77,v77
v_mfma_f32_16x16x32_bf16 a[236:239],a[148:151],v[36:39],0
v_exp_f32 v78,v78
v_mfma_f32_16x16x32_bf16 a[188:191],a[148:151],v[32:35],0
v_exp_f32 v79,v79
v_mfma_f32_16x16x32_bf16 a[184:187],a[144:147],v[32:35],0
v_cvt_pk_bf16_f32 v46,v76,v77
v_cvt_pk_bf16_f32 v47,v78,v79
v_mfma_f32_16x16x32_bf16 v[136:139],a[144:147],v[28:31],0
v_fma_f32 v87,v87,s36,v14
v_fma_f32 v92,v92,s36,v15
v_mfma_f32_16x16x32_bf16 v[140:143],a[148:151],v[28:31],0
v_exp_f32 v84,v84
v_mfma_f32_16x16x32_bf16 v[236:239],a[148:151],v[24:27],0
v_exp_f32 v85,v85
v_mfma_f32_16x16x32_bf16 v[232:235],a[144:147],v[24:27],0
v_exp_f32 v86,v86
v_mfma_f32_16x16x32_bf16 v[184:187],a[144:147],v[20:23],0
v_exp_f32 v87,v87
v_mfma_f32_16x16x32_bf16 v[188:191],a[148:151],v[20:23],0
v_cvt_pk_bf16_f32 v50,v84,v85
v_cvt_pk_bf16_f32 v51,v86,v87
v_mfma_f32_16x16x32_bf16 v[192:195],a[120:123],v[20:23],0
v_fma_f32 v93,v93,s36,v15
v_fma_f32 v94,v94,s36,v15
v_smfmac_f32_16x16x64_bf16 v[60:63],a[152:155],v[44:51],v18
v_fma_f32 v95,v95,s36,v15
v_mfma_f32_16x16x32_bf16 v[196:199],a[124:127],v[20:23],0
s_waitcnt vmcnt(30)
v_exp_f32 v92,v92
v_mfma_f32_16x16x32_bf16 v[244:247],a[124:127],v[24:27],0
s_barrier
v_mfma_f32_16x16x32_bf16 v[240:243],a[120:123],v[24:27],0
ds_read_b128 a[136:139],v0 offset:24576
v_fma_f32 v100,v100,s36,v16
v_mfma_f32_16x16x32_bf16 v[144:147],a[120:123],v[28:31],0
ds_read_b128 a[140:143],v1 offset:24576
v_fma_f32 v101,v101,s36,v16
v_mfma_f32_16x16x32_bf16 v[148:151],a[124:127],v[28:31],0
ds_read_b128 a[144:147],v0 offset:24704
v_fma_f32 v102,v102,s36,v16
v_mfma_f32_16x16x32_bf16 a[196:199],a[124:127],v[32:35],0
ds_read_b128 a[148:151],v1 offset:24704
v_fma_f32 v103,v103,s36,v16
v_mfma_f32_16x16x32_bf16 a[192:195],a[120:123],v[32:35],0
v_exp_f32 v93,v93
v_mfma_f32_16x16x32_bf16 a[240:243],a[120:123],v[36:39],0
buffer_load_dwordx4 v6,s[8:11],s21 offen offset:0 lds
v_mfma_f32_16x16x32_bf16 a[244:247],a[124:127],v[36:39],0
ds_read_b128 a[120:123],v0 offset:24832
v_cvt_pk_bf16_f32 v54,v92,v93
v_mfma_f32_16x16x32_bf16 a[248:251],a[128:131],v[36:39],0
ds_read_b128 a[124:127],v1 offset:24832
v_fma_f32 v108,v108,s36,v17
v_mfma_f32_16x16x32_bf16 a[252:255],a[132:135],v[36:39],0
v_exp_f32 v94,v94
v_mfma_f32_16x16x32_bf16 a[204:207],a[132:135],v[32:35],0
v_exp_f32 v95,v95
v_mfma_f32_16x16x32_bf16 a[200:203],a[128:131],v[32:35],0
v_cvt_pk_bf16_f32 v55,v94,v95
v_fma_f32 v109,v109,s36,v17
v_mfma_f32_16x16x32_bf16 v[152:155],a[128:131],v[28:31],0
v_exp_f32 v100,v100
v_mfma_f32_16x16x32_bf16 v[156:159],a[132:135],v[28:31],0
v_exp_f32 v101,v101
v_mfma_f32_16x16x32_bf16 v[252:255],a[132:135],v[24:27],0
v_exp_f32 v102,v102
v_mfma_f32_16x16x32_bf16 v[248:251],a[128:131],v[24:27],0
v_exp_f32 v103,v103
v_mfma_f32_16x16x32_bf16 v[200:203],a[128:131],v[20:23],0
ds_read_b128 a[128:131],v0 offset:30720
v_cvt_pk_bf16_f32 v58,v100,v101
v_mfma_f32_16x16x32_bf16 v[204:207],a[132:135],v[20:23],0
buffer_load_dwordx4 v7,s[8:11],s21 offen offset:1024 lds
s_waitcnt lgkmcnt(1)
v_mfma_f32_16x16x32_bf16 v[72:75],a[136:139],a[0:3],0
ds_read_b128 a[132:135],v1 offset:30720
v_cvt_pk_bf16_f32 v59,v102,v103
v_mfma_f32_16x16x32_bf16 v[72:75],a[140:143],a[4:7],v[72:75]
v_fma_f32 v110,v110,s36,v17
v_fma_f32 v111,v111,s36,v17
v_smfmac_f32_16x16x64_bf16 v[64:67],a[152:155],v[52:59],v18
v_mfma_f32_16x16x32_bf16 v[72:75],a[144:147],a[8:11],v[72:75]
v_exp_f32 v108,v108
v_mfma_f32_16x16x32_bf16 v[72:75],a[148:151],a[12:15],v[72:75]
v_exp_f32 v109,v109
v_mfma_f32_16x16x32_bf16 v[72:75],a[120:123],a[16:19],v[72:75]
v_exp_f32 v110,v110
v_mfma_f32_16x16x32_bf16 v[72:75],a[124:127],a[20:23],v[72:75]
v_exp_f32 v111,v111
v_mfma_f32_16x16x32_bf16 v[80:83],a[124:127],a[44:47],0
v_cvt_pk_bf16_f32 v42,v108,v109
v_cvt_pk_bf16_f32 v43,v110,v111
v_mfma_f32_16x16x32_bf16 v[80:83],a[120:123],a[40:43],v[80:83]
v_mfma_f32_16x16x32_bf16 v[80:83],a[148:151],a[36:39],v[80:83]
v_smfmac_f32_16x16x64_bf16 v[68:71],a[152:155],v[36:43],v18
buffer_load_dwordx4 v8,s[8:11],s21 offen offset:2048 lds
v_mfma_f32_16x16x32_bf16 v[80:83],a[144:147],a[32:35],v[80:83]
s_add_u32 s21,s21,12288
v_fma_f32 v72,v72,s36,v13
v_fma_f32 v73,v73,s36,v13
v_mfma_f32_16x16x32_bf16 v[80:83],a[140:143],a[28:31],v[80:83]
s_add_u32 m0,s22,12288
v_fma_f32 v74,v74,s36,v13
v_fma_f32 v75,v75,s36,v13
v_mfma_f32_16x16x32_bf16 v[80:83],a[136:139],a[24:27],v[80:83]
v_exp_f32 v72,v72
v_mfma_f32_16x16x32_bf16 v[88:91],a[136:139],a[48:51],0
v_exp_f32 v73,v73
v_mfma_f32_16x16x32_bf16 v[88:91],a[140:143],a[52:55],v[88:91]
v_exp_f32 v74,v74
v_mfma_f32_16x16x32_bf16 v[88:91],a[144:147],a[56:59],v[88:91]
v_exp_f32 v75,v75
v_mfma_f32_16x16x32_bf16 v[88:91],a[148:151],a[60:63],v[88:91]
v_fma_f32 v80,v80,s36,v14
v_fma_f32 v81,v81,s36,v14
v_mfma_f32_16x16x32_bf16 v[88:91],a[120:123],a[64:67],v[88:91]
v_fma_f32 v82,v82,s36,v14
v_fma_f32 v83,v83,s36,v14
v_mfma_f32_16x16x32_bf16 v[88:91],a[124:127],a[68:71],v[88:91]
v_exp_f32 v80,v80
v_mfma_f32_16x16x32_bf16 v[96:99],a[124:127],a[92:95],0
v_exp_f32 v81,v81
v_mfma_f32_16x16x32_bf16 v[96:99],a[120:123],a[88:91],v[96:99]
buffer_load_dwordx4 v6,s[4:7],s20 offen offset:0 lds
v_mfma_f32_16x16x32_bf16 v[96:99],a[148:151],a[84:87],v[96:99]
v_exp_f32 v82,v82
v_mfma_f32_16x16x32_bf16 v[96:99],a[144:147],a[80:83],v[96:99]
v_fma_f32 v88,v88,s36,v15
v_fma_f32 v89,v89,s36,v15
v_mfma_f32_16x16x32_bf16 v[96:99],a[140:143],a[76:79],v[96:99]
v_exp_f32 v83,v83
v_mfma_f32_16x16x32_bf16 v[96:99],a[136:139],a[72:75],v[96:99]
v_exp_f32 v88,v88
v_mfma_f32_16x16x32_bf16 v[104:107],a[136:139],a[96:99],0
ds_read_b128 a[136:139],v0 offset:30848
v_cvt_pk_bf16_f32 v20,v72,v73
v_mfma_f32_16x16x32_bf16 v[104:107],a[140:143],a[100:103],v[104:107]
ds_read_b128 a[140:143],v1 offset:30848
v_cvt_pk_bf16_f32 v21,v74,v75
v_mfma_f32_16x16x32_bf16 v[104:107],a[144:147],a[104:107],v[104:107]
ds_read_b128 a[144:147],v0 offset:30976
v_cvt_pk_bf16_f32 v24,v80,v81
v_mfma_f32_16x16x32_bf16 v[104:107],a[148:151],a[108:111],v[104:107]
ds_read_b128 a[148:151],v1 offset:30976
v_cvt_pk_bf16_f32 v25,v82,v83
v_mfma_f32_16x16x32_bf16 v[104:107],a[120:123],a[112:115],v[104:107]
v_exp_f32 v89,v89
v_mfma_f32_16x16x32_bf16 v[104:107],a[124:127],a[116:119],v[104:107]
s_waitcnt lgkmcnt(4)
v_cvt_pk_bf16_f32 v28,v88,v89
v_mfma_f32_16x16x32_bf16 v[76:79],a[128:131],a[0:3],0
v_mfma_f32_16x16x32_bf16 v[76:79],a[132:135],a[4:7],v[76:79]
buffer_load_dwordx4 v7,s[4:7],s20 offen offset:1024 lds
s_waitcnt lgkmcnt(3)
v_mfma_f32_16x16x32_bf16 v[76:79],a[136:139],a[8:11],v[76:79]
s_waitcnt lgkmcnt(2)
v_mfma_f32_16x16x32_bf16 v[76:79],a[140:143],a[12:15],v[76:79]
s_waitcnt lgkmcnt(1)
v_mfma_f32_16x16x32_bf16 v[76:79],a[144:147],a[16:19],v[76:79]
s_waitcnt lgkmcnt(0)
v_mfma_f32_16x16x32_bf16 v[76:79],a[148:151],a[20:23],v[76:79]
v_mfma_f32_16x16x32_bf16 v[84:87],a[148:151],a[44:47],0
v_mfma_f32_16x16x32_bf16 v[84:87],a[144:147],a[40:43],v[84:87]
v_mfma_f32_16x16x32_bf16 v[84:87],a[140:143],a[36:39],v[84:87]
v_mfma_f32_16x16x32_bf16 v[84:87],a[136:139],a[32:35],v[84:87]
v_mfma_f32_16x16x32_bf16 v[84:87],a[132:135],a[28:31],v[84:87]
v_mfma_f32_16x16x32_bf16 v[84:87],a[128:131],a[24:27],v[84:87]
v_mfma_f32_16x16x32_bf16 v[92:95],a[128:131],a[48:51],0
buffer_load_dwordx4 v8,s[4:7],s20 offen offset:2048 lds
v_mfma_f32_16x16x32_bf16 v[92:95],a[132:135],a[52:55],v[92:95]
s_add_u32 s20,s20,12288
v_mfma_f32_16x16x32_bf16 v[92:95],a[136:139],a[56:59],v[92:95]
v_mfma_f32_16x16x32_bf16 v[92:95],a[140:143],a[60:63],v[92:95]
v_mfma_f32_16x16x32_bf16 v[92:95],a[144:147],a[64:67],v[92:95]
v_mfma_f32_16x16x32_bf16 v[92:95],a[148:151],a[68:71],v[92:95]
ds_read_b64_tr_b16 a[120:121],v2 offset:12288
v_mfma_f32_16x16x32_bf16 v[100:103],a[148:151],a[92:95],0
ds_read_b64_tr_b16 a[122:123],v2 offset:18432
v_mfma_f32_16x16x32_bf16 v[100:103],a[144:147],a[88:91],v[100:103]
v_mfma_f32_16x16x32_bf16 v[100:103],a[140:143],a[84:87],v[100:103]
ds_read_b64_tr_b16 a[124:125],v3 offset:12288
v_mfma_f32_16x16x32_bf16 v[100:103],a[136:139],a[80:83],v[100:103]
ds_read_b64_tr_b16 a[126:127],v3 offset:18432
v_mfma_f32_16x16x32_bf16 v[100:103],a[132:135],a[76:79],v[100:103]
v_mfma_f32_16x16x32_bf16 v[100:103],a[128:131],a[72:75],v[100:103]
v_mfma_f32_16x16x32_bf16 v[108:111],a[128:131],a[96:99],0
ds_read_b64_tr_b16 a[128:129],v4 offset:12288
v_mfma_f32_16x16x32_bf16 v[108:111],a[132:135],a[100:103],v[108:111]
ds_read_b64_tr_b16 a[130:131],v4 offset:18432
v_mfma_f32_16x16x32_bf16 v[108:111],a[136:139],a[104:107],v[108:111]
ds_read_b64_tr_b16 a[132:133],v5 offset:12288
v_mfma_f32_16x16x32_bf16 v[108:111],a[140:143],a[108:111],v[108:111]
ds_read_b64_tr_b16 a[134:135],v5 offset:18432
v_mfma_f32_16x16x32_bf16 v[108:111],a[144:147],a[112:115],v[108:111]
v_mfma_f32_16x16x32_bf16 v[108:111],a[148:151],a[116:119],v[108:111]
s_waitcnt lgkmcnt(4)
v_mfma_f32_16x16x32_bf16 v[160:163],a[120:123],v[44:47],v[160:163]
s_add_u32 m0,s23,12288
ds_read_b64_tr_b16 a[136:137],v2 offset:12416
v_fma_f32 v90,v90,s36,v15
v_mfma_f32_16x16x32_bf16 v[164:167],a[124:127],v[44:47],v[164:167]
ds_read_b64_tr_b16 a[138:139],v2 offset:18560
v_fma_f32 v91,v91,s36,v15
v_mfma_f32_16x16x32_bf16 v[212:215],a[124:127],v[48:51],v[212:215]
ds_read_b64_tr_b16 a[140:141],v3 offset:12416
v_fma_f32 v96,v96,s36,v16
v_mfma_f32_16x16x32_bf16 v[208:211],a[120:123],v[48:51],v[208:211]
ds_read_b64_tr_b16 a[142:143],v3 offset:18560
v_fma_f32 v97,v97,s36,v16
v_mfma_f32_16x16x32_bf16 v[112:115],a[120:123],v[52:55],v[112:115]
ds_read_b64_tr_b16 a[144:145],v4 offset:12416
v_fma_f32 v98,v98,s36,v16
v_mfma_f32_16x16x32_bf16 v[116:119],a[124:127],v[52:55],v[116:119]
ds_read_b64_tr_b16 a[146:147],v4 offset:18560
v_fma_f32 v99,v99,s36,v16
v_mfma_f32_16x16x32_bf16 a[164:167],a[124:127],v[56:59],a[164:167]
ds_read_b64_tr_b16 a[148:149],v5 offset:12416
v_fma_f32 v104,v104,s36,v17
v_mfma_f32_16x16x32_bf16 a[160:163],a[120:123],v[56:59],a[160:163]
ds_read_b64_tr_b16 a[150:151],v5 offset:18560
v_fma_f32 v105,v105,s36,v17
v_mfma_f32_16x16x32_bf16 a[208:211],a[120:123],v[40:43],a[208:211]
ds_read_b64_tr_b16 a[120:121],v2 offset:12544
v_fma_f32 v106,v106,s36,v17
v_mfma_f32_16x16x32_bf16 a[212:215],a[124:127],v[40:43],a[212:215]
s_waitcnt lgkmcnt(6)
ds_read_b64_tr_b16 a[122:123],v2 offset:18688
v_fma_f32 v107,v107,s36,v17
v_mfma_f32_16x16x32_bf16 a[216:219],a[128:131],v[40:43],a[216:219]
ds_read_b64_tr_b16 a[124:125],v3 offset:12544
v_fma_f32 v76,v76,s36,v13
v_mfma_f32_16x16x32_bf16 a[220:223],a[132:135],v[40:43],a[220:223]
ds_read_b64_tr_b16 a[126:127],v3 offset:18688
v_fma_f32 v77,v77,s36,v13
v_mfma_f32_16x16x32_bf16 a[172:175],a[132:135],v[56:59],a[172:175]
v_exp_f32 v90,v90
v_mfma_f32_16x16x32_bf16 a[168:171],a[128:131],v[56:59],a[168:171]
v_exp_f32 v91,v91
v_mfma_f32_16x16x32_bf16 v[120:123],a[128:131],v[52:55],v[120:123]
v_cvt_pk_bf16_f32 v29,v90,v91
v_fma_f32 v78,v78,s36,v13
v_mfma_f32_16x16x32_bf16 v[124:127],a[132:135],v[52:55],v[124:127]
v_exp_f32 v96,v96
v_mfma_f32_16x16x32_bf16 v[220:223],a[132:135],v[48:51],v[220:223]
v_exp_f32 v97,v97
v_mfma_f32_16x16x32_bf16 v[216:219],a[128:131],v[48:51],v[216:219]
v_exp_f32 v98,v98
v_mfma_f32_16x16x32_bf16 v[168:171],a[128:131],v[44:47],v[168:171]
ds_read_b64_tr_b16 a[128:129],v4 offset:12544
v_cvt_pk_bf16_f32 v32,v96,v97
v_mfma_f32_16x16x32_bf16 v[172:175],a[132:135],v[44:47],v[172:175]
ds_read_b64_tr_b16 a[130:131],v4 offset:18688
v_fma_f32 v79,v79,s36,v13
v_mfma_f32_16x16x32_bf16 v[176:179],a[136:139],v[44:47],v[176:179]
s_waitcnt lgkmcnt(2)
ds_read_b64_tr_b16 a[132:133],v5 offset:12544
v_fma_f32 v84,v84,s36,v14
v_mfma_f32_16x16x32_bf16 v[180:183],a[140:143],v[44:47],v[180:183]
ds_read_b64_tr_b16 a[134:135],v5 offset:18688
v_fma_f32 v85,v85,s36,v14
v_mfma_f32_16x16x32_bf16 v[228:231],a[140:143],v[48:51],v[228:231]
v_exp_f32 v99,v99
v_mfma_f32_16x16x32_bf16 v[224:227],a[136:139],v[48:51],v[224:227]
v_cvt_pk_bf16_f32 v33,v98,v99
v_fma_f32 v86,v86,s36,v14
v_mfma_f32_16x16x32_bf16 v[128:131],a[136:139],v[52:55],v[128:131]
v_exp_f32 v104,v104
v_mfma_f32_16x16x32_bf16 v[132:135],a[140:143],v[52:55],v[132:135]
v_exp_f32 v105,v105
v_mfma_f32_16x16x32_bf16 a[180:183],a[140:143],v[56:59],a[180:183]
v_exp_f32 v106,v106
v_mfma_f32_16x16x32_bf16 a[176:179],a[136:139],v[56:59],a[176:179]
v_exp_f32 v107,v107
v_mfma_f32_16x16x32_bf16 a[224:227],a[136:139],v[40:43],a[224:227]
v_cvt_pk_bf16_f32 v36,v104,v105
v_cvt_pk_bf16_f32 v37,v106,v107
v_mfma_f32_16x16x32_bf16 a[228:231],a[140:143],v[40:43],a[228:231]
v_exp_f32 v76,v76
v_mfma_f32_16x16x32_bf16 a[232:235],a[144:147],v[40:43],a[232:235]
v_exp_f32 v77,v77
v_mfma_f32_16x16x32_bf16 a[236:239],a[148:151],v[40:43],a[236:239]
v_exp_f32 v78,v78
v_mfma_f32_16x16x32_bf16 a[188:191],a[148:151],v[56:59],a[188:191]
v_exp_f32 v79,v79
v_mfma_f32_16x16x32_bf16 a[184:187],a[144:147],v[56:59],a[184:187]
v_cvt_pk_bf16_f32 v22,v76,v77
v_cvt_pk_bf16_f32 v23,v78,v79
v_mfma_f32_16x16x32_bf16 v[136:139],a[144:147],v[52:55],v[136:139]
v_fma_f32 v87,v87,s36,v14
v_fma_f32 v92,v92,s36,v15
v_mfma_f32_16x16x32_bf16 v[140:143],a[148:151],v[52:55],v[140:143]
v_exp_f32 v84,v84
v_mfma_f32_16x16x32_bf16 v[236:239],a[148:151],v[48:51],v[236:239]
v_exp_f32 v85,v85
v_mfma_f32_16x16x32_bf16 v[232:235],a[144:147],v[48:51],v[232:235]
v_exp_f32 v86,v86
v_mfma_f32_16x16x32_bf16 v[184:187],a[144:147],v[44:47],v[184:187]
v_exp_f32 v87,v87
v_mfma_f32_16x16x32_bf16 v[188:191],a[148:151],v[44:47],v[188:191]
v_cvt_pk_bf16_f32 v26,v84,v85
v_cvt_pk_bf16_f32 v27,v86,v87
v_mfma_f32_16x16x32_bf16 v[192:195],a[120:123],v[44:47],v[192:195]
v_fma_f32 v93,v93,s36,v15
v_fma_f32 v94,v94,s36,v15
v_smfmac_f32_16x16x64_bf16 v[60:63],a[152:155],v[20:27],v18
v_fma_f32 v95,v95,s36,v15
v_mfma_f32_16x16x32_bf16 v[196:199],a[124:127],v[44:47],v[196:199]
s_waitcnt vmcnt(6) lgkmcnt(0)
v_exp_f32 v92,v92
v_mfma_f32_16x16x32_bf16 v[244:247],a[124:127],v[48:51],v[244:247]
s_barrier
v_mfma_f32_16x16x32_bf16 v[240:243],a[120:123],v[48:51],v[240:243]
ds_read_b128 a[136:139],v0 offset:0
v_fma_f32 v100,v100,s36,v16
v_mfma_f32_16x16x32_bf16 v[144:147],a[120:123],v[52:55],v[144:147]
ds_read_b128 a[140:143],v1 offset:0
v_fma_f32 v101,v101,s36,v16
v_mfma_f32_16x16x32_bf16 v[148:151],a[124:127],v[52:55],v[148:151]
ds_read_b128 a[144:147],v0 offset:128
v_fma_f32 v102,v102,s36,v16
v_mfma_f32_16x16x32_bf16 a[196:199],a[124:127],v[56:59],a[196:199]
ds_read_b128 a[148:151],v1 offset:128
v_fma_f32 v103,v103,s36,v16
v_mfma_f32_16x16x32_bf16 a[192:195],a[120:123],v[56:59],a[192:195]
v_exp_f32 v93,v93
v_mfma_f32_16x16x32_bf16 a[240:243],a[120:123],v[40:43],a[240:243]
buffer_load_dwordx4 v6,s[8:11],s21 offen offset:0 lds
v_mfma_f32_16x16x32_bf16 a[244:247],a[124:127],v[40:43],a[244:247]
ds_read_b128 a[120:123],v0 offset:256
v_cvt_pk_bf16_f32 v30,v92,v93
v_mfma_f32_16x16x32_bf16 a[248:251],a[128:131],v[40:43],a[248:251]
ds_read_b128 a[124:127],v1 offset:256
v_fma_f32 v108,v108,s36,v17
v_mfma_f32_16x16x32_bf16 a[252:255],a[132:135],v[40:43],a[252:255]
v_exp_f32 v94,v94
v_mfma_f32_16x16x32_bf16 a[204:207],a[132:135],v[56:59],a[204:207]
v_exp_f32 v95,v95
v_mfma_f32_16x16x32_bf16 a[200:203],a[128:131],v[56:59],a[200:203]
v_cvt_pk_bf16_f32 v31,v94,v95
v_fma_f32 v109,v109,s36,v17
v_mfma_f32_16x16x32_bf16 v[152:155],a[128:131],v[52:55],v[152:155]
v_exp_f32 v100,v100
v_mfma_f32_16x16x32_bf16 v[156:159],a[132:135],v[52:55],v[156:159]
v_exp_f32 v101,v101
v_mfma_f32_16x16x32_bf16 v[252:255],a[132:135],v[48:51],v[252:255]
v_exp_f32 v102,v102
v_mfma_f32_16x16x32_bf16 v[248:251],a[128:131],v[48:51],v[248:251]
v_exp_f32 v103,v103
v_mfma_f32_16x16x32_bf16 v[200:203],a[128:131],v[44:47],v[200:203]
ds_read_b128 a[128:131],v0 offset:6144
v_cvt_pk_bf16_f32 v34,v100,v101
v_mfma_f32_16x16x32_bf16 v[204:207],a[132:135],v[44:47],v[204:207]
buffer_load_dwordx4 v7,s[8:11],s21 offen offset:1024 lds
s_waitcnt lgkmcnt(1)
v_mfma_f32_16x16x32_bf16 v[72:75],a[136:139],a[0:3],0
ds_read_b128 a[132:135],v1 offset:6144
v_cvt_pk_bf16_f32 v35,v102,v103
v_mfma_f32_16x16x32_bf16 v[72:75],a[140:143],a[4:7],v[72:75]
v_fma_f32 v110,v110,s36,v17
v_fma_f32 v111,v111,s36,v17
v_smfmac_f32_16x16x64_bf16 v[64:67],a[152:155],v[28:35],v18
v_mfma_f32_16x16x32_bf16 v[72:75],a[144:147],a[8:11],v[72:75]
v_exp_f32 v108,v108
v_mfma_f32_16x16x32_bf16 v[72:75],a[148:151],a[12:15],v[72:75]
v_exp_f32 v109,v109
v_mfma_f32_16x16x32_bf16 v[72:75],a[120:123],a[16:19],v[72:75]
v_exp_f32 v110,v110
v_mfma_f32_16x16x32_bf16 v[72:75],a[124:127],a[20:23],v[72:75]
v_exp_f32 v111,v111
v_mfma_f32_16x16x32_bf16 v[80:83],a[124:127],a[44:47],0
v_cvt_pk_bf16_f32 v38,v108,v109
v_cvt_pk_bf16_f32 v39,v110,v111
v_mfma_f32_16x16x32_bf16 v[80:83],a[120:123],a[40:43],v[80:83]
v_mfma_f32_16x16x32_bf16 v[80:83],a[148:151],a[36:39],v[80:83]
v_mfma_f32_16x16x32_bf16 v[80:83],a[144:147],a[32:35],v[80:83]
buffer_load_dwordx4 v8,s[8:11],s21 offen offset:2048 lds
v_mfma_f32_16x16x32_bf16 v[80:83],a[140:143],a[28:31],v[80:83]
s_add_u32 s21,s21,12288
v_fma_f32 v72,v72,s36,v13
v_fma_f32 v73,v73,s36,v13
v_mfma_f32_16x16x32_bf16 v[80:83],a[136:139],a[24:27],v[80:83]
s_add_u32 m0,s22,24576
v_fma_f32 v74,v74,s36,v13
v_fma_f32 v75,v75,s36,v13
v_mfma_f32_16x16x32_bf16 v[88:91],a[136:139],a[48:51],0
v_exp_f32 v72,v72
v_mfma_f32_16x16x32_bf16 v[88:91],a[140:143],a[52:55],v[88:91]
v_exp_f32 v73,v73
v_mfma_f32_16x16x32_bf16 v[88:91],a[144:147],a[56:59],v[88:91]
v_fma_f32 v80,v80,s36,v14
v_fma_f32 v81,v81,s36,v14
v_mfma_f32_16x16x32_bf16 v[88:91],a[148:151],a[60:63],v[88:91]
v_fma_f32 v82,v82,s36,v14
v_fma_f32 v83,v83,s36,v14
v_mfma_f32_16x16x32_bf16 v[88:91],a[120:123],a[64:67],v[88:91]
v_exp_f32 v74,v74
v_mfma_f32_16x16x32_bf16 v[88:91],a[124:127],a[68:71],v[88:91]
v_exp_f32 v75,v75
v_mfma_f32_16x16x32_bf16 v[96:99],a[124:127],a[92:95],0
v_exp_f32 v80,v80
v_mfma_f32_16x16x32_bf16 v[96:99],a[120:123],a[88:91],v[96:99]
v_exp_f32 v81,v81
v_mfma_f32_16x16x32_bf16 v[96:99],a[148:151],a[84:87],v[96:99]
v_exp_f32 v82,v82
v_mfma_f32_16x16x32_bf16 v[96:99],a[144:147],a[80:83],v[96:99]
buffer_load_dwordx4 v6,s[4:7],s20 offen offset:0 lds
v_mfma_f32_16x16x32_bf16 v[96:99],a[140:143],a[76:79],v[96:99]
v_fma_f32 v88,v88,s36,v15
v_fma_f32 v89,v89,s36,v15
v_mfma_f32_16x16x32_bf16 v[96:99],a[136:139],a[72:75],v[96:99]
v_exp_f32 v83,v83
v_mfma_f32_16x16x32_bf16 v[104:107],a[136:139],a[96:99],0
ds_read_b128 a[136:139],v0 offset:6272
v_cvt_pk_bf16_f32 v44,v72,v73
v_mfma_f32_16x16x32_bf16 v[104:107],a[140:143],a[100:103],v[104:107]
ds_read_b128 a[140:143],v1 offset:6272
v_cvt_pk_bf16_f32 v45,v74,v75
v_mfma_f32_16x16x32_bf16 v[104:107],a[144:147],a[104:107],v[104:107]
ds_read_b128 a[144:147],v0 offset:6400
v_cvt_pk_bf16_f32 v48,v80,v81
v_mfma_f32_16x16x32_bf16 v[104:107],a[148:151],a[108:111],v[104:107]
ds_read_b128 a[148:151],v1 offset:6400
v_cvt_pk_bf16_f32 v49,v82,v83
v_mfma_f32_16x16x32_bf16 v[104:107],a[120:123],a[112:115],v[104:107]
v_exp_f32 v88,v88
v_mfma_f32_16x16x32_bf16 v[104:107],a[124:127],a[116:119],v[104:107]
s_waitcnt lgkmcnt(4)
v_exp_f32 v89,v89
v_mfma_f32_16x16x32_bf16 v[76:79],a[128:131],a[0:3],0
v_cvt_pk_bf16_f32 v52,v88,v89
v_mfma_f32_16x16x32_bf16 v[76:79],a[132:135],a[4:7],v[76:79]
s_waitcnt lgkmcnt(3)
v_mfma_f32_16x16x32_bf16 v[76:79],a[136:139],a[8:11],v[76:79]
buffer_load_dwordx4 v7,s[4:7],s20 offen offset:1024 lds
s_waitcnt lgkmcnt(2)
v_mfma_f32_16x16x32_bf16 v[76:79],a[140:143],a[12:15],v[76:79]
s_waitcnt lgkmcnt(1)
v_mfma_f32_16x16x32_bf16 v[76:79],a[144:147],a[16:19],v[76:79]
s_waitcnt lgkmcnt(0)
v_mfma_f32_16x16x32_bf16 v[76:79],a[148:151],a[20:23],v[76:79]
v_mfma_f32_16x16x32_bf16 v[84:87],a[148:151],a[44:47],0
v_mfma_f32_16x16x32_bf16 v[84:87],a[144:147],a[40:43],v[84:87]
v_mfma_f32_16x16x32_bf16 v[84:87],a[140:143],a[36:39],v[84:87]
v_mfma_f32_16x16x32_bf16 v[84:87],a[136:139],a[32:35],v[84:87]
v_mfma_f32_16x16x32_bf16 v[84:87],a[132:135],a[28:31],v[84:87]
v_mfma_f32_16x16x32_bf16 v[84:87],a[128:131],a[24:27],v[84:87]
v_mfma_f32_16x16x32_bf16 v[92:95],a[128:131],a[48:51],0
v_mfma_f32_16x16x32_bf16 v[92:95],a[132:135],a[52:55],v[92:95]
buffer_load_dwordx4 v8,s[4:7],s20 offen offset:2048 lds
v_mfma_f32_16x16x32_bf16 v[92:95],a[136:139],a[56:59],v[92:95]
s_add_u32 s20,s20,12288
v_mfma_f32_16x16x32_bf16 v[92:95],a[140:143],a[60:63],v[92:95]
v_mfma_f32_16x16x32_bf16 v[92:95],a[144:147],a[64:67],v[92:95]
v_mfma_f32_16x16x32_bf16 v[92:95],a[148:151],a[68:71],v[92:95]
v_mfma_f32_16x16x32_bf16 v[100:103],a[148:151],a[92:95],0
v_mfma_f32_16x16x32_bf16 v[100:103],a[144:147],a[88:91],v[100:103]
ds_read_b64_tr_b16 a[120:121],v2 offset:24576
v_mfma_f32_16x16x32_bf16 v[100:103],a[140:143],a[84:87],v[100:103]
ds_read_b64_tr_b16 a[122:123],v2 offset:30720
v_mfma_f32_16x16x32_bf16 v[100:103],a[136:139],a[80:83],v[100:103]
ds_read_b64_tr_b16 a[124:125],v3 offset:24576
v_mfma_f32_16x16x32_bf16 v[100:103],a[132:135],a[76:79],v[100:103]
ds_read_b64_tr_b16 a[126:127],v3 offset:30720
v_mfma_f32_16x16x32_bf16 v[100:103],a[128:131],a[72:75],v[100:103]
v_mfma_f32_16x16x32_bf16 v[108:111],a[128:131],a[96:99],0
ds_read_b64_tr_b16 a[128:129],v4 offset:24576
v_mfma_f32_16x16x32_bf16 v[108:111],a[132:135],a[100:103],v[108:111]
ds_read_b64_tr_b16 a[130:131],v4 offset:30720
v_mfma_f32_16x16x32_bf16 v[108:111],a[136:139],a[104:107],v[108:111]
ds_read_b64_tr_b16 a[132:133],v5 offset:24576
v_mfma_f32_16x16x32_bf16 v[108:111],a[140:143],a[108:111],v[108:111]
ds_read_b64_tr_b16 a[134:135],v5 offset:30720
v_mfma_f32_16x16x32_bf16 v[108:111],a[144:147],a[112:115],v[108:111]
v_mfma_f32_16x16x32_bf16 v[108:111],a[148:151],a[116:119],v[108:111]
s_mov_b32 s38,0
s_branch L_loop5
L_tr44:
s_waitcnt vmcnt(43)
s_waitcnt lgkmcnt(3)
v_mfma_f32_16x16x32_bf16 v[160:163],a[120:123],v[20:23],v[160:163]
s_add_u32 m0,s24,0
ds_read_b128 a[4:7],v12 offset:0
v_fma_f32 v79,v79,s36,v13
v_mfma_f32_16x16x32_bf16 v[164:167],a[124:127],v[20:23],v[164:167]
ds_read_b128 a[12:15],v12 offset:128
v_fma_f32 v100,v100,s36,v16
v_mfma_f32_16x16x32_bf16 v[212:215],a[124:127],v[24:27],v[212:215]
ds_read_b128 a[20:23],v12 offset:256
v_fma_f32 v101,v101,s36,v16
v_mfma_f32_16x16x32_bf16 v[208:211],a[120:123],v[24:27],v[208:211]
ds_read_b128 a[8:11],v11 offset:128
v_fma_f32 v89,v89,s36,v15
v_mfma_f32_16x16x32_bf16 v[112:115],a[120:123],v[28:31],v[112:115]
ds_read_b128 a[0:3],v11 offset:0
v_fma_f32 v76,v76,s36,v13
v_mfma_f32_16x16x32_bf16 v[116:119],a[124:127],v[28:31],v[116:119]
ds_read_b128 a[16:19],v11 offset:256
v_fma_f32 v83,v83,s36,v14
v_mfma_f32_16x16x32_bf16 a[164:167],a[124:127],v[32:35],a[164:167]
ds_read_b64_tr_b16 a[138:139],v2 offset:30848
v_fma_f32 v90,v90,s36,v15
v_mfma_f32_16x16x32_bf16 a[160:163],a[120:123],v[32:35],a[160:163]
s_waitcnt lgkmcnt(6)
ds_read_b64_tr_b16 a[136:137],v2 offset:24704
v_fma_f32 v88,v88,s36,v15
v_mfma_f32_16x16x32_bf16 a[168:171],a[128:131],v[32:35],a[168:171]
ds_read_b64_tr_b16 a[142:143],v3 offset:30848
ds_read_b64_tr_b16 a[140:141],v3 offset:24704
ds_read_b64_tr_b16 a[146:147],v4 offset:30848
ds_read_b64_tr_b16 a[144:145],v4 offset:24704
ds_read_b64_tr_b16 a[150:151],v5 offset:30848
ds_read_b64_tr_b16 a[148:149],v5 offset:24704
ds_read_b128 a[32:35],v11 offset:6272
v_mfma_f32_16x16x32_bf16 a[172:175],a[132:135],v[32:35],a[172:175]
v_fma_f32 v91,v91,s36,v15
ds_read_b128 a[40:43],v11 offset:6400
v_mfma_f32_16x16x32_bf16 v[124:127],a[132:135],v[28:31],v[124:127]
s_waitcnt lgkmcnt(10)
buffer_load_dwordx4 v6,s[12:15],s28 offen offset:0 nt lds
v_mfma_f32_16x16x32_bf16 v[120:123],a[128:131],v[28:31],v[120:123]
ds_read_b64_tr_b16 a[122:123],v2 offset:30976
ds_read_b64_tr_b16 a[120:121],v2 offset:24832
ds_read_b64_tr_b16 a[124:125],v3 offset:24832
ds_read_b64_tr_b16 a[126:127],v3 offset:30976
ds_read_b128 a[44:47],v12 offset:6400
v_mfma_f32_16x16x32_bf16 v[216:219],a[128:131],v[24:27],v[216:219]
v_fma_f32 v93,v93,s36,v15
ds_read_b128 a[28:31],v12 offset:6144
v_mfma_f32_16x16x32_bf16 v[220:223],a[132:135],v[24:27],v[220:223]
v_fma_f32 v98,v98,s36,v16
ds_read_b128 a[36:39],v12 offset:6272
v_mfma_f32_16x16x32_bf16 v[172:175],a[132:135],v[20:23],v[172:175]
buffer_load_dwordx4 v7,s[12:15],s28 offen offset:1024 nt lds
v_mfma_f32_16x16x32_bf16 v[168:171],a[128:131],v[20:23],v[168:171]
s_waitcnt lgkmcnt(7)
ds_read_b64_tr_b16 a[130:131],v4 offset:30976
ds_read_b128 a[24:27],v11 offset:6144
v_mfma_f32_16x16x32_bf16 v[176:179],a[136:139],v[20:23],v[176:179]
v_fma_f32 v82,v82,s36,v14
v_exp_f32 v93,v93
v_mfma_f32_16x16x32_bf16 v[180:183],a[140:143],v[20:23],v[180:183]
ds_read_b64_tr_b16 a[128:129],v4 offset:24832
v_fma_f32 v85,v85,s36,v14
v_mfma_f32_16x16x32_bf16 v[228:231],a[140:143],v[24:27],v[228:231]
ds_read_b64_tr_b16 a[134:135],v5 offset:30976
v_exp_f32 v82,v82
v_mfma_f32_16x16x32_bf16 v[224:227],a[136:139],v[24:27],v[224:227]
ds_read_b64_tr_b16 a[132:133],v5 offset:24832
v_fma_f32 v84,v84,s36,v14
v_mfma_f32_16x16x32_bf16 v[128:131],a[136:139],v[28:31],v[128:131]
v_exp_f32 v84,v84
v_mfma_f32_16x16x32_bf16 v[132:135],a[140:143],v[28:31],v[132:135]
buffer_load_dwordx4 v8,s[12:15],s28 offen offset:2048 nt lds
v_mfma_f32_16x16x32_bf16 a[180:183],a[140:143],v[32:35],a[180:183]
s_add_u32 s28,s28,3072
v_fma_f32 v103,v103,s36,v16
v_exp_f32 v103,v103
v_mfma_f32_16x16x32_bf16 a[176:179],a[136:139],v[32:35],a[176:179]
s_add_u32 m0,s24,3072
v_fma_f32 v87,v87,s36,v14
v_exp_f32 v87,v87
v_mfma_f32_16x16x32_bf16 a[184:187],a[144:147],v[32:35],a[184:187]
v_fma_f32 v77,v77,s36,v13
v_exp_f32 v77,v77
v_mfma_f32_16x16x32_bf16 a[188:191],a[148:151],v[32:35],a[188:191]
v_fma_f32 v97,v97,s36,v16
v_exp_f32 v91,v91
v_mfma_f32_16x16x32_bf16 v[140:143],a[148:151],v[28:31],v[140:143]
v_fma_f32 v102,v102,s36,v16
v_exp_f32 v85,v85
v_mfma_f32_16x16x32_bf16 v[136:139],a[144:147],v[28:31],v[136:139]
v_exp_f32 v89,v89
v_mfma_f32_16x16x32_bf16 v[232:235],a[144:147],v[24:27],v[232:235]
buffer_load_dwordx4 v6,s[12:15],s28 offen offset:0 nt lds
v_mfma_f32_16x16x32_bf16 v[236:239],a[148:151],v[24:27],v[236:239]
v_fma_f32 v92,v92,s36,v15
v_exp_f32 v101,v101
v_mfma_f32_16x16x32_bf16 v[188:191],a[148:151],v[20:23],v[188:191]
v_fma_f32 v94,v94,s36,v15
v_fma_f32 v95,v95,s36,v15
v_mfma_f32_16x16x32_bf16 v[184:187],a[144:147],v[20:23],v[184:187]
s_waitcnt lgkmcnt(0)
v_exp_f32 v95,v95
v_mfma_f32_16x16x32_bf16 v[192:195],a[120:123],v[20:23],v[192:195]
v_fma_f32 v86,v86,s36,v14
v_fma_f32 v78,v78,s36,v13
v_mfma_f32_16x16x32_bf16 v[196:199],a[124:127],v[20:23],v[196:199]
v_exp_f32 v92,v92
v_mfma_f32_16x16x32_bf16 v[244:247],a[124:127],v[24:27],v[244:247]
v_exp_f32 v78,v78
v_mfma_f32_16x16x32_bf16 v[240:243],a[120:123],v[24:27],v[240:243]
buffer_load_dwordx4 v7,s[12:15],s28 offen offset:1024 nt lds
v_mfma_f32_16x16x32_bf16 v[144:147],a[120:123],v[28:31],v[144:147]
v_exp_f32 v94,v94
v_mfma_f32_16x16x32_bf16 v[148:151],a[124:127],v[28:31],v[148:151]
v_exp_f32 v90,v90
v_mfma_f32_16x16x32_bf16 a[196:199],a[124:127],v[32:35],a[196:199]
v_fma_f32 v96,v96,s36,v16
v_exp_f32 v96,v96
v_mfma_f32_16x16x32_bf16 a[192:195],a[120:123],v[32:35],a[192:195]
v_fma_f32 v99,v99,s36,v16
v_exp_f32 v83,v83
v_mfma_f32_16x16x32_bf16 a[200:203],a[128:131],v[32:35],a[200:203]
v_exp_f32 v97,v97
v_mfma_f32_16x16x32_bf16 a[204:207],a[132:135],v[32:35],a[204:207]
v_exp_f32 v88,v88
v_mfma_f32_16x16x32_bf16 v[156:159],a[132:135],v[28:31],v[156:159]
v_exp_f32 v98,v98
v_mfma_f32_16x16x32_bf16 v[152:155],a[128:131],v[28:31],v[152:155]
buffer_load_dwordx4 v8,s[12:15],s28 offen offset:2048 nt lds
s_waitcnt vmcnt(20)
s_barrier
v_mfma_f32_16x16x32_bf16 v[248:251],a[128:131],v[24:27],v[248:251]
s_add_u32 s28,s28,3072
ds_read_b64_tr_b16 a[138:139],v2 offset:6144
v_exp_f32 v79,v79
v_mfma_f32_16x16x32_bf16 v[252:255],a[132:135],v[24:27],v[252:255]
s_add_u32 m0,s22,0
ds_read_b64_tr_b16 a[136:137],v2 offset:0
buffer_load_dwordx4 v6,s[4:7],s25 offen offset:0 lds
v_mfma_f32_16x16x32_bf16 v[204:207],a[132:135],v[20:23],v[204:207]
buffer_load_dwordx4 v7,s[4:7],s25 offen offset:1024 lds
v_mfma_f32_16x16x32_bf16 v[200:203],a[128:131],v[20:23],v[200:203]
buffer_load_dwordx4 v8,s[4:7],s25 offen offset:2048 lds
ds_read_b64_tr_b16 a[142:143],v3 offset:6144
ds_read_b64_tr_b16 a[140:141],v3 offset:0
ds_read_b64_tr_b16 a[144:145],v4 offset:0
ds_read_b64_tr_b16 a[146:147],v4 offset:6144
ds_read_b64_tr_b16 a[148:149],v5 offset:0
ds_read_b64_tr_b16 a[150:151],v5 offset:6144
v_exp_f32 v100,v100
v_cvt_pk_bf16_f32 v47,v78,v79
v_cvt_pk_bf16_f32 v49,v82,v83
v_exp_f32 v76,v76
v_exp_f32 v102,v102
v_exp_f32 v86,v86
v_cvt_pk_bf16_f32 v59,v102,v103
v_exp_f32 v99,v99
v_cvt_pk_bf16_f32 v50,v84,v85
v_cvt_pk_bf16_f32 v57,v98,v99
v_cvt_pk_bf16_f32 v55,v94,v95
v_cvt_pk_bf16_f32 v54,v92,v93
v_cvt_pk_bf16_f32 v58,v100,v101
v_cvt_pk_bf16_f32 v51,v86,v87
v_cvt_pk_bf16_f32 v53,v90,v91
v_cvt_pk_bf16_f32 v46,v76,v77
v_cvt_pk_bf16_f32 v52,v88,v89
v_cvt_pk_bf16_f32 v56,v96,v97
v_smfmac_f32_16x16x64_bf16 v[60:63],a[152:155],v[44:51],v18
v_subrev_u32 v10,18432,v10
v_smfmac_f32_16x16x64_bf16 v[64:67],a[152:155],v[52:59],v18
s_waitcnt lgkmcnt(0)
v_mfma_f32_16x16x32_bf16 v[160:163],a[136:139],v[44:47],v[160:163]
s_add_u32 s87,s42,18432
ds_read_b64_tr_b16 a[120:121],v2 offset:128
v_mbcnt_lo_u32_b32 v39,-1,0
v_mfma_f32_16x16x32_bf16 v[164:167],a[140:143],v[44:47],v[164:167]
ds_read_b64_tr_b16 a[122:123],v2 offset:6272
v_mbcnt_hi_u32_b32 v39,-1,v39
v_mfma_f32_16x16x32_bf16 v[212:215],a[140:143],v[48:51],v[212:215]
ds_read_b64_tr_b16 a[124:125],v3 offset:128
v_and_b32 v38,7,v39
v_mfma_f32_16x16x32_bf16 v[208:211],a[136:139],v[48:51],v[208:211]
ds_read_b64_tr_b16 a[126:127],v3 offset:6272
v_lshrrev_b32 v19,5,v39
v_mfma_f32_16x16x32_bf16 v[112:115],a[136:139],v[52:55],v[112:115]
ds_read_b64_tr_b16 a[128:129],v4 offset:128
v_xor_b32 v38,v38,v19
v_mfma_f32_16x16x32_bf16 v[116:119],a[140:143],v[52:55],v[116:119]
ds_read_b64_tr_b16 a[130:131],v4 offset:6272
ds_read_b64_tr_b16 a[132:133],v5 offset:128
ds_read_b64_tr_b16 a[134:135],v5 offset:6272
v_mfma_f32_16x16x32_bf16 a[164:167],a[140:143],v[56:59],a[164:167]
ds_read_b64_tr_b16 a[140:141],v3 offset:256
v_and_b32 v19,15,v39
v_mfma_f32_16x16x32_bf16 a[160:163],a[136:139],v[56:59],a[160:163]
ds_read_b64_tr_b16 a[136:137],v2 offset:256
v_lshl_add_u32 v19,v19,7,s24
v_mfma_f32_16x16x32_bf16 a[168:171],a[144:147],v[56:59],a[168:171]
ds_read_b64_tr_b16 a[138:139],v2 offset:6400
v_lshl_add_u32 v19,v38,4,v19
v_mfma_f32_16x16x32_bf16 a[172:175],a[148:151],v[56:59],a[172:175]
ds_read_b64_tr_b16 a[142:143],v3 offset:6400
v_bfe_u32 v38,v39,4,1
v_mfma_f32_16x16x32_bf16 v[124:127],a[148:151],v[52:55],v[124:127]
v_lshl_add_u32 v36,v38,3,v19
v_xor_b32 v37,32,v36
v_mfma_f32_16x16x32_bf16 v[120:123],a[144:147],v[52:55],v[120:123]
v_bfe_u32 v19,v39,3,1
v_xor_b32 v38,64,v36
v_mfma_f32_16x16x32_bf16 v[216:219],a[144:147],v[48:51],v[216:219]
v_xor_b32 v39,96,v36
v_lshlrev_b32 v19,11,v19
v_mfma_f32_16x16x32_bf16 v[220:223],a[148:151],v[48:51],v[220:223]
v_add_f32 v66,v66,v67
v_rcp_f32 v66,v66
v_mfma_f32_16x16x32_bf16 v[172:175],a[148:151],v[44:47],v[172:175]
ds_read_b64_tr_b16 a[148:149],v5 offset:256
v_accvgpr_read_b32 v80,a164
v_mfma_f32_16x16x32_bf16 v[168:171],a[144:147],v[44:47],v[168:171]
s_waitcnt lgkmcnt(2)
ds_read_b64_tr_b16 a[144:145],v4 offset:256
v_accvgpr_read_b32 v81,a165
v_mfma_f32_16x16x32_bf16 v[176:179],a[120:123],v[44:47],v[176:179]
ds_read_b64_tr_b16 a[146:147],v4 offset:6400
v_accvgpr_read_b32 v82,a166
v_mfma_f32_16x16x32_bf16 v[180:183],a[124:127],v[44:47],v[180:183]
ds_read_b64_tr_b16 a[150:151],v5 offset:6400
v_accvgpr_read_b32 v83,a167
v_mfma_f32_16x16x32_bf16 v[228:231],a[124:127],v[48:51],v[228:231]
v_accvgpr_read_b32 v72,a160
v_accvgpr_read_b32 v73,a161
v_mfma_f32_16x16x32_bf16 v[224:227],a[120:123],v[48:51],v[224:227]
v_accvgpr_read_b32 v74,a162
v_accvgpr_read_b32 v75,a163
v_mfma_f32_16x16x32_bf16 v[128:131],a[120:123],v[52:55],v[128:131]
v_accvgpr_read_b32 v88,a168
v_accvgpr_read_b32 v89,a169
v_mfma_f32_16x16x32_bf16 v[132:135],a[124:127],v[52:55],v[132:135]
v_accvgpr_read_b32 v90,a170
v_accvgpr_read_b32 v91,a171
v_mfma_f32_16x16x32_bf16 a[180:183],a[124:127],v[56:59],a[180:183]
v_accvgpr_read_b32 v96,a172
v_accvgpr_read_b32 v97,a173
v_mfma_f32_16x16x32_bf16 a[176:179],a[120:123],v[56:59],a[176:179]
v_accvgpr_read_b32 v98,a174
v_accvgpr_read_b32 v99,a175
v_mfma_f32_16x16x32_bf16 a[184:187],a[128:131],v[56:59],a[184:187]
v_add_f32 v62,v62,v63
v_rcp_f32 v62,v62
v_mfma_f32_16x16x32_bf16 a[188:191],a[132:135],v[56:59],a[188:191]
v_accvgpr_read_b32 v84,a180
v_accvgpr_read_b32 v85,a181
v_mfma_f32_16x16x32_bf16 v[140:143],a[132:135],v[52:55],v[140:143]
v_accvgpr_read_b32 v86,a182
v_accvgpr_read_b32 v87,a183
v_accvgpr_read_b32 v76,a176
v_accvgpr_read_b32 v77,a177
v_accvgpr_read_b32 v78,a178
v_pk_mul_f32 v[72:73],v[72:73],v[66:67] op_sel_hi:[1,0]
v_pk_mul_f32 v[74:75],v[74:75],v[66:67] op_sel_hi:[1,0]
v_pk_mul_f32 v[80:81],v[80:81],v[66:67] op_sel_hi:[1,0]
v_pk_mul_f32 v[82:83],v[82:83],v[66:67] op_sel_hi:[1,0]
v_pk_mul_f32 v[84:85],v[84:85],v[66:67] op_sel_hi:[1,0]
v_pk_mul_f32 v[86:87],v[86:87],v[66:67] op_sel_hi:[1,0]
v_pk_mul_f32 v[76:77],v[76:77],v[66:67] op_sel_hi:[1,0]
v_accvgpr_read_b32 v79,a179
v_pk_mul_f32 v[78:79],v[78:79],v[66:67] op_sel_hi:[1,0]
v_accvgpr_read_b32 v92,a184
v_accvgpr_read_b32 v93,a185
v_mfma_f32_16x16x32_bf16 v[136:139],a[128:131],v[52:55],v[136:139]
v_accvgpr_read_b32 v94,a186
v_accvgpr_read_b32 v95,a187
v_accvgpr_read_b32 v100,a188
v_accvgpr_read_b32 v101,a189
v_accvgpr_read_b32 v102,a190
v_pk_mul_f32 v[88:89],v[88:89],v[66:67] op_sel_hi:[1,0]
v_pk_mul_f32 v[90:91],v[90:91],v[66:67] op_sel_hi:[1,0]
v_pk_mul_f32 v[92:93],v[92:93],v[66:67] op_sel_hi:[1,0]
v_pk_mul_f32 v[94:95],v[94:95],v[66:67] op_sel_hi:[1,0]
v_accvgpr_read_b32 v103,a191
v_cvt_pk_bf16_f32 v72,v72,v73
v_mfma_f32_16x16x32_bf16 v[232:235],a[128:131],v[48:51],v[232:235]
v_cvt_pk_bf16_f32 v76,v76,v77
v_cvt_pk_bf16_f32 v80,v80,v81
v_cvt_pk_bf16_f32 v84,v84,v85
v_cvt_pk_bf16_f32 v73,v74,v75
v_cvt_pk_bf16_f32 v77,v78,v79
ds_write2st64_b64 v36,v[72:73],v[76:77] offset0:36 offset1:40
v_pk_mul_f32 v[96:97],v[96:97],v[66:67] op_sel_hi:[1,0]
v_pk_mul_f32 v[98:99],v[98:99],v[66:67] op_sel_hi:[1,0]
v_pk_mul_f32 v[100:101],v[100:101],v[66:67] op_sel_hi:[1,0]
v_pk_mul_f32 v[102:103],v[102:103],v[66:67] op_sel_hi:[1,0]
v_cvt_pk_bf16_f32 v88,v88,v89
v_cvt_pk_bf16_f32 v92,v92,v93
v_mfma_f32_16x16x32_bf16 v[236:239],a[132:135],v[48:51],v[236:239]
v_cvt_pk_bf16_f32 v81,v82,v83
v_cvt_pk_bf16_f32 v85,v86,v87
v_mfma_f32_16x16x32_bf16 v[188:191],a[132:135],v[44:47],v[188:191]
v_cvt_pk_bf16_f32 v96,v96,v97
v_cvt_pk_bf16_f32 v100,v100,v101
v_mfma_f32_16x16x32_bf16 v[184:187],a[128:131],v[44:47],v[184:187]
ds_write2st64_b64 v37,v[80:81],v[84:85] offset0:36 offset1:40
v_mfma_f32_16x16x32_bf16 v[192:195],a[136:139],v[44:47],v[192:195]
s_waitcnt lgkmcnt(1)
v_cvt_pk_bf16_f32 v89,v90,v91
v_cvt_pk_bf16_f32 v93,v94,v95
v_mfma_f32_16x16x32_bf16 v[196:199],a[140:143],v[44:47],v[196:199]
v_cvt_pk_bf16_f32 v97,v98,v99
v_cvt_pk_bf16_f32 v101,v102,v103
v_mfma_f32_16x16x32_bf16 v[244:247],a[140:143],v[48:51],v[244:247]
v_add_f32 v64,v64,v65
v_rcp_f32 v64,v64
v_mfma_f32_16x16x32_bf16 v[240:243],a[136:139],v[48:51],v[240:243]
ds_write2st64_b64 v38,v[88:89],v[92:93] offset0:36 offset1:40
v_mfma_f32_16x16x32_bf16 v[144:147],a[136:139],v[52:55],v[144:147]
v_add_f32 v60,v60,v61
v_rcp_f32 v60,v60
v_mfma_f32_16x16x32_bf16 v[148:151],a[140:143],v[52:55],v[148:151]
v_min3_f32 v61,v60,v62,v64
v_min_f32 v61,v61,v66
v_mfma_f32_16x16x32_bf16 a[196:199],a[140:143],v[56:59],a[196:199]
v_cmp_nlt_f32 vcc,s37,v61
v_mov_b32 v67,0
v_mfma_f32_16x16x32_bf16 a[192:195],a[136:139],v[56:59],a[192:195]
ds_write2st64_b64 v39,v[96:97],v[100:101] offset0:36 offset1:40
v_mfma_f32_16x16x32_bf16 a[200:203],a[144:147],v[56:59],a[200:203]
s_cmp_lg_u64 vcc,0
v_mov_b32 v63,0
v_mov_b32 v65,0
v_mfma_f32_16x16x32_bf16 a[204:207],a[148:151],v[56:59],a[204:207]
s_cselect_b32 s62,s32,0
ds_read_b128 v[104:107],v10 offset:18432
v_accvgpr_read_b32 v84,a196
v_mfma_f32_16x16x32_bf16 v[156:159],a[148:151],v[52:55],v[156:159]
s_or_b32 s31,s31,s62
ds_read_b128 v[108:111],v10 offset:19456
v_accvgpr_read_b32 v85,a197
ds_read_b128 v[72:75],v10 offset:20480
v_pk_mul_f32 v[84:85],v[84:85],v[66:67] op_sel_hi:[1,0]
ds_read_b128 v[76:79],v10 offset:21504
v_accvgpr_read_b32 v86,a198
v_accvgpr_read_b32 v87,a199
v_pk_mul_f32 v[86:87],v[86:87],v[66:67] op_sel_hi:[1,0]
v_accvgpr_read_b32 v80,a192
v_accvgpr_read_b32 v81,a193
v_pk_mul_f32 v[80:81],v[80:81],v[66:67] op_sel_hi:[1,0]
v_accvgpr_read_b32 v82,a194
v_accvgpr_read_b32 v83,a195
v_pk_mul_f32 v[82:83],v[82:83],v[66:67] op_sel_hi:[1,0]
v_accvgpr_read_b32 v88,a200
v_accvgpr_read_b32 v89,a201
v_mfma_f32_16x16x32_bf16 v[152:155],a[144:147],v[52:55],v[152:155]
s_waitcnt vmcnt(15)
ds_read_b128 a[68:71],v12 offset:12544
v_accvgpr_read_b32 v90,a202
ds_read_b128 a[64:67],v11 offset:12544
s_waitcnt lgkmcnt(5)
buffer_store_dwordx4 v[104:107],v9,s[16:19],s87 offen offset:0 nt
ds_read_b128 a[60:63],v12 offset:12416
v_pk_mul_f32 v[88:89],v[88:89],v[66:67] op_sel_hi:[1,0]
ds_read_b128 a[56:59],v11 offset:12416
v_accvgpr_read_b32 v91,a203
ds_read_b128 a[52:55],v12 offset:12288
v_pk_mul_f32 v[90:91],v[90:91],v[66:67] op_sel_hi:[1,0]
v_accvgpr_read_b32 v92,a204
v_accvgpr_read_b32 v93,a205
v_mfma_f32_16x16x32_bf16 v[248:251],a[144:147],v[48:51],v[248:251]
s_lshl_b32 s32,s32,1
s_waitcnt lgkmcnt(5)
buffer_store_dwordx4 v[108:111],v9,s[16:19],s87 offen offset:3072 nt
ds_read_b128 a[48:51],v11 offset:12288
v_accvgpr_read_b32 v94,a206
v_pk_mul_f32 v[92:93],v[92:93],v[66:67] op_sel_hi:[1,0]
v_pk_mul_f32 v[208:209],v[208:209],v[62:63] op_sel_hi:[1,0]
v_pk_mul_f32 v[210:211],v[210:211],v[62:63] op_sel_hi:[1,0]
v_pk_mul_f32 v[224:225],v[224:225],v[62:63] op_sel_hi:[1,0]
v_pk_mul_f32 v[226:227],v[226:227],v[62:63] op_sel_hi:[1,0]
v_pk_mul_f32 v[212:213],v[212:213],v[62:63] op_sel_hi:[1,0]
v_pk_mul_f32 v[214:215],v[214:215],v[62:63] op_sel_hi:[1,0]
v_pk_mul_f32 v[228:229],v[228:229],v[62:63] op_sel_hi:[1,0]
v_pk_mul_f32 v[230:231],v[230:231],v[62:63] op_sel_hi:[1,0]
buffer_store_dwordx4 v[72:75],v9,s[16:19],s87 offen offset:128 nt
v_pk_mul_f32 v[216:217],v[216:217],v[62:63] op_sel_hi:[1,0]
v_pk_mul_f32 v[218:219],v[218:219],v[62:63] op_sel_hi:[1,0]
v_pk_mul_f32 v[232:233],v[232:233],v[62:63] op_sel_hi:[1,0]
v_pk_mul_f32 v[234:235],v[234:235],v[62:63] op_sel_hi:[1,0]
v_pk_mul_f32 v[220:221],v[220:221],v[62:63] op_sel_hi:[1,0]
v_pk_mul_f32 v[222:223],v[222:223],v[62:63] op_sel_hi:[1,0]
v_pk_mul_f32 v[236:237],v[236:237],v[62:63] op_sel_hi:[1,0]
v_pk_mul_f32 v[238:239],v[238:239],v[62:63] op_sel_hi:[1,0]
v_accvgpr_read_b32 v95,a207
v_pk_mul_f32 v[94:95],v[94:95],v[66:67] op_sel_hi:[1,0]
v_cvt_pk_bf16_f32 v80,v80,v81
v_cvt_pk_bf16_f32 v81,v82,v83
v_mfma_f32_16x16x32_bf16 v[252:255],a[148:151],v[48:51],v[252:255]
s_add_u32 m0,s23,0
ds_write_b64 v36,v[80:81] offset:18432
v_mfma_f32_16x16x32_bf16 v[204:207],a[148:151],v[44:47],v[204:207]
buffer_store_dwordx4 v[76:79],v9,s[16:19],s87 offen offset:3200 nt
v_add_u32 v36,v36,v19
v_cvt_pk_bf16_f32 v84,v84,v85
v_cvt_pk_bf16_f32 v88,v88,v89
v_pk_mul_f32 v[240:241],v[240:241],v[62:63] op_sel_hi:[1,0]
v_pk_mul_f32 v[242:243],v[242:243],v[62:63] op_sel_hi:[1,0]
v_pk_mul_f32 v[112:113],v[112:113],v[64:65] op_sel_hi:[1,0]
v_pk_mul_f32 v[114:115],v[114:115],v[64:65] op_sel_hi:[1,0]
v_cvt_pk_bf16_f32 v85,v86,v87
v_cvt_pk_bf16_f32 v92,v92,v93
v_mfma_f32_16x16x32_bf16 v[200:203],a[144:147],v[44:47],v[200:203]
ds_write_b64 v37,v[84:85] offset:18432
v_add_u32 v37,v37,v19
v_cvt_pk_bf16_f32 v89,v90,v91
v_cvt_pk_bf16_f32 v93,v94,v95
v_cvt_pk_bf16_f32 v208,v208,v209
ds_write_b64 v38,v[88:89] offset:18432
v_add_u32 v38,v38,v19
v_cvt_pk_bf16_f32 v224,v224,v225
v_cvt_pk_bf16_f32 v212,v212,v213
v_cvt_pk_bf16_f32 v228,v228,v229
ds_write_b64 v39,v[92:93] offset:18432
ds_read_b128 v[96:99],v10 offset:18432
v_add_u32 v39,v39,v19
ds_read_b128 v[100:103],v10 offset:19456
v_cvt_pk_bf16_f32 v209,v210,v211
v_cvt_pk_bf16_f32 v225,v226,v227
ds_write2st64_b64 v36,v[208:209],v[224:225] offset0:12 offset1:14
v_cvt_pk_bf16_f32 v216,v216,v217
v_cvt_pk_bf16_f32 v232,v232,v233
v_cvt_pk_bf16_f32 v213,v214,v215
v_cvt_pk_bf16_f32 v229,v230,v231
v_cvt_pk_bf16_f32 v220,v220,v221
v_cvt_pk_bf16_f32 v236,v236,v237
v_cvt_pk_bf16_f32 v217,v218,v219
v_cvt_pk_bf16_f32 v233,v234,v235
v_cvt_pk_bf16_f32 v240,v240,v241
v_cvt_pk_bf16_f32 v112,v112,v113
v_cvt_pk_bf16_f32 v221,v222,v223
ds_write2st64_b64 v37,v[212:213],v[228:229] offset0:12 offset1:14
v_cvt_pk_bf16_f32 v237,v238,v239
s_waitcnt vmcnt(4)
s_barrier
ds_read_b128 a[140:143],v1 offset:256
s_waitcnt lgkmcnt(2)
buffer_store_dwordx4 v[96:99],v9,s[16:19],s87 offen offset:256 nt
ds_read_b128 a[136:139],v0 offset:256
v_cvt_pk_bf16_f32 v241,v242,v243
ds_read_b128 a[132:135],v1 offset:128
v_cvt_pk_bf16_f32 v113,v114,v115
ds_read_b128 a[128:131],v0 offset:128
v_mov_b32 v61,0
ds_write2st64_b64 v38,v[216:217],v[232:233] offset0:12 offset1:14
v_mov_b32 v66,0
buffer_load_dwordx4 v6,s[8:11],s25 offen offset:0 lds
ds_read_b128 a[124:127],v1 offset:0
s_waitcnt lgkmcnt(5)
v_mfma_f32_16x16x32_bf16 v[72:75],a[140:143],a[20:23],0
buffer_store_dwordx4 v[100:103],v9,s[16:19],s87 offen offset:3328 nt
ds_read_b128 a[120:123],v0 offset:0
s_waitcnt lgkmcnt(4)
v_mfma_f32_16x16x32_bf16 v[72:75],a[136:139],a[16:19],v[72:75]
ds_read_b128 a[144:147],v0 offset:6144
ds_read_b128 a[148:151],v1 offset:6144
v_pk_mul_f32 v[244:245],v[244:245],v[62:63] op_sel_hi:[1,0]
ds_write2st64_b64 v39,v[220:221],v[236:237] offset0:12 offset1:14
v_pk_mul_f32 v[246:247],v[246:247],v[62:63] op_sel_hi:[1,0]
v_pk_mul_f32 v[116:117],v[116:117],v[64:65] op_sel_hi:[1,0]
v_pk_mul_f32 v[118:119],v[118:119],v[64:65] op_sel_hi:[1,0]
v_cvt_pk_bf16_f32 v244,v244,v245
v_cvt_pk_bf16_f32 v116,v116,v117
v_mfma_f32_16x16x32_bf16 v[72:75],a[132:135],a[12:15],v[72:75]
buffer_load_dwordx4 v7,s[8:11],s25 offen offset:1024 lds
s_waitcnt lgkmcnt(4)
v_mfma_f32_16x16x32_bf16 v[72:75],a[128:131],a[8:11],v[72:75]
v_cvt_pk_bf16_f32 v245,v246,v247
v_cvt_pk_bf16_f32 v117,v118,v119
v_mfma_f32_16x16x32_bf16 v[72:75],a[124:127],a[4:7],v[72:75]
s_waitcnt lgkmcnt(1)
ds_write2st64_b64 v36,v[240:241],v[112:113] offset0:16 offset1:24
v_mfma_f32_16x16x32_bf16 v[72:75],a[120:123],a[0:3],v[72:75]
v_pk_mul_f32 v[248:249],v[248:249],v[62:63] op_sel_hi:[1,0]
v_pk_mul_f32 v[250:251],v[250:251],v[62:63] op_sel_hi:[1,0]
v_pk_mul_f32 v[120:121],v[120:121],v[64:65] op_sel_hi:[1,0]
v_pk_mul_f32 v[122:123],v[122:123],v[64:65] op_sel_hi:[1,0]
v_cvt_pk_bf16_f32 v248,v248,v249
v_cvt_pk_bf16_f32 v120,v120,v121
v_mfma_f32_16x16x32_bf16 v[80:83],a[120:123],a[24:27],0
buffer_load_dwordx4 v8,s[8:11],s25 offen offset:2048 lds
v_mfma_f32_16x16x32_bf16 v[80:83],a[124:127],a[28:31],v[80:83]
s_waitcnt vmcnt(12)
ds_read_b128 a[72:75],v11 offset:0
v_max3_f32 v44,v72,v73,v74
v_mfma_f32_16x16x32_bf16 v[80:83],a[128:131],a[32:35],v[80:83]
s_mov_b32 s27,s42
ds_read_b128 a[76:79],v12 offset:0
v_cvt_pk_bf16_f32 v249,v250,v251
ds_read_b128 a[80:83],v11 offset:128
v_pk_mul_f32 v[252:253],v[252:253],v[62:63] op_sel_hi:[1,0]
ds_read_b128 a[84:87],v12 offset:128
v_pk_mul_f32 v[254:255],v[254:255],v[62:63] op_sel_hi:[1,0]
ds_read_b128 a[88:91],v11 offset:256
v_pk_mul_f32 v[124:125],v[124:125],v[64:65] op_sel_hi:[1,0]
ds_read_b128 a[92:95],v12 offset:256
v_pk_mul_f32 v[126:127],v[126:127],v[64:65] op_sel_hi:[1,0]
ds_write2st64_b64 v37,v[244:245],v[116:117] offset0:16 offset1:24
v_cvt_pk_bf16_f32 v121,v122,v123
v_mfma_f32_16x16x32_bf16 v[80:83],a[132:135],a[36:39],v[80:83]
s_mov_b32 s42,s41
v_cvt_pk_bf16_f32 v252,v252,v253
v_cvt_pk_bf16_f32 v124,v124,v125
v_mfma_f32_16x16x32_bf16 v[80:83],a[136:139],a[40:43],v[80:83]
s_add_u32 s69,s69,1
v_cvt_pk_bf16_f32 v253,v254,v255
v_cvt_pk_bf16_f32 v125,v126,v127
v_mfma_f32_16x16x32_bf16 v[80:83],a[140:143],a[44:47],v[80:83]
s_lshl_b32 s62,s69,5
ds_write2st64_b64 v38,v[248:249],v[120:121] offset0:16 offset1:24
v_pk_mul_f32 v[128:129],v[128:129],v[64:65] op_sel_hi:[1,0]
v_pk_mul_f32 v[130:131],v[130:131],v[64:65] op_sel_hi:[1,0]
v_pk_mul_f32 v[144:145],v[144:145],v[64:65] op_sel_hi:[1,0]
v_pk_mul_f32 v[146:147],v[146:147],v[64:65] op_sel_hi:[1,0]
v_cvt_pk_bf16_f32 v128,v128,v129
v_cvt_pk_bf16_f32 v144,v144,v145
v_mfma_f32_16x16x32_bf16 v[88:91],a[140:143],a[68:71],0
s_add_u32 s62,s62,s34
v_max3_f32 v48,v80,v81,v82
v_cvt_pk_bf16_f32 v129,v130,v131
v_mfma_f32_16x16x32_bf16 v[88:91],a[136:139],a[64:67],v[88:91]
s_mul_i32 s63,s62,171
v_cvt_pk_bf16_f32 v145,v146,v147
v_mov_b32 v62,0
v_mfma_f32_16x16x32_bf16 v[88:91],a[132:135],a[60:63],v[88:91]
s_lshr_b32 s63,s63,9
ds_write2st64_b64 v39,v[252:253],v[124:125] offset0:16 offset1:24
v_pk_mul_f32 v[132:133],v[132:133],v[64:65] op_sel_hi:[1,0]
v_pk_mul_f32 v[134:135],v[134:135],v[64:65] op_sel_hi:[1,0]
v_pk_mul_f32 v[148:149],v[148:149],v[64:65] op_sel_hi:[1,0]
v_pk_mul_f32 v[150:151],v[150:151],v[64:65] op_sel_hi:[1,0]
v_cvt_pk_bf16_f32 v132,v132,v133
v_cvt_pk_bf16_f32 v148,v148,v149
v_mfma_f32_16x16x32_bf16 v[88:91],a[128:131],a[56:59],v[88:91]
s_mul_i32 s64,s63,3
v_cvt_pk_bf16_f32 v133,v134,v135
v_cvt_pk_bf16_f32 v149,v150,v151
v_mfma_f32_16x16x32_bf16 v[88:91],a[124:127],a[52:55],v[88:91]
s_sub_u32 s62,s62,s64
s_add_u32 s63,s63,s33
ds_write2st64_b64 v36,v[128:129],v[144:145] offset0:26 offset1:28
v_mfma_f32_16x16x32_bf16 v[88:91],a[120:123],a[48:51],v[88:91]
s_mul_i32 s30,s63,196608
s_mul_i32 s41,s63,325632
s_lshl_b32 s63,s3,2
s_waitcnt lgkmcnt(2)
v_mfma_f32_16x16x32_bf16 v[96:99],a[120:123],a[72:75],0
s_add_u32 s64,s63,21
ds_read_b128 a[120:123],v0 offset:6272
s_cmp_eq_u32 s3,0
s_cselect_b32 s64,20,s64
s_cselect_b32 s40,1,0
v_max3_f32 v52,v88,v89,v90
ds_write2st64_b64 v37,v[132:133],v[148:149] offset0:26 offset1:28
v_pk_mul_f32 v[136:137],v[136:137],v[64:65] op_sel_hi:[1,0]
v_pk_mul_f32 v[138:139],v[138:139],v[64:65] op_sel_hi:[1,0]
v_pk_mul_f32 v[152:153],v[152:153],v[64:65] op_sel_hi:[1,0]
v_pk_mul_f32 v[154:155],v[154:155],v[64:65] op_sel_hi:[1,0]
v_cvt_pk_bf16_f32 v136,v136,v137
v_cvt_pk_bf16_f32 v152,v152,v153
v_mfma_f32_16x16x32_bf16 v[96:99],a[124:127],a[76:79],v[96:99]
s_add_u32 s65,s63,37
ds_read_b128 a[124:127],v1 offset:6272
v_cvt_pk_bf16_f32 v137,v138,v139
v_mfma_f32_16x16x32_bf16 v[96:99],a[128:131],a[80:83],v[96:99]
s_cmp_eq_u32 s62,2
ds_read_b128 a[128:131],v0 offset:6400
v_cvt_pk_bf16_f32 v153,v154,v155
v_mfma_f32_16x16x32_bf16 v[96:99],a[132:135],a[84:87],v[96:99]
s_cselect_b32 s64,s65,s64
ds_write2st64_b64 v38,v[136:137],v[152:153] offset0:26 offset1:28
v_pk_mul_f32 v[140:141],v[140:141],v[64:65] op_sel_hi:[1,0]
v_pk_mul_f32 v[142:143],v[142:143],v[64:65] op_sel_hi:[1,0]
v_pk_mul_f32 v[156:157],v[156:157],v[64:65] op_sel_hi:[1,0]
ds_read_b128 a[132:135],v1 offset:6400
v_pk_mul_f32 v[158:159],v[158:159],v[64:65] op_sel_hi:[1,0]
v_cvt_pk_bf16_f32 v140,v140,v141
v_cvt_pk_bf16_f32 v156,v156,v157
v_mfma_f32_16x16x32_bf16 v[96:99],a[136:139],a[88:91],v[96:99]
s_cselect_b32 s40,0,s40
ds_read_b128 a[136:139],v0 offset:12288
v_cvt_pk_bf16_f32 v141,v142,v143
v_mfma_f32_16x16x32_bf16 v[96:99],a[140:143],a[92:95],v[96:99]
s_add_u32 s65,s63,s3
ds_read_b128 a[140:143],v1 offset:12288
v_cvt_pk_bf16_f32 v157,v158,v159
v_mfma_f32_16x16x32_bf16 v[76:79],a[144:147],a[0:3],0
s_cmp_eq_u32 s62,0
ds_write2st64_b64 v39,v[140:141],v[156:157] offset0:26 offset1:28
v_pk_mul_f32 v[160:161],v[160:161],v[60:61] op_sel_hi:[1,0]
v_pk_mul_f32 v[162:163],v[162:163],v[60:61] op_sel_hi:[1,0]
v_pk_mul_f32 v[176:177],v[176:177],v[60:61] op_sel_hi:[1,0]
v_pk_mul_f32 v[178:179],v[178:179],v[60:61] op_sel_hi:[1,0]
v_max3_f32 v56,v96,v97,v98
v_cvt_pk_bf16_f32 v160,v160,v161
v_mfma_f32_16x16x32_bf16 v[76:79],a[148:151],a[4:7],v[76:79]
s_cselect_b32 s64,s65,s64
v_cvt_pk_bf16_f32 v176,v176,v177
v_cvt_pk_bf16_f32 v161,v162,v163
s_waitcnt lgkmcnt(4)
v_mfma_f32_16x16x32_bf16 v[76:79],a[120:123],a[8:11],v[76:79]
s_cselect_b32 s40,1,s40
v_cvt_pk_bf16_f32 v177,v178,v179
v_mov_b32 v64,0
v_mfma_f32_16x16x32_bf16 v[76:79],a[124:127],a[12:15],v[76:79]
s_mul_i32 s64,s64,6144
ds_write2st64_b64 v36,v[160:161],v[176:177] offset0:0 offset1:2
v_pk_mul_f32 v[164:165],v[164:165],v[60:61] op_sel_hi:[1,0]
v_pk_mul_f32 v[166:167],v[166:167],v[60:61] op_sel_hi:[1,0]
v_pk_mul_f32 v[180:181],v[180:181],v[60:61] op_sel_hi:[1,0]
v_pk_mul_f32 v[182:183],v[182:183],v[60:61] op_sel_hi:[1,0]
v_cvt_pk_bf16_f32 v164,v164,v165
v_cvt_pk_bf16_f32 v180,v180,v181
v_mfma_f32_16x16x32_bf16 v[76:79],a[128:131],a[16:19],v[76:79]
s_add_u32 s41,s41,s64
v_cvt_pk_bf16_f32 v165,v166,v167
v_cvt_pk_bf16_f32 v181,v182,v183
s_waitcnt lgkmcnt(1)
v_mfma_f32_16x16x32_bf16 v[76:79],a[132:135],a[20:23],v[76:79]
s_cmp_ge_u32 s69,6
s_cselect_b32 s41,166723584,s41
ds_write2st64_b64 v37,v[164:165],v[180:181] offset0:0 offset1:2
v_mfma_f32_16x16x32_bf16 v[84:87],a[132:135],a[44:47],0
s_cselect_b32 s30,100663296,s30
s_add_u32 s25,s30,s22
s_add_u32 s26,s25,12288
v_mfma_f32_16x16x32_bf16 v[84:87],a[128:131],a[40:43],v[84:87]
s_add_u32 m0,s23,24576
v_max3_f32 v44,v44,v75,v76
v_max3_f32 v44,v44,v77,v78
v_max_f32 v44,v44,v79
v_mov_b32 v45,v44
s_mov_b32 s28,s41
v_pk_mul_f32 v[168:169],v[168:169],v[60:61] op_sel_hi:[1,0]
v_pk_mul_f32 v[170:171],v[170:171],v[60:61] op_sel_hi:[1,0]
v_pk_mul_f32 v[184:185],v[184:185],v[60:61] op_sel_hi:[1,0]
v_pk_mul_f32 v[186:187],v[186:187],v[60:61] op_sel_hi:[1,0]
v_permlane32_swap_b32 v45,v44
v_max_f32 v44,v44,v45
v_mfma_f32_16x16x32_bf16 v[84:87],a[124:127],a[36:39],v[84:87]
s_mov_b32 s29,s24
v_mov_b32 v45,v44
v_cvt_pk_bf16_f32 v168,v168,v169
v_mfma_f32_16x16x32_bf16 v[84:87],a[120:123],a[32:35],v[84:87]
buffer_load_dwordx4 v6,s[8:11],s21 offen offset:0 lds
v_mfma_f32_16x16x32_bf16 v[84:87],a[148:151],a[28:31],v[84:87]
v_permlane16_swap_b32 v45,v44
v_max_f32 v44,v44,v45
v_mul_f32_e64 v13,-s36,v44
v_fma_f32 v72,v72,s36,v13
v_pk_mul_f32 v[172:173],v[172:173],v[60:61] op_sel_hi:[1,0]
v_pk_mul_f32 v[174:175],v[174:175],v[60:61] op_sel_hi:[1,0]
v_pk_mul_f32 v[188:189],v[188:189],v[60:61] op_sel_hi:[1,0]
v_pk_mul_f32 v[190:191],v[190:191],v[60:61] op_sel_hi:[1,0]
v_fma_f32 v73,v73,s36,v13
v_fma_f32 v74,v74,s36,v13
v_mfma_f32_16x16x32_bf16 v[84:87],a[144:147],a[24:27],v[84:87]
v_fma_f32 v75,v75,s36,v13
v_exp_f32 v72,v72
v_mfma_f32_16x16x32_bf16 v[92:95],a[144:147],a[48:51],0
v_exp_f32 v73,v73
v_mfma_f32_16x16x32_bf16 v[92:95],a[148:151],a[52:55],v[92:95]
v_exp_f32 v74,v74
v_exp_f32 v75,v75
buffer_load_dwordx4 v7,s[8:11],s21 offen offset:1024 lds
v_pk_mul_f32 v[192:193],v[192:193],v[60:61] op_sel_hi:[1,0]
v_pk_mul_f32 v[194:195],v[194:195],v[60:61] op_sel_hi:[1,0]
v_cvt_pk_bf16_f32 v20,v72,v73
v_cvt_pk_bf16_f32 v21,v74,v75
v_mfma_f32_16x16x32_bf16 v[92:95],a[120:123],a[56:59],v[92:95]
v_max3_f32 v48,v48,v83,v84
v_max3_f32 v48,v48,v85,v86
v_mfma_f32_16x16x32_bf16 v[92:95],a[124:127],a[60:63],v[92:95]
v_max_f32 v48,v48,v87
v_mov_b32 v49,v48
v_mfma_f32_16x16x32_bf16 v[92:95],a[128:131],a[64:67],v[92:95]
v_fma_f32 v76,v76,s36,v13
v_permlane32_swap_b32 v49,v48
v_max_f32 v48,v48,v49
v_mov_b32 v49,v48
v_pk_mul_f32 v[196:197],v[196:197],v[60:61] op_sel_hi:[1,0]
v_pk_mul_f32 v[198:199],v[198:199],v[60:61] op_sel_hi:[1,0]
v_permlane16_swap_b32 v49,v48
v_max_f32 v48,v48,v49
v_mfma_f32_16x16x32_bf16 v[92:95],a[132:135],a[68:71],v[92:95]
v_mul_f32_e64 v14,-s36,v48
v_fma_f32 v80,v80,s36,v14
v_mfma_f32_16x16x32_bf16 v[100:103],a[132:135],a[92:95],0
buffer_load_dwordx4 v8,s[8:11],s21 offen offset:2048 lds
v_mfma_f32_16x16x32_bf16 v[100:103],a[128:131],a[88:91],v[100:103]
s_add_u32 s21,s21,12288
ds_read_b128 a[128:131],v0 offset:18432
v_fma_f32 v81,v81,s36,v14
v_mfma_f32_16x16x32_bf16 v[100:103],a[124:127],a[84:87],v[100:103]
s_add_u32 m0,s22,0
ds_read_b128 a[124:127],v1 offset:12544
v_fma_f32 v82,v82,s36,v14
ds_read_b128 a[132:135],v1 offset:18432
v_pk_mul_f32 v[200:201],v[200:201],v[60:61] op_sel_hi:[1,0]
v_pk_mul_f32 v[202:203],v[202:203],v[60:61] op_sel_hi:[1,0]
v_fma_f32 v83,v83,s36,v14
v_exp_f32 v80,v80
v_mfma_f32_16x16x32_bf16 v[100:103],a[120:123],a[80:83],v[100:103]
ds_read_b128 a[120:123],v0 offset:12544
v_exp_f32 v81,v81
v_mfma_f32_16x16x32_bf16 v[100:103],a[148:151],a[76:79],v[100:103]
ds_read_b128 a[148:151],v1 offset:12416
v_exp_f32 v82,v82
v_mfma_f32_16x16x32_bf16 v[100:103],a[144:147],a[72:75],v[100:103]
ds_read_b128 a[144:147],v0 offset:12416
v_exp_f32 v83,v83
v_cvt_pk_bf16_f32 v24,v80,v81
v_cvt_pk_bf16_f32 v25,v82,v83
v_pk_mul_f32 v[204:205],v[204:205],v[60:61] op_sel_hi:[1,0]
v_pk_mul_f32 v[206:207],v[206:207],v[60:61] op_sel_hi:[1,0]
v_max3_f32 v52,v52,v91,v92
v_max3_f32 v52,v52,v93,v94
s_waitcnt lgkmcnt(4)
v_mfma_f32_16x16x32_bf16 v[72:75],a[124:127],a[20:23],0
v_max_f32 v52,v52,v95
v_mov_b32 v53,v52
v_max3_f32 v56,v56,v99,v100
v_max3_f32 v56,v56,v101,v102
v_permlane32_swap_b32 v53,v52
v_max_f32 v52,v52,v53
v_mov_b32 v53,v52
v_max_f32 v56,v56,v103
s_waitcnt lgkmcnt(2)
v_mfma_f32_16x16x32_bf16 v[72:75],a[120:123],a[16:19],v[72:75]
s_waitcnt lgkmcnt(1)
v_permlane16_swap_b32 v53,v52
v_max_f32 v52,v52,v53
v_mfma_f32_16x16x32_bf16 v[72:75],a[148:151],a[12:15],v[72:75]
s_waitcnt lgkmcnt(0)
v_mul_f32_e64 v15,-s36,v52
v_fma_f32 v88,v88,s36,v15
v_fma_f32 v89,v89,s36,v15
v_mfma_f32_16x16x32_bf16 v[72:75],a[144:147],a[8:11],v[72:75]
v_fma_f32 v90,v90,s36,v15
v_fma_f32 v91,v91,s36,v15
v_mfma_f32_16x16x32_bf16 v[72:75],a[140:143],a[4:7],v[72:75]
v_exp_f32 v88,v88
v_mfma_f32_16x16x32_bf16 v[72:75],a[136:139],a[0:3],v[72:75]
v_exp_f32 v89,v89
v_mfma_f32_16x16x32_bf16 v[80:83],a[136:139],a[24:27],0
v_exp_f32 v90,v90
v_mfma_f32_16x16x32_bf16 v[80:83],a[140:143],a[28:31],v[80:83]
v_exp_f32 v91,v91
v_mfma_f32_16x16x32_bf16 v[80:83],a[144:147],a[32:35],v[80:83]
v_cvt_pk_bf16_f32 v28,v88,v89
v_cvt_pk_bf16_f32 v29,v90,v91
v_mfma_f32_16x16x32_bf16 v[80:83],a[148:151],a[36:39],v[80:83]
v_mov_b32 v57,v56
v_fma_f32 v77,v77,s36,v13
v_mfma_f32_16x16x32_bf16 v[80:83],a[120:123],a[40:43],v[80:83]
v_permlane32_swap_b32 v57,v56
v_mfma_f32_16x16x32_bf16 v[80:83],a[124:127],a[44:47],v[80:83]
v_max_f32 v56,v56,v57
v_mov_b32 v57,v56
v_mfma_f32_16x16x32_bf16 v[88:91],a[124:127],a[68:71],0
v_fma_f32 v78,v78,s36,v13
v_permlane16_swap_b32 v57,v56
v_mfma_f32_16x16x32_bf16 v[88:91],a[120:123],a[64:67],v[88:91]
v_max_f32 v56,v56,v57
v_mul_f32_e64 v16,-s36,v56
v_mfma_f32_16x16x32_bf16 v[88:91],a[148:151],a[60:63],v[88:91]
v_fma_f32 v96,v96,s36,v16
v_fma_f32 v97,v97,s36,v16
v_mfma_f32_16x16x32_bf16 v[88:91],a[144:147],a[56:59],v[88:91]
v_fma_f32 v98,v98,s36,v16
v_fma_f32 v99,v99,s36,v16
v_mfma_f32_16x16x32_bf16 v[88:91],a[140:143],a[52:55],v[88:91]
v_exp_f32 v96,v96
v_mfma_f32_16x16x32_bf16 v[88:91],a[136:139],a[48:51],v[88:91]
v_exp_f32 v97,v97
v_exp_f32 v98,v98
v_exp_f32 v99,v99
v_cvt_pk_bf16_f32 v32,v96,v97
v_cvt_pk_bf16_f32 v33,v98,v99
v_mfma_f32_16x16x32_bf16 v[96:99],a[136:139],a[72:75],0
ds_read_b128 a[136:139],v0 offset:18560
v_fma_f32 v79,v79,s36,v13
v_mfma_f32_16x16x32_bf16 v[96:99],a[140:143],a[76:79],v[96:99]
ds_read_b128 a[140:143],v1 offset:18560
v_exp_f32 v76,v76
v_mfma_f32_16x16x32_bf16 v[96:99],a[144:147],a[80:83],v[96:99]
ds_read_b128 a[144:147],v0 offset:18688
v_exp_f32 v77,v77
v_mfma_f32_16x16x32_bf16 v[96:99],a[148:151],a[84:87],v[96:99]
ds_read_b128 a[148:151],v1 offset:18688
v_exp_f32 v78,v78
v_mfma_f32_16x16x32_bf16 v[96:99],a[120:123],a[88:91],v[96:99]
v_exp_f32 v79,v79
v_mfma_f32_16x16x32_bf16 v[96:99],a[124:127],a[92:95],v[96:99]
v_cvt_pk_bf16_f32 v22,v76,v77
v_cvt_pk_bf16_f32 v23,v78,v79
v_mfma_f32_16x16x32_bf16 v[76:79],a[128:131],a[0:3],0
v_fma_f32 v84,v84,s36,v14
v_fma_f32 v85,v85,s36,v14
v_mfma_f32_16x16x32_bf16 v[76:79],a[132:135],a[4:7],v[76:79]
s_waitcnt lgkmcnt(3)
v_fma_f32 v86,v86,s36,v14
v_fma_f32 v87,v87,s36,v14
v_mfma_f32_16x16x32_bf16 v[76:79],a[136:139],a[8:11],v[76:79]
s_waitcnt lgkmcnt(2)
v_exp_f32 v84,v84
v_mfma_f32_16x16x32_bf16 v[76:79],a[140:143],a[12:15],v[76:79]
s_waitcnt lgkmcnt(1)
v_exp_f32 v85,v85
v_mfma_f32_16x16x32_bf16 v[76:79],a[144:147],a[16:19],v[76:79]
s_waitcnt lgkmcnt(0)
v_exp_f32 v86,v86
v_mfma_f32_16x16x32_bf16 v[76:79],a[148:151],a[20:23],v[76:79]
v_exp_f32 v87,v87
v_cvt_pk_bf16_f32 v26,v84,v85
v_cvt_pk_bf16_f32 v27,v86,v87
v_mfma_f32_16x16x32_bf16 v[84:87],a[148:151],a[44:47],0
v_fma_f32 v92,v92,s36,v15
v_fma_f32 v93,v93,s36,v15
v_mfma_f32_16x16x32_bf16 v[84:87],a[144:147],a[40:43],v[84:87]
v_fma_f32 v94,v94,s36,v15
v_fma_f32 v95,v95,s36,v15
v_mfma_f32_16x16x32_bf16 v[84:87],a[140:143],a[36:39],v[84:87]
v_exp_f32 v92,v92
v_mfma_f32_16x16x32_bf16 v[84:87],a[136:139],a[32:35],v[84:87]
v_exp_f32 v93,v93
v_mfma_f32_16x16x32_bf16 v[84:87],a[132:135],a[28:31],v[84:87]
v_exp_f32 v94,v94
v_mfma_f32_16x16x32_bf16 v[84:87],a[128:131],a[24:27],v[84:87]
v_exp_f32 v95,v95
v_cvt_pk_bf16_f32 v30,v92,v93
v_cvt_pk_bf16_f32 v31,v94,v95
v_mfma_f32_16x16x32_bf16 v[92:95],a[128:131],a[48:51],0
v_fma_f32 v100,v100,s36,v16
v_fma_f32 v101,v101,s36,v16
v_mfma_f32_16x16x32_bf16 v[92:95],a[132:135],a[52:55],v[92:95]
s_waitcnt vmcnt(3)
s_barrier
v_mfma_f32_16x16x32_bf16 v[92:95],a[136:139],a[56:59],v[92:95]
v_fma_f32 v102,v102,s36,v16
v_fma_f32 v103,v103,s36,v16
v_mfma_f32_16x16x32_bf16 v[92:95],a[140:143],a[60:63],v[92:95]
buffer_load_dwordx4 v6,s[4:7],s20 offen offset:0 lds
v_mfma_f32_16x16x32_bf16 v[92:95],a[144:147],a[64:67],v[92:95]
v_exp_f32 v100,v100
v_mfma_f32_16x16x32_bf16 v[92:95],a[148:151],a[68:71],v[92:95]
v_exp_f32 v101,v101
v_exp_f32 v102,v102
v_exp_f32 v103,v103
v_cvt_pk_bf16_f32 v34,v100,v101
v_cvt_pk_bf16_f32 v35,v102,v103
v_mfma_f32_16x16x32_bf16 v[100:103],a[148:151],a[92:95],0
v_cvt_pk_bf16_f32 v184,v184,v185
v_cvt_pk_bf16_f32 v169,v170,v171
v_smfmac_f32_16x16x64_bf16 v[64:67],a[152:155],v[28:35],v18
buffer_load_dwordx4 v7,s[4:7],s20 offen offset:1024 lds
v_mfma_f32_16x16x32_bf16 v[100:103],a[144:147],a[88:91],v[100:103]
v_cvt_pk_bf16_f32 v172,v172,v173
v_cvt_pk_bf16_f32 v188,v188,v189
v_mfma_f32_16x16x32_bf16 v[100:103],a[140:143],a[84:87],v[100:103]
v_mov_b32 v60,0
v_cvt_pk_bf16_f32 v185,v186,v187
v_mfma_f32_16x16x32_bf16 v[100:103],a[136:139],a[80:83],v[100:103]
ds_write2st64_b64 v38,v[168:169],v[184:185] offset0:0 offset1:2
v_smfmac_f32_16x16x64_bf16 v[60:63],a[152:155],v[20:27],v18
v_cvt_pk_bf16_f32 v192,v192,v193
v_mfma_f32_16x16x32_bf16 v[100:103],a[132:135],a[76:79],v[100:103]
buffer_load_dwordx4 v8,s[4:7],s20 offen offset:2048 lds
v_mfma_f32_16x16x32_bf16 v[100:103],a[128:131],a[72:75],v[100:103]
s_add_u32 s20,s20,12288
ds_read_b64_tr_b16 a[120:121],v2 offset:0
ds_read_b64_tr_b16 a[122:123],v2 offset:6144
ds_read_b64_tr_b16 a[124:125],v3 offset:0
ds_read_b64_tr_b16 a[126:127],v3 offset:6144
ds_read_b64_tr_b16 a[128:129],v4 offset:0
ds_read_b64_tr_b16 a[130:131],v4 offset:6144
ds_read_b64_tr_b16 a[132:133],v5 offset:0
ds_read_b64_tr_b16 a[134:135],v5 offset:6144
v_cvt_pk_bf16_f32 v173,v174,v175
v_cvt_pk_bf16_f32 v189,v190,v191
ds_write2st64_b64 v39,v[172:173],v[188:189] offset0:0 offset1:2
v_cvt_pk_bf16_f32 v196,v196,v197
v_fma_f32 v72,v72,s36,v13
v_fma_f32 v73,v73,s36,v13
v_fma_f32 v74,v74,s36,v13
v_fma_f32 v75,v75,s36,v13
v_fma_f32 v80,v80,s36,v14
v_fma_f32 v81,v81,s36,v14
v_cvt_pk_bf16_f32 v193,v194,v195
v_cvt_pk_bf16_f32 v200,v200,v201
v_cvt_pk_bf16_f32 v197,v198,v199
v_exp_f32 v72,v72
ds_write_b64 v36,v[192:193] offset:2048
v_exp_f32 v73,v73
v_exp_f32 v74,v74
ds_write_b64 v37,v[196:197] offset:2048
v_exp_f32 v75,v75
v_exp_f32 v80,v80
v_exp_f32 v81,v81
v_cvt_pk_bf16_f32 v204,v204,v205
v_cvt_pk_bf16_f32 v201,v202,v203
ds_write_b64 v38,v[200:201] offset:2048
v_cvt_pk_bf16_f32 v205,v206,v207
v_cvt_pk_bf16_f32 v44,v72,v73
v_cvt_pk_bf16_f32 v45,v74,v75
v_cvt_pk_bf16_f32 v48,v80,v81
ds_write_b64 v39,v[204:205] offset:2048
s_waitcnt lgkmcnt(3)
v_mfma_f32_16x16x32_bf16 v[160:163],a[120:123],v[20:23],0
s_add_u32 m0,s23,0
ds_read_b64_tr_b16 a[136:137],v2 offset:128
v_fma_f32 v82,v82,s36,v14
v_mfma_f32_16x16x32_bf16 v[164:167],a[124:127],v[20:23],0
ds_read_b64_tr_b16 a[138:139],v2 offset:6272
v_fma_f32 v83,v83,s36,v14
v_mfma_f32_16x16x32_bf16 v[212:215],a[124:127],v[24:27],0
ds_read_b64_tr_b16 a[140:141],v3 offset:128
v_fma_f32 v88,v88,s36,v15
v_mfma_f32_16x16x32_bf16 v[208:211],a[120:123],v[24:27],0
ds_read_b64_tr_b16 a[142:143],v3 offset:6272
v_fma_f32 v89,v89,s36,v15
v_mfma_f32_16x16x32_bf16 v[112:115],a[120:123],v[28:31],0
ds_read_b64_tr_b16 a[144:145],v4 offset:128
v_fma_f32 v90,v90,s36,v15
v_mfma_f32_16x16x32_bf16 v[116:119],a[124:127],v[28:31],0
ds_read_b64_tr_b16 a[146:147],v4 offset:6272
v_fma_f32 v91,v91,s36,v15
v_mfma_f32_16x16x32_bf16 a[164:167],a[124:127],v[32:35],0
ds_read_b64_tr_b16 a[148:149],v5 offset:128
v_fma_f32 v96,v96,s36,v16
v_mfma_f32_16x16x32_bf16 a[160:163],a[120:123],v[32:35],0
ds_read_b64_tr_b16 a[150:151],v5 offset:6272
v_fma_f32 v97,v97,s36,v16
v_mfma_f32_16x16x32_bf16 a[168:171],a[128:131],v[32:35],0
ds_read_b64_tr_b16 a[120:121],v2 offset:256
v_fma_f32 v98,v98,s36,v16
v_mfma_f32_16x16x32_bf16 a[172:175],a[132:135],v[32:35],0
ds_read_b64_tr_b16 a[122:123],v2 offset:6400
v_fma_f32 v99,v99,s36,v16
v_mfma_f32_16x16x32_bf16 v[124:127],a[132:135],v[28:31],0
ds_read_b64_tr_b16 a[124:125],v3 offset:256
v_fma_f32 v76,v76,s36,v13
v_mfma_f32_16x16x32_bf16 v[120:123],a[128:131],v[28:31],0
ds_read_b64_tr_b16 a[126:127],v3 offset:6400
v_fma_f32 v77,v77,s36,v13
v_mfma_f32_16x16x32_bf16 v[216:219],a[128:131],v[24:27],0
v_exp_f32 v82,v82
v_mfma_f32_16x16x32_bf16 v[220:223],a[132:135],v[24:27],0
v_exp_f32 v83,v83
v_mfma_f32_16x16x32_bf16 v[172:175],a[132:135],v[20:23],0
ds_read_b64_tr_b16 a[132:133],v5 offset:256
v_cvt_pk_bf16_f32 v49,v82,v83
v_mfma_f32_16x16x32_bf16 v[168:171],a[128:131],v[20:23],0
s_waitcnt lgkmcnt(4)
ds_read_b64_tr_b16 a[128:129],v4 offset:256
v_fma_f32 v78,v78,s36,v13
v_mfma_f32_16x16x32_bf16 v[176:179],a[136:139],v[20:23],0
ds_read_b64_tr_b16 a[130:131],v4 offset:6400
v_fma_f32 v79,v79,s36,v13
v_mfma_f32_16x16x32_bf16 v[180:183],a[140:143],v[20:23],0
ds_read_b64_tr_b16 a[134:135],v5 offset:6400
v_fma_f32 v84,v84,s36,v14
v_mfma_f32_16x16x32_bf16 v[228:231],a[140:143],v[24:27],0
v_exp_f32 v88,v88
v_mfma_f32_16x16x32_bf16 v[224:227],a[136:139],v[24:27],0
v_exp_f32 v89,v89
v_mfma_f32_16x16x32_bf16 v[128:131],a[136:139],v[28:31],0
v_exp_f32 v90,v90
v_mfma_f32_16x16x32_bf16 v[132:135],a[140:143],v[28:31],0
v_exp_f32 v91,v91
v_mfma_f32_16x16x32_bf16 a[180:183],a[140:143],v[32:35],0
v_cvt_pk_bf16_f32 v52,v88,v89
v_cvt_pk_bf16_f32 v53,v90,v91
v_mfma_f32_16x16x32_bf16 a[176:179],a[136:139],v[32:35],0
v_exp_f32 v96,v96
v_mfma_f32_16x16x32_bf16 a[184:187],a[144:147],v[32:35],0
v_exp_f32 v97,v97
v_mfma_f32_16x16x32_bf16 a[188:191],a[148:151],v[32:35],0
v_exp_f32 v98,v98
v_mfma_f32_16x16x32_bf16 v[140:143],a[148:151],v[28:31],0
v_exp_f32 v99,v99
v_mfma_f32_16x16x32_bf16 v[136:139],a[144:147],v[28:31],0
v_cvt_pk_bf16_f32 v56,v96,v97
v_cvt_pk_bf16_f32 v57,v98,v99
v_mfma_f32_16x16x32_bf16 v[232:235],a[144:147],v[24:27],0
v_exp_f32 v76,v76
v_mfma_f32_16x16x32_bf16 v[236:239],a[148:151],v[24:27],0
v_exp_f32 v77,v77
v_mfma_f32_16x16x32_bf16 v[188:191],a[148:151],v[20:23],0
v_exp_f32 v78,v78
v_mfma_f32_16x16x32_bf16 v[184:187],a[144:147],v[20:23],0
s_waitcnt lgkmcnt(0)
v_exp_f32 v79,v79
v_mfma_f32_16x16x32_bf16 v[192:195],a[120:123],v[20:23],0
v_cvt_pk_bf16_f32 v46,v76,v77
v_cvt_pk_bf16_f32 v47,v78,v79
v_mfma_f32_16x16x32_bf16 v[196:199],a[124:127],v[20:23],0
s_waitcnt vmcnt(24)
v_fma_f32 v85,v85,s36,v14
v_fma_f32 v86,v86,s36,v14
v_mfma_f32_16x16x32_bf16 v[244:247],a[124:127],v[24:27],0
s_barrier
v_mfma_f32_16x16x32_bf16 v[240:243],a[120:123],v[24:27],0
ds_read_b128 a[148:151],v1 offset:24704
v_fma_f32 v87,v87,s36,v14
v_mfma_f32_16x16x32_bf16 v[144:147],a[120:123],v[28:31],0
ds_read_b128 a[144:147],v0 offset:24704
v_fma_f32 v92,v92,s36,v15
v_mfma_f32_16x16x32_bf16 v[148:151],a[124:127],v[28:31],0
ds_read_b128 a[140:143],v1 offset:24576
v_fma_f32 v93,v93,s36,v15
v_mfma_f32_16x16x32_bf16 a[196:199],a[124:127],v[32:35],0
ds_read_b128 a[124:127],v1 offset:24832
v_fma_f32 v94,v94,s36,v15
v_mfma_f32_16x16x32_bf16 a[192:195],a[120:123],v[32:35],0
ds_read_b128 a[120:123],v0 offset:24832
v_fma_f32 v95,v95,s36,v15
v_mfma_f32_16x16x32_bf16 a[200:203],a[128:131],v[32:35],0
buffer_load_dwordx4 v6,s[8:11],s21 offen offset:0 lds
v_mfma_f32_16x16x32_bf16 a[204:207],a[132:135],v[32:35],0
ds_read_b128 a[136:139],v0 offset:24576
v_fma_f32 v100,v100,s36,v16
v_mfma_f32_16x16x32_bf16 v[156:159],a[132:135],v[28:31],0
v_exp_f32 v84,v84
v_mfma_f32_16x16x32_bf16 v[152:155],a[128:131],v[28:31],0
v_exp_f32 v85,v85
v_mfma_f32_16x16x32_bf16 v[248:251],a[128:131],v[24:27],0
v_exp_f32 v86,v86
v_mfma_f32_16x16x32_bf16 v[252:255],a[132:135],v[24:27],0
v_exp_f32 v87,v87
v_mfma_f32_16x16x32_bf16 v[204:207],a[132:135],v[20:23],0
ds_read_b128 a[132:135],v1 offset:30720
v_cvt_pk_bf16_f32 v50,v84,v85
v_mfma_f32_16x16x32_bf16 v[200:203],a[128:131],v[20:23],0
s_waitcnt lgkmcnt(2)
ds_read_b128 a[128:131],v0 offset:30720
v_cvt_pk_bf16_f32 v51,v86,v87
v_mfma_f32_16x16x32_bf16 v[72:75],a[124:127],a[20:23],0
v_exp_f32 v92,v92
v_smfmac_f32_16x16x64_bf16 v[60:63],a[152:155],v[44:51],v18
buffer_load_dwordx4 v7,s[8:11],s21 offen offset:1024 lds
v_mfma_f32_16x16x32_bf16 v[72:75],a[120:123],a[16:19],v[72:75]
v_exp_f32 v93,v93
v_mfma_f32_16x16x32_bf16 v[72:75],a[148:151],a[12:15],v[72:75]
v_exp_f32 v94,v94
v_mfma_f32_16x16x32_bf16 v[72:75],a[144:147],a[8:11],v[72:75]
v_exp_f32 v95,v95
v_mfma_f32_16x16x32_bf16 v[72:75],a[140:143],a[4:7],v[72:75]
s_waitcnt lgkmcnt(1)
v_cvt_pk_bf16_f32 v54,v92,v93
v_cvt_pk_bf16_f32 v55,v94,v95
v_mfma_f32_16x16x32_bf16 v[72:75],a[136:139],a[0:3],v[72:75]
v_fma_f32 v101,v101,s36,v16
v_fma_f32 v102,v102,s36,v16
v_mfma_f32_16x16x32_bf16 v[80:83],a[136:139],a[24:27],0
v_fma_f32 v103,v103,s36,v16
v_mfma_f32_16x16x32_bf16 v[80:83],a[140:143],a[28:31],v[80:83]
v_exp_f32 v100,v100
v_mfma_f32_16x16x32_bf16 v[80:83],a[144:147],a[32:35],v[80:83]
buffer_load_dwordx4 v8,s[8:11],s21 offen offset:2048 lds
v_mfma_f32_16x16x32_bf16 v[80:83],a[148:151],a[36:39],v[80:83]
s_add_u32 s21,s21,12288
v_exp_f32 v101,v101
v_mfma_f32_16x16x32_bf16 v[80:83],a[120:123],a[40:43],v[80:83]
s_add_u32 m0,s22,12288
v_exp_f32 v102,v102
v_mfma_f32_16x16x32_bf16 v[80:83],a[124:127],a[44:47],v[80:83]
v_exp_f32 v103,v103
v_mfma_f32_16x16x32_bf16 v[88:91],a[124:127],a[68:71],0
v_cvt_pk_bf16_f32 v58,v100,v101
v_cvt_pk_bf16_f32 v59,v102,v103
v_mfma_f32_16x16x32_bf16 v[88:91],a[120:123],a[64:67],v[88:91]
v_fma_f32 v72,v72,s36,v13
v_fma_f32 v73,v73,s36,v13
v_smfmac_f32_16x16x64_bf16 v[64:67],a[152:155],v[52:59],v18
v_fma_f32 v74,v74,s36,v13
v_mfma_f32_16x16x32_bf16 v[88:91],a[148:151],a[60:63],v[88:91]
v_fma_f32 v75,v75,s36,v13
v_fma_f32 v80,v80,s36,v14
v_mfma_f32_16x16x32_bf16 v[88:91],a[144:147],a[56:59],v[88:91]
v_fma_f32 v81,v81,s36,v14
v_mfma_f32_16x16x32_bf16 v[88:91],a[140:143],a[52:55],v[88:91]
buffer_load_dwordx4 v6,s[4:7],s20 offen offset:0 lds
v_mfma_f32_16x16x32_bf16 v[88:91],a[136:139],a[48:51],v[88:91]
v_exp_f32 v72,v72
v_mfma_f32_16x16x32_bf16 v[96:99],a[136:139],a[72:75],0
ds_read_b128 a[136:139],v0 offset:30848
v_mfma_f32_16x16x32_bf16 v[96:99],a[140:143],a[76:79],v[96:99]
ds_read_b128 a[140:143],v1 offset:30848
v_mfma_f32_16x16x32_bf16 v[96:99],a[144:147],a[80:83],v[96:99]
ds_read_b128 a[144:147],v0 offset:30976
v_mfma_f32_16x16x32_bf16 v[96:99],a[148:151],a[84:87],v[96:99]
ds_read_b128 a[148:151],v1 offset:30976
v_mfma_f32_16x16x32_bf16 v[96:99],a[120:123],a[88:91],v[96:99]
v_exp_f32 v73,v73
v_mfma_f32_16x16x32_bf16 v[96:99],a[124:127],a[92:95],v[96:99]
s_waitcnt lgkmcnt(4)
v_exp_f32 v74,v74
v_mfma_f32_16x16x32_bf16 v[76:79],a[128:131],a[0:3],0
v_exp_f32 v75,v75
v_mfma_f32_16x16x32_bf16 v[76:79],a[132:135],a[4:7],v[76:79]
buffer_load_dwordx4 v7,s[4:7],s20 offen offset:1024 lds
s_waitcnt lgkmcnt(3)
v_mfma_f32_16x16x32_bf16 v[76:79],a[136:139],a[8:11],v[76:79]
s_waitcnt lgkmcnt(2)
v_exp_f32 v80,v80
v_mfma_f32_16x16x32_bf16 v[76:79],a[140:143],a[12:15],v[76:79]
s_waitcnt lgkmcnt(0)
v_exp_f32 v81,v81
v_mfma_f32_16x16x32_bf16 v[76:79],a[144:147],a[16:19],v[76:79]
v_cvt_pk_bf16_f32 v20,v72,v73
v_cvt_pk_bf16_f32 v21,v74,v75
v_mfma_f32_16x16x32_bf16 v[76:79],a[148:151],a[20:23],v[76:79]
v_cvt_pk_bf16_f32 v24,v80,v81
v_mfma_f32_16x16x32_bf16 v[84:87],a[148:151],a[44:47],0
v_mfma_f32_16x16x32_bf16 v[84:87],a[144:147],a[40:43],v[84:87]
v_mfma_f32_16x16x32_bf16 v[84:87],a[140:143],a[36:39],v[84:87]
v_mfma_f32_16x16x32_bf16 v[84:87],a[136:139],a[32:35],v[84:87]
v_mfma_f32_16x16x32_bf16 v[84:87],a[132:135],a[28:31],v[84:87]
buffer_load_dwordx4 v8,s[4:7],s20 offen offset:2048 lds
v_mfma_f32_16x16x32_bf16 v[84:87],a[128:131],a[24:27],v[84:87]
s_add_u32 s20,s20,12288
v_mfma_f32_16x16x32_bf16 v[92:95],a[128:131],a[48:51],0
ds_read_b64_tr_b16 a[120:121],v2 offset:12288
v_mfma_f32_16x16x32_bf16 v[92:95],a[132:135],a[52:55],v[92:95]
ds_read_b64_tr_b16 a[122:123],v2 offset:18432
v_mfma_f32_16x16x32_bf16 v[92:95],a[136:139],a[56:59],v[92:95]
ds_read_b64_tr_b16 a[124:125],v3 offset:12288
v_mfma_f32_16x16x32_bf16 v[92:95],a[140:143],a[60:63],v[92:95]
ds_read_b64_tr_b16 a[126:127],v3 offset:18432
v_mfma_f32_16x16x32_bf16 v[92:95],a[144:147],a[64:67],v[92:95]
v_mfma_f32_16x16x32_bf16 v[92:95],a[148:151],a[68:71],v[92:95]
v_mfma_f32_16x16x32_bf16 v[100:103],a[148:151],a[92:95],0
v_mfma_f32_16x16x32_bf16 v[100:103],a[144:147],a[88:91],v[100:103]
v_mfma_f32_16x16x32_bf16 v[100:103],a[140:143],a[84:87],v[100:103]
v_mfma_f32_16x16x32_bf16 v[100:103],a[136:139],a[80:83],v[100:103]
v_mfma_f32_16x16x32_bf16 v[100:103],a[132:135],a[76:79],v[100:103]
ds_read_b64_tr_b16 a[132:133],v5 offset:12288
v_mfma_f32_16x16x32_bf16 v[100:103],a[128:131],a[72:75],v[100:103]
s_waitcnt lgkmcnt(1)
ds_read_b64_tr_b16 a[128:129],v4 offset:12288
ds_read_b64_tr_b16 a[130:131],v4 offset:18432
ds_read_b64_tr_b16 a[134:135],v5 offset:18432
v_mfma_f32_16x16x32_bf16 v[160:163],a[120:123],v[44:47],v[160:163]
s_add_u32 m0,s23,12288
ds_read_b64_tr_b16 a[136:137],v2 offset:12416
v_fma_f32 v82,v82,s36,v14
v_mfma_f32_16x16x32_bf16 v[164:167],a[124:127],v[44:47],v[164:167]
ds_read_b64_tr_b16 a[138:139],v2 offset:18560
v_fma_f32 v83,v83,s36,v14
v_mfma_f32_16x16x32_bf16 v[212:215],a[124:127],v[48:51],v[212:215]
ds_read_b64_tr_b16 a[140:141],v3 offset:12416
v_fma_f32 v88,v88,s36,v15
v_mfma_f32_16x16x32_bf16 v[208:211],a[120:123],v[48:51],v[208:211]
ds_read_b64_tr_b16 a[142:143],v3 offset:18560
v_fma_f32 v89,v89,s36,v15
v_mfma_f32_16x16x32_bf16 v[112:115],a[120:123],v[52:55],v[112:115]
ds_read_b64_tr_b16 a[144:145],v4 offset:12416
v_fma_f32 v90,v90,s36,v15
v_mfma_f32_16x16x32_bf16 v[116:119],a[124:127],v[52:55],v[116:119]
ds_read_b64_tr_b16 a[146:147],v4 offset:18560
v_fma_f32 v91,v91,s36,v15
v_mfma_f32_16x16x32_bf16 a[164:167],a[124:127],v[56:59],a[164:167]
ds_read_b64_tr_b16 a[148:149],v5 offset:12416
v_fma_f32 v96,v96,s36,v16
v_mfma_f32_16x16x32_bf16 a[160:163],a[120:123],v[56:59],a[160:163]
s_waitcnt lgkmcnt(6)
ds_read_b64_tr_b16 a[150:151],v5 offset:18560
v_fma_f32 v97,v97,s36,v16
v_mfma_f32_16x16x32_bf16 a[168:171],a[128:131],v[56:59],a[168:171]
ds_read_b64_tr_b16 a[120:121],v2 offset:12544
v_fma_f32 v98,v98,s36,v16
v_mfma_f32_16x16x32_bf16 a[172:175],a[132:135],v[56:59],a[172:175]
ds_read_b64_tr_b16 a[122:123],v2 offset:18688
v_fma_f32 v99,v99,s36,v16
v_mfma_f32_16x16x32_bf16 v[124:127],a[132:135],v[52:55],v[124:127]
ds_read_b64_tr_b16 a[124:125],v3 offset:12544
v_fma_f32 v76,v76,s36,v13
v_mfma_f32_16x16x32_bf16 v[120:123],a[128:131],v[52:55],v[120:123]
ds_read_b64_tr_b16 a[126:127],v3 offset:18688
v_fma_f32 v77,v77,s36,v13
v_mfma_f32_16x16x32_bf16 v[216:219],a[128:131],v[48:51],v[216:219]
v_exp_f32 v82,v82
v_mfma_f32_16x16x32_bf16 v[220:223],a[132:135],v[48:51],v[220:223]
v_exp_f32 v83,v83
v_mfma_f32_16x16x32_bf16 v[172:175],a[132:135],v[44:47],v[172:175]
ds_read_b64_tr_b16 a[132:133],v5 offset:12544
v_cvt_pk_bf16_f32 v25,v82,v83
v_mfma_f32_16x16x32_bf16 v[168:171],a[128:131],v[44:47],v[168:171]
s_waitcnt lgkmcnt(4)
ds_read_b64_tr_b16 a[128:129],v4 offset:12544
v_fma_f32 v78,v78,s36,v13
v_mfma_f32_16x16x32_bf16 v[176:179],a[136:139],v[44:47],v[176:179]
ds_read_b64_tr_b16 a[130:131],v4 offset:18688
v_fma_f32 v79,v79,s36,v13
v_mfma_f32_16x16x32_bf16 v[180:183],a[140:143],v[44:47],v[180:183]
ds_read_b64_tr_b16 a[134:135],v5 offset:18688
v_fma_f32 v84,v84,s36,v14
v_mfma_f32_16x16x32_bf16 v[228:231],a[140:143],v[48:51],v[228:231]
v_exp_f32 v88,v88
v_mfma_f32_16x16x32_bf16 v[224:227],a[136:139],v[48:51],v[224:227]
v_exp_f32 v89,v89
v_mfma_f32_16x16x32_bf16 v[128:131],a[136:139],v[52:55],v[128:131]
v_exp_f32 v90,v90
v_mfma_f32_16x16x32_bf16 v[132:135],a[140:143],v[52:55],v[132:135]
v_exp_f32 v91,v91
v_mfma_f32_16x16x32_bf16 a[180:183],a[140:143],v[56:59],a[180:183]
v_cvt_pk_bf16_f32 v28,v88,v89
v_cvt_pk_bf16_f32 v29,v90,v91
v_mfma_f32_16x16x32_bf16 a[176:179],a[136:139],v[56:59],a[176:179]
v_exp_f32 v96,v96
v_mfma_f32_16x16x32_bf16 a[184:187],a[144:147],v[56:59],a[184:187]
v_exp_f32 v97,v97
v_mfma_f32_16x16x32_bf16 a[188:191],a[148:151],v[56:59],a[188:191]
v_exp_f32 v98,v98
v_mfma_f32_16x16x32_bf16 v[140:143],a[148:151],v[52:55],v[140:143]
v_exp_f32 v99,v99
v_mfma_f32_16x16x32_bf16 v[136:139],a[144:147],v[52:55],v[136:139]
v_cvt_pk_bf16_f32 v32,v96,v97
v_cvt_pk_bf16_f32 v33,v98,v99
v_mfma_f32_16x16x32_bf16 v[232:235],a[144:147],v[48:51],v[232:235]
v_exp_f32 v76,v76
v_mfma_f32_16x16x32_bf16 v[236:239],a[148:151],v[48:51],v[236:239]
v_exp_f32 v77,v77
v_mfma_f32_16x16x32_bf16 v[188:191],a[148:151],v[44:47],v[188:191]
v_exp_f32 v78,v78
v_mfma_f32_16x16x32_bf16 v[184:187],a[144:147],v[44:47],v[184:187]
s_waitcnt lgkmcnt(0)
v_exp_f32 v79,v79
v_mfma_f32_16x16x32_bf16 v[192:195],a[120:123],v[44:47],v[192:195]
v_cvt_pk_bf16_f32 v22,v76,v77
v_cvt_pk_bf16_f32 v23,v78,v79
v_mfma_f32_16x16x32_bf16 v[196:199],a[124:127],v[44:47],v[196:199]
s_waitcnt vmcnt(6)
v_fma_f32 v85,v85,s36,v14
v_fma_f32 v86,v86,s36,v14
v_mfma_f32_16x16x32_bf16 v[244:247],a[124:127],v[48:51],v[244:247]
s_barrier
v_mfma_f32_16x16x32_bf16 v[240:243],a[120:123],v[48:51],v[240:243]
ds_read_b128 a[148:151],v1 offset:128
v_fma_f32 v87,v87,s36,v14
v_mfma_f32_16x16x32_bf16 v[144:147],a[120:123],v[52:55],v[144:147]
ds_read_b128 a[144:147],v0 offset:128
v_fma_f32 v92,v92,s36,v15
v_mfma_f32_16x16x32_bf16 v[148:151],a[124:127],v[52:55],v[148:151]
ds_read_b128 a[140:143],v1 offset:0
v_fma_f32 v93,v93,s36,v15
v_mfma_f32_16x16x32_bf16 a[196:199],a[124:127],v[56:59],a[196:199]
ds_read_b128 a[124:127],v1 offset:256
v_fma_f32 v94,v94,s36,v15
v_mfma_f32_16x16x32_bf16 a[192:195],a[120:123],v[56:59],a[192:195]
ds_read_b128 a[120:123],v0 offset:256
v_fma_f32 v95,v95,s36,v15
v_mfma_f32_16x16x32_bf16 a[200:203],a[128:131],v[56:59],a[200:203]
buffer_load_dwordx4 v6,s[8:11],s21 offen offset:0 lds
v_mfma_f32_16x16x32_bf16 a[204:207],a[132:135],v[56:59],a[204:207]
ds_read_b128 a[136:139],v0 offset:0
v_fma_f32 v100,v100,s36,v16
v_mfma_f32_16x16x32_bf16 v[156:159],a[132:135],v[52:55],v[156:159]
v_exp_f32 v84,v84
v_mfma_f32_16x16x32_bf16 v[152:155],a[128:131],v[52:55],v[152:155]
v_exp_f32 v85,v85
v_mfma_f32_16x16x32_bf16 v[248:251],a[128:131],v[48:51],v[248:251]
v_exp_f32 v86,v86
v_mfma_f32_16x16x32_bf16 v[252:255],a[132:135],v[48:51],v[252:255]
v_exp_f32 v87,v87
v_mfma_f32_16x16x32_bf16 v[204:207],a[132:135],v[44:47],v[204:207]
ds_read_b128 a[132:135],v1 offset:6144
v_cvt_pk_bf16_f32 v26,v84,v85
v_mfma_f32_16x16x32_bf16 v[200:203],a[128:131],v[44:47],v[200:203]
s_waitcnt lgkmcnt(2)
ds_read_b128 a[128:131],v0 offset:6144
v_cvt_pk_bf16_f32 v27,v86,v87
v_mfma_f32_16x16x32_bf16 v[72:75],a[124:127],a[20:23],0
v_exp_f32 v92,v92
v_smfmac_f32_16x16x64_bf16 v[60:63],a[152:155],v[20:27],v18
buffer_load_dwordx4 v7,s[8:11],s21 offen offset:1024 lds
v_mfma_f32_16x16x32_bf16 v[72:75],a[120:123],a[16:19],v[72:75]
v_exp_f32 v93,v93
v_mfma_f32_16x16x32_bf16 v[72:75],a[148:151],a[12:15],v[72:75]
v_exp_f32 v94,v94
v_mfma_f32_16x16x32_bf16 v[72:75],a[144:147],a[8:11],v[72:75]
v_exp_f32 v95,v95
v_mfma_f32_16x16x32_bf16 v[72:75],a[140:143],a[4:7],v[72:75]
s_waitcnt lgkmcnt(1)
v_cvt_pk_bf16_f32 v30,v92,v93
v_cvt_pk_bf16_f32 v31,v94,v95
v_mfma_f32_16x16x32_bf16 v[72:75],a[136:139],a[0:3],v[72:75]
v_fma_f32 v101,v101,s36,v16
v_fma_f32 v102,v102,s36,v16
v_mfma_f32_16x16x32_bf16 v[80:83],a[136:139],a[24:27],0
v_fma_f32 v103,v103,s36,v16
v_mfma_f32_16x16x32_bf16 v[80:83],a[140:143],a[28:31],v[80:83]
v_exp_f32 v100,v100
v_mfma_f32_16x16x32_bf16 v[80:83],a[144:147],a[32:35],v[80:83]
buffer_load_dwordx4 v8,s[8:11],s21 offen offset:2048 lds
v_mfma_f32_16x16x32_bf16 v[80:83],a[148:151],a[36:39],v[80:83]
s_add_u32 s21,s21,12288
v_exp_f32 v101,v101
v_mfma_f32_16x16x32_bf16 v[80:83],a[120:123],a[40:43],v[80:83]
s_add_u32 m0,s22,24576
v_exp_f32 v102,v102
v_mfma_f32_16x16x32_bf16 v[80:83],a[124:127],a[44:47],v[80:83]
v_exp_f32 v103,v103
v_mfma_f32_16x16x32_bf16 v[88:91],a[124:127],a[68:71],0
v_cvt_pk_bf16_f32 v34,v100,v101
v_cvt_pk_bf16_f32 v35,v102,v103
v_mfma_f32_16x16x32_bf16 v[88:91],a[120:123],a[64:67],v[88:91]
v_fma_f32 v72,v72,s36,v13
v_fma_f32 v73,v73,s36,v13
v_smfmac_f32_16x16x64_bf16 v[64:67],a[152:155],v[28:35],v18
v_fma_f32 v74,v74,s36,v13
v_mfma_f32_16x16x32_bf16 v[88:91],a[148:151],a[60:63],v[88:91]
v_fma_f32 v75,v75,s36,v13
v_fma_f32 v80,v80,s36,v14
v_mfma_f32_16x16x32_bf16 v[88:91],a[144:147],a[56:59],v[88:91]
v_fma_f32 v81,v81,s36,v14
v_mfma_f32_16x16x32_bf16 v[88:91],a[140:143],a[52:55],v[88:91]
buffer_load_dwordx4 v6,s[4:7],s20 offen offset:0 lds
v_mfma_f32_16x16x32_bf16 v[88:91],a[136:139],a[48:51],v[88:91]
v_exp_f32 v72,v72
v_mfma_f32_16x16x32_bf16 v[96:99],a[136:139],a[72:75],0
ds_read_b128 a[136:139],v0 offset:6272
v_mfma_f32_16x16x32_bf16 v[96:99],a[140:143],a[76:79],v[96:99]
ds_read_b128 a[140:143],v1 offset:6272
v_mfma_f32_16x16x32_bf16 v[96:99],a[144:147],a[80:83],v[96:99]
ds_read_b128 a[144:147],v0 offset:6400
v_mfma_f32_16x16x32_bf16 v[96:99],a[148:151],a[84:87],v[96:99]
ds_read_b128 a[148:151],v1 offset:6400
v_mfma_f32_16x16x32_bf16 v[96:99],a[120:123],a[88:91],v[96:99]
v_exp_f32 v73,v73
v_mfma_f32_16x16x32_bf16 v[96:99],a[124:127],a[92:95],v[96:99]
s_waitcnt lgkmcnt(4)
v_exp_f32 v74,v74
v_mfma_f32_16x16x32_bf16 v[76:79],a[128:131],a[0:3],0
v_exp_f32 v75,v75
v_mfma_f32_16x16x32_bf16 v[76:79],a[132:135],a[4:7],v[76:79]
buffer_load_dwordx4 v7,s[4:7],s20 offen offset:1024 lds
s_waitcnt lgkmcnt(3)
v_mfma_f32_16x16x32_bf16 v[76:79],a[136:139],a[8:11],v[76:79]
s_waitcnt lgkmcnt(2)
v_exp_f32 v80,v80
v_mfma_f32_16x16x32_bf16 v[76:79],a[140:143],a[12:15],v[76:79]
s_waitcnt lgkmcnt(0)
v_exp_f32 v81,v81
v_mfma_f32_16x16x32_bf16 v[76:79],a[144:147],a[16:19],v[76:79]
v_cvt_pk_bf16_f32 v44,v72,v73
v_cvt_pk_bf16_f32 v45,v74,v75
v_mfma_f32_16x16x32_bf16 v[76:79],a[148:151],a[20:23],v[76:79]
v_cvt_pk_bf16_f32 v48,v80,v81
v_mfma_f32_16x16x32_bf16 v[84:87],a[148:151],a[44:47],0
v_mfma_f32_16x16x32_bf16 v[84:87],a[144:147],a[40:43],v[84:87]
v_mfma_f32_16x16x32_bf16 v[84:87],a[140:143],a[36:39],v[84:87]
v_mfma_f32_16x16x32_bf16 v[84:87],a[136:139],a[32:35],v[84:87]
v_mfma_f32_16x16x32_bf16 v[84:87],a[132:135],a[28:31],v[84:87]
buffer_load_dwordx4 v8,s[4:7],s20 offen offset:2048 lds
v_mfma_f32_16x16x32_bf16 v[84:87],a[128:131],a[24:27],v[84:87]
s_add_u32 s20,s20,12288
v_mfma_f32_16x16x32_bf16 v[92:95],a[128:131],a[48:51],0
ds_read_b64_tr_b16 a[120:121],v2 offset:24576
v_mfma_f32_16x16x32_bf16 v[92:95],a[132:135],a[52:55],v[92:95]
ds_read_b64_tr_b16 a[122:123],v2 offset:30720
v_mfma_f32_16x16x32_bf16 v[92:95],a[136:139],a[56:59],v[92:95]
ds_read_b64_tr_b16 a[124:125],v3 offset:24576
v_mfma_f32_16x16x32_bf16 v[92:95],a[140:143],a[60:63],v[92:95]
ds_read_b64_tr_b16 a[126:127],v3 offset:30720
v_mfma_f32_16x16x32_bf16 v[92:95],a[144:147],a[64:67],v[92:95]
v_mfma_f32_16x16x32_bf16 v[92:95],a[148:151],a[68:71],v[92:95]
v_mfma_f32_16x16x32_bf16 v[100:103],a[148:151],a[92:95],0
v_mfma_f32_16x16x32_bf16 v[100:103],a[144:147],a[88:91],v[100:103]
v_mfma_f32_16x16x32_bf16 v[100:103],a[140:143],a[84:87],v[100:103]
v_mfma_f32_16x16x32_bf16 v[100:103],a[136:139],a[80:83],v[100:103]
v_mfma_f32_16x16x32_bf16 v[100:103],a[132:135],a[76:79],v[100:103]
ds_read_b64_tr_b16 a[132:133],v5 offset:24576
v_mfma_f32_16x16x32_bf16 v[100:103],a[128:131],a[72:75],v[100:103]
ds_read_b64_tr_b16 a[128:129],v4 offset:24576
ds_read_b64_tr_b16 a[130:131],v4 offset:30720
ds_read_b64_tr_b16 a[134:135],v5 offset:30720
s_mov_b32 s38,0
s_branch L_loop4
L_end5:
s_waitcnt lgkmcnt(3)
v_mfma_f32_16x16x32_bf16 v[160:163],a[120:123],v[20:23],v[160:163]
ds_read_b64_tr_b16 a[136:137],v2 offset:24704
v_fma_f32 v90,v90,s36,v15
v_mfma_f32_16x16x32_bf16 v[164:167],a[124:127],v[20:23],v[164:167]
ds_read_b64_tr_b16 a[138:139],v2 offset:30848
v_fma_f32 v91,v91,s36,v15
v_mfma_f32_16x16x32_bf16 v[212:215],a[124:127],v[24:27],v[212:215]
ds_read_b64_tr_b16 a[140:141],v3 offset:24704
v_fma_f32 v96,v96,s36,v16
v_mfma_f32_16x16x32_bf16 v[208:211],a[120:123],v[24:27],v[208:211]
ds_read_b64_tr_b16 a[142:143],v3 offset:30848
v_fma_f32 v97,v97,s36,v16
v_mfma_f32_16x16x32_bf16 v[112:115],a[120:123],v[28:31],v[112:115]
ds_read_b64_tr_b16 a[144:145],v4 offset:24704
v_fma_f32 v98,v98,s36,v16
v_mfma_f32_16x16x32_bf16 v[116:119],a[124:127],v[28:31],v[116:119]
ds_read_b64_tr_b16 a[146:147],v4 offset:30848
ds_read_b64_tr_b16 a[148:149],v5 offset:24704
ds_read_b64_tr_b16 a[150:151],v5 offset:30848
v_mfma_f32_16x16x32_bf16 a[164:167],a[124:127],v[32:35],a[164:167]
v_fma_f32 v99,v99,s36,v16
v_fma_f32 v104,v104,s36,v17
v_mfma_f32_16x16x32_bf16 a[160:163],a[120:123],v[32:35],a[160:163]
v_fma_f32 v105,v105,s36,v17
v_fma_f32 v106,v106,s36,v17
v_mfma_f32_16x16x32_bf16 a[208:211],a[120:123],v[36:39],a[208:211]
ds_read_b64_tr_b16 a[120:121],v2 offset:24832
v_fma_f32 v107,v107,s36,v17
v_mfma_f32_16x16x32_bf16 a[212:215],a[124:127],v[36:39],a[212:215]
s_waitcnt lgkmcnt(6)
ds_read_b64_tr_b16 a[122:123],v2 offset:30976
v_fma_f32 v76,v76,s36,v13
v_mfma_f32_16x16x32_bf16 a[216:219],a[128:131],v[36:39],a[216:219]
ds_read_b64_tr_b16 a[124:125],v3 offset:24832
v_fma_f32 v77,v77,s36,v13
v_mfma_f32_16x16x32_bf16 a[220:223],a[132:135],v[36:39],a[220:223]
ds_read_b64_tr_b16 a[126:127],v3 offset:30976
v_fma_f32 v78,v78,s36,v13
v_mfma_f32_16x16x32_bf16 a[172:175],a[132:135],v[32:35],a[172:175]
v_fma_f32 v79,v79,s36,v13
v_fma_f32 v84,v84,s36,v14
v_mfma_f32_16x16x32_bf16 a[168:171],a[128:131],v[32:35],a[168:171]
v_fma_f32 v85,v85,s36,v14
v_fma_f32 v86,v86,s36,v14
v_mfma_f32_16x16x32_bf16 v[120:123],a[128:131],v[28:31],v[120:123]
v_fma_f32 v87,v87,s36,v14
v_fma_f32 v92,v92,s36,v15
v_mfma_f32_16x16x32_bf16 v[124:127],a[132:135],v[28:31],v[124:127]
v_fma_f32 v93,v93,s36,v15
v_fma_f32 v94,v94,s36,v15
v_mfma_f32_16x16x32_bf16 v[220:223],a[132:135],v[24:27],v[220:223]
v_fma_f32 v95,v95,s36,v15
v_fma_f32 v100,v100,s36,v16
v_mfma_f32_16x16x32_bf16 v[216:219],a[128:131],v[24:27],v[216:219]
v_fma_f32 v101,v101,s36,v16
v_fma_f32 v102,v102,s36,v16
v_mfma_f32_16x16x32_bf16 v[168:171],a[128:131],v[20:23],v[168:171]
ds_read_b64_tr_b16 a[128:129],v4 offset:24832
v_fma_f32 v103,v103,s36,v16
v_mfma_f32_16x16x32_bf16 v[172:175],a[132:135],v[20:23],v[172:175]
ds_read_b64_tr_b16 a[130:131],v4 offset:30976
v_fma_f32 v108,v108,s36,v17
v_mfma_f32_16x16x32_bf16 v[176:179],a[136:139],v[20:23],v[176:179]
s_waitcnt lgkmcnt(2)
ds_read_b64_tr_b16 a[132:133],v5 offset:24832
v_fma_f32 v109,v109,s36,v17
v_mfma_f32_16x16x32_bf16 v[180:183],a[140:143],v[20:23],v[180:183]
ds_read_b64_tr_b16 a[134:135],v5 offset:30976
v_fma_f32 v110,v110,s36,v17
v_mfma_f32_16x16x32_bf16 v[228:231],a[140:143],v[24:27],v[228:231]
v_fma_f32 v111,v111,s36,v17
v_exp_f32 v90,v90
v_mfma_f32_16x16x32_bf16 v[224:227],a[136:139],v[24:27],v[224:227]
v_exp_f32 v91,v91
v_mfma_f32_16x16x32_bf16 v[128:131],a[136:139],v[28:31],v[128:131]
v_exp_f32 v96,v96
v_mfma_f32_16x16x32_bf16 v[132:135],a[140:143],v[28:31],v[132:135]
v_exp_f32 v97,v97
v_mfma_f32_16x16x32_bf16 a[180:183],a[140:143],v[32:35],a[180:183]
v_exp_f32 v98,v98
v_mfma_f32_16x16x32_bf16 a[176:179],a[136:139],v[32:35],a[176:179]
v_exp_f32 v99,v99
v_mfma_f32_16x16x32_bf16 a[224:227],a[136:139],v[36:39],a[224:227]
v_exp_f32 v104,v104
v_mfma_f32_16x16x32_bf16 a[228:231],a[140:143],v[36:39],a[228:231]
v_exp_f32 v105,v105
v_mfma_f32_16x16x32_bf16 a[232:235],a[144:147],v[36:39],a[232:235]
v_exp_f32 v106,v106
v_mfma_f32_16x16x32_bf16 a[236:239],a[148:151],v[36:39],a[236:239]
v_exp_f32 v107,v107
v_mfma_f32_16x16x32_bf16 a[188:191],a[148:151],v[32:35],a[188:191]
v_exp_f32 v76,v76
v_mfma_f32_16x16x32_bf16 a[184:187],a[144:147],v[32:35],a[184:187]
v_exp_f32 v77,v77
v_mfma_f32_16x16x32_bf16 v[136:139],a[144:147],v[28:31],v[136:139]
v_exp_f32 v78,v78
v_mfma_f32_16x16x32_bf16 v[140:143],a[148:151],v[28:31],v[140:143]
v_exp_f32 v79,v79
v_mfma_f32_16x16x32_bf16 v[236:239],a[148:151],v[24:27],v[236:239]
v_exp_f32 v84,v84
v_mfma_f32_16x16x32_bf16 v[232:235],a[144:147],v[24:27],v[232:235]
v_exp_f32 v85,v85
v_mfma_f32_16x16x32_bf16 v[184:187],a[144:147],v[20:23],v[184:187]
v_exp_f32 v86,v86
v_mfma_f32_16x16x32_bf16 v[188:191],a[148:151],v[20:23],v[188:191]
v_exp_f32 v87,v87
v_mfma_f32_16x16x32_bf16 v[192:195],a[120:123],v[20:23],v[192:195]
v_exp_f32 v92,v92
v_mfma_f32_16x16x32_bf16 v[196:199],a[124:127],v[20:23],v[196:199]
v_exp_f32 v93,v93
v_mfma_f32_16x16x32_bf16 v[244:247],a[124:127],v[24:27],v[244:247]
v_exp_f32 v94,v94
v_mfma_f32_16x16x32_bf16 v[240:243],a[120:123],v[24:27],v[240:243]
v_exp_f32 v95,v95
v_mfma_f32_16x16x32_bf16 v[144:147],a[120:123],v[28:31],v[144:147]
v_exp_f32 v100,v100
v_mfma_f32_16x16x32_bf16 v[148:151],a[124:127],v[28:31],v[148:151]
v_exp_f32 v101,v101
v_mfma_f32_16x16x32_bf16 a[196:199],a[124:127],v[32:35],a[196:199]
v_exp_f32 v102,v102
v_mfma_f32_16x16x32_bf16 a[192:195],a[120:123],v[32:35],a[192:195]
v_exp_f32 v103,v103
v_mfma_f32_16x16x32_bf16 a[240:243],a[120:123],v[36:39],a[240:243]
v_exp_f32 v108,v108
s_waitcnt vmcnt(14) lgkmcnt(0)
s_barrier
v_mfma_f32_16x16x32_bf16 a[244:247],a[124:127],v[36:39],a[244:247]
v_exp_f32 v109,v109
v_mfma_f32_16x16x32_bf16 a[248:251],a[128:131],v[36:39],a[248:251]
v_exp_f32 v110,v110
v_mfma_f32_16x16x32_bf16 a[252:255],a[132:135],v[36:39],a[252:255]
v_exp_f32 v111,v111
v_mfma_f32_16x16x32_bf16 a[204:207],a[132:135],v[32:35],a[204:207]
v_cvt_pk_bf16_f32 v53,v90,v91
v_cvt_pk_bf16_f32 v56,v96,v97
v_mfma_f32_16x16x32_bf16 a[200:203],a[128:131],v[32:35],a[200:203]
v_cvt_pk_bf16_f32 v57,v98,v99
v_cvt_pk_bf16_f32 v40,v104,v105
v_mfma_f32_16x16x32_bf16 v[152:155],a[128:131],v[28:31],v[152:155]
v_cvt_pk_bf16_f32 v41,v106,v107
v_cvt_pk_bf16_f32 v46,v76,v77
v_mfma_f32_16x16x32_bf16 v[156:159],a[132:135],v[28:31],v[156:159]
v_cvt_pk_bf16_f32 v47,v78,v79
v_cvt_pk_bf16_f32 v50,v84,v85
v_mfma_f32_16x16x32_bf16 v[252:255],a[132:135],v[24:27],v[252:255]
v_cvt_pk_bf16_f32 v51,v86,v87
v_cvt_pk_bf16_f32 v54,v92,v93
v_mfma_f32_16x16x32_bf16 v[248:251],a[128:131],v[24:27],v[248:251]
v_cvt_pk_bf16_f32 v55,v94,v95
v_cvt_pk_bf16_f32 v58,v100,v101
v_smfmac_f32_16x16x64_bf16 v[60:63],a[152:155],v[44:51],v18
v_cvt_pk_bf16_f32 v59,v102,v103
v_mfma_f32_16x16x32_bf16 v[200:203],a[128:131],v[20:23],v[200:203]
v_cvt_pk_bf16_f32 v42,v108,v109
v_cvt_pk_bf16_f32 v43,v110,v111
v_smfmac_f32_16x16x64_bf16 v[64:67],a[152:155],v[52:59],v18
v_subrev_u32 v10,18432,v10
v_smfmac_f32_16x16x64_bf16 v[68:71],a[152:155],v[36:43],v18
v_mfma_f32_16x16x32_bf16 v[204:207],a[132:135],v[20:23],v[204:207]
ds_read_b64_tr_b16 a[136:137],v2 offset:0
ds_read_b64_tr_b16 a[138:139],v2 offset:6144
ds_read_b64_tr_b16 a[140:141],v3 offset:0
ds_read_b64_tr_b16 a[142:143],v3 offset:6144
ds_read_b64_tr_b16 a[144:145],v4 offset:0
ds_read_b64_tr_b16 a[146:147],v4 offset:6144
ds_read_b64_tr_b16 a[148:149],v5 offset:0
ds_read_b64_tr_b16 a[150:151],v5 offset:6144
s_waitcnt lgkmcnt(6)
v_mfma_f32_16x16x32_bf16 v[160:163],a[136:139],v[44:47],v[160:163]
s_waitcnt vmcnt(6)
ds_read_b64_tr_b16 a[120:121],v2 offset:128
v_mbcnt_lo_u32_b32 v39,-1,0
s_waitcnt lgkmcnt(5)
v_mfma_f32_16x16x32_bf16 v[164:167],a[140:143],v[44:47],v[164:167]
s_add_u32 s84,s42,0
ds_read_b64_tr_b16 a[122:123],v2 offset:6272
v_mbcnt_hi_u32_b32 v39,-1,v39
v_mfma_f32_16x16x32_bf16 v[212:215],a[140:143],v[48:51],v[212:215]
s_add_u32 s85,s42,6144
ds_read_b64_tr_b16 a[124:125],v3 offset:128
v_and_b32 v38,7,v39
v_mfma_f32_16x16x32_bf16 v[208:211],a[136:139],v[48:51],v[208:211]
s_add_u32 s86,s42,12288
ds_read_b64_tr_b16 a[126:127],v3 offset:6272
v_lshrrev_b32 v19,5,v39
v_mfma_f32_16x16x32_bf16 v[112:115],a[136:139],v[52:55],v[112:115]
s_add_u32 s87,s42,18432
ds_read_b64_tr_b16 a[128:129],v4 offset:128
v_xor_b32 v38,v38,v19
v_mfma_f32_16x16x32_bf16 v[116:119],a[140:143],v[52:55],v[116:119]
s_add_u32 s66,s42,24576
ds_read_b64_tr_b16 a[130:131],v4 offset:6272
ds_read_b64_tr_b16 a[132:133],v5 offset:128
ds_read_b64_tr_b16 a[134:135],v5 offset:6272
v_mfma_f32_16x16x32_bf16 a[164:167],a[140:143],v[56:59],a[164:167]
v_and_b32 v19,15,v39
v_lshl_add_u32 v19,v19,7,s24
v_mfma_f32_16x16x32_bf16 a[160:163],a[136:139],v[56:59],a[160:163]
v_lshl_add_u32 v19,v38,4,v19
v_bfe_u32 v38,v39,4,1
v_mfma_f32_16x16x32_bf16 a[208:211],a[136:139],v[40:43],a[208:211]
ds_read_b64_tr_b16 a[136:137],v2 offset:256
v_lshl_add_u32 v36,v38,3,v19
v_mfma_f32_16x16x32_bf16 a[212:215],a[140:143],v[40:43],a[212:215]
s_waitcnt lgkmcnt(6)
ds_read_b64_tr_b16 a[138:139],v2 offset:6400
v_xor_b32 v37,32,v36
v_mfma_f32_16x16x32_bf16 a[216:219],a[144:147],v[40:43],a[216:219]
ds_read_b64_tr_b16 a[140:141],v3 offset:256
v_xor_b32 v38,64,v36
v_mfma_f32_16x16x32_bf16 a[220:223],a[148:151],v[40:43],a[220:223]
ds_read_b64_tr_b16 a[142:143],v3 offset:6400
v_bfe_u32 v19,v39,3,1
v_xor_b32 v39,96,v36
v_lshlrev_b32 v19,11,v19
v_add_f32 v68,v68,v69
v_add_f32 v68,v68,v70
v_add_f32 v66,v66,v67
v_add_f32 v68,v68,v71
v_rcp_f32 v66,v66
v_rcp_f32 v68,v68
v_accvgpr_read_b32 v72,a160
v_accvgpr_read_b32 v73,a161
v_pk_mul_f32 v[72:73],v[72:73],v[66:67] op_sel_hi:[1,0]
v_accvgpr_read_b32 v74,a162
v_accvgpr_read_b32 v75,a163
v_pk_mul_f32 v[74:75],v[74:75],v[66:67] op_sel_hi:[1,0]
v_accvgpr_read_b32 v76,a208
v_accvgpr_read_b32 v77,a209
v_pk_mul_f32 v[76:77],v[76:77],v[68:69] op_sel_hi:[1,0]
v_accvgpr_read_b32 v78,a210
v_accvgpr_read_b32 v79,a211
v_pk_mul_f32 v[78:79],v[78:79],v[68:69] op_sel_hi:[1,0]
v_accvgpr_read_b32 v80,a164
v_accvgpr_read_b32 v81,a165
v_mfma_f32_16x16x32_bf16 a[172:175],a[148:151],v[56:59],a[172:175]
v_accvgpr_read_b32 v82,a166
v_accvgpr_read_b32 v83,a167
v_accvgpr_read_b32 v84,a212
v_accvgpr_read_b32 v85,a213
v_accvgpr_read_b32 v86,a214
v_pk_mul_f32 v[80:81],v[80:81],v[66:67] op_sel_hi:[1,0]
v_pk_mul_f32 v[82:83],v[82:83],v[66:67] op_sel_hi:[1,0]
v_pk_mul_f32 v[84:85],v[84:85],v[68:69] op_sel_hi:[1,0]
v_accvgpr_read_b32 v87,a215
v_pk_mul_f32 v[86:87],v[86:87],v[68:69] op_sel_hi:[1,0]
v_accvgpr_read_b32 v92,a216
v_accvgpr_read_b32 v93,a217
v_mfma_f32_16x16x32_bf16 a[168:171],a[144:147],v[56:59],a[168:171]
v_accvgpr_read_b32 v94,a218
v_accvgpr_read_b32 v95,a219
v_mfma_f32_16x16x32_bf16 v[120:123],a[144:147],v[52:55],v[120:123]
v_accvgpr_read_b32 v100,a220
v_accvgpr_read_b32 v101,a221
v_mfma_f32_16x16x32_bf16 v[124:127],a[148:151],v[52:55],v[124:127]
v_accvgpr_read_b32 v102,a222
v_accvgpr_read_b32 v103,a223
v_mfma_f32_16x16x32_bf16 v[220:223],a[148:151],v[48:51],v[220:223]
v_accvgpr_read_b32 v96,a172
v_accvgpr_read_b32 v97,a173
v_accvgpr_read_b32 v98,a174
v_accvgpr_read_b32 v99,a175
v_accvgpr_read_b32 v88,a168
v_pk_mul_f32 v[92:93],v[92:93],v[68:69] op_sel_hi:[1,0]
v_pk_mul_f32 v[94:95],v[94:95],v[68:69] op_sel_hi:[1,0]
v_pk_mul_f32 v[100:101],v[100:101],v[68:69] op_sel_hi:[1,0]
v_pk_mul_f32 v[102:103],v[102:103],v[68:69] op_sel_hi:[1,0]
v_pk_mul_f32 v[96:97],v[96:97],v[66:67] op_sel_hi:[1,0]
v_pk_mul_f32 v[98:99],v[98:99],v[66:67] op_sel_hi:[1,0]
v_accvgpr_read_b32 v89,a169
v_pk_mul_f32 v[88:89],v[88:89],v[66:67] op_sel_hi:[1,0]
v_accvgpr_read_b32 v90,a170
v_accvgpr_read_b32 v91,a171
v_pk_mul_f32 v[90:91],v[90:91],v[66:67] op_sel_hi:[1,0]
v_cvt_pk_bf16_f32 v72,v72,v73
v_cvt_pk_bf16_f32 v76,v76,v77
v_mfma_f32_16x16x32_bf16 v[216:219],a[144:147],v[48:51],v[216:219]
v_cvt_pk_bf16_f32 v80,v80,v81
v_cvt_pk_bf16_f32 v84,v84,v85
v_mfma_f32_16x16x32_bf16 v[168:171],a[144:147],v[44:47],v[168:171]
ds_read_b64_tr_b16 a[144:145],v4 offset:256
v_cvt_pk_bf16_f32 v73,v74,v75
v_mfma_f32_16x16x32_bf16 v[172:175],a[148:151],v[44:47],v[172:175]
ds_read_b64_tr_b16 a[146:147],v4 offset:6400
v_cvt_pk_bf16_f32 v77,v78,v79
v_mfma_f32_16x16x32_bf16 v[176:179],a[120:123],v[44:47],v[176:179]
s_waitcnt lgkmcnt(2)
ds_read_b64_tr_b16 a[148:149],v5 offset:256
v_cvt_pk_bf16_f32 v81,v82,v83
v_mfma_f32_16x16x32_bf16 v[180:183],a[124:127],v[44:47],v[180:183]
ds_read_b64_tr_b16 a[150:151],v5 offset:6400
v_cvt_pk_bf16_f32 v85,v86,v87
v_mfma_f32_16x16x32_bf16 v[228:231],a[124:127],v[48:51],v[228:231]
ds_write2st64_b64 v36,v[72:73],v[76:77] offset0:36 offset1:40
v_mfma_f32_16x16x32_bf16 v[224:227],a[120:123],v[48:51],v[224:227]
v_cvt_pk_bf16_f32 v92,v92,v93
v_cvt_pk_bf16_f32 v88,v88,v89
v_mfma_f32_16x16x32_bf16 v[128:131],a[120:123],v[52:55],v[128:131]
v_cvt_pk_bf16_f32 v93,v94,v95
v_cvt_pk_bf16_f32 v89,v90,v91
v_mfma_f32_16x16x32_bf16 v[132:135],a[124:127],v[52:55],v[132:135]
v_cvt_pk_bf16_f32 v100,v100,v101
v_cvt_pk_bf16_f32 v96,v96,v97
v_mfma_f32_16x16x32_bf16 a[180:183],a[124:127],v[56:59],a[180:183]
ds_write2st64_b64 v37,v[80:81],v[84:85] offset0:36 offset1:40
v_mfma_f32_16x16x32_bf16 a[176:179],a[120:123],v[56:59],a[176:179]
v_cvt_pk_bf16_f32 v101,v102,v103
v_cvt_pk_bf16_f32 v97,v98,v99
v_mfma_f32_16x16x32_bf16 a[224:227],a[120:123],v[40:43],a[224:227]
v_add_f32 v62,v62,v63
v_add_f32 v64,v64,v65
v_mfma_f32_16x16x32_bf16 a[228:231],a[124:127],v[40:43],a[228:231]
v_accvgpr_read_b32 v90,a182
v_accvgpr_read_b32 v91,a183
v_mfma_f32_16x16x32_bf16 a[232:235],a[128:131],v[40:43],a[232:235]
ds_write2st64_b64 v38,v[88:89],v[92:93] offset0:36 offset1:40
v_mfma_f32_16x16x32_bf16 a[236:239],a[132:135],v[40:43],a[236:239]
v_accvgpr_read_b32 v80,a176
v_accvgpr_read_b32 v81,a177
v_accvgpr_read_b32 v82,a178
v_accvgpr_read_b32 v83,a179
v_accvgpr_read_b32 v84,a224
v_pk_mul_f32 v[80:81],v[80:81],v[66:67] op_sel_hi:[1,0]
v_pk_mul_f32 v[82:83],v[82:83],v[66:67] op_sel_hi:[1,0]
v_accvgpr_read_b32 v85,a225
v_pk_mul_f32 v[84:85],v[84:85],v[68:69] op_sel_hi:[1,0]
ds_write2st64_b64 v39,v[96:97],v[100:101] offset0:36 offset1:40
v_accvgpr_read_b32 v86,a226
v_accvgpr_read_b32 v87,a227
v_pk_mul_f32 v[86:87],v[86:87],v[68:69] op_sel_hi:[1,0]
v_accvgpr_read_b32 v94,a230
v_accvgpr_read_b32 v95,a231
v_mfma_f32_16x16x32_bf16 a[188:191],a[132:135],v[56:59],a[188:191]
ds_read_b128 v[104:107],v10 offset:18432
v_accvgpr_read_b32 v88,a180
ds_read_b128 v[108:111],v10 offset:19456
v_pk_mul_f32 v[90:91],v[90:91],v[66:67] op_sel_hi:[1,0]
ds_read_b128 v[72:75],v10 offset:20480
v_pk_mul_f32 v[94:95],v[94:95],v[68:69] op_sel_hi:[1,0]
ds_read_b128 v[76:79],v10 offset:21504
v_accvgpr_read_b32 v89,a181
v_pk_mul_f32 v[88:89],v[88:89],v[66:67] op_sel_hi:[1,0]
v_accvgpr_read_b32 v92,a228
v_accvgpr_read_b32 v93,a229
v_pk_mul_f32 v[92:93],v[92:93],v[68:69] op_sel_hi:[1,0]
v_cvt_pk_bf16_f32 v80,v80,v81
v_cvt_pk_bf16_f32 v84,v84,v85
v_mfma_f32_16x16x32_bf16 a[184:187],a[128:131],v[56:59],a[184:187]
v_cvt_pk_bf16_f32 v81,v82,v83
v_cvt_pk_bf16_f32 v85,v86,v87
v_mfma_f32_16x16x32_bf16 v[136:139],a[128:131],v[52:55],v[136:139]
ds_write2st64_b64 v36,v[80:81],v[84:85] offset0:36 offset1:40
v_mfma_f32_16x16x32_bf16 v[140:143],a[132:135],v[52:55],v[140:143]
v_accvgpr_read_b32 v102,a234
v_accvgpr_read_b32 v103,a235
v_mfma_f32_16x16x32_bf16 v[236:239],a[132:135],v[48:51],v[236:239]
s_waitcnt lgkmcnt(3)
buffer_store_dwordx4 v[104:107],v9,s[16:19],s87 offen offset:0 nt
v_accvgpr_read_b32 v100,a232
v_accvgpr_read_b32 v101,a233
v_accvgpr_read_b32 v96,a184
v_pk_mul_f32 v[102:103],v[102:103],v[68:69] op_sel_hi:[1,0]
v_pk_mul_f32 v[100:101],v[100:101],v[68:69] op_sel_hi:[1,0]
v_accvgpr_read_b32 v97,a185
v_pk_mul_f32 v[96:97],v[96:97],v[66:67] op_sel_hi:[1,0]
v_accvgpr_read_b32 v98,a186
v_accvgpr_read_b32 v99,a187
v_pk_mul_f32 v[98:99],v[98:99],v[66:67] op_sel_hi:[1,0]
v_accvgpr_read_b32 v82,a190
buffer_store_dwordx4 v[108:111],v9,s[16:19],s87 offen offset:3072 nt
v_accvgpr_read_b32 v83,a191
v_pk_mul_f32 v[82:83],v[82:83],v[66:67] op_sel_hi:[1,0]
v_accvgpr_read_b32 v86,a238
v_accvgpr_read_b32 v87,a239
v_pk_mul_f32 v[86:87],v[86:87],v[68:69] op_sel_hi:[1,0]
v_accvgpr_read_b32 v80,a188
v_accvgpr_read_b32 v81,a189
v_pk_mul_f32 v[80:81],v[80:81],v[66:67] op_sel_hi:[1,0]
v_accvgpr_read_b32 v84,a236
v_accvgpr_read_b32 v85,a237
v_pk_mul_f32 v[84:85],v[84:85],v[68:69] op_sel_hi:[1,0]
v_cvt_pk_bf16_f32 v88,v88,v89
v_cvt_pk_bf16_f32 v92,v92,v93
v_mfma_f32_16x16x32_bf16 v[232:235],a[128:131],v[48:51],v[232:235]
s_waitcnt lgkmcnt(0)
buffer_store_dwordx4 v[72:75],v9,s[16:19],s66 offen offset:0 nt
v_cvt_pk_bf16_f32 v100,v100,v101
v_cvt_pk_bf16_f32 v96,v96,v97
v_cvt_pk_bf16_f32 v89,v90,v91
v_mfma_f32_16x16x32_bf16 v[184:187],a[128:131],v[44:47],v[184:187]
v_cvt_pk_bf16_f32 v93,v94,v95
v_cvt_pk_bf16_f32 v80,v80,v81
v_mfma_f32_16x16x32_bf16 v[188:191],a[132:135],v[44:47],v[188:191]
v_cvt_pk_bf16_f32 v84,v84,v85
v_cvt_pk_bf16_f32 v101,v102,v103
v_mfma_f32_16x16x32_bf16 v[192:195],a[136:139],v[44:47],v[192:195]
ds_write2st64_b64 v37,v[88:89],v[92:93] offset0:36 offset1:40
v_mfma_f32_16x16x32_bf16 v[196:199],a[140:143],v[44:47],v[196:199]
v_cvt_pk_bf16_f32 v97,v98,v99
v_cvt_pk_bf16_f32 v81,v82,v83
v_mfma_f32_16x16x32_bf16 v[244:247],a[140:143],v[48:51],v[244:247]
buffer_store_dwordx4 v[76:79],v9,s[16:19],s66 offen offset:3072 nt
v_cvt_pk_bf16_f32 v85,v86,v87
v_rcp_f32 v62,v62
v_mfma_f32_16x16x32_bf16 v[240:243],a[136:139],v[48:51],v[240:243]
v_rcp_f32 v64,v64
v_mfma_f32_16x16x32_bf16 v[144:147],a[136:139],v[52:55],v[144:147]
v_add_f32 v60,v60,v61
v_rcp_f32 v60,v60
v_mfma_f32_16x16x32_bf16 v[148:151],a[140:143],v[52:55],v[148:151]
ds_write2st64_b64 v38,v[96:97],v[100:101] offset0:36 offset1:40
v_mfma_f32_16x16x32_bf16 a[196:199],a[140:143],v[56:59],a[196:199]
v_min3_f32 v61,v60,v62,v64
v_min3_f32 v61,v61,v66,v68
v_mfma_f32_16x16x32_bf16 a[192:195],a[136:139],v[56:59],a[192:195]
v_cmp_nlt_f32 vcc,s37,v61
v_mfma_f32_16x16x32_bf16 a[240:243],a[136:139],v[40:43],a[240:243]
v_mfma_f32_16x16x32_bf16 a[244:247],a[140:143],v[40:43],a[244:247]
ds_write2st64_b64 v39,v[80:81],v[84:85] offset0:36 offset1:40
v_mfma_f32_16x16x32_bf16 a[248:251],a[144:147],v[40:43],a[248:251]
s_cmp_lg_u64 vcc,0
v_accvgpr_read_b32 v96,a196
v_accvgpr_read_b32 v97,a197
v_mfma_f32_16x16x32_bf16 a[252:255],a[148:151],v[40:43],a[252:255]
s_cselect_b32 s62,s32,0
ds_read_b128 v[72:75],v10 offset:18432
v_accvgpr_read_b32 v104,a192
ds_read_b128 v[76:79],v10 offset:19456
v_accvgpr_read_b32 v105,a193
ds_read_b128 v[88:91],v10 offset:20480
v_pk_mul_f32 v[104:105],v[104:105],v[66:67] op_sel_hi:[1,0]
ds_read_b128 v[92:95],v10 offset:21504
v_accvgpr_read_b32 v106,a194
v_accvgpr_read_b32 v107,a195
v_pk_mul_f32 v[106:107],v[106:107],v[66:67] op_sel_hi:[1,0]
v_accvgpr_read_b32 v108,a240
v_accvgpr_read_b32 v109,a241
v_pk_mul_f32 v[108:109],v[108:109],v[68:69] op_sel_hi:[1,0]
v_accvgpr_read_b32 v110,a242
v_accvgpr_read_b32 v111,a243
v_pk_mul_f32 v[110:111],v[110:111],v[68:69] op_sel_hi:[1,0]
v_accvgpr_read_b32 v98,a198
v_accvgpr_read_b32 v99,a199
v_mfma_f32_16x16x32_bf16 a[204:207],a[148:151],v[56:59],a[204:207]
s_or_b32 s31,s31,s62
v_accvgpr_read_b32 v100,a244
v_accvgpr_read_b32 v101,a245
s_waitcnt lgkmcnt(3)
buffer_store_dwordx4 v[72:75],v9,s[16:19],s87 offen offset:128 nt
v_pk_mul_f32 v[96:97],v[96:97],v[66:67] op_sel_hi:[1,0]
v_pk_mul_f32 v[98:99],v[98:99],v[66:67] op_sel_hi:[1,0]
v_pk_mul_f32 v[100:101],v[100:101],v[68:69] op_sel_hi:[1,0]
v_accvgpr_read_b32 v102,a246
v_accvgpr_read_b32 v103,a247
v_pk_mul_f32 v[102:103],v[102:103],v[68:69] op_sel_hi:[1,0]
v_cvt_pk_bf16_f32 v104,v104,v105
v_cvt_pk_bf16_f32 v108,v108,v109
v_mfma_f32_16x16x32_bf16 a[200:203],a[144:147],v[56:59],a[200:203]
s_lshl_b32 s32,s32,1
v_cvt_pk_bf16_f32 v105,v106,v107
v_cvt_pk_bf16_f32 v109,v110,v111
v_mfma_f32_16x16x32_bf16 v[152:155],a[144:147],v[52:55],v[152:155]
ds_write2st64_b64 v36,v[104:105],v[108:109] offset0:36 offset1:40
v_mfma_f32_16x16x32_bf16 v[156:159],a[148:151],v[52:55],v[156:159]
v_add_u32 v36,v36,v19
v_accvgpr_read_b32 v84,a248
v_mfma_f32_16x16x32_bf16 v[252:255],a[148:151],v[48:51],v[252:255]
s_waitcnt lgkmcnt(1)
buffer_store_dwordx4 v[76:79],v9,s[16:19],s87 offen offset:3200 nt
v_accvgpr_read_b32 v85,a249
v_accvgpr_read_b32 v80,a200
v_accvgpr_read_b32 v81,a201
v_pk_mul_f32 v[84:85],v[84:85],v[68:69] op_sel_hi:[1,0]
v_pk_mul_f32 v[80:81],v[80:81],v[66:67] op_sel_hi:[1,0]
v_pk_mul_f32 v[208:209],v[208:209],v[62:63] op_sel_hi:[1,0]
v_pk_mul_f32 v[210:211],v[210:211],v[62:63] op_sel_hi:[1,0]
v_pk_mul_f32 v[224:225],v[224:225],v[62:63] op_sel_hi:[1,0]
v_pk_mul_f32 v[226:227],v[226:227],v[62:63] op_sel_hi:[1,0]
v_pk_mul_f32 v[212:213],v[212:213],v[62:63] op_sel_hi:[1,0]
v_pk_mul_f32 v[214:215],v[214:215],v[62:63] op_sel_hi:[1,0]
buffer_store_dwordx4 v[88:91],v9,s[16:19],s66 offen offset:128 nt
v_pk_mul_f32 v[228:229],v[228:229],v[62:63] op_sel_hi:[1,0]
v_pk_mul_f32 v[230:231],v[230:231],v[62:63] op_sel_hi:[1,0]
v_pk_mul_f32 v[216:217],v[216:217],v[62:63] op_sel_hi:[1,0]
v_pk_mul_f32 v[218:219],v[218:219],v[62:63] op_sel_hi:[1,0]
v_pk_mul_f32 v[232:233],v[232:233],v[62:63] op_sel_hi:[1,0]
v_pk_mul_f32 v[234:235],v[234:235],v[62:63] op_sel_hi:[1,0]
v_pk_mul_f32 v[220:221],v[220:221],v[62:63] op_sel_hi:[1,0]
v_pk_mul_f32 v[222:223],v[222:223],v[62:63] op_sel_hi:[1,0]
v_pk_mul_f32 v[236:237],v[236:237],v[62:63] op_sel_hi:[1,0]
v_pk_mul_f32 v[238:239],v[238:239],v[62:63] op_sel_hi:[1,0]
v_pk_mul_f32 v[240:241],v[240:241],v[62:63] op_sel_hi:[1,0]
buffer_store_dwordx4 v[92:95],v9,s[16:19],s66 offen offset:3200 nt
v_pk_mul_f32 v[242:243],v[242:243],v[62:63] op_sel_hi:[1,0]
v_pk_mul_f32 v[112:113],v[112:113],v[64:65] op_sel_hi:[1,0]
v_pk_mul_f32 v[114:115],v[114:115],v[64:65] op_sel_hi:[1,0]
v_pk_mul_f32 v[244:245],v[244:245],v[62:63] op_sel_hi:[1,0]
v_pk_mul_f32 v[246:247],v[246:247],v[62:63] op_sel_hi:[1,0]
v_pk_mul_f32 v[116:117],v[116:117],v[64:65] op_sel_hi:[1,0]
v_pk_mul_f32 v[118:119],v[118:119],v[64:65] op_sel_hi:[1,0]
v_accvgpr_read_b32 v86,a250
v_accvgpr_read_b32 v87,a251
v_pk_mul_f32 v[86:87],v[86:87],v[68:69] op_sel_hi:[1,0]
v_cvt_pk_bf16_f32 v96,v96,v97
v_cvt_pk_bf16_f32 v100,v100,v101
v_accvgpr_read_b32 v82,a202
v_accvgpr_read_b32 v83,a203
v_pk_mul_f32 v[82:83],v[82:83],v[66:67] op_sel_hi:[1,0]
v_accvgpr_read_b32 v104,a204
v_accvgpr_read_b32 v105,a205
v_pk_mul_f32 v[104:105],v[104:105],v[66:67] op_sel_hi:[1,0]
v_accvgpr_read_b32 v108,a252
v_accvgpr_read_b32 v109,a253
v_pk_mul_f32 v[108:109],v[108:109],v[68:69] op_sel_hi:[1,0]
v_accvgpr_read_b32 v106,a206
v_accvgpr_read_b32 v107,a207
v_pk_mul_f32 v[106:107],v[106:107],v[66:67] op_sel_hi:[1,0]
v_accvgpr_read_b32 v110,a254
v_accvgpr_read_b32 v111,a255
v_pk_mul_f32 v[110:111],v[110:111],v[68:69] op_sel_hi:[1,0]
v_cvt_pk_bf16_f32 v84,v84,v85
v_cvt_pk_bf16_f32 v80,v80,v81
v_mfma_f32_16x16x32_bf16 v[248:251],a[144:147],v[48:51],v[248:251]
v_cvt_pk_bf16_f32 v97,v98,v99
v_cvt_pk_bf16_f32 v101,v102,v103
v_mfma_f32_16x16x32_bf16 v[200:203],a[144:147],v[44:47],v[200:203]
ds_write2st64_b64 v37,v[96:97],v[100:101] offset0:36 offset1:40
v_mfma_f32_16x16x32_bf16 v[204:207],a[148:151],v[44:47],v[204:207]
v_add_u32 v37,v37,v19
v_cvt_pk_bf16_f32 v104,v104,v105
v_cvt_pk_bf16_f32 v108,v108,v109
v_cvt_pk_bf16_f32 v85,v86,v87
v_cvt_pk_bf16_f32 v81,v82,v83
v_pk_mul_f32 v[248:249],v[248:249],v[62:63] op_sel_hi:[1,0]
v_pk_mul_f32 v[120:121],v[120:121],v[64:65] op_sel_hi:[1,0]
v_pk_mul_f32 v[250:251],v[250:251],v[62:63] op_sel_hi:[1,0]
v_pk_mul_f32 v[122:123],v[122:123],v[64:65] op_sel_hi:[1,0]
ds_write2st64_b64 v38,v[80:81],v[84:85] offset0:36 offset1:40
v_pk_mul_f32 v[252:253],v[252:253],v[62:63] op_sel_hi:[1,0]
v_pk_mul_f32 v[124:125],v[124:125],v[64:65] op_sel_hi:[1,0]
v_pk_mul_f32 v[254:255],v[254:255],v[62:63] op_sel_hi:[1,0]
v_pk_mul_f32 v[126:127],v[126:127],v[64:65] op_sel_hi:[1,0]
v_pk_mul_f32 v[128:129],v[128:129],v[64:65] op_sel_hi:[1,0]
v_pk_mul_f32 v[144:145],v[144:145],v[64:65] op_sel_hi:[1,0]
v_pk_mul_f32 v[130:131],v[130:131],v[64:65] op_sel_hi:[1,0]
v_pk_mul_f32 v[146:147],v[146:147],v[64:65] op_sel_hi:[1,0]
v_pk_mul_f32 v[132:133],v[132:133],v[64:65] op_sel_hi:[1,0]
v_pk_mul_f32 v[148:149],v[148:149],v[64:65] op_sel_hi:[1,0]
v_pk_mul_f32 v[134:135],v[134:135],v[64:65] op_sel_hi:[1,0]
v_pk_mul_f32 v[150:151],v[150:151],v[64:65] op_sel_hi:[1,0]
v_pk_mul_f32 v[136:137],v[136:137],v[64:65] op_sel_hi:[1,0]
v_pk_mul_f32 v[152:153],v[152:153],v[64:65] op_sel_hi:[1,0]
v_pk_mul_f32 v[138:139],v[138:139],v[64:65] op_sel_hi:[1,0]
v_pk_mul_f32 v[154:155],v[154:155],v[64:65] op_sel_hi:[1,0]
v_pk_mul_f32 v[140:141],v[140:141],v[64:65] op_sel_hi:[1,0]
v_pk_mul_f32 v[156:157],v[156:157],v[64:65] op_sel_hi:[1,0]
v_pk_mul_f32 v[142:143],v[142:143],v[64:65] op_sel_hi:[1,0]
v_pk_mul_f32 v[158:159],v[158:159],v[64:65] op_sel_hi:[1,0]
v_pk_mul_f32 v[160:161],v[160:161],v[60:61] op_sel_hi:[1,0]
v_pk_mul_f32 v[176:177],v[176:177],v[60:61] op_sel_hi:[1,0]
v_pk_mul_f32 v[162:163],v[162:163],v[60:61] op_sel_hi:[1,0]
v_pk_mul_f32 v[178:179],v[178:179],v[60:61] op_sel_hi:[1,0]
v_pk_mul_f32 v[164:165],v[164:165],v[60:61] op_sel_hi:[1,0]
v_pk_mul_f32 v[180:181],v[180:181],v[60:61] op_sel_hi:[1,0]
v_pk_mul_f32 v[166:167],v[166:167],v[60:61] op_sel_hi:[1,0]
v_pk_mul_f32 v[182:183],v[182:183],v[60:61] op_sel_hi:[1,0]
v_pk_mul_f32 v[168:169],v[168:169],v[60:61] op_sel_hi:[1,0]
v_pk_mul_f32 v[184:185],v[184:185],v[60:61] op_sel_hi:[1,0]
v_pk_mul_f32 v[170:171],v[170:171],v[60:61] op_sel_hi:[1,0]
v_pk_mul_f32 v[186:187],v[186:187],v[60:61] op_sel_hi:[1,0]
v_pk_mul_f32 v[172:173],v[172:173],v[60:61] op_sel_hi:[1,0]
v_pk_mul_f32 v[188:189],v[188:189],v[60:61] op_sel_hi:[1,0]
v_pk_mul_f32 v[174:175],v[174:175],v[60:61] op_sel_hi:[1,0]
v_pk_mul_f32 v[190:191],v[190:191],v[60:61] op_sel_hi:[1,0]
v_pk_mul_f32 v[192:193],v[192:193],v[60:61] op_sel_hi:[1,0]
v_pk_mul_f32 v[194:195],v[194:195],v[60:61] op_sel_hi:[1,0]
v_pk_mul_f32 v[196:197],v[196:197],v[60:61] op_sel_hi:[1,0]
v_pk_mul_f32 v[198:199],v[198:199],v[60:61] op_sel_hi:[1,0]
v_pk_mul_f32 v[200:201],v[200:201],v[60:61] op_sel_hi:[1,0]
v_pk_mul_f32 v[202:203],v[202:203],v[60:61] op_sel_hi:[1,0]
v_pk_mul_f32 v[204:205],v[204:205],v[60:61] op_sel_hi:[1,0]
v_pk_mul_f32 v[206:207],v[206:207],v[60:61] op_sel_hi:[1,0]
v_add_u32 v38,v38,v19
v_cvt_pk_bf16_f32 v105,v106,v107
v_cvt_pk_bf16_f32 v109,v110,v111
ds_write2st64_b64 v39,v[104:105],v[108:109] offset0:36 offset1:40
v_add_u32 v39,v39,v19
v_cvt_pk_bf16_f32 v208,v208,v209
v_cvt_pk_bf16_f32 v224,v224,v225
ds_read_b128 v[72:75],v10 offset:18432
v_cvt_pk_bf16_f32 v212,v212,v213
ds_read_b128 v[76:79],v10 offset:19456
v_cvt_pk_bf16_f32 v228,v228,v229
ds_read_b128 v[88:91],v10 offset:20480
v_cvt_pk_bf16_f32 v209,v210,v211
ds_read_b128 v[92:95],v10 offset:21504
v_cvt_pk_bf16_f32 v225,v226,v227
ds_write2st64_b64 v36,v[208:209],v[224:225] offset0:12 offset1:14
v_cvt_pk_bf16_f32 v216,v216,v217
v_cvt_pk_bf16_f32 v232,v232,v233
v_cvt_pk_bf16_f32 v213,v214,v215
v_cvt_pk_bf16_f32 v229,v230,v231
v_cvt_pk_bf16_f32 v220,v220,v221
v_cvt_pk_bf16_f32 v236,v236,v237
v_cvt_pk_bf16_f32 v217,v218,v219
s_waitcnt lgkmcnt(4)
buffer_store_dwordx4 v[72:75],v9,s[16:19],s87 offen offset:256 nt
v_cvt_pk_bf16_f32 v233,v234,v235
v_cvt_pk_bf16_f32 v221,v222,v223
v_cvt_pk_bf16_f32 v237,v238,v239
v_cvt_pk_bf16_f32 v240,v240,v241
v_cvt_pk_bf16_f32 v112,v112,v113
v_cvt_pk_bf16_f32 v244,v244,v245
v_cvt_pk_bf16_f32 v116,v116,v117
v_cvt_pk_bf16_f32 v241,v242,v243
v_cvt_pk_bf16_f32 v113,v114,v115
ds_write2st64_b64 v37,v[212:213],v[228:229] offset0:12 offset1:14
v_cvt_pk_bf16_f32 v248,v248,v249
v_cvt_pk_bf16_f32 v120,v120,v121
v_cvt_pk_bf16_f32 v245,v246,v247
s_waitcnt lgkmcnt(1)
buffer_store_dwordx4 v[76:79],v9,s[16:19],s87 offen offset:3328 nt
v_cvt_pk_bf16_f32 v117,v118,v119
v_cvt_pk_bf16_f32 v252,v252,v253
v_cvt_pk_bf16_f32 v124,v124,v125
v_cvt_pk_bf16_f32 v249,v250,v251
v_cvt_pk_bf16_f32 v121,v122,v123
v_cvt_pk_bf16_f32 v253,v254,v255
v_cvt_pk_bf16_f32 v125,v126,v127
v_cvt_pk_bf16_f32 v128,v128,v129
v_cvt_pk_bf16_f32 v144,v144,v145
ds_write2st64_b64 v38,v[216:217],v[232:233] offset0:12 offset1:14
v_cvt_pk_bf16_f32 v132,v132,v133
v_cvt_pk_bf16_f32 v148,v148,v149
v_cvt_pk_bf16_f32 v129,v130,v131
buffer_store_dwordx4 v[88:91],v9,s[16:19],s66 offen offset:256 nt
v_cvt_pk_bf16_f32 v145,v146,v147
v_cvt_pk_bf16_f32 v136,v136,v137
v_cvt_pk_bf16_f32 v152,v152,v153
v_cvt_pk_bf16_f32 v133,v134,v135
v_cvt_pk_bf16_f32 v149,v150,v151
v_cvt_pk_bf16_f32 v140,v140,v141
v_cvt_pk_bf16_f32 v156,v156,v157
v_cvt_pk_bf16_f32 v137,v138,v139
v_cvt_pk_bf16_f32 v153,v154,v155
ds_write2st64_b64 v39,v[220:221],v[236:237] offset0:12 offset1:14
v_cvt_pk_bf16_f32 v141,v142,v143
v_cvt_pk_bf16_f32 v157,v158,v159
v_cvt_pk_bf16_f32 v160,v160,v161
ds_read_b128 v[96:99],v10 offset:6144
buffer_store_dwordx4 v[92:95],v9,s[16:19],s66 offen offset:3328 nt
ds_read_b128 v[100:103],v10 offset:9216
v_cvt_pk_bf16_f32 v176,v176,v177
ds_read_b128 v[80:83],v10 offset:7168
v_cvt_pk_bf16_f32 v164,v164,v165
ds_read_b128 v[84:87],v10 offset:10240
v_cvt_pk_bf16_f32 v180,v180,v181
ds_write2st64_b64 v36,v[240:241],v[112:113] offset0:16 offset1:24
v_cvt_pk_bf16_f32 v161,v162,v163
v_cvt_pk_bf16_f32 v177,v178,v179
v_cvt_pk_bf16_f32 v168,v168,v169
v_cvt_pk_bf16_f32 v184,v184,v185
v_cvt_pk_bf16_f32 v165,v166,v167
v_cvt_pk_bf16_f32 v181,v182,v183
v_cvt_pk_bf16_f32 v172,v172,v173
s_waitcnt lgkmcnt(4)
buffer_store_dwordx4 v[96:99],v9,s[16:19],s85 offen offset:0 nt
v_cvt_pk_bf16_f32 v188,v188,v189
v_cvt_pk_bf16_f32 v169,v170,v171
v_cvt_pk_bf16_f32 v185,v186,v187
v_cvt_pk_bf16_f32 v173,v174,v175
v_cvt_pk_bf16_f32 v189,v190,v191
v_cvt_pk_bf16_f32 v192,v192,v193
v_cvt_pk_bf16_f32 v196,v196,v197
v_cvt_pk_bf16_f32 v193,v194,v195
v_cvt_pk_bf16_f32 v200,v200,v201
ds_write2st64_b64 v37,v[244:245],v[116:117] offset0:16 offset1:24
v_cvt_pk_bf16_f32 v197,v198,v199
v_cvt_pk_bf16_f32 v204,v204,v205
v_cvt_pk_bf16_f32 v201,v202,v203
s_waitcnt lgkmcnt(1)
buffer_store_dwordx4 v[100:103],v9,s[16:19],s85 offen offset:3072 nt
v_cvt_pk_bf16_f32 v205,v206,v207
ds_write2st64_b64 v38,v[248:249],v[120:121] offset0:16 offset1:24
buffer_store_dwordx4 v[80:83],v9,s[16:19],s85 offen offset:128 nt
ds_write2st64_b64 v39,v[252:253],v[124:125] offset0:16 offset1:24
ds_read_b128 v[104:107],v10 offset:8192
buffer_store_dwordx4 v[84:87],v9,s[16:19],s85 offen offset:3200 nt
ds_read_b128 v[108:111],v10 offset:11264
ds_read_b128 v[208:211],v10 offset:12288
ds_read_b128 v[224:227],v10 offset:15360
ds_write2st64_b64 v36,v[128:129],v[144:145] offset0:26 offset1:28
s_waitcnt lgkmcnt(4)
buffer_store_dwordx4 v[104:107],v9,s[16:19],s85 offen offset:256 nt
ds_write2st64_b64 v37,v[132:133],v[148:149] offset0:26 offset1:28
s_waitcnt lgkmcnt(1)
buffer_store_dwordx4 v[108:111],v9,s[16:19],s85 offen offset:3328 nt
ds_write2st64_b64 v38,v[136:137],v[152:153] offset0:26 offset1:28
buffer_store_dwordx4 v[208:211],v9,s[16:19],s86 offen offset:0 nt
ds_write2st64_b64 v39,v[140:141],v[156:157] offset0:26 offset1:28
ds_read_b128 v[72:75],v10 offset:13312
buffer_store_dwordx4 v[224:227],v9,s[16:19],s86 offen offset:3072 nt
ds_read_b128 v[76:79],v10 offset:16384
ds_read_b128 v[88:91],v10 offset:14336
ds_read_b128 v[92:95],v10 offset:17408
ds_write2st64_b64 v36,v[160:161],v[176:177] offset0:0 offset1:2
s_waitcnt lgkmcnt(4)
buffer_store_dwordx4 v[72:75],v9,s[16:19],s86 offen offset:128 nt
ds_write2st64_b64 v37,v[164:165],v[180:181] offset0:0 offset1:2
s_waitcnt lgkmcnt(1)
buffer_store_dwordx4 v[76:79],v9,s[16:19],s86 offen offset:3200 nt
ds_write2st64_b64 v38,v[168:169],v[184:185] offset0:0 offset1:2
buffer_store_dwordx4 v[88:91],v9,s[16:19],s86 offen offset:256 nt
ds_write2st64_b64 v39,v[172:173],v[188:189] offset0:0 offset1:2
ds_read_b128 v[212:215],v10 offset:0
buffer_store_dwordx4 v[92:95],v9,s[16:19],s86 offen offset:3328 nt
ds_read_b128 v[228:231],v10 offset:3072
ds_read_b128 v[216:219],v10 offset:1024
ds_read_b128 v[232:235],v10 offset:4096
ds_write_b64 v36,v[192:193] offset:2048
ds_write_b64 v37,v[196:197] offset:2048
s_waitcnt lgkmcnt(5)
buffer_store_dwordx4 v[212:215],v9,s[16:19],s84 offen offset:0 nt
ds_write_b64 v38,v[200:201] offset:2048
s_waitcnt lgkmcnt(2)
buffer_store_dwordx4 v[228:231],v9,s[16:19],s84 offen offset:3072 nt
ds_write_b64 v39,v[204:205] offset:2048
ds_read_b128 v[220:223],v10 offset:2048
buffer_store_dwordx4 v[216:219],v9,s[16:19],s84 offen offset:128 nt
ds_read_b128 v[236:239],v10 offset:5120
buffer_store_dwordx4 v[232:235],v9,s[16:19],s84 offen offset:3200 nt
s_waitcnt lgkmcnt(1)
buffer_store_dwordx4 v[220:223],v9,s[16:19],s84 offen offset:256 nt
s_waitcnt lgkmcnt(0)
buffer_store_dwordx4 v[236:239],v9,s[16:19],s84 offen offset:3328 nt
s_branch L_fin
L_end4:
s_waitcnt lgkmcnt(3)
v_mfma_f32_16x16x32_bf16 v[160:163],a[120:123],v[20:23],v[160:163]
ds_read_b64_tr_b16 a[136:137],v2 offset:24704
v_fma_f32 v102,v102,s36,v16
v_mfma_f32_16x16x32_bf16 v[164:167],a[124:127],v[20:23],v[164:167]
ds_read_b64_tr_b16 a[138:139],v2 offset:30848
v_fma_f32 v98,v98,s36,v16
v_mfma_f32_16x16x32_bf16 v[212:215],a[124:127],v[24:27],v[212:215]
ds_read_b64_tr_b16 a[140:141],v3 offset:24704
v_fma_f32 v76,v76,s36,v13
v_mfma_f32_16x16x32_bf16 v[208:211],a[120:123],v[24:27],v[208:211]
ds_read_b64_tr_b16 a[142:143],v3 offset:30848
v_fma_f32 v91,v91,s36,v15
v_mfma_f32_16x16x32_bf16 v[112:115],a[120:123],v[28:31],v[112:115]
ds_read_b64_tr_b16 a[144:145],v4 offset:24704
v_fma_f32 v95,v95,s36,v15
v_mfma_f32_16x16x32_bf16 v[116:119],a[124:127],v[28:31],v[116:119]
ds_read_b64_tr_b16 a[146:147],v4 offset:30848
v_fma_f32 v85,v85,s36,v14
v_mfma_f32_16x16x32_bf16 a[164:167],a[124:127],v[32:35],a[164:167]
ds_read_b64_tr_b16 a[148:149],v5 offset:24704
v_exp_f32 v76,v76
v_mfma_f32_16x16x32_bf16 a[160:163],a[120:123],v[32:35],a[160:163]
s_waitcnt lgkmcnt(6)
ds_read_b64_tr_b16 a[150:151],v5 offset:30848
v_fma_f32 v103,v103,s36,v16
v_mfma_f32_16x16x32_bf16 a[168:171],a[128:131],v[32:35],a[168:171]
ds_read_b64_tr_b16 a[120:121],v2 offset:24832
v_fma_f32 v79,v79,s36,v13
v_mfma_f32_16x16x32_bf16 a[172:175],a[132:135],v[32:35],a[172:175]
ds_read_b64_tr_b16 a[122:123],v2 offset:30976
v_fma_f32 v96,v96,s36,v16
v_mfma_f32_16x16x32_bf16 v[124:127],a[132:135],v[28:31],v[124:127]
ds_read_b64_tr_b16 a[124:125],v3 offset:24832
v_exp_f32 v102,v102
v_mfma_f32_16x16x32_bf16 v[120:123],a[128:131],v[28:31],v[120:123]
ds_read_b64_tr_b16 a[126:127],v3 offset:30976
v_fma_f32 v89,v89,s36,v15
v_mfma_f32_16x16x32_bf16 v[216:219],a[128:131],v[24:27],v[216:219]
v_fma_f32 v86,v86,s36,v14
v_fma_f32 v100,v100,s36,v16
v_mfma_f32_16x16x32_bf16 v[220:223],a[132:135],v[24:27],v[220:223]
v_exp_f32 v100,v100
v_mfma_f32_16x16x32_bf16 v[172:175],a[132:135],v[20:23],v[172:175]
ds_read_b64_tr_b16 a[132:133],v5 offset:24832
v_fma_f32 v84,v84,s36,v14
v_mfma_f32_16x16x32_bf16 v[168:171],a[128:131],v[20:23],v[168:171]
s_waitcnt lgkmcnt(4)
ds_read_b64_tr_b16 a[128:129],v4 offset:24832
v_exp_f32 v98,v98
v_mfma_f32_16x16x32_bf16 v[176:179],a[136:139],v[20:23],v[176:179]
ds_read_b64_tr_b16 a[130:131],v4 offset:30976
v_exp_f32 v79,v79
v_mfma_f32_16x16x32_bf16 v[180:183],a[140:143],v[20:23],v[180:183]
ds_read_b64_tr_b16 a[134:135],v5 offset:30976
v_exp_f32 v89,v89
v_mfma_f32_16x16x32_bf16 v[228:231],a[140:143],v[24:27],v[228:231]
v_fma_f32 v82,v82,s36,v14
v_exp_f32 v82,v82
v_mfma_f32_16x16x32_bf16 v[224:227],a[136:139],v[24:27],v[224:227]
v_fma_f32 v77,v77,s36,v13
v_exp_f32 v77,v77
v_mfma_f32_16x16x32_bf16 v[128:131],a[136:139],v[28:31],v[128:131]
v_fma_f32 v87,v87,s36,v14
v_exp_f32 v87,v87
v_mfma_f32_16x16x32_bf16 v[132:135],a[140:143],v[28:31],v[132:135]
v_exp_f32 v96,v96
v_mfma_f32_16x16x32_bf16 a[180:183],a[140:143],v[32:35],a[180:183]
v_fma_f32 v78,v78,s36,v13
v_fma_f32 v83,v83,s36,v14
v_mfma_f32_16x16x32_bf16 a[176:179],a[136:139],v[32:35],a[176:179]
v_fma_f32 v92,v92,s36,v15
v_exp_f32 v92,v92
v_mfma_f32_16x16x32_bf16 a[184:187],a[144:147],v[32:35],a[184:187]
v_fma_f32 v90,v90,s36,v15
v_exp_f32 v90,v90
v_mfma_f32_16x16x32_bf16 a[188:191],a[148:151],v[32:35],a[188:191]
v_fma_f32 v101,v101,s36,v16
v_exp_f32 v101,v101
v_mfma_f32_16x16x32_bf16 v[140:143],a[148:151],v[28:31],v[140:143]
v_fma_f32 v99,v99,s36,v16
v_exp_f32 v99,v99
v_mfma_f32_16x16x32_bf16 v[136:139],a[144:147],v[28:31],v[136:139]
v_exp_f32 v84,v84
v_mfma_f32_16x16x32_bf16 v[232:235],a[144:147],v[24:27],v[232:235]
v_fma_f32 v94,v94,s36,v15
v_fma_f32 v88,v88,s36,v15
v_mfma_f32_16x16x32_bf16 v[236:239],a[148:151],v[24:27],v[236:239]
v_fma_f32 v97,v97,s36,v16
v_exp_f32 v97,v97
v_mfma_f32_16x16x32_bf16 v[188:191],a[148:151],v[20:23],v[188:191]
v_fma_f32 v93,v93,s36,v15
v_exp_f32 v93,v93
v_mfma_f32_16x16x32_bf16 v[184:187],a[144:147],v[20:23],v[184:187]
s_waitcnt lgkmcnt(0)
v_exp_f32 v94,v94
v_mfma_f32_16x16x32_bf16 v[192:195],a[120:123],v[20:23],v[192:195]
v_exp_f32 v83,v83
v_mfma_f32_16x16x32_bf16 v[196:199],a[124:127],v[20:23],v[196:199]
v_exp_f32 v103,v103
v_mfma_f32_16x16x32_bf16 v[244:247],a[124:127],v[24:27],v[244:247]
v_exp_f32 v78,v78
v_mfma_f32_16x16x32_bf16 v[240:243],a[120:123],v[24:27],v[240:243]
v_exp_f32 v95,v95
v_mfma_f32_16x16x32_bf16 v[144:147],a[120:123],v[28:31],v[144:147]
v_cvt_pk_bf16_f32 v55,v94,v95
s_waitcnt vmcnt(14)
s_barrier
v_mfma_f32_16x16x32_bf16 v[148:151],a[124:127],v[28:31],v[148:151]
v_exp_f32 v91,v91
v_mfma_f32_16x16x32_bf16 a[196:199],a[124:127],v[32:35],a[196:199]
v_exp_f32 v85,v85
v_mfma_f32_16x16x32_bf16 a[192:195],a[120:123],v[32:35],a[192:195]
v_exp_f32 v88,v88
v_mfma_f32_16x16x32_bf16 a[200:203],a[128:131],v[32:35],a[200:203]
v_cvt_pk_bf16_f32 v52,v88,v89
v_exp_f32 v86,v86
v_mfma_f32_16x16x32_bf16 a[204:207],a[132:135],v[32:35],a[204:207]
v_cvt_pk_bf16_f32 v46,v76,v77
v_cvt_pk_bf16_f32 v49,v82,v83
v_mfma_f32_16x16x32_bf16 v[156:159],a[132:135],v[28:31],v[156:159]
v_cvt_pk_bf16_f32 v57,v98,v99
v_cvt_pk_bf16_f32 v47,v78,v79
v_mfma_f32_16x16x32_bf16 v[152:155],a[128:131],v[28:31],v[152:155]
v_cvt_pk_bf16_f32 v58,v100,v101
v_cvt_pk_bf16_f32 v59,v102,v103
v_mfma_f32_16x16x32_bf16 v[248:251],a[128:131],v[24:27],v[248:251]
v_cvt_pk_bf16_f32 v54,v92,v93
v_cvt_pk_bf16_f32 v50,v84,v85
v_mfma_f32_16x16x32_bf16 v[252:255],a[132:135],v[24:27],v[252:255]
v_cvt_pk_bf16_f32 v53,v90,v91
v_cvt_pk_bf16_f32 v51,v86,v87
v_mfma_f32_16x16x32_bf16 v[204:207],a[132:135],v[20:23],v[204:207]
v_cvt_pk_bf16_f32 v56,v96,v97
v_subrev_u32 v10,18432,v10
v_smfmac_f32_16x16x64_bf16 v[60:63],a[152:155],v[44:51],v18
ds_read_b64_tr_b16 a[138:139],v2 offset:6144
v_smfmac_f32_16x16x64_bf16 v[64:67],a[152:155],v[52:59],v18
ds_read_b64_tr_b16 a[136:137],v2 offset:0
v_mfma_f32_16x16x32_bf16 v[200:203],a[128:131],v[20:23],v[200:203]
ds_read_b64_tr_b16 a[142:143],v3 offset:6144
ds_read_b64_tr_b16 a[140:141],v3 offset:0
ds_read_b64_tr_b16 a[146:147],v4 offset:6144
ds_read_b64_tr_b16 a[144:145],v4 offset:0
ds_read_b64_tr_b16 a[150:151],v5 offset:6144
ds_read_b64_tr_b16 a[148:149],v5 offset:0
s_waitcnt lgkmcnt(6)
v_mfma_f32_16x16x32_bf16 v[160:163],a[136:139],v[44:47],v[160:163]
s_waitcnt vmcnt(6)
ds_read_b64_tr_b16 a[122:123],v2 offset:6272
v_mbcnt_lo_u32_b32 v39,-1,0
s_waitcnt lgkmcnt(5)
v_mfma_f32_16x16x32_bf16 v[164:167],a[140:143],v[44:47],v[164:167]
s_add_u32 s84,s42,0
ds_read_b64_tr_b16 a[120:121],v2 offset:128
v_mbcnt_hi_u32_b32 v39,-1,v39
v_mfma_f32_16x16x32_bf16 v[212:215],a[140:143],v[48:51],v[212:215]
s_add_u32 s85,s42,6144
ds_read_b64_tr_b16 a[124:125],v3 offset:128
v_and_b32 v38,7,v39
v_mfma_f32_16x16x32_bf16 v[208:211],a[136:139],v[48:51],v[208:211]
s_add_u32 s86,s42,12288
ds_read_b64_tr_b16 a[126:127],v3 offset:6272
v_lshrrev_b32 v19,5,v39
v_mfma_f32_16x16x32_bf16 v[112:115],a[136:139],v[52:55],v[112:115]
s_add_u32 s87,s42,18432
ds_read_b64_tr_b16 a[128:129],v4 offset:128
v_xor_b32 v38,v38,v19
v_mfma_f32_16x16x32_bf16 v[116:119],a[140:143],v[52:55],v[116:119]
ds_read_b64_tr_b16 a[130:131],v4 offset:6272
v_and_b32 v19,15,v39
v_mfma_f32_16x16x32_bf16 a[164:167],a[140:143],v[56:59],a[164:167]
ds_read_b64_tr_b16 a[134:135],v5 offset:6272
v_lshl_add_u32 v19,v19,7,s24
v_mfma_f32_16x16x32_bf16 a[160:163],a[136:139],v[56:59],a[160:163]
s_waitcnt lgkmcnt(6)
ds_read_b64_tr_b16 a[132:133],v5 offset:128
v_lshl_add_u32 v19,v38,4,v19
v_mfma_f32_16x16x32_bf16 a[168:171],a[144:147],v[56:59],a[168:171]
ds_read_b64_tr_b16 a[136:137],v2 offset:256
v_bfe_u32 v38,v39,4,1
v_mfma_f32_16x16x32_bf16 a[172:175],a[148:151],v[56:59],a[172:175]
ds_read_b64_tr_b16 a[138:139],v2 offset:6400
v_lshl_add_u32 v36,v38,3,v19
v_mfma_f32_16x16x32_bf16 v[124:127],a[148:151],v[52:55],v[124:127]
ds_read_b64_tr_b16 a[140:141],v3 offset:256
v_xor_b32 v37,32,v36
v_mfma_f32_16x16x32_bf16 v[120:123],a[144:147],v[52:55],v[120:123]
ds_read_b64_tr_b16 a[142:143],v3 offset:6400
v_xor_b32 v38,64,v36
v_mfma_f32_16x16x32_bf16 v[216:219],a[144:147],v[48:51],v[216:219]
v_bfe_u32 v19,v39,3,1
v_xor_b32 v39,96,v36
v_mfma_f32_16x16x32_bf16 v[220:223],a[148:151],v[48:51],v[220:223]
v_lshlrev_b32 v19,11,v19
v_add_f32 v66,v66,v67
v_mfma_f32_16x16x32_bf16 v[172:175],a[148:151],v[44:47],v[172:175]
ds_read_b64_tr_b16 a[150:151],v5 offset:6400
v_accvgpr_read_b32 v82,a166
v_mfma_f32_16x16x32_bf16 v[168:171],a[144:147],v[44:47],v[168:171]
s_waitcnt lgkmcnt(4)
ds_read_b64_tr_b16 a[146:147],v4 offset:6400
v_accvgpr_read_b32 v83,a167
v_mfma_f32_16x16x32_bf16 v[176:179],a[120:123],v[44:47],v[176:179]
ds_read_b64_tr_b16 a[144:145],v4 offset:256
v_accvgpr_read_b32 v80,a164
v_mfma_f32_16x16x32_bf16 v[180:183],a[124:127],v[44:47],v[180:183]
ds_read_b64_tr_b16 a[148:149],v5 offset:256
v_accvgpr_read_b32 v81,a165
v_mfma_f32_16x16x32_bf16 v[228:231],a[124:127],v[48:51],v[228:231]
v_accvgpr_read_b32 v72,a160
v_accvgpr_read_b32 v73,a161
v_mfma_f32_16x16x32_bf16 v[224:227],a[120:123],v[48:51],v[224:227]
v_rcp_f32 v66,v66
v_mfma_f32_16x16x32_bf16 v[128:131],a[120:123],v[52:55],v[128:131]
v_accvgpr_read_b32 v75,a163
v_accvgpr_read_b32 v74,a162
v_mfma_f32_16x16x32_bf16 v[132:135],a[124:127],v[52:55],v[132:135]
v_accvgpr_read_b32 v90,a170
v_accvgpr_read_b32 v91,a171
v_mfma_f32_16x16x32_bf16 a[180:183],a[124:127],v[56:59],a[180:183]
v_accvgpr_read_b32 v88,a168
v_accvgpr_read_b32 v89,a169
v_mfma_f32_16x16x32_bf16 a[176:179],a[120:123],v[56:59],a[176:179]
v_accvgpr_read_b32 v98,a174
v_accvgpr_read_b32 v99,a175
v_mfma_f32_16x16x32_bf16 a[184:187],a[128:131],v[56:59],a[184:187]
v_accvgpr_read_b32 v97,a173
v_accvgpr_read_b32 v96,a172
v_mfma_f32_16x16x32_bf16 a[188:191],a[132:135],v[56:59],a[188:191]
v_accvgpr_read_b32 v87,a183
v_accvgpr_read_b32 v84,a180
v_mfma_f32_16x16x32_bf16 v[140:143],a[132:135],v[52:55],v[140:143]
v_accvgpr_read_b32 v79,a179
v_accvgpr_read_b32 v77,a177
v_accvgpr_read_b32 v76,a176
v_accvgpr_read_b32 v78,a178
v_accvgpr_read_b32 v85,a181
v_pk_mul_f32 v[76:77],v[76:77],v[66:67] op_sel_hi:[1,0]
v_pk_mul_f32 v[74:75],v[74:75],v[66:67] op_sel_hi:[1,0]
v_pk_mul_f32 v[82:83],v[82:83],v[66:67] op_sel_hi:[1,0]
v_pk_mul_f32 v[78:79],v[78:79],v[66:67] op_sel_hi:[1,0]
v_pk_mul_f32 v[84:85],v[84:85],v[66:67] op_sel_hi:[1,0]
v_pk_mul_f32 v[80:81],v[80:81],v[66:67] op_sel_hi:[1,0]
v_pk_mul_f32 v[72:73],v[72:73],v[66:67] op_sel_hi:[1,0]
v_accvgpr_read_b32 v86,a182
v_pk_mul_f32 v[86:87],v[86:87],v[66:67] op_sel_hi:[1,0]
v_accvgpr_read_b32 v92,a184
v_accvgpr_read_b32 v95,a187
v_mfma_f32_16x16x32_bf16 v[136:139],a[128:131],v[52:55],v[136:139]
v_accvgpr_read_b32 v94,a186
v_accvgpr_read_b32 v93,a185
v_accvgpr_read_b32 v102,a190
v_accvgpr_read_b32 v103,a191
v_accvgpr_read_b32 v101,a189
v_pk_mul_f32 v[94:95],v[94:95],v[66:67] op_sel_hi:[1,0]
v_pk_mul_f32 v[88:89],v[88:89],v[66:67] op_sel_hi:[1,0]
v_pk_mul_f32 v[90:91],v[90:91],v[66:67] op_sel_hi:[1,0]
v_pk_mul_f32 v[92:93],v[92:93],v[66:67] op_sel_hi:[1,0]
v_accvgpr_read_b32 v100,a188
v_cvt_pk_bf16_f32 v76,v76,v77
v_mfma_f32_16x16x32_bf16 v[232:235],a[128:131],v[48:51],v[232:235]
v_cvt_pk_bf16_f32 v80,v80,v81
v_cvt_pk_bf16_f32 v84,v84,v85
v_cvt_pk_bf16_f32 v81,v82,v83
v_cvt_pk_bf16_f32 v92,v92,v93
v_cvt_pk_bf16_f32 v85,v86,v87
v_pk_mul_f32 v[100:101],v[100:101],v[66:67] op_sel_hi:[1,0]
v_pk_mul_f32 v[102:103],v[102:103],v[66:67] op_sel_hi:[1,0]
v_pk_mul_f32 v[96:97],v[96:97],v[66:67] op_sel_hi:[1,0]
v_pk_mul_f32 v[98:99],v[98:99],v[66:67] op_sel_hi:[1,0]
v_cvt_pk_bf16_f32 v100,v100,v101
v_cvt_pk_bf16_f32 v77,v78,v79
v_mfma_f32_16x16x32_bf16 v[236:239],a[132:135],v[48:51],v[236:239]
v_cvt_pk_bf16_f32 v72,v72,v73
v_cvt_pk_bf16_f32 v73,v74,v75
v_mfma_f32_16x16x32_bf16 v[188:191],a[132:135],v[44:47],v[188:191]
ds_write2st64_b64 v36,v[72:73],v[76:77] offset0:36 offset1:40
v_mfma_f32_16x16x32_bf16 v[184:187],a[128:131],v[44:47],v[184:187]
s_waitcnt lgkmcnt(1)
v_cvt_pk_bf16_f32 v93,v94,v95
v_cvt_pk_bf16_f32 v88,v88,v89
v_mfma_f32_16x16x32_bf16 v[192:195],a[136:139],v[44:47],v[192:195]
v_cvt_pk_bf16_f32 v89,v90,v91
v_cvt_pk_bf16_f32 v101,v102,v103
v_mfma_f32_16x16x32_bf16 v[196:199],a[140:143],v[44:47],v[196:199]
v_cvt_pk_bf16_f32 v96,v96,v97
v_cvt_pk_bf16_f32 v97,v98,v99
v_mfma_f32_16x16x32_bf16 v[244:247],a[140:143],v[48:51],v[244:247]
ds_write2st64_b64 v37,v[80:81],v[84:85] offset0:36 offset1:40
v_mfma_f32_16x16x32_bf16 v[240:243],a[136:139],v[48:51],v[240:243]
v_add_f32 v62,v62,v63
v_add_f32 v64,v64,v65
v_mfma_f32_16x16x32_bf16 v[144:147],a[136:139],v[52:55],v[144:147]
v_rcp_f32 v64,v64
v_mfma_f32_16x16x32_bf16 v[148:151],a[140:143],v[52:55],v[148:151]
v_rcp_f32 v62,v62
v_mfma_f32_16x16x32_bf16 a[196:199],a[140:143],v[56:59],a[196:199]
ds_write2st64_b64 v38,v[88:89],v[92:93] offset0:36 offset1:40
v_mfma_f32_16x16x32_bf16 a[192:195],a[136:139],v[56:59],a[192:195]
v_add_f32 v60,v60,v61
v_rcp_f32 v60,v60
v_mfma_f32_16x16x32_bf16 a[200:203],a[144:147],v[56:59],a[200:203]
v_min3_f32 v61,v60,v62,v64
v_min_f32 v61,v61,v66
v_mfma_f32_16x16x32_bf16 a[204:207],a[148:151],v[56:59],a[204:207]
v_accvgpr_read_b32 v84,a196
v_accvgpr_read_b32 v86,a198
v_mfma_f32_16x16x32_bf16 v[156:159],a[148:151],v[52:55],v[156:159]
ds_write2st64_b64 v39,v[96:97],v[100:101] offset0:36 offset1:40
v_accvgpr_read_b32 v82,a194
v_accvgpr_read_b32 v83,a195
v_pk_mul_f32 v[82:83],v[82:83],v[66:67] op_sel_hi:[1,0]
ds_read_b128 v[104:107],v10 offset:18432
v_accvgpr_read_b32 v80,a192
ds_read_b128 v[108:111],v10 offset:19456
v_accvgpr_read_b32 v85,a197
ds_read_b128 v[72:75],v10 offset:20480
v_pk_mul_f32 v[84:85],v[84:85],v[66:67] op_sel_hi:[1,0]
ds_read_b128 v[76:79],v10 offset:21504
v_accvgpr_read_b32 v81,a193
v_pk_mul_f32 v[80:81],v[80:81],v[66:67] op_sel_hi:[1,0]
v_accvgpr_read_b32 v87,a199
v_pk_mul_f32 v[86:87],v[86:87],v[66:67] op_sel_hi:[1,0]
v_accvgpr_read_b32 v91,a203
v_accvgpr_read_b32 v88,a200
v_mfma_f32_16x16x32_bf16 v[152:155],a[144:147],v[52:55],v[152:155]
v_cvt_pk_bf16_f32 v84,v84,v85
v_accvgpr_read_b32 v90,a202
v_cvt_pk_bf16_f32 v80,v80,v81
v_cvt_pk_bf16_f32 v81,v82,v83
ds_write_b64 v36,v[80:81] offset:18432
s_waitcnt lgkmcnt(4)
buffer_store_dwordx4 v[104:107],v9,s[16:19],s87 offen offset:0 nt
v_pk_mul_f32 v[90:91],v[90:91],v[66:67] op_sel_hi:[1,0]
v_add_u32 v36,v36,v19
v_accvgpr_read_b32 v89,a201
v_pk_mul_f32 v[88:89],v[88:89],v[66:67] op_sel_hi:[1,0]
v_accvgpr_read_b32 v94,a206
v_cvt_pk_bf16_f32 v88,v88,v89
v_mfma_f32_16x16x32_bf16 v[248:251],a[144:147],v[48:51],v[248:251]
s_waitcnt lgkmcnt(1)
v_accvgpr_read_b32 v95,a207
v_cvt_pk_bf16_f32 v85,v86,v87
ds_write_b64 v37,v[84:85] offset:18432
buffer_store_dwordx4 v[108:111],v9,s[16:19],s87 offen offset:3072 nt
v_pk_mul_f32 v[94:95],v[94:95],v[66:67] op_sel_hi:[1,0]
v_pk_mul_f32 v[222:223],v[222:223],v[62:63] op_sel_hi:[1,0]
v_pk_mul_f32 v[114:115],v[114:115],v[64:65] op_sel_hi:[1,0]
v_pk_mul_f32 v[240:241],v[240:241],v[62:63] op_sel_hi:[1,0]
v_pk_mul_f32 v[242:243],v[242:243],v[62:63] op_sel_hi:[1,0]
v_pk_mul_f32 v[212:213],v[212:213],v[62:63] op_sel_hi:[1,0]
v_pk_mul_f32 v[230:231],v[230:231],v[62:63] op_sel_hi:[1,0]
v_pk_mul_f32 v[246:247],v[246:247],v[62:63] op_sel_hi:[1,0]
v_pk_mul_f32 v[236:237],v[236:237],v[62:63] op_sel_hi:[1,0]
v_pk_mul_f32 v[226:227],v[226:227],v[62:63] op_sel_hi:[1,0]
v_pk_mul_f32 v[228:229],v[228:229],v[62:63] op_sel_hi:[1,0]
buffer_store_dwordx4 v[72:75],v9,s[16:19],s87 offen offset:128 nt
v_pk_mul_f32 v[208:209],v[208:209],v[62:63] op_sel_hi:[1,0]
v_pk_mul_f32 v[210:211],v[210:211],v[62:63] op_sel_hi:[1,0]
v_pk_mul_f32 v[232:233],v[232:233],v[62:63] op_sel_hi:[1,0]
v_pk_mul_f32 v[116:117],v[116:117],v[64:65] op_sel_hi:[1,0]
v_pk_mul_f32 v[220:221],v[220:221],v[62:63] op_sel_hi:[1,0]
v_pk_mul_f32 v[224:225],v[224:225],v[62:63] op_sel_hi:[1,0]
v_pk_mul_f32 v[218:219],v[218:219],v[62:63] op_sel_hi:[1,0]
v_pk_mul_f32 v[238:239],v[238:239],v[62:63] op_sel_hi:[1,0]
v_pk_mul_f32 v[234:235],v[234:235],v[62:63] op_sel_hi:[1,0]
v_pk_mul_f32 v[118:119],v[118:119],v[64:65] op_sel_hi:[1,0]
v_pk_mul_f32 v[244:245],v[244:245],v[62:63] op_sel_hi:[1,0]
buffer_store_dwordx4 v[76:79],v9,s[16:19],s87 offen offset:3200 nt
v_pk_mul_f32 v[214:215],v[214:215],v[62:63] op_sel_hi:[1,0]
v_pk_mul_f32 v[216:217],v[216:217],v[62:63] op_sel_hi:[1,0]
v_pk_mul_f32 v[112:113],v[112:113],v[64:65] op_sel_hi:[1,0]
v_add_u32 v37,v37,v19
v_cvt_pk_bf16_f32 v89,v90,v91
v_accvgpr_read_b32 v93,a205
v_accvgpr_read_b32 v92,a204
v_pk_mul_f32 v[92:93],v[92:93],v[66:67] op_sel_hi:[1,0]
v_cvt_pk_bf16_f32 v228,v228,v229
v_cvt_pk_bf16_f32 v92,v92,v93
v_mfma_f32_16x16x32_bf16 v[252:255],a[148:151],v[48:51],v[252:255]
ds_write_b64 v38,v[88:89] offset:18432
v_mfma_f32_16x16x32_bf16 v[204:207],a[148:151],v[44:47],v[204:207]
v_add_u32 v38,v38,v19
v_cvt_pk_bf16_f32 v93,v94,v95
v_mfma_f32_16x16x32_bf16 v[200:203],a[144:147],v[44:47],v[200:203]
ds_write_b64 v39,v[92:93] offset:18432
ds_read_b128 v[96:99],v10 offset:18432
v_pk_mul_f32 v[248:249],v[248:249],v[62:63] op_sel_hi:[1,0]
ds_read_b128 v[100:103],v10 offset:19456
v_pk_mul_f32 v[250:251],v[250:251],v[62:63] op_sel_hi:[1,0]
v_pk_mul_f32 v[122:123],v[122:123],v[64:65] op_sel_hi:[1,0]
v_pk_mul_f32 v[252:253],v[252:253],v[62:63] op_sel_hi:[1,0]
v_pk_mul_f32 v[120:121],v[120:121],v[64:65] op_sel_hi:[1,0]
v_pk_mul_f32 v[126:127],v[126:127],v[64:65] op_sel_hi:[1,0]
v_pk_mul_f32 v[124:125],v[124:125],v[64:65] op_sel_hi:[1,0]
v_pk_mul_f32 v[254:255],v[254:255],v[62:63] op_sel_hi:[1,0]
v_pk_mul_f32 v[128:129],v[128:129],v[64:65] op_sel_hi:[1,0]
v_pk_mul_f32 v[146:147],v[146:147],v[64:65] op_sel_hi:[1,0]
v_pk_mul_f32 v[130:131],v[130:131],v[64:65] op_sel_hi:[1,0]
v_pk_mul_f32 v[132:133],v[132:133],v[64:65] op_sel_hi:[1,0]
v_pk_mul_f32 v[148:149],v[148:149],v[64:65] op_sel_hi:[1,0]
v_pk_mul_f32 v[136:137],v[136:137],v[64:65] op_sel_hi:[1,0]
v_pk_mul_f32 v[134:135],v[134:135],v[64:65] op_sel_hi:[1,0]
v_pk_mul_f32 v[150:151],v[150:151],v[64:65] op_sel_hi:[1,0]
v_pk_mul_f32 v[144:145],v[144:145],v[64:65] op_sel_hi:[1,0]
v_pk_mul_f32 v[152:153],v[152:153],v[64:65] op_sel_hi:[1,0]
v_pk_mul_f32 v[142:143],v[142:143],v[64:65] op_sel_hi:[1,0]
v_pk_mul_f32 v[156:157],v[156:157],v[64:65] op_sel_hi:[1,0]
v_pk_mul_f32 v[154:155],v[154:155],v[64:65] op_sel_hi:[1,0]
v_pk_mul_f32 v[158:159],v[158:159],v[64:65] op_sel_hi:[1,0]
v_pk_mul_f32 v[140:141],v[140:141],v[64:65] op_sel_hi:[1,0]
v_pk_mul_f32 v[138:139],v[138:139],v[64:65] op_sel_hi:[1,0]
s_waitcnt lgkmcnt(1)
buffer_store_dwordx4 v[96:99],v9,s[16:19],s87 offen offset:256 nt
v_pk_mul_f32 v[176:177],v[176:177],v[60:61] op_sel_hi:[1,0]
v_pk_mul_f32 v[166:167],v[166:167],v[60:61] op_sel_hi:[1,0]
v_pk_mul_f32 v[160:161],v[160:161],v[60:61] op_sel_hi:[1,0]
v_pk_mul_f32 v[182:183],v[182:183],v[60:61] op_sel_hi:[1,0]
v_pk_mul_f32 v[184:185],v[184:185],v[60:61] op_sel_hi:[1,0]
v_pk_mul_f32 v[178:179],v[178:179],v[60:61] op_sel_hi:[1,0]
v_pk_mul_f32 v[162:163],v[162:163],v[60:61] op_sel_hi:[1,0]
v_pk_mul_f32 v[186:187],v[186:187],v[60:61] op_sel_hi:[1,0]
v_pk_mul_f32 v[168:169],v[168:169],v[60:61] op_sel_hi:[1,0]
v_pk_mul_f32 v[170:171],v[170:171],v[60:61] op_sel_hi:[1,0]
v_pk_mul_f32 v[180:181],v[180:181],v[60:61] op_sel_hi:[1,0]
s_waitcnt lgkmcnt(0)
buffer_store_dwordx4 v[100:103],v9,s[16:19],s87 offen offset:3328 nt
v_pk_mul_f32 v[164:165],v[164:165],v[60:61] op_sel_hi:[1,0]
v_pk_mul_f32 v[174:175],v[174:175],v[60:61] op_sel_hi:[1,0]
v_pk_mul_f32 v[190:191],v[190:191],v[60:61] op_sel_hi:[1,0]
v_pk_mul_f32 v[172:173],v[172:173],v[60:61] op_sel_hi:[1,0]
v_pk_mul_f32 v[188:189],v[188:189],v[60:61] op_sel_hi:[1,0]
v_pk_mul_f32 v[192:193],v[192:193],v[60:61] op_sel_hi:[1,0]
v_pk_mul_f32 v[194:195],v[194:195],v[60:61] op_sel_hi:[1,0]
v_pk_mul_f32 v[196:197],v[196:197],v[60:61] op_sel_hi:[1,0]
v_pk_mul_f32 v[206:207],v[206:207],v[60:61] op_sel_hi:[1,0]
v_pk_mul_f32 v[200:201],v[200:201],v[60:61] op_sel_hi:[1,0]
v_pk_mul_f32 v[198:199],v[198:199],v[60:61] op_sel_hi:[1,0]
v_pk_mul_f32 v[202:203],v[202:203],v[60:61] op_sel_hi:[1,0]
v_pk_mul_f32 v[204:205],v[204:205],v[60:61] op_sel_hi:[1,0]
v_add_u32 v39,v39,v19
v_cvt_pk_bf16_f32 v224,v224,v225
v_cvt_pk_bf16_f32 v225,v226,v227
v_cvt_pk_bf16_f32 v220,v220,v221
v_cvt_pk_bf16_f32 v229,v230,v231
v_cvt_pk_bf16_f32 v208,v208,v209
v_cvt_pk_bf16_f32 v209,v210,v211
ds_write2st64_b64 v36,v[208:209],v[224:225] offset0:12 offset1:14
v_cvt_pk_bf16_f32 v216,v216,v217
v_cvt_pk_bf16_f32 v232,v232,v233
v_cvt_pk_bf16_f32 v212,v212,v213
v_cvt_pk_bf16_f32 v213,v214,v215
v_cvt_pk_bf16_f32 v233,v234,v235
v_cvt_pk_bf16_f32 v217,v218,v219
v_cvt_pk_bf16_f32 v236,v236,v237
v_cvt_pk_bf16_f32 v221,v222,v223
v_cvt_pk_bf16_f32 v237,v238,v239
v_cvt_pk_bf16_f32 v240,v240,v241
v_cvt_pk_bf16_f32 v248,v248,v249
ds_write2st64_b64 v37,v[212:213],v[228:229] offset0:12 offset1:14
v_cvt_pk_bf16_f32 v112,v112,v113
v_cvt_pk_bf16_f32 v249,v250,v251
v_cvt_pk_bf16_f32 v241,v242,v243
v_cvt_pk_bf16_f32 v113,v114,v115
v_cvt_pk_bf16_f32 v244,v244,v245
v_cvt_pk_bf16_f32 v120,v120,v121
v_cvt_pk_bf16_f32 v116,v116,v117
v_cvt_pk_bf16_f32 v117,v118,v119
v_cvt_pk_bf16_f32 v245,v246,v247
v_cvt_pk_bf16_f32 v121,v122,v123
v_cvt_pk_bf16_f32 v124,v124,v125
ds_write2st64_b64 v38,v[216:217],v[232:233] offset0:12 offset1:14
v_cvt_pk_bf16_f32 v125,v126,v127
v_cvt_pk_bf16_f32 v252,v252,v253
v_cvt_pk_bf16_f32 v253,v254,v255
v_cvt_pk_bf16_f32 v128,v128,v129
v_cvt_pk_bf16_f32 v136,v136,v137
v_cvt_pk_bf16_f32 v148,v148,v149
v_cvt_pk_bf16_f32 v144,v144,v145
v_cvt_pk_bf16_f32 v145,v146,v147
v_cvt_pk_bf16_f32 v129,v130,v131
v_cvt_pk_bf16_f32 v137,v138,v139
v_cvt_pk_bf16_f32 v132,v132,v133
ds_write2st64_b64 v39,v[220:221],v[236:237] offset0:12 offset1:14
v_cvt_pk_bf16_f32 v133,v134,v135
v_cvt_pk_bf16_f32 v149,v150,v151
v_cvt_pk_bf16_f32 v140,v140,v141
ds_read_b128 v[80:83],v10 offset:6144
v_cvt_pk_bf16_f32 v141,v142,v143
ds_read_b128 v[72:75],v10 offset:9216
v_cvt_pk_bf16_f32 v152,v152,v153
ds_read_b128 v[76:79],v10 offset:7168
v_cvt_pk_bf16_f32 v156,v156,v157
ds_read_b128 v[84:87],v10 offset:10240
v_cvt_pk_bf16_f32 v157,v158,v159
ds_write2st64_b64 v36,v[240:241],v[112:113] offset0:16 offset1:24
v_cvt_pk_bf16_f32 v153,v154,v155
v_cvt_pk_bf16_f32 v176,v176,v177
v_cvt_pk_bf16_f32 v177,v178,v179
v_cvt_pk_bf16_f32 v160,v160,v161
v_cvt_pk_bf16_f32 v161,v162,v163
v_cvt_pk_bf16_f32 v184,v184,v185
v_cvt_pk_bf16_f32 v172,v172,v173
s_waitcnt lgkmcnt(4)
buffer_store_dwordx4 v[80:83],v9,s[16:19],s85 offen offset:0 nt
v_cvt_pk_bf16_f32 v168,v168,v169
v_cvt_pk_bf16_f32 v164,v164,v165
v_cvt_pk_bf16_f32 v180,v180,v181
v_cvt_pk_bf16_f32 v181,v182,v183
v_cvt_pk_bf16_f32 v188,v188,v189
v_cvt_pk_bf16_f32 v185,v186,v187
v_cvt_pk_bf16_f32 v165,v166,v167
v_cvt_pk_bf16_f32 v169,v170,v171
v_cvt_pk_bf16_f32 v173,v174,v175
ds_write2st64_b64 v37,v[244:245],v[116:117] offset0:16 offset1:24
v_cvt_pk_bf16_f32 v189,v190,v191
v_cvt_pk_bf16_f32 v192,v192,v193
v_cvt_pk_bf16_f32 v193,v194,v195
s_waitcnt lgkmcnt(1)
buffer_store_dwordx4 v[72:75],v9,s[16:19],s85 offen offset:3072 nt
v_cvt_pk_bf16_f32 v196,v196,v197
v_cvt_pk_bf16_f32 v197,v198,v199
v_cvt_pk_bf16_f32 v200,v200,v201
v_cvt_pk_bf16_f32 v204,v204,v205
v_cvt_pk_bf16_f32 v205,v206,v207
v_cvt_pk_bf16_f32 v201,v202,v203
v_cmp_nlt_f32 vcc,s37,v61
ds_write2st64_b64 v38,v[248:249],v[120:121] offset0:16 offset1:24
buffer_store_dwordx4 v[76:79],v9,s[16:19],s85 offen offset:128 nt
ds_write2st64_b64 v39,v[252:253],v[124:125] offset0:16 offset1:24
ds_read_b128 v[104:107],v10 offset:8192
buffer_store_dwordx4 v[84:87],v9,s[16:19],s85 offen offset:3200 nt
ds_read_b128 v[108:111],v10 offset:11264
s_cmp_lg_u64 vcc,0
ds_read_b128 v[88:91],v10 offset:12288
s_cselect_b32 s62,s32,0
ds_read_b128 v[92:95],v10 offset:15360
s_or_b32 s31,s31,s62
ds_write2st64_b64 v36,v[128:129],v[144:145] offset0:26 offset1:28
s_lshl_b32 s32,s32,1
s_waitcnt lgkmcnt(4)
buffer_store_dwordx4 v[104:107],v9,s[16:19],s85 offen offset:256 nt
ds_write2st64_b64 v37,v[132:133],v[148:149] offset0:26 offset1:28
s_waitcnt lgkmcnt(1)
buffer_store_dwordx4 v[108:111],v9,s[16:19],s85 offen offset:3328 nt
ds_write2st64_b64 v38,v[136:137],v[152:153] offset0:26 offset1:28
buffer_store_dwordx4 v[88:91],v9,s[16:19],s86 offen offset:0 nt
ds_write2st64_b64 v39,v[140:141],v[156:157] offset0:26 offset1:28
ds_read_b128 v[208:211],v10 offset:13312
buffer_store_dwordx4 v[92:95],v9,s[16:19],s86 offen offset:3072 nt
ds_read_b128 v[224:227],v10 offset:16384
ds_read_b128 v[96:99],v10 offset:14336
ds_read_b128 v[100:103],v10 offset:17408
ds_write2st64_b64 v36,v[160:161],v[176:177] offset0:0 offset1:2
s_waitcnt lgkmcnt(4)
buffer_store_dwordx4 v[208:211],v9,s[16:19],s86 offen offset:128 nt
ds_write2st64_b64 v37,v[164:165],v[180:181] offset0:0 offset1:2
s_waitcnt lgkmcnt(1)
buffer_store_dwordx4 v[224:227],v9,s[16:19],s86 offen offset:3200 nt
ds_write2st64_b64 v38,v[168:169],v[184:185] offset0:0 offset1:2
buffer_store_dwordx4 v[96:99],v9,s[16:19],s86 offen offset:256 nt
ds_write2st64_b64 v39,v[172:173],v[188:189] offset0:0 offset1:2
ds_read_b128 v[212:215],v10 offset:0
buffer_store_dwordx4 v[100:103],v9,s[16:19],s86 offen offset:3328 nt
ds_read_b128 v[228:231],v10 offset:3072
ds_read_b128 v[216:219],v10 offset:1024
ds_read_b128 v[232:235],v10 offset:4096
ds_write_b64 v36,v[192:193] offset:2048
ds_write_b64 v37,v[196:197] offset:2048
s_waitcnt lgkmcnt(5)
buffer_store_dwordx4 v[212:215],v9,s[16:19],s84 offen offset:0 nt
ds_write_b64 v38,v[200:201] offset:2048
s_waitcnt lgkmcnt(2)
buffer_store_dwordx4 v[228:231],v9,s[16:19],s84 offen offset:3072 nt
ds_write_b64 v39,v[204:205] offset:2048
ds_read_b128 v[220:223],v10 offset:2048
buffer_store_dwordx4 v[216:219],v9,s[16:19],s84 offen offset:128 nt
ds_read_b128 v[236:239],v10 offset:5120
buffer_store_dwordx4 v[232:235],v9,s[16:19],s84 offen offset:3200 nt
s_waitcnt lgkmcnt(1)
buffer_store_dwordx4 v[220:223],v9,s[16:19],s84 offen offset:256 nt
s_waitcnt lgkmcnt(0)
buffer_store_dwordx4 v[236:239],v9,s[16:19],s84 offen offset:3328 nt
s_branch L_fin
L_fin:
s_waitcnt vmcnt(0)
L_stamped:
s_cmp_lg_u32 s31,0
s_cbranch_scc1 L_fix
L_done:
L_end:
s_endpgm
L_fix:
s_sub_u32 s62,s24,36864
v_add_u32 v112,s62,v2
v_add_u32 v113,s62,v3
v_add_u32 v114,s62,v4
v_add_u32 v115,s62,v5
v_mbcnt_lo_u32_b32 v19,-1,0
v_mbcnt_hi_u32_b32 v19,-1,v19
v_and_b32 v81,15,v19
v_mul_u32_u24 v81,384,v81
v_lshrrev_b32 v82,4,v19
v_lshl_add_u32 v83,v82,3,v81
v_lshl_add_u32 v81,v82,4,v81
L_fix_pass:
s_ff1_i32_b32 s50,s31
s_bitset0_b32 s31,s50
s_lshl_b32 s62,s50,5
s_add_u32 s62,s62,s34
s_mul_i32 s63,s62,171
s_lshr_b32 s63,s63,9
s_mul_i32 s64,s63,3
s_sub_u32 s62,s62,s64
s_add_u32 s63,s63,s33
s_mul_i32 s30,s63,196608
s_mul_i32 s41,s63,325632
s_lshl_b32 s63,s3,2
s_add_u32 s64,s63,21
s_cmp_eq_u32 s3,0
s_cselect_b32 s64,20,s64
s_cselect_b32 s40,1,0
s_add_u32 s65,s63,37
s_cmp_eq_u32 s62,2
s_cselect_b32 s64,s65,s64
s_cselect_b32 s40,0,s40
s_add_u32 s65,s63,s3
s_cmp_eq_u32 s62,0
s_cselect_b32 s64,s65,s64
s_cselect_b32 s40,1,s40
s_mul_i32 s64,s64,6144
s_add_u32 s41,s41,s64
s_add_u32 s55,s40,4
s_mov_b32 s51,0
L_fix_tile:
buffer_load_dwordx4 a[0:3],v81,s[12:15],s41 offen offset:0
buffer_load_dwordx4 a[4:7],v81,s[12:15],s41 offen offset:64
buffer_load_dwordx4 a[8:11],v81,s[12:15],s41 offen offset:128
buffer_load_dwordx4 a[12:15],v81,s[12:15],s41 offen offset:192
buffer_load_dwordx4 a[16:19],v81,s[12:15],s41 offen offset:256
buffer_load_dwordx4 a[20:23],v81,s[12:15],s41 offen offset:320
v_mov_b32 v80,0xff800000
s_mov_b32 s53,s30
s_mov_b32 s52,0
L_fix_max:
s_mov_b32 s63,s53
s_add_u32 m0,s24,0
s_nop 0
buffer_load_dwordx4 v6,s[4:7],s63 offen offset:0 lds
buffer_load_dwordx4 v7,s[4:7],s63 offen offset:1024 lds
buffer_load_dwordx4 v8,s[4:7],s63 offen offset:2048 lds
s_add_u32 s63,s63,3072
s_add_u32 m0,s24,3072
s_nop 0
buffer_load_dwordx4 v6,s[4:7],s63 offen offset:0 lds
buffer_load_dwordx4 v7,s[4:7],s63 offen offset:1024 lds
buffer_load_dwordx4 v8,s[4:7],s63 offen offset:2048 lds
s_add_u32 s63,s63,3072
s_add_u32 m0,s24,6144
s_nop 0
buffer_load_dwordx4 v6,s[4:7],s63 offen offset:0 lds
buffer_load_dwordx4 v7,s[4:7],s63 offen offset:1024 lds
buffer_load_dwordx4 v8,s[4:7],s63 offen offset:2048 lds
s_add_u32 s63,s63,3072
s_add_u32 m0,s24,9216
s_nop 0
buffer_load_dwordx4 v6,s[4:7],s63 offen offset:0 lds
buffer_load_dwordx4 v7,s[4:7],s63 offen offset:1024 lds
buffer_load_dwordx4 v8,s[4:7],s63 offen offset:2048 lds
s_add_u32 s63,s63,3072
s_waitcnt vmcnt(0)
ds_read_b128 a[160:163],v11 offset:0
ds_read_b128 a[164:167],v12 offset:0
ds_read_b128 a[168:171],v11 offset:128
ds_read_b128 a[172:175],v12 offset:128
ds_read_b128 a[176:179],v11 offset:256
ds_read_b128 a[180:183],v12 offset:256
ds_read_b128 a[184:187],v11 offset:6144
ds_read_b128 a[188:191],v12 offset:6144
ds_read_b128 a[192:195],v11 offset:6272
ds_read_b128 a[196:199],v12 offset:6272
ds_read_b128 a[200:203],v11 offset:6400
ds_read_b128 a[204:207],v12 offset:6400
s_waitcnt lgkmcnt(0)
v_mfma_f32_16x16x32_bf16 v[72:75],a[160:163],a[0:3],0
v_mfma_f32_16x16x32_bf16 v[72:75],a[164:167],a[4:7],v[72:75]
v_mfma_f32_16x16x32_bf16 v[72:75],a[168:171],a[8:11],v[72:75]
v_mfma_f32_16x16x32_bf16 v[72:75],a[172:175],a[12:15],v[72:75]
v_mfma_f32_16x16x32_bf16 v[72:75],a[176:179],a[16:19],v[72:75]
v_mfma_f32_16x16x32_bf16 v[72:75],a[180:183],a[20:23],v[72:75]
v_mfma_f32_16x16x32_bf16 v[76:79],a[184:187],a[0:3],0
v_mfma_f32_16x16x32_bf16 v[76:79],a[188:191],a[4:7],v[76:79]
v_mfma_f32_16x16x32_bf16 v[76:79],a[192:195],a[8:11],v[76:79]
v_mfma_f32_16x16x32_bf16 v[76:79],a[196:199],a[12:15],v[76:79]
v_mfma_f32_16x16x32_bf16 v[76:79],a[200:203],a[16:19],v[76:79]
v_mfma_f32_16x16x32_bf16 v[76:79],a[204:207],a[20:23],v[76:79]
s_nop 7
v_max3_f32 v80,v80,v72,v73
v_max3_f32 v80,v80,v74,v75
v_max3_f32 v80,v80,v76,v77
v_max3_f32 v80,v80,v78,v79
s_add_u32 s53,s53,12288
s_add_u32 s52,s52,1
s_cmp_lt_u32 s52,16
s_cbranch_scc1 L_fix_max
v_mov_b32 v19,v80
s_nop 1
v_permlane32_swap_b32 v19,v80
v_max_f32 v80,v80,v19
v_mov_b32 v19,v80
s_nop 1
v_permlane16_swap_b32 v19,v80
v_max_f32 v80,v80,v19
v_mul_f32_e64 v13,-s36,v80
v_mov_b32 v160,0
v_mov_b32 v161,0
v_mov_b32 v162,0
v_mov_b32 v163,0
v_mov_b32 v164,0
v_mov_b32 v165,0
v_mov_b32 v166,0
v_mov_b32 v167,0
v_mov_b32 v168,0
v_mov_b32 v169,0
v_mov_b32 v170,0
v_mov_b32 v171,0
v_mov_b32 v172,0
v_mov_b32 v173,0
v_mov_b32 v174,0
v_mov_b32 v175,0
v_mov_b32 v176,0
v_mov_b32 v177,0
v_mov_b32 v178,0
v_mov_b32 v179,0
v_mov_b32 v180,0
v_mov_b32 v181,0
v_mov_b32 v182,0
v_mov_b32 v183,0
v_mov_b32 v184,0
v_mov_b32 v185,0
v_mov_b32 v186,0
v_mov_b32 v187,0
v_mov_b32 v188,0
v_mov_b32 v189,0
v_mov_b32 v190,0
v_mov_b32 v191,0
v_mov_b32 v192,0
v_mov_b32 v193,0
v_mov_b32 v194,0
v_mov_b32 v195,0
v_mov_b32 v196,0
v_mov_b32 v197,0
v_mov_b32 v198,0
v_mov_b32 v199,0
v_mov_b32 v200,0
v_mov_b32 v201,0
v_mov_b32 v202,0
v_mov_b32 v203,0
v_mov_b32 v204,0
v_mov_b32 v205,0
v_mov_b32 v206,0
v_mov_b32 v207,0
v_mov_b32 v60,0
v_mov_b32 v24,0
v_mov_b32 v61,0
v_mov_b32 v25,0
v_mov_b32 v62,0
v_mov_b32 v26,0
v_mov_b32 v63,0
v_mov_b32 v27,0
s_mov_b32 s53,s30
s_mov_b32 s52,0
L_fix_acc:
s_mov_b32 s63,s53
s_add_u32 m0,s24,0
s_nop 0
buffer_load_dwordx4 v6,s[4:7],s63 offen offset:0 lds
buffer_load_dwordx4 v7,s[4:7],s63 offen offset:1024 lds
buffer_load_dwordx4 v8,s[4:7],s63 offen offset:2048 lds
s_add_u32 s63,s63,3072
s_add_u32 m0,s24,3072
s_nop 0
buffer_load_dwordx4 v6,s[4:7],s63 offen offset:0 lds
buffer_load_dwordx4 v7,s[4:7],s63 offen offset:1024 lds
buffer_load_dwordx4 v8,s[4:7],s63 offen offset:2048 lds
s_add_u32 s63,s63,3072
s_add_u32 m0,s24,6144
s_nop 0
buffer_load_dwordx4 v6,s[4:7],s63 offen offset:0 lds
buffer_load_dwordx4 v7,s[4:7],s63 offen offset:1024 lds
buffer_load_dwordx4 v8,s[4:7],s63 offen offset:2048 lds
s_add_u32 s63,s63,3072
s_add_u32 m0,s24,9216
s_nop 0
buffer_load_dwordx4 v6,s[4:7],s63 offen offset:0 lds
buffer_load_dwordx4 v7,s[4:7],s63 offen offset:1024 lds
buffer_load_dwordx4 v8,s[4:7],s63 offen offset:2048 lds
s_add_u32 s63,s63,3072
s_waitcnt vmcnt(0)
ds_read_b128 a[160:163],v11 offset:0
ds_read_b128 a[164:167],v12 offset:0
ds_read_b128 a[168:171],v11 offset:128
ds_read_b128 a[172:175],v12 offset:128
ds_read_b128 a[176:179],v11 offset:256
ds_read_b128 a[180:183],v12 offset:256
ds_read_b128 a[184:187],v11 offset:6144
ds_read_b128 a[188:191],v12 offset:6144
ds_read_b128 a[192:195],v11 offset:6272
ds_read_b128 a[196:199],v12 offset:6272
ds_read_b128 a[200:203],v11 offset:6400
ds_read_b128 a[204:207],v12 offset:6400
s_waitcnt lgkmcnt(0)
v_mfma_f32_16x16x32_bf16 v[72:75],a[160:163],a[0:3],0
v_mfma_f32_16x16x32_bf16 v[72:75],a[164:167],a[4:7],v[72:75]
v_mfma_f32_16x16x32_bf16 v[72:75],a[168:171],a[8:11],v[72:75]
v_mfma_f32_16x16x32_bf16 v[72:75],a[172:175],a[12:15],v[72:75]
v_mfma_f32_16x16x32_bf16 v[72:75],a[176:179],a[16:19],v[72:75]
v_mfma_f32_16x16x32_bf16 v[72:75],a[180:183],a[20:23],v[72:75]
v_mfma_f32_16x16x32_bf16 v[76:79],a[184:187],a[0:3],0
v_mfma_f32_16x16x32_bf16 v[76:79],a[188:191],a[4:7],v[76:79]
v_mfma_f32_16x16x32_bf16 v[76:79],a[192:195],a[8:11],v[76:79]
v_mfma_f32_16x16x32_bf16 v[76:79],a[196:199],a[12:15],v[76:79]
v_mfma_f32_16x16x32_bf16 v[76:79],a[200:203],a[16:19],v[76:79]
v_mfma_f32_16x16x32_bf16 v[76:79],a[204:207],a[20:23],v[76:79]
s_nop 7
v_fma_f32 v72,v72,s36,v13
v_fma_f32 v73,v73,s36,v13
v_exp_f32 v72,v72
v_exp_f32 v73,v73
s_nop 0
v_cvt_pk_bf16_f32 v20,v72,v73
v_fma_f32 v74,v74,s36,v13
v_fma_f32 v75,v75,s36,v13
v_exp_f32 v74,v74
v_exp_f32 v75,v75
s_nop 0
v_cvt_pk_bf16_f32 v21,v74,v75
v_fma_f32 v76,v76,s36,v13
v_fma_f32 v77,v77,s36,v13
v_exp_f32 v76,v76
v_exp_f32 v77,v77
s_nop 0
v_cvt_pk_bf16_f32 v22,v76,v77
v_fma_f32 v78,v78,s36,v13
v_fma_f32 v79,v79,s36,v13
v_exp_f32 v78,v78
v_exp_f32 v79,v79
s_nop 0
v_cvt_pk_bf16_f32 v23,v78,v79
s_nop 1
v_smfmac_f32_16x16x64_bf16 v[60:63],a[152:155],v[20:27],v18
s_mov_b32 s63,s53
s_add_u32 m0,s24,0
s_nop 0
buffer_load_dwordx4 v6,s[8:11],s63 offen offset:0 lds
buffer_load_dwordx4 v7,s[8:11],s63 offen offset:1024 lds
buffer_load_dwordx4 v8,s[8:11],s63 offen offset:2048 lds
s_add_u32 s63,s63,3072
s_add_u32 m0,s24,3072
s_nop 0
buffer_load_dwordx4 v6,s[8:11],s63 offen offset:0 lds
buffer_load_dwordx4 v7,s[8:11],s63 offen offset:1024 lds
buffer_load_dwordx4 v8,s[8:11],s63 offen offset:2048 lds
s_add_u32 s63,s63,3072
s_add_u32 m0,s24,6144
s_nop 0
buffer_load_dwordx4 v6,s[8:11],s63 offen offset:0 lds
buffer_load_dwordx4 v7,s[8:11],s63 offen offset:1024 lds
buffer_load_dwordx4 v8,s[8:11],s63 offen offset:2048 lds
s_add_u32 s63,s63,3072
s_add_u32 m0,s24,9216
s_nop 0
buffer_load_dwordx4 v6,s[8:11],s63 offen offset:0 lds
buffer_load_dwordx4 v7,s[8:11],s63 offen offset:1024 lds
buffer_load_dwordx4 v8,s[8:11],s63 offen offset:2048 lds
s_add_u32 s63,s63,3072
s_waitcnt vmcnt(0)
ds_read_b64_tr_b16 a[160:161],v112 offset:0
ds_read_b64_tr_b16 a[162:163],v112 offset:6144
ds_read_b64_tr_b16 a[164:165],v113 offset:0
ds_read_b64_tr_b16 a[166:167],v113 offset:6144
ds_read_b64_tr_b16 a[168:169],v114 offset:0
ds_read_b64_tr_b16 a[170:171],v114 offset:6144
ds_read_b64_tr_b16 a[172:173],v115 offset:0
ds_read_b64_tr_b16 a[174:175],v115 offset:6144
ds_read_b64_tr_b16 a[176:177],v112 offset:128
ds_read_b64_tr_b16 a[178:179],v112 offset:6272
ds_read_b64_tr_b16 a[180:181],v113 offset:128
ds_read_b64_tr_b16 a[182:183],v113 offset:6272
ds_read_b64_tr_b16 a[184:185],v114 offset:128
ds_read_b64_tr_b16 a[186:187],v114 offset:6272
ds_read_b64_tr_b16 a[188:189],v115 offset:128
ds_read_b64_tr_b16 a[190:191],v115 offset:6272
ds_read_b64_tr_b16 a[192:193],v112 offset:256
ds_read_b64_tr_b16 a[194:195],v112 offset:6400
ds_read_b64_tr_b16 a[196:197],v113 offset:256
ds_read_b64_tr_b16 a[198:199],v113 offset:6400
ds_read_b64_tr_b16 a[200:201],v114 offset:256
ds_read_b64_tr_b16 a[202:203],v114 offset:6400
ds_read_b64_tr_b16 a[204:205],v115 offset:256
ds_read_b64_tr_b16 a[206:207],v115 offset:6400
s_waitcnt lgkmcnt(0)
v_mfma_f32_16x16x32_bf16 v[160:163],a[160:163],v[20:23],v[160:163]
v_mfma_f32_16x16x32_bf16 v[164:167],a[164:167],v[20:23],v[164:167]
v_mfma_f32_16x16x32_bf16 v[168:171],a[168:171],v[20:23],v[168:171]
v_mfma_f32_16x16x32_bf16 v[172:175],a[172:175],v[20:23],v[172:175]
v_mfma_f32_16x16x32_bf16 v[176:179],a[176:179],v[20:23],v[176:179]
v_mfma_f32_16x16x32_bf16 v[180:183],a[180:183],v[20:23],v[180:183]
v_mfma_f32_16x16x32_bf16 v[184:187],a[184:187],v[20:23],v[184:187]
v_mfma_f32_16x16x32_bf16 v[188:191],a[188:191],v[20:23],v[188:191]
v_mfma_f32_16x16x32_bf16 v[192:195],a[192:195],v[20:23],v[192:195]
v_mfma_f32_16x16x32_bf16 v[196:199],a[196:199],v[20:23],v[196:199]
v_mfma_f32_16x16x32_bf16 v[200:203],a[200:203],v[20:23],v[200:203]
v_mfma_f32_16x16x32_bf16 v[204:207],a[204:207],v[20:23],v[204:207]
s_add_u32 s53,s53,12288
s_add_u32 s52,s52,1
s_cmp_lt_u32 s52,16
s_cbranch_scc1 L_fix_acc
s_nop 7
v_add_f32 v19,v60,v61
v_rcp_f32 v19,v19
s_nop 0
v_mul_f32 v160,v160,v19
v_mul_f32 v161,v161,v19
v_mul_f32 v162,v162,v19
v_mul_f32 v163,v163,v19
v_cvt_pk_bf16_f32 v160,v160,v161
v_cvt_pk_bf16_f32 v161,v162,v163
buffer_store_dwordx2 v[160:161],v83,s[16:19],s41 offen offset:0
v_mul_f32 v164,v164,v19
v_mul_f32 v165,v165,v19
v_mul_f32 v166,v166,v19
v_mul_f32 v167,v167,v19
v_cvt_pk_bf16_f32 v164,v164,v165
v_cvt_pk_bf16_f32 v165,v166,v167
buffer_store_dwordx2 v[164:165],v83,s[16:19],s41 offen offset:32
v_mul_f32 v168,v168,v19
v_mul_f32 v169,v169,v19
v_mul_f32 v170,v170,v19
v_mul_f32 v171,v171,v19
v_cvt_pk_bf16_f32 v168,v168,v169
v_cvt_pk_bf16_f32 v169,v170,v171
buffer_store_dwordx2 v[168:169],v83,s[16:19],s41 offen offset:64
v_mul_f32 v172,v172,v19
v_mul_f32 v173,v173,v19
v_mul_f32 v174,v174,v19
v_mul_f32 v175,v175,v19
v_cvt_pk_bf16_f32 v172,v172,v173
v_cvt_pk_bf16_f32 v173,v174,v175
buffer_store_dwordx2 v[172:173],v83,s[16:19],s41 offen offset:96
v_mul_f32 v176,v176,v19
v_mul_f32 v177,v177,v19
v_mul_f32 v178,v178,v19
v_mul_f32 v179,v179,v19
v_cvt_pk_bf16_f32 v176,v176,v177
v_cvt_pk_bf16_f32 v177,v178,v179
buffer_store_dwordx2 v[176:177],v83,s[16:19],s41 offen offset:128
v_mul_f32 v180,v180,v19
v_mul_f32 v181,v181,v19
v_mul_f32 v182,v182,v19
v_mul_f32 v183,v183,v19
v_cvt_pk_bf16_f32 v180,v180,v181
v_cvt_pk_bf16_f32 v181,v182,v183
buffer_store_dwordx2 v[180:181],v83,s[16:19],s41 offen offset:160
v_mul_f32 v184,v184,v19
v_mul_f32 v185,v185,v19
v_mul_f32 v186,v186,v19
v_mul_f32 v187,v187,v19
v_cvt_pk_bf16_f32 v184,v184,v185
v_cvt_pk_bf16_f32 v185,v186,v187
buffer_store_dwordx2 v[184:185],v83,s[16:19],s41 offen offset:192
v_mul_f32 v188,v188,v19
v_mul_f32 v189,v189,v19
v_mul_f32 v190,v190,v19
v_mul_f32 v191,v191,v19
v_cvt_pk_bf16_f32 v188,v188,v189
v_cvt_pk_bf16_f32 v189,v190,v191
buffer_store_dwordx2 v[188:189],v83,s[16:19],s41 offen offset:224
v_mul_f32 v192,v192,v19
v_mul_f32 v193,v193,v19
v_mul_f32 v194,v194,v19
v_mul_f32 v195,v195,v19
v_cvt_pk_bf16_f32 v192,v192,v193
v_cvt_pk_bf16_f32 v193,v194,v195
buffer_store_dwordx2 v[192:193],v83,s[16:19],s41 offen offset:256
v_mul_f32 v196,v196,v19
v_mul_f32 v197,v197,v19
v_mul_f32 v198,v198,v19
v_mul_f32 v199,v199,v19
v_cvt_pk_bf16_f32 v196,v196,v197
v_cvt_pk_bf16_f32 v197,v198,v199
buffer_store_dwordx2 v[196:197],v83,s[16:19],s41 offen offset:288
v_mul_f32 v200,v200,v19
v_mul_f32 v201,v201,v19
v_mul_f32 v202,v202,v19
v_mul_f32 v203,v203,v19
v_cvt_pk_bf16_f32 v200,v200,v201
v_cvt_pk_bf16_f32 v201,v202,v203
buffer_store_dwordx2 v[200:201],v83,s[16:19],s41 offen offset:320
v_mul_f32 v204,v204,v19
v_mul_f32 v205,v205,v19
v_mul_f32 v206,v206,v19
v_mul_f32 v207,v207,v19
v_cvt_pk_bf16_f32 v204,v204,v205
v_cvt_pk_bf16_f32 v205,v206,v207
buffer_store_dwordx2 v[204:205],v83,s[16:19],s41 offen offset:352
s_waitcnt vmcnt(0)
s_add_u32 s41,s41,6144
s_add_u32 s51,s51,1
s_cmp_lt_u32 s51,s55
s_cbranch_scc1 L_fix_tile
s_cmp_lg_u32 s31,0
s_cbranch_scc1 L_fix_pass
s_branch L_done
L_codeend:
.section .rodata,"a"
.p2align 6
.amdhsa_kernel standalone__gqa_softmax__near_ridge_kernel
  .amdhsa_next_free_vgpr 512
  .amdhsa_next_free_sgpr 102
  .amdhsa_accum_offset 256
  .amdhsa_group_segment_fixed_size 0
  .amdhsa_kernarg_size 48
  .amdhsa_user_sgpr_count 2
  .amdhsa_user_sgpr_kernarg_segment_ptr 1
  .amdhsa_system_sgpr_workgroup_id_x 1
.end_amdhsa_kernel
```

```asm
; @launch grid=(256,1,1) block=(256,1,1) lds=163840
.amdgcn_target "amdgcn-amd-amdhsa--gfx950"
.text
.globl standalone__gqa_softmax__near_ridge_kernel
.p2align 8
.type standalone__gqa_softmax__near_ridge_kernel,@function
standalone__gqa_softmax__near_ridge_kernel:
s_cmp_ge_u32 s2,256
s_cbranch_scc1 L_end
s_load_dwordx4 s[84:87],s[0:1],0
s_load_dwordx4 s[88:91],s[0:1],16
v_lshrrev_b32 v80,6,v0
v_and_b32 v19,63,v0
v_readfirstlane_b32 s3,v80
s_lshr_b32 s34,s2,3
v_lshrrev_b32 v80,3,v19
v_and_b32 v82,7,v19
v_add_u32 v81,0,v80
v_mul_u32_u24 v81,43,v81
v_lshrrev_b32 v81,7,v81
v_and_b32 v81,6,v81
v_xor_b32 v81,v81,v82
v_lshlrev_b32 v81,4,v81
v_lshl_add_u32 v6,v80,7,v81
v_add_u32 v81,8,v80
v_mul_u32_u24 v81,43,v81
v_lshrrev_b32 v81,7,v81
v_and_b32 v81,6,v81
v_xor_b32 v81,v81,v82
v_lshlrev_b32 v81,4,v81
v_lshl_add_u32 v7,v80,7,v81
v_add_u32 v81,16,v80
v_mul_u32_u24 v81,43,v81
v_lshrrev_b32 v81,7,v81
v_and_b32 v81,6,v81
v_xor_b32 v81,v81,v82
v_lshlrev_b32 v81,4,v81
v_lshl_add_u32 v8,v80,7,v81
s_mov_b32 s37,0x21800000
s_mov_b32 s36,0x3dd53b95
s_mov_b32 s31,0
s_mov_b32 s32,1
s_and_b32 s62,s2,7
s_lshl_b32 s33,s62,6
s_mul_i32 s22,s3,3072
s_add_u32 s23,s22,36864
s_mul_i32 s24,s3,22528
s_add_u32 s24,s24,73728
s_mov_b32 s69,0
s_lshl_b32 s62,s69,5
s_add_u32 s62,s62,s34
s_mul_i32 s63,s62,171
s_lshr_b32 s63,s63,9
s_mul_i32 s64,s63,3
s_sub_u32 s62,s62,s64
s_add_u32 s63,s63,s33
s_mul_i32 s30,s63,196608
s_mul_i32 s41,s63,325632
s_lshl_b32 s63,s3,2
s_add_u32 s64,s63,21
s_cmp_eq_u32 s3,0
s_cselect_b32 s64,20,s64
s_cselect_b32 s40,1,0
s_add_u32 s65,s63,37
s_cmp_eq_u32 s62,2
s_cselect_b32 s64,s65,s64
s_cselect_b32 s40,0,s40
s_add_u32 s65,s63,s3
s_cmp_eq_u32 s62,0
s_cselect_b32 s64,s65,s64
s_cselect_b32 s40,1,s40
s_mul_i32 s64,s64,6144
s_add_u32 s41,s41,s64
s_add_u32 s20,s30,s22
s_mov_b32 s21,s20
s_waitcnt lgkmcnt(0)
s_mov_b32 s4,s86
s_and_b32 s5,s87,0xffff
s_mov_b32 s6,100663296
s_mov_b32 s7,0x20000
s_mov_b32 s12,s84
s_and_b32 s13,s85,0xffff
s_mov_b32 s14,166723584
s_mov_b32 s15,0x20000
s_mov_b32 s8,s88
s_and_b32 s9,s89,0xffff
s_mov_b32 s10,100663296
s_mov_b32 s11,0x20000
s_mov_b32 s16,s90
s_and_b32 s17,s91,0xffff
s_mov_b32 s18,166723584
s_mov_b32 s19,0x20000
s_mov_b32 s28,s41
s_add_u32 m0,s22,0
s_nop 0
buffer_load_dwordx4 v6,s[4:7],s20 offen offset:0 lds
buffer_load_dwordx4 v7,s[4:7],s20 offen offset:1024 lds
buffer_load_dwordx4 v8,s[4:7],s20 offen offset:2048 lds
s_add_u32 s20,s20,12288
s_add_u32 m0,s24,0
s_nop 0
buffer_load_dwordx4 v6,s[12:15],s28 offen offset:0 nt lds
buffer_load_dwordx4 v7,s[12:15],s28 offen offset:1024 nt lds
buffer_load_dwordx4 v8,s[12:15],s28 offen offset:2048 nt lds
s_add_u32 s28,s28,3072
s_add_u32 m0,s24,3072
s_nop 0
buffer_load_dwordx4 v6,s[12:15],s28 offen offset:0 nt lds
buffer_load_dwordx4 v7,s[12:15],s28 offen offset:1024 nt lds
buffer_load_dwordx4 v8,s[12:15],s28 offen offset:2048 nt lds
s_add_u32 s28,s28,3072
s_add_u32 m0,s22,12288
s_nop 0
buffer_load_dwordx4 v6,s[4:7],s20 offen offset:0 lds
buffer_load_dwordx4 v7,s[4:7],s20 offen offset:1024 lds
buffer_load_dwordx4 v8,s[4:7],s20 offen offset:2048 lds
s_add_u32 s20,s20,12288
s_add_u32 m0,s22,24576
s_nop 0
buffer_load_dwordx4 v6,s[4:7],s20 offen offset:0 lds
buffer_load_dwordx4 v7,s[4:7],s20 offen offset:1024 lds
buffer_load_dwordx4 v8,s[4:7],s20 offen offset:2048 lds
s_add_u32 s20,s20,12288
s_add_u32 m0,s23,0
s_nop 0
buffer_load_dwordx4 v6,s[8:11],s21 offen offset:0 lds
buffer_load_dwordx4 v7,s[8:11],s21 offen offset:1024 lds
buffer_load_dwordx4 v8,s[8:11],s21 offen offset:2048 lds
s_add_u32 s21,s21,12288
s_add_u32 m0,s24,6144
s_nop 0
buffer_load_dwordx4 v6,s[12:15],s28 offen offset:0 nt lds
buffer_load_dwordx4 v7,s[12:15],s28 offen offset:1024 nt lds
buffer_load_dwordx4 v8,s[12:15],s28 offen offset:2048 nt lds
s_add_u32 s28,s28,3072
s_add_u32 m0,s24,9216
s_nop 0
buffer_load_dwordx4 v6,s[12:15],s28 offen offset:0 nt lds
buffer_load_dwordx4 v7,s[12:15],s28 offen offset:1024 nt lds
buffer_load_dwordx4 v8,s[12:15],s28 offen offset:2048 nt lds
s_add_u32 s28,s28,3072
s_getpc_b64 s[46:47]
s_mul_i32 s62,s34,4096
s_mul_i32 s48,s3,1024
s_add_u32 s48,s48,s62
v_min_u32 v85,31,v19
v_lshlrev_b32 v85,7,v85
v_add_u32 v85,s62,v85
v_min_u32 v85,L_codeend-L_first-4,v85
s_cmp_lg_u32 s3,0
s_cbranch_scc1 L_nopre
global_load_dword v112,v85,s[46:47]
L_nopre:
v_and_b32 v80,15,v19
v_lshrrev_b32 v81,4,v19
v_mul_u32_u24 v0,384,v80
v_and_b32 v83,6,v80
v_xor_b32 v83,v83,v81
v_lshl_add_u32 v0,v83,4,v0
v_xor_b32 v1,64,v0
v_add_u32 v11,s24,v0
v_add_u32 v12,s24,v1
v_lshrrev_b32 v80,2,v19
v_mul_u32_u24 v2,384,v80
v_and_b32 v80,6,v80
v_bfe_u32 v83,v19,1,1
v_xor_b32 v80,v80,v83
v_lshl_add_u32 v2,v80,4,v2
v_and_b32 v83,1,v19
v_lshl_add_u32 v2,v83,3,v2
v_add_u32 v2,36864,v2
v_xor_b32 v3,32,v2
v_xor_b32 v4,64,v2
v_xor_b32 v5,96,v2
v_lshrrev_b32 v80,3,v19
v_and_b32 v81,7,v19
v_xor_b32 v83,v81,v80
v_lshl_add_u32 v10,v80,7,s24
v_lshl_add_u32 v10,v83,4,v10
v_mul_u32_u24 v9,384,v80
v_lshl_add_u32 v9,v81,4,v9
v_lshrrev_b32 v80,4,v19
v_xor_b32 v80,v80,v19
v_bfe_u32 v80,v80,1,1
v_subrev_u32 v80,1,v80
v_and_b32 v80,0x3f803f80,v80
v_accvgpr_write_b32 a152,v80
v_accvgpr_write_b32 a153,v80
v_accvgpr_write_b32 a154,v80
v_accvgpr_write_b32 a155,v80
v_and_b32 v80,1,v19
v_mul_u32_u24 v80,0xaaaa,v80
v_add_u32 v18,0x4444,v80
L_first:
s_waitcnt vmcnt(12)
s_barrier
s_cmp_eq_u32 s40,0
s_cbranch_scc1 L_start4
L_start5:
s_add_u32 m0,s24,12288
s_waitcnt vmcnt(15)
ds_read_b128 a[4:7],v12 offset:0
buffer_load_dwordx4 v6,s[12:15],s28 offen offset:0 nt lds
ds_read_b128 a[12:15],v12 offset:128
buffer_load_dwordx4 v7,s[12:15],s28 offen offset:1024 nt lds
ds_read_b128 a[0:3],v11 offset:0
buffer_load_dwordx4 v8,s[12:15],s28 offen offset:2048 nt lds
s_add_u32 s28,s28,3072
s_add_u32 m0,s24,15360
ds_read_b128 a[8:11],v11 offset:128
buffer_load_dwordx4 v6,s[12:15],s28 offen offset:0 nt lds
ds_read_b128 a[16:19],v11 offset:256
buffer_load_dwordx4 v7,s[12:15],s28 offen offset:1024 nt lds
ds_read_b128 a[20:23],v12 offset:256
buffer_load_dwordx4 v8,s[12:15],s28 offen offset:2048 nt lds
s_add_u32 s28,s28,3072
s_add_u32 m0,s24,0
ds_read_b128 a[124:127],v1 offset:0
v_mov_b32 v62,0
ds_read_b128 a[120:123],v0 offset:0
v_mov_b32 v63,0
ds_read_b128 a[132:135],v1 offset:128
v_mov_b32 v66,0
ds_read_b128 a[128:131],v0 offset:128
v_mov_b32 v64,0
ds_read_b128 a[136:139],v0 offset:256
v_mov_b32 v61,0
ds_read_b128 a[140:143],v1 offset:256
v_mov_b32 v70,0
ds_read_b128 a[144:147],v0 offset:6144
v_mov_b32 v65,0
ds_read_b128 a[148:151],v1 offset:6144
v_mov_b32 v67,0
v_mov_b32 v68,0
v_mov_b32 v60,0
v_mov_b32 v71,0
v_mov_b32 v69,0
s_waitcnt lgkmcnt(6)
v_mfma_f32_16x16x32_bf16 v[72:75],a[120:123],a[0:3],0
ds_read_b128 a[120:123],v0 offset:6272
v_mfma_f32_16x16x32_bf16 v[72:75],a[124:127],a[4:7],v[72:75]
s_waitcnt lgkmcnt(5)
ds_read_b128 a[124:127],v1 offset:6272
v_mfma_f32_16x16x32_bf16 v[72:75],a[128:131],a[8:11],v[72:75]
ds_read_b128 a[128:131],v0 offset:6400
v_mfma_f32_16x16x32_bf16 v[72:75],a[132:135],a[12:15],v[72:75]
s_waitcnt lgkmcnt(5)
ds_read_b128 a[132:135],v1 offset:6400
v_mfma_f32_16x16x32_bf16 v[72:75],a[136:139],a[16:19],v[72:75]
ds_read_b128 a[136:139],v0 offset:12288
v_mfma_f32_16x16x32_bf16 v[72:75],a[140:143],a[20:23],v[72:75]
s_waitcnt lgkmcnt(5)
ds_read_b128 a[140:143],v1 offset:12288
v_mfma_f32_16x16x32_bf16 v[76:79],a[144:147],a[0:3],0
ds_read_b128 a[144:147],v0 offset:12416
v_mfma_f32_16x16x32_bf16 v[76:79],a[148:151],a[4:7],v[76:79]
s_waitcnt lgkmcnt(6)
ds_read_b128 a[148:151],v1 offset:12416
v_mfma_f32_16x16x32_bf16 v[76:79],a[120:123],a[8:11],v[76:79]
s_waitcnt lgkmcnt(6)
ds_read_b128 a[120:123],v0 offset:12544
v_mfma_f32_16x16x32_bf16 v[76:79],a[124:127],a[12:15],v[76:79]
s_waitcnt lgkmcnt(6)
ds_read_b128 a[124:127],v1 offset:12544
v_max3_f32 v44,v72,v73,v74
v_mfma_f32_16x16x32_bf16 v[76:79],a[128:131],a[16:19],v[76:79]
s_waitcnt lgkmcnt(6)
ds_read_b128 a[128:131],v0 offset:18432
v_mfma_f32_16x16x32_bf16 v[76:79],a[132:135],a[20:23],v[76:79]
ds_read_b128 a[132:135],v1 offset:18432
s_nop 6
v_max3_f32 v44,v44,v75,v76
v_max3_f32 v44,v44,v77,v78
v_max_f32 v44,v44,v79
v_mov_b32 v45,v44
s_nop 1
v_permlane32_swap_b32 v45,v44
v_max_f32 v44,v44,v45
v_mov_b32 v45,v44
s_nop 1
v_permlane16_swap_b32 v45,v44
v_max_f32 v44,v44,v45
v_mul_f32_e64 v13,-s36,v44
v_fma_f32 v73,v73,s36,v13
v_exp_f32 v73,v73
v_fma_f32 v75,v75,s36,v13
v_exp_f32 v75,v75
v_fma_f32 v74,v74,s36,v13
v_exp_f32 v74,v74
v_fma_f32 v72,v72,s36,v13
v_exp_f32 v72,v72
v_cvt_pk_bf16_f32 v21,v74,v75
v_cvt_pk_bf16_f32 v20,v72,v73
s_waitcnt lgkmcnt(0)
v_mfma_f32_16x16x32_bf16 v[72:75],a[136:139],a[0:3],0
ds_read_b128 a[136:139],v0 offset:18560
v_fma_f32 v77,v77,s36,v13
v_mfma_f32_16x16x32_bf16 v[72:75],a[140:143],a[4:7],v[72:75]
ds_read_b128 a[140:143],v1 offset:18560
v_exp_f32 v77,v77
v_mfma_f32_16x16x32_bf16 v[72:75],a[144:147],a[8:11],v[72:75]
ds_read_b128 a[144:147],v0 offset:18688
v_fma_f32 v76,v76,s36,v13
v_mfma_f32_16x16x32_bf16 v[72:75],a[148:151],a[12:15],v[72:75]
ds_read_b128 a[148:151],v1 offset:18688
v_exp_f32 v76,v76
v_mfma_f32_16x16x32_bf16 v[72:75],a[120:123],a[16:19],v[72:75]
v_fma_f32 v79,v79,s36,v13
v_exp_f32 v79,v79
v_mfma_f32_16x16x32_bf16 v[72:75],a[124:127],a[20:23],v[72:75]
v_fma_f32 v78,v78,s36,v13
v_exp_f32 v78,v78
v_cvt_pk_bf16_f32 v22,v76,v77
v_cvt_pk_bf16_f32 v23,v78,v79
v_mfma_f32_16x16x32_bf16 v[76:79],a[128:131],a[0:3],0
v_mfma_f32_16x16x32_bf16 v[76:79],a[132:135],a[4:7],v[76:79]
s_waitcnt lgkmcnt(2)
v_mfma_f32_16x16x32_bf16 v[76:79],a[136:139],a[8:11],v[76:79]
v_mfma_f32_16x16x32_bf16 v[76:79],a[140:143],a[12:15],v[76:79]
s_waitcnt lgkmcnt(0)
v_fma_f32 v73,v73,s36,v13
v_fma_f32 v74,v74,s36,v13
v_mfma_f32_16x16x32_bf16 v[76:79],a[144:147],a[16:19],v[76:79]
v_exp_f32 v74,v74
v_mfma_f32_16x16x32_bf16 v[76:79],a[148:151],a[20:23],v[76:79]
s_waitcnt vmcnt(12)
s_barrier
ds_read_b64_tr_b16 a[120:121],v2 offset:0
ds_read_b64_tr_b16 a[122:123],v2 offset:6144
ds_read_b64_tr_b16 a[126:127],v3 offset:6144
ds_read_b64_tr_b16 a[124:125],v3 offset:0
ds_read_b64_tr_b16 a[136:137],v2 offset:128
ds_read_b64_tr_b16 a[132:133],v5 offset:0
ds_read_b64_tr_b16 a[130:131],v4 offset:6144
ds_read_b64_tr_b16 a[140:141],v3 offset:128
ds_read_b64_tr_b16 a[138:139],v2 offset:6272
ds_read_b64_tr_b16 a[134:135],v5 offset:6144
ds_read_b64_tr_b16 a[144:145],v4 offset:128
ds_read_b64_tr_b16 a[128:129],v4 offset:0
ds_read_b64_tr_b16 a[148:149],v5 offset:128
ds_read_b64_tr_b16 a[146:147],v4 offset:6272
ds_read_b64_tr_b16 a[142:143],v3 offset:6272
ds_read_b64_tr_b16 a[150:151],v5 offset:6272
v_fma_f32 v75,v75,s36,v13
s_waitcnt lgkmcnt(14)
v_mfma_f32_16x16x32_bf16 v[160:163],a[120:123],v[20:23],0
s_waitcnt lgkmcnt(12)
ds_read_b64_tr_b16 a[122:123],v2 offset:6400
v_exp_f32 v75,v75
v_mfma_f32_16x16x32_bf16 v[164:167],a[124:127],v[20:23],0
ds_read_b64_tr_b16 a[126:127],v3 offset:6400
ds_read_b64_tr_b16 a[120:121],v2 offset:256
ds_read_b64_tr_b16 a[124:125],v3 offset:256
v_fma_f32 v72,v72,s36,v13
v_exp_f32 v72,v72
v_exp_f32 v73,v73
v_cvt_pk_bf16_f32 v45,v74,v75
v_cvt_pk_bf16_f32 v44,v72,v73
v_fma_f32 v76,v76,s36,v13
s_waitcnt lgkmcnt(8)
v_mfma_f32_16x16x32_bf16 v[168:171],a[128:131],v[20:23],0
ds_read_b64_tr_b16 a[128:129],v4 offset:256
v_fma_f32 v79,v79,s36,v13
v_mfma_f32_16x16x32_bf16 v[172:175],a[132:135],v[20:23],0
ds_read_b64_tr_b16 a[132:133],v5 offset:256
v_exp_f32 v79,v79
v_mfma_f32_16x16x32_bf16 v[176:179],a[136:139],v[20:23],0
s_waitcnt lgkmcnt(5)
ds_read_b64_tr_b16 a[130:131],v4 offset:6400
v_fma_f32 v78,v78,s36,v13
v_mfma_f32_16x16x32_bf16 v[180:183],a[140:143],v[20:23],0
ds_read_b128 a[140:143],v1 offset:24576
v_exp_f32 v78,v78
v_mfma_f32_16x16x32_bf16 v[184:187],a[144:147],v[20:23],0
ds_read_b64_tr_b16 a[134:135],v5 offset:6400
v_cvt_pk_bf16_f32 v47,v78,v79
v_mfma_f32_16x16x32_bf16 v[188:191],a[148:151],v[20:23],0
s_waitcnt lgkmcnt(5)
ds_read_b128 a[136:139],v0 offset:24576
v_fma_f32 v77,v77,s36,v13
v_mfma_f32_16x16x32_bf16 v[192:195],a[120:123],v[20:23],0
ds_read_b128 a[120:123],v0 offset:24832
v_exp_f32 v77,v77
v_mfma_f32_16x16x32_bf16 v[196:199],a[124:127],v[20:23],0
ds_read_b128 a[144:147],v0 offset:24704
v_exp_f32 v76,v76
ds_read_b128 a[148:151],v1 offset:24704
v_cvt_pk_bf16_f32 v46,v76,v77
s_waitcnt lgkmcnt(6)
v_mfma_f32_16x16x32_bf16 v[200:203],a[128:131],v[20:23],0
s_waitcnt lgkmcnt(4)
ds_read_b128 a[128:131],v0 offset:30720
ds_read_b128 a[124:127],v1 offset:24832
v_mfma_f32_16x16x32_bf16 v[204:207],a[132:135],v[20:23],0
s_waitcnt lgkmcnt(5)
ds_read_b128 a[132:135],v1 offset:30720
v_mfma_f32_16x16x32_bf16 v[72:75],a[136:139],a[0:3],0
ds_read_b128 a[136:139],v0 offset:30848
v_mfma_f32_16x16x32_bf16 v[72:75],a[140:143],a[4:7],v[72:75]
s_waitcnt lgkmcnt(5)
ds_read_b128 a[140:143],v1 offset:30848
v_mfma_f32_16x16x32_bf16 v[72:75],a[144:147],a[8:11],v[72:75]
s_waitcnt lgkmcnt(5)
ds_read_b128 a[144:147],v0 offset:30976
v_mfma_f32_16x16x32_bf16 v[72:75],a[148:151],a[12:15],v[72:75]
ds_read_b128 a[148:151],v1 offset:30976
v_mfma_f32_16x16x32_bf16 v[72:75],a[120:123],a[16:19],v[72:75]
s_waitcnt lgkmcnt(5)
ds_read_b128 a[120:123],v0 offset:0
v_mfma_f32_16x16x32_bf16 v[72:75],a[124:127],a[20:23],v[72:75]
ds_read_b128 a[124:127],v1 offset:0
v_mfma_f32_16x16x32_bf16 v[76:79],a[128:131],a[0:3],0
s_waitcnt lgkmcnt(6)
ds_read_b128 a[128:131],v0 offset:128
v_mfma_f32_16x16x32_bf16 v[76:79],a[132:135],a[4:7],v[76:79]
s_waitcnt lgkmcnt(6)
ds_read_b128 a[132:135],v1 offset:128
v_mfma_f32_16x16x32_bf16 v[76:79],a[136:139],a[8:11],v[76:79]
s_waitcnt lgkmcnt(6)
ds_read_b128 a[136:139],v0 offset:256
v_mfma_f32_16x16x32_bf16 v[76:79],a[140:143],a[12:15],v[76:79]
s_waitcnt lgkmcnt(6)
ds_read_b128 a[140:143],v1 offset:256
v_fma_f32 v72,v72,s36,v13
v_mfma_f32_16x16x32_bf16 v[76:79],a[144:147],a[16:19],v[76:79]
s_waitcnt lgkmcnt(6)
ds_read_b128 a[144:147],v0 offset:6144
v_exp_f32 v72,v72
v_mfma_f32_16x16x32_bf16 v[76:79],a[148:151],a[20:23],v[76:79]
s_waitcnt vmcnt(6)
ds_read_b128 a[28:31],v12 offset:6144
buffer_load_dwordx4 v6,s[12:15],s28 offen offset:0 nt lds
ds_read_b128 a[24:27],v11 offset:6144
buffer_load_dwordx4 v7,s[12:15],s28 offen offset:1024 nt lds
ds_read_b128 a[32:35],v11 offset:6272
buffer_load_dwordx4 v8,s[12:15],s28 offen offset:2048 nt lds
s_add_u32 s28,s28,3072
s_add_u32 m0,s24,3072
ds_read_b128 a[40:43],v11 offset:6400
buffer_load_dwordx4 v6,s[12:15],s28 offen offset:0 nt lds
ds_read_b128 a[36:39],v12 offset:6272
buffer_load_dwordx4 v7,s[12:15],s28 offen offset:1024 nt lds
ds_read_b128 a[44:47],v12 offset:6400
buffer_load_dwordx4 v8,s[12:15],s28 offen offset:2048 nt lds
s_add_u32 s28,s28,3072
s_add_u32 m0,s24,6144
ds_read_b128 a[148:151],v1 offset:6144
v_fma_f32 v75,v75,s36,v13
v_exp_f32 v75,v75
v_fma_f32 v74,v74,s36,v13
v_exp_f32 v74,v74
s_waitcnt lgkmcnt(5)
v_mfma_f32_16x16x32_bf16 v[80:83],a[120:123],a[24:27],0
ds_read_b128 a[120:123],v0 offset:6272
v_fma_f32 v73,v73,s36,v13
v_mfma_f32_16x16x32_bf16 v[80:83],a[124:127],a[28:31],v[80:83]
s_waitcnt lgkmcnt(4)
ds_read_b128 a[124:127],v1 offset:6272
v_exp_f32 v73,v73
v_mfma_f32_16x16x32_bf16 v[80:83],a[128:131],a[32:35],v[80:83]
s_waitcnt lgkmcnt(4)
ds_read_b128 a[128:131],v0 offset:6400
v_mfma_f32_16x16x32_bf16 v[80:83],a[132:135],a[36:39],v[80:83]
ds_read_b128 a[132:135],v1 offset:6400
v_mfma_f32_16x16x32_bf16 v[80:83],a[136:139],a[40:43],v[80:83]
s_waitcnt lgkmcnt(4)
ds_read_b128 a[136:139],v0 offset:12288
v_mfma_f32_16x16x32_bf16 v[80:83],a[140:143],a[44:47],v[80:83]
ds_read_b128 a[140:143],v1 offset:12288
v_mfma_f32_16x16x32_bf16 v[84:87],a[144:147],a[24:27],0
ds_read_b128 a[144:147],v0 offset:12416
v_mfma_f32_16x16x32_bf16 v[84:87],a[148:151],a[28:31],v[84:87]
s_waitcnt lgkmcnt(6)
ds_read_b128 a[148:151],v1 offset:12416
v_mfma_f32_16x16x32_bf16 v[84:87],a[120:123],a[32:35],v[84:87]
s_waitcnt lgkmcnt(6)
ds_read_b128 a[120:123],v0 offset:12544
v_mfma_f32_16x16x32_bf16 v[84:87],a[124:127],a[36:39],v[84:87]
s_waitcnt lgkmcnt(6)
ds_read_b128 a[124:127],v1 offset:12544
v_max3_f32 v48,v80,v81,v82
v_mfma_f32_16x16x32_bf16 v[84:87],a[128:131],a[40:43],v[84:87]
s_waitcnt lgkmcnt(6)
ds_read_b128 a[128:131],v0 offset:18432
v_mfma_f32_16x16x32_bf16 v[84:87],a[132:135],a[44:47],v[84:87]
ds_read_b128 a[132:135],v1 offset:18432
s_nop 6
v_max3_f32 v48,v48,v83,v84
v_max3_f32 v48,v48,v85,v86
v_max_f32 v48,v48,v87
v_mov_b32 v49,v48
s_nop 1
v_permlane32_swap_b32 v49,v48
v_max_f32 v48,v48,v49
v_mov_b32 v49,v48
s_nop 1
v_permlane16_swap_b32 v49,v48
v_max_f32 v48,v48,v49
v_mul_f32_e64 v14,-s36,v48
v_fma_f32 v80,v80,s36,v14
v_fma_f32 v83,v83,s36,v14
v_fma_f32 v82,v82,s36,v14
v_fma_f32 v81,v81,s36,v14
v_exp_f32 v81,v81
v_exp_f32 v80,v80
v_exp_f32 v83,v83
v_exp_f32 v82,v82
v_fma_f32 v87,v87,s36,v14
v_cvt_pk_bf16_f32 v25,v82,v83
v_cvt_pk_bf16_f32 v24,v80,v81
s_waitcnt lgkmcnt(0)
v_mfma_f32_16x16x32_bf16 v[80:83],a[136:139],a[24:27],0
ds_read_b128 a[136:139],v0 offset:18560
v_fma_f32 v86,v86,s36,v14
v_mfma_f32_16x16x32_bf16 v[80:83],a[140:143],a[28:31],v[80:83]
ds_read_b128 a[140:143],v1 offset:18560
v_exp_f32 v86,v86
v_mfma_f32_16x16x32_bf16 v[80:83],a[144:147],a[32:35],v[80:83]
ds_read_b128 a[144:147],v0 offset:18688
v_fma_f32 v84,v84,s36,v14
v_mfma_f32_16x16x32_bf16 v[80:83],a[148:151],a[36:39],v[80:83]
ds_read_b128 a[148:151],v1 offset:18688
v_exp_f32 v87,v87
v_mfma_f32_16x16x32_bf16 v[80:83],a[120:123],a[40:43],v[80:83]
ds_read_b64_tr_b16 a[120:121],v2 offset:0
v_cvt_pk_bf16_f32 v27,v86,v87
v_mfma_f32_16x16x32_bf16 v[80:83],a[124:127],a[44:47],v[80:83]
ds_read_b64_tr_b16 a[126:127],v3 offset:6144
ds_read_b64_tr_b16 a[124:125],v3 offset:0
ds_read_b64_tr_b16 a[122:123],v2 offset:6144
v_exp_f32 v84,v84
v_fma_f32 v85,v85,s36,v14
v_exp_f32 v85,v85
s_nop 0
v_cvt_pk_bf16_f32 v26,v84,v85
v_mfma_f32_16x16x32_bf16 v[84:87],a[128:131],a[24:27],0
ds_read_b64_tr_b16 a[128:129],v4 offset:0
v_fma_f32 v80,v80,s36,v14
v_smfmac_f32_16x16x64_bf16 v[60:63],a[152:155],v[20:27],v18
ds_read_b64_tr_b16 a[130:131],v4 offset:6144
v_mfma_f32_16x16x32_bf16 v[84:87],a[132:135],a[28:31],v[84:87]
s_waitcnt lgkmcnt(6)
ds_read_b64_tr_b16 a[134:135],v5 offset:6144
v_fma_f32 v81,v81,s36,v14
v_mfma_f32_16x16x32_bf16 v[84:87],a[136:139],a[32:35],v[84:87]
ds_read_b64_tr_b16 a[138:139],v2 offset:6272
v_exp_f32 v81,v81
v_mfma_f32_16x16x32_bf16 v[84:87],a[140:143],a[36:39],v[84:87]
ds_read_b64_tr_b16 a[132:133],v5 offset:0
v_exp_f32 v80,v80
v_mfma_f32_16x16x32_bf16 v[84:87],a[144:147],a[40:43],v[84:87]
ds_read_b64_tr_b16 a[136:137],v2 offset:128
v_cvt_pk_bf16_f32 v48,v80,v81
v_mfma_f32_16x16x32_bf16 v[84:87],a[148:151],a[44:47],v[84:87]
s_waitcnt lgkmcnt(6)
ds_read_b64_tr_b16 a[150:151],v5 offset:6272
v_fma_f32 v82,v82,s36,v14
v_mfma_f32_16x16x32_bf16 v[208:211],a[120:123],v[24:27],0
ds_read_b64_tr_b16 a[142:143],v3 offset:6272
v_exp_f32 v82,v82
v_mfma_f32_16x16x32_bf16 v[212:215],a[124:127],v[24:27],0
s_waitcnt lgkmcnt(5)
ds_read_b64_tr_b16 a[120:121],v2 offset:256
v_fma_f32 v83,v83,s36,v14
v_mfma_f32_16x16x32_bf16 v[216:219],a[128:131],v[24:27],0
ds_read_b64_tr_b16 a[146:147],v4 offset:6272
ds_read_b64_tr_b16 a[148:149],v5 offset:128
ds_read_b64_tr_b16 a[140:141],v3 offset:128
ds_read_b64_tr_b16 a[144:145],v4 offset:128
v_exp_f32 v83,v83
s_waitcnt lgkmcnt(8)
v_mfma_f32_16x16x32_bf16 v[220:223],a[132:135],v[24:27],0
s_waitcnt lgkmcnt(7)
ds_read_b64_tr_b16 a[122:123],v2 offset:6400
v_cvt_pk_bf16_f32 v49,v82,v83
v_mfma_f32_16x16x32_bf16 v[224:227],a[136:139],v[24:27],0
ds_read_b64_tr_b16 a[132:133],v5 offset:256
ds_read_b64_tr_b16 a[134:135],v5 offset:6400
ds_read_b64_tr_b16 a[126:127],v3 offset:6400
ds_read_b64_tr_b16 a[130:131],v4 offset:6400
ds_read_b64_tr_b16 a[124:125],v3 offset:256
ds_read_b64_tr_b16 a[128:129],v4 offset:256
ds_read_b128 a[136:139],v0 offset:24576
v_fma_f32 v86,v86,s36,v14
v_fma_f32 v87,v87,s36,v14
v_exp_f32 v87,v87
v_fma_f32 v85,v85,s36,v14
v_exp_f32 v85,v85
s_waitcnt lgkmcnt(9)
v_mfma_f32_16x16x32_bf16 v[228:231],a[140:143],v[24:27],0
s_waitcnt lgkmcnt(8)
ds_read_b128 a[140:143],v1 offset:24576
v_fma_f32 v84,v84,s36,v14
v_mfma_f32_16x16x32_bf16 v[232:235],a[144:147],v[24:27],0
ds_read_b128 a[144:147],v0 offset:24704
v_exp_f32 v84,v84
v_mfma_f32_16x16x32_bf16 v[236:239],a[148:151],v[24:27],0
s_waitcnt lgkmcnt(9)
ds_read_b128 a[148:151],v1 offset:24704
v_cvt_pk_bf16_f32 v50,v84,v85
v_mfma_f32_16x16x32_bf16 v[240:243],a[120:123],v[24:27],0
s_waitcnt lgkmcnt(4)
ds_read_b128 a[120:123],v0 offset:24832
v_exp_f32 v86,v86
v_mfma_f32_16x16x32_bf16 v[244:247],a[124:127],v[24:27],0
ds_read_b128 a[124:127],v1 offset:24832
v_cvt_pk_bf16_f32 v51,v86,v87
v_mfma_f32_16x16x32_bf16 v[248:251],a[128:131],v[24:27],0
ds_read_b128 a[128:131],v0 offset:30720
v_cvt_pk_bf16_f32 v20,v72,v73
v_smfmac_f32_16x16x64_bf16 v[60:63],a[152:155],v[44:51],v18
v_cvt_pk_bf16_f32 v21,v74,v75
v_mfma_f32_16x16x32_bf16 v[252:255],a[132:135],v[24:27],0
s_waitcnt lgkmcnt(4)
ds_read_b128 a[132:135],v1 offset:30720
v_mfma_f32_16x16x32_bf16 v[80:83],a[136:139],a[24:27],0
ds_read_b128 a[136:139],v0 offset:30848
v_mfma_f32_16x16x32_bf16 v[80:83],a[140:143],a[28:31],v[80:83]
ds_read_b128 a[140:143],v1 offset:30848
v_mfma_f32_16x16x32_bf16 v[80:83],a[144:147],a[32:35],v[80:83]
s_waitcnt lgkmcnt(5)
ds_read_b128 a[144:147],v0 offset:30976
v_mfma_f32_16x16x32_bf16 v[80:83],a[148:151],a[36:39],v[80:83]
ds_read_b128 a[148:151],v1 offset:30976
v_mfma_f32_16x16x32_bf16 v[80:83],a[120:123],a[40:43],v[80:83]
s_waitcnt lgkmcnt(5)
ds_read_b128 a[120:123],v0 offset:0
v_mfma_f32_16x16x32_bf16 v[80:83],a[124:127],a[44:47],v[80:83]
ds_read_b128 a[124:127],v1 offset:0
v_mfma_f32_16x16x32_bf16 v[84:87],a[128:131],a[24:27],0
s_waitcnt lgkmcnt(6)
ds_read_b128 a[128:131],v0 offset:128
v_mfma_f32_16x16x32_bf16 v[84:87],a[132:135],a[28:31],v[84:87]
s_waitcnt lgkmcnt(6)
ds_read_b128 a[132:135],v1 offset:128
v_mfma_f32_16x16x32_bf16 v[84:87],a[136:139],a[32:35],v[84:87]
s_waitcnt lgkmcnt(6)
ds_read_b128 a[136:139],v0 offset:256
v_mfma_f32_16x16x32_bf16 v[84:87],a[140:143],a[36:39],v[84:87]
s_waitcnt lgkmcnt(6)
ds_read_b128 a[140:143],v1 offset:256
v_fma_f32 v82,v82,s36,v14
v_mfma_f32_16x16x32_bf16 v[84:87],a[144:147],a[40:43],v[84:87]
s_waitcnt lgkmcnt(6)
ds_read_b128 a[144:147],v0 offset:6144
v_fma_f32 v81,v81,s36,v14
v_mfma_f32_16x16x32_bf16 v[84:87],a[148:151],a[44:47],v[84:87]
s_waitcnt vmcnt(6)
ds_read_b128 a[48:51],v11 offset:12288
buffer_load_dwordx4 v6,s[12:15],s28 offen offset:0 nt lds
ds_read_b128 a[64:67],v11 offset:12544
buffer_load_dwordx4 v7,s[12:15],s28 offen offset:1024 nt lds
ds_read_b128 a[60:63],v12 offset:12416
buffer_load_dwordx4 v8,s[12:15],s28 offen offset:2048 nt lds
s_add_u32 s28,s28,3072
s_add_u32 m0,s24,9216
ds_read_b128 a[52:55],v12 offset:12288
buffer_load_dwordx4 v6,s[12:15],s28 offen offset:0 nt lds
ds_read_b128 a[68:71],v12 offset:12544
buffer_load_dwordx4 v7,s[12:15],s28 offen offset:1024 nt lds
ds_read_b128 a[56:59],v11 offset:12416
buffer_load_dwordx4 v8,s[12:15],s28 offen offset:2048 nt lds
s_add_u32 s28,s28,3072
s_add_u32 m0,s23,12288
ds_read_b128 a[148:151],v1 offset:6144
v_exp_f32 v82,v82
s_waitcnt lgkmcnt(6)
v_mfma_f32_16x16x32_bf16 v[88:91],a[120:123],a[48:51],0
ds_read_b128 a[120:123],v0 offset:6272
v_fma_f32 v80,v80,s36,v14
v_exp_f32 v81,v81
v_exp_f32 v80,v80
v_fma_f32 v83,v83,s36,v14
v_exp_f32 v83,v83
v_cvt_pk_bf16_f32 v24,v80,v81
v_cvt_pk_bf16_f32 v25,v82,v83
s_waitcnt lgkmcnt(4)
v_mfma_f32_16x16x32_bf16 v[88:91],a[124:127],a[52:55],v[88:91]
s_waitcnt lgkmcnt(2)
ds_read_b128 a[124:127],v1 offset:6272
v_mfma_f32_16x16x32_bf16 v[88:91],a[128:131],a[56:59],v[88:91]
ds_read_b128 a[128:131],v0 offset:6400
v_mfma_f32_16x16x32_bf16 v[88:91],a[132:135],a[60:63],v[88:91]
ds_read_b128 a[132:135],v1 offset:6400
v_mfma_f32_16x16x32_bf16 v[88:91],a[136:139],a[64:67],v[88:91]
ds_read_b128 a[136:139],v0 offset:12288
v_mfma_f32_16x16x32_bf16 v[88:91],a[140:143],a[68:71],v[88:91]
ds_read_b128 a[140:143],v1 offset:12288
v_mfma_f32_16x16x32_bf16 v[92:95],a[144:147],a[48:51],0
s_waitcnt lgkmcnt(5)
ds_read_b128 a[144:147],v0 offset:12416
v_mfma_f32_16x16x32_bf16 v[92:95],a[148:151],a[52:55],v[92:95]
ds_read_b128 a[148:151],v1 offset:12416
v_mfma_f32_16x16x32_bf16 v[92:95],a[120:123],a[56:59],v[92:95]
s_waitcnt lgkmcnt(6)
ds_read_b128 a[120:123],v0 offset:12544
v_mfma_f32_16x16x32_bf16 v[92:95],a[124:127],a[60:63],v[92:95]
s_waitcnt lgkmcnt(6)
ds_read_b128 a[124:127],v1 offset:12544
v_max3_f32 v52,v88,v89,v90
v_mfma_f32_16x16x32_bf16 v[92:95],a[128:131],a[64:67],v[92:95]
s_waitcnt lgkmcnt(6)
ds_read_b128 a[128:131],v0 offset:18432
v_mfma_f32_16x16x32_bf16 v[92:95],a[132:135],a[68:71],v[92:95]
ds_read_b128 a[132:135],v1 offset:18432
s_nop 6
v_max3_f32 v52,v52,v91,v92
v_max3_f32 v52,v52,v93,v94
v_max_f32 v52,v52,v95
v_mov_b32 v53,v52
s_nop 1
v_permlane32_swap_b32 v53,v52
v_max_f32 v52,v52,v53
v_mov_b32 v53,v52
s_nop 1
v_permlane16_swap_b32 v53,v52
v_max_f32 v52,v52,v53
v_mul_f32_e64 v15,-s36,v52
v_fma_f32 v89,v89,s36,v15
v_fma_f32 v88,v88,s36,v15
v_exp_f32 v88,v88
v_exp_f32 v89,v89
v_fma_f32 v90,v90,s36,v15
v_exp_f32 v90,v90
v_cvt_pk_bf16_f32 v28,v88,v89
v_fma_f32 v91,v91,s36,v15
v_exp_f32 v91,v91
v_fma_f32 v95,v95,s36,v15
v_cvt_pk_bf16_f32 v29,v90,v91
s_waitcnt lgkmcnt(0)
v_mfma_f32_16x16x32_bf16 v[88:91],a[136:139],a[48:51],0
ds_read_b128 a[136:139],v0 offset:18560
v_fma_f32 v93,v93,s36,v15
v_mfma_f32_16x16x32_bf16 v[88:91],a[140:143],a[52:55],v[88:91]
ds_read_b128 a[140:143],v1 offset:18560
v_exp_f32 v93,v93
v_mfma_f32_16x16x32_bf16 v[88:91],a[144:147],a[56:59],v[88:91]
ds_read_b128 a[144:147],v0 offset:18688
v_fma_f32 v92,v92,s36,v15
v_mfma_f32_16x16x32_bf16 v[88:91],a[148:151],a[60:63],v[88:91]
ds_read_b128 a[148:151],v1 offset:18688
v_fma_f32 v94,v94,s36,v15
v_mfma_f32_16x16x32_bf16 v[88:91],a[120:123],a[64:67],v[88:91]
ds_read_b64_tr_b16 a[120:121],v2 offset:0
v_exp_f32 v94,v94
v_mfma_f32_16x16x32_bf16 v[88:91],a[124:127],a[68:71],v[88:91]
ds_read_b64_tr_b16 a[124:125],v3 offset:0
ds_read_b64_tr_b16 a[126:127],v3 offset:6144
ds_read_b64_tr_b16 a[122:123],v2 offset:6144
v_exp_f32 v92,v92
v_exp_f32 v95,v95
v_cvt_pk_bf16_f32 v30,v92,v93
v_cvt_pk_bf16_f32 v31,v94,v95
v_mfma_f32_16x16x32_bf16 v[92:95],a[128:131],a[48:51],0
ds_read_b64_tr_b16 a[130:131],v4 offset:6144
v_fma_f32 v90,v90,s36,v15
v_mfma_f32_16x16x32_bf16 v[92:95],a[132:135],a[52:55],v[92:95]
s_waitcnt lgkmcnt(6)
ds_read_b64_tr_b16 a[128:129],v4 offset:0
v_exp_f32 v90,v90
v_mfma_f32_16x16x32_bf16 v[92:95],a[136:139],a[56:59],v[92:95]
ds_read_b64_tr_b16 a[132:133],v5 offset:0
v_fma_f32 v89,v89,s36,v15
v_mfma_f32_16x16x32_bf16 v[92:95],a[140:143],a[60:63],v[92:95]
ds_read_b64_tr_b16 a[140:141],v3 offset:128
v_exp_f32 v89,v89
v_mfma_f32_16x16x32_bf16 v[92:95],a[144:147],a[64:67],v[92:95]
s_waitcnt lgkmcnt(4)
ds_read_b64_tr_b16 a[138:139],v2 offset:6272
v_fma_f32 v88,v88,s36,v15
v_mfma_f32_16x16x32_bf16 v[92:95],a[148:151],a[68:71],v[92:95]
ds_read_b64_tr_b16 a[134:135],v5 offset:6144
v_exp_f32 v88,v88
v_mfma_f32_16x16x32_bf16 v[112:115],a[120:123],v[28:31],0
ds_read_b64_tr_b16 a[150:151],v5 offset:6272
v_cvt_pk_bf16_f32 v52,v88,v89
v_mfma_f32_16x16x32_bf16 v[116:119],a[124:127],v[28:31],0
s_waitcnt lgkmcnt(5)
ds_read_b64_tr_b16 a[146:147],v4 offset:6272
ds_read_b64_tr_b16 a[136:137],v2 offset:128
ds_read_b64_tr_b16 a[142:143],v3 offset:6272
v_mfma_f32_16x16x32_bf16 v[120:123],a[128:131],v[28:31],0
ds_read_b64_tr_b16 a[148:149],v5 offset:128
ds_read_b64_tr_b16 a[126:127],v3 offset:6400
ds_read_b64_tr_b16 a[144:145],v4 offset:128
ds_read_b64_tr_b16 a[122:123],v2 offset:6400
ds_read_b64_tr_b16 a[128:129],v4 offset:256
ds_read_b64_tr_b16 a[130:131],v4 offset:6400
ds_read_b64_tr_b16 a[120:121],v2 offset:256
v_fma_f32 v91,v91,s36,v15
ds_read_b64_tr_b16 a[124:125],v3 offset:256
s_waitcnt lgkmcnt(12)
v_mfma_f32_16x16x32_bf16 v[124:127],a[132:135],v[28:31],0
ds_read_b64_tr_b16 a[134:135],v5 offset:6400
ds_read_b64_tr_b16 a[132:133],v5 offset:256
v_exp_f32 v91,v91
v_fma_f32 v94,v94,s36,v15
s_waitcnt lgkmcnt(11)
v_mfma_f32_16x16x32_bf16 v[128:131],a[136:139],v[28:31],0
s_waitcnt lgkmcnt(10)
ds_read_b128 a[136:139],v0 offset:24576
v_cvt_pk_bf16_f32 v53,v90,v91
v_mfma_f32_16x16x32_bf16 v[132:135],a[140:143],v[28:31],0
s_waitcnt lgkmcnt(8)
ds_read_b128 a[140:143],v1 offset:24576
v_exp_f32 v94,v94
v_mfma_f32_16x16x32_bf16 v[136:139],a[144:147],v[28:31],0
ds_read_b128 a[144:147],v0 offset:24704
v_fma_f32 v93,v93,s36,v15
v_mfma_f32_16x16x32_bf16 v[140:143],a[148:151],v[28:31],0
s_waitcnt lgkmcnt(5)
ds_read_b128 a[148:151],v1 offset:24704
v_exp_f32 v93,v93
v_mfma_f32_16x16x32_bf16 v[144:147],a[120:123],v[28:31],0
ds_read_b128 a[120:123],v0 offset:24832
v_fma_f32 v95,v95,s36,v15
v_mfma_f32_16x16x32_bf16 v[148:151],a[124:127],v[28:31],0
ds_read_b128 a[124:127],v1 offset:24832
v_exp_f32 v95,v95
v_mfma_f32_16x16x32_bf16 v[152:155],a[128:131],v[28:31],0
s_waitcnt lgkmcnt(5)
ds_read_b128 a[128:131],v0 offset:30720
v_fma_f32 v92,v92,s36,v15
v_mfma_f32_16x16x32_bf16 v[156:159],a[132:135],v[28:31],0
ds_read_b128 a[132:135],v1 offset:30720
v_exp_f32 v92,v92
v_mfma_f32_16x16x32_bf16 v[88:91],a[136:139],a[48:51],0
s_waitcnt lgkmcnt(5)
ds_read_b128 a[136:139],v0 offset:30848
v_cvt_pk_bf16_f32 v54,v92,v93
v_mfma_f32_16x16x32_bf16 v[88:91],a[140:143],a[52:55],v[88:91]
ds_read_b128 a[140:143],v1 offset:30848
v_cvt_pk_bf16_f32 v55,v94,v95
v_mfma_f32_16x16x32_bf16 v[88:91],a[144:147],a[56:59],v[88:91]
s_waitcnt lgkmcnt(5)
ds_read_b128 a[144:147],v0 offset:30976
v_mfma_f32_16x16x32_bf16 v[88:91],a[148:151],a[60:63],v[88:91]
ds_read_b128 a[148:151],v1 offset:30976
v_mfma_f32_16x16x32_bf16 v[88:91],a[120:123],a[64:67],v[88:91]
s_waitcnt lgkmcnt(6)
ds_read_b128 a[120:123],v0 offset:0
v_mfma_f32_16x16x32_bf16 v[88:91],a[124:127],a[68:71],v[88:91]
s_waitcnt lgkmcnt(6)
ds_read_b128 a[124:127],v1 offset:0
v_mfma_f32_16x16x32_bf16 v[92:95],a[128:131],a[48:51],0
s_waitcnt lgkmcnt(6)
ds_read_b128 a[128:131],v0 offset:128
v_mfma_f32_16x16x32_bf16 v[92:95],a[132:135],a[52:55],v[92:95]
s_waitcnt lgkmcnt(6)
ds_read_b128 a[132:135],v1 offset:128
v_mfma_f32_16x16x32_bf16 v[92:95],a[136:139],a[56:59],v[92:95]
s_waitcnt lgkmcnt(6)
ds_read_b128 a[136:139],v0 offset:256
v_mfma_f32_16x16x32_bf16 v[92:95],a[140:143],a[60:63],v[92:95]
s_waitcnt lgkmcnt(6)
ds_read_b128 a[140:143],v1 offset:256
v_fma_f32 v88,v88,s36,v15
v_mfma_f32_16x16x32_bf16 v[92:95],a[144:147],a[64:67],v[92:95]
s_waitcnt lgkmcnt(6)
ds_read_b128 a[144:147],v0 offset:6144
v_exp_f32 v88,v88
v_mfma_f32_16x16x32_bf16 v[92:95],a[148:151],a[68:71],v[92:95]
s_waitcnt vmcnt(6)
ds_read_b128 a[80:83],v11 offset:128
buffer_load_dwordx4 v6,s[8:11],s21 offen offset:0 lds
ds_read_b128 a[72:75],v11 offset:0
buffer_load_dwordx4 v7,s[8:11],s21 offen offset:1024 lds
ds_read_b128 a[84:87],v12 offset:128
buffer_load_dwordx4 v8,s[8:11],s21 offen offset:2048 lds
s_add_u32 s21,s21,12288
s_add_u32 m0,s23,24576
ds_read_b128 a[76:79],v12 offset:0
v_fma_f32 v89,v89,s36,v15
ds_read_b128 a[88:91],v11 offset:256
v_exp_f32 v89,v89
ds_read_b128 a[92:95],v12 offset:256
ds_read_b128 a[148:151],v1 offset:6144
s_waitcnt lgkmcnt(5)
v_mfma_f32_16x16x32_bf16 v[96:99],a[120:123],a[72:75],0
s_waitcnt lgkmcnt(3)
ds_read_b128 a[120:123],v0 offset:6272
v_mfma_f32_16x16x32_bf16 v[96:99],a[124:127],a[76:79],v[96:99]
ds_read_b128 a[124:127],v1 offset:6272
v_mfma_f32_16x16x32_bf16 v[96:99],a[128:131],a[80:83],v[96:99]
ds_read_b128 a[128:131],v0 offset:6400
v_mfma_f32_16x16x32_bf16 v[96:99],a[132:135],a[84:87],v[96:99]
s_waitcnt lgkmcnt(5)
ds_read_b128 a[132:135],v1 offset:6400
v_mfma_f32_16x16x32_bf16 v[96:99],a[136:139],a[88:91],v[96:99]
s_waitcnt lgkmcnt(5)
ds_read_b128 a[136:139],v0 offset:12288
v_mfma_f32_16x16x32_bf16 v[96:99],a[140:143],a[92:95],v[96:99]
ds_read_b128 a[140:143],v1 offset:12288
v_mfma_f32_16x16x32_bf16 v[100:103],a[144:147],a[72:75],0
s_waitcnt lgkmcnt(6)
ds_read_b128 a[144:147],v0 offset:12416
v_mfma_f32_16x16x32_bf16 v[100:103],a[148:151],a[76:79],v[100:103]
s_waitcnt lgkmcnt(6)
ds_read_b128 a[148:151],v1 offset:12416
v_mfma_f32_16x16x32_bf16 v[100:103],a[120:123],a[80:83],v[100:103]
s_waitcnt lgkmcnt(6)
ds_read_b128 a[120:123],v0 offset:12544
v_mfma_f32_16x16x32_bf16 v[100:103],a[124:127],a[84:87],v[100:103]
s_waitcnt lgkmcnt(6)
ds_read_b128 a[124:127],v1 offset:12544
v_max3_f32 v56,v96,v97,v98
v_mfma_f32_16x16x32_bf16 v[100:103],a[128:131],a[88:91],v[100:103]
s_waitcnt lgkmcnt(6)
ds_read_b128 a[128:131],v0 offset:18432
v_mfma_f32_16x16x32_bf16 v[100:103],a[132:135],a[92:95],v[100:103]
ds_read_b128 a[132:135],v1 offset:18432
s_nop 6
v_max3_f32 v56,v56,v99,v100
v_max3_f32 v56,v56,v101,v102
v_max_f32 v56,v56,v103
v_mov_b32 v57,v56
s_nop 1
v_permlane32_swap_b32 v57,v56
v_max_f32 v56,v56,v57
v_mov_b32 v57,v56
s_nop 1
v_permlane16_swap_b32 v57,v56
v_max_f32 v56,v56,v57
v_mul_f32_e64 v16,-s36,v56
v_fma_f32 v99,v99,s36,v16
v_exp_f32 v99,v99
v_fma_f32 v97,v97,s36,v16
v_exp_f32 v97,v97
v_fma_f32 v96,v96,s36,v16
v_exp_f32 v96,v96
v_fma_f32 v98,v98,s36,v16
v_exp_f32 v98,v98
v_fma_f32 v103,v103,s36,v16
v_cvt_pk_bf16_f32 v33,v98,v99
v_exp_f32 v103,v103
v_cvt_pk_bf16_f32 v32,v96,v97
s_waitcnt lgkmcnt(0)
v_mfma_f32_16x16x32_bf16 v[96:99],a[136:139],a[72:75],0
ds_read_b128 a[136:139],v0 offset:18560
v_fma_f32 v101,v101,s36,v16
v_mfma_f32_16x16x32_bf16 v[96:99],a[140:143],a[76:79],v[96:99]
ds_read_b128 a[140:143],v1 offset:18560
v_fma_f32 v102,v102,s36,v16
v_mfma_f32_16x16x32_bf16 v[96:99],a[144:147],a[80:83],v[96:99]
ds_read_b128 a[144:147],v0 offset:18688
v_exp_f32 v102,v102
v_mfma_f32_16x16x32_bf16 v[96:99],a[148:151],a[84:87],v[96:99]
ds_read_b128 a[148:151],v1 offset:18688
v_cvt_pk_bf16_f32 v35,v102,v103
v_mfma_f32_16x16x32_bf16 v[96:99],a[120:123],a[88:91],v[96:99]
ds_read_b64_tr_b16 a[122:123],v2 offset:6144
v_exp_f32 v101,v101
v_mfma_f32_16x16x32_bf16 v[96:99],a[124:127],a[92:95],v[96:99]
ds_read_b64_tr_b16 a[120:121],v2 offset:0
ds_read_b64_tr_b16 a[126:127],v3 offset:6144
ds_read_b64_tr_b16 a[124:125],v3 offset:0
v_fma_f32 v100,v100,s36,v16
v_exp_f32 v100,v100
s_nop 0
v_cvt_pk_bf16_f32 v34,v100,v101
v_mfma_f32_16x16x32_bf16 v[100:103],a[128:131],a[72:75],0
ds_read_b64_tr_b16 a[128:129],v4 offset:0
v_fma_f32 v97,v97,s36,v16
v_smfmac_f32_16x16x64_bf16 v[64:67],a[152:155],v[28:35],v18
ds_read_b64_tr_b16 a[130:131],v4 offset:6144
v_mfma_f32_16x16x32_bf16 v[100:103],a[132:135],a[76:79],v[100:103]
s_waitcnt lgkmcnt(7)
ds_read_b64_tr_b16 a[132:133],v5 offset:0
v_fma_f32 v98,v98,s36,v16
v_mfma_f32_16x16x32_bf16 v[100:103],a[136:139],a[80:83],v[100:103]
ds_read_b64_tr_b16 a[138:139],v2 offset:6272
v_exp_f32 v98,v98
v_mfma_f32_16x16x32_bf16 v[100:103],a[140:143],a[84:87],v[100:103]
ds_read_b64_tr_b16 a[136:137],v2 offset:128
v_fma_f32 v96,v96,s36,v16
v_mfma_f32_16x16x32_bf16 v[100:103],a[144:147],a[88:91],v[100:103]
s_waitcnt lgkmcnt(5)
ds_read_b64_tr_b16 a[142:143],v3 offset:6272
v_exp_f32 v96,v96
v_mfma_f32_16x16x32_bf16 v[100:103],a[148:151],a[92:95],v[100:103]
ds_read_b64_tr_b16 a[134:135],v5 offset:6144
v_exp_f32 v97,v97
v_mfma_f32_16x16x32_bf16 a[160:163],a[120:123],v[32:35],0
ds_read_b64_tr_b16 a[146:147],v4 offset:6272
v_cvt_pk_bf16_f32 v56,v96,v97
v_mfma_f32_16x16x32_bf16 a[164:167],a[124:127],v[32:35],0
s_waitcnt lgkmcnt(5)
ds_read_b64_tr_b16 a[120:121],v2 offset:256
v_fma_f32 v99,v99,s36,v16
v_mfma_f32_16x16x32_bf16 a[168:171],a[128:131],v[32:35],0
ds_read_b64_tr_b16 a[150:151],v5 offset:6272
ds_read_b64_tr_b16 a[144:145],v4 offset:128
ds_read_b64_tr_b16 a[148:149],v5 offset:128
ds_read_b64_tr_b16 a[126:127],v3 offset:6400
ds_read_b64_tr_b16 a[124:125],v3 offset:256
ds_read_b64_tr_b16 a[128:129],v4 offset:256
ds_read_b64_tr_b16 a[140:141],v3 offset:128
ds_read_b64_tr_b16 a[122:123],v2 offset:6400
v_exp_f32 v99,v99
s_waitcnt lgkmcnt(10)
v_mfma_f32_16x16x32_bf16 a[172:175],a[132:135],v[32:35],0
ds_read_b64_tr_b16 a[134:135],v5 offset:6400
v_cvt_pk_bf16_f32 v57,v98,v99
ds_read_b64_tr_b16 a[130:131],v4 offset:6400
v_mfma_f32_16x16x32_bf16 a[176:179],a[136:139],v[32:35],0
ds_read_b128 a[136:139],v0 offset:24576
v_fma_f32 v102,v102,s36,v16
ds_read_b64_tr_b16 a[132:133],v5 offset:256
v_fma_f32 v103,v103,s36,v16
v_exp_f32 v103,v103
v_exp_f32 v102,v102
v_fma_f32 v101,v101,s36,v16
v_exp_f32 v101,v101
v_cvt_pk_bf16_f32 v59,v102,v103
v_fma_f32 v100,v100,s36,v16
v_exp_f32 v100,v100
s_waitcnt lgkmcnt(4)
v_mfma_f32_16x16x32_bf16 a[180:183],a[140:143],v[32:35],0
ds_read_b128 a[140:143],v1 offset:24576
v_cvt_pk_bf16_f32 v58,v100,v101
v_mfma_f32_16x16x32_bf16 a[184:187],a[144:147],v[32:35],0
ds_read_b128 a[144:147],v0 offset:24704
v_cvt_pk_bf16_f32 v28,v88,v89
v_smfmac_f32_16x16x64_bf16 v[64:67],a[152:155],v[52:59],v18
v_mfma_f32_16x16x32_bf16 a[188:191],a[148:151],v[32:35],0
ds_read_b128 a[148:151],v1 offset:24704
v_mfma_f32_16x16x32_bf16 a[192:195],a[120:123],v[32:35],0
ds_read_b128 a[120:123],v0 offset:24832
v_mfma_f32_16x16x32_bf16 a[196:199],a[124:127],v[32:35],0
s_waitcnt lgkmcnt(4)
ds_read_b128 a[124:127],v1 offset:24832
v_mfma_f32_16x16x32_bf16 a[200:203],a[128:131],v[32:35],0
ds_read_b128 a[128:131],v0 offset:30720
v_mfma_f32_16x16x32_bf16 a[204:207],a[132:135],v[32:35],0
ds_read_b128 a[132:135],v1 offset:30720
v_mfma_f32_16x16x32_bf16 v[96:99],a[136:139],a[72:75],0
s_waitcnt lgkmcnt(5)
ds_read_b128 a[136:139],v0 offset:30848
v_mfma_f32_16x16x32_bf16 v[96:99],a[140:143],a[76:79],v[96:99]
ds_read_b128 a[140:143],v1 offset:30848
v_mfma_f32_16x16x32_bf16 v[96:99],a[144:147],a[80:83],v[96:99]
s_waitcnt lgkmcnt(6)
ds_read_b128 a[144:147],v0 offset:30976
v_mfma_f32_16x16x32_bf16 v[96:99],a[148:151],a[84:87],v[96:99]
s_waitcnt lgkmcnt(6)
ds_read_b128 a[148:151],v1 offset:30976
v_mfma_f32_16x16x32_bf16 v[96:99],a[120:123],a[88:91],v[96:99]
s_waitcnt lgkmcnt(6)
ds_read_b128 a[120:123],v0 offset:0
v_mfma_f32_16x16x32_bf16 v[96:99],a[124:127],a[92:95],v[96:99]
s_waitcnt lgkmcnt(6)
ds_read_b128 a[124:127],v1 offset:0
v_mfma_f32_16x16x32_bf16 v[100:103],a[128:131],a[72:75],0
s_waitcnt lgkmcnt(6)
ds_read_b128 a[128:131],v0 offset:128
v_mfma_f32_16x16x32_bf16 v[100:103],a[132:135],a[76:79],v[100:103]
s_waitcnt lgkmcnt(6)
ds_read_b128 a[132:135],v1 offset:128
v_mfma_f32_16x16x32_bf16 v[100:103],a[136:139],a[80:83],v[100:103]
s_waitcnt lgkmcnt(6)
ds_read_b128 a[136:139],v0 offset:256
v_mfma_f32_16x16x32_bf16 v[100:103],a[140:143],a[84:87],v[100:103]
s_waitcnt lgkmcnt(6)
ds_read_b128 a[140:143],v1 offset:256
v_mfma_f32_16x16x32_bf16 v[100:103],a[144:147],a[88:91],v[100:103]
s_waitcnt lgkmcnt(6)
ds_read_b128 a[144:147],v0 offset:6144
v_mfma_f32_16x16x32_bf16 v[100:103],a[148:151],a[92:95],v[100:103]
s_waitcnt vmcnt(3)
ds_read_b128 a[96:99],v11 offset:6144
buffer_load_dwordx4 v6,s[8:11],s21 offen offset:0 lds
ds_read_b128 a[108:111],v12 offset:6272
buffer_load_dwordx4 v7,s[8:11],s21 offen offset:1024 lds
ds_read_b128 a[104:107],v11 offset:6272
buffer_load_dwordx4 v8,s[8:11],s21 offen offset:2048 lds
s_add_u32 s21,s21,12288
ds_read_b128 a[100:103],v12 offset:6144
s_add_u32 m0,s22,0
ds_read_b128 a[112:115],v11 offset:6400
ds_read_b128 a[116:119],v12 offset:6400
ds_read_b128 a[148:151],v1 offset:6144
s_waitcnt lgkmcnt(6)
v_mfma_f32_16x16x32_bf16 v[104:107],a[120:123],a[96:99],0
s_waitcnt lgkmcnt(3)
ds_read_b128 a[120:123],v0 offset:6272
v_mfma_f32_16x16x32_bf16 v[104:107],a[124:127],a[100:103],v[104:107]
ds_read_b128 a[124:127],v1 offset:6272
v_mfma_f32_16x16x32_bf16 v[104:107],a[128:131],a[104:107],v[104:107]
ds_read_b128 a[128:131],v0 offset:6400
v_mfma_f32_16x16x32_bf16 v[104:107],a[132:135],a[108:111],v[104:107]
ds_read_b128 a[132:135],v1 offset:6400
s_waitcnt vmcnt(3)
s_waitcnt lgkmcnt(6)
v_mfma_f32_16x16x32_bf16 v[104:107],a[136:139],a[112:115],v[104:107]
s_waitcnt lgkmcnt(5)
v_mfma_f32_16x16x32_bf16 v[104:107],a[140:143],a[116:119],v[104:107]
v_mfma_f32_16x16x32_bf16 v[108:111],a[144:147],a[96:99],0
s_waitcnt lgkmcnt(4)
v_mfma_f32_16x16x32_bf16 v[108:111],a[148:151],a[100:103],v[108:111]
s_waitcnt lgkmcnt(3)
v_mfma_f32_16x16x32_bf16 v[108:111],a[120:123],a[104:107],v[108:111]
s_waitcnt lgkmcnt(2)
v_mfma_f32_16x16x32_bf16 v[108:111],a[124:127],a[108:111],v[108:111]
s_waitcnt lgkmcnt(1)
v_mfma_f32_16x16x32_bf16 v[108:111],a[128:131],a[112:115],v[108:111]
s_waitcnt lgkmcnt(0)
v_mfma_f32_16x16x32_bf16 v[108:111],a[132:135],a[116:119],v[108:111]
s_barrier
buffer_load_dwordx4 v6,s[4:7],s20 offen offset:0 lds
buffer_load_dwordx4 v7,s[4:7],s20 offen offset:1024 lds
buffer_load_dwordx4 v8,s[4:7],s20 offen offset:2048 lds
ds_read_b128 a[148:151],v1 offset:12416
v_max3_f32 v40,v104,v105,v106
ds_read_b128 a[140:143],v1 offset:12288
s_add_u32 s20,s20,12288
ds_read_b128 a[124:127],v1 offset:12544
v_max3_f32 v40,v40,v107,v108
ds_read_b128 a[136:139],v0 offset:12288
v_max3_f32 v40,v40,v109,v110
ds_read_b128 a[144:147],v0 offset:12416
v_max_f32 v40,v40,v111
ds_read_b128 a[120:123],v0 offset:12544
v_mov_b32 v41,v40
ds_read_b128 a[132:135],v1 offset:18432
s_mov_b32 s27,166723584
ds_read_b128 a[128:131],v0 offset:18432
v_permlane32_swap_b32 v41,v40
v_max_f32 v40,v40,v41
v_mov_b32 v41,v40
s_mov_b32 s42,s41
s_add_u32 s69,s69,1
v_permlane16_swap_b32 v41,v40
v_max_f32 v40,v40,v41
v_mul_f32_e64 v17,-s36,v40
v_fma_f32 v105,v105,s36,v17
v_fma_f32 v104,v104,s36,v17
v_fma_f32 v106,v106,s36,v17
v_fma_f32 v107,v107,s36,v17
v_exp_f32 v105,v105
v_exp_f32 v107,v107
v_exp_f32 v104,v104
v_exp_f32 v106,v106
v_cvt_pk_bf16_f32 v36,v104,v105
v_fma_f32 v110,v110,s36,v17
v_cvt_pk_bf16_f32 v37,v106,v107
s_waitcnt lgkmcnt(2)
v_mfma_f32_16x16x32_bf16 v[104:107],a[136:139],a[96:99],0
s_lshl_b32 s62,s69,5
ds_read_b128 a[136:139],v0 offset:18560
v_fma_f32 v109,v109,s36,v17
v_mfma_f32_16x16x32_bf16 v[104:107],a[140:143],a[100:103],v[104:107]
s_add_u32 s62,s62,s34
ds_read_b128 a[140:143],v1 offset:18560
v_exp_f32 v109,v109
v_mfma_f32_16x16x32_bf16 v[104:107],a[144:147],a[104:107],v[104:107]
s_mul_i32 s63,s62,171
ds_read_b128 a[144:147],v0 offset:18688
v_exp_f32 v110,v110
v_mfma_f32_16x16x32_bf16 v[104:107],a[148:151],a[108:111],v[104:107]
s_lshr_b32 s63,s63,9
ds_read_b128 a[148:151],v1 offset:18688
v_fma_f32 v108,v108,s36,v17
v_mfma_f32_16x16x32_bf16 v[104:107],a[120:123],a[112:115],v[104:107]
s_mul_i32 s64,s63,3
ds_read_b64_tr_b16 a[122:123],v2 offset:6144
v_exp_f32 v108,v108
v_mfma_f32_16x16x32_bf16 v[104:107],a[124:127],a[116:119],v[104:107]
s_sub_u32 s62,s62,s64
ds_read_b64_tr_b16 a[120:121],v2 offset:0
ds_read_b64_tr_b16 a[126:127],v3 offset:6144
ds_read_b64_tr_b16 a[124:125],v3 offset:0
v_cvt_pk_bf16_f32 v38,v108,v109
v_fma_f32 v111,v111,s36,v17
v_exp_f32 v111,v111
s_add_u32 s63,s63,s33
v_cvt_pk_bf16_f32 v39,v110,v111
s_waitcnt lgkmcnt(7)
v_mfma_f32_16x16x32_bf16 v[108:111],a[128:131],a[96:99],0
s_mul_i32 s30,s63,196608
ds_read_b64_tr_b16 a[130:131],v4 offset:6144
v_fma_f32 v107,v107,s36,v17
v_mfma_f32_16x16x32_bf16 v[108:111],a[132:135],a[100:103],v[108:111]
s_mul_i32 s41,s63,325632
ds_read_b64_tr_b16 a[134:135],v5 offset:6144
v_exp_f32 v107,v107
v_mfma_f32_16x16x32_bf16 v[108:111],a[136:139],a[104:107],v[108:111]
s_lshl_b32 s63,s3,2
ds_read_b64_tr_b16 a[132:133],v5 offset:0
v_fma_f32 v104,v104,s36,v17
s_waitcnt lgkmcnt(7)
v_mfma_f32_16x16x32_bf16 v[108:111],a[140:143],a[108:111],v[108:111]
s_add_u32 s64,s63,21
ds_read_b64_tr_b16 a[128:129],v4 offset:0
v_fma_f32 v105,v105,s36,v17
v_mfma_f32_16x16x32_bf16 v[108:111],a[144:147],a[112:115],v[108:111]
s_cmp_eq_u32 s3,0
ds_read_b64_tr_b16 a[142:143],v3 offset:6272
v_exp_f32 v105,v105
v_mfma_f32_16x16x32_bf16 v[108:111],a[148:151],a[116:119],v[108:111]
s_cselect_b32 s64,20,s64
ds_read_b64_tr_b16 a[146:147],v4 offset:6272
v_fma_f32 v106,v106,s36,v17
s_waitcnt lgkmcnt(6)
v_mfma_f32_16x16x32_bf16 a[208:211],a[120:123],v[36:39],0
s_cselect_b32 s40,1,0
ds_read_b64_tr_b16 a[138:139],v2 offset:6272
v_exp_f32 v104,v104
v_mfma_f32_16x16x32_bf16 a[212:215],a[124:127],v[36:39],0
s_add_u32 s65,s63,37
ds_read_b64_tr_b16 a[124:125],v3 offset:256
ds_read_b64_tr_b16 a[136:137],v2 offset:128
ds_read_b64_tr_b16 a[144:145],v4 offset:128
ds_read_b64_tr_b16 a[122:123],v2 offset:6400
ds_read_b64_tr_b16 a[148:149],v5 offset:128
ds_read_b64_tr_b16 a[140:141],v3 offset:128
v_cvt_pk_bf16_f32 v40,v104,v105
ds_read_b64_tr_b16 a[150:151],v5 offset:6272
s_waitcnt lgkmcnt(10)
v_mfma_f32_16x16x32_bf16 a[216:219],a[128:131],v[36:39],0
s_cmp_eq_u32 s62,2
ds_read_b64_tr_b16 a[128:129],v4 offset:256
ds_read_b64_tr_b16 a[120:121],v2 offset:256
v_mfma_f32_16x16x32_bf16 a[220:223],a[132:135],v[36:39],0
s_cselect_b32 s64,s65,s64
ds_read_b64_tr_b16 a[134:135],v5 offset:6400
ds_read_b64_tr_b16 a[132:133],v5 offset:256
ds_read_b64_tr_b16 a[126:127],v3 offset:6400
ds_read_b64_tr_b16 a[130:131],v4 offset:6400
s_waitcnt vmcnt(6)
v_exp_f32 v106,v106
s_waitcnt lgkmcnt(11)
v_mfma_f32_16x16x32_bf16 a[224:227],a[136:139],v[36:39],0
s_cselect_b32 s40,0,s40
v_cvt_pk_bf16_f32 v41,v106,v107
v_fma_f32 v108,v108,s36,v17
v_exp_f32 v108,v108
v_fma_f32 v110,v110,s36,v17
v_exp_f32 v110,v110
s_waitcnt lgkmcnt(7)
v_mfma_f32_16x16x32_bf16 a[228:231],a[140:143],v[36:39],0
s_add_u32 s65,s63,s3
v_fma_f32 v111,v111,s36,v17
v_exp_f32 v111,v111
v_mfma_f32_16x16x32_bf16 a[232:235],a[144:147],v[36:39],0
s_cmp_eq_u32 s62,0
v_fma_f32 v109,v109,s36,v17
v_exp_f32 v109,v109
s_waitcnt lgkmcnt(4)
v_mfma_f32_16x16x32_bf16 a[236:239],a[148:151],v[36:39],0
s_cselect_b32 s64,s65,s64
v_cvt_pk_bf16_f32 v42,v108,v109
v_cvt_pk_bf16_f32 v43,v110,v111
v_mfma_f32_16x16x32_bf16 a[240:243],a[120:123],v[36:39],0
s_cselect_b32 s40,1,s40
s_mul_i32 s64,s64,6144
s_waitcnt lgkmcnt(0)
s_barrier
v_smfmac_f32_16x16x64_bf16 v[68:71],a[152:155],v[36:43],v18
s_add_u32 s41,s41,s64
s_cmp_ge_u32 s69,6
ds_read_b128 a[144:147],v0 offset:24704
v_mfma_f32_16x16x32_bf16 a[244:247],a[124:127],v[36:39],0
s_cselect_b32 s41,166723584,s41
s_cselect_b32 s30,100663296,s30
ds_read_b128 a[136:139],v0 offset:24576
v_mfma_f32_16x16x32_bf16 a[248:251],a[128:131],v[36:39],0
s_add_u32 s25,s30,s22
s_add_u32 s26,s25,12288
ds_read_b128 a[120:123],v0 offset:24832
v_mfma_f32_16x16x32_bf16 a[252:255],a[132:135],v[36:39],0
s_mov_b32 s28,s41
ds_read_b128 a[124:127],v1 offset:24832
s_mov_b32 s29,s24
ds_read_b128 a[140:143],v1 offset:24576
s_add_u32 m0,s23,0
ds_read_b128 a[148:151],v1 offset:24704
buffer_load_dwordx4 v6,s[8:11],s21 offen offset:0 lds
buffer_load_dwordx4 v7,s[8:11],s21 offen offset:1024 lds
buffer_load_dwordx4 v8,s[8:11],s21 offen offset:2048 lds
ds_read_b128 a[128:131],v0 offset:30720
s_add_u32 s21,s21,12288
ds_read_b128 a[132:135],v1 offset:30720
s_waitcnt lgkmcnt(6)
v_mfma_f32_16x16x32_bf16 v[104:107],a[136:139],a[96:99],0
s_add_u32 m0,s22,12288
ds_read_b128 a[136:139],v0 offset:30848
buffer_load_dwordx4 v6,s[4:7],s20 offen offset:0 lds
buffer_load_dwordx4 v7,s[4:7],s20 offen offset:1024 lds
buffer_load_dwordx4 v8,s[4:7],s20 offen offset:2048 lds
s_waitcnt lgkmcnt(4)
v_mfma_f32_16x16x32_bf16 v[104:107],a[140:143],a[100:103],v[104:107]
s_add_u32 s20,s20,12288
ds_read_b128 a[140:143],v1 offset:30848
v_mfma_f32_16x16x32_bf16 v[104:107],a[144:147],a[104:107],v[104:107]
s_waitcnt lgkmcnt(4)
ds_read_b128 a[144:147],v0 offset:30976
v_mfma_f32_16x16x32_bf16 v[104:107],a[148:151],a[108:111],v[104:107]
ds_read_b128 a[148:151],v1 offset:30976
v_mfma_f32_16x16x32_bf16 v[104:107],a[120:123],a[112:115],v[104:107]
ds_read_b64_tr_b16 a[120:121],v2 offset:12288
v_mfma_f32_16x16x32_bf16 v[104:107],a[124:127],a[116:119],v[104:107]
s_waitcnt lgkmcnt(4)
ds_read_b64_tr_b16 a[124:125],v3 offset:12288
v_mfma_f32_16x16x32_bf16 v[108:111],a[128:131],a[96:99],0
ds_read_b64_tr_b16 a[126:127],v3 offset:18432
v_mfma_f32_16x16x32_bf16 v[108:111],a[132:135],a[100:103],v[108:111]
ds_read_b64_tr_b16 a[122:123],v2 offset:18432
v_mfma_f32_16x16x32_bf16 v[108:111],a[136:139],a[104:107],v[108:111]
s_waitcnt lgkmcnt(6)
ds_read_b64_tr_b16 a[128:129],v4 offset:12288
v_mfma_f32_16x16x32_bf16 v[108:111],a[140:143],a[108:111],v[108:111]
s_waitcnt lgkmcnt(6)
ds_read_b64_tr_b16 a[130:131],v4 offset:18432
v_mfma_f32_16x16x32_bf16 v[108:111],a[144:147],a[112:115],v[108:111]
s_waitcnt lgkmcnt(6)
ds_read_b64_tr_b16 a[132:133],v5 offset:12288
v_mfma_f32_16x16x32_bf16 v[108:111],a[148:151],a[116:119],v[108:111]
s_waitcnt lgkmcnt(3)
ds_read_b64_tr_b16 a[134:135],v5 offset:18432
v_mfma_f32_16x16x32_bf16 v[160:163],a[120:123],v[44:47],v[160:163]
s_add_u32 m0,s23,12288
ds_read_b64_tr_b16 a[136:137],v2 offset:12416
v_fma_f32 v90,v90,s36,v15
v_mfma_f32_16x16x32_bf16 v[164:167],a[124:127],v[44:47],v[164:167]
ds_read_b64_tr_b16 a[138:139],v2 offset:18560
v_fma_f32 v91,v91,s36,v15
v_mfma_f32_16x16x32_bf16 v[212:215],a[124:127],v[48:51],v[212:215]
ds_read_b64_tr_b16 a[140:141],v3 offset:12416
v_fma_f32 v96,v96,s36,v16
v_mfma_f32_16x16x32_bf16 v[208:211],a[120:123],v[48:51],v[208:211]
ds_read_b64_tr_b16 a[142:143],v3 offset:18560
v_fma_f32 v97,v97,s36,v16
v_mfma_f32_16x16x32_bf16 v[112:115],a[120:123],v[52:55],v[112:115]
ds_read_b64_tr_b16 a[144:145],v4 offset:12416
v_fma_f32 v98,v98,s36,v16
v_mfma_f32_16x16x32_bf16 v[116:119],a[124:127],v[52:55],v[116:119]
ds_read_b64_tr_b16 a[146:147],v4 offset:18560
v_fma_f32 v99,v99,s36,v16
v_mfma_f32_16x16x32_bf16 a[164:167],a[124:127],v[56:59],a[164:167]
ds_read_b64_tr_b16 a[148:149],v5 offset:12416
v_fma_f32 v104,v104,s36,v17
v_mfma_f32_16x16x32_bf16 a[160:163],a[120:123],v[56:59],a[160:163]
ds_read_b64_tr_b16 a[150:151],v5 offset:18560
v_fma_f32 v105,v105,s36,v17
v_mfma_f32_16x16x32_bf16 a[208:211],a[120:123],v[40:43],a[208:211]
ds_read_b64_tr_b16 a[120:121],v2 offset:12544
v_fma_f32 v106,v106,s36,v17
v_mfma_f32_16x16x32_bf16 a[212:215],a[124:127],v[40:43],a[212:215]
s_waitcnt lgkmcnt(6)
ds_read_b64_tr_b16 a[122:123],v2 offset:18688
v_fma_f32 v107,v107,s36,v17
v_mfma_f32_16x16x32_bf16 a[216:219],a[128:131],v[40:43],a[216:219]
ds_read_b64_tr_b16 a[124:125],v3 offset:12544
v_fma_f32 v76,v76,s36,v13
v_mfma_f32_16x16x32_bf16 a[220:223],a[132:135],v[40:43],a[220:223]
ds_read_b64_tr_b16 a[126:127],v3 offset:18688
v_fma_f32 v77,v77,s36,v13
v_mfma_f32_16x16x32_bf16 a[172:175],a[132:135],v[56:59],a[172:175]
v_exp_f32 v90,v90
v_mfma_f32_16x16x32_bf16 a[168:171],a[128:131],v[56:59],a[168:171]
v_exp_f32 v91,v91
v_mfma_f32_16x16x32_bf16 v[120:123],a[128:131],v[52:55],v[120:123]
v_cvt_pk_bf16_f32 v29,v90,v91
v_fma_f32 v78,v78,s36,v13
v_mfma_f32_16x16x32_bf16 v[124:127],a[132:135],v[52:55],v[124:127]
v_exp_f32 v96,v96
v_mfma_f32_16x16x32_bf16 v[220:223],a[132:135],v[48:51],v[220:223]
v_exp_f32 v97,v97
v_mfma_f32_16x16x32_bf16 v[216:219],a[128:131],v[48:51],v[216:219]
v_exp_f32 v98,v98
v_mfma_f32_16x16x32_bf16 v[168:171],a[128:131],v[44:47],v[168:171]
ds_read_b64_tr_b16 a[128:129],v4 offset:12544
v_cvt_pk_bf16_f32 v32,v96,v97
v_mfma_f32_16x16x32_bf16 v[172:175],a[132:135],v[44:47],v[172:175]
ds_read_b64_tr_b16 a[130:131],v4 offset:18688
v_fma_f32 v79,v79,s36,v13
v_mfma_f32_16x16x32_bf16 v[176:179],a[136:139],v[44:47],v[176:179]
s_waitcnt lgkmcnt(2)
ds_read_b64_tr_b16 a[132:133],v5 offset:12544
v_fma_f32 v84,v84,s36,v14
v_mfma_f32_16x16x32_bf16 v[180:183],a[140:143],v[44:47],v[180:183]
ds_read_b64_tr_b16 a[134:135],v5 offset:18688
v_fma_f32 v85,v85,s36,v14
v_mfma_f32_16x16x32_bf16 v[228:231],a[140:143],v[48:51],v[228:231]
v_exp_f32 v99,v99
v_mfma_f32_16x16x32_bf16 v[224:227],a[136:139],v[48:51],v[224:227]
v_cvt_pk_bf16_f32 v33,v98,v99
v_fma_f32 v86,v86,s36,v14
v_mfma_f32_16x16x32_bf16 v[128:131],a[136:139],v[52:55],v[128:131]
v_exp_f32 v104,v104
v_mfma_f32_16x16x32_bf16 v[132:135],a[140:143],v[52:55],v[132:135]
v_exp_f32 v105,v105
v_mfma_f32_16x16x32_bf16 a[180:183],a[140:143],v[56:59],a[180:183]
v_exp_f32 v106,v106
v_mfma_f32_16x16x32_bf16 a[176:179],a[136:139],v[56:59],a[176:179]
v_exp_f32 v107,v107
v_mfma_f32_16x16x32_bf16 a[224:227],a[136:139],v[40:43],a[224:227]
v_cvt_pk_bf16_f32 v36,v104,v105
v_cvt_pk_bf16_f32 v37,v106,v107
v_mfma_f32_16x16x32_bf16 a[228:231],a[140:143],v[40:43],a[228:231]
v_exp_f32 v76,v76
v_mfma_f32_16x16x32_bf16 a[232:235],a[144:147],v[40:43],a[232:235]
v_exp_f32 v77,v77
v_mfma_f32_16x16x32_bf16 a[236:239],a[148:151],v[40:43],a[236:239]
v_exp_f32 v78,v78
v_mfma_f32_16x16x32_bf16 a[188:191],a[148:151],v[56:59],a[188:191]
v_exp_f32 v79,v79
v_mfma_f32_16x16x32_bf16 a[184:187],a[144:147],v[56:59],a[184:187]
v_cvt_pk_bf16_f32 v22,v76,v77
v_cvt_pk_bf16_f32 v23,v78,v79
v_mfma_f32_16x16x32_bf16 v[136:139],a[144:147],v[52:55],v[136:139]
v_fma_f32 v87,v87,s36,v14
v_fma_f32 v92,v92,s36,v15
v_mfma_f32_16x16x32_bf16 v[140:143],a[148:151],v[52:55],v[140:143]
v_exp_f32 v84,v84
v_mfma_f32_16x16x32_bf16 v[236:239],a[148:151],v[48:51],v[236:239]
v_exp_f32 v85,v85
v_mfma_f32_16x16x32_bf16 v[232:235],a[144:147],v[48:51],v[232:235]
v_exp_f32 v86,v86
v_mfma_f32_16x16x32_bf16 v[184:187],a[144:147],v[44:47],v[184:187]
v_exp_f32 v87,v87
v_mfma_f32_16x16x32_bf16 v[188:191],a[148:151],v[44:47],v[188:191]
v_cvt_pk_bf16_f32 v26,v84,v85
v_cvt_pk_bf16_f32 v27,v86,v87
v_mfma_f32_16x16x32_bf16 v[192:195],a[120:123],v[44:47],v[192:195]
s_waitcnt vmcnt(6) lgkmcnt(0)
v_fma_f32 v93,v93,s36,v15
v_fma_f32 v94,v94,s36,v15
v_smfmac_f32_16x16x64_bf16 v[60:63],a[152:155],v[20:27],v18
s_barrier
v_mfma_f32_16x16x32_bf16 v[196:199],a[124:127],v[44:47],v[196:199]
ds_read_b128 a[136:139],v0 offset:0
v_fma_f32 v95,v95,s36,v15
v_mfma_f32_16x16x32_bf16 v[244:247],a[124:127],v[48:51],v[244:247]
ds_read_b128 a[140:143],v1 offset:0
v_fma_f32 v100,v100,s36,v16
v_mfma_f32_16x16x32_bf16 v[240:243],a[120:123],v[48:51],v[240:243]
ds_read_b128 a[144:147],v0 offset:128
v_fma_f32 v101,v101,s36,v16
v_mfma_f32_16x16x32_bf16 v[144:147],a[120:123],v[52:55],v[144:147]
ds_read_b128 a[148:151],v1 offset:128
v_fma_f32 v102,v102,s36,v16
v_mfma_f32_16x16x32_bf16 v[148:151],a[124:127],v[52:55],v[148:151]
v_exp_f32 v92,v92
v_mfma_f32_16x16x32_bf16 a[196:199],a[124:127],v[56:59],a[196:199]
buffer_load_dwordx4 v6,s[8:11],s21 offen offset:0 lds
v_mfma_f32_16x16x32_bf16 a[192:195],a[120:123],v[56:59],a[192:195]
v_exp_f32 v93,v93
v_mfma_f32_16x16x32_bf16 a[240:243],a[120:123],v[40:43],a[240:243]
ds_read_b128 a[120:123],v0 offset:256
v_cvt_pk_bf16_f32 v30,v92,v93
v_mfma_f32_16x16x32_bf16 a[244:247],a[124:127],v[40:43],a[244:247]
ds_read_b128 a[124:127],v1 offset:256
v_fma_f32 v103,v103,s36,v16
v_mfma_f32_16x16x32_bf16 a[248:251],a[128:131],v[40:43],a[248:251]
v_exp_f32 v94,v94
v_mfma_f32_16x16x32_bf16 a[252:255],a[132:135],v[40:43],a[252:255]
v_exp_f32 v95,v95
v_mfma_f32_16x16x32_bf16 a[204:207],a[132:135],v[56:59],a[204:207]
v_cvt_pk_bf16_f32 v31,v94,v95
v_fma_f32 v108,v108,s36,v17
v_mfma_f32_16x16x32_bf16 a[200:203],a[128:131],v[56:59],a[200:203]
v_exp_f32 v100,v100
v_mfma_f32_16x16x32_bf16 v[152:155],a[128:131],v[52:55],v[152:155]
v_exp_f32 v101,v101
v_mfma_f32_16x16x32_bf16 v[156:159],a[132:135],v[52:55],v[156:159]
v_exp_f32 v102,v102
v_mfma_f32_16x16x32_bf16 v[252:255],a[132:135],v[48:51],v[252:255]
v_exp_f32 v103,v103
v_mfma_f32_16x16x32_bf16 v[248:251],a[128:131],v[48:51],v[248:251]
buffer_load_dwordx4 v7,s[8:11],s21 offen offset:1024 lds
v_mfma_f32_16x16x32_bf16 v[200:203],a[128:131],v[44:47],v[200:203]
ds_read_b128 a[128:131],v0 offset:6144
v_cvt_pk_bf16_f32 v34,v100,v101
v_mfma_f32_16x16x32_bf16 v[204:207],a[132:135],v[44:47],v[204:207]
s_waitcnt lgkmcnt(1)
ds_read_b128 a[132:135],v1 offset:6144
v_cvt_pk_bf16_f32 v35,v102,v103
v_mfma_f32_16x16x32_bf16 v[72:75],a[136:139],a[0:3],0
v_fma_f32 v109,v109,s36,v17
v_fma_f32 v110,v110,s36,v17
v_smfmac_f32_16x16x64_bf16 v[64:67],a[152:155],v[28:35],v18
v_fma_f32 v111,v111,s36,v17
v_mfma_f32_16x16x32_bf16 v[72:75],a[140:143],a[4:7],v[72:75]
v_exp_f32 v108,v108
v_mfma_f32_16x16x32_bf16 v[72:75],a[144:147],a[8:11],v[72:75]
v_exp_f32 v109,v109
v_mfma_f32_16x16x32_bf16 v[72:75],a[148:151],a[12:15],v[72:75]
v_exp_f32 v110,v110
v_mfma_f32_16x16x32_bf16 v[72:75],a[120:123],a[16:19],v[72:75]
v_exp_f32 v111,v111
v_mfma_f32_16x16x32_bf16 v[72:75],a[124:127],a[20:23],v[72:75]
v_cvt_pk_bf16_f32 v38,v108,v109
v_cvt_pk_bf16_f32 v39,v110,v111
v_mfma_f32_16x16x32_bf16 v[80:83],a[124:127],a[44:47],0
v_mfma_f32_16x16x32_bf16 v[80:83],a[120:123],a[40:43],v[80:83]
v_mfma_f32_16x16x32_bf16 v[80:83],a[148:151],a[36:39],v[80:83]
buffer_load_dwordx4 v8,s[8:11],s21 offen offset:2048 lds
v_mfma_f32_16x16x32_bf16 v[80:83],a[144:147],a[32:35],v[80:83]
s_add_u32 s21,s21,12288
v_fma_f32 v72,v72,s36,v13
v_fma_f32 v73,v73,s36,v13
v_mfma_f32_16x16x32_bf16 v[80:83],a[140:143],a[28:31],v[80:83]
s_add_u32 m0,s22,24576
v_fma_f32 v74,v74,s36,v13
v_fma_f32 v75,v75,s36,v13
v_mfma_f32_16x16x32_bf16 v[80:83],a[136:139],a[24:27],v[80:83]
v_exp_f32 v72,v72
v_mfma_f32_16x16x32_bf16 v[88:91],a[136:139],a[48:51],0
v_exp_f32 v73,v73
v_mfma_f32_16x16x32_bf16 v[88:91],a[140:143],a[52:55],v[88:91]
v_exp_f32 v74,v74
v_mfma_f32_16x16x32_bf16 v[88:91],a[144:147],a[56:59],v[88:91]
v_exp_f32 v75,v75
v_mfma_f32_16x16x32_bf16 v[88:91],a[148:151],a[60:63],v[88:91]
v_fma_f32 v80,v80,s36,v14
v_fma_f32 v81,v81,s36,v14
v_mfma_f32_16x16x32_bf16 v[88:91],a[120:123],a[64:67],v[88:91]
v_fma_f32 v82,v82,s36,v14
v_fma_f32 v83,v83,s36,v14
v_mfma_f32_16x16x32_bf16 v[88:91],a[124:127],a[68:71],v[88:91]
v_exp_f32 v80,v80
v_mfma_f32_16x16x32_bf16 v[96:99],a[124:127],a[92:95],0
v_exp_f32 v81,v81
v_mfma_f32_16x16x32_bf16 v[96:99],a[120:123],a[88:91],v[96:99]
v_exp_f32 v82,v82
v_mfma_f32_16x16x32_bf16 v[96:99],a[148:151],a[84:87],v[96:99]
buffer_load_dwordx4 v6,s[4:7],s20 offen offset:0 lds
v_mfma_f32_16x16x32_bf16 v[96:99],a[144:147],a[80:83],v[96:99]
v_fma_f32 v88,v88,s36,v15
v_fma_f32 v89,v89,s36,v15
v_mfma_f32_16x16x32_bf16 v[96:99],a[140:143],a[76:79],v[96:99]
v_exp_f32 v83,v83
v_mfma_f32_16x16x32_bf16 v[96:99],a[136:139],a[72:75],v[96:99]
v_exp_f32 v88,v88
v_mfma_f32_16x16x32_bf16 v[104:107],a[136:139],a[96:99],0
ds_read_b128 a[136:139],v0 offset:6272
v_cvt_pk_bf16_f32 v44,v72,v73
v_mfma_f32_16x16x32_bf16 v[104:107],a[140:143],a[100:103],v[104:107]
ds_read_b128 a[140:143],v1 offset:6272
v_cvt_pk_bf16_f32 v45,v74,v75
v_mfma_f32_16x16x32_bf16 v[104:107],a[144:147],a[104:107],v[104:107]
ds_read_b128 a[144:147],v0 offset:6400
v_cvt_pk_bf16_f32 v48,v80,v81
v_mfma_f32_16x16x32_bf16 v[104:107],a[148:151],a[108:111],v[104:107]
ds_read_b128 a[148:151],v1 offset:6400
v_cvt_pk_bf16_f32 v49,v82,v83
v_mfma_f32_16x16x32_bf16 v[104:107],a[120:123],a[112:115],v[104:107]
v_exp_f32 v89,v89
v_mfma_f32_16x16x32_bf16 v[104:107],a[124:127],a[116:119],v[104:107]
s_waitcnt lgkmcnt(4)
v_cvt_pk_bf16_f32 v52,v88,v89
v_mfma_f32_16x16x32_bf16 v[76:79],a[128:131],a[0:3],0
v_mfma_f32_16x16x32_bf16 v[76:79],a[132:135],a[4:7],v[76:79]
buffer_load_dwordx4 v7,s[4:7],s20 offen offset:1024 lds
s_waitcnt lgkmcnt(3)
v_mfma_f32_16x16x32_bf16 v[76:79],a[136:139],a[8:11],v[76:79]
s_waitcnt lgkmcnt(2)
v_mfma_f32_16x16x32_bf16 v[76:79],a[140:143],a[12:15],v[76:79]
s_waitcnt lgkmcnt(1)
v_mfma_f32_16x16x32_bf16 v[76:79],a[144:147],a[16:19],v[76:79]
s_waitcnt lgkmcnt(0)
v_mfma_f32_16x16x32_bf16 v[76:79],a[148:151],a[20:23],v[76:79]
v_mfma_f32_16x16x32_bf16 v[84:87],a[148:151],a[44:47],0
v_mfma_f32_16x16x32_bf16 v[84:87],a[144:147],a[40:43],v[84:87]
v_mfma_f32_16x16x32_bf16 v[84:87],a[140:143],a[36:39],v[84:87]
v_mfma_f32_16x16x32_bf16 v[84:87],a[136:139],a[32:35],v[84:87]
v_mfma_f32_16x16x32_bf16 v[84:87],a[132:135],a[28:31],v[84:87]
v_mfma_f32_16x16x32_bf16 v[84:87],a[128:131],a[24:27],v[84:87]
v_mfma_f32_16x16x32_bf16 v[92:95],a[128:131],a[48:51],0
v_mfma_f32_16x16x32_bf16 v[92:95],a[132:135],a[52:55],v[92:95]
buffer_load_dwordx4 v8,s[4:7],s20 offen offset:2048 lds
v_mfma_f32_16x16x32_bf16 v[92:95],a[136:139],a[56:59],v[92:95]
s_add_u32 s20,s20,12288
v_mfma_f32_16x16x32_bf16 v[92:95],a[140:143],a[60:63],v[92:95]
v_mfma_f32_16x16x32_bf16 v[92:95],a[144:147],a[64:67],v[92:95]
v_mfma_f32_16x16x32_bf16 v[92:95],a[148:151],a[68:71],v[92:95]
v_mfma_f32_16x16x32_bf16 v[100:103],a[148:151],a[92:95],0
v_mfma_f32_16x16x32_bf16 v[100:103],a[144:147],a[88:91],v[100:103]
ds_read_b64_tr_b16 a[120:121],v2 offset:24576
v_mfma_f32_16x16x32_bf16 v[100:103],a[140:143],a[84:87],v[100:103]
ds_read_b64_tr_b16 a[122:123],v2 offset:30720
v_mfma_f32_16x16x32_bf16 v[100:103],a[136:139],a[80:83],v[100:103]
ds_read_b64_tr_b16 a[124:125],v3 offset:24576
v_mfma_f32_16x16x32_bf16 v[100:103],a[132:135],a[76:79],v[100:103]
ds_read_b64_tr_b16 a[126:127],v3 offset:30720
v_mfma_f32_16x16x32_bf16 v[100:103],a[128:131],a[72:75],v[100:103]
v_mfma_f32_16x16x32_bf16 v[108:111],a[128:131],a[96:99],0
ds_read_b64_tr_b16 a[128:129],v4 offset:24576
v_mfma_f32_16x16x32_bf16 v[108:111],a[132:135],a[100:103],v[108:111]
ds_read_b64_tr_b16 a[130:131],v4 offset:30720
v_mfma_f32_16x16x32_bf16 v[108:111],a[136:139],a[104:107],v[108:111]
ds_read_b64_tr_b16 a[132:133],v5 offset:24576
v_mfma_f32_16x16x32_bf16 v[108:111],a[140:143],a[108:111],v[108:111]
ds_read_b64_tr_b16 a[134:135],v5 offset:30720
v_mfma_f32_16x16x32_bf16 v[108:111],a[144:147],a[112:115],v[108:111]
v_mfma_f32_16x16x32_bf16 v[108:111],a[148:151],a[116:119],v[108:111]
s_mov_b32 s38,0
s_branch L_loop5
L_start4:
s_add_u32 m0,s24,12288
s_waitcnt vmcnt(15)
ds_read_b128 a[0:3],v11 offset:0
buffer_load_dwordx4 v6,s[12:15],s28 offen offset:0 nt lds
ds_read_b128 a[4:7],v12 offset:0
buffer_load_dwordx4 v7,s[12:15],s28 offen offset:1024 nt lds
ds_read_b128 a[16:19],v11 offset:256
buffer_load_dwordx4 v8,s[12:15],s28 offen offset:2048 nt lds
s_add_u32 s28,s28,3072
s_add_u32 m0,s24,15360
ds_read_b128 a[20:23],v12 offset:256
buffer_load_dwordx4 v6,s[12:15],s28 offen offset:0 nt lds
ds_read_b128 a[8:11],v11 offset:128
buffer_load_dwordx4 v7,s[12:15],s28 offen offset:1024 nt lds
ds_read_b128 a[12:15],v12 offset:128
buffer_load_dwordx4 v8,s[12:15],s28 offen offset:2048 nt lds
s_add_u32 s28,s28,3072
s_add_u32 m0,s24,0
ds_read_b128 a[124:127],v1 offset:0
v_mov_b32 v60,0
ds_read_b128 a[120:123],v0 offset:0
v_mov_b32 v67,0
ds_read_b128 a[132:135],v1 offset:128
v_mov_b32 v65,0
ds_read_b128 a[136:139],v0 offset:256
v_mov_b32 v64,0
ds_read_b128 a[128:131],v0 offset:128
v_mov_b32 v66,0
ds_read_b128 a[140:143],v1 offset:256
v_mov_b32 v63,0
ds_read_b128 a[148:151],v1 offset:6144
v_mov_b32 v61,0
ds_read_b128 a[144:147],v0 offset:6144
v_mov_b32 v62,0
s_waitcnt lgkmcnt(6)
v_mfma_f32_16x16x32_bf16 v[72:75],a[120:123],a[0:3],0
ds_read_b128 a[120:123],v0 offset:6272
v_mfma_f32_16x16x32_bf16 v[72:75],a[124:127],a[4:7],v[72:75]
s_waitcnt lgkmcnt(4)
ds_read_b128 a[124:127],v1 offset:6272
v_mfma_f32_16x16x32_bf16 v[72:75],a[128:131],a[8:11],v[72:75]
ds_read_b128 a[128:131],v0 offset:6400
v_mfma_f32_16x16x32_bf16 v[72:75],a[132:135],a[12:15],v[72:75]
ds_read_b128 a[132:135],v1 offset:6400
v_mfma_f32_16x16x32_bf16 v[72:75],a[136:139],a[16:19],v[72:75]
s_waitcnt lgkmcnt(6)
ds_read_b128 a[136:139],v0 offset:12288
v_mfma_f32_16x16x32_bf16 v[72:75],a[140:143],a[20:23],v[72:75]
s_waitcnt lgkmcnt(5)
ds_read_b128 a[140:143],v1 offset:12288
v_mfma_f32_16x16x32_bf16 v[76:79],a[144:147],a[0:3],0
ds_read_b128 a[144:147],v0 offset:12416
v_mfma_f32_16x16x32_bf16 v[76:79],a[148:151],a[4:7],v[76:79]
s_waitcnt lgkmcnt(6)
ds_read_b128 a[148:151],v1 offset:12416
v_mfma_f32_16x16x32_bf16 v[76:79],a[120:123],a[8:11],v[76:79]
s_waitcnt lgkmcnt(6)
ds_read_b128 a[120:123],v0 offset:12544
v_mfma_f32_16x16x32_bf16 v[76:79],a[124:127],a[12:15],v[76:79]
s_waitcnt lgkmcnt(6)
ds_read_b128 a[124:127],v1 offset:12544
v_max3_f32 v44,v72,v73,v74
v_mfma_f32_16x16x32_bf16 v[76:79],a[128:131],a[16:19],v[76:79]
s_waitcnt lgkmcnt(6)
ds_read_b128 a[128:131],v0 offset:18432
v_mfma_f32_16x16x32_bf16 v[76:79],a[132:135],a[20:23],v[76:79]
ds_read_b128 a[132:135],v1 offset:18432
s_nop 6
v_max3_f32 v44,v44,v75,v76
v_max3_f32 v44,v44,v77,v78
v_max_f32 v44,v44,v79
v_mov_b32 v45,v44
s_nop 1
v_permlane32_swap_b32 v45,v44
v_max_f32 v44,v44,v45
v_mov_b32 v45,v44
s_nop 1
v_permlane16_swap_b32 v45,v44
v_max_f32 v44,v44,v45
v_mul_f32_e64 v13,-s36,v44
v_fma_f32 v74,v74,s36,v13
v_exp_f32 v74,v74
v_fma_f32 v75,v75,s36,v13
v_exp_f32 v75,v75
v_fma_f32 v73,v73,s36,v13
v_exp_f32 v73,v73
v_cvt_pk_bf16_f32 v21,v74,v75
v_fma_f32 v72,v72,s36,v13
v_exp_f32 v72,v72
v_fma_f32 v78,v78,s36,v13
v_cvt_pk_bf16_f32 v20,v72,v73
s_waitcnt lgkmcnt(0)
v_mfma_f32_16x16x32_bf16 v[72:75],a[136:139],a[0:3],0
ds_read_b128 a[136:139],v0 offset:18560
v_fma_f32 v76,v76,s36,v13
v_mfma_f32_16x16x32_bf16 v[72:75],a[140:143],a[4:7],v[72:75]
ds_read_b128 a[140:143],v1 offset:18560
v_exp_f32 v76,v76
v_mfma_f32_16x16x32_bf16 v[72:75],a[144:147],a[8:11],v[72:75]
ds_read_b128 a[144:147],v0 offset:18688
v_fma_f32 v79,v79,s36,v13
v_mfma_f32_16x16x32_bf16 v[72:75],a[148:151],a[12:15],v[72:75]
ds_read_b128 a[148:151],v1 offset:18688
v_exp_f32 v79,v79
v_mfma_f32_16x16x32_bf16 v[72:75],a[120:123],a[16:19],v[72:75]
v_fma_f32 v77,v77,s36,v13
v_exp_f32 v78,v78
v_mfma_f32_16x16x32_bf16 v[72:75],a[124:127],a[20:23],v[72:75]
v_cvt_pk_bf16_f32 v23,v78,v79
v_exp_f32 v77,v77
s_nop 0
v_cvt_pk_bf16_f32 v22,v76,v77
v_mfma_f32_16x16x32_bf16 v[76:79],a[128:131],a[0:3],0
v_mfma_f32_16x16x32_bf16 v[76:79],a[132:135],a[4:7],v[76:79]
s_waitcnt lgkmcnt(2)
v_mfma_f32_16x16x32_bf16 v[76:79],a[136:139],a[8:11],v[76:79]
v_mfma_f32_16x16x32_bf16 v[76:79],a[140:143],a[12:15],v[76:79]
s_waitcnt lgkmcnt(0)
v_fma_f32 v73,v73,s36,v13
v_exp_f32 v73,v73
v_mfma_f32_16x16x32_bf16 v[76:79],a[144:147],a[16:19],v[76:79]
v_fma_f32 v75,v75,s36,v13
v_exp_f32 v75,v75
v_mfma_f32_16x16x32_bf16 v[76:79],a[148:151],a[20:23],v[76:79]
s_waitcnt vmcnt(12)
s_barrier
ds_read_b64_tr_b16 a[122:123],v2 offset:6144
ds_read_b64_tr_b16 a[130:131],v4 offset:6144
ds_read_b64_tr_b16 a[120:121],v2 offset:0
ds_read_b64_tr_b16 a[126:127],v3 offset:6144
ds_read_b64_tr_b16 a[128:129],v4 offset:0
ds_read_b64_tr_b16 a[124:125],v3 offset:0
ds_read_b64_tr_b16 a[136:137],v2 offset:128
ds_read_b64_tr_b16 a[140:141],v3 offset:128
ds_read_b64_tr_b16 a[146:147],v4 offset:6272
ds_read_b64_tr_b16 a[132:133],v5 offset:0
ds_read_b64_tr_b16 a[148:149],v5 offset:128
ds_read_b64_tr_b16 a[138:139],v2 offset:6272
ds_read_b64_tr_b16 a[134:135],v5 offset:6144
ds_read_b64_tr_b16 a[144:145],v4 offset:128
ds_read_b64_tr_b16 a[142:143],v3 offset:6272
ds_read_b64_tr_b16 a[150:151],v5 offset:6272
v_fma_f32 v72,v72,s36,v13
v_exp_f32 v72,v72
s_waitcnt lgkmcnt(13)
v_mfma_f32_16x16x32_bf16 v[160:163],a[120:123],v[20:23],0
ds_read_b64_tr_b16 a[122:123],v2 offset:6400
v_cvt_pk_bf16_f32 v44,v72,v73
v_fma_f32 v74,v74,s36,v13
v_exp_f32 v74,v74
s_waitcnt lgkmcnt(11)
v_mfma_f32_16x16x32_bf16 v[164:167],a[124:127],v[20:23],0
ds_read_b64_tr_b16 a[124:125],v3 offset:256
v_cvt_pk_bf16_f32 v45,v74,v75
v_mfma_f32_16x16x32_bf16 v[168:171],a[128:131],v[20:23],0
ds_read_b64_tr_b16 a[130:131],v4 offset:6400
ds_read_b64_tr_b16 a[120:121],v2 offset:256
v_fma_f32 v78,v78,s36,v13
v_fma_f32 v76,v76,s36,v13
v_fma_f32 v77,v77,s36,v13
v_exp_f32 v77,v77
s_waitcnt lgkmcnt(7)
v_mfma_f32_16x16x32_bf16 v[172:175],a[132:135],v[20:23],0
ds_read_b64_tr_b16 a[132:133],v5 offset:256
v_fma_f32 v79,v79,s36,v13
v_mfma_f32_16x16x32_bf16 v[176:179],a[136:139],v[20:23],0
s_waitcnt lgkmcnt(5)
ds_read_b64_tr_b16 a[126:127],v3 offset:6400
v_exp_f32 v79,v79
v_mfma_f32_16x16x32_bf16 v[180:183],a[140:143],v[20:23],0
ds_read_b64_tr_b16 a[134:135],v5 offset:6400
v_exp_f32 v78,v78
ds_read_b64_tr_b16 a[128:129],v4 offset:256
v_mfma_f32_16x16x32_bf16 v[184:187],a[144:147],v[20:23],0
ds_read_b128 a[140:143],v1 offset:24576
v_cvt_pk_bf16_f32 v47,v78,v79
v_mfma_f32_16x16x32_bf16 v[188:191],a[148:151],v[20:23],0
s_waitcnt lgkmcnt(5)
ds_read_b128 a[148:151],v1 offset:24704
v_exp_f32 v76,v76
v_mfma_f32_16x16x32_bf16 v[192:195],a[120:123],v[20:23],0
s_waitcnt lgkmcnt(4)
ds_read_b128 a[136:139],v0 offset:24576
v_cvt_pk_bf16_f32 v46,v76,v77
ds_read_b128 a[120:123],v0 offset:24832
v_mfma_f32_16x16x32_bf16 v[196:199],a[124:127],v[20:23],0
s_waitcnt lgkmcnt(4)
ds_read_b128 a[144:147],v0 offset:24704
ds_read_b128 a[124:127],v1 offset:24832
v_mfma_f32_16x16x32_bf16 v[200:203],a[128:131],v[20:23],0
ds_read_b128 a[128:131],v0 offset:30720
v_mfma_f32_16x16x32_bf16 v[204:207],a[132:135],v[20:23],0
s_waitcnt lgkmcnt(4)
ds_read_b128 a[132:135],v1 offset:30720
v_mfma_f32_16x16x32_bf16 v[72:75],a[136:139],a[0:3],0
ds_read_b128 a[136:139],v0 offset:30848
v_mfma_f32_16x16x32_bf16 v[72:75],a[140:143],a[4:7],v[72:75]
s_waitcnt lgkmcnt(4)
ds_read_b128 a[140:143],v1 offset:30848
v_mfma_f32_16x16x32_bf16 v[72:75],a[144:147],a[8:11],v[72:75]
ds_read_b128 a[144:147],v0 offset:30976
v_mfma_f32_16x16x32_bf16 v[72:75],a[148:151],a[12:15],v[72:75]
ds_read_b128 a[148:151],v1 offset:30976
v_mfma_f32_16x16x32_bf16 v[72:75],a[120:123],a[16:19],v[72:75]
s_waitcnt lgkmcnt(6)
ds_read_b128 a[120:123],v0 offset:0
v_mfma_f32_16x16x32_bf16 v[72:75],a[124:127],a[20:23],v[72:75]
s_waitcnt lgkmcnt(6)
ds_read_b128 a[124:127],v1 offset:0
v_mfma_f32_16x16x32_bf16 v[76:79],a[128:131],a[0:3],0
s_waitcnt lgkmcnt(6)
ds_read_b128 a[128:131],v0 offset:128
v_mfma_f32_16x16x32_bf16 v[76:79],a[132:135],a[4:7],v[76:79]
s_waitcnt lgkmcnt(6)
ds_read_b128 a[132:135],v1 offset:128
v_mfma_f32_16x16x32_bf16 v[76:79],a[136:139],a[8:11],v[76:79]
s_waitcnt lgkmcnt(6)
ds_read_b128 a[136:139],v0 offset:256
v_mfma_f32_16x16x32_bf16 v[76:79],a[140:143],a[12:15],v[76:79]
s_waitcnt lgkmcnt(6)
ds_read_b128 a[140:143],v1 offset:256
v_fma_f32 v73,v73,s36,v13
v_mfma_f32_16x16x32_bf16 v[76:79],a[144:147],a[16:19],v[76:79]
s_waitcnt lgkmcnt(6)
ds_read_b128 a[144:147],v0 offset:6144
v_fma_f32 v75,v75,s36,v13
v_mfma_f32_16x16x32_bf16 v[76:79],a[148:151],a[20:23],v[76:79]
s_waitcnt vmcnt(6)
ds_read_b128 a[40:43],v11 offset:6400
buffer_load_dwordx4 v6,s[12:15],s28 offen offset:0 nt lds
ds_read_b128 a[24:27],v11 offset:6144
buffer_load_dwordx4 v7,s[12:15],s28 offen offset:1024 nt lds
ds_read_b128 a[28:31],v12 offset:6144
buffer_load_dwordx4 v8,s[12:15],s28 offen offset:2048 nt lds
s_add_u32 s28,s28,3072
s_add_u32 m0,s24,3072
ds_read_b128 a[36:39],v12 offset:6272
buffer_load_dwordx4 v6,s[12:15],s28 offen offset:0 nt lds
ds_read_b128 a[32:35],v11 offset:6272
buffer_load_dwordx4 v7,s[12:15],s28 offen offset:1024 nt lds
ds_read_b128 a[44:47],v12 offset:6400
buffer_load_dwordx4 v8,s[12:15],s28 offen offset:2048 nt lds
s_add_u32 s28,s28,3072
s_add_u32 m0,s23,12288
ds_read_b128 a[148:151],v1 offset:6144
v_exp_f32 v75,v75
v_fma_f32 v72,v72,s36,v13
v_exp_f32 v72,v72
s_waitcnt lgkmcnt(5)
v_mfma_f32_16x16x32_bf16 v[80:83],a[120:123],a[24:27],0
s_waitcnt lgkmcnt(4)
ds_read_b128 a[120:123],v0 offset:6272
v_exp_f32 v73,v73
v_mfma_f32_16x16x32_bf16 v[80:83],a[124:127],a[28:31],v[80:83]
s_waitcnt lgkmcnt(3)
ds_read_b128 a[124:127],v1 offset:6272
v_fma_f32 v74,v74,s36,v13
v_exp_f32 v74,v74
v_mfma_f32_16x16x32_bf16 v[80:83],a[128:131],a[32:35],v[80:83]
ds_read_b128 a[128:131],v0 offset:6400
v_mfma_f32_16x16x32_bf16 v[80:83],a[132:135],a[36:39],v[80:83]
ds_read_b128 a[132:135],v1 offset:6400
v_mfma_f32_16x16x32_bf16 v[80:83],a[136:139],a[40:43],v[80:83]
s_waitcnt lgkmcnt(4)
ds_read_b128 a[136:139],v0 offset:12288
v_mfma_f32_16x16x32_bf16 v[80:83],a[140:143],a[44:47],v[80:83]
ds_read_b128 a[140:143],v1 offset:12288
v_mfma_f32_16x16x32_bf16 v[84:87],a[144:147],a[24:27],0
ds_read_b128 a[144:147],v0 offset:12416
v_mfma_f32_16x16x32_bf16 v[84:87],a[148:151],a[28:31],v[84:87]
s_waitcnt lgkmcnt(6)
ds_read_b128 a[148:151],v1 offset:12416
v_mfma_f32_16x16x32_bf16 v[84:87],a[120:123],a[32:35],v[84:87]
s_waitcnt lgkmcnt(6)
ds_read_b128 a[120:123],v0 offset:12544
v_mfma_f32_16x16x32_bf16 v[84:87],a[124:127],a[36:39],v[84:87]
s_waitcnt lgkmcnt(6)
ds_read_b128 a[124:127],v1 offset:12544
v_max3_f32 v48,v80,v81,v82
v_mfma_f32_16x16x32_bf16 v[84:87],a[128:131],a[40:43],v[84:87]
s_waitcnt lgkmcnt(6)
ds_read_b128 a[128:131],v0 offset:18432
v_mfma_f32_16x16x32_bf16 v[84:87],a[132:135],a[44:47],v[84:87]
ds_read_b128 a[132:135],v1 offset:18432
s_nop 6
v_max3_f32 v48,v48,v83,v84
v_max3_f32 v48,v48,v85,v86
v_max_f32 v48,v48,v87
v_mov_b32 v49,v48
s_nop 1
v_permlane32_swap_b32 v49,v48
v_max_f32 v48,v48,v49
v_mov_b32 v49,v48
s_nop 1
v_permlane16_swap_b32 v49,v48
v_max_f32 v48,v48,v49
v_mul_f32_e64 v14,-s36,v48
v_fma_f32 v81,v81,s36,v14
v_exp_f32 v81,v81
v_fma_f32 v82,v82,s36,v14
v_fma_f32 v83,v83,s36,v14
v_exp_f32 v83,v83
v_exp_f32 v82,v82
v_fma_f32 v80,v80,s36,v14
v_exp_f32 v80,v80
v_cvt_pk_bf16_f32 v25,v82,v83
v_cvt_pk_bf16_f32 v24,v80,v81
s_waitcnt lgkmcnt(0)
v_mfma_f32_16x16x32_bf16 v[80:83],a[136:139],a[24:27],0
ds_read_b128 a[136:139],v0 offset:18560
v_fma_f32 v85,v85,s36,v14
v_mfma_f32_16x16x32_bf16 v[80:83],a[140:143],a[28:31],v[80:83]
ds_read_b128 a[140:143],v1 offset:18560
v_fma_f32 v87,v87,s36,v14
v_mfma_f32_16x16x32_bf16 v[80:83],a[144:147],a[32:35],v[80:83]
ds_read_b128 a[144:147],v0 offset:18688
v_exp_f32 v87,v87
v_mfma_f32_16x16x32_bf16 v[80:83],a[148:151],a[36:39],v[80:83]
ds_read_b128 a[148:151],v1 offset:18688
v_fma_f32 v86,v86,s36,v14
v_mfma_f32_16x16x32_bf16 v[80:83],a[120:123],a[40:43],v[80:83]
ds_read_b64_tr_b16 a[120:121],v2 offset:0
v_fma_f32 v84,v84,s36,v14
v_mfma_f32_16x16x32_bf16 v[80:83],a[124:127],a[44:47],v[80:83]
ds_read_b64_tr_b16 a[124:125],v3 offset:0
ds_read_b64_tr_b16 a[126:127],v3 offset:6144
ds_read_b64_tr_b16 a[122:123],v2 offset:6144
v_exp_f32 v84,v84
v_exp_f32 v85,v85
v_exp_f32 v86,v86
v_cvt_pk_bf16_f32 v26,v84,v85
v_cvt_pk_bf16_f32 v27,v86,v87
v_mfma_f32_16x16x32_bf16 v[84:87],a[128:131],a[24:27],0
ds_read_b64_tr_b16 a[130:131],v4 offset:6144
v_fma_f32 v81,v81,s36,v14
v_smfmac_f32_16x16x64_bf16 v[60:63],a[152:155],v[20:27],v18
ds_read_b64_tr_b16 a[128:129],v4 offset:0
v_mfma_f32_16x16x32_bf16 v[84:87],a[132:135],a[28:31],v[84:87]
s_waitcnt lgkmcnt(6)
ds_read_b64_tr_b16 a[132:133],v5 offset:0
v_fma_f32 v80,v80,s36,v14
v_mfma_f32_16x16x32_bf16 v[84:87],a[136:139],a[32:35],v[84:87]
ds_read_b64_tr_b16 a[134:135],v5 offset:6144
v_exp_f32 v80,v80
v_mfma_f32_16x16x32_bf16 v[84:87],a[140:143],a[36:39],v[84:87]
ds_read_b64_tr_b16 a[140:141],v3 offset:128
v_exp_f32 v81,v81
v_mfma_f32_16x16x32_bf16 v[84:87],a[144:147],a[40:43],v[84:87]
ds_read_b64_tr_b16 a[146:147],v4 offset:6272
v_fma_f32 v82,v82,s36,v14
v_mfma_f32_16x16x32_bf16 v[84:87],a[148:151],a[44:47],v[84:87]
s_waitcnt lgkmcnt(5)
ds_read_b64_tr_b16 a[148:149],v5 offset:128
v_exp_f32 v82,v82
v_mfma_f32_16x16x32_bf16 v[208:211],a[120:123],v[24:27],0
ds_read_b64_tr_b16 a[122:123],v2 offset:6400
v_cvt_pk_bf16_f32 v48,v80,v81
ds_read_b64_tr_b16 a[136:137],v2 offset:128
ds_read_b64_tr_b16 a[138:139],v2 offset:6272
ds_read_b64_tr_b16 a[142:143],v3 offset:6272
v_mfma_f32_16x16x32_bf16 v[212:215],a[124:127],v[24:27],0
s_waitcnt lgkmcnt(7)
ds_read_b64_tr_b16 a[150:151],v5 offset:6272
ds_read_b64_tr_b16 a[144:145],v4 offset:128
v_mfma_f32_16x16x32_bf16 v[216:219],a[128:131],v[24:27],0
ds_read_b64_tr_b16 a[128:129],v4 offset:256
v_fma_f32 v83,v83,s36,v14
v_mfma_f32_16x16x32_bf16 v[220:223],a[132:135],v[24:27],0
ds_read_b64_tr_b16 a[132:133],v5 offset:256
ds_read_b64_tr_b16 a[134:135],v5 offset:6400
ds_read_b64_tr_b16 a[120:121],v2 offset:256
ds_read_b64_tr_b16 a[126:127],v3 offset:6400
ds_read_b64_tr_b16 a[124:125],v3 offset:256
ds_read_b64_tr_b16 a[130:131],v4 offset:6400
v_exp_f32 v83,v83
v_fma_f32 v87,v87,s36,v14
v_cvt_pk_bf16_f32 v49,v82,v83
v_fma_f32 v85,v85,s36,v14
s_waitcnt lgkmcnt(10)
v_mfma_f32_16x16x32_bf16 v[224:227],a[136:139],v[24:27],0
s_waitcnt lgkmcnt(9)
ds_read_b128 a[136:139],v0 offset:24576
v_exp_f32 v85,v85
v_mfma_f32_16x16x32_bf16 v[228:231],a[140:143],v[24:27],0
s_waitcnt lgkmcnt(8)
ds_read_b128 a[140:143],v1 offset:24576
v_exp_f32 v87,v87
v_mfma_f32_16x16x32_bf16 v[232:235],a[144:147],v[24:27],0
ds_read_b128 a[144:147],v0 offset:24704
v_fma_f32 v86,v86,s36,v14
v_mfma_f32_16x16x32_bf16 v[236:239],a[148:151],v[24:27],0
s_waitcnt lgkmcnt(5)
ds_read_b128 a[148:151],v1 offset:24704
v_exp_f32 v86,v86
v_mfma_f32_16x16x32_bf16 v[240:243],a[120:123],v[24:27],0
s_waitcnt lgkmcnt(4)
ds_read_b128 a[120:123],v0 offset:24832
v_cvt_pk_bf16_f32 v51,v86,v87
v_mfma_f32_16x16x32_bf16 v[244:247],a[124:127],v[24:27],0
ds_read_b128 a[124:127],v1 offset:24832
v_fma_f32 v84,v84,s36,v14
v_mfma_f32_16x16x32_bf16 v[248:251],a[128:131],v[24:27],0
ds_read_b128 a[128:131],v0 offset:30720
v_exp_f32 v84,v84
v_mfma_f32_16x16x32_bf16 v[252:255],a[132:135],v[24:27],0
s_waitcnt lgkmcnt(5)
ds_read_b128 a[132:135],v1 offset:30720
v_cvt_pk_bf16_f32 v50,v84,v85
v_mfma_f32_16x16x32_bf16 v[80:83],a[136:139],a[24:27],0
ds_read_b128 a[136:139],v0 offset:30848
v_cvt_pk_bf16_f32 v21,v74,v75
v_smfmac_f32_16x16x64_bf16 v[60:63],a[152:155],v[44:51],v18
v_cvt_pk_bf16_f32 v20,v72,v73
v_mfma_f32_16x16x32_bf16 v[80:83],a[140:143],a[28:31],v[80:83]
s_waitcnt lgkmcnt(5)
ds_read_b128 a[140:143],v1 offset:30848
v_mfma_f32_16x16x32_bf16 v[80:83],a[144:147],a[32:35],v[80:83]
ds_read_b128 a[144:147],v0 offset:30976
v_mfma_f32_16x16x32_bf16 v[80:83],a[148:151],a[36:39],v[80:83]
s_waitcnt lgkmcnt(5)
ds_read_b128 a[148:151],v1 offset:30976
v_mfma_f32_16x16x32_bf16 v[80:83],a[120:123],a[40:43],v[80:83]
ds_read_b128 a[120:123],v0 offset:0
v_mfma_f32_16x16x32_bf16 v[80:83],a[124:127],a[44:47],v[80:83]
s_waitcnt lgkmcnt(5)
ds_read_b128 a[124:127],v1 offset:0
v_mfma_f32_16x16x32_bf16 v[84:87],a[128:131],a[24:27],0
ds_read_b128 a[128:131],v0 offset:128
v_mfma_f32_16x16x32_bf16 v[84:87],a[132:135],a[28:31],v[84:87]
s_waitcnt lgkmcnt(6)
ds_read_b128 a[132:135],v1 offset:128
v_mfma_f32_16x16x32_bf16 v[84:87],a[136:139],a[32:35],v[84:87]
s_waitcnt lgkmcnt(6)
ds_read_b128 a[136:139],v0 offset:256
v_mfma_f32_16x16x32_bf16 v[84:87],a[140:143],a[36:39],v[84:87]
s_waitcnt lgkmcnt(6)
ds_read_b128 a[140:143],v1 offset:256
v_fma_f32 v80,v80,s36,v14
v_mfma_f32_16x16x32_bf16 v[84:87],a[144:147],a[40:43],v[84:87]
s_waitcnt lgkmcnt(6)
ds_read_b128 a[144:147],v0 offset:6144
v_exp_f32 v80,v80
v_mfma_f32_16x16x32_bf16 v[84:87],a[148:151],a[44:47],v[84:87]
s_waitcnt vmcnt(6)
ds_read_b128 a[52:55],v12 offset:12288
buffer_load_dwordx4 v6,s[8:11],s21 offen offset:0 lds
ds_read_b128 a[64:67],v11 offset:12544
buffer_load_dwordx4 v7,s[8:11],s21 offen offset:1024 lds
ds_read_b128 a[60:63],v12 offset:12416
buffer_load_dwordx4 v8,s[8:11],s21 offen offset:2048 lds
s_add_u32 s21,s21,12288
s_add_u32 m0,s23,24576
ds_read_b128 a[48:51],v11 offset:12288
v_fma_f32 v81,v81,s36,v14
ds_read_b128 a[56:59],v11 offset:12416
v_exp_f32 v81,v81
ds_read_b128 a[68:71],v12 offset:12544
v_cvt_pk_bf16_f32 v24,v80,v81
ds_read_b128 a[148:151],v1 offset:6144
s_waitcnt lgkmcnt(3)
v_mfma_f32_16x16x32_bf16 v[88:91],a[120:123],a[48:51],0
ds_read_b128 a[120:123],v0 offset:6272
v_mfma_f32_16x16x32_bf16 v[88:91],a[124:127],a[52:55],v[88:91]
s_waitcnt lgkmcnt(3)
ds_read_b128 a[124:127],v1 offset:6272
v_mfma_f32_16x16x32_bf16 v[88:91],a[128:131],a[56:59],v[88:91]
ds_read_b128 a[128:131],v0 offset:6400
v_mfma_f32_16x16x32_bf16 v[88:91],a[132:135],a[60:63],v[88:91]
ds_read_b128 a[132:135],v1 offset:6400
v_mfma_f32_16x16x32_bf16 v[88:91],a[136:139],a[64:67],v[88:91]
s_waitcnt lgkmcnt(5)
ds_read_b128 a[136:139],v0 offset:12288
v_mfma_f32_16x16x32_bf16 v[88:91],a[140:143],a[68:71],v[88:91]
ds_read_b128 a[140:143],v1 offset:12288
v_mfma_f32_16x16x32_bf16 v[92:95],a[144:147],a[48:51],0
s_waitcnt lgkmcnt(6)
ds_read_b128 a[144:147],v0 offset:12416
v_mfma_f32_16x16x32_bf16 v[92:95],a[148:151],a[52:55],v[92:95]
s_waitcnt lgkmcnt(6)
ds_read_b128 a[148:151],v1 offset:12416
v_mfma_f32_16x16x32_bf16 v[92:95],a[120:123],a[56:59],v[92:95]
s_waitcnt lgkmcnt(6)
ds_read_b128 a[120:123],v0 offset:12544
v_mfma_f32_16x16x32_bf16 v[92:95],a[124:127],a[60:63],v[92:95]
s_waitcnt lgkmcnt(6)
ds_read_b128 a[124:127],v1 offset:12544
v_max3_f32 v52,v88,v89,v90
v_mfma_f32_16x16x32_bf16 v[92:95],a[128:131],a[64:67],v[92:95]
s_waitcnt lgkmcnt(6)
ds_read_b128 a[128:131],v0 offset:18432
v_mfma_f32_16x16x32_bf16 v[92:95],a[132:135],a[68:71],v[92:95]
ds_read_b128 a[132:135],v1 offset:18432
s_nop 6
v_max3_f32 v52,v52,v91,v92
v_max3_f32 v52,v52,v93,v94
v_max_f32 v52,v52,v95
v_mov_b32 v53,v52
s_nop 1
v_permlane32_swap_b32 v53,v52
v_max_f32 v52,v52,v53
v_mov_b32 v53,v52
s_nop 1
v_permlane16_swap_b32 v53,v52
v_max_f32 v52,v52,v53
v_mul_f32_e64 v15,-s36,v52
v_fma_f32 v89,v89,s36,v15
v_exp_f32 v89,v89
v_fma_f32 v91,v91,s36,v15
v_fma_f32 v88,v88,s36,v15
v_exp_f32 v88,v88
v_exp_f32 v91,v91
v_cvt_pk_bf16_f32 v28,v88,v89
v_fma_f32 v90,v90,s36,v15
v_exp_f32 v90,v90
v_fma_f32 v94,v94,s36,v15
v_cvt_pk_bf16_f32 v29,v90,v91
s_waitcnt lgkmcnt(0)
v_mfma_f32_16x16x32_bf16 v[88:91],a[136:139],a[48:51],0
ds_read_b128 a[136:139],v0 offset:18560
v_exp_f32 v94,v94
v_mfma_f32_16x16x32_bf16 v[88:91],a[140:143],a[52:55],v[88:91]
ds_read_b128 a[140:143],v1 offset:18560
v_fma_f32 v92,v92,s36,v15
v_mfma_f32_16x16x32_bf16 v[88:91],a[144:147],a[56:59],v[88:91]
ds_read_b128 a[144:147],v0 offset:18688
v_fma_f32 v93,v93,s36,v15
v_mfma_f32_16x16x32_bf16 v[88:91],a[148:151],a[60:63],v[88:91]
ds_read_b128 a[148:151],v1 offset:18688
v_fma_f32 v95,v95,s36,v15
v_mfma_f32_16x16x32_bf16 v[88:91],a[120:123],a[64:67],v[88:91]
ds_read_b64_tr_b16 a[122:123],v2 offset:6144
v_exp_f32 v93,v93
v_mfma_f32_16x16x32_bf16 v[88:91],a[124:127],a[68:71],v[88:91]
ds_read_b64_tr_b16 a[124:125],v3 offset:0
ds_read_b64_tr_b16 a[120:121],v2 offset:0
ds_read_b64_tr_b16 a[126:127],v3 offset:6144
v_exp_f32 v95,v95
v_exp_f32 v92,v92
v_cvt_pk_bf16_f32 v31,v94,v95
v_cvt_pk_bf16_f32 v30,v92,v93
v_mfma_f32_16x16x32_bf16 v[92:95],a[128:131],a[48:51],0
ds_read_b64_tr_b16 a[130:131],v4 offset:6144
v_fma_f32 v89,v89,s36,v15
v_mfma_f32_16x16x32_bf16 v[92:95],a[132:135],a[52:55],v[92:95]
s_waitcnt lgkmcnt(6)
ds_read_b64_tr_b16 a[134:135],v5 offset:6144
v_fma_f32 v90,v90,s36,v15
v_mfma_f32_16x16x32_bf16 v[92:95],a[136:139],a[56:59],v[92:95]
ds_read_b64_tr_b16 a[128:129],v4 offset:0
v_exp_f32 v90,v90
v_mfma_f32_16x16x32_bf16 v[92:95],a[140:143],a[60:63],v[92:95]
ds_read_b64_tr_b16 a[136:137],v2 offset:128
v_fma_f32 v91,v91,s36,v15
v_mfma_f32_16x16x32_bf16 v[92:95],a[144:147],a[64:67],v[92:95]
s_waitcnt lgkmcnt(4)
ds_read_b64_tr_b16 a[132:133],v5 offset:0
v_exp_f32 v91,v91
v_mfma_f32_16x16x32_bf16 v[92:95],a[148:151],a[68:71],v[92:95]
ds_read_b64_tr_b16 a[142:143],v3 offset:6272
v_cvt_pk_bf16_f32 v53,v90,v91
v_mfma_f32_16x16x32_bf16 v[112:115],a[120:123],v[28:31],0
ds_read_b64_tr_b16 a[140:141],v3 offset:128
v_exp_f32 v89,v89
ds_read_b64_tr_b16 a[138:139],v2 offset:6272
v_mfma_f32_16x16x32_bf16 v[116:119],a[124:127],v[28:31],0
ds_read_b64_tr_b16 a[148:149],v5 offset:128
v_fma_f32 v88,v88,s36,v15
v_exp_f32 v88,v88
ds_read_b64_tr_b16 a[146:147],v4 offset:6272
ds_read_b64_tr_b16 a[144:145],v4 offset:128
ds_read_b64_tr_b16 a[150:151],v5 offset:6272
s_waitcnt lgkmcnt(8)
v_mfma_f32_16x16x32_bf16 v[120:123],a[128:131],v[28:31],0
s_waitcnt lgkmcnt(7)
ds_read_b64_tr_b16 a[122:123],v2 offset:6400
ds_read_b64_tr_b16 a[120:121],v2 offset:256
v_mfma_f32_16x16x32_bf16 v[124:127],a[132:135],v[28:31],0
ds_read_b64_tr_b16 a[124:125],v3 offset:256
ds_read_b64_tr_b16 a[126:127],v3 offset:6400
ds_read_b64_tr_b16 a[130:131],v4 offset:6400
v_cvt_pk_bf16_f32 v52,v88,v89
v_fma_f32 v92,v92,s36,v15
v_fma_f32 v95,v95,s36,v15
v_fma_f32 v93,v93,s36,v15
s_waitcnt lgkmcnt(9)
v_mfma_f32_16x16x32_bf16 v[128:131],a[136:139],v[28:31],0
ds_read_b128 a[136:139],v0 offset:24576
v_fma_f32 v94,v94,s36,v15
v_mfma_f32_16x16x32_bf16 v[132:135],a[140:143],v[28:31],0
ds_read_b128 a[140:143],v1 offset:24576
v_exp_f32 v94,v94
ds_read_b64_tr_b16 a[128:129],v4 offset:256
ds_read_b64_tr_b16 a[134:135],v5 offset:6400
ds_read_b64_tr_b16 a[132:133],v5 offset:256
s_waitcnt lgkmcnt(10)
v_mfma_f32_16x16x32_bf16 v[136:139],a[144:147],v[28:31],0
ds_read_b128 a[144:147],v0 offset:24704
v_exp_f32 v95,v95
v_mfma_f32_16x16x32_bf16 v[140:143],a[148:151],v[28:31],0
s_waitcnt lgkmcnt(6)
ds_read_b128 a[148:151],v1 offset:24704
v_exp_f32 v92,v92
v_mfma_f32_16x16x32_bf16 v[144:147],a[120:123],v[28:31],0
ds_read_b128 a[120:123],v0 offset:24832
v_cvt_pk_bf16_f32 v55,v94,v95
v_mfma_f32_16x16x32_bf16 v[148:151],a[124:127],v[28:31],0
s_waitcnt lgkmcnt(5)
ds_read_b128 a[124:127],v1 offset:24832
v_exp_f32 v93,v93
v_mfma_f32_16x16x32_bf16 v[152:155],a[128:131],v[28:31],0
s_waitcnt lgkmcnt(4)
ds_read_b128 a[128:131],v0 offset:30720
v_cvt_pk_bf16_f32 v54,v92,v93
v_mfma_f32_16x16x32_bf16 v[156:159],a[132:135],v[28:31],0
ds_read_b128 a[132:135],v1 offset:30720
v_mfma_f32_16x16x32_bf16 v[88:91],a[136:139],a[48:51],0
ds_read_b128 a[136:139],v0 offset:30848
v_mfma_f32_16x16x32_bf16 v[88:91],a[140:143],a[52:55],v[88:91]
s_waitcnt lgkmcnt(5)
ds_read_b128 a[140:143],v1 offset:30848
v_mfma_f32_16x16x32_bf16 v[88:91],a[144:147],a[56:59],v[88:91]
ds_read_b128 a[144:147],v0 offset:30976
v_mfma_f32_16x16x32_bf16 v[88:91],a[148:151],a[60:63],v[88:91]
s_waitcnt lgkmcnt(6)
ds_read_b128 a[148:151],v1 offset:30976
v_mfma_f32_16x16x32_bf16 v[88:91],a[120:123],a[64:67],v[88:91]
s_waitcnt lgkmcnt(6)
ds_read_b128 a[120:123],v0 offset:0
v_mfma_f32_16x16x32_bf16 v[88:91],a[124:127],a[68:71],v[88:91]
s_waitcnt lgkmcnt(6)
ds_read_b128 a[124:127],v1 offset:0
v_mfma_f32_16x16x32_bf16 v[92:95],a[128:131],a[48:51],0
s_waitcnt lgkmcnt(6)
ds_read_b128 a[128:131],v0 offset:128
v_mfma_f32_16x16x32_bf16 v[92:95],a[132:135],a[52:55],v[92:95]
s_waitcnt lgkmcnt(6)
ds_read_b128 a[132:135],v1 offset:128
v_mfma_f32_16x16x32_bf16 v[92:95],a[136:139],a[56:59],v[92:95]
s_waitcnt lgkmcnt(6)
ds_read_b128 a[136:139],v0 offset:256
v_mfma_f32_16x16x32_bf16 v[92:95],a[140:143],a[60:63],v[92:95]
s_waitcnt lgkmcnt(6)
ds_read_b128 a[140:143],v1 offset:256
v_mfma_f32_16x16x32_bf16 v[92:95],a[144:147],a[64:67],v[92:95]
s_waitcnt lgkmcnt(6)
ds_read_b128 a[144:147],v0 offset:6144
v_mfma_f32_16x16x32_bf16 v[92:95],a[148:151],a[68:71],v[92:95]
s_waitcnt vmcnt(3)
ds_read_b128 a[72:75],v11 offset:0
buffer_load_dwordx4 v6,s[8:11],s21 offen offset:0 lds
ds_read_b128 a[76:79],v12 offset:0
buffer_load_dwordx4 v7,s[8:11],s21 offen offset:1024 lds
ds_read_b128 a[92:95],v12 offset:256
buffer_load_dwordx4 v8,s[8:11],s21 offen offset:2048 lds
s_add_u32 s21,s21,12288
ds_read_b128 a[80:83],v11 offset:128
s_add_u32 m0,s22,0
ds_read_b128 a[88:91],v11 offset:256
ds_read_b128 a[84:87],v12 offset:128
ds_read_b128 a[148:151],v1 offset:6144
s_waitcnt lgkmcnt(6)
v_mfma_f32_16x16x32_bf16 v[96:99],a[120:123],a[72:75],0
s_waitcnt lgkmcnt(5)
ds_read_b128 a[120:123],v0 offset:6272
v_mfma_f32_16x16x32_bf16 v[96:99],a[124:127],a[76:79],v[96:99]
s_waitcnt lgkmcnt(4)
ds_read_b128 a[124:127],v1 offset:6272
v_mfma_f32_16x16x32_bf16 v[96:99],a[128:131],a[80:83],v[96:99]
s_waitcnt lgkmcnt(3)
ds_read_b128 a[128:131],v0 offset:6400
v_mfma_f32_16x16x32_bf16 v[96:99],a[132:135],a[84:87],v[96:99]
ds_read_b128 a[132:135],v1 offset:6400
s_waitcnt vmcnt(3)
v_mfma_f32_16x16x32_bf16 v[96:99],a[136:139],a[88:91],v[96:99]
v_mfma_f32_16x16x32_bf16 v[96:99],a[140:143],a[92:95],v[96:99]
v_mfma_f32_16x16x32_bf16 v[100:103],a[144:147],a[72:75],0
s_waitcnt lgkmcnt(4)
v_mfma_f32_16x16x32_bf16 v[100:103],a[148:151],a[76:79],v[100:103]
s_waitcnt lgkmcnt(3)
v_mfma_f32_16x16x32_bf16 v[100:103],a[120:123],a[80:83],v[100:103]
s_waitcnt lgkmcnt(2)
v_mfma_f32_16x16x32_bf16 v[100:103],a[124:127],a[84:87],v[100:103]
s_waitcnt lgkmcnt(1)
v_mfma_f32_16x16x32_bf16 v[100:103],a[128:131],a[88:91],v[100:103]
s_waitcnt lgkmcnt(0)
v_mfma_f32_16x16x32_bf16 v[100:103],a[132:135],a[92:95],v[100:103]
s_barrier
buffer_load_dwordx4 v6,s[4:7],s20 offen offset:0 lds
buffer_load_dwordx4 v7,s[4:7],s20 offen offset:1024 lds
buffer_load_dwordx4 v8,s[4:7],s20 offen offset:2048 lds
ds_read_b128 a[136:139],v0 offset:12288
v_max3_f32 v56,v96,v97,v98
ds_read_b128 a[144:147],v0 offset:12416
s_add_u32 s20,s20,12288
ds_read_b128 a[120:123],v0 offset:12544
v_max3_f32 v56,v56,v99,v100
ds_read_b128 a[124:127],v1 offset:12544
v_max3_f32 v56,v56,v101,v102
ds_read_b128 a[140:143],v1 offset:12288
v_max_f32 v56,v56,v103
ds_read_b128 a[148:151],v1 offset:12416
v_mov_b32 v57,v56
ds_read_b128 a[132:135],v1 offset:18432
s_mov_b32 s27,166723584
ds_read_b128 a[128:131],v0 offset:18432
v_permlane32_swap_b32 v57,v56
v_max_f32 v56,v56,v57
v_mov_b32 v57,v56
s_mov_b32 s42,s41
s_add_u32 s69,s69,1
v_permlane16_swap_b32 v57,v56
v_max_f32 v56,v56,v57
v_mul_f32_e64 v16,-s36,v56
v_fma_f32 v99,v99,s36,v16
v_fma_f32 v96,v96,s36,v16
v_exp_f32 v99,v99
v_fma_f32 v98,v98,s36,v16
v_exp_f32 v98,v98
v_fma_f32 v97,v97,s36,v16
v_exp_f32 v97,v97
v_fma_f32 v100,v100,s36,v16
v_cvt_pk_bf16_f32 v33,v98,v99
v_exp_f32 v96,v96
v_fma_f32 v102,v102,s36,v16
v_cvt_pk_bf16_f32 v32,v96,v97
s_waitcnt lgkmcnt(2)
v_mfma_f32_16x16x32_bf16 v[96:99],a[136:139],a[72:75],0
s_lshl_b32 s62,s69,5
ds_read_b128 a[136:139],v0 offset:18560
v_exp_f32 v102,v102
v_mfma_f32_16x16x32_bf16 v[96:99],a[140:143],a[76:79],v[96:99]
s_add_u32 s62,s62,s34
ds_read_b128 a[140:143],v1 offset:18560
v_fma_f32 v103,v103,s36,v16
v_mfma_f32_16x16x32_bf16 v[96:99],a[144:147],a[80:83],v[96:99]
s_mul_i32 s63,s62,171
ds_read_b128 a[144:147],v0 offset:18688
v_exp_f32 v103,v103
v_mfma_f32_16x16x32_bf16 v[96:99],a[148:151],a[84:87],v[96:99]
s_lshr_b32 s63,s63,9
ds_read_b128 a[148:151],v1 offset:18688
v_fma_f32 v101,v101,s36,v16
v_mfma_f32_16x16x32_bf16 v[96:99],a[120:123],a[88:91],v[96:99]
s_mul_i32 s64,s63,3
ds_read_b64_tr_b16 a[120:121],v2 offset:0
v_cvt_pk_bf16_f32 v35,v102,v103
v_mfma_f32_16x16x32_bf16 v[96:99],a[124:127],a[92:95],v[96:99]
s_sub_u32 s62,s62,s64
ds_read_b64_tr_b16 a[124:125],v3 offset:0
ds_read_b64_tr_b16 a[126:127],v3 offset:6144
ds_read_b64_tr_b16 a[122:123],v2 offset:6144
v_exp_f32 v100,v100
v_exp_f32 v101,v101
s_add_u32 s63,s63,s33
v_cvt_pk_bf16_f32 v34,v100,v101
s_waitcnt lgkmcnt(7)
v_mfma_f32_16x16x32_bf16 v[100:103],a[128:131],a[72:75],0
s_mul_i32 s30,s63,196608
ds_read_b64_tr_b16 a[128:129],v4 offset:0
v_fma_f32 v97,v97,s36,v16
v_smfmac_f32_16x16x64_bf16 v[64:67],a[152:155],v[28:35],v18
s_mul_i32 s41,s63,325632
s_lshl_b32 s63,s3,2
ds_read_b64_tr_b16 a[130:131],v4 offset:6144
v_mfma_f32_16x16x32_bf16 v[100:103],a[132:135],a[76:79],v[100:103]
s_add_u32 s64,s63,21
ds_read_b64_tr_b16 a[132:133],v5 offset:0
v_fma_f32 v96,v96,s36,v16
v_mfma_f32_16x16x32_bf16 v[100:103],a[136:139],a[80:83],v[100:103]
s_cmp_eq_u32 s3,0
ds_read_b64_tr_b16 a[134:135],v5 offset:6144
v_fma_f32 v99,v99,s36,v16
s_waitcnt lgkmcnt(7)
v_mfma_f32_16x16x32_bf16 v[100:103],a[140:143],a[84:87],v[100:103]
s_cselect_b32 s64,20,s64
ds_read_b64_tr_b16 a[140:141],v3 offset:128
v_exp_f32 v97,v97
v_mfma_f32_16x16x32_bf16 v[100:103],a[144:147],a[88:91],v[100:103]
s_cselect_b32 s40,1,0
ds_read_b64_tr_b16 a[136:137],v2 offset:128
v_fma_f32 v98,v98,s36,v16
v_mfma_f32_16x16x32_bf16 v[100:103],a[148:151],a[92:95],v[100:103]
s_add_u32 s65,s63,37
ds_read_b64_tr_b16 a[148:149],v5 offset:128
v_exp_f32 v98,v98
s_waitcnt lgkmcnt(7)
v_mfma_f32_16x16x32_bf16 a[160:163],a[120:123],v[32:35],0
s_cmp_eq_u32 s62,2
ds_read_b64_tr_b16 a[122:123],v2 offset:6400
v_exp_f32 v99,v99
ds_read_b64_tr_b16 a[138:139],v2 offset:6272
v_mfma_f32_16x16x32_bf16 a[164:167],a[124:127],v[32:35],0
s_cselect_b32 s64,s65,s64
ds_read_b64_tr_b16 a[120:121],v2 offset:256
ds_read_b64_tr_b16 a[142:143],v3 offset:6272
s_waitcnt lgkmcnt(7)
v_mfma_f32_16x16x32_bf16 a[168:171],a[128:131],v[32:35],0
s_cselect_b32 s40,0,s40
ds_read_b64_tr_b16 a[126:127],v3 offset:6400
ds_read_b64_tr_b16 a[146:147],v4 offset:6272
ds_read_b64_tr_b16 a[144:145],v4 offset:128
ds_read_b64_tr_b16 a[150:151],v5 offset:6272
v_mfma_f32_16x16x32_bf16 a[172:175],a[132:135],v[32:35],0
s_add_u32 s65,s63,s3
ds_read_b64_tr_b16 a[128:129],v4 offset:256
ds_read_b64_tr_b16 a[130:131],v4 offset:6400
ds_read_b64_tr_b16 a[134:135],v5 offset:6400
ds_read_b64_tr_b16 a[124:125],v3 offset:256
ds_read_b64_tr_b16 a[132:133],v5 offset:256
s_waitcnt vmcnt(6)
v_cvt_pk_bf16_f32 v57,v98,v99
v_exp_f32 v96,v96
s_waitcnt lgkmcnt(11)
v_mfma_f32_16x16x32_bf16 a[176:179],a[136:139],v[32:35],0
s_cmp_eq_u32 s62,0
v_cvt_pk_bf16_f32 v56,v96,v97
v_fma_f32 v102,v102,s36,v16
v_exp_f32 v102,v102
s_waitcnt lgkmcnt(9)
v_mfma_f32_16x16x32_bf16 a[180:183],a[140:143],v[32:35],0
s_cselect_b32 s64,s65,s64
v_fma_f32 v100,v100,s36,v16
v_fma_f32 v101,v101,s36,v16
v_fma_f32 v103,v103,s36,v16
v_exp_f32 v103,v103
s_waitcnt lgkmcnt(6)
v_mfma_f32_16x16x32_bf16 a[184:187],a[144:147],v[32:35],0
s_cselect_b32 s40,1,s40
v_cvt_pk_bf16_f32 v59,v102,v103
v_exp_f32 v100,v100
s_waitcnt lgkmcnt(4)
v_mfma_f32_16x16x32_bf16 a[188:191],a[148:151],v[32:35],0
s_mul_i32 s64,s64,6144
v_exp_f32 v101,v101
v_mfma_f32_16x16x32_bf16 a[192:195],a[120:123],v[32:35],0
s_add_u32 s41,s41,s64
v_cvt_pk_bf16_f32 v58,v100,v101
s_waitcnt lgkmcnt(0)
s_barrier
v_mfma_f32_16x16x32_bf16 a[196:199],a[124:127],v[32:35],0
s_cmp_ge_u32 s69,6
ds_read_b128 a[136:139],v0 offset:24576
s_cselect_b32 s41,166723584,s41
v_smfmac_f32_16x16x64_bf16 v[64:67],a[152:155],v[52:59],v18
s_cselect_b32 s30,100663296,s30
s_add_u32 s25,s30,s22
ds_read_b128 a[120:123],v0 offset:24832
v_mfma_f32_16x16x32_bf16 a[200:203],a[128:131],v[32:35],0
s_add_u32 s26,s25,12288
s_mov_b32 s28,s41
ds_read_b128 a[140:143],v1 offset:24576
v_mfma_f32_16x16x32_bf16 a[204:207],a[132:135],v[32:35],0
s_mov_b32 s29,s24
ds_read_b128 a[148:151],v1 offset:24704
s_add_u32 m0,s23,0
ds_read_b128 a[124:127],v1 offset:24832
buffer_load_dwordx4 v6,s[8:11],s21 offen offset:0 lds
buffer_load_dwordx4 v7,s[8:11],s21 offen offset:1024 lds
buffer_load_dwordx4 v8,s[8:11],s21 offen offset:2048 lds
ds_read_b128 a[144:147],v0 offset:24704
s_add_u32 s21,s21,12288
ds_read_b128 a[128:131],v0 offset:30720
s_waitcnt lgkmcnt(6)
v_mfma_f32_16x16x32_bf16 v[96:99],a[136:139],a[72:75],0
s_add_u32 m0,s22,12288
ds_read_b128 a[132:135],v1 offset:30720
buffer_load_dwordx4 v6,s[4:7],s20 offen offset:0 lds
s_waitcnt lgkmcnt(5)
v_mfma_f32_16x16x32_bf16 v[96:99],a[140:143],a[76:79],v[96:99]
buffer_load_dwordx4 v7,s[4:7],s20 offen offset:1024 lds
buffer_load_dwordx4 v8,s[4:7],s20 offen offset:2048 lds
ds_read_b128 a[140:143],v1 offset:30848
s_add_u32 s20,s20,12288
ds_read_b128 a[136:139],v0 offset:30848
s_waitcnt lgkmcnt(4)
v_mfma_f32_16x16x32_bf16 v[96:99],a[144:147],a[80:83],v[96:99]
ds_read_b128 a[144:147],v0 offset:30976
v_mfma_f32_16x16x32_bf16 v[96:99],a[148:151],a[84:87],v[96:99]
ds_read_b128 a[148:151],v1 offset:30976
v_mfma_f32_16x16x32_bf16 v[96:99],a[120:123],a[88:91],v[96:99]
ds_read_b64_tr_b16 a[122:123],v2 offset:18432
v_mfma_f32_16x16x32_bf16 v[96:99],a[124:127],a[92:95],v[96:99]
s_waitcnt lgkmcnt(5)
ds_read_b64_tr_b16 a[126:127],v3 offset:18432
v_mfma_f32_16x16x32_bf16 v[100:103],a[128:131],a[72:75],0
ds_read_b64_tr_b16 a[120:121],v2 offset:12288
v_mfma_f32_16x16x32_bf16 v[100:103],a[132:135],a[76:79],v[100:103]
s_waitcnt lgkmcnt(5)
ds_read_b64_tr_b16 a[124:125],v3 offset:12288
v_mfma_f32_16x16x32_bf16 v[100:103],a[136:139],a[80:83],v[100:103]
ds_read_b64_tr_b16 a[128:129],v4 offset:12288
v_mfma_f32_16x16x32_bf16 v[100:103],a[140:143],a[84:87],v[100:103]
s_waitcnt lgkmcnt(6)
ds_read_b64_tr_b16 a[132:133],v5 offset:12288
v_mfma_f32_16x16x32_bf16 v[100:103],a[144:147],a[88:91],v[100:103]
s_waitcnt lgkmcnt(6)
ds_read_b64_tr_b16 a[130:131],v4 offset:18432
v_mfma_f32_16x16x32_bf16 v[100:103],a[148:151],a[92:95],v[100:103]
s_waitcnt lgkmcnt(4)
ds_read_b64_tr_b16 a[134:135],v5 offset:18432
v_mfma_f32_16x16x32_bf16 v[160:163],a[120:123],v[44:47],v[160:163]
s_add_u32 m0,s23,12288
ds_read_b64_tr_b16 a[136:137],v2 offset:12416
v_fma_f32 v82,v82,s36,v14
s_waitcnt lgkmcnt(5)
v_mfma_f32_16x16x32_bf16 v[164:167],a[124:127],v[44:47],v[164:167]
ds_read_b64_tr_b16 a[138:139],v2 offset:18560
v_fma_f32 v83,v83,s36,v14
v_mfma_f32_16x16x32_bf16 v[212:215],a[124:127],v[48:51],v[212:215]
ds_read_b64_tr_b16 a[140:141],v3 offset:12416
v_fma_f32 v88,v88,s36,v15
v_mfma_f32_16x16x32_bf16 v[208:211],a[120:123],v[48:51],v[208:211]
ds_read_b64_tr_b16 a[142:143],v3 offset:18560
v_fma_f32 v89,v89,s36,v15
v_mfma_f32_16x16x32_bf16 v[112:115],a[120:123],v[52:55],v[112:115]
ds_read_b64_tr_b16 a[144:145],v4 offset:12416
v_fma_f32 v90,v90,s36,v15
v_mfma_f32_16x16x32_bf16 v[116:119],a[124:127],v[52:55],v[116:119]
ds_read_b64_tr_b16 a[146:147],v4 offset:18560
v_fma_f32 v91,v91,s36,v15
v_mfma_f32_16x16x32_bf16 a[164:167],a[124:127],v[56:59],a[164:167]
ds_read_b64_tr_b16 a[148:149],v5 offset:12416
v_fma_f32 v96,v96,s36,v16
v_mfma_f32_16x16x32_bf16 a[160:163],a[120:123],v[56:59],a[160:163]
s_waitcnt lgkmcnt(6)
ds_read_b64_tr_b16 a[150:151],v5 offset:18560
v_fma_f32 v97,v97,s36,v16
v_mfma_f32_16x16x32_bf16 a[168:171],a[128:131],v[56:59],a[168:171]
ds_read_b64_tr_b16 a[120:121],v2 offset:12544
v_fma_f32 v98,v98,s36,v16
v_mfma_f32_16x16x32_bf16 a[172:175],a[132:135],v[56:59],a[172:175]
ds_read_b64_tr_b16 a[122:123],v2 offset:18688
v_fma_f32 v99,v99,s36,v16
v_mfma_f32_16x16x32_bf16 v[124:127],a[132:135],v[52:55],v[124:127]
ds_read_b64_tr_b16 a[124:125],v3 offset:12544
v_fma_f32 v76,v76,s36,v13
v_mfma_f32_16x16x32_bf16 v[120:123],a[128:131],v[52:55],v[120:123]
ds_read_b64_tr_b16 a[126:127],v3 offset:18688
v_fma_f32 v77,v77,s36,v13
v_mfma_f32_16x16x32_bf16 v[216:219],a[128:131],v[48:51],v[216:219]
v_exp_f32 v82,v82
v_mfma_f32_16x16x32_bf16 v[220:223],a[132:135],v[48:51],v[220:223]
v_exp_f32 v83,v83
v_mfma_f32_16x16x32_bf16 v[172:175],a[132:135],v[44:47],v[172:175]
ds_read_b64_tr_b16 a[132:133],v5 offset:12544
v_cvt_pk_bf16_f32 v25,v82,v83
v_mfma_f32_16x16x32_bf16 v[168:171],a[128:131],v[44:47],v[168:171]
s_waitcnt lgkmcnt(4)
ds_read_b64_tr_b16 a[128:129],v4 offset:12544
v_fma_f32 v78,v78,s36,v13
v_mfma_f32_16x16x32_bf16 v[176:179],a[136:139],v[44:47],v[176:179]
ds_read_b64_tr_b16 a[130:131],v4 offset:18688
v_fma_f32 v79,v79,s36,v13
v_mfma_f32_16x16x32_bf16 v[180:183],a[140:143],v[44:47],v[180:183]
ds_read_b64_tr_b16 a[134:135],v5 offset:18688
v_fma_f32 v84,v84,s36,v14
v_mfma_f32_16x16x32_bf16 v[228:231],a[140:143],v[48:51],v[228:231]
v_exp_f32 v88,v88
v_mfma_f32_16x16x32_bf16 v[224:227],a[136:139],v[48:51],v[224:227]
v_exp_f32 v89,v89
v_mfma_f32_16x16x32_bf16 v[128:131],a[136:139],v[52:55],v[128:131]
v_exp_f32 v90,v90
v_mfma_f32_16x16x32_bf16 v[132:135],a[140:143],v[52:55],v[132:135]
v_exp_f32 v91,v91
v_mfma_f32_16x16x32_bf16 a[180:183],a[140:143],v[56:59],a[180:183]
v_cvt_pk_bf16_f32 v28,v88,v89
v_cvt_pk_bf16_f32 v29,v90,v91
v_mfma_f32_16x16x32_bf16 a[176:179],a[136:139],v[56:59],a[176:179]
v_exp_f32 v96,v96
v_mfma_f32_16x16x32_bf16 a[184:187],a[144:147],v[56:59],a[184:187]
v_exp_f32 v97,v97
v_mfma_f32_16x16x32_bf16 a[188:191],a[148:151],v[56:59],a[188:191]
v_exp_f32 v98,v98
v_mfma_f32_16x16x32_bf16 v[140:143],a[148:151],v[52:55],v[140:143]
v_exp_f32 v99,v99
v_mfma_f32_16x16x32_bf16 v[136:139],a[144:147],v[52:55],v[136:139]
v_cvt_pk_bf16_f32 v32,v96,v97
v_cvt_pk_bf16_f32 v33,v98,v99
v_mfma_f32_16x16x32_bf16 v[232:235],a[144:147],v[48:51],v[232:235]
v_exp_f32 v76,v76
v_mfma_f32_16x16x32_bf16 v[236:239],a[148:151],v[48:51],v[236:239]
v_exp_f32 v77,v77
v_mfma_f32_16x16x32_bf16 v[188:191],a[148:151],v[44:47],v[188:191]
v_exp_f32 v78,v78
v_mfma_f32_16x16x32_bf16 v[184:187],a[144:147],v[44:47],v[184:187]
s_waitcnt lgkmcnt(0)
v_exp_f32 v79,v79
v_mfma_f32_16x16x32_bf16 v[192:195],a[120:123],v[44:47],v[192:195]
s_waitcnt vmcnt(6)
v_cvt_pk_bf16_f32 v22,v76,v77
v_cvt_pk_bf16_f32 v23,v78,v79
v_mfma_f32_16x16x32_bf16 v[196:199],a[124:127],v[44:47],v[196:199]
s_barrier
v_mfma_f32_16x16x32_bf16 v[244:247],a[124:127],v[48:51],v[244:247]
ds_read_b128 a[148:151],v1 offset:128
v_fma_f32 v85,v85,s36,v14
v_mfma_f32_16x16x32_bf16 v[240:243],a[120:123],v[48:51],v[240:243]
ds_read_b128 a[144:147],v0 offset:128
v_fma_f32 v86,v86,s36,v14
v_mfma_f32_16x16x32_bf16 v[144:147],a[120:123],v[52:55],v[144:147]
ds_read_b128 a[140:143],v1 offset:0
v_fma_f32 v87,v87,s36,v14
v_mfma_f32_16x16x32_bf16 v[148:151],a[124:127],v[52:55],v[148:151]
ds_read_b128 a[136:139],v0 offset:0
v_fma_f32 v92,v92,s36,v15
v_mfma_f32_16x16x32_bf16 a[196:199],a[124:127],v[56:59],a[196:199]
ds_read_b128 a[124:127],v1 offset:256
v_fma_f32 v93,v93,s36,v15
v_mfma_f32_16x16x32_bf16 a[192:195],a[120:123],v[56:59],a[192:195]
buffer_load_dwordx4 v6,s[8:11],s21 offen offset:0 lds
v_mfma_f32_16x16x32_bf16 a[200:203],a[128:131],v[56:59],a[200:203]
ds_read_b128 a[120:123],v0 offset:256
v_fma_f32 v94,v94,s36,v15
v_mfma_f32_16x16x32_bf16 a[204:207],a[132:135],v[56:59],a[204:207]
v_exp_f32 v84,v84
v_mfma_f32_16x16x32_bf16 v[156:159],a[132:135],v[52:55],v[156:159]
v_exp_f32 v85,v85
v_mfma_f32_16x16x32_bf16 v[152:155],a[128:131],v[52:55],v[152:155]
v_exp_f32 v86,v86
v_mfma_f32_16x16x32_bf16 v[248:251],a[128:131],v[48:51],v[248:251]
v_exp_f32 v87,v87
v_mfma_f32_16x16x32_bf16 v[252:255],a[132:135],v[48:51],v[252:255]
v_cvt_pk_bf16_f32 v26,v84,v85
v_cvt_pk_bf16_f32 v27,v86,v87
v_mfma_f32_16x16x32_bf16 v[204:207],a[132:135],v[44:47],v[204:207]
ds_read_b128 a[132:135],v1 offset:6144
v_fma_f32 v95,v95,s36,v15
v_smfmac_f32_16x16x64_bf16 v[60:63],a[152:155],v[20:27],v18
v_fma_f32 v100,v100,s36,v16
v_mfma_f32_16x16x32_bf16 v[200:203],a[128:131],v[44:47],v[200:203]
buffer_load_dwordx4 v7,s[8:11],s21 offen offset:1024 lds
s_waitcnt lgkmcnt(1)
v_mfma_f32_16x16x32_bf16 v[72:75],a[124:127],a[20:23],0
ds_read_b128 a[128:131],v0 offset:6144
v_fma_f32 v101,v101,s36,v16
v_mfma_f32_16x16x32_bf16 v[72:75],a[120:123],a[16:19],v[72:75]
v_exp_f32 v92,v92
v_mfma_f32_16x16x32_bf16 v[72:75],a[148:151],a[12:15],v[72:75]
v_exp_f32 v93,v93
v_mfma_f32_16x16x32_bf16 v[72:75],a[144:147],a[8:11],v[72:75]
v_exp_f32 v94,v94
v_mfma_f32_16x16x32_bf16 v[72:75],a[140:143],a[4:7],v[72:75]
v_exp_f32 v95,v95
v_mfma_f32_16x16x32_bf16 v[72:75],a[136:139],a[0:3],v[72:75]
v_cvt_pk_bf16_f32 v30,v92,v93
v_cvt_pk_bf16_f32 v31,v94,v95
v_mfma_f32_16x16x32_bf16 v[80:83],a[136:139],a[24:27],0
v_fma_f32 v102,v102,s36,v16
v_fma_f32 v103,v103,s36,v16
v_mfma_f32_16x16x32_bf16 v[80:83],a[140:143],a[28:31],v[80:83]
v_exp_f32 v100,v100
v_mfma_f32_16x16x32_bf16 v[80:83],a[144:147],a[32:35],v[80:83]
buffer_load_dwordx4 v8,s[8:11],s21 offen offset:2048 lds
v_mfma_f32_16x16x32_bf16 v[80:83],a[148:151],a[36:39],v[80:83]
s_add_u32 s21,s21,12288
v_exp_f32 v101,v101
v_mfma_f32_16x16x32_bf16 v[80:83],a[120:123],a[40:43],v[80:83]
s_add_u32 m0,s22,24576
v_exp_f32 v102,v102
v_mfma_f32_16x16x32_bf16 v[80:83],a[124:127],a[44:47],v[80:83]
v_exp_f32 v103,v103
v_mfma_f32_16x16x32_bf16 v[88:91],a[124:127],a[68:71],0
v_cvt_pk_bf16_f32 v34,v100,v101
v_cvt_pk_bf16_f32 v35,v102,v103
v_mfma_f32_16x16x32_bf16 v[88:91],a[120:123],a[64:67],v[88:91]
v_fma_f32 v72,v72,s36,v13
v_fma_f32 v73,v73,s36,v13
v_smfmac_f32_16x16x64_bf16 v[64:67],a[152:155],v[28:35],v18
v_fma_f32 v74,v74,s36,v13
v_mfma_f32_16x16x32_bf16 v[88:91],a[148:151],a[60:63],v[88:91]
v_fma_f32 v75,v75,s36,v13
v_fma_f32 v80,v80,s36,v14
v_mfma_f32_16x16x32_bf16 v[88:91],a[144:147],a[56:59],v[88:91]
v_fma_f32 v81,v81,s36,v14
v_mfma_f32_16x16x32_bf16 v[88:91],a[140:143],a[52:55],v[88:91]
buffer_load_dwordx4 v6,s[4:7],s20 offen offset:0 lds
v_mfma_f32_16x16x32_bf16 v[88:91],a[136:139],a[48:51],v[88:91]
v_exp_f32 v72,v72
v_mfma_f32_16x16x32_bf16 v[96:99],a[136:139],a[72:75],0
ds_read_b128 a[136:139],v0 offset:6272
v_mfma_f32_16x16x32_bf16 v[96:99],a[140:143],a[76:79],v[96:99]
ds_read_b128 a[140:143],v1 offset:6272
v_mfma_f32_16x16x32_bf16 v[96:99],a[144:147],a[80:83],v[96:99]
ds_read_b128 a[144:147],v0 offset:6400
v_mfma_f32_16x16x32_bf16 v[96:99],a[148:151],a[84:87],v[96:99]
ds_read_b128 a[148:151],v1 offset:6400
v_mfma_f32_16x16x32_bf16 v[96:99],a[120:123],a[88:91],v[96:99]
v_exp_f32 v73,v73
v_mfma_f32_16x16x32_bf16 v[96:99],a[124:127],a[92:95],v[96:99]
s_waitcnt lgkmcnt(4)
v_exp_f32 v74,v74
v_mfma_f32_16x16x32_bf16 v[76:79],a[128:131],a[0:3],0
v_exp_f32 v75,v75
v_mfma_f32_16x16x32_bf16 v[76:79],a[132:135],a[4:7],v[76:79]
buffer_load_dwordx4 v7,s[4:7],s20 offen offset:1024 lds
s_waitcnt lgkmcnt(3)
v_mfma_f32_16x16x32_bf16 v[76:79],a[136:139],a[8:11],v[76:79]
s_waitcnt lgkmcnt(2)
v_exp_f32 v80,v80
v_mfma_f32_16x16x32_bf16 v[76:79],a[140:143],a[12:15],v[76:79]
s_waitcnt lgkmcnt(0)
v_exp_f32 v81,v81
v_mfma_f32_16x16x32_bf16 v[76:79],a[144:147],a[16:19],v[76:79]
v_cvt_pk_bf16_f32 v44,v72,v73
v_cvt_pk_bf16_f32 v45,v74,v75
v_mfma_f32_16x16x32_bf16 v[76:79],a[148:151],a[20:23],v[76:79]
v_cvt_pk_bf16_f32 v48,v80,v81
v_mfma_f32_16x16x32_bf16 v[84:87],a[148:151],a[44:47],0
v_mfma_f32_16x16x32_bf16 v[84:87],a[144:147],a[40:43],v[84:87]
v_mfma_f32_16x16x32_bf16 v[84:87],a[140:143],a[36:39],v[84:87]
v_mfma_f32_16x16x32_bf16 v[84:87],a[136:139],a[32:35],v[84:87]
v_mfma_f32_16x16x32_bf16 v[84:87],a[132:135],a[28:31],v[84:87]
buffer_load_dwordx4 v8,s[4:7],s20 offen offset:2048 lds
v_mfma_f32_16x16x32_bf16 v[84:87],a[128:131],a[24:27],v[84:87]
s_add_u32 s20,s20,12288
v_mfma_f32_16x16x32_bf16 v[92:95],a[128:131],a[48:51],0
ds_read_b64_tr_b16 a[120:121],v2 offset:24576
v_mfma_f32_16x16x32_bf16 v[92:95],a[132:135],a[52:55],v[92:95]
ds_read_b64_tr_b16 a[122:123],v2 offset:30720
v_mfma_f32_16x16x32_bf16 v[92:95],a[136:139],a[56:59],v[92:95]
ds_read_b64_tr_b16 a[124:125],v3 offset:24576
v_mfma_f32_16x16x32_bf16 v[92:95],a[140:143],a[60:63],v[92:95]
ds_read_b64_tr_b16 a[126:127],v3 offset:30720
v_mfma_f32_16x16x32_bf16 v[92:95],a[144:147],a[64:67],v[92:95]
v_mfma_f32_16x16x32_bf16 v[92:95],a[148:151],a[68:71],v[92:95]
v_mfma_f32_16x16x32_bf16 v[100:103],a[148:151],a[92:95],0
v_mfma_f32_16x16x32_bf16 v[100:103],a[144:147],a[88:91],v[100:103]
v_mfma_f32_16x16x32_bf16 v[100:103],a[140:143],a[84:87],v[100:103]
v_mfma_f32_16x16x32_bf16 v[100:103],a[136:139],a[80:83],v[100:103]
v_mfma_f32_16x16x32_bf16 v[100:103],a[132:135],a[76:79],v[100:103]
ds_read_b64_tr_b16 a[132:133],v5 offset:24576
v_mfma_f32_16x16x32_bf16 v[100:103],a[128:131],a[72:75],v[100:103]
ds_read_b64_tr_b16 a[128:129],v4 offset:24576
ds_read_b64_tr_b16 a[130:131],v4 offset:30720
ds_read_b64_tr_b16 a[134:135],v5 offset:30720
s_mov_b32 s38,0
s_branch L_loop4
L_loop5:
.p2align 6
L_loop5w0:
s_waitcnt lgkmcnt(3)
v_mfma_f32_16x16x32_bf16 v[160:163],a[120:123],v[20:23],v[160:163]
ds_read_b128 a[156:159],v10 offset:0
v_fma_f32 v90,v90,s36,v15
v_mfma_f32_16x16x32_bf16 v[164:167],a[124:127],v[20:23],v[164:167]
ds_read_b64_tr_b16 a[136:137],v2 offset:24704
v_fma_f32 v91,v91,s36,v15
v_mfma_f32_16x16x32_bf16 v[212:215],a[124:127],v[24:27],v[212:215]
ds_read_b64_tr_b16 a[138:139],v2 offset:30848
v_fma_f32 v96,v96,s36,v16
v_mfma_f32_16x16x32_bf16 v[208:211],a[120:123],v[24:27],v[208:211]
ds_read_b64_tr_b16 a[140:141],v3 offset:24704
v_fma_f32 v97,v97,s36,v16
v_mfma_f32_16x16x32_bf16 v[112:115],a[120:123],v[28:31],v[112:115]
ds_read_b64_tr_b16 a[142:143],v3 offset:30848
v_fma_f32 v98,v98,s36,v16
v_mfma_f32_16x16x32_bf16 v[116:119],a[124:127],v[28:31],v[116:119]
ds_read_b64_tr_b16 a[144:145],v4 offset:24704
v_fma_f32 v99,v99,s36,v16
v_mfma_f32_16x16x32_bf16 a[164:167],a[124:127],v[32:35],a[164:167]
ds_read_b64_tr_b16 a[146:147],v4 offset:30848
v_fma_f32 v104,v104,s36,v17
v_mfma_f32_16x16x32_bf16 a[160:163],a[120:123],v[32:35],a[160:163]
ds_read_b64_tr_b16 a[148:149],v5 offset:24704
v_fma_f32 v105,v105,s36,v17
v_mfma_f32_16x16x32_bf16 a[208:211],a[120:123],v[36:39],a[208:211]
ds_read_b64_tr_b16 a[150:151],v5 offset:30848
v_fma_f32 v106,v106,s36,v17
v_mfma_f32_16x16x32_bf16 a[212:215],a[124:127],v[36:39],a[212:215]
s_waitcnt lgkmcnt(6)
ds_read_b64_tr_b16 a[120:121],v2 offset:24832
v_fma_f32 v107,v107,s36,v17
v_mfma_f32_16x16x32_bf16 a[216:219],a[128:131],v[36:39],a[216:219]
ds_read_b64_tr_b16 a[122:123],v2 offset:30976
v_fma_f32 v76,v76,s36,v13
v_mfma_f32_16x16x32_bf16 a[220:223],a[132:135],v[36:39],a[220:223]
ds_read_b64_tr_b16 a[124:125],v3 offset:24832
v_fma_f32 v77,v77,s36,v13
v_mfma_f32_16x16x32_bf16 a[172:175],a[132:135],v[32:35],a[172:175]
ds_read_b64_tr_b16 a[126:127],v3 offset:30976
v_fma_f32 v78,v78,s36,v13
v_mfma_f32_16x16x32_bf16 a[168:171],a[128:131],v[32:35],a[168:171]
v_exp_f32 v90,v90
v_mfma_f32_16x16x32_bf16 v[120:123],a[128:131],v[28:31],v[120:123]
v_exp_f32 v91,v91
v_mfma_f32_16x16x32_bf16 v[124:127],a[132:135],v[28:31],v[124:127]
v_cvt_pk_bf16_f32 v53,v90,v91
v_fma_f32 v79,v79,s36,v13
v_mfma_f32_16x16x32_bf16 v[220:223],a[132:135],v[24:27],v[220:223]
v_exp_f32 v96,v96
v_mfma_f32_16x16x32_bf16 v[216:219],a[128:131],v[24:27],v[216:219]
buffer_store_dwordx4 a[156:159],v9,s[16:19],s27 offen offset:0 nt
v_exp_f32 v97,v97
v_fma_f32 v84,v84,s36,v14
v_mfma_f32_16x16x32_bf16 v[168:171],a[128:131],v[20:23],v[168:171]
ds_read_b128 a[156:159],v10 offset:1024
v_cvt_pk_bf16_f32 v56,v96,v97
v_mfma_f32_16x16x32_bf16 v[172:175],a[132:135],v[20:23],v[172:175]
ds_read_b64_tr_b16 a[128:129],v4 offset:24832
v_fma_f32 v85,v85,s36,v14
v_mfma_f32_16x16x32_bf16 v[176:179],a[136:139],v[20:23],v[176:179]
s_waitcnt lgkmcnt(2)
ds_read_b64_tr_b16 a[130:131],v4 offset:30976
v_fma_f32 v86,v86,s36,v14
v_mfma_f32_16x16x32_bf16 v[180:183],a[140:143],v[20:23],v[180:183]
ds_read_b64_tr_b16 a[132:133],v5 offset:24832
v_fma_f32 v87,v87,s36,v14
v_mfma_f32_16x16x32_bf16 v[228:231],a[140:143],v[24:27],v[228:231]
ds_read_b64_tr_b16 a[134:135],v5 offset:30976
v_fma_f32 v92,v92,s36,v15
v_mfma_f32_16x16x32_bf16 v[224:227],a[136:139],v[24:27],v[224:227]
v_exp_f32 v98,v98
v_mfma_f32_16x16x32_bf16 v[128:131],a[136:139],v[28:31],v[128:131]
v_exp_f32 v99,v99
v_mfma_f32_16x16x32_bf16 v[132:135],a[140:143],v[28:31],v[132:135]
v_cvt_pk_bf16_f32 v57,v98,v99
v_fma_f32 v93,v93,s36,v15
v_mfma_f32_16x16x32_bf16 a[180:183],a[140:143],v[32:35],a[180:183]
s_waitcnt lgkmcnt(4)
buffer_store_dwordx4 a[156:159],v9,s[16:19],s27 offen offset:128 nt
v_exp_f32 v104,v104
v_fma_f32 v94,v94,s36,v15
v_mfma_f32_16x16x32_bf16 a[176:179],a[136:139],v[32:35],a[176:179]
ds_read_b128 a[156:159],v10 offset:2048
v_fma_f32 v95,v95,s36,v15
v_mfma_f32_16x16x32_bf16 a[224:227],a[136:139],v[36:39],a[224:227]
v_exp_f32 v105,v105
v_mfma_f32_16x16x32_bf16 a[228:231],a[140:143],v[36:39],a[228:231]
v_exp_f32 v106,v106
v_mfma_f32_16x16x32_bf16 a[232:235],a[144:147],v[36:39],a[232:235]
v_exp_f32 v107,v107
v_mfma_f32_16x16x32_bf16 a[236:239],a[148:151],v[36:39],a[236:239]
v_cvt_pk_bf16_f32 v40,v104,v105
v_cvt_pk_bf16_f32 v41,v106,v107
v_mfma_f32_16x16x32_bf16 a[188:191],a[148:151],v[32:35],a[188:191]
v_exp_f32 v76,v76
v_mfma_f32_16x16x32_bf16 a[184:187],a[144:147],v[32:35],a[184:187]
v_exp_f32 v77,v77
v_mfma_f32_16x16x32_bf16 v[136:139],a[144:147],v[28:31],v[136:139]
v_exp_f32 v78,v78
v_mfma_f32_16x16x32_bf16 v[140:143],a[148:151],v[28:31],v[140:143]
s_waitcnt lgkmcnt(0)
buffer_store_dwordx4 a[156:159],v9,s[16:19],s27 offen offset:256 nt
v_exp_f32 v79,v79
v_cvt_pk_bf16_f32 v46,v76,v77
v_mfma_f32_16x16x32_bf16 v[236:239],a[148:151],v[24:27],v[236:239]
s_add_u32 s27,s27,3072
v_cvt_pk_bf16_f32 v47,v78,v79
v_fma_f32 v100,v100,s36,v16
v_mfma_f32_16x16x32_bf16 v[232:235],a[144:147],v[24:27],v[232:235]
s_waitcnt vmcnt(9)
v_exp_f32 v84,v84
v_mfma_f32_16x16x32_bf16 v[184:187],a[144:147],v[20:23],v[184:187]
s_barrier
v_mfma_f32_16x16x32_bf16 v[188:191],a[148:151],v[20:23],v[188:191]
s_add_u32 m0,s23,24576
ds_read_b128 a[136:139],v0 offset:12288
v_fma_f32 v101,v101,s36,v16
v_mfma_f32_16x16x32_bf16 v[192:195],a[120:123],v[20:23],v[192:195]
ds_read_b128 a[140:143],v1 offset:12288
v_fma_f32 v102,v102,s36,v16
v_mfma_f32_16x16x32_bf16 v[196:199],a[124:127],v[20:23],v[196:199]
ds_read_b128 a[144:147],v0 offset:12416
v_fma_f32 v103,v103,s36,v16
v_mfma_f32_16x16x32_bf16 v[244:247],a[124:127],v[24:27],v[244:247]
ds_read_b128 a[148:151],v1 offset:12416
v_fma_f32 v108,v108,s36,v17
v_mfma_f32_16x16x32_bf16 v[240:243],a[120:123],v[24:27],v[240:243]
v_exp_f32 v85,v85
v_mfma_f32_16x16x32_bf16 v[144:147],a[120:123],v[28:31],v[144:147]
buffer_load_dwordx4 v6,s[8:11],s21 offen offset:0 lds
v_mfma_f32_16x16x32_bf16 v[148:151],a[124:127],v[28:31],v[148:151]
v_exp_f32 v86,v86
v_mfma_f32_16x16x32_bf16 a[196:199],a[124:127],v[32:35],a[196:199]
v_exp_f32 v87,v87
v_mfma_f32_16x16x32_bf16 a[192:195],a[120:123],v[32:35],a[192:195]
v_cvt_pk_bf16_f32 v50,v84,v85
v_cvt_pk_bf16_f32 v51,v86,v87
v_mfma_f32_16x16x32_bf16 a[240:243],a[120:123],v[36:39],a[240:243]
ds_read_b128 a[120:123],v0 offset:12544
v_fma_f32 v109,v109,s36,v17
v_smfmac_f32_16x16x64_bf16 v[60:63],a[152:155],v[44:51],v18
v_fma_f32 v110,v110,s36,v17
v_mfma_f32_16x16x32_bf16 a[244:247],a[124:127],v[36:39],a[244:247]
ds_read_b128 a[124:127],v1 offset:12544
v_fma_f32 v111,v111,s36,v17
v_mfma_f32_16x16x32_bf16 a[248:251],a[128:131],v[36:39],a[248:251]
v_exp_f32 v92,v92
v_mfma_f32_16x16x32_bf16 a[252:255],a[132:135],v[36:39],a[252:255]
v_exp_f32 v93,v93
v_mfma_f32_16x16x32_bf16 a[204:207],a[132:135],v[32:35],a[204:207]
v_exp_f32 v94,v94
v_mfma_f32_16x16x32_bf16 a[200:203],a[128:131],v[32:35],a[200:203]
v_exp_f32 v95,v95
v_mfma_f32_16x16x32_bf16 v[152:155],a[128:131],v[28:31],v[152:155]
v_cvt_pk_bf16_f32 v54,v92,v93
v_cvt_pk_bf16_f32 v55,v94,v95
v_mfma_f32_16x16x32_bf16 v[156:159],a[132:135],v[28:31],v[156:159]
buffer_load_dwordx4 v7,s[8:11],s21 offen offset:1024 lds
v_mfma_f32_16x16x32_bf16 v[252:255],a[132:135],v[24:27],v[252:255]
v_exp_f32 v100,v100
v_mfma_f32_16x16x32_bf16 v[248:251],a[128:131],v[24:27],v[248:251]
v_exp_f32 v101,v101
v_mfma_f32_16x16x32_bf16 v[200:203],a[128:131],v[20:23],v[200:203]
ds_read_b128 a[128:131],v0 offset:18432
v_cvt_pk_bf16_f32 v58,v100,v101
v_mfma_f32_16x16x32_bf16 v[204:207],a[132:135],v[20:23],v[204:207]
s_waitcnt lgkmcnt(1)
ds_read_b128 a[132:135],v1 offset:18432
v_mfma_f32_16x16x32_bf16 v[72:75],a[136:139],a[0:3],0
v_exp_f32 v102,v102
v_mfma_f32_16x16x32_bf16 v[72:75],a[140:143],a[4:7],v[72:75]
v_exp_f32 v103,v103
v_mfma_f32_16x16x32_bf16 v[72:75],a[144:147],a[8:11],v[72:75]
v_cvt_pk_bf16_f32 v59,v102,v103
v_mfma_f32_16x16x32_bf16 v[72:75],a[148:151],a[12:15],v[72:75]
v_exp_f32 v108,v108
v_smfmac_f32_16x16x64_bf16 v[64:67],a[152:155],v[52:59],v18
v_mfma_f32_16x16x32_bf16 v[72:75],a[120:123],a[16:19],v[72:75]
v_exp_f32 v109,v109
v_mfma_f32_16x16x32_bf16 v[72:75],a[124:127],a[20:23],v[72:75]
buffer_load_dwordx4 v8,s[8:11],s21 offen offset:2048 lds
v_mfma_f32_16x16x32_bf16 v[80:83],a[124:127],a[44:47],0
s_add_u32 s21,s21,12288
v_exp_f32 v110,v110
v_mfma_f32_16x16x32_bf16 v[80:83],a[120:123],a[40:43],v[80:83]
s_add_u32 m0,s22,0
v_exp_f32 v111,v111
v_mfma_f32_16x16x32_bf16 v[80:83],a[148:151],a[36:39],v[80:83]
v_cvt_pk_bf16_f32 v42,v108,v109
v_cvt_pk_bf16_f32 v43,v110,v111
v_mfma_f32_16x16x32_bf16 v[80:83],a[144:147],a[32:35],v[80:83]
v_fma_f32 v72,v72,s36,v13
v_fma_f32 v73,v73,s36,v13
v_smfmac_f32_16x16x64_bf16 v[68:71],a[152:155],v[36:43],v18
v_fma_f32 v74,v74,s36,v13
v_mfma_f32_16x16x32_bf16 v[80:83],a[140:143],a[28:31],v[80:83]
v_fma_f32 v75,v75,s36,v13
v_mfma_f32_16x16x32_bf16 v[80:83],a[136:139],a[24:27],v[80:83]
v_exp_f32 v72,v72
v_mfma_f32_16x16x32_bf16 v[88:91],a[136:139],a[48:51],0
v_exp_f32 v73,v73
v_mfma_f32_16x16x32_bf16 v[88:91],a[140:143],a[52:55],v[88:91]
v_exp_f32 v74,v74
v_mfma_f32_16x16x32_bf16 v[88:91],a[144:147],a[56:59],v[88:91]
v_exp_f32 v75,v75
v_mfma_f32_16x16x32_bf16 v[88:91],a[148:151],a[60:63],v[88:91]
v_fma_f32 v80,v80,s36,v14
v_fma_f32 v81,v81,s36,v14
v_mfma_f32_16x16x32_bf16 v[88:91],a[120:123],a[64:67],v[88:91]
buffer_load_dwordx4 v6,s[4:7],s20 offen offset:0 lds
v_mfma_f32_16x16x32_bf16 v[88:91],a[124:127],a[68:71],v[88:91]
v_fma_f32 v82,v82,s36,v14
v_fma_f32 v83,v83,s36,v14
v_mfma_f32_16x16x32_bf16 v[96:99],a[124:127],a[92:95],0
v_exp_f32 v80,v80
v_mfma_f32_16x16x32_bf16 v[96:99],a[120:123],a[88:91],v[96:99]
v_exp_f32 v81,v81
v_mfma_f32_16x16x32_bf16 v[96:99],a[148:151],a[84:87],v[96:99]
v_exp_f32 v82,v82
v_mfma_f32_16x16x32_bf16 v[96:99],a[144:147],a[80:83],v[96:99]
v_fma_f32 v88,v88,s36,v15
v_fma_f32 v89,v89,s36,v15
v_mfma_f32_16x16x32_bf16 v[96:99],a[140:143],a[76:79],v[96:99]
v_exp_f32 v83,v83
v_mfma_f32_16x16x32_bf16 v[96:99],a[136:139],a[72:75],v[96:99]
v_exp_f32 v88,v88
v_mfma_f32_16x16x32_bf16 v[104:107],a[136:139],a[96:99],0
ds_read_b128 a[136:139],v0 offset:18560
v_cvt_pk_bf16_f32 v20,v72,v73
v_mfma_f32_16x16x32_bf16 v[104:107],a[140:143],a[100:103],v[104:107]
ds_read_b128 a[140:143],v1 offset:18560
v_cvt_pk_bf16_f32 v21,v74,v75
v_mfma_f32_16x16x32_bf16 v[104:107],a[144:147],a[104:107],v[104:107]
ds_read_b128 a[144:147],v0 offset:18688
v_cvt_pk_bf16_f32 v24,v80,v81
v_mfma_f32_16x16x32_bf16 v[104:107],a[148:151],a[108:111],v[104:107]
ds_read_b128 a[148:151],v1 offset:18688
v_cvt_pk_bf16_f32 v25,v82,v83
v_mfma_f32_16x16x32_bf16 v[104:107],a[120:123],a[112:115],v[104:107]
buffer_load_dwordx4 v7,s[4:7],s20 offen offset:1024 lds
v_mfma_f32_16x16x32_bf16 v[104:107],a[124:127],a[116:119],v[104:107]
s_waitcnt lgkmcnt(4)
v_exp_f32 v89,v89
v_mfma_f32_16x16x32_bf16 v[76:79],a[128:131],a[0:3],0
v_cvt_pk_bf16_f32 v28,v88,v89
v_mfma_f32_16x16x32_bf16 v[76:79],a[132:135],a[4:7],v[76:79]
s_waitcnt lgkmcnt(3)
v_mfma_f32_16x16x32_bf16 v[76:79],a[136:139],a[8:11],v[76:79]
s_waitcnt lgkmcnt(2)
v_mfma_f32_16x16x32_bf16 v[76:79],a[140:143],a[12:15],v[76:79]
s_waitcnt lgkmcnt(1)
v_mfma_f32_16x16x32_bf16 v[76:79],a[144:147],a[16:19],v[76:79]
s_waitcnt lgkmcnt(0)
v_mfma_f32_16x16x32_bf16 v[76:79],a[148:151],a[20:23],v[76:79]
v_mfma_f32_16x16x32_bf16 v[84:87],a[148:151],a[44:47],0
v_mfma_f32_16x16x32_bf16 v[84:87],a[144:147],a[40:43],v[84:87]
v_mfma_f32_16x16x32_bf16 v[84:87],a[140:143],a[36:39],v[84:87]
v_mfma_f32_16x16x32_bf16 v[84:87],a[136:139],a[32:35],v[84:87]
buffer_load_dwordx4 v8,s[4:7],s20 offen offset:2048 lds
v_mfma_f32_16x16x32_bf16 v[84:87],a[132:135],a[28:31],v[84:87]
s_add_u32 s20,s20,12288
v_mfma_f32_16x16x32_bf16 v[84:87],a[128:131],a[24:27],v[84:87]
v_mfma_f32_16x16x32_bf16 v[92:95],a[128:131],a[48:51],0
v_mfma_f32_16x16x32_bf16 v[92:95],a[132:135],a[52:55],v[92:95]
v_mfma_f32_16x16x32_bf16 v[92:95],a[136:139],a[56:59],v[92:95]
v_mfma_f32_16x16x32_bf16 v[92:95],a[140:143],a[60:63],v[92:95]
ds_read_b64_tr_b16 a[120:121],v2 offset:0
v_mfma_f32_16x16x32_bf16 v[92:95],a[144:147],a[64:67],v[92:95]
ds_read_b64_tr_b16 a[122:123],v2 offset:6144
v_mfma_f32_16x16x32_bf16 v[92:95],a[148:151],a[68:71],v[92:95]
v_mfma_f32_16x16x32_bf16 v[100:103],a[148:151],a[92:95],0
ds_read_b64_tr_b16 a[124:125],v3 offset:0
v_mfma_f32_16x16x32_bf16 v[100:103],a[144:147],a[88:91],v[100:103]
ds_read_b64_tr_b16 a[126:127],v3 offset:6144
v_mfma_f32_16x16x32_bf16 v[100:103],a[140:143],a[84:87],v[100:103]
v_mfma_f32_16x16x32_bf16 v[100:103],a[136:139],a[80:83],v[100:103]
v_mfma_f32_16x16x32_bf16 v[100:103],a[132:135],a[76:79],v[100:103]
v_mfma_f32_16x16x32_bf16 v[100:103],a[128:131],a[72:75],v[100:103]
v_mfma_f32_16x16x32_bf16 v[108:111],a[128:131],a[96:99],0
ds_read_b64_tr_b16 a[128:129],v4 offset:0
v_mfma_f32_16x16x32_bf16 v[108:111],a[132:135],a[100:103],v[108:111]
ds_read_b64_tr_b16 a[130:131],v4 offset:6144
v_mfma_f32_16x16x32_bf16 v[108:111],a[136:139],a[104:107],v[108:111]
ds_read_b64_tr_b16 a[132:133],v5 offset:0
v_mfma_f32_16x16x32_bf16 v[108:111],a[140:143],a[108:111],v[108:111]
ds_read_b64_tr_b16 a[134:135],v5 offset:6144
v_mfma_f32_16x16x32_bf16 v[108:111],a[144:147],a[112:115],v[108:111]
v_mfma_f32_16x16x32_bf16 v[108:111],a[148:151],a[116:119],v[108:111]
s_waitcnt lgkmcnt(4)
v_mfma_f32_16x16x32_bf16 v[160:163],a[120:123],v[44:47],v[160:163]
s_add_u32 m0,s29,0
ds_read_b64_tr_b16 a[136:137],v2 offset:128
v_fma_f32 v90,v90,s36,v15
v_mfma_f32_16x16x32_bf16 v[164:167],a[124:127],v[44:47],v[164:167]
ds_read_b64_tr_b16 a[138:139],v2 offset:6272
v_fma_f32 v91,v91,s36,v15
v_mfma_f32_16x16x32_bf16 v[212:215],a[124:127],v[48:51],v[212:215]
ds_read_b64_tr_b16 a[140:141],v3 offset:128
v_fma_f32 v96,v96,s36,v16
v_mfma_f32_16x16x32_bf16 v[208:211],a[120:123],v[48:51],v[208:211]
ds_read_b64_tr_b16 a[142:143],v3 offset:6272
v_fma_f32 v97,v97,s36,v16
v_mfma_f32_16x16x32_bf16 v[112:115],a[120:123],v[52:55],v[112:115]
ds_read_b64_tr_b16 a[144:145],v4 offset:128
v_fma_f32 v98,v98,s36,v16
v_mfma_f32_16x16x32_bf16 v[116:119],a[124:127],v[52:55],v[116:119]
ds_read_b64_tr_b16 a[146:147],v4 offset:6272
v_fma_f32 v99,v99,s36,v16
v_mfma_f32_16x16x32_bf16 a[164:167],a[124:127],v[56:59],a[164:167]
ds_read_b64_tr_b16 a[148:149],v5 offset:128
v_fma_f32 v104,v104,s36,v17
v_mfma_f32_16x16x32_bf16 a[160:163],a[120:123],v[56:59],a[160:163]
buffer_load_dwordx4 v6,s[12:15],s28 offen offset:0 nt lds
v_mfma_f32_16x16x32_bf16 a[208:211],a[120:123],v[40:43],a[208:211]
ds_read_b64_tr_b16 a[150:151],v5 offset:6272
v_fma_f32 v105,v105,s36,v17
v_mfma_f32_16x16x32_bf16 a[212:215],a[124:127],v[40:43],a[212:215]
s_waitcnt lgkmcnt(5)
ds_read_b64_tr_b16 a[120:121],v2 offset:256
v_fma_f32 v106,v106,s36,v17
v_mfma_f32_16x16x32_bf16 a[216:219],a[128:131],v[40:43],a[216:219]
ds_read_b64_tr_b16 a[122:123],v2 offset:6400
v_fma_f32 v107,v107,s36,v17
v_mfma_f32_16x16x32_bf16 a[220:223],a[132:135],v[40:43],a[220:223]
ds_read_b64_tr_b16 a[124:125],v3 offset:256
v_fma_f32 v76,v76,s36,v13
v_mfma_f32_16x16x32_bf16 a[172:175],a[132:135],v[56:59],a[172:175]
ds_read_b64_tr_b16 a[126:127],v3 offset:6400
v_fma_f32 v77,v77,s36,v13
v_mfma_f32_16x16x32_bf16 a[168:171],a[128:131],v[56:59],a[168:171]
v_exp_f32 v90,v90
v_mfma_f32_16x16x32_bf16 v[120:123],a[128:131],v[52:55],v[120:123]
v_exp_f32 v91,v91
v_mfma_f32_16x16x32_bf16 v[124:127],a[132:135],v[52:55],v[124:127]
v_cvt_pk_bf16_f32 v29,v90,v91
v_fma_f32 v78,v78,s36,v13
v_mfma_f32_16x16x32_bf16 v[220:223],a[132:135],v[48:51],v[220:223]
v_exp_f32 v96,v96
v_mfma_f32_16x16x32_bf16 v[216:219],a[128:131],v[48:51],v[216:219]
buffer_load_dwordx4 v7,s[12:15],s28 offen offset:1024 nt lds
v_mfma_f32_16x16x32_bf16 v[168:171],a[128:131],v[44:47],v[168:171]
ds_read_b64_tr_b16 a[128:129],v4 offset:256
v_fma_f32 v79,v79,s36,v13
v_mfma_f32_16x16x32_bf16 v[172:175],a[132:135],v[44:47],v[172:175]
ds_read_b64_tr_b16 a[130:131],v4 offset:6400
v_fma_f32 v84,v84,s36,v14
v_mfma_f32_16x16x32_bf16 v[176:179],a[136:139],v[44:47],v[176:179]
s_waitcnt lgkmcnt(2)
ds_read_b64_tr_b16 a[132:133],v5 offset:256
v_fma_f32 v85,v85,s36,v14
v_mfma_f32_16x16x32_bf16 v[180:183],a[140:143],v[44:47],v[180:183]
ds_read_b64_tr_b16 a[134:135],v5 offset:6400
v_fma_f32 v86,v86,s36,v14
v_mfma_f32_16x16x32_bf16 v[228:231],a[140:143],v[48:51],v[228:231]
v_exp_f32 v97,v97
v_mfma_f32_16x16x32_bf16 v[224:227],a[136:139],v[48:51],v[224:227]
v_exp_f32 v98,v98
v_mfma_f32_16x16x32_bf16 v[128:131],a[136:139],v[52:55],v[128:131]
v_exp_f32 v99,v99
v_mfma_f32_16x16x32_bf16 v[132:135],a[140:143],v[52:55],v[132:135]
v_cvt_pk_bf16_f32 v32,v96,v97
v_cvt_pk_bf16_f32 v33,v98,v99
v_mfma_f32_16x16x32_bf16 a[180:183],a[140:143],v[56:59],a[180:183]
v_exp_f32 v104,v104
v_mfma_f32_16x16x32_bf16 a[176:179],a[136:139],v[56:59],a[176:179]
buffer_load_dwordx4 v8,s[12:15],s28 offen offset:2048 nt lds
v_mfma_f32_16x16x32_bf16 a[224:227],a[136:139],v[40:43],a[224:227]
s_add_u32 s28,s28,3072
v_exp_f32 v105,v105
v_mfma_f32_16x16x32_bf16 a[228:231],a[140:143],v[40:43],a[228:231]
s_add_u32 s29,s29,3072
v_exp_f32 v106,v106
v_mfma_f32_16x16x32_bf16 a[232:235],a[144:147],v[40:43],a[232:235]
s_add_u32 m0,s23,0
v_exp_f32 v107,v107
v_mfma_f32_16x16x32_bf16 a[236:239],a[148:151],v[40:43],a[236:239]
v_cvt_pk_bf16_f32 v36,v104,v105
v_cvt_pk_bf16_f32 v37,v106,v107
v_mfma_f32_16x16x32_bf16 a[188:191],a[148:151],v[56:59],a[188:191]
v_exp_f32 v76,v76
v_mfma_f32_16x16x32_bf16 a[184:187],a[144:147],v[56:59],a[184:187]
v_exp_f32 v77,v77
v_mfma_f32_16x16x32_bf16 v[136:139],a[144:147],v[52:55],v[136:139]
v_exp_f32 v78,v78
v_mfma_f32_16x16x32_bf16 v[140:143],a[148:151],v[52:55],v[140:143]
v_exp_f32 v79,v79
v_mfma_f32_16x16x32_bf16 v[236:239],a[148:151],v[48:51],v[236:239]
v_cvt_pk_bf16_f32 v22,v76,v77
v_cvt_pk_bf16_f32 v23,v78,v79
v_mfma_f32_16x16x32_bf16 v[232:235],a[144:147],v[48:51],v[232:235]
v_fma_f32 v87,v87,s36,v14
v_fma_f32 v92,v92,s36,v15
v_mfma_f32_16x16x32_bf16 v[184:187],a[144:147],v[44:47],v[184:187]
v_exp_f32 v84,v84
v_mfma_f32_16x16x32_bf16 v[188:191],a[148:151],v[44:47],v[188:191]
s_waitcnt vmcnt(12) lgkmcnt(0)
v_exp_f32 v85,v85
v_mfma_f32_16x16x32_bf16 v[192:195],a[120:123],v[44:47],v[192:195]
s_barrier
v_mfma_f32_16x16x32_bf16 v[196:199],a[124:127],v[44:47],v[196:199]
ds_read_b128 a[136:139],v0 offset:24576
v_cvt_pk_bf16_f32 v26,v84,v85
v_mfma_f32_16x16x32_bf16 v[244:247],a[124:127],v[48:51],v[244:247]
ds_read_b128 a[140:143],v1 offset:24576
v_fma_f32 v93,v93,s36,v15
v_mfma_f32_16x16x32_bf16 v[240:243],a[120:123],v[48:51],v[240:243]
ds_read_b128 a[144:147],v0 offset:24704
v_fma_f32 v94,v94,s36,v15
v_mfma_f32_16x16x32_bf16 v[144:147],a[120:123],v[52:55],v[144:147]
ds_read_b128 a[148:151],v1 offset:24704
v_fma_f32 v95,v95,s36,v15
v_mfma_f32_16x16x32_bf16 v[148:151],a[124:127],v[52:55],v[148:151]
v_exp_f32 v86,v86
v_mfma_f32_16x16x32_bf16 a[196:199],a[124:127],v[56:59],a[196:199]
buffer_load_dwordx4 v6,s[8:11],s21 offen offset:0 lds
v_mfma_f32_16x16x32_bf16 a[192:195],a[120:123],v[56:59],a[192:195]
v_exp_f32 v87,v87
v_mfma_f32_16x16x32_bf16 a[240:243],a[120:123],v[40:43],a[240:243]
ds_read_b128 a[120:123],v0 offset:24832
v_cvt_pk_bf16_f32 v27,v86,v87
v_mfma_f32_16x16x32_bf16 a[244:247],a[124:127],v[40:43],a[244:247]
ds_read_b128 a[124:127],v1 offset:24832
v_fma_f32 v100,v100,s36,v16
v_smfmac_f32_16x16x64_bf16 v[60:63],a[152:155],v[20:27],v18
v_fma_f32 v101,v101,s36,v16
v_mfma_f32_16x16x32_bf16 a[248:251],a[128:131],v[40:43],a[248:251]
v_exp_f32 v92,v92
v_mfma_f32_16x16x32_bf16 a[252:255],a[132:135],v[40:43],a[252:255]
v_exp_f32 v93,v93
v_mfma_f32_16x16x32_bf16 a[204:207],a[132:135],v[56:59],a[204:207]
v_exp_f32 v94,v94
v_mfma_f32_16x16x32_bf16 a[200:203],a[128:131],v[56:59],a[200:203]
v_exp_f32 v95,v95
v_mfma_f32_16x16x32_bf16 v[152:155],a[128:131],v[52:55],v[152:155]
v_cvt_pk_bf16_f32 v30,v92,v93
v_cvt_pk_bf16_f32 v31,v94,v95
v_mfma_f32_16x16x32_bf16 v[156:159],a[132:135],v[52:55],v[156:159]
v_fma_f32 v102,v102,s36,v16
v_fma_f32 v103,v103,s36,v16
v_mfma_f32_16x16x32_bf16 v[252:255],a[132:135],v[48:51],v[252:255]
v_exp_f32 v100,v100
v_mfma_f32_16x16x32_bf16 v[248:251],a[128:131],v[48:51],v[248:251]
buffer_load_dwordx4 v7,s[8:11],s21 offen offset:1024 lds
v_mfma_f32_16x16x32_bf16 v[200:203],a[128:131],v[44:47],v[200:203]
ds_read_b128 a[128:131],v0 offset:30720
v_fma_f32 v108,v108,s36,v17
v_mfma_f32_16x16x32_bf16 v[204:207],a[132:135],v[44:47],v[204:207]
s_waitcnt lgkmcnt(1)
ds_read_b128 a[132:135],v1 offset:30720
v_fma_f32 v109,v109,s36,v17
v_mfma_f32_16x16x32_bf16 v[72:75],a[136:139],a[0:3],0
v_exp_f32 v101,v101
v_mfma_f32_16x16x32_bf16 v[72:75],a[140:143],a[4:7],v[72:75]
v_exp_f32 v102,v102
v_mfma_f32_16x16x32_bf16 v[72:75],a[144:147],a[8:11],v[72:75]
v_exp_f32 v103,v103
v_mfma_f32_16x16x32_bf16 v[72:75],a[148:151],a[12:15],v[72:75]
v_cvt_pk_bf16_f32 v34,v100,v101
v_cvt_pk_bf16_f32 v35,v102,v103
v_mfma_f32_16x16x32_bf16 v[72:75],a[120:123],a[16:19],v[72:75]
v_fma_f32 v110,v110,s36,v17
v_fma_f32 v111,v111,s36,v17
v_smfmac_f32_16x16x64_bf16 v[64:67],a[152:155],v[28:35],v18
v_mfma_f32_16x16x32_bf16 v[72:75],a[124:127],a[20:23],v[72:75]
v_exp_f32 v108,v108
v_mfma_f32_16x16x32_bf16 v[80:83],a[124:127],a[44:47],0
v_exp_f32 v109,v109
v_mfma_f32_16x16x32_bf16 v[80:83],a[120:123],a[40:43],v[80:83]
buffer_load_dwordx4 v8,s[8:11],s21 offen offset:2048 lds
v_mfma_f32_16x16x32_bf16 v[80:83],a[148:151],a[36:39],v[80:83]
s_add_u32 s21,s21,12288
v_exp_f32 v110,v110
v_mfma_f32_16x16x32_bf16 v[80:83],a[144:147],a[32:35],v[80:83]
s_add_u32 m0,s22,12288
v_exp_f32 v111,v111
v_mfma_f32_16x16x32_bf16 v[80:83],a[140:143],a[28:31],v[80:83]
v_cvt_pk_bf16_f32 v38,v108,v109
v_cvt_pk_bf16_f32 v39,v110,v111
v_mfma_f32_16x16x32_bf16 v[80:83],a[136:139],a[24:27],v[80:83]
v_fma_f32 v72,v72,s36,v13
v_fma_f32 v73,v73,s36,v13
v_mfma_f32_16x16x32_bf16 v[88:91],a[136:139],a[48:51],0
v_fma_f32 v74,v74,s36,v13
v_fma_f32 v75,v75,s36,v13
v_mfma_f32_16x16x32_bf16 v[88:91],a[140:143],a[52:55],v[88:91]
v_exp_f32 v72,v72
v_mfma_f32_16x16x32_bf16 v[88:91],a[144:147],a[56:59],v[88:91]
v_fma_f32 v80,v80,s36,v14
v_fma_f32 v81,v81,s36,v14
v_mfma_f32_16x16x32_bf16 v[88:91],a[148:151],a[60:63],v[88:91]
v_fma_f32 v82,v82,s36,v14
v_fma_f32 v83,v83,s36,v14
v_mfma_f32_16x16x32_bf16 v[88:91],a[120:123],a[64:67],v[88:91]
v_exp_f32 v73,v73
v_mfma_f32_16x16x32_bf16 v[88:91],a[124:127],a[68:71],v[88:91]
v_exp_f32 v74,v74
v_mfma_f32_16x16x32_bf16 v[96:99],a[124:127],a[92:95],0
v_exp_f32 v75,v75
v_mfma_f32_16x16x32_bf16 v[96:99],a[120:123],a[88:91],v[96:99]
buffer_load_dwordx4 v6,s[4:7],s20 offen offset:0 lds
v_mfma_f32_16x16x32_bf16 v[96:99],a[148:151],a[84:87],v[96:99]
v_exp_f32 v80,v80
v_mfma_f32_16x16x32_bf16 v[96:99],a[144:147],a[80:83],v[96:99]
v_fma_f32 v88,v88,s36,v15
v_fma_f32 v89,v89,s36,v15
v_mfma_f32_16x16x32_bf16 v[96:99],a[140:143],a[76:79],v[96:99]
v_exp_f32 v81,v81
v_mfma_f32_16x16x32_bf16 v[96:99],a[136:139],a[72:75],v[96:99]
v_exp_f32 v82,v82
v_mfma_f32_16x16x32_bf16 v[104:107],a[136:139],a[96:99],0
ds_read_b128 a[136:139],v0 offset:30848
v_cvt_pk_bf16_f32 v44,v72,v73
v_mfma_f32_16x16x32_bf16 v[104:107],a[140:143],a[100:103],v[104:107]
ds_read_b128 a[140:143],v1 offset:30848
v_cvt_pk_bf16_f32 v45,v74,v75
v_mfma_f32_16x16x32_bf16 v[104:107],a[144:147],a[104:107],v[104:107]
ds_read_b128 a[144:147],v0 offset:30976
v_cvt_pk_bf16_f32 v48,v80,v81
v_mfma_f32_16x16x32_bf16 v[104:107],a[148:151],a[108:111],v[104:107]
ds_read_b128 a[148:151],v1 offset:30976
v_mfma_f32_16x16x32_bf16 v[104:107],a[120:123],a[112:115],v[104:107]
v_exp_f32 v83,v83
v_mfma_f32_16x16x32_bf16 v[104:107],a[124:127],a[116:119],v[104:107]
s_waitcnt lgkmcnt(4)
v_exp_f32 v88,v88
v_mfma_f32_16x16x32_bf16 v[76:79],a[128:131],a[0:3],0
v_exp_f32 v89,v89
v_mfma_f32_16x16x32_bf16 v[76:79],a[132:135],a[4:7],v[76:79]
buffer_load_dwordx4 v7,s[4:7],s20 offen offset:1024 lds
s_waitcnt lgkmcnt(3)
v_mfma_f32_16x16x32_bf16 v[76:79],a[136:139],a[8:11],v[76:79]
s_waitcnt lgkmcnt(2)
v_cvt_pk_bf16_f32 v49,v82,v83
v_cvt_pk_bf16_f32 v52,v88,v89
v_mfma_f32_16x16x32_bf16 v[76:79],a[140:143],a[12:15],v[76:79]
s_waitcnt lgkmcnt(0)
v_mfma_f32_16x16x32_bf16 v[76:79],a[144:147],a[16:19],v[76:79]
v_mfma_f32_16x16x32_bf16 v[76:79],a[148:151],a[20:23],v[76:79]
v_mfma_f32_16x16x32_bf16 v[84:87],a[148:151],a[44:47],0
v_mfma_f32_16x16x32_bf16 v[84:87],a[144:147],a[40:43],v[84:87]
v_mfma_f32_16x16x32_bf16 v[84:87],a[140:143],a[36:39],v[84:87]
v_mfma_f32_16x16x32_bf16 v[84:87],a[136:139],a[32:35],v[84:87]
v_mfma_f32_16x16x32_bf16 v[84:87],a[132:135],a[28:31],v[84:87]
v_mfma_f32_16x16x32_bf16 v[84:87],a[128:131],a[24:27],v[84:87]
v_mfma_f32_16x16x32_bf16 v[92:95],a[128:131],a[48:51],0
buffer_load_dwordx4 v8,s[4:7],s20 offen offset:2048 lds
v_mfma_f32_16x16x32_bf16 v[92:95],a[132:135],a[52:55],v[92:95]
s_add_u32 s20,s20,12288
v_mfma_f32_16x16x32_bf16 v[92:95],a[136:139],a[56:59],v[92:95]
v_mfma_f32_16x16x32_bf16 v[92:95],a[140:143],a[60:63],v[92:95]
v_mfma_f32_16x16x32_bf16 v[92:95],a[144:147],a[64:67],v[92:95]
v_mfma_f32_16x16x32_bf16 v[92:95],a[148:151],a[68:71],v[92:95]
v_mfma_f32_16x16x32_bf16 v[100:103],a[148:151],a[92:95],0
ds_read_b64_tr_b16 a[120:121],v2 offset:12288
v_mfma_f32_16x16x32_bf16 v[100:103],a[144:147],a[88:91],v[100:103]
ds_read_b64_tr_b16 a[122:123],v2 offset:18432
v_mfma_f32_16x16x32_bf16 v[100:103],a[140:143],a[84:87],v[100:103]
v_mfma_f32_16x16x32_bf16 v[100:103],a[136:139],a[80:83],v[100:103]
ds_read_b64_tr_b16 a[124:125],v3 offset:12288
v_mfma_f32_16x16x32_bf16 v[100:103],a[132:135],a[76:79],v[100:103]
ds_read_b64_tr_b16 a[126:127],v3 offset:18432
v_mfma_f32_16x16x32_bf16 v[100:103],a[128:131],a[72:75],v[100:103]
v_mfma_f32_16x16x32_bf16 v[108:111],a[128:131],a[96:99],0
ds_read_b64_tr_b16 a[128:129],v4 offset:12288
v_mfma_f32_16x16x32_bf16 v[108:111],a[132:135],a[100:103],v[108:111]
ds_read_b64_tr_b16 a[130:131],v4 offset:18432
v_mfma_f32_16x16x32_bf16 v[108:111],a[136:139],a[104:107],v[108:111]
ds_read_b64_tr_b16 a[132:133],v5 offset:12288
v_mfma_f32_16x16x32_bf16 v[108:111],a[140:143],a[108:111],v[108:111]
ds_read_b64_tr_b16 a[134:135],v5 offset:18432
v_mfma_f32_16x16x32_bf16 v[108:111],a[144:147],a[112:115],v[108:111]
v_mfma_f32_16x16x32_bf16 v[108:111],a[148:151],a[116:119],v[108:111]
s_waitcnt lgkmcnt(4)
v_mfma_f32_16x16x32_bf16 v[160:163],a[120:123],v[20:23],v[160:163]
ds_read_b128 a[156:159],v10 offset:3072
v_mbcnt_lo_u32_b32 v19,-1,0
v_mfma_f32_16x16x32_bf16 v[164:167],a[124:127],v[20:23],v[164:167]
ds_read_b64_tr_b16 a[138:139],v2 offset:18560
v_mbcnt_hi_u32_b32 v19,-1,v19
v_mfma_f32_16x16x32_bf16 v[212:215],a[124:127],v[24:27],v[212:215]
ds_read_b64_tr_b16 a[136:137],v2 offset:12416
v_min_u32 v19,7,v19
v_mfma_f32_16x16x32_bf16 v[208:211],a[120:123],v[24:27],v[208:211]
ds_read_b64_tr_b16 a[140:141],v3 offset:12416
v_lshl_add_u32 v19,v19,7,s48
v_mfma_f32_16x16x32_bf16 v[112:115],a[120:123],v[28:31],v[112:115]
ds_read_b64_tr_b16 a[142:143],v3 offset:18560
v_min_u32 v19,L_codeend-L_first-4,v19
v_mfma_f32_16x16x32_bf16 v[116:119],a[124:127],v[28:31],v[116:119]
ds_read_b64_tr_b16 a[144:145],v4 offset:12416
v_fma_f32 v91,v91,s36,v15
v_mfma_f32_16x16x32_bf16 a[164:167],a[124:127],v[32:35],a[164:167]
ds_read_b64_tr_b16 a[146:147],v4 offset:18560
v_fma_f32 v90,v90,s36,v15
v_mfma_f32_16x16x32_bf16 a[160:163],a[120:123],v[32:35],a[160:163]
ds_read_b64_tr_b16 a[150:151],v5 offset:18560
v_fma_f32 v99,v99,s36,v16
v_mfma_f32_16x16x32_bf16 a[208:211],a[120:123],v[36:39],a[208:211]
ds_read_b64_tr_b16 a[148:149],v5 offset:12416
v_fma_f32 v96,v96,s36,v16
v_mfma_f32_16x16x32_bf16 a[212:215],a[124:127],v[36:39],a[212:215]
s_waitcnt lgkmcnt(6)
ds_read_b64_tr_b16 a[122:123],v2 offset:18688
v_fma_f32 v98,v98,s36,v16
v_mfma_f32_16x16x32_bf16 a[216:219],a[128:131],v[36:39],a[216:219]
ds_read_b64_tr_b16 a[120:121],v2 offset:12544
v_fma_f32 v97,v97,s36,v16
v_mfma_f32_16x16x32_bf16 a[220:223],a[132:135],v[36:39],a[220:223]
ds_read_b64_tr_b16 a[126:127],v3 offset:18688
v_fma_f32 v107,v107,s36,v17
v_mfma_f32_16x16x32_bf16 a[172:175],a[132:135],v[32:35],a[172:175]
ds_read_b64_tr_b16 a[124:125],v3 offset:12544
v_fma_f32 v105,v105,s36,v17
v_mfma_f32_16x16x32_bf16 a[168:171],a[128:131],v[32:35],a[168:171]
v_exp_f32 v90,v90
v_mfma_f32_16x16x32_bf16 v[120:123],a[128:131],v[28:31],v[120:123]
v_exp_f32 v91,v91
v_mfma_f32_16x16x32_bf16 v[124:127],a[132:135],v[28:31],v[124:127]
v_cvt_pk_bf16_f32 v53,v90,v91
v_fma_f32 v106,v106,s36,v17
v_mfma_f32_16x16x32_bf16 v[220:223],a[132:135],v[24:27],v[220:223]
v_exp_f32 v97,v97
v_mfma_f32_16x16x32_bf16 v[216:219],a[128:131],v[24:27],v[216:219]
buffer_store_dwordx4 a[156:159],v9,s[16:19],s27 offen offset:0 nt
v_exp_f32 v98,v98
v_fma_f32 v104,v104,s36,v17
v_mfma_f32_16x16x32_bf16 v[168:171],a[128:131],v[20:23],v[168:171]
ds_read_b128 a[156:159],v10 offset:4096
v_fma_f32 v78,v78,s36,v13
v_mfma_f32_16x16x32_bf16 v[172:175],a[132:135],v[20:23],v[172:175]
global_load_dword v19,v19,s[46:47]
v_mfma_f32_16x16x32_bf16 v[176:179],a[136:139],v[20:23],v[176:179]
s_waitcnt lgkmcnt(1)
ds_read_b64_tr_b16 a[128:129],v4 offset:12544
v_fma_f32 v76,v76,s36,v13
v_mfma_f32_16x16x32_bf16 v[180:183],a[140:143],v[20:23],v[180:183]
ds_read_b64_tr_b16 a[132:133],v5 offset:12544
v_fma_f32 v77,v77,s36,v13
v_mfma_f32_16x16x32_bf16 v[228:231],a[140:143],v[24:27],v[228:231]
ds_read_b64_tr_b16 a[130:131],v4 offset:18688
v_fma_f32 v79,v79,s36,v13
v_mfma_f32_16x16x32_bf16 v[224:227],a[136:139],v[24:27],v[224:227]
ds_read_b64_tr_b16 a[134:135],v5 offset:18688
v_fma_f32 v86,v86,s36,v14
v_mfma_f32_16x16x32_bf16 v[128:131],a[136:139],v[28:31],v[128:131]
v_exp_f32 v99,v99
v_mfma_f32_16x16x32_bf16 v[132:135],a[140:143],v[28:31],v[132:135]
v_exp_f32 v96,v96
v_mfma_f32_16x16x32_bf16 a[180:183],a[140:143],v[32:35],a[180:183]
s_waitcnt lgkmcnt(4)
buffer_store_dwordx4 a[156:159],v9,s[16:19],s27 offen offset:128 nt
v_cvt_pk_bf16_f32 v57,v98,v99
v_cvt_pk_bf16_f32 v56,v96,v97
v_fma_f32 v87,v87,s36,v14
v_mfma_f32_16x16x32_bf16 a[176:179],a[136:139],v[32:35],a[176:179]
ds_read_b128 a[156:159],v10 offset:5120
v_fma_f32 v84,v84,s36,v14
v_mfma_f32_16x16x32_bf16 a[224:227],a[136:139],v[36:39],a[224:227]
v_exp_f32 v105,v105
v_mfma_f32_16x16x32_bf16 a[228:231],a[140:143],v[36:39],a[228:231]
v_exp_f32 v104,v104
v_mfma_f32_16x16x32_bf16 a[232:235],a[144:147],v[36:39],a[232:235]
v_exp_f32 v107,v107
v_mfma_f32_16x16x32_bf16 a[236:239],a[148:151],v[36:39],a[236:239]
v_exp_f32 v106,v106
v_mfma_f32_16x16x32_bf16 a[188:191],a[148:151],v[32:35],a[188:191]
v_cvt_pk_bf16_f32 v41,v106,v107
v_cvt_pk_bf16_f32 v40,v104,v105
v_mfma_f32_16x16x32_bf16 a[184:187],a[144:147],v[32:35],a[184:187]
v_exp_f32 v79,v79
v_mfma_f32_16x16x32_bf16 v[136:139],a[144:147],v[28:31],v[136:139]
v_exp_f32 v76,v76
v_mfma_f32_16x16x32_bf16 v[140:143],a[148:151],v[28:31],v[140:143]
s_waitcnt lgkmcnt(0)
buffer_store_dwordx4 a[156:159],v9,s[16:19],s27 offen offset:256 nt
v_exp_f32 v78,v78
v_fma_f32 v85,v85,s36,v14
v_mfma_f32_16x16x32_bf16 v[236:239],a[148:151],v[24:27],v[236:239]
s_add_u32 s27,s27,3072
v_exp_f32 v77,v77
v_mfma_f32_16x16x32_bf16 v[232:235],a[144:147],v[24:27],v[232:235]
s_waitcnt vmcnt(13)
v_cvt_pk_bf16_f32 v47,v78,v79
v_cvt_pk_bf16_f32 v46,v76,v77
v_mfma_f32_16x16x32_bf16 v[184:187],a[144:147],v[20:23],v[184:187]
s_barrier
v_mfma_f32_16x16x32_bf16 v[188:191],a[148:151],v[20:23],v[188:191]
s_add_u32 m0,s23,12288
ds_read_b128 a[136:139],v0 offset:0
v_fma_f32 v94,v94,s36,v15
v_mfma_f32_16x16x32_bf16 v[192:195],a[120:123],v[20:23],v[192:195]
ds_read_b128 a[140:143],v1 offset:0
v_fma_f32 v95,v95,s36,v15
v_mfma_f32_16x16x32_bf16 v[196:199],a[124:127],v[20:23],v[196:199]
ds_read_b128 a[144:147],v0 offset:128
v_fma_f32 v92,v92,s36,v15
v_mfma_f32_16x16x32_bf16 v[244:247],a[124:127],v[24:27],v[244:247]
ds_read_b128 a[148:151],v1 offset:128
v_fma_f32 v93,v93,s36,v15
v_mfma_f32_16x16x32_bf16 v[240:243],a[120:123],v[24:27],v[240:243]
v_exp_f32 v84,v84
v_mfma_f32_16x16x32_bf16 v[144:147],a[120:123],v[28:31],v[144:147]
buffer_load_dwordx4 v6,s[8:11],s21 offen offset:0 lds
v_mfma_f32_16x16x32_bf16 v[148:151],a[124:127],v[28:31],v[148:151]
v_exp_f32 v85,v85
v_mfma_f32_16x16x32_bf16 a[196:199],a[124:127],v[32:35],a[196:199]
v_exp_f32 v87,v87
v_mfma_f32_16x16x32_bf16 a[192:195],a[120:123],v[32:35],a[192:195]
v_exp_f32 v86,v86
v_mfma_f32_16x16x32_bf16 a[240:243],a[120:123],v[36:39],a[240:243]
ds_read_b128 a[120:123],v0 offset:256
v_cvt_pk_bf16_f32 v51,v86,v87
v_mfma_f32_16x16x32_bf16 a[244:247],a[124:127],v[36:39],a[244:247]
ds_read_b128 a[124:127],v1 offset:256
v_cvt_pk_bf16_f32 v50,v84,v85
v_mfma_f32_16x16x32_bf16 a[248:251],a[128:131],v[36:39],a[248:251]
v_exp_f32 v92,v92
v_smfmac_f32_16x16x64_bf16 v[60:63],a[152:155],v[44:51],v18
v_fma_f32 v103,v103,s36,v16
v_mfma_f32_16x16x32_bf16 a[252:255],a[132:135],v[36:39],a[252:255]
v_exp_f32 v93,v93
v_mfma_f32_16x16x32_bf16 a[204:207],a[132:135],v[32:35],a[204:207]
v_exp_f32 v94,v94
v_mfma_f32_16x16x32_bf16 a[200:203],a[128:131],v[32:35],a[200:203]
v_exp_f32 v95,v95
v_mfma_f32_16x16x32_bf16 v[152:155],a[128:131],v[28:31],v[152:155]
buffer_load_dwordx4 v7,s[8:11],s21 offen offset:1024 lds
v_mfma_f32_16x16x32_bf16 v[156:159],a[132:135],v[28:31],v[156:159]
v_cvt_pk_bf16_f32 v55,v94,v95
v_cvt_pk_bf16_f32 v54,v92,v93
v_mfma_f32_16x16x32_bf16 v[252:255],a[132:135],v[24:27],v[252:255]
v_exp_f32 v103,v103
v_mfma_f32_16x16x32_bf16 v[248:251],a[128:131],v[24:27],v[248:251]
v_fma_f32 v101,v101,s36,v16
v_fma_f32 v102,v102,s36,v16
v_mfma_f32_16x16x32_bf16 v[200:203],a[128:131],v[20:23],v[200:203]
ds_read_b128 a[128:131],v0 offset:6144
v_fma_f32 v100,v100,s36,v16
v_mfma_f32_16x16x32_bf16 v[204:207],a[132:135],v[20:23],v[204:207]
s_waitcnt lgkmcnt(1)
ds_read_b128 a[132:135],v1 offset:6144
v_fma_f32 v109,v109,s36,v17
v_mfma_f32_16x16x32_bf16 v[72:75],a[136:139],a[0:3],0
v_exp_f32 v100,v100
v_mfma_f32_16x16x32_bf16 v[72:75],a[140:143],a[4:7],v[72:75]
v_exp_f32 v101,v101
v_mfma_f32_16x16x32_bf16 v[72:75],a[144:147],a[8:11],v[72:75]
v_exp_f32 v102,v102
v_mfma_f32_16x16x32_bf16 v[72:75],a[148:151],a[12:15],v[72:75]
v_cvt_pk_bf16_f32 v59,v102,v103
v_cvt_pk_bf16_f32 v58,v100,v101
v_mfma_f32_16x16x32_bf16 v[72:75],a[120:123],a[16:19],v[72:75]
v_exp_f32 v109,v109
v_smfmac_f32_16x16x64_bf16 v[64:67],a[152:155],v[52:59],v18
v_fma_f32 v110,v110,s36,v17
v_mfma_f32_16x16x32_bf16 v[72:75],a[124:127],a[20:23],v[72:75]
buffer_load_dwordx4 v8,s[8:11],s21 offen offset:2048 lds
v_mfma_f32_16x16x32_bf16 v[80:83],a[124:127],a[44:47],0
s_add_u32 s21,s21,12288
v_exp_f32 v110,v110
v_mfma_f32_16x16x32_bf16 v[80:83],a[120:123],a[40:43],v[80:83]
s_add_u32 m0,s22,24576
v_fma_f32 v111,v111,s36,v17
v_fma_f32 v108,v108,s36,v17
v_mfma_f32_16x16x32_bf16 v[80:83],a[148:151],a[36:39],v[80:83]
v_exp_f32 v111,v111
v_mfma_f32_16x16x32_bf16 v[80:83],a[144:147],a[32:35],v[80:83]
v_exp_f32 v108,v108
v_mfma_f32_16x16x32_bf16 v[80:83],a[140:143],a[28:31],v[80:83]
v_cvt_pk_bf16_f32 v42,v108,v109
v_cvt_pk_bf16_f32 v43,v110,v111
v_mfma_f32_16x16x32_bf16 v[80:83],a[136:139],a[24:27],v[80:83]
v_fma_f32 v73,v73,s36,v13
v_fma_f32 v72,v72,s36,v13
v_smfmac_f32_16x16x64_bf16 v[68:71],a[152:155],v[36:43],v18
v_fma_f32 v74,v74,s36,v13
v_mfma_f32_16x16x32_bf16 v[88:91],a[136:139],a[48:51],0
v_exp_f32 v72,v72
v_mfma_f32_16x16x32_bf16 v[88:91],a[140:143],a[52:55],v[88:91]
v_exp_f32 v74,v74
v_mfma_f32_16x16x32_bf16 v[88:91],a[144:147],a[56:59],v[88:91]
v_exp_f32 v73,v73
v_mfma_f32_16x16x32_bf16 v[88:91],a[148:151],a[60:63],v[88:91]
v_fma_f32 v82,v82,s36,v14
v_fma_f32 v81,v81,s36,v14
v_mfma_f32_16x16x32_bf16 v[88:91],a[120:123],a[64:67],v[88:91]
buffer_load_dwordx4 v6,s[4:7],s20 offen offset:0 lds
v_mfma_f32_16x16x32_bf16 v[88:91],a[124:127],a[68:71],v[88:91]
v_exp_f32 v82,v82
v_mfma_f32_16x16x32_bf16 v[96:99],a[124:127],a[92:95],0
v_exp_f32 v81,v81
v_mfma_f32_16x16x32_bf16 v[96:99],a[120:123],a[88:91],v[96:99]
v_fma_f32 v80,v80,s36,v14
v_fma_f32 v75,v75,s36,v13
v_mfma_f32_16x16x32_bf16 v[96:99],a[148:151],a[84:87],v[96:99]
v_exp_f32 v75,v75
v_mfma_f32_16x16x32_bf16 v[96:99],a[144:147],a[80:83],v[96:99]
v_exp_f32 v80,v80
v_mfma_f32_16x16x32_bf16 v[96:99],a[140:143],a[76:79],v[96:99]
v_fma_f32 v83,v83,s36,v14
v_fma_f32 v88,v88,s36,v15
v_mfma_f32_16x16x32_bf16 v[96:99],a[136:139],a[72:75],v[96:99]
v_exp_f32 v83,v83
v_mfma_f32_16x16x32_bf16 v[104:107],a[136:139],a[96:99],0
ds_read_b128 a[136:139],v0 offset:6272
v_fma_f32 v89,v89,s36,v15
v_mfma_f32_16x16x32_bf16 v[104:107],a[140:143],a[100:103],v[104:107]
ds_read_b128 a[140:143],v1 offset:6272
v_cvt_pk_bf16_f32 v20,v72,v73
v_mfma_f32_16x16x32_bf16 v[104:107],a[144:147],a[104:107],v[104:107]
ds_read_b128 a[144:147],v0 offset:6400
v_cvt_pk_bf16_f32 v24,v80,v81
v_mfma_f32_16x16x32_bf16 v[104:107],a[148:151],a[108:111],v[104:107]
buffer_load_dwordx4 v7,s[4:7],s20 offen offset:1024 lds
v_mfma_f32_16x16x32_bf16 v[104:107],a[120:123],a[112:115],v[104:107]
ds_read_b128 a[148:151],v1 offset:6400
v_cvt_pk_bf16_f32 v25,v82,v83
v_mfma_f32_16x16x32_bf16 v[104:107],a[124:127],a[116:119],v[104:107]
s_waitcnt lgkmcnt(4)
v_exp_f32 v88,v88
v_mfma_f32_16x16x32_bf16 v[76:79],a[128:131],a[0:3],0
v_exp_f32 v89,v89
v_mfma_f32_16x16x32_bf16 v[76:79],a[132:135],a[4:7],v[76:79]
s_waitcnt lgkmcnt(3)
v_cvt_pk_bf16_f32 v28,v88,v89
v_cvt_pk_bf16_f32 v21,v74,v75
v_mfma_f32_16x16x32_bf16 v[76:79],a[136:139],a[8:11],v[76:79]
s_waitcnt lgkmcnt(2)
v_mfma_f32_16x16x32_bf16 v[76:79],a[140:143],a[12:15],v[76:79]
s_waitcnt lgkmcnt(1)
v_mfma_f32_16x16x32_bf16 v[76:79],a[144:147],a[16:19],v[76:79]
s_waitcnt lgkmcnt(0)
v_mfma_f32_16x16x32_bf16 v[76:79],a[148:151],a[20:23],v[76:79]
v_mfma_f32_16x16x32_bf16 v[84:87],a[148:151],a[44:47],0
v_mfma_f32_16x16x32_bf16 v[84:87],a[144:147],a[40:43],v[84:87]
v_mfma_f32_16x16x32_bf16 v[84:87],a[140:143],a[36:39],v[84:87]
buffer_load_dwordx4 v8,s[4:7],s20 offen offset:2048 lds
v_mfma_f32_16x16x32_bf16 v[84:87],a[136:139],a[32:35],v[84:87]
s_add_u32 s20,s20,12288
v_mfma_f32_16x16x32_bf16 v[84:87],a[132:135],a[28:31],v[84:87]
v_mfma_f32_16x16x32_bf16 v[84:87],a[128:131],a[24:27],v[84:87]
v_mfma_f32_16x16x32_bf16 v[92:95],a[128:131],a[48:51],0
v_mfma_f32_16x16x32_bf16 v[92:95],a[132:135],a[52:55],v[92:95]
v_mfma_f32_16x16x32_bf16 v[92:95],a[136:139],a[56:59],v[92:95]
ds_read_b64_tr_b16 a[122:123],v2 offset:30720
v_mfma_f32_16x16x32_bf16 v[92:95],a[140:143],a[60:63],v[92:95]
ds_read_b64_tr_b16 a[120:121],v2 offset:24576
v_mfma_f32_16x16x32_bf16 v[92:95],a[144:147],a[64:67],v[92:95]
ds_read_b64_tr_b16 a[124:125],v3 offset:24576
v_mfma_f32_16x16x32_bf16 v[92:95],a[148:151],a[68:71],v[92:95]
ds_read_b64_tr_b16 a[126:127],v3 offset:30720
v_mfma_f32_16x16x32_bf16 v[100:103],a[148:151],a[92:95],0
v_mfma_f32_16x16x32_bf16 v[100:103],a[144:147],a[88:91],v[100:103]
v_mfma_f32_16x16x32_bf16 v[100:103],a[140:143],a[84:87],v[100:103]
v_mfma_f32_16x16x32_bf16 v[100:103],a[136:139],a[80:83],v[100:103]
v_mfma_f32_16x16x32_bf16 v[100:103],a[132:135],a[76:79],v[100:103]
v_mfma_f32_16x16x32_bf16 v[100:103],a[128:131],a[72:75],v[100:103]
v_mfma_f32_16x16x32_bf16 v[108:111],a[128:131],a[96:99],0
ds_read_b64_tr_b16 a[128:129],v4 offset:24576
v_mfma_f32_16x16x32_bf16 v[108:111],a[132:135],a[100:103],v[108:111]
ds_read_b64_tr_b16 a[130:131],v4 offset:30720
v_mfma_f32_16x16x32_bf16 v[108:111],a[136:139],a[104:107],v[108:111]
ds_read_b64_tr_b16 a[132:133],v5 offset:24576
v_mfma_f32_16x16x32_bf16 v[108:111],a[140:143],a[108:111],v[108:111]
ds_read_b64_tr_b16 a[134:135],v5 offset:30720
v_mfma_f32_16x16x32_bf16 v[108:111],a[144:147],a[112:115],v[108:111]
v_mfma_f32_16x16x32_bf16 v[108:111],a[148:151],a[116:119],v[108:111]
s_waitcnt lgkmcnt(4)
v_mfma_f32_16x16x32_bf16 v[160:163],a[120:123],v[44:47],v[160:163]
s_add_u32 m0,s29,0
ds_read_b64_tr_b16 a[136:137],v2 offset:24704
v_fma_f32 v90,v90,s36,v15
v_mfma_f32_16x16x32_bf16 v[164:167],a[124:127],v[44:47],v[164:167]
ds_read_b64_tr_b16 a[138:139],v2 offset:30848
v_fma_f32 v91,v91,s36,v15
v_mfma_f32_16x16x32_bf16 v[212:215],a[124:127],v[48:51],v[212:215]
ds_read_b64_tr_b16 a[140:141],v3 offset:24704
v_fma_f32 v96,v96,s36,v16
v_mfma_f32_16x16x32_bf16 v[208:211],a[120:123],v[48:51],v[208:211]
ds_read_b64_tr_b16 a[142:143],v3 offset:30848
v_fma_f32 v97,v97,s36,v16
v_mfma_f32_16x16x32_bf16 v[112:115],a[120:123],v[52:55],v[112:115]
ds_read_b64_tr_b16 a[144:145],v4 offset:24704
v_fma_f32 v98,v98,s36,v16
v_mfma_f32_16x16x32_bf16 v[116:119],a[124:127],v[52:55],v[116:119]
ds_read_b64_tr_b16 a[146:147],v4 offset:30848
v_fma_f32 v99,v99,s36,v16
v_mfma_f32_16x16x32_bf16 a[164:167],a[124:127],v[56:59],a[164:167]
ds_read_b64_tr_b16 a[148:149],v5 offset:24704
v_fma_f32 v104,v104,s36,v17
v_mfma_f32_16x16x32_bf16 a[160:163],a[120:123],v[56:59],a[160:163]
buffer_load_dwordx4 v6,s[12:15],s28 offen offset:0 nt lds
v_mfma_f32_16x16x32_bf16 a[208:211],a[120:123],v[40:43],a[208:211]
ds_read_b64_tr_b16 a[150:151],v5 offset:30848
v_fma_f32 v105,v105,s36,v17
v_mfma_f32_16x16x32_bf16 a[212:215],a[124:127],v[40:43],a[212:215]
s_waitcnt lgkmcnt(5)
ds_read_b64_tr_b16 a[120:121],v2 offset:24832
v_fma_f32 v106,v106,s36,v17
v_mfma_f32_16x16x32_bf16 a[216:219],a[128:131],v[40:43],a[216:219]
ds_read_b64_tr_b16 a[122:123],v2 offset:30976
v_fma_f32 v107,v107,s36,v17
v_mfma_f32_16x16x32_bf16 a[220:223],a[132:135],v[40:43],a[220:223]
ds_read_b64_tr_b16 a[124:125],v3 offset:24832
v_fma_f32 v76,v76,s36,v13
v_mfma_f32_16x16x32_bf16 a[172:175],a[132:135],v[56:59],a[172:175]
ds_read_b64_tr_b16 a[126:127],v3 offset:30976
v_fma_f32 v77,v77,s36,v13
v_mfma_f32_16x16x32_bf16 a[168:171],a[128:131],v[56:59],a[168:171]
v_exp_f32 v90,v90
v_mfma_f32_16x16x32_bf16 v[120:123],a[128:131],v[52:55],v[120:123]
v_exp_f32 v91,v91
v_mfma_f32_16x16x32_bf16 v[124:127],a[132:135],v[52:55],v[124:127]
v_cvt_pk_bf16_f32 v29,v90,v91
v_fma_f32 v78,v78,s36,v13
v_mfma_f32_16x16x32_bf16 v[220:223],a[132:135],v[48:51],v[220:223]
v_exp_f32 v96,v96
v_mfma_f32_16x16x32_bf16 v[216:219],a[128:131],v[48:51],v[216:219]
buffer_load_dwordx4 v7,s[12:15],s28 offen offset:1024 nt lds
v_mfma_f32_16x16x32_bf16 v[168:171],a[128:131],v[44:47],v[168:171]
ds_read_b64_tr_b16 a[128:129],v4 offset:24832
v_fma_f32 v79,v79,s36,v13
v_mfma_f32_16x16x32_bf16 v[172:175],a[132:135],v[44:47],v[172:175]
ds_read_b64_tr_b16 a[130:131],v4 offset:30976
v_fma_f32 v84,v84,s36,v14
v_mfma_f32_16x16x32_bf16 v[176:179],a[136:139],v[44:47],v[176:179]
s_waitcnt lgkmcnt(2)
ds_read_b64_tr_b16 a[132:133],v5 offset:24832
v_fma_f32 v85,v85,s36,v14
v_mfma_f32_16x16x32_bf16 v[180:183],a[140:143],v[44:47],v[180:183]
ds_read_b64_tr_b16 a[134:135],v5 offset:30976
v_fma_f32 v86,v86,s36,v14
v_mfma_f32_16x16x32_bf16 v[228:231],a[140:143],v[48:51],v[228:231]
v_exp_f32 v97,v97
v_mfma_f32_16x16x32_bf16 v[224:227],a[136:139],v[48:51],v[224:227]
v_exp_f32 v98,v98
v_mfma_f32_16x16x32_bf16 v[128:131],a[136:139],v[52:55],v[128:131]
v_exp_f32 v99,v99
v_mfma_f32_16x16x32_bf16 v[132:135],a[140:143],v[52:55],v[132:135]
v_cvt_pk_bf16_f32 v32,v96,v97
v_cvt_pk_bf16_f32 v33,v98,v99
v_mfma_f32_16x16x32_bf16 a[180:183],a[140:143],v[56:59],a[180:183]
v_exp_f32 v104,v104
v_mfma_f32_16x16x32_bf16 a[176:179],a[136:139],v[56:59],a[176:179]
buffer_load_dwordx4 v8,s[12:15],s28 offen offset:2048 nt lds
v_mfma_f32_16x16x32_bf16 a[224:227],a[136:139],v[40:43],a[224:227]
s_add_u32 s28,s28,3072
v_exp_f32 v105,v105
v_mfma_f32_16x16x32_bf16 a[228:231],a[140:143],v[40:43],a[228:231]
s_add_u32 s29,s29,3072
v_exp_f32 v106,v106
v_mfma_f32_16x16x32_bf16 a[232:235],a[144:147],v[40:43],a[232:235]
s_add_u32 m0,s23,24576
v_exp_f32 v107,v107
v_mfma_f32_16x16x32_bf16 a[236:239],a[148:151],v[40:43],a[236:239]
v_cvt_pk_bf16_f32 v36,v104,v105
v_cvt_pk_bf16_f32 v37,v106,v107
v_mfma_f32_16x16x32_bf16 a[188:191],a[148:151],v[56:59],a[188:191]
v_exp_f32 v76,v76
v_mfma_f32_16x16x32_bf16 a[184:187],a[144:147],v[56:59],a[184:187]
v_exp_f32 v77,v77
v_mfma_f32_16x16x32_bf16 v[136:139],a[144:147],v[52:55],v[136:139]
v_exp_f32 v78,v78
v_mfma_f32_16x16x32_bf16 v[140:143],a[148:151],v[52:55],v[140:143]
v_exp_f32 v79,v79
v_mfma_f32_16x16x32_bf16 v[236:239],a[148:151],v[48:51],v[236:239]
v_cvt_pk_bf16_f32 v22,v76,v77
v_cvt_pk_bf16_f32 v23,v78,v79
v_mfma_f32_16x16x32_bf16 v[232:235],a[144:147],v[48:51],v[232:235]
v_fma_f32 v87,v87,s36,v14
v_fma_f32 v92,v92,s36,v15
v_mfma_f32_16x16x32_bf16 v[184:187],a[144:147],v[44:47],v[184:187]
v_exp_f32 v84,v84
v_mfma_f32_16x16x32_bf16 v[188:191],a[148:151],v[44:47],v[188:191]
s_waitcnt vmcnt(13) lgkmcnt(0)
v_exp_f32 v85,v85
v_mfma_f32_16x16x32_bf16 v[192:195],a[120:123],v[44:47],v[192:195]
s_barrier
v_mfma_f32_16x16x32_bf16 v[196:199],a[124:127],v[44:47],v[196:199]
ds_read_b128 a[136:139],v0 offset:12288
v_cvt_pk_bf16_f32 v26,v84,v85
v_mfma_f32_16x16x32_bf16 v[244:247],a[124:127],v[48:51],v[244:247]
ds_read_b128 a[140:143],v1 offset:12288
v_fma_f32 v93,v93,s36,v15
v_mfma_f32_16x16x32_bf16 v[240:243],a[120:123],v[48:51],v[240:243]
ds_read_b128 a[144:147],v0 offset:12416
v_fma_f32 v94,v94,s36,v15
v_mfma_f32_16x16x32_bf16 v[144:147],a[120:123],v[52:55],v[144:147]
ds_read_b128 a[148:151],v1 offset:12416
v_fma_f32 v95,v95,s36,v15
v_mfma_f32_16x16x32_bf16 v[148:151],a[124:127],v[52:55],v[148:151]
v_exp_f32 v86,v86
v_mfma_f32_16x16x32_bf16 a[196:199],a[124:127],v[56:59],a[196:199]
buffer_load_dwordx4 v6,s[8:11],s21 offen offset:0 lds
v_mfma_f32_16x16x32_bf16 a[192:195],a[120:123],v[56:59],a[192:195]
v_exp_f32 v87,v87
v_mfma_f32_16x16x32_bf16 a[240:243],a[120:123],v[40:43],a[240:243]
ds_read_b128 a[120:123],v0 offset:12544
v_cvt_pk_bf16_f32 v27,v86,v87
v_mfma_f32_16x16x32_bf16 a[244:247],a[124:127],v[40:43],a[244:247]
ds_read_b128 a[124:127],v1 offset:12544
v_fma_f32 v100,v100,s36,v16
v_smfmac_f32_16x16x64_bf16 v[60:63],a[152:155],v[20:27],v18
v_fma_f32 v101,v101,s36,v16
v_mfma_f32_16x16x32_bf16 a[248:251],a[128:131],v[40:43],a[248:251]
v_exp_f32 v92,v92
v_mfma_f32_16x16x32_bf16 a[252:255],a[132:135],v[40:43],a[252:255]
v_exp_f32 v93,v93
v_mfma_f32_16x16x32_bf16 a[204:207],a[132:135],v[56:59],a[204:207]
v_exp_f32 v94,v94
v_mfma_f32_16x16x32_bf16 a[200:203],a[128:131],v[56:59],a[200:203]
v_exp_f32 v95,v95
v_mfma_f32_16x16x32_bf16 v[152:155],a[128:131],v[52:55],v[152:155]
v_cvt_pk_bf16_f32 v30,v92,v93
v_cvt_pk_bf16_f32 v31,v94,v95
v_mfma_f32_16x16x32_bf16 v[156:159],a[132:135],v[52:55],v[156:159]
v_fma_f32 v102,v102,s36,v16
v_fma_f32 v103,v103,s36,v16
v_mfma_f32_16x16x32_bf16 v[252:255],a[132:135],v[48:51],v[252:255]
v_exp_f32 v100,v100
v_mfma_f32_16x16x32_bf16 v[248:251],a[128:131],v[48:51],v[248:251]
buffer_load_dwordx4 v7,s[8:11],s21 offen offset:1024 lds
v_mfma_f32_16x16x32_bf16 v[200:203],a[128:131],v[44:47],v[200:203]
ds_read_b128 a[128:131],v0 offset:18432
v_fma_f32 v108,v108,s36,v17
v_mfma_f32_16x16x32_bf16 v[204:207],a[132:135],v[44:47],v[204:207]
s_waitcnt lgkmcnt(1)
ds_read_b128 a[132:135],v1 offset:18432
v_fma_f32 v109,v109,s36,v17
v_mfma_f32_16x16x32_bf16 v[72:75],a[136:139],a[0:3],0
v_exp_f32 v101,v101
v_mfma_f32_16x16x32_bf16 v[72:75],a[140:143],a[4:7],v[72:75]
v_exp_f32 v102,v102
v_mfma_f32_16x16x32_bf16 v[72:75],a[144:147],a[8:11],v[72:75]
v_exp_f32 v103,v103
v_mfma_f32_16x16x32_bf16 v[72:75],a[148:151],a[12:15],v[72:75]
v_cvt_pk_bf16_f32 v34,v100,v101
v_cvt_pk_bf16_f32 v35,v102,v103
v_mfma_f32_16x16x32_bf16 v[72:75],a[120:123],a[16:19],v[72:75]
v_fma_f32 v110,v110,s36,v17
v_fma_f32 v111,v111,s36,v17
v_smfmac_f32_16x16x64_bf16 v[64:67],a[152:155],v[28:35],v18
v_mfma_f32_16x16x32_bf16 v[72:75],a[124:127],a[20:23],v[72:75]
v_exp_f32 v108,v108
v_mfma_f32_16x16x32_bf16 v[80:83],a[124:127],a[44:47],0
v_exp_f32 v109,v109
v_mfma_f32_16x16x32_bf16 v[80:83],a[120:123],a[40:43],v[80:83]
buffer_load_dwordx4 v8,s[8:11],s21 offen offset:2048 lds
v_mfma_f32_16x16x32_bf16 v[80:83],a[148:151],a[36:39],v[80:83]
s_add_u32 s21,s21,12288
v_exp_f32 v110,v110
v_mfma_f32_16x16x32_bf16 v[80:83],a[144:147],a[32:35],v[80:83]
s_add_u32 m0,s22,0
v_exp_f32 v111,v111
v_mfma_f32_16x16x32_bf16 v[80:83],a[140:143],a[28:31],v[80:83]
v_cvt_pk_bf16_f32 v38,v108,v109
v_cvt_pk_bf16_f32 v39,v110,v111
v_mfma_f32_16x16x32_bf16 v[80:83],a[136:139],a[24:27],v[80:83]
v_fma_f32 v72,v72,s36,v13
v_fma_f32 v73,v73,s36,v13
v_mfma_f32_16x16x32_bf16 v[88:91],a[136:139],a[48:51],0
v_fma_f32 v74,v74,s36,v13
v_fma_f32 v75,v75,s36,v13
v_mfma_f32_16x16x32_bf16 v[88:91],a[140:143],a[52:55],v[88:91]
v_exp_f32 v72,v72
v_mfma_f32_16x16x32_bf16 v[88:91],a[144:147],a[56:59],v[88:91]
v_fma_f32 v80,v80,s36,v14
v_fma_f32 v81,v81,s36,v14
v_mfma_f32_16x16x32_bf16 v[88:91],a[148:151],a[60:63],v[88:91]
v_fma_f32 v82,v82,s36,v14
v_fma_f32 v83,v83,s36,v14
v_mfma_f32_16x16x32_bf16 v[88:91],a[120:123],a[64:67],v[88:91]
v_exp_f32 v73,v73
v_mfma_f32_16x16x32_bf16 v[88:91],a[124:127],a[68:71],v[88:91]
v_exp_f32 v74,v74
v_mfma_f32_16x16x32_bf16 v[96:99],a[124:127],a[92:95],0
v_exp_f32 v75,v75
v_mfma_f32_16x16x32_bf16 v[96:99],a[120:123],a[88:91],v[96:99]
buffer_load_dwordx4 v6,s[4:7],s20 offen offset:0 lds
v_mfma_f32_16x16x32_bf16 v[96:99],a[148:151],a[84:87],v[96:99]
v_exp_f32 v80,v80
v_mfma_f32_16x16x32_bf16 v[96:99],a[144:147],a[80:83],v[96:99]
v_fma_f32 v88,v88,s36,v15
v_fma_f32 v89,v89,s36,v15
v_mfma_f32_16x16x32_bf16 v[96:99],a[140:143],a[76:79],v[96:99]
v_exp_f32 v81,v81
v_mfma_f32_16x16x32_bf16 v[96:99],a[136:139],a[72:75],v[96:99]
v_exp_f32 v82,v82
v_mfma_f32_16x16x32_bf16 v[104:107],a[136:139],a[96:99],0
ds_read_b128 a[136:139],v0 offset:18560
v_cvt_pk_bf16_f32 v44,v72,v73
v_mfma_f32_16x16x32_bf16 v[104:107],a[140:143],a[100:103],v[104:107]
ds_read_b128 a[140:143],v1 offset:18560
v_cvt_pk_bf16_f32 v45,v74,v75
v_mfma_f32_16x16x32_bf16 v[104:107],a[144:147],a[104:107],v[104:107]
ds_read_b128 a[144:147],v0 offset:18688
v_cvt_pk_bf16_f32 v48,v80,v81
v_mfma_f32_16x16x32_bf16 v[104:107],a[148:151],a[108:111],v[104:107]
ds_read_b128 a[148:151],v1 offset:18688
v_mfma_f32_16x16x32_bf16 v[104:107],a[120:123],a[112:115],v[104:107]
v_exp_f32 v83,v83
v_mfma_f32_16x16x32_bf16 v[104:107],a[124:127],a[116:119],v[104:107]
s_waitcnt lgkmcnt(4)
v_exp_f32 v88,v88
v_mfma_f32_16x16x32_bf16 v[76:79],a[128:131],a[0:3],0
v_exp_f32 v89,v89
v_mfma_f32_16x16x32_bf16 v[76:79],a[132:135],a[4:7],v[76:79]
buffer_load_dwordx4 v7,s[4:7],s20 offen offset:1024 lds
s_waitcnt lgkmcnt(3)
v_mfma_f32_16x16x32_bf16 v[76:79],a[136:139],a[8:11],v[76:79]
s_waitcnt lgkmcnt(2)
v_cvt_pk_bf16_f32 v49,v82,v83
v_cvt_pk_bf16_f32 v52,v88,v89
v_mfma_f32_16x16x32_bf16 v[76:79],a[140:143],a[12:15],v[76:79]
s_waitcnt lgkmcnt(0)
v_mfma_f32_16x16x32_bf16 v[76:79],a[144:147],a[16:19],v[76:79]
v_mfma_f32_16x16x32_bf16 v[76:79],a[148:151],a[20:23],v[76:79]
v_mfma_f32_16x16x32_bf16 v[84:87],a[148:151],a[44:47],0
v_mfma_f32_16x16x32_bf16 v[84:87],a[144:147],a[40:43],v[84:87]
v_mfma_f32_16x16x32_bf16 v[84:87],a[140:143],a[36:39],v[84:87]
v_mfma_f32_16x16x32_bf16 v[84:87],a[136:139],a[32:35],v[84:87]
v_mfma_f32_16x16x32_bf16 v[84:87],a[132:135],a[28:31],v[84:87]
v_mfma_f32_16x16x32_bf16 v[84:87],a[128:131],a[24:27],v[84:87]
v_mfma_f32_16x16x32_bf16 v[92:95],a[128:131],a[48:51],0
buffer_load_dwordx4 v8,s[4:7],s20 offen offset:2048 lds
v_mfma_f32_16x16x32_bf16 v[92:95],a[132:135],a[52:55],v[92:95]
s_add_u32 s20,s20,12288
v_mfma_f32_16x16x32_bf16 v[92:95],a[136:139],a[56:59],v[92:95]
v_mfma_f32_16x16x32_bf16 v[92:95],a[140:143],a[60:63],v[92:95]
v_mfma_f32_16x16x32_bf16 v[92:95],a[144:147],a[64:67],v[92:95]
v_mfma_f32_16x16x32_bf16 v[92:95],a[148:151],a[68:71],v[92:95]
v_mfma_f32_16x16x32_bf16 v[100:103],a[148:151],a[92:95],0
ds_read_b64_tr_b16 a[120:121],v2 offset:0
v_mfma_f32_16x16x32_bf16 v[100:103],a[144:147],a[88:91],v[100:103]
ds_read_b64_tr_b16 a[122:123],v2 offset:6144
v_mfma_f32_16x16x32_bf16 v[100:103],a[140:143],a[84:87],v[100:103]
v_mfma_f32_16x16x32_bf16 v[100:103],a[136:139],a[80:83],v[100:103]
ds_read_b64_tr_b16 a[124:125],v3 offset:0
v_mfma_f32_16x16x32_bf16 v[100:103],a[132:135],a[76:79],v[100:103]
ds_read_b64_tr_b16 a[126:127],v3 offset:6144
v_mfma_f32_16x16x32_bf16 v[100:103],a[128:131],a[72:75],v[100:103]
v_mfma_f32_16x16x32_bf16 v[108:111],a[128:131],a[96:99],0
ds_read_b64_tr_b16 a[128:129],v4 offset:0
v_mfma_f32_16x16x32_bf16 v[108:111],a[132:135],a[100:103],v[108:111]
ds_read_b64_tr_b16 a[130:131],v4 offset:6144
v_mfma_f32_16x16x32_bf16 v[108:111],a[136:139],a[104:107],v[108:111]
ds_read_b64_tr_b16 a[132:133],v5 offset:0
v_mfma_f32_16x16x32_bf16 v[108:111],a[140:143],a[108:111],v[108:111]
ds_read_b64_tr_b16 a[134:135],v5 offset:6144
v_mfma_f32_16x16x32_bf16 v[108:111],a[144:147],a[112:115],v[108:111]
v_mfma_f32_16x16x32_bf16 v[108:111],a[148:151],a[116:119],v[108:111]
s_waitcnt lgkmcnt(4)
v_mfma_f32_16x16x32_bf16 v[160:163],a[120:123],v[20:23],v[160:163]
ds_read_b128 a[156:159],v10 offset:6144
v_fma_f32 v90,v90,s36,v15
v_mfma_f32_16x16x32_bf16 v[164:167],a[124:127],v[20:23],v[164:167]
ds_read_b64_tr_b16 a[136:137],v2 offset:128
v_fma_f32 v91,v91,s36,v15
v_mfma_f32_16x16x32_bf16 v[212:215],a[124:127],v[24:27],v[212:215]
ds_read_b64_tr_b16 a[138:139],v2 offset:6272
v_fma_f32 v96,v96,s36,v16
v_mfma_f32_16x16x32_bf16 v[208:211],a[120:123],v[24:27],v[208:211]
ds_read_b64_tr_b16 a[140:141],v3 offset:128
v_fma_f32 v97,v97,s36,v16
v_mfma_f32_16x16x32_bf16 v[112:115],a[120:123],v[28:31],v[112:115]
ds_read_b64_tr_b16 a[142:143],v3 offset:6272
v_fma_f32 v98,v98,s36,v16
v_mfma_f32_16x16x32_bf16 v[116:119],a[124:127],v[28:31],v[116:119]
ds_read_b64_tr_b16 a[144:145],v4 offset:128
v_fma_f32 v99,v99,s36,v16
v_mfma_f32_16x16x32_bf16 a[164:167],a[124:127],v[32:35],a[164:167]
ds_read_b64_tr_b16 a[146:147],v4 offset:6272
v_fma_f32 v104,v104,s36,v17
v_mfma_f32_16x16x32_bf16 a[160:163],a[120:123],v[32:35],a[160:163]
ds_read_b64_tr_b16 a[148:149],v5 offset:128
v_fma_f32 v105,v105,s36,v17
v_mfma_f32_16x16x32_bf16 a[208:211],a[120:123],v[36:39],a[208:211]
ds_read_b64_tr_b16 a[150:151],v5 offset:6272
v_fma_f32 v106,v106,s36,v17
v_mfma_f32_16x16x32_bf16 a[212:215],a[124:127],v[36:39],a[212:215]
s_waitcnt lgkmcnt(6)
ds_read_b64_tr_b16 a[120:121],v2 offset:256
v_fma_f32 v107,v107,s36,v17
v_mfma_f32_16x16x32_bf16 a[216:219],a[128:131],v[36:39],a[216:219]
ds_read_b64_tr_b16 a[122:123],v2 offset:6400
v_fma_f32 v76,v76,s36,v13
v_mfma_f32_16x16x32_bf16 a[220:223],a[132:135],v[36:39],a[220:223]
ds_read_b64_tr_b16 a[124:125],v3 offset:256
v_fma_f32 v77,v77,s36,v13
v_mfma_f32_16x16x32_bf16 a[172:175],a[132:135],v[32:35],a[172:175]
ds_read_b64_tr_b16 a[126:127],v3 offset:6400
v_fma_f32 v78,v78,s36,v13
v_mfma_f32_16x16x32_bf16 a[168:171],a[128:131],v[32:35],a[168:171]
v_exp_f32 v90,v90
v_mfma_f32_16x16x32_bf16 v[120:123],a[128:131],v[28:31],v[120:123]
v_exp_f32 v91,v91
v_mfma_f32_16x16x32_bf16 v[124:127],a[132:135],v[28:31],v[124:127]
v_cvt_pk_bf16_f32 v53,v90,v91
v_fma_f32 v79,v79,s36,v13
v_mfma_f32_16x16x32_bf16 v[220:223],a[132:135],v[24:27],v[220:223]
v_exp_f32 v96,v96
v_mfma_f32_16x16x32_bf16 v[216:219],a[128:131],v[24:27],v[216:219]
buffer_store_dwordx4 a[156:159],v9,s[16:19],s27 offen offset:0 nt
v_exp_f32 v97,v97
v_fma_f32 v84,v84,s36,v14
v_mfma_f32_16x16x32_bf16 v[168:171],a[128:131],v[20:23],v[168:171]
ds_read_b128 a[156:159],v10 offset:7168
v_cvt_pk_bf16_f32 v56,v96,v97
v_mfma_f32_16x16x32_bf16 v[172:175],a[132:135],v[20:23],v[172:175]
ds_read_b64_tr_b16 a[128:129],v4 offset:256
v_fma_f32 v85,v85,s36,v14
v_mfma_f32_16x16x32_bf16 v[176:179],a[136:139],v[20:23],v[176:179]
s_waitcnt lgkmcnt(2)
ds_read_b64_tr_b16 a[130:131],v4 offset:6400
v_fma_f32 v86,v86,s36,v14
v_mfma_f32_16x16x32_bf16 v[180:183],a[140:143],v[20:23],v[180:183]
ds_read_b64_tr_b16 a[132:133],v5 offset:256
v_fma_f32 v87,v87,s36,v14
v_mfma_f32_16x16x32_bf16 v[228:231],a[140:143],v[24:27],v[228:231]
ds_read_b64_tr_b16 a[134:135],v5 offset:6400
v_fma_f32 v92,v92,s36,v15
v_mfma_f32_16x16x32_bf16 v[224:227],a[136:139],v[24:27],v[224:227]
v_exp_f32 v98,v98
v_mfma_f32_16x16x32_bf16 v[128:131],a[136:139],v[28:31],v[128:131]
v_exp_f32 v99,v99
v_mfma_f32_16x16x32_bf16 v[132:135],a[140:143],v[28:31],v[132:135]
v_cvt_pk_bf16_f32 v57,v98,v99
v_fma_f32 v93,v93,s36,v15
v_mfma_f32_16x16x32_bf16 a[180:183],a[140:143],v[32:35],a[180:183]
s_waitcnt lgkmcnt(4)
buffer_store_dwordx4 a[156:159],v9,s[16:19],s27 offen offset:128 nt
v_exp_f32 v104,v104
v_fma_f32 v94,v94,s36,v15
v_mfma_f32_16x16x32_bf16 a[176:179],a[136:139],v[32:35],a[176:179]
ds_read_b128 a[156:159],v10 offset:8192
v_fma_f32 v95,v95,s36,v15
v_mfma_f32_16x16x32_bf16 a[224:227],a[136:139],v[36:39],a[224:227]
v_exp_f32 v105,v105
v_mfma_f32_16x16x32_bf16 a[228:231],a[140:143],v[36:39],a[228:231]
v_exp_f32 v106,v106
v_mfma_f32_16x16x32_bf16 a[232:235],a[144:147],v[36:39],a[232:235]
v_exp_f32 v107,v107
v_mfma_f32_16x16x32_bf16 a[236:239],a[148:151],v[36:39],a[236:239]
v_cvt_pk_bf16_f32 v40,v104,v105
v_cvt_pk_bf16_f32 v41,v106,v107
v_mfma_f32_16x16x32_bf16 a[188:191],a[148:151],v[32:35],a[188:191]
v_exp_f32 v76,v76
v_mfma_f32_16x16x32_bf16 a[184:187],a[144:147],v[32:35],a[184:187]
v_exp_f32 v77,v77
v_mfma_f32_16x16x32_bf16 v[136:139],a[144:147],v[28:31],v[136:139]
v_exp_f32 v78,v78
v_mfma_f32_16x16x32_bf16 v[140:143],a[148:151],v[28:31],v[140:143]
s_waitcnt lgkmcnt(0)
buffer_store_dwordx4 a[156:159],v9,s[16:19],s27 offen offset:256 nt
v_exp_f32 v79,v79
v_cvt_pk_bf16_f32 v46,v76,v77
v_mfma_f32_16x16x32_bf16 v[236:239],a[148:151],v[24:27],v[236:239]
s_add_u32 s27,s27,3072
v_cvt_pk_bf16_f32 v47,v78,v79
v_fma_f32 v100,v100,s36,v16
v_mfma_f32_16x16x32_bf16 v[232:235],a[144:147],v[24:27],v[232:235]
s_waitcnt vmcnt(12)
v_exp_f32 v84,v84
v_mfma_f32_16x16x32_bf16 v[184:187],a[144:147],v[20:23],v[184:187]
s_barrier
v_mfma_f32_16x16x32_bf16 v[188:191],a[148:151],v[20:23],v[188:191]
s_add_u32 m0,s23,0
ds_read_b128 a[136:139],v0 offset:24576
v_fma_f32 v101,v101,s36,v16
v_mfma_f32_16x16x32_bf16 v[192:195],a[120:123],v[20:23],v[192:195]
ds_read_b128 a[140:143],v1 offset:24576
v_fma_f32 v102,v102,s36,v16
v_mfma_f32_16x16x32_bf16 v[196:199],a[124:127],v[20:23],v[196:199]
ds_read_b128 a[144:147],v0 offset:24704
v_fma_f32 v103,v103,s36,v16
v_mfma_f32_16x16x32_bf16 v[244:247],a[124:127],v[24:27],v[244:247]
ds_read_b128 a[148:151],v1 offset:24704
v_fma_f32 v108,v108,s36,v17
v_mfma_f32_16x16x32_bf16 v[240:243],a[120:123],v[24:27],v[240:243]
v_exp_f32 v85,v85
v_mfma_f32_16x16x32_bf16 v[144:147],a[120:123],v[28:31],v[144:147]
buffer_load_dwordx4 v6,s[8:11],s21 offen offset:0 lds
v_mfma_f32_16x16x32_bf16 v[148:151],a[124:127],v[28:31],v[148:151]
v_exp_f32 v86,v86
v_mfma_f32_16x16x32_bf16 a[196:199],a[124:127],v[32:35],a[196:199]
v_exp_f32 v87,v87
v_mfma_f32_16x16x32_bf16 a[192:195],a[120:123],v[32:35],a[192:195]
v_cvt_pk_bf16_f32 v50,v84,v85
v_cvt_pk_bf16_f32 v51,v86,v87
v_mfma_f32_16x16x32_bf16 a[240:243],a[120:123],v[36:39],a[240:243]
ds_read_b128 a[120:123],v0 offset:24832
v_fma_f32 v109,v109,s36,v17
v_smfmac_f32_16x16x64_bf16 v[60:63],a[152:155],v[44:51],v18
v_fma_f32 v110,v110,s36,v17
v_mfma_f32_16x16x32_bf16 a[244:247],a[124:127],v[36:39],a[244:247]
ds_read_b128 a[124:127],v1 offset:24832
v_fma_f32 v111,v111,s36,v17
v_mfma_f32_16x16x32_bf16 a[248:251],a[128:131],v[36:39],a[248:251]
v_exp_f32 v92,v92
v_mfma_f32_16x16x32_bf16 a[252:255],a[132:135],v[36:39],a[252:255]
v_exp_f32 v93,v93
v_mfma_f32_16x16x32_bf16 a[204:207],a[132:135],v[32:35],a[204:207]
v_exp_f32 v94,v94
v_mfma_f32_16x16x32_bf16 a[200:203],a[128:131],v[32:35],a[200:203]
v_exp_f32 v95,v95
v_mfma_f32_16x16x32_bf16 v[152:155],a[128:131],v[28:31],v[152:155]
v_cvt_pk_bf16_f32 v54,v92,v93
v_cvt_pk_bf16_f32 v55,v94,v95
v_mfma_f32_16x16x32_bf16 v[156:159],a[132:135],v[28:31],v[156:159]
buffer_load_dwordx4 v7,s[8:11],s21 offen offset:1024 lds
v_mfma_f32_16x16x32_bf16 v[252:255],a[132:135],v[24:27],v[252:255]
v_exp_f32 v100,v100
v_mfma_f32_16x16x32_bf16 v[248:251],a[128:131],v[24:27],v[248:251]
v_exp_f32 v101,v101
v_mfma_f32_16x16x32_bf16 v[200:203],a[128:131],v[20:23],v[200:203]
ds_read_b128 a[128:131],v0 offset:30720
v_cvt_pk_bf16_f32 v58,v100,v101
v_mfma_f32_16x16x32_bf16 v[204:207],a[132:135],v[20:23],v[204:207]
s_waitcnt lgkmcnt(1)
ds_read_b128 a[132:135],v1 offset:30720
v_mfma_f32_16x16x32_bf16 v[72:75],a[136:139],a[0:3],0
v_exp_f32 v102,v102
v_mfma_f32_16x16x32_bf16 v[72:75],a[140:143],a[4:7],v[72:75]
v_exp_f32 v103,v103
v_mfma_f32_16x16x32_bf16 v[72:75],a[144:147],a[8:11],v[72:75]
v_cvt_pk_bf16_f32 v59,v102,v103
v_mfma_f32_16x16x32_bf16 v[72:75],a[148:151],a[12:15],v[72:75]
v_exp_f32 v108,v108
v_smfmac_f32_16x16x64_bf16 v[64:67],a[152:155],v[52:59],v18
v_mfma_f32_16x16x32_bf16 v[72:75],a[120:123],a[16:19],v[72:75]
v_exp_f32 v109,v109
v_mfma_f32_16x16x32_bf16 v[72:75],a[124:127],a[20:23],v[72:75]
buffer_load_dwordx4 v8,s[8:11],s21 offen offset:2048 lds
v_mfma_f32_16x16x32_bf16 v[80:83],a[124:127],a[44:47],0
s_add_u32 s21,s21,12288
v_exp_f32 v110,v110
v_mfma_f32_16x16x32_bf16 v[80:83],a[120:123],a[40:43],v[80:83]
s_cmp_eq_u32 s38,1
v_exp_f32 v111,v111
v_mfma_f32_16x16x32_bf16 v[80:83],a[148:151],a[36:39],v[80:83]
s_cselect_b32 s20,s26,s20
v_cvt_pk_bf16_f32 v42,v108,v109
v_cvt_pk_bf16_f32 v43,v110,v111
v_mfma_f32_16x16x32_bf16 v[80:83],a[144:147],a[32:35],v[80:83]
s_add_u32 m0,s22,12288
v_fma_f32 v72,v72,s36,v13
v_fma_f32 v73,v73,s36,v13
v_smfmac_f32_16x16x64_bf16 v[68:71],a[152:155],v[36:43],v18
v_fma_f32 v74,v74,s36,v13
v_mfma_f32_16x16x32_bf16 v[80:83],a[140:143],a[28:31],v[80:83]
v_fma_f32 v75,v75,s36,v13
v_mfma_f32_16x16x32_bf16 v[80:83],a[136:139],a[24:27],v[80:83]
v_exp_f32 v72,v72
v_mfma_f32_16x16x32_bf16 v[88:91],a[136:139],a[48:51],0
v_exp_f32 v73,v73
v_mfma_f32_16x16x32_bf16 v[88:91],a[140:143],a[52:55],v[88:91]
v_exp_f32 v74,v74
v_mfma_f32_16x16x32_bf16 v[88:91],a[144:147],a[56:59],v[88:91]
v_exp_f32 v75,v75
v_mfma_f32_16x16x32_bf16 v[88:91],a[148:151],a[60:63],v[88:91]
v_fma_f32 v80,v80,s36,v14
v_fma_f32 v81,v81,s36,v14
v_mfma_f32_16x16x32_bf16 v[88:91],a[120:123],a[64:67],v[88:91]
buffer_load_dwordx4 v6,s[4:7],s20 offen offset:0 lds
v_mfma_f32_16x16x32_bf16 v[88:91],a[124:127],a[68:71],v[88:91]
v_fma_f32 v82,v82,s36,v14
v_fma_f32 v83,v83,s36,v14
v_mfma_f32_16x16x32_bf16 v[96:99],a[124:127],a[92:95],0
v_exp_f32 v80,v80
v_mfma_f32_16x16x32_bf16 v[96:99],a[120:123],a[88:91],v[96:99]
v_exp_f32 v81,v81
v_mfma_f32_16x16x32_bf16 v[96:99],a[148:151],a[84:87],v[96:99]
v_exp_f32 v82,v82
v_mfma_f32_16x16x32_bf16 v[96:99],a[144:147],a[80:83],v[96:99]
v_fma_f32 v88,v88,s36,v15
v_fma_f32 v89,v89,s36,v15
v_mfma_f32_16x16x32_bf16 v[96:99],a[140:143],a[76:79],v[96:99]
v_exp_f32 v83,v83
v_mfma_f32_16x16x32_bf16 v[96:99],a[136:139],a[72:75],v[96:99]
v_exp_f32 v88,v88
v_mfma_f32_16x16x32_bf16 v[104:107],a[136:139],a[96:99],0
ds_read_b128 a[136:139],v0 offset:30848
v_cvt_pk_bf16_f32 v20,v72,v73
v_mfma_f32_16x16x32_bf16 v[104:107],a[140:143],a[100:103],v[104:107]
ds_read_b128 a[140:143],v1 offset:30848
v_cvt_pk_bf16_f32 v21,v74,v75
v_mfma_f32_16x16x32_bf16 v[104:107],a[144:147],a[104:107],v[104:107]
ds_read_b128 a[144:147],v0 offset:30976
v_cvt_pk_bf16_f32 v24,v80,v81
v_mfma_f32_16x16x32_bf16 v[104:107],a[148:151],a[108:111],v[104:107]
ds_read_b128 a[148:151],v1 offset:30976
v_cvt_pk_bf16_f32 v25,v82,v83
v_mfma_f32_16x16x32_bf16 v[104:107],a[120:123],a[112:115],v[104:107]
buffer_load_dwordx4 v7,s[4:7],s20 offen offset:1024 lds
v_mfma_f32_16x16x32_bf16 v[104:107],a[124:127],a[116:119],v[104:107]
s_waitcnt lgkmcnt(4)
v_exp_f32 v89,v89
v_mfma_f32_16x16x32_bf16 v[76:79],a[128:131],a[0:3],0
v_cvt_pk_bf16_f32 v28,v88,v89
v_mfma_f32_16x16x32_bf16 v[76:79],a[132:135],a[4:7],v[76:79]
s_waitcnt lgkmcnt(3)
v_mfma_f32_16x16x32_bf16 v[76:79],a[136:139],a[8:11],v[76:79]
s_waitcnt lgkmcnt(2)
v_mfma_f32_16x16x32_bf16 v[76:79],a[140:143],a[12:15],v[76:79]
s_waitcnt lgkmcnt(1)
v_mfma_f32_16x16x32_bf16 v[76:79],a[144:147],a[16:19],v[76:79]
s_waitcnt lgkmcnt(0)
v_mfma_f32_16x16x32_bf16 v[76:79],a[148:151],a[20:23],v[76:79]
v_mfma_f32_16x16x32_bf16 v[84:87],a[148:151],a[44:47],0
v_mfma_f32_16x16x32_bf16 v[84:87],a[144:147],a[40:43],v[84:87]
v_mfma_f32_16x16x32_bf16 v[84:87],a[140:143],a[36:39],v[84:87]
v_mfma_f32_16x16x32_bf16 v[84:87],a[136:139],a[32:35],v[84:87]
buffer_load_dwordx4 v8,s[4:7],s20 offen offset:2048 lds
v_mfma_f32_16x16x32_bf16 v[84:87],a[132:135],a[28:31],v[84:87]
s_add_u32 s20,s20,12288
v_mfma_f32_16x16x32_bf16 v[84:87],a[128:131],a[24:27],v[84:87]
v_mfma_f32_16x16x32_bf16 v[92:95],a[128:131],a[48:51],0
v_mfma_f32_16x16x32_bf16 v[92:95],a[132:135],a[52:55],v[92:95]
v_mfma_f32_16x16x32_bf16 v[92:95],a[136:139],a[56:59],v[92:95]
v_mfma_f32_16x16x32_bf16 v[92:95],a[140:143],a[60:63],v[92:95]
ds_read_b64_tr_b16 a[120:121],v2 offset:12288
v_mfma_f32_16x16x32_bf16 v[92:95],a[144:147],a[64:67],v[92:95]
ds_read_b64_tr_b16 a[122:123],v2 offset:18432
v_mfma_f32_16x16x32_bf16 v[92:95],a[148:151],a[68:71],v[92:95]
v_mfma_f32_16x16x32_bf16 v[100:103],a[148:151],a[92:95],0
ds_read_b64_tr_b16 a[124:125],v3 offset:12288
v_mfma_f32_16x16x32_bf16 v[100:103],a[144:147],a[88:91],v[100:103]
ds_read_b64_tr_b16 a[126:127],v3 offset:18432
v_mfma_f32_16x16x32_bf16 v[100:103],a[140:143],a[84:87],v[100:103]
v_mfma_f32_16x16x32_bf16 v[100:103],a[136:139],a[80:83],v[100:103]
v_mfma_f32_16x16x32_bf16 v[100:103],a[132:135],a[76:79],v[100:103]
v_mfma_f32_16x16x32_bf16 v[100:103],a[128:131],a[72:75],v[100:103]
v_mfma_f32_16x16x32_bf16 v[108:111],a[128:131],a[96:99],0
ds_read_b64_tr_b16 a[128:129],v4 offset:12288
v_mfma_f32_16x16x32_bf16 v[108:111],a[132:135],a[100:103],v[108:111]
ds_read_b64_tr_b16 a[130:131],v4 offset:18432
v_mfma_f32_16x16x32_bf16 v[108:111],a[136:139],a[104:107],v[108:111]
ds_read_b64_tr_b16 a[132:133],v5 offset:12288
v_mfma_f32_16x16x32_bf16 v[108:111],a[140:143],a[108:111],v[108:111]
ds_read_b64_tr_b16 a[134:135],v5 offset:18432
v_mfma_f32_16x16x32_bf16 v[108:111],a[144:147],a[112:115],v[108:111]
v_mfma_f32_16x16x32_bf16 v[108:111],a[148:151],a[116:119],v[108:111]
s_waitcnt lgkmcnt(4)
v_mfma_f32_16x16x32_bf16 v[160:163],a[120:123],v[44:47],v[160:163]
s_add_u32 m0,s29,0
ds_read_b64_tr_b16 a[136:137],v2 offset:12416
v_fma_f32 v90,v90,s36,v15
v_mfma_f32_16x16x32_bf16 v[164:167],a[124:127],v[44:47],v[164:167]
ds_read_b64_tr_b16 a[138:139],v2 offset:18560
v_fma_f32 v91,v91,s36,v15
v_mfma_f32_16x16x32_bf16 v[212:215],a[124:127],v[48:51],v[212:215]
ds_read_b64_tr_b16 a[140:141],v3 offset:12416
v_fma_f32 v96,v96,s36,v16
v_mfma_f32_16x16x32_bf16 v[208:211],a[120:123],v[48:51],v[208:211]
ds_read_b64_tr_b16 a[142:143],v3 offset:18560
v_fma_f32 v97,v97,s36,v16
v_mfma_f32_16x16x32_bf16 v[112:115],a[120:123],v[52:55],v[112:115]
ds_read_b64_tr_b16 a[144:145],v4 offset:12416
v_fma_f32 v98,v98,s36,v16
v_mfma_f32_16x16x32_bf16 v[116:119],a[124:127],v[52:55],v[116:119]
ds_read_b64_tr_b16 a[146:147],v4 offset:18560
v_fma_f32 v99,v99,s36,v16
v_mfma_f32_16x16x32_bf16 a[164:167],a[124:127],v[56:59],a[164:167]
ds_read_b64_tr_b16 a[148:149],v5 offset:12416
v_fma_f32 v104,v104,s36,v17
v_mfma_f32_16x16x32_bf16 a[160:163],a[120:123],v[56:59],a[160:163]
buffer_load_dwordx4 v6,s[12:15],s28 offen offset:0 nt lds
v_mfma_f32_16x16x32_bf16 a[208:211],a[120:123],v[40:43],a[208:211]
ds_read_b64_tr_b16 a[150:151],v5 offset:18560
v_fma_f32 v105,v105,s36,v17
v_mfma_f32_16x16x32_bf16 a[212:215],a[124:127],v[40:43],a[212:215]
s_waitcnt lgkmcnt(5)
ds_read_b64_tr_b16 a[120:121],v2 offset:12544
v_fma_f32 v106,v106,s36,v17
v_mfma_f32_16x16x32_bf16 a[216:219],a[128:131],v[40:43],a[216:219]
ds_read_b64_tr_b16 a[122:123],v2 offset:18688
v_fma_f32 v107,v107,s36,v17
v_mfma_f32_16x16x32_bf16 a[220:223],a[132:135],v[40:43],a[220:223]
ds_read_b64_tr_b16 a[124:125],v3 offset:12544
v_fma_f32 v76,v76,s36,v13
v_mfma_f32_16x16x32_bf16 a[172:175],a[132:135],v[56:59],a[172:175]
ds_read_b64_tr_b16 a[126:127],v3 offset:18688
v_fma_f32 v77,v77,s36,v13
v_mfma_f32_16x16x32_bf16 a[168:171],a[128:131],v[56:59],a[168:171]
v_exp_f32 v90,v90
v_mfma_f32_16x16x32_bf16 v[120:123],a[128:131],v[52:55],v[120:123]
v_exp_f32 v91,v91
v_mfma_f32_16x16x32_bf16 v[124:127],a[132:135],v[52:55],v[124:127]
v_cvt_pk_bf16_f32 v29,v90,v91
v_fma_f32 v78,v78,s36,v13
v_mfma_f32_16x16x32_bf16 v[220:223],a[132:135],v[48:51],v[220:223]
v_exp_f32 v96,v96
v_mfma_f32_16x16x32_bf16 v[216:219],a[128:131],v[48:51],v[216:219]
buffer_load_dwordx4 v7,s[12:15],s28 offen offset:1024 nt lds
v_mfma_f32_16x16x32_bf16 v[168:171],a[128:131],v[44:47],v[168:171]
ds_read_b64_tr_b16 a[128:129],v4 offset:12544
v_fma_f32 v79,v79,s36,v13
v_mfma_f32_16x16x32_bf16 v[172:175],a[132:135],v[44:47],v[172:175]
ds_read_b64_tr_b16 a[130:131],v4 offset:18688
v_fma_f32 v84,v84,s36,v14
v_mfma_f32_16x16x32_bf16 v[176:179],a[136:139],v[44:47],v[176:179]
s_waitcnt lgkmcnt(2)
ds_read_b64_tr_b16 a[132:133],v5 offset:12544
v_fma_f32 v85,v85,s36,v14
v_mfma_f32_16x16x32_bf16 v[180:183],a[140:143],v[44:47],v[180:183]
ds_read_b64_tr_b16 a[134:135],v5 offset:18688
v_fma_f32 v86,v86,s36,v14
v_mfma_f32_16x16x32_bf16 v[228:231],a[140:143],v[48:51],v[228:231]
v_exp_f32 v97,v97
v_mfma_f32_16x16x32_bf16 v[224:227],a[136:139],v[48:51],v[224:227]
v_exp_f32 v98,v98
v_mfma_f32_16x16x32_bf16 v[128:131],a[136:139],v[52:55],v[128:131]
v_exp_f32 v99,v99
v_mfma_f32_16x16x32_bf16 v[132:135],a[140:143],v[52:55],v[132:135]
v_cvt_pk_bf16_f32 v32,v96,v97
v_cvt_pk_bf16_f32 v33,v98,v99
v_mfma_f32_16x16x32_bf16 a[180:183],a[140:143],v[56:59],a[180:183]
v_exp_f32 v104,v104
v_mfma_f32_16x16x32_bf16 a[176:179],a[136:139],v[56:59],a[176:179]
buffer_load_dwordx4 v8,s[12:15],s28 offen offset:2048 nt lds
v_mfma_f32_16x16x32_bf16 a[224:227],a[136:139],v[40:43],a[224:227]
s_add_u32 s28,s28,3072
v_exp_f32 v105,v105
v_mfma_f32_16x16x32_bf16 a[228:231],a[140:143],v[40:43],a[228:231]
s_add_u32 s29,s29,3072
v_exp_f32 v106,v106
v_mfma_f32_16x16x32_bf16 a[232:235],a[144:147],v[40:43],a[232:235]
s_cmp_eq_u32 s38,1
v_exp_f32 v107,v107
v_mfma_f32_16x16x32_bf16 a[236:239],a[148:151],v[40:43],a[236:239]
s_cselect_b32 s21,s26,s21
v_cvt_pk_bf16_f32 v36,v104,v105
v_cvt_pk_bf16_f32 v37,v106,v107
v_mfma_f32_16x16x32_bf16 a[188:191],a[148:151],v[56:59],a[188:191]
s_add_u32 m0,s23,12288
v_exp_f32 v76,v76
v_mfma_f32_16x16x32_bf16 a[184:187],a[144:147],v[56:59],a[184:187]
v_exp_f32 v77,v77
v_mfma_f32_16x16x32_bf16 v[136:139],a[144:147],v[52:55],v[136:139]
v_exp_f32 v78,v78
v_mfma_f32_16x16x32_bf16 v[140:143],a[148:151],v[52:55],v[140:143]
v_exp_f32 v79,v79
v_mfma_f32_16x16x32_bf16 v[236:239],a[148:151],v[48:51],v[236:239]
v_cvt_pk_bf16_f32 v22,v76,v77
v_cvt_pk_bf16_f32 v23,v78,v79
v_mfma_f32_16x16x32_bf16 v[232:235],a[144:147],v[48:51],v[232:235]
v_fma_f32 v87,v87,s36,v14
v_fma_f32 v92,v92,s36,v15
v_mfma_f32_16x16x32_bf16 v[184:187],a[144:147],v[44:47],v[184:187]
v_exp_f32 v84,v84
v_mfma_f32_16x16x32_bf16 v[188:191],a[148:151],v[44:47],v[188:191]
s_waitcnt vmcnt(12) lgkmcnt(0)
v_exp_f32 v85,v85
v_mfma_f32_16x16x32_bf16 v[192:195],a[120:123],v[44:47],v[192:195]
s_barrier
v_mfma_f32_16x16x32_bf16 v[196:199],a[124:127],v[44:47],v[196:199]
ds_read_b128 a[136:139],v0 offset:0
v_cvt_pk_bf16_f32 v26,v84,v85
v_mfma_f32_16x16x32_bf16 v[244:247],a[124:127],v[48:51],v[244:247]
ds_read_b128 a[140:143],v1 offset:0
v_fma_f32 v93,v93,s36,v15
v_mfma_f32_16x16x32_bf16 v[240:243],a[120:123],v[48:51],v[240:243]
ds_read_b128 a[144:147],v0 offset:128
v_fma_f32 v94,v94,s36,v15
v_mfma_f32_16x16x32_bf16 v[144:147],a[120:123],v[52:55],v[144:147]
ds_read_b128 a[148:151],v1 offset:128
v_fma_f32 v95,v95,s36,v15
v_mfma_f32_16x16x32_bf16 v[148:151],a[124:127],v[52:55],v[148:151]
v_exp_f32 v86,v86
v_mfma_f32_16x16x32_bf16 a[196:199],a[124:127],v[56:59],a[196:199]
buffer_load_dwordx4 v6,s[8:11],s21 offen offset:0 lds
v_mfma_f32_16x16x32_bf16 a[192:195],a[120:123],v[56:59],a[192:195]
v_exp_f32 v87,v87
v_mfma_f32_16x16x32_bf16 a[240:243],a[120:123],v[40:43],a[240:243]
ds_read_b128 a[120:123],v0 offset:256
v_cvt_pk_bf16_f32 v27,v86,v87
v_mfma_f32_16x16x32_bf16 a[244:247],a[124:127],v[40:43],a[244:247]
ds_read_b128 a[124:127],v1 offset:256
v_fma_f32 v100,v100,s36,v16
v_smfmac_f32_16x16x64_bf16 v[60:63],a[152:155],v[20:27],v18
v_fma_f32 v101,v101,s36,v16
v_mfma_f32_16x16x32_bf16 a[248:251],a[128:131],v[40:43],a[248:251]
v_exp_f32 v92,v92
v_mfma_f32_16x16x32_bf16 a[252:255],a[132:135],v[40:43],a[252:255]
v_exp_f32 v93,v93
v_mfma_f32_16x16x32_bf16 a[204:207],a[132:135],v[56:59],a[204:207]
v_exp_f32 v94,v94
v_mfma_f32_16x16x32_bf16 a[200:203],a[128:131],v[56:59],a[200:203]
v_exp_f32 v95,v95
v_mfma_f32_16x16x32_bf16 v[152:155],a[128:131],v[52:55],v[152:155]
v_cvt_pk_bf16_f32 v30,v92,v93
v_cvt_pk_bf16_f32 v31,v94,v95
v_mfma_f32_16x16x32_bf16 v[156:159],a[132:135],v[52:55],v[156:159]
v_fma_f32 v102,v102,s36,v16
v_fma_f32 v103,v103,s36,v16
v_mfma_f32_16x16x32_bf16 v[252:255],a[132:135],v[48:51],v[252:255]
v_exp_f32 v100,v100
v_mfma_f32_16x16x32_bf16 v[248:251],a[128:131],v[48:51],v[248:251]
buffer_load_dwordx4 v7,s[8:11],s21 offen offset:1024 lds
v_mfma_f32_16x16x32_bf16 v[200:203],a[128:131],v[44:47],v[200:203]
ds_read_b128 a[128:131],v0 offset:6144
v_fma_f32 v108,v108,s36,v17
v_mfma_f32_16x16x32_bf16 v[204:207],a[132:135],v[44:47],v[204:207]
s_waitcnt lgkmcnt(1)
ds_read_b128 a[132:135],v1 offset:6144
v_fma_f32 v109,v109,s36,v17
v_mfma_f32_16x16x32_bf16 v[72:75],a[136:139],a[0:3],0
v_exp_f32 v101,v101
v_mfma_f32_16x16x32_bf16 v[72:75],a[140:143],a[4:7],v[72:75]
v_exp_f32 v102,v102
v_mfma_f32_16x16x32_bf16 v[72:75],a[144:147],a[8:11],v[72:75]
v_exp_f32 v103,v103
v_mfma_f32_16x16x32_bf16 v[72:75],a[148:151],a[12:15],v[72:75]
v_cvt_pk_bf16_f32 v34,v100,v101
v_cvt_pk_bf16_f32 v35,v102,v103
v_mfma_f32_16x16x32_bf16 v[72:75],a[120:123],a[16:19],v[72:75]
v_fma_f32 v110,v110,s36,v17
v_fma_f32 v111,v111,s36,v17
v_smfmac_f32_16x16x64_bf16 v[64:67],a[152:155],v[28:35],v18
v_add_u32 v10,9216,v10
v_mfma_f32_16x16x32_bf16 v[72:75],a[124:127],a[20:23],v[72:75]
v_exp_f32 v108,v108
v_mfma_f32_16x16x32_bf16 v[80:83],a[124:127],a[44:47],0
v_exp_f32 v109,v109
v_mfma_f32_16x16x32_bf16 v[80:83],a[120:123],a[40:43],v[80:83]
buffer_load_dwordx4 v8,s[8:11],s21 offen offset:2048 lds
v_mfma_f32_16x16x32_bf16 v[80:83],a[148:151],a[36:39],v[80:83]
s_add_u32 s21,s21,12288
v_exp_f32 v110,v110
v_mfma_f32_16x16x32_bf16 v[80:83],a[144:147],a[32:35],v[80:83]
s_add_u32 m0,s22,24576
v_exp_f32 v111,v111
v_mfma_f32_16x16x32_bf16 v[80:83],a[140:143],a[28:31],v[80:83]
v_cvt_pk_bf16_f32 v38,v108,v109
v_cvt_pk_bf16_f32 v39,v110,v111
v_mfma_f32_16x16x32_bf16 v[80:83],a[136:139],a[24:27],v[80:83]
v_fma_f32 v72,v72,s36,v13
v_fma_f32 v73,v73,s36,v13
v_mfma_f32_16x16x32_bf16 v[88:91],a[136:139],a[48:51],0
v_fma_f32 v74,v74,s36,v13
v_fma_f32 v75,v75,s36,v13
v_mfma_f32_16x16x32_bf16 v[88:91],a[140:143],a[52:55],v[88:91]
v_exp_f32 v72,v72
v_mfma_f32_16x16x32_bf16 v[88:91],a[144:147],a[56:59],v[88:91]
v_fma_f32 v80,v80,s36,v14
v_fma_f32 v81,v81,s36,v14
v_mfma_f32_16x16x32_bf16 v[88:91],a[148:151],a[60:63],v[88:91]
v_fma_f32 v82,v82,s36,v14
v_fma_f32 v83,v83,s36,v14
v_mfma_f32_16x16x32_bf16 v[88:91],a[120:123],a[64:67],v[88:91]
v_exp_f32 v73,v73
v_mfma_f32_16x16x32_bf16 v[88:91],a[124:127],a[68:71],v[88:91]
v_exp_f32 v74,v74
v_mfma_f32_16x16x32_bf16 v[96:99],a[124:127],a[92:95],0
v_exp_f32 v75,v75
v_mfma_f32_16x16x32_bf16 v[96:99],a[120:123],a[88:91],v[96:99]
buffer_load_dwordx4 v6,s[4:7],s20 offen offset:0 lds
v_mfma_f32_16x16x32_bf16 v[96:99],a[148:151],a[84:87],v[96:99]
v_exp_f32 v80,v80
v_mfma_f32_16x16x32_bf16 v[96:99],a[144:147],a[80:83],v[96:99]
v_fma_f32 v88,v88,s36,v15
v_fma_f32 v89,v89,s36,v15
v_mfma_f32_16x16x32_bf16 v[96:99],a[140:143],a[76:79],v[96:99]
v_exp_f32 v81,v81
v_mfma_f32_16x16x32_bf16 v[96:99],a[136:139],a[72:75],v[96:99]
v_exp_f32 v82,v82
v_mfma_f32_16x16x32_bf16 v[104:107],a[136:139],a[96:99],0
ds_read_b128 a[136:139],v0 offset:6272
v_cvt_pk_bf16_f32 v44,v72,v73
v_mfma_f32_16x16x32_bf16 v[104:107],a[140:143],a[100:103],v[104:107]
ds_read_b128 a[140:143],v1 offset:6272
v_cvt_pk_bf16_f32 v45,v74,v75
v_mfma_f32_16x16x32_bf16 v[104:107],a[144:147],a[104:107],v[104:107]
ds_read_b128 a[144:147],v0 offset:6400
v_cvt_pk_bf16_f32 v48,v80,v81
v_mfma_f32_16x16x32_bf16 v[104:107],a[148:151],a[108:111],v[104:107]
ds_read_b128 a[148:151],v1 offset:6400
v_mfma_f32_16x16x32_bf16 v[104:107],a[120:123],a[112:115],v[104:107]
v_exp_f32 v83,v83
v_mfma_f32_16x16x32_bf16 v[104:107],a[124:127],a[116:119],v[104:107]
s_waitcnt lgkmcnt(4)
v_exp_f32 v88,v88
v_mfma_f32_16x16x32_bf16 v[76:79],a[128:131],a[0:3],0
v_exp_f32 v89,v89
v_mfma_f32_16x16x32_bf16 v[76:79],a[132:135],a[4:7],v[76:79]
buffer_load_dwordx4 v7,s[4:7],s20 offen offset:1024 lds
s_waitcnt lgkmcnt(3)
v_mfma_f32_16x16x32_bf16 v[76:79],a[136:139],a[8:11],v[76:79]
s_waitcnt lgkmcnt(2)
v_cvt_pk_bf16_f32 v49,v82,v83
v_cvt_pk_bf16_f32 v52,v88,v89
v_mfma_f32_16x16x32_bf16 v[76:79],a[140:143],a[12:15],v[76:79]
s_waitcnt lgkmcnt(0)
v_mfma_f32_16x16x32_bf16 v[76:79],a[144:147],a[16:19],v[76:79]
v_mfma_f32_16x16x32_bf16 v[76:79],a[148:151],a[20:23],v[76:79]
v_mfma_f32_16x16x32_bf16 v[84:87],a[148:151],a[44:47],0
v_mfma_f32_16x16x32_bf16 v[84:87],a[144:147],a[40:43],v[84:87]
v_mfma_f32_16x16x32_bf16 v[84:87],a[140:143],a[36:39],v[84:87]
v_mfma_f32_16x16x32_bf16 v[84:87],a[136:139],a[32:35],v[84:87]
v_mfma_f32_16x16x32_bf16 v[84:87],a[132:135],a[28:31],v[84:87]
v_mfma_f32_16x16x32_bf16 v[84:87],a[128:131],a[24:27],v[84:87]
v_mfma_f32_16x16x32_bf16 v[92:95],a[128:131],a[48:51],0
buffer_load_dwordx4 v8,s[4:7],s20 offen offset:2048 lds
v_mfma_f32_16x16x32_bf16 v[92:95],a[132:135],a[52:55],v[92:95]
s_add_u32 s20,s20,12288
s_add_u32 s38,s38,1
s_cmp_lt_u32 s38,2
v_mfma_f32_16x16x32_bf16 v[92:95],a[136:139],a[56:59],v[92:95]
v_mfma_f32_16x16x32_bf16 v[92:95],a[140:143],a[60:63],v[92:95]
v_mfma_f32_16x16x32_bf16 v[92:95],a[144:147],a[64:67],v[92:95]
v_mfma_f32_16x16x32_bf16 v[92:95],a[148:151],a[68:71],v[92:95]
v_mfma_f32_16x16x32_bf16 v[100:103],a[148:151],a[92:95],0
ds_read_b64_tr_b16 a[120:121],v2 offset:24576
v_mfma_f32_16x16x32_bf16 v[100:103],a[144:147],a[88:91],v[100:103]
ds_read_b64_tr_b16 a[122:123],v2 offset:30720
v_mfma_f32_16x16x32_bf16 v[100:103],a[140:143],a[84:87],v[100:103]
v_mfma_f32_16x16x32_bf16 v[100:103],a[136:139],a[80:83],v[100:103]
ds_read_b64_tr_b16 a[124:125],v3 offset:24576
v_mfma_f32_16x16x32_bf16 v[100:103],a[132:135],a[76:79],v[100:103]
ds_read_b64_tr_b16 a[126:127],v3 offset:30720
v_mfma_f32_16x16x32_bf16 v[100:103],a[128:131],a[72:75],v[100:103]
v_mfma_f32_16x16x32_bf16 v[108:111],a[128:131],a[96:99],0
ds_read_b64_tr_b16 a[128:129],v4 offset:24576
v_mfma_f32_16x16x32_bf16 v[108:111],a[132:135],a[100:103],v[108:111]
ds_read_b64_tr_b16 a[130:131],v4 offset:30720
v_mfma_f32_16x16x32_bf16 v[108:111],a[136:139],a[104:107],v[108:111]
ds_read_b64_tr_b16 a[132:133],v5 offset:24576
v_mfma_f32_16x16x32_bf16 v[108:111],a[140:143],a[108:111],v[108:111]
ds_read_b64_tr_b16 a[134:135],v5 offset:30720
v_mfma_f32_16x16x32_bf16 v[108:111],a[144:147],a[112:115],v[108:111]
v_mfma_f32_16x16x32_bf16 v[108:111],a[148:151],a[116:119],v[108:111]
s_cbranch_scc1 L_loop5w0
s_cmp_ge_u32 s69,6
s_cbranch_scc1 L_end5
s_cmp_eq_u32 s40,0
s_cbranch_scc1 L_tr54
s_branch L_tr55
L_tr54:
s_waitcnt vmcnt(43)
s_waitcnt lgkmcnt(3)
v_mfma_f32_16x16x32_bf16 v[160:163],a[120:123],v[20:23],v[160:163]
s_add_u32 m0,s24,0
ds_read_b128 a[12:15],v12 offset:128
v_fma_f32 v101,v101,s36,v16
v_mfma_f32_16x16x32_bf16 v[164:167],a[124:127],v[20:23],v[164:167]
ds_read_b128 a[20:23],v12 offset:256
v_fma_f32 v103,v103,s36,v16
v_mfma_f32_16x16x32_bf16 v[212:215],a[124:127],v[24:27],v[212:215]
ds_read_b128 a[4:7],v12 offset:0
v_fma_f32 v87,v87,s36,v14
v_mfma_f32_16x16x32_bf16 v[208:211],a[120:123],v[24:27],v[208:211]
ds_read_b128 a[16:19],v11 offset:256
v_fma_f32 v106,v106,s36,v17
v_mfma_f32_16x16x32_bf16 v[112:115],a[120:123],v[28:31],v[112:115]
ds_read_b128 a[0:3],v11 offset:0
v_fma_f32 v99,v99,s36,v16
v_mfma_f32_16x16x32_bf16 v[116:119],a[124:127],v[28:31],v[116:119]
ds_read_b128 a[8:11],v11 offset:128
v_fma_f32 v96,v96,s36,v16
v_mfma_f32_16x16x32_bf16 a[164:167],a[124:127],v[32:35],a[164:167]
ds_read_b64_tr_b16 a[136:137],v2 offset:24704
v_fma_f32 v77,v77,s36,v13
v_mfma_f32_16x16x32_bf16 a[160:163],a[120:123],v[32:35],a[160:163]
ds_read_b64_tr_b16 a[138:139],v2 offset:30848
v_fma_f32 v85,v85,s36,v14
v_mfma_f32_16x16x32_bf16 a[208:211],a[120:123],v[36:39],a[208:211]
ds_read_b64_tr_b16 a[140:141],v3 offset:24704
ds_read_b64_tr_b16 a[142:143],v3 offset:30848
ds_read_b64_tr_b16 a[144:145],v4 offset:24704
ds_read_b64_tr_b16 a[146:147],v4 offset:30848
ds_read_b64_tr_b16 a[150:151],v5 offset:30848
ds_read_b64_tr_b16 a[148:149],v5 offset:24704
ds_read_b128 a[40:43],v11 offset:6400
v_mfma_f32_16x16x32_bf16 a[212:215],a[124:127],v[36:39],a[212:215]
s_waitcnt lgkmcnt(11)
v_fma_f32 v84,v84,s36,v14
ds_read_b128 a[32:35],v11 offset:6272
v_mfma_f32_16x16x32_bf16 a[216:219],a[128:131],v[36:39],a[216:219]
s_waitcnt lgkmcnt(10)
buffer_load_dwordx4 v6,s[12:15],s28 offen offset:0 nt lds
v_mfma_f32_16x16x32_bf16 a[220:223],a[132:135],v[36:39],a[220:223]
ds_read_b64_tr_b16 a[122:123],v2 offset:30976
ds_read_b128 a[44:47],v12 offset:6400
v_mfma_f32_16x16x32_bf16 a[172:175],a[132:135],v[32:35],a[172:175]
v_exp_f32 v101,v101
ds_read_b64_tr_b16 a[120:121],v2 offset:24832
ds_read_b128 a[24:27],v11 offset:6144
v_mfma_f32_16x16x32_bf16 a[168:171],a[128:131],v[32:35],a[168:171]
v_exp_f32 v77,v77
ds_read_b128 a[28:31],v12 offset:6144
v_mfma_f32_16x16x32_bf16 v[120:123],a[128:131],v[28:31],v[120:123]
v_fma_f32 v111,v111,s36,v17
ds_read_b64_tr_b16 a[126:127],v3 offset:30976
ds_read_b64_tr_b16 a[124:125],v3 offset:24832
ds_read_b128 a[36:39],v12 offset:6272
v_mfma_f32_16x16x32_bf16 v[124:127],a[132:135],v[28:31],v[124:127]
buffer_load_dwordx4 v7,s[12:15],s28 offen offset:1024 nt lds
v_mfma_f32_16x16x32_bf16 v[220:223],a[132:135],v[24:27],v[220:223]
v_fma_f32 v95,v95,s36,v15
v_fma_f32 v100,v100,s36,v16
v_mfma_f32_16x16x32_bf16 v[216:219],a[128:131],v[24:27],v[216:219]
v_exp_f32 v106,v106
v_mfma_f32_16x16x32_bf16 v[168:171],a[128:131],v[20:23],v[168:171]
ds_read_b64_tr_b16 a[130:131],v4 offset:30976
v_fma_f32 v93,v93,s36,v15
v_mfma_f32_16x16x32_bf16 v[172:175],a[132:135],v[20:23],v[172:175]
s_waitcnt lgkmcnt(4)
ds_read_b64_tr_b16 a[128:129],v4 offset:24832
v_exp_f32 v111,v111
v_mfma_f32_16x16x32_bf16 v[176:179],a[136:139],v[20:23],v[176:179]
ds_read_b64_tr_b16 a[132:133],v5 offset:24832
buffer_load_dwordx4 v8,s[12:15],s28 offen offset:2048 nt lds
v_mfma_f32_16x16x32_bf16 v[180:183],a[140:143],v[20:23],v[180:183]
s_add_u32 s28,s28,3072
ds_read_b64_tr_b16 a[134:135],v5 offset:30976
v_fma_f32 v107,v107,s36,v17
v_mfma_f32_16x16x32_bf16 v[228:231],a[140:143],v[24:27],v[228:231]
s_add_u32 m0,s24,3072
v_fma_f32 v92,v92,s36,v15
v_exp_f32 v92,v92
v_mfma_f32_16x16x32_bf16 v[224:227],a[136:139],v[24:27],v[224:227]
v_fma_f32 v109,v109,s36,v17
v_exp_f32 v109,v109
v_mfma_f32_16x16x32_bf16 v[128:131],a[136:139],v[28:31],v[128:131]
v_fma_f32 v97,v97,s36,v16
v_exp_f32 v84,v84
v_mfma_f32_16x16x32_bf16 v[132:135],a[140:143],v[28:31],v[132:135]
v_fma_f32 v94,v94,s36,v15
v_exp_f32 v94,v94
v_mfma_f32_16x16x32_bf16 a[180:183],a[140:143],v[32:35],a[180:183]
v_fma_f32 v104,v104,s36,v17
v_fma_f32 v90,v90,s36,v15
v_mfma_f32_16x16x32_bf16 a[176:179],a[136:139],v[32:35],a[176:179]
buffer_load_dwordx4 v6,s[12:15],s28 offen offset:0 nt lds
v_mfma_f32_16x16x32_bf16 a[224:227],a[136:139],v[36:39],a[224:227]
v_exp_f32 v93,v93
v_mfma_f32_16x16x32_bf16 a[228:231],a[140:143],v[36:39],a[228:231]
v_exp_f32 v104,v104
v_mfma_f32_16x16x32_bf16 a[232:235],a[144:147],v[36:39],a[232:235]
v_exp_f32 v96,v96
v_mfma_f32_16x16x32_bf16 a[236:239],a[148:151],v[36:39],a[236:239]
v_fma_f32 v78,v78,s36,v13
v_exp_f32 v78,v78
v_mfma_f32_16x16x32_bf16 a[188:191],a[148:151],v[32:35],a[188:191]
v_fma_f32 v110,v110,s36,v17
v_exp_f32 v110,v110
v_mfma_f32_16x16x32_bf16 a[184:187],a[144:147],v[32:35],a[184:187]
v_exp_f32 v97,v97
v_mfma_f32_16x16x32_bf16 v[136:139],a[144:147],v[28:31],v[136:139]
v_exp_f32 v100,v100
v_mfma_f32_16x16x32_bf16 v[140:143],a[148:151],v[28:31],v[140:143]
buffer_load_dwordx4 v7,s[12:15],s28 offen offset:1024 nt lds
v_mfma_f32_16x16x32_bf16 v[236:239],a[148:151],v[24:27],v[236:239]
v_fma_f32 v102,v102,s36,v16
v_exp_f32 v102,v102
v_mfma_f32_16x16x32_bf16 v[232:235],a[144:147],v[24:27],v[232:235]
v_fma_f32 v79,v79,s36,v13
v_exp_f32 v79,v79
v_mfma_f32_16x16x32_bf16 v[184:187],a[144:147],v[20:23],v[184:187]
v_exp_f32 v85,v85
v_mfma_f32_16x16x32_bf16 v[188:191],a[148:151],v[20:23],v[188:191]
v_fma_f32 v108,v108,s36,v17
v_exp_f32 v108,v108
v_mfma_f32_16x16x32_bf16 v[192:195],a[120:123],v[20:23],v[192:195]
s_waitcnt lgkmcnt(0)
v_fma_f32 v98,v98,s36,v16
v_exp_f32 v87,v87
v_mfma_f32_16x16x32_bf16 v[196:199],a[124:127],v[20:23],v[196:199]
v_fma_f32 v76,v76,s36,v13
v_exp_f32 v76,v76
v_mfma_f32_16x16x32_bf16 v[244:247],a[124:127],v[24:27],v[244:247]
buffer_load_dwordx4 v8,s[12:15],s28 offen offset:2048 nt lds
s_waitcnt vmcnt(18)
s_barrier
v_mfma_f32_16x16x32_bf16 v[240:243],a[120:123],v[24:27],v[240:243]
s_add_u32 s28,s28,3072
v_fma_f32 v105,v105,s36,v17
v_exp_f32 v107,v107
v_mfma_f32_16x16x32_bf16 v[144:147],a[120:123],v[28:31],v[144:147]
s_add_u32 m0,s22,0
v_fma_f32 v91,v91,s36,v15
v_exp_f32 v91,v91
v_mfma_f32_16x16x32_bf16 v[148:151],a[124:127],v[28:31],v[148:151]
buffer_load_dwordx4 v6,s[4:7],s25 offen offset:0 lds
v_mfma_f32_16x16x32_bf16 a[196:199],a[124:127],v[32:35],a[196:199]
buffer_load_dwordx4 v7,s[4:7],s25 offen offset:1024 lds
v_mfma_f32_16x16x32_bf16 a[192:195],a[120:123],v[32:35],a[192:195]
buffer_load_dwordx4 v8,s[4:7],s25 offen offset:2048 lds
v_mfma_f32_16x16x32_bf16 a[240:243],a[120:123],v[36:39],a[240:243]
v_fma_f32 v86,v86,s36,v14
v_exp_f32 v86,v86
v_mfma_f32_16x16x32_bf16 a[244:247],a[124:127],v[36:39],a[244:247]
v_exp_f32 v95,v95
v_mfma_f32_16x16x32_bf16 a[248:251],a[128:131],v[36:39],a[248:251]
v_exp_f32 v103,v103
v_mfma_f32_16x16x32_bf16 a[252:255],a[132:135],v[36:39],a[252:255]
ds_read_b64_tr_b16 a[136:137],v2 offset:0
v_cvt_pk_bf16_f32 v41,v106,v107
v_mfma_f32_16x16x32_bf16 a[204:207],a[132:135],v[32:35],a[204:207]
ds_read_b64_tr_b16 a[138:139],v2 offset:6144
v_exp_f32 v99,v99
v_mfma_f32_16x16x32_bf16 a[200:203],a[128:131],v[32:35],a[200:203]
ds_read_b64_tr_b16 a[140:141],v3 offset:0
v_cvt_pk_bf16_f32 v42,v108,v109
v_mfma_f32_16x16x32_bf16 v[152:155],a[128:131],v[28:31],v[152:155]
ds_read_b64_tr_b16 a[142:143],v3 offset:6144
v_cvt_pk_bf16_f32 v50,v84,v85
v_mfma_f32_16x16x32_bf16 v[156:159],a[132:135],v[28:31],v[156:159]
ds_read_b64_tr_b16 a[144:145],v4 offset:0
v_exp_f32 v90,v90
v_mfma_f32_16x16x32_bf16 v[252:255],a[132:135],v[24:27],v[252:255]
ds_read_b64_tr_b16 a[146:147],v4 offset:6144
v_exp_f32 v105,v105
v_mfma_f32_16x16x32_bf16 v[248:251],a[128:131],v[24:27],v[248:251]
ds_read_b64_tr_b16 a[148:149],v5 offset:0
v_cvt_pk_bf16_f32 v55,v94,v95
v_mfma_f32_16x16x32_bf16 v[200:203],a[128:131],v[20:23],v[200:203]
ds_read_b64_tr_b16 a[150:151],v5 offset:6144
v_cvt_pk_bf16_f32 v51,v86,v87
v_mfma_f32_16x16x32_bf16 v[204:207],a[132:135],v[20:23],v[204:207]
v_cvt_pk_bf16_f32 v59,v102,v103
v_exp_f32 v98,v98
v_cvt_pk_bf16_f32 v54,v92,v93
v_cvt_pk_bf16_f32 v56,v96,v97
v_cvt_pk_bf16_f32 v53,v90,v91
v_cvt_pk_bf16_f32 v47,v78,v79
v_cvt_pk_bf16_f32 v43,v110,v111
v_cvt_pk_bf16_f32 v58,v100,v101
v_cvt_pk_bf16_f32 v46,v76,v77
v_cvt_pk_bf16_f32 v57,v98,v99
v_cvt_pk_bf16_f32 v40,v104,v105
v_smfmac_f32_16x16x64_bf16 v[60:63],a[152:155],v[44:51],v18
v_subrev_u32 v10,18432,v10
v_smfmac_f32_16x16x64_bf16 v[64:67],a[152:155],v[52:59],v18
v_smfmac_f32_16x16x64_bf16 v[68:71],a[152:155],v[36:43],v18
s_waitcnt lgkmcnt(1)
v_mfma_f32_16x16x32_bf16 v[160:163],a[136:139],v[44:47],v[160:163]
s_add_u32 s87,s42,18432
ds_read_b64_tr_b16 a[120:121],v2 offset:128
v_mbcnt_lo_u32_b32 v39,-1,0
v_mfma_f32_16x16x32_bf16 v[164:167],a[140:143],v[44:47],v[164:167]
s_add_u32 s66,s42,24576
ds_read_b64_tr_b16 a[122:123],v2 offset:6272
v_mbcnt_hi_u32_b32 v39,-1,v39
v_mfma_f32_16x16x32_bf16 v[212:215],a[140:143],v[48:51],v[212:215]
ds_read_b64_tr_b16 a[124:125],v3 offset:128
v_and_b32 v38,7,v39
v_mfma_f32_16x16x32_bf16 v[208:211],a[136:139],v[48:51],v[208:211]
ds_read_b64_tr_b16 a[126:127],v3 offset:6272
v_lshrrev_b32 v19,5,v39
v_mfma_f32_16x16x32_bf16 v[112:115],a[136:139],v[52:55],v[112:115]
ds_read_b64_tr_b16 a[128:129],v4 offset:128
v_xor_b32 v38,v38,v19
v_mfma_f32_16x16x32_bf16 v[116:119],a[140:143],v[52:55],v[116:119]
ds_read_b64_tr_b16 a[130:131],v4 offset:6272
ds_read_b64_tr_b16 a[132:133],v5 offset:128
ds_read_b64_tr_b16 a[134:135],v5 offset:6272
v_mfma_f32_16x16x32_bf16 a[164:167],a[140:143],v[56:59],a[164:167]
v_and_b32 v19,15,v39
v_lshl_add_u32 v19,v19,7,s24
v_mfma_f32_16x16x32_bf16 a[160:163],a[136:139],v[56:59],a[160:163]
v_lshl_add_u32 v19,v38,4,v19
v_bfe_u32 v38,v39,4,1
v_mfma_f32_16x16x32_bf16 a[208:211],a[136:139],v[40:43],a[208:211]
ds_read_b64_tr_b16 a[136:137],v2 offset:256
v_lshl_add_u32 v36,v38,3,v19
v_mfma_f32_16x16x32_bf16 a[212:215],a[140:143],v[40:43],a[212:215]
ds_read_b64_tr_b16 a[138:139],v2 offset:6400
v_xor_b32 v37,32,v36
v_mfma_f32_16x16x32_bf16 a[216:219],a[144:147],v[40:43],a[216:219]
s_waitcnt lgkmcnt(6)
ds_read_b64_tr_b16 a[140:141],v3 offset:256
v_bfe_u32 v19,v39,3,1
v_mfma_f32_16x16x32_bf16 a[220:223],a[148:151],v[40:43],a[220:223]
ds_read_b64_tr_b16 a[142:143],v3 offset:6400
v_xor_b32 v38,64,v36
v_xor_b32 v39,96,v36
v_lshlrev_b32 v19,11,v19
v_add_f32 v68,v68,v69
v_add_f32 v68,v68,v70
v_add_f32 v66,v66,v67
v_add_f32 v68,v68,v71
v_rcp_f32 v66,v66
v_rcp_f32 v68,v68
v_accvgpr_read_b32 v72,a160
v_accvgpr_read_b32 v73,a161
v_pk_mul_f32 v[72:73],v[72:73],v[66:67] op_sel_hi:[1,0]
v_accvgpr_read_b32 v74,a162
v_accvgpr_read_b32 v75,a163
v_pk_mul_f32 v[74:75],v[74:75],v[66:67] op_sel_hi:[1,0]
v_accvgpr_read_b32 v76,a208
v_accvgpr_read_b32 v77,a209
v_pk_mul_f32 v[76:77],v[76:77],v[68:69] op_sel_hi:[1,0]
v_accvgpr_read_b32 v78,a210
v_accvgpr_read_b32 v79,a211
v_pk_mul_f32 v[78:79],v[78:79],v[68:69] op_sel_hi:[1,0]
v_accvgpr_read_b32 v80,a164
v_accvgpr_read_b32 v81,a165
v_mfma_f32_16x16x32_bf16 a[172:175],a[148:151],v[56:59],a[172:175]
v_accvgpr_read_b32 v82,a166
v_accvgpr_read_b32 v83,a167
v_accvgpr_read_b32 v84,a212
v_accvgpr_read_b32 v85,a213
v_accvgpr_read_b32 v86,a214
v_pk_mul_f32 v[80:81],v[80:81],v[66:67] op_sel_hi:[1,0]
v_pk_mul_f32 v[82:83],v[82:83],v[66:67] op_sel_hi:[1,0]
v_pk_mul_f32 v[84:85],v[84:85],v[68:69] op_sel_hi:[1,0]
v_accvgpr_read_b32 v87,a215
v_pk_mul_f32 v[86:87],v[86:87],v[68:69] op_sel_hi:[1,0]
v_accvgpr_read_b32 v92,a216
v_accvgpr_read_b32 v93,a217
v_mfma_f32_16x16x32_bf16 a[168:171],a[144:147],v[56:59],a[168:171]
v_accvgpr_read_b32 v94,a218
v_accvgpr_read_b32 v95,a219
v_mfma_f32_16x16x32_bf16 v[120:123],a[144:147],v[52:55],v[120:123]
v_accvgpr_read_b32 v100,a220
v_accvgpr_read_b32 v101,a221
v_mfma_f32_16x16x32_bf16 v[124:127],a[148:151],v[52:55],v[124:127]
v_accvgpr_read_b32 v102,a222
v_accvgpr_read_b32 v103,a223
v_mfma_f32_16x16x32_bf16 v[220:223],a[148:151],v[48:51],v[220:223]
v_accvgpr_read_b32 v88,a168
v_accvgpr_read_b32 v89,a169
v_accvgpr_read_b32 v90,a170
v_accvgpr_read_b32 v91,a171
v_accvgpr_read_b32 v96,a172
v_pk_mul_f32 v[92:93],v[92:93],v[68:69] op_sel_hi:[1,0]
v_pk_mul_f32 v[94:95],v[94:95],v[68:69] op_sel_hi:[1,0]
v_pk_mul_f32 v[88:89],v[88:89],v[66:67] op_sel_hi:[1,0]
v_pk_mul_f32 v[90:91],v[90:91],v[66:67] op_sel_hi:[1,0]
v_accvgpr_read_b32 v97,a173
v_accvgpr_read_b32 v98,a174
v_mfma_f32_16x16x32_bf16 v[216:219],a[144:147],v[48:51],v[216:219]
v_accvgpr_read_b32 v99,a175
v_add_f32 v62,v62,v63
v_rcp_f32 v62,v62
v_cvt_pk_bf16_f32 v72,v72,v73
v_pk_mul_f32 v[96:97],v[96:97],v[66:67] op_sel_hi:[1,0]
v_pk_mul_f32 v[100:101],v[100:101],v[68:69] op_sel_hi:[1,0]
v_pk_mul_f32 v[102:103],v[102:103],v[68:69] op_sel_hi:[1,0]
v_pk_mul_f32 v[98:99],v[98:99],v[66:67] op_sel_hi:[1,0]
v_cvt_pk_bf16_f32 v76,v76,v77
v_cvt_pk_bf16_f32 v80,v80,v81
v_mfma_f32_16x16x32_bf16 v[168:171],a[144:147],v[44:47],v[168:171]
ds_read_b64_tr_b16 a[144:145],v4 offset:256
v_cvt_pk_bf16_f32 v84,v84,v85
v_mfma_f32_16x16x32_bf16 v[172:175],a[148:151],v[44:47],v[172:175]
ds_read_b64_tr_b16 a[146:147],v4 offset:6400
v_cvt_pk_bf16_f32 v73,v74,v75
v_mfma_f32_16x16x32_bf16 v[176:179],a[120:123],v[44:47],v[176:179]
ds_read_b64_tr_b16 a[148:149],v5 offset:256
v_cvt_pk_bf16_f32 v77,v78,v79
v_mfma_f32_16x16x32_bf16 v[180:183],a[124:127],v[44:47],v[180:183]
ds_read_b64_tr_b16 a[150:151],v5 offset:6400
v_cvt_pk_bf16_f32 v92,v92,v93
v_mfma_f32_16x16x32_bf16 v[228:231],a[124:127],v[48:51],v[228:231]
ds_write2st64_b64 v36,v[72:73],v[76:77] offset0:36 offset1:40
v_mfma_f32_16x16x32_bf16 v[224:227],a[120:123],v[48:51],v[224:227]
v_add_u32 v36,v36,v19
v_cvt_pk_bf16_f32 v88,v88,v89
v_mfma_f32_16x16x32_bf16 v[128:131],a[120:123],v[52:55],v[128:131]
v_cvt_pk_bf16_f32 v81,v82,v83
v_cvt_pk_bf16_f32 v85,v86,v87
v_mfma_f32_16x16x32_bf16 v[132:135],a[124:127],v[52:55],v[132:135]
v_cvt_pk_bf16_f32 v96,v96,v97
v_cvt_pk_bf16_f32 v100,v100,v101
v_mfma_f32_16x16x32_bf16 a[180:183],a[124:127],v[56:59],a[180:183]
ds_write2st64_b64 v37,v[80:81],v[84:85] offset0:36 offset1:40
v_pk_mul_f32 v[208:209],v[208:209],v[62:63] op_sel_hi:[1,0]
v_pk_mul_f32 v[210:211],v[210:211],v[62:63] op_sel_hi:[1,0]
v_pk_mul_f32 v[224:225],v[224:225],v[62:63] op_sel_hi:[1,0]
v_pk_mul_f32 v[226:227],v[226:227],v[62:63] op_sel_hi:[1,0]
v_pk_mul_f32 v[212:213],v[212:213],v[62:63] op_sel_hi:[1,0]
v_pk_mul_f32 v[214:215],v[214:215],v[62:63] op_sel_hi:[1,0]
v_pk_mul_f32 v[228:229],v[228:229],v[62:63] op_sel_hi:[1,0]
v_pk_mul_f32 v[230:231],v[230:231],v[62:63] op_sel_hi:[1,0]
v_add_u32 v37,v37,v19
v_cvt_pk_bf16_f32 v93,v94,v95
v_mfma_f32_16x16x32_bf16 a[176:179],a[120:123],v[56:59],a[176:179]
v_cvt_pk_bf16_f32 v89,v90,v91
v_cvt_pk_bf16_f32 v97,v98,v99
v_mfma_f32_16x16x32_bf16 a[224:227],a[120:123],v[40:43],a[224:227]
ds_write2st64_b64 v38,v[88:89],v[92:93] offset0:36 offset1:40
v_mfma_f32_16x16x32_bf16 a[228:231],a[124:127],v[40:43],a[228:231]
s_waitcnt lgkmcnt(1)
v_add_u32 v38,v38,v19
v_cvt_pk_bf16_f32 v101,v102,v103
v_mfma_f32_16x16x32_bf16 a[232:235],a[128:131],v[40:43],a[232:235]
v_accvgpr_read_b32 v80,a176
v_accvgpr_read_b32 v81,a177
v_mfma_f32_16x16x32_bf16 a[236:239],a[132:135],v[40:43],a[236:239]
v_accvgpr_read_b32 v82,a178
v_accvgpr_read_b32 v83,a179
v_mfma_f32_16x16x32_bf16 a[188:191],a[132:135],v[56:59],a[188:191]
ds_write2st64_b64 v39,v[96:97],v[100:101] offset0:36 offset1:40
v_mfma_f32_16x16x32_bf16 a[184:187],a[128:131],v[56:59],a[184:187]
v_add_u32 v39,v39,v19
v_accvgpr_read_b32 v90,a182
v_mfma_f32_16x16x32_bf16 v[136:139],a[128:131],v[52:55],v[136:139]
ds_read_b128 v[104:107],v10 offset:18432
v_accvgpr_read_b32 v91,a183
v_mfma_f32_16x16x32_bf16 v[140:143],a[132:135],v[52:55],v[140:143]
ds_read_b128 v[108:111],v10 offset:19456
v_accvgpr_read_b32 v84,a224
v_mfma_f32_16x16x32_bf16 v[236:239],a[132:135],v[48:51],v[236:239]
ds_read_b128 v[72:75],v10 offset:20480
v_accvgpr_read_b32 v85,a225
v_mfma_f32_16x16x32_bf16 v[232:235],a[128:131],v[48:51],v[232:235]
s_waitcnt vmcnt(15)
ds_read_b128 a[68:71],v12 offset:12544
v_accvgpr_read_b32 v86,a226
v_mfma_f32_16x16x32_bf16 v[184:187],a[128:131],v[44:47],v[184:187]
ds_read_b128 a[64:67],v11 offset:12544
v_accvgpr_read_b32 v87,a227
v_mfma_f32_16x16x32_bf16 v[188:191],a[132:135],v[44:47],v[188:191]
ds_read_b128 a[60:63],v12 offset:12416
v_accvgpr_read_b32 v88,a180
v_mfma_f32_16x16x32_bf16 v[192:195],a[136:139],v[44:47],v[192:195]
s_waitcnt lgkmcnt(5)
ds_read_b128 a[56:59],v11 offset:12416
v_accvgpr_read_b32 v89,a181
ds_read_b128 a[52:55],v12 offset:12288
buffer_store_dwordx4 v[104:107],v9,s[16:19],s87 offen offset:0 nt
ds_read_b128 a[48:51],v11 offset:12288
v_pk_mul_f32 v[216:217],v[216:217],v[62:63] op_sel_hi:[1,0]
ds_read_b128 v[76:79],v10 offset:21504
v_pk_mul_f32 v[218:219],v[218:219],v[62:63] op_sel_hi:[1,0]
v_pk_mul_f32 v[232:233],v[232:233],v[62:63] op_sel_hi:[1,0]
v_pk_mul_f32 v[234:235],v[234:235],v[62:63] op_sel_hi:[1,0]
v_pk_mul_f32 v[220:221],v[220:221],v[62:63] op_sel_hi:[1,0]
v_pk_mul_f32 v[222:223],v[222:223],v[62:63] op_sel_hi:[1,0]
v_pk_mul_f32 v[236:237],v[236:237],v[62:63] op_sel_hi:[1,0]
s_waitcnt lgkmcnt(6)
buffer_store_dwordx4 v[108:111],v9,s[16:19],s87 offen offset:3072 nt
v_pk_mul_f32 v[238:239],v[238:239],v[62:63] op_sel_hi:[1,0]
v_pk_mul_f32 v[80:81],v[80:81],v[66:67] op_sel_hi:[1,0]
v_pk_mul_f32 v[82:83],v[82:83],v[66:67] op_sel_hi:[1,0]
v_pk_mul_f32 v[84:85],v[84:85],v[68:69] op_sel_hi:[1,0]
v_pk_mul_f32 v[86:87],v[86:87],v[68:69] op_sel_hi:[1,0]
v_pk_mul_f32 v[90:91],v[90:91],v[66:67] op_sel_hi:[1,0]
v_pk_mul_f32 v[88:89],v[88:89],v[66:67] op_sel_hi:[1,0]
v_accvgpr_read_b32 v92,a228
v_accvgpr_read_b32 v93,a229
v_pk_mul_f32 v[92:93],v[92:93],v[68:69] op_sel_hi:[1,0]
v_accvgpr_read_b32 v94,a230
buffer_store_dwordx4 v[72:75],v9,s[16:19],s66 offen offset:0 nt
v_accvgpr_read_b32 v95,a231
v_pk_mul_f32 v[94:95],v[94:95],v[68:69] op_sel_hi:[1,0]
v_accvgpr_read_b32 v102,a234
v_accvgpr_read_b32 v103,a235
v_pk_mul_f32 v[102:103],v[102:103],v[68:69] op_sel_hi:[1,0]
v_accvgpr_read_b32 v100,a232
v_accvgpr_read_b32 v101,a233
v_pk_mul_f32 v[100:101],v[100:101],v[68:69] op_sel_hi:[1,0]
v_accvgpr_read_b32 v96,a184
v_accvgpr_read_b32 v97,a185
v_pk_mul_f32 v[96:97],v[96:97],v[66:67] op_sel_hi:[1,0]
s_waitcnt lgkmcnt(0)
buffer_store_dwordx4 v[76:79],v9,s[16:19],s66 offen offset:3072 nt
v_accvgpr_read_b32 v98,a186
v_accvgpr_read_b32 v99,a187
v_pk_mul_f32 v[98:99],v[98:99],v[66:67] op_sel_hi:[1,0]
v_cvt_pk_bf16_f32 v208,v208,v209
v_cvt_pk_bf16_f32 v224,v224,v225
v_mfma_f32_16x16x32_bf16 v[196:199],a[140:143],v[44:47],v[196:199]
v_cvt_pk_bf16_f32 v209,v210,v211
v_cvt_pk_bf16_f32 v225,v226,v227
v_mfma_f32_16x16x32_bf16 v[244:247],a[140:143],v[48:51],v[244:247]
ds_write2st64_b64 v36,v[208:209],v[224:225] offset0:12 offset1:14
v_sub_u32 v36,v36,v19
v_accvgpr_read_b32 v210,a190
v_accvgpr_read_b32 v211,a191
v_pk_mul_f32 v[210:211],v[210:211],v[66:67] op_sel_hi:[1,0]
v_accvgpr_read_b32 v226,a238
v_accvgpr_read_b32 v227,a239
v_pk_mul_f32 v[226:227],v[226:227],v[68:69] op_sel_hi:[1,0]
v_accvgpr_read_b32 v208,a188
v_accvgpr_read_b32 v209,a189
v_pk_mul_f32 v[208:209],v[208:209],v[66:67] op_sel_hi:[1,0]
v_accvgpr_read_b32 v224,a236
v_accvgpr_read_b32 v225,a237
v_pk_mul_f32 v[224:225],v[224:225],v[68:69] op_sel_hi:[1,0]
v_add_f32 v64,v64,v65
v_rcp_f32 v64,v64
v_mfma_f32_16x16x32_bf16 v[240:243],a[136:139],v[48:51],v[240:243]
v_cvt_pk_bf16_f32 v212,v212,v213
v_cvt_pk_bf16_f32 v228,v228,v229
v_mfma_f32_16x16x32_bf16 v[144:147],a[136:139],v[52:55],v[144:147]
v_cvt_pk_bf16_f32 v216,v216,v217
v_cvt_pk_bf16_f32 v232,v232,v233
v_mfma_f32_16x16x32_bf16 v[148:151],a[140:143],v[52:55],v[148:151]
v_cvt_pk_bf16_f32 v213,v214,v215
v_cvt_pk_bf16_f32 v229,v230,v231
v_mfma_f32_16x16x32_bf16 a[196:199],a[140:143],v[56:59],a[196:199]
ds_write2st64_b64 v37,v[212:213],v[228:229] offset0:12 offset1:14
v_pk_mul_f32 v[240:241],v[240:241],v[62:63] op_sel_hi:[1,0]
v_pk_mul_f32 v[242:243],v[242:243],v[62:63] op_sel_hi:[1,0]
v_pk_mul_f32 v[112:113],v[112:113],v[64:65] op_sel_hi:[1,0]
v_pk_mul_f32 v[114:115],v[114:115],v[64:65] op_sel_hi:[1,0]
v_sub_u32 v37,v37,v19
v_cvt_pk_bf16_f32 v217,v218,v219
v_mfma_f32_16x16x32_bf16 a[192:195],a[136:139],v[56:59],a[192:195]
v_cvt_pk_bf16_f32 v233,v234,v235
v_cvt_pk_bf16_f32 v220,v220,v221
v_mfma_f32_16x16x32_bf16 a[240:243],a[136:139],v[40:43],a[240:243]
v_cvt_pk_bf16_f32 v236,v236,v237
v_cvt_pk_bf16_f32 v221,v222,v223
v_mfma_f32_16x16x32_bf16 a[244:247],a[140:143],v[40:43],a[244:247]
ds_write2st64_b64 v38,v[216:217],v[232:233] offset0:12 offset1:14
v_pk_mul_f32 v[244:245],v[244:245],v[62:63] op_sel_hi:[1,0]
v_pk_mul_f32 v[246:247],v[246:247],v[62:63] op_sel_hi:[1,0]
v_pk_mul_f32 v[116:117],v[116:117],v[64:65] op_sel_hi:[1,0]
v_pk_mul_f32 v[118:119],v[118:119],v[64:65] op_sel_hi:[1,0]
v_sub_u32 v38,v38,v19
v_accvgpr_read_b32 v228,a192
v_mfma_f32_16x16x32_bf16 a[248:251],a[144:147],v[40:43],a[248:251]
v_accvgpr_read_b32 v229,a193
v_accvgpr_read_b32 v230,a194
v_mfma_f32_16x16x32_bf16 a[252:255],a[148:151],v[40:43],a[252:255]
s_waitcnt vmcnt(4)
s_barrier
v_mfma_f32_16x16x32_bf16 a[204:207],a[148:151],v[56:59],a[204:207]
ds_read_b128 a[140:143],v1 offset:256
v_accvgpr_read_b32 v231,a195
v_mfma_f32_16x16x32_bf16 a[200:203],a[144:147],v[56:59],a[200:203]
ds_read_b128 a[136:139],v0 offset:256
v_accvgpr_read_b32 v218,a242
v_mfma_f32_16x16x32_bf16 v[152:155],a[144:147],v[52:55],v[152:155]
ds_read_b128 a[132:135],v1 offset:128
v_accvgpr_read_b32 v219,a243
v_mfma_f32_16x16x32_bf16 v[156:159],a[148:151],v[52:55],v[156:159]
ds_read_b128 a[128:131],v0 offset:128
v_accvgpr_read_b32 v216,a240
v_mfma_f32_16x16x32_bf16 v[252:255],a[148:151],v[48:51],v[252:255]
ds_read_b128 a[124:127],v1 offset:0
v_accvgpr_read_b32 v217,a241
v_mfma_f32_16x16x32_bf16 v[248:251],a[144:147],v[48:51],v[248:251]
ds_read_b128 a[120:123],v0 offset:0
v_cvt_pk_bf16_f32 v237,v238,v239
v_mfma_f32_16x16x32_bf16 v[200:203],a[144:147],v[44:47],v[200:203]
ds_write2st64_b64 v39,v[220:221],v[236:237] offset0:12 offset1:14
v_mfma_f32_16x16x32_bf16 v[204:207],a[148:151],v[44:47],v[204:207]
s_waitcnt lgkmcnt(6)
v_sub_u32 v39,v39,v19
v_accvgpr_read_b32 v234,a198
v_mfma_f32_16x16x32_bf16 v[72:75],a[140:143],a[20:23],0
ds_read_b128 a[144:147],v0 offset:6144
v_accvgpr_read_b32 v235,a199
ds_read_b128 a[148:151],v1 offset:6144
v_pk_mul_f32 v[248:249],v[248:249],v[62:63] op_sel_hi:[1,0]
v_pk_mul_f32 v[250:251],v[250:251],v[62:63] op_sel_hi:[1,0]
v_pk_mul_f32 v[120:121],v[120:121],v[64:65] op_sel_hi:[1,0]
v_pk_mul_f32 v[122:123],v[122:123],v[64:65] op_sel_hi:[1,0]
v_pk_mul_f32 v[252:253],v[252:253],v[62:63] op_sel_hi:[1,0]
v_pk_mul_f32 v[254:255],v[254:255],v[62:63] op_sel_hi:[1,0]
v_pk_mul_f32 v[124:125],v[124:125],v[64:65] op_sel_hi:[1,0]
v_pk_mul_f32 v[126:127],v[126:127],v[64:65] op_sel_hi:[1,0]
v_pk_mul_f32 v[228:229],v[228:229],v[66:67] op_sel_hi:[1,0]
v_pk_mul_f32 v[230:231],v[230:231],v[66:67] op_sel_hi:[1,0]
v_pk_mul_f32 v[216:217],v[216:217],v[68:69] op_sel_hi:[1,0]
v_pk_mul_f32 v[218:219],v[218:219],v[68:69] op_sel_hi:[1,0]
v_accvgpr_read_b32 v222,a246
v_accvgpr_read_b32 v223,a247
s_waitcnt lgkmcnt(2)
v_mfma_f32_16x16x32_bf16 v[72:75],a[136:139],a[16:19],v[72:75]
v_accvgpr_read_b32 v232,a196
v_accvgpr_read_b32 v233,a197
v_mfma_f32_16x16x32_bf16 v[72:75],a[132:135],a[12:15],v[72:75]
v_accvgpr_read_b32 v220,a244
v_accvgpr_read_b32 v221,a245
v_cvt_pk_bf16_f32 v80,v80,v81
v_cvt_pk_bf16_f32 v84,v84,v85
v_cvt_pk_bf16_f32 v81,v82,v83
v_pk_mul_f32 v[232:233],v[232:233],v[66:67] op_sel_hi:[1,0]
v_pk_mul_f32 v[234:235],v[234:235],v[66:67] op_sel_hi:[1,0]
v_pk_mul_f32 v[222:223],v[222:223],v[68:69] op_sel_hi:[1,0]
v_pk_mul_f32 v[220:221],v[220:221],v[68:69] op_sel_hi:[1,0]
v_cvt_pk_bf16_f32 v85,v86,v87
v_accvgpr_read_b32 v238,a202
v_mfma_f32_16x16x32_bf16 v[72:75],a[128:131],a[8:11],v[72:75]
ds_write2st64_b64 v36,v[80:81],v[84:85] offset0:36 offset1:40
v_mfma_f32_16x16x32_bf16 v[72:75],a[124:127],a[4:7],v[72:75]
v_add_u32 v36,v36,v19
v_accvgpr_read_b32 v239,a203
v_mfma_f32_16x16x32_bf16 v[72:75],a[120:123],a[0:3],v[72:75]
v_accvgpr_read_b32 v236,a200
v_accvgpr_read_b32 v237,a201
v_accvgpr_read_b32 v86,a250
v_accvgpr_read_b32 v87,a251
v_accvgpr_read_b32 v84,a248
v_pk_mul_f32 v[238:239],v[238:239],v[66:67] op_sel_hi:[1,0]
v_pk_mul_f32 v[236:237],v[236:237],v[66:67] op_sel_hi:[1,0]
v_pk_mul_f32 v[86:87],v[86:87],v[68:69] op_sel_hi:[1,0]
v_accvgpr_read_b32 v85,a249
v_pk_mul_f32 v[84:85],v[84:85],v[68:69] op_sel_hi:[1,0]
v_add_f32 v60,v60,v61
v_rcp_f32 v60,v60
v_mfma_f32_16x16x32_bf16 v[80:83],a[120:123],a[24:27],0
v_cvt_pk_bf16_f32 v88,v88,v89
v_cvt_pk_bf16_f32 v92,v92,v93
v_mfma_f32_16x16x32_bf16 v[80:83],a[124:127],a[28:31],v[80:83]
v_min3_f32 v61,v60,v62,v64
v_cvt_pk_bf16_f32 v100,v100,v101
v_mfma_f32_16x16x32_bf16 v[80:83],a[128:131],a[32:35],v[80:83]
v_cvt_pk_bf16_f32 v96,v96,v97
v_cvt_pk_bf16_f32 v89,v90,v91
v_cvt_pk_bf16_f32 v93,v94,v95
ds_write2st64_b64 v37,v[88:89],v[92:93] offset0:36 offset1:40
v_add_u32 v37,v37,v19
v_min3_f32 v61,v61,v66,v68
v_cvt_pk_bf16_f32 v101,v102,v103
v_cvt_pk_bf16_f32 v97,v98,v99
v_cmp_nlt_f32 vcc,s37,v61
v_accvgpr_read_b32 v94,a206
v_accvgpr_read_b32 v95,a207
v_pk_mul_f32 v[94:95],v[94:95],v[66:67] op_sel_hi:[1,0]
v_accvgpr_read_b32 v92,a204
v_accvgpr_read_b32 v93,a205
v_pk_mul_f32 v[92:93],v[92:93],v[66:67] op_sel_hi:[1,0]
ds_write2st64_b64 v38,v[96:97],v[100:101] offset0:36 offset1:40
v_add_u32 v38,v38,v19
v_accvgpr_read_b32 v98,a254
v_accvgpr_read_b32 v99,a255
v_pk_mul_f32 v[98:99],v[98:99],v[68:69] op_sel_hi:[1,0]
v_accvgpr_read_b32 v96,a252
v_accvgpr_read_b32 v97,a253
v_pk_mul_f32 v[96:97],v[96:97],v[68:69] op_sel_hi:[1,0]
v_cvt_pk_bf16_f32 v208,v208,v209
v_cvt_pk_bf16_f32 v224,v224,v225
v_mfma_f32_16x16x32_bf16 v[80:83],a[132:135],a[36:39],v[80:83]
s_cmp_lg_u64 vcc,0
v_cvt_pk_bf16_f32 v209,v210,v211
v_cvt_pk_bf16_f32 v225,v226,v227
v_mfma_f32_16x16x32_bf16 v[80:83],a[136:139],a[40:43],v[80:83]
s_cselect_b32 s62,s32,0
ds_write2st64_b64 v39,v[208:209],v[224:225] offset0:36 offset1:40
v_mfma_f32_16x16x32_bf16 v[80:83],a[140:143],a[44:47],v[80:83]
s_or_b32 s31,s31,s62
v_add_u32 v39,v39,v19
v_cvt_pk_bf16_f32 v240,v240,v241
v_mfma_f32_16x16x32_bf16 v[88:91],a[140:143],a[68:71],0
s_lshl_b32 s32,s32,1
ds_read_b128 v[76:79],v10 offset:18432
v_cvt_pk_bf16_f32 v112,v112,v113
ds_read_b128 v[104:107],v10 offset:19456
v_pk_mul_f32 v[128:129],v[128:129],v[64:65] op_sel_hi:[1,0]
ds_read_b128 v[108:111],v10 offset:20480
v_pk_mul_f32 v[130:131],v[130:131],v[64:65] op_sel_hi:[1,0]
ds_read_b128 v[212:215],v10 offset:21504
v_pk_mul_f32 v[144:145],v[144:145],v[64:65] op_sel_hi:[1,0]
v_pk_mul_f32 v[146:147],v[146:147],v[64:65] op_sel_hi:[1,0]
v_cvt_pk_bf16_f32 v244,v244,v245
v_cvt_pk_bf16_f32 v116,v116,v117
v_mfma_f32_16x16x32_bf16 v[88:91],a[136:139],a[64:67],v[88:91]
s_add_u32 m0,s23,0
v_cvt_pk_bf16_f32 v241,v242,v243
v_cvt_pk_bf16_f32 v113,v114,v115
v_mfma_f32_16x16x32_bf16 v[88:91],a[132:135],a[60:63],v[88:91]
buffer_load_dwordx4 v6,s[8:11],s25 offen offset:0 lds
v_mfma_f32_16x16x32_bf16 v[88:91],a[128:131],a[56:59],v[88:91]
buffer_load_dwordx4 v7,s[8:11],s25 offen offset:1024 lds
buffer_load_dwordx4 v8,s[8:11],s25 offen offset:2048 lds
ds_write2st64_b64 v36,v[240:241],v[112:113] offset0:16 offset1:24
v_pk_mul_f32 v[132:133],v[132:133],v[64:65] op_sel_hi:[1,0]
v_pk_mul_f32 v[134:135],v[134:135],v[64:65] op_sel_hi:[1,0]
v_pk_mul_f32 v[148:149],v[148:149],v[64:65] op_sel_hi:[1,0]
s_waitcnt lgkmcnt(1)
buffer_store_dwordx4 v[76:79],v9,s[16:19],s87 offen offset:128 nt
v_pk_mul_f32 v[150:151],v[150:151],v[64:65] op_sel_hi:[1,0]
v_sub_u32 v36,v36,v19
v_cvt_pk_bf16_f32 v248,v248,v249
v_mfma_f32_16x16x32_bf16 v[88:91],a[124:127],a[52:55],v[88:91]
s_waitcnt vmcnt(11)
ds_read_b128 a[72:75],v11 offset:0
v_cvt_pk_bf16_f32 v120,v120,v121
v_mfma_f32_16x16x32_bf16 v[88:91],a[120:123],a[48:51],v[88:91]
s_mov_b32 s27,s42
ds_read_b128 a[76:79],v12 offset:0
v_cvt_pk_bf16_f32 v245,v246,v247
ds_read_b128 a[80:83],v11 offset:128
buffer_store_dwordx4 v[104:107],v9,s[16:19],s87 offen offset:3200 nt
ds_read_b128 a[84:87],v12 offset:128
v_cvt_pk_bf16_f32 v117,v118,v119
ds_read_b128 a[88:91],v11 offset:256
v_cvt_pk_bf16_f32 v252,v252,v253
ds_read_b128 a[92:95],v12 offset:256
v_cvt_pk_bf16_f32 v124,v124,v125
ds_write2st64_b64 v37,v[244:245],v[116:117] offset0:16 offset1:24
v_sub_u32 v37,v37,v19
v_cvt_pk_bf16_f32 v249,v250,v251
v_cvt_pk_bf16_f32 v121,v122,v123
buffer_store_dwordx4 v[108:111],v9,s[16:19],s66 offen offset:128 nt
v_cvt_pk_bf16_f32 v228,v228,v229
v_cvt_pk_bf16_f32 v216,v216,v217
v_cvt_pk_bf16_f32 v253,v254,v255
v_cvt_pk_bf16_f32 v125,v126,v127
v_cvt_pk_bf16_f32 v232,v232,v233
v_cvt_pk_bf16_f32 v220,v220,v221
v_cvt_pk_bf16_f32 v229,v230,v231
v_cvt_pk_bf16_f32 v217,v218,v219
v_cvt_pk_bf16_f32 v236,v236,v237
ds_write2st64_b64 v38,v[248:249],v[120:121] offset0:16 offset1:24
v_sub_u32 v38,v38,v19
v_cvt_pk_bf16_f32 v84,v84,v85
v_cvt_pk_bf16_f32 v233,v234,v235
buffer_store_dwordx4 v[212:215],v9,s[16:19],s66 offen offset:3200 nt
v_cvt_pk_bf16_f32 v221,v222,v223
v_cvt_pk_bf16_f32 v92,v92,v93
v_cvt_pk_bf16_f32 v96,v96,v97
v_cvt_pk_bf16_f32 v237,v238,v239
v_cvt_pk_bf16_f32 v85,v86,v87
v_cvt_pk_bf16_f32 v93,v94,v95
v_cvt_pk_bf16_f32 v97,v98,v99
v_max3_f32 v44,v72,v73,v74
v_max3_f32 v48,v80,v81,v82
ds_write2st64_b64 v39,v[252:253],v[124:125] offset0:16 offset1:24
v_sub_u32 v39,v39,v19
v_max3_f32 v52,v88,v89,v90
v_cvt_pk_bf16_f32 v128,v128,v129
v_cvt_pk_bf16_f32 v144,v144,v145
v_cvt_pk_bf16_f32 v132,v132,v133
v_cvt_pk_bf16_f32 v148,v148,v149
v_cvt_pk_bf16_f32 v129,v130,v131
v_cvt_pk_bf16_f32 v145,v146,v147
v_cvt_pk_bf16_f32 v133,v134,v135
v_cvt_pk_bf16_f32 v149,v150,v151
v_mov_b32 v67,0
ds_write2st64_b64 v36,v[228:229],v[216:217] offset0:36 offset1:40
v_add_u32 v36,v36,v19
v_mov_b32 v63,0
v_mov_b32 v65,0
v_mov_b32 v62,0
v_mov_b32 v61,0
v_mov_b32 v66,0
s_mov_b32 s42,s41
s_add_u32 s69,s69,1
s_lshl_b32 s62,s69,5
s_add_u32 s62,s62,s34
s_mul_i32 s63,s62,171
ds_write2st64_b64 v37,v[232:233],v[220:221] offset0:36 offset1:40
v_add_u32 v37,v37,v19
s_lshr_b32 s63,s63,9
s_mul_i32 s64,s63,3
s_sub_u32 s62,s62,s64
s_add_u32 s63,s63,s33
s_mul_i32 s30,s63,196608
s_mul_i32 s41,s63,325632
s_lshl_b32 s63,s3,2
s_add_u32 s64,s63,21
s_cmp_eq_u32 s3,0
s_cselect_b32 s64,20,s64
ds_write2st64_b64 v38,v[236:237],v[84:85] offset0:36 offset1:40
v_add_u32 v38,v38,v19
s_cselect_b32 s40,1,0
s_add_u32 s65,s63,37
s_cmp_eq_u32 s62,2
s_cselect_b32 s64,s65,s64
s_cselect_b32 s40,0,s40
s_add_u32 s65,s63,s3
s_cmp_eq_u32 s62,0
s_cselect_b32 s64,s65,s64
s_cselect_b32 s40,1,s40
s_mul_i32 s64,s64,6144
ds_write2st64_b64 v39,v[92:93],v[96:97] offset0:36 offset1:40
s_waitcnt lgkmcnt(2)
v_mfma_f32_16x16x32_bf16 v[96:99],a[120:123],a[72:75],0
s_add_u32 s41,s41,s64
v_add_u32 v39,v39,v19
ds_read_b128 v[100:103],v10 offset:18432
s_cmp_ge_u32 s69,6
ds_read_b128 v[208:211],v10 offset:19456
v_pk_mul_f32 v[136:137],v[136:137],v[64:65] op_sel_hi:[1,0]
ds_read_b128 v[224:227],v10 offset:20480
v_pk_mul_f32 v[138:139],v[138:139],v[64:65] op_sel_hi:[1,0]
ds_read_b128 v[240:243],v10 offset:21504
v_pk_mul_f32 v[152:153],v[152:153],v[64:65] op_sel_hi:[1,0]
ds_write2st64_b64 v36,v[128:129],v[144:145] offset0:26 offset1:28
v_pk_mul_f32 v[154:155],v[154:155],v[64:65] op_sel_hi:[1,0]
v_cvt_pk_bf16_f32 v136,v136,v137
v_cvt_pk_bf16_f32 v152,v152,v153
ds_read_b128 a[120:123],v0 offset:6272
v_mfma_f32_16x16x32_bf16 v[96:99],a[124:127],a[76:79],v[96:99]
s_cselect_b32 s41,166723584,s41
v_cvt_pk_bf16_f32 v137,v138,v139
v_cvt_pk_bf16_f32 v153,v154,v155
v_mfma_f32_16x16x32_bf16 v[96:99],a[128:131],a[80:83],v[96:99]
s_cselect_b32 s30,100663296,s30
ds_read_b128 a[124:127],v1 offset:6272
s_waitcnt lgkmcnt(5)
buffer_store_dwordx4 v[100:103],v9,s[16:19],s87 offen offset:256 nt
s_add_u32 s25,s30,s22
ds_read_b128 a[128:131],v0 offset:6400
s_add_u32 s26,s25,12288
v_mfma_f32_16x16x32_bf16 v[96:99],a[132:135],a[84:87],v[96:99]
s_add_u32 m0,s23,24576
ds_read_b128 a[132:135],v1 offset:6400
s_mov_b32 s28,s41
s_mov_b32 s29,s24
v_pk_mul_f32 v[140:141],v[140:141],v[64:65] op_sel_hi:[1,0]
ds_write2st64_b64 v37,v[132:133],v[148:149] offset0:26 offset1:28
v_pk_mul_f32 v[142:143],v[142:143],v[64:65] op_sel_hi:[1,0]
v_pk_mul_f32 v[156:157],v[156:157],v[64:65] op_sel_hi:[1,0]
v_pk_mul_f32 v[158:159],v[158:159],v[64:65] op_sel_hi:[1,0]
v_cvt_pk_bf16_f32 v140,v140,v141
v_cvt_pk_bf16_f32 v156,v156,v157
v_mfma_f32_16x16x32_bf16 v[96:99],a[136:139],a[88:91],v[96:99]
ds_read_b128 a[136:139],v0 offset:12288
buffer_store_dwordx4 v[208:211],v9,s[16:19],s87 offen offset:3328 nt
v_cvt_pk_bf16_f32 v141,v142,v143
v_cvt_pk_bf16_f32 v157,v158,v159
v_mov_b32 v64,0
v_mfma_f32_16x16x32_bf16 v[96:99],a[140:143],a[92:95],v[96:99]
ds_read_b128 a[140:143],v1 offset:12288
v_mfma_f32_16x16x32_bf16 v[76:79],a[144:147],a[0:3],0
ds_write2st64_b64 v38,v[136:137],v[152:153] offset0:26 offset1:28
v_pk_mul_f32 v[160:161],v[160:161],v[60:61] op_sel_hi:[1,0]
v_pk_mul_f32 v[162:163],v[162:163],v[60:61] op_sel_hi:[1,0]
v_pk_mul_f32 v[176:177],v[176:177],v[60:61] op_sel_hi:[1,0]
s_waitcnt lgkmcnt(3)
buffer_store_dwordx4 v[224:227],v9,s[16:19],s66 offen offset:256 nt
v_pk_mul_f32 v[178:179],v[178:179],v[60:61] op_sel_hi:[1,0]
v_max3_f32 v56,v96,v97,v98
v_cvt_pk_bf16_f32 v160,v160,v161
v_mfma_f32_16x16x32_bf16 v[76:79],a[148:151],a[4:7],v[76:79]
v_cvt_pk_bf16_f32 v176,v176,v177
v_cvt_pk_bf16_f32 v161,v162,v163
v_mfma_f32_16x16x32_bf16 v[76:79],a[120:123],a[8:11],v[76:79]
v_cvt_pk_bf16_f32 v177,v178,v179
v_mfma_f32_16x16x32_bf16 v[76:79],a[124:127],a[12:15],v[76:79]
ds_write2st64_b64 v39,v[140:141],v[156:157] offset0:26 offset1:28
v_mfma_f32_16x16x32_bf16 v[76:79],a[128:131],a[16:19],v[76:79]
buffer_store_dwordx4 v[240:243],v9,s[16:19],s66 offen offset:3328 nt
buffer_load_dwordx4 v6,s[8:11],s21 offen offset:0 lds
v_pk_mul_f32 v[164:165],v[164:165],v[60:61] op_sel_hi:[1,0]
v_pk_mul_f32 v[166:167],v[166:167],v[60:61] op_sel_hi:[1,0]
v_pk_mul_f32 v[180:181],v[180:181],v[60:61] op_sel_hi:[1,0]
v_pk_mul_f32 v[182:183],v[182:183],v[60:61] op_sel_hi:[1,0]
v_cvt_pk_bf16_f32 v164,v164,v165
v_cvt_pk_bf16_f32 v180,v180,v181
v_mfma_f32_16x16x32_bf16 v[76:79],a[132:135],a[20:23],v[76:79]
ds_write2st64_b64 v36,v[160:161],v[176:177] offset0:0 offset1:2
v_mfma_f32_16x16x32_bf16 v[84:87],a[132:135],a[44:47],0
v_cvt_pk_bf16_f32 v165,v166,v167
v_cvt_pk_bf16_f32 v181,v182,v183
v_mfma_f32_16x16x32_bf16 v[84:87],a[128:131],a[40:43],v[84:87]
v_pk_mul_f32 v[168:169],v[168:169],v[60:61] op_sel_hi:[1,0]
ds_write2st64_b64 v37,v[164:165],v[180:181] offset0:0 offset1:2
v_pk_mul_f32 v[170:171],v[170:171],v[60:61] op_sel_hi:[1,0]
v_pk_mul_f32 v[184:185],v[184:185],v[60:61] op_sel_hi:[1,0]
v_pk_mul_f32 v[186:187],v[186:187],v[60:61] op_sel_hi:[1,0]
v_max3_f32 v44,v44,v75,v76
v_max3_f32 v44,v44,v77,v78
v_mfma_f32_16x16x32_bf16 v[84:87],a[124:127],a[36:39],v[84:87]
buffer_load_dwordx4 v7,s[8:11],s21 offen offset:1024 lds
v_mfma_f32_16x16x32_bf16 v[84:87],a[120:123],a[32:35],v[84:87]
v_max_f32 v44,v44,v79
v_mov_b32 v45,v44
v_mfma_f32_16x16x32_bf16 v[84:87],a[148:151],a[28:31],v[84:87]
v_cvt_pk_bf16_f32 v168,v168,v169
v_permlane32_swap_b32 v45,v44
v_max_f32 v44,v44,v45
v_mov_b32 v45,v44
v_pk_mul_f32 v[172:173],v[172:173],v[60:61] op_sel_hi:[1,0]
v_pk_mul_f32 v[174:175],v[174:175],v[60:61] op_sel_hi:[1,0]
v_pk_mul_f32 v[188:189],v[188:189],v[60:61] op_sel_hi:[1,0]
v_pk_mul_f32 v[190:191],v[190:191],v[60:61] op_sel_hi:[1,0]
v_permlane16_swap_b32 v45,v44
v_max_f32 v44,v44,v45
v_mfma_f32_16x16x32_bf16 v[84:87],a[144:147],a[24:27],v[84:87]
v_mul_f32_e64 v13,-s36,v44
v_fma_f32 v72,v72,s36,v13
v_mfma_f32_16x16x32_bf16 v[92:95],a[144:147],a[48:51],0
buffer_load_dwordx4 v8,s[8:11],s21 offen offset:2048 lds
v_mfma_f32_16x16x32_bf16 v[92:95],a[148:151],a[52:55],v[92:95]
s_add_u32 s21,s21,12288
v_fma_f32 v73,v73,s36,v13
v_fma_f32 v74,v74,s36,v13
v_fma_f32 v75,v75,s36,v13
v_exp_f32 v72,v72
v_pk_mul_f32 v[192:193],v[192:193],v[60:61] op_sel_hi:[1,0]
v_pk_mul_f32 v[194:195],v[194:195],v[60:61] op_sel_hi:[1,0]
v_exp_f32 v73,v73
v_exp_f32 v74,v74
v_mfma_f32_16x16x32_bf16 v[92:95],a[120:123],a[56:59],v[92:95]
s_add_u32 m0,s22,0
v_exp_f32 v75,v75
v_mfma_f32_16x16x32_bf16 v[92:95],a[124:127],a[60:63],v[92:95]
v_cvt_pk_bf16_f32 v20,v72,v73
v_cvt_pk_bf16_f32 v21,v74,v75
v_mfma_f32_16x16x32_bf16 v[92:95],a[128:131],a[64:67],v[92:95]
v_max3_f32 v48,v48,v83,v84
v_max3_f32 v48,v48,v85,v86
v_mfma_f32_16x16x32_bf16 v[92:95],a[132:135],a[68:71],v[92:95]
v_max_f32 v48,v48,v87
v_mov_b32 v49,v48
v_fma_f32 v76,v76,s36,v13
v_fma_f32 v77,v77,s36,v13
v_permlane32_swap_b32 v49,v48
v_pk_mul_f32 v[196:197],v[196:197],v[60:61] op_sel_hi:[1,0]
v_pk_mul_f32 v[198:199],v[198:199],v[60:61] op_sel_hi:[1,0]
v_max_f32 v48,v48,v49
v_mov_b32 v49,v48
v_mfma_f32_16x16x32_bf16 v[100:103],a[132:135],a[92:95],0
ds_read_b128 a[132:135],v1 offset:18432
v_permlane16_swap_b32 v49,v48
v_mfma_f32_16x16x32_bf16 v[100:103],a[128:131],a[88:91],v[100:103]
ds_read_b128 a[128:131],v0 offset:18432
v_max_f32 v48,v48,v49
v_mfma_f32_16x16x32_bf16 v[100:103],a[124:127],a[84:87],v[100:103]
ds_read_b128 a[124:127],v1 offset:12544
v_mul_f32_e64 v14,-s36,v48
v_fma_f32 v80,v80,s36,v14
v_fma_f32 v81,v81,s36,v14
v_fma_f32 v82,v82,s36,v14
v_pk_mul_f32 v[200:201],v[200:201],v[60:61] op_sel_hi:[1,0]
v_pk_mul_f32 v[202:203],v[202:203],v[60:61] op_sel_hi:[1,0]
v_fma_f32 v83,v83,s36,v14
v_exp_f32 v80,v80
v_mfma_f32_16x16x32_bf16 v[100:103],a[120:123],a[80:83],v[100:103]
ds_read_b128 a[120:123],v0 offset:12544
v_exp_f32 v81,v81
v_mfma_f32_16x16x32_bf16 v[100:103],a[148:151],a[76:79],v[100:103]
ds_read_b128 a[148:151],v1 offset:12416
v_exp_f32 v82,v82
v_mfma_f32_16x16x32_bf16 v[100:103],a[144:147],a[72:75],v[100:103]
ds_read_b128 a[144:147],v0 offset:12416
v_exp_f32 v83,v83
v_cvt_pk_bf16_f32 v24,v80,v81
v_cvt_pk_bf16_f32 v25,v82,v83
v_pk_mul_f32 v[204:205],v[204:205],v[60:61] op_sel_hi:[1,0]
v_pk_mul_f32 v[206:207],v[206:207],v[60:61] op_sel_hi:[1,0]
v_max3_f32 v52,v52,v91,v92
v_max3_f32 v52,v52,v93,v94
s_waitcnt lgkmcnt(3)
v_mfma_f32_16x16x32_bf16 v[72:75],a[124:127],a[20:23],0
v_max_f32 v52,v52,v95
v_mov_b32 v53,v52
v_max3_f32 v56,v56,v99,v100
v_max3_f32 v56,v56,v101,v102
v_permlane32_swap_b32 v53,v52
v_max_f32 v52,v52,v53
v_mov_b32 v53,v52
v_max_f32 v56,v56,v103
s_waitcnt lgkmcnt(2)
v_mfma_f32_16x16x32_bf16 v[72:75],a[120:123],a[16:19],v[72:75]
s_waitcnt lgkmcnt(1)
v_permlane16_swap_b32 v53,v52
v_max_f32 v52,v52,v53
v_mfma_f32_16x16x32_bf16 v[72:75],a[148:151],a[12:15],v[72:75]
s_waitcnt lgkmcnt(0)
v_mul_f32_e64 v15,-s36,v52
v_fma_f32 v88,v88,s36,v15
v_fma_f32 v89,v89,s36,v15
v_mfma_f32_16x16x32_bf16 v[72:75],a[144:147],a[8:11],v[72:75]
v_fma_f32 v90,v90,s36,v15
v_fma_f32 v91,v91,s36,v15
v_mfma_f32_16x16x32_bf16 v[72:75],a[140:143],a[4:7],v[72:75]
v_exp_f32 v88,v88
v_mfma_f32_16x16x32_bf16 v[72:75],a[136:139],a[0:3],v[72:75]
v_exp_f32 v89,v89
v_mfma_f32_16x16x32_bf16 v[80:83],a[136:139],a[24:27],0
v_exp_f32 v90,v90
v_mfma_f32_16x16x32_bf16 v[80:83],a[140:143],a[28:31],v[80:83]
v_exp_f32 v91,v91
v_mfma_f32_16x16x32_bf16 v[80:83],a[144:147],a[32:35],v[80:83]
v_cvt_pk_bf16_f32 v28,v88,v89
v_cvt_pk_bf16_f32 v29,v90,v91
v_mfma_f32_16x16x32_bf16 v[80:83],a[148:151],a[36:39],v[80:83]
v_mov_b32 v57,v56
v_fma_f32 v78,v78,s36,v13
v_mfma_f32_16x16x32_bf16 v[80:83],a[120:123],a[40:43],v[80:83]
v_permlane32_swap_b32 v57,v56
v_mfma_f32_16x16x32_bf16 v[80:83],a[124:127],a[44:47],v[80:83]
v_max_f32 v56,v56,v57
v_mov_b32 v57,v56
v_mfma_f32_16x16x32_bf16 v[88:91],a[124:127],a[68:71],0
v_fma_f32 v79,v79,s36,v13
v_permlane16_swap_b32 v57,v56
v_mfma_f32_16x16x32_bf16 v[88:91],a[120:123],a[64:67],v[88:91]
v_max_f32 v56,v56,v57
v_mul_f32_e64 v16,-s36,v56
v_mfma_f32_16x16x32_bf16 v[88:91],a[148:151],a[60:63],v[88:91]
v_fma_f32 v96,v96,s36,v16
v_fma_f32 v97,v97,s36,v16
v_mfma_f32_16x16x32_bf16 v[88:91],a[144:147],a[56:59],v[88:91]
v_fma_f32 v98,v98,s36,v16
v_fma_f32 v99,v99,s36,v16
v_mfma_f32_16x16x32_bf16 v[88:91],a[140:143],a[52:55],v[88:91]
v_exp_f32 v96,v96
v_mfma_f32_16x16x32_bf16 v[88:91],a[136:139],a[48:51],v[88:91]
v_exp_f32 v97,v97
v_exp_f32 v98,v98
v_exp_f32 v99,v99
v_cvt_pk_bf16_f32 v32,v96,v97
v_cvt_pk_bf16_f32 v33,v98,v99
v_mfma_f32_16x16x32_bf16 v[96:99],a[136:139],a[72:75],0
ds_read_b128 a[136:139],v0 offset:18560
v_exp_f32 v76,v76
v_mfma_f32_16x16x32_bf16 v[96:99],a[140:143],a[76:79],v[96:99]
ds_read_b128 a[140:143],v1 offset:18560
v_exp_f32 v77,v77
v_mfma_f32_16x16x32_bf16 v[96:99],a[144:147],a[80:83],v[96:99]
ds_read_b128 a[144:147],v0 offset:18688
v_exp_f32 v78,v78
v_mfma_f32_16x16x32_bf16 v[96:99],a[148:151],a[84:87],v[96:99]
ds_read_b128 a[148:151],v1 offset:18688
v_exp_f32 v79,v79
v_mfma_f32_16x16x32_bf16 v[96:99],a[120:123],a[88:91],v[96:99]
v_cvt_pk_bf16_f32 v22,v76,v77
v_cvt_pk_bf16_f32 v23,v78,v79
v_mfma_f32_16x16x32_bf16 v[96:99],a[124:127],a[92:95],v[96:99]
v_fma_f32 v84,v84,s36,v14
v_fma_f32 v85,v85,s36,v14
v_mfma_f32_16x16x32_bf16 v[76:79],a[128:131],a[0:3],0
v_fma_f32 v86,v86,s36,v14
v_fma_f32 v87,v87,s36,v14
v_mfma_f32_16x16x32_bf16 v[76:79],a[132:135],a[4:7],v[76:79]
s_waitcnt lgkmcnt(3)
v_exp_f32 v84,v84
v_mfma_f32_16x16x32_bf16 v[76:79],a[136:139],a[8:11],v[76:79]
s_waitcnt lgkmcnt(2)
v_exp_f32 v85,v85
v_mfma_f32_16x16x32_bf16 v[76:79],a[140:143],a[12:15],v[76:79]
s_waitcnt vmcnt(11)
s_barrier
s_waitcnt lgkmcnt(0)
v_mfma_f32_16x16x32_bf16 v[76:79],a[144:147],a[16:19],v[76:79]
v_exp_f32 v86,v86
v_mfma_f32_16x16x32_bf16 v[76:79],a[148:151],a[20:23],v[76:79]
buffer_load_dwordx4 v6,s[4:7],s20 offen offset:0 lds
v_exp_f32 v87,v87
v_cvt_pk_bf16_f32 v26,v84,v85
v_cvt_pk_bf16_f32 v27,v86,v87
v_mfma_f32_16x16x32_bf16 v[84:87],a[148:151],a[44:47],0
v_fma_f32 v92,v92,s36,v15
v_fma_f32 v93,v93,s36,v15
v_mfma_f32_16x16x32_bf16 v[84:87],a[144:147],a[40:43],v[84:87]
v_fma_f32 v94,v94,s36,v15
v_fma_f32 v95,v95,s36,v15
v_mfma_f32_16x16x32_bf16 v[84:87],a[140:143],a[36:39],v[84:87]
v_exp_f32 v92,v92
v_mfma_f32_16x16x32_bf16 v[84:87],a[136:139],a[32:35],v[84:87]
buffer_load_dwordx4 v7,s[4:7],s20 offen offset:1024 lds
v_mfma_f32_16x16x32_bf16 v[84:87],a[132:135],a[28:31],v[84:87]
v_exp_f32 v93,v93
v_mfma_f32_16x16x32_bf16 v[84:87],a[128:131],a[24:27],v[84:87]
v_exp_f32 v94,v94
v_exp_f32 v95,v95
v_cvt_pk_bf16_f32 v30,v92,v93
ds_read_b64_tr_b16 a[120:121],v2 offset:0
ds_read_b64_tr_b16 a[122:123],v2 offset:6144
v_cvt_pk_bf16_f32 v31,v94,v95
v_mfma_f32_16x16x32_bf16 v[92:95],a[128:131],a[48:51],0
v_fma_f32 v100,v100,s36,v16
v_fma_f32 v101,v101,s36,v16
v_mfma_f32_16x16x32_bf16 v[92:95],a[132:135],a[52:55],v[92:95]
buffer_load_dwordx4 v8,s[4:7],s20 offen offset:2048 lds
v_mfma_f32_16x16x32_bf16 v[92:95],a[136:139],a[56:59],v[92:95]
s_add_u32 s20,s20,12288
ds_read_b64_tr_b16 a[124:125],v3 offset:0
v_fma_f32 v102,v102,s36,v16
v_mfma_f32_16x16x32_bf16 v[92:95],a[140:143],a[60:63],v[92:95]
ds_read_b64_tr_b16 a[126:127],v3 offset:6144
v_fma_f32 v103,v103,s36,v16
v_mfma_f32_16x16x32_bf16 v[92:95],a[144:147],a[64:67],v[92:95]
v_exp_f32 v100,v100
v_mfma_f32_16x16x32_bf16 v[92:95],a[148:151],a[68:71],v[92:95]
v_exp_f32 v101,v101
v_exp_f32 v102,v102
v_exp_f32 v103,v103
v_cvt_pk_bf16_f32 v34,v100,v101
v_cvt_pk_bf16_f32 v35,v102,v103
v_mfma_f32_16x16x32_bf16 v[100:103],a[148:151],a[92:95],0
v_cvt_pk_bf16_f32 v184,v184,v185
v_cvt_pk_bf16_f32 v169,v170,v171
v_smfmac_f32_16x16x64_bf16 v[64:67],a[152:155],v[28:35],v18
v_cvt_pk_bf16_f32 v172,v172,v173
v_mfma_f32_16x16x32_bf16 v[100:103],a[144:147],a[88:91],v[100:103]
v_cvt_pk_bf16_f32 v188,v188,v189
v_mov_b32 v60,0
v_mfma_f32_16x16x32_bf16 v[100:103],a[140:143],a[84:87],v[100:103]
v_cvt_pk_bf16_f32 v185,v186,v187
v_cvt_pk_bf16_f32 v192,v192,v193
v_smfmac_f32_16x16x64_bf16 v[60:63],a[152:155],v[20:27],v18
ds_write2st64_b64 v38,v[168:169],v[184:185] offset0:0 offset1:2
v_mfma_f32_16x16x32_bf16 v[100:103],a[136:139],a[80:83],v[100:103]
v_cvt_pk_bf16_f32 v173,v174,v175
v_cvt_pk_bf16_f32 v189,v190,v191
v_mfma_f32_16x16x32_bf16 v[100:103],a[132:135],a[76:79],v[100:103]
ds_read_b64_tr_b16 a[132:133],v5 offset:0
v_cvt_pk_bf16_f32 v196,v196,v197
v_mfma_f32_16x16x32_bf16 v[100:103],a[128:131],a[72:75],v[100:103]
ds_read_b64_tr_b16 a[128:129],v4 offset:0
ds_write2st64_b64 v39,v[172:173],v[188:189] offset0:0 offset1:2
v_fma_f32 v72,v72,s36,v13
v_fma_f32 v73,v73,s36,v13
v_fma_f32 v74,v74,s36,v13
ds_read_b64_tr_b16 a[130:131],v4 offset:6144
ds_read_b64_tr_b16 a[134:135],v5 offset:6144
v_fma_f32 v75,v75,s36,v13
v_fma_f32 v80,v80,s36,v14
v_fma_f32 v81,v81,s36,v14
v_cvt_pk_bf16_f32 v193,v194,v195
ds_write_b64 v36,v[192:193] offset:2048
v_cvt_pk_bf16_f32 v200,v200,v201
v_cvt_pk_bf16_f32 v197,v198,v199
v_exp_f32 v72,v72
ds_write_b64 v37,v[196:197] offset:2048
v_exp_f32 v73,v73
v_exp_f32 v74,v74
v_exp_f32 v75,v75
v_exp_f32 v80,v80
v_exp_f32 v81,v81
v_cvt_pk_bf16_f32 v204,v204,v205
v_cvt_pk_bf16_f32 v201,v202,v203
ds_write_b64 v38,v[200:201] offset:2048
v_cvt_pk_bf16_f32 v205,v206,v207
v_cvt_pk_bf16_f32 v44,v72,v73
v_cvt_pk_bf16_f32 v45,v74,v75
v_cvt_pk_bf16_f32 v48,v80,v81
ds_write_b64 v39,v[204:205] offset:2048
s_waitcnt lgkmcnt(3)
v_mfma_f32_16x16x32_bf16 v[160:163],a[120:123],v[20:23],0
s_add_u32 m0,s23,0
ds_read_b64_tr_b16 a[136:137],v2 offset:128
v_fma_f32 v82,v82,s36,v14
v_mfma_f32_16x16x32_bf16 v[164:167],a[124:127],v[20:23],0
ds_read_b64_tr_b16 a[138:139],v2 offset:6272
v_fma_f32 v83,v83,s36,v14
v_mfma_f32_16x16x32_bf16 v[212:215],a[124:127],v[24:27],0
ds_read_b64_tr_b16 a[140:141],v3 offset:128
v_fma_f32 v88,v88,s36,v15
v_mfma_f32_16x16x32_bf16 v[208:211],a[120:123],v[24:27],0
ds_read_b64_tr_b16 a[142:143],v3 offset:6272
v_fma_f32 v89,v89,s36,v15
v_mfma_f32_16x16x32_bf16 v[112:115],a[120:123],v[28:31],0
ds_read_b64_tr_b16 a[144:145],v4 offset:128
v_fma_f32 v90,v90,s36,v15
v_mfma_f32_16x16x32_bf16 v[116:119],a[124:127],v[28:31],0
ds_read_b64_tr_b16 a[146:147],v4 offset:6272
v_fma_f32 v91,v91,s36,v15
v_mfma_f32_16x16x32_bf16 a[164:167],a[124:127],v[32:35],0
ds_read_b64_tr_b16 a[148:149],v5 offset:128
v_fma_f32 v96,v96,s36,v16
v_mfma_f32_16x16x32_bf16 a[160:163],a[120:123],v[32:35],0
ds_read_b64_tr_b16 a[150:151],v5 offset:6272
v_fma_f32 v97,v97,s36,v16
v_mfma_f32_16x16x32_bf16 a[168:171],a[128:131],v[32:35],0
ds_read_b64_tr_b16 a[120:121],v2 offset:256
v_fma_f32 v98,v98,s36,v16
v_mfma_f32_16x16x32_bf16 a[172:175],a[132:135],v[32:35],0
ds_read_b64_tr_b16 a[122:123],v2 offset:6400
v_fma_f32 v99,v99,s36,v16
v_mfma_f32_16x16x32_bf16 v[124:127],a[132:135],v[28:31],0
ds_read_b64_tr_b16 a[124:125],v3 offset:256
v_fma_f32 v76,v76,s36,v13
v_mfma_f32_16x16x32_bf16 v[120:123],a[128:131],v[28:31],0
ds_read_b64_tr_b16 a[126:127],v3 offset:6400
v_fma_f32 v77,v77,s36,v13
v_mfma_f32_16x16x32_bf16 v[216:219],a[128:131],v[24:27],0
v_exp_f32 v82,v82
v_mfma_f32_16x16x32_bf16 v[220:223],a[132:135],v[24:27],0
v_exp_f32 v83,v83
v_mfma_f32_16x16x32_bf16 v[172:175],a[132:135],v[20:23],0
ds_read_b64_tr_b16 a[132:133],v5 offset:256
v_cvt_pk_bf16_f32 v49,v82,v83
v_mfma_f32_16x16x32_bf16 v[168:171],a[128:131],v[20:23],0
s_waitcnt lgkmcnt(4)
ds_read_b64_tr_b16 a[128:129],v4 offset:256
v_fma_f32 v78,v78,s36,v13
v_mfma_f32_16x16x32_bf16 v[176:179],a[136:139],v[20:23],0
ds_read_b64_tr_b16 a[130:131],v4 offset:6400
v_fma_f32 v79,v79,s36,v13
v_mfma_f32_16x16x32_bf16 v[180:183],a[140:143],v[20:23],0
ds_read_b64_tr_b16 a[134:135],v5 offset:6400
v_fma_f32 v84,v84,s36,v14
v_mfma_f32_16x16x32_bf16 v[228:231],a[140:143],v[24:27],0
v_exp_f32 v88,v88
v_mfma_f32_16x16x32_bf16 v[224:227],a[136:139],v[24:27],0
v_exp_f32 v89,v89
v_mfma_f32_16x16x32_bf16 v[128:131],a[136:139],v[28:31],0
v_exp_f32 v90,v90
v_mfma_f32_16x16x32_bf16 v[132:135],a[140:143],v[28:31],0
v_exp_f32 v91,v91
v_mfma_f32_16x16x32_bf16 a[180:183],a[140:143],v[32:35],0
v_cvt_pk_bf16_f32 v52,v88,v89
v_cvt_pk_bf16_f32 v53,v90,v91
v_mfma_f32_16x16x32_bf16 a[176:179],a[136:139],v[32:35],0
v_exp_f32 v96,v96
v_mfma_f32_16x16x32_bf16 a[184:187],a[144:147],v[32:35],0
v_exp_f32 v97,v97
v_mfma_f32_16x16x32_bf16 a[188:191],a[148:151],v[32:35],0
v_exp_f32 v98,v98
v_mfma_f32_16x16x32_bf16 v[140:143],a[148:151],v[28:31],0
v_exp_f32 v99,v99
v_mfma_f32_16x16x32_bf16 v[136:139],a[144:147],v[28:31],0
v_cvt_pk_bf16_f32 v56,v96,v97
v_cvt_pk_bf16_f32 v57,v98,v99
v_mfma_f32_16x16x32_bf16 v[232:235],a[144:147],v[24:27],0
v_exp_f32 v76,v76
v_mfma_f32_16x16x32_bf16 v[236:239],a[148:151],v[24:27],0
v_exp_f32 v77,v77
v_mfma_f32_16x16x32_bf16 v[188:191],a[148:151],v[20:23],0
v_exp_f32 v78,v78
v_mfma_f32_16x16x32_bf16 v[184:187],a[144:147],v[20:23],0
s_waitcnt lgkmcnt(0)
v_exp_f32 v79,v79
v_mfma_f32_16x16x32_bf16 v[192:195],a[120:123],v[20:23],0
s_waitcnt vmcnt(30)
v_cvt_pk_bf16_f32 v46,v76,v77
v_cvt_pk_bf16_f32 v47,v78,v79
v_mfma_f32_16x16x32_bf16 v[196:199],a[124:127],v[20:23],0
s_barrier
v_mfma_f32_16x16x32_bf16 v[244:247],a[124:127],v[24:27],0
ds_read_b128 a[148:151],v1 offset:24704
v_fma_f32 v85,v85,s36,v14
v_mfma_f32_16x16x32_bf16 v[240:243],a[120:123],v[24:27],0
ds_read_b128 a[144:147],v0 offset:24704
v_fma_f32 v86,v86,s36,v14
v_mfma_f32_16x16x32_bf16 v[144:147],a[120:123],v[28:31],0
ds_read_b128 a[140:143],v1 offset:24576
v_fma_f32 v87,v87,s36,v14
v_mfma_f32_16x16x32_bf16 v[148:151],a[124:127],v[28:31],0
ds_read_b128 a[136:139],v0 offset:24576
v_fma_f32 v92,v92,s36,v15
v_mfma_f32_16x16x32_bf16 a[196:199],a[124:127],v[32:35],0
ds_read_b128 a[124:127],v1 offset:24832
v_fma_f32 v93,v93,s36,v15
v_mfma_f32_16x16x32_bf16 a[192:195],a[120:123],v[32:35],0
buffer_load_dwordx4 v6,s[8:11],s21 offen offset:0 lds
v_mfma_f32_16x16x32_bf16 a[200:203],a[128:131],v[32:35],0
ds_read_b128 a[120:123],v0 offset:24832
v_fma_f32 v94,v94,s36,v15
v_mfma_f32_16x16x32_bf16 a[204:207],a[132:135],v[32:35],0
v_exp_f32 v84,v84
v_mfma_f32_16x16x32_bf16 v[156:159],a[132:135],v[28:31],0
v_exp_f32 v85,v85
v_mfma_f32_16x16x32_bf16 v[152:155],a[128:131],v[28:31],0
v_exp_f32 v86,v86
v_mfma_f32_16x16x32_bf16 v[248:251],a[128:131],v[24:27],0
v_exp_f32 v87,v87
v_mfma_f32_16x16x32_bf16 v[252:255],a[132:135],v[24:27],0
v_cvt_pk_bf16_f32 v50,v84,v85
v_cvt_pk_bf16_f32 v51,v86,v87
v_mfma_f32_16x16x32_bf16 v[204:207],a[132:135],v[20:23],0
ds_read_b128 a[132:135],v1 offset:30720
v_fma_f32 v95,v95,s36,v15
v_smfmac_f32_16x16x64_bf16 v[60:63],a[152:155],v[44:51],v18
v_fma_f32 v100,v100,s36,v16
v_mfma_f32_16x16x32_bf16 v[200:203],a[128:131],v[20:23],0
buffer_load_dwordx4 v7,s[8:11],s21 offen offset:1024 lds
s_waitcnt lgkmcnt(1)
v_mfma_f32_16x16x32_bf16 v[72:75],a[124:127],a[20:23],0
ds_read_b128 a[128:131],v0 offset:30720
v_fma_f32 v101,v101,s36,v16
v_mfma_f32_16x16x32_bf16 v[72:75],a[120:123],a[16:19],v[72:75]
v_exp_f32 v92,v92
v_mfma_f32_16x16x32_bf16 v[72:75],a[148:151],a[12:15],v[72:75]
v_exp_f32 v93,v93
v_mfma_f32_16x16x32_bf16 v[72:75],a[144:147],a[8:11],v[72:75]
v_exp_f32 v94,v94
v_mfma_f32_16x16x32_bf16 v[72:75],a[140:143],a[4:7],v[72:75]
v_exp_f32 v95,v95
v_mfma_f32_16x16x32_bf16 v[72:75],a[136:139],a[0:3],v[72:75]
v_cvt_pk_bf16_f32 v54,v92,v93
v_cvt_pk_bf16_f32 v55,v94,v95
v_mfma_f32_16x16x32_bf16 v[80:83],a[136:139],a[24:27],0
v_fma_f32 v102,v102,s36,v16
v_fma_f32 v103,v103,s36,v16
v_mfma_f32_16x16x32_bf16 v[80:83],a[140:143],a[28:31],v[80:83]
v_exp_f32 v100,v100
v_mfma_f32_16x16x32_bf16 v[80:83],a[144:147],a[32:35],v[80:83]
buffer_load_dwordx4 v8,s[8:11],s21 offen offset:2048 lds
v_mfma_f32_16x16x32_bf16 v[80:83],a[148:151],a[36:39],v[80:83]
s_add_u32 s21,s21,12288
v_exp_f32 v101,v101
v_mfma_f32_16x16x32_bf16 v[80:83],a[120:123],a[40:43],v[80:83]
s_add_u32 m0,s22,12288
v_exp_f32 v102,v102
v_mfma_f32_16x16x32_bf16 v[80:83],a[124:127],a[44:47],v[80:83]
v_exp_f32 v103,v103
v_mfma_f32_16x16x32_bf16 v[88:91],a[124:127],a[68:71],0
v_cvt_pk_bf16_f32 v58,v100,v101
v_cvt_pk_bf16_f32 v59,v102,v103
v_mfma_f32_16x16x32_bf16 v[88:91],a[120:123],a[64:67],v[88:91]
v_fma_f32 v72,v72,s36,v13
v_fma_f32 v73,v73,s36,v13
v_smfmac_f32_16x16x64_bf16 v[64:67],a[152:155],v[52:59],v18
v_fma_f32 v74,v74,s36,v13
v_mfma_f32_16x16x32_bf16 v[88:91],a[148:151],a[60:63],v[88:91]
v_fma_f32 v75,v75,s36,v13
v_fma_f32 v80,v80,s36,v14
v_mfma_f32_16x16x32_bf16 v[88:91],a[144:147],a[56:59],v[88:91]
v_fma_f32 v81,v81,s36,v14
v_mfma_f32_16x16x32_bf16 v[88:91],a[140:143],a[52:55],v[88:91]
buffer_load_dwordx4 v6,s[4:7],s20 offen offset:0 lds
v_mfma_f32_16x16x32_bf16 v[88:91],a[136:139],a[48:51],v[88:91]
v_exp_f32 v72,v72
v_mfma_f32_16x16x32_bf16 v[96:99],a[136:139],a[72:75],0
ds_read_b128 a[136:139],v0 offset:30848
v_mfma_f32_16x16x32_bf16 v[96:99],a[140:143],a[76:79],v[96:99]
ds_read_b128 a[140:143],v1 offset:30848
v_mfma_f32_16x16x32_bf16 v[96:99],a[144:147],a[80:83],v[96:99]
ds_read_b128 a[144:147],v0 offset:30976
v_mfma_f32_16x16x32_bf16 v[96:99],a[148:151],a[84:87],v[96:99]
ds_read_b128 a[148:151],v1 offset:30976
v_mfma_f32_16x16x32_bf16 v[96:99],a[120:123],a[88:91],v[96:99]
v_exp_f32 v73,v73
v_mfma_f32_16x16x32_bf16 v[96:99],a[124:127],a[92:95],v[96:99]
s_waitcnt lgkmcnt(4)
v_exp_f32 v74,v74
v_mfma_f32_16x16x32_bf16 v[76:79],a[128:131],a[0:3],0
v_exp_f32 v75,v75
v_mfma_f32_16x16x32_bf16 v[76:79],a[132:135],a[4:7],v[76:79]
buffer_load_dwordx4 v7,s[4:7],s20 offen offset:1024 lds
s_waitcnt lgkmcnt(3)
v_mfma_f32_16x16x32_bf16 v[76:79],a[136:139],a[8:11],v[76:79]
s_waitcnt lgkmcnt(2)
v_exp_f32 v80,v80
v_mfma_f32_16x16x32_bf16 v[76:79],a[140:143],a[12:15],v[76:79]
s_waitcnt lgkmcnt(0)
v_exp_f32 v81,v81
v_mfma_f32_16x16x32_bf16 v[76:79],a[144:147],a[16:19],v[76:79]
v_cvt_pk_bf16_f32 v20,v72,v73
v_cvt_pk_bf16_f32 v21,v74,v75
v_mfma_f32_16x16x32_bf16 v[76:79],a[148:151],a[20:23],v[76:79]
v_cvt_pk_bf16_f32 v24,v80,v81
v_mfma_f32_16x16x32_bf16 v[84:87],a[148:151],a[44:47],0
v_mfma_f32_16x16x32_bf16 v[84:87],a[144:147],a[40:43],v[84:87]
v_mfma_f32_16x16x32_bf16 v[84:87],a[140:143],a[36:39],v[84:87]
v_mfma_f32_16x16x32_bf16 v[84:87],a[136:139],a[32:35],v[84:87]
v_mfma_f32_16x16x32_bf16 v[84:87],a[132:135],a[28:31],v[84:87]
buffer_load_dwordx4 v8,s[4:7],s20 offen offset:2048 lds
v_mfma_f32_16x16x32_bf16 v[84:87],a[128:131],a[24:27],v[84:87]
s_add_u32 s20,s20,12288
v_mfma_f32_16x16x32_bf16 v[92:95],a[128:131],a[48:51],0
ds_read_b64_tr_b16 a[120:121],v2 offset:12288
v_mfma_f32_16x16x32_bf16 v[92:95],a[132:135],a[52:55],v[92:95]
ds_read_b64_tr_b16 a[122:123],v2 offset:18432
v_mfma_f32_16x16x32_bf16 v[92:95],a[136:139],a[56:59],v[92:95]
ds_read_b64_tr_b16 a[124:125],v3 offset:12288
v_mfma_f32_16x16x32_bf16 v[92:95],a[140:143],a[60:63],v[92:95]
ds_read_b64_tr_b16 a[126:127],v3 offset:18432
v_mfma_f32_16x16x32_bf16 v[92:95],a[144:147],a[64:67],v[92:95]
v_mfma_f32_16x16x32_bf16 v[92:95],a[148:151],a[68:71],v[92:95]
v_mfma_f32_16x16x32_bf16 v[100:103],a[148:151],a[92:95],0
v_mfma_f32_16x16x32_bf16 v[100:103],a[144:147],a[88:91],v[100:103]
v_mfma_f32_16x16x32_bf16 v[100:103],a[140:143],a[84:87],v[100:103]
v_mfma_f32_16x16x32_bf16 v[100:103],a[136:139],a[80:83],v[100:103]
v_mfma_f32_16x16x32_bf16 v[100:103],a[132:135],a[76:79],v[100:103]
ds_read_b64_tr_b16 a[132:133],v5 offset:12288
v_mfma_f32_16x16x32_bf16 v[100:103],a[128:131],a[72:75],v[100:103]
s_waitcnt lgkmcnt(1)
ds_read_b64_tr_b16 a[128:129],v4 offset:12288
ds_read_b64_tr_b16 a[130:131],v4 offset:18432
ds_read_b64_tr_b16 a[134:135],v5 offset:18432
v_mfma_f32_16x16x32_bf16 v[160:163],a[120:123],v[44:47],v[160:163]
s_add_u32 m0,s23,12288
ds_read_b64_tr_b16 a[136:137],v2 offset:12416
v_fma_f32 v82,v82,s36,v14
v_mfma_f32_16x16x32_bf16 v[164:167],a[124:127],v[44:47],v[164:167]
ds_read_b64_tr_b16 a[138:139],v2 offset:18560
v_fma_f32 v83,v83,s36,v14
v_mfma_f32_16x16x32_bf16 v[212:215],a[124:127],v[48:51],v[212:215]
ds_read_b64_tr_b16 a[140:141],v3 offset:12416
v_fma_f32 v88,v88,s36,v15
v_mfma_f32_16x16x32_bf16 v[208:211],a[120:123],v[48:51],v[208:211]
ds_read_b64_tr_b16 a[142:143],v3 offset:18560
v_fma_f32 v89,v89,s36,v15
v_mfma_f32_16x16x32_bf16 v[112:115],a[120:123],v[52:55],v[112:115]
ds_read_b64_tr_b16 a[144:145],v4 offset:12416
v_fma_f32 v90,v90,s36,v15
v_mfma_f32_16x16x32_bf16 v[116:119],a[124:127],v[52:55],v[116:119]
ds_read_b64_tr_b16 a[146:147],v4 offset:18560
v_fma_f32 v91,v91,s36,v15
v_mfma_f32_16x16x32_bf16 a[164:167],a[124:127],v[56:59],a[164:167]
ds_read_b64_tr_b16 a[148:149],v5 offset:12416
v_fma_f32 v96,v96,s36,v16
v_mfma_f32_16x16x32_bf16 a[160:163],a[120:123],v[56:59],a[160:163]
s_waitcnt lgkmcnt(6)
ds_read_b64_tr_b16 a[150:151],v5 offset:18560
v_fma_f32 v97,v97,s36,v16
v_mfma_f32_16x16x32_bf16 a[168:171],a[128:131],v[56:59],a[168:171]
ds_read_b64_tr_b16 a[120:121],v2 offset:12544
v_fma_f32 v98,v98,s36,v16
v_mfma_f32_16x16x32_bf16 a[172:175],a[132:135],v[56:59],a[172:175]
ds_read_b64_tr_b16 a[122:123],v2 offset:18688
v_fma_f32 v99,v99,s36,v16
v_mfma_f32_16x16x32_bf16 v[124:127],a[132:135],v[52:55],v[124:127]
ds_read_b64_tr_b16 a[124:125],v3 offset:12544
v_fma_f32 v76,v76,s36,v13
v_mfma_f32_16x16x32_bf16 v[120:123],a[128:131],v[52:55],v[120:123]
ds_read_b64_tr_b16 a[126:127],v3 offset:18688
v_fma_f32 v77,v77,s36,v13
v_mfma_f32_16x16x32_bf16 v[216:219],a[128:131],v[48:51],v[216:219]
v_exp_f32 v82,v82
v_mfma_f32_16x16x32_bf16 v[220:223],a[132:135],v[48:51],v[220:223]
v_exp_f32 v83,v83
v_mfma_f32_16x16x32_bf16 v[172:175],a[132:135],v[44:47],v[172:175]
ds_read_b64_tr_b16 a[132:133],v5 offset:12544
v_cvt_pk_bf16_f32 v25,v82,v83
v_mfma_f32_16x16x32_bf16 v[168:171],a[128:131],v[44:47],v[168:171]
s_waitcnt lgkmcnt(4)
ds_read_b64_tr_b16 a[128:129],v4 offset:12544
v_fma_f32 v78,v78,s36,v13
v_mfma_f32_16x16x32_bf16 v[176:179],a[136:139],v[44:47],v[176:179]
ds_read_b64_tr_b16 a[130:131],v4 offset:18688
v_fma_f32 v79,v79,s36,v13
v_mfma_f32_16x16x32_bf16 v[180:183],a[140:143],v[44:47],v[180:183]
ds_read_b64_tr_b16 a[134:135],v5 offset:18688
v_fma_f32 v84,v84,s36,v14
v_mfma_f32_16x16x32_bf16 v[228:231],a[140:143],v[48:51],v[228:231]
v_exp_f32 v88,v88
v_mfma_f32_16x16x32_bf16 v[224:227],a[136:139],v[48:51],v[224:227]
v_exp_f32 v89,v89
v_mfma_f32_16x16x32_bf16 v[128:131],a[136:139],v[52:55],v[128:131]
v_exp_f32 v90,v90
v_mfma_f32_16x16x32_bf16 v[132:135],a[140:143],v[52:55],v[132:135]
v_exp_f32 v91,v91
v_mfma_f32_16x16x32_bf16 a[180:183],a[140:143],v[56:59],a[180:183]
v_cvt_pk_bf16_f32 v28,v88,v89
v_cvt_pk_bf16_f32 v29,v90,v91
v_mfma_f32_16x16x32_bf16 a[176:179],a[136:139],v[56:59],a[176:179]
v_exp_f32 v96,v96
v_mfma_f32_16x16x32_bf16 a[184:187],a[144:147],v[56:59],a[184:187]
v_exp_f32 v97,v97
v_mfma_f32_16x16x32_bf16 a[188:191],a[148:151],v[56:59],a[188:191]
v_exp_f32 v98,v98
v_mfma_f32_16x16x32_bf16 v[140:143],a[148:151],v[52:55],v[140:143]
v_exp_f32 v99,v99
v_mfma_f32_16x16x32_bf16 v[136:139],a[144:147],v[52:55],v[136:139]
v_cvt_pk_bf16_f32 v32,v96,v97
v_cvt_pk_bf16_f32 v33,v98,v99
v_mfma_f32_16x16x32_bf16 v[232:235],a[144:147],v[48:51],v[232:235]
v_exp_f32 v76,v76
v_mfma_f32_16x16x32_bf16 v[236:239],a[148:151],v[48:51],v[236:239]
v_exp_f32 v77,v77
v_mfma_f32_16x16x32_bf16 v[188:191],a[148:151],v[44:47],v[188:191]
v_exp_f32 v78,v78
v_mfma_f32_16x16x32_bf16 v[184:187],a[144:147],v[44:47],v[184:187]
s_waitcnt lgkmcnt(0)
v_exp_f32 v79,v79
v_mfma_f32_16x16x32_bf16 v[192:195],a[120:123],v[44:47],v[192:195]
s_waitcnt vmcnt(6)
v_cvt_pk_bf16_f32 v22,v76,v77
v_cvt_pk_bf16_f32 v23,v78,v79
v_mfma_f32_16x16x32_bf16 v[196:199],a[124:127],v[44:47],v[196:199]
s_barrier
v_mfma_f32_16x16x32_bf16 v[244:247],a[124:127],v[48:51],v[244:247]
ds_read_b128 a[148:151],v1 offset:128
v_fma_f32 v85,v85,s36,v14
v_mfma_f32_16x16x32_bf16 v[240:243],a[120:123],v[48:51],v[240:243]
ds_read_b128 a[144:147],v0 offset:128
v_fma_f32 v86,v86,s36,v14
v_mfma_f32_16x16x32_bf16 v[144:147],a[120:123],v[52:55],v[144:147]
ds_read_b128 a[140:143],v1 offset:0
v_fma_f32 v87,v87,s36,v14
v_mfma_f32_16x16x32_bf16 v[148:151],a[124:127],v[52:55],v[148:151]
ds_read_b128 a[136:139],v0 offset:0
v_fma_f32 v92,v92,s36,v15
v_mfma_f32_16x16x32_bf16 a[196:199],a[124:127],v[56:59],a[196:199]
ds_read_b128 a[124:127],v1 offset:256
v_fma_f32 v93,v93,s36,v15
v_mfma_f32_16x16x32_bf16 a[192:195],a[120:123],v[56:59],a[192:195]
buffer_load_dwordx4 v6,s[8:11],s21 offen offset:0 lds
v_mfma_f32_16x16x32_bf16 a[200:203],a[128:131],v[56:59],a[200:203]
ds_read_b128 a[120:123],v0 offset:256
v_fma_f32 v94,v94,s36,v15
v_mfma_f32_16x16x32_bf16 a[204:207],a[132:135],v[56:59],a[204:207]
v_exp_f32 v84,v84
v_mfma_f32_16x16x32_bf16 v[156:159],a[132:135],v[52:55],v[156:159]
v_exp_f32 v85,v85
v_mfma_f32_16x16x32_bf16 v[152:155],a[128:131],v[52:55],v[152:155]
v_exp_f32 v86,v86
v_mfma_f32_16x16x32_bf16 v[248:251],a[128:131],v[48:51],v[248:251]
v_exp_f32 v87,v87
v_mfma_f32_16x16x32_bf16 v[252:255],a[132:135],v[48:51],v[252:255]
v_cvt_pk_bf16_f32 v26,v84,v85
v_cvt_pk_bf16_f32 v27,v86,v87
v_mfma_f32_16x16x32_bf16 v[204:207],a[132:135],v[44:47],v[204:207]
ds_read_b128 a[132:135],v1 offset:6144
v_fma_f32 v95,v95,s36,v15
v_smfmac_f32_16x16x64_bf16 v[60:63],a[152:155],v[20:27],v18
v_fma_f32 v100,v100,s36,v16
v_mfma_f32_16x16x32_bf16 v[200:203],a[128:131],v[44:47],v[200:203]
buffer_load_dwordx4 v7,s[8:11],s21 offen offset:1024 lds
s_waitcnt lgkmcnt(1)
v_mfma_f32_16x16x32_bf16 v[72:75],a[124:127],a[20:23],0
ds_read_b128 a[128:131],v0 offset:6144
v_fma_f32 v101,v101,s36,v16
v_mfma_f32_16x16x32_bf16 v[72:75],a[120:123],a[16:19],v[72:75]
v_exp_f32 v92,v92
v_mfma_f32_16x16x32_bf16 v[72:75],a[148:151],a[12:15],v[72:75]
v_exp_f32 v93,v93
v_mfma_f32_16x16x32_bf16 v[72:75],a[144:147],a[8:11],v[72:75]
v_exp_f32 v94,v94
v_mfma_f32_16x16x32_bf16 v[72:75],a[140:143],a[4:7],v[72:75]
v_exp_f32 v95,v95
v_mfma_f32_16x16x32_bf16 v[72:75],a[136:139],a[0:3],v[72:75]
v_cvt_pk_bf16_f32 v30,v92,v93
v_cvt_pk_bf16_f32 v31,v94,v95
v_mfma_f32_16x16x32_bf16 v[80:83],a[136:139],a[24:27],0
v_fma_f32 v102,v102,s36,v16
v_fma_f32 v103,v103,s36,v16
v_mfma_f32_16x16x32_bf16 v[80:83],a[140:143],a[28:31],v[80:83]
v_exp_f32 v100,v100
v_mfma_f32_16x16x32_bf16 v[80:83],a[144:147],a[32:35],v[80:83]
buffer_load_dwordx4 v8,s[8:11],s21 offen offset:2048 lds
v_mfma_f32_16x16x32_bf16 v[80:83],a[148:151],a[36:39],v[80:83]
s_add_u32 s21,s21,12288
v_exp_f32 v101,v101
v_mfma_f32_16x16x32_bf16 v[80:83],a[120:123],a[40:43],v[80:83]
s_add_u32 m0,s22,24576
v_exp_f32 v102,v102
v_mfma_f32_16x16x32_bf16 v[80:83],a[124:127],a[44:47],v[80:83]
v_exp_f32 v103,v103
v_mfma_f32_16x16x32_bf16 v[88:91],a[124:127],a[68:71],0
v_cvt_pk_bf16_f32 v34,v100,v101
v_cvt_pk_bf16_f32 v35,v102,v103
v_mfma_f32_16x16x32_bf16 v[88:91],a[120:123],a[64:67],v[88:91]
v_fma_f32 v72,v72,s36,v13
v_fma_f32 v73,v73,s36,v13
v_smfmac_f32_16x16x64_bf16 v[64:67],a[152:155],v[28:35],v18
v_fma_f32 v74,v74,s36,v13
v_mfma_f32_16x16x32_bf16 v[88:91],a[148:151],a[60:63],v[88:91]
v_fma_f32 v75,v75,s36,v13
v_fma_f32 v80,v80,s36,v14
v_mfma_f32_16x16x32_bf16 v[88:91],a[144:147],a[56:59],v[88:91]
v_fma_f32 v81,v81,s36,v14
v_mfma_f32_16x16x32_bf16 v[88:91],a[140:143],a[52:55],v[88:91]
buffer_load_dwordx4 v6,s[4:7],s20 offen offset:0 lds
v_mfma_f32_16x16x32_bf16 v[88:91],a[136:139],a[48:51],v[88:91]
v_exp_f32 v72,v72
v_mfma_f32_16x16x32_bf16 v[96:99],a[136:139],a[72:75],0
ds_read_b128 a[136:139],v0 offset:6272
v_mfma_f32_16x16x32_bf16 v[96:99],a[140:143],a[76:79],v[96:99]
ds_read_b128 a[140:143],v1 offset:6272
v_mfma_f32_16x16x32_bf16 v[96:99],a[144:147],a[80:83],v[96:99]
ds_read_b128 a[144:147],v0 offset:6400
v_mfma_f32_16x16x32_bf16 v[96:99],a[148:151],a[84:87],v[96:99]
ds_read_b128 a[148:151],v1 offset:6400
v_mfma_f32_16x16x32_bf16 v[96:99],a[120:123],a[88:91],v[96:99]
v_exp_f32 v73,v73
v_mfma_f32_16x16x32_bf16 v[96:99],a[124:127],a[92:95],v[96:99]
s_waitcnt lgkmcnt(4)
v_exp_f32 v74,v74
v_mfma_f32_16x16x32_bf16 v[76:79],a[128:131],a[0:3],0
v_exp_f32 v75,v75
v_mfma_f32_16x16x32_bf16 v[76:79],a[132:135],a[4:7],v[76:79]
buffer_load_dwordx4 v7,s[4:7],s20 offen offset:1024 lds
s_waitcnt lgkmcnt(3)
v_mfma_f32_16x16x32_bf16 v[76:79],a[136:139],a[8:11],v[76:79]
s_waitcnt lgkmcnt(2)
v_exp_f32 v80,v80
v_mfma_f32_16x16x32_bf16 v[76:79],a[140:143],a[12:15],v[76:79]
s_waitcnt lgkmcnt(0)
v_exp_f32 v81,v81
v_mfma_f32_16x16x32_bf16 v[76:79],a[144:147],a[16:19],v[76:79]
v_cvt_pk_bf16_f32 v44,v72,v73
v_cvt_pk_bf16_f32 v45,v74,v75
v_mfma_f32_16x16x32_bf16 v[76:79],a[148:151],a[20:23],v[76:79]
v_cvt_pk_bf16_f32 v48,v80,v81
v_mfma_f32_16x16x32_bf16 v[84:87],a[148:151],a[44:47],0
v_mfma_f32_16x16x32_bf16 v[84:87],a[144:147],a[40:43],v[84:87]
v_mfma_f32_16x16x32_bf16 v[84:87],a[140:143],a[36:39],v[84:87]
v_mfma_f32_16x16x32_bf16 v[84:87],a[136:139],a[32:35],v[84:87]
v_mfma_f32_16x16x32_bf16 v[84:87],a[132:135],a[28:31],v[84:87]
buffer_load_dwordx4 v8,s[4:7],s20 offen offset:2048 lds
v_mfma_f32_16x16x32_bf16 v[84:87],a[128:131],a[24:27],v[84:87]
s_add_u32 s20,s20,12288
v_mfma_f32_16x16x32_bf16 v[92:95],a[128:131],a[48:51],0
ds_read_b64_tr_b16 a[120:121],v2 offset:24576
v_mfma_f32_16x16x32_bf16 v[92:95],a[132:135],a[52:55],v[92:95]
ds_read_b64_tr_b16 a[122:123],v2 offset:30720
v_mfma_f32_16x16x32_bf16 v[92:95],a[136:139],a[56:59],v[92:95]
ds_read_b64_tr_b16 a[124:125],v3 offset:24576
v_mfma_f32_16x16x32_bf16 v[92:95],a[140:143],a[60:63],v[92:95]
ds_read_b64_tr_b16 a[126:127],v3 offset:30720
v_mfma_f32_16x16x32_bf16 v[92:95],a[144:147],a[64:67],v[92:95]
v_mfma_f32_16x16x32_bf16 v[92:95],a[148:151],a[68:71],v[92:95]
v_mfma_f32_16x16x32_bf16 v[100:103],a[148:151],a[92:95],0
v_mfma_f32_16x16x32_bf16 v[100:103],a[144:147],a[88:91],v[100:103]
v_mfma_f32_16x16x32_bf16 v[100:103],a[140:143],a[84:87],v[100:103]
v_mfma_f32_16x16x32_bf16 v[100:103],a[136:139],a[80:83],v[100:103]
v_mfma_f32_16x16x32_bf16 v[100:103],a[132:135],a[76:79],v[100:103]
ds_read_b64_tr_b16 a[132:133],v5 offset:24576
v_mfma_f32_16x16x32_bf16 v[100:103],a[128:131],a[72:75],v[100:103]
ds_read_b64_tr_b16 a[128:129],v4 offset:24576
ds_read_b64_tr_b16 a[130:131],v4 offset:30720
ds_read_b64_tr_b16 a[134:135],v5 offset:30720
s_mov_b32 s38,0
s_branch L_loop4
L_tr55:
s_waitcnt vmcnt(43)
s_waitcnt lgkmcnt(3)
v_mfma_f32_16x16x32_bf16 v[160:163],a[120:123],v[20:23],v[160:163]
s_add_u32 m0,s24,0
ds_read_b128 a[12:15],v12 offset:128
v_fma_f32 v101,v101,s36,v16
v_mfma_f32_16x16x32_bf16 v[164:167],a[124:127],v[20:23],v[164:167]
ds_read_b128 a[20:23],v12 offset:256
v_fma_f32 v103,v103,s36,v16
v_mfma_f32_16x16x32_bf16 v[212:215],a[124:127],v[24:27],v[212:215]
ds_read_b128 a[4:7],v12 offset:0
v_fma_f32 v87,v87,s36,v14
v_mfma_f32_16x16x32_bf16 v[208:211],a[120:123],v[24:27],v[208:211]
ds_read_b128 a[16:19],v11 offset:256
v_fma_f32 v106,v106,s36,v17
v_mfma_f32_16x16x32_bf16 v[112:115],a[120:123],v[28:31],v[112:115]
ds_read_b128 a[0:3],v11 offset:0
v_fma_f32 v99,v99,s36,v16
v_mfma_f32_16x16x32_bf16 v[116:119],a[124:127],v[28:31],v[116:119]
ds_read_b128 a[8:11],v11 offset:128
v_fma_f32 v96,v96,s36,v16
v_mfma_f32_16x16x32_bf16 a[164:167],a[124:127],v[32:35],a[164:167]
ds_read_b64_tr_b16 a[136:137],v2 offset:24704
v_fma_f32 v77,v77,s36,v13
v_mfma_f32_16x16x32_bf16 a[160:163],a[120:123],v[32:35],a[160:163]
ds_read_b64_tr_b16 a[138:139],v2 offset:30848
v_fma_f32 v85,v85,s36,v14
v_mfma_f32_16x16x32_bf16 a[208:211],a[120:123],v[36:39],a[208:211]
ds_read_b64_tr_b16 a[140:141],v3 offset:24704
ds_read_b64_tr_b16 a[142:143],v3 offset:30848
ds_read_b64_tr_b16 a[144:145],v4 offset:24704
ds_read_b64_tr_b16 a[146:147],v4 offset:30848
ds_read_b64_tr_b16 a[150:151],v5 offset:30848
ds_read_b64_tr_b16 a[148:149],v5 offset:24704
ds_read_b128 a[40:43],v11 offset:6400
v_mfma_f32_16x16x32_bf16 a[212:215],a[124:127],v[36:39],a[212:215]
s_waitcnt lgkmcnt(11)
v_fma_f32 v84,v84,s36,v14
ds_read_b128 a[32:35],v11 offset:6272
v_mfma_f32_16x16x32_bf16 a[216:219],a[128:131],v[36:39],a[216:219]
s_waitcnt lgkmcnt(10)
buffer_load_dwordx4 v6,s[12:15],s28 offen offset:0 nt lds
v_mfma_f32_16x16x32_bf16 a[220:223],a[132:135],v[36:39],a[220:223]
ds_read_b64_tr_b16 a[122:123],v2 offset:30976
ds_read_b128 a[44:47],v12 offset:6400
v_mfma_f32_16x16x32_bf16 a[172:175],a[132:135],v[32:35],a[172:175]
v_exp_f32 v101,v101
ds_read_b64_tr_b16 a[120:121],v2 offset:24832
ds_read_b128 a[24:27],v11 offset:6144
v_mfma_f32_16x16x32_bf16 a[168:171],a[128:131],v[32:35],a[168:171]
v_exp_f32 v77,v77
ds_read_b128 a[28:31],v12 offset:6144
v_mfma_f32_16x16x32_bf16 v[120:123],a[128:131],v[28:31],v[120:123]
v_fma_f32 v111,v111,s36,v17
ds_read_b64_tr_b16 a[126:127],v3 offset:30976
ds_read_b64_tr_b16 a[124:125],v3 offset:24832
ds_read_b128 a[36:39],v12 offset:6272
v_mfma_f32_16x16x32_bf16 v[124:127],a[132:135],v[28:31],v[124:127]
buffer_load_dwordx4 v7,s[12:15],s28 offen offset:1024 nt lds
v_mfma_f32_16x16x32_bf16 v[220:223],a[132:135],v[24:27],v[220:223]
v_fma_f32 v95,v95,s36,v15
v_fma_f32 v100,v100,s36,v16
v_mfma_f32_16x16x32_bf16 v[216:219],a[128:131],v[24:27],v[216:219]
v_exp_f32 v106,v106
v_mfma_f32_16x16x32_bf16 v[168:171],a[128:131],v[20:23],v[168:171]
ds_read_b64_tr_b16 a[130:131],v4 offset:30976
v_fma_f32 v93,v93,s36,v15
v_mfma_f32_16x16x32_bf16 v[172:175],a[132:135],v[20:23],v[172:175]
s_waitcnt lgkmcnt(4)
ds_read_b64_tr_b16 a[128:129],v4 offset:24832
v_exp_f32 v111,v111
v_mfma_f32_16x16x32_bf16 v[176:179],a[136:139],v[20:23],v[176:179]
ds_read_b64_tr_b16 a[132:133],v5 offset:24832
buffer_load_dwordx4 v8,s[12:15],s28 offen offset:2048 nt lds
v_mfma_f32_16x16x32_bf16 v[180:183],a[140:143],v[20:23],v[180:183]
s_add_u32 s28,s28,3072
ds_read_b64_tr_b16 a[134:135],v5 offset:30976
v_fma_f32 v107,v107,s36,v17
v_mfma_f32_16x16x32_bf16 v[228:231],a[140:143],v[24:27],v[228:231]
s_add_u32 m0,s24,3072
v_fma_f32 v92,v92,s36,v15
v_exp_f32 v92,v92
v_mfma_f32_16x16x32_bf16 v[224:227],a[136:139],v[24:27],v[224:227]
v_fma_f32 v109,v109,s36,v17
v_exp_f32 v109,v109
v_mfma_f32_16x16x32_bf16 v[128:131],a[136:139],v[28:31],v[128:131]
v_fma_f32 v97,v97,s36,v16
v_exp_f32 v84,v84
v_mfma_f32_16x16x32_bf16 v[132:135],a[140:143],v[28:31],v[132:135]
v_fma_f32 v94,v94,s36,v15
v_exp_f32 v94,v94
v_mfma_f32_16x16x32_bf16 a[180:183],a[140:143],v[32:35],a[180:183]
v_fma_f32 v104,v104,s36,v17
v_fma_f32 v90,v90,s36,v15
v_mfma_f32_16x16x32_bf16 a[176:179],a[136:139],v[32:35],a[176:179]
buffer_load_dwordx4 v6,s[12:15],s28 offen offset:0 nt lds
v_mfma_f32_16x16x32_bf16 a[224:227],a[136:139],v[36:39],a[224:227]
v_exp_f32 v93,v93
v_mfma_f32_16x16x32_bf16 a[228:231],a[140:143],v[36:39],a[228:231]
v_exp_f32 v104,v104
v_mfma_f32_16x16x32_bf16 a[232:235],a[144:147],v[36:39],a[232:235]
v_exp_f32 v96,v96
v_mfma_f32_16x16x32_bf16 a[236:239],a[148:151],v[36:39],a[236:239]
v_fma_f32 v78,v78,s36,v13
v_exp_f32 v78,v78
v_mfma_f32_16x16x32_bf16 a[188:191],a[148:151],v[32:35],a[188:191]
v_fma_f32 v110,v110,s36,v17
v_exp_f32 v110,v110
v_mfma_f32_16x16x32_bf16 a[184:187],a[144:147],v[32:35],a[184:187]
v_exp_f32 v97,v97
v_mfma_f32_16x16x32_bf16 v[136:139],a[144:147],v[28:31],v[136:139]
v_exp_f32 v100,v100
v_mfma_f32_16x16x32_bf16 v[140:143],a[148:151],v[28:31],v[140:143]
buffer_load_dwordx4 v7,s[12:15],s28 offen offset:1024 nt lds
v_mfma_f32_16x16x32_bf16 v[236:239],a[148:151],v[24:27],v[236:239]
v_fma_f32 v102,v102,s36,v16
v_exp_f32 v102,v102
v_mfma_f32_16x16x32_bf16 v[232:235],a[144:147],v[24:27],v[232:235]
v_fma_f32 v79,v79,s36,v13
v_exp_f32 v79,v79
v_mfma_f32_16x16x32_bf16 v[184:187],a[144:147],v[20:23],v[184:187]
v_exp_f32 v85,v85
v_mfma_f32_16x16x32_bf16 v[188:191],a[148:151],v[20:23],v[188:191]
v_fma_f32 v108,v108,s36,v17
v_exp_f32 v108,v108
v_mfma_f32_16x16x32_bf16 v[192:195],a[120:123],v[20:23],v[192:195]
s_waitcnt lgkmcnt(0)
v_fma_f32 v98,v98,s36,v16
v_exp_f32 v87,v87
v_mfma_f32_16x16x32_bf16 v[196:199],a[124:127],v[20:23],v[196:199]
v_fma_f32 v76,v76,s36,v13
v_exp_f32 v76,v76
v_mfma_f32_16x16x32_bf16 v[244:247],a[124:127],v[24:27],v[244:247]
buffer_load_dwordx4 v8,s[12:15],s28 offen offset:2048 nt lds
s_waitcnt vmcnt(18)
s_barrier
v_mfma_f32_16x16x32_bf16 v[240:243],a[120:123],v[24:27],v[240:243]
s_add_u32 s28,s28,3072
v_fma_f32 v105,v105,s36,v17
v_exp_f32 v107,v107
v_mfma_f32_16x16x32_bf16 v[144:147],a[120:123],v[28:31],v[144:147]
s_add_u32 m0,s22,0
v_fma_f32 v91,v91,s36,v15
v_exp_f32 v91,v91
v_mfma_f32_16x16x32_bf16 v[148:151],a[124:127],v[28:31],v[148:151]
buffer_load_dwordx4 v6,s[4:7],s25 offen offset:0 lds
v_mfma_f32_16x16x32_bf16 a[196:199],a[124:127],v[32:35],a[196:199]
buffer_load_dwordx4 v7,s[4:7],s25 offen offset:1024 lds
v_mfma_f32_16x16x32_bf16 a[192:195],a[120:123],v[32:35],a[192:195]
buffer_load_dwordx4 v8,s[4:7],s25 offen offset:2048 lds
v_mfma_f32_16x16x32_bf16 a[240:243],a[120:123],v[36:39],a[240:243]
v_fma_f32 v86,v86,s36,v14
v_exp_f32 v86,v86
v_mfma_f32_16x16x32_bf16 a[244:247],a[124:127],v[36:39],a[244:247]
v_exp_f32 v95,v95
v_mfma_f32_16x16x32_bf16 a[248:251],a[128:131],v[36:39],a[248:251]
v_exp_f32 v103,v103
v_mfma_f32_16x16x32_bf16 a[252:255],a[132:135],v[36:39],a[252:255]
ds_read_b64_tr_b16 a[136:137],v2 offset:0
v_cvt_pk_bf16_f32 v41,v106,v107
v_mfma_f32_16x16x32_bf16 a[204:207],a[132:135],v[32:35],a[204:207]
ds_read_b64_tr_b16 a[138:139],v2 offset:6144
v_exp_f32 v99,v99
v_mfma_f32_16x16x32_bf16 a[200:203],a[128:131],v[32:35],a[200:203]
ds_read_b64_tr_b16 a[140:141],v3 offset:0
v_cvt_pk_bf16_f32 v42,v108,v109
v_mfma_f32_16x16x32_bf16 v[152:155],a[128:131],v[28:31],v[152:155]
ds_read_b64_tr_b16 a[142:143],v3 offset:6144
v_cvt_pk_bf16_f32 v50,v84,v85
v_mfma_f32_16x16x32_bf16 v[156:159],a[132:135],v[28:31],v[156:159]
ds_read_b64_tr_b16 a[144:145],v4 offset:0
v_exp_f32 v90,v90
v_mfma_f32_16x16x32_bf16 v[252:255],a[132:135],v[24:27],v[252:255]
ds_read_b64_tr_b16 a[146:147],v4 offset:6144
v_exp_f32 v105,v105
v_mfma_f32_16x16x32_bf16 v[248:251],a[128:131],v[24:27],v[248:251]
ds_read_b64_tr_b16 a[148:149],v5 offset:0
v_cvt_pk_bf16_f32 v55,v94,v95
v_mfma_f32_16x16x32_bf16 v[200:203],a[128:131],v[20:23],v[200:203]
ds_read_b64_tr_b16 a[150:151],v5 offset:6144
v_cvt_pk_bf16_f32 v51,v86,v87
v_mfma_f32_16x16x32_bf16 v[204:207],a[132:135],v[20:23],v[204:207]
v_cvt_pk_bf16_f32 v59,v102,v103
v_exp_f32 v98,v98
v_cvt_pk_bf16_f32 v54,v92,v93
v_cvt_pk_bf16_f32 v56,v96,v97
v_cvt_pk_bf16_f32 v53,v90,v91
v_cvt_pk_bf16_f32 v47,v78,v79
v_cvt_pk_bf16_f32 v43,v110,v111
v_cvt_pk_bf16_f32 v58,v100,v101
v_cvt_pk_bf16_f32 v46,v76,v77
v_cvt_pk_bf16_f32 v57,v98,v99
v_cvt_pk_bf16_f32 v40,v104,v105
v_smfmac_f32_16x16x64_bf16 v[60:63],a[152:155],v[44:51],v18
v_subrev_u32 v10,18432,v10
v_smfmac_f32_16x16x64_bf16 v[64:67],a[152:155],v[52:59],v18
v_smfmac_f32_16x16x64_bf16 v[68:71],a[152:155],v[36:43],v18
s_waitcnt lgkmcnt(1)
v_mfma_f32_16x16x32_bf16 v[160:163],a[136:139],v[44:47],v[160:163]
s_add_u32 s87,s42,18432
ds_read_b64_tr_b16 a[120:121],v2 offset:128
v_mbcnt_lo_u32_b32 v39,-1,0
v_mfma_f32_16x16x32_bf16 v[164:167],a[140:143],v[44:47],v[164:167]
s_add_u32 s66,s42,24576
ds_read_b64_tr_b16 a[122:123],v2 offset:6272
v_mbcnt_hi_u32_b32 v39,-1,v39
v_mfma_f32_16x16x32_bf16 v[212:215],a[140:143],v[48:51],v[212:215]
ds_read_b64_tr_b16 a[124:125],v3 offset:128
v_and_b32 v38,7,v39
v_mfma_f32_16x16x32_bf16 v[208:211],a[136:139],v[48:51],v[208:211]
ds_read_b64_tr_b16 a[126:127],v3 offset:6272
v_lshrrev_b32 v19,5,v39
v_mfma_f32_16x16x32_bf16 v[112:115],a[136:139],v[52:55],v[112:115]
ds_read_b64_tr_b16 a[128:129],v4 offset:128
v_xor_b32 v38,v38,v19
v_mfma_f32_16x16x32_bf16 v[116:119],a[140:143],v[52:55],v[116:119]
ds_read_b64_tr_b16 a[130:131],v4 offset:6272
ds_read_b64_tr_b16 a[132:133],v5 offset:128
ds_read_b64_tr_b16 a[134:135],v5 offset:6272
v_mfma_f32_16x16x32_bf16 a[164:167],a[140:143],v[56:59],a[164:167]
v_and_b32 v19,15,v39
v_lshl_add_u32 v19,v19,7,s24
v_mfma_f32_16x16x32_bf16 a[160:163],a[136:139],v[56:59],a[160:163]
v_lshl_add_u32 v19,v38,4,v19
v_bfe_u32 v38,v39,4,1
v_mfma_f32_16x16x32_bf16 a[208:211],a[136:139],v[40:43],a[208:211]
ds_read_b64_tr_b16 a[136:137],v2 offset:256
v_lshl_add_u32 v36,v38,3,v19
v_mfma_f32_16x16x32_bf16 a[212:215],a[140:143],v[40:43],a[212:215]
ds_read_b64_tr_b16 a[138:139],v2 offset:6400
v_xor_b32 v37,32,v36
v_mfma_f32_16x16x32_bf16 a[216:219],a[144:147],v[40:43],a[216:219]
s_waitcnt lgkmcnt(6)
ds_read_b64_tr_b16 a[140:141],v3 offset:256
v_xor_b32 v38,64,v36
v_mfma_f32_16x16x32_bf16 a[220:223],a[148:151],v[40:43],a[220:223]
ds_read_b64_tr_b16 a[142:143],v3 offset:6400
v_bfe_u32 v19,v39,3,1
v_xor_b32 v39,96,v36
v_lshlrev_b32 v19,11,v19
v_add_f32 v68,v68,v69
v_add_f32 v68,v68,v70
v_add_f32 v66,v66,v67
v_add_f32 v68,v68,v71
v_rcp_f32 v66,v66
v_rcp_f32 v68,v68
v_accvgpr_read_b32 v72,a160
v_accvgpr_read_b32 v73,a161
v_pk_mul_f32 v[72:73],v[72:73],v[66:67] op_sel_hi:[1,0]
v_accvgpr_read_b32 v74,a162
v_accvgpr_read_b32 v75,a163
v_pk_mul_f32 v[74:75],v[74:75],v[66:67] op_sel_hi:[1,0]
v_accvgpr_read_b32 v76,a208
v_accvgpr_read_b32 v77,a209
v_pk_mul_f32 v[76:77],v[76:77],v[68:69] op_sel_hi:[1,0]
v_accvgpr_read_b32 v78,a210
v_accvgpr_read_b32 v79,a211
v_pk_mul_f32 v[78:79],v[78:79],v[68:69] op_sel_hi:[1,0]
v_accvgpr_read_b32 v80,a164
v_accvgpr_read_b32 v81,a165
v_mfma_f32_16x16x32_bf16 a[172:175],a[148:151],v[56:59],a[172:175]
v_accvgpr_read_b32 v82,a166
v_accvgpr_read_b32 v83,a167
v_accvgpr_read_b32 v84,a212
v_accvgpr_read_b32 v85,a213
v_accvgpr_read_b32 v86,a214
v_pk_mul_f32 v[80:81],v[80:81],v[66:67] op_sel_hi:[1,0]
v_pk_mul_f32 v[82:83],v[82:83],v[66:67] op_sel_hi:[1,0]
v_pk_mul_f32 v[84:85],v[84:85],v[68:69] op_sel_hi:[1,0]
v_accvgpr_read_b32 v87,a215
v_pk_mul_f32 v[86:87],v[86:87],v[68:69] op_sel_hi:[1,0]
v_accvgpr_read_b32 v92,a216
v_accvgpr_read_b32 v93,a217
v_mfma_f32_16x16x32_bf16 a[168:171],a[144:147],v[56:59],a[168:171]
v_accvgpr_read_b32 v94,a218
v_accvgpr_read_b32 v95,a219
v_mfma_f32_16x16x32_bf16 v[120:123],a[144:147],v[52:55],v[120:123]
v_accvgpr_read_b32 v100,a220
v_accvgpr_read_b32 v101,a221
v_mfma_f32_16x16x32_bf16 v[124:127],a[148:151],v[52:55],v[124:127]
v_accvgpr_read_b32 v102,a222
v_accvgpr_read_b32 v103,a223
v_mfma_f32_16x16x32_bf16 v[220:223],a[148:151],v[48:51],v[220:223]
v_accvgpr_read_b32 v88,a168
v_accvgpr_read_b32 v89,a169
v_accvgpr_read_b32 v90,a170
v_accvgpr_read_b32 v91,a171
v_accvgpr_read_b32 v96,a172
v_pk_mul_f32 v[92:93],v[92:93],v[68:69] op_sel_hi:[1,0]
v_pk_mul_f32 v[94:95],v[94:95],v[68:69] op_sel_hi:[1,0]
v_pk_mul_f32 v[88:89],v[88:89],v[66:67] op_sel_hi:[1,0]
v_pk_mul_f32 v[90:91],v[90:91],v[66:67] op_sel_hi:[1,0]
v_accvgpr_read_b32 v97,a173
v_accvgpr_read_b32 v98,a174
v_mfma_f32_16x16x32_bf16 v[216:219],a[144:147],v[48:51],v[216:219]
v_accvgpr_read_b32 v99,a175
v_cvt_pk_bf16_f32 v72,v72,v73
v_mfma_f32_16x16x32_bf16 v[168:171],a[144:147],v[44:47],v[168:171]
ds_read_b64_tr_b16 a[144:145],v4 offset:256
ds_read_b64_tr_b16 a[146:147],v4 offset:6400
v_cvt_pk_bf16_f32 v76,v76,v77
v_cvt_pk_bf16_f32 v80,v80,v81
v_pk_mul_f32 v[96:97],v[96:97],v[66:67] op_sel_hi:[1,0]
v_pk_mul_f32 v[98:99],v[98:99],v[66:67] op_sel_hi:[1,0]
v_pk_mul_f32 v[100:101],v[100:101],v[68:69] op_sel_hi:[1,0]
v_pk_mul_f32 v[102:103],v[102:103],v[68:69] op_sel_hi:[1,0]
v_cvt_pk_bf16_f32 v84,v84,v85
v_cvt_pk_bf16_f32 v73,v74,v75
v_mfma_f32_16x16x32_bf16 v[172:175],a[148:151],v[44:47],v[172:175]
ds_read_b64_tr_b16 a[148:149],v5 offset:256
v_cvt_pk_bf16_f32 v77,v78,v79
v_mfma_f32_16x16x32_bf16 v[176:179],a[120:123],v[44:47],v[176:179]
ds_read_b64_tr_b16 a[150:151],v5 offset:6400
v_cvt_pk_bf16_f32 v81,v82,v83
v_mfma_f32_16x16x32_bf16 v[180:183],a[124:127],v[44:47],v[180:183]
ds_write2st64_b64 v36,v[72:73],v[76:77] offset0:36 offset1:40
v_mfma_f32_16x16x32_bf16 v[228:231],a[124:127],v[48:51],v[228:231]
v_cvt_pk_bf16_f32 v85,v86,v87
v_cvt_pk_bf16_f32 v92,v92,v93
v_mfma_f32_16x16x32_bf16 v[224:227],a[120:123],v[48:51],v[224:227]
v_cvt_pk_bf16_f32 v88,v88,v89
v_cvt_pk_bf16_f32 v93,v94,v95
v_mfma_f32_16x16x32_bf16 v[128:131],a[120:123],v[52:55],v[128:131]
v_cvt_pk_bf16_f32 v89,v90,v91
v_cvt_pk_bf16_f32 v96,v96,v97
v_mfma_f32_16x16x32_bf16 v[132:135],a[124:127],v[52:55],v[132:135]
ds_write2st64_b64 v37,v[80:81],v[84:85] offset0:36 offset1:40
v_mfma_f32_16x16x32_bf16 a[180:183],a[124:127],v[56:59],a[180:183]
v_cvt_pk_bf16_f32 v100,v100,v101
v_cvt_pk_bf16_f32 v97,v98,v99
v_mfma_f32_16x16x32_bf16 a[176:179],a[120:123],v[56:59],a[176:179]
v_cvt_pk_bf16_f32 v101,v102,v103
v_add_f32 v64,v64,v65
v_mfma_f32_16x16x32_bf16 a[224:227],a[120:123],v[40:43],a[224:227]
v_rcp_f32 v64,v64
v_mfma_f32_16x16x32_bf16 a[228:231],a[124:127],v[40:43],a[228:231]
s_waitcnt lgkmcnt(1)
ds_write2st64_b64 v38,v[88:89],v[92:93] offset0:36 offset1:40
v_mfma_f32_16x16x32_bf16 a[232:235],a[128:131],v[40:43],a[232:235]
v_accvgpr_read_b32 v90,a182
v_accvgpr_read_b32 v80,a176
v_mfma_f32_16x16x32_bf16 a[236:239],a[132:135],v[40:43],a[236:239]
v_accvgpr_read_b32 v81,a177
v_accvgpr_read_b32 v82,a178
v_accvgpr_read_b32 v83,a179
v_accvgpr_read_b32 v84,a224
v_accvgpr_read_b32 v85,a225
ds_write2st64_b64 v39,v[96:97],v[100:101] offset0:36 offset1:40
v_pk_mul_f32 v[80:81],v[80:81],v[66:67] op_sel_hi:[1,0]
v_pk_mul_f32 v[82:83],v[82:83],v[66:67] op_sel_hi:[1,0]
v_pk_mul_f32 v[84:85],v[84:85],v[68:69] op_sel_hi:[1,0]
ds_read_b128 v[104:107],v10 offset:18432
v_accvgpr_read_b32 v86,a226
ds_read_b128 v[108:111],v10 offset:19456
v_accvgpr_read_b32 v87,a227
ds_read_b128 v[72:75],v10 offset:20480
v_pk_mul_f32 v[86:87],v[86:87],v[68:69] op_sel_hi:[1,0]
v_accvgpr_read_b32 v91,a183
v_accvgpr_read_b32 v94,a230
v_mfma_f32_16x16x32_bf16 a[188:191],a[132:135],v[56:59],a[188:191]
ds_read_b128 v[76:79],v10 offset:21504
v_accvgpr_read_b32 v95,a231
v_accvgpr_read_b32 v88,a180
v_accvgpr_read_b32 v89,a181
v_accvgpr_read_b32 v92,a228
v_pk_mul_f32 v[90:91],v[90:91],v[66:67] op_sel_hi:[1,0]
v_pk_mul_f32 v[94:95],v[94:95],v[68:69] op_sel_hi:[1,0]
v_pk_mul_f32 v[88:89],v[88:89],v[66:67] op_sel_hi:[1,0]
v_accvgpr_read_b32 v93,a229
v_pk_mul_f32 v[92:93],v[92:93],v[68:69] op_sel_hi:[1,0]
v_cvt_pk_bf16_f32 v80,v80,v81
v_cvt_pk_bf16_f32 v84,v84,v85
v_mfma_f32_16x16x32_bf16 a[184:187],a[128:131],v[56:59],a[184:187]
v_cvt_pk_bf16_f32 v81,v82,v83
v_cvt_pk_bf16_f32 v85,v86,v87
v_mfma_f32_16x16x32_bf16 v[136:139],a[128:131],v[52:55],v[136:139]
ds_write2st64_b64 v36,v[80:81],v[84:85] offset0:36 offset1:40
v_mfma_f32_16x16x32_bf16 v[140:143],a[132:135],v[52:55],v[140:143]
v_add_u32 v36,v36,v19
v_accvgpr_read_b32 v102,a234
v_mfma_f32_16x16x32_bf16 v[236:239],a[132:135],v[48:51],v[236:239]
s_waitcnt lgkmcnt(2)
buffer_store_dwordx4 v[104:107],v9,s[16:19],s87 offen offset:0 nt
v_accvgpr_read_b32 v103,a235
v_accvgpr_read_b32 v100,a232
v_accvgpr_read_b32 v101,a233
v_pk_mul_f32 v[112:113],v[112:113],v[64:65] op_sel_hi:[1,0]
v_pk_mul_f32 v[114:115],v[114:115],v[64:65] op_sel_hi:[1,0]
v_pk_mul_f32 v[128:129],v[128:129],v[64:65] op_sel_hi:[1,0]
v_pk_mul_f32 v[130:131],v[130:131],v[64:65] op_sel_hi:[1,0]
v_pk_mul_f32 v[102:103],v[102:103],v[68:69] op_sel_hi:[1,0]
v_pk_mul_f32 v[100:101],v[100:101],v[68:69] op_sel_hi:[1,0]
v_accvgpr_read_b32 v96,a184
v_accvgpr_read_b32 v97,a185
buffer_store_dwordx4 v[108:111],v9,s[16:19],s87 offen offset:3072 nt
v_pk_mul_f32 v[96:97],v[96:97],v[66:67] op_sel_hi:[1,0]
v_accvgpr_read_b32 v98,a186
v_accvgpr_read_b32 v99,a187
v_pk_mul_f32 v[98:99],v[98:99],v[66:67] op_sel_hi:[1,0]
v_accvgpr_read_b32 v82,a190
v_accvgpr_read_b32 v83,a191
v_pk_mul_f32 v[82:83],v[82:83],v[66:67] op_sel_hi:[1,0]
v_accvgpr_read_b32 v86,a238
v_accvgpr_read_b32 v87,a239
v_pk_mul_f32 v[86:87],v[86:87],v[68:69] op_sel_hi:[1,0]
v_accvgpr_read_b32 v80,a188
buffer_store_dwordx4 v[72:75],v9,s[16:19],s66 offen offset:0 nt
v_accvgpr_read_b32 v81,a189
v_pk_mul_f32 v[80:81],v[80:81],v[66:67] op_sel_hi:[1,0]
v_accvgpr_read_b32 v84,a236
v_accvgpr_read_b32 v85,a237
v_pk_mul_f32 v[84:85],v[84:85],v[68:69] op_sel_hi:[1,0]
v_add_f32 v60,v60,v61
v_add_f32 v62,v62,v63
v_mfma_f32_16x16x32_bf16 v[232:235],a[128:131],v[48:51],v[232:235]
v_rcp_f32 v60,v60
v_mfma_f32_16x16x32_bf16 v[184:187],a[128:131],v[44:47],v[184:187]
s_waitcnt lgkmcnt(0)
buffer_store_dwordx4 v[76:79],v9,s[16:19],s66 offen offset:3072 nt
v_rcp_f32 v62,v62
v_cvt_pk_bf16_f32 v88,v88,v89
v_mfma_f32_16x16x32_bf16 v[188:191],a[132:135],v[44:47],v[188:191]
v_min3_f32 v61,v60,v62,v64
v_min3_f32 v61,v61,v66,v68
v_mfma_f32_16x16x32_bf16 v[192:195],a[136:139],v[44:47],v[192:195]
v_cmp_nlt_f32 vcc,s37,v61
v_cvt_pk_bf16_f32 v92,v92,v93
v_cvt_pk_bf16_f32 v100,v100,v101
v_cvt_pk_bf16_f32 v96,v96,v97
v_cvt_pk_bf16_f32 v89,v90,v91
v_pk_mul_f32 v[116:117],v[116:117],v[64:65] op_sel_hi:[1,0]
v_pk_mul_f32 v[118:119],v[118:119],v[64:65] op_sel_hi:[1,0]
v_pk_mul_f32 v[132:133],v[132:133],v[64:65] op_sel_hi:[1,0]
v_pk_mul_f32 v[134:135],v[134:135],v[64:65] op_sel_hi:[1,0]
v_cvt_pk_bf16_f32 v93,v94,v95
v_cvt_pk_bf16_f32 v80,v80,v81
v_mfma_f32_16x16x32_bf16 v[196:199],a[140:143],v[44:47],v[196:199]
s_cmp_lg_u64 vcc,0
ds_write2st64_b64 v37,v[88:89],v[92:93] offset0:36 offset1:40
v_mfma_f32_16x16x32_bf16 v[244:247],a[140:143],v[48:51],v[244:247]
s_cselect_b32 s62,s32,0
v_add_u32 v37,v37,v19
v_cvt_pk_bf16_f32 v84,v84,v85
v_mfma_f32_16x16x32_bf16 v[240:243],a[136:139],v[48:51],v[240:243]
s_or_b32 s31,s31,s62
v_cvt_pk_bf16_f32 v101,v102,v103
v_cvt_pk_bf16_f32 v97,v98,v99
v_cvt_pk_bf16_f32 v81,v82,v83
v_cvt_pk_bf16_f32 v85,v86,v87
v_cvt_pk_bf16_f32 v112,v112,v113
ds_write2st64_b64 v38,v[96:97],v[100:101] offset0:36 offset1:40
v_pk_mul_f32 v[120:121],v[120:121],v[64:65] op_sel_hi:[1,0]
v_pk_mul_f32 v[122:123],v[122:123],v[64:65] op_sel_hi:[1,0]
v_pk_mul_f32 v[136:137],v[136:137],v[64:65] op_sel_hi:[1,0]
v_pk_mul_f32 v[138:139],v[138:139],v[64:65] op_sel_hi:[1,0]
v_add_u32 v38,v38,v19
v_cvt_pk_bf16_f32 v128,v128,v129
v_mfma_f32_16x16x32_bf16 v[144:147],a[136:139],v[52:55],v[144:147]
s_lshl_b32 s32,s32,1
v_cvt_pk_bf16_f32 v113,v114,v115
v_cvt_pk_bf16_f32 v129,v130,v131
v_mfma_f32_16x16x32_bf16 v[148:151],a[140:143],v[52:55],v[148:151]
s_add_u32 m0,s24,6144
v_cvt_pk_bf16_f32 v116,v116,v117
v_cvt_pk_bf16_f32 v132,v132,v133
v_mfma_f32_16x16x32_bf16 a[196:199],a[140:143],v[56:59],a[196:199]
buffer_load_dwordx4 v6,s[12:15],s28 offen offset:0 nt lds
v_mfma_f32_16x16x32_bf16 a[192:195],a[136:139],v[56:59],a[192:195]
buffer_load_dwordx4 v7,s[12:15],s28 offen offset:1024 nt lds
buffer_load_dwordx4 v8,s[12:15],s28 offen offset:2048 nt lds
ds_write2st64_b64 v39,v[80:81],v[84:85] offset0:36 offset1:40
v_pk_mul_f32 v[124:125],v[124:125],v[64:65] op_sel_hi:[1,0]
v_pk_mul_f32 v[126:127],v[126:127],v[64:65] op_sel_hi:[1,0]
v_pk_mul_f32 v[140:141],v[140:141],v[64:65] op_sel_hi:[1,0]
ds_read_b128 v[72:75],v10 offset:18432
v_pk_mul_f32 v[142:143],v[142:143],v[64:65] op_sel_hi:[1,0]
v_add_u32 v39,v39,v19
v_accvgpr_read_b32 v104,a192
v_mfma_f32_16x16x32_bf16 a[240:243],a[136:139],v[40:43],a[240:243]
s_add_u32 s28,s28,3072
ds_read_b128 v[76:79],v10 offset:19456
v_accvgpr_read_b32 v105,a193
v_mfma_f32_16x16x32_bf16 a[244:247],a[140:143],v[40:43],a[244:247]
s_add_u32 m0,s24,9216
ds_read_b128 v[88:91],v10 offset:20480
buffer_load_dwordx4 v6,s[12:15],s28 offen offset:0 nt lds
v_mfma_f32_16x16x32_bf16 a[248:251],a[144:147],v[40:43],a[248:251]
buffer_load_dwordx4 v7,s[12:15],s28 offen offset:1024 nt lds
v_mfma_f32_16x16x32_bf16 a[252:255],a[148:151],v[40:43],a[252:255]
buffer_load_dwordx4 v8,s[12:15],s28 offen offset:2048 nt lds
ds_read_b128 v[92:95],v10 offset:21504
v_accvgpr_read_b32 v106,a194
v_pk_mul_f32 v[104:105],v[104:105],v[66:67] op_sel_hi:[1,0]
v_accvgpr_read_b32 v107,a195
s_waitcnt lgkmcnt(3)
buffer_store_dwordx4 v[72:75],v9,s[16:19],s87 offen offset:128 nt
v_pk_mul_f32 v[106:107],v[106:107],v[66:67] op_sel_hi:[1,0]
v_accvgpr_read_b32 v108,a240
v_accvgpr_read_b32 v109,a241
v_pk_mul_f32 v[108:109],v[108:109],v[68:69] op_sel_hi:[1,0]
v_accvgpr_read_b32 v110,a242
v_accvgpr_read_b32 v111,a243
v_pk_mul_f32 v[110:111],v[110:111],v[68:69] op_sel_hi:[1,0]
v_accvgpr_read_b32 v96,a196
v_accvgpr_read_b32 v97,a197
v_mfma_f32_16x16x32_bf16 a[204:207],a[148:151],v[56:59],a[204:207]
s_waitcnt vmcnt(26)
s_waitcnt vmcnt(11)
s_barrier
v_mfma_f32_16x16x32_bf16 a[200:203],a[144:147],v[56:59],a[200:203]
s_add_u32 s28,s28,3072
ds_read_b128 a[48:51],v11 offset:12288
s_waitcnt lgkmcnt(2)
buffer_store_dwordx4 v[76:79],v9,s[16:19],s87 offen offset:3200 nt
v_accvgpr_read_b32 v98,a198
v_accvgpr_read_b32 v99,a199
v_accvgpr_read_b32 v100,a244
v_mfma_f32_16x16x32_bf16 v[152:155],a[144:147],v[52:55],v[152:155]
s_add_u32 m0,s23,0
ds_read_b128 a[52:55],v12 offset:12288
v_accvgpr_read_b32 v101,a245
ds_read_b128 a[56:59],v11 offset:12416
buffer_load_dwordx4 v6,s[8:11],s25 offen offset:0 lds
buffer_load_dwordx4 v7,s[8:11],s25 offen offset:1024 lds
ds_read_b128 a[60:63],v12 offset:12416
buffer_store_dwordx4 v[88:91],v9,s[16:19],s66 offen offset:128 nt
ds_read_b128 a[64:67],v11 offset:12544
v_pk_mul_f32 v[96:97],v[96:97],v[66:67] op_sel_hi:[1,0]
ds_read_b128 a[68:71],v12 offset:12544
v_pk_mul_f32 v[98:99],v[98:99],v[66:67] op_sel_hi:[1,0]
ds_read_b128 a[120:123],v0 offset:0
v_pk_mul_f32 v[100:101],v[100:101],v[68:69] op_sel_hi:[1,0]
ds_write2st64_b64 v36,v[112:113],v[128:129] offset0:24 offset1:26
v_sub_u32 v36,v36,v19
v_accvgpr_read_b32 v102,a246
v_accvgpr_read_b32 v103,a247
buffer_load_dwordx4 v8,s[8:11],s25 offen offset:2048 lds
ds_read_b128 a[124:127],v1 offset:0
s_waitcnt lgkmcnt(6)
buffer_store_dwordx4 v[92:95],v9,s[16:19],s66 offen offset:3200 nt
ds_read_b128 a[128:131],v0 offset:128
v_pk_mul_f32 v[102:103],v[102:103],v[68:69] op_sel_hi:[1,0]
ds_read_b128 a[132:135],v1 offset:128
v_accvgpr_read_b32 v84,a248
ds_read_b128 a[136:139],v0 offset:256
v_mfma_f32_16x16x32_bf16 v[156:159],a[148:151],v[52:55],v[156:159]
s_waitcnt vmcnt(20)
ds_read_b128 a[140:143],v1 offset:256
v_mfma_f32_16x16x32_bf16 v[252:255],a[148:151],v[48:51],v[252:255]
s_mov_b32 s27,s42
v_accvgpr_read_b32 v85,a249
v_accvgpr_read_b32 v86,a250
v_mfma_f32_16x16x32_bf16 v[248:251],a[144:147],v[48:51],v[248:251]
s_mov_b32 s42,s41
ds_read_b128 a[92:95],v12 offset:256
v_accvgpr_read_b32 v87,a251
v_mfma_f32_16x16x32_bf16 v[200:203],a[144:147],v[44:47],v[200:203]
s_add_u32 s69,s69,1
ds_read_b128 a[88:91],v11 offset:256
v_accvgpr_read_b32 v80,a200
ds_read_b128 a[84:87],v12 offset:128
v_pk_mul_f32 v[84:85],v[84:85],v[68:69] op_sel_hi:[1,0]
ds_read_b128 a[80:83],v11 offset:128
v_pk_mul_f32 v[86:87],v[86:87],v[68:69] op_sel_hi:[1,0]
ds_read_b128 a[76:79],v12 offset:0
v_accvgpr_read_b32 v81,a201
ds_read_b128 a[72:75],v11 offset:0
v_pk_mul_f32 v[80:81],v[80:81],v[66:67] op_sel_hi:[1,0]
ds_read_b128 a[144:147],v0 offset:6144
v_accvgpr_read_b32 v82,a202
v_accvgpr_read_b32 v83,a203
v_pk_mul_f32 v[82:83],v[82:83],v[66:67] op_sel_hi:[1,0]
v_accvgpr_read_b32 v130,a254
v_accvgpr_read_b32 v131,a255
v_mfma_f32_16x16x32_bf16 v[204:207],a[148:151],v[44:47],v[204:207]
s_lshl_b32 s62,s69,5
ds_read_b128 a[148:151],v1 offset:6144
v_accvgpr_read_b32 v114,a206
s_waitcnt lgkmcnt(6)
v_mfma_f32_16x16x32_bf16 v[72:75],a[120:123],a[0:3],0
s_add_u32 s62,s62,s34
v_accvgpr_read_b32 v115,a207
v_accvgpr_read_b32 v112,a204
v_mfma_f32_16x16x32_bf16 v[72:75],a[124:127],a[4:7],v[72:75]
s_mul_i32 s63,s62,171
v_accvgpr_read_b32 v113,a205
v_accvgpr_read_b32 v128,a252
v_accvgpr_read_b32 v129,a253
v_cvt_pk_bf16_f32 v120,v120,v121
v_cvt_pk_bf16_f32 v136,v136,v137
v_pk_mul_f32 v[114:115],v[114:115],v[66:67] op_sel_hi:[1,0]
v_pk_mul_f32 v[130:131],v[130:131],v[68:69] op_sel_hi:[1,0]
v_pk_mul_f32 v[112:113],v[112:113],v[66:67] op_sel_hi:[1,0]
v_pk_mul_f32 v[128:129],v[128:129],v[68:69] op_sel_hi:[1,0]
v_cvt_pk_bf16_f32 v117,v118,v119
v_cvt_pk_bf16_f32 v133,v134,v135
v_mfma_f32_16x16x32_bf16 v[72:75],a[128:131],a[8:11],v[72:75]
s_lshr_b32 s63,s63,9
ds_write2st64_b64 v37,v[116:117],v[132:133] offset0:24 offset1:26
v_mfma_f32_16x16x32_bf16 v[72:75],a[132:135],a[12:15],v[72:75]
s_mul_i32 s64,s63,3
v_sub_u32 v37,v37,v19
v_cvt_pk_bf16_f32 v124,v124,v125
v_mfma_f32_16x16x32_bf16 v[72:75],a[136:139],a[16:19],v[72:75]
s_sub_u32 s62,s62,s64
v_cvt_pk_bf16_f32 v140,v140,v141
v_cvt_pk_bf16_f32 v121,v122,v123
v_mfma_f32_16x16x32_bf16 v[72:75],a[140:143],a[20:23],v[72:75]
s_add_u32 s63,s63,s33
v_cvt_pk_bf16_f32 v137,v138,v139
ds_write2st64_b64 v38,v[120:121],v[136:137] offset0:24 offset1:26
v_pk_mul_f32 v[144:145],v[144:145],v[64:65] op_sel_hi:[1,0]
v_pk_mul_f32 v[146:147],v[146:147],v[64:65] op_sel_hi:[1,0]
v_pk_mul_f32 v[160:161],v[160:161],v[60:61] op_sel_hi:[1,0]
v_pk_mul_f32 v[162:163],v[162:163],v[60:61] op_sel_hi:[1,0]
v_sub_u32 v38,v38,v19
v_cvt_pk_bf16_f32 v104,v104,v105
v_cvt_pk_bf16_f32 v108,v108,v109
v_cvt_pk_bf16_f32 v125,v126,v127
v_cvt_pk_bf16_f32 v141,v142,v143
v_cvt_pk_bf16_f32 v96,v96,v97
v_cvt_pk_bf16_f32 v100,v100,v101
ds_write2st64_b64 v39,v[124:125],v[140:141] offset0:24 offset1:26
v_sub_u32 v39,v39,v19
v_cvt_pk_bf16_f32 v105,v106,v107
v_cvt_pk_bf16_f32 v109,v110,v111
v_cvt_pk_bf16_f32 v84,v84,v85
v_cvt_pk_bf16_f32 v80,v80,v81
v_cvt_pk_bf16_f32 v97,v98,v99
v_cvt_pk_bf16_f32 v101,v102,v103
v_cvt_pk_bf16_f32 v85,v86,v87
v_cvt_pk_bf16_f32 v81,v82,v83
v_cvt_pk_bf16_f32 v112,v112,v113
v_cvt_pk_bf16_f32 v128,v128,v129
ds_write2st64_b64 v36,v[104:105],v[108:109] offset0:36 offset1:40
v_add_u32 v36,v36,v19
v_cvt_pk_bf16_f32 v113,v114,v115
v_cvt_pk_bf16_f32 v129,v130,v131
v_max3_f32 v44,v72,v73,v74
v_cvt_pk_bf16_f32 v144,v144,v145
v_cvt_pk_bf16_f32 v160,v160,v161
v_cvt_pk_bf16_f32 v145,v146,v147
v_cvt_pk_bf16_f32 v161,v162,v163
v_mov_b32 v67,0
v_mov_b32 v65,0
v_mov_b32 v63,0
ds_write2st64_b64 v37,v[96:97],v[100:101] offset0:36 offset1:40
v_add_u32 v37,v37,v19
v_mov_b32 v61,0
v_mov_b32 v66,0
v_mov_b32 v69,0
v_mov_b32 v70,0
v_mov_b32 v71,0
v_mov_b32 v68,0
s_waitcnt vmcnt(7)
ds_read_b128 a[96:99],v11 offset:6144
s_mul_i32 s30,s63,196608
ds_read_b128 a[100:103],v12 offset:6144
s_mul_i32 s41,s63,325632
ds_read_b128 a[104:107],v11 offset:6272
s_lshl_b32 s63,s3,2
ds_read_b128 a[108:111],v12 offset:6272
s_add_u32 s64,s63,21
ds_read_b128 a[112:115],v11 offset:6400
s_cmp_eq_u32 s3,0
ds_read_b128 a[116:119],v12 offset:6400
s_cselect_b32 s64,20,s64
ds_write2st64_b64 v38,v[80:81],v[84:85] offset0:36 offset1:40
v_mfma_f32_16x16x32_bf16 v[80:83],a[140:143],a[44:47],0
s_cselect_b32 s40,1,0
v_add_u32 v38,v38,v19
s_add_u32 s65,s63,37
v_mfma_f32_16x16x32_bf16 v[80:83],a[136:139],a[40:43],v[80:83]
s_cmp_eq_u32 s62,2
s_cselect_b32 s64,s65,s64
s_cselect_b32 s40,0,s40
v_mfma_f32_16x16x32_bf16 v[80:83],a[132:135],a[36:39],v[80:83]
s_add_u32 s65,s63,s3
s_cmp_eq_u32 s62,0
ds_write2st64_b64 v39,v[112:113],v[128:129] offset0:36 offset1:40
v_pk_mul_f32 v[148:149],v[148:149],v[64:65] op_sel_hi:[1,0]
v_pk_mul_f32 v[150:151],v[150:151],v[64:65] op_sel_hi:[1,0]
v_pk_mul_f32 v[164:165],v[164:165],v[60:61] op_sel_hi:[1,0]
ds_read_b128 v[76:79],v10 offset:18432
v_pk_mul_f32 v[166:167],v[166:167],v[60:61] op_sel_hi:[1,0]
v_add_u32 v39,v39,v19
v_cvt_pk_bf16_f32 v148,v148,v149
v_mfma_f32_16x16x32_bf16 v[80:83],a[128:131],a[32:35],v[80:83]
s_cselect_b32 s64,s65,s64
ds_read_b128 v[92:95],v10 offset:19456
v_cvt_pk_bf16_f32 v164,v164,v165
v_mfma_f32_16x16x32_bf16 v[80:83],a[124:127],a[28:31],v[80:83]
s_cselect_b32 s40,1,s40
ds_read_b128 v[116:119],v10 offset:20480
v_cvt_pk_bf16_f32 v149,v150,v151
v_mfma_f32_16x16x32_bf16 v[80:83],a[120:123],a[24:27],v[80:83]
s_mul_i32 s64,s64,6144
ds_read_b128 v[132:135],v10 offset:21504
v_cvt_pk_bf16_f32 v165,v166,v167
v_mfma_f32_16x16x32_bf16 v[88:91],a[120:123],a[48:51],0
s_add_u32 s41,s41,s64
ds_write2st64_b64 v36,v[144:145],v[160:161] offset0:28 offset1:0
v_pk_mul_f32 v[152:153],v[152:153],v[64:65] op_sel_hi:[1,0]
v_pk_mul_f32 v[154:155],v[154:155],v[64:65] op_sel_hi:[1,0]
v_pk_mul_f32 v[168:169],v[168:169],v[60:61] op_sel_hi:[1,0]
v_pk_mul_f32 v[170:171],v[170:171],v[60:61] op_sel_hi:[1,0]
v_max3_f32 v48,v80,v81,v82
v_cvt_pk_bf16_f32 v152,v152,v153
v_mfma_f32_16x16x32_bf16 v[88:91],a[124:127],a[52:55],v[88:91]
s_cmp_ge_u32 s69,6
v_cvt_pk_bf16_f32 v168,v168,v169
v_cvt_pk_bf16_f32 v153,v154,v155
v_mfma_f32_16x16x32_bf16 v[88:91],a[128:131],a[56:59],v[88:91]
s_cselect_b32 s41,166723584,s41
v_cvt_pk_bf16_f32 v169,v170,v171
s_cselect_b32 s30,100663296,s30
v_mfma_f32_16x16x32_bf16 v[88:91],a[132:135],a[60:63],v[88:91]
s_add_u32 s25,s30,s22
ds_write2st64_b64 v37,v[148:149],v[164:165] offset0:28 offset1:0
v_mfma_f32_16x16x32_bf16 v[88:91],a[136:139],a[64:67],v[88:91]
s_add_u32 s26,s25,12288
s_add_u32 m0,s23,24576
s_waitcnt lgkmcnt(1)
buffer_store_dwordx4 v[76:79],v9,s[16:19],s87 offen offset:256 nt
v_pk_mul_f32 v[156:157],v[156:157],v[64:65] op_sel_hi:[1,0]
v_pk_mul_f32 v[158:159],v[158:159],v[64:65] op_sel_hi:[1,0]
v_pk_mul_f32 v[172:173],v[172:173],v[60:61] op_sel_hi:[1,0]
v_pk_mul_f32 v[174:175],v[174:175],v[60:61] op_sel_hi:[1,0]
v_cvt_pk_bf16_f32 v156,v156,v157
v_cvt_pk_bf16_f32 v172,v172,v173
v_mfma_f32_16x16x32_bf16 v[88:91],a[140:143],a[68:71],v[88:91]
s_mov_b32 s28,s41
v_cvt_pk_bf16_f32 v157,v158,v159
v_cvt_pk_bf16_f32 v173,v174,v175
v_mfma_f32_16x16x32_bf16 v[96:99],a[140:143],a[92:95],0
s_mov_b32 s29,s24
ds_write2st64_b64 v38,v[152:153],v[168:169] offset0:28 offset1:0
v_mfma_f32_16x16x32_bf16 v[96:99],a[136:139],a[88:91],v[96:99]
v_mov_b32 v64,0
buffer_store_dwordx4 v[92:95],v9,s[16:19],s87 offen offset:3328 nt
v_pk_mul_f32 v[176:177],v[176:177],v[60:61] op_sel_hi:[1,0]
v_pk_mul_f32 v[178:179],v[178:179],v[60:61] op_sel_hi:[1,0]
v_pk_mul_f32 v[192:193],v[192:193],v[60:61] op_sel_hi:[1,0]
v_pk_mul_f32 v[194:195],v[194:195],v[60:61] op_sel_hi:[1,0]
v_max3_f32 v52,v88,v89,v90
v_cvt_pk_bf16_f32 v176,v176,v177
v_mfma_f32_16x16x32_bf16 v[96:99],a[132:135],a[84:87],v[96:99]
v_cvt_pk_bf16_f32 v192,v192,v193
v_cvt_pk_bf16_f32 v177,v178,v179
v_mfma_f32_16x16x32_bf16 v[96:99],a[128:131],a[80:83],v[96:99]
ds_write2st64_b64 v39,v[156:157],v[172:173] offset0:28 offset1:0
v_mfma_f32_16x16x32_bf16 v[96:99],a[124:127],a[76:79],v[96:99]
v_cvt_pk_bf16_f32 v193,v194,v195
v_mfma_f32_16x16x32_bf16 v[96:99],a[120:123],a[72:75],v[96:99]
buffer_store_dwordx4 v[116:119],v9,s[16:19],s66 offen offset:256 nt
v_pk_mul_f32 v[180:181],v[180:181],v[60:61] op_sel_hi:[1,0]
v_pk_mul_f32 v[182:183],v[182:183],v[60:61] op_sel_hi:[1,0]
v_pk_mul_f32 v[196:197],v[196:197],v[60:61] op_sel_hi:[1,0]
v_pk_mul_f32 v[198:199],v[198:199],v[60:61] op_sel_hi:[1,0]
v_cvt_pk_bf16_f32 v180,v180,v181
v_cvt_pk_bf16_f32 v196,v196,v197
v_mfma_f32_16x16x32_bf16 v[104:107],a[120:123],a[96:99],0
ds_write2st64_b64 v36,v[176:177],v[192:193] offset0:2 offset1:4
v_mfma_f32_16x16x32_bf16 v[104:107],a[124:127],a[100:103],v[104:107]
v_max3_f32 v56,v96,v97,v98
v_cvt_pk_bf16_f32 v181,v182,v183
v_mfma_f32_16x16x32_bf16 v[104:107],a[128:131],a[104:107],v[104:107]
ds_read_b128 a[120:123],v0 offset:6272
buffer_store_dwordx4 v[132:135],v9,s[16:19],s66 offen offset:3328 nt
ds_read_b128 a[124:127],v1 offset:6272
v_pk_mul_f32 v[184:185],v[184:185],v[60:61] op_sel_hi:[1,0]
ds_read_b128 a[128:131],v0 offset:6400
v_pk_mul_f32 v[186:187],v[186:187],v[60:61] op_sel_hi:[1,0]
v_pk_mul_f32 v[200:201],v[200:201],v[60:61] op_sel_hi:[1,0]
v_pk_mul_f32 v[202:203],v[202:203],v[60:61] op_sel_hi:[1,0]
v_cvt_pk_bf16_f32 v197,v198,v199
v_cvt_pk_bf16_f32 v184,v184,v185
v_mfma_f32_16x16x32_bf16 v[104:107],a[132:135],a[108:111],v[104:107]
ds_write2st64_b64 v37,v[180:181],v[196:197] offset0:2 offset1:4
v_mfma_f32_16x16x32_bf16 v[104:107],a[136:139],a[112:115],v[104:107]
v_cvt_pk_bf16_f32 v200,v200,v201
v_cvt_pk_bf16_f32 v185,v186,v187
v_mfma_f32_16x16x32_bf16 v[104:107],a[140:143],a[116:119],v[104:107]
ds_read_b128 a[136:139],v0 offset:12288
v_cvt_pk_bf16_f32 v201,v202,v203
v_mfma_f32_16x16x32_bf16 v[76:79],a[144:147],a[0:3],0
ds_read_b128 a[140:143],v1 offset:12288
ds_write2st64_b64 v38,v[184:185],v[200:201] offset0:2 offset1:4
v_pk_mul_f32 v[188:189],v[188:189],v[60:61] op_sel_hi:[1,0]
v_pk_mul_f32 v[190:191],v[190:191],v[60:61] op_sel_hi:[1,0]
v_pk_mul_f32 v[204:205],v[204:205],v[60:61] op_sel_hi:[1,0]
buffer_load_dwordx4 v6,s[8:11],s21 offen offset:0 lds
ds_read_b128 a[132:135],v1 offset:6400
v_pk_mul_f32 v[206:207],v[206:207],v[60:61] op_sel_hi:[1,0]
v_max3_f32 v40,v104,v105,v106
v_cvt_pk_bf16_f32 v188,v188,v189
v_mfma_f32_16x16x32_bf16 v[76:79],a[148:151],a[4:7],v[76:79]
s_waitcnt lgkmcnt(4)
v_cvt_pk_bf16_f32 v204,v204,v205
v_cvt_pk_bf16_f32 v189,v190,v191
v_mfma_f32_16x16x32_bf16 v[76:79],a[120:123],a[8:11],v[76:79]
v_cvt_pk_bf16_f32 v205,v206,v207
v_mov_b32 v60,0
v_mfma_f32_16x16x32_bf16 v[76:79],a[124:127],a[12:15],v[76:79]
ds_write2st64_b64 v39,v[188:189],v[204:205] offset0:2 offset1:4
v_mfma_f32_16x16x32_bf16 v[76:79],a[128:131],a[16:19],v[76:79]
v_pk_mul_f32 v[208:209],v[208:209],v[62:63] op_sel_hi:[1,0]
v_pk_mul_f32 v[210:211],v[210:211],v[62:63] op_sel_hi:[1,0]
buffer_load_dwordx4 v7,s[8:11],s21 offen offset:1024 lds
v_pk_mul_f32 v[224:225],v[224:225],v[62:63] op_sel_hi:[1,0]
v_pk_mul_f32 v[226:227],v[226:227],v[62:63] op_sel_hi:[1,0]
v_cvt_pk_bf16_f32 v208,v208,v209
v_cvt_pk_bf16_f32 v224,v224,v225
s_waitcnt lgkmcnt(1)
v_mfma_f32_16x16x32_bf16 v[76:79],a[132:135],a[20:23],v[76:79]
v_cvt_pk_bf16_f32 v209,v210,v211
v_cvt_pk_bf16_f32 v225,v226,v227
v_mfma_f32_16x16x32_bf16 v[84:87],a[132:135],a[44:47],0
ds_write2st64_b64 v36,v[208:209],v[224:225] offset0:12 offset1:14
v_mfma_f32_16x16x32_bf16 v[84:87],a[128:131],a[40:43],v[84:87]
v_pk_mul_f32 v[212:213],v[212:213],v[62:63] op_sel_hi:[1,0]
v_pk_mul_f32 v[214:215],v[214:215],v[62:63] op_sel_hi:[1,0]
v_pk_mul_f32 v[228:229],v[228:229],v[62:63] op_sel_hi:[1,0]
v_pk_mul_f32 v[230:231],v[230:231],v[62:63] op_sel_hi:[1,0]
v_max3_f32 v44,v44,v75,v76
v_max3_f32 v44,v44,v77,v78
v_mfma_f32_16x16x32_bf16 v[84:87],a[124:127],a[36:39],v[84:87]
buffer_load_dwordx4 v8,s[8:11],s21 offen offset:2048 lds
v_mfma_f32_16x16x32_bf16 v[84:87],a[120:123],a[32:35],v[84:87]
s_add_u32 s21,s21,12288
v_max_f32 v44,v44,v79
v_mov_b32 v45,v44
v_mfma_f32_16x16x32_bf16 v[84:87],a[148:151],a[28:31],v[84:87]
s_add_u32 m0,s22,0
v_permlane32_swap_b32 v45,v44
v_mfma_f32_16x16x32_bf16 v[84:87],a[144:147],a[24:27],v[84:87]
v_max_f32 v44,v44,v45
v_mov_b32 v45,v44
v_cvt_pk_bf16_f32 v212,v212,v213
v_cvt_pk_bf16_f32 v228,v228,v229
v_permlane16_swap_b32 v45,v44
v_pk_mul_f32 v[216:217],v[216:217],v[62:63] op_sel_hi:[1,0]
v_pk_mul_f32 v[218:219],v[218:219],v[62:63] op_sel_hi:[1,0]
v_pk_mul_f32 v[232:233],v[232:233],v[62:63] op_sel_hi:[1,0]
v_pk_mul_f32 v[234:235],v[234:235],v[62:63] op_sel_hi:[1,0]
v_max_f32 v44,v44,v45
v_mul_f32_e64 v13,-s36,v44
v_mfma_f32_16x16x32_bf16 v[92:95],a[144:147],a[48:51],0
v_fma_f32 v72,v72,s36,v13
v_fma_f32 v73,v73,s36,v13
v_mfma_f32_16x16x32_bf16 v[92:95],a[148:151],a[52:55],v[92:95]
v_fma_f32 v74,v74,s36,v13
v_fma_f32 v75,v75,s36,v13
v_mfma_f32_16x16x32_bf16 v[92:95],a[120:123],a[56:59],v[92:95]
v_exp_f32 v72,v72
v_mfma_f32_16x16x32_bf16 v[92:95],a[124:127],a[60:63],v[92:95]
v_exp_f32 v73,v73
v_exp_f32 v74,v74
v_exp_f32 v75,v75
v_pk_mul_f32 v[220:221],v[220:221],v[62:63] op_sel_hi:[1,0]
v_pk_mul_f32 v[222:223],v[222:223],v[62:63] op_sel_hi:[1,0]
v_pk_mul_f32 v[236:237],v[236:237],v[62:63] op_sel_hi:[1,0]
v_pk_mul_f32 v[238:239],v[238:239],v[62:63] op_sel_hi:[1,0]
v_cvt_pk_bf16_f32 v20,v72,v73
v_cvt_pk_bf16_f32 v21,v74,v75
v_mfma_f32_16x16x32_bf16 v[92:95],a[128:131],a[64:67],v[92:95]
v_max3_f32 v48,v48,v83,v84
v_max3_f32 v48,v48,v85,v86
v_mfma_f32_16x16x32_bf16 v[92:95],a[132:135],a[68:71],v[92:95]
v_max_f32 v48,v48,v87
v_mov_b32 v49,v48
v_mfma_f32_16x16x32_bf16 v[100:103],a[132:135],a[92:95],0
v_cvt_pk_bf16_f32 v213,v214,v215
v_permlane32_swap_b32 v49,v48
v_max_f32 v48,v48,v49
v_mov_b32 v49,v48
v_pk_mul_f32 v[240:241],v[240:241],v[62:63] op_sel_hi:[1,0]
v_pk_mul_f32 v[242:243],v[242:243],v[62:63] op_sel_hi:[1,0]
v_permlane16_swap_b32 v49,v48
v_max_f32 v48,v48,v49
v_mfma_f32_16x16x32_bf16 v[100:103],a[128:131],a[88:91],v[100:103]
v_mul_f32_e64 v14,-s36,v48
v_fma_f32 v80,v80,s36,v14
v_mfma_f32_16x16x32_bf16 v[100:103],a[124:127],a[84:87],v[100:103]
v_fma_f32 v81,v81,s36,v14
v_fma_f32 v82,v82,s36,v14
v_mfma_f32_16x16x32_bf16 v[100:103],a[120:123],a[80:83],v[100:103]
v_fma_f32 v83,v83,s36,v14
v_exp_f32 v80,v80
v_mfma_f32_16x16x32_bf16 v[100:103],a[148:151],a[76:79],v[100:103]
v_exp_f32 v81,v81
v_exp_f32 v82,v82
v_exp_f32 v83,v83
v_pk_mul_f32 v[244:245],v[244:245],v[62:63] op_sel_hi:[1,0]
v_pk_mul_f32 v[246:247],v[246:247],v[62:63] op_sel_hi:[1,0]
v_cvt_pk_bf16_f32 v24,v80,v81
v_cvt_pk_bf16_f32 v25,v82,v83
v_mfma_f32_16x16x32_bf16 v[100:103],a[144:147],a[72:75],v[100:103]
v_max3_f32 v52,v52,v91,v92
v_max3_f32 v52,v52,v93,v94
v_mfma_f32_16x16x32_bf16 v[108:111],a[144:147],a[96:99],0
ds_read_b128 a[144:147],v0 offset:12416
v_max_f32 v52,v52,v95
v_mfma_f32_16x16x32_bf16 v[108:111],a[148:151],a[100:103],v[108:111]
ds_read_b128 a[148:151],v1 offset:12416
v_mov_b32 v53,v52
v_max3_f32 v56,v56,v99,v100
v_max3_f32 v56,v56,v101,v102
v_permlane32_swap_b32 v53,v52
v_pk_mul_f32 v[248:249],v[248:249],v[62:63] op_sel_hi:[1,0]
v_pk_mul_f32 v[250:251],v[250:251],v[62:63] op_sel_hi:[1,0]
v_max_f32 v52,v52,v53
v_mov_b32 v53,v52
v_mfma_f32_16x16x32_bf16 v[108:111],a[120:123],a[104:107],v[108:111]
ds_read_b128 a[120:123],v0 offset:12544
v_permlane16_swap_b32 v53,v52
v_mfma_f32_16x16x32_bf16 v[108:111],a[124:127],a[108:111],v[108:111]
ds_read_b128 a[124:127],v1 offset:12544
v_max_f32 v52,v52,v53
v_mfma_f32_16x16x32_bf16 v[108:111],a[128:131],a[112:115],v[108:111]
ds_read_b128 a[128:131],v0 offset:18432
v_mul_f32_e64 v15,-s36,v52
v_mfma_f32_16x16x32_bf16 v[108:111],a[132:135],a[116:119],v[108:111]
ds_read_b128 a[132:135],v1 offset:18432
v_fma_f32 v88,v88,s36,v15
v_fma_f32 v89,v89,s36,v15
v_fma_f32 v90,v90,s36,v15
v_fma_f32 v91,v91,s36,v15
v_pk_mul_f32 v[252:253],v[252:253],v[62:63] op_sel_hi:[1,0]
v_pk_mul_f32 v[254:255],v[254:255],v[62:63] op_sel_hi:[1,0]
v_exp_f32 v88,v88
v_exp_f32 v89,v89
v_mfma_f32_16x16x32_bf16 v[72:75],a[136:139],a[0:3],0
v_exp_f32 v90,v90
v_mfma_f32_16x16x32_bf16 v[72:75],a[140:143],a[4:7],v[72:75]
s_waitcnt lgkmcnt(3)
v_exp_f32 v91,v91
v_mfma_f32_16x16x32_bf16 v[72:75],a[144:147],a[8:11],v[72:75]
v_cvt_pk_bf16_f32 v28,v88,v89
v_cvt_pk_bf16_f32 v29,v90,v91
v_mfma_f32_16x16x32_bf16 v[72:75],a[148:151],a[12:15],v[72:75]
v_max_f32 v56,v56,v103
v_mov_b32 v57,v56
v_mfma_f32_16x16x32_bf16 v[72:75],a[120:123],a[16:19],v[72:75]
s_waitcnt lgkmcnt(0)
v_max3_f32 v40,v40,v107,v108
v_permlane32_swap_b32 v57,v56
v_mfma_f32_16x16x32_bf16 v[72:75],a[124:127],a[20:23],v[72:75]
v_max_f32 v56,v56,v57
v_mov_b32 v57,v56
v_mfma_f32_16x16x32_bf16 v[80:83],a[124:127],a[44:47],0
v_max3_f32 v40,v40,v109,v110
v_permlane16_swap_b32 v57,v56
v_mfma_f32_16x16x32_bf16 v[80:83],a[120:123],a[40:43],v[80:83]
v_max_f32 v56,v56,v57
v_mul_f32_e64 v16,-s36,v56
v_mfma_f32_16x16x32_bf16 v[80:83],a[148:151],a[36:39],v[80:83]
v_fma_f32 v96,v96,s36,v16
v_fma_f32 v97,v97,s36,v16
v_mfma_f32_16x16x32_bf16 v[80:83],a[144:147],a[32:35],v[80:83]
v_fma_f32 v98,v98,s36,v16
v_fma_f32 v99,v99,s36,v16
v_mfma_f32_16x16x32_bf16 v[80:83],a[140:143],a[28:31],v[80:83]
v_exp_f32 v96,v96
v_mfma_f32_16x16x32_bf16 v[80:83],a[136:139],a[24:27],v[80:83]
v_exp_f32 v97,v97
v_mfma_f32_16x16x32_bf16 v[88:91],a[136:139],a[48:51],0
v_exp_f32 v98,v98
v_mfma_f32_16x16x32_bf16 v[88:91],a[140:143],a[52:55],v[88:91]
v_exp_f32 v99,v99
v_mfma_f32_16x16x32_bf16 v[88:91],a[144:147],a[56:59],v[88:91]
v_cvt_pk_bf16_f32 v32,v96,v97
v_cvt_pk_bf16_f32 v33,v98,v99
v_mfma_f32_16x16x32_bf16 v[88:91],a[148:151],a[60:63],v[88:91]
v_max_f32 v40,v40,v111
v_mov_b32 v41,v40
v_mfma_f32_16x16x32_bf16 v[88:91],a[120:123],a[64:67],v[88:91]
v_cvt_pk_bf16_f32 v229,v230,v231
v_permlane32_swap_b32 v41,v40
v_mfma_f32_16x16x32_bf16 v[88:91],a[124:127],a[68:71],v[88:91]
ds_write2st64_b64 v37,v[212:213],v[228:229] offset0:12 offset1:14
v_mfma_f32_16x16x32_bf16 v[96:99],a[124:127],a[92:95],0
v_max_f32 v40,v40,v41
v_mov_b32 v41,v40
v_mfma_f32_16x16x32_bf16 v[96:99],a[120:123],a[88:91],v[96:99]
v_cvt_pk_bf16_f32 v216,v216,v217
v_permlane16_swap_b32 v41,v40
v_mfma_f32_16x16x32_bf16 v[96:99],a[148:151],a[84:87],v[96:99]
v_cvt_pk_bf16_f32 v232,v232,v233
v_max_f32 v40,v40,v41
v_mfma_f32_16x16x32_bf16 v[96:99],a[144:147],a[80:83],v[96:99]
v_cvt_pk_bf16_f32 v220,v220,v221
v_cvt_pk_bf16_f32 v236,v236,v237
v_mfma_f32_16x16x32_bf16 v[96:99],a[140:143],a[76:79],v[96:99]
v_cvt_pk_bf16_f32 v217,v218,v219
v_cvt_pk_bf16_f32 v233,v234,v235
v_mfma_f32_16x16x32_bf16 v[96:99],a[136:139],a[72:75],v[96:99]
ds_write2st64_b64 v38,v[216:217],v[232:233] offset0:12 offset1:14
v_mul_f32_e64 v17,-s36,v40
v_cvt_pk_bf16_f32 v240,v240,v241
v_cvt_pk_bf16_f32 v221,v222,v223
v_cvt_pk_bf16_f32 v237,v238,v239
v_fma_f32 v104,v104,s36,v17
v_fma_f32 v105,v105,s36,v17
v_fma_f32 v106,v106,s36,v17
v_fma_f32 v107,v107,s36,v17
v_cvt_pk_bf16_f32 v244,v244,v245
v_cvt_pk_bf16_f32 v241,v242,v243
v_exp_f32 v104,v104
ds_write2st64_b64 v39,v[220:221],v[236:237] offset0:12 offset1:14
v_exp_f32 v105,v105
v_exp_f32 v106,v106
v_exp_f32 v107,v107
v_cvt_pk_bf16_f32 v245,v246,v247
v_fma_f32 v76,v76,s36,v13
v_fma_f32 v77,v77,s36,v13
v_fma_f32 v78,v78,s36,v13
v_fma_f32 v79,v79,s36,v13
ds_write_b64 v36,v[240:241] offset:8192
v_cvt_pk_bf16_f32 v36,v104,v105
v_exp_f32 v76,v76
v_exp_f32 v77,v77
ds_write_b64 v37,v[244:245] offset:8192
v_cvt_pk_bf16_f32 v37,v106,v107
v_mfma_f32_16x16x32_bf16 v[104:107],a[136:139],a[96:99],0
ds_read_b128 a[136:139],v0 offset:18560
v_exp_f32 v78,v78
v_mfma_f32_16x16x32_bf16 v[104:107],a[140:143],a[100:103],v[104:107]
ds_read_b128 a[140:143],v1 offset:18560
v_exp_f32 v79,v79
v_mfma_f32_16x16x32_bf16 v[104:107],a[144:147],a[104:107],v[104:107]
ds_read_b128 a[144:147],v0 offset:18688
v_cvt_pk_bf16_f32 v22,v76,v77
v_mfma_f32_16x16x32_bf16 v[104:107],a[148:151],a[108:111],v[104:107]
s_waitcnt vmcnt(8)
s_barrier
v_mfma_f32_16x16x32_bf16 v[104:107],a[120:123],a[112:115],v[104:107]
ds_read_b128 a[148:151],v1 offset:18688
buffer_load_dwordx4 v6,s[4:7],s20 offen offset:0 lds
v_mfma_f32_16x16x32_bf16 v[104:107],a[124:127],a[116:119],v[104:107]
v_cvt_pk_bf16_f32 v23,v78,v79
v_fma_f32 v84,v84,s36,v14
v_mfma_f32_16x16x32_bf16 v[76:79],a[128:131],a[0:3],0
v_fma_f32 v85,v85,s36,v14
v_fma_f32 v86,v86,s36,v14
v_mfma_f32_16x16x32_bf16 v[76:79],a[132:135],a[4:7],v[76:79]
s_waitcnt lgkmcnt(2)
v_fma_f32 v87,v87,s36,v14
v_exp_f32 v84,v84
v_mfma_f32_16x16x32_bf16 v[76:79],a[136:139],a[8:11],v[76:79]
v_exp_f32 v85,v85
v_mfma_f32_16x16x32_bf16 v[76:79],a[140:143],a[12:15],v[76:79]
s_waitcnt lgkmcnt(1)
v_exp_f32 v86,v86
v_mfma_f32_16x16x32_bf16 v[76:79],a[144:147],a[16:19],v[76:79]
buffer_load_dwordx4 v7,s[4:7],s20 offen offset:1024 lds
s_waitcnt lgkmcnt(0)
v_mfma_f32_16x16x32_bf16 v[76:79],a[148:151],a[20:23],v[76:79]
v_exp_f32 v87,v87
v_cvt_pk_bf16_f32 v26,v84,v85
v_cvt_pk_bf16_f32 v27,v86,v87
v_mfma_f32_16x16x32_bf16 v[84:87],a[148:151],a[44:47],0
v_fma_f32 v92,v92,s36,v15
v_fma_f32 v93,v93,s36,v15
v_mfma_f32_16x16x32_bf16 v[84:87],a[144:147],a[40:43],v[84:87]
ds_read_b64_tr_b16 a[120:121],v2 offset:0
v_fma_f32 v94,v94,s36,v15
v_mfma_f32_16x16x32_bf16 v[84:87],a[140:143],a[36:39],v[84:87]
ds_read_b64_tr_b16 a[122:123],v2 offset:6144
v_fma_f32 v95,v95,s36,v15
v_mfma_f32_16x16x32_bf16 v[84:87],a[136:139],a[32:35],v[84:87]
buffer_load_dwordx4 v8,s[4:7],s20 offen offset:2048 lds
v_mfma_f32_16x16x32_bf16 v[84:87],a[132:135],a[28:31],v[84:87]
s_add_u32 s20,s20,12288
ds_read_b64_tr_b16 a[124:125],v3 offset:0
v_exp_f32 v92,v92
v_mfma_f32_16x16x32_bf16 v[84:87],a[128:131],a[24:27],v[84:87]
ds_read_b64_tr_b16 a[126:127],v3 offset:6144
v_exp_f32 v93,v93
v_exp_f32 v94,v94
v_exp_f32 v95,v95
v_cvt_pk_bf16_f32 v30,v92,v93
v_cvt_pk_bf16_f32 v31,v94,v95
v_mfma_f32_16x16x32_bf16 v[92:95],a[128:131],a[48:51],0
v_fma_f32 v100,v100,s36,v16
v_fma_f32 v101,v101,s36,v16
v_mfma_f32_16x16x32_bf16 v[92:95],a[132:135],a[52:55],v[92:95]
v_fma_f32 v102,v102,s36,v16
v_fma_f32 v103,v103,s36,v16
v_mfma_f32_16x16x32_bf16 v[92:95],a[136:139],a[56:59],v[92:95]
v_exp_f32 v100,v100
v_mfma_f32_16x16x32_bf16 v[92:95],a[140:143],a[60:63],v[92:95]
v_exp_f32 v101,v101
v_mfma_f32_16x16x32_bf16 v[92:95],a[144:147],a[64:67],v[92:95]
v_exp_f32 v102,v102
v_mfma_f32_16x16x32_bf16 v[92:95],a[148:151],a[68:71],v[92:95]
v_exp_f32 v103,v103
v_cvt_pk_bf16_f32 v34,v100,v101
v_cvt_pk_bf16_f32 v35,v102,v103
v_mfma_f32_16x16x32_bf16 v[100:103],a[148:151],a[92:95],0
v_cvt_pk_bf16_f32 v248,v248,v249
v_fma_f32 v108,v108,s36,v17
v_smfmac_f32_16x16x64_bf16 v[64:67],a[152:155],v[28:35],v18
v_fma_f32 v109,v109,s36,v17
v_mfma_f32_16x16x32_bf16 v[100:103],a[144:147],a[88:91],v[100:103]
v_fma_f32 v110,v110,s36,v17
v_fma_f32 v111,v111,s36,v17
v_mfma_f32_16x16x32_bf16 v[100:103],a[140:143],a[84:87],v[100:103]
v_cvt_pk_bf16_f32 v252,v252,v253
v_cvt_pk_bf16_f32 v249,v250,v251
v_mfma_f32_16x16x32_bf16 v[100:103],a[136:139],a[80:83],v[100:103]
ds_write_b64 v38,v[248:249] offset:8192
v_mfma_f32_16x16x32_bf16 v[100:103],a[132:135],a[76:79],v[100:103]
v_exp_f32 v108,v108
v_mfma_f32_16x16x32_bf16 v[100:103],a[128:131],a[72:75],v[100:103]
v_exp_f32 v109,v109
v_exp_f32 v110,v110
v_exp_f32 v111,v111
v_cvt_pk_bf16_f32 v253,v254,v255
ds_write_b64 v39,v[252:253] offset:8192
v_cvt_pk_bf16_f32 v38,v108,v109
v_cvt_pk_bf16_f32 v39,v110,v111
v_mfma_f32_16x16x32_bf16 v[108:111],a[128:131],a[96:99],0
ds_read_b64_tr_b16 a[128:129],v4 offset:0
v_mov_b32 v62,0
v_mfma_f32_16x16x32_bf16 v[108:111],a[132:135],a[100:103],v[108:111]
ds_read_b64_tr_b16 a[130:131],v4 offset:6144
v_fma_f32 v72,v72,s36,v13
v_smfmac_f32_16x16x64_bf16 v[60:63],a[152:155],v[20:27],v18
ds_read_b64_tr_b16 a[132:133],v5 offset:0
v_mfma_f32_16x16x32_bf16 v[108:111],a[136:139],a[104:107],v[108:111]
ds_read_b64_tr_b16 a[134:135],v5 offset:6144
v_fma_f32 v73,v73,s36,v13
v_mfma_f32_16x16x32_bf16 v[108:111],a[140:143],a[108:111],v[108:111]
v_fma_f32 v74,v74,s36,v13
v_fma_f32 v75,v75,s36,v13
v_mfma_f32_16x16x32_bf16 v[108:111],a[144:147],a[112:115],v[108:111]
v_fma_f32 v80,v80,s36,v14
v_fma_f32 v81,v81,s36,v14
v_mfma_f32_16x16x32_bf16 v[108:111],a[148:151],a[116:119],v[108:111]
v_fma_f32 v82,v82,s36,v14
v_fma_f32 v83,v83,s36,v14
v_fma_f32 v88,v88,s36,v15
v_fma_f32 v89,v89,s36,v15
v_exp_f32 v72,v72
v_exp_f32 v73,v73
v_exp_f32 v74,v74
v_exp_f32 v75,v75
v_exp_f32 v80,v80
v_exp_f32 v81,v81
v_exp_f32 v82,v82
v_exp_f32 v83,v83
v_exp_f32 v88,v88
v_exp_f32 v89,v89
v_cvt_pk_bf16_f32 v44,v72,v73
v_cvt_pk_bf16_f32 v45,v74,v75
v_cvt_pk_bf16_f32 v48,v80,v81
v_cvt_pk_bf16_f32 v49,v82,v83
v_cvt_pk_bf16_f32 v52,v88,v89
s_waitcnt lgkmcnt(0)
v_mfma_f32_16x16x32_bf16 v[160:163],a[120:123],v[20:23],0
s_add_u32 m0,s23,0
ds_read_b64_tr_b16 a[136:137],v2 offset:128
v_fma_f32 v90,v90,s36,v15
v_mfma_f32_16x16x32_bf16 v[164:167],a[124:127],v[20:23],0
ds_read_b64_tr_b16 a[138:139],v2 offset:6272
v_fma_f32 v91,v91,s36,v15
v_mfma_f32_16x16x32_bf16 v[212:215],a[124:127],v[24:27],0
ds_read_b64_tr_b16 a[140:141],v3 offset:128
v_fma_f32 v96,v96,s36,v16
v_mfma_f32_16x16x32_bf16 v[208:211],a[120:123],v[24:27],0
ds_read_b64_tr_b16 a[142:143],v3 offset:6272
v_fma_f32 v97,v97,s36,v16
v_mfma_f32_16x16x32_bf16 v[112:115],a[120:123],v[28:31],0
ds_read_b64_tr_b16 a[144:145],v4 offset:128
v_fma_f32 v98,v98,s36,v16
v_mfma_f32_16x16x32_bf16 v[116:119],a[124:127],v[28:31],0
ds_read_b64_tr_b16 a[146:147],v4 offset:6272
v_fma_f32 v99,v99,s36,v16
v_mfma_f32_16x16x32_bf16 a[164:167],a[124:127],v[32:35],0
ds_read_b64_tr_b16 a[148:149],v5 offset:128
v_fma_f32 v104,v104,s36,v17
v_mfma_f32_16x16x32_bf16 a[160:163],a[120:123],v[32:35],0
ds_read_b64_tr_b16 a[150:151],v5 offset:6272
v_fma_f32 v105,v105,s36,v17
v_mfma_f32_16x16x32_bf16 a[208:211],a[120:123],v[36:39],0
ds_read_b64_tr_b16 a[120:121],v2 offset:256
v_fma_f32 v106,v106,s36,v17
v_mfma_f32_16x16x32_bf16 a[212:215],a[124:127],v[36:39],0
ds_read_b64_tr_b16 a[122:123],v2 offset:6400
v_fma_f32 v107,v107,s36,v17
v_mfma_f32_16x16x32_bf16 a[216:219],a[128:131],v[36:39],0
ds_read_b64_tr_b16 a[124:125],v3 offset:256
v_fma_f32 v76,v76,s36,v13
v_mfma_f32_16x16x32_bf16 a[220:223],a[132:135],v[36:39],0
ds_read_b64_tr_b16 a[126:127],v3 offset:6400
v_fma_f32 v77,v77,s36,v13
v_mfma_f32_16x16x32_bf16 a[172:175],a[132:135],v[32:35],0
v_exp_f32 v90,v90
v_mfma_f32_16x16x32_bf16 a[168:171],a[128:131],v[32:35],0
v_exp_f32 v91,v91
v_mfma_f32_16x16x32_bf16 v[120:123],a[128:131],v[28:31],0
v_cvt_pk_bf16_f32 v53,v90,v91
v_fma_f32 v78,v78,s36,v13
v_mfma_f32_16x16x32_bf16 v[124:127],a[132:135],v[28:31],0
v_exp_f32 v96,v96
v_mfma_f32_16x16x32_bf16 v[220:223],a[132:135],v[24:27],0
v_exp_f32 v97,v97
v_mfma_f32_16x16x32_bf16 v[216:219],a[128:131],v[24:27],0
v_exp_f32 v98,v98
v_mfma_f32_16x16x32_bf16 v[168:171],a[128:131],v[20:23],0
ds_read_b64_tr_b16 a[128:129],v4 offset:256
v_cvt_pk_bf16_f32 v56,v96,v97
v_mfma_f32_16x16x32_bf16 v[172:175],a[132:135],v[20:23],0
s_waitcnt lgkmcnt(1)
ds_read_b64_tr_b16 a[130:131],v4 offset:6400
v_fma_f32 v79,v79,s36,v13
v_mfma_f32_16x16x32_bf16 v[176:179],a[136:139],v[20:23],0
ds_read_b64_tr_b16 a[132:133],v5 offset:256
v_fma_f32 v84,v84,s36,v14
v_mfma_f32_16x16x32_bf16 v[180:183],a[140:143],v[20:23],0
ds_read_b64_tr_b16 a[134:135],v5 offset:6400
v_fma_f32 v85,v85,s36,v14
v_mfma_f32_16x16x32_bf16 v[228:231],a[140:143],v[24:27],0
v_exp_f32 v99,v99
v_mfma_f32_16x16x32_bf16 v[224:227],a[136:139],v[24:27],0
v_cvt_pk_bf16_f32 v57,v98,v99
v_fma_f32 v86,v86,s36,v14
v_mfma_f32_16x16x32_bf16 v[128:131],a[136:139],v[28:31],0
v_exp_f32 v104,v104
v_mfma_f32_16x16x32_bf16 v[132:135],a[140:143],v[28:31],0
v_exp_f32 v105,v105
v_mfma_f32_16x16x32_bf16 a[180:183],a[140:143],v[32:35],0
v_exp_f32 v106,v106
v_mfma_f32_16x16x32_bf16 a[176:179],a[136:139],v[32:35],0
v_exp_f32 v107,v107
v_mfma_f32_16x16x32_bf16 a[224:227],a[136:139],v[36:39],0
v_cvt_pk_bf16_f32 v40,v104,v105
v_cvt_pk_bf16_f32 v41,v106,v107
v_mfma_f32_16x16x32_bf16 a[228:231],a[140:143],v[36:39],0
v_exp_f32 v76,v76
v_mfma_f32_16x16x32_bf16 a[232:235],a[144:147],v[36:39],0
v_exp_f32 v77,v77
v_mfma_f32_16x16x32_bf16 a[236:239],a[148:151],v[36:39],0
v_exp_f32 v78,v78
v_mfma_f32_16x16x32_bf16 a[188:191],a[148:151],v[32:35],0
v_exp_f32 v79,v79
v_mfma_f32_16x16x32_bf16 a[184:187],a[144:147],v[32:35],0
v_cvt_pk_bf16_f32 v46,v76,v77
v_cvt_pk_bf16_f32 v47,v78,v79
v_mfma_f32_16x16x32_bf16 v[136:139],a[144:147],v[28:31],0
v_fma_f32 v87,v87,s36,v14
v_fma_f32 v92,v92,s36,v15
v_mfma_f32_16x16x32_bf16 v[140:143],a[148:151],v[28:31],0
v_exp_f32 v84,v84
v_mfma_f32_16x16x32_bf16 v[236:239],a[148:151],v[24:27],0
v_exp_f32 v85,v85
v_mfma_f32_16x16x32_bf16 v[232:235],a[144:147],v[24:27],0
v_exp_f32 v86,v86
v_mfma_f32_16x16x32_bf16 v[184:187],a[144:147],v[20:23],0
v_exp_f32 v87,v87
v_mfma_f32_16x16x32_bf16 v[188:191],a[148:151],v[20:23],0
v_cvt_pk_bf16_f32 v50,v84,v85
v_cvt_pk_bf16_f32 v51,v86,v87
v_mfma_f32_16x16x32_bf16 v[192:195],a[120:123],v[20:23],0
s_waitcnt vmcnt(36) lgkmcnt(0)
v_fma_f32 v93,v93,s36,v15
v_fma_f32 v94,v94,s36,v15
v_smfmac_f32_16x16x64_bf16 v[60:63],a[152:155],v[44:51],v18
s_barrier
v_mfma_f32_16x16x32_bf16 v[196:199],a[124:127],v[20:23],0
ds_read_b128 a[136:139],v0 offset:24576
v_fma_f32 v95,v95,s36,v15
v_mfma_f32_16x16x32_bf16 v[244:247],a[124:127],v[24:27],0
ds_read_b128 a[140:143],v1 offset:24576
v_fma_f32 v100,v100,s36,v16
v_mfma_f32_16x16x32_bf16 v[240:243],a[120:123],v[24:27],0
ds_read_b128 a[144:147],v0 offset:24704
v_fma_f32 v101,v101,s36,v16
v_mfma_f32_16x16x32_bf16 v[144:147],a[120:123],v[28:31],0
ds_read_b128 a[148:151],v1 offset:24704
v_fma_f32 v102,v102,s36,v16
v_mfma_f32_16x16x32_bf16 v[148:151],a[124:127],v[28:31],0
v_exp_f32 v92,v92
v_mfma_f32_16x16x32_bf16 a[196:199],a[124:127],v[32:35],0
buffer_load_dwordx4 v6,s[8:11],s21 offen offset:0 lds
v_mfma_f32_16x16x32_bf16 a[192:195],a[120:123],v[32:35],0
v_exp_f32 v93,v93
v_mfma_f32_16x16x32_bf16 a[240:243],a[120:123],v[36:39],0
ds_read_b128 a[120:123],v0 offset:24832
v_cvt_pk_bf16_f32 v54,v92,v93
v_mfma_f32_16x16x32_bf16 a[244:247],a[124:127],v[36:39],0
ds_read_b128 a[124:127],v1 offset:24832
v_fma_f32 v103,v103,s36,v16
v_mfma_f32_16x16x32_bf16 a[248:251],a[128:131],v[36:39],0
v_exp_f32 v94,v94
v_mfma_f32_16x16x32_bf16 a[252:255],a[132:135],v[36:39],0
v_exp_f32 v95,v95
v_mfma_f32_16x16x32_bf16 a[204:207],a[132:135],v[32:35],0
v_cvt_pk_bf16_f32 v55,v94,v95
v_fma_f32 v108,v108,s36,v17
v_mfma_f32_16x16x32_bf16 a[200:203],a[128:131],v[32:35],0
v_exp_f32 v100,v100
v_mfma_f32_16x16x32_bf16 v[152:155],a[128:131],v[28:31],0
v_exp_f32 v101,v101
v_mfma_f32_16x16x32_bf16 v[156:159],a[132:135],v[28:31],0
v_exp_f32 v102,v102
v_mfma_f32_16x16x32_bf16 v[252:255],a[132:135],v[24:27],0
v_exp_f32 v103,v103
v_mfma_f32_16x16x32_bf16 v[248:251],a[128:131],v[24:27],0
buffer_load_dwordx4 v7,s[8:11],s21 offen offset:1024 lds
v_mfma_f32_16x16x32_bf16 v[200:203],a[128:131],v[20:23],0
ds_read_b128 a[128:131],v0 offset:30720
v_cvt_pk_bf16_f32 v58,v100,v101
v_mfma_f32_16x16x32_bf16 v[204:207],a[132:135],v[20:23],0
s_waitcnt lgkmcnt(1)
ds_read_b128 a[132:135],v1 offset:30720
v_cvt_pk_bf16_f32 v59,v102,v103
v_mfma_f32_16x16x32_bf16 v[72:75],a[136:139],a[0:3],0
v_fma_f32 v109,v109,s36,v17
v_fma_f32 v110,v110,s36,v17
v_smfmac_f32_16x16x64_bf16 v[64:67],a[152:155],v[52:59],v18
v_fma_f32 v111,v111,s36,v17
v_mfma_f32_16x16x32_bf16 v[72:75],a[140:143],a[4:7],v[72:75]
v_exp_f32 v108,v108
v_mfma_f32_16x16x32_bf16 v[72:75],a[144:147],a[8:11],v[72:75]
v_exp_f32 v109,v109
v_mfma_f32_16x16x32_bf16 v[72:75],a[148:151],a[12:15],v[72:75]
v_exp_f32 v110,v110
v_mfma_f32_16x16x32_bf16 v[72:75],a[120:123],a[16:19],v[72:75]
v_exp_f32 v111,v111
v_mfma_f32_16x16x32_bf16 v[72:75],a[124:127],a[20:23],v[72:75]
v_cvt_pk_bf16_f32 v42,v108,v109
v_cvt_pk_bf16_f32 v43,v110,v111
v_mfma_f32_16x16x32_bf16 v[80:83],a[124:127],a[44:47],0
v_mfma_f32_16x16x32_bf16 v[80:83],a[120:123],a[40:43],v[80:83]
v_smfmac_f32_16x16x64_bf16 v[68:71],a[152:155],v[36:43],v18
buffer_load_dwordx4 v8,s[8:11],s21 offen offset:2048 lds
v_mfma_f32_16x16x32_bf16 v[80:83],a[148:151],a[36:39],v[80:83]
s_add_u32 s21,s21,12288
v_fma_f32 v72,v72,s36,v13
v_fma_f32 v73,v73,s36,v13
v_mfma_f32_16x16x32_bf16 v[80:83],a[144:147],a[32:35],v[80:83]
s_add_u32 m0,s22,12288
v_fma_f32 v74,v74,s36,v13
v_fma_f32 v75,v75,s36,v13
v_mfma_f32_16x16x32_bf16 v[80:83],a[140:143],a[28:31],v[80:83]
v_exp_f32 v72,v72
v_mfma_f32_16x16x32_bf16 v[80:83],a[136:139],a[24:27],v[80:83]
v_exp_f32 v73,v73
v_mfma_f32_16x16x32_bf16 v[88:91],a[136:139],a[48:51],0
v_exp_f32 v74,v74
v_mfma_f32_16x16x32_bf16 v[88:91],a[140:143],a[52:55],v[88:91]
v_exp_f32 v75,v75
v_mfma_f32_16x16x32_bf16 v[88:91],a[144:147],a[56:59],v[88:91]
v_cvt_pk_bf16_f32 v20,v72,v73
v_cvt_pk_bf16_f32 v21,v74,v75
v_mfma_f32_16x16x32_bf16 v[88:91],a[148:151],a[60:63],v[88:91]
v_fma_f32 v80,v80,s36,v14
v_fma_f32 v81,v81,s36,v14
v_mfma_f32_16x16x32_bf16 v[88:91],a[120:123],a[64:67],v[88:91]
v_fma_f32 v82,v82,s36,v14
v_fma_f32 v83,v83,s36,v14
v_mfma_f32_16x16x32_bf16 v[88:91],a[124:127],a[68:71],v[88:91]
v_exp_f32 v80,v80
v_mfma_f32_16x16x32_bf16 v[96:99],a[124:127],a[92:95],0
buffer_load_dwordx4 v6,s[4:7],s20 offen offset:0 lds
v_mfma_f32_16x16x32_bf16 v[96:99],a[120:123],a[88:91],v[96:99]
v_exp_f32 v81,v81
v_mfma_f32_16x16x32_bf16 v[96:99],a[148:151],a[84:87],v[96:99]
v_exp_f32 v82,v82
v_mfma_f32_16x16x32_bf16 v[96:99],a[144:147],a[80:83],v[96:99]
v_fma_f32 v88,v88,s36,v15
v_fma_f32 v89,v89,s36,v15
v_mfma_f32_16x16x32_bf16 v[96:99],a[140:143],a[76:79],v[96:99]
v_exp_f32 v83,v83
v_mfma_f32_16x16x32_bf16 v[96:99],a[136:139],a[72:75],v[96:99]
v_exp_f32 v88,v88
v_mfma_f32_16x16x32_bf16 v[104:107],a[136:139],a[96:99],0
ds_read_b128 a[136:139],v0 offset:30848
v_cvt_pk_bf16_f32 v24,v80,v81
v_mfma_f32_16x16x32_bf16 v[104:107],a[140:143],a[100:103],v[104:107]
ds_read_b128 a[140:143],v1 offset:30848
v_cvt_pk_bf16_f32 v25,v82,v83
v_mfma_f32_16x16x32_bf16 v[104:107],a[144:147],a[104:107],v[104:107]
ds_read_b128 a[144:147],v0 offset:30976
v_mfma_f32_16x16x32_bf16 v[104:107],a[148:151],a[108:111],v[104:107]
ds_read_b128 a[148:151],v1 offset:30976
v_mfma_f32_16x16x32_bf16 v[104:107],a[120:123],a[112:115],v[104:107]
v_exp_f32 v89,v89
v_mfma_f32_16x16x32_bf16 v[104:107],a[124:127],a[116:119],v[104:107]
s_waitcnt lgkmcnt(4)
v_cvt_pk_bf16_f32 v28,v88,v89
v_mfma_f32_16x16x32_bf16 v[76:79],a[128:131],a[0:3],0
buffer_load_dwordx4 v7,s[4:7],s20 offen offset:1024 lds
v_mfma_f32_16x16x32_bf16 v[76:79],a[132:135],a[4:7],v[76:79]
s_waitcnt lgkmcnt(3)
v_mfma_f32_16x16x32_bf16 v[76:79],a[136:139],a[8:11],v[76:79]
s_waitcnt lgkmcnt(2)
v_mfma_f32_16x16x32_bf16 v[76:79],a[140:143],a[12:15],v[76:79]
s_waitcnt lgkmcnt(1)
v_mfma_f32_16x16x32_bf16 v[76:79],a[144:147],a[16:19],v[76:79]
s_waitcnt lgkmcnt(0)
v_mfma_f32_16x16x32_bf16 v[76:79],a[148:151],a[20:23],v[76:79]
v_mfma_f32_16x16x32_bf16 v[84:87],a[148:151],a[44:47],0
v_mfma_f32_16x16x32_bf16 v[84:87],a[144:147],a[40:43],v[84:87]
v_mfma_f32_16x16x32_bf16 v[84:87],a[140:143],a[36:39],v[84:87]
v_mfma_f32_16x16x32_bf16 v[84:87],a[136:139],a[32:35],v[84:87]
v_mfma_f32_16x16x32_bf16 v[84:87],a[132:135],a[28:31],v[84:87]
v_mfma_f32_16x16x32_bf16 v[84:87],a[128:131],a[24:27],v[84:87]
v_mfma_f32_16x16x32_bf16 v[92:95],a[128:131],a[48:51],0
buffer_load_dwordx4 v8,s[4:7],s20 offen offset:2048 lds
v_mfma_f32_16x16x32_bf16 v[92:95],a[132:135],a[52:55],v[92:95]
s_add_u32 s20,s20,12288
v_mfma_f32_16x16x32_bf16 v[92:95],a[136:139],a[56:59],v[92:95]
v_mfma_f32_16x16x32_bf16 v[92:95],a[140:143],a[60:63],v[92:95]
v_mfma_f32_16x16x32_bf16 v[92:95],a[144:147],a[64:67],v[92:95]
v_mfma_f32_16x16x32_bf16 v[92:95],a[148:151],a[68:71],v[92:95]
ds_read_b64_tr_b16 a[120:121],v2 offset:12288
v_mfma_f32_16x16x32_bf16 v[100:103],a[148:151],a[92:95],0
ds_read_b64_tr_b16 a[122:123],v2 offset:18432
v_mfma_f32_16x16x32_bf16 v[100:103],a[144:147],a[88:91],v[100:103]
v_mfma_f32_16x16x32_bf16 v[100:103],a[140:143],a[84:87],v[100:103]
ds_read_b64_tr_b16 a[124:125],v3 offset:12288
v_mfma_f32_16x16x32_bf16 v[100:103],a[136:139],a[80:83],v[100:103]
ds_read_b64_tr_b16 a[126:127],v3 offset:18432
v_mfma_f32_16x16x32_bf16 v[100:103],a[132:135],a[76:79],v[100:103]
v_mfma_f32_16x16x32_bf16 v[100:103],a[128:131],a[72:75],v[100:103]
v_mfma_f32_16x16x32_bf16 v[108:111],a[128:131],a[96:99],0
ds_read_b64_tr_b16 a[128:129],v4 offset:12288
v_mfma_f32_16x16x32_bf16 v[108:111],a[132:135],a[100:103],v[108:111]
ds_read_b64_tr_b16 a[130:131],v4 offset:18432
v_mfma_f32_16x16x32_bf16 v[108:111],a[136:139],a[104:107],v[108:111]
ds_read_b64_tr_b16 a[132:133],v5 offset:12288
v_mfma_f32_16x16x32_bf16 v[108:111],a[140:143],a[108:111],v[108:111]
ds_read_b64_tr_b16 a[134:135],v5 offset:18432
v_mfma_f32_16x16x32_bf16 v[108:111],a[144:147],a[112:115],v[108:111]
v_mfma_f32_16x16x32_bf16 v[108:111],a[148:151],a[116:119],v[108:111]
s_waitcnt lgkmcnt(4)
v_mfma_f32_16x16x32_bf16 v[160:163],a[120:123],v[44:47],v[160:163]
s_add_u32 m0,s23,12288
ds_read_b64_tr_b16 a[136:137],v2 offset:12416
v_fma_f32 v90,v90,s36,v15
v_mfma_f32_16x16x32_bf16 v[164:167],a[124:127],v[44:47],v[164:167]
ds_read_b64_tr_b16 a[138:139],v2 offset:18560
v_fma_f32 v91,v91,s36,v15
v_mfma_f32_16x16x32_bf16 v[212:215],a[124:127],v[48:51],v[212:215]
ds_read_b64_tr_b16 a[140:141],v3 offset:12416
v_fma_f32 v96,v96,s36,v16
v_mfma_f32_16x16x32_bf16 v[208:211],a[120:123],v[48:51],v[208:211]
ds_read_b64_tr_b16 a[142:143],v3 offset:18560
v_fma_f32 v97,v97,s36,v16
v_mfma_f32_16x16x32_bf16 v[112:115],a[120:123],v[52:55],v[112:115]
ds_read_b64_tr_b16 a[144:145],v4 offset:12416
v_fma_f32 v98,v98,s36,v16
v_mfma_f32_16x16x32_bf16 v[116:119],a[124:127],v[52:55],v[116:119]
ds_read_b64_tr_b16 a[146:147],v4 offset:18560
v_fma_f32 v99,v99,s36,v16
v_mfma_f32_16x16x32_bf16 a[164:167],a[124:127],v[56:59],a[164:167]
ds_read_b64_tr_b16 a[148:149],v5 offset:12416
v_fma_f32 v104,v104,s36,v17
v_mfma_f32_16x16x32_bf16 a[160:163],a[120:123],v[56:59],a[160:163]
ds_read_b64_tr_b16 a[150:151],v5 offset:18560
v_fma_f32 v105,v105,s36,v17
v_mfma_f32_16x16x32_bf16 a[208:211],a[120:123],v[40:43],a[208:211]
ds_read_b64_tr_b16 a[120:121],v2 offset:12544
v_fma_f32 v106,v106,s36,v17
v_mfma_f32_16x16x32_bf16 a[212:215],a[124:127],v[40:43],a[212:215]
s_waitcnt lgkmcnt(6)
ds_read_b64_tr_b16 a[122:123],v2 offset:18688
v_fma_f32 v107,v107,s36,v17
v_mfma_f32_16x16x32_bf16 a[216:219],a[128:131],v[40:43],a[216:219]
ds_read_b64_tr_b16 a[124:125],v3 offset:12544
v_fma_f32 v76,v76,s36,v13
v_mfma_f32_16x16x32_bf16 a[220:223],a[132:135],v[40:43],a[220:223]
ds_read_b64_tr_b16 a[126:127],v3 offset:18688
v_fma_f32 v77,v77,s36,v13
v_mfma_f32_16x16x32_bf16 a[172:175],a[132:135],v[56:59],a[172:175]
v_exp_f32 v90,v90
v_mfma_f32_16x16x32_bf16 a[168:171],a[128:131],v[56:59],a[168:171]
v_exp_f32 v91,v91
v_mfma_f32_16x16x32_bf16 v[120:123],a[128:131],v[52:55],v[120:123]
v_cvt_pk_bf16_f32 v29,v90,v91
v_fma_f32 v78,v78,s36,v13
v_mfma_f32_16x16x32_bf16 v[124:127],a[132:135],v[52:55],v[124:127]
v_exp_f32 v96,v96
v_mfma_f32_16x16x32_bf16 v[220:223],a[132:135],v[48:51],v[220:223]
v_exp_f32 v97,v97
v_mfma_f32_16x16x32_bf16 v[216:219],a[128:131],v[48:51],v[216:219]
v_exp_f32 v98,v98
v_mfma_f32_16x16x32_bf16 v[168:171],a[128:131],v[44:47],v[168:171]
ds_read_b64_tr_b16 a[128:129],v4 offset:12544
v_cvt_pk_bf16_f32 v32,v96,v97
v_mfma_f32_16x16x32_bf16 v[172:175],a[132:135],v[44:47],v[172:175]
ds_read_b64_tr_b16 a[130:131],v4 offset:18688
v_fma_f32 v79,v79,s36,v13
v_mfma_f32_16x16x32_bf16 v[176:179],a[136:139],v[44:47],v[176:179]
s_waitcnt lgkmcnt(2)
ds_read_b64_tr_b16 a[132:133],v5 offset:12544
v_fma_f32 v84,v84,s36,v14
v_mfma_f32_16x16x32_bf16 v[180:183],a[140:143],v[44:47],v[180:183]
ds_read_b64_tr_b16 a[134:135],v5 offset:18688
v_fma_f32 v85,v85,s36,v14
v_mfma_f32_16x16x32_bf16 v[228:231],a[140:143],v[48:51],v[228:231]
v_exp_f32 v99,v99
v_mfma_f32_16x16x32_bf16 v[224:227],a[136:139],v[48:51],v[224:227]
v_cvt_pk_bf16_f32 v33,v98,v99
v_fma_f32 v86,v86,s36,v14
v_mfma_f32_16x16x32_bf16 v[128:131],a[136:139],v[52:55],v[128:131]
v_exp_f32 v104,v104
v_mfma_f32_16x16x32_bf16 v[132:135],a[140:143],v[52:55],v[132:135]
v_exp_f32 v105,v105
v_mfma_f32_16x16x32_bf16 a[180:183],a[140:143],v[56:59],a[180:183]
v_exp_f32 v106,v106
v_mfma_f32_16x16x32_bf16 a[176:179],a[136:139],v[56:59],a[176:179]
v_exp_f32 v107,v107
v_mfma_f32_16x16x32_bf16 a[224:227],a[136:139],v[40:43],a[224:227]
v_cvt_pk_bf16_f32 v36,v104,v105
v_cvt_pk_bf16_f32 v37,v106,v107
v_mfma_f32_16x16x32_bf16 a[228:231],a[140:143],v[40:43],a[228:231]
v_exp_f32 v76,v76
v_mfma_f32_16x16x32_bf16 a[232:235],a[144:147],v[40:43],a[232:235]
v_exp_f32 v77,v77
v_mfma_f32_16x16x32_bf16 a[236:239],a[148:151],v[40:43],a[236:239]
v_exp_f32 v78,v78
v_mfma_f32_16x16x32_bf16 a[188:191],a[148:151],v[56:59],a[188:191]
v_exp_f32 v79,v79
v_mfma_f32_16x16x32_bf16 a[184:187],a[144:147],v[56:59],a[184:187]
v_cvt_pk_bf16_f32 v22,v76,v77
v_cvt_pk_bf16_f32 v23,v78,v79
v_mfma_f32_16x16x32_bf16 v[136:139],a[144:147],v[52:55],v[136:139]
v_fma_f32 v87,v87,s36,v14
v_fma_f32 v92,v92,s36,v15
v_mfma_f32_16x16x32_bf16 v[140:143],a[148:151],v[52:55],v[140:143]
v_exp_f32 v84,v84
v_mfma_f32_16x16x32_bf16 v[236:239],a[148:151],v[48:51],v[236:239]
v_exp_f32 v85,v85
v_mfma_f32_16x16x32_bf16 v[232:235],a[144:147],v[48:51],v[232:235]
v_exp_f32 v86,v86
v_mfma_f32_16x16x32_bf16 v[184:187],a[144:147],v[44:47],v[184:187]
v_exp_f32 v87,v87
v_mfma_f32_16x16x32_bf16 v[188:191],a[148:151],v[44:47],v[188:191]
v_cvt_pk_bf16_f32 v26,v84,v85
v_cvt_pk_bf16_f32 v27,v86,v87
v_mfma_f32_16x16x32_bf16 v[192:195],a[120:123],v[44:47],v[192:195]
s_waitcnt vmcnt(6) lgkmcnt(0)
v_fma_f32 v93,v93,s36,v15
v_fma_f32 v94,v94,s36,v15
v_smfmac_f32_16x16x64_bf16 v[60:63],a[152:155],v[20:27],v18
s_barrier
v_mfma_f32_16x16x32_bf16 v[196:199],a[124:127],v[44:47],v[196:199]
ds_read_b128 a[136:139],v0 offset:0
v_fma_f32 v95,v95,s36,v15
v_mfma_f32_16x16x32_bf16 v[244:247],a[124:127],v[48:51],v[244:247]
ds_read_b128 a[140:143],v1 offset:0
v_fma_f32 v100,v100,s36,v16
v_mfma_f32_16x16x32_bf16 v[240:243],a[120:123],v[48:51],v[240:243]
ds_read_b128 a[144:147],v0 offset:128
v_fma_f32 v101,v101,s36,v16
v_mfma_f32_16x16x32_bf16 v[144:147],a[120:123],v[52:55],v[144:147]
ds_read_b128 a[148:151],v1 offset:128
v_fma_f32 v102,v102,s36,v16
v_mfma_f32_16x16x32_bf16 v[148:151],a[124:127],v[52:55],v[148:151]
v_exp_f32 v92,v92
v_mfma_f32_16x16x32_bf16 a[196:199],a[124:127],v[56:59],a[196:199]
buffer_load_dwordx4 v6,s[8:11],s21 offen offset:0 lds
v_mfma_f32_16x16x32_bf16 a[192:195],a[120:123],v[56:59],a[192:195]
v_exp_f32 v93,v93
v_mfma_f32_16x16x32_bf16 a[240:243],a[120:123],v[40:43],a[240:243]
ds_read_b128 a[120:123],v0 offset:256
v_cvt_pk_bf16_f32 v30,v92,v93
v_mfma_f32_16x16x32_bf16 a[244:247],a[124:127],v[40:43],a[244:247]
ds_read_b128 a[124:127],v1 offset:256
v_fma_f32 v103,v103,s36,v16
v_mfma_f32_16x16x32_bf16 a[248:251],a[128:131],v[40:43],a[248:251]
v_exp_f32 v94,v94
v_mfma_f32_16x16x32_bf16 a[252:255],a[132:135],v[40:43],a[252:255]
v_exp_f32 v95,v95
v_mfma_f32_16x16x32_bf16 a[204:207],a[132:135],v[56:59],a[204:207]
v_cvt_pk_bf16_f32 v31,v94,v95
v_fma_f32 v108,v108,s36,v17
v_mfma_f32_16x16x32_bf16 a[200:203],a[128:131],v[56:59],a[200:203]
v_exp_f32 v100,v100
v_mfma_f32_16x16x32_bf16 v[152:155],a[128:131],v[52:55],v[152:155]
v_exp_f32 v101,v101
v_mfma_f32_16x16x32_bf16 v[156:159],a[132:135],v[52:55],v[156:159]
v_exp_f32 v102,v102
v_mfma_f32_16x16x32_bf16 v[252:255],a[132:135],v[48:51],v[252:255]
v_exp_f32 v103,v103
v_mfma_f32_16x16x32_bf16 v[248:251],a[128:131],v[48:51],v[248:251]
buffer_load_dwordx4 v7,s[8:11],s21 offen offset:1024 lds
v_mfma_f32_16x16x32_bf16 v[200:203],a[128:131],v[44:47],v[200:203]
ds_read_b128 a[128:131],v0 offset:6144
v_cvt_pk_bf16_f32 v34,v100,v101
v_mfma_f32_16x16x32_bf16 v[204:207],a[132:135],v[44:47],v[204:207]
s_waitcnt lgkmcnt(1)
ds_read_b128 a[132:135],v1 offset:6144
v_cvt_pk_bf16_f32 v35,v102,v103
v_mfma_f32_16x16x32_bf16 v[72:75],a[136:139],a[0:3],0
v_fma_f32 v109,v109,s36,v17
v_fma_f32 v110,v110,s36,v17
v_smfmac_f32_16x16x64_bf16 v[64:67],a[152:155],v[28:35],v18
v_fma_f32 v111,v111,s36,v17
v_mfma_f32_16x16x32_bf16 v[72:75],a[140:143],a[4:7],v[72:75]
v_exp_f32 v108,v108
v_mfma_f32_16x16x32_bf16 v[72:75],a[144:147],a[8:11],v[72:75]
v_exp_f32 v109,v109
v_mfma_f32_16x16x32_bf16 v[72:75],a[148:151],a[12:15],v[72:75]
v_exp_f32 v110,v110
v_mfma_f32_16x16x32_bf16 v[72:75],a[120:123],a[16:19],v[72:75]
v_exp_f32 v111,v111
v_mfma_f32_16x16x32_bf16 v[72:75],a[124:127],a[20:23],v[72:75]
v_cvt_pk_bf16_f32 v38,v108,v109
v_cvt_pk_bf16_f32 v39,v110,v111
v_mfma_f32_16x16x32_bf16 v[80:83],a[124:127],a[44:47],0
v_mfma_f32_16x16x32_bf16 v[80:83],a[120:123],a[40:43],v[80:83]
v_mfma_f32_16x16x32_bf16 v[80:83],a[148:151],a[36:39],v[80:83]
buffer_load_dwordx4 v8,s[8:11],s21 offen offset:2048 lds
v_mfma_f32_16x16x32_bf16 v[80:83],a[144:147],a[32:35],v[80:83]
s_add_u32 s21,s21,12288
v_fma_f32 v72,v72,s36,v13
v_fma_f32 v73,v73,s36,v13
v_mfma_f32_16x16x32_bf16 v[80:83],a[140:143],a[28:31],v[80:83]
s_add_u32 m0,s22,24576
v_fma_f32 v74,v74,s36,v13
v_fma_f32 v75,v75,s36,v13
v_mfma_f32_16x16x32_bf16 v[80:83],a[136:139],a[24:27],v[80:83]
v_exp_f32 v72,v72
v_mfma_f32_16x16x32_bf16 v[88:91],a[136:139],a[48:51],0
v_exp_f32 v73,v73
v_mfma_f32_16x16x32_bf16 v[88:91],a[140:143],a[52:55],v[88:91]
v_exp_f32 v74,v74
v_mfma_f32_16x16x32_bf16 v[88:91],a[144:147],a[56:59],v[88:91]
v_exp_f32 v75,v75
v_mfma_f32_16x16x32_bf16 v[88:91],a[148:151],a[60:63],v[88:91]
v_fma_f32 v80,v80,s36,v14
v_fma_f32 v81,v81,s36,v14
v_mfma_f32_16x16x32_bf16 v[88:91],a[120:123],a[64:67],v[88:91]
v_fma_f32 v82,v82,s36,v14
v_fma_f32 v83,v83,s36,v14
v_mfma_f32_16x16x32_bf16 v[88:91],a[124:127],a[68:71],v[88:91]
v_exp_f32 v80,v80
v_mfma_f32_16x16x32_bf16 v[96:99],a[124:127],a[92:95],0
v_exp_f32 v81,v81
v_mfma_f32_16x16x32_bf16 v[96:99],a[120:123],a[88:91],v[96:99]
v_exp_f32 v82,v82
v_mfma_f32_16x16x32_bf16 v[96:99],a[148:151],a[84:87],v[96:99]
buffer_load_dwordx4 v6,s[4:7],s20 offen offset:0 lds
v_mfma_f32_16x16x32_bf16 v[96:99],a[144:147],a[80:83],v[96:99]
v_fma_f32 v88,v88,s36,v15
v_fma_f32 v89,v89,s36,v15
v_mfma_f32_16x16x32_bf16 v[96:99],a[140:143],a[76:79],v[96:99]
v_exp_f32 v83,v83
v_mfma_f32_16x16x32_bf16 v[96:99],a[136:139],a[72:75],v[96:99]
v_exp_f32 v88,v88
v_mfma_f32_16x16x32_bf16 v[104:107],a[136:139],a[96:99],0
ds_read_b128 a[136:139],v0 offset:6272
v_cvt_pk_bf16_f32 v44,v72,v73
v_mfma_f32_16x16x32_bf16 v[104:107],a[140:143],a[100:103],v[104:107]
ds_read_b128 a[140:143],v1 offset:6272
v_cvt_pk_bf16_f32 v45,v74,v75
v_mfma_f32_16x16x32_bf16 v[104:107],a[144:147],a[104:107],v[104:107]
ds_read_b128 a[144:147],v0 offset:6400
v_cvt_pk_bf16_f32 v48,v80,v81
v_mfma_f32_16x16x32_bf16 v[104:107],a[148:151],a[108:111],v[104:107]
ds_read_b128 a[148:151],v1 offset:6400
v_cvt_pk_bf16_f32 v49,v82,v83
v_mfma_f32_16x16x32_bf16 v[104:107],a[120:123],a[112:115],v[104:107]
v_exp_f32 v89,v89
v_mfma_f32_16x16x32_bf16 v[104:107],a[124:127],a[116:119],v[104:107]
s_waitcnt lgkmcnt(4)
v_cvt_pk_bf16_f32 v52,v88,v89
v_mfma_f32_16x16x32_bf16 v[76:79],a[128:131],a[0:3],0
v_mfma_f32_16x16x32_bf16 v[76:79],a[132:135],a[4:7],v[76:79]
buffer_load_dwordx4 v7,s[4:7],s20 offen offset:1024 lds
s_waitcnt lgkmcnt(3)
v_mfma_f32_16x16x32_bf16 v[76:79],a[136:139],a[8:11],v[76:79]
s_waitcnt lgkmcnt(2)
v_mfma_f32_16x16x32_bf16 v[76:79],a[140:143],a[12:15],v[76:79]
s_waitcnt lgkmcnt(1)
v_mfma_f32_16x16x32_bf16 v[76:79],a[144:147],a[16:19],v[76:79]
s_waitcnt lgkmcnt(0)
v_mfma_f32_16x16x32_bf16 v[76:79],a[148:151],a[20:23],v[76:79]
v_mfma_f32_16x16x32_bf16 v[84:87],a[148:151],a[44:47],0
v_mfma_f32_16x16x32_bf16 v[84:87],a[144:147],a[40:43],v[84:87]
v_mfma_f32_16x16x32_bf16 v[84:87],a[140:143],a[36:39],v[84:87]
v_mfma_f32_16x16x32_bf16 v[84:87],a[136:139],a[32:35],v[84:87]
v_mfma_f32_16x16x32_bf16 v[84:87],a[132:135],a[28:31],v[84:87]
v_mfma_f32_16x16x32_bf16 v[84:87],a[128:131],a[24:27],v[84:87]
v_mfma_f32_16x16x32_bf16 v[92:95],a[128:131],a[48:51],0
v_mfma_f32_16x16x32_bf16 v[92:95],a[132:135],a[52:55],v[92:95]
buffer_load_dwordx4 v8,s[4:7],s20 offen offset:2048 lds
v_mfma_f32_16x16x32_bf16 v[92:95],a[136:139],a[56:59],v[92:95]
s_add_u32 s20,s20,12288
v_mfma_f32_16x16x32_bf16 v[92:95],a[140:143],a[60:63],v[92:95]
v_mfma_f32_16x16x32_bf16 v[92:95],a[144:147],a[64:67],v[92:95]
v_mfma_f32_16x16x32_bf16 v[92:95],a[148:151],a[68:71],v[92:95]
v_mfma_f32_16x16x32_bf16 v[100:103],a[148:151],a[92:95],0
v_mfma_f32_16x16x32_bf16 v[100:103],a[144:147],a[88:91],v[100:103]
ds_read_b64_tr_b16 a[120:121],v2 offset:24576
v_mfma_f32_16x16x32_bf16 v[100:103],a[140:143],a[84:87],v[100:103]
ds_read_b64_tr_b16 a[122:123],v2 offset:30720
v_mfma_f32_16x16x32_bf16 v[100:103],a[136:139],a[80:83],v[100:103]
ds_read_b64_tr_b16 a[124:125],v3 offset:24576
v_mfma_f32_16x16x32_bf16 v[100:103],a[132:135],a[76:79],v[100:103]
ds_read_b64_tr_b16 a[126:127],v3 offset:30720
v_mfma_f32_16x16x32_bf16 v[100:103],a[128:131],a[72:75],v[100:103]
v_mfma_f32_16x16x32_bf16 v[108:111],a[128:131],a[96:99],0
ds_read_b64_tr_b16 a[128:129],v4 offset:24576
v_mfma_f32_16x16x32_bf16 v[108:111],a[132:135],a[100:103],v[108:111]
ds_read_b64_tr_b16 a[130:131],v4 offset:30720
v_mfma_f32_16x16x32_bf16 v[108:111],a[136:139],a[104:107],v[108:111]
ds_read_b64_tr_b16 a[132:133],v5 offset:24576
v_mfma_f32_16x16x32_bf16 v[108:111],a[140:143],a[108:111],v[108:111]
ds_read_b64_tr_b16 a[134:135],v5 offset:30720
v_mfma_f32_16x16x32_bf16 v[108:111],a[144:147],a[112:115],v[108:111]
v_mfma_f32_16x16x32_bf16 v[108:111],a[148:151],a[116:119],v[108:111]
s_mov_b32 s38,0
s_branch L_loop5
L_loop4:
.p2align 6
L_loop4w0:
s_waitcnt lgkmcnt(3)
v_mfma_f32_16x16x32_bf16 v[160:163],a[120:123],v[20:23],v[160:163]
ds_read_b128 a[156:159],v10 offset:0
v_fma_f32 v82,v82,s36,v14
v_mfma_f32_16x16x32_bf16 v[164:167],a[124:127],v[20:23],v[164:167]
ds_read_b64_tr_b16 a[136:137],v2 offset:24704
v_fma_f32 v83,v83,s36,v14
v_mfma_f32_16x16x32_bf16 v[212:215],a[124:127],v[24:27],v[212:215]
ds_read_b64_tr_b16 a[138:139],v2 offset:30848
v_fma_f32 v88,v88,s36,v15
v_mfma_f32_16x16x32_bf16 v[208:211],a[120:123],v[24:27],v[208:211]
ds_read_b64_tr_b16 a[140:141],v3 offset:24704
v_fma_f32 v89,v89,s36,v15
v_mfma_f32_16x16x32_bf16 v[112:115],a[120:123],v[28:31],v[112:115]
ds_read_b64_tr_b16 a[142:143],v3 offset:30848
v_fma_f32 v90,v90,s36,v15
v_mfma_f32_16x16x32_bf16 v[116:119],a[124:127],v[28:31],v[116:119]
ds_read_b64_tr_b16 a[144:145],v4 offset:24704
v_fma_f32 v91,v91,s36,v15
v_mfma_f32_16x16x32_bf16 a[164:167],a[124:127],v[32:35],a[164:167]
ds_read_b64_tr_b16 a[146:147],v4 offset:30848
v_fma_f32 v96,v96,s36,v16
v_mfma_f32_16x16x32_bf16 a[160:163],a[120:123],v[32:35],a[160:163]
s_waitcnt lgkmcnt(6)
ds_read_b64_tr_b16 a[148:149],v5 offset:24704
v_fma_f32 v97,v97,s36,v16
v_mfma_f32_16x16x32_bf16 a[168:171],a[128:131],v[32:35],a[168:171]
ds_read_b64_tr_b16 a[150:151],v5 offset:30848
v_fma_f32 v98,v98,s36,v16
v_mfma_f32_16x16x32_bf16 a[172:175],a[132:135],v[32:35],a[172:175]
ds_read_b64_tr_b16 a[120:121],v2 offset:24832
v_fma_f32 v99,v99,s36,v16
v_mfma_f32_16x16x32_bf16 v[124:127],a[132:135],v[28:31],v[124:127]
ds_read_b64_tr_b16 a[122:123],v2 offset:30976
v_fma_f32 v76,v76,s36,v13
v_mfma_f32_16x16x32_bf16 v[120:123],a[128:131],v[28:31],v[120:123]
ds_read_b64_tr_b16 a[124:125],v3 offset:24832
v_fma_f32 v77,v77,s36,v13
v_mfma_f32_16x16x32_bf16 v[216:219],a[128:131],v[24:27],v[216:219]
ds_read_b64_tr_b16 a[126:127],v3 offset:30976
v_fma_f32 v78,v78,s36,v13
v_mfma_f32_16x16x32_bf16 v[220:223],a[132:135],v[24:27],v[220:223]
v_exp_f32 v82,v82
v_mfma_f32_16x16x32_bf16 v[172:175],a[132:135],v[20:23],v[172:175]
ds_read_b64_tr_b16 a[132:133],v5 offset:24832
v_fma_f32 v79,v79,s36,v13
v_mfma_f32_16x16x32_bf16 v[168:171],a[128:131],v[20:23],v[168:171]
s_waitcnt lgkmcnt(5)
ds_read_b64_tr_b16 a[128:129],v4 offset:24832
v_fma_f32 v84,v84,s36,v14
v_mfma_f32_16x16x32_bf16 v[176:179],a[136:139],v[20:23],v[176:179]
buffer_store_dwordx4 a[156:159],v9,s[16:19],s27 offen offset:0 nt
ds_read_b64_tr_b16 a[130:131],v4 offset:30976
ds_read_b128 a[156:159],v10 offset:1024
v_mfma_f32_16x16x32_bf16 v[180:183],a[140:143],v[20:23],v[180:183]
ds_read_b64_tr_b16 a[134:135],v5 offset:30976
v_mfma_f32_16x16x32_bf16 v[228:231],a[140:143],v[24:27],v[228:231]
v_exp_f32 v83,v83
v_mfma_f32_16x16x32_bf16 v[224:227],a[136:139],v[24:27],v[224:227]
v_cvt_pk_bf16_f32 v49,v82,v83
v_fma_f32 v85,v85,s36,v14
v_mfma_f32_16x16x32_bf16 v[128:131],a[136:139],v[28:31],v[128:131]
v_exp_f32 v88,v88
v_mfma_f32_16x16x32_bf16 v[132:135],a[140:143],v[28:31],v[132:135]
v_exp_f32 v89,v89
v_mfma_f32_16x16x32_bf16 a[180:183],a[140:143],v[32:35],a[180:183]
v_exp_f32 v90,v90
v_mfma_f32_16x16x32_bf16 a[176:179],a[136:139],v[32:35],a[176:179]
v_exp_f32 v91,v91
v_mfma_f32_16x16x32_bf16 a[184:187],a[144:147],v[32:35],a[184:187]
s_waitcnt lgkmcnt(1)
buffer_store_dwordx4 a[156:159],v9,s[16:19],s27 offen offset:128 nt
v_cvt_pk_bf16_f32 v52,v88,v89
v_cvt_pk_bf16_f32 v53,v90,v91
v_fma_f32 v86,v86,s36,v14
v_mfma_f32_16x16x32_bf16 a[188:191],a[148:151],v[32:35],a[188:191]
ds_read_b128 a[156:159],v10 offset:2048
v_fma_f32 v87,v87,s36,v14
v_mfma_f32_16x16x32_bf16 v[140:143],a[148:151],v[28:31],v[140:143]
v_exp_f32 v96,v96
v_mfma_f32_16x16x32_bf16 v[136:139],a[144:147],v[28:31],v[136:139]
v_exp_f32 v97,v97
v_mfma_f32_16x16x32_bf16 v[232:235],a[144:147],v[24:27],v[232:235]
v_exp_f32 v98,v98
v_mfma_f32_16x16x32_bf16 v[236:239],a[148:151],v[24:27],v[236:239]
v_exp_f32 v99,v99
v_mfma_f32_16x16x32_bf16 v[188:191],a[148:151],v[20:23],v[188:191]
v_cvt_pk_bf16_f32 v56,v96,v97
v_cvt_pk_bf16_f32 v57,v98,v99
v_mfma_f32_16x16x32_bf16 v[184:187],a[144:147],v[20:23],v[184:187]
v_exp_f32 v76,v76
v_mfma_f32_16x16x32_bf16 v[192:195],a[120:123],v[20:23],v[192:195]
v_exp_f32 v77,v77
v_mfma_f32_16x16x32_bf16 v[196:199],a[124:127],v[20:23],v[196:199]
s_waitcnt lgkmcnt(0)
buffer_store_dwordx4 a[156:159],v9,s[16:19],s27 offen offset:256 nt
v_exp_f32 v78,v78
v_cvt_pk_bf16_f32 v46,v76,v77
v_mfma_f32_16x16x32_bf16 v[244:247],a[124:127],v[24:27],v[244:247]
s_waitcnt vmcnt(9)
v_exp_f32 v79,v79
v_mfma_f32_16x16x32_bf16 v[240:243],a[120:123],v[24:27],v[240:243]
s_barrier
v_mfma_f32_16x16x32_bf16 v[144:147],a[120:123],v[28:31],v[144:147]
s_add_u32 s27,s27,3072
ds_read_b128 a[148:151],v1 offset:12416
v_cvt_pk_bf16_f32 v47,v78,v79
v_mfma_f32_16x16x32_bf16 v[148:151],a[124:127],v[28:31],v[148:151]
s_add_u32 m0,s23,24576
ds_read_b128 a[144:147],v0 offset:12416
v_fma_f32 v92,v92,s36,v15
v_mfma_f32_16x16x32_bf16 a[196:199],a[124:127],v[32:35],a[196:199]
buffer_load_dwordx4 v6,s[8:11],s21 offen offset:0 lds
v_mfma_f32_16x16x32_bf16 a[192:195],a[120:123],v[32:35],a[192:195]
ds_read_b128 a[124:127],v1 offset:12544
v_fma_f32 v93,v93,s36,v15
v_mfma_f32_16x16x32_bf16 a[200:203],a[128:131],v[32:35],a[200:203]
ds_read_b128 a[120:123],v0 offset:12544
v_fma_f32 v94,v94,s36,v15
v_mfma_f32_16x16x32_bf16 a[204:207],a[132:135],v[32:35],a[204:207]
ds_read_b128 a[140:143],v1 offset:12288
v_fma_f32 v95,v95,s36,v15
v_mfma_f32_16x16x32_bf16 v[156:159],a[132:135],v[28:31],v[156:159]
ds_read_b128 a[136:139],v0 offset:12288
v_fma_f32 v100,v100,s36,v16
v_mfma_f32_16x16x32_bf16 v[152:155],a[128:131],v[28:31],v[152:155]
v_exp_f32 v84,v84
v_mfma_f32_16x16x32_bf16 v[248:251],a[128:131],v[24:27],v[248:251]
v_exp_f32 v85,v85
v_mfma_f32_16x16x32_bf16 v[252:255],a[132:135],v[24:27],v[252:255]
buffer_load_dwordx4 v7,s[8:11],s21 offen offset:1024 lds
v_mfma_f32_16x16x32_bf16 v[204:207],a[132:135],v[20:23],v[204:207]
ds_read_b128 a[132:135],v1 offset:18432
v_cvt_pk_bf16_f32 v50,v84,v85
v_mfma_f32_16x16x32_bf16 v[200:203],a[128:131],v[20:23],v[200:203]
s_waitcnt lgkmcnt(3)
ds_read_b128 a[128:131],v0 offset:18432
v_fma_f32 v101,v101,s36,v16
v_mfma_f32_16x16x32_bf16 v[72:75],a[124:127],a[20:23],0
v_exp_f32 v86,v86
v_mfma_f32_16x16x32_bf16 v[72:75],a[120:123],a[16:19],v[72:75]
v_exp_f32 v87,v87
v_mfma_f32_16x16x32_bf16 v[72:75],a[148:151],a[12:15],v[72:75]
v_cvt_pk_bf16_f32 v51,v86,v87
v_fma_f32 v102,v102,s36,v16
v_mfma_f32_16x16x32_bf16 v[72:75],a[144:147],a[8:11],v[72:75]
v_exp_f32 v92,v92
v_smfmac_f32_16x16x64_bf16 v[60:63],a[152:155],v[44:51],v18
s_waitcnt lgkmcnt(2)
v_fma_f32 v103,v103,s36,v16
v_mfma_f32_16x16x32_bf16 v[72:75],a[140:143],a[4:7],v[72:75]
v_exp_f32 v93,v93
v_mfma_f32_16x16x32_bf16 v[72:75],a[136:139],a[0:3],v[72:75]
buffer_load_dwordx4 v8,s[8:11],s21 offen offset:2048 lds
v_mfma_f32_16x16x32_bf16 v[80:83],a[136:139],a[24:27],0
s_add_u32 s21,s21,12288
v_exp_f32 v94,v94
v_mfma_f32_16x16x32_bf16 v[80:83],a[140:143],a[28:31],v[80:83]
s_add_u32 m0,s22,0
v_exp_f32 v95,v95
v_mfma_f32_16x16x32_bf16 v[80:83],a[144:147],a[32:35],v[80:83]
v_cvt_pk_bf16_f32 v54,v92,v93
v_cvt_pk_bf16_f32 v55,v94,v95
v_mfma_f32_16x16x32_bf16 v[80:83],a[148:151],a[36:39],v[80:83]
v_exp_f32 v100,v100
v_mfma_f32_16x16x32_bf16 v[80:83],a[120:123],a[40:43],v[80:83]
v_exp_f32 v101,v101
v_mfma_f32_16x16x32_bf16 v[80:83],a[124:127],a[44:47],v[80:83]
v_exp_f32 v102,v102
v_mfma_f32_16x16x32_bf16 v[88:91],a[124:127],a[68:71],0
v_exp_f32 v103,v103
v_mfma_f32_16x16x32_bf16 v[88:91],a[120:123],a[64:67],v[88:91]
v_cvt_pk_bf16_f32 v58,v100,v101
v_cvt_pk_bf16_f32 v59,v102,v103
v_mfma_f32_16x16x32_bf16 v[88:91],a[148:151],a[60:63],v[88:91]
buffer_load_dwordx4 v6,s[4:7],s20 offen offset:0 lds
v_smfmac_f32_16x16x64_bf16 v[64:67],a[152:155],v[52:59],v18
v_fma_f32 v72,v72,s36,v13
v_mfma_f32_16x16x32_bf16 v[88:91],a[144:147],a[56:59],v[88:91]
v_fma_f32 v73,v73,s36,v13
v_fma_f32 v74,v74,s36,v13
v_mfma_f32_16x16x32_bf16 v[88:91],a[140:143],a[52:55],v[88:91]
v_fma_f32 v75,v75,s36,v13
v_fma_f32 v80,v80,s36,v14
v_mfma_f32_16x16x32_bf16 v[88:91],a[136:139],a[48:51],v[88:91]
v_fma_f32 v81,v81,s36,v14
v_mfma_f32_16x16x32_bf16 v[96:99],a[136:139],a[72:75],0
ds_read_b128 a[136:139],v0 offset:18560
v_mfma_f32_16x16x32_bf16 v[96:99],a[140:143],a[76:79],v[96:99]
ds_read_b128 a[140:143],v1 offset:18560
v_mfma_f32_16x16x32_bf16 v[96:99],a[144:147],a[80:83],v[96:99]
ds_read_b128 a[144:147],v0 offset:18688
v_mfma_f32_16x16x32_bf16 v[96:99],a[148:151],a[84:87],v[96:99]
ds_read_b128 a[148:151],v1 offset:18688
v_mfma_f32_16x16x32_bf16 v[96:99],a[120:123],a[88:91],v[96:99]
buffer_load_dwordx4 v7,s[4:7],s20 offen offset:1024 lds
v_mfma_f32_16x16x32_bf16 v[96:99],a[124:127],a[92:95],v[96:99]
s_waitcnt lgkmcnt(4)
v_exp_f32 v72,v72
v_mfma_f32_16x16x32_bf16 v[76:79],a[128:131],a[0:3],0
v_exp_f32 v73,v73
v_mfma_f32_16x16x32_bf16 v[76:79],a[132:135],a[4:7],v[76:79]
s_waitcnt lgkmcnt(3)
v_exp_f32 v74,v74
v_mfma_f32_16x16x32_bf16 v[76:79],a[136:139],a[8:11],v[76:79]
s_waitcnt lgkmcnt(2)
v_exp_f32 v75,v75
v_mfma_f32_16x16x32_bf16 v[76:79],a[140:143],a[12:15],v[76:79]
s_waitcnt lgkmcnt(0)
v_exp_f32 v80,v80
v_mfma_f32_16x16x32_bf16 v[76:79],a[144:147],a[16:19],v[76:79]
v_exp_f32 v81,v81
v_mfma_f32_16x16x32_bf16 v[76:79],a[148:151],a[20:23],v[76:79]
v_cvt_pk_bf16_f32 v20,v72,v73
v_cvt_pk_bf16_f32 v21,v74,v75
v_mfma_f32_16x16x32_bf16 v[84:87],a[148:151],a[44:47],0
v_cvt_pk_bf16_f32 v24,v80,v81
v_mfma_f32_16x16x32_bf16 v[84:87],a[144:147],a[40:43],v[84:87]
buffer_load_dwordx4 v8,s[4:7],s20 offen offset:2048 lds
v_mfma_f32_16x16x32_bf16 v[84:87],a[140:143],a[36:39],v[84:87]
s_add_u32 s20,s20,12288
v_mfma_f32_16x16x32_bf16 v[84:87],a[136:139],a[32:35],v[84:87]
ds_read_b64_tr_b16 a[120:121],v2 offset:0
v_mfma_f32_16x16x32_bf16 v[84:87],a[132:135],a[28:31],v[84:87]
ds_read_b64_tr_b16 a[122:123],v2 offset:6144
v_mfma_f32_16x16x32_bf16 v[84:87],a[128:131],a[24:27],v[84:87]
ds_read_b64_tr_b16 a[124:125],v3 offset:0
v_mfma_f32_16x16x32_bf16 v[92:95],a[128:131],a[48:51],0
ds_read_b64_tr_b16 a[126:127],v3 offset:6144
v_mfma_f32_16x16x32_bf16 v[92:95],a[132:135],a[52:55],v[92:95]
v_mfma_f32_16x16x32_bf16 v[92:95],a[136:139],a[56:59],v[92:95]
v_mfma_f32_16x16x32_bf16 v[92:95],a[140:143],a[60:63],v[92:95]
v_mfma_f32_16x16x32_bf16 v[92:95],a[144:147],a[64:67],v[92:95]
v_mfma_f32_16x16x32_bf16 v[92:95],a[148:151],a[68:71],v[92:95]
v_mfma_f32_16x16x32_bf16 v[100:103],a[148:151],a[92:95],0
v_mfma_f32_16x16x32_bf16 v[100:103],a[144:147],a[88:91],v[100:103]
v_mfma_f32_16x16x32_bf16 v[100:103],a[140:143],a[84:87],v[100:103]
v_mfma_f32_16x16x32_bf16 v[100:103],a[136:139],a[80:83],v[100:103]
v_mfma_f32_16x16x32_bf16 v[100:103],a[132:135],a[76:79],v[100:103]
ds_read_b64_tr_b16 a[132:133],v5 offset:0
v_mfma_f32_16x16x32_bf16 v[100:103],a[128:131],a[72:75],v[100:103]
s_waitcnt lgkmcnt(1)
ds_read_b64_tr_b16 a[128:129],v4 offset:0
ds_read_b64_tr_b16 a[130:131],v4 offset:6144
ds_read_b64_tr_b16 a[134:135],v5 offset:6144
v_mfma_f32_16x16x32_bf16 v[160:163],a[120:123],v[44:47],v[160:163]
s_add_u32 m0,s29,0
ds_read_b64_tr_b16 a[136:137],v2 offset:128
v_fma_f32 v82,v82,s36,v14
v_mfma_f32_16x16x32_bf16 v[164:167],a[124:127],v[44:47],v[164:167]
ds_read_b64_tr_b16 a[138:139],v2 offset:6272
v_fma_f32 v83,v83,s36,v14
v_mfma_f32_16x16x32_bf16 v[212:215],a[124:127],v[48:51],v[212:215]
ds_read_b64_tr_b16 a[140:141],v3 offset:128
v_fma_f32 v88,v88,s36,v15
v_mfma_f32_16x16x32_bf16 v[208:211],a[120:123],v[48:51],v[208:211]
ds_read_b64_tr_b16 a[142:143],v3 offset:6272
v_fma_f32 v89,v89,s36,v15
v_mfma_f32_16x16x32_bf16 v[112:115],a[120:123],v[52:55],v[112:115]
ds_read_b64_tr_b16 a[144:145],v4 offset:128
v_fma_f32 v90,v90,s36,v15
v_mfma_f32_16x16x32_bf16 v[116:119],a[124:127],v[52:55],v[116:119]
ds_read_b64_tr_b16 a[146:147],v4 offset:6272
v_fma_f32 v91,v91,s36,v15
v_mfma_f32_16x16x32_bf16 a[164:167],a[124:127],v[56:59],a[164:167]
buffer_load_dwordx4 v6,s[12:15],s28 offen offset:0 nt lds
v_mfma_f32_16x16x32_bf16 a[160:163],a[120:123],v[56:59],a[160:163]
s_waitcnt lgkmcnt(5)
ds_read_b64_tr_b16 a[148:149],v5 offset:128
v_fma_f32 v96,v96,s36,v16
v_mfma_f32_16x16x32_bf16 a[168:171],a[128:131],v[56:59],a[168:171]
ds_read_b64_tr_b16 a[150:151],v5 offset:6272
v_fma_f32 v97,v97,s36,v16
v_mfma_f32_16x16x32_bf16 a[172:175],a[132:135],v[56:59],a[172:175]
ds_read_b64_tr_b16 a[120:121],v2 offset:256
v_fma_f32 v98,v98,s36,v16
v_mfma_f32_16x16x32_bf16 v[124:127],a[132:135],v[52:55],v[124:127]
ds_read_b64_tr_b16 a[122:123],v2 offset:6400
v_fma_f32 v99,v99,s36,v16
v_mfma_f32_16x16x32_bf16 v[120:123],a[128:131],v[52:55],v[120:123]
ds_read_b64_tr_b16 a[124:125],v3 offset:256
v_fma_f32 v76,v76,s36,v13
v_mfma_f32_16x16x32_bf16 v[216:219],a[128:131],v[48:51],v[216:219]
ds_read_b64_tr_b16 a[126:127],v3 offset:6400
v_fma_f32 v77,v77,s36,v13
v_mfma_f32_16x16x32_bf16 v[220:223],a[132:135],v[48:51],v[220:223]
buffer_load_dwordx4 v7,s[12:15],s28 offen offset:1024 nt lds
v_mfma_f32_16x16x32_bf16 v[172:175],a[132:135],v[44:47],v[172:175]
ds_read_b64_tr_b16 a[132:133],v5 offset:256
v_fma_f32 v78,v78,s36,v13
v_mfma_f32_16x16x32_bf16 v[168:171],a[128:131],v[44:47],v[168:171]
s_waitcnt lgkmcnt(5)
ds_read_b64_tr_b16 a[128:129],v4 offset:256
v_fma_f32 v79,v79,s36,v13
v_mfma_f32_16x16x32_bf16 v[176:179],a[136:139],v[44:47],v[176:179]
ds_read_b64_tr_b16 a[130:131],v4 offset:6400
v_fma_f32 v84,v84,s36,v14
v_mfma_f32_16x16x32_bf16 v[180:183],a[140:143],v[44:47],v[180:183]
ds_read_b64_tr_b16 a[134:135],v5 offset:6400
v_fma_f32 v85,v85,s36,v14
v_mfma_f32_16x16x32_bf16 v[228:231],a[140:143],v[48:51],v[228:231]
v_exp_f32 v82,v82
v_mfma_f32_16x16x32_bf16 v[224:227],a[136:139],v[48:51],v[224:227]
v_exp_f32 v83,v83
v_mfma_f32_16x16x32_bf16 v[128:131],a[136:139],v[52:55],v[128:131]
v_cvt_pk_bf16_f32 v25,v82,v83
v_fma_f32 v86,v86,s36,v14
v_mfma_f32_16x16x32_bf16 v[132:135],a[140:143],v[52:55],v[132:135]
buffer_load_dwordx4 v8,s[12:15],s28 offen offset:2048 nt lds
v_mfma_f32_16x16x32_bf16 a[180:183],a[140:143],v[56:59],a[180:183]
s_add_u32 s28,s28,3072
v_exp_f32 v88,v88
v_mfma_f32_16x16x32_bf16 a[176:179],a[136:139],v[56:59],a[176:179]
s_add_u32 s29,s29,3072
v_exp_f32 v89,v89
v_mfma_f32_16x16x32_bf16 a[184:187],a[144:147],v[56:59],a[184:187]
s_add_u32 m0,s23,0
v_exp_f32 v90,v90
v_mfma_f32_16x16x32_bf16 a[188:191],a[148:151],v[56:59],a[188:191]
v_exp_f32 v91,v91
v_mfma_f32_16x16x32_bf16 v[140:143],a[148:151],v[52:55],v[140:143]
v_cvt_pk_bf16_f32 v28,v88,v89
v_cvt_pk_bf16_f32 v29,v90,v91
v_mfma_f32_16x16x32_bf16 v[136:139],a[144:147],v[52:55],v[136:139]
v_exp_f32 v96,v96
v_mfma_f32_16x16x32_bf16 v[232:235],a[144:147],v[48:51],v[232:235]
v_exp_f32 v97,v97
v_mfma_f32_16x16x32_bf16 v[236:239],a[148:151],v[48:51],v[236:239]
v_exp_f32 v98,v98
v_mfma_f32_16x16x32_bf16 v[188:191],a[148:151],v[44:47],v[188:191]
v_exp_f32 v99,v99
v_mfma_f32_16x16x32_bf16 v[184:187],a[144:147],v[44:47],v[184:187]
s_waitcnt vmcnt(12)
v_cvt_pk_bf16_f32 v32,v96,v97
v_cvt_pk_bf16_f32 v33,v98,v99
s_waitcnt lgkmcnt(0)
v_mfma_f32_16x16x32_bf16 v[192:195],a[120:123],v[44:47],v[192:195]
s_barrier
v_mfma_f32_16x16x32_bf16 v[196:199],a[124:127],v[44:47],v[196:199]
ds_read_b128 a[148:151],v1 offset:24704
v_fma_f32 v87,v87,s36,v14
v_mfma_f32_16x16x32_bf16 v[244:247],a[124:127],v[48:51],v[244:247]
ds_read_b128 a[144:147],v0 offset:24704
v_fma_f32 v92,v92,s36,v15
v_mfma_f32_16x16x32_bf16 v[240:243],a[120:123],v[48:51],v[240:243]
ds_read_b128 a[140:143],v1 offset:24576
v_fma_f32 v93,v93,s36,v15
v_mfma_f32_16x16x32_bf16 v[144:147],a[120:123],v[52:55],v[144:147]
ds_read_b128 a[136:139],v0 offset:24576
v_fma_f32 v94,v94,s36,v15
v_mfma_f32_16x16x32_bf16 v[148:151],a[124:127],v[52:55],v[148:151]
v_exp_f32 v76,v76
v_mfma_f32_16x16x32_bf16 a[196:199],a[124:127],v[56:59],a[196:199]
buffer_load_dwordx4 v6,s[8:11],s21 offen offset:0 lds
v_mfma_f32_16x16x32_bf16 a[192:195],a[120:123],v[56:59],a[192:195]
ds_read_b128 a[124:127],v1 offset:24832
v_fma_f32 v95,v95,s36,v15
v_mfma_f32_16x16x32_bf16 a[200:203],a[128:131],v[56:59],a[200:203]
ds_read_b128 a[120:123],v0 offset:24832
v_fma_f32 v100,v100,s36,v16
v_mfma_f32_16x16x32_bf16 a[204:207],a[132:135],v[56:59],a[204:207]
v_exp_f32 v77,v77
v_mfma_f32_16x16x32_bf16 v[156:159],a[132:135],v[52:55],v[156:159]
v_exp_f32 v78,v78
v_mfma_f32_16x16x32_bf16 v[152:155],a[128:131],v[52:55],v[152:155]
v_exp_f32 v79,v79
v_mfma_f32_16x16x32_bf16 v[248:251],a[128:131],v[48:51],v[248:251]
v_cvt_pk_bf16_f32 v22,v76,v77
v_cvt_pk_bf16_f32 v23,v78,v79
v_mfma_f32_16x16x32_bf16 v[252:255],a[132:135],v[48:51],v[252:255]
v_exp_f32 v84,v84
v_mfma_f32_16x16x32_bf16 v[204:207],a[132:135],v[44:47],v[204:207]
ds_read_b128 a[132:135],v1 offset:30720
v_fma_f32 v101,v101,s36,v16
v_mfma_f32_16x16x32_bf16 v[200:203],a[128:131],v[44:47],v[200:203]
buffer_load_dwordx4 v7,s[8:11],s21 offen offset:1024 lds
s_waitcnt lgkmcnt(1)
v_mfma_f32_16x16x32_bf16 v[72:75],a[124:127],a[20:23],0
ds_read_b128 a[128:131],v0 offset:30720
v_fma_f32 v102,v102,s36,v16
v_mfma_f32_16x16x32_bf16 v[72:75],a[120:123],a[16:19],v[72:75]
v_exp_f32 v85,v85
v_mfma_f32_16x16x32_bf16 v[72:75],a[148:151],a[12:15],v[72:75]
v_exp_f32 v86,v86
v_mfma_f32_16x16x32_bf16 v[72:75],a[144:147],a[8:11],v[72:75]
v_exp_f32 v87,v87
v_mfma_f32_16x16x32_bf16 v[72:75],a[140:143],a[4:7],v[72:75]
v_cvt_pk_bf16_f32 v26,v84,v85
v_cvt_pk_bf16_f32 v27,v86,v87
v_mfma_f32_16x16x32_bf16 v[72:75],a[136:139],a[0:3],v[72:75]
v_exp_f32 v92,v92
v_smfmac_f32_16x16x64_bf16 v[60:63],a[152:155],v[20:27],v18
v_fma_f32 v103,v103,s36,v16
v_mfma_f32_16x16x32_bf16 v[80:83],a[136:139],a[24:27],0
v_exp_f32 v93,v93
v_mfma_f32_16x16x32_bf16 v[80:83],a[140:143],a[28:31],v[80:83]
buffer_load_dwordx4 v8,s[8:11],s21 offen offset:2048 lds
v_mfma_f32_16x16x32_bf16 v[80:83],a[144:147],a[32:35],v[80:83]
s_add_u32 s21,s21,12288
v_exp_f32 v94,v94
v_mfma_f32_16x16x32_bf16 v[80:83],a[148:151],a[36:39],v[80:83]
s_add_u32 m0,s22,12288
v_exp_f32 v95,v95
v_mfma_f32_16x16x32_bf16 v[80:83],a[120:123],a[40:43],v[80:83]
v_cvt_pk_bf16_f32 v30,v92,v93
v_cvt_pk_bf16_f32 v31,v94,v95
v_mfma_f32_16x16x32_bf16 v[80:83],a[124:127],a[44:47],v[80:83]
v_exp_f32 v100,v100
v_mfma_f32_16x16x32_bf16 v[88:91],a[124:127],a[68:71],0
v_exp_f32 v101,v101
v_mfma_f32_16x16x32_bf16 v[88:91],a[120:123],a[64:67],v[88:91]
v_exp_f32 v102,v102
v_mfma_f32_16x16x32_bf16 v[88:91],a[148:151],a[60:63],v[88:91]
v_exp_f32 v103,v103
v_mfma_f32_16x16x32_bf16 v[88:91],a[144:147],a[56:59],v[88:91]
v_cvt_pk_bf16_f32 v34,v100,v101
v_cvt_pk_bf16_f32 v35,v102,v103
v_mfma_f32_16x16x32_bf16 v[88:91],a[140:143],a[52:55],v[88:91]
buffer_load_dwordx4 v6,s[4:7],s20 offen offset:0 lds
v_smfmac_f32_16x16x64_bf16 v[64:67],a[152:155],v[28:35],v18
v_fma_f32 v72,v72,s36,v13
v_mfma_f32_16x16x32_bf16 v[88:91],a[136:139],a[48:51],v[88:91]
v_fma_f32 v73,v73,s36,v13
v_fma_f32 v74,v74,s36,v13
v_mfma_f32_16x16x32_bf16 v[96:99],a[136:139],a[72:75],0
ds_read_b128 a[136:139],v0 offset:30848
v_fma_f32 v75,v75,s36,v13
v_mfma_f32_16x16x32_bf16 v[96:99],a[140:143],a[76:79],v[96:99]
ds_read_b128 a[140:143],v1 offset:30848
v_fma_f32 v80,v80,s36,v14
v_mfma_f32_16x16x32_bf16 v[96:99],a[144:147],a[80:83],v[96:99]
ds_read_b128 a[144:147],v0 offset:30976
v_fma_f32 v81,v81,s36,v14
v_mfma_f32_16x16x32_bf16 v[96:99],a[148:151],a[84:87],v[96:99]
ds_read_b128 a[148:151],v1 offset:30976
v_mfma_f32_16x16x32_bf16 v[96:99],a[120:123],a[88:91],v[96:99]
v_exp_f32 v72,v72
v_mfma_f32_16x16x32_bf16 v[96:99],a[124:127],a[92:95],v[96:99]
s_waitcnt lgkmcnt(4)
v_exp_f32 v73,v73
v_mfma_f32_16x16x32_bf16 v[76:79],a[128:131],a[0:3],0
buffer_load_dwordx4 v7,s[4:7],s20 offen offset:1024 lds
v_mfma_f32_16x16x32_bf16 v[76:79],a[132:135],a[4:7],v[76:79]
s_waitcnt lgkmcnt(3)
v_exp_f32 v74,v74
v_mfma_f32_16x16x32_bf16 v[76:79],a[136:139],a[8:11],v[76:79]
s_waitcnt lgkmcnt(2)
v_exp_f32 v75,v75
v_mfma_f32_16x16x32_bf16 v[76:79],a[140:143],a[12:15],v[76:79]
s_waitcnt lgkmcnt(0)
v_exp_f32 v80,v80
v_mfma_f32_16x16x32_bf16 v[76:79],a[144:147],a[16:19],v[76:79]
v_exp_f32 v81,v81
v_mfma_f32_16x16x32_bf16 v[76:79],a[148:151],a[20:23],v[76:79]
v_cvt_pk_bf16_f32 v44,v72,v73
v_cvt_pk_bf16_f32 v45,v74,v75
v_mfma_f32_16x16x32_bf16 v[84:87],a[148:151],a[44:47],0
v_cvt_pk_bf16_f32 v48,v80,v81
v_mfma_f32_16x16x32_bf16 v[84:87],a[144:147],a[40:43],v[84:87]
v_mfma_f32_16x16x32_bf16 v[84:87],a[140:143],a[36:39],v[84:87]
v_mfma_f32_16x16x32_bf16 v[84:87],a[136:139],a[32:35],v[84:87]
buffer_load_dwordx4 v8,s[4:7],s20 offen offset:2048 lds
v_mfma_f32_16x16x32_bf16 v[84:87],a[132:135],a[28:31],v[84:87]
s_add_u32 s20,s20,12288
v_mfma_f32_16x16x32_bf16 v[84:87],a[128:131],a[24:27],v[84:87]
ds_read_b64_tr_b16 a[120:121],v2 offset:12288
v_mfma_f32_16x16x32_bf16 v[92:95],a[128:131],a[48:51],0
ds_read_b64_tr_b16 a[122:123],v2 offset:18432
v_mfma_f32_16x16x32_bf16 v[92:95],a[132:135],a[52:55],v[92:95]
ds_read_b64_tr_b16 a[124:125],v3 offset:12288
v_mfma_f32_16x16x32_bf16 v[92:95],a[136:139],a[56:59],v[92:95]
ds_read_b64_tr_b16 a[126:127],v3 offset:18432
v_mfma_f32_16x16x32_bf16 v[92:95],a[140:143],a[60:63],v[92:95]
v_mfma_f32_16x16x32_bf16 v[92:95],a[144:147],a[64:67],v[92:95]
v_mfma_f32_16x16x32_bf16 v[92:95],a[148:151],a[68:71],v[92:95]
v_mfma_f32_16x16x32_bf16 v[100:103],a[148:151],a[92:95],0
v_mfma_f32_16x16x32_bf16 v[100:103],a[144:147],a[88:91],v[100:103]
v_mfma_f32_16x16x32_bf16 v[100:103],a[140:143],a[84:87],v[100:103]
v_mfma_f32_16x16x32_bf16 v[100:103],a[136:139],a[80:83],v[100:103]
v_mfma_f32_16x16x32_bf16 v[100:103],a[132:135],a[76:79],v[100:103]
ds_read_b64_tr_b16 a[132:133],v5 offset:12288
v_mfma_f32_16x16x32_bf16 v[100:103],a[128:131],a[72:75],v[100:103]
s_waitcnt lgkmcnt(1)
ds_read_b64_tr_b16 a[128:129],v4 offset:12288
ds_read_b64_tr_b16 a[130:131],v4 offset:18432
ds_read_b64_tr_b16 a[134:135],v5 offset:18432
v_mfma_f32_16x16x32_bf16 v[160:163],a[120:123],v[20:23],v[160:163]
ds_read_b128 a[156:159],v10 offset:3072
v_mbcnt_lo_u32_b32 v19,-1,0
v_mfma_f32_16x16x32_bf16 v[164:167],a[124:127],v[20:23],v[164:167]
ds_read_b64_tr_b16 a[136:137],v2 offset:12416
v_mbcnt_hi_u32_b32 v19,-1,v19
v_mfma_f32_16x16x32_bf16 v[212:215],a[124:127],v[24:27],v[212:215]
ds_read_b64_tr_b16 a[138:139],v2 offset:18560
v_min_u32 v19,7,v19
v_mfma_f32_16x16x32_bf16 v[208:211],a[120:123],v[24:27],v[208:211]
ds_read_b64_tr_b16 a[140:141],v3 offset:12416
v_lshl_add_u32 v19,v19,7,s48
v_mfma_f32_16x16x32_bf16 v[112:115],a[120:123],v[28:31],v[112:115]
ds_read_b64_tr_b16 a[142:143],v3 offset:18560
v_min_u32 v19,L_codeend-L_first-4,v19
v_mfma_f32_16x16x32_bf16 v[116:119],a[124:127],v[28:31],v[116:119]
ds_read_b64_tr_b16 a[150:151],v5 offset:18560
v_fma_f32 v82,v82,s36,v14
v_mfma_f32_16x16x32_bf16 a[164:167],a[124:127],v[32:35],a[164:167]
ds_read_b64_tr_b16 a[144:145],v4 offset:12416
v_fma_f32 v83,v83,s36,v14
v_mfma_f32_16x16x32_bf16 a[160:163],a[120:123],v[32:35],a[160:163]
s_waitcnt lgkmcnt(6)
ds_read_b64_tr_b16 a[146:147],v4 offset:18560
v_fma_f32 v91,v91,s36,v15
v_mfma_f32_16x16x32_bf16 a[168:171],a[128:131],v[32:35],a[168:171]
ds_read_b64_tr_b16 a[148:149],v5 offset:12416
v_fma_f32 v90,v90,s36,v15
v_mfma_f32_16x16x32_bf16 a[172:175],a[132:135],v[32:35],a[172:175]
ds_read_b64_tr_b16 a[122:123],v2 offset:18688
v_fma_f32 v89,v89,s36,v15
v_mfma_f32_16x16x32_bf16 v[124:127],a[132:135],v[28:31],v[124:127]
ds_read_b64_tr_b16 a[120:121],v2 offset:12544
v_fma_f32 v88,v88,s36,v15
v_mfma_f32_16x16x32_bf16 v[120:123],a[128:131],v[28:31],v[120:123]
ds_read_b64_tr_b16 a[126:127],v3 offset:18688
v_fma_f32 v97,v97,s36,v16
v_mfma_f32_16x16x32_bf16 v[216:219],a[128:131],v[24:27],v[216:219]
ds_read_b64_tr_b16 a[124:125],v3 offset:12544
v_fma_f32 v98,v98,s36,v16
v_mfma_f32_16x16x32_bf16 v[220:223],a[132:135],v[24:27],v[220:223]
v_exp_f32 v82,v82
v_mfma_f32_16x16x32_bf16 v[172:175],a[132:135],v[20:23],v[172:175]
ds_read_b64_tr_b16 a[134:135],v5 offset:18688
v_fma_f32 v96,v96,s36,v16
v_mfma_f32_16x16x32_bf16 v[168:171],a[128:131],v[20:23],v[168:171]
global_load_dword v19,v19,s[46:47]
s_waitcnt lgkmcnt(5)
v_mfma_f32_16x16x32_bf16 v[176:179],a[136:139],v[20:23],v[176:179]
buffer_store_dwordx4 a[156:159],v9,s[16:19],s27 offen offset:0 nt
ds_read_b64_tr_b16 a[132:133],v5 offset:12544
ds_read_b128 a[156:159],v10 offset:4096
v_mfma_f32_16x16x32_bf16 v[180:183],a[140:143],v[20:23],v[180:183]
ds_read_b64_tr_b16 a[130:131],v4 offset:18688
v_mfma_f32_16x16x32_bf16 v[228:231],a[140:143],v[24:27],v[228:231]
ds_read_b64_tr_b16 a[128:129],v4 offset:12544
v_fma_f32 v99,v99,s36,v16
v_mfma_f32_16x16x32_bf16 v[224:227],a[136:139],v[24:27],v[224:227]
v_exp_f32 v83,v83
v_mfma_f32_16x16x32_bf16 v[128:131],a[136:139],v[28:31],v[128:131]
v_cvt_pk_bf16_f32 v49,v82,v83
v_fma_f32 v78,v78,s36,v13
v_mfma_f32_16x16x32_bf16 v[132:135],a[140:143],v[28:31],v[132:135]
v_exp_f32 v91,v91
v_mfma_f32_16x16x32_bf16 a[180:183],a[140:143],v[32:35],a[180:183]
v_exp_f32 v88,v88
v_mfma_f32_16x16x32_bf16 a[176:179],a[136:139],v[32:35],a[176:179]
v_exp_f32 v89,v89
v_mfma_f32_16x16x32_bf16 a[184:187],a[144:147],v[32:35],a[184:187]
s_waitcnt lgkmcnt(2)
buffer_store_dwordx4 a[156:159],v9,s[16:19],s27 offen offset:128 nt
v_exp_f32 v90,v90
v_cvt_pk_bf16_f32 v52,v88,v89
v_mfma_f32_16x16x32_bf16 a[188:191],a[148:151],v[32:35],a[188:191]
ds_read_b128 a[156:159],v10 offset:5120
v_cvt_pk_bf16_f32 v53,v90,v91
v_mfma_f32_16x16x32_bf16 v[140:143],a[148:151],v[28:31],v[140:143]
v_exp_f32 v98,v98
v_mfma_f32_16x16x32_bf16 v[136:139],a[144:147],v[28:31],v[136:139]
v_exp_f32 v97,v97
v_mfma_f32_16x16x32_bf16 v[232:235],a[144:147],v[24:27],v[232:235]
v_exp_f32 v99,v99
v_mfma_f32_16x16x32_bf16 v[236:239],a[148:151],v[24:27],v[236:239]
v_exp_f32 v96,v96
v_mfma_f32_16x16x32_bf16 v[188:191],a[148:151],v[20:23],v[188:191]
v_cvt_pk_bf16_f32 v56,v96,v97
v_cvt_pk_bf16_f32 v57,v98,v99
v_mfma_f32_16x16x32_bf16 v[184:187],a[144:147],v[20:23],v[184:187]
v_exp_f32 v78,v78
v_mfma_f32_16x16x32_bf16 v[192:195],a[120:123],v[20:23],v[192:195]
v_fma_f32 v76,v76,s36,v13
v_fma_f32 v79,v79,s36,v13
v_mfma_f32_16x16x32_bf16 v[196:199],a[124:127],v[20:23],v[196:199]
s_waitcnt lgkmcnt(0)
buffer_store_dwordx4 a[156:159],v9,s[16:19],s27 offen offset:256 nt
v_exp_f32 v76,v76
v_fma_f32 v77,v77,s36,v13
v_mfma_f32_16x16x32_bf16 v[244:247],a[124:127],v[24:27],v[244:247]
s_waitcnt vmcnt(13)
v_exp_f32 v79,v79
v_mfma_f32_16x16x32_bf16 v[240:243],a[120:123],v[24:27],v[240:243]
s_barrier
v_mfma_f32_16x16x32_bf16 v[144:147],a[120:123],v[28:31],v[144:147]
s_add_u32 s27,s27,3072
ds_read_b128 a[148:151],v1 offset:128
v_cvt_pk_bf16_f32 v47,v78,v79
v_mfma_f32_16x16x32_bf16 v[148:151],a[124:127],v[28:31],v[148:151]
s_add_u32 m0,s23,12288
ds_read_b128 a[144:147],v0 offset:128
v_fma_f32 v87,v87,s36,v14
v_mfma_f32_16x16x32_bf16 a[196:199],a[124:127],v[32:35],a[196:199]
buffer_load_dwordx4 v6,s[8:11],s21 offen offset:0 lds
v_mfma_f32_16x16x32_bf16 a[192:195],a[120:123],v[32:35],a[192:195]
ds_read_b128 a[124:127],v1 offset:256
v_fma_f32 v86,v86,s36,v14
v_mfma_f32_16x16x32_bf16 a[200:203],a[128:131],v[32:35],a[200:203]
ds_read_b128 a[120:123],v0 offset:256
v_fma_f32 v84,v84,s36,v14
v_mfma_f32_16x16x32_bf16 a[204:207],a[132:135],v[32:35],a[204:207]
ds_read_b128 a[140:143],v1 offset:0
v_fma_f32 v85,v85,s36,v14
v_mfma_f32_16x16x32_bf16 v[156:159],a[132:135],v[28:31],v[156:159]
ds_read_b128 a[136:139],v0 offset:0
v_fma_f32 v95,v95,s36,v15
v_mfma_f32_16x16x32_bf16 v[152:155],a[128:131],v[28:31],v[152:155]
v_exp_f32 v77,v77
v_mfma_f32_16x16x32_bf16 v[248:251],a[128:131],v[24:27],v[248:251]
v_cvt_pk_bf16_f32 v46,v76,v77
v_fma_f32 v92,v92,s36,v15
v_mfma_f32_16x16x32_bf16 v[252:255],a[132:135],v[24:27],v[252:255]
buffer_load_dwordx4 v7,s[8:11],s21 offen offset:1024 lds
v_mfma_f32_16x16x32_bf16 v[204:207],a[132:135],v[20:23],v[204:207]
ds_read_b128 a[132:135],v1 offset:6144
v_fma_f32 v94,v94,s36,v15
v_mfma_f32_16x16x32_bf16 v[200:203],a[128:131],v[20:23],v[200:203]
s_waitcnt lgkmcnt(3)
ds_read_b128 a[128:131],v0 offset:6144
v_fma_f32 v93,v93,s36,v15
v_mfma_f32_16x16x32_bf16 v[72:75],a[124:127],a[20:23],0
v_exp_f32 v84,v84
v_mfma_f32_16x16x32_bf16 v[72:75],a[120:123],a[16:19],v[72:75]
v_exp_f32 v87,v87
v_mfma_f32_16x16x32_bf16 v[72:75],a[148:151],a[12:15],v[72:75]
v_exp_f32 v85,v85
v_mfma_f32_16x16x32_bf16 v[72:75],a[144:147],a[8:11],v[72:75]
s_waitcnt lgkmcnt(2)
v_cvt_pk_bf16_f32 v50,v84,v85
v_fma_f32 v100,v100,s36,v16
v_mfma_f32_16x16x32_bf16 v[72:75],a[140:143],a[4:7],v[72:75]
v_exp_f32 v86,v86
v_mfma_f32_16x16x32_bf16 v[72:75],a[136:139],a[0:3],v[72:75]
v_cvt_pk_bf16_f32 v51,v86,v87
v_fma_f32 v102,v102,s36,v16
v_mfma_f32_16x16x32_bf16 v[80:83],a[136:139],a[24:27],0
buffer_load_dwordx4 v8,s[8:11],s21 offen offset:2048 lds
v_smfmac_f32_16x16x64_bf16 v[60:63],a[152:155],v[44:51],v18
s_add_u32 s21,s21,12288
v_fma_f32 v101,v101,s36,v16
v_mfma_f32_16x16x32_bf16 v[80:83],a[140:143],a[28:31],v[80:83]
s_add_u32 m0,s22,24576
v_exp_f32 v94,v94
v_mfma_f32_16x16x32_bf16 v[80:83],a[144:147],a[32:35],v[80:83]
v_exp_f32 v92,v92
v_mfma_f32_16x16x32_bf16 v[80:83],a[148:151],a[36:39],v[80:83]
v_exp_f32 v93,v93
v_mfma_f32_16x16x32_bf16 v[80:83],a[120:123],a[40:43],v[80:83]
v_cvt_pk_bf16_f32 v54,v92,v93
v_fma_f32 v103,v103,s36,v16
v_mfma_f32_16x16x32_bf16 v[80:83],a[124:127],a[44:47],v[80:83]
v_exp_f32 v95,v95
v_mfma_f32_16x16x32_bf16 v[88:91],a[124:127],a[68:71],0
v_cvt_pk_bf16_f32 v55,v94,v95
v_fma_f32 v73,v73,s36,v13
v_mfma_f32_16x16x32_bf16 v[88:91],a[120:123],a[64:67],v[88:91]
v_exp_f32 v102,v102
v_mfma_f32_16x16x32_bf16 v[88:91],a[148:151],a[60:63],v[88:91]
buffer_load_dwordx4 v6,s[4:7],s20 offen offset:0 lds
v_mfma_f32_16x16x32_bf16 v[88:91],a[144:147],a[56:59],v[88:91]
v_exp_f32 v103,v103
v_mfma_f32_16x16x32_bf16 v[88:91],a[140:143],a[52:55],v[88:91]
v_exp_f32 v100,v100
v_mfma_f32_16x16x32_bf16 v[88:91],a[136:139],a[48:51],v[88:91]
v_exp_f32 v101,v101
v_mfma_f32_16x16x32_bf16 v[96:99],a[136:139],a[72:75],0
ds_read_b128 a[136:139],v0 offset:6272
v_cvt_pk_bf16_f32 v59,v102,v103
v_mfma_f32_16x16x32_bf16 v[96:99],a[140:143],a[76:79],v[96:99]
ds_read_b128 a[140:143],v1 offset:6272
v_cvt_pk_bf16_f32 v58,v100,v101
v_mfma_f32_16x16x32_bf16 v[96:99],a[144:147],a[80:83],v[96:99]
ds_read_b128 a[144:147],v0 offset:6400
v_fma_f32 v81,v81,s36,v14
v_smfmac_f32_16x16x64_bf16 v[64:67],a[152:155],v[52:59],v18
v_fma_f32 v74,v74,s36,v13
v_mfma_f32_16x16x32_bf16 v[96:99],a[148:151],a[84:87],v[96:99]
ds_read_b128 a[148:151],v1 offset:6400
v_fma_f32 v72,v72,s36,v13
v_mfma_f32_16x16x32_bf16 v[96:99],a[120:123],a[88:91],v[96:99]
buffer_load_dwordx4 v7,s[4:7],s20 offen offset:1024 lds
v_mfma_f32_16x16x32_bf16 v[96:99],a[124:127],a[92:95],v[96:99]
s_waitcnt lgkmcnt(4)
v_exp_f32 v72,v72
v_mfma_f32_16x16x32_bf16 v[76:79],a[128:131],a[0:3],0
v_fma_f32 v75,v75,s36,v13
v_fma_f32 v80,v80,s36,v14
v_mfma_f32_16x16x32_bf16 v[76:79],a[132:135],a[4:7],v[76:79]
s_waitcnt lgkmcnt(2)
v_exp_f32 v73,v73
v_mfma_f32_16x16x32_bf16 v[76:79],a[136:139],a[8:11],v[76:79]
v_exp_f32 v80,v80
v_mfma_f32_16x16x32_bf16 v[76:79],a[140:143],a[12:15],v[76:79]
s_waitcnt lgkmcnt(1)
v_cvt_pk_bf16_f32 v20,v72,v73
v_mfma_f32_16x16x32_bf16 v[76:79],a[144:147],a[16:19],v[76:79]
s_waitcnt lgkmcnt(0)
v_exp_f32 v75,v75
v_mfma_f32_16x16x32_bf16 v[76:79],a[148:151],a[20:23],v[76:79]
v_exp_f32 v81,v81
v_mfma_f32_16x16x32_bf16 v[84:87],a[148:151],a[44:47],0
v_cvt_pk_bf16_f32 v24,v80,v81
v_mfma_f32_16x16x32_bf16 v[84:87],a[144:147],a[40:43],v[84:87]
buffer_load_dwordx4 v8,s[4:7],s20 offen offset:2048 lds
v_mfma_f32_16x16x32_bf16 v[84:87],a[140:143],a[36:39],v[84:87]
s_add_u32 s20,s20,12288
v_exp_f32 v74,v74
v_mfma_f32_16x16x32_bf16 v[84:87],a[136:139],a[32:35],v[84:87]
ds_read_b64_tr_b16 a[122:123],v2 offset:30720
v_mfma_f32_16x16x32_bf16 v[84:87],a[132:135],a[28:31],v[84:87]
ds_read_b64_tr_b16 a[120:121],v2 offset:24576
v_cvt_pk_bf16_f32 v21,v74,v75
v_mfma_f32_16x16x32_bf16 v[84:87],a[128:131],a[24:27],v[84:87]
ds_read_b64_tr_b16 a[124:125],v3 offset:24576
v_mfma_f32_16x16x32_bf16 v[92:95],a[128:131],a[48:51],0
ds_read_b64_tr_b16 a[126:127],v3 offset:30720
v_mfma_f32_16x16x32_bf16 v[92:95],a[132:135],a[52:55],v[92:95]
v_mfma_f32_16x16x32_bf16 v[92:95],a[136:139],a[56:59],v[92:95]
v_mfma_f32_16x16x32_bf16 v[92:95],a[140:143],a[60:63],v[92:95]
v_mfma_f32_16x16x32_bf16 v[92:95],a[144:147],a[64:67],v[92:95]
v_mfma_f32_16x16x32_bf16 v[92:95],a[148:151],a[68:71],v[92:95]
v_mfma_f32_16x16x32_bf16 v[100:103],a[148:151],a[92:95],0
v_mfma_f32_16x16x32_bf16 v[100:103],a[144:147],a[88:91],v[100:103]
v_mfma_f32_16x16x32_bf16 v[100:103],a[140:143],a[84:87],v[100:103]
v_mfma_f32_16x16x32_bf16 v[100:103],a[136:139],a[80:83],v[100:103]
v_mfma_f32_16x16x32_bf16 v[100:103],a[132:135],a[76:79],v[100:103]
ds_read_b64_tr_b16 a[132:133],v5 offset:24576
v_mfma_f32_16x16x32_bf16 v[100:103],a[128:131],a[72:75],v[100:103]
s_waitcnt lgkmcnt(1)
ds_read_b64_tr_b16 a[128:129],v4 offset:24576
ds_read_b64_tr_b16 a[130:131],v4 offset:30720
ds_read_b64_tr_b16 a[134:135],v5 offset:30720
v_mfma_f32_16x16x32_bf16 v[160:163],a[120:123],v[44:47],v[160:163]
s_add_u32 m0,s29,0
ds_read_b64_tr_b16 a[136:137],v2 offset:24704
v_fma_f32 v82,v82,s36,v14
v_mfma_f32_16x16x32_bf16 v[164:167],a[124:127],v[44:47],v[164:167]
ds_read_b64_tr_b16 a[138:139],v2 offset:30848
v_fma_f32 v83,v83,s36,v14
v_mfma_f32_16x16x32_bf16 v[212:215],a[124:127],v[48:51],v[212:215]
ds_read_b64_tr_b16 a[140:141],v3 offset:24704
v_fma_f32 v88,v88,s36,v15
v_mfma_f32_16x16x32_bf16 v[208:211],a[120:123],v[48:51],v[208:211]
ds_read_b64_tr_b16 a[142:143],v3 offset:30848
v_fma_f32 v89,v89,s36,v15
v_mfma_f32_16x16x32_bf16 v[112:115],a[120:123],v[52:55],v[112:115]
ds_read_b64_tr_b16 a[144:145],v4 offset:24704
v_fma_f32 v90,v90,s36,v15
v_mfma_f32_16x16x32_bf16 v[116:119],a[124:127],v[52:55],v[116:119]
ds_read_b64_tr_b16 a[146:147],v4 offset:30848
v_fma_f32 v91,v91,s36,v15
v_mfma_f32_16x16x32_bf16 a[164:167],a[124:127],v[56:59],a[164:167]
buffer_load_dwordx4 v6,s[12:15],s28 offen offset:0 nt lds
v_mfma_f32_16x16x32_bf16 a[160:163],a[120:123],v[56:59],a[160:163]
s_waitcnt lgkmcnt(5)
ds_read_b64_tr_b16 a[148:149],v5 offset:24704
v_fma_f32 v96,v96,s36,v16
v_mfma_f32_16x16x32_bf16 a[168:171],a[128:131],v[56:59],a[168:171]
ds_read_b64_tr_b16 a[150:151],v5 offset:30848
v_fma_f32 v97,v97,s36,v16
v_mfma_f32_16x16x32_bf16 a[172:175],a[132:135],v[56:59],a[172:175]
ds_read_b64_tr_b16 a[120:121],v2 offset:24832
v_fma_f32 v98,v98,s36,v16
v_mfma_f32_16x16x32_bf16 v[124:127],a[132:135],v[52:55],v[124:127]
ds_read_b64_tr_b16 a[122:123],v2 offset:30976
v_fma_f32 v99,v99,s36,v16
v_mfma_f32_16x16x32_bf16 v[120:123],a[128:131],v[52:55],v[120:123]
ds_read_b64_tr_b16 a[124:125],v3 offset:24832
v_fma_f32 v76,v76,s36,v13
v_mfma_f32_16x16x32_bf16 v[216:219],a[128:131],v[48:51],v[216:219]
ds_read_b64_tr_b16 a[126:127],v3 offset:30976
v_fma_f32 v77,v77,s36,v13
v_mfma_f32_16x16x32_bf16 v[220:223],a[132:135],v[48:51],v[220:223]
buffer_load_dwordx4 v7,s[12:15],s28 offen offset:1024 nt lds
v_mfma_f32_16x16x32_bf16 v[172:175],a[132:135],v[44:47],v[172:175]
ds_read_b64_tr_b16 a[132:133],v5 offset:24832
v_fma_f32 v78,v78,s36,v13
v_mfma_f32_16x16x32_bf16 v[168:171],a[128:131],v[44:47],v[168:171]
s_waitcnt lgkmcnt(5)
ds_read_b64_tr_b16 a[128:129],v4 offset:24832
v_fma_f32 v79,v79,s36,v13
v_mfma_f32_16x16x32_bf16 v[176:179],a[136:139],v[44:47],v[176:179]
ds_read_b64_tr_b16 a[130:131],v4 offset:30976
v_fma_f32 v84,v84,s36,v14
v_mfma_f32_16x16x32_bf16 v[180:183],a[140:143],v[44:47],v[180:183]
ds_read_b64_tr_b16 a[134:135],v5 offset:30976
v_fma_f32 v85,v85,s36,v14
v_mfma_f32_16x16x32_bf16 v[228:231],a[140:143],v[48:51],v[228:231]
v_exp_f32 v82,v82
v_mfma_f32_16x16x32_bf16 v[224:227],a[136:139],v[48:51],v[224:227]
v_exp_f32 v83,v83
v_mfma_f32_16x16x32_bf16 v[128:131],a[136:139],v[52:55],v[128:131]
v_cvt_pk_bf16_f32 v25,v82,v83
v_fma_f32 v86,v86,s36,v14
v_mfma_f32_16x16x32_bf16 v[132:135],a[140:143],v[52:55],v[132:135]
buffer_load_dwordx4 v8,s[12:15],s28 offen offset:2048 nt lds
v_mfma_f32_16x16x32_bf16 a[180:183],a[140:143],v[56:59],a[180:183]
s_add_u32 s28,s28,3072
v_exp_f32 v88,v88
v_mfma_f32_16x16x32_bf16 a[176:179],a[136:139],v[56:59],a[176:179]
s_add_u32 s29,s29,3072
v_exp_f32 v89,v89
v_mfma_f32_16x16x32_bf16 a[184:187],a[144:147],v[56:59],a[184:187]
s_add_u32 m0,s23,24576
v_exp_f32 v90,v90
v_mfma_f32_16x16x32_bf16 a[188:191],a[148:151],v[56:59],a[188:191]
v_exp_f32 v91,v91
v_mfma_f32_16x16x32_bf16 v[140:143],a[148:151],v[52:55],v[140:143]
v_cvt_pk_bf16_f32 v28,v88,v89
v_cvt_pk_bf16_f32 v29,v90,v91
v_mfma_f32_16x16x32_bf16 v[136:139],a[144:147],v[52:55],v[136:139]
v_exp_f32 v96,v96
v_mfma_f32_16x16x32_bf16 v[232:235],a[144:147],v[48:51],v[232:235]
v_exp_f32 v97,v97
v_mfma_f32_16x16x32_bf16 v[236:239],a[148:151],v[48:51],v[236:239]
v_exp_f32 v98,v98
v_mfma_f32_16x16x32_bf16 v[188:191],a[148:151],v[44:47],v[188:191]
v_exp_f32 v99,v99
v_mfma_f32_16x16x32_bf16 v[184:187],a[144:147],v[44:47],v[184:187]
s_waitcnt vmcnt(13)
v_cvt_pk_bf16_f32 v32,v96,v97
v_cvt_pk_bf16_f32 v33,v98,v99
s_waitcnt lgkmcnt(0)
v_mfma_f32_16x16x32_bf16 v[192:195],a[120:123],v[44:47],v[192:195]
s_barrier
v_mfma_f32_16x16x32_bf16 v[196:199],a[124:127],v[44:47],v[196:199]
ds_read_b128 a[148:151],v1 offset:12416
v_fma_f32 v87,v87,s36,v14
v_mfma_f32_16x16x32_bf16 v[244:247],a[124:127],v[48:51],v[244:247]
ds_read_b128 a[144:147],v0 offset:12416
v_fma_f32 v92,v92,s36,v15
v_mfma_f32_16x16x32_bf16 v[240:243],a[120:123],v[48:51],v[240:243]
ds_read_b128 a[140:143],v1 offset:12288
v_fma_f32 v93,v93,s36,v15
v_mfma_f32_16x16x32_bf16 v[144:147],a[120:123],v[52:55],v[144:147]
ds_read_b128 a[136:139],v0 offset:12288
v_fma_f32 v94,v94,s36,v15
v_mfma_f32_16x16x32_bf16 v[148:151],a[124:127],v[52:55],v[148:151]
v_exp_f32 v76,v76
v_mfma_f32_16x16x32_bf16 a[196:199],a[124:127],v[56:59],a[196:199]
buffer_load_dwordx4 v6,s[8:11],s21 offen offset:0 lds
v_mfma_f32_16x16x32_bf16 a[192:195],a[120:123],v[56:59],a[192:195]
ds_read_b128 a[124:127],v1 offset:12544
v_fma_f32 v95,v95,s36,v15
v_mfma_f32_16x16x32_bf16 a[200:203],a[128:131],v[56:59],a[200:203]
ds_read_b128 a[120:123],v0 offset:12544
v_fma_f32 v100,v100,s36,v16
v_mfma_f32_16x16x32_bf16 a[204:207],a[132:135],v[56:59],a[204:207]
v_exp_f32 v77,v77
v_mfma_f32_16x16x32_bf16 v[156:159],a[132:135],v[52:55],v[156:159]
v_exp_f32 v78,v78
v_mfma_f32_16x16x32_bf16 v[152:155],a[128:131],v[52:55],v[152:155]
v_exp_f32 v79,v79
v_mfma_f32_16x16x32_bf16 v[248:251],a[128:131],v[48:51],v[248:251]
v_cvt_pk_bf16_f32 v22,v76,v77
v_cvt_pk_bf16_f32 v23,v78,v79
v_mfma_f32_16x16x32_bf16 v[252:255],a[132:135],v[48:51],v[252:255]
v_exp_f32 v84,v84
v_mfma_f32_16x16x32_bf16 v[204:207],a[132:135],v[44:47],v[204:207]
ds_read_b128 a[132:135],v1 offset:18432
v_fma_f32 v101,v101,s36,v16
v_mfma_f32_16x16x32_bf16 v[200:203],a[128:131],v[44:47],v[200:203]
buffer_load_dwordx4 v7,s[8:11],s21 offen offset:1024 lds
s_waitcnt lgkmcnt(1)
v_mfma_f32_16x16x32_bf16 v[72:75],a[124:127],a[20:23],0
ds_read_b128 a[128:131],v0 offset:18432
v_fma_f32 v102,v102,s36,v16
v_mfma_f32_16x16x32_bf16 v[72:75],a[120:123],a[16:19],v[72:75]
v_exp_f32 v85,v85
v_mfma_f32_16x16x32_bf16 v[72:75],a[148:151],a[12:15],v[72:75]
v_exp_f32 v86,v86
v_mfma_f32_16x16x32_bf16 v[72:75],a[144:147],a[8:11],v[72:75]
v_exp_f32 v87,v87
v_mfma_f32_16x16x32_bf16 v[72:75],a[140:143],a[4:7],v[72:75]
v_cvt_pk_bf16_f32 v26,v84,v85
v_cvt_pk_bf16_f32 v27,v86,v87
v_mfma_f32_16x16x32_bf16 v[72:75],a[136:139],a[0:3],v[72:75]
v_exp_f32 v92,v92
v_smfmac_f32_16x16x64_bf16 v[60:63],a[152:155],v[20:27],v18
v_fma_f32 v103,v103,s36,v16
v_mfma_f32_16x16x32_bf16 v[80:83],a[136:139],a[24:27],0
v_exp_f32 v93,v93
v_mfma_f32_16x16x32_bf16 v[80:83],a[140:143],a[28:31],v[80:83]
buffer_load_dwordx4 v8,s[8:11],s21 offen offset:2048 lds
v_mfma_f32_16x16x32_bf16 v[80:83],a[144:147],a[32:35],v[80:83]
s_add_u32 s21,s21,12288
v_exp_f32 v94,v94
v_mfma_f32_16x16x32_bf16 v[80:83],a[148:151],a[36:39],v[80:83]
s_add_u32 m0,s22,0
v_exp_f32 v95,v95
v_mfma_f32_16x16x32_bf16 v[80:83],a[120:123],a[40:43],v[80:83]
v_cvt_pk_bf16_f32 v30,v92,v93
v_cvt_pk_bf16_f32 v31,v94,v95
v_mfma_f32_16x16x32_bf16 v[80:83],a[124:127],a[44:47],v[80:83]
v_exp_f32 v100,v100
v_mfma_f32_16x16x32_bf16 v[88:91],a[124:127],a[68:71],0
v_exp_f32 v101,v101
v_mfma_f32_16x16x32_bf16 v[88:91],a[120:123],a[64:67],v[88:91]
v_exp_f32 v102,v102
v_mfma_f32_16x16x32_bf16 v[88:91],a[148:151],a[60:63],v[88:91]
v_exp_f32 v103,v103
v_mfma_f32_16x16x32_bf16 v[88:91],a[144:147],a[56:59],v[88:91]
v_cvt_pk_bf16_f32 v34,v100,v101
v_cvt_pk_bf16_f32 v35,v102,v103
v_mfma_f32_16x16x32_bf16 v[88:91],a[140:143],a[52:55],v[88:91]
buffer_load_dwordx4 v6,s[4:7],s20 offen offset:0 lds
v_smfmac_f32_16x16x64_bf16 v[64:67],a[152:155],v[28:35],v18
v_fma_f32 v72,v72,s36,v13
v_mfma_f32_16x16x32_bf16 v[88:91],a[136:139],a[48:51],v[88:91]
v_fma_f32 v73,v73,s36,v13
v_fma_f32 v74,v74,s36,v13
v_mfma_f32_16x16x32_bf16 v[96:99],a[136:139],a[72:75],0
ds_read_b128 a[136:139],v0 offset:18560
v_fma_f32 v75,v75,s36,v13
v_mfma_f32_16x16x32_bf16 v[96:99],a[140:143],a[76:79],v[96:99]
ds_read_b128 a[140:143],v1 offset:18560
v_fma_f32 v80,v80,s36,v14
v_mfma_f32_16x16x32_bf16 v[96:99],a[144:147],a[80:83],v[96:99]
ds_read_b128 a[144:147],v0 offset:18688
v_fma_f32 v81,v81,s36,v14
v_mfma_f32_16x16x32_bf16 v[96:99],a[148:151],a[84:87],v[96:99]
ds_read_b128 a[148:151],v1 offset:18688
v_mfma_f32_16x16x32_bf16 v[96:99],a[120:123],a[88:91],v[96:99]
v_exp_f32 v72,v72
v_mfma_f32_16x16x32_bf16 v[96:99],a[124:127],a[92:95],v[96:99]
s_waitcnt lgkmcnt(4)
v_exp_f32 v73,v73
v_mfma_f32_16x16x32_bf16 v[76:79],a[128:131],a[0:3],0
buffer_load_dwordx4 v7,s[4:7],s20 offen offset:1024 lds
v_mfma_f32_16x16x32_bf16 v[76:79],a[132:135],a[4:7],v[76:79]
s_waitcnt lgkmcnt(3)
v_exp_f32 v74,v74
v_mfma_f32_16x16x32_bf16 v[76:79],a[136:139],a[8:11],v[76:79]
s_waitcnt lgkmcnt(2)
v_exp_f32 v75,v75
v_mfma_f32_16x16x32_bf16 v[76:79],a[140:143],a[12:15],v[76:79]
s_waitcnt lgkmcnt(0)
v_exp_f32 v80,v80
v_mfma_f32_16x16x32_bf16 v[76:79],a[144:147],a[16:19],v[76:79]
v_exp_f32 v81,v81
v_mfma_f32_16x16x32_bf16 v[76:79],a[148:151],a[20:23],v[76:79]
v_cvt_pk_bf16_f32 v44,v72,v73
v_cvt_pk_bf16_f32 v45,v74,v75
v_mfma_f32_16x16x32_bf16 v[84:87],a[148:151],a[44:47],0
v_cvt_pk_bf16_f32 v48,v80,v81
v_mfma_f32_16x16x32_bf16 v[84:87],a[144:147],a[40:43],v[84:87]
v_mfma_f32_16x16x32_bf16 v[84:87],a[140:143],a[36:39],v[84:87]
v_mfma_f32_16x16x32_bf16 v[84:87],a[136:139],a[32:35],v[84:87]
buffer_load_dwordx4 v8,s[4:7],s20 offen offset:2048 lds
v_mfma_f32_16x16x32_bf16 v[84:87],a[132:135],a[28:31],v[84:87]
s_add_u32 s20,s20,12288
v_mfma_f32_16x16x32_bf16 v[84:87],a[128:131],a[24:27],v[84:87]
ds_read_b64_tr_b16 a[120:121],v2 offset:0
v_mfma_f32_16x16x32_bf16 v[92:95],a[128:131],a[48:51],0
ds_read_b64_tr_b16 a[122:123],v2 offset:6144
v_mfma_f32_16x16x32_bf16 v[92:95],a[132:135],a[52:55],v[92:95]
ds_read_b64_tr_b16 a[124:125],v3 offset:0
v_mfma_f32_16x16x32_bf16 v[92:95],a[136:139],a[56:59],v[92:95]
ds_read_b64_tr_b16 a[126:127],v3 offset:6144
v_mfma_f32_16x16x32_bf16 v[92:95],a[140:143],a[60:63],v[92:95]
v_mfma_f32_16x16x32_bf16 v[92:95],a[144:147],a[64:67],v[92:95]
v_mfma_f32_16x16x32_bf16 v[92:95],a[148:151],a[68:71],v[92:95]
v_mfma_f32_16x16x32_bf16 v[100:103],a[148:151],a[92:95],0
v_mfma_f32_16x16x32_bf16 v[100:103],a[144:147],a[88:91],v[100:103]
v_mfma_f32_16x16x32_bf16 v[100:103],a[140:143],a[84:87],v[100:103]
v_mfma_f32_16x16x32_bf16 v[100:103],a[136:139],a[80:83],v[100:103]
v_mfma_f32_16x16x32_bf16 v[100:103],a[132:135],a[76:79],v[100:103]
ds_read_b64_tr_b16 a[132:133],v5 offset:0
v_mfma_f32_16x16x32_bf16 v[100:103],a[128:131],a[72:75],v[100:103]
s_waitcnt lgkmcnt(1)
ds_read_b64_tr_b16 a[128:129],v4 offset:0
ds_read_b64_tr_b16 a[130:131],v4 offset:6144
ds_read_b64_tr_b16 a[134:135],v5 offset:6144
v_mfma_f32_16x16x32_bf16 v[160:163],a[120:123],v[20:23],v[160:163]
ds_read_b128 a[156:159],v10 offset:6144
v_fma_f32 v82,v82,s36,v14
v_mfma_f32_16x16x32_bf16 v[164:167],a[124:127],v[20:23],v[164:167]
ds_read_b64_tr_b16 a[136:137],v2 offset:128
v_fma_f32 v83,v83,s36,v14
v_mfma_f32_16x16x32_bf16 v[212:215],a[124:127],v[24:27],v[212:215]
ds_read_b64_tr_b16 a[138:139],v2 offset:6272
v_fma_f32 v88,v88,s36,v15
v_mfma_f32_16x16x32_bf16 v[208:211],a[120:123],v[24:27],v[208:211]
ds_read_b64_tr_b16 a[140:141],v3 offset:128
v_fma_f32 v89,v89,s36,v15
v_mfma_f32_16x16x32_bf16 v[112:115],a[120:123],v[28:31],v[112:115]
ds_read_b64_tr_b16 a[142:143],v3 offset:6272
v_fma_f32 v90,v90,s36,v15
v_mfma_f32_16x16x32_bf16 v[116:119],a[124:127],v[28:31],v[116:119]
ds_read_b64_tr_b16 a[144:145],v4 offset:128
v_fma_f32 v91,v91,s36,v15
v_mfma_f32_16x16x32_bf16 a[164:167],a[124:127],v[32:35],a[164:167]
ds_read_b64_tr_b16 a[146:147],v4 offset:6272
v_fma_f32 v96,v96,s36,v16
v_mfma_f32_16x16x32_bf16 a[160:163],a[120:123],v[32:35],a[160:163]
s_waitcnt lgkmcnt(6)
ds_read_b64_tr_b16 a[148:149],v5 offset:128
v_fma_f32 v97,v97,s36,v16
v_mfma_f32_16x16x32_bf16 a[168:171],a[128:131],v[32:35],a[168:171]
ds_read_b64_tr_b16 a[150:151],v5 offset:6272
v_fma_f32 v98,v98,s36,v16
v_mfma_f32_16x16x32_bf16 a[172:175],a[132:135],v[32:35],a[172:175]
ds_read_b64_tr_b16 a[120:121],v2 offset:256
v_fma_f32 v99,v99,s36,v16
v_mfma_f32_16x16x32_bf16 v[124:127],a[132:135],v[28:31],v[124:127]
ds_read_b64_tr_b16 a[122:123],v2 offset:6400
v_fma_f32 v76,v76,s36,v13
v_mfma_f32_16x16x32_bf16 v[120:123],a[128:131],v[28:31],v[120:123]
ds_read_b64_tr_b16 a[124:125],v3 offset:256
v_fma_f32 v77,v77,s36,v13
v_mfma_f32_16x16x32_bf16 v[216:219],a[128:131],v[24:27],v[216:219]
ds_read_b64_tr_b16 a[126:127],v3 offset:6400
v_fma_f32 v78,v78,s36,v13
v_mfma_f32_16x16x32_bf16 v[220:223],a[132:135],v[24:27],v[220:223]
v_exp_f32 v82,v82
v_mfma_f32_16x16x32_bf16 v[172:175],a[132:135],v[20:23],v[172:175]
ds_read_b64_tr_b16 a[132:133],v5 offset:256
v_fma_f32 v79,v79,s36,v13
v_mfma_f32_16x16x32_bf16 v[168:171],a[128:131],v[20:23],v[168:171]
s_waitcnt lgkmcnt(5)
ds_read_b64_tr_b16 a[128:129],v4 offset:256
v_fma_f32 v84,v84,s36,v14
v_mfma_f32_16x16x32_bf16 v[176:179],a[136:139],v[20:23],v[176:179]
buffer_store_dwordx4 a[156:159],v9,s[16:19],s27 offen offset:0 nt
ds_read_b64_tr_b16 a[130:131],v4 offset:6400
ds_read_b128 a[156:159],v10 offset:7168
v_mfma_f32_16x16x32_bf16 v[180:183],a[140:143],v[20:23],v[180:183]
ds_read_b64_tr_b16 a[134:135],v5 offset:6400
v_mfma_f32_16x16x32_bf16 v[228:231],a[140:143],v[24:27],v[228:231]
v_exp_f32 v83,v83
v_mfma_f32_16x16x32_bf16 v[224:227],a[136:139],v[24:27],v[224:227]
v_cvt_pk_bf16_f32 v49,v82,v83
v_fma_f32 v85,v85,s36,v14
v_mfma_f32_16x16x32_bf16 v[128:131],a[136:139],v[28:31],v[128:131]
v_exp_f32 v88,v88
v_mfma_f32_16x16x32_bf16 v[132:135],a[140:143],v[28:31],v[132:135]
v_exp_f32 v89,v89
v_mfma_f32_16x16x32_bf16 a[180:183],a[140:143],v[32:35],a[180:183]
v_exp_f32 v90,v90
v_mfma_f32_16x16x32_bf16 a[176:179],a[136:139],v[32:35],a[176:179]
v_exp_f32 v91,v91
v_mfma_f32_16x16x32_bf16 a[184:187],a[144:147],v[32:35],a[184:187]
s_waitcnt lgkmcnt(1)
buffer_store_dwordx4 a[156:159],v9,s[16:19],s27 offen offset:128 nt
v_cvt_pk_bf16_f32 v52,v88,v89
v_cvt_pk_bf16_f32 v53,v90,v91
v_fma_f32 v86,v86,s36,v14
v_mfma_f32_16x16x32_bf16 a[188:191],a[148:151],v[32:35],a[188:191]
ds_read_b128 a[156:159],v10 offset:8192
v_fma_f32 v87,v87,s36,v14
v_mfma_f32_16x16x32_bf16 v[140:143],a[148:151],v[28:31],v[140:143]
v_exp_f32 v96,v96
v_mfma_f32_16x16x32_bf16 v[136:139],a[144:147],v[28:31],v[136:139]
v_exp_f32 v97,v97
v_mfma_f32_16x16x32_bf16 v[232:235],a[144:147],v[24:27],v[232:235]
v_exp_f32 v98,v98
v_mfma_f32_16x16x32_bf16 v[236:239],a[148:151],v[24:27],v[236:239]
v_exp_f32 v99,v99
v_mfma_f32_16x16x32_bf16 v[188:191],a[148:151],v[20:23],v[188:191]
v_cvt_pk_bf16_f32 v56,v96,v97
v_cvt_pk_bf16_f32 v57,v98,v99
v_mfma_f32_16x16x32_bf16 v[184:187],a[144:147],v[20:23],v[184:187]
v_exp_f32 v76,v76
v_mfma_f32_16x16x32_bf16 v[192:195],a[120:123],v[20:23],v[192:195]
v_exp_f32 v77,v77
v_mfma_f32_16x16x32_bf16 v[196:199],a[124:127],v[20:23],v[196:199]
s_waitcnt lgkmcnt(0)
buffer_store_dwordx4 a[156:159],v9,s[16:19],s27 offen offset:256 nt
v_exp_f32 v78,v78
v_cvt_pk_bf16_f32 v46,v76,v77
v_mfma_f32_16x16x32_bf16 v[244:247],a[124:127],v[24:27],v[244:247]
s_waitcnt vmcnt(12)
v_exp_f32 v79,v79
v_mfma_f32_16x16x32_bf16 v[240:243],a[120:123],v[24:27],v[240:243]
s_barrier
v_mfma_f32_16x16x32_bf16 v[144:147],a[120:123],v[28:31],v[144:147]
s_add_u32 s27,s27,3072
ds_read_b128 a[148:151],v1 offset:24704
v_cvt_pk_bf16_f32 v47,v78,v79
v_mfma_f32_16x16x32_bf16 v[148:151],a[124:127],v[28:31],v[148:151]
s_add_u32 m0,s23,0
ds_read_b128 a[144:147],v0 offset:24704
v_fma_f32 v92,v92,s36,v15
v_mfma_f32_16x16x32_bf16 a[196:199],a[124:127],v[32:35],a[196:199]
buffer_load_dwordx4 v6,s[8:11],s21 offen offset:0 lds
v_mfma_f32_16x16x32_bf16 a[192:195],a[120:123],v[32:35],a[192:195]
ds_read_b128 a[124:127],v1 offset:24832
v_fma_f32 v93,v93,s36,v15
v_mfma_f32_16x16x32_bf16 a[200:203],a[128:131],v[32:35],a[200:203]
ds_read_b128 a[120:123],v0 offset:24832
v_fma_f32 v94,v94,s36,v15
v_mfma_f32_16x16x32_bf16 a[204:207],a[132:135],v[32:35],a[204:207]
ds_read_b128 a[140:143],v1 offset:24576
v_fma_f32 v95,v95,s36,v15
v_mfma_f32_16x16x32_bf16 v[156:159],a[132:135],v[28:31],v[156:159]
ds_read_b128 a[136:139],v0 offset:24576
v_fma_f32 v100,v100,s36,v16
v_mfma_f32_16x16x32_bf16 v[152:155],a[128:131],v[28:31],v[152:155]
v_exp_f32 v84,v84
v_mfma_f32_16x16x32_bf16 v[248:251],a[128:131],v[24:27],v[248:251]
v_exp_f32 v85,v85
v_mfma_f32_16x16x32_bf16 v[252:255],a[132:135],v[24:27],v[252:255]
buffer_load_dwordx4 v7,s[8:11],s21 offen offset:1024 lds
v_mfma_f32_16x16x32_bf16 v[204:207],a[132:135],v[20:23],v[204:207]
ds_read_b128 a[132:135],v1 offset:30720
v_cvt_pk_bf16_f32 v50,v84,v85
v_mfma_f32_16x16x32_bf16 v[200:203],a[128:131],v[20:23],v[200:203]
s_waitcnt lgkmcnt(3)
ds_read_b128 a[128:131],v0 offset:30720
v_fma_f32 v101,v101,s36,v16
v_mfma_f32_16x16x32_bf16 v[72:75],a[124:127],a[20:23],0
v_exp_f32 v86,v86
v_mfma_f32_16x16x32_bf16 v[72:75],a[120:123],a[16:19],v[72:75]
v_exp_f32 v87,v87
v_mfma_f32_16x16x32_bf16 v[72:75],a[148:151],a[12:15],v[72:75]
v_cvt_pk_bf16_f32 v51,v86,v87
v_fma_f32 v102,v102,s36,v16
v_mfma_f32_16x16x32_bf16 v[72:75],a[144:147],a[8:11],v[72:75]
v_exp_f32 v92,v92
v_smfmac_f32_16x16x64_bf16 v[60:63],a[152:155],v[44:51],v18
s_waitcnt lgkmcnt(2)
v_fma_f32 v103,v103,s36,v16
v_mfma_f32_16x16x32_bf16 v[72:75],a[140:143],a[4:7],v[72:75]
v_exp_f32 v93,v93
v_mfma_f32_16x16x32_bf16 v[72:75],a[136:139],a[0:3],v[72:75]
buffer_load_dwordx4 v8,s[8:11],s21 offen offset:2048 lds
v_mfma_f32_16x16x32_bf16 v[80:83],a[136:139],a[24:27],0
s_add_u32 s21,s21,12288
v_exp_f32 v94,v94
v_mfma_f32_16x16x32_bf16 v[80:83],a[140:143],a[28:31],v[80:83]
s_cmp_eq_u32 s38,1
v_exp_f32 v95,v95
v_mfma_f32_16x16x32_bf16 v[80:83],a[144:147],a[32:35],v[80:83]
s_cselect_b32 s20,s26,s20
v_cvt_pk_bf16_f32 v54,v92,v93
v_cvt_pk_bf16_f32 v55,v94,v95
v_mfma_f32_16x16x32_bf16 v[80:83],a[148:151],a[36:39],v[80:83]
s_add_u32 m0,s22,12288
v_exp_f32 v100,v100
v_mfma_f32_16x16x32_bf16 v[80:83],a[120:123],a[40:43],v[80:83]
v_exp_f32 v101,v101
v_mfma_f32_16x16x32_bf16 v[80:83],a[124:127],a[44:47],v[80:83]
v_exp_f32 v102,v102
v_mfma_f32_16x16x32_bf16 v[88:91],a[124:127],a[68:71],0
v_exp_f32 v103,v103
v_mfma_f32_16x16x32_bf16 v[88:91],a[120:123],a[64:67],v[88:91]
v_cvt_pk_bf16_f32 v58,v100,v101
v_cvt_pk_bf16_f32 v59,v102,v103
v_mfma_f32_16x16x32_bf16 v[88:91],a[148:151],a[60:63],v[88:91]
buffer_load_dwordx4 v6,s[4:7],s20 offen offset:0 lds
v_smfmac_f32_16x16x64_bf16 v[64:67],a[152:155],v[52:59],v18
v_fma_f32 v72,v72,s36,v13
v_mfma_f32_16x16x32_bf16 v[88:91],a[144:147],a[56:59],v[88:91]
v_fma_f32 v73,v73,s36,v13
v_fma_f32 v74,v74,s36,v13
v_mfma_f32_16x16x32_bf16 v[88:91],a[140:143],a[52:55],v[88:91]
v_fma_f32 v75,v75,s36,v13
v_fma_f32 v80,v80,s36,v14
v_mfma_f32_16x16x32_bf16 v[88:91],a[136:139],a[48:51],v[88:91]
v_fma_f32 v81,v81,s36,v14
v_mfma_f32_16x16x32_bf16 v[96:99],a[136:139],a[72:75],0
ds_read_b128 a[136:139],v0 offset:30848
v_mfma_f32_16x16x32_bf16 v[96:99],a[140:143],a[76:79],v[96:99]
ds_read_b128 a[140:143],v1 offset:30848
v_mfma_f32_16x16x32_bf16 v[96:99],a[144:147],a[80:83],v[96:99]
ds_read_b128 a[144:147],v0 offset:30976
v_mfma_f32_16x16x32_bf16 v[96:99],a[148:151],a[84:87],v[96:99]
ds_read_b128 a[148:151],v1 offset:30976
v_mfma_f32_16x16x32_bf16 v[96:99],a[120:123],a[88:91],v[96:99]
buffer_load_dwordx4 v7,s[4:7],s20 offen offset:1024 lds
v_mfma_f32_16x16x32_bf16 v[96:99],a[124:127],a[92:95],v[96:99]
s_waitcnt lgkmcnt(4)
v_exp_f32 v72,v72
v_mfma_f32_16x16x32_bf16 v[76:79],a[128:131],a[0:3],0
v_exp_f32 v73,v73
v_mfma_f32_16x16x32_bf16 v[76:79],a[132:135],a[4:7],v[76:79]
s_waitcnt lgkmcnt(3)
v_exp_f32 v74,v74
v_mfma_f32_16x16x32_bf16 v[76:79],a[136:139],a[8:11],v[76:79]
s_waitcnt lgkmcnt(2)
v_exp_f32 v75,v75
v_mfma_f32_16x16x32_bf16 v[76:79],a[140:143],a[12:15],v[76:79]
s_waitcnt lgkmcnt(0)
v_exp_f32 v80,v80
v_mfma_f32_16x16x32_bf16 v[76:79],a[144:147],a[16:19],v[76:79]
v_exp_f32 v81,v81
v_mfma_f32_16x16x32_bf16 v[76:79],a[148:151],a[20:23],v[76:79]
v_cvt_pk_bf16_f32 v20,v72,v73
v_cvt_pk_bf16_f32 v21,v74,v75
v_mfma_f32_16x16x32_bf16 v[84:87],a[148:151],a[44:47],0
v_cvt_pk_bf16_f32 v24,v80,v81
v_mfma_f32_16x16x32_bf16 v[84:87],a[144:147],a[40:43],v[84:87]
buffer_load_dwordx4 v8,s[4:7],s20 offen offset:2048 lds
v_mfma_f32_16x16x32_bf16 v[84:87],a[140:143],a[36:39],v[84:87]
s_add_u32 s20,s20,12288
v_mfma_f32_16x16x32_bf16 v[84:87],a[136:139],a[32:35],v[84:87]
ds_read_b64_tr_b16 a[120:121],v2 offset:12288
v_mfma_f32_16x16x32_bf16 v[84:87],a[132:135],a[28:31],v[84:87]
ds_read_b64_tr_b16 a[122:123],v2 offset:18432
v_mfma_f32_16x16x32_bf16 v[84:87],a[128:131],a[24:27],v[84:87]
ds_read_b64_tr_b16 a[124:125],v3 offset:12288
v_mfma_f32_16x16x32_bf16 v[92:95],a[128:131],a[48:51],0
ds_read_b64_tr_b16 a[126:127],v3 offset:18432
v_mfma_f32_16x16x32_bf16 v[92:95],a[132:135],a[52:55],v[92:95]
v_mfma_f32_16x16x32_bf16 v[92:95],a[136:139],a[56:59],v[92:95]
v_mfma_f32_16x16x32_bf16 v[92:95],a[140:143],a[60:63],v[92:95]
v_mfma_f32_16x16x32_bf16 v[92:95],a[144:147],a[64:67],v[92:95]
v_mfma_f32_16x16x32_bf16 v[92:95],a[148:151],a[68:71],v[92:95]
v_mfma_f32_16x16x32_bf16 v[100:103],a[148:151],a[92:95],0
v_mfma_f32_16x16x32_bf16 v[100:103],a[144:147],a[88:91],v[100:103]
v_mfma_f32_16x16x32_bf16 v[100:103],a[140:143],a[84:87],v[100:103]
v_mfma_f32_16x16x32_bf16 v[100:103],a[136:139],a[80:83],v[100:103]
v_mfma_f32_16x16x32_bf16 v[100:103],a[132:135],a[76:79],v[100:103]
ds_read_b64_tr_b16 a[132:133],v5 offset:12288
v_mfma_f32_16x16x32_bf16 v[100:103],a[128:131],a[72:75],v[100:103]
s_waitcnt lgkmcnt(1)
ds_read_b64_tr_b16 a[128:129],v4 offset:12288
ds_read_b64_tr_b16 a[130:131],v4 offset:18432
ds_read_b64_tr_b16 a[134:135],v5 offset:18432
v_mfma_f32_16x16x32_bf16 v[160:163],a[120:123],v[44:47],v[160:163]
s_add_u32 m0,s29,0
ds_read_b64_tr_b16 a[136:137],v2 offset:12416
v_fma_f32 v82,v82,s36,v14
v_mfma_f32_16x16x32_bf16 v[164:167],a[124:127],v[44:47],v[164:167]
ds_read_b64_tr_b16 a[138:139],v2 offset:18560
v_fma_f32 v83,v83,s36,v14
v_mfma_f32_16x16x32_bf16 v[212:215],a[124:127],v[48:51],v[212:215]
ds_read_b64_tr_b16 a[140:141],v3 offset:12416
v_fma_f32 v88,v88,s36,v15
v_mfma_f32_16x16x32_bf16 v[208:211],a[120:123],v[48:51],v[208:211]
ds_read_b64_tr_b16 a[142:143],v3 offset:18560
v_fma_f32 v89,v89,s36,v15
v_mfma_f32_16x16x32_bf16 v[112:115],a[120:123],v[52:55],v[112:115]
ds_read_b64_tr_b16 a[144:145],v4 offset:12416
v_fma_f32 v90,v90,s36,v15
v_mfma_f32_16x16x32_bf16 v[116:119],a[124:127],v[52:55],v[116:119]
ds_read_b64_tr_b16 a[146:147],v4 offset:18560
v_fma_f32 v91,v91,s36,v15
v_mfma_f32_16x16x32_bf16 a[164:167],a[124:127],v[56:59],a[164:167]
buffer_load_dwordx4 v6,s[12:15],s28 offen offset:0 nt lds
v_mfma_f32_16x16x32_bf16 a[160:163],a[120:123],v[56:59],a[160:163]
s_waitcnt lgkmcnt(5)
ds_read_b64_tr_b16 a[148:149],v5 offset:12416
v_fma_f32 v96,v96,s36,v16
v_mfma_f32_16x16x32_bf16 a[168:171],a[128:131],v[56:59],a[168:171]
ds_read_b64_tr_b16 a[150:151],v5 offset:18560
v_fma_f32 v97,v97,s36,v16
v_mfma_f32_16x16x32_bf16 a[172:175],a[132:135],v[56:59],a[172:175]
ds_read_b64_tr_b16 a[120:121],v2 offset:12544
v_fma_f32 v98,v98,s36,v16
v_mfma_f32_16x16x32_bf16 v[124:127],a[132:135],v[52:55],v[124:127]
ds_read_b64_tr_b16 a[122:123],v2 offset:18688
v_fma_f32 v99,v99,s36,v16
v_mfma_f32_16x16x32_bf16 v[120:123],a[128:131],v[52:55],v[120:123]
ds_read_b64_tr_b16 a[124:125],v3 offset:12544
v_fma_f32 v76,v76,s36,v13
v_mfma_f32_16x16x32_bf16 v[216:219],a[128:131],v[48:51],v[216:219]
ds_read_b64_tr_b16 a[126:127],v3 offset:18688
v_fma_f32 v77,v77,s36,v13
v_mfma_f32_16x16x32_bf16 v[220:223],a[132:135],v[48:51],v[220:223]
buffer_load_dwordx4 v7,s[12:15],s28 offen offset:1024 nt lds
v_mfma_f32_16x16x32_bf16 v[172:175],a[132:135],v[44:47],v[172:175]
ds_read_b64_tr_b16 a[132:133],v5 offset:12544
v_fma_f32 v78,v78,s36,v13
v_mfma_f32_16x16x32_bf16 v[168:171],a[128:131],v[44:47],v[168:171]
s_waitcnt lgkmcnt(5)
ds_read_b64_tr_b16 a[128:129],v4 offset:12544
v_fma_f32 v79,v79,s36,v13
v_mfma_f32_16x16x32_bf16 v[176:179],a[136:139],v[44:47],v[176:179]
ds_read_b64_tr_b16 a[130:131],v4 offset:18688
v_fma_f32 v84,v84,s36,v14
v_mfma_f32_16x16x32_bf16 v[180:183],a[140:143],v[44:47],v[180:183]
ds_read_b64_tr_b16 a[134:135],v5 offset:18688
v_fma_f32 v85,v85,s36,v14
v_mfma_f32_16x16x32_bf16 v[228:231],a[140:143],v[48:51],v[228:231]
v_exp_f32 v82,v82
v_mfma_f32_16x16x32_bf16 v[224:227],a[136:139],v[48:51],v[224:227]
v_exp_f32 v83,v83
v_mfma_f32_16x16x32_bf16 v[128:131],a[136:139],v[52:55],v[128:131]
v_cvt_pk_bf16_f32 v25,v82,v83
v_fma_f32 v86,v86,s36,v14
v_mfma_f32_16x16x32_bf16 v[132:135],a[140:143],v[52:55],v[132:135]
buffer_load_dwordx4 v8,s[12:15],s28 offen offset:2048 nt lds
v_mfma_f32_16x16x32_bf16 a[180:183],a[140:143],v[56:59],a[180:183]
s_add_u32 s28,s28,3072
v_exp_f32 v88,v88
v_mfma_f32_16x16x32_bf16 a[176:179],a[136:139],v[56:59],a[176:179]
s_add_u32 s29,s29,3072
v_exp_f32 v89,v89
v_mfma_f32_16x16x32_bf16 a[184:187],a[144:147],v[56:59],a[184:187]
s_cmp_eq_u32 s38,1
v_exp_f32 v90,v90
v_mfma_f32_16x16x32_bf16 a[188:191],a[148:151],v[56:59],a[188:191]
s_cselect_b32 s21,s26,s21
v_exp_f32 v91,v91
v_mfma_f32_16x16x32_bf16 v[140:143],a[148:151],v[52:55],v[140:143]
s_add_u32 m0,s23,12288
v_cvt_pk_bf16_f32 v28,v88,v89
v_cvt_pk_bf16_f32 v29,v90,v91
v_mfma_f32_16x16x32_bf16 v[136:139],a[144:147],v[52:55],v[136:139]
v_exp_f32 v96,v96
v_mfma_f32_16x16x32_bf16 v[232:235],a[144:147],v[48:51],v[232:235]
v_exp_f32 v97,v97
v_mfma_f32_16x16x32_bf16 v[236:239],a[148:151],v[48:51],v[236:239]
v_exp_f32 v98,v98
v_mfma_f32_16x16x32_bf16 v[188:191],a[148:151],v[44:47],v[188:191]
v_exp_f32 v99,v99
v_mfma_f32_16x16x32_bf16 v[184:187],a[144:147],v[44:47],v[184:187]
s_waitcnt vmcnt(12)
v_cvt_pk_bf16_f32 v32,v96,v97
v_cvt_pk_bf16_f32 v33,v98,v99
s_waitcnt lgkmcnt(0)
v_mfma_f32_16x16x32_bf16 v[192:195],a[120:123],v[44:47],v[192:195]
s_barrier
v_mfma_f32_16x16x32_bf16 v[196:199],a[124:127],v[44:47],v[196:199]
ds_read_b128 a[148:151],v1 offset:128
v_fma_f32 v87,v87,s36,v14
v_mfma_f32_16x16x32_bf16 v[244:247],a[124:127],v[48:51],v[244:247]
ds_read_b128 a[144:147],v0 offset:128
v_fma_f32 v92,v92,s36,v15
v_mfma_f32_16x16x32_bf16 v[240:243],a[120:123],v[48:51],v[240:243]
ds_read_b128 a[140:143],v1 offset:0
v_fma_f32 v93,v93,s36,v15
v_mfma_f32_16x16x32_bf16 v[144:147],a[120:123],v[52:55],v[144:147]
ds_read_b128 a[136:139],v0 offset:0
v_fma_f32 v94,v94,s36,v15
v_mfma_f32_16x16x32_bf16 v[148:151],a[124:127],v[52:55],v[148:151]
v_exp_f32 v76,v76
v_mfma_f32_16x16x32_bf16 a[196:199],a[124:127],v[56:59],a[196:199]
buffer_load_dwordx4 v6,s[8:11],s21 offen offset:0 lds
v_mfma_f32_16x16x32_bf16 a[192:195],a[120:123],v[56:59],a[192:195]
ds_read_b128 a[124:127],v1 offset:256
v_fma_f32 v95,v95,s36,v15
v_mfma_f32_16x16x32_bf16 a[200:203],a[128:131],v[56:59],a[200:203]
ds_read_b128 a[120:123],v0 offset:256
v_fma_f32 v100,v100,s36,v16
v_mfma_f32_16x16x32_bf16 a[204:207],a[132:135],v[56:59],a[204:207]
v_exp_f32 v77,v77
v_mfma_f32_16x16x32_bf16 v[156:159],a[132:135],v[52:55],v[156:159]
v_exp_f32 v78,v78
v_mfma_f32_16x16x32_bf16 v[152:155],a[128:131],v[52:55],v[152:155]
v_exp_f32 v79,v79
v_mfma_f32_16x16x32_bf16 v[248:251],a[128:131],v[48:51],v[248:251]
v_cvt_pk_bf16_f32 v22,v76,v77
v_cvt_pk_bf16_f32 v23,v78,v79
v_mfma_f32_16x16x32_bf16 v[252:255],a[132:135],v[48:51],v[252:255]
v_exp_f32 v84,v84
v_mfma_f32_16x16x32_bf16 v[204:207],a[132:135],v[44:47],v[204:207]
ds_read_b128 a[132:135],v1 offset:6144
v_fma_f32 v101,v101,s36,v16
v_mfma_f32_16x16x32_bf16 v[200:203],a[128:131],v[44:47],v[200:203]
buffer_load_dwordx4 v7,s[8:11],s21 offen offset:1024 lds
s_waitcnt lgkmcnt(1)
v_mfma_f32_16x16x32_bf16 v[72:75],a[124:127],a[20:23],0
ds_read_b128 a[128:131],v0 offset:6144
v_fma_f32 v102,v102,s36,v16
v_mfma_f32_16x16x32_bf16 v[72:75],a[120:123],a[16:19],v[72:75]
v_exp_f32 v85,v85
v_mfma_f32_16x16x32_bf16 v[72:75],a[148:151],a[12:15],v[72:75]
v_exp_f32 v86,v86
v_mfma_f32_16x16x32_bf16 v[72:75],a[144:147],a[8:11],v[72:75]
v_exp_f32 v87,v87
v_mfma_f32_16x16x32_bf16 v[72:75],a[140:143],a[4:7],v[72:75]
v_cvt_pk_bf16_f32 v26,v84,v85
v_cvt_pk_bf16_f32 v27,v86,v87
v_mfma_f32_16x16x32_bf16 v[72:75],a[136:139],a[0:3],v[72:75]
v_exp_f32 v92,v92
v_smfmac_f32_16x16x64_bf16 v[60:63],a[152:155],v[20:27],v18
v_fma_f32 v103,v103,s36,v16
v_mfma_f32_16x16x32_bf16 v[80:83],a[136:139],a[24:27],0
v_exp_f32 v93,v93
v_mfma_f32_16x16x32_bf16 v[80:83],a[140:143],a[28:31],v[80:83]
buffer_load_dwordx4 v8,s[8:11],s21 offen offset:2048 lds
v_mfma_f32_16x16x32_bf16 v[80:83],a[144:147],a[32:35],v[80:83]
s_add_u32 s21,s21,12288
v_exp_f32 v94,v94
v_mfma_f32_16x16x32_bf16 v[80:83],a[148:151],a[36:39],v[80:83]
s_add_u32 m0,s22,24576
v_exp_f32 v95,v95
v_mfma_f32_16x16x32_bf16 v[80:83],a[120:123],a[40:43],v[80:83]
v_cvt_pk_bf16_f32 v30,v92,v93
v_cvt_pk_bf16_f32 v31,v94,v95
v_mfma_f32_16x16x32_bf16 v[80:83],a[124:127],a[44:47],v[80:83]
v_exp_f32 v100,v100
v_mfma_f32_16x16x32_bf16 v[88:91],a[124:127],a[68:71],0
v_exp_f32 v101,v101
v_mfma_f32_16x16x32_bf16 v[88:91],a[120:123],a[64:67],v[88:91]
v_exp_f32 v102,v102
v_mfma_f32_16x16x32_bf16 v[88:91],a[148:151],a[60:63],v[88:91]
v_exp_f32 v103,v103
v_mfma_f32_16x16x32_bf16 v[88:91],a[144:147],a[56:59],v[88:91]
v_cvt_pk_bf16_f32 v34,v100,v101
v_cvt_pk_bf16_f32 v35,v102,v103
v_mfma_f32_16x16x32_bf16 v[88:91],a[140:143],a[52:55],v[88:91]
buffer_load_dwordx4 v6,s[4:7],s20 offen offset:0 lds
v_smfmac_f32_16x16x64_bf16 v[64:67],a[152:155],v[28:35],v18
v_fma_f32 v72,v72,s36,v13
v_mfma_f32_16x16x32_bf16 v[88:91],a[136:139],a[48:51],v[88:91]
v_fma_f32 v73,v73,s36,v13
v_fma_f32 v74,v74,s36,v13
v_mfma_f32_16x16x32_bf16 v[96:99],a[136:139],a[72:75],0
ds_read_b128 a[136:139],v0 offset:6272
v_fma_f32 v75,v75,s36,v13
v_mfma_f32_16x16x32_bf16 v[96:99],a[140:143],a[76:79],v[96:99]
ds_read_b128 a[140:143],v1 offset:6272
v_fma_f32 v80,v80,s36,v14
v_mfma_f32_16x16x32_bf16 v[96:99],a[144:147],a[80:83],v[96:99]
ds_read_b128 a[144:147],v0 offset:6400
v_fma_f32 v81,v81,s36,v14
v_mfma_f32_16x16x32_bf16 v[96:99],a[148:151],a[84:87],v[96:99]
ds_read_b128 a[148:151],v1 offset:6400
v_add_u32 v10,9216,v10
v_mfma_f32_16x16x32_bf16 v[96:99],a[120:123],a[88:91],v[96:99]
v_exp_f32 v72,v72
v_mfma_f32_16x16x32_bf16 v[96:99],a[124:127],a[92:95],v[96:99]
s_waitcnt lgkmcnt(4)
v_exp_f32 v73,v73
v_mfma_f32_16x16x32_bf16 v[76:79],a[128:131],a[0:3],0
buffer_load_dwordx4 v7,s[4:7],s20 offen offset:1024 lds
v_mfma_f32_16x16x32_bf16 v[76:79],a[132:135],a[4:7],v[76:79]
s_waitcnt lgkmcnt(3)
v_exp_f32 v74,v74
v_mfma_f32_16x16x32_bf16 v[76:79],a[136:139],a[8:11],v[76:79]
s_waitcnt lgkmcnt(2)
v_exp_f32 v75,v75
v_mfma_f32_16x16x32_bf16 v[76:79],a[140:143],a[12:15],v[76:79]
s_waitcnt lgkmcnt(0)
v_exp_f32 v80,v80
v_mfma_f32_16x16x32_bf16 v[76:79],a[144:147],a[16:19],v[76:79]
v_exp_f32 v81,v81
v_mfma_f32_16x16x32_bf16 v[76:79],a[148:151],a[20:23],v[76:79]
v_cvt_pk_bf16_f32 v44,v72,v73
v_cvt_pk_bf16_f32 v45,v74,v75
v_mfma_f32_16x16x32_bf16 v[84:87],a[148:151],a[44:47],0
v_cvt_pk_bf16_f32 v48,v80,v81
v_mfma_f32_16x16x32_bf16 v[84:87],a[144:147],a[40:43],v[84:87]
v_mfma_f32_16x16x32_bf16 v[84:87],a[140:143],a[36:39],v[84:87]
v_mfma_f32_16x16x32_bf16 v[84:87],a[136:139],a[32:35],v[84:87]
buffer_load_dwordx4 v8,s[4:7],s20 offen offset:2048 lds
v_mfma_f32_16x16x32_bf16 v[84:87],a[132:135],a[28:31],v[84:87]
s_add_u32 s20,s20,12288
s_add_u32 s38,s38,1
s_cmp_lt_u32 s38,2
v_mfma_f32_16x16x32_bf16 v[84:87],a[128:131],a[24:27],v[84:87]
ds_read_b64_tr_b16 a[120:121],v2 offset:24576
v_mfma_f32_16x16x32_bf16 v[92:95],a[128:131],a[48:51],0
ds_read_b64_tr_b16 a[122:123],v2 offset:30720
v_mfma_f32_16x16x32_bf16 v[92:95],a[132:135],a[52:55],v[92:95]
ds_read_b64_tr_b16 a[124:125],v3 offset:24576
v_mfma_f32_16x16x32_bf16 v[92:95],a[136:139],a[56:59],v[92:95]
ds_read_b64_tr_b16 a[126:127],v3 offset:30720
v_mfma_f32_16x16x32_bf16 v[92:95],a[140:143],a[60:63],v[92:95]
v_mfma_f32_16x16x32_bf16 v[92:95],a[144:147],a[64:67],v[92:95]
v_mfma_f32_16x16x32_bf16 v[92:95],a[148:151],a[68:71],v[92:95]
v_mfma_f32_16x16x32_bf16 v[100:103],a[148:151],a[92:95],0
v_mfma_f32_16x16x32_bf16 v[100:103],a[144:147],a[88:91],v[100:103]
v_mfma_f32_16x16x32_bf16 v[100:103],a[140:143],a[84:87],v[100:103]
v_mfma_f32_16x16x32_bf16 v[100:103],a[136:139],a[80:83],v[100:103]
v_mfma_f32_16x16x32_bf16 v[100:103],a[132:135],a[76:79],v[100:103]
ds_read_b64_tr_b16 a[132:133],v5 offset:24576
v_mfma_f32_16x16x32_bf16 v[100:103],a[128:131],a[72:75],v[100:103]
ds_read_b64_tr_b16 a[128:129],v4 offset:24576
ds_read_b64_tr_b16 a[130:131],v4 offset:30720
ds_read_b64_tr_b16 a[134:135],v5 offset:30720
s_cbranch_scc1 L_loop4w0
s_cmp_ge_u32 s69,6
s_cbranch_scc1 L_end4
s_cmp_eq_u32 s40,0
s_cbranch_scc1 L_tr44
s_branch L_tr45
L_tr45:
s_waitcnt vmcnt(43)
s_waitcnt lgkmcnt(3)
v_mfma_f32_16x16x32_bf16 v[160:163],a[120:123],v[20:23],v[160:163]
s_add_u32 m0,s24,0
ds_read_b128 a[4:7],v12 offset:0
v_fma_f32 v79,v79,s36,v13
v_mfma_f32_16x16x32_bf16 v[164:167],a[124:127],v[20:23],v[164:167]
ds_read_b128 a[12:15],v12 offset:128
v_fma_f32 v100,v100,s36,v16
v_mfma_f32_16x16x32_bf16 v[212:215],a[124:127],v[24:27],v[212:215]
ds_read_b128 a[20:23],v12 offset:256
v_fma_f32 v101,v101,s36,v16
v_mfma_f32_16x16x32_bf16 v[208:211],a[120:123],v[24:27],v[208:211]
ds_read_b128 a[8:11],v11 offset:128
v_fma_f32 v89,v89,s36,v15
v_mfma_f32_16x16x32_bf16 v[112:115],a[120:123],v[28:31],v[112:115]
ds_read_b128 a[0:3],v11 offset:0
v_fma_f32 v76,v76,s36,v13
v_mfma_f32_16x16x32_bf16 v[116:119],a[124:127],v[28:31],v[116:119]
ds_read_b128 a[16:19],v11 offset:256
v_fma_f32 v83,v83,s36,v14
v_mfma_f32_16x16x32_bf16 a[164:167],a[124:127],v[32:35],a[164:167]
ds_read_b64_tr_b16 a[138:139],v2 offset:30848
v_fma_f32 v90,v90,s36,v15
v_mfma_f32_16x16x32_bf16 a[160:163],a[120:123],v[32:35],a[160:163]
s_waitcnt lgkmcnt(6)
ds_read_b64_tr_b16 a[136:137],v2 offset:24704
v_fma_f32 v88,v88,s36,v15
v_mfma_f32_16x16x32_bf16 a[168:171],a[128:131],v[32:35],a[168:171]
ds_read_b64_tr_b16 a[142:143],v3 offset:30848
ds_read_b64_tr_b16 a[140:141],v3 offset:24704
ds_read_b64_tr_b16 a[146:147],v4 offset:30848
ds_read_b64_tr_b16 a[144:145],v4 offset:24704
ds_read_b64_tr_b16 a[150:151],v5 offset:30848
ds_read_b64_tr_b16 a[148:149],v5 offset:24704
ds_read_b128 a[32:35],v11 offset:6272
v_mfma_f32_16x16x32_bf16 a[172:175],a[132:135],v[32:35],a[172:175]
v_fma_f32 v91,v91,s36,v15
ds_read_b128 a[40:43],v11 offset:6400
v_mfma_f32_16x16x32_bf16 v[124:127],a[132:135],v[28:31],v[124:127]
s_waitcnt lgkmcnt(10)
buffer_load_dwordx4 v6,s[12:15],s28 offen offset:0 nt lds
v_mfma_f32_16x16x32_bf16 v[120:123],a[128:131],v[28:31],v[120:123]
ds_read_b64_tr_b16 a[122:123],v2 offset:30976
ds_read_b64_tr_b16 a[120:121],v2 offset:24832
ds_read_b64_tr_b16 a[124:125],v3 offset:24832
ds_read_b64_tr_b16 a[126:127],v3 offset:30976
ds_read_b128 a[44:47],v12 offset:6400
v_mfma_f32_16x16x32_bf16 v[216:219],a[128:131],v[24:27],v[216:219]
v_fma_f32 v93,v93,s36,v15
ds_read_b128 a[28:31],v12 offset:6144
v_mfma_f32_16x16x32_bf16 v[220:223],a[132:135],v[24:27],v[220:223]
v_fma_f32 v98,v98,s36,v16
ds_read_b128 a[36:39],v12 offset:6272
v_mfma_f32_16x16x32_bf16 v[172:175],a[132:135],v[20:23],v[172:175]
buffer_load_dwordx4 v7,s[12:15],s28 offen offset:1024 nt lds
v_mfma_f32_16x16x32_bf16 v[168:171],a[128:131],v[20:23],v[168:171]
s_waitcnt lgkmcnt(7)
ds_read_b64_tr_b16 a[130:131],v4 offset:30976
ds_read_b128 a[24:27],v11 offset:6144
v_mfma_f32_16x16x32_bf16 v[176:179],a[136:139],v[20:23],v[176:179]
v_fma_f32 v82,v82,s36,v14
v_exp_f32 v93,v93
v_mfma_f32_16x16x32_bf16 v[180:183],a[140:143],v[20:23],v[180:183]
ds_read_b64_tr_b16 a[128:129],v4 offset:24832
v_fma_f32 v85,v85,s36,v14
v_mfma_f32_16x16x32_bf16 v[228:231],a[140:143],v[24:27],v[228:231]
ds_read_b64_tr_b16 a[134:135],v5 offset:30976
v_exp_f32 v82,v82
v_mfma_f32_16x16x32_bf16 v[224:227],a[136:139],v[24:27],v[224:227]
ds_read_b64_tr_b16 a[132:133],v5 offset:24832
v_fma_f32 v84,v84,s36,v14
v_mfma_f32_16x16x32_bf16 v[128:131],a[136:139],v[28:31],v[128:131]
v_exp_f32 v84,v84
v_mfma_f32_16x16x32_bf16 v[132:135],a[140:143],v[28:31],v[132:135]
buffer_load_dwordx4 v8,s[12:15],s28 offen offset:2048 nt lds
v_mfma_f32_16x16x32_bf16 a[180:183],a[140:143],v[32:35],a[180:183]
s_add_u32 s28,s28,3072
v_fma_f32 v103,v103,s36,v16
v_exp_f32 v103,v103
v_mfma_f32_16x16x32_bf16 a[176:179],a[136:139],v[32:35],a[176:179]
s_add_u32 m0,s24,3072
v_fma_f32 v87,v87,s36,v14
v_exp_f32 v87,v87
v_mfma_f32_16x16x32_bf16 a[184:187],a[144:147],v[32:35],a[184:187]
v_fma_f32 v77,v77,s36,v13
v_exp_f32 v77,v77
v_mfma_f32_16x16x32_bf16 a[188:191],a[148:151],v[32:35],a[188:191]
v_fma_f32 v97,v97,s36,v16
v_exp_f32 v91,v91
v_mfma_f32_16x16x32_bf16 v[140:143],a[148:151],v[28:31],v[140:143]
v_fma_f32 v102,v102,s36,v16
v_exp_f32 v85,v85
v_mfma_f32_16x16x32_bf16 v[136:139],a[144:147],v[28:31],v[136:139]
v_exp_f32 v89,v89
v_mfma_f32_16x16x32_bf16 v[232:235],a[144:147],v[24:27],v[232:235]
buffer_load_dwordx4 v6,s[12:15],s28 offen offset:0 nt lds
v_mfma_f32_16x16x32_bf16 v[236:239],a[148:151],v[24:27],v[236:239]
v_fma_f32 v92,v92,s36,v15
v_exp_f32 v101,v101
v_mfma_f32_16x16x32_bf16 v[188:191],a[148:151],v[20:23],v[188:191]
v_fma_f32 v94,v94,s36,v15
v_fma_f32 v95,v95,s36,v15
v_mfma_f32_16x16x32_bf16 v[184:187],a[144:147],v[20:23],v[184:187]
s_waitcnt lgkmcnt(0)
v_exp_f32 v95,v95
v_mfma_f32_16x16x32_bf16 v[192:195],a[120:123],v[20:23],v[192:195]
v_fma_f32 v86,v86,s36,v14
v_fma_f32 v78,v78,s36,v13
v_mfma_f32_16x16x32_bf16 v[196:199],a[124:127],v[20:23],v[196:199]
v_exp_f32 v92,v92
v_mfma_f32_16x16x32_bf16 v[244:247],a[124:127],v[24:27],v[244:247]
v_exp_f32 v78,v78
v_mfma_f32_16x16x32_bf16 v[240:243],a[120:123],v[24:27],v[240:243]
buffer_load_dwordx4 v7,s[12:15],s28 offen offset:1024 nt lds
v_mfma_f32_16x16x32_bf16 v[144:147],a[120:123],v[28:31],v[144:147]
v_exp_f32 v94,v94
v_mfma_f32_16x16x32_bf16 v[148:151],a[124:127],v[28:31],v[148:151]
v_exp_f32 v90,v90
v_mfma_f32_16x16x32_bf16 a[196:199],a[124:127],v[32:35],a[196:199]
v_fma_f32 v96,v96,s36,v16
v_exp_f32 v96,v96
v_mfma_f32_16x16x32_bf16 a[192:195],a[120:123],v[32:35],a[192:195]
v_fma_f32 v99,v99,s36,v16
v_exp_f32 v83,v83
v_mfma_f32_16x16x32_bf16 a[200:203],a[128:131],v[32:35],a[200:203]
v_exp_f32 v97,v97
v_mfma_f32_16x16x32_bf16 a[204:207],a[132:135],v[32:35],a[204:207]
v_exp_f32 v88,v88
v_mfma_f32_16x16x32_bf16 v[156:159],a[132:135],v[28:31],v[156:159]
v_exp_f32 v98,v98
v_mfma_f32_16x16x32_bf16 v[152:155],a[128:131],v[28:31],v[152:155]
buffer_load_dwordx4 v8,s[12:15],s28 offen offset:2048 nt lds
s_waitcnt vmcnt(18)
s_barrier
v_mfma_f32_16x16x32_bf16 v[248:251],a[128:131],v[24:27],v[248:251]
s_add_u32 s28,s28,3072
ds_read_b64_tr_b16 a[138:139],v2 offset:6144
v_exp_f32 v79,v79
v_mfma_f32_16x16x32_bf16 v[252:255],a[132:135],v[24:27],v[252:255]
s_add_u32 m0,s22,0
ds_read_b64_tr_b16 a[136:137],v2 offset:0
buffer_load_dwordx4 v6,s[4:7],s25 offen offset:0 lds
v_mfma_f32_16x16x32_bf16 v[204:207],a[132:135],v[20:23],v[204:207]
buffer_load_dwordx4 v7,s[4:7],s25 offen offset:1024 lds
v_mfma_f32_16x16x32_bf16 v[200:203],a[128:131],v[20:23],v[200:203]
buffer_load_dwordx4 v8,s[4:7],s25 offen offset:2048 lds
ds_read_b64_tr_b16 a[142:143],v3 offset:6144
ds_read_b64_tr_b16 a[140:141],v3 offset:0
ds_read_b64_tr_b16 a[144:145],v4 offset:0
ds_read_b64_tr_b16 a[146:147],v4 offset:6144
ds_read_b64_tr_b16 a[148:149],v5 offset:0
ds_read_b64_tr_b16 a[150:151],v5 offset:6144
v_exp_f32 v100,v100
v_cvt_pk_bf16_f32 v47,v78,v79
v_cvt_pk_bf16_f32 v49,v82,v83
v_exp_f32 v76,v76
v_exp_f32 v102,v102
v_exp_f32 v86,v86
v_cvt_pk_bf16_f32 v59,v102,v103
v_exp_f32 v99,v99
v_cvt_pk_bf16_f32 v50,v84,v85
v_cvt_pk_bf16_f32 v57,v98,v99
v_cvt_pk_bf16_f32 v55,v94,v95
v_cvt_pk_bf16_f32 v54,v92,v93
v_cvt_pk_bf16_f32 v58,v100,v101
v_cvt_pk_bf16_f32 v51,v86,v87
v_cvt_pk_bf16_f32 v53,v90,v91
v_cvt_pk_bf16_f32 v46,v76,v77
v_cvt_pk_bf16_f32 v52,v88,v89
v_cvt_pk_bf16_f32 v56,v96,v97
v_smfmac_f32_16x16x64_bf16 v[60:63],a[152:155],v[44:51],v18
v_subrev_u32 v10,18432,v10
v_smfmac_f32_16x16x64_bf16 v[64:67],a[152:155],v[52:59],v18
s_waitcnt lgkmcnt(0)
v_mfma_f32_16x16x32_bf16 v[160:163],a[136:139],v[44:47],v[160:163]
s_add_u32 s87,s42,18432
ds_read_b64_tr_b16 a[120:121],v2 offset:128
v_mbcnt_lo_u32_b32 v39,-1,0
v_mfma_f32_16x16x32_bf16 v[164:167],a[140:143],v[44:47],v[164:167]
ds_read_b64_tr_b16 a[122:123],v2 offset:6272
v_mbcnt_hi_u32_b32 v39,-1,v39
v_mfma_f32_16x16x32_bf16 v[212:215],a[140:143],v[48:51],v[212:215]
ds_read_b64_tr_b16 a[124:125],v3 offset:128
v_lshrrev_b32 v19,5,v39
v_mfma_f32_16x16x32_bf16 v[208:211],a[136:139],v[48:51],v[208:211]
ds_read_b64_tr_b16 a[126:127],v3 offset:6272
v_and_b32 v38,7,v39
v_mfma_f32_16x16x32_bf16 v[112:115],a[136:139],v[52:55],v[112:115]
ds_read_b64_tr_b16 a[128:129],v4 offset:128
v_xor_b32 v38,v38,v19
v_mfma_f32_16x16x32_bf16 v[116:119],a[140:143],v[52:55],v[116:119]
ds_read_b64_tr_b16 a[130:131],v4 offset:6272
v_and_b32 v19,15,v39
v_mfma_f32_16x16x32_bf16 a[164:167],a[140:143],v[56:59],a[164:167]
ds_read_b64_tr_b16 a[134:135],v5 offset:6272
v_lshl_add_u32 v19,v19,7,s24
v_mfma_f32_16x16x32_bf16 a[160:163],a[136:139],v[56:59],a[160:163]
ds_read_b64_tr_b16 a[132:133],v5 offset:128
v_lshl_add_u32 v19,v38,4,v19
v_mfma_f32_16x16x32_bf16 a[168:171],a[144:147],v[56:59],a[168:171]
ds_read_b64_tr_b16 a[136:137],v2 offset:256
v_bfe_u32 v38,v39,4,1
v_mfma_f32_16x16x32_bf16 a[172:175],a[148:151],v[56:59],a[172:175]
ds_read_b64_tr_b16 a[138:139],v2 offset:6400
v_lshl_add_u32 v36,v38,3,v19
v_mfma_f32_16x16x32_bf16 v[124:127],a[148:151],v[52:55],v[124:127]
ds_read_b64_tr_b16 a[142:143],v3 offset:6400
v_xor_b32 v38,64,v36
v_mfma_f32_16x16x32_bf16 v[120:123],a[144:147],v[52:55],v[120:123]
ds_read_b64_tr_b16 a[140:141],v3 offset:256
v_xor_b32 v37,32,v36
v_mfma_f32_16x16x32_bf16 v[216:219],a[144:147],v[48:51],v[216:219]
v_bfe_u32 v19,v39,3,1
v_xor_b32 v39,96,v36
v_mfma_f32_16x16x32_bf16 v[220:223],a[148:151],v[48:51],v[220:223]
v_lshlrev_b32 v19,11,v19
v_add_f32 v66,v66,v67
v_mfma_f32_16x16x32_bf16 v[172:175],a[148:151],v[44:47],v[172:175]
ds_read_b64_tr_b16 a[148:149],v5 offset:256
v_accvgpr_read_b32 v75,a163
v_mfma_f32_16x16x32_bf16 v[168:171],a[144:147],v[44:47],v[168:171]
s_waitcnt lgkmcnt(4)
ds_read_b64_tr_b16 a[150:151],v5 offset:6400
v_accvgpr_read_b32 v80,a164
v_mfma_f32_16x16x32_bf16 v[176:179],a[120:123],v[44:47],v[176:179]
ds_read_b64_tr_b16 a[144:145],v4 offset:256
v_accvgpr_read_b32 v81,a165
v_mfma_f32_16x16x32_bf16 v[180:183],a[124:127],v[44:47],v[180:183]
ds_read_b64_tr_b16 a[146:147],v4 offset:6400
v_accvgpr_read_b32 v72,a160
v_mfma_f32_16x16x32_bf16 v[228:231],a[124:127],v[48:51],v[228:231]
v_accvgpr_read_b32 v83,a167
v_rcp_f32 v66,v66
v_mfma_f32_16x16x32_bf16 v[224:227],a[120:123],v[48:51],v[224:227]
v_accvgpr_read_b32 v74,a162
v_accvgpr_read_b32 v73,a161
v_mfma_f32_16x16x32_bf16 v[128:131],a[120:123],v[52:55],v[128:131]
v_accvgpr_read_b32 v82,a166
v_accvgpr_read_b32 v89,a169
v_mfma_f32_16x16x32_bf16 v[132:135],a[124:127],v[52:55],v[132:135]
v_add_f32 v64,v64,v65
v_accvgpr_read_b32 v90,a170
v_mfma_f32_16x16x32_bf16 a[180:183],a[124:127],v[56:59],a[180:183]
v_accvgpr_read_b32 v88,a168
v_accvgpr_read_b32 v91,a171
v_mfma_f32_16x16x32_bf16 a[176:179],a[120:123],v[56:59],a[176:179]
v_rcp_f32 v64,v64
v_mfma_f32_16x16x32_bf16 a[184:187],a[128:131],v[56:59],a[184:187]
v_accvgpr_read_b32 v98,a174
v_accvgpr_read_b32 v97,a173
v_mfma_f32_16x16x32_bf16 a[188:191],a[132:135],v[56:59],a[188:191]
v_accvgpr_read_b32 v86,a182
v_accvgpr_read_b32 v84,a180
v_mfma_f32_16x16x32_bf16 v[140:143],a[132:135],v[52:55],v[140:143]
v_accvgpr_read_b32 v79,a179
v_accvgpr_read_b32 v78,a178
v_accvgpr_read_b32 v77,a177
v_accvgpr_read_b32 v87,a183
v_accvgpr_read_b32 v85,a181
v_pk_mul_f32 v[78:79],v[78:79],v[66:67] op_sel_hi:[1,0]
v_pk_mul_f32 v[86:87],v[86:87],v[66:67] op_sel_hi:[1,0]
v_pk_mul_f32 v[82:83],v[82:83],v[66:67] op_sel_hi:[1,0]
v_pk_mul_f32 v[80:81],v[80:81],v[66:67] op_sel_hi:[1,0]
v_pk_mul_f32 v[74:75],v[74:75],v[66:67] op_sel_hi:[1,0]
v_pk_mul_f32 v[72:73],v[72:73],v[66:67] op_sel_hi:[1,0]
v_pk_mul_f32 v[84:85],v[84:85],v[66:67] op_sel_hi:[1,0]
v_accvgpr_read_b32 v76,a176
v_pk_mul_f32 v[76:77],v[76:77],v[66:67] op_sel_hi:[1,0]
v_accvgpr_read_b32 v94,a186
v_accvgpr_read_b32 v95,a187
v_mfma_f32_16x16x32_bf16 v[136:139],a[128:131],v[52:55],v[136:139]
v_accvgpr_read_b32 v92,a184
v_accvgpr_read_b32 v93,a185
v_accvgpr_read_b32 v103,a191
v_accvgpr_read_b32 v102,a190
v_accvgpr_read_b32 v101,a189
v_pk_mul_f32 v[92:93],v[92:93],v[66:67] op_sel_hi:[1,0]
v_pk_mul_f32 v[88:89],v[88:89],v[66:67] op_sel_hi:[1,0]
v_pk_mul_f32 v[94:95],v[94:95],v[66:67] op_sel_hi:[1,0]
v_pk_mul_f32 v[90:91],v[90:91],v[66:67] op_sel_hi:[1,0]
v_accvgpr_read_b32 v100,a188
v_accvgpr_read_b32 v96,a172
v_mfma_f32_16x16x32_bf16 v[232:235],a[128:131],v[48:51],v[232:235]
v_accvgpr_read_b32 v99,a175
v_add_f32 v60,v60,v61
v_rcp_f32 v60,v60
v_add_f32 v62,v62,v63
v_pk_mul_f32 v[96:97],v[96:97],v[66:67] op_sel_hi:[1,0]
v_pk_mul_f32 v[98:99],v[98:99],v[66:67] op_sel_hi:[1,0]
v_pk_mul_f32 v[100:101],v[100:101],v[66:67] op_sel_hi:[1,0]
v_pk_mul_f32 v[116:117],v[116:117],v[64:65] op_sel_hi:[1,0]
v_pk_mul_f32 v[102:103],v[102:103],v[66:67] op_sel_hi:[1,0]
v_pk_mul_f32 v[118:119],v[118:119],v[64:65] op_sel_hi:[1,0]
v_pk_mul_f32 v[132:133],v[132:133],v[64:65] op_sel_hi:[1,0]
v_pk_mul_f32 v[114:115],v[114:115],v[64:65] op_sel_hi:[1,0]
v_pk_mul_f32 v[112:113],v[112:113],v[64:65] op_sel_hi:[1,0]
v_pk_mul_f32 v[134:135],v[134:135],v[64:65] op_sel_hi:[1,0]
v_pk_mul_f32 v[128:129],v[128:129],v[64:65] op_sel_hi:[1,0]
v_pk_mul_f32 v[130:131],v[130:131],v[64:65] op_sel_hi:[1,0]
v_rcp_f32 v62,v62
v_cvt_pk_bf16_f32 v84,v84,v85
v_mfma_f32_16x16x32_bf16 v[236:239],a[132:135],v[48:51],v[236:239]
v_min3_f32 v61,v60,v62,v64
v_min_f32 v61,v61,v66
v_mfma_f32_16x16x32_bf16 v[188:191],a[132:135],v[44:47],v[188:191]
v_cmp_nlt_f32 vcc,s37,v61
v_cvt_pk_bf16_f32 v85,v86,v87
v_cvt_pk_bf16_f32 v76,v76,v77
v_cvt_pk_bf16_f32 v77,v78,v79
v_cvt_pk_bf16_f32 v80,v80,v81
v_pk_mul_f32 v[122:123],v[122:123],v[64:65] op_sel_hi:[1,0]
v_pk_mul_f32 v[138:139],v[138:139],v[64:65] op_sel_hi:[1,0]
v_pk_mul_f32 v[120:121],v[120:121],v[64:65] op_sel_hi:[1,0]
v_pk_mul_f32 v[136:137],v[136:137],v[64:65] op_sel_hi:[1,0]
v_cvt_pk_bf16_f32 v88,v88,v89
v_cvt_pk_bf16_f32 v72,v72,v73
v_mfma_f32_16x16x32_bf16 v[184:187],a[128:131],v[44:47],v[184:187]
s_cmp_lg_u64 vcc,0
v_cvt_pk_bf16_f32 v89,v90,v91
v_cvt_pk_bf16_f32 v73,v74,v75
s_waitcnt lgkmcnt(0)
v_mfma_f32_16x16x32_bf16 v[192:195],a[136:139],v[44:47],v[192:195]
s_cselect_b32 s62,s32,0
ds_write2st64_b64 v36,v[72:73],v[76:77] offset0:36 offset1:40
v_mfma_f32_16x16x32_bf16 v[196:199],a[140:143],v[44:47],v[196:199]
s_or_b32 s31,s31,s62
v_add_u32 v36,v36,v19
v_cvt_pk_bf16_f32 v100,v100,v101
v_cvt_pk_bf16_f32 v81,v82,v83
v_cvt_pk_bf16_f32 v92,v92,v93
v_cvt_pk_bf16_f32 v93,v94,v95
v_pk_mul_f32 v[140:141],v[140:141],v[64:65] op_sel_hi:[1,0]
v_pk_mul_f32 v[124:125],v[124:125],v[64:65] op_sel_hi:[1,0]
v_pk_mul_f32 v[142:143],v[142:143],v[64:65] op_sel_hi:[1,0]
v_pk_mul_f32 v[126:127],v[126:127],v[64:65] op_sel_hi:[1,0]
v_cvt_pk_bf16_f32 v96,v96,v97
v_cvt_pk_bf16_f32 v101,v102,v103
v_mfma_f32_16x16x32_bf16 v[244:247],a[140:143],v[48:51],v[244:247]
s_lshl_b32 s32,s32,1
ds_write2st64_b64 v37,v[80:81],v[84:85] offset0:36 offset1:40
v_mfma_f32_16x16x32_bf16 v[240:243],a[136:139],v[48:51],v[240:243]
s_add_u32 m0,s24,6144
v_add_u32 v37,v37,v19
v_cvt_pk_bf16_f32 v97,v98,v99
v_mfma_f32_16x16x32_bf16 v[144:147],a[136:139],v[52:55],v[144:147]
buffer_load_dwordx4 v6,s[12:15],s28 offen offset:0 nt lds
v_mfma_f32_16x16x32_bf16 v[148:151],a[140:143],v[52:55],v[148:151]
buffer_load_dwordx4 v7,s[12:15],s28 offen offset:1024 nt lds
v_mfma_f32_16x16x32_bf16 a[196:199],a[140:143],v[56:59],a[196:199]
buffer_load_dwordx4 v8,s[12:15],s28 offen offset:2048 nt lds
v_mfma_f32_16x16x32_bf16 a[192:195],a[136:139],v[56:59],a[192:195]
s_add_u32 s28,s28,3072
ds_write2st64_b64 v38,v[88:89],v[92:93] offset0:36 offset1:40
v_mfma_f32_16x16x32_bf16 a[200:203],a[144:147],v[56:59],a[200:203]
s_add_u32 m0,s24,9216
v_add_u32 v38,v38,v19
v_cvt_pk_bf16_f32 v128,v128,v129
v_mfma_f32_16x16x32_bf16 a[204:207],a[148:151],v[56:59],a[204:207]
buffer_load_dwordx4 v6,s[12:15],s28 offen offset:0 nt lds
v_mfma_f32_16x16x32_bf16 v[156:159],a[148:151],v[52:55],v[156:159]
buffer_load_dwordx4 v7,s[12:15],s28 offen offset:1024 nt lds
buffer_load_dwordx4 v8,s[12:15],s28 offen offset:2048 nt lds
ds_write2st64_b64 v39,v[96:97],v[100:101] offset0:36 offset1:40
v_add_u32 v39,v39,v19
v_accvgpr_read_b32 v84,a196
v_accvgpr_read_b32 v83,a195
v_accvgpr_read_b32 v86,a198
v_accvgpr_read_b32 v82,a194
v_pk_mul_f32 v[82:83],v[82:83],v[66:67] op_sel_hi:[1,0]
ds_read_b128 v[104:107],v10 offset:18432
v_accvgpr_read_b32 v85,a197
v_pk_mul_f32 v[84:85],v[84:85],v[66:67] op_sel_hi:[1,0]
v_accvgpr_read_b32 v87,a199
v_pk_mul_f32 v[86:87],v[86:87],v[66:67] op_sel_hi:[1,0]
ds_read_b128 v[108:111],v10 offset:19456
v_accvgpr_read_b32 v81,a193
v_accvgpr_read_b32 v80,a192
v_pk_mul_f32 v[80:81],v[80:81],v[66:67] op_sel_hi:[1,0]
v_accvgpr_read_b32 v90,a202
v_accvgpr_read_b32 v88,a200
v_mfma_f32_16x16x32_bf16 v[152:155],a[144:147],v[52:55],v[152:155]
s_waitcnt vmcnt(21)
ds_read_b128 a[52:55],v12 offset:12288
v_accvgpr_read_b32 v89,a201
v_mfma_f32_16x16x32_bf16 v[248:251],a[144:147],v[48:51],v[248:251]
s_add_u32 s28,s28,3072
ds_read_b128 a[60:63],v12 offset:12416
v_accvgpr_read_b32 v91,a203
ds_read_b128 a[68:71],v12 offset:12544
v_pk_mul_f32 v[88:89],v[88:89],v[66:67] op_sel_hi:[1,0]
ds_read_b128 a[56:59],v11 offset:12416
v_pk_mul_f32 v[90:91],v[90:91],v[66:67] op_sel_hi:[1,0]
v_accvgpr_read_b32 v93,a205
v_accvgpr_read_b32 v92,a204
v_mfma_f32_16x16x32_bf16 v[252:255],a[148:151],v[48:51],v[252:255]
s_add_u32 m0,s23,0
ds_read_b128 a[48:51],v11 offset:12288
s_waitcnt lgkmcnt(6)
buffer_store_dwordx4 v[104:107],v9,s[16:19],s87 offen offset:0 nt
ds_read_b128 a[64:67],v11 offset:12544
v_accvgpr_read_b32 v94,a206
ds_read_b128 v[72:75],v10 offset:20480
v_mfma_f32_16x16x32_bf16 v[204:207],a[148:151],v[44:47],v[204:207]
v_accvgpr_read_b32 v95,a207
v_cvt_pk_bf16_f32 v112,v112,v113
v_mfma_f32_16x16x32_bf16 v[200:203],a[144:147],v[44:47],v[200:203]
s_waitcnt lgkmcnt(5)
ds_read_b128 v[76:79],v10 offset:21504
buffer_store_dwordx4 v[108:111],v9,s[16:19],s87 offen offset:3072 nt
v_cvt_pk_bf16_f32 v129,v130,v131
v_cvt_pk_bf16_f32 v113,v114,v115
v_cvt_pk_bf16_f32 v136,v136,v137
v_cvt_pk_bf16_f32 v132,v132,v133
v_cvt_pk_bf16_f32 v133,v134,v135
v_cvt_pk_bf16_f32 v116,v116,v117
v_cvt_pk_bf16_f32 v124,v124,v125
v_cvt_pk_bf16_f32 v120,v120,v121
v_cvt_pk_bf16_f32 v140,v140,v141
v_cvt_pk_bf16_f32 v121,v122,v123
v_cvt_pk_bf16_f32 v80,v80,v81
v_cvt_pk_bf16_f32 v117,v118,v119
ds_write2st64_b64 v36,v[112:113],v[128:129] offset0:24 offset1:26
v_sub_u32 v36,v36,v19
v_cvt_pk_bf16_f32 v125,v126,v127
v_cvt_pk_bf16_f32 v81,v82,v83
v_cvt_pk_bf16_f32 v137,v138,v139
v_cvt_pk_bf16_f32 v141,v142,v143
v_cvt_pk_bf16_f32 v84,v84,v85
s_waitcnt lgkmcnt(1)
buffer_store_dwordx4 v[72:75],v9,s[16:19],s87 offen offset:128 nt
v_cvt_pk_bf16_f32 v88,v88,v89
v_cvt_pk_bf16_f32 v85,v86,v87
v_cvt_pk_bf16_f32 v89,v90,v91
v_mov_b32 v61,0
v_mov_b32 v67,0
v_mov_b32 v65,0
v_mov_b32 v63,0
v_mov_b32 v71,0
v_mov_b32 v68,0
v_mov_b32 v69,0
v_mov_b32 v70,0
ds_write2st64_b64 v37,v[116:117],v[132:133] offset0:24 offset1:26
v_sub_u32 v37,v37,v19
buffer_store_dwordx4 v[76:79],v9,s[16:19],s87 offen offset:3200 nt
s_waitcnt vmcnt(10)
s_barrier
ds_write2st64_b64 v38,v[120:121],v[136:137] offset0:24 offset1:26
v_sub_u32 v38,v38,v19
ds_read_b128 a[120:123],v0 offset:0
ds_read_b128 a[124:127],v1 offset:0
ds_write2st64_b64 v39,v[124:125],v[140:141] offset0:24 offset1:26
v_sub_u32 v39,v39,v19
buffer_load_dwordx4 v6,s[8:11],s25 offen offset:0 lds
ds_read_b128 a[128:131],v0 offset:128
ds_read_b128 a[132:135],v1 offset:128
ds_write_b64 v36,v[80:81] offset:18432
s_waitcnt lgkmcnt(5)
v_mfma_f32_16x16x32_bf16 v[72:75],a[120:123],a[0:3],0
ds_read_b128 a[136:139],v0 offset:256
v_add_u32 v36,v36,v19
ds_read_b128 a[140:143],v1 offset:256
v_pk_mul_f32 v[94:95],v[94:95],v[66:67] op_sel_hi:[1,0]
ds_write_b64 v37,v[84:85] offset:18432
ds_read_b128 a[144:147],v0 offset:6144
buffer_load_dwordx4 v7,s[8:11],s25 offen offset:1024 lds
ds_write_b64 v38,v[88:89] offset:18432
ds_read_b128 a[148:151],v1 offset:6144
v_pk_mul_f32 v[92:93],v[92:93],v[66:67] op_sel_hi:[1,0]
v_add_u32 v37,v37,v19
v_add_u32 v38,v38,v19
s_waitcnt lgkmcnt(6)
v_mfma_f32_16x16x32_bf16 v[72:75],a[124:127],a[4:7],v[72:75]
v_cvt_pk_bf16_f32 v92,v92,v93
v_cvt_pk_bf16_f32 v93,v94,v95
v_mfma_f32_16x16x32_bf16 v[72:75],a[128:131],a[8:11],v[72:75]
ds_write_b64 v39,v[92:93] offset:18432
v_mfma_f32_16x16x32_bf16 v[72:75],a[132:135],a[12:15],v[72:75]
ds_read_b128 v[96:99],v10 offset:18432
v_add_u32 v39,v39,v19
v_mov_b32 v66,0
ds_read_b128 v[100:103],v10 offset:19456
buffer_load_dwordx4 v8,s[8:11],s25 offen offset:2048 lds
v_pk_mul_f32 v[162:163],v[162:163],v[60:61] op_sel_hi:[1,0]
v_pk_mul_f32 v[160:161],v[160:161],v[60:61] op_sel_hi:[1,0]
v_pk_mul_f32 v[144:145],v[144:145],v[64:65] op_sel_hi:[1,0]
v_pk_mul_f32 v[146:147],v[146:147],v[64:65] op_sel_hi:[1,0]
v_cvt_pk_bf16_f32 v160,v160,v161
v_cvt_pk_bf16_f32 v161,v162,v163
s_waitcnt lgkmcnt(3)
v_mfma_f32_16x16x32_bf16 v[72:75],a[136:139],a[16:19],v[72:75]
s_waitcnt vmcnt(16)
ds_read_b128 a[92:95],v12 offset:256
v_cvt_pk_bf16_f32 v144,v144,v145
v_mfma_f32_16x16x32_bf16 v[72:75],a[140:143],a[20:23],v[72:75]
s_mov_b32 s27,s42
ds_read_b128 a[88:91],v11 offset:256
v_cvt_pk_bf16_f32 v145,v146,v147
v_mfma_f32_16x16x32_bf16 v[80:83],a[140:143],a[44:47],0
s_mov_b32 s42,s41
ds_read_b128 a[84:87],v12 offset:128
s_add_u32 s69,s69,1
v_mfma_f32_16x16x32_bf16 v[80:83],a[136:139],a[40:43],v[80:83]
s_lshl_b32 s62,s69,5
ds_read_b128 a[80:83],v11 offset:128
s_waitcnt lgkmcnt(5)
buffer_store_dwordx4 v[96:99],v9,s[16:19],s87 offen offset:256 nt
ds_read_b128 a[76:79],v12 offset:0
v_pk_mul_f32 v[148:149],v[148:149],v[64:65] op_sel_hi:[1,0]
ds_read_b128 a[72:75],v11 offset:0
v_pk_mul_f32 v[166:167],v[166:167],v[60:61] op_sel_hi:[1,0]
v_pk_mul_f32 v[164:165],v[164:165],v[60:61] op_sel_hi:[1,0]
v_pk_mul_f32 v[150:151],v[150:151],v[64:65] op_sel_hi:[1,0]
v_max3_f32 v44,v72,v73,v74
v_cvt_pk_bf16_f32 v164,v164,v165
v_mfma_f32_16x16x32_bf16 v[80:83],a[132:135],a[36:39],v[80:83]
s_add_u32 s62,s62,s34
ds_write2st64_b64 v36,v[144:145],v[160:161] offset0:28 offset1:0
v_mfma_f32_16x16x32_bf16 v[80:83],a[128:131],a[32:35],v[80:83]
s_mul_i32 s63,s62,171
v_cvt_pk_bf16_f32 v165,v166,v167
v_cvt_pk_bf16_f32 v148,v148,v149
v_mfma_f32_16x16x32_bf16 v[80:83],a[124:127],a[28:31],v[80:83]
s_lshr_b32 s63,s63,9
v_cvt_pk_bf16_f32 v149,v150,v151
s_mul_i32 s64,s63,3
v_mfma_f32_16x16x32_bf16 v[80:83],a[120:123],a[24:27],v[80:83]
s_sub_u32 s62,s62,s64
s_waitcnt lgkmcnt(3)
buffer_store_dwordx4 v[100:103],v9,s[16:19],s87 offen offset:3328 nt
s_add_u32 s63,s63,s33
s_mul_i32 s30,s63,196608
v_pk_mul_f32 v[170:171],v[170:171],v[60:61] op_sel_hi:[1,0]
v_pk_mul_f32 v[168:169],v[168:169],v[60:61] op_sel_hi:[1,0]
v_pk_mul_f32 v[152:153],v[152:153],v[64:65] op_sel_hi:[1,0]
v_pk_mul_f32 v[154:155],v[154:155],v[64:65] op_sel_hi:[1,0]
v_max3_f32 v48,v80,v81,v82
v_cvt_pk_bf16_f32 v168,v168,v169
v_mfma_f32_16x16x32_bf16 v[88:91],a[120:123],a[48:51],0
s_mul_i32 s41,s63,325632
v_cvt_pk_bf16_f32 v169,v170,v171
v_cvt_pk_bf16_f32 v152,v152,v153
v_mfma_f32_16x16x32_bf16 v[88:91],a[124:127],a[52:55],v[88:91]
s_lshl_b32 s63,s3,2
ds_write2st64_b64 v37,v[148:149],v[164:165] offset0:28 offset1:0
v_mfma_f32_16x16x32_bf16 v[88:91],a[128:131],a[56:59],v[88:91]
s_add_u32 s64,s63,21
v_cvt_pk_bf16_f32 v153,v154,v155
s_cmp_eq_u32 s3,0
v_mfma_f32_16x16x32_bf16 v[88:91],a[132:135],a[60:63],v[88:91]
s_cselect_b32 s64,20,s64
s_cselect_b32 s40,1,0
s_add_u32 s65,s63,37
s_cmp_eq_u32 s62,2
s_cselect_b32 s64,s65,s64
s_cselect_b32 s40,0,s40
v_pk_mul_f32 v[156:157],v[156:157],v[64:65] op_sel_hi:[1,0]
v_pk_mul_f32 v[172:173],v[172:173],v[60:61] op_sel_hi:[1,0]
v_pk_mul_f32 v[158:159],v[158:159],v[64:65] op_sel_hi:[1,0]
ds_write2st64_b64 v38,v[152:153],v[168:169] offset0:28 offset1:0
v_pk_mul_f32 v[174:175],v[174:175],v[60:61] op_sel_hi:[1,0]
v_cvt_pk_bf16_f32 v172,v172,v173
v_cvt_pk_bf16_f32 v156,v156,v157
v_mfma_f32_16x16x32_bf16 v[88:91],a[136:139],a[64:67],v[88:91]
s_add_u32 s65,s63,s3
v_cvt_pk_bf16_f32 v157,v158,v159
v_cvt_pk_bf16_f32 v173,v174,v175
v_mfma_f32_16x16x32_bf16 v[88:91],a[140:143],a[68:71],v[88:91]
s_cmp_eq_u32 s62,0
v_mov_b32 v64,0
s_cselect_b32 s64,s65,s64
v_mfma_f32_16x16x32_bf16 v[96:99],a[140:143],a[92:95],0
s_waitcnt vmcnt(9)
ds_read_b128 a[96:99],v11 offset:6144
s_cselect_b32 s40,1,s40
ds_write2st64_b64 v39,v[156:157],v[172:173] offset0:28 offset1:0
v_pk_mul_f32 v[192:193],v[192:193],v[60:61] op_sel_hi:[1,0]
v_pk_mul_f32 v[194:195],v[194:195],v[60:61] op_sel_hi:[1,0]
v_pk_mul_f32 v[176:177],v[176:177],v[60:61] op_sel_hi:[1,0]
ds_read_b128 a[100:103],v12 offset:6144
v_pk_mul_f32 v[178:179],v[178:179],v[60:61] op_sel_hi:[1,0]
v_max3_f32 v52,v88,v89,v90
v_cvt_pk_bf16_f32 v192,v192,v193
v_mfma_f32_16x16x32_bf16 v[96:99],a[136:139],a[88:91],v[96:99]
s_mul_i32 s64,s64,6144
ds_read_b128 a[104:107],v11 offset:6272
v_cvt_pk_bf16_f32 v193,v194,v195
v_mfma_f32_16x16x32_bf16 v[96:99],a[132:135],a[84:87],v[96:99]
s_add_u32 s41,s41,s64
ds_read_b128 a[108:111],v12 offset:6272
v_cvt_pk_bf16_f32 v176,v176,v177
v_mfma_f32_16x16x32_bf16 v[96:99],a[128:131],a[80:83],v[96:99]
s_cmp_ge_u32 s69,6
ds_read_b128 a[112:115],v11 offset:6400
v_cvt_pk_bf16_f32 v177,v178,v179
s_waitcnt lgkmcnt(6)
v_mfma_f32_16x16x32_bf16 v[96:99],a[124:127],a[76:79],v[96:99]
s_cselect_b32 s41,166723584,s41
ds_read_b128 a[116:119],v12 offset:6400
s_cselect_b32 s30,100663296,s30
ds_write2st64_b64 v36,v[176:177],v[192:193] offset0:2 offset1:4
v_pk_mul_f32 v[182:183],v[182:183],v[60:61] op_sel_hi:[1,0]
v_pk_mul_f32 v[196:197],v[196:197],v[60:61] op_sel_hi:[1,0]
v_pk_mul_f32 v[198:199],v[198:199],v[60:61] op_sel_hi:[1,0]
v_pk_mul_f32 v[180:181],v[180:181],v[60:61] op_sel_hi:[1,0]
v_cvt_pk_bf16_f32 v196,v196,v197
v_cvt_pk_bf16_f32 v180,v180,v181
v_mfma_f32_16x16x32_bf16 v[96:99],a[120:123],a[72:75],v[96:99]
s_add_u32 s25,s30,s22
v_cvt_pk_bf16_f32 v197,v198,v199
v_cvt_pk_bf16_f32 v181,v182,v183
s_waitcnt lgkmcnt(4)
v_mfma_f32_16x16x32_bf16 v[104:107],a[120:123],a[96:99],0
s_add_u32 s26,s25,12288
ds_read_b128 a[120:123],v0 offset:6272
s_add_u32 m0,s23,24576
v_mfma_f32_16x16x32_bf16 v[104:107],a[124:127],a[100:103],v[104:107]
s_mov_b32 s28,s41
ds_write2st64_b64 v37,v[180:181],v[196:197] offset0:2 offset1:4
v_mfma_f32_16x16x32_bf16 v[104:107],a[128:131],a[104:107],v[104:107]
s_mov_b32 s29,s24
v_max3_f32 v56,v96,v97,v98
ds_read_b128 a[124:127],v1 offset:6272
v_pk_mul_f32 v[202:203],v[202:203],v[60:61] op_sel_hi:[1,0]
ds_read_b128 a[128:131],v0 offset:6400
v_pk_mul_f32 v[186:187],v[186:187],v[60:61] op_sel_hi:[1,0]
v_pk_mul_f32 v[200:201],v[200:201],v[60:61] op_sel_hi:[1,0]
v_pk_mul_f32 v[184:185],v[184:185],v[60:61] op_sel_hi:[1,0]
v_cvt_pk_bf16_f32 v200,v200,v201
v_cvt_pk_bf16_f32 v184,v184,v185
s_waitcnt lgkmcnt(4)
v_mfma_f32_16x16x32_bf16 v[104:107],a[132:135],a[108:111],v[104:107]
ds_read_b128 a[132:135],v1 offset:6400
v_cvt_pk_bf16_f32 v185,v186,v187
v_mfma_f32_16x16x32_bf16 v[104:107],a[136:139],a[112:115],v[104:107]
ds_read_b128 a[136:139],v0 offset:12288
v_cvt_pk_bf16_f32 v201,v202,v203
v_mfma_f32_16x16x32_bf16 v[104:107],a[140:143],a[116:119],v[104:107]
ds_read_b128 a[140:143],v1 offset:12288
ds_write2st64_b64 v38,v[184:185],v[200:201] offset0:2 offset1:4
v_pk_mul_f32 v[190:191],v[190:191],v[60:61] op_sel_hi:[1,0]
v_pk_mul_f32 v[206:207],v[206:207],v[60:61] op_sel_hi:[1,0]
v_pk_mul_f32 v[204:205],v[204:205],v[60:61] op_sel_hi:[1,0]
v_pk_mul_f32 v[188:189],v[188:189],v[60:61] op_sel_hi:[1,0]
v_cvt_pk_bf16_f32 v204,v204,v205
v_cvt_pk_bf16_f32 v188,v188,v189
v_mfma_f32_16x16x32_bf16 v[76:79],a[144:147],a[0:3],0
v_max3_f32 v40,v104,v105,v106
v_cvt_pk_bf16_f32 v205,v206,v207
v_mfma_f32_16x16x32_bf16 v[76:79],a[148:151],a[4:7],v[76:79]
buffer_load_dwordx4 v6,s[8:11],s21 offen offset:0 lds
s_waitcnt lgkmcnt(4)
v_mfma_f32_16x16x32_bf16 v[76:79],a[120:123],a[8:11],v[76:79]
v_cvt_pk_bf16_f32 v189,v190,v191
v_mov_b32 v60,0
v_mfma_f32_16x16x32_bf16 v[76:79],a[124:127],a[12:15],v[76:79]
ds_write2st64_b64 v39,v[188:189],v[204:205] offset0:2 offset1:4
v_pk_mul_f32 v[224:225],v[224:225],v[62:63] op_sel_hi:[1,0]
v_pk_mul_f32 v[208:209],v[208:209],v[62:63] op_sel_hi:[1,0]
v_pk_mul_f32 v[226:227],v[226:227],v[62:63] op_sel_hi:[1,0]
v_pk_mul_f32 v[210:211],v[210:211],v[62:63] op_sel_hi:[1,0]
v_cvt_pk_bf16_f32 v208,v208,v209
v_cvt_pk_bf16_f32 v224,v224,v225
v_mfma_f32_16x16x32_bf16 v[76:79],a[128:131],a[16:19],v[76:79]
s_waitcnt lgkmcnt(1)
v_cvt_pk_bf16_f32 v209,v210,v211
v_cvt_pk_bf16_f32 v225,v226,v227
v_mfma_f32_16x16x32_bf16 v[76:79],a[132:135],a[20:23],v[76:79]
ds_write2st64_b64 v36,v[208:209],v[224:225] offset0:12 offset1:14
v_mfma_f32_16x16x32_bf16 v[84:87],a[132:135],a[44:47],0
v_mfma_f32_16x16x32_bf16 v[84:87],a[128:131],a[40:43],v[84:87]
buffer_load_dwordx4 v7,s[8:11],s21 offen offset:1024 lds
v_pk_mul_f32 v[228:229],v[228:229],v[62:63] op_sel_hi:[1,0]
v_pk_mul_f32 v[212:213],v[212:213],v[62:63] op_sel_hi:[1,0]
v_pk_mul_f32 v[230:231],v[230:231],v[62:63] op_sel_hi:[1,0]
v_pk_mul_f32 v[214:215],v[214:215],v[62:63] op_sel_hi:[1,0]
v_max3_f32 v44,v44,v75,v76
v_max3_f32 v44,v44,v77,v78
v_mfma_f32_16x16x32_bf16 v[84:87],a[124:127],a[36:39],v[84:87]
v_max_f32 v44,v44,v79
v_mov_b32 v45,v44
v_mfma_f32_16x16x32_bf16 v[84:87],a[120:123],a[32:35],v[84:87]
v_cvt_pk_bf16_f32 v228,v228,v229
v_permlane32_swap_b32 v45,v44
v_mfma_f32_16x16x32_bf16 v[84:87],a[148:151],a[28:31],v[84:87]
v_max_f32 v44,v44,v45
v_mov_b32 v45,v44
v_cvt_pk_bf16_f32 v229,v230,v231
v_cvt_pk_bf16_f32 v212,v212,v213
v_permlane16_swap_b32 v45,v44
buffer_load_dwordx4 v8,s[8:11],s21 offen offset:2048 lds
v_pk_mul_f32 v[234:235],v[234:235],v[62:63] op_sel_hi:[1,0]
v_pk_mul_f32 v[232:233],v[232:233],v[62:63] op_sel_hi:[1,0]
v_pk_mul_f32 v[216:217],v[216:217],v[62:63] op_sel_hi:[1,0]
v_pk_mul_f32 v[218:219],v[218:219],v[62:63] op_sel_hi:[1,0]
v_max_f32 v44,v44,v45
v_mul_f32_e64 v13,-s36,v44
v_mfma_f32_16x16x32_bf16 v[84:87],a[144:147],a[24:27],v[84:87]
s_add_u32 s21,s21,12288
v_fma_f32 v72,v72,s36,v13
v_fma_f32 v74,v74,s36,v13
v_mfma_f32_16x16x32_bf16 v[92:95],a[144:147],a[48:51],0
s_add_u32 m0,s22,0
v_fma_f32 v75,v75,s36,v13
v_exp_f32 v75,v75
v_mfma_f32_16x16x32_bf16 v[92:95],a[148:151],a[52:55],v[92:95]
v_exp_f32 v72,v72
v_mfma_f32_16x16x32_bf16 v[92:95],a[120:123],a[56:59],v[92:95]
v_fma_f32 v73,v73,s36,v13
v_exp_f32 v73,v73
v_exp_f32 v74,v74
v_pk_mul_f32 v[238:239],v[238:239],v[62:63] op_sel_hi:[1,0]
v_pk_mul_f32 v[220:221],v[220:221],v[62:63] op_sel_hi:[1,0]
v_pk_mul_f32 v[236:237],v[236:237],v[62:63] op_sel_hi:[1,0]
v_pk_mul_f32 v[222:223],v[222:223],v[62:63] op_sel_hi:[1,0]
v_cvt_pk_bf16_f32 v21,v74,v75
v_cvt_pk_bf16_f32 v20,v72,v73
v_mfma_f32_16x16x32_bf16 v[92:95],a[124:127],a[60:63],v[92:95]
v_max3_f32 v48,v48,v83,v84
v_max3_f32 v48,v48,v85,v86
v_mfma_f32_16x16x32_bf16 v[92:95],a[128:131],a[64:67],v[92:95]
v_max_f32 v48,v48,v87
v_mov_b32 v49,v48
v_mfma_f32_16x16x32_bf16 v[92:95],a[132:135],a[68:71],v[92:95]
v_cvt_pk_bf16_f32 v232,v232,v233
v_permlane32_swap_b32 v49,v48
v_mfma_f32_16x16x32_bf16 v[100:103],a[132:135],a[92:95],0
v_max_f32 v48,v48,v49
v_mov_b32 v49,v48
v_cvt_pk_bf16_f32 v220,v220,v221
v_cvt_pk_bf16_f32 v233,v234,v235
v_permlane16_swap_b32 v49,v48
v_pk_mul_f32 v[240:241],v[240:241],v[62:63] op_sel_hi:[1,0]
v_pk_mul_f32 v[242:243],v[242:243],v[62:63] op_sel_hi:[1,0]
v_max_f32 v48,v48,v49
v_mul_f32_e64 v14,-s36,v48
v_mfma_f32_16x16x32_bf16 v[100:103],a[128:131],a[88:91],v[100:103]
v_fma_f32 v81,v81,s36,v14
v_fma_f32 v82,v82,s36,v14
v_mfma_f32_16x16x32_bf16 v[100:103],a[124:127],a[84:87],v[100:103]
v_exp_f32 v81,v81
v_mfma_f32_16x16x32_bf16 v[100:103],a[120:123],a[80:83],v[100:103]
v_fma_f32 v83,v83,s36,v14
v_exp_f32 v83,v83
v_mfma_f32_16x16x32_bf16 v[100:103],a[148:151],a[76:79],v[100:103]
v_fma_f32 v80,v80,s36,v14
v_exp_f32 v80,v80
v_exp_f32 v82,v82
v_pk_mul_f32 v[244:245],v[244:245],v[62:63] op_sel_hi:[1,0]
v_pk_mul_f32 v[246:247],v[246:247],v[62:63] op_sel_hi:[1,0]
v_cvt_pk_bf16_f32 v25,v82,v83
v_cvt_pk_bf16_f32 v24,v80,v81
v_mfma_f32_16x16x32_bf16 v[100:103],a[144:147],a[72:75],v[100:103]
v_max3_f32 v52,v52,v91,v92
v_max3_f32 v52,v52,v93,v94
v_mfma_f32_16x16x32_bf16 v[108:111],a[144:147],a[96:99],0
ds_read_b128 a[144:147],v0 offset:12416
v_max_f32 v52,v52,v95
v_mfma_f32_16x16x32_bf16 v[108:111],a[148:151],a[100:103],v[108:111]
ds_read_b128 a[148:151],v1 offset:12416
v_mov_b32 v53,v52
v_max3_f32 v56,v56,v99,v100
v_max3_f32 v56,v56,v101,v102
v_permlane32_swap_b32 v53,v52
v_pk_mul_f32 v[250:251],v[250:251],v[62:63] op_sel_hi:[1,0]
v_pk_mul_f32 v[248:249],v[248:249],v[62:63] op_sel_hi:[1,0]
v_max_f32 v52,v52,v53
v_mov_b32 v53,v52
v_mfma_f32_16x16x32_bf16 v[108:111],a[120:123],a[104:107],v[108:111]
ds_read_b128 a[120:123],v0 offset:12544
v_permlane16_swap_b32 v53,v52
v_mfma_f32_16x16x32_bf16 v[108:111],a[124:127],a[108:111],v[108:111]
ds_read_b128 a[124:127],v1 offset:12544
v_max_f32 v52,v52,v53
v_mfma_f32_16x16x32_bf16 v[108:111],a[128:131],a[112:115],v[108:111]
ds_read_b128 a[128:131],v0 offset:18432
v_mul_f32_e64 v15,-s36,v52
v_mfma_f32_16x16x32_bf16 v[108:111],a[132:135],a[116:119],v[108:111]
ds_read_b128 a[132:135],v1 offset:18432
v_fma_f32 v88,v88,s36,v15
v_fma_f32 v91,v91,s36,v15
v_fma_f32 v90,v90,s36,v15
v_fma_f32 v89,v89,s36,v15
v_pk_mul_f32 v[252:253],v[252:253],v[62:63] op_sel_hi:[1,0]
v_pk_mul_f32 v[254:255],v[254:255],v[62:63] op_sel_hi:[1,0]
v_exp_f32 v89,v89
v_exp_f32 v90,v90
v_mfma_f32_16x16x32_bf16 v[72:75],a[136:139],a[0:3],0
v_exp_f32 v91,v91
v_mfma_f32_16x16x32_bf16 v[72:75],a[140:143],a[4:7],v[72:75]
s_waitcnt lgkmcnt(3)
v_exp_f32 v88,v88
v_mfma_f32_16x16x32_bf16 v[72:75],a[144:147],a[8:11],v[72:75]
v_cvt_pk_bf16_f32 v28,v88,v89
v_cvt_pk_bf16_f32 v29,v90,v91
v_mfma_f32_16x16x32_bf16 v[72:75],a[148:151],a[12:15],v[72:75]
v_max_f32 v56,v56,v103
v_mov_b32 v57,v56
v_mfma_f32_16x16x32_bf16 v[72:75],a[120:123],a[16:19],v[72:75]
s_waitcnt lgkmcnt(0)
v_max3_f32 v40,v40,v107,v108
v_permlane32_swap_b32 v57,v56
v_mfma_f32_16x16x32_bf16 v[72:75],a[124:127],a[20:23],v[72:75]
v_max_f32 v56,v56,v57
v_mov_b32 v57,v56
v_mfma_f32_16x16x32_bf16 v[80:83],a[124:127],a[44:47],0
v_max3_f32 v40,v40,v109,v110
v_permlane16_swap_b32 v57,v56
v_mfma_f32_16x16x32_bf16 v[80:83],a[120:123],a[40:43],v[80:83]
v_max_f32 v56,v56,v57
v_mul_f32_e64 v16,-s36,v56
v_mfma_f32_16x16x32_bf16 v[80:83],a[148:151],a[36:39],v[80:83]
v_fma_f32 v97,v97,s36,v16
v_fma_f32 v96,v96,s36,v16
v_mfma_f32_16x16x32_bf16 v[80:83],a[144:147],a[32:35],v[80:83]
v_exp_f32 v97,v97
v_mfma_f32_16x16x32_bf16 v[80:83],a[140:143],a[28:31],v[80:83]
v_exp_f32 v96,v96
v_mfma_f32_16x16x32_bf16 v[80:83],a[136:139],a[24:27],v[80:83]
v_fma_f32 v98,v98,s36,v16
v_fma_f32 v99,v99,s36,v16
v_mfma_f32_16x16x32_bf16 v[88:91],a[136:139],a[48:51],0
v_exp_f32 v99,v99
v_mfma_f32_16x16x32_bf16 v[88:91],a[140:143],a[52:55],v[88:91]
v_exp_f32 v98,v98
v_mfma_f32_16x16x32_bf16 v[88:91],a[144:147],a[56:59],v[88:91]
v_cvt_pk_bf16_f32 v32,v96,v97
v_cvt_pk_bf16_f32 v33,v98,v99
v_mfma_f32_16x16x32_bf16 v[88:91],a[148:151],a[60:63],v[88:91]
v_max_f32 v40,v40,v111
v_mov_b32 v41,v40
v_mfma_f32_16x16x32_bf16 v[88:91],a[120:123],a[64:67],v[88:91]
v_cvt_pk_bf16_f32 v213,v214,v215
v_permlane32_swap_b32 v41,v40
v_mfma_f32_16x16x32_bf16 v[88:91],a[124:127],a[68:71],v[88:91]
ds_write2st64_b64 v37,v[212:213],v[228:229] offset0:12 offset1:14
v_mfma_f32_16x16x32_bf16 v[96:99],a[124:127],a[92:95],0
v_max_f32 v40,v40,v41
v_mov_b32 v41,v40
v_mfma_f32_16x16x32_bf16 v[96:99],a[120:123],a[88:91],v[96:99]
v_cvt_pk_bf16_f32 v221,v222,v223
v_permlane16_swap_b32 v41,v40
v_mfma_f32_16x16x32_bf16 v[96:99],a[148:151],a[84:87],v[96:99]
v_max_f32 v40,v40,v41
v_mul_f32_e64 v17,-s36,v40
v_mfma_f32_16x16x32_bf16 v[96:99],a[144:147],a[80:83],v[96:99]
v_fma_f32 v104,v104,s36,v17
v_cvt_pk_bf16_f32 v240,v240,v241
v_mfma_f32_16x16x32_bf16 v[96:99],a[140:143],a[76:79],v[96:99]
v_cvt_pk_bf16_f32 v216,v216,v217
v_cvt_pk_bf16_f32 v236,v236,v237
v_mfma_f32_16x16x32_bf16 v[96:99],a[136:139],a[72:75],v[96:99]
v_cvt_pk_bf16_f32 v237,v238,v239
v_fma_f32 v106,v106,s36,v17
v_exp_f32 v106,v106
v_cvt_pk_bf16_f32 v217,v218,v219
v_cvt_pk_bf16_f32 v244,v244,v245
v_exp_f32 v104,v104
ds_write2st64_b64 v38,v[216:217],v[232:233] offset0:12 offset1:14
v_cvt_pk_bf16_f32 v241,v242,v243
v_fma_f32 v105,v105,s36,v17
v_exp_f32 v105,v105
v_fma_f32 v107,v107,s36,v17
v_cvt_pk_bf16_f32 v245,v246,v247
v_exp_f32 v107,v107
v_fma_f32 v76,v76,s36,v13
v_fma_f32 v79,v79,s36,v13
v_exp_f32 v76,v76
v_exp_f32 v79,v79
v_fma_f32 v77,v77,s36,v13
ds_write2st64_b64 v39,v[220:221],v[236:237] offset0:12 offset1:14
v_exp_f32 v77,v77
v_fma_f32 v78,v78,s36,v13
v_exp_f32 v78,v78
v_cvt_pk_bf16_f32 v22,v76,v77
v_cvt_pk_bf16_f32 v23,v78,v79
v_fma_f32 v84,v84,s36,v14
v_exp_f32 v84,v84
v_fma_f32 v86,v86,s36,v14
v_fma_f32 v85,v85,s36,v14
v_exp_f32 v85,v85
ds_write_b64 v36,v[240:241] offset:8192
v_cvt_pk_bf16_f32 v36,v104,v105
v_exp_f32 v86,v86
v_fma_f32 v87,v87,s36,v14
v_exp_f32 v87,v87
v_cvt_pk_bf16_f32 v26,v84,v85
ds_write_b64 v37,v[244:245] offset:8192
v_cvt_pk_bf16_f32 v37,v106,v107
v_mfma_f32_16x16x32_bf16 v[104:107],a[136:139],a[96:99],0
ds_read_b128 a[136:139],v0 offset:18560
v_cvt_pk_bf16_f32 v27,v86,v87
v_mfma_f32_16x16x32_bf16 v[104:107],a[140:143],a[100:103],v[104:107]
s_waitcnt vmcnt(5)
s_barrier
v_mfma_f32_16x16x32_bf16 v[104:107],a[144:147],a[104:107],v[104:107]
ds_read_b128 a[140:143],v1 offset:18560
buffer_load_dwordx4 v6,s[4:7],s20 offen offset:0 lds
v_mfma_f32_16x16x32_bf16 v[104:107],a[148:151],a[108:111],v[104:107]
ds_read_b128 a[144:147],v0 offset:18688
v_fma_f32 v92,v92,s36,v15
v_mfma_f32_16x16x32_bf16 v[104:107],a[120:123],a[112:115],v[104:107]
ds_read_b128 a[148:151],v1 offset:18688
v_fma_f32 v93,v93,s36,v15
v_mfma_f32_16x16x32_bf16 v[104:107],a[124:127],a[116:119],v[104:107]
v_exp_f32 v92,v92
v_mfma_f32_16x16x32_bf16 v[76:79],a[128:131],a[0:3],0
v_fma_f32 v94,v94,s36,v15
v_fma_f32 v95,v95,s36,v15
v_mfma_f32_16x16x32_bf16 v[76:79],a[132:135],a[4:7],v[76:79]
s_waitcnt lgkmcnt(3)
v_exp_f32 v95,v95
v_mfma_f32_16x16x32_bf16 v[76:79],a[136:139],a[8:11],v[76:79]
buffer_load_dwordx4 v7,s[4:7],s20 offen offset:1024 lds
v_exp_f32 v93,v93
s_waitcnt lgkmcnt(2)
v_mfma_f32_16x16x32_bf16 v[76:79],a[140:143],a[12:15],v[76:79]
s_waitcnt lgkmcnt(1)
v_exp_f32 v94,v94
v_cvt_pk_bf16_f32 v30,v92,v93
v_mfma_f32_16x16x32_bf16 v[76:79],a[144:147],a[16:19],v[76:79]
s_waitcnt lgkmcnt(0)
v_cvt_pk_bf16_f32 v31,v94,v95
v_fma_f32 v101,v101,s36,v16
v_mfma_f32_16x16x32_bf16 v[76:79],a[148:151],a[20:23],v[76:79]
ds_read_b64_tr_b16 a[122:123],v2 offset:6144
v_fma_f32 v103,v103,s36,v16
v_mfma_f32_16x16x32_bf16 v[84:87],a[148:151],a[44:47],0
ds_read_b64_tr_b16 a[120:121],v2 offset:0
v_exp_f32 v103,v103
v_mfma_f32_16x16x32_bf16 v[84:87],a[144:147],a[40:43],v[84:87]
buffer_load_dwordx4 v8,s[4:7],s20 offen offset:2048 lds
v_mfma_f32_16x16x32_bf16 v[84:87],a[140:143],a[36:39],v[84:87]
s_add_u32 s20,s20,12288
ds_read_b64_tr_b16 a[124:125],v3 offset:0
v_fma_f32 v100,v100,s36,v16
v_mfma_f32_16x16x32_bf16 v[84:87],a[136:139],a[32:35],v[84:87]
ds_read_b64_tr_b16 a[126:127],v3 offset:6144
v_exp_f32 v101,v101
v_mfma_f32_16x16x32_bf16 v[84:87],a[132:135],a[28:31],v[84:87]
v_fma_f32 v102,v102,s36,v16
v_exp_f32 v102,v102
v_mfma_f32_16x16x32_bf16 v[84:87],a[128:131],a[24:27],v[84:87]
v_exp_f32 v100,v100
v_mfma_f32_16x16x32_bf16 v[92:95],a[128:131],a[48:51],0
v_cvt_pk_bf16_f32 v35,v102,v103
v_cvt_pk_bf16_f32 v34,v100,v101
v_mfma_f32_16x16x32_bf16 v[92:95],a[132:135],a[52:55],v[92:95]
v_fma_f32 v111,v111,s36,v17
v_fma_f32 v109,v109,s36,v17
v_smfmac_f32_16x16x64_bf16 v[64:67],a[152:155],v[28:35],v18
v_cvt_pk_bf16_f32 v248,v248,v249
v_mfma_f32_16x16x32_bf16 v[92:95],a[136:139],a[56:59],v[92:95]
v_exp_f32 v111,v111
v_mfma_f32_16x16x32_bf16 v[92:95],a[140:143],a[60:63],v[92:95]
v_fma_f32 v108,v108,s36,v17
v_fma_f32 v110,v110,s36,v17
v_mfma_f32_16x16x32_bf16 v[92:95],a[144:147],a[64:67],v[92:95]
v_exp_f32 v110,v110
v_mfma_f32_16x16x32_bf16 v[92:95],a[148:151],a[68:71],v[92:95]
v_cvt_pk_bf16_f32 v252,v252,v253
v_cvt_pk_bf16_f32 v249,v250,v251
v_mfma_f32_16x16x32_bf16 v[100:103],a[148:151],a[92:95],0
ds_write_b64 v38,v[248:249] offset:8192
v_mfma_f32_16x16x32_bf16 v[100:103],a[144:147],a[88:91],v[100:103]
v_exp_f32 v109,v109
v_mfma_f32_16x16x32_bf16 v[100:103],a[140:143],a[84:87],v[100:103]
v_cvt_pk_bf16_f32 v253,v254,v255
v_exp_f32 v108,v108
v_mfma_f32_16x16x32_bf16 v[100:103],a[136:139],a[80:83],v[100:103]
ds_write_b64 v39,v[252:253] offset:8192
v_mfma_f32_16x16x32_bf16 v[100:103],a[132:135],a[76:79],v[100:103]
v_cvt_pk_bf16_f32 v39,v110,v111
v_cvt_pk_bf16_f32 v38,v108,v109
v_mfma_f32_16x16x32_bf16 v[100:103],a[128:131],a[72:75],v[100:103]
v_fma_f32 v83,v83,s36,v14
v_fma_f32 v89,v89,s36,v15
v_mfma_f32_16x16x32_bf16 v[108:111],a[128:131],a[96:99],0
ds_read_b64_tr_b16 a[130:131],v4 offset:6144
v_fma_f32 v81,v81,s36,v14
v_mfma_f32_16x16x32_bf16 v[108:111],a[132:135],a[100:103],v[108:111]
ds_read_b64_tr_b16 a[128:129],v4 offset:0
v_mov_b32 v62,0
v_mfma_f32_16x16x32_bf16 v[108:111],a[136:139],a[104:107],v[108:111]
ds_read_b64_tr_b16 a[134:135],v5 offset:6144
v_fma_f32 v88,v88,s36,v15
v_smfmac_f32_16x16x64_bf16 v[60:63],a[152:155],v[20:27],v18
ds_read_b64_tr_b16 a[132:133],v5 offset:0
v_mfma_f32_16x16x32_bf16 v[108:111],a[140:143],a[108:111],v[108:111]
v_fma_f32 v82,v82,s36,v14
v_fma_f32 v72,v72,s36,v13
v_mfma_f32_16x16x32_bf16 v[108:111],a[144:147],a[112:115],v[108:111]
v_exp_f32 v72,v72
v_mfma_f32_16x16x32_bf16 v[108:111],a[148:151],a[116:119],v[108:111]
v_exp_f32 v82,v82
v_fma_f32 v80,v80,s36,v14
v_exp_f32 v80,v80
v_fma_f32 v74,v74,s36,v13
v_exp_f32 v74,v74
v_exp_f32 v83,v83
v_fma_f32 v73,v73,s36,v13
v_exp_f32 v73,v73
v_fma_f32 v75,v75,s36,v13
v_exp_f32 v75,v75
v_exp_f32 v88,v88
v_exp_f32 v81,v81
v_exp_f32 v89,v89
v_cvt_pk_bf16_f32 v48,v80,v81
v_cvt_pk_bf16_f32 v44,v72,v73
v_cvt_pk_bf16_f32 v52,v88,v89
v_cvt_pk_bf16_f32 v49,v82,v83
v_cvt_pk_bf16_f32 v45,v74,v75
s_waitcnt lgkmcnt(0)
v_mfma_f32_16x16x32_bf16 v[160:163],a[120:123],v[20:23],0
s_add_u32 m0,s23,0
ds_read_b64_tr_b16 a[136:137],v2 offset:128
v_fma_f32 v90,v90,s36,v15
v_mfma_f32_16x16x32_bf16 v[164:167],a[124:127],v[20:23],0
ds_read_b64_tr_b16 a[138:139],v2 offset:6272
v_fma_f32 v91,v91,s36,v15
v_mfma_f32_16x16x32_bf16 v[212:215],a[124:127],v[24:27],0
ds_read_b64_tr_b16 a[140:141],v3 offset:128
v_fma_f32 v96,v96,s36,v16
v_mfma_f32_16x16x32_bf16 v[208:211],a[120:123],v[24:27],0
ds_read_b64_tr_b16 a[142:143],v3 offset:6272
v_fma_f32 v97,v97,s36,v16
v_mfma_f32_16x16x32_bf16 v[112:115],a[120:123],v[28:31],0
ds_read_b64_tr_b16 a[144:145],v4 offset:128
v_fma_f32 v98,v98,s36,v16
v_mfma_f32_16x16x32_bf16 v[116:119],a[124:127],v[28:31],0
ds_read_b64_tr_b16 a[146:147],v4 offset:6272
v_fma_f32 v99,v99,s36,v16
v_mfma_f32_16x16x32_bf16 a[164:167],a[124:127],v[32:35],0
ds_read_b64_tr_b16 a[148:149],v5 offset:128
v_fma_f32 v104,v104,s36,v17
v_mfma_f32_16x16x32_bf16 a[160:163],a[120:123],v[32:35],0
ds_read_b64_tr_b16 a[150:151],v5 offset:6272
v_fma_f32 v105,v105,s36,v17
v_mfma_f32_16x16x32_bf16 a[208:211],a[120:123],v[36:39],0
ds_read_b64_tr_b16 a[120:121],v2 offset:256
v_fma_f32 v106,v106,s36,v17
v_mfma_f32_16x16x32_bf16 a[212:215],a[124:127],v[36:39],0
ds_read_b64_tr_b16 a[122:123],v2 offset:6400
v_fma_f32 v107,v107,s36,v17
v_mfma_f32_16x16x32_bf16 a[216:219],a[128:131],v[36:39],0
ds_read_b64_tr_b16 a[124:125],v3 offset:256
v_fma_f32 v76,v76,s36,v13
v_mfma_f32_16x16x32_bf16 a[220:223],a[132:135],v[36:39],0
ds_read_b64_tr_b16 a[126:127],v3 offset:6400
v_fma_f32 v77,v77,s36,v13
v_mfma_f32_16x16x32_bf16 a[172:175],a[132:135],v[32:35],0
v_exp_f32 v90,v90
v_mfma_f32_16x16x32_bf16 a[168:171],a[128:131],v[32:35],0
v_exp_f32 v91,v91
v_mfma_f32_16x16x32_bf16 v[120:123],a[128:131],v[28:31],0
v_cvt_pk_bf16_f32 v53,v90,v91
v_fma_f32 v78,v78,s36,v13
v_mfma_f32_16x16x32_bf16 v[124:127],a[132:135],v[28:31],0
v_exp_f32 v96,v96
v_mfma_f32_16x16x32_bf16 v[220:223],a[132:135],v[24:27],0
v_exp_f32 v97,v97
v_mfma_f32_16x16x32_bf16 v[216:219],a[128:131],v[24:27],0
v_exp_f32 v98,v98
v_mfma_f32_16x16x32_bf16 v[168:171],a[128:131],v[20:23],0
ds_read_b64_tr_b16 a[128:129],v4 offset:256
v_cvt_pk_bf16_f32 v56,v96,v97
v_mfma_f32_16x16x32_bf16 v[172:175],a[132:135],v[20:23],0
s_waitcnt lgkmcnt(1)
ds_read_b64_tr_b16 a[130:131],v4 offset:6400
v_fma_f32 v79,v79,s36,v13
v_mfma_f32_16x16x32_bf16 v[176:179],a[136:139],v[20:23],0
ds_read_b64_tr_b16 a[132:133],v5 offset:256
v_fma_f32 v84,v84,s36,v14
v_mfma_f32_16x16x32_bf16 v[180:183],a[140:143],v[20:23],0
ds_read_b64_tr_b16 a[134:135],v5 offset:6400
v_fma_f32 v85,v85,s36,v14
v_mfma_f32_16x16x32_bf16 v[228:231],a[140:143],v[24:27],0
v_exp_f32 v99,v99
v_mfma_f32_16x16x32_bf16 v[224:227],a[136:139],v[24:27],0
v_cvt_pk_bf16_f32 v57,v98,v99
v_fma_f32 v86,v86,s36,v14
v_mfma_f32_16x16x32_bf16 v[128:131],a[136:139],v[28:31],0
v_exp_f32 v104,v104
v_mfma_f32_16x16x32_bf16 v[132:135],a[140:143],v[28:31],0
v_exp_f32 v105,v105
v_mfma_f32_16x16x32_bf16 a[180:183],a[140:143],v[32:35],0
v_exp_f32 v106,v106
v_mfma_f32_16x16x32_bf16 a[176:179],a[136:139],v[32:35],0
v_exp_f32 v107,v107
v_mfma_f32_16x16x32_bf16 a[224:227],a[136:139],v[36:39],0
v_cvt_pk_bf16_f32 v40,v104,v105
v_cvt_pk_bf16_f32 v41,v106,v107
v_mfma_f32_16x16x32_bf16 a[228:231],a[140:143],v[36:39],0
v_exp_f32 v76,v76
v_mfma_f32_16x16x32_bf16 a[232:235],a[144:147],v[36:39],0
v_exp_f32 v77,v77
v_mfma_f32_16x16x32_bf16 a[236:239],a[148:151],v[36:39],0
v_exp_f32 v78,v78
v_mfma_f32_16x16x32_bf16 a[188:191],a[148:151],v[32:35],0
v_exp_f32 v79,v79
v_mfma_f32_16x16x32_bf16 a[184:187],a[144:147],v[32:35],0
v_cvt_pk_bf16_f32 v46,v76,v77
v_cvt_pk_bf16_f32 v47,v78,v79
v_mfma_f32_16x16x32_bf16 v[136:139],a[144:147],v[28:31],0
v_fma_f32 v87,v87,s36,v14
v_fma_f32 v92,v92,s36,v15
v_mfma_f32_16x16x32_bf16 v[140:143],a[148:151],v[28:31],0
v_exp_f32 v84,v84
v_mfma_f32_16x16x32_bf16 v[236:239],a[148:151],v[24:27],0
v_exp_f32 v85,v85
v_mfma_f32_16x16x32_bf16 v[232:235],a[144:147],v[24:27],0
v_exp_f32 v86,v86
v_mfma_f32_16x16x32_bf16 v[184:187],a[144:147],v[20:23],0
v_exp_f32 v87,v87
v_mfma_f32_16x16x32_bf16 v[188:191],a[148:151],v[20:23],0
v_cvt_pk_bf16_f32 v50,v84,v85
v_cvt_pk_bf16_f32 v51,v86,v87
v_mfma_f32_16x16x32_bf16 v[192:195],a[120:123],v[20:23],0
s_waitcnt vmcnt(30) lgkmcnt(0)
v_fma_f32 v93,v93,s36,v15
v_fma_f32 v94,v94,s36,v15
v_smfmac_f32_16x16x64_bf16 v[60:63],a[152:155],v[44:51],v18
s_barrier
v_mfma_f32_16x16x32_bf16 v[196:199],a[124:127],v[20:23],0
ds_read_b128 a[136:139],v0 offset:24576
v_fma_f32 v95,v95,s36,v15
v_mfma_f32_16x16x32_bf16 v[244:247],a[124:127],v[24:27],0
ds_read_b128 a[140:143],v1 offset:24576
v_fma_f32 v100,v100,s36,v16
v_mfma_f32_16x16x32_bf16 v[240:243],a[120:123],v[24:27],0
ds_read_b128 a[144:147],v0 offset:24704
v_fma_f32 v101,v101,s36,v16
v_mfma_f32_16x16x32_bf16 v[144:147],a[120:123],v[28:31],0
ds_read_b128 a[148:151],v1 offset:24704
v_fma_f32 v102,v102,s36,v16
v_mfma_f32_16x16x32_bf16 v[148:151],a[124:127],v[28:31],0
v_exp_f32 v92,v92
v_mfma_f32_16x16x32_bf16 a[196:199],a[124:127],v[32:35],0
buffer_load_dwordx4 v6,s[8:11],s21 offen offset:0 lds
v_mfma_f32_16x16x32_bf16 a[192:195],a[120:123],v[32:35],0
v_exp_f32 v93,v93
v_mfma_f32_16x16x32_bf16 a[240:243],a[120:123],v[36:39],0
ds_read_b128 a[120:123],v0 offset:24832
v_cvt_pk_bf16_f32 v54,v92,v93
v_mfma_f32_16x16x32_bf16 a[244:247],a[124:127],v[36:39],0
ds_read_b128 a[124:127],v1 offset:24832
v_fma_f32 v103,v103,s36,v16
v_mfma_f32_16x16x32_bf16 a[248:251],a[128:131],v[36:39],0
v_exp_f32 v94,v94
v_mfma_f32_16x16x32_bf16 a[252:255],a[132:135],v[36:39],0
v_exp_f32 v95,v95
v_mfma_f32_16x16x32_bf16 a[204:207],a[132:135],v[32:35],0
v_cvt_pk_bf16_f32 v55,v94,v95
v_fma_f32 v108,v108,s36,v17
v_mfma_f32_16x16x32_bf16 a[200:203],a[128:131],v[32:35],0
v_exp_f32 v100,v100
v_mfma_f32_16x16x32_bf16 v[152:155],a[128:131],v[28:31],0
v_exp_f32 v101,v101
v_mfma_f32_16x16x32_bf16 v[156:159],a[132:135],v[28:31],0
v_exp_f32 v102,v102
v_mfma_f32_16x16x32_bf16 v[252:255],a[132:135],v[24:27],0
v_exp_f32 v103,v103
v_mfma_f32_16x16x32_bf16 v[248:251],a[128:131],v[24:27],0
buffer_load_dwordx4 v7,s[8:11],s21 offen offset:1024 lds
v_mfma_f32_16x16x32_bf16 v[200:203],a[128:131],v[20:23],0
ds_read_b128 a[128:131],v0 offset:30720
v_cvt_pk_bf16_f32 v58,v100,v101
v_mfma_f32_16x16x32_bf16 v[204:207],a[132:135],v[20:23],0
s_waitcnt lgkmcnt(1)
ds_read_b128 a[132:135],v1 offset:30720
v_cvt_pk_bf16_f32 v59,v102,v103
v_mfma_f32_16x16x32_bf16 v[72:75],a[136:139],a[0:3],0
v_fma_f32 v109,v109,s36,v17
v_fma_f32 v110,v110,s36,v17
v_smfmac_f32_16x16x64_bf16 v[64:67],a[152:155],v[52:59],v18
v_fma_f32 v111,v111,s36,v17
v_mfma_f32_16x16x32_bf16 v[72:75],a[140:143],a[4:7],v[72:75]
v_exp_f32 v108,v108
v_mfma_f32_16x16x32_bf16 v[72:75],a[144:147],a[8:11],v[72:75]
v_exp_f32 v109,v109
v_mfma_f32_16x16x32_bf16 v[72:75],a[148:151],a[12:15],v[72:75]
v_exp_f32 v110,v110
v_mfma_f32_16x16x32_bf16 v[72:75],a[120:123],a[16:19],v[72:75]
v_exp_f32 v111,v111
v_mfma_f32_16x16x32_bf16 v[72:75],a[124:127],a[20:23],v[72:75]
v_cvt_pk_bf16_f32 v42,v108,v109
v_cvt_pk_bf16_f32 v43,v110,v111
v_mfma_f32_16x16x32_bf16 v[80:83],a[124:127],a[44:47],0
v_mfma_f32_16x16x32_bf16 v[80:83],a[120:123],a[40:43],v[80:83]
v_smfmac_f32_16x16x64_bf16 v[68:71],a[152:155],v[36:43],v18
buffer_load_dwordx4 v8,s[8:11],s21 offen offset:2048 lds
v_mfma_f32_16x16x32_bf16 v[80:83],a[148:151],a[36:39],v[80:83]
s_add_u32 s21,s21,12288
v_fma_f32 v72,v72,s36,v13
v_fma_f32 v73,v73,s36,v13
v_mfma_f32_16x16x32_bf16 v[80:83],a[144:147],a[32:35],v[80:83]
s_add_u32 m0,s22,12288
v_fma_f32 v74,v74,s36,v13
v_fma_f32 v75,v75,s36,v13
v_mfma_f32_16x16x32_bf16 v[80:83],a[140:143],a[28:31],v[80:83]
v_exp_f32 v72,v72
v_mfma_f32_16x16x32_bf16 v[80:83],a[136:139],a[24:27],v[80:83]
v_exp_f32 v73,v73
v_mfma_f32_16x16x32_bf16 v[88:91],a[136:139],a[48:51],0
v_exp_f32 v74,v74
v_mfma_f32_16x16x32_bf16 v[88:91],a[140:143],a[52:55],v[88:91]
v_exp_f32 v75,v75
v_mfma_f32_16x16x32_bf16 v[88:91],a[144:147],a[56:59],v[88:91]
v_cvt_pk_bf16_f32 v20,v72,v73
v_cvt_pk_bf16_f32 v21,v74,v75
v_mfma_f32_16x16x32_bf16 v[88:91],a[148:151],a[60:63],v[88:91]
v_fma_f32 v80,v80,s36,v14
v_fma_f32 v81,v81,s36,v14
v_mfma_f32_16x16x32_bf16 v[88:91],a[120:123],a[64:67],v[88:91]
v_fma_f32 v82,v82,s36,v14
v_fma_f32 v83,v83,s36,v14
v_mfma_f32_16x16x32_bf16 v[88:91],a[124:127],a[68:71],v[88:91]
v_exp_f32 v80,v80
v_mfma_f32_16x16x32_bf16 v[96:99],a[124:127],a[92:95],0
buffer_load_dwordx4 v6,s[4:7],s20 offen offset:0 lds
v_mfma_f32_16x16x32_bf16 v[96:99],a[120:123],a[88:91],v[96:99]
v_exp_f32 v81,v81
v_mfma_f32_16x16x32_bf16 v[96:99],a[148:151],a[84:87],v[96:99]
v_exp_f32 v82,v82
v_mfma_f32_16x16x32_bf16 v[96:99],a[144:147],a[80:83],v[96:99]
v_fma_f32 v88,v88,s36,v15
v_fma_f32 v89,v89,s36,v15
v_mfma_f32_16x16x32_bf16 v[96:99],a[140:143],a[76:79],v[96:99]
v_exp_f32 v83,v83
v_mfma_f32_16x16x32_bf16 v[96:99],a[136:139],a[72:75],v[96:99]
v_exp_f32 v88,v88
v_mfma_f32_16x16x32_bf16 v[104:107],a[136:139],a[96:99],0
ds_read_b128 a[136:139],v0 offset:30848
v_cvt_pk_bf16_f32 v24,v80,v81
v_mfma_f32_16x16x32_bf16 v[104:107],a[140:143],a[100:103],v[104:107]
ds_read_b128 a[140:143],v1 offset:30848
v_cvt_pk_bf16_f32 v25,v82,v83
v_mfma_f32_16x16x32_bf16 v[104:107],a[144:147],a[104:107],v[104:107]
ds_read_b128 a[144:147],v0 offset:30976
v_mfma_f32_16x16x32_bf16 v[104:107],a[148:151],a[108:111],v[104:107]
ds_read_b128 a[148:151],v1 offset:30976
v_mfma_f32_16x16x32_bf16 v[104:107],a[120:123],a[112:115],v[104:107]
v_exp_f32 v89,v89
v_mfma_f32_16x16x32_bf16 v[104:107],a[124:127],a[116:119],v[104:107]
s_waitcnt lgkmcnt(4)
v_cvt_pk_bf16_f32 v28,v88,v89
v_mfma_f32_16x16x32_bf16 v[76:79],a[128:131],a[0:3],0
buffer_load_dwordx4 v7,s[4:7],s20 offen offset:1024 lds
v_mfma_f32_16x16x32_bf16 v[76:79],a[132:135],a[4:7],v[76:79]
s_waitcnt lgkmcnt(3)
v_mfma_f32_16x16x32_bf16 v[76:79],a[136:139],a[8:11],v[76:79]
s_waitcnt lgkmcnt(2)
v_mfma_f32_16x16x32_bf16 v[76:79],a[140:143],a[12:15],v[76:79]
s_waitcnt lgkmcnt(1)
v_mfma_f32_16x16x32_bf16 v[76:79],a[144:147],a[16:19],v[76:79]
s_waitcnt lgkmcnt(0)
v_mfma_f32_16x16x32_bf16 v[76:79],a[148:151],a[20:23],v[76:79]
v_mfma_f32_16x16x32_bf16 v[84:87],a[148:151],a[44:47],0
v_mfma_f32_16x16x32_bf16 v[84:87],a[144:147],a[40:43],v[84:87]
v_mfma_f32_16x16x32_bf16 v[84:87],a[140:143],a[36:39],v[84:87]
v_mfma_f32_16x16x32_bf16 v[84:87],a[136:139],a[32:35],v[84:87]
v_mfma_f32_16x16x32_bf16 v[84:87],a[132:135],a[28:31],v[84:87]
v_mfma_f32_16x16x32_bf16 v[84:87],a[128:131],a[24:27],v[84:87]
v_mfma_f32_16x16x32_bf16 v[92:95],a[128:131],a[48:51],0
buffer_load_dwordx4 v8,s[4:7],s20 offen offset:2048 lds
v_mfma_f32_16x16x32_bf16 v[92:95],a[132:135],a[52:55],v[92:95]
s_add_u32 s20,s20,12288
v_mfma_f32_16x16x32_bf16 v[92:95],a[136:139],a[56:59],v[92:95]
v_mfma_f32_16x16x32_bf16 v[92:95],a[140:143],a[60:63],v[92:95]
v_mfma_f32_16x16x32_bf16 v[92:95],a[144:147],a[64:67],v[92:95]
v_mfma_f32_16x16x32_bf16 v[92:95],a[148:151],a[68:71],v[92:95]
ds_read_b64_tr_b16 a[120:121],v2 offset:12288
v_mfma_f32_16x16x32_bf16 v[100:103],a[148:151],a[92:95],0
ds_read_b64_tr_b16 a[122:123],v2 offset:18432
v_mfma_f32_16x16x32_bf16 v[100:103],a[144:147],a[88:91],v[100:103]
v_mfma_f32_16x16x32_bf16 v[100:103],a[140:143],a[84:87],v[100:103]
ds_read_b64_tr_b16 a[124:125],v3 offset:12288
v_mfma_f32_16x16x32_bf16 v[100:103],a[136:139],a[80:83],v[100:103]
ds_read_b64_tr_b16 a[126:127],v3 offset:18432
v_mfma_f32_16x16x32_bf16 v[100:103],a[132:135],a[76:79],v[100:103]
v_mfma_f32_16x16x32_bf16 v[100:103],a[128:131],a[72:75],v[100:103]
v_mfma_f32_16x16x32_bf16 v[108:111],a[128:131],a[96:99],0
ds_read_b64_tr_b16 a[128:129],v4 offset:12288
v_mfma_f32_16x16x32_bf16 v[108:111],a[132:135],a[100:103],v[108:111]
ds_read_b64_tr_b16 a[130:131],v4 offset:18432
v_mfma_f32_16x16x32_bf16 v[108:111],a[136:139],a[104:107],v[108:111]
ds_read_b64_tr_b16 a[132:133],v5 offset:12288
v_mfma_f32_16x16x32_bf16 v[108:111],a[140:143],a[108:111],v[108:111]
ds_read_b64_tr_b16 a[134:135],v5 offset:18432
v_mfma_f32_16x16x32_bf16 v[108:111],a[144:147],a[112:115],v[108:111]
v_mfma_f32_16x16x32_bf16 v[108:111],a[148:151],a[116:119],v[108:111]
s_waitcnt lgkmcnt(4)
v_mfma_f32_16x16x32_bf16 v[160:163],a[120:123],v[44:47],v[160:163]
s_add_u32 m0,s23,12288
ds_read_b64_tr_b16 a[136:137],v2 offset:12416
v_fma_f32 v90,v90,s36,v15
v_mfma_f32_16x16x32_bf16 v[164:167],a[124:127],v[44:47],v[164:167]
ds_read_b64_tr_b16 a[138:139],v2 offset:18560
v_fma_f32 v91,v91,s36,v15
v_mfma_f32_16x16x32_bf16 v[212:215],a[124:127],v[48:51],v[212:215]
ds_read_b64_tr_b16 a[140:141],v3 offset:12416
v_fma_f32 v96,v96,s36,v16
v_mfma_f32_16x16x32_bf16 v[208:211],a[120:123],v[48:51],v[208:211]
ds_read_b64_tr_b16 a[142:143],v3 offset:18560
v_fma_f32 v97,v97,s36,v16
v_mfma_f32_16x16x32_bf16 v[112:115],a[120:123],v[52:55],v[112:115]
ds_read_b64_tr_b16 a[144:145],v4 offset:12416
v_fma_f32 v98,v98,s36,v16
v_mfma_f32_16x16x32_bf16 v[116:119],a[124:127],v[52:55],v[116:119]
ds_read_b64_tr_b16 a[146:147],v4 offset:18560
v_fma_f32 v99,v99,s36,v16
v_mfma_f32_16x16x32_bf16 a[164:167],a[124:127],v[56:59],a[164:167]
ds_read_b64_tr_b16 a[148:149],v5 offset:12416
v_fma_f32 v104,v104,s36,v17
v_mfma_f32_16x16x32_bf16 a[160:163],a[120:123],v[56:59],a[160:163]
ds_read_b64_tr_b16 a[150:151],v5 offset:18560
v_fma_f32 v105,v105,s36,v17
v_mfma_f32_16x16x32_bf16 a[208:211],a[120:123],v[40:43],a[208:211]
ds_read_b64_tr_b16 a[120:121],v2 offset:12544
v_fma_f32 v106,v106,s36,v17
v_mfma_f32_16x16x32_bf16 a[212:215],a[124:127],v[40:43],a[212:215]
s_waitcnt lgkmcnt(6)
ds_read_b64_tr_b16 a[122:123],v2 offset:18688
v_fma_f32 v107,v107,s36,v17
v_mfma_f32_16x16x32_bf16 a[216:219],a[128:131],v[40:43],a[216:219]
ds_read_b64_tr_b16 a[124:125],v3 offset:12544
v_fma_f32 v76,v76,s36,v13
v_mfma_f32_16x16x32_bf16 a[220:223],a[132:135],v[40:43],a[220:223]
ds_read_b64_tr_b16 a[126:127],v3 offset:18688
v_fma_f32 v77,v77,s36,v13
v_mfma_f32_16x16x32_bf16 a[172:175],a[132:135],v[56:59],a[172:175]
v_exp_f32 v90,v90
v_mfma_f32_16x16x32_bf16 a[168:171],a[128:131],v[56:59],a[168:171]
v_exp_f32 v91,v91
v_mfma_f32_16x16x32_bf16 v[120:123],a[128:131],v[52:55],v[120:123]
v_cvt_pk_bf16_f32 v29,v90,v91
v_fma_f32 v78,v78,s36,v13
v_mfma_f32_16x16x32_bf16 v[124:127],a[132:135],v[52:55],v[124:127]
v_exp_f32 v96,v96
v_mfma_f32_16x16x32_bf16 v[220:223],a[132:135],v[48:51],v[220:223]
v_exp_f32 v97,v97
v_mfma_f32_16x16x32_bf16 v[216:219],a[128:131],v[48:51],v[216:219]
v_exp_f32 v98,v98
v_mfma_f32_16x16x32_bf16 v[168:171],a[128:131],v[44:47],v[168:171]
ds_read_b64_tr_b16 a[128:129],v4 offset:12544
v_cvt_pk_bf16_f32 v32,v96,v97
v_mfma_f32_16x16x32_bf16 v[172:175],a[132:135],v[44:47],v[172:175]
ds_read_b64_tr_b16 a[130:131],v4 offset:18688
v_fma_f32 v79,v79,s36,v13
v_mfma_f32_16x16x32_bf16 v[176:179],a[136:139],v[44:47],v[176:179]
s_waitcnt lgkmcnt(2)
ds_read_b64_tr_b16 a[132:133],v5 offset:12544
v_fma_f32 v84,v84,s36,v14
v_mfma_f32_16x16x32_bf16 v[180:183],a[140:143],v[44:47],v[180:183]
ds_read_b64_tr_b16 a[134:135],v5 offset:18688
v_fma_f32 v85,v85,s36,v14
v_mfma_f32_16x16x32_bf16 v[228:231],a[140:143],v[48:51],v[228:231]
v_exp_f32 v99,v99
v_mfma_f32_16x16x32_bf16 v[224:227],a[136:139],v[48:51],v[224:227]
v_cvt_pk_bf16_f32 v33,v98,v99
v_fma_f32 v86,v86,s36,v14
v_mfma_f32_16x16x32_bf16 v[128:131],a[136:139],v[52:55],v[128:131]
v_exp_f32 v104,v104
v_mfma_f32_16x16x32_bf16 v[132:135],a[140:143],v[52:55],v[132:135]
v_exp_f32 v105,v105
v_mfma_f32_16x16x32_bf16 a[180:183],a[140:143],v[56:59],a[180:183]
v_exp_f32 v106,v106
v_mfma_f32_16x16x32_bf16 a[176:179],a[136:139],v[56:59],a[176:179]
v_exp_f32 v107,v107
v_mfma_f32_16x16x32_bf16 a[224:227],a[136:139],v[40:43],a[224:227]
v_cvt_pk_bf16_f32 v36,v104,v105
v_cvt_pk_bf16_f32 v37,v106,v107
v_mfma_f32_16x16x32_bf16 a[228:231],a[140:143],v[40:43],a[228:231]
v_exp_f32 v76,v76
v_mfma_f32_16x16x32_bf16 a[232:235],a[144:147],v[40:43],a[232:235]
v_exp_f32 v77,v77
v_mfma_f32_16x16x32_bf16 a[236:239],a[148:151],v[40:43],a[236:239]
v_exp_f32 v78,v78
v_mfma_f32_16x16x32_bf16 a[188:191],a[148:151],v[56:59],a[188:191]
v_exp_f32 v79,v79
v_mfma_f32_16x16x32_bf16 a[184:187],a[144:147],v[56:59],a[184:187]
v_cvt_pk_bf16_f32 v22,v76,v77
v_cvt_pk_bf16_f32 v23,v78,v79
v_mfma_f32_16x16x32_bf16 v[136:139],a[144:147],v[52:55],v[136:139]
v_fma_f32 v87,v87,s36,v14
v_fma_f32 v92,v92,s36,v15
v_mfma_f32_16x16x32_bf16 v[140:143],a[148:151],v[52:55],v[140:143]
v_exp_f32 v84,v84
v_mfma_f32_16x16x32_bf16 v[236:239],a[148:151],v[48:51],v[236:239]
v_exp_f32 v85,v85
v_mfma_f32_16x16x32_bf16 v[232:235],a[144:147],v[48:51],v[232:235]
v_exp_f32 v86,v86
v_mfma_f32_16x16x32_bf16 v[184:187],a[144:147],v[44:47],v[184:187]
v_exp_f32 v87,v87
v_mfma_f32_16x16x32_bf16 v[188:191],a[148:151],v[44:47],v[188:191]
v_cvt_pk_bf16_f32 v26,v84,v85
v_cvt_pk_bf16_f32 v27,v86,v87
v_mfma_f32_16x16x32_bf16 v[192:195],a[120:123],v[44:47],v[192:195]
s_waitcnt vmcnt(6) lgkmcnt(0)
v_fma_f32 v93,v93,s36,v15
v_fma_f32 v94,v94,s36,v15
v_smfmac_f32_16x16x64_bf16 v[60:63],a[152:155],v[20:27],v18
s_barrier
v_mfma_f32_16x16x32_bf16 v[196:199],a[124:127],v[44:47],v[196:199]
ds_read_b128 a[136:139],v0 offset:0
v_fma_f32 v95,v95,s36,v15
v_mfma_f32_16x16x32_bf16 v[244:247],a[124:127],v[48:51],v[244:247]
ds_read_b128 a[140:143],v1 offset:0
v_fma_f32 v100,v100,s36,v16
v_mfma_f32_16x16x32_bf16 v[240:243],a[120:123],v[48:51],v[240:243]
ds_read_b128 a[144:147],v0 offset:128
v_fma_f32 v101,v101,s36,v16
v_mfma_f32_16x16x32_bf16 v[144:147],a[120:123],v[52:55],v[144:147]
ds_read_b128 a[148:151],v1 offset:128
v_fma_f32 v102,v102,s36,v16
v_mfma_f32_16x16x32_bf16 v[148:151],a[124:127],v[52:55],v[148:151]
v_exp_f32 v92,v92
v_mfma_f32_16x16x32_bf16 a[196:199],a[124:127],v[56:59],a[196:199]
buffer_load_dwordx4 v6,s[8:11],s21 offen offset:0 lds
v_mfma_f32_16x16x32_bf16 a[192:195],a[120:123],v[56:59],a[192:195]
v_exp_f32 v93,v93
v_mfma_f32_16x16x32_bf16 a[240:243],a[120:123],v[40:43],a[240:243]
ds_read_b128 a[120:123],v0 offset:256
v_cvt_pk_bf16_f32 v30,v92,v93
v_mfma_f32_16x16x32_bf16 a[244:247],a[124:127],v[40:43],a[244:247]
ds_read_b128 a[124:127],v1 offset:256
v_fma_f32 v103,v103,s36,v16
v_mfma_f32_16x16x32_bf16 a[248:251],a[128:131],v[40:43],a[248:251]
v_exp_f32 v94,v94
v_mfma_f32_16x16x32_bf16 a[252:255],a[132:135],v[40:43],a[252:255]
v_exp_f32 v95,v95
v_mfma_f32_16x16x32_bf16 a[204:207],a[132:135],v[56:59],a[204:207]
v_cvt_pk_bf16_f32 v31,v94,v95
v_fma_f32 v108,v108,s36,v17
v_mfma_f32_16x16x32_bf16 a[200:203],a[128:131],v[56:59],a[200:203]
v_exp_f32 v100,v100
v_mfma_f32_16x16x32_bf16 v[152:155],a[128:131],v[52:55],v[152:155]
v_exp_f32 v101,v101
v_mfma_f32_16x16x32_bf16 v[156:159],a[132:135],v[52:55],v[156:159]
v_exp_f32 v102,v102
v_mfma_f32_16x16x32_bf16 v[252:255],a[132:135],v[48:51],v[252:255]
v_exp_f32 v103,v103
v_mfma_f32_16x16x32_bf16 v[248:251],a[128:131],v[48:51],v[248:251]
buffer_load_dwordx4 v7,s[8:11],s21 offen offset:1024 lds
v_mfma_f32_16x16x32_bf16 v[200:203],a[128:131],v[44:47],v[200:203]
ds_read_b128 a[128:131],v0 offset:6144
v_cvt_pk_bf16_f32 v34,v100,v101
v_mfma_f32_16x16x32_bf16 v[204:207],a[132:135],v[44:47],v[204:207]
s_waitcnt lgkmcnt(1)
ds_read_b128 a[132:135],v1 offset:6144
v_cvt_pk_bf16_f32 v35,v102,v103
v_mfma_f32_16x16x32_bf16 v[72:75],a[136:139],a[0:3],0
v_fma_f32 v109,v109,s36,v17
v_fma_f32 v110,v110,s36,v17
v_smfmac_f32_16x16x64_bf16 v[64:67],a[152:155],v[28:35],v18
v_fma_f32 v111,v111,s36,v17
v_mfma_f32_16x16x32_bf16 v[72:75],a[140:143],a[4:7],v[72:75]
v_exp_f32 v108,v108
v_mfma_f32_16x16x32_bf16 v[72:75],a[144:147],a[8:11],v[72:75]
v_exp_f32 v109,v109
v_mfma_f32_16x16x32_bf16 v[72:75],a[148:151],a[12:15],v[72:75]
v_exp_f32 v110,v110
v_mfma_f32_16x16x32_bf16 v[72:75],a[120:123],a[16:19],v[72:75]
v_exp_f32 v111,v111
v_mfma_f32_16x16x32_bf16 v[72:75],a[124:127],a[20:23],v[72:75]
v_cvt_pk_bf16_f32 v38,v108,v109
v_cvt_pk_bf16_f32 v39,v110,v111
v_mfma_f32_16x16x32_bf16 v[80:83],a[124:127],a[44:47],0
v_mfma_f32_16x16x32_bf16 v[80:83],a[120:123],a[40:43],v[80:83]
v_mfma_f32_16x16x32_bf16 v[80:83],a[148:151],a[36:39],v[80:83]
buffer_load_dwordx4 v8,s[8:11],s21 offen offset:2048 lds
v_mfma_f32_16x16x32_bf16 v[80:83],a[144:147],a[32:35],v[80:83]
s_add_u32 s21,s21,12288
v_fma_f32 v72,v72,s36,v13
v_fma_f32 v73,v73,s36,v13
v_mfma_f32_16x16x32_bf16 v[80:83],a[140:143],a[28:31],v[80:83]
s_add_u32 m0,s22,24576
v_fma_f32 v74,v74,s36,v13
v_fma_f32 v75,v75,s36,v13
v_mfma_f32_16x16x32_bf16 v[80:83],a[136:139],a[24:27],v[80:83]
v_exp_f32 v72,v72
v_mfma_f32_16x16x32_bf16 v[88:91],a[136:139],a[48:51],0
v_exp_f32 v73,v73
v_mfma_f32_16x16x32_bf16 v[88:91],a[140:143],a[52:55],v[88:91]
v_exp_f32 v74,v74
v_mfma_f32_16x16x32_bf16 v[88:91],a[144:147],a[56:59],v[88:91]
v_exp_f32 v75,v75
v_mfma_f32_16x16x32_bf16 v[88:91],a[148:151],a[60:63],v[88:91]
v_fma_f32 v80,v80,s36,v14
v_fma_f32 v81,v81,s36,v14
v_mfma_f32_16x16x32_bf16 v[88:91],a[120:123],a[64:67],v[88:91]
v_fma_f32 v82,v82,s36,v14
v_fma_f32 v83,v83,s36,v14
v_mfma_f32_16x16x32_bf16 v[88:91],a[124:127],a[68:71],v[88:91]
v_exp_f32 v80,v80
v_mfma_f32_16x16x32_bf16 v[96:99],a[124:127],a[92:95],0
v_exp_f32 v81,v81
v_mfma_f32_16x16x32_bf16 v[96:99],a[120:123],a[88:91],v[96:99]
v_exp_f32 v82,v82
v_mfma_f32_16x16x32_bf16 v[96:99],a[148:151],a[84:87],v[96:99]
buffer_load_dwordx4 v6,s[4:7],s20 offen offset:0 lds
v_mfma_f32_16x16x32_bf16 v[96:99],a[144:147],a[80:83],v[96:99]
v_fma_f32 v88,v88,s36,v15
v_fma_f32 v89,v89,s36,v15
v_mfma_f32_16x16x32_bf16 v[96:99],a[140:143],a[76:79],v[96:99]
v_exp_f32 v83,v83
v_mfma_f32_16x16x32_bf16 v[96:99],a[136:139],a[72:75],v[96:99]
v_exp_f32 v88,v88
v_mfma_f32_16x16x32_bf16 v[104:107],a[136:139],a[96:99],0
ds_read_b128 a[136:139],v0 offset:6272
v_cvt_pk_bf16_f32 v44,v72,v73
v_mfma_f32_16x16x32_bf16 v[104:107],a[140:143],a[100:103],v[104:107]
ds_read_b128 a[140:143],v1 offset:6272
v_cvt_pk_bf16_f32 v45,v74,v75
v_mfma_f32_16x16x32_bf16 v[104:107],a[144:147],a[104:107],v[104:107]
ds_read_b128 a[144:147],v0 offset:6400
v_cvt_pk_bf16_f32 v48,v80,v81
v_mfma_f32_16x16x32_bf16 v[104:107],a[148:151],a[108:111],v[104:107]
ds_read_b128 a[148:151],v1 offset:6400
v_cvt_pk_bf16_f32 v49,v82,v83
v_mfma_f32_16x16x32_bf16 v[104:107],a[120:123],a[112:115],v[104:107]
v_exp_f32 v89,v89
v_mfma_f32_16x16x32_bf16 v[104:107],a[124:127],a[116:119],v[104:107]
s_waitcnt lgkmcnt(4)
v_cvt_pk_bf16_f32 v52,v88,v89
v_mfma_f32_16x16x32_bf16 v[76:79],a[128:131],a[0:3],0
v_mfma_f32_16x16x32_bf16 v[76:79],a[132:135],a[4:7],v[76:79]
buffer_load_dwordx4 v7,s[4:7],s20 offen offset:1024 lds
s_waitcnt lgkmcnt(3)
v_mfma_f32_16x16x32_bf16 v[76:79],a[136:139],a[8:11],v[76:79]
s_waitcnt lgkmcnt(2)
v_mfma_f32_16x16x32_bf16 v[76:79],a[140:143],a[12:15],v[76:79]
s_waitcnt lgkmcnt(1)
v_mfma_f32_16x16x32_bf16 v[76:79],a[144:147],a[16:19],v[76:79]
s_waitcnt lgkmcnt(0)
v_mfma_f32_16x16x32_bf16 v[76:79],a[148:151],a[20:23],v[76:79]
v_mfma_f32_16x16x32_bf16 v[84:87],a[148:151],a[44:47],0
v_mfma_f32_16x16x32_bf16 v[84:87],a[144:147],a[40:43],v[84:87]
v_mfma_f32_16x16x32_bf16 v[84:87],a[140:143],a[36:39],v[84:87]
v_mfma_f32_16x16x32_bf16 v[84:87],a[136:139],a[32:35],v[84:87]
v_mfma_f32_16x16x32_bf16 v[84:87],a[132:135],a[28:31],v[84:87]
v_mfma_f32_16x16x32_bf16 v[84:87],a[128:131],a[24:27],v[84:87]
v_mfma_f32_16x16x32_bf16 v[92:95],a[128:131],a[48:51],0
v_mfma_f32_16x16x32_bf16 v[92:95],a[132:135],a[52:55],v[92:95]
buffer_load_dwordx4 v8,s[4:7],s20 offen offset:2048 lds
v_mfma_f32_16x16x32_bf16 v[92:95],a[136:139],a[56:59],v[92:95]
s_add_u32 s20,s20,12288
v_mfma_f32_16x16x32_bf16 v[92:95],a[140:143],a[60:63],v[92:95]
v_mfma_f32_16x16x32_bf16 v[92:95],a[144:147],a[64:67],v[92:95]
v_mfma_f32_16x16x32_bf16 v[92:95],a[148:151],a[68:71],v[92:95]
v_mfma_f32_16x16x32_bf16 v[100:103],a[148:151],a[92:95],0
v_mfma_f32_16x16x32_bf16 v[100:103],a[144:147],a[88:91],v[100:103]
ds_read_b64_tr_b16 a[120:121],v2 offset:24576
v_mfma_f32_16x16x32_bf16 v[100:103],a[140:143],a[84:87],v[100:103]
ds_read_b64_tr_b16 a[122:123],v2 offset:30720
v_mfma_f32_16x16x32_bf16 v[100:103],a[136:139],a[80:83],v[100:103]
ds_read_b64_tr_b16 a[124:125],v3 offset:24576
v_mfma_f32_16x16x32_bf16 v[100:103],a[132:135],a[76:79],v[100:103]
ds_read_b64_tr_b16 a[126:127],v3 offset:30720
v_mfma_f32_16x16x32_bf16 v[100:103],a[128:131],a[72:75],v[100:103]
v_mfma_f32_16x16x32_bf16 v[108:111],a[128:131],a[96:99],0
ds_read_b64_tr_b16 a[128:129],v4 offset:24576
v_mfma_f32_16x16x32_bf16 v[108:111],a[132:135],a[100:103],v[108:111]
ds_read_b64_tr_b16 a[130:131],v4 offset:30720
v_mfma_f32_16x16x32_bf16 v[108:111],a[136:139],a[104:107],v[108:111]
ds_read_b64_tr_b16 a[132:133],v5 offset:24576
v_mfma_f32_16x16x32_bf16 v[108:111],a[140:143],a[108:111],v[108:111]
ds_read_b64_tr_b16 a[134:135],v5 offset:30720
v_mfma_f32_16x16x32_bf16 v[108:111],a[144:147],a[112:115],v[108:111]
v_mfma_f32_16x16x32_bf16 v[108:111],a[148:151],a[116:119],v[108:111]
s_mov_b32 s38,0
s_branch L_loop5
L_tr44:
s_waitcnt vmcnt(43)
s_waitcnt lgkmcnt(3)
v_mfma_f32_16x16x32_bf16 v[160:163],a[120:123],v[20:23],v[160:163]
s_add_u32 m0,s24,0
ds_read_b128 a[4:7],v12 offset:0
v_fma_f32 v79,v79,s36,v13
v_mfma_f32_16x16x32_bf16 v[164:167],a[124:127],v[20:23],v[164:167]
ds_read_b128 a[12:15],v12 offset:128
v_fma_f32 v100,v100,s36,v16
v_mfma_f32_16x16x32_bf16 v[212:215],a[124:127],v[24:27],v[212:215]
ds_read_b128 a[20:23],v12 offset:256
v_fma_f32 v101,v101,s36,v16
v_mfma_f32_16x16x32_bf16 v[208:211],a[120:123],v[24:27],v[208:211]
ds_read_b128 a[8:11],v11 offset:128
v_fma_f32 v89,v89,s36,v15
v_mfma_f32_16x16x32_bf16 v[112:115],a[120:123],v[28:31],v[112:115]
ds_read_b128 a[0:3],v11 offset:0
v_fma_f32 v76,v76,s36,v13
v_mfma_f32_16x16x32_bf16 v[116:119],a[124:127],v[28:31],v[116:119]
ds_read_b128 a[16:19],v11 offset:256
v_fma_f32 v83,v83,s36,v14
v_mfma_f32_16x16x32_bf16 a[164:167],a[124:127],v[32:35],a[164:167]
ds_read_b64_tr_b16 a[138:139],v2 offset:30848
v_fma_f32 v90,v90,s36,v15
v_mfma_f32_16x16x32_bf16 a[160:163],a[120:123],v[32:35],a[160:163]
s_waitcnt lgkmcnt(6)
ds_read_b64_tr_b16 a[136:137],v2 offset:24704
v_fma_f32 v88,v88,s36,v15
v_mfma_f32_16x16x32_bf16 a[168:171],a[128:131],v[32:35],a[168:171]
ds_read_b64_tr_b16 a[142:143],v3 offset:30848
ds_read_b64_tr_b16 a[140:141],v3 offset:24704
ds_read_b64_tr_b16 a[146:147],v4 offset:30848
ds_read_b64_tr_b16 a[144:145],v4 offset:24704
ds_read_b64_tr_b16 a[150:151],v5 offset:30848
ds_read_b64_tr_b16 a[148:149],v5 offset:24704
ds_read_b128 a[32:35],v11 offset:6272
v_mfma_f32_16x16x32_bf16 a[172:175],a[132:135],v[32:35],a[172:175]
v_fma_f32 v91,v91,s36,v15
ds_read_b128 a[40:43],v11 offset:6400
v_mfma_f32_16x16x32_bf16 v[124:127],a[132:135],v[28:31],v[124:127]
s_waitcnt lgkmcnt(10)
buffer_load_dwordx4 v6,s[12:15],s28 offen offset:0 nt lds
v_mfma_f32_16x16x32_bf16 v[120:123],a[128:131],v[28:31],v[120:123]
ds_read_b64_tr_b16 a[122:123],v2 offset:30976
ds_read_b64_tr_b16 a[120:121],v2 offset:24832
ds_read_b64_tr_b16 a[124:125],v3 offset:24832
ds_read_b64_tr_b16 a[126:127],v3 offset:30976
ds_read_b128 a[44:47],v12 offset:6400
v_mfma_f32_16x16x32_bf16 v[216:219],a[128:131],v[24:27],v[216:219]
v_fma_f32 v93,v93,s36,v15
ds_read_b128 a[28:31],v12 offset:6144
v_mfma_f32_16x16x32_bf16 v[220:223],a[132:135],v[24:27],v[220:223]
v_fma_f32 v98,v98,s36,v16
ds_read_b128 a[36:39],v12 offset:6272
v_mfma_f32_16x16x32_bf16 v[172:175],a[132:135],v[20:23],v[172:175]
buffer_load_dwordx4 v7,s[12:15],s28 offen offset:1024 nt lds
v_mfma_f32_16x16x32_bf16 v[168:171],a[128:131],v[20:23],v[168:171]
s_waitcnt lgkmcnt(7)
ds_read_b64_tr_b16 a[130:131],v4 offset:30976
ds_read_b128 a[24:27],v11 offset:6144
v_mfma_f32_16x16x32_bf16 v[176:179],a[136:139],v[20:23],v[176:179]
v_fma_f32 v82,v82,s36,v14
v_exp_f32 v93,v93
v_mfma_f32_16x16x32_bf16 v[180:183],a[140:143],v[20:23],v[180:183]
ds_read_b64_tr_b16 a[128:129],v4 offset:24832
v_fma_f32 v85,v85,s36,v14
v_mfma_f32_16x16x32_bf16 v[228:231],a[140:143],v[24:27],v[228:231]
ds_read_b64_tr_b16 a[134:135],v5 offset:30976
v_exp_f32 v82,v82
v_mfma_f32_16x16x32_bf16 v[224:227],a[136:139],v[24:27],v[224:227]
ds_read_b64_tr_b16 a[132:133],v5 offset:24832
v_fma_f32 v84,v84,s36,v14
v_mfma_f32_16x16x32_bf16 v[128:131],a[136:139],v[28:31],v[128:131]
v_exp_f32 v84,v84
v_mfma_f32_16x16x32_bf16 v[132:135],a[140:143],v[28:31],v[132:135]
buffer_load_dwordx4 v8,s[12:15],s28 offen offset:2048 nt lds
v_mfma_f32_16x16x32_bf16 a[180:183],a[140:143],v[32:35],a[180:183]
s_add_u32 s28,s28,3072
v_fma_f32 v103,v103,s36,v16
v_exp_f32 v103,v103
v_mfma_f32_16x16x32_bf16 a[176:179],a[136:139],v[32:35],a[176:179]
s_add_u32 m0,s24,3072
v_fma_f32 v87,v87,s36,v14
v_exp_f32 v87,v87
v_mfma_f32_16x16x32_bf16 a[184:187],a[144:147],v[32:35],a[184:187]
v_fma_f32 v77,v77,s36,v13
v_exp_f32 v77,v77
v_mfma_f32_16x16x32_bf16 a[188:191],a[148:151],v[32:35],a[188:191]
v_fma_f32 v97,v97,s36,v16
v_exp_f32 v91,v91
v_mfma_f32_16x16x32_bf16 v[140:143],a[148:151],v[28:31],v[140:143]
v_fma_f32 v102,v102,s36,v16
v_exp_f32 v85,v85
v_mfma_f32_16x16x32_bf16 v[136:139],a[144:147],v[28:31],v[136:139]
v_exp_f32 v89,v89
v_mfma_f32_16x16x32_bf16 v[232:235],a[144:147],v[24:27],v[232:235]
buffer_load_dwordx4 v6,s[12:15],s28 offen offset:0 nt lds
v_mfma_f32_16x16x32_bf16 v[236:239],a[148:151],v[24:27],v[236:239]
v_fma_f32 v92,v92,s36,v15
v_exp_f32 v101,v101
v_mfma_f32_16x16x32_bf16 v[188:191],a[148:151],v[20:23],v[188:191]
v_fma_f32 v94,v94,s36,v15
v_fma_f32 v95,v95,s36,v15
v_mfma_f32_16x16x32_bf16 v[184:187],a[144:147],v[20:23],v[184:187]
s_waitcnt lgkmcnt(0)
v_exp_f32 v95,v95
v_mfma_f32_16x16x32_bf16 v[192:195],a[120:123],v[20:23],v[192:195]
v_fma_f32 v86,v86,s36,v14
v_fma_f32 v78,v78,s36,v13
v_mfma_f32_16x16x32_bf16 v[196:199],a[124:127],v[20:23],v[196:199]
v_exp_f32 v92,v92
v_mfma_f32_16x16x32_bf16 v[244:247],a[124:127],v[24:27],v[244:247]
v_exp_f32 v78,v78
v_mfma_f32_16x16x32_bf16 v[240:243],a[120:123],v[24:27],v[240:243]
buffer_load_dwordx4 v7,s[12:15],s28 offen offset:1024 nt lds
v_mfma_f32_16x16x32_bf16 v[144:147],a[120:123],v[28:31],v[144:147]
v_exp_f32 v94,v94
v_mfma_f32_16x16x32_bf16 v[148:151],a[124:127],v[28:31],v[148:151]
v_exp_f32 v90,v90
v_mfma_f32_16x16x32_bf16 a[196:199],a[124:127],v[32:35],a[196:199]
v_fma_f32 v96,v96,s36,v16
v_exp_f32 v96,v96
v_mfma_f32_16x16x32_bf16 a[192:195],a[120:123],v[32:35],a[192:195]
v_fma_f32 v99,v99,s36,v16
v_exp_f32 v83,v83
v_mfma_f32_16x16x32_bf16 a[200:203],a[128:131],v[32:35],a[200:203]
v_exp_f32 v97,v97
v_mfma_f32_16x16x32_bf16 a[204:207],a[132:135],v[32:35],a[204:207]
v_exp_f32 v88,v88
v_mfma_f32_16x16x32_bf16 v[156:159],a[132:135],v[28:31],v[156:159]
v_exp_f32 v98,v98
v_mfma_f32_16x16x32_bf16 v[152:155],a[128:131],v[28:31],v[152:155]
buffer_load_dwordx4 v8,s[12:15],s28 offen offset:2048 nt lds
s_waitcnt vmcnt(18)
s_barrier
v_mfma_f32_16x16x32_bf16 v[248:251],a[128:131],v[24:27],v[248:251]
s_add_u32 s28,s28,3072
ds_read_b64_tr_b16 a[138:139],v2 offset:6144
v_exp_f32 v79,v79
v_mfma_f32_16x16x32_bf16 v[252:255],a[132:135],v[24:27],v[252:255]
s_add_u32 m0,s22,0
ds_read_b64_tr_b16 a[136:137],v2 offset:0
buffer_load_dwordx4 v6,s[4:7],s25 offen offset:0 lds
v_mfma_f32_16x16x32_bf16 v[204:207],a[132:135],v[20:23],v[204:207]
buffer_load_dwordx4 v7,s[4:7],s25 offen offset:1024 lds
v_mfma_f32_16x16x32_bf16 v[200:203],a[128:131],v[20:23],v[200:203]
buffer_load_dwordx4 v8,s[4:7],s25 offen offset:2048 lds
ds_read_b64_tr_b16 a[142:143],v3 offset:6144
ds_read_b64_tr_b16 a[140:141],v3 offset:0
ds_read_b64_tr_b16 a[144:145],v4 offset:0
ds_read_b64_tr_b16 a[146:147],v4 offset:6144
ds_read_b64_tr_b16 a[148:149],v5 offset:0
ds_read_b64_tr_b16 a[150:151],v5 offset:6144
v_exp_f32 v100,v100
v_cvt_pk_bf16_f32 v47,v78,v79
v_cvt_pk_bf16_f32 v49,v82,v83
v_exp_f32 v76,v76
v_exp_f32 v102,v102
v_exp_f32 v86,v86
v_cvt_pk_bf16_f32 v59,v102,v103
v_exp_f32 v99,v99
v_cvt_pk_bf16_f32 v50,v84,v85
v_cvt_pk_bf16_f32 v57,v98,v99
v_cvt_pk_bf16_f32 v55,v94,v95
v_cvt_pk_bf16_f32 v54,v92,v93
v_cvt_pk_bf16_f32 v58,v100,v101
v_cvt_pk_bf16_f32 v51,v86,v87
v_cvt_pk_bf16_f32 v53,v90,v91
v_cvt_pk_bf16_f32 v46,v76,v77
v_cvt_pk_bf16_f32 v52,v88,v89
v_cvt_pk_bf16_f32 v56,v96,v97
v_smfmac_f32_16x16x64_bf16 v[60:63],a[152:155],v[44:51],v18
v_subrev_u32 v10,18432,v10
v_smfmac_f32_16x16x64_bf16 v[64:67],a[152:155],v[52:59],v18
s_waitcnt lgkmcnt(0)
v_mfma_f32_16x16x32_bf16 v[160:163],a[136:139],v[44:47],v[160:163]
s_add_u32 s87,s42,18432
ds_read_b64_tr_b16 a[122:123],v2 offset:6272
v_mbcnt_lo_u32_b32 v39,-1,0
v_mfma_f32_16x16x32_bf16 v[164:167],a[140:143],v[44:47],v[164:167]
ds_read_b64_tr_b16 a[120:121],v2 offset:128
v_mbcnt_hi_u32_b32 v39,-1,v39
v_mfma_f32_16x16x32_bf16 v[212:215],a[140:143],v[48:51],v[212:215]
ds_read_b64_tr_b16 a[124:125],v3 offset:128
v_and_b32 v38,7,v39
v_mfma_f32_16x16x32_bf16 v[208:211],a[136:139],v[48:51],v[208:211]
ds_read_b64_tr_b16 a[126:127],v3 offset:6272
v_lshrrev_b32 v19,5,v39
v_mfma_f32_16x16x32_bf16 v[112:115],a[136:139],v[52:55],v[112:115]
ds_read_b64_tr_b16 a[130:131],v4 offset:6272
v_xor_b32 v38,v38,v19
v_mfma_f32_16x16x32_bf16 v[116:119],a[140:143],v[52:55],v[116:119]
ds_read_b64_tr_b16 a[128:129],v4 offset:128
ds_read_b64_tr_b16 a[132:133],v5 offset:128
ds_read_b64_tr_b16 a[134:135],v5 offset:6272
v_mfma_f32_16x16x32_bf16 a[164:167],a[140:143],v[56:59],a[164:167]
ds_read_b64_tr_b16 a[140:141],v3 offset:256
v_and_b32 v19,15,v39
v_mfma_f32_16x16x32_bf16 a[160:163],a[136:139],v[56:59],a[160:163]
ds_read_b64_tr_b16 a[138:139],v2 offset:6400
v_lshl_add_u32 v19,v19,7,s24
v_mfma_f32_16x16x32_bf16 a[168:171],a[144:147],v[56:59],a[168:171]
ds_read_b64_tr_b16 a[136:137],v2 offset:256
v_lshl_add_u32 v19,v38,4,v19
v_mfma_f32_16x16x32_bf16 a[172:175],a[148:151],v[56:59],a[172:175]
ds_read_b64_tr_b16 a[142:143],v3 offset:6400
v_bfe_u32 v38,v39,4,1
v_mfma_f32_16x16x32_bf16 v[124:127],a[148:151],v[52:55],v[124:127]
v_lshl_add_u32 v36,v38,3,v19
v_bfe_u32 v19,v39,3,1
v_mfma_f32_16x16x32_bf16 v[120:123],a[144:147],v[52:55],v[120:123]
v_xor_b32 v39,96,v36
v_lshlrev_b32 v19,11,v19
v_mfma_f32_16x16x32_bf16 v[216:219],a[144:147],v[48:51],v[216:219]
v_xor_b32 v38,64,v36
v_add_u32 v38,v38,v19
v_mfma_f32_16x16x32_bf16 v[220:223],a[148:151],v[48:51],v[220:223]
v_xor_b32 v37,32,v36
v_add_u32 v37,v37,v19
v_mfma_f32_16x16x32_bf16 v[172:175],a[148:151],v[44:47],v[172:175]
ds_read_b64_tr_b16 a[150:151],v5 offset:6400
v_add_u32 v36,v36,v19
v_mfma_f32_16x16x32_bf16 v[168:171],a[144:147],v[44:47],v[168:171]
s_waitcnt lgkmcnt(2)
ds_read_b64_tr_b16 a[146:147],v4 offset:6400
v_add_u32 v39,v39,v19
v_mfma_f32_16x16x32_bf16 v[176:179],a[120:123],v[44:47],v[176:179]
ds_read_b64_tr_b16 a[144:145],v4 offset:256
v_add_f32 v62,v62,v63
v_mfma_f32_16x16x32_bf16 v[180:183],a[124:127],v[44:47],v[180:183]
ds_read_b64_tr_b16 a[148:149],v5 offset:256
v_rcp_f32 v62,v62
v_mfma_f32_16x16x32_bf16 v[228:231],a[124:127],v[48:51],v[228:231]
v_accvgpr_read_b32 v96,a172
v_add_f32 v66,v66,v67
v_mfma_f32_16x16x32_bf16 v[224:227],a[120:123],v[48:51],v[224:227]
v_accvgpr_read_b32 v72,a160
v_accvgpr_read_b32 v82,a166
v_mfma_f32_16x16x32_bf16 v[128:131],a[120:123],v[52:55],v[128:131]
v_accvgpr_read_b32 v74,a162
v_accvgpr_read_b32 v99,a175
v_mfma_f32_16x16x32_bf16 v[132:135],a[124:127],v[52:55],v[132:135]
v_accvgpr_read_b32 v98,a174
v_rcp_f32 v66,v66
v_mfma_f32_16x16x32_bf16 a[180:183],a[124:127],v[56:59],a[180:183]
v_accvgpr_read_b32 v97,a173
v_accvgpr_read_b32 v81,a165
v_accvgpr_read_b32 v73,a161
v_accvgpr_read_b32 v83,a167
v_accvgpr_read_b32 v91,a171
v_pk_mul_f32 v[212:213],v[212:213],v[62:63] op_sel_hi:[1,0]
v_pk_mul_f32 v[230:231],v[230:231],v[62:63] op_sel_hi:[1,0]
v_pk_mul_f32 v[226:227],v[226:227],v[62:63] op_sel_hi:[1,0]
v_pk_mul_f32 v[208:209],v[208:209],v[62:63] op_sel_hi:[1,0]
v_pk_mul_f32 v[210:211],v[210:211],v[62:63] op_sel_hi:[1,0]
v_pk_mul_f32 v[224:225],v[224:225],v[62:63] op_sel_hi:[1,0]
v_pk_mul_f32 v[214:215],v[214:215],v[62:63] op_sel_hi:[1,0]
v_pk_mul_f32 v[228:229],v[228:229],v[62:63] op_sel_hi:[1,0]
v_accvgpr_read_b32 v87,a183
v_accvgpr_read_b32 v85,a181
v_mfma_f32_16x16x32_bf16 a[176:179],a[120:123],v[56:59],a[176:179]
v_accvgpr_read_b32 v86,a182
v_accvgpr_read_b32 v84,a180
v_mfma_f32_16x16x32_bf16 a[184:187],a[128:131],v[56:59],a[184:187]
v_accvgpr_read_b32 v90,a170
v_accvgpr_read_b32 v80,a164
v_mfma_f32_16x16x32_bf16 a[188:191],a[132:135],v[56:59],a[188:191]
v_accvgpr_read_b32 v89,a169
v_accvgpr_read_b32 v88,a168
v_mfma_f32_16x16x32_bf16 v[140:143],a[132:135],v[52:55],v[140:143]
v_accvgpr_read_b32 v77,a177
v_accvgpr_read_b32 v78,a178
v_mfma_f32_16x16x32_bf16 v[136:139],a[128:131],v[52:55],v[136:139]
v_accvgpr_read_b32 v95,a187
v_accvgpr_read_b32 v94,a186
v_mfma_f32_16x16x32_bf16 v[232:235],a[128:131],v[48:51],v[232:235]
v_accvgpr_read_b32 v103,a191
v_accvgpr_read_b32 v93,a185
v_mfma_f32_16x16x32_bf16 v[236:239],a[132:135],v[48:51],v[236:239]
v_accvgpr_read_b32 v92,a184
v_accvgpr_read_b32 v101,a189
v_mfma_f32_16x16x32_bf16 v[188:191],a[132:135],v[44:47],v[188:191]
v_accvgpr_read_b32 v102,a190
v_accvgpr_read_b32 v76,a176
v_mfma_f32_16x16x32_bf16 v[184:187],a[128:131],v[44:47],v[184:187]
v_accvgpr_read_b32 v79,a179
v_accvgpr_read_b32 v100,a188
v_accvgpr_read_b32 v75,a163
v_add_f32 v64,v64,v65
v_rcp_f32 v64,v64
v_pk_mul_f32 v[216:217],v[216:217],v[62:63] op_sel_hi:[1,0]
v_pk_mul_f32 v[234:235],v[234:235],v[62:63] op_sel_hi:[1,0]
v_pk_mul_f32 v[218:219],v[218:219],v[62:63] op_sel_hi:[1,0]
v_pk_mul_f32 v[232:233],v[232:233],v[62:63] op_sel_hi:[1,0]
v_cvt_pk_bf16_f32 v228,v228,v229
v_cvt_pk_bf16_f32 v208,v208,v209
v_mfma_f32_16x16x32_bf16 v[192:195],a[136:139],v[44:47],v[192:195]
v_cvt_pk_bf16_f32 v209,v210,v211
v_cvt_pk_bf16_f32 v224,v224,v225
v_cvt_pk_bf16_f32 v212,v212,v213
v_cvt_pk_bf16_f32 v213,v214,v215
v_cvt_pk_bf16_f32 v229,v230,v231
v_pk_mul_f32 v[238:239],v[238:239],v[62:63] op_sel_hi:[1,0]
v_pk_mul_f32 v[80:81],v[80:81],v[66:67] op_sel_hi:[1,0]
v_pk_mul_f32 v[76:77],v[76:77],v[66:67] op_sel_hi:[1,0]
v_pk_mul_f32 v[86:87],v[86:87],v[66:67] op_sel_hi:[1,0]
v_pk_mul_f32 v[96:97],v[96:97],v[66:67] op_sel_hi:[1,0]
v_pk_mul_f32 v[84:85],v[84:85],v[66:67] op_sel_hi:[1,0]
v_pk_mul_f32 v[88:89],v[88:89],v[66:67] op_sel_hi:[1,0]
v_pk_mul_f32 v[98:99],v[98:99],v[66:67] op_sel_hi:[1,0]
v_pk_mul_f32 v[82:83],v[82:83],v[66:67] op_sel_hi:[1,0]
v_pk_mul_f32 v[74:75],v[74:75],v[66:67] op_sel_hi:[1,0]
v_pk_mul_f32 v[100:101],v[100:101],v[66:67] op_sel_hi:[1,0]
v_pk_mul_f32 v[220:221],v[220:221],v[62:63] op_sel_hi:[1,0]
v_pk_mul_f32 v[72:73],v[72:73],v[66:67] op_sel_hi:[1,0]
v_pk_mul_f32 v[90:91],v[90:91],v[66:67] op_sel_hi:[1,0]
v_pk_mul_f32 v[222:223],v[222:223],v[62:63] op_sel_hi:[1,0]
v_pk_mul_f32 v[102:103],v[102:103],v[66:67] op_sel_hi:[1,0]
v_pk_mul_f32 v[92:93],v[92:93],v[66:67] op_sel_hi:[1,0]
v_pk_mul_f32 v[94:95],v[94:95],v[66:67] op_sel_hi:[1,0]
v_pk_mul_f32 v[78:79],v[78:79],v[66:67] op_sel_hi:[1,0]
v_pk_mul_f32 v[236:237],v[236:237],v[62:63] op_sel_hi:[1,0]
v_cvt_pk_bf16_f32 v232,v232,v233
v_cvt_pk_bf16_f32 v236,v236,v237
s_waitcnt lgkmcnt(0)
v_mfma_f32_16x16x32_bf16 v[196:199],a[140:143],v[44:47],v[196:199]
v_cvt_pk_bf16_f32 v216,v216,v217
v_cvt_pk_bf16_f32 v237,v238,v239
v_mfma_f32_16x16x32_bf16 v[244:247],a[140:143],v[48:51],v[244:247]
v_cvt_pk_bf16_f32 v233,v234,v235
v_cvt_pk_bf16_f32 v225,v226,v227
v_mfma_f32_16x16x32_bf16 v[240:243],a[136:139],v[48:51],v[240:243]
ds_write2st64_b64 v36,v[208:209],v[224:225] offset0:12 offset1:14
v_mfma_f32_16x16x32_bf16 v[144:147],a[136:139],v[52:55],v[144:147]
v_sub_u32 v36,v36,v19
v_cvt_pk_bf16_f32 v220,v220,v221
v_mfma_f32_16x16x32_bf16 v[148:151],a[140:143],v[52:55],v[148:151]
v_cvt_pk_bf16_f32 v221,v222,v223
v_cvt_pk_bf16_f32 v72,v72,v73
v_mfma_f32_16x16x32_bf16 a[196:199],a[140:143],v[56:59],a[196:199]
v_cvt_pk_bf16_f32 v217,v218,v219
ds_write2st64_b64 v37,v[212:213],v[228:229] offset0:12 offset1:14
v_pk_mul_f32 v[246:247],v[246:247],v[62:63] op_sel_hi:[1,0]
v_pk_mul_f32 v[116:117],v[116:117],v[64:65] op_sel_hi:[1,0]
v_pk_mul_f32 v[112:113],v[112:113],v[64:65] op_sel_hi:[1,0]
v_pk_mul_f32 v[114:115],v[114:115],v[64:65] op_sel_hi:[1,0]
v_pk_mul_f32 v[240:241],v[240:241],v[62:63] op_sel_hi:[1,0]
v_pk_mul_f32 v[242:243],v[242:243],v[62:63] op_sel_hi:[1,0]
v_pk_mul_f32 v[244:245],v[244:245],v[62:63] op_sel_hi:[1,0]
v_pk_mul_f32 v[118:119],v[118:119],v[64:65] op_sel_hi:[1,0]
v_sub_u32 v37,v37,v19
v_cvt_pk_bf16_f32 v76,v76,v77
v_mfma_f32_16x16x32_bf16 a[192:195],a[136:139],v[56:59],a[192:195]
s_waitcnt vmcnt(15)
ds_read_b128 a[68:71],v12 offset:12544
v_cvt_pk_bf16_f32 v77,v78,v79
v_mfma_f32_16x16x32_bf16 a[200:203],a[144:147],v[56:59],a[200:203]
ds_read_b128 a[64:67],v11 offset:12544
v_cvt_pk_bf16_f32 v73,v74,v75
v_mfma_f32_16x16x32_bf16 a[204:207],a[148:151],v[56:59],a[204:207]
ds_read_b128 a[60:63],v12 offset:12416
v_accvgpr_read_b32 v213,a193
v_mfma_f32_16x16x32_bf16 v[156:159],a[148:151],v[52:55],v[156:159]
ds_read_b128 a[56:59],v11 offset:12416
v_accvgpr_read_b32 v215,a195
v_mfma_f32_16x16x32_bf16 v[152:155],a[144:147],v[52:55],v[152:155]
ds_read_b128 a[52:55],v12 offset:12288
v_accvgpr_read_b32 v214,a194
v_mfma_f32_16x16x32_bf16 v[248:251],a[144:147],v[48:51],v[248:251]
ds_read_b128 a[48:51],v11 offset:12288
v_accvgpr_read_b32 v212,a192
ds_write2st64_b64 v38,v[216:217],v[232:233] offset0:12 offset1:14
v_mfma_f32_16x16x32_bf16 v[252:255],a[148:151],v[48:51],v[252:255]
v_sub_u32 v38,v38,v19
v_accvgpr_read_b32 v228,a196
v_mfma_f32_16x16x32_bf16 v[204:207],a[148:151],v[44:47],v[204:207]
v_accvgpr_read_b32 v231,a199
v_accvgpr_read_b32 v230,a198
v_mfma_f32_16x16x32_bf16 v[200:203],a[144:147],v[44:47],v[200:203]
v_accvgpr_read_b32 v229,a197
ds_write2st64_b64 v39,v[220:221],v[236:237] offset0:12 offset1:14
v_pk_mul_f32 v[248:249],v[248:249],v[62:63] op_sel_hi:[1,0]
v_pk_mul_f32 v[122:123],v[122:123],v[64:65] op_sel_hi:[1,0]
v_pk_mul_f32 v[120:121],v[120:121],v[64:65] op_sel_hi:[1,0]
v_pk_mul_f32 v[250:251],v[250:251],v[62:63] op_sel_hi:[1,0]
v_sub_u32 v39,v39,v19
v_cvt_pk_bf16_f32 v84,v84,v85
v_accvgpr_read_b32 v217,a201
v_cvt_pk_bf16_f32 v80,v80,v81
v_cvt_pk_bf16_f32 v85,v86,v87
v_cvt_pk_bf16_f32 v81,v82,v83
v_accvgpr_read_b32 v218,a202
ds_write2st64_b64 v36,v[72:73],v[76:77] offset0:36 offset1:40
v_add_u32 v36,v36,v19
v_accvgpr_read_b32 v219,a203
v_accvgpr_read_b32 v216,a200
v_add_f32 v60,v60,v61
v_rcp_f32 v60,v60
v_accvgpr_read_b32 v235,a207
v_min3_f32 v61,v60,v62,v64
v_min_f32 v61,v61,v66
v_cmp_nlt_f32 vcc,s37,v61
v_accvgpr_read_b32 v234,a206
ds_write2st64_b64 v37,v[80:81],v[84:85] offset0:36 offset1:40
v_add_u32 v37,v37,v19
v_accvgpr_read_b32 v232,a204
v_accvgpr_read_b32 v233,a205
v_cvt_pk_bf16_f32 v92,v92,v93
v_cvt_pk_bf16_f32 v93,v94,v95
v_cvt_pk_bf16_f32 v88,v88,v89
v_cvt_pk_bf16_f32 v89,v90,v91
v_cvt_pk_bf16_f32 v100,v100,v101
v_cvt_pk_bf16_f32 v96,v96,v97
v_cvt_pk_bf16_f32 v101,v102,v103
v_cvt_pk_bf16_f32 v97,v98,v99
ds_write2st64_b64 v38,v[88:89],v[92:93] offset0:36 offset1:40
v_add_u32 v38,v38,v19
v_cvt_pk_bf16_f32 v112,v112,v113
v_cvt_pk_bf16_f32 v116,v116,v117
v_cvt_pk_bf16_f32 v120,v120,v121
v_cvt_pk_bf16_f32 v248,v248,v249
v_cvt_pk_bf16_f32 v113,v114,v115
v_cvt_pk_bf16_f32 v240,v240,v241
v_cvt_pk_bf16_f32 v121,v122,v123
v_cvt_pk_bf16_f32 v244,v244,v245
v_cvt_pk_bf16_f32 v117,v118,v119
v_cvt_pk_bf16_f32 v245,v246,v247
ds_write2st64_b64 v39,v[96:97],v[100:101] offset0:36 offset1:40
v_add_u32 v39,v39,v19
v_cvt_pk_bf16_f32 v241,v242,v243
v_cvt_pk_bf16_f32 v249,v250,v251
ds_read_b128 v[104:107],v10 offset:18432
v_mov_b32 v61,0
ds_read_b128 v[108:111],v10 offset:19456
v_mov_b32 v65,0
ds_read_b128 v[208:211],v10 offset:20480
v_mov_b32 v67,0
ds_read_b128 v[224:227],v10 offset:21504
v_mov_b32 v63,0
ds_write2st64_b64 v36,v[240:241],v[112:113] offset0:16 offset1:24
s_waitcnt vmcnt(0)
s_barrier
ds_read_b128 a[140:143],v1 offset:256
v_sub_u32 v36,v36,v19
ds_read_b128 a[136:139],v0 offset:256
s_waitcnt lgkmcnt(6)
buffer_store_dwordx4 v[104:107],v9,s[16:19],s87 offen offset:0 nt
ds_read_b128 a[132:135],v1 offset:128
s_cmp_lg_u64 vcc,0
ds_read_b128 a[128:131],v0 offset:128
s_cselect_b32 s62,s32,0
ds_read_b128 a[124:127],v1 offset:0
s_or_b32 s31,s31,s62
ds_write2st64_b64 v37,v[244:245],v[116:117] offset0:16 offset1:24
v_sub_u32 v37,v37,v19
s_lshl_b32 s32,s32,1
s_add_u32 m0,s23,0
ds_read_b128 a[120:123],v0 offset:0
s_waitcnt lgkmcnt(6)
v_mfma_f32_16x16x32_bf16 v[72:75],a[140:143],a[20:23],0
buffer_load_dwordx4 v6,s[8:11],s25 offen offset:0 lds
ds_write2st64_b64 v38,v[248:249],v[120:121] offset0:16 offset1:24
v_pk_mul_f32 v[252:253],v[252:253],v[62:63] op_sel_hi:[1,0]
v_pk_mul_f32 v[254:255],v[254:255],v[62:63] op_sel_hi:[1,0]
v_pk_mul_f32 v[126:127],v[126:127],v[64:65] op_sel_hi:[1,0]
ds_read_b128 a[144:147],v0 offset:6144
buffer_store_dwordx4 v[108:111],v9,s[16:19],s87 offen offset:3072 nt
ds_read_b128 a[148:151],v1 offset:6144
v_pk_mul_f32 v[212:213],v[212:213],v[66:67] op_sel_hi:[1,0]
v_pk_mul_f32 v[214:215],v[214:215],v[66:67] op_sel_hi:[1,0]
v_pk_mul_f32 v[124:125],v[124:125],v[64:65] op_sel_hi:[1,0]
v_sub_u32 v38,v38,v19
v_cvt_pk_bf16_f32 v252,v252,v253
s_waitcnt lgkmcnt(4)
v_mfma_f32_16x16x32_bf16 v[72:75],a[136:139],a[16:19],v[72:75]
v_cvt_pk_bf16_f32 v124,v124,v125
buffer_load_dwordx4 v7,s[8:11],s25 offen offset:1024 lds
buffer_store_dwordx4 v[208:211],v9,s[16:19],s87 offen offset:128 nt
v_pk_mul_f32 v[230:231],v[230:231],v[66:67] op_sel_hi:[1,0]
v_pk_mul_f32 v[228:229],v[228:229],v[66:67] op_sel_hi:[1,0]
v_cvt_pk_bf16_f32 v253,v254,v255
v_cvt_pk_bf16_f32 v228,v228,v229
v_mfma_f32_16x16x32_bf16 v[72:75],a[132:135],a[12:15],v[72:75]
v_cvt_pk_bf16_f32 v125,v126,v127
v_cvt_pk_bf16_f32 v229,v230,v231
v_mfma_f32_16x16x32_bf16 v[72:75],a[128:131],a[8:11],v[72:75]
v_cvt_pk_bf16_f32 v212,v212,v213
v_cvt_pk_bf16_f32 v213,v214,v215
v_mfma_f32_16x16x32_bf16 v[72:75],a[124:127],a[4:7],v[72:75]
s_waitcnt lgkmcnt(0)
ds_write2st64_b64 v39,v[252:253],v[124:125] offset0:16 offset1:24
v_mfma_f32_16x16x32_bf16 v[72:75],a[120:123],a[0:3],v[72:75]
v_sub_u32 v39,v39,v19
buffer_load_dwordx4 v8,s[8:11],s25 offen offset:2048 lds
buffer_store_dwordx4 v[224:227],v9,s[16:19],s87 offen offset:3200 nt
v_pk_mul_f32 v[218:219],v[218:219],v[66:67] op_sel_hi:[1,0]
v_pk_mul_f32 v[216:217],v[216:217],v[66:67] op_sel_hi:[1,0]
v_mov_b32 v62,0
v_cvt_pk_bf16_f32 v216,v216,v217
v_mfma_f32_16x16x32_bf16 v[80:83],a[120:123],a[24:27],0
s_waitcnt vmcnt(10)
ds_read_b128 a[72:75],v11 offset:0
v_max3_f32 v44,v72,v73,v74
v_mfma_f32_16x16x32_bf16 v[80:83],a[124:127],a[28:31],v[80:83]
s_mov_b32 s27,s42
ds_read_b128 a[76:79],v12 offset:0
v_cvt_pk_bf16_f32 v217,v218,v219
v_mfma_f32_16x16x32_bf16 v[80:83],a[128:131],a[32:35],v[80:83]
s_mov_b32 s42,s41
ds_read_b128 a[80:83],v11 offset:128
s_add_u32 s69,s69,1
ds_read_b128 a[84:87],v12 offset:128
v_pk_mul_f32 v[232:233],v[232:233],v[66:67] op_sel_hi:[1,0]
ds_read_b128 a[88:91],v11 offset:256
v_pk_mul_f32 v[234:235],v[234:235],v[66:67] op_sel_hi:[1,0]
v_cvt_pk_bf16_f32 v232,v232,v233
v_cvt_pk_bf16_f32 v233,v234,v235
v_mfma_f32_16x16x32_bf16 v[80:83],a[132:135],a[36:39],v[80:83]
s_lshl_b32 s62,s69,5
ds_read_b128 a[92:95],v12 offset:256
v_mov_b32 v66,0
ds_write_b64 v36,v[212:213] offset:18432
v_mfma_f32_16x16x32_bf16 v[80:83],a[136:139],a[40:43],v[80:83]
s_add_u32 s62,s62,s34
v_add_u32 v36,v36,v19
s_mul_i32 s63,s62,171
v_mfma_f32_16x16x32_bf16 v[80:83],a[140:143],a[44:47],v[80:83]
s_lshr_b32 s63,s63,9
ds_write_b64 v37,v[228:229] offset:18432
v_add_u32 v37,v37,v19
s_mul_i32 s64,s63,3
v_pk_mul_f32 v[146:147],v[146:147],v[64:65] op_sel_hi:[1,0]
v_pk_mul_f32 v[144:145],v[144:145],v[64:65] op_sel_hi:[1,0]
ds_write_b64 v38,v[216:217] offset:18432
v_pk_mul_f32 v[128:129],v[128:129],v[64:65] op_sel_hi:[1,0]
v_pk_mul_f32 v[130:131],v[130:131],v[64:65] op_sel_hi:[1,0]
v_add_u32 v38,v38,v19
v_max3_f32 v48,v80,v81,v82
v_mfma_f32_16x16x32_bf16 v[88:91],a[140:143],a[68:71],0
s_sub_u32 s62,s62,s64
ds_write_b64 v39,v[232:233] offset:18432
v_mfma_f32_16x16x32_bf16 v[88:91],a[136:139],a[64:67],v[88:91]
s_add_u32 s63,s63,s33
ds_read_b128 v[220:223],v10 offset:18432
v_add_u32 v39,v39,v19
v_mfma_f32_16x16x32_bf16 v[88:91],a[132:135],a[60:63],v[88:91]
s_mul_i32 s30,s63,196608
ds_read_b128 v[236:239],v10 offset:19456
v_cvt_pk_bf16_f32 v128,v128,v129
v_cvt_pk_bf16_f32 v144,v144,v145
v_cvt_pk_bf16_f32 v129,v130,v131
v_cvt_pk_bf16_f32 v145,v146,v147
ds_write2st64_b64 v36,v[128:129],v[144:145] offset0:26 offset1:28
v_pk_mul_f32 v[132:133],v[132:133],v[64:65] op_sel_hi:[1,0]
v_pk_mul_f32 v[150:151],v[150:151],v[64:65] op_sel_hi:[1,0]
v_pk_mul_f32 v[148:149],v[148:149],v[64:65] op_sel_hi:[1,0]
v_pk_mul_f32 v[134:135],v[134:135],v[64:65] op_sel_hi:[1,0]
v_cvt_pk_bf16_f32 v132,v132,v133
v_cvt_pk_bf16_f32 v148,v148,v149
v_mfma_f32_16x16x32_bf16 v[88:91],a[128:131],a[56:59],v[88:91]
s_mul_i32 s41,s63,325632
v_cvt_pk_bf16_f32 v149,v150,v151
v_cvt_pk_bf16_f32 v133,v134,v135
v_mfma_f32_16x16x32_bf16 v[88:91],a[124:127],a[52:55],v[88:91]
s_lshl_b32 s63,s3,2
s_add_u32 s64,s63,21
ds_write2st64_b64 v37,v[132:133],v[148:149] offset0:26 offset1:28
v_mfma_f32_16x16x32_bf16 v[88:91],a[120:123],a[48:51],v[88:91]
s_cmp_eq_u32 s3,0
s_cselect_b32 s64,20,s64
s_cselect_b32 s40,1,0
s_waitcnt lgkmcnt(2)
v_mfma_f32_16x16x32_bf16 v[96:99],a[120:123],a[72:75],0
s_add_u32 s65,s63,37
buffer_store_dwordx4 v[220:223],v9,s[16:19],s87 offen offset:256 nt
ds_read_b128 a[120:123],v0 offset:6272
s_cmp_eq_u32 s62,2
v_pk_mul_f32 v[138:139],v[138:139],v[64:65] op_sel_hi:[1,0]
v_pk_mul_f32 v[154:155],v[154:155],v[64:65] op_sel_hi:[1,0]
v_pk_mul_f32 v[136:137],v[136:137],v[64:65] op_sel_hi:[1,0]
v_pk_mul_f32 v[152:153],v[152:153],v[64:65] op_sel_hi:[1,0]
v_max3_f32 v52,v88,v89,v90
v_cvt_pk_bf16_f32 v152,v152,v153
v_mfma_f32_16x16x32_bf16 v[96:99],a[124:127],a[76:79],v[96:99]
s_cselect_b32 s64,s65,s64
ds_read_b128 a[124:127],v1 offset:6272
v_cvt_pk_bf16_f32 v136,v136,v137
v_mfma_f32_16x16x32_bf16 v[96:99],a[128:131],a[80:83],v[96:99]
s_cselect_b32 s40,0,s40
ds_read_b128 a[128:131],v0 offset:6400
buffer_store_dwordx4 v[236:239],v9,s[16:19],s87 offen offset:3328 nt
v_cvt_pk_bf16_f32 v137,v138,v139
v_cvt_pk_bf16_f32 v153,v154,v155
s_add_u32 s65,s63,s3
v_mfma_f32_16x16x32_bf16 v[96:99],a[132:135],a[84:87],v[96:99]
s_cmp_eq_u32 s62,0
ds_read_b128 a[132:135],v1 offset:6400
s_cselect_b32 s64,s65,s64
s_cselect_b32 s40,1,s40
s_mul_i32 s64,s64,6144
ds_write2st64_b64 v38,v[136:137],v[152:153] offset0:26 offset1:28
v_pk_mul_f32 v[156:157],v[156:157],v[64:65] op_sel_hi:[1,0]
v_pk_mul_f32 v[140:141],v[140:141],v[64:65] op_sel_hi:[1,0]
v_pk_mul_f32 v[158:159],v[158:159],v[64:65] op_sel_hi:[1,0]
v_pk_mul_f32 v[142:143],v[142:143],v[64:65] op_sel_hi:[1,0]
v_cvt_pk_bf16_f32 v156,v156,v157
v_cvt_pk_bf16_f32 v140,v140,v141
v_mfma_f32_16x16x32_bf16 v[96:99],a[136:139],a[88:91],v[96:99]
s_add_u32 s41,s41,s64
ds_read_b128 a[136:139],v0 offset:12288
v_cvt_pk_bf16_f32 v157,v158,v159
v_mfma_f32_16x16x32_bf16 v[96:99],a[140:143],a[92:95],v[96:99]
s_cmp_ge_u32 s69,6
ds_read_b128 a[140:143],v1 offset:12288
v_cvt_pk_bf16_f32 v141,v142,v143
v_mfma_f32_16x16x32_bf16 v[76:79],a[144:147],a[0:3],0
s_cselect_b32 s41,166723584,s41
ds_write2st64_b64 v39,v[140:141],v[156:157] offset0:26 offset1:28
v_pk_mul_f32 v[176:177],v[176:177],v[60:61] op_sel_hi:[1,0]
v_pk_mul_f32 v[178:179],v[178:179],v[60:61] op_sel_hi:[1,0]
v_pk_mul_f32 v[160:161],v[160:161],v[60:61] op_sel_hi:[1,0]
v_pk_mul_f32 v[162:163],v[162:163],v[60:61] op_sel_hi:[1,0]
v_max3_f32 v56,v96,v97,v98
v_cvt_pk_bf16_f32 v176,v176,v177
v_mfma_f32_16x16x32_bf16 v[76:79],a[148:151],a[4:7],v[76:79]
s_cselect_b32 s30,100663296,s30
v_cvt_pk_bf16_f32 v177,v178,v179
v_cvt_pk_bf16_f32 v160,v160,v161
s_waitcnt lgkmcnt(3)
v_mfma_f32_16x16x32_bf16 v[76:79],a[120:123],a[8:11],v[76:79]
s_add_u32 s25,s30,s22
v_cvt_pk_bf16_f32 v161,v162,v163
v_mov_b32 v64,0
v_mfma_f32_16x16x32_bf16 v[76:79],a[124:127],a[12:15],v[76:79]
s_add_u32 s26,s25,12288
ds_write2st64_b64 v36,v[160:161],v[176:177] offset0:0 offset1:2
v_pk_mul_f32 v[166:167],v[166:167],v[60:61] op_sel_hi:[1,0]
v_pk_mul_f32 v[180:181],v[180:181],v[60:61] op_sel_hi:[1,0]
v_pk_mul_f32 v[164:165],v[164:165],v[60:61] op_sel_hi:[1,0]
v_pk_mul_f32 v[182:183],v[182:183],v[60:61] op_sel_hi:[1,0]
v_cvt_pk_bf16_f32 v180,v180,v181
v_cvt_pk_bf16_f32 v181,v182,v183
v_mfma_f32_16x16x32_bf16 v[76:79],a[128:131],a[16:19],v[76:79]
s_add_u32 m0,s23,24576
v_cvt_pk_bf16_f32 v164,v164,v165
v_cvt_pk_bf16_f32 v165,v166,v167
v_mfma_f32_16x16x32_bf16 v[76:79],a[132:135],a[20:23],v[76:79]
s_mov_b32 s28,s41
s_mov_b32 s29,s24
ds_write2st64_b64 v37,v[164:165],v[180:181] offset0:0 offset1:2
v_mfma_f32_16x16x32_bf16 v[84:87],a[132:135],a[44:47],0
v_mfma_f32_16x16x32_bf16 v[84:87],a[128:131],a[40:43],v[84:87]
buffer_load_dwordx4 v6,s[8:11],s21 offen offset:0 lds
v_pk_mul_f32 v[186:187],v[186:187],v[60:61] op_sel_hi:[1,0]
v_pk_mul_f32 v[184:185],v[184:185],v[60:61] op_sel_hi:[1,0]
v_pk_mul_f32 v[170:171],v[170:171],v[60:61] op_sel_hi:[1,0]
v_pk_mul_f32 v[168:169],v[168:169],v[60:61] op_sel_hi:[1,0]
v_max3_f32 v44,v44,v75,v76
v_max3_f32 v44,v44,v77,v78
v_mfma_f32_16x16x32_bf16 v[84:87],a[124:127],a[36:39],v[84:87]
v_max_f32 v44,v44,v79
v_mov_b32 v45,v44
v_mfma_f32_16x16x32_bf16 v[84:87],a[120:123],a[32:35],v[84:87]
v_cvt_pk_bf16_f32 v168,v168,v169
v_permlane32_swap_b32 v45,v44
v_mfma_f32_16x16x32_bf16 v[84:87],a[148:151],a[28:31],v[84:87]
v_max_f32 v44,v44,v45
v_mov_b32 v45,v44
v_cvt_pk_bf16_f32 v184,v184,v185
v_cvt_pk_bf16_f32 v185,v186,v187
v_permlane16_swap_b32 v45,v44
v_pk_mul_f32 v[174:175],v[174:175],v[60:61] op_sel_hi:[1,0]
v_pk_mul_f32 v[188:189],v[188:189],v[60:61] op_sel_hi:[1,0]
v_pk_mul_f32 v[172:173],v[172:173],v[60:61] op_sel_hi:[1,0]
v_pk_mul_f32 v[190:191],v[190:191],v[60:61] op_sel_hi:[1,0]
v_max_f32 v44,v44,v45
v_mul_f32_e64 v13,-s36,v44
v_mfma_f32_16x16x32_bf16 v[84:87],a[144:147],a[24:27],v[84:87]
buffer_load_dwordx4 v7,s[8:11],s21 offen offset:1024 lds
v_mfma_f32_16x16x32_bf16 v[92:95],a[144:147],a[48:51],0
v_fma_f32 v72,v72,s36,v13
v_fma_f32 v73,v73,s36,v13
v_mfma_f32_16x16x32_bf16 v[92:95],a[148:151],a[52:55],v[92:95]
v_fma_f32 v74,v74,s36,v13
v_exp_f32 v74,v74
v_fma_f32 v75,v75,s36,v13
v_exp_f32 v72,v72
v_pk_mul_f32 v[194:195],v[194:195],v[60:61] op_sel_hi:[1,0]
v_pk_mul_f32 v[192:193],v[192:193],v[60:61] op_sel_hi:[1,0]
v_exp_f32 v73,v73
v_exp_f32 v75,v75
v_mfma_f32_16x16x32_bf16 v[92:95],a[120:123],a[56:59],v[92:95]
v_cvt_pk_bf16_f32 v21,v74,v75
v_cvt_pk_bf16_f32 v20,v72,v73
v_mfma_f32_16x16x32_bf16 v[92:95],a[124:127],a[60:63],v[92:95]
v_max3_f32 v48,v48,v83,v84
v_max3_f32 v48,v48,v85,v86
v_mfma_f32_16x16x32_bf16 v[92:95],a[128:131],a[64:67],v[92:95]
buffer_load_dwordx4 v8,s[8:11],s21 offen offset:2048 lds
v_max_f32 v48,v48,v87
v_mov_b32 v49,v48
v_pk_mul_f32 v[196:197],v[196:197],v[60:61] op_sel_hi:[1,0]
v_pk_mul_f32 v[198:199],v[198:199],v[60:61] op_sel_hi:[1,0]
v_permlane32_swap_b32 v49,v48
v_max_f32 v48,v48,v49
v_mfma_f32_16x16x32_bf16 v[92:95],a[132:135],a[68:71],v[92:95]
s_add_u32 s21,s21,12288
v_mov_b32 v49,v48
v_fma_f32 v79,v79,s36,v13
v_mfma_f32_16x16x32_bf16 v[100:103],a[132:135],a[92:95],0
s_add_u32 m0,s22,0
ds_read_b128 a[132:135],v1 offset:18432
v_permlane16_swap_b32 v49,v48
v_mfma_f32_16x16x32_bf16 v[100:103],a[128:131],a[88:91],v[100:103]
ds_read_b128 a[128:131],v0 offset:18432
v_max_f32 v48,v48,v49
v_mfma_f32_16x16x32_bf16 v[100:103],a[124:127],a[84:87],v[100:103]
ds_read_b128 a[124:127],v1 offset:12544
v_mul_f32_e64 v14,-s36,v48
v_fma_f32 v81,v81,s36,v14
v_fma_f32 v80,v80,s36,v14
v_exp_f32 v81,v81
v_pk_mul_f32 v[200:201],v[200:201],v[60:61] op_sel_hi:[1,0]
v_pk_mul_f32 v[202:203],v[202:203],v[60:61] op_sel_hi:[1,0]
v_fma_f32 v83,v83,s36,v14
v_exp_f32 v80,v80
v_mfma_f32_16x16x32_bf16 v[100:103],a[120:123],a[80:83],v[100:103]
ds_read_b128 a[120:123],v0 offset:12544
v_fma_f32 v82,v82,s36,v14
v_mfma_f32_16x16x32_bf16 v[100:103],a[148:151],a[76:79],v[100:103]
ds_read_b128 a[148:151],v1 offset:12416
v_exp_f32 v82,v82
v_mfma_f32_16x16x32_bf16 v[100:103],a[144:147],a[72:75],v[100:103]
ds_read_b128 a[144:147],v0 offset:12416
v_exp_f32 v83,v83
v_cvt_pk_bf16_f32 v24,v80,v81
v_cvt_pk_bf16_f32 v25,v82,v83
v_pk_mul_f32 v[206:207],v[206:207],v[60:61] op_sel_hi:[1,0]
v_pk_mul_f32 v[204:205],v[204:205],v[60:61] op_sel_hi:[1,0]
v_max3_f32 v52,v52,v91,v92
v_max3_f32 v52,v52,v93,v94
s_waitcnt lgkmcnt(3)
v_mfma_f32_16x16x32_bf16 v[72:75],a[124:127],a[20:23],0
v_max_f32 v52,v52,v95
v_mov_b32 v53,v52
v_max3_f32 v56,v56,v99,v100
v_max3_f32 v56,v56,v101,v102
v_permlane32_swap_b32 v53,v52
v_max_f32 v52,v52,v53
v_mov_b32 v53,v52
v_max_f32 v56,v56,v103
v_mov_b32 v57,v56
s_waitcnt lgkmcnt(2)
v_mfma_f32_16x16x32_bf16 v[72:75],a[120:123],a[16:19],v[72:75]
s_waitcnt lgkmcnt(1)
v_permlane16_swap_b32 v53,v52
v_mfma_f32_16x16x32_bf16 v[72:75],a[148:151],a[12:15],v[72:75]
s_waitcnt lgkmcnt(0)
v_max_f32 v52,v52,v53
v_mul_f32_e64 v15,-s36,v52
v_fma_f32 v89,v89,s36,v15
v_mfma_f32_16x16x32_bf16 v[72:75],a[144:147],a[8:11],v[72:75]
v_fma_f32 v88,v88,s36,v15
v_fma_f32 v90,v90,s36,v15
v_mfma_f32_16x16x32_bf16 v[72:75],a[140:143],a[4:7],v[72:75]
v_exp_f32 v89,v89
v_mfma_f32_16x16x32_bf16 v[72:75],a[136:139],a[0:3],v[72:75]
v_fma_f32 v91,v91,s36,v15
v_exp_f32 v91,v91
v_mfma_f32_16x16x32_bf16 v[80:83],a[136:139],a[24:27],0
v_exp_f32 v88,v88
v_mfma_f32_16x16x32_bf16 v[80:83],a[140:143],a[28:31],v[80:83]
v_exp_f32 v90,v90
v_mfma_f32_16x16x32_bf16 v[80:83],a[144:147],a[32:35],v[80:83]
v_cvt_pk_bf16_f32 v28,v88,v89
v_cvt_pk_bf16_f32 v29,v90,v91
v_mfma_f32_16x16x32_bf16 v[80:83],a[148:151],a[36:39],v[80:83]
v_permlane32_swap_b32 v57,v56
v_mfma_f32_16x16x32_bf16 v[80:83],a[120:123],a[40:43],v[80:83]
v_max_f32 v56,v56,v57
v_mov_b32 v57,v56
v_mfma_f32_16x16x32_bf16 v[80:83],a[124:127],a[44:47],v[80:83]
v_fma_f32 v77,v77,s36,v13
v_permlane16_swap_b32 v57,v56
v_mfma_f32_16x16x32_bf16 v[88:91],a[124:127],a[68:71],0
v_max_f32 v56,v56,v57
v_mul_f32_e64 v16,-s36,v56
v_mfma_f32_16x16x32_bf16 v[88:91],a[120:123],a[64:67],v[88:91]
v_fma_f32 v98,v98,s36,v16
v_fma_f32 v99,v99,s36,v16
v_mfma_f32_16x16x32_bf16 v[88:91],a[148:151],a[60:63],v[88:91]
v_fma_f32 v97,v97,s36,v16
v_exp_f32 v98,v98
v_mfma_f32_16x16x32_bf16 v[88:91],a[144:147],a[56:59],v[88:91]
v_fma_f32 v96,v96,s36,v16
v_exp_f32 v99,v99
v_mfma_f32_16x16x32_bf16 v[88:91],a[140:143],a[52:55],v[88:91]
v_exp_f32 v96,v96
v_mfma_f32_16x16x32_bf16 v[88:91],a[136:139],a[48:51],v[88:91]
v_cvt_pk_bf16_f32 v33,v98,v99
v_exp_f32 v97,v97
v_fma_f32 v78,v78,s36,v13
v_cvt_pk_bf16_f32 v32,v96,v97
v_mfma_f32_16x16x32_bf16 v[96:99],a[136:139],a[72:75],0
ds_read_b128 a[136:139],v0 offset:18560
v_exp_f32 v77,v77
v_mfma_f32_16x16x32_bf16 v[96:99],a[140:143],a[76:79],v[96:99]
ds_read_b128 a[140:143],v1 offset:18560
v_exp_f32 v78,v78
v_mfma_f32_16x16x32_bf16 v[96:99],a[144:147],a[80:83],v[96:99]
ds_read_b128 a[144:147],v0 offset:18688
v_exp_f32 v79,v79
v_mfma_f32_16x16x32_bf16 v[96:99],a[148:151],a[84:87],v[96:99]
ds_read_b128 a[148:151],v1 offset:18688
v_fma_f32 v76,v76,s36,v13
v_mfma_f32_16x16x32_bf16 v[96:99],a[120:123],a[88:91],v[96:99]
v_exp_f32 v76,v76
v_mfma_f32_16x16x32_bf16 v[96:99],a[124:127],a[92:95],v[96:99]
v_cvt_pk_bf16_f32 v22,v76,v77
v_cvt_pk_bf16_f32 v23,v78,v79
v_mfma_f32_16x16x32_bf16 v[76:79],a[128:131],a[0:3],0
v_fma_f32 v84,v84,s36,v14
v_fma_f32 v87,v87,s36,v14
v_mfma_f32_16x16x32_bf16 v[76:79],a[132:135],a[4:7],v[76:79]
s_waitcnt lgkmcnt(3)
v_fma_f32 v86,v86,s36,v14
v_exp_f32 v86,v86
v_mfma_f32_16x16x32_bf16 v[76:79],a[136:139],a[8:11],v[76:79]
s_waitcnt lgkmcnt(1)
v_fma_f32 v85,v85,s36,v14
v_exp_f32 v87,v87
v_mfma_f32_16x16x32_bf16 v[76:79],a[140:143],a[12:15],v[76:79]
v_exp_f32 v84,v84
v_mfma_f32_16x16x32_bf16 v[76:79],a[144:147],a[16:19],v[76:79]
s_waitcnt lgkmcnt(0)
v_exp_f32 v85,v85
v_mfma_f32_16x16x32_bf16 v[76:79],a[148:151],a[20:23],v[76:79]
v_cvt_pk_bf16_f32 v27,v86,v87
v_cvt_pk_bf16_f32 v26,v84,v85
v_mfma_f32_16x16x32_bf16 v[84:87],a[148:151],a[44:47],0
v_fma_f32 v93,v93,s36,v15
v_exp_f32 v93,v93
v_mfma_f32_16x16x32_bf16 v[84:87],a[144:147],a[40:43],v[84:87]
v_fma_f32 v94,v94,s36,v15
v_fma_f32 v92,v92,s36,v15
v_mfma_f32_16x16x32_bf16 v[84:87],a[140:143],a[36:39],v[84:87]
v_fma_f32 v95,v95,s36,v15
v_exp_f32 v95,v95
v_mfma_f32_16x16x32_bf16 v[84:87],a[136:139],a[32:35],v[84:87]
v_exp_f32 v94,v94
s_waitcnt vmcnt(6)
s_barrier
v_mfma_f32_16x16x32_bf16 v[84:87],a[132:135],a[28:31],v[84:87]
buffer_load_dwordx4 v6,s[4:7],s20 offen offset:0 lds
v_mfma_f32_16x16x32_bf16 v[84:87],a[128:131],a[24:27],v[84:87]
v_exp_f32 v92,v92
v_cvt_pk_bf16_f32 v31,v94,v95
v_cvt_pk_bf16_f32 v30,v92,v93
v_mfma_f32_16x16x32_bf16 v[92:95],a[128:131],a[48:51],0
v_fma_f32 v100,v100,s36,v16
v_fma_f32 v102,v102,s36,v16
v_mfma_f32_16x16x32_bf16 v[92:95],a[132:135],a[52:55],v[92:95]
v_exp_f32 v100,v100
v_mfma_f32_16x16x32_bf16 v[92:95],a[136:139],a[56:59],v[92:95]
v_fma_f32 v103,v103,s36,v16
v_exp_f32 v103,v103
v_mfma_f32_16x16x32_bf16 v[92:95],a[140:143],a[60:63],v[92:95]
buffer_load_dwordx4 v7,s[4:7],s20 offen offset:1024 lds
v_mfma_f32_16x16x32_bf16 v[92:95],a[144:147],a[64:67],v[92:95]
v_fma_f32 v101,v101,s36,v16
v_exp_f32 v102,v102
v_mfma_f32_16x16x32_bf16 v[92:95],a[148:151],a[68:71],v[92:95]
v_exp_f32 v101,v101
v_cvt_pk_bf16_f32 v35,v102,v103
ds_read_b64_tr_b16 a[120:121],v2 offset:0
ds_read_b64_tr_b16 a[122:123],v2 offset:6144
v_cvt_pk_bf16_f32 v34,v100,v101
v_mfma_f32_16x16x32_bf16 v[100:103],a[148:151],a[92:95],0
v_cvt_pk_bf16_f32 v172,v172,v173
v_cvt_pk_bf16_f32 v192,v192,v193
v_smfmac_f32_16x16x64_bf16 v[64:67],a[152:155],v[28:35],v18
buffer_load_dwordx4 v8,s[4:7],s20 offen offset:2048 lds
v_mfma_f32_16x16x32_bf16 v[100:103],a[144:147],a[88:91],v[100:103]
s_add_u32 s20,s20,12288
ds_read_b64_tr_b16 a[126:127],v3 offset:6144
v_fma_f32 v81,v81,s36,v14
v_mfma_f32_16x16x32_bf16 v[100:103],a[140:143],a[84:87],v[100:103]
ds_read_b64_tr_b16 a[124:125],v3 offset:0
v_cvt_pk_bf16_f32 v196,v196,v197
v_mfma_f32_16x16x32_bf16 v[100:103],a[136:139],a[80:83],v[100:103]
v_cvt_pk_bf16_f32 v188,v188,v189
v_cvt_pk_bf16_f32 v189,v190,v191
v_mfma_f32_16x16x32_bf16 v[100:103],a[132:135],a[76:79],v[100:103]
ds_read_b64_tr_b16 a[132:133],v5 offset:0
v_cvt_pk_bf16_f32 v169,v170,v171
v_mfma_f32_16x16x32_bf16 v[100:103],a[128:131],a[72:75],v[100:103]
ds_write2st64_b64 v38,v[168:169],v[184:185] offset0:0 offset1:2
v_cvt_pk_bf16_f32 v173,v174,v175
v_mov_b32 v60,0
v_cvt_pk_bf16_f32 v200,v200,v201
v_fma_f32 v72,v72,s36,v13
v_smfmac_f32_16x16x64_bf16 v[60:63],a[152:155],v[20:27],v18
ds_read_b64_tr_b16 a[128:129],v4 offset:0
ds_read_b64_tr_b16 a[130:131],v4 offset:6144
ds_read_b64_tr_b16 a[134:135],v5 offset:6144
ds_write2st64_b64 v39,v[172:173],v[188:189] offset0:0 offset1:2
v_exp_f32 v72,v72
v_cvt_pk_bf16_f32 v193,v194,v195
v_cvt_pk_bf16_f32 v201,v202,v203
v_fma_f32 v75,v75,s36,v13
v_exp_f32 v75,v75
v_cvt_pk_bf16_f32 v204,v204,v205
v_fma_f32 v73,v73,s36,v13
v_exp_f32 v73,v73
ds_write_b64 v36,v[192:193] offset:2048
v_fma_f32 v80,v80,s36,v14
v_fma_f32 v74,v74,s36,v13
v_exp_f32 v74,v74
v_exp_f32 v80,v80
v_cvt_pk_bf16_f32 v197,v198,v199
ds_write_b64 v37,v[196:197] offset:2048
v_exp_f32 v81,v81
v_cvt_pk_bf16_f32 v205,v206,v207
v_cvt_pk_bf16_f32 v44,v72,v73
ds_write_b64 v38,v[200:201] offset:2048
v_cvt_pk_bf16_f32 v45,v74,v75
v_cvt_pk_bf16_f32 v48,v80,v81
ds_write_b64 v39,v[204:205] offset:2048
s_waitcnt lgkmcnt(3)
v_mfma_f32_16x16x32_bf16 v[160:163],a[120:123],v[20:23],0
s_add_u32 m0,s23,0
ds_read_b64_tr_b16 a[136:137],v2 offset:128
v_fma_f32 v82,v82,s36,v14
v_mfma_f32_16x16x32_bf16 v[164:167],a[124:127],v[20:23],0
ds_read_b64_tr_b16 a[138:139],v2 offset:6272
v_fma_f32 v83,v83,s36,v14
v_mfma_f32_16x16x32_bf16 v[212:215],a[124:127],v[24:27],0
ds_read_b64_tr_b16 a[140:141],v3 offset:128
v_fma_f32 v88,v88,s36,v15
v_mfma_f32_16x16x32_bf16 v[208:211],a[120:123],v[24:27],0
ds_read_b64_tr_b16 a[142:143],v3 offset:6272
v_fma_f32 v89,v89,s36,v15
v_mfma_f32_16x16x32_bf16 v[112:115],a[120:123],v[28:31],0
ds_read_b64_tr_b16 a[144:145],v4 offset:128
v_fma_f32 v90,v90,s36,v15
v_mfma_f32_16x16x32_bf16 v[116:119],a[124:127],v[28:31],0
ds_read_b64_tr_b16 a[146:147],v4 offset:6272
v_fma_f32 v91,v91,s36,v15
v_mfma_f32_16x16x32_bf16 a[164:167],a[124:127],v[32:35],0
ds_read_b64_tr_b16 a[148:149],v5 offset:128
v_fma_f32 v96,v96,s36,v16
v_mfma_f32_16x16x32_bf16 a[160:163],a[120:123],v[32:35],0
ds_read_b64_tr_b16 a[150:151],v5 offset:6272
v_fma_f32 v97,v97,s36,v16
v_mfma_f32_16x16x32_bf16 a[168:171],a[128:131],v[32:35],0
ds_read_b64_tr_b16 a[120:121],v2 offset:256
v_fma_f32 v98,v98,s36,v16
v_mfma_f32_16x16x32_bf16 a[172:175],a[132:135],v[32:35],0
ds_read_b64_tr_b16 a[122:123],v2 offset:6400
v_fma_f32 v99,v99,s36,v16
v_mfma_f32_16x16x32_bf16 v[124:127],a[132:135],v[28:31],0
ds_read_b64_tr_b16 a[124:125],v3 offset:256
v_fma_f32 v76,v76,s36,v13
v_mfma_f32_16x16x32_bf16 v[120:123],a[128:131],v[28:31],0
ds_read_b64_tr_b16 a[126:127],v3 offset:6400
v_fma_f32 v77,v77,s36,v13
v_mfma_f32_16x16x32_bf16 v[216:219],a[128:131],v[24:27],0
v_exp_f32 v82,v82
v_mfma_f32_16x16x32_bf16 v[220:223],a[132:135],v[24:27],0
v_exp_f32 v83,v83
v_mfma_f32_16x16x32_bf16 v[172:175],a[132:135],v[20:23],0
ds_read_b64_tr_b16 a[132:133],v5 offset:256
v_cvt_pk_bf16_f32 v49,v82,v83
v_mfma_f32_16x16x32_bf16 v[168:171],a[128:131],v[20:23],0
s_waitcnt lgkmcnt(4)
ds_read_b64_tr_b16 a[128:129],v4 offset:256
v_fma_f32 v78,v78,s36,v13
v_mfma_f32_16x16x32_bf16 v[176:179],a[136:139],v[20:23],0
ds_read_b64_tr_b16 a[130:131],v4 offset:6400
v_fma_f32 v79,v79,s36,v13
v_mfma_f32_16x16x32_bf16 v[180:183],a[140:143],v[20:23],0
ds_read_b64_tr_b16 a[134:135],v5 offset:6400
v_fma_f32 v84,v84,s36,v14
v_mfma_f32_16x16x32_bf16 v[228:231],a[140:143],v[24:27],0
v_exp_f32 v88,v88
v_mfma_f32_16x16x32_bf16 v[224:227],a[136:139],v[24:27],0
v_exp_f32 v89,v89
v_mfma_f32_16x16x32_bf16 v[128:131],a[136:139],v[28:31],0
v_exp_f32 v90,v90
v_mfma_f32_16x16x32_bf16 v[132:135],a[140:143],v[28:31],0
v_exp_f32 v91,v91
v_mfma_f32_16x16x32_bf16 a[180:183],a[140:143],v[32:35],0
v_cvt_pk_bf16_f32 v52,v88,v89
v_cvt_pk_bf16_f32 v53,v90,v91
v_mfma_f32_16x16x32_bf16 a[176:179],a[136:139],v[32:35],0
v_exp_f32 v96,v96
v_mfma_f32_16x16x32_bf16 a[184:187],a[144:147],v[32:35],0
v_exp_f32 v97,v97
v_mfma_f32_16x16x32_bf16 a[188:191],a[148:151],v[32:35],0
v_exp_f32 v98,v98
v_mfma_f32_16x16x32_bf16 v[140:143],a[148:151],v[28:31],0
v_exp_f32 v99,v99
v_mfma_f32_16x16x32_bf16 v[136:139],a[144:147],v[28:31],0
v_cvt_pk_bf16_f32 v56,v96,v97
v_cvt_pk_bf16_f32 v57,v98,v99
v_mfma_f32_16x16x32_bf16 v[232:235],a[144:147],v[24:27],0
v_exp_f32 v76,v76
v_mfma_f32_16x16x32_bf16 v[236:239],a[148:151],v[24:27],0
v_exp_f32 v77,v77
v_mfma_f32_16x16x32_bf16 v[188:191],a[148:151],v[20:23],0
v_exp_f32 v78,v78
v_mfma_f32_16x16x32_bf16 v[184:187],a[144:147],v[20:23],0
s_waitcnt lgkmcnt(0)
v_exp_f32 v79,v79
v_mfma_f32_16x16x32_bf16 v[192:195],a[120:123],v[20:23],0
s_waitcnt vmcnt(24)
v_cvt_pk_bf16_f32 v46,v76,v77
v_cvt_pk_bf16_f32 v47,v78,v79
v_mfma_f32_16x16x32_bf16 v[196:199],a[124:127],v[20:23],0
s_barrier
v_mfma_f32_16x16x32_bf16 v[244:247],a[124:127],v[24:27],0
ds_read_b128 a[148:151],v1 offset:24704
v_fma_f32 v85,v85,s36,v14
v_mfma_f32_16x16x32_bf16 v[240:243],a[120:123],v[24:27],0
ds_read_b128 a[144:147],v0 offset:24704
v_fma_f32 v86,v86,s36,v14
v_mfma_f32_16x16x32_bf16 v[144:147],a[120:123],v[28:31],0
ds_read_b128 a[140:143],v1 offset:24576
v_fma_f32 v87,v87,s36,v14
v_mfma_f32_16x16x32_bf16 v[148:151],a[124:127],v[28:31],0
ds_read_b128 a[136:139],v0 offset:24576
v_fma_f32 v92,v92,s36,v15
v_mfma_f32_16x16x32_bf16 a[196:199],a[124:127],v[32:35],0
ds_read_b128 a[124:127],v1 offset:24832
v_fma_f32 v93,v93,s36,v15
v_mfma_f32_16x16x32_bf16 a[192:195],a[120:123],v[32:35],0
buffer_load_dwordx4 v6,s[8:11],s21 offen offset:0 lds
v_mfma_f32_16x16x32_bf16 a[200:203],a[128:131],v[32:35],0
ds_read_b128 a[120:123],v0 offset:24832
v_fma_f32 v94,v94,s36,v15
v_mfma_f32_16x16x32_bf16 a[204:207],a[132:135],v[32:35],0
v_exp_f32 v84,v84
v_mfma_f32_16x16x32_bf16 v[156:159],a[132:135],v[28:31],0
v_exp_f32 v85,v85
v_mfma_f32_16x16x32_bf16 v[152:155],a[128:131],v[28:31],0
v_exp_f32 v86,v86
v_mfma_f32_16x16x32_bf16 v[248:251],a[128:131],v[24:27],0
v_exp_f32 v87,v87
v_mfma_f32_16x16x32_bf16 v[252:255],a[132:135],v[24:27],0
v_cvt_pk_bf16_f32 v50,v84,v85
v_cvt_pk_bf16_f32 v51,v86,v87
v_mfma_f32_16x16x32_bf16 v[204:207],a[132:135],v[20:23],0
ds_read_b128 a[132:135],v1 offset:30720
v_fma_f32 v95,v95,s36,v15
v_smfmac_f32_16x16x64_bf16 v[60:63],a[152:155],v[44:51],v18
v_fma_f32 v100,v100,s36,v16
v_mfma_f32_16x16x32_bf16 v[200:203],a[128:131],v[20:23],0
buffer_load_dwordx4 v7,s[8:11],s21 offen offset:1024 lds
s_waitcnt lgkmcnt(1)
v_mfma_f32_16x16x32_bf16 v[72:75],a[124:127],a[20:23],0
ds_read_b128 a[128:131],v0 offset:30720
v_fma_f32 v101,v101,s36,v16
v_mfma_f32_16x16x32_bf16 v[72:75],a[120:123],a[16:19],v[72:75]
v_exp_f32 v92,v92
v_mfma_f32_16x16x32_bf16 v[72:75],a[148:151],a[12:15],v[72:75]
v_exp_f32 v93,v93
v_mfma_f32_16x16x32_bf16 v[72:75],a[144:147],a[8:11],v[72:75]
v_exp_f32 v94,v94
v_mfma_f32_16x16x32_bf16 v[72:75],a[140:143],a[4:7],v[72:75]
v_exp_f32 v95,v95
v_mfma_f32_16x16x32_bf16 v[72:75],a[136:139],a[0:3],v[72:75]
v_cvt_pk_bf16_f32 v54,v92,v93
v_cvt_pk_bf16_f32 v55,v94,v95
v_mfma_f32_16x16x32_bf16 v[80:83],a[136:139],a[24:27],0
v_fma_f32 v102,v102,s36,v16
v_fma_f32 v103,v103,s36,v16
v_mfma_f32_16x16x32_bf16 v[80:83],a[140:143],a[28:31],v[80:83]
v_exp_f32 v100,v100
v_mfma_f32_16x16x32_bf16 v[80:83],a[144:147],a[32:35],v[80:83]
buffer_load_dwordx4 v8,s[8:11],s21 offen offset:2048 lds
v_mfma_f32_16x16x32_bf16 v[80:83],a[148:151],a[36:39],v[80:83]
s_add_u32 s21,s21,12288
v_exp_f32 v101,v101
v_mfma_f32_16x16x32_bf16 v[80:83],a[120:123],a[40:43],v[80:83]
s_add_u32 m0,s22,12288
v_exp_f32 v102,v102
v_mfma_f32_16x16x32_bf16 v[80:83],a[124:127],a[44:47],v[80:83]
v_exp_f32 v103,v103
v_mfma_f32_16x16x32_bf16 v[88:91],a[124:127],a[68:71],0
v_cvt_pk_bf16_f32 v58,v100,v101
v_cvt_pk_bf16_f32 v59,v102,v103
v_mfma_f32_16x16x32_bf16 v[88:91],a[120:123],a[64:67],v[88:91]
v_fma_f32 v72,v72,s36,v13
v_fma_f32 v73,v73,s36,v13
v_smfmac_f32_16x16x64_bf16 v[64:67],a[152:155],v[52:59],v18
v_fma_f32 v74,v74,s36,v13
v_mfma_f32_16x16x32_bf16 v[88:91],a[148:151],a[60:63],v[88:91]
v_fma_f32 v75,v75,s36,v13
v_fma_f32 v80,v80,s36,v14
v_mfma_f32_16x16x32_bf16 v[88:91],a[144:147],a[56:59],v[88:91]
v_fma_f32 v81,v81,s36,v14
v_mfma_f32_16x16x32_bf16 v[88:91],a[140:143],a[52:55],v[88:91]
buffer_load_dwordx4 v6,s[4:7],s20 offen offset:0 lds
v_mfma_f32_16x16x32_bf16 v[88:91],a[136:139],a[48:51],v[88:91]
v_exp_f32 v72,v72
v_mfma_f32_16x16x32_bf16 v[96:99],a[136:139],a[72:75],0
ds_read_b128 a[136:139],v0 offset:30848
v_mfma_f32_16x16x32_bf16 v[96:99],a[140:143],a[76:79],v[96:99]
ds_read_b128 a[140:143],v1 offset:30848
v_mfma_f32_16x16x32_bf16 v[96:99],a[144:147],a[80:83],v[96:99]
ds_read_b128 a[144:147],v0 offset:30976
v_mfma_f32_16x16x32_bf16 v[96:99],a[148:151],a[84:87],v[96:99]
ds_read_b128 a[148:151],v1 offset:30976
v_mfma_f32_16x16x32_bf16 v[96:99],a[120:123],a[88:91],v[96:99]
v_exp_f32 v73,v73
v_mfma_f32_16x16x32_bf16 v[96:99],a[124:127],a[92:95],v[96:99]
s_waitcnt lgkmcnt(4)
v_exp_f32 v74,v74
v_mfma_f32_16x16x32_bf16 v[76:79],a[128:131],a[0:3],0
v_exp_f32 v75,v75
v_mfma_f32_16x16x32_bf16 v[76:79],a[132:135],a[4:7],v[76:79]
buffer_load_dwordx4 v7,s[4:7],s20 offen offset:1024 lds
s_waitcnt lgkmcnt(3)
v_mfma_f32_16x16x32_bf16 v[76:79],a[136:139],a[8:11],v[76:79]
s_waitcnt lgkmcnt(2)
v_exp_f32 v80,v80
v_mfma_f32_16x16x32_bf16 v[76:79],a[140:143],a[12:15],v[76:79]
s_waitcnt lgkmcnt(0)
v_exp_f32 v81,v81
v_mfma_f32_16x16x32_bf16 v[76:79],a[144:147],a[16:19],v[76:79]
v_cvt_pk_bf16_f32 v20,v72,v73
v_cvt_pk_bf16_f32 v21,v74,v75
v_mfma_f32_16x16x32_bf16 v[76:79],a[148:151],a[20:23],v[76:79]
v_cvt_pk_bf16_f32 v24,v80,v81
v_mfma_f32_16x16x32_bf16 v[84:87],a[148:151],a[44:47],0
v_mfma_f32_16x16x32_bf16 v[84:87],a[144:147],a[40:43],v[84:87]
v_mfma_f32_16x16x32_bf16 v[84:87],a[140:143],a[36:39],v[84:87]
v_mfma_f32_16x16x32_bf16 v[84:87],a[136:139],a[32:35],v[84:87]
v_mfma_f32_16x16x32_bf16 v[84:87],a[132:135],a[28:31],v[84:87]
buffer_load_dwordx4 v8,s[4:7],s20 offen offset:2048 lds
v_mfma_f32_16x16x32_bf16 v[84:87],a[128:131],a[24:27],v[84:87]
s_add_u32 s20,s20,12288
v_mfma_f32_16x16x32_bf16 v[92:95],a[128:131],a[48:51],0
ds_read_b64_tr_b16 a[120:121],v2 offset:12288
v_mfma_f32_16x16x32_bf16 v[92:95],a[132:135],a[52:55],v[92:95]
ds_read_b64_tr_b16 a[122:123],v2 offset:18432
v_mfma_f32_16x16x32_bf16 v[92:95],a[136:139],a[56:59],v[92:95]
ds_read_b64_tr_b16 a[124:125],v3 offset:12288
v_mfma_f32_16x16x32_bf16 v[92:95],a[140:143],a[60:63],v[92:95]
ds_read_b64_tr_b16 a[126:127],v3 offset:18432
v_mfma_f32_16x16x32_bf16 v[92:95],a[144:147],a[64:67],v[92:95]
v_mfma_f32_16x16x32_bf16 v[92:95],a[148:151],a[68:71],v[92:95]
v_mfma_f32_16x16x32_bf16 v[100:103],a[148:151],a[92:95],0
v_mfma_f32_16x16x32_bf16 v[100:103],a[144:147],a[88:91],v[100:103]
v_mfma_f32_16x16x32_bf16 v[100:103],a[140:143],a[84:87],v[100:103]
v_mfma_f32_16x16x32_bf16 v[100:103],a[136:139],a[80:83],v[100:103]
v_mfma_f32_16x16x32_bf16 v[100:103],a[132:135],a[76:79],v[100:103]
ds_read_b64_tr_b16 a[132:133],v5 offset:12288
v_mfma_f32_16x16x32_bf16 v[100:103],a[128:131],a[72:75],v[100:103]
s_waitcnt lgkmcnt(1)
ds_read_b64_tr_b16 a[128:129],v4 offset:12288
ds_read_b64_tr_b16 a[130:131],v4 offset:18432
ds_read_b64_tr_b16 a[134:135],v5 offset:18432
v_mfma_f32_16x16x32_bf16 v[160:163],a[120:123],v[44:47],v[160:163]
s_add_u32 m0,s23,12288
ds_read_b64_tr_b16 a[136:137],v2 offset:12416
v_fma_f32 v82,v82,s36,v14
v_mfma_f32_16x16x32_bf16 v[164:167],a[124:127],v[44:47],v[164:167]
ds_read_b64_tr_b16 a[138:139],v2 offset:18560
v_fma_f32 v83,v83,s36,v14
v_mfma_f32_16x16x32_bf16 v[212:215],a[124:127],v[48:51],v[212:215]
ds_read_b64_tr_b16 a[140:141],v3 offset:12416
v_fma_f32 v88,v88,s36,v15
v_mfma_f32_16x16x32_bf16 v[208:211],a[120:123],v[48:51],v[208:211]
ds_read_b64_tr_b16 a[142:143],v3 offset:18560
v_fma_f32 v89,v89,s36,v15
v_mfma_f32_16x16x32_bf16 v[112:115],a[120:123],v[52:55],v[112:115]
ds_read_b64_tr_b16 a[144:145],v4 offset:12416
v_fma_f32 v90,v90,s36,v15
v_mfma_f32_16x16x32_bf16 v[116:119],a[124:127],v[52:55],v[116:119]
ds_read_b64_tr_b16 a[146:147],v4 offset:18560
v_fma_f32 v91,v91,s36,v15
v_mfma_f32_16x16x32_bf16 a[164:167],a[124:127],v[56:59],a[164:167]
ds_read_b64_tr_b16 a[148:149],v5 offset:12416
v_fma_f32 v96,v96,s36,v16
v_mfma_f32_16x16x32_bf16 a[160:163],a[120:123],v[56:59],a[160:163]
s_waitcnt lgkmcnt(6)
ds_read_b64_tr_b16 a[150:151],v5 offset:18560
v_fma_f32 v97,v97,s36,v16
v_mfma_f32_16x16x32_bf16 a[168:171],a[128:131],v[56:59],a[168:171]
ds_read_b64_tr_b16 a[120:121],v2 offset:12544
v_fma_f32 v98,v98,s36,v16
v_mfma_f32_16x16x32_bf16 a[172:175],a[132:135],v[56:59],a[172:175]
ds_read_b64_tr_b16 a[122:123],v2 offset:18688
v_fma_f32 v99,v99,s36,v16
v_mfma_f32_16x16x32_bf16 v[124:127],a[132:135],v[52:55],v[124:127]
ds_read_b64_tr_b16 a[124:125],v3 offset:12544
v_fma_f32 v76,v76,s36,v13
v_mfma_f32_16x16x32_bf16 v[120:123],a[128:131],v[52:55],v[120:123]
ds_read_b64_tr_b16 a[126:127],v3 offset:18688
v_fma_f32 v77,v77,s36,v13
v_mfma_f32_16x16x32_bf16 v[216:219],a[128:131],v[48:51],v[216:219]
v_exp_f32 v82,v82
v_mfma_f32_16x16x32_bf16 v[220:223],a[132:135],v[48:51],v[220:223]
v_exp_f32 v83,v83
v_mfma_f32_16x16x32_bf16 v[172:175],a[132:135],v[44:47],v[172:175]
ds_read_b64_tr_b16 a[132:133],v5 offset:12544
v_cvt_pk_bf16_f32 v25,v82,v83
v_mfma_f32_16x16x32_bf16 v[168:171],a[128:131],v[44:47],v[168:171]
s_waitcnt lgkmcnt(4)
ds_read_b64_tr_b16 a[128:129],v4 offset:12544
v_fma_f32 v78,v78,s36,v13
v_mfma_f32_16x16x32_bf16 v[176:179],a[136:139],v[44:47],v[176:179]
ds_read_b64_tr_b16 a[130:131],v4 offset:18688
v_fma_f32 v79,v79,s36,v13
v_mfma_f32_16x16x32_bf16 v[180:183],a[140:143],v[44:47],v[180:183]
ds_read_b64_tr_b16 a[134:135],v5 offset:18688
v_fma_f32 v84,v84,s36,v14
v_mfma_f32_16x16x32_bf16 v[228:231],a[140:143],v[48:51],v[228:231]
v_exp_f32 v88,v88
v_mfma_f32_16x16x32_bf16 v[224:227],a[136:139],v[48:51],v[224:227]
v_exp_f32 v89,v89
v_mfma_f32_16x16x32_bf16 v[128:131],a[136:139],v[52:55],v[128:131]
v_exp_f32 v90,v90
v_mfma_f32_16x16x32_bf16 v[132:135],a[140:143],v[52:55],v[132:135]
v_exp_f32 v91,v91
v_mfma_f32_16x16x32_bf16 a[180:183],a[140:143],v[56:59],a[180:183]
v_cvt_pk_bf16_f32 v28,v88,v89
v_cvt_pk_bf16_f32 v29,v90,v91
v_mfma_f32_16x16x32_bf16 a[176:179],a[136:139],v[56:59],a[176:179]
v_exp_f32 v96,v96
v_mfma_f32_16x16x32_bf16 a[184:187],a[144:147],v[56:59],a[184:187]
v_exp_f32 v97,v97
v_mfma_f32_16x16x32_bf16 a[188:191],a[148:151],v[56:59],a[188:191]
v_exp_f32 v98,v98
v_mfma_f32_16x16x32_bf16 v[140:143],a[148:151],v[52:55],v[140:143]
v_exp_f32 v99,v99
v_mfma_f32_16x16x32_bf16 v[136:139],a[144:147],v[52:55],v[136:139]
v_cvt_pk_bf16_f32 v32,v96,v97
v_cvt_pk_bf16_f32 v33,v98,v99
v_mfma_f32_16x16x32_bf16 v[232:235],a[144:147],v[48:51],v[232:235]
v_exp_f32 v76,v76
v_mfma_f32_16x16x32_bf16 v[236:239],a[148:151],v[48:51],v[236:239]
v_exp_f32 v77,v77
v_mfma_f32_16x16x32_bf16 v[188:191],a[148:151],v[44:47],v[188:191]
v_exp_f32 v78,v78
v_mfma_f32_16x16x32_bf16 v[184:187],a[144:147],v[44:47],v[184:187]
s_waitcnt lgkmcnt(0)
v_exp_f32 v79,v79
v_mfma_f32_16x16x32_bf16 v[192:195],a[120:123],v[44:47],v[192:195]
s_waitcnt vmcnt(6)
v_cvt_pk_bf16_f32 v22,v76,v77
v_cvt_pk_bf16_f32 v23,v78,v79
v_mfma_f32_16x16x32_bf16 v[196:199],a[124:127],v[44:47],v[196:199]
s_barrier
v_mfma_f32_16x16x32_bf16 v[244:247],a[124:127],v[48:51],v[244:247]
ds_read_b128 a[148:151],v1 offset:128
v_fma_f32 v85,v85,s36,v14
v_mfma_f32_16x16x32_bf16 v[240:243],a[120:123],v[48:51],v[240:243]
ds_read_b128 a[144:147],v0 offset:128
v_fma_f32 v86,v86,s36,v14
v_mfma_f32_16x16x32_bf16 v[144:147],a[120:123],v[52:55],v[144:147]
ds_read_b128 a[140:143],v1 offset:0
v_fma_f32 v87,v87,s36,v14
v_mfma_f32_16x16x32_bf16 v[148:151],a[124:127],v[52:55],v[148:151]
ds_read_b128 a[136:139],v0 offset:0
v_fma_f32 v92,v92,s36,v15
v_mfma_f32_16x16x32_bf16 a[196:199],a[124:127],v[56:59],a[196:199]
ds_read_b128 a[124:127],v1 offset:256
v_fma_f32 v93,v93,s36,v15
v_mfma_f32_16x16x32_bf16 a[192:195],a[120:123],v[56:59],a[192:195]
buffer_load_dwordx4 v6,s[8:11],s21 offen offset:0 lds
v_mfma_f32_16x16x32_bf16 a[200:203],a[128:131],v[56:59],a[200:203]
ds_read_b128 a[120:123],v0 offset:256
v_fma_f32 v94,v94,s36,v15
v_mfma_f32_16x16x32_bf16 a[204:207],a[132:135],v[56:59],a[204:207]
v_exp_f32 v84,v84
v_mfma_f32_16x16x32_bf16 v[156:159],a[132:135],v[52:55],v[156:159]
v_exp_f32 v85,v85
v_mfma_f32_16x16x32_bf16 v[152:155],a[128:131],v[52:55],v[152:155]
v_exp_f32 v86,v86
v_mfma_f32_16x16x32_bf16 v[248:251],a[128:131],v[48:51],v[248:251]
v_exp_f32 v87,v87
v_mfma_f32_16x16x32_bf16 v[252:255],a[132:135],v[48:51],v[252:255]
v_cvt_pk_bf16_f32 v26,v84,v85
v_cvt_pk_bf16_f32 v27,v86,v87
v_mfma_f32_16x16x32_bf16 v[204:207],a[132:135],v[44:47],v[204:207]
ds_read_b128 a[132:135],v1 offset:6144
v_fma_f32 v95,v95,s36,v15
v_smfmac_f32_16x16x64_bf16 v[60:63],a[152:155],v[20:27],v18
v_fma_f32 v100,v100,s36,v16
v_mfma_f32_16x16x32_bf16 v[200:203],a[128:131],v[44:47],v[200:203]
buffer_load_dwordx4 v7,s[8:11],s21 offen offset:1024 lds
s_waitcnt lgkmcnt(1)
v_mfma_f32_16x16x32_bf16 v[72:75],a[124:127],a[20:23],0
ds_read_b128 a[128:131],v0 offset:6144
v_fma_f32 v101,v101,s36,v16
v_mfma_f32_16x16x32_bf16 v[72:75],a[120:123],a[16:19],v[72:75]
v_exp_f32 v92,v92
v_mfma_f32_16x16x32_bf16 v[72:75],a[148:151],a[12:15],v[72:75]
v_exp_f32 v93,v93
v_mfma_f32_16x16x32_bf16 v[72:75],a[144:147],a[8:11],v[72:75]
v_exp_f32 v94,v94
v_mfma_f32_16x16x32_bf16 v[72:75],a[140:143],a[4:7],v[72:75]
v_exp_f32 v95,v95
v_mfma_f32_16x16x32_bf16 v[72:75],a[136:139],a[0:3],v[72:75]
v_cvt_pk_bf16_f32 v30,v92,v93
v_cvt_pk_bf16_f32 v31,v94,v95
v_mfma_f32_16x16x32_bf16 v[80:83],a[136:139],a[24:27],0
v_fma_f32 v102,v102,s36,v16
v_fma_f32 v103,v103,s36,v16
v_mfma_f32_16x16x32_bf16 v[80:83],a[140:143],a[28:31],v[80:83]
v_exp_f32 v100,v100
v_mfma_f32_16x16x32_bf16 v[80:83],a[144:147],a[32:35],v[80:83]
buffer_load_dwordx4 v8,s[8:11],s21 offen offset:2048 lds
v_mfma_f32_16x16x32_bf16 v[80:83],a[148:151],a[36:39],v[80:83]
s_add_u32 s21,s21,12288
v_exp_f32 v101,v101
v_mfma_f32_16x16x32_bf16 v[80:83],a[120:123],a[40:43],v[80:83]
s_add_u32 m0,s22,24576
v_exp_f32 v102,v102
v_mfma_f32_16x16x32_bf16 v[80:83],a[124:127],a[44:47],v[80:83]
v_exp_f32 v103,v103
v_mfma_f32_16x16x32_bf16 v[88:91],a[124:127],a[68:71],0
v_cvt_pk_bf16_f32 v34,v100,v101
v_cvt_pk_bf16_f32 v35,v102,v103
v_mfma_f32_16x16x32_bf16 v[88:91],a[120:123],a[64:67],v[88:91]
v_fma_f32 v72,v72,s36,v13
v_fma_f32 v73,v73,s36,v13
v_smfmac_f32_16x16x64_bf16 v[64:67],a[152:155],v[28:35],v18
v_fma_f32 v74,v74,s36,v13
v_mfma_f32_16x16x32_bf16 v[88:91],a[148:151],a[60:63],v[88:91]
v_fma_f32 v75,v75,s36,v13
v_fma_f32 v80,v80,s36,v14
v_mfma_f32_16x16x32_bf16 v[88:91],a[144:147],a[56:59],v[88:91]
v_fma_f32 v81,v81,s36,v14
v_mfma_f32_16x16x32_bf16 v[88:91],a[140:143],a[52:55],v[88:91]
buffer_load_dwordx4 v6,s[4:7],s20 offen offset:0 lds
v_mfma_f32_16x16x32_bf16 v[88:91],a[136:139],a[48:51],v[88:91]
v_exp_f32 v72,v72
v_mfma_f32_16x16x32_bf16 v[96:99],a[136:139],a[72:75],0
ds_read_b128 a[136:139],v0 offset:6272
v_mfma_f32_16x16x32_bf16 v[96:99],a[140:143],a[76:79],v[96:99]
ds_read_b128 a[140:143],v1 offset:6272
v_mfma_f32_16x16x32_bf16 v[96:99],a[144:147],a[80:83],v[96:99]
ds_read_b128 a[144:147],v0 offset:6400
v_mfma_f32_16x16x32_bf16 v[96:99],a[148:151],a[84:87],v[96:99]
ds_read_b128 a[148:151],v1 offset:6400
v_mfma_f32_16x16x32_bf16 v[96:99],a[120:123],a[88:91],v[96:99]
v_exp_f32 v73,v73
v_mfma_f32_16x16x32_bf16 v[96:99],a[124:127],a[92:95],v[96:99]
s_waitcnt lgkmcnt(4)
v_exp_f32 v74,v74
v_mfma_f32_16x16x32_bf16 v[76:79],a[128:131],a[0:3],0
v_exp_f32 v75,v75
v_mfma_f32_16x16x32_bf16 v[76:79],a[132:135],a[4:7],v[76:79]
buffer_load_dwordx4 v7,s[4:7],s20 offen offset:1024 lds
s_waitcnt lgkmcnt(3)
v_mfma_f32_16x16x32_bf16 v[76:79],a[136:139],a[8:11],v[76:79]
s_waitcnt lgkmcnt(2)
v_exp_f32 v80,v80
v_mfma_f32_16x16x32_bf16 v[76:79],a[140:143],a[12:15],v[76:79]
s_waitcnt lgkmcnt(0)
v_exp_f32 v81,v81
v_mfma_f32_16x16x32_bf16 v[76:79],a[144:147],a[16:19],v[76:79]
v_cvt_pk_bf16_f32 v44,v72,v73
v_cvt_pk_bf16_f32 v45,v74,v75
v_mfma_f32_16x16x32_bf16 v[76:79],a[148:151],a[20:23],v[76:79]
v_cvt_pk_bf16_f32 v48,v80,v81
v_mfma_f32_16x16x32_bf16 v[84:87],a[148:151],a[44:47],0
v_mfma_f32_16x16x32_bf16 v[84:87],a[144:147],a[40:43],v[84:87]
v_mfma_f32_16x16x32_bf16 v[84:87],a[140:143],a[36:39],v[84:87]
v_mfma_f32_16x16x32_bf16 v[84:87],a[136:139],a[32:35],v[84:87]
v_mfma_f32_16x16x32_bf16 v[84:87],a[132:135],a[28:31],v[84:87]
buffer_load_dwordx4 v8,s[4:7],s20 offen offset:2048 lds
v_mfma_f32_16x16x32_bf16 v[84:87],a[128:131],a[24:27],v[84:87]
s_add_u32 s20,s20,12288
v_mfma_f32_16x16x32_bf16 v[92:95],a[128:131],a[48:51],0
ds_read_b64_tr_b16 a[120:121],v2 offset:24576
v_mfma_f32_16x16x32_bf16 v[92:95],a[132:135],a[52:55],v[92:95]
ds_read_b64_tr_b16 a[122:123],v2 offset:30720
v_mfma_f32_16x16x32_bf16 v[92:95],a[136:139],a[56:59],v[92:95]
ds_read_b64_tr_b16 a[124:125],v3 offset:24576
v_mfma_f32_16x16x32_bf16 v[92:95],a[140:143],a[60:63],v[92:95]
ds_read_b64_tr_b16 a[126:127],v3 offset:30720
v_mfma_f32_16x16x32_bf16 v[92:95],a[144:147],a[64:67],v[92:95]
v_mfma_f32_16x16x32_bf16 v[92:95],a[148:151],a[68:71],v[92:95]
v_mfma_f32_16x16x32_bf16 v[100:103],a[148:151],a[92:95],0
v_mfma_f32_16x16x32_bf16 v[100:103],a[144:147],a[88:91],v[100:103]
v_mfma_f32_16x16x32_bf16 v[100:103],a[140:143],a[84:87],v[100:103]
v_mfma_f32_16x16x32_bf16 v[100:103],a[136:139],a[80:83],v[100:103]
v_mfma_f32_16x16x32_bf16 v[100:103],a[132:135],a[76:79],v[100:103]
ds_read_b64_tr_b16 a[132:133],v5 offset:24576
v_mfma_f32_16x16x32_bf16 v[100:103],a[128:131],a[72:75],v[100:103]
ds_read_b64_tr_b16 a[128:129],v4 offset:24576
ds_read_b64_tr_b16 a[130:131],v4 offset:30720
ds_read_b64_tr_b16 a[134:135],v5 offset:30720
s_mov_b32 s38,0
s_branch L_loop4
L_end5:
s_waitcnt lgkmcnt(3)
v_mfma_f32_16x16x32_bf16 v[160:163],a[120:123],v[20:23],v[160:163]
ds_read_b64_tr_b16 a[136:137],v2 offset:24704
v_fma_f32 v90,v90,s36,v15
v_mfma_f32_16x16x32_bf16 v[164:167],a[124:127],v[20:23],v[164:167]
ds_read_b64_tr_b16 a[138:139],v2 offset:30848
v_fma_f32 v91,v91,s36,v15
v_mfma_f32_16x16x32_bf16 v[212:215],a[124:127],v[24:27],v[212:215]
ds_read_b64_tr_b16 a[140:141],v3 offset:24704
v_fma_f32 v96,v96,s36,v16
v_mfma_f32_16x16x32_bf16 v[208:211],a[120:123],v[24:27],v[208:211]
ds_read_b64_tr_b16 a[142:143],v3 offset:30848
v_fma_f32 v97,v97,s36,v16
v_mfma_f32_16x16x32_bf16 v[112:115],a[120:123],v[28:31],v[112:115]
ds_read_b64_tr_b16 a[144:145],v4 offset:24704
v_fma_f32 v98,v98,s36,v16
v_mfma_f32_16x16x32_bf16 v[116:119],a[124:127],v[28:31],v[116:119]
ds_read_b64_tr_b16 a[146:147],v4 offset:30848
ds_read_b64_tr_b16 a[148:149],v5 offset:24704
ds_read_b64_tr_b16 a[150:151],v5 offset:30848
v_mfma_f32_16x16x32_bf16 a[164:167],a[124:127],v[32:35],a[164:167]
v_fma_f32 v99,v99,s36,v16
v_fma_f32 v104,v104,s36,v17
v_mfma_f32_16x16x32_bf16 a[160:163],a[120:123],v[32:35],a[160:163]
v_fma_f32 v105,v105,s36,v17
v_fma_f32 v106,v106,s36,v17
v_mfma_f32_16x16x32_bf16 a[208:211],a[120:123],v[36:39],a[208:211]
ds_read_b64_tr_b16 a[120:121],v2 offset:24832
v_fma_f32 v107,v107,s36,v17
v_mfma_f32_16x16x32_bf16 a[212:215],a[124:127],v[36:39],a[212:215]
s_waitcnt lgkmcnt(6)
ds_read_b64_tr_b16 a[122:123],v2 offset:30976
v_fma_f32 v76,v76,s36,v13
v_mfma_f32_16x16x32_bf16 a[216:219],a[128:131],v[36:39],a[216:219]
ds_read_b64_tr_b16 a[124:125],v3 offset:24832
v_fma_f32 v77,v77,s36,v13
v_mfma_f32_16x16x32_bf16 a[220:223],a[132:135],v[36:39],a[220:223]
ds_read_b64_tr_b16 a[126:127],v3 offset:30976
v_fma_f32 v78,v78,s36,v13
v_mfma_f32_16x16x32_bf16 a[172:175],a[132:135],v[32:35],a[172:175]
v_fma_f32 v79,v79,s36,v13
v_fma_f32 v84,v84,s36,v14
v_mfma_f32_16x16x32_bf16 a[168:171],a[128:131],v[32:35],a[168:171]
v_fma_f32 v85,v85,s36,v14
v_fma_f32 v86,v86,s36,v14
v_mfma_f32_16x16x32_bf16 v[120:123],a[128:131],v[28:31],v[120:123]
v_fma_f32 v87,v87,s36,v14
v_fma_f32 v92,v92,s36,v15
v_mfma_f32_16x16x32_bf16 v[124:127],a[132:135],v[28:31],v[124:127]
v_fma_f32 v93,v93,s36,v15
v_fma_f32 v94,v94,s36,v15
v_mfma_f32_16x16x32_bf16 v[220:223],a[132:135],v[24:27],v[220:223]
v_fma_f32 v95,v95,s36,v15
v_fma_f32 v100,v100,s36,v16
v_mfma_f32_16x16x32_bf16 v[216:219],a[128:131],v[24:27],v[216:219]
v_fma_f32 v101,v101,s36,v16
v_fma_f32 v102,v102,s36,v16
v_mfma_f32_16x16x32_bf16 v[168:171],a[128:131],v[20:23],v[168:171]
ds_read_b64_tr_b16 a[128:129],v4 offset:24832
v_fma_f32 v103,v103,s36,v16
v_mfma_f32_16x16x32_bf16 v[172:175],a[132:135],v[20:23],v[172:175]
ds_read_b64_tr_b16 a[130:131],v4 offset:30976
v_fma_f32 v108,v108,s36,v17
v_mfma_f32_16x16x32_bf16 v[176:179],a[136:139],v[20:23],v[176:179]
s_waitcnt lgkmcnt(2)
ds_read_b64_tr_b16 a[132:133],v5 offset:24832
v_fma_f32 v109,v109,s36,v17
v_mfma_f32_16x16x32_bf16 v[180:183],a[140:143],v[20:23],v[180:183]
ds_read_b64_tr_b16 a[134:135],v5 offset:30976
v_fma_f32 v110,v110,s36,v17
v_mfma_f32_16x16x32_bf16 v[228:231],a[140:143],v[24:27],v[228:231]
v_fma_f32 v111,v111,s36,v17
v_exp_f32 v90,v90
v_mfma_f32_16x16x32_bf16 v[224:227],a[136:139],v[24:27],v[224:227]
v_exp_f32 v91,v91
v_mfma_f32_16x16x32_bf16 v[128:131],a[136:139],v[28:31],v[128:131]
v_exp_f32 v96,v96
v_mfma_f32_16x16x32_bf16 v[132:135],a[140:143],v[28:31],v[132:135]
v_exp_f32 v97,v97
v_mfma_f32_16x16x32_bf16 a[180:183],a[140:143],v[32:35],a[180:183]
v_exp_f32 v98,v98
v_mfma_f32_16x16x32_bf16 a[176:179],a[136:139],v[32:35],a[176:179]
v_exp_f32 v99,v99
v_mfma_f32_16x16x32_bf16 a[224:227],a[136:139],v[36:39],a[224:227]
v_exp_f32 v104,v104
v_mfma_f32_16x16x32_bf16 a[228:231],a[140:143],v[36:39],a[228:231]
v_exp_f32 v105,v105
v_mfma_f32_16x16x32_bf16 a[232:235],a[144:147],v[36:39],a[232:235]
v_exp_f32 v106,v106
v_mfma_f32_16x16x32_bf16 a[236:239],a[148:151],v[36:39],a[236:239]
v_exp_f32 v107,v107
v_mfma_f32_16x16x32_bf16 a[188:191],a[148:151],v[32:35],a[188:191]
v_exp_f32 v76,v76
v_mfma_f32_16x16x32_bf16 a[184:187],a[144:147],v[32:35],a[184:187]
v_exp_f32 v77,v77
v_mfma_f32_16x16x32_bf16 v[136:139],a[144:147],v[28:31],v[136:139]
v_exp_f32 v78,v78
v_mfma_f32_16x16x32_bf16 v[140:143],a[148:151],v[28:31],v[140:143]
v_exp_f32 v79,v79
v_mfma_f32_16x16x32_bf16 v[236:239],a[148:151],v[24:27],v[236:239]
v_exp_f32 v84,v84
v_mfma_f32_16x16x32_bf16 v[232:235],a[144:147],v[24:27],v[232:235]
v_exp_f32 v85,v85
v_mfma_f32_16x16x32_bf16 v[184:187],a[144:147],v[20:23],v[184:187]
v_exp_f32 v86,v86
v_mfma_f32_16x16x32_bf16 v[188:191],a[148:151],v[20:23],v[188:191]
v_exp_f32 v87,v87
v_mfma_f32_16x16x32_bf16 v[192:195],a[120:123],v[20:23],v[192:195]
v_exp_f32 v92,v92
v_mfma_f32_16x16x32_bf16 v[196:199],a[124:127],v[20:23],v[196:199]
v_exp_f32 v93,v93
v_mfma_f32_16x16x32_bf16 v[244:247],a[124:127],v[24:27],v[244:247]
v_exp_f32 v94,v94
v_mfma_f32_16x16x32_bf16 v[240:243],a[120:123],v[24:27],v[240:243]
v_exp_f32 v95,v95
v_mfma_f32_16x16x32_bf16 v[144:147],a[120:123],v[28:31],v[144:147]
v_exp_f32 v100,v100
v_mfma_f32_16x16x32_bf16 v[148:151],a[124:127],v[28:31],v[148:151]
v_exp_f32 v101,v101
v_mfma_f32_16x16x32_bf16 a[196:199],a[124:127],v[32:35],a[196:199]
v_exp_f32 v102,v102
v_mfma_f32_16x16x32_bf16 a[192:195],a[120:123],v[32:35],a[192:195]
v_exp_f32 v103,v103
v_mfma_f32_16x16x32_bf16 a[240:243],a[120:123],v[36:39],a[240:243]
v_exp_f32 v108,v108
s_waitcnt vmcnt(12) lgkmcnt(0)
s_barrier
v_mfma_f32_16x16x32_bf16 a[244:247],a[124:127],v[36:39],a[244:247]
v_exp_f32 v109,v109
v_mfma_f32_16x16x32_bf16 a[248:251],a[128:131],v[36:39],a[248:251]
v_exp_f32 v110,v110
v_mfma_f32_16x16x32_bf16 a[252:255],a[132:135],v[36:39],a[252:255]
v_exp_f32 v111,v111
v_mfma_f32_16x16x32_bf16 a[204:207],a[132:135],v[32:35],a[204:207]
v_cvt_pk_bf16_f32 v53,v90,v91
v_cvt_pk_bf16_f32 v56,v96,v97
v_mfma_f32_16x16x32_bf16 a[200:203],a[128:131],v[32:35],a[200:203]
v_cvt_pk_bf16_f32 v57,v98,v99
v_cvt_pk_bf16_f32 v40,v104,v105
v_mfma_f32_16x16x32_bf16 v[152:155],a[128:131],v[28:31],v[152:155]
v_cvt_pk_bf16_f32 v41,v106,v107
v_cvt_pk_bf16_f32 v46,v76,v77
v_mfma_f32_16x16x32_bf16 v[156:159],a[132:135],v[28:31],v[156:159]
v_cvt_pk_bf16_f32 v47,v78,v79
v_cvt_pk_bf16_f32 v50,v84,v85
v_mfma_f32_16x16x32_bf16 v[252:255],a[132:135],v[24:27],v[252:255]
v_cvt_pk_bf16_f32 v51,v86,v87
v_cvt_pk_bf16_f32 v54,v92,v93
v_mfma_f32_16x16x32_bf16 v[248:251],a[128:131],v[24:27],v[248:251]
v_cvt_pk_bf16_f32 v55,v94,v95
v_cvt_pk_bf16_f32 v58,v100,v101
v_smfmac_f32_16x16x64_bf16 v[60:63],a[152:155],v[44:51],v18
v_cvt_pk_bf16_f32 v59,v102,v103
v_mfma_f32_16x16x32_bf16 v[200:203],a[128:131],v[20:23],v[200:203]
v_cvt_pk_bf16_f32 v42,v108,v109
v_cvt_pk_bf16_f32 v43,v110,v111
v_smfmac_f32_16x16x64_bf16 v[64:67],a[152:155],v[52:59],v18
v_subrev_u32 v10,18432,v10
v_smfmac_f32_16x16x64_bf16 v[68:71],a[152:155],v[36:43],v18
v_mfma_f32_16x16x32_bf16 v[204:207],a[132:135],v[20:23],v[204:207]
ds_read_b64_tr_b16 a[136:137],v2 offset:0
ds_read_b64_tr_b16 a[138:139],v2 offset:6144
ds_read_b64_tr_b16 a[140:141],v3 offset:0
ds_read_b64_tr_b16 a[142:143],v3 offset:6144
ds_read_b64_tr_b16 a[144:145],v4 offset:0
ds_read_b64_tr_b16 a[146:147],v4 offset:6144
ds_read_b64_tr_b16 a[148:149],v5 offset:0
ds_read_b64_tr_b16 a[150:151],v5 offset:6144
s_waitcnt lgkmcnt(6)
v_mfma_f32_16x16x32_bf16 v[160:163],a[136:139],v[44:47],v[160:163]
s_waitcnt vmcnt(6)
ds_read_b64_tr_b16 a[122:123],v2 offset:6272
v_mbcnt_lo_u32_b32 v39,-1,0
s_waitcnt lgkmcnt(5)
v_mfma_f32_16x16x32_bf16 v[164:167],a[140:143],v[44:47],v[164:167]
s_add_u32 s84,s42,0
ds_read_b64_tr_b16 a[120:121],v2 offset:128
v_mbcnt_hi_u32_b32 v39,-1,v39
v_mfma_f32_16x16x32_bf16 v[212:215],a[140:143],v[48:51],v[212:215]
s_add_u32 s85,s42,6144
ds_read_b64_tr_b16 a[126:127],v3 offset:6272
v_and_b32 v38,7,v39
v_mfma_f32_16x16x32_bf16 v[208:211],a[136:139],v[48:51],v[208:211]
s_add_u32 s86,s42,12288
ds_read_b64_tr_b16 a[124:125],v3 offset:128
v_lshrrev_b32 v19,5,v39
v_mfma_f32_16x16x32_bf16 v[112:115],a[136:139],v[52:55],v[112:115]
s_add_u32 s87,s42,18432
ds_read_b64_tr_b16 a[130:131],v4 offset:6272
v_xor_b32 v38,v38,v19
v_mfma_f32_16x16x32_bf16 v[116:119],a[140:143],v[52:55],v[116:119]
s_add_u32 s66,s42,24576
ds_read_b64_tr_b16 a[128:129],v4 offset:128
ds_read_b64_tr_b16 a[132:133],v5 offset:128
ds_read_b64_tr_b16 a[134:135],v5 offset:6272
v_mfma_f32_16x16x32_bf16 a[164:167],a[140:143],v[56:59],a[164:167]
v_and_b32 v19,15,v39
v_lshl_add_u32 v19,v19,7,s24
v_mfma_f32_16x16x32_bf16 a[160:163],a[136:139],v[56:59],a[160:163]
v_lshl_add_u32 v19,v38,4,v19
v_bfe_u32 v38,v39,4,1
v_mfma_f32_16x16x32_bf16 a[208:211],a[136:139],v[40:43],a[208:211]
ds_read_b64_tr_b16 a[136:137],v2 offset:256
v_lshl_add_u32 v36,v38,3,v19
v_mfma_f32_16x16x32_bf16 a[212:215],a[140:143],v[40:43],a[212:215]
s_waitcnt lgkmcnt(6)
ds_read_b64_tr_b16 a[138:139],v2 offset:6400
v_xor_b32 v38,64,v36
v_mfma_f32_16x16x32_bf16 a[216:219],a[144:147],v[40:43],a[216:219]
ds_read_b64_tr_b16 a[140:141],v3 offset:256
v_bfe_u32 v19,v39,3,1
v_mfma_f32_16x16x32_bf16 a[220:223],a[148:151],v[40:43],a[220:223]
ds_read_b64_tr_b16 a[142:143],v3 offset:6400
v_xor_b32 v37,32,v36
v_mfma_f32_16x16x32_bf16 a[172:175],a[148:151],v[56:59],a[172:175]
v_xor_b32 v39,96,v36
v_lshlrev_b32 v19,11,v19
v_mfma_f32_16x16x32_bf16 a[168:171],a[144:147],v[56:59],a[168:171]
v_add_u32 v36,v36,v19
v_add_u32 v37,v37,v19
v_mfma_f32_16x16x32_bf16 v[120:123],a[144:147],v[52:55],v[120:123]
v_add_u32 v38,v38,v19
v_add_u32 v39,v39,v19
v_mfma_f32_16x16x32_bf16 v[124:127],a[148:151],v[52:55],v[124:127]
v_add_f32 v62,v62,v63
v_rcp_f32 v62,v62
v_mfma_f32_16x16x32_bf16 v[220:223],a[148:151],v[48:51],v[220:223]
v_add_f32 v68,v68,v69
v_add_f32 v68,v68,v70
v_mfma_f32_16x16x32_bf16 v[216:219],a[144:147],v[48:51],v[216:219]
v_add_f32 v68,v68,v71
v_rcp_f32 v68,v68
v_mfma_f32_16x16x32_bf16 v[168:171],a[144:147],v[44:47],v[168:171]
ds_read_b64_tr_b16 a[146:147],v4 offset:6400
v_accvgpr_read_b32 v106,a170
v_mfma_f32_16x16x32_bf16 v[172:175],a[148:151],v[44:47],v[172:175]
ds_read_b64_tr_b16 a[144:145],v4 offset:256
v_accvgpr_read_b32 v91,a163
v_mfma_f32_16x16x32_bf16 v[176:179],a[120:123],v[44:47],v[176:179]
s_waitcnt lgkmcnt(2)
ds_read_b64_tr_b16 a[150:151],v5 offset:6400
v_accvgpr_read_b32 v108,a216
v_mfma_f32_16x16x32_bf16 v[180:183],a[124:127],v[44:47],v[180:183]
ds_read_b64_tr_b16 a[148:149],v5 offset:256
v_accvgpr_read_b32 v98,a166
v_mfma_f32_16x16x32_bf16 v[228:231],a[124:127],v[48:51],v[228:231]
v_add_f32 v66,v66,v67
v_rcp_f32 v66,v66
v_mfma_f32_16x16x32_bf16 v[224:227],a[120:123],v[48:51],v[224:227]
v_accvgpr_read_b32 v99,a167
v_accvgpr_read_b32 v88,a160
v_mfma_f32_16x16x32_bf16 v[128:131],a[120:123],v[52:55],v[128:131]
v_accvgpr_read_b32 v94,a210
v_accvgpr_read_b32 v111,a219
v_mfma_f32_16x16x32_bf16 v[132:135],a[124:127],v[52:55],v[132:135]
v_accvgpr_read_b32 v110,a218
v_accvgpr_read_b32 v105,a169
v_mfma_f32_16x16x32_bf16 a[180:183],a[124:127],v[56:59],a[180:183]
v_accvgpr_read_b32 v109,a217
v_accvgpr_read_b32 v93,a209
v_accvgpr_read_b32 v89,a161
v_accvgpr_read_b32 v104,a168
v_accvgpr_read_b32 v96,a164
v_pk_mul_f32 v[228:229],v[228:229],v[62:63] op_sel_hi:[1,0]
v_pk_mul_f32 v[224:225],v[224:225],v[62:63] op_sel_hi:[1,0]
v_pk_mul_f32 v[230:231],v[230:231],v[62:63] op_sel_hi:[1,0]
v_pk_mul_f32 v[214:215],v[214:215],v[62:63] op_sel_hi:[1,0]
v_pk_mul_f32 v[210:211],v[210:211],v[62:63] op_sel_hi:[1,0]
v_pk_mul_f32 v[226:227],v[226:227],v[62:63] op_sel_hi:[1,0]
v_pk_mul_f32 v[208:209],v[208:209],v[62:63] op_sel_hi:[1,0]
v_pk_mul_f32 v[212:213],v[212:213],v[62:63] op_sel_hi:[1,0]
v_cvt_pk_bf16_f32 v208,v208,v209
v_cvt_pk_bf16_f32 v224,v224,v225
v_mfma_f32_16x16x32_bf16 a[176:179],a[120:123],v[56:59],a[176:179]
v_cvt_pk_bf16_f32 v225,v226,v227
v_accvgpr_read_b32 v227,a223
v_mfma_f32_16x16x32_bf16 a[224:227],a[120:123],v[40:43],a[224:227]
v_accvgpr_read_b32 v226,a222
v_cvt_pk_bf16_f32 v209,v210,v211
v_mfma_f32_16x16x32_bf16 a[228:231],a[124:127],v[40:43],a[228:231]
ds_write2st64_b64 v36,v[208:209],v[224:225] offset0:12 offset1:14
v_mfma_f32_16x16x32_bf16 a[232:235],a[128:131],v[40:43],a[232:235]
v_sub_u32 v36,v36,v19
v_accvgpr_read_b32 v210,a174
v_mfma_f32_16x16x32_bf16 a[236:239],a[132:135],v[40:43],a[236:239]
v_accvgpr_read_b32 v211,a175
v_accvgpr_read_b32 v225,a221
v_mfma_f32_16x16x32_bf16 a[188:191],a[132:135],v[56:59],a[188:191]
v_accvgpr_read_b32 v208,a172
v_accvgpr_read_b32 v209,a173
v_mfma_f32_16x16x32_bf16 a[184:187],a[128:131],v[56:59],a[184:187]
v_accvgpr_read_b32 v107,a171
v_accvgpr_read_b32 v97,a165
v_mfma_f32_16x16x32_bf16 v[136:139],a[128:131],v[52:55],v[136:139]
v_accvgpr_read_b32 v224,a220
v_accvgpr_read_b32 v95,a211
v_mfma_f32_16x16x32_bf16 v[140:143],a[132:135],v[52:55],v[140:143]
v_accvgpr_read_b32 v103,a215
v_accvgpr_read_b32 v90,a162
v_mfma_f32_16x16x32_bf16 v[236:239],a[132:135],v[48:51],v[236:239]
v_accvgpr_read_b32 v102,a214
v_accvgpr_read_b32 v92,a208
v_mfma_f32_16x16x32_bf16 v[232:235],a[128:131],v[48:51],v[232:235]
v_accvgpr_read_b32 v101,a213
v_accvgpr_read_b32 v100,a212
v_mfma_f32_16x16x32_bf16 v[184:187],a[128:131],v[44:47],v[184:187]
v_add_f32 v64,v64,v65
v_rcp_f32 v64,v64
v_mfma_f32_16x16x32_bf16 v[188:191],a[132:135],v[44:47],v[188:191]
v_cvt_pk_bf16_f32 v212,v212,v213
v_cvt_pk_bf16_f32 v228,v228,v229
v_mfma_f32_16x16x32_bf16 v[192:195],a[136:139],v[44:47],v[192:195]
v_cvt_pk_bf16_f32 v229,v230,v231
v_cvt_pk_bf16_f32 v213,v214,v215
ds_write2st64_b64 v37,v[212:213],v[228:229] offset0:12 offset1:14
v_pk_mul_f32 v[238:239],v[238:239],v[62:63] op_sel_hi:[1,0]
v_pk_mul_f32 v[236:237],v[236:237],v[62:63] op_sel_hi:[1,0]
v_pk_mul_f32 v[210:211],v[210:211],v[66:67] op_sel_hi:[1,0]
v_pk_mul_f32 v[92:93],v[92:93],v[68:69] op_sel_hi:[1,0]
v_pk_mul_f32 v[226:227],v[226:227],v[68:69] op_sel_hi:[1,0]
v_pk_mul_f32 v[96:97],v[96:97],v[66:67] op_sel_hi:[1,0]
v_pk_mul_f32 v[98:99],v[98:99],v[66:67] op_sel_hi:[1,0]
v_pk_mul_f32 v[108:109],v[108:109],v[68:69] op_sel_hi:[1,0]
v_pk_mul_f32 v[100:101],v[100:101],v[68:69] op_sel_hi:[1,0]
v_pk_mul_f32 v[232:233],v[232:233],v[62:63] op_sel_hi:[1,0]
v_pk_mul_f32 v[234:235],v[234:235],v[62:63] op_sel_hi:[1,0]
v_pk_mul_f32 v[106:107],v[106:107],v[66:67] op_sel_hi:[1,0]
v_pk_mul_f32 v[218:219],v[218:219],v[62:63] op_sel_hi:[1,0]
v_pk_mul_f32 v[216:217],v[216:217],v[62:63] op_sel_hi:[1,0]
v_pk_mul_f32 v[110:111],v[110:111],v[68:69] op_sel_hi:[1,0]
v_pk_mul_f32 v[94:95],v[94:95],v[68:69] op_sel_hi:[1,0]
v_pk_mul_f32 v[222:223],v[222:223],v[62:63] op_sel_hi:[1,0]
v_pk_mul_f32 v[224:225],v[224:225],v[68:69] op_sel_hi:[1,0]
v_pk_mul_f32 v[102:103],v[102:103],v[68:69] op_sel_hi:[1,0]
v_pk_mul_f32 v[220:221],v[220:221],v[62:63] op_sel_hi:[1,0]
v_pk_mul_f32 v[90:91],v[90:91],v[66:67] op_sel_hi:[1,0]
v_pk_mul_f32 v[208:209],v[208:209],v[66:67] op_sel_hi:[1,0]
v_pk_mul_f32 v[104:105],v[104:105],v[66:67] op_sel_hi:[1,0]
v_pk_mul_f32 v[88:89],v[88:89],v[66:67] op_sel_hi:[1,0]
v_sub_u32 v37,v37,v19
v_cvt_pk_bf16_f32 v236,v236,v237
v_mfma_f32_16x16x32_bf16 v[196:199],a[140:143],v[44:47],v[196:199]
v_cvt_pk_bf16_f32 v232,v232,v233
v_cvt_pk_bf16_f32 v220,v220,v221
v_mfma_f32_16x16x32_bf16 v[244:247],a[140:143],v[48:51],v[244:247]
v_cvt_pk_bf16_f32 v237,v238,v239
v_cvt_pk_bf16_f32 v233,v234,v235
v_mfma_f32_16x16x32_bf16 v[240:243],a[136:139],v[48:51],v[240:243]
v_cvt_pk_bf16_f32 v216,v216,v217
v_cvt_pk_bf16_f32 v217,v218,v219
v_mfma_f32_16x16x32_bf16 v[144:147],a[136:139],v[52:55],v[144:147]
ds_write2st64_b64 v38,v[216:217],v[232:233] offset0:12 offset1:14
v_mfma_f32_16x16x32_bf16 v[148:151],a[140:143],v[52:55],v[148:151]
v_sub_u32 v38,v38,v19
v_cvt_pk_bf16_f32 v221,v222,v223
v_mfma_f32_16x16x32_bf16 a[196:199],a[140:143],v[56:59],a[196:199]
v_cvt_pk_bf16_f32 v88,v88,v89
v_cvt_pk_bf16_f32 v92,v92,v93
v_cvt_pk_bf16_f32 v96,v96,v97
v_cvt_pk_bf16_f32 v93,v94,v95
v_cvt_pk_bf16_f32 v89,v90,v91
ds_write2st64_b64 v39,v[220:221],v[236:237] offset0:12 offset1:14
v_pk_mul_f32 v[244:245],v[244:245],v[62:63] op_sel_hi:[1,0]
v_pk_mul_f32 v[242:243],v[242:243],v[62:63] op_sel_hi:[1,0]
v_pk_mul_f32 v[112:113],v[112:113],v[64:65] op_sel_hi:[1,0]
ds_read_b128 v[72:75],v10 offset:6144
v_pk_mul_f32 v[118:119],v[118:119],v[64:65] op_sel_hi:[1,0]
ds_read_b128 v[76:79],v10 offset:9216
v_pk_mul_f32 v[116:117],v[116:117],v[64:65] op_sel_hi:[1,0]
ds_read_b128 v[80:83],v10 offset:7168
v_pk_mul_f32 v[240:241],v[240:241],v[62:63] op_sel_hi:[1,0]
ds_read_b128 v[84:87],v10 offset:10240
v_pk_mul_f32 v[114:115],v[114:115],v[64:65] op_sel_hi:[1,0]
ds_write2st64_b64 v36,v[88:89],v[92:93] offset0:36 offset1:40
v_pk_mul_f32 v[246:247],v[246:247],v[62:63] op_sel_hi:[1,0]
v_sub_u32 v39,v39,v19
v_add_u32 v36,v36,v19
v_mfma_f32_16x16x32_bf16 a[192:195],a[136:139],v[56:59],a[192:195]
v_cvt_pk_bf16_f32 v104,v104,v105
v_cvt_pk_bf16_f32 v224,v224,v225
v_mfma_f32_16x16x32_bf16 a[240:243],a[136:139],v[40:43],a[240:243]
s_waitcnt lgkmcnt(4)
buffer_store_dwordx4 v[72:75],v9,s[16:19],s85 offen offset:0 nt
v_cvt_pk_bf16_f32 v100,v100,v101
v_cvt_pk_bf16_f32 v108,v108,v109
v_cvt_pk_bf16_f32 v105,v106,v107
v_mfma_f32_16x16x32_bf16 a[244:247],a[140:143],v[40:43],a[244:247]
v_cvt_pk_bf16_f32 v101,v102,v103
v_cvt_pk_bf16_f32 v208,v208,v209
v_mfma_f32_16x16x32_bf16 a[248:251],a[144:147],v[40:43],a[248:251]
v_cvt_pk_bf16_f32 v97,v98,v99
v_cvt_pk_bf16_f32 v109,v110,v111
v_mfma_f32_16x16x32_bf16 a[252:255],a[148:151],v[40:43],a[252:255]
ds_write2st64_b64 v37,v[96:97],v[100:101] offset0:36 offset1:40
v_mfma_f32_16x16x32_bf16 a[204:207],a[148:151],v[56:59],a[204:207]
v_add_u32 v37,v37,v19
v_cvt_pk_bf16_f32 v225,v226,v227
v_mfma_f32_16x16x32_bf16 a[200:203],a[144:147],v[56:59],a[200:203]
s_waitcnt lgkmcnt(1)
buffer_store_dwordx4 v[76:79],v9,s[16:19],s85 offen offset:3072 nt
v_cvt_pk_bf16_f32 v209,v210,v211
v_cvt_pk_bf16_f32 v112,v112,v113
v_cvt_pk_bf16_f32 v116,v116,v117
v_mfma_f32_16x16x32_bf16 v[152:155],a[144:147],v[52:55],v[152:155]
v_cvt_pk_bf16_f32 v244,v244,v245
v_cvt_pk_bf16_f32 v117,v118,v119
v_mfma_f32_16x16x32_bf16 v[156:159],a[148:151],v[52:55],v[156:159]
v_cvt_pk_bf16_f32 v240,v240,v241
v_cvt_pk_bf16_f32 v113,v114,v115
v_mfma_f32_16x16x32_bf16 v[252:255],a[148:151],v[48:51],v[252:255]
ds_write2st64_b64 v38,v[104:105],v[108:109] offset0:36 offset1:40
v_mfma_f32_16x16x32_bf16 v[248:251],a[144:147],v[48:51],v[248:251]
v_add_u32 v38,v38,v19
v_cvt_pk_bf16_f32 v241,v242,v243
v_mfma_f32_16x16x32_bf16 v[200:203],a[144:147],v[44:47],v[200:203]
buffer_store_dwordx4 v[80:83],v9,s[16:19],s85 offen offset:128 nt
v_cvt_pk_bf16_f32 v245,v246,v247
v_accvgpr_read_b32 v77,a225
v_accvgpr_read_b32 v72,a176
v_mfma_f32_16x16x32_bf16 v[204:207],a[148:151],v[44:47],v[204:207]
v_accvgpr_read_b32 v74,a178
v_accvgpr_read_b32 v81,a181
v_accvgpr_read_b32 v101,a233
v_accvgpr_read_b32 v80,a180
ds_write2st64_b64 v39,v[208:209],v[224:225] offset0:36 offset1:40
v_pk_mul_f32 v[248:249],v[248:249],v[62:63] op_sel_hi:[1,0]
v_pk_mul_f32 v[250:251],v[250:251],v[62:63] op_sel_hi:[1,0]
v_pk_mul_f32 v[122:123],v[122:123],v[64:65] op_sel_hi:[1,0]
ds_read_b128 v[212:215],v10 offset:18432
buffer_store_dwordx4 v[84:87],v9,s[16:19],s85 offen offset:3200 nt
ds_read_b128 v[228:231],v10 offset:19456
v_pk_mul_f32 v[120:121],v[120:121],v[64:65] op_sel_hi:[1,0]
ds_read_b128 v[216:219],v10 offset:20480
v_pk_mul_f32 v[252:253],v[252:253],v[62:63] op_sel_hi:[1,0]
ds_read_b128 v[232:235],v10 offset:21504
v_pk_mul_f32 v[124:125],v[124:125],v[64:65] op_sel_hi:[1,0]
ds_write2st64_b64 v36,v[240:241],v[112:113] offset0:16 offset1:24
v_pk_mul_f32 v[126:127],v[126:127],v[64:65] op_sel_hi:[1,0]
v_pk_mul_f32 v[254:255],v[254:255],v[62:63] op_sel_hi:[1,0]
v_pk_mul_f32 v[80:81],v[80:81],v[66:67] op_sel_hi:[1,0]
v_pk_mul_f32 v[128:129],v[128:129],v[64:65] op_sel_hi:[1,0]
v_pk_mul_f32 v[150:151],v[150:151],v[64:65] op_sel_hi:[1,0]
v_pk_mul_f32 v[146:147],v[146:147],v[64:65] op_sel_hi:[1,0]
v_pk_mul_f32 v[144:145],v[144:145],v[64:65] op_sel_hi:[1,0]
s_waitcnt lgkmcnt(4)
buffer_store_dwordx4 v[212:215],v9,s[16:19],s87 offen offset:0 nt
v_pk_mul_f32 v[148:149],v[148:149],v[64:65] op_sel_hi:[1,0]
v_pk_mul_f32 v[156:157],v[156:157],v[64:65] op_sel_hi:[1,0]
v_pk_mul_f32 v[136:137],v[136:137],v[64:65] op_sel_hi:[1,0]
v_pk_mul_f32 v[132:133],v[132:133],v[64:65] op_sel_hi:[1,0]
v_pk_mul_f32 v[154:155],v[154:155],v[64:65] op_sel_hi:[1,0]
v_pk_mul_f32 v[152:153],v[152:153],v[64:65] op_sel_hi:[1,0]
v_pk_mul_f32 v[130:131],v[130:131],v[64:65] op_sel_hi:[1,0]
v_pk_mul_f32 v[158:159],v[158:159],v[64:65] op_sel_hi:[1,0]
v_pk_mul_f32 v[134:135],v[134:135],v[64:65] op_sel_hi:[1,0]
ds_write2st64_b64 v37,v[244:245],v[116:117] offset0:16 offset1:24
v_pk_mul_f32 v[138:139],v[138:139],v[64:65] op_sel_hi:[1,0]
v_pk_mul_f32 v[142:143],v[142:143],v[64:65] op_sel_hi:[1,0]
v_pk_mul_f32 v[140:141],v[140:141],v[64:65] op_sel_hi:[1,0]
s_waitcnt lgkmcnt(1)
buffer_store_dwordx4 v[228:231],v9,s[16:19],s87 offen offset:3072 nt
v_add_u32 v39,v39,v19
v_sub_u32 v37,v37,v19
v_sub_u32 v36,v36,v19
v_cvt_pk_bf16_f32 v248,v248,v249
v_cvt_pk_bf16_f32 v120,v120,v121
v_cvt_pk_bf16_f32 v252,v252,v253
v_cvt_pk_bf16_f32 v249,v250,v251
v_cvt_pk_bf16_f32 v121,v122,v123
v_cvt_pk_bf16_f32 v124,v124,v125
ds_write2st64_b64 v38,v[248:249],v[120:121] offset0:16 offset1:24
v_sub_u32 v38,v38,v19
v_cvt_pk_bf16_f32 v125,v126,v127
v_cvt_pk_bf16_f32 v253,v254,v255
buffer_store_dwordx4 v[216:219],v9,s[16:19],s66 offen offset:0 nt
v_accvgpr_read_b32 v84,a228
v_accvgpr_read_b32 v100,a232
v_pk_mul_f32 v[100:101],v[100:101],v[68:69] op_sel_hi:[1,0]
v_accvgpr_read_b32 v97,a185
v_accvgpr_read_b32 v78,a226
v_accvgpr_read_b32 v98,a186
v_accvgpr_read_b32 v75,a179
v_pk_mul_f32 v[74:75],v[74:75],v[66:67] op_sel_hi:[1,0]
v_accvgpr_read_b32 v109,a237
ds_write2st64_b64 v39,v[252:253],v[124:125] offset0:16 offset1:24
v_sub_u32 v39,v39,v19
v_cvt_pk_bf16_f32 v80,v80,v81
v_accvgpr_read_b32 v79,a227
ds_read_b128 v[220:223],v10 offset:8192
buffer_store_dwordx4 v[232:235],v9,s[16:19],s66 offen offset:3072 nt
ds_read_b128 v[236:239],v10 offset:11264
v_pk_mul_f32 v[78:79],v[78:79],v[68:69] op_sel_hi:[1,0]
ds_read_b128 v[88:91],v10 offset:12288
v_accvgpr_read_b32 v73,a177
ds_read_b128 v[92:95],v10 offset:15360
v_pk_mul_f32 v[72:73],v[72:73],v[66:67] op_sel_hi:[1,0]
v_accvgpr_read_b32 v76,a224
v_pk_mul_f32 v[76:77],v[76:77],v[68:69] op_sel_hi:[1,0]
v_cvt_pk_bf16_f32 v72,v72,v73
v_cvt_pk_bf16_f32 v76,v76,v77
v_accvgpr_read_b32 v85,a229
v_pk_mul_f32 v[84:85],v[84:85],v[68:69] op_sel_hi:[1,0]
v_accvgpr_read_b32 v82,a182
v_cvt_pk_bf16_f32 v84,v84,v85
v_accvgpr_read_b32 v104,a188
v_cvt_pk_bf16_f32 v100,v100,v101
v_accvgpr_read_b32 v111,a239
v_accvgpr_read_b32 v96,a184
v_pk_mul_f32 v[96:97],v[96:97],v[66:67] op_sel_hi:[1,0]
v_accvgpr_read_b32 v102,a234
s_waitcnt lgkmcnt(3)
buffer_store_dwordx4 v[220:223],v9,s[16:19],s85 offen offset:256 nt
v_accvgpr_read_b32 v86,a230
v_accvgpr_read_b32 v83,a183
v_pk_mul_f32 v[82:83],v[82:83],v[66:67] op_sel_hi:[1,0]
v_cvt_pk_bf16_f32 v73,v74,v75
v_cvt_pk_bf16_f32 v81,v82,v83
v_accvgpr_read_b32 v87,a231
v_pk_mul_f32 v[86:87],v[86:87],v[68:69] op_sel_hi:[1,0]
v_accvgpr_read_b32 v108,a236
v_pk_mul_f32 v[108:109],v[108:109],v[68:69] op_sel_hi:[1,0]
v_cvt_pk_bf16_f32 v85,v86,v87
v_accvgpr_read_b32 v107,a191
s_waitcnt lgkmcnt(0)
buffer_store_dwordx4 v[236:239],v9,s[16:19],s85 offen offset:3328 nt
v_cvt_pk_bf16_f32 v96,v96,v97
v_accvgpr_read_b32 v103,a235
v_pk_mul_f32 v[102:103],v[102:103],v[68:69] op_sel_hi:[1,0]
v_accvgpr_read_b32 v106,a190
v_pk_mul_f32 v[106:107],v[106:107],v[66:67] op_sel_hi:[1,0]
v_accvgpr_read_b32 v110,a238
v_pk_mul_f32 v[110:111],v[110:111],v[68:69] op_sel_hi:[1,0]
v_cvt_pk_bf16_f32 v77,v78,v79
v_accvgpr_read_b32 v105,a189
ds_write2st64_b64 v36,v[72:73],v[76:77] offset0:36 offset1:40
v_pk_mul_f32 v[104:105],v[104:105],v[66:67] op_sel_hi:[1,0]
v_add_u32 v36,v36,v19
v_accvgpr_read_b32 v99,a187
buffer_store_dwordx4 v[88:91],v9,s[16:19],s86 offen offset:0 nt
v_pk_mul_f32 v[98:99],v[98:99],v[66:67] op_sel_hi:[1,0]
v_cvt_pk_bf16_f32 v104,v104,v105
v_cvt_pk_bf16_f32 v97,v98,v99
v_cvt_pk_bf16_f32 v105,v106,v107
v_cvt_pk_bf16_f32 v101,v102,v103
v_cvt_pk_bf16_f32 v108,v108,v109
v_cvt_pk_bf16_f32 v109,v110,v111
v_cvt_pk_bf16_f32 v144,v144,v145
v_cvt_pk_bf16_f32 v132,v132,v133
ds_write2st64_b64 v37,v[80:81],v[84:85] offset0:36 offset1:40
v_add_u32 v37,v37,v19
v_cvt_pk_bf16_f32 v152,v152,v153
v_cvt_pk_bf16_f32 v136,v136,v137
buffer_store_dwordx4 v[92:95],v9,s[16:19],s86 offen offset:3072 nt
v_cvt_pk_bf16_f32 v128,v128,v129
v_cvt_pk_bf16_f32 v129,v130,v131
v_cvt_pk_bf16_f32 v133,v134,v135
v_cvt_pk_bf16_f32 v156,v156,v157
v_cvt_pk_bf16_f32 v145,v146,v147
v_cvt_pk_bf16_f32 v140,v140,v141
v_cvt_pk_bf16_f32 v148,v148,v149
v_cvt_pk_bf16_f32 v137,v138,v139
v_cvt_pk_bf16_f32 v149,v150,v151
ds_write2st64_b64 v38,v[96:97],v[100:101] offset0:36 offset1:40
v_add_u32 v38,v38,v19
v_cvt_pk_bf16_f32 v153,v154,v155
v_accvgpr_read_b32 v244,a192
v_accvgpr_read_b32 v116,a240
v_cvt_pk_bf16_f32 v141,v142,v143
v_cvt_pk_bf16_f32 v157,v158,v159
v_accvgpr_read_b32 v245,a193
v_pk_mul_f32 v[244:245],v[244:245],v[66:67] op_sel_hi:[1,0]
v_accvgpr_read_b32 v247,a195
v_cvt_pk_bf16_f32 v244,v244,v245
v_accvgpr_read_b32 v127,a251
ds_write2st64_b64 v39,v[104:105],v[108:109] offset0:36 offset1:40
v_add_u32 v39,v39,v19
v_accvgpr_read_b32 v119,a243
v_accvgpr_read_b32 v122,a246
ds_read_b128 v[208:211],v10 offset:18432
v_accvgpr_read_b32 v76,a252
ds_read_b128 v[224:227],v10 offset:19456
v_accvgpr_read_b32 v125,a249
ds_read_b128 v[240:243],v10 offset:20480
v_accvgpr_read_b32 v250,a198
ds_read_b128 v[112:115],v10 offset:21504
v_accvgpr_read_b32 v249,a197
ds_write2st64_b64 v36,v[128:129],v[144:145] offset0:26 offset1:28
v_sub_u32 v36,v36,v19
v_accvgpr_read_b32 v251,a199
v_pk_mul_f32 v[250:251],v[250:251],v[66:67] op_sel_hi:[1,0]
v_accvgpr_read_b32 v117,a241
v_pk_mul_f32 v[116:117],v[116:117],v[68:69] op_sel_hi:[1,0]
v_accvgpr_read_b32 v123,a247
v_pk_mul_f32 v[122:123],v[122:123],v[68:69] op_sel_hi:[1,0]
s_waitcnt lgkmcnt(4)
buffer_store_dwordx4 v[208:211],v9,s[16:19],s87 offen offset:128 nt
v_cvt_pk_bf16_f32 v116,v116,v117
v_accvgpr_read_b32 v248,a196
v_pk_mul_f32 v[248:249],v[248:249],v[66:67] op_sel_hi:[1,0]
v_accvgpr_read_b32 v252,a200
v_accvgpr_read_b32 v120,a244
v_accvgpr_read_b32 v118,a242
v_pk_mul_f32 v[118:119],v[118:119],v[68:69] op_sel_hi:[1,0]
v_accvgpr_read_b32 v79,a255
v_cvt_pk_bf16_f32 v117,v118,v119
ds_write2st64_b64 v37,v[132:133],v[148:149] offset0:26 offset1:28
v_sub_u32 v37,v37,v19
v_accvgpr_read_b32 v246,a194
v_pk_mul_f32 v[246:247],v[246:247],v[66:67] op_sel_hi:[1,0]
s_waitcnt lgkmcnt(1)
buffer_store_dwordx4 v[224:227],v9,s[16:19],s87 offen offset:3200 nt
v_accvgpr_read_b32 v121,a245
v_pk_mul_f32 v[120:121],v[120:121],v[68:69] op_sel_hi:[1,0]
v_accvgpr_read_b32 v255,a203
v_cvt_pk_bf16_f32 v120,v120,v121
v_accvgpr_read_b32 v78,a254
v_pk_mul_f32 v[78:79],v[78:79],v[68:69] op_sel_hi:[1,0]
v_accvgpr_read_b32 v124,a248
v_pk_mul_f32 v[124:125],v[124:125],v[68:69] op_sel_hi:[1,0]
v_accvgpr_read_b32 v126,a250
ds_write2st64_b64 v38,v[136:137],v[152:153] offset0:26 offset1:28
v_pk_mul_f32 v[126:127],v[126:127],v[68:69] op_sel_hi:[1,0]
v_sub_u32 v38,v38,v19
v_accvgpr_read_b32 v254,a202
buffer_store_dwordx4 v[240:243],v9,s[16:19],s66 offen offset:128 nt
v_pk_mul_f32 v[254:255],v[254:255],v[66:67] op_sel_hi:[1,0]
v_cvt_pk_bf16_f32 v124,v124,v125
v_accvgpr_read_b32 v77,a253
v_pk_mul_f32 v[76:77],v[76:77],v[68:69] op_sel_hi:[1,0]
v_accvgpr_read_b32 v74,a206
v_accvgpr_read_b32 v253,a201
v_pk_mul_f32 v[252:253],v[252:253],v[66:67] op_sel_hi:[1,0]
v_accvgpr_read_b32 v73,a205
v_cvt_pk_bf16_f32 v252,v252,v253
ds_write2st64_b64 v39,v[140:141],v[156:157] offset0:26 offset1:28
v_sub_u32 v39,v39,v19
v_cvt_pk_bf16_f32 v125,v126,v127
v_accvgpr_read_b32 v72,a204
ds_read_b128 v[212:215],v10 offset:13312
buffer_store_dwordx4 v[112:115],v9,s[16:19],s66 offen offset:3200 nt
ds_read_b128 v[228:231],v10 offset:16384
v_pk_mul_f32 v[72:73],v[72:73],v[66:67] op_sel_hi:[1,0]
ds_read_b128 v[216:219],v10 offset:14336
v_cvt_pk_bf16_f32 v76,v76,v77
ds_read_b128 v[232:235],v10 offset:17408
v_cvt_pk_bf16_f32 v245,v246,v247
ds_write2st64_b64 v36,v[244:245],v[116:117] offset0:36 offset1:40
v_add_u32 v36,v36,v19
v_cvt_pk_bf16_f32 v72,v72,v73
v_cvt_pk_bf16_f32 v248,v248,v249
v_cvt_pk_bf16_f32 v249,v250,v251
v_accvgpr_read_b32 v75,a207
v_pk_mul_f32 v[74:75],v[74:75],v[66:67] op_sel_hi:[1,0]
v_cvt_pk_bf16_f32 v121,v122,v123
s_waitcnt lgkmcnt(4)
buffer_store_dwordx4 v[212:215],v9,s[16:19],s86 offen offset:128 nt
v_add_f32 v60,v60,v61
v_cvt_pk_bf16_f32 v253,v254,v255
v_cvt_pk_bf16_f32 v73,v74,v75
v_cvt_pk_bf16_f32 v77,v78,v79
v_rcp_f32 v60,v60
ds_write2st64_b64 v37,v[248:249],v[120:121] offset0:36 offset1:40
v_pk_mul_f32 v[176:177],v[176:177],v[60:61] op_sel_hi:[1,0]
v_pk_mul_f32 v[180:181],v[180:181],v[60:61] op_sel_hi:[1,0]
v_pk_mul_f32 v[164:165],v[164:165],v[60:61] op_sel_hi:[1,0]
s_waitcnt lgkmcnt(1)
buffer_store_dwordx4 v[228:231],v9,s[16:19],s86 offen offset:3200 nt
v_pk_mul_f32 v[166:167],v[166:167],v[60:61] op_sel_hi:[1,0]
v_pk_mul_f32 v[162:163],v[162:163],v[60:61] op_sel_hi:[1,0]
v_pk_mul_f32 v[160:161],v[160:161],v[60:61] op_sel_hi:[1,0]
v_pk_mul_f32 v[182:183],v[182:183],v[60:61] op_sel_hi:[1,0]
v_pk_mul_f32 v[186:187],v[186:187],v[60:61] op_sel_hi:[1,0]
v_pk_mul_f32 v[168:169],v[168:169],v[60:61] op_sel_hi:[1,0]
v_pk_mul_f32 v[178:179],v[178:179],v[60:61] op_sel_hi:[1,0]
v_pk_mul_f32 v[190:191],v[190:191],v[60:61] op_sel_hi:[1,0]
v_pk_mul_f32 v[172:173],v[172:173],v[60:61] op_sel_hi:[1,0]
ds_write2st64_b64 v38,v[252:253],v[124:125] offset0:36 offset1:40
v_pk_mul_f32 v[188:189],v[188:189],v[60:61] op_sel_hi:[1,0]
v_pk_mul_f32 v[170:171],v[170:171],v[60:61] op_sel_hi:[1,0]
v_pk_mul_f32 v[184:185],v[184:185],v[60:61] op_sel_hi:[1,0]
buffer_store_dwordx4 v[216:219],v9,s[16:19],s86 offen offset:256 nt
v_pk_mul_f32 v[174:175],v[174:175],v[60:61] op_sel_hi:[1,0]
v_pk_mul_f32 v[196:197],v[196:197],v[60:61] op_sel_hi:[1,0]
v_pk_mul_f32 v[192:193],v[192:193],v[60:61] op_sel_hi:[1,0]
v_pk_mul_f32 v[200:201],v[200:201],v[60:61] op_sel_hi:[1,0]
v_pk_mul_f32 v[198:199],v[198:199],v[60:61] op_sel_hi:[1,0]
v_pk_mul_f32 v[194:195],v[194:195],v[60:61] op_sel_hi:[1,0]
v_pk_mul_f32 v[202:203],v[202:203],v[60:61] op_sel_hi:[1,0]
v_pk_mul_f32 v[204:205],v[204:205],v[60:61] op_sel_hi:[1,0]
v_pk_mul_f32 v[206:207],v[206:207],v[60:61] op_sel_hi:[1,0]
ds_write2st64_b64 v39,v[72:73],v[76:77] offset0:36 offset1:40
v_add_u32 v37,v37,v19
v_add_u32 v38,v38,v19
v_add_u32 v39,v39,v19
ds_read_b128 v[80:83],v10 offset:18432
buffer_store_dwordx4 v[232:235],v9,s[16:19],s86 offen offset:3328 nt
ds_read_b128 v[84:87],v10 offset:19456
v_cvt_pk_bf16_f32 v160,v160,v161
ds_read_b128 v[88:91],v10 offset:20480
v_cvt_pk_bf16_f32 v180,v180,v181
ds_read_b128 v[92:95],v10 offset:21504
v_cvt_pk_bf16_f32 v161,v162,v163
v_cvt_pk_bf16_f32 v176,v176,v177
v_cvt_pk_bf16_f32 v168,v168,v169
v_cvt_pk_bf16_f32 v172,v172,v173
v_cvt_pk_bf16_f32 v177,v178,v179
ds_write2st64_b64 v36,v[160:161],v[176:177] offset0:0 offset1:2
v_cvt_pk_bf16_f32 v164,v164,v165
v_cvt_pk_bf16_f32 v184,v184,v185
v_cvt_pk_bf16_f32 v169,v170,v171
s_waitcnt lgkmcnt(4)
buffer_store_dwordx4 v[80:83],v9,s[16:19],s87 offen offset:256 nt
v_cvt_pk_bf16_f32 v181,v182,v183
v_cvt_pk_bf16_f32 v185,v186,v187
v_cvt_pk_bf16_f32 v165,v166,v167
v_cvt_pk_bf16_f32 v188,v188,v189
v_cvt_pk_bf16_f32 v189,v190,v191
v_cvt_pk_bf16_f32 v173,v174,v175
v_cvt_pk_bf16_f32 v192,v192,v193
v_cvt_pk_bf16_f32 v193,v194,v195
v_cvt_pk_bf16_f32 v204,v204,v205
ds_write2st64_b64 v37,v[164:165],v[180:181] offset0:0 offset1:2
v_cvt_pk_bf16_f32 v196,v196,v197
v_cvt_pk_bf16_f32 v197,v198,v199
v_cvt_pk_bf16_f32 v200,v200,v201
s_waitcnt lgkmcnt(1)
buffer_store_dwordx4 v[84:87],v9,s[16:19],s87 offen offset:3328 nt
v_cvt_pk_bf16_f32 v201,v202,v203
v_cvt_pk_bf16_f32 v205,v206,v207
v_min3_f32 v61,v60,v62,v64
v_min3_f32 v61,v61,v66,v68
v_cmp_nlt_f32 vcc,s37,v61
ds_write2st64_b64 v38,v[168:169],v[184:185] offset0:0 offset1:2
buffer_store_dwordx4 v[88:91],v9,s[16:19],s66 offen offset:256 nt
ds_write2st64_b64 v39,v[172:173],v[188:189] offset0:0 offset1:2
ds_read_b128 v[220:223],v10 offset:0
buffer_store_dwordx4 v[92:95],v9,s[16:19],s66 offen offset:3328 nt
ds_read_b128 v[236:239],v10 offset:3072
s_cmp_lg_u64 vcc,0
ds_read_b128 v[96:99],v10 offset:1024
s_cselect_b32 s62,s32,0
ds_read_b128 v[100:103],v10 offset:4096
s_or_b32 s31,s31,s62
ds_write_b64 v36,v[192:193] offset:2048
s_lshl_b32 s32,s32,1
ds_write_b64 v37,v[196:197] offset:2048
s_waitcnt lgkmcnt(5)
buffer_store_dwordx4 v[220:223],v9,s[16:19],s84 offen offset:0 nt
ds_write_b64 v38,v[200:201] offset:2048
s_waitcnt lgkmcnt(2)
buffer_store_dwordx4 v[236:239],v9,s[16:19],s84 offen offset:3072 nt
ds_write_b64 v39,v[204:205] offset:2048
ds_read_b128 v[104:107],v10 offset:2048
buffer_store_dwordx4 v[96:99],v9,s[16:19],s84 offen offset:128 nt
ds_read_b128 v[108:111],v10 offset:5120
buffer_store_dwordx4 v[100:103],v9,s[16:19],s84 offen offset:3200 nt
s_waitcnt lgkmcnt(1)
buffer_store_dwordx4 v[104:107],v9,s[16:19],s84 offen offset:256 nt
s_waitcnt lgkmcnt(0)
buffer_store_dwordx4 v[108:111],v9,s[16:19],s84 offen offset:3328 nt
s_branch L_fin
L_end4:
s_waitcnt lgkmcnt(3)
v_mfma_f32_16x16x32_bf16 v[160:163],a[120:123],v[20:23],v[160:163]
ds_read_b64_tr_b16 a[136:137],v2 offset:24704
v_fma_f32 v102,v102,s36,v16
v_mfma_f32_16x16x32_bf16 v[164:167],a[124:127],v[20:23],v[164:167]
ds_read_b64_tr_b16 a[138:139],v2 offset:30848
v_fma_f32 v98,v98,s36,v16
v_mfma_f32_16x16x32_bf16 v[212:215],a[124:127],v[24:27],v[212:215]
ds_read_b64_tr_b16 a[140:141],v3 offset:24704
v_fma_f32 v76,v76,s36,v13
v_mfma_f32_16x16x32_bf16 v[208:211],a[120:123],v[24:27],v[208:211]
ds_read_b64_tr_b16 a[142:143],v3 offset:30848
v_fma_f32 v91,v91,s36,v15
v_mfma_f32_16x16x32_bf16 v[112:115],a[120:123],v[28:31],v[112:115]
ds_read_b64_tr_b16 a[144:145],v4 offset:24704
v_fma_f32 v95,v95,s36,v15
v_mfma_f32_16x16x32_bf16 v[116:119],a[124:127],v[28:31],v[116:119]
ds_read_b64_tr_b16 a[146:147],v4 offset:30848
v_fma_f32 v85,v85,s36,v14
v_mfma_f32_16x16x32_bf16 a[164:167],a[124:127],v[32:35],a[164:167]
ds_read_b64_tr_b16 a[148:149],v5 offset:24704
v_exp_f32 v76,v76
v_mfma_f32_16x16x32_bf16 a[160:163],a[120:123],v[32:35],a[160:163]
s_waitcnt lgkmcnt(6)
ds_read_b64_tr_b16 a[150:151],v5 offset:30848
v_fma_f32 v103,v103,s36,v16
v_mfma_f32_16x16x32_bf16 a[168:171],a[128:131],v[32:35],a[168:171]
ds_read_b64_tr_b16 a[120:121],v2 offset:24832
v_fma_f32 v79,v79,s36,v13
v_mfma_f32_16x16x32_bf16 a[172:175],a[132:135],v[32:35],a[172:175]
ds_read_b64_tr_b16 a[122:123],v2 offset:30976
v_fma_f32 v96,v96,s36,v16
v_mfma_f32_16x16x32_bf16 v[124:127],a[132:135],v[28:31],v[124:127]
ds_read_b64_tr_b16 a[124:125],v3 offset:24832
v_exp_f32 v102,v102
v_mfma_f32_16x16x32_bf16 v[120:123],a[128:131],v[28:31],v[120:123]
ds_read_b64_tr_b16 a[126:127],v3 offset:30976
v_fma_f32 v89,v89,s36,v15
v_mfma_f32_16x16x32_bf16 v[216:219],a[128:131],v[24:27],v[216:219]
v_fma_f32 v86,v86,s36,v14
v_fma_f32 v100,v100,s36,v16
v_mfma_f32_16x16x32_bf16 v[220:223],a[132:135],v[24:27],v[220:223]
v_exp_f32 v100,v100
v_mfma_f32_16x16x32_bf16 v[172:175],a[132:135],v[20:23],v[172:175]
ds_read_b64_tr_b16 a[132:133],v5 offset:24832
v_fma_f32 v84,v84,s36,v14
v_mfma_f32_16x16x32_bf16 v[168:171],a[128:131],v[20:23],v[168:171]
s_waitcnt lgkmcnt(4)
ds_read_b64_tr_b16 a[128:129],v4 offset:24832
v_exp_f32 v98,v98
v_mfma_f32_16x16x32_bf16 v[176:179],a[136:139],v[20:23],v[176:179]
ds_read_b64_tr_b16 a[130:131],v4 offset:30976
v_exp_f32 v79,v79
v_mfma_f32_16x16x32_bf16 v[180:183],a[140:143],v[20:23],v[180:183]
ds_read_b64_tr_b16 a[134:135],v5 offset:30976
v_exp_f32 v89,v89
v_mfma_f32_16x16x32_bf16 v[228:231],a[140:143],v[24:27],v[228:231]
v_fma_f32 v82,v82,s36,v14
v_exp_f32 v82,v82
v_mfma_f32_16x16x32_bf16 v[224:227],a[136:139],v[24:27],v[224:227]
v_fma_f32 v77,v77,s36,v13
v_exp_f32 v77,v77
v_mfma_f32_16x16x32_bf16 v[128:131],a[136:139],v[28:31],v[128:131]
v_fma_f32 v87,v87,s36,v14
v_exp_f32 v87,v87
v_mfma_f32_16x16x32_bf16 v[132:135],a[140:143],v[28:31],v[132:135]
v_exp_f32 v96,v96
v_mfma_f32_16x16x32_bf16 a[180:183],a[140:143],v[32:35],a[180:183]
v_fma_f32 v78,v78,s36,v13
v_fma_f32 v83,v83,s36,v14
v_mfma_f32_16x16x32_bf16 a[176:179],a[136:139],v[32:35],a[176:179]
v_fma_f32 v92,v92,s36,v15
v_exp_f32 v92,v92
v_mfma_f32_16x16x32_bf16 a[184:187],a[144:147],v[32:35],a[184:187]
v_fma_f32 v90,v90,s36,v15
v_exp_f32 v90,v90
v_mfma_f32_16x16x32_bf16 a[188:191],a[148:151],v[32:35],a[188:191]
v_fma_f32 v101,v101,s36,v16
v_exp_f32 v101,v101
v_mfma_f32_16x16x32_bf16 v[140:143],a[148:151],v[28:31],v[140:143]
v_fma_f32 v99,v99,s36,v16
v_exp_f32 v99,v99
v_mfma_f32_16x16x32_bf16 v[136:139],a[144:147],v[28:31],v[136:139]
v_exp_f32 v84,v84
v_mfma_f32_16x16x32_bf16 v[232:235],a[144:147],v[24:27],v[232:235]
v_fma_f32 v94,v94,s36,v15
v_fma_f32 v88,v88,s36,v15
v_mfma_f32_16x16x32_bf16 v[236:239],a[148:151],v[24:27],v[236:239]
v_fma_f32 v97,v97,s36,v16
v_exp_f32 v97,v97
v_mfma_f32_16x16x32_bf16 v[188:191],a[148:151],v[20:23],v[188:191]
v_fma_f32 v93,v93,s36,v15
v_exp_f32 v93,v93
v_mfma_f32_16x16x32_bf16 v[184:187],a[144:147],v[20:23],v[184:187]
s_waitcnt lgkmcnt(0)
v_exp_f32 v94,v94
v_mfma_f32_16x16x32_bf16 v[192:195],a[120:123],v[20:23],v[192:195]
v_exp_f32 v83,v83
v_mfma_f32_16x16x32_bf16 v[196:199],a[124:127],v[20:23],v[196:199]
v_exp_f32 v103,v103
v_mfma_f32_16x16x32_bf16 v[244:247],a[124:127],v[24:27],v[244:247]
v_exp_f32 v78,v78
v_mfma_f32_16x16x32_bf16 v[240:243],a[120:123],v[24:27],v[240:243]
v_exp_f32 v95,v95
v_mfma_f32_16x16x32_bf16 v[144:147],a[120:123],v[28:31],v[144:147]
v_cvt_pk_bf16_f32 v55,v94,v95
s_waitcnt vmcnt(12)
s_barrier
v_mfma_f32_16x16x32_bf16 v[148:151],a[124:127],v[28:31],v[148:151]
v_exp_f32 v91,v91
v_mfma_f32_16x16x32_bf16 a[196:199],a[124:127],v[32:35],a[196:199]
v_exp_f32 v85,v85
v_mfma_f32_16x16x32_bf16 a[192:195],a[120:123],v[32:35],a[192:195]
v_exp_f32 v88,v88
v_mfma_f32_16x16x32_bf16 a[200:203],a[128:131],v[32:35],a[200:203]
v_cvt_pk_bf16_f32 v52,v88,v89
v_exp_f32 v86,v86
v_mfma_f32_16x16x32_bf16 a[204:207],a[132:135],v[32:35],a[204:207]
v_cvt_pk_bf16_f32 v46,v76,v77
v_cvt_pk_bf16_f32 v49,v82,v83
v_mfma_f32_16x16x32_bf16 v[156:159],a[132:135],v[28:31],v[156:159]
v_cvt_pk_bf16_f32 v57,v98,v99
v_cvt_pk_bf16_f32 v47,v78,v79
v_mfma_f32_16x16x32_bf16 v[152:155],a[128:131],v[28:31],v[152:155]
v_cvt_pk_bf16_f32 v58,v100,v101
v_cvt_pk_bf16_f32 v59,v102,v103
v_mfma_f32_16x16x32_bf16 v[248:251],a[128:131],v[24:27],v[248:251]
v_cvt_pk_bf16_f32 v54,v92,v93
v_cvt_pk_bf16_f32 v50,v84,v85
v_mfma_f32_16x16x32_bf16 v[252:255],a[132:135],v[24:27],v[252:255]
v_cvt_pk_bf16_f32 v53,v90,v91
v_cvt_pk_bf16_f32 v51,v86,v87
v_mfma_f32_16x16x32_bf16 v[204:207],a[132:135],v[20:23],v[204:207]
v_cvt_pk_bf16_f32 v56,v96,v97
v_subrev_u32 v10,18432,v10
v_smfmac_f32_16x16x64_bf16 v[60:63],a[152:155],v[44:51],v18
ds_read_b64_tr_b16 a[138:139],v2 offset:6144
v_smfmac_f32_16x16x64_bf16 v[64:67],a[152:155],v[52:59],v18
ds_read_b64_tr_b16 a[136:137],v2 offset:0
v_mfma_f32_16x16x32_bf16 v[200:203],a[128:131],v[20:23],v[200:203]
ds_read_b64_tr_b16 a[142:143],v3 offset:6144
ds_read_b64_tr_b16 a[140:141],v3 offset:0
ds_read_b64_tr_b16 a[146:147],v4 offset:6144
ds_read_b64_tr_b16 a[144:145],v4 offset:0
ds_read_b64_tr_b16 a[150:151],v5 offset:6144
ds_read_b64_tr_b16 a[148:149],v5 offset:0
s_waitcnt lgkmcnt(6)
v_mfma_f32_16x16x32_bf16 v[160:163],a[136:139],v[44:47],v[160:163]
s_waitcnt vmcnt(6)
ds_read_b64_tr_b16 a[120:121],v2 offset:128
v_mbcnt_lo_u32_b32 v39,-1,0
s_waitcnt lgkmcnt(5)
v_mfma_f32_16x16x32_bf16 v[164:167],a[140:143],v[44:47],v[164:167]
s_add_u32 s84,s42,0
ds_read_b64_tr_b16 a[122:123],v2 offset:6272
v_mbcnt_hi_u32_b32 v39,-1,v39
v_mfma_f32_16x16x32_bf16 v[212:215],a[140:143],v[48:51],v[212:215]
s_add_u32 s85,s42,6144
ds_read_b64_tr_b16 a[124:125],v3 offset:128
v_and_b32 v38,7,v39
v_mfma_f32_16x16x32_bf16 v[208:211],a[136:139],v[48:51],v[208:211]
s_add_u32 s86,s42,12288
ds_read_b64_tr_b16 a[126:127],v3 offset:6272
v_lshrrev_b32 v19,5,v39
v_mfma_f32_16x16x32_bf16 v[112:115],a[136:139],v[52:55],v[112:115]
s_add_u32 s87,s42,18432
ds_read_b64_tr_b16 a[128:129],v4 offset:128
v_xor_b32 v38,v38,v19
v_mfma_f32_16x16x32_bf16 v[116:119],a[140:143],v[52:55],v[116:119]
ds_read_b64_tr_b16 a[130:131],v4 offset:6272
ds_read_b64_tr_b16 a[132:133],v5 offset:128
ds_read_b64_tr_b16 a[134:135],v5 offset:6272
v_mfma_f32_16x16x32_bf16 a[164:167],a[140:143],v[56:59],a[164:167]
ds_read_b64_tr_b16 a[140:141],v3 offset:256
v_and_b32 v19,15,v39
v_mfma_f32_16x16x32_bf16 a[160:163],a[136:139],v[56:59],a[160:163]
s_waitcnt lgkmcnt(8)
ds_read_b64_tr_b16 a[136:137],v2 offset:256
v_lshl_add_u32 v19,v19,7,s24
v_mfma_f32_16x16x32_bf16 a[168:171],a[144:147],v[56:59],a[168:171]
ds_read_b64_tr_b16 a[138:139],v2 offset:6400
v_lshl_add_u32 v19,v38,4,v19
v_mfma_f32_16x16x32_bf16 a[172:175],a[148:151],v[56:59],a[172:175]
ds_read_b64_tr_b16 a[142:143],v3 offset:6400
v_bfe_u32 v38,v39,4,1
v_mfma_f32_16x16x32_bf16 v[124:127],a[148:151],v[52:55],v[124:127]
v_lshl_add_u32 v36,v38,3,v19
v_bfe_u32 v19,v39,3,1
v_mfma_f32_16x16x32_bf16 v[120:123],a[144:147],v[52:55],v[120:123]
v_xor_b32 v37,32,v36
v_xor_b32 v38,64,v36
v_mfma_f32_16x16x32_bf16 v[216:219],a[144:147],v[48:51],v[216:219]
v_lshlrev_b32 v19,11,v19
v_xor_b32 v39,96,v36
v_mfma_f32_16x16x32_bf16 v[220:223],a[148:151],v[48:51],v[220:223]
v_add_u32 v36,v36,v19
v_add_u32 v37,v37,v19
v_mfma_f32_16x16x32_bf16 v[172:175],a[148:151],v[44:47],v[172:175]
ds_read_b64_tr_b16 a[148:149],v5 offset:256
v_add_u32 v38,v38,v19
v_mfma_f32_16x16x32_bf16 v[168:171],a[144:147],v[44:47],v[168:171]
s_waitcnt lgkmcnt(2)
ds_read_b64_tr_b16 a[144:145],v4 offset:256
v_add_u32 v39,v39,v19
v_mfma_f32_16x16x32_bf16 v[176:179],a[120:123],v[44:47],v[176:179]
ds_read_b64_tr_b16 a[146:147],v4 offset:6400
v_add_f32 v62,v62,v63
v_mfma_f32_16x16x32_bf16 v[180:183],a[124:127],v[44:47],v[180:183]
ds_read_b64_tr_b16 a[150:151],v5 offset:6400
v_rcp_f32 v62,v62
v_mfma_f32_16x16x32_bf16 v[228:231],a[124:127],v[48:51],v[228:231]
v_add_f32 v66,v66,v67
v_rcp_f32 v66,v66
v_mfma_f32_16x16x32_bf16 v[224:227],a[120:123],v[48:51],v[224:227]
v_accvgpr_read_b32 v96,a164
v_accvgpr_read_b32 v97,a165
v_mfma_f32_16x16x32_bf16 v[128:131],a[120:123],v[52:55],v[128:131]
v_accvgpr_read_b32 v98,a166
v_accvgpr_read_b32 v99,a167
v_mfma_f32_16x16x32_bf16 v[132:135],a[124:127],v[52:55],v[132:135]
v_accvgpr_read_b32 v88,a160
v_accvgpr_read_b32 v89,a161
v_mfma_f32_16x16x32_bf16 a[180:183],a[124:127],v[56:59],a[180:183]
v_accvgpr_read_b32 v90,a162
v_accvgpr_read_b32 v91,a163
v_accvgpr_read_b32 v104,a168
v_accvgpr_read_b32 v105,a169
v_accvgpr_read_b32 v106,a170
v_pk_mul_f32 v[208:209],v[208:209],v[62:63] op_sel_hi:[1,0]
v_pk_mul_f32 v[210:211],v[210:211],v[62:63] op_sel_hi:[1,0]
v_pk_mul_f32 v[224:225],v[224:225],v[62:63] op_sel_hi:[1,0]
v_pk_mul_f32 v[226:227],v[226:227],v[62:63] op_sel_hi:[1,0]
v_pk_mul_f32 v[212:213],v[212:213],v[62:63] op_sel_hi:[1,0]
v_pk_mul_f32 v[214:215],v[214:215],v[62:63] op_sel_hi:[1,0]
v_pk_mul_f32 v[228:229],v[228:229],v[62:63] op_sel_hi:[1,0]
v_pk_mul_f32 v[230:231],v[230:231],v[62:63] op_sel_hi:[1,0]
v_cvt_pk_bf16_f32 v208,v208,v209
v_cvt_pk_bf16_f32 v224,v224,v225
v_mfma_f32_16x16x32_bf16 a[176:179],a[120:123],v[56:59],a[176:179]
v_cvt_pk_bf16_f32 v209,v210,v211
v_cvt_pk_bf16_f32 v225,v226,v227
v_mfma_f32_16x16x32_bf16 a[184:187],a[128:131],v[56:59],a[184:187]
ds_write2st64_b64 v36,v[208:209],v[224:225] offset0:12 offset1:14
v_mfma_f32_16x16x32_bf16 a[188:191],a[132:135],v[56:59],a[188:191]
v_sub_u32 v36,v36,v19
v_accvgpr_read_b32 v107,a171
v_mfma_f32_16x16x32_bf16 v[140:143],a[132:135],v[52:55],v[140:143]
v_accvgpr_read_b32 v100,a180
v_accvgpr_read_b32 v101,a181
v_mfma_f32_16x16x32_bf16 v[136:139],a[128:131],v[52:55],v[136:139]
v_accvgpr_read_b32 v102,a182
v_accvgpr_read_b32 v103,a183
v_mfma_f32_16x16x32_bf16 v[232:235],a[128:131],v[48:51],v[232:235]
v_accvgpr_read_b32 v92,a176
v_accvgpr_read_b32 v93,a177
v_mfma_f32_16x16x32_bf16 v[236:239],a[132:135],v[48:51],v[236:239]
v_accvgpr_read_b32 v94,a178
v_accvgpr_read_b32 v95,a179
v_mfma_f32_16x16x32_bf16 v[188:191],a[132:135],v[44:47],v[188:191]
v_accvgpr_read_b32 v210,a174
v_accvgpr_read_b32 v211,a175
v_mfma_f32_16x16x32_bf16 v[184:187],a[128:131],v[44:47],v[184:187]
v_accvgpr_read_b32 v108,a184
v_accvgpr_read_b32 v109,a185
v_accvgpr_read_b32 v110,a186
v_accvgpr_read_b32 v111,a187
v_accvgpr_read_b32 v208,a172
v_pk_mul_f32 v[216:217],v[216:217],v[62:63] op_sel_hi:[1,0]
v_pk_mul_f32 v[218:219],v[218:219],v[62:63] op_sel_hi:[1,0]
v_pk_mul_f32 v[232:233],v[232:233],v[62:63] op_sel_hi:[1,0]
v_pk_mul_f32 v[234:235],v[234:235],v[62:63] op_sel_hi:[1,0]
v_accvgpr_read_b32 v209,a173
v_accvgpr_read_b32 v224,a188
v_mfma_f32_16x16x32_bf16 v[192:195],a[136:139],v[44:47],v[192:195]
v_accvgpr_read_b32 v225,a189
v_accvgpr_read_b32 v226,a190
v_accvgpr_read_b32 v227,a191
v_add_f32 v64,v64,v65
v_rcp_f32 v64,v64
v_pk_mul_f32 v[220:221],v[220:221],v[62:63] op_sel_hi:[1,0]
v_pk_mul_f32 v[222:223],v[222:223],v[62:63] op_sel_hi:[1,0]
v_pk_mul_f32 v[236:237],v[236:237],v[62:63] op_sel_hi:[1,0]
v_pk_mul_f32 v[238:239],v[238:239],v[62:63] op_sel_hi:[1,0]
v_pk_mul_f32 v[88:89],v[88:89],v[66:67] op_sel_hi:[1,0]
v_pk_mul_f32 v[90:91],v[90:91],v[66:67] op_sel_hi:[1,0]
v_pk_mul_f32 v[92:93],v[92:93],v[66:67] op_sel_hi:[1,0]
v_pk_mul_f32 v[94:95],v[94:95],v[66:67] op_sel_hi:[1,0]
v_pk_mul_f32 v[96:97],v[96:97],v[66:67] op_sel_hi:[1,0]
v_pk_mul_f32 v[98:99],v[98:99],v[66:67] op_sel_hi:[1,0]
v_pk_mul_f32 v[100:101],v[100:101],v[66:67] op_sel_hi:[1,0]
v_pk_mul_f32 v[102:103],v[102:103],v[66:67] op_sel_hi:[1,0]
v_pk_mul_f32 v[104:105],v[104:105],v[66:67] op_sel_hi:[1,0]
v_pk_mul_f32 v[106:107],v[106:107],v[66:67] op_sel_hi:[1,0]
v_pk_mul_f32 v[108:109],v[108:109],v[66:67] op_sel_hi:[1,0]
v_pk_mul_f32 v[110:111],v[110:111],v[66:67] op_sel_hi:[1,0]
v_pk_mul_f32 v[208:209],v[208:209],v[66:67] op_sel_hi:[1,0]
v_pk_mul_f32 v[210:211],v[210:211],v[66:67] op_sel_hi:[1,0]
v_pk_mul_f32 v[224:225],v[224:225],v[66:67] op_sel_hi:[1,0]
v_pk_mul_f32 v[226:227],v[226:227],v[66:67] op_sel_hi:[1,0]
v_cvt_pk_bf16_f32 v212,v212,v213
v_cvt_pk_bf16_f32 v228,v228,v229
s_waitcnt lgkmcnt(0)
v_mfma_f32_16x16x32_bf16 v[196:199],a[140:143],v[44:47],v[196:199]
v_cvt_pk_bf16_f32 v216,v216,v217
v_cvt_pk_bf16_f32 v232,v232,v233
v_mfma_f32_16x16x32_bf16 v[244:247],a[140:143],v[48:51],v[244:247]
v_cvt_pk_bf16_f32 v213,v214,v215
v_cvt_pk_bf16_f32 v229,v230,v231
v_mfma_f32_16x16x32_bf16 v[240:243],a[136:139],v[48:51],v[240:243]
ds_write2st64_b64 v37,v[212:213],v[228:229] offset0:12 offset1:14
v_mfma_f32_16x16x32_bf16 v[144:147],a[136:139],v[52:55],v[144:147]
v_sub_u32 v37,v37,v19
v_cvt_pk_bf16_f32 v220,v220,v221
v_mfma_f32_16x16x32_bf16 v[148:151],a[140:143],v[52:55],v[148:151]
v_cvt_pk_bf16_f32 v236,v236,v237
v_cvt_pk_bf16_f32 v217,v218,v219
v_mfma_f32_16x16x32_bf16 a[196:199],a[140:143],v[56:59],a[196:199]
v_cvt_pk_bf16_f32 v233,v234,v235
ds_write2st64_b64 v38,v[216:217],v[232:233] offset0:12 offset1:14
v_pk_mul_f32 v[240:241],v[240:241],v[62:63] op_sel_hi:[1,0]
v_pk_mul_f32 v[242:243],v[242:243],v[62:63] op_sel_hi:[1,0]
v_pk_mul_f32 v[112:113],v[112:113],v[64:65] op_sel_hi:[1,0]
v_pk_mul_f32 v[114:115],v[114:115],v[64:65] op_sel_hi:[1,0]
v_pk_mul_f32 v[244:245],v[244:245],v[62:63] op_sel_hi:[1,0]
v_pk_mul_f32 v[246:247],v[246:247],v[62:63] op_sel_hi:[1,0]
v_pk_mul_f32 v[116:117],v[116:117],v[64:65] op_sel_hi:[1,0]
v_pk_mul_f32 v[118:119],v[118:119],v[64:65] op_sel_hi:[1,0]
v_sub_u32 v38,v38,v19
v_cvt_pk_bf16_f32 v221,v222,v223
v_mfma_f32_16x16x32_bf16 a[192:195],a[136:139],v[56:59],a[192:195]
v_cvt_pk_bf16_f32 v237,v238,v239
v_cvt_pk_bf16_f32 v88,v88,v89
v_mfma_f32_16x16x32_bf16 a[200:203],a[144:147],v[56:59],a[200:203]
ds_write2st64_b64 v39,v[220:221],v[236:237] offset0:12 offset1:14
v_mfma_f32_16x16x32_bf16 a[204:207],a[148:151],v[56:59],a[204:207]
v_sub_u32 v39,v39,v19
v_cvt_pk_bf16_f32 v92,v92,v93
v_mfma_f32_16x16x32_bf16 v[156:159],a[148:151],v[52:55],v[156:159]
ds_read_b128 v[72:75],v10 offset:6144
v_cvt_pk_bf16_f32 v96,v96,v97
v_mfma_f32_16x16x32_bf16 v[152:155],a[144:147],v[52:55],v[152:155]
ds_read_b128 v[76:79],v10 offset:9216
v_cvt_pk_bf16_f32 v100,v100,v101
v_mfma_f32_16x16x32_bf16 v[248:251],a[144:147],v[48:51],v[248:251]
ds_read_b128 v[80:83],v10 offset:7168
v_cvt_pk_bf16_f32 v89,v90,v91
v_mfma_f32_16x16x32_bf16 v[252:255],a[148:151],v[48:51],v[252:255]
ds_read_b128 v[84:87],v10 offset:10240
v_cvt_pk_bf16_f32 v93,v94,v95
v_mfma_f32_16x16x32_bf16 v[204:207],a[148:151],v[44:47],v[204:207]
ds_write2st64_b64 v36,v[88:89],v[92:93] offset0:36 offset1:40
v_mfma_f32_16x16x32_bf16 v[200:203],a[144:147],v[44:47],v[200:203]
v_add_u32 v36,v36,v19
v_cvt_pk_bf16_f32 v104,v104,v105
v_cvt_pk_bf16_f32 v108,v108,v109
v_cvt_pk_bf16_f32 v97,v98,v99
v_cvt_pk_bf16_f32 v101,v102,v103
s_waitcnt lgkmcnt(4)
buffer_store_dwordx4 v[72:75],v9,s[16:19],s85 offen offset:0 nt
v_pk_mul_f32 v[248:249],v[248:249],v[62:63] op_sel_hi:[1,0]
v_pk_mul_f32 v[120:121],v[120:121],v[64:65] op_sel_hi:[1,0]
v_pk_mul_f32 v[250:251],v[250:251],v[62:63] op_sel_hi:[1,0]
v_pk_mul_f32 v[122:123],v[122:123],v[64:65] op_sel_hi:[1,0]
v_pk_mul_f32 v[252:253],v[252:253],v[62:63] op_sel_hi:[1,0]
v_pk_mul_f32 v[124:125],v[124:125],v[64:65] op_sel_hi:[1,0]
v_pk_mul_f32 v[254:255],v[254:255],v[62:63] op_sel_hi:[1,0]
v_pk_mul_f32 v[126:127],v[126:127],v[64:65] op_sel_hi:[1,0]
v_pk_mul_f32 v[128:129],v[128:129],v[64:65] op_sel_hi:[1,0]
ds_write2st64_b64 v37,v[96:97],v[100:101] offset0:36 offset1:40
v_pk_mul_f32 v[144:145],v[144:145],v[64:65] op_sel_hi:[1,0]
v_pk_mul_f32 v[130:131],v[130:131],v[64:65] op_sel_hi:[1,0]
v_pk_mul_f32 v[146:147],v[146:147],v[64:65] op_sel_hi:[1,0]
s_waitcnt lgkmcnt(1)
buffer_store_dwordx4 v[76:79],v9,s[16:19],s85 offen offset:3072 nt
v_pk_mul_f32 v[132:133],v[132:133],v[64:65] op_sel_hi:[1,0]
v_pk_mul_f32 v[148:149],v[148:149],v[64:65] op_sel_hi:[1,0]
v_pk_mul_f32 v[134:135],v[134:135],v[64:65] op_sel_hi:[1,0]
v_pk_mul_f32 v[150:151],v[150:151],v[64:65] op_sel_hi:[1,0]
v_pk_mul_f32 v[136:137],v[136:137],v[64:65] op_sel_hi:[1,0]
v_pk_mul_f32 v[152:153],v[152:153],v[64:65] op_sel_hi:[1,0]
v_pk_mul_f32 v[138:139],v[138:139],v[64:65] op_sel_hi:[1,0]
v_pk_mul_f32 v[154:155],v[154:155],v[64:65] op_sel_hi:[1,0]
v_pk_mul_f32 v[140:141],v[140:141],v[64:65] op_sel_hi:[1,0]
v_pk_mul_f32 v[156:157],v[156:157],v[64:65] op_sel_hi:[1,0]
v_pk_mul_f32 v[142:143],v[142:143],v[64:65] op_sel_hi:[1,0]
buffer_store_dwordx4 v[80:83],v9,s[16:19],s85 offen offset:128 nt
v_pk_mul_f32 v[158:159],v[158:159],v[64:65] op_sel_hi:[1,0]
v_add_u32 v37,v37,v19
v_cvt_pk_bf16_f32 v208,v208,v209
v_cvt_pk_bf16_f32 v224,v224,v225
v_cvt_pk_bf16_f32 v105,v106,v107
v_cvt_pk_bf16_f32 v109,v110,v111
v_cvt_pk_bf16_f32 v209,v210,v211
v_cvt_pk_bf16_f32 v225,v226,v227
v_cvt_pk_bf16_f32 v240,v240,v241
ds_write2st64_b64 v38,v[104:105],v[108:109] offset0:36 offset1:40
v_add_u32 v38,v38,v19
v_cvt_pk_bf16_f32 v112,v112,v113
v_cvt_pk_bf16_f32 v244,v244,v245
buffer_store_dwordx4 v[84:87],v9,s[16:19],s85 offen offset:3200 nt
v_cvt_pk_bf16_f32 v116,v116,v117
v_cvt_pk_bf16_f32 v241,v242,v243
v_cvt_pk_bf16_f32 v113,v114,v115
v_cvt_pk_bf16_f32 v248,v248,v249
v_cvt_pk_bf16_f32 v120,v120,v121
v_cvt_pk_bf16_f32 v245,v246,v247
v_cvt_pk_bf16_f32 v117,v118,v119
v_cvt_pk_bf16_f32 v252,v252,v253
v_cvt_pk_bf16_f32 v124,v124,v125
ds_write2st64_b64 v39,v[208:209],v[224:225] offset0:36 offset1:40
v_add_u32 v39,v39,v19
v_cvt_pk_bf16_f32 v249,v250,v251
v_cvt_pk_bf16_f32 v121,v122,v123
ds_read_b128 v[212:215],v10 offset:18432
v_cvt_pk_bf16_f32 v253,v254,v255
ds_read_b128 v[228:231],v10 offset:19456
v_cvt_pk_bf16_f32 v125,v126,v127
ds_read_b128 v[216:219],v10 offset:20480
v_accvgpr_read_b32 v72,a192
ds_read_b128 v[232:235],v10 offset:21504
v_accvgpr_read_b32 v73,a193
ds_write2st64_b64 v36,v[240:241],v[112:113] offset0:16 offset1:24
v_pk_mul_f32 v[72:73],v[72:73],v[66:67] op_sel_hi:[1,0]
v_sub_u32 v36,v36,v19
v_accvgpr_read_b32 v74,a194
v_accvgpr_read_b32 v75,a195
v_pk_mul_f32 v[74:75],v[74:75],v[66:67] op_sel_hi:[1,0]
v_accvgpr_read_b32 v76,a196
v_accvgpr_read_b32 v77,a197
s_waitcnt lgkmcnt(4)
buffer_store_dwordx4 v[212:215],v9,s[16:19],s87 offen offset:0 nt
v_pk_mul_f32 v[76:77],v[76:77],v[66:67] op_sel_hi:[1,0]
v_accvgpr_read_b32 v78,a198
v_accvgpr_read_b32 v79,a199
v_pk_mul_f32 v[78:79],v[78:79],v[66:67] op_sel_hi:[1,0]
v_accvgpr_read_b32 v80,a200
v_accvgpr_read_b32 v81,a201
v_pk_mul_f32 v[80:81],v[80:81],v[66:67] op_sel_hi:[1,0]
v_cvt_pk_bf16_f32 v72,v72,v73
v_accvgpr_read_b32 v82,a202
ds_write2st64_b64 v37,v[244:245],v[116:117] offset0:16 offset1:24
v_sub_u32 v37,v37,v19
v_accvgpr_read_b32 v83,a203
v_pk_mul_f32 v[82:83],v[82:83],v[66:67] op_sel_hi:[1,0]
s_waitcnt lgkmcnt(1)
buffer_store_dwordx4 v[228:231],v9,s[16:19],s87 offen offset:3072 nt
v_accvgpr_read_b32 v84,a204
v_accvgpr_read_b32 v85,a205
v_pk_mul_f32 v[84:85],v[84:85],v[66:67] op_sel_hi:[1,0]
v_cvt_pk_bf16_f32 v76,v76,v77
v_cvt_pk_bf16_f32 v73,v74,v75
v_accvgpr_read_b32 v86,a206
v_accvgpr_read_b32 v87,a207
v_pk_mul_f32 v[86:87],v[86:87],v[66:67] op_sel_hi:[1,0]
v_cvt_pk_bf16_f32 v80,v80,v81
ds_write2st64_b64 v38,v[248:249],v[120:121] offset0:16 offset1:24
v_sub_u32 v38,v38,v19
v_cvt_pk_bf16_f32 v77,v78,v79
v_cvt_pk_bf16_f32 v84,v84,v85
buffer_store_dwordx4 v[216:219],v9,s[16:19],s87 offen offset:128 nt
v_cvt_pk_bf16_f32 v81,v82,v83
v_cvt_pk_bf16_f32 v85,v86,v87
v_cvt_pk_bf16_f32 v128,v128,v129
v_cvt_pk_bf16_f32 v144,v144,v145
v_cvt_pk_bf16_f32 v132,v132,v133
v_cvt_pk_bf16_f32 v148,v148,v149
v_cvt_pk_bf16_f32 v129,v130,v131
v_cvt_pk_bf16_f32 v145,v146,v147
v_cvt_pk_bf16_f32 v136,v136,v137
ds_write2st64_b64 v39,v[252:253],v[124:125] offset0:16 offset1:24
v_sub_u32 v39,v39,v19
v_cvt_pk_bf16_f32 v152,v152,v153
v_cvt_pk_bf16_f32 v133,v134,v135
ds_read_b128 v[220:223],v10 offset:8192
buffer_store_dwordx4 v[232:235],v9,s[16:19],s87 offen offset:3200 nt
ds_read_b128 v[236:239],v10 offset:11264
v_cvt_pk_bf16_f32 v149,v150,v151
ds_read_b128 v[88:91],v10 offset:12288
v_add_f32 v60,v60,v61
ds_read_b128 v[92:95],v10 offset:15360
v_cvt_pk_bf16_f32 v140,v140,v141
ds_write_b64 v36,v[72:73] offset:18432
v_add_u32 v36,v36,v19
v_cvt_pk_bf16_f32 v156,v156,v157
v_cvt_pk_bf16_f32 v137,v138,v139
v_cvt_pk_bf16_f32 v153,v154,v155
ds_write_b64 v37,v[76:77] offset:18432
s_waitcnt lgkmcnt(5)
buffer_store_dwordx4 v[220:223],v9,s[16:19],s85 offen offset:256 nt
v_add_u32 v37,v37,v19
v_rcp_f32 v60,v60
v_cvt_pk_bf16_f32 v141,v142,v143
v_pk_mul_f32 v[160:161],v[160:161],v[60:61] op_sel_hi:[1,0]
v_pk_mul_f32 v[176:177],v[176:177],v[60:61] op_sel_hi:[1,0]
v_pk_mul_f32 v[162:163],v[162:163],v[60:61] op_sel_hi:[1,0]
v_pk_mul_f32 v[178:179],v[178:179],v[60:61] op_sel_hi:[1,0]
v_pk_mul_f32 v[164:165],v[164:165],v[60:61] op_sel_hi:[1,0]
ds_write_b64 v38,v[80:81] offset:18432
s_waitcnt lgkmcnt(2)
buffer_store_dwordx4 v[236:239],v9,s[16:19],s85 offen offset:3328 nt
v_pk_mul_f32 v[180:181],v[180:181],v[60:61] op_sel_hi:[1,0]
v_pk_mul_f32 v[166:167],v[166:167],v[60:61] op_sel_hi:[1,0]
v_pk_mul_f32 v[182:183],v[182:183],v[60:61] op_sel_hi:[1,0]
v_pk_mul_f32 v[168:169],v[168:169],v[60:61] op_sel_hi:[1,0]
v_pk_mul_f32 v[184:185],v[184:185],v[60:61] op_sel_hi:[1,0]
v_pk_mul_f32 v[170:171],v[170:171],v[60:61] op_sel_hi:[1,0]
v_pk_mul_f32 v[186:187],v[186:187],v[60:61] op_sel_hi:[1,0]
v_pk_mul_f32 v[172:173],v[172:173],v[60:61] op_sel_hi:[1,0]
v_pk_mul_f32 v[188:189],v[188:189],v[60:61] op_sel_hi:[1,0]
ds_write_b64 v39,v[84:85] offset:18432
ds_read_b128 v[96:99],v10 offset:18432
buffer_store_dwordx4 v[88:91],v9,s[16:19],s86 offen offset:0 nt
ds_read_b128 v[100:103],v10 offset:19456
v_pk_mul_f32 v[174:175],v[174:175],v[60:61] op_sel_hi:[1,0]
v_pk_mul_f32 v[190:191],v[190:191],v[60:61] op_sel_hi:[1,0]
v_pk_mul_f32 v[192:193],v[192:193],v[60:61] op_sel_hi:[1,0]
v_pk_mul_f32 v[194:195],v[194:195],v[60:61] op_sel_hi:[1,0]
v_pk_mul_f32 v[196:197],v[196:197],v[60:61] op_sel_hi:[1,0]
v_pk_mul_f32 v[198:199],v[198:199],v[60:61] op_sel_hi:[1,0]
v_pk_mul_f32 v[200:201],v[200:201],v[60:61] op_sel_hi:[1,0]
ds_write2st64_b64 v36,v[128:129],v[144:145] offset0:26 offset1:28
v_pk_mul_f32 v[202:203],v[202:203],v[60:61] op_sel_hi:[1,0]
v_pk_mul_f32 v[204:205],v[204:205],v[60:61] op_sel_hi:[1,0]
v_pk_mul_f32 v[206:207],v[206:207],v[60:61] op_sel_hi:[1,0]
buffer_store_dwordx4 v[92:95],v9,s[16:19],s86 offen offset:3072 nt
v_add_u32 v38,v38,v19
v_add_u32 v39,v39,v19
v_cvt_pk_bf16_f32 v157,v158,v159
v_cvt_pk_bf16_f32 v160,v160,v161
v_cvt_pk_bf16_f32 v176,v176,v177
v_cvt_pk_bf16_f32 v164,v164,v165
v_cvt_pk_bf16_f32 v180,v180,v181
v_cvt_pk_bf16_f32 v161,v162,v163
v_cvt_pk_bf16_f32 v177,v178,v179
ds_write2st64_b64 v37,v[132:133],v[148:149] offset0:26 offset1:28
v_cvt_pk_bf16_f32 v168,v168,v169
v_cvt_pk_bf16_f32 v184,v184,v185
v_cvt_pk_bf16_f32 v165,v166,v167
s_waitcnt lgkmcnt(1)
buffer_store_dwordx4 v[96:99],v9,s[16:19],s87 offen offset:256 nt
v_cvt_pk_bf16_f32 v181,v182,v183
v_cvt_pk_bf16_f32 v172,v172,v173
v_cvt_pk_bf16_f32 v188,v188,v189
v_cvt_pk_bf16_f32 v169,v170,v171
v_cvt_pk_bf16_f32 v185,v186,v187
v_cvt_pk_bf16_f32 v173,v174,v175
v_cvt_pk_bf16_f32 v189,v190,v191
v_cvt_pk_bf16_f32 v192,v192,v193
v_cvt_pk_bf16_f32 v196,v196,v197
ds_write2st64_b64 v38,v[136:137],v[152:153] offset0:26 offset1:28
v_cvt_pk_bf16_f32 v193,v194,v195
v_cvt_pk_bf16_f32 v200,v200,v201
v_cvt_pk_bf16_f32 v197,v198,v199
buffer_store_dwordx4 v[100:103],v9,s[16:19],s87 offen offset:3328 nt
v_cvt_pk_bf16_f32 v204,v204,v205
v_cvt_pk_bf16_f32 v201,v202,v203
v_cvt_pk_bf16_f32 v205,v206,v207
v_min3_f32 v61,v60,v62,v64
v_min_f32 v61,v61,v66
v_cmp_nlt_f32 vcc,s37,v61
ds_write2st64_b64 v39,v[140:141],v[156:157] offset0:26 offset1:28
ds_read_b128 v[104:107],v10 offset:13312
ds_read_b128 v[108:111],v10 offset:16384
ds_read_b128 v[208:211],v10 offset:14336
s_cmp_lg_u64 vcc,0
ds_read_b128 v[224:227],v10 offset:17408
s_cselect_b32 s62,s32,0
ds_write2st64_b64 v36,v[160:161],v[176:177] offset0:0 offset1:2
s_or_b32 s31,s31,s62
s_lshl_b32 s32,s32,1
s_waitcnt lgkmcnt(4)
buffer_store_dwordx4 v[104:107],v9,s[16:19],s86 offen offset:128 nt
ds_write2st64_b64 v37,v[164:165],v[180:181] offset0:0 offset1:2
s_waitcnt lgkmcnt(1)
buffer_store_dwordx4 v[108:111],v9,s[16:19],s86 offen offset:3200 nt
ds_write2st64_b64 v38,v[168:169],v[184:185] offset0:0 offset1:2
buffer_store_dwordx4 v[208:211],v9,s[16:19],s86 offen offset:256 nt
ds_write2st64_b64 v39,v[172:173],v[188:189] offset0:0 offset1:2
ds_read_b128 v[240:243],v10 offset:0
buffer_store_dwordx4 v[224:227],v9,s[16:19],s86 offen offset:3328 nt
ds_read_b128 v[112:115],v10 offset:3072
ds_read_b128 v[212:215],v10 offset:1024
ds_read_b128 v[228:231],v10 offset:4096
ds_write_b64 v36,v[192:193] offset:2048
ds_write_b64 v37,v[196:197] offset:2048
s_waitcnt lgkmcnt(5)
buffer_store_dwordx4 v[240:243],v9,s[16:19],s84 offen offset:0 nt
ds_write_b64 v38,v[200:201] offset:2048
s_waitcnt lgkmcnt(2)
buffer_store_dwordx4 v[112:115],v9,s[16:19],s84 offen offset:3072 nt
ds_write_b64 v39,v[204:205] offset:2048
ds_read_b128 v[216:219],v10 offset:2048
buffer_store_dwordx4 v[212:215],v9,s[16:19],s84 offen offset:128 nt
ds_read_b128 v[232:235],v10 offset:5120
buffer_store_dwordx4 v[228:231],v9,s[16:19],s84 offen offset:3200 nt
s_waitcnt lgkmcnt(1)
buffer_store_dwordx4 v[216:219],v9,s[16:19],s84 offen offset:256 nt
s_waitcnt lgkmcnt(0)
buffer_store_dwordx4 v[232:235],v9,s[16:19],s84 offen offset:3328 nt
s_branch L_fin
L_fin:
s_waitcnt vmcnt(0)
L_stamped:
s_cmp_lg_u32 s31,0
s_cbranch_scc1 L_fix
L_done:
L_end:
s_endpgm
L_fix:
s_sub_u32 s62,s24,36864
v_add_u32 v112,s62,v2
v_add_u32 v113,s62,v3
v_add_u32 v114,s62,v4
v_add_u32 v115,s62,v5
v_mbcnt_lo_u32_b32 v19,-1,0
v_mbcnt_hi_u32_b32 v19,-1,v19
v_and_b32 v81,15,v19
v_mul_u32_u24 v81,384,v81
v_lshrrev_b32 v82,4,v19
v_lshl_add_u32 v83,v82,3,v81
v_lshl_add_u32 v81,v82,4,v81
L_fix_pass:
s_ff1_i32_b32 s50,s31
s_bitset0_b32 s31,s50
s_lshl_b32 s62,s50,5
s_add_u32 s62,s62,s34
s_mul_i32 s63,s62,171
s_lshr_b32 s63,s63,9
s_mul_i32 s64,s63,3
s_sub_u32 s62,s62,s64
s_add_u32 s63,s63,s33
s_mul_i32 s30,s63,196608
s_mul_i32 s41,s63,325632
s_lshl_b32 s63,s3,2
s_add_u32 s64,s63,21
s_cmp_eq_u32 s3,0
s_cselect_b32 s64,20,s64
s_cselect_b32 s40,1,0
s_add_u32 s65,s63,37
s_cmp_eq_u32 s62,2
s_cselect_b32 s64,s65,s64
s_cselect_b32 s40,0,s40
s_add_u32 s65,s63,s3
s_cmp_eq_u32 s62,0
s_cselect_b32 s64,s65,s64
s_cselect_b32 s40,1,s40
s_mul_i32 s64,s64,6144
s_add_u32 s41,s41,s64
s_add_u32 s55,s40,4
s_mov_b32 s51,0
L_fix_tile:
buffer_load_dwordx4 a[0:3],v81,s[12:15],s41 offen offset:0
buffer_load_dwordx4 a[4:7],v81,s[12:15],s41 offen offset:64
buffer_load_dwordx4 a[8:11],v81,s[12:15],s41 offen offset:128
buffer_load_dwordx4 a[12:15],v81,s[12:15],s41 offen offset:192
buffer_load_dwordx4 a[16:19],v81,s[12:15],s41 offen offset:256
buffer_load_dwordx4 a[20:23],v81,s[12:15],s41 offen offset:320
v_mov_b32 v80,0xff800000
s_mov_b32 s53,s30
s_mov_b32 s52,0
L_fix_max:
s_mov_b32 s63,s53
s_add_u32 m0,s24,0
s_nop 0
buffer_load_dwordx4 v6,s[4:7],s63 offen offset:0 lds
buffer_load_dwordx4 v7,s[4:7],s63 offen offset:1024 lds
buffer_load_dwordx4 v8,s[4:7],s63 offen offset:2048 lds
s_add_u32 s63,s63,3072
s_add_u32 m0,s24,3072
s_nop 0
buffer_load_dwordx4 v6,s[4:7],s63 offen offset:0 lds
buffer_load_dwordx4 v7,s[4:7],s63 offen offset:1024 lds
buffer_load_dwordx4 v8,s[4:7],s63 offen offset:2048 lds
s_add_u32 s63,s63,3072
s_add_u32 m0,s24,6144
s_nop 0
buffer_load_dwordx4 v6,s[4:7],s63 offen offset:0 lds
buffer_load_dwordx4 v7,s[4:7],s63 offen offset:1024 lds
buffer_load_dwordx4 v8,s[4:7],s63 offen offset:2048 lds
s_add_u32 s63,s63,3072
s_add_u32 m0,s24,9216
s_nop 0
buffer_load_dwordx4 v6,s[4:7],s63 offen offset:0 lds
buffer_load_dwordx4 v7,s[4:7],s63 offen offset:1024 lds
buffer_load_dwordx4 v8,s[4:7],s63 offen offset:2048 lds
s_add_u32 s63,s63,3072
s_waitcnt vmcnt(0)
ds_read_b128 a[160:163],v11 offset:0
ds_read_b128 a[164:167],v12 offset:0
ds_read_b128 a[168:171],v11 offset:128
ds_read_b128 a[172:175],v12 offset:128
ds_read_b128 a[176:179],v11 offset:256
ds_read_b128 a[180:183],v12 offset:256
ds_read_b128 a[184:187],v11 offset:6144
ds_read_b128 a[188:191],v12 offset:6144
ds_read_b128 a[192:195],v11 offset:6272
ds_read_b128 a[196:199],v12 offset:6272
ds_read_b128 a[200:203],v11 offset:6400
ds_read_b128 a[204:207],v12 offset:6400
s_waitcnt lgkmcnt(0)
v_mfma_f32_16x16x32_bf16 v[72:75],a[160:163],a[0:3],0
v_mfma_f32_16x16x32_bf16 v[72:75],a[164:167],a[4:7],v[72:75]
v_mfma_f32_16x16x32_bf16 v[72:75],a[168:171],a[8:11],v[72:75]
v_mfma_f32_16x16x32_bf16 v[72:75],a[172:175],a[12:15],v[72:75]
v_mfma_f32_16x16x32_bf16 v[72:75],a[176:179],a[16:19],v[72:75]
v_mfma_f32_16x16x32_bf16 v[72:75],a[180:183],a[20:23],v[72:75]
v_mfma_f32_16x16x32_bf16 v[76:79],a[184:187],a[0:3],0
v_mfma_f32_16x16x32_bf16 v[76:79],a[188:191],a[4:7],v[76:79]
v_mfma_f32_16x16x32_bf16 v[76:79],a[192:195],a[8:11],v[76:79]
v_mfma_f32_16x16x32_bf16 v[76:79],a[196:199],a[12:15],v[76:79]
v_mfma_f32_16x16x32_bf16 v[76:79],a[200:203],a[16:19],v[76:79]
v_mfma_f32_16x16x32_bf16 v[76:79],a[204:207],a[20:23],v[76:79]
s_nop 7
v_max3_f32 v80,v80,v72,v73
v_max3_f32 v80,v80,v74,v75
v_max3_f32 v80,v80,v76,v77
v_max3_f32 v80,v80,v78,v79
s_add_u32 s53,s53,12288
s_add_u32 s52,s52,1
s_cmp_lt_u32 s52,16
s_cbranch_scc1 L_fix_max
v_mov_b32 v19,v80
s_nop 1
v_permlane32_swap_b32 v19,v80
v_max_f32 v80,v80,v19
v_mov_b32 v19,v80
s_nop 1
v_permlane16_swap_b32 v19,v80
v_max_f32 v80,v80,v19
v_mul_f32_e64 v13,-s36,v80
v_mov_b32 v160,0
v_mov_b32 v161,0
v_mov_b32 v162,0
v_mov_b32 v163,0
v_mov_b32 v164,0
v_mov_b32 v165,0
v_mov_b32 v166,0
v_mov_b32 v167,0
v_mov_b32 v168,0
v_mov_b32 v169,0
v_mov_b32 v170,0
v_mov_b32 v171,0
v_mov_b32 v172,0
v_mov_b32 v173,0
v_mov_b32 v174,0
v_mov_b32 v175,0
v_mov_b32 v176,0
v_mov_b32 v177,0
v_mov_b32 v178,0
v_mov_b32 v179,0
v_mov_b32 v180,0
v_mov_b32 v181,0
v_mov_b32 v182,0
v_mov_b32 v183,0
v_mov_b32 v184,0
v_mov_b32 v185,0
v_mov_b32 v186,0
v_mov_b32 v187,0
v_mov_b32 v188,0
v_mov_b32 v189,0
v_mov_b32 v190,0
v_mov_b32 v191,0
v_mov_b32 v192,0
v_mov_b32 v193,0
v_mov_b32 v194,0
v_mov_b32 v195,0
v_mov_b32 v196,0
v_mov_b32 v197,0
v_mov_b32 v198,0
v_mov_b32 v199,0
v_mov_b32 v200,0
v_mov_b32 v201,0
v_mov_b32 v202,0
v_mov_b32 v203,0
v_mov_b32 v204,0
v_mov_b32 v205,0
v_mov_b32 v206,0
v_mov_b32 v207,0
v_mov_b32 v60,0
v_mov_b32 v24,0
v_mov_b32 v61,0
v_mov_b32 v25,0
v_mov_b32 v62,0
v_mov_b32 v26,0
v_mov_b32 v63,0
v_mov_b32 v27,0
s_mov_b32 s53,s30
s_mov_b32 s52,0
L_fix_acc:
s_mov_b32 s63,s53
s_add_u32 m0,s24,0
s_nop 0
buffer_load_dwordx4 v6,s[4:7],s63 offen offset:0 lds
buffer_load_dwordx4 v7,s[4:7],s63 offen offset:1024 lds
buffer_load_dwordx4 v8,s[4:7],s63 offen offset:2048 lds
s_add_u32 s63,s63,3072
s_add_u32 m0,s24,3072
s_nop 0
buffer_load_dwordx4 v6,s[4:7],s63 offen offset:0 lds
buffer_load_dwordx4 v7,s[4:7],s63 offen offset:1024 lds
buffer_load_dwordx4 v8,s[4:7],s63 offen offset:2048 lds
s_add_u32 s63,s63,3072
s_add_u32 m0,s24,6144
s_nop 0
buffer_load_dwordx4 v6,s[4:7],s63 offen offset:0 lds
buffer_load_dwordx4 v7,s[4:7],s63 offen offset:1024 lds
buffer_load_dwordx4 v8,s[4:7],s63 offen offset:2048 lds
s_add_u32 s63,s63,3072
s_add_u32 m0,s24,9216
s_nop 0
buffer_load_dwordx4 v6,s[4:7],s63 offen offset:0 lds
buffer_load_dwordx4 v7,s[4:7],s63 offen offset:1024 lds
buffer_load_dwordx4 v8,s[4:7],s63 offen offset:2048 lds
s_add_u32 s63,s63,3072
s_waitcnt vmcnt(0)
ds_read_b128 a[160:163],v11 offset:0
ds_read_b128 a[164:167],v12 offset:0
ds_read_b128 a[168:171],v11 offset:128
ds_read_b128 a[172:175],v12 offset:128
ds_read_b128 a[176:179],v11 offset:256
ds_read_b128 a[180:183],v12 offset:256
ds_read_b128 a[184:187],v11 offset:6144
ds_read_b128 a[188:191],v12 offset:6144
ds_read_b128 a[192:195],v11 offset:6272
ds_read_b128 a[196:199],v12 offset:6272
ds_read_b128 a[200:203],v11 offset:6400
ds_read_b128 a[204:207],v12 offset:6400
s_waitcnt lgkmcnt(0)
v_mfma_f32_16x16x32_bf16 v[72:75],a[160:163],a[0:3],0
v_mfma_f32_16x16x32_bf16 v[72:75],a[164:167],a[4:7],v[72:75]
v_mfma_f32_16x16x32_bf16 v[72:75],a[168:171],a[8:11],v[72:75]
v_mfma_f32_16x16x32_bf16 v[72:75],a[172:175],a[12:15],v[72:75]
v_mfma_f32_16x16x32_bf16 v[72:75],a[176:179],a[16:19],v[72:75]
v_mfma_f32_16x16x32_bf16 v[72:75],a[180:183],a[20:23],v[72:75]
v_mfma_f32_16x16x32_bf16 v[76:79],a[184:187],a[0:3],0
v_mfma_f32_16x16x32_bf16 v[76:79],a[188:191],a[4:7],v[76:79]
v_mfma_f32_16x16x32_bf16 v[76:79],a[192:195],a[8:11],v[76:79]
v_mfma_f32_16x16x32_bf16 v[76:79],a[196:199],a[12:15],v[76:79]
v_mfma_f32_16x16x32_bf16 v[76:79],a[200:203],a[16:19],v[76:79]
v_mfma_f32_16x16x32_bf16 v[76:79],a[204:207],a[20:23],v[76:79]
s_nop 7
v_fma_f32 v72,v72,s36,v13
v_fma_f32 v73,v73,s36,v13
v_exp_f32 v72,v72
v_exp_f32 v73,v73
s_nop 0
v_cvt_pk_bf16_f32 v20,v72,v73
v_fma_f32 v74,v74,s36,v13
v_fma_f32 v75,v75,s36,v13
v_exp_f32 v74,v74
v_exp_f32 v75,v75
s_nop 0
v_cvt_pk_bf16_f32 v21,v74,v75
v_fma_f32 v76,v76,s36,v13
v_fma_f32 v77,v77,s36,v13
v_exp_f32 v76,v76
v_exp_f32 v77,v77
s_nop 0
v_cvt_pk_bf16_f32 v22,v76,v77
v_fma_f32 v78,v78,s36,v13
v_fma_f32 v79,v79,s36,v13
v_exp_f32 v78,v78
v_exp_f32 v79,v79
s_nop 0
v_cvt_pk_bf16_f32 v23,v78,v79
s_nop 1
v_smfmac_f32_16x16x64_bf16 v[60:63],a[152:155],v[20:27],v18
s_mov_b32 s63,s53
s_add_u32 m0,s24,0
s_nop 0
buffer_load_dwordx4 v6,s[8:11],s63 offen offset:0 lds
buffer_load_dwordx4 v7,s[8:11],s63 offen offset:1024 lds
buffer_load_dwordx4 v8,s[8:11],s63 offen offset:2048 lds
s_add_u32 s63,s63,3072
s_add_u32 m0,s24,3072
s_nop 0
buffer_load_dwordx4 v6,s[8:11],s63 offen offset:0 lds
buffer_load_dwordx4 v7,s[8:11],s63 offen offset:1024 lds
buffer_load_dwordx4 v8,s[8:11],s63 offen offset:2048 lds
s_add_u32 s63,s63,3072
s_add_u32 m0,s24,6144
s_nop 0
buffer_load_dwordx4 v6,s[8:11],s63 offen offset:0 lds
buffer_load_dwordx4 v7,s[8:11],s63 offen offset:1024 lds
buffer_load_dwordx4 v8,s[8:11],s63 offen offset:2048 lds
s_add_u32 s63,s63,3072
s_add_u32 m0,s24,9216
s_nop 0
buffer_load_dwordx4 v6,s[8:11],s63 offen offset:0 lds
buffer_load_dwordx4 v7,s[8:11],s63 offen offset:1024 lds
buffer_load_dwordx4 v8,s[8:11],s63 offen offset:2048 lds
s_add_u32 s63,s63,3072
s_waitcnt vmcnt(0)
ds_read_b64_tr_b16 a[160:161],v112 offset:0
ds_read_b64_tr_b16 a[162:163],v112 offset:6144
ds_read_b64_tr_b16 a[164:165],v113 offset:0
ds_read_b64_tr_b16 a[166:167],v113 offset:6144
ds_read_b64_tr_b16 a[168:169],v114 offset:0
ds_read_b64_tr_b16 a[170:171],v114 offset:6144
ds_read_b64_tr_b16 a[172:173],v115 offset:0
ds_read_b64_tr_b16 a[174:175],v115 offset:6144
ds_read_b64_tr_b16 a[176:177],v112 offset:128
ds_read_b64_tr_b16 a[178:179],v112 offset:6272
ds_read_b64_tr_b16 a[180:181],v113 offset:128
ds_read_b64_tr_b16 a[182:183],v113 offset:6272
ds_read_b64_tr_b16 a[184:185],v114 offset:128
ds_read_b64_tr_b16 a[186:187],v114 offset:6272
ds_read_b64_tr_b16 a[188:189],v115 offset:128
ds_read_b64_tr_b16 a[190:191],v115 offset:6272
ds_read_b64_tr_b16 a[192:193],v112 offset:256
ds_read_b64_tr_b16 a[194:195],v112 offset:6400
ds_read_b64_tr_b16 a[196:197],v113 offset:256
ds_read_b64_tr_b16 a[198:199],v113 offset:6400
ds_read_b64_tr_b16 a[200:201],v114 offset:256
ds_read_b64_tr_b16 a[202:203],v114 offset:6400
ds_read_b64_tr_b16 a[204:205],v115 offset:256
ds_read_b64_tr_b16 a[206:207],v115 offset:6400
s_waitcnt lgkmcnt(0)
v_mfma_f32_16x16x32_bf16 v[160:163],a[160:163],v[20:23],v[160:163]
v_mfma_f32_16x16x32_bf16 v[164:167],a[164:167],v[20:23],v[164:167]
v_mfma_f32_16x16x32_bf16 v[168:171],a[168:171],v[20:23],v[168:171]
v_mfma_f32_16x16x32_bf16 v[172:175],a[172:175],v[20:23],v[172:175]
v_mfma_f32_16x16x32_bf16 v[176:179],a[176:179],v[20:23],v[176:179]
v_mfma_f32_16x16x32_bf16 v[180:183],a[180:183],v[20:23],v[180:183]
v_mfma_f32_16x16x32_bf16 v[184:187],a[184:187],v[20:23],v[184:187]
v_mfma_f32_16x16x32_bf16 v[188:191],a[188:191],v[20:23],v[188:191]
v_mfma_f32_16x16x32_bf16 v[192:195],a[192:195],v[20:23],v[192:195]
v_mfma_f32_16x16x32_bf16 v[196:199],a[196:199],v[20:23],v[196:199]
v_mfma_f32_16x16x32_bf16 v[200:203],a[200:203],v[20:23],v[200:203]
v_mfma_f32_16x16x32_bf16 v[204:207],a[204:207],v[20:23],v[204:207]
s_add_u32 s53,s53,12288
s_add_u32 s52,s52,1
s_cmp_lt_u32 s52,16
s_cbranch_scc1 L_fix_acc
s_nop 7
v_add_f32 v19,v60,v61
v_rcp_f32 v19,v19
s_nop 0
v_mul_f32 v160,v160,v19
v_mul_f32 v161,v161,v19
v_mul_f32 v162,v162,v19
v_mul_f32 v163,v163,v19
v_cvt_pk_bf16_f32 v160,v160,v161
v_cvt_pk_bf16_f32 v161,v162,v163
buffer_store_dwordx2 v[160:161],v83,s[16:19],s41 offen offset:0
v_mul_f32 v164,v164,v19
v_mul_f32 v165,v165,v19
v_mul_f32 v166,v166,v19
v_mul_f32 v167,v167,v19
v_cvt_pk_bf16_f32 v164,v164,v165
v_cvt_pk_bf16_f32 v165,v166,v167
buffer_store_dwordx2 v[164:165],v83,s[16:19],s41 offen offset:32
v_mul_f32 v168,v168,v19
v_mul_f32 v169,v169,v19
v_mul_f32 v170,v170,v19
v_mul_f32 v171,v171,v19
v_cvt_pk_bf16_f32 v168,v168,v169
v_cvt_pk_bf16_f32 v169,v170,v171
buffer_store_dwordx2 v[168:169],v83,s[16:19],s41 offen offset:64
v_mul_f32 v172,v172,v19
v_mul_f32 v173,v173,v19
v_mul_f32 v174,v174,v19
v_mul_f32 v175,v175,v19
v_cvt_pk_bf16_f32 v172,v172,v173
v_cvt_pk_bf16_f32 v173,v174,v175
buffer_store_dwordx2 v[172:173],v83,s[16:19],s41 offen offset:96
v_mul_f32 v176,v176,v19
v_mul_f32 v177,v177,v19
v_mul_f32 v178,v178,v19
v_mul_f32 v179,v179,v19
v_cvt_pk_bf16_f32 v176,v176,v177
v_cvt_pk_bf16_f32 v177,v178,v179
buffer_store_dwordx2 v[176:177],v83,s[16:19],s41 offen offset:128
v_mul_f32 v180,v180,v19
v_mul_f32 v181,v181,v19
v_mul_f32 v182,v182,v19
v_mul_f32 v183,v183,v19
v_cvt_pk_bf16_f32 v180,v180,v181
v_cvt_pk_bf16_f32 v181,v182,v183
buffer_store_dwordx2 v[180:181],v83,s[16:19],s41 offen offset:160
v_mul_f32 v184,v184,v19
v_mul_f32 v185,v185,v19
v_mul_f32 v186,v186,v19
v_mul_f32 v187,v187,v19
v_cvt_pk_bf16_f32 v184,v184,v185
v_cvt_pk_bf16_f32 v185,v186,v187
buffer_store_dwordx2 v[184:185],v83,s[16:19],s41 offen offset:192
v_mul_f32 v188,v188,v19
v_mul_f32 v189,v189,v19
v_mul_f32 v190,v190,v19
v_mul_f32 v191,v191,v19
v_cvt_pk_bf16_f32 v188,v188,v189
v_cvt_pk_bf16_f32 v189,v190,v191
buffer_store_dwordx2 v[188:189],v83,s[16:19],s41 offen offset:224
v_mul_f32 v192,v192,v19
v_mul_f32 v193,v193,v19
v_mul_f32 v194,v194,v19
v_mul_f32 v195,v195,v19
v_cvt_pk_bf16_f32 v192,v192,v193
v_cvt_pk_bf16_f32 v193,v194,v195
buffer_store_dwordx2 v[192:193],v83,s[16:19],s41 offen offset:256
v_mul_f32 v196,v196,v19
v_mul_f32 v197,v197,v19
v_mul_f32 v198,v198,v19
v_mul_f32 v199,v199,v19
v_cvt_pk_bf16_f32 v196,v196,v197
v_cvt_pk_bf16_f32 v197,v198,v199
buffer_store_dwordx2 v[196:197],v83,s[16:19],s41 offen offset:288
v_mul_f32 v200,v200,v19
v_mul_f32 v201,v201,v19
v_mul_f32 v202,v202,v19
v_mul_f32 v203,v203,v19
v_cvt_pk_bf16_f32 v200,v200,v201
v_cvt_pk_bf16_f32 v201,v202,v203
buffer_store_dwordx2 v[200:201],v83,s[16:19],s41 offen offset:320
v_mul_f32 v204,v204,v19
v_mul_f32 v205,v205,v19
v_mul_f32 v206,v206,v19
v_mul_f32 v207,v207,v19
v_cvt_pk_bf16_f32 v204,v204,v205
v_cvt_pk_bf16_f32 v205,v206,v207
buffer_store_dwordx2 v[204:205],v83,s[16:19],s41 offen offset:352
s_waitcnt vmcnt(0)
s_add_u32 s41,s41,6144
s_add_u32 s51,s51,1
s_cmp_lt_u32 s51,s55
s_cbranch_scc1 L_fix_tile
s_cmp_lg_u32 s31,0
s_cbranch_scc1 L_fix_pass
s_branch L_done
L_codeend:
.section .rodata,"a"
.p2align 6
.amdhsa_kernel standalone__gqa_softmax__near_ridge_kernel
  .amdhsa_next_free_vgpr 512
  .amdhsa_next_free_sgpr 102
  .amdhsa_accum_offset 256
  .amdhsa_group_segment_fixed_size 0
  .amdhsa_kernarg_size 48
  .amdhsa_user_sgpr_count 2
  .amdhsa_user_sgpr_kernarg_segment_ptr 1
  .amdhsa_system_sgpr_workgroup_id_x 1
.end_amdhsa_kernel
```

```asm
; @launch grid=(256,1,1) block=(256,1,1) lds=163840
.amdgcn_target "amdgcn-amd-amdhsa--gfx950"
.text
.globl standalone__gqa_softmax__near_ridge_kernel
.p2align 8
.type standalone__gqa_softmax__near_ridge_kernel,@function
standalone__gqa_softmax__near_ridge_kernel:
s_cmp_ge_u32 s2,256
s_cbranch_scc1 L_end
s_load_dwordx4 s[84:87],s[0:1],0
s_load_dwordx4 s[88:91],s[0:1],16
v_lshrrev_b32 v80,6,v0
v_and_b32 v19,63,v0
v_readfirstlane_b32 s3,v80
s_lshr_b32 s34,s2,3
v_lshrrev_b32 v80,3,v19
v_and_b32 v82,7,v19
v_add_u32 v81,0,v80
v_mul_u32_u24 v81,43,v81
v_lshrrev_b32 v81,7,v81
v_and_b32 v81,6,v81
v_xor_b32 v81,v81,v82
v_lshlrev_b32 v81,4,v81
v_lshl_add_u32 v6,v80,7,v81
v_add_u32 v81,8,v80
v_mul_u32_u24 v81,43,v81
v_lshrrev_b32 v81,7,v81
v_and_b32 v81,6,v81
v_xor_b32 v81,v81,v82
v_lshlrev_b32 v81,4,v81
v_lshl_add_u32 v7,v80,7,v81
v_add_u32 v81,16,v80
v_mul_u32_u24 v81,43,v81
v_lshrrev_b32 v81,7,v81
v_and_b32 v81,6,v81
v_xor_b32 v81,v81,v82
v_lshlrev_b32 v81,4,v81
v_lshl_add_u32 v8,v80,7,v81
s_mov_b32 s37,0x21800000
s_mov_b32 s36,0x3dd53b95
s_mov_b32 s31,0
s_mov_b32 s32,1
s_and_b32 s62,s2,7
s_lshl_b32 s33,s62,6
s_mul_i32 s22,s3,3072
s_add_u32 s23,s22,36864
s_mul_i32 s24,s3,22528
s_add_u32 s24,s24,73728
s_mov_b32 s69,0
s_lshl_b32 s62,s69,5
s_add_u32 s62,s62,s34
s_mul_i32 s63,s62,171
s_lshr_b32 s63,s63,9
s_mul_i32 s64,s63,3
s_sub_u32 s62,s62,s64
s_add_u32 s63,s63,s33
s_mul_i32 s30,s63,196608
s_mul_i32 s41,s63,325632
s_lshl_b32 s63,s3,2
s_add_u32 s64,s63,21
s_cmp_eq_u32 s3,0
s_cselect_b32 s64,20,s64
s_cselect_b32 s40,1,0
s_add_u32 s65,s63,37
s_cmp_eq_u32 s62,2
s_cselect_b32 s64,s65,s64
s_cselect_b32 s40,0,s40
s_add_u32 s65,s63,s3
s_cmp_eq_u32 s62,0
s_cselect_b32 s64,s65,s64
s_cselect_b32 s40,1,s40
s_mul_i32 s64,s64,6144
s_add_u32 s41,s41,s64
s_add_u32 s20,s30,s22
s_mov_b32 s21,s20
s_waitcnt lgkmcnt(0)
s_mov_b32 s4,s86
s_and_b32 s5,s87,0xffff
s_mov_b32 s6,100663296
s_mov_b32 s7,0x20000
s_mov_b32 s12,s84
s_and_b32 s13,s85,0xffff
s_mov_b32 s14,166723584
s_mov_b32 s15,0x20000
s_mov_b32 s8,s88
s_and_b32 s9,s89,0xffff
s_mov_b32 s10,100663296
s_mov_b32 s11,0x20000
s_mov_b32 s16,s90
s_and_b32 s17,s91,0xffff
s_mov_b32 s18,166723584
s_mov_b32 s19,0x20000
s_mov_b32 s28,s41
s_add_u32 m0,s22,0
s_nop 0
buffer_load_dwordx4 v6,s[4:7],s20 offen offset:0 lds
buffer_load_dwordx4 v7,s[4:7],s20 offen offset:1024 lds
buffer_load_dwordx4 v8,s[4:7],s20 offen offset:2048 lds
s_add_u32 s20,s20,12288
s_add_u32 m0,s24,0
s_nop 0
buffer_load_dwordx4 v6,s[12:15],s28 offen offset:0 nt lds
buffer_load_dwordx4 v7,s[12:15],s28 offen offset:1024 nt lds
buffer_load_dwordx4 v8,s[12:15],s28 offen offset:2048 nt lds
s_add_u32 s28,s28,3072
s_add_u32 m0,s24,3072
s_nop 0
buffer_load_dwordx4 v6,s[12:15],s28 offen offset:0 nt lds
buffer_load_dwordx4 v7,s[12:15],s28 offen offset:1024 nt lds
buffer_load_dwordx4 v8,s[12:15],s28 offen offset:2048 nt lds
s_add_u32 s28,s28,3072
s_add_u32 m0,s22,12288
s_nop 0
buffer_load_dwordx4 v6,s[4:7],s20 offen offset:0 lds
buffer_load_dwordx4 v7,s[4:7],s20 offen offset:1024 lds
buffer_load_dwordx4 v8,s[4:7],s20 offen offset:2048 lds
s_add_u32 s20,s20,12288
s_add_u32 m0,s22,24576
s_nop 0
buffer_load_dwordx4 v6,s[4:7],s20 offen offset:0 lds
buffer_load_dwordx4 v7,s[4:7],s20 offen offset:1024 lds
buffer_load_dwordx4 v8,s[4:7],s20 offen offset:2048 lds
s_add_u32 s20,s20,12288
s_add_u32 m0,s23,0
s_nop 0
buffer_load_dwordx4 v6,s[8:11],s21 offen offset:0 lds
buffer_load_dwordx4 v7,s[8:11],s21 offen offset:1024 lds
buffer_load_dwordx4 v8,s[8:11],s21 offen offset:2048 lds
s_add_u32 s21,s21,12288
s_add_u32 m0,s24,6144
s_nop 0
buffer_load_dwordx4 v6,s[12:15],s28 offen offset:0 nt lds
buffer_load_dwordx4 v7,s[12:15],s28 offen offset:1024 nt lds
buffer_load_dwordx4 v8,s[12:15],s28 offen offset:2048 nt lds
s_add_u32 s28,s28,3072
s_add_u32 m0,s24,9216
s_nop 0
buffer_load_dwordx4 v6,s[12:15],s28 offen offset:0 nt lds
buffer_load_dwordx4 v7,s[12:15],s28 offen offset:1024 nt lds
buffer_load_dwordx4 v8,s[12:15],s28 offen offset:2048 nt lds
s_add_u32 s28,s28,3072
s_getpc_b64 s[46:47]
s_mul_i32 s62,s34,4096
s_mul_i32 s48,s3,1024
s_add_u32 s48,s48,s62
v_min_u32 v85,31,v19
v_lshlrev_b32 v85,7,v85
v_add_u32 v85,s62,v85
v_min_u32 v85,L_codeend-L_first-4,v85
s_cmp_lg_u32 s3,0
s_cbranch_scc1 L_nopre
global_load_dword v112,v85,s[46:47]
L_nopre:
v_and_b32 v80,15,v19
v_lshrrev_b32 v81,4,v19
v_mul_u32_u24 v0,384,v80
v_and_b32 v83,6,v80
v_xor_b32 v83,v83,v81
v_lshl_add_u32 v0,v83,4,v0
v_xor_b32 v1,64,v0
v_add_u32 v11,s24,v0
v_add_u32 v12,s24,v1
v_lshrrev_b32 v80,2,v19
v_mul_u32_u24 v2,384,v80
v_and_b32 v80,6,v80
v_bfe_u32 v83,v19,1,1
v_xor_b32 v80,v80,v83
v_lshl_add_u32 v2,v80,4,v2
v_and_b32 v83,1,v19
v_lshl_add_u32 v2,v83,3,v2
v_add_u32 v2,36864,v2
v_xor_b32 v3,32,v2
v_xor_b32 v4,64,v2
v_xor_b32 v5,96,v2
v_lshrrev_b32 v80,3,v19
v_and_b32 v81,7,v19
v_xor_b32 v83,v81,v80
v_lshl_add_u32 v10,v80,7,s24
v_lshl_add_u32 v10,v83,4,v10
v_mul_u32_u24 v9,384,v80
v_lshl_add_u32 v9,v81,4,v9
v_lshrrev_b32 v80,4,v19
v_xor_b32 v80,v80,v19
v_bfe_u32 v80,v80,1,1
v_subrev_u32 v80,1,v80
v_and_b32 v80,0x3f803f80,v80
v_accvgpr_write_b32 a152,v80
v_accvgpr_write_b32 a153,v80
v_accvgpr_write_b32 a154,v80
v_accvgpr_write_b32 a155,v80
v_and_b32 v80,1,v19
v_mul_u32_u24 v80,0xaaaa,v80
v_add_u32 v18,0x4444,v80
L_first:
s_waitcnt vmcnt(12)
s_barrier
s_cmp_eq_u32 s40,0
s_cbranch_scc1 L_start4
L_start5:
s_add_u32 m0,s24,12288
s_waitcnt vmcnt(15)
ds_read_b128 a[0:3],v11 offset:0
buffer_load_dwordx4 v6,s[12:15],s28 offen offset:0 nt lds
ds_read_b128 a[8:11],v11 offset:128
buffer_load_dwordx4 v7,s[12:15],s28 offen offset:1024 nt lds
ds_read_b128 a[4:7],v12 offset:0
buffer_load_dwordx4 v8,s[12:15],s28 offen offset:2048 nt lds
s_add_u32 s28,s28,3072
s_add_u32 m0,s24,15360
ds_read_b128 a[12:15],v12 offset:128
buffer_load_dwordx4 v6,s[12:15],s28 offen offset:0 nt lds
ds_read_b128 a[16:19],v11 offset:256
buffer_load_dwordx4 v7,s[12:15],s28 offen offset:1024 nt lds
ds_read_b128 a[20:23],v12 offset:256
buffer_load_dwordx4 v8,s[12:15],s28 offen offset:2048 nt lds
s_add_u32 s28,s28,3072
s_add_u32 m0,s24,0
ds_read_b128 a[120:123],v0 offset:0
v_mov_b32 v66,0
ds_read_b128 a[128:131],v0 offset:128
v_mov_b32 v71,0
ds_read_b128 a[124:127],v1 offset:0
v_mov_b32 v69,0
ds_read_b128 a[132:135],v1 offset:128
v_mov_b32 v65,0
ds_read_b128 a[140:143],v1 offset:256
v_mov_b32 v68,0
ds_read_b128 a[136:139],v0 offset:256
v_mov_b32 v67,0
ds_read_b128 a[144:147],v0 offset:6144
v_mov_b32 v70,0
ds_read_b128 a[148:151],v1 offset:6144
v_mov_b32 v63,0
s_waitcnt lgkmcnt(7)
v_mfma_f32_16x16x32_bf16 v[72:75],a[120:123],a[0:3],0
ds_read_b128 a[120:123],v0 offset:6272
v_mov_b32 v61,0
v_mov_b32 v60,0
v_mov_b32 v64,0
v_mov_b32 v62,0
s_waitcnt lgkmcnt(6)
v_mfma_f32_16x16x32_bf16 v[72:75],a[124:127],a[4:7],v[72:75]
ds_read_b128 a[124:127],v1 offset:6272
v_mfma_f32_16x16x32_bf16 v[72:75],a[128:131],a[8:11],v[72:75]
s_waitcnt lgkmcnt(5)
ds_read_b128 a[128:131],v0 offset:6400
v_mfma_f32_16x16x32_bf16 v[72:75],a[132:135],a[12:15],v[72:75]
s_waitcnt lgkmcnt(5)
ds_read_b128 a[132:135],v1 offset:6400
v_mfma_f32_16x16x32_bf16 v[72:75],a[136:139],a[16:19],v[72:75]
ds_read_b128 a[136:139],v0 offset:12288
v_mfma_f32_16x16x32_bf16 v[72:75],a[140:143],a[20:23],v[72:75]
s_waitcnt lgkmcnt(5)
ds_read_b128 a[140:143],v1 offset:12288
v_mfma_f32_16x16x32_bf16 v[76:79],a[144:147],a[0:3],0
ds_read_b128 a[144:147],v0 offset:12416
v_mfma_f32_16x16x32_bf16 v[76:79],a[148:151],a[4:7],v[76:79]
s_waitcnt lgkmcnt(6)
ds_read_b128 a[148:151],v1 offset:12416
v_mfma_f32_16x16x32_bf16 v[76:79],a[120:123],a[8:11],v[76:79]
s_waitcnt lgkmcnt(6)
ds_read_b128 a[120:123],v0 offset:12544
v_mfma_f32_16x16x32_bf16 v[76:79],a[124:127],a[12:15],v[76:79]
s_waitcnt lgkmcnt(6)
ds_read_b128 a[124:127],v1 offset:12544
v_max3_f32 v44,v72,v73,v74
v_mfma_f32_16x16x32_bf16 v[76:79],a[128:131],a[16:19],v[76:79]
s_waitcnt lgkmcnt(6)
ds_read_b128 a[128:131],v0 offset:18432
v_max_f32 v44,v44,v75
v_mfma_f32_16x16x32_bf16 v[76:79],a[132:135],a[20:23],v[76:79]
ds_read_b128 a[132:135],v1 offset:18432
v_mov_b32 v45,v44
s_nop 1
v_permlane32_swap_b32 v45,v44
v_max_f32 v44,v44,v45
v_mov_b32 v45,v44
s_nop 1
v_permlane16_swap_b32 v45,v44
v_max_f32 v44,v44,v45
v_mul_f32_e64 v13,-s36,v44
v_fma_f32 v74,v74,s36,v13
v_exp_f32 v74,v74
v_fma_f32 v73,v73,s36,v13
v_fma_f32 v75,v75,s36,v13
v_exp_f32 v75,v75
v_fma_f32 v72,v72,s36,v13
v_exp_f32 v72,v72
v_cvt_pk_bf16_f32 v21,v74,v75
v_exp_f32 v73,v73
v_fma_f32 v79,v79,s36,v13
v_cvt_pk_bf16_f32 v20,v72,v73
s_waitcnt lgkmcnt(1)
v_mfma_f32_16x16x32_bf16 v[72:75],a[136:139],a[0:3],0
ds_read_b128 a[136:139],v0 offset:18560
v_fma_f32 v78,v78,s36,v13
v_mfma_f32_16x16x32_bf16 v[72:75],a[140:143],a[4:7],v[72:75]
ds_read_b128 a[140:143],v1 offset:18560
v_exp_f32 v78,v78
v_mfma_f32_16x16x32_bf16 v[72:75],a[144:147],a[8:11],v[72:75]
ds_read_b128 a[144:147],v0 offset:18688
v_fma_f32 v77,v77,s36,v13
v_mfma_f32_16x16x32_bf16 v[72:75],a[148:151],a[12:15],v[72:75]
ds_read_b128 a[148:151],v1 offset:18688
v_exp_f32 v77,v77
v_mfma_f32_16x16x32_bf16 v[72:75],a[120:123],a[16:19],v[72:75]
v_fma_f32 v76,v76,s36,v13
v_exp_f32 v76,v76
v_mfma_f32_16x16x32_bf16 v[72:75],a[124:127],a[20:23],v[72:75]
v_exp_f32 v79,v79
v_cvt_pk_bf16_f32 v22,v76,v77
v_cvt_pk_bf16_f32 v23,v78,v79
v_mfma_f32_16x16x32_bf16 v[76:79],a[128:131],a[0:3],0
s_waitcnt lgkmcnt(3)
v_mfma_f32_16x16x32_bf16 v[76:79],a[132:135],a[4:7],v[76:79]
v_mfma_f32_16x16x32_bf16 v[76:79],a[136:139],a[8:11],v[76:79]
s_waitcnt lgkmcnt(1)
v_mfma_f32_16x16x32_bf16 v[76:79],a[140:143],a[12:15],v[76:79]
v_mfma_f32_16x16x32_bf16 v[76:79],a[144:147],a[16:19],v[76:79]
s_waitcnt lgkmcnt(0)
v_fma_f32 v75,v75,s36,v13
v_fma_f32 v74,v74,s36,v13
v_mfma_f32_16x16x32_bf16 v[76:79],a[148:151],a[20:23],v[76:79]
s_waitcnt vmcnt(12)
s_barrier
ds_read_b64_tr_b16 a[120:121],v2 offset:0
ds_read_b64_tr_b16 a[126:127],v3 offset:6144
ds_read_b64_tr_b16 a[124:125],v3 offset:0
ds_read_b64_tr_b16 a[122:123],v2 offset:6144
ds_read_b64_tr_b16 a[128:129],v4 offset:0
ds_read_b64_tr_b16 a[132:133],v5 offset:0
ds_read_b64_tr_b16 a[130:131],v4 offset:6144
ds_read_b64_tr_b16 a[138:139],v2 offset:6272
ds_read_b64_tr_b16 a[134:135],v5 offset:6144
ds_read_b64_tr_b16 a[146:147],v4 offset:6272
ds_read_b64_tr_b16 a[136:137],v2 offset:128
ds_read_b64_tr_b16 a[144:145],v4 offset:128
ds_read_b64_tr_b16 a[148:149],v5 offset:128
ds_read_b64_tr_b16 a[140:141],v3 offset:128
ds_read_b64_tr_b16 a[142:143],v3 offset:6272
ds_read_b64_tr_b16 a[150:151],v5 offset:6272
v_exp_f32 v75,v75
v_fma_f32 v72,v72,s36,v13
v_fma_f32 v73,v73,s36,v13
v_exp_f32 v73,v73
s_waitcnt lgkmcnt(12)
v_mfma_f32_16x16x32_bf16 v[160:163],a[120:123],v[20:23],0
ds_read_b64_tr_b16 a[120:121],v2 offset:256
v_exp_f32 v72,v72
v_mfma_f32_16x16x32_bf16 v[164:167],a[124:127],v[20:23],0
s_waitcnt lgkmcnt(10)
ds_read_b64_tr_b16 a[126:127],v3 offset:6400
v_cvt_pk_bf16_f32 v44,v72,v73
v_mfma_f32_16x16x32_bf16 v[168:171],a[128:131],v[20:23],0
s_waitcnt lgkmcnt(9)
ds_read_b64_tr_b16 a[122:123],v2 offset:6400
v_exp_f32 v74,v74
v_mfma_f32_16x16x32_bf16 v[172:175],a[132:135],v[20:23],0
s_waitcnt lgkmcnt(5)
ds_read_b64_tr_b16 a[130:131],v4 offset:6400
v_cvt_pk_bf16_f32 v45,v74,v75
v_mfma_f32_16x16x32_bf16 v[176:179],a[136:139],v[20:23],0
s_waitcnt lgkmcnt(4)
ds_read_b64_tr_b16 a[132:133],v5 offset:256
v_fma_f32 v79,v79,s36,v13
v_mfma_f32_16x16x32_bf16 v[180:183],a[140:143],v[20:23],0
ds_read_b64_tr_b16 a[124:125],v3 offset:256
v_fma_f32 v77,v77,s36,v13
v_mfma_f32_16x16x32_bf16 v[184:187],a[144:147],v[20:23],0
ds_read_b64_tr_b16 a[134:135],v5 offset:6400
v_fma_f32 v76,v76,s36,v13
v_mfma_f32_16x16x32_bf16 v[188:191],a[148:151],v[20:23],0
ds_read_b128 a[136:139],v0 offset:24576
v_exp_f32 v76,v76
ds_read_b64_tr_b16 a[128:129],v4 offset:256
ds_read_b128 a[144:147],v0 offset:24704
v_fma_f32 v78,v78,s36,v13
s_waitcnt lgkmcnt(7)
v_mfma_f32_16x16x32_bf16 v[192:195],a[120:123],v[20:23],0
ds_read_b128 a[148:151],v1 offset:24704
v_exp_f32 v78,v78
ds_read_b128 a[140:143],v1 offset:24576
v_exp_f32 v77,v77
ds_read_b128 a[120:123],v0 offset:24832
s_waitcnt lgkmcnt(7)
v_mfma_f32_16x16x32_bf16 v[196:199],a[124:127],v[20:23],0
v_exp_f32 v79,v79
ds_read_b128 a[124:127],v1 offset:24832
v_cvt_pk_bf16_f32 v47,v78,v79
v_cvt_pk_bf16_f32 v46,v76,v77
s_waitcnt lgkmcnt(5)
v_mfma_f32_16x16x32_bf16 v[200:203],a[128:131],v[20:23],0
ds_read_b128 a[128:131],v0 offset:30720
v_mfma_f32_16x16x32_bf16 v[204:207],a[132:135],v[20:23],0
ds_read_b128 a[132:135],v1 offset:30720
v_mfma_f32_16x16x32_bf16 v[72:75],a[136:139],a[0:3],0
s_waitcnt lgkmcnt(4)
ds_read_b128 a[136:139],v0 offset:30848
v_mfma_f32_16x16x32_bf16 v[72:75],a[140:143],a[4:7],v[72:75]
ds_read_b128 a[140:143],v1 offset:30848
v_mfma_f32_16x16x32_bf16 v[72:75],a[144:147],a[8:11],v[72:75]
ds_read_b128 a[144:147],v0 offset:30976
v_mfma_f32_16x16x32_bf16 v[72:75],a[148:151],a[12:15],v[72:75]
s_waitcnt lgkmcnt(6)
ds_read_b128 a[148:151],v1 offset:30976
v_mfma_f32_16x16x32_bf16 v[72:75],a[120:123],a[16:19],v[72:75]
s_waitcnt lgkmcnt(6)
ds_read_b128 a[120:123],v0 offset:0
v_mfma_f32_16x16x32_bf16 v[72:75],a[124:127],a[20:23],v[72:75]
s_waitcnt lgkmcnt(6)
ds_read_b128 a[124:127],v1 offset:0
v_mfma_f32_16x16x32_bf16 v[76:79],a[128:131],a[0:3],0
s_waitcnt lgkmcnt(6)
ds_read_b128 a[128:131],v0 offset:128
v_mfma_f32_16x16x32_bf16 v[76:79],a[132:135],a[4:7],v[76:79]
s_waitcnt lgkmcnt(6)
ds_read_b128 a[132:135],v1 offset:128
v_mfma_f32_16x16x32_bf16 v[76:79],a[136:139],a[8:11],v[76:79]
s_waitcnt lgkmcnt(6)
ds_read_b128 a[136:139],v0 offset:256
v_mfma_f32_16x16x32_bf16 v[76:79],a[140:143],a[12:15],v[76:79]
s_waitcnt lgkmcnt(6)
ds_read_b128 a[140:143],v1 offset:256
v_fma_f32 v75,v75,s36,v13
v_mfma_f32_16x16x32_bf16 v[76:79],a[144:147],a[16:19],v[76:79]
s_waitcnt lgkmcnt(6)
ds_read_b128 a[144:147],v0 offset:6144
v_fma_f32 v74,v74,s36,v13
v_mfma_f32_16x16x32_bf16 v[76:79],a[148:151],a[20:23],v[76:79]
s_waitcnt vmcnt(6)
ds_read_b128 a[24:27],v11 offset:6144
buffer_load_dwordx4 v6,s[12:15],s28 offen offset:0 nt lds
ds_read_b128 a[28:31],v12 offset:6144
buffer_load_dwordx4 v7,s[12:15],s28 offen offset:1024 nt lds
ds_read_b128 a[32:35],v11 offset:6272
buffer_load_dwordx4 v8,s[12:15],s28 offen offset:2048 nt lds
s_add_u32 s28,s28,3072
s_add_u32 m0,s24,3072
ds_read_b128 a[40:43],v11 offset:6400
buffer_load_dwordx4 v6,s[12:15],s28 offen offset:0 nt lds
ds_read_b128 a[36:39],v12 offset:6272
buffer_load_dwordx4 v7,s[12:15],s28 offen offset:1024 nt lds
ds_read_b128 a[44:47],v12 offset:6400
buffer_load_dwordx4 v8,s[12:15],s28 offen offset:2048 nt lds
s_add_u32 s28,s28,3072
s_add_u32 m0,s24,6144
ds_read_b128 a[148:151],v1 offset:6144
v_fma_f32 v73,v73,s36,v13
s_waitcnt lgkmcnt(6)
v_mfma_f32_16x16x32_bf16 v[80:83],a[120:123],a[24:27],0
s_waitcnt lgkmcnt(5)
ds_read_b128 a[120:123],v0 offset:6272
v_exp_f32 v74,v74
v_mfma_f32_16x16x32_bf16 v[80:83],a[124:127],a[28:31],v[80:83]
s_waitcnt lgkmcnt(5)
ds_read_b128 a[124:127],v1 offset:6272
v_fma_f32 v72,v72,s36,v13
v_mfma_f32_16x16x32_bf16 v[80:83],a[128:131],a[32:35],v[80:83]
ds_read_b128 a[128:131],v0 offset:6400
v_exp_f32 v72,v72
v_exp_f32 v75,v75
v_exp_f32 v73,v73
s_waitcnt lgkmcnt(5)
v_mfma_f32_16x16x32_bf16 v[80:83],a[132:135],a[36:39],v[80:83]
ds_read_b128 a[132:135],v1 offset:6400
v_mfma_f32_16x16x32_bf16 v[80:83],a[136:139],a[40:43],v[80:83]
s_waitcnt lgkmcnt(4)
ds_read_b128 a[136:139],v0 offset:12288
v_mfma_f32_16x16x32_bf16 v[80:83],a[140:143],a[44:47],v[80:83]
ds_read_b128 a[140:143],v1 offset:12288
v_mfma_f32_16x16x32_bf16 v[84:87],a[144:147],a[24:27],0
ds_read_b128 a[144:147],v0 offset:12416
v_mfma_f32_16x16x32_bf16 v[84:87],a[148:151],a[28:31],v[84:87]
s_waitcnt lgkmcnt(5)
ds_read_b128 a[148:151],v1 offset:12416
v_mfma_f32_16x16x32_bf16 v[84:87],a[120:123],a[32:35],v[84:87]
ds_read_b128 a[120:123],v0 offset:12544
v_mfma_f32_16x16x32_bf16 v[84:87],a[124:127],a[36:39],v[84:87]
s_waitcnt lgkmcnt(6)
ds_read_b128 a[124:127],v1 offset:12544
v_max3_f32 v48,v80,v81,v82
v_mfma_f32_16x16x32_bf16 v[84:87],a[128:131],a[40:43],v[84:87]
s_waitcnt lgkmcnt(6)
ds_read_b128 a[128:131],v0 offset:18432
v_max_f32 v48,v48,v83
v_mfma_f32_16x16x32_bf16 v[84:87],a[132:135],a[44:47],v[84:87]
ds_read_b128 a[132:135],v1 offset:18432
v_mov_b32 v49,v48
s_nop 1
v_permlane32_swap_b32 v49,v48
v_max_f32 v48,v48,v49
v_mov_b32 v49,v48
s_nop 1
v_permlane16_swap_b32 v49,v48
v_max_f32 v48,v48,v49
v_mul_f32_e64 v14,-s36,v48
v_fma_f32 v81,v81,s36,v14
v_fma_f32 v82,v82,s36,v14
v_exp_f32 v82,v82
v_fma_f32 v80,v80,s36,v14
v_exp_f32 v80,v80
v_fma_f32 v83,v83,s36,v14
v_exp_f32 v83,v83
v_exp_f32 v81,v81
v_cvt_pk_bf16_f32 v25,v82,v83
v_cvt_pk_bf16_f32 v24,v80,v81
s_waitcnt lgkmcnt(1)
v_mfma_f32_16x16x32_bf16 v[80:83],a[136:139],a[24:27],0
ds_read_b128 a[136:139],v0 offset:18560
v_fma_f32 v84,v84,s36,v14
v_mfma_f32_16x16x32_bf16 v[80:83],a[140:143],a[28:31],v[80:83]
ds_read_b128 a[140:143],v1 offset:18560
v_exp_f32 v84,v84
v_mfma_f32_16x16x32_bf16 v[80:83],a[144:147],a[32:35],v[80:83]
ds_read_b128 a[144:147],v0 offset:18688
v_fma_f32 v86,v86,s36,v14
v_mfma_f32_16x16x32_bf16 v[80:83],a[148:151],a[36:39],v[80:83]
ds_read_b128 a[148:151],v1 offset:18688
v_exp_f32 v86,v86
v_mfma_f32_16x16x32_bf16 v[80:83],a[120:123],a[40:43],v[80:83]
ds_read_b64_tr_b16 a[120:121],v2 offset:0
v_fma_f32 v87,v87,s36,v14
v_mfma_f32_16x16x32_bf16 v[80:83],a[124:127],a[44:47],v[80:83]
ds_read_b64_tr_b16 a[124:125],v3 offset:0
ds_read_b64_tr_b16 a[122:123],v2 offset:6144
ds_read_b64_tr_b16 a[126:127],v3 offset:6144
v_fma_f32 v85,v85,s36,v14
v_exp_f32 v85,v85
v_exp_f32 v87,v87
v_cvt_pk_bf16_f32 v26,v84,v85
v_cvt_pk_bf16_f32 v27,v86,v87
v_mfma_f32_16x16x32_bf16 v[84:87],a[128:131],a[24:27],0
ds_read_b64_tr_b16 a[128:129],v4 offset:0
v_fma_f32 v82,v82,s36,v14
v_smfmac_f32_16x16x64_bf16 v[60:63],a[152:155],v[20:27],v18
s_waitcnt lgkmcnt(6)
ds_read_b64_tr_b16 a[130:131],v4 offset:6144
v_mfma_f32_16x16x32_bf16 v[84:87],a[132:135],a[28:31],v[84:87]
ds_read_b64_tr_b16 a[134:135],v5 offset:6144
v_exp_f32 v82,v82
v_mfma_f32_16x16x32_bf16 v[84:87],a[136:139],a[32:35],v[84:87]
ds_read_b64_tr_b16 a[132:133],v5 offset:0
v_fma_f32 v81,v81,s36,v14
v_mfma_f32_16x16x32_bf16 v[84:87],a[140:143],a[36:39],v[84:87]
ds_read_b64_tr_b16 a[138:139],v2 offset:6272
v_exp_f32 v81,v81
v_mfma_f32_16x16x32_bf16 v[84:87],a[144:147],a[40:43],v[84:87]
s_waitcnt lgkmcnt(5)
ds_read_b64_tr_b16 a[144:145],v4 offset:128
v_fma_f32 v83,v83,s36,v14
v_mfma_f32_16x16x32_bf16 v[84:87],a[148:151],a[44:47],v[84:87]
ds_read_b64_tr_b16 a[146:147],v4 offset:6272
v_fma_f32 v80,v80,s36,v14
v_mfma_f32_16x16x32_bf16 v[208:211],a[120:123],v[24:27],0
ds_read_b64_tr_b16 a[150:151],v5 offset:6272
v_exp_f32 v80,v80
v_mfma_f32_16x16x32_bf16 v[212:215],a[124:127],v[24:27],0
s_waitcnt lgkmcnt(5)
ds_read_b64_tr_b16 a[140:141],v3 offset:128
v_cvt_pk_bf16_f32 v48,v80,v81
v_mfma_f32_16x16x32_bf16 v[216:219],a[128:131],v[24:27],0
s_waitcnt lgkmcnt(5)
ds_read_b64_tr_b16 a[136:137],v2 offset:128
ds_read_b64_tr_b16 a[142:143],v3 offset:6272
v_exp_f32 v83,v83
v_mfma_f32_16x16x32_bf16 v[220:223],a[132:135],v[24:27],0
ds_read_b64_tr_b16 a[122:123],v2 offset:6400
ds_read_b64_tr_b16 a[148:149],v5 offset:128
ds_read_b64_tr_b16 a[126:127],v3 offset:6400
ds_read_b64_tr_b16 a[120:121],v2 offset:256
ds_read_b64_tr_b16 a[124:125],v3 offset:256
ds_read_b64_tr_b16 a[128:129],v4 offset:256
ds_read_b64_tr_b16 a[134:135],v5 offset:6400
ds_read_b64_tr_b16 a[132:133],v5 offset:256
ds_read_b64_tr_b16 a[130:131],v4 offset:6400
v_cvt_pk_bf16_f32 v49,v82,v83
v_fma_f32 v84,v84,s36,v14
v_fma_f32 v87,v87,s36,v14
v_exp_f32 v87,v87
v_exp_f32 v84,v84
s_waitcnt lgkmcnt(10)
v_mfma_f32_16x16x32_bf16 v[224:227],a[136:139],v[24:27],0
s_waitcnt lgkmcnt(9)
ds_read_b128 a[136:139],v0 offset:24576
v_fma_f32 v85,v85,s36,v14
v_mfma_f32_16x16x32_bf16 v[228:231],a[140:143],v[24:27],0
ds_read_b128 a[140:143],v1 offset:24576
v_exp_f32 v85,v85
v_mfma_f32_16x16x32_bf16 v[232:235],a[144:147],v[24:27],0
s_waitcnt lgkmcnt(9)
ds_read_b128 a[144:147],v0 offset:24704
v_cvt_pk_bf16_f32 v50,v84,v85
v_mfma_f32_16x16x32_bf16 v[236:239],a[148:151],v[24:27],0
s_waitcnt lgkmcnt(5)
ds_read_b128 a[148:151],v1 offset:24704
v_fma_f32 v86,v86,s36,v14
v_mfma_f32_16x16x32_bf16 v[240:243],a[120:123],v[24:27],0
ds_read_b128 a[120:123],v0 offset:24832
v_exp_f32 v86,v86
v_mfma_f32_16x16x32_bf16 v[244:247],a[124:127],v[24:27],0
s_waitcnt lgkmcnt(5)
ds_read_b128 a[124:127],v1 offset:24832
v_cvt_pk_bf16_f32 v51,v86,v87
v_mfma_f32_16x16x32_bf16 v[248:251],a[128:131],v[24:27],0
ds_read_b128 a[128:131],v0 offset:30720
v_cvt_pk_bf16_f32 v20,v72,v73
v_smfmac_f32_16x16x64_bf16 v[60:63],a[152:155],v[44:51],v18
v_cvt_pk_bf16_f32 v21,v74,v75
v_mfma_f32_16x16x32_bf16 v[252:255],a[132:135],v[24:27],0
s_waitcnt lgkmcnt(4)
ds_read_b128 a[132:135],v1 offset:30720
v_mfma_f32_16x16x32_bf16 v[80:83],a[136:139],a[24:27],0
ds_read_b128 a[136:139],v0 offset:30848
v_mfma_f32_16x16x32_bf16 v[80:83],a[140:143],a[28:31],v[80:83]
ds_read_b128 a[140:143],v1 offset:30848
v_mfma_f32_16x16x32_bf16 v[80:83],a[144:147],a[32:35],v[80:83]
s_waitcnt lgkmcnt(5)
ds_read_b128 a[144:147],v0 offset:30976
v_mfma_f32_16x16x32_bf16 v[80:83],a[148:151],a[36:39],v[80:83]
ds_read_b128 a[148:151],v1 offset:30976
v_mfma_f32_16x16x32_bf16 v[80:83],a[120:123],a[40:43],v[80:83]
s_waitcnt lgkmcnt(5)
ds_read_b128 a[120:123],v0 offset:0
v_mfma_f32_16x16x32_bf16 v[80:83],a[124:127],a[44:47],v[80:83]
ds_read_b128 a[124:127],v1 offset:0
v_mfma_f32_16x16x32_bf16 v[84:87],a[128:131],a[24:27],0
s_waitcnt lgkmcnt(6)
ds_read_b128 a[128:131],v0 offset:128
v_mfma_f32_16x16x32_bf16 v[84:87],a[132:135],a[28:31],v[84:87]
s_waitcnt lgkmcnt(6)
ds_read_b128 a[132:135],v1 offset:128
v_mfma_f32_16x16x32_bf16 v[84:87],a[136:139],a[32:35],v[84:87]
s_waitcnt lgkmcnt(6)
ds_read_b128 a[136:139],v0 offset:256
v_mfma_f32_16x16x32_bf16 v[84:87],a[140:143],a[36:39],v[84:87]
s_waitcnt lgkmcnt(6)
ds_read_b128 a[140:143],v1 offset:256
v_fma_f32 v83,v83,s36,v14
v_mfma_f32_16x16x32_bf16 v[84:87],a[144:147],a[40:43],v[84:87]
s_waitcnt lgkmcnt(6)
ds_read_b128 a[144:147],v0 offset:6144
v_fma_f32 v81,v81,s36,v14
v_mfma_f32_16x16x32_bf16 v[84:87],a[148:151],a[44:47],v[84:87]
s_waitcnt vmcnt(6)
ds_read_b128 a[52:55],v12 offset:12288
buffer_load_dwordx4 v6,s[12:15],s28 offen offset:0 nt lds
ds_read_b128 a[60:63],v12 offset:12416
buffer_load_dwordx4 v7,s[12:15],s28 offen offset:1024 nt lds
ds_read_b128 a[48:51],v11 offset:12288
buffer_load_dwordx4 v8,s[12:15],s28 offen offset:2048 nt lds
s_add_u32 s28,s28,3072
s_add_u32 m0,s24,9216
ds_read_b128 a[56:59],v11 offset:12416
buffer_load_dwordx4 v6,s[12:15],s28 offen offset:0 nt lds
ds_read_b128 a[68:71],v12 offset:12544
buffer_load_dwordx4 v7,s[12:15],s28 offen offset:1024 nt lds
ds_read_b128 a[64:67],v11 offset:12544
buffer_load_dwordx4 v8,s[12:15],s28 offen offset:2048 nt lds
s_add_u32 s28,s28,3072
s_add_u32 m0,s23,12288
ds_read_b128 a[148:151],v1 offset:6144
v_exp_f32 v83,v83
v_fma_f32 v80,v80,s36,v14
v_exp_f32 v80,v80
v_exp_f32 v81,v81
v_fma_f32 v82,v82,s36,v14
v_exp_f32 v82,v82
s_waitcnt lgkmcnt(4)
v_mfma_f32_16x16x32_bf16 v[88:91],a[120:123],a[48:51],0
ds_read_b128 a[120:123],v0 offset:6272
v_cvt_pk_bf16_f32 v25,v82,v83
v_mfma_f32_16x16x32_bf16 v[88:91],a[124:127],a[52:55],v[88:91]
s_waitcnt lgkmcnt(3)
ds_read_b128 a[124:127],v1 offset:6272
v_cvt_pk_bf16_f32 v24,v80,v81
v_mfma_f32_16x16x32_bf16 v[88:91],a[128:131],a[56:59],v[88:91]
ds_read_b128 a[128:131],v0 offset:6400
v_mfma_f32_16x16x32_bf16 v[88:91],a[132:135],a[60:63],v[88:91]
s_waitcnt lgkmcnt(4)
ds_read_b128 a[132:135],v1 offset:6400
v_mfma_f32_16x16x32_bf16 v[88:91],a[136:139],a[64:67],v[88:91]
ds_read_b128 a[136:139],v0 offset:12288
v_mfma_f32_16x16x32_bf16 v[88:91],a[140:143],a[68:71],v[88:91]
ds_read_b128 a[140:143],v1 offset:12288
v_mfma_f32_16x16x32_bf16 v[92:95],a[144:147],a[48:51],0
s_waitcnt lgkmcnt(6)
ds_read_b128 a[144:147],v0 offset:12416
v_mfma_f32_16x16x32_bf16 v[92:95],a[148:151],a[52:55],v[92:95]
s_waitcnt lgkmcnt(6)
ds_read_b128 a[148:151],v1 offset:12416
v_mfma_f32_16x16x32_bf16 v[92:95],a[120:123],a[56:59],v[92:95]
s_waitcnt lgkmcnt(6)
ds_read_b128 a[120:123],v0 offset:12544
v_mfma_f32_16x16x32_bf16 v[92:95],a[124:127],a[60:63],v[92:95]
s_waitcnt lgkmcnt(6)
ds_read_b128 a[124:127],v1 offset:12544
v_max3_f32 v52,v88,v89,v90
v_mfma_f32_16x16x32_bf16 v[92:95],a[128:131],a[64:67],v[92:95]
s_waitcnt lgkmcnt(6)
ds_read_b128 a[128:131],v0 offset:18432
v_max_f32 v52,v52,v91
v_mfma_f32_16x16x32_bf16 v[92:95],a[132:135],a[68:71],v[92:95]
ds_read_b128 a[132:135],v1 offset:18432
v_mov_b32 v53,v52
s_nop 1
v_permlane32_swap_b32 v53,v52
v_max_f32 v52,v52,v53
v_mov_b32 v53,v52
s_nop 1
v_permlane16_swap_b32 v53,v52
v_max_f32 v52,v52,v53
v_mul_f32_e64 v15,-s36,v52
v_fma_f32 v89,v89,s36,v15
v_fma_f32 v88,v88,s36,v15
v_exp_f32 v89,v89
v_fma_f32 v91,v91,s36,v15
v_exp_f32 v91,v91
v_exp_f32 v88,v88
v_fma_f32 v90,v90,s36,v15
v_exp_f32 v90,v90
v_cvt_pk_bf16_f32 v28,v88,v89
v_cvt_pk_bf16_f32 v29,v90,v91
s_waitcnt lgkmcnt(1)
v_mfma_f32_16x16x32_bf16 v[88:91],a[136:139],a[48:51],0
ds_read_b128 a[136:139],v0 offset:18560
v_fma_f32 v95,v95,s36,v15
v_mfma_f32_16x16x32_bf16 v[88:91],a[140:143],a[52:55],v[88:91]
ds_read_b128 a[140:143],v1 offset:18560
v_fma_f32 v93,v93,s36,v15
v_mfma_f32_16x16x32_bf16 v[88:91],a[144:147],a[56:59],v[88:91]
ds_read_b128 a[144:147],v0 offset:18688
v_exp_f32 v95,v95
v_mfma_f32_16x16x32_bf16 v[88:91],a[148:151],a[60:63],v[88:91]
ds_read_b128 a[148:151],v1 offset:18688
v_exp_f32 v93,v93
v_mfma_f32_16x16x32_bf16 v[88:91],a[120:123],a[64:67],v[88:91]
ds_read_b64_tr_b16 a[122:123],v2 offset:6144
v_fma_f32 v92,v92,s36,v15
v_mfma_f32_16x16x32_bf16 v[88:91],a[124:127],a[68:71],v[88:91]
ds_read_b64_tr_b16 a[120:121],v2 offset:0
ds_read_b64_tr_b16 a[124:125],v3 offset:0
ds_read_b64_tr_b16 a[126:127],v3 offset:6144
v_exp_f32 v92,v92
v_fma_f32 v94,v94,s36,v15
v_exp_f32 v94,v94
v_cvt_pk_bf16_f32 v30,v92,v93
v_cvt_pk_bf16_f32 v31,v94,v95
v_mfma_f32_16x16x32_bf16 v[92:95],a[128:131],a[48:51],0
s_waitcnt lgkmcnt(6)
ds_read_b64_tr_b16 a[128:129],v4 offset:0
v_fma_f32 v90,v90,s36,v15
v_mfma_f32_16x16x32_bf16 v[92:95],a[132:135],a[52:55],v[92:95]
ds_read_b64_tr_b16 a[134:135],v5 offset:6144
v_exp_f32 v90,v90
v_mfma_f32_16x16x32_bf16 v[92:95],a[136:139],a[56:59],v[92:95]
ds_read_b64_tr_b16 a[138:139],v2 offset:6272
v_fma_f32 v89,v89,s36,v15
v_mfma_f32_16x16x32_bf16 v[92:95],a[140:143],a[60:63],v[92:95]
s_waitcnt lgkmcnt(6)
ds_read_b64_tr_b16 a[132:133],v5 offset:0
v_exp_f32 v89,v89
v_mfma_f32_16x16x32_bf16 v[92:95],a[144:147],a[64:67],v[92:95]
ds_read_b64_tr_b16 a[130:131],v4 offset:6144
v_fma_f32 v88,v88,s36,v15
v_mfma_f32_16x16x32_bf16 v[92:95],a[148:151],a[68:71],v[92:95]
s_waitcnt lgkmcnt(5)
ds_read_b64_tr_b16 a[136:137],v2 offset:128
v_exp_f32 v88,v88
v_mfma_f32_16x16x32_bf16 v[112:115],a[120:123],v[28:31],0
ds_read_b64_tr_b16 a[148:149],v5 offset:128
v_cvt_pk_bf16_f32 v52,v88,v89
v_mfma_f32_16x16x32_bf16 v[116:119],a[124:127],v[28:31],0
ds_read_b64_tr_b16 a[142:143],v3 offset:6272
ds_read_b64_tr_b16 a[140:141],v3 offset:128
ds_read_b64_tr_b16 a[146:147],v4 offset:6272
ds_read_b64_tr_b16 a[144:145],v4 offset:128
ds_read_b64_tr_b16 a[122:123],v2 offset:6400
ds_read_b64_tr_b16 a[150:151],v5 offset:6272
ds_read_b64_tr_b16 a[124:125],v3 offset:256
ds_read_b64_tr_b16 a[120:121],v2 offset:256
v_fma_f32 v91,v91,s36,v15
v_exp_f32 v91,v91
s_waitcnt lgkmcnt(10)
v_mfma_f32_16x16x32_bf16 v[120:123],a[128:131],v[28:31],0
ds_read_b64_tr_b16 a[130:131],v4 offset:6400
v_cvt_pk_bf16_f32 v53,v90,v91
v_mfma_f32_16x16x32_bf16 v[124:127],a[132:135],v[28:31],0
s_waitcnt lgkmcnt(10)
ds_read_b64_tr_b16 a[132:133],v5 offset:256
v_fma_f32 v95,v95,s36,v15
v_mfma_f32_16x16x32_bf16 v[128:131],a[136:139],v[28:31],0
s_waitcnt lgkmcnt(8)
ds_read_b64_tr_b16 a[126:127],v3 offset:6400
ds_read_b64_tr_b16 a[128:129],v4 offset:256
v_fma_f32 v94,v94,s36,v15
v_mfma_f32_16x16x32_bf16 v[132:135],a[140:143],v[28:31],0
s_waitcnt lgkmcnt(8)
ds_read_b64_tr_b16 a[134:135],v5 offset:6400
v_exp_f32 v94,v94
v_mfma_f32_16x16x32_bf16 v[136:139],a[144:147],v[28:31],0
s_waitcnt lgkmcnt(5)
ds_read_b128 a[136:139],v0 offset:24576
v_fma_f32 v92,v92,s36,v15
v_mfma_f32_16x16x32_bf16 v[140:143],a[148:151],v[28:31],0
ds_read_b128 a[140:143],v1 offset:24576
v_exp_f32 v92,v92
v_mfma_f32_16x16x32_bf16 v[144:147],a[120:123],v[28:31],0
ds_read_b128 a[120:123],v0 offset:24832
v_exp_f32 v95,v95
ds_read_b128 a[144:147],v0 offset:24704
v_cvt_pk_bf16_f32 v55,v94,v95
ds_read_b128 a[148:151],v1 offset:24704
s_waitcnt lgkmcnt(6)
v_mfma_f32_16x16x32_bf16 v[148:151],a[124:127],v[28:31],0
v_fma_f32 v93,v93,s36,v15
v_exp_f32 v93,v93
v_mfma_f32_16x16x32_bf16 v[152:155],a[128:131],v[28:31],0
s_waitcnt lgkmcnt(4)
ds_read_b128 a[124:127],v1 offset:24832
v_cvt_pk_bf16_f32 v54,v92,v93
v_mfma_f32_16x16x32_bf16 v[156:159],a[132:135],v[28:31],0
ds_read_b128 a[128:131],v0 offset:30720
v_mfma_f32_16x16x32_bf16 v[88:91],a[136:139],a[48:51],0
s_waitcnt lgkmcnt(5)
ds_read_b128 a[136:139],v0 offset:30848
v_mfma_f32_16x16x32_bf16 v[88:91],a[140:143],a[52:55],v[88:91]
s_waitcnt lgkmcnt(4)
ds_read_b128 a[132:135],v1 offset:30720
ds_read_b128 a[140:143],v1 offset:30848
v_mfma_f32_16x16x32_bf16 v[88:91],a[144:147],a[56:59],v[88:91]
s_waitcnt lgkmcnt(5)
ds_read_b128 a[144:147],v0 offset:30976
v_mfma_f32_16x16x32_bf16 v[88:91],a[148:151],a[60:63],v[88:91]
ds_read_b128 a[148:151],v1 offset:30976
v_mfma_f32_16x16x32_bf16 v[88:91],a[120:123],a[64:67],v[88:91]
s_waitcnt lgkmcnt(6)
ds_read_b128 a[120:123],v0 offset:0
v_mfma_f32_16x16x32_bf16 v[88:91],a[124:127],a[68:71],v[88:91]
s_waitcnt lgkmcnt(6)
ds_read_b128 a[124:127],v1 offset:0
v_mfma_f32_16x16x32_bf16 v[92:95],a[128:131],a[48:51],0
s_waitcnt lgkmcnt(5)
ds_read_b128 a[128:131],v0 offset:128
v_mfma_f32_16x16x32_bf16 v[92:95],a[132:135],a[52:55],v[92:95]
ds_read_b128 a[132:135],v1 offset:128
v_mfma_f32_16x16x32_bf16 v[92:95],a[136:139],a[56:59],v[92:95]
s_waitcnt lgkmcnt(6)
ds_read_b128 a[136:139],v0 offset:256
v_mfma_f32_16x16x32_bf16 v[92:95],a[140:143],a[60:63],v[92:95]
s_waitcnt lgkmcnt(6)
ds_read_b128 a[140:143],v1 offset:256
v_fma_f32 v88,v88,s36,v15
v_mfma_f32_16x16x32_bf16 v[92:95],a[144:147],a[64:67],v[92:95]
s_waitcnt lgkmcnt(6)
ds_read_b128 a[144:147],v0 offset:6144
v_fma_f32 v89,v89,s36,v15
v_mfma_f32_16x16x32_bf16 v[92:95],a[148:151],a[68:71],v[92:95]
s_waitcnt vmcnt(6)
ds_read_b128 a[72:75],v11 offset:0
buffer_load_dwordx4 v6,s[8:11],s21 offen offset:0 lds
ds_read_b128 a[84:87],v12 offset:128
buffer_load_dwordx4 v7,s[8:11],s21 offen offset:1024 lds
ds_read_b128 a[76:79],v12 offset:0
buffer_load_dwordx4 v8,s[8:11],s21 offen offset:2048 lds
s_add_u32 s21,s21,12288
s_add_u32 m0,s23,24576
ds_read_b128 a[80:83],v11 offset:128
v_exp_f32 v89,v89
ds_read_b128 a[92:95],v12 offset:256
v_exp_f32 v88,v88
ds_read_b128 a[88:91],v11 offset:256
ds_read_b128 a[148:151],v1 offset:6144
s_waitcnt lgkmcnt(6)
v_mfma_f32_16x16x32_bf16 v[96:99],a[120:123],a[72:75],0
s_waitcnt lgkmcnt(4)
ds_read_b128 a[120:123],v0 offset:6272
v_mfma_f32_16x16x32_bf16 v[96:99],a[124:127],a[76:79],v[96:99]
s_waitcnt lgkmcnt(4)
ds_read_b128 a[124:127],v1 offset:6272
v_mfma_f32_16x16x32_bf16 v[96:99],a[128:131],a[80:83],v[96:99]
ds_read_b128 a[128:131],v0 offset:6400
v_mfma_f32_16x16x32_bf16 v[96:99],a[132:135],a[84:87],v[96:99]
s_waitcnt lgkmcnt(4)
ds_read_b128 a[132:135],v1 offset:6400
v_mfma_f32_16x16x32_bf16 v[96:99],a[136:139],a[88:91],v[96:99]
ds_read_b128 a[136:139],v0 offset:12288
v_mfma_f32_16x16x32_bf16 v[96:99],a[140:143],a[92:95],v[96:99]
ds_read_b128 a[140:143],v1 offset:12288
v_mfma_f32_16x16x32_bf16 v[100:103],a[144:147],a[72:75],0
s_waitcnt lgkmcnt(6)
ds_read_b128 a[144:147],v0 offset:12416
v_mfma_f32_16x16x32_bf16 v[100:103],a[148:151],a[76:79],v[100:103]
s_waitcnt lgkmcnt(6)
ds_read_b128 a[148:151],v1 offset:12416
v_mfma_f32_16x16x32_bf16 v[100:103],a[120:123],a[80:83],v[100:103]
s_waitcnt lgkmcnt(6)
ds_read_b128 a[120:123],v0 offset:12544
v_mfma_f32_16x16x32_bf16 v[100:103],a[124:127],a[84:87],v[100:103]
s_waitcnt lgkmcnt(6)
ds_read_b128 a[124:127],v1 offset:12544
v_max3_f32 v56,v96,v97,v98
v_mfma_f32_16x16x32_bf16 v[100:103],a[128:131],a[88:91],v[100:103]
s_waitcnt lgkmcnt(6)
ds_read_b128 a[128:131],v0 offset:18432
v_max_f32 v56,v56,v99
v_mfma_f32_16x16x32_bf16 v[100:103],a[132:135],a[92:95],v[100:103]
ds_read_b128 a[132:135],v1 offset:18432
v_mov_b32 v57,v56
s_nop 1
v_permlane32_swap_b32 v57,v56
v_max_f32 v56,v56,v57
v_mov_b32 v57,v56
s_nop 1
v_permlane16_swap_b32 v57,v56
v_max_f32 v56,v56,v57
v_mul_f32_e64 v16,-s36,v56
v_fma_f32 v97,v97,s36,v16
v_exp_f32 v97,v97
v_fma_f32 v96,v96,s36,v16
v_exp_f32 v96,v96
v_fma_f32 v99,v99,s36,v16
v_exp_f32 v99,v99
v_cvt_pk_bf16_f32 v32,v96,v97
v_fma_f32 v98,v98,s36,v16
v_exp_f32 v98,v98
v_fma_f32 v103,v103,s36,v16
v_cvt_pk_bf16_f32 v33,v98,v99
s_waitcnt lgkmcnt(1)
v_mfma_f32_16x16x32_bf16 v[96:99],a[136:139],a[72:75],0
ds_read_b128 a[136:139],v0 offset:18560
v_fma_f32 v100,v100,s36,v16
v_mfma_f32_16x16x32_bf16 v[96:99],a[140:143],a[76:79],v[96:99]
ds_read_b128 a[140:143],v1 offset:18560
v_exp_f32 v103,v103
v_mfma_f32_16x16x32_bf16 v[96:99],a[144:147],a[80:83],v[96:99]
ds_read_b128 a[144:147],v0 offset:18688
v_fma_f32 v101,v101,s36,v16
v_mfma_f32_16x16x32_bf16 v[96:99],a[148:151],a[84:87],v[96:99]
ds_read_b128 a[148:151],v1 offset:18688
v_exp_f32 v100,v100
v_mfma_f32_16x16x32_bf16 v[96:99],a[120:123],a[88:91],v[96:99]
ds_read_b64_tr_b16 a[120:121],v2 offset:0
v_fma_f32 v102,v102,s36,v16
v_mfma_f32_16x16x32_bf16 v[96:99],a[124:127],a[92:95],v[96:99]
ds_read_b64_tr_b16 a[122:123],v2 offset:6144
ds_read_b64_tr_b16 a[124:125],v3 offset:0
ds_read_b64_tr_b16 a[126:127],v3 offset:6144
v_exp_f32 v102,v102
v_exp_f32 v101,v101
v_cvt_pk_bf16_f32 v35,v102,v103
v_cvt_pk_bf16_f32 v34,v100,v101
v_mfma_f32_16x16x32_bf16 v[100:103],a[128:131],a[72:75],0
ds_read_b64_tr_b16 a[128:129],v4 offset:0
v_fma_f32 v99,v99,s36,v16
v_smfmac_f32_16x16x64_bf16 v[64:67],a[152:155],v[28:35],v18
s_waitcnt lgkmcnt(6)
ds_read_b64_tr_b16 a[130:131],v4 offset:6144
v_mfma_f32_16x16x32_bf16 v[100:103],a[132:135],a[76:79],v[100:103]
ds_read_b64_tr_b16 a[134:135],v5 offset:6144
v_fma_f32 v96,v96,s36,v16
v_mfma_f32_16x16x32_bf16 v[100:103],a[136:139],a[80:83],v[100:103]
ds_read_b64_tr_b16 a[132:133],v5 offset:0
v_exp_f32 v96,v96
v_mfma_f32_16x16x32_bf16 v[100:103],a[140:143],a[84:87],v[100:103]
ds_read_b64_tr_b16 a[142:143],v3 offset:6272
v_fma_f32 v98,v98,s36,v16
v_mfma_f32_16x16x32_bf16 v[100:103],a[144:147],a[88:91],v[100:103]
s_waitcnt lgkmcnt(5)
ds_read_b64_tr_b16 a[136:137],v2 offset:128
v_exp_f32 v99,v99
v_mfma_f32_16x16x32_bf16 v[100:103],a[148:151],a[92:95],v[100:103]
ds_read_b64_tr_b16 a[140:141],v3 offset:128
v_exp_f32 v98,v98
v_mfma_f32_16x16x32_bf16 a[160:163],a[120:123],v[32:35],0
ds_read_b64_tr_b16 a[150:151],v5 offset:6272
v_cvt_pk_bf16_f32 v57,v98,v99
v_mfma_f32_16x16x32_bf16 a[164:167],a[124:127],v[32:35],0
s_waitcnt lgkmcnt(5)
ds_read_b64_tr_b16 a[138:139],v2 offset:6272
v_fma_f32 v97,v97,s36,v16
v_mfma_f32_16x16x32_bf16 a[168:171],a[128:131],v[32:35],0
s_waitcnt lgkmcnt(5)
ds_read_b64_tr_b16 a[148:149],v5 offset:128
v_exp_f32 v97,v97
v_mfma_f32_16x16x32_bf16 a[172:175],a[132:135],v[32:35],0
ds_read_b64_tr_b16 a[120:121],v2 offset:256
ds_read_b64_tr_b16 a[144:145],v4 offset:128
ds_read_b64_tr_b16 a[124:125],v3 offset:256
ds_read_b64_tr_b16 a[126:127],v3 offset:6400
ds_read_b64_tr_b16 a[146:147],v4 offset:6272
ds_read_b64_tr_b16 a[122:123],v2 offset:6400
ds_read_b64_tr_b16 a[132:133],v5 offset:256
ds_read_b64_tr_b16 a[128:129],v4 offset:256
ds_read_b64_tr_b16 a[134:135],v5 offset:6400
ds_read_b64_tr_b16 a[130:131],v4 offset:6400
v_cvt_pk_bf16_f32 v56,v96,v97
v_fma_f32 v102,v102,s36,v16
s_waitcnt lgkmcnt(11)
v_mfma_f32_16x16x32_bf16 a[176:179],a[136:139],v[32:35],0
ds_read_b128 a[136:139],v0 offset:24576
v_fma_f32 v100,v100,s36,v16
v_mfma_f32_16x16x32_bf16 a[180:183],a[140:143],v[32:35],0
ds_read_b128 a[140:143],v1 offset:24576
v_exp_f32 v100,v100
v_exp_f32 v102,v102
v_fma_f32 v101,v101,s36,v16
v_exp_f32 v101,v101
v_fma_f32 v103,v103,s36,v16
v_exp_f32 v103,v103
s_waitcnt lgkmcnt(7)
v_mfma_f32_16x16x32_bf16 a[184:187],a[144:147],v[32:35],0
ds_read_b128 a[144:147],v0 offset:24704
v_cvt_pk_bf16_f32 v59,v102,v103
v_mfma_f32_16x16x32_bf16 a[188:191],a[148:151],v[32:35],0
s_waitcnt lgkmcnt(3)
ds_read_b128 a[148:151],v1 offset:24704
v_cvt_pk_bf16_f32 v58,v100,v101
v_mfma_f32_16x16x32_bf16 a[192:195],a[120:123],v[32:35],0
ds_read_b128 a[120:123],v0 offset:24832
v_cvt_pk_bf16_f32 v28,v88,v89
v_smfmac_f32_16x16x64_bf16 v[64:67],a[152:155],v[52:59],v18
v_mfma_f32_16x16x32_bf16 a[196:199],a[124:127],v[32:35],0
ds_read_b128 a[124:127],v1 offset:24832
v_mfma_f32_16x16x32_bf16 a[200:203],a[128:131],v[32:35],0
ds_read_b128 a[128:131],v0 offset:30720
v_mfma_f32_16x16x32_bf16 a[204:207],a[132:135],v[32:35],0
s_waitcnt lgkmcnt(5)
ds_read_b128 a[132:135],v1 offset:30720
v_mfma_f32_16x16x32_bf16 v[96:99],a[136:139],a[72:75],0
ds_read_b128 a[136:139],v0 offset:30848
v_mfma_f32_16x16x32_bf16 v[96:99],a[140:143],a[76:79],v[96:99]
s_waitcnt lgkmcnt(5)
ds_read_b128 a[140:143],v1 offset:30848
v_mfma_f32_16x16x32_bf16 v[96:99],a[144:147],a[80:83],v[96:99]
ds_read_b128 a[144:147],v0 offset:30976
v_mfma_f32_16x16x32_bf16 v[96:99],a[148:151],a[84:87],v[96:99]
s_waitcnt lgkmcnt(6)
ds_read_b128 a[148:151],v1 offset:30976
v_mfma_f32_16x16x32_bf16 v[96:99],a[120:123],a[88:91],v[96:99]
s_waitcnt lgkmcnt(6)
ds_read_b128 a[120:123],v0 offset:0
v_mfma_f32_16x16x32_bf16 v[96:99],a[124:127],a[92:95],v[96:99]
s_waitcnt lgkmcnt(6)
ds_read_b128 a[124:127],v1 offset:0
v_mfma_f32_16x16x32_bf16 v[100:103],a[128:131],a[72:75],0
s_waitcnt lgkmcnt(6)
ds_read_b128 a[128:131],v0 offset:128
v_mfma_f32_16x16x32_bf16 v[100:103],a[132:135],a[76:79],v[100:103]
s_waitcnt lgkmcnt(6)
ds_read_b128 a[132:135],v1 offset:128
v_mfma_f32_16x16x32_bf16 v[100:103],a[136:139],a[80:83],v[100:103]
s_waitcnt lgkmcnt(6)
ds_read_b128 a[136:139],v0 offset:256
v_mfma_f32_16x16x32_bf16 v[100:103],a[140:143],a[84:87],v[100:103]
s_waitcnt lgkmcnt(6)
ds_read_b128 a[140:143],v1 offset:256
v_mfma_f32_16x16x32_bf16 v[100:103],a[144:147],a[88:91],v[100:103]
s_waitcnt lgkmcnt(6)
ds_read_b128 a[144:147],v0 offset:6144
v_mfma_f32_16x16x32_bf16 v[100:103],a[148:151],a[92:95],v[100:103]
s_waitcnt vmcnt(3)
ds_read_b128 a[100:103],v12 offset:6144
buffer_load_dwordx4 v6,s[8:11],s21 offen offset:0 lds
ds_read_b128 a[96:99],v11 offset:6144
buffer_load_dwordx4 v7,s[8:11],s21 offen offset:1024 lds
ds_read_b128 a[104:107],v11 offset:6272
buffer_load_dwordx4 v8,s[8:11],s21 offen offset:2048 lds
s_add_u32 s21,s21,12288
ds_read_b128 a[108:111],v12 offset:6272
s_add_u32 m0,s22,0
ds_read_b128 a[116:119],v12 offset:6400
ds_read_b128 a[112:115],v11 offset:6400
ds_read_b128 a[148:151],v1 offset:6144
s_waitcnt lgkmcnt(5)
v_mfma_f32_16x16x32_bf16 v[104:107],a[120:123],a[96:99],0
ds_read_b128 a[120:123],v0 offset:6272
v_mfma_f32_16x16x32_bf16 v[104:107],a[124:127],a[100:103],v[104:107]
s_waitcnt lgkmcnt(5)
ds_read_b128 a[124:127],v1 offset:6272
v_mfma_f32_16x16x32_bf16 v[104:107],a[128:131],a[104:107],v[104:107]
s_waitcnt lgkmcnt(5)
ds_read_b128 a[128:131],v0 offset:6400
v_mfma_f32_16x16x32_bf16 v[104:107],a[132:135],a[108:111],v[104:107]
ds_read_b128 a[132:135],v1 offset:6400
s_waitcnt vmcnt(3)
s_waitcnt lgkmcnt(5)
v_mfma_f32_16x16x32_bf16 v[104:107],a[136:139],a[112:115],v[104:107]
v_mfma_f32_16x16x32_bf16 v[104:107],a[140:143],a[116:119],v[104:107]
v_mfma_f32_16x16x32_bf16 v[108:111],a[144:147],a[96:99],0
s_waitcnt lgkmcnt(4)
v_mfma_f32_16x16x32_bf16 v[108:111],a[148:151],a[100:103],v[108:111]
s_waitcnt lgkmcnt(3)
v_mfma_f32_16x16x32_bf16 v[108:111],a[120:123],a[104:107],v[108:111]
s_waitcnt lgkmcnt(2)
v_mfma_f32_16x16x32_bf16 v[108:111],a[124:127],a[108:111],v[108:111]
s_waitcnt lgkmcnt(1)
v_mfma_f32_16x16x32_bf16 v[108:111],a[128:131],a[112:115],v[108:111]
s_waitcnt lgkmcnt(0)
s_barrier
v_mfma_f32_16x16x32_bf16 v[108:111],a[132:135],a[116:119],v[108:111]
buffer_load_dwordx4 v6,s[4:7],s20 offen offset:0 lds
buffer_load_dwordx4 v7,s[4:7],s20 offen offset:1024 lds
buffer_load_dwordx4 v8,s[4:7],s20 offen offset:2048 lds
ds_read_b128 a[136:139],v0 offset:12288
v_max3_f32 v40,v104,v105,v106
ds_read_b128 a[140:143],v1 offset:12288
v_max_f32 v40,v40,v107
ds_read_b128 a[148:151],v1 offset:12416
v_mov_b32 v41,v40
ds_read_b128 a[144:147],v0 offset:12416
s_add_u32 s20,s20,12288
ds_read_b128 a[124:127],v1 offset:12544
v_permlane32_swap_b32 v41,v40
ds_read_b128 a[128:131],v0 offset:18432
v_max_f32 v40,v40,v41
ds_read_b128 a[120:123],v0 offset:12544
v_mov_b32 v41,v40
ds_read_b128 a[132:135],v1 offset:18432
s_mov_b32 s27,166723584
v_permlane16_swap_b32 v41,v40
v_max_f32 v40,v40,v41
v_mul_f32_e64 v17,-s36,v40
v_fma_f32 v106,v106,s36,v17
v_fma_f32 v107,v107,s36,v17
v_exp_f32 v106,v106
v_fma_f32 v104,v104,s36,v17
v_exp_f32 v104,v104
v_fma_f32 v105,v105,s36,v17
v_exp_f32 v105,v105
v_exp_f32 v107,v107
v_cvt_pk_bf16_f32 v36,v104,v105
v_cvt_pk_bf16_f32 v37,v106,v107
s_waitcnt lgkmcnt(3)
v_mfma_f32_16x16x32_bf16 v[104:107],a[136:139],a[96:99],0
s_mov_b32 s42,s41
ds_read_b128 a[136:139],v0 offset:18560
v_fma_f32 v109,v109,s36,v17
v_mfma_f32_16x16x32_bf16 v[104:107],a[140:143],a[100:103],v[104:107]
s_add_u32 s69,s69,1
ds_read_b128 a[140:143],v1 offset:18560
v_fma_f32 v108,v108,s36,v17
v_mfma_f32_16x16x32_bf16 v[104:107],a[144:147],a[104:107],v[104:107]
s_lshl_b32 s62,s69,5
ds_read_b128 a[144:147],v0 offset:18688
v_exp_f32 v108,v108
v_mfma_f32_16x16x32_bf16 v[104:107],a[148:151],a[108:111],v[104:107]
s_add_u32 s62,s62,s34
ds_read_b128 a[148:151],v1 offset:18688
v_fma_f32 v111,v111,s36,v17
s_waitcnt lgkmcnt(4)
v_mfma_f32_16x16x32_bf16 v[104:107],a[120:123],a[112:115],v[104:107]
s_mul_i32 s63,s62,171
ds_read_b64_tr_b16 a[120:121],v2 offset:0
v_exp_f32 v111,v111
v_mfma_f32_16x16x32_bf16 v[104:107],a[124:127],a[116:119],v[104:107]
s_lshr_b32 s63,s63,9
ds_read_b64_tr_b16 a[122:123],v2 offset:6144
ds_read_b64_tr_b16 a[126:127],v3 offset:6144
ds_read_b64_tr_b16 a[124:125],v3 offset:0
v_fma_f32 v110,v110,s36,v17
v_exp_f32 v110,v110
v_exp_f32 v109,v109
v_cvt_pk_bf16_f32 v39,v110,v111
v_cvt_pk_bf16_f32 v38,v108,v109
v_mfma_f32_16x16x32_bf16 v[108:111],a[128:131],a[96:99],0
s_mul_i32 s64,s63,3
ds_read_b64_tr_b16 a[128:129],v4 offset:0
v_fma_f32 v104,v104,s36,v17
v_mfma_f32_16x16x32_bf16 v[108:111],a[132:135],a[100:103],v[108:111]
s_sub_u32 s62,s62,s64
ds_read_b64_tr_b16 a[130:131],v4 offset:6144
v_fma_f32 v106,v106,s36,v17
s_waitcnt lgkmcnt(7)
v_mfma_f32_16x16x32_bf16 v[108:111],a[136:139],a[104:107],v[108:111]
s_add_u32 s63,s63,s33
ds_read_b64_tr_b16 a[134:135],v5 offset:6144
v_fma_f32 v105,v105,s36,v17
v_mfma_f32_16x16x32_bf16 v[108:111],a[140:143],a[108:111],v[108:111]
s_mul_i32 s30,s63,196608
ds_read_b64_tr_b16 a[132:133],v5 offset:0
v_fma_f32 v107,v107,s36,v17
v_mfma_f32_16x16x32_bf16 v[108:111],a[144:147],a[112:115],v[108:111]
s_mul_i32 s41,s63,325632
ds_read_b64_tr_b16 a[140:141],v3 offset:128
v_exp_f32 v104,v104
s_waitcnt lgkmcnt(5)
v_mfma_f32_16x16x32_bf16 v[108:111],a[148:151],a[116:119],v[108:111]
s_lshl_b32 s63,s3,2
ds_read_b64_tr_b16 a[142:143],v3 offset:6272
v_exp_f32 v106,v106
v_mfma_f32_16x16x32_bf16 a[208:211],a[120:123],v[36:39],0
s_add_u32 s64,s63,21
ds_read_b64_tr_b16 a[122:123],v2 offset:6400
v_exp_f32 v107,v107
v_mfma_f32_16x16x32_bf16 a[212:215],a[124:127],v[36:39],0
s_cmp_eq_u32 s3,0
ds_read_b64_tr_b16 a[124:125],v3 offset:256
v_cvt_pk_bf16_f32 v41,v106,v107
v_exp_f32 v105,v105
s_waitcnt lgkmcnt(6)
v_mfma_f32_16x16x32_bf16 a[216:219],a[128:131],v[36:39],0
s_cselect_b32 s64,20,s64
ds_read_b64_tr_b16 a[130:131],v4 offset:6400
ds_read_b64_tr_b16 a[138:139],v2 offset:6272
ds_read_b64_tr_b16 a[136:137],v2 offset:128
s_waitcnt lgkmcnt(7)
v_mfma_f32_16x16x32_bf16 a[220:223],a[132:135],v[36:39],0
s_cselect_b32 s40,1,0
ds_read_b64_tr_b16 a[134:135],v5 offset:6400
ds_read_b64_tr_b16 a[150:151],v5 offset:6272
ds_read_b64_tr_b16 a[132:133],v5 offset:256
ds_read_b64_tr_b16 a[120:121],v2 offset:256
ds_read_b64_tr_b16 a[126:127],v3 offset:6400
ds_read_b64_tr_b16 a[128:129],v4 offset:256
ds_read_b64_tr_b16 a[148:149],v5 offset:128
ds_read_b64_tr_b16 a[146:147],v4 offset:6272
ds_read_b64_tr_b16 a[144:145],v4 offset:128
s_waitcnt vmcnt(6)
v_cvt_pk_bf16_f32 v40,v104,v105
v_fma_f32 v110,v110,s36,v17
v_exp_f32 v110,v110
v_fma_f32 v111,v111,s36,v17
v_fma_f32 v109,v109,s36,v17
v_fma_f32 v108,v108,s36,v17
v_exp_f32 v108,v108
s_waitcnt lgkmcnt(9)
v_mfma_f32_16x16x32_bf16 a[224:227],a[136:139],v[36:39],0
s_add_u32 s65,s63,37
v_exp_f32 v111,v111
v_mfma_f32_16x16x32_bf16 a[228:231],a[140:143],v[36:39],0
s_cmp_eq_u32 s62,2
v_cvt_pk_bf16_f32 v43,v110,v111
v_exp_f32 v109,v109
s_cselect_b32 s64,s65,s64
v_cvt_pk_bf16_f32 v42,v108,v109
s_cselect_b32 s40,0,s40
s_add_u32 s65,s63,s3
v_smfmac_f32_16x16x64_bf16 v[68:71],a[152:155],v[36:43],v18
s_cmp_eq_u32 s62,0
s_cselect_b32 s64,s65,s64
s_cselect_b32 s40,1,s40
s_mul_i32 s64,s64,6144
s_add_u32 s41,s41,s64
s_waitcnt lgkmcnt(0)
s_barrier
v_mfma_f32_16x16x32_bf16 a[232:235],a[144:147],v[36:39],0
s_cmp_ge_u32 s69,6
ds_read_b128 a[136:139],v0 offset:24576
s_cselect_b32 s41,166723584,s41
v_mfma_f32_16x16x32_bf16 a[236:239],a[148:151],v[36:39],0
s_cselect_b32 s30,100663296,s30
ds_read_b128 a[144:147],v0 offset:24704
s_add_u32 s25,s30,s22
v_mfma_f32_16x16x32_bf16 a[240:243],a[120:123],v[36:39],0
s_add_u32 s26,s25,12288
ds_read_b128 a[120:123],v0 offset:24832
s_mov_b32 s28,s41
v_mfma_f32_16x16x32_bf16 a[244:247],a[124:127],v[36:39],0
s_mov_b32 s29,s24
ds_read_b128 a[140:143],v1 offset:24576
s_add_u32 m0,s23,0
v_mfma_f32_16x16x32_bf16 a[248:251],a[128:131],v[36:39],0
buffer_load_dwordx4 v6,s[8:11],s21 offen offset:0 lds
v_mfma_f32_16x16x32_bf16 a[252:255],a[132:135],v[36:39],0
buffer_load_dwordx4 v7,s[8:11],s21 offen offset:1024 lds
buffer_load_dwordx4 v8,s[8:11],s21 offen offset:2048 lds
ds_read_b128 a[128:131],v0 offset:30720
s_add_u32 s21,s21,12288
s_add_u32 m0,s22,12288
s_waitcnt lgkmcnt(4)
v_mfma_f32_16x16x32_bf16 v[104:107],a[136:139],a[96:99],0
buffer_load_dwordx4 v6,s[4:7],s20 offen offset:0 lds
buffer_load_dwordx4 v7,s[4:7],s20 offen offset:1024 lds
buffer_load_dwordx4 v8,s[4:7],s20 offen offset:2048 lds
ds_read_b128 a[148:151],v1 offset:24704
s_waitcnt lgkmcnt(2)
v_mfma_f32_16x16x32_bf16 v[104:107],a[140:143],a[100:103],v[104:107]
s_add_u32 s20,s20,12288
ds_read_b128 a[124:127],v1 offset:24832
v_mfma_f32_16x16x32_bf16 v[104:107],a[144:147],a[104:107],v[104:107]
ds_read_b128 a[132:135],v1 offset:30720
ds_read_b128 a[144:147],v0 offset:30976
ds_read_b128 a[140:143],v1 offset:30848
ds_read_b128 a[136:139],v0 offset:30848
s_waitcnt lgkmcnt(5)
v_mfma_f32_16x16x32_bf16 v[104:107],a[148:151],a[108:111],v[104:107]
ds_read_b128 a[148:151],v1 offset:30976
v_mfma_f32_16x16x32_bf16 v[104:107],a[120:123],a[112:115],v[104:107]
s_waitcnt lgkmcnt(5)
ds_read_b64_tr_b16 a[120:121],v2 offset:12288
v_mfma_f32_16x16x32_bf16 v[104:107],a[124:127],a[116:119],v[104:107]
ds_read_b64_tr_b16 a[122:123],v2 offset:18432
v_mfma_f32_16x16x32_bf16 v[108:111],a[128:131],a[96:99],0
s_waitcnt lgkmcnt(6)
ds_read_b64_tr_b16 a[126:127],v3 offset:18432
v_mfma_f32_16x16x32_bf16 v[108:111],a[132:135],a[100:103],v[108:111]
s_waitcnt lgkmcnt(4)
ds_read_b64_tr_b16 a[124:125],v3 offset:12288
v_mfma_f32_16x16x32_bf16 v[108:111],a[136:139],a[104:107],v[108:111]
ds_read_b64_tr_b16 a[130:131],v4 offset:18432
v_mfma_f32_16x16x32_bf16 v[108:111],a[140:143],a[108:111],v[108:111]
ds_read_b64_tr_b16 a[128:129],v4 offset:12288
v_mfma_f32_16x16x32_bf16 v[108:111],a[144:147],a[112:115],v[108:111]
s_waitcnt lgkmcnt(6)
ds_read_b64_tr_b16 a[132:133],v5 offset:12288
v_mfma_f32_16x16x32_bf16 v[108:111],a[148:151],a[116:119],v[108:111]
s_waitcnt lgkmcnt(5)
ds_read_b64_tr_b16 a[134:135],v5 offset:18432
v_mfma_f32_16x16x32_bf16 v[160:163],a[120:123],v[44:47],v[160:163]
s_add_u32 m0,s23,12288
ds_read_b64_tr_b16 a[136:137],v2 offset:12416
v_fma_f32 v90,v90,s36,v15
s_waitcnt lgkmcnt(5)
v_mfma_f32_16x16x32_bf16 v[164:167],a[124:127],v[44:47],v[164:167]
ds_read_b64_tr_b16 a[138:139],v2 offset:18560
v_fma_f32 v91,v91,s36,v15
v_mfma_f32_16x16x32_bf16 v[212:215],a[124:127],v[48:51],v[212:215]
ds_read_b64_tr_b16 a[140:141],v3 offset:12416
v_fma_f32 v96,v96,s36,v16
v_mfma_f32_16x16x32_bf16 v[208:211],a[120:123],v[48:51],v[208:211]
ds_read_b64_tr_b16 a[142:143],v3 offset:18560
v_fma_f32 v97,v97,s36,v16
v_mfma_f32_16x16x32_bf16 v[112:115],a[120:123],v[52:55],v[112:115]
ds_read_b64_tr_b16 a[144:145],v4 offset:12416
v_fma_f32 v98,v98,s36,v16
v_mfma_f32_16x16x32_bf16 v[116:119],a[124:127],v[52:55],v[116:119]
ds_read_b64_tr_b16 a[146:147],v4 offset:18560
v_fma_f32 v99,v99,s36,v16
v_mfma_f32_16x16x32_bf16 a[164:167],a[124:127],v[56:59],a[164:167]
ds_read_b64_tr_b16 a[148:149],v5 offset:12416
v_fma_f32 v104,v104,s36,v17
v_mfma_f32_16x16x32_bf16 a[160:163],a[120:123],v[56:59],a[160:163]
ds_read_b64_tr_b16 a[150:151],v5 offset:18560
v_fma_f32 v105,v105,s36,v17
v_mfma_f32_16x16x32_bf16 a[208:211],a[120:123],v[40:43],a[208:211]
ds_read_b64_tr_b16 a[120:121],v2 offset:12544
v_fma_f32 v106,v106,s36,v17
v_mfma_f32_16x16x32_bf16 a[212:215],a[124:127],v[40:43],a[212:215]
s_waitcnt lgkmcnt(6)
ds_read_b64_tr_b16 a[122:123],v2 offset:18688
v_fma_f32 v107,v107,s36,v17
v_mfma_f32_16x16x32_bf16 a[216:219],a[128:131],v[40:43],a[216:219]
ds_read_b64_tr_b16 a[124:125],v3 offset:12544
v_fma_f32 v76,v76,s36,v13
v_mfma_f32_16x16x32_bf16 a[220:223],a[132:135],v[40:43],a[220:223]
ds_read_b64_tr_b16 a[126:127],v3 offset:18688
v_fma_f32 v77,v77,s36,v13
v_mfma_f32_16x16x32_bf16 a[172:175],a[132:135],v[56:59],a[172:175]
v_exp_f32 v90,v90
v_mfma_f32_16x16x32_bf16 a[168:171],a[128:131],v[56:59],a[168:171]
v_exp_f32 v91,v91
v_mfma_f32_16x16x32_bf16 v[120:123],a[128:131],v[52:55],v[120:123]
v_cvt_pk_bf16_f32 v29,v90,v91
v_fma_f32 v78,v78,s36,v13
v_mfma_f32_16x16x32_bf16 v[124:127],a[132:135],v[52:55],v[124:127]
v_exp_f32 v96,v96
v_mfma_f32_16x16x32_bf16 v[220:223],a[132:135],v[48:51],v[220:223]
v_exp_f32 v97,v97
v_mfma_f32_16x16x32_bf16 v[216:219],a[128:131],v[48:51],v[216:219]
v_exp_f32 v98,v98
v_mfma_f32_16x16x32_bf16 v[168:171],a[128:131],v[44:47],v[168:171]
ds_read_b64_tr_b16 a[128:129],v4 offset:12544
v_cvt_pk_bf16_f32 v32,v96,v97
v_mfma_f32_16x16x32_bf16 v[172:175],a[132:135],v[44:47],v[172:175]
ds_read_b64_tr_b16 a[130:131],v4 offset:18688
v_fma_f32 v79,v79,s36,v13
v_mfma_f32_16x16x32_bf16 v[176:179],a[136:139],v[44:47],v[176:179]
s_waitcnt lgkmcnt(2)
ds_read_b64_tr_b16 a[132:133],v5 offset:12544
v_fma_f32 v84,v84,s36,v14
v_mfma_f32_16x16x32_bf16 v[180:183],a[140:143],v[44:47],v[180:183]
ds_read_b64_tr_b16 a[134:135],v5 offset:18688
v_fma_f32 v85,v85,s36,v14
v_mfma_f32_16x16x32_bf16 v[228:231],a[140:143],v[48:51],v[228:231]
v_exp_f32 v99,v99
v_mfma_f32_16x16x32_bf16 v[224:227],a[136:139],v[48:51],v[224:227]
v_cvt_pk_bf16_f32 v33,v98,v99
v_fma_f32 v86,v86,s36,v14
v_mfma_f32_16x16x32_bf16 v[128:131],a[136:139],v[52:55],v[128:131]
v_exp_f32 v104,v104
v_mfma_f32_16x16x32_bf16 v[132:135],a[140:143],v[52:55],v[132:135]
v_exp_f32 v105,v105
v_mfma_f32_16x16x32_bf16 a[180:183],a[140:143],v[56:59],a[180:183]
v_exp_f32 v106,v106
v_mfma_f32_16x16x32_bf16 a[176:179],a[136:139],v[56:59],a[176:179]
v_exp_f32 v107,v107
v_mfma_f32_16x16x32_bf16 a[224:227],a[136:139],v[40:43],a[224:227]
v_cvt_pk_bf16_f32 v36,v104,v105
v_cvt_pk_bf16_f32 v37,v106,v107
v_mfma_f32_16x16x32_bf16 a[228:231],a[140:143],v[40:43],a[228:231]
v_exp_f32 v76,v76
v_mfma_f32_16x16x32_bf16 a[232:235],a[144:147],v[40:43],a[232:235]
v_exp_f32 v77,v77
v_mfma_f32_16x16x32_bf16 a[236:239],a[148:151],v[40:43],a[236:239]
v_exp_f32 v78,v78
v_mfma_f32_16x16x32_bf16 a[188:191],a[148:151],v[56:59],a[188:191]
v_exp_f32 v79,v79
v_mfma_f32_16x16x32_bf16 a[184:187],a[144:147],v[56:59],a[184:187]
v_cvt_pk_bf16_f32 v22,v76,v77
v_cvt_pk_bf16_f32 v23,v78,v79
v_mfma_f32_16x16x32_bf16 v[136:139],a[144:147],v[52:55],v[136:139]
v_fma_f32 v87,v87,s36,v14
v_fma_f32 v92,v92,s36,v15
v_mfma_f32_16x16x32_bf16 v[140:143],a[148:151],v[52:55],v[140:143]
v_exp_f32 v84,v84
v_mfma_f32_16x16x32_bf16 v[236:239],a[148:151],v[48:51],v[236:239]
v_exp_f32 v85,v85
v_mfma_f32_16x16x32_bf16 v[232:235],a[144:147],v[48:51],v[232:235]
v_exp_f32 v86,v86
v_mfma_f32_16x16x32_bf16 v[184:187],a[144:147],v[44:47],v[184:187]
v_exp_f32 v87,v87
v_mfma_f32_16x16x32_bf16 v[188:191],a[148:151],v[44:47],v[188:191]
v_cvt_pk_bf16_f32 v26,v84,v85
v_cvt_pk_bf16_f32 v27,v86,v87
v_mfma_f32_16x16x32_bf16 v[192:195],a[120:123],v[44:47],v[192:195]
s_waitcnt vmcnt(6) lgkmcnt(0)
v_fma_f32 v93,v93,s36,v15
v_fma_f32 v94,v94,s36,v15
v_smfmac_f32_16x16x64_bf16 v[60:63],a[152:155],v[20:27],v18
s_barrier
v_mfma_f32_16x16x32_bf16 v[196:199],a[124:127],v[44:47],v[196:199]
ds_read_b128 a[136:139],v0 offset:0
v_fma_f32 v95,v95,s36,v15
v_mfma_f32_16x16x32_bf16 v[244:247],a[124:127],v[48:51],v[244:247]
ds_read_b128 a[140:143],v1 offset:0
v_fma_f32 v100,v100,s36,v16
v_mfma_f32_16x16x32_bf16 v[240:243],a[120:123],v[48:51],v[240:243]
ds_read_b128 a[144:147],v0 offset:128
v_fma_f32 v101,v101,s36,v16
v_mfma_f32_16x16x32_bf16 v[144:147],a[120:123],v[52:55],v[144:147]
ds_read_b128 a[148:151],v1 offset:128
v_fma_f32 v102,v102,s36,v16
v_mfma_f32_16x16x32_bf16 v[148:151],a[124:127],v[52:55],v[148:151]
v_exp_f32 v92,v92
v_mfma_f32_16x16x32_bf16 a[196:199],a[124:127],v[56:59],a[196:199]
buffer_load_dwordx4 v6,s[8:11],s21 offen offset:0 lds
v_mfma_f32_16x16x32_bf16 a[192:195],a[120:123],v[56:59],a[192:195]
v_exp_f32 v93,v93
v_mfma_f32_16x16x32_bf16 a[240:243],a[120:123],v[40:43],a[240:243]
ds_read_b128 a[120:123],v0 offset:256
v_cvt_pk_bf16_f32 v30,v92,v93
v_mfma_f32_16x16x32_bf16 a[244:247],a[124:127],v[40:43],a[244:247]
ds_read_b128 a[124:127],v1 offset:256
v_fma_f32 v103,v103,s36,v16
v_mfma_f32_16x16x32_bf16 a[248:251],a[128:131],v[40:43],a[248:251]
v_exp_f32 v94,v94
v_mfma_f32_16x16x32_bf16 a[252:255],a[132:135],v[40:43],a[252:255]
v_exp_f32 v95,v95
v_mfma_f32_16x16x32_bf16 a[204:207],a[132:135],v[56:59],a[204:207]
v_cvt_pk_bf16_f32 v31,v94,v95
v_fma_f32 v108,v108,s36,v17
v_mfma_f32_16x16x32_bf16 a[200:203],a[128:131],v[56:59],a[200:203]
v_exp_f32 v100,v100
v_mfma_f32_16x16x32_bf16 v[152:155],a[128:131],v[52:55],v[152:155]
v_exp_f32 v101,v101
v_mfma_f32_16x16x32_bf16 v[156:159],a[132:135],v[52:55],v[156:159]
v_exp_f32 v102,v102
v_mfma_f32_16x16x32_bf16 v[252:255],a[132:135],v[48:51],v[252:255]
v_exp_f32 v103,v103
v_mfma_f32_16x16x32_bf16 v[248:251],a[128:131],v[48:51],v[248:251]
buffer_load_dwordx4 v7,s[8:11],s21 offen offset:1024 lds
v_mfma_f32_16x16x32_bf16 v[200:203],a[128:131],v[44:47],v[200:203]
ds_read_b128 a[128:131],v0 offset:6144
v_cvt_pk_bf16_f32 v34,v100,v101
v_mfma_f32_16x16x32_bf16 v[204:207],a[132:135],v[44:47],v[204:207]
s_waitcnt lgkmcnt(1)
ds_read_b128 a[132:135],v1 offset:6144
v_cvt_pk_bf16_f32 v35,v102,v103
v_mfma_f32_16x16x32_bf16 v[72:75],a[136:139],a[0:3],0
v_fma_f32 v109,v109,s36,v17
v_fma_f32 v110,v110,s36,v17
v_smfmac_f32_16x16x64_bf16 v[64:67],a[152:155],v[28:35],v18
v_fma_f32 v111,v111,s36,v17
v_mfma_f32_16x16x32_bf16 v[72:75],a[140:143],a[4:7],v[72:75]
v_exp_f32 v108,v108
v_mfma_f32_16x16x32_bf16 v[72:75],a[144:147],a[8:11],v[72:75]
v_exp_f32 v109,v109
v_mfma_f32_16x16x32_bf16 v[72:75],a[148:151],a[12:15],v[72:75]
v_exp_f32 v110,v110
v_mfma_f32_16x16x32_bf16 v[72:75],a[120:123],a[16:19],v[72:75]
v_exp_f32 v111,v111
v_mfma_f32_16x16x32_bf16 v[72:75],a[124:127],a[20:23],v[72:75]
v_cvt_pk_bf16_f32 v38,v108,v109
v_cvt_pk_bf16_f32 v39,v110,v111
v_mfma_f32_16x16x32_bf16 v[80:83],a[124:127],a[44:47],0
v_mfma_f32_16x16x32_bf16 v[80:83],a[120:123],a[40:43],v[80:83]
v_mfma_f32_16x16x32_bf16 v[80:83],a[148:151],a[36:39],v[80:83]
buffer_load_dwordx4 v8,s[8:11],s21 offen offset:2048 lds
v_mfma_f32_16x16x32_bf16 v[80:83],a[144:147],a[32:35],v[80:83]
s_add_u32 s21,s21,12288
v_fma_f32 v72,v72,s36,v13
v_fma_f32 v73,v73,s36,v13
v_mfma_f32_16x16x32_bf16 v[80:83],a[140:143],a[28:31],v[80:83]
s_add_u32 m0,s22,24576
v_fma_f32 v74,v74,s36,v13
v_fma_f32 v75,v75,s36,v13
v_mfma_f32_16x16x32_bf16 v[80:83],a[136:139],a[24:27],v[80:83]
v_exp_f32 v72,v72
v_mfma_f32_16x16x32_bf16 v[88:91],a[136:139],a[48:51],0
v_exp_f32 v73,v73
v_mfma_f32_16x16x32_bf16 v[88:91],a[140:143],a[52:55],v[88:91]
v_exp_f32 v74,v74
v_mfma_f32_16x16x32_bf16 v[88:91],a[144:147],a[56:59],v[88:91]
v_exp_f32 v75,v75
v_mfma_f32_16x16x32_bf16 v[88:91],a[148:151],a[60:63],v[88:91]
v_fma_f32 v80,v80,s36,v14
v_fma_f32 v81,v81,s36,v14
v_mfma_f32_16x16x32_bf16 v[88:91],a[120:123],a[64:67],v[88:91]
v_fma_f32 v82,v82,s36,v14
v_fma_f32 v83,v83,s36,v14
v_mfma_f32_16x16x32_bf16 v[88:91],a[124:127],a[68:71],v[88:91]
v_exp_f32 v80,v80
v_mfma_f32_16x16x32_bf16 v[96:99],a[124:127],a[92:95],0
v_exp_f32 v81,v81
v_mfma_f32_16x16x32_bf16 v[96:99],a[120:123],a[88:91],v[96:99]
v_exp_f32 v82,v82
v_mfma_f32_16x16x32_bf16 v[96:99],a[148:151],a[84:87],v[96:99]
buffer_load_dwordx4 v6,s[4:7],s20 offen offset:0 lds
v_mfma_f32_16x16x32_bf16 v[96:99],a[144:147],a[80:83],v[96:99]
v_fma_f32 v88,v88,s36,v15
v_fma_f32 v89,v89,s36,v15
v_mfma_f32_16x16x32_bf16 v[96:99],a[140:143],a[76:79],v[96:99]
v_exp_f32 v83,v83
v_mfma_f32_16x16x32_bf16 v[96:99],a[136:139],a[72:75],v[96:99]
v_exp_f32 v88,v88
v_mfma_f32_16x16x32_bf16 v[104:107],a[136:139],a[96:99],0
ds_read_b128 a[136:139],v0 offset:6272
v_cvt_pk_bf16_f32 v44,v72,v73
v_mfma_f32_16x16x32_bf16 v[104:107],a[140:143],a[100:103],v[104:107]
ds_read_b128 a[140:143],v1 offset:6272
v_cvt_pk_bf16_f32 v45,v74,v75
v_mfma_f32_16x16x32_bf16 v[104:107],a[144:147],a[104:107],v[104:107]
ds_read_b128 a[144:147],v0 offset:6400
v_cvt_pk_bf16_f32 v48,v80,v81
v_mfma_f32_16x16x32_bf16 v[104:107],a[148:151],a[108:111],v[104:107]
ds_read_b128 a[148:151],v1 offset:6400
v_cvt_pk_bf16_f32 v49,v82,v83
v_mfma_f32_16x16x32_bf16 v[104:107],a[120:123],a[112:115],v[104:107]
v_exp_f32 v89,v89
v_mfma_f32_16x16x32_bf16 v[104:107],a[124:127],a[116:119],v[104:107]
s_waitcnt lgkmcnt(4)
v_cvt_pk_bf16_f32 v52,v88,v89
v_mfma_f32_16x16x32_bf16 v[76:79],a[128:131],a[0:3],0
v_mfma_f32_16x16x32_bf16 v[76:79],a[132:135],a[4:7],v[76:79]
buffer_load_dwordx4 v7,s[4:7],s20 offen offset:1024 lds
s_waitcnt lgkmcnt(3)
v_mfma_f32_16x16x32_bf16 v[76:79],a[136:139],a[8:11],v[76:79]
s_waitcnt lgkmcnt(2)
v_mfma_f32_16x16x32_bf16 v[76:79],a[140:143],a[12:15],v[76:79]
s_waitcnt lgkmcnt(1)
v_mfma_f32_16x16x32_bf16 v[76:79],a[144:147],a[16:19],v[76:79]
s_waitcnt lgkmcnt(0)
v_mfma_f32_16x16x32_bf16 v[76:79],a[148:151],a[20:23],v[76:79]
v_mfma_f32_16x16x32_bf16 v[84:87],a[148:151],a[44:47],0
v_mfma_f32_16x16x32_bf16 v[84:87],a[144:147],a[40:43],v[84:87]
v_mfma_f32_16x16x32_bf16 v[84:87],a[140:143],a[36:39],v[84:87]
v_mfma_f32_16x16x32_bf16 v[84:87],a[136:139],a[32:35],v[84:87]
v_mfma_f32_16x16x32_bf16 v[84:87],a[132:135],a[28:31],v[84:87]
v_mfma_f32_16x16x32_bf16 v[84:87],a[128:131],a[24:27],v[84:87]
v_mfma_f32_16x16x32_bf16 v[92:95],a[128:131],a[48:51],0
v_mfma_f32_16x16x32_bf16 v[92:95],a[132:135],a[52:55],v[92:95]
buffer_load_dwordx4 v8,s[4:7],s20 offen offset:2048 lds
v_mfma_f32_16x16x32_bf16 v[92:95],a[136:139],a[56:59],v[92:95]
s_add_u32 s20,s20,12288
v_mfma_f32_16x16x32_bf16 v[92:95],a[140:143],a[60:63],v[92:95]
v_mfma_f32_16x16x32_bf16 v[92:95],a[144:147],a[64:67],v[92:95]
v_mfma_f32_16x16x32_bf16 v[92:95],a[148:151],a[68:71],v[92:95]
v_mfma_f32_16x16x32_bf16 v[100:103],a[148:151],a[92:95],0
v_mfma_f32_16x16x32_bf16 v[100:103],a[144:147],a[88:91],v[100:103]
ds_read_b64_tr_b16 a[120:121],v2 offset:24576
v_mfma_f32_16x16x32_bf16 v[100:103],a[140:143],a[84:87],v[100:103]
ds_read_b64_tr_b16 a[122:123],v2 offset:30720
v_mfma_f32_16x16x32_bf16 v[100:103],a[136:139],a[80:83],v[100:103]
ds_read_b64_tr_b16 a[124:125],v3 offset:24576
v_mfma_f32_16x16x32_bf16 v[100:103],a[132:135],a[76:79],v[100:103]
ds_read_b64_tr_b16 a[126:127],v3 offset:30720
v_mfma_f32_16x16x32_bf16 v[100:103],a[128:131],a[72:75],v[100:103]
v_mfma_f32_16x16x32_bf16 v[108:111],a[128:131],a[96:99],0
ds_read_b64_tr_b16 a[128:129],v4 offset:24576
v_mfma_f32_16x16x32_bf16 v[108:111],a[132:135],a[100:103],v[108:111]
ds_read_b64_tr_b16 a[130:131],v4 offset:30720
v_mfma_f32_16x16x32_bf16 v[108:111],a[136:139],a[104:107],v[108:111]
ds_read_b64_tr_b16 a[132:133],v5 offset:24576
v_mfma_f32_16x16x32_bf16 v[108:111],a[140:143],a[108:111],v[108:111]
ds_read_b64_tr_b16 a[134:135],v5 offset:30720
v_mfma_f32_16x16x32_bf16 v[108:111],a[144:147],a[112:115],v[108:111]
v_mfma_f32_16x16x32_bf16 v[108:111],a[148:151],a[116:119],v[108:111]
s_mov_b32 s38,0
s_branch L_loop5
L_start4:
s_add_u32 m0,s24,12288
s_waitcnt vmcnt(15)
ds_read_b128 a[8:11],v11 offset:128
buffer_load_dwordx4 v6,s[12:15],s28 offen offset:0 nt lds
ds_read_b128 a[0:3],v11 offset:0
buffer_load_dwordx4 v7,s[12:15],s28 offen offset:1024 nt lds
ds_read_b128 a[4:7],v12 offset:0
buffer_load_dwordx4 v8,s[12:15],s28 offen offset:2048 nt lds
s_add_u32 s28,s28,3072
s_add_u32 m0,s24,15360
ds_read_b128 a[12:15],v12 offset:128
buffer_load_dwordx4 v6,s[12:15],s28 offen offset:0 nt lds
ds_read_b128 a[16:19],v11 offset:256
buffer_load_dwordx4 v7,s[12:15],s28 offen offset:1024 nt lds
ds_read_b128 a[20:23],v12 offset:256
buffer_load_dwordx4 v8,s[12:15],s28 offen offset:2048 nt lds
s_add_u32 s28,s28,3072
s_add_u32 m0,s24,0
ds_read_b128 a[120:123],v0 offset:0
v_mov_b32 v65,0
v_mov_b32 v66,0
v_mov_b32 v61,0
v_mov_b32 v67,0
v_mov_b32 v64,0
v_mov_b32 v60,0
v_mov_b32 v63,0
ds_read_b128 a[124:127],v1 offset:0
v_mov_b32 v62,0
ds_read_b128 a[132:135],v1 offset:128
ds_read_b128 a[128:131],v0 offset:128
ds_read_b128 a[136:139],v0 offset:256
ds_read_b128 a[144:147],v0 offset:6144
s_waitcnt lgkmcnt(5)
v_mfma_f32_16x16x32_bf16 v[72:75],a[120:123],a[0:3],0
s_waitcnt lgkmcnt(4)
ds_read_b128 a[140:143],v1 offset:256
ds_read_b128 a[148:151],v1 offset:6144
v_mfma_f32_16x16x32_bf16 v[72:75],a[124:127],a[4:7],v[72:75]
s_waitcnt lgkmcnt(4)
ds_read_b128 a[120:123],v0 offset:6272
ds_read_b128 a[124:127],v1 offset:6272
v_mfma_f32_16x16x32_bf16 v[72:75],a[128:131],a[8:11],v[72:75]
ds_read_b128 a[128:131],v0 offset:6400
v_mfma_f32_16x16x32_bf16 v[72:75],a[132:135],a[12:15],v[72:75]
s_waitcnt lgkmcnt(6)
ds_read_b128 a[132:135],v1 offset:6400
v_mfma_f32_16x16x32_bf16 v[72:75],a[136:139],a[16:19],v[72:75]
s_waitcnt lgkmcnt(5)
ds_read_b128 a[136:139],v0 offset:12288
v_mfma_f32_16x16x32_bf16 v[72:75],a[140:143],a[20:23],v[72:75]
ds_read_b128 a[140:143],v1 offset:12288
v_mfma_f32_16x16x32_bf16 v[76:79],a[144:147],a[0:3],0
s_waitcnt lgkmcnt(6)
ds_read_b128 a[144:147],v0 offset:12416
v_mfma_f32_16x16x32_bf16 v[76:79],a[148:151],a[4:7],v[76:79]
s_waitcnt lgkmcnt(6)
ds_read_b128 a[148:151],v1 offset:12416
v_mfma_f32_16x16x32_bf16 v[76:79],a[120:123],a[8:11],v[76:79]
s_waitcnt lgkmcnt(6)
ds_read_b128 a[120:123],v0 offset:12544
v_mfma_f32_16x16x32_bf16 v[76:79],a[124:127],a[12:15],v[76:79]
s_waitcnt lgkmcnt(6)
ds_read_b128 a[124:127],v1 offset:12544
v_max3_f32 v44,v72,v73,v74
v_mfma_f32_16x16x32_bf16 v[76:79],a[128:131],a[16:19],v[76:79]
s_waitcnt lgkmcnt(6)
ds_read_b128 a[128:131],v0 offset:18432
v_max_f32 v44,v44,v75
v_mfma_f32_16x16x32_bf16 v[76:79],a[132:135],a[20:23],v[76:79]
ds_read_b128 a[132:135],v1 offset:18432
v_mov_b32 v45,v44
s_nop 1
v_permlane32_swap_b32 v45,v44
v_max_f32 v44,v44,v45
v_mov_b32 v45,v44
s_nop 1
v_permlane16_swap_b32 v45,v44
v_max_f32 v44,v44,v45
v_mul_f32_e64 v13,-s36,v44
v_fma_f32 v75,v75,s36,v13
v_fma_f32 v72,v72,s36,v13
v_exp_f32 v75,v75
v_fma_f32 v73,v73,s36,v13
v_exp_f32 v73,v73
v_fma_f32 v74,v74,s36,v13
v_exp_f32 v74,v74
v_exp_f32 v72,v72
v_cvt_pk_bf16_f32 v21,v74,v75
v_cvt_pk_bf16_f32 v20,v72,v73
s_waitcnt lgkmcnt(1)
v_mfma_f32_16x16x32_bf16 v[72:75],a[136:139],a[0:3],0
ds_read_b128 a[136:139],v0 offset:18560
v_fma_f32 v77,v77,s36,v13
v_mfma_f32_16x16x32_bf16 v[72:75],a[140:143],a[4:7],v[72:75]
ds_read_b128 a[140:143],v1 offset:18560
v_fma_f32 v78,v78,s36,v13
v_mfma_f32_16x16x32_bf16 v[72:75],a[144:147],a[8:11],v[72:75]
ds_read_b128 a[144:147],v0 offset:18688
v_exp_f32 v78,v78
v_mfma_f32_16x16x32_bf16 v[72:75],a[148:151],a[12:15],v[72:75]
ds_read_b128 a[148:151],v1 offset:18688
v_fma_f32 v76,v76,s36,v13
v_mfma_f32_16x16x32_bf16 v[72:75],a[120:123],a[16:19],v[72:75]
v_exp_f32 v76,v76
v_mfma_f32_16x16x32_bf16 v[72:75],a[124:127],a[20:23],v[72:75]
v_fma_f32 v79,v79,s36,v13
v_exp_f32 v79,v79
v_exp_f32 v77,v77
v_cvt_pk_bf16_f32 v23,v78,v79
v_cvt_pk_bf16_f32 v22,v76,v77
v_mfma_f32_16x16x32_bf16 v[76:79],a[128:131],a[0:3],0
s_waitcnt lgkmcnt(3)
v_mfma_f32_16x16x32_bf16 v[76:79],a[132:135],a[4:7],v[76:79]
v_mfma_f32_16x16x32_bf16 v[76:79],a[136:139],a[8:11],v[76:79]
s_waitcnt lgkmcnt(1)
v_fma_f32 v74,v74,s36,v13
v_fma_f32 v75,v75,s36,v13
v_mfma_f32_16x16x32_bf16 v[76:79],a[140:143],a[12:15],v[76:79]
v_exp_f32 v75,v75
v_mfma_f32_16x16x32_bf16 v[76:79],a[144:147],a[16:19],v[76:79]
s_waitcnt lgkmcnt(0)
v_fma_f32 v72,v72,s36,v13
v_fma_f32 v73,v73,s36,v13
v_mfma_f32_16x16x32_bf16 v[76:79],a[148:151],a[20:23],v[76:79]
s_waitcnt vmcnt(12)
s_barrier
ds_read_b64_tr_b16 a[122:123],v2 offset:6144
v_exp_f32 v73,v73
v_exp_f32 v72,v72
v_exp_f32 v74,v74
ds_read_b64_tr_b16 a[124:125],v3 offset:0
ds_read_b64_tr_b16 a[126:127],v3 offset:6144
ds_read_b64_tr_b16 a[120:121],v2 offset:0
ds_read_b64_tr_b16 a[128:129],v4 offset:0
ds_read_b64_tr_b16 a[134:135],v5 offset:6144
ds_read_b64_tr_b16 a[132:133],v5 offset:0
ds_read_b64_tr_b16 a[140:141],v3 offset:128
ds_read_b64_tr_b16 a[142:143],v3 offset:6272
ds_read_b64_tr_b16 a[130:131],v4 offset:6144
ds_read_b64_tr_b16 a[136:137],v2 offset:128
ds_read_b64_tr_b16 a[138:139],v2 offset:6272
ds_read_b64_tr_b16 a[144:145],v4 offset:128
ds_read_b64_tr_b16 a[150:151],v5 offset:6272
ds_read_b64_tr_b16 a[148:149],v5 offset:128
ds_read_b64_tr_b16 a[146:147],v4 offset:6272
v_cvt_pk_bf16_f32 v45,v74,v75
v_cvt_pk_bf16_f32 v44,v72,v73
v_fma_f32 v79,v79,s36,v13
v_fma_f32 v78,v78,s36,v13
v_fma_f32 v77,v77,s36,v13
s_waitcnt lgkmcnt(12)
v_mfma_f32_16x16x32_bf16 v[160:163],a[120:123],v[20:23],0
ds_read_b64_tr_b16 a[122:123],v2 offset:6400
v_exp_f32 v77,v77
v_mfma_f32_16x16x32_bf16 v[164:167],a[124:127],v[20:23],0
s_waitcnt lgkmcnt(7)
ds_read_b64_tr_b16 a[126:127],v3 offset:6400
v_exp_f32 v78,v78
v_exp_f32 v79,v79
v_mfma_f32_16x16x32_bf16 v[168:171],a[128:131],v[20:23],0
ds_read_b64_tr_b16 a[130:131],v4 offset:6400
v_fma_f32 v76,v76,s36,v13
v_mfma_f32_16x16x32_bf16 v[172:175],a[132:135],v[20:23],0
s_waitcnt lgkmcnt(4)
ds_read_b64_tr_b16 a[124:125],v3 offset:256
v_exp_f32 v76,v76
v_mfma_f32_16x16x32_bf16 v[176:179],a[136:139],v[20:23],0
ds_read_b64_tr_b16 a[120:121],v2 offset:256
v_cvt_pk_bf16_f32 v47,v78,v79
v_mfma_f32_16x16x32_bf16 v[180:183],a[140:143],v[20:23],0
s_waitcnt lgkmcnt(5)
ds_read_b64_tr_b16 a[134:135],v5 offset:6400
v_cvt_pk_bf16_f32 v46,v76,v77
v_mfma_f32_16x16x32_bf16 v[184:187],a[144:147],v[20:23],0
ds_read_b128 a[140:143],v1 offset:24576
v_mfma_f32_16x16x32_bf16 v[188:191],a[148:151],v[20:23],0
ds_read_b64_tr_b16 a[128:129],v4 offset:256
ds_read_b64_tr_b16 a[132:133],v5 offset:256
ds_read_b128 a[136:139],v0 offset:24576
ds_read_b128 a[148:151],v1 offset:24704
ds_read_b128 a[144:147],v0 offset:24704
s_waitcnt lgkmcnt(7)
v_mfma_f32_16x16x32_bf16 v[192:195],a[120:123],v[20:23],0
ds_read_b128 a[120:123],v0 offset:24832
v_mfma_f32_16x16x32_bf16 v[196:199],a[124:127],v[20:23],0
s_waitcnt lgkmcnt(5)
ds_read_b128 a[124:127],v1 offset:24832
v_mfma_f32_16x16x32_bf16 v[200:203],a[128:131],v[20:23],0
s_waitcnt lgkmcnt(5)
ds_read_b128 a[128:131],v0 offset:30720
v_mfma_f32_16x16x32_bf16 v[204:207],a[132:135],v[20:23],0
s_waitcnt lgkmcnt(5)
ds_read_b128 a[132:135],v1 offset:30720
v_mfma_f32_16x16x32_bf16 v[72:75],a[136:139],a[0:3],0
ds_read_b128 a[136:139],v0 offset:30848
v_mfma_f32_16x16x32_bf16 v[72:75],a[140:143],a[4:7],v[72:75]
s_waitcnt lgkmcnt(5)
ds_read_b128 a[140:143],v1 offset:30848
v_mfma_f32_16x16x32_bf16 v[72:75],a[144:147],a[8:11],v[72:75]
ds_read_b128 a[144:147],v0 offset:30976
v_mfma_f32_16x16x32_bf16 v[72:75],a[148:151],a[12:15],v[72:75]
s_waitcnt lgkmcnt(6)
ds_read_b128 a[148:151],v1 offset:30976
v_mfma_f32_16x16x32_bf16 v[72:75],a[120:123],a[16:19],v[72:75]
s_waitcnt lgkmcnt(6)
ds_read_b128 a[120:123],v0 offset:0
v_mfma_f32_16x16x32_bf16 v[72:75],a[124:127],a[20:23],v[72:75]
s_waitcnt lgkmcnt(6)
ds_read_b128 a[124:127],v1 offset:0
v_mfma_f32_16x16x32_bf16 v[76:79],a[128:131],a[0:3],0
s_waitcnt lgkmcnt(6)
ds_read_b128 a[128:131],v0 offset:128
v_mfma_f32_16x16x32_bf16 v[76:79],a[132:135],a[4:7],v[76:79]
s_waitcnt lgkmcnt(6)
ds_read_b128 a[132:135],v1 offset:128
v_mfma_f32_16x16x32_bf16 v[76:79],a[136:139],a[8:11],v[76:79]
s_waitcnt lgkmcnt(6)
ds_read_b128 a[136:139],v0 offset:256
v_mfma_f32_16x16x32_bf16 v[76:79],a[140:143],a[12:15],v[76:79]
s_waitcnt lgkmcnt(6)
ds_read_b128 a[140:143],v1 offset:256
v_fma_f32 v74,v74,s36,v13
v_mfma_f32_16x16x32_bf16 v[76:79],a[144:147],a[16:19],v[76:79]
s_waitcnt lgkmcnt(6)
ds_read_b128 a[144:147],v0 offset:6144
v_fma_f32 v73,v73,s36,v13
v_mfma_f32_16x16x32_bf16 v[76:79],a[148:151],a[20:23],v[76:79]
s_waitcnt vmcnt(6)
ds_read_b128 a[24:27],v11 offset:6144
buffer_load_dwordx4 v6,s[12:15],s28 offen offset:0 nt lds
ds_read_b128 a[28:31],v12 offset:6144
buffer_load_dwordx4 v7,s[12:15],s28 offen offset:1024 nt lds
ds_read_b128 a[32:35],v11 offset:6272
buffer_load_dwordx4 v8,s[12:15],s28 offen offset:2048 nt lds
s_add_u32 s28,s28,3072
s_add_u32 m0,s24,3072
ds_read_b128 a[36:39],v12 offset:6272
buffer_load_dwordx4 v6,s[12:15],s28 offen offset:0 nt lds
ds_read_b128 a[40:43],v11 offset:6400
buffer_load_dwordx4 v7,s[12:15],s28 offen offset:1024 nt lds
ds_read_b128 a[44:47],v12 offset:6400
buffer_load_dwordx4 v8,s[12:15],s28 offen offset:2048 nt lds
s_add_u32 s28,s28,3072
s_add_u32 m0,s23,12288
ds_read_b128 a[148:151],v1 offset:6144
v_exp_f32 v74,v74
s_waitcnt lgkmcnt(6)
v_mfma_f32_16x16x32_bf16 v[80:83],a[120:123],a[24:27],0
s_waitcnt lgkmcnt(5)
ds_read_b128 a[120:123],v0 offset:6272
v_exp_f32 v73,v73
v_mfma_f32_16x16x32_bf16 v[80:83],a[124:127],a[28:31],v[80:83]
s_waitcnt lgkmcnt(5)
ds_read_b128 a[124:127],v1 offset:6272
v_fma_f32 v72,v72,s36,v13
v_mfma_f32_16x16x32_bf16 v[80:83],a[128:131],a[32:35],v[80:83]
s_waitcnt lgkmcnt(4)
ds_read_b128 a[128:131],v0 offset:6400
v_exp_f32 v72,v72
v_mfma_f32_16x16x32_bf16 v[80:83],a[132:135],a[36:39],v[80:83]
ds_read_b128 a[132:135],v1 offset:6400
v_fma_f32 v75,v75,s36,v13
v_mfma_f32_16x16x32_bf16 v[80:83],a[136:139],a[40:43],v[80:83]
s_waitcnt lgkmcnt(4)
ds_read_b128 a[136:139],v0 offset:12288
v_exp_f32 v75,v75
v_mfma_f32_16x16x32_bf16 v[80:83],a[140:143],a[44:47],v[80:83]
ds_read_b128 a[140:143],v1 offset:12288
v_mfma_f32_16x16x32_bf16 v[84:87],a[144:147],a[24:27],0
ds_read_b128 a[144:147],v0 offset:12416
v_mfma_f32_16x16x32_bf16 v[84:87],a[148:151],a[28:31],v[84:87]
s_waitcnt lgkmcnt(5)
ds_read_b128 a[148:151],v1 offset:12416
v_mfma_f32_16x16x32_bf16 v[84:87],a[120:123],a[32:35],v[84:87]
ds_read_b128 a[120:123],v0 offset:12544
v_mfma_f32_16x16x32_bf16 v[84:87],a[124:127],a[36:39],v[84:87]
s_waitcnt lgkmcnt(6)
ds_read_b128 a[124:127],v1 offset:12544
v_max3_f32 v48,v80,v81,v82
v_mfma_f32_16x16x32_bf16 v[84:87],a[128:131],a[40:43],v[84:87]
s_waitcnt lgkmcnt(6)
ds_read_b128 a[128:131],v0 offset:18432
v_max_f32 v48,v48,v83
v_mfma_f32_16x16x32_bf16 v[84:87],a[132:135],a[44:47],v[84:87]
ds_read_b128 a[132:135],v1 offset:18432
v_mov_b32 v49,v48
s_nop 1
v_permlane32_swap_b32 v49,v48
v_max_f32 v48,v48,v49
v_mov_b32 v49,v48
s_nop 1
v_permlane16_swap_b32 v49,v48
v_max_f32 v48,v48,v49
v_mul_f32_e64 v14,-s36,v48
v_fma_f32 v80,v80,s36,v14
v_exp_f32 v80,v80
v_fma_f32 v83,v83,s36,v14
v_fma_f32 v82,v82,s36,v14
v_fma_f32 v81,v81,s36,v14
v_exp_f32 v81,v81
v_exp_f32 v83,v83
v_exp_f32 v82,v82
v_cvt_pk_bf16_f32 v24,v80,v81
v_cvt_pk_bf16_f32 v25,v82,v83
s_waitcnt lgkmcnt(1)
v_mfma_f32_16x16x32_bf16 v[80:83],a[136:139],a[24:27],0
ds_read_b128 a[136:139],v0 offset:18560
v_fma_f32 v85,v85,s36,v14
v_mfma_f32_16x16x32_bf16 v[80:83],a[140:143],a[28:31],v[80:83]
ds_read_b128 a[140:143],v1 offset:18560
v_fma_f32 v84,v84,s36,v14
v_mfma_f32_16x16x32_bf16 v[80:83],a[144:147],a[32:35],v[80:83]
ds_read_b128 a[144:147],v0 offset:18688
v_exp_f32 v84,v84
v_mfma_f32_16x16x32_bf16 v[80:83],a[148:151],a[36:39],v[80:83]
ds_read_b128 a[148:151],v1 offset:18688
v_exp_f32 v85,v85
v_mfma_f32_16x16x32_bf16 v[80:83],a[120:123],a[40:43],v[80:83]
ds_read_b64_tr_b16 a[120:121],v2 offset:0
v_fma_f32 v87,v87,s36,v14
v_mfma_f32_16x16x32_bf16 v[80:83],a[124:127],a[44:47],v[80:83]
ds_read_b64_tr_b16 a[124:125],v3 offset:0
v_exp_f32 v87,v87
ds_read_b64_tr_b16 a[122:123],v2 offset:6144
v_fma_f32 v86,v86,s36,v14
ds_read_b64_tr_b16 a[126:127],v3 offset:6144
v_exp_f32 v86,v86
v_cvt_pk_bf16_f32 v26,v84,v85
v_cvt_pk_bf16_f32 v27,v86,v87
v_mfma_f32_16x16x32_bf16 v[84:87],a[128:131],a[24:27],0
ds_read_b64_tr_b16 a[128:129],v4 offset:0
v_fma_f32 v83,v83,s36,v14
v_smfmac_f32_16x16x64_bf16 v[60:63],a[152:155],v[20:27],v18
s_waitcnt lgkmcnt(5)
ds_read_b64_tr_b16 a[130:131],v4 offset:6144
v_mfma_f32_16x16x32_bf16 v[84:87],a[132:135],a[28:31],v[84:87]
ds_read_b64_tr_b16 a[134:135],v5 offset:6144
v_fma_f32 v80,v80,s36,v14
v_mfma_f32_16x16x32_bf16 v[84:87],a[136:139],a[32:35],v[84:87]
ds_read_b64_tr_b16 a[132:133],v5 offset:0
v_exp_f32 v83,v83
v_mfma_f32_16x16x32_bf16 v[84:87],a[140:143],a[36:39],v[84:87]
ds_read_b64_tr_b16 a[142:143],v3 offset:6272
v_fma_f32 v81,v81,s36,v14
v_mfma_f32_16x16x32_bf16 v[84:87],a[144:147],a[40:43],v[84:87]
ds_read_b64_tr_b16 a[140:141],v3 offset:128
v_fma_f32 v82,v82,s36,v14
v_mfma_f32_16x16x32_bf16 v[84:87],a[148:151],a[44:47],v[84:87]
s_waitcnt lgkmcnt(6)
ds_read_b64_tr_b16 a[136:137],v2 offset:128
v_exp_f32 v82,v82
v_mfma_f32_16x16x32_bf16 v[208:211],a[120:123],v[24:27],0
ds_read_b64_tr_b16 a[138:139],v2 offset:6272
v_cvt_pk_bf16_f32 v49,v82,v83
v_mfma_f32_16x16x32_bf16 v[212:215],a[124:127],v[24:27],0
s_waitcnt lgkmcnt(5)
ds_read_b64_tr_b16 a[148:149],v5 offset:128
v_exp_f32 v80,v80
v_mfma_f32_16x16x32_bf16 v[216:219],a[128:131],v[24:27],0
s_waitcnt lgkmcnt(4)
ds_read_b64_tr_b16 a[146:147],v4 offset:6272
v_exp_f32 v81,v81
ds_read_b64_tr_b16 a[144:145],v4 offset:128
v_mfma_f32_16x16x32_bf16 v[220:223],a[132:135],v[24:27],0
ds_read_b64_tr_b16 a[150:151],v5 offset:6272
ds_read_b64_tr_b16 a[120:121],v2 offset:256
ds_read_b64_tr_b16 a[128:129],v4 offset:256
ds_read_b64_tr_b16 a[122:123],v2 offset:6400
ds_read_b64_tr_b16 a[126:127],v3 offset:6400
ds_read_b64_tr_b16 a[124:125],v3 offset:256
v_cvt_pk_bf16_f32 v48,v80,v81
v_fma_f32 v84,v84,s36,v14
ds_read_b64_tr_b16 a[130:131],v4 offset:6400
s_waitcnt lgkmcnt(10)
v_mfma_f32_16x16x32_bf16 v[224:227],a[136:139],v[24:27],0
ds_read_b64_tr_b16 a[132:133],v5 offset:256
v_exp_f32 v84,v84
ds_read_b64_tr_b16 a[134:135],v5 offset:6400
v_mfma_f32_16x16x32_bf16 v[228:231],a[140:143],v[24:27],0
s_waitcnt lgkmcnt(9)
ds_read_b128 a[140:143],v1 offset:24576
v_fma_f32 v85,v85,s36,v14
v_mfma_f32_16x16x32_bf16 v[232:235],a[144:147],v[24:27],0
s_waitcnt lgkmcnt(9)
ds_read_b128 a[136:139],v0 offset:24576
v_fma_f32 v86,v86,s36,v14
v_mfma_f32_16x16x32_bf16 v[236:239],a[148:151],v[24:27],0
s_waitcnt lgkmcnt(5)
ds_read_b128 a[148:151],v1 offset:24704
v_exp_f32 v85,v85
v_mfma_f32_16x16x32_bf16 v[240:243],a[120:123],v[24:27],0
ds_read_b128 a[120:123],v0 offset:24832
v_exp_f32 v86,v86
v_mfma_f32_16x16x32_bf16 v[244:247],a[124:127],v[24:27],0
s_waitcnt lgkmcnt(5)
ds_read_b128 a[144:147],v0 offset:24704
v_fma_f32 v87,v87,s36,v14
v_mfma_f32_16x16x32_bf16 v[248:251],a[128:131],v[24:27],0
ds_read_b128 a[128:131],v0 offset:30720
v_cvt_pk_bf16_f32 v50,v84,v85
v_exp_f32 v87,v87
v_cvt_pk_bf16_f32 v20,v72,v73
s_waitcnt lgkmcnt(5)
v_mfma_f32_16x16x32_bf16 v[252:255],a[132:135],v[24:27],0
s_waitcnt lgkmcnt(4)
ds_read_b128 a[124:127],v1 offset:24832
v_cvt_pk_bf16_f32 v51,v86,v87
v_cvt_pk_bf16_f32 v21,v74,v75
v_mfma_f32_16x16x32_bf16 v[80:83],a[136:139],a[24:27],0
ds_read_b128 a[136:139],v0 offset:30848
v_smfmac_f32_16x16x64_bf16 v[60:63],a[152:155],v[44:51],v18
ds_read_b128 a[132:135],v1 offset:30720
v_mfma_f32_16x16x32_bf16 v[80:83],a[140:143],a[28:31],v[80:83]
s_waitcnt lgkmcnt(4)
ds_read_b128 a[140:143],v1 offset:30848
v_mfma_f32_16x16x32_bf16 v[80:83],a[144:147],a[32:35],v[80:83]
ds_read_b128 a[144:147],v0 offset:30976
v_mfma_f32_16x16x32_bf16 v[80:83],a[148:151],a[36:39],v[80:83]
ds_read_b128 a[148:151],v1 offset:30976
v_mfma_f32_16x16x32_bf16 v[80:83],a[120:123],a[40:43],v[80:83]
s_waitcnt lgkmcnt(5)
ds_read_b128 a[120:123],v0 offset:0
v_mfma_f32_16x16x32_bf16 v[80:83],a[124:127],a[44:47],v[80:83]
ds_read_b128 a[124:127],v1 offset:0
v_mfma_f32_16x16x32_bf16 v[84:87],a[128:131],a[24:27],0
s_waitcnt lgkmcnt(5)
ds_read_b128 a[128:131],v0 offset:128
v_mfma_f32_16x16x32_bf16 v[84:87],a[132:135],a[28:31],v[84:87]
ds_read_b128 a[132:135],v1 offset:128
v_mfma_f32_16x16x32_bf16 v[84:87],a[136:139],a[32:35],v[84:87]
s_waitcnt lgkmcnt(6)
ds_read_b128 a[136:139],v0 offset:256
v_mfma_f32_16x16x32_bf16 v[84:87],a[140:143],a[36:39],v[84:87]
s_waitcnt lgkmcnt(6)
ds_read_b128 a[140:143],v1 offset:256
v_fma_f32 v81,v81,s36,v14
v_mfma_f32_16x16x32_bf16 v[84:87],a[144:147],a[40:43],v[84:87]
s_waitcnt lgkmcnt(6)
ds_read_b128 a[144:147],v0 offset:6144
v_fma_f32 v80,v80,s36,v14
v_mfma_f32_16x16x32_bf16 v[84:87],a[148:151],a[44:47],v[84:87]
s_waitcnt vmcnt(6)
ds_read_b128 a[48:51],v11 offset:12288
buffer_load_dwordx4 v6,s[8:11],s21 offen offset:0 lds
ds_read_b128 a[52:55],v12 offset:12288
buffer_load_dwordx4 v7,s[8:11],s21 offen offset:1024 lds
ds_read_b128 a[56:59],v11 offset:12416
buffer_load_dwordx4 v8,s[8:11],s21 offen offset:2048 lds
s_add_u32 s21,s21,12288
s_add_u32 m0,s23,24576
ds_read_b128 a[60:63],v12 offset:12416
v_exp_f32 v81,v81
v_exp_f32 v80,v80
ds_read_b128 a[68:71],v12 offset:12544
v_cvt_pk_bf16_f32 v24,v80,v81
ds_read_b128 a[64:67],v11 offset:12544
ds_read_b128 a[148:151],v1 offset:6144
s_waitcnt lgkmcnt(6)
v_mfma_f32_16x16x32_bf16 v[88:91],a[120:123],a[48:51],0
s_waitcnt lgkmcnt(5)
ds_read_b128 a[120:123],v0 offset:6272
v_mfma_f32_16x16x32_bf16 v[88:91],a[124:127],a[52:55],v[88:91]
s_waitcnt lgkmcnt(5)
ds_read_b128 a[124:127],v1 offset:6272
v_mfma_f32_16x16x32_bf16 v[88:91],a[128:131],a[56:59],v[88:91]
s_waitcnt lgkmcnt(5)
ds_read_b128 a[128:131],v0 offset:6400
v_mfma_f32_16x16x32_bf16 v[88:91],a[132:135],a[60:63],v[88:91]
s_waitcnt lgkmcnt(4)
ds_read_b128 a[132:135],v1 offset:6400
v_mfma_f32_16x16x32_bf16 v[88:91],a[136:139],a[64:67],v[88:91]
ds_read_b128 a[136:139],v0 offset:12288
v_mfma_f32_16x16x32_bf16 v[88:91],a[140:143],a[68:71],v[88:91]
ds_read_b128 a[140:143],v1 offset:12288
v_mfma_f32_16x16x32_bf16 v[92:95],a[144:147],a[48:51],0
s_waitcnt lgkmcnt(6)
ds_read_b128 a[144:147],v0 offset:12416
v_mfma_f32_16x16x32_bf16 v[92:95],a[148:151],a[52:55],v[92:95]
s_waitcnt lgkmcnt(6)
ds_read_b128 a[148:151],v1 offset:12416
v_mfma_f32_16x16x32_bf16 v[92:95],a[120:123],a[56:59],v[92:95]
s_waitcnt lgkmcnt(6)
ds_read_b128 a[120:123],v0 offset:12544
v_mfma_f32_16x16x32_bf16 v[92:95],a[124:127],a[60:63],v[92:95]
s_waitcnt lgkmcnt(6)
ds_read_b128 a[124:127],v1 offset:12544
v_max3_f32 v52,v88,v89,v90
v_mfma_f32_16x16x32_bf16 v[92:95],a[128:131],a[64:67],v[92:95]
s_waitcnt lgkmcnt(6)
ds_read_b128 a[128:131],v0 offset:18432
v_max_f32 v52,v52,v91
v_mfma_f32_16x16x32_bf16 v[92:95],a[132:135],a[68:71],v[92:95]
ds_read_b128 a[132:135],v1 offset:18432
v_mov_b32 v53,v52
s_nop 1
v_permlane32_swap_b32 v53,v52
v_max_f32 v52,v52,v53
v_mov_b32 v53,v52
s_nop 1
v_permlane16_swap_b32 v53,v52
v_max_f32 v52,v52,v53
v_mul_f32_e64 v15,-s36,v52
v_fma_f32 v88,v88,s36,v15
v_exp_f32 v88,v88
v_fma_f32 v90,v90,s36,v15
v_fma_f32 v89,v89,s36,v15
v_exp_f32 v89,v89
v_fma_f32 v91,v91,s36,v15
v_exp_f32 v91,v91
v_exp_f32 v90,v90
v_cvt_pk_bf16_f32 v28,v88,v89
v_cvt_pk_bf16_f32 v29,v90,v91
s_waitcnt lgkmcnt(1)
v_mfma_f32_16x16x32_bf16 v[88:91],a[136:139],a[48:51],0
ds_read_b128 a[136:139],v0 offset:18560
v_fma_f32 v95,v95,s36,v15
v_mfma_f32_16x16x32_bf16 v[88:91],a[140:143],a[52:55],v[88:91]
ds_read_b128 a[140:143],v1 offset:18560
v_fma_f32 v92,v92,s36,v15
v_mfma_f32_16x16x32_bf16 v[88:91],a[144:147],a[56:59],v[88:91]
ds_read_b128 a[144:147],v0 offset:18688
v_exp_f32 v92,v92
v_mfma_f32_16x16x32_bf16 v[88:91],a[148:151],a[60:63],v[88:91]
ds_read_b128 a[148:151],v1 offset:18688
v_fma_f32 v94,v94,s36,v15
v_mfma_f32_16x16x32_bf16 v[88:91],a[120:123],a[64:67],v[88:91]
ds_read_b64_tr_b16 a[122:123],v2 offset:6144
v_exp_f32 v94,v94
v_mfma_f32_16x16x32_bf16 v[88:91],a[124:127],a[68:71],v[88:91]
ds_read_b64_tr_b16 a[120:121],v2 offset:0
v_exp_f32 v95,v95
v_fma_f32 v93,v93,s36,v15
v_exp_f32 v93,v93
v_cvt_pk_bf16_f32 v31,v94,v95
ds_read_b64_tr_b16 a[124:125],v3 offset:0
ds_read_b64_tr_b16 a[126:127],v3 offset:6144
v_cvt_pk_bf16_f32 v30,v92,v93
v_mfma_f32_16x16x32_bf16 v[92:95],a[128:131],a[48:51],0
s_waitcnt lgkmcnt(5)
ds_read_b64_tr_b16 a[130:131],v4 offset:6144
v_fma_f32 v89,v89,s36,v15
v_mfma_f32_16x16x32_bf16 v[92:95],a[132:135],a[52:55],v[92:95]
ds_read_b64_tr_b16 a[128:129],v4 offset:0
v_fma_f32 v91,v91,s36,v15
v_mfma_f32_16x16x32_bf16 v[92:95],a[136:139],a[56:59],v[92:95]
ds_read_b64_tr_b16 a[134:135],v5 offset:6144
v_exp_f32 v91,v91
v_mfma_f32_16x16x32_bf16 v[92:95],a[140:143],a[60:63],v[92:95]
ds_read_b64_tr_b16 a[136:137],v2 offset:128
v_fma_f32 v90,v90,s36,v15
v_mfma_f32_16x16x32_bf16 v[92:95],a[144:147],a[64:67],v[92:95]
s_waitcnt lgkmcnt(6)
ds_read_b64_tr_b16 a[142:143],v3 offset:6272
v_exp_f32 v90,v90
v_mfma_f32_16x16x32_bf16 v[92:95],a[148:151],a[68:71],v[92:95]
ds_read_b64_tr_b16 a[132:133],v5 offset:0
v_cvt_pk_bf16_f32 v53,v90,v91
v_mfma_f32_16x16x32_bf16 v[112:115],a[120:123],v[28:31],0
s_waitcnt lgkmcnt(5)
ds_read_b64_tr_b16 a[138:139],v2 offset:6272
v_fma_f32 v88,v88,s36,v15
v_mfma_f32_16x16x32_bf16 v[116:119],a[124:127],v[28:31],0
s_waitcnt lgkmcnt(5)
ds_read_b64_tr_b16 a[140:141],v3 offset:128
v_exp_f32 v88,v88
v_exp_f32 v89,v89
v_mfma_f32_16x16x32_bf16 v[120:123],a[128:131],v[28:31],0
ds_read_b64_tr_b16 a[144:145],v4 offset:128
ds_read_b64_tr_b16 a[150:151],v5 offset:6272
ds_read_b64_tr_b16 a[146:147],v4 offset:6272
ds_read_b64_tr_b16 a[122:123],v2 offset:6400
ds_read_b64_tr_b16 a[148:149],v5 offset:128
ds_read_b64_tr_b16 a[120:121],v2 offset:256
v_cvt_pk_bf16_f32 v52,v88,v89
v_fma_f32 v94,v94,s36,v15
v_fma_f32 v95,v95,s36,v15
ds_read_b64_tr_b16 a[124:125],v3 offset:256
ds_read_b64_tr_b16 a[126:127],v3 offset:6400
s_waitcnt lgkmcnt(10)
v_mfma_f32_16x16x32_bf16 v[124:127],a[132:135],v[28:31],0
s_waitcnt lgkmcnt(9)
ds_read_b64_tr_b16 a[132:133],v5 offset:256
ds_read_b64_tr_b16 a[128:129],v4 offset:256
ds_read_b64_tr_b16 a[130:131],v4 offset:6400
v_mfma_f32_16x16x32_bf16 v[128:131],a[136:139],v[28:31],0
s_waitcnt lgkmcnt(11)
ds_read_b64_tr_b16 a[134:135],v5 offset:6400
v_exp_f32 v94,v94
v_mfma_f32_16x16x32_bf16 v[132:135],a[140:143],v[28:31],0
s_waitcnt lgkmcnt(9)
ds_read_b128 a[136:139],v0 offset:24576
v_fma_f32 v93,v93,s36,v15
v_mfma_f32_16x16x32_bf16 v[136:139],a[144:147],v[28:31],0
s_waitcnt lgkmcnt(7)
ds_read_b128 a[140:143],v1 offset:24576
v_exp_f32 v93,v93
v_mfma_f32_16x16x32_bf16 v[140:143],a[148:151],v[28:31],0
ds_read_b128 a[144:147],v0 offset:24704
v_fma_f32 v92,v92,s36,v15
v_mfma_f32_16x16x32_bf16 v[144:147],a[120:123],v[28:31],0
s_waitcnt lgkmcnt(6)
ds_read_b128 a[120:123],v0 offset:24832
v_exp_f32 v92,v92
v_mfma_f32_16x16x32_bf16 v[148:151],a[124:127],v[28:31],0
s_waitcnt lgkmcnt(4)
ds_read_b128 a[148:151],v1 offset:24704
v_cvt_pk_bf16_f32 v54,v92,v93
v_exp_f32 v95,v95
v_mfma_f32_16x16x32_bf16 v[152:155],a[128:131],v[28:31],0
ds_read_b128 a[128:131],v0 offset:30720
v_cvt_pk_bf16_f32 v55,v94,v95
v_mfma_f32_16x16x32_bf16 v[156:159],a[132:135],v[28:31],0
s_waitcnt lgkmcnt(5)
ds_read_b128 a[124:127],v1 offset:24832
v_mfma_f32_16x16x32_bf16 v[88:91],a[136:139],a[48:51],0
s_waitcnt lgkmcnt(5)
ds_read_b128 a[132:135],v1 offset:30720
v_mfma_f32_16x16x32_bf16 v[88:91],a[140:143],a[52:55],v[88:91]
s_waitcnt lgkmcnt(5)
ds_read_b128 a[136:139],v0 offset:30848
v_mfma_f32_16x16x32_bf16 v[88:91],a[144:147],a[56:59],v[88:91]
s_waitcnt lgkmcnt(4)
ds_read_b128 a[144:147],v0 offset:30976
ds_read_b128 a[140:143],v1 offset:30848
v_mfma_f32_16x16x32_bf16 v[88:91],a[148:151],a[60:63],v[88:91]
ds_read_b128 a[148:151],v1 offset:30976
v_mfma_f32_16x16x32_bf16 v[88:91],a[120:123],a[64:67],v[88:91]
s_waitcnt lgkmcnt(5)
ds_read_b128 a[120:123],v0 offset:0
v_mfma_f32_16x16x32_bf16 v[88:91],a[124:127],a[68:71],v[88:91]
ds_read_b128 a[124:127],v1 offset:0
v_mfma_f32_16x16x32_bf16 v[92:95],a[128:131],a[48:51],0
s_waitcnt lgkmcnt(6)
ds_read_b128 a[128:131],v0 offset:128
v_mfma_f32_16x16x32_bf16 v[92:95],a[132:135],a[52:55],v[92:95]
s_waitcnt lgkmcnt(6)
ds_read_b128 a[132:135],v1 offset:128
v_mfma_f32_16x16x32_bf16 v[92:95],a[136:139],a[56:59],v[92:95]
s_waitcnt lgkmcnt(5)
ds_read_b128 a[136:139],v0 offset:256
v_mfma_f32_16x16x32_bf16 v[92:95],a[140:143],a[60:63],v[92:95]
ds_read_b128 a[140:143],v1 offset:256
v_mfma_f32_16x16x32_bf16 v[92:95],a[144:147],a[64:67],v[92:95]
s_waitcnt lgkmcnt(6)
ds_read_b128 a[144:147],v0 offset:6144
v_mfma_f32_16x16x32_bf16 v[92:95],a[148:151],a[68:71],v[92:95]
s_waitcnt vmcnt(3)
ds_read_b128 a[72:75],v11 offset:0
buffer_load_dwordx4 v6,s[8:11],s21 offen offset:0 lds
ds_read_b128 a[76:79],v12 offset:0
buffer_load_dwordx4 v7,s[8:11],s21 offen offset:1024 lds
ds_read_b128 a[80:83],v11 offset:128
buffer_load_dwordx4 v8,s[8:11],s21 offen offset:2048 lds
s_add_u32 s21,s21,12288
ds_read_b128 a[84:87],v12 offset:128
s_add_u32 m0,s22,0
ds_read_b128 a[88:91],v11 offset:256
ds_read_b128 a[92:95],v12 offset:256
ds_read_b128 a[148:151],v1 offset:6144
s_waitcnt lgkmcnt(6)
v_mfma_f32_16x16x32_bf16 v[96:99],a[120:123],a[72:75],0
s_waitcnt lgkmcnt(5)
ds_read_b128 a[120:123],v0 offset:6272
v_mfma_f32_16x16x32_bf16 v[96:99],a[124:127],a[76:79],v[96:99]
s_waitcnt lgkmcnt(5)
ds_read_b128 a[124:127],v1 offset:6272
v_mfma_f32_16x16x32_bf16 v[96:99],a[128:131],a[80:83],v[96:99]
s_waitcnt lgkmcnt(5)
ds_read_b128 a[128:131],v0 offset:6400
v_mfma_f32_16x16x32_bf16 v[96:99],a[132:135],a[84:87],v[96:99]
ds_read_b128 a[132:135],v1 offset:6400
s_waitcnt vmcnt(3)
s_waitcnt lgkmcnt(6)
v_mfma_f32_16x16x32_bf16 v[96:99],a[136:139],a[88:91],v[96:99]
s_waitcnt lgkmcnt(5)
v_mfma_f32_16x16x32_bf16 v[96:99],a[140:143],a[92:95],v[96:99]
v_mfma_f32_16x16x32_bf16 v[100:103],a[144:147],a[72:75],0
s_waitcnt lgkmcnt(4)
v_mfma_f32_16x16x32_bf16 v[100:103],a[148:151],a[76:79],v[100:103]
s_waitcnt lgkmcnt(3)
v_mfma_f32_16x16x32_bf16 v[100:103],a[120:123],a[80:83],v[100:103]
s_waitcnt lgkmcnt(2)
v_mfma_f32_16x16x32_bf16 v[100:103],a[124:127],a[84:87],v[100:103]
s_waitcnt lgkmcnt(1)
v_mfma_f32_16x16x32_bf16 v[100:103],a[128:131],a[88:91],v[100:103]
s_waitcnt lgkmcnt(0)
v_mfma_f32_16x16x32_bf16 v[100:103],a[132:135],a[92:95],v[100:103]
s_barrier
buffer_load_dwordx4 v6,s[4:7],s20 offen offset:0 lds
buffer_load_dwordx4 v7,s[4:7],s20 offen offset:1024 lds
buffer_load_dwordx4 v8,s[4:7],s20 offen offset:2048 lds
ds_read_b128 a[136:139],v0 offset:12288
v_max3_f32 v56,v96,v97,v98
v_max_f32 v56,v56,v99
v_mov_b32 v57,v56
s_add_u32 s20,s20,12288
s_mov_b32 s27,166723584
ds_read_b128 a[144:147],v0 offset:12416
v_permlane32_swap_b32 v57,v56
ds_read_b128 a[140:143],v1 offset:12288
v_max_f32 v56,v56,v57
ds_read_b128 a[148:151],v1 offset:12416
v_mov_b32 v57,v56
ds_read_b128 a[124:127],v1 offset:12544
s_mov_b32 s42,s41
ds_read_b128 a[120:123],v0 offset:12544
v_permlane16_swap_b32 v57,v56
ds_read_b128 a[128:131],v0 offset:18432
v_max_f32 v56,v56,v57
ds_read_b128 a[132:135],v1 offset:18432
v_mul_f32_e64 v16,-s36,v56
v_fma_f32 v96,v96,s36,v16
v_exp_f32 v96,v96
v_fma_f32 v97,v97,s36,v16
v_exp_f32 v97,v97
v_fma_f32 v99,v99,s36,v16
v_exp_f32 v99,v99
v_fma_f32 v98,v98,s36,v16
v_exp_f32 v98,v98
v_cvt_pk_bf16_f32 v32,v96,v97
v_cvt_pk_bf16_f32 v33,v98,v99
s_waitcnt lgkmcnt(4)
v_mfma_f32_16x16x32_bf16 v[96:99],a[136:139],a[72:75],0
s_add_u32 s69,s69,1
ds_read_b128 a[136:139],v0 offset:18560
v_fma_f32 v103,v103,s36,v16
v_mfma_f32_16x16x32_bf16 v[96:99],a[140:143],a[76:79],v[96:99]
s_lshl_b32 s62,s69,5
ds_read_b128 a[140:143],v1 offset:18560
v_fma_f32 v101,v101,s36,v16
v_mfma_f32_16x16x32_bf16 v[96:99],a[144:147],a[80:83],v[96:99]
s_add_u32 s62,s62,s34
ds_read_b128 a[144:147],v0 offset:18688
v_fma_f32 v102,v102,s36,v16
v_mfma_f32_16x16x32_bf16 v[96:99],a[148:151],a[84:87],v[96:99]
s_mul_i32 s63,s62,171
ds_read_b128 a[148:151],v1 offset:18688
v_exp_f32 v103,v103
s_waitcnt lgkmcnt(4)
v_mfma_f32_16x16x32_bf16 v[96:99],a[120:123],a[88:91],v[96:99]
s_lshr_b32 s63,s63,9
ds_read_b64_tr_b16 a[122:123],v2 offset:6144
v_exp_f32 v101,v101
v_mfma_f32_16x16x32_bf16 v[96:99],a[124:127],a[92:95],v[96:99]
s_mul_i32 s64,s63,3
ds_read_b64_tr_b16 a[120:121],v2 offset:0
v_exp_f32 v102,v102
v_fma_f32 v100,v100,s36,v16
v_exp_f32 v100,v100
v_cvt_pk_bf16_f32 v35,v102,v103
ds_read_b64_tr_b16 a[124:125],v3 offset:0
ds_read_b64_tr_b16 a[126:127],v3 offset:6144
v_cvt_pk_bf16_f32 v34,v100,v101
v_mfma_f32_16x16x32_bf16 v[100:103],a[128:131],a[72:75],0
s_sub_u32 s62,s62,s64
ds_read_b64_tr_b16 a[130:131],v4 offset:6144
v_fma_f32 v98,v98,s36,v16
v_smfmac_f32_16x16x64_bf16 v[64:67],a[152:155],v[28:35],v18
s_add_u32 s63,s63,s33
s_mul_i32 s30,s63,196608
ds_read_b64_tr_b16 a[128:129],v4 offset:0
v_mfma_f32_16x16x32_bf16 v[100:103],a[132:135],a[76:79],v[100:103]
s_mul_i32 s41,s63,325632
ds_read_b64_tr_b16 a[134:135],v5 offset:6144
v_exp_f32 v98,v98
s_waitcnt lgkmcnt(6)
v_mfma_f32_16x16x32_bf16 v[100:103],a[136:139],a[80:83],v[100:103]
s_lshl_b32 s63,s3,2
ds_read_b64_tr_b16 a[132:133],v5 offset:0
v_fma_f32 v97,v97,s36,v16
v_mfma_f32_16x16x32_bf16 v[100:103],a[140:143],a[84:87],v[100:103]
s_add_u32 s64,s63,21
ds_read_b64_tr_b16 a[136:137],v2 offset:128
v_exp_f32 v97,v97
v_mfma_f32_16x16x32_bf16 v[100:103],a[144:147],a[88:91],v[100:103]
s_cmp_eq_u32 s3,0
ds_read_b64_tr_b16 a[144:145],v4 offset:128
v_fma_f32 v96,v96,s36,v16
v_mfma_f32_16x16x32_bf16 v[100:103],a[148:151],a[92:95],v[100:103]
s_cselect_b32 s64,20,s64
ds_read_b64_tr_b16 a[138:139],v2 offset:6272
v_fma_f32 v99,v99,s36,v16
s_waitcnt lgkmcnt(7)
v_mfma_f32_16x16x32_bf16 a[160:163],a[120:123],v[32:35],0
s_cselect_b32 s40,1,0
ds_read_b64_tr_b16 a[120:121],v2 offset:256
v_exp_f32 v99,v99
v_mfma_f32_16x16x32_bf16 a[164:167],a[124:127],v[32:35],0
s_add_u32 s65,s63,37
ds_read_b64_tr_b16 a[126:127],v3 offset:6400
v_cvt_pk_bf16_f32 v57,v98,v99
s_waitcnt lgkmcnt(6)
v_mfma_f32_16x16x32_bf16 a[168:171],a[128:131],v[32:35],0
s_cmp_eq_u32 s62,2
ds_read_b64_tr_b16 a[130:131],v4 offset:6400
ds_read_b64_tr_b16 a[140:141],v3 offset:128
ds_read_b64_tr_b16 a[142:143],v3 offset:6272
ds_read_b64_tr_b16 a[146:147],v4 offset:6272
s_waitcnt lgkmcnt(9)
v_mfma_f32_16x16x32_bf16 a[172:175],a[132:135],v[32:35],0
s_cselect_b32 s64,s65,s64
ds_read_b64_tr_b16 a[132:133],v5 offset:256
ds_read_b64_tr_b16 a[128:129],v4 offset:256
ds_read_b64_tr_b16 a[148:149],v5 offset:128
ds_read_b64_tr_b16 a[122:123],v2 offset:6400
ds_read_b64_tr_b16 a[150:151],v5 offset:6272
ds_read_b64_tr_b16 a[124:125],v3 offset:256
s_waitcnt lgkmcnt(12)
v_mfma_f32_16x16x32_bf16 a[176:179],a[136:139],v[32:35],0
s_cselect_b32 s40,0,s40
ds_read_b64_tr_b16 a[134:135],v5 offset:6400
s_waitcnt vmcnt(6)
v_exp_f32 v96,v96
v_fma_f32 v102,v102,s36,v16
v_cvt_pk_bf16_f32 v56,v96,v97
v_fma_f32 v103,v103,s36,v16
v_exp_f32 v103,v103
v_fma_f32 v100,v100,s36,v16
v_exp_f32 v102,v102
s_waitcnt lgkmcnt(8)
v_mfma_f32_16x16x32_bf16 a[180:183],a[140:143],v[32:35],0
s_add_u32 s65,s63,s3
v_cvt_pk_bf16_f32 v59,v102,v103
v_fma_f32 v101,v101,s36,v16
s_waitcnt lgkmcnt(7)
v_mfma_f32_16x16x32_bf16 a[184:187],a[144:147],v[32:35],0
s_cmp_eq_u32 s62,0
v_exp_f32 v101,v101
v_exp_f32 v100,v100
s_cselect_b32 s64,s65,s64
v_cvt_pk_bf16_f32 v58,v100,v101
s_cselect_b32 s40,1,s40
s_waitcnt lgkmcnt(1)
v_mfma_f32_16x16x32_bf16 a[188:191],a[148:151],v[32:35],0
s_mul_i32 s64,s64,6144
s_add_u32 s41,s41,s64
s_cmp_ge_u32 s69,6
v_smfmac_f32_16x16x64_bf16 v[64:67],a[152:155],v[52:59],v18
s_waitcnt lgkmcnt(0)
s_barrier
v_mfma_f32_16x16x32_bf16 a[192:195],a[120:123],v[32:35],0
s_cselect_b32 s41,166723584,s41
ds_read_b128 a[140:143],v1 offset:24576
s_cselect_b32 s30,100663296,s30
v_mfma_f32_16x16x32_bf16 a[196:199],a[124:127],v[32:35],0
s_add_u32 s25,s30,s22
ds_read_b128 a[144:147],v0 offset:24704
s_add_u32 s26,s25,12288
v_mfma_f32_16x16x32_bf16 a[200:203],a[128:131],v[32:35],0
s_mov_b32 s28,s41
ds_read_b128 a[136:139],v0 offset:24576
s_mov_b32 s29,s24
v_mfma_f32_16x16x32_bf16 a[204:207],a[132:135],v[32:35],0
s_add_u32 m0,s23,0
ds_read_b128 a[148:151],v1 offset:24704
buffer_load_dwordx4 v6,s[8:11],s21 offen offset:0 lds
buffer_load_dwordx4 v7,s[8:11],s21 offen offset:1024 lds
buffer_load_dwordx4 v8,s[8:11],s21 offen offset:2048 lds
ds_read_b128 a[124:127],v1 offset:24832
s_add_u32 s21,s21,12288
ds_read_b128 a[120:123],v0 offset:24832
s_add_u32 m0,s22,12288
ds_read_b128 a[128:131],v0 offset:30720
buffer_load_dwordx4 v6,s[4:7],s20 offen offset:0 lds
buffer_load_dwordx4 v7,s[4:7],s20 offen offset:1024 lds
buffer_load_dwordx4 v8,s[4:7],s20 offen offset:2048 lds
s_waitcnt lgkmcnt(4)
v_mfma_f32_16x16x32_bf16 v[96:99],a[136:139],a[72:75],0
s_add_u32 s20,s20,12288
ds_read_b128 a[132:135],v1 offset:30720
v_mfma_f32_16x16x32_bf16 v[96:99],a[140:143],a[76:79],v[96:99]
ds_read_b128 a[136:139],v0 offset:30848
v_mfma_f32_16x16x32_bf16 v[96:99],a[144:147],a[80:83],v[96:99]
s_waitcnt lgkmcnt(5)
ds_read_b128 a[140:143],v1 offset:30848
v_mfma_f32_16x16x32_bf16 v[96:99],a[148:151],a[84:87],v[96:99]
s_waitcnt lgkmcnt(4)
ds_read_b128 a[144:147],v0 offset:30976
v_mfma_f32_16x16x32_bf16 v[96:99],a[120:123],a[88:91],v[96:99]
ds_read_b64_tr_b16 a[122:123],v2 offset:18432
v_mfma_f32_16x16x32_bf16 v[96:99],a[124:127],a[92:95],v[96:99]
s_waitcnt lgkmcnt(5)
ds_read_b64_tr_b16 a[120:121],v2 offset:12288
v_mfma_f32_16x16x32_bf16 v[100:103],a[128:131],a[72:75],0
s_waitcnt lgkmcnt(5)
ds_read_b64_tr_b16 a[124:125],v3 offset:12288
ds_read_b128 a[148:151],v1 offset:30976
v_mfma_f32_16x16x32_bf16 v[100:103],a[132:135],a[76:79],v[100:103]
s_waitcnt lgkmcnt(6)
ds_read_b64_tr_b16 a[126:127],v3 offset:18432
v_mfma_f32_16x16x32_bf16 v[100:103],a[136:139],a[80:83],v[100:103]
s_waitcnt lgkmcnt(6)
ds_read_b64_tr_b16 a[130:131],v4 offset:18432
v_mfma_f32_16x16x32_bf16 v[100:103],a[140:143],a[84:87],v[100:103]
s_waitcnt lgkmcnt(6)
ds_read_b64_tr_b16 a[128:129],v4 offset:12288
v_mfma_f32_16x16x32_bf16 v[100:103],a[144:147],a[88:91],v[100:103]
s_waitcnt lgkmcnt(3)
ds_read_b64_tr_b16 a[132:133],v5 offset:12288
ds_read_b64_tr_b16 a[134:135],v5 offset:18432
v_mfma_f32_16x16x32_bf16 v[100:103],a[148:151],a[92:95],v[100:103]
v_mfma_f32_16x16x32_bf16 v[160:163],a[120:123],v[44:47],v[160:163]
s_add_u32 m0,s23,12288
ds_read_b64_tr_b16 a[136:137],v2 offset:12416
v_fma_f32 v82,v82,s36,v14
s_waitcnt lgkmcnt(5)
v_mfma_f32_16x16x32_bf16 v[164:167],a[124:127],v[44:47],v[164:167]
ds_read_b64_tr_b16 a[138:139],v2 offset:18560
v_fma_f32 v83,v83,s36,v14
v_mfma_f32_16x16x32_bf16 v[212:215],a[124:127],v[48:51],v[212:215]
ds_read_b64_tr_b16 a[140:141],v3 offset:12416
v_fma_f32 v88,v88,s36,v15
v_mfma_f32_16x16x32_bf16 v[208:211],a[120:123],v[48:51],v[208:211]
ds_read_b64_tr_b16 a[142:143],v3 offset:18560
v_fma_f32 v89,v89,s36,v15
v_mfma_f32_16x16x32_bf16 v[112:115],a[120:123],v[52:55],v[112:115]
ds_read_b64_tr_b16 a[144:145],v4 offset:12416
v_fma_f32 v90,v90,s36,v15
v_mfma_f32_16x16x32_bf16 v[116:119],a[124:127],v[52:55],v[116:119]
ds_read_b64_tr_b16 a[146:147],v4 offset:18560
v_fma_f32 v91,v91,s36,v15
v_mfma_f32_16x16x32_bf16 a[164:167],a[124:127],v[56:59],a[164:167]
ds_read_b64_tr_b16 a[148:149],v5 offset:12416
v_fma_f32 v96,v96,s36,v16
v_mfma_f32_16x16x32_bf16 a[160:163],a[120:123],v[56:59],a[160:163]
s_waitcnt lgkmcnt(6)
ds_read_b64_tr_b16 a[150:151],v5 offset:18560
v_fma_f32 v97,v97,s36,v16
v_mfma_f32_16x16x32_bf16 a[168:171],a[128:131],v[56:59],a[168:171]
ds_read_b64_tr_b16 a[120:121],v2 offset:12544
v_fma_f32 v98,v98,s36,v16
v_mfma_f32_16x16x32_bf16 a[172:175],a[132:135],v[56:59],a[172:175]
ds_read_b64_tr_b16 a[122:123],v2 offset:18688
v_fma_f32 v99,v99,s36,v16
v_mfma_f32_16x16x32_bf16 v[124:127],a[132:135],v[52:55],v[124:127]
ds_read_b64_tr_b16 a[124:125],v3 offset:12544
v_fma_f32 v76,v76,s36,v13
v_mfma_f32_16x16x32_bf16 v[120:123],a[128:131],v[52:55],v[120:123]
ds_read_b64_tr_b16 a[126:127],v3 offset:18688
v_fma_f32 v77,v77,s36,v13
v_mfma_f32_16x16x32_bf16 v[216:219],a[128:131],v[48:51],v[216:219]
v_exp_f32 v82,v82
v_mfma_f32_16x16x32_bf16 v[220:223],a[132:135],v[48:51],v[220:223]
v_exp_f32 v83,v83
v_mfma_f32_16x16x32_bf16 v[172:175],a[132:135],v[44:47],v[172:175]
ds_read_b64_tr_b16 a[132:133],v5 offset:12544
v_cvt_pk_bf16_f32 v25,v82,v83
v_mfma_f32_16x16x32_bf16 v[168:171],a[128:131],v[44:47],v[168:171]
s_waitcnt lgkmcnt(4)
ds_read_b64_tr_b16 a[128:129],v4 offset:12544
v_fma_f32 v78,v78,s36,v13
v_mfma_f32_16x16x32_bf16 v[176:179],a[136:139],v[44:47],v[176:179]
ds_read_b64_tr_b16 a[130:131],v4 offset:18688
v_fma_f32 v79,v79,s36,v13
v_mfma_f32_16x16x32_bf16 v[180:183],a[140:143],v[44:47],v[180:183]
ds_read_b64_tr_b16 a[134:135],v5 offset:18688
v_fma_f32 v84,v84,s36,v14
v_mfma_f32_16x16x32_bf16 v[228:231],a[140:143],v[48:51],v[228:231]
v_exp_f32 v88,v88
v_mfma_f32_16x16x32_bf16 v[224:227],a[136:139],v[48:51],v[224:227]
v_exp_f32 v89,v89
v_mfma_f32_16x16x32_bf16 v[128:131],a[136:139],v[52:55],v[128:131]
v_exp_f32 v90,v90
v_mfma_f32_16x16x32_bf16 v[132:135],a[140:143],v[52:55],v[132:135]
v_exp_f32 v91,v91
v_mfma_f32_16x16x32_bf16 a[180:183],a[140:143],v[56:59],a[180:183]
v_cvt_pk_bf16_f32 v28,v88,v89
v_cvt_pk_bf16_f32 v29,v90,v91
v_mfma_f32_16x16x32_bf16 a[176:179],a[136:139],v[56:59],a[176:179]
v_exp_f32 v96,v96
v_mfma_f32_16x16x32_bf16 a[184:187],a[144:147],v[56:59],a[184:187]
v_exp_f32 v97,v97
v_mfma_f32_16x16x32_bf16 a[188:191],a[148:151],v[56:59],a[188:191]
v_exp_f32 v98,v98
v_mfma_f32_16x16x32_bf16 v[140:143],a[148:151],v[52:55],v[140:143]
v_exp_f32 v99,v99
v_mfma_f32_16x16x32_bf16 v[136:139],a[144:147],v[52:55],v[136:139]
v_cvt_pk_bf16_f32 v32,v96,v97
v_cvt_pk_bf16_f32 v33,v98,v99
v_mfma_f32_16x16x32_bf16 v[232:235],a[144:147],v[48:51],v[232:235]
v_exp_f32 v76,v76
v_mfma_f32_16x16x32_bf16 v[236:239],a[148:151],v[48:51],v[236:239]
v_exp_f32 v77,v77
v_mfma_f32_16x16x32_bf16 v[188:191],a[148:151],v[44:47],v[188:191]
v_exp_f32 v78,v78
v_mfma_f32_16x16x32_bf16 v[184:187],a[144:147],v[44:47],v[184:187]
s_waitcnt lgkmcnt(0)
v_exp_f32 v79,v79
v_mfma_f32_16x16x32_bf16 v[192:195],a[120:123],v[44:47],v[192:195]
s_waitcnt vmcnt(6)
v_cvt_pk_bf16_f32 v22,v76,v77
v_cvt_pk_bf16_f32 v23,v78,v79
v_mfma_f32_16x16x32_bf16 v[196:199],a[124:127],v[44:47],v[196:199]
s_barrier
v_mfma_f32_16x16x32_bf16 v[244:247],a[124:127],v[48:51],v[244:247]
ds_read_b128 a[148:151],v1 offset:128
v_fma_f32 v85,v85,s36,v14
v_mfma_f32_16x16x32_bf16 v[240:243],a[120:123],v[48:51],v[240:243]
ds_read_b128 a[144:147],v0 offset:128
v_fma_f32 v86,v86,s36,v14
v_mfma_f32_16x16x32_bf16 v[144:147],a[120:123],v[52:55],v[144:147]
ds_read_b128 a[140:143],v1 offset:0
v_fma_f32 v87,v87,s36,v14
v_mfma_f32_16x16x32_bf16 v[148:151],a[124:127],v[52:55],v[148:151]
ds_read_b128 a[136:139],v0 offset:0
v_fma_f32 v92,v92,s36,v15
v_mfma_f32_16x16x32_bf16 a[196:199],a[124:127],v[56:59],a[196:199]
ds_read_b128 a[124:127],v1 offset:256
v_fma_f32 v93,v93,s36,v15
v_mfma_f32_16x16x32_bf16 a[192:195],a[120:123],v[56:59],a[192:195]
buffer_load_dwordx4 v6,s[8:11],s21 offen offset:0 lds
v_mfma_f32_16x16x32_bf16 a[200:203],a[128:131],v[56:59],a[200:203]
ds_read_b128 a[120:123],v0 offset:256
v_fma_f32 v94,v94,s36,v15
v_mfma_f32_16x16x32_bf16 a[204:207],a[132:135],v[56:59],a[204:207]
v_exp_f32 v84,v84
v_mfma_f32_16x16x32_bf16 v[156:159],a[132:135],v[52:55],v[156:159]
v_exp_f32 v85,v85
v_mfma_f32_16x16x32_bf16 v[152:155],a[128:131],v[52:55],v[152:155]
v_exp_f32 v86,v86
v_mfma_f32_16x16x32_bf16 v[248:251],a[128:131],v[48:51],v[248:251]
v_exp_f32 v87,v87
v_mfma_f32_16x16x32_bf16 v[252:255],a[132:135],v[48:51],v[252:255]
v_cvt_pk_bf16_f32 v26,v84,v85
v_cvt_pk_bf16_f32 v27,v86,v87
v_mfma_f32_16x16x32_bf16 v[204:207],a[132:135],v[44:47],v[204:207]
ds_read_b128 a[132:135],v1 offset:6144
v_fma_f32 v95,v95,s36,v15
v_smfmac_f32_16x16x64_bf16 v[60:63],a[152:155],v[20:27],v18
v_fma_f32 v100,v100,s36,v16
v_mfma_f32_16x16x32_bf16 v[200:203],a[128:131],v[44:47],v[200:203]
buffer_load_dwordx4 v7,s[8:11],s21 offen offset:1024 lds
s_waitcnt lgkmcnt(1)
v_mfma_f32_16x16x32_bf16 v[72:75],a[124:127],a[20:23],0
ds_read_b128 a[128:131],v0 offset:6144
v_fma_f32 v101,v101,s36,v16
v_mfma_f32_16x16x32_bf16 v[72:75],a[120:123],a[16:19],v[72:75]
v_exp_f32 v92,v92
v_mfma_f32_16x16x32_bf16 v[72:75],a[148:151],a[12:15],v[72:75]
v_exp_f32 v93,v93
v_mfma_f32_16x16x32_bf16 v[72:75],a[144:147],a[8:11],v[72:75]
v_exp_f32 v94,v94
v_mfma_f32_16x16x32_bf16 v[72:75],a[140:143],a[4:7],v[72:75]
v_exp_f32 v95,v95
v_mfma_f32_16x16x32_bf16 v[72:75],a[136:139],a[0:3],v[72:75]
v_cvt_pk_bf16_f32 v30,v92,v93
v_cvt_pk_bf16_f32 v31,v94,v95
v_mfma_f32_16x16x32_bf16 v[80:83],a[136:139],a[24:27],0
v_fma_f32 v102,v102,s36,v16
v_fma_f32 v103,v103,s36,v16
v_mfma_f32_16x16x32_bf16 v[80:83],a[140:143],a[28:31],v[80:83]
v_exp_f32 v100,v100
v_mfma_f32_16x16x32_bf16 v[80:83],a[144:147],a[32:35],v[80:83]
buffer_load_dwordx4 v8,s[8:11],s21 offen offset:2048 lds
v_mfma_f32_16x16x32_bf16 v[80:83],a[148:151],a[36:39],v[80:83]
s_add_u32 s21,s21,12288
v_exp_f32 v101,v101
v_mfma_f32_16x16x32_bf16 v[80:83],a[120:123],a[40:43],v[80:83]
s_add_u32 m0,s22,24576
v_exp_f32 v102,v102
v_mfma_f32_16x16x32_bf16 v[80:83],a[124:127],a[44:47],v[80:83]
v_exp_f32 v103,v103
v_mfma_f32_16x16x32_bf16 v[88:91],a[124:127],a[68:71],0
v_cvt_pk_bf16_f32 v34,v100,v101
v_cvt_pk_bf16_f32 v35,v102,v103
v_mfma_f32_16x16x32_bf16 v[88:91],a[120:123],a[64:67],v[88:91]
v_fma_f32 v72,v72,s36,v13
v_fma_f32 v73,v73,s36,v13
v_smfmac_f32_16x16x64_bf16 v[64:67],a[152:155],v[28:35],v18
v_fma_f32 v74,v74,s36,v13
v_mfma_f32_16x16x32_bf16 v[88:91],a[148:151],a[60:63],v[88:91]
v_fma_f32 v75,v75,s36,v13
v_fma_f32 v80,v80,s36,v14
v_mfma_f32_16x16x32_bf16 v[88:91],a[144:147],a[56:59],v[88:91]
v_fma_f32 v81,v81,s36,v14
v_mfma_f32_16x16x32_bf16 v[88:91],a[140:143],a[52:55],v[88:91]
buffer_load_dwordx4 v6,s[4:7],s20 offen offset:0 lds
v_mfma_f32_16x16x32_bf16 v[88:91],a[136:139],a[48:51],v[88:91]
v_exp_f32 v72,v72
v_mfma_f32_16x16x32_bf16 v[96:99],a[136:139],a[72:75],0
ds_read_b128 a[136:139],v0 offset:6272
v_mfma_f32_16x16x32_bf16 v[96:99],a[140:143],a[76:79],v[96:99]
ds_read_b128 a[140:143],v1 offset:6272
v_mfma_f32_16x16x32_bf16 v[96:99],a[144:147],a[80:83],v[96:99]
ds_read_b128 a[144:147],v0 offset:6400
v_mfma_f32_16x16x32_bf16 v[96:99],a[148:151],a[84:87],v[96:99]
ds_read_b128 a[148:151],v1 offset:6400
v_mfma_f32_16x16x32_bf16 v[96:99],a[120:123],a[88:91],v[96:99]
v_exp_f32 v73,v73
v_mfma_f32_16x16x32_bf16 v[96:99],a[124:127],a[92:95],v[96:99]
s_waitcnt lgkmcnt(4)
v_exp_f32 v74,v74
v_mfma_f32_16x16x32_bf16 v[76:79],a[128:131],a[0:3],0
v_exp_f32 v75,v75
v_mfma_f32_16x16x32_bf16 v[76:79],a[132:135],a[4:7],v[76:79]
buffer_load_dwordx4 v7,s[4:7],s20 offen offset:1024 lds
s_waitcnt lgkmcnt(3)
v_mfma_f32_16x16x32_bf16 v[76:79],a[136:139],a[8:11],v[76:79]
s_waitcnt lgkmcnt(2)
v_exp_f32 v80,v80
v_mfma_f32_16x16x32_bf16 v[76:79],a[140:143],a[12:15],v[76:79]
s_waitcnt lgkmcnt(0)
v_exp_f32 v81,v81
v_mfma_f32_16x16x32_bf16 v[76:79],a[144:147],a[16:19],v[76:79]
v_cvt_pk_bf16_f32 v44,v72,v73
v_cvt_pk_bf16_f32 v45,v74,v75
v_mfma_f32_16x16x32_bf16 v[76:79],a[148:151],a[20:23],v[76:79]
v_cvt_pk_bf16_f32 v48,v80,v81
v_mfma_f32_16x16x32_bf16 v[84:87],a[148:151],a[44:47],0
v_mfma_f32_16x16x32_bf16 v[84:87],a[144:147],a[40:43],v[84:87]
v_mfma_f32_16x16x32_bf16 v[84:87],a[140:143],a[36:39],v[84:87]
v_mfma_f32_16x16x32_bf16 v[84:87],a[136:139],a[32:35],v[84:87]
v_mfma_f32_16x16x32_bf16 v[84:87],a[132:135],a[28:31],v[84:87]
buffer_load_dwordx4 v8,s[4:7],s20 offen offset:2048 lds
v_mfma_f32_16x16x32_bf16 v[84:87],a[128:131],a[24:27],v[84:87]
s_add_u32 s20,s20,12288
v_mfma_f32_16x16x32_bf16 v[92:95],a[128:131],a[48:51],0
ds_read_b64_tr_b16 a[120:121],v2 offset:24576
v_mfma_f32_16x16x32_bf16 v[92:95],a[132:135],a[52:55],v[92:95]
ds_read_b64_tr_b16 a[122:123],v2 offset:30720
v_mfma_f32_16x16x32_bf16 v[92:95],a[136:139],a[56:59],v[92:95]
ds_read_b64_tr_b16 a[124:125],v3 offset:24576
v_mfma_f32_16x16x32_bf16 v[92:95],a[140:143],a[60:63],v[92:95]
ds_read_b64_tr_b16 a[126:127],v3 offset:30720
v_mfma_f32_16x16x32_bf16 v[92:95],a[144:147],a[64:67],v[92:95]
v_mfma_f32_16x16x32_bf16 v[92:95],a[148:151],a[68:71],v[92:95]
v_mfma_f32_16x16x32_bf16 v[100:103],a[148:151],a[92:95],0
v_mfma_f32_16x16x32_bf16 v[100:103],a[144:147],a[88:91],v[100:103]
v_mfma_f32_16x16x32_bf16 v[100:103],a[140:143],a[84:87],v[100:103]
v_mfma_f32_16x16x32_bf16 v[100:103],a[136:139],a[80:83],v[100:103]
v_mfma_f32_16x16x32_bf16 v[100:103],a[132:135],a[76:79],v[100:103]
ds_read_b64_tr_b16 a[132:133],v5 offset:24576
v_mfma_f32_16x16x32_bf16 v[100:103],a[128:131],a[72:75],v[100:103]
ds_read_b64_tr_b16 a[128:129],v4 offset:24576
ds_read_b64_tr_b16 a[130:131],v4 offset:30720
ds_read_b64_tr_b16 a[134:135],v5 offset:30720
s_mov_b32 s38,0
s_branch L_loop4
L_loop5:
.p2align 6
L_loop5w0:
s_waitcnt lgkmcnt(3)
v_mfma_f32_16x16x32_bf16 v[160:163],a[120:123],v[20:23],v[160:163]
ds_read_b128 a[156:159],v10 offset:0
v_fma_f32 v90,v90,s36,v15
v_mfma_f32_16x16x32_bf16 v[164:167],a[124:127],v[20:23],v[164:167]
ds_read_b64_tr_b16 a[136:137],v2 offset:24704
v_fma_f32 v91,v91,s36,v15
v_mfma_f32_16x16x32_bf16 v[212:215],a[124:127],v[24:27],v[212:215]
ds_read_b64_tr_b16 a[138:139],v2 offset:30848
v_fma_f32 v96,v96,s36,v16
v_mfma_f32_16x16x32_bf16 v[208:211],a[120:123],v[24:27],v[208:211]
ds_read_b64_tr_b16 a[140:141],v3 offset:24704
v_fma_f32 v97,v97,s36,v16
v_mfma_f32_16x16x32_bf16 v[112:115],a[120:123],v[28:31],v[112:115]
ds_read_b64_tr_b16 a[142:143],v3 offset:30848
v_fma_f32 v98,v98,s36,v16
v_mfma_f32_16x16x32_bf16 v[116:119],a[124:127],v[28:31],v[116:119]
ds_read_b64_tr_b16 a[144:145],v4 offset:24704
v_fma_f32 v99,v99,s36,v16
v_mfma_f32_16x16x32_bf16 a[164:167],a[124:127],v[32:35],a[164:167]
ds_read_b64_tr_b16 a[146:147],v4 offset:30848
v_fma_f32 v104,v104,s36,v17
v_mfma_f32_16x16x32_bf16 a[160:163],a[120:123],v[32:35],a[160:163]
ds_read_b64_tr_b16 a[148:149],v5 offset:24704
v_fma_f32 v105,v105,s36,v17
v_mfma_f32_16x16x32_bf16 a[208:211],a[120:123],v[36:39],a[208:211]
ds_read_b64_tr_b16 a[150:151],v5 offset:30848
v_fma_f32 v106,v106,s36,v17
v_mfma_f32_16x16x32_bf16 a[212:215],a[124:127],v[36:39],a[212:215]
s_waitcnt lgkmcnt(6)
ds_read_b64_tr_b16 a[120:121],v2 offset:24832
v_fma_f32 v107,v107,s36,v17
v_mfma_f32_16x16x32_bf16 a[216:219],a[128:131],v[36:39],a[216:219]
ds_read_b64_tr_b16 a[122:123],v2 offset:30976
v_fma_f32 v76,v76,s36,v13
v_mfma_f32_16x16x32_bf16 a[220:223],a[132:135],v[36:39],a[220:223]
ds_read_b64_tr_b16 a[124:125],v3 offset:24832
v_fma_f32 v77,v77,s36,v13
v_mfma_f32_16x16x32_bf16 a[172:175],a[132:135],v[32:35],a[172:175]
ds_read_b64_tr_b16 a[126:127],v3 offset:30976
v_fma_f32 v78,v78,s36,v13
v_mfma_f32_16x16x32_bf16 a[168:171],a[128:131],v[32:35],a[168:171]
v_exp_f32 v90,v90
v_mfma_f32_16x16x32_bf16 v[120:123],a[128:131],v[28:31],v[120:123]
v_exp_f32 v91,v91
v_mfma_f32_16x16x32_bf16 v[124:127],a[132:135],v[28:31],v[124:127]
v_cvt_pk_bf16_f32 v53,v90,v91
v_fma_f32 v79,v79,s36,v13
v_mfma_f32_16x16x32_bf16 v[220:223],a[132:135],v[24:27],v[220:223]
v_exp_f32 v96,v96
v_mfma_f32_16x16x32_bf16 v[216:219],a[128:131],v[24:27],v[216:219]
buffer_store_dwordx4 a[156:159],v9,s[16:19],s27 offen offset:0 nt
v_exp_f32 v97,v97
v_fma_f32 v84,v84,s36,v14
v_mfma_f32_16x16x32_bf16 v[168:171],a[128:131],v[20:23],v[168:171]
ds_read_b128 a[156:159],v10 offset:1024
v_cvt_pk_bf16_f32 v56,v96,v97
v_mfma_f32_16x16x32_bf16 v[172:175],a[132:135],v[20:23],v[172:175]
ds_read_b64_tr_b16 a[128:129],v4 offset:24832
v_fma_f32 v85,v85,s36,v14
v_mfma_f32_16x16x32_bf16 v[176:179],a[136:139],v[20:23],v[176:179]
s_waitcnt lgkmcnt(2)
ds_read_b64_tr_b16 a[130:131],v4 offset:30976
v_fma_f32 v86,v86,s36,v14
v_mfma_f32_16x16x32_bf16 v[180:183],a[140:143],v[20:23],v[180:183]
ds_read_b64_tr_b16 a[132:133],v5 offset:24832
v_fma_f32 v87,v87,s36,v14
v_mfma_f32_16x16x32_bf16 v[228:231],a[140:143],v[24:27],v[228:231]
ds_read_b64_tr_b16 a[134:135],v5 offset:30976
v_fma_f32 v92,v92,s36,v15
v_mfma_f32_16x16x32_bf16 v[224:227],a[136:139],v[24:27],v[224:227]
v_exp_f32 v98,v98
v_mfma_f32_16x16x32_bf16 v[128:131],a[136:139],v[28:31],v[128:131]
v_exp_f32 v99,v99
v_mfma_f32_16x16x32_bf16 v[132:135],a[140:143],v[28:31],v[132:135]
v_cvt_pk_bf16_f32 v57,v98,v99
v_fma_f32 v93,v93,s36,v15
v_mfma_f32_16x16x32_bf16 a[180:183],a[140:143],v[32:35],a[180:183]
s_waitcnt lgkmcnt(4)
buffer_store_dwordx4 a[156:159],v9,s[16:19],s27 offen offset:128 nt
v_exp_f32 v104,v104
v_fma_f32 v94,v94,s36,v15
v_mfma_f32_16x16x32_bf16 a[176:179],a[136:139],v[32:35],a[176:179]
ds_read_b128 a[156:159],v10 offset:2048
v_fma_f32 v95,v95,s36,v15
v_mfma_f32_16x16x32_bf16 a[224:227],a[136:139],v[36:39],a[224:227]
v_exp_f32 v105,v105
v_mfma_f32_16x16x32_bf16 a[228:231],a[140:143],v[36:39],a[228:231]
v_exp_f32 v106,v106
v_mfma_f32_16x16x32_bf16 a[232:235],a[144:147],v[36:39],a[232:235]
v_exp_f32 v107,v107
v_mfma_f32_16x16x32_bf16 a[236:239],a[148:151],v[36:39],a[236:239]
v_cvt_pk_bf16_f32 v40,v104,v105
v_cvt_pk_bf16_f32 v41,v106,v107
v_mfma_f32_16x16x32_bf16 a[188:191],a[148:151],v[32:35],a[188:191]
v_exp_f32 v76,v76
v_mfma_f32_16x16x32_bf16 a[184:187],a[144:147],v[32:35],a[184:187]
v_exp_f32 v77,v77
v_mfma_f32_16x16x32_bf16 v[136:139],a[144:147],v[28:31],v[136:139]
v_exp_f32 v78,v78
v_mfma_f32_16x16x32_bf16 v[140:143],a[148:151],v[28:31],v[140:143]
s_waitcnt lgkmcnt(0)
buffer_store_dwordx4 a[156:159],v9,s[16:19],s27 offen offset:256 nt
v_exp_f32 v79,v79
v_cvt_pk_bf16_f32 v46,v76,v77
v_mfma_f32_16x16x32_bf16 v[236:239],a[148:151],v[24:27],v[236:239]
s_add_u32 s27,s27,3072
v_cvt_pk_bf16_f32 v47,v78,v79
v_fma_f32 v100,v100,s36,v16
v_mfma_f32_16x16x32_bf16 v[232:235],a[144:147],v[24:27],v[232:235]
s_waitcnt vmcnt(9)
v_exp_f32 v84,v84
v_mfma_f32_16x16x32_bf16 v[184:187],a[144:147],v[20:23],v[184:187]
s_barrier
v_mfma_f32_16x16x32_bf16 v[188:191],a[148:151],v[20:23],v[188:191]
s_add_u32 m0,s23,24576
ds_read_b128 a[136:139],v0 offset:12288
v_fma_f32 v101,v101,s36,v16
v_mfma_f32_16x16x32_bf16 v[192:195],a[120:123],v[20:23],v[192:195]
ds_read_b128 a[140:143],v1 offset:12288
v_fma_f32 v102,v102,s36,v16
v_mfma_f32_16x16x32_bf16 v[196:199],a[124:127],v[20:23],v[196:199]
ds_read_b128 a[144:147],v0 offset:12416
v_fma_f32 v103,v103,s36,v16
v_mfma_f32_16x16x32_bf16 v[244:247],a[124:127],v[24:27],v[244:247]
ds_read_b128 a[148:151],v1 offset:12416
v_fma_f32 v108,v108,s36,v17
v_mfma_f32_16x16x32_bf16 v[240:243],a[120:123],v[24:27],v[240:243]
v_exp_f32 v85,v85
v_mfma_f32_16x16x32_bf16 v[144:147],a[120:123],v[28:31],v[144:147]
buffer_load_dwordx4 v6,s[8:11],s21 offen offset:0 lds
v_mfma_f32_16x16x32_bf16 v[148:151],a[124:127],v[28:31],v[148:151]
v_exp_f32 v86,v86
v_mfma_f32_16x16x32_bf16 a[196:199],a[124:127],v[32:35],a[196:199]
v_exp_f32 v87,v87
v_mfma_f32_16x16x32_bf16 a[192:195],a[120:123],v[32:35],a[192:195]
v_cvt_pk_bf16_f32 v50,v84,v85
v_cvt_pk_bf16_f32 v51,v86,v87
v_mfma_f32_16x16x32_bf16 a[240:243],a[120:123],v[36:39],a[240:243]
ds_read_b128 a[120:123],v0 offset:12544
v_fma_f32 v109,v109,s36,v17
v_smfmac_f32_16x16x64_bf16 v[60:63],a[152:155],v[44:51],v18
v_fma_f32 v110,v110,s36,v17
v_mfma_f32_16x16x32_bf16 a[244:247],a[124:127],v[36:39],a[244:247]
ds_read_b128 a[124:127],v1 offset:12544
v_fma_f32 v111,v111,s36,v17
v_mfma_f32_16x16x32_bf16 a[248:251],a[128:131],v[36:39],a[248:251]
v_exp_f32 v92,v92
v_mfma_f32_16x16x32_bf16 a[252:255],a[132:135],v[36:39],a[252:255]
v_exp_f32 v93,v93
v_mfma_f32_16x16x32_bf16 a[204:207],a[132:135],v[32:35],a[204:207]
v_exp_f32 v94,v94
v_mfma_f32_16x16x32_bf16 a[200:203],a[128:131],v[32:35],a[200:203]
v_exp_f32 v95,v95
v_mfma_f32_16x16x32_bf16 v[152:155],a[128:131],v[28:31],v[152:155]
v_cvt_pk_bf16_f32 v54,v92,v93
v_cvt_pk_bf16_f32 v55,v94,v95
v_mfma_f32_16x16x32_bf16 v[156:159],a[132:135],v[28:31],v[156:159]
buffer_load_dwordx4 v7,s[8:11],s21 offen offset:1024 lds
v_mfma_f32_16x16x32_bf16 v[252:255],a[132:135],v[24:27],v[252:255]
v_exp_f32 v100,v100
v_mfma_f32_16x16x32_bf16 v[248:251],a[128:131],v[24:27],v[248:251]
v_exp_f32 v101,v101
v_mfma_f32_16x16x32_bf16 v[200:203],a[128:131],v[20:23],v[200:203]
ds_read_b128 a[128:131],v0 offset:18432
v_cvt_pk_bf16_f32 v58,v100,v101
v_mfma_f32_16x16x32_bf16 v[204:207],a[132:135],v[20:23],v[204:207]
s_waitcnt lgkmcnt(1)
ds_read_b128 a[132:135],v1 offset:18432
v_mfma_f32_16x16x32_bf16 v[72:75],a[136:139],a[0:3],0
v_exp_f32 v102,v102
v_mfma_f32_16x16x32_bf16 v[72:75],a[140:143],a[4:7],v[72:75]
v_exp_f32 v103,v103
v_mfma_f32_16x16x32_bf16 v[72:75],a[144:147],a[8:11],v[72:75]
v_cvt_pk_bf16_f32 v59,v102,v103
v_mfma_f32_16x16x32_bf16 v[72:75],a[148:151],a[12:15],v[72:75]
v_exp_f32 v108,v108
v_smfmac_f32_16x16x64_bf16 v[64:67],a[152:155],v[52:59],v18
v_mfma_f32_16x16x32_bf16 v[72:75],a[120:123],a[16:19],v[72:75]
v_exp_f32 v109,v109
v_mfma_f32_16x16x32_bf16 v[72:75],a[124:127],a[20:23],v[72:75]
buffer_load_dwordx4 v8,s[8:11],s21 offen offset:2048 lds
v_mfma_f32_16x16x32_bf16 v[80:83],a[124:127],a[44:47],0
s_add_u32 s21,s21,12288
v_exp_f32 v110,v110
v_mfma_f32_16x16x32_bf16 v[80:83],a[120:123],a[40:43],v[80:83]
s_add_u32 m0,s22,0
v_exp_f32 v111,v111
v_mfma_f32_16x16x32_bf16 v[80:83],a[148:151],a[36:39],v[80:83]
v_cvt_pk_bf16_f32 v42,v108,v109
v_cvt_pk_bf16_f32 v43,v110,v111
v_mfma_f32_16x16x32_bf16 v[80:83],a[144:147],a[32:35],v[80:83]
v_fma_f32 v72,v72,s36,v13
v_fma_f32 v73,v73,s36,v13
v_smfmac_f32_16x16x64_bf16 v[68:71],a[152:155],v[36:43],v18
v_fma_f32 v74,v74,s36,v13
v_mfma_f32_16x16x32_bf16 v[80:83],a[140:143],a[28:31],v[80:83]
v_fma_f32 v75,v75,s36,v13
v_mfma_f32_16x16x32_bf16 v[80:83],a[136:139],a[24:27],v[80:83]
v_exp_f32 v72,v72
v_mfma_f32_16x16x32_bf16 v[88:91],a[136:139],a[48:51],0
v_exp_f32 v73,v73
v_mfma_f32_16x16x32_bf16 v[88:91],a[140:143],a[52:55],v[88:91]
v_exp_f32 v74,v74
v_mfma_f32_16x16x32_bf16 v[88:91],a[144:147],a[56:59],v[88:91]
v_exp_f32 v75,v75
v_mfma_f32_16x16x32_bf16 v[88:91],a[148:151],a[60:63],v[88:91]
v_fma_f32 v80,v80,s36,v14
v_fma_f32 v81,v81,s36,v14
v_mfma_f32_16x16x32_bf16 v[88:91],a[120:123],a[64:67],v[88:91]
buffer_load_dwordx4 v6,s[4:7],s20 offen offset:0 lds
v_mfma_f32_16x16x32_bf16 v[88:91],a[124:127],a[68:71],v[88:91]
v_fma_f32 v82,v82,s36,v14
v_fma_f32 v83,v83,s36,v14
v_mfma_f32_16x16x32_bf16 v[96:99],a[124:127],a[92:95],0
v_exp_f32 v80,v80
v_mfma_f32_16x16x32_bf16 v[96:99],a[120:123],a[88:91],v[96:99]
v_exp_f32 v81,v81
v_mfma_f32_16x16x32_bf16 v[96:99],a[148:151],a[84:87],v[96:99]
v_exp_f32 v82,v82
v_mfma_f32_16x16x32_bf16 v[96:99],a[144:147],a[80:83],v[96:99]
v_fma_f32 v88,v88,s36,v15
v_fma_f32 v89,v89,s36,v15
v_mfma_f32_16x16x32_bf16 v[96:99],a[140:143],a[76:79],v[96:99]
v_exp_f32 v83,v83
v_mfma_f32_16x16x32_bf16 v[96:99],a[136:139],a[72:75],v[96:99]
v_exp_f32 v88,v88
v_mfma_f32_16x16x32_bf16 v[104:107],a[136:139],a[96:99],0
ds_read_b128 a[136:139],v0 offset:18560
v_cvt_pk_bf16_f32 v20,v72,v73
v_mfma_f32_16x16x32_bf16 v[104:107],a[140:143],a[100:103],v[104:107]
ds_read_b128 a[140:143],v1 offset:18560
v_cvt_pk_bf16_f32 v21,v74,v75
v_mfma_f32_16x16x32_bf16 v[104:107],a[144:147],a[104:107],v[104:107]
ds_read_b128 a[144:147],v0 offset:18688
v_cvt_pk_bf16_f32 v24,v80,v81
v_mfma_f32_16x16x32_bf16 v[104:107],a[148:151],a[108:111],v[104:107]
ds_read_b128 a[148:151],v1 offset:18688
v_cvt_pk_bf16_f32 v25,v82,v83
v_mfma_f32_16x16x32_bf16 v[104:107],a[120:123],a[112:115],v[104:107]
buffer_load_dwordx4 v7,s[4:7],s20 offen offset:1024 lds
v_mfma_f32_16x16x32_bf16 v[104:107],a[124:127],a[116:119],v[104:107]
s_waitcnt lgkmcnt(4)
v_exp_f32 v89,v89
v_mfma_f32_16x16x32_bf16 v[76:79],a[128:131],a[0:3],0
v_cvt_pk_bf16_f32 v28,v88,v89
v_mfma_f32_16x16x32_bf16 v[76:79],a[132:135],a[4:7],v[76:79]
s_waitcnt lgkmcnt(3)
v_mfma_f32_16x16x32_bf16 v[76:79],a[136:139],a[8:11],v[76:79]
s_waitcnt lgkmcnt(2)
v_mfma_f32_16x16x32_bf16 v[76:79],a[140:143],a[12:15],v[76:79]
s_waitcnt lgkmcnt(1)
v_mfma_f32_16x16x32_bf16 v[76:79],a[144:147],a[16:19],v[76:79]
s_waitcnt lgkmcnt(0)
v_mfma_f32_16x16x32_bf16 v[76:79],a[148:151],a[20:23],v[76:79]
v_mfma_f32_16x16x32_bf16 v[84:87],a[148:151],a[44:47],0
v_mfma_f32_16x16x32_bf16 v[84:87],a[144:147],a[40:43],v[84:87]
v_mfma_f32_16x16x32_bf16 v[84:87],a[140:143],a[36:39],v[84:87]
v_mfma_f32_16x16x32_bf16 v[84:87],a[136:139],a[32:35],v[84:87]
buffer_load_dwordx4 v8,s[4:7],s20 offen offset:2048 lds
v_mfma_f32_16x16x32_bf16 v[84:87],a[132:135],a[28:31],v[84:87]
s_add_u32 s20,s20,12288
v_mfma_f32_16x16x32_bf16 v[84:87],a[128:131],a[24:27],v[84:87]
v_mfma_f32_16x16x32_bf16 v[92:95],a[128:131],a[48:51],0
v_mfma_f32_16x16x32_bf16 v[92:95],a[132:135],a[52:55],v[92:95]
v_mfma_f32_16x16x32_bf16 v[92:95],a[136:139],a[56:59],v[92:95]
v_mfma_f32_16x16x32_bf16 v[92:95],a[140:143],a[60:63],v[92:95]
ds_read_b64_tr_b16 a[120:121],v2 offset:0
v_mfma_f32_16x16x32_bf16 v[92:95],a[144:147],a[64:67],v[92:95]
ds_read_b64_tr_b16 a[122:123],v2 offset:6144
v_mfma_f32_16x16x32_bf16 v[92:95],a[148:151],a[68:71],v[92:95]
v_mfma_f32_16x16x32_bf16 v[100:103],a[148:151],a[92:95],0
ds_read_b64_tr_b16 a[124:125],v3 offset:0
v_mfma_f32_16x16x32_bf16 v[100:103],a[144:147],a[88:91],v[100:103]
ds_read_b64_tr_b16 a[126:127],v3 offset:6144
v_mfma_f32_16x16x32_bf16 v[100:103],a[140:143],a[84:87],v[100:103]
v_mfma_f32_16x16x32_bf16 v[100:103],a[136:139],a[80:83],v[100:103]
v_mfma_f32_16x16x32_bf16 v[100:103],a[132:135],a[76:79],v[100:103]
v_mfma_f32_16x16x32_bf16 v[100:103],a[128:131],a[72:75],v[100:103]
v_mfma_f32_16x16x32_bf16 v[108:111],a[128:131],a[96:99],0
ds_read_b64_tr_b16 a[128:129],v4 offset:0
v_mfma_f32_16x16x32_bf16 v[108:111],a[132:135],a[100:103],v[108:111]
ds_read_b64_tr_b16 a[130:131],v4 offset:6144
v_mfma_f32_16x16x32_bf16 v[108:111],a[136:139],a[104:107],v[108:111]
ds_read_b64_tr_b16 a[132:133],v5 offset:0
v_mfma_f32_16x16x32_bf16 v[108:111],a[140:143],a[108:111],v[108:111]
ds_read_b64_tr_b16 a[134:135],v5 offset:6144
v_mfma_f32_16x16x32_bf16 v[108:111],a[144:147],a[112:115],v[108:111]
v_mfma_f32_16x16x32_bf16 v[108:111],a[148:151],a[116:119],v[108:111]
s_waitcnt lgkmcnt(4)
v_mfma_f32_16x16x32_bf16 v[160:163],a[120:123],v[44:47],v[160:163]
s_add_u32 m0,s29,0
ds_read_b64_tr_b16 a[136:137],v2 offset:128
v_fma_f32 v90,v90,s36,v15
v_mfma_f32_16x16x32_bf16 v[164:167],a[124:127],v[44:47],v[164:167]
ds_read_b64_tr_b16 a[138:139],v2 offset:6272
v_fma_f32 v91,v91,s36,v15
v_mfma_f32_16x16x32_bf16 v[212:215],a[124:127],v[48:51],v[212:215]
ds_read_b64_tr_b16 a[140:141],v3 offset:128
v_fma_f32 v96,v96,s36,v16
v_mfma_f32_16x16x32_bf16 v[208:211],a[120:123],v[48:51],v[208:211]
ds_read_b64_tr_b16 a[142:143],v3 offset:6272
v_fma_f32 v97,v97,s36,v16
v_mfma_f32_16x16x32_bf16 v[112:115],a[120:123],v[52:55],v[112:115]
ds_read_b64_tr_b16 a[144:145],v4 offset:128
v_fma_f32 v98,v98,s36,v16
v_mfma_f32_16x16x32_bf16 v[116:119],a[124:127],v[52:55],v[116:119]
ds_read_b64_tr_b16 a[146:147],v4 offset:6272
v_fma_f32 v99,v99,s36,v16
v_mfma_f32_16x16x32_bf16 a[164:167],a[124:127],v[56:59],a[164:167]
ds_read_b64_tr_b16 a[148:149],v5 offset:128
v_fma_f32 v104,v104,s36,v17
v_mfma_f32_16x16x32_bf16 a[160:163],a[120:123],v[56:59],a[160:163]
buffer_load_dwordx4 v6,s[12:15],s28 offen offset:0 nt lds
v_mfma_f32_16x16x32_bf16 a[208:211],a[120:123],v[40:43],a[208:211]
ds_read_b64_tr_b16 a[150:151],v5 offset:6272
v_fma_f32 v105,v105,s36,v17
v_mfma_f32_16x16x32_bf16 a[212:215],a[124:127],v[40:43],a[212:215]
s_waitcnt lgkmcnt(5)
ds_read_b64_tr_b16 a[120:121],v2 offset:256
v_fma_f32 v106,v106,s36,v17
v_mfma_f32_16x16x32_bf16 a[216:219],a[128:131],v[40:43],a[216:219]
ds_read_b64_tr_b16 a[122:123],v2 offset:6400
v_fma_f32 v107,v107,s36,v17
v_mfma_f32_16x16x32_bf16 a[220:223],a[132:135],v[40:43],a[220:223]
ds_read_b64_tr_b16 a[124:125],v3 offset:256
v_fma_f32 v76,v76,s36,v13
v_mfma_f32_16x16x32_bf16 a[172:175],a[132:135],v[56:59],a[172:175]
ds_read_b64_tr_b16 a[126:127],v3 offset:6400
v_fma_f32 v77,v77,s36,v13
v_mfma_f32_16x16x32_bf16 a[168:171],a[128:131],v[56:59],a[168:171]
v_exp_f32 v90,v90
v_mfma_f32_16x16x32_bf16 v[120:123],a[128:131],v[52:55],v[120:123]
v_exp_f32 v91,v91
v_mfma_f32_16x16x32_bf16 v[124:127],a[132:135],v[52:55],v[124:127]
v_cvt_pk_bf16_f32 v29,v90,v91
v_fma_f32 v78,v78,s36,v13
v_mfma_f32_16x16x32_bf16 v[220:223],a[132:135],v[48:51],v[220:223]
v_exp_f32 v96,v96
v_mfma_f32_16x16x32_bf16 v[216:219],a[128:131],v[48:51],v[216:219]
buffer_load_dwordx4 v7,s[12:15],s28 offen offset:1024 nt lds
v_mfma_f32_16x16x32_bf16 v[168:171],a[128:131],v[44:47],v[168:171]
ds_read_b64_tr_b16 a[128:129],v4 offset:256
v_fma_f32 v79,v79,s36,v13
v_mfma_f32_16x16x32_bf16 v[172:175],a[132:135],v[44:47],v[172:175]
ds_read_b64_tr_b16 a[130:131],v4 offset:6400
v_fma_f32 v84,v84,s36,v14
v_mfma_f32_16x16x32_bf16 v[176:179],a[136:139],v[44:47],v[176:179]
s_waitcnt lgkmcnt(2)
ds_read_b64_tr_b16 a[132:133],v5 offset:256
v_fma_f32 v85,v85,s36,v14
v_mfma_f32_16x16x32_bf16 v[180:183],a[140:143],v[44:47],v[180:183]
ds_read_b64_tr_b16 a[134:135],v5 offset:6400
v_fma_f32 v86,v86,s36,v14
v_mfma_f32_16x16x32_bf16 v[228:231],a[140:143],v[48:51],v[228:231]
v_exp_f32 v97,v97
v_mfma_f32_16x16x32_bf16 v[224:227],a[136:139],v[48:51],v[224:227]
v_exp_f32 v98,v98
v_mfma_f32_16x16x32_bf16 v[128:131],a[136:139],v[52:55],v[128:131]
v_exp_f32 v99,v99
v_mfma_f32_16x16x32_bf16 v[132:135],a[140:143],v[52:55],v[132:135]
v_cvt_pk_bf16_f32 v32,v96,v97
v_cvt_pk_bf16_f32 v33,v98,v99
v_mfma_f32_16x16x32_bf16 a[180:183],a[140:143],v[56:59],a[180:183]
v_exp_f32 v104,v104
v_mfma_f32_16x16x32_bf16 a[176:179],a[136:139],v[56:59],a[176:179]
buffer_load_dwordx4 v8,s[12:15],s28 offen offset:2048 nt lds
v_mfma_f32_16x16x32_bf16 a[224:227],a[136:139],v[40:43],a[224:227]
s_add_u32 s28,s28,3072
v_exp_f32 v105,v105
v_mfma_f32_16x16x32_bf16 a[228:231],a[140:143],v[40:43],a[228:231]
s_add_u32 s29,s29,3072
v_exp_f32 v106,v106
v_mfma_f32_16x16x32_bf16 a[232:235],a[144:147],v[40:43],a[232:235]
s_add_u32 m0,s23,0
v_exp_f32 v107,v107
v_mfma_f32_16x16x32_bf16 a[236:239],a[148:151],v[40:43],a[236:239]
v_cvt_pk_bf16_f32 v36,v104,v105
v_cvt_pk_bf16_f32 v37,v106,v107
v_mfma_f32_16x16x32_bf16 a[188:191],a[148:151],v[56:59],a[188:191]
v_exp_f32 v76,v76
v_mfma_f32_16x16x32_bf16 a[184:187],a[144:147],v[56:59],a[184:187]
v_exp_f32 v77,v77
v_mfma_f32_16x16x32_bf16 v[136:139],a[144:147],v[52:55],v[136:139]
v_exp_f32 v78,v78
v_mfma_f32_16x16x32_bf16 v[140:143],a[148:151],v[52:55],v[140:143]
v_exp_f32 v79,v79
v_mfma_f32_16x16x32_bf16 v[236:239],a[148:151],v[48:51],v[236:239]
v_cvt_pk_bf16_f32 v22,v76,v77
v_cvt_pk_bf16_f32 v23,v78,v79
v_mfma_f32_16x16x32_bf16 v[232:235],a[144:147],v[48:51],v[232:235]
v_fma_f32 v87,v87,s36,v14
v_fma_f32 v92,v92,s36,v15
v_mfma_f32_16x16x32_bf16 v[184:187],a[144:147],v[44:47],v[184:187]
v_exp_f32 v84,v84
v_mfma_f32_16x16x32_bf16 v[188:191],a[148:151],v[44:47],v[188:191]
s_waitcnt vmcnt(12) lgkmcnt(0)
v_exp_f32 v85,v85
v_mfma_f32_16x16x32_bf16 v[192:195],a[120:123],v[44:47],v[192:195]
s_barrier
v_mfma_f32_16x16x32_bf16 v[196:199],a[124:127],v[44:47],v[196:199]
ds_read_b128 a[136:139],v0 offset:24576
v_cvt_pk_bf16_f32 v26,v84,v85
v_mfma_f32_16x16x32_bf16 v[244:247],a[124:127],v[48:51],v[244:247]
ds_read_b128 a[140:143],v1 offset:24576
v_fma_f32 v93,v93,s36,v15
v_mfma_f32_16x16x32_bf16 v[240:243],a[120:123],v[48:51],v[240:243]
ds_read_b128 a[144:147],v0 offset:24704
v_fma_f32 v94,v94,s36,v15
v_mfma_f32_16x16x32_bf16 v[144:147],a[120:123],v[52:55],v[144:147]
ds_read_b128 a[148:151],v1 offset:24704
v_fma_f32 v95,v95,s36,v15
v_mfma_f32_16x16x32_bf16 v[148:151],a[124:127],v[52:55],v[148:151]
v_exp_f32 v86,v86
v_mfma_f32_16x16x32_bf16 a[196:199],a[124:127],v[56:59],a[196:199]
buffer_load_dwordx4 v6,s[8:11],s21 offen offset:0 lds
v_mfma_f32_16x16x32_bf16 a[192:195],a[120:123],v[56:59],a[192:195]
v_exp_f32 v87,v87
v_mfma_f32_16x16x32_bf16 a[240:243],a[120:123],v[40:43],a[240:243]
ds_read_b128 a[120:123],v0 offset:24832
v_cvt_pk_bf16_f32 v27,v86,v87
v_mfma_f32_16x16x32_bf16 a[244:247],a[124:127],v[40:43],a[244:247]
ds_read_b128 a[124:127],v1 offset:24832
v_fma_f32 v100,v100,s36,v16
v_smfmac_f32_16x16x64_bf16 v[60:63],a[152:155],v[20:27],v18
v_fma_f32 v101,v101,s36,v16
v_mfma_f32_16x16x32_bf16 a[248:251],a[128:131],v[40:43],a[248:251]
v_exp_f32 v92,v92
v_mfma_f32_16x16x32_bf16 a[252:255],a[132:135],v[40:43],a[252:255]
v_exp_f32 v93,v93
v_mfma_f32_16x16x32_bf16 a[204:207],a[132:135],v[56:59],a[204:207]
v_exp_f32 v94,v94
v_mfma_f32_16x16x32_bf16 a[200:203],a[128:131],v[56:59],a[200:203]
v_exp_f32 v95,v95
v_mfma_f32_16x16x32_bf16 v[152:155],a[128:131],v[52:55],v[152:155]
v_cvt_pk_bf16_f32 v30,v92,v93
v_cvt_pk_bf16_f32 v31,v94,v95
v_mfma_f32_16x16x32_bf16 v[156:159],a[132:135],v[52:55],v[156:159]
v_fma_f32 v102,v102,s36,v16
v_fma_f32 v103,v103,s36,v16
v_mfma_f32_16x16x32_bf16 v[252:255],a[132:135],v[48:51],v[252:255]
v_exp_f32 v100,v100
v_mfma_f32_16x16x32_bf16 v[248:251],a[128:131],v[48:51],v[248:251]
buffer_load_dwordx4 v7,s[8:11],s21 offen offset:1024 lds
v_mfma_f32_16x16x32_bf16 v[200:203],a[128:131],v[44:47],v[200:203]
ds_read_b128 a[128:131],v0 offset:30720
v_fma_f32 v108,v108,s36,v17
v_mfma_f32_16x16x32_bf16 v[204:207],a[132:135],v[44:47],v[204:207]
s_waitcnt lgkmcnt(1)
ds_read_b128 a[132:135],v1 offset:30720
v_fma_f32 v109,v109,s36,v17
v_mfma_f32_16x16x32_bf16 v[72:75],a[136:139],a[0:3],0
v_exp_f32 v101,v101
v_mfma_f32_16x16x32_bf16 v[72:75],a[140:143],a[4:7],v[72:75]
v_exp_f32 v102,v102
v_mfma_f32_16x16x32_bf16 v[72:75],a[144:147],a[8:11],v[72:75]
v_exp_f32 v103,v103
v_mfma_f32_16x16x32_bf16 v[72:75],a[148:151],a[12:15],v[72:75]
v_cvt_pk_bf16_f32 v34,v100,v101
v_cvt_pk_bf16_f32 v35,v102,v103
v_mfma_f32_16x16x32_bf16 v[72:75],a[120:123],a[16:19],v[72:75]
v_fma_f32 v110,v110,s36,v17
v_fma_f32 v111,v111,s36,v17
v_smfmac_f32_16x16x64_bf16 v[64:67],a[152:155],v[28:35],v18
v_mfma_f32_16x16x32_bf16 v[72:75],a[124:127],a[20:23],v[72:75]
v_exp_f32 v108,v108
v_mfma_f32_16x16x32_bf16 v[80:83],a[124:127],a[44:47],0
v_exp_f32 v109,v109
v_mfma_f32_16x16x32_bf16 v[80:83],a[120:123],a[40:43],v[80:83]
buffer_load_dwordx4 v8,s[8:11],s21 offen offset:2048 lds
v_mfma_f32_16x16x32_bf16 v[80:83],a[148:151],a[36:39],v[80:83]
s_add_u32 s21,s21,12288
v_exp_f32 v110,v110
v_mfma_f32_16x16x32_bf16 v[80:83],a[144:147],a[32:35],v[80:83]
s_add_u32 m0,s22,12288
v_exp_f32 v111,v111
v_mfma_f32_16x16x32_bf16 v[80:83],a[140:143],a[28:31],v[80:83]
v_cvt_pk_bf16_f32 v38,v108,v109
v_cvt_pk_bf16_f32 v39,v110,v111
v_mfma_f32_16x16x32_bf16 v[80:83],a[136:139],a[24:27],v[80:83]
v_fma_f32 v72,v72,s36,v13
v_fma_f32 v73,v73,s36,v13
v_mfma_f32_16x16x32_bf16 v[88:91],a[136:139],a[48:51],0
v_fma_f32 v74,v74,s36,v13
v_fma_f32 v75,v75,s36,v13
v_mfma_f32_16x16x32_bf16 v[88:91],a[140:143],a[52:55],v[88:91]
v_exp_f32 v72,v72
v_mfma_f32_16x16x32_bf16 v[88:91],a[144:147],a[56:59],v[88:91]
v_fma_f32 v80,v80,s36,v14
v_fma_f32 v81,v81,s36,v14
v_mfma_f32_16x16x32_bf16 v[88:91],a[148:151],a[60:63],v[88:91]
v_fma_f32 v82,v82,s36,v14
v_fma_f32 v83,v83,s36,v14
v_mfma_f32_16x16x32_bf16 v[88:91],a[120:123],a[64:67],v[88:91]
v_exp_f32 v73,v73
v_mfma_f32_16x16x32_bf16 v[88:91],a[124:127],a[68:71],v[88:91]
v_exp_f32 v74,v74
v_mfma_f32_16x16x32_bf16 v[96:99],a[124:127],a[92:95],0
v_exp_f32 v75,v75
v_mfma_f32_16x16x32_bf16 v[96:99],a[120:123],a[88:91],v[96:99]
buffer_load_dwordx4 v6,s[4:7],s20 offen offset:0 lds
v_mfma_f32_16x16x32_bf16 v[96:99],a[148:151],a[84:87],v[96:99]
v_exp_f32 v80,v80
v_mfma_f32_16x16x32_bf16 v[96:99],a[144:147],a[80:83],v[96:99]
v_fma_f32 v88,v88,s36,v15
v_fma_f32 v89,v89,s36,v15
v_mfma_f32_16x16x32_bf16 v[96:99],a[140:143],a[76:79],v[96:99]
v_exp_f32 v81,v81
v_mfma_f32_16x16x32_bf16 v[96:99],a[136:139],a[72:75],v[96:99]
v_exp_f32 v82,v82
v_mfma_f32_16x16x32_bf16 v[104:107],a[136:139],a[96:99],0
ds_read_b128 a[136:139],v0 offset:30848
v_cvt_pk_bf16_f32 v44,v72,v73
v_mfma_f32_16x16x32_bf16 v[104:107],a[140:143],a[100:103],v[104:107]
ds_read_b128 a[140:143],v1 offset:30848
v_cvt_pk_bf16_f32 v45,v74,v75
v_mfma_f32_16x16x32_bf16 v[104:107],a[144:147],a[104:107],v[104:107]
ds_read_b128 a[144:147],v0 offset:30976
v_cvt_pk_bf16_f32 v48,v80,v81
v_mfma_f32_16x16x32_bf16 v[104:107],a[148:151],a[108:111],v[104:107]
ds_read_b128 a[148:151],v1 offset:30976
v_mfma_f32_16x16x32_bf16 v[104:107],a[120:123],a[112:115],v[104:107]
v_exp_f32 v83,v83
v_mfma_f32_16x16x32_bf16 v[104:107],a[124:127],a[116:119],v[104:107]
s_waitcnt lgkmcnt(4)
v_exp_f32 v88,v88
v_mfma_f32_16x16x32_bf16 v[76:79],a[128:131],a[0:3],0
v_exp_f32 v89,v89
v_mfma_f32_16x16x32_bf16 v[76:79],a[132:135],a[4:7],v[76:79]
buffer_load_dwordx4 v7,s[4:7],s20 offen offset:1024 lds
s_waitcnt lgkmcnt(3)
v_mfma_f32_16x16x32_bf16 v[76:79],a[136:139],a[8:11],v[76:79]
s_waitcnt lgkmcnt(2)
v_cvt_pk_bf16_f32 v49,v82,v83
v_cvt_pk_bf16_f32 v52,v88,v89
v_mfma_f32_16x16x32_bf16 v[76:79],a[140:143],a[12:15],v[76:79]
s_waitcnt lgkmcnt(0)
v_mfma_f32_16x16x32_bf16 v[76:79],a[144:147],a[16:19],v[76:79]
v_mfma_f32_16x16x32_bf16 v[76:79],a[148:151],a[20:23],v[76:79]
v_mfma_f32_16x16x32_bf16 v[84:87],a[148:151],a[44:47],0
v_mfma_f32_16x16x32_bf16 v[84:87],a[144:147],a[40:43],v[84:87]
v_mfma_f32_16x16x32_bf16 v[84:87],a[140:143],a[36:39],v[84:87]
v_mfma_f32_16x16x32_bf16 v[84:87],a[136:139],a[32:35],v[84:87]
v_mfma_f32_16x16x32_bf16 v[84:87],a[132:135],a[28:31],v[84:87]
v_mfma_f32_16x16x32_bf16 v[84:87],a[128:131],a[24:27],v[84:87]
v_mfma_f32_16x16x32_bf16 v[92:95],a[128:131],a[48:51],0
buffer_load_dwordx4 v8,s[4:7],s20 offen offset:2048 lds
v_mfma_f32_16x16x32_bf16 v[92:95],a[132:135],a[52:55],v[92:95]
s_add_u32 s20,s20,12288
v_mfma_f32_16x16x32_bf16 v[92:95],a[136:139],a[56:59],v[92:95]
v_mfma_f32_16x16x32_bf16 v[92:95],a[140:143],a[60:63],v[92:95]
v_mfma_f32_16x16x32_bf16 v[92:95],a[144:147],a[64:67],v[92:95]
v_mfma_f32_16x16x32_bf16 v[92:95],a[148:151],a[68:71],v[92:95]
v_mfma_f32_16x16x32_bf16 v[100:103],a[148:151],a[92:95],0
ds_read_b64_tr_b16 a[120:121],v2 offset:12288
v_mfma_f32_16x16x32_bf16 v[100:103],a[144:147],a[88:91],v[100:103]
ds_read_b64_tr_b16 a[122:123],v2 offset:18432
v_mfma_f32_16x16x32_bf16 v[100:103],a[140:143],a[84:87],v[100:103]
v_mfma_f32_16x16x32_bf16 v[100:103],a[136:139],a[80:83],v[100:103]
ds_read_b64_tr_b16 a[124:125],v3 offset:12288
v_mfma_f32_16x16x32_bf16 v[100:103],a[132:135],a[76:79],v[100:103]
ds_read_b64_tr_b16 a[126:127],v3 offset:18432
v_mfma_f32_16x16x32_bf16 v[100:103],a[128:131],a[72:75],v[100:103]
v_mfma_f32_16x16x32_bf16 v[108:111],a[128:131],a[96:99],0
ds_read_b64_tr_b16 a[128:129],v4 offset:12288
v_mfma_f32_16x16x32_bf16 v[108:111],a[132:135],a[100:103],v[108:111]
ds_read_b64_tr_b16 a[130:131],v4 offset:18432
v_mfma_f32_16x16x32_bf16 v[108:111],a[136:139],a[104:107],v[108:111]
ds_read_b64_tr_b16 a[132:133],v5 offset:12288
v_mfma_f32_16x16x32_bf16 v[108:111],a[140:143],a[108:111],v[108:111]
ds_read_b64_tr_b16 a[134:135],v5 offset:18432
v_mfma_f32_16x16x32_bf16 v[108:111],a[144:147],a[112:115],v[108:111]
v_mfma_f32_16x16x32_bf16 v[108:111],a[148:151],a[116:119],v[108:111]
s_waitcnt lgkmcnt(4)
v_mfma_f32_16x16x32_bf16 v[160:163],a[120:123],v[20:23],v[160:163]
ds_read_b128 a[156:159],v10 offset:3072
v_mbcnt_lo_u32_b32 v19,-1,0
v_mfma_f32_16x16x32_bf16 v[164:167],a[124:127],v[20:23],v[164:167]
ds_read_b64_tr_b16 a[138:139],v2 offset:18560
v_mbcnt_hi_u32_b32 v19,-1,v19
v_mfma_f32_16x16x32_bf16 v[212:215],a[124:127],v[24:27],v[212:215]
ds_read_b64_tr_b16 a[136:137],v2 offset:12416
v_min_u32 v19,7,v19
v_mfma_f32_16x16x32_bf16 v[208:211],a[120:123],v[24:27],v[208:211]
ds_read_b64_tr_b16 a[140:141],v3 offset:12416
v_lshl_add_u32 v19,v19,7,s48
v_mfma_f32_16x16x32_bf16 v[112:115],a[120:123],v[28:31],v[112:115]
ds_read_b64_tr_b16 a[142:143],v3 offset:18560
v_min_u32 v19,L_codeend-L_first-4,v19
v_mfma_f32_16x16x32_bf16 v[116:119],a[124:127],v[28:31],v[116:119]
ds_read_b64_tr_b16 a[144:145],v4 offset:12416
v_fma_f32 v91,v91,s36,v15
v_mfma_f32_16x16x32_bf16 a[164:167],a[124:127],v[32:35],a[164:167]
ds_read_b64_tr_b16 a[146:147],v4 offset:18560
v_fma_f32 v90,v90,s36,v15
v_mfma_f32_16x16x32_bf16 a[160:163],a[120:123],v[32:35],a[160:163]
ds_read_b64_tr_b16 a[150:151],v5 offset:18560
v_fma_f32 v99,v99,s36,v16
v_mfma_f32_16x16x32_bf16 a[208:211],a[120:123],v[36:39],a[208:211]
ds_read_b64_tr_b16 a[148:149],v5 offset:12416
v_fma_f32 v96,v96,s36,v16
v_mfma_f32_16x16x32_bf16 a[212:215],a[124:127],v[36:39],a[212:215]
s_waitcnt lgkmcnt(6)
ds_read_b64_tr_b16 a[122:123],v2 offset:18688
v_fma_f32 v98,v98,s36,v16
v_mfma_f32_16x16x32_bf16 a[216:219],a[128:131],v[36:39],a[216:219]
ds_read_b64_tr_b16 a[120:121],v2 offset:12544
v_fma_f32 v97,v97,s36,v16
v_mfma_f32_16x16x32_bf16 a[220:223],a[132:135],v[36:39],a[220:223]
ds_read_b64_tr_b16 a[126:127],v3 offset:18688
v_fma_f32 v107,v107,s36,v17
v_mfma_f32_16x16x32_bf16 a[172:175],a[132:135],v[32:35],a[172:175]
ds_read_b64_tr_b16 a[124:125],v3 offset:12544
v_fma_f32 v105,v105,s36,v17
v_mfma_f32_16x16x32_bf16 a[168:171],a[128:131],v[32:35],a[168:171]
v_exp_f32 v90,v90
v_mfma_f32_16x16x32_bf16 v[120:123],a[128:131],v[28:31],v[120:123]
v_exp_f32 v91,v91
v_mfma_f32_16x16x32_bf16 v[124:127],a[132:135],v[28:31],v[124:127]
v_cvt_pk_bf16_f32 v53,v90,v91
v_fma_f32 v106,v106,s36,v17
v_mfma_f32_16x16x32_bf16 v[220:223],a[132:135],v[24:27],v[220:223]
v_exp_f32 v97,v97
v_mfma_f32_16x16x32_bf16 v[216:219],a[128:131],v[24:27],v[216:219]
buffer_store_dwordx4 a[156:159],v9,s[16:19],s27 offen offset:0 nt
v_exp_f32 v98,v98
v_fma_f32 v104,v104,s36,v17
v_mfma_f32_16x16x32_bf16 v[168:171],a[128:131],v[20:23],v[168:171]
ds_read_b128 a[156:159],v10 offset:4096
v_fma_f32 v78,v78,s36,v13
v_mfma_f32_16x16x32_bf16 v[172:175],a[132:135],v[20:23],v[172:175]
global_load_dword v19,v19,s[46:47]
v_mfma_f32_16x16x32_bf16 v[176:179],a[136:139],v[20:23],v[176:179]
s_waitcnt lgkmcnt(1)
ds_read_b64_tr_b16 a[128:129],v4 offset:12544
v_fma_f32 v76,v76,s36,v13
v_mfma_f32_16x16x32_bf16 v[180:183],a[140:143],v[20:23],v[180:183]
ds_read_b64_tr_b16 a[132:133],v5 offset:12544
v_fma_f32 v77,v77,s36,v13
v_mfma_f32_16x16x32_bf16 v[228:231],a[140:143],v[24:27],v[228:231]
ds_read_b64_tr_b16 a[130:131],v4 offset:18688
v_fma_f32 v79,v79,s36,v13
v_mfma_f32_16x16x32_bf16 v[224:227],a[136:139],v[24:27],v[224:227]
ds_read_b64_tr_b16 a[134:135],v5 offset:18688
v_fma_f32 v86,v86,s36,v14
v_mfma_f32_16x16x32_bf16 v[128:131],a[136:139],v[28:31],v[128:131]
v_exp_f32 v99,v99
v_mfma_f32_16x16x32_bf16 v[132:135],a[140:143],v[28:31],v[132:135]
v_exp_f32 v96,v96
v_mfma_f32_16x16x32_bf16 a[180:183],a[140:143],v[32:35],a[180:183]
s_waitcnt lgkmcnt(4)
buffer_store_dwordx4 a[156:159],v9,s[16:19],s27 offen offset:128 nt
v_cvt_pk_bf16_f32 v57,v98,v99
v_cvt_pk_bf16_f32 v56,v96,v97
v_fma_f32 v87,v87,s36,v14
v_mfma_f32_16x16x32_bf16 a[176:179],a[136:139],v[32:35],a[176:179]
ds_read_b128 a[156:159],v10 offset:5120
v_fma_f32 v84,v84,s36,v14
v_mfma_f32_16x16x32_bf16 a[224:227],a[136:139],v[36:39],a[224:227]
v_exp_f32 v105,v105
v_mfma_f32_16x16x32_bf16 a[228:231],a[140:143],v[36:39],a[228:231]
v_exp_f32 v104,v104
v_mfma_f32_16x16x32_bf16 a[232:235],a[144:147],v[36:39],a[232:235]
v_exp_f32 v107,v107
v_mfma_f32_16x16x32_bf16 a[236:239],a[148:151],v[36:39],a[236:239]
v_exp_f32 v106,v106
v_mfma_f32_16x16x32_bf16 a[188:191],a[148:151],v[32:35],a[188:191]
v_cvt_pk_bf16_f32 v41,v106,v107
v_cvt_pk_bf16_f32 v40,v104,v105
v_mfma_f32_16x16x32_bf16 a[184:187],a[144:147],v[32:35],a[184:187]
v_exp_f32 v79,v79
v_mfma_f32_16x16x32_bf16 v[136:139],a[144:147],v[28:31],v[136:139]
v_exp_f32 v76,v76
v_mfma_f32_16x16x32_bf16 v[140:143],a[148:151],v[28:31],v[140:143]
s_waitcnt lgkmcnt(0)
buffer_store_dwordx4 a[156:159],v9,s[16:19],s27 offen offset:256 nt
v_exp_f32 v78,v78
v_fma_f32 v85,v85,s36,v14
v_mfma_f32_16x16x32_bf16 v[236:239],a[148:151],v[24:27],v[236:239]
s_add_u32 s27,s27,3072
v_exp_f32 v77,v77
v_mfma_f32_16x16x32_bf16 v[232:235],a[144:147],v[24:27],v[232:235]
s_waitcnt vmcnt(13)
v_cvt_pk_bf16_f32 v47,v78,v79
v_cvt_pk_bf16_f32 v46,v76,v77
v_mfma_f32_16x16x32_bf16 v[184:187],a[144:147],v[20:23],v[184:187]
s_barrier
v_mfma_f32_16x16x32_bf16 v[188:191],a[148:151],v[20:23],v[188:191]
s_add_u32 m0,s23,12288
ds_read_b128 a[136:139],v0 offset:0
v_fma_f32 v94,v94,s36,v15
v_mfma_f32_16x16x32_bf16 v[192:195],a[120:123],v[20:23],v[192:195]
ds_read_b128 a[140:143],v1 offset:0
v_fma_f32 v95,v95,s36,v15
v_mfma_f32_16x16x32_bf16 v[196:199],a[124:127],v[20:23],v[196:199]
ds_read_b128 a[144:147],v0 offset:128
v_fma_f32 v92,v92,s36,v15
v_mfma_f32_16x16x32_bf16 v[244:247],a[124:127],v[24:27],v[244:247]
ds_read_b128 a[148:151],v1 offset:128
v_fma_f32 v93,v93,s36,v15
v_mfma_f32_16x16x32_bf16 v[240:243],a[120:123],v[24:27],v[240:243]
v_exp_f32 v84,v84
v_mfma_f32_16x16x32_bf16 v[144:147],a[120:123],v[28:31],v[144:147]
buffer_load_dwordx4 v6,s[8:11],s21 offen offset:0 lds
v_mfma_f32_16x16x32_bf16 v[148:151],a[124:127],v[28:31],v[148:151]
v_exp_f32 v85,v85
v_mfma_f32_16x16x32_bf16 a[196:199],a[124:127],v[32:35],a[196:199]
v_exp_f32 v87,v87
v_mfma_f32_16x16x32_bf16 a[192:195],a[120:123],v[32:35],a[192:195]
v_exp_f32 v86,v86
v_mfma_f32_16x16x32_bf16 a[240:243],a[120:123],v[36:39],a[240:243]
ds_read_b128 a[120:123],v0 offset:256
v_cvt_pk_bf16_f32 v51,v86,v87
v_mfma_f32_16x16x32_bf16 a[244:247],a[124:127],v[36:39],a[244:247]
ds_read_b128 a[124:127],v1 offset:256
v_cvt_pk_bf16_f32 v50,v84,v85
v_mfma_f32_16x16x32_bf16 a[248:251],a[128:131],v[36:39],a[248:251]
v_exp_f32 v92,v92
v_smfmac_f32_16x16x64_bf16 v[60:63],a[152:155],v[44:51],v18
v_fma_f32 v103,v103,s36,v16
v_mfma_f32_16x16x32_bf16 a[252:255],a[132:135],v[36:39],a[252:255]
v_exp_f32 v93,v93
v_mfma_f32_16x16x32_bf16 a[204:207],a[132:135],v[32:35],a[204:207]
v_exp_f32 v94,v94
v_mfma_f32_16x16x32_bf16 a[200:203],a[128:131],v[32:35],a[200:203]
v_exp_f32 v95,v95
v_mfma_f32_16x16x32_bf16 v[152:155],a[128:131],v[28:31],v[152:155]
buffer_load_dwordx4 v7,s[8:11],s21 offen offset:1024 lds
v_mfma_f32_16x16x32_bf16 v[156:159],a[132:135],v[28:31],v[156:159]
v_cvt_pk_bf16_f32 v55,v94,v95
v_cvt_pk_bf16_f32 v54,v92,v93
v_mfma_f32_16x16x32_bf16 v[252:255],a[132:135],v[24:27],v[252:255]
v_exp_f32 v103,v103
v_mfma_f32_16x16x32_bf16 v[248:251],a[128:131],v[24:27],v[248:251]
v_fma_f32 v101,v101,s36,v16
v_fma_f32 v102,v102,s36,v16
v_mfma_f32_16x16x32_bf16 v[200:203],a[128:131],v[20:23],v[200:203]
ds_read_b128 a[128:131],v0 offset:6144
v_fma_f32 v100,v100,s36,v16
v_mfma_f32_16x16x32_bf16 v[204:207],a[132:135],v[20:23],v[204:207]
s_waitcnt lgkmcnt(1)
ds_read_b128 a[132:135],v1 offset:6144
v_fma_f32 v109,v109,s36,v17
v_mfma_f32_16x16x32_bf16 v[72:75],a[136:139],a[0:3],0
v_exp_f32 v100,v100
v_mfma_f32_16x16x32_bf16 v[72:75],a[140:143],a[4:7],v[72:75]
v_exp_f32 v101,v101
v_mfma_f32_16x16x32_bf16 v[72:75],a[144:147],a[8:11],v[72:75]
v_exp_f32 v102,v102
v_mfma_f32_16x16x32_bf16 v[72:75],a[148:151],a[12:15],v[72:75]
v_cvt_pk_bf16_f32 v59,v102,v103
v_cvt_pk_bf16_f32 v58,v100,v101
v_mfma_f32_16x16x32_bf16 v[72:75],a[120:123],a[16:19],v[72:75]
v_exp_f32 v109,v109
v_smfmac_f32_16x16x64_bf16 v[64:67],a[152:155],v[52:59],v18
v_fma_f32 v110,v110,s36,v17
v_mfma_f32_16x16x32_bf16 v[72:75],a[124:127],a[20:23],v[72:75]
buffer_load_dwordx4 v8,s[8:11],s21 offen offset:2048 lds
v_mfma_f32_16x16x32_bf16 v[80:83],a[124:127],a[44:47],0
s_add_u32 s21,s21,12288
v_exp_f32 v110,v110
v_mfma_f32_16x16x32_bf16 v[80:83],a[120:123],a[40:43],v[80:83]
s_add_u32 m0,s22,24576
v_fma_f32 v111,v111,s36,v17
v_fma_f32 v108,v108,s36,v17
v_mfma_f32_16x16x32_bf16 v[80:83],a[148:151],a[36:39],v[80:83]
v_exp_f32 v111,v111
v_mfma_f32_16x16x32_bf16 v[80:83],a[144:147],a[32:35],v[80:83]
v_exp_f32 v108,v108
v_mfma_f32_16x16x32_bf16 v[80:83],a[140:143],a[28:31],v[80:83]
v_cvt_pk_bf16_f32 v42,v108,v109
v_cvt_pk_bf16_f32 v43,v110,v111
v_mfma_f32_16x16x32_bf16 v[80:83],a[136:139],a[24:27],v[80:83]
v_fma_f32 v73,v73,s36,v13
v_fma_f32 v72,v72,s36,v13
v_smfmac_f32_16x16x64_bf16 v[68:71],a[152:155],v[36:43],v18
v_fma_f32 v74,v74,s36,v13
v_mfma_f32_16x16x32_bf16 v[88:91],a[136:139],a[48:51],0
v_exp_f32 v72,v72
v_mfma_f32_16x16x32_bf16 v[88:91],a[140:143],a[52:55],v[88:91]
v_exp_f32 v74,v74
v_mfma_f32_16x16x32_bf16 v[88:91],a[144:147],a[56:59],v[88:91]
v_exp_f32 v73,v73
v_mfma_f32_16x16x32_bf16 v[88:91],a[148:151],a[60:63],v[88:91]
v_fma_f32 v82,v82,s36,v14
v_fma_f32 v81,v81,s36,v14
v_mfma_f32_16x16x32_bf16 v[88:91],a[120:123],a[64:67],v[88:91]
buffer_load_dwordx4 v6,s[4:7],s20 offen offset:0 lds
v_mfma_f32_16x16x32_bf16 v[88:91],a[124:127],a[68:71],v[88:91]
v_exp_f32 v82,v82
v_mfma_f32_16x16x32_bf16 v[96:99],a[124:127],a[92:95],0
v_exp_f32 v81,v81
v_mfma_f32_16x16x32_bf16 v[96:99],a[120:123],a[88:91],v[96:99]
v_fma_f32 v80,v80,s36,v14
v_fma_f32 v75,v75,s36,v13
v_mfma_f32_16x16x32_bf16 v[96:99],a[148:151],a[84:87],v[96:99]
v_exp_f32 v75,v75
v_mfma_f32_16x16x32_bf16 v[96:99],a[144:147],a[80:83],v[96:99]
v_exp_f32 v80,v80
v_mfma_f32_16x16x32_bf16 v[96:99],a[140:143],a[76:79],v[96:99]
v_fma_f32 v83,v83,s36,v14
v_fma_f32 v88,v88,s36,v15
v_mfma_f32_16x16x32_bf16 v[96:99],a[136:139],a[72:75],v[96:99]
v_exp_f32 v83,v83
v_mfma_f32_16x16x32_bf16 v[104:107],a[136:139],a[96:99],0
ds_read_b128 a[136:139],v0 offset:6272
v_fma_f32 v89,v89,s36,v15
v_mfma_f32_16x16x32_bf16 v[104:107],a[140:143],a[100:103],v[104:107]
ds_read_b128 a[140:143],v1 offset:6272
v_cvt_pk_bf16_f32 v20,v72,v73
v_mfma_f32_16x16x32_bf16 v[104:107],a[144:147],a[104:107],v[104:107]
ds_read_b128 a[144:147],v0 offset:6400
v_cvt_pk_bf16_f32 v24,v80,v81
v_mfma_f32_16x16x32_bf16 v[104:107],a[148:151],a[108:111],v[104:107]
buffer_load_dwordx4 v7,s[4:7],s20 offen offset:1024 lds
v_mfma_f32_16x16x32_bf16 v[104:107],a[120:123],a[112:115],v[104:107]
ds_read_b128 a[148:151],v1 offset:6400
v_cvt_pk_bf16_f32 v25,v82,v83
v_mfma_f32_16x16x32_bf16 v[104:107],a[124:127],a[116:119],v[104:107]
s_waitcnt lgkmcnt(4)
v_exp_f32 v88,v88
v_mfma_f32_16x16x32_bf16 v[76:79],a[128:131],a[0:3],0
v_exp_f32 v89,v89
v_mfma_f32_16x16x32_bf16 v[76:79],a[132:135],a[4:7],v[76:79]
s_waitcnt lgkmcnt(3)
v_cvt_pk_bf16_f32 v28,v88,v89
v_cvt_pk_bf16_f32 v21,v74,v75
v_mfma_f32_16x16x32_bf16 v[76:79],a[136:139],a[8:11],v[76:79]
s_waitcnt lgkmcnt(2)
v_mfma_f32_16x16x32_bf16 v[76:79],a[140:143],a[12:15],v[76:79]
s_waitcnt lgkmcnt(1)
v_mfma_f32_16x16x32_bf16 v[76:79],a[144:147],a[16:19],v[76:79]
s_waitcnt lgkmcnt(0)
v_mfma_f32_16x16x32_bf16 v[76:79],a[148:151],a[20:23],v[76:79]
v_mfma_f32_16x16x32_bf16 v[84:87],a[148:151],a[44:47],0
v_mfma_f32_16x16x32_bf16 v[84:87],a[144:147],a[40:43],v[84:87]
v_mfma_f32_16x16x32_bf16 v[84:87],a[140:143],a[36:39],v[84:87]
buffer_load_dwordx4 v8,s[4:7],s20 offen offset:2048 lds
v_mfma_f32_16x16x32_bf16 v[84:87],a[136:139],a[32:35],v[84:87]
s_add_u32 s20,s20,12288
v_mfma_f32_16x16x32_bf16 v[84:87],a[132:135],a[28:31],v[84:87]
v_mfma_f32_16x16x32_bf16 v[84:87],a[128:131],a[24:27],v[84:87]
v_mfma_f32_16x16x32_bf16 v[92:95],a[128:131],a[48:51],0
v_mfma_f32_16x16x32_bf16 v[92:95],a[132:135],a[52:55],v[92:95]
v_mfma_f32_16x16x32_bf16 v[92:95],a[136:139],a[56:59],v[92:95]
ds_read_b64_tr_b16 a[122:123],v2 offset:30720
v_mfma_f32_16x16x32_bf16 v[92:95],a[140:143],a[60:63],v[92:95]
ds_read_b64_tr_b16 a[120:121],v2 offset:24576
v_mfma_f32_16x16x32_bf16 v[92:95],a[144:147],a[64:67],v[92:95]
ds_read_b64_tr_b16 a[124:125],v3 offset:24576
v_mfma_f32_16x16x32_bf16 v[92:95],a[148:151],a[68:71],v[92:95]
ds_read_b64_tr_b16 a[126:127],v3 offset:30720
v_mfma_f32_16x16x32_bf16 v[100:103],a[148:151],a[92:95],0
v_mfma_f32_16x16x32_bf16 v[100:103],a[144:147],a[88:91],v[100:103]
v_mfma_f32_16x16x32_bf16 v[100:103],a[140:143],a[84:87],v[100:103]
v_mfma_f32_16x16x32_bf16 v[100:103],a[136:139],a[80:83],v[100:103]
v_mfma_f32_16x16x32_bf16 v[100:103],a[132:135],a[76:79],v[100:103]
v_mfma_f32_16x16x32_bf16 v[100:103],a[128:131],a[72:75],v[100:103]
v_mfma_f32_16x16x32_bf16 v[108:111],a[128:131],a[96:99],0
ds_read_b64_tr_b16 a[128:129],v4 offset:24576
v_mfma_f32_16x16x32_bf16 v[108:111],a[132:135],a[100:103],v[108:111]
ds_read_b64_tr_b16 a[130:131],v4 offset:30720
v_mfma_f32_16x16x32_bf16 v[108:111],a[136:139],a[104:107],v[108:111]
ds_read_b64_tr_b16 a[132:133],v5 offset:24576
v_mfma_f32_16x16x32_bf16 v[108:111],a[140:143],a[108:111],v[108:111]
ds_read_b64_tr_b16 a[134:135],v5 offset:30720
v_mfma_f32_16x16x32_bf16 v[108:111],a[144:147],a[112:115],v[108:111]
v_mfma_f32_16x16x32_bf16 v[108:111],a[148:151],a[116:119],v[108:111]
s_waitcnt lgkmcnt(4)
v_mfma_f32_16x16x32_bf16 v[160:163],a[120:123],v[44:47],v[160:163]
s_add_u32 m0,s29,0
ds_read_b64_tr_b16 a[136:137],v2 offset:24704
v_fma_f32 v90,v90,s36,v15
v_mfma_f32_16x16x32_bf16 v[164:167],a[124:127],v[44:47],v[164:167]
ds_read_b64_tr_b16 a[138:139],v2 offset:30848
v_fma_f32 v91,v91,s36,v15
v_mfma_f32_16x16x32_bf16 v[212:215],a[124:127],v[48:51],v[212:215]
ds_read_b64_tr_b16 a[140:141],v3 offset:24704
v_fma_f32 v96,v96,s36,v16
v_mfma_f32_16x16x32_bf16 v[208:211],a[120:123],v[48:51],v[208:211]
ds_read_b64_tr_b16 a[142:143],v3 offset:30848
v_fma_f32 v97,v97,s36,v16
v_mfma_f32_16x16x32_bf16 v[112:115],a[120:123],v[52:55],v[112:115]
ds_read_b64_tr_b16 a[144:145],v4 offset:24704
v_fma_f32 v98,v98,s36,v16
v_mfma_f32_16x16x32_bf16 v[116:119],a[124:127],v[52:55],v[116:119]
ds_read_b64_tr_b16 a[146:147],v4 offset:30848
v_fma_f32 v99,v99,s36,v16
v_mfma_f32_16x16x32_bf16 a[164:167],a[124:127],v[56:59],a[164:167]
ds_read_b64_tr_b16 a[148:149],v5 offset:24704
v_fma_f32 v104,v104,s36,v17
v_mfma_f32_16x16x32_bf16 a[160:163],a[120:123],v[56:59],a[160:163]
buffer_load_dwordx4 v6,s[12:15],s28 offen offset:0 nt lds
v_mfma_f32_16x16x32_bf16 a[208:211],a[120:123],v[40:43],a[208:211]
ds_read_b64_tr_b16 a[150:151],v5 offset:30848
v_fma_f32 v105,v105,s36,v17
v_mfma_f32_16x16x32_bf16 a[212:215],a[124:127],v[40:43],a[212:215]
s_waitcnt lgkmcnt(5)
ds_read_b64_tr_b16 a[120:121],v2 offset:24832
v_fma_f32 v106,v106,s36,v17
v_mfma_f32_16x16x32_bf16 a[216:219],a[128:131],v[40:43],a[216:219]
ds_read_b64_tr_b16 a[122:123],v2 offset:30976
v_fma_f32 v107,v107,s36,v17
v_mfma_f32_16x16x32_bf16 a[220:223],a[132:135],v[40:43],a[220:223]
ds_read_b64_tr_b16 a[124:125],v3 offset:24832
v_fma_f32 v76,v76,s36,v13
v_mfma_f32_16x16x32_bf16 a[172:175],a[132:135],v[56:59],a[172:175]
ds_read_b64_tr_b16 a[126:127],v3 offset:30976
v_fma_f32 v77,v77,s36,v13
v_mfma_f32_16x16x32_bf16 a[168:171],a[128:131],v[56:59],a[168:171]
v_exp_f32 v90,v90
v_mfma_f32_16x16x32_bf16 v[120:123],a[128:131],v[52:55],v[120:123]
v_exp_f32 v91,v91
v_mfma_f32_16x16x32_bf16 v[124:127],a[132:135],v[52:55],v[124:127]
v_cvt_pk_bf16_f32 v29,v90,v91
v_fma_f32 v78,v78,s36,v13
v_mfma_f32_16x16x32_bf16 v[220:223],a[132:135],v[48:51],v[220:223]
v_exp_f32 v96,v96
v_mfma_f32_16x16x32_bf16 v[216:219],a[128:131],v[48:51],v[216:219]
buffer_load_dwordx4 v7,s[12:15],s28 offen offset:1024 nt lds
v_mfma_f32_16x16x32_bf16 v[168:171],a[128:131],v[44:47],v[168:171]
ds_read_b64_tr_b16 a[128:129],v4 offset:24832
v_fma_f32 v79,v79,s36,v13
v_mfma_f32_16x16x32_bf16 v[172:175],a[132:135],v[44:47],v[172:175]
ds_read_b64_tr_b16 a[130:131],v4 offset:30976
v_fma_f32 v84,v84,s36,v14
v_mfma_f32_16x16x32_bf16 v[176:179],a[136:139],v[44:47],v[176:179]
s_waitcnt lgkmcnt(2)
ds_read_b64_tr_b16 a[132:133],v5 offset:24832
v_fma_f32 v85,v85,s36,v14
v_mfma_f32_16x16x32_bf16 v[180:183],a[140:143],v[44:47],v[180:183]
ds_read_b64_tr_b16 a[134:135],v5 offset:30976
v_fma_f32 v86,v86,s36,v14
v_mfma_f32_16x16x32_bf16 v[228:231],a[140:143],v[48:51],v[228:231]
v_exp_f32 v97,v97
v_mfma_f32_16x16x32_bf16 v[224:227],a[136:139],v[48:51],v[224:227]
v_exp_f32 v98,v98
v_mfma_f32_16x16x32_bf16 v[128:131],a[136:139],v[52:55],v[128:131]
v_exp_f32 v99,v99
v_mfma_f32_16x16x32_bf16 v[132:135],a[140:143],v[52:55],v[132:135]
v_cvt_pk_bf16_f32 v32,v96,v97
v_cvt_pk_bf16_f32 v33,v98,v99
v_mfma_f32_16x16x32_bf16 a[180:183],a[140:143],v[56:59],a[180:183]
v_exp_f32 v104,v104
v_mfma_f32_16x16x32_bf16 a[176:179],a[136:139],v[56:59],a[176:179]
buffer_load_dwordx4 v8,s[12:15],s28 offen offset:2048 nt lds
v_mfma_f32_16x16x32_bf16 a[224:227],a[136:139],v[40:43],a[224:227]
s_add_u32 s28,s28,3072
v_exp_f32 v105,v105
v_mfma_f32_16x16x32_bf16 a[228:231],a[140:143],v[40:43],a[228:231]
s_add_u32 s29,s29,3072
v_exp_f32 v106,v106
v_mfma_f32_16x16x32_bf16 a[232:235],a[144:147],v[40:43],a[232:235]
s_add_u32 m0,s23,24576
v_exp_f32 v107,v107
v_mfma_f32_16x16x32_bf16 a[236:239],a[148:151],v[40:43],a[236:239]
v_cvt_pk_bf16_f32 v36,v104,v105
v_cvt_pk_bf16_f32 v37,v106,v107
v_mfma_f32_16x16x32_bf16 a[188:191],a[148:151],v[56:59],a[188:191]
v_exp_f32 v76,v76
v_mfma_f32_16x16x32_bf16 a[184:187],a[144:147],v[56:59],a[184:187]
v_exp_f32 v77,v77
v_mfma_f32_16x16x32_bf16 v[136:139],a[144:147],v[52:55],v[136:139]
v_exp_f32 v78,v78
v_mfma_f32_16x16x32_bf16 v[140:143],a[148:151],v[52:55],v[140:143]
v_exp_f32 v79,v79
v_mfma_f32_16x16x32_bf16 v[236:239],a[148:151],v[48:51],v[236:239]
v_cvt_pk_bf16_f32 v22,v76,v77
v_cvt_pk_bf16_f32 v23,v78,v79
v_mfma_f32_16x16x32_bf16 v[232:235],a[144:147],v[48:51],v[232:235]
v_fma_f32 v87,v87,s36,v14
v_fma_f32 v92,v92,s36,v15
v_mfma_f32_16x16x32_bf16 v[184:187],a[144:147],v[44:47],v[184:187]
v_exp_f32 v84,v84
v_mfma_f32_16x16x32_bf16 v[188:191],a[148:151],v[44:47],v[188:191]
s_waitcnt vmcnt(13) lgkmcnt(0)
v_exp_f32 v85,v85
v_mfma_f32_16x16x32_bf16 v[192:195],a[120:123],v[44:47],v[192:195]
s_barrier
v_mfma_f32_16x16x32_bf16 v[196:199],a[124:127],v[44:47],v[196:199]
ds_read_b128 a[136:139],v0 offset:12288
v_cvt_pk_bf16_f32 v26,v84,v85
v_mfma_f32_16x16x32_bf16 v[244:247],a[124:127],v[48:51],v[244:247]
ds_read_b128 a[140:143],v1 offset:12288
v_fma_f32 v93,v93,s36,v15
v_mfma_f32_16x16x32_bf16 v[240:243],a[120:123],v[48:51],v[240:243]
ds_read_b128 a[144:147],v0 offset:12416
v_fma_f32 v94,v94,s36,v15
v_mfma_f32_16x16x32_bf16 v[144:147],a[120:123],v[52:55],v[144:147]
ds_read_b128 a[148:151],v1 offset:12416
v_fma_f32 v95,v95,s36,v15
v_mfma_f32_16x16x32_bf16 v[148:151],a[124:127],v[52:55],v[148:151]
v_exp_f32 v86,v86
v_mfma_f32_16x16x32_bf16 a[196:199],a[124:127],v[56:59],a[196:199]
buffer_load_dwordx4 v6,s[8:11],s21 offen offset:0 lds
v_mfma_f32_16x16x32_bf16 a[192:195],a[120:123],v[56:59],a[192:195]
v_exp_f32 v87,v87
v_mfma_f32_16x16x32_bf16 a[240:243],a[120:123],v[40:43],a[240:243]
ds_read_b128 a[120:123],v0 offset:12544
v_cvt_pk_bf16_f32 v27,v86,v87
v_mfma_f32_16x16x32_bf16 a[244:247],a[124:127],v[40:43],a[244:247]
ds_read_b128 a[124:127],v1 offset:12544
v_fma_f32 v100,v100,s36,v16
v_smfmac_f32_16x16x64_bf16 v[60:63],a[152:155],v[20:27],v18
v_fma_f32 v101,v101,s36,v16
v_mfma_f32_16x16x32_bf16 a[248:251],a[128:131],v[40:43],a[248:251]
v_exp_f32 v92,v92
v_mfma_f32_16x16x32_bf16 a[252:255],a[132:135],v[40:43],a[252:255]
v_exp_f32 v93,v93
v_mfma_f32_16x16x32_bf16 a[204:207],a[132:135],v[56:59],a[204:207]
v_exp_f32 v94,v94
v_mfma_f32_16x16x32_bf16 a[200:203],a[128:131],v[56:59],a[200:203]
v_exp_f32 v95,v95
v_mfma_f32_16x16x32_bf16 v[152:155],a[128:131],v[52:55],v[152:155]
v_cvt_pk_bf16_f32 v30,v92,v93
v_cvt_pk_bf16_f32 v31,v94,v95
v_mfma_f32_16x16x32_bf16 v[156:159],a[132:135],v[52:55],v[156:159]
v_fma_f32 v102,v102,s36,v16
v_fma_f32 v103,v103,s36,v16
v_mfma_f32_16x16x32_bf16 v[252:255],a[132:135],v[48:51],v[252:255]
v_exp_f32 v100,v100
v_mfma_f32_16x16x32_bf16 v[248:251],a[128:131],v[48:51],v[248:251]
buffer_load_dwordx4 v7,s[8:11],s21 offen offset:1024 lds
v_mfma_f32_16x16x32_bf16 v[200:203],a[128:131],v[44:47],v[200:203]
ds_read_b128 a[128:131],v0 offset:18432
v_fma_f32 v108,v108,s36,v17
v_mfma_f32_16x16x32_bf16 v[204:207],a[132:135],v[44:47],v[204:207]
s_waitcnt lgkmcnt(1)
ds_read_b128 a[132:135],v1 offset:18432
v_fma_f32 v109,v109,s36,v17
v_mfma_f32_16x16x32_bf16 v[72:75],a[136:139],a[0:3],0
v_exp_f32 v101,v101
v_mfma_f32_16x16x32_bf16 v[72:75],a[140:143],a[4:7],v[72:75]
v_exp_f32 v102,v102
v_mfma_f32_16x16x32_bf16 v[72:75],a[144:147],a[8:11],v[72:75]
v_exp_f32 v103,v103
v_mfma_f32_16x16x32_bf16 v[72:75],a[148:151],a[12:15],v[72:75]
v_cvt_pk_bf16_f32 v34,v100,v101
v_cvt_pk_bf16_f32 v35,v102,v103
v_mfma_f32_16x16x32_bf16 v[72:75],a[120:123],a[16:19],v[72:75]
v_fma_f32 v110,v110,s36,v17
v_fma_f32 v111,v111,s36,v17
v_smfmac_f32_16x16x64_bf16 v[64:67],a[152:155],v[28:35],v18
v_mfma_f32_16x16x32_bf16 v[72:75],a[124:127],a[20:23],v[72:75]
v_exp_f32 v108,v108
v_mfma_f32_16x16x32_bf16 v[80:83],a[124:127],a[44:47],0
v_exp_f32 v109,v109
v_mfma_f32_16x16x32_bf16 v[80:83],a[120:123],a[40:43],v[80:83]
buffer_load_dwordx4 v8,s[8:11],s21 offen offset:2048 lds
v_mfma_f32_16x16x32_bf16 v[80:83],a[148:151],a[36:39],v[80:83]
s_add_u32 s21,s21,12288
v_exp_f32 v110,v110
v_mfma_f32_16x16x32_bf16 v[80:83],a[144:147],a[32:35],v[80:83]
s_add_u32 m0,s22,0
v_exp_f32 v111,v111
v_mfma_f32_16x16x32_bf16 v[80:83],a[140:143],a[28:31],v[80:83]
v_cvt_pk_bf16_f32 v38,v108,v109
v_cvt_pk_bf16_f32 v39,v110,v111
v_mfma_f32_16x16x32_bf16 v[80:83],a[136:139],a[24:27],v[80:83]
v_fma_f32 v72,v72,s36,v13
v_fma_f32 v73,v73,s36,v13
v_mfma_f32_16x16x32_bf16 v[88:91],a[136:139],a[48:51],0
v_fma_f32 v74,v74,s36,v13
v_fma_f32 v75,v75,s36,v13
v_mfma_f32_16x16x32_bf16 v[88:91],a[140:143],a[52:55],v[88:91]
v_exp_f32 v72,v72
v_mfma_f32_16x16x32_bf16 v[88:91],a[144:147],a[56:59],v[88:91]
v_fma_f32 v80,v80,s36,v14
v_fma_f32 v81,v81,s36,v14
v_mfma_f32_16x16x32_bf16 v[88:91],a[148:151],a[60:63],v[88:91]
v_fma_f32 v82,v82,s36,v14
v_fma_f32 v83,v83,s36,v14
v_mfma_f32_16x16x32_bf16 v[88:91],a[120:123],a[64:67],v[88:91]
v_exp_f32 v73,v73
v_mfma_f32_16x16x32_bf16 v[88:91],a[124:127],a[68:71],v[88:91]
v_exp_f32 v74,v74
v_mfma_f32_16x16x32_bf16 v[96:99],a[124:127],a[92:95],0
v_exp_f32 v75,v75
v_mfma_f32_16x16x32_bf16 v[96:99],a[120:123],a[88:91],v[96:99]
buffer_load_dwordx4 v6,s[4:7],s20 offen offset:0 lds
v_mfma_f32_16x16x32_bf16 v[96:99],a[148:151],a[84:87],v[96:99]
v_exp_f32 v80,v80
v_mfma_f32_16x16x32_bf16 v[96:99],a[144:147],a[80:83],v[96:99]
v_fma_f32 v88,v88,s36,v15
v_fma_f32 v89,v89,s36,v15
v_mfma_f32_16x16x32_bf16 v[96:99],a[140:143],a[76:79],v[96:99]
v_exp_f32 v81,v81
v_mfma_f32_16x16x32_bf16 v[96:99],a[136:139],a[72:75],v[96:99]
v_exp_f32 v82,v82
v_mfma_f32_16x16x32_bf16 v[104:107],a[136:139],a[96:99],0
ds_read_b128 a[136:139],v0 offset:18560
v_cvt_pk_bf16_f32 v44,v72,v73
v_mfma_f32_16x16x32_bf16 v[104:107],a[140:143],a[100:103],v[104:107]
ds_read_b128 a[140:143],v1 offset:18560
v_cvt_pk_bf16_f32 v45,v74,v75
v_mfma_f32_16x16x32_bf16 v[104:107],a[144:147],a[104:107],v[104:107]
ds_read_b128 a[144:147],v0 offset:18688
v_cvt_pk_bf16_f32 v48,v80,v81
v_mfma_f32_16x16x32_bf16 v[104:107],a[148:151],a[108:111],v[104:107]
ds_read_b128 a[148:151],v1 offset:18688
v_mfma_f32_16x16x32_bf16 v[104:107],a[120:123],a[112:115],v[104:107]
v_exp_f32 v83,v83
v_mfma_f32_16x16x32_bf16 v[104:107],a[124:127],a[116:119],v[104:107]
s_waitcnt lgkmcnt(4)
v_exp_f32 v88,v88
v_mfma_f32_16x16x32_bf16 v[76:79],a[128:131],a[0:3],0
v_exp_f32 v89,v89
v_mfma_f32_16x16x32_bf16 v[76:79],a[132:135],a[4:7],v[76:79]
buffer_load_dwordx4 v7,s[4:7],s20 offen offset:1024 lds
s_waitcnt lgkmcnt(3)
v_mfma_f32_16x16x32_bf16 v[76:79],a[136:139],a[8:11],v[76:79]
s_waitcnt lgkmcnt(2)
v_cvt_pk_bf16_f32 v49,v82,v83
v_cvt_pk_bf16_f32 v52,v88,v89
v_mfma_f32_16x16x32_bf16 v[76:79],a[140:143],a[12:15],v[76:79]
s_waitcnt lgkmcnt(0)
v_mfma_f32_16x16x32_bf16 v[76:79],a[144:147],a[16:19],v[76:79]
v_mfma_f32_16x16x32_bf16 v[76:79],a[148:151],a[20:23],v[76:79]
v_mfma_f32_16x16x32_bf16 v[84:87],a[148:151],a[44:47],0
v_mfma_f32_16x16x32_bf16 v[84:87],a[144:147],a[40:43],v[84:87]
v_mfma_f32_16x16x32_bf16 v[84:87],a[140:143],a[36:39],v[84:87]
v_mfma_f32_16x16x32_bf16 v[84:87],a[136:139],a[32:35],v[84:87]
v_mfma_f32_16x16x32_bf16 v[84:87],a[132:135],a[28:31],v[84:87]
v_mfma_f32_16x16x32_bf16 v[84:87],a[128:131],a[24:27],v[84:87]
v_mfma_f32_16x16x32_bf16 v[92:95],a[128:131],a[48:51],0
buffer_load_dwordx4 v8,s[4:7],s20 offen offset:2048 lds
v_mfma_f32_16x16x32_bf16 v[92:95],a[132:135],a[52:55],v[92:95]
s_add_u32 s20,s20,12288
v_mfma_f32_16x16x32_bf16 v[92:95],a[136:139],a[56:59],v[92:95]
v_mfma_f32_16x16x32_bf16 v[92:95],a[140:143],a[60:63],v[92:95]
v_mfma_f32_16x16x32_bf16 v[92:95],a[144:147],a[64:67],v[92:95]
v_mfma_f32_16x16x32_bf16 v[92:95],a[148:151],a[68:71],v[92:95]
v_mfma_f32_16x16x32_bf16 v[100:103],a[148:151],a[92:95],0
ds_read_b64_tr_b16 a[120:121],v2 offset:0
v_mfma_f32_16x16x32_bf16 v[100:103],a[144:147],a[88:91],v[100:103]
ds_read_b64_tr_b16 a[122:123],v2 offset:6144
v_mfma_f32_16x16x32_bf16 v[100:103],a[140:143],a[84:87],v[100:103]
v_mfma_f32_16x16x32_bf16 v[100:103],a[136:139],a[80:83],v[100:103]
ds_read_b64_tr_b16 a[124:125],v3 offset:0
v_mfma_f32_16x16x32_bf16 v[100:103],a[132:135],a[76:79],v[100:103]
ds_read_b64_tr_b16 a[126:127],v3 offset:6144
v_mfma_f32_16x16x32_bf16 v[100:103],a[128:131],a[72:75],v[100:103]
v_mfma_f32_16x16x32_bf16 v[108:111],a[128:131],a[96:99],0
ds_read_b64_tr_b16 a[128:129],v4 offset:0
v_mfma_f32_16x16x32_bf16 v[108:111],a[132:135],a[100:103],v[108:111]
ds_read_b64_tr_b16 a[130:131],v4 offset:6144
v_mfma_f32_16x16x32_bf16 v[108:111],a[136:139],a[104:107],v[108:111]
ds_read_b64_tr_b16 a[132:133],v5 offset:0
v_mfma_f32_16x16x32_bf16 v[108:111],a[140:143],a[108:111],v[108:111]
ds_read_b64_tr_b16 a[134:135],v5 offset:6144
v_mfma_f32_16x16x32_bf16 v[108:111],a[144:147],a[112:115],v[108:111]
v_mfma_f32_16x16x32_bf16 v[108:111],a[148:151],a[116:119],v[108:111]
s_waitcnt lgkmcnt(4)
v_mfma_f32_16x16x32_bf16 v[160:163],a[120:123],v[20:23],v[160:163]
ds_read_b128 a[156:159],v10 offset:6144
v_fma_f32 v90,v90,s36,v15
v_mfma_f32_16x16x32_bf16 v[164:167],a[124:127],v[20:23],v[164:167]
ds_read_b64_tr_b16 a[136:137],v2 offset:128
v_fma_f32 v91,v91,s36,v15
v_mfma_f32_16x16x32_bf16 v[212:215],a[124:127],v[24:27],v[212:215]
ds_read_b64_tr_b16 a[138:139],v2 offset:6272
v_fma_f32 v96,v96,s36,v16
v_mfma_f32_16x16x32_bf16 v[208:211],a[120:123],v[24:27],v[208:211]
ds_read_b64_tr_b16 a[140:141],v3 offset:128
v_fma_f32 v97,v97,s36,v16
v_mfma_f32_16x16x32_bf16 v[112:115],a[120:123],v[28:31],v[112:115]
ds_read_b64_tr_b16 a[142:143],v3 offset:6272
v_fma_f32 v98,v98,s36,v16
v_mfma_f32_16x16x32_bf16 v[116:119],a[124:127],v[28:31],v[116:119]
ds_read_b64_tr_b16 a[144:145],v4 offset:128
v_fma_f32 v99,v99,s36,v16
v_mfma_f32_16x16x32_bf16 a[164:167],a[124:127],v[32:35],a[164:167]
ds_read_b64_tr_b16 a[146:147],v4 offset:6272
v_fma_f32 v104,v104,s36,v17
v_mfma_f32_16x16x32_bf16 a[160:163],a[120:123],v[32:35],a[160:163]
ds_read_b64_tr_b16 a[148:149],v5 offset:128
v_fma_f32 v105,v105,s36,v17
v_mfma_f32_16x16x32_bf16 a[208:211],a[120:123],v[36:39],a[208:211]
ds_read_b64_tr_b16 a[150:151],v5 offset:6272
v_fma_f32 v106,v106,s36,v17
v_mfma_f32_16x16x32_bf16 a[212:215],a[124:127],v[36:39],a[212:215]
s_waitcnt lgkmcnt(6)
ds_read_b64_tr_b16 a[120:121],v2 offset:256
v_fma_f32 v107,v107,s36,v17
v_mfma_f32_16x16x32_bf16 a[216:219],a[128:131],v[36:39],a[216:219]
ds_read_b64_tr_b16 a[122:123],v2 offset:6400
v_fma_f32 v76,v76,s36,v13
v_mfma_f32_16x16x32_bf16 a[220:223],a[132:135],v[36:39],a[220:223]
ds_read_b64_tr_b16 a[124:125],v3 offset:256
v_fma_f32 v77,v77,s36,v13
v_mfma_f32_16x16x32_bf16 a[172:175],a[132:135],v[32:35],a[172:175]
ds_read_b64_tr_b16 a[126:127],v3 offset:6400
v_fma_f32 v78,v78,s36,v13
v_mfma_f32_16x16x32_bf16 a[168:171],a[128:131],v[32:35],a[168:171]
v_exp_f32 v90,v90
v_mfma_f32_16x16x32_bf16 v[120:123],a[128:131],v[28:31],v[120:123]
v_exp_f32 v91,v91
v_mfma_f32_16x16x32_bf16 v[124:127],a[132:135],v[28:31],v[124:127]
v_cvt_pk_bf16_f32 v53,v90,v91
v_fma_f32 v79,v79,s36,v13
v_mfma_f32_16x16x32_bf16 v[220:223],a[132:135],v[24:27],v[220:223]
v_exp_f32 v96,v96
v_mfma_f32_16x16x32_bf16 v[216:219],a[128:131],v[24:27],v[216:219]
buffer_store_dwordx4 a[156:159],v9,s[16:19],s27 offen offset:0 nt
v_exp_f32 v97,v97
v_fma_f32 v84,v84,s36,v14
v_mfma_f32_16x16x32_bf16 v[168:171],a[128:131],v[20:23],v[168:171]
ds_read_b128 a[156:159],v10 offset:7168
v_cvt_pk_bf16_f32 v56,v96,v97
v_mfma_f32_16x16x32_bf16 v[172:175],a[132:135],v[20:23],v[172:175]
ds_read_b64_tr_b16 a[128:129],v4 offset:256
v_fma_f32 v85,v85,s36,v14
v_mfma_f32_16x16x32_bf16 v[176:179],a[136:139],v[20:23],v[176:179]
s_waitcnt lgkmcnt(2)
ds_read_b64_tr_b16 a[130:131],v4 offset:6400
v_fma_f32 v86,v86,s36,v14
v_mfma_f32_16x16x32_bf16 v[180:183],a[140:143],v[20:23],v[180:183]
ds_read_b64_tr_b16 a[132:133],v5 offset:256
v_fma_f32 v87,v87,s36,v14
v_mfma_f32_16x16x32_bf16 v[228:231],a[140:143],v[24:27],v[228:231]
ds_read_b64_tr_b16 a[134:135],v5 offset:6400
v_fma_f32 v92,v92,s36,v15
v_mfma_f32_16x16x32_bf16 v[224:227],a[136:139],v[24:27],v[224:227]
v_exp_f32 v98,v98
v_mfma_f32_16x16x32_bf16 v[128:131],a[136:139],v[28:31],v[128:131]
v_exp_f32 v99,v99
v_mfma_f32_16x16x32_bf16 v[132:135],a[140:143],v[28:31],v[132:135]
v_cvt_pk_bf16_f32 v57,v98,v99
v_fma_f32 v93,v93,s36,v15
v_mfma_f32_16x16x32_bf16 a[180:183],a[140:143],v[32:35],a[180:183]
s_waitcnt lgkmcnt(4)
buffer_store_dwordx4 a[156:159],v9,s[16:19],s27 offen offset:128 nt
v_exp_f32 v104,v104
v_fma_f32 v94,v94,s36,v15
v_mfma_f32_16x16x32_bf16 a[176:179],a[136:139],v[32:35],a[176:179]
ds_read_b128 a[156:159],v10 offset:8192
v_fma_f32 v95,v95,s36,v15
v_mfma_f32_16x16x32_bf16 a[224:227],a[136:139],v[36:39],a[224:227]
v_exp_f32 v105,v105
v_mfma_f32_16x16x32_bf16 a[228:231],a[140:143],v[36:39],a[228:231]
v_exp_f32 v106,v106
v_mfma_f32_16x16x32_bf16 a[232:235],a[144:147],v[36:39],a[232:235]
v_exp_f32 v107,v107
v_mfma_f32_16x16x32_bf16 a[236:239],a[148:151],v[36:39],a[236:239]
v_cvt_pk_bf16_f32 v40,v104,v105
v_cvt_pk_bf16_f32 v41,v106,v107
v_mfma_f32_16x16x32_bf16 a[188:191],a[148:151],v[32:35],a[188:191]
v_exp_f32 v76,v76
v_mfma_f32_16x16x32_bf16 a[184:187],a[144:147],v[32:35],a[184:187]
v_exp_f32 v77,v77
v_mfma_f32_16x16x32_bf16 v[136:139],a[144:147],v[28:31],v[136:139]
v_exp_f32 v78,v78
v_mfma_f32_16x16x32_bf16 v[140:143],a[148:151],v[28:31],v[140:143]
s_waitcnt lgkmcnt(0)
buffer_store_dwordx4 a[156:159],v9,s[16:19],s27 offen offset:256 nt
v_exp_f32 v79,v79
v_cvt_pk_bf16_f32 v46,v76,v77
v_mfma_f32_16x16x32_bf16 v[236:239],a[148:151],v[24:27],v[236:239]
s_add_u32 s27,s27,3072
v_cvt_pk_bf16_f32 v47,v78,v79
v_fma_f32 v100,v100,s36,v16
v_mfma_f32_16x16x32_bf16 v[232:235],a[144:147],v[24:27],v[232:235]
s_waitcnt vmcnt(12)
v_exp_f32 v84,v84
v_mfma_f32_16x16x32_bf16 v[184:187],a[144:147],v[20:23],v[184:187]
s_barrier
v_mfma_f32_16x16x32_bf16 v[188:191],a[148:151],v[20:23],v[188:191]
s_add_u32 m0,s23,0
ds_read_b128 a[136:139],v0 offset:24576
v_fma_f32 v101,v101,s36,v16
v_mfma_f32_16x16x32_bf16 v[192:195],a[120:123],v[20:23],v[192:195]
ds_read_b128 a[140:143],v1 offset:24576
v_fma_f32 v102,v102,s36,v16
v_mfma_f32_16x16x32_bf16 v[196:199],a[124:127],v[20:23],v[196:199]
ds_read_b128 a[144:147],v0 offset:24704
v_fma_f32 v103,v103,s36,v16
v_mfma_f32_16x16x32_bf16 v[244:247],a[124:127],v[24:27],v[244:247]
ds_read_b128 a[148:151],v1 offset:24704
v_fma_f32 v108,v108,s36,v17
v_mfma_f32_16x16x32_bf16 v[240:243],a[120:123],v[24:27],v[240:243]
v_exp_f32 v85,v85
v_mfma_f32_16x16x32_bf16 v[144:147],a[120:123],v[28:31],v[144:147]
buffer_load_dwordx4 v6,s[8:11],s21 offen offset:0 lds
v_mfma_f32_16x16x32_bf16 v[148:151],a[124:127],v[28:31],v[148:151]
v_exp_f32 v86,v86
v_mfma_f32_16x16x32_bf16 a[196:199],a[124:127],v[32:35],a[196:199]
v_exp_f32 v87,v87
v_mfma_f32_16x16x32_bf16 a[192:195],a[120:123],v[32:35],a[192:195]
v_cvt_pk_bf16_f32 v50,v84,v85
v_cvt_pk_bf16_f32 v51,v86,v87
v_mfma_f32_16x16x32_bf16 a[240:243],a[120:123],v[36:39],a[240:243]
ds_read_b128 a[120:123],v0 offset:24832
v_fma_f32 v109,v109,s36,v17
v_smfmac_f32_16x16x64_bf16 v[60:63],a[152:155],v[44:51],v18
v_fma_f32 v110,v110,s36,v17
v_mfma_f32_16x16x32_bf16 a[244:247],a[124:127],v[36:39],a[244:247]
ds_read_b128 a[124:127],v1 offset:24832
v_fma_f32 v111,v111,s36,v17
v_mfma_f32_16x16x32_bf16 a[248:251],a[128:131],v[36:39],a[248:251]
v_exp_f32 v92,v92
v_mfma_f32_16x16x32_bf16 a[252:255],a[132:135],v[36:39],a[252:255]
v_exp_f32 v93,v93
v_mfma_f32_16x16x32_bf16 a[204:207],a[132:135],v[32:35],a[204:207]
v_exp_f32 v94,v94
v_mfma_f32_16x16x32_bf16 a[200:203],a[128:131],v[32:35],a[200:203]
v_exp_f32 v95,v95
v_mfma_f32_16x16x32_bf16 v[152:155],a[128:131],v[28:31],v[152:155]
v_cvt_pk_bf16_f32 v54,v92,v93
v_cvt_pk_bf16_f32 v55,v94,v95
v_mfma_f32_16x16x32_bf16 v[156:159],a[132:135],v[28:31],v[156:159]
buffer_load_dwordx4 v7,s[8:11],s21 offen offset:1024 lds
v_mfma_f32_16x16x32_bf16 v[252:255],a[132:135],v[24:27],v[252:255]
v_exp_f32 v100,v100
v_mfma_f32_16x16x32_bf16 v[248:251],a[128:131],v[24:27],v[248:251]
v_exp_f32 v101,v101
v_mfma_f32_16x16x32_bf16 v[200:203],a[128:131],v[20:23],v[200:203]
ds_read_b128 a[128:131],v0 offset:30720
v_cvt_pk_bf16_f32 v58,v100,v101
v_mfma_f32_16x16x32_bf16 v[204:207],a[132:135],v[20:23],v[204:207]
s_waitcnt lgkmcnt(1)
ds_read_b128 a[132:135],v1 offset:30720
v_mfma_f32_16x16x32_bf16 v[72:75],a[136:139],a[0:3],0
v_exp_f32 v102,v102
v_mfma_f32_16x16x32_bf16 v[72:75],a[140:143],a[4:7],v[72:75]
v_exp_f32 v103,v103
v_mfma_f32_16x16x32_bf16 v[72:75],a[144:147],a[8:11],v[72:75]
v_cvt_pk_bf16_f32 v59,v102,v103
v_mfma_f32_16x16x32_bf16 v[72:75],a[148:151],a[12:15],v[72:75]
v_exp_f32 v108,v108
v_smfmac_f32_16x16x64_bf16 v[64:67],a[152:155],v[52:59],v18
v_mfma_f32_16x16x32_bf16 v[72:75],a[120:123],a[16:19],v[72:75]
v_exp_f32 v109,v109
v_mfma_f32_16x16x32_bf16 v[72:75],a[124:127],a[20:23],v[72:75]
buffer_load_dwordx4 v8,s[8:11],s21 offen offset:2048 lds
v_mfma_f32_16x16x32_bf16 v[80:83],a[124:127],a[44:47],0
s_add_u32 s21,s21,12288
v_exp_f32 v110,v110
v_mfma_f32_16x16x32_bf16 v[80:83],a[120:123],a[40:43],v[80:83]
s_cmp_eq_u32 s38,1
v_exp_f32 v111,v111
v_mfma_f32_16x16x32_bf16 v[80:83],a[148:151],a[36:39],v[80:83]
s_cselect_b32 s20,s26,s20
v_cvt_pk_bf16_f32 v42,v108,v109
v_cvt_pk_bf16_f32 v43,v110,v111
v_mfma_f32_16x16x32_bf16 v[80:83],a[144:147],a[32:35],v[80:83]
s_add_u32 m0,s22,12288
v_fma_f32 v72,v72,s36,v13
v_fma_f32 v73,v73,s36,v13
v_smfmac_f32_16x16x64_bf16 v[68:71],a[152:155],v[36:43],v18
v_fma_f32 v74,v74,s36,v13
v_mfma_f32_16x16x32_bf16 v[80:83],a[140:143],a[28:31],v[80:83]
v_fma_f32 v75,v75,s36,v13
v_mfma_f32_16x16x32_bf16 v[80:83],a[136:139],a[24:27],v[80:83]
v_exp_f32 v72,v72
v_mfma_f32_16x16x32_bf16 v[88:91],a[136:139],a[48:51],0
v_exp_f32 v73,v73
v_mfma_f32_16x16x32_bf16 v[88:91],a[140:143],a[52:55],v[88:91]
v_exp_f32 v74,v74
v_mfma_f32_16x16x32_bf16 v[88:91],a[144:147],a[56:59],v[88:91]
v_exp_f32 v75,v75
v_mfma_f32_16x16x32_bf16 v[88:91],a[148:151],a[60:63],v[88:91]
v_fma_f32 v80,v80,s36,v14
v_fma_f32 v81,v81,s36,v14
v_mfma_f32_16x16x32_bf16 v[88:91],a[120:123],a[64:67],v[88:91]
buffer_load_dwordx4 v6,s[4:7],s20 offen offset:0 lds
v_mfma_f32_16x16x32_bf16 v[88:91],a[124:127],a[68:71],v[88:91]
v_fma_f32 v82,v82,s36,v14
v_fma_f32 v83,v83,s36,v14
v_mfma_f32_16x16x32_bf16 v[96:99],a[124:127],a[92:95],0
v_exp_f32 v80,v80
v_mfma_f32_16x16x32_bf16 v[96:99],a[120:123],a[88:91],v[96:99]
v_exp_f32 v81,v81
v_mfma_f32_16x16x32_bf16 v[96:99],a[148:151],a[84:87],v[96:99]
v_exp_f32 v82,v82
v_mfma_f32_16x16x32_bf16 v[96:99],a[144:147],a[80:83],v[96:99]
v_fma_f32 v88,v88,s36,v15
v_fma_f32 v89,v89,s36,v15
v_mfma_f32_16x16x32_bf16 v[96:99],a[140:143],a[76:79],v[96:99]
v_exp_f32 v83,v83
v_mfma_f32_16x16x32_bf16 v[96:99],a[136:139],a[72:75],v[96:99]
v_exp_f32 v88,v88
v_mfma_f32_16x16x32_bf16 v[104:107],a[136:139],a[96:99],0
ds_read_b128 a[136:139],v0 offset:30848
v_cvt_pk_bf16_f32 v20,v72,v73
v_mfma_f32_16x16x32_bf16 v[104:107],a[140:143],a[100:103],v[104:107]
ds_read_b128 a[140:143],v1 offset:30848
v_cvt_pk_bf16_f32 v21,v74,v75
v_mfma_f32_16x16x32_bf16 v[104:107],a[144:147],a[104:107],v[104:107]
ds_read_b128 a[144:147],v0 offset:30976
v_cvt_pk_bf16_f32 v24,v80,v81
v_mfma_f32_16x16x32_bf16 v[104:107],a[148:151],a[108:111],v[104:107]
ds_read_b128 a[148:151],v1 offset:30976
v_cvt_pk_bf16_f32 v25,v82,v83
v_mfma_f32_16x16x32_bf16 v[104:107],a[120:123],a[112:115],v[104:107]
buffer_load_dwordx4 v7,s[4:7],s20 offen offset:1024 lds
v_mfma_f32_16x16x32_bf16 v[104:107],a[124:127],a[116:119],v[104:107]
s_waitcnt lgkmcnt(4)
v_exp_f32 v89,v89
v_mfma_f32_16x16x32_bf16 v[76:79],a[128:131],a[0:3],0
v_cvt_pk_bf16_f32 v28,v88,v89
v_mfma_f32_16x16x32_bf16 v[76:79],a[132:135],a[4:7],v[76:79]
s_waitcnt lgkmcnt(3)
v_mfma_f32_16x16x32_bf16 v[76:79],a[136:139],a[8:11],v[76:79]
s_waitcnt lgkmcnt(2)
v_mfma_f32_16x16x32_bf16 v[76:79],a[140:143],a[12:15],v[76:79]
s_waitcnt lgkmcnt(1)
v_mfma_f32_16x16x32_bf16 v[76:79],a[144:147],a[16:19],v[76:79]
s_waitcnt lgkmcnt(0)
v_mfma_f32_16x16x32_bf16 v[76:79],a[148:151],a[20:23],v[76:79]
v_mfma_f32_16x16x32_bf16 v[84:87],a[148:151],a[44:47],0
v_mfma_f32_16x16x32_bf16 v[84:87],a[144:147],a[40:43],v[84:87]
v_mfma_f32_16x16x32_bf16 v[84:87],a[140:143],a[36:39],v[84:87]
v_mfma_f32_16x16x32_bf16 v[84:87],a[136:139],a[32:35],v[84:87]
buffer_load_dwordx4 v8,s[4:7],s20 offen offset:2048 lds
v_mfma_f32_16x16x32_bf16 v[84:87],a[132:135],a[28:31],v[84:87]
s_add_u32 s20,s20,12288
v_mfma_f32_16x16x32_bf16 v[84:87],a[128:131],a[24:27],v[84:87]
v_mfma_f32_16x16x32_bf16 v[92:95],a[128:131],a[48:51],0
v_mfma_f32_16x16x32_bf16 v[92:95],a[132:135],a[52:55],v[92:95]
v_mfma_f32_16x16x32_bf16 v[92:95],a[136:139],a[56:59],v[92:95]
v_mfma_f32_16x16x32_bf16 v[92:95],a[140:143],a[60:63],v[92:95]
ds_read_b64_tr_b16 a[120:121],v2 offset:12288
v_mfma_f32_16x16x32_bf16 v[92:95],a[144:147],a[64:67],v[92:95]
ds_read_b64_tr_b16 a[122:123],v2 offset:18432
v_mfma_f32_16x16x32_bf16 v[92:95],a[148:151],a[68:71],v[92:95]
v_mfma_f32_16x16x32_bf16 v[100:103],a[148:151],a[92:95],0
ds_read_b64_tr_b16 a[124:125],v3 offset:12288
v_mfma_f32_16x16x32_bf16 v[100:103],a[144:147],a[88:91],v[100:103]
ds_read_b64_tr_b16 a[126:127],v3 offset:18432
v_mfma_f32_16x16x32_bf16 v[100:103],a[140:143],a[84:87],v[100:103]
v_mfma_f32_16x16x32_bf16 v[100:103],a[136:139],a[80:83],v[100:103]
v_mfma_f32_16x16x32_bf16 v[100:103],a[132:135],a[76:79],v[100:103]
v_mfma_f32_16x16x32_bf16 v[100:103],a[128:131],a[72:75],v[100:103]
v_mfma_f32_16x16x32_bf16 v[108:111],a[128:131],a[96:99],0
ds_read_b64_tr_b16 a[128:129],v4 offset:12288
v_mfma_f32_16x16x32_bf16 v[108:111],a[132:135],a[100:103],v[108:111]
ds_read_b64_tr_b16 a[130:131],v4 offset:18432
v_mfma_f32_16x16x32_bf16 v[108:111],a[136:139],a[104:107],v[108:111]
ds_read_b64_tr_b16 a[132:133],v5 offset:12288
v_mfma_f32_16x16x32_bf16 v[108:111],a[140:143],a[108:111],v[108:111]
ds_read_b64_tr_b16 a[134:135],v5 offset:18432
v_mfma_f32_16x16x32_bf16 v[108:111],a[144:147],a[112:115],v[108:111]
v_mfma_f32_16x16x32_bf16 v[108:111],a[148:151],a[116:119],v[108:111]
s_waitcnt lgkmcnt(4)
v_mfma_f32_16x16x32_bf16 v[160:163],a[120:123],v[44:47],v[160:163]
s_add_u32 m0,s29,0
ds_read_b64_tr_b16 a[136:137],v2 offset:12416
v_fma_f32 v90,v90,s36,v15
v_mfma_f32_16x16x32_bf16 v[164:167],a[124:127],v[44:47],v[164:167]
ds_read_b64_tr_b16 a[138:139],v2 offset:18560
v_fma_f32 v91,v91,s36,v15
v_mfma_f32_16x16x32_bf16 v[212:215],a[124:127],v[48:51],v[212:215]
ds_read_b64_tr_b16 a[140:141],v3 offset:12416
v_fma_f32 v96,v96,s36,v16
v_mfma_f32_16x16x32_bf16 v[208:211],a[120:123],v[48:51],v[208:211]
ds_read_b64_tr_b16 a[142:143],v3 offset:18560
v_fma_f32 v97,v97,s36,v16
v_mfma_f32_16x16x32_bf16 v[112:115],a[120:123],v[52:55],v[112:115]
ds_read_b64_tr_b16 a[144:145],v4 offset:12416
v_fma_f32 v98,v98,s36,v16
v_mfma_f32_16x16x32_bf16 v[116:119],a[124:127],v[52:55],v[116:119]
ds_read_b64_tr_b16 a[146:147],v4 offset:18560
v_fma_f32 v99,v99,s36,v16
v_mfma_f32_16x16x32_bf16 a[164:167],a[124:127],v[56:59],a[164:167]
ds_read_b64_tr_b16 a[148:149],v5 offset:12416
v_fma_f32 v104,v104,s36,v17
v_mfma_f32_16x16x32_bf16 a[160:163],a[120:123],v[56:59],a[160:163]
buffer_load_dwordx4 v6,s[12:15],s28 offen offset:0 nt lds
v_mfma_f32_16x16x32_bf16 a[208:211],a[120:123],v[40:43],a[208:211]
ds_read_b64_tr_b16 a[150:151],v5 offset:18560
v_fma_f32 v105,v105,s36,v17
v_mfma_f32_16x16x32_bf16 a[212:215],a[124:127],v[40:43],a[212:215]
s_waitcnt lgkmcnt(5)
ds_read_b64_tr_b16 a[120:121],v2 offset:12544
v_fma_f32 v106,v106,s36,v17
v_mfma_f32_16x16x32_bf16 a[216:219],a[128:131],v[40:43],a[216:219]
ds_read_b64_tr_b16 a[122:123],v2 offset:18688
v_fma_f32 v107,v107,s36,v17
v_mfma_f32_16x16x32_bf16 a[220:223],a[132:135],v[40:43],a[220:223]
ds_read_b64_tr_b16 a[124:125],v3 offset:12544
v_fma_f32 v76,v76,s36,v13
v_mfma_f32_16x16x32_bf16 a[172:175],a[132:135],v[56:59],a[172:175]
ds_read_b64_tr_b16 a[126:127],v3 offset:18688
v_fma_f32 v77,v77,s36,v13
v_mfma_f32_16x16x32_bf16 a[168:171],a[128:131],v[56:59],a[168:171]
v_exp_f32 v90,v90
v_mfma_f32_16x16x32_bf16 v[120:123],a[128:131],v[52:55],v[120:123]
v_exp_f32 v91,v91
v_mfma_f32_16x16x32_bf16 v[124:127],a[132:135],v[52:55],v[124:127]
v_cvt_pk_bf16_f32 v29,v90,v91
v_fma_f32 v78,v78,s36,v13
v_mfma_f32_16x16x32_bf16 v[220:223],a[132:135],v[48:51],v[220:223]
v_exp_f32 v96,v96
v_mfma_f32_16x16x32_bf16 v[216:219],a[128:131],v[48:51],v[216:219]
buffer_load_dwordx4 v7,s[12:15],s28 offen offset:1024 nt lds
v_mfma_f32_16x16x32_bf16 v[168:171],a[128:131],v[44:47],v[168:171]
ds_read_b64_tr_b16 a[128:129],v4 offset:12544
v_fma_f32 v79,v79,s36,v13
v_mfma_f32_16x16x32_bf16 v[172:175],a[132:135],v[44:47],v[172:175]
ds_read_b64_tr_b16 a[130:131],v4 offset:18688
v_fma_f32 v84,v84,s36,v14
v_mfma_f32_16x16x32_bf16 v[176:179],a[136:139],v[44:47],v[176:179]
s_waitcnt lgkmcnt(2)
ds_read_b64_tr_b16 a[132:133],v5 offset:12544
v_fma_f32 v85,v85,s36,v14
v_mfma_f32_16x16x32_bf16 v[180:183],a[140:143],v[44:47],v[180:183]
ds_read_b64_tr_b16 a[134:135],v5 offset:18688
v_fma_f32 v86,v86,s36,v14
v_mfma_f32_16x16x32_bf16 v[228:231],a[140:143],v[48:51],v[228:231]
v_exp_f32 v97,v97
v_mfma_f32_16x16x32_bf16 v[224:227],a[136:139],v[48:51],v[224:227]
v_exp_f32 v98,v98
v_mfma_f32_16x16x32_bf16 v[128:131],a[136:139],v[52:55],v[128:131]
v_exp_f32 v99,v99
v_mfma_f32_16x16x32_bf16 v[132:135],a[140:143],v[52:55],v[132:135]
v_cvt_pk_bf16_f32 v32,v96,v97
v_cvt_pk_bf16_f32 v33,v98,v99
v_mfma_f32_16x16x32_bf16 a[180:183],a[140:143],v[56:59],a[180:183]
v_exp_f32 v104,v104
v_mfma_f32_16x16x32_bf16 a[176:179],a[136:139],v[56:59],a[176:179]
buffer_load_dwordx4 v8,s[12:15],s28 offen offset:2048 nt lds
v_mfma_f32_16x16x32_bf16 a[224:227],a[136:139],v[40:43],a[224:227]
s_add_u32 s28,s28,3072
v_exp_f32 v105,v105
v_mfma_f32_16x16x32_bf16 a[228:231],a[140:143],v[40:43],a[228:231]
s_add_u32 s29,s29,3072
v_exp_f32 v106,v106
v_mfma_f32_16x16x32_bf16 a[232:235],a[144:147],v[40:43],a[232:235]
s_cmp_eq_u32 s38,1
v_exp_f32 v107,v107
v_mfma_f32_16x16x32_bf16 a[236:239],a[148:151],v[40:43],a[236:239]
s_cselect_b32 s21,s26,s21
v_cvt_pk_bf16_f32 v36,v104,v105
v_cvt_pk_bf16_f32 v37,v106,v107
v_mfma_f32_16x16x32_bf16 a[188:191],a[148:151],v[56:59],a[188:191]
s_add_u32 m0,s23,12288
v_exp_f32 v76,v76
v_mfma_f32_16x16x32_bf16 a[184:187],a[144:147],v[56:59],a[184:187]
v_exp_f32 v77,v77
v_mfma_f32_16x16x32_bf16 v[136:139],a[144:147],v[52:55],v[136:139]
v_exp_f32 v78,v78
v_mfma_f32_16x16x32_bf16 v[140:143],a[148:151],v[52:55],v[140:143]
v_exp_f32 v79,v79
v_mfma_f32_16x16x32_bf16 v[236:239],a[148:151],v[48:51],v[236:239]
v_cvt_pk_bf16_f32 v22,v76,v77
v_cvt_pk_bf16_f32 v23,v78,v79
v_mfma_f32_16x16x32_bf16 v[232:235],a[144:147],v[48:51],v[232:235]
v_fma_f32 v87,v87,s36,v14
v_fma_f32 v92,v92,s36,v15
v_mfma_f32_16x16x32_bf16 v[184:187],a[144:147],v[44:47],v[184:187]
v_exp_f32 v84,v84
v_mfma_f32_16x16x32_bf16 v[188:191],a[148:151],v[44:47],v[188:191]
s_waitcnt vmcnt(12) lgkmcnt(0)
v_exp_f32 v85,v85
v_mfma_f32_16x16x32_bf16 v[192:195],a[120:123],v[44:47],v[192:195]
s_barrier
v_mfma_f32_16x16x32_bf16 v[196:199],a[124:127],v[44:47],v[196:199]
ds_read_b128 a[136:139],v0 offset:0
v_cvt_pk_bf16_f32 v26,v84,v85
v_mfma_f32_16x16x32_bf16 v[244:247],a[124:127],v[48:51],v[244:247]
ds_read_b128 a[140:143],v1 offset:0
v_fma_f32 v93,v93,s36,v15
v_mfma_f32_16x16x32_bf16 v[240:243],a[120:123],v[48:51],v[240:243]
ds_read_b128 a[144:147],v0 offset:128
v_fma_f32 v94,v94,s36,v15
v_mfma_f32_16x16x32_bf16 v[144:147],a[120:123],v[52:55],v[144:147]
ds_read_b128 a[148:151],v1 offset:128
v_fma_f32 v95,v95,s36,v15
v_mfma_f32_16x16x32_bf16 v[148:151],a[124:127],v[52:55],v[148:151]
v_exp_f32 v86,v86
v_mfma_f32_16x16x32_bf16 a[196:199],a[124:127],v[56:59],a[196:199]
buffer_load_dwordx4 v6,s[8:11],s21 offen offset:0 lds
v_mfma_f32_16x16x32_bf16 a[192:195],a[120:123],v[56:59],a[192:195]
v_exp_f32 v87,v87
v_mfma_f32_16x16x32_bf16 a[240:243],a[120:123],v[40:43],a[240:243]
ds_read_b128 a[120:123],v0 offset:256
v_cvt_pk_bf16_f32 v27,v86,v87
v_mfma_f32_16x16x32_bf16 a[244:247],a[124:127],v[40:43],a[244:247]
ds_read_b128 a[124:127],v1 offset:256
v_fma_f32 v100,v100,s36,v16
v_smfmac_f32_16x16x64_bf16 v[60:63],a[152:155],v[20:27],v18
v_fma_f32 v101,v101,s36,v16
v_mfma_f32_16x16x32_bf16 a[248:251],a[128:131],v[40:43],a[248:251]
v_exp_f32 v92,v92
v_mfma_f32_16x16x32_bf16 a[252:255],a[132:135],v[40:43],a[252:255]
v_exp_f32 v93,v93
v_mfma_f32_16x16x32_bf16 a[204:207],a[132:135],v[56:59],a[204:207]
v_exp_f32 v94,v94
v_mfma_f32_16x16x32_bf16 a[200:203],a[128:131],v[56:59],a[200:203]
v_exp_f32 v95,v95
v_mfma_f32_16x16x32_bf16 v[152:155],a[128:131],v[52:55],v[152:155]
v_cvt_pk_bf16_f32 v30,v92,v93
v_cvt_pk_bf16_f32 v31,v94,v95
v_mfma_f32_16x16x32_bf16 v[156:159],a[132:135],v[52:55],v[156:159]
v_fma_f32 v102,v102,s36,v16
v_fma_f32 v103,v103,s36,v16
v_mfma_f32_16x16x32_bf16 v[252:255],a[132:135],v[48:51],v[252:255]
v_exp_f32 v100,v100
v_mfma_f32_16x16x32_bf16 v[248:251],a[128:131],v[48:51],v[248:251]
buffer_load_dwordx4 v7,s[8:11],s21 offen offset:1024 lds
v_mfma_f32_16x16x32_bf16 v[200:203],a[128:131],v[44:47],v[200:203]
ds_read_b128 a[128:131],v0 offset:6144
v_fma_f32 v108,v108,s36,v17
v_mfma_f32_16x16x32_bf16 v[204:207],a[132:135],v[44:47],v[204:207]
s_waitcnt lgkmcnt(1)
ds_read_b128 a[132:135],v1 offset:6144
v_fma_f32 v109,v109,s36,v17
v_mfma_f32_16x16x32_bf16 v[72:75],a[136:139],a[0:3],0
v_exp_f32 v101,v101
v_mfma_f32_16x16x32_bf16 v[72:75],a[140:143],a[4:7],v[72:75]
v_exp_f32 v102,v102
v_mfma_f32_16x16x32_bf16 v[72:75],a[144:147],a[8:11],v[72:75]
v_exp_f32 v103,v103
v_mfma_f32_16x16x32_bf16 v[72:75],a[148:151],a[12:15],v[72:75]
v_cvt_pk_bf16_f32 v34,v100,v101
v_cvt_pk_bf16_f32 v35,v102,v103
v_mfma_f32_16x16x32_bf16 v[72:75],a[120:123],a[16:19],v[72:75]
v_fma_f32 v110,v110,s36,v17
v_fma_f32 v111,v111,s36,v17
v_smfmac_f32_16x16x64_bf16 v[64:67],a[152:155],v[28:35],v18
v_add_u32 v10,9216,v10
v_mfma_f32_16x16x32_bf16 v[72:75],a[124:127],a[20:23],v[72:75]
v_exp_f32 v108,v108
v_mfma_f32_16x16x32_bf16 v[80:83],a[124:127],a[44:47],0
v_exp_f32 v109,v109
v_mfma_f32_16x16x32_bf16 v[80:83],a[120:123],a[40:43],v[80:83]
buffer_load_dwordx4 v8,s[8:11],s21 offen offset:2048 lds
v_mfma_f32_16x16x32_bf16 v[80:83],a[148:151],a[36:39],v[80:83]
s_add_u32 s21,s21,12288
v_exp_f32 v110,v110
v_mfma_f32_16x16x32_bf16 v[80:83],a[144:147],a[32:35],v[80:83]
s_add_u32 m0,s22,24576
v_exp_f32 v111,v111
v_mfma_f32_16x16x32_bf16 v[80:83],a[140:143],a[28:31],v[80:83]
v_cvt_pk_bf16_f32 v38,v108,v109
v_cvt_pk_bf16_f32 v39,v110,v111
v_mfma_f32_16x16x32_bf16 v[80:83],a[136:139],a[24:27],v[80:83]
v_fma_f32 v72,v72,s36,v13
v_fma_f32 v73,v73,s36,v13
v_mfma_f32_16x16x32_bf16 v[88:91],a[136:139],a[48:51],0
v_fma_f32 v74,v74,s36,v13
v_fma_f32 v75,v75,s36,v13
v_mfma_f32_16x16x32_bf16 v[88:91],a[140:143],a[52:55],v[88:91]
v_exp_f32 v72,v72
v_mfma_f32_16x16x32_bf16 v[88:91],a[144:147],a[56:59],v[88:91]
v_fma_f32 v80,v80,s36,v14
v_fma_f32 v81,v81,s36,v14
v_mfma_f32_16x16x32_bf16 v[88:91],a[148:151],a[60:63],v[88:91]
v_fma_f32 v82,v82,s36,v14
v_fma_f32 v83,v83,s36,v14
v_mfma_f32_16x16x32_bf16 v[88:91],a[120:123],a[64:67],v[88:91]
v_exp_f32 v73,v73
v_mfma_f32_16x16x32_bf16 v[88:91],a[124:127],a[68:71],v[88:91]
v_exp_f32 v74,v74
v_mfma_f32_16x16x32_bf16 v[96:99],a[124:127],a[92:95],0
v_exp_f32 v75,v75
v_mfma_f32_16x16x32_bf16 v[96:99],a[120:123],a[88:91],v[96:99]
buffer_load_dwordx4 v6,s[4:7],s20 offen offset:0 lds
v_mfma_f32_16x16x32_bf16 v[96:99],a[148:151],a[84:87],v[96:99]
v_exp_f32 v80,v80
v_mfma_f32_16x16x32_bf16 v[96:99],a[144:147],a[80:83],v[96:99]
v_fma_f32 v88,v88,s36,v15
v_fma_f32 v89,v89,s36,v15
v_mfma_f32_16x16x32_bf16 v[96:99],a[140:143],a[76:79],v[96:99]
v_exp_f32 v81,v81
v_mfma_f32_16x16x32_bf16 v[96:99],a[136:139],a[72:75],v[96:99]
v_exp_f32 v82,v82
v_mfma_f32_16x16x32_bf16 v[104:107],a[136:139],a[96:99],0
ds_read_b128 a[136:139],v0 offset:6272
v_cvt_pk_bf16_f32 v44,v72,v73
v_mfma_f32_16x16x32_bf16 v[104:107],a[140:143],a[100:103],v[104:107]
ds_read_b128 a[140:143],v1 offset:6272
v_cvt_pk_bf16_f32 v45,v74,v75
v_mfma_f32_16x16x32_bf16 v[104:107],a[144:147],a[104:107],v[104:107]
ds_read_b128 a[144:147],v0 offset:6400
v_cvt_pk_bf16_f32 v48,v80,v81
v_mfma_f32_16x16x32_bf16 v[104:107],a[148:151],a[108:111],v[104:107]
ds_read_b128 a[148:151],v1 offset:6400
v_mfma_f32_16x16x32_bf16 v[104:107],a[120:123],a[112:115],v[104:107]
v_exp_f32 v83,v83
v_mfma_f32_16x16x32_bf16 v[104:107],a[124:127],a[116:119],v[104:107]
s_waitcnt lgkmcnt(4)
v_exp_f32 v88,v88
v_mfma_f32_16x16x32_bf16 v[76:79],a[128:131],a[0:3],0
v_exp_f32 v89,v89
v_mfma_f32_16x16x32_bf16 v[76:79],a[132:135],a[4:7],v[76:79]
buffer_load_dwordx4 v7,s[4:7],s20 offen offset:1024 lds
s_waitcnt lgkmcnt(3)
v_mfma_f32_16x16x32_bf16 v[76:79],a[136:139],a[8:11],v[76:79]
s_waitcnt lgkmcnt(2)
v_cvt_pk_bf16_f32 v49,v82,v83
v_cvt_pk_bf16_f32 v52,v88,v89
v_mfma_f32_16x16x32_bf16 v[76:79],a[140:143],a[12:15],v[76:79]
s_waitcnt lgkmcnt(0)
v_mfma_f32_16x16x32_bf16 v[76:79],a[144:147],a[16:19],v[76:79]
v_mfma_f32_16x16x32_bf16 v[76:79],a[148:151],a[20:23],v[76:79]
v_mfma_f32_16x16x32_bf16 v[84:87],a[148:151],a[44:47],0
v_mfma_f32_16x16x32_bf16 v[84:87],a[144:147],a[40:43],v[84:87]
v_mfma_f32_16x16x32_bf16 v[84:87],a[140:143],a[36:39],v[84:87]
v_mfma_f32_16x16x32_bf16 v[84:87],a[136:139],a[32:35],v[84:87]
v_mfma_f32_16x16x32_bf16 v[84:87],a[132:135],a[28:31],v[84:87]
v_mfma_f32_16x16x32_bf16 v[84:87],a[128:131],a[24:27],v[84:87]
v_mfma_f32_16x16x32_bf16 v[92:95],a[128:131],a[48:51],0
buffer_load_dwordx4 v8,s[4:7],s20 offen offset:2048 lds
v_mfma_f32_16x16x32_bf16 v[92:95],a[132:135],a[52:55],v[92:95]
s_add_u32 s20,s20,12288
s_add_u32 s38,s38,1
s_cmp_lt_u32 s38,2
v_mfma_f32_16x16x32_bf16 v[92:95],a[136:139],a[56:59],v[92:95]
v_mfma_f32_16x16x32_bf16 v[92:95],a[140:143],a[60:63],v[92:95]
v_mfma_f32_16x16x32_bf16 v[92:95],a[144:147],a[64:67],v[92:95]
v_mfma_f32_16x16x32_bf16 v[92:95],a[148:151],a[68:71],v[92:95]
v_mfma_f32_16x16x32_bf16 v[100:103],a[148:151],a[92:95],0
ds_read_b64_tr_b16 a[120:121],v2 offset:24576
v_mfma_f32_16x16x32_bf16 v[100:103],a[144:147],a[88:91],v[100:103]
ds_read_b64_tr_b16 a[122:123],v2 offset:30720
v_mfma_f32_16x16x32_bf16 v[100:103],a[140:143],a[84:87],v[100:103]
v_mfma_f32_16x16x32_bf16 v[100:103],a[136:139],a[80:83],v[100:103]
ds_read_b64_tr_b16 a[124:125],v3 offset:24576
v_mfma_f32_16x16x32_bf16 v[100:103],a[132:135],a[76:79],v[100:103]
ds_read_b64_tr_b16 a[126:127],v3 offset:30720
v_mfma_f32_16x16x32_bf16 v[100:103],a[128:131],a[72:75],v[100:103]
v_mfma_f32_16x16x32_bf16 v[108:111],a[128:131],a[96:99],0
ds_read_b64_tr_b16 a[128:129],v4 offset:24576
v_mfma_f32_16x16x32_bf16 v[108:111],a[132:135],a[100:103],v[108:111]
ds_read_b64_tr_b16 a[130:131],v4 offset:30720
v_mfma_f32_16x16x32_bf16 v[108:111],a[136:139],a[104:107],v[108:111]
ds_read_b64_tr_b16 a[132:133],v5 offset:24576
v_mfma_f32_16x16x32_bf16 v[108:111],a[140:143],a[108:111],v[108:111]
ds_read_b64_tr_b16 a[134:135],v5 offset:30720
v_mfma_f32_16x16x32_bf16 v[108:111],a[144:147],a[112:115],v[108:111]
v_mfma_f32_16x16x32_bf16 v[108:111],a[148:151],a[116:119],v[108:111]
s_cbranch_scc1 L_loop5w0
s_cmp_ge_u32 s69,6
s_cbranch_scc1 L_end5
s_cmp_eq_u32 s40,0
s_cbranch_scc1 L_tr54
s_branch L_tr55
L_tr54:
s_waitcnt vmcnt(43)
s_waitcnt lgkmcnt(3)
v_mfma_f32_16x16x32_bf16 v[160:163],a[120:123],v[20:23],v[160:163]
s_add_u32 m0,s24,0
ds_read_b128 a[12:15],v12 offset:128
v_fma_f32 v101,v101,s36,v16
v_mfma_f32_16x16x32_bf16 v[164:167],a[124:127],v[20:23],v[164:167]
ds_read_b128 a[20:23],v12 offset:256
v_fma_f32 v103,v103,s36,v16
v_mfma_f32_16x16x32_bf16 v[212:215],a[124:127],v[24:27],v[212:215]
ds_read_b128 a[4:7],v12 offset:0
v_fma_f32 v87,v87,s36,v14
v_mfma_f32_16x16x32_bf16 v[208:211],a[120:123],v[24:27],v[208:211]
ds_read_b128 a[16:19],v11 offset:256
v_fma_f32 v106,v106,s36,v17
v_mfma_f32_16x16x32_bf16 v[112:115],a[120:123],v[28:31],v[112:115]
ds_read_b128 a[0:3],v11 offset:0
v_fma_f32 v99,v99,s36,v16
v_mfma_f32_16x16x32_bf16 v[116:119],a[124:127],v[28:31],v[116:119]
ds_read_b128 a[8:11],v11 offset:128
v_fma_f32 v96,v96,s36,v16
v_mfma_f32_16x16x32_bf16 a[164:167],a[124:127],v[32:35],a[164:167]
ds_read_b64_tr_b16 a[136:137],v2 offset:24704
v_fma_f32 v77,v77,s36,v13
v_mfma_f32_16x16x32_bf16 a[160:163],a[120:123],v[32:35],a[160:163]
ds_read_b64_tr_b16 a[138:139],v2 offset:30848
v_fma_f32 v85,v85,s36,v14
v_mfma_f32_16x16x32_bf16 a[208:211],a[120:123],v[36:39],a[208:211]
ds_read_b64_tr_b16 a[140:141],v3 offset:24704
ds_read_b64_tr_b16 a[142:143],v3 offset:30848
ds_read_b64_tr_b16 a[144:145],v4 offset:24704
ds_read_b64_tr_b16 a[146:147],v4 offset:30848
ds_read_b64_tr_b16 a[150:151],v5 offset:30848
ds_read_b64_tr_b16 a[148:149],v5 offset:24704
ds_read_b128 a[40:43],v11 offset:6400
v_mfma_f32_16x16x32_bf16 a[212:215],a[124:127],v[36:39],a[212:215]
s_waitcnt lgkmcnt(11)
v_fma_f32 v84,v84,s36,v14
ds_read_b128 a[32:35],v11 offset:6272
v_mfma_f32_16x16x32_bf16 a[216:219],a[128:131],v[36:39],a[216:219]
s_waitcnt lgkmcnt(10)
buffer_load_dwordx4 v6,s[12:15],s28 offen offset:0 nt lds
v_mfma_f32_16x16x32_bf16 a[220:223],a[132:135],v[36:39],a[220:223]
ds_read_b64_tr_b16 a[122:123],v2 offset:30976
ds_read_b128 a[44:47],v12 offset:6400
v_mfma_f32_16x16x32_bf16 a[172:175],a[132:135],v[32:35],a[172:175]
v_exp_f32 v101,v101
ds_read_b64_tr_b16 a[120:121],v2 offset:24832
ds_read_b128 a[24:27],v11 offset:6144
v_mfma_f32_16x16x32_bf16 a[168:171],a[128:131],v[32:35],a[168:171]
v_exp_f32 v77,v77
ds_read_b128 a[28:31],v12 offset:6144
v_mfma_f32_16x16x32_bf16 v[120:123],a[128:131],v[28:31],v[120:123]
v_fma_f32 v111,v111,s36,v17
ds_read_b64_tr_b16 a[126:127],v3 offset:30976
ds_read_b64_tr_b16 a[124:125],v3 offset:24832
ds_read_b128 a[36:39],v12 offset:6272
v_mfma_f32_16x16x32_bf16 v[124:127],a[132:135],v[28:31],v[124:127]
buffer_load_dwordx4 v7,s[12:15],s28 offen offset:1024 nt lds
v_mfma_f32_16x16x32_bf16 v[220:223],a[132:135],v[24:27],v[220:223]
v_fma_f32 v95,v95,s36,v15
v_fma_f32 v100,v100,s36,v16
v_mfma_f32_16x16x32_bf16 v[216:219],a[128:131],v[24:27],v[216:219]
v_exp_f32 v106,v106
v_mfma_f32_16x16x32_bf16 v[168:171],a[128:131],v[20:23],v[168:171]
ds_read_b64_tr_b16 a[130:131],v4 offset:30976
v_fma_f32 v93,v93,s36,v15
v_mfma_f32_16x16x32_bf16 v[172:175],a[132:135],v[20:23],v[172:175]
s_waitcnt lgkmcnt(4)
ds_read_b64_tr_b16 a[128:129],v4 offset:24832
v_exp_f32 v111,v111
v_mfma_f32_16x16x32_bf16 v[176:179],a[136:139],v[20:23],v[176:179]
ds_read_b64_tr_b16 a[132:133],v5 offset:24832
buffer_load_dwordx4 v8,s[12:15],s28 offen offset:2048 nt lds
v_mfma_f32_16x16x32_bf16 v[180:183],a[140:143],v[20:23],v[180:183]
s_add_u32 s28,s28,3072
ds_read_b64_tr_b16 a[134:135],v5 offset:30976
v_fma_f32 v107,v107,s36,v17
v_mfma_f32_16x16x32_bf16 v[228:231],a[140:143],v[24:27],v[228:231]
s_add_u32 m0,s24,3072
v_fma_f32 v92,v92,s36,v15
v_exp_f32 v92,v92
v_mfma_f32_16x16x32_bf16 v[224:227],a[136:139],v[24:27],v[224:227]
v_fma_f32 v109,v109,s36,v17
v_exp_f32 v109,v109
v_mfma_f32_16x16x32_bf16 v[128:131],a[136:139],v[28:31],v[128:131]
v_fma_f32 v97,v97,s36,v16
v_exp_f32 v84,v84
v_mfma_f32_16x16x32_bf16 v[132:135],a[140:143],v[28:31],v[132:135]
v_fma_f32 v94,v94,s36,v15
v_exp_f32 v94,v94
v_mfma_f32_16x16x32_bf16 a[180:183],a[140:143],v[32:35],a[180:183]
v_fma_f32 v104,v104,s36,v17
v_fma_f32 v90,v90,s36,v15
v_mfma_f32_16x16x32_bf16 a[176:179],a[136:139],v[32:35],a[176:179]
buffer_load_dwordx4 v6,s[12:15],s28 offen offset:0 nt lds
v_mfma_f32_16x16x32_bf16 a[224:227],a[136:139],v[36:39],a[224:227]
v_exp_f32 v93,v93
v_mfma_f32_16x16x32_bf16 a[228:231],a[140:143],v[36:39],a[228:231]
v_exp_f32 v104,v104
v_mfma_f32_16x16x32_bf16 a[232:235],a[144:147],v[36:39],a[232:235]
v_exp_f32 v96,v96
v_mfma_f32_16x16x32_bf16 a[236:239],a[148:151],v[36:39],a[236:239]
v_fma_f32 v78,v78,s36,v13
v_exp_f32 v78,v78
v_mfma_f32_16x16x32_bf16 a[188:191],a[148:151],v[32:35],a[188:191]
v_fma_f32 v110,v110,s36,v17
v_exp_f32 v110,v110
v_mfma_f32_16x16x32_bf16 a[184:187],a[144:147],v[32:35],a[184:187]
v_exp_f32 v97,v97
v_mfma_f32_16x16x32_bf16 v[136:139],a[144:147],v[28:31],v[136:139]
v_exp_f32 v100,v100
v_mfma_f32_16x16x32_bf16 v[140:143],a[148:151],v[28:31],v[140:143]
buffer_load_dwordx4 v7,s[12:15],s28 offen offset:1024 nt lds
v_mfma_f32_16x16x32_bf16 v[236:239],a[148:151],v[24:27],v[236:239]
v_fma_f32 v102,v102,s36,v16
v_exp_f32 v102,v102
v_mfma_f32_16x16x32_bf16 v[232:235],a[144:147],v[24:27],v[232:235]
v_fma_f32 v79,v79,s36,v13
v_exp_f32 v79,v79
v_mfma_f32_16x16x32_bf16 v[184:187],a[144:147],v[20:23],v[184:187]
v_exp_f32 v85,v85
v_mfma_f32_16x16x32_bf16 v[188:191],a[148:151],v[20:23],v[188:191]
v_fma_f32 v108,v108,s36,v17
v_exp_f32 v108,v108
v_mfma_f32_16x16x32_bf16 v[192:195],a[120:123],v[20:23],v[192:195]
s_waitcnt lgkmcnt(0)
v_fma_f32 v98,v98,s36,v16
v_exp_f32 v87,v87
v_mfma_f32_16x16x32_bf16 v[196:199],a[124:127],v[20:23],v[196:199]
v_fma_f32 v76,v76,s36,v13
v_exp_f32 v76,v76
v_mfma_f32_16x16x32_bf16 v[244:247],a[124:127],v[24:27],v[244:247]
buffer_load_dwordx4 v8,s[12:15],s28 offen offset:2048 nt lds
s_waitcnt vmcnt(18)
s_barrier
v_mfma_f32_16x16x32_bf16 v[240:243],a[120:123],v[24:27],v[240:243]
s_add_u32 s28,s28,3072
v_fma_f32 v105,v105,s36,v17
v_exp_f32 v107,v107
v_mfma_f32_16x16x32_bf16 v[144:147],a[120:123],v[28:31],v[144:147]
s_add_u32 m0,s22,0
v_fma_f32 v91,v91,s36,v15
v_exp_f32 v91,v91
v_mfma_f32_16x16x32_bf16 v[148:151],a[124:127],v[28:31],v[148:151]
buffer_load_dwordx4 v6,s[4:7],s25 offen offset:0 lds
v_mfma_f32_16x16x32_bf16 a[196:199],a[124:127],v[32:35],a[196:199]
buffer_load_dwordx4 v7,s[4:7],s25 offen offset:1024 lds
v_mfma_f32_16x16x32_bf16 a[192:195],a[120:123],v[32:35],a[192:195]
buffer_load_dwordx4 v8,s[4:7],s25 offen offset:2048 lds
v_mfma_f32_16x16x32_bf16 a[240:243],a[120:123],v[36:39],a[240:243]
v_fma_f32 v86,v86,s36,v14
v_exp_f32 v86,v86
v_mfma_f32_16x16x32_bf16 a[244:247],a[124:127],v[36:39],a[244:247]
v_exp_f32 v95,v95
v_mfma_f32_16x16x32_bf16 a[248:251],a[128:131],v[36:39],a[248:251]
v_exp_f32 v103,v103
v_mfma_f32_16x16x32_bf16 a[252:255],a[132:135],v[36:39],a[252:255]
ds_read_b64_tr_b16 a[136:137],v2 offset:0
v_cvt_pk_bf16_f32 v41,v106,v107
v_mfma_f32_16x16x32_bf16 a[204:207],a[132:135],v[32:35],a[204:207]
ds_read_b64_tr_b16 a[138:139],v2 offset:6144
v_exp_f32 v99,v99
v_mfma_f32_16x16x32_bf16 a[200:203],a[128:131],v[32:35],a[200:203]
ds_read_b64_tr_b16 a[140:141],v3 offset:0
v_cvt_pk_bf16_f32 v42,v108,v109
v_mfma_f32_16x16x32_bf16 v[152:155],a[128:131],v[28:31],v[152:155]
ds_read_b64_tr_b16 a[142:143],v3 offset:6144
v_cvt_pk_bf16_f32 v50,v84,v85
v_mfma_f32_16x16x32_bf16 v[156:159],a[132:135],v[28:31],v[156:159]
ds_read_b64_tr_b16 a[144:145],v4 offset:0
v_exp_f32 v90,v90
v_mfma_f32_16x16x32_bf16 v[252:255],a[132:135],v[24:27],v[252:255]
ds_read_b64_tr_b16 a[146:147],v4 offset:6144
v_exp_f32 v105,v105
v_mfma_f32_16x16x32_bf16 v[248:251],a[128:131],v[24:27],v[248:251]
ds_read_b64_tr_b16 a[148:149],v5 offset:0
v_cvt_pk_bf16_f32 v55,v94,v95
v_mfma_f32_16x16x32_bf16 v[200:203],a[128:131],v[20:23],v[200:203]
ds_read_b64_tr_b16 a[150:151],v5 offset:6144
v_cvt_pk_bf16_f32 v51,v86,v87
v_mfma_f32_16x16x32_bf16 v[204:207],a[132:135],v[20:23],v[204:207]
v_cvt_pk_bf16_f32 v59,v102,v103
v_exp_f32 v98,v98
v_cvt_pk_bf16_f32 v54,v92,v93
v_cvt_pk_bf16_f32 v56,v96,v97
v_cvt_pk_bf16_f32 v53,v90,v91
v_cvt_pk_bf16_f32 v47,v78,v79
v_cvt_pk_bf16_f32 v43,v110,v111
v_cvt_pk_bf16_f32 v58,v100,v101
v_cvt_pk_bf16_f32 v46,v76,v77
v_cvt_pk_bf16_f32 v57,v98,v99
v_cvt_pk_bf16_f32 v40,v104,v105
v_smfmac_f32_16x16x64_bf16 v[60:63],a[152:155],v[44:51],v18
v_subrev_u32 v10,18432,v10
v_smfmac_f32_16x16x64_bf16 v[64:67],a[152:155],v[52:59],v18
v_smfmac_f32_16x16x64_bf16 v[68:71],a[152:155],v[36:43],v18
s_waitcnt lgkmcnt(1)
v_mfma_f32_16x16x32_bf16 v[160:163],a[136:139],v[44:47],v[160:163]
s_add_u32 s87,s42,18432
ds_read_b64_tr_b16 a[122:123],v2 offset:6272
v_mbcnt_lo_u32_b32 v39,-1,0
v_mfma_f32_16x16x32_bf16 v[164:167],a[140:143],v[44:47],v[164:167]
s_add_u32 s66,s42,24576
ds_read_b64_tr_b16 a[120:121],v2 offset:128
v_mbcnt_hi_u32_b32 v39,-1,v39
v_mfma_f32_16x16x32_bf16 v[212:215],a[140:143],v[48:51],v[212:215]
ds_read_b64_tr_b16 a[126:127],v3 offset:6272
v_and_b32 v38,7,v39
v_mfma_f32_16x16x32_bf16 v[208:211],a[136:139],v[48:51],v[208:211]
ds_read_b64_tr_b16 a[124:125],v3 offset:128
v_lshrrev_b32 v19,5,v39
v_mfma_f32_16x16x32_bf16 v[112:115],a[136:139],v[52:55],v[112:115]
ds_read_b64_tr_b16 a[130:131],v4 offset:6272
v_xor_b32 v38,v38,v19
v_mfma_f32_16x16x32_bf16 v[116:119],a[140:143],v[52:55],v[116:119]
ds_read_b64_tr_b16 a[128:129],v4 offset:128
v_and_b32 v19,15,v39
v_mfma_f32_16x16x32_bf16 a[164:167],a[140:143],v[56:59],a[164:167]
ds_read_b64_tr_b16 a[132:133],v5 offset:128
v_lshl_add_u32 v19,v19,7,s24
v_mfma_f32_16x16x32_bf16 a[160:163],a[136:139],v[56:59],a[160:163]
ds_read_b64_tr_b16 a[134:135],v5 offset:6272
v_lshl_add_u32 v19,v38,4,v19
v_mfma_f32_16x16x32_bf16 a[208:211],a[136:139],v[40:43],a[208:211]
ds_read_b64_tr_b16 a[138:139],v2 offset:6400
v_bfe_u32 v38,v39,4,1
v_mfma_f32_16x16x32_bf16 a[212:215],a[140:143],v[40:43],a[212:215]
ds_read_b64_tr_b16 a[136:137],v2 offset:256
v_lshl_add_u32 v36,v38,3,v19
v_mfma_f32_16x16x32_bf16 a[216:219],a[144:147],v[40:43],a[216:219]
s_waitcnt lgkmcnt(6)
ds_read_b64_tr_b16 a[140:141],v3 offset:256
v_xor_b32 v38,64,v36
v_mfma_f32_16x16x32_bf16 a[220:223],a[148:151],v[40:43],a[220:223]
ds_read_b64_tr_b16 a[142:143],v3 offset:6400
v_bfe_u32 v19,v39,3,1
v_xor_b32 v39,96,v36
v_xor_b32 v37,32,v36
v_lshlrev_b32 v19,11,v19
v_add_f32 v68,v68,v69
v_add_f32 v68,v68,v70
v_add_f32 v66,v66,v67
v_add_f32 v68,v68,v71
v_rcp_f32 v68,v68
v_accvgpr_read_b32 v78,a210
v_rcp_f32 v66,v66
v_accvgpr_read_b32 v73,a161
v_accvgpr_read_b32 v76,a208
v_accvgpr_read_b32 v77,a209
v_pk_mul_f32 v[76:77],v[76:77],v[68:69] op_sel_hi:[1,0]
v_accvgpr_read_b32 v79,a211
v_pk_mul_f32 v[78:79],v[78:79],v[68:69] op_sel_hi:[1,0]
v_accvgpr_read_b32 v75,a163
v_accvgpr_read_b32 v74,a162
v_pk_mul_f32 v[74:75],v[74:75],v[66:67] op_sel_hi:[1,0]
v_accvgpr_read_b32 v72,a160
v_pk_mul_f32 v[72:73],v[72:73],v[66:67] op_sel_hi:[1,0]
v_accvgpr_read_b32 v86,a214
v_accvgpr_read_b32 v83,a167
v_mfma_f32_16x16x32_bf16 a[172:175],a[148:151],v[56:59],a[172:175]
v_accvgpr_read_b32 v84,a212
v_accvgpr_read_b32 v80,a164
v_accvgpr_read_b32 v85,a213
v_accvgpr_read_b32 v82,a166
v_accvgpr_read_b32 v81,a165
v_pk_mul_f32 v[84:85],v[84:85],v[68:69] op_sel_hi:[1,0]
v_pk_mul_f32 v[80:81],v[80:81],v[66:67] op_sel_hi:[1,0]
v_pk_mul_f32 v[82:83],v[82:83],v[66:67] op_sel_hi:[1,0]
v_accvgpr_read_b32 v87,a215
v_pk_mul_f32 v[86:87],v[86:87],v[68:69] op_sel_hi:[1,0]
v_accvgpr_read_b32 v95,a219
v_accvgpr_read_b32 v92,a216
v_mfma_f32_16x16x32_bf16 a[168:171],a[144:147],v[56:59],a[168:171]
v_accvgpr_read_b32 v93,a217
v_accvgpr_read_b32 v94,a218
v_mfma_f32_16x16x32_bf16 v[120:123],a[144:147],v[52:55],v[120:123]
v_accvgpr_read_b32 v97,a173
v_accvgpr_read_b32 v98,a174
v_mfma_f32_16x16x32_bf16 v[124:127],a[148:151],v[52:55],v[124:127]
v_accvgpr_read_b32 v99,a175
v_accvgpr_read_b32 v101,a221
v_mfma_f32_16x16x32_bf16 v[220:223],a[148:151],v[48:51],v[220:223]
v_accvgpr_read_b32 v89,a169
v_accvgpr_read_b32 v91,a171
v_accvgpr_read_b32 v90,a170
v_accvgpr_read_b32 v88,a168
v_accvgpr_read_b32 v96,a172
v_pk_mul_f32 v[94:95],v[94:95],v[68:69] op_sel_hi:[1,0]
v_pk_mul_f32 v[88:89],v[88:89],v[66:67] op_sel_hi:[1,0]
v_pk_mul_f32 v[92:93],v[92:93],v[68:69] op_sel_hi:[1,0]
v_pk_mul_f32 v[90:91],v[90:91],v[66:67] op_sel_hi:[1,0]
v_accvgpr_read_b32 v103,a223
v_accvgpr_read_b32 v102,a222
v_mfma_f32_16x16x32_bf16 v[216:219],a[144:147],v[48:51],v[216:219]
v_accvgpr_read_b32 v100,a220
v_add_f32 v62,v62,v63
v_rcp_f32 v62,v62
v_cvt_pk_bf16_f32 v76,v76,v77
v_pk_mul_f32 v[102:103],v[102:103],v[68:69] op_sel_hi:[1,0]
v_pk_mul_f32 v[98:99],v[98:99],v[66:67] op_sel_hi:[1,0]
v_pk_mul_f32 v[100:101],v[100:101],v[68:69] op_sel_hi:[1,0]
v_pk_mul_f32 v[96:97],v[96:97],v[66:67] op_sel_hi:[1,0]
v_cvt_pk_bf16_f32 v72,v72,v73
v_cvt_pk_bf16_f32 v84,v84,v85
v_mfma_f32_16x16x32_bf16 v[168:171],a[144:147],v[44:47],v[168:171]
ds_read_b64_tr_b16 a[144:145],v4 offset:256
v_cvt_pk_bf16_f32 v85,v86,v87
v_mfma_f32_16x16x32_bf16 v[172:175],a[148:151],v[44:47],v[172:175]
ds_read_b64_tr_b16 a[146:147],v4 offset:6400
v_cvt_pk_bf16_f32 v80,v80,v81
v_mfma_f32_16x16x32_bf16 v[176:179],a[120:123],v[44:47],v[176:179]
ds_read_b64_tr_b16 a[150:151],v5 offset:6400
v_cvt_pk_bf16_f32 v81,v82,v83
v_mfma_f32_16x16x32_bf16 v[180:183],a[124:127],v[44:47],v[180:183]
ds_read_b64_tr_b16 a[148:149],v5 offset:256
v_cvt_pk_bf16_f32 v92,v92,v93
v_mfma_f32_16x16x32_bf16 v[228:231],a[124:127],v[48:51],v[228:231]
v_cvt_pk_bf16_f32 v73,v74,v75
v_cvt_pk_bf16_f32 v77,v78,v79
v_mfma_f32_16x16x32_bf16 v[224:227],a[120:123],v[48:51],v[224:227]
ds_write2st64_b64 v36,v[72:73],v[76:77] offset0:36 offset1:40
v_mfma_f32_16x16x32_bf16 v[128:131],a[120:123],v[52:55],v[128:131]
v_add_u32 v36,v36,v19
v_cvt_pk_bf16_f32 v93,v94,v95
v_mfma_f32_16x16x32_bf16 v[132:135],a[124:127],v[52:55],v[132:135]
v_cvt_pk_bf16_f32 v100,v100,v101
v_cvt_pk_bf16_f32 v88,v88,v89
v_mfma_f32_16x16x32_bf16 a[180:183],a[124:127],v[56:59],a[180:183]
v_cvt_pk_bf16_f32 v89,v90,v91
v_cvt_pk_bf16_f32 v96,v96,v97
v_cvt_pk_bf16_f32 v97,v98,v99
v_cvt_pk_bf16_f32 v101,v102,v103
ds_write2st64_b64 v37,v[80:81],v[84:85] offset0:36 offset1:40
v_pk_mul_f32 v[212:213],v[212:213],v[62:63] op_sel_hi:[1,0]
v_pk_mul_f32 v[230:231],v[230:231],v[62:63] op_sel_hi:[1,0]
v_pk_mul_f32 v[210:211],v[210:211],v[62:63] op_sel_hi:[1,0]
v_pk_mul_f32 v[208:209],v[208:209],v[62:63] op_sel_hi:[1,0]
v_pk_mul_f32 v[214:215],v[214:215],v[62:63] op_sel_hi:[1,0]
v_pk_mul_f32 v[228:229],v[228:229],v[62:63] op_sel_hi:[1,0]
v_pk_mul_f32 v[226:227],v[226:227],v[62:63] op_sel_hi:[1,0]
v_pk_mul_f32 v[224:225],v[224:225],v[62:63] op_sel_hi:[1,0]
v_add_u32 v37,v37,v19
v_accvgpr_read_b32 v91,a183
v_mfma_f32_16x16x32_bf16 a[176:179],a[120:123],v[56:59],a[176:179]
v_accvgpr_read_b32 v90,a182
v_cvt_pk_bf16_f32 v224,v224,v225
v_mfma_f32_16x16x32_bf16 a[224:227],a[120:123],v[40:43],a[224:227]
ds_write2st64_b64 v38,v[88:89],v[92:93] offset0:36 offset1:40
v_mfma_f32_16x16x32_bf16 a[228:231],a[124:127],v[40:43],a[228:231]
s_waitcnt lgkmcnt(1)
v_add_u32 v38,v38,v19
v_accvgpr_read_b32 v88,a180
v_mfma_f32_16x16x32_bf16 a[232:235],a[128:131],v[40:43],a[232:235]
v_accvgpr_read_b32 v81,a177
v_accvgpr_read_b32 v80,a176
v_mfma_f32_16x16x32_bf16 a[236:239],a[132:135],v[40:43],a[236:239]
v_accvgpr_read_b32 v84,a224
v_accvgpr_read_b32 v89,a181
v_mfma_f32_16x16x32_bf16 a[188:191],a[132:135],v[56:59],a[188:191]
ds_write2st64_b64 v39,v[96:97],v[100:101] offset0:36 offset1:40
v_mfma_f32_16x16x32_bf16 a[184:187],a[128:131],v[56:59],a[184:187]
v_add_u32 v39,v39,v19
v_accvgpr_read_b32 v93,a229
v_mfma_f32_16x16x32_bf16 v[136:139],a[128:131],v[52:55],v[136:139]
ds_read_b128 v[104:107],v10 offset:18432
v_accvgpr_read_b32 v103,a235
v_mfma_f32_16x16x32_bf16 v[140:143],a[132:135],v[52:55],v[140:143]
ds_read_b128 v[108:111],v10 offset:19456
v_accvgpr_read_b32 v100,a232
v_mfma_f32_16x16x32_bf16 v[236:239],a[132:135],v[48:51],v[236:239]
s_waitcnt vmcnt(15)
ds_read_b128 a[68:71],v12 offset:12544
v_accvgpr_read_b32 v97,a185
v_mfma_f32_16x16x32_bf16 v[232:235],a[128:131],v[48:51],v[232:235]
ds_read_b128 a[64:67],v11 offset:12544
v_accvgpr_read_b32 v94,a230
v_mfma_f32_16x16x32_bf16 v[184:187],a[128:131],v[44:47],v[184:187]
ds_read_b128 a[60:63],v12 offset:12416
v_accvgpr_read_b32 v82,a178
v_mfma_f32_16x16x32_bf16 v[188:191],a[132:135],v[44:47],v[188:191]
ds_read_b128 a[56:59],v11 offset:12416
v_accvgpr_read_b32 v87,a227
v_mfma_f32_16x16x32_bf16 v[192:195],a[136:139],v[44:47],v[192:195]
ds_read_b128 a[52:55],v12 offset:12288
v_accvgpr_read_b32 v102,a234
ds_read_b128 a[48:51],v11 offset:12288
v_pk_mul_f32 v[236:237],v[236:237],v[62:63] op_sel_hi:[1,0]
ds_read_b128 v[72:75],v10 offset:20480
s_waitcnt lgkmcnt(8)
buffer_store_dwordx4 v[104:107],v9,s[16:19],s87 offen offset:0 nt
v_pk_mul_f32 v[232:233],v[232:233],v[62:63] op_sel_hi:[1,0]
v_pk_mul_f32 v[102:103],v[102:103],v[68:69] op_sel_hi:[1,0]
v_pk_mul_f32 v[238:239],v[238:239],v[62:63] op_sel_hi:[1,0]
ds_read_b128 v[76:79],v10 offset:21504
v_pk_mul_f32 v[234:235],v[234:235],v[62:63] op_sel_hi:[1,0]
v_pk_mul_f32 v[216:217],v[216:217],v[62:63] op_sel_hi:[1,0]
v_pk_mul_f32 v[222:223],v[222:223],v[62:63] op_sel_hi:[1,0]
v_pk_mul_f32 v[90:91],v[90:91],v[66:67] op_sel_hi:[1,0]
v_pk_mul_f32 v[88:89],v[88:89],v[66:67] op_sel_hi:[1,0]
v_pk_mul_f32 v[220:221],v[220:221],v[62:63] op_sel_hi:[1,0]
v_pk_mul_f32 v[80:81],v[80:81],v[66:67] op_sel_hi:[1,0]
v_pk_mul_f32 v[218:219],v[218:219],v[62:63] op_sel_hi:[1,0]
s_waitcnt lgkmcnt(4)
buffer_store_dwordx4 v[108:111],v9,s[16:19],s87 offen offset:3072 nt
v_accvgpr_read_b32 v83,a179
v_pk_mul_f32 v[82:83],v[82:83],v[66:67] op_sel_hi:[1,0]
v_accvgpr_read_b32 v101,a233
v_pk_mul_f32 v[100:101],v[100:101],v[68:69] op_sel_hi:[1,0]
v_accvgpr_read_b32 v92,a228
v_pk_mul_f32 v[92:93],v[92:93],v[68:69] op_sel_hi:[1,0]
v_accvgpr_read_b32 v96,a184
v_pk_mul_f32 v[96:97],v[96:97],v[66:67] op_sel_hi:[1,0]
v_accvgpr_read_b32 v98,a186
v_accvgpr_read_b32 v86,a226
v_pk_mul_f32 v[86:87],v[86:87],v[68:69] op_sel_hi:[1,0]
v_accvgpr_read_b32 v95,a231
v_pk_mul_f32 v[94:95],v[94:95],v[68:69] op_sel_hi:[1,0]
v_accvgpr_read_b32 v85,a225
s_waitcnt lgkmcnt(1)
buffer_store_dwordx4 v[72:75],v9,s[16:19],s66 offen offset:0 nt
v_pk_mul_f32 v[84:85],v[84:85],v[68:69] op_sel_hi:[1,0]
v_accvgpr_read_b32 v99,a187
v_pk_mul_f32 v[98:99],v[98:99],v[66:67] op_sel_hi:[1,0]
v_cvt_pk_bf16_f32 v225,v226,v227
v_cvt_pk_bf16_f32 v208,v208,v209
v_mfma_f32_16x16x32_bf16 v[196:199],a[140:143],v[44:47],v[196:199]
v_cvt_pk_bf16_f32 v209,v210,v211
v_accvgpr_read_b32 v211,a191
v_mfma_f32_16x16x32_bf16 v[244:247],a[140:143],v[48:51],v[244:247]
ds_write2st64_b64 v36,v[208:209],v[224:225] offset0:12 offset1:14
v_sub_u32 v36,v36,v19
v_accvgpr_read_b32 v209,a189
v_accvgpr_read_b32 v227,a239
v_accvgpr_read_b32 v226,a238
v_pk_mul_f32 v[226:227],v[226:227],v[68:69] op_sel_hi:[1,0]
v_accvgpr_read_b32 v208,a188
s_waitcnt lgkmcnt(1)
buffer_store_dwordx4 v[76:79],v9,s[16:19],s66 offen offset:3072 nt
v_pk_mul_f32 v[208:209],v[208:209],v[66:67] op_sel_hi:[1,0]
v_accvgpr_read_b32 v210,a190
v_pk_mul_f32 v[210:211],v[210:211],v[66:67] op_sel_hi:[1,0]
v_accvgpr_read_b32 v224,a236
v_accvgpr_read_b32 v225,a237
v_pk_mul_f32 v[224:225],v[224:225],v[68:69] op_sel_hi:[1,0]
v_add_f32 v64,v64,v65
v_rcp_f32 v64,v64
v_mfma_f32_16x16x32_bf16 v[240:243],a[136:139],v[48:51],v[240:243]
v_cvt_pk_bf16_f32 v228,v228,v229
v_cvt_pk_bf16_f32 v212,v212,v213
v_mfma_f32_16x16x32_bf16 v[144:147],a[136:139],v[52:55],v[144:147]
v_cvt_pk_bf16_f32 v229,v230,v231
v_cvt_pk_bf16_f32 v213,v214,v215
v_mfma_f32_16x16x32_bf16 v[148:151],a[140:143],v[52:55],v[148:151]
ds_write2st64_b64 v37,v[212:213],v[228:229] offset0:12 offset1:14
v_mfma_f32_16x16x32_bf16 a[196:199],a[140:143],v[56:59],a[196:199]
v_sub_u32 v37,v37,v19
v_cvt_pk_bf16_f32 v216,v216,v217
v_cvt_pk_bf16_f32 v232,v232,v233
v_cvt_pk_bf16_f32 v233,v234,v235
v_cvt_pk_bf16_f32 v217,v218,v219
v_pk_mul_f32 v[112:113],v[112:113],v[64:65] op_sel_hi:[1,0]
v_pk_mul_f32 v[114:115],v[114:115],v[64:65] op_sel_hi:[1,0]
v_pk_mul_f32 v[240:241],v[240:241],v[62:63] op_sel_hi:[1,0]
v_pk_mul_f32 v[242:243],v[242:243],v[62:63] op_sel_hi:[1,0]
v_accvgpr_read_b32 v235,a199
v_cvt_pk_bf16_f32 v236,v236,v237
v_mfma_f32_16x16x32_bf16 a[192:195],a[136:139],v[56:59],a[192:195]
ds_write2st64_b64 v38,v[216:217],v[232:233] offset0:12 offset1:14
v_mfma_f32_16x16x32_bf16 a[240:243],a[136:139],v[40:43],a[240:243]
v_sub_u32 v38,v38,v19
v_cvt_pk_bf16_f32 v220,v220,v221
v_mfma_f32_16x16x32_bf16 a[244:247],a[140:143],v[40:43],a[244:247]
v_cvt_pk_bf16_f32 v221,v222,v223
v_accvgpr_read_b32 v232,a196
v_accvgpr_read_b32 v233,a197
v_accvgpr_read_b32 v231,a195
v_accvgpr_read_b32 v228,a192
v_pk_mul_f32 v[244:245],v[244:245],v[62:63] op_sel_hi:[1,0]
v_pk_mul_f32 v[116:117],v[116:117],v[64:65] op_sel_hi:[1,0]
v_pk_mul_f32 v[246:247],v[246:247],v[62:63] op_sel_hi:[1,0]
v_pk_mul_f32 v[118:119],v[118:119],v[64:65] op_sel_hi:[1,0]
s_waitcnt vmcnt(4)
s_barrier
v_mfma_f32_16x16x32_bf16 a[248:251],a[144:147],v[40:43],a[248:251]
ds_read_b128 a[140:143],v1 offset:256
v_accvgpr_read_b32 v216,a240
v_mfma_f32_16x16x32_bf16 a[252:255],a[148:151],v[40:43],a[252:255]
ds_read_b128 a[136:139],v0 offset:256
v_accvgpr_read_b32 v218,a242
v_mfma_f32_16x16x32_bf16 a[204:207],a[148:151],v[56:59],a[204:207]
ds_read_b128 a[132:135],v1 offset:128
v_accvgpr_read_b32 v219,a243
v_mfma_f32_16x16x32_bf16 a[200:203],a[144:147],v[56:59],a[200:203]
ds_read_b128 a[128:131],v0 offset:128
v_accvgpr_read_b32 v217,a241
v_mfma_f32_16x16x32_bf16 v[152:155],a[144:147],v[52:55],v[152:155]
ds_read_b128 a[124:127],v1 offset:0
v_accvgpr_read_b32 v229,a193
v_mfma_f32_16x16x32_bf16 v[156:159],a[148:151],v[52:55],v[156:159]
ds_read_b128 a[120:123],v0 offset:0
v_accvgpr_read_b32 v230,a194
v_mfma_f32_16x16x32_bf16 v[252:255],a[148:151],v[48:51],v[252:255]
v_accvgpr_read_b32 v222,a246
v_cvt_pk_bf16_f32 v237,v238,v239
v_mfma_f32_16x16x32_bf16 v[248:251],a[144:147],v[48:51],v[248:251]
ds_write2st64_b64 v39,v[220:221],v[236:237] offset0:12 offset1:14
v_mfma_f32_16x16x32_bf16 v[200:203],a[144:147],v[44:47],v[200:203]
v_sub_u32 v39,v39,v19
v_accvgpr_read_b32 v221,a245
v_mfma_f32_16x16x32_bf16 v[204:207],a[148:151],v[44:47],v[204:207]
s_waitcnt lgkmcnt(4)
ds_read_b128 a[144:147],v0 offset:6144
v_accvgpr_read_b32 v223,a247
v_mfma_f32_16x16x32_bf16 v[72:75],a[140:143],a[20:23],0
ds_read_b128 a[148:151],v1 offset:6144
v_accvgpr_read_b32 v234,a198
v_accvgpr_read_b32 v220,a244
v_cvt_pk_bf16_f32 v84,v84,v85
v_cvt_pk_bf16_f32 v85,v86,v87
v_pk_mul_f32 v[252:253],v[252:253],v[62:63] op_sel_hi:[1,0]
v_pk_mul_f32 v[122:123],v[122:123],v[64:65] op_sel_hi:[1,0]
v_pk_mul_f32 v[120:121],v[120:121],v[64:65] op_sel_hi:[1,0]
v_pk_mul_f32 v[254:255],v[254:255],v[62:63] op_sel_hi:[1,0]
v_pk_mul_f32 v[248:249],v[248:249],v[62:63] op_sel_hi:[1,0]
v_pk_mul_f32 v[228:229],v[228:229],v[66:67] op_sel_hi:[1,0]
v_pk_mul_f32 v[124:125],v[124:125],v[64:65] op_sel_hi:[1,0]
v_pk_mul_f32 v[218:219],v[218:219],v[68:69] op_sel_hi:[1,0]
v_pk_mul_f32 v[250:251],v[250:251],v[62:63] op_sel_hi:[1,0]
v_pk_mul_f32 v[126:127],v[126:127],v[64:65] op_sel_hi:[1,0]
v_pk_mul_f32 v[216:217],v[216:217],v[68:69] op_sel_hi:[1,0]
v_pk_mul_f32 v[230:231],v[230:231],v[66:67] op_sel_hi:[1,0]
v_cvt_pk_bf16_f32 v80,v80,v81
v_cvt_pk_bf16_f32 v81,v82,v83
v_mfma_f32_16x16x32_bf16 v[72:75],a[136:139],a[16:19],v[72:75]
ds_write2st64_b64 v36,v[80:81],v[84:85] offset0:36 offset1:40
v_mfma_f32_16x16x32_bf16 v[72:75],a[132:135],a[12:15],v[72:75]
v_add_u32 v36,v36,v19
v_accvgpr_read_b32 v238,a202
v_accvgpr_read_b32 v85,a249
v_accvgpr_read_b32 v237,a201
v_accvgpr_read_b32 v86,a250
v_pk_mul_f32 v[234:235],v[234:235],v[66:67] op_sel_hi:[1,0]
v_pk_mul_f32 v[222:223],v[222:223],v[68:69] op_sel_hi:[1,0]
v_pk_mul_f32 v[220:221],v[220:221],v[68:69] op_sel_hi:[1,0]
v_pk_mul_f32 v[232:233],v[232:233],v[66:67] op_sel_hi:[1,0]
v_accvgpr_read_b32 v87,a251
v_accvgpr_read_b32 v84,a248
s_waitcnt lgkmcnt(1)
v_mfma_f32_16x16x32_bf16 v[72:75],a[128:131],a[8:11],v[72:75]
v_accvgpr_read_b32 v236,a200
v_accvgpr_read_b32 v239,a203
v_mfma_f32_16x16x32_bf16 v[72:75],a[124:127],a[4:7],v[72:75]
v_add_f32 v60,v60,v61
v_rcp_f32 v60,v60
v_mfma_f32_16x16x32_bf16 v[72:75],a[120:123],a[0:3],v[72:75]
v_cvt_pk_bf16_f32 v88,v88,v89
v_cvt_pk_bf16_f32 v96,v96,v97
v_min3_f32 v61,v60,v62,v64
v_cvt_pk_bf16_f32 v92,v92,v93
v_cvt_pk_bf16_f32 v89,v90,v91
v_pk_mul_f32 v[236:237],v[236:237],v[66:67] op_sel_hi:[1,0]
v_pk_mul_f32 v[84:85],v[84:85],v[68:69] op_sel_hi:[1,0]
v_pk_mul_f32 v[86:87],v[86:87],v[68:69] op_sel_hi:[1,0]
v_pk_mul_f32 v[238:239],v[238:239],v[66:67] op_sel_hi:[1,0]
v_cvt_pk_bf16_f32 v93,v94,v95
v_cvt_pk_bf16_f32 v100,v100,v101
v_mfma_f32_16x16x32_bf16 v[80:83],a[120:123],a[24:27],0
ds_write2st64_b64 v37,v[88:89],v[92:93] offset0:36 offset1:40
v_mfma_f32_16x16x32_bf16 v[80:83],a[124:127],a[28:31],v[80:83]
v_add_u32 v37,v37,v19
v_cvt_pk_bf16_f32 v97,v98,v99
v_mfma_f32_16x16x32_bf16 v[80:83],a[128:131],a[32:35],v[80:83]
v_min3_f32 v61,v61,v66,v68
v_accvgpr_read_b32 v92,a204
v_cmp_nlt_f32 vcc,s37,v61
v_accvgpr_read_b32 v93,a205
v_cvt_pk_bf16_f32 v101,v102,v103
v_pk_mul_f32 v[92:93],v[92:93],v[66:67] op_sel_hi:[1,0]
v_accvgpr_read_b32 v99,a255
v_accvgpr_read_b32 v95,a207
ds_write2st64_b64 v38,v[96:97],v[100:101] offset0:36 offset1:40
v_add_u32 v38,v38,v19
v_accvgpr_read_b32 v97,a253
v_accvgpr_read_b32 v96,a252
v_pk_mul_f32 v[96:97],v[96:97],v[68:69] op_sel_hi:[1,0]
v_accvgpr_read_b32 v98,a254
v_pk_mul_f32 v[98:99],v[98:99],v[68:69] op_sel_hi:[1,0]
v_accvgpr_read_b32 v94,a206
v_pk_mul_f32 v[94:95],v[94:95],v[66:67] op_sel_hi:[1,0]
v_cvt_pk_bf16_f32 v208,v208,v209
v_cvt_pk_bf16_f32 v209,v210,v211
v_mfma_f32_16x16x32_bf16 v[80:83],a[132:135],a[36:39],v[80:83]
s_cmp_lg_u64 vcc,0
v_cvt_pk_bf16_f32 v224,v224,v225
v_cvt_pk_bf16_f32 v225,v226,v227
v_mfma_f32_16x16x32_bf16 v[80:83],a[136:139],a[40:43],v[80:83]
s_cselect_b32 s62,s32,0
ds_write2st64_b64 v39,v[208:209],v[224:225] offset0:36 offset1:40
v_mfma_f32_16x16x32_bf16 v[80:83],a[140:143],a[44:47],v[80:83]
s_or_b32 s31,s31,s62
v_add_u32 v39,v39,v19
v_cvt_pk_bf16_f32 v240,v240,v241
v_mfma_f32_16x16x32_bf16 v[88:91],a[140:143],a[68:71],0
s_lshl_b32 s32,s32,1
ds_read_b128 v[76:79],v10 offset:18432
v_cvt_pk_bf16_f32 v116,v116,v117
v_cvt_pk_bf16_f32 v117,v118,v119
v_cvt_pk_bf16_f32 v244,v244,v245
v_cvt_pk_bf16_f32 v112,v112,v113
ds_read_b128 v[104:107],v10 offset:19456
v_pk_mul_f32 v[128:129],v[128:129],v[64:65] op_sel_hi:[1,0]
v_pk_mul_f32 v[144:145],v[144:145],v[64:65] op_sel_hi:[1,0]
v_pk_mul_f32 v[146:147],v[146:147],v[64:65] op_sel_hi:[1,0]
v_pk_mul_f32 v[130:131],v[130:131],v[64:65] op_sel_hi:[1,0]
v_cvt_pk_bf16_f32 v241,v242,v243
v_cvt_pk_bf16_f32 v245,v246,v247
v_mfma_f32_16x16x32_bf16 v[88:91],a[136:139],a[64:67],v[88:91]
s_add_u32 m0,s23,0
ds_read_b128 v[108:111],v10 offset:20480
buffer_load_dwordx4 v6,s[8:11],s25 offen offset:0 lds
v_mfma_f32_16x16x32_bf16 v[88:91],a[132:135],a[60:63],v[88:91]
buffer_load_dwordx4 v7,s[8:11],s25 offen offset:1024 lds
v_mfma_f32_16x16x32_bf16 v[88:91],a[128:131],a[56:59],v[88:91]
buffer_load_dwordx4 v8,s[8:11],s25 offen offset:2048 lds
ds_read_b128 v[212:215],v10 offset:21504
s_waitcnt lgkmcnt(3)
buffer_store_dwordx4 v[76:79],v9,s[16:19],s87 offen offset:128 nt
v_pk_mul_f32 v[132:133],v[132:133],v[64:65] op_sel_hi:[1,0]
v_pk_mul_f32 v[148:149],v[148:149],v[64:65] op_sel_hi:[1,0]
v_pk_mul_f32 v[150:151],v[150:151],v[64:65] op_sel_hi:[1,0]
v_pk_mul_f32 v[134:135],v[134:135],v[64:65] op_sel_hi:[1,0]
v_cvt_pk_bf16_f32 v248,v248,v249
v_cvt_pk_bf16_f32 v249,v250,v251
v_mfma_f32_16x16x32_bf16 v[88:91],a[124:127],a[52:55],v[88:91]
s_waitcnt vmcnt(11)
ds_read_b128 a[72:75],v11 offset:0
v_cvt_pk_bf16_f32 v228,v228,v229
v_mfma_f32_16x16x32_bf16 v[88:91],a[120:123],a[48:51],v[88:91]
s_mov_b32 s27,s42
ds_read_b128 a[76:79],v12 offset:0
s_waitcnt lgkmcnt(3)
buffer_store_dwordx4 v[104:107],v9,s[16:19],s87 offen offset:3200 nt
ds_read_b128 a[80:83],v11 offset:128
v_cvt_pk_bf16_f32 v113,v114,v115
ds_read_b128 a[84:87],v12 offset:128
v_cvt_pk_bf16_f32 v120,v120,v121
ds_read_b128 a[88:91],v11 offset:256
v_cvt_pk_bf16_f32 v124,v124,v125
ds_read_b128 a[92:95],v12 offset:256
buffer_store_dwordx4 v[108:111],v9,s[16:19],s66 offen offset:128 nt
v_cvt_pk_bf16_f32 v125,v126,v127
v_cvt_pk_bf16_f32 v121,v122,v123
v_cvt_pk_bf16_f32 v216,v216,v217
v_cvt_pk_bf16_f32 v252,v252,v253
v_cvt_pk_bf16_f32 v253,v254,v255
v_cvt_pk_bf16_f32 v232,v232,v233
v_cvt_pk_bf16_f32 v233,v234,v235
v_cvt_pk_bf16_f32 v229,v230,v231
v_cvt_pk_bf16_f32 v236,v236,v237
ds_write2st64_b64 v36,v[240:241],v[112:113] offset0:16 offset1:24
v_sub_u32 v36,v36,v19
v_cvt_pk_bf16_f32 v220,v220,v221
v_cvt_pk_bf16_f32 v221,v222,v223
v_cvt_pk_bf16_f32 v237,v238,v239
v_cvt_pk_bf16_f32 v217,v218,v219
v_cvt_pk_bf16_f32 v84,v84,v85
s_waitcnt lgkmcnt(2)
buffer_store_dwordx4 v[212:215],v9,s[16:19],s66 offen offset:3200 nt
v_cvt_pk_bf16_f32 v85,v86,v87
v_cvt_pk_bf16_f32 v96,v96,v97
v_cvt_pk_bf16_f32 v92,v92,v93
v_cvt_pk_bf16_f32 v93,v94,v95
v_cvt_pk_bf16_f32 v97,v98,v99
v_max3_f32 v44,v72,v73,v74
v_max_f32 v44,v44,v75
v_mov_b32 v45,v44
v_max3_f32 v48,v80,v81,v82
v_max_f32 v48,v48,v83
v_permlane32_swap_b32 v45,v44
ds_write2st64_b64 v37,v[244:245],v[116:117] offset0:16 offset1:24
v_sub_u32 v37,v37,v19
v_max_f32 v44,v44,v45
v_mov_b32 v45,v44
v_mov_b32 v49,v48
v_max3_f32 v52,v88,v89,v90
v_permlane16_swap_b32 v45,v44
v_max_f32 v44,v44,v45
v_mul_f32_e64 v13,-s36,v44
v_fma_f32 v73,v73,s36,v13
v_exp_f32 v73,v73
v_fma_f32 v72,v72,s36,v13
v_fma_f32 v74,v74,s36,v13
v_exp_f32 v74,v74
ds_write2st64_b64 v38,v[248:249],v[120:121] offset0:16 offset1:24
v_sub_u32 v38,v38,v19
v_fma_f32 v75,v75,s36,v13
v_exp_f32 v75,v75
v_exp_f32 v72,v72
v_cvt_pk_bf16_f32 v21,v74,v75
v_cvt_pk_bf16_f32 v20,v72,v73
v_permlane32_swap_b32 v49,v48
v_max_f32 v48,v48,v49
v_mov_b32 v49,v48
v_max_f32 v52,v52,v91
v_mov_b32 v53,v52
ds_write2st64_b64 v39,v[252:253],v[124:125] offset0:16 offset1:24
v_sub_u32 v39,v39,v19
v_permlane16_swap_b32 v49,v48
v_max_f32 v48,v48,v49
v_mul_f32_e64 v14,-s36,v48
v_fma_f32 v83,v83,s36,v14
v_fma_f32 v81,v81,s36,v14
v_exp_f32 v83,v83
v_fma_f32 v82,v82,s36,v14
v_exp_f32 v81,v81
v_exp_f32 v82,v82
v_fma_f32 v80,v80,s36,v14
ds_write2st64_b64 v36,v[228:229],v[216:217] offset0:36 offset1:40
v_add_u32 v36,v36,v19
v_exp_f32 v80,v80
v_cvt_pk_bf16_f32 v25,v82,v83
v_cvt_pk_bf16_f32 v24,v80,v81
v_permlane32_swap_b32 v53,v52
v_max_f32 v52,v52,v53
v_mov_b32 v53,v52
v_cvt_pk_bf16_f32 v128,v128,v129
v_cvt_pk_bf16_f32 v144,v144,v145
v_permlane16_swap_b32 v53,v52
v_max_f32 v52,v52,v53
ds_write2st64_b64 v37,v[232:233],v[220:221] offset0:36 offset1:40
v_add_u32 v37,v37,v19
v_mul_f32_e64 v15,-s36,v52
v_fma_f32 v88,v88,s36,v15
v_fma_f32 v89,v89,s36,v15
v_fma_f32 v90,v90,s36,v15
v_exp_f32 v89,v89
v_fma_f32 v91,v91,s36,v15
v_exp_f32 v91,v91
v_exp_f32 v88,v88
v_exp_f32 v90,v90
v_cvt_pk_bf16_f32 v28,v88,v89
ds_write2st64_b64 v38,v[236:237],v[84:85] offset0:36 offset1:40
v_add_u32 v38,v38,v19
v_cvt_pk_bf16_f32 v29,v90,v91
v_cvt_pk_bf16_f32 v132,v132,v133
v_cvt_pk_bf16_f32 v129,v130,v131
v_cvt_pk_bf16_f32 v145,v146,v147
v_cvt_pk_bf16_f32 v148,v148,v149
v_cvt_pk_bf16_f32 v149,v150,v151
v_cvt_pk_bf16_f32 v133,v134,v135
v_mov_b32 v65,0
v_mov_b32 v66,0
v_mov_b32 v62,0
v_mov_b32 v67,0
v_mov_b32 v61,0
v_mov_b32 v63,0
ds_write2st64_b64 v39,v[92:93],v[96:97] offset0:36 offset1:40
v_mfma_f32_16x16x32_bf16 v[96:99],a[120:123],a[72:75],0
s_mov_b32 s42,s41
v_add_u32 v39,v39,v19
s_add_u32 s69,s69,1
s_lshl_b32 s62,s69,5
ds_read_b128 v[100:103],v10 offset:18432
s_add_u32 s62,s62,s34
ds_read_b128 a[120:123],v0 offset:6272
v_pk_mul_f32 v[154:155],v[154:155],v[64:65] op_sel_hi:[1,0]
ds_read_b128 v[208:211],v10 offset:19456
v_pk_mul_f32 v[136:137],v[136:137],v[64:65] op_sel_hi:[1,0]
v_pk_mul_f32 v[152:153],v[152:153],v[64:65] op_sel_hi:[1,0]
v_pk_mul_f32 v[138:139],v[138:139],v[64:65] op_sel_hi:[1,0]
v_cvt_pk_bf16_f32 v152,v152,v153
v_cvt_pk_bf16_f32 v136,v136,v137
v_mfma_f32_16x16x32_bf16 v[96:99],a[124:127],a[76:79],v[96:99]
s_mul_i32 s63,s62,171
ds_read_b128 v[224:227],v10 offset:20480
v_cvt_pk_bf16_f32 v153,v154,v155
v_mfma_f32_16x16x32_bf16 v[96:99],a[128:131],a[80:83],v[96:99]
s_lshr_b32 s63,s63,9
ds_read_b128 v[240:243],v10 offset:21504
v_cvt_pk_bf16_f32 v137,v138,v139
v_mfma_f32_16x16x32_bf16 v[96:99],a[132:135],a[84:87],v[96:99]
s_mul_i32 s64,s63,3
ds_write2st64_b64 v36,v[128:129],v[144:145] offset0:26 offset1:28
v_pk_mul_f32 v[156:157],v[156:157],v[64:65] op_sel_hi:[1,0]
v_pk_mul_f32 v[142:143],v[142:143],v[64:65] op_sel_hi:[1,0]
v_pk_mul_f32 v[158:159],v[158:159],v[64:65] op_sel_hi:[1,0]
ds_read_b128 a[124:127],v1 offset:6272
s_waitcnt lgkmcnt(5)
buffer_store_dwordx4 v[100:103],v9,s[16:19],s87 offen offset:256 nt
ds_read_b128 a[128:131],v0 offset:6400
v_pk_mul_f32 v[140:141],v[140:141],v[64:65] op_sel_hi:[1,0]
v_cvt_pk_bf16_f32 v156,v156,v157
v_cvt_pk_bf16_f32 v157,v158,v159
v_mfma_f32_16x16x32_bf16 v[96:99],a[136:139],a[88:91],v[96:99]
s_sub_u32 s62,s62,s64
ds_read_b128 a[132:135],v1 offset:6400
v_cvt_pk_bf16_f32 v140,v140,v141
v_mfma_f32_16x16x32_bf16 v[96:99],a[140:143],a[92:95],v[96:99]
s_add_u32 s63,s63,s33
ds_write2st64_b64 v37,v[132:133],v[148:149] offset0:26 offset1:28
v_mfma_f32_16x16x32_bf16 v[76:79],a[144:147],a[0:3],0
s_mul_i32 s30,s63,196608
v_cvt_pk_bf16_f32 v141,v142,v143
ds_read_b128 a[136:139],v0 offset:12288
s_waitcnt lgkmcnt(5)
buffer_store_dwordx4 v[208:211],v9,s[16:19],s87 offen offset:3328 nt
ds_read_b128 a[140:143],v1 offset:12288
v_pk_mul_f32 v[178:179],v[178:179],v[60:61] op_sel_hi:[1,0]
v_pk_mul_f32 v[176:177],v[176:177],v[60:61] op_sel_hi:[1,0]
v_pk_mul_f32 v[160:161],v[160:161],v[60:61] op_sel_hi:[1,0]
v_pk_mul_f32 v[162:163],v[162:163],v[60:61] op_sel_hi:[1,0]
v_max3_f32 v56,v96,v97,v98
v_max_f32 v56,v56,v99
v_mfma_f32_16x16x32_bf16 v[76:79],a[148:151],a[4:7],v[76:79]
s_mul_i32 s41,s63,325632
v_mov_b32 v57,v56
v_cvt_pk_bf16_f32 v176,v176,v177
v_mfma_f32_16x16x32_bf16 v[76:79],a[120:123],a[8:11],v[76:79]
s_lshl_b32 s63,s3,2
ds_write2st64_b64 v38,v[136:137],v[152:153] offset0:26 offset1:28
s_waitcnt lgkmcnt(3)
v_mfma_f32_16x16x32_bf16 v[76:79],a[124:127],a[12:15],v[76:79]
s_add_u32 s64,s63,21
v_permlane32_swap_b32 v57,v56
v_mfma_f32_16x16x32_bf16 v[76:79],a[128:131],a[16:19],v[76:79]
s_cmp_eq_u32 s3,0
buffer_store_dwordx4 v[224:227],v9,s[16:19],s66 offen offset:256 nt
v_max_f32 v56,v56,v57
v_mov_b32 v57,v56
v_pk_mul_f32 v[164:165],v[164:165],v[60:61] op_sel_hi:[1,0]
v_pk_mul_f32 v[166:167],v[166:167],v[60:61] op_sel_hi:[1,0]
v_pk_mul_f32 v[182:183],v[182:183],v[60:61] op_sel_hi:[1,0]
v_pk_mul_f32 v[180:181],v[180:181],v[60:61] op_sel_hi:[1,0]
v_permlane16_swap_b32 v57,v56
v_max_f32 v56,v56,v57
v_mfma_f32_16x16x32_bf16 v[76:79],a[132:135],a[20:23],v[76:79]
s_cselect_b32 s64,20,s64
ds_write2st64_b64 v39,v[140:141],v[156:157] offset0:26 offset1:28
v_mfma_f32_16x16x32_bf16 v[84:87],a[132:135],a[44:47],0
s_cselect_b32 s40,1,0
v_mul_f32_e64 v16,-s36,v56
v_fma_f32 v96,v96,s36,v16
v_mfma_f32_16x16x32_bf16 v[84:87],a[128:131],a[40:43],v[84:87]
s_add_u32 s65,s63,37
buffer_store_dwordx4 v[240:243],v9,s[16:19],s66 offen offset:3328 nt
v_fma_f32 v97,v97,s36,v16
v_fma_f32 v98,v98,s36,v16
v_pk_mul_f32 v[170:171],v[170:171],v[60:61] op_sel_hi:[1,0]
v_pk_mul_f32 v[184:185],v[184:185],v[60:61] op_sel_hi:[1,0]
v_pk_mul_f32 v[186:187],v[186:187],v[60:61] op_sel_hi:[1,0]
v_pk_mul_f32 v[168:169],v[168:169],v[60:61] op_sel_hi:[1,0]
v_exp_f32 v97,v97
v_fma_f32 v99,v99,s36,v16
v_mfma_f32_16x16x32_bf16 v[84:87],a[124:127],a[36:39],v[84:87]
s_cmp_eq_u32 s62,2
v_exp_f32 v98,v98
v_mfma_f32_16x16x32_bf16 v[84:87],a[120:123],a[32:35],v[84:87]
s_cselect_b32 s64,s65,s64
v_exp_f32 v96,v96
v_mfma_f32_16x16x32_bf16 v[84:87],a[148:151],a[28:31],v[84:87]
s_cselect_b32 s40,0,s40
v_exp_f32 v99,v99
v_cvt_pk_bf16_f32 v32,v96,v97
v_cvt_pk_bf16_f32 v33,v98,v99
v_fma_f32 v78,v78,s36,v13
v_pk_mul_f32 v[172:173],v[172:173],v[60:61] op_sel_hi:[1,0]
v_pk_mul_f32 v[190:191],v[190:191],v[60:61] op_sel_hi:[1,0]
v_pk_mul_f32 v[174:175],v[174:175],v[60:61] op_sel_hi:[1,0]
v_pk_mul_f32 v[188:189],v[188:189],v[60:61] op_sel_hi:[1,0]
v_fma_f32 v76,v76,s36,v13
v_exp_f32 v76,v76
v_mfma_f32_16x16x32_bf16 v[84:87],a[144:147],a[24:27],v[84:87]
s_add_u32 s65,s63,s3
v_fma_f32 v77,v77,s36,v13
v_exp_f32 v77,v77
v_mfma_f32_16x16x32_bf16 v[92:95],a[144:147],a[48:51],0
s_cmp_eq_u32 s62,0
v_fma_f32 v79,v79,s36,v13
v_exp_f32 v79,v79
v_mfma_f32_16x16x32_bf16 v[92:95],a[148:151],a[52:55],v[92:95]
s_cselect_b32 s64,s65,s64
v_exp_f32 v78,v78
v_cvt_pk_bf16_f32 v22,v76,v77
v_cvt_pk_bf16_f32 v23,v78,v79
v_cvt_pk_bf16_f32 v180,v180,v181
v_pk_mul_f32 v[192:193],v[192:193],v[60:61] op_sel_hi:[1,0]
v_pk_mul_f32 v[194:195],v[194:195],v[60:61] op_sel_hi:[1,0]
v_cvt_pk_bf16_f32 v184,v184,v185
v_cvt_pk_bf16_f32 v164,v164,v165
v_mfma_f32_16x16x32_bf16 v[92:95],a[120:123],a[56:59],v[92:95]
s_cselect_b32 s40,1,s40
v_cvt_pk_bf16_f32 v165,v166,v167
v_cvt_pk_bf16_f32 v160,v160,v161
v_mfma_f32_16x16x32_bf16 v[92:95],a[124:127],a[60:63],v[92:95]
s_mul_i32 s64,s64,6144
v_cvt_pk_bf16_f32 v172,v172,v173
v_cvt_pk_bf16_f32 v161,v162,v163
v_mfma_f32_16x16x32_bf16 v[92:95],a[128:131],a[64:67],v[92:95]
s_add_u32 s41,s41,s64
v_cvt_pk_bf16_f32 v181,v182,v183
v_cvt_pk_bf16_f32 v177,v178,v179
v_mfma_f32_16x16x32_bf16 v[92:95],a[132:135],a[68:71],v[92:95]
s_cmp_ge_u32 s69,6
ds_write2st64_b64 v36,v[160:161],v[176:177] offset0:0 offset1:2
v_pk_mul_f32 v[196:197],v[196:197],v[60:61] op_sel_hi:[1,0]
v_pk_mul_f32 v[198:199],v[198:199],v[60:61] op_sel_hi:[1,0]
v_cvt_pk_bf16_f32 v188,v188,v189
v_cvt_pk_bf16_f32 v192,v192,v193
v_mfma_f32_16x16x32_bf16 v[100:103],a[132:135],a[92:95],0
s_cselect_b32 s41,166723584,s41
ds_read_b128 a[132:135],v1 offset:18432
v_cvt_pk_bf16_f32 v168,v168,v169
v_mfma_f32_16x16x32_bf16 v[100:103],a[128:131],a[88:91],v[100:103]
s_cselect_b32 s30,100663296,s30
ds_read_b128 a[128:131],v0 offset:18432
v_cvt_pk_bf16_f32 v169,v170,v171
v_mfma_f32_16x16x32_bf16 v[100:103],a[124:127],a[84:87],v[100:103]
s_add_u32 s25,s30,s22
ds_read_b128 a[124:127],v1 offset:12544
v_cvt_pk_bf16_f32 v185,v186,v187
ds_write2st64_b64 v37,v[164:165],v[180:181] offset0:0 offset1:2
v_pk_mul_f32 v[202:203],v[202:203],v[60:61] op_sel_hi:[1,0]
v_pk_mul_f32 v[200:201],v[200:201],v[60:61] op_sel_hi:[1,0]
v_cvt_pk_bf16_f32 v196,v196,v197
v_mov_b32 v64,0
v_mfma_f32_16x16x32_bf16 v[100:103],a[120:123],a[80:83],v[100:103]
s_add_u32 s26,s25,12288
ds_read_b128 a[120:123],v0 offset:12544
v_cvt_pk_bf16_f32 v189,v190,v191
v_mfma_f32_16x16x32_bf16 v[100:103],a[148:151],a[76:79],v[100:103]
s_add_u32 m0,s23,24576
ds_read_b128 a[148:151],v1 offset:12416
buffer_load_dwordx4 v6,s[8:11],s21 offen offset:0 lds
v_mfma_f32_16x16x32_bf16 v[100:103],a[144:147],a[72:75],v[100:103]
s_mov_b32 s28,s41
ds_read_b128 a[144:147],v0 offset:12416
buffer_load_dwordx4 v7,s[8:11],s21 offen offset:1024 lds
buffer_load_dwordx4 v8,s[8:11],s21 offen offset:2048 lds
ds_write2st64_b64 v38,v[168:169],v[184:185] offset0:0 offset1:2
v_pk_mul_f32 v[206:207],v[206:207],v[60:61] op_sel_hi:[1,0]
v_pk_mul_f32 v[204:205],v[204:205],v[60:61] op_sel_hi:[1,0]
v_mov_b32 v60,0
v_cvt_pk_bf16_f32 v173,v174,v175
s_waitcnt lgkmcnt(4)
v_mfma_f32_16x16x32_bf16 v[72:75],a[124:127],a[20:23],0
s_add_u32 s21,s21,12288
v_cvt_pk_bf16_f32 v200,v200,v201
v_cvt_pk_bf16_f32 v197,v198,v199
s_waitcnt lgkmcnt(3)
v_mfma_f32_16x16x32_bf16 v[72:75],a[120:123],a[16:19],v[72:75]
s_add_u32 m0,s22,0
v_cvt_pk_bf16_f32 v193,v194,v195
v_cvt_pk_bf16_f32 v201,v202,v203
s_waitcnt lgkmcnt(2)
v_mfma_f32_16x16x32_bf16 v[72:75],a[148:151],a[12:15],v[72:75]
s_mov_b32 s29,s24
ds_write2st64_b64 v39,v[172:173],v[188:189] offset0:0 offset1:2
s_waitcnt lgkmcnt(2)
v_mfma_f32_16x16x32_bf16 v[72:75],a[144:147],a[8:11],v[72:75]
v_fma_f32 v85,v85,s36,v14
v_exp_f32 v85,v85
v_mfma_f32_16x16x32_bf16 v[72:75],a[140:143],a[4:7],v[72:75]
v_fma_f32 v87,v87,s36,v14
v_fma_f32 v84,v84,s36,v14
v_mfma_f32_16x16x32_bf16 v[72:75],a[136:139],a[0:3],v[72:75]
v_exp_f32 v84,v84
v_mfma_f32_16x16x32_bf16 v[80:83],a[136:139],a[24:27],0
ds_write_b64 v36,v[192:193] offset:2048
v_mfma_f32_16x16x32_bf16 v[80:83],a[140:143],a[28:31],v[80:83]
v_fma_f32 v86,v86,s36,v14
v_exp_f32 v86,v86
v_mfma_f32_16x16x32_bf16 v[80:83],a[144:147],a[32:35],v[80:83]
ds_write_b64 v37,v[196:197] offset:2048
v_mfma_f32_16x16x32_bf16 v[80:83],a[148:151],a[36:39],v[80:83]
v_exp_f32 v87,v87
v_mfma_f32_16x16x32_bf16 v[80:83],a[120:123],a[40:43],v[80:83]
ds_write_b64 v38,v[200:201] offset:2048
v_mfma_f32_16x16x32_bf16 v[80:83],a[124:127],a[44:47],v[80:83]
v_cvt_pk_bf16_f32 v27,v86,v87
v_cvt_pk_bf16_f32 v26,v84,v85
v_mfma_f32_16x16x32_bf16 v[88:91],a[124:127],a[68:71],0
v_fma_f32 v93,v93,s36,v15
v_fma_f32 v94,v94,s36,v15
v_smfmac_f32_16x16x64_bf16 v[60:63],a[152:155],v[20:27],v18
v_exp_f32 v94,v94
v_mfma_f32_16x16x32_bf16 v[88:91],a[120:123],a[64:67],v[88:91]
v_fma_f32 v95,v95,s36,v15
v_exp_f32 v95,v95
v_mfma_f32_16x16x32_bf16 v[88:91],a[148:151],a[60:63],v[88:91]
v_fma_f32 v92,v92,s36,v15
v_exp_f32 v93,v93
v_mfma_f32_16x16x32_bf16 v[88:91],a[144:147],a[56:59],v[88:91]
v_exp_f32 v92,v92
v_mfma_f32_16x16x32_bf16 v[88:91],a[140:143],a[52:55],v[88:91]
v_cvt_pk_bf16_f32 v31,v94,v95
v_cvt_pk_bf16_f32 v30,v92,v93
v_mfma_f32_16x16x32_bf16 v[88:91],a[136:139],a[48:51],v[88:91]
v_fma_f32 v103,v103,s36,v16
v_fma_f32 v101,v101,s36,v16
v_mfma_f32_16x16x32_bf16 v[96:99],a[136:139],a[72:75],0
ds_read_b128 a[136:139],v0 offset:18560
v_fma_f32 v100,v100,s36,v16
v_mfma_f32_16x16x32_bf16 v[96:99],a[140:143],a[76:79],v[96:99]
ds_read_b128 a[140:143],v1 offset:18560
v_fma_f32 v102,v102,s36,v16
v_mfma_f32_16x16x32_bf16 v[96:99],a[144:147],a[80:83],v[96:99]
ds_read_b128 a[144:147],v0 offset:18688
v_exp_f32 v101,v101
v_mfma_f32_16x16x32_bf16 v[96:99],a[148:151],a[84:87],v[96:99]
ds_read_b128 a[148:151],v1 offset:18688
v_exp_f32 v103,v103
v_mfma_f32_16x16x32_bf16 v[96:99],a[120:123],a[88:91],v[96:99]
v_exp_f32 v102,v102
v_mfma_f32_16x16x32_bf16 v[96:99],a[124:127],a[92:95],v[96:99]
v_exp_f32 v100,v100
s_waitcnt vmcnt(11)
s_barrier
v_mfma_f32_16x16x32_bf16 v[76:79],a[128:131],a[0:3],0
v_cvt_pk_bf16_f32 v34,v100,v101
v_cvt_pk_bf16_f32 v35,v102,v103
v_mfma_f32_16x16x32_bf16 v[76:79],a[132:135],a[4:7],v[76:79]
buffer_load_dwordx4 v6,s[4:7],s20 offen offset:0 lds
v_smfmac_f32_16x16x64_bf16 v[64:67],a[152:155],v[28:35],v18
s_waitcnt lgkmcnt(1)
v_fma_f32 v72,v72,s36,v13
v_mfma_f32_16x16x32_bf16 v[76:79],a[136:139],a[8:11],v[76:79]
v_exp_f32 v72,v72
v_mfma_f32_16x16x32_bf16 v[76:79],a[140:143],a[12:15],v[76:79]
v_fma_f32 v80,v80,s36,v14
v_fma_f32 v81,v81,s36,v14
v_mfma_f32_16x16x32_bf16 v[76:79],a[144:147],a[16:19],v[76:79]
s_waitcnt lgkmcnt(0)
v_exp_f32 v80,v80
v_mfma_f32_16x16x32_bf16 v[76:79],a[148:151],a[20:23],v[76:79]
buffer_load_dwordx4 v7,s[4:7],s20 offen offset:1024 lds
v_mfma_f32_16x16x32_bf16 v[84:87],a[148:151],a[44:47],0
v_fma_f32 v75,v75,s36,v13
v_fma_f32 v74,v74,s36,v13
v_mfma_f32_16x16x32_bf16 v[84:87],a[144:147],a[40:43],v[84:87]
v_exp_f32 v81,v81
v_mfma_f32_16x16x32_bf16 v[84:87],a[140:143],a[36:39],v[84:87]
v_exp_f32 v74,v74
v_mfma_f32_16x16x32_bf16 v[84:87],a[136:139],a[32:35],v[84:87]
ds_read_b64_tr_b16 a[122:123],v2 offset:6144
v_fma_f32 v73,v73,s36,v13
v_mfma_f32_16x16x32_bf16 v[84:87],a[132:135],a[28:31],v[84:87]
ds_read_b64_tr_b16 a[120:121],v2 offset:0
v_exp_f32 v73,v73
v_mfma_f32_16x16x32_bf16 v[84:87],a[128:131],a[24:27],v[84:87]
buffer_load_dwordx4 v8,s[4:7],s20 offen offset:2048 lds
v_mfma_f32_16x16x32_bf16 v[92:95],a[128:131],a[48:51],0
s_add_u32 s20,s20,12288
ds_read_b64_tr_b16 a[124:125],v3 offset:0
v_exp_f32 v75,v75
v_mfma_f32_16x16x32_bf16 v[92:95],a[132:135],a[52:55],v[92:95]
ds_read_b64_tr_b16 a[126:127],v3 offset:6144
v_cvt_pk_bf16_f32 v44,v72,v73
v_mfma_f32_16x16x32_bf16 v[92:95],a[136:139],a[56:59],v[92:95]
v_cvt_pk_bf16_f32 v204,v204,v205
v_cvt_pk_bf16_f32 v205,v206,v207
v_mfma_f32_16x16x32_bf16 v[92:95],a[140:143],a[60:63],v[92:95]
ds_write_b64 v39,v[204:205] offset:2048
v_mfma_f32_16x16x32_bf16 v[92:95],a[144:147],a[64:67],v[92:95]
v_cvt_pk_bf16_f32 v45,v74,v75
v_cvt_pk_bf16_f32 v48,v80,v81
v_mfma_f32_16x16x32_bf16 v[92:95],a[148:151],a[68:71],v[92:95]
v_mfma_f32_16x16x32_bf16 v[100:103],a[148:151],a[92:95],0
v_mfma_f32_16x16x32_bf16 v[100:103],a[144:147],a[88:91],v[100:103]
v_mfma_f32_16x16x32_bf16 v[100:103],a[140:143],a[84:87],v[100:103]
v_mfma_f32_16x16x32_bf16 v[100:103],a[136:139],a[80:83],v[100:103]
v_mfma_f32_16x16x32_bf16 v[100:103],a[132:135],a[76:79],v[100:103]
ds_read_b64_tr_b16 a[132:133],v5 offset:0
v_mfma_f32_16x16x32_bf16 v[100:103],a[128:131],a[72:75],v[100:103]
s_waitcnt lgkmcnt(1)
ds_read_b64_tr_b16 a[130:131],v4 offset:6144
ds_read_b64_tr_b16 a[134:135],v5 offset:6144
ds_read_b64_tr_b16 a[128:129],v4 offset:0
v_mfma_f32_16x16x32_bf16 v[160:163],a[120:123],v[20:23],0
s_add_u32 m0,s23,0
ds_read_b64_tr_b16 a[136:137],v2 offset:128
v_fma_f32 v82,v82,s36,v14
v_mfma_f32_16x16x32_bf16 v[164:167],a[124:127],v[20:23],0
ds_read_b64_tr_b16 a[138:139],v2 offset:6272
v_fma_f32 v83,v83,s36,v14
v_mfma_f32_16x16x32_bf16 v[212:215],a[124:127],v[24:27],0
ds_read_b64_tr_b16 a[140:141],v3 offset:128
v_fma_f32 v88,v88,s36,v15
v_mfma_f32_16x16x32_bf16 v[208:211],a[120:123],v[24:27],0
ds_read_b64_tr_b16 a[142:143],v3 offset:6272
v_fma_f32 v89,v89,s36,v15
v_mfma_f32_16x16x32_bf16 v[112:115],a[120:123],v[28:31],0
ds_read_b64_tr_b16 a[144:145],v4 offset:128
v_fma_f32 v90,v90,s36,v15
v_mfma_f32_16x16x32_bf16 v[116:119],a[124:127],v[28:31],0
ds_read_b64_tr_b16 a[146:147],v4 offset:6272
v_fma_f32 v91,v91,s36,v15
v_mfma_f32_16x16x32_bf16 a[164:167],a[124:127],v[32:35],0
ds_read_b64_tr_b16 a[148:149],v5 offset:128
v_fma_f32 v96,v96,s36,v16
v_mfma_f32_16x16x32_bf16 a[160:163],a[120:123],v[32:35],0
s_waitcnt lgkmcnt(6)
ds_read_b64_tr_b16 a[150:151],v5 offset:6272
v_fma_f32 v97,v97,s36,v16
v_mfma_f32_16x16x32_bf16 a[168:171],a[128:131],v[32:35],0
ds_read_b64_tr_b16 a[120:121],v2 offset:256
v_fma_f32 v98,v98,s36,v16
v_mfma_f32_16x16x32_bf16 a[172:175],a[132:135],v[32:35],0
ds_read_b64_tr_b16 a[122:123],v2 offset:6400
v_fma_f32 v99,v99,s36,v16
v_mfma_f32_16x16x32_bf16 v[124:127],a[132:135],v[28:31],0
ds_read_b64_tr_b16 a[124:125],v3 offset:256
v_fma_f32 v76,v76,s36,v13
v_mfma_f32_16x16x32_bf16 v[120:123],a[128:131],v[28:31],0
ds_read_b64_tr_b16 a[126:127],v3 offset:6400
v_fma_f32 v77,v77,s36,v13
v_mfma_f32_16x16x32_bf16 v[216:219],a[128:131],v[24:27],0
v_exp_f32 v82,v82
v_mfma_f32_16x16x32_bf16 v[220:223],a[132:135],v[24:27],0
v_exp_f32 v83,v83
v_mfma_f32_16x16x32_bf16 v[172:175],a[132:135],v[20:23],0
ds_read_b64_tr_b16 a[132:133],v5 offset:256
v_cvt_pk_bf16_f32 v49,v82,v83
v_mfma_f32_16x16x32_bf16 v[168:171],a[128:131],v[20:23],0
s_waitcnt lgkmcnt(4)
ds_read_b64_tr_b16 a[128:129],v4 offset:256
v_fma_f32 v78,v78,s36,v13
v_mfma_f32_16x16x32_bf16 v[176:179],a[136:139],v[20:23],0
ds_read_b64_tr_b16 a[130:131],v4 offset:6400
v_fma_f32 v79,v79,s36,v13
v_mfma_f32_16x16x32_bf16 v[180:183],a[140:143],v[20:23],0
ds_read_b64_tr_b16 a[134:135],v5 offset:6400
v_fma_f32 v84,v84,s36,v14
v_mfma_f32_16x16x32_bf16 v[228:231],a[140:143],v[24:27],0
v_exp_f32 v88,v88
v_mfma_f32_16x16x32_bf16 v[224:227],a[136:139],v[24:27],0
v_exp_f32 v89,v89
v_mfma_f32_16x16x32_bf16 v[128:131],a[136:139],v[28:31],0
v_exp_f32 v90,v90
v_mfma_f32_16x16x32_bf16 v[132:135],a[140:143],v[28:31],0
v_exp_f32 v91,v91
v_mfma_f32_16x16x32_bf16 a[180:183],a[140:143],v[32:35],0
v_cvt_pk_bf16_f32 v52,v88,v89
v_cvt_pk_bf16_f32 v53,v90,v91
v_mfma_f32_16x16x32_bf16 a[176:179],a[136:139],v[32:35],0
v_exp_f32 v96,v96
v_mfma_f32_16x16x32_bf16 a[184:187],a[144:147],v[32:35],0
v_exp_f32 v97,v97
v_mfma_f32_16x16x32_bf16 a[188:191],a[148:151],v[32:35],0
v_exp_f32 v98,v98
v_mfma_f32_16x16x32_bf16 v[140:143],a[148:151],v[28:31],0
v_exp_f32 v99,v99
v_mfma_f32_16x16x32_bf16 v[136:139],a[144:147],v[28:31],0
v_cvt_pk_bf16_f32 v56,v96,v97
v_cvt_pk_bf16_f32 v57,v98,v99
v_mfma_f32_16x16x32_bf16 v[232:235],a[144:147],v[24:27],0
v_exp_f32 v76,v76
v_mfma_f32_16x16x32_bf16 v[236:239],a[148:151],v[24:27],0
v_exp_f32 v77,v77
v_mfma_f32_16x16x32_bf16 v[188:191],a[148:151],v[20:23],0
v_exp_f32 v78,v78
v_mfma_f32_16x16x32_bf16 v[184:187],a[144:147],v[20:23],0
s_waitcnt lgkmcnt(0)
v_exp_f32 v79,v79
v_mfma_f32_16x16x32_bf16 v[192:195],a[120:123],v[20:23],0
s_waitcnt vmcnt(30)
v_cvt_pk_bf16_f32 v46,v76,v77
v_cvt_pk_bf16_f32 v47,v78,v79
v_mfma_f32_16x16x32_bf16 v[196:199],a[124:127],v[20:23],0
s_barrier
v_mfma_f32_16x16x32_bf16 v[244:247],a[124:127],v[24:27],0
ds_read_b128 a[148:151],v1 offset:24704
v_fma_f32 v85,v85,s36,v14
v_mfma_f32_16x16x32_bf16 v[240:243],a[120:123],v[24:27],0
ds_read_b128 a[144:147],v0 offset:24704
v_fma_f32 v86,v86,s36,v14
v_mfma_f32_16x16x32_bf16 v[144:147],a[120:123],v[28:31],0
ds_read_b128 a[140:143],v1 offset:24576
v_fma_f32 v87,v87,s36,v14
v_mfma_f32_16x16x32_bf16 v[148:151],a[124:127],v[28:31],0
ds_read_b128 a[136:139],v0 offset:24576
v_fma_f32 v92,v92,s36,v15
v_mfma_f32_16x16x32_bf16 a[196:199],a[124:127],v[32:35],0
ds_read_b128 a[124:127],v1 offset:24832
v_fma_f32 v93,v93,s36,v15
v_mfma_f32_16x16x32_bf16 a[192:195],a[120:123],v[32:35],0
buffer_load_dwordx4 v6,s[8:11],s21 offen offset:0 lds
v_mfma_f32_16x16x32_bf16 a[200:203],a[128:131],v[32:35],0
ds_read_b128 a[120:123],v0 offset:24832
v_fma_f32 v94,v94,s36,v15
v_mfma_f32_16x16x32_bf16 a[204:207],a[132:135],v[32:35],0
v_exp_f32 v84,v84
v_mfma_f32_16x16x32_bf16 v[156:159],a[132:135],v[28:31],0
v_exp_f32 v85,v85
v_mfma_f32_16x16x32_bf16 v[152:155],a[128:131],v[28:31],0
v_exp_f32 v86,v86
v_mfma_f32_16x16x32_bf16 v[248:251],a[128:131],v[24:27],0
v_exp_f32 v87,v87
v_mfma_f32_16x16x32_bf16 v[252:255],a[132:135],v[24:27],0
v_cvt_pk_bf16_f32 v50,v84,v85
v_cvt_pk_bf16_f32 v51,v86,v87
v_mfma_f32_16x16x32_bf16 v[204:207],a[132:135],v[20:23],0
ds_read_b128 a[132:135],v1 offset:30720
v_fma_f32 v95,v95,s36,v15
v_smfmac_f32_16x16x64_bf16 v[60:63],a[152:155],v[44:51],v18
v_fma_f32 v100,v100,s36,v16
v_mfma_f32_16x16x32_bf16 v[200:203],a[128:131],v[20:23],0
buffer_load_dwordx4 v7,s[8:11],s21 offen offset:1024 lds
s_waitcnt lgkmcnt(1)
v_mfma_f32_16x16x32_bf16 v[72:75],a[124:127],a[20:23],0
ds_read_b128 a[128:131],v0 offset:30720
v_fma_f32 v101,v101,s36,v16
v_mfma_f32_16x16x32_bf16 v[72:75],a[120:123],a[16:19],v[72:75]
v_exp_f32 v92,v92
v_mfma_f32_16x16x32_bf16 v[72:75],a[148:151],a[12:15],v[72:75]
v_exp_f32 v93,v93
v_mfma_f32_16x16x32_bf16 v[72:75],a[144:147],a[8:11],v[72:75]
v_exp_f32 v94,v94
v_mfma_f32_16x16x32_bf16 v[72:75],a[140:143],a[4:7],v[72:75]
v_exp_f32 v95,v95
v_mfma_f32_16x16x32_bf16 v[72:75],a[136:139],a[0:3],v[72:75]
v_cvt_pk_bf16_f32 v54,v92,v93
v_cvt_pk_bf16_f32 v55,v94,v95
v_mfma_f32_16x16x32_bf16 v[80:83],a[136:139],a[24:27],0
v_fma_f32 v102,v102,s36,v16
v_fma_f32 v103,v103,s36,v16
v_mfma_f32_16x16x32_bf16 v[80:83],a[140:143],a[28:31],v[80:83]
v_exp_f32 v100,v100
v_mfma_f32_16x16x32_bf16 v[80:83],a[144:147],a[32:35],v[80:83]
buffer_load_dwordx4 v8,s[8:11],s21 offen offset:2048 lds
v_mfma_f32_16x16x32_bf16 v[80:83],a[148:151],a[36:39],v[80:83]
s_add_u32 s21,s21,12288
v_exp_f32 v101,v101
v_mfma_f32_16x16x32_bf16 v[80:83],a[120:123],a[40:43],v[80:83]
s_add_u32 m0,s22,12288
v_exp_f32 v102,v102
v_mfma_f32_16x16x32_bf16 v[80:83],a[124:127],a[44:47],v[80:83]
v_exp_f32 v103,v103
v_mfma_f32_16x16x32_bf16 v[88:91],a[124:127],a[68:71],0
v_cvt_pk_bf16_f32 v58,v100,v101
v_cvt_pk_bf16_f32 v59,v102,v103
v_mfma_f32_16x16x32_bf16 v[88:91],a[120:123],a[64:67],v[88:91]
v_fma_f32 v72,v72,s36,v13
v_fma_f32 v73,v73,s36,v13
v_smfmac_f32_16x16x64_bf16 v[64:67],a[152:155],v[52:59],v18
v_fma_f32 v74,v74,s36,v13
v_mfma_f32_16x16x32_bf16 v[88:91],a[148:151],a[60:63],v[88:91]
v_fma_f32 v75,v75,s36,v13
v_fma_f32 v80,v80,s36,v14
v_mfma_f32_16x16x32_bf16 v[88:91],a[144:147],a[56:59],v[88:91]
v_fma_f32 v81,v81,s36,v14
v_mfma_f32_16x16x32_bf16 v[88:91],a[140:143],a[52:55],v[88:91]
buffer_load_dwordx4 v6,s[4:7],s20 offen offset:0 lds
v_mfma_f32_16x16x32_bf16 v[88:91],a[136:139],a[48:51],v[88:91]
v_exp_f32 v72,v72
v_mfma_f32_16x16x32_bf16 v[96:99],a[136:139],a[72:75],0
ds_read_b128 a[136:139],v0 offset:30848
v_mfma_f32_16x16x32_bf16 v[96:99],a[140:143],a[76:79],v[96:99]
ds_read_b128 a[140:143],v1 offset:30848
v_mfma_f32_16x16x32_bf16 v[96:99],a[144:147],a[80:83],v[96:99]
ds_read_b128 a[144:147],v0 offset:30976
v_mfma_f32_16x16x32_bf16 v[96:99],a[148:151],a[84:87],v[96:99]
ds_read_b128 a[148:151],v1 offset:30976
v_mfma_f32_16x16x32_bf16 v[96:99],a[120:123],a[88:91],v[96:99]
v_exp_f32 v73,v73
v_mfma_f32_16x16x32_bf16 v[96:99],a[124:127],a[92:95],v[96:99]
s_waitcnt lgkmcnt(4)
v_exp_f32 v74,v74
v_mfma_f32_16x16x32_bf16 v[76:79],a[128:131],a[0:3],0
v_exp_f32 v75,v75
v_mfma_f32_16x16x32_bf16 v[76:79],a[132:135],a[4:7],v[76:79]
buffer_load_dwordx4 v7,s[4:7],s20 offen offset:1024 lds
s_waitcnt lgkmcnt(3)
v_mfma_f32_16x16x32_bf16 v[76:79],a[136:139],a[8:11],v[76:79]
s_waitcnt lgkmcnt(2)
v_exp_f32 v80,v80
v_mfma_f32_16x16x32_bf16 v[76:79],a[140:143],a[12:15],v[76:79]
s_waitcnt lgkmcnt(0)
v_exp_f32 v81,v81
v_mfma_f32_16x16x32_bf16 v[76:79],a[144:147],a[16:19],v[76:79]
v_cvt_pk_bf16_f32 v20,v72,v73
v_cvt_pk_bf16_f32 v21,v74,v75
v_mfma_f32_16x16x32_bf16 v[76:79],a[148:151],a[20:23],v[76:79]
v_cvt_pk_bf16_f32 v24,v80,v81
v_mfma_f32_16x16x32_bf16 v[84:87],a[148:151],a[44:47],0
v_mfma_f32_16x16x32_bf16 v[84:87],a[144:147],a[40:43],v[84:87]
v_mfma_f32_16x16x32_bf16 v[84:87],a[140:143],a[36:39],v[84:87]
v_mfma_f32_16x16x32_bf16 v[84:87],a[136:139],a[32:35],v[84:87]
v_mfma_f32_16x16x32_bf16 v[84:87],a[132:135],a[28:31],v[84:87]
buffer_load_dwordx4 v8,s[4:7],s20 offen offset:2048 lds
v_mfma_f32_16x16x32_bf16 v[84:87],a[128:131],a[24:27],v[84:87]
s_add_u32 s20,s20,12288
v_mfma_f32_16x16x32_bf16 v[92:95],a[128:131],a[48:51],0
ds_read_b64_tr_b16 a[120:121],v2 offset:12288
v_mfma_f32_16x16x32_bf16 v[92:95],a[132:135],a[52:55],v[92:95]
ds_read_b64_tr_b16 a[122:123],v2 offset:18432
v_mfma_f32_16x16x32_bf16 v[92:95],a[136:139],a[56:59],v[92:95]
ds_read_b64_tr_b16 a[124:125],v3 offset:12288
v_mfma_f32_16x16x32_bf16 v[92:95],a[140:143],a[60:63],v[92:95]
ds_read_b64_tr_b16 a[126:127],v3 offset:18432
v_mfma_f32_16x16x32_bf16 v[92:95],a[144:147],a[64:67],v[92:95]
v_mfma_f32_16x16x32_bf16 v[92:95],a[148:151],a[68:71],v[92:95]
v_mfma_f32_16x16x32_bf16 v[100:103],a[148:151],a[92:95],0
v_mfma_f32_16x16x32_bf16 v[100:103],a[144:147],a[88:91],v[100:103]
v_mfma_f32_16x16x32_bf16 v[100:103],a[140:143],a[84:87],v[100:103]
v_mfma_f32_16x16x32_bf16 v[100:103],a[136:139],a[80:83],v[100:103]
v_mfma_f32_16x16x32_bf16 v[100:103],a[132:135],a[76:79],v[100:103]
ds_read_b64_tr_b16 a[132:133],v5 offset:12288
v_mfma_f32_16x16x32_bf16 v[100:103],a[128:131],a[72:75],v[100:103]
s_waitcnt lgkmcnt(1)
ds_read_b64_tr_b16 a[128:129],v4 offset:12288
ds_read_b64_tr_b16 a[130:131],v4 offset:18432
ds_read_b64_tr_b16 a[134:135],v5 offset:18432
v_mfma_f32_16x16x32_bf16 v[160:163],a[120:123],v[44:47],v[160:163]
s_add_u32 m0,s23,12288
ds_read_b64_tr_b16 a[136:137],v2 offset:12416
v_fma_f32 v82,v82,s36,v14
v_mfma_f32_16x16x32_bf16 v[164:167],a[124:127],v[44:47],v[164:167]
ds_read_b64_tr_b16 a[138:139],v2 offset:18560
v_fma_f32 v83,v83,s36,v14
v_mfma_f32_16x16x32_bf16 v[212:215],a[124:127],v[48:51],v[212:215]
ds_read_b64_tr_b16 a[140:141],v3 offset:12416
v_fma_f32 v88,v88,s36,v15
v_mfma_f32_16x16x32_bf16 v[208:211],a[120:123],v[48:51],v[208:211]
ds_read_b64_tr_b16 a[142:143],v3 offset:18560
v_fma_f32 v89,v89,s36,v15
v_mfma_f32_16x16x32_bf16 v[112:115],a[120:123],v[52:55],v[112:115]
ds_read_b64_tr_b16 a[144:145],v4 offset:12416
v_fma_f32 v90,v90,s36,v15
v_mfma_f32_16x16x32_bf16 v[116:119],a[124:127],v[52:55],v[116:119]
ds_read_b64_tr_b16 a[146:147],v4 offset:18560
v_fma_f32 v91,v91,s36,v15
v_mfma_f32_16x16x32_bf16 a[164:167],a[124:127],v[56:59],a[164:167]
ds_read_b64_tr_b16 a[148:149],v5 offset:12416
v_fma_f32 v96,v96,s36,v16
v_mfma_f32_16x16x32_bf16 a[160:163],a[120:123],v[56:59],a[160:163]
s_waitcnt lgkmcnt(6)
ds_read_b64_tr_b16 a[150:151],v5 offset:18560
v_fma_f32 v97,v97,s36,v16
v_mfma_f32_16x16x32_bf16 a[168:171],a[128:131],v[56:59],a[168:171]
ds_read_b64_tr_b16 a[120:121],v2 offset:12544
v_fma_f32 v98,v98,s36,v16
v_mfma_f32_16x16x32_bf16 a[172:175],a[132:135],v[56:59],a[172:175]
ds_read_b64_tr_b16 a[122:123],v2 offset:18688
v_fma_f32 v99,v99,s36,v16
v_mfma_f32_16x16x32_bf16 v[124:127],a[132:135],v[52:55],v[124:127]
ds_read_b64_tr_b16 a[124:125],v3 offset:12544
v_fma_f32 v76,v76,s36,v13
v_mfma_f32_16x16x32_bf16 v[120:123],a[128:131],v[52:55],v[120:123]
ds_read_b64_tr_b16 a[126:127],v3 offset:18688
v_fma_f32 v77,v77,s36,v13
v_mfma_f32_16x16x32_bf16 v[216:219],a[128:131],v[48:51],v[216:219]
v_exp_f32 v82,v82
v_mfma_f32_16x16x32_bf16 v[220:223],a[132:135],v[48:51],v[220:223]
v_exp_f32 v83,v83
v_mfma_f32_16x16x32_bf16 v[172:175],a[132:135],v[44:47],v[172:175]
ds_read_b64_tr_b16 a[132:133],v5 offset:12544
v_cvt_pk_bf16_f32 v25,v82,v83
v_mfma_f32_16x16x32_bf16 v[168:171],a[128:131],v[44:47],v[168:171]
s_waitcnt lgkmcnt(4)
ds_read_b64_tr_b16 a[128:129],v4 offset:12544
v_fma_f32 v78,v78,s36,v13
v_mfma_f32_16x16x32_bf16 v[176:179],a[136:139],v[44:47],v[176:179]
ds_read_b64_tr_b16 a[130:131],v4 offset:18688
v_fma_f32 v79,v79,s36,v13
v_mfma_f32_16x16x32_bf16 v[180:183],a[140:143],v[44:47],v[180:183]
ds_read_b64_tr_b16 a[134:135],v5 offset:18688
v_fma_f32 v84,v84,s36,v14
v_mfma_f32_16x16x32_bf16 v[228:231],a[140:143],v[48:51],v[228:231]
v_exp_f32 v88,v88
v_mfma_f32_16x16x32_bf16 v[224:227],a[136:139],v[48:51],v[224:227]
v_exp_f32 v89,v89
v_mfma_f32_16x16x32_bf16 v[128:131],a[136:139],v[52:55],v[128:131]
v_exp_f32 v90,v90
v_mfma_f32_16x16x32_bf16 v[132:135],a[140:143],v[52:55],v[132:135]
v_exp_f32 v91,v91
v_mfma_f32_16x16x32_bf16 a[180:183],a[140:143],v[56:59],a[180:183]
v_cvt_pk_bf16_f32 v28,v88,v89
v_cvt_pk_bf16_f32 v29,v90,v91
v_mfma_f32_16x16x32_bf16 a[176:179],a[136:139],v[56:59],a[176:179]
v_exp_f32 v96,v96
v_mfma_f32_16x16x32_bf16 a[184:187],a[144:147],v[56:59],a[184:187]
v_exp_f32 v97,v97
v_mfma_f32_16x16x32_bf16 a[188:191],a[148:151],v[56:59],a[188:191]
v_exp_f32 v98,v98
v_mfma_f32_16x16x32_bf16 v[140:143],a[148:151],v[52:55],v[140:143]
v_exp_f32 v99,v99
v_mfma_f32_16x16x32_bf16 v[136:139],a[144:147],v[52:55],v[136:139]
v_cvt_pk_bf16_f32 v32,v96,v97
v_cvt_pk_bf16_f32 v33,v98,v99
v_mfma_f32_16x16x32_bf16 v[232:235],a[144:147],v[48:51],v[232:235]
v_exp_f32 v76,v76
v_mfma_f32_16x16x32_bf16 v[236:239],a[148:151],v[48:51],v[236:239]
v_exp_f32 v77,v77
v_mfma_f32_16x16x32_bf16 v[188:191],a[148:151],v[44:47],v[188:191]
v_exp_f32 v78,v78
v_mfma_f32_16x16x32_bf16 v[184:187],a[144:147],v[44:47],v[184:187]
s_waitcnt lgkmcnt(0)
v_exp_f32 v79,v79
v_mfma_f32_16x16x32_bf16 v[192:195],a[120:123],v[44:47],v[192:195]
s_waitcnt vmcnt(6)
v_cvt_pk_bf16_f32 v22,v76,v77
v_cvt_pk_bf16_f32 v23,v78,v79
v_mfma_f32_16x16x32_bf16 v[196:199],a[124:127],v[44:47],v[196:199]
s_barrier
v_mfma_f32_16x16x32_bf16 v[244:247],a[124:127],v[48:51],v[244:247]
ds_read_b128 a[148:151],v1 offset:128
v_fma_f32 v85,v85,s36,v14
v_mfma_f32_16x16x32_bf16 v[240:243],a[120:123],v[48:51],v[240:243]
ds_read_b128 a[144:147],v0 offset:128
v_fma_f32 v86,v86,s36,v14
v_mfma_f32_16x16x32_bf16 v[144:147],a[120:123],v[52:55],v[144:147]
ds_read_b128 a[140:143],v1 offset:0
v_fma_f32 v87,v87,s36,v14
v_mfma_f32_16x16x32_bf16 v[148:151],a[124:127],v[52:55],v[148:151]
ds_read_b128 a[136:139],v0 offset:0
v_fma_f32 v92,v92,s36,v15
v_mfma_f32_16x16x32_bf16 a[196:199],a[124:127],v[56:59],a[196:199]
ds_read_b128 a[124:127],v1 offset:256
v_fma_f32 v93,v93,s36,v15
v_mfma_f32_16x16x32_bf16 a[192:195],a[120:123],v[56:59],a[192:195]
buffer_load_dwordx4 v6,s[8:11],s21 offen offset:0 lds
v_mfma_f32_16x16x32_bf16 a[200:203],a[128:131],v[56:59],a[200:203]
ds_read_b128 a[120:123],v0 offset:256
v_fma_f32 v94,v94,s36,v15
v_mfma_f32_16x16x32_bf16 a[204:207],a[132:135],v[56:59],a[204:207]
v_exp_f32 v84,v84
v_mfma_f32_16x16x32_bf16 v[156:159],a[132:135],v[52:55],v[156:159]
v_exp_f32 v85,v85
v_mfma_f32_16x16x32_bf16 v[152:155],a[128:131],v[52:55],v[152:155]
v_exp_f32 v86,v86
v_mfma_f32_16x16x32_bf16 v[248:251],a[128:131],v[48:51],v[248:251]
v_exp_f32 v87,v87
v_mfma_f32_16x16x32_bf16 v[252:255],a[132:135],v[48:51],v[252:255]
v_cvt_pk_bf16_f32 v26,v84,v85
v_cvt_pk_bf16_f32 v27,v86,v87
v_mfma_f32_16x16x32_bf16 v[204:207],a[132:135],v[44:47],v[204:207]
ds_read_b128 a[132:135],v1 offset:6144
v_fma_f32 v95,v95,s36,v15
v_smfmac_f32_16x16x64_bf16 v[60:63],a[152:155],v[20:27],v18
v_fma_f32 v100,v100,s36,v16
v_mfma_f32_16x16x32_bf16 v[200:203],a[128:131],v[44:47],v[200:203]
buffer_load_dwordx4 v7,s[8:11],s21 offen offset:1024 lds
s_waitcnt lgkmcnt(1)
v_mfma_f32_16x16x32_bf16 v[72:75],a[124:127],a[20:23],0
ds_read_b128 a[128:131],v0 offset:6144
v_fma_f32 v101,v101,s36,v16
v_mfma_f32_16x16x32_bf16 v[72:75],a[120:123],a[16:19],v[72:75]
v_exp_f32 v92,v92
v_mfma_f32_16x16x32_bf16 v[72:75],a[148:151],a[12:15],v[72:75]
v_exp_f32 v93,v93
v_mfma_f32_16x16x32_bf16 v[72:75],a[144:147],a[8:11],v[72:75]
v_exp_f32 v94,v94
v_mfma_f32_16x16x32_bf16 v[72:75],a[140:143],a[4:7],v[72:75]
v_exp_f32 v95,v95
v_mfma_f32_16x16x32_bf16 v[72:75],a[136:139],a[0:3],v[72:75]
v_cvt_pk_bf16_f32 v30,v92,v93
v_cvt_pk_bf16_f32 v31,v94,v95
v_mfma_f32_16x16x32_bf16 v[80:83],a[136:139],a[24:27],0
v_fma_f32 v102,v102,s36,v16
v_fma_f32 v103,v103,s36,v16
v_mfma_f32_16x16x32_bf16 v[80:83],a[140:143],a[28:31],v[80:83]
v_exp_f32 v100,v100
v_mfma_f32_16x16x32_bf16 v[80:83],a[144:147],a[32:35],v[80:83]
buffer_load_dwordx4 v8,s[8:11],s21 offen offset:2048 lds
v_mfma_f32_16x16x32_bf16 v[80:83],a[148:151],a[36:39],v[80:83]
s_add_u32 s21,s21,12288
v_exp_f32 v101,v101
v_mfma_f32_16x16x32_bf16 v[80:83],a[120:123],a[40:43],v[80:83]
s_add_u32 m0,s22,24576
v_exp_f32 v102,v102
v_mfma_f32_16x16x32_bf16 v[80:83],a[124:127],a[44:47],v[80:83]
v_exp_f32 v103,v103
v_mfma_f32_16x16x32_bf16 v[88:91],a[124:127],a[68:71],0
v_cvt_pk_bf16_f32 v34,v100,v101
v_cvt_pk_bf16_f32 v35,v102,v103
v_mfma_f32_16x16x32_bf16 v[88:91],a[120:123],a[64:67],v[88:91]
v_fma_f32 v72,v72,s36,v13
v_fma_f32 v73,v73,s36,v13
v_smfmac_f32_16x16x64_bf16 v[64:67],a[152:155],v[28:35],v18
v_fma_f32 v74,v74,s36,v13
v_mfma_f32_16x16x32_bf16 v[88:91],a[148:151],a[60:63],v[88:91]
v_fma_f32 v75,v75,s36,v13
v_fma_f32 v80,v80,s36,v14
v_mfma_f32_16x16x32_bf16 v[88:91],a[144:147],a[56:59],v[88:91]
v_fma_f32 v81,v81,s36,v14
v_mfma_f32_16x16x32_bf16 v[88:91],a[140:143],a[52:55],v[88:91]
buffer_load_dwordx4 v6,s[4:7],s20 offen offset:0 lds
v_mfma_f32_16x16x32_bf16 v[88:91],a[136:139],a[48:51],v[88:91]
v_exp_f32 v72,v72
v_mfma_f32_16x16x32_bf16 v[96:99],a[136:139],a[72:75],0
ds_read_b128 a[136:139],v0 offset:6272
v_mfma_f32_16x16x32_bf16 v[96:99],a[140:143],a[76:79],v[96:99]
ds_read_b128 a[140:143],v1 offset:6272
v_mfma_f32_16x16x32_bf16 v[96:99],a[144:147],a[80:83],v[96:99]
ds_read_b128 a[144:147],v0 offset:6400
v_mfma_f32_16x16x32_bf16 v[96:99],a[148:151],a[84:87],v[96:99]
ds_read_b128 a[148:151],v1 offset:6400
v_mfma_f32_16x16x32_bf16 v[96:99],a[120:123],a[88:91],v[96:99]
v_exp_f32 v73,v73
v_mfma_f32_16x16x32_bf16 v[96:99],a[124:127],a[92:95],v[96:99]
s_waitcnt lgkmcnt(4)
v_exp_f32 v74,v74
v_mfma_f32_16x16x32_bf16 v[76:79],a[128:131],a[0:3],0
v_exp_f32 v75,v75
v_mfma_f32_16x16x32_bf16 v[76:79],a[132:135],a[4:7],v[76:79]
buffer_load_dwordx4 v7,s[4:7],s20 offen offset:1024 lds
s_waitcnt lgkmcnt(3)
v_mfma_f32_16x16x32_bf16 v[76:79],a[136:139],a[8:11],v[76:79]
s_waitcnt lgkmcnt(2)
v_exp_f32 v80,v80
v_mfma_f32_16x16x32_bf16 v[76:79],a[140:143],a[12:15],v[76:79]
s_waitcnt lgkmcnt(0)
v_exp_f32 v81,v81
v_mfma_f32_16x16x32_bf16 v[76:79],a[144:147],a[16:19],v[76:79]
v_cvt_pk_bf16_f32 v44,v72,v73
v_cvt_pk_bf16_f32 v45,v74,v75
v_mfma_f32_16x16x32_bf16 v[76:79],a[148:151],a[20:23],v[76:79]
v_cvt_pk_bf16_f32 v48,v80,v81
v_mfma_f32_16x16x32_bf16 v[84:87],a[148:151],a[44:47],0
v_mfma_f32_16x16x32_bf16 v[84:87],a[144:147],a[40:43],v[84:87]
v_mfma_f32_16x16x32_bf16 v[84:87],a[140:143],a[36:39],v[84:87]
v_mfma_f32_16x16x32_bf16 v[84:87],a[136:139],a[32:35],v[84:87]
v_mfma_f32_16x16x32_bf16 v[84:87],a[132:135],a[28:31],v[84:87]
buffer_load_dwordx4 v8,s[4:7],s20 offen offset:2048 lds
v_mfma_f32_16x16x32_bf16 v[84:87],a[128:131],a[24:27],v[84:87]
s_add_u32 s20,s20,12288
v_mfma_f32_16x16x32_bf16 v[92:95],a[128:131],a[48:51],0
ds_read_b64_tr_b16 a[120:121],v2 offset:24576
v_mfma_f32_16x16x32_bf16 v[92:95],a[132:135],a[52:55],v[92:95]
ds_read_b64_tr_b16 a[122:123],v2 offset:30720
v_mfma_f32_16x16x32_bf16 v[92:95],a[136:139],a[56:59],v[92:95]
ds_read_b64_tr_b16 a[124:125],v3 offset:24576
v_mfma_f32_16x16x32_bf16 v[92:95],a[140:143],a[60:63],v[92:95]
ds_read_b64_tr_b16 a[126:127],v3 offset:30720
v_mfma_f32_16x16x32_bf16 v[92:95],a[144:147],a[64:67],v[92:95]
v_mfma_f32_16x16x32_bf16 v[92:95],a[148:151],a[68:71],v[92:95]
v_mfma_f32_16x16x32_bf16 v[100:103],a[148:151],a[92:95],0
v_mfma_f32_16x16x32_bf16 v[100:103],a[144:147],a[88:91],v[100:103]
v_mfma_f32_16x16x32_bf16 v[100:103],a[140:143],a[84:87],v[100:103]
v_mfma_f32_16x16x32_bf16 v[100:103],a[136:139],a[80:83],v[100:103]
v_mfma_f32_16x16x32_bf16 v[100:103],a[132:135],a[76:79],v[100:103]
ds_read_b64_tr_b16 a[132:133],v5 offset:24576
v_mfma_f32_16x16x32_bf16 v[100:103],a[128:131],a[72:75],v[100:103]
ds_read_b64_tr_b16 a[128:129],v4 offset:24576
ds_read_b64_tr_b16 a[130:131],v4 offset:30720
ds_read_b64_tr_b16 a[134:135],v5 offset:30720
s_mov_b32 s38,0
s_branch L_loop4
L_tr55:
s_waitcnt vmcnt(43)
s_waitcnt lgkmcnt(3)
v_mfma_f32_16x16x32_bf16 v[160:163],a[120:123],v[20:23],v[160:163]
s_add_u32 m0,s24,0
ds_read_b128 a[12:15],v12 offset:128
v_fma_f32 v101,v101,s36,v16
v_mfma_f32_16x16x32_bf16 v[164:167],a[124:127],v[20:23],v[164:167]
ds_read_b128 a[20:23],v12 offset:256
v_fma_f32 v103,v103,s36,v16
v_mfma_f32_16x16x32_bf16 v[212:215],a[124:127],v[24:27],v[212:215]
ds_read_b128 a[4:7],v12 offset:0
v_fma_f32 v87,v87,s36,v14
v_mfma_f32_16x16x32_bf16 v[208:211],a[120:123],v[24:27],v[208:211]
ds_read_b128 a[16:19],v11 offset:256
v_fma_f32 v106,v106,s36,v17
v_mfma_f32_16x16x32_bf16 v[112:115],a[120:123],v[28:31],v[112:115]
ds_read_b128 a[0:3],v11 offset:0
v_fma_f32 v99,v99,s36,v16
v_mfma_f32_16x16x32_bf16 v[116:119],a[124:127],v[28:31],v[116:119]
ds_read_b128 a[8:11],v11 offset:128
v_fma_f32 v96,v96,s36,v16
v_mfma_f32_16x16x32_bf16 a[164:167],a[124:127],v[32:35],a[164:167]
ds_read_b64_tr_b16 a[136:137],v2 offset:24704
v_fma_f32 v77,v77,s36,v13
v_mfma_f32_16x16x32_bf16 a[160:163],a[120:123],v[32:35],a[160:163]
ds_read_b64_tr_b16 a[138:139],v2 offset:30848
v_fma_f32 v85,v85,s36,v14
v_mfma_f32_16x16x32_bf16 a[208:211],a[120:123],v[36:39],a[208:211]
ds_read_b64_tr_b16 a[140:141],v3 offset:24704
ds_read_b64_tr_b16 a[142:143],v3 offset:30848
ds_read_b64_tr_b16 a[144:145],v4 offset:24704
ds_read_b64_tr_b16 a[146:147],v4 offset:30848
ds_read_b64_tr_b16 a[150:151],v5 offset:30848
ds_read_b64_tr_b16 a[148:149],v5 offset:24704
ds_read_b128 a[40:43],v11 offset:6400
v_mfma_f32_16x16x32_bf16 a[212:215],a[124:127],v[36:39],a[212:215]
s_waitcnt lgkmcnt(11)
v_fma_f32 v84,v84,s36,v14
ds_read_b128 a[32:35],v11 offset:6272
v_mfma_f32_16x16x32_bf16 a[216:219],a[128:131],v[36:39],a[216:219]
s_waitcnt lgkmcnt(10)
buffer_load_dwordx4 v6,s[12:15],s28 offen offset:0 nt lds
v_mfma_f32_16x16x32_bf16 a[220:223],a[132:135],v[36:39],a[220:223]
ds_read_b64_tr_b16 a[122:123],v2 offset:30976
ds_read_b128 a[44:47],v12 offset:6400
v_mfma_f32_16x16x32_bf16 a[172:175],a[132:135],v[32:35],a[172:175]
v_exp_f32 v101,v101
ds_read_b64_tr_b16 a[120:121],v2 offset:24832
ds_read_b128 a[24:27],v11 offset:6144
v_mfma_f32_16x16x32_bf16 a[168:171],a[128:131],v[32:35],a[168:171]
v_exp_f32 v77,v77
ds_read_b128 a[28:31],v12 offset:6144
v_mfma_f32_16x16x32_bf16 v[120:123],a[128:131],v[28:31],v[120:123]
v_fma_f32 v111,v111,s36,v17
ds_read_b64_tr_b16 a[126:127],v3 offset:30976
ds_read_b64_tr_b16 a[124:125],v3 offset:24832
ds_read_b128 a[36:39],v12 offset:6272
v_mfma_f32_16x16x32_bf16 v[124:127],a[132:135],v[28:31],v[124:127]
buffer_load_dwordx4 v7,s[12:15],s28 offen offset:1024 nt lds
v_mfma_f32_16x16x32_bf16 v[220:223],a[132:135],v[24:27],v[220:223]
v_fma_f32 v95,v95,s36,v15
v_fma_f32 v100,v100,s36,v16
v_mfma_f32_16x16x32_bf16 v[216:219],a[128:131],v[24:27],v[216:219]
v_exp_f32 v106,v106
v_mfma_f32_16x16x32_bf16 v[168:171],a[128:131],v[20:23],v[168:171]
ds_read_b64_tr_b16 a[130:131],v4 offset:30976
v_fma_f32 v93,v93,s36,v15
v_mfma_f32_16x16x32_bf16 v[172:175],a[132:135],v[20:23],v[172:175]
s_waitcnt lgkmcnt(4)
ds_read_b64_tr_b16 a[128:129],v4 offset:24832
v_exp_f32 v111,v111
v_mfma_f32_16x16x32_bf16 v[176:179],a[136:139],v[20:23],v[176:179]
ds_read_b64_tr_b16 a[132:133],v5 offset:24832
buffer_load_dwordx4 v8,s[12:15],s28 offen offset:2048 nt lds
v_mfma_f32_16x16x32_bf16 v[180:183],a[140:143],v[20:23],v[180:183]
s_add_u32 s28,s28,3072
ds_read_b64_tr_b16 a[134:135],v5 offset:30976
v_fma_f32 v107,v107,s36,v17
v_mfma_f32_16x16x32_bf16 v[228:231],a[140:143],v[24:27],v[228:231]
s_add_u32 m0,s24,3072
v_fma_f32 v92,v92,s36,v15
v_exp_f32 v92,v92
v_mfma_f32_16x16x32_bf16 v[224:227],a[136:139],v[24:27],v[224:227]
v_fma_f32 v109,v109,s36,v17
v_exp_f32 v109,v109
v_mfma_f32_16x16x32_bf16 v[128:131],a[136:139],v[28:31],v[128:131]
v_fma_f32 v97,v97,s36,v16
v_exp_f32 v84,v84
v_mfma_f32_16x16x32_bf16 v[132:135],a[140:143],v[28:31],v[132:135]
v_fma_f32 v94,v94,s36,v15
v_exp_f32 v94,v94
v_mfma_f32_16x16x32_bf16 a[180:183],a[140:143],v[32:35],a[180:183]
v_fma_f32 v104,v104,s36,v17
v_fma_f32 v90,v90,s36,v15
v_mfma_f32_16x16x32_bf16 a[176:179],a[136:139],v[32:35],a[176:179]
buffer_load_dwordx4 v6,s[12:15],s28 offen offset:0 nt lds
v_mfma_f32_16x16x32_bf16 a[224:227],a[136:139],v[36:39],a[224:227]
v_exp_f32 v93,v93
v_mfma_f32_16x16x32_bf16 a[228:231],a[140:143],v[36:39],a[228:231]
v_exp_f32 v104,v104
v_mfma_f32_16x16x32_bf16 a[232:235],a[144:147],v[36:39],a[232:235]
v_exp_f32 v96,v96
v_mfma_f32_16x16x32_bf16 a[236:239],a[148:151],v[36:39],a[236:239]
v_fma_f32 v78,v78,s36,v13
v_exp_f32 v78,v78
v_mfma_f32_16x16x32_bf16 a[188:191],a[148:151],v[32:35],a[188:191]
v_fma_f32 v110,v110,s36,v17
v_exp_f32 v110,v110
v_mfma_f32_16x16x32_bf16 a[184:187],a[144:147],v[32:35],a[184:187]
v_exp_f32 v97,v97
v_mfma_f32_16x16x32_bf16 v[136:139],a[144:147],v[28:31],v[136:139]
v_exp_f32 v100,v100
v_mfma_f32_16x16x32_bf16 v[140:143],a[148:151],v[28:31],v[140:143]
buffer_load_dwordx4 v7,s[12:15],s28 offen offset:1024 nt lds
v_mfma_f32_16x16x32_bf16 v[236:239],a[148:151],v[24:27],v[236:239]
v_fma_f32 v102,v102,s36,v16
v_exp_f32 v102,v102
v_mfma_f32_16x16x32_bf16 v[232:235],a[144:147],v[24:27],v[232:235]
v_fma_f32 v79,v79,s36,v13
v_exp_f32 v79,v79
v_mfma_f32_16x16x32_bf16 v[184:187],a[144:147],v[20:23],v[184:187]
v_exp_f32 v85,v85
v_mfma_f32_16x16x32_bf16 v[188:191],a[148:151],v[20:23],v[188:191]
v_fma_f32 v108,v108,s36,v17
v_exp_f32 v108,v108
v_mfma_f32_16x16x32_bf16 v[192:195],a[120:123],v[20:23],v[192:195]
s_waitcnt lgkmcnt(0)
v_fma_f32 v98,v98,s36,v16
v_exp_f32 v87,v87
v_mfma_f32_16x16x32_bf16 v[196:199],a[124:127],v[20:23],v[196:199]
v_fma_f32 v76,v76,s36,v13
v_exp_f32 v76,v76
v_mfma_f32_16x16x32_bf16 v[244:247],a[124:127],v[24:27],v[244:247]
buffer_load_dwordx4 v8,s[12:15],s28 offen offset:2048 nt lds
s_waitcnt vmcnt(18)
s_barrier
v_mfma_f32_16x16x32_bf16 v[240:243],a[120:123],v[24:27],v[240:243]
s_add_u32 s28,s28,3072
v_fma_f32 v105,v105,s36,v17
v_exp_f32 v107,v107
v_mfma_f32_16x16x32_bf16 v[144:147],a[120:123],v[28:31],v[144:147]
s_add_u32 m0,s22,0
v_fma_f32 v91,v91,s36,v15
v_exp_f32 v91,v91
v_mfma_f32_16x16x32_bf16 v[148:151],a[124:127],v[28:31],v[148:151]
buffer_load_dwordx4 v6,s[4:7],s25 offen offset:0 lds
v_mfma_f32_16x16x32_bf16 a[196:199],a[124:127],v[32:35],a[196:199]
buffer_load_dwordx4 v7,s[4:7],s25 offen offset:1024 lds
v_mfma_f32_16x16x32_bf16 a[192:195],a[120:123],v[32:35],a[192:195]
buffer_load_dwordx4 v8,s[4:7],s25 offen offset:2048 lds
v_mfma_f32_16x16x32_bf16 a[240:243],a[120:123],v[36:39],a[240:243]
v_fma_f32 v86,v86,s36,v14
v_exp_f32 v86,v86
v_mfma_f32_16x16x32_bf16 a[244:247],a[124:127],v[36:39],a[244:247]
v_exp_f32 v95,v95
v_mfma_f32_16x16x32_bf16 a[248:251],a[128:131],v[36:39],a[248:251]
v_exp_f32 v103,v103
v_mfma_f32_16x16x32_bf16 a[252:255],a[132:135],v[36:39],a[252:255]
ds_read_b64_tr_b16 a[136:137],v2 offset:0
v_cvt_pk_bf16_f32 v41,v106,v107
v_mfma_f32_16x16x32_bf16 a[204:207],a[132:135],v[32:35],a[204:207]
ds_read_b64_tr_b16 a[138:139],v2 offset:6144
v_exp_f32 v99,v99
v_mfma_f32_16x16x32_bf16 a[200:203],a[128:131],v[32:35],a[200:203]
ds_read_b64_tr_b16 a[140:141],v3 offset:0
v_cvt_pk_bf16_f32 v42,v108,v109
v_mfma_f32_16x16x32_bf16 v[152:155],a[128:131],v[28:31],v[152:155]
ds_read_b64_tr_b16 a[142:143],v3 offset:6144
v_cvt_pk_bf16_f32 v50,v84,v85
v_mfma_f32_16x16x32_bf16 v[156:159],a[132:135],v[28:31],v[156:159]
ds_read_b64_tr_b16 a[144:145],v4 offset:0
v_exp_f32 v90,v90
v_mfma_f32_16x16x32_bf16 v[252:255],a[132:135],v[24:27],v[252:255]
ds_read_b64_tr_b16 a[146:147],v4 offset:6144
v_exp_f32 v105,v105
v_mfma_f32_16x16x32_bf16 v[248:251],a[128:131],v[24:27],v[248:251]
ds_read_b64_tr_b16 a[148:149],v5 offset:0
v_cvt_pk_bf16_f32 v55,v94,v95
v_mfma_f32_16x16x32_bf16 v[200:203],a[128:131],v[20:23],v[200:203]
ds_read_b64_tr_b16 a[150:151],v5 offset:6144
v_cvt_pk_bf16_f32 v51,v86,v87
v_mfma_f32_16x16x32_bf16 v[204:207],a[132:135],v[20:23],v[204:207]
v_cvt_pk_bf16_f32 v59,v102,v103
v_exp_f32 v98,v98
v_cvt_pk_bf16_f32 v54,v92,v93
v_cvt_pk_bf16_f32 v56,v96,v97
v_cvt_pk_bf16_f32 v53,v90,v91
v_cvt_pk_bf16_f32 v47,v78,v79
v_cvt_pk_bf16_f32 v43,v110,v111
v_cvt_pk_bf16_f32 v58,v100,v101
v_cvt_pk_bf16_f32 v46,v76,v77
v_cvt_pk_bf16_f32 v57,v98,v99
v_cvt_pk_bf16_f32 v40,v104,v105
v_smfmac_f32_16x16x64_bf16 v[60:63],a[152:155],v[44:51],v18
v_subrev_u32 v10,18432,v10
v_smfmac_f32_16x16x64_bf16 v[64:67],a[152:155],v[52:59],v18
v_smfmac_f32_16x16x64_bf16 v[68:71],a[152:155],v[36:43],v18
s_waitcnt lgkmcnt(1)
v_mfma_f32_16x16x32_bf16 v[160:163],a[136:139],v[44:47],v[160:163]
s_add_u32 s87,s42,18432
ds_read_b64_tr_b16 a[120:121],v2 offset:128
v_mbcnt_lo_u32_b32 v39,-1,0
v_mfma_f32_16x16x32_bf16 v[164:167],a[140:143],v[44:47],v[164:167]
s_add_u32 s66,s42,24576
ds_read_b64_tr_b16 a[122:123],v2 offset:6272
v_mbcnt_hi_u32_b32 v39,-1,v39
v_mfma_f32_16x16x32_bf16 v[212:215],a[140:143],v[48:51],v[212:215]
ds_read_b64_tr_b16 a[126:127],v3 offset:6272
v_lshrrev_b32 v19,5,v39
v_mfma_f32_16x16x32_bf16 v[208:211],a[136:139],v[48:51],v[208:211]
ds_read_b64_tr_b16 a[124:125],v3 offset:128
v_and_b32 v38,7,v39
v_mfma_f32_16x16x32_bf16 v[112:115],a[136:139],v[52:55],v[112:115]
ds_read_b64_tr_b16 a[130:131],v4 offset:6272
v_xor_b32 v38,v38,v19
v_mfma_f32_16x16x32_bf16 v[116:119],a[140:143],v[52:55],v[116:119]
ds_read_b64_tr_b16 a[128:129],v4 offset:128
ds_read_b64_tr_b16 a[134:135],v5 offset:6272
ds_read_b64_tr_b16 a[132:133],v5 offset:128
v_mfma_f32_16x16x32_bf16 a[164:167],a[140:143],v[56:59],a[164:167]
v_and_b32 v19,15,v39
v_lshl_add_u32 v19,v19,7,s24
v_mfma_f32_16x16x32_bf16 a[160:163],a[136:139],v[56:59],a[160:163]
v_lshl_add_u32 v19,v38,4,v19
v_bfe_u32 v38,v39,4,1
v_mfma_f32_16x16x32_bf16 a[208:211],a[136:139],v[40:43],a[208:211]
ds_read_b64_tr_b16 a[136:137],v2 offset:256
v_lshl_add_u32 v36,v38,3,v19
v_mfma_f32_16x16x32_bf16 a[212:215],a[140:143],v[40:43],a[212:215]
ds_read_b64_tr_b16 a[138:139],v2 offset:6400
v_xor_b32 v37,32,v36
v_mfma_f32_16x16x32_bf16 a[216:219],a[144:147],v[40:43],a[216:219]
s_waitcnt lgkmcnt(6)
ds_read_b64_tr_b16 a[140:141],v3 offset:256
v_xor_b32 v38,64,v36
v_mfma_f32_16x16x32_bf16 a[220:223],a[148:151],v[40:43],a[220:223]
ds_read_b64_tr_b16 a[142:143],v3 offset:6400
v_bfe_u32 v19,v39,3,1
v_xor_b32 v39,96,v36
v_lshlrev_b32 v19,11,v19
v_add_f32 v68,v68,v69
v_add_f32 v68,v68,v70
v_accvgpr_read_b32 v75,a163
v_add_f32 v66,v66,v67
v_accvgpr_read_b32 v74,a162
v_add_f32 v68,v68,v71
v_rcp_f32 v68,v68
v_accvgpr_read_b32 v78,a210
v_accvgpr_read_b32 v72,a160
v_accvgpr_read_b32 v76,a208
v_rcp_f32 v66,v66
v_accvgpr_read_b32 v79,a211
v_pk_mul_f32 v[74:75],v[74:75],v[66:67] op_sel_hi:[1,0]
v_pk_mul_f32 v[78:79],v[78:79],v[68:69] op_sel_hi:[1,0]
v_accvgpr_read_b32 v77,a209
v_pk_mul_f32 v[76:77],v[76:77],v[68:69] op_sel_hi:[1,0]
v_accvgpr_read_b32 v73,a161
v_pk_mul_f32 v[72:73],v[72:73],v[66:67] op_sel_hi:[1,0]
v_accvgpr_read_b32 v82,a166
v_accvgpr_read_b32 v84,a212
v_mfma_f32_16x16x32_bf16 a[172:175],a[148:151],v[56:59],a[172:175]
v_accvgpr_read_b32 v85,a213
v_accvgpr_read_b32 v87,a215
v_accvgpr_read_b32 v83,a167
v_accvgpr_read_b32 v80,a164
v_accvgpr_read_b32 v81,a165
v_pk_mul_f32 v[82:83],v[82:83],v[66:67] op_sel_hi:[1,0]
v_pk_mul_f32 v[84:85],v[84:85],v[68:69] op_sel_hi:[1,0]
v_pk_mul_f32 v[80:81],v[80:81],v[66:67] op_sel_hi:[1,0]
v_accvgpr_read_b32 v86,a214
v_pk_mul_f32 v[86:87],v[86:87],v[68:69] op_sel_hi:[1,0]
v_accvgpr_read_b32 v92,a216
v_accvgpr_read_b32 v95,a219
v_mfma_f32_16x16x32_bf16 a[168:171],a[144:147],v[56:59],a[168:171]
v_accvgpr_read_b32 v93,a217
v_accvgpr_read_b32 v94,a218
v_mfma_f32_16x16x32_bf16 v[120:123],a[144:147],v[52:55],v[120:123]
v_accvgpr_read_b32 v102,a222
v_accvgpr_read_b32 v100,a220
v_mfma_f32_16x16x32_bf16 v[124:127],a[148:151],v[52:55],v[124:127]
v_accvgpr_read_b32 v101,a221
v_accvgpr_read_b32 v99,a175
v_mfma_f32_16x16x32_bf16 v[220:223],a[148:151],v[48:51],v[220:223]
v_accvgpr_read_b32 v88,a168
v_accvgpr_read_b32 v90,a170
v_accvgpr_read_b32 v91,a171
v_accvgpr_read_b32 v89,a169
v_accvgpr_read_b32 v103,a223
v_pk_mul_f32 v[88:89],v[88:89],v[66:67] op_sel_hi:[1,0]
v_pk_mul_f32 v[90:91],v[90:91],v[66:67] op_sel_hi:[1,0]
v_pk_mul_f32 v[94:95],v[94:95],v[68:69] op_sel_hi:[1,0]
v_pk_mul_f32 v[92:93],v[92:93],v[68:69] op_sel_hi:[1,0]
v_accvgpr_read_b32 v98,a174
v_accvgpr_read_b32 v97,a173
v_mfma_f32_16x16x32_bf16 v[216:219],a[144:147],v[48:51],v[216:219]
v_accvgpr_read_b32 v96,a172
v_cvt_pk_bf16_f32 v84,v84,v85
v_mfma_f32_16x16x32_bf16 v[168:171],a[144:147],v[44:47],v[168:171]
ds_read_b64_tr_b16 a[144:145],v4 offset:256
ds_read_b64_tr_b16 a[146:147],v4 offset:6400
v_cvt_pk_bf16_f32 v72,v72,v73
v_cvt_pk_bf16_f32 v76,v76,v77
v_pk_mul_f32 v[96:97],v[96:97],v[66:67] op_sel_hi:[1,0]
v_pk_mul_f32 v[102:103],v[102:103],v[68:69] op_sel_hi:[1,0]
v_pk_mul_f32 v[100:101],v[100:101],v[68:69] op_sel_hi:[1,0]
v_pk_mul_f32 v[98:99],v[98:99],v[66:67] op_sel_hi:[1,0]
v_cvt_pk_bf16_f32 v77,v78,v79
v_cvt_pk_bf16_f32 v85,v86,v87
v_mfma_f32_16x16x32_bf16 v[172:175],a[148:151],v[44:47],v[172:175]
ds_read_b64_tr_b16 a[148:149],v5 offset:256
v_cvt_pk_bf16_f32 v73,v74,v75
v_mfma_f32_16x16x32_bf16 v[176:179],a[120:123],v[44:47],v[176:179]
ds_read_b64_tr_b16 a[150:151],v5 offset:6400
v_cvt_pk_bf16_f32 v80,v80,v81
v_mfma_f32_16x16x32_bf16 v[180:183],a[124:127],v[44:47],v[180:183]
ds_write2st64_b64 v36,v[72:73],v[76:77] offset0:36 offset1:40
v_mfma_f32_16x16x32_bf16 v[228:231],a[124:127],v[48:51],v[228:231]
v_cvt_pk_bf16_f32 v81,v82,v83
v_cvt_pk_bf16_f32 v88,v88,v89
v_mfma_f32_16x16x32_bf16 v[224:227],a[120:123],v[48:51],v[224:227]
v_cvt_pk_bf16_f32 v92,v92,v93
v_cvt_pk_bf16_f32 v89,v90,v91
v_mfma_f32_16x16x32_bf16 v[128:131],a[120:123],v[52:55],v[128:131]
v_cvt_pk_bf16_f32 v93,v94,v95
v_cvt_pk_bf16_f32 v100,v100,v101
v_mfma_f32_16x16x32_bf16 v[132:135],a[124:127],v[52:55],v[132:135]
ds_write2st64_b64 v37,v[80:81],v[84:85] offset0:36 offset1:40
v_mfma_f32_16x16x32_bf16 a[180:183],a[124:127],v[56:59],a[180:183]
v_cvt_pk_bf16_f32 v101,v102,v103
v_cvt_pk_bf16_f32 v96,v96,v97
v_mfma_f32_16x16x32_bf16 a[176:179],a[120:123],v[56:59],a[176:179]
v_cvt_pk_bf16_f32 v97,v98,v99
v_add_f32 v64,v64,v65
v_mfma_f32_16x16x32_bf16 a[224:227],a[120:123],v[40:43],a[224:227]
v_rcp_f32 v64,v64
v_mfma_f32_16x16x32_bf16 a[228:231],a[124:127],v[40:43],a[228:231]
s_waitcnt lgkmcnt(1)
ds_write2st64_b64 v38,v[88:89],v[92:93] offset0:36 offset1:40
v_mfma_f32_16x16x32_bf16 a[232:235],a[128:131],v[40:43],a[232:235]
v_accvgpr_read_b32 v89,a181
v_accvgpr_read_b32 v83,a179
v_mfma_f32_16x16x32_bf16 a[236:239],a[132:135],v[40:43],a[236:239]
v_accvgpr_read_b32 v80,a176
v_accvgpr_read_b32 v84,a224
v_accvgpr_read_b32 v86,a226
v_accvgpr_read_b32 v85,a225
v_accvgpr_read_b32 v81,a177
ds_write2st64_b64 v39,v[96:97],v[100:101] offset0:36 offset1:40
v_pk_mul_f32 v[84:85],v[84:85],v[68:69] op_sel_hi:[1,0]
v_pk_mul_f32 v[80:81],v[80:81],v[66:67] op_sel_hi:[1,0]
v_accvgpr_read_b32 v82,a178
ds_read_b128 v[104:107],v10 offset:18432
v_pk_mul_f32 v[82:83],v[82:83],v[66:67] op_sel_hi:[1,0]
ds_read_b128 v[108:111],v10 offset:19456
v_accvgpr_read_b32 v87,a227
ds_read_b128 v[72:75],v10 offset:20480
v_pk_mul_f32 v[86:87],v[86:87],v[68:69] op_sel_hi:[1,0]
v_accvgpr_read_b32 v94,a230
v_accvgpr_read_b32 v90,a182
v_mfma_f32_16x16x32_bf16 a[188:191],a[132:135],v[56:59],a[188:191]
ds_read_b128 v[76:79],v10 offset:21504
v_accvgpr_read_b32 v91,a183
v_accvgpr_read_b32 v93,a229
v_accvgpr_read_b32 v95,a231
v_accvgpr_read_b32 v92,a228
v_pk_mul_f32 v[92:93],v[92:93],v[68:69] op_sel_hi:[1,0]
v_pk_mul_f32 v[90:91],v[90:91],v[66:67] op_sel_hi:[1,0]
v_pk_mul_f32 v[94:95],v[94:95],v[68:69] op_sel_hi:[1,0]
v_accvgpr_read_b32 v88,a180
v_pk_mul_f32 v[88:89],v[88:89],v[66:67] op_sel_hi:[1,0]
v_cvt_pk_bf16_f32 v84,v84,v85
v_cvt_pk_bf16_f32 v80,v80,v81
v_mfma_f32_16x16x32_bf16 a[184:187],a[128:131],v[56:59],a[184:187]
v_cvt_pk_bf16_f32 v81,v82,v83
v_cvt_pk_bf16_f32 v85,v86,v87
v_mfma_f32_16x16x32_bf16 v[136:139],a[128:131],v[52:55],v[136:139]
ds_write2st64_b64 v36,v[80:81],v[84:85] offset0:36 offset1:40
v_mfma_f32_16x16x32_bf16 v[140:143],a[132:135],v[52:55],v[140:143]
v_add_u32 v36,v36,v19
v_accvgpr_read_b32 v100,a232
v_mfma_f32_16x16x32_bf16 v[236:239],a[132:135],v[48:51],v[236:239]
s_waitcnt lgkmcnt(2)
buffer_store_dwordx4 v[104:107],v9,s[16:19],s87 offen offset:0 nt
v_accvgpr_read_b32 v96,a184
v_accvgpr_read_b32 v81,a189
v_accvgpr_read_b32 v101,a233
v_pk_mul_f32 v[112:113],v[112:113],v[64:65] op_sel_hi:[1,0]
v_pk_mul_f32 v[128:129],v[128:129],v[64:65] op_sel_hi:[1,0]
v_pk_mul_f32 v[130:131],v[130:131],v[64:65] op_sel_hi:[1,0]
v_pk_mul_f32 v[100:101],v[100:101],v[68:69] op_sel_hi:[1,0]
v_pk_mul_f32 v[114:115],v[114:115],v[64:65] op_sel_hi:[1,0]
v_accvgpr_read_b32 v99,a187
v_accvgpr_read_b32 v98,a186
v_pk_mul_f32 v[98:99],v[98:99],v[66:67] op_sel_hi:[1,0]
buffer_store_dwordx4 v[108:111],v9,s[16:19],s87 offen offset:3072 nt
v_accvgpr_read_b32 v102,a234
v_accvgpr_read_b32 v84,a236
v_accvgpr_read_b32 v103,a235
v_pk_mul_f32 v[102:103],v[102:103],v[68:69] op_sel_hi:[1,0]
v_accvgpr_read_b32 v97,a185
v_pk_mul_f32 v[96:97],v[96:97],v[66:67] op_sel_hi:[1,0]
v_accvgpr_read_b32 v80,a188
v_pk_mul_f32 v[80:81],v[80:81],v[66:67] op_sel_hi:[1,0]
v_accvgpr_read_b32 v82,a190
v_accvgpr_read_b32 v87,a239
v_accvgpr_read_b32 v83,a191
buffer_store_dwordx4 v[72:75],v9,s[16:19],s66 offen offset:0 nt
v_pk_mul_f32 v[82:83],v[82:83],v[66:67] op_sel_hi:[1,0]
v_accvgpr_read_b32 v85,a237
v_pk_mul_f32 v[84:85],v[84:85],v[68:69] op_sel_hi:[1,0]
v_accvgpr_read_b32 v86,a238
v_pk_mul_f32 v[86:87],v[86:87],v[68:69] op_sel_hi:[1,0]
v_add_f32 v62,v62,v63
v_rcp_f32 v62,v62
v_mfma_f32_16x16x32_bf16 v[232:235],a[128:131],v[48:51],v[232:235]
v_add_f32 v60,v60,v61
v_rcp_f32 v60,v60
v_mfma_f32_16x16x32_bf16 v[184:187],a[128:131],v[44:47],v[184:187]
s_waitcnt lgkmcnt(0)
buffer_store_dwordx4 v[76:79],v9,s[16:19],s66 offen offset:3072 nt
v_min3_f32 v61,v60,v62,v64
v_min3_f32 v61,v61,v66,v68
v_cmp_nlt_f32 vcc,s37,v61
v_mfma_f32_16x16x32_bf16 v[188:191],a[132:135],v[44:47],v[188:191]
v_cvt_pk_bf16_f32 v92,v92,v93
v_cvt_pk_bf16_f32 v93,v94,v95
v_mfma_f32_16x16x32_bf16 v[192:195],a[136:139],v[44:47],v[192:195]
s_cmp_lg_u64 vcc,0
v_cvt_pk_bf16_f32 v84,v84,v85
v_cvt_pk_bf16_f32 v88,v88,v89
v_cvt_pk_bf16_f32 v89,v90,v91
ds_write2st64_b64 v37,v[88:89],v[92:93] offset0:36 offset1:40
v_pk_mul_f32 v[134:135],v[134:135],v[64:65] op_sel_hi:[1,0]
v_pk_mul_f32 v[132:133],v[132:133],v[64:65] op_sel_hi:[1,0]
v_pk_mul_f32 v[116:117],v[116:117],v[64:65] op_sel_hi:[1,0]
v_pk_mul_f32 v[118:119],v[118:119],v[64:65] op_sel_hi:[1,0]
v_add_u32 v37,v37,v19
v_cvt_pk_bf16_f32 v96,v96,v97
v_mfma_f32_16x16x32_bf16 v[196:199],a[140:143],v[44:47],v[196:199]
s_cselect_b32 s62,s32,0
v_cvt_pk_bf16_f32 v97,v98,v99
v_cvt_pk_bf16_f32 v100,v100,v101
v_mfma_f32_16x16x32_bf16 v[244:247],a[140:143],v[48:51],v[244:247]
s_or_b32 s31,s31,s62
v_cvt_pk_bf16_f32 v85,v86,v87
v_cvt_pk_bf16_f32 v101,v102,v103
v_mfma_f32_16x16x32_bf16 v[240:243],a[136:139],v[48:51],v[240:243]
s_lshl_b32 s32,s32,1
ds_write2st64_b64 v38,v[96:97],v[100:101] offset0:36 offset1:40
v_pk_mul_f32 v[138:139],v[138:139],v[64:65] op_sel_hi:[1,0]
v_pk_mul_f32 v[136:137],v[136:137],v[64:65] op_sel_hi:[1,0]
v_pk_mul_f32 v[120:121],v[120:121],v[64:65] op_sel_hi:[1,0]
v_pk_mul_f32 v[122:123],v[122:123],v[64:65] op_sel_hi:[1,0]
v_add_u32 v38,v38,v19
v_cvt_pk_bf16_f32 v80,v80,v81
v_mfma_f32_16x16x32_bf16 v[144:147],a[136:139],v[52:55],v[144:147]
s_add_u32 m0,s24,6144
v_cvt_pk_bf16_f32 v81,v82,v83
v_cvt_pk_bf16_f32 v112,v112,v113
v_mfma_f32_16x16x32_bf16 v[148:151],a[140:143],v[52:55],v[148:151]
buffer_load_dwordx4 v6,s[12:15],s28 offen offset:0 nt lds
v_mfma_f32_16x16x32_bf16 a[196:199],a[140:143],v[56:59],a[196:199]
buffer_load_dwordx4 v7,s[12:15],s28 offen offset:1024 nt lds
v_mfma_f32_16x16x32_bf16 a[192:195],a[136:139],v[56:59],a[192:195]
buffer_load_dwordx4 v8,s[12:15],s28 offen offset:2048 nt lds
ds_write2st64_b64 v39,v[80:81],v[84:85] offset0:36 offset1:40
v_pk_mul_f32 v[124:125],v[124:125],v[64:65] op_sel_hi:[1,0]
v_pk_mul_f32 v[142:143],v[142:143],v[64:65] op_sel_hi:[1,0]
v_pk_mul_f32 v[140:141],v[140:141],v[64:65] op_sel_hi:[1,0]
ds_read_b128 v[72:75],v10 offset:18432
v_pk_mul_f32 v[126:127],v[126:127],v[64:65] op_sel_hi:[1,0]
v_add_u32 v39,v39,v19
v_accvgpr_read_b32 v106,a194
v_mfma_f32_16x16x32_bf16 a[240:243],a[136:139],v[40:43],a[240:243]
s_add_u32 s28,s28,3072
ds_read_b128 v[76:79],v10 offset:19456
v_accvgpr_read_b32 v105,a193
v_mfma_f32_16x16x32_bf16 a[244:247],a[140:143],v[40:43],a[244:247]
s_add_u32 m0,s24,9216
ds_read_b128 v[88:91],v10 offset:20480
buffer_load_dwordx4 v6,s[12:15],s28 offen offset:0 nt lds
v_mfma_f32_16x16x32_bf16 a[248:251],a[144:147],v[40:43],a[248:251]
buffer_load_dwordx4 v7,s[12:15],s28 offen offset:1024 nt lds
v_mfma_f32_16x16x32_bf16 a[252:255],a[148:151],v[40:43],a[252:255]
buffer_load_dwordx4 v8,s[12:15],s28 offen offset:2048 nt lds
ds_read_b128 v[92:95],v10 offset:21504
v_accvgpr_read_b32 v111,a243
v_accvgpr_read_b32 v109,a241
v_accvgpr_read_b32 v110,a242
s_waitcnt lgkmcnt(3)
buffer_store_dwordx4 v[72:75],v9,s[16:19],s87 offen offset:128 nt
v_pk_mul_f32 v[110:111],v[110:111],v[68:69] op_sel_hi:[1,0]
v_accvgpr_read_b32 v108,a240
v_pk_mul_f32 v[108:109],v[108:109],v[68:69] op_sel_hi:[1,0]
v_accvgpr_read_b32 v104,a192
v_pk_mul_f32 v[104:105],v[104:105],v[66:67] op_sel_hi:[1,0]
v_accvgpr_read_b32 v107,a195
v_pk_mul_f32 v[106:107],v[106:107],v[66:67] op_sel_hi:[1,0]
v_accvgpr_read_b32 v97,a197
v_accvgpr_read_b32 v96,a196
v_mfma_f32_16x16x32_bf16 a[204:207],a[148:151],v[56:59],a[204:207]
s_waitcnt vmcnt(26)
s_waitcnt vmcnt(11)
s_barrier
v_mfma_f32_16x16x32_bf16 a[200:203],a[144:147],v[56:59],a[200:203]
s_add_u32 s28,s28,3072
ds_read_b128 a[64:67],v11 offset:12544
s_waitcnt lgkmcnt(2)
buffer_store_dwordx4 v[76:79],v9,s[16:19],s87 offen offset:3200 nt
v_accvgpr_read_b32 v102,a246
v_accvgpr_read_b32 v99,a199
v_accvgpr_read_b32 v101,a245
v_mfma_f32_16x16x32_bf16 v[152:155],a[144:147],v[52:55],v[152:155]
s_add_u32 m0,s23,0
ds_read_b128 a[48:51],v11 offset:12288
v_accvgpr_read_b32 v98,a198
ds_read_b128 a[68:71],v12 offset:12544
buffer_load_dwordx4 v6,s[8:11],s25 offen offset:0 lds
buffer_load_dwordx4 v7,s[8:11],s25 offen offset:1024 lds
ds_read_b128 a[60:63],v12 offset:12416
buffer_store_dwordx4 v[88:91],v9,s[16:19],s66 offen offset:128 nt
ds_read_b128 a[52:55],v12 offset:12288
v_pk_mul_f32 v[96:97],v[96:97],v[66:67] op_sel_hi:[1,0]
ds_read_b128 a[56:59],v11 offset:12416
v_pk_mul_f32 v[98:99],v[98:99],v[66:67] op_sel_hi:[1,0]
ds_read_b128 a[120:123],v0 offset:0
v_accvgpr_read_b32 v100,a244
ds_read_b128 a[124:127],v1 offset:0
s_waitcnt lgkmcnt(7)
buffer_store_dwordx4 v[92:95],v9,s[16:19],s66 offen offset:3200 nt
ds_read_b128 a[128:131],v0 offset:128
v_pk_mul_f32 v[100:101],v[100:101],v[68:69] op_sel_hi:[1,0]
ds_read_b128 a[132:135],v1 offset:128
v_accvgpr_read_b32 v103,a247
ds_read_b128 a[136:139],v0 offset:256
buffer_load_dwordx4 v8,s[8:11],s25 offen offset:2048 lds
ds_read_b128 a[140:143],v1 offset:256
v_pk_mul_f32 v[102:103],v[102:103],v[68:69] op_sel_hi:[1,0]
v_accvgpr_read_b32 v83,a203
v_accvgpr_read_b32 v84,a248
v_mfma_f32_16x16x32_bf16 v[156:159],a[148:151],v[52:55],v[156:159]
s_waitcnt vmcnt(20)
ds_read_b128 a[92:95],v12 offset:256
v_accvgpr_read_b32 v80,a200
v_mfma_f32_16x16x32_bf16 v[252:255],a[148:151],v[48:51],v[252:255]
s_mov_b32 s27,s42
ds_read_b128 a[88:91],v11 offset:256
v_accvgpr_read_b32 v85,a249
v_mfma_f32_16x16x32_bf16 v[248:251],a[144:147],v[48:51],v[248:251]
s_mov_b32 s42,s41
ds_read_b128 a[84:87],v12 offset:128
v_accvgpr_read_b32 v87,a251
v_mfma_f32_16x16x32_bf16 v[200:203],a[144:147],v[44:47],v[200:203]
s_add_u32 s69,s69,1
ds_read_b128 a[80:83],v11 offset:128
v_accvgpr_read_b32 v82,a202
ds_read_b128 a[76:79],v12 offset:0
v_pk_mul_f32 v[82:83],v[82:83],v[66:67] op_sel_hi:[1,0]
ds_read_b128 a[72:75],v11 offset:0
v_pk_mul_f32 v[84:85],v[84:85],v[68:69] op_sel_hi:[1,0]
ds_read_b128 a[144:147],v0 offset:6144
v_accvgpr_read_b32 v86,a250
v_pk_mul_f32 v[86:87],v[86:87],v[68:69] op_sel_hi:[1,0]
v_accvgpr_read_b32 v81,a201
v_pk_mul_f32 v[80:81],v[80:81],v[66:67] op_sel_hi:[1,0]
v_cvt_pk_bf16_f32 v113,v114,v115
v_cvt_pk_bf16_f32 v128,v128,v129
v_mfma_f32_16x16x32_bf16 v[204:207],a[148:151],v[44:47],v[204:207]
s_lshl_b32 s62,s69,5
ds_read_b128 a[148:151],v1 offset:6144
v_cvt_pk_bf16_f32 v129,v130,v131
s_waitcnt lgkmcnt(6)
v_mfma_f32_16x16x32_bf16 v[72:75],a[120:123],a[0:3],0
s_add_u32 s62,s62,s34
ds_write2st64_b64 v36,v[112:113],v[128:129] offset0:24 offset1:26
v_mfma_f32_16x16x32_bf16 v[72:75],a[124:127],a[4:7],v[72:75]
s_mul_i32 s63,s62,171
v_sub_u32 v36,v36,v19
v_accvgpr_read_b32 v112,a204
v_accvgpr_read_b32 v131,a255
v_accvgpr_read_b32 v129,a253
v_accvgpr_read_b32 v115,a207
v_accvgpr_read_b32 v128,a252
v_pk_mul_f32 v[128:129],v[128:129],v[68:69] op_sel_hi:[1,0]
v_accvgpr_read_b32 v113,a205
v_pk_mul_f32 v[112:113],v[112:113],v[66:67] op_sel_hi:[1,0]
v_accvgpr_read_b32 v114,a206
v_pk_mul_f32 v[114:115],v[114:115],v[66:67] op_sel_hi:[1,0]
v_accvgpr_read_b32 v130,a254
v_pk_mul_f32 v[130:131],v[130:131],v[68:69] op_sel_hi:[1,0]
v_cvt_pk_bf16_f32 v132,v132,v133
v_cvt_pk_bf16_f32 v120,v120,v121
v_mfma_f32_16x16x32_bf16 v[72:75],a[128:131],a[8:11],v[72:75]
s_lshr_b32 s63,s63,9
v_cvt_pk_bf16_f32 v133,v134,v135
v_cvt_pk_bf16_f32 v136,v136,v137
v_mfma_f32_16x16x32_bf16 v[72:75],a[132:135],a[12:15],v[72:75]
s_mul_i32 s64,s63,3
v_cvt_pk_bf16_f32 v124,v124,v125
v_cvt_pk_bf16_f32 v140,v140,v141
v_mfma_f32_16x16x32_bf16 v[72:75],a[136:139],a[16:19],v[72:75]
s_sub_u32 s62,s62,s64
v_cvt_pk_bf16_f32 v141,v142,v143
v_cvt_pk_bf16_f32 v116,v116,v117
v_mfma_f32_16x16x32_bf16 v[72:75],a[140:143],a[20:23],v[72:75]
s_add_u32 s63,s63,s33
v_cvt_pk_bf16_f32 v121,v122,v123
v_cvt_pk_bf16_f32 v125,v126,v127
v_cvt_pk_bf16_f32 v117,v118,v119
ds_write2st64_b64 v37,v[116:117],v[132:133] offset0:24 offset1:26
v_pk_mul_f32 v[162:163],v[162:163],v[60:61] op_sel_hi:[1,0]
v_pk_mul_f32 v[144:145],v[144:145],v[64:65] op_sel_hi:[1,0]
v_pk_mul_f32 v[160:161],v[160:161],v[60:61] op_sel_hi:[1,0]
v_pk_mul_f32 v[146:147],v[146:147],v[64:65] op_sel_hi:[1,0]
v_sub_u32 v37,v37,v19
v_cvt_pk_bf16_f32 v137,v138,v139
v_cvt_pk_bf16_f32 v108,v108,v109
v_cvt_pk_bf16_f32 v84,v84,v85
v_cvt_pk_bf16_f32 v96,v96,v97
v_cvt_pk_bf16_f32 v97,v98,v99
v_cvt_pk_bf16_f32 v100,v100,v101
ds_write2st64_b64 v38,v[120:121],v[136:137] offset0:24 offset1:26
v_sub_u32 v38,v38,v19
v_cvt_pk_bf16_f32 v104,v104,v105
v_cvt_pk_bf16_f32 v105,v106,v107
v_cvt_pk_bf16_f32 v109,v110,v111
v_cvt_pk_bf16_f32 v85,v86,v87
v_cvt_pk_bf16_f32 v80,v80,v81
v_cvt_pk_bf16_f32 v101,v102,v103
v_cvt_pk_bf16_f32 v81,v82,v83
v_cvt_pk_bf16_f32 v112,v112,v113
v_cvt_pk_bf16_f32 v128,v128,v129
v_cvt_pk_bf16_f32 v129,v130,v131
ds_write2st64_b64 v39,v[124:125],v[140:141] offset0:24 offset1:26
v_sub_u32 v39,v39,v19
v_cvt_pk_bf16_f32 v113,v114,v115
v_max3_f32 v44,v72,v73,v74
v_max_f32 v44,v44,v75
v_mov_b32 v45,v44
v_cvt_pk_bf16_f32 v144,v144,v145
v_cvt_pk_bf16_f32 v145,v146,v147
v_permlane32_swap_b32 v45,v44
v_max_f32 v44,v44,v45
v_mov_b32 v45,v44
ds_write2st64_b64 v36,v[104:105],v[108:109] offset0:36 offset1:40
v_add_u32 v36,v36,v19
v_permlane16_swap_b32 v45,v44
v_max_f32 v44,v44,v45
v_mul_f32_e64 v13,-s36,v44
v_fma_f32 v75,v75,s36,v13
v_exp_f32 v75,v75
v_fma_f32 v74,v74,s36,v13
v_fma_f32 v73,v73,s36,v13
v_exp_f32 v73,v73
ds_write2st64_b64 v37,v[96:97],v[100:101] offset0:36 offset1:40
v_add_u32 v37,v37,v19
v_fma_f32 v72,v72,s36,v13
v_exp_f32 v72,v72
v_exp_f32 v74,v74
v_cvt_pk_bf16_f32 v20,v72,v73
v_cvt_pk_bf16_f32 v21,v74,v75
v_cvt_pk_bf16_f32 v160,v160,v161
v_cvt_pk_bf16_f32 v161,v162,v163
v_mov_b32 v67,0
ds_write2st64_b64 v38,v[80:81],v[84:85] offset0:36 offset1:40
v_mfma_f32_16x16x32_bf16 v[80:83],a[140:143],a[44:47],0
s_waitcnt vmcnt(7)
v_add_u32 v38,v38,v19
v_mov_b32 v61,0
v_mfma_f32_16x16x32_bf16 v[80:83],a[136:139],a[40:43],v[80:83]
s_mul_i32 s30,s63,196608
ds_read_b128 a[96:99],v11 offset:6144
v_mov_b32 v63,0
v_mfma_f32_16x16x32_bf16 v[80:83],a[132:135],a[36:39],v[80:83]
s_mul_i32 s41,s63,325632
ds_read_b128 a[100:103],v12 offset:6144
v_mov_b32 v66,0
ds_read_b128 a[104:107],v11 offset:6272
v_pk_mul_f32 v[164:165],v[164:165],v[60:61] op_sel_hi:[1,0]
ds_read_b128 a[108:111],v12 offset:6272
v_pk_mul_f32 v[166:167],v[166:167],v[60:61] op_sel_hi:[1,0]
ds_read_b128 a[112:115],v11 offset:6400
v_pk_mul_f32 v[150:151],v[150:151],v[64:65] op_sel_hi:[1,0]
ds_read_b128 a[116:119],v12 offset:6400
v_pk_mul_f32 v[148:149],v[148:149],v[64:65] op_sel_hi:[1,0]
v_cvt_pk_bf16_f32 v164,v164,v165
v_cvt_pk_bf16_f32 v148,v148,v149
v_mfma_f32_16x16x32_bf16 v[80:83],a[128:131],a[32:35],v[80:83]
s_lshl_b32 s63,s3,2
ds_write2st64_b64 v39,v[112:113],v[128:129] offset0:36 offset1:40
v_mfma_f32_16x16x32_bf16 v[80:83],a[124:127],a[28:31],v[80:83]
s_add_u32 s64,s63,21
v_add_u32 v39,v39,v19
v_cvt_pk_bf16_f32 v149,v150,v151
v_mfma_f32_16x16x32_bf16 v[80:83],a[120:123],a[24:27],v[80:83]
s_cmp_eq_u32 s3,0
ds_read_b128 v[76:79],v10 offset:18432
v_cvt_pk_bf16_f32 v165,v166,v167
v_mfma_f32_16x16x32_bf16 v[88:91],a[120:123],a[48:51],0
s_cselect_b32 s64,20,s64
ds_read_b128 v[92:95],v10 offset:19456
v_mov_b32 v65,0
ds_read_b128 v[116:119],v10 offset:20480
v_pk_mul_f32 v[152:153],v[152:153],v[64:65] op_sel_hi:[1,0]
ds_read_b128 v[132:135],v10 offset:21504
v_pk_mul_f32 v[154:155],v[154:155],v[64:65] op_sel_hi:[1,0]
ds_write2st64_b64 v36,v[144:145],v[160:161] offset0:28 offset1:0
v_pk_mul_f32 v[170:171],v[170:171],v[60:61] op_sel_hi:[1,0]
v_pk_mul_f32 v[168:169],v[168:169],v[60:61] op_sel_hi:[1,0]
v_max3_f32 v48,v80,v81,v82
v_max_f32 v48,v48,v83
v_mfma_f32_16x16x32_bf16 v[88:91],a[124:127],a[52:55],v[88:91]
s_cselect_b32 s40,1,0
v_mov_b32 v49,v48
v_cvt_pk_bf16_f32 v152,v152,v153
v_mfma_f32_16x16x32_bf16 v[88:91],a[128:131],a[56:59],v[88:91]
s_add_u32 s65,s63,37
v_permlane32_swap_b32 v49,v48
v_mfma_f32_16x16x32_bf16 v[88:91],a[132:135],a[60:63],v[88:91]
s_cmp_eq_u32 s62,2
ds_write2st64_b64 v37,v[148:149],v[164:165] offset0:28 offset1:0
v_mfma_f32_16x16x32_bf16 v[88:91],a[136:139],a[64:67],v[88:91]
s_cselect_b32 s64,s65,s64
v_max_f32 v48,v48,v49
s_waitcnt lgkmcnt(2)
buffer_store_dwordx4 v[76:79],v9,s[16:19],s87 offen offset:256 nt
v_pk_mul_f32 v[156:157],v[156:157],v[64:65] op_sel_hi:[1,0]
v_pk_mul_f32 v[158:159],v[158:159],v[64:65] op_sel_hi:[1,0]
v_pk_mul_f32 v[172:173],v[172:173],v[60:61] op_sel_hi:[1,0]
v_pk_mul_f32 v[174:175],v[174:175],v[60:61] op_sel_hi:[1,0]
v_mov_b32 v49,v48
v_cvt_pk_bf16_f32 v153,v154,v155
v_mfma_f32_16x16x32_bf16 v[88:91],a[140:143],a[68:71],v[88:91]
s_cselect_b32 s40,0,s40
v_permlane16_swap_b32 v49,v48
v_mfma_f32_16x16x32_bf16 v[96:99],a[140:143],a[92:95],0
s_add_u32 s65,s63,s3
v_max_f32 v48,v48,v49
v_mul_f32_e64 v14,-s36,v48
v_mfma_f32_16x16x32_bf16 v[96:99],a[136:139],a[88:91],v[96:99]
s_cmp_eq_u32 s62,0
buffer_store_dwordx4 v[92:95],v9,s[16:19],s87 offen offset:3328 nt
v_fma_f32 v80,v80,s36,v14
v_fma_f32 v83,v83,s36,v14
v_pk_mul_f32 v[176:177],v[176:177],v[60:61] op_sel_hi:[1,0]
v_pk_mul_f32 v[178:179],v[178:179],v[60:61] op_sel_hi:[1,0]
v_pk_mul_f32 v[194:195],v[194:195],v[60:61] op_sel_hi:[1,0]
v_pk_mul_f32 v[192:193],v[192:193],v[60:61] op_sel_hi:[1,0]
v_fma_f32 v82,v82,s36,v14
v_exp_f32 v82,v82
v_mfma_f32_16x16x32_bf16 v[96:99],a[132:135],a[84:87],v[96:99]
s_cselect_b32 s64,s65,s64
v_fma_f32 v81,v81,s36,v14
v_exp_f32 v81,v81
v_mfma_f32_16x16x32_bf16 v[96:99],a[128:131],a[80:83],v[96:99]
s_cselect_b32 s40,1,s40
v_exp_f32 v80,v80
v_mfma_f32_16x16x32_bf16 v[96:99],a[124:127],a[76:79],v[96:99]
s_mul_i32 s64,s64,6144
v_exp_f32 v83,v83
v_mfma_f32_16x16x32_bf16 v[96:99],a[120:123],a[72:75],v[96:99]
s_add_u32 s41,s41,s64
buffer_store_dwordx4 v[116:119],v9,s[16:19],s66 offen offset:256 nt
v_cvt_pk_bf16_f32 v24,v80,v81
v_cvt_pk_bf16_f32 v25,v82,v83
v_pk_mul_f32 v[182:183],v[182:183],v[60:61] op_sel_hi:[1,0]
v_pk_mul_f32 v[180:181],v[180:181],v[60:61] op_sel_hi:[1,0]
v_pk_mul_f32 v[196:197],v[196:197],v[60:61] op_sel_hi:[1,0]
v_pk_mul_f32 v[198:199],v[198:199],v[60:61] op_sel_hi:[1,0]
v_max3_f32 v52,v88,v89,v90
v_max_f32 v52,v52,v91
v_mfma_f32_16x16x32_bf16 v[104:107],a[120:123],a[96:99],0
s_cmp_ge_u32 s69,6
ds_read_b128 a[120:123],v0 offset:6272
v_mov_b32 v53,v52
v_mfma_f32_16x16x32_bf16 v[104:107],a[124:127],a[100:103],v[104:107]
s_cselect_b32 s41,166723584,s41
ds_read_b128 a[124:127],v1 offset:6272
buffer_store_dwordx4 v[132:135],v9,s[16:19],s66 offen offset:3328 nt
v_permlane32_swap_b32 v53,v52
v_max_f32 v52,v52,v53
v_mfma_f32_16x16x32_bf16 v[104:107],a[128:131],a[104:107],v[104:107]
s_cselect_b32 s30,100663296,s30
ds_read_b128 a[128:131],v0 offset:6400
v_mov_b32 v53,v52
v_max3_f32 v56,v96,v97,v98
v_max_f32 v56,v56,v99
v_permlane16_swap_b32 v53,v52
v_pk_mul_f32 v[200:201],v[200:201],v[60:61] op_sel_hi:[1,0]
v_pk_mul_f32 v[184:185],v[184:185],v[60:61] op_sel_hi:[1,0]
v_pk_mul_f32 v[202:203],v[202:203],v[60:61] op_sel_hi:[1,0]
v_pk_mul_f32 v[186:187],v[186:187],v[60:61] op_sel_hi:[1,0]
v_max_f32 v52,v52,v53
v_mul_f32_e64 v15,-s36,v52
v_mfma_f32_16x16x32_bf16 v[104:107],a[132:135],a[108:111],v[104:107]
s_add_u32 s25,s30,s22
ds_read_b128 a[132:135],v1 offset:6400
v_fma_f32 v90,v90,s36,v15
v_mfma_f32_16x16x32_bf16 v[104:107],a[136:139],a[112:115],v[104:107]
s_add_u32 s26,s25,12288
ds_read_b128 a[136:139],v0 offset:12288
v_fma_f32 v89,v89,s36,v15
v_mfma_f32_16x16x32_bf16 v[104:107],a[140:143],a[116:119],v[104:107]
s_add_u32 m0,s23,24576
ds_read_b128 a[140:143],v1 offset:12288
v_fma_f32 v91,v91,s36,v15
v_mfma_f32_16x16x32_bf16 v[76:79],a[144:147],a[0:3],0
s_mov_b32 s28,s41
v_fma_f32 v88,v88,s36,v15
v_exp_f32 v90,v90
v_exp_f32 v91,v91
v_pk_mul_f32 v[204:205],v[204:205],v[60:61] op_sel_hi:[1,0]
v_pk_mul_f32 v[206:207],v[206:207],v[60:61] op_sel_hi:[1,0]
v_pk_mul_f32 v[188:189],v[188:189],v[60:61] op_sel_hi:[1,0]
v_pk_mul_f32 v[190:191],v[190:191],v[60:61] op_sel_hi:[1,0]
v_exp_f32 v89,v89
v_exp_f32 v88,v88
v_mfma_f32_16x16x32_bf16 v[76:79],a[148:151],a[4:7],v[76:79]
s_mov_b32 s29,s24
v_cvt_pk_bf16_f32 v28,v88,v89
v_cvt_pk_bf16_f32 v29,v90,v91
s_waitcnt lgkmcnt(3)
v_mfma_f32_16x16x32_bf16 v[76:79],a[120:123],a[8:11],v[76:79]
buffer_load_dwordx4 v6,s[8:11],s21 offen offset:0 lds
v_mfma_f32_16x16x32_bf16 v[76:79],a[124:127],a[12:15],v[76:79]
v_mov_b32 v57,v56
v_max3_f32 v40,v104,v105,v106
v_mfma_f32_16x16x32_bf16 v[76:79],a[128:131],a[16:19],v[76:79]
v_permlane32_swap_b32 v57,v56
v_max_f32 v56,v56,v57
v_mov_b32 v57,v56
v_max_f32 v40,v40,v107
v_pk_mul_f32 v[226:227],v[226:227],v[62:63] op_sel_hi:[1,0]
v_pk_mul_f32 v[224:225],v[224:225],v[62:63] op_sel_hi:[1,0]
v_pk_mul_f32 v[208:209],v[208:209],v[62:63] op_sel_hi:[1,0]
v_pk_mul_f32 v[210:211],v[210:211],v[62:63] op_sel_hi:[1,0]
v_permlane16_swap_b32 v57,v56
v_max_f32 v56,v56,v57
s_waitcnt lgkmcnt(0)
v_mfma_f32_16x16x32_bf16 v[76:79],a[132:135],a[20:23],v[76:79]
v_mul_f32_e64 v16,-s36,v56
v_fma_f32 v97,v97,s36,v16
v_mfma_f32_16x16x32_bf16 v[84:87],a[132:135],a[44:47],0
v_fma_f32 v99,v99,s36,v16
v_exp_f32 v97,v97
v_mfma_f32_16x16x32_bf16 v[84:87],a[128:131],a[40:43],v[84:87]
buffer_load_dwordx4 v7,s[8:11],s21 offen offset:1024 lds
v_fma_f32 v98,v98,s36,v16
v_exp_f32 v98,v98
v_pk_mul_f32 v[212:213],v[212:213],v[62:63] op_sel_hi:[1,0]
v_pk_mul_f32 v[214:215],v[214:215],v[62:63] op_sel_hi:[1,0]
v_pk_mul_f32 v[228:229],v[228:229],v[62:63] op_sel_hi:[1,0]
v_pk_mul_f32 v[230:231],v[230:231],v[62:63] op_sel_hi:[1,0]
v_fma_f32 v96,v96,s36,v16
v_exp_f32 v96,v96
v_mfma_f32_16x16x32_bf16 v[84:87],a[124:127],a[36:39],v[84:87]
v_exp_f32 v99,v99
v_mfma_f32_16x16x32_bf16 v[84:87],a[120:123],a[32:35],v[84:87]
v_cvt_pk_bf16_f32 v33,v98,v99
v_cvt_pk_bf16_f32 v32,v96,v97
v_mfma_f32_16x16x32_bf16 v[84:87],a[148:151],a[28:31],v[84:87]
v_cvt_pk_bf16_f32 v172,v172,v173
v_cvt_pk_bf16_f32 v168,v168,v169
v_mfma_f32_16x16x32_bf16 v[84:87],a[144:147],a[24:27],v[84:87]
v_cvt_pk_bf16_f32 v176,v176,v177
v_cvt_pk_bf16_f32 v192,v192,v193
v_cvt_pk_bf16_f32 v177,v178,v179
v_cvt_pk_bf16_f32 v180,v180,v181
buffer_load_dwordx4 v8,s[8:11],s21 offen offset:2048 lds
v_pk_mul_f32 v[232:233],v[232:233],v[62:63] op_sel_hi:[1,0]
v_pk_mul_f32 v[234:235],v[234:235],v[62:63] op_sel_hi:[1,0]
v_pk_mul_f32 v[216:217],v[216:217],v[62:63] op_sel_hi:[1,0]
v_pk_mul_f32 v[218:219],v[218:219],v[62:63] op_sel_hi:[1,0]
v_cvt_pk_bf16_f32 v169,v170,v171
v_cvt_pk_bf16_f32 v200,v200,v201
v_mfma_f32_16x16x32_bf16 v[92:95],a[144:147],a[48:51],0
s_add_u32 s21,s21,12288
ds_write2st64_b64 v38,v[152:153],v[168:169] offset0:28 offset1:0
v_mfma_f32_16x16x32_bf16 v[92:95],a[148:151],a[52:55],v[92:95]
s_add_u32 m0,s22,0
v_cvt_pk_bf16_f32 v156,v156,v157
v_cvt_pk_bf16_f32 v157,v158,v159
v_mfma_f32_16x16x32_bf16 v[92:95],a[120:123],a[56:59],v[92:95]
v_cvt_pk_bf16_f32 v181,v182,v183
v_cvt_pk_bf16_f32 v204,v204,v205
v_mfma_f32_16x16x32_bf16 v[92:95],a[124:127],a[60:63],v[92:95]
v_cvt_pk_bf16_f32 v193,v194,v195
v_cvt_pk_bf16_f32 v184,v184,v185
v_cvt_pk_bf16_f32 v201,v202,v203
v_cvt_pk_bf16_f32 v173,v174,v175
ds_write2st64_b64 v39,v[156:157],v[172:173] offset0:28 offset1:0
v_pk_mul_f32 v[220:221],v[220:221],v[62:63] op_sel_hi:[1,0]
v_pk_mul_f32 v[222:223],v[222:223],v[62:63] op_sel_hi:[1,0]
v_pk_mul_f32 v[236:237],v[236:237],v[62:63] op_sel_hi:[1,0]
v_pk_mul_f32 v[238:239],v[238:239],v[62:63] op_sel_hi:[1,0]
v_cvt_pk_bf16_f32 v196,v196,v197
v_cvt_pk_bf16_f32 v197,v198,v199
v_mfma_f32_16x16x32_bf16 v[92:95],a[128:131],a[64:67],v[92:95]
v_mov_b32 v41,v40
v_cvt_pk_bf16_f32 v208,v208,v209
v_mfma_f32_16x16x32_bf16 v[92:95],a[132:135],a[68:71],v[92:95]
v_permlane32_swap_b32 v41,v40
v_mfma_f32_16x16x32_bf16 v[100:103],a[132:135],a[92:95],0
ds_write2st64_b64 v36,v[176:177],v[192:193] offset0:2 offset1:4
v_pk_mul_f32 v[240:241],v[240:241],v[62:63] op_sel_hi:[1,0]
v_pk_mul_f32 v[242:243],v[242:243],v[62:63] op_sel_hi:[1,0]
v_max_f32 v40,v40,v41
v_mov_b32 v41,v40
v_mfma_f32_16x16x32_bf16 v[100:103],a[128:131],a[88:91],v[100:103]
v_cvt_pk_bf16_f32 v205,v206,v207
v_cvt_pk_bf16_f32 v212,v212,v213
v_mfma_f32_16x16x32_bf16 v[100:103],a[124:127],a[84:87],v[100:103]
v_cvt_pk_bf16_f32 v185,v186,v187
v_cvt_pk_bf16_f32 v188,v188,v189
v_mfma_f32_16x16x32_bf16 v[100:103],a[120:123],a[80:83],v[100:103]
ds_write2st64_b64 v37,v[180:181],v[196:197] offset0:2 offset1:4
v_mfma_f32_16x16x32_bf16 v[100:103],a[148:151],a[76:79],v[100:103]
v_cvt_pk_bf16_f32 v216,v216,v217
v_cvt_pk_bf16_f32 v209,v210,v211
v_permlane16_swap_b32 v41,v40
v_cvt_pk_bf16_f32 v236,v236,v237
v_pk_mul_f32 v[244:245],v[244:245],v[62:63] op_sel_hi:[1,0]
v_pk_mul_f32 v[246:247],v[246:247],v[62:63] op_sel_hi:[1,0]
v_cvt_pk_bf16_f32 v224,v224,v225
v_cvt_pk_bf16_f32 v228,v228,v229
v_mfma_f32_16x16x32_bf16 v[100:103],a[144:147],a[72:75],v[100:103]
ds_write2st64_b64 v38,v[184:185],v[200:201] offset0:2 offset1:4
v_mfma_f32_16x16x32_bf16 v[108:111],a[144:147],a[96:99],0
v_cvt_pk_bf16_f32 v229,v230,v231
v_cvt_pk_bf16_f32 v189,v190,v191
v_mfma_f32_16x16x32_bf16 v[108:111],a[148:151],a[100:103],v[108:111]
ds_read_b128 a[144:147],v0 offset:12416
v_max_f32 v40,v40,v41
ds_read_b128 a[148:151],v1 offset:12416
v_pk_mul_f32 v[248:249],v[248:249],v[62:63] op_sel_hi:[1,0]
ds_write2st64_b64 v39,v[188:189],v[204:205] offset0:2 offset1:4
v_pk_mul_f32 v[250:251],v[250:251],v[62:63] op_sel_hi:[1,0]
v_cvt_pk_bf16_f32 v225,v226,v227
v_cvt_pk_bf16_f32 v232,v232,v233
v_mfma_f32_16x16x32_bf16 v[108:111],a[120:123],a[104:107],v[108:111]
ds_read_b128 a[120:123],v0 offset:12544
v_cvt_pk_bf16_f32 v217,v218,v219
v_mfma_f32_16x16x32_bf16 v[108:111],a[124:127],a[108:111],v[108:111]
ds_read_b128 a[124:127],v1 offset:12544
v_cvt_pk_bf16_f32 v233,v234,v235
v_mfma_f32_16x16x32_bf16 v[108:111],a[128:131],a[112:115],v[108:111]
ds_write2st64_b64 v36,v[208:209],v[224:225] offset0:12 offset1:14
v_mfma_f32_16x16x32_bf16 v[108:111],a[132:135],a[116:119],v[108:111]
v_cvt_pk_bf16_f32 v213,v214,v215
ds_read_b128 a[128:131],v0 offset:18432
v_mul_f32_e64 v17,-s36,v40
ds_read_b128 a[132:135],v1 offset:18432
v_pk_mul_f32 v[254:255],v[254:255],v[62:63] op_sel_hi:[1,0]
ds_write2st64_b64 v37,v[212:213],v[228:229] offset0:12 offset1:14
v_pk_mul_f32 v[252:253],v[252:253],v[62:63] op_sel_hi:[1,0]
v_fma_f32 v104,v104,s36,v17
v_fma_f32 v106,v106,s36,v17
v_mfma_f32_16x16x32_bf16 v[72:75],a[136:139],a[0:3],0
v_exp_f32 v106,v106
v_mfma_f32_16x16x32_bf16 v[72:75],a[140:143],a[4:7],v[72:75]
s_waitcnt lgkmcnt(3)
v_exp_f32 v104,v104
v_mfma_f32_16x16x32_bf16 v[72:75],a[144:147],a[8:11],v[72:75]
ds_write2st64_b64 v38,v[216:217],v[232:233] offset0:12 offset1:14
v_mfma_f32_16x16x32_bf16 v[72:75],a[148:151],a[12:15],v[72:75]
v_cvt_pk_bf16_f32 v237,v238,v239
v_cvt_pk_bf16_f32 v240,v240,v241
v_mfma_f32_16x16x32_bf16 v[72:75],a[120:123],a[16:19],v[72:75]
v_cvt_pk_bf16_f32 v241,v242,v243
v_fma_f32 v105,v105,s36,v17
v_mfma_f32_16x16x32_bf16 v[72:75],a[124:127],a[20:23],v[72:75]
v_fma_f32 v107,v107,s36,v17
v_exp_f32 v107,v107
v_mfma_f32_16x16x32_bf16 v[80:83],a[124:127],a[44:47],0
v_cvt_pk_bf16_f32 v220,v220,v221
v_cvt_pk_bf16_f32 v221,v222,v223
v_mfma_f32_16x16x32_bf16 v[80:83],a[120:123],a[40:43],v[80:83]
ds_write2st64_b64 v39,v[220:221],v[236:237] offset0:12 offset1:14
v_mfma_f32_16x16x32_bf16 v[80:83],a[148:151],a[36:39],v[80:83]
v_exp_f32 v105,v105
v_mfma_f32_16x16x32_bf16 v[80:83],a[144:147],a[32:35],v[80:83]
v_cvt_pk_bf16_f32 v244,v244,v245
v_cvt_pk_bf16_f32 v245,v246,v247
v_mfma_f32_16x16x32_bf16 v[80:83],a[140:143],a[28:31],v[80:83]
v_fma_f32 v76,v76,s36,v13
v_fma_f32 v79,v79,s36,v13
v_mfma_f32_16x16x32_bf16 v[80:83],a[136:139],a[24:27],v[80:83]
ds_write_b64 v36,v[240:241] offset:8192
v_mfma_f32_16x16x32_bf16 v[88:91],a[136:139],a[48:51],0
v_cvt_pk_bf16_f32 v36,v104,v105
v_exp_f32 v79,v79
v_mfma_f32_16x16x32_bf16 v[88:91],a[140:143],a[52:55],v[88:91]
ds_write_b64 v37,v[244:245] offset:8192
v_mfma_f32_16x16x32_bf16 v[88:91],a[144:147],a[56:59],v[88:91]
v_cvt_pk_bf16_f32 v37,v106,v107
v_fma_f32 v78,v78,s36,v13
v_mfma_f32_16x16x32_bf16 v[88:91],a[148:151],a[60:63],v[88:91]
v_exp_f32 v76,v76
v_mfma_f32_16x16x32_bf16 v[88:91],a[120:123],a[64:67],v[88:91]
v_fma_f32 v77,v77,s36,v13
v_exp_f32 v77,v77
v_mfma_f32_16x16x32_bf16 v[88:91],a[124:127],a[68:71],v[88:91]
v_exp_f32 v78,v78
v_mfma_f32_16x16x32_bf16 v[96:99],a[124:127],a[92:95],0
v_cvt_pk_bf16_f32 v22,v76,v77
v_cvt_pk_bf16_f32 v23,v78,v79
v_mfma_f32_16x16x32_bf16 v[96:99],a[120:123],a[88:91],v[96:99]
v_fma_f32 v86,v86,s36,v14
v_exp_f32 v86,v86
v_mfma_f32_16x16x32_bf16 v[96:99],a[148:151],a[84:87],v[96:99]
v_fma_f32 v85,v85,s36,v14
v_fma_f32 v84,v84,s36,v14
v_mfma_f32_16x16x32_bf16 v[96:99],a[144:147],a[80:83],v[96:99]
v_exp_f32 v84,v84
v_mfma_f32_16x16x32_bf16 v[96:99],a[140:143],a[76:79],v[96:99]
v_fma_f32 v87,v87,s36,v14
v_exp_f32 v85,v85
v_mfma_f32_16x16x32_bf16 v[96:99],a[136:139],a[72:75],v[96:99]
v_exp_f32 v87,v87
v_mfma_f32_16x16x32_bf16 v[104:107],a[136:139],a[96:99],0
ds_read_b128 a[136:139],v0 offset:18560
v_cvt_pk_bf16_f32 v26,v84,v85
v_mfma_f32_16x16x32_bf16 v[104:107],a[140:143],a[100:103],v[104:107]
ds_read_b128 a[140:143],v1 offset:18560
v_cvt_pk_bf16_f32 v27,v86,v87
v_mfma_f32_16x16x32_bf16 v[104:107],a[144:147],a[104:107],v[104:107]
ds_read_b128 a[144:147],v0 offset:18688
v_fma_f32 v95,v95,s36,v15
v_mfma_f32_16x16x32_bf16 v[104:107],a[148:151],a[108:111],v[104:107]
ds_read_b128 a[148:151],v1 offset:18688
v_fma_f32 v93,v93,s36,v15
v_mfma_f32_16x16x32_bf16 v[104:107],a[120:123],a[112:115],v[104:107]
v_fma_f32 v92,v92,s36,v15
v_fma_f32 v94,v94,s36,v15
v_mfma_f32_16x16x32_bf16 v[104:107],a[124:127],a[116:119],v[104:107]
s_waitcnt lgkmcnt(4)
v_exp_f32 v94,v94
v_mfma_f32_16x16x32_bf16 v[76:79],a[128:131],a[0:3],0
v_exp_f32 v95,v95
v_mfma_f32_16x16x32_bf16 v[76:79],a[132:135],a[4:7],v[76:79]
s_waitcnt lgkmcnt(3)
v_exp_f32 v93,v93
v_mfma_f32_16x16x32_bf16 v[76:79],a[136:139],a[8:11],v[76:79]
s_waitcnt lgkmcnt(2)
v_exp_f32 v92,v92
v_mfma_f32_16x16x32_bf16 v[76:79],a[140:143],a[12:15],v[76:79]
s_waitcnt lgkmcnt(1)
v_cvt_pk_bf16_f32 v30,v92,v93
v_cvt_pk_bf16_f32 v31,v94,v95
v_mfma_f32_16x16x32_bf16 v[76:79],a[144:147],a[16:19],v[76:79]
s_waitcnt lgkmcnt(0)
v_fma_f32 v100,v100,s36,v16
v_fma_f32 v102,v102,s36,v16
v_mfma_f32_16x16x32_bf16 v[76:79],a[148:151],a[20:23],v[76:79]
v_fma_f32 v101,v101,s36,v16
s_waitcnt vmcnt(7)
s_barrier
v_mfma_f32_16x16x32_bf16 v[84:87],a[148:151],a[44:47],0
v_exp_f32 v101,v101
v_mfma_f32_16x16x32_bf16 v[84:87],a[144:147],a[40:43],v[84:87]
buffer_load_dwordx4 v6,s[4:7],s20 offen offset:0 lds
v_mfma_f32_16x16x32_bf16 v[84:87],a[140:143],a[36:39],v[84:87]
v_exp_f32 v100,v100
v_mfma_f32_16x16x32_bf16 v[84:87],a[136:139],a[32:35],v[84:87]
v_fma_f32 v103,v103,s36,v16
v_exp_f32 v103,v103
v_mfma_f32_16x16x32_bf16 v[84:87],a[132:135],a[28:31],v[84:87]
v_exp_f32 v102,v102
v_mfma_f32_16x16x32_bf16 v[84:87],a[128:131],a[24:27],v[84:87]
v_cvt_pk_bf16_f32 v34,v100,v101
v_cvt_pk_bf16_f32 v35,v102,v103
v_mfma_f32_16x16x32_bf16 v[92:95],a[128:131],a[48:51],0
buffer_load_dwordx4 v7,s[4:7],s20 offen offset:1024 lds
v_mfma_f32_16x16x32_bf16 v[92:95],a[132:135],a[52:55],v[92:95]
v_fma_f32 v109,v109,s36,v17
v_cvt_pk_bf16_f32 v248,v248,v249
v_mfma_f32_16x16x32_bf16 v[92:95],a[136:139],a[56:59],v[92:95]
v_fma_f32 v111,v111,s36,v17
v_exp_f32 v111,v111
v_mfma_f32_16x16x32_bf16 v[92:95],a[140:143],a[60:63],v[92:95]
v_cvt_pk_bf16_f32 v252,v252,v253
v_cvt_pk_bf16_f32 v253,v254,v255
v_mfma_f32_16x16x32_bf16 v[92:95],a[144:147],a[64:67],v[92:95]
ds_read_b64_tr_b16 a[122:123],v2 offset:6144
v_fma_f32 v110,v110,s36,v17
v_mfma_f32_16x16x32_bf16 v[92:95],a[148:151],a[68:71],v[92:95]
ds_read_b64_tr_b16 a[120:121],v2 offset:0
buffer_load_dwordx4 v8,s[4:7],s20 offen offset:2048 lds
v_mfma_f32_16x16x32_bf16 v[100:103],a[148:151],a[92:95],0
s_add_u32 s20,s20,12288
ds_read_b64_tr_b16 a[126:127],v3 offset:6144
v_exp_f32 v110,v110
v_mfma_f32_16x16x32_bf16 v[100:103],a[144:147],a[88:91],v[100:103]
ds_read_b64_tr_b16 a[124:125],v3 offset:0
v_fma_f32 v108,v108,s36,v17
v_mfma_f32_16x16x32_bf16 v[100:103],a[140:143],a[84:87],v[100:103]
v_exp_f32 v109,v109
v_mfma_f32_16x16x32_bf16 v[100:103],a[136:139],a[80:83],v[100:103]
v_exp_f32 v108,v108
v_mfma_f32_16x16x32_bf16 v[100:103],a[132:135],a[76:79],v[100:103]
v_cvt_pk_bf16_f32 v249,v250,v251
v_mov_b32 v62,0
v_mfma_f32_16x16x32_bf16 v[100:103],a[128:131],a[72:75],v[100:103]
ds_write_b64 v38,v[248:249] offset:8192
v_cvt_pk_bf16_f32 v38,v108,v109
v_fma_f32 v88,v88,s36,v15
v_mov_b32 v64,0
v_exp_f32 v88,v88
v_fma_f32 v89,v89,s36,v15
v_smfmac_f32_16x16x64_bf16 v[64:67],a[152:155],v[28:35],v18
ds_write_b64 v39,v[252:253] offset:8192
v_cvt_pk_bf16_f32 v39,v110,v111
v_mfma_f32_16x16x32_bf16 v[108:111],a[128:131],a[96:99],0
ds_read_b64_tr_b16 a[128:129],v4 offset:0
v_mov_b32 v60,0
v_mfma_f32_16x16x32_bf16 v[108:111],a[132:135],a[100:103],v[108:111]
ds_read_b64_tr_b16 a[130:131],v4 offset:6144
v_fma_f32 v72,v72,s36,v13
v_smfmac_f32_16x16x64_bf16 v[60:63],a[152:155],v[20:27],v18
ds_read_b64_tr_b16 a[134:135],v5 offset:6144
v_mfma_f32_16x16x32_bf16 v[108:111],a[136:139],a[104:107],v[108:111]
ds_read_b64_tr_b16 a[132:133],v5 offset:0
v_fma_f32 v75,v75,s36,v13
v_mfma_f32_16x16x32_bf16 v[108:111],a[140:143],a[108:111],v[108:111]
v_fma_f32 v74,v74,s36,v13
v_fma_f32 v81,v81,s36,v14
v_mfma_f32_16x16x32_bf16 v[108:111],a[144:147],a[112:115],v[108:111]
v_exp_f32 v89,v89
v_mfma_f32_16x16x32_bf16 v[108:111],a[148:151],a[116:119],v[108:111]
v_fma_f32 v73,v73,s36,v13
v_exp_f32 v72,v72
v_fma_f32 v83,v83,s36,v14
v_exp_f32 v83,v83
v_exp_f32 v74,v74
v_fma_f32 v80,v80,s36,v14
v_exp_f32 v80,v80
v_fma_f32 v82,v82,s36,v14
v_exp_f32 v82,v82
v_exp_f32 v81,v81
v_exp_f32 v73,v73
v_exp_f32 v75,v75
v_mov_b32 v71,0
v_mov_b32 v69,0
v_cvt_pk_bf16_f32 v48,v80,v81
v_cvt_pk_bf16_f32 v45,v74,v75
v_mov_b32 v70,0
v_cvt_pk_bf16_f32 v49,v82,v83
v_mov_b32 v68,0
v_cvt_pk_bf16_f32 v52,v88,v89
v_cvt_pk_bf16_f32 v44,v72,v73
s_waitcnt lgkmcnt(0)
v_mfma_f32_16x16x32_bf16 v[160:163],a[120:123],v[20:23],0
s_add_u32 m0,s23,0
ds_read_b64_tr_b16 a[136:137],v2 offset:128
v_fma_f32 v90,v90,s36,v15
v_mfma_f32_16x16x32_bf16 v[164:167],a[124:127],v[20:23],0
ds_read_b64_tr_b16 a[138:139],v2 offset:6272
v_fma_f32 v91,v91,s36,v15
v_mfma_f32_16x16x32_bf16 v[212:215],a[124:127],v[24:27],0
ds_read_b64_tr_b16 a[140:141],v3 offset:128
v_fma_f32 v96,v96,s36,v16
v_mfma_f32_16x16x32_bf16 v[208:211],a[120:123],v[24:27],0
ds_read_b64_tr_b16 a[142:143],v3 offset:6272
v_fma_f32 v97,v97,s36,v16
v_mfma_f32_16x16x32_bf16 v[112:115],a[120:123],v[28:31],0
ds_read_b64_tr_b16 a[144:145],v4 offset:128
v_fma_f32 v98,v98,s36,v16
v_mfma_f32_16x16x32_bf16 v[116:119],a[124:127],v[28:31],0
ds_read_b64_tr_b16 a[146:147],v4 offset:6272
v_fma_f32 v99,v99,s36,v16
v_mfma_f32_16x16x32_bf16 a[164:167],a[124:127],v[32:35],0
ds_read_b64_tr_b16 a[148:149],v5 offset:128
v_fma_f32 v104,v104,s36,v17
v_mfma_f32_16x16x32_bf16 a[160:163],a[120:123],v[32:35],0
ds_read_b64_tr_b16 a[150:151],v5 offset:6272
v_fma_f32 v105,v105,s36,v17
v_mfma_f32_16x16x32_bf16 a[208:211],a[120:123],v[36:39],0
ds_read_b64_tr_b16 a[120:121],v2 offset:256
v_fma_f32 v106,v106,s36,v17
v_mfma_f32_16x16x32_bf16 a[212:215],a[124:127],v[36:39],0
ds_read_b64_tr_b16 a[122:123],v2 offset:6400
v_fma_f32 v107,v107,s36,v17
v_mfma_f32_16x16x32_bf16 a[216:219],a[128:131],v[36:39],0
ds_read_b64_tr_b16 a[124:125],v3 offset:256
v_fma_f32 v76,v76,s36,v13
v_mfma_f32_16x16x32_bf16 a[220:223],a[132:135],v[36:39],0
ds_read_b64_tr_b16 a[126:127],v3 offset:6400
v_fma_f32 v77,v77,s36,v13
v_mfma_f32_16x16x32_bf16 a[172:175],a[132:135],v[32:35],0
v_exp_f32 v90,v90
v_mfma_f32_16x16x32_bf16 a[168:171],a[128:131],v[32:35],0
v_exp_f32 v91,v91
v_mfma_f32_16x16x32_bf16 v[120:123],a[128:131],v[28:31],0
v_cvt_pk_bf16_f32 v53,v90,v91
v_fma_f32 v78,v78,s36,v13
v_mfma_f32_16x16x32_bf16 v[124:127],a[132:135],v[28:31],0
v_exp_f32 v96,v96
v_mfma_f32_16x16x32_bf16 v[220:223],a[132:135],v[24:27],0
v_exp_f32 v97,v97
v_mfma_f32_16x16x32_bf16 v[216:219],a[128:131],v[24:27],0
v_exp_f32 v98,v98
v_mfma_f32_16x16x32_bf16 v[168:171],a[128:131],v[20:23],0
ds_read_b64_tr_b16 a[128:129],v4 offset:256
v_cvt_pk_bf16_f32 v56,v96,v97
v_mfma_f32_16x16x32_bf16 v[172:175],a[132:135],v[20:23],0
s_waitcnt lgkmcnt(1)
ds_read_b64_tr_b16 a[130:131],v4 offset:6400
v_fma_f32 v79,v79,s36,v13
v_mfma_f32_16x16x32_bf16 v[176:179],a[136:139],v[20:23],0
ds_read_b64_tr_b16 a[132:133],v5 offset:256
v_fma_f32 v84,v84,s36,v14
v_mfma_f32_16x16x32_bf16 v[180:183],a[140:143],v[20:23],0
ds_read_b64_tr_b16 a[134:135],v5 offset:6400
v_fma_f32 v85,v85,s36,v14
v_mfma_f32_16x16x32_bf16 v[228:231],a[140:143],v[24:27],0
v_exp_f32 v99,v99
v_mfma_f32_16x16x32_bf16 v[224:227],a[136:139],v[24:27],0
v_cvt_pk_bf16_f32 v57,v98,v99
v_fma_f32 v86,v86,s36,v14
v_mfma_f32_16x16x32_bf16 v[128:131],a[136:139],v[28:31],0
v_exp_f32 v104,v104
v_mfma_f32_16x16x32_bf16 v[132:135],a[140:143],v[28:31],0
v_exp_f32 v105,v105
v_mfma_f32_16x16x32_bf16 a[180:183],a[140:143],v[32:35],0
v_exp_f32 v106,v106
v_mfma_f32_16x16x32_bf16 a[176:179],a[136:139],v[32:35],0
v_exp_f32 v107,v107
v_mfma_f32_16x16x32_bf16 a[224:227],a[136:139],v[36:39],0
v_cvt_pk_bf16_f32 v40,v104,v105
v_cvt_pk_bf16_f32 v41,v106,v107
v_mfma_f32_16x16x32_bf16 a[228:231],a[140:143],v[36:39],0
v_exp_f32 v76,v76
v_mfma_f32_16x16x32_bf16 a[232:235],a[144:147],v[36:39],0
v_exp_f32 v77,v77
v_mfma_f32_16x16x32_bf16 a[236:239],a[148:151],v[36:39],0
v_exp_f32 v78,v78
v_mfma_f32_16x16x32_bf16 a[188:191],a[148:151],v[32:35],0
v_exp_f32 v79,v79
v_mfma_f32_16x16x32_bf16 a[184:187],a[144:147],v[32:35],0
v_cvt_pk_bf16_f32 v46,v76,v77
v_cvt_pk_bf16_f32 v47,v78,v79
v_mfma_f32_16x16x32_bf16 v[136:139],a[144:147],v[28:31],0
v_fma_f32 v87,v87,s36,v14
v_fma_f32 v92,v92,s36,v15
v_mfma_f32_16x16x32_bf16 v[140:143],a[148:151],v[28:31],0
v_exp_f32 v84,v84
v_mfma_f32_16x16x32_bf16 v[236:239],a[148:151],v[24:27],0
v_exp_f32 v85,v85
v_mfma_f32_16x16x32_bf16 v[232:235],a[144:147],v[24:27],0
v_exp_f32 v86,v86
v_mfma_f32_16x16x32_bf16 v[184:187],a[144:147],v[20:23],0
v_exp_f32 v87,v87
v_mfma_f32_16x16x32_bf16 v[188:191],a[148:151],v[20:23],0
v_cvt_pk_bf16_f32 v50,v84,v85
v_cvt_pk_bf16_f32 v51,v86,v87
v_mfma_f32_16x16x32_bf16 v[192:195],a[120:123],v[20:23],0
s_waitcnt vmcnt(36) lgkmcnt(0)
v_fma_f32 v93,v93,s36,v15
v_fma_f32 v94,v94,s36,v15
v_smfmac_f32_16x16x64_bf16 v[60:63],a[152:155],v[44:51],v18
s_barrier
v_mfma_f32_16x16x32_bf16 v[196:199],a[124:127],v[20:23],0
ds_read_b128 a[136:139],v0 offset:24576
v_fma_f32 v95,v95,s36,v15
v_mfma_f32_16x16x32_bf16 v[244:247],a[124:127],v[24:27],0
ds_read_b128 a[140:143],v1 offset:24576
v_fma_f32 v100,v100,s36,v16
v_mfma_f32_16x16x32_bf16 v[240:243],a[120:123],v[24:27],0
ds_read_b128 a[144:147],v0 offset:24704
v_fma_f32 v101,v101,s36,v16
v_mfma_f32_16x16x32_bf16 v[144:147],a[120:123],v[28:31],0
ds_read_b128 a[148:151],v1 offset:24704
v_fma_f32 v102,v102,s36,v16
v_mfma_f32_16x16x32_bf16 v[148:151],a[124:127],v[28:31],0
v_exp_f32 v92,v92
v_mfma_f32_16x16x32_bf16 a[196:199],a[124:127],v[32:35],0
buffer_load_dwordx4 v6,s[8:11],s21 offen offset:0 lds
v_mfma_f32_16x16x32_bf16 a[192:195],a[120:123],v[32:35],0
v_exp_f32 v93,v93
v_mfma_f32_16x16x32_bf16 a[240:243],a[120:123],v[36:39],0
ds_read_b128 a[120:123],v0 offset:24832
v_cvt_pk_bf16_f32 v54,v92,v93
v_mfma_f32_16x16x32_bf16 a[244:247],a[124:127],v[36:39],0
ds_read_b128 a[124:127],v1 offset:24832
v_fma_f32 v103,v103,s36,v16
v_mfma_f32_16x16x32_bf16 a[248:251],a[128:131],v[36:39],0
v_exp_f32 v94,v94
v_mfma_f32_16x16x32_bf16 a[252:255],a[132:135],v[36:39],0
v_exp_f32 v95,v95
v_mfma_f32_16x16x32_bf16 a[204:207],a[132:135],v[32:35],0
v_cvt_pk_bf16_f32 v55,v94,v95
v_fma_f32 v108,v108,s36,v17
v_mfma_f32_16x16x32_bf16 a[200:203],a[128:131],v[32:35],0
v_exp_f32 v100,v100
v_mfma_f32_16x16x32_bf16 v[152:155],a[128:131],v[28:31],0
v_exp_f32 v101,v101
v_mfma_f32_16x16x32_bf16 v[156:159],a[132:135],v[28:31],0
v_exp_f32 v102,v102
v_mfma_f32_16x16x32_bf16 v[252:255],a[132:135],v[24:27],0
v_exp_f32 v103,v103
v_mfma_f32_16x16x32_bf16 v[248:251],a[128:131],v[24:27],0
buffer_load_dwordx4 v7,s[8:11],s21 offen offset:1024 lds
v_mfma_f32_16x16x32_bf16 v[200:203],a[128:131],v[20:23],0
ds_read_b128 a[128:131],v0 offset:30720
v_cvt_pk_bf16_f32 v58,v100,v101
v_mfma_f32_16x16x32_bf16 v[204:207],a[132:135],v[20:23],0
s_waitcnt lgkmcnt(1)
ds_read_b128 a[132:135],v1 offset:30720
v_cvt_pk_bf16_f32 v59,v102,v103
v_mfma_f32_16x16x32_bf16 v[72:75],a[136:139],a[0:3],0
v_fma_f32 v109,v109,s36,v17
v_fma_f32 v110,v110,s36,v17
v_smfmac_f32_16x16x64_bf16 v[64:67],a[152:155],v[52:59],v18
v_fma_f32 v111,v111,s36,v17
v_mfma_f32_16x16x32_bf16 v[72:75],a[140:143],a[4:7],v[72:75]
v_exp_f32 v108,v108
v_mfma_f32_16x16x32_bf16 v[72:75],a[144:147],a[8:11],v[72:75]
v_exp_f32 v109,v109
v_mfma_f32_16x16x32_bf16 v[72:75],a[148:151],a[12:15],v[72:75]
v_exp_f32 v110,v110
v_mfma_f32_16x16x32_bf16 v[72:75],a[120:123],a[16:19],v[72:75]
v_exp_f32 v111,v111
v_mfma_f32_16x16x32_bf16 v[72:75],a[124:127],a[20:23],v[72:75]
v_cvt_pk_bf16_f32 v42,v108,v109
v_cvt_pk_bf16_f32 v43,v110,v111
v_mfma_f32_16x16x32_bf16 v[80:83],a[124:127],a[44:47],0
v_mfma_f32_16x16x32_bf16 v[80:83],a[120:123],a[40:43],v[80:83]
v_smfmac_f32_16x16x64_bf16 v[68:71],a[152:155],v[36:43],v18
buffer_load_dwordx4 v8,s[8:11],s21 offen offset:2048 lds
v_mfma_f32_16x16x32_bf16 v[80:83],a[148:151],a[36:39],v[80:83]
s_add_u32 s21,s21,12288
v_fma_f32 v72,v72,s36,v13
v_fma_f32 v73,v73,s36,v13
v_mfma_f32_16x16x32_bf16 v[80:83],a[144:147],a[32:35],v[80:83]
s_add_u32 m0,s22,12288
v_fma_f32 v74,v74,s36,v13
v_fma_f32 v75,v75,s36,v13
v_mfma_f32_16x16x32_bf16 v[80:83],a[140:143],a[28:31],v[80:83]
v_exp_f32 v72,v72
v_mfma_f32_16x16x32_bf16 v[80:83],a[136:139],a[24:27],v[80:83]
v_exp_f32 v73,v73
v_mfma_f32_16x16x32_bf16 v[88:91],a[136:139],a[48:51],0
v_exp_f32 v74,v74
v_mfma_f32_16x16x32_bf16 v[88:91],a[140:143],a[52:55],v[88:91]
v_exp_f32 v75,v75
v_mfma_f32_16x16x32_bf16 v[88:91],a[144:147],a[56:59],v[88:91]
v_cvt_pk_bf16_f32 v20,v72,v73
v_cvt_pk_bf16_f32 v21,v74,v75
v_mfma_f32_16x16x32_bf16 v[88:91],a[148:151],a[60:63],v[88:91]
v_fma_f32 v80,v80,s36,v14
v_fma_f32 v81,v81,s36,v14
v_mfma_f32_16x16x32_bf16 v[88:91],a[120:123],a[64:67],v[88:91]
v_fma_f32 v82,v82,s36,v14
v_fma_f32 v83,v83,s36,v14
v_mfma_f32_16x16x32_bf16 v[88:91],a[124:127],a[68:71],v[88:91]
v_exp_f32 v80,v80
v_mfma_f32_16x16x32_bf16 v[96:99],a[124:127],a[92:95],0
buffer_load_dwordx4 v6,s[4:7],s20 offen offset:0 lds
v_mfma_f32_16x16x32_bf16 v[96:99],a[120:123],a[88:91],v[96:99]
v_exp_f32 v81,v81
v_mfma_f32_16x16x32_bf16 v[96:99],a[148:151],a[84:87],v[96:99]
v_exp_f32 v82,v82
v_mfma_f32_16x16x32_bf16 v[96:99],a[144:147],a[80:83],v[96:99]
v_fma_f32 v88,v88,s36,v15
v_fma_f32 v89,v89,s36,v15
v_mfma_f32_16x16x32_bf16 v[96:99],a[140:143],a[76:79],v[96:99]
v_exp_f32 v83,v83
v_mfma_f32_16x16x32_bf16 v[96:99],a[136:139],a[72:75],v[96:99]
v_exp_f32 v88,v88
v_mfma_f32_16x16x32_bf16 v[104:107],a[136:139],a[96:99],0
ds_read_b128 a[136:139],v0 offset:30848
v_cvt_pk_bf16_f32 v24,v80,v81
v_mfma_f32_16x16x32_bf16 v[104:107],a[140:143],a[100:103],v[104:107]
ds_read_b128 a[140:143],v1 offset:30848
v_cvt_pk_bf16_f32 v25,v82,v83
v_mfma_f32_16x16x32_bf16 v[104:107],a[144:147],a[104:107],v[104:107]
ds_read_b128 a[144:147],v0 offset:30976
v_mfma_f32_16x16x32_bf16 v[104:107],a[148:151],a[108:111],v[104:107]
ds_read_b128 a[148:151],v1 offset:30976
v_mfma_f32_16x16x32_bf16 v[104:107],a[120:123],a[112:115],v[104:107]
v_exp_f32 v89,v89
v_mfma_f32_16x16x32_bf16 v[104:107],a[124:127],a[116:119],v[104:107]
s_waitcnt lgkmcnt(4)
v_cvt_pk_bf16_f32 v28,v88,v89
v_mfma_f32_16x16x32_bf16 v[76:79],a[128:131],a[0:3],0
buffer_load_dwordx4 v7,s[4:7],s20 offen offset:1024 lds
v_mfma_f32_16x16x32_bf16 v[76:79],a[132:135],a[4:7],v[76:79]
s_waitcnt lgkmcnt(3)
v_mfma_f32_16x16x32_bf16 v[76:79],a[136:139],a[8:11],v[76:79]
s_waitcnt lgkmcnt(2)
v_mfma_f32_16x16x32_bf16 v[76:79],a[140:143],a[12:15],v[76:79]
s_waitcnt lgkmcnt(1)
v_mfma_f32_16x16x32_bf16 v[76:79],a[144:147],a[16:19],v[76:79]
s_waitcnt lgkmcnt(0)
v_mfma_f32_16x16x32_bf16 v[76:79],a[148:151],a[20:23],v[76:79]
v_mfma_f32_16x16x32_bf16 v[84:87],a[148:151],a[44:47],0
v_mfma_f32_16x16x32_bf16 v[84:87],a[144:147],a[40:43],v[84:87]
v_mfma_f32_16x16x32_bf16 v[84:87],a[140:143],a[36:39],v[84:87]
v_mfma_f32_16x16x32_bf16 v[84:87],a[136:139],a[32:35],v[84:87]
v_mfma_f32_16x16x32_bf16 v[84:87],a[132:135],a[28:31],v[84:87]
v_mfma_f32_16x16x32_bf16 v[84:87],a[128:131],a[24:27],v[84:87]
v_mfma_f32_16x16x32_bf16 v[92:95],a[128:131],a[48:51],0
buffer_load_dwordx4 v8,s[4:7],s20 offen offset:2048 lds
v_mfma_f32_16x16x32_bf16 v[92:95],a[132:135],a[52:55],v[92:95]
s_add_u32 s20,s20,12288
v_mfma_f32_16x16x32_bf16 v[92:95],a[136:139],a[56:59],v[92:95]
v_mfma_f32_16x16x32_bf16 v[92:95],a[140:143],a[60:63],v[92:95]
v_mfma_f32_16x16x32_bf16 v[92:95],a[144:147],a[64:67],v[92:95]
v_mfma_f32_16x16x32_bf16 v[92:95],a[148:151],a[68:71],v[92:95]
ds_read_b64_tr_b16 a[120:121],v2 offset:12288
v_mfma_f32_16x16x32_bf16 v[100:103],a[148:151],a[92:95],0
ds_read_b64_tr_b16 a[122:123],v2 offset:18432
v_mfma_f32_16x16x32_bf16 v[100:103],a[144:147],a[88:91],v[100:103]
v_mfma_f32_16x16x32_bf16 v[100:103],a[140:143],a[84:87],v[100:103]
ds_read_b64_tr_b16 a[124:125],v3 offset:12288
v_mfma_f32_16x16x32_bf16 v[100:103],a[136:139],a[80:83],v[100:103]
ds_read_b64_tr_b16 a[126:127],v3 offset:18432
v_mfma_f32_16x16x32_bf16 v[100:103],a[132:135],a[76:79],v[100:103]
v_mfma_f32_16x16x32_bf16 v[100:103],a[128:131],a[72:75],v[100:103]
v_mfma_f32_16x16x32_bf16 v[108:111],a[128:131],a[96:99],0
ds_read_b64_tr_b16 a[128:129],v4 offset:12288
v_mfma_f32_16x16x32_bf16 v[108:111],a[132:135],a[100:103],v[108:111]
ds_read_b64_tr_b16 a[130:131],v4 offset:18432
v_mfma_f32_16x16x32_bf16 v[108:111],a[136:139],a[104:107],v[108:111]
ds_read_b64_tr_b16 a[132:133],v5 offset:12288
v_mfma_f32_16x16x32_bf16 v[108:111],a[140:143],a[108:111],v[108:111]
ds_read_b64_tr_b16 a[134:135],v5 offset:18432
v_mfma_f32_16x16x32_bf16 v[108:111],a[144:147],a[112:115],v[108:111]
v_mfma_f32_16x16x32_bf16 v[108:111],a[148:151],a[116:119],v[108:111]
s_waitcnt lgkmcnt(4)
v_mfma_f32_16x16x32_bf16 v[160:163],a[120:123],v[44:47],v[160:163]
s_add_u32 m0,s23,12288
ds_read_b64_tr_b16 a[136:137],v2 offset:12416
v_fma_f32 v90,v90,s36,v15
v_mfma_f32_16x16x32_bf16 v[164:167],a[124:127],v[44:47],v[164:167]
ds_read_b64_tr_b16 a[138:139],v2 offset:18560
v_fma_f32 v91,v91,s36,v15
v_mfma_f32_16x16x32_bf16 v[212:215],a[124:127],v[48:51],v[212:215]
ds_read_b64_tr_b16 a[140:141],v3 offset:12416
v_fma_f32 v96,v96,s36,v16
v_mfma_f32_16x16x32_bf16 v[208:211],a[120:123],v[48:51],v[208:211]
ds_read_b64_tr_b16 a[142:143],v3 offset:18560
v_fma_f32 v97,v97,s36,v16
v_mfma_f32_16x16x32_bf16 v[112:115],a[120:123],v[52:55],v[112:115]
ds_read_b64_tr_b16 a[144:145],v4 offset:12416
v_fma_f32 v98,v98,s36,v16
v_mfma_f32_16x16x32_bf16 v[116:119],a[124:127],v[52:55],v[116:119]
ds_read_b64_tr_b16 a[146:147],v4 offset:18560
v_fma_f32 v99,v99,s36,v16
v_mfma_f32_16x16x32_bf16 a[164:167],a[124:127],v[56:59],a[164:167]
ds_read_b64_tr_b16 a[148:149],v5 offset:12416
v_fma_f32 v104,v104,s36,v17
v_mfma_f32_16x16x32_bf16 a[160:163],a[120:123],v[56:59],a[160:163]
ds_read_b64_tr_b16 a[150:151],v5 offset:18560
v_fma_f32 v105,v105,s36,v17
v_mfma_f32_16x16x32_bf16 a[208:211],a[120:123],v[40:43],a[208:211]
ds_read_b64_tr_b16 a[120:121],v2 offset:12544
v_fma_f32 v106,v106,s36,v17
v_mfma_f32_16x16x32_bf16 a[212:215],a[124:127],v[40:43],a[212:215]
s_waitcnt lgkmcnt(6)
ds_read_b64_tr_b16 a[122:123],v2 offset:18688
v_fma_f32 v107,v107,s36,v17
v_mfma_f32_16x16x32_bf16 a[216:219],a[128:131],v[40:43],a[216:219]
ds_read_b64_tr_b16 a[124:125],v3 offset:12544
v_fma_f32 v76,v76,s36,v13
v_mfma_f32_16x16x32_bf16 a[220:223],a[132:135],v[40:43],a[220:223]
ds_read_b64_tr_b16 a[126:127],v3 offset:18688
v_fma_f32 v77,v77,s36,v13
v_mfma_f32_16x16x32_bf16 a[172:175],a[132:135],v[56:59],a[172:175]
v_exp_f32 v90,v90
v_mfma_f32_16x16x32_bf16 a[168:171],a[128:131],v[56:59],a[168:171]
v_exp_f32 v91,v91
v_mfma_f32_16x16x32_bf16 v[120:123],a[128:131],v[52:55],v[120:123]
v_cvt_pk_bf16_f32 v29,v90,v91
v_fma_f32 v78,v78,s36,v13
v_mfma_f32_16x16x32_bf16 v[124:127],a[132:135],v[52:55],v[124:127]
v_exp_f32 v96,v96
v_mfma_f32_16x16x32_bf16 v[220:223],a[132:135],v[48:51],v[220:223]
v_exp_f32 v97,v97
v_mfma_f32_16x16x32_bf16 v[216:219],a[128:131],v[48:51],v[216:219]
v_exp_f32 v98,v98
v_mfma_f32_16x16x32_bf16 v[168:171],a[128:131],v[44:47],v[168:171]
ds_read_b64_tr_b16 a[128:129],v4 offset:12544
v_cvt_pk_bf16_f32 v32,v96,v97
v_mfma_f32_16x16x32_bf16 v[172:175],a[132:135],v[44:47],v[172:175]
ds_read_b64_tr_b16 a[130:131],v4 offset:18688
v_fma_f32 v79,v79,s36,v13
v_mfma_f32_16x16x32_bf16 v[176:179],a[136:139],v[44:47],v[176:179]
s_waitcnt lgkmcnt(2)
ds_read_b64_tr_b16 a[132:133],v5 offset:12544
v_fma_f32 v84,v84,s36,v14
v_mfma_f32_16x16x32_bf16 v[180:183],a[140:143],v[44:47],v[180:183]
ds_read_b64_tr_b16 a[134:135],v5 offset:18688
v_fma_f32 v85,v85,s36,v14
v_mfma_f32_16x16x32_bf16 v[228:231],a[140:143],v[48:51],v[228:231]
v_exp_f32 v99,v99
v_mfma_f32_16x16x32_bf16 v[224:227],a[136:139],v[48:51],v[224:227]
v_cvt_pk_bf16_f32 v33,v98,v99
v_fma_f32 v86,v86,s36,v14
v_mfma_f32_16x16x32_bf16 v[128:131],a[136:139],v[52:55],v[128:131]
v_exp_f32 v104,v104
v_mfma_f32_16x16x32_bf16 v[132:135],a[140:143],v[52:55],v[132:135]
v_exp_f32 v105,v105
v_mfma_f32_16x16x32_bf16 a[180:183],a[140:143],v[56:59],a[180:183]
v_exp_f32 v106,v106
v_mfma_f32_16x16x32_bf16 a[176:179],a[136:139],v[56:59],a[176:179]
v_exp_f32 v107,v107
v_mfma_f32_16x16x32_bf16 a[224:227],a[136:139],v[40:43],a[224:227]
v_cvt_pk_bf16_f32 v36,v104,v105
v_cvt_pk_bf16_f32 v37,v106,v107
v_mfma_f32_16x16x32_bf16 a[228:231],a[140:143],v[40:43],a[228:231]
v_exp_f32 v76,v76
v_mfma_f32_16x16x32_bf16 a[232:235],a[144:147],v[40:43],a[232:235]
v_exp_f32 v77,v77
v_mfma_f32_16x16x32_bf16 a[236:239],a[148:151],v[40:43],a[236:239]
v_exp_f32 v78,v78
v_mfma_f32_16x16x32_bf16 a[188:191],a[148:151],v[56:59],a[188:191]
v_exp_f32 v79,v79
v_mfma_f32_16x16x32_bf16 a[184:187],a[144:147],v[56:59],a[184:187]
v_cvt_pk_bf16_f32 v22,v76,v77
v_cvt_pk_bf16_f32 v23,v78,v79
v_mfma_f32_16x16x32_bf16 v[136:139],a[144:147],v[52:55],v[136:139]
v_fma_f32 v87,v87,s36,v14
v_fma_f32 v92,v92,s36,v15
v_mfma_f32_16x16x32_bf16 v[140:143],a[148:151],v[52:55],v[140:143]
v_exp_f32 v84,v84
v_mfma_f32_16x16x32_bf16 v[236:239],a[148:151],v[48:51],v[236:239]
v_exp_f32 v85,v85
v_mfma_f32_16x16x32_bf16 v[232:235],a[144:147],v[48:51],v[232:235]
v_exp_f32 v86,v86
v_mfma_f32_16x16x32_bf16 v[184:187],a[144:147],v[44:47],v[184:187]
v_exp_f32 v87,v87
v_mfma_f32_16x16x32_bf16 v[188:191],a[148:151],v[44:47],v[188:191]
v_cvt_pk_bf16_f32 v26,v84,v85
v_cvt_pk_bf16_f32 v27,v86,v87
v_mfma_f32_16x16x32_bf16 v[192:195],a[120:123],v[44:47],v[192:195]
s_waitcnt vmcnt(6) lgkmcnt(0)
v_fma_f32 v93,v93,s36,v15
v_fma_f32 v94,v94,s36,v15
v_smfmac_f32_16x16x64_bf16 v[60:63],a[152:155],v[20:27],v18
s_barrier
v_mfma_f32_16x16x32_bf16 v[196:199],a[124:127],v[44:47],v[196:199]
ds_read_b128 a[136:139],v0 offset:0
v_fma_f32 v95,v95,s36,v15
v_mfma_f32_16x16x32_bf16 v[244:247],a[124:127],v[48:51],v[244:247]
ds_read_b128 a[140:143],v1 offset:0
v_fma_f32 v100,v100,s36,v16
v_mfma_f32_16x16x32_bf16 v[240:243],a[120:123],v[48:51],v[240:243]
ds_read_b128 a[144:147],v0 offset:128
v_fma_f32 v101,v101,s36,v16
v_mfma_f32_16x16x32_bf16 v[144:147],a[120:123],v[52:55],v[144:147]
ds_read_b128 a[148:151],v1 offset:128
v_fma_f32 v102,v102,s36,v16
v_mfma_f32_16x16x32_bf16 v[148:151],a[124:127],v[52:55],v[148:151]
v_exp_f32 v92,v92
v_mfma_f32_16x16x32_bf16 a[196:199],a[124:127],v[56:59],a[196:199]
buffer_load_dwordx4 v6,s[8:11],s21 offen offset:0 lds
v_mfma_f32_16x16x32_bf16 a[192:195],a[120:123],v[56:59],a[192:195]
v_exp_f32 v93,v93
v_mfma_f32_16x16x32_bf16 a[240:243],a[120:123],v[40:43],a[240:243]
ds_read_b128 a[120:123],v0 offset:256
v_cvt_pk_bf16_f32 v30,v92,v93
v_mfma_f32_16x16x32_bf16 a[244:247],a[124:127],v[40:43],a[244:247]
ds_read_b128 a[124:127],v1 offset:256
v_fma_f32 v103,v103,s36,v16
v_mfma_f32_16x16x32_bf16 a[248:251],a[128:131],v[40:43],a[248:251]
v_exp_f32 v94,v94
v_mfma_f32_16x16x32_bf16 a[252:255],a[132:135],v[40:43],a[252:255]
v_exp_f32 v95,v95
v_mfma_f32_16x16x32_bf16 a[204:207],a[132:135],v[56:59],a[204:207]
v_cvt_pk_bf16_f32 v31,v94,v95
v_fma_f32 v108,v108,s36,v17
v_mfma_f32_16x16x32_bf16 a[200:203],a[128:131],v[56:59],a[200:203]
v_exp_f32 v100,v100
v_mfma_f32_16x16x32_bf16 v[152:155],a[128:131],v[52:55],v[152:155]
v_exp_f32 v101,v101
v_mfma_f32_16x16x32_bf16 v[156:159],a[132:135],v[52:55],v[156:159]
v_exp_f32 v102,v102
v_mfma_f32_16x16x32_bf16 v[252:255],a[132:135],v[48:51],v[252:255]
v_exp_f32 v103,v103
v_mfma_f32_16x16x32_bf16 v[248:251],a[128:131],v[48:51],v[248:251]
buffer_load_dwordx4 v7,s[8:11],s21 offen offset:1024 lds
v_mfma_f32_16x16x32_bf16 v[200:203],a[128:131],v[44:47],v[200:203]
ds_read_b128 a[128:131],v0 offset:6144
v_cvt_pk_bf16_f32 v34,v100,v101
v_mfma_f32_16x16x32_bf16 v[204:207],a[132:135],v[44:47],v[204:207]
s_waitcnt lgkmcnt(1)
ds_read_b128 a[132:135],v1 offset:6144
v_cvt_pk_bf16_f32 v35,v102,v103
v_mfma_f32_16x16x32_bf16 v[72:75],a[136:139],a[0:3],0
v_fma_f32 v109,v109,s36,v17
v_fma_f32 v110,v110,s36,v17
v_smfmac_f32_16x16x64_bf16 v[64:67],a[152:155],v[28:35],v18
v_fma_f32 v111,v111,s36,v17
v_mfma_f32_16x16x32_bf16 v[72:75],a[140:143],a[4:7],v[72:75]
v_exp_f32 v108,v108
v_mfma_f32_16x16x32_bf16 v[72:75],a[144:147],a[8:11],v[72:75]
v_exp_f32 v109,v109
v_mfma_f32_16x16x32_bf16 v[72:75],a[148:151],a[12:15],v[72:75]
v_exp_f32 v110,v110
v_mfma_f32_16x16x32_bf16 v[72:75],a[120:123],a[16:19],v[72:75]
v_exp_f32 v111,v111
v_mfma_f32_16x16x32_bf16 v[72:75],a[124:127],a[20:23],v[72:75]
v_cvt_pk_bf16_f32 v38,v108,v109
v_cvt_pk_bf16_f32 v39,v110,v111
v_mfma_f32_16x16x32_bf16 v[80:83],a[124:127],a[44:47],0
v_mfma_f32_16x16x32_bf16 v[80:83],a[120:123],a[40:43],v[80:83]
v_mfma_f32_16x16x32_bf16 v[80:83],a[148:151],a[36:39],v[80:83]
buffer_load_dwordx4 v8,s[8:11],s21 offen offset:2048 lds
v_mfma_f32_16x16x32_bf16 v[80:83],a[144:147],a[32:35],v[80:83]
s_add_u32 s21,s21,12288
v_fma_f32 v72,v72,s36,v13
v_fma_f32 v73,v73,s36,v13
v_mfma_f32_16x16x32_bf16 v[80:83],a[140:143],a[28:31],v[80:83]
s_add_u32 m0,s22,24576
v_fma_f32 v74,v74,s36,v13
v_fma_f32 v75,v75,s36,v13
v_mfma_f32_16x16x32_bf16 v[80:83],a[136:139],a[24:27],v[80:83]
v_exp_f32 v72,v72
v_mfma_f32_16x16x32_bf16 v[88:91],a[136:139],a[48:51],0
v_exp_f32 v73,v73
v_mfma_f32_16x16x32_bf16 v[88:91],a[140:143],a[52:55],v[88:91]
v_exp_f32 v74,v74
v_mfma_f32_16x16x32_bf16 v[88:91],a[144:147],a[56:59],v[88:91]
v_exp_f32 v75,v75
v_mfma_f32_16x16x32_bf16 v[88:91],a[148:151],a[60:63],v[88:91]
v_fma_f32 v80,v80,s36,v14
v_fma_f32 v81,v81,s36,v14
v_mfma_f32_16x16x32_bf16 v[88:91],a[120:123],a[64:67],v[88:91]
v_fma_f32 v82,v82,s36,v14
v_fma_f32 v83,v83,s36,v14
v_mfma_f32_16x16x32_bf16 v[88:91],a[124:127],a[68:71],v[88:91]
v_exp_f32 v80,v80
v_mfma_f32_16x16x32_bf16 v[96:99],a[124:127],a[92:95],0
v_exp_f32 v81,v81
v_mfma_f32_16x16x32_bf16 v[96:99],a[120:123],a[88:91],v[96:99]
v_exp_f32 v82,v82
v_mfma_f32_16x16x32_bf16 v[96:99],a[148:151],a[84:87],v[96:99]
buffer_load_dwordx4 v6,s[4:7],s20 offen offset:0 lds
v_mfma_f32_16x16x32_bf16 v[96:99],a[144:147],a[80:83],v[96:99]
v_fma_f32 v88,v88,s36,v15
v_fma_f32 v89,v89,s36,v15
v_mfma_f32_16x16x32_bf16 v[96:99],a[140:143],a[76:79],v[96:99]
v_exp_f32 v83,v83
v_mfma_f32_16x16x32_bf16 v[96:99],a[136:139],a[72:75],v[96:99]
v_exp_f32 v88,v88
v_mfma_f32_16x16x32_bf16 v[104:107],a[136:139],a[96:99],0
ds_read_b128 a[136:139],v0 offset:6272
v_cvt_pk_bf16_f32 v44,v72,v73
v_mfma_f32_16x16x32_bf16 v[104:107],a[140:143],a[100:103],v[104:107]
ds_read_b128 a[140:143],v1 offset:6272
v_cvt_pk_bf16_f32 v45,v74,v75
v_mfma_f32_16x16x32_bf16 v[104:107],a[144:147],a[104:107],v[104:107]
ds_read_b128 a[144:147],v0 offset:6400
v_cvt_pk_bf16_f32 v48,v80,v81
v_mfma_f32_16x16x32_bf16 v[104:107],a[148:151],a[108:111],v[104:107]
ds_read_b128 a[148:151],v1 offset:6400
v_cvt_pk_bf16_f32 v49,v82,v83
v_mfma_f32_16x16x32_bf16 v[104:107],a[120:123],a[112:115],v[104:107]
v_exp_f32 v89,v89
v_mfma_f32_16x16x32_bf16 v[104:107],a[124:127],a[116:119],v[104:107]
s_waitcnt lgkmcnt(4)
v_cvt_pk_bf16_f32 v52,v88,v89
v_mfma_f32_16x16x32_bf16 v[76:79],a[128:131],a[0:3],0
v_mfma_f32_16x16x32_bf16 v[76:79],a[132:135],a[4:7],v[76:79]
buffer_load_dwordx4 v7,s[4:7],s20 offen offset:1024 lds
s_waitcnt lgkmcnt(3)
v_mfma_f32_16x16x32_bf16 v[76:79],a[136:139],a[8:11],v[76:79]
s_waitcnt lgkmcnt(2)
v_mfma_f32_16x16x32_bf16 v[76:79],a[140:143],a[12:15],v[76:79]
s_waitcnt lgkmcnt(1)
v_mfma_f32_16x16x32_bf16 v[76:79],a[144:147],a[16:19],v[76:79]
s_waitcnt lgkmcnt(0)
v_mfma_f32_16x16x32_bf16 v[76:79],a[148:151],a[20:23],v[76:79]
v_mfma_f32_16x16x32_bf16 v[84:87],a[148:151],a[44:47],0
v_mfma_f32_16x16x32_bf16 v[84:87],a[144:147],a[40:43],v[84:87]
v_mfma_f32_16x16x32_bf16 v[84:87],a[140:143],a[36:39],v[84:87]
v_mfma_f32_16x16x32_bf16 v[84:87],a[136:139],a[32:35],v[84:87]
v_mfma_f32_16x16x32_bf16 v[84:87],a[132:135],a[28:31],v[84:87]
v_mfma_f32_16x16x32_bf16 v[84:87],a[128:131],a[24:27],v[84:87]
v_mfma_f32_16x16x32_bf16 v[92:95],a[128:131],a[48:51],0
v_mfma_f32_16x16x32_bf16 v[92:95],a[132:135],a[52:55],v[92:95]
buffer_load_dwordx4 v8,s[4:7],s20 offen offset:2048 lds
v_mfma_f32_16x16x32_bf16 v[92:95],a[136:139],a[56:59],v[92:95]
s_add_u32 s20,s20,12288
v_mfma_f32_16x16x32_bf16 v[92:95],a[140:143],a[60:63],v[92:95]
v_mfma_f32_16x16x32_bf16 v[92:95],a[144:147],a[64:67],v[92:95]
v_mfma_f32_16x16x32_bf16 v[92:95],a[148:151],a[68:71],v[92:95]
v_mfma_f32_16x16x32_bf16 v[100:103],a[148:151],a[92:95],0
v_mfma_f32_16x16x32_bf16 v[100:103],a[144:147],a[88:91],v[100:103]
ds_read_b64_tr_b16 a[120:121],v2 offset:24576
v_mfma_f32_16x16x32_bf16 v[100:103],a[140:143],a[84:87],v[100:103]
ds_read_b64_tr_b16 a[122:123],v2 offset:30720
v_mfma_f32_16x16x32_bf16 v[100:103],a[136:139],a[80:83],v[100:103]
ds_read_b64_tr_b16 a[124:125],v3 offset:24576
v_mfma_f32_16x16x32_bf16 v[100:103],a[132:135],a[76:79],v[100:103]
ds_read_b64_tr_b16 a[126:127],v3 offset:30720
v_mfma_f32_16x16x32_bf16 v[100:103],a[128:131],a[72:75],v[100:103]
v_mfma_f32_16x16x32_bf16 v[108:111],a[128:131],a[96:99],0
ds_read_b64_tr_b16 a[128:129],v4 offset:24576
v_mfma_f32_16x16x32_bf16 v[108:111],a[132:135],a[100:103],v[108:111]
ds_read_b64_tr_b16 a[130:131],v4 offset:30720
v_mfma_f32_16x16x32_bf16 v[108:111],a[136:139],a[104:107],v[108:111]
ds_read_b64_tr_b16 a[132:133],v5 offset:24576
v_mfma_f32_16x16x32_bf16 v[108:111],a[140:143],a[108:111],v[108:111]
ds_read_b64_tr_b16 a[134:135],v5 offset:30720
v_mfma_f32_16x16x32_bf16 v[108:111],a[144:147],a[112:115],v[108:111]
v_mfma_f32_16x16x32_bf16 v[108:111],a[148:151],a[116:119],v[108:111]
s_mov_b32 s38,0
s_branch L_loop5
L_loop4:
.p2align 6
L_loop4w0:
s_waitcnt lgkmcnt(3)
v_mfma_f32_16x16x32_bf16 v[160:163],a[120:123],v[20:23],v[160:163]
ds_read_b128 a[156:159],v10 offset:0
v_fma_f32 v82,v82,s36,v14
v_mfma_f32_16x16x32_bf16 v[164:167],a[124:127],v[20:23],v[164:167]
ds_read_b64_tr_b16 a[136:137],v2 offset:24704
v_fma_f32 v83,v83,s36,v14
v_mfma_f32_16x16x32_bf16 v[212:215],a[124:127],v[24:27],v[212:215]
ds_read_b64_tr_b16 a[138:139],v2 offset:30848
v_fma_f32 v88,v88,s36,v15
v_mfma_f32_16x16x32_bf16 v[208:211],a[120:123],v[24:27],v[208:211]
ds_read_b64_tr_b16 a[140:141],v3 offset:24704
v_fma_f32 v89,v89,s36,v15
v_mfma_f32_16x16x32_bf16 v[112:115],a[120:123],v[28:31],v[112:115]
ds_read_b64_tr_b16 a[142:143],v3 offset:30848
v_fma_f32 v90,v90,s36,v15
v_mfma_f32_16x16x32_bf16 v[116:119],a[124:127],v[28:31],v[116:119]
ds_read_b64_tr_b16 a[144:145],v4 offset:24704
v_fma_f32 v91,v91,s36,v15
v_mfma_f32_16x16x32_bf16 a[164:167],a[124:127],v[32:35],a[164:167]
ds_read_b64_tr_b16 a[146:147],v4 offset:30848
v_fma_f32 v96,v96,s36,v16
v_mfma_f32_16x16x32_bf16 a[160:163],a[120:123],v[32:35],a[160:163]
s_waitcnt lgkmcnt(6)
ds_read_b64_tr_b16 a[148:149],v5 offset:24704
v_fma_f32 v97,v97,s36,v16
v_mfma_f32_16x16x32_bf16 a[168:171],a[128:131],v[32:35],a[168:171]
ds_read_b64_tr_b16 a[150:151],v5 offset:30848
v_fma_f32 v98,v98,s36,v16
v_mfma_f32_16x16x32_bf16 a[172:175],a[132:135],v[32:35],a[172:175]
ds_read_b64_tr_b16 a[120:121],v2 offset:24832
v_fma_f32 v99,v99,s36,v16
v_mfma_f32_16x16x32_bf16 v[124:127],a[132:135],v[28:31],v[124:127]
ds_read_b64_tr_b16 a[122:123],v2 offset:30976
v_fma_f32 v76,v76,s36,v13
v_mfma_f32_16x16x32_bf16 v[120:123],a[128:131],v[28:31],v[120:123]
ds_read_b64_tr_b16 a[124:125],v3 offset:24832
v_fma_f32 v77,v77,s36,v13
v_mfma_f32_16x16x32_bf16 v[216:219],a[128:131],v[24:27],v[216:219]
ds_read_b64_tr_b16 a[126:127],v3 offset:30976
v_fma_f32 v78,v78,s36,v13
v_mfma_f32_16x16x32_bf16 v[220:223],a[132:135],v[24:27],v[220:223]
v_exp_f32 v82,v82
v_mfma_f32_16x16x32_bf16 v[172:175],a[132:135],v[20:23],v[172:175]
ds_read_b64_tr_b16 a[132:133],v5 offset:24832
v_fma_f32 v79,v79,s36,v13
v_mfma_f32_16x16x32_bf16 v[168:171],a[128:131],v[20:23],v[168:171]
s_waitcnt lgkmcnt(5)
ds_read_b64_tr_b16 a[128:129],v4 offset:24832
v_fma_f32 v84,v84,s36,v14
v_mfma_f32_16x16x32_bf16 v[176:179],a[136:139],v[20:23],v[176:179]
buffer_store_dwordx4 a[156:159],v9,s[16:19],s27 offen offset:0 nt
ds_read_b64_tr_b16 a[130:131],v4 offset:30976
ds_read_b128 a[156:159],v10 offset:1024
v_mfma_f32_16x16x32_bf16 v[180:183],a[140:143],v[20:23],v[180:183]
ds_read_b64_tr_b16 a[134:135],v5 offset:30976
v_mfma_f32_16x16x32_bf16 v[228:231],a[140:143],v[24:27],v[228:231]
v_exp_f32 v83,v83
v_mfma_f32_16x16x32_bf16 v[224:227],a[136:139],v[24:27],v[224:227]
v_cvt_pk_bf16_f32 v49,v82,v83
v_fma_f32 v85,v85,s36,v14
v_mfma_f32_16x16x32_bf16 v[128:131],a[136:139],v[28:31],v[128:131]
v_exp_f32 v88,v88
v_mfma_f32_16x16x32_bf16 v[132:135],a[140:143],v[28:31],v[132:135]
v_exp_f32 v89,v89
v_mfma_f32_16x16x32_bf16 a[180:183],a[140:143],v[32:35],a[180:183]
v_exp_f32 v90,v90
v_mfma_f32_16x16x32_bf16 a[176:179],a[136:139],v[32:35],a[176:179]
v_exp_f32 v91,v91
v_mfma_f32_16x16x32_bf16 a[184:187],a[144:147],v[32:35],a[184:187]
s_waitcnt lgkmcnt(1)
buffer_store_dwordx4 a[156:159],v9,s[16:19],s27 offen offset:128 nt
v_cvt_pk_bf16_f32 v52,v88,v89
v_cvt_pk_bf16_f32 v53,v90,v91
v_fma_f32 v86,v86,s36,v14
v_mfma_f32_16x16x32_bf16 a[188:191],a[148:151],v[32:35],a[188:191]
ds_read_b128 a[156:159],v10 offset:2048
v_fma_f32 v87,v87,s36,v14
v_mfma_f32_16x16x32_bf16 v[140:143],a[148:151],v[28:31],v[140:143]
v_exp_f32 v96,v96
v_mfma_f32_16x16x32_bf16 v[136:139],a[144:147],v[28:31],v[136:139]
v_exp_f32 v97,v97
v_mfma_f32_16x16x32_bf16 v[232:235],a[144:147],v[24:27],v[232:235]
v_exp_f32 v98,v98
v_mfma_f32_16x16x32_bf16 v[236:239],a[148:151],v[24:27],v[236:239]
v_exp_f32 v99,v99
v_mfma_f32_16x16x32_bf16 v[188:191],a[148:151],v[20:23],v[188:191]
v_cvt_pk_bf16_f32 v56,v96,v97
v_cvt_pk_bf16_f32 v57,v98,v99
v_mfma_f32_16x16x32_bf16 v[184:187],a[144:147],v[20:23],v[184:187]
v_exp_f32 v76,v76
v_mfma_f32_16x16x32_bf16 v[192:195],a[120:123],v[20:23],v[192:195]
v_exp_f32 v77,v77
v_mfma_f32_16x16x32_bf16 v[196:199],a[124:127],v[20:23],v[196:199]
s_waitcnt lgkmcnt(0)
buffer_store_dwordx4 a[156:159],v9,s[16:19],s27 offen offset:256 nt
v_exp_f32 v78,v78
v_cvt_pk_bf16_f32 v46,v76,v77
v_mfma_f32_16x16x32_bf16 v[244:247],a[124:127],v[24:27],v[244:247]
s_waitcnt vmcnt(9)
v_exp_f32 v79,v79
v_mfma_f32_16x16x32_bf16 v[240:243],a[120:123],v[24:27],v[240:243]
s_barrier
v_mfma_f32_16x16x32_bf16 v[144:147],a[120:123],v[28:31],v[144:147]
s_add_u32 s27,s27,3072
ds_read_b128 a[148:151],v1 offset:12416
v_cvt_pk_bf16_f32 v47,v78,v79
v_mfma_f32_16x16x32_bf16 v[148:151],a[124:127],v[28:31],v[148:151]
s_add_u32 m0,s23,24576
ds_read_b128 a[144:147],v0 offset:12416
v_fma_f32 v92,v92,s36,v15
v_mfma_f32_16x16x32_bf16 a[196:199],a[124:127],v[32:35],a[196:199]
buffer_load_dwordx4 v6,s[8:11],s21 offen offset:0 lds
v_mfma_f32_16x16x32_bf16 a[192:195],a[120:123],v[32:35],a[192:195]
ds_read_b128 a[124:127],v1 offset:12544
v_fma_f32 v93,v93,s36,v15
v_mfma_f32_16x16x32_bf16 a[200:203],a[128:131],v[32:35],a[200:203]
ds_read_b128 a[120:123],v0 offset:12544
v_fma_f32 v94,v94,s36,v15
v_mfma_f32_16x16x32_bf16 a[204:207],a[132:135],v[32:35],a[204:207]
ds_read_b128 a[140:143],v1 offset:12288
v_fma_f32 v95,v95,s36,v15
v_mfma_f32_16x16x32_bf16 v[156:159],a[132:135],v[28:31],v[156:159]
ds_read_b128 a[136:139],v0 offset:12288
v_fma_f32 v100,v100,s36,v16
v_mfma_f32_16x16x32_bf16 v[152:155],a[128:131],v[28:31],v[152:155]
v_exp_f32 v84,v84
v_mfma_f32_16x16x32_bf16 v[248:251],a[128:131],v[24:27],v[248:251]
v_exp_f32 v85,v85
v_mfma_f32_16x16x32_bf16 v[252:255],a[132:135],v[24:27],v[252:255]
buffer_load_dwordx4 v7,s[8:11],s21 offen offset:1024 lds
v_mfma_f32_16x16x32_bf16 v[204:207],a[132:135],v[20:23],v[204:207]
ds_read_b128 a[132:135],v1 offset:18432
v_cvt_pk_bf16_f32 v50,v84,v85
v_mfma_f32_16x16x32_bf16 v[200:203],a[128:131],v[20:23],v[200:203]
s_waitcnt lgkmcnt(3)
ds_read_b128 a[128:131],v0 offset:18432
v_fma_f32 v101,v101,s36,v16
v_mfma_f32_16x16x32_bf16 v[72:75],a[124:127],a[20:23],0
v_exp_f32 v86,v86
v_mfma_f32_16x16x32_bf16 v[72:75],a[120:123],a[16:19],v[72:75]
v_exp_f32 v87,v87
v_mfma_f32_16x16x32_bf16 v[72:75],a[148:151],a[12:15],v[72:75]
v_cvt_pk_bf16_f32 v51,v86,v87
v_fma_f32 v102,v102,s36,v16
v_mfma_f32_16x16x32_bf16 v[72:75],a[144:147],a[8:11],v[72:75]
v_exp_f32 v92,v92
v_smfmac_f32_16x16x64_bf16 v[60:63],a[152:155],v[44:51],v18
s_waitcnt lgkmcnt(2)
v_fma_f32 v103,v103,s36,v16
v_mfma_f32_16x16x32_bf16 v[72:75],a[140:143],a[4:7],v[72:75]
v_exp_f32 v93,v93
v_mfma_f32_16x16x32_bf16 v[72:75],a[136:139],a[0:3],v[72:75]
buffer_load_dwordx4 v8,s[8:11],s21 offen offset:2048 lds
v_mfma_f32_16x16x32_bf16 v[80:83],a[136:139],a[24:27],0
s_add_u32 s21,s21,12288
v_exp_f32 v94,v94
v_mfma_f32_16x16x32_bf16 v[80:83],a[140:143],a[28:31],v[80:83]
s_add_u32 m0,s22,0
v_exp_f32 v95,v95
v_mfma_f32_16x16x32_bf16 v[80:83],a[144:147],a[32:35],v[80:83]
v_cvt_pk_bf16_f32 v54,v92,v93
v_cvt_pk_bf16_f32 v55,v94,v95
v_mfma_f32_16x16x32_bf16 v[80:83],a[148:151],a[36:39],v[80:83]
v_exp_f32 v100,v100
v_mfma_f32_16x16x32_bf16 v[80:83],a[120:123],a[40:43],v[80:83]
v_exp_f32 v101,v101
v_mfma_f32_16x16x32_bf16 v[80:83],a[124:127],a[44:47],v[80:83]
v_exp_f32 v102,v102
v_mfma_f32_16x16x32_bf16 v[88:91],a[124:127],a[68:71],0
v_exp_f32 v103,v103
v_mfma_f32_16x16x32_bf16 v[88:91],a[120:123],a[64:67],v[88:91]
v_cvt_pk_bf16_f32 v58,v100,v101
v_cvt_pk_bf16_f32 v59,v102,v103
v_mfma_f32_16x16x32_bf16 v[88:91],a[148:151],a[60:63],v[88:91]
buffer_load_dwordx4 v6,s[4:7],s20 offen offset:0 lds
v_smfmac_f32_16x16x64_bf16 v[64:67],a[152:155],v[52:59],v18
v_fma_f32 v72,v72,s36,v13
v_mfma_f32_16x16x32_bf16 v[88:91],a[144:147],a[56:59],v[88:91]
v_fma_f32 v73,v73,s36,v13
v_fma_f32 v74,v74,s36,v13
v_mfma_f32_16x16x32_bf16 v[88:91],a[140:143],a[52:55],v[88:91]
v_fma_f32 v75,v75,s36,v13
v_fma_f32 v80,v80,s36,v14
v_mfma_f32_16x16x32_bf16 v[88:91],a[136:139],a[48:51],v[88:91]
v_fma_f32 v81,v81,s36,v14
v_mfma_f32_16x16x32_bf16 v[96:99],a[136:139],a[72:75],0
ds_read_b128 a[136:139],v0 offset:18560
v_mfma_f32_16x16x32_bf16 v[96:99],a[140:143],a[76:79],v[96:99]
ds_read_b128 a[140:143],v1 offset:18560
v_mfma_f32_16x16x32_bf16 v[96:99],a[144:147],a[80:83],v[96:99]
ds_read_b128 a[144:147],v0 offset:18688
v_mfma_f32_16x16x32_bf16 v[96:99],a[148:151],a[84:87],v[96:99]
ds_read_b128 a[148:151],v1 offset:18688
v_mfma_f32_16x16x32_bf16 v[96:99],a[120:123],a[88:91],v[96:99]
buffer_load_dwordx4 v7,s[4:7],s20 offen offset:1024 lds
v_mfma_f32_16x16x32_bf16 v[96:99],a[124:127],a[92:95],v[96:99]
s_waitcnt lgkmcnt(4)
v_exp_f32 v72,v72
v_mfma_f32_16x16x32_bf16 v[76:79],a[128:131],a[0:3],0
v_exp_f32 v73,v73
v_mfma_f32_16x16x32_bf16 v[76:79],a[132:135],a[4:7],v[76:79]
s_waitcnt lgkmcnt(3)
v_exp_f32 v74,v74
v_mfma_f32_16x16x32_bf16 v[76:79],a[136:139],a[8:11],v[76:79]
s_waitcnt lgkmcnt(2)
v_exp_f32 v75,v75
v_mfma_f32_16x16x32_bf16 v[76:79],a[140:143],a[12:15],v[76:79]
s_waitcnt lgkmcnt(0)
v_exp_f32 v80,v80
v_mfma_f32_16x16x32_bf16 v[76:79],a[144:147],a[16:19],v[76:79]
v_exp_f32 v81,v81
v_mfma_f32_16x16x32_bf16 v[76:79],a[148:151],a[20:23],v[76:79]
v_cvt_pk_bf16_f32 v20,v72,v73
v_cvt_pk_bf16_f32 v21,v74,v75
v_mfma_f32_16x16x32_bf16 v[84:87],a[148:151],a[44:47],0
v_cvt_pk_bf16_f32 v24,v80,v81
v_mfma_f32_16x16x32_bf16 v[84:87],a[144:147],a[40:43],v[84:87]
buffer_load_dwordx4 v8,s[4:7],s20 offen offset:2048 lds
v_mfma_f32_16x16x32_bf16 v[84:87],a[140:143],a[36:39],v[84:87]
s_add_u32 s20,s20,12288
v_mfma_f32_16x16x32_bf16 v[84:87],a[136:139],a[32:35],v[84:87]
ds_read_b64_tr_b16 a[120:121],v2 offset:0
v_mfma_f32_16x16x32_bf16 v[84:87],a[132:135],a[28:31],v[84:87]
ds_read_b64_tr_b16 a[122:123],v2 offset:6144
v_mfma_f32_16x16x32_bf16 v[84:87],a[128:131],a[24:27],v[84:87]
ds_read_b64_tr_b16 a[124:125],v3 offset:0
v_mfma_f32_16x16x32_bf16 v[92:95],a[128:131],a[48:51],0
ds_read_b64_tr_b16 a[126:127],v3 offset:6144
v_mfma_f32_16x16x32_bf16 v[92:95],a[132:135],a[52:55],v[92:95]
v_mfma_f32_16x16x32_bf16 v[92:95],a[136:139],a[56:59],v[92:95]
v_mfma_f32_16x16x32_bf16 v[92:95],a[140:143],a[60:63],v[92:95]
v_mfma_f32_16x16x32_bf16 v[92:95],a[144:147],a[64:67],v[92:95]
v_mfma_f32_16x16x32_bf16 v[92:95],a[148:151],a[68:71],v[92:95]
v_mfma_f32_16x16x32_bf16 v[100:103],a[148:151],a[92:95],0
v_mfma_f32_16x16x32_bf16 v[100:103],a[144:147],a[88:91],v[100:103]
v_mfma_f32_16x16x32_bf16 v[100:103],a[140:143],a[84:87],v[100:103]
v_mfma_f32_16x16x32_bf16 v[100:103],a[136:139],a[80:83],v[100:103]
v_mfma_f32_16x16x32_bf16 v[100:103],a[132:135],a[76:79],v[100:103]
ds_read_b64_tr_b16 a[132:133],v5 offset:0
v_mfma_f32_16x16x32_bf16 v[100:103],a[128:131],a[72:75],v[100:103]
s_waitcnt lgkmcnt(1)
ds_read_b64_tr_b16 a[128:129],v4 offset:0
ds_read_b64_tr_b16 a[130:131],v4 offset:6144
ds_read_b64_tr_b16 a[134:135],v5 offset:6144
v_mfma_f32_16x16x32_bf16 v[160:163],a[120:123],v[44:47],v[160:163]
s_add_u32 m0,s29,0
ds_read_b64_tr_b16 a[136:137],v2 offset:128
v_fma_f32 v82,v82,s36,v14
v_mfma_f32_16x16x32_bf16 v[164:167],a[124:127],v[44:47],v[164:167]
ds_read_b64_tr_b16 a[138:139],v2 offset:6272
v_fma_f32 v83,v83,s36,v14
v_mfma_f32_16x16x32_bf16 v[212:215],a[124:127],v[48:51],v[212:215]
ds_read_b64_tr_b16 a[140:141],v3 offset:128
v_fma_f32 v88,v88,s36,v15
v_mfma_f32_16x16x32_bf16 v[208:211],a[120:123],v[48:51],v[208:211]
ds_read_b64_tr_b16 a[142:143],v3 offset:6272
v_fma_f32 v89,v89,s36,v15
v_mfma_f32_16x16x32_bf16 v[112:115],a[120:123],v[52:55],v[112:115]
ds_read_b64_tr_b16 a[144:145],v4 offset:128
v_fma_f32 v90,v90,s36,v15
v_mfma_f32_16x16x32_bf16 v[116:119],a[124:127],v[52:55],v[116:119]
ds_read_b64_tr_b16 a[146:147],v4 offset:6272
v_fma_f32 v91,v91,s36,v15
v_mfma_f32_16x16x32_bf16 a[164:167],a[124:127],v[56:59],a[164:167]
buffer_load_dwordx4 v6,s[12:15],s28 offen offset:0 nt lds
v_mfma_f32_16x16x32_bf16 a[160:163],a[120:123],v[56:59],a[160:163]
s_waitcnt lgkmcnt(5)
ds_read_b64_tr_b16 a[148:149],v5 offset:128
v_fma_f32 v96,v96,s36,v16
v_mfma_f32_16x16x32_bf16 a[168:171],a[128:131],v[56:59],a[168:171]
ds_read_b64_tr_b16 a[150:151],v5 offset:6272
v_fma_f32 v97,v97,s36,v16
v_mfma_f32_16x16x32_bf16 a[172:175],a[132:135],v[56:59],a[172:175]
ds_read_b64_tr_b16 a[120:121],v2 offset:256
v_fma_f32 v98,v98,s36,v16
v_mfma_f32_16x16x32_bf16 v[124:127],a[132:135],v[52:55],v[124:127]
ds_read_b64_tr_b16 a[122:123],v2 offset:6400
v_fma_f32 v99,v99,s36,v16
v_mfma_f32_16x16x32_bf16 v[120:123],a[128:131],v[52:55],v[120:123]
ds_read_b64_tr_b16 a[124:125],v3 offset:256
v_fma_f32 v76,v76,s36,v13
v_mfma_f32_16x16x32_bf16 v[216:219],a[128:131],v[48:51],v[216:219]
ds_read_b64_tr_b16 a[126:127],v3 offset:6400
v_fma_f32 v77,v77,s36,v13
v_mfma_f32_16x16x32_bf16 v[220:223],a[132:135],v[48:51],v[220:223]
buffer_load_dwordx4 v7,s[12:15],s28 offen offset:1024 nt lds
v_mfma_f32_16x16x32_bf16 v[172:175],a[132:135],v[44:47],v[172:175]
ds_read_b64_tr_b16 a[132:133],v5 offset:256
v_fma_f32 v78,v78,s36,v13
v_mfma_f32_16x16x32_bf16 v[168:171],a[128:131],v[44:47],v[168:171]
s_waitcnt lgkmcnt(5)
ds_read_b64_tr_b16 a[128:129],v4 offset:256
v_fma_f32 v79,v79,s36,v13
v_mfma_f32_16x16x32_bf16 v[176:179],a[136:139],v[44:47],v[176:179]
ds_read_b64_tr_b16 a[130:131],v4 offset:6400
v_fma_f32 v84,v84,s36,v14
v_mfma_f32_16x16x32_bf16 v[180:183],a[140:143],v[44:47],v[180:183]
ds_read_b64_tr_b16 a[134:135],v5 offset:6400
v_fma_f32 v85,v85,s36,v14
v_mfma_f32_16x16x32_bf16 v[228:231],a[140:143],v[48:51],v[228:231]
v_exp_f32 v82,v82
v_mfma_f32_16x16x32_bf16 v[224:227],a[136:139],v[48:51],v[224:227]
v_exp_f32 v83,v83
v_mfma_f32_16x16x32_bf16 v[128:131],a[136:139],v[52:55],v[128:131]
v_cvt_pk_bf16_f32 v25,v82,v83
v_fma_f32 v86,v86,s36,v14
v_mfma_f32_16x16x32_bf16 v[132:135],a[140:143],v[52:55],v[132:135]
buffer_load_dwordx4 v8,s[12:15],s28 offen offset:2048 nt lds
v_mfma_f32_16x16x32_bf16 a[180:183],a[140:143],v[56:59],a[180:183]
s_add_u32 s28,s28,3072
v_exp_f32 v88,v88
v_mfma_f32_16x16x32_bf16 a[176:179],a[136:139],v[56:59],a[176:179]
s_add_u32 s29,s29,3072
v_exp_f32 v89,v89
v_mfma_f32_16x16x32_bf16 a[184:187],a[144:147],v[56:59],a[184:187]
s_add_u32 m0,s23,0
v_exp_f32 v90,v90
v_mfma_f32_16x16x32_bf16 a[188:191],a[148:151],v[56:59],a[188:191]
v_exp_f32 v91,v91
v_mfma_f32_16x16x32_bf16 v[140:143],a[148:151],v[52:55],v[140:143]
v_cvt_pk_bf16_f32 v28,v88,v89
v_cvt_pk_bf16_f32 v29,v90,v91
v_mfma_f32_16x16x32_bf16 v[136:139],a[144:147],v[52:55],v[136:139]
v_exp_f32 v96,v96
v_mfma_f32_16x16x32_bf16 v[232:235],a[144:147],v[48:51],v[232:235]
v_exp_f32 v97,v97
v_mfma_f32_16x16x32_bf16 v[236:239],a[148:151],v[48:51],v[236:239]
v_exp_f32 v98,v98
v_mfma_f32_16x16x32_bf16 v[188:191],a[148:151],v[44:47],v[188:191]
v_exp_f32 v99,v99
v_mfma_f32_16x16x32_bf16 v[184:187],a[144:147],v[44:47],v[184:187]
s_waitcnt vmcnt(12)
v_cvt_pk_bf16_f32 v32,v96,v97
v_cvt_pk_bf16_f32 v33,v98,v99
s_waitcnt lgkmcnt(0)
v_mfma_f32_16x16x32_bf16 v[192:195],a[120:123],v[44:47],v[192:195]
s_barrier
v_mfma_f32_16x16x32_bf16 v[196:199],a[124:127],v[44:47],v[196:199]
ds_read_b128 a[148:151],v1 offset:24704
v_fma_f32 v87,v87,s36,v14
v_mfma_f32_16x16x32_bf16 v[244:247],a[124:127],v[48:51],v[244:247]
ds_read_b128 a[144:147],v0 offset:24704
v_fma_f32 v92,v92,s36,v15
v_mfma_f32_16x16x32_bf16 v[240:243],a[120:123],v[48:51],v[240:243]
ds_read_b128 a[140:143],v1 offset:24576
v_fma_f32 v93,v93,s36,v15
v_mfma_f32_16x16x32_bf16 v[144:147],a[120:123],v[52:55],v[144:147]
ds_read_b128 a[136:139],v0 offset:24576
v_fma_f32 v94,v94,s36,v15
v_mfma_f32_16x16x32_bf16 v[148:151],a[124:127],v[52:55],v[148:151]
v_exp_f32 v76,v76
v_mfma_f32_16x16x32_bf16 a[196:199],a[124:127],v[56:59],a[196:199]
buffer_load_dwordx4 v6,s[8:11],s21 offen offset:0 lds
v_mfma_f32_16x16x32_bf16 a[192:195],a[120:123],v[56:59],a[192:195]
ds_read_b128 a[124:127],v1 offset:24832
v_fma_f32 v95,v95,s36,v15
v_mfma_f32_16x16x32_bf16 a[200:203],a[128:131],v[56:59],a[200:203]
ds_read_b128 a[120:123],v0 offset:24832
v_fma_f32 v100,v100,s36,v16
v_mfma_f32_16x16x32_bf16 a[204:207],a[132:135],v[56:59],a[204:207]
v_exp_f32 v77,v77
v_mfma_f32_16x16x32_bf16 v[156:159],a[132:135],v[52:55],v[156:159]
v_exp_f32 v78,v78
v_mfma_f32_16x16x32_bf16 v[152:155],a[128:131],v[52:55],v[152:155]
v_exp_f32 v79,v79
v_mfma_f32_16x16x32_bf16 v[248:251],a[128:131],v[48:51],v[248:251]
v_cvt_pk_bf16_f32 v22,v76,v77
v_cvt_pk_bf16_f32 v23,v78,v79
v_mfma_f32_16x16x32_bf16 v[252:255],a[132:135],v[48:51],v[252:255]
v_exp_f32 v84,v84
v_mfma_f32_16x16x32_bf16 v[204:207],a[132:135],v[44:47],v[204:207]
ds_read_b128 a[132:135],v1 offset:30720
v_fma_f32 v101,v101,s36,v16
v_mfma_f32_16x16x32_bf16 v[200:203],a[128:131],v[44:47],v[200:203]
buffer_load_dwordx4 v7,s[8:11],s21 offen offset:1024 lds
s_waitcnt lgkmcnt(1)
v_mfma_f32_16x16x32_bf16 v[72:75],a[124:127],a[20:23],0
ds_read_b128 a[128:131],v0 offset:30720
v_fma_f32 v102,v102,s36,v16
v_mfma_f32_16x16x32_bf16 v[72:75],a[120:123],a[16:19],v[72:75]
v_exp_f32 v85,v85
v_mfma_f32_16x16x32_bf16 v[72:75],a[148:151],a[12:15],v[72:75]
v_exp_f32 v86,v86
v_mfma_f32_16x16x32_bf16 v[72:75],a[144:147],a[8:11],v[72:75]
v_exp_f32 v87,v87
v_mfma_f32_16x16x32_bf16 v[72:75],a[140:143],a[4:7],v[72:75]
v_cvt_pk_bf16_f32 v26,v84,v85
v_cvt_pk_bf16_f32 v27,v86,v87
v_mfma_f32_16x16x32_bf16 v[72:75],a[136:139],a[0:3],v[72:75]
v_exp_f32 v92,v92
v_smfmac_f32_16x16x64_bf16 v[60:63],a[152:155],v[20:27],v18
v_fma_f32 v103,v103,s36,v16
v_mfma_f32_16x16x32_bf16 v[80:83],a[136:139],a[24:27],0
v_exp_f32 v93,v93
v_mfma_f32_16x16x32_bf16 v[80:83],a[140:143],a[28:31],v[80:83]
buffer_load_dwordx4 v8,s[8:11],s21 offen offset:2048 lds
v_mfma_f32_16x16x32_bf16 v[80:83],a[144:147],a[32:35],v[80:83]
s_add_u32 s21,s21,12288
v_exp_f32 v94,v94
v_mfma_f32_16x16x32_bf16 v[80:83],a[148:151],a[36:39],v[80:83]
s_add_u32 m0,s22,12288
v_exp_f32 v95,v95
v_mfma_f32_16x16x32_bf16 v[80:83],a[120:123],a[40:43],v[80:83]
v_cvt_pk_bf16_f32 v30,v92,v93
v_cvt_pk_bf16_f32 v31,v94,v95
v_mfma_f32_16x16x32_bf16 v[80:83],a[124:127],a[44:47],v[80:83]
v_exp_f32 v100,v100
v_mfma_f32_16x16x32_bf16 v[88:91],a[124:127],a[68:71],0
v_exp_f32 v101,v101
v_mfma_f32_16x16x32_bf16 v[88:91],a[120:123],a[64:67],v[88:91]
v_exp_f32 v102,v102
v_mfma_f32_16x16x32_bf16 v[88:91],a[148:151],a[60:63],v[88:91]
v_exp_f32 v103,v103
v_mfma_f32_16x16x32_bf16 v[88:91],a[144:147],a[56:59],v[88:91]
v_cvt_pk_bf16_f32 v34,v100,v101
v_cvt_pk_bf16_f32 v35,v102,v103
v_mfma_f32_16x16x32_bf16 v[88:91],a[140:143],a[52:55],v[88:91]
buffer_load_dwordx4 v6,s[4:7],s20 offen offset:0 lds
v_smfmac_f32_16x16x64_bf16 v[64:67],a[152:155],v[28:35],v18
v_fma_f32 v72,v72,s36,v13
v_mfma_f32_16x16x32_bf16 v[88:91],a[136:139],a[48:51],v[88:91]
v_fma_f32 v73,v73,s36,v13
v_fma_f32 v74,v74,s36,v13
v_mfma_f32_16x16x32_bf16 v[96:99],a[136:139],a[72:75],0
ds_read_b128 a[136:139],v0 offset:30848
v_fma_f32 v75,v75,s36,v13
v_mfma_f32_16x16x32_bf16 v[96:99],a[140:143],a[76:79],v[96:99]
ds_read_b128 a[140:143],v1 offset:30848
v_fma_f32 v80,v80,s36,v14
v_mfma_f32_16x16x32_bf16 v[96:99],a[144:147],a[80:83],v[96:99]
ds_read_b128 a[144:147],v0 offset:30976
v_fma_f32 v81,v81,s36,v14
v_mfma_f32_16x16x32_bf16 v[96:99],a[148:151],a[84:87],v[96:99]
ds_read_b128 a[148:151],v1 offset:30976
v_mfma_f32_16x16x32_bf16 v[96:99],a[120:123],a[88:91],v[96:99]
v_exp_f32 v72,v72
v_mfma_f32_16x16x32_bf16 v[96:99],a[124:127],a[92:95],v[96:99]
s_waitcnt lgkmcnt(4)
v_exp_f32 v73,v73
v_mfma_f32_16x16x32_bf16 v[76:79],a[128:131],a[0:3],0
buffer_load_dwordx4 v7,s[4:7],s20 offen offset:1024 lds
v_mfma_f32_16x16x32_bf16 v[76:79],a[132:135],a[4:7],v[76:79]
s_waitcnt lgkmcnt(3)
v_exp_f32 v74,v74
v_mfma_f32_16x16x32_bf16 v[76:79],a[136:139],a[8:11],v[76:79]
s_waitcnt lgkmcnt(2)
v_exp_f32 v75,v75
v_mfma_f32_16x16x32_bf16 v[76:79],a[140:143],a[12:15],v[76:79]
s_waitcnt lgkmcnt(0)
v_exp_f32 v80,v80
v_mfma_f32_16x16x32_bf16 v[76:79],a[144:147],a[16:19],v[76:79]
v_exp_f32 v81,v81
v_mfma_f32_16x16x32_bf16 v[76:79],a[148:151],a[20:23],v[76:79]
v_cvt_pk_bf16_f32 v44,v72,v73
v_cvt_pk_bf16_f32 v45,v74,v75
v_mfma_f32_16x16x32_bf16 v[84:87],a[148:151],a[44:47],0
v_cvt_pk_bf16_f32 v48,v80,v81
v_mfma_f32_16x16x32_bf16 v[84:87],a[144:147],a[40:43],v[84:87]
v_mfma_f32_16x16x32_bf16 v[84:87],a[140:143],a[36:39],v[84:87]
v_mfma_f32_16x16x32_bf16 v[84:87],a[136:139],a[32:35],v[84:87]
buffer_load_dwordx4 v8,s[4:7],s20 offen offset:2048 lds
v_mfma_f32_16x16x32_bf16 v[84:87],a[132:135],a[28:31],v[84:87]
s_add_u32 s20,s20,12288
v_mfma_f32_16x16x32_bf16 v[84:87],a[128:131],a[24:27],v[84:87]
ds_read_b64_tr_b16 a[120:121],v2 offset:12288
v_mfma_f32_16x16x32_bf16 v[92:95],a[128:131],a[48:51],0
ds_read_b64_tr_b16 a[122:123],v2 offset:18432
v_mfma_f32_16x16x32_bf16 v[92:95],a[132:135],a[52:55],v[92:95]
ds_read_b64_tr_b16 a[124:125],v3 offset:12288
v_mfma_f32_16x16x32_bf16 v[92:95],a[136:139],a[56:59],v[92:95]
ds_read_b64_tr_b16 a[126:127],v3 offset:18432
v_mfma_f32_16x16x32_bf16 v[92:95],a[140:143],a[60:63],v[92:95]
v_mfma_f32_16x16x32_bf16 v[92:95],a[144:147],a[64:67],v[92:95]
v_mfma_f32_16x16x32_bf16 v[92:95],a[148:151],a[68:71],v[92:95]
v_mfma_f32_16x16x32_bf16 v[100:103],a[148:151],a[92:95],0
v_mfma_f32_16x16x32_bf16 v[100:103],a[144:147],a[88:91],v[100:103]
v_mfma_f32_16x16x32_bf16 v[100:103],a[140:143],a[84:87],v[100:103]
v_mfma_f32_16x16x32_bf16 v[100:103],a[136:139],a[80:83],v[100:103]
v_mfma_f32_16x16x32_bf16 v[100:103],a[132:135],a[76:79],v[100:103]
ds_read_b64_tr_b16 a[132:133],v5 offset:12288
v_mfma_f32_16x16x32_bf16 v[100:103],a[128:131],a[72:75],v[100:103]
s_waitcnt lgkmcnt(1)
ds_read_b64_tr_b16 a[128:129],v4 offset:12288
ds_read_b64_tr_b16 a[130:131],v4 offset:18432
ds_read_b64_tr_b16 a[134:135],v5 offset:18432
v_mfma_f32_16x16x32_bf16 v[160:163],a[120:123],v[20:23],v[160:163]
ds_read_b128 a[156:159],v10 offset:3072
v_mbcnt_lo_u32_b32 v19,-1,0
v_mfma_f32_16x16x32_bf16 v[164:167],a[124:127],v[20:23],v[164:167]
ds_read_b64_tr_b16 a[136:137],v2 offset:12416
v_mbcnt_hi_u32_b32 v19,-1,v19
v_mfma_f32_16x16x32_bf16 v[212:215],a[124:127],v[24:27],v[212:215]
ds_read_b64_tr_b16 a[138:139],v2 offset:18560
v_min_u32 v19,7,v19
v_mfma_f32_16x16x32_bf16 v[208:211],a[120:123],v[24:27],v[208:211]
ds_read_b64_tr_b16 a[140:141],v3 offset:12416
v_lshl_add_u32 v19,v19,7,s48
v_mfma_f32_16x16x32_bf16 v[112:115],a[120:123],v[28:31],v[112:115]
ds_read_b64_tr_b16 a[142:143],v3 offset:18560
v_min_u32 v19,L_codeend-L_first-4,v19
v_mfma_f32_16x16x32_bf16 v[116:119],a[124:127],v[28:31],v[116:119]
ds_read_b64_tr_b16 a[150:151],v5 offset:18560
v_fma_f32 v82,v82,s36,v14
v_mfma_f32_16x16x32_bf16 a[164:167],a[124:127],v[32:35],a[164:167]
ds_read_b64_tr_b16 a[144:145],v4 offset:12416
v_fma_f32 v83,v83,s36,v14
v_mfma_f32_16x16x32_bf16 a[160:163],a[120:123],v[32:35],a[160:163]
s_waitcnt lgkmcnt(6)
ds_read_b64_tr_b16 a[146:147],v4 offset:18560
v_fma_f32 v91,v91,s36,v15
v_mfma_f32_16x16x32_bf16 a[168:171],a[128:131],v[32:35],a[168:171]
ds_read_b64_tr_b16 a[148:149],v5 offset:12416
v_fma_f32 v90,v90,s36,v15
v_mfma_f32_16x16x32_bf16 a[172:175],a[132:135],v[32:35],a[172:175]
ds_read_b64_tr_b16 a[122:123],v2 offset:18688
v_fma_f32 v89,v89,s36,v15
v_mfma_f32_16x16x32_bf16 v[124:127],a[132:135],v[28:31],v[124:127]
ds_read_b64_tr_b16 a[120:121],v2 offset:12544
v_fma_f32 v88,v88,s36,v15
v_mfma_f32_16x16x32_bf16 v[120:123],a[128:131],v[28:31],v[120:123]
ds_read_b64_tr_b16 a[126:127],v3 offset:18688
v_fma_f32 v97,v97,s36,v16
v_mfma_f32_16x16x32_bf16 v[216:219],a[128:131],v[24:27],v[216:219]
ds_read_b64_tr_b16 a[124:125],v3 offset:12544
v_fma_f32 v98,v98,s36,v16
v_mfma_f32_16x16x32_bf16 v[220:223],a[132:135],v[24:27],v[220:223]
v_exp_f32 v82,v82
v_mfma_f32_16x16x32_bf16 v[172:175],a[132:135],v[20:23],v[172:175]
ds_read_b64_tr_b16 a[134:135],v5 offset:18688
v_fma_f32 v96,v96,s36,v16
v_mfma_f32_16x16x32_bf16 v[168:171],a[128:131],v[20:23],v[168:171]
global_load_dword v19,v19,s[46:47]
s_waitcnt lgkmcnt(5)
v_mfma_f32_16x16x32_bf16 v[176:179],a[136:139],v[20:23],v[176:179]
buffer_store_dwordx4 a[156:159],v9,s[16:19],s27 offen offset:0 nt
ds_read_b64_tr_b16 a[132:133],v5 offset:12544
ds_read_b128 a[156:159],v10 offset:4096
v_mfma_f32_16x16x32_bf16 v[180:183],a[140:143],v[20:23],v[180:183]
ds_read_b64_tr_b16 a[130:131],v4 offset:18688
v_mfma_f32_16x16x32_bf16 v[228:231],a[140:143],v[24:27],v[228:231]
ds_read_b64_tr_b16 a[128:129],v4 offset:12544
v_fma_f32 v99,v99,s36,v16
v_mfma_f32_16x16x32_bf16 v[224:227],a[136:139],v[24:27],v[224:227]
v_exp_f32 v83,v83
v_mfma_f32_16x16x32_bf16 v[128:131],a[136:139],v[28:31],v[128:131]
v_cvt_pk_bf16_f32 v49,v82,v83
v_fma_f32 v78,v78,s36,v13
v_mfma_f32_16x16x32_bf16 v[132:135],a[140:143],v[28:31],v[132:135]
v_exp_f32 v91,v91
v_mfma_f32_16x16x32_bf16 a[180:183],a[140:143],v[32:35],a[180:183]
v_exp_f32 v88,v88
v_mfma_f32_16x16x32_bf16 a[176:179],a[136:139],v[32:35],a[176:179]
v_exp_f32 v89,v89
v_mfma_f32_16x16x32_bf16 a[184:187],a[144:147],v[32:35],a[184:187]
s_waitcnt lgkmcnt(2)
buffer_store_dwordx4 a[156:159],v9,s[16:19],s27 offen offset:128 nt
v_exp_f32 v90,v90
v_cvt_pk_bf16_f32 v52,v88,v89
v_mfma_f32_16x16x32_bf16 a[188:191],a[148:151],v[32:35],a[188:191]
ds_read_b128 a[156:159],v10 offset:5120
v_cvt_pk_bf16_f32 v53,v90,v91
v_mfma_f32_16x16x32_bf16 v[140:143],a[148:151],v[28:31],v[140:143]
v_exp_f32 v98,v98
v_mfma_f32_16x16x32_bf16 v[136:139],a[144:147],v[28:31],v[136:139]
v_exp_f32 v97,v97
v_mfma_f32_16x16x32_bf16 v[232:235],a[144:147],v[24:27],v[232:235]
v_exp_f32 v99,v99
v_mfma_f32_16x16x32_bf16 v[236:239],a[148:151],v[24:27],v[236:239]
v_exp_f32 v96,v96
v_mfma_f32_16x16x32_bf16 v[188:191],a[148:151],v[20:23],v[188:191]
v_cvt_pk_bf16_f32 v56,v96,v97
v_cvt_pk_bf16_f32 v57,v98,v99
v_mfma_f32_16x16x32_bf16 v[184:187],a[144:147],v[20:23],v[184:187]
v_exp_f32 v78,v78
v_mfma_f32_16x16x32_bf16 v[192:195],a[120:123],v[20:23],v[192:195]
v_fma_f32 v76,v76,s36,v13
v_fma_f32 v79,v79,s36,v13
v_mfma_f32_16x16x32_bf16 v[196:199],a[124:127],v[20:23],v[196:199]
s_waitcnt lgkmcnt(0)
buffer_store_dwordx4 a[156:159],v9,s[16:19],s27 offen offset:256 nt
v_exp_f32 v76,v76
v_fma_f32 v77,v77,s36,v13
v_mfma_f32_16x16x32_bf16 v[244:247],a[124:127],v[24:27],v[244:247]
s_waitcnt vmcnt(13)
v_exp_f32 v79,v79
v_mfma_f32_16x16x32_bf16 v[240:243],a[120:123],v[24:27],v[240:243]
s_barrier
v_mfma_f32_16x16x32_bf16 v[144:147],a[120:123],v[28:31],v[144:147]
s_add_u32 s27,s27,3072
ds_read_b128 a[148:151],v1 offset:128
v_cvt_pk_bf16_f32 v47,v78,v79
v_mfma_f32_16x16x32_bf16 v[148:151],a[124:127],v[28:31],v[148:151]
s_add_u32 m0,s23,12288
ds_read_b128 a[144:147],v0 offset:128
v_fma_f32 v87,v87,s36,v14
v_mfma_f32_16x16x32_bf16 a[196:199],a[124:127],v[32:35],a[196:199]
buffer_load_dwordx4 v6,s[8:11],s21 offen offset:0 lds
v_mfma_f32_16x16x32_bf16 a[192:195],a[120:123],v[32:35],a[192:195]
ds_read_b128 a[124:127],v1 offset:256
v_fma_f32 v86,v86,s36,v14
v_mfma_f32_16x16x32_bf16 a[200:203],a[128:131],v[32:35],a[200:203]
ds_read_b128 a[120:123],v0 offset:256
v_fma_f32 v84,v84,s36,v14
v_mfma_f32_16x16x32_bf16 a[204:207],a[132:135],v[32:35],a[204:207]
ds_read_b128 a[140:143],v1 offset:0
v_fma_f32 v85,v85,s36,v14
v_mfma_f32_16x16x32_bf16 v[156:159],a[132:135],v[28:31],v[156:159]
ds_read_b128 a[136:139],v0 offset:0
v_fma_f32 v95,v95,s36,v15
v_mfma_f32_16x16x32_bf16 v[152:155],a[128:131],v[28:31],v[152:155]
v_exp_f32 v77,v77
v_mfma_f32_16x16x32_bf16 v[248:251],a[128:131],v[24:27],v[248:251]
v_cvt_pk_bf16_f32 v46,v76,v77
v_fma_f32 v92,v92,s36,v15
v_mfma_f32_16x16x32_bf16 v[252:255],a[132:135],v[24:27],v[252:255]
buffer_load_dwordx4 v7,s[8:11],s21 offen offset:1024 lds
v_mfma_f32_16x16x32_bf16 v[204:207],a[132:135],v[20:23],v[204:207]
ds_read_b128 a[132:135],v1 offset:6144
v_fma_f32 v94,v94,s36,v15
v_mfma_f32_16x16x32_bf16 v[200:203],a[128:131],v[20:23],v[200:203]
s_waitcnt lgkmcnt(3)
ds_read_b128 a[128:131],v0 offset:6144
v_fma_f32 v93,v93,s36,v15
v_mfma_f32_16x16x32_bf16 v[72:75],a[124:127],a[20:23],0
v_exp_f32 v84,v84
v_mfma_f32_16x16x32_bf16 v[72:75],a[120:123],a[16:19],v[72:75]
v_exp_f32 v87,v87
v_mfma_f32_16x16x32_bf16 v[72:75],a[148:151],a[12:15],v[72:75]
v_exp_f32 v85,v85
v_mfma_f32_16x16x32_bf16 v[72:75],a[144:147],a[8:11],v[72:75]
s_waitcnt lgkmcnt(2)
v_cvt_pk_bf16_f32 v50,v84,v85
v_fma_f32 v100,v100,s36,v16
v_mfma_f32_16x16x32_bf16 v[72:75],a[140:143],a[4:7],v[72:75]
v_exp_f32 v86,v86
v_mfma_f32_16x16x32_bf16 v[72:75],a[136:139],a[0:3],v[72:75]
v_cvt_pk_bf16_f32 v51,v86,v87
v_fma_f32 v102,v102,s36,v16
v_mfma_f32_16x16x32_bf16 v[80:83],a[136:139],a[24:27],0
buffer_load_dwordx4 v8,s[8:11],s21 offen offset:2048 lds
v_smfmac_f32_16x16x64_bf16 v[60:63],a[152:155],v[44:51],v18
s_add_u32 s21,s21,12288
v_fma_f32 v101,v101,s36,v16
v_mfma_f32_16x16x32_bf16 v[80:83],a[140:143],a[28:31],v[80:83]
s_add_u32 m0,s22,24576
v_exp_f32 v94,v94
v_mfma_f32_16x16x32_bf16 v[80:83],a[144:147],a[32:35],v[80:83]
v_exp_f32 v92,v92
v_mfma_f32_16x16x32_bf16 v[80:83],a[148:151],a[36:39],v[80:83]
v_exp_f32 v93,v93
v_mfma_f32_16x16x32_bf16 v[80:83],a[120:123],a[40:43],v[80:83]
v_cvt_pk_bf16_f32 v54,v92,v93
v_fma_f32 v103,v103,s36,v16
v_mfma_f32_16x16x32_bf16 v[80:83],a[124:127],a[44:47],v[80:83]
v_exp_f32 v95,v95
v_mfma_f32_16x16x32_bf16 v[88:91],a[124:127],a[68:71],0
v_cvt_pk_bf16_f32 v55,v94,v95
v_fma_f32 v73,v73,s36,v13
v_mfma_f32_16x16x32_bf16 v[88:91],a[120:123],a[64:67],v[88:91]
v_exp_f32 v102,v102
v_mfma_f32_16x16x32_bf16 v[88:91],a[148:151],a[60:63],v[88:91]
buffer_load_dwordx4 v6,s[4:7],s20 offen offset:0 lds
v_mfma_f32_16x16x32_bf16 v[88:91],a[144:147],a[56:59],v[88:91]
v_exp_f32 v103,v103
v_mfma_f32_16x16x32_bf16 v[88:91],a[140:143],a[52:55],v[88:91]
v_exp_f32 v100,v100
v_mfma_f32_16x16x32_bf16 v[88:91],a[136:139],a[48:51],v[88:91]
v_exp_f32 v101,v101
v_mfma_f32_16x16x32_bf16 v[96:99],a[136:139],a[72:75],0
ds_read_b128 a[136:139],v0 offset:6272
v_cvt_pk_bf16_f32 v59,v102,v103
v_mfma_f32_16x16x32_bf16 v[96:99],a[140:143],a[76:79],v[96:99]
ds_read_b128 a[140:143],v1 offset:6272
v_cvt_pk_bf16_f32 v58,v100,v101
v_mfma_f32_16x16x32_bf16 v[96:99],a[144:147],a[80:83],v[96:99]
ds_read_b128 a[144:147],v0 offset:6400
v_fma_f32 v81,v81,s36,v14
v_smfmac_f32_16x16x64_bf16 v[64:67],a[152:155],v[52:59],v18
v_fma_f32 v74,v74,s36,v13
v_mfma_f32_16x16x32_bf16 v[96:99],a[148:151],a[84:87],v[96:99]
ds_read_b128 a[148:151],v1 offset:6400
v_fma_f32 v72,v72,s36,v13
v_mfma_f32_16x16x32_bf16 v[96:99],a[120:123],a[88:91],v[96:99]
buffer_load_dwordx4 v7,s[4:7],s20 offen offset:1024 lds
v_mfma_f32_16x16x32_bf16 v[96:99],a[124:127],a[92:95],v[96:99]
s_waitcnt lgkmcnt(4)
v_exp_f32 v72,v72
v_mfma_f32_16x16x32_bf16 v[76:79],a[128:131],a[0:3],0
v_fma_f32 v75,v75,s36,v13
v_fma_f32 v80,v80,s36,v14
v_mfma_f32_16x16x32_bf16 v[76:79],a[132:135],a[4:7],v[76:79]
s_waitcnt lgkmcnt(2)
v_exp_f32 v73,v73
v_mfma_f32_16x16x32_bf16 v[76:79],a[136:139],a[8:11],v[76:79]
v_exp_f32 v80,v80
v_mfma_f32_16x16x32_bf16 v[76:79],a[140:143],a[12:15],v[76:79]
s_waitcnt lgkmcnt(1)
v_cvt_pk_bf16_f32 v20,v72,v73
v_mfma_f32_16x16x32_bf16 v[76:79],a[144:147],a[16:19],v[76:79]
s_waitcnt lgkmcnt(0)
v_exp_f32 v75,v75
v_mfma_f32_16x16x32_bf16 v[76:79],a[148:151],a[20:23],v[76:79]
v_exp_f32 v81,v81
v_mfma_f32_16x16x32_bf16 v[84:87],a[148:151],a[44:47],0
v_cvt_pk_bf16_f32 v24,v80,v81
v_mfma_f32_16x16x32_bf16 v[84:87],a[144:147],a[40:43],v[84:87]
buffer_load_dwordx4 v8,s[4:7],s20 offen offset:2048 lds
v_mfma_f32_16x16x32_bf16 v[84:87],a[140:143],a[36:39],v[84:87]
s_add_u32 s20,s20,12288
v_exp_f32 v74,v74
v_mfma_f32_16x16x32_bf16 v[84:87],a[136:139],a[32:35],v[84:87]
ds_read_b64_tr_b16 a[122:123],v2 offset:30720
v_mfma_f32_16x16x32_bf16 v[84:87],a[132:135],a[28:31],v[84:87]
ds_read_b64_tr_b16 a[120:121],v2 offset:24576
v_cvt_pk_bf16_f32 v21,v74,v75
v_mfma_f32_16x16x32_bf16 v[84:87],a[128:131],a[24:27],v[84:87]
ds_read_b64_tr_b16 a[124:125],v3 offset:24576
v_mfma_f32_16x16x32_bf16 v[92:95],a[128:131],a[48:51],0
ds_read_b64_tr_b16 a[126:127],v3 offset:30720
v_mfma_f32_16x16x32_bf16 v[92:95],a[132:135],a[52:55],v[92:95]
v_mfma_f32_16x16x32_bf16 v[92:95],a[136:139],a[56:59],v[92:95]
v_mfma_f32_16x16x32_bf16 v[92:95],a[140:143],a[60:63],v[92:95]
v_mfma_f32_16x16x32_bf16 v[92:95],a[144:147],a[64:67],v[92:95]
v_mfma_f32_16x16x32_bf16 v[92:95],a[148:151],a[68:71],v[92:95]
v_mfma_f32_16x16x32_bf16 v[100:103],a[148:151],a[92:95],0
v_mfma_f32_16x16x32_bf16 v[100:103],a[144:147],a[88:91],v[100:103]
v_mfma_f32_16x16x32_bf16 v[100:103],a[140:143],a[84:87],v[100:103]
v_mfma_f32_16x16x32_bf16 v[100:103],a[136:139],a[80:83],v[100:103]
v_mfma_f32_16x16x32_bf16 v[100:103],a[132:135],a[76:79],v[100:103]
ds_read_b64_tr_b16 a[132:133],v5 offset:24576
v_mfma_f32_16x16x32_bf16 v[100:103],a[128:131],a[72:75],v[100:103]
s_waitcnt lgkmcnt(1)
ds_read_b64_tr_b16 a[128:129],v4 offset:24576
ds_read_b64_tr_b16 a[130:131],v4 offset:30720
ds_read_b64_tr_b16 a[134:135],v5 offset:30720
v_mfma_f32_16x16x32_bf16 v[160:163],a[120:123],v[44:47],v[160:163]
s_add_u32 m0,s29,0
ds_read_b64_tr_b16 a[136:137],v2 offset:24704
v_fma_f32 v82,v82,s36,v14
v_mfma_f32_16x16x32_bf16 v[164:167],a[124:127],v[44:47],v[164:167]
ds_read_b64_tr_b16 a[138:139],v2 offset:30848
v_fma_f32 v83,v83,s36,v14
v_mfma_f32_16x16x32_bf16 v[212:215],a[124:127],v[48:51],v[212:215]
ds_read_b64_tr_b16 a[140:141],v3 offset:24704
v_fma_f32 v88,v88,s36,v15
v_mfma_f32_16x16x32_bf16 v[208:211],a[120:123],v[48:51],v[208:211]
ds_read_b64_tr_b16 a[142:143],v3 offset:30848
v_fma_f32 v89,v89,s36,v15
v_mfma_f32_16x16x32_bf16 v[112:115],a[120:123],v[52:55],v[112:115]
ds_read_b64_tr_b16 a[144:145],v4 offset:24704
v_fma_f32 v90,v90,s36,v15
v_mfma_f32_16x16x32_bf16 v[116:119],a[124:127],v[52:55],v[116:119]
ds_read_b64_tr_b16 a[146:147],v4 offset:30848
v_fma_f32 v91,v91,s36,v15
v_mfma_f32_16x16x32_bf16 a[164:167],a[124:127],v[56:59],a[164:167]
buffer_load_dwordx4 v6,s[12:15],s28 offen offset:0 nt lds
v_mfma_f32_16x16x32_bf16 a[160:163],a[120:123],v[56:59],a[160:163]
s_waitcnt lgkmcnt(5)
ds_read_b64_tr_b16 a[148:149],v5 offset:24704
v_fma_f32 v96,v96,s36,v16
v_mfma_f32_16x16x32_bf16 a[168:171],a[128:131],v[56:59],a[168:171]
ds_read_b64_tr_b16 a[150:151],v5 offset:30848
v_fma_f32 v97,v97,s36,v16
v_mfma_f32_16x16x32_bf16 a[172:175],a[132:135],v[56:59],a[172:175]
ds_read_b64_tr_b16 a[120:121],v2 offset:24832
v_fma_f32 v98,v98,s36,v16
v_mfma_f32_16x16x32_bf16 v[124:127],a[132:135],v[52:55],v[124:127]
ds_read_b64_tr_b16 a[122:123],v2 offset:30976
v_fma_f32 v99,v99,s36,v16
v_mfma_f32_16x16x32_bf16 v[120:123],a[128:131],v[52:55],v[120:123]
ds_read_b64_tr_b16 a[124:125],v3 offset:24832
v_fma_f32 v76,v76,s36,v13
v_mfma_f32_16x16x32_bf16 v[216:219],a[128:131],v[48:51],v[216:219]
ds_read_b64_tr_b16 a[126:127],v3 offset:30976
v_fma_f32 v77,v77,s36,v13
v_mfma_f32_16x16x32_bf16 v[220:223],a[132:135],v[48:51],v[220:223]
buffer_load_dwordx4 v7,s[12:15],s28 offen offset:1024 nt lds
v_mfma_f32_16x16x32_bf16 v[172:175],a[132:135],v[44:47],v[172:175]
ds_read_b64_tr_b16 a[132:133],v5 offset:24832
v_fma_f32 v78,v78,s36,v13
v_mfma_f32_16x16x32_bf16 v[168:171],a[128:131],v[44:47],v[168:171]
s_waitcnt lgkmcnt(5)
ds_read_b64_tr_b16 a[128:129],v4 offset:24832
v_fma_f32 v79,v79,s36,v13
v_mfma_f32_16x16x32_bf16 v[176:179],a[136:139],v[44:47],v[176:179]
ds_read_b64_tr_b16 a[130:131],v4 offset:30976
v_fma_f32 v84,v84,s36,v14
v_mfma_f32_16x16x32_bf16 v[180:183],a[140:143],v[44:47],v[180:183]
ds_read_b64_tr_b16 a[134:135],v5 offset:30976
v_fma_f32 v85,v85,s36,v14
v_mfma_f32_16x16x32_bf16 v[228:231],a[140:143],v[48:51],v[228:231]
v_exp_f32 v82,v82
v_mfma_f32_16x16x32_bf16 v[224:227],a[136:139],v[48:51],v[224:227]
v_exp_f32 v83,v83
v_mfma_f32_16x16x32_bf16 v[128:131],a[136:139],v[52:55],v[128:131]
v_cvt_pk_bf16_f32 v25,v82,v83
v_fma_f32 v86,v86,s36,v14
v_mfma_f32_16x16x32_bf16 v[132:135],a[140:143],v[52:55],v[132:135]
buffer_load_dwordx4 v8,s[12:15],s28 offen offset:2048 nt lds
v_mfma_f32_16x16x32_bf16 a[180:183],a[140:143],v[56:59],a[180:183]
s_add_u32 s28,s28,3072
v_exp_f32 v88,v88
v_mfma_f32_16x16x32_bf16 a[176:179],a[136:139],v[56:59],a[176:179]
s_add_u32 s29,s29,3072
v_exp_f32 v89,v89
v_mfma_f32_16x16x32_bf16 a[184:187],a[144:147],v[56:59],a[184:187]
s_add_u32 m0,s23,24576
v_exp_f32 v90,v90
v_mfma_f32_16x16x32_bf16 a[188:191],a[148:151],v[56:59],a[188:191]
v_exp_f32 v91,v91
v_mfma_f32_16x16x32_bf16 v[140:143],a[148:151],v[52:55],v[140:143]
v_cvt_pk_bf16_f32 v28,v88,v89
v_cvt_pk_bf16_f32 v29,v90,v91
v_mfma_f32_16x16x32_bf16 v[136:139],a[144:147],v[52:55],v[136:139]
v_exp_f32 v96,v96
v_mfma_f32_16x16x32_bf16 v[232:235],a[144:147],v[48:51],v[232:235]
v_exp_f32 v97,v97
v_mfma_f32_16x16x32_bf16 v[236:239],a[148:151],v[48:51],v[236:239]
v_exp_f32 v98,v98
v_mfma_f32_16x16x32_bf16 v[188:191],a[148:151],v[44:47],v[188:191]
v_exp_f32 v99,v99
v_mfma_f32_16x16x32_bf16 v[184:187],a[144:147],v[44:47],v[184:187]
s_waitcnt vmcnt(13)
v_cvt_pk_bf16_f32 v32,v96,v97
v_cvt_pk_bf16_f32 v33,v98,v99
s_waitcnt lgkmcnt(0)
v_mfma_f32_16x16x32_bf16 v[192:195],a[120:123],v[44:47],v[192:195]
s_barrier
v_mfma_f32_16x16x32_bf16 v[196:199],a[124:127],v[44:47],v[196:199]
ds_read_b128 a[148:151],v1 offset:12416
v_fma_f32 v87,v87,s36,v14
v_mfma_f32_16x16x32_bf16 v[244:247],a[124:127],v[48:51],v[244:247]
ds_read_b128 a[144:147],v0 offset:12416
v_fma_f32 v92,v92,s36,v15
v_mfma_f32_16x16x32_bf16 v[240:243],a[120:123],v[48:51],v[240:243]
ds_read_b128 a[140:143],v1 offset:12288
v_fma_f32 v93,v93,s36,v15
v_mfma_f32_16x16x32_bf16 v[144:147],a[120:123],v[52:55],v[144:147]
ds_read_b128 a[136:139],v0 offset:12288
v_fma_f32 v94,v94,s36,v15
v_mfma_f32_16x16x32_bf16 v[148:151],a[124:127],v[52:55],v[148:151]
v_exp_f32 v76,v76
v_mfma_f32_16x16x32_bf16 a[196:199],a[124:127],v[56:59],a[196:199]
buffer_load_dwordx4 v6,s[8:11],s21 offen offset:0 lds
v_mfma_f32_16x16x32_bf16 a[192:195],a[120:123],v[56:59],a[192:195]
ds_read_b128 a[124:127],v1 offset:12544
v_fma_f32 v95,v95,s36,v15
v_mfma_f32_16x16x32_bf16 a[200:203],a[128:131],v[56:59],a[200:203]
ds_read_b128 a[120:123],v0 offset:12544
v_fma_f32 v100,v100,s36,v16
v_mfma_f32_16x16x32_bf16 a[204:207],a[132:135],v[56:59],a[204:207]
v_exp_f32 v77,v77
v_mfma_f32_16x16x32_bf16 v[156:159],a[132:135],v[52:55],v[156:159]
v_exp_f32 v78,v78
v_mfma_f32_16x16x32_bf16 v[152:155],a[128:131],v[52:55],v[152:155]
v_exp_f32 v79,v79
v_mfma_f32_16x16x32_bf16 v[248:251],a[128:131],v[48:51],v[248:251]
v_cvt_pk_bf16_f32 v22,v76,v77
v_cvt_pk_bf16_f32 v23,v78,v79
v_mfma_f32_16x16x32_bf16 v[252:255],a[132:135],v[48:51],v[252:255]
v_exp_f32 v84,v84
v_mfma_f32_16x16x32_bf16 v[204:207],a[132:135],v[44:47],v[204:207]
ds_read_b128 a[132:135],v1 offset:18432
v_fma_f32 v101,v101,s36,v16
v_mfma_f32_16x16x32_bf16 v[200:203],a[128:131],v[44:47],v[200:203]
buffer_load_dwordx4 v7,s[8:11],s21 offen offset:1024 lds
s_waitcnt lgkmcnt(1)
v_mfma_f32_16x16x32_bf16 v[72:75],a[124:127],a[20:23],0
ds_read_b128 a[128:131],v0 offset:18432
v_fma_f32 v102,v102,s36,v16
v_mfma_f32_16x16x32_bf16 v[72:75],a[120:123],a[16:19],v[72:75]
v_exp_f32 v85,v85
v_mfma_f32_16x16x32_bf16 v[72:75],a[148:151],a[12:15],v[72:75]
v_exp_f32 v86,v86
v_mfma_f32_16x16x32_bf16 v[72:75],a[144:147],a[8:11],v[72:75]
v_exp_f32 v87,v87
v_mfma_f32_16x16x32_bf16 v[72:75],a[140:143],a[4:7],v[72:75]
v_cvt_pk_bf16_f32 v26,v84,v85
v_cvt_pk_bf16_f32 v27,v86,v87
v_mfma_f32_16x16x32_bf16 v[72:75],a[136:139],a[0:3],v[72:75]
v_exp_f32 v92,v92
v_smfmac_f32_16x16x64_bf16 v[60:63],a[152:155],v[20:27],v18
v_fma_f32 v103,v103,s36,v16
v_mfma_f32_16x16x32_bf16 v[80:83],a[136:139],a[24:27],0
v_exp_f32 v93,v93
v_mfma_f32_16x16x32_bf16 v[80:83],a[140:143],a[28:31],v[80:83]
buffer_load_dwordx4 v8,s[8:11],s21 offen offset:2048 lds
v_mfma_f32_16x16x32_bf16 v[80:83],a[144:147],a[32:35],v[80:83]
s_add_u32 s21,s21,12288
v_exp_f32 v94,v94
v_mfma_f32_16x16x32_bf16 v[80:83],a[148:151],a[36:39],v[80:83]
s_add_u32 m0,s22,0
v_exp_f32 v95,v95
v_mfma_f32_16x16x32_bf16 v[80:83],a[120:123],a[40:43],v[80:83]
v_cvt_pk_bf16_f32 v30,v92,v93
v_cvt_pk_bf16_f32 v31,v94,v95
v_mfma_f32_16x16x32_bf16 v[80:83],a[124:127],a[44:47],v[80:83]
v_exp_f32 v100,v100
v_mfma_f32_16x16x32_bf16 v[88:91],a[124:127],a[68:71],0
v_exp_f32 v101,v101
v_mfma_f32_16x16x32_bf16 v[88:91],a[120:123],a[64:67],v[88:91]
v_exp_f32 v102,v102
v_mfma_f32_16x16x32_bf16 v[88:91],a[148:151],a[60:63],v[88:91]
v_exp_f32 v103,v103
v_mfma_f32_16x16x32_bf16 v[88:91],a[144:147],a[56:59],v[88:91]
v_cvt_pk_bf16_f32 v34,v100,v101
v_cvt_pk_bf16_f32 v35,v102,v103
v_mfma_f32_16x16x32_bf16 v[88:91],a[140:143],a[52:55],v[88:91]
buffer_load_dwordx4 v6,s[4:7],s20 offen offset:0 lds
v_smfmac_f32_16x16x64_bf16 v[64:67],a[152:155],v[28:35],v18
v_fma_f32 v72,v72,s36,v13
v_mfma_f32_16x16x32_bf16 v[88:91],a[136:139],a[48:51],v[88:91]
v_fma_f32 v73,v73,s36,v13
v_fma_f32 v74,v74,s36,v13
v_mfma_f32_16x16x32_bf16 v[96:99],a[136:139],a[72:75],0
ds_read_b128 a[136:139],v0 offset:18560
v_fma_f32 v75,v75,s36,v13
v_mfma_f32_16x16x32_bf16 v[96:99],a[140:143],a[76:79],v[96:99]
ds_read_b128 a[140:143],v1 offset:18560
v_fma_f32 v80,v80,s36,v14
v_mfma_f32_16x16x32_bf16 v[96:99],a[144:147],a[80:83],v[96:99]
ds_read_b128 a[144:147],v0 offset:18688
v_fma_f32 v81,v81,s36,v14
v_mfma_f32_16x16x32_bf16 v[96:99],a[148:151],a[84:87],v[96:99]
ds_read_b128 a[148:151],v1 offset:18688
v_mfma_f32_16x16x32_bf16 v[96:99],a[120:123],a[88:91],v[96:99]
v_exp_f32 v72,v72
v_mfma_f32_16x16x32_bf16 v[96:99],a[124:127],a[92:95],v[96:99]
s_waitcnt lgkmcnt(4)
v_exp_f32 v73,v73
v_mfma_f32_16x16x32_bf16 v[76:79],a[128:131],a[0:3],0
buffer_load_dwordx4 v7,s[4:7],s20 offen offset:1024 lds
v_mfma_f32_16x16x32_bf16 v[76:79],a[132:135],a[4:7],v[76:79]
s_waitcnt lgkmcnt(3)
v_exp_f32 v74,v74
v_mfma_f32_16x16x32_bf16 v[76:79],a[136:139],a[8:11],v[76:79]
s_waitcnt lgkmcnt(2)
v_exp_f32 v75,v75
v_mfma_f32_16x16x32_bf16 v[76:79],a[140:143],a[12:15],v[76:79]
s_waitcnt lgkmcnt(0)
v_exp_f32 v80,v80
v_mfma_f32_16x16x32_bf16 v[76:79],a[144:147],a[16:19],v[76:79]
v_exp_f32 v81,v81
v_mfma_f32_16x16x32_bf16 v[76:79],a[148:151],a[20:23],v[76:79]
v_cvt_pk_bf16_f32 v44,v72,v73
v_cvt_pk_bf16_f32 v45,v74,v75
v_mfma_f32_16x16x32_bf16 v[84:87],a[148:151],a[44:47],0
v_cvt_pk_bf16_f32 v48,v80,v81
v_mfma_f32_16x16x32_bf16 v[84:87],a[144:147],a[40:43],v[84:87]
v_mfma_f32_16x16x32_bf16 v[84:87],a[140:143],a[36:39],v[84:87]
v_mfma_f32_16x16x32_bf16 v[84:87],a[136:139],a[32:35],v[84:87]
buffer_load_dwordx4 v8,s[4:7],s20 offen offset:2048 lds
v_mfma_f32_16x16x32_bf16 v[84:87],a[132:135],a[28:31],v[84:87]
s_add_u32 s20,s20,12288
v_mfma_f32_16x16x32_bf16 v[84:87],a[128:131],a[24:27],v[84:87]
ds_read_b64_tr_b16 a[120:121],v2 offset:0
v_mfma_f32_16x16x32_bf16 v[92:95],a[128:131],a[48:51],0
ds_read_b64_tr_b16 a[122:123],v2 offset:6144
v_mfma_f32_16x16x32_bf16 v[92:95],a[132:135],a[52:55],v[92:95]
ds_read_b64_tr_b16 a[124:125],v3 offset:0
v_mfma_f32_16x16x32_bf16 v[92:95],a[136:139],a[56:59],v[92:95]
ds_read_b64_tr_b16 a[126:127],v3 offset:6144
v_mfma_f32_16x16x32_bf16 v[92:95],a[140:143],a[60:63],v[92:95]
v_mfma_f32_16x16x32_bf16 v[92:95],a[144:147],a[64:67],v[92:95]
v_mfma_f32_16x16x32_bf16 v[92:95],a[148:151],a[68:71],v[92:95]
v_mfma_f32_16x16x32_bf16 v[100:103],a[148:151],a[92:95],0
v_mfma_f32_16x16x32_bf16 v[100:103],a[144:147],a[88:91],v[100:103]
v_mfma_f32_16x16x32_bf16 v[100:103],a[140:143],a[84:87],v[100:103]
v_mfma_f32_16x16x32_bf16 v[100:103],a[136:139],a[80:83],v[100:103]
v_mfma_f32_16x16x32_bf16 v[100:103],a[132:135],a[76:79],v[100:103]
ds_read_b64_tr_b16 a[132:133],v5 offset:0
v_mfma_f32_16x16x32_bf16 v[100:103],a[128:131],a[72:75],v[100:103]
s_waitcnt lgkmcnt(1)
ds_read_b64_tr_b16 a[128:129],v4 offset:0
ds_read_b64_tr_b16 a[130:131],v4 offset:6144
ds_read_b64_tr_b16 a[134:135],v5 offset:6144
v_mfma_f32_16x16x32_bf16 v[160:163],a[120:123],v[20:23],v[160:163]
ds_read_b128 a[156:159],v10 offset:6144
v_fma_f32 v82,v82,s36,v14
v_mfma_f32_16x16x32_bf16 v[164:167],a[124:127],v[20:23],v[164:167]
ds_read_b64_tr_b16 a[136:137],v2 offset:128
v_fma_f32 v83,v83,s36,v14
v_mfma_f32_16x16x32_bf16 v[212:215],a[124:127],v[24:27],v[212:215]
ds_read_b64_tr_b16 a[138:139],v2 offset:6272
v_fma_f32 v88,v88,s36,v15
v_mfma_f32_16x16x32_bf16 v[208:211],a[120:123],v[24:27],v[208:211]
ds_read_b64_tr_b16 a[140:141],v3 offset:128
v_fma_f32 v89,v89,s36,v15
v_mfma_f32_16x16x32_bf16 v[112:115],a[120:123],v[28:31],v[112:115]
ds_read_b64_tr_b16 a[142:143],v3 offset:6272
v_fma_f32 v90,v90,s36,v15
v_mfma_f32_16x16x32_bf16 v[116:119],a[124:127],v[28:31],v[116:119]
ds_read_b64_tr_b16 a[144:145],v4 offset:128
v_fma_f32 v91,v91,s36,v15
v_mfma_f32_16x16x32_bf16 a[164:167],a[124:127],v[32:35],a[164:167]
ds_read_b64_tr_b16 a[146:147],v4 offset:6272
v_fma_f32 v96,v96,s36,v16
v_mfma_f32_16x16x32_bf16 a[160:163],a[120:123],v[32:35],a[160:163]
s_waitcnt lgkmcnt(6)
ds_read_b64_tr_b16 a[148:149],v5 offset:128
v_fma_f32 v97,v97,s36,v16
v_mfma_f32_16x16x32_bf16 a[168:171],a[128:131],v[32:35],a[168:171]
ds_read_b64_tr_b16 a[150:151],v5 offset:6272
v_fma_f32 v98,v98,s36,v16
v_mfma_f32_16x16x32_bf16 a[172:175],a[132:135],v[32:35],a[172:175]
ds_read_b64_tr_b16 a[120:121],v2 offset:256
v_fma_f32 v99,v99,s36,v16
v_mfma_f32_16x16x32_bf16 v[124:127],a[132:135],v[28:31],v[124:127]
ds_read_b64_tr_b16 a[122:123],v2 offset:6400
v_fma_f32 v76,v76,s36,v13
v_mfma_f32_16x16x32_bf16 v[120:123],a[128:131],v[28:31],v[120:123]
ds_read_b64_tr_b16 a[124:125],v3 offset:256
v_fma_f32 v77,v77,s36,v13
v_mfma_f32_16x16x32_bf16 v[216:219],a[128:131],v[24:27],v[216:219]
ds_read_b64_tr_b16 a[126:127],v3 offset:6400
v_fma_f32 v78,v78,s36,v13
v_mfma_f32_16x16x32_bf16 v[220:223],a[132:135],v[24:27],v[220:223]
v_exp_f32 v82,v82
v_mfma_f32_16x16x32_bf16 v[172:175],a[132:135],v[20:23],v[172:175]
ds_read_b64_tr_b16 a[132:133],v5 offset:256
v_fma_f32 v79,v79,s36,v13
v_mfma_f32_16x16x32_bf16 v[168:171],a[128:131],v[20:23],v[168:171]
s_waitcnt lgkmcnt(5)
ds_read_b64_tr_b16 a[128:129],v4 offset:256
v_fma_f32 v84,v84,s36,v14
v_mfma_f32_16x16x32_bf16 v[176:179],a[136:139],v[20:23],v[176:179]
buffer_store_dwordx4 a[156:159],v9,s[16:19],s27 offen offset:0 nt
ds_read_b64_tr_b16 a[130:131],v4 offset:6400
ds_read_b128 a[156:159],v10 offset:7168
v_mfma_f32_16x16x32_bf16 v[180:183],a[140:143],v[20:23],v[180:183]
ds_read_b64_tr_b16 a[134:135],v5 offset:6400
v_mfma_f32_16x16x32_bf16 v[228:231],a[140:143],v[24:27],v[228:231]
v_exp_f32 v83,v83
v_mfma_f32_16x16x32_bf16 v[224:227],a[136:139],v[24:27],v[224:227]
v_cvt_pk_bf16_f32 v49,v82,v83
v_fma_f32 v85,v85,s36,v14
v_mfma_f32_16x16x32_bf16 v[128:131],a[136:139],v[28:31],v[128:131]
v_exp_f32 v88,v88
v_mfma_f32_16x16x32_bf16 v[132:135],a[140:143],v[28:31],v[132:135]
v_exp_f32 v89,v89
v_mfma_f32_16x16x32_bf16 a[180:183],a[140:143],v[32:35],a[180:183]
v_exp_f32 v90,v90
v_mfma_f32_16x16x32_bf16 a[176:179],a[136:139],v[32:35],a[176:179]
v_exp_f32 v91,v91
v_mfma_f32_16x16x32_bf16 a[184:187],a[144:147],v[32:35],a[184:187]
s_waitcnt lgkmcnt(1)
buffer_store_dwordx4 a[156:159],v9,s[16:19],s27 offen offset:128 nt
v_cvt_pk_bf16_f32 v52,v88,v89
v_cvt_pk_bf16_f32 v53,v90,v91
v_fma_f32 v86,v86,s36,v14
v_mfma_f32_16x16x32_bf16 a[188:191],a[148:151],v[32:35],a[188:191]
ds_read_b128 a[156:159],v10 offset:8192
v_fma_f32 v87,v87,s36,v14
v_mfma_f32_16x16x32_bf16 v[140:143],a[148:151],v[28:31],v[140:143]
v_exp_f32 v96,v96
v_mfma_f32_16x16x32_bf16 v[136:139],a[144:147],v[28:31],v[136:139]
v_exp_f32 v97,v97
v_mfma_f32_16x16x32_bf16 v[232:235],a[144:147],v[24:27],v[232:235]
v_exp_f32 v98,v98
v_mfma_f32_16x16x32_bf16 v[236:239],a[148:151],v[24:27],v[236:239]
v_exp_f32 v99,v99
v_mfma_f32_16x16x32_bf16 v[188:191],a[148:151],v[20:23],v[188:191]
v_cvt_pk_bf16_f32 v56,v96,v97
v_cvt_pk_bf16_f32 v57,v98,v99
v_mfma_f32_16x16x32_bf16 v[184:187],a[144:147],v[20:23],v[184:187]
v_exp_f32 v76,v76
v_mfma_f32_16x16x32_bf16 v[192:195],a[120:123],v[20:23],v[192:195]
v_exp_f32 v77,v77
v_mfma_f32_16x16x32_bf16 v[196:199],a[124:127],v[20:23],v[196:199]
s_waitcnt lgkmcnt(0)
buffer_store_dwordx4 a[156:159],v9,s[16:19],s27 offen offset:256 nt
v_exp_f32 v78,v78
v_cvt_pk_bf16_f32 v46,v76,v77
v_mfma_f32_16x16x32_bf16 v[244:247],a[124:127],v[24:27],v[244:247]
s_waitcnt vmcnt(12)
v_exp_f32 v79,v79
v_mfma_f32_16x16x32_bf16 v[240:243],a[120:123],v[24:27],v[240:243]
s_barrier
v_mfma_f32_16x16x32_bf16 v[144:147],a[120:123],v[28:31],v[144:147]
s_add_u32 s27,s27,3072
ds_read_b128 a[148:151],v1 offset:24704
v_cvt_pk_bf16_f32 v47,v78,v79
v_mfma_f32_16x16x32_bf16 v[148:151],a[124:127],v[28:31],v[148:151]
s_add_u32 m0,s23,0
ds_read_b128 a[144:147],v0 offset:24704
v_fma_f32 v92,v92,s36,v15
v_mfma_f32_16x16x32_bf16 a[196:199],a[124:127],v[32:35],a[196:199]
buffer_load_dwordx4 v6,s[8:11],s21 offen offset:0 lds
v_mfma_f32_16x16x32_bf16 a[192:195],a[120:123],v[32:35],a[192:195]
ds_read_b128 a[124:127],v1 offset:24832
v_fma_f32 v93,v93,s36,v15
v_mfma_f32_16x16x32_bf16 a[200:203],a[128:131],v[32:35],a[200:203]
ds_read_b128 a[120:123],v0 offset:24832
v_fma_f32 v94,v94,s36,v15
v_mfma_f32_16x16x32_bf16 a[204:207],a[132:135],v[32:35],a[204:207]
ds_read_b128 a[140:143],v1 offset:24576
v_fma_f32 v95,v95,s36,v15
v_mfma_f32_16x16x32_bf16 v[156:159],a[132:135],v[28:31],v[156:159]
ds_read_b128 a[136:139],v0 offset:24576
v_fma_f32 v100,v100,s36,v16
v_mfma_f32_16x16x32_bf16 v[152:155],a[128:131],v[28:31],v[152:155]
v_exp_f32 v84,v84
v_mfma_f32_16x16x32_bf16 v[248:251],a[128:131],v[24:27],v[248:251]
v_exp_f32 v85,v85
v_mfma_f32_16x16x32_bf16 v[252:255],a[132:135],v[24:27],v[252:255]
buffer_load_dwordx4 v7,s[8:11],s21 offen offset:1024 lds
v_mfma_f32_16x16x32_bf16 v[204:207],a[132:135],v[20:23],v[204:207]
ds_read_b128 a[132:135],v1 offset:30720
v_cvt_pk_bf16_f32 v50,v84,v85
v_mfma_f32_16x16x32_bf16 v[200:203],a[128:131],v[20:23],v[200:203]
s_waitcnt lgkmcnt(3)
ds_read_b128 a[128:131],v0 offset:30720
v_fma_f32 v101,v101,s36,v16
v_mfma_f32_16x16x32_bf16 v[72:75],a[124:127],a[20:23],0
v_exp_f32 v86,v86
v_mfma_f32_16x16x32_bf16 v[72:75],a[120:123],a[16:19],v[72:75]
v_exp_f32 v87,v87
v_mfma_f32_16x16x32_bf16 v[72:75],a[148:151],a[12:15],v[72:75]
v_cvt_pk_bf16_f32 v51,v86,v87
v_fma_f32 v102,v102,s36,v16
v_mfma_f32_16x16x32_bf16 v[72:75],a[144:147],a[8:11],v[72:75]
v_exp_f32 v92,v92
v_smfmac_f32_16x16x64_bf16 v[60:63],a[152:155],v[44:51],v18
s_waitcnt lgkmcnt(2)
v_fma_f32 v103,v103,s36,v16
v_mfma_f32_16x16x32_bf16 v[72:75],a[140:143],a[4:7],v[72:75]
v_exp_f32 v93,v93
v_mfma_f32_16x16x32_bf16 v[72:75],a[136:139],a[0:3],v[72:75]
buffer_load_dwordx4 v8,s[8:11],s21 offen offset:2048 lds
v_mfma_f32_16x16x32_bf16 v[80:83],a[136:139],a[24:27],0
s_add_u32 s21,s21,12288
v_exp_f32 v94,v94
v_mfma_f32_16x16x32_bf16 v[80:83],a[140:143],a[28:31],v[80:83]
s_cmp_eq_u32 s38,1
v_exp_f32 v95,v95
v_mfma_f32_16x16x32_bf16 v[80:83],a[144:147],a[32:35],v[80:83]
s_cselect_b32 s20,s26,s20
v_cvt_pk_bf16_f32 v54,v92,v93
v_cvt_pk_bf16_f32 v55,v94,v95
v_mfma_f32_16x16x32_bf16 v[80:83],a[148:151],a[36:39],v[80:83]
s_add_u32 m0,s22,12288
v_exp_f32 v100,v100
v_mfma_f32_16x16x32_bf16 v[80:83],a[120:123],a[40:43],v[80:83]
v_exp_f32 v101,v101
v_mfma_f32_16x16x32_bf16 v[80:83],a[124:127],a[44:47],v[80:83]
v_exp_f32 v102,v102
v_mfma_f32_16x16x32_bf16 v[88:91],a[124:127],a[68:71],0
v_exp_f32 v103,v103
v_mfma_f32_16x16x32_bf16 v[88:91],a[120:123],a[64:67],v[88:91]
v_cvt_pk_bf16_f32 v58,v100,v101
v_cvt_pk_bf16_f32 v59,v102,v103
v_mfma_f32_16x16x32_bf16 v[88:91],a[148:151],a[60:63],v[88:91]
buffer_load_dwordx4 v6,s[4:7],s20 offen offset:0 lds
v_smfmac_f32_16x16x64_bf16 v[64:67],a[152:155],v[52:59],v18
v_fma_f32 v72,v72,s36,v13
v_mfma_f32_16x16x32_bf16 v[88:91],a[144:147],a[56:59],v[88:91]
v_fma_f32 v73,v73,s36,v13
v_fma_f32 v74,v74,s36,v13
v_mfma_f32_16x16x32_bf16 v[88:91],a[140:143],a[52:55],v[88:91]
v_fma_f32 v75,v75,s36,v13
v_fma_f32 v80,v80,s36,v14
v_mfma_f32_16x16x32_bf16 v[88:91],a[136:139],a[48:51],v[88:91]
v_fma_f32 v81,v81,s36,v14
v_mfma_f32_16x16x32_bf16 v[96:99],a[136:139],a[72:75],0
ds_read_b128 a[136:139],v0 offset:30848
v_mfma_f32_16x16x32_bf16 v[96:99],a[140:143],a[76:79],v[96:99]
ds_read_b128 a[140:143],v1 offset:30848
v_mfma_f32_16x16x32_bf16 v[96:99],a[144:147],a[80:83],v[96:99]
ds_read_b128 a[144:147],v0 offset:30976
v_mfma_f32_16x16x32_bf16 v[96:99],a[148:151],a[84:87],v[96:99]
ds_read_b128 a[148:151],v1 offset:30976
v_mfma_f32_16x16x32_bf16 v[96:99],a[120:123],a[88:91],v[96:99]
buffer_load_dwordx4 v7,s[4:7],s20 offen offset:1024 lds
v_mfma_f32_16x16x32_bf16 v[96:99],a[124:127],a[92:95],v[96:99]
s_waitcnt lgkmcnt(4)
v_exp_f32 v72,v72
v_mfma_f32_16x16x32_bf16 v[76:79],a[128:131],a[0:3],0
v_exp_f32 v73,v73
v_mfma_f32_16x16x32_bf16 v[76:79],a[132:135],a[4:7],v[76:79]
s_waitcnt lgkmcnt(3)
v_exp_f32 v74,v74
v_mfma_f32_16x16x32_bf16 v[76:79],a[136:139],a[8:11],v[76:79]
s_waitcnt lgkmcnt(2)
v_exp_f32 v75,v75
v_mfma_f32_16x16x32_bf16 v[76:79],a[140:143],a[12:15],v[76:79]
s_waitcnt lgkmcnt(0)
v_exp_f32 v80,v80
v_mfma_f32_16x16x32_bf16 v[76:79],a[144:147],a[16:19],v[76:79]
v_exp_f32 v81,v81
v_mfma_f32_16x16x32_bf16 v[76:79],a[148:151],a[20:23],v[76:79]
v_cvt_pk_bf16_f32 v20,v72,v73
v_cvt_pk_bf16_f32 v21,v74,v75
v_mfma_f32_16x16x32_bf16 v[84:87],a[148:151],a[44:47],0
v_cvt_pk_bf16_f32 v24,v80,v81
v_mfma_f32_16x16x32_bf16 v[84:87],a[144:147],a[40:43],v[84:87]
buffer_load_dwordx4 v8,s[4:7],s20 offen offset:2048 lds
v_mfma_f32_16x16x32_bf16 v[84:87],a[140:143],a[36:39],v[84:87]
s_add_u32 s20,s20,12288
v_mfma_f32_16x16x32_bf16 v[84:87],a[136:139],a[32:35],v[84:87]
ds_read_b64_tr_b16 a[120:121],v2 offset:12288
v_mfma_f32_16x16x32_bf16 v[84:87],a[132:135],a[28:31],v[84:87]
ds_read_b64_tr_b16 a[122:123],v2 offset:18432
v_mfma_f32_16x16x32_bf16 v[84:87],a[128:131],a[24:27],v[84:87]
ds_read_b64_tr_b16 a[124:125],v3 offset:12288
v_mfma_f32_16x16x32_bf16 v[92:95],a[128:131],a[48:51],0
ds_read_b64_tr_b16 a[126:127],v3 offset:18432
v_mfma_f32_16x16x32_bf16 v[92:95],a[132:135],a[52:55],v[92:95]
v_mfma_f32_16x16x32_bf16 v[92:95],a[136:139],a[56:59],v[92:95]
v_mfma_f32_16x16x32_bf16 v[92:95],a[140:143],a[60:63],v[92:95]
v_mfma_f32_16x16x32_bf16 v[92:95],a[144:147],a[64:67],v[92:95]
v_mfma_f32_16x16x32_bf16 v[92:95],a[148:151],a[68:71],v[92:95]
v_mfma_f32_16x16x32_bf16 v[100:103],a[148:151],a[92:95],0
v_mfma_f32_16x16x32_bf16 v[100:103],a[144:147],a[88:91],v[100:103]
v_mfma_f32_16x16x32_bf16 v[100:103],a[140:143],a[84:87],v[100:103]
v_mfma_f32_16x16x32_bf16 v[100:103],a[136:139],a[80:83],v[100:103]
v_mfma_f32_16x16x32_bf16 v[100:103],a[132:135],a[76:79],v[100:103]
ds_read_b64_tr_b16 a[132:133],v5 offset:12288
v_mfma_f32_16x16x32_bf16 v[100:103],a[128:131],a[72:75],v[100:103]
s_waitcnt lgkmcnt(1)
ds_read_b64_tr_b16 a[128:129],v4 offset:12288
ds_read_b64_tr_b16 a[130:131],v4 offset:18432
ds_read_b64_tr_b16 a[134:135],v5 offset:18432
v_mfma_f32_16x16x32_bf16 v[160:163],a[120:123],v[44:47],v[160:163]
s_add_u32 m0,s29,0
ds_read_b64_tr_b16 a[136:137],v2 offset:12416
v_fma_f32 v82,v82,s36,v14
v_mfma_f32_16x16x32_bf16 v[164:167],a[124:127],v[44:47],v[164:167]
ds_read_b64_tr_b16 a[138:139],v2 offset:18560
v_fma_f32 v83,v83,s36,v14
v_mfma_f32_16x16x32_bf16 v[212:215],a[124:127],v[48:51],v[212:215]
ds_read_b64_tr_b16 a[140:141],v3 offset:12416
v_fma_f32 v88,v88,s36,v15
v_mfma_f32_16x16x32_bf16 v[208:211],a[120:123],v[48:51],v[208:211]
ds_read_b64_tr_b16 a[142:143],v3 offset:18560
v_fma_f32 v89,v89,s36,v15
v_mfma_f32_16x16x32_bf16 v[112:115],a[120:123],v[52:55],v[112:115]
ds_read_b64_tr_b16 a[144:145],v4 offset:12416
v_fma_f32 v90,v90,s36,v15
v_mfma_f32_16x16x32_bf16 v[116:119],a[124:127],v[52:55],v[116:119]
ds_read_b64_tr_b16 a[146:147],v4 offset:18560
v_fma_f32 v91,v91,s36,v15
v_mfma_f32_16x16x32_bf16 a[164:167],a[124:127],v[56:59],a[164:167]
buffer_load_dwordx4 v6,s[12:15],s28 offen offset:0 nt lds
v_mfma_f32_16x16x32_bf16 a[160:163],a[120:123],v[56:59],a[160:163]
s_waitcnt lgkmcnt(5)
ds_read_b64_tr_b16 a[148:149],v5 offset:12416
v_fma_f32 v96,v96,s36,v16
v_mfma_f32_16x16x32_bf16 a[168:171],a[128:131],v[56:59],a[168:171]
ds_read_b64_tr_b16 a[150:151],v5 offset:18560
v_fma_f32 v97,v97,s36,v16
v_mfma_f32_16x16x32_bf16 a[172:175],a[132:135],v[56:59],a[172:175]
ds_read_b64_tr_b16 a[120:121],v2 offset:12544
v_fma_f32 v98,v98,s36,v16
v_mfma_f32_16x16x32_bf16 v[124:127],a[132:135],v[52:55],v[124:127]
ds_read_b64_tr_b16 a[122:123],v2 offset:18688
v_fma_f32 v99,v99,s36,v16
v_mfma_f32_16x16x32_bf16 v[120:123],a[128:131],v[52:55],v[120:123]
ds_read_b64_tr_b16 a[124:125],v3 offset:12544
v_fma_f32 v76,v76,s36,v13
v_mfma_f32_16x16x32_bf16 v[216:219],a[128:131],v[48:51],v[216:219]
ds_read_b64_tr_b16 a[126:127],v3 offset:18688
v_fma_f32 v77,v77,s36,v13
v_mfma_f32_16x16x32_bf16 v[220:223],a[132:135],v[48:51],v[220:223]
buffer_load_dwordx4 v7,s[12:15],s28 offen offset:1024 nt lds
v_mfma_f32_16x16x32_bf16 v[172:175],a[132:135],v[44:47],v[172:175]
ds_read_b64_tr_b16 a[132:133],v5 offset:12544
v_fma_f32 v78,v78,s36,v13
v_mfma_f32_16x16x32_bf16 v[168:171],a[128:131],v[44:47],v[168:171]
s_waitcnt lgkmcnt(5)
ds_read_b64_tr_b16 a[128:129],v4 offset:12544
v_fma_f32 v79,v79,s36,v13
v_mfma_f32_16x16x32_bf16 v[176:179],a[136:139],v[44:47],v[176:179]
ds_read_b64_tr_b16 a[130:131],v4 offset:18688
v_fma_f32 v84,v84,s36,v14
v_mfma_f32_16x16x32_bf16 v[180:183],a[140:143],v[44:47],v[180:183]
ds_read_b64_tr_b16 a[134:135],v5 offset:18688
v_fma_f32 v85,v85,s36,v14
v_mfma_f32_16x16x32_bf16 v[228:231],a[140:143],v[48:51],v[228:231]
v_exp_f32 v82,v82
v_mfma_f32_16x16x32_bf16 v[224:227],a[136:139],v[48:51],v[224:227]
v_exp_f32 v83,v83
v_mfma_f32_16x16x32_bf16 v[128:131],a[136:139],v[52:55],v[128:131]
v_cvt_pk_bf16_f32 v25,v82,v83
v_fma_f32 v86,v86,s36,v14
v_mfma_f32_16x16x32_bf16 v[132:135],a[140:143],v[52:55],v[132:135]
buffer_load_dwordx4 v8,s[12:15],s28 offen offset:2048 nt lds
v_mfma_f32_16x16x32_bf16 a[180:183],a[140:143],v[56:59],a[180:183]
s_add_u32 s28,s28,3072
v_exp_f32 v88,v88
v_mfma_f32_16x16x32_bf16 a[176:179],a[136:139],v[56:59],a[176:179]
s_add_u32 s29,s29,3072
v_exp_f32 v89,v89
v_mfma_f32_16x16x32_bf16 a[184:187],a[144:147],v[56:59],a[184:187]
s_cmp_eq_u32 s38,1
v_exp_f32 v90,v90
v_mfma_f32_16x16x32_bf16 a[188:191],a[148:151],v[56:59],a[188:191]
s_cselect_b32 s21,s26,s21
v_exp_f32 v91,v91
v_mfma_f32_16x16x32_bf16 v[140:143],a[148:151],v[52:55],v[140:143]
s_add_u32 m0,s23,12288
v_cvt_pk_bf16_f32 v28,v88,v89
v_cvt_pk_bf16_f32 v29,v90,v91
v_mfma_f32_16x16x32_bf16 v[136:139],a[144:147],v[52:55],v[136:139]
v_exp_f32 v96,v96
v_mfma_f32_16x16x32_bf16 v[232:235],a[144:147],v[48:51],v[232:235]
v_exp_f32 v97,v97
v_mfma_f32_16x16x32_bf16 v[236:239],a[148:151],v[48:51],v[236:239]
v_exp_f32 v98,v98
v_mfma_f32_16x16x32_bf16 v[188:191],a[148:151],v[44:47],v[188:191]
v_exp_f32 v99,v99
v_mfma_f32_16x16x32_bf16 v[184:187],a[144:147],v[44:47],v[184:187]
s_waitcnt vmcnt(12)
v_cvt_pk_bf16_f32 v32,v96,v97
v_cvt_pk_bf16_f32 v33,v98,v99
s_waitcnt lgkmcnt(0)
v_mfma_f32_16x16x32_bf16 v[192:195],a[120:123],v[44:47],v[192:195]
s_barrier
v_mfma_f32_16x16x32_bf16 v[196:199],a[124:127],v[44:47],v[196:199]
ds_read_b128 a[148:151],v1 offset:128
v_fma_f32 v87,v87,s36,v14
v_mfma_f32_16x16x32_bf16 v[244:247],a[124:127],v[48:51],v[244:247]
ds_read_b128 a[144:147],v0 offset:128
v_fma_f32 v92,v92,s36,v15
v_mfma_f32_16x16x32_bf16 v[240:243],a[120:123],v[48:51],v[240:243]
ds_read_b128 a[140:143],v1 offset:0
v_fma_f32 v93,v93,s36,v15
v_mfma_f32_16x16x32_bf16 v[144:147],a[120:123],v[52:55],v[144:147]
ds_read_b128 a[136:139],v0 offset:0
v_fma_f32 v94,v94,s36,v15
v_mfma_f32_16x16x32_bf16 v[148:151],a[124:127],v[52:55],v[148:151]
v_exp_f32 v76,v76
v_mfma_f32_16x16x32_bf16 a[196:199],a[124:127],v[56:59],a[196:199]
buffer_load_dwordx4 v6,s[8:11],s21 offen offset:0 lds
v_mfma_f32_16x16x32_bf16 a[192:195],a[120:123],v[56:59],a[192:195]
ds_read_b128 a[124:127],v1 offset:256
v_fma_f32 v95,v95,s36,v15
v_mfma_f32_16x16x32_bf16 a[200:203],a[128:131],v[56:59],a[200:203]
ds_read_b128 a[120:123],v0 offset:256
v_fma_f32 v100,v100,s36,v16
v_mfma_f32_16x16x32_bf16 a[204:207],a[132:135],v[56:59],a[204:207]
v_exp_f32 v77,v77
v_mfma_f32_16x16x32_bf16 v[156:159],a[132:135],v[52:55],v[156:159]
v_exp_f32 v78,v78
v_mfma_f32_16x16x32_bf16 v[152:155],a[128:131],v[52:55],v[152:155]
v_exp_f32 v79,v79
v_mfma_f32_16x16x32_bf16 v[248:251],a[128:131],v[48:51],v[248:251]
v_cvt_pk_bf16_f32 v22,v76,v77
v_cvt_pk_bf16_f32 v23,v78,v79
v_mfma_f32_16x16x32_bf16 v[252:255],a[132:135],v[48:51],v[252:255]
v_exp_f32 v84,v84
v_mfma_f32_16x16x32_bf16 v[204:207],a[132:135],v[44:47],v[204:207]
ds_read_b128 a[132:135],v1 offset:6144
v_fma_f32 v101,v101,s36,v16
v_mfma_f32_16x16x32_bf16 v[200:203],a[128:131],v[44:47],v[200:203]
buffer_load_dwordx4 v7,s[8:11],s21 offen offset:1024 lds
s_waitcnt lgkmcnt(1)
v_mfma_f32_16x16x32_bf16 v[72:75],a[124:127],a[20:23],0
ds_read_b128 a[128:131],v0 offset:6144
v_fma_f32 v102,v102,s36,v16
v_mfma_f32_16x16x32_bf16 v[72:75],a[120:123],a[16:19],v[72:75]
v_exp_f32 v85,v85
v_mfma_f32_16x16x32_bf16 v[72:75],a[148:151],a[12:15],v[72:75]
v_exp_f32 v86,v86
v_mfma_f32_16x16x32_bf16 v[72:75],a[144:147],a[8:11],v[72:75]
v_exp_f32 v87,v87
v_mfma_f32_16x16x32_bf16 v[72:75],a[140:143],a[4:7],v[72:75]
v_cvt_pk_bf16_f32 v26,v84,v85
v_cvt_pk_bf16_f32 v27,v86,v87
v_mfma_f32_16x16x32_bf16 v[72:75],a[136:139],a[0:3],v[72:75]
v_exp_f32 v92,v92
v_smfmac_f32_16x16x64_bf16 v[60:63],a[152:155],v[20:27],v18
v_fma_f32 v103,v103,s36,v16
v_mfma_f32_16x16x32_bf16 v[80:83],a[136:139],a[24:27],0
v_exp_f32 v93,v93
v_mfma_f32_16x16x32_bf16 v[80:83],a[140:143],a[28:31],v[80:83]
buffer_load_dwordx4 v8,s[8:11],s21 offen offset:2048 lds
v_mfma_f32_16x16x32_bf16 v[80:83],a[144:147],a[32:35],v[80:83]
s_add_u32 s21,s21,12288
v_exp_f32 v94,v94
v_mfma_f32_16x16x32_bf16 v[80:83],a[148:151],a[36:39],v[80:83]
s_add_u32 m0,s22,24576
v_exp_f32 v95,v95
v_mfma_f32_16x16x32_bf16 v[80:83],a[120:123],a[40:43],v[80:83]
v_cvt_pk_bf16_f32 v30,v92,v93
v_cvt_pk_bf16_f32 v31,v94,v95
v_mfma_f32_16x16x32_bf16 v[80:83],a[124:127],a[44:47],v[80:83]
v_exp_f32 v100,v100
v_mfma_f32_16x16x32_bf16 v[88:91],a[124:127],a[68:71],0
v_exp_f32 v101,v101
v_mfma_f32_16x16x32_bf16 v[88:91],a[120:123],a[64:67],v[88:91]
v_exp_f32 v102,v102
v_mfma_f32_16x16x32_bf16 v[88:91],a[148:151],a[60:63],v[88:91]
v_exp_f32 v103,v103
v_mfma_f32_16x16x32_bf16 v[88:91],a[144:147],a[56:59],v[88:91]
v_cvt_pk_bf16_f32 v34,v100,v101
v_cvt_pk_bf16_f32 v35,v102,v103
v_mfma_f32_16x16x32_bf16 v[88:91],a[140:143],a[52:55],v[88:91]
buffer_load_dwordx4 v6,s[4:7],s20 offen offset:0 lds
v_smfmac_f32_16x16x64_bf16 v[64:67],a[152:155],v[28:35],v18
v_fma_f32 v72,v72,s36,v13
v_mfma_f32_16x16x32_bf16 v[88:91],a[136:139],a[48:51],v[88:91]
v_fma_f32 v73,v73,s36,v13
v_fma_f32 v74,v74,s36,v13
v_mfma_f32_16x16x32_bf16 v[96:99],a[136:139],a[72:75],0
ds_read_b128 a[136:139],v0 offset:6272
v_fma_f32 v75,v75,s36,v13
v_mfma_f32_16x16x32_bf16 v[96:99],a[140:143],a[76:79],v[96:99]
ds_read_b128 a[140:143],v1 offset:6272
v_fma_f32 v80,v80,s36,v14
v_mfma_f32_16x16x32_bf16 v[96:99],a[144:147],a[80:83],v[96:99]
ds_read_b128 a[144:147],v0 offset:6400
v_fma_f32 v81,v81,s36,v14
v_mfma_f32_16x16x32_bf16 v[96:99],a[148:151],a[84:87],v[96:99]
ds_read_b128 a[148:151],v1 offset:6400
v_add_u32 v10,9216,v10
v_mfma_f32_16x16x32_bf16 v[96:99],a[120:123],a[88:91],v[96:99]
v_exp_f32 v72,v72
v_mfma_f32_16x16x32_bf16 v[96:99],a[124:127],a[92:95],v[96:99]
s_waitcnt lgkmcnt(4)
v_exp_f32 v73,v73
v_mfma_f32_16x16x32_bf16 v[76:79],a[128:131],a[0:3],0
buffer_load_dwordx4 v7,s[4:7],s20 offen offset:1024 lds
v_mfma_f32_16x16x32_bf16 v[76:79],a[132:135],a[4:7],v[76:79]
s_waitcnt lgkmcnt(3)
v_exp_f32 v74,v74
v_mfma_f32_16x16x32_bf16 v[76:79],a[136:139],a[8:11],v[76:79]
s_waitcnt lgkmcnt(2)
v_exp_f32 v75,v75
v_mfma_f32_16x16x32_bf16 v[76:79],a[140:143],a[12:15],v[76:79]
s_waitcnt lgkmcnt(0)
v_exp_f32 v80,v80
v_mfma_f32_16x16x32_bf16 v[76:79],a[144:147],a[16:19],v[76:79]
v_exp_f32 v81,v81
v_mfma_f32_16x16x32_bf16 v[76:79],a[148:151],a[20:23],v[76:79]
v_cvt_pk_bf16_f32 v44,v72,v73
v_cvt_pk_bf16_f32 v45,v74,v75
v_mfma_f32_16x16x32_bf16 v[84:87],a[148:151],a[44:47],0
v_cvt_pk_bf16_f32 v48,v80,v81
v_mfma_f32_16x16x32_bf16 v[84:87],a[144:147],a[40:43],v[84:87]
v_mfma_f32_16x16x32_bf16 v[84:87],a[140:143],a[36:39],v[84:87]
v_mfma_f32_16x16x32_bf16 v[84:87],a[136:139],a[32:35],v[84:87]
buffer_load_dwordx4 v8,s[4:7],s20 offen offset:2048 lds
v_mfma_f32_16x16x32_bf16 v[84:87],a[132:135],a[28:31],v[84:87]
s_add_u32 s20,s20,12288
s_add_u32 s38,s38,1
s_cmp_lt_u32 s38,2
v_mfma_f32_16x16x32_bf16 v[84:87],a[128:131],a[24:27],v[84:87]
ds_read_b64_tr_b16 a[120:121],v2 offset:24576
v_mfma_f32_16x16x32_bf16 v[92:95],a[128:131],a[48:51],0
ds_read_b64_tr_b16 a[122:123],v2 offset:30720
v_mfma_f32_16x16x32_bf16 v[92:95],a[132:135],a[52:55],v[92:95]
ds_read_b64_tr_b16 a[124:125],v3 offset:24576
v_mfma_f32_16x16x32_bf16 v[92:95],a[136:139],a[56:59],v[92:95]
ds_read_b64_tr_b16 a[126:127],v3 offset:30720
v_mfma_f32_16x16x32_bf16 v[92:95],a[140:143],a[60:63],v[92:95]
v_mfma_f32_16x16x32_bf16 v[92:95],a[144:147],a[64:67],v[92:95]
v_mfma_f32_16x16x32_bf16 v[92:95],a[148:151],a[68:71],v[92:95]
v_mfma_f32_16x16x32_bf16 v[100:103],a[148:151],a[92:95],0
v_mfma_f32_16x16x32_bf16 v[100:103],a[144:147],a[88:91],v[100:103]
v_mfma_f32_16x16x32_bf16 v[100:103],a[140:143],a[84:87],v[100:103]
v_mfma_f32_16x16x32_bf16 v[100:103],a[136:139],a[80:83],v[100:103]
v_mfma_f32_16x16x32_bf16 v[100:103],a[132:135],a[76:79],v[100:103]
ds_read_b64_tr_b16 a[132:133],v5 offset:24576
v_mfma_f32_16x16x32_bf16 v[100:103],a[128:131],a[72:75],v[100:103]
ds_read_b64_tr_b16 a[128:129],v4 offset:24576
ds_read_b64_tr_b16 a[130:131],v4 offset:30720
ds_read_b64_tr_b16 a[134:135],v5 offset:30720
s_cbranch_scc1 L_loop4w0
s_cmp_ge_u32 s69,6
s_cbranch_scc1 L_end4
s_cmp_eq_u32 s40,0
s_cbranch_scc1 L_tr44
s_branch L_tr45
L_tr45:
s_waitcnt vmcnt(43)
s_waitcnt lgkmcnt(3)
v_mfma_f32_16x16x32_bf16 v[160:163],a[120:123],v[20:23],v[160:163]
s_add_u32 m0,s24,0
ds_read_b128 a[4:7],v12 offset:0
v_fma_f32 v79,v79,s36,v13
v_mfma_f32_16x16x32_bf16 v[164:167],a[124:127],v[20:23],v[164:167]
ds_read_b128 a[12:15],v12 offset:128
v_fma_f32 v100,v100,s36,v16
v_mfma_f32_16x16x32_bf16 v[212:215],a[124:127],v[24:27],v[212:215]
ds_read_b128 a[20:23],v12 offset:256
v_fma_f32 v101,v101,s36,v16
v_mfma_f32_16x16x32_bf16 v[208:211],a[120:123],v[24:27],v[208:211]
ds_read_b128 a[8:11],v11 offset:128
v_fma_f32 v89,v89,s36,v15
v_mfma_f32_16x16x32_bf16 v[112:115],a[120:123],v[28:31],v[112:115]
ds_read_b128 a[0:3],v11 offset:0
v_fma_f32 v76,v76,s36,v13
v_mfma_f32_16x16x32_bf16 v[116:119],a[124:127],v[28:31],v[116:119]
ds_read_b128 a[16:19],v11 offset:256
v_fma_f32 v83,v83,s36,v14
v_mfma_f32_16x16x32_bf16 a[164:167],a[124:127],v[32:35],a[164:167]
ds_read_b64_tr_b16 a[138:139],v2 offset:30848
v_fma_f32 v90,v90,s36,v15
v_mfma_f32_16x16x32_bf16 a[160:163],a[120:123],v[32:35],a[160:163]
s_waitcnt lgkmcnt(6)
ds_read_b64_tr_b16 a[136:137],v2 offset:24704
v_fma_f32 v88,v88,s36,v15
v_mfma_f32_16x16x32_bf16 a[168:171],a[128:131],v[32:35],a[168:171]
ds_read_b64_tr_b16 a[142:143],v3 offset:30848
ds_read_b64_tr_b16 a[140:141],v3 offset:24704
ds_read_b64_tr_b16 a[146:147],v4 offset:30848
ds_read_b64_tr_b16 a[144:145],v4 offset:24704
ds_read_b64_tr_b16 a[150:151],v5 offset:30848
ds_read_b64_tr_b16 a[148:149],v5 offset:24704
ds_read_b128 a[32:35],v11 offset:6272
v_mfma_f32_16x16x32_bf16 a[172:175],a[132:135],v[32:35],a[172:175]
v_fma_f32 v91,v91,s36,v15
ds_read_b128 a[40:43],v11 offset:6400
v_mfma_f32_16x16x32_bf16 v[124:127],a[132:135],v[28:31],v[124:127]
s_waitcnt lgkmcnt(10)
buffer_load_dwordx4 v6,s[12:15],s28 offen offset:0 nt lds
v_mfma_f32_16x16x32_bf16 v[120:123],a[128:131],v[28:31],v[120:123]
ds_read_b64_tr_b16 a[122:123],v2 offset:30976
ds_read_b64_tr_b16 a[120:121],v2 offset:24832
ds_read_b64_tr_b16 a[124:125],v3 offset:24832
ds_read_b64_tr_b16 a[126:127],v3 offset:30976
ds_read_b128 a[44:47],v12 offset:6400
v_mfma_f32_16x16x32_bf16 v[216:219],a[128:131],v[24:27],v[216:219]
v_fma_f32 v93,v93,s36,v15
ds_read_b128 a[28:31],v12 offset:6144
v_mfma_f32_16x16x32_bf16 v[220:223],a[132:135],v[24:27],v[220:223]
v_fma_f32 v98,v98,s36,v16
ds_read_b128 a[36:39],v12 offset:6272
v_mfma_f32_16x16x32_bf16 v[172:175],a[132:135],v[20:23],v[172:175]
buffer_load_dwordx4 v7,s[12:15],s28 offen offset:1024 nt lds
v_mfma_f32_16x16x32_bf16 v[168:171],a[128:131],v[20:23],v[168:171]
s_waitcnt lgkmcnt(7)
ds_read_b64_tr_b16 a[130:131],v4 offset:30976
ds_read_b128 a[24:27],v11 offset:6144
v_mfma_f32_16x16x32_bf16 v[176:179],a[136:139],v[20:23],v[176:179]
v_fma_f32 v82,v82,s36,v14
v_exp_f32 v93,v93
v_mfma_f32_16x16x32_bf16 v[180:183],a[140:143],v[20:23],v[180:183]
ds_read_b64_tr_b16 a[128:129],v4 offset:24832
v_fma_f32 v85,v85,s36,v14
v_mfma_f32_16x16x32_bf16 v[228:231],a[140:143],v[24:27],v[228:231]
ds_read_b64_tr_b16 a[134:135],v5 offset:30976
v_exp_f32 v82,v82
v_mfma_f32_16x16x32_bf16 v[224:227],a[136:139],v[24:27],v[224:227]
ds_read_b64_tr_b16 a[132:133],v5 offset:24832
v_fma_f32 v84,v84,s36,v14
v_mfma_f32_16x16x32_bf16 v[128:131],a[136:139],v[28:31],v[128:131]
v_exp_f32 v84,v84
v_mfma_f32_16x16x32_bf16 v[132:135],a[140:143],v[28:31],v[132:135]
buffer_load_dwordx4 v8,s[12:15],s28 offen offset:2048 nt lds
v_mfma_f32_16x16x32_bf16 a[180:183],a[140:143],v[32:35],a[180:183]
s_add_u32 s28,s28,3072
v_fma_f32 v103,v103,s36,v16
v_exp_f32 v103,v103
v_mfma_f32_16x16x32_bf16 a[176:179],a[136:139],v[32:35],a[176:179]
s_add_u32 m0,s24,3072
v_fma_f32 v87,v87,s36,v14
v_exp_f32 v87,v87
v_mfma_f32_16x16x32_bf16 a[184:187],a[144:147],v[32:35],a[184:187]
v_fma_f32 v77,v77,s36,v13
v_exp_f32 v77,v77
v_mfma_f32_16x16x32_bf16 a[188:191],a[148:151],v[32:35],a[188:191]
v_fma_f32 v97,v97,s36,v16
v_exp_f32 v91,v91
v_mfma_f32_16x16x32_bf16 v[140:143],a[148:151],v[28:31],v[140:143]
v_fma_f32 v102,v102,s36,v16
v_exp_f32 v85,v85
v_mfma_f32_16x16x32_bf16 v[136:139],a[144:147],v[28:31],v[136:139]
v_exp_f32 v89,v89
v_mfma_f32_16x16x32_bf16 v[232:235],a[144:147],v[24:27],v[232:235]
buffer_load_dwordx4 v6,s[12:15],s28 offen offset:0 nt lds
v_mfma_f32_16x16x32_bf16 v[236:239],a[148:151],v[24:27],v[236:239]
v_fma_f32 v92,v92,s36,v15
v_exp_f32 v101,v101
v_mfma_f32_16x16x32_bf16 v[188:191],a[148:151],v[20:23],v[188:191]
v_fma_f32 v94,v94,s36,v15
v_fma_f32 v95,v95,s36,v15
v_mfma_f32_16x16x32_bf16 v[184:187],a[144:147],v[20:23],v[184:187]
s_waitcnt lgkmcnt(0)
v_exp_f32 v95,v95
v_mfma_f32_16x16x32_bf16 v[192:195],a[120:123],v[20:23],v[192:195]
v_fma_f32 v86,v86,s36,v14
v_fma_f32 v78,v78,s36,v13
v_mfma_f32_16x16x32_bf16 v[196:199],a[124:127],v[20:23],v[196:199]
v_exp_f32 v92,v92
v_mfma_f32_16x16x32_bf16 v[244:247],a[124:127],v[24:27],v[244:247]
v_exp_f32 v78,v78
v_mfma_f32_16x16x32_bf16 v[240:243],a[120:123],v[24:27],v[240:243]
buffer_load_dwordx4 v7,s[12:15],s28 offen offset:1024 nt lds
v_mfma_f32_16x16x32_bf16 v[144:147],a[120:123],v[28:31],v[144:147]
v_exp_f32 v94,v94
v_mfma_f32_16x16x32_bf16 v[148:151],a[124:127],v[28:31],v[148:151]
v_exp_f32 v90,v90
v_mfma_f32_16x16x32_bf16 a[196:199],a[124:127],v[32:35],a[196:199]
v_fma_f32 v96,v96,s36,v16
v_exp_f32 v96,v96
v_mfma_f32_16x16x32_bf16 a[192:195],a[120:123],v[32:35],a[192:195]
v_fma_f32 v99,v99,s36,v16
v_exp_f32 v83,v83
v_mfma_f32_16x16x32_bf16 a[200:203],a[128:131],v[32:35],a[200:203]
v_exp_f32 v97,v97
v_mfma_f32_16x16x32_bf16 a[204:207],a[132:135],v[32:35],a[204:207]
v_exp_f32 v88,v88
v_mfma_f32_16x16x32_bf16 v[156:159],a[132:135],v[28:31],v[156:159]
v_exp_f32 v98,v98
v_mfma_f32_16x16x32_bf16 v[152:155],a[128:131],v[28:31],v[152:155]
buffer_load_dwordx4 v8,s[12:15],s28 offen offset:2048 nt lds
s_waitcnt vmcnt(18)
s_barrier
v_mfma_f32_16x16x32_bf16 v[248:251],a[128:131],v[24:27],v[248:251]
s_add_u32 s28,s28,3072
ds_read_b64_tr_b16 a[138:139],v2 offset:6144
v_exp_f32 v79,v79
v_mfma_f32_16x16x32_bf16 v[252:255],a[132:135],v[24:27],v[252:255]
s_add_u32 m0,s22,0
ds_read_b64_tr_b16 a[136:137],v2 offset:0
buffer_load_dwordx4 v6,s[4:7],s25 offen offset:0 lds
v_mfma_f32_16x16x32_bf16 v[204:207],a[132:135],v[20:23],v[204:207]
buffer_load_dwordx4 v7,s[4:7],s25 offen offset:1024 lds
v_mfma_f32_16x16x32_bf16 v[200:203],a[128:131],v[20:23],v[200:203]
buffer_load_dwordx4 v8,s[4:7],s25 offen offset:2048 lds
ds_read_b64_tr_b16 a[142:143],v3 offset:6144
ds_read_b64_tr_b16 a[140:141],v3 offset:0
ds_read_b64_tr_b16 a[144:145],v4 offset:0
ds_read_b64_tr_b16 a[146:147],v4 offset:6144
ds_read_b64_tr_b16 a[148:149],v5 offset:0
ds_read_b64_tr_b16 a[150:151],v5 offset:6144
v_exp_f32 v100,v100
v_cvt_pk_bf16_f32 v47,v78,v79
v_cvt_pk_bf16_f32 v49,v82,v83
v_exp_f32 v76,v76
v_exp_f32 v102,v102
v_exp_f32 v86,v86
v_cvt_pk_bf16_f32 v59,v102,v103
v_exp_f32 v99,v99
v_cvt_pk_bf16_f32 v50,v84,v85
v_cvt_pk_bf16_f32 v57,v98,v99
v_cvt_pk_bf16_f32 v55,v94,v95
v_cvt_pk_bf16_f32 v54,v92,v93
v_cvt_pk_bf16_f32 v58,v100,v101
v_cvt_pk_bf16_f32 v51,v86,v87
v_cvt_pk_bf16_f32 v53,v90,v91
v_cvt_pk_bf16_f32 v46,v76,v77
v_cvt_pk_bf16_f32 v52,v88,v89
v_cvt_pk_bf16_f32 v56,v96,v97
v_smfmac_f32_16x16x64_bf16 v[60:63],a[152:155],v[44:51],v18
v_subrev_u32 v10,18432,v10
v_smfmac_f32_16x16x64_bf16 v[64:67],a[152:155],v[52:59],v18
s_waitcnt lgkmcnt(0)
v_mfma_f32_16x16x32_bf16 v[160:163],a[136:139],v[44:47],v[160:163]
s_add_u32 s87,s42,18432
ds_read_b64_tr_b16 a[120:121],v2 offset:128
v_mbcnt_lo_u32_b32 v39,-1,0
v_mfma_f32_16x16x32_bf16 v[164:167],a[140:143],v[44:47],v[164:167]
ds_read_b64_tr_b16 a[124:125],v3 offset:128
v_mbcnt_hi_u32_b32 v39,-1,v39
v_mfma_f32_16x16x32_bf16 v[212:215],a[140:143],v[48:51],v[212:215]
ds_read_b64_tr_b16 a[122:123],v2 offset:6272
v_lshrrev_b32 v19,5,v39
v_mfma_f32_16x16x32_bf16 v[208:211],a[136:139],v[48:51],v[208:211]
ds_read_b64_tr_b16 a[126:127],v3 offset:6272
v_and_b32 v38,7,v39
v_mfma_f32_16x16x32_bf16 v[112:115],a[136:139],v[52:55],v[112:115]
ds_read_b64_tr_b16 a[130:131],v4 offset:6272
v_xor_b32 v38,v38,v19
v_mfma_f32_16x16x32_bf16 v[116:119],a[140:143],v[52:55],v[116:119]
ds_read_b64_tr_b16 a[134:135],v5 offset:6272
v_and_b32 v19,15,v39
v_mfma_f32_16x16x32_bf16 a[164:167],a[140:143],v[56:59],a[164:167]
ds_read_b64_tr_b16 a[128:129],v4 offset:128
v_lshl_add_u32 v19,v19,7,s24
v_mfma_f32_16x16x32_bf16 a[160:163],a[136:139],v[56:59],a[160:163]
ds_read_b64_tr_b16 a[132:133],v5 offset:128
v_lshl_add_u32 v19,v38,4,v19
v_mfma_f32_16x16x32_bf16 a[168:171],a[144:147],v[56:59],a[168:171]
ds_read_b64_tr_b16 a[136:137],v2 offset:256
v_bfe_u32 v38,v39,4,1
v_mfma_f32_16x16x32_bf16 a[172:175],a[148:151],v[56:59],a[172:175]
ds_read_b64_tr_b16 a[140:141],v3 offset:256
v_lshl_add_u32 v36,v38,3,v19
v_mfma_f32_16x16x32_bf16 v[124:127],a[148:151],v[52:55],v[124:127]
ds_read_b64_tr_b16 a[142:143],v3 offset:6400
v_bfe_u32 v19,v39,3,1
v_mfma_f32_16x16x32_bf16 v[120:123],a[144:147],v[52:55],v[120:123]
ds_read_b64_tr_b16 a[138:139],v2 offset:6400
v_xor_b32 v37,32,v36
v_mfma_f32_16x16x32_bf16 v[216:219],a[144:147],v[48:51],v[216:219]
v_xor_b32 v38,64,v36
v_xor_b32 v39,96,v36
v_mfma_f32_16x16x32_bf16 v[220:223],a[148:151],v[48:51],v[220:223]
v_lshlrev_b32 v19,11,v19
v_accvgpr_read_b32 v80,a164
v_mfma_f32_16x16x32_bf16 v[172:175],a[148:151],v[44:47],v[172:175]
ds_read_b64_tr_b16 a[148:149],v5 offset:256
v_accvgpr_read_b32 v83,a167
v_mfma_f32_16x16x32_bf16 v[168:171],a[144:147],v[44:47],v[168:171]
s_waitcnt lgkmcnt(4)
ds_read_b64_tr_b16 a[146:147],v4 offset:6400
v_accvgpr_read_b32 v75,a163
v_mfma_f32_16x16x32_bf16 v[176:179],a[120:123],v[44:47],v[176:179]
ds_read_b64_tr_b16 a[144:145],v4 offset:256
v_accvgpr_read_b32 v81,a165
v_mfma_f32_16x16x32_bf16 v[180:183],a[124:127],v[44:47],v[180:183]
ds_read_b64_tr_b16 a[150:151],v5 offset:6400
v_add_f32 v66,v66,v67
v_mfma_f32_16x16x32_bf16 v[228:231],a[124:127],v[48:51],v[228:231]
v_accvgpr_read_b32 v91,a171
v_accvgpr_read_b32 v82,a166
v_mfma_f32_16x16x32_bf16 v[224:227],a[120:123],v[48:51],v[224:227]
v_accvgpr_read_b32 v74,a162
v_accvgpr_read_b32 v73,a161
v_mfma_f32_16x16x32_bf16 v[128:131],a[120:123],v[52:55],v[128:131]
v_accvgpr_read_b32 v90,a170
v_accvgpr_read_b32 v97,a173
v_mfma_f32_16x16x32_bf16 v[132:135],a[124:127],v[52:55],v[132:135]
v_rcp_f32 v66,v66
v_mfma_f32_16x16x32_bf16 a[180:183],a[124:127],v[56:59],a[180:183]
v_add_f32 v64,v64,v65
v_accvgpr_read_b32 v89,a169
v_mfma_f32_16x16x32_bf16 a[176:179],a[120:123],v[56:59],a[176:179]
v_accvgpr_read_b32 v72,a160
v_accvgpr_read_b32 v88,a168
v_mfma_f32_16x16x32_bf16 a[184:187],a[128:131],v[56:59],a[184:187]
v_accvgpr_read_b32 v96,a172
v_rcp_f32 v64,v64
v_mfma_f32_16x16x32_bf16 a[188:191],a[132:135],v[56:59],a[188:191]
v_accvgpr_read_b32 v85,a181
v_accvgpr_read_b32 v86,a182
v_mfma_f32_16x16x32_bf16 v[140:143],a[132:135],v[52:55],v[140:143]
v_accvgpr_read_b32 v76,a176
v_accvgpr_read_b32 v78,a178
v_accvgpr_read_b32 v77,a177
v_accvgpr_read_b32 v95,a187
v_accvgpr_read_b32 v93,a185
v_pk_mul_f32 v[80:81],v[80:81],v[66:67] op_sel_hi:[1,0]
v_pk_mul_f32 v[76:77],v[76:77],v[66:67] op_sel_hi:[1,0]
v_pk_mul_f32 v[74:75],v[74:75],v[66:67] op_sel_hi:[1,0]
v_pk_mul_f32 v[72:73],v[72:73],v[66:67] op_sel_hi:[1,0]
v_pk_mul_f32 v[82:83],v[82:83],v[66:67] op_sel_hi:[1,0]
v_accvgpr_read_b32 v84,a180
v_pk_mul_f32 v[84:85],v[84:85],v[66:67] op_sel_hi:[1,0]
v_accvgpr_read_b32 v103,a191
v_accvgpr_read_b32 v79,a179
v_pk_mul_f32 v[78:79],v[78:79],v[66:67] op_sel_hi:[1,0]
v_accvgpr_read_b32 v92,a184
v_accvgpr_read_b32 v94,a186
v_accvgpr_read_b32 v87,a183
v_pk_mul_f32 v[86:87],v[86:87],v[66:67] op_sel_hi:[1,0]
v_accvgpr_read_b32 v100,a188
v_accvgpr_read_b32 v101,a189
v_mfma_f32_16x16x32_bf16 v[136:139],a[128:131],v[52:55],v[136:139]
v_accvgpr_read_b32 v102,a190
v_accvgpr_read_b32 v98,a174
v_accvgpr_read_b32 v99,a175
v_add_f32 v60,v60,v61
v_rcp_f32 v60,v60
v_pk_mul_f32 v[90:91],v[90:91],v[66:67] op_sel_hi:[1,0]
v_pk_mul_f32 v[92:93],v[92:93],v[66:67] op_sel_hi:[1,0]
v_pk_mul_f32 v[94:95],v[94:95],v[66:67] op_sel_hi:[1,0]
v_pk_mul_f32 v[88:89],v[88:89],v[66:67] op_sel_hi:[1,0]
v_add_f32 v62,v62,v63
v_rcp_f32 v62,v62
v_mfma_f32_16x16x32_bf16 v[232:235],a[128:131],v[48:51],v[232:235]
v_min3_f32 v61,v60,v62,v64
v_cvt_pk_bf16_f32 v84,v84,v85
v_min_f32 v61,v61,v66
v_cmp_nlt_f32 vcc,s37,v61
v_cvt_pk_bf16_f32 v80,v80,v81
v_pk_mul_f32 v[118:119],v[118:119],v[64:65] op_sel_hi:[1,0]
v_pk_mul_f32 v[98:99],v[98:99],v[66:67] op_sel_hi:[1,0]
v_pk_mul_f32 v[116:117],v[116:117],v[64:65] op_sel_hi:[1,0]
v_pk_mul_f32 v[96:97],v[96:97],v[66:67] op_sel_hi:[1,0]
v_pk_mul_f32 v[132:133],v[132:133],v[64:65] op_sel_hi:[1,0]
v_pk_mul_f32 v[128:129],v[128:129],v[64:65] op_sel_hi:[1,0]
v_pk_mul_f32 v[114:115],v[114:115],v[64:65] op_sel_hi:[1,0]
v_pk_mul_f32 v[130:131],v[130:131],v[64:65] op_sel_hi:[1,0]
v_pk_mul_f32 v[134:135],v[134:135],v[64:65] op_sel_hi:[1,0]
v_pk_mul_f32 v[102:103],v[102:103],v[66:67] op_sel_hi:[1,0]
v_pk_mul_f32 v[112:113],v[112:113],v[64:65] op_sel_hi:[1,0]
v_pk_mul_f32 v[100:101],v[100:101],v[66:67] op_sel_hi:[1,0]
v_cvt_pk_bf16_f32 v96,v96,v97
v_cvt_pk_bf16_f32 v81,v82,v83
v_mfma_f32_16x16x32_bf16 v[236:239],a[132:135],v[48:51],v[236:239]
s_cmp_lg_u64 vcc,0
v_cvt_pk_bf16_f32 v72,v72,v73
v_cvt_pk_bf16_f32 v100,v100,v101
v_mfma_f32_16x16x32_bf16 v[188:191],a[132:135],v[44:47],v[188:191]
s_cselect_b32 s62,s32,0
v_cvt_pk_bf16_f32 v101,v102,v103
v_cvt_pk_bf16_f32 v85,v86,v87
v_cvt_pk_bf16_f32 v76,v76,v77
v_cvt_pk_bf16_f32 v77,v78,v79
v_cvt_pk_bf16_f32 v73,v74,v75
ds_write2st64_b64 v36,v[72:73],v[76:77] offset0:36 offset1:40
v_pk_mul_f32 v[136:137],v[136:137],v[64:65] op_sel_hi:[1,0]
v_pk_mul_f32 v[122:123],v[122:123],v[64:65] op_sel_hi:[1,0]
v_pk_mul_f32 v[138:139],v[138:139],v[64:65] op_sel_hi:[1,0]
v_pk_mul_f32 v[120:121],v[120:121],v[64:65] op_sel_hi:[1,0]
v_add_u32 v36,v36,v19
v_cvt_pk_bf16_f32 v92,v92,v93
v_mfma_f32_16x16x32_bf16 v[184:187],a[128:131],v[44:47],v[184:187]
s_or_b32 s31,s31,s62
v_cvt_pk_bf16_f32 v93,v94,v95
v_cvt_pk_bf16_f32 v88,v88,v89
s_waitcnt lgkmcnt(1)
v_mfma_f32_16x16x32_bf16 v[192:195],a[136:139],v[44:47],v[192:195]
s_lshl_b32 s32,s32,1
v_cvt_pk_bf16_f32 v89,v90,v91
v_cvt_pk_bf16_f32 v97,v98,v99
v_mfma_f32_16x16x32_bf16 v[196:199],a[140:143],v[44:47],v[196:199]
s_add_u32 m0,s24,6144
ds_write2st64_b64 v37,v[80:81],v[84:85] offset0:36 offset1:40
v_pk_mul_f32 v[140:141],v[140:141],v[64:65] op_sel_hi:[1,0]
v_pk_mul_f32 v[124:125],v[124:125],v[64:65] op_sel_hi:[1,0]
v_pk_mul_f32 v[126:127],v[126:127],v[64:65] op_sel_hi:[1,0]
buffer_load_dwordx4 v6,s[12:15],s28 offen offset:0 nt lds
buffer_load_dwordx4 v7,s[12:15],s28 offen offset:1024 nt lds
ds_write2st64_b64 v38,v[88:89],v[92:93] offset0:36 offset1:40
v_pk_mul_f32 v[142:143],v[142:143],v[64:65] op_sel_hi:[1,0]
v_add_u32 v37,v37,v19
v_add_u32 v38,v38,v19
v_mfma_f32_16x16x32_bf16 v[244:247],a[140:143],v[48:51],v[244:247]
buffer_load_dwordx4 v8,s[12:15],s28 offen offset:2048 nt lds
v_mfma_f32_16x16x32_bf16 v[240:243],a[136:139],v[48:51],v[240:243]
s_add_u32 s28,s28,3072
v_cvt_pk_bf16_f32 v112,v112,v113
v_cvt_pk_bf16_f32 v132,v132,v133
v_mfma_f32_16x16x32_bf16 v[144:147],a[136:139],v[52:55],v[144:147]
s_add_u32 m0,s24,9216
ds_write2st64_b64 v39,v[96:97],v[100:101] offset0:36 offset1:40
v_mfma_f32_16x16x32_bf16 v[148:151],a[140:143],v[52:55],v[148:151]
v_add_u32 v39,v39,v19
v_cvt_pk_bf16_f32 v136,v136,v137
v_mfma_f32_16x16x32_bf16 a[196:199],a[140:143],v[56:59],a[196:199]
buffer_load_dwordx4 v6,s[12:15],s28 offen offset:0 nt lds
v_mfma_f32_16x16x32_bf16 a[192:195],a[136:139],v[56:59],a[192:195]
buffer_load_dwordx4 v7,s[12:15],s28 offen offset:1024 nt lds
v_mfma_f32_16x16x32_bf16 a[200:203],a[144:147],v[56:59],a[200:203]
buffer_load_dwordx4 v8,s[12:15],s28 offen offset:2048 nt lds
v_mfma_f32_16x16x32_bf16 a[204:207],a[148:151],v[56:59],a[204:207]
s_waitcnt vmcnt(21)
ds_read_b128 a[48:51],v11 offset:12288
v_accvgpr_read_b32 v86,a198
v_mfma_f32_16x16x32_bf16 v[156:159],a[148:151],v[52:55],v[156:159]
s_add_u32 s28,s28,3072
ds_read_b128 a[60:63],v12 offset:12416
v_accvgpr_read_b32 v83,a195
ds_read_b128 a[52:55],v12 offset:12288
v_accvgpr_read_b32 v84,a196
ds_read_b128 a[56:59],v11 offset:12416
v_accvgpr_read_b32 v87,a199
ds_read_b128 a[64:67],v11 offset:12544
v_pk_mul_f32 v[86:87],v[86:87],v[66:67] op_sel_hi:[1,0]
ds_read_b128 a[68:71],v12 offset:12544
v_accvgpr_read_b32 v85,a197
ds_read_b128 v[104:107],v10 offset:18432
v_pk_mul_f32 v[84:85],v[84:85],v[66:67] op_sel_hi:[1,0]
ds_read_b128 v[108:111],v10 offset:19456
v_accvgpr_read_b32 v80,a192
ds_read_b128 v[72:75],v10 offset:20480
v_accvgpr_read_b32 v82,a194
ds_read_b128 v[76:79],v10 offset:21504
v_pk_mul_f32 v[82:83],v[82:83],v[66:67] op_sel_hi:[1,0]
v_accvgpr_read_b32 v81,a193
v_pk_mul_f32 v[80:81],v[80:81],v[66:67] op_sel_hi:[1,0]
v_accvgpr_read_b32 v91,a203
v_accvgpr_read_b32 v89,a201
v_mfma_f32_16x16x32_bf16 v[152:155],a[144:147],v[52:55],v[152:155]
s_add_u32 m0,s23,0
v_accvgpr_read_b32 v90,a202
v_accvgpr_read_b32 v88,a200
v_mfma_f32_16x16x32_bf16 v[248:251],a[144:147],v[48:51],v[248:251]
v_accvgpr_read_b32 v92,a204
v_accvgpr_read_b32 v93,a205
v_accvgpr_read_b32 v95,a207
v_accvgpr_read_b32 v94,a206
s_waitcnt lgkmcnt(3)
buffer_store_dwordx4 v[104:107],v9,s[16:19],s87 offen offset:0 nt
v_pk_mul_f32 v[88:89],v[88:89],v[66:67] op_sel_hi:[1,0]
v_pk_mul_f32 v[90:91],v[90:91],v[66:67] op_sel_hi:[1,0]
v_cvt_pk_bf16_f32 v128,v128,v129
v_cvt_pk_bf16_f32 v129,v130,v131
v_mfma_f32_16x16x32_bf16 v[252:255],a[148:151],v[48:51],v[252:255]
v_cvt_pk_bf16_f32 v133,v134,v135
v_cvt_pk_bf16_f32 v140,v140,v141
v_mfma_f32_16x16x32_bf16 v[204:207],a[148:151],v[44:47],v[204:207]
v_cvt_pk_bf16_f32 v113,v114,v115
v_cvt_pk_bf16_f32 v141,v142,v143
v_mfma_f32_16x16x32_bf16 v[200:203],a[144:147],v[44:47],v[200:203]
ds_write2st64_b64 v36,v[112:113],v[128:129] offset0:24 offset1:26
v_sub_u32 v36,v36,v19
v_cvt_pk_bf16_f32 v80,v80,v81
v_cvt_pk_bf16_f32 v81,v82,v83
s_waitcnt lgkmcnt(1)
buffer_store_dwordx4 v[108:111],v9,s[16:19],s87 offen offset:3072 nt
v_cvt_pk_bf16_f32 v124,v124,v125
v_cvt_pk_bf16_f32 v120,v120,v121
v_cvt_pk_bf16_f32 v121,v122,v123
v_cvt_pk_bf16_f32 v116,v116,v117
v_cvt_pk_bf16_f32 v117,v118,v119
v_cvt_pk_bf16_f32 v137,v138,v139
v_cvt_pk_bf16_f32 v125,v126,v127
v_cvt_pk_bf16_f32 v88,v88,v89
v_cvt_pk_bf16_f32 v89,v90,v91
ds_write2st64_b64 v37,v[116:117],v[132:133] offset0:24 offset1:26
v_sub_u32 v37,v37,v19
v_cvt_pk_bf16_f32 v84,v84,v85
v_cvt_pk_bf16_f32 v85,v86,v87
buffer_store_dwordx4 v[72:75],v9,s[16:19],s87 offen offset:128 nt
v_mov_b32 v63,0
v_mov_b32 v65,0
v_mov_b32 v70,0
v_mov_b32 v67,0
v_mov_b32 v69,0
v_mov_b32 v71,0
v_mov_b32 v61,0
v_mov_b32 v68,0
s_waitcnt vmcnt(9)
s_barrier
ds_write2st64_b64 v38,v[120:121],v[136:137] offset0:24 offset1:26
v_sub_u32 v38,v38,v19
ds_read_b128 a[120:123],v0 offset:0
buffer_store_dwordx4 v[76:79],v9,s[16:19],s87 offen offset:3200 nt
ds_read_b128 a[124:127],v1 offset:0
ds_read_b128 a[128:131],v0 offset:128
ds_read_b128 a[136:139],v0 offset:256
buffer_load_dwordx4 v6,s[8:11],s25 offen offset:0 lds
ds_write2st64_b64 v39,v[124:125],v[140:141] offset0:24 offset1:26
v_sub_u32 v39,v39,v19
ds_read_b128 a[132:135],v1 offset:128
s_waitcnt lgkmcnt(5)
v_mfma_f32_16x16x32_bf16 v[72:75],a[120:123],a[0:3],0
ds_read_b128 a[140:143],v1 offset:256
ds_write_b64 v36,v[80:81] offset:18432
ds_read_b128 a[144:147],v0 offset:6144
buffer_load_dwordx4 v7,s[8:11],s25 offen offset:1024 lds
ds_write_b64 v37,v[84:85] offset:18432
ds_read_b128 a[148:151],v1 offset:6144
v_pk_mul_f32 v[92:93],v[92:93],v[66:67] op_sel_hi:[1,0]
ds_write_b64 v38,v[88:89] offset:18432
v_pk_mul_f32 v[94:95],v[94:95],v[66:67] op_sel_hi:[1,0]
v_add_u32 v37,v37,v19
v_add_u32 v36,v36,v19
s_waitcnt lgkmcnt(6)
v_mfma_f32_16x16x32_bf16 v[72:75],a[124:127],a[4:7],v[72:75]
v_add_u32 v38,v38,v19
v_cvt_pk_bf16_f32 v92,v92,v93
v_mfma_f32_16x16x32_bf16 v[72:75],a[128:131],a[8:11],v[72:75]
v_cvt_pk_bf16_f32 v93,v94,v95
v_mov_b32 v66,0
v_mfma_f32_16x16x32_bf16 v[72:75],a[132:135],a[12:15],v[72:75]
ds_write_b64 v39,v[92:93] offset:18432
ds_read_b128 v[96:99],v10 offset:18432
buffer_load_dwordx4 v8,s[8:11],s25 offen offset:2048 lds
ds_read_b128 v[100:103],v10 offset:19456
v_pk_mul_f32 v[160:161],v[160:161],v[60:61] op_sel_hi:[1,0]
v_pk_mul_f32 v[144:145],v[144:145],v[64:65] op_sel_hi:[1,0]
v_pk_mul_f32 v[146:147],v[146:147],v[64:65] op_sel_hi:[1,0]
v_pk_mul_f32 v[162:163],v[162:163],v[60:61] op_sel_hi:[1,0]
v_add_u32 v39,v39,v19
v_cvt_pk_bf16_f32 v144,v144,v145
v_mfma_f32_16x16x32_bf16 v[72:75],a[136:139],a[16:19],v[72:75]
s_waitcnt vmcnt(16)
ds_read_b128 a[92:95],v12 offset:256
v_cvt_pk_bf16_f32 v145,v146,v147
s_waitcnt lgkmcnt(4)
v_mfma_f32_16x16x32_bf16 v[72:75],a[140:143],a[20:23],v[72:75]
s_mov_b32 s27,s42
ds_read_b128 a[88:91],v11 offset:256
v_cvt_pk_bf16_f32 v160,v160,v161
v_mfma_f32_16x16x32_bf16 v[80:83],a[140:143],a[44:47],0
s_mov_b32 s42,s41
ds_read_b128 a[80:83],v11 offset:128
v_cvt_pk_bf16_f32 v161,v162,v163
v_mfma_f32_16x16x32_bf16 v[80:83],a[136:139],a[40:43],v[80:83]
s_add_u32 s69,s69,1
ds_read_b128 a[84:87],v12 offset:128
v_max3_f32 v44,v72,v73,v74
ds_read_b128 a[76:79],v12 offset:0
s_waitcnt lgkmcnt(6)
buffer_store_dwordx4 v[96:99],v9,s[16:19],s87 offen offset:256 nt
ds_read_b128 a[72:75],v11 offset:0
v_pk_mul_f32 v[166:167],v[166:167],v[60:61] op_sel_hi:[1,0]
v_pk_mul_f32 v[164:165],v[164:165],v[60:61] op_sel_hi:[1,0]
v_pk_mul_f32 v[148:149],v[148:149],v[64:65] op_sel_hi:[1,0]
v_pk_mul_f32 v[150:151],v[150:151],v[64:65] op_sel_hi:[1,0]
v_max_f32 v44,v44,v75
v_mov_b32 v45,v44
v_mfma_f32_16x16x32_bf16 v[80:83],a[132:135],a[36:39],v[80:83]
s_lshl_b32 s62,s69,5
v_permlane32_swap_b32 v45,v44
v_mfma_f32_16x16x32_bf16 v[80:83],a[128:131],a[32:35],v[80:83]
s_add_u32 s62,s62,s34
ds_write2st64_b64 v36,v[144:145],v[160:161] offset0:28 offset1:0
v_mfma_f32_16x16x32_bf16 v[80:83],a[124:127],a[28:31],v[80:83]
s_mul_i32 s63,s62,171
v_max_f32 v44,v44,v45
v_mov_b32 v45,v44
v_mfma_f32_16x16x32_bf16 v[80:83],a[120:123],a[24:27],v[80:83]
s_lshr_b32 s63,s63,9
s_waitcnt lgkmcnt(3)
buffer_store_dwordx4 v[100:103],v9,s[16:19],s87 offen offset:3328 nt
v_permlane16_swap_b32 v45,v44
v_pk_mul_f32 v[154:155],v[154:155],v[64:65] op_sel_hi:[1,0]
v_pk_mul_f32 v[170:171],v[170:171],v[60:61] op_sel_hi:[1,0]
v_pk_mul_f32 v[168:169],v[168:169],v[60:61] op_sel_hi:[1,0]
v_pk_mul_f32 v[152:153],v[152:153],v[64:65] op_sel_hi:[1,0]
v_max_f32 v44,v44,v45
v_mul_f32_e64 v13,-s36,v44
v_mfma_f32_16x16x32_bf16 v[88:91],a[120:123],a[48:51],0
s_mul_i32 s64,s63,3
v_fma_f32 v74,v74,s36,v13
v_exp_f32 v74,v74
v_mfma_f32_16x16x32_bf16 v[88:91],a[124:127],a[52:55],v[88:91]
s_sub_u32 s62,s62,s64
v_fma_f32 v72,v72,s36,v13
v_fma_f32 v73,v73,s36,v13
v_mfma_f32_16x16x32_bf16 v[88:91],a[128:131],a[56:59],v[88:91]
s_add_u32 s63,s63,s33
v_exp_f32 v73,v73
v_mfma_f32_16x16x32_bf16 v[88:91],a[132:135],a[60:63],v[88:91]
s_mul_i32 s30,s63,196608
v_fma_f32 v75,v75,s36,v13
v_exp_f32 v75,v75
v_exp_f32 v72,v72
v_pk_mul_f32 v[158:159],v[158:159],v[64:65] op_sel_hi:[1,0]
v_pk_mul_f32 v[156:157],v[156:157],v[64:65] op_sel_hi:[1,0]
v_pk_mul_f32 v[174:175],v[174:175],v[60:61] op_sel_hi:[1,0]
v_pk_mul_f32 v[172:173],v[172:173],v[60:61] op_sel_hi:[1,0]
v_max3_f32 v48,v80,v81,v82
v_cvt_pk_bf16_f32 v20,v72,v73
v_mfma_f32_16x16x32_bf16 v[88:91],a[136:139],a[64:67],v[88:91]
s_mul_i32 s41,s63,325632
v_cvt_pk_bf16_f32 v21,v74,v75
v_max_f32 v48,v48,v83
v_mfma_f32_16x16x32_bf16 v[88:91],a[140:143],a[68:71],v[88:91]
s_lshl_b32 s63,s3,2
v_mov_b32 v49,v48
v_cvt_pk_bf16_f32 v156,v156,v157
v_mfma_f32_16x16x32_bf16 v[96:99],a[140:143],a[92:95],0
s_add_u32 s64,s63,21
v_permlane32_swap_b32 v49,v48
v_max_f32 v48,v48,v49
v_mov_b32 v49,v48
v_max3_f32 v52,v88,v89,v90
v_pk_mul_f32 v[192:193],v[192:193],v[60:61] op_sel_hi:[1,0]
v_pk_mul_f32 v[178:179],v[178:179],v[60:61] op_sel_hi:[1,0]
v_pk_mul_f32 v[194:195],v[194:195],v[60:61] op_sel_hi:[1,0]
v_pk_mul_f32 v[176:177],v[176:177],v[60:61] op_sel_hi:[1,0]
v_permlane16_swap_b32 v49,v48
v_max_f32 v48,v48,v49
v_mfma_f32_16x16x32_bf16 v[96:99],a[136:139],a[88:91],v[96:99]
s_waitcnt vmcnt(9)
ds_read_b128 a[96:99],v11 offset:6144
v_mul_f32_e64 v14,-s36,v48
v_mfma_f32_16x16x32_bf16 v[96:99],a[132:135],a[84:87],v[96:99]
s_cmp_eq_u32 s3,0
ds_read_b128 a[104:107],v11 offset:6272
v_fma_f32 v81,v81,s36,v14
v_mfma_f32_16x16x32_bf16 v[96:99],a[128:131],a[80:83],v[96:99]
s_cselect_b32 s64,20,s64
ds_read_b128 a[100:103],v12 offset:6144
v_fma_f32 v82,v82,s36,v14
s_waitcnt lgkmcnt(3)
v_mfma_f32_16x16x32_bf16 v[96:99],a[124:127],a[76:79],v[96:99]
s_cselect_b32 s40,1,0
ds_read_b128 a[108:111],v12 offset:6272
v_exp_f32 v82,v82
ds_read_b128 a[112:115],v11 offset:6400
v_pk_mul_f32 v[180:181],v[180:181],v[60:61] op_sel_hi:[1,0]
ds_read_b128 a[116:119],v12 offset:6400
v_pk_mul_f32 v[196:197],v[196:197],v[60:61] op_sel_hi:[1,0]
v_pk_mul_f32 v[198:199],v[198:199],v[60:61] op_sel_hi:[1,0]
v_pk_mul_f32 v[182:183],v[182:183],v[60:61] op_sel_hi:[1,0]
v_fma_f32 v80,v80,s36,v14
v_exp_f32 v80,v80
v_mfma_f32_16x16x32_bf16 v[96:99],a[120:123],a[72:75],v[96:99]
s_add_u32 s65,s63,37
v_fma_f32 v83,v83,s36,v14
v_exp_f32 v83,v83
s_waitcnt lgkmcnt(4)
v_mfma_f32_16x16x32_bf16 v[104:107],a[120:123],a[96:99],0
s_cmp_eq_u32 s62,2
ds_read_b128 a[120:123],v0 offset:6272
v_exp_f32 v81,v81
s_waitcnt lgkmcnt(4)
v_mfma_f32_16x16x32_bf16 v[104:107],a[124:127],a[100:103],v[104:107]
s_cselect_b32 s64,s65,s64
ds_read_b128 a[124:127],v1 offset:6272
v_cvt_pk_bf16_f32 v24,v80,v81
v_mfma_f32_16x16x32_bf16 v[104:107],a[128:131],a[104:107],v[104:107]
s_cselect_b32 s40,0,s40
ds_read_b128 a[128:131],v0 offset:6400
v_cvt_pk_bf16_f32 v25,v82,v83
v_max_f32 v52,v52,v91
v_mov_b32 v53,v52
v_max3_f32 v56,v96,v97,v98
v_pk_mul_f32 v[200:201],v[200:201],v[60:61] op_sel_hi:[1,0]
v_pk_mul_f32 v[202:203],v[202:203],v[60:61] op_sel_hi:[1,0]
v_pk_mul_f32 v[184:185],v[184:185],v[60:61] op_sel_hi:[1,0]
v_pk_mul_f32 v[186:187],v[186:187],v[60:61] op_sel_hi:[1,0]
v_permlane32_swap_b32 v53,v52
v_max_f32 v52,v52,v53
s_waitcnt lgkmcnt(3)
v_mfma_f32_16x16x32_bf16 v[104:107],a[132:135],a[108:111],v[104:107]
s_add_u32 s65,s63,s3
ds_read_b128 a[132:135],v1 offset:6400
v_mov_b32 v53,v52
v_mfma_f32_16x16x32_bf16 v[104:107],a[136:139],a[112:115],v[104:107]
s_cmp_eq_u32 s62,0
ds_read_b128 a[136:139],v0 offset:12288
v_permlane16_swap_b32 v53,v52
v_mfma_f32_16x16x32_bf16 v[104:107],a[140:143],a[116:119],v[104:107]
s_cselect_b32 s64,s65,s64
ds_read_b128 a[140:143],v1 offset:12288
v_max_f32 v52,v52,v53
v_mul_f32_e64 v15,-s36,v52
v_fma_f32 v90,v90,s36,v15
v_fma_f32 v89,v89,s36,v15
v_pk_mul_f32 v[188:189],v[188:189],v[60:61] op_sel_hi:[1,0]
v_pk_mul_f32 v[190:191],v[190:191],v[60:61] op_sel_hi:[1,0]
v_pk_mul_f32 v[204:205],v[204:205],v[60:61] op_sel_hi:[1,0]
v_pk_mul_f32 v[206:207],v[206:207],v[60:61] op_sel_hi:[1,0]
v_fma_f32 v91,v91,s36,v15
v_exp_f32 v90,v90
v_mfma_f32_16x16x32_bf16 v[76:79],a[144:147],a[0:3],0
s_cselect_b32 s40,1,s40
v_fma_f32 v88,v88,s36,v15
v_exp_f32 v88,v88
v_mfma_f32_16x16x32_bf16 v[76:79],a[148:151],a[4:7],v[76:79]
s_mul_i32 s64,s64,6144
v_exp_f32 v89,v89
s_waitcnt lgkmcnt(2)
v_mfma_f32_16x16x32_bf16 v[76:79],a[120:123],a[8:11],v[76:79]
s_add_u32 s41,s41,s64
v_cvt_pk_bf16_f32 v28,v88,v89
v_exp_f32 v91,v91
v_mfma_f32_16x16x32_bf16 v[76:79],a[124:127],a[12:15],v[76:79]
s_cmp_ge_u32 s69,6
v_cvt_pk_bf16_f32 v29,v90,v91
v_max_f32 v56,v56,v99
v_mov_b32 v57,v56
v_cvt_pk_bf16_f32 v200,v200,v201
v_cvt_pk_bf16_f32 v164,v164,v165
v_pk_mul_f32 v[208:209],v[208:209],v[62:63] op_sel_hi:[1,0]
v_pk_mul_f32 v[210:211],v[210:211],v[62:63] op_sel_hi:[1,0]
v_pk_mul_f32 v[226:227],v[226:227],v[62:63] op_sel_hi:[1,0]
v_pk_mul_f32 v[224:225],v[224:225],v[62:63] op_sel_hi:[1,0]
v_permlane32_swap_b32 v57,v56
v_max_f32 v56,v56,v57
v_mfma_f32_16x16x32_bf16 v[76:79],a[128:131],a[16:19],v[76:79]
s_cselect_b32 s41,166723584,s41
v_mov_b32 v57,v56
v_cvt_pk_bf16_f32 v165,v166,v167
v_mfma_f32_16x16x32_bf16 v[76:79],a[132:135],a[20:23],v[76:79]
s_cselect_b32 s30,100663296,s30
v_permlane16_swap_b32 v57,v56
v_mfma_f32_16x16x32_bf16 v[84:87],a[132:135],a[44:47],0
s_add_u32 s25,s30,s22
v_max_f32 v56,v56,v57
v_mul_f32_e64 v16,-s36,v56
v_mfma_f32_16x16x32_bf16 v[84:87],a[128:131],a[40:43],v[84:87]
s_add_u32 s26,s25,12288
v_fma_f32 v96,v96,s36,v16
v_exp_f32 v96,v96
v_fma_f32 v98,v98,s36,v16
v_fma_f32 v99,v99,s36,v16
v_pk_mul_f32 v[228:229],v[228:229],v[62:63] op_sel_hi:[1,0]
v_pk_mul_f32 v[214:215],v[214:215],v[62:63] op_sel_hi:[1,0]
v_pk_mul_f32 v[230:231],v[230:231],v[62:63] op_sel_hi:[1,0]
v_pk_mul_f32 v[212:213],v[212:213],v[62:63] op_sel_hi:[1,0]
v_exp_f32 v99,v99
v_exp_f32 v98,v98
v_mfma_f32_16x16x32_bf16 v[84:87],a[124:127],a[36:39],v[84:87]
s_add_u32 m0,s23,24576
v_cvt_pk_bf16_f32 v33,v98,v99
v_fma_f32 v97,v97,s36,v16
v_mfma_f32_16x16x32_bf16 v[84:87],a[120:123],a[32:35],v[84:87]
s_mov_b32 s28,s41
v_exp_f32 v97,v97
v_mfma_f32_16x16x32_bf16 v[84:87],a[148:151],a[28:31],v[84:87]
s_mov_b32 s29,s24
buffer_load_dwordx4 v6,s[8:11],s21 offen offset:0 lds
buffer_load_dwordx4 v7,s[8:11],s21 offen offset:1024 lds
v_pk_mul_f32 v[216:217],v[216:217],v[62:63] op_sel_hi:[1,0]
v_pk_mul_f32 v[232:233],v[232:233],v[62:63] op_sel_hi:[1,0]
v_pk_mul_f32 v[218:219],v[218:219],v[62:63] op_sel_hi:[1,0]
v_pk_mul_f32 v[234:235],v[234:235],v[62:63] op_sel_hi:[1,0]
v_cvt_pk_bf16_f32 v32,v96,v97
v_cvt_pk_bf16_f32 v172,v172,v173
v_mfma_f32_16x16x32_bf16 v[84:87],a[144:147],a[24:27],v[84:87]
v_cvt_pk_bf16_f32 v173,v174,v175
v_cvt_pk_bf16_f32 v168,v168,v169
v_mfma_f32_16x16x32_bf16 v[92:95],a[144:147],a[48:51],0
v_cvt_pk_bf16_f32 v204,v204,v205
v_cvt_pk_bf16_f32 v205,v206,v207
v_mfma_f32_16x16x32_bf16 v[92:95],a[148:151],a[52:55],v[92:95]
buffer_load_dwordx4 v8,s[8:11],s21 offen offset:2048 lds
v_mfma_f32_16x16x32_bf16 v[92:95],a[120:123],a[56:59],v[92:95]
s_add_u32 s21,s21,12288
v_cvt_pk_bf16_f32 v196,v196,v197
v_cvt_pk_bf16_f32 v228,v228,v229
v_cvt_pk_bf16_f32 v208,v208,v209
v_cvt_pk_bf16_f32 v192,v192,v193
v_cvt_pk_bf16_f32 v148,v148,v149
v_pk_mul_f32 v[238:239],v[238:239],v[62:63] op_sel_hi:[1,0]
v_pk_mul_f32 v[236:237],v[236:237],v[62:63] op_sel_hi:[1,0]
v_pk_mul_f32 v[220:221],v[220:221],v[62:63] op_sel_hi:[1,0]
v_pk_mul_f32 v[222:223],v[222:223],v[62:63] op_sel_hi:[1,0]
v_cvt_pk_bf16_f32 v149,v150,v151
v_cvt_pk_bf16_f32 v180,v180,v181
v_mfma_f32_16x16x32_bf16 v[92:95],a[124:127],a[60:63],v[92:95]
s_add_u32 m0,s22,0
ds_write2st64_b64 v37,v[148:149],v[164:165] offset0:28 offset1:0
v_mfma_f32_16x16x32_bf16 v[92:95],a[128:131],a[64:67],v[92:95]
v_cvt_pk_bf16_f32 v181,v182,v183
v_cvt_pk_bf16_f32 v152,v152,v153
v_mfma_f32_16x16x32_bf16 v[92:95],a[132:135],a[68:71],v[92:95]
v_cvt_pk_bf16_f32 v153,v154,v155
v_cvt_pk_bf16_f32 v157,v158,v159
v_mfma_f32_16x16x32_bf16 v[100:103],a[132:135],a[92:95],0
v_cvt_pk_bf16_f32 v229,v230,v231
v_cvt_pk_bf16_f32 v224,v224,v225
v_max3_f32 v40,v104,v105,v106
v_max_f32 v40,v40,v107
v_mov_b32 v41,v40
v_pk_mul_f32 v[240:241],v[240:241],v[62:63] op_sel_hi:[1,0]
v_pk_mul_f32 v[242:243],v[242:243],v[62:63] op_sel_hi:[1,0]
v_cvt_pk_bf16_f32 v169,v170,v171
v_cvt_pk_bf16_f32 v236,v236,v237
v_mfma_f32_16x16x32_bf16 v[100:103],a[128:131],a[88:91],v[100:103]
ds_write2st64_b64 v38,v[152:153],v[168:169] offset0:28 offset1:0
v_mfma_f32_16x16x32_bf16 v[100:103],a[124:127],a[84:87],v[100:103]
v_cvt_pk_bf16_f32 v201,v202,v203
v_cvt_pk_bf16_f32 v188,v188,v189
v_mfma_f32_16x16x32_bf16 v[100:103],a[120:123],a[80:83],v[100:103]
v_cvt_pk_bf16_f32 v189,v190,v191
v_cvt_pk_bf16_f32 v184,v184,v185
v_mfma_f32_16x16x32_bf16 v[100:103],a[148:151],a[76:79],v[100:103]
v_cvt_pk_bf16_f32 v216,v216,v217
ds_write2st64_b64 v39,v[156:157],v[172:173] offset0:28 offset1:0
v_pk_mul_f32 v[244:245],v[244:245],v[62:63] op_sel_hi:[1,0]
v_pk_mul_f32 v[246:247],v[246:247],v[62:63] op_sel_hi:[1,0]
v_cvt_pk_bf16_f32 v232,v232,v233
v_cvt_pk_bf16_f32 v185,v186,v187
v_mfma_f32_16x16x32_bf16 v[100:103],a[144:147],a[72:75],v[100:103]
v_cvt_pk_bf16_f32 v193,v194,v195
v_cvt_pk_bf16_f32 v220,v220,v221
v_mfma_f32_16x16x32_bf16 v[108:111],a[144:147],a[96:99],0
ds_read_b128 a[144:147],v0 offset:12416
v_cvt_pk_bf16_f32 v225,v226,v227
v_mfma_f32_16x16x32_bf16 v[108:111],a[148:151],a[100:103],v[108:111]
ds_read_b128 a[148:151],v1 offset:12416
v_cvt_pk_bf16_f32 v176,v176,v177
v_cvt_pk_bf16_f32 v177,v178,v179
ds_write2st64_b64 v36,v[176:177],v[192:193] offset0:2 offset1:4
v_pk_mul_f32 v[250:251],v[250:251],v[62:63] op_sel_hi:[1,0]
v_pk_mul_f32 v[248:249],v[248:249],v[62:63] op_sel_hi:[1,0]
v_cvt_pk_bf16_f32 v240,v240,v241
v_cvt_pk_bf16_f32 v241,v242,v243
v_mfma_f32_16x16x32_bf16 v[108:111],a[120:123],a[104:107],v[108:111]
ds_read_b128 a[120:123],v0 offset:12544
v_permlane32_swap_b32 v41,v40
v_mfma_f32_16x16x32_bf16 v[108:111],a[124:127],a[108:111],v[108:111]
ds_read_b128 a[124:127],v1 offset:12544
v_max_f32 v40,v40,v41
v_mfma_f32_16x16x32_bf16 v[108:111],a[128:131],a[112:115],v[108:111]
ds_read_b128 a[128:131],v0 offset:18432
v_mov_b32 v41,v40
v_mfma_f32_16x16x32_bf16 v[108:111],a[132:135],a[116:119],v[108:111]
ds_read_b128 a[132:135],v1 offset:18432
v_permlane16_swap_b32 v41,v40
v_cvt_pk_bf16_f32 v209,v210,v211
v_cvt_pk_bf16_f32 v197,v198,v199
ds_write2st64_b64 v37,v[180:181],v[196:197] offset0:2 offset1:4
v_pk_mul_f32 v[252:253],v[252:253],v[62:63] op_sel_hi:[1,0]
v_pk_mul_f32 v[254:255],v[254:255],v[62:63] op_sel_hi:[1,0]
v_cvt_pk_bf16_f32 v244,v244,v245
v_cvt_pk_bf16_f32 v245,v246,v247
s_waitcnt lgkmcnt(5)
v_mfma_f32_16x16x32_bf16 v[72:75],a[136:139],a[0:3],0
v_cvt_pk_bf16_f32 v233,v234,v235
v_cvt_pk_bf16_f32 v237,v238,v239
v_mfma_f32_16x16x32_bf16 v[72:75],a[140:143],a[4:7],v[72:75]
v_cvt_pk_bf16_f32 v212,v212,v213
v_cvt_pk_bf16_f32 v213,v214,v215
v_mfma_f32_16x16x32_bf16 v[72:75],a[144:147],a[8:11],v[72:75]
ds_write2st64_b64 v38,v[184:185],v[200:201] offset0:2 offset1:4
v_mfma_f32_16x16x32_bf16 v[72:75],a[148:151],a[12:15],v[72:75]
s_waitcnt lgkmcnt(2)
v_cvt_pk_bf16_f32 v221,v222,v223
v_max_f32 v40,v40,v41
v_mfma_f32_16x16x32_bf16 v[72:75],a[120:123],a[16:19],v[72:75]
v_mul_f32_e64 v17,-s36,v40
v_fma_f32 v106,v106,s36,v17
v_mfma_f32_16x16x32_bf16 v[72:75],a[124:127],a[20:23],v[72:75]
v_fma_f32 v107,v107,s36,v17
v_exp_f32 v107,v107
v_mfma_f32_16x16x32_bf16 v[80:83],a[124:127],a[44:47],0
ds_write2st64_b64 v39,v[188:189],v[204:205] offset0:2 offset1:4
v_mfma_f32_16x16x32_bf16 v[80:83],a[120:123],a[40:43],v[80:83]
v_fma_f32 v105,v105,s36,v17
v_exp_f32 v105,v105
v_mfma_f32_16x16x32_bf16 v[80:83],a[148:151],a[36:39],v[80:83]
v_fma_f32 v104,v104,s36,v17
v_exp_f32 v104,v104
v_mfma_f32_16x16x32_bf16 v[80:83],a[144:147],a[32:35],v[80:83]
v_cvt_pk_bf16_f32 v217,v218,v219
v_exp_f32 v106,v106
v_mfma_f32_16x16x32_bf16 v[80:83],a[140:143],a[28:31],v[80:83]
ds_write2st64_b64 v36,v[208:209],v[224:225] offset0:12 offset1:14
v_mfma_f32_16x16x32_bf16 v[80:83],a[136:139],a[24:27],v[80:83]
v_fma_f32 v78,v78,s36,v13
v_fma_f32 v76,v76,s36,v13
v_mfma_f32_16x16x32_bf16 v[88:91],a[136:139],a[48:51],0
v_exp_f32 v76,v76
v_mfma_f32_16x16x32_bf16 v[88:91],a[140:143],a[52:55],v[88:91]
v_fma_f32 v79,v79,s36,v13
v_exp_f32 v79,v79
v_mfma_f32_16x16x32_bf16 v[88:91],a[144:147],a[56:59],v[88:91]
ds_write2st64_b64 v37,v[212:213],v[228:229] offset0:12 offset1:14
v_mfma_f32_16x16x32_bf16 v[88:91],a[148:151],a[60:63],v[88:91]
v_exp_f32 v78,v78
v_mfma_f32_16x16x32_bf16 v[88:91],a[120:123],a[64:67],v[88:91]
v_cvt_pk_bf16_f32 v23,v78,v79
v_fma_f32 v77,v77,s36,v13
v_mfma_f32_16x16x32_bf16 v[88:91],a[124:127],a[68:71],v[88:91]
v_exp_f32 v77,v77
v_mfma_f32_16x16x32_bf16 v[96:99],a[124:127],a[92:95],0
ds_write2st64_b64 v38,v[216:217],v[232:233] offset0:12 offset1:14
v_mfma_f32_16x16x32_bf16 v[96:99],a[120:123],a[88:91],v[96:99]
v_cvt_pk_bf16_f32 v22,v76,v77
v_fma_f32 v84,v84,s36,v14
v_mfma_f32_16x16x32_bf16 v[96:99],a[148:151],a[84:87],v[96:99]
v_fma_f32 v85,v85,s36,v14
v_fma_f32 v86,v86,s36,v14
v_mfma_f32_16x16x32_bf16 v[96:99],a[144:147],a[80:83],v[96:99]
v_exp_f32 v86,v86
v_mfma_f32_16x16x32_bf16 v[96:99],a[140:143],a[76:79],v[96:99]
ds_write2st64_b64 v39,v[220:221],v[236:237] offset0:12 offset1:14
v_mfma_f32_16x16x32_bf16 v[96:99],a[136:139],a[72:75],v[96:99]
v_exp_f32 v85,v85
v_exp_f32 v84,v84
v_fma_f32 v87,v87,s36,v14
v_exp_f32 v87,v87
v_cvt_pk_bf16_f32 v26,v84,v85
v_cvt_pk_bf16_f32 v27,v86,v87
ds_write_b64 v36,v[240:241] offset:8192
v_cvt_pk_bf16_f32 v36,v104,v105
v_fma_f32 v94,v94,s36,v15
v_exp_f32 v94,v94
ds_write_b64 v37,v[244:245] offset:8192
v_cvt_pk_bf16_f32 v37,v106,v107
v_mfma_f32_16x16x32_bf16 v[104:107],a[136:139],a[96:99],0
ds_read_b128 a[136:139],v0 offset:18560
v_fma_f32 v95,v95,s36,v15
v_mfma_f32_16x16x32_bf16 v[104:107],a[140:143],a[100:103],v[104:107]
ds_read_b128 a[140:143],v1 offset:18560
v_fma_f32 v93,v93,s36,v15
v_mfma_f32_16x16x32_bf16 v[104:107],a[144:147],a[104:107],v[104:107]
ds_read_b128 a[144:147],v0 offset:18688
v_exp_f32 v93,v93
v_mfma_f32_16x16x32_bf16 v[104:107],a[148:151],a[108:111],v[104:107]
ds_read_b128 a[148:151],v1 offset:18688
v_exp_f32 v95,v95
v_mfma_f32_16x16x32_bf16 v[104:107],a[120:123],a[112:115],v[104:107]
v_fma_f32 v92,v92,s36,v15
v_exp_f32 v92,v92
v_mfma_f32_16x16x32_bf16 v[104:107],a[124:127],a[116:119],v[104:107]
v_cvt_pk_bf16_f32 v30,v92,v93
v_cvt_pk_bf16_f32 v31,v94,v95
v_mfma_f32_16x16x32_bf16 v[76:79],a[128:131],a[0:3],0
v_fma_f32 v100,v100,s36,v16
v_fma_f32 v103,v103,s36,v16
v_mfma_f32_16x16x32_bf16 v[76:79],a[132:135],a[4:7],v[76:79]
s_waitcnt lgkmcnt(3)
v_fma_f32 v102,v102,s36,v16
v_fma_f32 v101,v101,s36,v16
v_mfma_f32_16x16x32_bf16 v[76:79],a[136:139],a[8:11],v[76:79]
s_waitcnt lgkmcnt(1)
v_exp_f32 v102,v102
v_mfma_f32_16x16x32_bf16 v[76:79],a[140:143],a[12:15],v[76:79]
v_exp_f32 v101,v101
s_waitcnt vmcnt(5)
s_barrier
v_mfma_f32_16x16x32_bf16 v[76:79],a[144:147],a[16:19],v[76:79]
buffer_load_dwordx4 v6,s[4:7],s20 offen offset:0 lds
s_waitcnt lgkmcnt(0)
v_mfma_f32_16x16x32_bf16 v[76:79],a[148:151],a[20:23],v[76:79]
v_exp_f32 v100,v100
v_mfma_f32_16x16x32_bf16 v[84:87],a[148:151],a[44:47],0
v_exp_f32 v103,v103
v_mfma_f32_16x16x32_bf16 v[84:87],a[144:147],a[40:43],v[84:87]
v_cvt_pk_bf16_f32 v34,v100,v101
v_cvt_pk_bf16_f32 v35,v102,v103
v_mfma_f32_16x16x32_bf16 v[84:87],a[140:143],a[36:39],v[84:87]
v_fma_f32 v111,v111,s36,v17
v_exp_f32 v111,v111
v_mfma_f32_16x16x32_bf16 v[84:87],a[136:139],a[32:35],v[84:87]
v_cvt_pk_bf16_f32 v248,v248,v249
v_cvt_pk_bf16_f32 v252,v252,v253
v_mfma_f32_16x16x32_bf16 v[84:87],a[132:135],a[28:31],v[84:87]
buffer_load_dwordx4 v7,s[4:7],s20 offen offset:1024 lds
v_mfma_f32_16x16x32_bf16 v[84:87],a[128:131],a[24:27],v[84:87]
v_fma_f32 v110,v110,s36,v17
v_fma_f32 v108,v108,s36,v17
v_mfma_f32_16x16x32_bf16 v[92:95],a[128:131],a[48:51],0
v_fma_f32 v109,v109,s36,v17
v_exp_f32 v109,v109
v_mfma_f32_16x16x32_bf16 v[92:95],a[132:135],a[52:55],v[92:95]
ds_read_b64_tr_b16 a[120:121],v2 offset:0
v_exp_f32 v110,v110
v_mfma_f32_16x16x32_bf16 v[92:95],a[136:139],a[56:59],v[92:95]
ds_read_b64_tr_b16 a[122:123],v2 offset:6144
v_cvt_pk_bf16_f32 v249,v250,v251
v_mfma_f32_16x16x32_bf16 v[92:95],a[140:143],a[60:63],v[92:95]
buffer_load_dwordx4 v8,s[4:7],s20 offen offset:2048 lds
v_mfma_f32_16x16x32_bf16 v[92:95],a[144:147],a[64:67],v[92:95]
s_add_u32 s20,s20,12288
ds_write_b64 v38,v[248:249] offset:8192
v_mfma_f32_16x16x32_bf16 v[92:95],a[148:151],a[68:71],v[92:95]
ds_read_b64_tr_b16 a[126:127],v3 offset:6144
v_exp_f32 v108,v108
v_mfma_f32_16x16x32_bf16 v[100:103],a[148:151],a[92:95],0
ds_read_b64_tr_b16 a[124:125],v3 offset:0
v_cvt_pk_bf16_f32 v253,v254,v255
v_mfma_f32_16x16x32_bf16 v[100:103],a[144:147],a[88:91],v[100:103]
ds_write_b64 v39,v[252:253] offset:8192
v_mfma_f32_16x16x32_bf16 v[100:103],a[140:143],a[84:87],v[100:103]
v_cvt_pk_bf16_f32 v39,v110,v111
v_cvt_pk_bf16_f32 v38,v108,v109
v_mfma_f32_16x16x32_bf16 v[100:103],a[136:139],a[80:83],v[100:103]
v_fma_f32 v73,v73,s36,v13
v_fma_f32 v80,v80,s36,v14
v_mfma_f32_16x16x32_bf16 v[100:103],a[132:135],a[76:79],v[100:103]
v_mov_b32 v60,0
v_fma_f32 v83,v83,s36,v14
v_mfma_f32_16x16x32_bf16 v[100:103],a[128:131],a[72:75],v[100:103]
v_fma_f32 v88,v88,s36,v15
v_fma_f32 v89,v89,s36,v15
v_mfma_f32_16x16x32_bf16 v[108:111],a[128:131],a[96:99],0
ds_read_b64_tr_b16 a[130:131],v4 offset:6144
v_exp_f32 v73,v73
v_mfma_f32_16x16x32_bf16 v[108:111],a[132:135],a[100:103],v[108:111]
ds_read_b64_tr_b16 a[128:129],v4 offset:0
v_mov_b32 v64,0
v_mfma_f32_16x16x32_bf16 v[108:111],a[136:139],a[104:107],v[108:111]
ds_read_b64_tr_b16 a[132:133],v5 offset:0
v_exp_f32 v83,v83
v_smfmac_f32_16x16x64_bf16 v[64:67],a[152:155],v[28:35],v18
ds_read_b64_tr_b16 a[134:135],v5 offset:6144
v_mfma_f32_16x16x32_bf16 v[108:111],a[140:143],a[108:111],v[108:111]
v_exp_f32 v88,v88
v_mfma_f32_16x16x32_bf16 v[108:111],a[144:147],a[112:115],v[108:111]
v_exp_f32 v89,v89
v_mfma_f32_16x16x32_bf16 v[108:111],a[148:151],a[116:119],v[108:111]
v_fma_f32 v74,v74,s36,v13
v_exp_f32 v74,v74
v_fma_f32 v82,v82,s36,v14
v_exp_f32 v82,v82
v_mov_b32 v62,0
v_fma_f32 v72,v72,s36,v13
v_exp_f32 v72,v72
v_smfmac_f32_16x16x64_bf16 v[60:63],a[152:155],v[20:27],v18
v_cvt_pk_bf16_f32 v44,v72,v73
v_fma_f32 v75,v75,s36,v13
v_exp_f32 v75,v75
v_exp_f32 v80,v80
v_fma_f32 v81,v81,s36,v14
v_exp_f32 v81,v81
v_cvt_pk_bf16_f32 v52,v88,v89
v_cvt_pk_bf16_f32 v48,v80,v81
v_cvt_pk_bf16_f32 v49,v82,v83
v_cvt_pk_bf16_f32 v45,v74,v75
s_waitcnt lgkmcnt(0)
v_mfma_f32_16x16x32_bf16 v[160:163],a[120:123],v[20:23],0
s_add_u32 m0,s23,0
ds_read_b64_tr_b16 a[136:137],v2 offset:128
v_fma_f32 v90,v90,s36,v15
v_mfma_f32_16x16x32_bf16 v[164:167],a[124:127],v[20:23],0
ds_read_b64_tr_b16 a[138:139],v2 offset:6272
v_fma_f32 v91,v91,s36,v15
v_mfma_f32_16x16x32_bf16 v[212:215],a[124:127],v[24:27],0
ds_read_b64_tr_b16 a[140:141],v3 offset:128
v_fma_f32 v96,v96,s36,v16
v_mfma_f32_16x16x32_bf16 v[208:211],a[120:123],v[24:27],0
ds_read_b64_tr_b16 a[142:143],v3 offset:6272
v_fma_f32 v97,v97,s36,v16
v_mfma_f32_16x16x32_bf16 v[112:115],a[120:123],v[28:31],0
ds_read_b64_tr_b16 a[144:145],v4 offset:128
v_fma_f32 v98,v98,s36,v16
v_mfma_f32_16x16x32_bf16 v[116:119],a[124:127],v[28:31],0
ds_read_b64_tr_b16 a[146:147],v4 offset:6272
v_fma_f32 v99,v99,s36,v16
v_mfma_f32_16x16x32_bf16 a[164:167],a[124:127],v[32:35],0
ds_read_b64_tr_b16 a[148:149],v5 offset:128
v_fma_f32 v104,v104,s36,v17
v_mfma_f32_16x16x32_bf16 a[160:163],a[120:123],v[32:35],0
ds_read_b64_tr_b16 a[150:151],v5 offset:6272
v_fma_f32 v105,v105,s36,v17
v_mfma_f32_16x16x32_bf16 a[208:211],a[120:123],v[36:39],0
ds_read_b64_tr_b16 a[120:121],v2 offset:256
v_fma_f32 v106,v106,s36,v17
v_mfma_f32_16x16x32_bf16 a[212:215],a[124:127],v[36:39],0
ds_read_b64_tr_b16 a[122:123],v2 offset:6400
v_fma_f32 v107,v107,s36,v17
v_mfma_f32_16x16x32_bf16 a[216:219],a[128:131],v[36:39],0
ds_read_b64_tr_b16 a[124:125],v3 offset:256
v_fma_f32 v76,v76,s36,v13
v_mfma_f32_16x16x32_bf16 a[220:223],a[132:135],v[36:39],0
ds_read_b64_tr_b16 a[126:127],v3 offset:6400
v_fma_f32 v77,v77,s36,v13
v_mfma_f32_16x16x32_bf16 a[172:175],a[132:135],v[32:35],0
v_exp_f32 v90,v90
v_mfma_f32_16x16x32_bf16 a[168:171],a[128:131],v[32:35],0
v_exp_f32 v91,v91
v_mfma_f32_16x16x32_bf16 v[120:123],a[128:131],v[28:31],0
v_cvt_pk_bf16_f32 v53,v90,v91
v_fma_f32 v78,v78,s36,v13
v_mfma_f32_16x16x32_bf16 v[124:127],a[132:135],v[28:31],0
v_exp_f32 v96,v96
v_mfma_f32_16x16x32_bf16 v[220:223],a[132:135],v[24:27],0
v_exp_f32 v97,v97
v_mfma_f32_16x16x32_bf16 v[216:219],a[128:131],v[24:27],0
v_exp_f32 v98,v98
v_mfma_f32_16x16x32_bf16 v[168:171],a[128:131],v[20:23],0
ds_read_b64_tr_b16 a[128:129],v4 offset:256
v_cvt_pk_bf16_f32 v56,v96,v97
v_mfma_f32_16x16x32_bf16 v[172:175],a[132:135],v[20:23],0
s_waitcnt lgkmcnt(1)
ds_read_b64_tr_b16 a[130:131],v4 offset:6400
v_fma_f32 v79,v79,s36,v13
v_mfma_f32_16x16x32_bf16 v[176:179],a[136:139],v[20:23],0
ds_read_b64_tr_b16 a[132:133],v5 offset:256
v_fma_f32 v84,v84,s36,v14
v_mfma_f32_16x16x32_bf16 v[180:183],a[140:143],v[20:23],0
ds_read_b64_tr_b16 a[134:135],v5 offset:6400
v_fma_f32 v85,v85,s36,v14
v_mfma_f32_16x16x32_bf16 v[228:231],a[140:143],v[24:27],0
v_exp_f32 v99,v99
v_mfma_f32_16x16x32_bf16 v[224:227],a[136:139],v[24:27],0
v_cvt_pk_bf16_f32 v57,v98,v99
v_fma_f32 v86,v86,s36,v14
v_mfma_f32_16x16x32_bf16 v[128:131],a[136:139],v[28:31],0
v_exp_f32 v104,v104
v_mfma_f32_16x16x32_bf16 v[132:135],a[140:143],v[28:31],0
v_exp_f32 v105,v105
v_mfma_f32_16x16x32_bf16 a[180:183],a[140:143],v[32:35],0
v_exp_f32 v106,v106
v_mfma_f32_16x16x32_bf16 a[176:179],a[136:139],v[32:35],0
v_exp_f32 v107,v107
v_mfma_f32_16x16x32_bf16 a[224:227],a[136:139],v[36:39],0
v_cvt_pk_bf16_f32 v40,v104,v105
v_cvt_pk_bf16_f32 v41,v106,v107
v_mfma_f32_16x16x32_bf16 a[228:231],a[140:143],v[36:39],0
v_exp_f32 v76,v76
v_mfma_f32_16x16x32_bf16 a[232:235],a[144:147],v[36:39],0
v_exp_f32 v77,v77
v_mfma_f32_16x16x32_bf16 a[236:239],a[148:151],v[36:39],0
v_exp_f32 v78,v78
v_mfma_f32_16x16x32_bf16 a[188:191],a[148:151],v[32:35],0
v_exp_f32 v79,v79
v_mfma_f32_16x16x32_bf16 a[184:187],a[144:147],v[32:35],0
v_cvt_pk_bf16_f32 v46,v76,v77
v_cvt_pk_bf16_f32 v47,v78,v79
v_mfma_f32_16x16x32_bf16 v[136:139],a[144:147],v[28:31],0
v_fma_f32 v87,v87,s36,v14
v_fma_f32 v92,v92,s36,v15
v_mfma_f32_16x16x32_bf16 v[140:143],a[148:151],v[28:31],0
v_exp_f32 v84,v84
v_mfma_f32_16x16x32_bf16 v[236:239],a[148:151],v[24:27],0
v_exp_f32 v85,v85
v_mfma_f32_16x16x32_bf16 v[232:235],a[144:147],v[24:27],0
v_exp_f32 v86,v86
v_mfma_f32_16x16x32_bf16 v[184:187],a[144:147],v[20:23],0
v_exp_f32 v87,v87
v_mfma_f32_16x16x32_bf16 v[188:191],a[148:151],v[20:23],0
v_cvt_pk_bf16_f32 v50,v84,v85
v_cvt_pk_bf16_f32 v51,v86,v87
v_mfma_f32_16x16x32_bf16 v[192:195],a[120:123],v[20:23],0
s_waitcnt vmcnt(30) lgkmcnt(0)
v_fma_f32 v93,v93,s36,v15
v_fma_f32 v94,v94,s36,v15
v_smfmac_f32_16x16x64_bf16 v[60:63],a[152:155],v[44:51],v18
s_barrier
v_mfma_f32_16x16x32_bf16 v[196:199],a[124:127],v[20:23],0
ds_read_b128 a[136:139],v0 offset:24576
v_fma_f32 v95,v95,s36,v15
v_mfma_f32_16x16x32_bf16 v[244:247],a[124:127],v[24:27],0
ds_read_b128 a[140:143],v1 offset:24576
v_fma_f32 v100,v100,s36,v16
v_mfma_f32_16x16x32_bf16 v[240:243],a[120:123],v[24:27],0
ds_read_b128 a[144:147],v0 offset:24704
v_fma_f32 v101,v101,s36,v16
v_mfma_f32_16x16x32_bf16 v[144:147],a[120:123],v[28:31],0
ds_read_b128 a[148:151],v1 offset:24704
v_fma_f32 v102,v102,s36,v16
v_mfma_f32_16x16x32_bf16 v[148:151],a[124:127],v[28:31],0
v_exp_f32 v92,v92
v_mfma_f32_16x16x32_bf16 a[196:199],a[124:127],v[32:35],0
buffer_load_dwordx4 v6,s[8:11],s21 offen offset:0 lds
v_mfma_f32_16x16x32_bf16 a[192:195],a[120:123],v[32:35],0
v_exp_f32 v93,v93
v_mfma_f32_16x16x32_bf16 a[240:243],a[120:123],v[36:39],0
ds_read_b128 a[120:123],v0 offset:24832
v_cvt_pk_bf16_f32 v54,v92,v93
v_mfma_f32_16x16x32_bf16 a[244:247],a[124:127],v[36:39],0
ds_read_b128 a[124:127],v1 offset:24832
v_fma_f32 v103,v103,s36,v16
v_mfma_f32_16x16x32_bf16 a[248:251],a[128:131],v[36:39],0
v_exp_f32 v94,v94
v_mfma_f32_16x16x32_bf16 a[252:255],a[132:135],v[36:39],0
v_exp_f32 v95,v95
v_mfma_f32_16x16x32_bf16 a[204:207],a[132:135],v[32:35],0
v_cvt_pk_bf16_f32 v55,v94,v95
v_fma_f32 v108,v108,s36,v17
v_mfma_f32_16x16x32_bf16 a[200:203],a[128:131],v[32:35],0
v_exp_f32 v100,v100
v_mfma_f32_16x16x32_bf16 v[152:155],a[128:131],v[28:31],0
v_exp_f32 v101,v101
v_mfma_f32_16x16x32_bf16 v[156:159],a[132:135],v[28:31],0
v_exp_f32 v102,v102
v_mfma_f32_16x16x32_bf16 v[252:255],a[132:135],v[24:27],0
v_exp_f32 v103,v103
v_mfma_f32_16x16x32_bf16 v[248:251],a[128:131],v[24:27],0
buffer_load_dwordx4 v7,s[8:11],s21 offen offset:1024 lds
v_mfma_f32_16x16x32_bf16 v[200:203],a[128:131],v[20:23],0
ds_read_b128 a[128:131],v0 offset:30720
v_cvt_pk_bf16_f32 v58,v100,v101
v_mfma_f32_16x16x32_bf16 v[204:207],a[132:135],v[20:23],0
s_waitcnt lgkmcnt(1)
ds_read_b128 a[132:135],v1 offset:30720
v_cvt_pk_bf16_f32 v59,v102,v103
v_mfma_f32_16x16x32_bf16 v[72:75],a[136:139],a[0:3],0
v_fma_f32 v109,v109,s36,v17
v_fma_f32 v110,v110,s36,v17
v_smfmac_f32_16x16x64_bf16 v[64:67],a[152:155],v[52:59],v18
v_fma_f32 v111,v111,s36,v17
v_mfma_f32_16x16x32_bf16 v[72:75],a[140:143],a[4:7],v[72:75]
v_exp_f32 v108,v108
v_mfma_f32_16x16x32_bf16 v[72:75],a[144:147],a[8:11],v[72:75]
v_exp_f32 v109,v109
v_mfma_f32_16x16x32_bf16 v[72:75],a[148:151],a[12:15],v[72:75]
v_exp_f32 v110,v110
v_mfma_f32_16x16x32_bf16 v[72:75],a[120:123],a[16:19],v[72:75]
v_exp_f32 v111,v111
v_mfma_f32_16x16x32_bf16 v[72:75],a[124:127],a[20:23],v[72:75]
v_cvt_pk_bf16_f32 v42,v108,v109
v_cvt_pk_bf16_f32 v43,v110,v111
v_mfma_f32_16x16x32_bf16 v[80:83],a[124:127],a[44:47],0
v_mfma_f32_16x16x32_bf16 v[80:83],a[120:123],a[40:43],v[80:83]
v_smfmac_f32_16x16x64_bf16 v[68:71],a[152:155],v[36:43],v18
buffer_load_dwordx4 v8,s[8:11],s21 offen offset:2048 lds
v_mfma_f32_16x16x32_bf16 v[80:83],a[148:151],a[36:39],v[80:83]
s_add_u32 s21,s21,12288
v_fma_f32 v72,v72,s36,v13
v_fma_f32 v73,v73,s36,v13
v_mfma_f32_16x16x32_bf16 v[80:83],a[144:147],a[32:35],v[80:83]
s_add_u32 m0,s22,12288
v_fma_f32 v74,v74,s36,v13
v_fma_f32 v75,v75,s36,v13
v_mfma_f32_16x16x32_bf16 v[80:83],a[140:143],a[28:31],v[80:83]
v_exp_f32 v72,v72
v_mfma_f32_16x16x32_bf16 v[80:83],a[136:139],a[24:27],v[80:83]
v_exp_f32 v73,v73
v_mfma_f32_16x16x32_bf16 v[88:91],a[136:139],a[48:51],0
v_exp_f32 v74,v74
v_mfma_f32_16x16x32_bf16 v[88:91],a[140:143],a[52:55],v[88:91]
v_exp_f32 v75,v75
v_mfma_f32_16x16x32_bf16 v[88:91],a[144:147],a[56:59],v[88:91]
v_cvt_pk_bf16_f32 v20,v72,v73
v_cvt_pk_bf16_f32 v21,v74,v75
v_mfma_f32_16x16x32_bf16 v[88:91],a[148:151],a[60:63],v[88:91]
v_fma_f32 v80,v80,s36,v14
v_fma_f32 v81,v81,s36,v14
v_mfma_f32_16x16x32_bf16 v[88:91],a[120:123],a[64:67],v[88:91]
v_fma_f32 v82,v82,s36,v14
v_fma_f32 v83,v83,s36,v14
v_mfma_f32_16x16x32_bf16 v[88:91],a[124:127],a[68:71],v[88:91]
v_exp_f32 v80,v80
v_mfma_f32_16x16x32_bf16 v[96:99],a[124:127],a[92:95],0
buffer_load_dwordx4 v6,s[4:7],s20 offen offset:0 lds
v_mfma_f32_16x16x32_bf16 v[96:99],a[120:123],a[88:91],v[96:99]
v_exp_f32 v81,v81
v_mfma_f32_16x16x32_bf16 v[96:99],a[148:151],a[84:87],v[96:99]
v_exp_f32 v82,v82
v_mfma_f32_16x16x32_bf16 v[96:99],a[144:147],a[80:83],v[96:99]
v_fma_f32 v88,v88,s36,v15
v_fma_f32 v89,v89,s36,v15
v_mfma_f32_16x16x32_bf16 v[96:99],a[140:143],a[76:79],v[96:99]
v_exp_f32 v83,v83
v_mfma_f32_16x16x32_bf16 v[96:99],a[136:139],a[72:75],v[96:99]
v_exp_f32 v88,v88
v_mfma_f32_16x16x32_bf16 v[104:107],a[136:139],a[96:99],0
ds_read_b128 a[136:139],v0 offset:30848
v_cvt_pk_bf16_f32 v24,v80,v81
v_mfma_f32_16x16x32_bf16 v[104:107],a[140:143],a[100:103],v[104:107]
ds_read_b128 a[140:143],v1 offset:30848
v_cvt_pk_bf16_f32 v25,v82,v83
v_mfma_f32_16x16x32_bf16 v[104:107],a[144:147],a[104:107],v[104:107]
ds_read_b128 a[144:147],v0 offset:30976
v_mfma_f32_16x16x32_bf16 v[104:107],a[148:151],a[108:111],v[104:107]
ds_read_b128 a[148:151],v1 offset:30976
v_mfma_f32_16x16x32_bf16 v[104:107],a[120:123],a[112:115],v[104:107]
v_exp_f32 v89,v89
v_mfma_f32_16x16x32_bf16 v[104:107],a[124:127],a[116:119],v[104:107]
s_waitcnt lgkmcnt(4)
v_cvt_pk_bf16_f32 v28,v88,v89
v_mfma_f32_16x16x32_bf16 v[76:79],a[128:131],a[0:3],0
buffer_load_dwordx4 v7,s[4:7],s20 offen offset:1024 lds
v_mfma_f32_16x16x32_bf16 v[76:79],a[132:135],a[4:7],v[76:79]
s_waitcnt lgkmcnt(3)
v_mfma_f32_16x16x32_bf16 v[76:79],a[136:139],a[8:11],v[76:79]
s_waitcnt lgkmcnt(2)
v_mfma_f32_16x16x32_bf16 v[76:79],a[140:143],a[12:15],v[76:79]
s_waitcnt lgkmcnt(1)
v_mfma_f32_16x16x32_bf16 v[76:79],a[144:147],a[16:19],v[76:79]
s_waitcnt lgkmcnt(0)
v_mfma_f32_16x16x32_bf16 v[76:79],a[148:151],a[20:23],v[76:79]
v_mfma_f32_16x16x32_bf16 v[84:87],a[148:151],a[44:47],0
v_mfma_f32_16x16x32_bf16 v[84:87],a[144:147],a[40:43],v[84:87]
v_mfma_f32_16x16x32_bf16 v[84:87],a[140:143],a[36:39],v[84:87]
v_mfma_f32_16x16x32_bf16 v[84:87],a[136:139],a[32:35],v[84:87]
v_mfma_f32_16x16x32_bf16 v[84:87],a[132:135],a[28:31],v[84:87]
v_mfma_f32_16x16x32_bf16 v[84:87],a[128:131],a[24:27],v[84:87]
v_mfma_f32_16x16x32_bf16 v[92:95],a[128:131],a[48:51],0
buffer_load_dwordx4 v8,s[4:7],s20 offen offset:2048 lds
v_mfma_f32_16x16x32_bf16 v[92:95],a[132:135],a[52:55],v[92:95]
s_add_u32 s20,s20,12288
v_mfma_f32_16x16x32_bf16 v[92:95],a[136:139],a[56:59],v[92:95]
v_mfma_f32_16x16x32_bf16 v[92:95],a[140:143],a[60:63],v[92:95]
v_mfma_f32_16x16x32_bf16 v[92:95],a[144:147],a[64:67],v[92:95]
v_mfma_f32_16x16x32_bf16 v[92:95],a[148:151],a[68:71],v[92:95]
ds_read_b64_tr_b16 a[120:121],v2 offset:12288
v_mfma_f32_16x16x32_bf16 v[100:103],a[148:151],a[92:95],0
ds_read_b64_tr_b16 a[122:123],v2 offset:18432
v_mfma_f32_16x16x32_bf16 v[100:103],a[144:147],a[88:91],v[100:103]
v_mfma_f32_16x16x32_bf16 v[100:103],a[140:143],a[84:87],v[100:103]
ds_read_b64_tr_b16 a[124:125],v3 offset:12288
v_mfma_f32_16x16x32_bf16 v[100:103],a[136:139],a[80:83],v[100:103]
ds_read_b64_tr_b16 a[126:127],v3 offset:18432
v_mfma_f32_16x16x32_bf16 v[100:103],a[132:135],a[76:79],v[100:103]
v_mfma_f32_16x16x32_bf16 v[100:103],a[128:131],a[72:75],v[100:103]
v_mfma_f32_16x16x32_bf16 v[108:111],a[128:131],a[96:99],0
ds_read_b64_tr_b16 a[128:129],v4 offset:12288
v_mfma_f32_16x16x32_bf16 v[108:111],a[132:135],a[100:103],v[108:111]
ds_read_b64_tr_b16 a[130:131],v4 offset:18432
v_mfma_f32_16x16x32_bf16 v[108:111],a[136:139],a[104:107],v[108:111]
ds_read_b64_tr_b16 a[132:133],v5 offset:12288
v_mfma_f32_16x16x32_bf16 v[108:111],a[140:143],a[108:111],v[108:111]
ds_read_b64_tr_b16 a[134:135],v5 offset:18432
v_mfma_f32_16x16x32_bf16 v[108:111],a[144:147],a[112:115],v[108:111]
v_mfma_f32_16x16x32_bf16 v[108:111],a[148:151],a[116:119],v[108:111]
s_waitcnt lgkmcnt(4)
v_mfma_f32_16x16x32_bf16 v[160:163],a[120:123],v[44:47],v[160:163]
s_add_u32 m0,s23,12288
ds_read_b64_tr_b16 a[136:137],v2 offset:12416
v_fma_f32 v90,v90,s36,v15
v_mfma_f32_16x16x32_bf16 v[164:167],a[124:127],v[44:47],v[164:167]
ds_read_b64_tr_b16 a[138:139],v2 offset:18560
v_fma_f32 v91,v91,s36,v15
v_mfma_f32_16x16x32_bf16 v[212:215],a[124:127],v[48:51],v[212:215]
ds_read_b64_tr_b16 a[140:141],v3 offset:12416
v_fma_f32 v96,v96,s36,v16
v_mfma_f32_16x16x32_bf16 v[208:211],a[120:123],v[48:51],v[208:211]
ds_read_b64_tr_b16 a[142:143],v3 offset:18560
v_fma_f32 v97,v97,s36,v16
v_mfma_f32_16x16x32_bf16 v[112:115],a[120:123],v[52:55],v[112:115]
ds_read_b64_tr_b16 a[144:145],v4 offset:12416
v_fma_f32 v98,v98,s36,v16
v_mfma_f32_16x16x32_bf16 v[116:119],a[124:127],v[52:55],v[116:119]
ds_read_b64_tr_b16 a[146:147],v4 offset:18560
v_fma_f32 v99,v99,s36,v16
v_mfma_f32_16x16x32_bf16 a[164:167],a[124:127],v[56:59],a[164:167]
ds_read_b64_tr_b16 a[148:149],v5 offset:12416
v_fma_f32 v104,v104,s36,v17
v_mfma_f32_16x16x32_bf16 a[160:163],a[120:123],v[56:59],a[160:163]
ds_read_b64_tr_b16 a[150:151],v5 offset:18560
v_fma_f32 v105,v105,s36,v17
v_mfma_f32_16x16x32_bf16 a[208:211],a[120:123],v[40:43],a[208:211]
ds_read_b64_tr_b16 a[120:121],v2 offset:12544
v_fma_f32 v106,v106,s36,v17
v_mfma_f32_16x16x32_bf16 a[212:215],a[124:127],v[40:43],a[212:215]
s_waitcnt lgkmcnt(6)
ds_read_b64_tr_b16 a[122:123],v2 offset:18688
v_fma_f32 v107,v107,s36,v17
v_mfma_f32_16x16x32_bf16 a[216:219],a[128:131],v[40:43],a[216:219]
ds_read_b64_tr_b16 a[124:125],v3 offset:12544
v_fma_f32 v76,v76,s36,v13
v_mfma_f32_16x16x32_bf16 a[220:223],a[132:135],v[40:43],a[220:223]
ds_read_b64_tr_b16 a[126:127],v3 offset:18688
v_fma_f32 v77,v77,s36,v13
v_mfma_f32_16x16x32_bf16 a[172:175],a[132:135],v[56:59],a[172:175]
v_exp_f32 v90,v90
v_mfma_f32_16x16x32_bf16 a[168:171],a[128:131],v[56:59],a[168:171]
v_exp_f32 v91,v91
v_mfma_f32_16x16x32_bf16 v[120:123],a[128:131],v[52:55],v[120:123]
v_cvt_pk_bf16_f32 v29,v90,v91
v_fma_f32 v78,v78,s36,v13
v_mfma_f32_16x16x32_bf16 v[124:127],a[132:135],v[52:55],v[124:127]
v_exp_f32 v96,v96
v_mfma_f32_16x16x32_bf16 v[220:223],a[132:135],v[48:51],v[220:223]
v_exp_f32 v97,v97
v_mfma_f32_16x16x32_bf16 v[216:219],a[128:131],v[48:51],v[216:219]
v_exp_f32 v98,v98
v_mfma_f32_16x16x32_bf16 v[168:171],a[128:131],v[44:47],v[168:171]
ds_read_b64_tr_b16 a[128:129],v4 offset:12544
v_cvt_pk_bf16_f32 v32,v96,v97
v_mfma_f32_16x16x32_bf16 v[172:175],a[132:135],v[44:47],v[172:175]
ds_read_b64_tr_b16 a[130:131],v4 offset:18688
v_fma_f32 v79,v79,s36,v13
v_mfma_f32_16x16x32_bf16 v[176:179],a[136:139],v[44:47],v[176:179]
s_waitcnt lgkmcnt(2)
ds_read_b64_tr_b16 a[132:133],v5 offset:12544
v_fma_f32 v84,v84,s36,v14
v_mfma_f32_16x16x32_bf16 v[180:183],a[140:143],v[44:47],v[180:183]
ds_read_b64_tr_b16 a[134:135],v5 offset:18688
v_fma_f32 v85,v85,s36,v14
v_mfma_f32_16x16x32_bf16 v[228:231],a[140:143],v[48:51],v[228:231]
v_exp_f32 v99,v99
v_mfma_f32_16x16x32_bf16 v[224:227],a[136:139],v[48:51],v[224:227]
v_cvt_pk_bf16_f32 v33,v98,v99
v_fma_f32 v86,v86,s36,v14
v_mfma_f32_16x16x32_bf16 v[128:131],a[136:139],v[52:55],v[128:131]
v_exp_f32 v104,v104
v_mfma_f32_16x16x32_bf16 v[132:135],a[140:143],v[52:55],v[132:135]
v_exp_f32 v105,v105
v_mfma_f32_16x16x32_bf16 a[180:183],a[140:143],v[56:59],a[180:183]
v_exp_f32 v106,v106
v_mfma_f32_16x16x32_bf16 a[176:179],a[136:139],v[56:59],a[176:179]
v_exp_f32 v107,v107
v_mfma_f32_16x16x32_bf16 a[224:227],a[136:139],v[40:43],a[224:227]
v_cvt_pk_bf16_f32 v36,v104,v105
v_cvt_pk_bf16_f32 v37,v106,v107
v_mfma_f32_16x16x32_bf16 a[228:231],a[140:143],v[40:43],a[228:231]
v_exp_f32 v76,v76
v_mfma_f32_16x16x32_bf16 a[232:235],a[144:147],v[40:43],a[232:235]
v_exp_f32 v77,v77
v_mfma_f32_16x16x32_bf16 a[236:239],a[148:151],v[40:43],a[236:239]
v_exp_f32 v78,v78
v_mfma_f32_16x16x32_bf16 a[188:191],a[148:151],v[56:59],a[188:191]
v_exp_f32 v79,v79
v_mfma_f32_16x16x32_bf16 a[184:187],a[144:147],v[56:59],a[184:187]
v_cvt_pk_bf16_f32 v22,v76,v77
v_cvt_pk_bf16_f32 v23,v78,v79
v_mfma_f32_16x16x32_bf16 v[136:139],a[144:147],v[52:55],v[136:139]
v_fma_f32 v87,v87,s36,v14
v_fma_f32 v92,v92,s36,v15
v_mfma_f32_16x16x32_bf16 v[140:143],a[148:151],v[52:55],v[140:143]
v_exp_f32 v84,v84
v_mfma_f32_16x16x32_bf16 v[236:239],a[148:151],v[48:51],v[236:239]
v_exp_f32 v85,v85
v_mfma_f32_16x16x32_bf16 v[232:235],a[144:147],v[48:51],v[232:235]
v_exp_f32 v86,v86
v_mfma_f32_16x16x32_bf16 v[184:187],a[144:147],v[44:47],v[184:187]
v_exp_f32 v87,v87
v_mfma_f32_16x16x32_bf16 v[188:191],a[148:151],v[44:47],v[188:191]
v_cvt_pk_bf16_f32 v26,v84,v85
v_cvt_pk_bf16_f32 v27,v86,v87
v_mfma_f32_16x16x32_bf16 v[192:195],a[120:123],v[44:47],v[192:195]
s_waitcnt vmcnt(6) lgkmcnt(0)
v_fma_f32 v93,v93,s36,v15
v_fma_f32 v94,v94,s36,v15
v_smfmac_f32_16x16x64_bf16 v[60:63],a[152:155],v[20:27],v18
s_barrier
v_mfma_f32_16x16x32_bf16 v[196:199],a[124:127],v[44:47],v[196:199]
ds_read_b128 a[136:139],v0 offset:0
v_fma_f32 v95,v95,s36,v15
v_mfma_f32_16x16x32_bf16 v[244:247],a[124:127],v[48:51],v[244:247]
ds_read_b128 a[140:143],v1 offset:0
v_fma_f32 v100,v100,s36,v16
v_mfma_f32_16x16x32_bf16 v[240:243],a[120:123],v[48:51],v[240:243]
ds_read_b128 a[144:147],v0 offset:128
v_fma_f32 v101,v101,s36,v16
v_mfma_f32_16x16x32_bf16 v[144:147],a[120:123],v[52:55],v[144:147]
ds_read_b128 a[148:151],v1 offset:128
v_fma_f32 v102,v102,s36,v16
v_mfma_f32_16x16x32_bf16 v[148:151],a[124:127],v[52:55],v[148:151]
v_exp_f32 v92,v92
v_mfma_f32_16x16x32_bf16 a[196:199],a[124:127],v[56:59],a[196:199]
buffer_load_dwordx4 v6,s[8:11],s21 offen offset:0 lds
v_mfma_f32_16x16x32_bf16 a[192:195],a[120:123],v[56:59],a[192:195]
v_exp_f32 v93,v93
v_mfma_f32_16x16x32_bf16 a[240:243],a[120:123],v[40:43],a[240:243]
ds_read_b128 a[120:123],v0 offset:256
v_cvt_pk_bf16_f32 v30,v92,v93
v_mfma_f32_16x16x32_bf16 a[244:247],a[124:127],v[40:43],a[244:247]
ds_read_b128 a[124:127],v1 offset:256
v_fma_f32 v103,v103,s36,v16
v_mfma_f32_16x16x32_bf16 a[248:251],a[128:131],v[40:43],a[248:251]
v_exp_f32 v94,v94
v_mfma_f32_16x16x32_bf16 a[252:255],a[132:135],v[40:43],a[252:255]
v_exp_f32 v95,v95
v_mfma_f32_16x16x32_bf16 a[204:207],a[132:135],v[56:59],a[204:207]
v_cvt_pk_bf16_f32 v31,v94,v95
v_fma_f32 v108,v108,s36,v17
v_mfma_f32_16x16x32_bf16 a[200:203],a[128:131],v[56:59],a[200:203]
v_exp_f32 v100,v100
v_mfma_f32_16x16x32_bf16 v[152:155],a[128:131],v[52:55],v[152:155]
v_exp_f32 v101,v101
v_mfma_f32_16x16x32_bf16 v[156:159],a[132:135],v[52:55],v[156:159]
v_exp_f32 v102,v102
v_mfma_f32_16x16x32_bf16 v[252:255],a[132:135],v[48:51],v[252:255]
v_exp_f32 v103,v103
v_mfma_f32_16x16x32_bf16 v[248:251],a[128:131],v[48:51],v[248:251]
buffer_load_dwordx4 v7,s[8:11],s21 offen offset:1024 lds
v_mfma_f32_16x16x32_bf16 v[200:203],a[128:131],v[44:47],v[200:203]
ds_read_b128 a[128:131],v0 offset:6144
v_cvt_pk_bf16_f32 v34,v100,v101
v_mfma_f32_16x16x32_bf16 v[204:207],a[132:135],v[44:47],v[204:207]
s_waitcnt lgkmcnt(1)
ds_read_b128 a[132:135],v1 offset:6144
v_cvt_pk_bf16_f32 v35,v102,v103
v_mfma_f32_16x16x32_bf16 v[72:75],a[136:139],a[0:3],0
v_fma_f32 v109,v109,s36,v17
v_fma_f32 v110,v110,s36,v17
v_smfmac_f32_16x16x64_bf16 v[64:67],a[152:155],v[28:35],v18
v_fma_f32 v111,v111,s36,v17
v_mfma_f32_16x16x32_bf16 v[72:75],a[140:143],a[4:7],v[72:75]
v_exp_f32 v108,v108
v_mfma_f32_16x16x32_bf16 v[72:75],a[144:147],a[8:11],v[72:75]
v_exp_f32 v109,v109
v_mfma_f32_16x16x32_bf16 v[72:75],a[148:151],a[12:15],v[72:75]
v_exp_f32 v110,v110
v_mfma_f32_16x16x32_bf16 v[72:75],a[120:123],a[16:19],v[72:75]
v_exp_f32 v111,v111
v_mfma_f32_16x16x32_bf16 v[72:75],a[124:127],a[20:23],v[72:75]
v_cvt_pk_bf16_f32 v38,v108,v109
v_cvt_pk_bf16_f32 v39,v110,v111
v_mfma_f32_16x16x32_bf16 v[80:83],a[124:127],a[44:47],0
v_mfma_f32_16x16x32_bf16 v[80:83],a[120:123],a[40:43],v[80:83]
v_mfma_f32_16x16x32_bf16 v[80:83],a[148:151],a[36:39],v[80:83]
buffer_load_dwordx4 v8,s[8:11],s21 offen offset:2048 lds
v_mfma_f32_16x16x32_bf16 v[80:83],a[144:147],a[32:35],v[80:83]
s_add_u32 s21,s21,12288
v_fma_f32 v72,v72,s36,v13
v_fma_f32 v73,v73,s36,v13
v_mfma_f32_16x16x32_bf16 v[80:83],a[140:143],a[28:31],v[80:83]
s_add_u32 m0,s22,24576
v_fma_f32 v74,v74,s36,v13
v_fma_f32 v75,v75,s36,v13
v_mfma_f32_16x16x32_bf16 v[80:83],a[136:139],a[24:27],v[80:83]
v_exp_f32 v72,v72
v_mfma_f32_16x16x32_bf16 v[88:91],a[136:139],a[48:51],0
v_exp_f32 v73,v73
v_mfma_f32_16x16x32_bf16 v[88:91],a[140:143],a[52:55],v[88:91]
v_exp_f32 v74,v74
v_mfma_f32_16x16x32_bf16 v[88:91],a[144:147],a[56:59],v[88:91]
v_exp_f32 v75,v75
v_mfma_f32_16x16x32_bf16 v[88:91],a[148:151],a[60:63],v[88:91]
v_fma_f32 v80,v80,s36,v14
v_fma_f32 v81,v81,s36,v14
v_mfma_f32_16x16x32_bf16 v[88:91],a[120:123],a[64:67],v[88:91]
v_fma_f32 v82,v82,s36,v14
v_fma_f32 v83,v83,s36,v14
v_mfma_f32_16x16x32_bf16 v[88:91],a[124:127],a[68:71],v[88:91]
v_exp_f32 v80,v80
v_mfma_f32_16x16x32_bf16 v[96:99],a[124:127],a[92:95],0
v_exp_f32 v81,v81
v_mfma_f32_16x16x32_bf16 v[96:99],a[120:123],a[88:91],v[96:99]
v_exp_f32 v82,v82
v_mfma_f32_16x16x32_bf16 v[96:99],a[148:151],a[84:87],v[96:99]
buffer_load_dwordx4 v6,s[4:7],s20 offen offset:0 lds
v_mfma_f32_16x16x32_bf16 v[96:99],a[144:147],a[80:83],v[96:99]
v_fma_f32 v88,v88,s36,v15
v_fma_f32 v89,v89,s36,v15
v_mfma_f32_16x16x32_bf16 v[96:99],a[140:143],a[76:79],v[96:99]
v_exp_f32 v83,v83
v_mfma_f32_16x16x32_bf16 v[96:99],a[136:139],a[72:75],v[96:99]
v_exp_f32 v88,v88
v_mfma_f32_16x16x32_bf16 v[104:107],a[136:139],a[96:99],0
ds_read_b128 a[136:139],v0 offset:6272
v_cvt_pk_bf16_f32 v44,v72,v73
v_mfma_f32_16x16x32_bf16 v[104:107],a[140:143],a[100:103],v[104:107]
ds_read_b128 a[140:143],v1 offset:6272
v_cvt_pk_bf16_f32 v45,v74,v75
v_mfma_f32_16x16x32_bf16 v[104:107],a[144:147],a[104:107],v[104:107]
ds_read_b128 a[144:147],v0 offset:6400
v_cvt_pk_bf16_f32 v48,v80,v81
v_mfma_f32_16x16x32_bf16 v[104:107],a[148:151],a[108:111],v[104:107]
ds_read_b128 a[148:151],v1 offset:6400
v_cvt_pk_bf16_f32 v49,v82,v83
v_mfma_f32_16x16x32_bf16 v[104:107],a[120:123],a[112:115],v[104:107]
v_exp_f32 v89,v89
v_mfma_f32_16x16x32_bf16 v[104:107],a[124:127],a[116:119],v[104:107]
s_waitcnt lgkmcnt(4)
v_cvt_pk_bf16_f32 v52,v88,v89
v_mfma_f32_16x16x32_bf16 v[76:79],a[128:131],a[0:3],0
v_mfma_f32_16x16x32_bf16 v[76:79],a[132:135],a[4:7],v[76:79]
buffer_load_dwordx4 v7,s[4:7],s20 offen offset:1024 lds
s_waitcnt lgkmcnt(3)
v_mfma_f32_16x16x32_bf16 v[76:79],a[136:139],a[8:11],v[76:79]
s_waitcnt lgkmcnt(2)
v_mfma_f32_16x16x32_bf16 v[76:79],a[140:143],a[12:15],v[76:79]
s_waitcnt lgkmcnt(1)
v_mfma_f32_16x16x32_bf16 v[76:79],a[144:147],a[16:19],v[76:79]
s_waitcnt lgkmcnt(0)
v_mfma_f32_16x16x32_bf16 v[76:79],a[148:151],a[20:23],v[76:79]
v_mfma_f32_16x16x32_bf16 v[84:87],a[148:151],a[44:47],0
v_mfma_f32_16x16x32_bf16 v[84:87],a[144:147],a[40:43],v[84:87]
v_mfma_f32_16x16x32_bf16 v[84:87],a[140:143],a[36:39],v[84:87]
v_mfma_f32_16x16x32_bf16 v[84:87],a[136:139],a[32:35],v[84:87]
v_mfma_f32_16x16x32_bf16 v[84:87],a[132:135],a[28:31],v[84:87]
v_mfma_f32_16x16x32_bf16 v[84:87],a[128:131],a[24:27],v[84:87]
v_mfma_f32_16x16x32_bf16 v[92:95],a[128:131],a[48:51],0
v_mfma_f32_16x16x32_bf16 v[92:95],a[132:135],a[52:55],v[92:95]
buffer_load_dwordx4 v8,s[4:7],s20 offen offset:2048 lds
v_mfma_f32_16x16x32_bf16 v[92:95],a[136:139],a[56:59],v[92:95]
s_add_u32 s20,s20,12288
v_mfma_f32_16x16x32_bf16 v[92:95],a[140:143],a[60:63],v[92:95]
v_mfma_f32_16x16x32_bf16 v[92:95],a[144:147],a[64:67],v[92:95]
v_mfma_f32_16x16x32_bf16 v[92:95],a[148:151],a[68:71],v[92:95]
v_mfma_f32_16x16x32_bf16 v[100:103],a[148:151],a[92:95],0
v_mfma_f32_16x16x32_bf16 v[100:103],a[144:147],a[88:91],v[100:103]
ds_read_b64_tr_b16 a[120:121],v2 offset:24576
v_mfma_f32_16x16x32_bf16 v[100:103],a[140:143],a[84:87],v[100:103]
ds_read_b64_tr_b16 a[122:123],v2 offset:30720
v_mfma_f32_16x16x32_bf16 v[100:103],a[136:139],a[80:83],v[100:103]
ds_read_b64_tr_b16 a[124:125],v3 offset:24576
v_mfma_f32_16x16x32_bf16 v[100:103],a[132:135],a[76:79],v[100:103]
ds_read_b64_tr_b16 a[126:127],v3 offset:30720
v_mfma_f32_16x16x32_bf16 v[100:103],a[128:131],a[72:75],v[100:103]
v_mfma_f32_16x16x32_bf16 v[108:111],a[128:131],a[96:99],0
ds_read_b64_tr_b16 a[128:129],v4 offset:24576
v_mfma_f32_16x16x32_bf16 v[108:111],a[132:135],a[100:103],v[108:111]
ds_read_b64_tr_b16 a[130:131],v4 offset:30720
v_mfma_f32_16x16x32_bf16 v[108:111],a[136:139],a[104:107],v[108:111]
ds_read_b64_tr_b16 a[132:133],v5 offset:24576
v_mfma_f32_16x16x32_bf16 v[108:111],a[140:143],a[108:111],v[108:111]
ds_read_b64_tr_b16 a[134:135],v5 offset:30720
v_mfma_f32_16x16x32_bf16 v[108:111],a[144:147],a[112:115],v[108:111]
v_mfma_f32_16x16x32_bf16 v[108:111],a[148:151],a[116:119],v[108:111]
s_mov_b32 s38,0
s_branch L_loop5
L_tr44:
s_waitcnt vmcnt(43)
s_waitcnt lgkmcnt(3)
v_mfma_f32_16x16x32_bf16 v[160:163],a[120:123],v[20:23],v[160:163]
s_add_u32 m0,s24,0
ds_read_b128 a[4:7],v12 offset:0
v_fma_f32 v79,v79,s36,v13
v_mfma_f32_16x16x32_bf16 v[164:167],a[124:127],v[20:23],v[164:167]
ds_read_b128 a[12:15],v12 offset:128
v_fma_f32 v100,v100,s36,v16
v_mfma_f32_16x16x32_bf16 v[212:215],a[124:127],v[24:27],v[212:215]
ds_read_b128 a[20:23],v12 offset:256
v_fma_f32 v101,v101,s36,v16
v_mfma_f32_16x16x32_bf16 v[208:211],a[120:123],v[24:27],v[208:211]
ds_read_b128 a[8:11],v11 offset:128
v_fma_f32 v89,v89,s36,v15
v_mfma_f32_16x16x32_bf16 v[112:115],a[120:123],v[28:31],v[112:115]
ds_read_b128 a[0:3],v11 offset:0
v_fma_f32 v76,v76,s36,v13
v_mfma_f32_16x16x32_bf16 v[116:119],a[124:127],v[28:31],v[116:119]
ds_read_b128 a[16:19],v11 offset:256
v_fma_f32 v83,v83,s36,v14
v_mfma_f32_16x16x32_bf16 a[164:167],a[124:127],v[32:35],a[164:167]
ds_read_b64_tr_b16 a[138:139],v2 offset:30848
v_fma_f32 v90,v90,s36,v15
v_mfma_f32_16x16x32_bf16 a[160:163],a[120:123],v[32:35],a[160:163]
s_waitcnt lgkmcnt(6)
ds_read_b64_tr_b16 a[136:137],v2 offset:24704
v_fma_f32 v88,v88,s36,v15
v_mfma_f32_16x16x32_bf16 a[168:171],a[128:131],v[32:35],a[168:171]
ds_read_b64_tr_b16 a[142:143],v3 offset:30848
ds_read_b64_tr_b16 a[140:141],v3 offset:24704
ds_read_b64_tr_b16 a[146:147],v4 offset:30848
ds_read_b64_tr_b16 a[144:145],v4 offset:24704
ds_read_b64_tr_b16 a[150:151],v5 offset:30848
ds_read_b64_tr_b16 a[148:149],v5 offset:24704
ds_read_b128 a[32:35],v11 offset:6272
v_mfma_f32_16x16x32_bf16 a[172:175],a[132:135],v[32:35],a[172:175]
v_fma_f32 v91,v91,s36,v15
ds_read_b128 a[40:43],v11 offset:6400
v_mfma_f32_16x16x32_bf16 v[124:127],a[132:135],v[28:31],v[124:127]
s_waitcnt lgkmcnt(10)
buffer_load_dwordx4 v6,s[12:15],s28 offen offset:0 nt lds
v_mfma_f32_16x16x32_bf16 v[120:123],a[128:131],v[28:31],v[120:123]
ds_read_b64_tr_b16 a[122:123],v2 offset:30976
ds_read_b64_tr_b16 a[120:121],v2 offset:24832
ds_read_b64_tr_b16 a[124:125],v3 offset:24832
ds_read_b64_tr_b16 a[126:127],v3 offset:30976
ds_read_b128 a[44:47],v12 offset:6400
v_mfma_f32_16x16x32_bf16 v[216:219],a[128:131],v[24:27],v[216:219]
v_fma_f32 v93,v93,s36,v15
ds_read_b128 a[28:31],v12 offset:6144
v_mfma_f32_16x16x32_bf16 v[220:223],a[132:135],v[24:27],v[220:223]
v_fma_f32 v98,v98,s36,v16
ds_read_b128 a[36:39],v12 offset:6272
v_mfma_f32_16x16x32_bf16 v[172:175],a[132:135],v[20:23],v[172:175]
buffer_load_dwordx4 v7,s[12:15],s28 offen offset:1024 nt lds
v_mfma_f32_16x16x32_bf16 v[168:171],a[128:131],v[20:23],v[168:171]
s_waitcnt lgkmcnt(7)
ds_read_b64_tr_b16 a[130:131],v4 offset:30976
ds_read_b128 a[24:27],v11 offset:6144
v_mfma_f32_16x16x32_bf16 v[176:179],a[136:139],v[20:23],v[176:179]
v_fma_f32 v82,v82,s36,v14
v_exp_f32 v93,v93
v_mfma_f32_16x16x32_bf16 v[180:183],a[140:143],v[20:23],v[180:183]
ds_read_b64_tr_b16 a[128:129],v4 offset:24832
v_fma_f32 v85,v85,s36,v14
v_mfma_f32_16x16x32_bf16 v[228:231],a[140:143],v[24:27],v[228:231]
ds_read_b64_tr_b16 a[134:135],v5 offset:30976
v_exp_f32 v82,v82
v_mfma_f32_16x16x32_bf16 v[224:227],a[136:139],v[24:27],v[224:227]
ds_read_b64_tr_b16 a[132:133],v5 offset:24832
v_fma_f32 v84,v84,s36,v14
v_mfma_f32_16x16x32_bf16 v[128:131],a[136:139],v[28:31],v[128:131]
v_exp_f32 v84,v84
v_mfma_f32_16x16x32_bf16 v[132:135],a[140:143],v[28:31],v[132:135]
buffer_load_dwordx4 v8,s[12:15],s28 offen offset:2048 nt lds
v_mfma_f32_16x16x32_bf16 a[180:183],a[140:143],v[32:35],a[180:183]
s_add_u32 s28,s28,3072
v_fma_f32 v103,v103,s36,v16
v_exp_f32 v103,v103
v_mfma_f32_16x16x32_bf16 a[176:179],a[136:139],v[32:35],a[176:179]
s_add_u32 m0,s24,3072
v_fma_f32 v87,v87,s36,v14
v_exp_f32 v87,v87
v_mfma_f32_16x16x32_bf16 a[184:187],a[144:147],v[32:35],a[184:187]
v_fma_f32 v77,v77,s36,v13
v_exp_f32 v77,v77
v_mfma_f32_16x16x32_bf16 a[188:191],a[148:151],v[32:35],a[188:191]
v_fma_f32 v97,v97,s36,v16
v_exp_f32 v91,v91
v_mfma_f32_16x16x32_bf16 v[140:143],a[148:151],v[28:31],v[140:143]
v_fma_f32 v102,v102,s36,v16
v_exp_f32 v85,v85
v_mfma_f32_16x16x32_bf16 v[136:139],a[144:147],v[28:31],v[136:139]
v_exp_f32 v89,v89
v_mfma_f32_16x16x32_bf16 v[232:235],a[144:147],v[24:27],v[232:235]
buffer_load_dwordx4 v6,s[12:15],s28 offen offset:0 nt lds
v_mfma_f32_16x16x32_bf16 v[236:239],a[148:151],v[24:27],v[236:239]
v_fma_f32 v92,v92,s36,v15
v_exp_f32 v101,v101
v_mfma_f32_16x16x32_bf16 v[188:191],a[148:151],v[20:23],v[188:191]
v_fma_f32 v94,v94,s36,v15
v_fma_f32 v95,v95,s36,v15
v_mfma_f32_16x16x32_bf16 v[184:187],a[144:147],v[20:23],v[184:187]
s_waitcnt lgkmcnt(0)
v_exp_f32 v95,v95
v_mfma_f32_16x16x32_bf16 v[192:195],a[120:123],v[20:23],v[192:195]
v_fma_f32 v86,v86,s36,v14
v_fma_f32 v78,v78,s36,v13
v_mfma_f32_16x16x32_bf16 v[196:199],a[124:127],v[20:23],v[196:199]
v_exp_f32 v92,v92
v_mfma_f32_16x16x32_bf16 v[244:247],a[124:127],v[24:27],v[244:247]
v_exp_f32 v78,v78
v_mfma_f32_16x16x32_bf16 v[240:243],a[120:123],v[24:27],v[240:243]
buffer_load_dwordx4 v7,s[12:15],s28 offen offset:1024 nt lds
v_mfma_f32_16x16x32_bf16 v[144:147],a[120:123],v[28:31],v[144:147]
v_exp_f32 v94,v94
v_mfma_f32_16x16x32_bf16 v[148:151],a[124:127],v[28:31],v[148:151]
v_exp_f32 v90,v90
v_mfma_f32_16x16x32_bf16 a[196:199],a[124:127],v[32:35],a[196:199]
v_fma_f32 v96,v96,s36,v16
v_exp_f32 v96,v96
v_mfma_f32_16x16x32_bf16 a[192:195],a[120:123],v[32:35],a[192:195]
v_fma_f32 v99,v99,s36,v16
v_exp_f32 v83,v83
v_mfma_f32_16x16x32_bf16 a[200:203],a[128:131],v[32:35],a[200:203]
v_exp_f32 v97,v97
v_mfma_f32_16x16x32_bf16 a[204:207],a[132:135],v[32:35],a[204:207]
v_exp_f32 v88,v88
v_mfma_f32_16x16x32_bf16 v[156:159],a[132:135],v[28:31],v[156:159]
v_exp_f32 v98,v98
v_mfma_f32_16x16x32_bf16 v[152:155],a[128:131],v[28:31],v[152:155]
buffer_load_dwordx4 v8,s[12:15],s28 offen offset:2048 nt lds
s_waitcnt vmcnt(18)
s_barrier
v_mfma_f32_16x16x32_bf16 v[248:251],a[128:131],v[24:27],v[248:251]
s_add_u32 s28,s28,3072
ds_read_b64_tr_b16 a[138:139],v2 offset:6144
v_exp_f32 v79,v79
v_mfma_f32_16x16x32_bf16 v[252:255],a[132:135],v[24:27],v[252:255]
s_add_u32 m0,s22,0
ds_read_b64_tr_b16 a[136:137],v2 offset:0
buffer_load_dwordx4 v6,s[4:7],s25 offen offset:0 lds
v_mfma_f32_16x16x32_bf16 v[204:207],a[132:135],v[20:23],v[204:207]
buffer_load_dwordx4 v7,s[4:7],s25 offen offset:1024 lds
v_mfma_f32_16x16x32_bf16 v[200:203],a[128:131],v[20:23],v[200:203]
buffer_load_dwordx4 v8,s[4:7],s25 offen offset:2048 lds
ds_read_b64_tr_b16 a[142:143],v3 offset:6144
ds_read_b64_tr_b16 a[140:141],v3 offset:0
ds_read_b64_tr_b16 a[144:145],v4 offset:0
ds_read_b64_tr_b16 a[146:147],v4 offset:6144
ds_read_b64_tr_b16 a[148:149],v5 offset:0
ds_read_b64_tr_b16 a[150:151],v5 offset:6144
v_exp_f32 v100,v100
v_cvt_pk_bf16_f32 v47,v78,v79
v_cvt_pk_bf16_f32 v49,v82,v83
v_exp_f32 v76,v76
v_exp_f32 v102,v102
v_exp_f32 v86,v86
v_cvt_pk_bf16_f32 v59,v102,v103
v_exp_f32 v99,v99
v_cvt_pk_bf16_f32 v50,v84,v85
v_cvt_pk_bf16_f32 v57,v98,v99
v_cvt_pk_bf16_f32 v55,v94,v95
v_cvt_pk_bf16_f32 v54,v92,v93
v_cvt_pk_bf16_f32 v58,v100,v101
v_cvt_pk_bf16_f32 v51,v86,v87
v_cvt_pk_bf16_f32 v53,v90,v91
v_cvt_pk_bf16_f32 v46,v76,v77
v_cvt_pk_bf16_f32 v52,v88,v89
v_cvt_pk_bf16_f32 v56,v96,v97
v_smfmac_f32_16x16x64_bf16 v[60:63],a[152:155],v[44:51],v18
v_subrev_u32 v10,18432,v10
v_smfmac_f32_16x16x64_bf16 v[64:67],a[152:155],v[52:59],v18
s_waitcnt lgkmcnt(0)
v_mfma_f32_16x16x32_bf16 v[160:163],a[136:139],v[44:47],v[160:163]
s_add_u32 s87,s42,18432
ds_read_b64_tr_b16 a[122:123],v2 offset:6272
v_mbcnt_lo_u32_b32 v39,-1,0
v_mfma_f32_16x16x32_bf16 v[164:167],a[140:143],v[44:47],v[164:167]
ds_read_b64_tr_b16 a[120:121],v2 offset:128
v_mbcnt_hi_u32_b32 v39,-1,v39
v_mfma_f32_16x16x32_bf16 v[212:215],a[140:143],v[48:51],v[212:215]
ds_read_b64_tr_b16 a[124:125],v3 offset:128
v_lshrrev_b32 v19,5,v39
v_mfma_f32_16x16x32_bf16 v[208:211],a[136:139],v[48:51],v[208:211]
ds_read_b64_tr_b16 a[126:127],v3 offset:6272
v_and_b32 v38,7,v39
v_mfma_f32_16x16x32_bf16 v[112:115],a[136:139],v[52:55],v[112:115]
ds_read_b64_tr_b16 a[130:131],v4 offset:6272
v_xor_b32 v38,v38,v19
v_mfma_f32_16x16x32_bf16 v[116:119],a[140:143],v[52:55],v[116:119]
ds_read_b64_tr_b16 a[128:129],v4 offset:128
v_and_b32 v19,15,v39
v_mfma_f32_16x16x32_bf16 a[164:167],a[140:143],v[56:59],a[164:167]
ds_read_b64_tr_b16 a[132:133],v5 offset:128
v_lshl_add_u32 v19,v19,7,s24
v_mfma_f32_16x16x32_bf16 a[160:163],a[136:139],v[56:59],a[160:163]
ds_read_b64_tr_b16 a[134:135],v5 offset:6272
v_lshl_add_u32 v19,v38,4,v19
v_mfma_f32_16x16x32_bf16 a[168:171],a[144:147],v[56:59],a[168:171]
ds_read_b64_tr_b16 a[136:137],v2 offset:256
v_bfe_u32 v38,v39,4,1
v_mfma_f32_16x16x32_bf16 a[172:175],a[148:151],v[56:59],a[172:175]
ds_read_b64_tr_b16 a[138:139],v2 offset:6400
v_lshl_add_u32 v36,v38,3,v19
v_mfma_f32_16x16x32_bf16 v[124:127],a[148:151],v[52:55],v[124:127]
ds_read_b64_tr_b16 a[140:141],v3 offset:256
v_bfe_u32 v19,v39,3,1
v_mfma_f32_16x16x32_bf16 v[120:123],a[144:147],v[52:55],v[120:123]
ds_read_b64_tr_b16 a[142:143],v3 offset:6400
v_xor_b32 v38,64,v36
v_mfma_f32_16x16x32_bf16 v[216:219],a[144:147],v[48:51],v[216:219]
v_xor_b32 v37,32,v36
v_xor_b32 v39,96,v36
v_mfma_f32_16x16x32_bf16 v[220:223],a[148:151],v[48:51],v[220:223]
v_lshlrev_b32 v19,11,v19
v_add_u32 v36,v36,v19
v_mfma_f32_16x16x32_bf16 v[172:175],a[148:151],v[44:47],v[172:175]
ds_read_b64_tr_b16 a[150:151],v5 offset:6400
v_add_u32 v38,v38,v19
v_mfma_f32_16x16x32_bf16 v[168:171],a[144:147],v[44:47],v[168:171]
s_waitcnt lgkmcnt(4)
ds_read_b64_tr_b16 a[144:145],v4 offset:256
v_add_u32 v39,v39,v19
v_mfma_f32_16x16x32_bf16 v[176:179],a[120:123],v[44:47],v[176:179]
ds_read_b64_tr_b16 a[146:147],v4 offset:6400
v_add_u32 v37,v37,v19
v_mfma_f32_16x16x32_bf16 v[180:183],a[124:127],v[44:47],v[180:183]
ds_read_b64_tr_b16 a[148:149],v5 offset:256
v_add_f32 v62,v62,v63
v_mfma_f32_16x16x32_bf16 v[228:231],a[124:127],v[48:51],v[228:231]
v_rcp_f32 v62,v62
v_mfma_f32_16x16x32_bf16 v[224:227],a[120:123],v[48:51],v[224:227]
v_add_f32 v66,v66,v67
v_accvgpr_read_b32 v74,a162
v_mfma_f32_16x16x32_bf16 v[128:131],a[120:123],v[52:55],v[128:131]
v_accvgpr_read_b32 v72,a160
v_rcp_f32 v66,v66
v_mfma_f32_16x16x32_bf16 v[132:135],a[124:127],v[52:55],v[132:135]
v_accvgpr_read_b32 v97,a173
v_accvgpr_read_b32 v81,a165
v_mfma_f32_16x16x32_bf16 a[180:183],a[124:127],v[56:59],a[180:183]
v_accvgpr_read_b32 v96,a172
v_accvgpr_read_b32 v83,a167
v_accvgpr_read_b32 v91,a171
v_accvgpr_read_b32 v99,a175
v_accvgpr_read_b32 v75,a163
v_pk_mul_f32 v[230:231],v[230:231],v[62:63] op_sel_hi:[1,0]
v_pk_mul_f32 v[212:213],v[212:213],v[62:63] op_sel_hi:[1,0]
v_pk_mul_f32 v[224:225],v[224:225],v[62:63] op_sel_hi:[1,0]
v_pk_mul_f32 v[208:209],v[208:209],v[62:63] op_sel_hi:[1,0]
v_pk_mul_f32 v[210:211],v[210:211],v[62:63] op_sel_hi:[1,0]
v_pk_mul_f32 v[226:227],v[226:227],v[62:63] op_sel_hi:[1,0]
v_pk_mul_f32 v[214:215],v[214:215],v[62:63] op_sel_hi:[1,0]
v_pk_mul_f32 v[228:229],v[228:229],v[62:63] op_sel_hi:[1,0]
v_accvgpr_read_b32 v84,a180
v_accvgpr_read_b32 v85,a181
v_mfma_f32_16x16x32_bf16 a[176:179],a[120:123],v[56:59],a[176:179]
v_accvgpr_read_b32 v86,a182
v_accvgpr_read_b32 v89,a169
v_mfma_f32_16x16x32_bf16 a[184:187],a[128:131],v[56:59],a[184:187]
v_accvgpr_read_b32 v98,a174
v_accvgpr_read_b32 v90,a170
v_mfma_f32_16x16x32_bf16 a[188:191],a[132:135],v[56:59],a[188:191]
v_accvgpr_read_b32 v87,a183
v_accvgpr_read_b32 v82,a166
v_mfma_f32_16x16x32_bf16 v[140:143],a[132:135],v[52:55],v[140:143]
v_accvgpr_read_b32 v76,a176
v_accvgpr_read_b32 v78,a178
v_mfma_f32_16x16x32_bf16 v[136:139],a[128:131],v[52:55],v[136:139]
v_accvgpr_read_b32 v77,a177
v_accvgpr_read_b32 v92,a184
v_mfma_f32_16x16x32_bf16 v[232:235],a[128:131],v[48:51],v[232:235]
v_accvgpr_read_b32 v101,a189
v_accvgpr_read_b32 v103,a191
v_mfma_f32_16x16x32_bf16 v[236:239],a[132:135],v[48:51],v[236:239]
v_accvgpr_read_b32 v100,a188
v_accvgpr_read_b32 v102,a190
v_mfma_f32_16x16x32_bf16 v[188:191],a[132:135],v[44:47],v[188:191]
v_accvgpr_read_b32 v94,a186
v_accvgpr_read_b32 v79,a179
v_mfma_f32_16x16x32_bf16 v[184:187],a[128:131],v[44:47],v[184:187]
v_accvgpr_read_b32 v88,a168
v_accvgpr_read_b32 v95,a187
v_accvgpr_read_b32 v93,a185
v_accvgpr_read_b32 v80,a164
v_accvgpr_read_b32 v73,a161
v_pk_mul_f32 v[234:235],v[234:235],v[62:63] op_sel_hi:[1,0]
v_pk_mul_f32 v[216:217],v[216:217],v[62:63] op_sel_hi:[1,0]
v_pk_mul_f32 v[232:233],v[232:233],v[62:63] op_sel_hi:[1,0]
v_pk_mul_f32 v[218:219],v[218:219],v[62:63] op_sel_hi:[1,0]
v_add_f32 v64,v64,v65
v_rcp_f32 v64,v64
s_waitcnt lgkmcnt(0)
v_mfma_f32_16x16x32_bf16 v[192:195],a[136:139],v[44:47],v[192:195]
v_cvt_pk_bf16_f32 v208,v208,v209
v_cvt_pk_bf16_f32 v224,v224,v225
v_cvt_pk_bf16_f32 v212,v212,v213
v_cvt_pk_bf16_f32 v213,v214,v215
v_cvt_pk_bf16_f32 v225,v226,v227
v_pk_mul_f32 v[74:75],v[74:75],v[66:67] op_sel_hi:[1,0]
v_pk_mul_f32 v[102:103],v[102:103],v[66:67] op_sel_hi:[1,0]
v_pk_mul_f32 v[72:73],v[72:73],v[66:67] op_sel_hi:[1,0]
v_pk_mul_f32 v[220:221],v[220:221],v[62:63] op_sel_hi:[1,0]
v_pk_mul_f32 v[80:81],v[80:81],v[66:67] op_sel_hi:[1,0]
v_pk_mul_f32 v[82:83],v[82:83],v[66:67] op_sel_hi:[1,0]
v_pk_mul_f32 v[88:89],v[88:89],v[66:67] op_sel_hi:[1,0]
v_pk_mul_f32 v[98:99],v[98:99],v[66:67] op_sel_hi:[1,0]
v_pk_mul_f32 v[84:85],v[84:85],v[66:67] op_sel_hi:[1,0]
v_pk_mul_f32 v[92:93],v[92:93],v[66:67] op_sel_hi:[1,0]
v_pk_mul_f32 v[90:91],v[90:91],v[66:67] op_sel_hi:[1,0]
v_pk_mul_f32 v[96:97],v[96:97],v[66:67] op_sel_hi:[1,0]
v_pk_mul_f32 v[238:239],v[238:239],v[62:63] op_sel_hi:[1,0]
v_pk_mul_f32 v[94:95],v[94:95],v[66:67] op_sel_hi:[1,0]
v_pk_mul_f32 v[222:223],v[222:223],v[62:63] op_sel_hi:[1,0]
v_pk_mul_f32 v[100:101],v[100:101],v[66:67] op_sel_hi:[1,0]
v_pk_mul_f32 v[78:79],v[78:79],v[66:67] op_sel_hi:[1,0]
v_pk_mul_f32 v[86:87],v[86:87],v[66:67] op_sel_hi:[1,0]
v_pk_mul_f32 v[236:237],v[236:237],v[62:63] op_sel_hi:[1,0]
v_pk_mul_f32 v[76:77],v[76:77],v[66:67] op_sel_hi:[1,0]
v_cvt_pk_bf16_f32 v236,v236,v237
v_cvt_pk_bf16_f32 v209,v210,v211
v_mfma_f32_16x16x32_bf16 v[196:199],a[140:143],v[44:47],v[196:199]
ds_write2st64_b64 v36,v[208:209],v[224:225] offset0:12 offset1:14
v_mfma_f32_16x16x32_bf16 v[244:247],a[140:143],v[48:51],v[244:247]
v_sub_u32 v36,v36,v19
v_cvt_pk_bf16_f32 v232,v232,v233
v_mfma_f32_16x16x32_bf16 v[240:243],a[136:139],v[48:51],v[240:243]
v_cvt_pk_bf16_f32 v233,v234,v235
v_cvt_pk_bf16_f32 v76,v76,v77
v_mfma_f32_16x16x32_bf16 v[144:147],a[136:139],v[52:55],v[144:147]
v_cvt_pk_bf16_f32 v228,v228,v229
v_cvt_pk_bf16_f32 v229,v230,v231
v_mfma_f32_16x16x32_bf16 v[148:151],a[140:143],v[52:55],v[148:151]
ds_write2st64_b64 v37,v[212:213],v[228:229] offset0:12 offset1:14
v_mfma_f32_16x16x32_bf16 a[196:199],a[140:143],v[56:59],a[196:199]
v_sub_u32 v37,v37,v19
v_cvt_pk_bf16_f32 v216,v216,v217
v_cvt_pk_bf16_f32 v217,v218,v219
v_cvt_pk_bf16_f32 v220,v220,v221
v_cvt_pk_bf16_f32 v237,v238,v239
v_pk_mul_f32 v[118:119],v[118:119],v[64:65] op_sel_hi:[1,0]
v_pk_mul_f32 v[112:113],v[112:113],v[64:65] op_sel_hi:[1,0]
v_pk_mul_f32 v[116:117],v[116:117],v[64:65] op_sel_hi:[1,0]
v_pk_mul_f32 v[244:245],v[244:245],v[62:63] op_sel_hi:[1,0]
v_pk_mul_f32 v[114:115],v[114:115],v[64:65] op_sel_hi:[1,0]
v_pk_mul_f32 v[242:243],v[242:243],v[62:63] op_sel_hi:[1,0]
v_pk_mul_f32 v[246:247],v[246:247],v[62:63] op_sel_hi:[1,0]
ds_write2st64_b64 v38,v[216:217],v[232:233] offset0:12 offset1:14
v_pk_mul_f32 v[240:241],v[240:241],v[62:63] op_sel_hi:[1,0]
v_sub_u32 v38,v38,v19
v_cvt_pk_bf16_f32 v77,v78,v79
v_mfma_f32_16x16x32_bf16 a[192:195],a[136:139],v[56:59],a[192:195]
s_waitcnt vmcnt(15)
ds_read_b128 a[68:71],v12 offset:12544
v_cvt_pk_bf16_f32 v221,v222,v223
v_mfma_f32_16x16x32_bf16 a[200:203],a[144:147],v[56:59],a[200:203]
ds_read_b128 a[64:67],v11 offset:12544
v_cvt_pk_bf16_f32 v72,v72,v73
v_mfma_f32_16x16x32_bf16 a[204:207],a[148:151],v[56:59],a[204:207]
ds_read_b128 a[60:63],v12 offset:12416
v_cvt_pk_bf16_f32 v73,v74,v75
v_mfma_f32_16x16x32_bf16 v[156:159],a[148:151],v[52:55],v[156:159]
ds_read_b128 a[56:59],v11 offset:12416
v_accvgpr_read_b32 v214,a194
v_mfma_f32_16x16x32_bf16 v[152:155],a[144:147],v[52:55],v[152:155]
ds_read_b128 a[52:55],v12 offset:12288
v_accvgpr_read_b32 v212,a192
v_mfma_f32_16x16x32_bf16 v[248:251],a[144:147],v[48:51],v[248:251]
ds_read_b128 a[48:51],v11 offset:12288
v_accvgpr_read_b32 v215,a195
v_mfma_f32_16x16x32_bf16 v[252:255],a[148:151],v[48:51],v[252:255]
ds_write2st64_b64 v39,v[220:221],v[236:237] offset0:12 offset1:14
v_mfma_f32_16x16x32_bf16 v[204:207],a[148:151],v[44:47],v[204:207]
v_sub_u32 v39,v39,v19
v_accvgpr_read_b32 v213,a193
v_mfma_f32_16x16x32_bf16 v[200:203],a[144:147],v[44:47],v[200:203]
v_accvgpr_read_b32 v230,a198
v_accvgpr_read_b32 v228,a196
v_accvgpr_read_b32 v231,a199
v_accvgpr_read_b32 v229,a197
v_cvt_pk_bf16_f32 v80,v80,v81
v_pk_mul_f32 v[248:249],v[248:249],v[62:63] op_sel_hi:[1,0]
v_pk_mul_f32 v[250:251],v[250:251],v[62:63] op_sel_hi:[1,0]
v_pk_mul_f32 v[122:123],v[122:123],v[64:65] op_sel_hi:[1,0]
ds_write2st64_b64 v36,v[72:73],v[76:77] offset0:36 offset1:40
v_pk_mul_f32 v[120:121],v[120:121],v[64:65] op_sel_hi:[1,0]
v_add_u32 v36,v36,v19
v_accvgpr_read_b32 v216,a200
v_cvt_pk_bf16_f32 v84,v84,v85
v_accvgpr_read_b32 v218,a202
v_cvt_pk_bf16_f32 v81,v82,v83
v_accvgpr_read_b32 v219,a203
v_accvgpr_read_b32 v217,a201
v_cvt_pk_bf16_f32 v85,v86,v87
v_add_f32 v60,v60,v61
v_rcp_f32 v60,v60
v_accvgpr_read_b32 v232,a204
v_min3_f32 v61,v60,v62,v64
v_min_f32 v61,v61,v66
ds_write2st64_b64 v37,v[80:81],v[84:85] offset0:36 offset1:40
v_add_u32 v37,v37,v19
v_cmp_nlt_f32 vcc,s37,v61
v_accvgpr_read_b32 v233,a205
v_accvgpr_read_b32 v235,a207
v_accvgpr_read_b32 v234,a206
v_cvt_pk_bf16_f32 v88,v88,v89
v_cvt_pk_bf16_f32 v92,v92,v93
v_cvt_pk_bf16_f32 v93,v94,v95
v_cvt_pk_bf16_f32 v89,v90,v91
v_cvt_pk_bf16_f32 v100,v100,v101
v_cvt_pk_bf16_f32 v96,v96,v97
v_cvt_pk_bf16_f32 v101,v102,v103
v_cvt_pk_bf16_f32 v97,v98,v99
v_cvt_pk_bf16_f32 v248,v248,v249
ds_write2st64_b64 v38,v[88:89],v[92:93] offset0:36 offset1:40
v_add_u32 v38,v38,v19
v_cvt_pk_bf16_f32 v116,v116,v117
v_cvt_pk_bf16_f32 v112,v112,v113
v_cvt_pk_bf16_f32 v120,v120,v121
v_cvt_pk_bf16_f32 v240,v240,v241
v_cvt_pk_bf16_f32 v241,v242,v243
v_cvt_pk_bf16_f32 v117,v118,v119
v_cvt_pk_bf16_f32 v249,v250,v251
v_cvt_pk_bf16_f32 v121,v122,v123
v_cvt_pk_bf16_f32 v244,v244,v245
v_cvt_pk_bf16_f32 v245,v246,v247
v_cvt_pk_bf16_f32 v113,v114,v115
v_mov_b32 v63,0
v_mov_b32 v65,0
ds_write2st64_b64 v39,v[96:97],v[100:101] offset0:36 offset1:40
v_add_u32 v39,v39,v19
v_mov_b32 v67,0
v_mov_b32 v61,0
s_cmp_lg_u64 vcc,0
s_cselect_b32 s62,s32,0
ds_read_b128 v[104:107],v10 offset:18432
s_or_b32 s31,s31,s62
s_lshl_b32 s32,s32,1
s_add_u32 m0,s23,0
ds_read_b128 v[108:111],v10 offset:19456
ds_read_b128 v[208:211],v10 offset:20480
ds_read_b128 v[224:227],v10 offset:21504
ds_write2st64_b64 v36,v[240:241],v[112:113] offset0:16 offset1:24
v_sub_u32 v36,v36,v19
s_waitcnt vmcnt(0)
s_barrier
ds_read_b128 a[140:143],v1 offset:256
s_waitcnt lgkmcnt(5)
buffer_store_dwordx4 v[104:107],v9,s[16:19],s87 offen offset:0 nt
ds_read_b128 a[136:139],v0 offset:256
ds_read_b128 a[132:135],v1 offset:128
ds_read_b128 a[128:131],v0 offset:128
ds_write2st64_b64 v37,v[244:245],v[116:117] offset0:16 offset1:24
v_sub_u32 v37,v37,v19
buffer_load_dwordx4 v6,s[8:11],s25 offen offset:0 lds
ds_read_b128 a[124:127],v1 offset:0
s_waitcnt lgkmcnt(5)
v_mfma_f32_16x16x32_bf16 v[72:75],a[140:143],a[20:23],0
buffer_store_dwordx4 v[108:111],v9,s[16:19],s87 offen offset:3072 nt
ds_read_b128 a[120:123],v0 offset:0
v_pk_mul_f32 v[124:125],v[124:125],v[64:65] op_sel_hi:[1,0]
v_pk_mul_f32 v[254:255],v[254:255],v[62:63] op_sel_hi:[1,0]
v_pk_mul_f32 v[212:213],v[212:213],v[66:67] op_sel_hi:[1,0]
v_pk_mul_f32 v[214:215],v[214:215],v[66:67] op_sel_hi:[1,0]
ds_read_b128 a[144:147],v0 offset:6144
v_pk_mul_f32 v[126:127],v[126:127],v[64:65] op_sel_hi:[1,0]
ds_read_b128 a[148:151],v1 offset:6144
buffer_store_dwordx4 v[208:211],v9,s[16:19],s87 offen offset:128 nt
v_pk_mul_f32 v[252:253],v[252:253],v[62:63] op_sel_hi:[1,0]
v_cvt_pk_bf16_f32 v124,v124,v125
v_cvt_pk_bf16_f32 v252,v252,v253
s_waitcnt lgkmcnt(4)
v_mfma_f32_16x16x32_bf16 v[72:75],a[136:139],a[16:19],v[72:75]
v_cvt_pk_bf16_f32 v253,v254,v255
v_cvt_pk_bf16_f32 v125,v126,v127
v_cvt_pk_bf16_f32 v212,v212,v213
v_cvt_pk_bf16_f32 v213,v214,v215
ds_write2st64_b64 v38,v[248:249],v[120:121] offset0:16 offset1:24
v_pk_mul_f32 v[228:229],v[228:229],v[66:67] op_sel_hi:[1,0]
v_pk_mul_f32 v[230:231],v[230:231],v[66:67] op_sel_hi:[1,0]
v_sub_u32 v38,v38,v19
v_cvt_pk_bf16_f32 v228,v228,v229
v_mfma_f32_16x16x32_bf16 v[72:75],a[132:135],a[12:15],v[72:75]
buffer_load_dwordx4 v7,s[8:11],s25 offen offset:1024 lds
v_mfma_f32_16x16x32_bf16 v[72:75],a[128:131],a[8:11],v[72:75]
buffer_store_dwordx4 v[224:227],v9,s[16:19],s87 offen offset:3200 nt
v_cvt_pk_bf16_f32 v229,v230,v231
v_mov_b32 v62,0
s_waitcnt lgkmcnt(1)
v_mfma_f32_16x16x32_bf16 v[72:75],a[124:127],a[4:7],v[72:75]
v_mfma_f32_16x16x32_bf16 v[72:75],a[120:123],a[0:3],v[72:75]
buffer_load_dwordx4 v8,s[8:11],s25 offen offset:2048 lds
ds_write2st64_b64 v39,v[252:253],v[124:125] offset0:16 offset1:24
v_pk_mul_f32 v[218:219],v[218:219],v[66:67] op_sel_hi:[1,0]
v_pk_mul_f32 v[216:217],v[216:217],v[66:67] op_sel_hi:[1,0]
v_sub_u32 v39,v39,v19
v_cvt_pk_bf16_f32 v216,v216,v217
v_mfma_f32_16x16x32_bf16 v[80:83],a[120:123],a[24:27],0
s_waitcnt vmcnt(10)
ds_read_b128 a[72:75],v11 offset:0
v_max3_f32 v44,v72,v73,v74
v_mfma_f32_16x16x32_bf16 v[80:83],a[124:127],a[28:31],v[80:83]
s_mov_b32 s27,s42
ds_read_b128 a[76:79],v12 offset:0
v_max_f32 v44,v44,v75
v_mfma_f32_16x16x32_bf16 v[80:83],a[128:131],a[32:35],v[80:83]
s_mov_b32 s42,s41
ds_read_b128 a[80:83],v11 offset:128
v_mov_b32 v45,v44
ds_read_b128 a[84:87],v12 offset:128
v_pk_mul_f32 v[232:233],v[232:233],v[66:67] op_sel_hi:[1,0]
ds_read_b128 a[88:91],v11 offset:256
v_pk_mul_f32 v[234:235],v[234:235],v[66:67] op_sel_hi:[1,0]
v_permlane32_swap_b32 v45,v44
v_max_f32 v44,v44,v45
v_mfma_f32_16x16x32_bf16 v[80:83],a[132:135],a[36:39],v[80:83]
s_add_u32 s69,s69,1
ds_read_b128 a[92:95],v12 offset:256
v_mov_b32 v45,v44
v_mfma_f32_16x16x32_bf16 v[80:83],a[136:139],a[40:43],v[80:83]
s_lshl_b32 s62,s69,5
ds_write_b64 v36,v[212:213] offset:18432
v_mfma_f32_16x16x32_bf16 v[80:83],a[140:143],a[44:47],v[80:83]
s_add_u32 s62,s62,s34
v_add_u32 v36,v36,v19
v_permlane16_swap_b32 v45,v44
v_max_f32 v44,v44,v45
v_mul_f32_e64 v13,-s36,v44
v_pk_mul_f32 v[146:147],v[146:147],v[64:65] op_sel_hi:[1,0]
ds_write_b64 v37,v[228:229] offset:18432
v_pk_mul_f32 v[144:145],v[144:145],v[64:65] op_sel_hi:[1,0]
v_pk_mul_f32 v[128:129],v[128:129],v[64:65] op_sel_hi:[1,0]
v_pk_mul_f32 v[130:131],v[130:131],v[64:65] op_sel_hi:[1,0]
v_add_u32 v37,v37,v19
v_fma_f32 v72,v72,s36,v13
v_mfma_f32_16x16x32_bf16 v[88:91],a[140:143],a[68:71],0
s_mul_i32 s63,s62,171
v_fma_f32 v75,v75,s36,v13
v_exp_f32 v72,v72
v_mfma_f32_16x16x32_bf16 v[88:91],a[136:139],a[64:67],v[88:91]
s_lshr_b32 s63,s63,9
v_fma_f32 v73,v73,s36,v13
v_exp_f32 v73,v73
v_mfma_f32_16x16x32_bf16 v[88:91],a[132:135],a[60:63],v[88:91]
s_mul_i32 s64,s63,3
v_fma_f32 v74,v74,s36,v13
v_exp_f32 v74,v74
v_exp_f32 v75,v75
v_pk_mul_f32 v[148:149],v[148:149],v[64:65] op_sel_hi:[1,0]
v_pk_mul_f32 v[150:151],v[150:151],v[64:65] op_sel_hi:[1,0]
v_pk_mul_f32 v[132:133],v[132:133],v[64:65] op_sel_hi:[1,0]
v_pk_mul_f32 v[134:135],v[134:135],v[64:65] op_sel_hi:[1,0]
v_cvt_pk_bf16_f32 v20,v72,v73
v_cvt_pk_bf16_f32 v21,v74,v75
v_mfma_f32_16x16x32_bf16 v[88:91],a[128:131],a[56:59],v[88:91]
s_sub_u32 s62,s62,s64
v_max3_f32 v48,v80,v81,v82
v_max_f32 v48,v48,v83
v_mfma_f32_16x16x32_bf16 v[88:91],a[124:127],a[52:55],v[88:91]
s_add_u32 s63,s63,s33
v_mov_b32 v49,v48
v_cvt_pk_bf16_f32 v217,v218,v219
v_mfma_f32_16x16x32_bf16 v[88:91],a[120:123],a[48:51],v[88:91]
s_mul_i32 s30,s63,196608
ds_write_b64 v38,v[216:217] offset:18432
s_waitcnt lgkmcnt(1)
v_mfma_f32_16x16x32_bf16 v[96:99],a[120:123],a[72:75],0
s_mul_i32 s41,s63,325632
ds_read_b128 a[120:123],v0 offset:6272
v_add_u32 v38,v38,v19
v_permlane32_swap_b32 v49,v48
v_max_f32 v48,v48,v49
v_pk_mul_f32 v[136:137],v[136:137],v[64:65] op_sel_hi:[1,0]
v_pk_mul_f32 v[152:153],v[152:153],v[64:65] op_sel_hi:[1,0]
v_pk_mul_f32 v[138:139],v[138:139],v[64:65] op_sel_hi:[1,0]
v_pk_mul_f32 v[154:155],v[154:155],v[64:65] op_sel_hi:[1,0]
v_mov_b32 v49,v48
v_max3_f32 v52,v88,v89,v90
v_mfma_f32_16x16x32_bf16 v[96:99],a[124:127],a[76:79],v[96:99]
s_lshl_b32 s63,s3,2
ds_read_b128 a[124:127],v1 offset:6272
v_permlane16_swap_b32 v49,v48
v_mfma_f32_16x16x32_bf16 v[96:99],a[128:131],a[80:83],v[96:99]
s_add_u32 s64,s63,21
ds_read_b128 a[128:131],v0 offset:6400
v_max_f32 v48,v48,v49
v_mfma_f32_16x16x32_bf16 v[96:99],a[132:135],a[84:87],v[96:99]
s_cmp_eq_u32 s3,0
ds_read_b128 a[132:135],v1 offset:6400
v_mul_f32_e64 v14,-s36,v48
v_fma_f32 v82,v82,s36,v14
v_fma_f32 v80,v80,s36,v14
v_fma_f32 v83,v83,s36,v14
v_pk_mul_f32 v[158:159],v[158:159],v[64:65] op_sel_hi:[1,0]
v_pk_mul_f32 v[156:157],v[156:157],v[64:65] op_sel_hi:[1,0]
v_pk_mul_f32 v[140:141],v[140:141],v[64:65] op_sel_hi:[1,0]
v_pk_mul_f32 v[142:143],v[142:143],v[64:65] op_sel_hi:[1,0]
v_exp_f32 v83,v83
v_exp_f32 v80,v80
v_mfma_f32_16x16x32_bf16 v[96:99],a[136:139],a[88:91],v[96:99]
s_cselect_b32 s64,20,s64
ds_read_b128 a[136:139],v0 offset:12288
v_fma_f32 v81,v81,s36,v14
v_mfma_f32_16x16x32_bf16 v[96:99],a[140:143],a[92:95],v[96:99]
s_cselect_b32 s40,1,0
ds_read_b128 a[140:143],v1 offset:12288
v_exp_f32 v81,v81
v_mfma_f32_16x16x32_bf16 v[76:79],a[144:147],a[0:3],0
s_add_u32 s65,s63,37
v_exp_f32 v82,v82
v_cvt_pk_bf16_f32 v24,v80,v81
v_cvt_pk_bf16_f32 v25,v82,v83
v_max_f32 v52,v52,v91
v_pk_mul_f32 v[160:161],v[160:161],v[60:61] op_sel_hi:[1,0]
v_pk_mul_f32 v[162:163],v[162:163],v[60:61] op_sel_hi:[1,0]
v_pk_mul_f32 v[176:177],v[176:177],v[60:61] op_sel_hi:[1,0]
v_pk_mul_f32 v[178:179],v[178:179],v[60:61] op_sel_hi:[1,0]
v_mov_b32 v53,v52
v_max3_f32 v56,v96,v97,v98
v_mfma_f32_16x16x32_bf16 v[76:79],a[148:151],a[4:7],v[76:79]
s_cmp_eq_u32 s62,2
v_permlane32_swap_b32 v53,v52
s_waitcnt lgkmcnt(2)
v_mfma_f32_16x16x32_bf16 v[76:79],a[120:123],a[8:11],v[76:79]
s_cselect_b32 s64,s65,s64
v_max_f32 v52,v52,v53
v_mov_b32 v53,v52
v_mfma_f32_16x16x32_bf16 v[76:79],a[124:127],a[12:15],v[76:79]
s_cselect_b32 s40,0,s40
v_permlane16_swap_b32 v53,v52
v_max_f32 v52,v52,v53
v_mul_f32_e64 v15,-s36,v52
v_fma_f32 v88,v88,s36,v15
v_pk_mul_f32 v[180:181],v[180:181],v[60:61] op_sel_hi:[1,0]
v_pk_mul_f32 v[164:165],v[164:165],v[60:61] op_sel_hi:[1,0]
v_pk_mul_f32 v[166:167],v[166:167],v[60:61] op_sel_hi:[1,0]
v_pk_mul_f32 v[182:183],v[182:183],v[60:61] op_sel_hi:[1,0]
v_fma_f32 v91,v91,s36,v15
v_exp_f32 v88,v88
v_mfma_f32_16x16x32_bf16 v[76:79],a[128:131],a[16:19],v[76:79]
s_add_u32 s65,s63,s3
v_fma_f32 v90,v90,s36,v15
v_fma_f32 v89,v89,s36,v15
v_mfma_f32_16x16x32_bf16 v[76:79],a[132:135],a[20:23],v[76:79]
s_cmp_eq_u32 s62,0
v_exp_f32 v89,v89
v_mfma_f32_16x16x32_bf16 v[84:87],a[132:135],a[44:47],0
s_cselect_b32 s64,s65,s64
v_exp_f32 v91,v91
v_mfma_f32_16x16x32_bf16 v[84:87],a[128:131],a[40:43],v[84:87]
s_cselect_b32 s40,1,s40
v_exp_f32 v90,v90
v_cvt_pk_bf16_f32 v28,v88,v89
v_cvt_pk_bf16_f32 v29,v90,v91
v_max_f32 v56,v56,v99
v_pk_mul_f32 v[170:171],v[170:171],v[60:61] op_sel_hi:[1,0]
v_pk_mul_f32 v[186:187],v[186:187],v[60:61] op_sel_hi:[1,0]
v_pk_mul_f32 v[184:185],v[184:185],v[60:61] op_sel_hi:[1,0]
v_pk_mul_f32 v[168:169],v[168:169],v[60:61] op_sel_hi:[1,0]
v_mov_b32 v57,v56
v_fma_f32 v79,v79,s36,v13
v_mfma_f32_16x16x32_bf16 v[84:87],a[124:127],a[36:39],v[84:87]
s_mul_i32 s64,s64,6144
v_permlane32_swap_b32 v57,v56
v_mfma_f32_16x16x32_bf16 v[84:87],a[120:123],a[32:35],v[84:87]
s_add_u32 s41,s41,s64
v_max_f32 v56,v56,v57
v_mov_b32 v57,v56
v_mfma_f32_16x16x32_bf16 v[84:87],a[148:151],a[28:31],v[84:87]
s_cmp_ge_u32 s69,6
v_permlane16_swap_b32 v57,v56
v_max_f32 v56,v56,v57
v_mul_f32_e64 v16,-s36,v56
v_fma_f32 v97,v97,s36,v16
v_pk_mul_f32 v[188:189],v[188:189],v[60:61] op_sel_hi:[1,0]
v_pk_mul_f32 v[172:173],v[172:173],v[60:61] op_sel_hi:[1,0]
v_pk_mul_f32 v[190:191],v[190:191],v[60:61] op_sel_hi:[1,0]
v_pk_mul_f32 v[174:175],v[174:175],v[60:61] op_sel_hi:[1,0]
v_fma_f32 v99,v99,s36,v16
v_fma_f32 v98,v98,s36,v16
v_mfma_f32_16x16x32_bf16 v[84:87],a[144:147],a[24:27],v[84:87]
s_cselect_b32 s41,166723584,s41
v_exp_f32 v97,v97
v_mfma_f32_16x16x32_bf16 v[92:95],a[144:147],a[48:51],0
s_cselect_b32 s30,100663296,s30
v_exp_f32 v98,v98
v_mfma_f32_16x16x32_bf16 v[92:95],a[148:151],a[52:55],v[92:95]
s_add_u32 s25,s30,s22
v_exp_f32 v99,v99
v_fma_f32 v96,v96,s36,v16
v_exp_f32 v96,v96
v_pk_mul_f32 v[194:195],v[194:195],v[60:61] op_sel_hi:[1,0]
v_pk_mul_f32 v[192:193],v[192:193],v[60:61] op_sel_hi:[1,0]
v_cvt_pk_bf16_f32 v32,v96,v97
v_cvt_pk_bf16_f32 v33,v98,v99
v_mfma_f32_16x16x32_bf16 v[92:95],a[120:123],a[56:59],v[92:95]
s_add_u32 s26,s25,12288
v_fma_f32 v78,v78,s36,v13
v_fma_f32 v77,v77,s36,v13
v_mfma_f32_16x16x32_bf16 v[92:95],a[124:127],a[60:63],v[92:95]
s_add_u32 m0,s23,24576
v_fma_f32 v76,v76,s36,v13
v_exp_f32 v79,v79
v_mfma_f32_16x16x32_bf16 v[92:95],a[128:131],a[64:67],v[92:95]
s_mov_b32 s28,s41
buffer_load_dwordx4 v6,s[8:11],s21 offen offset:0 lds
buffer_load_dwordx4 v7,s[8:11],s21 offen offset:1024 lds
v_pk_mul_f32 v[198:199],v[198:199],v[60:61] op_sel_hi:[1,0]
v_pk_mul_f32 v[196:197],v[196:197],v[60:61] op_sel_hi:[1,0]
v_exp_f32 v76,v76
v_exp_f32 v78,v78
v_mfma_f32_16x16x32_bf16 v[92:95],a[132:135],a[68:71],v[92:95]
s_mov_b32 s29,s24
v_cvt_pk_bf16_f32 v23,v78,v79
v_exp_f32 v77,v77
v_mfma_f32_16x16x32_bf16 v[100:103],a[132:135],a[92:95],0
ds_read_b128 a[132:135],v1 offset:18432
v_cvt_pk_bf16_f32 v22,v76,v77
v_mfma_f32_16x16x32_bf16 v[100:103],a[128:131],a[88:91],v[100:103]
ds_read_b128 a[128:131],v0 offset:18432
buffer_load_dwordx4 v8,s[8:11],s21 offen offset:2048 lds
v_mfma_f32_16x16x32_bf16 v[100:103],a[124:127],a[84:87],v[100:103]
s_add_u32 s21,s21,12288
ds_read_b128 a[124:127],v1 offset:12544
v_cvt_pk_bf16_f32 v232,v232,v233
v_cvt_pk_bf16_f32 v233,v234,v235
v_cvt_pk_bf16_f32 v128,v128,v129
v_cvt_pk_bf16_f32 v129,v130,v131
v_pk_mul_f32 v[200:201],v[200:201],v[60:61] op_sel_hi:[1,0]
ds_write_b64 v39,v[232:233] offset:18432
v_pk_mul_f32 v[202:203],v[202:203],v[60:61] op_sel_hi:[1,0]
v_add_u32 v39,v39,v19
v_cvt_pk_bf16_f32 v132,v132,v133
v_mfma_f32_16x16x32_bf16 v[100:103],a[120:123],a[80:83],v[100:103]
s_add_u32 m0,s22,0
ds_read_b128 a[120:123],v0 offset:12544
v_cvt_pk_bf16_f32 v144,v144,v145
v_mfma_f32_16x16x32_bf16 v[100:103],a[148:151],a[76:79],v[100:103]
ds_read_b128 a[148:151],v1 offset:12416
v_cvt_pk_bf16_f32 v145,v146,v147
v_mfma_f32_16x16x32_bf16 v[100:103],a[144:147],a[72:75],v[100:103]
ds_read_b128 a[144:147],v0 offset:12416
v_cvt_pk_bf16_f32 v152,v152,v153
ds_read_b128 v[220:223],v10 offset:18432
v_pk_mul_f32 v[204:205],v[204:205],v[60:61] op_sel_hi:[1,0]
v_pk_mul_f32 v[206:207],v[206:207],v[60:61] op_sel_hi:[1,0]
v_cvt_pk_bf16_f32 v153,v154,v155
v_cvt_pk_bf16_f32 v136,v136,v137
s_waitcnt lgkmcnt(5)
v_mfma_f32_16x16x32_bf16 v[72:75],a[124:127],a[20:23],0
ds_read_b128 v[236:239],v10 offset:19456
v_cvt_pk_bf16_f32 v148,v148,v149
v_cvt_pk_bf16_f32 v133,v134,v135
v_cvt_pk_bf16_f32 v137,v138,v139
v_cvt_pk_bf16_f32 v140,v140,v141
v_cvt_pk_bf16_f32 v141,v142,v143
v_cvt_pk_bf16_f32 v149,v150,v151
v_cvt_pk_bf16_f32 v164,v164,v165
v_cvt_pk_bf16_f32 v156,v156,v157
v_mov_b32 v66,0
v_cvt_pk_bf16_f32 v176,v176,v177
s_waitcnt lgkmcnt(4)
v_mfma_f32_16x16x32_bf16 v[72:75],a[120:123],a[16:19],v[72:75]
s_waitcnt lgkmcnt(2)
ds_write2st64_b64 v36,v[128:129],v[144:145] offset0:26 offset1:28
v_mfma_f32_16x16x32_bf16 v[72:75],a[148:151],a[12:15],v[72:75]
v_fma_f32 v87,v87,s36,v14
v_fma_f32 v84,v84,s36,v14
v_mfma_f32_16x16x32_bf16 v[72:75],a[144:147],a[8:11],v[72:75]
s_waitcnt lgkmcnt(2)
buffer_store_dwordx4 v[220:223],v9,s[16:19],s87 offen offset:256 nt
v_fma_f32 v86,v86,s36,v14
v_exp_f32 v86,v86
v_mfma_f32_16x16x32_bf16 v[72:75],a[140:143],a[4:7],v[72:75]
v_fma_f32 v85,v85,s36,v14
v_exp_f32 v85,v85
v_mfma_f32_16x16x32_bf16 v[72:75],a[136:139],a[0:3],v[72:75]
v_exp_f32 v84,v84
v_mfma_f32_16x16x32_bf16 v[80:83],a[136:139],a[24:27],0
ds_write2st64_b64 v37,v[132:133],v[148:149] offset0:26 offset1:28
v_mfma_f32_16x16x32_bf16 v[80:83],a[140:143],a[28:31],v[80:83]
v_cvt_pk_bf16_f32 v26,v84,v85
v_exp_f32 v87,v87
v_mfma_f32_16x16x32_bf16 v[80:83],a[144:147],a[32:35],v[80:83]
s_waitcnt lgkmcnt(1)
buffer_store_dwordx4 v[236:239],v9,s[16:19],s87 offen offset:3328 nt
v_cvt_pk_bf16_f32 v27,v86,v87
v_fma_f32 v95,v95,s36,v15
v_fma_f32 v94,v94,s36,v15
v_mfma_f32_16x16x32_bf16 v[80:83],a[148:151],a[36:39],v[80:83]
v_exp_f32 v94,v94
v_mfma_f32_16x16x32_bf16 v[80:83],a[120:123],a[40:43],v[80:83]
v_exp_f32 v95,v95
v_mfma_f32_16x16x32_bf16 v[80:83],a[124:127],a[44:47],v[80:83]
ds_write2st64_b64 v38,v[136:137],v[152:153] offset0:26 offset1:28
v_mfma_f32_16x16x32_bf16 v[88:91],a[124:127],a[68:71],0
v_fma_f32 v92,v92,s36,v15
v_fma_f32 v93,v93,s36,v15
v_mfma_f32_16x16x32_bf16 v[88:91],a[120:123],a[64:67],v[88:91]
v_exp_f32 v93,v93
v_mfma_f32_16x16x32_bf16 v[88:91],a[148:151],a[60:63],v[88:91]
v_exp_f32 v92,v92
v_mfma_f32_16x16x32_bf16 v[88:91],a[144:147],a[56:59],v[88:91]
v_cvt_pk_bf16_f32 v30,v92,v93
v_cvt_pk_bf16_f32 v31,v94,v95
v_mfma_f32_16x16x32_bf16 v[88:91],a[140:143],a[52:55],v[88:91]
v_fma_f32 v102,v102,s36,v16
v_fma_f32 v100,v100,s36,v16
v_mfma_f32_16x16x32_bf16 v[88:91],a[136:139],a[48:51],v[88:91]
v_fma_f32 v101,v101,s36,v16
v_fma_f32 v103,v103,s36,v16
v_mfma_f32_16x16x32_bf16 v[96:99],a[136:139],a[72:75],0
ds_read_b128 a[136:139],v0 offset:18560
v_exp_f32 v101,v101
v_mfma_f32_16x16x32_bf16 v[96:99],a[140:143],a[76:79],v[96:99]
ds_read_b128 a[140:143],v1 offset:18560
v_exp_f32 v103,v103
v_mfma_f32_16x16x32_bf16 v[96:99],a[144:147],a[80:83],v[96:99]
ds_read_b128 a[144:147],v0 offset:18688
v_exp_f32 v102,v102
v_mfma_f32_16x16x32_bf16 v[96:99],a[148:151],a[84:87],v[96:99]
ds_read_b128 a[148:151],v1 offset:18688
v_exp_f32 v100,v100
v_mfma_f32_16x16x32_bf16 v[96:99],a[120:123],a[88:91],v[96:99]
v_cvt_pk_bf16_f32 v35,v102,v103
v_cvt_pk_bf16_f32 v34,v100,v101
v_mfma_f32_16x16x32_bf16 v[96:99],a[124:127],a[92:95],v[96:99]
v_cvt_pk_bf16_f32 v177,v178,v179
v_cvt_pk_bf16_f32 v157,v158,v159
v_mfma_f32_16x16x32_bf16 v[76:79],a[128:131],a[0:3],0
ds_write2st64_b64 v39,v[140:141],v[156:157] offset0:26 offset1:28
v_mfma_f32_16x16x32_bf16 v[76:79],a[132:135],a[4:7],v[76:79]
s_waitcnt lgkmcnt(3)
v_cvt_pk_bf16_f32 v188,v188,v189
v_cvt_pk_bf16_f32 v160,v160,v161
v_mfma_f32_16x16x32_bf16 v[76:79],a[136:139],a[8:11],v[76:79]
v_cvt_pk_bf16_f32 v161,v162,v163
v_cvt_pk_bf16_f32 v184,v184,v185
v_mfma_f32_16x16x32_bf16 v[76:79],a[140:143],a[12:15],v[76:79]
s_waitcnt lgkmcnt(1)
v_cvt_pk_bf16_f32 v180,v180,v181
v_cvt_pk_bf16_f32 v181,v182,v183
v_mfma_f32_16x16x32_bf16 v[76:79],a[144:147],a[16:19],v[76:79]
ds_write2st64_b64 v36,v[160:161],v[176:177] offset0:0 offset1:2
v_mfma_f32_16x16x32_bf16 v[76:79],a[148:151],a[20:23],v[76:79]
v_cvt_pk_bf16_f32 v168,v168,v169
v_cvt_pk_bf16_f32 v169,v170,v171
v_mfma_f32_16x16x32_bf16 v[84:87],a[148:151],a[44:47],0
v_cvt_pk_bf16_f32 v165,v166,v167
v_mov_b32 v64,0
v_mfma_f32_16x16x32_bf16 v[84:87],a[144:147],a[40:43],v[84:87]
v_fma_f32 v73,v73,s36,v13
v_cvt_pk_bf16_f32 v196,v196,v197
v_smfmac_f32_16x16x64_bf16 v[64:67],a[152:155],v[28:35],v18
ds_write2st64_b64 v37,v[164:165],v[180:181] offset0:0 offset1:2
v_mfma_f32_16x16x32_bf16 v[84:87],a[140:143],a[36:39],v[84:87]
v_fma_f32 v74,v74,s36,v13
s_waitcnt vmcnt(5)
s_barrier
v_mfma_f32_16x16x32_bf16 v[84:87],a[136:139],a[32:35],v[84:87]
v_mov_b32 v60,0
v_cvt_pk_bf16_f32 v189,v190,v191
v_mfma_f32_16x16x32_bf16 v[84:87],a[132:135],a[28:31],v[84:87]
buffer_load_dwordx4 v6,s[4:7],s20 offen offset:0 lds
v_smfmac_f32_16x16x64_bf16 v[60:63],a[152:155],v[20:27],v18
v_cvt_pk_bf16_f32 v172,v172,v173
v_mfma_f32_16x16x32_bf16 v[84:87],a[128:131],a[24:27],v[84:87]
v_cvt_pk_bf16_f32 v173,v174,v175
v_fma_f32 v75,v75,s36,v13
v_mfma_f32_16x16x32_bf16 v[92:95],a[128:131],a[48:51],0
v_cvt_pk_bf16_f32 v185,v186,v187
v_exp_f32 v73,v73
v_mfma_f32_16x16x32_bf16 v[92:95],a[132:135],a[52:55],v[92:95]
ds_write2st64_b64 v38,v[168:169],v[184:185] offset0:0 offset1:2
v_mfma_f32_16x16x32_bf16 v[92:95],a[136:139],a[56:59],v[92:95]
v_exp_f32 v74,v74
v_mfma_f32_16x16x32_bf16 v[92:95],a[140:143],a[60:63],v[92:95]
buffer_load_dwordx4 v7,s[4:7],s20 offen offset:1024 lds
v_mfma_f32_16x16x32_bf16 v[92:95],a[144:147],a[64:67],v[92:95]
v_cvt_pk_bf16_f32 v192,v192,v193
v_cvt_pk_bf16_f32 v193,v194,v195
v_mfma_f32_16x16x32_bf16 v[92:95],a[148:151],a[68:71],v[92:95]
ds_write2st64_b64 v39,v[172:173],v[188:189] offset0:0 offset1:2
v_mfma_f32_16x16x32_bf16 v[100:103],a[148:151],a[92:95],0
v_cvt_pk_bf16_f32 v200,v200,v201
v_cvt_pk_bf16_f32 v201,v202,v203
v_mfma_f32_16x16x32_bf16 v[100:103],a[144:147],a[88:91],v[100:103]
buffer_load_dwordx4 v8,s[4:7],s20 offen offset:2048 lds
v_mfma_f32_16x16x32_bf16 v[100:103],a[140:143],a[84:87],v[100:103]
s_add_u32 s20,s20,12288
ds_read_b64_tr_b16 a[122:123],v2 offset:6144
v_fma_f32 v72,v72,s36,v13
v_mfma_f32_16x16x32_bf16 v[100:103],a[136:139],a[80:83],v[100:103]
ds_write_b64 v36,v[192:193] offset:2048
v_mfma_f32_16x16x32_bf16 v[100:103],a[132:135],a[76:79],v[100:103]
ds_read_b64_tr_b16 a[120:121],v2 offset:0
v_exp_f32 v72,v72
v_mfma_f32_16x16x32_bf16 v[100:103],a[128:131],a[72:75],v[100:103]
ds_read_b64_tr_b16 a[124:125],v3 offset:0
ds_read_b64_tr_b16 a[126:127],v3 offset:6144
ds_read_b64_tr_b16 a[132:133],v5 offset:0
ds_read_b64_tr_b16 a[130:131],v4 offset:6144
ds_read_b64_tr_b16 a[128:129],v4 offset:0
ds_read_b64_tr_b16 a[134:135],v5 offset:6144
v_fma_f32 v80,v80,s36,v14
v_cvt_pk_bf16_f32 v204,v204,v205
v_cvt_pk_bf16_f32 v197,v198,v199
v_exp_f32 v75,v75
v_fma_f32 v81,v81,s36,v14
ds_write_b64 v37,v[196:197] offset:2048
v_exp_f32 v80,v80
v_exp_f32 v81,v81
v_cvt_pk_bf16_f32 v205,v206,v207
v_cvt_pk_bf16_f32 v48,v80,v81
v_cvt_pk_bf16_f32 v45,v74,v75
ds_write_b64 v38,v[200:201] offset:2048
v_cvt_pk_bf16_f32 v44,v72,v73
ds_write_b64 v39,v[204:205] offset:2048
s_waitcnt lgkmcnt(3)
v_mfma_f32_16x16x32_bf16 v[160:163],a[120:123],v[20:23],0
s_add_u32 m0,s23,0
ds_read_b64_tr_b16 a[136:137],v2 offset:128
v_fma_f32 v82,v82,s36,v14
v_mfma_f32_16x16x32_bf16 v[164:167],a[124:127],v[20:23],0
ds_read_b64_tr_b16 a[138:139],v2 offset:6272
v_fma_f32 v83,v83,s36,v14
v_mfma_f32_16x16x32_bf16 v[212:215],a[124:127],v[24:27],0
ds_read_b64_tr_b16 a[140:141],v3 offset:128
v_fma_f32 v88,v88,s36,v15
v_mfma_f32_16x16x32_bf16 v[208:211],a[120:123],v[24:27],0
ds_read_b64_tr_b16 a[142:143],v3 offset:6272
v_fma_f32 v89,v89,s36,v15
v_mfma_f32_16x16x32_bf16 v[112:115],a[120:123],v[28:31],0
ds_read_b64_tr_b16 a[144:145],v4 offset:128
v_fma_f32 v90,v90,s36,v15
v_mfma_f32_16x16x32_bf16 v[116:119],a[124:127],v[28:31],0
ds_read_b64_tr_b16 a[146:147],v4 offset:6272
v_fma_f32 v91,v91,s36,v15
v_mfma_f32_16x16x32_bf16 a[164:167],a[124:127],v[32:35],0
ds_read_b64_tr_b16 a[148:149],v5 offset:128
v_fma_f32 v96,v96,s36,v16
v_mfma_f32_16x16x32_bf16 a[160:163],a[120:123],v[32:35],0
ds_read_b64_tr_b16 a[150:151],v5 offset:6272
v_fma_f32 v97,v97,s36,v16
v_mfma_f32_16x16x32_bf16 a[168:171],a[128:131],v[32:35],0
ds_read_b64_tr_b16 a[120:121],v2 offset:256
v_fma_f32 v98,v98,s36,v16
v_mfma_f32_16x16x32_bf16 a[172:175],a[132:135],v[32:35],0
ds_read_b64_tr_b16 a[122:123],v2 offset:6400
v_fma_f32 v99,v99,s36,v16
v_mfma_f32_16x16x32_bf16 v[124:127],a[132:135],v[28:31],0
ds_read_b64_tr_b16 a[124:125],v3 offset:256
v_fma_f32 v76,v76,s36,v13
v_mfma_f32_16x16x32_bf16 v[120:123],a[128:131],v[28:31],0
ds_read_b64_tr_b16 a[126:127],v3 offset:6400
v_fma_f32 v77,v77,s36,v13
v_mfma_f32_16x16x32_bf16 v[216:219],a[128:131],v[24:27],0
v_exp_f32 v82,v82
v_mfma_f32_16x16x32_bf16 v[220:223],a[132:135],v[24:27],0
v_exp_f32 v83,v83
v_mfma_f32_16x16x32_bf16 v[172:175],a[132:135],v[20:23],0
ds_read_b64_tr_b16 a[132:133],v5 offset:256
v_cvt_pk_bf16_f32 v49,v82,v83
v_mfma_f32_16x16x32_bf16 v[168:171],a[128:131],v[20:23],0
s_waitcnt lgkmcnt(4)
ds_read_b64_tr_b16 a[128:129],v4 offset:256
v_fma_f32 v78,v78,s36,v13
v_mfma_f32_16x16x32_bf16 v[176:179],a[136:139],v[20:23],0
ds_read_b64_tr_b16 a[130:131],v4 offset:6400
v_fma_f32 v79,v79,s36,v13
v_mfma_f32_16x16x32_bf16 v[180:183],a[140:143],v[20:23],0
ds_read_b64_tr_b16 a[134:135],v5 offset:6400
v_fma_f32 v84,v84,s36,v14
v_mfma_f32_16x16x32_bf16 v[228:231],a[140:143],v[24:27],0
v_exp_f32 v88,v88
v_mfma_f32_16x16x32_bf16 v[224:227],a[136:139],v[24:27],0
v_exp_f32 v89,v89
v_mfma_f32_16x16x32_bf16 v[128:131],a[136:139],v[28:31],0
v_exp_f32 v90,v90
v_mfma_f32_16x16x32_bf16 v[132:135],a[140:143],v[28:31],0
v_exp_f32 v91,v91
v_mfma_f32_16x16x32_bf16 a[180:183],a[140:143],v[32:35],0
v_cvt_pk_bf16_f32 v52,v88,v89
v_cvt_pk_bf16_f32 v53,v90,v91
v_mfma_f32_16x16x32_bf16 a[176:179],a[136:139],v[32:35],0
v_exp_f32 v96,v96
v_mfma_f32_16x16x32_bf16 a[184:187],a[144:147],v[32:35],0
v_exp_f32 v97,v97
v_mfma_f32_16x16x32_bf16 a[188:191],a[148:151],v[32:35],0
v_exp_f32 v98,v98
v_mfma_f32_16x16x32_bf16 v[140:143],a[148:151],v[28:31],0
v_exp_f32 v99,v99
v_mfma_f32_16x16x32_bf16 v[136:139],a[144:147],v[28:31],0
v_cvt_pk_bf16_f32 v56,v96,v97
v_cvt_pk_bf16_f32 v57,v98,v99
v_mfma_f32_16x16x32_bf16 v[232:235],a[144:147],v[24:27],0
v_exp_f32 v76,v76
v_mfma_f32_16x16x32_bf16 v[236:239],a[148:151],v[24:27],0
v_exp_f32 v77,v77
v_mfma_f32_16x16x32_bf16 v[188:191],a[148:151],v[20:23],0
v_exp_f32 v78,v78
v_mfma_f32_16x16x32_bf16 v[184:187],a[144:147],v[20:23],0
s_waitcnt lgkmcnt(0)
v_exp_f32 v79,v79
v_mfma_f32_16x16x32_bf16 v[192:195],a[120:123],v[20:23],0
s_waitcnt vmcnt(24)
v_cvt_pk_bf16_f32 v46,v76,v77
v_cvt_pk_bf16_f32 v47,v78,v79
v_mfma_f32_16x16x32_bf16 v[196:199],a[124:127],v[20:23],0
s_barrier
v_mfma_f32_16x16x32_bf16 v[244:247],a[124:127],v[24:27],0
ds_read_b128 a[148:151],v1 offset:24704
v_fma_f32 v85,v85,s36,v14
v_mfma_f32_16x16x32_bf16 v[240:243],a[120:123],v[24:27],0
ds_read_b128 a[144:147],v0 offset:24704
v_fma_f32 v86,v86,s36,v14
v_mfma_f32_16x16x32_bf16 v[144:147],a[120:123],v[28:31],0
ds_read_b128 a[140:143],v1 offset:24576
v_fma_f32 v87,v87,s36,v14
v_mfma_f32_16x16x32_bf16 v[148:151],a[124:127],v[28:31],0
ds_read_b128 a[136:139],v0 offset:24576
v_fma_f32 v92,v92,s36,v15
v_mfma_f32_16x16x32_bf16 a[196:199],a[124:127],v[32:35],0
ds_read_b128 a[124:127],v1 offset:24832
v_fma_f32 v93,v93,s36,v15
v_mfma_f32_16x16x32_bf16 a[192:195],a[120:123],v[32:35],0
buffer_load_dwordx4 v6,s[8:11],s21 offen offset:0 lds
v_mfma_f32_16x16x32_bf16 a[200:203],a[128:131],v[32:35],0
ds_read_b128 a[120:123],v0 offset:24832
v_fma_f32 v94,v94,s36,v15
v_mfma_f32_16x16x32_bf16 a[204:207],a[132:135],v[32:35],0
v_exp_f32 v84,v84
v_mfma_f32_16x16x32_bf16 v[156:159],a[132:135],v[28:31],0
v_exp_f32 v85,v85
v_mfma_f32_16x16x32_bf16 v[152:155],a[128:131],v[28:31],0
v_exp_f32 v86,v86
v_mfma_f32_16x16x32_bf16 v[248:251],a[128:131],v[24:27],0
v_exp_f32 v87,v87
v_mfma_f32_16x16x32_bf16 v[252:255],a[132:135],v[24:27],0
v_cvt_pk_bf16_f32 v50,v84,v85
v_cvt_pk_bf16_f32 v51,v86,v87
v_mfma_f32_16x16x32_bf16 v[204:207],a[132:135],v[20:23],0
ds_read_b128 a[132:135],v1 offset:30720
v_fma_f32 v95,v95,s36,v15
v_smfmac_f32_16x16x64_bf16 v[60:63],a[152:155],v[44:51],v18
v_fma_f32 v100,v100,s36,v16
v_mfma_f32_16x16x32_bf16 v[200:203],a[128:131],v[20:23],0
buffer_load_dwordx4 v7,s[8:11],s21 offen offset:1024 lds
s_waitcnt lgkmcnt(1)
v_mfma_f32_16x16x32_bf16 v[72:75],a[124:127],a[20:23],0
ds_read_b128 a[128:131],v0 offset:30720
v_fma_f32 v101,v101,s36,v16
v_mfma_f32_16x16x32_bf16 v[72:75],a[120:123],a[16:19],v[72:75]
v_exp_f32 v92,v92
v_mfma_f32_16x16x32_bf16 v[72:75],a[148:151],a[12:15],v[72:75]
v_exp_f32 v93,v93
v_mfma_f32_16x16x32_bf16 v[72:75],a[144:147],a[8:11],v[72:75]
v_exp_f32 v94,v94
v_mfma_f32_16x16x32_bf16 v[72:75],a[140:143],a[4:7],v[72:75]
v_exp_f32 v95,v95
v_mfma_f32_16x16x32_bf16 v[72:75],a[136:139],a[0:3],v[72:75]
v_cvt_pk_bf16_f32 v54,v92,v93
v_cvt_pk_bf16_f32 v55,v94,v95
v_mfma_f32_16x16x32_bf16 v[80:83],a[136:139],a[24:27],0
v_fma_f32 v102,v102,s36,v16
v_fma_f32 v103,v103,s36,v16
v_mfma_f32_16x16x32_bf16 v[80:83],a[140:143],a[28:31],v[80:83]
v_exp_f32 v100,v100
v_mfma_f32_16x16x32_bf16 v[80:83],a[144:147],a[32:35],v[80:83]
buffer_load_dwordx4 v8,s[8:11],s21 offen offset:2048 lds
v_mfma_f32_16x16x32_bf16 v[80:83],a[148:151],a[36:39],v[80:83]
s_add_u32 s21,s21,12288
v_exp_f32 v101,v101
v_mfma_f32_16x16x32_bf16 v[80:83],a[120:123],a[40:43],v[80:83]
s_add_u32 m0,s22,12288
v_exp_f32 v102,v102
v_mfma_f32_16x16x32_bf16 v[80:83],a[124:127],a[44:47],v[80:83]
v_exp_f32 v103,v103
v_mfma_f32_16x16x32_bf16 v[88:91],a[124:127],a[68:71],0
v_cvt_pk_bf16_f32 v58,v100,v101
v_cvt_pk_bf16_f32 v59,v102,v103
v_mfma_f32_16x16x32_bf16 v[88:91],a[120:123],a[64:67],v[88:91]
v_fma_f32 v72,v72,s36,v13
v_fma_f32 v73,v73,s36,v13
v_smfmac_f32_16x16x64_bf16 v[64:67],a[152:155],v[52:59],v18
v_fma_f32 v74,v74,s36,v13
v_mfma_f32_16x16x32_bf16 v[88:91],a[148:151],a[60:63],v[88:91]
v_fma_f32 v75,v75,s36,v13
v_fma_f32 v80,v80,s36,v14
v_mfma_f32_16x16x32_bf16 v[88:91],a[144:147],a[56:59],v[88:91]
v_fma_f32 v81,v81,s36,v14
v_mfma_f32_16x16x32_bf16 v[88:91],a[140:143],a[52:55],v[88:91]
buffer_load_dwordx4 v6,s[4:7],s20 offen offset:0 lds
v_mfma_f32_16x16x32_bf16 v[88:91],a[136:139],a[48:51],v[88:91]
v_exp_f32 v72,v72
v_mfma_f32_16x16x32_bf16 v[96:99],a[136:139],a[72:75],0
ds_read_b128 a[136:139],v0 offset:30848
v_mfma_f32_16x16x32_bf16 v[96:99],a[140:143],a[76:79],v[96:99]
ds_read_b128 a[140:143],v1 offset:30848
v_mfma_f32_16x16x32_bf16 v[96:99],a[144:147],a[80:83],v[96:99]
ds_read_b128 a[144:147],v0 offset:30976
v_mfma_f32_16x16x32_bf16 v[96:99],a[148:151],a[84:87],v[96:99]
ds_read_b128 a[148:151],v1 offset:30976
v_mfma_f32_16x16x32_bf16 v[96:99],a[120:123],a[88:91],v[96:99]
v_exp_f32 v73,v73
v_mfma_f32_16x16x32_bf16 v[96:99],a[124:127],a[92:95],v[96:99]
s_waitcnt lgkmcnt(4)
v_exp_f32 v74,v74
v_mfma_f32_16x16x32_bf16 v[76:79],a[128:131],a[0:3],0
v_exp_f32 v75,v75
v_mfma_f32_16x16x32_bf16 v[76:79],a[132:135],a[4:7],v[76:79]
buffer_load_dwordx4 v7,s[4:7],s20 offen offset:1024 lds
s_waitcnt lgkmcnt(3)
v_mfma_f32_16x16x32_bf16 v[76:79],a[136:139],a[8:11],v[76:79]
s_waitcnt lgkmcnt(2)
v_exp_f32 v80,v80
v_mfma_f32_16x16x32_bf16 v[76:79],a[140:143],a[12:15],v[76:79]
s_waitcnt lgkmcnt(0)
v_exp_f32 v81,v81
v_mfma_f32_16x16x32_bf16 v[76:79],a[144:147],a[16:19],v[76:79]
v_cvt_pk_bf16_f32 v20,v72,v73
v_cvt_pk_bf16_f32 v21,v74,v75
v_mfma_f32_16x16x32_bf16 v[76:79],a[148:151],a[20:23],v[76:79]
v_cvt_pk_bf16_f32 v24,v80,v81
v_mfma_f32_16x16x32_bf16 v[84:87],a[148:151],a[44:47],0
v_mfma_f32_16x16x32_bf16 v[84:87],a[144:147],a[40:43],v[84:87]
v_mfma_f32_16x16x32_bf16 v[84:87],a[140:143],a[36:39],v[84:87]
v_mfma_f32_16x16x32_bf16 v[84:87],a[136:139],a[32:35],v[84:87]
v_mfma_f32_16x16x32_bf16 v[84:87],a[132:135],a[28:31],v[84:87]
buffer_load_dwordx4 v8,s[4:7],s20 offen offset:2048 lds
v_mfma_f32_16x16x32_bf16 v[84:87],a[128:131],a[24:27],v[84:87]
s_add_u32 s20,s20,12288
v_mfma_f32_16x16x32_bf16 v[92:95],a[128:131],a[48:51],0
ds_read_b64_tr_b16 a[120:121],v2 offset:12288
v_mfma_f32_16x16x32_bf16 v[92:95],a[132:135],a[52:55],v[92:95]
ds_read_b64_tr_b16 a[122:123],v2 offset:18432
v_mfma_f32_16x16x32_bf16 v[92:95],a[136:139],a[56:59],v[92:95]
ds_read_b64_tr_b16 a[124:125],v3 offset:12288
v_mfma_f32_16x16x32_bf16 v[92:95],a[140:143],a[60:63],v[92:95]
ds_read_b64_tr_b16 a[126:127],v3 offset:18432
v_mfma_f32_16x16x32_bf16 v[92:95],a[144:147],a[64:67],v[92:95]
v_mfma_f32_16x16x32_bf16 v[92:95],a[148:151],a[68:71],v[92:95]
v_mfma_f32_16x16x32_bf16 v[100:103],a[148:151],a[92:95],0
v_mfma_f32_16x16x32_bf16 v[100:103],a[144:147],a[88:91],v[100:103]
v_mfma_f32_16x16x32_bf16 v[100:103],a[140:143],a[84:87],v[100:103]
v_mfma_f32_16x16x32_bf16 v[100:103],a[136:139],a[80:83],v[100:103]
v_mfma_f32_16x16x32_bf16 v[100:103],a[132:135],a[76:79],v[100:103]
ds_read_b64_tr_b16 a[132:133],v5 offset:12288
v_mfma_f32_16x16x32_bf16 v[100:103],a[128:131],a[72:75],v[100:103]
s_waitcnt lgkmcnt(1)
ds_read_b64_tr_b16 a[128:129],v4 offset:12288
ds_read_b64_tr_b16 a[130:131],v4 offset:18432
ds_read_b64_tr_b16 a[134:135],v5 offset:18432
v_mfma_f32_16x16x32_bf16 v[160:163],a[120:123],v[44:47],v[160:163]
s_add_u32 m0,s23,12288
ds_read_b64_tr_b16 a[136:137],v2 offset:12416
v_fma_f32 v82,v82,s36,v14
v_mfma_f32_16x16x32_bf16 v[164:167],a[124:127],v[44:47],v[164:167]
ds_read_b64_tr_b16 a[138:139],v2 offset:18560
v_fma_f32 v83,v83,s36,v14
v_mfma_f32_16x16x32_bf16 v[212:215],a[124:127],v[48:51],v[212:215]
ds_read_b64_tr_b16 a[140:141],v3 offset:12416
v_fma_f32 v88,v88,s36,v15
v_mfma_f32_16x16x32_bf16 v[208:211],a[120:123],v[48:51],v[208:211]
ds_read_b64_tr_b16 a[142:143],v3 offset:18560
v_fma_f32 v89,v89,s36,v15
v_mfma_f32_16x16x32_bf16 v[112:115],a[120:123],v[52:55],v[112:115]
ds_read_b64_tr_b16 a[144:145],v4 offset:12416
v_fma_f32 v90,v90,s36,v15
v_mfma_f32_16x16x32_bf16 v[116:119],a[124:127],v[52:55],v[116:119]
ds_read_b64_tr_b16 a[146:147],v4 offset:18560
v_fma_f32 v91,v91,s36,v15
v_mfma_f32_16x16x32_bf16 a[164:167],a[124:127],v[56:59],a[164:167]
ds_read_b64_tr_b16 a[148:149],v5 offset:12416
v_fma_f32 v96,v96,s36,v16
v_mfma_f32_16x16x32_bf16 a[160:163],a[120:123],v[56:59],a[160:163]
s_waitcnt lgkmcnt(6)
ds_read_b64_tr_b16 a[150:151],v5 offset:18560
v_fma_f32 v97,v97,s36,v16
v_mfma_f32_16x16x32_bf16 a[168:171],a[128:131],v[56:59],a[168:171]
ds_read_b64_tr_b16 a[120:121],v2 offset:12544
v_fma_f32 v98,v98,s36,v16
v_mfma_f32_16x16x32_bf16 a[172:175],a[132:135],v[56:59],a[172:175]
ds_read_b64_tr_b16 a[122:123],v2 offset:18688
v_fma_f32 v99,v99,s36,v16
v_mfma_f32_16x16x32_bf16 v[124:127],a[132:135],v[52:55],v[124:127]
ds_read_b64_tr_b16 a[124:125],v3 offset:12544
v_fma_f32 v76,v76,s36,v13
v_mfma_f32_16x16x32_bf16 v[120:123],a[128:131],v[52:55],v[120:123]
ds_read_b64_tr_b16 a[126:127],v3 offset:18688
v_fma_f32 v77,v77,s36,v13
v_mfma_f32_16x16x32_bf16 v[216:219],a[128:131],v[48:51],v[216:219]
v_exp_f32 v82,v82
v_mfma_f32_16x16x32_bf16 v[220:223],a[132:135],v[48:51],v[220:223]
v_exp_f32 v83,v83
v_mfma_f32_16x16x32_bf16 v[172:175],a[132:135],v[44:47],v[172:175]
ds_read_b64_tr_b16 a[132:133],v5 offset:12544
v_cvt_pk_bf16_f32 v25,v82,v83
v_mfma_f32_16x16x32_bf16 v[168:171],a[128:131],v[44:47],v[168:171]
s_waitcnt lgkmcnt(4)
ds_read_b64_tr_b16 a[128:129],v4 offset:12544
v_fma_f32 v78,v78,s36,v13
v_mfma_f32_16x16x32_bf16 v[176:179],a[136:139],v[44:47],v[176:179]
ds_read_b64_tr_b16 a[130:131],v4 offset:18688
v_fma_f32 v79,v79,s36,v13
v_mfma_f32_16x16x32_bf16 v[180:183],a[140:143],v[44:47],v[180:183]
ds_read_b64_tr_b16 a[134:135],v5 offset:18688
v_fma_f32 v84,v84,s36,v14
v_mfma_f32_16x16x32_bf16 v[228:231],a[140:143],v[48:51],v[228:231]
v_exp_f32 v88,v88
v_mfma_f32_16x16x32_bf16 v[224:227],a[136:139],v[48:51],v[224:227]
v_exp_f32 v89,v89
v_mfma_f32_16x16x32_bf16 v[128:131],a[136:139],v[52:55],v[128:131]
v_exp_f32 v90,v90
v_mfma_f32_16x16x32_bf16 v[132:135],a[140:143],v[52:55],v[132:135]
v_exp_f32 v91,v91
v_mfma_f32_16x16x32_bf16 a[180:183],a[140:143],v[56:59],a[180:183]
v_cvt_pk_bf16_f32 v28,v88,v89
v_cvt_pk_bf16_f32 v29,v90,v91
v_mfma_f32_16x16x32_bf16 a[176:179],a[136:139],v[56:59],a[176:179]
v_exp_f32 v96,v96
v_mfma_f32_16x16x32_bf16 a[184:187],a[144:147],v[56:59],a[184:187]
v_exp_f32 v97,v97
v_mfma_f32_16x16x32_bf16 a[188:191],a[148:151],v[56:59],a[188:191]
v_exp_f32 v98,v98
v_mfma_f32_16x16x32_bf16 v[140:143],a[148:151],v[52:55],v[140:143]
v_exp_f32 v99,v99
v_mfma_f32_16x16x32_bf16 v[136:139],a[144:147],v[52:55],v[136:139]
v_cvt_pk_bf16_f32 v32,v96,v97
v_cvt_pk_bf16_f32 v33,v98,v99
v_mfma_f32_16x16x32_bf16 v[232:235],a[144:147],v[48:51],v[232:235]
v_exp_f32 v76,v76
v_mfma_f32_16x16x32_bf16 v[236:239],a[148:151],v[48:51],v[236:239]
v_exp_f32 v77,v77
v_mfma_f32_16x16x32_bf16 v[188:191],a[148:151],v[44:47],v[188:191]
v_exp_f32 v78,v78
v_mfma_f32_16x16x32_bf16 v[184:187],a[144:147],v[44:47],v[184:187]
s_waitcnt lgkmcnt(0)
v_exp_f32 v79,v79
v_mfma_f32_16x16x32_bf16 v[192:195],a[120:123],v[44:47],v[192:195]
s_waitcnt vmcnt(6)
v_cvt_pk_bf16_f32 v22,v76,v77
v_cvt_pk_bf16_f32 v23,v78,v79
v_mfma_f32_16x16x32_bf16 v[196:199],a[124:127],v[44:47],v[196:199]
s_barrier
v_mfma_f32_16x16x32_bf16 v[244:247],a[124:127],v[48:51],v[244:247]
ds_read_b128 a[148:151],v1 offset:128
v_fma_f32 v85,v85,s36,v14
v_mfma_f32_16x16x32_bf16 v[240:243],a[120:123],v[48:51],v[240:243]
ds_read_b128 a[144:147],v0 offset:128
v_fma_f32 v86,v86,s36,v14
v_mfma_f32_16x16x32_bf16 v[144:147],a[120:123],v[52:55],v[144:147]
ds_read_b128 a[140:143],v1 offset:0
v_fma_f32 v87,v87,s36,v14
v_mfma_f32_16x16x32_bf16 v[148:151],a[124:127],v[52:55],v[148:151]
ds_read_b128 a[136:139],v0 offset:0
v_fma_f32 v92,v92,s36,v15
v_mfma_f32_16x16x32_bf16 a[196:199],a[124:127],v[56:59],a[196:199]
ds_read_b128 a[124:127],v1 offset:256
v_fma_f32 v93,v93,s36,v15
v_mfma_f32_16x16x32_bf16 a[192:195],a[120:123],v[56:59],a[192:195]
buffer_load_dwordx4 v6,s[8:11],s21 offen offset:0 lds
v_mfma_f32_16x16x32_bf16 a[200:203],a[128:131],v[56:59],a[200:203]
ds_read_b128 a[120:123],v0 offset:256
v_fma_f32 v94,v94,s36,v15
v_mfma_f32_16x16x32_bf16 a[204:207],a[132:135],v[56:59],a[204:207]
v_exp_f32 v84,v84
v_mfma_f32_16x16x32_bf16 v[156:159],a[132:135],v[52:55],v[156:159]
v_exp_f32 v85,v85
v_mfma_f32_16x16x32_bf16 v[152:155],a[128:131],v[52:55],v[152:155]
v_exp_f32 v86,v86
v_mfma_f32_16x16x32_bf16 v[248:251],a[128:131],v[48:51],v[248:251]
v_exp_f32 v87,v87
v_mfma_f32_16x16x32_bf16 v[252:255],a[132:135],v[48:51],v[252:255]
v_cvt_pk_bf16_f32 v26,v84,v85
v_cvt_pk_bf16_f32 v27,v86,v87
v_mfma_f32_16x16x32_bf16 v[204:207],a[132:135],v[44:47],v[204:207]
ds_read_b128 a[132:135],v1 offset:6144
v_fma_f32 v95,v95,s36,v15
v_smfmac_f32_16x16x64_bf16 v[60:63],a[152:155],v[20:27],v18
v_fma_f32 v100,v100,s36,v16
v_mfma_f32_16x16x32_bf16 v[200:203],a[128:131],v[44:47],v[200:203]
buffer_load_dwordx4 v7,s[8:11],s21 offen offset:1024 lds
s_waitcnt lgkmcnt(1)
v_mfma_f32_16x16x32_bf16 v[72:75],a[124:127],a[20:23],0
ds_read_b128 a[128:131],v0 offset:6144
v_fma_f32 v101,v101,s36,v16
v_mfma_f32_16x16x32_bf16 v[72:75],a[120:123],a[16:19],v[72:75]
v_exp_f32 v92,v92
v_mfma_f32_16x16x32_bf16 v[72:75],a[148:151],a[12:15],v[72:75]
v_exp_f32 v93,v93
v_mfma_f32_16x16x32_bf16 v[72:75],a[144:147],a[8:11],v[72:75]
v_exp_f32 v94,v94
v_mfma_f32_16x16x32_bf16 v[72:75],a[140:143],a[4:7],v[72:75]
v_exp_f32 v95,v95
v_mfma_f32_16x16x32_bf16 v[72:75],a[136:139],a[0:3],v[72:75]
v_cvt_pk_bf16_f32 v30,v92,v93
v_cvt_pk_bf16_f32 v31,v94,v95
v_mfma_f32_16x16x32_bf16 v[80:83],a[136:139],a[24:27],0
v_fma_f32 v102,v102,s36,v16
v_fma_f32 v103,v103,s36,v16
v_mfma_f32_16x16x32_bf16 v[80:83],a[140:143],a[28:31],v[80:83]
v_exp_f32 v100,v100
v_mfma_f32_16x16x32_bf16 v[80:83],a[144:147],a[32:35],v[80:83]
buffer_load_dwordx4 v8,s[8:11],s21 offen offset:2048 lds
v_mfma_f32_16x16x32_bf16 v[80:83],a[148:151],a[36:39],v[80:83]
s_add_u32 s21,s21,12288
v_exp_f32 v101,v101
v_mfma_f32_16x16x32_bf16 v[80:83],a[120:123],a[40:43],v[80:83]
s_add_u32 m0,s22,24576
v_exp_f32 v102,v102
v_mfma_f32_16x16x32_bf16 v[80:83],a[124:127],a[44:47],v[80:83]
v_exp_f32 v103,v103
v_mfma_f32_16x16x32_bf16 v[88:91],a[124:127],a[68:71],0
v_cvt_pk_bf16_f32 v34,v100,v101
v_cvt_pk_bf16_f32 v35,v102,v103
v_mfma_f32_16x16x32_bf16 v[88:91],a[120:123],a[64:67],v[88:91]
v_fma_f32 v72,v72,s36,v13
v_fma_f32 v73,v73,s36,v13
v_smfmac_f32_16x16x64_bf16 v[64:67],a[152:155],v[28:35],v18
v_fma_f32 v74,v74,s36,v13
v_mfma_f32_16x16x32_bf16 v[88:91],a[148:151],a[60:63],v[88:91]
v_fma_f32 v75,v75,s36,v13
v_fma_f32 v80,v80,s36,v14
v_mfma_f32_16x16x32_bf16 v[88:91],a[144:147],a[56:59],v[88:91]
v_fma_f32 v81,v81,s36,v14
v_mfma_f32_16x16x32_bf16 v[88:91],a[140:143],a[52:55],v[88:91]
buffer_load_dwordx4 v6,s[4:7],s20 offen offset:0 lds
v_mfma_f32_16x16x32_bf16 v[88:91],a[136:139],a[48:51],v[88:91]
v_exp_f32 v72,v72
v_mfma_f32_16x16x32_bf16 v[96:99],a[136:139],a[72:75],0
ds_read_b128 a[136:139],v0 offset:6272
v_mfma_f32_16x16x32_bf16 v[96:99],a[140:143],a[76:79],v[96:99]
ds_read_b128 a[140:143],v1 offset:6272
v_mfma_f32_16x16x32_bf16 v[96:99],a[144:147],a[80:83],v[96:99]
ds_read_b128 a[144:147],v0 offset:6400
v_mfma_f32_16x16x32_bf16 v[96:99],a[148:151],a[84:87],v[96:99]
ds_read_b128 a[148:151],v1 offset:6400
v_mfma_f32_16x16x32_bf16 v[96:99],a[120:123],a[88:91],v[96:99]
v_exp_f32 v73,v73
v_mfma_f32_16x16x32_bf16 v[96:99],a[124:127],a[92:95],v[96:99]
s_waitcnt lgkmcnt(4)
v_exp_f32 v74,v74
v_mfma_f32_16x16x32_bf16 v[76:79],a[128:131],a[0:3],0
v_exp_f32 v75,v75
v_mfma_f32_16x16x32_bf16 v[76:79],a[132:135],a[4:7],v[76:79]
buffer_load_dwordx4 v7,s[4:7],s20 offen offset:1024 lds
s_waitcnt lgkmcnt(3)
v_mfma_f32_16x16x32_bf16 v[76:79],a[136:139],a[8:11],v[76:79]
s_waitcnt lgkmcnt(2)
v_exp_f32 v80,v80
v_mfma_f32_16x16x32_bf16 v[76:79],a[140:143],a[12:15],v[76:79]
s_waitcnt lgkmcnt(0)
v_exp_f32 v81,v81
v_mfma_f32_16x16x32_bf16 v[76:79],a[144:147],a[16:19],v[76:79]
v_cvt_pk_bf16_f32 v44,v72,v73
v_cvt_pk_bf16_f32 v45,v74,v75
v_mfma_f32_16x16x32_bf16 v[76:79],a[148:151],a[20:23],v[76:79]
v_cvt_pk_bf16_f32 v48,v80,v81
v_mfma_f32_16x16x32_bf16 v[84:87],a[148:151],a[44:47],0
v_mfma_f32_16x16x32_bf16 v[84:87],a[144:147],a[40:43],v[84:87]
v_mfma_f32_16x16x32_bf16 v[84:87],a[140:143],a[36:39],v[84:87]
v_mfma_f32_16x16x32_bf16 v[84:87],a[136:139],a[32:35],v[84:87]
v_mfma_f32_16x16x32_bf16 v[84:87],a[132:135],a[28:31],v[84:87]
buffer_load_dwordx4 v8,s[4:7],s20 offen offset:2048 lds
v_mfma_f32_16x16x32_bf16 v[84:87],a[128:131],a[24:27],v[84:87]
s_add_u32 s20,s20,12288
v_mfma_f32_16x16x32_bf16 v[92:95],a[128:131],a[48:51],0
ds_read_b64_tr_b16 a[120:121],v2 offset:24576
v_mfma_f32_16x16x32_bf16 v[92:95],a[132:135],a[52:55],v[92:95]
ds_read_b64_tr_b16 a[122:123],v2 offset:30720
v_mfma_f32_16x16x32_bf16 v[92:95],a[136:139],a[56:59],v[92:95]
ds_read_b64_tr_b16 a[124:125],v3 offset:24576
v_mfma_f32_16x16x32_bf16 v[92:95],a[140:143],a[60:63],v[92:95]
ds_read_b64_tr_b16 a[126:127],v3 offset:30720
v_mfma_f32_16x16x32_bf16 v[92:95],a[144:147],a[64:67],v[92:95]
v_mfma_f32_16x16x32_bf16 v[92:95],a[148:151],a[68:71],v[92:95]
v_mfma_f32_16x16x32_bf16 v[100:103],a[148:151],a[92:95],0
v_mfma_f32_16x16x32_bf16 v[100:103],a[144:147],a[88:91],v[100:103]
v_mfma_f32_16x16x32_bf16 v[100:103],a[140:143],a[84:87],v[100:103]
v_mfma_f32_16x16x32_bf16 v[100:103],a[136:139],a[80:83],v[100:103]
v_mfma_f32_16x16x32_bf16 v[100:103],a[132:135],a[76:79],v[100:103]
ds_read_b64_tr_b16 a[132:133],v5 offset:24576
v_mfma_f32_16x16x32_bf16 v[100:103],a[128:131],a[72:75],v[100:103]
ds_read_b64_tr_b16 a[128:129],v4 offset:24576
ds_read_b64_tr_b16 a[130:131],v4 offset:30720
ds_read_b64_tr_b16 a[134:135],v5 offset:30720
s_mov_b32 s38,0
s_branch L_loop4
L_end5:
s_waitcnt lgkmcnt(3)
v_mfma_f32_16x16x32_bf16 v[160:163],a[120:123],v[20:23],v[160:163]
ds_read_b64_tr_b16 a[136:137],v2 offset:24704
v_fma_f32 v90,v90,s36,v15
v_mfma_f32_16x16x32_bf16 v[164:167],a[124:127],v[20:23],v[164:167]
ds_read_b64_tr_b16 a[138:139],v2 offset:30848
v_fma_f32 v91,v91,s36,v15
v_mfma_f32_16x16x32_bf16 v[212:215],a[124:127],v[24:27],v[212:215]
ds_read_b64_tr_b16 a[140:141],v3 offset:24704
v_fma_f32 v96,v96,s36,v16
v_mfma_f32_16x16x32_bf16 v[208:211],a[120:123],v[24:27],v[208:211]
ds_read_b64_tr_b16 a[142:143],v3 offset:30848
v_fma_f32 v97,v97,s36,v16
v_mfma_f32_16x16x32_bf16 v[112:115],a[120:123],v[28:31],v[112:115]
ds_read_b64_tr_b16 a[144:145],v4 offset:24704
v_fma_f32 v98,v98,s36,v16
v_mfma_f32_16x16x32_bf16 v[116:119],a[124:127],v[28:31],v[116:119]
ds_read_b64_tr_b16 a[146:147],v4 offset:30848
ds_read_b64_tr_b16 a[148:149],v5 offset:24704
ds_read_b64_tr_b16 a[150:151],v5 offset:30848
v_mfma_f32_16x16x32_bf16 a[164:167],a[124:127],v[32:35],a[164:167]
v_fma_f32 v99,v99,s36,v16
v_fma_f32 v104,v104,s36,v17
v_mfma_f32_16x16x32_bf16 a[160:163],a[120:123],v[32:35],a[160:163]
v_fma_f32 v105,v105,s36,v17
v_fma_f32 v106,v106,s36,v17
v_mfma_f32_16x16x32_bf16 a[208:211],a[120:123],v[36:39],a[208:211]
ds_read_b64_tr_b16 a[120:121],v2 offset:24832
v_fma_f32 v107,v107,s36,v17
v_mfma_f32_16x16x32_bf16 a[212:215],a[124:127],v[36:39],a[212:215]
s_waitcnt lgkmcnt(6)
ds_read_b64_tr_b16 a[122:123],v2 offset:30976
v_fma_f32 v76,v76,s36,v13
v_mfma_f32_16x16x32_bf16 a[216:219],a[128:131],v[36:39],a[216:219]
ds_read_b64_tr_b16 a[124:125],v3 offset:24832
v_fma_f32 v77,v77,s36,v13
v_mfma_f32_16x16x32_bf16 a[220:223],a[132:135],v[36:39],a[220:223]
ds_read_b64_tr_b16 a[126:127],v3 offset:30976
v_fma_f32 v78,v78,s36,v13
v_mfma_f32_16x16x32_bf16 a[172:175],a[132:135],v[32:35],a[172:175]
v_fma_f32 v79,v79,s36,v13
v_fma_f32 v84,v84,s36,v14
v_mfma_f32_16x16x32_bf16 a[168:171],a[128:131],v[32:35],a[168:171]
v_fma_f32 v85,v85,s36,v14
v_fma_f32 v86,v86,s36,v14
v_mfma_f32_16x16x32_bf16 v[120:123],a[128:131],v[28:31],v[120:123]
v_fma_f32 v87,v87,s36,v14
v_fma_f32 v92,v92,s36,v15
v_mfma_f32_16x16x32_bf16 v[124:127],a[132:135],v[28:31],v[124:127]
v_fma_f32 v93,v93,s36,v15
v_fma_f32 v94,v94,s36,v15
v_mfma_f32_16x16x32_bf16 v[220:223],a[132:135],v[24:27],v[220:223]
v_fma_f32 v95,v95,s36,v15
v_fma_f32 v100,v100,s36,v16
v_mfma_f32_16x16x32_bf16 v[216:219],a[128:131],v[24:27],v[216:219]
v_fma_f32 v101,v101,s36,v16
v_fma_f32 v102,v102,s36,v16
v_mfma_f32_16x16x32_bf16 v[168:171],a[128:131],v[20:23],v[168:171]
ds_read_b64_tr_b16 a[128:129],v4 offset:24832
v_fma_f32 v103,v103,s36,v16
v_mfma_f32_16x16x32_bf16 v[172:175],a[132:135],v[20:23],v[172:175]
ds_read_b64_tr_b16 a[130:131],v4 offset:30976
v_fma_f32 v108,v108,s36,v17
v_mfma_f32_16x16x32_bf16 v[176:179],a[136:139],v[20:23],v[176:179]
s_waitcnt lgkmcnt(2)
ds_read_b64_tr_b16 a[132:133],v5 offset:24832
v_fma_f32 v109,v109,s36,v17
v_mfma_f32_16x16x32_bf16 v[180:183],a[140:143],v[20:23],v[180:183]
ds_read_b64_tr_b16 a[134:135],v5 offset:30976
v_fma_f32 v110,v110,s36,v17
v_mfma_f32_16x16x32_bf16 v[228:231],a[140:143],v[24:27],v[228:231]
v_fma_f32 v111,v111,s36,v17
v_exp_f32 v90,v90
v_mfma_f32_16x16x32_bf16 v[224:227],a[136:139],v[24:27],v[224:227]
v_exp_f32 v91,v91
v_mfma_f32_16x16x32_bf16 v[128:131],a[136:139],v[28:31],v[128:131]
v_exp_f32 v96,v96
v_mfma_f32_16x16x32_bf16 v[132:135],a[140:143],v[28:31],v[132:135]
v_exp_f32 v97,v97
v_mfma_f32_16x16x32_bf16 a[180:183],a[140:143],v[32:35],a[180:183]
v_exp_f32 v98,v98
v_mfma_f32_16x16x32_bf16 a[176:179],a[136:139],v[32:35],a[176:179]
v_exp_f32 v99,v99
v_mfma_f32_16x16x32_bf16 a[224:227],a[136:139],v[36:39],a[224:227]
v_exp_f32 v104,v104
v_mfma_f32_16x16x32_bf16 a[228:231],a[140:143],v[36:39],a[228:231]
v_exp_f32 v105,v105
v_mfma_f32_16x16x32_bf16 a[232:235],a[144:147],v[36:39],a[232:235]
v_exp_f32 v106,v106
v_mfma_f32_16x16x32_bf16 a[236:239],a[148:151],v[36:39],a[236:239]
v_exp_f32 v107,v107
v_mfma_f32_16x16x32_bf16 a[188:191],a[148:151],v[32:35],a[188:191]
v_exp_f32 v76,v76
v_mfma_f32_16x16x32_bf16 a[184:187],a[144:147],v[32:35],a[184:187]
v_exp_f32 v77,v77
v_mfma_f32_16x16x32_bf16 v[136:139],a[144:147],v[28:31],v[136:139]
v_exp_f32 v78,v78
v_mfma_f32_16x16x32_bf16 v[140:143],a[148:151],v[28:31],v[140:143]
v_exp_f32 v79,v79
v_mfma_f32_16x16x32_bf16 v[236:239],a[148:151],v[24:27],v[236:239]
v_exp_f32 v84,v84
v_mfma_f32_16x16x32_bf16 v[232:235],a[144:147],v[24:27],v[232:235]
v_exp_f32 v85,v85
v_mfma_f32_16x16x32_bf16 v[184:187],a[144:147],v[20:23],v[184:187]
v_exp_f32 v86,v86
v_mfma_f32_16x16x32_bf16 v[188:191],a[148:151],v[20:23],v[188:191]
v_exp_f32 v87,v87
v_mfma_f32_16x16x32_bf16 v[192:195],a[120:123],v[20:23],v[192:195]
v_exp_f32 v92,v92
v_mfma_f32_16x16x32_bf16 v[196:199],a[124:127],v[20:23],v[196:199]
v_exp_f32 v93,v93
v_mfma_f32_16x16x32_bf16 v[244:247],a[124:127],v[24:27],v[244:247]
v_exp_f32 v94,v94
v_mfma_f32_16x16x32_bf16 v[240:243],a[120:123],v[24:27],v[240:243]
v_exp_f32 v95,v95
v_mfma_f32_16x16x32_bf16 v[144:147],a[120:123],v[28:31],v[144:147]
v_exp_f32 v100,v100
v_mfma_f32_16x16x32_bf16 v[148:151],a[124:127],v[28:31],v[148:151]
v_exp_f32 v101,v101
v_mfma_f32_16x16x32_bf16 a[196:199],a[124:127],v[32:35],a[196:199]
v_exp_f32 v102,v102
v_mfma_f32_16x16x32_bf16 a[192:195],a[120:123],v[32:35],a[192:195]
v_exp_f32 v103,v103
v_mfma_f32_16x16x32_bf16 a[240:243],a[120:123],v[36:39],a[240:243]
v_exp_f32 v108,v108
s_waitcnt vmcnt(12) lgkmcnt(0)
s_barrier
v_mfma_f32_16x16x32_bf16 a[244:247],a[124:127],v[36:39],a[244:247]
v_exp_f32 v109,v109
v_mfma_f32_16x16x32_bf16 a[248:251],a[128:131],v[36:39],a[248:251]
v_exp_f32 v110,v110
v_mfma_f32_16x16x32_bf16 a[252:255],a[132:135],v[36:39],a[252:255]
v_exp_f32 v111,v111
v_mfma_f32_16x16x32_bf16 a[204:207],a[132:135],v[32:35],a[204:207]
v_cvt_pk_bf16_f32 v53,v90,v91
v_cvt_pk_bf16_f32 v56,v96,v97
v_mfma_f32_16x16x32_bf16 a[200:203],a[128:131],v[32:35],a[200:203]
v_cvt_pk_bf16_f32 v57,v98,v99
v_cvt_pk_bf16_f32 v40,v104,v105
v_mfma_f32_16x16x32_bf16 v[152:155],a[128:131],v[28:31],v[152:155]
v_cvt_pk_bf16_f32 v41,v106,v107
v_cvt_pk_bf16_f32 v46,v76,v77
v_mfma_f32_16x16x32_bf16 v[156:159],a[132:135],v[28:31],v[156:159]
v_cvt_pk_bf16_f32 v47,v78,v79
v_cvt_pk_bf16_f32 v50,v84,v85
v_mfma_f32_16x16x32_bf16 v[252:255],a[132:135],v[24:27],v[252:255]
v_cvt_pk_bf16_f32 v51,v86,v87
v_cvt_pk_bf16_f32 v54,v92,v93
v_mfma_f32_16x16x32_bf16 v[248:251],a[128:131],v[24:27],v[248:251]
v_cvt_pk_bf16_f32 v55,v94,v95
v_cvt_pk_bf16_f32 v58,v100,v101
v_smfmac_f32_16x16x64_bf16 v[60:63],a[152:155],v[44:51],v18
v_cvt_pk_bf16_f32 v59,v102,v103
v_mfma_f32_16x16x32_bf16 v[200:203],a[128:131],v[20:23],v[200:203]
v_cvt_pk_bf16_f32 v42,v108,v109
v_cvt_pk_bf16_f32 v43,v110,v111
v_smfmac_f32_16x16x64_bf16 v[64:67],a[152:155],v[52:59],v18
v_subrev_u32 v10,18432,v10
v_smfmac_f32_16x16x64_bf16 v[68:71],a[152:155],v[36:43],v18
v_mfma_f32_16x16x32_bf16 v[204:207],a[132:135],v[20:23],v[204:207]
ds_read_b64_tr_b16 a[136:137],v2 offset:0
ds_read_b64_tr_b16 a[138:139],v2 offset:6144
ds_read_b64_tr_b16 a[140:141],v3 offset:0
ds_read_b64_tr_b16 a[142:143],v3 offset:6144
ds_read_b64_tr_b16 a[144:145],v4 offset:0
ds_read_b64_tr_b16 a[146:147],v4 offset:6144
ds_read_b64_tr_b16 a[148:149],v5 offset:0
ds_read_b64_tr_b16 a[150:151],v5 offset:6144
s_waitcnt lgkmcnt(6)
v_mfma_f32_16x16x32_bf16 v[160:163],a[136:139],v[44:47],v[160:163]
s_waitcnt vmcnt(6)
ds_read_b64_tr_b16 a[122:123],v2 offset:6272
v_mbcnt_lo_u32_b32 v39,-1,0
s_waitcnt lgkmcnt(5)
v_mfma_f32_16x16x32_bf16 v[164:167],a[140:143],v[44:47],v[164:167]
s_add_u32 s84,s42,0
ds_read_b64_tr_b16 a[120:121],v2 offset:128
v_mbcnt_hi_u32_b32 v39,-1,v39
v_mfma_f32_16x16x32_bf16 v[212:215],a[140:143],v[48:51],v[212:215]
s_add_u32 s85,s42,6144
ds_read_b64_tr_b16 a[126:127],v3 offset:6272
v_and_b32 v38,7,v39
v_mfma_f32_16x16x32_bf16 v[208:211],a[136:139],v[48:51],v[208:211]
s_add_u32 s86,s42,12288
ds_read_b64_tr_b16 a[124:125],v3 offset:128
v_lshrrev_b32 v19,5,v39
v_mfma_f32_16x16x32_bf16 v[112:115],a[136:139],v[52:55],v[112:115]
s_add_u32 s87,s42,18432
ds_read_b64_tr_b16 a[130:131],v4 offset:6272
v_xor_b32 v38,v38,v19
v_mfma_f32_16x16x32_bf16 v[116:119],a[140:143],v[52:55],v[116:119]
s_add_u32 s66,s42,24576
ds_read_b64_tr_b16 a[128:129],v4 offset:128
ds_read_b64_tr_b16 a[132:133],v5 offset:128
ds_read_b64_tr_b16 a[134:135],v5 offset:6272
v_mfma_f32_16x16x32_bf16 a[164:167],a[140:143],v[56:59],a[164:167]
v_and_b32 v19,15,v39
v_lshl_add_u32 v19,v19,7,s24
v_mfma_f32_16x16x32_bf16 a[160:163],a[136:139],v[56:59],a[160:163]
v_lshl_add_u32 v19,v38,4,v19
v_bfe_u32 v38,v39,4,1
v_mfma_f32_16x16x32_bf16 a[208:211],a[136:139],v[40:43],a[208:211]
ds_read_b64_tr_b16 a[136:137],v2 offset:256
v_lshl_add_u32 v36,v38,3,v19
v_mfma_f32_16x16x32_bf16 a[212:215],a[140:143],v[40:43],a[212:215]
s_waitcnt lgkmcnt(6)
ds_read_b64_tr_b16 a[138:139],v2 offset:6400
v_xor_b32 v38,64,v36
v_mfma_f32_16x16x32_bf16 a[216:219],a[144:147],v[40:43],a[216:219]
ds_read_b64_tr_b16 a[140:141],v3 offset:256
v_bfe_u32 v19,v39,3,1
v_mfma_f32_16x16x32_bf16 a[220:223],a[148:151],v[40:43],a[220:223]
ds_read_b64_tr_b16 a[142:143],v3 offset:6400
v_xor_b32 v37,32,v36
v_mfma_f32_16x16x32_bf16 a[172:175],a[148:151],v[56:59],a[172:175]
v_xor_b32 v39,96,v36
v_lshlrev_b32 v19,11,v19
v_mfma_f32_16x16x32_bf16 a[168:171],a[144:147],v[56:59],a[168:171]
v_add_u32 v36,v36,v19
v_add_u32 v37,v37,v19
v_mfma_f32_16x16x32_bf16 v[120:123],a[144:147],v[52:55],v[120:123]
v_add_u32 v38,v38,v19
v_add_u32 v39,v39,v19
v_mfma_f32_16x16x32_bf16 v[124:127],a[148:151],v[52:55],v[124:127]
v_add_f32 v62,v62,v63
v_rcp_f32 v62,v62
v_mfma_f32_16x16x32_bf16 v[220:223],a[148:151],v[48:51],v[220:223]
v_add_f32 v68,v68,v69
v_add_f32 v68,v68,v70
v_mfma_f32_16x16x32_bf16 v[216:219],a[144:147],v[48:51],v[216:219]
v_add_f32 v68,v68,v71
v_rcp_f32 v68,v68
v_mfma_f32_16x16x32_bf16 v[168:171],a[144:147],v[44:47],v[168:171]
ds_read_b64_tr_b16 a[146:147],v4 offset:6400
v_accvgpr_read_b32 v106,a170
v_mfma_f32_16x16x32_bf16 v[172:175],a[148:151],v[44:47],v[172:175]
ds_read_b64_tr_b16 a[144:145],v4 offset:256
v_accvgpr_read_b32 v91,a163
v_mfma_f32_16x16x32_bf16 v[176:179],a[120:123],v[44:47],v[176:179]
s_waitcnt lgkmcnt(2)
ds_read_b64_tr_b16 a[150:151],v5 offset:6400
v_accvgpr_read_b32 v108,a216
v_mfma_f32_16x16x32_bf16 v[180:183],a[124:127],v[44:47],v[180:183]
ds_read_b64_tr_b16 a[148:149],v5 offset:256
v_accvgpr_read_b32 v98,a166
v_mfma_f32_16x16x32_bf16 v[228:231],a[124:127],v[48:51],v[228:231]
v_add_f32 v66,v66,v67
v_rcp_f32 v66,v66
v_mfma_f32_16x16x32_bf16 v[224:227],a[120:123],v[48:51],v[224:227]
v_accvgpr_read_b32 v99,a167
v_accvgpr_read_b32 v88,a160
v_mfma_f32_16x16x32_bf16 v[128:131],a[120:123],v[52:55],v[128:131]
v_accvgpr_read_b32 v94,a210
v_accvgpr_read_b32 v111,a219
v_mfma_f32_16x16x32_bf16 v[132:135],a[124:127],v[52:55],v[132:135]
v_accvgpr_read_b32 v110,a218
v_accvgpr_read_b32 v105,a169
v_mfma_f32_16x16x32_bf16 a[180:183],a[124:127],v[56:59],a[180:183]
v_accvgpr_read_b32 v109,a217
v_accvgpr_read_b32 v93,a209
v_accvgpr_read_b32 v89,a161
v_accvgpr_read_b32 v104,a168
v_accvgpr_read_b32 v96,a164
v_pk_mul_f32 v[228:229],v[228:229],v[62:63] op_sel_hi:[1,0]
v_pk_mul_f32 v[224:225],v[224:225],v[62:63] op_sel_hi:[1,0]
v_pk_mul_f32 v[230:231],v[230:231],v[62:63] op_sel_hi:[1,0]
v_pk_mul_f32 v[214:215],v[214:215],v[62:63] op_sel_hi:[1,0]
v_pk_mul_f32 v[210:211],v[210:211],v[62:63] op_sel_hi:[1,0]
v_pk_mul_f32 v[226:227],v[226:227],v[62:63] op_sel_hi:[1,0]
v_pk_mul_f32 v[208:209],v[208:209],v[62:63] op_sel_hi:[1,0]
v_pk_mul_f32 v[212:213],v[212:213],v[62:63] op_sel_hi:[1,0]
v_cvt_pk_bf16_f32 v208,v208,v209
v_cvt_pk_bf16_f32 v224,v224,v225
v_mfma_f32_16x16x32_bf16 a[176:179],a[120:123],v[56:59],a[176:179]
v_cvt_pk_bf16_f32 v225,v226,v227
v_accvgpr_read_b32 v227,a223
v_mfma_f32_16x16x32_bf16 a[224:227],a[120:123],v[40:43],a[224:227]
v_accvgpr_read_b32 v226,a222
v_cvt_pk_bf16_f32 v209,v210,v211
v_mfma_f32_16x16x32_bf16 a[228:231],a[124:127],v[40:43],a[228:231]
ds_write2st64_b64 v36,v[208:209],v[224:225] offset0:12 offset1:14
v_mfma_f32_16x16x32_bf16 a[232:235],a[128:131],v[40:43],a[232:235]
v_sub_u32 v36,v36,v19
v_accvgpr_read_b32 v210,a174
v_mfma_f32_16x16x32_bf16 a[236:239],a[132:135],v[40:43],a[236:239]
v_accvgpr_read_b32 v211,a175
v_accvgpr_read_b32 v225,a221
v_mfma_f32_16x16x32_bf16 a[188:191],a[132:135],v[56:59],a[188:191]
v_accvgpr_read_b32 v208,a172
v_accvgpr_read_b32 v209,a173
v_mfma_f32_16x16x32_bf16 a[184:187],a[128:131],v[56:59],a[184:187]
v_accvgpr_read_b32 v107,a171
v_accvgpr_read_b32 v97,a165
v_mfma_f32_16x16x32_bf16 v[136:139],a[128:131],v[52:55],v[136:139]
v_accvgpr_read_b32 v224,a220
v_accvgpr_read_b32 v95,a211
v_mfma_f32_16x16x32_bf16 v[140:143],a[132:135],v[52:55],v[140:143]
v_accvgpr_read_b32 v103,a215
v_accvgpr_read_b32 v90,a162
v_mfma_f32_16x16x32_bf16 v[236:239],a[132:135],v[48:51],v[236:239]
v_accvgpr_read_b32 v102,a214
v_accvgpr_read_b32 v92,a208
v_mfma_f32_16x16x32_bf16 v[232:235],a[128:131],v[48:51],v[232:235]
v_accvgpr_read_b32 v101,a213
v_accvgpr_read_b32 v100,a212
v_mfma_f32_16x16x32_bf16 v[184:187],a[128:131],v[44:47],v[184:187]
v_add_f32 v64,v64,v65
v_rcp_f32 v64,v64
v_mfma_f32_16x16x32_bf16 v[188:191],a[132:135],v[44:47],v[188:191]
v_cvt_pk_bf16_f32 v212,v212,v213
v_cvt_pk_bf16_f32 v228,v228,v229
v_mfma_f32_16x16x32_bf16 v[192:195],a[136:139],v[44:47],v[192:195]
v_cvt_pk_bf16_f32 v229,v230,v231
v_cvt_pk_bf16_f32 v213,v214,v215
ds_write2st64_b64 v37,v[212:213],v[228:229] offset0:12 offset1:14
v_pk_mul_f32 v[238:239],v[238:239],v[62:63] op_sel_hi:[1,0]
v_pk_mul_f32 v[236:237],v[236:237],v[62:63] op_sel_hi:[1,0]
v_pk_mul_f32 v[210:211],v[210:211],v[66:67] op_sel_hi:[1,0]
v_pk_mul_f32 v[92:93],v[92:93],v[68:69] op_sel_hi:[1,0]
v_pk_mul_f32 v[226:227],v[226:227],v[68:69] op_sel_hi:[1,0]
v_pk_mul_f32 v[96:97],v[96:97],v[66:67] op_sel_hi:[1,0]
v_pk_mul_f32 v[98:99],v[98:99],v[66:67] op_sel_hi:[1,0]
v_pk_mul_f32 v[108:109],v[108:109],v[68:69] op_sel_hi:[1,0]
v_pk_mul_f32 v[100:101],v[100:101],v[68:69] op_sel_hi:[1,0]
v_pk_mul_f32 v[232:233],v[232:233],v[62:63] op_sel_hi:[1,0]
v_pk_mul_f32 v[234:235],v[234:235],v[62:63] op_sel_hi:[1,0]
v_pk_mul_f32 v[106:107],v[106:107],v[66:67] op_sel_hi:[1,0]
v_pk_mul_f32 v[218:219],v[218:219],v[62:63] op_sel_hi:[1,0]
v_pk_mul_f32 v[216:217],v[216:217],v[62:63] op_sel_hi:[1,0]
v_pk_mul_f32 v[110:111],v[110:111],v[68:69] op_sel_hi:[1,0]
v_pk_mul_f32 v[94:95],v[94:95],v[68:69] op_sel_hi:[1,0]
v_pk_mul_f32 v[222:223],v[222:223],v[62:63] op_sel_hi:[1,0]
v_pk_mul_f32 v[224:225],v[224:225],v[68:69] op_sel_hi:[1,0]
v_pk_mul_f32 v[102:103],v[102:103],v[68:69] op_sel_hi:[1,0]
v_pk_mul_f32 v[220:221],v[220:221],v[62:63] op_sel_hi:[1,0]
v_pk_mul_f32 v[90:91],v[90:91],v[66:67] op_sel_hi:[1,0]
v_pk_mul_f32 v[208:209],v[208:209],v[66:67] op_sel_hi:[1,0]
v_pk_mul_f32 v[104:105],v[104:105],v[66:67] op_sel_hi:[1,0]
v_pk_mul_f32 v[88:89],v[88:89],v[66:67] op_sel_hi:[1,0]
v_sub_u32 v37,v37,v19
v_cvt_pk_bf16_f32 v236,v236,v237
v_mfma_f32_16x16x32_bf16 v[196:199],a[140:143],v[44:47],v[196:199]
v_cvt_pk_bf16_f32 v232,v232,v233
v_cvt_pk_bf16_f32 v220,v220,v221
v_mfma_f32_16x16x32_bf16 v[244:247],a[140:143],v[48:51],v[244:247]
v_cvt_pk_bf16_f32 v237,v238,v239
v_cvt_pk_bf16_f32 v233,v234,v235
v_mfma_f32_16x16x32_bf16 v[240:243],a[136:139],v[48:51],v[240:243]
v_cvt_pk_bf16_f32 v216,v216,v217
v_cvt_pk_bf16_f32 v217,v218,v219
v_mfma_f32_16x16x32_bf16 v[144:147],a[136:139],v[52:55],v[144:147]
ds_write2st64_b64 v38,v[216:217],v[232:233] offset0:12 offset1:14
v_mfma_f32_16x16x32_bf16 v[148:151],a[140:143],v[52:55],v[148:151]
v_sub_u32 v38,v38,v19
v_cvt_pk_bf16_f32 v221,v222,v223
v_mfma_f32_16x16x32_bf16 a[196:199],a[140:143],v[56:59],a[196:199]
v_cvt_pk_bf16_f32 v88,v88,v89
v_cvt_pk_bf16_f32 v92,v92,v93
v_cvt_pk_bf16_f32 v96,v96,v97
v_cvt_pk_bf16_f32 v93,v94,v95
v_cvt_pk_bf16_f32 v89,v90,v91
ds_write2st64_b64 v39,v[220:221],v[236:237] offset0:12 offset1:14
v_pk_mul_f32 v[244:245],v[244:245],v[62:63] op_sel_hi:[1,0]
v_pk_mul_f32 v[242:243],v[242:243],v[62:63] op_sel_hi:[1,0]
v_pk_mul_f32 v[112:113],v[112:113],v[64:65] op_sel_hi:[1,0]
ds_read_b128 v[72:75],v10 offset:6144
v_pk_mul_f32 v[118:119],v[118:119],v[64:65] op_sel_hi:[1,0]
ds_read_b128 v[76:79],v10 offset:9216
v_pk_mul_f32 v[116:117],v[116:117],v[64:65] op_sel_hi:[1,0]
ds_read_b128 v[80:83],v10 offset:7168
v_pk_mul_f32 v[240:241],v[240:241],v[62:63] op_sel_hi:[1,0]
ds_read_b128 v[84:87],v10 offset:10240
v_pk_mul_f32 v[114:115],v[114:115],v[64:65] op_sel_hi:[1,0]
ds_write2st64_b64 v36,v[88:89],v[92:93] offset0:36 offset1:40
v_pk_mul_f32 v[246:247],v[246:247],v[62:63] op_sel_hi:[1,0]
v_sub_u32 v39,v39,v19
v_add_u32 v36,v36,v19
v_mfma_f32_16x16x32_bf16 a[192:195],a[136:139],v[56:59],a[192:195]
v_cvt_pk_bf16_f32 v104,v104,v105
v_cvt_pk_bf16_f32 v224,v224,v225
v_mfma_f32_16x16x32_bf16 a[240:243],a[136:139],v[40:43],a[240:243]
s_waitcnt lgkmcnt(4)
buffer_store_dwordx4 v[72:75],v9,s[16:19],s85 offen offset:0 nt
v_cvt_pk_bf16_f32 v100,v100,v101
v_cvt_pk_bf16_f32 v108,v108,v109
v_cvt_pk_bf16_f32 v105,v106,v107
v_mfma_f32_16x16x32_bf16 a[244:247],a[140:143],v[40:43],a[244:247]
v_cvt_pk_bf16_f32 v101,v102,v103
v_cvt_pk_bf16_f32 v208,v208,v209
v_mfma_f32_16x16x32_bf16 a[248:251],a[144:147],v[40:43],a[248:251]
v_cvt_pk_bf16_f32 v97,v98,v99
v_cvt_pk_bf16_f32 v109,v110,v111
v_mfma_f32_16x16x32_bf16 a[252:255],a[148:151],v[40:43],a[252:255]
ds_write2st64_b64 v37,v[96:97],v[100:101] offset0:36 offset1:40
v_mfma_f32_16x16x32_bf16 a[204:207],a[148:151],v[56:59],a[204:207]
v_add_u32 v37,v37,v19
v_cvt_pk_bf16_f32 v225,v226,v227
v_mfma_f32_16x16x32_bf16 a[200:203],a[144:147],v[56:59],a[200:203]
s_waitcnt lgkmcnt(1)
buffer_store_dwordx4 v[76:79],v9,s[16:19],s85 offen offset:3072 nt
v_cvt_pk_bf16_f32 v209,v210,v211
v_cvt_pk_bf16_f32 v112,v112,v113
v_cvt_pk_bf16_f32 v116,v116,v117
v_mfma_f32_16x16x32_bf16 v[152:155],a[144:147],v[52:55],v[152:155]
v_cvt_pk_bf16_f32 v244,v244,v245
v_cvt_pk_bf16_f32 v117,v118,v119
v_mfma_f32_16x16x32_bf16 v[156:159],a[148:151],v[52:55],v[156:159]
v_cvt_pk_bf16_f32 v240,v240,v241
v_cvt_pk_bf16_f32 v113,v114,v115
v_mfma_f32_16x16x32_bf16 v[252:255],a[148:151],v[48:51],v[252:255]
ds_write2st64_b64 v38,v[104:105],v[108:109] offset0:36 offset1:40
v_mfma_f32_16x16x32_bf16 v[248:251],a[144:147],v[48:51],v[248:251]
v_add_u32 v38,v38,v19
v_cvt_pk_bf16_f32 v241,v242,v243
v_mfma_f32_16x16x32_bf16 v[200:203],a[144:147],v[44:47],v[200:203]
buffer_store_dwordx4 v[80:83],v9,s[16:19],s85 offen offset:128 nt
v_cvt_pk_bf16_f32 v245,v246,v247
v_accvgpr_read_b32 v77,a225
v_accvgpr_read_b32 v72,a176
v_mfma_f32_16x16x32_bf16 v[204:207],a[148:151],v[44:47],v[204:207]
v_accvgpr_read_b32 v74,a178
v_accvgpr_read_b32 v81,a181
v_accvgpr_read_b32 v101,a233
v_accvgpr_read_b32 v80,a180
ds_write2st64_b64 v39,v[208:209],v[224:225] offset0:36 offset1:40
v_pk_mul_f32 v[248:249],v[248:249],v[62:63] op_sel_hi:[1,0]
v_pk_mul_f32 v[250:251],v[250:251],v[62:63] op_sel_hi:[1,0]
v_pk_mul_f32 v[122:123],v[122:123],v[64:65] op_sel_hi:[1,0]
ds_read_b128 v[212:215],v10 offset:18432
buffer_store_dwordx4 v[84:87],v9,s[16:19],s85 offen offset:3200 nt
ds_read_b128 v[228:231],v10 offset:19456
v_pk_mul_f32 v[120:121],v[120:121],v[64:65] op_sel_hi:[1,0]
ds_read_b128 v[216:219],v10 offset:20480
v_pk_mul_f32 v[252:253],v[252:253],v[62:63] op_sel_hi:[1,0]
ds_read_b128 v[232:235],v10 offset:21504
v_pk_mul_f32 v[124:125],v[124:125],v[64:65] op_sel_hi:[1,0]
ds_write2st64_b64 v36,v[240:241],v[112:113] offset0:16 offset1:24
v_pk_mul_f32 v[126:127],v[126:127],v[64:65] op_sel_hi:[1,0]
v_pk_mul_f32 v[254:255],v[254:255],v[62:63] op_sel_hi:[1,0]
v_pk_mul_f32 v[80:81],v[80:81],v[66:67] op_sel_hi:[1,0]
v_pk_mul_f32 v[128:129],v[128:129],v[64:65] op_sel_hi:[1,0]
v_pk_mul_f32 v[150:151],v[150:151],v[64:65] op_sel_hi:[1,0]
v_pk_mul_f32 v[146:147],v[146:147],v[64:65] op_sel_hi:[1,0]
v_pk_mul_f32 v[144:145],v[144:145],v[64:65] op_sel_hi:[1,0]
s_waitcnt lgkmcnt(4)
buffer_store_dwordx4 v[212:215],v9,s[16:19],s87 offen offset:0 nt
v_pk_mul_f32 v[148:149],v[148:149],v[64:65] op_sel_hi:[1,0]
v_pk_mul_f32 v[156:157],v[156:157],v[64:65] op_sel_hi:[1,0]
v_pk_mul_f32 v[136:137],v[136:137],v[64:65] op_sel_hi:[1,0]
v_pk_mul_f32 v[132:133],v[132:133],v[64:65] op_sel_hi:[1,0]
v_pk_mul_f32 v[154:155],v[154:155],v[64:65] op_sel_hi:[1,0]
v_pk_mul_f32 v[152:153],v[152:153],v[64:65] op_sel_hi:[1,0]
v_pk_mul_f32 v[130:131],v[130:131],v[64:65] op_sel_hi:[1,0]
v_pk_mul_f32 v[158:159],v[158:159],v[64:65] op_sel_hi:[1,0]
v_pk_mul_f32 v[134:135],v[134:135],v[64:65] op_sel_hi:[1,0]
ds_write2st64_b64 v37,v[244:245],v[116:117] offset0:16 offset1:24
v_pk_mul_f32 v[138:139],v[138:139],v[64:65] op_sel_hi:[1,0]
v_pk_mul_f32 v[142:143],v[142:143],v[64:65] op_sel_hi:[1,0]
v_pk_mul_f32 v[140:141],v[140:141],v[64:65] op_sel_hi:[1,0]
s_waitcnt lgkmcnt(1)
buffer_store_dwordx4 v[228:231],v9,s[16:19],s87 offen offset:3072 nt
v_add_u32 v39,v39,v19
v_sub_u32 v37,v37,v19
v_sub_u32 v36,v36,v19
v_cvt_pk_bf16_f32 v248,v248,v249
v_cvt_pk_bf16_f32 v120,v120,v121
v_cvt_pk_bf16_f32 v252,v252,v253
v_cvt_pk_bf16_f32 v249,v250,v251
v_cvt_pk_bf16_f32 v121,v122,v123
v_cvt_pk_bf16_f32 v124,v124,v125
ds_write2st64_b64 v38,v[248:249],v[120:121] offset0:16 offset1:24
v_sub_u32 v38,v38,v19
v_cvt_pk_bf16_f32 v125,v126,v127
v_cvt_pk_bf16_f32 v253,v254,v255
buffer_store_dwordx4 v[216:219],v9,s[16:19],s66 offen offset:0 nt
v_accvgpr_read_b32 v84,a228
v_accvgpr_read_b32 v100,a232
v_pk_mul_f32 v[100:101],v[100:101],v[68:69] op_sel_hi:[1,0]
v_accvgpr_read_b32 v97,a185
v_accvgpr_read_b32 v78,a226
v_accvgpr_read_b32 v98,a186
v_accvgpr_read_b32 v75,a179
v_pk_mul_f32 v[74:75],v[74:75],v[66:67] op_sel_hi:[1,0]
v_accvgpr_read_b32 v109,a237
ds_write2st64_b64 v39,v[252:253],v[124:125] offset0:16 offset1:24
v_sub_u32 v39,v39,v19
v_cvt_pk_bf16_f32 v80,v80,v81
v_accvgpr_read_b32 v79,a227
ds_read_b128 v[220:223],v10 offset:8192
buffer_store_dwordx4 v[232:235],v9,s[16:19],s66 offen offset:3072 nt
ds_read_b128 v[236:239],v10 offset:11264
v_pk_mul_f32 v[78:79],v[78:79],v[68:69] op_sel_hi:[1,0]
ds_read_b128 v[88:91],v10 offset:12288
v_accvgpr_read_b32 v73,a177
ds_read_b128 v[92:95],v10 offset:15360
v_pk_mul_f32 v[72:73],v[72:73],v[66:67] op_sel_hi:[1,0]
v_accvgpr_read_b32 v76,a224
v_pk_mul_f32 v[76:77],v[76:77],v[68:69] op_sel_hi:[1,0]
v_cvt_pk_bf16_f32 v72,v72,v73
v_cvt_pk_bf16_f32 v76,v76,v77
v_accvgpr_read_b32 v85,a229
v_pk_mul_f32 v[84:85],v[84:85],v[68:69] op_sel_hi:[1,0]
v_accvgpr_read_b32 v82,a182
v_cvt_pk_bf16_f32 v84,v84,v85
v_accvgpr_read_b32 v104,a188
v_cvt_pk_bf16_f32 v100,v100,v101
v_accvgpr_read_b32 v111,a239
v_accvgpr_read_b32 v96,a184
v_pk_mul_f32 v[96:97],v[96:97],v[66:67] op_sel_hi:[1,0]
v_accvgpr_read_b32 v102,a234
s_waitcnt lgkmcnt(3)
buffer_store_dwordx4 v[220:223],v9,s[16:19],s85 offen offset:256 nt
v_accvgpr_read_b32 v86,a230
v_accvgpr_read_b32 v83,a183
v_pk_mul_f32 v[82:83],v[82:83],v[66:67] op_sel_hi:[1,0]
v_cvt_pk_bf16_f32 v73,v74,v75
v_cvt_pk_bf16_f32 v81,v82,v83
v_accvgpr_read_b32 v87,a231
v_pk_mul_f32 v[86:87],v[86:87],v[68:69] op_sel_hi:[1,0]
v_accvgpr_read_b32 v108,a236
v_pk_mul_f32 v[108:109],v[108:109],v[68:69] op_sel_hi:[1,0]
v_cvt_pk_bf16_f32 v85,v86,v87
v_accvgpr_read_b32 v107,a191
s_waitcnt lgkmcnt(0)
buffer_store_dwordx4 v[236:239],v9,s[16:19],s85 offen offset:3328 nt
v_cvt_pk_bf16_f32 v96,v96,v97
v_accvgpr_read_b32 v103,a235
v_pk_mul_f32 v[102:103],v[102:103],v[68:69] op_sel_hi:[1,0]
v_accvgpr_read_b32 v106,a190
v_pk_mul_f32 v[106:107],v[106:107],v[66:67] op_sel_hi:[1,0]
v_accvgpr_read_b32 v110,a238
v_pk_mul_f32 v[110:111],v[110:111],v[68:69] op_sel_hi:[1,0]
v_cvt_pk_bf16_f32 v77,v78,v79
v_accvgpr_read_b32 v105,a189
ds_write2st64_b64 v36,v[72:73],v[76:77] offset0:36 offset1:40
v_pk_mul_f32 v[104:105],v[104:105],v[66:67] op_sel_hi:[1,0]
v_add_u32 v36,v36,v19
v_accvgpr_read_b32 v99,a187
buffer_store_dwordx4 v[88:91],v9,s[16:19],s86 offen offset:0 nt
v_pk_mul_f32 v[98:99],v[98:99],v[66:67] op_sel_hi:[1,0]
v_cvt_pk_bf16_f32 v104,v104,v105
v_cvt_pk_bf16_f32 v97,v98,v99
v_cvt_pk_bf16_f32 v105,v106,v107
v_cvt_pk_bf16_f32 v101,v102,v103
v_cvt_pk_bf16_f32 v108,v108,v109
v_cvt_pk_bf16_f32 v109,v110,v111
v_cvt_pk_bf16_f32 v144,v144,v145
v_cvt_pk_bf16_f32 v132,v132,v133
ds_write2st64_b64 v37,v[80:81],v[84:85] offset0:36 offset1:40
v_add_u32 v37,v37,v19
v_cvt_pk_bf16_f32 v152,v152,v153
v_cvt_pk_bf16_f32 v136,v136,v137
buffer_store_dwordx4 v[92:95],v9,s[16:19],s86 offen offset:3072 nt
v_cvt_pk_bf16_f32 v128,v128,v129
v_cvt_pk_bf16_f32 v129,v130,v131
v_cvt_pk_bf16_f32 v133,v134,v135
v_cvt_pk_bf16_f32 v156,v156,v157
v_cvt_pk_bf16_f32 v145,v146,v147
v_cvt_pk_bf16_f32 v140,v140,v141
v_cvt_pk_bf16_f32 v148,v148,v149
v_cvt_pk_bf16_f32 v137,v138,v139
v_cvt_pk_bf16_f32 v149,v150,v151
ds_write2st64_b64 v38,v[96:97],v[100:101] offset0:36 offset1:40
v_add_u32 v38,v38,v19
v_cvt_pk_bf16_f32 v153,v154,v155
v_accvgpr_read_b32 v244,a192
v_accvgpr_read_b32 v116,a240
v_cvt_pk_bf16_f32 v141,v142,v143
v_cvt_pk_bf16_f32 v157,v158,v159
v_accvgpr_read_b32 v245,a193
v_pk_mul_f32 v[244:245],v[244:245],v[66:67] op_sel_hi:[1,0]
v_accvgpr_read_b32 v247,a195
v_cvt_pk_bf16_f32 v244,v244,v245
v_accvgpr_read_b32 v127,a251
ds_write2st64_b64 v39,v[104:105],v[108:109] offset0:36 offset1:40
v_add_u32 v39,v39,v19
v_accvgpr_read_b32 v119,a243
v_accvgpr_read_b32 v122,a246
ds_read_b128 v[208:211],v10 offset:18432
v_accvgpr_read_b32 v76,a252
ds_read_b128 v[224:227],v10 offset:19456
v_accvgpr_read_b32 v125,a249
ds_read_b128 v[240:243],v10 offset:20480
v_accvgpr_read_b32 v250,a198
ds_read_b128 v[112:115],v10 offset:21504
v_accvgpr_read_b32 v249,a197
ds_write2st64_b64 v36,v[128:129],v[144:145] offset0:26 offset1:28
v_sub_u32 v36,v36,v19
v_accvgpr_read_b32 v251,a199
v_pk_mul_f32 v[250:251],v[250:251],v[66:67] op_sel_hi:[1,0]
v_accvgpr_read_b32 v117,a241
v_pk_mul_f32 v[116:117],v[116:117],v[68:69] op_sel_hi:[1,0]
v_accvgpr_read_b32 v123,a247
v_pk_mul_f32 v[122:123],v[122:123],v[68:69] op_sel_hi:[1,0]
s_waitcnt lgkmcnt(4)
buffer_store_dwordx4 v[208:211],v9,s[16:19],s87 offen offset:128 nt
v_cvt_pk_bf16_f32 v116,v116,v117
v_accvgpr_read_b32 v248,a196
v_pk_mul_f32 v[248:249],v[248:249],v[66:67] op_sel_hi:[1,0]
v_accvgpr_read_b32 v252,a200
v_accvgpr_read_b32 v120,a244
v_accvgpr_read_b32 v118,a242
v_pk_mul_f32 v[118:119],v[118:119],v[68:69] op_sel_hi:[1,0]
v_accvgpr_read_b32 v79,a255
v_cvt_pk_bf16_f32 v117,v118,v119
ds_write2st64_b64 v37,v[132:133],v[148:149] offset0:26 offset1:28
v_sub_u32 v37,v37,v19
v_accvgpr_read_b32 v246,a194
v_pk_mul_f32 v[246:247],v[246:247],v[66:67] op_sel_hi:[1,0]
s_waitcnt lgkmcnt(1)
buffer_store_dwordx4 v[224:227],v9,s[16:19],s87 offen offset:3200 nt
v_accvgpr_read_b32 v121,a245
v_pk_mul_f32 v[120:121],v[120:121],v[68:69] op_sel_hi:[1,0]
v_accvgpr_read_b32 v255,a203
v_cvt_pk_bf16_f32 v120,v120,v121
v_accvgpr_read_b32 v78,a254
v_pk_mul_f32 v[78:79],v[78:79],v[68:69] op_sel_hi:[1,0]
v_accvgpr_read_b32 v124,a248
v_pk_mul_f32 v[124:125],v[124:125],v[68:69] op_sel_hi:[1,0]
v_accvgpr_read_b32 v126,a250
ds_write2st64_b64 v38,v[136:137],v[152:153] offset0:26 offset1:28
v_pk_mul_f32 v[126:127],v[126:127],v[68:69] op_sel_hi:[1,0]
v_sub_u32 v38,v38,v19
v_accvgpr_read_b32 v254,a202
buffer_store_dwordx4 v[240:243],v9,s[16:19],s66 offen offset:128 nt
v_pk_mul_f32 v[254:255],v[254:255],v[66:67] op_sel_hi:[1,0]
v_cvt_pk_bf16_f32 v124,v124,v125
v_accvgpr_read_b32 v77,a253
v_pk_mul_f32 v[76:77],v[76:77],v[68:69] op_sel_hi:[1,0]
v_accvgpr_read_b32 v74,a206
v_accvgpr_read_b32 v253,a201
v_pk_mul_f32 v[252:253],v[252:253],v[66:67] op_sel_hi:[1,0]
v_accvgpr_read_b32 v73,a205
v_cvt_pk_bf16_f32 v252,v252,v253
ds_write2st64_b64 v39,v[140:141],v[156:157] offset0:26 offset1:28
v_sub_u32 v39,v39,v19
v_cvt_pk_bf16_f32 v125,v126,v127
v_accvgpr_read_b32 v72,a204
ds_read_b128 v[212:215],v10 offset:13312
buffer_store_dwordx4 v[112:115],v9,s[16:19],s66 offen offset:3200 nt
ds_read_b128 v[228:231],v10 offset:16384
v_pk_mul_f32 v[72:73],v[72:73],v[66:67] op_sel_hi:[1,0]
ds_read_b128 v[216:219],v10 offset:14336
v_cvt_pk_bf16_f32 v76,v76,v77
ds_read_b128 v[232:235],v10 offset:17408
v_cvt_pk_bf16_f32 v245,v246,v247
ds_write2st64_b64 v36,v[244:245],v[116:117] offset0:36 offset1:40
v_add_u32 v36,v36,v19
v_cvt_pk_bf16_f32 v72,v72,v73
v_cvt_pk_bf16_f32 v248,v248,v249
v_cvt_pk_bf16_f32 v249,v250,v251
v_accvgpr_read_b32 v75,a207
v_pk_mul_f32 v[74:75],v[74:75],v[66:67] op_sel_hi:[1,0]
v_cvt_pk_bf16_f32 v121,v122,v123
s_waitcnt lgkmcnt(4)
buffer_store_dwordx4 v[212:215],v9,s[16:19],s86 offen offset:128 nt
v_add_f32 v60,v60,v61
v_cvt_pk_bf16_f32 v253,v254,v255
v_cvt_pk_bf16_f32 v73,v74,v75
v_cvt_pk_bf16_f32 v77,v78,v79
v_rcp_f32 v60,v60
ds_write2st64_b64 v37,v[248:249],v[120:121] offset0:36 offset1:40
v_pk_mul_f32 v[176:177],v[176:177],v[60:61] op_sel_hi:[1,0]
v_pk_mul_f32 v[180:181],v[180:181],v[60:61] op_sel_hi:[1,0]
v_pk_mul_f32 v[164:165],v[164:165],v[60:61] op_sel_hi:[1,0]
s_waitcnt lgkmcnt(1)
buffer_store_dwordx4 v[228:231],v9,s[16:19],s86 offen offset:3200 nt
v_pk_mul_f32 v[166:167],v[166:167],v[60:61] op_sel_hi:[1,0]
v_pk_mul_f32 v[162:163],v[162:163],v[60:61] op_sel_hi:[1,0]
v_pk_mul_f32 v[160:161],v[160:161],v[60:61] op_sel_hi:[1,0]
v_pk_mul_f32 v[182:183],v[182:183],v[60:61] op_sel_hi:[1,0]
v_pk_mul_f32 v[186:187],v[186:187],v[60:61] op_sel_hi:[1,0]
v_pk_mul_f32 v[168:169],v[168:169],v[60:61] op_sel_hi:[1,0]
v_pk_mul_f32 v[178:179],v[178:179],v[60:61] op_sel_hi:[1,0]
v_pk_mul_f32 v[190:191],v[190:191],v[60:61] op_sel_hi:[1,0]
v_pk_mul_f32 v[172:173],v[172:173],v[60:61] op_sel_hi:[1,0]
ds_write2st64_b64 v38,v[252:253],v[124:125] offset0:36 offset1:40
v_pk_mul_f32 v[188:189],v[188:189],v[60:61] op_sel_hi:[1,0]
v_pk_mul_f32 v[170:171],v[170:171],v[60:61] op_sel_hi:[1,0]
v_pk_mul_f32 v[184:185],v[184:185],v[60:61] op_sel_hi:[1,0]
buffer_store_dwordx4 v[216:219],v9,s[16:19],s86 offen offset:256 nt
v_pk_mul_f32 v[174:175],v[174:175],v[60:61] op_sel_hi:[1,0]
v_pk_mul_f32 v[196:197],v[196:197],v[60:61] op_sel_hi:[1,0]
v_pk_mul_f32 v[192:193],v[192:193],v[60:61] op_sel_hi:[1,0]
v_pk_mul_f32 v[200:201],v[200:201],v[60:61] op_sel_hi:[1,0]
v_pk_mul_f32 v[198:199],v[198:199],v[60:61] op_sel_hi:[1,0]
v_pk_mul_f32 v[194:195],v[194:195],v[60:61] op_sel_hi:[1,0]
v_pk_mul_f32 v[202:203],v[202:203],v[60:61] op_sel_hi:[1,0]
v_pk_mul_f32 v[204:205],v[204:205],v[60:61] op_sel_hi:[1,0]
v_pk_mul_f32 v[206:207],v[206:207],v[60:61] op_sel_hi:[1,0]
ds_write2st64_b64 v39,v[72:73],v[76:77] offset0:36 offset1:40
v_add_u32 v37,v37,v19
v_add_u32 v38,v38,v19
v_add_u32 v39,v39,v19
ds_read_b128 v[80:83],v10 offset:18432
buffer_store_dwordx4 v[232:235],v9,s[16:19],s86 offen offset:3328 nt
ds_read_b128 v[84:87],v10 offset:19456
v_cvt_pk_bf16_f32 v160,v160,v161
ds_read_b128 v[88:91],v10 offset:20480
v_cvt_pk_bf16_f32 v180,v180,v181
ds_read_b128 v[92:95],v10 offset:21504
v_cvt_pk_bf16_f32 v161,v162,v163
v_cvt_pk_bf16_f32 v176,v176,v177
v_cvt_pk_bf16_f32 v168,v168,v169
v_cvt_pk_bf16_f32 v172,v172,v173
v_cvt_pk_bf16_f32 v177,v178,v179
ds_write2st64_b64 v36,v[160:161],v[176:177] offset0:0 offset1:2
v_cvt_pk_bf16_f32 v164,v164,v165
v_cvt_pk_bf16_f32 v184,v184,v185
v_cvt_pk_bf16_f32 v169,v170,v171
s_waitcnt lgkmcnt(4)
buffer_store_dwordx4 v[80:83],v9,s[16:19],s87 offen offset:256 nt
v_cvt_pk_bf16_f32 v181,v182,v183
v_cvt_pk_bf16_f32 v185,v186,v187
v_cvt_pk_bf16_f32 v165,v166,v167
v_cvt_pk_bf16_f32 v188,v188,v189
v_cvt_pk_bf16_f32 v189,v190,v191
v_cvt_pk_bf16_f32 v173,v174,v175
v_cvt_pk_bf16_f32 v192,v192,v193
v_cvt_pk_bf16_f32 v193,v194,v195
v_cvt_pk_bf16_f32 v204,v204,v205
ds_write2st64_b64 v37,v[164:165],v[180:181] offset0:0 offset1:2
v_cvt_pk_bf16_f32 v196,v196,v197
v_cvt_pk_bf16_f32 v197,v198,v199
v_cvt_pk_bf16_f32 v200,v200,v201
s_waitcnt lgkmcnt(1)
buffer_store_dwordx4 v[84:87],v9,s[16:19],s87 offen offset:3328 nt
v_cvt_pk_bf16_f32 v201,v202,v203
v_cvt_pk_bf16_f32 v205,v206,v207
v_min3_f32 v61,v60,v62,v64
v_min3_f32 v61,v61,v66,v68
v_cmp_nlt_f32 vcc,s37,v61
ds_write2st64_b64 v38,v[168:169],v[184:185] offset0:0 offset1:2
buffer_store_dwordx4 v[88:91],v9,s[16:19],s66 offen offset:256 nt
ds_write2st64_b64 v39,v[172:173],v[188:189] offset0:0 offset1:2
ds_read_b128 v[220:223],v10 offset:0
buffer_store_dwordx4 v[92:95],v9,s[16:19],s66 offen offset:3328 nt
ds_read_b128 v[236:239],v10 offset:3072
s_cmp_lg_u64 vcc,0
ds_read_b128 v[96:99],v10 offset:1024
s_cselect_b32 s62,s32,0
ds_read_b128 v[100:103],v10 offset:4096
s_or_b32 s31,s31,s62
ds_write_b64 v36,v[192:193] offset:2048
s_lshl_b32 s32,s32,1
ds_write_b64 v37,v[196:197] offset:2048
s_waitcnt lgkmcnt(5)
buffer_store_dwordx4 v[220:223],v9,s[16:19],s84 offen offset:0 nt
ds_write_b64 v38,v[200:201] offset:2048
s_waitcnt lgkmcnt(2)
buffer_store_dwordx4 v[236:239],v9,s[16:19],s84 offen offset:3072 nt
ds_write_b64 v39,v[204:205] offset:2048
ds_read_b128 v[104:107],v10 offset:2048
buffer_store_dwordx4 v[96:99],v9,s[16:19],s84 offen offset:128 nt
ds_read_b128 v[108:111],v10 offset:5120
buffer_store_dwordx4 v[100:103],v9,s[16:19],s84 offen offset:3200 nt
s_waitcnt lgkmcnt(1)
buffer_store_dwordx4 v[104:107],v9,s[16:19],s84 offen offset:256 nt
s_waitcnt lgkmcnt(0)
buffer_store_dwordx4 v[108:111],v9,s[16:19],s84 offen offset:3328 nt
s_branch L_fin
L_end4:
s_waitcnt lgkmcnt(3)
v_mfma_f32_16x16x32_bf16 v[160:163],a[120:123],v[20:23],v[160:163]
ds_read_b64_tr_b16 a[136:137],v2 offset:24704
v_fma_f32 v102,v102,s36,v16
v_mfma_f32_16x16x32_bf16 v[164:167],a[124:127],v[20:23],v[164:167]
ds_read_b64_tr_b16 a[138:139],v2 offset:30848
v_fma_f32 v98,v98,s36,v16
v_mfma_f32_16x16x32_bf16 v[212:215],a[124:127],v[24:27],v[212:215]
ds_read_b64_tr_b16 a[140:141],v3 offset:24704
v_fma_f32 v76,v76,s36,v13
v_mfma_f32_16x16x32_bf16 v[208:211],a[120:123],v[24:27],v[208:211]
ds_read_b64_tr_b16 a[142:143],v3 offset:30848
v_fma_f32 v91,v91,s36,v15
v_mfma_f32_16x16x32_bf16 v[112:115],a[120:123],v[28:31],v[112:115]
ds_read_b64_tr_b16 a[144:145],v4 offset:24704
v_fma_f32 v95,v95,s36,v15
v_mfma_f32_16x16x32_bf16 v[116:119],a[124:127],v[28:31],v[116:119]
ds_read_b64_tr_b16 a[146:147],v4 offset:30848
v_fma_f32 v85,v85,s36,v14
v_mfma_f32_16x16x32_bf16 a[164:167],a[124:127],v[32:35],a[164:167]
ds_read_b64_tr_b16 a[148:149],v5 offset:24704
v_exp_f32 v76,v76
v_mfma_f32_16x16x32_bf16 a[160:163],a[120:123],v[32:35],a[160:163]
s_waitcnt lgkmcnt(6)
ds_read_b64_tr_b16 a[150:151],v5 offset:30848
v_fma_f32 v103,v103,s36,v16
v_mfma_f32_16x16x32_bf16 a[168:171],a[128:131],v[32:35],a[168:171]
ds_read_b64_tr_b16 a[120:121],v2 offset:24832
v_fma_f32 v79,v79,s36,v13
v_mfma_f32_16x16x32_bf16 a[172:175],a[132:135],v[32:35],a[172:175]
ds_read_b64_tr_b16 a[122:123],v2 offset:30976
v_fma_f32 v96,v96,s36,v16
v_mfma_f32_16x16x32_bf16 v[124:127],a[132:135],v[28:31],v[124:127]
ds_read_b64_tr_b16 a[124:125],v3 offset:24832
v_exp_f32 v102,v102
v_mfma_f32_16x16x32_bf16 v[120:123],a[128:131],v[28:31],v[120:123]
ds_read_b64_tr_b16 a[126:127],v3 offset:30976
v_fma_f32 v89,v89,s36,v15
v_mfma_f32_16x16x32_bf16 v[216:219],a[128:131],v[24:27],v[216:219]
v_fma_f32 v86,v86,s36,v14
v_fma_f32 v100,v100,s36,v16
v_mfma_f32_16x16x32_bf16 v[220:223],a[132:135],v[24:27],v[220:223]
v_exp_f32 v100,v100
v_mfma_f32_16x16x32_bf16 v[172:175],a[132:135],v[20:23],v[172:175]
ds_read_b64_tr_b16 a[132:133],v5 offset:24832
v_fma_f32 v84,v84,s36,v14
v_mfma_f32_16x16x32_bf16 v[168:171],a[128:131],v[20:23],v[168:171]
s_waitcnt lgkmcnt(4)
ds_read_b64_tr_b16 a[128:129],v4 offset:24832
v_exp_f32 v98,v98
v_mfma_f32_16x16x32_bf16 v[176:179],a[136:139],v[20:23],v[176:179]
ds_read_b64_tr_b16 a[130:131],v4 offset:30976
v_exp_f32 v79,v79
v_mfma_f32_16x16x32_bf16 v[180:183],a[140:143],v[20:23],v[180:183]
ds_read_b64_tr_b16 a[134:135],v5 offset:30976
v_exp_f32 v89,v89
v_mfma_f32_16x16x32_bf16 v[228:231],a[140:143],v[24:27],v[228:231]
v_fma_f32 v82,v82,s36,v14
v_exp_f32 v82,v82
v_mfma_f32_16x16x32_bf16 v[224:227],a[136:139],v[24:27],v[224:227]
v_fma_f32 v77,v77,s36,v13
v_exp_f32 v77,v77
v_mfma_f32_16x16x32_bf16 v[128:131],a[136:139],v[28:31],v[128:131]
v_fma_f32 v87,v87,s36,v14
v_exp_f32 v87,v87
v_mfma_f32_16x16x32_bf16 v[132:135],a[140:143],v[28:31],v[132:135]
v_exp_f32 v96,v96
v_mfma_f32_16x16x32_bf16 a[180:183],a[140:143],v[32:35],a[180:183]
v_fma_f32 v78,v78,s36,v13
v_fma_f32 v83,v83,s36,v14
v_mfma_f32_16x16x32_bf16 a[176:179],a[136:139],v[32:35],a[176:179]
v_fma_f32 v92,v92,s36,v15
v_exp_f32 v92,v92
v_mfma_f32_16x16x32_bf16 a[184:187],a[144:147],v[32:35],a[184:187]
v_fma_f32 v90,v90,s36,v15
v_exp_f32 v90,v90
v_mfma_f32_16x16x32_bf16 a[188:191],a[148:151],v[32:35],a[188:191]
v_fma_f32 v101,v101,s36,v16
v_exp_f32 v101,v101
v_mfma_f32_16x16x32_bf16 v[140:143],a[148:151],v[28:31],v[140:143]
v_fma_f32 v99,v99,s36,v16
v_exp_f32 v99,v99
v_mfma_f32_16x16x32_bf16 v[136:139],a[144:147],v[28:31],v[136:139]
v_exp_f32 v84,v84
v_mfma_f32_16x16x32_bf16 v[232:235],a[144:147],v[24:27],v[232:235]
v_fma_f32 v94,v94,s36,v15
v_fma_f32 v88,v88,s36,v15
v_mfma_f32_16x16x32_bf16 v[236:239],a[148:151],v[24:27],v[236:239]
v_fma_f32 v97,v97,s36,v16
v_exp_f32 v97,v97
v_mfma_f32_16x16x32_bf16 v[188:191],a[148:151],v[20:23],v[188:191]
v_fma_f32 v93,v93,s36,v15
v_exp_f32 v93,v93
v_mfma_f32_16x16x32_bf16 v[184:187],a[144:147],v[20:23],v[184:187]
s_waitcnt lgkmcnt(0)
v_exp_f32 v94,v94
v_mfma_f32_16x16x32_bf16 v[192:195],a[120:123],v[20:23],v[192:195]
v_exp_f32 v83,v83
v_mfma_f32_16x16x32_bf16 v[196:199],a[124:127],v[20:23],v[196:199]
v_exp_f32 v103,v103
v_mfma_f32_16x16x32_bf16 v[244:247],a[124:127],v[24:27],v[244:247]
v_exp_f32 v78,v78
v_mfma_f32_16x16x32_bf16 v[240:243],a[120:123],v[24:27],v[240:243]
v_exp_f32 v95,v95
v_mfma_f32_16x16x32_bf16 v[144:147],a[120:123],v[28:31],v[144:147]
v_cvt_pk_bf16_f32 v55,v94,v95
s_waitcnt vmcnt(12)
s_barrier
v_mfma_f32_16x16x32_bf16 v[148:151],a[124:127],v[28:31],v[148:151]
v_exp_f32 v91,v91
v_mfma_f32_16x16x32_bf16 a[196:199],a[124:127],v[32:35],a[196:199]
v_exp_f32 v85,v85
v_mfma_f32_16x16x32_bf16 a[192:195],a[120:123],v[32:35],a[192:195]
v_exp_f32 v88,v88
v_mfma_f32_16x16x32_bf16 a[200:203],a[128:131],v[32:35],a[200:203]
v_cvt_pk_bf16_f32 v52,v88,v89
v_exp_f32 v86,v86
v_mfma_f32_16x16x32_bf16 a[204:207],a[132:135],v[32:35],a[204:207]
v_cvt_pk_bf16_f32 v46,v76,v77
v_cvt_pk_bf16_f32 v49,v82,v83
v_mfma_f32_16x16x32_bf16 v[156:159],a[132:135],v[28:31],v[156:159]
v_cvt_pk_bf16_f32 v57,v98,v99
v_cvt_pk_bf16_f32 v47,v78,v79
v_mfma_f32_16x16x32_bf16 v[152:155],a[128:131],v[28:31],v[152:155]
v_cvt_pk_bf16_f32 v58,v100,v101
v_cvt_pk_bf16_f32 v59,v102,v103
v_mfma_f32_16x16x32_bf16 v[248:251],a[128:131],v[24:27],v[248:251]
v_cvt_pk_bf16_f32 v54,v92,v93
v_cvt_pk_bf16_f32 v50,v84,v85
v_mfma_f32_16x16x32_bf16 v[252:255],a[132:135],v[24:27],v[252:255]
v_cvt_pk_bf16_f32 v53,v90,v91
v_cvt_pk_bf16_f32 v51,v86,v87
v_mfma_f32_16x16x32_bf16 v[204:207],a[132:135],v[20:23],v[204:207]
v_cvt_pk_bf16_f32 v56,v96,v97
v_subrev_u32 v10,18432,v10
v_smfmac_f32_16x16x64_bf16 v[60:63],a[152:155],v[44:51],v18
ds_read_b64_tr_b16 a[138:139],v2 offset:6144
v_smfmac_f32_16x16x64_bf16 v[64:67],a[152:155],v[52:59],v18
ds_read_b64_tr_b16 a[136:137],v2 offset:0
v_mfma_f32_16x16x32_bf16 v[200:203],a[128:131],v[20:23],v[200:203]
ds_read_b64_tr_b16 a[142:143],v3 offset:6144
ds_read_b64_tr_b16 a[140:141],v3 offset:0
ds_read_b64_tr_b16 a[146:147],v4 offset:6144
ds_read_b64_tr_b16 a[144:145],v4 offset:0
ds_read_b64_tr_b16 a[150:151],v5 offset:6144
ds_read_b64_tr_b16 a[148:149],v5 offset:0
s_waitcnt lgkmcnt(6)
v_mfma_f32_16x16x32_bf16 v[160:163],a[136:139],v[44:47],v[160:163]
s_waitcnt vmcnt(6)
ds_read_b64_tr_b16 a[120:121],v2 offset:128
v_mbcnt_lo_u32_b32 v39,-1,0
s_waitcnt lgkmcnt(5)
v_mfma_f32_16x16x32_bf16 v[164:167],a[140:143],v[44:47],v[164:167]
s_add_u32 s84,s42,0
ds_read_b64_tr_b16 a[122:123],v2 offset:6272
v_mbcnt_hi_u32_b32 v39,-1,v39
v_mfma_f32_16x16x32_bf16 v[212:215],a[140:143],v[48:51],v[212:215]
s_add_u32 s85,s42,6144
ds_read_b64_tr_b16 a[124:125],v3 offset:128
v_and_b32 v38,7,v39
v_mfma_f32_16x16x32_bf16 v[208:211],a[136:139],v[48:51],v[208:211]
s_add_u32 s86,s42,12288
ds_read_b64_tr_b16 a[126:127],v3 offset:6272
v_lshrrev_b32 v19,5,v39
v_mfma_f32_16x16x32_bf16 v[112:115],a[136:139],v[52:55],v[112:115]
s_add_u32 s87,s42,18432
ds_read_b64_tr_b16 a[128:129],v4 offset:128
v_xor_b32 v38,v38,v19
v_mfma_f32_16x16x32_bf16 v[116:119],a[140:143],v[52:55],v[116:119]
ds_read_b64_tr_b16 a[130:131],v4 offset:6272
ds_read_b64_tr_b16 a[132:133],v5 offset:128
ds_read_b64_tr_b16 a[134:135],v5 offset:6272
v_mfma_f32_16x16x32_bf16 a[164:167],a[140:143],v[56:59],a[164:167]
ds_read_b64_tr_b16 a[140:141],v3 offset:256
v_and_b32 v19,15,v39
v_mfma_f32_16x16x32_bf16 a[160:163],a[136:139],v[56:59],a[160:163]
s_waitcnt lgkmcnt(8)
ds_read_b64_tr_b16 a[136:137],v2 offset:256
v_lshl_add_u32 v19,v19,7,s24
v_mfma_f32_16x16x32_bf16 a[168:171],a[144:147],v[56:59],a[168:171]
ds_read_b64_tr_b16 a[138:139],v2 offset:6400
v_lshl_add_u32 v19,v38,4,v19
v_mfma_f32_16x16x32_bf16 a[172:175],a[148:151],v[56:59],a[172:175]
ds_read_b64_tr_b16 a[142:143],v3 offset:6400
v_bfe_u32 v38,v39,4,1
v_mfma_f32_16x16x32_bf16 v[124:127],a[148:151],v[52:55],v[124:127]
v_lshl_add_u32 v36,v38,3,v19
v_bfe_u32 v19,v39,3,1
v_mfma_f32_16x16x32_bf16 v[120:123],a[144:147],v[52:55],v[120:123]
v_xor_b32 v37,32,v36
v_xor_b32 v38,64,v36
v_mfma_f32_16x16x32_bf16 v[216:219],a[144:147],v[48:51],v[216:219]
v_lshlrev_b32 v19,11,v19
v_xor_b32 v39,96,v36
v_mfma_f32_16x16x32_bf16 v[220:223],a[148:151],v[48:51],v[220:223]
v_add_u32 v36,v36,v19
v_add_u32 v37,v37,v19
v_mfma_f32_16x16x32_bf16 v[172:175],a[148:151],v[44:47],v[172:175]
ds_read_b64_tr_b16 a[148:149],v5 offset:256
v_add_u32 v38,v38,v19
v_mfma_f32_16x16x32_bf16 v[168:171],a[144:147],v[44:47],v[168:171]
s_waitcnt lgkmcnt(2)
ds_read_b64_tr_b16 a[144:145],v4 offset:256
v_add_u32 v39,v39,v19
v_mfma_f32_16x16x32_bf16 v[176:179],a[120:123],v[44:47],v[176:179]
ds_read_b64_tr_b16 a[146:147],v4 offset:6400
v_add_f32 v62,v62,v63
v_mfma_f32_16x16x32_bf16 v[180:183],a[124:127],v[44:47],v[180:183]
ds_read_b64_tr_b16 a[150:151],v5 offset:6400
v_rcp_f32 v62,v62
v_mfma_f32_16x16x32_bf16 v[228:231],a[124:127],v[48:51],v[228:231]
v_add_f32 v66,v66,v67
v_rcp_f32 v66,v66
v_mfma_f32_16x16x32_bf16 v[224:227],a[120:123],v[48:51],v[224:227]
v_accvgpr_read_b32 v96,a164
v_accvgpr_read_b32 v97,a165
v_mfma_f32_16x16x32_bf16 v[128:131],a[120:123],v[52:55],v[128:131]
v_accvgpr_read_b32 v98,a166
v_accvgpr_read_b32 v99,a167
v_mfma_f32_16x16x32_bf16 v[132:135],a[124:127],v[52:55],v[132:135]
v_accvgpr_read_b32 v88,a160
v_accvgpr_read_b32 v89,a161
v_mfma_f32_16x16x32_bf16 a[180:183],a[124:127],v[56:59],a[180:183]
v_accvgpr_read_b32 v90,a162
v_accvgpr_read_b32 v91,a163
v_accvgpr_read_b32 v104,a168
v_accvgpr_read_b32 v105,a169
v_accvgpr_read_b32 v106,a170
v_pk_mul_f32 v[208:209],v[208:209],v[62:63] op_sel_hi:[1,0]
v_pk_mul_f32 v[210:211],v[210:211],v[62:63] op_sel_hi:[1,0]
v_pk_mul_f32 v[224:225],v[224:225],v[62:63] op_sel_hi:[1,0]
v_pk_mul_f32 v[226:227],v[226:227],v[62:63] op_sel_hi:[1,0]
v_pk_mul_f32 v[212:213],v[212:213],v[62:63] op_sel_hi:[1,0]
v_pk_mul_f32 v[214:215],v[214:215],v[62:63] op_sel_hi:[1,0]
v_pk_mul_f32 v[228:229],v[228:229],v[62:63] op_sel_hi:[1,0]
v_pk_mul_f32 v[230:231],v[230:231],v[62:63] op_sel_hi:[1,0]
v_cvt_pk_bf16_f32 v208,v208,v209
v_cvt_pk_bf16_f32 v224,v224,v225
v_mfma_f32_16x16x32_bf16 a[176:179],a[120:123],v[56:59],a[176:179]
v_cvt_pk_bf16_f32 v209,v210,v211
v_cvt_pk_bf16_f32 v225,v226,v227
v_mfma_f32_16x16x32_bf16 a[184:187],a[128:131],v[56:59],a[184:187]
ds_write2st64_b64 v36,v[208:209],v[224:225] offset0:12 offset1:14
v_mfma_f32_16x16x32_bf16 a[188:191],a[132:135],v[56:59],a[188:191]
v_sub_u32 v36,v36,v19
v_accvgpr_read_b32 v107,a171
v_mfma_f32_16x16x32_bf16 v[140:143],a[132:135],v[52:55],v[140:143]
v_accvgpr_read_b32 v100,a180
v_accvgpr_read_b32 v101,a181
v_mfma_f32_16x16x32_bf16 v[136:139],a[128:131],v[52:55],v[136:139]
v_accvgpr_read_b32 v102,a182
v_accvgpr_read_b32 v103,a183
v_mfma_f32_16x16x32_bf16 v[232:235],a[128:131],v[48:51],v[232:235]
v_accvgpr_read_b32 v92,a176
v_accvgpr_read_b32 v93,a177
v_mfma_f32_16x16x32_bf16 v[236:239],a[132:135],v[48:51],v[236:239]
v_accvgpr_read_b32 v94,a178
v_accvgpr_read_b32 v95,a179
v_mfma_f32_16x16x32_bf16 v[188:191],a[132:135],v[44:47],v[188:191]
v_accvgpr_read_b32 v210,a174
v_accvgpr_read_b32 v211,a175
v_mfma_f32_16x16x32_bf16 v[184:187],a[128:131],v[44:47],v[184:187]
v_accvgpr_read_b32 v108,a184
v_accvgpr_read_b32 v109,a185
v_accvgpr_read_b32 v110,a186
v_accvgpr_read_b32 v111,a187
v_accvgpr_read_b32 v208,a172
v_pk_mul_f32 v[216:217],v[216:217],v[62:63] op_sel_hi:[1,0]
v_pk_mul_f32 v[218:219],v[218:219],v[62:63] op_sel_hi:[1,0]
v_pk_mul_f32 v[232:233],v[232:233],v[62:63] op_sel_hi:[1,0]
v_pk_mul_f32 v[234:235],v[234:235],v[62:63] op_sel_hi:[1,0]
v_accvgpr_read_b32 v209,a173
v_accvgpr_read_b32 v224,a188
v_mfma_f32_16x16x32_bf16 v[192:195],a[136:139],v[44:47],v[192:195]
v_accvgpr_read_b32 v225,a189
v_accvgpr_read_b32 v226,a190
v_accvgpr_read_b32 v227,a191
v_add_f32 v64,v64,v65
v_rcp_f32 v64,v64
v_pk_mul_f32 v[220:221],v[220:221],v[62:63] op_sel_hi:[1,0]
v_pk_mul_f32 v[222:223],v[222:223],v[62:63] op_sel_hi:[1,0]
v_pk_mul_f32 v[236:237],v[236:237],v[62:63] op_sel_hi:[1,0]
v_pk_mul_f32 v[238:239],v[238:239],v[62:63] op_sel_hi:[1,0]
v_pk_mul_f32 v[88:89],v[88:89],v[66:67] op_sel_hi:[1,0]
v_pk_mul_f32 v[90:91],v[90:91],v[66:67] op_sel_hi:[1,0]
v_pk_mul_f32 v[92:93],v[92:93],v[66:67] op_sel_hi:[1,0]
v_pk_mul_f32 v[94:95],v[94:95],v[66:67] op_sel_hi:[1,0]
v_pk_mul_f32 v[96:97],v[96:97],v[66:67] op_sel_hi:[1,0]
v_pk_mul_f32 v[98:99],v[98:99],v[66:67] op_sel_hi:[1,0]
v_pk_mul_f32 v[100:101],v[100:101],v[66:67] op_sel_hi:[1,0]
v_pk_mul_f32 v[102:103],v[102:103],v[66:67] op_sel_hi:[1,0]
v_pk_mul_f32 v[104:105],v[104:105],v[66:67] op_sel_hi:[1,0]
v_pk_mul_f32 v[106:107],v[106:107],v[66:67] op_sel_hi:[1,0]
v_pk_mul_f32 v[108:109],v[108:109],v[66:67] op_sel_hi:[1,0]
v_pk_mul_f32 v[110:111],v[110:111],v[66:67] op_sel_hi:[1,0]
v_pk_mul_f32 v[208:209],v[208:209],v[66:67] op_sel_hi:[1,0]
v_pk_mul_f32 v[210:211],v[210:211],v[66:67] op_sel_hi:[1,0]
v_pk_mul_f32 v[224:225],v[224:225],v[66:67] op_sel_hi:[1,0]
v_pk_mul_f32 v[226:227],v[226:227],v[66:67] op_sel_hi:[1,0]
v_cvt_pk_bf16_f32 v212,v212,v213
v_cvt_pk_bf16_f32 v228,v228,v229
s_waitcnt lgkmcnt(0)
v_mfma_f32_16x16x32_bf16 v[196:199],a[140:143],v[44:47],v[196:199]
v_cvt_pk_bf16_f32 v216,v216,v217
v_cvt_pk_bf16_f32 v232,v232,v233
v_mfma_f32_16x16x32_bf16 v[244:247],a[140:143],v[48:51],v[244:247]
v_cvt_pk_bf16_f32 v213,v214,v215
v_cvt_pk_bf16_f32 v229,v230,v231
v_mfma_f32_16x16x32_bf16 v[240:243],a[136:139],v[48:51],v[240:243]
ds_write2st64_b64 v37,v[212:213],v[228:229] offset0:12 offset1:14
v_mfma_f32_16x16x32_bf16 v[144:147],a[136:139],v[52:55],v[144:147]
v_sub_u32 v37,v37,v19
v_cvt_pk_bf16_f32 v220,v220,v221
v_mfma_f32_16x16x32_bf16 v[148:151],a[140:143],v[52:55],v[148:151]
v_cvt_pk_bf16_f32 v236,v236,v237
v_cvt_pk_bf16_f32 v217,v218,v219
v_mfma_f32_16x16x32_bf16 a[196:199],a[140:143],v[56:59],a[196:199]
v_cvt_pk_bf16_f32 v233,v234,v235
ds_write2st64_b64 v38,v[216:217],v[232:233] offset0:12 offset1:14
v_pk_mul_f32 v[240:241],v[240:241],v[62:63] op_sel_hi:[1,0]
v_pk_mul_f32 v[242:243],v[242:243],v[62:63] op_sel_hi:[1,0]
v_pk_mul_f32 v[112:113],v[112:113],v[64:65] op_sel_hi:[1,0]
v_pk_mul_f32 v[114:115],v[114:115],v[64:65] op_sel_hi:[1,0]
v_pk_mul_f32 v[244:245],v[244:245],v[62:63] op_sel_hi:[1,0]
v_pk_mul_f32 v[246:247],v[246:247],v[62:63] op_sel_hi:[1,0]
v_pk_mul_f32 v[116:117],v[116:117],v[64:65] op_sel_hi:[1,0]
v_pk_mul_f32 v[118:119],v[118:119],v[64:65] op_sel_hi:[1,0]
v_sub_u32 v38,v38,v19
v_cvt_pk_bf16_f32 v221,v222,v223
v_mfma_f32_16x16x32_bf16 a[192:195],a[136:139],v[56:59],a[192:195]
v_cvt_pk_bf16_f32 v237,v238,v239
v_cvt_pk_bf16_f32 v88,v88,v89
v_mfma_f32_16x16x32_bf16 a[200:203],a[144:147],v[56:59],a[200:203]
ds_write2st64_b64 v39,v[220:221],v[236:237] offset0:12 offset1:14
v_mfma_f32_16x16x32_bf16 a[204:207],a[148:151],v[56:59],a[204:207]
v_sub_u32 v39,v39,v19
v_cvt_pk_bf16_f32 v92,v92,v93
v_mfma_f32_16x16x32_bf16 v[156:159],a[148:151],v[52:55],v[156:159]
ds_read_b128 v[72:75],v10 offset:6144
v_cvt_pk_bf16_f32 v96,v96,v97
v_mfma_f32_16x16x32_bf16 v[152:155],a[144:147],v[52:55],v[152:155]
ds_read_b128 v[76:79],v10 offset:9216
v_cvt_pk_bf16_f32 v100,v100,v101
v_mfma_f32_16x16x32_bf16 v[248:251],a[144:147],v[48:51],v[248:251]
ds_read_b128 v[80:83],v10 offset:7168
v_cvt_pk_bf16_f32 v89,v90,v91
v_mfma_f32_16x16x32_bf16 v[252:255],a[148:151],v[48:51],v[252:255]
ds_read_b128 v[84:87],v10 offset:10240
v_cvt_pk_bf16_f32 v93,v94,v95
v_mfma_f32_16x16x32_bf16 v[204:207],a[148:151],v[44:47],v[204:207]
ds_write2st64_b64 v36,v[88:89],v[92:93] offset0:36 offset1:40
v_mfma_f32_16x16x32_bf16 v[200:203],a[144:147],v[44:47],v[200:203]
v_add_u32 v36,v36,v19
v_cvt_pk_bf16_f32 v104,v104,v105
v_cvt_pk_bf16_f32 v108,v108,v109
v_cvt_pk_bf16_f32 v97,v98,v99
v_cvt_pk_bf16_f32 v101,v102,v103
s_waitcnt lgkmcnt(4)
buffer_store_dwordx4 v[72:75],v9,s[16:19],s85 offen offset:0 nt
v_pk_mul_f32 v[248:249],v[248:249],v[62:63] op_sel_hi:[1,0]
v_pk_mul_f32 v[120:121],v[120:121],v[64:65] op_sel_hi:[1,0]
v_pk_mul_f32 v[250:251],v[250:251],v[62:63] op_sel_hi:[1,0]
v_pk_mul_f32 v[122:123],v[122:123],v[64:65] op_sel_hi:[1,0]
v_pk_mul_f32 v[252:253],v[252:253],v[62:63] op_sel_hi:[1,0]
v_pk_mul_f32 v[124:125],v[124:125],v[64:65] op_sel_hi:[1,0]
v_pk_mul_f32 v[254:255],v[254:255],v[62:63] op_sel_hi:[1,0]
v_pk_mul_f32 v[126:127],v[126:127],v[64:65] op_sel_hi:[1,0]
v_pk_mul_f32 v[128:129],v[128:129],v[64:65] op_sel_hi:[1,0]
ds_write2st64_b64 v37,v[96:97],v[100:101] offset0:36 offset1:40
v_pk_mul_f32 v[144:145],v[144:145],v[64:65] op_sel_hi:[1,0]
v_pk_mul_f32 v[130:131],v[130:131],v[64:65] op_sel_hi:[1,0]
v_pk_mul_f32 v[146:147],v[146:147],v[64:65] op_sel_hi:[1,0]
s_waitcnt lgkmcnt(1)
buffer_store_dwordx4 v[76:79],v9,s[16:19],s85 offen offset:3072 nt
v_pk_mul_f32 v[132:133],v[132:133],v[64:65] op_sel_hi:[1,0]
v_pk_mul_f32 v[148:149],v[148:149],v[64:65] op_sel_hi:[1,0]
v_pk_mul_f32 v[134:135],v[134:135],v[64:65] op_sel_hi:[1,0]
v_pk_mul_f32 v[150:151],v[150:151],v[64:65] op_sel_hi:[1,0]
v_pk_mul_f32 v[136:137],v[136:137],v[64:65] op_sel_hi:[1,0]
v_pk_mul_f32 v[152:153],v[152:153],v[64:65] op_sel_hi:[1,0]
v_pk_mul_f32 v[138:139],v[138:139],v[64:65] op_sel_hi:[1,0]
v_pk_mul_f32 v[154:155],v[154:155],v[64:65] op_sel_hi:[1,0]
v_pk_mul_f32 v[140:141],v[140:141],v[64:65] op_sel_hi:[1,0]
v_pk_mul_f32 v[156:157],v[156:157],v[64:65] op_sel_hi:[1,0]
v_pk_mul_f32 v[142:143],v[142:143],v[64:65] op_sel_hi:[1,0]
buffer_store_dwordx4 v[80:83],v9,s[16:19],s85 offen offset:128 nt
v_pk_mul_f32 v[158:159],v[158:159],v[64:65] op_sel_hi:[1,0]
v_add_u32 v37,v37,v19
v_cvt_pk_bf16_f32 v208,v208,v209
v_cvt_pk_bf16_f32 v224,v224,v225
v_cvt_pk_bf16_f32 v105,v106,v107
v_cvt_pk_bf16_f32 v109,v110,v111
v_cvt_pk_bf16_f32 v209,v210,v211
v_cvt_pk_bf16_f32 v225,v226,v227
v_cvt_pk_bf16_f32 v240,v240,v241
ds_write2st64_b64 v38,v[104:105],v[108:109] offset0:36 offset1:40
v_add_u32 v38,v38,v19
v_cvt_pk_bf16_f32 v112,v112,v113
v_cvt_pk_bf16_f32 v244,v244,v245
buffer_store_dwordx4 v[84:87],v9,s[16:19],s85 offen offset:3200 nt
v_cvt_pk_bf16_f32 v116,v116,v117
v_cvt_pk_bf16_f32 v241,v242,v243
v_cvt_pk_bf16_f32 v113,v114,v115
v_cvt_pk_bf16_f32 v248,v248,v249
v_cvt_pk_bf16_f32 v120,v120,v121
v_cvt_pk_bf16_f32 v245,v246,v247
v_cvt_pk_bf16_f32 v117,v118,v119
v_cvt_pk_bf16_f32 v252,v252,v253
v_cvt_pk_bf16_f32 v124,v124,v125
ds_write2st64_b64 v39,v[208:209],v[224:225] offset0:36 offset1:40
v_add_u32 v39,v39,v19
v_cvt_pk_bf16_f32 v249,v250,v251
v_cvt_pk_bf16_f32 v121,v122,v123
ds_read_b128 v[212:215],v10 offset:18432
v_cvt_pk_bf16_f32 v253,v254,v255
ds_read_b128 v[228:231],v10 offset:19456
v_cvt_pk_bf16_f32 v125,v126,v127
ds_read_b128 v[216:219],v10 offset:20480
v_accvgpr_read_b32 v72,a192
ds_read_b128 v[232:235],v10 offset:21504
v_accvgpr_read_b32 v73,a193
ds_write2st64_b64 v36,v[240:241],v[112:113] offset0:16 offset1:24
v_pk_mul_f32 v[72:73],v[72:73],v[66:67] op_sel_hi:[1,0]
v_sub_u32 v36,v36,v19
v_accvgpr_read_b32 v74,a194
v_accvgpr_read_b32 v75,a195
v_pk_mul_f32 v[74:75],v[74:75],v[66:67] op_sel_hi:[1,0]
v_accvgpr_read_b32 v76,a196
v_accvgpr_read_b32 v77,a197
s_waitcnt lgkmcnt(4)
buffer_store_dwordx4 v[212:215],v9,s[16:19],s87 offen offset:0 nt
v_pk_mul_f32 v[76:77],v[76:77],v[66:67] op_sel_hi:[1,0]
v_accvgpr_read_b32 v78,a198
v_accvgpr_read_b32 v79,a199
v_pk_mul_f32 v[78:79],v[78:79],v[66:67] op_sel_hi:[1,0]
v_accvgpr_read_b32 v80,a200
v_accvgpr_read_b32 v81,a201
v_pk_mul_f32 v[80:81],v[80:81],v[66:67] op_sel_hi:[1,0]
v_cvt_pk_bf16_f32 v72,v72,v73
v_accvgpr_read_b32 v82,a202
ds_write2st64_b64 v37,v[244:245],v[116:117] offset0:16 offset1:24
v_sub_u32 v37,v37,v19
v_accvgpr_read_b32 v83,a203
v_pk_mul_f32 v[82:83],v[82:83],v[66:67] op_sel_hi:[1,0]
s_waitcnt lgkmcnt(1)
buffer_store_dwordx4 v[228:231],v9,s[16:19],s87 offen offset:3072 nt
v_accvgpr_read_b32 v84,a204
v_accvgpr_read_b32 v85,a205
v_pk_mul_f32 v[84:85],v[84:85],v[66:67] op_sel_hi:[1,0]
v_cvt_pk_bf16_f32 v76,v76,v77
v_cvt_pk_bf16_f32 v73,v74,v75
v_accvgpr_read_b32 v86,a206
v_accvgpr_read_b32 v87,a207
v_pk_mul_f32 v[86:87],v[86:87],v[66:67] op_sel_hi:[1,0]
v_cvt_pk_bf16_f32 v80,v80,v81
ds_write2st64_b64 v38,v[248:249],v[120:121] offset0:16 offset1:24
v_sub_u32 v38,v38,v19
v_cvt_pk_bf16_f32 v77,v78,v79
v_cvt_pk_bf16_f32 v84,v84,v85
buffer_store_dwordx4 v[216:219],v9,s[16:19],s87 offen offset:128 nt
v_cvt_pk_bf16_f32 v81,v82,v83
v_cvt_pk_bf16_f32 v85,v86,v87
v_cvt_pk_bf16_f32 v128,v128,v129
v_cvt_pk_bf16_f32 v144,v144,v145
v_cvt_pk_bf16_f32 v132,v132,v133
v_cvt_pk_bf16_f32 v148,v148,v149
v_cvt_pk_bf16_f32 v129,v130,v131
v_cvt_pk_bf16_f32 v145,v146,v147
v_cvt_pk_bf16_f32 v136,v136,v137
ds_write2st64_b64 v39,v[252:253],v[124:125] offset0:16 offset1:24
v_sub_u32 v39,v39,v19
v_cvt_pk_bf16_f32 v152,v152,v153
v_cvt_pk_bf16_f32 v133,v134,v135
ds_read_b128 v[220:223],v10 offset:8192
buffer_store_dwordx4 v[232:235],v9,s[16:19],s87 offen offset:3200 nt
ds_read_b128 v[236:239],v10 offset:11264
v_cvt_pk_bf16_f32 v149,v150,v151
ds_read_b128 v[88:91],v10 offset:12288
v_add_f32 v60,v60,v61
ds_read_b128 v[92:95],v10 offset:15360
v_cvt_pk_bf16_f32 v140,v140,v141
ds_write_b64 v36,v[72:73] offset:18432
v_add_u32 v36,v36,v19
v_cvt_pk_bf16_f32 v156,v156,v157
v_cvt_pk_bf16_f32 v137,v138,v139
v_cvt_pk_bf16_f32 v153,v154,v155
ds_write_b64 v37,v[76:77] offset:18432
s_waitcnt lgkmcnt(5)
buffer_store_dwordx4 v[220:223],v9,s[16:19],s85 offen offset:256 nt
v_add_u32 v37,v37,v19
v_rcp_f32 v60,v60
v_cvt_pk_bf16_f32 v141,v142,v143
v_pk_mul_f32 v[160:161],v[160:161],v[60:61] op_sel_hi:[1,0]
v_pk_mul_f32 v[176:177],v[176:177],v[60:61] op_sel_hi:[1,0]
v_pk_mul_f32 v[162:163],v[162:163],v[60:61] op_sel_hi:[1,0]
v_pk_mul_f32 v[178:179],v[178:179],v[60:61] op_sel_hi:[1,0]
v_pk_mul_f32 v[164:165],v[164:165],v[60:61] op_sel_hi:[1,0]
ds_write_b64 v38,v[80:81] offset:18432
s_waitcnt lgkmcnt(2)
buffer_store_dwordx4 v[236:239],v9,s[16:19],s85 offen offset:3328 nt
v_pk_mul_f32 v[180:181],v[180:181],v[60:61] op_sel_hi:[1,0]
v_pk_mul_f32 v[166:167],v[166:167],v[60:61] op_sel_hi:[1,0]
v_pk_mul_f32 v[182:183],v[182:183],v[60:61] op_sel_hi:[1,0]
v_pk_mul_f32 v[168:169],v[168:169],v[60:61] op_sel_hi:[1,0]
v_pk_mul_f32 v[184:185],v[184:185],v[60:61] op_sel_hi:[1,0]
v_pk_mul_f32 v[170:171],v[170:171],v[60:61] op_sel_hi:[1,0]
v_pk_mul_f32 v[186:187],v[186:187],v[60:61] op_sel_hi:[1,0]
v_pk_mul_f32 v[172:173],v[172:173],v[60:61] op_sel_hi:[1,0]
v_pk_mul_f32 v[188:189],v[188:189],v[60:61] op_sel_hi:[1,0]
ds_write_b64 v39,v[84:85] offset:18432
ds_read_b128 v[96:99],v10 offset:18432
buffer_store_dwordx4 v[88:91],v9,s[16:19],s86 offen offset:0 nt
ds_read_b128 v[100:103],v10 offset:19456
v_pk_mul_f32 v[174:175],v[174:175],v[60:61] op_sel_hi:[1,0]
v_pk_mul_f32 v[190:191],v[190:191],v[60:61] op_sel_hi:[1,0]
v_pk_mul_f32 v[192:193],v[192:193],v[60:61] op_sel_hi:[1,0]
v_pk_mul_f32 v[194:195],v[194:195],v[60:61] op_sel_hi:[1,0]
v_pk_mul_f32 v[196:197],v[196:197],v[60:61] op_sel_hi:[1,0]
v_pk_mul_f32 v[198:199],v[198:199],v[60:61] op_sel_hi:[1,0]
v_pk_mul_f32 v[200:201],v[200:201],v[60:61] op_sel_hi:[1,0]
ds_write2st64_b64 v36,v[128:129],v[144:145] offset0:26 offset1:28
v_pk_mul_f32 v[202:203],v[202:203],v[60:61] op_sel_hi:[1,0]
v_pk_mul_f32 v[204:205],v[204:205],v[60:61] op_sel_hi:[1,0]
v_pk_mul_f32 v[206:207],v[206:207],v[60:61] op_sel_hi:[1,0]
buffer_store_dwordx4 v[92:95],v9,s[16:19],s86 offen offset:3072 nt
v_add_u32 v38,v38,v19
v_add_u32 v39,v39,v19
v_cvt_pk_bf16_f32 v157,v158,v159
v_cvt_pk_bf16_f32 v160,v160,v161
v_cvt_pk_bf16_f32 v176,v176,v177
v_cvt_pk_bf16_f32 v164,v164,v165
v_cvt_pk_bf16_f32 v180,v180,v181
v_cvt_pk_bf16_f32 v161,v162,v163
v_cvt_pk_bf16_f32 v177,v178,v179
ds_write2st64_b64 v37,v[132:133],v[148:149] offset0:26 offset1:28
v_cvt_pk_bf16_f32 v168,v168,v169
v_cvt_pk_bf16_f32 v184,v184,v185
v_cvt_pk_bf16_f32 v165,v166,v167
s_waitcnt lgkmcnt(1)
buffer_store_dwordx4 v[96:99],v9,s[16:19],s87 offen offset:256 nt
v_cvt_pk_bf16_f32 v181,v182,v183
v_cvt_pk_bf16_f32 v172,v172,v173
v_cvt_pk_bf16_f32 v188,v188,v189
v_cvt_pk_bf16_f32 v169,v170,v171
v_cvt_pk_bf16_f32 v185,v186,v187
v_cvt_pk_bf16_f32 v173,v174,v175
v_cvt_pk_bf16_f32 v189,v190,v191
v_cvt_pk_bf16_f32 v192,v192,v193
v_cvt_pk_bf16_f32 v196,v196,v197
ds_write2st64_b64 v38,v[136:137],v[152:153] offset0:26 offset1:28
v_cvt_pk_bf16_f32 v193,v194,v195
v_cvt_pk_bf16_f32 v200,v200,v201
v_cvt_pk_bf16_f32 v197,v198,v199
buffer_store_dwordx4 v[100:103],v9,s[16:19],s87 offen offset:3328 nt
v_cvt_pk_bf16_f32 v204,v204,v205
v_cvt_pk_bf16_f32 v201,v202,v203
v_cvt_pk_bf16_f32 v205,v206,v207
v_min3_f32 v61,v60,v62,v64
v_min_f32 v61,v61,v66
v_cmp_nlt_f32 vcc,s37,v61
ds_write2st64_b64 v39,v[140:141],v[156:157] offset0:26 offset1:28
ds_read_b128 v[104:107],v10 offset:13312
ds_read_b128 v[108:111],v10 offset:16384
ds_read_b128 v[208:211],v10 offset:14336
s_cmp_lg_u64 vcc,0
ds_read_b128 v[224:227],v10 offset:17408
s_cselect_b32 s62,s32,0
ds_write2st64_b64 v36,v[160:161],v[176:177] offset0:0 offset1:2
s_or_b32 s31,s31,s62
s_lshl_b32 s32,s32,1
s_waitcnt lgkmcnt(4)
buffer_store_dwordx4 v[104:107],v9,s[16:19],s86 offen offset:128 nt
ds_write2st64_b64 v37,v[164:165],v[180:181] offset0:0 offset1:2
s_waitcnt lgkmcnt(1)
buffer_store_dwordx4 v[108:111],v9,s[16:19],s86 offen offset:3200 nt
ds_write2st64_b64 v38,v[168:169],v[184:185] offset0:0 offset1:2
buffer_store_dwordx4 v[208:211],v9,s[16:19],s86 offen offset:256 nt
ds_write2st64_b64 v39,v[172:173],v[188:189] offset0:0 offset1:2
ds_read_b128 v[240:243],v10 offset:0
buffer_store_dwordx4 v[224:227],v9,s[16:19],s86 offen offset:3328 nt
ds_read_b128 v[112:115],v10 offset:3072
ds_read_b128 v[212:215],v10 offset:1024
ds_read_b128 v[228:231],v10 offset:4096
ds_write_b64 v36,v[192:193] offset:2048
ds_write_b64 v37,v[196:197] offset:2048
s_waitcnt lgkmcnt(5)
buffer_store_dwordx4 v[240:243],v9,s[16:19],s84 offen offset:0 nt
ds_write_b64 v38,v[200:201] offset:2048
s_waitcnt lgkmcnt(2)
buffer_store_dwordx4 v[112:115],v9,s[16:19],s84 offen offset:3072 nt
ds_write_b64 v39,v[204:205] offset:2048
ds_read_b128 v[216:219],v10 offset:2048
buffer_store_dwordx4 v[212:215],v9,s[16:19],s84 offen offset:128 nt
ds_read_b128 v[232:235],v10 offset:5120
buffer_store_dwordx4 v[228:231],v9,s[16:19],s84 offen offset:3200 nt
s_waitcnt lgkmcnt(1)
buffer_store_dwordx4 v[216:219],v9,s[16:19],s84 offen offset:256 nt
s_waitcnt lgkmcnt(0)
buffer_store_dwordx4 v[232:235],v9,s[16:19],s84 offen offset:3328 nt
s_branch L_fin
L_fin:
s_waitcnt vmcnt(0)
L_stamped:
s_cmp_lg_u32 s31,0
s_cbranch_scc1 L_fix
L_done:
L_end:
s_endpgm
L_fix:
s_sub_u32 s62,s24,36864
v_add_u32 v112,s62,v2
v_add_u32 v113,s62,v3
v_add_u32 v114,s62,v4
v_add_u32 v115,s62,v5
v_mbcnt_lo_u32_b32 v19,-1,0
v_mbcnt_hi_u32_b32 v19,-1,v19
v_and_b32 v81,15,v19
v_mul_u32_u24 v81,384,v81
v_lshrrev_b32 v82,4,v19
v_lshl_add_u32 v83,v82,3,v81
v_lshl_add_u32 v81,v82,4,v81
L_fix_pass:
s_ff1_i32_b32 s50,s31
s_bitset0_b32 s31,s50
s_lshl_b32 s62,s50,5
s_add_u32 s62,s62,s34
s_mul_i32 s63,s62,171
s_lshr_b32 s63,s63,9
s_mul_i32 s64,s63,3
s_sub_u32 s62,s62,s64
s_add_u32 s63,s63,s33
s_mul_i32 s30,s63,196608
s_mul_i32 s41,s63,325632
s_lshl_b32 s63,s3,2
s_add_u32 s64,s63,21
s_cmp_eq_u32 s3,0
s_cselect_b32 s64,20,s64
s_cselect_b32 s40,1,0
s_add_u32 s65,s63,37
s_cmp_eq_u32 s62,2
s_cselect_b32 s64,s65,s64
s_cselect_b32 s40,0,s40
s_add_u32 s65,s63,s3
s_cmp_eq_u32 s62,0
s_cselect_b32 s64,s65,s64
s_cselect_b32 s40,1,s40
s_mul_i32 s64,s64,6144
s_add_u32 s41,s41,s64
s_add_u32 s55,s40,4
s_mov_b32 s51,0
L_fix_tile:
buffer_load_dwordx4 a[0:3],v81,s[12:15],s41 offen offset:0
buffer_load_dwordx4 a[4:7],v81,s[12:15],s41 offen offset:64
buffer_load_dwordx4 a[8:11],v81,s[12:15],s41 offen offset:128
buffer_load_dwordx4 a[12:15],v81,s[12:15],s41 offen offset:192
buffer_load_dwordx4 a[16:19],v81,s[12:15],s41 offen offset:256
buffer_load_dwordx4 a[20:23],v81,s[12:15],s41 offen offset:320
v_mov_b32 v80,0xff800000
s_mov_b32 s53,s30
s_mov_b32 s52,0
L_fix_max:
s_mov_b32 s63,s53
s_add_u32 m0,s24,0
s_nop 0
buffer_load_dwordx4 v6,s[4:7],s63 offen offset:0 lds
buffer_load_dwordx4 v7,s[4:7],s63 offen offset:1024 lds
buffer_load_dwordx4 v8,s[4:7],s63 offen offset:2048 lds
s_add_u32 s63,s63,3072
s_add_u32 m0,s24,3072
s_nop 0
buffer_load_dwordx4 v6,s[4:7],s63 offen offset:0 lds
buffer_load_dwordx4 v7,s[4:7],s63 offen offset:1024 lds
buffer_load_dwordx4 v8,s[4:7],s63 offen offset:2048 lds
s_add_u32 s63,s63,3072
s_add_u32 m0,s24,6144
s_nop 0
buffer_load_dwordx4 v6,s[4:7],s63 offen offset:0 lds
buffer_load_dwordx4 v7,s[4:7],s63 offen offset:1024 lds
buffer_load_dwordx4 v8,s[4:7],s63 offen offset:2048 lds
s_add_u32 s63,s63,3072
s_add_u32 m0,s24,9216
s_nop 0
buffer_load_dwordx4 v6,s[4:7],s63 offen offset:0 lds
buffer_load_dwordx4 v7,s[4:7],s63 offen offset:1024 lds
buffer_load_dwordx4 v8,s[4:7],s63 offen offset:2048 lds
s_add_u32 s63,s63,3072
s_waitcnt vmcnt(0)
ds_read_b128 a[160:163],v11 offset:0
ds_read_b128 a[164:167],v12 offset:0
ds_read_b128 a[168:171],v11 offset:128
ds_read_b128 a[172:175],v12 offset:128
ds_read_b128 a[176:179],v11 offset:256
ds_read_b128 a[180:183],v12 offset:256
ds_read_b128 a[184:187],v11 offset:6144
ds_read_b128 a[188:191],v12 offset:6144
ds_read_b128 a[192:195],v11 offset:6272
ds_read_b128 a[196:199],v12 offset:6272
ds_read_b128 a[200:203],v11 offset:6400
ds_read_b128 a[204:207],v12 offset:6400
s_waitcnt lgkmcnt(0)
v_mfma_f32_16x16x32_bf16 v[72:75],a[160:163],a[0:3],0
v_mfma_f32_16x16x32_bf16 v[72:75],a[164:167],a[4:7],v[72:75]
v_mfma_f32_16x16x32_bf16 v[72:75],a[168:171],a[8:11],v[72:75]
v_mfma_f32_16x16x32_bf16 v[72:75],a[172:175],a[12:15],v[72:75]
v_mfma_f32_16x16x32_bf16 v[72:75],a[176:179],a[16:19],v[72:75]
v_mfma_f32_16x16x32_bf16 v[72:75],a[180:183],a[20:23],v[72:75]
v_mfma_f32_16x16x32_bf16 v[76:79],a[184:187],a[0:3],0
v_mfma_f32_16x16x32_bf16 v[76:79],a[188:191],a[4:7],v[76:79]
v_mfma_f32_16x16x32_bf16 v[76:79],a[192:195],a[8:11],v[76:79]
v_mfma_f32_16x16x32_bf16 v[76:79],a[196:199],a[12:15],v[76:79]
v_mfma_f32_16x16x32_bf16 v[76:79],a[200:203],a[16:19],v[76:79]
v_mfma_f32_16x16x32_bf16 v[76:79],a[204:207],a[20:23],v[76:79]
s_nop 7
v_max3_f32 v80,v80,v72,v73
v_max3_f32 v80,v80,v74,v75
v_max3_f32 v80,v80,v76,v77
v_max3_f32 v80,v80,v78,v79
s_add_u32 s53,s53,12288
s_add_u32 s52,s52,1
s_cmp_lt_u32 s52,16
s_cbranch_scc1 L_fix_max
v_mov_b32 v19,v80
s_nop 1
v_permlane32_swap_b32 v19,v80
v_max_f32 v80,v80,v19
v_mov_b32 v19,v80
s_nop 1
v_permlane16_swap_b32 v19,v80
v_max_f32 v80,v80,v19
v_mul_f32_e64 v13,-s36,v80
v_mov_b32 v160,0
v_mov_b32 v161,0
v_mov_b32 v162,0
v_mov_b32 v163,0
v_mov_b32 v164,0
v_mov_b32 v165,0
v_mov_b32 v166,0
v_mov_b32 v167,0
v_mov_b32 v168,0
v_mov_b32 v169,0
v_mov_b32 v170,0
v_mov_b32 v171,0
v_mov_b32 v172,0
v_mov_b32 v173,0
v_mov_b32 v174,0
v_mov_b32 v175,0
v_mov_b32 v176,0
v_mov_b32 v177,0
v_mov_b32 v178,0
v_mov_b32 v179,0
v_mov_b32 v180,0
v_mov_b32 v181,0
v_mov_b32 v182,0
v_mov_b32 v183,0
v_mov_b32 v184,0
v_mov_b32 v185,0
v_mov_b32 v186,0
v_mov_b32 v187,0
v_mov_b32 v188,0
v_mov_b32 v189,0
v_mov_b32 v190,0
v_mov_b32 v191,0
v_mov_b32 v192,0
v_mov_b32 v193,0
v_mov_b32 v194,0
v_mov_b32 v195,0
v_mov_b32 v196,0
v_mov_b32 v197,0
v_mov_b32 v198,0
v_mov_b32 v199,0
v_mov_b32 v200,0
v_mov_b32 v201,0
v_mov_b32 v202,0
v_mov_b32 v203,0
v_mov_b32 v204,0
v_mov_b32 v205,0
v_mov_b32 v206,0
v_mov_b32 v207,0
v_mov_b32 v60,0
v_mov_b32 v24,0
v_mov_b32 v61,0
v_mov_b32 v25,0
v_mov_b32 v62,0
v_mov_b32 v26,0
v_mov_b32 v63,0
v_mov_b32 v27,0
s_mov_b32 s53,s30
s_mov_b32 s52,0
L_fix_acc:
s_mov_b32 s63,s53
s_add_u32 m0,s24,0
s_nop 0
buffer_load_dwordx4 v6,s[4:7],s63 offen offset:0 lds
buffer_load_dwordx4 v7,s[4:7],s63 offen offset:1024 lds
buffer_load_dwordx4 v8,s[4:7],s63 offen offset:2048 lds
s_add_u32 s63,s63,3072
s_add_u32 m0,s24,3072
s_nop 0
buffer_load_dwordx4 v6,s[4:7],s63 offen offset:0 lds
buffer_load_dwordx4 v7,s[4:7],s63 offen offset:1024 lds
buffer_load_dwordx4 v8,s[4:7],s63 offen offset:2048 lds
s_add_u32 s63,s63,3072
s_add_u32 m0,s24,6144
s_nop 0
buffer_load_dwordx4 v6,s[4:7],s63 offen offset:0 lds
buffer_load_dwordx4 v7,s[4:7],s63 offen offset:1024 lds
buffer_load_dwordx4 v8,s[4:7],s63 offen offset:2048 lds
s_add_u32 s63,s63,3072
s_add_u32 m0,s24,9216
s_nop 0
buffer_load_dwordx4 v6,s[4:7],s63 offen offset:0 lds
buffer_load_dwordx4 v7,s[4:7],s63 offen offset:1024 lds
buffer_load_dwordx4 v8,s[4:7],s63 offen offset:2048 lds
s_add_u32 s63,s63,3072
s_waitcnt vmcnt(0)
ds_read_b128 a[160:163],v11 offset:0
ds_read_b128 a[164:167],v12 offset:0
ds_read_b128 a[168:171],v11 offset:128
ds_read_b128 a[172:175],v12 offset:128
ds_read_b128 a[176:179],v11 offset:256
ds_read_b128 a[180:183],v12 offset:256
ds_read_b128 a[184:187],v11 offset:6144
ds_read_b128 a[188:191],v12 offset:6144
ds_read_b128 a[192:195],v11 offset:6272
ds_read_b128 a[196:199],v12 offset:6272
ds_read_b128 a[200:203],v11 offset:6400
ds_read_b128 a[204:207],v12 offset:6400
s_waitcnt lgkmcnt(0)
v_mfma_f32_16x16x32_bf16 v[72:75],a[160:163],a[0:3],0
v_mfma_f32_16x16x32_bf16 v[72:75],a[164:167],a[4:7],v[72:75]
v_mfma_f32_16x16x32_bf16 v[72:75],a[168:171],a[8:11],v[72:75]
v_mfma_f32_16x16x32_bf16 v[72:75],a[172:175],a[12:15],v[72:75]
v_mfma_f32_16x16x32_bf16 v[72:75],a[176:179],a[16:19],v[72:75]
v_mfma_f32_16x16x32_bf16 v[72:75],a[180:183],a[20:23],v[72:75]
v_mfma_f32_16x16x32_bf16 v[76:79],a[184:187],a[0:3],0
v_mfma_f32_16x16x32_bf16 v[76:79],a[188:191],a[4:7],v[76:79]
v_mfma_f32_16x16x32_bf16 v[76:79],a[192:195],a[8:11],v[76:79]
v_mfma_f32_16x16x32_bf16 v[76:79],a[196:199],a[12:15],v[76:79]
v_mfma_f32_16x16x32_bf16 v[76:79],a[200:203],a[16:19],v[76:79]
v_mfma_f32_16x16x32_bf16 v[76:79],a[204:207],a[20:23],v[76:79]
s_nop 7
v_fma_f32 v72,v72,s36,v13
v_fma_f32 v73,v73,s36,v13
v_exp_f32 v72,v72
v_exp_f32 v73,v73
s_nop 0
v_cvt_pk_bf16_f32 v20,v72,v73
v_fma_f32 v74,v74,s36,v13
v_fma_f32 v75,v75,s36,v13
v_exp_f32 v74,v74
v_exp_f32 v75,v75
s_nop 0
v_cvt_pk_bf16_f32 v21,v74,v75
v_fma_f32 v76,v76,s36,v13
v_fma_f32 v77,v77,s36,v13
v_exp_f32 v76,v76
v_exp_f32 v77,v77
s_nop 0
v_cvt_pk_bf16_f32 v22,v76,v77
v_fma_f32 v78,v78,s36,v13
v_fma_f32 v79,v79,s36,v13
v_exp_f32 v78,v78
v_exp_f32 v79,v79
s_nop 0
v_cvt_pk_bf16_f32 v23,v78,v79
s_nop 1
v_smfmac_f32_16x16x64_bf16 v[60:63],a[152:155],v[20:27],v18
s_mov_b32 s63,s53
s_add_u32 m0,s24,0
s_nop 0
buffer_load_dwordx4 v6,s[8:11],s63 offen offset:0 lds
buffer_load_dwordx4 v7,s[8:11],s63 offen offset:1024 lds
buffer_load_dwordx4 v8,s[8:11],s63 offen offset:2048 lds
s_add_u32 s63,s63,3072
s_add_u32 m0,s24,3072
s_nop 0
buffer_load_dwordx4 v6,s[8:11],s63 offen offset:0 lds
buffer_load_dwordx4 v7,s[8:11],s63 offen offset:1024 lds
buffer_load_dwordx4 v8,s[8:11],s63 offen offset:2048 lds
s_add_u32 s63,s63,3072
s_add_u32 m0,s24,6144
s_nop 0
buffer_load_dwordx4 v6,s[8:11],s63 offen offset:0 lds
buffer_load_dwordx4 v7,s[8:11],s63 offen offset:1024 lds
buffer_load_dwordx4 v8,s[8:11],s63 offen offset:2048 lds
s_add_u32 s63,s63,3072
s_add_u32 m0,s24,9216
s_nop 0
buffer_load_dwordx4 v6,s[8:11],s63 offen offset:0 lds
buffer_load_dwordx4 v7,s[8:11],s63 offen offset:1024 lds
buffer_load_dwordx4 v8,s[8:11],s63 offen offset:2048 lds
s_add_u32 s63,s63,3072
s_waitcnt vmcnt(0)
ds_read_b64_tr_b16 a[160:161],v112 offset:0
ds_read_b64_tr_b16 a[162:163],v112 offset:6144
ds_read_b64_tr_b16 a[164:165],v113 offset:0
ds_read_b64_tr_b16 a[166:167],v113 offset:6144
ds_read_b64_tr_b16 a[168:169],v114 offset:0
ds_read_b64_tr_b16 a[170:171],v114 offset:6144
ds_read_b64_tr_b16 a[172:173],v115 offset:0
ds_read_b64_tr_b16 a[174:175],v115 offset:6144
ds_read_b64_tr_b16 a[176:177],v112 offset:128
ds_read_b64_tr_b16 a[178:179],v112 offset:6272
ds_read_b64_tr_b16 a[180:181],v113 offset:128
ds_read_b64_tr_b16 a[182:183],v113 offset:6272
ds_read_b64_tr_b16 a[184:185],v114 offset:128
ds_read_b64_tr_b16 a[186:187],v114 offset:6272
ds_read_b64_tr_b16 a[188:189],v115 offset:128
ds_read_b64_tr_b16 a[190:191],v115 offset:6272
ds_read_b64_tr_b16 a[192:193],v112 offset:256
ds_read_b64_tr_b16 a[194:195],v112 offset:6400
ds_read_b64_tr_b16 a[196:197],v113 offset:256
ds_read_b64_tr_b16 a[198:199],v113 offset:6400
ds_read_b64_tr_b16 a[200:201],v114 offset:256
ds_read_b64_tr_b16 a[202:203],v114 offset:6400
ds_read_b64_tr_b16 a[204:205],v115 offset:256
ds_read_b64_tr_b16 a[206:207],v115 offset:6400
s_waitcnt lgkmcnt(0)
v_mfma_f32_16x16x32_bf16 v[160:163],a[160:163],v[20:23],v[160:163]
v_mfma_f32_16x16x32_bf16 v[164:167],a[164:167],v[20:23],v[164:167]
v_mfma_f32_16x16x32_bf16 v[168:171],a[168:171],v[20:23],v[168:171]
v_mfma_f32_16x16x32_bf16 v[172:175],a[172:175],v[20:23],v[172:175]
v_mfma_f32_16x16x32_bf16 v[176:179],a[176:179],v[20:23],v[176:179]
v_mfma_f32_16x16x32_bf16 v[180:183],a[180:183],v[20:23],v[180:183]
v_mfma_f32_16x16x32_bf16 v[184:187],a[184:187],v[20:23],v[184:187]
v_mfma_f32_16x16x32_bf16 v[188:191],a[188:191],v[20:23],v[188:191]
v_mfma_f32_16x16x32_bf16 v[192:195],a[192:195],v[20:23],v[192:195]
v_mfma_f32_16x16x32_bf16 v[196:199],a[196:199],v[20:23],v[196:199]
v_mfma_f32_16x16x32_bf16 v[200:203],a[200:203],v[20:23],v[200:203]
v_mfma_f32_16x16x32_bf16 v[204:207],a[204:207],v[20:23],v[204:207]
s_add_u32 s53,s53,12288
s_add_u32 s52,s52,1
s_cmp_lt_u32 s52,16
s_cbranch_scc1 L_fix_acc
s_nop 7
v_add_f32 v19,v60,v61
v_rcp_f32 v19,v19
s_nop 0
v_mul_f32 v160,v160,v19
v_mul_f32 v161,v161,v19
v_mul_f32 v162,v162,v19
v_mul_f32 v163,v163,v19
v_cvt_pk_bf16_f32 v160,v160,v161
v_cvt_pk_bf16_f32 v161,v162,v163
buffer_store_dwordx2 v[160:161],v83,s[16:19],s41 offen offset:0
v_mul_f32 v164,v164,v19
v_mul_f32 v165,v165,v19
v_mul_f32 v166,v166,v19
v_mul_f32 v167,v167,v19
v_cvt_pk_bf16_f32 v164,v164,v165
v_cvt_pk_bf16_f32 v165,v166,v167
buffer_store_dwordx2 v[164:165],v83,s[16:19],s41 offen offset:32
v_mul_f32 v168,v168,v19
v_mul_f32 v169,v169,v19
v_mul_f32 v170,v170,v19
v_mul_f32 v171,v171,v19
v_cvt_pk_bf16_f32 v168,v168,v169
v_cvt_pk_bf16_f32 v169,v170,v171
buffer_store_dwordx2 v[168:169],v83,s[16:19],s41 offen offset:64
v_mul_f32 v172,v172,v19
v_mul_f32 v173,v173,v19
v_mul_f32 v174,v174,v19
v_mul_f32 v175,v175,v19
v_cvt_pk_bf16_f32 v172,v172,v173
v_cvt_pk_bf16_f32 v173,v174,v175
buffer_store_dwordx2 v[172:173],v83,s[16:19],s41 offen offset:96
v_mul_f32 v176,v176,v19
v_mul_f32 v177,v177,v19
v_mul_f32 v178,v178,v19
v_mul_f32 v179,v179,v19
v_cvt_pk_bf16_f32 v176,v176,v177
v_cvt_pk_bf16_f32 v177,v178,v179
buffer_store_dwordx2 v[176:177],v83,s[16:19],s41 offen offset:128
v_mul_f32 v180,v180,v19
v_mul_f32 v181,v181,v19
v_mul_f32 v182,v182,v19
v_mul_f32 v183,v183,v19
v_cvt_pk_bf16_f32 v180,v180,v181
v_cvt_pk_bf16_f32 v181,v182,v183
buffer_store_dwordx2 v[180:181],v83,s[16:19],s41 offen offset:160
v_mul_f32 v184,v184,v19
v_mul_f32 v185,v185,v19
v_mul_f32 v186,v186,v19
v_mul_f32 v187,v187,v19
v_cvt_pk_bf16_f32 v184,v184,v185
v_cvt_pk_bf16_f32 v185,v186,v187
buffer_store_dwordx2 v[184:185],v83,s[16:19],s41 offen offset:192
v_mul_f32 v188,v188,v19
v_mul_f32 v189,v189,v19
v_mul_f32 v190,v190,v19
v_mul_f32 v191,v191,v19
v_cvt_pk_bf16_f32 v188,v188,v189
v_cvt_pk_bf16_f32 v189,v190,v191
buffer_store_dwordx2 v[188:189],v83,s[16:19],s41 offen offset:224
v_mul_f32 v192,v192,v19
v_mul_f32 v193,v193,v19
v_mul_f32 v194,v194,v19
v_mul_f32 v195,v195,v19
v_cvt_pk_bf16_f32 v192,v192,v193
v_cvt_pk_bf16_f32 v193,v194,v195
buffer_store_dwordx2 v[192:193],v83,s[16:19],s41 offen offset:256
v_mul_f32 v196,v196,v19
v_mul_f32 v197,v197,v19
v_mul_f32 v198,v198,v19
v_mul_f32 v199,v199,v19
v_cvt_pk_bf16_f32 v196,v196,v197
v_cvt_pk_bf16_f32 v197,v198,v199
buffer_store_dwordx2 v[196:197],v83,s[16:19],s41 offen offset:288
v_mul_f32 v200,v200,v19
v_mul_f32 v201,v201,v19
v_mul_f32 v202,v202,v19
v_mul_f32 v203,v203,v19
v_cvt_pk_bf16_f32 v200,v200,v201
v_cvt_pk_bf16_f32 v201,v202,v203
buffer_store_dwordx2 v[200:201],v83,s[16:19],s41 offen offset:320
v_mul_f32 v204,v204,v19
v_mul_f32 v205,v205,v19
v_mul_f32 v206,v206,v19
v_mul_f32 v207,v207,v19
v_cvt_pk_bf16_f32 v204,v204,v205
v_cvt_pk_bf16_f32 v205,v206,v207
buffer_store_dwordx2 v[204:205],v83,s[16:19],s41 offen offset:352
s_waitcnt vmcnt(0)
s_add_u32 s41,s41,6144
s_add_u32 s51,s51,1
s_cmp_lt_u32 s51,s55
s_cbranch_scc1 L_fix_tile
s_cmp_lg_u32 s31,0
s_cbranch_scc1 L_fix_pass
s_branch L_done
L_codeend:
.section .rodata,"a"
.p2align 6
.amdhsa_kernel standalone__gqa_softmax__near_ridge_kernel
  .amdhsa_next_free_vgpr 512
  .amdhsa_next_free_sgpr 102
  .amdhsa_accum_offset 256
  .amdhsa_group_segment_fixed_size 0
  .amdhsa_kernarg_size 48
  .amdhsa_user_sgpr_count 2
  .amdhsa_user_sgpr_kernarg_segment_ptr 1
  .amdhsa_system_sgpr_workgroup_id_x 1
.end_amdhsa_kernel
```

```asm
; @launch grid=(256,1,1) block=(256,1,1) lds=163840
.amdgcn_target "amdgcn-amd-amdhsa--gfx950"
.text
.globl standalone__gqa_softmax__near_ridge_kernel
.p2align 8
.type standalone__gqa_softmax__near_ridge_kernel,@function
standalone__gqa_softmax__near_ridge_kernel:
s_cmp_ge_u32 s2,256
s_cbranch_scc1 L_end
s_load_dwordx4 s[84:87],s[0:1],0
s_load_dwordx4 s[88:91],s[0:1],16
v_lshrrev_b32 v80,6,v0
v_and_b32 v19,63,v0
v_readfirstlane_b32 s3,v80
s_lshr_b32 s34,s2,3
v_lshrrev_b32 v80,3,v19
v_and_b32 v82,7,v19
v_add_u32 v81,0,v80
v_mul_u32_u24 v81,43,v81
v_lshrrev_b32 v81,7,v81
v_and_b32 v81,6,v81
v_xor_b32 v81,v81,v82
v_lshlrev_b32 v81,4,v81
v_lshl_add_u32 v6,v80,7,v81
v_add_u32 v81,8,v80
v_mul_u32_u24 v81,43,v81
v_lshrrev_b32 v81,7,v81
v_and_b32 v81,6,v81
v_xor_b32 v81,v81,v82
v_lshlrev_b32 v81,4,v81
v_lshl_add_u32 v7,v80,7,v81
v_add_u32 v81,16,v80
v_mul_u32_u24 v81,43,v81
v_lshrrev_b32 v81,7,v81
v_and_b32 v81,6,v81
v_xor_b32 v81,v81,v82
v_lshlrev_b32 v81,4,v81
v_lshl_add_u32 v8,v80,7,v81
s_mov_b32 s37,0x21800000
s_mov_b32 s36,0x3dd53b95
s_mov_b32 s31,0
s_mov_b32 s32,1
s_and_b32 s62,s2,7
s_lshl_b32 s33,s62,6
s_mul_i32 s22,s3,3072
s_add_u32 s23,s22,36864
s_mul_i32 s24,s3,22528
s_add_u32 s24,s24,73728
s_mov_b32 s69,0
s_lshl_b32 s62,s69,5
s_add_u32 s62,s62,s34
s_mul_i32 s63,s62,171
s_lshr_b32 s63,s63,9
s_mul_i32 s64,s63,3
s_sub_u32 s62,s62,s64
s_add_u32 s63,s63,s33
s_mul_i32 s30,s63,196608
s_mul_i32 s41,s63,325632
s_lshl_b32 s63,s3,2
s_add_u32 s64,s63,21
s_cmp_eq_u32 s3,0
s_cselect_b32 s64,20,s64
s_cselect_b32 s40,1,0
s_add_u32 s65,s63,37
s_cmp_eq_u32 s62,2
s_cselect_b32 s64,s65,s64
s_cselect_b32 s40,0,s40
s_add_u32 s65,s63,s3
s_cmp_eq_u32 s62,0
s_cselect_b32 s64,s65,s64
s_cselect_b32 s40,1,s40
s_mul_i32 s64,s64,6144
s_add_u32 s41,s41,s64
s_add_u32 s20,s30,s22
s_mov_b32 s21,s20
s_waitcnt lgkmcnt(0)
s_mov_b32 s4,s86
s_and_b32 s5,s87,0xffff
s_mov_b32 s6,100663296
s_mov_b32 s7,0x20000
s_mov_b32 s12,s84
s_and_b32 s13,s85,0xffff
s_mov_b32 s14,166723584
s_mov_b32 s15,0x20000
s_mov_b32 s8,s88
s_and_b32 s9,s89,0xffff
s_mov_b32 s10,100663296
s_mov_b32 s11,0x20000
s_mov_b32 s16,s90
s_and_b32 s17,s91,0xffff
s_mov_b32 s18,166723584
s_mov_b32 s19,0x20000
s_mov_b32 s28,s41
s_add_u32 m0,s22,0
s_nop 0
buffer_load_dwordx4 v6,s[4:7],s20 offen offset:0 lds
buffer_load_dwordx4 v7,s[4:7],s20 offen offset:1024 lds
buffer_load_dwordx4 v8,s[4:7],s20 offen offset:2048 lds
s_add_u32 s20,s20,12288
s_add_u32 m0,s24,0
s_nop 0
buffer_load_dwordx4 v6,s[12:15],s28 offen offset:0 nt lds
buffer_load_dwordx4 v7,s[12:15],s28 offen offset:1024 nt lds
buffer_load_dwordx4 v8,s[12:15],s28 offen offset:2048 nt lds
s_add_u32 s28,s28,3072
s_add_u32 m0,s24,3072
s_nop 0
buffer_load_dwordx4 v6,s[12:15],s28 offen offset:0 nt lds
buffer_load_dwordx4 v7,s[12:15],s28 offen offset:1024 nt lds
buffer_load_dwordx4 v8,s[12:15],s28 offen offset:2048 nt lds
s_add_u32 s28,s28,3072
s_add_u32 m0,s22,12288
s_nop 0
buffer_load_dwordx4 v6,s[4:7],s20 offen offset:0 lds
buffer_load_dwordx4 v7,s[4:7],s20 offen offset:1024 lds
buffer_load_dwordx4 v8,s[4:7],s20 offen offset:2048 lds
s_add_u32 s20,s20,12288
s_add_u32 m0,s22,24576
s_nop 0
buffer_load_dwordx4 v6,s[4:7],s20 offen offset:0 lds
buffer_load_dwordx4 v7,s[4:7],s20 offen offset:1024 lds
buffer_load_dwordx4 v8,s[4:7],s20 offen offset:2048 lds
s_add_u32 s20,s20,12288
s_add_u32 m0,s23,0
s_nop 0
buffer_load_dwordx4 v6,s[8:11],s21 offen offset:0 lds
buffer_load_dwordx4 v7,s[8:11],s21 offen offset:1024 lds
buffer_load_dwordx4 v8,s[8:11],s21 offen offset:2048 lds
s_add_u32 s21,s21,12288
s_add_u32 m0,s24,6144
s_nop 0
buffer_load_dwordx4 v6,s[12:15],s28 offen offset:0 nt lds
buffer_load_dwordx4 v7,s[12:15],s28 offen offset:1024 nt lds
buffer_load_dwordx4 v8,s[12:15],s28 offen offset:2048 nt lds
s_add_u32 s28,s28,3072
s_add_u32 m0,s24,9216
s_nop 0
buffer_load_dwordx4 v6,s[12:15],s28 offen offset:0 nt lds
buffer_load_dwordx4 v7,s[12:15],s28 offen offset:1024 nt lds
buffer_load_dwordx4 v8,s[12:15],s28 offen offset:2048 nt lds
s_add_u32 s28,s28,3072
s_getpc_b64 s[46:47]
s_mul_i32 s62,s34,4096
s_mul_i32 s48,s3,1024
s_add_u32 s48,s48,s62
v_min_u32 v85,31,v19
v_lshlrev_b32 v85,7,v85
v_add_u32 v85,s62,v85
v_min_u32 v85,L_codeend-L_first-4,v85
s_cmp_lg_u32 s3,0
s_cbranch_scc1 L_nopre
global_load_dword v112,v85,s[46:47]
L_nopre:
v_and_b32 v80,15,v19
v_lshrrev_b32 v81,4,v19
v_mul_u32_u24 v0,384,v80
v_and_b32 v83,6,v80
v_xor_b32 v83,v83,v81
v_lshl_add_u32 v0,v83,4,v0
v_xor_b32 v1,64,v0
v_add_u32 v11,s24,v0
v_add_u32 v12,s24,v1
v_lshrrev_b32 v80,2,v19
v_mul_u32_u24 v2,384,v80
v_and_b32 v80,6,v80
v_bfe_u32 v83,v19,1,1
v_xor_b32 v80,v80,v83
v_lshl_add_u32 v2,v80,4,v2
v_and_b32 v83,1,v19
v_lshl_add_u32 v2,v83,3,v2
v_add_u32 v2,36864,v2
v_xor_b32 v3,32,v2
v_xor_b32 v4,64,v2
v_xor_b32 v5,96,v2
v_lshrrev_b32 v80,3,v19
v_and_b32 v81,7,v19
v_xor_b32 v83,v81,v80
v_lshl_add_u32 v10,v80,7,s24
v_lshl_add_u32 v10,v83,4,v10
v_mul_u32_u24 v9,384,v80
v_lshl_add_u32 v9,v81,4,v9
v_lshrrev_b32 v80,4,v19
v_xor_b32 v80,v80,v19
v_bfe_u32 v80,v80,1,1
v_subrev_u32 v80,1,v80
v_and_b32 v80,0x3f803f80,v80
v_accvgpr_write_b32 a152,v80
v_accvgpr_write_b32 a153,v80
v_accvgpr_write_b32 a154,v80
v_accvgpr_write_b32 a155,v80
v_and_b32 v80,1,v19
v_mul_u32_u24 v80,0xaaaa,v80
v_add_u32 v18,0x4444,v80
L_first:
s_waitcnt vmcnt(12)
s_barrier
s_cmp_eq_u32 s40,0
s_cbranch_scc1 L_start4
L_start5:
s_add_u32 m0,s24,12288
s_waitcnt vmcnt(15)
ds_read_b128 a[0:3],v11 offset:0
buffer_load_dwordx4 v6,s[12:15],s28 offen offset:0 nt lds
ds_read_b128 a[4:7],v12 offset:0
buffer_load_dwordx4 v7,s[12:15],s28 offen offset:1024 nt lds
ds_read_b128 a[8:11],v11 offset:128
buffer_load_dwordx4 v8,s[12:15],s28 offen offset:2048 nt lds
s_add_u32 s28,s28,3072
s_add_u32 m0,s24,15360
ds_read_b128 a[12:15],v12 offset:128
buffer_load_dwordx4 v6,s[12:15],s28 offen offset:0 nt lds
ds_read_b128 a[16:19],v11 offset:256
buffer_load_dwordx4 v7,s[12:15],s28 offen offset:1024 nt lds
ds_read_b128 a[20:23],v12 offset:256
buffer_load_dwordx4 v8,s[12:15],s28 offen offset:2048 nt lds
s_add_u32 s28,s28,3072
s_add_u32 m0,s24,0
ds_read_b128 a[120:123],v0 offset:0
v_pk_mov_b32 v[62:63],0,0
v_pk_mov_b32 v[66:67],0,0
v_pk_mov_b32 v[60:61],0,0
v_pk_mov_b32 v[64:65],0,0
ds_read_b128 a[124:127],v1 offset:0
v_pk_mov_b32 v[70:71],0,0
ds_read_b128 a[128:131],v0 offset:128
v_pk_mov_b32 v[68:69],0,0
ds_read_b128 a[132:135],v1 offset:128
ds_read_b128 a[136:139],v0 offset:256
ds_read_b128 a[140:143],v1 offset:256
ds_read_b128 a[144:147],v0 offset:6144
s_waitcnt lgkmcnt(6)
v_mfma_f32_16x16x32_bf16 v[72:75],a[120:123],a[0:3],0
s_waitcnt lgkmcnt(5)
ds_read_b128 a[148:151],v1 offset:6144
ds_read_b128 a[120:123],v0 offset:6272
v_mfma_f32_16x16x32_bf16 v[72:75],a[124:127],a[4:7],v[72:75]
s_waitcnt lgkmcnt(6)
ds_read_b128 a[124:127],v1 offset:6272
v_mfma_f32_16x16x32_bf16 v[72:75],a[128:131],a[8:11],v[72:75]
s_waitcnt lgkmcnt(6)
ds_read_b128 a[128:131],v0 offset:6400
v_mfma_f32_16x16x32_bf16 v[72:75],a[132:135],a[12:15],v[72:75]
s_waitcnt lgkmcnt(6)
ds_read_b128 a[132:135],v1 offset:6400
v_mfma_f32_16x16x32_bf16 v[72:75],a[136:139],a[16:19],v[72:75]
s_waitcnt lgkmcnt(6)
ds_read_b128 a[136:139],v0 offset:12288
v_mfma_f32_16x16x32_bf16 v[72:75],a[140:143],a[20:23],v[72:75]
s_waitcnt lgkmcnt(6)
ds_read_b128 a[140:143],v1 offset:12288
v_mfma_f32_16x16x32_bf16 v[76:79],a[144:147],a[0:3],0
s_waitcnt lgkmcnt(6)
ds_read_b128 a[144:147],v0 offset:12416
v_mfma_f32_16x16x32_bf16 v[76:79],a[148:151],a[4:7],v[76:79]
s_waitcnt lgkmcnt(6)
ds_read_b128 a[148:151],v1 offset:12416
v_mfma_f32_16x16x32_bf16 v[76:79],a[120:123],a[8:11],v[76:79]
s_waitcnt lgkmcnt(6)
ds_read_b128 a[120:123],v0 offset:12544
v_mfma_f32_16x16x32_bf16 v[76:79],a[124:127],a[12:15],v[76:79]
s_waitcnt lgkmcnt(6)
ds_read_b128 a[124:127],v1 offset:12544
v_max3_f32 v44,v72,v73,v74
v_mfma_f32_16x16x32_bf16 v[76:79],a[128:131],a[16:19],v[76:79]
s_waitcnt lgkmcnt(6)
ds_read_b128 a[128:131],v0 offset:18432
v_max_f32 v44,v44,v75
v_mfma_f32_16x16x32_bf16 v[76:79],a[132:135],a[20:23],v[76:79]
ds_read_b128 a[132:135],v1 offset:18432
v_mov_b32 v45,v44
s_nop 1
v_permlane32_swap_b32 v45,v44
v_max_f32 v44,v44,v45
v_mov_b32 v45,v44
s_nop 1
v_permlane16_swap_b32 v45,v44
v_max_f32 v44,v44,v45
v_mul_f32_e64 v13,-s36,v44
v_fma_f32 v74,v74,s36,v13
v_fma_f32 v72,v72,s36,v13
v_exp_f32 v72,v72
v_fma_f32 v75,v75,s36,v13
v_exp_f32 v75,v75
v_fma_f32 v73,v73,s36,v13
v_exp_f32 v73,v73
v_exp_f32 v74,v74
v_cvt_pk_bf16_f32 v20,v72,v73
v_cvt_pk_bf16_f32 v21,v74,v75
s_waitcnt lgkmcnt(1)
v_mfma_f32_16x16x32_bf16 v[72:75],a[136:139],a[0:3],0
ds_read_b128 a[136:139],v0 offset:18560
v_fma_f32 v77,v77,s36,v13
v_mfma_f32_16x16x32_bf16 v[72:75],a[140:143],a[4:7],v[72:75]
ds_read_b128 a[140:143],v1 offset:18560
v_exp_f32 v77,v77
v_mfma_f32_16x16x32_bf16 v[72:75],a[144:147],a[8:11],v[72:75]
ds_read_b128 a[144:147],v0 offset:18688
v_fma_f32 v76,v76,s36,v13
v_mfma_f32_16x16x32_bf16 v[72:75],a[148:151],a[12:15],v[72:75]
ds_read_b128 a[148:151],v1 offset:18688
v_fma_f32 v78,v78,s36,v13
v_mfma_f32_16x16x32_bf16 v[72:75],a[120:123],a[16:19],v[72:75]
v_exp_f32 v78,v78
v_mfma_f32_16x16x32_bf16 v[72:75],a[124:127],a[20:23],v[72:75]
v_exp_f32 v76,v76
v_fma_f32 v79,v79,s36,v13
v_exp_f32 v79,v79
v_cvt_pk_bf16_f32 v22,v76,v77
v_cvt_pk_bf16_f32 v23,v78,v79
v_mfma_f32_16x16x32_bf16 v[76:79],a[128:131],a[0:3],0
s_waitcnt lgkmcnt(3)
v_mfma_f32_16x16x32_bf16 v[76:79],a[132:135],a[4:7],v[76:79]
v_mfma_f32_16x16x32_bf16 v[76:79],a[136:139],a[8:11],v[76:79]
s_waitcnt lgkmcnt(1)
v_fma_f32 v72,v72,s36,v13
v_fma_f32 v73,v73,s36,v13
v_mfma_f32_16x16x32_bf16 v[76:79],a[140:143],a[12:15],v[76:79]
v_fma_f32 v74,v74,s36,v13
v_exp_f32 v74,v74
v_mfma_f32_16x16x32_bf16 v[76:79],a[144:147],a[16:19],v[76:79]
s_waitcnt lgkmcnt(0)
v_exp_f32 v72,v72
v_mfma_f32_16x16x32_bf16 v[76:79],a[148:151],a[20:23],v[76:79]
s_waitcnt vmcnt(12)
s_barrier
ds_read_b64_tr_b16 a[122:123],v2 offset:6144
v_fma_f32 v75,v75,s36,v13
v_exp_f32 v75,v75
ds_read_b64_tr_b16 a[120:121],v2 offset:0
ds_read_b64_tr_b16 a[126:127],v3 offset:6144
ds_read_b64_tr_b16 a[124:125],v3 offset:0
ds_read_b64_tr_b16 a[130:131],v4 offset:6144
ds_read_b64_tr_b16 a[128:129],v4 offset:0
ds_read_b64_tr_b16 a[134:135],v5 offset:6144
ds_read_b64_tr_b16 a[132:133],v5 offset:0
ds_read_b64_tr_b16 a[138:139],v2 offset:6272
ds_read_b64_tr_b16 a[136:137],v2 offset:128
ds_read_b64_tr_b16 a[142:143],v3 offset:6272
ds_read_b64_tr_b16 a[140:141],v3 offset:128
ds_read_b64_tr_b16 a[146:147],v4 offset:6272
ds_read_b64_tr_b16 a[144:145],v4 offset:128
ds_read_b64_tr_b16 a[148:149],v5 offset:128
ds_read_b64_tr_b16 a[150:151],v5 offset:6272
v_exp_f32 v73,v73
s_waitcnt lgkmcnt(14)
v_mfma_f32_16x16x32_bf16 v[160:163],a[120:123],v[20:23],0
s_waitcnt lgkmcnt(12)
ds_read_b64_tr_b16 a[122:123],v2 offset:6400
v_cvt_pk_bf16_f32 v45,v74,v75
v_mfma_f32_16x16x32_bf16 v[164:167],a[124:127],v[20:23],0
s_waitcnt lgkmcnt(11)
ds_read_b64_tr_b16 a[120:121],v2 offset:256
v_cvt_pk_bf16_f32 v44,v72,v73
v_mfma_f32_16x16x32_bf16 v[168:171],a[128:131],v[20:23],0
s_waitcnt lgkmcnt(10)
ds_read_b64_tr_b16 a[124:125],v3 offset:256
v_fma_f32 v78,v78,s36,v13
v_mfma_f32_16x16x32_bf16 v[172:175],a[132:135],v[20:23],0
s_waitcnt lgkmcnt(9)
ds_read_b64_tr_b16 a[126:127],v3 offset:6400
v_fma_f32 v77,v77,s36,v13
v_mfma_f32_16x16x32_bf16 v[176:179],a[136:139],v[20:23],0
s_waitcnt lgkmcnt(5)
ds_read_b64_tr_b16 a[130:131],v4 offset:6400
v_exp_f32 v78,v78
v_mfma_f32_16x16x32_bf16 v[180:183],a[140:143],v[20:23],0
ds_read_b64_tr_b16 a[128:129],v4 offset:256
v_exp_f32 v77,v77
v_mfma_f32_16x16x32_bf16 v[184:187],a[144:147],v[20:23],0
s_waitcnt lgkmcnt(5)
ds_read_b64_tr_b16 a[132:133],v5 offset:256
v_fma_f32 v76,v76,s36,v13
v_mfma_f32_16x16x32_bf16 v[188:191],a[148:151],v[20:23],0
s_waitcnt lgkmcnt(4)
ds_read_b64_tr_b16 a[134:135],v5 offset:6400
ds_read_b128 a[136:139],v0 offset:24576
v_exp_f32 v76,v76
v_mfma_f32_16x16x32_bf16 v[192:195],a[120:123],v[20:23],0
s_waitcnt lgkmcnt(5)
ds_read_b128 a[140:143],v1 offset:24576
v_fma_f32 v79,v79,s36,v13
ds_read_b128 a[144:147],v0 offset:24704
v_mfma_f32_16x16x32_bf16 v[196:199],a[124:127],v[20:23],0
v_exp_f32 v79,v79
ds_read_b128 a[148:151],v1 offset:24704
v_cvt_pk_bf16_f32 v46,v76,v77
v_cvt_pk_bf16_f32 v47,v78,v79
s_waitcnt lgkmcnt(6)
v_mfma_f32_16x16x32_bf16 v[200:203],a[128:131],v[20:23],0
s_waitcnt lgkmcnt(4)
ds_read_b128 a[120:123],v0 offset:24832
ds_read_b128 a[124:127],v1 offset:24832
v_mfma_f32_16x16x32_bf16 v[204:207],a[132:135],v[20:23],0
s_waitcnt lgkmcnt(5)
ds_read_b128 a[128:131],v0 offset:30720
v_mfma_f32_16x16x32_bf16 v[72:75],a[136:139],a[0:3],0
s_waitcnt lgkmcnt(5)
ds_read_b128 a[132:135],v1 offset:30720
v_mfma_f32_16x16x32_bf16 v[72:75],a[140:143],a[4:7],v[72:75]
s_waitcnt lgkmcnt(5)
ds_read_b128 a[136:139],v0 offset:30848
v_mfma_f32_16x16x32_bf16 v[72:75],a[144:147],a[8:11],v[72:75]
s_waitcnt lgkmcnt(5)
ds_read_b128 a[140:143],v1 offset:30848
v_mfma_f32_16x16x32_bf16 v[72:75],a[148:151],a[12:15],v[72:75]
s_waitcnt lgkmcnt(5)
ds_read_b128 a[144:147],v0 offset:30976
v_mfma_f32_16x16x32_bf16 v[72:75],a[120:123],a[16:19],v[72:75]
s_waitcnt lgkmcnt(5)
ds_read_b128 a[148:151],v1 offset:30976
v_mfma_f32_16x16x32_bf16 v[72:75],a[124:127],a[20:23],v[72:75]
s_waitcnt lgkmcnt(5)
ds_read_b128 a[120:123],v0 offset:0
v_mfma_f32_16x16x32_bf16 v[76:79],a[128:131],a[0:3],0
s_waitcnt lgkmcnt(5)
ds_read_b128 a[124:127],v1 offset:0
v_mfma_f32_16x16x32_bf16 v[76:79],a[132:135],a[4:7],v[76:79]
s_waitcnt lgkmcnt(5)
ds_read_b128 a[128:131],v0 offset:128
v_mfma_f32_16x16x32_bf16 v[76:79],a[136:139],a[8:11],v[76:79]
s_waitcnt lgkmcnt(5)
ds_read_b128 a[132:135],v1 offset:128
v_mfma_f32_16x16x32_bf16 v[76:79],a[140:143],a[12:15],v[76:79]
s_waitcnt lgkmcnt(5)
ds_read_b128 a[136:139],v0 offset:256
v_fma_f32 v74,v74,s36,v13
v_exp_f32 v74,v74
v_mfma_f32_16x16x32_bf16 v[76:79],a[144:147],a[16:19],v[76:79]
s_waitcnt lgkmcnt(5)
ds_read_b128 a[140:143],v1 offset:256
v_fma_f32 v73,v73,s36,v13
v_exp_f32 v73,v73
v_mfma_f32_16x16x32_bf16 v[76:79],a[148:151],a[20:23],v[76:79]
s_waitcnt vmcnt(6)
ds_read_b128 a[24:27],v11 offset:6144
buffer_load_dwordx4 v6,s[12:15],s28 offen offset:0 nt lds
ds_read_b128 a[28:31],v12 offset:6144
buffer_load_dwordx4 v7,s[12:15],s28 offen offset:1024 nt lds
ds_read_b128 a[32:35],v11 offset:6272
buffer_load_dwordx4 v8,s[12:15],s28 offen offset:2048 nt lds
s_add_u32 s28,s28,3072
s_add_u32 m0,s24,3072
ds_read_b128 a[36:39],v12 offset:6272
buffer_load_dwordx4 v6,s[12:15],s28 offen offset:0 nt lds
ds_read_b128 a[40:43],v11 offset:6400
buffer_load_dwordx4 v7,s[12:15],s28 offen offset:1024 nt lds
ds_read_b128 a[44:47],v12 offset:6400
buffer_load_dwordx4 v8,s[12:15],s28 offen offset:2048 nt lds
s_add_u32 s28,s28,3072
s_add_u32 m0,s24,6144
ds_read_b128 a[144:147],v0 offset:6144
v_fma_f32 v72,v72,s36,v13
s_waitcnt lgkmcnt(6)
v_mfma_f32_16x16x32_bf16 v[80:83],a[120:123],a[24:27],0
s_waitcnt lgkmcnt(5)
ds_read_b128 a[148:151],v1 offset:6144
v_fma_f32 v75,v75,s36,v13
v_mfma_f32_16x16x32_bf16 v[80:83],a[124:127],a[28:31],v[80:83]
s_waitcnt lgkmcnt(5)
ds_read_b128 a[120:123],v0 offset:6272
v_exp_f32 v72,v72
v_mfma_f32_16x16x32_bf16 v[80:83],a[128:131],a[32:35],v[80:83]
s_waitcnt lgkmcnt(5)
ds_read_b128 a[124:127],v1 offset:6272
v_exp_f32 v75,v75
v_mfma_f32_16x16x32_bf16 v[80:83],a[132:135],a[36:39],v[80:83]
s_waitcnt lgkmcnt(4)
ds_read_b128 a[128:131],v0 offset:6400
v_mfma_f32_16x16x32_bf16 v[80:83],a[136:139],a[40:43],v[80:83]
ds_read_b128 a[132:135],v1 offset:6400
v_mfma_f32_16x16x32_bf16 v[80:83],a[140:143],a[44:47],v[80:83]
s_waitcnt lgkmcnt(5)
ds_read_b128 a[136:139],v0 offset:12288
v_mfma_f32_16x16x32_bf16 v[84:87],a[144:147],a[24:27],0
s_waitcnt lgkmcnt(5)
ds_read_b128 a[140:143],v1 offset:12288
v_mfma_f32_16x16x32_bf16 v[84:87],a[148:151],a[28:31],v[84:87]
s_waitcnt lgkmcnt(5)
ds_read_b128 a[144:147],v0 offset:12416
v_mfma_f32_16x16x32_bf16 v[84:87],a[120:123],a[32:35],v[84:87]
s_waitcnt lgkmcnt(5)
ds_read_b128 a[148:151],v1 offset:12416
v_mfma_f32_16x16x32_bf16 v[84:87],a[124:127],a[36:39],v[84:87]
s_waitcnt lgkmcnt(5)
ds_read_b128 a[120:123],v0 offset:12544
v_max3_f32 v48,v80,v81,v82
v_max_f32 v48,v48,v83
v_mfma_f32_16x16x32_bf16 v[84:87],a[128:131],a[40:43],v[84:87]
s_waitcnt lgkmcnt(5)
ds_read_b128 a[124:127],v1 offset:12544
v_mov_b32 v49,v48
v_mfma_f32_16x16x32_bf16 v[84:87],a[132:135],a[44:47],v[84:87]
ds_read_b128 a[128:131],v0 offset:18432
v_permlane32_swap_b32 v49,v48
v_max_f32 v48,v48,v49
v_mov_b32 v49,v48
ds_read_b128 a[132:135],v1 offset:18432
s_nop 0
v_permlane16_swap_b32 v49,v48
v_max_f32 v48,v48,v49
v_mul_f32_e64 v14,-s36,v48
v_fma_f32 v82,v82,s36,v14
v_fma_f32 v81,v81,s36,v14
v_fma_f32 v83,v83,s36,v14
v_exp_f32 v82,v82
v_fma_f32 v80,v80,s36,v14
v_exp_f32 v80,v80
v_exp_f32 v83,v83
v_exp_f32 v81,v81
v_cvt_pk_bf16_f32 v25,v82,v83
v_cvt_pk_bf16_f32 v24,v80,v81
s_waitcnt lgkmcnt(2)
v_mfma_f32_16x16x32_bf16 v[80:83],a[136:139],a[24:27],0
ds_read_b128 a[136:139],v0 offset:18560
v_fma_f32 v84,v84,s36,v14
v_mfma_f32_16x16x32_bf16 v[80:83],a[140:143],a[28:31],v[80:83]
ds_read_b128 a[140:143],v1 offset:18560
v_fma_f32 v86,v86,s36,v14
v_mfma_f32_16x16x32_bf16 v[80:83],a[144:147],a[32:35],v[80:83]
ds_read_b128 a[144:147],v0 offset:18688
v_fma_f32 v87,v87,s36,v14
v_mfma_f32_16x16x32_bf16 v[80:83],a[148:151],a[36:39],v[80:83]
ds_read_b128 a[148:151],v1 offset:18688
v_exp_f32 v84,v84
v_mfma_f32_16x16x32_bf16 v[80:83],a[120:123],a[40:43],v[80:83]
ds_read_b64_tr_b16 a[122:123],v2 offset:6144
v_exp_f32 v86,v86
v_mfma_f32_16x16x32_bf16 v[80:83],a[124:127],a[44:47],v[80:83]
ds_read_b64_tr_b16 a[120:121],v2 offset:0
v_exp_f32 v87,v87
v_fma_f32 v85,v85,s36,v14
ds_read_b64_tr_b16 a[124:125],v3 offset:0
ds_read_b64_tr_b16 a[126:127],v3 offset:6144
v_exp_f32 v85,v85
v_cvt_pk_bf16_f32 v27,v86,v87
v_cvt_pk_bf16_f32 v26,v84,v85
s_waitcnt lgkmcnt(6)
v_mfma_f32_16x16x32_bf16 v[84:87],a[128:131],a[24:27],0
ds_read_b64_tr_b16 a[128:129],v4 offset:0
v_fma_f32 v83,v83,s36,v14
v_smfmac_f32_16x16x64_bf16 v[60:63],a[152:155],v[20:27],v18
ds_read_b64_tr_b16 a[130:131],v4 offset:6144
v_mfma_f32_16x16x32_bf16 v[84:87],a[132:135],a[28:31],v[84:87]
ds_read_b64_tr_b16 a[134:135],v5 offset:6144
v_fma_f32 v80,v80,s36,v14
v_mfma_f32_16x16x32_bf16 v[84:87],a[136:139],a[32:35],v[84:87]
ds_read_b64_tr_b16 a[132:133],v5 offset:0
v_exp_f32 v80,v80
v_mfma_f32_16x16x32_bf16 v[84:87],a[140:143],a[36:39],v[84:87]
s_waitcnt lgkmcnt(6)
ds_read_b64_tr_b16 a[136:137],v2 offset:128
v_fma_f32 v81,v81,s36,v14
v_mfma_f32_16x16x32_bf16 v[84:87],a[144:147],a[40:43],v[84:87]
ds_read_b64_tr_b16 a[138:139],v2 offset:6272
v_fma_f32 v82,v82,s36,v14
v_mfma_f32_16x16x32_bf16 v[84:87],a[148:151],a[44:47],v[84:87]
ds_read_b64_tr_b16 a[140:141],v3 offset:128
v_exp_f32 v82,v82
v_mfma_f32_16x16x32_bf16 v[208:211],a[120:123],v[24:27],0
s_waitcnt lgkmcnt(6)
ds_read_b64_tr_b16 a[142:143],v3 offset:6272
v_exp_f32 v83,v83
v_mfma_f32_16x16x32_bf16 v[212:215],a[124:127],v[24:27],0
s_waitcnt lgkmcnt(5)
ds_read_b64_tr_b16 a[144:145],v4 offset:128
v_exp_f32 v81,v81
v_mfma_f32_16x16x32_bf16 v[216:219],a[128:131],v[24:27],0
s_waitcnt lgkmcnt(5)
ds_read_b64_tr_b16 a[146:147],v4 offset:6272
v_cvt_pk_bf16_f32 v48,v80,v81
v_mfma_f32_16x16x32_bf16 v[220:223],a[132:135],v[24:27],0
ds_read_b64_tr_b16 a[148:149],v5 offset:128
ds_read_b64_tr_b16 a[150:151],v5 offset:6272
ds_read_b64_tr_b16 a[120:121],v2 offset:256
v_cvt_pk_bf16_f32 v49,v82,v83
v_fma_f32 v84,v84,s36,v14
s_waitcnt lgkmcnt(7)
v_mfma_f32_16x16x32_bf16 v[224:227],a[136:139],v[24:27],0
ds_read_b64_tr_b16 a[122:123],v2 offset:6400
ds_read_b64_tr_b16 a[126:127],v3 offset:6400
ds_read_b64_tr_b16 a[124:125],v3 offset:256
v_fma_f32 v85,v85,s36,v14
v_fma_f32 v87,v87,s36,v14
s_waitcnt lgkmcnt(8)
v_mfma_f32_16x16x32_bf16 v[228:231],a[140:143],v[24:27],0
ds_read_b64_tr_b16 a[128:129],v4 offset:256
ds_read_b64_tr_b16 a[130:131],v4 offset:6400
ds_read_b64_tr_b16 a[132:133],v5 offset:256
ds_read_b64_tr_b16 a[134:135],v5 offset:6400
v_exp_f32 v87,v87
s_waitcnt lgkmcnt(10)
v_mfma_f32_16x16x32_bf16 v[232:235],a[144:147],v[24:27],0
s_waitcnt lgkmcnt(8)
ds_read_b128 a[136:139],v0 offset:24576
v_fma_f32 v86,v86,s36,v14
v_exp_f32 v85,v85
v_mfma_f32_16x16x32_bf16 v[236:239],a[148:151],v[24:27],0
s_waitcnt lgkmcnt(7)
ds_read_b128 a[140:143],v1 offset:24576
v_exp_f32 v84,v84
v_exp_f32 v86,v86
v_mfma_f32_16x16x32_bf16 v[240:243],a[120:123],v[24:27],0
s_waitcnt lgkmcnt(6)
ds_read_b128 a[144:147],v0 offset:24704
v_cvt_pk_bf16_f32 v51,v86,v87
v_mfma_f32_16x16x32_bf16 v[244:247],a[124:127],v[24:27],0
ds_read_b128 a[148:151],v1 offset:24704
v_cvt_pk_bf16_f32 v50,v84,v85
v_cvt_pk_bf16_f32 v21,v74,v75
v_cvt_pk_bf16_f32 v20,v72,v73
v_smfmac_f32_16x16x64_bf16 v[60:63],a[152:155],v[44:51],v18
s_waitcnt lgkmcnt(4)
ds_read_b128 a[120:123],v0 offset:24832
v_mfma_f32_16x16x32_bf16 v[248:251],a[128:131],v[24:27],0
ds_read_b128 a[124:127],v1 offset:24832
v_mfma_f32_16x16x32_bf16 v[252:255],a[132:135],v[24:27],0
s_waitcnt lgkmcnt(4)
ds_read_b128 a[128:131],v0 offset:30720
v_mfma_f32_16x16x32_bf16 v[80:83],a[136:139],a[24:27],0
ds_read_b128 a[132:135],v1 offset:30720
v_mfma_f32_16x16x32_bf16 v[80:83],a[140:143],a[28:31],v[80:83]
s_waitcnt lgkmcnt(5)
ds_read_b128 a[136:139],v0 offset:30848
v_mfma_f32_16x16x32_bf16 v[80:83],a[144:147],a[32:35],v[80:83]
s_waitcnt lgkmcnt(5)
ds_read_b128 a[140:143],v1 offset:30848
v_mfma_f32_16x16x32_bf16 v[80:83],a[148:151],a[36:39],v[80:83]
s_waitcnt lgkmcnt(5)
ds_read_b128 a[144:147],v0 offset:30976
ds_read_b128 a[148:151],v1 offset:30976
v_mfma_f32_16x16x32_bf16 v[80:83],a[120:123],a[40:43],v[80:83]
s_waitcnt lgkmcnt(6)
ds_read_b128 a[120:123],v0 offset:0
v_mfma_f32_16x16x32_bf16 v[80:83],a[124:127],a[44:47],v[80:83]
s_waitcnt lgkmcnt(6)
ds_read_b128 a[124:127],v1 offset:0
v_mfma_f32_16x16x32_bf16 v[84:87],a[128:131],a[24:27],0
s_waitcnt lgkmcnt(6)
ds_read_b128 a[128:131],v0 offset:128
v_mfma_f32_16x16x32_bf16 v[84:87],a[132:135],a[28:31],v[84:87]
s_waitcnt lgkmcnt(6)
ds_read_b128 a[132:135],v1 offset:128
v_mfma_f32_16x16x32_bf16 v[84:87],a[136:139],a[32:35],v[84:87]
s_waitcnt lgkmcnt(6)
ds_read_b128 a[136:139],v0 offset:256
v_mfma_f32_16x16x32_bf16 v[84:87],a[140:143],a[36:39],v[84:87]
s_waitcnt lgkmcnt(6)
ds_read_b128 a[140:143],v1 offset:256
v_fma_f32 v80,v80,s36,v14
v_mfma_f32_16x16x32_bf16 v[84:87],a[144:147],a[40:43],v[84:87]
s_waitcnt lgkmcnt(6)
ds_read_b128 a[144:147],v0 offset:6144
v_fma_f32 v83,v83,s36,v14
v_mfma_f32_16x16x32_bf16 v[84:87],a[148:151],a[44:47],v[84:87]
s_waitcnt vmcnt(6)
ds_read_b128 a[48:51],v11 offset:12288
buffer_load_dwordx4 v6,s[12:15],s28 offen offset:0 nt lds
ds_read_b128 a[52:55],v12 offset:12288
buffer_load_dwordx4 v7,s[12:15],s28 offen offset:1024 nt lds
ds_read_b128 a[56:59],v11 offset:12416
buffer_load_dwordx4 v8,s[12:15],s28 offen offset:2048 nt lds
s_add_u32 s28,s28,3072
s_add_u32 m0,s24,9216
ds_read_b128 a[60:63],v12 offset:12416
buffer_load_dwordx4 v6,s[12:15],s28 offen offset:0 nt lds
ds_read_b128 a[64:67],v11 offset:12544
buffer_load_dwordx4 v7,s[12:15],s28 offen offset:1024 nt lds
ds_read_b128 a[68:71],v12 offset:12544
buffer_load_dwordx4 v8,s[12:15],s28 offen offset:2048 nt lds
s_add_u32 s28,s28,3072
s_add_u32 m0,s23,12288
ds_read_b128 a[148:151],v1 offset:6144
v_exp_f32 v83,v83
s_waitcnt lgkmcnt(6)
v_mfma_f32_16x16x32_bf16 v[88:91],a[120:123],a[48:51],0
s_waitcnt lgkmcnt(5)
ds_read_b128 a[120:123],v0 offset:6272
v_fma_f32 v82,v82,s36,v14
v_mfma_f32_16x16x32_bf16 v[88:91],a[124:127],a[52:55],v[88:91]
s_waitcnt lgkmcnt(5)
ds_read_b128 a[124:127],v1 offset:6272
v_exp_f32 v82,v82
v_mfma_f32_16x16x32_bf16 v[88:91],a[128:131],a[56:59],v[88:91]
s_waitcnt lgkmcnt(4)
ds_read_b128 a[128:131],v0 offset:6400
v_exp_f32 v80,v80
v_mfma_f32_16x16x32_bf16 v[88:91],a[132:135],a[60:63],v[88:91]
ds_read_b128 a[132:135],v1 offset:6400
v_fma_f32 v81,v81,s36,v14
v_mfma_f32_16x16x32_bf16 v[88:91],a[136:139],a[64:67],v[88:91]
s_waitcnt lgkmcnt(4)
ds_read_b128 a[136:139],v0 offset:12288
v_exp_f32 v81,v81
v_mfma_f32_16x16x32_bf16 v[88:91],a[140:143],a[68:71],v[88:91]
ds_read_b128 a[140:143],v1 offset:12288
v_cvt_pk_bf16_f32 v25,v82,v83
v_mfma_f32_16x16x32_bf16 v[92:95],a[144:147],a[48:51],0
ds_read_b128 a[144:147],v0 offset:12416
v_cvt_pk_bf16_f32 v24,v80,v81
v_mfma_f32_16x16x32_bf16 v[92:95],a[148:151],a[52:55],v[92:95]
s_waitcnt lgkmcnt(5)
ds_read_b128 a[148:151],v1 offset:12416
v_mfma_f32_16x16x32_bf16 v[92:95],a[120:123],a[56:59],v[92:95]
ds_read_b128 a[120:123],v0 offset:12544
v_max3_f32 v52,v88,v89,v90
v_mfma_f32_16x16x32_bf16 v[92:95],a[124:127],a[60:63],v[92:95]
s_waitcnt lgkmcnt(6)
ds_read_b128 a[124:127],v1 offset:12544
v_max_f32 v52,v52,v91
v_mfma_f32_16x16x32_bf16 v[92:95],a[128:131],a[64:67],v[92:95]
s_waitcnt lgkmcnt(6)
ds_read_b128 a[128:131],v0 offset:18432
v_mov_b32 v53,v52
v_mfma_f32_16x16x32_bf16 v[92:95],a[132:135],a[68:71],v[92:95]
ds_read_b128 a[132:135],v1 offset:18432
v_permlane32_swap_b32 v53,v52
v_max_f32 v52,v52,v53
v_mov_b32 v53,v52
s_nop 1
v_permlane16_swap_b32 v53,v52
v_max_f32 v52,v52,v53
v_mul_f32_e64 v15,-s36,v52
v_fma_f32 v88,v88,s36,v15
v_fma_f32 v91,v91,s36,v15
v_exp_f32 v88,v88
v_fma_f32 v89,v89,s36,v15
v_fma_f32 v90,v90,s36,v15
v_exp_f32 v90,v90
v_exp_f32 v91,v91
v_exp_f32 v89,v89
v_cvt_pk_bf16_f32 v29,v90,v91
v_cvt_pk_bf16_f32 v28,v88,v89
s_waitcnt lgkmcnt(1)
v_mfma_f32_16x16x32_bf16 v[88:91],a[136:139],a[48:51],0
ds_read_b128 a[136:139],v0 offset:18560
v_fma_f32 v94,v94,s36,v15
v_mfma_f32_16x16x32_bf16 v[88:91],a[140:143],a[52:55],v[88:91]
ds_read_b128 a[140:143],v1 offset:18560
v_fma_f32 v95,v95,s36,v15
v_mfma_f32_16x16x32_bf16 v[88:91],a[144:147],a[56:59],v[88:91]
ds_read_b128 a[144:147],v0 offset:18688
v_fma_f32 v93,v93,s36,v15
v_mfma_f32_16x16x32_bf16 v[88:91],a[148:151],a[60:63],v[88:91]
ds_read_b128 a[148:151],v1 offset:18688
v_exp_f32 v93,v93
v_mfma_f32_16x16x32_bf16 v[88:91],a[120:123],a[64:67],v[88:91]
ds_read_b64_tr_b16 a[120:121],v2 offset:0
v_fma_f32 v92,v92,s36,v15
v_mfma_f32_16x16x32_bf16 v[88:91],a[124:127],a[68:71],v[88:91]
ds_read_b64_tr_b16 a[122:123],v2 offset:6144
v_exp_f32 v95,v95
v_exp_f32 v92,v92
ds_read_b64_tr_b16 a[124:125],v3 offset:0
ds_read_b64_tr_b16 a[126:127],v3 offset:6144
v_exp_f32 v94,v94
v_cvt_pk_bf16_f32 v30,v92,v93
v_cvt_pk_bf16_f32 v31,v94,v95
v_mfma_f32_16x16x32_bf16 v[92:95],a[128:131],a[48:51],0
s_waitcnt lgkmcnt(5)
ds_read_b64_tr_b16 a[128:129],v4 offset:0
v_fma_f32 v90,v90,s36,v15
v_mfma_f32_16x16x32_bf16 v[92:95],a[132:135],a[52:55],v[92:95]
ds_read_b64_tr_b16 a[130:131],v4 offset:6144
v_fma_f32 v91,v91,s36,v15
v_mfma_f32_16x16x32_bf16 v[92:95],a[136:139],a[56:59],v[92:95]
ds_read_b64_tr_b16 a[132:133],v5 offset:0
v_exp_f32 v91,v91
v_mfma_f32_16x16x32_bf16 v[92:95],a[140:143],a[60:63],v[92:95]
ds_read_b64_tr_b16 a[134:135],v5 offset:6144
v_fma_f32 v89,v89,s36,v15
v_mfma_f32_16x16x32_bf16 v[92:95],a[144:147],a[64:67],v[92:95]
s_waitcnt lgkmcnt(6)
ds_read_b64_tr_b16 a[138:139],v2 offset:6272
v_fma_f32 v88,v88,s36,v15
v_mfma_f32_16x16x32_bf16 v[92:95],a[148:151],a[68:71],v[92:95]
ds_read_b64_tr_b16 a[136:137],v2 offset:128
v_exp_f32 v88,v88
v_mfma_f32_16x16x32_bf16 v[112:115],a[120:123],v[28:31],0
s_waitcnt lgkmcnt(5)
ds_read_b64_tr_b16 a[140:141],v3 offset:128
v_exp_f32 v89,v89
v_mfma_f32_16x16x32_bf16 v[116:119],a[124:127],v[28:31],0
s_waitcnt lgkmcnt(5)
ds_read_b64_tr_b16 a[142:143],v3 offset:6272
v_exp_f32 v90,v90
v_mfma_f32_16x16x32_bf16 v[120:123],a[128:131],v[28:31],0
ds_read_b64_tr_b16 a[144:145],v4 offset:128
ds_read_b64_tr_b16 a[146:147],v4 offset:6272
ds_read_b64_tr_b16 a[148:149],v5 offset:128
v_cvt_pk_bf16_f32 v52,v88,v89
v_cvt_pk_bf16_f32 v53,v90,v91
s_waitcnt lgkmcnt(7)
v_mfma_f32_16x16x32_bf16 v[124:127],a[132:135],v[28:31],0
ds_read_b64_tr_b16 a[150:151],v5 offset:6272
ds_read_b64_tr_b16 a[122:123],v2 offset:6400
ds_read_b64_tr_b16 a[120:121],v2 offset:256
v_fma_f32 v92,v92,s36,v15
s_waitcnt lgkmcnt(8)
v_mfma_f32_16x16x32_bf16 v[128:131],a[136:139],v[28:31],0
ds_read_b64_tr_b16 a[126:127],v3 offset:6400
ds_read_b64_tr_b16 a[124:125],v3 offset:256
ds_read_b64_tr_b16 a[130:131],v4 offset:6400
ds_read_b64_tr_b16 a[128:129],v4 offset:256
v_fma_f32 v94,v94,s36,v15
s_waitcnt lgkmcnt(10)
v_mfma_f32_16x16x32_bf16 v[132:135],a[140:143],v[28:31],0
ds_read_b64_tr_b16 a[132:133],v5 offset:256
ds_read_b64_tr_b16 a[134:135],v5 offset:6400
v_fma_f32 v93,v93,s36,v15
v_exp_f32 v92,v92
s_waitcnt lgkmcnt(10)
v_mfma_f32_16x16x32_bf16 v[136:139],a[144:147],v[28:31],0
s_waitcnt lgkmcnt(8)
ds_read_b128 a[136:139],v0 offset:24576
v_fma_f32 v95,v95,s36,v15
v_exp_f32 v95,v95
v_mfma_f32_16x16x32_bf16 v[140:143],a[148:151],v[28:31],0
s_waitcnt lgkmcnt(7)
ds_read_b128 a[140:143],v1 offset:24576
v_exp_f32 v94,v94
v_mfma_f32_16x16x32_bf16 v[144:147],a[120:123],v[28:31],0
s_waitcnt lgkmcnt(5)
ds_read_b128 a[144:147],v0 offset:24704
v_exp_f32 v93,v93
v_mfma_f32_16x16x32_bf16 v[148:151],a[124:127],v[28:31],0
s_waitcnt lgkmcnt(5)
ds_read_b128 a[148:151],v1 offset:24704
v_cvt_pk_bf16_f32 v54,v92,v93
v_mfma_f32_16x16x32_bf16 v[152:155],a[128:131],v[28:31],0
s_waitcnt lgkmcnt(4)
ds_read_b128 a[120:123],v0 offset:24832
v_cvt_pk_bf16_f32 v55,v94,v95
v_mfma_f32_16x16x32_bf16 v[156:159],a[132:135],v[28:31],0
s_waitcnt lgkmcnt(4)
ds_read_b128 a[124:127],v1 offset:24832
v_mfma_f32_16x16x32_bf16 v[88:91],a[136:139],a[48:51],0
s_waitcnt lgkmcnt(4)
ds_read_b128 a[128:131],v0 offset:30720
v_mfma_f32_16x16x32_bf16 v[88:91],a[140:143],a[52:55],v[88:91]
s_waitcnt lgkmcnt(4)
ds_read_b128 a[132:135],v1 offset:30720
v_mfma_f32_16x16x32_bf16 v[88:91],a[144:147],a[56:59],v[88:91]
s_waitcnt lgkmcnt(4)
ds_read_b128 a[136:139],v0 offset:30848
v_mfma_f32_16x16x32_bf16 v[88:91],a[148:151],a[60:63],v[88:91]
s_waitcnt lgkmcnt(4)
ds_read_b128 a[140:143],v1 offset:30848
v_mfma_f32_16x16x32_bf16 v[88:91],a[120:123],a[64:67],v[88:91]
s_waitcnt lgkmcnt(4)
ds_read_b128 a[144:147],v0 offset:30976
v_mfma_f32_16x16x32_bf16 v[88:91],a[124:127],a[68:71],v[88:91]
s_waitcnt lgkmcnt(4)
ds_read_b128 a[148:151],v1 offset:30976
v_mfma_f32_16x16x32_bf16 v[92:95],a[128:131],a[48:51],0
s_waitcnt lgkmcnt(4)
ds_read_b128 a[120:123],v0 offset:0
v_mfma_f32_16x16x32_bf16 v[92:95],a[132:135],a[52:55],v[92:95]
s_waitcnt lgkmcnt(4)
ds_read_b128 a[124:127],v1 offset:0
v_mfma_f32_16x16x32_bf16 v[92:95],a[136:139],a[56:59],v[92:95]
s_waitcnt lgkmcnt(4)
ds_read_b128 a[128:131],v0 offset:128
v_mfma_f32_16x16x32_bf16 v[92:95],a[140:143],a[60:63],v[92:95]
s_waitcnt lgkmcnt(4)
ds_read_b128 a[132:135],v1 offset:128
v_fma_f32 v88,v88,s36,v15
v_mfma_f32_16x16x32_bf16 v[92:95],a[144:147],a[64:67],v[92:95]
s_waitcnt lgkmcnt(4)
ds_read_b128 a[136:139],v0 offset:256
v_fma_f32 v89,v89,s36,v15
v_exp_f32 v88,v88
v_mfma_f32_16x16x32_bf16 v[92:95],a[148:151],a[68:71],v[92:95]
s_waitcnt vmcnt(6)
ds_read_b128 a[72:75],v11 offset:0
buffer_load_dwordx4 v6,s[8:11],s21 offen offset:0 lds
ds_read_b128 a[76:79],v12 offset:0
buffer_load_dwordx4 v7,s[8:11],s21 offen offset:1024 lds
ds_read_b128 a[80:83],v11 offset:128
buffer_load_dwordx4 v8,s[8:11],s21 offen offset:2048 lds
s_add_u32 s21,s21,12288
s_add_u32 m0,s23,24576
ds_read_b128 a[84:87],v12 offset:128
v_exp_f32 v89,v89
ds_read_b128 a[140:143],v1 offset:256
ds_read_b128 a[88:91],v11 offset:256
ds_read_b128 a[92:95],v12 offset:256
s_waitcnt lgkmcnt(6)
v_mfma_f32_16x16x32_bf16 v[96:99],a[120:123],a[72:75],0
s_waitcnt lgkmcnt(5)
ds_read_b128 a[144:147],v0 offset:6144
v_mfma_f32_16x16x32_bf16 v[96:99],a[124:127],a[76:79],v[96:99]
s_waitcnt lgkmcnt(5)
ds_read_b128 a[148:151],v1 offset:6144
v_mfma_f32_16x16x32_bf16 v[96:99],a[128:131],a[80:83],v[96:99]
s_waitcnt lgkmcnt(5)
ds_read_b128 a[120:123],v0 offset:6272
v_mfma_f32_16x16x32_bf16 v[96:99],a[132:135],a[84:87],v[96:99]
s_waitcnt lgkmcnt(4)
ds_read_b128 a[124:127],v1 offset:6272
ds_read_b128 a[128:131],v0 offset:6400
v_mfma_f32_16x16x32_bf16 v[96:99],a[136:139],a[88:91],v[96:99]
s_waitcnt lgkmcnt(5)
ds_read_b128 a[132:135],v1 offset:6400
v_mfma_f32_16x16x32_bf16 v[96:99],a[140:143],a[92:95],v[96:99]
s_waitcnt lgkmcnt(5)
ds_read_b128 a[136:139],v0 offset:12288
v_mfma_f32_16x16x32_bf16 v[100:103],a[144:147],a[72:75],0
s_waitcnt lgkmcnt(5)
ds_read_b128 a[140:143],v1 offset:12288
v_mfma_f32_16x16x32_bf16 v[100:103],a[148:151],a[76:79],v[100:103]
s_waitcnt lgkmcnt(5)
ds_read_b128 a[144:147],v0 offset:12416
v_mfma_f32_16x16x32_bf16 v[100:103],a[120:123],a[80:83],v[100:103]
s_waitcnt lgkmcnt(5)
ds_read_b128 a[148:151],v1 offset:12416
v_mfma_f32_16x16x32_bf16 v[100:103],a[124:127],a[84:87],v[100:103]
s_waitcnt lgkmcnt(5)
ds_read_b128 a[120:123],v0 offset:12544
v_max3_f32 v56,v96,v97,v98
v_mfma_f32_16x16x32_bf16 v[100:103],a[128:131],a[88:91],v[100:103]
s_waitcnt lgkmcnt(5)
ds_read_b128 a[124:127],v1 offset:12544
v_max_f32 v56,v56,v99
v_mov_b32 v57,v56
v_mfma_f32_16x16x32_bf16 v[100:103],a[132:135],a[92:95],v[100:103]
ds_read_b128 a[128:131],v0 offset:18432
v_permlane32_swap_b32 v57,v56
v_max_f32 v56,v56,v57
v_mov_b32 v57,v56
ds_read_b128 a[132:135],v1 offset:18432
s_nop 0
v_permlane16_swap_b32 v57,v56
v_max_f32 v56,v56,v57
v_mul_f32_e64 v16,-s36,v56
v_fma_f32 v97,v97,s36,v16
v_fma_f32 v96,v96,s36,v16
v_fma_f32 v99,v99,s36,v16
v_exp_f32 v99,v99
v_fma_f32 v98,v98,s36,v16
v_exp_f32 v98,v98
v_exp_f32 v97,v97
v_exp_f32 v96,v96
v_cvt_pk_bf16_f32 v33,v98,v99
v_cvt_pk_bf16_f32 v32,v96,v97
s_waitcnt lgkmcnt(2)
v_mfma_f32_16x16x32_bf16 v[96:99],a[136:139],a[72:75],0
ds_read_b128 a[136:139],v0 offset:18560
v_fma_f32 v102,v102,s36,v16
v_mfma_f32_16x16x32_bf16 v[96:99],a[140:143],a[76:79],v[96:99]
ds_read_b128 a[140:143],v1 offset:18560
v_exp_f32 v102,v102
v_mfma_f32_16x16x32_bf16 v[96:99],a[144:147],a[80:83],v[96:99]
ds_read_b128 a[144:147],v0 offset:18688
v_fma_f32 v101,v101,s36,v16
v_mfma_f32_16x16x32_bf16 v[96:99],a[148:151],a[84:87],v[96:99]
ds_read_b128 a[148:151],v1 offset:18688
v_exp_f32 v101,v101
v_mfma_f32_16x16x32_bf16 v[96:99],a[120:123],a[88:91],v[96:99]
ds_read_b64_tr_b16 a[120:121],v2 offset:0
v_fma_f32 v100,v100,s36,v16
v_mfma_f32_16x16x32_bf16 v[96:99],a[124:127],a[92:95],v[96:99]
ds_read_b64_tr_b16 a[122:123],v2 offset:6144
v_fma_f32 v103,v103,s36,v16
v_exp_f32 v103,v103
ds_read_b64_tr_b16 a[126:127],v3 offset:6144
ds_read_b64_tr_b16 a[124:125],v3 offset:0
v_exp_f32 v100,v100
v_cvt_pk_bf16_f32 v35,v102,v103
v_cvt_pk_bf16_f32 v34,v100,v101
s_waitcnt lgkmcnt(6)
v_mfma_f32_16x16x32_bf16 v[100:103],a[128:131],a[72:75],0
ds_read_b64_tr_b16 a[128:129],v4 offset:0
v_fma_f32 v96,v96,s36,v16
v_smfmac_f32_16x16x64_bf16 v[64:67],a[152:155],v[28:35],v18
ds_read_b64_tr_b16 a[130:131],v4 offset:6144
v_mfma_f32_16x16x32_bf16 v[100:103],a[132:135],a[76:79],v[100:103]
ds_read_b64_tr_b16 a[132:133],v5 offset:0
v_fma_f32 v97,v97,s36,v16
v_mfma_f32_16x16x32_bf16 v[100:103],a[136:139],a[80:83],v[100:103]
ds_read_b64_tr_b16 a[134:135],v5 offset:6144
v_fma_f32 v99,v99,s36,v16
v_mfma_f32_16x16x32_bf16 v[100:103],a[140:143],a[84:87],v[100:103]
s_waitcnt lgkmcnt(6)
ds_read_b64_tr_b16 a[138:139],v2 offset:6272
v_exp_f32 v99,v99
v_mfma_f32_16x16x32_bf16 v[100:103],a[144:147],a[88:91],v[100:103]
ds_read_b64_tr_b16 a[136:137],v2 offset:128
v_exp_f32 v97,v97
v_mfma_f32_16x16x32_bf16 v[100:103],a[148:151],a[92:95],v[100:103]
ds_read_b64_tr_b16 a[140:141],v3 offset:128
v_fma_f32 v98,v98,s36,v16
v_mfma_f32_16x16x32_bf16 a[160:163],a[120:123],v[32:35],0
s_waitcnt lgkmcnt(6)
ds_read_b64_tr_b16 a[142:143],v3 offset:6272
v_exp_f32 v98,v98
v_mfma_f32_16x16x32_bf16 a[164:167],a[124:127],v[32:35],0
s_waitcnt lgkmcnt(5)
ds_read_b64_tr_b16 a[146:147],v4 offset:6272
v_exp_f32 v96,v96
v_mfma_f32_16x16x32_bf16 a[168:171],a[128:131],v[32:35],0
s_waitcnt lgkmcnt(5)
ds_read_b64_tr_b16 a[144:145],v4 offset:128
v_cvt_pk_bf16_f32 v57,v98,v99
v_mfma_f32_16x16x32_bf16 a[172:175],a[132:135],v[32:35],0
ds_read_b64_tr_b16 a[150:151],v5 offset:6272
ds_read_b64_tr_b16 a[148:149],v5 offset:128
ds_read_b64_tr_b16 a[122:123],v2 offset:6400
v_cvt_pk_bf16_f32 v56,v96,v97
v_fma_f32 v100,v100,s36,v16
s_waitcnt lgkmcnt(7)
v_mfma_f32_16x16x32_bf16 a[176:179],a[136:139],v[32:35],0
ds_read_b64_tr_b16 a[120:121],v2 offset:256
ds_read_b64_tr_b16 a[124:125],v3 offset:256
ds_read_b64_tr_b16 a[126:127],v3 offset:6400
v_fma_f32 v101,v101,s36,v16
v_fma_f32 v102,v102,s36,v16
s_waitcnt lgkmcnt(8)
v_mfma_f32_16x16x32_bf16 a[180:183],a[140:143],v[32:35],0
ds_read_b64_tr_b16 a[130:131],v4 offset:6400
ds_read_b64_tr_b16 a[128:129],v4 offset:256
ds_read_b64_tr_b16 a[132:133],v5 offset:256
ds_read_b64_tr_b16 a[134:135],v5 offset:6400
v_exp_f32 v102,v102
s_waitcnt lgkmcnt(10)
v_mfma_f32_16x16x32_bf16 a[184:187],a[144:147],v[32:35],0
s_waitcnt lgkmcnt(8)
ds_read_b128 a[136:139],v0 offset:24576
v_exp_f32 v100,v100
v_mfma_f32_16x16x32_bf16 a[188:191],a[148:151],v[32:35],0
s_waitcnt lgkmcnt(7)
ds_read_b128 a[140:143],v1 offset:24576
v_fma_f32 v103,v103,s36,v16
ds_read_b128 a[144:147],v0 offset:24704
v_mfma_f32_16x16x32_bf16 a[192:195],a[120:123],v[32:35],0
s_waitcnt lgkmcnt(7)
v_exp_f32 v101,v101
v_mfma_f32_16x16x32_bf16 a[196:199],a[124:127],v[32:35],0
ds_read_b128 a[148:151],v1 offset:24704
v_exp_f32 v103,v103
v_cvt_pk_bf16_f32 v58,v100,v101
v_cvt_pk_bf16_f32 v59,v102,v103
s_waitcnt lgkmcnt(4)
v_mfma_f32_16x16x32_bf16 a[200:203],a[128:131],v[32:35],0
ds_read_b128 a[120:123],v0 offset:24832
v_cvt_pk_bf16_f32 v28,v88,v89
v_smfmac_f32_16x16x64_bf16 v[64:67],a[152:155],v[52:59],v18
ds_read_b128 a[124:127],v1 offset:24832
v_mfma_f32_16x16x32_bf16 a[204:207],a[132:135],v[32:35],0
s_waitcnt lgkmcnt(4)
ds_read_b128 a[128:131],v0 offset:30720
v_mfma_f32_16x16x32_bf16 v[96:99],a[136:139],a[72:75],0
ds_read_b128 a[132:135],v1 offset:30720
v_mfma_f32_16x16x32_bf16 v[96:99],a[140:143],a[76:79],v[96:99]
s_waitcnt lgkmcnt(5)
ds_read_b128 a[136:139],v0 offset:30848
v_mfma_f32_16x16x32_bf16 v[96:99],a[144:147],a[80:83],v[96:99]
s_waitcnt lgkmcnt(5)
ds_read_b128 a[140:143],v1 offset:30848
v_mfma_f32_16x16x32_bf16 v[96:99],a[148:151],a[84:87],v[96:99]
s_waitcnt lgkmcnt(5)
ds_read_b128 a[144:147],v0 offset:30976
ds_read_b128 a[148:151],v1 offset:30976
v_mfma_f32_16x16x32_bf16 v[96:99],a[120:123],a[88:91],v[96:99]
s_waitcnt lgkmcnt(6)
ds_read_b128 a[120:123],v0 offset:0
v_mfma_f32_16x16x32_bf16 v[96:99],a[124:127],a[92:95],v[96:99]
s_waitcnt lgkmcnt(6)
ds_read_b128 a[124:127],v1 offset:0
v_mfma_f32_16x16x32_bf16 v[100:103],a[128:131],a[72:75],0
s_waitcnt lgkmcnt(6)
ds_read_b128 a[128:131],v0 offset:128
v_mfma_f32_16x16x32_bf16 v[100:103],a[132:135],a[76:79],v[100:103]
s_waitcnt lgkmcnt(6)
ds_read_b128 a[132:135],v1 offset:128
v_mfma_f32_16x16x32_bf16 v[100:103],a[136:139],a[80:83],v[100:103]
s_waitcnt lgkmcnt(6)
ds_read_b128 a[136:139],v0 offset:256
v_mfma_f32_16x16x32_bf16 v[100:103],a[140:143],a[84:87],v[100:103]
s_waitcnt lgkmcnt(6)
ds_read_b128 a[140:143],v1 offset:256
v_mfma_f32_16x16x32_bf16 v[100:103],a[144:147],a[88:91],v[100:103]
s_waitcnt lgkmcnt(6)
ds_read_b128 a[144:147],v0 offset:6144
v_mfma_f32_16x16x32_bf16 v[100:103],a[148:151],a[92:95],v[100:103]
s_waitcnt vmcnt(3)
ds_read_b128 a[96:99],v11 offset:6144
buffer_load_dwordx4 v6,s[8:11],s21 offen offset:0 lds
ds_read_b128 a[100:103],v12 offset:6144
buffer_load_dwordx4 v7,s[8:11],s21 offen offset:1024 lds
ds_read_b128 a[104:107],v11 offset:6272
buffer_load_dwordx4 v8,s[8:11],s21 offen offset:2048 lds
s_add_u32 s21,s21,12288
ds_read_b128 a[108:111],v12 offset:6272
s_add_u32 m0,s22,0
ds_read_b128 a[112:115],v11 offset:6400
ds_read_b128 a[116:119],v12 offset:6400
ds_read_b128 a[148:151],v1 offset:6144
s_waitcnt lgkmcnt(6)
v_mfma_f32_16x16x32_bf16 v[104:107],a[120:123],a[96:99],0
s_waitcnt lgkmcnt(5)
ds_read_b128 a[120:123],v0 offset:6272
v_mfma_f32_16x16x32_bf16 v[104:107],a[124:127],a[100:103],v[104:107]
s_waitcnt lgkmcnt(5)
ds_read_b128 a[124:127],v1 offset:6272
v_mfma_f32_16x16x32_bf16 v[104:107],a[128:131],a[104:107],v[104:107]
s_waitcnt lgkmcnt(5)
ds_read_b128 a[128:131],v0 offset:6400
v_mfma_f32_16x16x32_bf16 v[104:107],a[132:135],a[108:111],v[104:107]
ds_read_b128 a[132:135],v1 offset:6400
s_waitcnt vmcnt(3)
s_waitcnt lgkmcnt(6)
v_mfma_f32_16x16x32_bf16 v[104:107],a[136:139],a[112:115],v[104:107]
s_waitcnt lgkmcnt(5)
v_mfma_f32_16x16x32_bf16 v[104:107],a[140:143],a[116:119],v[104:107]
v_mfma_f32_16x16x32_bf16 v[108:111],a[144:147],a[96:99],0
s_waitcnt lgkmcnt(4)
v_mfma_f32_16x16x32_bf16 v[108:111],a[148:151],a[100:103],v[108:111]
s_waitcnt lgkmcnt(3)
v_mfma_f32_16x16x32_bf16 v[108:111],a[120:123],a[104:107],v[108:111]
s_waitcnt lgkmcnt(2)
v_mfma_f32_16x16x32_bf16 v[108:111],a[124:127],a[108:111],v[108:111]
s_waitcnt lgkmcnt(1)
v_mfma_f32_16x16x32_bf16 v[108:111],a[128:131],a[112:115],v[108:111]
s_waitcnt lgkmcnt(0)
v_mfma_f32_16x16x32_bf16 v[108:111],a[132:135],a[116:119],v[108:111]
s_barrier
buffer_load_dwordx4 v6,s[4:7],s20 offen offset:0 lds
buffer_load_dwordx4 v7,s[4:7],s20 offen offset:1024 lds
buffer_load_dwordx4 v8,s[4:7],s20 offen offset:2048 lds
ds_read_b128 a[136:139],v0 offset:12288
v_max3_f32 v40,v104,v105,v106
v_max_f32 v40,v40,v107
v_mov_b32 v41,v40
s_add_u32 s20,s20,12288
ds_read_b128 a[140:143],v1 offset:12288
v_permlane32_swap_b32 v41,v40
ds_read_b128 a[144:147],v0 offset:12416
v_max_f32 v40,v40,v41
ds_read_b128 a[148:151],v1 offset:12416
v_mov_b32 v41,v40
ds_read_b128 a[120:123],v0 offset:12544
s_mov_b32 s27,166723584
ds_read_b128 a[124:127],v1 offset:12544
v_permlane16_swap_b32 v41,v40
ds_read_b128 a[128:131],v0 offset:18432
v_max_f32 v40,v40,v41
ds_read_b128 a[132:135],v1 offset:18432
v_mul_f32_e64 v17,-s36,v40
v_fma_f32 v105,v105,s36,v17
v_fma_f32 v104,v104,s36,v17
v_exp_f32 v105,v105
v_fma_f32 v107,v107,s36,v17
v_fma_f32 v106,v106,s36,v17
v_exp_f32 v104,v104
v_exp_f32 v106,v106
v_exp_f32 v107,v107
v_cvt_pk_bf16_f32 v36,v104,v105
v_cvt_pk_bf16_f32 v37,v106,v107
s_waitcnt lgkmcnt(4)
v_mfma_f32_16x16x32_bf16 v[104:107],a[136:139],a[96:99],0
s_mov_b32 s42,s41
ds_read_b128 a[136:139],v0 offset:18560
v_fma_f32 v110,v110,s36,v17
v_mfma_f32_16x16x32_bf16 v[104:107],a[140:143],a[100:103],v[104:107]
s_add_u32 s69,s69,1
ds_read_b128 a[140:143],v1 offset:18560
v_fma_f32 v111,v111,s36,v17
v_mfma_f32_16x16x32_bf16 v[104:107],a[144:147],a[104:107],v[104:107]
s_lshl_b32 s62,s69,5
ds_read_b128 a[144:147],v0 offset:18688
v_exp_f32 v111,v111
v_mfma_f32_16x16x32_bf16 v[104:107],a[148:151],a[108:111],v[104:107]
s_add_u32 s62,s62,s34
ds_read_b128 a[148:151],v1 offset:18688
v_fma_f32 v109,v109,s36,v17
s_waitcnt lgkmcnt(4)
v_mfma_f32_16x16x32_bf16 v[104:107],a[120:123],a[112:115],v[104:107]
s_mul_i32 s63,s62,171
ds_read_b64_tr_b16 a[122:123],v2 offset:6144
v_exp_f32 v109,v109
v_mfma_f32_16x16x32_bf16 v[104:107],a[124:127],a[116:119],v[104:107]
s_lshr_b32 s63,s63,9
ds_read_b64_tr_b16 a[120:121],v2 offset:0
v_fma_f32 v108,v108,s36,v17
v_exp_f32 v110,v110
ds_read_b64_tr_b16 a[126:127],v3 offset:6144
ds_read_b64_tr_b16 a[124:125],v3 offset:0
v_exp_f32 v108,v108
v_cvt_pk_bf16_f32 v39,v110,v111
v_cvt_pk_bf16_f32 v38,v108,v109
v_mfma_f32_16x16x32_bf16 v[108:111],a[128:131],a[96:99],0
s_mul_i32 s64,s63,3
ds_read_b64_tr_b16 a[128:129],v4 offset:0
v_fma_f32 v107,v107,s36,v17
v_mfma_f32_16x16x32_bf16 v[108:111],a[132:135],a[100:103],v[108:111]
s_sub_u32 s62,s62,s64
ds_read_b64_tr_b16 a[130:131],v4 offset:6144
v_fma_f32 v106,v106,s36,v17
s_waitcnt lgkmcnt(6)
v_mfma_f32_16x16x32_bf16 v[108:111],a[136:139],a[104:107],v[108:111]
s_add_u32 s63,s63,s33
ds_read_b64_tr_b16 a[132:133],v5 offset:0
v_fma_f32 v105,v105,s36,v17
v_mfma_f32_16x16x32_bf16 v[108:111],a[140:143],a[108:111],v[108:111]
s_mul_i32 s30,s63,196608
ds_read_b64_tr_b16 a[134:135],v5 offset:6144
v_exp_f32 v107,v107
v_mfma_f32_16x16x32_bf16 v[108:111],a[144:147],a[112:115],v[108:111]
s_mul_i32 s41,s63,325632
ds_read_b64_tr_b16 a[146:147],v4 offset:6272
v_fma_f32 v104,v104,s36,v17
v_mfma_f32_16x16x32_bf16 v[108:111],a[148:151],a[116:119],v[108:111]
s_lshl_b32 s63,s3,2
ds_read_b64_tr_b16 a[144:145],v4 offset:128
v_exp_f32 v104,v104
s_waitcnt lgkmcnt(6)
v_mfma_f32_16x16x32_bf16 a[208:211],a[120:123],v[36:39],0
s_add_u32 s64,s63,21
ds_read_b64_tr_b16 a[120:121],v2 offset:256
v_exp_f32 v105,v105
v_mfma_f32_16x16x32_bf16 a[212:215],a[124:127],v[36:39],0
s_cmp_eq_u32 s3,0
ds_read_b64_tr_b16 a[148:149],v5 offset:128
v_exp_f32 v106,v106
s_waitcnt lgkmcnt(6)
v_mfma_f32_16x16x32_bf16 a[216:219],a[128:131],v[36:39],0
s_cselect_b32 s64,20,s64
ds_read_b64_tr_b16 a[128:129],v4 offset:256
ds_read_b64_tr_b16 a[138:139],v2 offset:6272
ds_read_b64_tr_b16 a[122:123],v2 offset:6400
ds_read_b64_tr_b16 a[136:137],v2 offset:128
ds_read_b64_tr_b16 a[142:143],v3 offset:6272
ds_read_b64_tr_b16 a[140:141],v3 offset:128
s_waitcnt lgkmcnt(10)
v_mfma_f32_16x16x32_bf16 a[220:223],a[132:135],v[36:39],0
s_cselect_b32 s40,1,0
ds_read_b64_tr_b16 a[130:131],v4 offset:6400
ds_read_b64_tr_b16 a[124:125],v3 offset:256
ds_read_b64_tr_b16 a[150:151],v5 offset:6272
ds_read_b64_tr_b16 a[134:135],v5 offset:6400
ds_read_b64_tr_b16 a[126:127],v3 offset:6400
ds_read_b64_tr_b16 a[132:133],v5 offset:256
s_waitcnt vmcnt(6)
v_cvt_pk_bf16_f32 v41,v106,v107
v_cvt_pk_bf16_f32 v40,v104,v105
v_fma_f32 v108,v108,s36,v17
v_fma_f32 v110,v110,s36,v17
v_fma_f32 v109,v109,s36,v17
v_fma_f32 v111,v111,s36,v17
v_exp_f32 v108,v108
v_exp_f32 v111,v111
v_exp_f32 v109,v109
s_waitcnt lgkmcnt(8)
v_mfma_f32_16x16x32_bf16 a[224:227],a[136:139],v[36:39],0
s_add_u32 s65,s63,37
v_exp_f32 v110,v110
s_waitcnt lgkmcnt(6)
v_mfma_f32_16x16x32_bf16 a[228:231],a[140:143],v[36:39],0
s_cmp_eq_u32 s62,2
v_cvt_pk_bf16_f32 v42,v108,v109
v_cvt_pk_bf16_f32 v43,v110,v111
v_mfma_f32_16x16x32_bf16 a[232:235],a[144:147],v[36:39],0
s_cselect_b32 s64,s65,s64
s_cselect_b32 s40,0,s40
s_add_u32 s65,s63,s3
v_smfmac_f32_16x16x64_bf16 v[68:71],a[152:155],v[36:43],v18
s_cmp_eq_u32 s62,0
s_cselect_b32 s64,s65,s64
s_cselect_b32 s40,1,s40
s_waitcnt lgkmcnt(0)
s_barrier
v_mfma_f32_16x16x32_bf16 a[236:239],a[148:151],v[36:39],0
s_mul_i32 s64,s64,6144
ds_read_b128 a[136:139],v0 offset:24576
s_add_u32 s41,s41,s64
v_mfma_f32_16x16x32_bf16 a[240:243],a[120:123],v[36:39],0
s_cmp_ge_u32 s69,6
ds_read_b128 a[140:143],v1 offset:24576
s_cselect_b32 s41,166723584,s41
v_mfma_f32_16x16x32_bf16 a[244:247],a[124:127],v[36:39],0
s_cselect_b32 s30,100663296,s30
ds_read_b128 a[144:147],v0 offset:24704
s_add_u32 s25,s30,s22
v_mfma_f32_16x16x32_bf16 a[248:251],a[128:131],v[36:39],0
s_add_u32 s26,s25,12288
ds_read_b128 a[148:151],v1 offset:24704
s_mov_b32 s28,s41
v_mfma_f32_16x16x32_bf16 a[252:255],a[132:135],v[36:39],0
s_mov_b32 s29,s24
ds_read_b128 a[120:123],v0 offset:24832
s_add_u32 m0,s23,0
ds_read_b128 a[124:127],v1 offset:24832
buffer_load_dwordx4 v6,s[8:11],s21 offen offset:0 lds
buffer_load_dwordx4 v7,s[8:11],s21 offen offset:1024 lds
buffer_load_dwordx4 v8,s[8:11],s21 offen offset:2048 lds
s_waitcnt lgkmcnt(5)
v_mfma_f32_16x16x32_bf16 v[104:107],a[136:139],a[96:99],0
s_add_u32 s21,s21,12288
ds_read_b128 a[128:131],v0 offset:30720
s_add_u32 m0,s22,12288
s_waitcnt lgkmcnt(5)
v_mfma_f32_16x16x32_bf16 v[104:107],a[140:143],a[100:103],v[104:107]
buffer_load_dwordx4 v6,s[4:7],s20 offen offset:0 lds
s_waitcnt lgkmcnt(4)
v_mfma_f32_16x16x32_bf16 v[104:107],a[144:147],a[104:107],v[104:107]
buffer_load_dwordx4 v7,s[4:7],s20 offen offset:1024 lds
s_waitcnt lgkmcnt(3)
v_mfma_f32_16x16x32_bf16 v[104:107],a[148:151],a[108:111],v[104:107]
buffer_load_dwordx4 v8,s[4:7],s20 offen offset:2048 lds
s_waitcnt lgkmcnt(1)
v_mfma_f32_16x16x32_bf16 v[104:107],a[120:123],a[112:115],v[104:107]
s_add_u32 s20,s20,12288
ds_read_b64_tr_b16 a[122:123],v2 offset:18432
ds_read_b128 a[132:135],v1 offset:30720
v_mfma_f32_16x16x32_bf16 v[104:107],a[124:127],a[116:119],v[104:107]
s_waitcnt lgkmcnt(2)
ds_read_b64_tr_b16 a[120:121],v2 offset:12288
ds_read_b128 a[136:139],v0 offset:30848
v_mfma_f32_16x16x32_bf16 v[108:111],a[128:131],a[96:99],0
ds_read_b64_tr_b16 a[124:125],v3 offset:12288
ds_read_b64_tr_b16 a[126:127],v3 offset:18432
ds_read_b128 a[140:143],v1 offset:30848
ds_read_b64_tr_b16 a[128:129],v4 offset:12288
ds_read_b64_tr_b16 a[130:131],v4 offset:18432
ds_read_b128 a[144:147],v0 offset:30976
ds_read_b128 a[148:151],v1 offset:30976
s_waitcnt lgkmcnt(9)
v_mfma_f32_16x16x32_bf16 v[108:111],a[132:135],a[100:103],v[108:111]
s_waitcnt lgkmcnt(7)
ds_read_b64_tr_b16 a[132:133],v5 offset:12288
ds_read_b64_tr_b16 a[134:135],v5 offset:18432
v_mfma_f32_16x16x32_bf16 v[108:111],a[136:139],a[104:107],v[108:111]
s_waitcnt lgkmcnt(6)
v_mfma_f32_16x16x32_bf16 v[108:111],a[140:143],a[108:111],v[108:111]
s_waitcnt lgkmcnt(3)
v_mfma_f32_16x16x32_bf16 v[108:111],a[144:147],a[112:115],v[108:111]
s_waitcnt lgkmcnt(2)
v_mfma_f32_16x16x32_bf16 v[108:111],a[148:151],a[116:119],v[108:111]
v_mfma_f32_16x16x32_bf16 v[160:163],a[120:123],v[44:47],v[160:163]
s_add_u32 m0,s23,12288
ds_read_b64_tr_b16 a[136:137],v2 offset:12416
v_fma_f32 v90,v90,s36,v15
v_mfma_f32_16x16x32_bf16 v[164:167],a[124:127],v[44:47],v[164:167]
ds_read_b64_tr_b16 a[138:139],v2 offset:18560
v_fma_f32 v91,v91,s36,v15
v_mfma_f32_16x16x32_bf16 v[212:215],a[124:127],v[48:51],v[212:215]
ds_read_b64_tr_b16 a[140:141],v3 offset:12416
v_fma_f32 v96,v96,s36,v16
v_mfma_f32_16x16x32_bf16 v[208:211],a[120:123],v[48:51],v[208:211]
ds_read_b64_tr_b16 a[142:143],v3 offset:18560
v_fma_f32 v97,v97,s36,v16
v_mfma_f32_16x16x32_bf16 v[112:115],a[120:123],v[52:55],v[112:115]
ds_read_b64_tr_b16 a[144:145],v4 offset:12416
v_fma_f32 v98,v98,s36,v16
v_mfma_f32_16x16x32_bf16 v[116:119],a[124:127],v[52:55],v[116:119]
ds_read_b64_tr_b16 a[146:147],v4 offset:18560
v_fma_f32 v99,v99,s36,v16
v_mfma_f32_16x16x32_bf16 a[164:167],a[124:127],v[56:59],a[164:167]
ds_read_b64_tr_b16 a[148:149],v5 offset:12416
v_fma_f32 v104,v104,s36,v17
v_mfma_f32_16x16x32_bf16 a[160:163],a[120:123],v[56:59],a[160:163]
ds_read_b64_tr_b16 a[150:151],v5 offset:18560
v_fma_f32 v105,v105,s36,v17
v_mfma_f32_16x16x32_bf16 a[208:211],a[120:123],v[40:43],a[208:211]
ds_read_b64_tr_b16 a[120:121],v2 offset:12544
v_fma_f32 v106,v106,s36,v17
v_mfma_f32_16x16x32_bf16 a[212:215],a[124:127],v[40:43],a[212:215]
ds_read_b64_tr_b16 a[122:123],v2 offset:18688
v_fma_f32 v107,v107,s36,v17
v_mfma_f32_16x16x32_bf16 a[216:219],a[128:131],v[40:43],a[216:219]
s_waitcnt lgkmcnt(6)
ds_read_b64_tr_b16 a[124:125],v3 offset:12544
v_fma_f32 v76,v76,s36,v13
v_mfma_f32_16x16x32_bf16 a[220:223],a[132:135],v[40:43],a[220:223]
ds_read_b64_tr_b16 a[126:127],v3 offset:18688
v_fma_f32 v77,v77,s36,v13
v_mfma_f32_16x16x32_bf16 a[172:175],a[132:135],v[56:59],a[172:175]
v_exp_f32 v90,v90
v_mfma_f32_16x16x32_bf16 a[168:171],a[128:131],v[56:59],a[168:171]
v_exp_f32 v91,v91
v_mfma_f32_16x16x32_bf16 v[120:123],a[128:131],v[52:55],v[120:123]
v_cvt_pk_bf16_f32 v29,v90,v91
v_fma_f32 v78,v78,s36,v13
v_mfma_f32_16x16x32_bf16 v[124:127],a[132:135],v[52:55],v[124:127]
v_exp_f32 v96,v96
v_mfma_f32_16x16x32_bf16 v[220:223],a[132:135],v[48:51],v[220:223]
v_exp_f32 v97,v97
v_mfma_f32_16x16x32_bf16 v[216:219],a[128:131],v[48:51],v[216:219]
v_exp_f32 v98,v98
v_mfma_f32_16x16x32_bf16 v[168:171],a[128:131],v[44:47],v[168:171]
ds_read_b64_tr_b16 a[128:129],v4 offset:12544
v_cvt_pk_bf16_f32 v32,v96,v97
v_mfma_f32_16x16x32_bf16 v[172:175],a[132:135],v[44:47],v[172:175]
ds_read_b64_tr_b16 a[130:131],v4 offset:18688
v_fma_f32 v79,v79,s36,v13
v_mfma_f32_16x16x32_bf16 v[176:179],a[136:139],v[44:47],v[176:179]
ds_read_b64_tr_b16 a[132:133],v5 offset:12544
v_fma_f32 v84,v84,s36,v14
v_mfma_f32_16x16x32_bf16 v[180:183],a[140:143],v[44:47],v[180:183]
ds_read_b64_tr_b16 a[134:135],v5 offset:18688
v_fma_f32 v85,v85,s36,v14
v_mfma_f32_16x16x32_bf16 v[228:231],a[140:143],v[48:51],v[228:231]
v_exp_f32 v99,v99
v_mfma_f32_16x16x32_bf16 v[224:227],a[136:139],v[48:51],v[224:227]
v_cvt_pk_bf16_f32 v33,v98,v99
v_fma_f32 v86,v86,s36,v14
v_mfma_f32_16x16x32_bf16 v[128:131],a[136:139],v[52:55],v[128:131]
v_exp_f32 v104,v104
v_mfma_f32_16x16x32_bf16 v[132:135],a[140:143],v[52:55],v[132:135]
v_exp_f32 v105,v105
v_mfma_f32_16x16x32_bf16 a[180:183],a[140:143],v[56:59],a[180:183]
v_exp_f32 v106,v106
v_mfma_f32_16x16x32_bf16 a[176:179],a[136:139],v[56:59],a[176:179]
v_exp_f32 v107,v107
v_mfma_f32_16x16x32_bf16 a[224:227],a[136:139],v[40:43],a[224:227]
v_cvt_pk_bf16_f32 v36,v104,v105
v_cvt_pk_bf16_f32 v37,v106,v107
v_mfma_f32_16x16x32_bf16 a[228:231],a[140:143],v[40:43],a[228:231]
s_waitcnt lgkmcnt(0)
v_exp_f32 v76,v76
v_mfma_f32_16x16x32_bf16 a[232:235],a[144:147],v[40:43],a[232:235]
v_exp_f32 v77,v77
v_mfma_f32_16x16x32_bf16 a[236:239],a[148:151],v[40:43],a[236:239]
v_exp_f32 v78,v78
v_mfma_f32_16x16x32_bf16 a[188:191],a[148:151],v[56:59],a[188:191]
v_exp_f32 v79,v79
v_mfma_f32_16x16x32_bf16 a[184:187],a[144:147],v[56:59],a[184:187]
v_cvt_pk_bf16_f32 v22,v76,v77
v_cvt_pk_bf16_f32 v23,v78,v79
v_mfma_f32_16x16x32_bf16 v[136:139],a[144:147],v[52:55],v[136:139]
v_fma_f32 v87,v87,s36,v14
v_fma_f32 v92,v92,s36,v15
v_mfma_f32_16x16x32_bf16 v[140:143],a[148:151],v[52:55],v[140:143]
v_exp_f32 v84,v84
v_mfma_f32_16x16x32_bf16 v[236:239],a[148:151],v[48:51],v[236:239]
v_exp_f32 v85,v85
v_mfma_f32_16x16x32_bf16 v[232:235],a[144:147],v[48:51],v[232:235]
v_exp_f32 v86,v86
v_mfma_f32_16x16x32_bf16 v[184:187],a[144:147],v[44:47],v[184:187]
v_exp_f32 v87,v87
v_mfma_f32_16x16x32_bf16 v[188:191],a[148:151],v[44:47],v[188:191]
v_cvt_pk_bf16_f32 v26,v84,v85
v_cvt_pk_bf16_f32 v27,v86,v87
v_mfma_f32_16x16x32_bf16 v[192:195],a[120:123],v[44:47],v[192:195]
s_waitcnt vmcnt(6)
v_fma_f32 v93,v93,s36,v15
v_fma_f32 v94,v94,s36,v15
v_smfmac_f32_16x16x64_bf16 v[60:63],a[152:155],v[20:27],v18
s_barrier
v_mfma_f32_16x16x32_bf16 v[196:199],a[124:127],v[44:47],v[196:199]
ds_read_b128 a[136:139],v0 offset:0
v_fma_f32 v95,v95,s36,v15
v_mfma_f32_16x16x32_bf16 v[244:247],a[124:127],v[48:51],v[244:247]
ds_read_b128 a[140:143],v1 offset:0
v_fma_f32 v100,v100,s36,v16
v_mfma_f32_16x16x32_bf16 v[240:243],a[120:123],v[48:51],v[240:243]
ds_read_b128 a[144:147],v0 offset:128
v_fma_f32 v101,v101,s36,v16
v_mfma_f32_16x16x32_bf16 v[144:147],a[120:123],v[52:55],v[144:147]
ds_read_b128 a[148:151],v1 offset:128
v_fma_f32 v102,v102,s36,v16
v_mfma_f32_16x16x32_bf16 v[148:151],a[124:127],v[52:55],v[148:151]
v_exp_f32 v92,v92
v_mfma_f32_16x16x32_bf16 a[196:199],a[124:127],v[56:59],a[196:199]
buffer_load_dwordx4 v6,s[8:11],s21 offen offset:0 lds
v_mfma_f32_16x16x32_bf16 a[192:195],a[120:123],v[56:59],a[192:195]
v_exp_f32 v93,v93
v_mfma_f32_16x16x32_bf16 a[240:243],a[120:123],v[40:43],a[240:243]
ds_read_b128 a[120:123],v0 offset:256
v_cvt_pk_bf16_f32 v30,v92,v93
v_mfma_f32_16x16x32_bf16 a[244:247],a[124:127],v[40:43],a[244:247]
ds_read_b128 a[124:127],v1 offset:256
v_fma_f32 v103,v103,s36,v16
v_mfma_f32_16x16x32_bf16 a[248:251],a[128:131],v[40:43],a[248:251]
v_exp_f32 v94,v94
v_mfma_f32_16x16x32_bf16 a[252:255],a[132:135],v[40:43],a[252:255]
v_exp_f32 v95,v95
v_mfma_f32_16x16x32_bf16 a[204:207],a[132:135],v[56:59],a[204:207]
v_cvt_pk_bf16_f32 v31,v94,v95
v_fma_f32 v108,v108,s36,v17
v_mfma_f32_16x16x32_bf16 a[200:203],a[128:131],v[56:59],a[200:203]
v_exp_f32 v100,v100
v_mfma_f32_16x16x32_bf16 v[152:155],a[128:131],v[52:55],v[152:155]
v_exp_f32 v101,v101
v_mfma_f32_16x16x32_bf16 v[156:159],a[132:135],v[52:55],v[156:159]
v_exp_f32 v102,v102
v_mfma_f32_16x16x32_bf16 v[252:255],a[132:135],v[48:51],v[252:255]
v_exp_f32 v103,v103
v_mfma_f32_16x16x32_bf16 v[248:251],a[128:131],v[48:51],v[248:251]
buffer_load_dwordx4 v7,s[8:11],s21 offen offset:1024 lds
v_mfma_f32_16x16x32_bf16 v[200:203],a[128:131],v[44:47],v[200:203]
ds_read_b128 a[128:131],v0 offset:6144
v_cvt_pk_bf16_f32 v34,v100,v101
v_mfma_f32_16x16x32_bf16 v[204:207],a[132:135],v[44:47],v[204:207]
s_waitcnt lgkmcnt(1)
ds_read_b128 a[132:135],v1 offset:6144
v_cvt_pk_bf16_f32 v35,v102,v103
v_mfma_f32_16x16x32_bf16 v[72:75],a[136:139],a[0:3],0
v_fma_f32 v109,v109,s36,v17
v_fma_f32 v110,v110,s36,v17
v_smfmac_f32_16x16x64_bf16 v[64:67],a[152:155],v[28:35],v18
v_fma_f32 v111,v111,s36,v17
v_mfma_f32_16x16x32_bf16 v[72:75],a[140:143],a[4:7],v[72:75]
v_exp_f32 v108,v108
v_mfma_f32_16x16x32_bf16 v[72:75],a[144:147],a[8:11],v[72:75]
v_exp_f32 v109,v109
v_mfma_f32_16x16x32_bf16 v[72:75],a[148:151],a[12:15],v[72:75]
v_exp_f32 v110,v110
v_mfma_f32_16x16x32_bf16 v[72:75],a[120:123],a[16:19],v[72:75]
v_exp_f32 v111,v111
v_mfma_f32_16x16x32_bf16 v[72:75],a[124:127],a[20:23],v[72:75]
v_cvt_pk_bf16_f32 v38,v108,v109
v_cvt_pk_bf16_f32 v39,v110,v111
v_mfma_f32_16x16x32_bf16 v[80:83],a[124:127],a[44:47],0
v_mfma_f32_16x16x32_bf16 v[80:83],a[120:123],a[40:43],v[80:83]
v_mfma_f32_16x16x32_bf16 v[80:83],a[148:151],a[36:39],v[80:83]
buffer_load_dwordx4 v8,s[8:11],s21 offen offset:2048 lds
v_mfma_f32_16x16x32_bf16 v[80:83],a[144:147],a[32:35],v[80:83]
s_add_u32 s21,s21,12288
v_fma_f32 v72,v72,s36,v13
v_fma_f32 v73,v73,s36,v13
v_mfma_f32_16x16x32_bf16 v[80:83],a[140:143],a[28:31],v[80:83]
s_add_u32 m0,s22,24576
v_fma_f32 v74,v74,s36,v13
v_fma_f32 v75,v75,s36,v13
v_mfma_f32_16x16x32_bf16 v[80:83],a[136:139],a[24:27],v[80:83]
v_exp_f32 v72,v72
v_mfma_f32_16x16x32_bf16 v[88:91],a[136:139],a[48:51],0
v_exp_f32 v73,v73
v_mfma_f32_16x16x32_bf16 v[88:91],a[140:143],a[52:55],v[88:91]
v_exp_f32 v74,v74
v_mfma_f32_16x16x32_bf16 v[88:91],a[144:147],a[56:59],v[88:91]
v_exp_f32 v75,v75
v_mfma_f32_16x16x32_bf16 v[88:91],a[148:151],a[60:63],v[88:91]
v_fma_f32 v80,v80,s36,v14
v_fma_f32 v81,v81,s36,v14
v_mfma_f32_16x16x32_bf16 v[88:91],a[120:123],a[64:67],v[88:91]
v_fma_f32 v82,v82,s36,v14
v_fma_f32 v83,v83,s36,v14
v_mfma_f32_16x16x32_bf16 v[88:91],a[124:127],a[68:71],v[88:91]
v_exp_f32 v80,v80
v_mfma_f32_16x16x32_bf16 v[96:99],a[124:127],a[92:95],0
v_exp_f32 v81,v81
v_mfma_f32_16x16x32_bf16 v[96:99],a[120:123],a[88:91],v[96:99]
v_exp_f32 v82,v82
v_mfma_f32_16x16x32_bf16 v[96:99],a[148:151],a[84:87],v[96:99]
buffer_load_dwordx4 v6,s[4:7],s20 offen offset:0 lds
v_mfma_f32_16x16x32_bf16 v[96:99],a[144:147],a[80:83],v[96:99]
v_fma_f32 v88,v88,s36,v15
v_fma_f32 v89,v89,s36,v15
v_mfma_f32_16x16x32_bf16 v[96:99],a[140:143],a[76:79],v[96:99]
v_exp_f32 v83,v83
v_mfma_f32_16x16x32_bf16 v[96:99],a[136:139],a[72:75],v[96:99]
v_exp_f32 v88,v88
v_mfma_f32_16x16x32_bf16 v[104:107],a[136:139],a[96:99],0
ds_read_b128 a[136:139],v0 offset:6272
v_cvt_pk_bf16_f32 v44,v72,v73
v_mfma_f32_16x16x32_bf16 v[104:107],a[140:143],a[100:103],v[104:107]
ds_read_b128 a[140:143],v1 offset:6272
v_cvt_pk_bf16_f32 v45,v74,v75
v_mfma_f32_16x16x32_bf16 v[104:107],a[144:147],a[104:107],v[104:107]
ds_read_b128 a[144:147],v0 offset:6400
v_cvt_pk_bf16_f32 v48,v80,v81
v_mfma_f32_16x16x32_bf16 v[104:107],a[148:151],a[108:111],v[104:107]
ds_read_b128 a[148:151],v1 offset:6400
v_cvt_pk_bf16_f32 v49,v82,v83
v_mfma_f32_16x16x32_bf16 v[104:107],a[120:123],a[112:115],v[104:107]
v_exp_f32 v89,v89
v_mfma_f32_16x16x32_bf16 v[104:107],a[124:127],a[116:119],v[104:107]
s_waitcnt lgkmcnt(4)
v_cvt_pk_bf16_f32 v52,v88,v89
v_mfma_f32_16x16x32_bf16 v[76:79],a[128:131],a[0:3],0
v_mfma_f32_16x16x32_bf16 v[76:79],a[132:135],a[4:7],v[76:79]
buffer_load_dwordx4 v7,s[4:7],s20 offen offset:1024 lds
s_waitcnt lgkmcnt(3)
v_mfma_f32_16x16x32_bf16 v[76:79],a[136:139],a[8:11],v[76:79]
s_waitcnt lgkmcnt(2)
v_mfma_f32_16x16x32_bf16 v[76:79],a[140:143],a[12:15],v[76:79]
s_waitcnt lgkmcnt(1)
v_mfma_f32_16x16x32_bf16 v[76:79],a[144:147],a[16:19],v[76:79]
s_waitcnt lgkmcnt(0)
v_mfma_f32_16x16x32_bf16 v[76:79],a[148:151],a[20:23],v[76:79]
v_mfma_f32_16x16x32_bf16 v[84:87],a[148:151],a[44:47],0
v_mfma_f32_16x16x32_bf16 v[84:87],a[144:147],a[40:43],v[84:87]
v_mfma_f32_16x16x32_bf16 v[84:87],a[140:143],a[36:39],v[84:87]
v_mfma_f32_16x16x32_bf16 v[84:87],a[136:139],a[32:35],v[84:87]
v_mfma_f32_16x16x32_bf16 v[84:87],a[132:135],a[28:31],v[84:87]
v_mfma_f32_16x16x32_bf16 v[84:87],a[128:131],a[24:27],v[84:87]
v_mfma_f32_16x16x32_bf16 v[92:95],a[128:131],a[48:51],0
v_mfma_f32_16x16x32_bf16 v[92:95],a[132:135],a[52:55],v[92:95]
buffer_load_dwordx4 v8,s[4:7],s20 offen offset:2048 lds
v_mfma_f32_16x16x32_bf16 v[92:95],a[136:139],a[56:59],v[92:95]
s_add_u32 s20,s20,12288
v_mfma_f32_16x16x32_bf16 v[92:95],a[140:143],a[60:63],v[92:95]
v_mfma_f32_16x16x32_bf16 v[92:95],a[144:147],a[64:67],v[92:95]
v_mfma_f32_16x16x32_bf16 v[92:95],a[148:151],a[68:71],v[92:95]
v_mfma_f32_16x16x32_bf16 v[100:103],a[148:151],a[92:95],0
v_mfma_f32_16x16x32_bf16 v[100:103],a[144:147],a[88:91],v[100:103]
ds_read_b64_tr_b16 a[120:121],v2 offset:24576
v_mfma_f32_16x16x32_bf16 v[100:103],a[140:143],a[84:87],v[100:103]
ds_read_b64_tr_b16 a[122:123],v2 offset:30720
v_mfma_f32_16x16x32_bf16 v[100:103],a[136:139],a[80:83],v[100:103]
ds_read_b64_tr_b16 a[124:125],v3 offset:24576
v_mfma_f32_16x16x32_bf16 v[100:103],a[132:135],a[76:79],v[100:103]
ds_read_b64_tr_b16 a[126:127],v3 offset:30720
v_mfma_f32_16x16x32_bf16 v[100:103],a[128:131],a[72:75],v[100:103]
v_mfma_f32_16x16x32_bf16 v[108:111],a[128:131],a[96:99],0
ds_read_b64_tr_b16 a[128:129],v4 offset:24576
v_mfma_f32_16x16x32_bf16 v[108:111],a[132:135],a[100:103],v[108:111]
ds_read_b64_tr_b16 a[130:131],v4 offset:30720
v_mfma_f32_16x16x32_bf16 v[108:111],a[136:139],a[104:107],v[108:111]
ds_read_b64_tr_b16 a[132:133],v5 offset:24576
v_mfma_f32_16x16x32_bf16 v[108:111],a[140:143],a[108:111],v[108:111]
ds_read_b64_tr_b16 a[134:135],v5 offset:30720
v_mfma_f32_16x16x32_bf16 v[108:111],a[144:147],a[112:115],v[108:111]
v_mfma_f32_16x16x32_bf16 v[108:111],a[148:151],a[116:119],v[108:111]
s_mov_b32 s38,0
s_branch L_loop5
L_start4:
s_add_u32 m0,s24,12288
s_waitcnt vmcnt(15)
ds_read_b128 a[8:11],v11 offset:128
buffer_load_dwordx4 v6,s[12:15],s28 offen offset:0 nt lds
ds_read_b128 a[0:3],v11 offset:0
buffer_load_dwordx4 v7,s[12:15],s28 offen offset:1024 nt lds
ds_read_b128 a[4:7],v12 offset:0
buffer_load_dwordx4 v8,s[12:15],s28 offen offset:2048 nt lds
s_add_u32 s28,s28,3072
s_add_u32 m0,s24,15360
ds_read_b128 a[12:15],v12 offset:128
buffer_load_dwordx4 v6,s[12:15],s28 offen offset:0 nt lds
ds_read_b128 a[16:19],v11 offset:256
buffer_load_dwordx4 v7,s[12:15],s28 offen offset:1024 nt lds
ds_read_b128 a[20:23],v12 offset:256
buffer_load_dwordx4 v8,s[12:15],s28 offen offset:2048 nt lds
s_add_u32 s28,s28,3072
s_add_u32 m0,s24,0
ds_read_b128 a[120:123],v0 offset:0
v_pk_mov_b32 v[66:67],0,0
v_pk_mov_b32 v[62:63],0,0
v_pk_mov_b32 v[60:61],0,0
v_pk_mov_b32 v[64:65],0,0
ds_read_b128 a[124:127],v1 offset:0
ds_read_b128 a[132:135],v1 offset:128
ds_read_b128 a[128:131],v0 offset:128
ds_read_b128 a[136:139],v0 offset:256
ds_read_b128 a[144:147],v0 offset:6144
ds_read_b128 a[140:143],v1 offset:256
s_waitcnt lgkmcnt(6)
v_mfma_f32_16x16x32_bf16 v[72:75],a[120:123],a[0:3],0
s_waitcnt lgkmcnt(5)
ds_read_b128 a[148:151],v1 offset:6144
ds_read_b128 a[120:123],v0 offset:6272
v_mfma_f32_16x16x32_bf16 v[72:75],a[124:127],a[4:7],v[72:75]
s_waitcnt lgkmcnt(5)
ds_read_b128 a[124:127],v1 offset:6272
v_mfma_f32_16x16x32_bf16 v[72:75],a[128:131],a[8:11],v[72:75]
ds_read_b128 a[128:131],v0 offset:6400
v_mfma_f32_16x16x32_bf16 v[72:75],a[132:135],a[12:15],v[72:75]
s_waitcnt lgkmcnt(6)
ds_read_b128 a[132:135],v1 offset:6400
v_mfma_f32_16x16x32_bf16 v[72:75],a[136:139],a[16:19],v[72:75]
s_waitcnt lgkmcnt(5)
ds_read_b128 a[136:139],v0 offset:12288
v_mfma_f32_16x16x32_bf16 v[72:75],a[140:143],a[20:23],v[72:75]
ds_read_b128 a[140:143],v1 offset:12288
v_mfma_f32_16x16x32_bf16 v[76:79],a[144:147],a[0:3],0
s_waitcnt lgkmcnt(6)
ds_read_b128 a[144:147],v0 offset:12416
v_mfma_f32_16x16x32_bf16 v[76:79],a[148:151],a[4:7],v[76:79]
s_waitcnt lgkmcnt(6)
ds_read_b128 a[148:151],v1 offset:12416
v_mfma_f32_16x16x32_bf16 v[76:79],a[120:123],a[8:11],v[76:79]
s_waitcnt lgkmcnt(6)
ds_read_b128 a[120:123],v0 offset:12544
v_mfma_f32_16x16x32_bf16 v[76:79],a[124:127],a[12:15],v[76:79]
s_waitcnt lgkmcnt(6)
ds_read_b128 a[124:127],v1 offset:12544
v_max3_f32 v44,v72,v73,v74
v_mfma_f32_16x16x32_bf16 v[76:79],a[128:131],a[16:19],v[76:79]
s_waitcnt lgkmcnt(6)
ds_read_b128 a[128:131],v0 offset:18432
v_max_f32 v44,v44,v75
v_mfma_f32_16x16x32_bf16 v[76:79],a[132:135],a[20:23],v[76:79]
ds_read_b128 a[132:135],v1 offset:18432
v_mov_b32 v45,v44
s_nop 1
v_permlane32_swap_b32 v45,v44
v_max_f32 v44,v44,v45
v_mov_b32 v45,v44
s_nop 1
v_permlane16_swap_b32 v45,v44
v_max_f32 v44,v44,v45
v_mul_f32_e64 v13,-s36,v44
v_fma_f32 v75,v75,s36,v13
v_fma_f32 v72,v72,s36,v13
v_exp_f32 v75,v75
v_fma_f32 v73,v73,s36,v13
v_exp_f32 v73,v73
v_fma_f32 v74,v74,s36,v13
v_exp_f32 v74,v74
v_exp_f32 v72,v72
v_cvt_pk_bf16_f32 v21,v74,v75
v_cvt_pk_bf16_f32 v20,v72,v73
s_waitcnt lgkmcnt(1)
v_mfma_f32_16x16x32_bf16 v[72:75],a[136:139],a[0:3],0
ds_read_b128 a[136:139],v0 offset:18560
v_fma_f32 v77,v77,s36,v13
v_mfma_f32_16x16x32_bf16 v[72:75],a[140:143],a[4:7],v[72:75]
ds_read_b128 a[140:143],v1 offset:18560
v_fma_f32 v78,v78,s36,v13
v_mfma_f32_16x16x32_bf16 v[72:75],a[144:147],a[8:11],v[72:75]
ds_read_b128 a[144:147],v0 offset:18688
v_exp_f32 v78,v78
v_mfma_f32_16x16x32_bf16 v[72:75],a[148:151],a[12:15],v[72:75]
ds_read_b128 a[148:151],v1 offset:18688
v_fma_f32 v76,v76,s36,v13
v_mfma_f32_16x16x32_bf16 v[72:75],a[120:123],a[16:19],v[72:75]
v_exp_f32 v76,v76
v_mfma_f32_16x16x32_bf16 v[72:75],a[124:127],a[20:23],v[72:75]
v_fma_f32 v79,v79,s36,v13
v_exp_f32 v79,v79
v_exp_f32 v77,v77
v_cvt_pk_bf16_f32 v23,v78,v79
v_cvt_pk_bf16_f32 v22,v76,v77
v_mfma_f32_16x16x32_bf16 v[76:79],a[128:131],a[0:3],0
s_waitcnt lgkmcnt(3)
v_mfma_f32_16x16x32_bf16 v[76:79],a[132:135],a[4:7],v[76:79]
v_mfma_f32_16x16x32_bf16 v[76:79],a[136:139],a[8:11],v[76:79]
s_waitcnt lgkmcnt(1)
v_fma_f32 v74,v74,s36,v13
v_fma_f32 v75,v75,s36,v13
v_mfma_f32_16x16x32_bf16 v[76:79],a[140:143],a[12:15],v[76:79]
v_exp_f32 v75,v75
v_mfma_f32_16x16x32_bf16 v[76:79],a[144:147],a[16:19],v[76:79]
s_waitcnt lgkmcnt(0)
v_fma_f32 v72,v72,s36,v13
v_fma_f32 v73,v73,s36,v13
v_mfma_f32_16x16x32_bf16 v[76:79],a[148:151],a[20:23],v[76:79]
s_waitcnt vmcnt(12)
s_barrier
ds_read_b64_tr_b16 a[122:123],v2 offset:6144
v_exp_f32 v73,v73
v_exp_f32 v72,v72
v_exp_f32 v74,v74
ds_read_b64_tr_b16 a[124:125],v3 offset:0
ds_read_b64_tr_b16 a[126:127],v3 offset:6144
ds_read_b64_tr_b16 a[120:121],v2 offset:0
ds_read_b64_tr_b16 a[128:129],v4 offset:0
ds_read_b64_tr_b16 a[134:135],v5 offset:6144
ds_read_b64_tr_b16 a[132:133],v5 offset:0
ds_read_b64_tr_b16 a[140:141],v3 offset:128
ds_read_b64_tr_b16 a[142:143],v3 offset:6272
ds_read_b64_tr_b16 a[130:131],v4 offset:6144
ds_read_b64_tr_b16 a[136:137],v2 offset:128
ds_read_b64_tr_b16 a[138:139],v2 offset:6272
ds_read_b64_tr_b16 a[144:145],v4 offset:128
ds_read_b64_tr_b16 a[150:151],v5 offset:6272
ds_read_b64_tr_b16 a[148:149],v5 offset:128
ds_read_b64_tr_b16 a[146:147],v4 offset:6272
v_cvt_pk_bf16_f32 v45,v74,v75
v_cvt_pk_bf16_f32 v44,v72,v73
v_fma_f32 v79,v79,s36,v13
v_fma_f32 v78,v78,s36,v13
v_fma_f32 v77,v77,s36,v13
s_waitcnt lgkmcnt(12)
v_mfma_f32_16x16x32_bf16 v[160:163],a[120:123],v[20:23],0
ds_read_b64_tr_b16 a[122:123],v2 offset:6400
v_exp_f32 v77,v77
v_mfma_f32_16x16x32_bf16 v[164:167],a[124:127],v[20:23],0
s_waitcnt lgkmcnt(7)
ds_read_b64_tr_b16 a[126:127],v3 offset:6400
v_exp_f32 v78,v78
v_exp_f32 v79,v79
v_mfma_f32_16x16x32_bf16 v[168:171],a[128:131],v[20:23],0
ds_read_b64_tr_b16 a[130:131],v4 offset:6400
v_fma_f32 v76,v76,s36,v13
v_mfma_f32_16x16x32_bf16 v[172:175],a[132:135],v[20:23],0
s_waitcnt lgkmcnt(4)
ds_read_b64_tr_b16 a[124:125],v3 offset:256
v_exp_f32 v76,v76
v_mfma_f32_16x16x32_bf16 v[176:179],a[136:139],v[20:23],0
ds_read_b64_tr_b16 a[120:121],v2 offset:256
v_cvt_pk_bf16_f32 v47,v78,v79
v_mfma_f32_16x16x32_bf16 v[180:183],a[140:143],v[20:23],0
s_waitcnt lgkmcnt(5)
ds_read_b64_tr_b16 a[134:135],v5 offset:6400
v_cvt_pk_bf16_f32 v46,v76,v77
v_mfma_f32_16x16x32_bf16 v[184:187],a[144:147],v[20:23],0
ds_read_b128 a[140:143],v1 offset:24576
v_mfma_f32_16x16x32_bf16 v[188:191],a[148:151],v[20:23],0
ds_read_b64_tr_b16 a[128:129],v4 offset:256
ds_read_b64_tr_b16 a[132:133],v5 offset:256
ds_read_b128 a[136:139],v0 offset:24576
ds_read_b128 a[148:151],v1 offset:24704
ds_read_b128 a[144:147],v0 offset:24704
s_waitcnt lgkmcnt(7)
v_mfma_f32_16x16x32_bf16 v[192:195],a[120:123],v[20:23],0
ds_read_b128 a[120:123],v0 offset:24832
v_mfma_f32_16x16x32_bf16 v[196:199],a[124:127],v[20:23],0
s_waitcnt lgkmcnt(5)
ds_read_b128 a[124:127],v1 offset:24832
v_mfma_f32_16x16x32_bf16 v[200:203],a[128:131],v[20:23],0
s_waitcnt lgkmcnt(5)
ds_read_b128 a[128:131],v0 offset:30720
v_mfma_f32_16x16x32_bf16 v[204:207],a[132:135],v[20:23],0
s_waitcnt lgkmcnt(5)
ds_read_b128 a[132:135],v1 offset:30720
v_mfma_f32_16x16x32_bf16 v[72:75],a[136:139],a[0:3],0
ds_read_b128 a[136:139],v0 offset:30848
v_mfma_f32_16x16x32_bf16 v[72:75],a[140:143],a[4:7],v[72:75]
s_waitcnt lgkmcnt(5)
ds_read_b128 a[140:143],v1 offset:30848
v_mfma_f32_16x16x32_bf16 v[72:75],a[144:147],a[8:11],v[72:75]
ds_read_b128 a[144:147],v0 offset:30976
v_mfma_f32_16x16x32_bf16 v[72:75],a[148:151],a[12:15],v[72:75]
s_waitcnt lgkmcnt(6)
ds_read_b128 a[148:151],v1 offset:30976
v_mfma_f32_16x16x32_bf16 v[72:75],a[120:123],a[16:19],v[72:75]
s_waitcnt lgkmcnt(6)
ds_read_b128 a[120:123],v0 offset:0
v_mfma_f32_16x16x32_bf16 v[72:75],a[124:127],a[20:23],v[72:75]
s_waitcnt lgkmcnt(6)
ds_read_b128 a[124:127],v1 offset:0
v_mfma_f32_16x16x32_bf16 v[76:79],a[128:131],a[0:3],0
s_waitcnt lgkmcnt(6)
ds_read_b128 a[128:131],v0 offset:128
v_mfma_f32_16x16x32_bf16 v[76:79],a[132:135],a[4:7],v[76:79]
s_waitcnt lgkmcnt(6)
ds_read_b128 a[132:135],v1 offset:128
v_mfma_f32_16x16x32_bf16 v[76:79],a[136:139],a[8:11],v[76:79]
s_waitcnt lgkmcnt(6)
ds_read_b128 a[136:139],v0 offset:256
v_mfma_f32_16x16x32_bf16 v[76:79],a[140:143],a[12:15],v[76:79]
s_waitcnt lgkmcnt(6)
ds_read_b128 a[140:143],v1 offset:256
v_fma_f32 v75,v75,s36,v13
v_mfma_f32_16x16x32_bf16 v[76:79],a[144:147],a[16:19],v[76:79]
s_waitcnt lgkmcnt(6)
ds_read_b128 a[144:147],v0 offset:6144
v_exp_f32 v75,v75
v_mfma_f32_16x16x32_bf16 v[76:79],a[148:151],a[20:23],v[76:79]
s_waitcnt vmcnt(6)
ds_read_b128 a[24:27],v11 offset:6144
buffer_load_dwordx4 v6,s[12:15],s28 offen offset:0 nt lds
ds_read_b128 a[28:31],v12 offset:6144
buffer_load_dwordx4 v7,s[12:15],s28 offen offset:1024 nt lds
ds_read_b128 a[32:35],v11 offset:6272
buffer_load_dwordx4 v8,s[12:15],s28 offen offset:2048 nt lds
s_add_u32 s28,s28,3072
s_add_u32 m0,s24,3072
ds_read_b128 a[36:39],v12 offset:6272
buffer_load_dwordx4 v6,s[12:15],s28 offen offset:0 nt lds
ds_read_b128 a[40:43],v11 offset:6400
buffer_load_dwordx4 v7,s[12:15],s28 offen offset:1024 nt lds
ds_read_b128 a[44:47],v12 offset:6400
buffer_load_dwordx4 v8,s[12:15],s28 offen offset:2048 nt lds
s_add_u32 s28,s28,3072
s_add_u32 m0,s23,12288
ds_read_b128 a[148:151],v1 offset:6144
v_fma_f32 v74,v74,s36,v13
s_waitcnt lgkmcnt(6)
v_mfma_f32_16x16x32_bf16 v[80:83],a[120:123],a[24:27],0
s_waitcnt lgkmcnt(5)
ds_read_b128 a[120:123],v0 offset:6272
v_fma_f32 v72,v72,s36,v13
v_mfma_f32_16x16x32_bf16 v[80:83],a[124:127],a[28:31],v[80:83]
s_waitcnt lgkmcnt(5)
ds_read_b128 a[124:127],v1 offset:6272
v_exp_f32 v72,v72
v_mfma_f32_16x16x32_bf16 v[80:83],a[128:131],a[32:35],v[80:83]
s_waitcnt lgkmcnt(5)
ds_read_b128 a[128:131],v0 offset:6400
v_exp_f32 v74,v74
v_mfma_f32_16x16x32_bf16 v[80:83],a[132:135],a[36:39],v[80:83]
s_waitcnt lgkmcnt(4)
ds_read_b128 a[132:135],v1 offset:6400
v_fma_f32 v73,v73,s36,v13
v_mfma_f32_16x16x32_bf16 v[80:83],a[136:139],a[40:43],v[80:83]
ds_read_b128 a[136:139],v0 offset:12288
v_exp_f32 v73,v73
v_mfma_f32_16x16x32_bf16 v[80:83],a[140:143],a[44:47],v[80:83]
ds_read_b128 a[140:143],v1 offset:12288
v_mfma_f32_16x16x32_bf16 v[84:87],a[144:147],a[24:27],0
s_waitcnt lgkmcnt(5)
ds_read_b128 a[144:147],v0 offset:12416
v_mfma_f32_16x16x32_bf16 v[84:87],a[148:151],a[28:31],v[84:87]
ds_read_b128 a[148:151],v1 offset:12416
v_mfma_f32_16x16x32_bf16 v[84:87],a[120:123],a[32:35],v[84:87]
s_waitcnt lgkmcnt(5)
ds_read_b128 a[120:123],v0 offset:12544
v_mfma_f32_16x16x32_bf16 v[84:87],a[124:127],a[36:39],v[84:87]
ds_read_b128 a[124:127],v1 offset:12544
v_max3_f32 v48,v80,v81,v82
v_mfma_f32_16x16x32_bf16 v[84:87],a[128:131],a[40:43],v[84:87]
s_waitcnt lgkmcnt(6)
ds_read_b128 a[128:131],v0 offset:18432
v_max_f32 v48,v48,v83
v_mfma_f32_16x16x32_bf16 v[84:87],a[132:135],a[44:47],v[84:87]
ds_read_b128 a[132:135],v1 offset:18432
v_mov_b32 v49,v48
s_nop 1
v_permlane32_swap_b32 v49,v48
v_max_f32 v48,v48,v49
v_mov_b32 v49,v48
s_nop 1
v_permlane16_swap_b32 v49,v48
v_max_f32 v48,v48,v49
v_mul_f32_e64 v14,-s36,v48
v_fma_f32 v80,v80,s36,v14
v_exp_f32 v80,v80
v_fma_f32 v83,v83,s36,v14
v_fma_f32 v82,v82,s36,v14
v_fma_f32 v81,v81,s36,v14
v_exp_f32 v81,v81
v_exp_f32 v83,v83
v_exp_f32 v82,v82
v_cvt_pk_bf16_f32 v24,v80,v81
v_cvt_pk_bf16_f32 v25,v82,v83
s_waitcnt lgkmcnt(1)
v_mfma_f32_16x16x32_bf16 v[80:83],a[136:139],a[24:27],0
ds_read_b128 a[136:139],v0 offset:18560
v_fma_f32 v85,v85,s36,v14
v_mfma_f32_16x16x32_bf16 v[80:83],a[140:143],a[28:31],v[80:83]
ds_read_b128 a[140:143],v1 offset:18560
v_fma_f32 v84,v84,s36,v14
v_mfma_f32_16x16x32_bf16 v[80:83],a[144:147],a[32:35],v[80:83]
ds_read_b128 a[144:147],v0 offset:18688
v_exp_f32 v84,v84
v_mfma_f32_16x16x32_bf16 v[80:83],a[148:151],a[36:39],v[80:83]
ds_read_b128 a[148:151],v1 offset:18688
v_exp_f32 v85,v85
v_mfma_f32_16x16x32_bf16 v[80:83],a[120:123],a[40:43],v[80:83]
ds_read_b64_tr_b16 a[120:121],v2 offset:0
v_fma_f32 v87,v87,s36,v14
v_mfma_f32_16x16x32_bf16 v[80:83],a[124:127],a[44:47],v[80:83]
ds_read_b64_tr_b16 a[124:125],v3 offset:0
v_exp_f32 v87,v87
ds_read_b64_tr_b16 a[122:123],v2 offset:6144
v_fma_f32 v86,v86,s36,v14
ds_read_b64_tr_b16 a[126:127],v3 offset:6144
v_exp_f32 v86,v86
v_cvt_pk_bf16_f32 v26,v84,v85
v_cvt_pk_bf16_f32 v27,v86,v87
v_mfma_f32_16x16x32_bf16 v[84:87],a[128:131],a[24:27],0
ds_read_b64_tr_b16 a[128:129],v4 offset:0
v_fma_f32 v83,v83,s36,v14
v_smfmac_f32_16x16x64_bf16 v[60:63],a[152:155],v[20:27],v18
s_waitcnt lgkmcnt(5)
ds_read_b64_tr_b16 a[130:131],v4 offset:6144
v_mfma_f32_16x16x32_bf16 v[84:87],a[132:135],a[28:31],v[84:87]
ds_read_b64_tr_b16 a[134:135],v5 offset:6144
v_fma_f32 v80,v80,s36,v14
v_mfma_f32_16x16x32_bf16 v[84:87],a[136:139],a[32:35],v[84:87]
ds_read_b64_tr_b16 a[132:133],v5 offset:0
v_exp_f32 v83,v83
v_mfma_f32_16x16x32_bf16 v[84:87],a[140:143],a[36:39],v[84:87]
ds_read_b64_tr_b16 a[142:143],v3 offset:6272
v_fma_f32 v81,v81,s36,v14
v_mfma_f32_16x16x32_bf16 v[84:87],a[144:147],a[40:43],v[84:87]
ds_read_b64_tr_b16 a[140:141],v3 offset:128
v_fma_f32 v82,v82,s36,v14
v_mfma_f32_16x16x32_bf16 v[84:87],a[148:151],a[44:47],v[84:87]
s_waitcnt lgkmcnt(6)
ds_read_b64_tr_b16 a[136:137],v2 offset:128
v_exp_f32 v82,v82
v_mfma_f32_16x16x32_bf16 v[208:211],a[120:123],v[24:27],0
ds_read_b64_tr_b16 a[138:139],v2 offset:6272
v_cvt_pk_bf16_f32 v49,v82,v83
v_mfma_f32_16x16x32_bf16 v[212:215],a[124:127],v[24:27],0
s_waitcnt lgkmcnt(5)
ds_read_b64_tr_b16 a[148:149],v5 offset:128
v_exp_f32 v80,v80
v_mfma_f32_16x16x32_bf16 v[216:219],a[128:131],v[24:27],0
s_waitcnt lgkmcnt(4)
ds_read_b64_tr_b16 a[146:147],v4 offset:6272
v_exp_f32 v81,v81
ds_read_b64_tr_b16 a[144:145],v4 offset:128
v_mfma_f32_16x16x32_bf16 v[220:223],a[132:135],v[24:27],0
ds_read_b64_tr_b16 a[150:151],v5 offset:6272
ds_read_b64_tr_b16 a[120:121],v2 offset:256
ds_read_b64_tr_b16 a[128:129],v4 offset:256
ds_read_b64_tr_b16 a[122:123],v2 offset:6400
ds_read_b64_tr_b16 a[126:127],v3 offset:6400
ds_read_b64_tr_b16 a[124:125],v3 offset:256
v_cvt_pk_bf16_f32 v48,v80,v81
v_fma_f32 v84,v84,s36,v14
ds_read_b64_tr_b16 a[130:131],v4 offset:6400
s_waitcnt lgkmcnt(10)
v_mfma_f32_16x16x32_bf16 v[224:227],a[136:139],v[24:27],0
ds_read_b64_tr_b16 a[132:133],v5 offset:256
v_exp_f32 v84,v84
ds_read_b64_tr_b16 a[134:135],v5 offset:6400
v_mfma_f32_16x16x32_bf16 v[228:231],a[140:143],v[24:27],0
s_waitcnt lgkmcnt(9)
ds_read_b128 a[140:143],v1 offset:24576
v_fma_f32 v85,v85,s36,v14
v_mfma_f32_16x16x32_bf16 v[232:235],a[144:147],v[24:27],0
s_waitcnt lgkmcnt(9)
ds_read_b128 a[136:139],v0 offset:24576
v_fma_f32 v86,v86,s36,v14
v_mfma_f32_16x16x32_bf16 v[236:239],a[148:151],v[24:27],0
s_waitcnt lgkmcnt(5)
ds_read_b128 a[148:151],v1 offset:24704
v_exp_f32 v85,v85
v_mfma_f32_16x16x32_bf16 v[240:243],a[120:123],v[24:27],0
ds_read_b128 a[120:123],v0 offset:24832
v_exp_f32 v86,v86
v_mfma_f32_16x16x32_bf16 v[244:247],a[124:127],v[24:27],0
s_waitcnt lgkmcnt(5)
ds_read_b128 a[144:147],v0 offset:24704
v_fma_f32 v87,v87,s36,v14
v_mfma_f32_16x16x32_bf16 v[248:251],a[128:131],v[24:27],0
ds_read_b128 a[128:131],v0 offset:30720
v_cvt_pk_bf16_f32 v50,v84,v85
v_exp_f32 v87,v87
v_cvt_pk_bf16_f32 v21,v74,v75
s_waitcnt lgkmcnt(5)
v_mfma_f32_16x16x32_bf16 v[252:255],a[132:135],v[24:27],0
s_waitcnt lgkmcnt(4)
ds_read_b128 a[124:127],v1 offset:24832
v_cvt_pk_bf16_f32 v51,v86,v87
v_cvt_pk_bf16_f32 v20,v72,v73
v_mfma_f32_16x16x32_bf16 v[80:83],a[136:139],a[24:27],0
ds_read_b128 a[136:139],v0 offset:30848
v_smfmac_f32_16x16x64_bf16 v[60:63],a[152:155],v[44:51],v18
ds_read_b128 a[132:135],v1 offset:30720
v_mfma_f32_16x16x32_bf16 v[80:83],a[140:143],a[28:31],v[80:83]
s_waitcnt lgkmcnt(4)
ds_read_b128 a[140:143],v1 offset:30848
v_mfma_f32_16x16x32_bf16 v[80:83],a[144:147],a[32:35],v[80:83]
ds_read_b128 a[144:147],v0 offset:30976
v_mfma_f32_16x16x32_bf16 v[80:83],a[148:151],a[36:39],v[80:83]
ds_read_b128 a[148:151],v1 offset:30976
v_mfma_f32_16x16x32_bf16 v[80:83],a[120:123],a[40:43],v[80:83]
s_waitcnt lgkmcnt(5)
ds_read_b128 a[120:123],v0 offset:0
v_mfma_f32_16x16x32_bf16 v[80:83],a[124:127],a[44:47],v[80:83]
ds_read_b128 a[124:127],v1 offset:0
v_mfma_f32_16x16x32_bf16 v[84:87],a[128:131],a[24:27],0
s_waitcnt lgkmcnt(5)
ds_read_b128 a[128:131],v0 offset:128
v_mfma_f32_16x16x32_bf16 v[84:87],a[132:135],a[28:31],v[84:87]
ds_read_b128 a[132:135],v1 offset:128
v_mfma_f32_16x16x32_bf16 v[84:87],a[136:139],a[32:35],v[84:87]
s_waitcnt lgkmcnt(6)
ds_read_b128 a[136:139],v0 offset:256
v_mfma_f32_16x16x32_bf16 v[84:87],a[140:143],a[36:39],v[84:87]
s_waitcnt lgkmcnt(6)
ds_read_b128 a[140:143],v1 offset:256
v_fma_f32 v81,v81,s36,v14
v_mfma_f32_16x16x32_bf16 v[84:87],a[144:147],a[40:43],v[84:87]
s_waitcnt lgkmcnt(6)
ds_read_b128 a[144:147],v0 offset:6144
v_fma_f32 v80,v80,s36,v14
v_mfma_f32_16x16x32_bf16 v[84:87],a[148:151],a[44:47],v[84:87]
s_waitcnt vmcnt(6)
ds_read_b128 a[48:51],v11 offset:12288
buffer_load_dwordx4 v6,s[8:11],s21 offen offset:0 lds
ds_read_b128 a[52:55],v12 offset:12288
buffer_load_dwordx4 v7,s[8:11],s21 offen offset:1024 lds
ds_read_b128 a[56:59],v11 offset:12416
buffer_load_dwordx4 v8,s[8:11],s21 offen offset:2048 lds
s_add_u32 s21,s21,12288
s_add_u32 m0,s23,24576
ds_read_b128 a[60:63],v12 offset:12416
v_exp_f32 v80,v80
v_exp_f32 v81,v81
ds_read_b128 a[68:71],v12 offset:12544
v_cvt_pk_bf16_f32 v24,v80,v81
ds_read_b128 a[64:67],v11 offset:12544
ds_read_b128 a[148:151],v1 offset:6144
s_waitcnt lgkmcnt(6)
v_mfma_f32_16x16x32_bf16 v[88:91],a[120:123],a[48:51],0
s_waitcnt lgkmcnt(5)
ds_read_b128 a[120:123],v0 offset:6272
v_mfma_f32_16x16x32_bf16 v[88:91],a[124:127],a[52:55],v[88:91]
s_waitcnt lgkmcnt(5)
ds_read_b128 a[124:127],v1 offset:6272
v_mfma_f32_16x16x32_bf16 v[88:91],a[128:131],a[56:59],v[88:91]
s_waitcnt lgkmcnt(5)
ds_read_b128 a[128:131],v0 offset:6400
v_mfma_f32_16x16x32_bf16 v[88:91],a[132:135],a[60:63],v[88:91]
s_waitcnt lgkmcnt(4)
ds_read_b128 a[132:135],v1 offset:6400
v_mfma_f32_16x16x32_bf16 v[88:91],a[136:139],a[64:67],v[88:91]
ds_read_b128 a[136:139],v0 offset:12288
v_mfma_f32_16x16x32_bf16 v[88:91],a[140:143],a[68:71],v[88:91]
ds_read_b128 a[140:143],v1 offset:12288
v_mfma_f32_16x16x32_bf16 v[92:95],a[144:147],a[48:51],0
s_waitcnt lgkmcnt(6)
ds_read_b128 a[144:147],v0 offset:12416
v_mfma_f32_16x16x32_bf16 v[92:95],a[148:151],a[52:55],v[92:95]
s_waitcnt lgkmcnt(6)
ds_read_b128 a[148:151],v1 offset:12416
v_mfma_f32_16x16x32_bf16 v[92:95],a[120:123],a[56:59],v[92:95]
s_waitcnt lgkmcnt(6)
ds_read_b128 a[120:123],v0 offset:12544
v_mfma_f32_16x16x32_bf16 v[92:95],a[124:127],a[60:63],v[92:95]
s_waitcnt lgkmcnt(6)
ds_read_b128 a[124:127],v1 offset:12544
v_max3_f32 v52,v88,v89,v90
v_mfma_f32_16x16x32_bf16 v[92:95],a[128:131],a[64:67],v[92:95]
s_waitcnt lgkmcnt(6)
ds_read_b128 a[128:131],v0 offset:18432
v_max_f32 v52,v52,v91
v_mfma_f32_16x16x32_bf16 v[92:95],a[132:135],a[68:71],v[92:95]
ds_read_b128 a[132:135],v1 offset:18432
v_mov_b32 v53,v52
s_nop 1
v_permlane32_swap_b32 v53,v52
v_max_f32 v52,v52,v53
v_mov_b32 v53,v52
s_nop 1
v_permlane16_swap_b32 v53,v52
v_max_f32 v52,v52,v53
v_mul_f32_e64 v15,-s36,v52
v_fma_f32 v88,v88,s36,v15
v_exp_f32 v88,v88
v_fma_f32 v90,v90,s36,v15
v_fma_f32 v89,v89,s36,v15
v_exp_f32 v89,v89
v_fma_f32 v91,v91,s36,v15
v_exp_f32 v91,v91
v_exp_f32 v90,v90
v_cvt_pk_bf16_f32 v28,v88,v89
v_cvt_pk_bf16_f32 v29,v90,v91
s_waitcnt lgkmcnt(1)
v_mfma_f32_16x16x32_bf16 v[88:91],a[136:139],a[48:51],0
ds_read_b128 a[136:139],v0 offset:18560
v_fma_f32 v95,v95,s36,v15
v_mfma_f32_16x16x32_bf16 v[88:91],a[140:143],a[52:55],v[88:91]
ds_read_b128 a[140:143],v1 offset:18560
v_fma_f32 v92,v92,s36,v15
v_mfma_f32_16x16x32_bf16 v[88:91],a[144:147],a[56:59],v[88:91]
ds_read_b128 a[144:147],v0 offset:18688
v_exp_f32 v92,v92
v_mfma_f32_16x16x32_bf16 v[88:91],a[148:151],a[60:63],v[88:91]
ds_read_b128 a[148:151],v1 offset:18688
v_fma_f32 v94,v94,s36,v15
v_mfma_f32_16x16x32_bf16 v[88:91],a[120:123],a[64:67],v[88:91]
ds_read_b64_tr_b16 a[122:123],v2 offset:6144
v_exp_f32 v94,v94
v_mfma_f32_16x16x32_bf16 v[88:91],a[124:127],a[68:71],v[88:91]
ds_read_b64_tr_b16 a[120:121],v2 offset:0
v_exp_f32 v95,v95
v_fma_f32 v93,v93,s36,v15
v_exp_f32 v93,v93
v_cvt_pk_bf16_f32 v31,v94,v95
ds_read_b64_tr_b16 a[124:125],v3 offset:0
ds_read_b64_tr_b16 a[126:127],v3 offset:6144
v_cvt_pk_bf16_f32 v30,v92,v93
v_mfma_f32_16x16x32_bf16 v[92:95],a[128:131],a[48:51],0
s_waitcnt lgkmcnt(5)
ds_read_b64_tr_b16 a[130:131],v4 offset:6144
v_fma_f32 v89,v89,s36,v15
v_mfma_f32_16x16x32_bf16 v[92:95],a[132:135],a[52:55],v[92:95]
ds_read_b64_tr_b16 a[128:129],v4 offset:0
v_fma_f32 v91,v91,s36,v15
v_mfma_f32_16x16x32_bf16 v[92:95],a[136:139],a[56:59],v[92:95]
ds_read_b64_tr_b16 a[134:135],v5 offset:6144
v_exp_f32 v91,v91
v_mfma_f32_16x16x32_bf16 v[92:95],a[140:143],a[60:63],v[92:95]
ds_read_b64_tr_b16 a[136:137],v2 offset:128
v_fma_f32 v90,v90,s36,v15
v_mfma_f32_16x16x32_bf16 v[92:95],a[144:147],a[64:67],v[92:95]
s_waitcnt lgkmcnt(6)
ds_read_b64_tr_b16 a[142:143],v3 offset:6272
v_exp_f32 v90,v90
v_mfma_f32_16x16x32_bf16 v[92:95],a[148:151],a[68:71],v[92:95]
ds_read_b64_tr_b16 a[132:133],v5 offset:0
v_cvt_pk_bf16_f32 v53,v90,v91
v_mfma_f32_16x16x32_bf16 v[112:115],a[120:123],v[28:31],0
s_waitcnt lgkmcnt(5)
ds_read_b64_tr_b16 a[138:139],v2 offset:6272
v_fma_f32 v88,v88,s36,v15
v_mfma_f32_16x16x32_bf16 v[116:119],a[124:127],v[28:31],0
s_waitcnt lgkmcnt(5)
ds_read_b64_tr_b16 a[140:141],v3 offset:128
v_exp_f32 v88,v88
v_exp_f32 v89,v89
v_mfma_f32_16x16x32_bf16 v[120:123],a[128:131],v[28:31],0
ds_read_b64_tr_b16 a[144:145],v4 offset:128
ds_read_b64_tr_b16 a[150:151],v5 offset:6272
ds_read_b64_tr_b16 a[146:147],v4 offset:6272
ds_read_b64_tr_b16 a[122:123],v2 offset:6400
ds_read_b64_tr_b16 a[148:149],v5 offset:128
ds_read_b64_tr_b16 a[120:121],v2 offset:256
v_cvt_pk_bf16_f32 v52,v88,v89
v_fma_f32 v94,v94,s36,v15
v_fma_f32 v95,v95,s36,v15
ds_read_b64_tr_b16 a[124:125],v3 offset:256
ds_read_b64_tr_b16 a[126:127],v3 offset:6400
s_waitcnt lgkmcnt(10)
v_mfma_f32_16x16x32_bf16 v[124:127],a[132:135],v[28:31],0
s_waitcnt lgkmcnt(9)
ds_read_b64_tr_b16 a[132:133],v5 offset:256
ds_read_b64_tr_b16 a[128:129],v4 offset:256
ds_read_b64_tr_b16 a[130:131],v4 offset:6400
v_mfma_f32_16x16x32_bf16 v[128:131],a[136:139],v[28:31],0
s_waitcnt lgkmcnt(11)
ds_read_b64_tr_b16 a[134:135],v5 offset:6400
v_exp_f32 v94,v94
v_mfma_f32_16x16x32_bf16 v[132:135],a[140:143],v[28:31],0
s_waitcnt lgkmcnt(9)
ds_read_b128 a[136:139],v0 offset:24576
v_fma_f32 v93,v93,s36,v15
v_mfma_f32_16x16x32_bf16 v[136:139],a[144:147],v[28:31],0
s_waitcnt lgkmcnt(7)
ds_read_b128 a[140:143],v1 offset:24576
v_exp_f32 v93,v93
v_mfma_f32_16x16x32_bf16 v[140:143],a[148:151],v[28:31],0
ds_read_b128 a[144:147],v0 offset:24704
v_fma_f32 v92,v92,s36,v15
v_mfma_f32_16x16x32_bf16 v[144:147],a[120:123],v[28:31],0
s_waitcnt lgkmcnt(6)
ds_read_b128 a[120:123],v0 offset:24832
v_exp_f32 v92,v92
v_mfma_f32_16x16x32_bf16 v[148:151],a[124:127],v[28:31],0
s_waitcnt lgkmcnt(4)
ds_read_b128 a[148:151],v1 offset:24704
v_cvt_pk_bf16_f32 v54,v92,v93
v_exp_f32 v95,v95
v_mfma_f32_16x16x32_bf16 v[152:155],a[128:131],v[28:31],0
ds_read_b128 a[128:131],v0 offset:30720
v_cvt_pk_bf16_f32 v55,v94,v95
v_mfma_f32_16x16x32_bf16 v[156:159],a[132:135],v[28:31],0
s_waitcnt lgkmcnt(5)
ds_read_b128 a[124:127],v1 offset:24832
v_mfma_f32_16x16x32_bf16 v[88:91],a[136:139],a[48:51],0
s_waitcnt lgkmcnt(5)
ds_read_b128 a[132:135],v1 offset:30720
v_mfma_f32_16x16x32_bf16 v[88:91],a[140:143],a[52:55],v[88:91]
s_waitcnt lgkmcnt(5)
ds_read_b128 a[136:139],v0 offset:30848
v_mfma_f32_16x16x32_bf16 v[88:91],a[144:147],a[56:59],v[88:91]
s_waitcnt lgkmcnt(4)
ds_read_b128 a[144:147],v0 offset:30976
ds_read_b128 a[140:143],v1 offset:30848
v_mfma_f32_16x16x32_bf16 v[88:91],a[148:151],a[60:63],v[88:91]
ds_read_b128 a[148:151],v1 offset:30976
v_mfma_f32_16x16x32_bf16 v[88:91],a[120:123],a[64:67],v[88:91]
s_waitcnt lgkmcnt(5)
ds_read_b128 a[120:123],v0 offset:0
v_mfma_f32_16x16x32_bf16 v[88:91],a[124:127],a[68:71],v[88:91]
ds_read_b128 a[124:127],v1 offset:0
v_mfma_f32_16x16x32_bf16 v[92:95],a[128:131],a[48:51],0
s_waitcnt lgkmcnt(6)
ds_read_b128 a[128:131],v0 offset:128
v_mfma_f32_16x16x32_bf16 v[92:95],a[132:135],a[52:55],v[92:95]
s_waitcnt lgkmcnt(6)
ds_read_b128 a[132:135],v1 offset:128
v_mfma_f32_16x16x32_bf16 v[92:95],a[136:139],a[56:59],v[92:95]
s_waitcnt lgkmcnt(5)
ds_read_b128 a[136:139],v0 offset:256
v_mfma_f32_16x16x32_bf16 v[92:95],a[140:143],a[60:63],v[92:95]
ds_read_b128 a[140:143],v1 offset:256
v_mfma_f32_16x16x32_bf16 v[92:95],a[144:147],a[64:67],v[92:95]
s_waitcnt lgkmcnt(6)
ds_read_b128 a[144:147],v0 offset:6144
v_mfma_f32_16x16x32_bf16 v[92:95],a[148:151],a[68:71],v[92:95]
s_waitcnt vmcnt(3)
ds_read_b128 a[72:75],v11 offset:0
buffer_load_dwordx4 v6,s[8:11],s21 offen offset:0 lds
ds_read_b128 a[76:79],v12 offset:0
buffer_load_dwordx4 v7,s[8:11],s21 offen offset:1024 lds
ds_read_b128 a[80:83],v11 offset:128
buffer_load_dwordx4 v8,s[8:11],s21 offen offset:2048 lds
s_add_u32 s21,s21,12288
ds_read_b128 a[84:87],v12 offset:128
s_add_u32 m0,s22,0
ds_read_b128 a[88:91],v11 offset:256
ds_read_b128 a[92:95],v12 offset:256
ds_read_b128 a[148:151],v1 offset:6144
s_waitcnt lgkmcnt(6)
v_mfma_f32_16x16x32_bf16 v[96:99],a[120:123],a[72:75],0
s_waitcnt lgkmcnt(5)
ds_read_b128 a[120:123],v0 offset:6272
v_mfma_f32_16x16x32_bf16 v[96:99],a[124:127],a[76:79],v[96:99]
s_waitcnt lgkmcnt(5)
ds_read_b128 a[124:127],v1 offset:6272
v_mfma_f32_16x16x32_bf16 v[96:99],a[128:131],a[80:83],v[96:99]
s_waitcnt lgkmcnt(5)
ds_read_b128 a[128:131],v0 offset:6400
v_mfma_f32_16x16x32_bf16 v[96:99],a[132:135],a[84:87],v[96:99]
ds_read_b128 a[132:135],v1 offset:6400
s_waitcnt vmcnt(3)
s_waitcnt lgkmcnt(6)
v_mfma_f32_16x16x32_bf16 v[96:99],a[136:139],a[88:91],v[96:99]
s_waitcnt lgkmcnt(5)
v_mfma_f32_16x16x32_bf16 v[96:99],a[140:143],a[92:95],v[96:99]
v_mfma_f32_16x16x32_bf16 v[100:103],a[144:147],a[72:75],0
s_waitcnt lgkmcnt(4)
v_mfma_f32_16x16x32_bf16 v[100:103],a[148:151],a[76:79],v[100:103]
s_waitcnt lgkmcnt(3)
v_mfma_f32_16x16x32_bf16 v[100:103],a[120:123],a[80:83],v[100:103]
s_waitcnt lgkmcnt(2)
v_mfma_f32_16x16x32_bf16 v[100:103],a[124:127],a[84:87],v[100:103]
s_waitcnt lgkmcnt(1)
v_mfma_f32_16x16x32_bf16 v[100:103],a[128:131],a[88:91],v[100:103]
s_waitcnt lgkmcnt(0)
v_mfma_f32_16x16x32_bf16 v[100:103],a[132:135],a[92:95],v[100:103]
s_barrier
buffer_load_dwordx4 v6,s[4:7],s20 offen offset:0 lds
buffer_load_dwordx4 v7,s[4:7],s20 offen offset:1024 lds
buffer_load_dwordx4 v8,s[4:7],s20 offen offset:2048 lds
ds_read_b128 a[136:139],v0 offset:12288
v_max3_f32 v56,v96,v97,v98
v_max_f32 v56,v56,v99
v_mov_b32 v57,v56
s_add_u32 s20,s20,12288
s_mov_b32 s27,166723584
ds_read_b128 a[144:147],v0 offset:12416
v_permlane32_swap_b32 v57,v56
ds_read_b128 a[140:143],v1 offset:12288
v_max_f32 v56,v56,v57
ds_read_b128 a[148:151],v1 offset:12416
v_mov_b32 v57,v56
ds_read_b128 a[124:127],v1 offset:12544
s_mov_b32 s42,s41
ds_read_b128 a[120:123],v0 offset:12544
v_permlane16_swap_b32 v57,v56
ds_read_b128 a[128:131],v0 offset:18432
v_max_f32 v56,v56,v57
ds_read_b128 a[132:135],v1 offset:18432
v_mul_f32_e64 v16,-s36,v56
v_fma_f32 v96,v96,s36,v16
v_exp_f32 v96,v96
v_fma_f32 v97,v97,s36,v16
v_exp_f32 v97,v97
v_fma_f32 v99,v99,s36,v16
v_exp_f32 v99,v99
v_fma_f32 v98,v98,s36,v16
v_exp_f32 v98,v98
v_cvt_pk_bf16_f32 v32,v96,v97
v_cvt_pk_bf16_f32 v33,v98,v99
s_waitcnt lgkmcnt(4)
v_mfma_f32_16x16x32_bf16 v[96:99],a[136:139],a[72:75],0
s_add_u32 s69,s69,1
ds_read_b128 a[136:139],v0 offset:18560
v_fma_f32 v103,v103,s36,v16
v_mfma_f32_16x16x32_bf16 v[96:99],a[140:143],a[76:79],v[96:99]
s_lshl_b32 s62,s69,5
ds_read_b128 a[140:143],v1 offset:18560
v_fma_f32 v101,v101,s36,v16
v_mfma_f32_16x16x32_bf16 v[96:99],a[144:147],a[80:83],v[96:99]
s_add_u32 s62,s62,s34
ds_read_b128 a[144:147],v0 offset:18688
v_fma_f32 v102,v102,s36,v16
v_mfma_f32_16x16x32_bf16 v[96:99],a[148:151],a[84:87],v[96:99]
s_mul_i32 s63,s62,171
ds_read_b128 a[148:151],v1 offset:18688
v_exp_f32 v103,v103
s_waitcnt lgkmcnt(4)
v_mfma_f32_16x16x32_bf16 v[96:99],a[120:123],a[88:91],v[96:99]
s_lshr_b32 s63,s63,9
ds_read_b64_tr_b16 a[122:123],v2 offset:6144
v_exp_f32 v101,v101
v_mfma_f32_16x16x32_bf16 v[96:99],a[124:127],a[92:95],v[96:99]
s_mul_i32 s64,s63,3
ds_read_b64_tr_b16 a[120:121],v2 offset:0
v_exp_f32 v102,v102
v_fma_f32 v100,v100,s36,v16
v_exp_f32 v100,v100
v_cvt_pk_bf16_f32 v35,v102,v103
ds_read_b64_tr_b16 a[124:125],v3 offset:0
ds_read_b64_tr_b16 a[126:127],v3 offset:6144
v_cvt_pk_bf16_f32 v34,v100,v101
v_mfma_f32_16x16x32_bf16 v[100:103],a[128:131],a[72:75],0
s_sub_u32 s62,s62,s64
ds_read_b64_tr_b16 a[130:131],v4 offset:6144
v_fma_f32 v98,v98,s36,v16
v_smfmac_f32_16x16x64_bf16 v[64:67],a[152:155],v[28:35],v18
s_add_u32 s63,s63,s33
s_mul_i32 s30,s63,196608
ds_read_b64_tr_b16 a[128:129],v4 offset:0
v_mfma_f32_16x16x32_bf16 v[100:103],a[132:135],a[76:79],v[100:103]
s_mul_i32 s41,s63,325632
ds_read_b64_tr_b16 a[134:135],v5 offset:6144
v_exp_f32 v98,v98
s_waitcnt lgkmcnt(6)
v_mfma_f32_16x16x32_bf16 v[100:103],a[136:139],a[80:83],v[100:103]
s_lshl_b32 s63,s3,2
ds_read_b64_tr_b16 a[132:133],v5 offset:0
v_fma_f32 v97,v97,s36,v16
v_mfma_f32_16x16x32_bf16 v[100:103],a[140:143],a[84:87],v[100:103]
s_add_u32 s64,s63,21
ds_read_b64_tr_b16 a[136:137],v2 offset:128
v_exp_f32 v97,v97
v_mfma_f32_16x16x32_bf16 v[100:103],a[144:147],a[88:91],v[100:103]
s_cmp_eq_u32 s3,0
ds_read_b64_tr_b16 a[144:145],v4 offset:128
v_fma_f32 v96,v96,s36,v16
v_mfma_f32_16x16x32_bf16 v[100:103],a[148:151],a[92:95],v[100:103]
s_cselect_b32 s64,20,s64
ds_read_b64_tr_b16 a[138:139],v2 offset:6272
v_fma_f32 v99,v99,s36,v16
s_waitcnt lgkmcnt(7)
v_mfma_f32_16x16x32_bf16 a[160:163],a[120:123],v[32:35],0
s_cselect_b32 s40,1,0
ds_read_b64_tr_b16 a[120:121],v2 offset:256
v_exp_f32 v99,v99
v_mfma_f32_16x16x32_bf16 a[164:167],a[124:127],v[32:35],0
s_add_u32 s65,s63,37
ds_read_b64_tr_b16 a[126:127],v3 offset:6400
v_cvt_pk_bf16_f32 v57,v98,v99
s_waitcnt lgkmcnt(6)
v_mfma_f32_16x16x32_bf16 a[168:171],a[128:131],v[32:35],0
s_cmp_eq_u32 s62,2
ds_read_b64_tr_b16 a[130:131],v4 offset:6400
ds_read_b64_tr_b16 a[140:141],v3 offset:128
ds_read_b64_tr_b16 a[142:143],v3 offset:6272
ds_read_b64_tr_b16 a[146:147],v4 offset:6272
s_waitcnt lgkmcnt(9)
v_mfma_f32_16x16x32_bf16 a[172:175],a[132:135],v[32:35],0
s_cselect_b32 s64,s65,s64
ds_read_b64_tr_b16 a[132:133],v5 offset:256
ds_read_b64_tr_b16 a[128:129],v4 offset:256
ds_read_b64_tr_b16 a[148:149],v5 offset:128
ds_read_b64_tr_b16 a[122:123],v2 offset:6400
ds_read_b64_tr_b16 a[150:151],v5 offset:6272
ds_read_b64_tr_b16 a[124:125],v3 offset:256
s_waitcnt lgkmcnt(12)
v_mfma_f32_16x16x32_bf16 a[176:179],a[136:139],v[32:35],0
s_cselect_b32 s40,0,s40
ds_read_b64_tr_b16 a[134:135],v5 offset:6400
s_waitcnt vmcnt(6)
v_exp_f32 v96,v96
v_fma_f32 v102,v102,s36,v16
v_cvt_pk_bf16_f32 v56,v96,v97
v_fma_f32 v103,v103,s36,v16
v_exp_f32 v103,v103
v_fma_f32 v100,v100,s36,v16
v_exp_f32 v102,v102
s_waitcnt lgkmcnt(8)
v_mfma_f32_16x16x32_bf16 a[180:183],a[140:143],v[32:35],0
s_add_u32 s65,s63,s3
v_cvt_pk_bf16_f32 v59,v102,v103
v_fma_f32 v101,v101,s36,v16
s_waitcnt lgkmcnt(7)
v_mfma_f32_16x16x32_bf16 a[184:187],a[144:147],v[32:35],0
s_cmp_eq_u32 s62,0
v_exp_f32 v101,v101
v_exp_f32 v100,v100
s_cselect_b32 s64,s65,s64
v_cvt_pk_bf16_f32 v58,v100,v101
s_cselect_b32 s40,1,s40
s_waitcnt lgkmcnt(1)
v_mfma_f32_16x16x32_bf16 a[188:191],a[148:151],v[32:35],0
s_mul_i32 s64,s64,6144
s_add_u32 s41,s41,s64
s_cmp_ge_u32 s69,6
v_smfmac_f32_16x16x64_bf16 v[64:67],a[152:155],v[52:59],v18
s_waitcnt lgkmcnt(0)
s_barrier
v_mfma_f32_16x16x32_bf16 a[192:195],a[120:123],v[32:35],0
s_cselect_b32 s41,166723584,s41
ds_read_b128 a[140:143],v1 offset:24576
s_cselect_b32 s30,100663296,s30
v_mfma_f32_16x16x32_bf16 a[196:199],a[124:127],v[32:35],0
s_add_u32 s25,s30,s22
ds_read_b128 a[136:139],v0 offset:24576
s_add_u32 s26,s25,12288
v_mfma_f32_16x16x32_bf16 a[200:203],a[128:131],v[32:35],0
s_mov_b32 s28,s41
ds_read_b128 a[148:151],v1 offset:24704
s_mov_b32 s29,s24
v_mfma_f32_16x16x32_bf16 a[204:207],a[132:135],v[32:35],0
s_add_u32 m0,s23,0
ds_read_b128 a[120:123],v0 offset:24832
buffer_load_dwordx4 v6,s[8:11],s21 offen offset:0 lds
buffer_load_dwordx4 v7,s[8:11],s21 offen offset:1024 lds
buffer_load_dwordx4 v8,s[8:11],s21 offen offset:2048 lds
ds_read_b128 a[144:147],v0 offset:24704
s_add_u32 s21,s21,12288
ds_read_b128 a[124:127],v1 offset:24832
s_add_u32 m0,s22,12288
ds_read_b128 a[128:131],v0 offset:30720
buffer_load_dwordx4 v6,s[4:7],s20 offen offset:0 lds
s_waitcnt lgkmcnt(5)
v_mfma_f32_16x16x32_bf16 v[96:99],a[136:139],a[72:75],0
buffer_load_dwordx4 v7,s[4:7],s20 offen offset:1024 lds
v_mfma_f32_16x16x32_bf16 v[96:99],a[140:143],a[76:79],v[96:99]
buffer_load_dwordx4 v8,s[4:7],s20 offen offset:2048 lds
ds_read_b128 a[132:135],v1 offset:30720
s_add_u32 s20,s20,12288
ds_read_b128 a[136:139],v0 offset:30848
s_waitcnt lgkmcnt(4)
v_mfma_f32_16x16x32_bf16 v[96:99],a[144:147],a[80:83],v[96:99]
ds_read_b128 a[140:143],v1 offset:30848
v_mfma_f32_16x16x32_bf16 v[96:99],a[148:151],a[84:87],v[96:99]
ds_read_b128 a[144:147],v0 offset:30976
v_mfma_f32_16x16x32_bf16 v[96:99],a[120:123],a[88:91],v[96:99]
s_waitcnt lgkmcnt(4)
ds_read_b64_tr_b16 a[120:121],v2 offset:12288
v_mfma_f32_16x16x32_bf16 v[96:99],a[124:127],a[92:95],v[96:99]
ds_read_b64_tr_b16 a[122:123],v2 offset:18432
v_mfma_f32_16x16x32_bf16 v[100:103],a[128:131],a[72:75],0
s_waitcnt lgkmcnt(5)
ds_read_b64_tr_b16 a[126:127],v3 offset:18432
ds_read_b64_tr_b16 a[124:125],v3 offset:12288
v_mfma_f32_16x16x32_bf16 v[100:103],a[132:135],a[76:79],v[100:103]
s_waitcnt lgkmcnt(6)
ds_read_b64_tr_b16 a[130:131],v4 offset:18432
v_mfma_f32_16x16x32_bf16 v[100:103],a[136:139],a[80:83],v[100:103]
s_waitcnt lgkmcnt(6)
ds_read_b64_tr_b16 a[128:129],v4 offset:12288
ds_read_b64_tr_b16 a[132:133],v5 offset:12288
ds_read_b128 a[148:151],v1 offset:30976
v_mfma_f32_16x16x32_bf16 v[100:103],a[140:143],a[84:87],v[100:103]
s_waitcnt lgkmcnt(8)
ds_read_b64_tr_b16 a[134:135],v5 offset:18432
v_mfma_f32_16x16x32_bf16 v[100:103],a[144:147],a[88:91],v[100:103]
s_waitcnt lgkmcnt(1)
v_mfma_f32_16x16x32_bf16 v[100:103],a[148:151],a[92:95],v[100:103]
v_mfma_f32_16x16x32_bf16 v[160:163],a[120:123],v[44:47],v[160:163]
s_add_u32 m0,s23,12288
ds_read_b64_tr_b16 a[136:137],v2 offset:12416
v_fma_f32 v82,v82,s36,v14
v_mfma_f32_16x16x32_bf16 v[164:167],a[124:127],v[44:47],v[164:167]
ds_read_b64_tr_b16 a[138:139],v2 offset:18560
v_fma_f32 v83,v83,s36,v14
v_mfma_f32_16x16x32_bf16 v[212:215],a[124:127],v[48:51],v[212:215]
ds_read_b64_tr_b16 a[140:141],v3 offset:12416
v_fma_f32 v88,v88,s36,v15
v_mfma_f32_16x16x32_bf16 v[208:211],a[120:123],v[48:51],v[208:211]
ds_read_b64_tr_b16 a[142:143],v3 offset:18560
v_fma_f32 v89,v89,s36,v15
v_mfma_f32_16x16x32_bf16 v[112:115],a[120:123],v[52:55],v[112:115]
ds_read_b64_tr_b16 a[144:145],v4 offset:12416
v_fma_f32 v90,v90,s36,v15
v_mfma_f32_16x16x32_bf16 v[116:119],a[124:127],v[52:55],v[116:119]
ds_read_b64_tr_b16 a[146:147],v4 offset:18560
v_fma_f32 v91,v91,s36,v15
v_mfma_f32_16x16x32_bf16 a[164:167],a[124:127],v[56:59],a[164:167]
ds_read_b64_tr_b16 a[148:149],v5 offset:12416
v_fma_f32 v96,v96,s36,v16
v_mfma_f32_16x16x32_bf16 a[160:163],a[120:123],v[56:59],a[160:163]
ds_read_b64_tr_b16 a[150:151],v5 offset:18560
v_fma_f32 v97,v97,s36,v16
v_mfma_f32_16x16x32_bf16 a[168:171],a[128:131],v[56:59],a[168:171]
s_waitcnt lgkmcnt(6)
ds_read_b64_tr_b16 a[120:121],v2 offset:12544
v_fma_f32 v98,v98,s36,v16
v_mfma_f32_16x16x32_bf16 a[172:175],a[132:135],v[56:59],a[172:175]
ds_read_b64_tr_b16 a[122:123],v2 offset:18688
v_fma_f32 v99,v99,s36,v16
v_mfma_f32_16x16x32_bf16 v[124:127],a[132:135],v[52:55],v[124:127]
ds_read_b64_tr_b16 a[124:125],v3 offset:12544
v_fma_f32 v76,v76,s36,v13
v_mfma_f32_16x16x32_bf16 v[120:123],a[128:131],v[52:55],v[120:123]
ds_read_b64_tr_b16 a[126:127],v3 offset:18688
v_fma_f32 v77,v77,s36,v13
v_mfma_f32_16x16x32_bf16 v[216:219],a[128:131],v[48:51],v[216:219]
v_exp_f32 v82,v82
v_mfma_f32_16x16x32_bf16 v[220:223],a[132:135],v[48:51],v[220:223]
v_exp_f32 v83,v83
v_mfma_f32_16x16x32_bf16 v[172:175],a[132:135],v[44:47],v[172:175]
ds_read_b64_tr_b16 a[132:133],v5 offset:12544
v_cvt_pk_bf16_f32 v25,v82,v83
v_mfma_f32_16x16x32_bf16 v[168:171],a[128:131],v[44:47],v[168:171]
ds_read_b64_tr_b16 a[128:129],v4 offset:12544
v_fma_f32 v78,v78,s36,v13
v_mfma_f32_16x16x32_bf16 v[176:179],a[136:139],v[44:47],v[176:179]
s_waitcnt lgkmcnt(4)
ds_read_b64_tr_b16 a[130:131],v4 offset:18688
v_fma_f32 v79,v79,s36,v13
v_mfma_f32_16x16x32_bf16 v[180:183],a[140:143],v[44:47],v[180:183]
ds_read_b64_tr_b16 a[134:135],v5 offset:18688
v_fma_f32 v84,v84,s36,v14
v_mfma_f32_16x16x32_bf16 v[228:231],a[140:143],v[48:51],v[228:231]
v_exp_f32 v88,v88
v_mfma_f32_16x16x32_bf16 v[224:227],a[136:139],v[48:51],v[224:227]
v_exp_f32 v89,v89
v_mfma_f32_16x16x32_bf16 v[128:131],a[136:139],v[52:55],v[128:131]
v_exp_f32 v90,v90
v_mfma_f32_16x16x32_bf16 v[132:135],a[140:143],v[52:55],v[132:135]
v_exp_f32 v91,v91
v_mfma_f32_16x16x32_bf16 a[180:183],a[140:143],v[56:59],a[180:183]
v_cvt_pk_bf16_f32 v28,v88,v89
v_cvt_pk_bf16_f32 v29,v90,v91
v_mfma_f32_16x16x32_bf16 a[176:179],a[136:139],v[56:59],a[176:179]
v_exp_f32 v96,v96
v_mfma_f32_16x16x32_bf16 a[184:187],a[144:147],v[56:59],a[184:187]
v_exp_f32 v97,v97
v_mfma_f32_16x16x32_bf16 a[188:191],a[148:151],v[56:59],a[188:191]
v_exp_f32 v98,v98
v_mfma_f32_16x16x32_bf16 v[140:143],a[148:151],v[52:55],v[140:143]
v_exp_f32 v99,v99
v_mfma_f32_16x16x32_bf16 v[136:139],a[144:147],v[52:55],v[136:139]
v_cvt_pk_bf16_f32 v32,v96,v97
v_cvt_pk_bf16_f32 v33,v98,v99
v_mfma_f32_16x16x32_bf16 v[232:235],a[144:147],v[48:51],v[232:235]
v_exp_f32 v76,v76
v_mfma_f32_16x16x32_bf16 v[236:239],a[148:151],v[48:51],v[236:239]
v_exp_f32 v77,v77
v_mfma_f32_16x16x32_bf16 v[188:191],a[148:151],v[44:47],v[188:191]
v_exp_f32 v78,v78
v_mfma_f32_16x16x32_bf16 v[184:187],a[144:147],v[44:47],v[184:187]
v_exp_f32 v79,v79
v_mfma_f32_16x16x32_bf16 v[192:195],a[120:123],v[44:47],v[192:195]
s_waitcnt vmcnt(6)
v_cvt_pk_bf16_f32 v22,v76,v77
v_cvt_pk_bf16_f32 v23,v78,v79
s_waitcnt lgkmcnt(0)
v_mfma_f32_16x16x32_bf16 v[196:199],a[124:127],v[44:47],v[196:199]
s_barrier
v_mfma_f32_16x16x32_bf16 v[244:247],a[124:127],v[48:51],v[244:247]
ds_read_b128 a[148:151],v1 offset:128
v_fma_f32 v85,v85,s36,v14
v_mfma_f32_16x16x32_bf16 v[240:243],a[120:123],v[48:51],v[240:243]
ds_read_b128 a[144:147],v0 offset:128
v_fma_f32 v86,v86,s36,v14
v_mfma_f32_16x16x32_bf16 v[144:147],a[120:123],v[52:55],v[144:147]
ds_read_b128 a[140:143],v1 offset:0
v_fma_f32 v87,v87,s36,v14
v_mfma_f32_16x16x32_bf16 v[148:151],a[124:127],v[52:55],v[148:151]
ds_read_b128 a[136:139],v0 offset:0
v_fma_f32 v92,v92,s36,v15
v_mfma_f32_16x16x32_bf16 a[196:199],a[124:127],v[56:59],a[196:199]
ds_read_b128 a[124:127],v1 offset:256
v_fma_f32 v93,v93,s36,v15
v_mfma_f32_16x16x32_bf16 a[192:195],a[120:123],v[56:59],a[192:195]
buffer_load_dwordx4 v6,s[8:11],s21 offen offset:0 lds
v_mfma_f32_16x16x32_bf16 a[200:203],a[128:131],v[56:59],a[200:203]
ds_read_b128 a[120:123],v0 offset:256
v_fma_f32 v94,v94,s36,v15
v_mfma_f32_16x16x32_bf16 a[204:207],a[132:135],v[56:59],a[204:207]
v_exp_f32 v84,v84
v_mfma_f32_16x16x32_bf16 v[156:159],a[132:135],v[52:55],v[156:159]
v_exp_f32 v85,v85
v_mfma_f32_16x16x32_bf16 v[152:155],a[128:131],v[52:55],v[152:155]
v_exp_f32 v86,v86
v_mfma_f32_16x16x32_bf16 v[248:251],a[128:131],v[48:51],v[248:251]
v_exp_f32 v87,v87
v_mfma_f32_16x16x32_bf16 v[252:255],a[132:135],v[48:51],v[252:255]
v_cvt_pk_bf16_f32 v26,v84,v85
v_cvt_pk_bf16_f32 v27,v86,v87
v_mfma_f32_16x16x32_bf16 v[204:207],a[132:135],v[44:47],v[204:207]
ds_read_b128 a[132:135],v1 offset:6144
v_fma_f32 v95,v95,s36,v15
v_smfmac_f32_16x16x64_bf16 v[60:63],a[152:155],v[20:27],v18
v_fma_f32 v100,v100,s36,v16
v_mfma_f32_16x16x32_bf16 v[200:203],a[128:131],v[44:47],v[200:203]
buffer_load_dwordx4 v7,s[8:11],s21 offen offset:1024 lds
s_waitcnt lgkmcnt(1)
v_mfma_f32_16x16x32_bf16 v[72:75],a[124:127],a[20:23],0
ds_read_b128 a[128:131],v0 offset:6144
v_fma_f32 v101,v101,s36,v16
v_mfma_f32_16x16x32_bf16 v[72:75],a[120:123],a[16:19],v[72:75]
v_exp_f32 v92,v92
v_mfma_f32_16x16x32_bf16 v[72:75],a[148:151],a[12:15],v[72:75]
v_exp_f32 v93,v93
v_mfma_f32_16x16x32_bf16 v[72:75],a[144:147],a[8:11],v[72:75]
v_exp_f32 v94,v94
v_mfma_f32_16x16x32_bf16 v[72:75],a[140:143],a[4:7],v[72:75]
v_exp_f32 v95,v95
v_mfma_f32_16x16x32_bf16 v[72:75],a[136:139],a[0:3],v[72:75]
v_cvt_pk_bf16_f32 v30,v92,v93
v_cvt_pk_bf16_f32 v31,v94,v95
v_mfma_f32_16x16x32_bf16 v[80:83],a[136:139],a[24:27],0
v_fma_f32 v102,v102,s36,v16
v_fma_f32 v103,v103,s36,v16
v_mfma_f32_16x16x32_bf16 v[80:83],a[140:143],a[28:31],v[80:83]
v_exp_f32 v100,v100
v_mfma_f32_16x16x32_bf16 v[80:83],a[144:147],a[32:35],v[80:83]
buffer_load_dwordx4 v8,s[8:11],s21 offen offset:2048 lds
v_mfma_f32_16x16x32_bf16 v[80:83],a[148:151],a[36:39],v[80:83]
s_add_u32 s21,s21,12288
v_exp_f32 v101,v101
v_mfma_f32_16x16x32_bf16 v[80:83],a[120:123],a[40:43],v[80:83]
s_add_u32 m0,s22,24576
v_exp_f32 v102,v102
v_mfma_f32_16x16x32_bf16 v[80:83],a[124:127],a[44:47],v[80:83]
v_exp_f32 v103,v103
v_mfma_f32_16x16x32_bf16 v[88:91],a[124:127],a[68:71],0
v_cvt_pk_bf16_f32 v34,v100,v101
v_cvt_pk_bf16_f32 v35,v102,v103
v_mfma_f32_16x16x32_bf16 v[88:91],a[120:123],a[64:67],v[88:91]
v_fma_f32 v72,v72,s36,v13
v_fma_f32 v73,v73,s36,v13
v_smfmac_f32_16x16x64_bf16 v[64:67],a[152:155],v[28:35],v18
v_fma_f32 v74,v74,s36,v13
v_mfma_f32_16x16x32_bf16 v[88:91],a[148:151],a[60:63],v[88:91]
v_fma_f32 v75,v75,s36,v13
v_fma_f32 v80,v80,s36,v14
v_mfma_f32_16x16x32_bf16 v[88:91],a[144:147],a[56:59],v[88:91]
v_fma_f32 v81,v81,s36,v14
v_mfma_f32_16x16x32_bf16 v[88:91],a[140:143],a[52:55],v[88:91]
buffer_load_dwordx4 v6,s[4:7],s20 offen offset:0 lds
v_mfma_f32_16x16x32_bf16 v[88:91],a[136:139],a[48:51],v[88:91]
v_exp_f32 v72,v72
v_mfma_f32_16x16x32_bf16 v[96:99],a[136:139],a[72:75],0
ds_read_b128 a[136:139],v0 offset:6272
v_mfma_f32_16x16x32_bf16 v[96:99],a[140:143],a[76:79],v[96:99]
ds_read_b128 a[140:143],v1 offset:6272
v_mfma_f32_16x16x32_bf16 v[96:99],a[144:147],a[80:83],v[96:99]
ds_read_b128 a[144:147],v0 offset:6400
v_mfma_f32_16x16x32_bf16 v[96:99],a[148:151],a[84:87],v[96:99]
ds_read_b128 a[148:151],v1 offset:6400
v_mfma_f32_16x16x32_bf16 v[96:99],a[120:123],a[88:91],v[96:99]
v_exp_f32 v73,v73
v_mfma_f32_16x16x32_bf16 v[96:99],a[124:127],a[92:95],v[96:99]
s_waitcnt lgkmcnt(4)
v_exp_f32 v74,v74
v_mfma_f32_16x16x32_bf16 v[76:79],a[128:131],a[0:3],0
v_exp_f32 v75,v75
v_mfma_f32_16x16x32_bf16 v[76:79],a[132:135],a[4:7],v[76:79]
buffer_load_dwordx4 v7,s[4:7],s20 offen offset:1024 lds
s_waitcnt lgkmcnt(3)
v_mfma_f32_16x16x32_bf16 v[76:79],a[136:139],a[8:11],v[76:79]
s_waitcnt lgkmcnt(2)
v_exp_f32 v80,v80
v_mfma_f32_16x16x32_bf16 v[76:79],a[140:143],a[12:15],v[76:79]
s_waitcnt lgkmcnt(0)
v_exp_f32 v81,v81
v_mfma_f32_16x16x32_bf16 v[76:79],a[144:147],a[16:19],v[76:79]
v_cvt_pk_bf16_f32 v44,v72,v73
v_cvt_pk_bf16_f32 v45,v74,v75
v_mfma_f32_16x16x32_bf16 v[76:79],a[148:151],a[20:23],v[76:79]
v_cvt_pk_bf16_f32 v48,v80,v81
v_mfma_f32_16x16x32_bf16 v[84:87],a[148:151],a[44:47],0
v_mfma_f32_16x16x32_bf16 v[84:87],a[144:147],a[40:43],v[84:87]
v_mfma_f32_16x16x32_bf16 v[84:87],a[140:143],a[36:39],v[84:87]
v_mfma_f32_16x16x32_bf16 v[84:87],a[136:139],a[32:35],v[84:87]
v_mfma_f32_16x16x32_bf16 v[84:87],a[132:135],a[28:31],v[84:87]
buffer_load_dwordx4 v8,s[4:7],s20 offen offset:2048 lds
v_mfma_f32_16x16x32_bf16 v[84:87],a[128:131],a[24:27],v[84:87]
s_add_u32 s20,s20,12288
v_mfma_f32_16x16x32_bf16 v[92:95],a[128:131],a[48:51],0
ds_read_b64_tr_b16 a[120:121],v2 offset:24576
v_mfma_f32_16x16x32_bf16 v[92:95],a[132:135],a[52:55],v[92:95]
ds_read_b64_tr_b16 a[122:123],v2 offset:30720
v_mfma_f32_16x16x32_bf16 v[92:95],a[136:139],a[56:59],v[92:95]
ds_read_b64_tr_b16 a[124:125],v3 offset:24576
v_mfma_f32_16x16x32_bf16 v[92:95],a[140:143],a[60:63],v[92:95]
ds_read_b64_tr_b16 a[126:127],v3 offset:30720
v_mfma_f32_16x16x32_bf16 v[92:95],a[144:147],a[64:67],v[92:95]
v_mfma_f32_16x16x32_bf16 v[92:95],a[148:151],a[68:71],v[92:95]
v_mfma_f32_16x16x32_bf16 v[100:103],a[148:151],a[92:95],0
v_mfma_f32_16x16x32_bf16 v[100:103],a[144:147],a[88:91],v[100:103]
v_mfma_f32_16x16x32_bf16 v[100:103],a[140:143],a[84:87],v[100:103]
v_mfma_f32_16x16x32_bf16 v[100:103],a[136:139],a[80:83],v[100:103]
v_mfma_f32_16x16x32_bf16 v[100:103],a[132:135],a[76:79],v[100:103]
ds_read_b64_tr_b16 a[132:133],v5 offset:24576
v_mfma_f32_16x16x32_bf16 v[100:103],a[128:131],a[72:75],v[100:103]
ds_read_b64_tr_b16 a[128:129],v4 offset:24576
ds_read_b64_tr_b16 a[130:131],v4 offset:30720
ds_read_b64_tr_b16 a[134:135],v5 offset:30720
s_mov_b32 s38,0
s_branch L_loop4
L_loop5:
.p2align 6
L_loop5w0:
s_waitcnt lgkmcnt(3)
v_mfma_f32_16x16x32_bf16 v[160:163],a[120:123],v[20:23],v[160:163]
ds_read_b128 a[156:159],v10 offset:0
v_fma_f32 v90,v90,s36,v15
v_mfma_f32_16x16x32_bf16 v[164:167],a[124:127],v[20:23],v[164:167]
ds_read_b64_tr_b16 a[136:137],v2 offset:24704
v_fma_f32 v91,v91,s36,v15
v_mfma_f32_16x16x32_bf16 v[212:215],a[124:127],v[24:27],v[212:215]
ds_read_b64_tr_b16 a[138:139],v2 offset:30848
v_fma_f32 v96,v96,s36,v16
v_mfma_f32_16x16x32_bf16 v[208:211],a[120:123],v[24:27],v[208:211]
ds_read_b64_tr_b16 a[140:141],v3 offset:24704
v_fma_f32 v97,v97,s36,v16
v_mfma_f32_16x16x32_bf16 v[112:115],a[120:123],v[28:31],v[112:115]
ds_read_b64_tr_b16 a[142:143],v3 offset:30848
v_fma_f32 v98,v98,s36,v16
v_mfma_f32_16x16x32_bf16 v[116:119],a[124:127],v[28:31],v[116:119]
ds_read_b64_tr_b16 a[144:145],v4 offset:24704
v_fma_f32 v99,v99,s36,v16
v_mfma_f32_16x16x32_bf16 a[164:167],a[124:127],v[32:35],a[164:167]
ds_read_b64_tr_b16 a[146:147],v4 offset:30848
v_fma_f32 v104,v104,s36,v17
v_mfma_f32_16x16x32_bf16 a[160:163],a[120:123],v[32:35],a[160:163]
ds_read_b64_tr_b16 a[148:149],v5 offset:24704
v_fma_f32 v105,v105,s36,v17
v_mfma_f32_16x16x32_bf16 a[208:211],a[120:123],v[36:39],a[208:211]
ds_read_b64_tr_b16 a[150:151],v5 offset:30848
v_fma_f32 v106,v106,s36,v17
v_mfma_f32_16x16x32_bf16 a[212:215],a[124:127],v[36:39],a[212:215]
s_waitcnt lgkmcnt(6)
ds_read_b64_tr_b16 a[120:121],v2 offset:24832
v_fma_f32 v107,v107,s36,v17
v_mfma_f32_16x16x32_bf16 a[216:219],a[128:131],v[36:39],a[216:219]
ds_read_b64_tr_b16 a[122:123],v2 offset:30976
v_fma_f32 v76,v76,s36,v13
v_mfma_f32_16x16x32_bf16 a[220:223],a[132:135],v[36:39],a[220:223]
ds_read_b64_tr_b16 a[124:125],v3 offset:24832
v_fma_f32 v77,v77,s36,v13
v_mfma_f32_16x16x32_bf16 a[172:175],a[132:135],v[32:35],a[172:175]
ds_read_b64_tr_b16 a[126:127],v3 offset:30976
v_fma_f32 v78,v78,s36,v13
v_mfma_f32_16x16x32_bf16 a[168:171],a[128:131],v[32:35],a[168:171]
v_exp_f32 v90,v90
v_mfma_f32_16x16x32_bf16 v[120:123],a[128:131],v[28:31],v[120:123]
v_exp_f32 v91,v91
v_mfma_f32_16x16x32_bf16 v[124:127],a[132:135],v[28:31],v[124:127]
v_cvt_pk_bf16_f32 v53,v90,v91
v_fma_f32 v79,v79,s36,v13
v_mfma_f32_16x16x32_bf16 v[220:223],a[132:135],v[24:27],v[220:223]
v_exp_f32 v96,v96
v_mfma_f32_16x16x32_bf16 v[216:219],a[128:131],v[24:27],v[216:219]
buffer_store_dwordx4 a[156:159],v9,s[16:19],s27 offen offset:0 nt
v_exp_f32 v97,v97
v_fma_f32 v84,v84,s36,v14
v_mfma_f32_16x16x32_bf16 v[168:171],a[128:131],v[20:23],v[168:171]
ds_read_b128 a[156:159],v10 offset:1024
v_cvt_pk_bf16_f32 v56,v96,v97
v_mfma_f32_16x16x32_bf16 v[172:175],a[132:135],v[20:23],v[172:175]
ds_read_b64_tr_b16 a[128:129],v4 offset:24832
v_fma_f32 v85,v85,s36,v14
v_mfma_f32_16x16x32_bf16 v[176:179],a[136:139],v[20:23],v[176:179]
s_waitcnt lgkmcnt(2)
ds_read_b64_tr_b16 a[130:131],v4 offset:30976
v_fma_f32 v86,v86,s36,v14
v_mfma_f32_16x16x32_bf16 v[180:183],a[140:143],v[20:23],v[180:183]
ds_read_b64_tr_b16 a[132:133],v5 offset:24832
v_fma_f32 v87,v87,s36,v14
v_mfma_f32_16x16x32_bf16 v[228:231],a[140:143],v[24:27],v[228:231]
ds_read_b64_tr_b16 a[134:135],v5 offset:30976
v_fma_f32 v92,v92,s36,v15
v_mfma_f32_16x16x32_bf16 v[224:227],a[136:139],v[24:27],v[224:227]
v_exp_f32 v98,v98
v_mfma_f32_16x16x32_bf16 v[128:131],a[136:139],v[28:31],v[128:131]
v_exp_f32 v99,v99
v_mfma_f32_16x16x32_bf16 v[132:135],a[140:143],v[28:31],v[132:135]
v_cvt_pk_bf16_f32 v57,v98,v99
v_fma_f32 v93,v93,s36,v15
v_mfma_f32_16x16x32_bf16 a[180:183],a[140:143],v[32:35],a[180:183]
s_waitcnt lgkmcnt(4)
buffer_store_dwordx4 a[156:159],v9,s[16:19],s27 offen offset:128 nt
v_exp_f32 v104,v104
v_fma_f32 v94,v94,s36,v15
v_mfma_f32_16x16x32_bf16 a[176:179],a[136:139],v[32:35],a[176:179]
ds_read_b128 a[156:159],v10 offset:2048
v_fma_f32 v95,v95,s36,v15
v_mfma_f32_16x16x32_bf16 a[224:227],a[136:139],v[36:39],a[224:227]
v_exp_f32 v105,v105
v_mfma_f32_16x16x32_bf16 a[228:231],a[140:143],v[36:39],a[228:231]
v_exp_f32 v106,v106
v_mfma_f32_16x16x32_bf16 a[232:235],a[144:147],v[36:39],a[232:235]
v_exp_f32 v107,v107
v_mfma_f32_16x16x32_bf16 a[236:239],a[148:151],v[36:39],a[236:239]
v_cvt_pk_bf16_f32 v40,v104,v105
v_cvt_pk_bf16_f32 v41,v106,v107
v_mfma_f32_16x16x32_bf16 a[188:191],a[148:151],v[32:35],a[188:191]
v_exp_f32 v76,v76
v_mfma_f32_16x16x32_bf16 a[184:187],a[144:147],v[32:35],a[184:187]
v_exp_f32 v77,v77
v_mfma_f32_16x16x32_bf16 v[136:139],a[144:147],v[28:31],v[136:139]
v_exp_f32 v78,v78
v_mfma_f32_16x16x32_bf16 v[140:143],a[148:151],v[28:31],v[140:143]
s_waitcnt lgkmcnt(0)
buffer_store_dwordx4 a[156:159],v9,s[16:19],s27 offen offset:256 nt
v_exp_f32 v79,v79
v_cvt_pk_bf16_f32 v46,v76,v77
v_mfma_f32_16x16x32_bf16 v[236:239],a[148:151],v[24:27],v[236:239]
s_add_u32 s27,s27,3072
v_cvt_pk_bf16_f32 v47,v78,v79
v_fma_f32 v100,v100,s36,v16
v_mfma_f32_16x16x32_bf16 v[232:235],a[144:147],v[24:27],v[232:235]
s_waitcnt vmcnt(9)
v_exp_f32 v84,v84
v_mfma_f32_16x16x32_bf16 v[184:187],a[144:147],v[20:23],v[184:187]
s_barrier
v_mfma_f32_16x16x32_bf16 v[188:191],a[148:151],v[20:23],v[188:191]
s_add_u32 m0,s23,24576
ds_read_b128 a[136:139],v0 offset:12288
v_fma_f32 v101,v101,s36,v16
v_mfma_f32_16x16x32_bf16 v[192:195],a[120:123],v[20:23],v[192:195]
ds_read_b128 a[140:143],v1 offset:12288
v_fma_f32 v102,v102,s36,v16
v_mfma_f32_16x16x32_bf16 v[196:199],a[124:127],v[20:23],v[196:199]
ds_read_b128 a[144:147],v0 offset:12416
v_fma_f32 v103,v103,s36,v16
v_mfma_f32_16x16x32_bf16 v[244:247],a[124:127],v[24:27],v[244:247]
ds_read_b128 a[148:151],v1 offset:12416
v_fma_f32 v108,v108,s36,v17
v_mfma_f32_16x16x32_bf16 v[240:243],a[120:123],v[24:27],v[240:243]
v_exp_f32 v85,v85
v_mfma_f32_16x16x32_bf16 v[144:147],a[120:123],v[28:31],v[144:147]
buffer_load_dwordx4 v6,s[8:11],s21 offen offset:0 lds
v_mfma_f32_16x16x32_bf16 v[148:151],a[124:127],v[28:31],v[148:151]
v_exp_f32 v86,v86
v_mfma_f32_16x16x32_bf16 a[196:199],a[124:127],v[32:35],a[196:199]
v_exp_f32 v87,v87
v_mfma_f32_16x16x32_bf16 a[192:195],a[120:123],v[32:35],a[192:195]
v_cvt_pk_bf16_f32 v50,v84,v85
v_cvt_pk_bf16_f32 v51,v86,v87
v_mfma_f32_16x16x32_bf16 a[240:243],a[120:123],v[36:39],a[240:243]
ds_read_b128 a[120:123],v0 offset:12544
v_fma_f32 v109,v109,s36,v17
v_smfmac_f32_16x16x64_bf16 v[60:63],a[152:155],v[44:51],v18
v_fma_f32 v110,v110,s36,v17
v_mfma_f32_16x16x32_bf16 a[244:247],a[124:127],v[36:39],a[244:247]
ds_read_b128 a[124:127],v1 offset:12544
v_fma_f32 v111,v111,s36,v17
v_mfma_f32_16x16x32_bf16 a[248:251],a[128:131],v[36:39],a[248:251]
v_exp_f32 v92,v92
v_mfma_f32_16x16x32_bf16 a[252:255],a[132:135],v[36:39],a[252:255]
v_exp_f32 v93,v93
v_mfma_f32_16x16x32_bf16 a[204:207],a[132:135],v[32:35],a[204:207]
v_exp_f32 v94,v94
v_mfma_f32_16x16x32_bf16 a[200:203],a[128:131],v[32:35],a[200:203]
v_exp_f32 v95,v95
v_mfma_f32_16x16x32_bf16 v[152:155],a[128:131],v[28:31],v[152:155]
v_cvt_pk_bf16_f32 v54,v92,v93
v_cvt_pk_bf16_f32 v55,v94,v95
v_mfma_f32_16x16x32_bf16 v[156:159],a[132:135],v[28:31],v[156:159]
buffer_load_dwordx4 v7,s[8:11],s21 offen offset:1024 lds
v_mfma_f32_16x16x32_bf16 v[252:255],a[132:135],v[24:27],v[252:255]
v_exp_f32 v100,v100
v_mfma_f32_16x16x32_bf16 v[248:251],a[128:131],v[24:27],v[248:251]
v_exp_f32 v101,v101
v_mfma_f32_16x16x32_bf16 v[200:203],a[128:131],v[20:23],v[200:203]
ds_read_b128 a[128:131],v0 offset:18432
v_cvt_pk_bf16_f32 v58,v100,v101
v_mfma_f32_16x16x32_bf16 v[204:207],a[132:135],v[20:23],v[204:207]
s_waitcnt lgkmcnt(1)
ds_read_b128 a[132:135],v1 offset:18432
v_mfma_f32_16x16x32_bf16 v[72:75],a[136:139],a[0:3],0
v_exp_f32 v102,v102
v_mfma_f32_16x16x32_bf16 v[72:75],a[140:143],a[4:7],v[72:75]
v_exp_f32 v103,v103
v_mfma_f32_16x16x32_bf16 v[72:75],a[144:147],a[8:11],v[72:75]
v_cvt_pk_bf16_f32 v59,v102,v103
v_mfma_f32_16x16x32_bf16 v[72:75],a[148:151],a[12:15],v[72:75]
v_exp_f32 v108,v108
v_smfmac_f32_16x16x64_bf16 v[64:67],a[152:155],v[52:59],v18
v_mfma_f32_16x16x32_bf16 v[72:75],a[120:123],a[16:19],v[72:75]
v_exp_f32 v109,v109
v_mfma_f32_16x16x32_bf16 v[72:75],a[124:127],a[20:23],v[72:75]
buffer_load_dwordx4 v8,s[8:11],s21 offen offset:2048 lds
v_mfma_f32_16x16x32_bf16 v[80:83],a[124:127],a[44:47],0
s_add_u32 s21,s21,12288
v_exp_f32 v110,v110
v_mfma_f32_16x16x32_bf16 v[80:83],a[120:123],a[40:43],v[80:83]
s_add_u32 m0,s22,0
v_exp_f32 v111,v111
v_mfma_f32_16x16x32_bf16 v[80:83],a[148:151],a[36:39],v[80:83]
v_cvt_pk_bf16_f32 v42,v108,v109
v_cvt_pk_bf16_f32 v43,v110,v111
v_mfma_f32_16x16x32_bf16 v[80:83],a[144:147],a[32:35],v[80:83]
v_fma_f32 v72,v72,s36,v13
v_fma_f32 v73,v73,s36,v13
v_smfmac_f32_16x16x64_bf16 v[68:71],a[152:155],v[36:43],v18
v_fma_f32 v74,v74,s36,v13
v_mfma_f32_16x16x32_bf16 v[80:83],a[140:143],a[28:31],v[80:83]
v_fma_f32 v75,v75,s36,v13
v_mfma_f32_16x16x32_bf16 v[80:83],a[136:139],a[24:27],v[80:83]
v_exp_f32 v72,v72
v_mfma_f32_16x16x32_bf16 v[88:91],a[136:139],a[48:51],0
v_exp_f32 v73,v73
v_mfma_f32_16x16x32_bf16 v[88:91],a[140:143],a[52:55],v[88:91]
v_exp_f32 v74,v74
v_mfma_f32_16x16x32_bf16 v[88:91],a[144:147],a[56:59],v[88:91]
v_exp_f32 v75,v75
v_mfma_f32_16x16x32_bf16 v[88:91],a[148:151],a[60:63],v[88:91]
v_fma_f32 v80,v80,s36,v14
v_fma_f32 v81,v81,s36,v14
v_mfma_f32_16x16x32_bf16 v[88:91],a[120:123],a[64:67],v[88:91]
buffer_load_dwordx4 v6,s[4:7],s20 offen offset:0 lds
v_mfma_f32_16x16x32_bf16 v[88:91],a[124:127],a[68:71],v[88:91]
v_fma_f32 v82,v82,s36,v14
v_fma_f32 v83,v83,s36,v14
v_mfma_f32_16x16x32_bf16 v[96:99],a[124:127],a[92:95],0
v_exp_f32 v80,v80
v_mfma_f32_16x16x32_bf16 v[96:99],a[120:123],a[88:91],v[96:99]
v_exp_f32 v81,v81
v_mfma_f32_16x16x32_bf16 v[96:99],a[148:151],a[84:87],v[96:99]
v_exp_f32 v82,v82
v_mfma_f32_16x16x32_bf16 v[96:99],a[144:147],a[80:83],v[96:99]
v_fma_f32 v88,v88,s36,v15
v_fma_f32 v89,v89,s36,v15
v_mfma_f32_16x16x32_bf16 v[96:99],a[140:143],a[76:79],v[96:99]
v_exp_f32 v83,v83
v_mfma_f32_16x16x32_bf16 v[96:99],a[136:139],a[72:75],v[96:99]
v_exp_f32 v88,v88
v_mfma_f32_16x16x32_bf16 v[104:107],a[136:139],a[96:99],0
ds_read_b128 a[136:139],v0 offset:18560
v_cvt_pk_bf16_f32 v20,v72,v73
v_mfma_f32_16x16x32_bf16 v[104:107],a[140:143],a[100:103],v[104:107]
ds_read_b128 a[140:143],v1 offset:18560
v_cvt_pk_bf16_f32 v21,v74,v75
v_mfma_f32_16x16x32_bf16 v[104:107],a[144:147],a[104:107],v[104:107]
ds_read_b128 a[144:147],v0 offset:18688
v_cvt_pk_bf16_f32 v24,v80,v81
v_mfma_f32_16x16x32_bf16 v[104:107],a[148:151],a[108:111],v[104:107]
ds_read_b128 a[148:151],v1 offset:18688
v_cvt_pk_bf16_f32 v25,v82,v83
v_mfma_f32_16x16x32_bf16 v[104:107],a[120:123],a[112:115],v[104:107]
buffer_load_dwordx4 v7,s[4:7],s20 offen offset:1024 lds
v_mfma_f32_16x16x32_bf16 v[104:107],a[124:127],a[116:119],v[104:107]
s_waitcnt lgkmcnt(4)
v_exp_f32 v89,v89
v_mfma_f32_16x16x32_bf16 v[76:79],a[128:131],a[0:3],0
v_cvt_pk_bf16_f32 v28,v88,v89
v_mfma_f32_16x16x32_bf16 v[76:79],a[132:135],a[4:7],v[76:79]
s_waitcnt lgkmcnt(3)
v_mfma_f32_16x16x32_bf16 v[76:79],a[136:139],a[8:11],v[76:79]
s_waitcnt lgkmcnt(2)
v_mfma_f32_16x16x32_bf16 v[76:79],a[140:143],a[12:15],v[76:79]
s_waitcnt lgkmcnt(1)
v_mfma_f32_16x16x32_bf16 v[76:79],a[144:147],a[16:19],v[76:79]
s_waitcnt lgkmcnt(0)
v_mfma_f32_16x16x32_bf16 v[76:79],a[148:151],a[20:23],v[76:79]
v_mfma_f32_16x16x32_bf16 v[84:87],a[148:151],a[44:47],0
v_mfma_f32_16x16x32_bf16 v[84:87],a[144:147],a[40:43],v[84:87]
v_mfma_f32_16x16x32_bf16 v[84:87],a[140:143],a[36:39],v[84:87]
v_mfma_f32_16x16x32_bf16 v[84:87],a[136:139],a[32:35],v[84:87]
buffer_load_dwordx4 v8,s[4:7],s20 offen offset:2048 lds
v_mfma_f32_16x16x32_bf16 v[84:87],a[132:135],a[28:31],v[84:87]
s_add_u32 s20,s20,12288
v_mfma_f32_16x16x32_bf16 v[84:87],a[128:131],a[24:27],v[84:87]
v_mfma_f32_16x16x32_bf16 v[92:95],a[128:131],a[48:51],0
v_mfma_f32_16x16x32_bf16 v[92:95],a[132:135],a[52:55],v[92:95]
v_mfma_f32_16x16x32_bf16 v[92:95],a[136:139],a[56:59],v[92:95]
v_mfma_f32_16x16x32_bf16 v[92:95],a[140:143],a[60:63],v[92:95]
ds_read_b64_tr_b16 a[120:121],v2 offset:0
v_mfma_f32_16x16x32_bf16 v[92:95],a[144:147],a[64:67],v[92:95]
ds_read_b64_tr_b16 a[122:123],v2 offset:6144
v_mfma_f32_16x16x32_bf16 v[92:95],a[148:151],a[68:71],v[92:95]
v_mfma_f32_16x16x32_bf16 v[100:103],a[148:151],a[92:95],0
ds_read_b64_tr_b16 a[124:125],v3 offset:0
v_mfma_f32_16x16x32_bf16 v[100:103],a[144:147],a[88:91],v[100:103]
ds_read_b64_tr_b16 a[126:127],v3 offset:6144
v_mfma_f32_16x16x32_bf16 v[100:103],a[140:143],a[84:87],v[100:103]
v_mfma_f32_16x16x32_bf16 v[100:103],a[136:139],a[80:83],v[100:103]
v_mfma_f32_16x16x32_bf16 v[100:103],a[132:135],a[76:79],v[100:103]
v_mfma_f32_16x16x32_bf16 v[100:103],a[128:131],a[72:75],v[100:103]
v_mfma_f32_16x16x32_bf16 v[108:111],a[128:131],a[96:99],0
ds_read_b64_tr_b16 a[128:129],v4 offset:0
v_mfma_f32_16x16x32_bf16 v[108:111],a[132:135],a[100:103],v[108:111]
ds_read_b64_tr_b16 a[130:131],v4 offset:6144
v_mfma_f32_16x16x32_bf16 v[108:111],a[136:139],a[104:107],v[108:111]
ds_read_b64_tr_b16 a[132:133],v5 offset:0
v_mfma_f32_16x16x32_bf16 v[108:111],a[140:143],a[108:111],v[108:111]
ds_read_b64_tr_b16 a[134:135],v5 offset:6144
v_mfma_f32_16x16x32_bf16 v[108:111],a[144:147],a[112:115],v[108:111]
v_mfma_f32_16x16x32_bf16 v[108:111],a[148:151],a[116:119],v[108:111]
s_waitcnt lgkmcnt(4)
v_mfma_f32_16x16x32_bf16 v[160:163],a[120:123],v[44:47],v[160:163]
s_add_u32 m0,s29,0
ds_read_b64_tr_b16 a[136:137],v2 offset:128
v_fma_f32 v90,v90,s36,v15
v_mfma_f32_16x16x32_bf16 v[164:167],a[124:127],v[44:47],v[164:167]
ds_read_b64_tr_b16 a[138:139],v2 offset:6272
v_fma_f32 v91,v91,s36,v15
v_mfma_f32_16x16x32_bf16 v[212:215],a[124:127],v[48:51],v[212:215]
ds_read_b64_tr_b16 a[140:141],v3 offset:128
v_fma_f32 v96,v96,s36,v16
v_mfma_f32_16x16x32_bf16 v[208:211],a[120:123],v[48:51],v[208:211]
ds_read_b64_tr_b16 a[142:143],v3 offset:6272
v_fma_f32 v97,v97,s36,v16
v_mfma_f32_16x16x32_bf16 v[112:115],a[120:123],v[52:55],v[112:115]
ds_read_b64_tr_b16 a[144:145],v4 offset:128
v_fma_f32 v98,v98,s36,v16
v_mfma_f32_16x16x32_bf16 v[116:119],a[124:127],v[52:55],v[116:119]
ds_read_b64_tr_b16 a[146:147],v4 offset:6272
v_fma_f32 v99,v99,s36,v16
v_mfma_f32_16x16x32_bf16 a[164:167],a[124:127],v[56:59],a[164:167]
ds_read_b64_tr_b16 a[148:149],v5 offset:128
v_fma_f32 v104,v104,s36,v17
v_mfma_f32_16x16x32_bf16 a[160:163],a[120:123],v[56:59],a[160:163]
buffer_load_dwordx4 v6,s[12:15],s28 offen offset:0 nt lds
v_mfma_f32_16x16x32_bf16 a[208:211],a[120:123],v[40:43],a[208:211]
ds_read_b64_tr_b16 a[150:151],v5 offset:6272
v_fma_f32 v105,v105,s36,v17
v_mfma_f32_16x16x32_bf16 a[212:215],a[124:127],v[40:43],a[212:215]
s_waitcnt lgkmcnt(5)
ds_read_b64_tr_b16 a[120:121],v2 offset:256
v_fma_f32 v106,v106,s36,v17
v_mfma_f32_16x16x32_bf16 a[216:219],a[128:131],v[40:43],a[216:219]
ds_read_b64_tr_b16 a[122:123],v2 offset:6400
v_fma_f32 v107,v107,s36,v17
v_mfma_f32_16x16x32_bf16 a[220:223],a[132:135],v[40:43],a[220:223]
ds_read_b64_tr_b16 a[124:125],v3 offset:256
v_fma_f32 v76,v76,s36,v13
v_mfma_f32_16x16x32_bf16 a[172:175],a[132:135],v[56:59],a[172:175]
ds_read_b64_tr_b16 a[126:127],v3 offset:6400
v_fma_f32 v77,v77,s36,v13
v_mfma_f32_16x16x32_bf16 a[168:171],a[128:131],v[56:59],a[168:171]
v_exp_f32 v90,v90
v_mfma_f32_16x16x32_bf16 v[120:123],a[128:131],v[52:55],v[120:123]
v_exp_f32 v91,v91
v_mfma_f32_16x16x32_bf16 v[124:127],a[132:135],v[52:55],v[124:127]
v_cvt_pk_bf16_f32 v29,v90,v91
v_fma_f32 v78,v78,s36,v13
v_mfma_f32_16x16x32_bf16 v[220:223],a[132:135],v[48:51],v[220:223]
v_exp_f32 v96,v96
v_mfma_f32_16x16x32_bf16 v[216:219],a[128:131],v[48:51],v[216:219]
buffer_load_dwordx4 v7,s[12:15],s28 offen offset:1024 nt lds
v_mfma_f32_16x16x32_bf16 v[168:171],a[128:131],v[44:47],v[168:171]
ds_read_b64_tr_b16 a[128:129],v4 offset:256
v_fma_f32 v79,v79,s36,v13
v_mfma_f32_16x16x32_bf16 v[172:175],a[132:135],v[44:47],v[172:175]
ds_read_b64_tr_b16 a[130:131],v4 offset:6400
v_fma_f32 v84,v84,s36,v14
v_mfma_f32_16x16x32_bf16 v[176:179],a[136:139],v[44:47],v[176:179]
s_waitcnt lgkmcnt(2)
ds_read_b64_tr_b16 a[132:133],v5 offset:256
v_fma_f32 v85,v85,s36,v14
v_mfma_f32_16x16x32_bf16 v[180:183],a[140:143],v[44:47],v[180:183]
ds_read_b64_tr_b16 a[134:135],v5 offset:6400
v_fma_f32 v86,v86,s36,v14
v_mfma_f32_16x16x32_bf16 v[228:231],a[140:143],v[48:51],v[228:231]
v_exp_f32 v97,v97
v_mfma_f32_16x16x32_bf16 v[224:227],a[136:139],v[48:51],v[224:227]
v_exp_f32 v98,v98
v_mfma_f32_16x16x32_bf16 v[128:131],a[136:139],v[52:55],v[128:131]
v_exp_f32 v99,v99
v_mfma_f32_16x16x32_bf16 v[132:135],a[140:143],v[52:55],v[132:135]
v_cvt_pk_bf16_f32 v32,v96,v97
v_cvt_pk_bf16_f32 v33,v98,v99
v_mfma_f32_16x16x32_bf16 a[180:183],a[140:143],v[56:59],a[180:183]
v_exp_f32 v104,v104
v_mfma_f32_16x16x32_bf16 a[176:179],a[136:139],v[56:59],a[176:179]
buffer_load_dwordx4 v8,s[12:15],s28 offen offset:2048 nt lds
v_mfma_f32_16x16x32_bf16 a[224:227],a[136:139],v[40:43],a[224:227]
s_add_u32 s28,s28,3072
v_exp_f32 v105,v105
v_mfma_f32_16x16x32_bf16 a[228:231],a[140:143],v[40:43],a[228:231]
s_add_u32 s29,s29,3072
v_exp_f32 v106,v106
v_mfma_f32_16x16x32_bf16 a[232:235],a[144:147],v[40:43],a[232:235]
s_add_u32 m0,s23,0
v_exp_f32 v107,v107
v_mfma_f32_16x16x32_bf16 a[236:239],a[148:151],v[40:43],a[236:239]
v_cvt_pk_bf16_f32 v36,v104,v105
v_cvt_pk_bf16_f32 v37,v106,v107
v_mfma_f32_16x16x32_bf16 a[188:191],a[148:151],v[56:59],a[188:191]
v_exp_f32 v76,v76
v_mfma_f32_16x16x32_bf16 a[184:187],a[144:147],v[56:59],a[184:187]
v_exp_f32 v77,v77
v_mfma_f32_16x16x32_bf16 v[136:139],a[144:147],v[52:55],v[136:139]
v_exp_f32 v78,v78
v_mfma_f32_16x16x32_bf16 v[140:143],a[148:151],v[52:55],v[140:143]
v_exp_f32 v79,v79
v_mfma_f32_16x16x32_bf16 v[236:239],a[148:151],v[48:51],v[236:239]
v_cvt_pk_bf16_f32 v22,v76,v77
v_cvt_pk_bf16_f32 v23,v78,v79
v_mfma_f32_16x16x32_bf16 v[232:235],a[144:147],v[48:51],v[232:235]
v_fma_f32 v87,v87,s36,v14
v_fma_f32 v92,v92,s36,v15
v_mfma_f32_16x16x32_bf16 v[184:187],a[144:147],v[44:47],v[184:187]
v_exp_f32 v84,v84
v_mfma_f32_16x16x32_bf16 v[188:191],a[148:151],v[44:47],v[188:191]
s_waitcnt vmcnt(12) lgkmcnt(0)
v_exp_f32 v85,v85
v_mfma_f32_16x16x32_bf16 v[192:195],a[120:123],v[44:47],v[192:195]
s_barrier
v_mfma_f32_16x16x32_bf16 v[196:199],a[124:127],v[44:47],v[196:199]
ds_read_b128 a[136:139],v0 offset:24576
v_cvt_pk_bf16_f32 v26,v84,v85
v_mfma_f32_16x16x32_bf16 v[244:247],a[124:127],v[48:51],v[244:247]
ds_read_b128 a[140:143],v1 offset:24576
v_fma_f32 v93,v93,s36,v15
v_mfma_f32_16x16x32_bf16 v[240:243],a[120:123],v[48:51],v[240:243]
ds_read_b128 a[144:147],v0 offset:24704
v_fma_f32 v94,v94,s36,v15
v_mfma_f32_16x16x32_bf16 v[144:147],a[120:123],v[52:55],v[144:147]
ds_read_b128 a[148:151],v1 offset:24704
v_fma_f32 v95,v95,s36,v15
v_mfma_f32_16x16x32_bf16 v[148:151],a[124:127],v[52:55],v[148:151]
v_exp_f32 v86,v86
v_mfma_f32_16x16x32_bf16 a[196:199],a[124:127],v[56:59],a[196:199]
buffer_load_dwordx4 v6,s[8:11],s21 offen offset:0 lds
v_mfma_f32_16x16x32_bf16 a[192:195],a[120:123],v[56:59],a[192:195]
v_exp_f32 v87,v87
v_mfma_f32_16x16x32_bf16 a[240:243],a[120:123],v[40:43],a[240:243]
ds_read_b128 a[120:123],v0 offset:24832
v_cvt_pk_bf16_f32 v27,v86,v87
v_mfma_f32_16x16x32_bf16 a[244:247],a[124:127],v[40:43],a[244:247]
ds_read_b128 a[124:127],v1 offset:24832
v_fma_f32 v100,v100,s36,v16
v_smfmac_f32_16x16x64_bf16 v[60:63],a[152:155],v[20:27],v18
v_fma_f32 v101,v101,s36,v16
v_mfma_f32_16x16x32_bf16 a[248:251],a[128:131],v[40:43],a[248:251]
v_exp_f32 v92,v92
v_mfma_f32_16x16x32_bf16 a[252:255],a[132:135],v[40:43],a[252:255]
v_exp_f32 v93,v93
v_mfma_f32_16x16x32_bf16 a[204:207],a[132:135],v[56:59],a[204:207]
v_exp_f32 v94,v94
v_mfma_f32_16x16x32_bf16 a[200:203],a[128:131],v[56:59],a[200:203]
v_exp_f32 v95,v95
v_mfma_f32_16x16x32_bf16 v[152:155],a[128:131],v[52:55],v[152:155]
v_cvt_pk_bf16_f32 v30,v92,v93
v_cvt_pk_bf16_f32 v31,v94,v95
v_mfma_f32_16x16x32_bf16 v[156:159],a[132:135],v[52:55],v[156:159]
v_fma_f32 v102,v102,s36,v16
v_fma_f32 v103,v103,s36,v16
v_mfma_f32_16x16x32_bf16 v[252:255],a[132:135],v[48:51],v[252:255]
v_exp_f32 v100,v100
v_mfma_f32_16x16x32_bf16 v[248:251],a[128:131],v[48:51],v[248:251]
buffer_load_dwordx4 v7,s[8:11],s21 offen offset:1024 lds
v_mfma_f32_16x16x32_bf16 v[200:203],a[128:131],v[44:47],v[200:203]
ds_read_b128 a[128:131],v0 offset:30720
v_fma_f32 v108,v108,s36,v17
v_mfma_f32_16x16x32_bf16 v[204:207],a[132:135],v[44:47],v[204:207]
s_waitcnt lgkmcnt(1)
ds_read_b128 a[132:135],v1 offset:30720
v_fma_f32 v109,v109,s36,v17
v_mfma_f32_16x16x32_bf16 v[72:75],a[136:139],a[0:3],0
v_exp_f32 v101,v101
v_mfma_f32_16x16x32_bf16 v[72:75],a[140:143],a[4:7],v[72:75]
v_exp_f32 v102,v102
v_mfma_f32_16x16x32_bf16 v[72:75],a[144:147],a[8:11],v[72:75]
v_exp_f32 v103,v103
v_mfma_f32_16x16x32_bf16 v[72:75],a[148:151],a[12:15],v[72:75]
v_cvt_pk_bf16_f32 v34,v100,v101
v_cvt_pk_bf16_f32 v35,v102,v103
v_mfma_f32_16x16x32_bf16 v[72:75],a[120:123],a[16:19],v[72:75]
v_fma_f32 v110,v110,s36,v17
v_fma_f32 v111,v111,s36,v17
v_smfmac_f32_16x16x64_bf16 v[64:67],a[152:155],v[28:35],v18
v_mfma_f32_16x16x32_bf16 v[72:75],a[124:127],a[20:23],v[72:75]
v_exp_f32 v108,v108
v_mfma_f32_16x16x32_bf16 v[80:83],a[124:127],a[44:47],0
v_exp_f32 v109,v109
v_mfma_f32_16x16x32_bf16 v[80:83],a[120:123],a[40:43],v[80:83]
buffer_load_dwordx4 v8,s[8:11],s21 offen offset:2048 lds
v_mfma_f32_16x16x32_bf16 v[80:83],a[148:151],a[36:39],v[80:83]
s_add_u32 s21,s21,12288
v_exp_f32 v110,v110
v_mfma_f32_16x16x32_bf16 v[80:83],a[144:147],a[32:35],v[80:83]
s_add_u32 m0,s22,12288
v_exp_f32 v111,v111
v_mfma_f32_16x16x32_bf16 v[80:83],a[140:143],a[28:31],v[80:83]
v_cvt_pk_bf16_f32 v38,v108,v109
v_cvt_pk_bf16_f32 v39,v110,v111
v_mfma_f32_16x16x32_bf16 v[80:83],a[136:139],a[24:27],v[80:83]
v_fma_f32 v72,v72,s36,v13
v_fma_f32 v73,v73,s36,v13
v_mfma_f32_16x16x32_bf16 v[88:91],a[136:139],a[48:51],0
v_fma_f32 v74,v74,s36,v13
v_fma_f32 v75,v75,s36,v13
v_mfma_f32_16x16x32_bf16 v[88:91],a[140:143],a[52:55],v[88:91]
v_exp_f32 v72,v72
v_mfma_f32_16x16x32_bf16 v[88:91],a[144:147],a[56:59],v[88:91]
v_fma_f32 v80,v80,s36,v14
v_fma_f32 v81,v81,s36,v14
v_mfma_f32_16x16x32_bf16 v[88:91],a[148:151],a[60:63],v[88:91]
v_fma_f32 v82,v82,s36,v14
v_fma_f32 v83,v83,s36,v14
v_mfma_f32_16x16x32_bf16 v[88:91],a[120:123],a[64:67],v[88:91]
v_exp_f32 v73,v73
v_mfma_f32_16x16x32_bf16 v[88:91],a[124:127],a[68:71],v[88:91]
v_exp_f32 v74,v74
v_mfma_f32_16x16x32_bf16 v[96:99],a[124:127],a[92:95],0
v_exp_f32 v75,v75
v_mfma_f32_16x16x32_bf16 v[96:99],a[120:123],a[88:91],v[96:99]
buffer_load_dwordx4 v6,s[4:7],s20 offen offset:0 lds
v_mfma_f32_16x16x32_bf16 v[96:99],a[148:151],a[84:87],v[96:99]
v_exp_f32 v80,v80
v_mfma_f32_16x16x32_bf16 v[96:99],a[144:147],a[80:83],v[96:99]
v_fma_f32 v88,v88,s36,v15
v_fma_f32 v89,v89,s36,v15
v_mfma_f32_16x16x32_bf16 v[96:99],a[140:143],a[76:79],v[96:99]
v_exp_f32 v81,v81
v_mfma_f32_16x16x32_bf16 v[96:99],a[136:139],a[72:75],v[96:99]
v_exp_f32 v82,v82
v_mfma_f32_16x16x32_bf16 v[104:107],a[136:139],a[96:99],0
ds_read_b128 a[136:139],v0 offset:30848
v_cvt_pk_bf16_f32 v44,v72,v73
v_mfma_f32_16x16x32_bf16 v[104:107],a[140:143],a[100:103],v[104:107]
ds_read_b128 a[140:143],v1 offset:30848
v_cvt_pk_bf16_f32 v45,v74,v75
v_mfma_f32_16x16x32_bf16 v[104:107],a[144:147],a[104:107],v[104:107]
ds_read_b128 a[144:147],v0 offset:30976
v_cvt_pk_bf16_f32 v48,v80,v81
v_mfma_f32_16x16x32_bf16 v[104:107],a[148:151],a[108:111],v[104:107]
ds_read_b128 a[148:151],v1 offset:30976
v_mfma_f32_16x16x32_bf16 v[104:107],a[120:123],a[112:115],v[104:107]
v_exp_f32 v83,v83
v_mfma_f32_16x16x32_bf16 v[104:107],a[124:127],a[116:119],v[104:107]
s_waitcnt lgkmcnt(4)
v_exp_f32 v88,v88
v_mfma_f32_16x16x32_bf16 v[76:79],a[128:131],a[0:3],0
v_exp_f32 v89,v89
v_mfma_f32_16x16x32_bf16 v[76:79],a[132:135],a[4:7],v[76:79]
buffer_load_dwordx4 v7,s[4:7],s20 offen offset:1024 lds
s_waitcnt lgkmcnt(3)
v_mfma_f32_16x16x32_bf16 v[76:79],a[136:139],a[8:11],v[76:79]
s_waitcnt lgkmcnt(2)
v_cvt_pk_bf16_f32 v49,v82,v83
v_cvt_pk_bf16_f32 v52,v88,v89
v_mfma_f32_16x16x32_bf16 v[76:79],a[140:143],a[12:15],v[76:79]
s_waitcnt lgkmcnt(0)
v_mfma_f32_16x16x32_bf16 v[76:79],a[144:147],a[16:19],v[76:79]
v_mfma_f32_16x16x32_bf16 v[76:79],a[148:151],a[20:23],v[76:79]
v_mfma_f32_16x16x32_bf16 v[84:87],a[148:151],a[44:47],0
v_mfma_f32_16x16x32_bf16 v[84:87],a[144:147],a[40:43],v[84:87]
v_mfma_f32_16x16x32_bf16 v[84:87],a[140:143],a[36:39],v[84:87]
v_mfma_f32_16x16x32_bf16 v[84:87],a[136:139],a[32:35],v[84:87]
v_mfma_f32_16x16x32_bf16 v[84:87],a[132:135],a[28:31],v[84:87]
v_mfma_f32_16x16x32_bf16 v[84:87],a[128:131],a[24:27],v[84:87]
v_mfma_f32_16x16x32_bf16 v[92:95],a[128:131],a[48:51],0
buffer_load_dwordx4 v8,s[4:7],s20 offen offset:2048 lds
v_mfma_f32_16x16x32_bf16 v[92:95],a[132:135],a[52:55],v[92:95]
s_add_u32 s20,s20,12288
v_mfma_f32_16x16x32_bf16 v[92:95],a[136:139],a[56:59],v[92:95]
v_mfma_f32_16x16x32_bf16 v[92:95],a[140:143],a[60:63],v[92:95]
v_mfma_f32_16x16x32_bf16 v[92:95],a[144:147],a[64:67],v[92:95]
v_mfma_f32_16x16x32_bf16 v[92:95],a[148:151],a[68:71],v[92:95]
v_mfma_f32_16x16x32_bf16 v[100:103],a[148:151],a[92:95],0
ds_read_b64_tr_b16 a[120:121],v2 offset:12288
v_mfma_f32_16x16x32_bf16 v[100:103],a[144:147],a[88:91],v[100:103]
ds_read_b64_tr_b16 a[122:123],v2 offset:18432
v_mfma_f32_16x16x32_bf16 v[100:103],a[140:143],a[84:87],v[100:103]
v_mfma_f32_16x16x32_bf16 v[100:103],a[136:139],a[80:83],v[100:103]
ds_read_b64_tr_b16 a[124:125],v3 offset:12288
v_mfma_f32_16x16x32_bf16 v[100:103],a[132:135],a[76:79],v[100:103]
ds_read_b64_tr_b16 a[126:127],v3 offset:18432
v_mfma_f32_16x16x32_bf16 v[100:103],a[128:131],a[72:75],v[100:103]
v_mfma_f32_16x16x32_bf16 v[108:111],a[128:131],a[96:99],0
ds_read_b64_tr_b16 a[128:129],v4 offset:12288
v_mfma_f32_16x16x32_bf16 v[108:111],a[132:135],a[100:103],v[108:111]
ds_read_b64_tr_b16 a[130:131],v4 offset:18432
v_mfma_f32_16x16x32_bf16 v[108:111],a[136:139],a[104:107],v[108:111]
ds_read_b64_tr_b16 a[132:133],v5 offset:12288
v_mfma_f32_16x16x32_bf16 v[108:111],a[140:143],a[108:111],v[108:111]
ds_read_b64_tr_b16 a[134:135],v5 offset:18432
v_mfma_f32_16x16x32_bf16 v[108:111],a[144:147],a[112:115],v[108:111]
v_mfma_f32_16x16x32_bf16 v[108:111],a[148:151],a[116:119],v[108:111]
s_waitcnt lgkmcnt(4)
v_mfma_f32_16x16x32_bf16 v[160:163],a[120:123],v[20:23],v[160:163]
ds_read_b128 a[156:159],v10 offset:3072
v_mbcnt_lo_u32_b32 v19,-1,0
v_mfma_f32_16x16x32_bf16 v[164:167],a[124:127],v[20:23],v[164:167]
ds_read_b64_tr_b16 a[138:139],v2 offset:18560
v_mbcnt_hi_u32_b32 v19,-1,v19
v_mfma_f32_16x16x32_bf16 v[212:215],a[124:127],v[24:27],v[212:215]
ds_read_b64_tr_b16 a[136:137],v2 offset:12416
v_min_u32 v19,7,v19
v_mfma_f32_16x16x32_bf16 v[208:211],a[120:123],v[24:27],v[208:211]
ds_read_b64_tr_b16 a[140:141],v3 offset:12416
v_lshl_add_u32 v19,v19,7,s48
v_mfma_f32_16x16x32_bf16 v[112:115],a[120:123],v[28:31],v[112:115]
ds_read_b64_tr_b16 a[142:143],v3 offset:18560
v_min_u32 v19,L_codeend-L_first-4,v19
v_mfma_f32_16x16x32_bf16 v[116:119],a[124:127],v[28:31],v[116:119]
ds_read_b64_tr_b16 a[144:145],v4 offset:12416
v_fma_f32 v91,v91,s36,v15
v_mfma_f32_16x16x32_bf16 a[164:167],a[124:127],v[32:35],a[164:167]
ds_read_b64_tr_b16 a[146:147],v4 offset:18560
v_fma_f32 v90,v90,s36,v15
v_mfma_f32_16x16x32_bf16 a[160:163],a[120:123],v[32:35],a[160:163]
ds_read_b64_tr_b16 a[150:151],v5 offset:18560
v_fma_f32 v99,v99,s36,v16
v_mfma_f32_16x16x32_bf16 a[208:211],a[120:123],v[36:39],a[208:211]
ds_read_b64_tr_b16 a[148:149],v5 offset:12416
v_fma_f32 v96,v96,s36,v16
v_mfma_f32_16x16x32_bf16 a[212:215],a[124:127],v[36:39],a[212:215]
s_waitcnt lgkmcnt(6)
ds_read_b64_tr_b16 a[122:123],v2 offset:18688
v_fma_f32 v98,v98,s36,v16
v_mfma_f32_16x16x32_bf16 a[216:219],a[128:131],v[36:39],a[216:219]
ds_read_b64_tr_b16 a[120:121],v2 offset:12544
v_fma_f32 v97,v97,s36,v16
v_mfma_f32_16x16x32_bf16 a[220:223],a[132:135],v[36:39],a[220:223]
ds_read_b64_tr_b16 a[126:127],v3 offset:18688
v_fma_f32 v107,v107,s36,v17
v_mfma_f32_16x16x32_bf16 a[172:175],a[132:135],v[32:35],a[172:175]
ds_read_b64_tr_b16 a[124:125],v3 offset:12544
v_fma_f32 v105,v105,s36,v17
v_mfma_f32_16x16x32_bf16 a[168:171],a[128:131],v[32:35],a[168:171]
v_exp_f32 v90,v90
v_mfma_f32_16x16x32_bf16 v[120:123],a[128:131],v[28:31],v[120:123]
v_exp_f32 v91,v91
v_mfma_f32_16x16x32_bf16 v[124:127],a[132:135],v[28:31],v[124:127]
v_cvt_pk_bf16_f32 v53,v90,v91
v_fma_f32 v106,v106,s36,v17
v_mfma_f32_16x16x32_bf16 v[220:223],a[132:135],v[24:27],v[220:223]
v_exp_f32 v97,v97
v_mfma_f32_16x16x32_bf16 v[216:219],a[128:131],v[24:27],v[216:219]
buffer_store_dwordx4 a[156:159],v9,s[16:19],s27 offen offset:0 nt
v_exp_f32 v98,v98
v_fma_f32 v104,v104,s36,v17
v_mfma_f32_16x16x32_bf16 v[168:171],a[128:131],v[20:23],v[168:171]
ds_read_b128 a[156:159],v10 offset:4096
v_fma_f32 v78,v78,s36,v13
v_mfma_f32_16x16x32_bf16 v[172:175],a[132:135],v[20:23],v[172:175]
global_load_dword v19,v19,s[46:47]
v_mfma_f32_16x16x32_bf16 v[176:179],a[136:139],v[20:23],v[176:179]
s_waitcnt lgkmcnt(1)
ds_read_b64_tr_b16 a[128:129],v4 offset:12544
v_fma_f32 v76,v76,s36,v13
v_mfma_f32_16x16x32_bf16 v[180:183],a[140:143],v[20:23],v[180:183]
ds_read_b64_tr_b16 a[132:133],v5 offset:12544
v_fma_f32 v77,v77,s36,v13
v_mfma_f32_16x16x32_bf16 v[228:231],a[140:143],v[24:27],v[228:231]
ds_read_b64_tr_b16 a[130:131],v4 offset:18688
v_fma_f32 v79,v79,s36,v13
v_mfma_f32_16x16x32_bf16 v[224:227],a[136:139],v[24:27],v[224:227]
ds_read_b64_tr_b16 a[134:135],v5 offset:18688
v_fma_f32 v86,v86,s36,v14
v_mfma_f32_16x16x32_bf16 v[128:131],a[136:139],v[28:31],v[128:131]
v_exp_f32 v99,v99
v_mfma_f32_16x16x32_bf16 v[132:135],a[140:143],v[28:31],v[132:135]
v_exp_f32 v96,v96
v_mfma_f32_16x16x32_bf16 a[180:183],a[140:143],v[32:35],a[180:183]
s_waitcnt lgkmcnt(4)
buffer_store_dwordx4 a[156:159],v9,s[16:19],s27 offen offset:128 nt
v_cvt_pk_bf16_f32 v57,v98,v99
v_cvt_pk_bf16_f32 v56,v96,v97
v_fma_f32 v87,v87,s36,v14
v_mfma_f32_16x16x32_bf16 a[176:179],a[136:139],v[32:35],a[176:179]
ds_read_b128 a[156:159],v10 offset:5120
v_fma_f32 v84,v84,s36,v14
v_mfma_f32_16x16x32_bf16 a[224:227],a[136:139],v[36:39],a[224:227]
v_exp_f32 v105,v105
v_mfma_f32_16x16x32_bf16 a[228:231],a[140:143],v[36:39],a[228:231]
v_exp_f32 v104,v104
v_mfma_f32_16x16x32_bf16 a[232:235],a[144:147],v[36:39],a[232:235]
v_exp_f32 v107,v107
v_mfma_f32_16x16x32_bf16 a[236:239],a[148:151],v[36:39],a[236:239]
v_exp_f32 v106,v106
v_mfma_f32_16x16x32_bf16 a[188:191],a[148:151],v[32:35],a[188:191]
v_cvt_pk_bf16_f32 v41,v106,v107
v_cvt_pk_bf16_f32 v40,v104,v105
v_mfma_f32_16x16x32_bf16 a[184:187],a[144:147],v[32:35],a[184:187]
v_exp_f32 v79,v79
v_mfma_f32_16x16x32_bf16 v[136:139],a[144:147],v[28:31],v[136:139]
v_exp_f32 v76,v76
v_mfma_f32_16x16x32_bf16 v[140:143],a[148:151],v[28:31],v[140:143]
s_waitcnt lgkmcnt(0)
buffer_store_dwordx4 a[156:159],v9,s[16:19],s27 offen offset:256 nt
v_exp_f32 v78,v78
v_fma_f32 v85,v85,s36,v14
v_mfma_f32_16x16x32_bf16 v[236:239],a[148:151],v[24:27],v[236:239]
s_add_u32 s27,s27,3072
v_exp_f32 v77,v77
v_mfma_f32_16x16x32_bf16 v[232:235],a[144:147],v[24:27],v[232:235]
s_waitcnt vmcnt(13)
v_cvt_pk_bf16_f32 v47,v78,v79
v_cvt_pk_bf16_f32 v46,v76,v77
v_mfma_f32_16x16x32_bf16 v[184:187],a[144:147],v[20:23],v[184:187]
s_barrier
v_mfma_f32_16x16x32_bf16 v[188:191],a[148:151],v[20:23],v[188:191]
s_add_u32 m0,s23,12288
ds_read_b128 a[136:139],v0 offset:0
v_fma_f32 v94,v94,s36,v15
v_mfma_f32_16x16x32_bf16 v[192:195],a[120:123],v[20:23],v[192:195]
ds_read_b128 a[140:143],v1 offset:0
v_fma_f32 v95,v95,s36,v15
v_mfma_f32_16x16x32_bf16 v[196:199],a[124:127],v[20:23],v[196:199]
ds_read_b128 a[144:147],v0 offset:128
v_fma_f32 v92,v92,s36,v15
v_mfma_f32_16x16x32_bf16 v[244:247],a[124:127],v[24:27],v[244:247]
ds_read_b128 a[148:151],v1 offset:128
v_fma_f32 v93,v93,s36,v15
v_mfma_f32_16x16x32_bf16 v[240:243],a[120:123],v[24:27],v[240:243]
v_exp_f32 v84,v84
v_mfma_f32_16x16x32_bf16 v[144:147],a[120:123],v[28:31],v[144:147]
buffer_load_dwordx4 v6,s[8:11],s21 offen offset:0 lds
v_mfma_f32_16x16x32_bf16 v[148:151],a[124:127],v[28:31],v[148:151]
v_exp_f32 v85,v85
v_mfma_f32_16x16x32_bf16 a[196:199],a[124:127],v[32:35],a[196:199]
v_exp_f32 v87,v87
v_mfma_f32_16x16x32_bf16 a[192:195],a[120:123],v[32:35],a[192:195]
v_exp_f32 v86,v86
v_mfma_f32_16x16x32_bf16 a[240:243],a[120:123],v[36:39],a[240:243]
ds_read_b128 a[120:123],v0 offset:256
v_cvt_pk_bf16_f32 v51,v86,v87
v_mfma_f32_16x16x32_bf16 a[244:247],a[124:127],v[36:39],a[244:247]
ds_read_b128 a[124:127],v1 offset:256
v_cvt_pk_bf16_f32 v50,v84,v85
v_mfma_f32_16x16x32_bf16 a[248:251],a[128:131],v[36:39],a[248:251]
v_exp_f32 v92,v92
v_smfmac_f32_16x16x64_bf16 v[60:63],a[152:155],v[44:51],v18
v_fma_f32 v103,v103,s36,v16
v_mfma_f32_16x16x32_bf16 a[252:255],a[132:135],v[36:39],a[252:255]
v_exp_f32 v93,v93
v_mfma_f32_16x16x32_bf16 a[204:207],a[132:135],v[32:35],a[204:207]
v_exp_f32 v94,v94
v_mfma_f32_16x16x32_bf16 a[200:203],a[128:131],v[32:35],a[200:203]
v_exp_f32 v95,v95
v_mfma_f32_16x16x32_bf16 v[152:155],a[128:131],v[28:31],v[152:155]
buffer_load_dwordx4 v7,s[8:11],s21 offen offset:1024 lds
v_mfma_f32_16x16x32_bf16 v[156:159],a[132:135],v[28:31],v[156:159]
v_cvt_pk_bf16_f32 v55,v94,v95
v_cvt_pk_bf16_f32 v54,v92,v93
v_mfma_f32_16x16x32_bf16 v[252:255],a[132:135],v[24:27],v[252:255]
v_exp_f32 v103,v103
v_mfma_f32_16x16x32_bf16 v[248:251],a[128:131],v[24:27],v[248:251]
v_fma_f32 v101,v101,s36,v16
v_fma_f32 v102,v102,s36,v16
v_mfma_f32_16x16x32_bf16 v[200:203],a[128:131],v[20:23],v[200:203]
ds_read_b128 a[128:131],v0 offset:6144
v_fma_f32 v100,v100,s36,v16
v_mfma_f32_16x16x32_bf16 v[204:207],a[132:135],v[20:23],v[204:207]
s_waitcnt lgkmcnt(1)
ds_read_b128 a[132:135],v1 offset:6144
v_fma_f32 v109,v109,s36,v17
v_mfma_f32_16x16x32_bf16 v[72:75],a[136:139],a[0:3],0
v_exp_f32 v100,v100
v_mfma_f32_16x16x32_bf16 v[72:75],a[140:143],a[4:7],v[72:75]
v_exp_f32 v101,v101
v_mfma_f32_16x16x32_bf16 v[72:75],a[144:147],a[8:11],v[72:75]
v_exp_f32 v102,v102
v_mfma_f32_16x16x32_bf16 v[72:75],a[148:151],a[12:15],v[72:75]
v_cvt_pk_bf16_f32 v59,v102,v103
v_cvt_pk_bf16_f32 v58,v100,v101
v_mfma_f32_16x16x32_bf16 v[72:75],a[120:123],a[16:19],v[72:75]
v_exp_f32 v109,v109
v_smfmac_f32_16x16x64_bf16 v[64:67],a[152:155],v[52:59],v18
v_fma_f32 v110,v110,s36,v17
v_mfma_f32_16x16x32_bf16 v[72:75],a[124:127],a[20:23],v[72:75]
buffer_load_dwordx4 v8,s[8:11],s21 offen offset:2048 lds
v_mfma_f32_16x16x32_bf16 v[80:83],a[124:127],a[44:47],0
s_add_u32 s21,s21,12288
v_exp_f32 v110,v110
v_mfma_f32_16x16x32_bf16 v[80:83],a[120:123],a[40:43],v[80:83]
s_add_u32 m0,s22,24576
v_fma_f32 v111,v111,s36,v17
v_fma_f32 v108,v108,s36,v17
v_mfma_f32_16x16x32_bf16 v[80:83],a[148:151],a[36:39],v[80:83]
v_exp_f32 v111,v111
v_mfma_f32_16x16x32_bf16 v[80:83],a[144:147],a[32:35],v[80:83]
v_exp_f32 v108,v108
v_mfma_f32_16x16x32_bf16 v[80:83],a[140:143],a[28:31],v[80:83]
v_cvt_pk_bf16_f32 v42,v108,v109
v_cvt_pk_bf16_f32 v43,v110,v111
v_mfma_f32_16x16x32_bf16 v[80:83],a[136:139],a[24:27],v[80:83]
v_fma_f32 v73,v73,s36,v13
v_fma_f32 v72,v72,s36,v13
v_smfmac_f32_16x16x64_bf16 v[68:71],a[152:155],v[36:43],v18
v_fma_f32 v74,v74,s36,v13
v_mfma_f32_16x16x32_bf16 v[88:91],a[136:139],a[48:51],0
v_exp_f32 v72,v72
v_mfma_f32_16x16x32_bf16 v[88:91],a[140:143],a[52:55],v[88:91]
v_exp_f32 v74,v74
v_mfma_f32_16x16x32_bf16 v[88:91],a[144:147],a[56:59],v[88:91]
v_exp_f32 v73,v73
v_mfma_f32_16x16x32_bf16 v[88:91],a[148:151],a[60:63],v[88:91]
v_fma_f32 v82,v82,s36,v14
v_fma_f32 v81,v81,s36,v14
v_mfma_f32_16x16x32_bf16 v[88:91],a[120:123],a[64:67],v[88:91]
buffer_load_dwordx4 v6,s[4:7],s20 offen offset:0 lds
v_mfma_f32_16x16x32_bf16 v[88:91],a[124:127],a[68:71],v[88:91]
v_exp_f32 v82,v82
v_mfma_f32_16x16x32_bf16 v[96:99],a[124:127],a[92:95],0
v_exp_f32 v81,v81
v_mfma_f32_16x16x32_bf16 v[96:99],a[120:123],a[88:91],v[96:99]
v_fma_f32 v80,v80,s36,v14
v_fma_f32 v75,v75,s36,v13
v_mfma_f32_16x16x32_bf16 v[96:99],a[148:151],a[84:87],v[96:99]
v_exp_f32 v75,v75
v_mfma_f32_16x16x32_bf16 v[96:99],a[144:147],a[80:83],v[96:99]
v_exp_f32 v80,v80
v_mfma_f32_16x16x32_bf16 v[96:99],a[140:143],a[76:79],v[96:99]
v_fma_f32 v83,v83,s36,v14
v_fma_f32 v88,v88,s36,v15
v_mfma_f32_16x16x32_bf16 v[96:99],a[136:139],a[72:75],v[96:99]
v_exp_f32 v83,v83
v_mfma_f32_16x16x32_bf16 v[104:107],a[136:139],a[96:99],0
ds_read_b128 a[136:139],v0 offset:6272
v_fma_f32 v89,v89,s36,v15
v_mfma_f32_16x16x32_bf16 v[104:107],a[140:143],a[100:103],v[104:107]
ds_read_b128 a[140:143],v1 offset:6272
v_cvt_pk_bf16_f32 v20,v72,v73
v_mfma_f32_16x16x32_bf16 v[104:107],a[144:147],a[104:107],v[104:107]
ds_read_b128 a[144:147],v0 offset:6400
v_cvt_pk_bf16_f32 v24,v80,v81
v_mfma_f32_16x16x32_bf16 v[104:107],a[148:151],a[108:111],v[104:107]
buffer_load_dwordx4 v7,s[4:7],s20 offen offset:1024 lds
v_mfma_f32_16x16x32_bf16 v[104:107],a[120:123],a[112:115],v[104:107]
ds_read_b128 a[148:151],v1 offset:6400
v_cvt_pk_bf16_f32 v25,v82,v83
v_mfma_f32_16x16x32_bf16 v[104:107],a[124:127],a[116:119],v[104:107]
s_waitcnt lgkmcnt(4)
v_exp_f32 v88,v88
v_mfma_f32_16x16x32_bf16 v[76:79],a[128:131],a[0:3],0
v_exp_f32 v89,v89
v_mfma_f32_16x16x32_bf16 v[76:79],a[132:135],a[4:7],v[76:79]
s_waitcnt lgkmcnt(3)
v_cvt_pk_bf16_f32 v28,v88,v89
v_cvt_pk_bf16_f32 v21,v74,v75
v_mfma_f32_16x16x32_bf16 v[76:79],a[136:139],a[8:11],v[76:79]
s_waitcnt lgkmcnt(2)
v_mfma_f32_16x16x32_bf16 v[76:79],a[140:143],a[12:15],v[76:79]
s_waitcnt lgkmcnt(1)
v_mfma_f32_16x16x32_bf16 v[76:79],a[144:147],a[16:19],v[76:79]
s_waitcnt lgkmcnt(0)
v_mfma_f32_16x16x32_bf16 v[76:79],a[148:151],a[20:23],v[76:79]
v_mfma_f32_16x16x32_bf16 v[84:87],a[148:151],a[44:47],0
v_mfma_f32_16x16x32_bf16 v[84:87],a[144:147],a[40:43],v[84:87]
v_mfma_f32_16x16x32_bf16 v[84:87],a[140:143],a[36:39],v[84:87]
buffer_load_dwordx4 v8,s[4:7],s20 offen offset:2048 lds
v_mfma_f32_16x16x32_bf16 v[84:87],a[136:139],a[32:35],v[84:87]
s_add_u32 s20,s20,12288
v_mfma_f32_16x16x32_bf16 v[84:87],a[132:135],a[28:31],v[84:87]
v_mfma_f32_16x16x32_bf16 v[84:87],a[128:131],a[24:27],v[84:87]
v_mfma_f32_16x16x32_bf16 v[92:95],a[128:131],a[48:51],0
v_mfma_f32_16x16x32_bf16 v[92:95],a[132:135],a[52:55],v[92:95]
v_mfma_f32_16x16x32_bf16 v[92:95],a[136:139],a[56:59],v[92:95]
ds_read_b64_tr_b16 a[122:123],v2 offset:30720
v_mfma_f32_16x16x32_bf16 v[92:95],a[140:143],a[60:63],v[92:95]
ds_read_b64_tr_b16 a[120:121],v2 offset:24576
v_mfma_f32_16x16x32_bf16 v[92:95],a[144:147],a[64:67],v[92:95]
ds_read_b64_tr_b16 a[124:125],v3 offset:24576
v_mfma_f32_16x16x32_bf16 v[92:95],a[148:151],a[68:71],v[92:95]
ds_read_b64_tr_b16 a[126:127],v3 offset:30720
v_mfma_f32_16x16x32_bf16 v[100:103],a[148:151],a[92:95],0
v_mfma_f32_16x16x32_bf16 v[100:103],a[144:147],a[88:91],v[100:103]
v_mfma_f32_16x16x32_bf16 v[100:103],a[140:143],a[84:87],v[100:103]
v_mfma_f32_16x16x32_bf16 v[100:103],a[136:139],a[80:83],v[100:103]
v_mfma_f32_16x16x32_bf16 v[100:103],a[132:135],a[76:79],v[100:103]
v_mfma_f32_16x16x32_bf16 v[100:103],a[128:131],a[72:75],v[100:103]
v_mfma_f32_16x16x32_bf16 v[108:111],a[128:131],a[96:99],0
ds_read_b64_tr_b16 a[128:129],v4 offset:24576
v_mfma_f32_16x16x32_bf16 v[108:111],a[132:135],a[100:103],v[108:111]
ds_read_b64_tr_b16 a[130:131],v4 offset:30720
v_mfma_f32_16x16x32_bf16 v[108:111],a[136:139],a[104:107],v[108:111]
ds_read_b64_tr_b16 a[132:133],v5 offset:24576
v_mfma_f32_16x16x32_bf16 v[108:111],a[140:143],a[108:111],v[108:111]
ds_read_b64_tr_b16 a[134:135],v5 offset:30720
v_mfma_f32_16x16x32_bf16 v[108:111],a[144:147],a[112:115],v[108:111]
v_mfma_f32_16x16x32_bf16 v[108:111],a[148:151],a[116:119],v[108:111]
s_waitcnt lgkmcnt(4)
v_mfma_f32_16x16x32_bf16 v[160:163],a[120:123],v[44:47],v[160:163]
s_add_u32 m0,s29,0
ds_read_b64_tr_b16 a[136:137],v2 offset:24704
v_fma_f32 v90,v90,s36,v15
v_mfma_f32_16x16x32_bf16 v[164:167],a[124:127],v[44:47],v[164:167]
ds_read_b64_tr_b16 a[138:139],v2 offset:30848
v_fma_f32 v91,v91,s36,v15
v_mfma_f32_16x16x32_bf16 v[212:215],a[124:127],v[48:51],v[212:215]
ds_read_b64_tr_b16 a[140:141],v3 offset:24704
v_fma_f32 v96,v96,s36,v16
v_mfma_f32_16x16x32_bf16 v[208:211],a[120:123],v[48:51],v[208:211]
ds_read_b64_tr_b16 a[142:143],v3 offset:30848
v_fma_f32 v97,v97,s36,v16
v_mfma_f32_16x16x32_bf16 v[112:115],a[120:123],v[52:55],v[112:115]
ds_read_b64_tr_b16 a[144:145],v4 offset:24704
v_fma_f32 v98,v98,s36,v16
v_mfma_f32_16x16x32_bf16 v[116:119],a[124:127],v[52:55],v[116:119]
ds_read_b64_tr_b16 a[146:147],v4 offset:30848
v_fma_f32 v99,v99,s36,v16
v_mfma_f32_16x16x32_bf16 a[164:167],a[124:127],v[56:59],a[164:167]
ds_read_b64_tr_b16 a[148:149],v5 offset:24704
v_fma_f32 v104,v104,s36,v17
v_mfma_f32_16x16x32_bf16 a[160:163],a[120:123],v[56:59],a[160:163]
buffer_load_dwordx4 v6,s[12:15],s28 offen offset:0 nt lds
v_mfma_f32_16x16x32_bf16 a[208:211],a[120:123],v[40:43],a[208:211]
ds_read_b64_tr_b16 a[150:151],v5 offset:30848
v_fma_f32 v105,v105,s36,v17
v_mfma_f32_16x16x32_bf16 a[212:215],a[124:127],v[40:43],a[212:215]
s_waitcnt lgkmcnt(5)
ds_read_b64_tr_b16 a[120:121],v2 offset:24832
v_fma_f32 v106,v106,s36,v17
v_mfma_f32_16x16x32_bf16 a[216:219],a[128:131],v[40:43],a[216:219]
ds_read_b64_tr_b16 a[122:123],v2 offset:30976
v_fma_f32 v107,v107,s36,v17
v_mfma_f32_16x16x32_bf16 a[220:223],a[132:135],v[40:43],a[220:223]
ds_read_b64_tr_b16 a[124:125],v3 offset:24832
v_fma_f32 v76,v76,s36,v13
v_mfma_f32_16x16x32_bf16 a[172:175],a[132:135],v[56:59],a[172:175]
ds_read_b64_tr_b16 a[126:127],v3 offset:30976
v_fma_f32 v77,v77,s36,v13
v_mfma_f32_16x16x32_bf16 a[168:171],a[128:131],v[56:59],a[168:171]
v_exp_f32 v90,v90
v_mfma_f32_16x16x32_bf16 v[120:123],a[128:131],v[52:55],v[120:123]
v_exp_f32 v91,v91
v_mfma_f32_16x16x32_bf16 v[124:127],a[132:135],v[52:55],v[124:127]
v_cvt_pk_bf16_f32 v29,v90,v91
v_fma_f32 v78,v78,s36,v13
v_mfma_f32_16x16x32_bf16 v[220:223],a[132:135],v[48:51],v[220:223]
v_exp_f32 v96,v96
v_mfma_f32_16x16x32_bf16 v[216:219],a[128:131],v[48:51],v[216:219]
buffer_load_dwordx4 v7,s[12:15],s28 offen offset:1024 nt lds
v_mfma_f32_16x16x32_bf16 v[168:171],a[128:131],v[44:47],v[168:171]
ds_read_b64_tr_b16 a[128:129],v4 offset:24832
v_fma_f32 v79,v79,s36,v13
v_mfma_f32_16x16x32_bf16 v[172:175],a[132:135],v[44:47],v[172:175]
ds_read_b64_tr_b16 a[130:131],v4 offset:30976
v_fma_f32 v84,v84,s36,v14
v_mfma_f32_16x16x32_bf16 v[176:179],a[136:139],v[44:47],v[176:179]
s_waitcnt lgkmcnt(2)
ds_read_b64_tr_b16 a[132:133],v5 offset:24832
v_fma_f32 v85,v85,s36,v14
v_mfma_f32_16x16x32_bf16 v[180:183],a[140:143],v[44:47],v[180:183]
ds_read_b64_tr_b16 a[134:135],v5 offset:30976
v_fma_f32 v86,v86,s36,v14
v_mfma_f32_16x16x32_bf16 v[228:231],a[140:143],v[48:51],v[228:231]
v_exp_f32 v97,v97
v_mfma_f32_16x16x32_bf16 v[224:227],a[136:139],v[48:51],v[224:227]
v_exp_f32 v98,v98
v_mfma_f32_16x16x32_bf16 v[128:131],a[136:139],v[52:55],v[128:131]
v_exp_f32 v99,v99
v_mfma_f32_16x16x32_bf16 v[132:135],a[140:143],v[52:55],v[132:135]
v_cvt_pk_bf16_f32 v32,v96,v97
v_cvt_pk_bf16_f32 v33,v98,v99
v_mfma_f32_16x16x32_bf16 a[180:183],a[140:143],v[56:59],a[180:183]
v_exp_f32 v104,v104
v_mfma_f32_16x16x32_bf16 a[176:179],a[136:139],v[56:59],a[176:179]
buffer_load_dwordx4 v8,s[12:15],s28 offen offset:2048 nt lds
v_mfma_f32_16x16x32_bf16 a[224:227],a[136:139],v[40:43],a[224:227]
s_add_u32 s28,s28,3072
v_exp_f32 v105,v105
v_mfma_f32_16x16x32_bf16 a[228:231],a[140:143],v[40:43],a[228:231]
s_add_u32 s29,s29,3072
v_exp_f32 v106,v106
v_mfma_f32_16x16x32_bf16 a[232:235],a[144:147],v[40:43],a[232:235]
s_add_u32 m0,s23,24576
v_exp_f32 v107,v107
v_mfma_f32_16x16x32_bf16 a[236:239],a[148:151],v[40:43],a[236:239]
v_cvt_pk_bf16_f32 v36,v104,v105
v_cvt_pk_bf16_f32 v37,v106,v107
v_mfma_f32_16x16x32_bf16 a[188:191],a[148:151],v[56:59],a[188:191]
v_exp_f32 v76,v76
v_mfma_f32_16x16x32_bf16 a[184:187],a[144:147],v[56:59],a[184:187]
v_exp_f32 v77,v77
v_mfma_f32_16x16x32_bf16 v[136:139],a[144:147],v[52:55],v[136:139]
v_exp_f32 v78,v78
v_mfma_f32_16x16x32_bf16 v[140:143],a[148:151],v[52:55],v[140:143]
v_exp_f32 v79,v79
v_mfma_f32_16x16x32_bf16 v[236:239],a[148:151],v[48:51],v[236:239]
v_cvt_pk_bf16_f32 v22,v76,v77
v_cvt_pk_bf16_f32 v23,v78,v79
v_mfma_f32_16x16x32_bf16 v[232:235],a[144:147],v[48:51],v[232:235]
v_fma_f32 v87,v87,s36,v14
v_fma_f32 v92,v92,s36,v15
v_mfma_f32_16x16x32_bf16 v[184:187],a[144:147],v[44:47],v[184:187]
v_exp_f32 v84,v84
v_mfma_f32_16x16x32_bf16 v[188:191],a[148:151],v[44:47],v[188:191]
s_waitcnt vmcnt(13) lgkmcnt(0)
v_exp_f32 v85,v85
v_mfma_f32_16x16x32_bf16 v[192:195],a[120:123],v[44:47],v[192:195]
s_barrier
v_mfma_f32_16x16x32_bf16 v[196:199],a[124:127],v[44:47],v[196:199]
ds_read_b128 a[136:139],v0 offset:12288
v_cvt_pk_bf16_f32 v26,v84,v85
v_mfma_f32_16x16x32_bf16 v[244:247],a[124:127],v[48:51],v[244:247]
ds_read_b128 a[140:143],v1 offset:12288
v_fma_f32 v93,v93,s36,v15
v_mfma_f32_16x16x32_bf16 v[240:243],a[120:123],v[48:51],v[240:243]
ds_read_b128 a[144:147],v0 offset:12416
v_fma_f32 v94,v94,s36,v15
v_mfma_f32_16x16x32_bf16 v[144:147],a[120:123],v[52:55],v[144:147]
ds_read_b128 a[148:151],v1 offset:12416
v_fma_f32 v95,v95,s36,v15
v_mfma_f32_16x16x32_bf16 v[148:151],a[124:127],v[52:55],v[148:151]
v_exp_f32 v86,v86
v_mfma_f32_16x16x32_bf16 a[196:199],a[124:127],v[56:59],a[196:199]
buffer_load_dwordx4 v6,s[8:11],s21 offen offset:0 lds
v_mfma_f32_16x16x32_bf16 a[192:195],a[120:123],v[56:59],a[192:195]
v_exp_f32 v87,v87
v_mfma_f32_16x16x32_bf16 a[240:243],a[120:123],v[40:43],a[240:243]
ds_read_b128 a[120:123],v0 offset:12544
v_cvt_pk_bf16_f32 v27,v86,v87
v_mfma_f32_16x16x32_bf16 a[244:247],a[124:127],v[40:43],a[244:247]
ds_read_b128 a[124:127],v1 offset:12544
v_fma_f32 v100,v100,s36,v16
v_smfmac_f32_16x16x64_bf16 v[60:63],a[152:155],v[20:27],v18
v_fma_f32 v101,v101,s36,v16
v_mfma_f32_16x16x32_bf16 a[248:251],a[128:131],v[40:43],a[248:251]
v_exp_f32 v92,v92
v_mfma_f32_16x16x32_bf16 a[252:255],a[132:135],v[40:43],a[252:255]
v_exp_f32 v93,v93
v_mfma_f32_16x16x32_bf16 a[204:207],a[132:135],v[56:59],a[204:207]
v_exp_f32 v94,v94
v_mfma_f32_16x16x32_bf16 a[200:203],a[128:131],v[56:59],a[200:203]
v_exp_f32 v95,v95
v_mfma_f32_16x16x32_bf16 v[152:155],a[128:131],v[52:55],v[152:155]
v_cvt_pk_bf16_f32 v30,v92,v93
v_cvt_pk_bf16_f32 v31,v94,v95
v_mfma_f32_16x16x32_bf16 v[156:159],a[132:135],v[52:55],v[156:159]
v_fma_f32 v102,v102,s36,v16
v_fma_f32 v103,v103,s36,v16
v_mfma_f32_16x16x32_bf16 v[252:255],a[132:135],v[48:51],v[252:255]
v_exp_f32 v100,v100
v_mfma_f32_16x16x32_bf16 v[248:251],a[128:131],v[48:51],v[248:251]
buffer_load_dwordx4 v7,s[8:11],s21 offen offset:1024 lds
v_mfma_f32_16x16x32_bf16 v[200:203],a[128:131],v[44:47],v[200:203]
ds_read_b128 a[128:131],v0 offset:18432
v_fma_f32 v108,v108,s36,v17
v_mfma_f32_16x16x32_bf16 v[204:207],a[132:135],v[44:47],v[204:207]
s_waitcnt lgkmcnt(1)
ds_read_b128 a[132:135],v1 offset:18432
v_fma_f32 v109,v109,s36,v17
v_mfma_f32_16x16x32_bf16 v[72:75],a[136:139],a[0:3],0
v_exp_f32 v101,v101
v_mfma_f32_16x16x32_bf16 v[72:75],a[140:143],a[4:7],v[72:75]
v_exp_f32 v102,v102
v_mfma_f32_16x16x32_bf16 v[72:75],a[144:147],a[8:11],v[72:75]
v_exp_f32 v103,v103
v_mfma_f32_16x16x32_bf16 v[72:75],a[148:151],a[12:15],v[72:75]
v_cvt_pk_bf16_f32 v34,v100,v101
v_cvt_pk_bf16_f32 v35,v102,v103
v_mfma_f32_16x16x32_bf16 v[72:75],a[120:123],a[16:19],v[72:75]
v_fma_f32 v110,v110,s36,v17
v_fma_f32 v111,v111,s36,v17
v_smfmac_f32_16x16x64_bf16 v[64:67],a[152:155],v[28:35],v18
v_mfma_f32_16x16x32_bf16 v[72:75],a[124:127],a[20:23],v[72:75]
v_exp_f32 v108,v108
v_mfma_f32_16x16x32_bf16 v[80:83],a[124:127],a[44:47],0
v_exp_f32 v109,v109
v_mfma_f32_16x16x32_bf16 v[80:83],a[120:123],a[40:43],v[80:83]
buffer_load_dwordx4 v8,s[8:11],s21 offen offset:2048 lds
v_mfma_f32_16x16x32_bf16 v[80:83],a[148:151],a[36:39],v[80:83]
s_add_u32 s21,s21,12288
v_exp_f32 v110,v110
v_mfma_f32_16x16x32_bf16 v[80:83],a[144:147],a[32:35],v[80:83]
s_add_u32 m0,s22,0
v_exp_f32 v111,v111
v_mfma_f32_16x16x32_bf16 v[80:83],a[140:143],a[28:31],v[80:83]
v_cvt_pk_bf16_f32 v38,v108,v109
v_cvt_pk_bf16_f32 v39,v110,v111
v_mfma_f32_16x16x32_bf16 v[80:83],a[136:139],a[24:27],v[80:83]
v_fma_f32 v72,v72,s36,v13
v_fma_f32 v73,v73,s36,v13
v_mfma_f32_16x16x32_bf16 v[88:91],a[136:139],a[48:51],0
v_fma_f32 v74,v74,s36,v13
v_fma_f32 v75,v75,s36,v13
v_mfma_f32_16x16x32_bf16 v[88:91],a[140:143],a[52:55],v[88:91]
v_exp_f32 v72,v72
v_mfma_f32_16x16x32_bf16 v[88:91],a[144:147],a[56:59],v[88:91]
v_fma_f32 v80,v80,s36,v14
v_fma_f32 v81,v81,s36,v14
v_mfma_f32_16x16x32_bf16 v[88:91],a[148:151],a[60:63],v[88:91]
v_fma_f32 v82,v82,s36,v14
v_fma_f32 v83,v83,s36,v14
v_mfma_f32_16x16x32_bf16 v[88:91],a[120:123],a[64:67],v[88:91]
v_exp_f32 v73,v73
v_mfma_f32_16x16x32_bf16 v[88:91],a[124:127],a[68:71],v[88:91]
v_exp_f32 v74,v74
v_mfma_f32_16x16x32_bf16 v[96:99],a[124:127],a[92:95],0
v_exp_f32 v75,v75
v_mfma_f32_16x16x32_bf16 v[96:99],a[120:123],a[88:91],v[96:99]
buffer_load_dwordx4 v6,s[4:7],s20 offen offset:0 lds
v_mfma_f32_16x16x32_bf16 v[96:99],a[148:151],a[84:87],v[96:99]
v_exp_f32 v80,v80
v_mfma_f32_16x16x32_bf16 v[96:99],a[144:147],a[80:83],v[96:99]
v_fma_f32 v88,v88,s36,v15
v_fma_f32 v89,v89,s36,v15
v_mfma_f32_16x16x32_bf16 v[96:99],a[140:143],a[76:79],v[96:99]
v_exp_f32 v81,v81
v_mfma_f32_16x16x32_bf16 v[96:99],a[136:139],a[72:75],v[96:99]
v_exp_f32 v82,v82
v_mfma_f32_16x16x32_bf16 v[104:107],a[136:139],a[96:99],0
ds_read_b128 a[136:139],v0 offset:18560
v_cvt_pk_bf16_f32 v44,v72,v73
v_mfma_f32_16x16x32_bf16 v[104:107],a[140:143],a[100:103],v[104:107]
ds_read_b128 a[140:143],v1 offset:18560
v_cvt_pk_bf16_f32 v45,v74,v75
v_mfma_f32_16x16x32_bf16 v[104:107],a[144:147],a[104:107],v[104:107]
ds_read_b128 a[144:147],v0 offset:18688
v_cvt_pk_bf16_f32 v48,v80,v81
v_mfma_f32_16x16x32_bf16 v[104:107],a[148:151],a[108:111],v[104:107]
ds_read_b128 a[148:151],v1 offset:18688
v_mfma_f32_16x16x32_bf16 v[104:107],a[120:123],a[112:115],v[104:107]
v_exp_f32 v83,v83
v_mfma_f32_16x16x32_bf16 v[104:107],a[124:127],a[116:119],v[104:107]
s_waitcnt lgkmcnt(4)
v_exp_f32 v88,v88
v_mfma_f32_16x16x32_bf16 v[76:79],a[128:131],a[0:3],0
v_exp_f32 v89,v89
v_mfma_f32_16x16x32_bf16 v[76:79],a[132:135],a[4:7],v[76:79]
buffer_load_dwordx4 v7,s[4:7],s20 offen offset:1024 lds
s_waitcnt lgkmcnt(3)
v_mfma_f32_16x16x32_bf16 v[76:79],a[136:139],a[8:11],v[76:79]
s_waitcnt lgkmcnt(2)
v_cvt_pk_bf16_f32 v49,v82,v83
v_cvt_pk_bf16_f32 v52,v88,v89
v_mfma_f32_16x16x32_bf16 v[76:79],a[140:143],a[12:15],v[76:79]
s_waitcnt lgkmcnt(0)
v_mfma_f32_16x16x32_bf16 v[76:79],a[144:147],a[16:19],v[76:79]
v_mfma_f32_16x16x32_bf16 v[76:79],a[148:151],a[20:23],v[76:79]
v_mfma_f32_16x16x32_bf16 v[84:87],a[148:151],a[44:47],0
v_mfma_f32_16x16x32_bf16 v[84:87],a[144:147],a[40:43],v[84:87]
v_mfma_f32_16x16x32_bf16 v[84:87],a[140:143],a[36:39],v[84:87]
v_mfma_f32_16x16x32_bf16 v[84:87],a[136:139],a[32:35],v[84:87]
v_mfma_f32_16x16x32_bf16 v[84:87],a[132:135],a[28:31],v[84:87]
v_mfma_f32_16x16x32_bf16 v[84:87],a[128:131],a[24:27],v[84:87]
v_mfma_f32_16x16x32_bf16 v[92:95],a[128:131],a[48:51],0
buffer_load_dwordx4 v8,s[4:7],s20 offen offset:2048 lds
v_mfma_f32_16x16x32_bf16 v[92:95],a[132:135],a[52:55],v[92:95]
s_add_u32 s20,s20,12288
v_mfma_f32_16x16x32_bf16 v[92:95],a[136:139],a[56:59],v[92:95]
v_mfma_f32_16x16x32_bf16 v[92:95],a[140:143],a[60:63],v[92:95]
v_mfma_f32_16x16x32_bf16 v[92:95],a[144:147],a[64:67],v[92:95]
v_mfma_f32_16x16x32_bf16 v[92:95],a[148:151],a[68:71],v[92:95]
v_mfma_f32_16x16x32_bf16 v[100:103],a[148:151],a[92:95],0
ds_read_b64_tr_b16 a[120:121],v2 offset:0
v_mfma_f32_16x16x32_bf16 v[100:103],a[144:147],a[88:91],v[100:103]
ds_read_b64_tr_b16 a[122:123],v2 offset:6144
v_mfma_f32_16x16x32_bf16 v[100:103],a[140:143],a[84:87],v[100:103]
v_mfma_f32_16x16x32_bf16 v[100:103],a[136:139],a[80:83],v[100:103]
ds_read_b64_tr_b16 a[124:125],v3 offset:0
v_mfma_f32_16x16x32_bf16 v[100:103],a[132:135],a[76:79],v[100:103]
ds_read_b64_tr_b16 a[126:127],v3 offset:6144
v_mfma_f32_16x16x32_bf16 v[100:103],a[128:131],a[72:75],v[100:103]
v_mfma_f32_16x16x32_bf16 v[108:111],a[128:131],a[96:99],0
ds_read_b64_tr_b16 a[128:129],v4 offset:0
v_mfma_f32_16x16x32_bf16 v[108:111],a[132:135],a[100:103],v[108:111]
ds_read_b64_tr_b16 a[130:131],v4 offset:6144
v_mfma_f32_16x16x32_bf16 v[108:111],a[136:139],a[104:107],v[108:111]
ds_read_b64_tr_b16 a[132:133],v5 offset:0
v_mfma_f32_16x16x32_bf16 v[108:111],a[140:143],a[108:111],v[108:111]
ds_read_b64_tr_b16 a[134:135],v5 offset:6144
v_mfma_f32_16x16x32_bf16 v[108:111],a[144:147],a[112:115],v[108:111]
v_mfma_f32_16x16x32_bf16 v[108:111],a[148:151],a[116:119],v[108:111]
s_waitcnt lgkmcnt(4)
v_mfma_f32_16x16x32_bf16 v[160:163],a[120:123],v[20:23],v[160:163]
ds_read_b128 a[156:159],v10 offset:6144
v_fma_f32 v90,v90,s36,v15
v_mfma_f32_16x16x32_bf16 v[164:167],a[124:127],v[20:23],v[164:167]
ds_read_b64_tr_b16 a[136:137],v2 offset:128
v_fma_f32 v91,v91,s36,v15
v_mfma_f32_16x16x32_bf16 v[212:215],a[124:127],v[24:27],v[212:215]
ds_read_b64_tr_b16 a[138:139],v2 offset:6272
v_fma_f32 v96,v96,s36,v16
v_mfma_f32_16x16x32_bf16 v[208:211],a[120:123],v[24:27],v[208:211]
ds_read_b64_tr_b16 a[140:141],v3 offset:128
v_fma_f32 v97,v97,s36,v16
v_mfma_f32_16x16x32_bf16 v[112:115],a[120:123],v[28:31],v[112:115]
ds_read_b64_tr_b16 a[142:143],v3 offset:6272
v_fma_f32 v98,v98,s36,v16
v_mfma_f32_16x16x32_bf16 v[116:119],a[124:127],v[28:31],v[116:119]
ds_read_b64_tr_b16 a[144:145],v4 offset:128
v_fma_f32 v99,v99,s36,v16
v_mfma_f32_16x16x32_bf16 a[164:167],a[124:127],v[32:35],a[164:167]
ds_read_b64_tr_b16 a[146:147],v4 offset:6272
v_fma_f32 v104,v104,s36,v17
v_mfma_f32_16x16x32_bf16 a[160:163],a[120:123],v[32:35],a[160:163]
ds_read_b64_tr_b16 a[148:149],v5 offset:128
v_fma_f32 v105,v105,s36,v17
v_mfma_f32_16x16x32_bf16 a[208:211],a[120:123],v[36:39],a[208:211]
ds_read_b64_tr_b16 a[150:151],v5 offset:6272
v_fma_f32 v106,v106,s36,v17
v_mfma_f32_16x16x32_bf16 a[212:215],a[124:127],v[36:39],a[212:215]
s_waitcnt lgkmcnt(6)
ds_read_b64_tr_b16 a[120:121],v2 offset:256
v_fma_f32 v107,v107,s36,v17
v_mfma_f32_16x16x32_bf16 a[216:219],a[128:131],v[36:39],a[216:219]
ds_read_b64_tr_b16 a[122:123],v2 offset:6400
v_fma_f32 v76,v76,s36,v13
v_mfma_f32_16x16x32_bf16 a[220:223],a[132:135],v[36:39],a[220:223]
ds_read_b64_tr_b16 a[124:125],v3 offset:256
v_fma_f32 v77,v77,s36,v13
v_mfma_f32_16x16x32_bf16 a[172:175],a[132:135],v[32:35],a[172:175]
ds_read_b64_tr_b16 a[126:127],v3 offset:6400
v_fma_f32 v78,v78,s36,v13
v_mfma_f32_16x16x32_bf16 a[168:171],a[128:131],v[32:35],a[168:171]
v_exp_f32 v90,v90
v_mfma_f32_16x16x32_bf16 v[120:123],a[128:131],v[28:31],v[120:123]
v_exp_f32 v91,v91
v_mfma_f32_16x16x32_bf16 v[124:127],a[132:135],v[28:31],v[124:127]
v_cvt_pk_bf16_f32 v53,v90,v91
v_fma_f32 v79,v79,s36,v13
v_mfma_f32_16x16x32_bf16 v[220:223],a[132:135],v[24:27],v[220:223]
v_exp_f32 v96,v96
v_mfma_f32_16x16x32_bf16 v[216:219],a[128:131],v[24:27],v[216:219]
buffer_store_dwordx4 a[156:159],v9,s[16:19],s27 offen offset:0 nt
v_exp_f32 v97,v97
v_fma_f32 v84,v84,s36,v14
v_mfma_f32_16x16x32_bf16 v[168:171],a[128:131],v[20:23],v[168:171]
ds_read_b128 a[156:159],v10 offset:7168
v_cvt_pk_bf16_f32 v56,v96,v97
v_mfma_f32_16x16x32_bf16 v[172:175],a[132:135],v[20:23],v[172:175]
ds_read_b64_tr_b16 a[128:129],v4 offset:256
v_fma_f32 v85,v85,s36,v14
v_mfma_f32_16x16x32_bf16 v[176:179],a[136:139],v[20:23],v[176:179]
s_waitcnt lgkmcnt(2)
ds_read_b64_tr_b16 a[130:131],v4 offset:6400
v_fma_f32 v86,v86,s36,v14
v_mfma_f32_16x16x32_bf16 v[180:183],a[140:143],v[20:23],v[180:183]
ds_read_b64_tr_b16 a[132:133],v5 offset:256
v_fma_f32 v87,v87,s36,v14
v_mfma_f32_16x16x32_bf16 v[228:231],a[140:143],v[24:27],v[228:231]
ds_read_b64_tr_b16 a[134:135],v5 offset:6400
v_fma_f32 v92,v92,s36,v15
v_mfma_f32_16x16x32_bf16 v[224:227],a[136:139],v[24:27],v[224:227]
v_exp_f32 v98,v98
v_mfma_f32_16x16x32_bf16 v[128:131],a[136:139],v[28:31],v[128:131]
v_exp_f32 v99,v99
v_mfma_f32_16x16x32_bf16 v[132:135],a[140:143],v[28:31],v[132:135]
v_cvt_pk_bf16_f32 v57,v98,v99
v_fma_f32 v93,v93,s36,v15
v_mfma_f32_16x16x32_bf16 a[180:183],a[140:143],v[32:35],a[180:183]
s_waitcnt lgkmcnt(4)
buffer_store_dwordx4 a[156:159],v9,s[16:19],s27 offen offset:128 nt
v_exp_f32 v104,v104
v_fma_f32 v94,v94,s36,v15
v_mfma_f32_16x16x32_bf16 a[176:179],a[136:139],v[32:35],a[176:179]
ds_read_b128 a[156:159],v10 offset:8192
v_fma_f32 v95,v95,s36,v15
v_mfma_f32_16x16x32_bf16 a[224:227],a[136:139],v[36:39],a[224:227]
v_exp_f32 v105,v105
v_mfma_f32_16x16x32_bf16 a[228:231],a[140:143],v[36:39],a[228:231]
v_exp_f32 v106,v106
v_mfma_f32_16x16x32_bf16 a[232:235],a[144:147],v[36:39],a[232:235]
v_exp_f32 v107,v107
v_mfma_f32_16x16x32_bf16 a[236:239],a[148:151],v[36:39],a[236:239]
v_cvt_pk_bf16_f32 v40,v104,v105
v_cvt_pk_bf16_f32 v41,v106,v107
v_mfma_f32_16x16x32_bf16 a[188:191],a[148:151],v[32:35],a[188:191]
v_exp_f32 v76,v76
v_mfma_f32_16x16x32_bf16 a[184:187],a[144:147],v[32:35],a[184:187]
v_exp_f32 v77,v77
v_mfma_f32_16x16x32_bf16 v[136:139],a[144:147],v[28:31],v[136:139]
v_exp_f32 v78,v78
v_mfma_f32_16x16x32_bf16 v[140:143],a[148:151],v[28:31],v[140:143]
s_waitcnt lgkmcnt(0)
buffer_store_dwordx4 a[156:159],v9,s[16:19],s27 offen offset:256 nt
v_exp_f32 v79,v79
v_cvt_pk_bf16_f32 v46,v76,v77
v_mfma_f32_16x16x32_bf16 v[236:239],a[148:151],v[24:27],v[236:239]
s_add_u32 s27,s27,3072
v_cvt_pk_bf16_f32 v47,v78,v79
v_fma_f32 v100,v100,s36,v16
v_mfma_f32_16x16x32_bf16 v[232:235],a[144:147],v[24:27],v[232:235]
s_waitcnt vmcnt(12)
v_exp_f32 v84,v84
v_mfma_f32_16x16x32_bf16 v[184:187],a[144:147],v[20:23],v[184:187]
s_barrier
v_mfma_f32_16x16x32_bf16 v[188:191],a[148:151],v[20:23],v[188:191]
s_add_u32 m0,s23,0
ds_read_b128 a[136:139],v0 offset:24576
v_fma_f32 v101,v101,s36,v16
v_mfma_f32_16x16x32_bf16 v[192:195],a[120:123],v[20:23],v[192:195]
ds_read_b128 a[140:143],v1 offset:24576
v_fma_f32 v102,v102,s36,v16
v_mfma_f32_16x16x32_bf16 v[196:199],a[124:127],v[20:23],v[196:199]
ds_read_b128 a[144:147],v0 offset:24704
v_fma_f32 v103,v103,s36,v16
v_mfma_f32_16x16x32_bf16 v[244:247],a[124:127],v[24:27],v[244:247]
ds_read_b128 a[148:151],v1 offset:24704
v_fma_f32 v108,v108,s36,v17
v_mfma_f32_16x16x32_bf16 v[240:243],a[120:123],v[24:27],v[240:243]
v_exp_f32 v85,v85
v_mfma_f32_16x16x32_bf16 v[144:147],a[120:123],v[28:31],v[144:147]
buffer_load_dwordx4 v6,s[8:11],s21 offen offset:0 lds
v_mfma_f32_16x16x32_bf16 v[148:151],a[124:127],v[28:31],v[148:151]
v_exp_f32 v86,v86
v_mfma_f32_16x16x32_bf16 a[196:199],a[124:127],v[32:35],a[196:199]
v_exp_f32 v87,v87
v_mfma_f32_16x16x32_bf16 a[192:195],a[120:123],v[32:35],a[192:195]
v_cvt_pk_bf16_f32 v50,v84,v85
v_cvt_pk_bf16_f32 v51,v86,v87
v_mfma_f32_16x16x32_bf16 a[240:243],a[120:123],v[36:39],a[240:243]
ds_read_b128 a[120:123],v0 offset:24832
v_fma_f32 v109,v109,s36,v17
v_smfmac_f32_16x16x64_bf16 v[60:63],a[152:155],v[44:51],v18
v_fma_f32 v110,v110,s36,v17
v_mfma_f32_16x16x32_bf16 a[244:247],a[124:127],v[36:39],a[244:247]
ds_read_b128 a[124:127],v1 offset:24832
v_fma_f32 v111,v111,s36,v17
v_mfma_f32_16x16x32_bf16 a[248:251],a[128:131],v[36:39],a[248:251]
v_exp_f32 v92,v92
v_mfma_f32_16x16x32_bf16 a[252:255],a[132:135],v[36:39],a[252:255]
v_exp_f32 v93,v93
v_mfma_f32_16x16x32_bf16 a[204:207],a[132:135],v[32:35],a[204:207]
v_exp_f32 v94,v94
v_mfma_f32_16x16x32_bf16 a[200:203],a[128:131],v[32:35],a[200:203]
v_exp_f32 v95,v95
v_mfma_f32_16x16x32_bf16 v[152:155],a[128:131],v[28:31],v[152:155]
v_cvt_pk_bf16_f32 v54,v92,v93
v_cvt_pk_bf16_f32 v55,v94,v95
v_mfma_f32_16x16x32_bf16 v[156:159],a[132:135],v[28:31],v[156:159]
buffer_load_dwordx4 v7,s[8:11],s21 offen offset:1024 lds
v_mfma_f32_16x16x32_bf16 v[252:255],a[132:135],v[24:27],v[252:255]
v_exp_f32 v100,v100
v_mfma_f32_16x16x32_bf16 v[248:251],a[128:131],v[24:27],v[248:251]
v_exp_f32 v101,v101
v_mfma_f32_16x16x32_bf16 v[200:203],a[128:131],v[20:23],v[200:203]
ds_read_b128 a[128:131],v0 offset:30720
v_cvt_pk_bf16_f32 v58,v100,v101
v_mfma_f32_16x16x32_bf16 v[204:207],a[132:135],v[20:23],v[204:207]
s_waitcnt lgkmcnt(1)
ds_read_b128 a[132:135],v1 offset:30720
v_mfma_f32_16x16x32_bf16 v[72:75],a[136:139],a[0:3],0
v_exp_f32 v102,v102
v_mfma_f32_16x16x32_bf16 v[72:75],a[140:143],a[4:7],v[72:75]
v_exp_f32 v103,v103
v_mfma_f32_16x16x32_bf16 v[72:75],a[144:147],a[8:11],v[72:75]
v_cvt_pk_bf16_f32 v59,v102,v103
v_mfma_f32_16x16x32_bf16 v[72:75],a[148:151],a[12:15],v[72:75]
v_exp_f32 v108,v108
v_smfmac_f32_16x16x64_bf16 v[64:67],a[152:155],v[52:59],v18
v_mfma_f32_16x16x32_bf16 v[72:75],a[120:123],a[16:19],v[72:75]
v_exp_f32 v109,v109
v_mfma_f32_16x16x32_bf16 v[72:75],a[124:127],a[20:23],v[72:75]
buffer_load_dwordx4 v8,s[8:11],s21 offen offset:2048 lds
v_mfma_f32_16x16x32_bf16 v[80:83],a[124:127],a[44:47],0
s_add_u32 s21,s21,12288
v_exp_f32 v110,v110
v_mfma_f32_16x16x32_bf16 v[80:83],a[120:123],a[40:43],v[80:83]
s_cmp_eq_u32 s38,1
v_exp_f32 v111,v111
v_mfma_f32_16x16x32_bf16 v[80:83],a[148:151],a[36:39],v[80:83]
s_cselect_b32 s20,s26,s20
v_cvt_pk_bf16_f32 v42,v108,v109
v_cvt_pk_bf16_f32 v43,v110,v111
v_mfma_f32_16x16x32_bf16 v[80:83],a[144:147],a[32:35],v[80:83]
s_add_u32 m0,s22,12288
v_fma_f32 v72,v72,s36,v13
v_fma_f32 v73,v73,s36,v13
v_smfmac_f32_16x16x64_bf16 v[68:71],a[152:155],v[36:43],v18
v_fma_f32 v74,v74,s36,v13
v_mfma_f32_16x16x32_bf16 v[80:83],a[140:143],a[28:31],v[80:83]
v_fma_f32 v75,v75,s36,v13
v_mfma_f32_16x16x32_bf16 v[80:83],a[136:139],a[24:27],v[80:83]
v_exp_f32 v72,v72
v_mfma_f32_16x16x32_bf16 v[88:91],a[136:139],a[48:51],0
v_exp_f32 v73,v73
v_mfma_f32_16x16x32_bf16 v[88:91],a[140:143],a[52:55],v[88:91]
v_exp_f32 v74,v74
v_mfma_f32_16x16x32_bf16 v[88:91],a[144:147],a[56:59],v[88:91]
v_exp_f32 v75,v75
v_mfma_f32_16x16x32_bf16 v[88:91],a[148:151],a[60:63],v[88:91]
v_fma_f32 v80,v80,s36,v14
v_fma_f32 v81,v81,s36,v14
v_mfma_f32_16x16x32_bf16 v[88:91],a[120:123],a[64:67],v[88:91]
buffer_load_dwordx4 v6,s[4:7],s20 offen offset:0 lds
v_mfma_f32_16x16x32_bf16 v[88:91],a[124:127],a[68:71],v[88:91]
v_fma_f32 v82,v82,s36,v14
v_fma_f32 v83,v83,s36,v14
v_mfma_f32_16x16x32_bf16 v[96:99],a[124:127],a[92:95],0
v_exp_f32 v80,v80
v_mfma_f32_16x16x32_bf16 v[96:99],a[120:123],a[88:91],v[96:99]
v_exp_f32 v81,v81
v_mfma_f32_16x16x32_bf16 v[96:99],a[148:151],a[84:87],v[96:99]
v_exp_f32 v82,v82
v_mfma_f32_16x16x32_bf16 v[96:99],a[144:147],a[80:83],v[96:99]
v_fma_f32 v88,v88,s36,v15
v_fma_f32 v89,v89,s36,v15
v_mfma_f32_16x16x32_bf16 v[96:99],a[140:143],a[76:79],v[96:99]
v_exp_f32 v83,v83
v_mfma_f32_16x16x32_bf16 v[96:99],a[136:139],a[72:75],v[96:99]
v_exp_f32 v88,v88
v_mfma_f32_16x16x32_bf16 v[104:107],a[136:139],a[96:99],0
ds_read_b128 a[136:139],v0 offset:30848
v_cvt_pk_bf16_f32 v20,v72,v73
v_mfma_f32_16x16x32_bf16 v[104:107],a[140:143],a[100:103],v[104:107]
ds_read_b128 a[140:143],v1 offset:30848
v_cvt_pk_bf16_f32 v21,v74,v75
v_mfma_f32_16x16x32_bf16 v[104:107],a[144:147],a[104:107],v[104:107]
ds_read_b128 a[144:147],v0 offset:30976
v_cvt_pk_bf16_f32 v24,v80,v81
v_mfma_f32_16x16x32_bf16 v[104:107],a[148:151],a[108:111],v[104:107]
ds_read_b128 a[148:151],v1 offset:30976
v_cvt_pk_bf16_f32 v25,v82,v83
v_mfma_f32_16x16x32_bf16 v[104:107],a[120:123],a[112:115],v[104:107]
buffer_load_dwordx4 v7,s[4:7],s20 offen offset:1024 lds
v_mfma_f32_16x16x32_bf16 v[104:107],a[124:127],a[116:119],v[104:107]
s_waitcnt lgkmcnt(4)
v_exp_f32 v89,v89
v_mfma_f32_16x16x32_bf16 v[76:79],a[128:131],a[0:3],0
v_cvt_pk_bf16_f32 v28,v88,v89
v_mfma_f32_16x16x32_bf16 v[76:79],a[132:135],a[4:7],v[76:79]
s_waitcnt lgkmcnt(3)
v_mfma_f32_16x16x32_bf16 v[76:79],a[136:139],a[8:11],v[76:79]
s_waitcnt lgkmcnt(2)
v_mfma_f32_16x16x32_bf16 v[76:79],a[140:143],a[12:15],v[76:79]
s_waitcnt lgkmcnt(1)
v_mfma_f32_16x16x32_bf16 v[76:79],a[144:147],a[16:19],v[76:79]
s_waitcnt lgkmcnt(0)
v_mfma_f32_16x16x32_bf16 v[76:79],a[148:151],a[20:23],v[76:79]
v_mfma_f32_16x16x32_bf16 v[84:87],a[148:151],a[44:47],0
v_mfma_f32_16x16x32_bf16 v[84:87],a[144:147],a[40:43],v[84:87]
v_mfma_f32_16x16x32_bf16 v[84:87],a[140:143],a[36:39],v[84:87]
v_mfma_f32_16x16x32_bf16 v[84:87],a[136:139],a[32:35],v[84:87]
buffer_load_dwordx4 v8,s[4:7],s20 offen offset:2048 lds
v_mfma_f32_16x16x32_bf16 v[84:87],a[132:135],a[28:31],v[84:87]
s_add_u32 s20,s20,12288
v_mfma_f32_16x16x32_bf16 v[84:87],a[128:131],a[24:27],v[84:87]
v_mfma_f32_16x16x32_bf16 v[92:95],a[128:131],a[48:51],0
v_mfma_f32_16x16x32_bf16 v[92:95],a[132:135],a[52:55],v[92:95]
v_mfma_f32_16x16x32_bf16 v[92:95],a[136:139],a[56:59],v[92:95]
v_mfma_f32_16x16x32_bf16 v[92:95],a[140:143],a[60:63],v[92:95]
ds_read_b64_tr_b16 a[120:121],v2 offset:12288
v_mfma_f32_16x16x32_bf16 v[92:95],a[144:147],a[64:67],v[92:95]
ds_read_b64_tr_b16 a[122:123],v2 offset:18432
v_mfma_f32_16x16x32_bf16 v[92:95],a[148:151],a[68:71],v[92:95]
v_mfma_f32_16x16x32_bf16 v[100:103],a[148:151],a[92:95],0
ds_read_b64_tr_b16 a[124:125],v3 offset:12288
v_mfma_f32_16x16x32_bf16 v[100:103],a[144:147],a[88:91],v[100:103]
ds_read_b64_tr_b16 a[126:127],v3 offset:18432
v_mfma_f32_16x16x32_bf16 v[100:103],a[140:143],a[84:87],v[100:103]
v_mfma_f32_16x16x32_bf16 v[100:103],a[136:139],a[80:83],v[100:103]
v_mfma_f32_16x16x32_bf16 v[100:103],a[132:135],a[76:79],v[100:103]
v_mfma_f32_16x16x32_bf16 v[100:103],a[128:131],a[72:75],v[100:103]
v_mfma_f32_16x16x32_bf16 v[108:111],a[128:131],a[96:99],0
ds_read_b64_tr_b16 a[128:129],v4 offset:12288
v_mfma_f32_16x16x32_bf16 v[108:111],a[132:135],a[100:103],v[108:111]
ds_read_b64_tr_b16 a[130:131],v4 offset:18432
v_mfma_f32_16x16x32_bf16 v[108:111],a[136:139],a[104:107],v[108:111]
ds_read_b64_tr_b16 a[132:133],v5 offset:12288
v_mfma_f32_16x16x32_bf16 v[108:111],a[140:143],a[108:111],v[108:111]
ds_read_b64_tr_b16 a[134:135],v5 offset:18432
v_mfma_f32_16x16x32_bf16 v[108:111],a[144:147],a[112:115],v[108:111]
v_mfma_f32_16x16x32_bf16 v[108:111],a[148:151],a[116:119],v[108:111]
s_waitcnt lgkmcnt(4)
v_mfma_f32_16x16x32_bf16 v[160:163],a[120:123],v[44:47],v[160:163]
s_add_u32 m0,s29,0
ds_read_b64_tr_b16 a[136:137],v2 offset:12416
v_fma_f32 v90,v90,s36,v15
v_mfma_f32_16x16x32_bf16 v[164:167],a[124:127],v[44:47],v[164:167]
ds_read_b64_tr_b16 a[138:139],v2 offset:18560
v_fma_f32 v91,v91,s36,v15
v_mfma_f32_16x16x32_bf16 v[212:215],a[124:127],v[48:51],v[212:215]
ds_read_b64_tr_b16 a[140:141],v3 offset:12416
v_fma_f32 v96,v96,s36,v16
v_mfma_f32_16x16x32_bf16 v[208:211],a[120:123],v[48:51],v[208:211]
ds_read_b64_tr_b16 a[142:143],v3 offset:18560
v_fma_f32 v97,v97,s36,v16
v_mfma_f32_16x16x32_bf16 v[112:115],a[120:123],v[52:55],v[112:115]
ds_read_b64_tr_b16 a[144:145],v4 offset:12416
v_fma_f32 v98,v98,s36,v16
v_mfma_f32_16x16x32_bf16 v[116:119],a[124:127],v[52:55],v[116:119]
ds_read_b64_tr_b16 a[146:147],v4 offset:18560
v_fma_f32 v99,v99,s36,v16
v_mfma_f32_16x16x32_bf16 a[164:167],a[124:127],v[56:59],a[164:167]
ds_read_b64_tr_b16 a[148:149],v5 offset:12416
v_fma_f32 v104,v104,s36,v17
v_mfma_f32_16x16x32_bf16 a[160:163],a[120:123],v[56:59],a[160:163]
buffer_load_dwordx4 v6,s[12:15],s28 offen offset:0 nt lds
v_mfma_f32_16x16x32_bf16 a[208:211],a[120:123],v[40:43],a[208:211]
ds_read_b64_tr_b16 a[150:151],v5 offset:18560
v_fma_f32 v105,v105,s36,v17
v_mfma_f32_16x16x32_bf16 a[212:215],a[124:127],v[40:43],a[212:215]
s_waitcnt lgkmcnt(5)
ds_read_b64_tr_b16 a[120:121],v2 offset:12544
v_fma_f32 v106,v106,s36,v17
v_mfma_f32_16x16x32_bf16 a[216:219],a[128:131],v[40:43],a[216:219]
ds_read_b64_tr_b16 a[122:123],v2 offset:18688
v_fma_f32 v107,v107,s36,v17
v_mfma_f32_16x16x32_bf16 a[220:223],a[132:135],v[40:43],a[220:223]
ds_read_b64_tr_b16 a[124:125],v3 offset:12544
v_fma_f32 v76,v76,s36,v13
v_mfma_f32_16x16x32_bf16 a[172:175],a[132:135],v[56:59],a[172:175]
ds_read_b64_tr_b16 a[126:127],v3 offset:18688
v_fma_f32 v77,v77,s36,v13
v_mfma_f32_16x16x32_bf16 a[168:171],a[128:131],v[56:59],a[168:171]
v_exp_f32 v90,v90
v_mfma_f32_16x16x32_bf16 v[120:123],a[128:131],v[52:55],v[120:123]
v_exp_f32 v91,v91
v_mfma_f32_16x16x32_bf16 v[124:127],a[132:135],v[52:55],v[124:127]
v_cvt_pk_bf16_f32 v29,v90,v91
v_fma_f32 v78,v78,s36,v13
v_mfma_f32_16x16x32_bf16 v[220:223],a[132:135],v[48:51],v[220:223]
v_exp_f32 v96,v96
v_mfma_f32_16x16x32_bf16 v[216:219],a[128:131],v[48:51],v[216:219]
buffer_load_dwordx4 v7,s[12:15],s28 offen offset:1024 nt lds
v_mfma_f32_16x16x32_bf16 v[168:171],a[128:131],v[44:47],v[168:171]
ds_read_b64_tr_b16 a[128:129],v4 offset:12544
v_fma_f32 v79,v79,s36,v13
v_mfma_f32_16x16x32_bf16 v[172:175],a[132:135],v[44:47],v[172:175]
ds_read_b64_tr_b16 a[130:131],v4 offset:18688
v_fma_f32 v84,v84,s36,v14
v_mfma_f32_16x16x32_bf16 v[176:179],a[136:139],v[44:47],v[176:179]
s_waitcnt lgkmcnt(2)
ds_read_b64_tr_b16 a[132:133],v5 offset:12544
v_fma_f32 v85,v85,s36,v14
v_mfma_f32_16x16x32_bf16 v[180:183],a[140:143],v[44:47],v[180:183]
ds_read_b64_tr_b16 a[134:135],v5 offset:18688
v_fma_f32 v86,v86,s36,v14
v_mfma_f32_16x16x32_bf16 v[228:231],a[140:143],v[48:51],v[228:231]
v_exp_f32 v97,v97
v_mfma_f32_16x16x32_bf16 v[224:227],a[136:139],v[48:51],v[224:227]
v_exp_f32 v98,v98
v_mfma_f32_16x16x32_bf16 v[128:131],a[136:139],v[52:55],v[128:131]
v_exp_f32 v99,v99
v_mfma_f32_16x16x32_bf16 v[132:135],a[140:143],v[52:55],v[132:135]
v_cvt_pk_bf16_f32 v32,v96,v97
v_cvt_pk_bf16_f32 v33,v98,v99
v_mfma_f32_16x16x32_bf16 a[180:183],a[140:143],v[56:59],a[180:183]
v_exp_f32 v104,v104
v_mfma_f32_16x16x32_bf16 a[176:179],a[136:139],v[56:59],a[176:179]
buffer_load_dwordx4 v8,s[12:15],s28 offen offset:2048 nt lds
v_mfma_f32_16x16x32_bf16 a[224:227],a[136:139],v[40:43],a[224:227]
s_add_u32 s28,s28,3072
v_exp_f32 v105,v105
v_mfma_f32_16x16x32_bf16 a[228:231],a[140:143],v[40:43],a[228:231]
s_add_u32 s29,s29,3072
v_exp_f32 v106,v106
v_mfma_f32_16x16x32_bf16 a[232:235],a[144:147],v[40:43],a[232:235]
s_cmp_eq_u32 s38,1
v_exp_f32 v107,v107
v_mfma_f32_16x16x32_bf16 a[236:239],a[148:151],v[40:43],a[236:239]
s_cselect_b32 s21,s26,s21
v_cvt_pk_bf16_f32 v36,v104,v105
v_cvt_pk_bf16_f32 v37,v106,v107
v_mfma_f32_16x16x32_bf16 a[188:191],a[148:151],v[56:59],a[188:191]
s_add_u32 m0,s23,12288
v_exp_f32 v76,v76
v_mfma_f32_16x16x32_bf16 a[184:187],a[144:147],v[56:59],a[184:187]
v_exp_f32 v77,v77
v_mfma_f32_16x16x32_bf16 v[136:139],a[144:147],v[52:55],v[136:139]
v_exp_f32 v78,v78
v_mfma_f32_16x16x32_bf16 v[140:143],a[148:151],v[52:55],v[140:143]
v_exp_f32 v79,v79
v_mfma_f32_16x16x32_bf16 v[236:239],a[148:151],v[48:51],v[236:239]
v_cvt_pk_bf16_f32 v22,v76,v77
v_cvt_pk_bf16_f32 v23,v78,v79
v_mfma_f32_16x16x32_bf16 v[232:235],a[144:147],v[48:51],v[232:235]
v_fma_f32 v87,v87,s36,v14
v_fma_f32 v92,v92,s36,v15
v_mfma_f32_16x16x32_bf16 v[184:187],a[144:147],v[44:47],v[184:187]
v_exp_f32 v84,v84
v_mfma_f32_16x16x32_bf16 v[188:191],a[148:151],v[44:47],v[188:191]
s_waitcnt vmcnt(12) lgkmcnt(0)
v_exp_f32 v85,v85
v_mfma_f32_16x16x32_bf16 v[192:195],a[120:123],v[44:47],v[192:195]
s_barrier
v_mfma_f32_16x16x32_bf16 v[196:199],a[124:127],v[44:47],v[196:199]
ds_read_b128 a[136:139],v0 offset:0
v_cvt_pk_bf16_f32 v26,v84,v85
v_mfma_f32_16x16x32_bf16 v[244:247],a[124:127],v[48:51],v[244:247]
ds_read_b128 a[140:143],v1 offset:0
v_fma_f32 v93,v93,s36,v15
v_mfma_f32_16x16x32_bf16 v[240:243],a[120:123],v[48:51],v[240:243]
ds_read_b128 a[144:147],v0 offset:128
v_fma_f32 v94,v94,s36,v15
v_mfma_f32_16x16x32_bf16 v[144:147],a[120:123],v[52:55],v[144:147]
ds_read_b128 a[148:151],v1 offset:128
v_fma_f32 v95,v95,s36,v15
v_mfma_f32_16x16x32_bf16 v[148:151],a[124:127],v[52:55],v[148:151]
v_exp_f32 v86,v86
v_mfma_f32_16x16x32_bf16 a[196:199],a[124:127],v[56:59],a[196:199]
buffer_load_dwordx4 v6,s[8:11],s21 offen offset:0 lds
v_mfma_f32_16x16x32_bf16 a[192:195],a[120:123],v[56:59],a[192:195]
v_exp_f32 v87,v87
v_mfma_f32_16x16x32_bf16 a[240:243],a[120:123],v[40:43],a[240:243]
ds_read_b128 a[120:123],v0 offset:256
v_cvt_pk_bf16_f32 v27,v86,v87
v_mfma_f32_16x16x32_bf16 a[244:247],a[124:127],v[40:43],a[244:247]
ds_read_b128 a[124:127],v1 offset:256
v_fma_f32 v100,v100,s36,v16
v_smfmac_f32_16x16x64_bf16 v[60:63],a[152:155],v[20:27],v18
v_fma_f32 v101,v101,s36,v16
v_mfma_f32_16x16x32_bf16 a[248:251],a[128:131],v[40:43],a[248:251]
v_exp_f32 v92,v92
v_mfma_f32_16x16x32_bf16 a[252:255],a[132:135],v[40:43],a[252:255]
v_exp_f32 v93,v93
v_mfma_f32_16x16x32_bf16 a[204:207],a[132:135],v[56:59],a[204:207]
v_exp_f32 v94,v94
v_mfma_f32_16x16x32_bf16 a[200:203],a[128:131],v[56:59],a[200:203]
v_exp_f32 v95,v95
v_mfma_f32_16x16x32_bf16 v[152:155],a[128:131],v[52:55],v[152:155]
v_cvt_pk_bf16_f32 v30,v92,v93
v_cvt_pk_bf16_f32 v31,v94,v95
v_mfma_f32_16x16x32_bf16 v[156:159],a[132:135],v[52:55],v[156:159]
v_fma_f32 v102,v102,s36,v16
v_fma_f32 v103,v103,s36,v16
v_mfma_f32_16x16x32_bf16 v[252:255],a[132:135],v[48:51],v[252:255]
v_exp_f32 v100,v100
v_mfma_f32_16x16x32_bf16 v[248:251],a[128:131],v[48:51],v[248:251]
buffer_load_dwordx4 v7,s[8:11],s21 offen offset:1024 lds
v_mfma_f32_16x16x32_bf16 v[200:203],a[128:131],v[44:47],v[200:203]
ds_read_b128 a[128:131],v0 offset:6144
v_fma_f32 v108,v108,s36,v17
v_mfma_f32_16x16x32_bf16 v[204:207],a[132:135],v[44:47],v[204:207]
s_waitcnt lgkmcnt(1)
ds_read_b128 a[132:135],v1 offset:6144
v_fma_f32 v109,v109,s36,v17
v_mfma_f32_16x16x32_bf16 v[72:75],a[136:139],a[0:3],0
v_exp_f32 v101,v101
v_mfma_f32_16x16x32_bf16 v[72:75],a[140:143],a[4:7],v[72:75]
v_exp_f32 v102,v102
v_mfma_f32_16x16x32_bf16 v[72:75],a[144:147],a[8:11],v[72:75]
v_exp_f32 v103,v103
v_mfma_f32_16x16x32_bf16 v[72:75],a[148:151],a[12:15],v[72:75]
v_cvt_pk_bf16_f32 v34,v100,v101
v_cvt_pk_bf16_f32 v35,v102,v103
v_mfma_f32_16x16x32_bf16 v[72:75],a[120:123],a[16:19],v[72:75]
v_fma_f32 v110,v110,s36,v17
v_fma_f32 v111,v111,s36,v17
v_smfmac_f32_16x16x64_bf16 v[64:67],a[152:155],v[28:35],v18
v_add_u32 v10,9216,v10
v_mfma_f32_16x16x32_bf16 v[72:75],a[124:127],a[20:23],v[72:75]
v_exp_f32 v108,v108
v_mfma_f32_16x16x32_bf16 v[80:83],a[124:127],a[44:47],0
v_exp_f32 v109,v109
v_mfma_f32_16x16x32_bf16 v[80:83],a[120:123],a[40:43],v[80:83]
buffer_load_dwordx4 v8,s[8:11],s21 offen offset:2048 lds
v_mfma_f32_16x16x32_bf16 v[80:83],a[148:151],a[36:39],v[80:83]
s_add_u32 s21,s21,12288
v_exp_f32 v110,v110
v_mfma_f32_16x16x32_bf16 v[80:83],a[144:147],a[32:35],v[80:83]
s_add_u32 m0,s22,24576
v_exp_f32 v111,v111
v_mfma_f32_16x16x32_bf16 v[80:83],a[140:143],a[28:31],v[80:83]
v_cvt_pk_bf16_f32 v38,v108,v109
v_cvt_pk_bf16_f32 v39,v110,v111
v_mfma_f32_16x16x32_bf16 v[80:83],a[136:139],a[24:27],v[80:83]
v_fma_f32 v72,v72,s36,v13
v_fma_f32 v73,v73,s36,v13
v_mfma_f32_16x16x32_bf16 v[88:91],a[136:139],a[48:51],0
v_fma_f32 v74,v74,s36,v13
v_fma_f32 v75,v75,s36,v13
v_mfma_f32_16x16x32_bf16 v[88:91],a[140:143],a[52:55],v[88:91]
v_exp_f32 v72,v72
v_mfma_f32_16x16x32_bf16 v[88:91],a[144:147],a[56:59],v[88:91]
v_fma_f32 v80,v80,s36,v14
v_fma_f32 v81,v81,s36,v14
v_mfma_f32_16x16x32_bf16 v[88:91],a[148:151],a[60:63],v[88:91]
v_fma_f32 v82,v82,s36,v14
v_fma_f32 v83,v83,s36,v14
v_mfma_f32_16x16x32_bf16 v[88:91],a[120:123],a[64:67],v[88:91]
v_exp_f32 v73,v73
v_mfma_f32_16x16x32_bf16 v[88:91],a[124:127],a[68:71],v[88:91]
v_exp_f32 v74,v74
v_mfma_f32_16x16x32_bf16 v[96:99],a[124:127],a[92:95],0
v_exp_f32 v75,v75
v_mfma_f32_16x16x32_bf16 v[96:99],a[120:123],a[88:91],v[96:99]
buffer_load_dwordx4 v6,s[4:7],s20 offen offset:0 lds
v_mfma_f32_16x16x32_bf16 v[96:99],a[148:151],a[84:87],v[96:99]
v_exp_f32 v80,v80
v_mfma_f32_16x16x32_bf16 v[96:99],a[144:147],a[80:83],v[96:99]
v_fma_f32 v88,v88,s36,v15
v_fma_f32 v89,v89,s36,v15
v_mfma_f32_16x16x32_bf16 v[96:99],a[140:143],a[76:79],v[96:99]
v_exp_f32 v81,v81
v_mfma_f32_16x16x32_bf16 v[96:99],a[136:139],a[72:75],v[96:99]
v_exp_f32 v82,v82
v_mfma_f32_16x16x32_bf16 v[104:107],a[136:139],a[96:99],0
ds_read_b128 a[136:139],v0 offset:6272
v_cvt_pk_bf16_f32 v44,v72,v73
v_mfma_f32_16x16x32_bf16 v[104:107],a[140:143],a[100:103],v[104:107]
ds_read_b128 a[140:143],v1 offset:6272
v_cvt_pk_bf16_f32 v45,v74,v75
v_mfma_f32_16x16x32_bf16 v[104:107],a[144:147],a[104:107],v[104:107]
ds_read_b128 a[144:147],v0 offset:6400
v_cvt_pk_bf16_f32 v48,v80,v81
v_mfma_f32_16x16x32_bf16 v[104:107],a[148:151],a[108:111],v[104:107]
ds_read_b128 a[148:151],v1 offset:6400
v_mfma_f32_16x16x32_bf16 v[104:107],a[120:123],a[112:115],v[104:107]
v_exp_f32 v83,v83
v_mfma_f32_16x16x32_bf16 v[104:107],a[124:127],a[116:119],v[104:107]
s_waitcnt lgkmcnt(4)
v_exp_f32 v88,v88
v_mfma_f32_16x16x32_bf16 v[76:79],a[128:131],a[0:3],0
v_exp_f32 v89,v89
v_mfma_f32_16x16x32_bf16 v[76:79],a[132:135],a[4:7],v[76:79]
buffer_load_dwordx4 v7,s[4:7],s20 offen offset:1024 lds
s_waitcnt lgkmcnt(3)
v_mfma_f32_16x16x32_bf16 v[76:79],a[136:139],a[8:11],v[76:79]
s_waitcnt lgkmcnt(2)
v_cvt_pk_bf16_f32 v49,v82,v83
v_cvt_pk_bf16_f32 v52,v88,v89
v_mfma_f32_16x16x32_bf16 v[76:79],a[140:143],a[12:15],v[76:79]
s_waitcnt lgkmcnt(0)
v_mfma_f32_16x16x32_bf16 v[76:79],a[144:147],a[16:19],v[76:79]
v_mfma_f32_16x16x32_bf16 v[76:79],a[148:151],a[20:23],v[76:79]
v_mfma_f32_16x16x32_bf16 v[84:87],a[148:151],a[44:47],0
v_mfma_f32_16x16x32_bf16 v[84:87],a[144:147],a[40:43],v[84:87]
v_mfma_f32_16x16x32_bf16 v[84:87],a[140:143],a[36:39],v[84:87]
v_mfma_f32_16x16x32_bf16 v[84:87],a[136:139],a[32:35],v[84:87]
v_mfma_f32_16x16x32_bf16 v[84:87],a[132:135],a[28:31],v[84:87]
v_mfma_f32_16x16x32_bf16 v[84:87],a[128:131],a[24:27],v[84:87]
v_mfma_f32_16x16x32_bf16 v[92:95],a[128:131],a[48:51],0
buffer_load_dwordx4 v8,s[4:7],s20 offen offset:2048 lds
v_mfma_f32_16x16x32_bf16 v[92:95],a[132:135],a[52:55],v[92:95]
s_add_u32 s20,s20,12288
s_add_u32 s38,s38,1
s_cmp_lt_u32 s38,2
v_mfma_f32_16x16x32_bf16 v[92:95],a[136:139],a[56:59],v[92:95]
v_mfma_f32_16x16x32_bf16 v[92:95],a[140:143],a[60:63],v[92:95]
v_mfma_f32_16x16x32_bf16 v[92:95],a[144:147],a[64:67],v[92:95]
v_mfma_f32_16x16x32_bf16 v[92:95],a[148:151],a[68:71],v[92:95]
v_mfma_f32_16x16x32_bf16 v[100:103],a[148:151],a[92:95],0
ds_read_b64_tr_b16 a[120:121],v2 offset:24576
v_mfma_f32_16x16x32_bf16 v[100:103],a[144:147],a[88:91],v[100:103]
ds_read_b64_tr_b16 a[122:123],v2 offset:30720
v_mfma_f32_16x16x32_bf16 v[100:103],a[140:143],a[84:87],v[100:103]
v_mfma_f32_16x16x32_bf16 v[100:103],a[136:139],a[80:83],v[100:103]
ds_read_b64_tr_b16 a[124:125],v3 offset:24576
v_mfma_f32_16x16x32_bf16 v[100:103],a[132:135],a[76:79],v[100:103]
ds_read_b64_tr_b16 a[126:127],v3 offset:30720
v_mfma_f32_16x16x32_bf16 v[100:103],a[128:131],a[72:75],v[100:103]
v_mfma_f32_16x16x32_bf16 v[108:111],a[128:131],a[96:99],0
ds_read_b64_tr_b16 a[128:129],v4 offset:24576
v_mfma_f32_16x16x32_bf16 v[108:111],a[132:135],a[100:103],v[108:111]
ds_read_b64_tr_b16 a[130:131],v4 offset:30720
v_mfma_f32_16x16x32_bf16 v[108:111],a[136:139],a[104:107],v[108:111]
ds_read_b64_tr_b16 a[132:133],v5 offset:24576
v_mfma_f32_16x16x32_bf16 v[108:111],a[140:143],a[108:111],v[108:111]
ds_read_b64_tr_b16 a[134:135],v5 offset:30720
v_mfma_f32_16x16x32_bf16 v[108:111],a[144:147],a[112:115],v[108:111]
v_mfma_f32_16x16x32_bf16 v[108:111],a[148:151],a[116:119],v[108:111]
s_cbranch_scc1 L_loop5w0
s_cmp_ge_u32 s69,6
s_cbranch_scc1 L_end5
s_cmp_eq_u32 s40,0
s_cbranch_scc1 L_tr54
s_branch L_tr55
L_tr54:
s_waitcnt vmcnt(43)
s_waitcnt lgkmcnt(3)
v_mfma_f32_16x16x32_bf16 v[160:163],a[120:123],v[20:23],v[160:163]
s_add_u32 m0,s24,0
ds_read_b128 a[12:15],v12 offset:128
v_fma_f32 v101,v101,s36,v16
v_mfma_f32_16x16x32_bf16 v[164:167],a[124:127],v[20:23],v[164:167]
ds_read_b128 a[20:23],v12 offset:256
v_fma_f32 v103,v103,s36,v16
v_mfma_f32_16x16x32_bf16 v[212:215],a[124:127],v[24:27],v[212:215]
ds_read_b128 a[4:7],v12 offset:0
v_fma_f32 v87,v87,s36,v14
v_mfma_f32_16x16x32_bf16 v[208:211],a[120:123],v[24:27],v[208:211]
ds_read_b128 a[16:19],v11 offset:256
v_fma_f32 v106,v106,s36,v17
v_mfma_f32_16x16x32_bf16 v[112:115],a[120:123],v[28:31],v[112:115]
ds_read_b128 a[0:3],v11 offset:0
v_fma_f32 v99,v99,s36,v16
v_mfma_f32_16x16x32_bf16 v[116:119],a[124:127],v[28:31],v[116:119]
ds_read_b128 a[8:11],v11 offset:128
v_fma_f32 v96,v96,s36,v16
v_mfma_f32_16x16x32_bf16 a[164:167],a[124:127],v[32:35],a[164:167]
ds_read_b64_tr_b16 a[136:137],v2 offset:24704
v_fma_f32 v77,v77,s36,v13
v_mfma_f32_16x16x32_bf16 a[160:163],a[120:123],v[32:35],a[160:163]
ds_read_b64_tr_b16 a[138:139],v2 offset:30848
v_fma_f32 v85,v85,s36,v14
v_mfma_f32_16x16x32_bf16 a[208:211],a[120:123],v[36:39],a[208:211]
ds_read_b64_tr_b16 a[140:141],v3 offset:24704
ds_read_b64_tr_b16 a[142:143],v3 offset:30848
ds_read_b64_tr_b16 a[144:145],v4 offset:24704
ds_read_b64_tr_b16 a[146:147],v4 offset:30848
ds_read_b64_tr_b16 a[150:151],v5 offset:30848
ds_read_b64_tr_b16 a[148:149],v5 offset:24704
ds_read_b128 a[40:43],v11 offset:6400
v_mfma_f32_16x16x32_bf16 a[212:215],a[124:127],v[36:39],a[212:215]
s_waitcnt lgkmcnt(11)
v_fma_f32 v84,v84,s36,v14
ds_read_b128 a[32:35],v11 offset:6272
v_mfma_f32_16x16x32_bf16 a[216:219],a[128:131],v[36:39],a[216:219]
s_waitcnt lgkmcnt(10)
buffer_load_dwordx4 v6,s[12:15],s28 offen offset:0 nt lds
v_mfma_f32_16x16x32_bf16 a[220:223],a[132:135],v[36:39],a[220:223]
ds_read_b64_tr_b16 a[122:123],v2 offset:30976
ds_read_b128 a[44:47],v12 offset:6400
v_mfma_f32_16x16x32_bf16 a[172:175],a[132:135],v[32:35],a[172:175]
v_exp_f32 v101,v101
ds_read_b64_tr_b16 a[120:121],v2 offset:24832
ds_read_b128 a[24:27],v11 offset:6144
v_mfma_f32_16x16x32_bf16 a[168:171],a[128:131],v[32:35],a[168:171]
v_exp_f32 v77,v77
ds_read_b128 a[28:31],v12 offset:6144
v_mfma_f32_16x16x32_bf16 v[120:123],a[128:131],v[28:31],v[120:123]
v_fma_f32 v111,v111,s36,v17
ds_read_b64_tr_b16 a[126:127],v3 offset:30976
ds_read_b64_tr_b16 a[124:125],v3 offset:24832
ds_read_b128 a[36:39],v12 offset:6272
v_mfma_f32_16x16x32_bf16 v[124:127],a[132:135],v[28:31],v[124:127]
buffer_load_dwordx4 v7,s[12:15],s28 offen offset:1024 nt lds
v_mfma_f32_16x16x32_bf16 v[220:223],a[132:135],v[24:27],v[220:223]
v_fma_f32 v95,v95,s36,v15
v_fma_f32 v100,v100,s36,v16
v_mfma_f32_16x16x32_bf16 v[216:219],a[128:131],v[24:27],v[216:219]
v_exp_f32 v106,v106
v_mfma_f32_16x16x32_bf16 v[168:171],a[128:131],v[20:23],v[168:171]
ds_read_b64_tr_b16 a[130:131],v4 offset:30976
v_fma_f32 v93,v93,s36,v15
v_mfma_f32_16x16x32_bf16 v[172:175],a[132:135],v[20:23],v[172:175]
s_waitcnt lgkmcnt(4)
ds_read_b64_tr_b16 a[128:129],v4 offset:24832
v_exp_f32 v111,v111
v_mfma_f32_16x16x32_bf16 v[176:179],a[136:139],v[20:23],v[176:179]
ds_read_b64_tr_b16 a[132:133],v5 offset:24832
buffer_load_dwordx4 v8,s[12:15],s28 offen offset:2048 nt lds
v_mfma_f32_16x16x32_bf16 v[180:183],a[140:143],v[20:23],v[180:183]
s_add_u32 s28,s28,3072
ds_read_b64_tr_b16 a[134:135],v5 offset:30976
v_fma_f32 v107,v107,s36,v17
v_mfma_f32_16x16x32_bf16 v[228:231],a[140:143],v[24:27],v[228:231]
s_add_u32 m0,s24,3072
v_fma_f32 v92,v92,s36,v15
v_exp_f32 v92,v92
v_mfma_f32_16x16x32_bf16 v[224:227],a[136:139],v[24:27],v[224:227]
v_fma_f32 v109,v109,s36,v17
v_exp_f32 v109,v109
v_mfma_f32_16x16x32_bf16 v[128:131],a[136:139],v[28:31],v[128:131]
v_fma_f32 v97,v97,s36,v16
v_exp_f32 v84,v84
v_mfma_f32_16x16x32_bf16 v[132:135],a[140:143],v[28:31],v[132:135]
v_fma_f32 v94,v94,s36,v15
v_exp_f32 v94,v94
v_mfma_f32_16x16x32_bf16 a[180:183],a[140:143],v[32:35],a[180:183]
v_fma_f32 v104,v104,s36,v17
v_fma_f32 v90,v90,s36,v15
v_mfma_f32_16x16x32_bf16 a[176:179],a[136:139],v[32:35],a[176:179]
buffer_load_dwordx4 v6,s[12:15],s28 offen offset:0 nt lds
v_mfma_f32_16x16x32_bf16 a[224:227],a[136:139],v[36:39],a[224:227]
v_exp_f32 v93,v93
v_mfma_f32_16x16x32_bf16 a[228:231],a[140:143],v[36:39],a[228:231]
v_exp_f32 v104,v104
v_mfma_f32_16x16x32_bf16 a[232:235],a[144:147],v[36:39],a[232:235]
v_exp_f32 v96,v96
v_mfma_f32_16x16x32_bf16 a[236:239],a[148:151],v[36:39],a[236:239]
v_fma_f32 v78,v78,s36,v13
v_exp_f32 v78,v78
v_mfma_f32_16x16x32_bf16 a[188:191],a[148:151],v[32:35],a[188:191]
v_fma_f32 v110,v110,s36,v17
v_exp_f32 v110,v110
v_mfma_f32_16x16x32_bf16 a[184:187],a[144:147],v[32:35],a[184:187]
v_exp_f32 v97,v97
v_mfma_f32_16x16x32_bf16 v[136:139],a[144:147],v[28:31],v[136:139]
v_exp_f32 v100,v100
v_mfma_f32_16x16x32_bf16 v[140:143],a[148:151],v[28:31],v[140:143]
buffer_load_dwordx4 v7,s[12:15],s28 offen offset:1024 nt lds
v_mfma_f32_16x16x32_bf16 v[236:239],a[148:151],v[24:27],v[236:239]
v_fma_f32 v102,v102,s36,v16
v_exp_f32 v102,v102
v_mfma_f32_16x16x32_bf16 v[232:235],a[144:147],v[24:27],v[232:235]
v_fma_f32 v79,v79,s36,v13
v_exp_f32 v79,v79
v_mfma_f32_16x16x32_bf16 v[184:187],a[144:147],v[20:23],v[184:187]
v_exp_f32 v85,v85
v_mfma_f32_16x16x32_bf16 v[188:191],a[148:151],v[20:23],v[188:191]
v_fma_f32 v108,v108,s36,v17
v_exp_f32 v108,v108
v_mfma_f32_16x16x32_bf16 v[192:195],a[120:123],v[20:23],v[192:195]
s_waitcnt lgkmcnt(0)
v_fma_f32 v98,v98,s36,v16
v_exp_f32 v87,v87
v_mfma_f32_16x16x32_bf16 v[196:199],a[124:127],v[20:23],v[196:199]
v_fma_f32 v76,v76,s36,v13
v_exp_f32 v76,v76
v_mfma_f32_16x16x32_bf16 v[244:247],a[124:127],v[24:27],v[244:247]
buffer_load_dwordx4 v8,s[12:15],s28 offen offset:2048 nt lds
s_waitcnt vmcnt(18)
s_barrier
v_mfma_f32_16x16x32_bf16 v[240:243],a[120:123],v[24:27],v[240:243]
s_add_u32 s28,s28,3072
v_fma_f32 v105,v105,s36,v17
v_exp_f32 v107,v107
v_mfma_f32_16x16x32_bf16 v[144:147],a[120:123],v[28:31],v[144:147]
s_add_u32 m0,s22,0
v_fma_f32 v91,v91,s36,v15
v_exp_f32 v91,v91
v_mfma_f32_16x16x32_bf16 v[148:151],a[124:127],v[28:31],v[148:151]
buffer_load_dwordx4 v6,s[4:7],s25 offen offset:0 lds
v_mfma_f32_16x16x32_bf16 a[196:199],a[124:127],v[32:35],a[196:199]
buffer_load_dwordx4 v7,s[4:7],s25 offen offset:1024 lds
v_mfma_f32_16x16x32_bf16 a[192:195],a[120:123],v[32:35],a[192:195]
buffer_load_dwordx4 v8,s[4:7],s25 offen offset:2048 lds
v_mfma_f32_16x16x32_bf16 a[240:243],a[120:123],v[36:39],a[240:243]
v_fma_f32 v86,v86,s36,v14
v_exp_f32 v86,v86
v_mfma_f32_16x16x32_bf16 a[244:247],a[124:127],v[36:39],a[244:247]
v_exp_f32 v95,v95
v_mfma_f32_16x16x32_bf16 a[248:251],a[128:131],v[36:39],a[248:251]
v_exp_f32 v103,v103
v_mfma_f32_16x16x32_bf16 a[252:255],a[132:135],v[36:39],a[252:255]
ds_read_b64_tr_b16 a[136:137],v2 offset:0
v_cvt_pk_bf16_f32 v41,v106,v107
v_mfma_f32_16x16x32_bf16 a[204:207],a[132:135],v[32:35],a[204:207]
ds_read_b64_tr_b16 a[138:139],v2 offset:6144
v_exp_f32 v99,v99
v_mfma_f32_16x16x32_bf16 a[200:203],a[128:131],v[32:35],a[200:203]
ds_read_b64_tr_b16 a[140:141],v3 offset:0
v_cvt_pk_bf16_f32 v42,v108,v109
v_mfma_f32_16x16x32_bf16 v[152:155],a[128:131],v[28:31],v[152:155]
ds_read_b64_tr_b16 a[142:143],v3 offset:6144
v_cvt_pk_bf16_f32 v50,v84,v85
v_mfma_f32_16x16x32_bf16 v[156:159],a[132:135],v[28:31],v[156:159]
ds_read_b64_tr_b16 a[144:145],v4 offset:0
v_exp_f32 v90,v90
v_mfma_f32_16x16x32_bf16 v[252:255],a[132:135],v[24:27],v[252:255]
ds_read_b64_tr_b16 a[146:147],v4 offset:6144
v_exp_f32 v105,v105
v_mfma_f32_16x16x32_bf16 v[248:251],a[128:131],v[24:27],v[248:251]
ds_read_b64_tr_b16 a[148:149],v5 offset:0
v_cvt_pk_bf16_f32 v55,v94,v95
v_mfma_f32_16x16x32_bf16 v[200:203],a[128:131],v[20:23],v[200:203]
ds_read_b64_tr_b16 a[150:151],v5 offset:6144
v_cvt_pk_bf16_f32 v51,v86,v87
v_mfma_f32_16x16x32_bf16 v[204:207],a[132:135],v[20:23],v[204:207]
v_cvt_pk_bf16_f32 v59,v102,v103
v_exp_f32 v98,v98
v_cvt_pk_bf16_f32 v54,v92,v93
v_cvt_pk_bf16_f32 v56,v96,v97
v_cvt_pk_bf16_f32 v53,v90,v91
v_cvt_pk_bf16_f32 v47,v78,v79
v_cvt_pk_bf16_f32 v43,v110,v111
v_cvt_pk_bf16_f32 v58,v100,v101
v_cvt_pk_bf16_f32 v46,v76,v77
v_cvt_pk_bf16_f32 v57,v98,v99
v_cvt_pk_bf16_f32 v40,v104,v105
v_smfmac_f32_16x16x64_bf16 v[60:63],a[152:155],v[44:51],v18
v_subrev_u32 v10,18432,v10
v_smfmac_f32_16x16x64_bf16 v[64:67],a[152:155],v[52:59],v18
v_smfmac_f32_16x16x64_bf16 v[68:71],a[152:155],v[36:43],v18
s_waitcnt lgkmcnt(1)
v_mfma_f32_16x16x32_bf16 v[160:163],a[136:139],v[44:47],v[160:163]
s_add_u32 s87,s42,18432
ds_read_b64_tr_b16 a[122:123],v2 offset:6272
v_mbcnt_lo_u32_b32 v35,-1,0
v_mfma_f32_16x16x32_bf16 v[164:167],a[140:143],v[44:47],v[164:167]
s_add_u32 s66,s42,24576
ds_read_b64_tr_b16 a[120:121],v2 offset:128
v_mbcnt_hi_u32_b32 v35,-1,v35
v_mfma_f32_16x16x32_bf16 v[212:215],a[140:143],v[48:51],v[212:215]
ds_read_b64_tr_b16 a[126:127],v3 offset:6272
v_and_b32 v34,7,v35
v_mfma_f32_16x16x32_bf16 v[208:211],a[136:139],v[48:51],v[208:211]
ds_read_b64_tr_b16 a[124:125],v3 offset:128
v_lshrrev_b32 v19,5,v35
v_mfma_f32_16x16x32_bf16 v[112:115],a[136:139],v[52:55],v[112:115]
ds_read_b64_tr_b16 a[128:129],v4 offset:128
v_xor_b32 v34,v34,v19
v_mfma_f32_16x16x32_bf16 v[116:119],a[140:143],v[52:55],v[116:119]
ds_read_b64_tr_b16 a[130:131],v4 offset:6272
ds_read_b64_tr_b16 a[134:135],v5 offset:6272
ds_read_b64_tr_b16 a[132:133],v5 offset:128
v_mfma_f32_16x16x32_bf16 a[164:167],a[140:143],v[56:59],a[164:167]
v_and_b32 v19,15,v35
v_lshl_add_u32 v19,v19,7,s24
v_mfma_f32_16x16x32_bf16 a[160:163],a[136:139],v[56:59],a[160:163]
v_lshl_add_u32 v19,v34,4,v19
v_bfe_u32 v34,v35,4,1
v_mfma_f32_16x16x32_bf16 a[208:211],a[136:139],v[40:43],a[208:211]
ds_read_b64_tr_b16 a[136:137],v2 offset:256
v_lshl_add_u32 v32,v34,3,v19
v_mfma_f32_16x16x32_bf16 a[212:215],a[140:143],v[40:43],a[212:215]
ds_read_b64_tr_b16 a[138:139],v2 offset:6400
v_xor_b32 v34,64,v32
v_mfma_f32_16x16x32_bf16 a[216:219],a[144:147],v[40:43],a[216:219]
s_waitcnt lgkmcnt(6)
ds_read_b64_tr_b16 a[142:143],v3 offset:6400
v_xor_b32 v33,32,v32
v_mfma_f32_16x16x32_bf16 a[220:223],a[148:151],v[40:43],a[220:223]
ds_read_b64_tr_b16 a[140:141],v3 offset:256
v_bfe_u32 v19,v35,3,1
v_xor_b32 v35,96,v32
v_lshlrev_b32 v19,11,v19
v_add_u32 v36,v32,v19
v_add_u32 v37,v33,v19
v_add_u32 v38,v34,v19
v_add_u32 v39,v35,v19
v_add_f32 v68,v68,v69
v_add_f32 v68,v68,v70
v_add_f32 v66,v66,v67
v_accvgpr_read_b32 v73,a161
v_add_f32 v68,v68,v71
v_rcp_f32 v68,v68
v_accvgpr_read_b32 v72,a160
v_accvgpr_read_b32 v76,a208
v_rcp_f32 v66,v66
v_accvgpr_read_b32 v75,a163
v_pk_mul_f32 v[72:73],v[72:73],v[66:67] op_sel_hi:[1,0]
v_accvgpr_read_b32 v74,a162
v_pk_mul_f32 v[74:75],v[74:75],v[66:67] op_sel_hi:[1,0]
v_accvgpr_read_b32 v77,a209
v_pk_mul_f32 v[76:77],v[76:77],v[68:69] op_sel_hi:[1,0]
v_accvgpr_read_b32 v78,a210
v_accvgpr_read_b32 v79,a211
v_pk_mul_f32 v[78:79],v[78:79],v[68:69] op_sel_hi:[1,0]
v_accvgpr_read_b32 v81,a165
v_accvgpr_read_b32 v80,a164
v_mfma_f32_16x16x32_bf16 a[172:175],a[148:151],v[56:59],a[172:175]
v_accvgpr_read_b32 v84,a212
v_accvgpr_read_b32 v82,a166
v_accvgpr_read_b32 v87,a215
v_accvgpr_read_b32 v86,a214
v_accvgpr_read_b32 v83,a167
v_pk_mul_f32 v[80:81],v[80:81],v[66:67] op_sel_hi:[1,0]
v_pk_mul_f32 v[86:87],v[86:87],v[68:69] op_sel_hi:[1,0]
v_pk_mul_f32 v[82:83],v[82:83],v[66:67] op_sel_hi:[1,0]
v_accvgpr_read_b32 v85,a213
v_pk_mul_f32 v[84:85],v[84:85],v[68:69] op_sel_hi:[1,0]
v_accvgpr_read_b32 v94,a218
v_accvgpr_read_b32 v92,a216
v_mfma_f32_16x16x32_bf16 a[168:171],a[144:147],v[56:59],a[168:171]
v_accvgpr_read_b32 v95,a219
v_accvgpr_read_b32 v93,a217
v_mfma_f32_16x16x32_bf16 v[120:123],a[144:147],v[52:55],v[120:123]
v_accvgpr_read_b32 v96,a172
v_accvgpr_read_b32 v98,a174
v_mfma_f32_16x16x32_bf16 v[124:127],a[148:151],v[52:55],v[124:127]
v_accvgpr_read_b32 v99,a175
v_accvgpr_read_b32 v97,a173
v_mfma_f32_16x16x32_bf16 v[220:223],a[148:151],v[48:51],v[220:223]
v_accvgpr_read_b32 v89,a169
v_accvgpr_read_b32 v91,a171
v_accvgpr_read_b32 v88,a168
v_accvgpr_read_b32 v90,a170
v_accvgpr_read_b32 v102,a222
v_pk_mul_f32 v[94:95],v[94:95],v[68:69] op_sel_hi:[1,0]
v_pk_mul_f32 v[88:89],v[88:89],v[66:67] op_sel_hi:[1,0]
v_pk_mul_f32 v[90:91],v[90:91],v[66:67] op_sel_hi:[1,0]
v_pk_mul_f32 v[92:93],v[92:93],v[68:69] op_sel_hi:[1,0]
v_accvgpr_read_b32 v103,a223
v_accvgpr_read_b32 v101,a221
v_mfma_f32_16x16x32_bf16 v[216:219],a[144:147],v[48:51],v[216:219]
v_accvgpr_read_b32 v100,a220
v_add_f32 v62,v62,v63
v_rcp_f32 v62,v62
v_cvt_pk_bf16_f32 v72,v72,v73
v_pk_mul_f32 v[96:97],v[96:97],v[66:67] op_sel_hi:[1,0]
v_pk_mul_f32 v[100:101],v[100:101],v[68:69] op_sel_hi:[1,0]
v_pk_mul_f32 v[102:103],v[102:103],v[68:69] op_sel_hi:[1,0]
v_pk_mul_f32 v[98:99],v[98:99],v[66:67] op_sel_hi:[1,0]
v_cvt_pk_bf16_f32 v80,v80,v81
v_cvt_pk_bf16_f32 v73,v74,v75
v_mfma_f32_16x16x32_bf16 v[168:171],a[144:147],v[44:47],v[168:171]
ds_read_b64_tr_b16 a[146:147],v4 offset:6400
v_cvt_pk_bf16_f32 v76,v76,v77
v_mfma_f32_16x16x32_bf16 v[172:175],a[148:151],v[44:47],v[172:175]
ds_read_b64_tr_b16 a[144:145],v4 offset:256
v_cvt_pk_bf16_f32 v77,v78,v79
v_mfma_f32_16x16x32_bf16 v[176:179],a[120:123],v[44:47],v[176:179]
ds_read_b64_tr_b16 a[148:149],v5 offset:256
v_cvt_pk_bf16_f32 v84,v84,v85
v_mfma_f32_16x16x32_bf16 v[180:183],a[124:127],v[44:47],v[180:183]
ds_read_b64_tr_b16 a[150:151],v5 offset:6400
v_cvt_pk_bf16_f32 v85,v86,v87
v_mfma_f32_16x16x32_bf16 v[228:231],a[124:127],v[48:51],v[228:231]
ds_write2st64_b64 v32,v[72:73],v[76:77] offset0:36 offset1:40
v_mfma_f32_16x16x32_bf16 v[224:227],a[120:123],v[48:51],v[224:227]
v_cvt_pk_bf16_f32 v81,v82,v83
v_cvt_pk_bf16_f32 v92,v92,v93
v_mfma_f32_16x16x32_bf16 v[128:131],a[120:123],v[52:55],v[128:131]
v_cvt_pk_bf16_f32 v93,v94,v95
v_cvt_pk_bf16_f32 v100,v100,v101
v_mfma_f32_16x16x32_bf16 v[132:135],a[124:127],v[52:55],v[132:135]
v_cvt_pk_bf16_f32 v88,v88,v89
v_cvt_pk_bf16_f32 v89,v90,v91
v_mfma_f32_16x16x32_bf16 a[180:183],a[124:127],v[56:59],a[180:183]
ds_write2st64_b64 v33,v[80:81],v[84:85] offset0:36 offset1:40
v_pk_mul_f32 v[212:213],v[212:213],v[62:63] op_sel_hi:[1,0]
v_pk_mul_f32 v[210:211],v[210:211],v[62:63] op_sel_hi:[1,0]
v_pk_mul_f32 v[208:209],v[208:209],v[62:63] op_sel_hi:[1,0]
v_pk_mul_f32 v[214:215],v[214:215],v[62:63] op_sel_hi:[1,0]
v_pk_mul_f32 v[224:225],v[224:225],v[62:63] op_sel_hi:[1,0]
v_pk_mul_f32 v[228:229],v[228:229],v[62:63] op_sel_hi:[1,0]
v_pk_mul_f32 v[226:227],v[226:227],v[62:63] op_sel_hi:[1,0]
v_pk_mul_f32 v[230:231],v[230:231],v[62:63] op_sel_hi:[1,0]
v_cvt_pk_bf16_f32 v101,v102,v103
v_cvt_pk_bf16_f32 v96,v96,v97
v_mfma_f32_16x16x32_bf16 a[176:179],a[120:123],v[56:59],a[176:179]
v_accvgpr_read_b32 v90,a182
v_accvgpr_read_b32 v91,a183
v_mfma_f32_16x16x32_bf16 a[224:227],a[120:123],v[40:43],a[224:227]
ds_write2st64_b64 v34,v[88:89],v[92:93] offset0:36 offset1:40
v_mfma_f32_16x16x32_bf16 a[228:231],a[124:127],v[40:43],a[228:231]
s_waitcnt lgkmcnt(1)
v_accvgpr_read_b32 v89,a181
v_accvgpr_read_b32 v88,a180
v_mfma_f32_16x16x32_bf16 a[232:235],a[128:131],v[40:43],a[232:235]
v_accvgpr_read_b32 v81,a177
v_cvt_pk_bf16_f32 v97,v98,v99
v_mfma_f32_16x16x32_bf16 a[236:239],a[132:135],v[40:43],a[236:239]
v_accvgpr_read_b32 v87,a227
v_accvgpr_read_b32 v85,a225
v_mfma_f32_16x16x32_bf16 a[188:191],a[132:135],v[56:59],a[188:191]
ds_write2st64_b64 v35,v[96:97],v[100:101] offset0:36 offset1:40
v_mfma_f32_16x16x32_bf16 a[184:187],a[128:131],v[56:59],a[184:187]
v_accvgpr_read_b32 v101,a233
v_accvgpr_read_b32 v100,a232
v_mfma_f32_16x16x32_bf16 v[136:139],a[128:131],v[52:55],v[136:139]
ds_read_b128 v[104:107],v10 offset:18432
v_accvgpr_read_b32 v103,a235
v_mfma_f32_16x16x32_bf16 v[140:143],a[132:135],v[52:55],v[140:143]
ds_read_b128 v[108:111],v10 offset:19456
v_accvgpr_read_b32 v83,a179
v_mfma_f32_16x16x32_bf16 v[236:239],a[132:135],v[48:51],v[236:239]
s_waitcnt vmcnt(15)
ds_read_b128 a[68:71],v12 offset:12544
v_accvgpr_read_b32 v97,a185
v_mfma_f32_16x16x32_bf16 v[232:235],a[128:131],v[48:51],v[232:235]
ds_read_b128 a[64:67],v11 offset:12544
v_accvgpr_read_b32 v98,a186
v_mfma_f32_16x16x32_bf16 v[184:187],a[128:131],v[44:47],v[184:187]
ds_read_b128 a[60:63],v12 offset:12416
v_accvgpr_read_b32 v84,a224
v_mfma_f32_16x16x32_bf16 v[188:191],a[132:135],v[44:47],v[188:191]
ds_read_b128 a[56:59],v11 offset:12416
v_accvgpr_read_b32 v94,a230
v_mfma_f32_16x16x32_bf16 v[192:195],a[136:139],v[44:47],v[192:195]
s_waitcnt lgkmcnt(5)
ds_read_b128 a[52:55],v12 offset:12288
v_accvgpr_read_b32 v92,a228
ds_read_b128 a[48:51],v11 offset:12288
buffer_store_dwordx4 v[104:107],v9,s[16:19],s87 offen offset:0 nt
ds_read_b128 v[72:75],v10 offset:20480
v_pk_mul_f32 v[216:217],v[216:217],v[62:63] op_sel_hi:[1,0]
ds_read_b128 v[76:79],v10 offset:21504
v_pk_mul_f32 v[100:101],v[100:101],v[68:69] op_sel_hi:[1,0]
v_pk_mul_f32 v[236:237],v[236:237],v[62:63] op_sel_hi:[1,0]
v_pk_mul_f32 v[238:239],v[238:239],v[62:63] op_sel_hi:[1,0]
v_pk_mul_f32 v[220:221],v[220:221],v[62:63] op_sel_hi:[1,0]
v_pk_mul_f32 v[222:223],v[222:223],v[62:63] op_sel_hi:[1,0]
v_pk_mul_f32 v[88:89],v[88:89],v[66:67] op_sel_hi:[1,0]
s_waitcnt lgkmcnt(6)
buffer_store_dwordx4 v[108:111],v9,s[16:19],s87 offen offset:3072 nt
v_pk_mul_f32 v[234:235],v[234:235],v[62:63] op_sel_hi:[1,0]
v_pk_mul_f32 v[232:233],v[232:233],v[62:63] op_sel_hi:[1,0]
v_pk_mul_f32 v[90:91],v[90:91],v[66:67] op_sel_hi:[1,0]
v_pk_mul_f32 v[218:219],v[218:219],v[62:63] op_sel_hi:[1,0]
v_pk_mul_f32 v[84:85],v[84:85],v[68:69] op_sel_hi:[1,0]
v_accvgpr_read_b32 v93,a229
v_pk_mul_f32 v[92:93],v[92:93],v[68:69] op_sel_hi:[1,0]
v_accvgpr_read_b32 v80,a176
v_pk_mul_f32 v[80:81],v[80:81],v[66:67] op_sel_hi:[1,0]
v_accvgpr_read_b32 v82,a178
v_pk_mul_f32 v[82:83],v[82:83],v[66:67] op_sel_hi:[1,0]
v_accvgpr_read_b32 v86,a226
v_pk_mul_f32 v[86:87],v[86:87],v[68:69] op_sel_hi:[1,0]
s_waitcnt lgkmcnt(1)
buffer_store_dwordx4 v[72:75],v9,s[16:19],s66 offen offset:0 nt
v_accvgpr_read_b32 v96,a184
v_pk_mul_f32 v[96:97],v[96:97],v[66:67] op_sel_hi:[1,0]
v_accvgpr_read_b32 v95,a231
v_pk_mul_f32 v[94:95],v[94:95],v[68:69] op_sel_hi:[1,0]
v_accvgpr_read_b32 v102,a234
v_pk_mul_f32 v[102:103],v[102:103],v[68:69] op_sel_hi:[1,0]
v_accvgpr_read_b32 v99,a187
v_pk_mul_f32 v[98:99],v[98:99],v[66:67] op_sel_hi:[1,0]
v_cvt_pk_bf16_f32 v208,v208,v209
v_cvt_pk_bf16_f32 v209,v210,v211
v_mfma_f32_16x16x32_bf16 v[196:199],a[140:143],v[44:47],v[196:199]
v_cvt_pk_bf16_f32 v224,v224,v225
v_cvt_pk_bf16_f32 v225,v226,v227
v_mfma_f32_16x16x32_bf16 v[244:247],a[140:143],v[48:51],v[244:247]
ds_write2st64_b64 v36,v[208:209],v[224:225] offset0:12 offset1:14
v_accvgpr_read_b32 v226,a238
v_accvgpr_read_b32 v227,a239
v_pk_mul_f32 v[226:227],v[226:227],v[68:69] op_sel_hi:[1,0]
s_waitcnt lgkmcnt(1)
buffer_store_dwordx4 v[76:79],v9,s[16:19],s66 offen offset:3072 nt
v_accvgpr_read_b32 v225,a237
v_accvgpr_read_b32 v211,a191
v_accvgpr_read_b32 v208,a188
v_accvgpr_read_b32 v224,a236
v_pk_mul_f32 v[224:225],v[224:225],v[68:69] op_sel_hi:[1,0]
v_accvgpr_read_b32 v210,a190
v_pk_mul_f32 v[210:211],v[210:211],v[66:67] op_sel_hi:[1,0]
v_accvgpr_read_b32 v209,a189
v_pk_mul_f32 v[208:209],v[208:209],v[66:67] op_sel_hi:[1,0]
v_add_f32 v64,v64,v65
v_rcp_f32 v64,v64
v_mfma_f32_16x16x32_bf16 v[240:243],a[136:139],v[48:51],v[240:243]
v_cvt_pk_bf16_f32 v216,v216,v217
v_cvt_pk_bf16_f32 v217,v218,v219
v_mfma_f32_16x16x32_bf16 v[144:147],a[136:139],v[52:55],v[144:147]
v_cvt_pk_bf16_f32 v212,v212,v213
v_cvt_pk_bf16_f32 v213,v214,v215
v_mfma_f32_16x16x32_bf16 v[148:151],a[140:143],v[52:55],v[148:151]
v_cvt_pk_bf16_f32 v228,v228,v229
v_cvt_pk_bf16_f32 v229,v230,v231
v_mfma_f32_16x16x32_bf16 a[196:199],a[140:143],v[56:59],a[196:199]
ds_write2st64_b64 v37,v[212:213],v[228:229] offset0:12 offset1:14
v_pk_mul_f32 v[242:243],v[242:243],v[62:63] op_sel_hi:[1,0]
v_pk_mul_f32 v[112:113],v[112:113],v[64:65] op_sel_hi:[1,0]
v_pk_mul_f32 v[114:115],v[114:115],v[64:65] op_sel_hi:[1,0]
v_pk_mul_f32 v[240:241],v[240:241],v[62:63] op_sel_hi:[1,0]
v_cvt_pk_bf16_f32 v232,v232,v233
v_cvt_pk_bf16_f32 v233,v234,v235
v_mfma_f32_16x16x32_bf16 a[192:195],a[136:139],v[56:59],a[192:195]
v_cvt_pk_bf16_f32 v236,v236,v237
v_cvt_pk_bf16_f32 v237,v238,v239
v_mfma_f32_16x16x32_bf16 a[240:243],a[136:139],v[40:43],a[240:243]
v_cvt_pk_bf16_f32 v220,v220,v221
v_accvgpr_read_b32 v234,a198
v_mfma_f32_16x16x32_bf16 a[244:247],a[140:143],v[40:43],a[244:247]
ds_write2st64_b64 v38,v[216:217],v[232:233] offset0:12 offset1:14
v_pk_mul_f32 v[246:247],v[246:247],v[62:63] op_sel_hi:[1,0]
v_pk_mul_f32 v[116:117],v[116:117],v[64:65] op_sel_hi:[1,0]
v_pk_mul_f32 v[118:119],v[118:119],v[64:65] op_sel_hi:[1,0]
v_pk_mul_f32 v[244:245],v[244:245],v[62:63] op_sel_hi:[1,0]
v_accvgpr_read_b32 v231,a195
v_accvgpr_read_b32 v230,a194
v_mfma_f32_16x16x32_bf16 a[248:251],a[144:147],v[40:43],a[248:251]
v_accvgpr_read_b32 v217,a241
v_accvgpr_read_b32 v219,a243
v_mfma_f32_16x16x32_bf16 a[252:255],a[148:151],v[40:43],a[252:255]
v_accvgpr_read_b32 v216,a240
s_waitcnt vmcnt(4)
s_barrier
v_mfma_f32_16x16x32_bf16 a[204:207],a[148:151],v[56:59],a[204:207]
ds_read_b128 a[140:143],v1 offset:256
v_accvgpr_read_b32 v218,a242
v_mfma_f32_16x16x32_bf16 a[200:203],a[144:147],v[56:59],a[200:203]
ds_read_b128 a[136:139],v0 offset:256
v_accvgpr_read_b32 v228,a192
v_mfma_f32_16x16x32_bf16 v[152:155],a[144:147],v[52:55],v[152:155]
ds_read_b128 a[132:135],v1 offset:128
v_accvgpr_read_b32 v229,a193
v_mfma_f32_16x16x32_bf16 v[156:159],a[148:151],v[52:55],v[156:159]
ds_read_b128 a[128:131],v0 offset:128
v_cvt_pk_bf16_f32 v221,v222,v223
v_mfma_f32_16x16x32_bf16 v[252:255],a[148:151],v[48:51],v[252:255]
ds_write2st64_b64 v39,v[220:221],v[236:237] offset0:12 offset1:14
v_mfma_f32_16x16x32_bf16 v[248:251],a[144:147],v[48:51],v[248:251]
v_accvgpr_read_b32 v222,a246
ds_read_b128 a[124:127],v1 offset:0
v_mfma_f32_16x16x32_bf16 v[200:203],a[144:147],v[44:47],v[200:203]
v_accvgpr_read_b32 v223,a247
ds_read_b128 a[120:123],v0 offset:0
v_mfma_f32_16x16x32_bf16 v[204:207],a[148:151],v[44:47],v[204:207]
s_waitcnt lgkmcnt(5)
v_accvgpr_read_b32 v233,a197
v_accvgpr_read_b32 v220,a244
v_mfma_f32_16x16x32_bf16 v[72:75],a[140:143],a[20:23],0
ds_read_b128 a[144:147],v0 offset:6144
v_accvgpr_read_b32 v221,a245
ds_read_b128 a[148:151],v1 offset:6144
v_pk_mul_f32 v[126:127],v[126:127],v[64:65] op_sel_hi:[1,0]
v_pk_mul_f32 v[216:217],v[216:217],v[68:69] op_sel_hi:[1,0]
v_pk_mul_f32 v[254:255],v[254:255],v[62:63] op_sel_hi:[1,0]
v_pk_mul_f32 v[230:231],v[230:231],v[66:67] op_sel_hi:[1,0]
v_pk_mul_f32 v[228:229],v[228:229],v[66:67] op_sel_hi:[1,0]
v_pk_mul_f32 v[122:123],v[122:123],v[64:65] op_sel_hi:[1,0]
v_pk_mul_f32 v[250:251],v[250:251],v[62:63] op_sel_hi:[1,0]
v_pk_mul_f32 v[248:249],v[248:249],v[62:63] op_sel_hi:[1,0]
v_pk_mul_f32 v[124:125],v[124:125],v[64:65] op_sel_hi:[1,0]
v_pk_mul_f32 v[120:121],v[120:121],v[64:65] op_sel_hi:[1,0]
v_pk_mul_f32 v[218:219],v[218:219],v[68:69] op_sel_hi:[1,0]
v_pk_mul_f32 v[252:253],v[252:253],v[62:63] op_sel_hi:[1,0]
v_accvgpr_read_b32 v235,a199
v_accvgpr_read_b32 v232,a196
v_mfma_f32_16x16x32_bf16 v[72:75],a[136:139],a[16:19],v[72:75]
s_waitcnt lgkmcnt(2)
v_cvt_pk_bf16_f32 v80,v80,v81
v_cvt_pk_bf16_f32 v84,v84,v85
v_mfma_f32_16x16x32_bf16 v[72:75],a[132:135],a[12:15],v[72:75]
v_cvt_pk_bf16_f32 v85,v86,v87
v_cvt_pk_bf16_f32 v81,v82,v83
ds_write2st64_b64 v32,v[80:81],v[84:85] offset0:36 offset1:40
v_pk_mul_f32 v[234:235],v[234:235],v[66:67] op_sel_hi:[1,0]
v_pk_mul_f32 v[222:223],v[222:223],v[68:69] op_sel_hi:[1,0]
v_pk_mul_f32 v[232:233],v[232:233],v[66:67] op_sel_hi:[1,0]
v_pk_mul_f32 v[220:221],v[220:221],v[68:69] op_sel_hi:[1,0]
v_accvgpr_read_b32 v238,a202
v_accvgpr_read_b32 v84,a248
v_mfma_f32_16x16x32_bf16 v[72:75],a[128:131],a[8:11],v[72:75]
v_accvgpr_read_b32 v87,a251
v_accvgpr_read_b32 v86,a250
v_mfma_f32_16x16x32_bf16 v[72:75],a[124:127],a[4:7],v[72:75]
v_accvgpr_read_b32 v236,a200
v_accvgpr_read_b32 v239,a203
v_mfma_f32_16x16x32_bf16 v[72:75],a[120:123],a[0:3],v[72:75]
v_accvgpr_read_b32 v237,a201
v_accvgpr_read_b32 v85,a249
v_add_f32 v60,v60,v61
v_rcp_f32 v60,v60
v_pk_mul_f32 v[86:87],v[86:87],v[68:69] op_sel_hi:[1,0]
v_pk_mul_f32 v[238:239],v[238:239],v[66:67] op_sel_hi:[1,0]
v_pk_mul_f32 v[236:237],v[236:237],v[66:67] op_sel_hi:[1,0]
v_pk_mul_f32 v[84:85],v[84:85],v[68:69] op_sel_hi:[1,0]
v_min3_f32 v61,v60,v62,v64
v_pk_mov_b32 v[62:63],0,0
v_cvt_pk_bf16_f32 v88,v88,v89
v_cvt_pk_bf16_f32 v96,v96,v97
v_mfma_f32_16x16x32_bf16 v[80:83],a[120:123],a[24:27],0
v_cvt_pk_bf16_f32 v100,v100,v101
v_cvt_pk_bf16_f32 v89,v90,v91
v_mfma_f32_16x16x32_bf16 v[80:83],a[124:127],a[28:31],v[80:83]
v_cvt_pk_bf16_f32 v92,v92,v93
v_min3_f32 v61,v61,v66,v68
v_mfma_f32_16x16x32_bf16 v[80:83],a[128:131],a[32:35],v[80:83]
v_cmp_nlt_f32 vcc,s37,v61
v_cvt_pk_bf16_f32 v93,v94,v95
ds_write2st64_b64 v33,v[88:89],v[92:93] offset0:36 offset1:40
v_accvgpr_read_b32 v95,a207
v_cvt_pk_bf16_f32 v97,v98,v99
v_accvgpr_read_b32 v92,a204
v_accvgpr_read_b32 v93,a205
v_pk_mul_f32 v[92:93],v[92:93],v[66:67] op_sel_hi:[1,0]
v_cvt_pk_bf16_f32 v101,v102,v103
v_accvgpr_read_b32 v94,a206
v_pk_mul_f32 v[94:95],v[94:95],v[66:67] op_sel_hi:[1,0]
v_pk_mov_b32 v[66:67],0,0
v_accvgpr_read_b32 v98,a254
v_accvgpr_read_b32 v99,a255
ds_write2st64_b64 v34,v[96:97],v[100:101] offset0:36 offset1:40
v_pk_mul_f32 v[98:99],v[98:99],v[68:69] op_sel_hi:[1,0]
v_accvgpr_read_b32 v96,a252
v_accvgpr_read_b32 v97,a253
v_pk_mul_f32 v[96:97],v[96:97],v[68:69] op_sel_hi:[1,0]
v_cvt_pk_bf16_f32 v208,v208,v209
v_cvt_pk_bf16_f32 v224,v224,v225
v_mfma_f32_16x16x32_bf16 v[80:83],a[132:135],a[36:39],v[80:83]
s_cmp_lg_u64 vcc,0
v_cvt_pk_bf16_f32 v225,v226,v227
v_cvt_pk_bf16_f32 v209,v210,v211
v_mfma_f32_16x16x32_bf16 v[80:83],a[136:139],a[40:43],v[80:83]
s_cselect_b32 s62,s32,0
v_cvt_pk_bf16_f32 v116,v116,v117
v_cvt_pk_bf16_f32 v240,v240,v241
v_mfma_f32_16x16x32_bf16 v[80:83],a[140:143],a[44:47],v[80:83]
s_or_b32 s31,s31,s62
ds_write2st64_b64 v35,v[208:209],v[224:225] offset0:36 offset1:40
v_mfma_f32_16x16x32_bf16 v[88:91],a[140:143],a[68:71],0
s_lshl_b32 s32,s32,1
v_cvt_pk_bf16_f32 v241,v242,v243
ds_read_b128 v[76:79],v10 offset:18432
v_cvt_pk_bf16_f32 v244,v244,v245
ds_read_b128 v[104:107],v10 offset:19456
v_pk_mul_f32 v[144:145],v[144:145],v[64:65] op_sel_hi:[1,0]
ds_read_b128 v[108:111],v10 offset:20480
v_pk_mul_f32 v[128:129],v[128:129],v[64:65] op_sel_hi:[1,0]
ds_read_b128 v[212:215],v10 offset:21504
v_pk_mul_f32 v[130:131],v[130:131],v[64:65] op_sel_hi:[1,0]
v_pk_mul_f32 v[146:147],v[146:147],v[64:65] op_sel_hi:[1,0]
v_cvt_pk_bf16_f32 v248,v248,v249
v_cvt_pk_bf16_f32 v112,v112,v113
v_mfma_f32_16x16x32_bf16 v[88:91],a[136:139],a[64:67],v[88:91]
s_add_u32 m0,s23,0
v_cvt_pk_bf16_f32 v113,v114,v115
v_cvt_pk_bf16_f32 v245,v246,v247
v_mfma_f32_16x16x32_bf16 v[88:91],a[132:135],a[60:63],v[88:91]
buffer_load_dwordx4 v6,s[8:11],s25 offen offset:0 lds
v_mfma_f32_16x16x32_bf16 v[88:91],a[128:131],a[56:59],v[88:91]
buffer_load_dwordx4 v7,s[8:11],s25 offen offset:1024 lds
buffer_load_dwordx4 v8,s[8:11],s25 offen offset:2048 lds
ds_write2st64_b64 v36,v[240:241],v[112:113] offset0:16 offset1:24
v_pk_mul_f32 v[134:135],v[134:135],v[64:65] op_sel_hi:[1,0]
v_pk_mul_f32 v[132:133],v[132:133],v[64:65] op_sel_hi:[1,0]
v_pk_mul_f32 v[148:149],v[148:149],v[64:65] op_sel_hi:[1,0]
s_waitcnt lgkmcnt(1)
buffer_store_dwordx4 v[76:79],v9,s[16:19],s87 offen offset:128 nt
v_pk_mul_f32 v[150:151],v[150:151],v[64:65] op_sel_hi:[1,0]
v_cvt_pk_bf16_f32 v117,v118,v119
v_cvt_pk_bf16_f32 v228,v228,v229
v_mfma_f32_16x16x32_bf16 v[88:91],a[124:127],a[52:55],v[88:91]
s_waitcnt vmcnt(11)
ds_read_b128 a[72:75],v11 offset:0
v_cvt_pk_bf16_f32 v124,v124,v125
v_mfma_f32_16x16x32_bf16 v[88:91],a[120:123],a[48:51],v[88:91]
s_mov_b32 s27,s42
ds_write2st64_b64 v37,v[244:245],v[116:117] offset0:16 offset1:24
v_cvt_pk_bf16_f32 v125,v126,v127
v_cvt_pk_bf16_f32 v120,v120,v121
v_cvt_pk_bf16_f32 v121,v122,v123
ds_read_b128 a[76:79],v12 offset:0
buffer_store_dwordx4 v[104:107],v9,s[16:19],s87 offen offset:3200 nt
ds_read_b128 a[80:83],v11 offset:128
v_cvt_pk_bf16_f32 v236,v236,v237
ds_read_b128 a[84:87],v12 offset:128
v_cvt_pk_bf16_f32 v252,v252,v253
ds_read_b128 a[88:91],v11 offset:256
v_cvt_pk_bf16_f32 v253,v254,v255
ds_read_b128 a[92:95],v12 offset:256
buffer_store_dwordx4 v[108:111],v9,s[16:19],s66 offen offset:128 nt
v_cvt_pk_bf16_f32 v249,v250,v251
v_cvt_pk_bf16_f32 v84,v84,v85
v_cvt_pk_bf16_f32 v216,v216,v217
v_cvt_pk_bf16_f32 v217,v218,v219
v_cvt_pk_bf16_f32 v85,v86,v87
v_cvt_pk_bf16_f32 v232,v232,v233
v_cvt_pk_bf16_f32 v229,v230,v231
v_cvt_pk_bf16_f32 v233,v234,v235
v_cvt_pk_bf16_f32 v220,v220,v221
ds_write2st64_b64 v38,v[248:249],v[120:121] offset0:16 offset1:24
v_cvt_pk_bf16_f32 v96,v96,v97
v_cvt_pk_bf16_f32 v221,v222,v223
v_cvt_pk_bf16_f32 v92,v92,v93
buffer_store_dwordx4 v[212:215],v9,s[16:19],s66 offen offset:3200 nt
v_cvt_pk_bf16_f32 v93,v94,v95
v_cvt_pk_bf16_f32 v237,v238,v239
v_cvt_pk_bf16_f32 v97,v98,v99
v_max3_f32 v44,v72,v73,v74
v_max_f32 v44,v44,v75
v_max3_f32 v48,v80,v81,v82
v_max_f32 v48,v48,v83
v_max3_f32 v52,v88,v89,v90
v_max_f32 v52,v52,v91
ds_write2st64_b64 v39,v[252:253],v[124:125] offset0:16 offset1:24
v_permlane32_swap_b32 v44,v48
v_max_f32 v44,v44,v48
v_mov_b32 v48,v44
v_cvt_pk_bf16_f32 v128,v128,v129
v_cvt_pk_bf16_f32 v129,v130,v131
v_permlane16_swap_b32 v48,v44
v_max_f32 v44,v44,v48
v_mul_f32_e64 v14,-s36,v44
v_mov_b32 v13,v14
ds_write2st64_b64 v32,v[228:229],v[216:217] offset0:36 offset1:40
v_cvt_pk_bf16_f32 v148,v148,v149
v_permlane32_swap_b32 v13,v14
v_fma_f32 v73,v73,s36,v13
v_fma_f32 v72,v72,s36,v13
v_exp_f32 v73,v73
v_fma_f32 v74,v74,s36,v13
v_exp_f32 v72,v72
v_fma_f32 v75,v75,s36,v13
ds_write2st64_b64 v33,v[232:233],v[220:221] offset0:36 offset1:40
v_exp_f32 v74,v74
v_exp_f32 v75,v75
v_cvt_pk_bf16_f32 v20,v72,v73
v_cvt_pk_bf16_f32 v21,v74,v75
v_fma_f32 v81,v81,s36,v14
v_fma_f32 v82,v82,s36,v14
v_fma_f32 v83,v83,s36,v14
v_exp_f32 v83,v83
ds_write2st64_b64 v34,v[236:237],v[84:85] offset0:36 offset1:40
v_exp_f32 v82,v82
v_fma_f32 v80,v80,s36,v14
v_exp_f32 v81,v81
v_exp_f32 v80,v80
v_cvt_pk_bf16_f32 v25,v82,v83
v_cvt_pk_bf16_f32 v24,v80,v81
v_cvt_pk_bf16_f32 v144,v144,v145
v_cvt_pk_bf16_f32 v145,v146,v147
ds_write2st64_b64 v35,v[92:93],v[96:97] offset0:36 offset1:40
s_waitcnt lgkmcnt(2)
v_mfma_f32_16x16x32_bf16 v[96:99],a[120:123],a[72:75],0
s_mov_b32 s42,s41
v_cvt_pk_bf16_f32 v149,v150,v151
ds_read_b128 v[100:103],v10 offset:18432
v_cvt_pk_bf16_f32 v132,v132,v133
ds_read_b128 v[208:211],v10 offset:19456
v_pk_mul_f32 v[138:139],v[138:139],v[64:65] op_sel_hi:[1,0]
ds_read_b128 v[224:227],v10 offset:20480
v_pk_mul_f32 v[152:153],v[152:153],v[64:65] op_sel_hi:[1,0]
ds_read_b128 v[240:243],v10 offset:21504
v_pk_mul_f32 v[154:155],v[154:155],v[64:65] op_sel_hi:[1,0]
ds_write2st64_b64 v36,v[128:129],v[144:145] offset0:26 offset1:28
v_pk_mul_f32 v[136:137],v[136:137],v[64:65] op_sel_hi:[1,0]
v_cvt_pk_bf16_f32 v152,v152,v153
v_cvt_pk_bf16_f32 v153,v154,v155
ds_read_b128 a[120:123],v0 offset:6272
v_mfma_f32_16x16x32_bf16 v[96:99],a[124:127],a[76:79],v[96:99]
s_add_u32 s69,s69,1
v_cvt_pk_bf16_f32 v133,v134,v135
v_cvt_pk_bf16_f32 v136,v136,v137
v_mfma_f32_16x16x32_bf16 v[96:99],a[128:131],a[80:83],v[96:99]
s_lshl_b32 s62,s69,5
ds_read_b128 a[124:127],v1 offset:6272
s_waitcnt lgkmcnt(5)
buffer_store_dwordx4 v[100:103],v9,s[16:19],s87 offen offset:256 nt
v_cvt_pk_bf16_f32 v137,v138,v139
s_add_u32 s62,s62,s34
s_mul_i32 s63,s62,171
v_mfma_f32_16x16x32_bf16 v[96:99],a[132:135],a[84:87],v[96:99]
s_lshr_b32 s63,s63,9
ds_read_b128 a[128:131],v0 offset:6400
s_mul_i32 s64,s63,3
ds_read_b128 a[132:135],v1 offset:6400
v_pk_mul_f32 v[142:143],v[142:143],v[64:65] op_sel_hi:[1,0]
ds_write2st64_b64 v37,v[132:133],v[148:149] offset0:26 offset1:28
v_pk_mul_f32 v[140:141],v[140:141],v[64:65] op_sel_hi:[1,0]
v_pk_mul_f32 v[156:157],v[156:157],v[64:65] op_sel_hi:[1,0]
v_pk_mul_f32 v[158:159],v[158:159],v[64:65] op_sel_hi:[1,0]
v_pk_mov_b32 v[64:65],0,0
v_cvt_pk_bf16_f32 v156,v156,v157
v_cvt_pk_bf16_f32 v157,v158,v159
v_mfma_f32_16x16x32_bf16 v[96:99],a[136:139],a[88:91],v[96:99]
s_sub_u32 s62,s62,s64
ds_read_b128 a[136:139],v0 offset:12288
buffer_store_dwordx4 v[208:211],v9,s[16:19],s87 offen offset:3328 nt
v_cvt_pk_bf16_f32 v140,v140,v141
v_cvt_pk_bf16_f32 v141,v142,v143
s_add_u32 s63,s63,s33
v_mfma_f32_16x16x32_bf16 v[96:99],a[140:143],a[92:95],v[96:99]
s_mul_i32 s30,s63,196608
ds_read_b128 a[140:143],v1 offset:12288
s_mul_i32 s41,s63,325632
v_mfma_f32_16x16x32_bf16 v[76:79],a[144:147],a[0:3],0
s_lshl_b32 s63,s3,2
ds_write2st64_b64 v38,v[136:137],v[152:153] offset0:26 offset1:28
v_pk_mul_f32 v[162:163],v[162:163],v[60:61] op_sel_hi:[1,0]
v_pk_mul_f32 v[160:161],v[160:161],v[60:61] op_sel_hi:[1,0]
v_pk_mul_f32 v[178:179],v[178:179],v[60:61] op_sel_hi:[1,0]
s_waitcnt lgkmcnt(3)
buffer_store_dwordx4 v[224:227],v9,s[16:19],s66 offen offset:256 nt
v_pk_mul_f32 v[176:177],v[176:177],v[60:61] op_sel_hi:[1,0]
v_max3_f32 v56,v96,v97,v98
v_max_f32 v56,v56,v99
v_mfma_f32_16x16x32_bf16 v[76:79],a[148:151],a[4:7],v[76:79]
s_add_u32 s64,s63,21
v_permlane32_swap_b32 v52,v56
v_mfma_f32_16x16x32_bf16 v[76:79],a[120:123],a[8:11],v[76:79]
s_cmp_eq_u32 s3,0
v_max_f32 v52,v52,v56
v_mov_b32 v56,v52
v_mfma_f32_16x16x32_bf16 v[76:79],a[124:127],a[12:15],v[76:79]
s_cselect_b32 s64,20,s64
ds_write2st64_b64 v39,v[140:141],v[156:157] offset0:26 offset1:28
v_mfma_f32_16x16x32_bf16 v[76:79],a[128:131],a[16:19],v[76:79]
s_cselect_b32 s40,1,0
v_permlane16_swap_b32 v56,v52
buffer_store_dwordx4 v[240:243],v9,s[16:19],s66 offen offset:3328 nt
v_pk_mul_f32 v[182:183],v[182:183],v[60:61] op_sel_hi:[1,0]
v_pk_mul_f32 v[180:181],v[180:181],v[60:61] op_sel_hi:[1,0]
v_pk_mul_f32 v[164:165],v[164:165],v[60:61] op_sel_hi:[1,0]
v_pk_mul_f32 v[166:167],v[166:167],v[60:61] op_sel_hi:[1,0]
v_max_f32 v52,v52,v56
v_mul_f32_e64 v16,-s36,v52
v_mfma_f32_16x16x32_bf16 v[76:79],a[132:135],a[20:23],v[76:79]
s_add_u32 s65,s63,37
v_mov_b32 v15,v16
v_cvt_pk_bf16_f32 v164,v164,v165
v_mfma_f32_16x16x32_bf16 v[84:87],a[132:135],a[44:47],0
s_cmp_eq_u32 s62,2
v_permlane32_swap_b32 v15,v16
v_mfma_f32_16x16x32_bf16 v[84:87],a[128:131],a[40:43],v[84:87]
s_cselect_b32 s64,s65,s64
v_fma_f32 v91,v91,s36,v15
v_exp_f32 v91,v91
v_fma_f32 v89,v89,s36,v15
v_fma_f32 v88,v88,s36,v15
v_pk_mul_f32 v[184:185],v[184:185],v[60:61] op_sel_hi:[1,0]
v_pk_mul_f32 v[186:187],v[186:187],v[60:61] op_sel_hi:[1,0]
v_pk_mul_f32 v[168:169],v[168:169],v[60:61] op_sel_hi:[1,0]
v_pk_mul_f32 v[170:171],v[170:171],v[60:61] op_sel_hi:[1,0]
v_fma_f32 v90,v90,s36,v15
v_exp_f32 v88,v88
v_mfma_f32_16x16x32_bf16 v[84:87],a[124:127],a[36:39],v[84:87]
s_cselect_b32 s40,0,s40
v_exp_f32 v89,v89
v_mfma_f32_16x16x32_bf16 v[84:87],a[120:123],a[32:35],v[84:87]
s_add_u32 s65,s63,s3
v_cvt_pk_bf16_f32 v28,v88,v89
v_exp_f32 v90,v90
v_mfma_f32_16x16x32_bf16 v[84:87],a[148:151],a[28:31],v[84:87]
s_cmp_eq_u32 s62,0
v_cvt_pk_bf16_f32 v29,v90,v91
v_fma_f32 v97,v97,s36,v16
v_fma_f32 v96,v96,s36,v16
v_exp_f32 v97,v97
v_pk_mul_f32 v[172:173],v[172:173],v[60:61] op_sel_hi:[1,0]
v_pk_mul_f32 v[174:175],v[174:175],v[60:61] op_sel_hi:[1,0]
v_pk_mul_f32 v[188:189],v[188:189],v[60:61] op_sel_hi:[1,0]
v_pk_mul_f32 v[190:191],v[190:191],v[60:61] op_sel_hi:[1,0]
v_fma_f32 v99,v99,s36,v16
v_fma_f32 v98,v98,s36,v16
v_mfma_f32_16x16x32_bf16 v[84:87],a[144:147],a[24:27],v[84:87]
s_cselect_b32 s64,s65,s64
v_exp_f32 v98,v98
v_mfma_f32_16x16x32_bf16 v[92:95],a[144:147],a[48:51],0
s_cselect_b32 s40,1,s40
v_exp_f32 v96,v96
v_mfma_f32_16x16x32_bf16 v[92:95],a[148:151],a[52:55],v[92:95]
s_mul_i32 s64,s64,6144
v_exp_f32 v99,v99
v_cvt_pk_bf16_f32 v32,v96,v97
v_cvt_pk_bf16_f32 v33,v98,v99
v_fma_f32 v77,v77,s36,v13
v_pk_mul_f32 v[192:193],v[192:193],v[60:61] op_sel_hi:[1,0]
v_pk_mul_f32 v[194:195],v[194:195],v[60:61] op_sel_hi:[1,0]
v_fma_f32 v78,v78,s36,v13
v_exp_f32 v77,v77
v_mfma_f32_16x16x32_bf16 v[92:95],a[120:123],a[56:59],v[92:95]
s_add_u32 s41,s41,s64
v_fma_f32 v79,v79,s36,v13
v_fma_f32 v76,v76,s36,v13
v_mfma_f32_16x16x32_bf16 v[92:95],a[124:127],a[60:63],v[92:95]
s_cmp_ge_u32 s69,6
v_exp_f32 v76,v76
v_mfma_f32_16x16x32_bf16 v[92:95],a[128:131],a[64:67],v[92:95]
s_cselect_b32 s41,166723584,s41
v_exp_f32 v79,v79
v_mfma_f32_16x16x32_bf16 v[92:95],a[132:135],a[68:71],v[92:95]
s_cselect_b32 s30,100663296,s30
v_exp_f32 v78,v78
v_cvt_pk_bf16_f32 v22,v76,v77
v_cvt_pk_bf16_f32 v23,v78,v79
v_cvt_pk_bf16_f32 v168,v168,v169
v_pk_mul_f32 v[196:197],v[196:197],v[60:61] op_sel_hi:[1,0]
v_pk_mul_f32 v[198:199],v[198:199],v[60:61] op_sel_hi:[1,0]
v_cvt_pk_bf16_f32 v160,v160,v161
v_cvt_pk_bf16_f32 v176,v176,v177
v_mfma_f32_16x16x32_bf16 v[100:103],a[132:135],a[92:95],0
s_add_u32 s25,s30,s22
ds_read_b128 a[132:135],v1 offset:18432
v_cvt_pk_bf16_f32 v177,v178,v179
v_mfma_f32_16x16x32_bf16 v[100:103],a[128:131],a[88:91],v[100:103]
s_add_u32 s26,s25,12288
ds_read_b128 a[128:131],v0 offset:18432
v_cvt_pk_bf16_f32 v169,v170,v171
v_mfma_f32_16x16x32_bf16 v[100:103],a[124:127],a[84:87],v[100:103]
s_add_u32 m0,s23,24576
ds_read_b128 a[124:127],v1 offset:12544
buffer_load_dwordx4 v6,s[8:11],s21 offen offset:0 lds
buffer_load_dwordx4 v7,s[8:11],s21 offen offset:1024 lds
buffer_load_dwordx4 v8,s[8:11],s21 offen offset:2048 lds
v_pk_mul_f32 v[202:203],v[202:203],v[60:61] op_sel_hi:[1,0]
v_pk_mul_f32 v[200:201],v[200:201],v[60:61] op_sel_hi:[1,0]
v_cvt_pk_bf16_f32 v180,v180,v181
v_cvt_pk_bf16_f32 v181,v182,v183
v_mfma_f32_16x16x32_bf16 v[100:103],a[120:123],a[80:83],v[100:103]
s_add_u32 s21,s21,12288
ds_read_b128 a[120:123],v0 offset:12544
v_cvt_pk_bf16_f32 v161,v162,v163
v_mfma_f32_16x16x32_bf16 v[100:103],a[148:151],a[76:79],v[100:103]
s_add_u32 m0,s22,0
ds_read_b128 a[148:151],v1 offset:12416
v_cvt_pk_bf16_f32 v165,v166,v167
v_mfma_f32_16x16x32_bf16 v[100:103],a[144:147],a[72:75],v[100:103]
s_mov_b32 s28,s41
ds_read_b128 a[144:147],v0 offset:12416
v_cvt_pk_bf16_f32 v172,v172,v173
ds_write2st64_b64 v36,v[160:161],v[176:177] offset0:0 offset1:2
v_pk_mul_f32 v[206:207],v[206:207],v[60:61] op_sel_hi:[1,0]
v_pk_mul_f32 v[204:205],v[204:205],v[60:61] op_sel_hi:[1,0]
v_pk_mov_b32 v[60:61],0,0
v_cvt_pk_bf16_f32 v188,v188,v189
v_cvt_pk_bf16_f32 v189,v190,v191
s_waitcnt lgkmcnt(4)
v_mfma_f32_16x16x32_bf16 v[72:75],a[124:127],a[20:23],0
s_mov_b32 s29,s24
v_cvt_pk_bf16_f32 v184,v184,v185
v_cvt_pk_bf16_f32 v173,v174,v175
v_cvt_pk_bf16_f32 v185,v186,v187
v_cvt_pk_bf16_f32 v192,v192,v193
v_cvt_pk_bf16_f32 v193,v194,v195
v_cvt_pk_bf16_f32 v196,v196,v197
s_waitcnt lgkmcnt(3)
v_mfma_f32_16x16x32_bf16 v[72:75],a[120:123],a[16:19],v[72:75]
s_waitcnt lgkmcnt(1)
ds_write2st64_b64 v37,v[164:165],v[180:181] offset0:0 offset1:2
v_mfma_f32_16x16x32_bf16 v[72:75],a[148:151],a[12:15],v[72:75]
v_fma_f32 v84,v84,s36,v14
v_fma_f32 v86,v86,s36,v14
v_mfma_f32_16x16x32_bf16 v[72:75],a[144:147],a[8:11],v[72:75]
v_exp_f32 v84,v84
v_mfma_f32_16x16x32_bf16 v[72:75],a[140:143],a[4:7],v[72:75]
v_fma_f32 v87,v87,s36,v14
v_fma_f32 v85,v85,s36,v14
v_mfma_f32_16x16x32_bf16 v[72:75],a[136:139],a[0:3],v[72:75]
ds_write2st64_b64 v38,v[168:169],v[184:185] offset0:0 offset1:2
v_mfma_f32_16x16x32_bf16 v[80:83],a[136:139],a[24:27],0
v_exp_f32 v85,v85
v_mfma_f32_16x16x32_bf16 v[80:83],a[140:143],a[28:31],v[80:83]
v_exp_f32 v86,v86
v_mfma_f32_16x16x32_bf16 v[80:83],a[144:147],a[32:35],v[80:83]
v_cvt_pk_bf16_f32 v26,v84,v85
v_exp_f32 v87,v87
v_mfma_f32_16x16x32_bf16 v[80:83],a[148:151],a[36:39],v[80:83]
ds_write2st64_b64 v39,v[172:173],v[188:189] offset0:0 offset1:2
v_mfma_f32_16x16x32_bf16 v[80:83],a[120:123],a[40:43],v[80:83]
v_cvt_pk_bf16_f32 v27,v86,v87
v_fma_f32 v93,v93,s36,v15
v_mfma_f32_16x16x32_bf16 v[80:83],a[124:127],a[44:47],v[80:83]
v_fma_f32 v95,v95,s36,v15
v_fma_f32 v92,v92,s36,v15
v_smfmac_f32_16x16x64_bf16 v[60:63],a[152:155],v[20:27],v18
v_exp_f32 v92,v92
v_mfma_f32_16x16x32_bf16 v[88:91],a[124:127],a[68:71],0
ds_write_b64 v36,v[192:193] offset:2048
v_mfma_f32_16x16x32_bf16 v[88:91],a[120:123],a[64:67],v[88:91]
v_exp_f32 v93,v93
v_mfma_f32_16x16x32_bf16 v[88:91],a[148:151],a[60:63],v[88:91]
v_exp_f32 v95,v95
v_mfma_f32_16x16x32_bf16 v[88:91],a[144:147],a[56:59],v[88:91]
v_fma_f32 v94,v94,s36,v15
v_exp_f32 v94,v94
v_mfma_f32_16x16x32_bf16 v[88:91],a[140:143],a[52:55],v[88:91]
v_cvt_pk_bf16_f32 v30,v92,v93
v_cvt_pk_bf16_f32 v31,v94,v95
v_mfma_f32_16x16x32_bf16 v[88:91],a[136:139],a[48:51],v[88:91]
v_fma_f32 v102,v102,s36,v16
v_fma_f32 v101,v101,s36,v16
v_mfma_f32_16x16x32_bf16 v[96:99],a[136:139],a[72:75],0
ds_read_b128 a[136:139],v0 offset:18560
v_fma_f32 v100,v100,s36,v16
v_mfma_f32_16x16x32_bf16 v[96:99],a[140:143],a[76:79],v[96:99]
ds_read_b128 a[140:143],v1 offset:18560
v_exp_f32 v100,v100
v_mfma_f32_16x16x32_bf16 v[96:99],a[144:147],a[80:83],v[96:99]
ds_read_b128 a[144:147],v0 offset:18688
v_fma_f32 v103,v103,s36,v16
v_mfma_f32_16x16x32_bf16 v[96:99],a[148:151],a[84:87],v[96:99]
ds_read_b128 a[148:151],v1 offset:18688
v_exp_f32 v101,v101
v_mfma_f32_16x16x32_bf16 v[96:99],a[120:123],a[88:91],v[96:99]
v_exp_f32 v102,v102
v_mfma_f32_16x16x32_bf16 v[96:99],a[124:127],a[92:95],v[96:99]
v_exp_f32 v103,v103
v_mfma_f32_16x16x32_bf16 v[76:79],a[128:131],a[0:3],0
v_cvt_pk_bf16_f32 v35,v102,v103
v_cvt_pk_bf16_f32 v34,v100,v101
v_mfma_f32_16x16x32_bf16 v[76:79],a[132:135],a[4:7],v[76:79]
v_fma_f32 v75,v75,s36,v13
v_fma_f32 v80,v80,s36,v14
v_smfmac_f32_16x16x64_bf16 v[64:67],a[152:155],v[28:35],v18
s_waitcnt lgkmcnt(2)
v_fma_f32 v73,v73,s36,v13
v_mfma_f32_16x16x32_bf16 v[76:79],a[136:139],a[8:11],v[76:79]
v_exp_f32 v73,v73
s_waitcnt vmcnt(11)
s_barrier
v_mfma_f32_16x16x32_bf16 v[76:79],a[140:143],a[12:15],v[76:79]
buffer_load_dwordx4 v6,s[4:7],s20 offen offset:0 lds
s_waitcnt lgkmcnt(0)
v_mfma_f32_16x16x32_bf16 v[76:79],a[144:147],a[16:19],v[76:79]
v_fma_f32 v81,v81,s36,v14
v_exp_f32 v81,v81
v_mfma_f32_16x16x32_bf16 v[76:79],a[148:151],a[20:23],v[76:79]
v_fma_f32 v74,v74,s36,v13
v_exp_f32 v74,v74
v_mfma_f32_16x16x32_bf16 v[84:87],a[148:151],a[44:47],0
v_fma_f32 v72,v72,s36,v13
v_exp_f32 v72,v72
v_mfma_f32_16x16x32_bf16 v[84:87],a[144:147],a[40:43],v[84:87]
v_exp_f32 v75,v75
v_mfma_f32_16x16x32_bf16 v[84:87],a[140:143],a[36:39],v[84:87]
buffer_load_dwordx4 v7,s[4:7],s20 offen offset:1024 lds
v_mfma_f32_16x16x32_bf16 v[84:87],a[136:139],a[32:35],v[84:87]
v_cvt_pk_bf16_f32 v204,v204,v205
v_exp_f32 v80,v80
v_mfma_f32_16x16x32_bf16 v[84:87],a[132:135],a[28:31],v[84:87]
v_cvt_pk_bf16_f32 v200,v200,v201
v_cvt_pk_bf16_f32 v197,v198,v199
v_mfma_f32_16x16x32_bf16 v[84:87],a[128:131],a[24:27],v[84:87]
ds_write_b64 v37,v[196:197] offset:2048
v_mfma_f32_16x16x32_bf16 v[92:95],a[128:131],a[48:51],0
ds_read_b64_tr_b16 a[122:123],v2 offset:6144
v_cvt_pk_bf16_f32 v201,v202,v203
v_mfma_f32_16x16x32_bf16 v[92:95],a[132:135],a[52:55],v[92:95]
buffer_load_dwordx4 v8,s[4:7],s20 offen offset:2048 lds
v_mfma_f32_16x16x32_bf16 v[92:95],a[136:139],a[56:59],v[92:95]
s_add_u32 s20,s20,12288
ds_write_b64 v38,v[200:201] offset:2048
v_mfma_f32_16x16x32_bf16 v[92:95],a[140:143],a[60:63],v[92:95]
ds_read_b64_tr_b16 a[120:121],v2 offset:0
v_cvt_pk_bf16_f32 v45,v74,v75
v_mfma_f32_16x16x32_bf16 v[92:95],a[144:147],a[64:67],v[92:95]
ds_read_b64_tr_b16 a[126:127],v3 offset:6144
v_cvt_pk_bf16_f32 v44,v72,v73
v_mfma_f32_16x16x32_bf16 v[92:95],a[148:151],a[68:71],v[92:95]
ds_read_b64_tr_b16 a[124:125],v3 offset:0
v_cvt_pk_bf16_f32 v48,v80,v81
v_mfma_f32_16x16x32_bf16 v[100:103],a[148:151],a[92:95],0
v_cvt_pk_bf16_f32 v205,v206,v207
v_mfma_f32_16x16x32_bf16 v[100:103],a[144:147],a[88:91],v[100:103]
ds_write_b64 v39,v[204:205] offset:2048
v_mfma_f32_16x16x32_bf16 v[100:103],a[140:143],a[84:87],v[100:103]
v_mfma_f32_16x16x32_bf16 v[100:103],a[136:139],a[80:83],v[100:103]
v_mfma_f32_16x16x32_bf16 v[100:103],a[132:135],a[76:79],v[100:103]
ds_read_b64_tr_b16 a[134:135],v5 offset:6144
v_mfma_f32_16x16x32_bf16 v[100:103],a[128:131],a[72:75],v[100:103]
s_waitcnt lgkmcnt(3)
ds_read_b64_tr_b16 a[130:131],v4 offset:6144
ds_read_b64_tr_b16 a[128:129],v4 offset:0
ds_read_b64_tr_b16 a[132:133],v5 offset:0
v_mfma_f32_16x16x32_bf16 v[160:163],a[120:123],v[20:23],0
s_add_u32 m0,s23,0
ds_read_b64_tr_b16 a[136:137],v2 offset:128
v_fma_f32 v82,v82,s36,v14
s_waitcnt lgkmcnt(6)
v_mfma_f32_16x16x32_bf16 v[164:167],a[124:127],v[20:23],0
ds_read_b64_tr_b16 a[138:139],v2 offset:6272
v_fma_f32 v83,v83,s36,v14
v_mfma_f32_16x16x32_bf16 v[212:215],a[124:127],v[24:27],0
ds_read_b64_tr_b16 a[140:141],v3 offset:128
v_fma_f32 v88,v88,s36,v15
v_mfma_f32_16x16x32_bf16 v[208:211],a[120:123],v[24:27],0
ds_read_b64_tr_b16 a[142:143],v3 offset:6272
v_fma_f32 v89,v89,s36,v15
v_mfma_f32_16x16x32_bf16 v[112:115],a[120:123],v[28:31],0
ds_read_b64_tr_b16 a[144:145],v4 offset:128
v_fma_f32 v90,v90,s36,v15
v_mfma_f32_16x16x32_bf16 v[116:119],a[124:127],v[28:31],0
ds_read_b64_tr_b16 a[146:147],v4 offset:6272
v_fma_f32 v91,v91,s36,v15
v_mfma_f32_16x16x32_bf16 a[164:167],a[124:127],v[32:35],0
ds_read_b64_tr_b16 a[148:149],v5 offset:128
v_fma_f32 v96,v96,s36,v16
v_mfma_f32_16x16x32_bf16 a[160:163],a[120:123],v[32:35],0
s_waitcnt lgkmcnt(6)
ds_read_b64_tr_b16 a[150:151],v5 offset:6272
v_fma_f32 v97,v97,s36,v16
v_mfma_f32_16x16x32_bf16 a[168:171],a[128:131],v[32:35],0
ds_read_b64_tr_b16 a[120:121],v2 offset:256
v_fma_f32 v98,v98,s36,v16
v_mfma_f32_16x16x32_bf16 a[172:175],a[132:135],v[32:35],0
ds_read_b64_tr_b16 a[122:123],v2 offset:6400
v_fma_f32 v99,v99,s36,v16
v_mfma_f32_16x16x32_bf16 v[124:127],a[132:135],v[28:31],0
ds_read_b64_tr_b16 a[124:125],v3 offset:256
v_fma_f32 v76,v76,s36,v13
v_mfma_f32_16x16x32_bf16 v[120:123],a[128:131],v[28:31],0
ds_read_b64_tr_b16 a[126:127],v3 offset:6400
v_fma_f32 v77,v77,s36,v13
v_mfma_f32_16x16x32_bf16 v[216:219],a[128:131],v[24:27],0
v_exp_f32 v82,v82
v_mfma_f32_16x16x32_bf16 v[220:223],a[132:135],v[24:27],0
v_exp_f32 v83,v83
v_mfma_f32_16x16x32_bf16 v[172:175],a[132:135],v[20:23],0
ds_read_b64_tr_b16 a[132:133],v5 offset:256
v_cvt_pk_bf16_f32 v49,v82,v83
v_mfma_f32_16x16x32_bf16 v[168:171],a[128:131],v[20:23],0
s_waitcnt lgkmcnt(4)
ds_read_b64_tr_b16 a[128:129],v4 offset:256
v_fma_f32 v78,v78,s36,v13
v_mfma_f32_16x16x32_bf16 v[176:179],a[136:139],v[20:23],0
ds_read_b64_tr_b16 a[130:131],v4 offset:6400
v_fma_f32 v79,v79,s36,v13
v_mfma_f32_16x16x32_bf16 v[180:183],a[140:143],v[20:23],0
ds_read_b64_tr_b16 a[134:135],v5 offset:6400
v_fma_f32 v84,v84,s36,v14
v_mfma_f32_16x16x32_bf16 v[228:231],a[140:143],v[24:27],0
v_exp_f32 v88,v88
v_mfma_f32_16x16x32_bf16 v[224:227],a[136:139],v[24:27],0
v_exp_f32 v89,v89
v_mfma_f32_16x16x32_bf16 v[128:131],a[136:139],v[28:31],0
v_exp_f32 v90,v90
v_mfma_f32_16x16x32_bf16 v[132:135],a[140:143],v[28:31],0
v_exp_f32 v91,v91
v_mfma_f32_16x16x32_bf16 a[180:183],a[140:143],v[32:35],0
v_cvt_pk_bf16_f32 v52,v88,v89
v_cvt_pk_bf16_f32 v53,v90,v91
v_mfma_f32_16x16x32_bf16 a[176:179],a[136:139],v[32:35],0
v_exp_f32 v96,v96
v_mfma_f32_16x16x32_bf16 a[184:187],a[144:147],v[32:35],0
v_exp_f32 v97,v97
v_mfma_f32_16x16x32_bf16 a[188:191],a[148:151],v[32:35],0
v_exp_f32 v98,v98
v_mfma_f32_16x16x32_bf16 v[140:143],a[148:151],v[28:31],0
v_exp_f32 v99,v99
v_mfma_f32_16x16x32_bf16 v[136:139],a[144:147],v[28:31],0
v_cvt_pk_bf16_f32 v56,v96,v97
v_cvt_pk_bf16_f32 v57,v98,v99
v_mfma_f32_16x16x32_bf16 v[232:235],a[144:147],v[24:27],0
v_exp_f32 v76,v76
v_mfma_f32_16x16x32_bf16 v[236:239],a[148:151],v[24:27],0
v_exp_f32 v77,v77
v_mfma_f32_16x16x32_bf16 v[188:191],a[148:151],v[20:23],0
v_exp_f32 v78,v78
v_mfma_f32_16x16x32_bf16 v[184:187],a[144:147],v[20:23],0
s_waitcnt lgkmcnt(0)
v_exp_f32 v79,v79
v_mfma_f32_16x16x32_bf16 v[192:195],a[120:123],v[20:23],0
s_waitcnt vmcnt(30)
v_cvt_pk_bf16_f32 v46,v76,v77
v_cvt_pk_bf16_f32 v47,v78,v79
v_mfma_f32_16x16x32_bf16 v[196:199],a[124:127],v[20:23],0
s_barrier
v_mfma_f32_16x16x32_bf16 v[244:247],a[124:127],v[24:27],0
ds_read_b128 a[148:151],v1 offset:24704
v_fma_f32 v85,v85,s36,v14
v_mfma_f32_16x16x32_bf16 v[240:243],a[120:123],v[24:27],0
ds_read_b128 a[144:147],v0 offset:24704
v_fma_f32 v86,v86,s36,v14
v_mfma_f32_16x16x32_bf16 v[144:147],a[120:123],v[28:31],0
ds_read_b128 a[140:143],v1 offset:24576
v_fma_f32 v87,v87,s36,v14
v_mfma_f32_16x16x32_bf16 v[148:151],a[124:127],v[28:31],0
ds_read_b128 a[136:139],v0 offset:24576
v_fma_f32 v92,v92,s36,v15
v_mfma_f32_16x16x32_bf16 a[196:199],a[124:127],v[32:35],0
ds_read_b128 a[124:127],v1 offset:24832
v_fma_f32 v93,v93,s36,v15
v_mfma_f32_16x16x32_bf16 a[192:195],a[120:123],v[32:35],0
buffer_load_dwordx4 v6,s[8:11],s21 offen offset:0 lds
v_mfma_f32_16x16x32_bf16 a[200:203],a[128:131],v[32:35],0
ds_read_b128 a[120:123],v0 offset:24832
v_fma_f32 v94,v94,s36,v15
v_mfma_f32_16x16x32_bf16 a[204:207],a[132:135],v[32:35],0
v_exp_f32 v84,v84
v_mfma_f32_16x16x32_bf16 v[156:159],a[132:135],v[28:31],0
v_exp_f32 v85,v85
v_mfma_f32_16x16x32_bf16 v[152:155],a[128:131],v[28:31],0
v_exp_f32 v86,v86
v_mfma_f32_16x16x32_bf16 v[248:251],a[128:131],v[24:27],0
v_exp_f32 v87,v87
v_mfma_f32_16x16x32_bf16 v[252:255],a[132:135],v[24:27],0
v_cvt_pk_bf16_f32 v50,v84,v85
v_cvt_pk_bf16_f32 v51,v86,v87
v_mfma_f32_16x16x32_bf16 v[204:207],a[132:135],v[20:23],0
ds_read_b128 a[132:135],v1 offset:30720
v_fma_f32 v95,v95,s36,v15
v_smfmac_f32_16x16x64_bf16 v[60:63],a[152:155],v[44:51],v18
v_fma_f32 v100,v100,s36,v16
v_mfma_f32_16x16x32_bf16 v[200:203],a[128:131],v[20:23],0
buffer_load_dwordx4 v7,s[8:11],s21 offen offset:1024 lds
s_waitcnt lgkmcnt(1)
v_mfma_f32_16x16x32_bf16 v[72:75],a[124:127],a[20:23],0
ds_read_b128 a[128:131],v0 offset:30720
v_fma_f32 v101,v101,s36,v16
v_mfma_f32_16x16x32_bf16 v[72:75],a[120:123],a[16:19],v[72:75]
v_exp_f32 v92,v92
v_mfma_f32_16x16x32_bf16 v[72:75],a[148:151],a[12:15],v[72:75]
v_exp_f32 v93,v93
v_mfma_f32_16x16x32_bf16 v[72:75],a[144:147],a[8:11],v[72:75]
v_exp_f32 v94,v94
v_mfma_f32_16x16x32_bf16 v[72:75],a[140:143],a[4:7],v[72:75]
v_exp_f32 v95,v95
v_mfma_f32_16x16x32_bf16 v[72:75],a[136:139],a[0:3],v[72:75]
v_cvt_pk_bf16_f32 v54,v92,v93
v_cvt_pk_bf16_f32 v55,v94,v95
v_mfma_f32_16x16x32_bf16 v[80:83],a[136:139],a[24:27],0
v_fma_f32 v102,v102,s36,v16
v_fma_f32 v103,v103,s36,v16
v_mfma_f32_16x16x32_bf16 v[80:83],a[140:143],a[28:31],v[80:83]
v_exp_f32 v100,v100
v_mfma_f32_16x16x32_bf16 v[80:83],a[144:147],a[32:35],v[80:83]
buffer_load_dwordx4 v8,s[8:11],s21 offen offset:2048 lds
v_mfma_f32_16x16x32_bf16 v[80:83],a[148:151],a[36:39],v[80:83]
s_add_u32 s21,s21,12288
v_exp_f32 v101,v101
v_mfma_f32_16x16x32_bf16 v[80:83],a[120:123],a[40:43],v[80:83]
s_add_u32 m0,s22,12288
v_exp_f32 v102,v102
v_mfma_f32_16x16x32_bf16 v[80:83],a[124:127],a[44:47],v[80:83]
v_exp_f32 v103,v103
v_mfma_f32_16x16x32_bf16 v[88:91],a[124:127],a[68:71],0
v_cvt_pk_bf16_f32 v58,v100,v101
v_cvt_pk_bf16_f32 v59,v102,v103
v_mfma_f32_16x16x32_bf16 v[88:91],a[120:123],a[64:67],v[88:91]
v_fma_f32 v72,v72,s36,v13
v_fma_f32 v73,v73,s36,v13
v_smfmac_f32_16x16x64_bf16 v[64:67],a[152:155],v[52:59],v18
v_fma_f32 v74,v74,s36,v13
v_mfma_f32_16x16x32_bf16 v[88:91],a[148:151],a[60:63],v[88:91]
v_fma_f32 v75,v75,s36,v13
v_fma_f32 v80,v80,s36,v14
v_mfma_f32_16x16x32_bf16 v[88:91],a[144:147],a[56:59],v[88:91]
v_fma_f32 v81,v81,s36,v14
v_mfma_f32_16x16x32_bf16 v[88:91],a[140:143],a[52:55],v[88:91]
buffer_load_dwordx4 v6,s[4:7],s20 offen offset:0 lds
v_mfma_f32_16x16x32_bf16 v[88:91],a[136:139],a[48:51],v[88:91]
v_exp_f32 v72,v72
v_mfma_f32_16x16x32_bf16 v[96:99],a[136:139],a[72:75],0
ds_read_b128 a[136:139],v0 offset:30848
v_mfma_f32_16x16x32_bf16 v[96:99],a[140:143],a[76:79],v[96:99]
ds_read_b128 a[140:143],v1 offset:30848
v_mfma_f32_16x16x32_bf16 v[96:99],a[144:147],a[80:83],v[96:99]
ds_read_b128 a[144:147],v0 offset:30976
v_mfma_f32_16x16x32_bf16 v[96:99],a[148:151],a[84:87],v[96:99]
ds_read_b128 a[148:151],v1 offset:30976
v_mfma_f32_16x16x32_bf16 v[96:99],a[120:123],a[88:91],v[96:99]
v_exp_f32 v73,v73
v_mfma_f32_16x16x32_bf16 v[96:99],a[124:127],a[92:95],v[96:99]
s_waitcnt lgkmcnt(4)
v_exp_f32 v74,v74
v_mfma_f32_16x16x32_bf16 v[76:79],a[128:131],a[0:3],0
v_exp_f32 v75,v75
v_mfma_f32_16x16x32_bf16 v[76:79],a[132:135],a[4:7],v[76:79]
buffer_load_dwordx4 v7,s[4:7],s20 offen offset:1024 lds
s_waitcnt lgkmcnt(3)
v_mfma_f32_16x16x32_bf16 v[76:79],a[136:139],a[8:11],v[76:79]
s_waitcnt lgkmcnt(2)
v_exp_f32 v80,v80
v_mfma_f32_16x16x32_bf16 v[76:79],a[140:143],a[12:15],v[76:79]
s_waitcnt lgkmcnt(0)
v_exp_f32 v81,v81
v_mfma_f32_16x16x32_bf16 v[76:79],a[144:147],a[16:19],v[76:79]
v_cvt_pk_bf16_f32 v20,v72,v73
v_cvt_pk_bf16_f32 v21,v74,v75
v_mfma_f32_16x16x32_bf16 v[76:79],a[148:151],a[20:23],v[76:79]
v_cvt_pk_bf16_f32 v24,v80,v81
v_mfma_f32_16x16x32_bf16 v[84:87],a[148:151],a[44:47],0
v_mfma_f32_16x16x32_bf16 v[84:87],a[144:147],a[40:43],v[84:87]
v_mfma_f32_16x16x32_bf16 v[84:87],a[140:143],a[36:39],v[84:87]
v_mfma_f32_16x16x32_bf16 v[84:87],a[136:139],a[32:35],v[84:87]
v_mfma_f32_16x16x32_bf16 v[84:87],a[132:135],a[28:31],v[84:87]
buffer_load_dwordx4 v8,s[4:7],s20 offen offset:2048 lds
v_mfma_f32_16x16x32_bf16 v[84:87],a[128:131],a[24:27],v[84:87]
s_add_u32 s20,s20,12288
v_mfma_f32_16x16x32_bf16 v[92:95],a[128:131],a[48:51],0
ds_read_b64_tr_b16 a[120:121],v2 offset:12288
v_mfma_f32_16x16x32_bf16 v[92:95],a[132:135],a[52:55],v[92:95]
ds_read_b64_tr_b16 a[122:123],v2 offset:18432
v_mfma_f32_16x16x32_bf16 v[92:95],a[136:139],a[56:59],v[92:95]
ds_read_b64_tr_b16 a[124:125],v3 offset:12288
v_mfma_f32_16x16x32_bf16 v[92:95],a[140:143],a[60:63],v[92:95]
ds_read_b64_tr_b16 a[126:127],v3 offset:18432
v_mfma_f32_16x16x32_bf16 v[92:95],a[144:147],a[64:67],v[92:95]
v_mfma_f32_16x16x32_bf16 v[92:95],a[148:151],a[68:71],v[92:95]
v_mfma_f32_16x16x32_bf16 v[100:103],a[148:151],a[92:95],0
v_mfma_f32_16x16x32_bf16 v[100:103],a[144:147],a[88:91],v[100:103]
v_mfma_f32_16x16x32_bf16 v[100:103],a[140:143],a[84:87],v[100:103]
v_mfma_f32_16x16x32_bf16 v[100:103],a[136:139],a[80:83],v[100:103]
v_mfma_f32_16x16x32_bf16 v[100:103],a[132:135],a[76:79],v[100:103]
ds_read_b64_tr_b16 a[132:133],v5 offset:12288
v_mfma_f32_16x16x32_bf16 v[100:103],a[128:131],a[72:75],v[100:103]
s_waitcnt lgkmcnt(1)
ds_read_b64_tr_b16 a[128:129],v4 offset:12288
ds_read_b64_tr_b16 a[130:131],v4 offset:18432
ds_read_b64_tr_b16 a[134:135],v5 offset:18432
v_mfma_f32_16x16x32_bf16 v[160:163],a[120:123],v[44:47],v[160:163]
s_add_u32 m0,s23,12288
ds_read_b64_tr_b16 a[136:137],v2 offset:12416
v_fma_f32 v82,v82,s36,v14
v_mfma_f32_16x16x32_bf16 v[164:167],a[124:127],v[44:47],v[164:167]
ds_read_b64_tr_b16 a[138:139],v2 offset:18560
v_fma_f32 v83,v83,s36,v14
v_mfma_f32_16x16x32_bf16 v[212:215],a[124:127],v[48:51],v[212:215]
ds_read_b64_tr_b16 a[140:141],v3 offset:12416
v_fma_f32 v88,v88,s36,v15
v_mfma_f32_16x16x32_bf16 v[208:211],a[120:123],v[48:51],v[208:211]
ds_read_b64_tr_b16 a[142:143],v3 offset:18560
v_fma_f32 v89,v89,s36,v15
v_mfma_f32_16x16x32_bf16 v[112:115],a[120:123],v[52:55],v[112:115]
ds_read_b64_tr_b16 a[144:145],v4 offset:12416
v_fma_f32 v90,v90,s36,v15
v_mfma_f32_16x16x32_bf16 v[116:119],a[124:127],v[52:55],v[116:119]
ds_read_b64_tr_b16 a[146:147],v4 offset:18560
v_fma_f32 v91,v91,s36,v15
v_mfma_f32_16x16x32_bf16 a[164:167],a[124:127],v[56:59],a[164:167]
ds_read_b64_tr_b16 a[148:149],v5 offset:12416
v_fma_f32 v96,v96,s36,v16
v_mfma_f32_16x16x32_bf16 a[160:163],a[120:123],v[56:59],a[160:163]
s_waitcnt lgkmcnt(6)
ds_read_b64_tr_b16 a[150:151],v5 offset:18560
v_fma_f32 v97,v97,s36,v16
v_mfma_f32_16x16x32_bf16 a[168:171],a[128:131],v[56:59],a[168:171]
ds_read_b64_tr_b16 a[120:121],v2 offset:12544
v_fma_f32 v98,v98,s36,v16
v_mfma_f32_16x16x32_bf16 a[172:175],a[132:135],v[56:59],a[172:175]
ds_read_b64_tr_b16 a[122:123],v2 offset:18688
v_fma_f32 v99,v99,s36,v16
v_mfma_f32_16x16x32_bf16 v[124:127],a[132:135],v[52:55],v[124:127]
ds_read_b64_tr_b16 a[124:125],v3 offset:12544
v_fma_f32 v76,v76,s36,v13
v_mfma_f32_16x16x32_bf16 v[120:123],a[128:131],v[52:55],v[120:123]
ds_read_b64_tr_b16 a[126:127],v3 offset:18688
v_fma_f32 v77,v77,s36,v13
v_mfma_f32_16x16x32_bf16 v[216:219],a[128:131],v[48:51],v[216:219]
v_exp_f32 v82,v82
v_mfma_f32_16x16x32_bf16 v[220:223],a[132:135],v[48:51],v[220:223]
v_exp_f32 v83,v83
v_mfma_f32_16x16x32_bf16 v[172:175],a[132:135],v[44:47],v[172:175]
ds_read_b64_tr_b16 a[132:133],v5 offset:12544
v_cvt_pk_bf16_f32 v25,v82,v83
v_mfma_f32_16x16x32_bf16 v[168:171],a[128:131],v[44:47],v[168:171]
s_waitcnt lgkmcnt(4)
ds_read_b64_tr_b16 a[128:129],v4 offset:12544
v_fma_f32 v78,v78,s36,v13
v_mfma_f32_16x16x32_bf16 v[176:179],a[136:139],v[44:47],v[176:179]
ds_read_b64_tr_b16 a[130:131],v4 offset:18688
v_fma_f32 v79,v79,s36,v13
v_mfma_f32_16x16x32_bf16 v[180:183],a[140:143],v[44:47],v[180:183]
ds_read_b64_tr_b16 a[134:135],v5 offset:18688
v_fma_f32 v84,v84,s36,v14
v_mfma_f32_16x16x32_bf16 v[228:231],a[140:143],v[48:51],v[228:231]
v_exp_f32 v88,v88
v_mfma_f32_16x16x32_bf16 v[224:227],a[136:139],v[48:51],v[224:227]
v_exp_f32 v89,v89
v_mfma_f32_16x16x32_bf16 v[128:131],a[136:139],v[52:55],v[128:131]
v_exp_f32 v90,v90
v_mfma_f32_16x16x32_bf16 v[132:135],a[140:143],v[52:55],v[132:135]
v_exp_f32 v91,v91
v_mfma_f32_16x16x32_bf16 a[180:183],a[140:143],v[56:59],a[180:183]
v_cvt_pk_bf16_f32 v28,v88,v89
v_cvt_pk_bf16_f32 v29,v90,v91
v_mfma_f32_16x16x32_bf16 a[176:179],a[136:139],v[56:59],a[176:179]
v_exp_f32 v96,v96
v_mfma_f32_16x16x32_bf16 a[184:187],a[144:147],v[56:59],a[184:187]
v_exp_f32 v97,v97
v_mfma_f32_16x16x32_bf16 a[188:191],a[148:151],v[56:59],a[188:191]
v_exp_f32 v98,v98
v_mfma_f32_16x16x32_bf16 v[140:143],a[148:151],v[52:55],v[140:143]
v_exp_f32 v99,v99
v_mfma_f32_16x16x32_bf16 v[136:139],a[144:147],v[52:55],v[136:139]
v_cvt_pk_bf16_f32 v32,v96,v97
v_cvt_pk_bf16_f32 v33,v98,v99
v_mfma_f32_16x16x32_bf16 v[232:235],a[144:147],v[48:51],v[232:235]
v_exp_f32 v76,v76
v_mfma_f32_16x16x32_bf16 v[236:239],a[148:151],v[48:51],v[236:239]
v_exp_f32 v77,v77
v_mfma_f32_16x16x32_bf16 v[188:191],a[148:151],v[44:47],v[188:191]
v_exp_f32 v78,v78
v_mfma_f32_16x16x32_bf16 v[184:187],a[144:147],v[44:47],v[184:187]
s_waitcnt lgkmcnt(0)
v_exp_f32 v79,v79
v_mfma_f32_16x16x32_bf16 v[192:195],a[120:123],v[44:47],v[192:195]
s_waitcnt vmcnt(6)
v_cvt_pk_bf16_f32 v22,v76,v77
v_cvt_pk_bf16_f32 v23,v78,v79
v_mfma_f32_16x16x32_bf16 v[196:199],a[124:127],v[44:47],v[196:199]
s_barrier
v_mfma_f32_16x16x32_bf16 v[244:247],a[124:127],v[48:51],v[244:247]
ds_read_b128 a[148:151],v1 offset:128
v_fma_f32 v85,v85,s36,v14
v_mfma_f32_16x16x32_bf16 v[240:243],a[120:123],v[48:51],v[240:243]
ds_read_b128 a[144:147],v0 offset:128
v_fma_f32 v86,v86,s36,v14
v_mfma_f32_16x16x32_bf16 v[144:147],a[120:123],v[52:55],v[144:147]
ds_read_b128 a[140:143],v1 offset:0
v_fma_f32 v87,v87,s36,v14
v_mfma_f32_16x16x32_bf16 v[148:151],a[124:127],v[52:55],v[148:151]
ds_read_b128 a[136:139],v0 offset:0
v_fma_f32 v92,v92,s36,v15
v_mfma_f32_16x16x32_bf16 a[196:199],a[124:127],v[56:59],a[196:199]
ds_read_b128 a[124:127],v1 offset:256
v_fma_f32 v93,v93,s36,v15
v_mfma_f32_16x16x32_bf16 a[192:195],a[120:123],v[56:59],a[192:195]
buffer_load_dwordx4 v6,s[8:11],s21 offen offset:0 lds
v_mfma_f32_16x16x32_bf16 a[200:203],a[128:131],v[56:59],a[200:203]
ds_read_b128 a[120:123],v0 offset:256
v_fma_f32 v94,v94,s36,v15
v_mfma_f32_16x16x32_bf16 a[204:207],a[132:135],v[56:59],a[204:207]
v_exp_f32 v84,v84
v_mfma_f32_16x16x32_bf16 v[156:159],a[132:135],v[52:55],v[156:159]
v_exp_f32 v85,v85
v_mfma_f32_16x16x32_bf16 v[152:155],a[128:131],v[52:55],v[152:155]
v_exp_f32 v86,v86
v_mfma_f32_16x16x32_bf16 v[248:251],a[128:131],v[48:51],v[248:251]
v_exp_f32 v87,v87
v_mfma_f32_16x16x32_bf16 v[252:255],a[132:135],v[48:51],v[252:255]
v_cvt_pk_bf16_f32 v26,v84,v85
v_cvt_pk_bf16_f32 v27,v86,v87
v_mfma_f32_16x16x32_bf16 v[204:207],a[132:135],v[44:47],v[204:207]
ds_read_b128 a[132:135],v1 offset:6144
v_fma_f32 v95,v95,s36,v15
v_smfmac_f32_16x16x64_bf16 v[60:63],a[152:155],v[20:27],v18
v_fma_f32 v100,v100,s36,v16
v_mfma_f32_16x16x32_bf16 v[200:203],a[128:131],v[44:47],v[200:203]
buffer_load_dwordx4 v7,s[8:11],s21 offen offset:1024 lds
s_waitcnt lgkmcnt(1)
v_mfma_f32_16x16x32_bf16 v[72:75],a[124:127],a[20:23],0
ds_read_b128 a[128:131],v0 offset:6144
v_fma_f32 v101,v101,s36,v16
v_mfma_f32_16x16x32_bf16 v[72:75],a[120:123],a[16:19],v[72:75]
v_exp_f32 v92,v92
v_mfma_f32_16x16x32_bf16 v[72:75],a[148:151],a[12:15],v[72:75]
v_exp_f32 v93,v93
v_mfma_f32_16x16x32_bf16 v[72:75],a[144:147],a[8:11],v[72:75]
v_exp_f32 v94,v94
v_mfma_f32_16x16x32_bf16 v[72:75],a[140:143],a[4:7],v[72:75]
v_exp_f32 v95,v95
v_mfma_f32_16x16x32_bf16 v[72:75],a[136:139],a[0:3],v[72:75]
v_cvt_pk_bf16_f32 v30,v92,v93
v_cvt_pk_bf16_f32 v31,v94,v95
v_mfma_f32_16x16x32_bf16 v[80:83],a[136:139],a[24:27],0
v_fma_f32 v102,v102,s36,v16
v_fma_f32 v103,v103,s36,v16
v_mfma_f32_16x16x32_bf16 v[80:83],a[140:143],a[28:31],v[80:83]
v_exp_f32 v100,v100
v_mfma_f32_16x16x32_bf16 v[80:83],a[144:147],a[32:35],v[80:83]
buffer_load_dwordx4 v8,s[8:11],s21 offen offset:2048 lds
v_mfma_f32_16x16x32_bf16 v[80:83],a[148:151],a[36:39],v[80:83]
s_add_u32 s21,s21,12288
v_exp_f32 v101,v101
v_mfma_f32_16x16x32_bf16 v[80:83],a[120:123],a[40:43],v[80:83]
s_add_u32 m0,s22,24576
v_exp_f32 v102,v102
v_mfma_f32_16x16x32_bf16 v[80:83],a[124:127],a[44:47],v[80:83]
v_exp_f32 v103,v103
v_mfma_f32_16x16x32_bf16 v[88:91],a[124:127],a[68:71],0
v_cvt_pk_bf16_f32 v34,v100,v101
v_cvt_pk_bf16_f32 v35,v102,v103
v_mfma_f32_16x16x32_bf16 v[88:91],a[120:123],a[64:67],v[88:91]
v_fma_f32 v72,v72,s36,v13
v_fma_f32 v73,v73,s36,v13
v_smfmac_f32_16x16x64_bf16 v[64:67],a[152:155],v[28:35],v18
v_fma_f32 v74,v74,s36,v13
v_mfma_f32_16x16x32_bf16 v[88:91],a[148:151],a[60:63],v[88:91]
v_fma_f32 v75,v75,s36,v13
v_fma_f32 v80,v80,s36,v14
v_mfma_f32_16x16x32_bf16 v[88:91],a[144:147],a[56:59],v[88:91]
v_fma_f32 v81,v81,s36,v14
v_mfma_f32_16x16x32_bf16 v[88:91],a[140:143],a[52:55],v[88:91]
buffer_load_dwordx4 v6,s[4:7],s20 offen offset:0 lds
v_mfma_f32_16x16x32_bf16 v[88:91],a[136:139],a[48:51],v[88:91]
v_exp_f32 v72,v72
v_mfma_f32_16x16x32_bf16 v[96:99],a[136:139],a[72:75],0
ds_read_b128 a[136:139],v0 offset:6272
v_mfma_f32_16x16x32_bf16 v[96:99],a[140:143],a[76:79],v[96:99]
ds_read_b128 a[140:143],v1 offset:6272
v_mfma_f32_16x16x32_bf16 v[96:99],a[144:147],a[80:83],v[96:99]
ds_read_b128 a[144:147],v0 offset:6400
v_mfma_f32_16x16x32_bf16 v[96:99],a[148:151],a[84:87],v[96:99]
ds_read_b128 a[148:151],v1 offset:6400
v_mfma_f32_16x16x32_bf16 v[96:99],a[120:123],a[88:91],v[96:99]
v_exp_f32 v73,v73
v_mfma_f32_16x16x32_bf16 v[96:99],a[124:127],a[92:95],v[96:99]
s_waitcnt lgkmcnt(4)
v_exp_f32 v74,v74
v_mfma_f32_16x16x32_bf16 v[76:79],a[128:131],a[0:3],0
v_exp_f32 v75,v75
v_mfma_f32_16x16x32_bf16 v[76:79],a[132:135],a[4:7],v[76:79]
buffer_load_dwordx4 v7,s[4:7],s20 offen offset:1024 lds
s_waitcnt lgkmcnt(3)
v_mfma_f32_16x16x32_bf16 v[76:79],a[136:139],a[8:11],v[76:79]
s_waitcnt lgkmcnt(2)
v_exp_f32 v80,v80
v_mfma_f32_16x16x32_bf16 v[76:79],a[140:143],a[12:15],v[76:79]
s_waitcnt lgkmcnt(0)
v_exp_f32 v81,v81
v_mfma_f32_16x16x32_bf16 v[76:79],a[144:147],a[16:19],v[76:79]
v_cvt_pk_bf16_f32 v44,v72,v73
v_cvt_pk_bf16_f32 v45,v74,v75
v_mfma_f32_16x16x32_bf16 v[76:79],a[148:151],a[20:23],v[76:79]
v_cvt_pk_bf16_f32 v48,v80,v81
v_mfma_f32_16x16x32_bf16 v[84:87],a[148:151],a[44:47],0
v_mfma_f32_16x16x32_bf16 v[84:87],a[144:147],a[40:43],v[84:87]
v_mfma_f32_16x16x32_bf16 v[84:87],a[140:143],a[36:39],v[84:87]
v_mfma_f32_16x16x32_bf16 v[84:87],a[136:139],a[32:35],v[84:87]
v_mfma_f32_16x16x32_bf16 v[84:87],a[132:135],a[28:31],v[84:87]
buffer_load_dwordx4 v8,s[4:7],s20 offen offset:2048 lds
v_mfma_f32_16x16x32_bf16 v[84:87],a[128:131],a[24:27],v[84:87]
s_add_u32 s20,s20,12288
v_mfma_f32_16x16x32_bf16 v[92:95],a[128:131],a[48:51],0
ds_read_b64_tr_b16 a[120:121],v2 offset:24576
v_mfma_f32_16x16x32_bf16 v[92:95],a[132:135],a[52:55],v[92:95]
ds_read_b64_tr_b16 a[122:123],v2 offset:30720
v_mfma_f32_16x16x32_bf16 v[92:95],a[136:139],a[56:59],v[92:95]
ds_read_b64_tr_b16 a[124:125],v3 offset:24576
v_mfma_f32_16x16x32_bf16 v[92:95],a[140:143],a[60:63],v[92:95]
ds_read_b64_tr_b16 a[126:127],v3 offset:30720
v_mfma_f32_16x16x32_bf16 v[92:95],a[144:147],a[64:67],v[92:95]
v_mfma_f32_16x16x32_bf16 v[92:95],a[148:151],a[68:71],v[92:95]
v_mfma_f32_16x16x32_bf16 v[100:103],a[148:151],a[92:95],0
v_mfma_f32_16x16x32_bf16 v[100:103],a[144:147],a[88:91],v[100:103]
v_mfma_f32_16x16x32_bf16 v[100:103],a[140:143],a[84:87],v[100:103]
v_mfma_f32_16x16x32_bf16 v[100:103],a[136:139],a[80:83],v[100:103]
v_mfma_f32_16x16x32_bf16 v[100:103],a[132:135],a[76:79],v[100:103]
ds_read_b64_tr_b16 a[132:133],v5 offset:24576
v_mfma_f32_16x16x32_bf16 v[100:103],a[128:131],a[72:75],v[100:103]
ds_read_b64_tr_b16 a[128:129],v4 offset:24576
ds_read_b64_tr_b16 a[130:131],v4 offset:30720
ds_read_b64_tr_b16 a[134:135],v5 offset:30720
s_mov_b32 s38,0
s_branch L_loop4
L_tr55:
s_waitcnt vmcnt(43)
s_waitcnt lgkmcnt(3)
v_mfma_f32_16x16x32_bf16 v[160:163],a[120:123],v[20:23],v[160:163]
s_add_u32 m0,s24,0
ds_read_b128 a[12:15],v12 offset:128
v_fma_f32 v101,v101,s36,v16
v_mfma_f32_16x16x32_bf16 v[164:167],a[124:127],v[20:23],v[164:167]
ds_read_b128 a[20:23],v12 offset:256
v_fma_f32 v103,v103,s36,v16
v_mfma_f32_16x16x32_bf16 v[212:215],a[124:127],v[24:27],v[212:215]
ds_read_b128 a[4:7],v12 offset:0
v_fma_f32 v87,v87,s36,v14
v_mfma_f32_16x16x32_bf16 v[208:211],a[120:123],v[24:27],v[208:211]
ds_read_b128 a[16:19],v11 offset:256
v_fma_f32 v106,v106,s36,v17
v_mfma_f32_16x16x32_bf16 v[112:115],a[120:123],v[28:31],v[112:115]
ds_read_b128 a[0:3],v11 offset:0
v_fma_f32 v99,v99,s36,v16
v_mfma_f32_16x16x32_bf16 v[116:119],a[124:127],v[28:31],v[116:119]
ds_read_b128 a[8:11],v11 offset:128
v_fma_f32 v96,v96,s36,v16
v_mfma_f32_16x16x32_bf16 a[164:167],a[124:127],v[32:35],a[164:167]
ds_read_b64_tr_b16 a[136:137],v2 offset:24704
v_fma_f32 v77,v77,s36,v13
v_mfma_f32_16x16x32_bf16 a[160:163],a[120:123],v[32:35],a[160:163]
ds_read_b64_tr_b16 a[138:139],v2 offset:30848
v_fma_f32 v85,v85,s36,v14
v_mfma_f32_16x16x32_bf16 a[208:211],a[120:123],v[36:39],a[208:211]
ds_read_b64_tr_b16 a[140:141],v3 offset:24704
ds_read_b64_tr_b16 a[142:143],v3 offset:30848
ds_read_b64_tr_b16 a[144:145],v4 offset:24704
ds_read_b64_tr_b16 a[146:147],v4 offset:30848
ds_read_b64_tr_b16 a[150:151],v5 offset:30848
ds_read_b64_tr_b16 a[148:149],v5 offset:24704
ds_read_b128 a[40:43],v11 offset:6400
v_mfma_f32_16x16x32_bf16 a[212:215],a[124:127],v[36:39],a[212:215]
s_waitcnt lgkmcnt(11)
v_fma_f32 v84,v84,s36,v14
ds_read_b128 a[32:35],v11 offset:6272
v_mfma_f32_16x16x32_bf16 a[216:219],a[128:131],v[36:39],a[216:219]
s_waitcnt lgkmcnt(10)
buffer_load_dwordx4 v6,s[12:15],s28 offen offset:0 nt lds
v_mfma_f32_16x16x32_bf16 a[220:223],a[132:135],v[36:39],a[220:223]
ds_read_b64_tr_b16 a[122:123],v2 offset:30976
ds_read_b128 a[44:47],v12 offset:6400
v_mfma_f32_16x16x32_bf16 a[172:175],a[132:135],v[32:35],a[172:175]
v_exp_f32 v101,v101
ds_read_b64_tr_b16 a[120:121],v2 offset:24832
ds_read_b128 a[24:27],v11 offset:6144
v_mfma_f32_16x16x32_bf16 a[168:171],a[128:131],v[32:35],a[168:171]
v_exp_f32 v77,v77
ds_read_b128 a[28:31],v12 offset:6144
v_mfma_f32_16x16x32_bf16 v[120:123],a[128:131],v[28:31],v[120:123]
v_fma_f32 v111,v111,s36,v17
ds_read_b64_tr_b16 a[126:127],v3 offset:30976
ds_read_b64_tr_b16 a[124:125],v3 offset:24832
ds_read_b128 a[36:39],v12 offset:6272
v_mfma_f32_16x16x32_bf16 v[124:127],a[132:135],v[28:31],v[124:127]
buffer_load_dwordx4 v7,s[12:15],s28 offen offset:1024 nt lds
v_mfma_f32_16x16x32_bf16 v[220:223],a[132:135],v[24:27],v[220:223]
v_fma_f32 v95,v95,s36,v15
v_fma_f32 v100,v100,s36,v16
v_mfma_f32_16x16x32_bf16 v[216:219],a[128:131],v[24:27],v[216:219]
v_exp_f32 v106,v106
v_mfma_f32_16x16x32_bf16 v[168:171],a[128:131],v[20:23],v[168:171]
ds_read_b64_tr_b16 a[130:131],v4 offset:30976
v_fma_f32 v93,v93,s36,v15
v_mfma_f32_16x16x32_bf16 v[172:175],a[132:135],v[20:23],v[172:175]
s_waitcnt lgkmcnt(4)
ds_read_b64_tr_b16 a[128:129],v4 offset:24832
v_exp_f32 v111,v111
v_mfma_f32_16x16x32_bf16 v[176:179],a[136:139],v[20:23],v[176:179]
ds_read_b64_tr_b16 a[132:133],v5 offset:24832
buffer_load_dwordx4 v8,s[12:15],s28 offen offset:2048 nt lds
v_mfma_f32_16x16x32_bf16 v[180:183],a[140:143],v[20:23],v[180:183]
s_add_u32 s28,s28,3072
ds_read_b64_tr_b16 a[134:135],v5 offset:30976
v_fma_f32 v107,v107,s36,v17
v_mfma_f32_16x16x32_bf16 v[228:231],a[140:143],v[24:27],v[228:231]
s_add_u32 m0,s24,3072
v_fma_f32 v92,v92,s36,v15
v_exp_f32 v92,v92
v_mfma_f32_16x16x32_bf16 v[224:227],a[136:139],v[24:27],v[224:227]
v_fma_f32 v109,v109,s36,v17
v_exp_f32 v109,v109
v_mfma_f32_16x16x32_bf16 v[128:131],a[136:139],v[28:31],v[128:131]
v_fma_f32 v97,v97,s36,v16
v_exp_f32 v84,v84
v_mfma_f32_16x16x32_bf16 v[132:135],a[140:143],v[28:31],v[132:135]
v_fma_f32 v94,v94,s36,v15
v_exp_f32 v94,v94
v_mfma_f32_16x16x32_bf16 a[180:183],a[140:143],v[32:35],a[180:183]
v_fma_f32 v104,v104,s36,v17
v_fma_f32 v90,v90,s36,v15
v_mfma_f32_16x16x32_bf16 a[176:179],a[136:139],v[32:35],a[176:179]
buffer_load_dwordx4 v6,s[12:15],s28 offen offset:0 nt lds
v_mfma_f32_16x16x32_bf16 a[224:227],a[136:139],v[36:39],a[224:227]
v_exp_f32 v93,v93
v_mfma_f32_16x16x32_bf16 a[228:231],a[140:143],v[36:39],a[228:231]
v_exp_f32 v104,v104
v_mfma_f32_16x16x32_bf16 a[232:235],a[144:147],v[36:39],a[232:235]
v_exp_f32 v96,v96
v_mfma_f32_16x16x32_bf16 a[236:239],a[148:151],v[36:39],a[236:239]
v_fma_f32 v78,v78,s36,v13
v_exp_f32 v78,v78
v_mfma_f32_16x16x32_bf16 a[188:191],a[148:151],v[32:35],a[188:191]
v_fma_f32 v110,v110,s36,v17
v_exp_f32 v110,v110
v_mfma_f32_16x16x32_bf16 a[184:187],a[144:147],v[32:35],a[184:187]
v_exp_f32 v97,v97
v_mfma_f32_16x16x32_bf16 v[136:139],a[144:147],v[28:31],v[136:139]
v_exp_f32 v100,v100
v_mfma_f32_16x16x32_bf16 v[140:143],a[148:151],v[28:31],v[140:143]
buffer_load_dwordx4 v7,s[12:15],s28 offen offset:1024 nt lds
v_mfma_f32_16x16x32_bf16 v[236:239],a[148:151],v[24:27],v[236:239]
v_fma_f32 v102,v102,s36,v16
v_exp_f32 v102,v102
v_mfma_f32_16x16x32_bf16 v[232:235],a[144:147],v[24:27],v[232:235]
v_fma_f32 v79,v79,s36,v13
v_exp_f32 v79,v79
v_mfma_f32_16x16x32_bf16 v[184:187],a[144:147],v[20:23],v[184:187]
v_exp_f32 v85,v85
v_mfma_f32_16x16x32_bf16 v[188:191],a[148:151],v[20:23],v[188:191]
v_fma_f32 v108,v108,s36,v17
v_exp_f32 v108,v108
v_mfma_f32_16x16x32_bf16 v[192:195],a[120:123],v[20:23],v[192:195]
s_waitcnt lgkmcnt(0)
v_fma_f32 v98,v98,s36,v16
v_exp_f32 v87,v87
v_mfma_f32_16x16x32_bf16 v[196:199],a[124:127],v[20:23],v[196:199]
v_fma_f32 v76,v76,s36,v13
v_exp_f32 v76,v76
v_mfma_f32_16x16x32_bf16 v[244:247],a[124:127],v[24:27],v[244:247]
buffer_load_dwordx4 v8,s[12:15],s28 offen offset:2048 nt lds
s_waitcnt vmcnt(18)
s_barrier
v_mfma_f32_16x16x32_bf16 v[240:243],a[120:123],v[24:27],v[240:243]
s_add_u32 s28,s28,3072
v_fma_f32 v105,v105,s36,v17
v_exp_f32 v107,v107
v_mfma_f32_16x16x32_bf16 v[144:147],a[120:123],v[28:31],v[144:147]
s_add_u32 m0,s22,0
v_fma_f32 v91,v91,s36,v15
v_exp_f32 v91,v91
v_mfma_f32_16x16x32_bf16 v[148:151],a[124:127],v[28:31],v[148:151]
buffer_load_dwordx4 v6,s[4:7],s25 offen offset:0 lds
v_mfma_f32_16x16x32_bf16 a[196:199],a[124:127],v[32:35],a[196:199]
buffer_load_dwordx4 v7,s[4:7],s25 offen offset:1024 lds
v_mfma_f32_16x16x32_bf16 a[192:195],a[120:123],v[32:35],a[192:195]
buffer_load_dwordx4 v8,s[4:7],s25 offen offset:2048 lds
v_mfma_f32_16x16x32_bf16 a[240:243],a[120:123],v[36:39],a[240:243]
v_fma_f32 v86,v86,s36,v14
v_exp_f32 v86,v86
v_mfma_f32_16x16x32_bf16 a[244:247],a[124:127],v[36:39],a[244:247]
v_exp_f32 v95,v95
v_mfma_f32_16x16x32_bf16 a[248:251],a[128:131],v[36:39],a[248:251]
v_exp_f32 v103,v103
v_mfma_f32_16x16x32_bf16 a[252:255],a[132:135],v[36:39],a[252:255]
ds_read_b64_tr_b16 a[136:137],v2 offset:0
v_cvt_pk_bf16_f32 v41,v106,v107
v_mfma_f32_16x16x32_bf16 a[204:207],a[132:135],v[32:35],a[204:207]
ds_read_b64_tr_b16 a[138:139],v2 offset:6144
v_exp_f32 v99,v99
v_mfma_f32_16x16x32_bf16 a[200:203],a[128:131],v[32:35],a[200:203]
ds_read_b64_tr_b16 a[140:141],v3 offset:0
v_cvt_pk_bf16_f32 v42,v108,v109
v_mfma_f32_16x16x32_bf16 v[152:155],a[128:131],v[28:31],v[152:155]
ds_read_b64_tr_b16 a[142:143],v3 offset:6144
v_cvt_pk_bf16_f32 v50,v84,v85
v_mfma_f32_16x16x32_bf16 v[156:159],a[132:135],v[28:31],v[156:159]
ds_read_b64_tr_b16 a[144:145],v4 offset:0
v_exp_f32 v90,v90
v_mfma_f32_16x16x32_bf16 v[252:255],a[132:135],v[24:27],v[252:255]
ds_read_b64_tr_b16 a[146:147],v4 offset:6144
v_exp_f32 v105,v105
v_mfma_f32_16x16x32_bf16 v[248:251],a[128:131],v[24:27],v[248:251]
ds_read_b64_tr_b16 a[148:149],v5 offset:0
v_cvt_pk_bf16_f32 v55,v94,v95
v_mfma_f32_16x16x32_bf16 v[200:203],a[128:131],v[20:23],v[200:203]
ds_read_b64_tr_b16 a[150:151],v5 offset:6144
v_cvt_pk_bf16_f32 v51,v86,v87
v_mfma_f32_16x16x32_bf16 v[204:207],a[132:135],v[20:23],v[204:207]
v_cvt_pk_bf16_f32 v59,v102,v103
v_exp_f32 v98,v98
v_cvt_pk_bf16_f32 v54,v92,v93
v_cvt_pk_bf16_f32 v56,v96,v97
v_cvt_pk_bf16_f32 v53,v90,v91
v_cvt_pk_bf16_f32 v47,v78,v79
v_cvt_pk_bf16_f32 v43,v110,v111
v_cvt_pk_bf16_f32 v58,v100,v101
v_cvt_pk_bf16_f32 v46,v76,v77
v_cvt_pk_bf16_f32 v57,v98,v99
v_cvt_pk_bf16_f32 v40,v104,v105
v_smfmac_f32_16x16x64_bf16 v[60:63],a[152:155],v[44:51],v18
v_subrev_u32 v10,18432,v10
v_smfmac_f32_16x16x64_bf16 v[64:67],a[152:155],v[52:59],v18
v_smfmac_f32_16x16x64_bf16 v[68:71],a[152:155],v[36:43],v18
s_waitcnt lgkmcnt(1)
v_mfma_f32_16x16x32_bf16 v[160:163],a[136:139],v[44:47],v[160:163]
s_add_u32 s87,s42,18432
ds_read_b64_tr_b16 a[122:123],v2 offset:6272
v_mbcnt_lo_u32_b32 v35,-1,0
v_mfma_f32_16x16x32_bf16 v[164:167],a[140:143],v[44:47],v[164:167]
s_add_u32 s66,s42,24576
ds_read_b64_tr_b16 a[120:121],v2 offset:128
v_mbcnt_hi_u32_b32 v35,-1,v35
v_mfma_f32_16x16x32_bf16 v[212:215],a[140:143],v[48:51],v[212:215]
ds_read_b64_tr_b16 a[124:125],v3 offset:128
v_and_b32 v34,7,v35
v_mfma_f32_16x16x32_bf16 v[208:211],a[136:139],v[48:51],v[208:211]
ds_read_b64_tr_b16 a[126:127],v3 offset:6272
v_lshrrev_b32 v19,5,v35
v_mfma_f32_16x16x32_bf16 v[112:115],a[136:139],v[52:55],v[112:115]
ds_read_b64_tr_b16 a[128:129],v4 offset:128
v_xor_b32 v34,v34,v19
v_mfma_f32_16x16x32_bf16 v[116:119],a[140:143],v[52:55],v[116:119]
ds_read_b64_tr_b16 a[130:131],v4 offset:6272
ds_read_b64_tr_b16 a[134:135],v5 offset:6272
ds_read_b64_tr_b16 a[132:133],v5 offset:128
v_mfma_f32_16x16x32_bf16 a[164:167],a[140:143],v[56:59],a[164:167]
v_and_b32 v19,15,v35
v_lshl_add_u32 v19,v19,7,s24
v_mfma_f32_16x16x32_bf16 a[160:163],a[136:139],v[56:59],a[160:163]
v_lshl_add_u32 v19,v34,4,v19
v_bfe_u32 v34,v35,4,1
v_mfma_f32_16x16x32_bf16 a[208:211],a[136:139],v[40:43],a[208:211]
ds_read_b64_tr_b16 a[138:139],v2 offset:6400
v_lshl_add_u32 v32,v34,3,v19
v_mfma_f32_16x16x32_bf16 a[212:215],a[140:143],v[40:43],a[212:215]
ds_read_b64_tr_b16 a[136:137],v2 offset:256
v_xor_b32 v33,32,v32
v_mfma_f32_16x16x32_bf16 a[216:219],a[144:147],v[40:43],a[216:219]
s_waitcnt lgkmcnt(6)
ds_read_b64_tr_b16 a[140:141],v3 offset:256
v_xor_b32 v34,64,v32
v_mfma_f32_16x16x32_bf16 a[220:223],a[148:151],v[40:43],a[220:223]
ds_read_b64_tr_b16 a[142:143],v3 offset:6400
v_bfe_u32 v19,v35,3,1
v_xor_b32 v35,96,v32
v_lshlrev_b32 v19,11,v19
v_add_u32 v38,v34,v19
v_add_u32 v36,v32,v19
v_add_u32 v37,v33,v19
v_add_u32 v39,v35,v19
v_accvgpr_read_b32 v72,a160
v_accvgpr_read_b32 v83,a167
v_accvgpr_read_b32 v81,a165
v_accvgpr_read_b32 v75,a163
v_accvgpr_read_b32 v86,a214
v_accvgpr_read_b32 v76,a208
v_add_f32 v66,v66,v67
v_rcp_f32 v66,v66
v_accvgpr_read_b32 v77,a209
v_accvgpr_read_b32 v82,a166
v_accvgpr_read_b32 v87,a215
v_accvgpr_read_b32 v85,a213
v_add_f32 v68,v68,v69
v_add_f32 v68,v68,v70
v_accvgpr_read_b32 v73,a161
v_pk_mul_f32 v[72:73],v[72:73],v[66:67] op_sel_hi:[1,0]
v_add_f32 v68,v68,v71
v_pk_mov_b32 v[70:71],0,0
v_rcp_f32 v68,v68
v_accvgpr_read_b32 v78,a210
v_pk_mul_f32 v[76:77],v[76:77],v[68:69] op_sel_hi:[1,0]
v_accvgpr_read_b32 v84,a212
v_accvgpr_read_b32 v74,a162
v_pk_mul_f32 v[74:75],v[74:75],v[66:67] op_sel_hi:[1,0]
v_accvgpr_read_b32 v93,a217
v_accvgpr_read_b32 v79,a211
v_pk_mul_f32 v[78:79],v[78:79],v[68:69] op_sel_hi:[1,0]
v_accvgpr_read_b32 v100,a220
v_accvgpr_read_b32 v101,a221
v_mfma_f32_16x16x32_bf16 a[172:175],a[148:151],v[56:59],a[172:175]
v_accvgpr_read_b32 v95,a219
v_accvgpr_read_b32 v80,a164
v_accvgpr_read_b32 v92,a216
v_accvgpr_read_b32 v94,a218
v_accvgpr_read_b32 v103,a223
v_pk_mul_f32 v[82:83],v[82:83],v[66:67] op_sel_hi:[1,0]
v_pk_mul_f32 v[86:87],v[86:87],v[68:69] op_sel_hi:[1,0]
v_pk_mul_f32 v[80:81],v[80:81],v[66:67] op_sel_hi:[1,0]
v_pk_mul_f32 v[84:85],v[84:85],v[68:69] op_sel_hi:[1,0]
v_accvgpr_read_b32 v96,a172
v_accvgpr_read_b32 v99,a175
v_mfma_f32_16x16x32_bf16 a[168:171],a[144:147],v[56:59],a[168:171]
v_accvgpr_read_b32 v98,a174
v_accvgpr_read_b32 v102,a222
v_mfma_f32_16x16x32_bf16 v[120:123],a[144:147],v[52:55],v[120:123]
v_accvgpr_read_b32 v97,a173
v_cvt_pk_bf16_f32 v72,v72,v73
v_mfma_f32_16x16x32_bf16 v[124:127],a[148:151],v[52:55],v[124:127]
v_cvt_pk_bf16_f32 v80,v80,v81
v_cvt_pk_bf16_f32 v81,v82,v83
v_mfma_f32_16x16x32_bf16 v[220:223],a[148:151],v[48:51],v[220:223]
v_accvgpr_read_b32 v90,a170
v_accvgpr_read_b32 v89,a169
v_accvgpr_read_b32 v88,a168
v_accvgpr_read_b32 v91,a171
v_cvt_pk_bf16_f32 v76,v76,v77
v_pk_mul_f32 v[90:91],v[90:91],v[66:67] op_sel_hi:[1,0]
v_pk_mul_f32 v[94:95],v[94:95],v[68:69] op_sel_hi:[1,0]
v_pk_mul_f32 v[92:93],v[92:93],v[68:69] op_sel_hi:[1,0]
v_pk_mul_f32 v[88:89],v[88:89],v[66:67] op_sel_hi:[1,0]
v_cvt_pk_bf16_f32 v92,v92,v93
v_cvt_pk_bf16_f32 v88,v88,v89
v_mfma_f32_16x16x32_bf16 v[216:219],a[144:147],v[48:51],v[216:219]
v_cvt_pk_bf16_f32 v89,v90,v91
v_cvt_pk_bf16_f32 v77,v78,v79
v_mfma_f32_16x16x32_bf16 v[168:171],a[144:147],v[44:47],v[168:171]
ds_read_b64_tr_b16 a[144:145],v4 offset:256
ds_read_b64_tr_b16 a[146:147],v4 offset:6400
v_cvt_pk_bf16_f32 v93,v94,v95
v_cvt_pk_bf16_f32 v73,v74,v75
ds_write2st64_b64 v32,v[72:73],v[76:77] offset0:36 offset1:40
v_pk_mul_f32 v[100:101],v[100:101],v[68:69] op_sel_hi:[1,0]
v_pk_mul_f32 v[96:97],v[96:97],v[66:67] op_sel_hi:[1,0]
v_pk_mul_f32 v[102:103],v[102:103],v[68:69] op_sel_hi:[1,0]
v_pk_mul_f32 v[98:99],v[98:99],v[66:67] op_sel_hi:[1,0]
v_cvt_pk_bf16_f32 v100,v100,v101
v_cvt_pk_bf16_f32 v84,v84,v85
v_mfma_f32_16x16x32_bf16 v[172:175],a[148:151],v[44:47],v[172:175]
ds_read_b64_tr_b16 a[148:149],v5 offset:256
v_cvt_pk_bf16_f32 v85,v86,v87
v_mfma_f32_16x16x32_bf16 v[176:179],a[120:123],v[44:47],v[176:179]
ds_read_b64_tr_b16 a[150:151],v5 offset:6400
v_cvt_pk_bf16_f32 v101,v102,v103
v_mfma_f32_16x16x32_bf16 v[180:183],a[124:127],v[44:47],v[180:183]
ds_write2st64_b64 v33,v[80:81],v[84:85] offset0:36 offset1:40
v_mfma_f32_16x16x32_bf16 v[228:231],a[124:127],v[48:51],v[228:231]
v_add_f32 v64,v64,v65
v_cvt_pk_bf16_f32 v96,v96,v97
v_mfma_f32_16x16x32_bf16 v[224:227],a[120:123],v[48:51],v[224:227]
v_rcp_f32 v64,v64
v_mfma_f32_16x16x32_bf16 v[128:131],a[120:123],v[52:55],v[128:131]
v_cvt_pk_bf16_f32 v97,v98,v99
v_add_f32 v60,v60,v61
v_mfma_f32_16x16x32_bf16 v[132:135],a[124:127],v[52:55],v[132:135]
ds_write2st64_b64 v34,v[88:89],v[92:93] offset0:36 offset1:40
v_mfma_f32_16x16x32_bf16 a[180:183],a[124:127],v[56:59],a[180:183]
v_rcp_f32 v60,v60
v_mfma_f32_16x16x32_bf16 a[176:179],a[120:123],v[56:59],a[176:179]
v_add_f32 v62,v62,v63
v_rcp_f32 v62,v62
v_mfma_f32_16x16x32_bf16 a[224:227],a[120:123],v[40:43],a[224:227]
v_min3_f32 v61,v60,v62,v64
v_min3_f32 v61,v61,v66,v68
v_mfma_f32_16x16x32_bf16 a[228:231],a[124:127],v[40:43],a[228:231]
s_waitcnt lgkmcnt(1)
ds_write2st64_b64 v35,v[96:97],v[100:101] offset0:36 offset1:40
v_mfma_f32_16x16x32_bf16 a[232:235],a[128:131],v[40:43],a[232:235]
v_accvgpr_read_b32 v81,a177
v_accvgpr_read_b32 v80,a176
v_mfma_f32_16x16x32_bf16 a[236:239],a[132:135],v[40:43],a[236:239]
ds_read_b128 v[104:107],v10 offset:18432
v_accvgpr_read_b32 v88,a180
ds_read_b128 v[108:111],v10 offset:19456
v_pk_mul_f32 v[80:81],v[80:81],v[66:67] op_sel_hi:[1,0]
ds_read_b128 v[72:75],v10 offset:20480
v_accvgpr_read_b32 v94,a230
ds_read_b128 v[76:79],v10 offset:21504
v_accvgpr_read_b32 v89,a181
v_accvgpr_read_b32 v87,a227
v_accvgpr_read_b32 v95,a231
v_accvgpr_read_b32 v91,a183
v_accvgpr_read_b32 v90,a182
v_accvgpr_read_b32 v83,a179
v_accvgpr_read_b32 v82,a178
v_pk_mul_f32 v[82:83],v[82:83],v[66:67] op_sel_hi:[1,0]
v_accvgpr_read_b32 v92,a228
v_accvgpr_read_b32 v85,a225
v_accvgpr_read_b32 v93,a229
v_accvgpr_read_b32 v84,a224
v_pk_mul_f32 v[84:85],v[84:85],v[68:69] op_sel_hi:[1,0]
v_accvgpr_read_b32 v86,a226
v_pk_mul_f32 v[86:87],v[86:87],v[68:69] op_sel_hi:[1,0]
v_cvt_pk_bf16_f32 v84,v84,v85
v_cvt_pk_bf16_f32 v85,v86,v87
v_mfma_f32_16x16x32_bf16 a[188:191],a[132:135],v[56:59],a[188:191]
s_waitcnt lgkmcnt(3)
buffer_store_dwordx4 v[104:107],v9,s[16:19],s87 offen offset:0 nt
v_accvgpr_read_b32 v86,a238
v_accvgpr_read_b32 v101,a233
v_cvt_pk_bf16_f32 v80,v80,v81
v_pk_mul_f32 v[90:91],v[90:91],v[66:67] op_sel_hi:[1,0]
v_pk_mul_f32 v[92:93],v[92:93],v[68:69] op_sel_hi:[1,0]
v_pk_mul_f32 v[94:95],v[94:95],v[68:69] op_sel_hi:[1,0]
v_pk_mul_f32 v[88:89],v[88:89],v[66:67] op_sel_hi:[1,0]
v_cvt_pk_bf16_f32 v81,v82,v83
v_accvgpr_read_b32 v82,a190
v_mfma_f32_16x16x32_bf16 a[184:187],a[128:131],v[56:59],a[184:187]
ds_write2st64_b64 v32,v[80:81],v[84:85] offset0:36 offset1:40
v_mfma_f32_16x16x32_bf16 v[136:139],a[128:131],v[52:55],v[136:139]
v_accvgpr_read_b32 v81,a189
v_accvgpr_read_b32 v85,a237
v_mfma_f32_16x16x32_bf16 v[140:143],a[132:135],v[52:55],v[140:143]
s_waitcnt lgkmcnt(1)
buffer_store_dwordx4 v[108:111],v9,s[16:19],s87 offen offset:3072 nt
v_accvgpr_read_b32 v103,a235
v_accvgpr_read_b32 v83,a191
v_accvgpr_read_b32 v99,a187
v_mfma_f32_16x16x32_bf16 v[236:239],a[132:135],v[48:51],v[236:239]
v_accvgpr_read_b32 v97,a185
v_accvgpr_read_b32 v98,a186
v_accvgpr_read_b32 v84,a236
v_accvgpr_read_b32 v102,a234
v_accvgpr_read_b32 v87,a239
v_pk_mul_f32 v[98:99],v[98:99],v[66:67] op_sel_hi:[1,0]
buffer_store_dwordx4 v[72:75],v9,s[16:19],s66 offen offset:0 nt
v_pk_mul_f32 v[84:85],v[84:85],v[68:69] op_sel_hi:[1,0]
v_pk_mul_f32 v[112:113],v[112:113],v[64:65] op_sel_hi:[1,0]
v_pk_mul_f32 v[82:83],v[82:83],v[66:67] op_sel_hi:[1,0]
v_pk_mul_f32 v[130:131],v[130:131],v[64:65] op_sel_hi:[1,0]
v_pk_mul_f32 v[114:115],v[114:115],v[64:65] op_sel_hi:[1,0]
v_pk_mul_f32 v[86:87],v[86:87],v[68:69] op_sel_hi:[1,0]
v_pk_mul_f32 v[128:129],v[128:129],v[64:65] op_sel_hi:[1,0]
v_pk_mul_f32 v[102:103],v[102:103],v[68:69] op_sel_hi:[1,0]
v_accvgpr_read_b32 v96,a184
v_pk_mul_f32 v[96:97],v[96:97],v[66:67] op_sel_hi:[1,0]
v_accvgpr_read_b32 v100,a232
buffer_store_dwordx4 v[76:79],v9,s[16:19],s66 offen offset:3072 nt
v_pk_mul_f32 v[100:101],v[100:101],v[68:69] op_sel_hi:[1,0]
v_accvgpr_read_b32 v80,a188
v_pk_mul_f32 v[80:81],v[80:81],v[66:67] op_sel_hi:[1,0]
v_cmp_nlt_f32 vcc,s37,v61
v_cvt_pk_bf16_f32 v84,v84,v85
v_mfma_f32_16x16x32_bf16 v[232:235],a[128:131],v[48:51],v[232:235]
v_cvt_pk_bf16_f32 v100,v100,v101
v_cvt_pk_bf16_f32 v101,v102,v103
v_mfma_f32_16x16x32_bf16 v[184:187],a[128:131],v[44:47],v[184:187]
s_cmp_lg_u64 vcc,0
v_cvt_pk_bf16_f32 v88,v88,v89
v_cvt_pk_bf16_f32 v96,v96,v97
v_mfma_f32_16x16x32_bf16 v[188:191],a[132:135],v[44:47],v[188:191]
s_cselect_b32 s62,s32,0
v_cvt_pk_bf16_f32 v80,v80,v81
v_cvt_pk_bf16_f32 v97,v98,v99
v_mfma_f32_16x16x32_bf16 v[192:195],a[136:139],v[44:47],v[192:195]
s_or_b32 s31,s31,s62
v_cvt_pk_bf16_f32 v81,v82,v83
v_cvt_pk_bf16_f32 v89,v90,v91
v_cvt_pk_bf16_f32 v92,v92,v93
v_cvt_pk_bf16_f32 v93,v94,v95
ds_write2st64_b64 v33,v[88:89],v[92:93] offset0:36 offset1:40
v_pk_mul_f32 v[132:133],v[132:133],v[64:65] op_sel_hi:[1,0]
v_pk_mul_f32 v[134:135],v[134:135],v[64:65] op_sel_hi:[1,0]
v_pk_mul_f32 v[118:119],v[118:119],v[64:65] op_sel_hi:[1,0]
v_pk_mul_f32 v[116:117],v[116:117],v[64:65] op_sel_hi:[1,0]
v_cvt_pk_bf16_f32 v85,v86,v87
v_cvt_pk_bf16_f32 v112,v112,v113
v_mfma_f32_16x16x32_bf16 v[196:199],a[140:143],v[44:47],v[196:199]
s_lshl_b32 s32,s32,1
v_cvt_pk_bf16_f32 v116,v116,v117
v_cvt_pk_bf16_f32 v113,v114,v115
v_mfma_f32_16x16x32_bf16 v[244:247],a[140:143],v[48:51],v[244:247]
s_add_u32 m0,s24,6144
v_cvt_pk_bf16_f32 v128,v128,v129
v_cvt_pk_bf16_f32 v129,v130,v131
v_mfma_f32_16x16x32_bf16 v[240:243],a[136:139],v[48:51],v[240:243]
buffer_load_dwordx4 v6,s[12:15],s28 offen offset:0 nt lds
buffer_load_dwordx4 v7,s[12:15],s28 offen offset:1024 nt lds
buffer_load_dwordx4 v8,s[12:15],s28 offen offset:2048 nt lds
ds_write2st64_b64 v34,v[96:97],v[100:101] offset0:36 offset1:40
v_pk_mul_f32 v[136:137],v[136:137],v[64:65] op_sel_hi:[1,0]
v_pk_mul_f32 v[138:139],v[138:139],v[64:65] op_sel_hi:[1,0]
v_pk_mul_f32 v[120:121],v[120:121],v[64:65] op_sel_hi:[1,0]
v_pk_mul_f32 v[122:123],v[122:123],v[64:65] op_sel_hi:[1,0]
v_cvt_pk_bf16_f32 v120,v120,v121
v_cvt_pk_bf16_f32 v121,v122,v123
v_mfma_f32_16x16x32_bf16 v[144:147],a[136:139],v[52:55],v[144:147]
s_add_u32 s28,s28,3072
v_cvt_pk_bf16_f32 v117,v118,v119
v_cvt_pk_bf16_f32 v132,v132,v133
v_mfma_f32_16x16x32_bf16 v[148:151],a[140:143],v[52:55],v[148:151]
s_add_u32 m0,s24,9216
v_cvt_pk_bf16_f32 v133,v134,v135
v_cvt_pk_bf16_f32 v136,v136,v137
v_mfma_f32_16x16x32_bf16 a[196:199],a[140:143],v[56:59],a[196:199]
buffer_load_dwordx4 v6,s[12:15],s28 offen offset:0 nt lds
v_mfma_f32_16x16x32_bf16 a[192:195],a[136:139],v[56:59],a[192:195]
buffer_load_dwordx4 v7,s[12:15],s28 offen offset:1024 nt lds
buffer_load_dwordx4 v8,s[12:15],s28 offen offset:2048 nt lds
ds_write2st64_b64 v35,v[80:81],v[84:85] offset0:36 offset1:40
v_pk_mul_f32 v[142:143],v[142:143],v[64:65] op_sel_hi:[1,0]
v_pk_mul_f32 v[124:125],v[124:125],v[64:65] op_sel_hi:[1,0]
v_pk_mul_f32 v[126:127],v[126:127],v[64:65] op_sel_hi:[1,0]
ds_read_b128 v[72:75],v10 offset:18432
v_pk_mul_f32 v[140:141],v[140:141],v[64:65] op_sel_hi:[1,0]
v_accvgpr_read_b32 v105,a193
v_accvgpr_read_b32 v97,a197
v_mfma_f32_16x16x32_bf16 a[240:243],a[136:139],v[40:43],a[240:243]
s_waitcnt vmcnt(25)
s_waitcnt vmcnt(10)
s_barrier
v_mfma_f32_16x16x32_bf16 a[244:247],a[140:143],v[40:43],a[244:247]
s_add_u32 s28,s28,3072
ds_read_b128 a[68:71],v12 offset:12544
v_accvgpr_read_b32 v104,a192
v_mfma_f32_16x16x32_bf16 a[248:251],a[144:147],v[40:43],a[248:251]
s_add_u32 m0,s23,0
ds_read_b128 a[48:51],v11 offset:12288
buffer_load_dwordx4 v6,s[8:11],s25 offen offset:0 lds
v_mfma_f32_16x16x32_bf16 a[252:255],a[148:151],v[40:43],a[252:255]
s_waitcnt lgkmcnt(2)
ds_read_b128 a[64:67],v11 offset:12544
v_accvgpr_read_b32 v110,a242
ds_read_b128 a[56:59],v11 offset:12416
buffer_store_dwordx4 v[72:75],v9,s[16:19],s87 offen offset:128 nt
ds_read_b128 a[60:63],v12 offset:12416
v_pk_mul_f32 v[104:105],v[104:105],v[66:67] op_sel_hi:[1,0]
ds_read_b128 a[52:55],v12 offset:12288
v_accvgpr_read_b32 v108,a240
ds_read_b128 v[76:79],v10 offset:19456
buffer_load_dwordx4 v7,s[8:11],s25 offen offset:1024 lds
ds_read_b128 v[88:91],v10 offset:20480
v_accvgpr_read_b32 v101,a245
ds_read_b128 v[92:95],v10 offset:21504
v_accvgpr_read_b32 v98,a198
ds_write2st64_b64 v36,v[112:113],v[128:129] offset0:24 offset1:26
v_accvgpr_read_b32 v106,a194
v_accvgpr_read_b32 v102,a246
v_accvgpr_read_b32 v109,a241
ds_read_b128 a[124:127],v1 offset:0
v_pk_mul_f32 v[108:109],v[108:109],v[68:69] op_sel_hi:[1,0]
ds_read_b128 a[128:131],v0 offset:128
s_waitcnt lgkmcnt(5)
buffer_store_dwordx4 v[76:79],v9,s[16:19],s87 offen offset:3200 nt
buffer_load_dwordx4 v8,s[8:11],s25 offen offset:2048 lds
ds_read_b128 a[136:139],v0 offset:256
v_accvgpr_read_b32 v100,a244
ds_read_b128 a[120:123],v0 offset:0
v_accvgpr_read_b32 v96,a196
ds_write2st64_b64 v37,v[116:117],v[132:133] offset0:24 offset1:26
v_accvgpr_read_b32 v107,a195
v_pk_mul_f32 v[106:107],v[106:107],v[66:67] op_sel_hi:[1,0]
v_accvgpr_read_b32 v111,a243
ds_read_b128 a[132:135],v1 offset:128
s_waitcnt lgkmcnt(5)
buffer_store_dwordx4 v[88:91],v9,s[16:19],s66 offen offset:128 nt
ds_read_b128 a[140:143],v1 offset:256
v_pk_mul_f32 v[110:111],v[110:111],v[68:69] op_sel_hi:[1,0]
v_accvgpr_read_b32 v103,a247
v_accvgpr_read_b32 v84,a248
v_mfma_f32_16x16x32_bf16 a[204:207],a[148:151],v[56:59],a[204:207]
s_waitcnt vmcnt(19)
ds_read_b128 a[92:95],v12 offset:256
v_accvgpr_read_b32 v85,a249
v_mfma_f32_16x16x32_bf16 a[200:203],a[144:147],v[56:59],a[200:203]
s_mov_b32 s27,s42
ds_read_b128 a[88:91],v11 offset:256
v_accvgpr_read_b32 v99,a199
v_mfma_f32_16x16x32_bf16 v[152:155],a[144:147],v[52:55],v[152:155]
s_mov_b32 s42,s41
buffer_store_dwordx4 v[92:95],v9,s[16:19],s66 offen offset:3200 nt
ds_read_b128 a[80:83],v11 offset:128
v_accvgpr_read_b32 v87,a251
ds_read_b128 a[76:79],v12 offset:0
v_pk_mul_f32 v[98:99],v[98:99],v[66:67] op_sel_hi:[1,0]
ds_read_b128 a[84:87],v12 offset:128
v_pk_mul_f32 v[96:97],v[96:97],v[66:67] op_sel_hi:[1,0]
ds_read_b128 a[72:75],v11 offset:0
v_pk_mul_f32 v[102:103],v[102:103],v[68:69] op_sel_hi:[1,0]
v_pk_mul_f32 v[100:101],v[100:101],v[68:69] op_sel_hi:[1,0]
v_accvgpr_read_b32 v82,a202
v_accvgpr_read_b32 v81,a201
v_mfma_f32_16x16x32_bf16 v[156:159],a[148:151],v[52:55],v[156:159]
s_add_u32 s69,s69,1
v_accvgpr_read_b32 v80,a200
v_accvgpr_read_b32 v83,a203
v_mfma_f32_16x16x32_bf16 v[252:255],a[148:151],v[48:51],v[252:255]
s_lshl_b32 s62,s69,5
v_accvgpr_read_b32 v131,a255
v_accvgpr_read_b32 v86,a250
v_mfma_f32_16x16x32_bf16 v[248:251],a[144:147],v[48:51],v[248:251]
s_add_u32 s62,s62,s34
v_accvgpr_read_b32 v112,a204
v_accvgpr_read_b32 v115,a207
v_mfma_f32_16x16x32_bf16 v[200:203],a[144:147],v[44:47],v[200:203]
s_mul_i32 s63,s62,171
ds_read_b128 a[144:147],v0 offset:6144
v_accvgpr_read_b32 v114,a206
v_accvgpr_read_b32 v130,a254
v_accvgpr_read_b32 v113,a205
v_cvt_pk_bf16_f32 v108,v108,v109
v_pk_mul_f32 v[84:85],v[84:85],v[68:69] op_sel_hi:[1,0]
v_pk_mul_f32 v[82:83],v[82:83],v[66:67] op_sel_hi:[1,0]
v_pk_mul_f32 v[86:87],v[86:87],v[68:69] op_sel_hi:[1,0]
v_pk_mul_f32 v[80:81],v[80:81],v[66:67] op_sel_hi:[1,0]
v_accvgpr_read_b32 v128,a252
v_cvt_pk_bf16_f32 v80,v80,v81
v_mfma_f32_16x16x32_bf16 v[204:207],a[148:151],v[44:47],v[204:207]
s_lshr_b32 s63,s63,9
ds_read_b128 a[148:151],v1 offset:6144
v_cvt_pk_bf16_f32 v84,v84,v85
s_waitcnt lgkmcnt(2)
v_mfma_f32_16x16x32_bf16 v[72:75],a[120:123],a[0:3],0
s_mul_i32 s64,s63,3
v_cvt_pk_bf16_f32 v85,v86,v87
v_cvt_pk_bf16_f32 v96,v96,v97
v_mfma_f32_16x16x32_bf16 v[72:75],a[124:127],a[4:7],v[72:75]
s_sub_u32 s62,s62,s64
v_accvgpr_read_b32 v129,a253
v_cvt_pk_bf16_f32 v104,v104,v105
v_cvt_pk_bf16_f32 v81,v82,v83
v_cvt_pk_bf16_f32 v137,v138,v139
ds_write2st64_b64 v38,v[120:121],v[136:137] offset0:24 offset1:26
v_pk_mul_f32 v[112:113],v[112:113],v[66:67] op_sel_hi:[1,0]
v_pk_mul_f32 v[128:129],v[128:129],v[68:69] op_sel_hi:[1,0]
v_pk_mul_f32 v[114:115],v[114:115],v[66:67] op_sel_hi:[1,0]
v_pk_mul_f32 v[130:131],v[130:131],v[68:69] op_sel_hi:[1,0]
v_pk_mov_b32 v[66:67],0,0
v_pk_mov_b32 v[68:69],0,0
v_cvt_pk_bf16_f32 v140,v140,v141
v_cvt_pk_bf16_f32 v141,v142,v143
v_mfma_f32_16x16x32_bf16 v[72:75],a[128:131],a[8:11],v[72:75]
s_waitcnt vmcnt(7)
ds_read_b128 a[100:103],v12 offset:6144
v_cvt_pk_bf16_f32 v109,v110,v111
v_mfma_f32_16x16x32_bf16 v[72:75],a[132:135],a[12:15],v[72:75]
s_add_u32 s63,s63,s33
ds_read_b128 a[104:107],v11 offset:6272
v_cvt_pk_bf16_f32 v124,v124,v125
v_mfma_f32_16x16x32_bf16 v[72:75],a[136:139],a[16:19],v[72:75]
s_mul_i32 s30,s63,196608
ds_read_b128 a[96:99],v11 offset:6144
v_cvt_pk_bf16_f32 v125,v126,v127
v_mfma_f32_16x16x32_bf16 v[72:75],a[140:143],a[20:23],v[72:75]
s_mul_i32 s41,s63,325632
ds_read_b128 a[108:111],v12 offset:6272
v_cvt_pk_bf16_f32 v97,v98,v99
ds_read_b128 a[116:119],v12 offset:6400
v_pk_mul_f32 v[162:163],v[162:163],v[60:61] op_sel_hi:[1,0]
ds_read_b128 a[112:115],v11 offset:6400
v_pk_mul_f32 v[144:145],v[144:145],v[64:65] op_sel_hi:[1,0]
ds_write2st64_b64 v39,v[124:125],v[140:141] offset0:24 offset1:26
v_pk_mul_f32 v[160:161],v[160:161],v[60:61] op_sel_hi:[1,0]
v_pk_mul_f32 v[146:147],v[146:147],v[64:65] op_sel_hi:[1,0]
v_cvt_pk_bf16_f32 v100,v100,v101
v_cvt_pk_bf16_f32 v101,v102,v103
v_cvt_pk_bf16_f32 v105,v106,v107
v_cvt_pk_bf16_f32 v112,v112,v113
v_cvt_pk_bf16_f32 v128,v128,v129
v_cvt_pk_bf16_f32 v129,v130,v131
v_cvt_pk_bf16_f32 v113,v114,v115
v_max3_f32 v44,v72,v73,v74
v_max_f32 v44,v44,v75
ds_write2st64_b64 v32,v[104:105],v[108:109] offset0:36 offset1:40
v_cvt_pk_bf16_f32 v160,v160,v161
v_cvt_pk_bf16_f32 v144,v144,v145
v_cvt_pk_bf16_f32 v145,v146,v147
v_cvt_pk_bf16_f32 v161,v162,v163
s_lshl_b32 s63,s3,2
s_add_u32 s64,s63,21
s_cmp_eq_u32 s3,0
s_cselect_b32 s64,20,s64
s_cselect_b32 s40,1,0
s_add_u32 s65,s63,37
s_cmp_eq_u32 s62,2
ds_write2st64_b64 v33,v[96:97],v[100:101] offset0:36 offset1:40
s_cselect_b32 s64,s65,s64
s_cselect_b32 s40,0,s40
s_add_u32 s65,s63,s3
s_cmp_eq_u32 s62,0
s_cselect_b32 s64,s65,s64
s_cselect_b32 s40,1,s40
s_mul_i32 s64,s64,6144
s_add_u32 s41,s41,s64
s_cmp_ge_u32 s69,6
s_cselect_b32 s41,166723584,s41
s_cselect_b32 s30,100663296,s30
ds_write2st64_b64 v34,v[80:81],v[84:85] offset0:36 offset1:40
v_mfma_f32_16x16x32_bf16 v[80:83],a[140:143],a[44:47],0
s_add_u32 s25,s30,s22
s_add_u32 s26,s25,12288
s_add_u32 m0,s23,24576
v_mfma_f32_16x16x32_bf16 v[80:83],a[136:139],a[40:43],v[80:83]
s_mov_b32 s28,s41
s_mov_b32 s29,s24
v_mfma_f32_16x16x32_bf16 v[80:83],a[132:135],a[36:39],v[80:83]
ds_write2st64_b64 v35,v[112:113],v[128:129] offset0:36 offset1:40
v_pk_mul_f32 v[148:149],v[148:149],v[64:65] op_sel_hi:[1,0]
v_pk_mul_f32 v[166:167],v[166:167],v[60:61] op_sel_hi:[1,0]
v_pk_mul_f32 v[150:151],v[150:151],v[64:65] op_sel_hi:[1,0]
ds_read_b128 v[76:79],v10 offset:18432
v_pk_mul_f32 v[164:165],v[164:165],v[60:61] op_sel_hi:[1,0]
v_cvt_pk_bf16_f32 v148,v148,v149
v_cvt_pk_bf16_f32 v164,v164,v165
v_mfma_f32_16x16x32_bf16 v[80:83],a[128:131],a[32:35],v[80:83]
ds_read_b128 v[92:95],v10 offset:19456
v_cvt_pk_bf16_f32 v165,v166,v167
v_mfma_f32_16x16x32_bf16 v[80:83],a[124:127],a[28:31],v[80:83]
ds_read_b128 v[116:119],v10 offset:20480
v_cvt_pk_bf16_f32 v149,v150,v151
v_mfma_f32_16x16x32_bf16 v[80:83],a[120:123],a[24:27],v[80:83]
ds_read_b128 v[132:135],v10 offset:21504
v_mfma_f32_16x16x32_bf16 v[88:91],a[120:123],a[48:51],0
ds_write2st64_b64 v36,v[144:145],v[160:161] offset0:28 offset1:0
v_pk_mul_f32 v[168:169],v[168:169],v[60:61] op_sel_hi:[1,0]
v_pk_mul_f32 v[154:155],v[154:155],v[64:65] op_sel_hi:[1,0]
v_pk_mul_f32 v[170:171],v[170:171],v[60:61] op_sel_hi:[1,0]
v_pk_mul_f32 v[152:153],v[152:153],v[64:65] op_sel_hi:[1,0]
v_cvt_pk_bf16_f32 v168,v168,v169
v_max3_f32 v48,v80,v81,v82
v_mfma_f32_16x16x32_bf16 v[88:91],a[124:127],a[52:55],v[88:91]
s_waitcnt lgkmcnt(4)
buffer_store_dwordx4 v[76:79],v9,s[16:19],s87 offen offset:256 nt
v_max_f32 v48,v48,v83
v_cvt_pk_bf16_f32 v169,v170,v171
v_cvt_pk_bf16_f32 v152,v152,v153
v_mfma_f32_16x16x32_bf16 v[88:91],a[128:131],a[56:59],v[88:91]
v_permlane32_swap_b32 v44,v48
v_mfma_f32_16x16x32_bf16 v[88:91],a[132:135],a[60:63],v[88:91]
v_max_f32 v44,v44,v48
v_mov_b32 v48,v44
v_mfma_f32_16x16x32_bf16 v[88:91],a[136:139],a[64:67],v[88:91]
ds_write2st64_b64 v37,v[148:149],v[164:165] offset0:28 offset1:0
v_pk_mul_f32 v[174:175],v[174:175],v[60:61] op_sel_hi:[1,0]
v_pk_mul_f32 v[158:159],v[158:159],v[64:65] op_sel_hi:[1,0]
v_pk_mul_f32 v[172:173],v[172:173],v[60:61] op_sel_hi:[1,0]
s_waitcnt lgkmcnt(1)
buffer_store_dwordx4 v[92:95],v9,s[16:19],s87 offen offset:3328 nt
v_pk_mul_f32 v[156:157],v[156:157],v[64:65] op_sel_hi:[1,0]
v_pk_mov_b32 v[64:65],0,0
v_permlane16_swap_b32 v48,v44
v_max_f32 v44,v44,v48
v_mfma_f32_16x16x32_bf16 v[88:91],a[140:143],a[68:71],v[88:91]
v_mul_f32_e64 v14,-s36,v44
v_mov_b32 v13,v14
v_mfma_f32_16x16x32_bf16 v[96:99],a[140:143],a[92:95],0
v_cvt_pk_bf16_f32 v156,v156,v157
v_permlane32_swap_b32 v13,v14
v_mfma_f32_16x16x32_bf16 v[96:99],a[136:139],a[88:91],v[96:99]
buffer_store_dwordx4 v[116:119],v9,s[16:19],s66 offen offset:256 nt
v_fma_f32 v81,v81,s36,v14
v_fma_f32 v74,v74,s36,v13
v_fma_f32 v72,v72,s36,v13
v_pk_mul_f32 v[192:193],v[192:193],v[60:61] op_sel_hi:[1,0]
v_pk_mul_f32 v[194:195],v[194:195],v[60:61] op_sel_hi:[1,0]
v_pk_mul_f32 v[176:177],v[176:177],v[60:61] op_sel_hi:[1,0]
v_pk_mul_f32 v[178:179],v[178:179],v[60:61] op_sel_hi:[1,0]
v_fma_f32 v75,v75,s36,v13
v_exp_f32 v75,v75
v_mfma_f32_16x16x32_bf16 v[96:99],a[132:135],a[84:87],v[96:99]
v_fma_f32 v73,v73,s36,v13
v_exp_f32 v73,v73
v_mfma_f32_16x16x32_bf16 v[96:99],a[128:131],a[80:83],v[96:99]
buffer_store_dwordx4 v[132:135],v9,s[16:19],s66 offen offset:3328 nt
v_exp_f32 v72,v72
v_exp_f32 v74,v74
v_mfma_f32_16x16x32_bf16 v[96:99],a[124:127],a[76:79],v[96:99]
v_cvt_pk_bf16_f32 v20,v72,v73
v_fma_f32 v83,v83,s36,v14
v_mfma_f32_16x16x32_bf16 v[96:99],a[120:123],a[72:75],v[96:99]
v_cvt_pk_bf16_f32 v21,v74,v75
v_exp_f32 v81,v81
v_fma_f32 v82,v82,s36,v14
v_exp_f32 v82,v82
v_pk_mul_f32 v[182:183],v[182:183],v[60:61] op_sel_hi:[1,0]
v_pk_mul_f32 v[198:199],v[198:199],v[60:61] op_sel_hi:[1,0]
v_pk_mul_f32 v[180:181],v[180:181],v[60:61] op_sel_hi:[1,0]
v_pk_mul_f32 v[196:197],v[196:197],v[60:61] op_sel_hi:[1,0]
v_exp_f32 v83,v83
v_max3_f32 v52,v88,v89,v90
v_mfma_f32_16x16x32_bf16 v[104:107],a[120:123],a[96:99],0
ds_read_b128 a[120:123],v0 offset:6272
v_max_f32 v52,v52,v91
v_mfma_f32_16x16x32_bf16 v[104:107],a[124:127],a[100:103],v[104:107]
ds_read_b128 a[124:127],v1 offset:6272
v_fma_f32 v80,v80,s36,v14
v_mfma_f32_16x16x32_bf16 v[104:107],a[128:131],a[104:107],v[104:107]
ds_read_b128 a[128:131],v0 offset:6400
v_exp_f32 v80,v80
v_cvt_pk_bf16_f32 v25,v82,v83
v_cvt_pk_bf16_f32 v24,v80,v81
v_pk_mul_f32 v[202:203],v[202:203],v[60:61] op_sel_hi:[1,0]
v_pk_mul_f32 v[186:187],v[186:187],v[60:61] op_sel_hi:[1,0]
v_pk_mul_f32 v[200:201],v[200:201],v[60:61] op_sel_hi:[1,0]
v_pk_mul_f32 v[184:185],v[184:185],v[60:61] op_sel_hi:[1,0]
v_max3_f32 v56,v96,v97,v98
v_max_f32 v56,v56,v99
v_mfma_f32_16x16x32_bf16 v[104:107],a[132:135],a[108:111],v[104:107]
ds_read_b128 a[132:135],v1 offset:6400
v_permlane32_swap_b32 v52,v56
v_mfma_f32_16x16x32_bf16 v[104:107],a[136:139],a[112:115],v[104:107]
ds_read_b128 a[136:139],v0 offset:12288
v_max_f32 v52,v52,v56
v_mfma_f32_16x16x32_bf16 v[104:107],a[140:143],a[116:119],v[104:107]
ds_read_b128 a[140:143],v1 offset:12288
v_mov_b32 v56,v52
v_mfma_f32_16x16x32_bf16 v[76:79],a[144:147],a[0:3],0
v_cvt_pk_bf16_f32 v200,v200,v201
v_permlane16_swap_b32 v56,v52
v_max_f32 v52,v52,v56
v_mul_f32_e64 v16,-s36,v52
v_pk_mul_f32 v[206:207],v[206:207],v[60:61] op_sel_hi:[1,0]
v_pk_mul_f32 v[190:191],v[190:191],v[60:61] op_sel_hi:[1,0]
v_pk_mul_f32 v[204:205],v[204:205],v[60:61] op_sel_hi:[1,0]
v_pk_mul_f32 v[188:189],v[188:189],v[60:61] op_sel_hi:[1,0]
v_pk_mov_b32 v[60:61],0,0
v_mov_b32 v15,v16
v_max3_f32 v40,v104,v105,v106
v_mfma_f32_16x16x32_bf16 v[76:79],a[148:151],a[4:7],v[76:79]
s_waitcnt lgkmcnt(3)
v_permlane32_swap_b32 v15,v16
v_mfma_f32_16x16x32_bf16 v[76:79],a[120:123],a[8:11],v[76:79]
buffer_load_dwordx4 v6,s[8:11],s21 offen offset:0 lds
v_mfma_f32_16x16x32_bf16 v[76:79],a[124:127],a[12:15],v[76:79]
v_fma_f32 v88,v88,s36,v15
v_fma_f32 v89,v89,s36,v15
v_mfma_f32_16x16x32_bf16 v[76:79],a[128:131],a[16:19],v[76:79]
v_exp_f32 v89,v89
v_fma_f32 v90,v90,s36,v15
v_exp_f32 v90,v90
v_pk_mul_f32 v[208:209],v[208:209],v[62:63] op_sel_hi:[1,0]
v_pk_mul_f32 v[210:211],v[210:211],v[62:63] op_sel_hi:[1,0]
v_pk_mul_f32 v[224:225],v[224:225],v[62:63] op_sel_hi:[1,0]
v_pk_mul_f32 v[226:227],v[226:227],v[62:63] op_sel_hi:[1,0]
v_exp_f32 v88,v88
v_fma_f32 v91,v91,s36,v15
s_waitcnt lgkmcnt(0)
v_mfma_f32_16x16x32_bf16 v[76:79],a[132:135],a[20:23],v[76:79]
v_exp_f32 v91,v91
v_mfma_f32_16x16x32_bf16 v[84:87],a[132:135],a[44:47],0
v_cvt_pk_bf16_f32 v29,v90,v91
v_cvt_pk_bf16_f32 v28,v88,v89
v_mfma_f32_16x16x32_bf16 v[84:87],a[128:131],a[40:43],v[84:87]
v_fma_f32 v98,v98,s36,v16
buffer_load_dwordx4 v7,s[8:11],s21 offen offset:1024 lds
v_pk_mul_f32 v[212:213],v[212:213],v[62:63] op_sel_hi:[1,0]
v_pk_mul_f32 v[214:215],v[214:215],v[62:63] op_sel_hi:[1,0]
v_pk_mul_f32 v[228:229],v[228:229],v[62:63] op_sel_hi:[1,0]
v_pk_mul_f32 v[230:231],v[230:231],v[62:63] op_sel_hi:[1,0]
v_exp_f32 v98,v98
v_fma_f32 v99,v99,s36,v16
v_mfma_f32_16x16x32_bf16 v[84:87],a[124:127],a[36:39],v[84:87]
v_cvt_pk_bf16_f32 v192,v192,v193
v_fma_f32 v96,v96,s36,v16
v_mfma_f32_16x16x32_bf16 v[84:87],a[120:123],a[32:35],v[84:87]
v_exp_f32 v96,v96
v_mfma_f32_16x16x32_bf16 v[84:87],a[148:151],a[28:31],v[84:87]
v_cvt_pk_bf16_f32 v184,v184,v185
v_fma_f32 v97,v97,s36,v16
v_mfma_f32_16x16x32_bf16 v[84:87],a[144:147],a[24:27],v[84:87]
v_exp_f32 v97,v97
v_cvt_pk_bf16_f32 v180,v180,v181
v_cvt_pk_bf16_f32 v181,v182,v183
v_cvt_pk_bf16_f32 v157,v158,v159
buffer_load_dwordx4 v8,s[8:11],s21 offen offset:2048 lds
v_pk_mul_f32 v[218:219],v[218:219],v[62:63] op_sel_hi:[1,0]
v_pk_mul_f32 v[234:235],v[234:235],v[62:63] op_sel_hi:[1,0]
v_pk_mul_f32 v[216:217],v[216:217],v[62:63] op_sel_hi:[1,0]
v_pk_mul_f32 v[232:233],v[232:233],v[62:63] op_sel_hi:[1,0]
v_exp_f32 v99,v99
v_cvt_pk_bf16_f32 v232,v232,v233
v_mfma_f32_16x16x32_bf16 v[92:95],a[144:147],a[48:51],0
s_add_u32 s21,s21,12288
v_cvt_pk_bf16_f32 v33,v98,v99
v_cvt_pk_bf16_f32 v208,v208,v209
v_mfma_f32_16x16x32_bf16 v[92:95],a[148:151],a[52:55],v[92:95]
s_add_u32 m0,s22,0
v_cvt_pk_bf16_f32 v209,v210,v211
v_cvt_pk_bf16_f32 v185,v186,v187
v_mfma_f32_16x16x32_bf16 v[92:95],a[120:123],a[56:59],v[92:95]
v_cvt_pk_bf16_f32 v212,v212,v213
v_cvt_pk_bf16_f32 v176,v176,v177
v_mfma_f32_16x16x32_bf16 v[92:95],a[124:127],a[60:63],v[92:95]
v_cvt_pk_bf16_f32 v32,v96,v97
v_cvt_pk_bf16_f32 v172,v172,v173
v_cvt_pk_bf16_f32 v173,v174,v175
v_cvt_pk_bf16_f32 v224,v224,v225
v_cvt_pk_bf16_f32 v225,v226,v227
v_pk_mul_f32 v[236:237],v[236:237],v[62:63] op_sel_hi:[1,0]
v_pk_mul_f32 v[220:221],v[220:221],v[62:63] op_sel_hi:[1,0]
v_pk_mul_f32 v[222:223],v[222:223],v[62:63] op_sel_hi:[1,0]
v_pk_mul_f32 v[238:239],v[238:239],v[62:63] op_sel_hi:[1,0]
v_max_f32 v40,v40,v107
v_mov_b32 v41,v40
v_mfma_f32_16x16x32_bf16 v[92:95],a[128:131],a[64:67],v[92:95]
v_cvt_pk_bf16_f32 v220,v220,v221
v_permlane32_swap_b32 v41,v40
v_mfma_f32_16x16x32_bf16 v[92:95],a[132:135],a[68:71],v[92:95]
v_max_f32 v40,v40,v41
v_mov_b32 v41,v40
v_mfma_f32_16x16x32_bf16 v[100:103],a[132:135],a[92:95],0
v_cvt_pk_bf16_f32 v221,v222,v223
v_cvt_pk_bf16_f32 v228,v228,v229
v_cvt_pk_bf16_f32 v213,v214,v215
v_cvt_pk_bf16_f32 v204,v204,v205
v_cvt_pk_bf16_f32 v153,v154,v155
ds_write2st64_b64 v38,v[152:153],v[168:169] offset0:28 offset1:0
v_pk_mul_f32 v[242:243],v[242:243],v[62:63] op_sel_hi:[1,0]
v_pk_mul_f32 v[240:241],v[240:241],v[62:63] op_sel_hi:[1,0]
v_cvt_pk_bf16_f32 v229,v230,v231
v_cvt_pk_bf16_f32 v236,v236,v237
v_mfma_f32_16x16x32_bf16 v[100:103],a[128:131],a[88:91],v[100:103]
v_cvt_pk_bf16_f32 v237,v238,v239
v_cvt_pk_bf16_f32 v196,v196,v197
v_mfma_f32_16x16x32_bf16 v[100:103],a[124:127],a[84:87],v[100:103]
v_cvt_pk_bf16_f32 v177,v178,v179
v_cvt_pk_bf16_f32 v240,v240,v241
v_mfma_f32_16x16x32_bf16 v[100:103],a[120:123],a[80:83],v[100:103]
ds_write2st64_b64 v39,v[156:157],v[172:173] offset0:28 offset1:0
v_mfma_f32_16x16x32_bf16 v[100:103],a[148:151],a[76:79],v[100:103]
v_cvt_pk_bf16_f32 v241,v242,v243
v_cvt_pk_bf16_f32 v197,v198,v199
v_cvt_pk_bf16_f32 v233,v234,v235
v_cvt_pk_bf16_f32 v201,v202,v203
v_cvt_pk_bf16_f32 v193,v194,v195
v_pk_mul_f32 v[244:245],v[244:245],v[62:63] op_sel_hi:[1,0]
v_pk_mul_f32 v[246:247],v[246:247],v[62:63] op_sel_hi:[1,0]
v_cvt_pk_bf16_f32 v188,v188,v189
v_cvt_pk_bf16_f32 v189,v190,v191
v_mfma_f32_16x16x32_bf16 v[100:103],a[144:147],a[72:75],v[100:103]
ds_write2st64_b64 v36,v[176:177],v[192:193] offset0:2 offset1:4
v_mfma_f32_16x16x32_bf16 v[108:111],a[144:147],a[96:99],0
v_permlane16_swap_b32 v41,v40
v_mfma_f32_16x16x32_bf16 v[108:111],a[148:151],a[100:103],v[108:111]
ds_read_b128 a[144:147],v0 offset:12416
v_max_f32 v40,v40,v41
ds_read_b128 a[148:151],v1 offset:12416
v_pk_mul_f32 v[248:249],v[248:249],v[62:63] op_sel_hi:[1,0]
ds_write2st64_b64 v37,v[180:181],v[196:197] offset0:2 offset1:4
v_pk_mul_f32 v[250:251],v[250:251],v[62:63] op_sel_hi:[1,0]
v_mul_f32_e64 v17,-s36,v40
v_fma_f32 v106,v106,s36,v17
v_mfma_f32_16x16x32_bf16 v[108:111],a[120:123],a[104:107],v[108:111]
ds_read_b128 a[120:123],v0 offset:12544
v_exp_f32 v106,v106
v_mfma_f32_16x16x32_bf16 v[108:111],a[124:127],a[108:111],v[108:111]
ds_read_b128 a[124:127],v1 offset:12544
v_fma_f32 v107,v107,s36,v17
v_mfma_f32_16x16x32_bf16 v[108:111],a[128:131],a[112:115],v[108:111]
ds_write2st64_b64 v38,v[184:185],v[200:201] offset0:2 offset1:4
v_mfma_f32_16x16x32_bf16 v[108:111],a[132:135],a[116:119],v[108:111]
v_exp_f32 v107,v107
ds_read_b128 a[132:135],v1 offset:18432
v_pk_mul_f32 v[252:253],v[252:253],v[62:63] op_sel_hi:[1,0]
ds_read_b128 a[128:131],v0 offset:18432
v_pk_mul_f32 v[254:255],v[254:255],v[62:63] op_sel_hi:[1,0]
v_pk_mov_b32 v[62:63],0,0
v_fma_f32 v104,v104,s36,v17
v_exp_f32 v104,v104
v_mfma_f32_16x16x32_bf16 v[72:75],a[136:139],a[0:3],0
v_fma_f32 v105,v105,s36,v17
v_exp_f32 v105,v105
v_mfma_f32_16x16x32_bf16 v[72:75],a[140:143],a[4:7],v[72:75]
s_waitcnt lgkmcnt(2)
v_cvt_pk_bf16_f32 v205,v206,v207
v_cvt_pk_bf16_f32 v216,v216,v217
v_mfma_f32_16x16x32_bf16 v[72:75],a[144:147],a[8:11],v[72:75]
ds_write2st64_b64 v39,v[188:189],v[204:205] offset0:2 offset1:4
v_mfma_f32_16x16x32_bf16 v[72:75],a[148:151],a[12:15],v[72:75]
v_fma_f32 v76,v76,s36,v13
v_cvt_pk_bf16_f32 v217,v218,v219
v_mfma_f32_16x16x32_bf16 v[72:75],a[120:123],a[16:19],v[72:75]
v_cvt_pk_bf16_f32 v244,v244,v245
v_cvt_pk_bf16_f32 v245,v246,v247
v_mfma_f32_16x16x32_bf16 v[72:75],a[124:127],a[20:23],v[72:75]
v_exp_f32 v76,v76
v_mfma_f32_16x16x32_bf16 v[80:83],a[124:127],a[44:47],0
ds_write2st64_b64 v36,v[208:209],v[224:225] offset0:12 offset1:14
v_mfma_f32_16x16x32_bf16 v[80:83],a[120:123],a[40:43],v[80:83]
v_fma_f32 v79,v79,s36,v13
v_exp_f32 v79,v79
v_mfma_f32_16x16x32_bf16 v[80:83],a[148:151],a[36:39],v[80:83]
v_fma_f32 v77,v77,s36,v13
v_exp_f32 v77,v77
v_mfma_f32_16x16x32_bf16 v[80:83],a[144:147],a[32:35],v[80:83]
v_fma_f32 v78,v78,s36,v13
v_exp_f32 v78,v78
v_mfma_f32_16x16x32_bf16 v[80:83],a[140:143],a[28:31],v[80:83]
ds_write2st64_b64 v37,v[212:213],v[228:229] offset0:12 offset1:14
v_mfma_f32_16x16x32_bf16 v[80:83],a[136:139],a[24:27],v[80:83]
v_cvt_pk_bf16_f32 v23,v78,v79
v_cvt_pk_bf16_f32 v22,v76,v77
v_mfma_f32_16x16x32_bf16 v[88:91],a[136:139],a[48:51],0
v_fma_f32 v84,v84,s36,v14
v_fma_f32 v86,v86,s36,v14
v_mfma_f32_16x16x32_bf16 v[88:91],a[140:143],a[52:55],v[88:91]
v_exp_f32 v84,v84
v_mfma_f32_16x16x32_bf16 v[88:91],a[144:147],a[56:59],v[88:91]
ds_write2st64_b64 v38,v[216:217],v[232:233] offset0:12 offset1:14
v_mfma_f32_16x16x32_bf16 v[88:91],a[148:151],a[60:63],v[88:91]
v_exp_f32 v86,v86
v_mfma_f32_16x16x32_bf16 v[88:91],a[120:123],a[64:67],v[88:91]
v_fma_f32 v85,v85,s36,v14
v_exp_f32 v85,v85
v_mfma_f32_16x16x32_bf16 v[88:91],a[124:127],a[68:71],v[88:91]
v_cvt_pk_bf16_f32 v26,v84,v85
v_fma_f32 v87,v87,s36,v14
v_mfma_f32_16x16x32_bf16 v[96:99],a[124:127],a[92:95],0
ds_write2st64_b64 v39,v[220:221],v[236:237] offset0:12 offset1:14
v_mfma_f32_16x16x32_bf16 v[96:99],a[120:123],a[88:91],v[96:99]
v_fma_f32 v93,v93,s36,v15
v_exp_f32 v93,v93
v_mfma_f32_16x16x32_bf16 v[96:99],a[148:151],a[84:87],v[96:99]
v_exp_f32 v87,v87
v_mfma_f32_16x16x32_bf16 v[96:99],a[144:147],a[80:83],v[96:99]
v_cvt_pk_bf16_f32 v27,v86,v87
v_fma_f32 v92,v92,s36,v15
v_mfma_f32_16x16x32_bf16 v[96:99],a[140:143],a[76:79],v[96:99]
ds_write_b64 v36,v[240:241] offset:8192
v_smfmac_f32_16x16x64_bf16 v[60:63],a[152:155],v[20:27],v18
v_cvt_pk_bf16_f32 v36,v104,v105
v_mfma_f32_16x16x32_bf16 v[96:99],a[136:139],a[72:75],v[96:99]
ds_write_b64 v37,v[244:245] offset:8192
v_cvt_pk_bf16_f32 v37,v106,v107
v_mfma_f32_16x16x32_bf16 v[104:107],a[136:139],a[96:99],0
ds_read_b128 a[136:139],v0 offset:18560
v_exp_f32 v92,v92
v_mfma_f32_16x16x32_bf16 v[104:107],a[140:143],a[100:103],v[104:107]
ds_read_b128 a[140:143],v1 offset:18560
v_cvt_pk_bf16_f32 v30,v92,v93
v_mfma_f32_16x16x32_bf16 v[104:107],a[144:147],a[104:107],v[104:107]
ds_read_b128 a[144:147],v0 offset:18688
v_fma_f32 v95,v95,s36,v15
v_mfma_f32_16x16x32_bf16 v[104:107],a[148:151],a[108:111],v[104:107]
ds_read_b128 a[148:151],v1 offset:18688
v_exp_f32 v95,v95
v_mfma_f32_16x16x32_bf16 v[104:107],a[120:123],a[112:115],v[104:107]
v_fma_f32 v102,v102,s36,v16
v_fma_f32 v100,v100,s36,v16
v_mfma_f32_16x16x32_bf16 v[104:107],a[124:127],a[116:119],v[104:107]
s_waitcnt lgkmcnt(4)
v_fma_f32 v94,v94,s36,v15
v_exp_f32 v94,v94
v_mfma_f32_16x16x32_bf16 v[76:79],a[128:131],a[0:3],0
v_cvt_pk_bf16_f32 v31,v94,v95
v_exp_f32 v100,v100
v_mfma_f32_16x16x32_bf16 v[76:79],a[132:135],a[4:7],v[76:79]
v_exp_f32 v102,v102
s_waitcnt vmcnt(9)
s_barrier
s_waitcnt lgkmcnt(1)
v_mfma_f32_16x16x32_bf16 v[76:79],a[136:139],a[8:11],v[76:79]
v_fma_f32 v110,v110,s36,v17
v_fma_f32 v109,v109,s36,v17
v_mfma_f32_16x16x32_bf16 v[76:79],a[140:143],a[12:15],v[76:79]
buffer_load_dwordx4 v6,s[4:7],s20 offen offset:0 lds
v_mfma_f32_16x16x32_bf16 v[76:79],a[144:147],a[16:19],v[76:79]
s_waitcnt lgkmcnt(0)
v_exp_f32 v110,v110
v_mfma_f32_16x16x32_bf16 v[76:79],a[148:151],a[20:23],v[76:79]
v_fma_f32 v101,v101,s36,v16
v_exp_f32 v101,v101
v_mfma_f32_16x16x32_bf16 v[84:87],a[148:151],a[44:47],0
v_cvt_pk_bf16_f32 v34,v100,v101
v_fma_f32 v103,v103,s36,v16
v_mfma_f32_16x16x32_bf16 v[84:87],a[144:147],a[40:43],v[84:87]
v_exp_f32 v103,v103
v_mfma_f32_16x16x32_bf16 v[84:87],a[140:143],a[36:39],v[84:87]
buffer_load_dwordx4 v7,s[4:7],s20 offen offset:1024 lds
v_mfma_f32_16x16x32_bf16 v[84:87],a[136:139],a[32:35],v[84:87]
v_cvt_pk_bf16_f32 v35,v102,v103
v_fma_f32 v111,v111,s36,v17
v_mfma_f32_16x16x32_bf16 v[84:87],a[132:135],a[28:31],v[84:87]
v_cvt_pk_bf16_f32 v252,v252,v253
v_cvt_pk_bf16_f32 v248,v248,v249
v_smfmac_f32_16x16x64_bf16 v[64:67],a[152:155],v[28:35],v18
v_cvt_pk_bf16_f32 v249,v250,v251
v_mfma_f32_16x16x32_bf16 v[84:87],a[128:131],a[24:27],v[84:87]
ds_write_b64 v38,v[248:249] offset:8192
v_mfma_f32_16x16x32_bf16 v[92:95],a[128:131],a[48:51],0
ds_read_b64_tr_b16 a[122:123],v2 offset:6144
buffer_load_dwordx4 v8,s[4:7],s20 offen offset:2048 lds
v_mfma_f32_16x16x32_bf16 v[92:95],a[132:135],a[52:55],v[92:95]
s_add_u32 s20,s20,12288
ds_read_b64_tr_b16 a[124:125],v3 offset:0
v_exp_f32 v109,v109
v_mfma_f32_16x16x32_bf16 v[92:95],a[136:139],a[56:59],v[92:95]
ds_read_b64_tr_b16 a[126:127],v3 offset:6144
v_exp_f32 v111,v111
ds_read_b64_tr_b16 a[120:121],v2 offset:0
v_mfma_f32_16x16x32_bf16 v[92:95],a[140:143],a[60:63],v[92:95]
v_fma_f32 v82,v82,s36,v14
v_fma_f32 v108,v108,s36,v17
v_mfma_f32_16x16x32_bf16 v[92:95],a[144:147],a[64:67],v[92:95]
v_exp_f32 v108,v108
v_mfma_f32_16x16x32_bf16 v[92:95],a[148:151],a[68:71],v[92:95]
v_exp_f32 v82,v82
v_mfma_f32_16x16x32_bf16 v[100:103],a[148:151],a[92:95],0
v_fma_f32 v89,v89,s36,v15
v_cvt_pk_bf16_f32 v38,v108,v109
v_mfma_f32_16x16x32_bf16 v[100:103],a[144:147],a[88:91],v[100:103]
v_fma_f32 v74,v74,s36,v13
v_exp_f32 v74,v74
v_mfma_f32_16x16x32_bf16 v[100:103],a[140:143],a[84:87],v[100:103]
v_fma_f32 v88,v88,s36,v15
v_cvt_pk_bf16_f32 v253,v254,v255
v_mfma_f32_16x16x32_bf16 v[100:103],a[136:139],a[80:83],v[100:103]
ds_write_b64 v39,v[252:253] offset:8192
v_mfma_f32_16x16x32_bf16 v[100:103],a[132:135],a[76:79],v[100:103]
v_cvt_pk_bf16_f32 v39,v110,v111
v_fma_f32 v73,v73,s36,v13
v_mfma_f32_16x16x32_bf16 v[100:103],a[128:131],a[72:75],v[100:103]
v_fma_f32 v83,v83,s36,v14
v_exp_f32 v88,v88
v_mfma_f32_16x16x32_bf16 v[108:111],a[128:131],a[96:99],0
ds_read_b64_tr_b16 a[130:131],v4 offset:6144
v_exp_f32 v89,v89
v_mfma_f32_16x16x32_bf16 v[108:111],a[132:135],a[100:103],v[108:111]
ds_read_b64_tr_b16 a[134:135],v5 offset:6144
v_cvt_pk_bf16_f32 v52,v88,v89
v_mfma_f32_16x16x32_bf16 v[108:111],a[136:139],a[104:107],v[108:111]
ds_read_b64_tr_b16 a[128:129],v4 offset:0
v_fma_f32 v81,v81,s36,v14
v_mfma_f32_16x16x32_bf16 v[108:111],a[140:143],a[108:111],v[108:111]
ds_read_b64_tr_b16 a[132:133],v5 offset:0
v_exp_f32 v81,v81
v_mfma_f32_16x16x32_bf16 v[108:111],a[144:147],a[112:115],v[108:111]
v_exp_f32 v83,v83
v_mfma_f32_16x16x32_bf16 v[108:111],a[148:151],a[116:119],v[108:111]
v_cvt_pk_bf16_f32 v49,v82,v83
v_fma_f32 v75,v75,s36,v13
v_exp_f32 v75,v75
v_fma_f32 v80,v80,s36,v14
v_exp_f32 v80,v80
v_cvt_pk_bf16_f32 v45,v74,v75
v_cvt_pk_bf16_f32 v48,v80,v81
v_fma_f32 v72,v72,s36,v13
v_exp_f32 v72,v72
v_exp_f32 v73,v73
s_nop 0
v_cvt_pk_bf16_f32 v44,v72,v73
s_waitcnt lgkmcnt(2)
v_mfma_f32_16x16x32_bf16 v[160:163],a[120:123],v[20:23],0
s_add_u32 m0,s23,0
ds_read_b64_tr_b16 a[136:137],v2 offset:128
v_fma_f32 v90,v90,s36,v15
v_mfma_f32_16x16x32_bf16 v[164:167],a[124:127],v[20:23],0
ds_read_b64_tr_b16 a[138:139],v2 offset:6272
v_fma_f32 v91,v91,s36,v15
v_mfma_f32_16x16x32_bf16 v[212:215],a[124:127],v[24:27],0
ds_read_b64_tr_b16 a[140:141],v3 offset:128
v_fma_f32 v96,v96,s36,v16
v_mfma_f32_16x16x32_bf16 v[208:211],a[120:123],v[24:27],0
ds_read_b64_tr_b16 a[142:143],v3 offset:6272
v_fma_f32 v97,v97,s36,v16
v_mfma_f32_16x16x32_bf16 v[112:115],a[120:123],v[28:31],0
ds_read_b64_tr_b16 a[144:145],v4 offset:128
v_fma_f32 v98,v98,s36,v16
v_mfma_f32_16x16x32_bf16 v[116:119],a[124:127],v[28:31],0
ds_read_b64_tr_b16 a[146:147],v4 offset:6272
v_fma_f32 v99,v99,s36,v16
v_mfma_f32_16x16x32_bf16 a[164:167],a[124:127],v[32:35],0
ds_read_b64_tr_b16 a[148:149],v5 offset:128
v_fma_f32 v104,v104,s36,v17
v_mfma_f32_16x16x32_bf16 a[160:163],a[120:123],v[32:35],0
ds_read_b64_tr_b16 a[150:151],v5 offset:6272
v_fma_f32 v105,v105,s36,v17
v_mfma_f32_16x16x32_bf16 a[208:211],a[120:123],v[36:39],0
ds_read_b64_tr_b16 a[120:121],v2 offset:256
v_fma_f32 v106,v106,s36,v17
v_mfma_f32_16x16x32_bf16 a[212:215],a[124:127],v[36:39],0
s_waitcnt lgkmcnt(6)
ds_read_b64_tr_b16 a[122:123],v2 offset:6400
v_fma_f32 v107,v107,s36,v17
v_mfma_f32_16x16x32_bf16 a[216:219],a[128:131],v[36:39],0
ds_read_b64_tr_b16 a[124:125],v3 offset:256
v_fma_f32 v76,v76,s36,v13
v_mfma_f32_16x16x32_bf16 a[220:223],a[132:135],v[36:39],0
ds_read_b64_tr_b16 a[126:127],v3 offset:6400
v_fma_f32 v77,v77,s36,v13
v_mfma_f32_16x16x32_bf16 a[172:175],a[132:135],v[32:35],0
v_exp_f32 v90,v90
v_mfma_f32_16x16x32_bf16 a[168:171],a[128:131],v[32:35],0
v_exp_f32 v91,v91
v_mfma_f32_16x16x32_bf16 v[120:123],a[128:131],v[28:31],0
v_cvt_pk_bf16_f32 v53,v90,v91
v_fma_f32 v78,v78,s36,v13
v_mfma_f32_16x16x32_bf16 v[124:127],a[132:135],v[28:31],0
v_exp_f32 v96,v96
v_mfma_f32_16x16x32_bf16 v[220:223],a[132:135],v[24:27],0
v_exp_f32 v97,v97
v_mfma_f32_16x16x32_bf16 v[216:219],a[128:131],v[24:27],0
v_exp_f32 v98,v98
v_mfma_f32_16x16x32_bf16 v[168:171],a[128:131],v[20:23],0
ds_read_b64_tr_b16 a[128:129],v4 offset:256
v_cvt_pk_bf16_f32 v56,v96,v97
v_mfma_f32_16x16x32_bf16 v[172:175],a[132:135],v[20:23],0
ds_read_b64_tr_b16 a[130:131],v4 offset:6400
v_fma_f32 v79,v79,s36,v13
v_mfma_f32_16x16x32_bf16 v[176:179],a[136:139],v[20:23],0
s_waitcnt lgkmcnt(2)
ds_read_b64_tr_b16 a[132:133],v5 offset:256
v_fma_f32 v84,v84,s36,v14
v_mfma_f32_16x16x32_bf16 v[180:183],a[140:143],v[20:23],0
ds_read_b64_tr_b16 a[134:135],v5 offset:6400
v_fma_f32 v85,v85,s36,v14
v_mfma_f32_16x16x32_bf16 v[228:231],a[140:143],v[24:27],0
v_exp_f32 v99,v99
v_mfma_f32_16x16x32_bf16 v[224:227],a[136:139],v[24:27],0
v_cvt_pk_bf16_f32 v57,v98,v99
v_fma_f32 v86,v86,s36,v14
v_mfma_f32_16x16x32_bf16 v[128:131],a[136:139],v[28:31],0
v_exp_f32 v104,v104
v_mfma_f32_16x16x32_bf16 v[132:135],a[140:143],v[28:31],0
v_exp_f32 v105,v105
v_mfma_f32_16x16x32_bf16 a[180:183],a[140:143],v[32:35],0
v_exp_f32 v106,v106
v_mfma_f32_16x16x32_bf16 a[176:179],a[136:139],v[32:35],0
v_exp_f32 v107,v107
v_mfma_f32_16x16x32_bf16 a[224:227],a[136:139],v[36:39],0
v_cvt_pk_bf16_f32 v40,v104,v105
v_cvt_pk_bf16_f32 v41,v106,v107
v_mfma_f32_16x16x32_bf16 a[228:231],a[140:143],v[36:39],0
v_exp_f32 v76,v76
v_mfma_f32_16x16x32_bf16 a[232:235],a[144:147],v[36:39],0
v_exp_f32 v77,v77
v_mfma_f32_16x16x32_bf16 a[236:239],a[148:151],v[36:39],0
v_exp_f32 v78,v78
v_mfma_f32_16x16x32_bf16 a[188:191],a[148:151],v[32:35],0
v_exp_f32 v79,v79
v_mfma_f32_16x16x32_bf16 a[184:187],a[144:147],v[32:35],0
v_cvt_pk_bf16_f32 v46,v76,v77
v_cvt_pk_bf16_f32 v47,v78,v79
v_mfma_f32_16x16x32_bf16 v[136:139],a[144:147],v[28:31],0
v_fma_f32 v87,v87,s36,v14
v_fma_f32 v92,v92,s36,v15
v_mfma_f32_16x16x32_bf16 v[140:143],a[148:151],v[28:31],0
v_exp_f32 v84,v84
v_mfma_f32_16x16x32_bf16 v[236:239],a[148:151],v[24:27],0
v_exp_f32 v85,v85
v_mfma_f32_16x16x32_bf16 v[232:235],a[144:147],v[24:27],0
v_exp_f32 v86,v86
v_mfma_f32_16x16x32_bf16 v[184:187],a[144:147],v[20:23],0
v_exp_f32 v87,v87
v_mfma_f32_16x16x32_bf16 v[188:191],a[148:151],v[20:23],0
v_cvt_pk_bf16_f32 v50,v84,v85
v_cvt_pk_bf16_f32 v51,v86,v87
v_mfma_f32_16x16x32_bf16 v[192:195],a[120:123],v[20:23],0
s_waitcnt vmcnt(36) lgkmcnt(0)
v_fma_f32 v93,v93,s36,v15
v_fma_f32 v94,v94,s36,v15
v_smfmac_f32_16x16x64_bf16 v[60:63],a[152:155],v[44:51],v18
s_barrier
v_mfma_f32_16x16x32_bf16 v[196:199],a[124:127],v[20:23],0
ds_read_b128 a[136:139],v0 offset:24576
v_fma_f32 v95,v95,s36,v15
v_mfma_f32_16x16x32_bf16 v[244:247],a[124:127],v[24:27],0
ds_read_b128 a[140:143],v1 offset:24576
v_fma_f32 v100,v100,s36,v16
v_mfma_f32_16x16x32_bf16 v[240:243],a[120:123],v[24:27],0
ds_read_b128 a[144:147],v0 offset:24704
v_fma_f32 v101,v101,s36,v16
v_mfma_f32_16x16x32_bf16 v[144:147],a[120:123],v[28:31],0
ds_read_b128 a[148:151],v1 offset:24704
v_fma_f32 v102,v102,s36,v16
v_mfma_f32_16x16x32_bf16 v[148:151],a[124:127],v[28:31],0
v_exp_f32 v92,v92
v_mfma_f32_16x16x32_bf16 a[196:199],a[124:127],v[32:35],0
buffer_load_dwordx4 v6,s[8:11],s21 offen offset:0 lds
v_mfma_f32_16x16x32_bf16 a[192:195],a[120:123],v[32:35],0
v_exp_f32 v93,v93
v_mfma_f32_16x16x32_bf16 a[240:243],a[120:123],v[36:39],0
ds_read_b128 a[120:123],v0 offset:24832
v_cvt_pk_bf16_f32 v54,v92,v93
v_mfma_f32_16x16x32_bf16 a[244:247],a[124:127],v[36:39],0
ds_read_b128 a[124:127],v1 offset:24832
v_fma_f32 v103,v103,s36,v16
v_mfma_f32_16x16x32_bf16 a[248:251],a[128:131],v[36:39],0
v_exp_f32 v94,v94
v_mfma_f32_16x16x32_bf16 a[252:255],a[132:135],v[36:39],0
v_exp_f32 v95,v95
v_mfma_f32_16x16x32_bf16 a[204:207],a[132:135],v[32:35],0
v_cvt_pk_bf16_f32 v55,v94,v95
v_fma_f32 v108,v108,s36,v17
v_mfma_f32_16x16x32_bf16 a[200:203],a[128:131],v[32:35],0
v_exp_f32 v100,v100
v_mfma_f32_16x16x32_bf16 v[152:155],a[128:131],v[28:31],0
v_exp_f32 v101,v101
v_mfma_f32_16x16x32_bf16 v[156:159],a[132:135],v[28:31],0
v_exp_f32 v102,v102
v_mfma_f32_16x16x32_bf16 v[252:255],a[132:135],v[24:27],0
v_exp_f32 v103,v103
v_mfma_f32_16x16x32_bf16 v[248:251],a[128:131],v[24:27],0
buffer_load_dwordx4 v7,s[8:11],s21 offen offset:1024 lds
v_mfma_f32_16x16x32_bf16 v[200:203],a[128:131],v[20:23],0
ds_read_b128 a[128:131],v0 offset:30720
v_cvt_pk_bf16_f32 v58,v100,v101
v_mfma_f32_16x16x32_bf16 v[204:207],a[132:135],v[20:23],0
s_waitcnt lgkmcnt(1)
ds_read_b128 a[132:135],v1 offset:30720
v_cvt_pk_bf16_f32 v59,v102,v103
v_mfma_f32_16x16x32_bf16 v[72:75],a[136:139],a[0:3],0
v_fma_f32 v109,v109,s36,v17
v_fma_f32 v110,v110,s36,v17
v_smfmac_f32_16x16x64_bf16 v[64:67],a[152:155],v[52:59],v18
v_fma_f32 v111,v111,s36,v17
v_mfma_f32_16x16x32_bf16 v[72:75],a[140:143],a[4:7],v[72:75]
v_exp_f32 v108,v108
v_mfma_f32_16x16x32_bf16 v[72:75],a[144:147],a[8:11],v[72:75]
v_exp_f32 v109,v109
v_mfma_f32_16x16x32_bf16 v[72:75],a[148:151],a[12:15],v[72:75]
v_exp_f32 v110,v110
v_mfma_f32_16x16x32_bf16 v[72:75],a[120:123],a[16:19],v[72:75]
v_exp_f32 v111,v111
v_mfma_f32_16x16x32_bf16 v[72:75],a[124:127],a[20:23],v[72:75]
v_cvt_pk_bf16_f32 v42,v108,v109
v_cvt_pk_bf16_f32 v43,v110,v111
v_mfma_f32_16x16x32_bf16 v[80:83],a[124:127],a[44:47],0
v_mfma_f32_16x16x32_bf16 v[80:83],a[120:123],a[40:43],v[80:83]
v_smfmac_f32_16x16x64_bf16 v[68:71],a[152:155],v[36:43],v18
buffer_load_dwordx4 v8,s[8:11],s21 offen offset:2048 lds
v_mfma_f32_16x16x32_bf16 v[80:83],a[148:151],a[36:39],v[80:83]
s_add_u32 s21,s21,12288
v_fma_f32 v72,v72,s36,v13
v_fma_f32 v73,v73,s36,v13
v_mfma_f32_16x16x32_bf16 v[80:83],a[144:147],a[32:35],v[80:83]
s_add_u32 m0,s22,12288
v_fma_f32 v74,v74,s36,v13
v_fma_f32 v75,v75,s36,v13
v_mfma_f32_16x16x32_bf16 v[80:83],a[140:143],a[28:31],v[80:83]
v_exp_f32 v72,v72
v_mfma_f32_16x16x32_bf16 v[80:83],a[136:139],a[24:27],v[80:83]
v_exp_f32 v73,v73
v_mfma_f32_16x16x32_bf16 v[88:91],a[136:139],a[48:51],0
v_exp_f32 v74,v74
v_mfma_f32_16x16x32_bf16 v[88:91],a[140:143],a[52:55],v[88:91]
v_exp_f32 v75,v75
v_mfma_f32_16x16x32_bf16 v[88:91],a[144:147],a[56:59],v[88:91]
v_cvt_pk_bf16_f32 v20,v72,v73
v_cvt_pk_bf16_f32 v21,v74,v75
v_mfma_f32_16x16x32_bf16 v[88:91],a[148:151],a[60:63],v[88:91]
v_fma_f32 v80,v80,s36,v14
v_fma_f32 v81,v81,s36,v14
v_mfma_f32_16x16x32_bf16 v[88:91],a[120:123],a[64:67],v[88:91]
v_fma_f32 v82,v82,s36,v14
v_fma_f32 v83,v83,s36,v14
v_mfma_f32_16x16x32_bf16 v[88:91],a[124:127],a[68:71],v[88:91]
v_exp_f32 v80,v80
v_mfma_f32_16x16x32_bf16 v[96:99],a[124:127],a[92:95],0
buffer_load_dwordx4 v6,s[4:7],s20 offen offset:0 lds
v_mfma_f32_16x16x32_bf16 v[96:99],a[120:123],a[88:91],v[96:99]
v_exp_f32 v81,v81
v_mfma_f32_16x16x32_bf16 v[96:99],a[148:151],a[84:87],v[96:99]
v_exp_f32 v82,v82
v_mfma_f32_16x16x32_bf16 v[96:99],a[144:147],a[80:83],v[96:99]
v_fma_f32 v88,v88,s36,v15
v_fma_f32 v89,v89,s36,v15
v_mfma_f32_16x16x32_bf16 v[96:99],a[140:143],a[76:79],v[96:99]
v_exp_f32 v83,v83
v_mfma_f32_16x16x32_bf16 v[96:99],a[136:139],a[72:75],v[96:99]
v_exp_f32 v88,v88
v_mfma_f32_16x16x32_bf16 v[104:107],a[136:139],a[96:99],0
ds_read_b128 a[136:139],v0 offset:30848
v_cvt_pk_bf16_f32 v24,v80,v81
v_mfma_f32_16x16x32_bf16 v[104:107],a[140:143],a[100:103],v[104:107]
ds_read_b128 a[140:143],v1 offset:30848
v_cvt_pk_bf16_f32 v25,v82,v83
v_mfma_f32_16x16x32_bf16 v[104:107],a[144:147],a[104:107],v[104:107]
ds_read_b128 a[144:147],v0 offset:30976
v_mfma_f32_16x16x32_bf16 v[104:107],a[148:151],a[108:111],v[104:107]
ds_read_b128 a[148:151],v1 offset:30976
v_mfma_f32_16x16x32_bf16 v[104:107],a[120:123],a[112:115],v[104:107]
v_exp_f32 v89,v89
v_mfma_f32_16x16x32_bf16 v[104:107],a[124:127],a[116:119],v[104:107]
s_waitcnt lgkmcnt(4)
v_cvt_pk_bf16_f32 v28,v88,v89
v_mfma_f32_16x16x32_bf16 v[76:79],a[128:131],a[0:3],0
buffer_load_dwordx4 v7,s[4:7],s20 offen offset:1024 lds
v_mfma_f32_16x16x32_bf16 v[76:79],a[132:135],a[4:7],v[76:79]
s_waitcnt lgkmcnt(3)
v_mfma_f32_16x16x32_bf16 v[76:79],a[136:139],a[8:11],v[76:79]
s_waitcnt lgkmcnt(2)
v_mfma_f32_16x16x32_bf16 v[76:79],a[140:143],a[12:15],v[76:79]
s_waitcnt lgkmcnt(1)
v_mfma_f32_16x16x32_bf16 v[76:79],a[144:147],a[16:19],v[76:79]
s_waitcnt lgkmcnt(0)
v_mfma_f32_16x16x32_bf16 v[76:79],a[148:151],a[20:23],v[76:79]
v_mfma_f32_16x16x32_bf16 v[84:87],a[148:151],a[44:47],0
v_mfma_f32_16x16x32_bf16 v[84:87],a[144:147],a[40:43],v[84:87]
v_mfma_f32_16x16x32_bf16 v[84:87],a[140:143],a[36:39],v[84:87]
v_mfma_f32_16x16x32_bf16 v[84:87],a[136:139],a[32:35],v[84:87]
v_mfma_f32_16x16x32_bf16 v[84:87],a[132:135],a[28:31],v[84:87]
v_mfma_f32_16x16x32_bf16 v[84:87],a[128:131],a[24:27],v[84:87]
v_mfma_f32_16x16x32_bf16 v[92:95],a[128:131],a[48:51],0
buffer_load_dwordx4 v8,s[4:7],s20 offen offset:2048 lds
v_mfma_f32_16x16x32_bf16 v[92:95],a[132:135],a[52:55],v[92:95]
s_add_u32 s20,s20,12288
v_mfma_f32_16x16x32_bf16 v[92:95],a[136:139],a[56:59],v[92:95]
v_mfma_f32_16x16x32_bf16 v[92:95],a[140:143],a[60:63],v[92:95]
v_mfma_f32_16x16x32_bf16 v[92:95],a[144:147],a[64:67],v[92:95]
v_mfma_f32_16x16x32_bf16 v[92:95],a[148:151],a[68:71],v[92:95]
ds_read_b64_tr_b16 a[120:121],v2 offset:12288
v_mfma_f32_16x16x32_bf16 v[100:103],a[148:151],a[92:95],0
ds_read_b64_tr_b16 a[122:123],v2 offset:18432
v_mfma_f32_16x16x32_bf16 v[100:103],a[144:147],a[88:91],v[100:103]
v_mfma_f32_16x16x32_bf16 v[100:103],a[140:143],a[84:87],v[100:103]
ds_read_b64_tr_b16 a[124:125],v3 offset:12288
v_mfma_f32_16x16x32_bf16 v[100:103],a[136:139],a[80:83],v[100:103]
ds_read_b64_tr_b16 a[126:127],v3 offset:18432
v_mfma_f32_16x16x32_bf16 v[100:103],a[132:135],a[76:79],v[100:103]
v_mfma_f32_16x16x32_bf16 v[100:103],a[128:131],a[72:75],v[100:103]
v_mfma_f32_16x16x32_bf16 v[108:111],a[128:131],a[96:99],0
ds_read_b64_tr_b16 a[128:129],v4 offset:12288
v_mfma_f32_16x16x32_bf16 v[108:111],a[132:135],a[100:103],v[108:111]
ds_read_b64_tr_b16 a[130:131],v4 offset:18432
v_mfma_f32_16x16x32_bf16 v[108:111],a[136:139],a[104:107],v[108:111]
ds_read_b64_tr_b16 a[132:133],v5 offset:12288
v_mfma_f32_16x16x32_bf16 v[108:111],a[140:143],a[108:111],v[108:111]
ds_read_b64_tr_b16 a[134:135],v5 offset:18432
v_mfma_f32_16x16x32_bf16 v[108:111],a[144:147],a[112:115],v[108:111]
v_mfma_f32_16x16x32_bf16 v[108:111],a[148:151],a[116:119],v[108:111]
s_waitcnt lgkmcnt(4)
v_mfma_f32_16x16x32_bf16 v[160:163],a[120:123],v[44:47],v[160:163]
s_add_u32 m0,s23,12288
ds_read_b64_tr_b16 a[136:137],v2 offset:12416
v_fma_f32 v90,v90,s36,v15
v_mfma_f32_16x16x32_bf16 v[164:167],a[124:127],v[44:47],v[164:167]
ds_read_b64_tr_b16 a[138:139],v2 offset:18560
v_fma_f32 v91,v91,s36,v15
v_mfma_f32_16x16x32_bf16 v[212:215],a[124:127],v[48:51],v[212:215]
ds_read_b64_tr_b16 a[140:141],v3 offset:12416
v_fma_f32 v96,v96,s36,v16
v_mfma_f32_16x16x32_bf16 v[208:211],a[120:123],v[48:51],v[208:211]
ds_read_b64_tr_b16 a[142:143],v3 offset:18560
v_fma_f32 v97,v97,s36,v16
v_mfma_f32_16x16x32_bf16 v[112:115],a[120:123],v[52:55],v[112:115]
ds_read_b64_tr_b16 a[144:145],v4 offset:12416
v_fma_f32 v98,v98,s36,v16
v_mfma_f32_16x16x32_bf16 v[116:119],a[124:127],v[52:55],v[116:119]
ds_read_b64_tr_b16 a[146:147],v4 offset:18560
v_fma_f32 v99,v99,s36,v16
v_mfma_f32_16x16x32_bf16 a[164:167],a[124:127],v[56:59],a[164:167]
ds_read_b64_tr_b16 a[148:149],v5 offset:12416
v_fma_f32 v104,v104,s36,v17
v_mfma_f32_16x16x32_bf16 a[160:163],a[120:123],v[56:59],a[160:163]
ds_read_b64_tr_b16 a[150:151],v5 offset:18560
v_fma_f32 v105,v105,s36,v17
v_mfma_f32_16x16x32_bf16 a[208:211],a[120:123],v[40:43],a[208:211]
ds_read_b64_tr_b16 a[120:121],v2 offset:12544
v_fma_f32 v106,v106,s36,v17
v_mfma_f32_16x16x32_bf16 a[212:215],a[124:127],v[40:43],a[212:215]
s_waitcnt lgkmcnt(6)
ds_read_b64_tr_b16 a[122:123],v2 offset:18688
v_fma_f32 v107,v107,s36,v17
v_mfma_f32_16x16x32_bf16 a[216:219],a[128:131],v[40:43],a[216:219]
ds_read_b64_tr_b16 a[124:125],v3 offset:12544
v_fma_f32 v76,v76,s36,v13
v_mfma_f32_16x16x32_bf16 a[220:223],a[132:135],v[40:43],a[220:223]
ds_read_b64_tr_b16 a[126:127],v3 offset:18688
v_fma_f32 v77,v77,s36,v13
v_mfma_f32_16x16x32_bf16 a[172:175],a[132:135],v[56:59],a[172:175]
v_exp_f32 v90,v90
v_mfma_f32_16x16x32_bf16 a[168:171],a[128:131],v[56:59],a[168:171]
v_exp_f32 v91,v91
v_mfma_f32_16x16x32_bf16 v[120:123],a[128:131],v[52:55],v[120:123]
v_cvt_pk_bf16_f32 v29,v90,v91
v_fma_f32 v78,v78,s36,v13
v_mfma_f32_16x16x32_bf16 v[124:127],a[132:135],v[52:55],v[124:127]
v_exp_f32 v96,v96
v_mfma_f32_16x16x32_bf16 v[220:223],a[132:135],v[48:51],v[220:223]
v_exp_f32 v97,v97
v_mfma_f32_16x16x32_bf16 v[216:219],a[128:131],v[48:51],v[216:219]
v_exp_f32 v98,v98
v_mfma_f32_16x16x32_bf16 v[168:171],a[128:131],v[44:47],v[168:171]
ds_read_b64_tr_b16 a[128:129],v4 offset:12544
v_cvt_pk_bf16_f32 v32,v96,v97
v_mfma_f32_16x16x32_bf16 v[172:175],a[132:135],v[44:47],v[172:175]
ds_read_b64_tr_b16 a[130:131],v4 offset:18688
v_fma_f32 v79,v79,s36,v13
v_mfma_f32_16x16x32_bf16 v[176:179],a[136:139],v[44:47],v[176:179]
s_waitcnt lgkmcnt(2)
ds_read_b64_tr_b16 a[132:133],v5 offset:12544
v_fma_f32 v84,v84,s36,v14
v_mfma_f32_16x16x32_bf16 v[180:183],a[140:143],v[44:47],v[180:183]
ds_read_b64_tr_b16 a[134:135],v5 offset:18688
v_fma_f32 v85,v85,s36,v14
v_mfma_f32_16x16x32_bf16 v[228:231],a[140:143],v[48:51],v[228:231]
v_exp_f32 v99,v99
v_mfma_f32_16x16x32_bf16 v[224:227],a[136:139],v[48:51],v[224:227]
v_cvt_pk_bf16_f32 v33,v98,v99
v_fma_f32 v86,v86,s36,v14
v_mfma_f32_16x16x32_bf16 v[128:131],a[136:139],v[52:55],v[128:131]
v_exp_f32 v104,v104
v_mfma_f32_16x16x32_bf16 v[132:135],a[140:143],v[52:55],v[132:135]
v_exp_f32 v105,v105
v_mfma_f32_16x16x32_bf16 a[180:183],a[140:143],v[56:59],a[180:183]
v_exp_f32 v106,v106
v_mfma_f32_16x16x32_bf16 a[176:179],a[136:139],v[56:59],a[176:179]
v_exp_f32 v107,v107
v_mfma_f32_16x16x32_bf16 a[224:227],a[136:139],v[40:43],a[224:227]
v_cvt_pk_bf16_f32 v36,v104,v105
v_cvt_pk_bf16_f32 v37,v106,v107
v_mfma_f32_16x16x32_bf16 a[228:231],a[140:143],v[40:43],a[228:231]
v_exp_f32 v76,v76
v_mfma_f32_16x16x32_bf16 a[232:235],a[144:147],v[40:43],a[232:235]
v_exp_f32 v77,v77
v_mfma_f32_16x16x32_bf16 a[236:239],a[148:151],v[40:43],a[236:239]
v_exp_f32 v78,v78
v_mfma_f32_16x16x32_bf16 a[188:191],a[148:151],v[56:59],a[188:191]
v_exp_f32 v79,v79
v_mfma_f32_16x16x32_bf16 a[184:187],a[144:147],v[56:59],a[184:187]
v_cvt_pk_bf16_f32 v22,v76,v77
v_cvt_pk_bf16_f32 v23,v78,v79
v_mfma_f32_16x16x32_bf16 v[136:139],a[144:147],v[52:55],v[136:139]
v_fma_f32 v87,v87,s36,v14
v_fma_f32 v92,v92,s36,v15
v_mfma_f32_16x16x32_bf16 v[140:143],a[148:151],v[52:55],v[140:143]
v_exp_f32 v84,v84
v_mfma_f32_16x16x32_bf16 v[236:239],a[148:151],v[48:51],v[236:239]
v_exp_f32 v85,v85
v_mfma_f32_16x16x32_bf16 v[232:235],a[144:147],v[48:51],v[232:235]
v_exp_f32 v86,v86
v_mfma_f32_16x16x32_bf16 v[184:187],a[144:147],v[44:47],v[184:187]
v_exp_f32 v87,v87
v_mfma_f32_16x16x32_bf16 v[188:191],a[148:151],v[44:47],v[188:191]
v_cvt_pk_bf16_f32 v26,v84,v85
v_cvt_pk_bf16_f32 v27,v86,v87
v_mfma_f32_16x16x32_bf16 v[192:195],a[120:123],v[44:47],v[192:195]
s_waitcnt vmcnt(6) lgkmcnt(0)
v_fma_f32 v93,v93,s36,v15
v_fma_f32 v94,v94,s36,v15
v_smfmac_f32_16x16x64_bf16 v[60:63],a[152:155],v[20:27],v18
s_barrier
v_mfma_f32_16x16x32_bf16 v[196:199],a[124:127],v[44:47],v[196:199]
ds_read_b128 a[136:139],v0 offset:0
v_fma_f32 v95,v95,s36,v15
v_mfma_f32_16x16x32_bf16 v[244:247],a[124:127],v[48:51],v[244:247]
ds_read_b128 a[140:143],v1 offset:0
v_fma_f32 v100,v100,s36,v16
v_mfma_f32_16x16x32_bf16 v[240:243],a[120:123],v[48:51],v[240:243]
ds_read_b128 a[144:147],v0 offset:128
v_fma_f32 v101,v101,s36,v16
v_mfma_f32_16x16x32_bf16 v[144:147],a[120:123],v[52:55],v[144:147]
ds_read_b128 a[148:151],v1 offset:128
v_fma_f32 v102,v102,s36,v16
v_mfma_f32_16x16x32_bf16 v[148:151],a[124:127],v[52:55],v[148:151]
v_exp_f32 v92,v92
v_mfma_f32_16x16x32_bf16 a[196:199],a[124:127],v[56:59],a[196:199]
buffer_load_dwordx4 v6,s[8:11],s21 offen offset:0 lds
v_mfma_f32_16x16x32_bf16 a[192:195],a[120:123],v[56:59],a[192:195]
v_exp_f32 v93,v93
v_mfma_f32_16x16x32_bf16 a[240:243],a[120:123],v[40:43],a[240:243]
ds_read_b128 a[120:123],v0 offset:256
v_cvt_pk_bf16_f32 v30,v92,v93
v_mfma_f32_16x16x32_bf16 a[244:247],a[124:127],v[40:43],a[244:247]
ds_read_b128 a[124:127],v1 offset:256
v_fma_f32 v103,v103,s36,v16
v_mfma_f32_16x16x32_bf16 a[248:251],a[128:131],v[40:43],a[248:251]
v_exp_f32 v94,v94
v_mfma_f32_16x16x32_bf16 a[252:255],a[132:135],v[40:43],a[252:255]
v_exp_f32 v95,v95
v_mfma_f32_16x16x32_bf16 a[204:207],a[132:135],v[56:59],a[204:207]
v_cvt_pk_bf16_f32 v31,v94,v95
v_fma_f32 v108,v108,s36,v17
v_mfma_f32_16x16x32_bf16 a[200:203],a[128:131],v[56:59],a[200:203]
v_exp_f32 v100,v100
v_mfma_f32_16x16x32_bf16 v[152:155],a[128:131],v[52:55],v[152:155]
v_exp_f32 v101,v101
v_mfma_f32_16x16x32_bf16 v[156:159],a[132:135],v[52:55],v[156:159]
v_exp_f32 v102,v102
v_mfma_f32_16x16x32_bf16 v[252:255],a[132:135],v[48:51],v[252:255]
v_exp_f32 v103,v103
v_mfma_f32_16x16x32_bf16 v[248:251],a[128:131],v[48:51],v[248:251]
buffer_load_dwordx4 v7,s[8:11],s21 offen offset:1024 lds
v_mfma_f32_16x16x32_bf16 v[200:203],a[128:131],v[44:47],v[200:203]
ds_read_b128 a[128:131],v0 offset:6144
v_cvt_pk_bf16_f32 v34,v100,v101
v_mfma_f32_16x16x32_bf16 v[204:207],a[132:135],v[44:47],v[204:207]
s_waitcnt lgkmcnt(1)
ds_read_b128 a[132:135],v1 offset:6144
v_cvt_pk_bf16_f32 v35,v102,v103
v_mfma_f32_16x16x32_bf16 v[72:75],a[136:139],a[0:3],0
v_fma_f32 v109,v109,s36,v17
v_fma_f32 v110,v110,s36,v17
v_smfmac_f32_16x16x64_bf16 v[64:67],a[152:155],v[28:35],v18
v_fma_f32 v111,v111,s36,v17
v_mfma_f32_16x16x32_bf16 v[72:75],a[140:143],a[4:7],v[72:75]
v_exp_f32 v108,v108
v_mfma_f32_16x16x32_bf16 v[72:75],a[144:147],a[8:11],v[72:75]
v_exp_f32 v109,v109
v_mfma_f32_16x16x32_bf16 v[72:75],a[148:151],a[12:15],v[72:75]
v_exp_f32 v110,v110
v_mfma_f32_16x16x32_bf16 v[72:75],a[120:123],a[16:19],v[72:75]
v_exp_f32 v111,v111
v_mfma_f32_16x16x32_bf16 v[72:75],a[124:127],a[20:23],v[72:75]
v_cvt_pk_bf16_f32 v38,v108,v109
v_cvt_pk_bf16_f32 v39,v110,v111
v_mfma_f32_16x16x32_bf16 v[80:83],a[124:127],a[44:47],0
v_mfma_f32_16x16x32_bf16 v[80:83],a[120:123],a[40:43],v[80:83]
v_mfma_f32_16x16x32_bf16 v[80:83],a[148:151],a[36:39],v[80:83]
buffer_load_dwordx4 v8,s[8:11],s21 offen offset:2048 lds
v_mfma_f32_16x16x32_bf16 v[80:83],a[144:147],a[32:35],v[80:83]
s_add_u32 s21,s21,12288
v_fma_f32 v72,v72,s36,v13
v_fma_f32 v73,v73,s36,v13
v_mfma_f32_16x16x32_bf16 v[80:83],a[140:143],a[28:31],v[80:83]
s_add_u32 m0,s22,24576
v_fma_f32 v74,v74,s36,v13
v_fma_f32 v75,v75,s36,v13
v_mfma_f32_16x16x32_bf16 v[80:83],a[136:139],a[24:27],v[80:83]
v_exp_f32 v72,v72
v_mfma_f32_16x16x32_bf16 v[88:91],a[136:139],a[48:51],0
v_exp_f32 v73,v73
v_mfma_f32_16x16x32_bf16 v[88:91],a[140:143],a[52:55],v[88:91]
v_exp_f32 v74,v74
v_mfma_f32_16x16x32_bf16 v[88:91],a[144:147],a[56:59],v[88:91]
v_exp_f32 v75,v75
v_mfma_f32_16x16x32_bf16 v[88:91],a[148:151],a[60:63],v[88:91]
v_fma_f32 v80,v80,s36,v14
v_fma_f32 v81,v81,s36,v14
v_mfma_f32_16x16x32_bf16 v[88:91],a[120:123],a[64:67],v[88:91]
v_fma_f32 v82,v82,s36,v14
v_fma_f32 v83,v83,s36,v14
v_mfma_f32_16x16x32_bf16 v[88:91],a[124:127],a[68:71],v[88:91]
v_exp_f32 v80,v80
v_mfma_f32_16x16x32_bf16 v[96:99],a[124:127],a[92:95],0
v_exp_f32 v81,v81
v_mfma_f32_16x16x32_bf16 v[96:99],a[120:123],a[88:91],v[96:99]
v_exp_f32 v82,v82
v_mfma_f32_16x16x32_bf16 v[96:99],a[148:151],a[84:87],v[96:99]
buffer_load_dwordx4 v6,s[4:7],s20 offen offset:0 lds
v_mfma_f32_16x16x32_bf16 v[96:99],a[144:147],a[80:83],v[96:99]
v_fma_f32 v88,v88,s36,v15
v_fma_f32 v89,v89,s36,v15
v_mfma_f32_16x16x32_bf16 v[96:99],a[140:143],a[76:79],v[96:99]
v_exp_f32 v83,v83
v_mfma_f32_16x16x32_bf16 v[96:99],a[136:139],a[72:75],v[96:99]
v_exp_f32 v88,v88
v_mfma_f32_16x16x32_bf16 v[104:107],a[136:139],a[96:99],0
ds_read_b128 a[136:139],v0 offset:6272
v_cvt_pk_bf16_f32 v44,v72,v73
v_mfma_f32_16x16x32_bf16 v[104:107],a[140:143],a[100:103],v[104:107]
ds_read_b128 a[140:143],v1 offset:6272
v_cvt_pk_bf16_f32 v45,v74,v75
v_mfma_f32_16x16x32_bf16 v[104:107],a[144:147],a[104:107],v[104:107]
ds_read_b128 a[144:147],v0 offset:6400
v_cvt_pk_bf16_f32 v48,v80,v81
v_mfma_f32_16x16x32_bf16 v[104:107],a[148:151],a[108:111],v[104:107]
ds_read_b128 a[148:151],v1 offset:6400
v_cvt_pk_bf16_f32 v49,v82,v83
v_mfma_f32_16x16x32_bf16 v[104:107],a[120:123],a[112:115],v[104:107]
v_exp_f32 v89,v89
v_mfma_f32_16x16x32_bf16 v[104:107],a[124:127],a[116:119],v[104:107]
s_waitcnt lgkmcnt(4)
v_cvt_pk_bf16_f32 v52,v88,v89
v_mfma_f32_16x16x32_bf16 v[76:79],a[128:131],a[0:3],0
v_mfma_f32_16x16x32_bf16 v[76:79],a[132:135],a[4:7],v[76:79]
buffer_load_dwordx4 v7,s[4:7],s20 offen offset:1024 lds
s_waitcnt lgkmcnt(3)
v_mfma_f32_16x16x32_bf16 v[76:79],a[136:139],a[8:11],v[76:79]
s_waitcnt lgkmcnt(2)
v_mfma_f32_16x16x32_bf16 v[76:79],a[140:143],a[12:15],v[76:79]
s_waitcnt lgkmcnt(1)
v_mfma_f32_16x16x32_bf16 v[76:79],a[144:147],a[16:19],v[76:79]
s_waitcnt lgkmcnt(0)
v_mfma_f32_16x16x32_bf16 v[76:79],a[148:151],a[20:23],v[76:79]
v_mfma_f32_16x16x32_bf16 v[84:87],a[148:151],a[44:47],0
v_mfma_f32_16x16x32_bf16 v[84:87],a[144:147],a[40:43],v[84:87]
v_mfma_f32_16x16x32_bf16 v[84:87],a[140:143],a[36:39],v[84:87]
v_mfma_f32_16x16x32_bf16 v[84:87],a[136:139],a[32:35],v[84:87]
v_mfma_f32_16x16x32_bf16 v[84:87],a[132:135],a[28:31],v[84:87]
v_mfma_f32_16x16x32_bf16 v[84:87],a[128:131],a[24:27],v[84:87]
v_mfma_f32_16x16x32_bf16 v[92:95],a[128:131],a[48:51],0
v_mfma_f32_16x16x32_bf16 v[92:95],a[132:135],a[52:55],v[92:95]
buffer_load_dwordx4 v8,s[4:7],s20 offen offset:2048 lds
v_mfma_f32_16x16x32_bf16 v[92:95],a[136:139],a[56:59],v[92:95]
s_add_u32 s20,s20,12288
v_mfma_f32_16x16x32_bf16 v[92:95],a[140:143],a[60:63],v[92:95]
v_mfma_f32_16x16x32_bf16 v[92:95],a[144:147],a[64:67],v[92:95]
v_mfma_f32_16x16x32_bf16 v[92:95],a[148:151],a[68:71],v[92:95]
v_mfma_f32_16x16x32_bf16 v[100:103],a[148:151],a[92:95],0
v_mfma_f32_16x16x32_bf16 v[100:103],a[144:147],a[88:91],v[100:103]
ds_read_b64_tr_b16 a[120:121],v2 offset:24576
v_mfma_f32_16x16x32_bf16 v[100:103],a[140:143],a[84:87],v[100:103]
ds_read_b64_tr_b16 a[122:123],v2 offset:30720
v_mfma_f32_16x16x32_bf16 v[100:103],a[136:139],a[80:83],v[100:103]
ds_read_b64_tr_b16 a[124:125],v3 offset:24576
v_mfma_f32_16x16x32_bf16 v[100:103],a[132:135],a[76:79],v[100:103]
ds_read_b64_tr_b16 a[126:127],v3 offset:30720
v_mfma_f32_16x16x32_bf16 v[100:103],a[128:131],a[72:75],v[100:103]
v_mfma_f32_16x16x32_bf16 v[108:111],a[128:131],a[96:99],0
ds_read_b64_tr_b16 a[128:129],v4 offset:24576
v_mfma_f32_16x16x32_bf16 v[108:111],a[132:135],a[100:103],v[108:111]
ds_read_b64_tr_b16 a[130:131],v4 offset:30720
v_mfma_f32_16x16x32_bf16 v[108:111],a[136:139],a[104:107],v[108:111]
ds_read_b64_tr_b16 a[132:133],v5 offset:24576
v_mfma_f32_16x16x32_bf16 v[108:111],a[140:143],a[108:111],v[108:111]
ds_read_b64_tr_b16 a[134:135],v5 offset:30720
v_mfma_f32_16x16x32_bf16 v[108:111],a[144:147],a[112:115],v[108:111]
v_mfma_f32_16x16x32_bf16 v[108:111],a[148:151],a[116:119],v[108:111]
s_mov_b32 s38,0
s_branch L_loop5
L_loop4:
.p2align 6
L_loop4w0:
s_waitcnt lgkmcnt(3)
v_mfma_f32_16x16x32_bf16 v[160:163],a[120:123],v[20:23],v[160:163]
ds_read_b128 a[156:159],v10 offset:0
v_fma_f32 v82,v82,s36,v14
v_mfma_f32_16x16x32_bf16 v[164:167],a[124:127],v[20:23],v[164:167]
ds_read_b64_tr_b16 a[136:137],v2 offset:24704
v_fma_f32 v83,v83,s36,v14
v_mfma_f32_16x16x32_bf16 v[212:215],a[124:127],v[24:27],v[212:215]
ds_read_b64_tr_b16 a[138:139],v2 offset:30848
v_fma_f32 v88,v88,s36,v15
v_mfma_f32_16x16x32_bf16 v[208:211],a[120:123],v[24:27],v[208:211]
ds_read_b64_tr_b16 a[140:141],v3 offset:24704
v_fma_f32 v89,v89,s36,v15
v_mfma_f32_16x16x32_bf16 v[112:115],a[120:123],v[28:31],v[112:115]
ds_read_b64_tr_b16 a[142:143],v3 offset:30848
v_fma_f32 v90,v90,s36,v15
v_mfma_f32_16x16x32_bf16 v[116:119],a[124:127],v[28:31],v[116:119]
ds_read_b64_tr_b16 a[144:145],v4 offset:24704
v_fma_f32 v91,v91,s36,v15
v_mfma_f32_16x16x32_bf16 a[164:167],a[124:127],v[32:35],a[164:167]
ds_read_b64_tr_b16 a[146:147],v4 offset:30848
v_fma_f32 v96,v96,s36,v16
v_mfma_f32_16x16x32_bf16 a[160:163],a[120:123],v[32:35],a[160:163]
s_waitcnt lgkmcnt(6)
ds_read_b64_tr_b16 a[148:149],v5 offset:24704
v_fma_f32 v97,v97,s36,v16
v_mfma_f32_16x16x32_bf16 a[168:171],a[128:131],v[32:35],a[168:171]
ds_read_b64_tr_b16 a[150:151],v5 offset:30848
v_fma_f32 v98,v98,s36,v16
v_mfma_f32_16x16x32_bf16 a[172:175],a[132:135],v[32:35],a[172:175]
ds_read_b64_tr_b16 a[120:121],v2 offset:24832
v_fma_f32 v99,v99,s36,v16
v_mfma_f32_16x16x32_bf16 v[124:127],a[132:135],v[28:31],v[124:127]
ds_read_b64_tr_b16 a[122:123],v2 offset:30976
v_fma_f32 v76,v76,s36,v13
v_mfma_f32_16x16x32_bf16 v[120:123],a[128:131],v[28:31],v[120:123]
ds_read_b64_tr_b16 a[124:125],v3 offset:24832
v_fma_f32 v77,v77,s36,v13
v_mfma_f32_16x16x32_bf16 v[216:219],a[128:131],v[24:27],v[216:219]
ds_read_b64_tr_b16 a[126:127],v3 offset:30976
v_fma_f32 v78,v78,s36,v13
v_mfma_f32_16x16x32_bf16 v[220:223],a[132:135],v[24:27],v[220:223]
v_exp_f32 v82,v82
v_mfma_f32_16x16x32_bf16 v[172:175],a[132:135],v[20:23],v[172:175]
ds_read_b64_tr_b16 a[132:133],v5 offset:24832
v_fma_f32 v79,v79,s36,v13
v_mfma_f32_16x16x32_bf16 v[168:171],a[128:131],v[20:23],v[168:171]
s_waitcnt lgkmcnt(5)
ds_read_b64_tr_b16 a[128:129],v4 offset:24832
v_fma_f32 v84,v84,s36,v14
v_mfma_f32_16x16x32_bf16 v[176:179],a[136:139],v[20:23],v[176:179]
buffer_store_dwordx4 a[156:159],v9,s[16:19],s27 offen offset:0 nt
ds_read_b64_tr_b16 a[130:131],v4 offset:30976
ds_read_b128 a[156:159],v10 offset:1024
v_mfma_f32_16x16x32_bf16 v[180:183],a[140:143],v[20:23],v[180:183]
ds_read_b64_tr_b16 a[134:135],v5 offset:30976
v_mfma_f32_16x16x32_bf16 v[228:231],a[140:143],v[24:27],v[228:231]
v_exp_f32 v83,v83
v_mfma_f32_16x16x32_bf16 v[224:227],a[136:139],v[24:27],v[224:227]
v_cvt_pk_bf16_f32 v49,v82,v83
v_fma_f32 v85,v85,s36,v14
v_mfma_f32_16x16x32_bf16 v[128:131],a[136:139],v[28:31],v[128:131]
v_exp_f32 v88,v88
v_mfma_f32_16x16x32_bf16 v[132:135],a[140:143],v[28:31],v[132:135]
v_exp_f32 v89,v89
v_mfma_f32_16x16x32_bf16 a[180:183],a[140:143],v[32:35],a[180:183]
v_exp_f32 v90,v90
v_mfma_f32_16x16x32_bf16 a[176:179],a[136:139],v[32:35],a[176:179]
v_exp_f32 v91,v91
v_mfma_f32_16x16x32_bf16 a[184:187],a[144:147],v[32:35],a[184:187]
s_waitcnt lgkmcnt(1)
buffer_store_dwordx4 a[156:159],v9,s[16:19],s27 offen offset:128 nt
v_cvt_pk_bf16_f32 v52,v88,v89
v_cvt_pk_bf16_f32 v53,v90,v91
v_fma_f32 v86,v86,s36,v14
v_mfma_f32_16x16x32_bf16 a[188:191],a[148:151],v[32:35],a[188:191]
ds_read_b128 a[156:159],v10 offset:2048
v_fma_f32 v87,v87,s36,v14
v_mfma_f32_16x16x32_bf16 v[140:143],a[148:151],v[28:31],v[140:143]
v_exp_f32 v96,v96
v_mfma_f32_16x16x32_bf16 v[136:139],a[144:147],v[28:31],v[136:139]
v_exp_f32 v97,v97
v_mfma_f32_16x16x32_bf16 v[232:235],a[144:147],v[24:27],v[232:235]
v_exp_f32 v98,v98
v_mfma_f32_16x16x32_bf16 v[236:239],a[148:151],v[24:27],v[236:239]
v_exp_f32 v99,v99
v_mfma_f32_16x16x32_bf16 v[188:191],a[148:151],v[20:23],v[188:191]
v_cvt_pk_bf16_f32 v56,v96,v97
v_cvt_pk_bf16_f32 v57,v98,v99
v_mfma_f32_16x16x32_bf16 v[184:187],a[144:147],v[20:23],v[184:187]
v_exp_f32 v76,v76
v_mfma_f32_16x16x32_bf16 v[192:195],a[120:123],v[20:23],v[192:195]
v_exp_f32 v77,v77
v_mfma_f32_16x16x32_bf16 v[196:199],a[124:127],v[20:23],v[196:199]
s_waitcnt lgkmcnt(0)
buffer_store_dwordx4 a[156:159],v9,s[16:19],s27 offen offset:256 nt
v_exp_f32 v78,v78
v_cvt_pk_bf16_f32 v46,v76,v77
v_mfma_f32_16x16x32_bf16 v[244:247],a[124:127],v[24:27],v[244:247]
s_waitcnt vmcnt(9)
v_exp_f32 v79,v79
v_mfma_f32_16x16x32_bf16 v[240:243],a[120:123],v[24:27],v[240:243]
s_barrier
v_mfma_f32_16x16x32_bf16 v[144:147],a[120:123],v[28:31],v[144:147]
s_add_u32 s27,s27,3072
ds_read_b128 a[148:151],v1 offset:12416
v_cvt_pk_bf16_f32 v47,v78,v79
v_mfma_f32_16x16x32_bf16 v[148:151],a[124:127],v[28:31],v[148:151]
s_add_u32 m0,s23,24576
ds_read_b128 a[144:147],v0 offset:12416
v_fma_f32 v92,v92,s36,v15
v_mfma_f32_16x16x32_bf16 a[196:199],a[124:127],v[32:35],a[196:199]
buffer_load_dwordx4 v6,s[8:11],s21 offen offset:0 lds
v_mfma_f32_16x16x32_bf16 a[192:195],a[120:123],v[32:35],a[192:195]
ds_read_b128 a[124:127],v1 offset:12544
v_fma_f32 v93,v93,s36,v15
v_mfma_f32_16x16x32_bf16 a[200:203],a[128:131],v[32:35],a[200:203]
ds_read_b128 a[120:123],v0 offset:12544
v_fma_f32 v94,v94,s36,v15
v_mfma_f32_16x16x32_bf16 a[204:207],a[132:135],v[32:35],a[204:207]
ds_read_b128 a[140:143],v1 offset:12288
v_fma_f32 v95,v95,s36,v15
v_mfma_f32_16x16x32_bf16 v[156:159],a[132:135],v[28:31],v[156:159]
ds_read_b128 a[136:139],v0 offset:12288
v_fma_f32 v100,v100,s36,v16
v_mfma_f32_16x16x32_bf16 v[152:155],a[128:131],v[28:31],v[152:155]
v_exp_f32 v84,v84
v_mfma_f32_16x16x32_bf16 v[248:251],a[128:131],v[24:27],v[248:251]
v_exp_f32 v85,v85
v_mfma_f32_16x16x32_bf16 v[252:255],a[132:135],v[24:27],v[252:255]
buffer_load_dwordx4 v7,s[8:11],s21 offen offset:1024 lds
v_mfma_f32_16x16x32_bf16 v[204:207],a[132:135],v[20:23],v[204:207]
ds_read_b128 a[132:135],v1 offset:18432
v_cvt_pk_bf16_f32 v50,v84,v85
v_mfma_f32_16x16x32_bf16 v[200:203],a[128:131],v[20:23],v[200:203]
s_waitcnt lgkmcnt(3)
ds_read_b128 a[128:131],v0 offset:18432
v_fma_f32 v101,v101,s36,v16
v_mfma_f32_16x16x32_bf16 v[72:75],a[124:127],a[20:23],0
v_exp_f32 v86,v86
v_mfma_f32_16x16x32_bf16 v[72:75],a[120:123],a[16:19],v[72:75]
v_exp_f32 v87,v87
v_mfma_f32_16x16x32_bf16 v[72:75],a[148:151],a[12:15],v[72:75]
v_cvt_pk_bf16_f32 v51,v86,v87
v_fma_f32 v102,v102,s36,v16
v_mfma_f32_16x16x32_bf16 v[72:75],a[144:147],a[8:11],v[72:75]
v_exp_f32 v92,v92
v_smfmac_f32_16x16x64_bf16 v[60:63],a[152:155],v[44:51],v18
s_waitcnt lgkmcnt(2)
v_fma_f32 v103,v103,s36,v16
v_mfma_f32_16x16x32_bf16 v[72:75],a[140:143],a[4:7],v[72:75]
v_exp_f32 v93,v93
v_mfma_f32_16x16x32_bf16 v[72:75],a[136:139],a[0:3],v[72:75]
buffer_load_dwordx4 v8,s[8:11],s21 offen offset:2048 lds
v_mfma_f32_16x16x32_bf16 v[80:83],a[136:139],a[24:27],0
s_add_u32 s21,s21,12288
v_exp_f32 v94,v94
v_mfma_f32_16x16x32_bf16 v[80:83],a[140:143],a[28:31],v[80:83]
s_add_u32 m0,s22,0
v_exp_f32 v95,v95
v_mfma_f32_16x16x32_bf16 v[80:83],a[144:147],a[32:35],v[80:83]
v_cvt_pk_bf16_f32 v54,v92,v93
v_cvt_pk_bf16_f32 v55,v94,v95
v_mfma_f32_16x16x32_bf16 v[80:83],a[148:151],a[36:39],v[80:83]
v_exp_f32 v100,v100
v_mfma_f32_16x16x32_bf16 v[80:83],a[120:123],a[40:43],v[80:83]
v_exp_f32 v101,v101
v_mfma_f32_16x16x32_bf16 v[80:83],a[124:127],a[44:47],v[80:83]
v_exp_f32 v102,v102
v_mfma_f32_16x16x32_bf16 v[88:91],a[124:127],a[68:71],0
v_exp_f32 v103,v103
v_mfma_f32_16x16x32_bf16 v[88:91],a[120:123],a[64:67],v[88:91]
v_cvt_pk_bf16_f32 v58,v100,v101
v_cvt_pk_bf16_f32 v59,v102,v103
v_mfma_f32_16x16x32_bf16 v[88:91],a[148:151],a[60:63],v[88:91]
buffer_load_dwordx4 v6,s[4:7],s20 offen offset:0 lds
v_smfmac_f32_16x16x64_bf16 v[64:67],a[152:155],v[52:59],v18
v_fma_f32 v72,v72,s36,v13
v_mfma_f32_16x16x32_bf16 v[88:91],a[144:147],a[56:59],v[88:91]
v_fma_f32 v73,v73,s36,v13
v_fma_f32 v74,v74,s36,v13
v_mfma_f32_16x16x32_bf16 v[88:91],a[140:143],a[52:55],v[88:91]
v_fma_f32 v75,v75,s36,v13
v_fma_f32 v80,v80,s36,v14
v_mfma_f32_16x16x32_bf16 v[88:91],a[136:139],a[48:51],v[88:91]
v_fma_f32 v81,v81,s36,v14
v_mfma_f32_16x16x32_bf16 v[96:99],a[136:139],a[72:75],0
ds_read_b128 a[136:139],v0 offset:18560
v_mfma_f32_16x16x32_bf16 v[96:99],a[140:143],a[76:79],v[96:99]
ds_read_b128 a[140:143],v1 offset:18560
v_mfma_f32_16x16x32_bf16 v[96:99],a[144:147],a[80:83],v[96:99]
ds_read_b128 a[144:147],v0 offset:18688
v_mfma_f32_16x16x32_bf16 v[96:99],a[148:151],a[84:87],v[96:99]
ds_read_b128 a[148:151],v1 offset:18688
v_mfma_f32_16x16x32_bf16 v[96:99],a[120:123],a[88:91],v[96:99]
buffer_load_dwordx4 v7,s[4:7],s20 offen offset:1024 lds
v_mfma_f32_16x16x32_bf16 v[96:99],a[124:127],a[92:95],v[96:99]
s_waitcnt lgkmcnt(4)
v_exp_f32 v72,v72
v_mfma_f32_16x16x32_bf16 v[76:79],a[128:131],a[0:3],0
v_exp_f32 v73,v73
v_mfma_f32_16x16x32_bf16 v[76:79],a[132:135],a[4:7],v[76:79]
s_waitcnt lgkmcnt(3)
v_exp_f32 v74,v74
v_mfma_f32_16x16x32_bf16 v[76:79],a[136:139],a[8:11],v[76:79]
s_waitcnt lgkmcnt(2)
v_exp_f32 v75,v75
v_mfma_f32_16x16x32_bf16 v[76:79],a[140:143],a[12:15],v[76:79]
s_waitcnt lgkmcnt(0)
v_exp_f32 v80,v80
v_mfma_f32_16x16x32_bf16 v[76:79],a[144:147],a[16:19],v[76:79]
v_exp_f32 v81,v81
v_mfma_f32_16x16x32_bf16 v[76:79],a[148:151],a[20:23],v[76:79]
v_cvt_pk_bf16_f32 v20,v72,v73
v_cvt_pk_bf16_f32 v21,v74,v75
v_mfma_f32_16x16x32_bf16 v[84:87],a[148:151],a[44:47],0
v_cvt_pk_bf16_f32 v24,v80,v81
v_mfma_f32_16x16x32_bf16 v[84:87],a[144:147],a[40:43],v[84:87]
buffer_load_dwordx4 v8,s[4:7],s20 offen offset:2048 lds
v_mfma_f32_16x16x32_bf16 v[84:87],a[140:143],a[36:39],v[84:87]
s_add_u32 s20,s20,12288
v_mfma_f32_16x16x32_bf16 v[84:87],a[136:139],a[32:35],v[84:87]
ds_read_b64_tr_b16 a[120:121],v2 offset:0
v_mfma_f32_16x16x32_bf16 v[84:87],a[132:135],a[28:31],v[84:87]
ds_read_b64_tr_b16 a[122:123],v2 offset:6144
v_mfma_f32_16x16x32_bf16 v[84:87],a[128:131],a[24:27],v[84:87]
ds_read_b64_tr_b16 a[124:125],v3 offset:0
v_mfma_f32_16x16x32_bf16 v[92:95],a[128:131],a[48:51],0
ds_read_b64_tr_b16 a[126:127],v3 offset:6144
v_mfma_f32_16x16x32_bf16 v[92:95],a[132:135],a[52:55],v[92:95]
v_mfma_f32_16x16x32_bf16 v[92:95],a[136:139],a[56:59],v[92:95]
v_mfma_f32_16x16x32_bf16 v[92:95],a[140:143],a[60:63],v[92:95]
v_mfma_f32_16x16x32_bf16 v[92:95],a[144:147],a[64:67],v[92:95]
v_mfma_f32_16x16x32_bf16 v[92:95],a[148:151],a[68:71],v[92:95]
v_mfma_f32_16x16x32_bf16 v[100:103],a[148:151],a[92:95],0
v_mfma_f32_16x16x32_bf16 v[100:103],a[144:147],a[88:91],v[100:103]
v_mfma_f32_16x16x32_bf16 v[100:103],a[140:143],a[84:87],v[100:103]
v_mfma_f32_16x16x32_bf16 v[100:103],a[136:139],a[80:83],v[100:103]
v_mfma_f32_16x16x32_bf16 v[100:103],a[132:135],a[76:79],v[100:103]
ds_read_b64_tr_b16 a[132:133],v5 offset:0
v_mfma_f32_16x16x32_bf16 v[100:103],a[128:131],a[72:75],v[100:103]
s_waitcnt lgkmcnt(1)
ds_read_b64_tr_b16 a[128:129],v4 offset:0
ds_read_b64_tr_b16 a[130:131],v4 offset:6144
ds_read_b64_tr_b16 a[134:135],v5 offset:6144
v_mfma_f32_16x16x32_bf16 v[160:163],a[120:123],v[44:47],v[160:163]
s_add_u32 m0,s29,0
ds_read_b64_tr_b16 a[136:137],v2 offset:128
v_fma_f32 v82,v82,s36,v14
v_mfma_f32_16x16x32_bf16 v[164:167],a[124:127],v[44:47],v[164:167]
ds_read_b64_tr_b16 a[138:139],v2 offset:6272
v_fma_f32 v83,v83,s36,v14
v_mfma_f32_16x16x32_bf16 v[212:215],a[124:127],v[48:51],v[212:215]
ds_read_b64_tr_b16 a[140:141],v3 offset:128
v_fma_f32 v88,v88,s36,v15
v_mfma_f32_16x16x32_bf16 v[208:211],a[120:123],v[48:51],v[208:211]
ds_read_b64_tr_b16 a[142:143],v3 offset:6272
v_fma_f32 v89,v89,s36,v15
v_mfma_f32_16x16x32_bf16 v[112:115],a[120:123],v[52:55],v[112:115]
ds_read_b64_tr_b16 a[144:145],v4 offset:128
v_fma_f32 v90,v90,s36,v15
v_mfma_f32_16x16x32_bf16 v[116:119],a[124:127],v[52:55],v[116:119]
ds_read_b64_tr_b16 a[146:147],v4 offset:6272
v_fma_f32 v91,v91,s36,v15
v_mfma_f32_16x16x32_bf16 a[164:167],a[124:127],v[56:59],a[164:167]
buffer_load_dwordx4 v6,s[12:15],s28 offen offset:0 nt lds
v_mfma_f32_16x16x32_bf16 a[160:163],a[120:123],v[56:59],a[160:163]
s_waitcnt lgkmcnt(5)
ds_read_b64_tr_b16 a[148:149],v5 offset:128
v_fma_f32 v96,v96,s36,v16
v_mfma_f32_16x16x32_bf16 a[168:171],a[128:131],v[56:59],a[168:171]
ds_read_b64_tr_b16 a[150:151],v5 offset:6272
v_fma_f32 v97,v97,s36,v16
v_mfma_f32_16x16x32_bf16 a[172:175],a[132:135],v[56:59],a[172:175]
ds_read_b64_tr_b16 a[120:121],v2 offset:256
v_fma_f32 v98,v98,s36,v16
v_mfma_f32_16x16x32_bf16 v[124:127],a[132:135],v[52:55],v[124:127]
ds_read_b64_tr_b16 a[122:123],v2 offset:6400
v_fma_f32 v99,v99,s36,v16
v_mfma_f32_16x16x32_bf16 v[120:123],a[128:131],v[52:55],v[120:123]
ds_read_b64_tr_b16 a[124:125],v3 offset:256
v_fma_f32 v76,v76,s36,v13
v_mfma_f32_16x16x32_bf16 v[216:219],a[128:131],v[48:51],v[216:219]
ds_read_b64_tr_b16 a[126:127],v3 offset:6400
v_fma_f32 v77,v77,s36,v13
v_mfma_f32_16x16x32_bf16 v[220:223],a[132:135],v[48:51],v[220:223]
buffer_load_dwordx4 v7,s[12:15],s28 offen offset:1024 nt lds
v_mfma_f32_16x16x32_bf16 v[172:175],a[132:135],v[44:47],v[172:175]
ds_read_b64_tr_b16 a[132:133],v5 offset:256
v_fma_f32 v78,v78,s36,v13
v_mfma_f32_16x16x32_bf16 v[168:171],a[128:131],v[44:47],v[168:171]
s_waitcnt lgkmcnt(5)
ds_read_b64_tr_b16 a[128:129],v4 offset:256
v_fma_f32 v79,v79,s36,v13
v_mfma_f32_16x16x32_bf16 v[176:179],a[136:139],v[44:47],v[176:179]
ds_read_b64_tr_b16 a[130:131],v4 offset:6400
v_fma_f32 v84,v84,s36,v14
v_mfma_f32_16x16x32_bf16 v[180:183],a[140:143],v[44:47],v[180:183]
ds_read_b64_tr_b16 a[134:135],v5 offset:6400
v_fma_f32 v85,v85,s36,v14
v_mfma_f32_16x16x32_bf16 v[228:231],a[140:143],v[48:51],v[228:231]
v_exp_f32 v82,v82
v_mfma_f32_16x16x32_bf16 v[224:227],a[136:139],v[48:51],v[224:227]
v_exp_f32 v83,v83
v_mfma_f32_16x16x32_bf16 v[128:131],a[136:139],v[52:55],v[128:131]
v_cvt_pk_bf16_f32 v25,v82,v83
v_fma_f32 v86,v86,s36,v14
v_mfma_f32_16x16x32_bf16 v[132:135],a[140:143],v[52:55],v[132:135]
buffer_load_dwordx4 v8,s[12:15],s28 offen offset:2048 nt lds
v_mfma_f32_16x16x32_bf16 a[180:183],a[140:143],v[56:59],a[180:183]
s_add_u32 s28,s28,3072
v_exp_f32 v88,v88
v_mfma_f32_16x16x32_bf16 a[176:179],a[136:139],v[56:59],a[176:179]
s_add_u32 s29,s29,3072
v_exp_f32 v89,v89
v_mfma_f32_16x16x32_bf16 a[184:187],a[144:147],v[56:59],a[184:187]
s_add_u32 m0,s23,0
v_exp_f32 v90,v90
v_mfma_f32_16x16x32_bf16 a[188:191],a[148:151],v[56:59],a[188:191]
v_exp_f32 v91,v91
v_mfma_f32_16x16x32_bf16 v[140:143],a[148:151],v[52:55],v[140:143]
v_cvt_pk_bf16_f32 v28,v88,v89
v_cvt_pk_bf16_f32 v29,v90,v91
v_mfma_f32_16x16x32_bf16 v[136:139],a[144:147],v[52:55],v[136:139]
v_exp_f32 v96,v96
v_mfma_f32_16x16x32_bf16 v[232:235],a[144:147],v[48:51],v[232:235]
v_exp_f32 v97,v97
v_mfma_f32_16x16x32_bf16 v[236:239],a[148:151],v[48:51],v[236:239]
v_exp_f32 v98,v98
v_mfma_f32_16x16x32_bf16 v[188:191],a[148:151],v[44:47],v[188:191]
v_exp_f32 v99,v99
v_mfma_f32_16x16x32_bf16 v[184:187],a[144:147],v[44:47],v[184:187]
s_waitcnt vmcnt(12)
v_cvt_pk_bf16_f32 v32,v96,v97
v_cvt_pk_bf16_f32 v33,v98,v99
s_waitcnt lgkmcnt(0)
v_mfma_f32_16x16x32_bf16 v[192:195],a[120:123],v[44:47],v[192:195]
s_barrier
v_mfma_f32_16x16x32_bf16 v[196:199],a[124:127],v[44:47],v[196:199]
ds_read_b128 a[148:151],v1 offset:24704
v_fma_f32 v87,v87,s36,v14
v_mfma_f32_16x16x32_bf16 v[244:247],a[124:127],v[48:51],v[244:247]
ds_read_b128 a[144:147],v0 offset:24704
v_fma_f32 v92,v92,s36,v15
v_mfma_f32_16x16x32_bf16 v[240:243],a[120:123],v[48:51],v[240:243]
ds_read_b128 a[140:143],v1 offset:24576
v_fma_f32 v93,v93,s36,v15
v_mfma_f32_16x16x32_bf16 v[144:147],a[120:123],v[52:55],v[144:147]
ds_read_b128 a[136:139],v0 offset:24576
v_fma_f32 v94,v94,s36,v15
v_mfma_f32_16x16x32_bf16 v[148:151],a[124:127],v[52:55],v[148:151]
v_exp_f32 v76,v76
v_mfma_f32_16x16x32_bf16 a[196:199],a[124:127],v[56:59],a[196:199]
buffer_load_dwordx4 v6,s[8:11],s21 offen offset:0 lds
v_mfma_f32_16x16x32_bf16 a[192:195],a[120:123],v[56:59],a[192:195]
ds_read_b128 a[124:127],v1 offset:24832
v_fma_f32 v95,v95,s36,v15
v_mfma_f32_16x16x32_bf16 a[200:203],a[128:131],v[56:59],a[200:203]
ds_read_b128 a[120:123],v0 offset:24832
v_fma_f32 v100,v100,s36,v16
v_mfma_f32_16x16x32_bf16 a[204:207],a[132:135],v[56:59],a[204:207]
v_exp_f32 v77,v77
v_mfma_f32_16x16x32_bf16 v[156:159],a[132:135],v[52:55],v[156:159]
v_exp_f32 v78,v78
v_mfma_f32_16x16x32_bf16 v[152:155],a[128:131],v[52:55],v[152:155]
v_exp_f32 v79,v79
v_mfma_f32_16x16x32_bf16 v[248:251],a[128:131],v[48:51],v[248:251]
v_cvt_pk_bf16_f32 v22,v76,v77
v_cvt_pk_bf16_f32 v23,v78,v79
v_mfma_f32_16x16x32_bf16 v[252:255],a[132:135],v[48:51],v[252:255]
v_exp_f32 v84,v84
v_mfma_f32_16x16x32_bf16 v[204:207],a[132:135],v[44:47],v[204:207]
ds_read_b128 a[132:135],v1 offset:30720
v_fma_f32 v101,v101,s36,v16
v_mfma_f32_16x16x32_bf16 v[200:203],a[128:131],v[44:47],v[200:203]
buffer_load_dwordx4 v7,s[8:11],s21 offen offset:1024 lds
s_waitcnt lgkmcnt(1)
v_mfma_f32_16x16x32_bf16 v[72:75],a[124:127],a[20:23],0
ds_read_b128 a[128:131],v0 offset:30720
v_fma_f32 v102,v102,s36,v16
v_mfma_f32_16x16x32_bf16 v[72:75],a[120:123],a[16:19],v[72:75]
v_exp_f32 v85,v85
v_mfma_f32_16x16x32_bf16 v[72:75],a[148:151],a[12:15],v[72:75]
v_exp_f32 v86,v86
v_mfma_f32_16x16x32_bf16 v[72:75],a[144:147],a[8:11],v[72:75]
v_exp_f32 v87,v87
v_mfma_f32_16x16x32_bf16 v[72:75],a[140:143],a[4:7],v[72:75]
v_cvt_pk_bf16_f32 v26,v84,v85
v_cvt_pk_bf16_f32 v27,v86,v87
v_mfma_f32_16x16x32_bf16 v[72:75],a[136:139],a[0:3],v[72:75]
v_exp_f32 v92,v92
v_smfmac_f32_16x16x64_bf16 v[60:63],a[152:155],v[20:27],v18
v_fma_f32 v103,v103,s36,v16
v_mfma_f32_16x16x32_bf16 v[80:83],a[136:139],a[24:27],0
v_exp_f32 v93,v93
v_mfma_f32_16x16x32_bf16 v[80:83],a[140:143],a[28:31],v[80:83]
buffer_load_dwordx4 v8,s[8:11],s21 offen offset:2048 lds
v_mfma_f32_16x16x32_bf16 v[80:83],a[144:147],a[32:35],v[80:83]
s_add_u32 s21,s21,12288
v_exp_f32 v94,v94
v_mfma_f32_16x16x32_bf16 v[80:83],a[148:151],a[36:39],v[80:83]
s_add_u32 m0,s22,12288
v_exp_f32 v95,v95
v_mfma_f32_16x16x32_bf16 v[80:83],a[120:123],a[40:43],v[80:83]
v_cvt_pk_bf16_f32 v30,v92,v93
v_cvt_pk_bf16_f32 v31,v94,v95
v_mfma_f32_16x16x32_bf16 v[80:83],a[124:127],a[44:47],v[80:83]
v_exp_f32 v100,v100
v_mfma_f32_16x16x32_bf16 v[88:91],a[124:127],a[68:71],0
v_exp_f32 v101,v101
v_mfma_f32_16x16x32_bf16 v[88:91],a[120:123],a[64:67],v[88:91]
v_exp_f32 v102,v102
v_mfma_f32_16x16x32_bf16 v[88:91],a[148:151],a[60:63],v[88:91]
v_exp_f32 v103,v103
v_mfma_f32_16x16x32_bf16 v[88:91],a[144:147],a[56:59],v[88:91]
v_cvt_pk_bf16_f32 v34,v100,v101
v_cvt_pk_bf16_f32 v35,v102,v103
v_mfma_f32_16x16x32_bf16 v[88:91],a[140:143],a[52:55],v[88:91]
buffer_load_dwordx4 v6,s[4:7],s20 offen offset:0 lds
v_smfmac_f32_16x16x64_bf16 v[64:67],a[152:155],v[28:35],v18
v_fma_f32 v72,v72,s36,v13
v_mfma_f32_16x16x32_bf16 v[88:91],a[136:139],a[48:51],v[88:91]
v_fma_f32 v73,v73,s36,v13
v_fma_f32 v74,v74,s36,v13
v_mfma_f32_16x16x32_bf16 v[96:99],a[136:139],a[72:75],0
ds_read_b128 a[136:139],v0 offset:30848
v_fma_f32 v75,v75,s36,v13
v_mfma_f32_16x16x32_bf16 v[96:99],a[140:143],a[76:79],v[96:99]
ds_read_b128 a[140:143],v1 offset:30848
v_fma_f32 v80,v80,s36,v14
v_mfma_f32_16x16x32_bf16 v[96:99],a[144:147],a[80:83],v[96:99]
ds_read_b128 a[144:147],v0 offset:30976
v_fma_f32 v81,v81,s36,v14
v_mfma_f32_16x16x32_bf16 v[96:99],a[148:151],a[84:87],v[96:99]
ds_read_b128 a[148:151],v1 offset:30976
v_mfma_f32_16x16x32_bf16 v[96:99],a[120:123],a[88:91],v[96:99]
v_exp_f32 v72,v72
v_mfma_f32_16x16x32_bf16 v[96:99],a[124:127],a[92:95],v[96:99]
s_waitcnt lgkmcnt(4)
v_exp_f32 v73,v73
v_mfma_f32_16x16x32_bf16 v[76:79],a[128:131],a[0:3],0
buffer_load_dwordx4 v7,s[4:7],s20 offen offset:1024 lds
v_mfma_f32_16x16x32_bf16 v[76:79],a[132:135],a[4:7],v[76:79]
s_waitcnt lgkmcnt(3)
v_exp_f32 v74,v74
v_mfma_f32_16x16x32_bf16 v[76:79],a[136:139],a[8:11],v[76:79]
s_waitcnt lgkmcnt(2)
v_exp_f32 v75,v75
v_mfma_f32_16x16x32_bf16 v[76:79],a[140:143],a[12:15],v[76:79]
s_waitcnt lgkmcnt(0)
v_exp_f32 v80,v80
v_mfma_f32_16x16x32_bf16 v[76:79],a[144:147],a[16:19],v[76:79]
v_exp_f32 v81,v81
v_mfma_f32_16x16x32_bf16 v[76:79],a[148:151],a[20:23],v[76:79]
v_cvt_pk_bf16_f32 v44,v72,v73
v_cvt_pk_bf16_f32 v45,v74,v75
v_mfma_f32_16x16x32_bf16 v[84:87],a[148:151],a[44:47],0
v_cvt_pk_bf16_f32 v48,v80,v81
v_mfma_f32_16x16x32_bf16 v[84:87],a[144:147],a[40:43],v[84:87]
v_mfma_f32_16x16x32_bf16 v[84:87],a[140:143],a[36:39],v[84:87]
v_mfma_f32_16x16x32_bf16 v[84:87],a[136:139],a[32:35],v[84:87]
buffer_load_dwordx4 v8,s[4:7],s20 offen offset:2048 lds
v_mfma_f32_16x16x32_bf16 v[84:87],a[132:135],a[28:31],v[84:87]
s_add_u32 s20,s20,12288
v_mfma_f32_16x16x32_bf16 v[84:87],a[128:131],a[24:27],v[84:87]
ds_read_b64_tr_b16 a[120:121],v2 offset:12288
v_mfma_f32_16x16x32_bf16 v[92:95],a[128:131],a[48:51],0
ds_read_b64_tr_b16 a[122:123],v2 offset:18432
v_mfma_f32_16x16x32_bf16 v[92:95],a[132:135],a[52:55],v[92:95]
ds_read_b64_tr_b16 a[124:125],v3 offset:12288
v_mfma_f32_16x16x32_bf16 v[92:95],a[136:139],a[56:59],v[92:95]
ds_read_b64_tr_b16 a[126:127],v3 offset:18432
v_mfma_f32_16x16x32_bf16 v[92:95],a[140:143],a[60:63],v[92:95]
v_mfma_f32_16x16x32_bf16 v[92:95],a[144:147],a[64:67],v[92:95]
v_mfma_f32_16x16x32_bf16 v[92:95],a[148:151],a[68:71],v[92:95]
v_mfma_f32_16x16x32_bf16 v[100:103],a[148:151],a[92:95],0
v_mfma_f32_16x16x32_bf16 v[100:103],a[144:147],a[88:91],v[100:103]
v_mfma_f32_16x16x32_bf16 v[100:103],a[140:143],a[84:87],v[100:103]
v_mfma_f32_16x16x32_bf16 v[100:103],a[136:139],a[80:83],v[100:103]
v_mfma_f32_16x16x32_bf16 v[100:103],a[132:135],a[76:79],v[100:103]
ds_read_b64_tr_b16 a[132:133],v5 offset:12288
v_mfma_f32_16x16x32_bf16 v[100:103],a[128:131],a[72:75],v[100:103]
s_waitcnt lgkmcnt(1)
ds_read_b64_tr_b16 a[128:129],v4 offset:12288
ds_read_b64_tr_b16 a[130:131],v4 offset:18432
ds_read_b64_tr_b16 a[134:135],v5 offset:18432
v_mfma_f32_16x16x32_bf16 v[160:163],a[120:123],v[20:23],v[160:163]
ds_read_b128 a[156:159],v10 offset:3072
v_mbcnt_lo_u32_b32 v19,-1,0
v_mfma_f32_16x16x32_bf16 v[164:167],a[124:127],v[20:23],v[164:167]
ds_read_b64_tr_b16 a[136:137],v2 offset:12416
v_mbcnt_hi_u32_b32 v19,-1,v19
v_mfma_f32_16x16x32_bf16 v[212:215],a[124:127],v[24:27],v[212:215]
ds_read_b64_tr_b16 a[138:139],v2 offset:18560
v_min_u32 v19,7,v19
v_mfma_f32_16x16x32_bf16 v[208:211],a[120:123],v[24:27],v[208:211]
ds_read_b64_tr_b16 a[140:141],v3 offset:12416
v_lshl_add_u32 v19,v19,7,s48
v_mfma_f32_16x16x32_bf16 v[112:115],a[120:123],v[28:31],v[112:115]
ds_read_b64_tr_b16 a[142:143],v3 offset:18560
v_min_u32 v19,L_codeend-L_first-4,v19
v_mfma_f32_16x16x32_bf16 v[116:119],a[124:127],v[28:31],v[116:119]
ds_read_b64_tr_b16 a[150:151],v5 offset:18560
v_fma_f32 v82,v82,s36,v14
v_mfma_f32_16x16x32_bf16 a[164:167],a[124:127],v[32:35],a[164:167]
ds_read_b64_tr_b16 a[144:145],v4 offset:12416
v_fma_f32 v83,v83,s36,v14
v_mfma_f32_16x16x32_bf16 a[160:163],a[120:123],v[32:35],a[160:163]
s_waitcnt lgkmcnt(6)
ds_read_b64_tr_b16 a[146:147],v4 offset:18560
v_fma_f32 v91,v91,s36,v15
v_mfma_f32_16x16x32_bf16 a[168:171],a[128:131],v[32:35],a[168:171]
ds_read_b64_tr_b16 a[148:149],v5 offset:12416
v_fma_f32 v90,v90,s36,v15
v_mfma_f32_16x16x32_bf16 a[172:175],a[132:135],v[32:35],a[172:175]
ds_read_b64_tr_b16 a[122:123],v2 offset:18688
v_fma_f32 v89,v89,s36,v15
v_mfma_f32_16x16x32_bf16 v[124:127],a[132:135],v[28:31],v[124:127]
ds_read_b64_tr_b16 a[120:121],v2 offset:12544
v_fma_f32 v88,v88,s36,v15
v_mfma_f32_16x16x32_bf16 v[120:123],a[128:131],v[28:31],v[120:123]
ds_read_b64_tr_b16 a[126:127],v3 offset:18688
v_fma_f32 v97,v97,s36,v16
v_mfma_f32_16x16x32_bf16 v[216:219],a[128:131],v[24:27],v[216:219]
ds_read_b64_tr_b16 a[124:125],v3 offset:12544
v_fma_f32 v98,v98,s36,v16
v_mfma_f32_16x16x32_bf16 v[220:223],a[132:135],v[24:27],v[220:223]
v_exp_f32 v82,v82
v_mfma_f32_16x16x32_bf16 v[172:175],a[132:135],v[20:23],v[172:175]
ds_read_b64_tr_b16 a[134:135],v5 offset:18688
v_fma_f32 v96,v96,s36,v16
v_mfma_f32_16x16x32_bf16 v[168:171],a[128:131],v[20:23],v[168:171]
global_load_dword v19,v19,s[46:47]
s_waitcnt lgkmcnt(5)
v_mfma_f32_16x16x32_bf16 v[176:179],a[136:139],v[20:23],v[176:179]
buffer_store_dwordx4 a[156:159],v9,s[16:19],s27 offen offset:0 nt
ds_read_b64_tr_b16 a[132:133],v5 offset:12544
ds_read_b128 a[156:159],v10 offset:4096
v_mfma_f32_16x16x32_bf16 v[180:183],a[140:143],v[20:23],v[180:183]
ds_read_b64_tr_b16 a[130:131],v4 offset:18688
v_mfma_f32_16x16x32_bf16 v[228:231],a[140:143],v[24:27],v[228:231]
ds_read_b64_tr_b16 a[128:129],v4 offset:12544
v_fma_f32 v99,v99,s36,v16
v_mfma_f32_16x16x32_bf16 v[224:227],a[136:139],v[24:27],v[224:227]
v_exp_f32 v83,v83
v_mfma_f32_16x16x32_bf16 v[128:131],a[136:139],v[28:31],v[128:131]
v_cvt_pk_bf16_f32 v49,v82,v83
v_fma_f32 v78,v78,s36,v13
v_mfma_f32_16x16x32_bf16 v[132:135],a[140:143],v[28:31],v[132:135]
v_exp_f32 v91,v91
v_mfma_f32_16x16x32_bf16 a[180:183],a[140:143],v[32:35],a[180:183]
v_exp_f32 v88,v88
v_mfma_f32_16x16x32_bf16 a[176:179],a[136:139],v[32:35],a[176:179]
v_exp_f32 v89,v89
v_mfma_f32_16x16x32_bf16 a[184:187],a[144:147],v[32:35],a[184:187]
s_waitcnt lgkmcnt(2)
buffer_store_dwordx4 a[156:159],v9,s[16:19],s27 offen offset:128 nt
v_exp_f32 v90,v90
v_cvt_pk_bf16_f32 v52,v88,v89
v_mfma_f32_16x16x32_bf16 a[188:191],a[148:151],v[32:35],a[188:191]
ds_read_b128 a[156:159],v10 offset:5120
v_cvt_pk_bf16_f32 v53,v90,v91
v_mfma_f32_16x16x32_bf16 v[140:143],a[148:151],v[28:31],v[140:143]
v_exp_f32 v98,v98
v_mfma_f32_16x16x32_bf16 v[136:139],a[144:147],v[28:31],v[136:139]
v_exp_f32 v97,v97
v_mfma_f32_16x16x32_bf16 v[232:235],a[144:147],v[24:27],v[232:235]
v_exp_f32 v99,v99
v_mfma_f32_16x16x32_bf16 v[236:239],a[148:151],v[24:27],v[236:239]
v_exp_f32 v96,v96
v_mfma_f32_16x16x32_bf16 v[188:191],a[148:151],v[20:23],v[188:191]
v_cvt_pk_bf16_f32 v56,v96,v97
v_cvt_pk_bf16_f32 v57,v98,v99
v_mfma_f32_16x16x32_bf16 v[184:187],a[144:147],v[20:23],v[184:187]
v_exp_f32 v78,v78
v_mfma_f32_16x16x32_bf16 v[192:195],a[120:123],v[20:23],v[192:195]
v_fma_f32 v76,v76,s36,v13
v_fma_f32 v79,v79,s36,v13
v_mfma_f32_16x16x32_bf16 v[196:199],a[124:127],v[20:23],v[196:199]
s_waitcnt lgkmcnt(0)
buffer_store_dwordx4 a[156:159],v9,s[16:19],s27 offen offset:256 nt
v_exp_f32 v76,v76
v_fma_f32 v77,v77,s36,v13
v_mfma_f32_16x16x32_bf16 v[244:247],a[124:127],v[24:27],v[244:247]
s_waitcnt vmcnt(13)
v_exp_f32 v79,v79
v_mfma_f32_16x16x32_bf16 v[240:243],a[120:123],v[24:27],v[240:243]
s_barrier
v_mfma_f32_16x16x32_bf16 v[144:147],a[120:123],v[28:31],v[144:147]
s_add_u32 s27,s27,3072
ds_read_b128 a[148:151],v1 offset:128
v_cvt_pk_bf16_f32 v47,v78,v79
v_mfma_f32_16x16x32_bf16 v[148:151],a[124:127],v[28:31],v[148:151]
s_add_u32 m0,s23,12288
ds_read_b128 a[144:147],v0 offset:128
v_fma_f32 v87,v87,s36,v14
v_mfma_f32_16x16x32_bf16 a[196:199],a[124:127],v[32:35],a[196:199]
buffer_load_dwordx4 v6,s[8:11],s21 offen offset:0 lds
v_mfma_f32_16x16x32_bf16 a[192:195],a[120:123],v[32:35],a[192:195]
ds_read_b128 a[124:127],v1 offset:256
v_fma_f32 v86,v86,s36,v14
v_mfma_f32_16x16x32_bf16 a[200:203],a[128:131],v[32:35],a[200:203]
ds_read_b128 a[120:123],v0 offset:256
v_fma_f32 v84,v84,s36,v14
v_mfma_f32_16x16x32_bf16 a[204:207],a[132:135],v[32:35],a[204:207]
ds_read_b128 a[140:143],v1 offset:0
v_fma_f32 v85,v85,s36,v14
v_mfma_f32_16x16x32_bf16 v[156:159],a[132:135],v[28:31],v[156:159]
ds_read_b128 a[136:139],v0 offset:0
v_fma_f32 v95,v95,s36,v15
v_mfma_f32_16x16x32_bf16 v[152:155],a[128:131],v[28:31],v[152:155]
v_exp_f32 v77,v77
v_mfma_f32_16x16x32_bf16 v[248:251],a[128:131],v[24:27],v[248:251]
v_cvt_pk_bf16_f32 v46,v76,v77
v_fma_f32 v92,v92,s36,v15
v_mfma_f32_16x16x32_bf16 v[252:255],a[132:135],v[24:27],v[252:255]
buffer_load_dwordx4 v7,s[8:11],s21 offen offset:1024 lds
v_mfma_f32_16x16x32_bf16 v[204:207],a[132:135],v[20:23],v[204:207]
ds_read_b128 a[132:135],v1 offset:6144
v_fma_f32 v94,v94,s36,v15
v_mfma_f32_16x16x32_bf16 v[200:203],a[128:131],v[20:23],v[200:203]
s_waitcnt lgkmcnt(3)
ds_read_b128 a[128:131],v0 offset:6144
v_fma_f32 v93,v93,s36,v15
v_mfma_f32_16x16x32_bf16 v[72:75],a[124:127],a[20:23],0
v_exp_f32 v84,v84
v_mfma_f32_16x16x32_bf16 v[72:75],a[120:123],a[16:19],v[72:75]
v_exp_f32 v87,v87
v_mfma_f32_16x16x32_bf16 v[72:75],a[148:151],a[12:15],v[72:75]
v_exp_f32 v85,v85
v_mfma_f32_16x16x32_bf16 v[72:75],a[144:147],a[8:11],v[72:75]
s_waitcnt lgkmcnt(2)
v_cvt_pk_bf16_f32 v50,v84,v85
v_fma_f32 v100,v100,s36,v16
v_mfma_f32_16x16x32_bf16 v[72:75],a[140:143],a[4:7],v[72:75]
v_exp_f32 v86,v86
v_mfma_f32_16x16x32_bf16 v[72:75],a[136:139],a[0:3],v[72:75]
v_cvt_pk_bf16_f32 v51,v86,v87
v_fma_f32 v102,v102,s36,v16
v_mfma_f32_16x16x32_bf16 v[80:83],a[136:139],a[24:27],0
buffer_load_dwordx4 v8,s[8:11],s21 offen offset:2048 lds
v_smfmac_f32_16x16x64_bf16 v[60:63],a[152:155],v[44:51],v18
s_add_u32 s21,s21,12288
v_fma_f32 v101,v101,s36,v16
v_mfma_f32_16x16x32_bf16 v[80:83],a[140:143],a[28:31],v[80:83]
s_add_u32 m0,s22,24576
v_exp_f32 v94,v94
v_mfma_f32_16x16x32_bf16 v[80:83],a[144:147],a[32:35],v[80:83]
v_exp_f32 v92,v92
v_mfma_f32_16x16x32_bf16 v[80:83],a[148:151],a[36:39],v[80:83]
v_exp_f32 v93,v93
v_mfma_f32_16x16x32_bf16 v[80:83],a[120:123],a[40:43],v[80:83]
v_cvt_pk_bf16_f32 v54,v92,v93
v_fma_f32 v103,v103,s36,v16
v_mfma_f32_16x16x32_bf16 v[80:83],a[124:127],a[44:47],v[80:83]
v_exp_f32 v95,v95
v_mfma_f32_16x16x32_bf16 v[88:91],a[124:127],a[68:71],0
v_cvt_pk_bf16_f32 v55,v94,v95
v_fma_f32 v73,v73,s36,v13
v_mfma_f32_16x16x32_bf16 v[88:91],a[120:123],a[64:67],v[88:91]
v_exp_f32 v102,v102
v_mfma_f32_16x16x32_bf16 v[88:91],a[148:151],a[60:63],v[88:91]
buffer_load_dwordx4 v6,s[4:7],s20 offen offset:0 lds
v_mfma_f32_16x16x32_bf16 v[88:91],a[144:147],a[56:59],v[88:91]
v_exp_f32 v103,v103
v_mfma_f32_16x16x32_bf16 v[88:91],a[140:143],a[52:55],v[88:91]
v_exp_f32 v100,v100
v_mfma_f32_16x16x32_bf16 v[88:91],a[136:139],a[48:51],v[88:91]
v_exp_f32 v101,v101
v_mfma_f32_16x16x32_bf16 v[96:99],a[136:139],a[72:75],0
ds_read_b128 a[136:139],v0 offset:6272
v_cvt_pk_bf16_f32 v59,v102,v103
v_mfma_f32_16x16x32_bf16 v[96:99],a[140:143],a[76:79],v[96:99]
ds_read_b128 a[140:143],v1 offset:6272
v_cvt_pk_bf16_f32 v58,v100,v101
v_mfma_f32_16x16x32_bf16 v[96:99],a[144:147],a[80:83],v[96:99]
ds_read_b128 a[144:147],v0 offset:6400
v_fma_f32 v81,v81,s36,v14
v_smfmac_f32_16x16x64_bf16 v[64:67],a[152:155],v[52:59],v18
v_fma_f32 v74,v74,s36,v13
v_mfma_f32_16x16x32_bf16 v[96:99],a[148:151],a[84:87],v[96:99]
ds_read_b128 a[148:151],v1 offset:6400
v_fma_f32 v72,v72,s36,v13
v_mfma_f32_16x16x32_bf16 v[96:99],a[120:123],a[88:91],v[96:99]
buffer_load_dwordx4 v7,s[4:7],s20 offen offset:1024 lds
v_mfma_f32_16x16x32_bf16 v[96:99],a[124:127],a[92:95],v[96:99]
s_waitcnt lgkmcnt(4)
v_exp_f32 v72,v72
v_mfma_f32_16x16x32_bf16 v[76:79],a[128:131],a[0:3],0
v_fma_f32 v75,v75,s36,v13
v_fma_f32 v80,v80,s36,v14
v_mfma_f32_16x16x32_bf16 v[76:79],a[132:135],a[4:7],v[76:79]
s_waitcnt lgkmcnt(2)
v_exp_f32 v73,v73
v_mfma_f32_16x16x32_bf16 v[76:79],a[136:139],a[8:11],v[76:79]
v_exp_f32 v80,v80
v_mfma_f32_16x16x32_bf16 v[76:79],a[140:143],a[12:15],v[76:79]
s_waitcnt lgkmcnt(1)
v_cvt_pk_bf16_f32 v20,v72,v73
v_mfma_f32_16x16x32_bf16 v[76:79],a[144:147],a[16:19],v[76:79]
s_waitcnt lgkmcnt(0)
v_exp_f32 v75,v75
v_mfma_f32_16x16x32_bf16 v[76:79],a[148:151],a[20:23],v[76:79]
v_exp_f32 v81,v81
v_mfma_f32_16x16x32_bf16 v[84:87],a[148:151],a[44:47],0
v_cvt_pk_bf16_f32 v24,v80,v81
v_mfma_f32_16x16x32_bf16 v[84:87],a[144:147],a[40:43],v[84:87]
buffer_load_dwordx4 v8,s[4:7],s20 offen offset:2048 lds
v_mfma_f32_16x16x32_bf16 v[84:87],a[140:143],a[36:39],v[84:87]
s_add_u32 s20,s20,12288
v_exp_f32 v74,v74
v_mfma_f32_16x16x32_bf16 v[84:87],a[136:139],a[32:35],v[84:87]
ds_read_b64_tr_b16 a[122:123],v2 offset:30720
v_mfma_f32_16x16x32_bf16 v[84:87],a[132:135],a[28:31],v[84:87]
ds_read_b64_tr_b16 a[120:121],v2 offset:24576
v_cvt_pk_bf16_f32 v21,v74,v75
v_mfma_f32_16x16x32_bf16 v[84:87],a[128:131],a[24:27],v[84:87]
ds_read_b64_tr_b16 a[124:125],v3 offset:24576
v_mfma_f32_16x16x32_bf16 v[92:95],a[128:131],a[48:51],0
ds_read_b64_tr_b16 a[126:127],v3 offset:30720
v_mfma_f32_16x16x32_bf16 v[92:95],a[132:135],a[52:55],v[92:95]
v_mfma_f32_16x16x32_bf16 v[92:95],a[136:139],a[56:59],v[92:95]
v_mfma_f32_16x16x32_bf16 v[92:95],a[140:143],a[60:63],v[92:95]
v_mfma_f32_16x16x32_bf16 v[92:95],a[144:147],a[64:67],v[92:95]
v_mfma_f32_16x16x32_bf16 v[92:95],a[148:151],a[68:71],v[92:95]
v_mfma_f32_16x16x32_bf16 v[100:103],a[148:151],a[92:95],0
v_mfma_f32_16x16x32_bf16 v[100:103],a[144:147],a[88:91],v[100:103]
v_mfma_f32_16x16x32_bf16 v[100:103],a[140:143],a[84:87],v[100:103]
v_mfma_f32_16x16x32_bf16 v[100:103],a[136:139],a[80:83],v[100:103]
v_mfma_f32_16x16x32_bf16 v[100:103],a[132:135],a[76:79],v[100:103]
ds_read_b64_tr_b16 a[132:133],v5 offset:24576
v_mfma_f32_16x16x32_bf16 v[100:103],a[128:131],a[72:75],v[100:103]
s_waitcnt lgkmcnt(1)
ds_read_b64_tr_b16 a[128:129],v4 offset:24576
ds_read_b64_tr_b16 a[130:131],v4 offset:30720
ds_read_b64_tr_b16 a[134:135],v5 offset:30720
v_mfma_f32_16x16x32_bf16 v[160:163],a[120:123],v[44:47],v[160:163]
s_add_u32 m0,s29,0
ds_read_b64_tr_b16 a[136:137],v2 offset:24704
v_fma_f32 v82,v82,s36,v14
v_mfma_f32_16x16x32_bf16 v[164:167],a[124:127],v[44:47],v[164:167]
ds_read_b64_tr_b16 a[138:139],v2 offset:30848
v_fma_f32 v83,v83,s36,v14
v_mfma_f32_16x16x32_bf16 v[212:215],a[124:127],v[48:51],v[212:215]
ds_read_b64_tr_b16 a[140:141],v3 offset:24704
v_fma_f32 v88,v88,s36,v15
v_mfma_f32_16x16x32_bf16 v[208:211],a[120:123],v[48:51],v[208:211]
ds_read_b64_tr_b16 a[142:143],v3 offset:30848
v_fma_f32 v89,v89,s36,v15
v_mfma_f32_16x16x32_bf16 v[112:115],a[120:123],v[52:55],v[112:115]
ds_read_b64_tr_b16 a[144:145],v4 offset:24704
v_fma_f32 v90,v90,s36,v15
v_mfma_f32_16x16x32_bf16 v[116:119],a[124:127],v[52:55],v[116:119]
ds_read_b64_tr_b16 a[146:147],v4 offset:30848
v_fma_f32 v91,v91,s36,v15
v_mfma_f32_16x16x32_bf16 a[164:167],a[124:127],v[56:59],a[164:167]
buffer_load_dwordx4 v6,s[12:15],s28 offen offset:0 nt lds
v_mfma_f32_16x16x32_bf16 a[160:163],a[120:123],v[56:59],a[160:163]
s_waitcnt lgkmcnt(5)
ds_read_b64_tr_b16 a[148:149],v5 offset:24704
v_fma_f32 v96,v96,s36,v16
v_mfma_f32_16x16x32_bf16 a[168:171],a[128:131],v[56:59],a[168:171]
ds_read_b64_tr_b16 a[150:151],v5 offset:30848
v_fma_f32 v97,v97,s36,v16
v_mfma_f32_16x16x32_bf16 a[172:175],a[132:135],v[56:59],a[172:175]
ds_read_b64_tr_b16 a[120:121],v2 offset:24832
v_fma_f32 v98,v98,s36,v16
v_mfma_f32_16x16x32_bf16 v[124:127],a[132:135],v[52:55],v[124:127]
ds_read_b64_tr_b16 a[122:123],v2 offset:30976
v_fma_f32 v99,v99,s36,v16
v_mfma_f32_16x16x32_bf16 v[120:123],a[128:131],v[52:55],v[120:123]
ds_read_b64_tr_b16 a[124:125],v3 offset:24832
v_fma_f32 v76,v76,s36,v13
v_mfma_f32_16x16x32_bf16 v[216:219],a[128:131],v[48:51],v[216:219]
ds_read_b64_tr_b16 a[126:127],v3 offset:30976
v_fma_f32 v77,v77,s36,v13
v_mfma_f32_16x16x32_bf16 v[220:223],a[132:135],v[48:51],v[220:223]
buffer_load_dwordx4 v7,s[12:15],s28 offen offset:1024 nt lds
v_mfma_f32_16x16x32_bf16 v[172:175],a[132:135],v[44:47],v[172:175]
ds_read_b64_tr_b16 a[132:133],v5 offset:24832
v_fma_f32 v78,v78,s36,v13
v_mfma_f32_16x16x32_bf16 v[168:171],a[128:131],v[44:47],v[168:171]
s_waitcnt lgkmcnt(5)
ds_read_b64_tr_b16 a[128:129],v4 offset:24832
v_fma_f32 v79,v79,s36,v13
v_mfma_f32_16x16x32_bf16 v[176:179],a[136:139],v[44:47],v[176:179]
ds_read_b64_tr_b16 a[130:131],v4 offset:30976
v_fma_f32 v84,v84,s36,v14
v_mfma_f32_16x16x32_bf16 v[180:183],a[140:143],v[44:47],v[180:183]
ds_read_b64_tr_b16 a[134:135],v5 offset:30976
v_fma_f32 v85,v85,s36,v14
v_mfma_f32_16x16x32_bf16 v[228:231],a[140:143],v[48:51],v[228:231]
v_exp_f32 v82,v82
v_mfma_f32_16x16x32_bf16 v[224:227],a[136:139],v[48:51],v[224:227]
v_exp_f32 v83,v83
v_mfma_f32_16x16x32_bf16 v[128:131],a[136:139],v[52:55],v[128:131]
v_cvt_pk_bf16_f32 v25,v82,v83
v_fma_f32 v86,v86,s36,v14
v_mfma_f32_16x16x32_bf16 v[132:135],a[140:143],v[52:55],v[132:135]
buffer_load_dwordx4 v8,s[12:15],s28 offen offset:2048 nt lds
v_mfma_f32_16x16x32_bf16 a[180:183],a[140:143],v[56:59],a[180:183]
s_add_u32 s28,s28,3072
v_exp_f32 v88,v88
v_mfma_f32_16x16x32_bf16 a[176:179],a[136:139],v[56:59],a[176:179]
s_add_u32 s29,s29,3072
v_exp_f32 v89,v89
v_mfma_f32_16x16x32_bf16 a[184:187],a[144:147],v[56:59],a[184:187]
s_add_u32 m0,s23,24576
v_exp_f32 v90,v90
v_mfma_f32_16x16x32_bf16 a[188:191],a[148:151],v[56:59],a[188:191]
v_exp_f32 v91,v91
v_mfma_f32_16x16x32_bf16 v[140:143],a[148:151],v[52:55],v[140:143]
v_cvt_pk_bf16_f32 v28,v88,v89
v_cvt_pk_bf16_f32 v29,v90,v91
v_mfma_f32_16x16x32_bf16 v[136:139],a[144:147],v[52:55],v[136:139]
v_exp_f32 v96,v96
v_mfma_f32_16x16x32_bf16 v[232:235],a[144:147],v[48:51],v[232:235]
v_exp_f32 v97,v97
v_mfma_f32_16x16x32_bf16 v[236:239],a[148:151],v[48:51],v[236:239]
v_exp_f32 v98,v98
v_mfma_f32_16x16x32_bf16 v[188:191],a[148:151],v[44:47],v[188:191]
v_exp_f32 v99,v99
v_mfma_f32_16x16x32_bf16 v[184:187],a[144:147],v[44:47],v[184:187]
s_waitcnt vmcnt(13)
v_cvt_pk_bf16_f32 v32,v96,v97
v_cvt_pk_bf16_f32 v33,v98,v99
s_waitcnt lgkmcnt(0)
v_mfma_f32_16x16x32_bf16 v[192:195],a[120:123],v[44:47],v[192:195]
s_barrier
v_mfma_f32_16x16x32_bf16 v[196:199],a[124:127],v[44:47],v[196:199]
ds_read_b128 a[148:151],v1 offset:12416
v_fma_f32 v87,v87,s36,v14
v_mfma_f32_16x16x32_bf16 v[244:247],a[124:127],v[48:51],v[244:247]
ds_read_b128 a[144:147],v0 offset:12416
v_fma_f32 v92,v92,s36,v15
v_mfma_f32_16x16x32_bf16 v[240:243],a[120:123],v[48:51],v[240:243]
ds_read_b128 a[140:143],v1 offset:12288
v_fma_f32 v93,v93,s36,v15
v_mfma_f32_16x16x32_bf16 v[144:147],a[120:123],v[52:55],v[144:147]
ds_read_b128 a[136:139],v0 offset:12288
v_fma_f32 v94,v94,s36,v15
v_mfma_f32_16x16x32_bf16 v[148:151],a[124:127],v[52:55],v[148:151]
v_exp_f32 v76,v76
v_mfma_f32_16x16x32_bf16 a[196:199],a[124:127],v[56:59],a[196:199]
buffer_load_dwordx4 v6,s[8:11],s21 offen offset:0 lds
v_mfma_f32_16x16x32_bf16 a[192:195],a[120:123],v[56:59],a[192:195]
ds_read_b128 a[124:127],v1 offset:12544
v_fma_f32 v95,v95,s36,v15
v_mfma_f32_16x16x32_bf16 a[200:203],a[128:131],v[56:59],a[200:203]
ds_read_b128 a[120:123],v0 offset:12544
v_fma_f32 v100,v100,s36,v16
v_mfma_f32_16x16x32_bf16 a[204:207],a[132:135],v[56:59],a[204:207]
v_exp_f32 v77,v77
v_mfma_f32_16x16x32_bf16 v[156:159],a[132:135],v[52:55],v[156:159]
v_exp_f32 v78,v78
v_mfma_f32_16x16x32_bf16 v[152:155],a[128:131],v[52:55],v[152:155]
v_exp_f32 v79,v79
v_mfma_f32_16x16x32_bf16 v[248:251],a[128:131],v[48:51],v[248:251]
v_cvt_pk_bf16_f32 v22,v76,v77
v_cvt_pk_bf16_f32 v23,v78,v79
v_mfma_f32_16x16x32_bf16 v[252:255],a[132:135],v[48:51],v[252:255]
v_exp_f32 v84,v84
v_mfma_f32_16x16x32_bf16 v[204:207],a[132:135],v[44:47],v[204:207]
ds_read_b128 a[132:135],v1 offset:18432
v_fma_f32 v101,v101,s36,v16
v_mfma_f32_16x16x32_bf16 v[200:203],a[128:131],v[44:47],v[200:203]
buffer_load_dwordx4 v7,s[8:11],s21 offen offset:1024 lds
s_waitcnt lgkmcnt(1)
v_mfma_f32_16x16x32_bf16 v[72:75],a[124:127],a[20:23],0
ds_read_b128 a[128:131],v0 offset:18432
v_fma_f32 v102,v102,s36,v16
v_mfma_f32_16x16x32_bf16 v[72:75],a[120:123],a[16:19],v[72:75]
v_exp_f32 v85,v85
v_mfma_f32_16x16x32_bf16 v[72:75],a[148:151],a[12:15],v[72:75]
v_exp_f32 v86,v86
v_mfma_f32_16x16x32_bf16 v[72:75],a[144:147],a[8:11],v[72:75]
v_exp_f32 v87,v87
v_mfma_f32_16x16x32_bf16 v[72:75],a[140:143],a[4:7],v[72:75]
v_cvt_pk_bf16_f32 v26,v84,v85
v_cvt_pk_bf16_f32 v27,v86,v87
v_mfma_f32_16x16x32_bf16 v[72:75],a[136:139],a[0:3],v[72:75]
v_exp_f32 v92,v92
v_smfmac_f32_16x16x64_bf16 v[60:63],a[152:155],v[20:27],v18
v_fma_f32 v103,v103,s36,v16
v_mfma_f32_16x16x32_bf16 v[80:83],a[136:139],a[24:27],0
v_exp_f32 v93,v93
v_mfma_f32_16x16x32_bf16 v[80:83],a[140:143],a[28:31],v[80:83]
buffer_load_dwordx4 v8,s[8:11],s21 offen offset:2048 lds
v_mfma_f32_16x16x32_bf16 v[80:83],a[144:147],a[32:35],v[80:83]
s_add_u32 s21,s21,12288
v_exp_f32 v94,v94
v_mfma_f32_16x16x32_bf16 v[80:83],a[148:151],a[36:39],v[80:83]
s_add_u32 m0,s22,0
v_exp_f32 v95,v95
v_mfma_f32_16x16x32_bf16 v[80:83],a[120:123],a[40:43],v[80:83]
v_cvt_pk_bf16_f32 v30,v92,v93
v_cvt_pk_bf16_f32 v31,v94,v95
v_mfma_f32_16x16x32_bf16 v[80:83],a[124:127],a[44:47],v[80:83]
v_exp_f32 v100,v100
v_mfma_f32_16x16x32_bf16 v[88:91],a[124:127],a[68:71],0
v_exp_f32 v101,v101
v_mfma_f32_16x16x32_bf16 v[88:91],a[120:123],a[64:67],v[88:91]
v_exp_f32 v102,v102
v_mfma_f32_16x16x32_bf16 v[88:91],a[148:151],a[60:63],v[88:91]
v_exp_f32 v103,v103
v_mfma_f32_16x16x32_bf16 v[88:91],a[144:147],a[56:59],v[88:91]
v_cvt_pk_bf16_f32 v34,v100,v101
v_cvt_pk_bf16_f32 v35,v102,v103
v_mfma_f32_16x16x32_bf16 v[88:91],a[140:143],a[52:55],v[88:91]
buffer_load_dwordx4 v6,s[4:7],s20 offen offset:0 lds
v_smfmac_f32_16x16x64_bf16 v[64:67],a[152:155],v[28:35],v18
v_fma_f32 v72,v72,s36,v13
v_mfma_f32_16x16x32_bf16 v[88:91],a[136:139],a[48:51],v[88:91]
v_fma_f32 v73,v73,s36,v13
v_fma_f32 v74,v74,s36,v13
v_mfma_f32_16x16x32_bf16 v[96:99],a[136:139],a[72:75],0
ds_read_b128 a[136:139],v0 offset:18560
v_fma_f32 v75,v75,s36,v13
v_mfma_f32_16x16x32_bf16 v[96:99],a[140:143],a[76:79],v[96:99]
ds_read_b128 a[140:143],v1 offset:18560
v_fma_f32 v80,v80,s36,v14
v_mfma_f32_16x16x32_bf16 v[96:99],a[144:147],a[80:83],v[96:99]
ds_read_b128 a[144:147],v0 offset:18688
v_fma_f32 v81,v81,s36,v14
v_mfma_f32_16x16x32_bf16 v[96:99],a[148:151],a[84:87],v[96:99]
ds_read_b128 a[148:151],v1 offset:18688
v_mfma_f32_16x16x32_bf16 v[96:99],a[120:123],a[88:91],v[96:99]
v_exp_f32 v72,v72
v_mfma_f32_16x16x32_bf16 v[96:99],a[124:127],a[92:95],v[96:99]
s_waitcnt lgkmcnt(4)
v_exp_f32 v73,v73
v_mfma_f32_16x16x32_bf16 v[76:79],a[128:131],a[0:3],0
buffer_load_dwordx4 v7,s[4:7],s20 offen offset:1024 lds
v_mfma_f32_16x16x32_bf16 v[76:79],a[132:135],a[4:7],v[76:79]
s_waitcnt lgkmcnt(3)
v_exp_f32 v74,v74
v_mfma_f32_16x16x32_bf16 v[76:79],a[136:139],a[8:11],v[76:79]
s_waitcnt lgkmcnt(2)
v_exp_f32 v75,v75
v_mfma_f32_16x16x32_bf16 v[76:79],a[140:143],a[12:15],v[76:79]
s_waitcnt lgkmcnt(0)
v_exp_f32 v80,v80
v_mfma_f32_16x16x32_bf16 v[76:79],a[144:147],a[16:19],v[76:79]
v_exp_f32 v81,v81
v_mfma_f32_16x16x32_bf16 v[76:79],a[148:151],a[20:23],v[76:79]
v_cvt_pk_bf16_f32 v44,v72,v73
v_cvt_pk_bf16_f32 v45,v74,v75
v_mfma_f32_16x16x32_bf16 v[84:87],a[148:151],a[44:47],0
v_cvt_pk_bf16_f32 v48,v80,v81
v_mfma_f32_16x16x32_bf16 v[84:87],a[144:147],a[40:43],v[84:87]
v_mfma_f32_16x16x32_bf16 v[84:87],a[140:143],a[36:39],v[84:87]
v_mfma_f32_16x16x32_bf16 v[84:87],a[136:139],a[32:35],v[84:87]
buffer_load_dwordx4 v8,s[4:7],s20 offen offset:2048 lds
v_mfma_f32_16x16x32_bf16 v[84:87],a[132:135],a[28:31],v[84:87]
s_add_u32 s20,s20,12288
v_mfma_f32_16x16x32_bf16 v[84:87],a[128:131],a[24:27],v[84:87]
ds_read_b64_tr_b16 a[120:121],v2 offset:0
v_mfma_f32_16x16x32_bf16 v[92:95],a[128:131],a[48:51],0
ds_read_b64_tr_b16 a[122:123],v2 offset:6144
v_mfma_f32_16x16x32_bf16 v[92:95],a[132:135],a[52:55],v[92:95]
ds_read_b64_tr_b16 a[124:125],v3 offset:0
v_mfma_f32_16x16x32_bf16 v[92:95],a[136:139],a[56:59],v[92:95]
ds_read_b64_tr_b16 a[126:127],v3 offset:6144
v_mfma_f32_16x16x32_bf16 v[92:95],a[140:143],a[60:63],v[92:95]
v_mfma_f32_16x16x32_bf16 v[92:95],a[144:147],a[64:67],v[92:95]
v_mfma_f32_16x16x32_bf16 v[92:95],a[148:151],a[68:71],v[92:95]
v_mfma_f32_16x16x32_bf16 v[100:103],a[148:151],a[92:95],0
v_mfma_f32_16x16x32_bf16 v[100:103],a[144:147],a[88:91],v[100:103]
v_mfma_f32_16x16x32_bf16 v[100:103],a[140:143],a[84:87],v[100:103]
v_mfma_f32_16x16x32_bf16 v[100:103],a[136:139],a[80:83],v[100:103]
v_mfma_f32_16x16x32_bf16 v[100:103],a[132:135],a[76:79],v[100:103]
ds_read_b64_tr_b16 a[132:133],v5 offset:0
v_mfma_f32_16x16x32_bf16 v[100:103],a[128:131],a[72:75],v[100:103]
s_waitcnt lgkmcnt(1)
ds_read_b64_tr_b16 a[128:129],v4 offset:0
ds_read_b64_tr_b16 a[130:131],v4 offset:6144
ds_read_b64_tr_b16 a[134:135],v5 offset:6144
v_mfma_f32_16x16x32_bf16 v[160:163],a[120:123],v[20:23],v[160:163]
ds_read_b128 a[156:159],v10 offset:6144
v_fma_f32 v82,v82,s36,v14
v_mfma_f32_16x16x32_bf16 v[164:167],a[124:127],v[20:23],v[164:167]
ds_read_b64_tr_b16 a[136:137],v2 offset:128
v_fma_f32 v83,v83,s36,v14
v_mfma_f32_16x16x32_bf16 v[212:215],a[124:127],v[24:27],v[212:215]
ds_read_b64_tr_b16 a[138:139],v2 offset:6272
v_fma_f32 v88,v88,s36,v15
v_mfma_f32_16x16x32_bf16 v[208:211],a[120:123],v[24:27],v[208:211]
ds_read_b64_tr_b16 a[140:141],v3 offset:128
v_fma_f32 v89,v89,s36,v15
v_mfma_f32_16x16x32_bf16 v[112:115],a[120:123],v[28:31],v[112:115]
ds_read_b64_tr_b16 a[142:143],v3 offset:6272
v_fma_f32 v90,v90,s36,v15
v_mfma_f32_16x16x32_bf16 v[116:119],a[124:127],v[28:31],v[116:119]
ds_read_b64_tr_b16 a[144:145],v4 offset:128
v_fma_f32 v91,v91,s36,v15
v_mfma_f32_16x16x32_bf16 a[164:167],a[124:127],v[32:35],a[164:167]
ds_read_b64_tr_b16 a[146:147],v4 offset:6272
v_fma_f32 v96,v96,s36,v16
v_mfma_f32_16x16x32_bf16 a[160:163],a[120:123],v[32:35],a[160:163]
s_waitcnt lgkmcnt(6)
ds_read_b64_tr_b16 a[148:149],v5 offset:128
v_fma_f32 v97,v97,s36,v16
v_mfma_f32_16x16x32_bf16 a[168:171],a[128:131],v[32:35],a[168:171]
ds_read_b64_tr_b16 a[150:151],v5 offset:6272
v_fma_f32 v98,v98,s36,v16
v_mfma_f32_16x16x32_bf16 a[172:175],a[132:135],v[32:35],a[172:175]
ds_read_b64_tr_b16 a[120:121],v2 offset:256
v_fma_f32 v99,v99,s36,v16
v_mfma_f32_16x16x32_bf16 v[124:127],a[132:135],v[28:31],v[124:127]
ds_read_b64_tr_b16 a[122:123],v2 offset:6400
v_fma_f32 v76,v76,s36,v13
v_mfma_f32_16x16x32_bf16 v[120:123],a[128:131],v[28:31],v[120:123]
ds_read_b64_tr_b16 a[124:125],v3 offset:256
v_fma_f32 v77,v77,s36,v13
v_mfma_f32_16x16x32_bf16 v[216:219],a[128:131],v[24:27],v[216:219]
ds_read_b64_tr_b16 a[126:127],v3 offset:6400
v_fma_f32 v78,v78,s36,v13
v_mfma_f32_16x16x32_bf16 v[220:223],a[132:135],v[24:27],v[220:223]
v_exp_f32 v82,v82
v_mfma_f32_16x16x32_bf16 v[172:175],a[132:135],v[20:23],v[172:175]
ds_read_b64_tr_b16 a[132:133],v5 offset:256
v_fma_f32 v79,v79,s36,v13
v_mfma_f32_16x16x32_bf16 v[168:171],a[128:131],v[20:23],v[168:171]
s_waitcnt lgkmcnt(5)
ds_read_b64_tr_b16 a[128:129],v4 offset:256
v_fma_f32 v84,v84,s36,v14
v_mfma_f32_16x16x32_bf16 v[176:179],a[136:139],v[20:23],v[176:179]
buffer_store_dwordx4 a[156:159],v9,s[16:19],s27 offen offset:0 nt
ds_read_b64_tr_b16 a[130:131],v4 offset:6400
ds_read_b128 a[156:159],v10 offset:7168
v_mfma_f32_16x16x32_bf16 v[180:183],a[140:143],v[20:23],v[180:183]
ds_read_b64_tr_b16 a[134:135],v5 offset:6400
v_mfma_f32_16x16x32_bf16 v[228:231],a[140:143],v[24:27],v[228:231]
v_exp_f32 v83,v83
v_mfma_f32_16x16x32_bf16 v[224:227],a[136:139],v[24:27],v[224:227]
v_cvt_pk_bf16_f32 v49,v82,v83
v_fma_f32 v85,v85,s36,v14
v_mfma_f32_16x16x32_bf16 v[128:131],a[136:139],v[28:31],v[128:131]
v_exp_f32 v88,v88
v_mfma_f32_16x16x32_bf16 v[132:135],a[140:143],v[28:31],v[132:135]
v_exp_f32 v89,v89
v_mfma_f32_16x16x32_bf16 a[180:183],a[140:143],v[32:35],a[180:183]
v_exp_f32 v90,v90
v_mfma_f32_16x16x32_bf16 a[176:179],a[136:139],v[32:35],a[176:179]
v_exp_f32 v91,v91
v_mfma_f32_16x16x32_bf16 a[184:187],a[144:147],v[32:35],a[184:187]
s_waitcnt lgkmcnt(1)
buffer_store_dwordx4 a[156:159],v9,s[16:19],s27 offen offset:128 nt
v_cvt_pk_bf16_f32 v52,v88,v89
v_cvt_pk_bf16_f32 v53,v90,v91
v_fma_f32 v86,v86,s36,v14
v_mfma_f32_16x16x32_bf16 a[188:191],a[148:151],v[32:35],a[188:191]
ds_read_b128 a[156:159],v10 offset:8192
v_fma_f32 v87,v87,s36,v14
v_mfma_f32_16x16x32_bf16 v[140:143],a[148:151],v[28:31],v[140:143]
v_exp_f32 v96,v96
v_mfma_f32_16x16x32_bf16 v[136:139],a[144:147],v[28:31],v[136:139]
v_exp_f32 v97,v97
v_mfma_f32_16x16x32_bf16 v[232:235],a[144:147],v[24:27],v[232:235]
v_exp_f32 v98,v98
v_mfma_f32_16x16x32_bf16 v[236:239],a[148:151],v[24:27],v[236:239]
v_exp_f32 v99,v99
v_mfma_f32_16x16x32_bf16 v[188:191],a[148:151],v[20:23],v[188:191]
v_cvt_pk_bf16_f32 v56,v96,v97
v_cvt_pk_bf16_f32 v57,v98,v99
v_mfma_f32_16x16x32_bf16 v[184:187],a[144:147],v[20:23],v[184:187]
v_exp_f32 v76,v76
v_mfma_f32_16x16x32_bf16 v[192:195],a[120:123],v[20:23],v[192:195]
v_exp_f32 v77,v77
v_mfma_f32_16x16x32_bf16 v[196:199],a[124:127],v[20:23],v[196:199]
s_waitcnt lgkmcnt(0)
buffer_store_dwordx4 a[156:159],v9,s[16:19],s27 offen offset:256 nt
v_exp_f32 v78,v78
v_cvt_pk_bf16_f32 v46,v76,v77
v_mfma_f32_16x16x32_bf16 v[244:247],a[124:127],v[24:27],v[244:247]
s_waitcnt vmcnt(12)
v_exp_f32 v79,v79
v_mfma_f32_16x16x32_bf16 v[240:243],a[120:123],v[24:27],v[240:243]
s_barrier
v_mfma_f32_16x16x32_bf16 v[144:147],a[120:123],v[28:31],v[144:147]
s_add_u32 s27,s27,3072
ds_read_b128 a[148:151],v1 offset:24704
v_cvt_pk_bf16_f32 v47,v78,v79
v_mfma_f32_16x16x32_bf16 v[148:151],a[124:127],v[28:31],v[148:151]
s_add_u32 m0,s23,0
ds_read_b128 a[144:147],v0 offset:24704
v_fma_f32 v92,v92,s36,v15
v_mfma_f32_16x16x32_bf16 a[196:199],a[124:127],v[32:35],a[196:199]
buffer_load_dwordx4 v6,s[8:11],s21 offen offset:0 lds
v_mfma_f32_16x16x32_bf16 a[192:195],a[120:123],v[32:35],a[192:195]
ds_read_b128 a[124:127],v1 offset:24832
v_fma_f32 v93,v93,s36,v15
v_mfma_f32_16x16x32_bf16 a[200:203],a[128:131],v[32:35],a[200:203]
ds_read_b128 a[120:123],v0 offset:24832
v_fma_f32 v94,v94,s36,v15
v_mfma_f32_16x16x32_bf16 a[204:207],a[132:135],v[32:35],a[204:207]
ds_read_b128 a[140:143],v1 offset:24576
v_fma_f32 v95,v95,s36,v15
v_mfma_f32_16x16x32_bf16 v[156:159],a[132:135],v[28:31],v[156:159]
ds_read_b128 a[136:139],v0 offset:24576
v_fma_f32 v100,v100,s36,v16
v_mfma_f32_16x16x32_bf16 v[152:155],a[128:131],v[28:31],v[152:155]
v_exp_f32 v84,v84
v_mfma_f32_16x16x32_bf16 v[248:251],a[128:131],v[24:27],v[248:251]
v_exp_f32 v85,v85
v_mfma_f32_16x16x32_bf16 v[252:255],a[132:135],v[24:27],v[252:255]
buffer_load_dwordx4 v7,s[8:11],s21 offen offset:1024 lds
v_mfma_f32_16x16x32_bf16 v[204:207],a[132:135],v[20:23],v[204:207]
ds_read_b128 a[132:135],v1 offset:30720
v_cvt_pk_bf16_f32 v50,v84,v85
v_mfma_f32_16x16x32_bf16 v[200:203],a[128:131],v[20:23],v[200:203]
s_waitcnt lgkmcnt(3)
ds_read_b128 a[128:131],v0 offset:30720
v_fma_f32 v101,v101,s36,v16
v_mfma_f32_16x16x32_bf16 v[72:75],a[124:127],a[20:23],0
v_exp_f32 v86,v86
v_mfma_f32_16x16x32_bf16 v[72:75],a[120:123],a[16:19],v[72:75]
v_exp_f32 v87,v87
v_mfma_f32_16x16x32_bf16 v[72:75],a[148:151],a[12:15],v[72:75]
v_cvt_pk_bf16_f32 v51,v86,v87
v_fma_f32 v102,v102,s36,v16
v_mfma_f32_16x16x32_bf16 v[72:75],a[144:147],a[8:11],v[72:75]
v_exp_f32 v92,v92
v_smfmac_f32_16x16x64_bf16 v[60:63],a[152:155],v[44:51],v18
s_waitcnt lgkmcnt(2)
v_fma_f32 v103,v103,s36,v16
v_mfma_f32_16x16x32_bf16 v[72:75],a[140:143],a[4:7],v[72:75]
v_exp_f32 v93,v93
v_mfma_f32_16x16x32_bf16 v[72:75],a[136:139],a[0:3],v[72:75]
buffer_load_dwordx4 v8,s[8:11],s21 offen offset:2048 lds
v_mfma_f32_16x16x32_bf16 v[80:83],a[136:139],a[24:27],0
s_add_u32 s21,s21,12288
v_exp_f32 v94,v94
v_mfma_f32_16x16x32_bf16 v[80:83],a[140:143],a[28:31],v[80:83]
s_cmp_eq_u32 s38,1
v_exp_f32 v95,v95
v_mfma_f32_16x16x32_bf16 v[80:83],a[144:147],a[32:35],v[80:83]
s_cselect_b32 s20,s26,s20
v_cvt_pk_bf16_f32 v54,v92,v93
v_cvt_pk_bf16_f32 v55,v94,v95
v_mfma_f32_16x16x32_bf16 v[80:83],a[148:151],a[36:39],v[80:83]
s_add_u32 m0,s22,12288
v_exp_f32 v100,v100
v_mfma_f32_16x16x32_bf16 v[80:83],a[120:123],a[40:43],v[80:83]
v_exp_f32 v101,v101
v_mfma_f32_16x16x32_bf16 v[80:83],a[124:127],a[44:47],v[80:83]
v_exp_f32 v102,v102
v_mfma_f32_16x16x32_bf16 v[88:91],a[124:127],a[68:71],0
v_exp_f32 v103,v103
v_mfma_f32_16x16x32_bf16 v[88:91],a[120:123],a[64:67],v[88:91]
v_cvt_pk_bf16_f32 v58,v100,v101
v_cvt_pk_bf16_f32 v59,v102,v103
v_mfma_f32_16x16x32_bf16 v[88:91],a[148:151],a[60:63],v[88:91]
buffer_load_dwordx4 v6,s[4:7],s20 offen offset:0 lds
v_smfmac_f32_16x16x64_bf16 v[64:67],a[152:155],v[52:59],v18
v_fma_f32 v72,v72,s36,v13
v_mfma_f32_16x16x32_bf16 v[88:91],a[144:147],a[56:59],v[88:91]
v_fma_f32 v73,v73,s36,v13
v_fma_f32 v74,v74,s36,v13
v_mfma_f32_16x16x32_bf16 v[88:91],a[140:143],a[52:55],v[88:91]
v_fma_f32 v75,v75,s36,v13
v_fma_f32 v80,v80,s36,v14
v_mfma_f32_16x16x32_bf16 v[88:91],a[136:139],a[48:51],v[88:91]
v_fma_f32 v81,v81,s36,v14
v_mfma_f32_16x16x32_bf16 v[96:99],a[136:139],a[72:75],0
ds_read_b128 a[136:139],v0 offset:30848
v_mfma_f32_16x16x32_bf16 v[96:99],a[140:143],a[76:79],v[96:99]
ds_read_b128 a[140:143],v1 offset:30848
v_mfma_f32_16x16x32_bf16 v[96:99],a[144:147],a[80:83],v[96:99]
ds_read_b128 a[144:147],v0 offset:30976
v_mfma_f32_16x16x32_bf16 v[96:99],a[148:151],a[84:87],v[96:99]
ds_read_b128 a[148:151],v1 offset:30976
v_mfma_f32_16x16x32_bf16 v[96:99],a[120:123],a[88:91],v[96:99]
buffer_load_dwordx4 v7,s[4:7],s20 offen offset:1024 lds
v_mfma_f32_16x16x32_bf16 v[96:99],a[124:127],a[92:95],v[96:99]
s_waitcnt lgkmcnt(4)
v_exp_f32 v72,v72
v_mfma_f32_16x16x32_bf16 v[76:79],a[128:131],a[0:3],0
v_exp_f32 v73,v73
v_mfma_f32_16x16x32_bf16 v[76:79],a[132:135],a[4:7],v[76:79]
s_waitcnt lgkmcnt(3)
v_exp_f32 v74,v74
v_mfma_f32_16x16x32_bf16 v[76:79],a[136:139],a[8:11],v[76:79]
s_waitcnt lgkmcnt(2)
v_exp_f32 v75,v75
v_mfma_f32_16x16x32_bf16 v[76:79],a[140:143],a[12:15],v[76:79]
s_waitcnt lgkmcnt(0)
v_exp_f32 v80,v80
v_mfma_f32_16x16x32_bf16 v[76:79],a[144:147],a[16:19],v[76:79]
v_exp_f32 v81,v81
v_mfma_f32_16x16x32_bf16 v[76:79],a[148:151],a[20:23],v[76:79]
v_cvt_pk_bf16_f32 v20,v72,v73
v_cvt_pk_bf16_f32 v21,v74,v75
v_mfma_f32_16x16x32_bf16 v[84:87],a[148:151],a[44:47],0
v_cvt_pk_bf16_f32 v24,v80,v81
v_mfma_f32_16x16x32_bf16 v[84:87],a[144:147],a[40:43],v[84:87]
buffer_load_dwordx4 v8,s[4:7],s20 offen offset:2048 lds
v_mfma_f32_16x16x32_bf16 v[84:87],a[140:143],a[36:39],v[84:87]
s_add_u32 s20,s20,12288
v_mfma_f32_16x16x32_bf16 v[84:87],a[136:139],a[32:35],v[84:87]
ds_read_b64_tr_b16 a[120:121],v2 offset:12288
v_mfma_f32_16x16x32_bf16 v[84:87],a[132:135],a[28:31],v[84:87]
ds_read_b64_tr_b16 a[122:123],v2 offset:18432
v_mfma_f32_16x16x32_bf16 v[84:87],a[128:131],a[24:27],v[84:87]
ds_read_b64_tr_b16 a[124:125],v3 offset:12288
v_mfma_f32_16x16x32_bf16 v[92:95],a[128:131],a[48:51],0
ds_read_b64_tr_b16 a[126:127],v3 offset:18432
v_mfma_f32_16x16x32_bf16 v[92:95],a[132:135],a[52:55],v[92:95]
v_mfma_f32_16x16x32_bf16 v[92:95],a[136:139],a[56:59],v[92:95]
v_mfma_f32_16x16x32_bf16 v[92:95],a[140:143],a[60:63],v[92:95]
v_mfma_f32_16x16x32_bf16 v[92:95],a[144:147],a[64:67],v[92:95]
v_mfma_f32_16x16x32_bf16 v[92:95],a[148:151],a[68:71],v[92:95]
v_mfma_f32_16x16x32_bf16 v[100:103],a[148:151],a[92:95],0
v_mfma_f32_16x16x32_bf16 v[100:103],a[144:147],a[88:91],v[100:103]
v_mfma_f32_16x16x32_bf16 v[100:103],a[140:143],a[84:87],v[100:103]
v_mfma_f32_16x16x32_bf16 v[100:103],a[136:139],a[80:83],v[100:103]
v_mfma_f32_16x16x32_bf16 v[100:103],a[132:135],a[76:79],v[100:103]
ds_read_b64_tr_b16 a[132:133],v5 offset:12288
v_mfma_f32_16x16x32_bf16 v[100:103],a[128:131],a[72:75],v[100:103]
s_waitcnt lgkmcnt(1)
ds_read_b64_tr_b16 a[128:129],v4 offset:12288
ds_read_b64_tr_b16 a[130:131],v4 offset:18432
ds_read_b64_tr_b16 a[134:135],v5 offset:18432
v_mfma_f32_16x16x32_bf16 v[160:163],a[120:123],v[44:47],v[160:163]
s_add_u32 m0,s29,0
ds_read_b64_tr_b16 a[136:137],v2 offset:12416
v_fma_f32 v82,v82,s36,v14
v_mfma_f32_16x16x32_bf16 v[164:167],a[124:127],v[44:47],v[164:167]
ds_read_b64_tr_b16 a[138:139],v2 offset:18560
v_fma_f32 v83,v83,s36,v14
v_mfma_f32_16x16x32_bf16 v[212:215],a[124:127],v[48:51],v[212:215]
ds_read_b64_tr_b16 a[140:141],v3 offset:12416
v_fma_f32 v88,v88,s36,v15
v_mfma_f32_16x16x32_bf16 v[208:211],a[120:123],v[48:51],v[208:211]
ds_read_b64_tr_b16 a[142:143],v3 offset:18560
v_fma_f32 v89,v89,s36,v15
v_mfma_f32_16x16x32_bf16 v[112:115],a[120:123],v[52:55],v[112:115]
ds_read_b64_tr_b16 a[144:145],v4 offset:12416
v_fma_f32 v90,v90,s36,v15
v_mfma_f32_16x16x32_bf16 v[116:119],a[124:127],v[52:55],v[116:119]
ds_read_b64_tr_b16 a[146:147],v4 offset:18560
v_fma_f32 v91,v91,s36,v15
v_mfma_f32_16x16x32_bf16 a[164:167],a[124:127],v[56:59],a[164:167]
buffer_load_dwordx4 v6,s[12:15],s28 offen offset:0 nt lds
v_mfma_f32_16x16x32_bf16 a[160:163],a[120:123],v[56:59],a[160:163]
s_waitcnt lgkmcnt(5)
ds_read_b64_tr_b16 a[148:149],v5 offset:12416
v_fma_f32 v96,v96,s36,v16
v_mfma_f32_16x16x32_bf16 a[168:171],a[128:131],v[56:59],a[168:171]
ds_read_b64_tr_b16 a[150:151],v5 offset:18560
v_fma_f32 v97,v97,s36,v16
v_mfma_f32_16x16x32_bf16 a[172:175],a[132:135],v[56:59],a[172:175]
ds_read_b64_tr_b16 a[120:121],v2 offset:12544
v_fma_f32 v98,v98,s36,v16
v_mfma_f32_16x16x32_bf16 v[124:127],a[132:135],v[52:55],v[124:127]
ds_read_b64_tr_b16 a[122:123],v2 offset:18688
v_fma_f32 v99,v99,s36,v16
v_mfma_f32_16x16x32_bf16 v[120:123],a[128:131],v[52:55],v[120:123]
ds_read_b64_tr_b16 a[124:125],v3 offset:12544
v_fma_f32 v76,v76,s36,v13
v_mfma_f32_16x16x32_bf16 v[216:219],a[128:131],v[48:51],v[216:219]
ds_read_b64_tr_b16 a[126:127],v3 offset:18688
v_fma_f32 v77,v77,s36,v13
v_mfma_f32_16x16x32_bf16 v[220:223],a[132:135],v[48:51],v[220:223]
buffer_load_dwordx4 v7,s[12:15],s28 offen offset:1024 nt lds
v_mfma_f32_16x16x32_bf16 v[172:175],a[132:135],v[44:47],v[172:175]
ds_read_b64_tr_b16 a[132:133],v5 offset:12544
v_fma_f32 v78,v78,s36,v13
v_mfma_f32_16x16x32_bf16 v[168:171],a[128:131],v[44:47],v[168:171]
s_waitcnt lgkmcnt(5)
ds_read_b64_tr_b16 a[128:129],v4 offset:12544
v_fma_f32 v79,v79,s36,v13
v_mfma_f32_16x16x32_bf16 v[176:179],a[136:139],v[44:47],v[176:179]
ds_read_b64_tr_b16 a[130:131],v4 offset:18688
v_fma_f32 v84,v84,s36,v14
v_mfma_f32_16x16x32_bf16 v[180:183],a[140:143],v[44:47],v[180:183]
ds_read_b64_tr_b16 a[134:135],v5 offset:18688
v_fma_f32 v85,v85,s36,v14
v_mfma_f32_16x16x32_bf16 v[228:231],a[140:143],v[48:51],v[228:231]
v_exp_f32 v82,v82
v_mfma_f32_16x16x32_bf16 v[224:227],a[136:139],v[48:51],v[224:227]
v_exp_f32 v83,v83
v_mfma_f32_16x16x32_bf16 v[128:131],a[136:139],v[52:55],v[128:131]
v_cvt_pk_bf16_f32 v25,v82,v83
v_fma_f32 v86,v86,s36,v14
v_mfma_f32_16x16x32_bf16 v[132:135],a[140:143],v[52:55],v[132:135]
buffer_load_dwordx4 v8,s[12:15],s28 offen offset:2048 nt lds
v_mfma_f32_16x16x32_bf16 a[180:183],a[140:143],v[56:59],a[180:183]
s_add_u32 s28,s28,3072
v_exp_f32 v88,v88
v_mfma_f32_16x16x32_bf16 a[176:179],a[136:139],v[56:59],a[176:179]
s_add_u32 s29,s29,3072
v_exp_f32 v89,v89
v_mfma_f32_16x16x32_bf16 a[184:187],a[144:147],v[56:59],a[184:187]
s_cmp_eq_u32 s38,1
v_exp_f32 v90,v90
v_mfma_f32_16x16x32_bf16 a[188:191],a[148:151],v[56:59],a[188:191]
s_cselect_b32 s21,s26,s21
v_exp_f32 v91,v91
v_mfma_f32_16x16x32_bf16 v[140:143],a[148:151],v[52:55],v[140:143]
s_add_u32 m0,s23,12288
v_cvt_pk_bf16_f32 v28,v88,v89
v_cvt_pk_bf16_f32 v29,v90,v91
v_mfma_f32_16x16x32_bf16 v[136:139],a[144:147],v[52:55],v[136:139]
v_exp_f32 v96,v96
v_mfma_f32_16x16x32_bf16 v[232:235],a[144:147],v[48:51],v[232:235]
v_exp_f32 v97,v97
v_mfma_f32_16x16x32_bf16 v[236:239],a[148:151],v[48:51],v[236:239]
v_exp_f32 v98,v98
v_mfma_f32_16x16x32_bf16 v[188:191],a[148:151],v[44:47],v[188:191]
v_exp_f32 v99,v99
v_mfma_f32_16x16x32_bf16 v[184:187],a[144:147],v[44:47],v[184:187]
s_waitcnt vmcnt(12)
v_cvt_pk_bf16_f32 v32,v96,v97
v_cvt_pk_bf16_f32 v33,v98,v99
s_waitcnt lgkmcnt(0)
v_mfma_f32_16x16x32_bf16 v[192:195],a[120:123],v[44:47],v[192:195]
s_barrier
v_mfma_f32_16x16x32_bf16 v[196:199],a[124:127],v[44:47],v[196:199]
ds_read_b128 a[148:151],v1 offset:128
v_fma_f32 v87,v87,s36,v14
v_mfma_f32_16x16x32_bf16 v[244:247],a[124:127],v[48:51],v[244:247]
ds_read_b128 a[144:147],v0 offset:128
v_fma_f32 v92,v92,s36,v15
v_mfma_f32_16x16x32_bf16 v[240:243],a[120:123],v[48:51],v[240:243]
ds_read_b128 a[140:143],v1 offset:0
v_fma_f32 v93,v93,s36,v15
v_mfma_f32_16x16x32_bf16 v[144:147],a[120:123],v[52:55],v[144:147]
ds_read_b128 a[136:139],v0 offset:0
v_fma_f32 v94,v94,s36,v15
v_mfma_f32_16x16x32_bf16 v[148:151],a[124:127],v[52:55],v[148:151]
v_exp_f32 v76,v76
v_mfma_f32_16x16x32_bf16 a[196:199],a[124:127],v[56:59],a[196:199]
buffer_load_dwordx4 v6,s[8:11],s21 offen offset:0 lds
v_mfma_f32_16x16x32_bf16 a[192:195],a[120:123],v[56:59],a[192:195]
ds_read_b128 a[124:127],v1 offset:256
v_fma_f32 v95,v95,s36,v15
v_mfma_f32_16x16x32_bf16 a[200:203],a[128:131],v[56:59],a[200:203]
ds_read_b128 a[120:123],v0 offset:256
v_fma_f32 v100,v100,s36,v16
v_mfma_f32_16x16x32_bf16 a[204:207],a[132:135],v[56:59],a[204:207]
v_exp_f32 v77,v77
v_mfma_f32_16x16x32_bf16 v[156:159],a[132:135],v[52:55],v[156:159]
v_exp_f32 v78,v78
v_mfma_f32_16x16x32_bf16 v[152:155],a[128:131],v[52:55],v[152:155]
v_exp_f32 v79,v79
v_mfma_f32_16x16x32_bf16 v[248:251],a[128:131],v[48:51],v[248:251]
v_cvt_pk_bf16_f32 v22,v76,v77
v_cvt_pk_bf16_f32 v23,v78,v79
v_mfma_f32_16x16x32_bf16 v[252:255],a[132:135],v[48:51],v[252:255]
v_exp_f32 v84,v84
v_mfma_f32_16x16x32_bf16 v[204:207],a[132:135],v[44:47],v[204:207]
ds_read_b128 a[132:135],v1 offset:6144
v_fma_f32 v101,v101,s36,v16
v_mfma_f32_16x16x32_bf16 v[200:203],a[128:131],v[44:47],v[200:203]
buffer_load_dwordx4 v7,s[8:11],s21 offen offset:1024 lds
s_waitcnt lgkmcnt(1)
v_mfma_f32_16x16x32_bf16 v[72:75],a[124:127],a[20:23],0
ds_read_b128 a[128:131],v0 offset:6144
v_fma_f32 v102,v102,s36,v16
v_mfma_f32_16x16x32_bf16 v[72:75],a[120:123],a[16:19],v[72:75]
v_exp_f32 v85,v85
v_mfma_f32_16x16x32_bf16 v[72:75],a[148:151],a[12:15],v[72:75]
v_exp_f32 v86,v86
v_mfma_f32_16x16x32_bf16 v[72:75],a[144:147],a[8:11],v[72:75]
v_exp_f32 v87,v87
v_mfma_f32_16x16x32_bf16 v[72:75],a[140:143],a[4:7],v[72:75]
v_cvt_pk_bf16_f32 v26,v84,v85
v_cvt_pk_bf16_f32 v27,v86,v87
v_mfma_f32_16x16x32_bf16 v[72:75],a[136:139],a[0:3],v[72:75]
v_exp_f32 v92,v92
v_smfmac_f32_16x16x64_bf16 v[60:63],a[152:155],v[20:27],v18
v_fma_f32 v103,v103,s36,v16
v_mfma_f32_16x16x32_bf16 v[80:83],a[136:139],a[24:27],0
v_exp_f32 v93,v93
v_mfma_f32_16x16x32_bf16 v[80:83],a[140:143],a[28:31],v[80:83]
buffer_load_dwordx4 v8,s[8:11],s21 offen offset:2048 lds
v_mfma_f32_16x16x32_bf16 v[80:83],a[144:147],a[32:35],v[80:83]
s_add_u32 s21,s21,12288
v_exp_f32 v94,v94
v_mfma_f32_16x16x32_bf16 v[80:83],a[148:151],a[36:39],v[80:83]
s_add_u32 m0,s22,24576
v_exp_f32 v95,v95
v_mfma_f32_16x16x32_bf16 v[80:83],a[120:123],a[40:43],v[80:83]
v_cvt_pk_bf16_f32 v30,v92,v93
v_cvt_pk_bf16_f32 v31,v94,v95
v_mfma_f32_16x16x32_bf16 v[80:83],a[124:127],a[44:47],v[80:83]
v_exp_f32 v100,v100
v_mfma_f32_16x16x32_bf16 v[88:91],a[124:127],a[68:71],0
v_exp_f32 v101,v101
v_mfma_f32_16x16x32_bf16 v[88:91],a[120:123],a[64:67],v[88:91]
v_exp_f32 v102,v102
v_mfma_f32_16x16x32_bf16 v[88:91],a[148:151],a[60:63],v[88:91]
v_exp_f32 v103,v103
v_mfma_f32_16x16x32_bf16 v[88:91],a[144:147],a[56:59],v[88:91]
v_cvt_pk_bf16_f32 v34,v100,v101
v_cvt_pk_bf16_f32 v35,v102,v103
v_mfma_f32_16x16x32_bf16 v[88:91],a[140:143],a[52:55],v[88:91]
buffer_load_dwordx4 v6,s[4:7],s20 offen offset:0 lds
v_smfmac_f32_16x16x64_bf16 v[64:67],a[152:155],v[28:35],v18
v_fma_f32 v72,v72,s36,v13
v_mfma_f32_16x16x32_bf16 v[88:91],a[136:139],a[48:51],v[88:91]
v_fma_f32 v73,v73,s36,v13
v_fma_f32 v74,v74,s36,v13
v_mfma_f32_16x16x32_bf16 v[96:99],a[136:139],a[72:75],0
ds_read_b128 a[136:139],v0 offset:6272
v_fma_f32 v75,v75,s36,v13
v_mfma_f32_16x16x32_bf16 v[96:99],a[140:143],a[76:79],v[96:99]
ds_read_b128 a[140:143],v1 offset:6272
v_fma_f32 v80,v80,s36,v14
v_mfma_f32_16x16x32_bf16 v[96:99],a[144:147],a[80:83],v[96:99]
ds_read_b128 a[144:147],v0 offset:6400
v_fma_f32 v81,v81,s36,v14
v_mfma_f32_16x16x32_bf16 v[96:99],a[148:151],a[84:87],v[96:99]
ds_read_b128 a[148:151],v1 offset:6400
v_add_u32 v10,9216,v10
v_mfma_f32_16x16x32_bf16 v[96:99],a[120:123],a[88:91],v[96:99]
v_exp_f32 v72,v72
v_mfma_f32_16x16x32_bf16 v[96:99],a[124:127],a[92:95],v[96:99]
s_waitcnt lgkmcnt(4)
v_exp_f32 v73,v73
v_mfma_f32_16x16x32_bf16 v[76:79],a[128:131],a[0:3],0
buffer_load_dwordx4 v7,s[4:7],s20 offen offset:1024 lds
v_mfma_f32_16x16x32_bf16 v[76:79],a[132:135],a[4:7],v[76:79]
s_waitcnt lgkmcnt(3)
v_exp_f32 v74,v74
v_mfma_f32_16x16x32_bf16 v[76:79],a[136:139],a[8:11],v[76:79]
s_waitcnt lgkmcnt(2)
v_exp_f32 v75,v75
v_mfma_f32_16x16x32_bf16 v[76:79],a[140:143],a[12:15],v[76:79]
s_waitcnt lgkmcnt(0)
v_exp_f32 v80,v80
v_mfma_f32_16x16x32_bf16 v[76:79],a[144:147],a[16:19],v[76:79]
v_exp_f32 v81,v81
v_mfma_f32_16x16x32_bf16 v[76:79],a[148:151],a[20:23],v[76:79]
v_cvt_pk_bf16_f32 v44,v72,v73
v_cvt_pk_bf16_f32 v45,v74,v75
v_mfma_f32_16x16x32_bf16 v[84:87],a[148:151],a[44:47],0
v_cvt_pk_bf16_f32 v48,v80,v81
v_mfma_f32_16x16x32_bf16 v[84:87],a[144:147],a[40:43],v[84:87]
v_mfma_f32_16x16x32_bf16 v[84:87],a[140:143],a[36:39],v[84:87]
v_mfma_f32_16x16x32_bf16 v[84:87],a[136:139],a[32:35],v[84:87]
buffer_load_dwordx4 v8,s[4:7],s20 offen offset:2048 lds
v_mfma_f32_16x16x32_bf16 v[84:87],a[132:135],a[28:31],v[84:87]
s_add_u32 s20,s20,12288
s_add_u32 s38,s38,1
s_cmp_lt_u32 s38,2
v_mfma_f32_16x16x32_bf16 v[84:87],a[128:131],a[24:27],v[84:87]
ds_read_b64_tr_b16 a[120:121],v2 offset:24576
v_mfma_f32_16x16x32_bf16 v[92:95],a[128:131],a[48:51],0
ds_read_b64_tr_b16 a[122:123],v2 offset:30720
v_mfma_f32_16x16x32_bf16 v[92:95],a[132:135],a[52:55],v[92:95]
ds_read_b64_tr_b16 a[124:125],v3 offset:24576
v_mfma_f32_16x16x32_bf16 v[92:95],a[136:139],a[56:59],v[92:95]
ds_read_b64_tr_b16 a[126:127],v3 offset:30720
v_mfma_f32_16x16x32_bf16 v[92:95],a[140:143],a[60:63],v[92:95]
v_mfma_f32_16x16x32_bf16 v[92:95],a[144:147],a[64:67],v[92:95]
v_mfma_f32_16x16x32_bf16 v[92:95],a[148:151],a[68:71],v[92:95]
v_mfma_f32_16x16x32_bf16 v[100:103],a[148:151],a[92:95],0
v_mfma_f32_16x16x32_bf16 v[100:103],a[144:147],a[88:91],v[100:103]
v_mfma_f32_16x16x32_bf16 v[100:103],a[140:143],a[84:87],v[100:103]
v_mfma_f32_16x16x32_bf16 v[100:103],a[136:139],a[80:83],v[100:103]
v_mfma_f32_16x16x32_bf16 v[100:103],a[132:135],a[76:79],v[100:103]
ds_read_b64_tr_b16 a[132:133],v5 offset:24576
v_mfma_f32_16x16x32_bf16 v[100:103],a[128:131],a[72:75],v[100:103]
ds_read_b64_tr_b16 a[128:129],v4 offset:24576
ds_read_b64_tr_b16 a[130:131],v4 offset:30720
ds_read_b64_tr_b16 a[134:135],v5 offset:30720
s_cbranch_scc1 L_loop4w0
s_cmp_ge_u32 s69,6
s_cbranch_scc1 L_end4
s_cmp_eq_u32 s40,0
s_cbranch_scc1 L_tr44
s_branch L_tr45
L_tr45:
s_waitcnt vmcnt(43)
s_waitcnt lgkmcnt(3)
v_mfma_f32_16x16x32_bf16 v[160:163],a[120:123],v[20:23],v[160:163]
s_add_u32 m0,s24,0
ds_read_b128 a[4:7],v12 offset:0
v_fma_f32 v79,v79,s36,v13
v_mfma_f32_16x16x32_bf16 v[164:167],a[124:127],v[20:23],v[164:167]
ds_read_b128 a[12:15],v12 offset:128
v_fma_f32 v100,v100,s36,v16
v_mfma_f32_16x16x32_bf16 v[212:215],a[124:127],v[24:27],v[212:215]
ds_read_b128 a[20:23],v12 offset:256
v_fma_f32 v101,v101,s36,v16
v_mfma_f32_16x16x32_bf16 v[208:211],a[120:123],v[24:27],v[208:211]
ds_read_b128 a[8:11],v11 offset:128
v_fma_f32 v89,v89,s36,v15
v_mfma_f32_16x16x32_bf16 v[112:115],a[120:123],v[28:31],v[112:115]
ds_read_b128 a[0:3],v11 offset:0
v_fma_f32 v76,v76,s36,v13
v_mfma_f32_16x16x32_bf16 v[116:119],a[124:127],v[28:31],v[116:119]
ds_read_b128 a[16:19],v11 offset:256
v_fma_f32 v83,v83,s36,v14
v_mfma_f32_16x16x32_bf16 a[164:167],a[124:127],v[32:35],a[164:167]
ds_read_b64_tr_b16 a[138:139],v2 offset:30848
v_fma_f32 v90,v90,s36,v15
v_mfma_f32_16x16x32_bf16 a[160:163],a[120:123],v[32:35],a[160:163]
s_waitcnt lgkmcnt(6)
ds_read_b64_tr_b16 a[136:137],v2 offset:24704
v_fma_f32 v88,v88,s36,v15
v_mfma_f32_16x16x32_bf16 a[168:171],a[128:131],v[32:35],a[168:171]
ds_read_b64_tr_b16 a[142:143],v3 offset:30848
ds_read_b64_tr_b16 a[140:141],v3 offset:24704
ds_read_b64_tr_b16 a[146:147],v4 offset:30848
ds_read_b64_tr_b16 a[144:145],v4 offset:24704
ds_read_b64_tr_b16 a[150:151],v5 offset:30848
ds_read_b64_tr_b16 a[148:149],v5 offset:24704
ds_read_b128 a[32:35],v11 offset:6272
v_mfma_f32_16x16x32_bf16 a[172:175],a[132:135],v[32:35],a[172:175]
v_fma_f32 v91,v91,s36,v15
ds_read_b128 a[40:43],v11 offset:6400
v_mfma_f32_16x16x32_bf16 v[124:127],a[132:135],v[28:31],v[124:127]
s_waitcnt lgkmcnt(10)
buffer_load_dwordx4 v6,s[12:15],s28 offen offset:0 nt lds
v_mfma_f32_16x16x32_bf16 v[120:123],a[128:131],v[28:31],v[120:123]
ds_read_b64_tr_b16 a[122:123],v2 offset:30976
ds_read_b64_tr_b16 a[120:121],v2 offset:24832
ds_read_b64_tr_b16 a[124:125],v3 offset:24832
ds_read_b64_tr_b16 a[126:127],v3 offset:30976
ds_read_b128 a[44:47],v12 offset:6400
v_mfma_f32_16x16x32_bf16 v[216:219],a[128:131],v[24:27],v[216:219]
v_fma_f32 v93,v93,s36,v15
ds_read_b128 a[28:31],v12 offset:6144
v_mfma_f32_16x16x32_bf16 v[220:223],a[132:135],v[24:27],v[220:223]
v_fma_f32 v98,v98,s36,v16
ds_read_b128 a[36:39],v12 offset:6272
v_mfma_f32_16x16x32_bf16 v[172:175],a[132:135],v[20:23],v[172:175]
buffer_load_dwordx4 v7,s[12:15],s28 offen offset:1024 nt lds
v_mfma_f32_16x16x32_bf16 v[168:171],a[128:131],v[20:23],v[168:171]
s_waitcnt lgkmcnt(7)
ds_read_b64_tr_b16 a[130:131],v4 offset:30976
ds_read_b128 a[24:27],v11 offset:6144
v_mfma_f32_16x16x32_bf16 v[176:179],a[136:139],v[20:23],v[176:179]
v_fma_f32 v82,v82,s36,v14
v_exp_f32 v93,v93
v_mfma_f32_16x16x32_bf16 v[180:183],a[140:143],v[20:23],v[180:183]
ds_read_b64_tr_b16 a[128:129],v4 offset:24832
v_fma_f32 v85,v85,s36,v14
v_mfma_f32_16x16x32_bf16 v[228:231],a[140:143],v[24:27],v[228:231]
ds_read_b64_tr_b16 a[134:135],v5 offset:30976
v_exp_f32 v82,v82
v_mfma_f32_16x16x32_bf16 v[224:227],a[136:139],v[24:27],v[224:227]
ds_read_b64_tr_b16 a[132:133],v5 offset:24832
v_fma_f32 v84,v84,s36,v14
v_mfma_f32_16x16x32_bf16 v[128:131],a[136:139],v[28:31],v[128:131]
v_exp_f32 v84,v84
v_mfma_f32_16x16x32_bf16 v[132:135],a[140:143],v[28:31],v[132:135]
buffer_load_dwordx4 v8,s[12:15],s28 offen offset:2048 nt lds
v_mfma_f32_16x16x32_bf16 a[180:183],a[140:143],v[32:35],a[180:183]
s_add_u32 s28,s28,3072
v_fma_f32 v103,v103,s36,v16
v_exp_f32 v103,v103
v_mfma_f32_16x16x32_bf16 a[176:179],a[136:139],v[32:35],a[176:179]
s_add_u32 m0,s24,3072
v_fma_f32 v87,v87,s36,v14
v_exp_f32 v87,v87
v_mfma_f32_16x16x32_bf16 a[184:187],a[144:147],v[32:35],a[184:187]
v_fma_f32 v77,v77,s36,v13
v_exp_f32 v77,v77
v_mfma_f32_16x16x32_bf16 a[188:191],a[148:151],v[32:35],a[188:191]
v_fma_f32 v97,v97,s36,v16
v_exp_f32 v91,v91
v_mfma_f32_16x16x32_bf16 v[140:143],a[148:151],v[28:31],v[140:143]
v_fma_f32 v102,v102,s36,v16
v_exp_f32 v85,v85
v_mfma_f32_16x16x32_bf16 v[136:139],a[144:147],v[28:31],v[136:139]
v_exp_f32 v89,v89
v_mfma_f32_16x16x32_bf16 v[232:235],a[144:147],v[24:27],v[232:235]
buffer_load_dwordx4 v6,s[12:15],s28 offen offset:0 nt lds
v_mfma_f32_16x16x32_bf16 v[236:239],a[148:151],v[24:27],v[236:239]
v_fma_f32 v92,v92,s36,v15
v_exp_f32 v101,v101
v_mfma_f32_16x16x32_bf16 v[188:191],a[148:151],v[20:23],v[188:191]
v_fma_f32 v94,v94,s36,v15
v_fma_f32 v95,v95,s36,v15
v_mfma_f32_16x16x32_bf16 v[184:187],a[144:147],v[20:23],v[184:187]
s_waitcnt lgkmcnt(0)
v_exp_f32 v95,v95
v_mfma_f32_16x16x32_bf16 v[192:195],a[120:123],v[20:23],v[192:195]
v_fma_f32 v86,v86,s36,v14
v_fma_f32 v78,v78,s36,v13
v_mfma_f32_16x16x32_bf16 v[196:199],a[124:127],v[20:23],v[196:199]
v_exp_f32 v92,v92
v_mfma_f32_16x16x32_bf16 v[244:247],a[124:127],v[24:27],v[244:247]
v_exp_f32 v78,v78
v_mfma_f32_16x16x32_bf16 v[240:243],a[120:123],v[24:27],v[240:243]
buffer_load_dwordx4 v7,s[12:15],s28 offen offset:1024 nt lds
v_mfma_f32_16x16x32_bf16 v[144:147],a[120:123],v[28:31],v[144:147]
v_exp_f32 v94,v94
v_mfma_f32_16x16x32_bf16 v[148:151],a[124:127],v[28:31],v[148:151]
v_exp_f32 v90,v90
v_mfma_f32_16x16x32_bf16 a[196:199],a[124:127],v[32:35],a[196:199]
v_fma_f32 v96,v96,s36,v16
v_exp_f32 v96,v96
v_mfma_f32_16x16x32_bf16 a[192:195],a[120:123],v[32:35],a[192:195]
v_fma_f32 v99,v99,s36,v16
v_exp_f32 v83,v83
v_mfma_f32_16x16x32_bf16 a[200:203],a[128:131],v[32:35],a[200:203]
v_exp_f32 v97,v97
v_mfma_f32_16x16x32_bf16 a[204:207],a[132:135],v[32:35],a[204:207]
v_exp_f32 v88,v88
v_mfma_f32_16x16x32_bf16 v[156:159],a[132:135],v[28:31],v[156:159]
v_exp_f32 v98,v98
v_mfma_f32_16x16x32_bf16 v[152:155],a[128:131],v[28:31],v[152:155]
buffer_load_dwordx4 v8,s[12:15],s28 offen offset:2048 nt lds
s_waitcnt vmcnt(18)
s_barrier
v_mfma_f32_16x16x32_bf16 v[248:251],a[128:131],v[24:27],v[248:251]
s_add_u32 s28,s28,3072
ds_read_b64_tr_b16 a[138:139],v2 offset:6144
v_exp_f32 v79,v79
v_mfma_f32_16x16x32_bf16 v[252:255],a[132:135],v[24:27],v[252:255]
s_add_u32 m0,s22,0
ds_read_b64_tr_b16 a[136:137],v2 offset:0
buffer_load_dwordx4 v6,s[4:7],s25 offen offset:0 lds
v_mfma_f32_16x16x32_bf16 v[204:207],a[132:135],v[20:23],v[204:207]
buffer_load_dwordx4 v7,s[4:7],s25 offen offset:1024 lds
v_mfma_f32_16x16x32_bf16 v[200:203],a[128:131],v[20:23],v[200:203]
buffer_load_dwordx4 v8,s[4:7],s25 offen offset:2048 lds
ds_read_b64_tr_b16 a[142:143],v3 offset:6144
ds_read_b64_tr_b16 a[140:141],v3 offset:0
ds_read_b64_tr_b16 a[144:145],v4 offset:0
ds_read_b64_tr_b16 a[146:147],v4 offset:6144
ds_read_b64_tr_b16 a[148:149],v5 offset:0
ds_read_b64_tr_b16 a[150:151],v5 offset:6144
v_exp_f32 v100,v100
v_cvt_pk_bf16_f32 v47,v78,v79
v_cvt_pk_bf16_f32 v49,v82,v83
v_exp_f32 v76,v76
v_exp_f32 v102,v102
v_exp_f32 v86,v86
v_cvt_pk_bf16_f32 v59,v102,v103
v_exp_f32 v99,v99
v_cvt_pk_bf16_f32 v50,v84,v85
v_cvt_pk_bf16_f32 v57,v98,v99
v_cvt_pk_bf16_f32 v55,v94,v95
v_cvt_pk_bf16_f32 v54,v92,v93
v_cvt_pk_bf16_f32 v58,v100,v101
v_cvt_pk_bf16_f32 v51,v86,v87
v_cvt_pk_bf16_f32 v53,v90,v91
v_cvt_pk_bf16_f32 v46,v76,v77
v_cvt_pk_bf16_f32 v52,v88,v89
v_cvt_pk_bf16_f32 v56,v96,v97
v_smfmac_f32_16x16x64_bf16 v[60:63],a[152:155],v[44:51],v18
v_subrev_u32 v10,18432,v10
v_smfmac_f32_16x16x64_bf16 v[64:67],a[152:155],v[52:59],v18
s_waitcnt lgkmcnt(0)
v_mfma_f32_16x16x32_bf16 v[160:163],a[136:139],v[44:47],v[160:163]
s_add_u32 s87,s42,18432
ds_read_b64_tr_b16 a[122:123],v2 offset:6272
v_mbcnt_lo_u32_b32 v35,-1,0
v_mfma_f32_16x16x32_bf16 v[164:167],a[140:143],v[44:47],v[164:167]
ds_read_b64_tr_b16 a[126:127],v3 offset:6272
v_mbcnt_hi_u32_b32 v35,-1,v35
v_mfma_f32_16x16x32_bf16 v[212:215],a[140:143],v[48:51],v[212:215]
ds_read_b64_tr_b16 a[120:121],v2 offset:128
v_and_b32 v34,7,v35
v_mfma_f32_16x16x32_bf16 v[208:211],a[136:139],v[48:51],v[208:211]
ds_read_b64_tr_b16 a[124:125],v3 offset:128
v_lshrrev_b32 v19,5,v35
v_mfma_f32_16x16x32_bf16 v[112:115],a[136:139],v[52:55],v[112:115]
ds_read_b64_tr_b16 a[128:129],v4 offset:128
v_xor_b32 v34,v34,v19
v_mfma_f32_16x16x32_bf16 v[116:119],a[140:143],v[52:55],v[116:119]
ds_read_b64_tr_b16 a[134:135],v5 offset:6272
ds_read_b64_tr_b16 a[130:131],v4 offset:6272
ds_read_b64_tr_b16 a[132:133],v5 offset:128
v_mfma_f32_16x16x32_bf16 a[164:167],a[140:143],v[56:59],a[164:167]
ds_read_b64_tr_b16 a[140:141],v3 offset:256
v_and_b32 v19,15,v35
v_mfma_f32_16x16x32_bf16 a[160:163],a[136:139],v[56:59],a[160:163]
ds_read_b64_tr_b16 a[138:139],v2 offset:6400
v_lshl_add_u32 v19,v19,7,s24
v_mfma_f32_16x16x32_bf16 a[168:171],a[144:147],v[56:59],a[168:171]
ds_read_b64_tr_b16 a[136:137],v2 offset:256
v_lshl_add_u32 v19,v34,4,v19
v_mfma_f32_16x16x32_bf16 a[172:175],a[148:151],v[56:59],a[172:175]
ds_read_b64_tr_b16 a[142:143],v3 offset:6400
v_bfe_u32 v34,v35,4,1
v_mfma_f32_16x16x32_bf16 v[124:127],a[148:151],v[52:55],v[124:127]
v_lshl_add_u32 v32,v34,3,v19
v_xor_b32 v34,64,v32
v_mfma_f32_16x16x32_bf16 v[120:123],a[144:147],v[52:55],v[120:123]
v_xor_b32 v33,32,v32
v_bfe_u32 v19,v35,3,1
v_mfma_f32_16x16x32_bf16 v[216:219],a[144:147],v[48:51],v[216:219]
v_xor_b32 v35,96,v32
v_lshlrev_b32 v19,11,v19
v_mfma_f32_16x16x32_bf16 v[220:223],a[148:151],v[48:51],v[220:223]
v_add_u32 v36,v32,v19
v_add_u32 v37,v33,v19
v_mfma_f32_16x16x32_bf16 v[172:175],a[148:151],v[44:47],v[172:175]
ds_read_b64_tr_b16 a[150:151],v5 offset:6400
v_add_u32 v38,v34,v19
v_mfma_f32_16x16x32_bf16 v[168:171],a[144:147],v[44:47],v[168:171]
s_waitcnt lgkmcnt(2)
ds_read_b64_tr_b16 a[146:147],v4 offset:6400
v_add_u32 v39,v35,v19
v_mfma_f32_16x16x32_bf16 v[176:179],a[120:123],v[44:47],v[176:179]
ds_read_b64_tr_b16 a[144:145],v4 offset:256
v_add_f32 v66,v66,v67
v_mfma_f32_16x16x32_bf16 v[180:183],a[124:127],v[44:47],v[180:183]
ds_read_b64_tr_b16 a[148:149],v5 offset:256
v_rcp_f32 v66,v66
v_mfma_f32_16x16x32_bf16 v[228:231],a[124:127],v[48:51],v[228:231]
v_accvgpr_read_b32 v74,a162
v_accvgpr_read_b32 v81,a165
v_mfma_f32_16x16x32_bf16 v[224:227],a[120:123],v[48:51],v[224:227]
v_add_f32 v64,v64,v65
v_accvgpr_read_b32 v82,a166
v_mfma_f32_16x16x32_bf16 v[128:131],a[120:123],v[52:55],v[128:131]
v_accvgpr_read_b32 v75,a163
v_accvgpr_read_b32 v73,a161
v_mfma_f32_16x16x32_bf16 v[132:135],a[124:127],v[52:55],v[132:135]
v_accvgpr_read_b32 v91,a171
v_accvgpr_read_b32 v98,a174
v_mfma_f32_16x16x32_bf16 a[180:183],a[124:127],v[56:59],a[180:183]
v_accvgpr_read_b32 v80,a164
v_accvgpr_read_b32 v72,a160
v_mfma_f32_16x16x32_bf16 a[176:179],a[120:123],v[56:59],a[176:179]
v_accvgpr_read_b32 v83,a167
v_accvgpr_read_b32 v90,a170
v_mfma_f32_16x16x32_bf16 a[184:187],a[128:131],v[56:59],a[184:187]
v_accvgpr_read_b32 v99,a175
v_accvgpr_read_b32 v88,a168
v_mfma_f32_16x16x32_bf16 a[188:191],a[132:135],v[56:59],a[188:191]
v_accvgpr_read_b32 v85,a181
v_accvgpr_read_b32 v86,a182
v_mfma_f32_16x16x32_bf16 v[140:143],a[132:135],v[52:55],v[140:143]
v_accvgpr_read_b32 v79,a179
v_accvgpr_read_b32 v76,a176
v_accvgpr_read_b32 v87,a183
v_accvgpr_read_b32 v84,a180
v_accvgpr_read_b32 v77,a177
v_pk_mul_f32 v[76:77],v[76:77],v[66:67] op_sel_hi:[1,0]
v_pk_mul_f32 v[86:87],v[86:87],v[66:67] op_sel_hi:[1,0]
v_pk_mul_f32 v[74:75],v[74:75],v[66:67] op_sel_hi:[1,0]
v_pk_mul_f32 v[82:83],v[82:83],v[66:67] op_sel_hi:[1,0]
v_pk_mul_f32 v[84:85],v[84:85],v[66:67] op_sel_hi:[1,0]
v_pk_mul_f32 v[80:81],v[80:81],v[66:67] op_sel_hi:[1,0]
v_pk_mul_f32 v[72:73],v[72:73],v[66:67] op_sel_hi:[1,0]
v_pk_mov_b32 v[68:69],0,0
v_pk_mov_b32 v[70:71],0,0
v_accvgpr_read_b32 v102,a190
v_accvgpr_read_b32 v93,a185
v_accvgpr_read_b32 v94,a186
v_accvgpr_read_b32 v78,a178
v_pk_mul_f32 v[78:79],v[78:79],v[66:67] op_sel_hi:[1,0]
v_accvgpr_read_b32 v92,a184
v_rcp_f32 v64,v64
v_mfma_f32_16x16x32_bf16 v[136:139],a[128:131],v[52:55],v[136:139]
v_accvgpr_read_b32 v100,a188
v_accvgpr_read_b32 v89,a169
v_accvgpr_read_b32 v95,a187
v_accvgpr_read_b32 v96,a172
v_accvgpr_read_b32 v103,a191
v_pk_mul_f32 v[90:91],v[90:91],v[66:67] op_sel_hi:[1,0]
v_pk_mul_f32 v[88:89],v[88:89],v[66:67] op_sel_hi:[1,0]
v_pk_mul_f32 v[94:95],v[94:95],v[66:67] op_sel_hi:[1,0]
v_pk_mul_f32 v[92:93],v[92:93],v[66:67] op_sel_hi:[1,0]
v_accvgpr_read_b32 v101,a189
v_accvgpr_read_b32 v97,a173
v_mfma_f32_16x16x32_bf16 v[232:235],a[128:131],v[48:51],v[232:235]
v_add_f32 v62,v62,v63
v_add_f32 v60,v60,v61
v_rcp_f32 v60,v60
v_rcp_f32 v62,v62
v_pk_mul_f32 v[134:135],v[134:135],v[64:65] op_sel_hi:[1,0]
v_pk_mul_f32 v[96:97],v[96:97],v[66:67] op_sel_hi:[1,0]
v_pk_mul_f32 v[116:117],v[116:117],v[64:65] op_sel_hi:[1,0]
v_pk_mul_f32 v[98:99],v[98:99],v[66:67] op_sel_hi:[1,0]
v_pk_mul_f32 v[130:131],v[130:131],v[64:65] op_sel_hi:[1,0]
v_pk_mul_f32 v[114:115],v[114:115],v[64:65] op_sel_hi:[1,0]
v_pk_mul_f32 v[128:129],v[128:129],v[64:65] op_sel_hi:[1,0]
v_pk_mul_f32 v[102:103],v[102:103],v[66:67] op_sel_hi:[1,0]
v_pk_mul_f32 v[112:113],v[112:113],v[64:65] op_sel_hi:[1,0]
v_pk_mul_f32 v[132:133],v[132:133],v[64:65] op_sel_hi:[1,0]
v_pk_mul_f32 v[118:119],v[118:119],v[64:65] op_sel_hi:[1,0]
v_pk_mul_f32 v[100:101],v[100:101],v[66:67] op_sel_hi:[1,0]
v_min3_f32 v61,v60,v62,v64
v_min_f32 v61,v61,v66
v_mfma_f32_16x16x32_bf16 v[236:239],a[132:135],v[48:51],v[236:239]
v_cmp_nlt_f32 vcc,s37,v61
v_cvt_pk_bf16_f32 v80,v80,v81
v_mfma_f32_16x16x32_bf16 v[188:191],a[132:135],v[44:47],v[188:191]
v_cvt_pk_bf16_f32 v72,v72,v73
v_cvt_pk_bf16_f32 v84,v84,v85
v_cvt_pk_bf16_f32 v100,v100,v101
v_cvt_pk_bf16_f32 v76,v76,v77
v_cvt_pk_bf16_f32 v73,v74,v75
v_pk_mul_f32 v[138:139],v[138:139],v[64:65] op_sel_hi:[1,0]
v_pk_mul_f32 v[122:123],v[122:123],v[64:65] op_sel_hi:[1,0]
v_pk_mul_f32 v[136:137],v[136:137],v[64:65] op_sel_hi:[1,0]
v_pk_mul_f32 v[120:121],v[120:121],v[64:65] op_sel_hi:[1,0]
v_cvt_pk_bf16_f32 v96,v96,v97
v_cvt_pk_bf16_f32 v92,v92,v93
v_mfma_f32_16x16x32_bf16 v[184:187],a[128:131],v[44:47],v[184:187]
s_cmp_lg_u64 vcc,0
v_cvt_pk_bf16_f32 v81,v82,v83
v_cvt_pk_bf16_f32 v101,v102,v103
v_mfma_f32_16x16x32_bf16 v[192:195],a[136:139],v[44:47],v[192:195]
s_cselect_b32 s62,s32,0
v_cvt_pk_bf16_f32 v97,v98,v99
v_cvt_pk_bf16_f32 v77,v78,v79
s_waitcnt lgkmcnt(0)
v_mfma_f32_16x16x32_bf16 v[196:199],a[140:143],v[44:47],v[196:199]
s_or_b32 s31,s31,s62
ds_write2st64_b64 v32,v[72:73],v[76:77] offset0:36 offset1:40
v_pk_mul_f32 v[142:143],v[142:143],v[64:65] op_sel_hi:[1,0]
v_pk_mul_f32 v[124:125],v[124:125],v[64:65] op_sel_hi:[1,0]
v_pk_mul_f32 v[140:141],v[140:141],v[64:65] op_sel_hi:[1,0]
v_pk_mul_f32 v[126:127],v[126:127],v[64:65] op_sel_hi:[1,0]
v_cvt_pk_bf16_f32 v85,v86,v87
v_cvt_pk_bf16_f32 v93,v94,v95
v_mfma_f32_16x16x32_bf16 v[244:247],a[140:143],v[48:51],v[244:247]
s_lshl_b32 s32,s32,1
v_cvt_pk_bf16_f32 v88,v88,v89
v_cvt_pk_bf16_f32 v89,v90,v91
v_mfma_f32_16x16x32_bf16 v[240:243],a[136:139],v[48:51],v[240:243]
s_add_u32 m0,s24,6144
v_cvt_pk_bf16_f32 v140,v140,v141
v_cvt_pk_bf16_f32 v136,v136,v137
v_mfma_f32_16x16x32_bf16 v[144:147],a[136:139],v[52:55],v[144:147]
buffer_load_dwordx4 v6,s[12:15],s28 offen offset:0 nt lds
v_mfma_f32_16x16x32_bf16 v[148:151],a[140:143],v[52:55],v[148:151]
buffer_load_dwordx4 v7,s[12:15],s28 offen offset:1024 nt lds
v_mfma_f32_16x16x32_bf16 a[196:199],a[140:143],v[56:59],a[196:199]
buffer_load_dwordx4 v8,s[12:15],s28 offen offset:2048 nt lds
v_mfma_f32_16x16x32_bf16 a[192:195],a[136:139],v[56:59],a[192:195]
s_add_u32 s28,s28,3072
ds_write2st64_b64 v33,v[80:81],v[84:85] offset0:36 offset1:40
v_mfma_f32_16x16x32_bf16 a[200:203],a[144:147],v[56:59],a[200:203]
s_add_u32 m0,s24,9216
v_cvt_pk_bf16_f32 v137,v138,v139
v_cvt_pk_bf16_f32 v132,v132,v133
v_mfma_f32_16x16x32_bf16 a[204:207],a[148:151],v[56:59],a[204:207]
buffer_load_dwordx4 v6,s[12:15],s28 offen offset:0 nt lds
v_mfma_f32_16x16x32_bf16 v[156:159],a[148:151],v[52:55],v[156:159]
buffer_load_dwordx4 v7,s[12:15],s28 offen offset:1024 nt lds
buffer_load_dwordx4 v8,s[12:15],s28 offen offset:2048 nt lds
ds_write2st64_b64 v34,v[88:89],v[92:93] offset0:36 offset1:40
v_accvgpr_read_b32 v86,a198
v_accvgpr_read_b32 v82,a194
v_accvgpr_read_b32 v84,a196
v_accvgpr_read_b32 v85,a197
v_pk_mul_f32 v[84:85],v[84:85],v[66:67] op_sel_hi:[1,0]
v_accvgpr_read_b32 v83,a195
v_pk_mul_f32 v[82:83],v[82:83],v[66:67] op_sel_hi:[1,0]
v_accvgpr_read_b32 v81,a193
v_accvgpr_read_b32 v80,a192
v_pk_mul_f32 v[80:81],v[80:81],v[66:67] op_sel_hi:[1,0]
v_accvgpr_read_b32 v87,a199
v_pk_mul_f32 v[86:87],v[86:87],v[66:67] op_sel_hi:[1,0]
v_accvgpr_read_b32 v91,a203
v_accvgpr_read_b32 v88,a200
v_mfma_f32_16x16x32_bf16 v[152:155],a[144:147],v[52:55],v[152:155]
s_waitcnt vmcnt(21)
ds_read_b128 a[60:63],v12 offset:12416
v_accvgpr_read_b32 v89,a201
v_mfma_f32_16x16x32_bf16 v[248:251],a[144:147],v[48:51],v[248:251]
s_add_u32 s28,s28,3072
ds_read_b128 a[56:59],v11 offset:12416
v_accvgpr_read_b32 v90,a202
ds_write2st64_b64 v35,v[96:97],v[100:101] offset0:36 offset1:40
v_pk_mul_f32 v[88:89],v[88:89],v[66:67] op_sel_hi:[1,0]
v_pk_mul_f32 v[90:91],v[90:91],v[66:67] op_sel_hi:[1,0]
v_accvgpr_read_b32 v93,a205
v_accvgpr_read_b32 v94,a206
v_mfma_f32_16x16x32_bf16 v[252:255],a[148:151],v[48:51],v[252:255]
s_add_u32 m0,s23,0
ds_read_b128 a[52:55],v12 offset:12288
v_accvgpr_read_b32 v95,a207
v_mfma_f32_16x16x32_bf16 v[204:207],a[148:151],v[44:47],v[204:207]
ds_read_b128 a[64:67],v11 offset:12544
v_accvgpr_read_b32 v92,a204
ds_read_b128 a[68:71],v12 offset:12544
v_mfma_f32_16x16x32_bf16 v[200:203],a[144:147],v[44:47],v[200:203]
v_cvt_pk_bf16_f32 v133,v134,v135
ds_read_b128 a[48:51],v11 offset:12288
v_cvt_pk_bf16_f32 v120,v120,v121
ds_read_b128 v[104:107],v10 offset:18432
v_cvt_pk_bf16_f32 v116,v116,v117
v_cvt_pk_bf16_f32 v112,v112,v113
v_cvt_pk_bf16_f32 v113,v114,v115
v_cvt_pk_bf16_f32 v128,v128,v129
v_cvt_pk_bf16_f32 v129,v130,v131
v_cvt_pk_bf16_f32 v80,v80,v81
v_cvt_pk_bf16_f32 v81,v82,v83
ds_read_b128 v[108:111],v10 offset:19456
v_cvt_pk_bf16_f32 v124,v124,v125
v_cvt_pk_bf16_f32 v125,v126,v127
v_cvt_pk_bf16_f32 v121,v122,v123
v_cvt_pk_bf16_f32 v117,v118,v119
v_cvt_pk_bf16_f32 v141,v142,v143
v_cvt_pk_bf16_f32 v84,v84,v85
v_cvt_pk_bf16_f32 v85,v86,v87
ds_read_b128 v[72:75],v10 offset:20480
v_cvt_pk_bf16_f32 v88,v88,v89
v_cvt_pk_bf16_f32 v89,v90,v91
ds_read_b128 v[76:79],v10 offset:21504
ds_write2st64_b64 v36,v[112:113],v[128:129] offset0:24 offset1:26
s_waitcnt lgkmcnt(4)
buffer_store_dwordx4 v[104:107],v9,s[16:19],s87 offen offset:0 nt
ds_write2st64_b64 v37,v[116:117],v[132:133] offset0:24 offset1:26
s_waitcnt lgkmcnt(1)
buffer_store_dwordx4 v[108:111],v9,s[16:19],s87 offen offset:3072 nt
s_waitcnt vmcnt(8)
s_barrier
ds_read_b128 a[124:127],v1 offset:0
ds_read_b128 a[120:123],v0 offset:0
buffer_store_dwordx4 v[72:75],v9,s[16:19],s87 offen offset:128 nt
ds_read_b128 a[128:131],v0 offset:128
ds_read_b128 a[132:135],v1 offset:128
ds_read_b128 a[136:139],v0 offset:256
buffer_load_dwordx4 v6,s[8:11],s25 offen offset:0 lds
ds_write2st64_b64 v38,v[120:121],v[136:137] offset0:24 offset1:26
ds_read_b128 a[140:143],v1 offset:256
s_waitcnt lgkmcnt(5)
v_mfma_f32_16x16x32_bf16 v[72:75],a[120:123],a[0:3],0
buffer_store_dwordx4 v[76:79],v9,s[16:19],s87 offen offset:3200 nt
ds_read_b128 a[144:147],v0 offset:6144
v_pk_mul_f32 v[94:95],v[94:95],v[66:67] op_sel_hi:[1,0]
v_pk_mul_f32 v[92:93],v[92:93],v[66:67] op_sel_hi:[1,0]
v_pk_mov_b32 v[66:67],0,0
v_cvt_pk_bf16_f32 v92,v92,v93
v_cvt_pk_bf16_f32 v93,v94,v95
v_mfma_f32_16x16x32_bf16 v[72:75],a[124:127],a[4:7],v[72:75]
s_waitcnt lgkmcnt(3)
ds_read_b128 a[148:151],v1 offset:6144
v_mfma_f32_16x16x32_bf16 v[72:75],a[128:131],a[8:11],v[72:75]
ds_write2st64_b64 v39,v[124:125],v[140:141] offset0:24 offset1:26
v_mfma_f32_16x16x32_bf16 v[72:75],a[132:135],a[12:15],v[72:75]
buffer_load_dwordx4 v7,s[8:11],s25 offen offset:1024 lds
v_pk_mul_f32 v[162:163],v[162:163],v[60:61] op_sel_hi:[1,0]
v_pk_mul_f32 v[160:161],v[160:161],v[60:61] op_sel_hi:[1,0]
v_pk_mul_f32 v[146:147],v[146:147],v[64:65] op_sel_hi:[1,0]
v_pk_mul_f32 v[144:145],v[144:145],v[64:65] op_sel_hi:[1,0]
v_cvt_pk_bf16_f32 v160,v160,v161
v_cvt_pk_bf16_f32 v161,v162,v163
v_mfma_f32_16x16x32_bf16 v[72:75],a[136:139],a[16:19],v[72:75]
s_waitcnt lgkmcnt(2)
ds_write_b64 v32,v[80:81] offset:18432
v_mfma_f32_16x16x32_bf16 v[72:75],a[140:143],a[20:23],v[72:75]
v_cvt_pk_bf16_f32 v144,v144,v145
v_cvt_pk_bf16_f32 v145,v146,v147
v_mfma_f32_16x16x32_bf16 v[80:83],a[140:143],a[44:47],0
ds_write_b64 v33,v[84:85] offset:18432
v_mfma_f32_16x16x32_bf16 v[80:83],a[136:139],a[40:43],v[80:83]
buffer_load_dwordx4 v8,s[8:11],s25 offen offset:2048 lds
s_waitcnt vmcnt(16)
ds_read_b128 a[92:95],v12 offset:256
v_pk_mul_f32 v[166:167],v[166:167],v[60:61] op_sel_hi:[1,0]
v_pk_mul_f32 v[150:151],v[150:151],v[64:65] op_sel_hi:[1,0]
v_pk_mul_f32 v[164:165],v[164:165],v[60:61] op_sel_hi:[1,0]
v_pk_mul_f32 v[148:149],v[148:149],v[64:65] op_sel_hi:[1,0]
v_max3_f32 v44,v72,v73,v74
v_max_f32 v44,v44,v75
v_mfma_f32_16x16x32_bf16 v[80:83],a[132:135],a[36:39],v[80:83]
s_mov_b32 s27,s42
ds_read_b128 a[84:87],v12 offset:128
v_cvt_pk_bf16_f32 v148,v148,v149
v_mfma_f32_16x16x32_bf16 v[80:83],a[128:131],a[32:35],v[80:83]
s_mov_b32 s42,s41
ds_read_b128 a[88:91],v11 offset:256
v_cvt_pk_bf16_f32 v149,v150,v151
v_mfma_f32_16x16x32_bf16 v[80:83],a[124:127],a[28:31],v[80:83]
s_add_u32 s69,s69,1
ds_read_b128 a[80:83],v11 offset:128
v_cvt_pk_bf16_f32 v164,v164,v165
ds_write_b64 v34,v[88:89] offset:18432
ds_read_b128 a[76:79],v12 offset:0
v_mfma_f32_16x16x32_bf16 v[80:83],a[120:123],a[24:27],v[80:83]
s_lshl_b32 s62,s69,5
ds_read_b128 a[72:75],v11 offset:0
v_cvt_pk_bf16_f32 v165,v166,v167
s_add_u32 s62,s62,s34
s_mul_i32 s63,s62,171
ds_write_b64 v35,v[92:93] offset:18432
v_pk_mul_f32 v[152:153],v[152:153],v[64:65] op_sel_hi:[1,0]
v_pk_mul_f32 v[168:169],v[168:169],v[60:61] op_sel_hi:[1,0]
v_pk_mul_f32 v[154:155],v[154:155],v[64:65] op_sel_hi:[1,0]
v_pk_mul_f32 v[170:171],v[170:171],v[60:61] op_sel_hi:[1,0]
v_max3_f32 v48,v80,v81,v82
v_max_f32 v48,v48,v83
v_mfma_f32_16x16x32_bf16 v[88:91],a[120:123],a[48:51],0
s_lshr_b32 s63,s63,9
ds_read_b128 v[96:99],v10 offset:18432
v_permlane32_swap_b32 v44,v48
v_mfma_f32_16x16x32_bf16 v[88:91],a[124:127],a[52:55],v[88:91]
s_mul_i32 s64,s63,3
ds_read_b128 v[100:103],v10 offset:19456
v_max_f32 v44,v44,v48
v_mfma_f32_16x16x32_bf16 v[88:91],a[128:131],a[56:59],v[88:91]
s_sub_u32 s62,s62,s64
ds_write2st64_b64 v36,v[144:145],v[160:161] offset0:28 offset1:0
v_mfma_f32_16x16x32_bf16 v[88:91],a[132:135],a[60:63],v[88:91]
s_add_u32 s63,s63,s33
v_mov_b32 v48,v44
v_cvt_pk_bf16_f32 v168,v168,v169
v_cvt_pk_bf16_f32 v169,v170,v171
v_permlane16_swap_b32 v48,v44
v_pk_mul_f32 v[172:173],v[172:173],v[60:61] op_sel_hi:[1,0]
v_pk_mul_f32 v[174:175],v[174:175],v[60:61] op_sel_hi:[1,0]
v_pk_mul_f32 v[156:157],v[156:157],v[64:65] op_sel_hi:[1,0]
v_pk_mul_f32 v[158:159],v[158:159],v[64:65] op_sel_hi:[1,0]
v_pk_mov_b32 v[64:65],0,0
v_max_f32 v44,v44,v48
v_mul_f32_e64 v14,-s36,v44
v_mfma_f32_16x16x32_bf16 v[88:91],a[136:139],a[64:67],v[88:91]
s_mul_i32 s30,s63,196608
ds_write2st64_b64 v37,v[148:149],v[164:165] offset0:28 offset1:0
v_mfma_f32_16x16x32_bf16 v[88:91],a[140:143],a[68:71],v[88:91]
s_mul_i32 s41,s63,325632
v_mov_b32 v13,v14
s_waitcnt lgkmcnt(1)
buffer_store_dwordx4 v[96:99],v9,s[16:19],s87 offen offset:256 nt
v_cvt_pk_bf16_f32 v172,v172,v173
v_permlane32_swap_b32 v13,v14
v_mfma_f32_16x16x32_bf16 v[96:99],a[140:143],a[92:95],0
s_lshl_b32 s63,s3,2
v_fma_f32 v75,v75,s36,v13
v_exp_f32 v75,v75
v_fma_f32 v74,v74,s36,v13
v_exp_f32 v74,v74
v_pk_mul_f32 v[194:195],v[194:195],v[60:61] op_sel_hi:[1,0]
v_pk_mul_f32 v[178:179],v[178:179],v[60:61] op_sel_hi:[1,0]
v_pk_mul_f32 v[192:193],v[192:193],v[60:61] op_sel_hi:[1,0]
v_pk_mul_f32 v[176:177],v[176:177],v[60:61] op_sel_hi:[1,0]
v_fma_f32 v72,v72,s36,v13
v_exp_f32 v72,v72
v_mfma_f32_16x16x32_bf16 v[96:99],a[136:139],a[88:91],v[96:99]
s_waitcnt vmcnt(8)
ds_read_b128 a[96:99],v11 offset:6144
buffer_store_dwordx4 v[100:103],v9,s[16:19],s87 offen offset:3328 nt
v_fma_f32 v73,v73,s36,v13
v_exp_f32 v73,v73
v_mfma_f32_16x16x32_bf16 v[96:99],a[132:135],a[84:87],v[96:99]
s_add_u32 s64,s63,21
ds_read_b128 a[100:103],v12 offset:6144
v_cvt_pk_bf16_f32 v20,v72,v73
v_mfma_f32_16x16x32_bf16 v[96:99],a[128:131],a[80:83],v[96:99]
s_cmp_eq_u32 s3,0
ds_read_b128 a[104:107],v11 offset:6272
v_cvt_pk_bf16_f32 v21,v74,v75
v_mfma_f32_16x16x32_bf16 v[96:99],a[124:127],a[76:79],v[96:99]
s_cselect_b32 s64,20,s64
ds_read_b128 a[112:115],v11 offset:6400
v_fma_f32 v82,v82,s36,v14
ds_read_b128 a[108:111],v12 offset:6272
v_pk_mul_f32 v[180:181],v[180:181],v[60:61] op_sel_hi:[1,0]
ds_read_b128 a[116:119],v12 offset:6400
v_pk_mul_f32 v[182:183],v[182:183],v[60:61] op_sel_hi:[1,0]
v_pk_mul_f32 v[198:199],v[198:199],v[60:61] op_sel_hi:[1,0]
v_pk_mul_f32 v[196:197],v[196:197],v[60:61] op_sel_hi:[1,0]
v_fma_f32 v83,v83,s36,v14
v_fma_f32 v81,v81,s36,v14
v_mfma_f32_16x16x32_bf16 v[96:99],a[120:123],a[72:75],v[96:99]
s_cselect_b32 s40,1,0
v_exp_f32 v81,v81
s_waitcnt lgkmcnt(5)
v_mfma_f32_16x16x32_bf16 v[104:107],a[120:123],a[96:99],0
s_add_u32 s65,s63,37
ds_read_b128 a[120:123],v0 offset:6272
v_exp_f32 v82,v82
s_waitcnt lgkmcnt(5)
v_mfma_f32_16x16x32_bf16 v[104:107],a[124:127],a[100:103],v[104:107]
s_cmp_eq_u32 s62,2
ds_read_b128 a[124:127],v1 offset:6272
v_fma_f32 v80,v80,s36,v14
s_waitcnt lgkmcnt(5)
v_mfma_f32_16x16x32_bf16 v[104:107],a[128:131],a[104:107],v[104:107]
s_cselect_b32 s64,s65,s64
ds_read_b128 a[128:131],v0 offset:6400
v_exp_f32 v80,v80
v_exp_f32 v83,v83
v_pk_mul_f32 v[184:185],v[184:185],v[60:61] op_sel_hi:[1,0]
v_pk_mul_f32 v[202:203],v[202:203],v[60:61] op_sel_hi:[1,0]
v_pk_mul_f32 v[200:201],v[200:201],v[60:61] op_sel_hi:[1,0]
v_pk_mul_f32 v[186:187],v[186:187],v[60:61] op_sel_hi:[1,0]
v_cvt_pk_bf16_f32 v25,v82,v83
v_max3_f32 v52,v88,v89,v90
s_waitcnt lgkmcnt(3)
v_mfma_f32_16x16x32_bf16 v[104:107],a[132:135],a[108:111],v[104:107]
s_cselect_b32 s40,0,s40
ds_read_b128 a[132:135],v1 offset:6400
v_cvt_pk_bf16_f32 v24,v80,v81
v_mfma_f32_16x16x32_bf16 v[104:107],a[136:139],a[112:115],v[104:107]
s_add_u32 s65,s63,s3
ds_read_b128 a[136:139],v0 offset:12288
v_max3_f32 v56,v96,v97,v98
v_mfma_f32_16x16x32_bf16 v[104:107],a[140:143],a[116:119],v[104:107]
s_cmp_eq_u32 s62,0
ds_read_b128 a[140:143],v1 offset:12288
v_max_f32 v56,v56,v99
v_max_f32 v52,v52,v91
v_cvt_pk_bf16_f32 v156,v156,v157
v_cvt_pk_bf16_f32 v157,v158,v159
v_pk_mul_f32 v[206:207],v[206:207],v[60:61] op_sel_hi:[1,0]
v_pk_mul_f32 v[188:189],v[188:189],v[60:61] op_sel_hi:[1,0]
v_pk_mul_f32 v[190:191],v[190:191],v[60:61] op_sel_hi:[1,0]
v_pk_mul_f32 v[204:205],v[204:205],v[60:61] op_sel_hi:[1,0]
v_pk_mov_b32 v[60:61],0,0
v_permlane32_swap_b32 v52,v56
v_max_f32 v52,v52,v56
v_mfma_f32_16x16x32_bf16 v[76:79],a[144:147],a[0:3],0
s_cselect_b32 s64,s65,s64
v_mov_b32 v56,v52
v_max3_f32 v40,v104,v105,v106
v_mfma_f32_16x16x32_bf16 v[76:79],a[148:151],a[4:7],v[76:79]
s_cselect_b32 s40,1,s40
v_permlane16_swap_b32 v56,v52
s_waitcnt lgkmcnt(3)
v_mfma_f32_16x16x32_bf16 v[76:79],a[120:123],a[8:11],v[76:79]
s_mul_i32 s64,s64,6144
v_max_f32 v52,v52,v56
v_mul_f32_e64 v16,-s36,v52
v_mfma_f32_16x16x32_bf16 v[76:79],a[124:127],a[12:15],v[76:79]
s_add_u32 s41,s41,s64
v_mov_b32 v15,v16
v_cvt_pk_bf16_f32 v204,v204,v205
v_max_f32 v40,v40,v107
v_permlane32_swap_b32 v15,v16
v_pk_mul_f32 v[226:227],v[226:227],v[62:63] op_sel_hi:[1,0]
v_pk_mul_f32 v[208:209],v[208:209],v[62:63] op_sel_hi:[1,0]
v_pk_mul_f32 v[210:211],v[210:211],v[62:63] op_sel_hi:[1,0]
v_pk_mul_f32 v[224:225],v[224:225],v[62:63] op_sel_hi:[1,0]
v_fma_f32 v88,v88,s36,v15
v_fma_f32 v91,v91,s36,v15
v_mfma_f32_16x16x32_bf16 v[76:79],a[128:131],a[16:19],v[76:79]
s_cmp_ge_u32 s69,6
v_exp_f32 v88,v88
s_waitcnt lgkmcnt(0)
v_mfma_f32_16x16x32_bf16 v[76:79],a[132:135],a[20:23],v[76:79]
s_cselect_b32 s41,166723584,s41
v_fma_f32 v89,v89,s36,v15
v_exp_f32 v89,v89
v_mfma_f32_16x16x32_bf16 v[84:87],a[132:135],a[44:47],0
s_cselect_b32 s30,100663296,s30
v_cvt_pk_bf16_f32 v28,v88,v89
v_exp_f32 v91,v91
v_mfma_f32_16x16x32_bf16 v[84:87],a[128:131],a[40:43],v[84:87]
s_add_u32 s25,s30,s22
v_fma_f32 v90,v90,s36,v15
v_exp_f32 v90,v90
v_fma_f32 v97,v97,s36,v16
v_cvt_pk_bf16_f32 v29,v90,v91
v_pk_mul_f32 v[212:213],v[212:213],v[62:63] op_sel_hi:[1,0]
v_pk_mul_f32 v[228:229],v[228:229],v[62:63] op_sel_hi:[1,0]
v_pk_mul_f32 v[214:215],v[214:215],v[62:63] op_sel_hi:[1,0]
v_pk_mul_f32 v[230:231],v[230:231],v[62:63] op_sel_hi:[1,0]
v_fma_f32 v98,v98,s36,v16
v_fma_f32 v99,v99,s36,v16
v_mfma_f32_16x16x32_bf16 v[84:87],a[124:127],a[36:39],v[84:87]
s_add_u32 s26,s25,12288
v_exp_f32 v99,v99
v_mfma_f32_16x16x32_bf16 v[84:87],a[120:123],a[32:35],v[84:87]
s_add_u32 m0,s23,24576
v_exp_f32 v98,v98
v_mfma_f32_16x16x32_bf16 v[84:87],a[148:151],a[28:31],v[84:87]
s_mov_b32 s28,s41
v_exp_f32 v97,v97
v_fma_f32 v96,v96,s36,v16
v_exp_f32 v96,v96
buffer_load_dwordx4 v6,s[8:11],s21 offen offset:0 lds
buffer_load_dwordx4 v7,s[8:11],s21 offen offset:1024 lds
v_pk_mul_f32 v[218:219],v[218:219],v[62:63] op_sel_hi:[1,0]
v_pk_mul_f32 v[234:235],v[234:235],v[62:63] op_sel_hi:[1,0]
v_pk_mul_f32 v[216:217],v[216:217],v[62:63] op_sel_hi:[1,0]
v_pk_mul_f32 v[232:233],v[232:233],v[62:63] op_sel_hi:[1,0]
v_cvt_pk_bf16_f32 v32,v96,v97
v_cvt_pk_bf16_f32 v33,v98,v99
v_mfma_f32_16x16x32_bf16 v[84:87],a[144:147],a[24:27],v[84:87]
s_mov_b32 s29,s24
v_cvt_pk_bf16_f32 v228,v228,v229
v_cvt_pk_bf16_f32 v229,v230,v231
v_mfma_f32_16x16x32_bf16 v[92:95],a[144:147],a[48:51],0
v_cvt_pk_bf16_f32 v212,v212,v213
v_cvt_pk_bf16_f32 v213,v214,v215
v_mfma_f32_16x16x32_bf16 v[92:95],a[148:151],a[52:55],v[92:95]
v_cvt_pk_bf16_f32 v188,v188,v189
v_cvt_pk_bf16_f32 v189,v190,v191
v_mfma_f32_16x16x32_bf16 v[92:95],a[120:123],a[56:59],v[92:95]
buffer_load_dwordx4 v8,s[8:11],s21 offen offset:2048 lds
v_cvt_pk_bf16_f32 v208,v208,v209
v_cvt_pk_bf16_f32 v209,v210,v211
v_pk_mul_f32 v[222:223],v[222:223],v[62:63] op_sel_hi:[1,0]
v_pk_mul_f32 v[236:237],v[236:237],v[62:63] op_sel_hi:[1,0]
v_pk_mul_f32 v[220:221],v[220:221],v[62:63] op_sel_hi:[1,0]
v_pk_mul_f32 v[238:239],v[238:239],v[62:63] op_sel_hi:[1,0]
v_cvt_pk_bf16_f32 v220,v220,v221
v_cvt_pk_bf16_f32 v152,v152,v153
v_mfma_f32_16x16x32_bf16 v[92:95],a[124:127],a[60:63],v[92:95]
s_add_u32 s21,s21,12288
v_cvt_pk_bf16_f32 v153,v154,v155
v_cvt_pk_bf16_f32 v184,v184,v185
v_mfma_f32_16x16x32_bf16 v[92:95],a[128:131],a[64:67],v[92:95]
s_add_u32 m0,s22,0
ds_write2st64_b64 v38,v[152:153],v[168:169] offset0:28 offset1:0
v_mfma_f32_16x16x32_bf16 v[92:95],a[132:135],a[68:71],v[92:95]
v_cvt_pk_bf16_f32 v185,v186,v187
v_cvt_pk_bf16_f32 v173,v174,v175
v_mfma_f32_16x16x32_bf16 v[100:103],a[132:135],a[92:95],0
v_cvt_pk_bf16_f32 v196,v196,v197
v_cvt_pk_bf16_f32 v197,v198,v199
v_cvt_pk_bf16_f32 v200,v200,v201
v_cvt_pk_bf16_f32 v201,v202,v203
v_cvt_pk_bf16_f32 v192,v192,v193
v_pk_mul_f32 v[242:243],v[242:243],v[62:63] op_sel_hi:[1,0]
v_pk_mul_f32 v[240:241],v[240:241],v[62:63] op_sel_hi:[1,0]
v_cvt_pk_bf16_f32 v193,v194,v195
v_cvt_pk_bf16_f32 v240,v240,v241
v_mfma_f32_16x16x32_bf16 v[100:103],a[128:131],a[88:91],v[100:103]
ds_write2st64_b64 v39,v[156:157],v[172:173] offset0:28 offset1:0
v_mfma_f32_16x16x32_bf16 v[100:103],a[124:127],a[84:87],v[100:103]
v_mov_b32 v41,v40
v_cvt_pk_bf16_f32 v232,v232,v233
v_mfma_f32_16x16x32_bf16 v[100:103],a[120:123],a[80:83],v[100:103]
v_permlane32_swap_b32 v41,v40
v_mfma_f32_16x16x32_bf16 v[100:103],a[148:151],a[76:79],v[100:103]
v_max_f32 v40,v40,v41
v_mov_b32 v41,v40
v_cvt_pk_bf16_f32 v205,v206,v207
v_cvt_pk_bf16_f32 v176,v176,v177
v_permlane16_swap_b32 v41,v40
v_pk_mul_f32 v[244:245],v[244:245],v[62:63] op_sel_hi:[1,0]
v_pk_mul_f32 v[246:247],v[246:247],v[62:63] op_sel_hi:[1,0]
v_cvt_pk_bf16_f32 v177,v178,v179
v_max_f32 v40,v40,v41
v_mfma_f32_16x16x32_bf16 v[100:103],a[144:147],a[72:75],v[100:103]
ds_write2st64_b64 v36,v[176:177],v[192:193] offset0:2 offset1:4
v_mfma_f32_16x16x32_bf16 v[108:111],a[144:147],a[96:99],0
v_cvt_pk_bf16_f32 v180,v180,v181
v_cvt_pk_bf16_f32 v181,v182,v183
v_mfma_f32_16x16x32_bf16 v[108:111],a[148:151],a[100:103],v[108:111]
ds_read_b128 a[148:151],v1 offset:12416
v_cvt_pk_bf16_f32 v244,v244,v245
v_cvt_pk_bf16_f32 v245,v246,v247
ds_read_b128 a[144:147],v0 offset:12416
v_pk_mul_f32 v[250:251],v[250:251],v[62:63] op_sel_hi:[1,0]
v_pk_mul_f32 v[248:249],v[248:249],v[62:63] op_sel_hi:[1,0]
v_cvt_pk_bf16_f32 v221,v222,v223
v_cvt_pk_bf16_f32 v236,v236,v237
v_mfma_f32_16x16x32_bf16 v[108:111],a[120:123],a[104:107],v[108:111]
ds_write2st64_b64 v37,v[180:181],v[196:197] offset0:2 offset1:4
v_mfma_f32_16x16x32_bf16 v[108:111],a[124:127],a[108:111],v[108:111]
v_cvt_pk_bf16_f32 v237,v238,v239
v_mul_f32_e64 v17,-s36,v40
v_mfma_f32_16x16x32_bf16 v[108:111],a[128:131],a[112:115],v[108:111]
ds_read_b128 a[120:123],v0 offset:12544
v_fma_f32 v105,v105,s36,v17
v_mfma_f32_16x16x32_bf16 v[108:111],a[132:135],a[116:119],v[108:111]
ds_read_b128 a[124:127],v1 offset:12544
v_cvt_pk_bf16_f32 v224,v224,v225
v_cvt_pk_bf16_f32 v225,v226,v227
v_cvt_pk_bf16_f32 v216,v216,v217
ds_read_b128 a[128:131],v0 offset:18432
v_pk_mul_f32 v[254:255],v[254:255],v[62:63] op_sel_hi:[1,0]
ds_write2st64_b64 v38,v[184:185],v[200:201] offset0:2 offset1:4
v_pk_mul_f32 v[252:253],v[252:253],v[62:63] op_sel_hi:[1,0]
v_pk_mov_b32 v[62:63],0,0
v_cvt_pk_bf16_f32 v217,v218,v219
v_fma_f32 v106,v106,s36,v17
v_mfma_f32_16x16x32_bf16 v[72:75],a[136:139],a[0:3],0
ds_read_b128 a[132:135],v1 offset:18432
v_cvt_pk_bf16_f32 v233,v234,v235
v_mfma_f32_16x16x32_bf16 v[72:75],a[140:143],a[4:7],v[72:75]
s_waitcnt lgkmcnt(4)
v_cvt_pk_bf16_f32 v241,v242,v243
v_fma_f32 v104,v104,s36,v17
v_mfma_f32_16x16x32_bf16 v[72:75],a[144:147],a[8:11],v[72:75]
ds_write2st64_b64 v39,v[188:189],v[204:205] offset0:2 offset1:4
v_mfma_f32_16x16x32_bf16 v[72:75],a[148:151],a[12:15],v[72:75]
v_exp_f32 v104,v104
v_mfma_f32_16x16x32_bf16 v[72:75],a[120:123],a[16:19],v[72:75]
s_waitcnt lgkmcnt(2)
v_exp_f32 v106,v106
v_mfma_f32_16x16x32_bf16 v[72:75],a[124:127],a[20:23],v[72:75]
v_fma_f32 v107,v107,s36,v17
v_exp_f32 v107,v107
v_mfma_f32_16x16x32_bf16 v[80:83],a[124:127],a[44:47],0
ds_write2st64_b64 v36,v[208:209],v[224:225] offset0:12 offset1:14
v_mfma_f32_16x16x32_bf16 v[80:83],a[120:123],a[40:43],v[80:83]
v_exp_f32 v105,v105
v_mfma_f32_16x16x32_bf16 v[80:83],a[148:151],a[36:39],v[80:83]
v_fma_f32 v79,v79,s36,v13
v_exp_f32 v79,v79
v_mfma_f32_16x16x32_bf16 v[80:83],a[144:147],a[32:35],v[80:83]
v_fma_f32 v78,v78,s36,v13
v_fma_f32 v77,v77,s36,v13
v_mfma_f32_16x16x32_bf16 v[80:83],a[140:143],a[28:31],v[80:83]
ds_write2st64_b64 v37,v[212:213],v[228:229] offset0:12 offset1:14
v_mfma_f32_16x16x32_bf16 v[80:83],a[136:139],a[24:27],v[80:83]
v_exp_f32 v77,v77
v_mfma_f32_16x16x32_bf16 v[88:91],a[136:139],a[48:51],0
v_exp_f32 v78,v78
v_mfma_f32_16x16x32_bf16 v[88:91],a[140:143],a[52:55],v[88:91]
v_cvt_pk_bf16_f32 v23,v78,v79
v_fma_f32 v76,v76,s36,v13
v_mfma_f32_16x16x32_bf16 v[88:91],a[144:147],a[56:59],v[88:91]
ds_write2st64_b64 v38,v[216:217],v[232:233] offset0:12 offset1:14
v_mfma_f32_16x16x32_bf16 v[88:91],a[148:151],a[60:63],v[88:91]
v_exp_f32 v76,v76
v_mfma_f32_16x16x32_bf16 v[88:91],a[120:123],a[64:67],v[88:91]
v_cvt_pk_bf16_f32 v22,v76,v77
v_fma_f32 v84,v84,s36,v14
v_mfma_f32_16x16x32_bf16 v[88:91],a[124:127],a[68:71],v[88:91]
v_exp_f32 v84,v84
v_mfma_f32_16x16x32_bf16 v[96:99],a[124:127],a[92:95],0
ds_write2st64_b64 v39,v[220:221],v[236:237] offset0:12 offset1:14
v_mfma_f32_16x16x32_bf16 v[96:99],a[120:123],a[88:91],v[96:99]
v_fma_f32 v85,v85,s36,v14
v_exp_f32 v85,v85
v_mfma_f32_16x16x32_bf16 v[96:99],a[148:151],a[84:87],v[96:99]
v_cvt_pk_bf16_f32 v26,v84,v85
v_fma_f32 v86,v86,s36,v14
v_mfma_f32_16x16x32_bf16 v[96:99],a[144:147],a[80:83],v[96:99]
v_fma_f32 v87,v87,s36,v14
v_exp_f32 v87,v87
v_mfma_f32_16x16x32_bf16 v[96:99],a[140:143],a[76:79],v[96:99]
ds_write_b64 v36,v[240:241] offset:8192
v_mfma_f32_16x16x32_bf16 v[96:99],a[136:139],a[72:75],v[96:99]
v_cvt_pk_bf16_f32 v36,v104,v105
v_exp_f32 v86,v86
v_fma_f32 v92,v92,s36,v15
v_cvt_pk_bf16_f32 v27,v86,v87
v_fma_f32 v95,v95,s36,v15
v_exp_f32 v95,v95
v_smfmac_f32_16x16x64_bf16 v[60:63],a[152:155],v[20:27],v18
ds_write_b64 v37,v[244:245] offset:8192
v_cvt_pk_bf16_f32 v37,v106,v107
v_mfma_f32_16x16x32_bf16 v[104:107],a[136:139],a[96:99],0
ds_read_b128 a[136:139],v0 offset:18560
v_fma_f32 v94,v94,s36,v15
v_mfma_f32_16x16x32_bf16 v[104:107],a[140:143],a[100:103],v[104:107]
ds_read_b128 a[140:143],v1 offset:18560
v_exp_f32 v94,v94
v_mfma_f32_16x16x32_bf16 v[104:107],a[144:147],a[104:107],v[104:107]
ds_read_b128 a[144:147],v0 offset:18688
v_fma_f32 v93,v93,s36,v15
v_mfma_f32_16x16x32_bf16 v[104:107],a[148:151],a[108:111],v[104:107]
ds_read_b128 a[148:151],v1 offset:18688
v_exp_f32 v93,v93
v_mfma_f32_16x16x32_bf16 v[104:107],a[120:123],a[112:115],v[104:107]
v_exp_f32 v92,v92
v_mfma_f32_16x16x32_bf16 v[104:107],a[124:127],a[116:119],v[104:107]
v_cvt_pk_bf16_f32 v30,v92,v93
v_cvt_pk_bf16_f32 v31,v94,v95
v_mfma_f32_16x16x32_bf16 v[76:79],a[128:131],a[0:3],0
s_waitcnt lgkmcnt(4)
v_fma_f32 v103,v103,s36,v16
v_fma_f32 v102,v102,s36,v16
v_mfma_f32_16x16x32_bf16 v[76:79],a[132:135],a[4:7],v[76:79]
s_waitcnt lgkmcnt(3)
v_exp_f32 v102,v102
v_mfma_f32_16x16x32_bf16 v[76:79],a[136:139],a[8:11],v[76:79]
s_waitcnt lgkmcnt(2)
v_exp_f32 v103,v103
v_mfma_f32_16x16x32_bf16 v[76:79],a[140:143],a[12:15],v[76:79]
s_waitcnt lgkmcnt(0)
v_cvt_pk_bf16_f32 v35,v102,v103
v_fma_f32 v100,v100,s36,v16
v_mfma_f32_16x16x32_bf16 v[76:79],a[144:147],a[16:19],v[76:79]
v_exp_f32 v100,v100
v_mfma_f32_16x16x32_bf16 v[76:79],a[148:151],a[20:23],v[76:79]
v_fma_f32 v101,v101,s36,v16
v_exp_f32 v101,v101
v_mfma_f32_16x16x32_bf16 v[84:87],a[148:151],a[44:47],0
v_cvt_pk_bf16_f32 v34,v100,v101
v_cvt_pk_bf16_f32 v248,v248,v249
s_waitcnt vmcnt(5)
s_barrier
v_smfmac_f32_16x16x64_bf16 v[64:67],a[152:155],v[28:35],v18
buffer_load_dwordx4 v6,s[4:7],s20 offen offset:0 lds
v_mfma_f32_16x16x32_bf16 v[84:87],a[144:147],a[40:43],v[84:87]
v_cvt_pk_bf16_f32 v249,v250,v251
v_fma_f32 v108,v108,s36,v17
v_mfma_f32_16x16x32_bf16 v[84:87],a[140:143],a[36:39],v[84:87]
ds_write_b64 v38,v[248:249] offset:8192
v_mfma_f32_16x16x32_bf16 v[84:87],a[136:139],a[32:35],v[84:87]
v_fma_f32 v111,v111,s36,v17
v_exp_f32 v111,v111
v_mfma_f32_16x16x32_bf16 v[84:87],a[132:135],a[28:31],v[84:87]
v_exp_f32 v108,v108
v_mfma_f32_16x16x32_bf16 v[84:87],a[128:131],a[24:27],v[84:87]
v_fma_f32 v110,v110,s36,v17
v_fma_f32 v109,v109,s36,v17
v_mfma_f32_16x16x32_bf16 v[92:95],a[128:131],a[48:51],0
buffer_load_dwordx4 v7,s[4:7],s20 offen offset:1024 lds
v_mfma_f32_16x16x32_bf16 v[92:95],a[132:135],a[52:55],v[92:95]
v_exp_f32 v109,v109
v_mfma_f32_16x16x32_bf16 v[92:95],a[136:139],a[56:59],v[92:95]
v_exp_f32 v110,v110
v_mfma_f32_16x16x32_bf16 v[92:95],a[140:143],a[60:63],v[92:95]
ds_read_b64_tr_b16 a[122:123],v2 offset:6144
v_cvt_pk_bf16_f32 v252,v252,v253
v_mfma_f32_16x16x32_bf16 v[92:95],a[144:147],a[64:67],v[92:95]
ds_read_b64_tr_b16 a[120:121],v2 offset:0
v_cvt_pk_bf16_f32 v253,v254,v255
v_mfma_f32_16x16x32_bf16 v[92:95],a[148:151],a[68:71],v[92:95]
buffer_load_dwordx4 v8,s[4:7],s20 offen offset:2048 lds
v_mfma_f32_16x16x32_bf16 v[100:103],a[148:151],a[92:95],0
s_add_u32 s20,s20,12288
ds_write_b64 v39,v[252:253] offset:8192
v_mfma_f32_16x16x32_bf16 v[100:103],a[144:147],a[88:91],v[100:103]
ds_read_b64_tr_b16 a[124:125],v3 offset:0
v_cvt_pk_bf16_f32 v39,v110,v111
v_mfma_f32_16x16x32_bf16 v[100:103],a[140:143],a[84:87],v[100:103]
ds_read_b64_tr_b16 a[126:127],v3 offset:6144
v_cvt_pk_bf16_f32 v38,v108,v109
v_mfma_f32_16x16x32_bf16 v[100:103],a[136:139],a[80:83],v[100:103]
v_fma_f32 v81,v81,s36,v14
v_fma_f32 v80,v80,s36,v14
v_mfma_f32_16x16x32_bf16 v[100:103],a[132:135],a[76:79],v[100:103]
v_exp_f32 v81,v81
v_mfma_f32_16x16x32_bf16 v[100:103],a[128:131],a[72:75],v[100:103]
v_fma_f32 v74,v74,s36,v13
v_exp_f32 v74,v74
v_mfma_f32_16x16x32_bf16 v[108:111],a[128:131],a[96:99],0
ds_read_b64_tr_b16 a[130:131],v4 offset:6144
v_fma_f32 v72,v72,s36,v13
v_mfma_f32_16x16x32_bf16 v[108:111],a[132:135],a[100:103],v[108:111]
ds_read_b64_tr_b16 a[128:129],v4 offset:0
v_exp_f32 v72,v72
v_mfma_f32_16x16x32_bf16 v[108:111],a[136:139],a[104:107],v[108:111]
ds_read_b64_tr_b16 a[132:133],v5 offset:0
v_fma_f32 v82,v82,s36,v14
v_mfma_f32_16x16x32_bf16 v[108:111],a[140:143],a[108:111],v[108:111]
ds_read_b64_tr_b16 a[134:135],v5 offset:6144
v_exp_f32 v82,v82
v_mfma_f32_16x16x32_bf16 v[108:111],a[144:147],a[112:115],v[108:111]
v_fma_f32 v75,v75,s36,v13
v_exp_f32 v75,v75
v_mfma_f32_16x16x32_bf16 v[108:111],a[148:151],a[116:119],v[108:111]
v_cvt_pk_bf16_f32 v45,v74,v75
v_fma_f32 v89,v89,s36,v15
v_exp_f32 v89,v89
v_fma_f32 v88,v88,s36,v15
v_exp_f32 v88,v88
v_fma_f32 v83,v83,s36,v14
v_cvt_pk_bf16_f32 v52,v88,v89
v_exp_f32 v80,v80
v_fma_f32 v73,v73,s36,v13
v_exp_f32 v73,v73
v_cvt_pk_bf16_f32 v48,v80,v81
v_cvt_pk_bf16_f32 v44,v72,v73
v_exp_f32 v83,v83
s_nop 0
v_cvt_pk_bf16_f32 v49,v82,v83
s_waitcnt lgkmcnt(0)
v_mfma_f32_16x16x32_bf16 v[160:163],a[120:123],v[20:23],0
s_add_u32 m0,s23,0
ds_read_b64_tr_b16 a[136:137],v2 offset:128
v_fma_f32 v90,v90,s36,v15
v_mfma_f32_16x16x32_bf16 v[164:167],a[124:127],v[20:23],0
ds_read_b64_tr_b16 a[138:139],v2 offset:6272
v_fma_f32 v91,v91,s36,v15
v_mfma_f32_16x16x32_bf16 v[212:215],a[124:127],v[24:27],0
ds_read_b64_tr_b16 a[140:141],v3 offset:128
v_fma_f32 v96,v96,s36,v16
v_mfma_f32_16x16x32_bf16 v[208:211],a[120:123],v[24:27],0
ds_read_b64_tr_b16 a[142:143],v3 offset:6272
v_fma_f32 v97,v97,s36,v16
v_mfma_f32_16x16x32_bf16 v[112:115],a[120:123],v[28:31],0
ds_read_b64_tr_b16 a[144:145],v4 offset:128
v_fma_f32 v98,v98,s36,v16
v_mfma_f32_16x16x32_bf16 v[116:119],a[124:127],v[28:31],0
ds_read_b64_tr_b16 a[146:147],v4 offset:6272
v_fma_f32 v99,v99,s36,v16
v_mfma_f32_16x16x32_bf16 a[164:167],a[124:127],v[32:35],0
ds_read_b64_tr_b16 a[148:149],v5 offset:128
v_fma_f32 v104,v104,s36,v17
v_mfma_f32_16x16x32_bf16 a[160:163],a[120:123],v[32:35],0
ds_read_b64_tr_b16 a[150:151],v5 offset:6272
v_fma_f32 v105,v105,s36,v17
v_mfma_f32_16x16x32_bf16 a[208:211],a[120:123],v[36:39],0
ds_read_b64_tr_b16 a[120:121],v2 offset:256
v_fma_f32 v106,v106,s36,v17
v_mfma_f32_16x16x32_bf16 a[212:215],a[124:127],v[36:39],0
ds_read_b64_tr_b16 a[122:123],v2 offset:6400
v_fma_f32 v107,v107,s36,v17
v_mfma_f32_16x16x32_bf16 a[216:219],a[128:131],v[36:39],0
ds_read_b64_tr_b16 a[124:125],v3 offset:256
v_fma_f32 v76,v76,s36,v13
v_mfma_f32_16x16x32_bf16 a[220:223],a[132:135],v[36:39],0
ds_read_b64_tr_b16 a[126:127],v3 offset:6400
v_fma_f32 v77,v77,s36,v13
v_mfma_f32_16x16x32_bf16 a[172:175],a[132:135],v[32:35],0
v_exp_f32 v90,v90
v_mfma_f32_16x16x32_bf16 a[168:171],a[128:131],v[32:35],0
v_exp_f32 v91,v91
v_mfma_f32_16x16x32_bf16 v[120:123],a[128:131],v[28:31],0
v_cvt_pk_bf16_f32 v53,v90,v91
v_fma_f32 v78,v78,s36,v13
v_mfma_f32_16x16x32_bf16 v[124:127],a[132:135],v[28:31],0
v_exp_f32 v96,v96
v_mfma_f32_16x16x32_bf16 v[220:223],a[132:135],v[24:27],0
v_exp_f32 v97,v97
v_mfma_f32_16x16x32_bf16 v[216:219],a[128:131],v[24:27],0
v_exp_f32 v98,v98
v_mfma_f32_16x16x32_bf16 v[168:171],a[128:131],v[20:23],0
ds_read_b64_tr_b16 a[128:129],v4 offset:256
v_cvt_pk_bf16_f32 v56,v96,v97
v_mfma_f32_16x16x32_bf16 v[172:175],a[132:135],v[20:23],0
s_waitcnt lgkmcnt(1)
ds_read_b64_tr_b16 a[130:131],v4 offset:6400
v_fma_f32 v79,v79,s36,v13
v_mfma_f32_16x16x32_bf16 v[176:179],a[136:139],v[20:23],0
ds_read_b64_tr_b16 a[132:133],v5 offset:256
v_fma_f32 v84,v84,s36,v14
v_mfma_f32_16x16x32_bf16 v[180:183],a[140:143],v[20:23],0
ds_read_b64_tr_b16 a[134:135],v5 offset:6400
v_fma_f32 v85,v85,s36,v14
v_mfma_f32_16x16x32_bf16 v[228:231],a[140:143],v[24:27],0
v_exp_f32 v99,v99
v_mfma_f32_16x16x32_bf16 v[224:227],a[136:139],v[24:27],0
v_cvt_pk_bf16_f32 v57,v98,v99
v_fma_f32 v86,v86,s36,v14
v_mfma_f32_16x16x32_bf16 v[128:131],a[136:139],v[28:31],0
v_exp_f32 v104,v104
v_mfma_f32_16x16x32_bf16 v[132:135],a[140:143],v[28:31],0
v_exp_f32 v105,v105
v_mfma_f32_16x16x32_bf16 a[180:183],a[140:143],v[32:35],0
v_exp_f32 v106,v106
v_mfma_f32_16x16x32_bf16 a[176:179],a[136:139],v[32:35],0
v_exp_f32 v107,v107
v_mfma_f32_16x16x32_bf16 a[224:227],a[136:139],v[36:39],0
v_cvt_pk_bf16_f32 v40,v104,v105
v_cvt_pk_bf16_f32 v41,v106,v107
v_mfma_f32_16x16x32_bf16 a[228:231],a[140:143],v[36:39],0
v_exp_f32 v76,v76
v_mfma_f32_16x16x32_bf16 a[232:235],a[144:147],v[36:39],0
v_exp_f32 v77,v77
v_mfma_f32_16x16x32_bf16 a[236:239],a[148:151],v[36:39],0
v_exp_f32 v78,v78
v_mfma_f32_16x16x32_bf16 a[188:191],a[148:151],v[32:35],0
v_exp_f32 v79,v79
v_mfma_f32_16x16x32_bf16 a[184:187],a[144:147],v[32:35],0
v_cvt_pk_bf16_f32 v46,v76,v77
v_cvt_pk_bf16_f32 v47,v78,v79
v_mfma_f32_16x16x32_bf16 v[136:139],a[144:147],v[28:31],0
v_fma_f32 v87,v87,s36,v14
v_fma_f32 v92,v92,s36,v15
v_mfma_f32_16x16x32_bf16 v[140:143],a[148:151],v[28:31],0
v_exp_f32 v84,v84
v_mfma_f32_16x16x32_bf16 v[236:239],a[148:151],v[24:27],0
v_exp_f32 v85,v85
v_mfma_f32_16x16x32_bf16 v[232:235],a[144:147],v[24:27],0
v_exp_f32 v86,v86
v_mfma_f32_16x16x32_bf16 v[184:187],a[144:147],v[20:23],0
v_exp_f32 v87,v87
v_mfma_f32_16x16x32_bf16 v[188:191],a[148:151],v[20:23],0
v_cvt_pk_bf16_f32 v50,v84,v85
v_cvt_pk_bf16_f32 v51,v86,v87
v_mfma_f32_16x16x32_bf16 v[192:195],a[120:123],v[20:23],0
s_waitcnt vmcnt(30) lgkmcnt(0)
v_fma_f32 v93,v93,s36,v15
v_fma_f32 v94,v94,s36,v15
v_smfmac_f32_16x16x64_bf16 v[60:63],a[152:155],v[44:51],v18
s_barrier
v_mfma_f32_16x16x32_bf16 v[196:199],a[124:127],v[20:23],0
ds_read_b128 a[136:139],v0 offset:24576
v_fma_f32 v95,v95,s36,v15
v_mfma_f32_16x16x32_bf16 v[244:247],a[124:127],v[24:27],0
ds_read_b128 a[140:143],v1 offset:24576
v_fma_f32 v100,v100,s36,v16
v_mfma_f32_16x16x32_bf16 v[240:243],a[120:123],v[24:27],0
ds_read_b128 a[144:147],v0 offset:24704
v_fma_f32 v101,v101,s36,v16
v_mfma_f32_16x16x32_bf16 v[144:147],a[120:123],v[28:31],0
ds_read_b128 a[148:151],v1 offset:24704
v_fma_f32 v102,v102,s36,v16
v_mfma_f32_16x16x32_bf16 v[148:151],a[124:127],v[28:31],0
v_exp_f32 v92,v92
v_mfma_f32_16x16x32_bf16 a[196:199],a[124:127],v[32:35],0
buffer_load_dwordx4 v6,s[8:11],s21 offen offset:0 lds
v_mfma_f32_16x16x32_bf16 a[192:195],a[120:123],v[32:35],0
v_exp_f32 v93,v93
v_mfma_f32_16x16x32_bf16 a[240:243],a[120:123],v[36:39],0
ds_read_b128 a[120:123],v0 offset:24832
v_cvt_pk_bf16_f32 v54,v92,v93
v_mfma_f32_16x16x32_bf16 a[244:247],a[124:127],v[36:39],0
ds_read_b128 a[124:127],v1 offset:24832
v_fma_f32 v103,v103,s36,v16
v_mfma_f32_16x16x32_bf16 a[248:251],a[128:131],v[36:39],0
v_exp_f32 v94,v94
v_mfma_f32_16x16x32_bf16 a[252:255],a[132:135],v[36:39],0
v_exp_f32 v95,v95
v_mfma_f32_16x16x32_bf16 a[204:207],a[132:135],v[32:35],0
v_cvt_pk_bf16_f32 v55,v94,v95
v_fma_f32 v108,v108,s36,v17
v_mfma_f32_16x16x32_bf16 a[200:203],a[128:131],v[32:35],0
v_exp_f32 v100,v100
v_mfma_f32_16x16x32_bf16 v[152:155],a[128:131],v[28:31],0
v_exp_f32 v101,v101
v_mfma_f32_16x16x32_bf16 v[156:159],a[132:135],v[28:31],0
v_exp_f32 v102,v102
v_mfma_f32_16x16x32_bf16 v[252:255],a[132:135],v[24:27],0
v_exp_f32 v103,v103
v_mfma_f32_16x16x32_bf16 v[248:251],a[128:131],v[24:27],0
buffer_load_dwordx4 v7,s[8:11],s21 offen offset:1024 lds
v_mfma_f32_16x16x32_bf16 v[200:203],a[128:131],v[20:23],0
ds_read_b128 a[128:131],v0 offset:30720
v_cvt_pk_bf16_f32 v58,v100,v101
v_mfma_f32_16x16x32_bf16 v[204:207],a[132:135],v[20:23],0
s_waitcnt lgkmcnt(1)
ds_read_b128 a[132:135],v1 offset:30720
v_cvt_pk_bf16_f32 v59,v102,v103
v_mfma_f32_16x16x32_bf16 v[72:75],a[136:139],a[0:3],0
v_fma_f32 v109,v109,s36,v17
v_fma_f32 v110,v110,s36,v17
v_smfmac_f32_16x16x64_bf16 v[64:67],a[152:155],v[52:59],v18
v_fma_f32 v111,v111,s36,v17
v_mfma_f32_16x16x32_bf16 v[72:75],a[140:143],a[4:7],v[72:75]
v_exp_f32 v108,v108
v_mfma_f32_16x16x32_bf16 v[72:75],a[144:147],a[8:11],v[72:75]
v_exp_f32 v109,v109
v_mfma_f32_16x16x32_bf16 v[72:75],a[148:151],a[12:15],v[72:75]
v_exp_f32 v110,v110
v_mfma_f32_16x16x32_bf16 v[72:75],a[120:123],a[16:19],v[72:75]
v_exp_f32 v111,v111
v_mfma_f32_16x16x32_bf16 v[72:75],a[124:127],a[20:23],v[72:75]
v_cvt_pk_bf16_f32 v42,v108,v109
v_cvt_pk_bf16_f32 v43,v110,v111
v_mfma_f32_16x16x32_bf16 v[80:83],a[124:127],a[44:47],0
v_mfma_f32_16x16x32_bf16 v[80:83],a[120:123],a[40:43],v[80:83]
v_smfmac_f32_16x16x64_bf16 v[68:71],a[152:155],v[36:43],v18
buffer_load_dwordx4 v8,s[8:11],s21 offen offset:2048 lds
v_mfma_f32_16x16x32_bf16 v[80:83],a[148:151],a[36:39],v[80:83]
s_add_u32 s21,s21,12288
v_fma_f32 v72,v72,s36,v13
v_fma_f32 v73,v73,s36,v13
v_mfma_f32_16x16x32_bf16 v[80:83],a[144:147],a[32:35],v[80:83]
s_add_u32 m0,s22,12288
v_fma_f32 v74,v74,s36,v13
v_fma_f32 v75,v75,s36,v13
v_mfma_f32_16x16x32_bf16 v[80:83],a[140:143],a[28:31],v[80:83]
v_exp_f32 v72,v72
v_mfma_f32_16x16x32_bf16 v[80:83],a[136:139],a[24:27],v[80:83]
v_exp_f32 v73,v73
v_mfma_f32_16x16x32_bf16 v[88:91],a[136:139],a[48:51],0
v_exp_f32 v74,v74
v_mfma_f32_16x16x32_bf16 v[88:91],a[140:143],a[52:55],v[88:91]
v_exp_f32 v75,v75
v_mfma_f32_16x16x32_bf16 v[88:91],a[144:147],a[56:59],v[88:91]
v_cvt_pk_bf16_f32 v20,v72,v73
v_cvt_pk_bf16_f32 v21,v74,v75
v_mfma_f32_16x16x32_bf16 v[88:91],a[148:151],a[60:63],v[88:91]
v_fma_f32 v80,v80,s36,v14
v_fma_f32 v81,v81,s36,v14
v_mfma_f32_16x16x32_bf16 v[88:91],a[120:123],a[64:67],v[88:91]
v_fma_f32 v82,v82,s36,v14
v_fma_f32 v83,v83,s36,v14
v_mfma_f32_16x16x32_bf16 v[88:91],a[124:127],a[68:71],v[88:91]
v_exp_f32 v80,v80
v_mfma_f32_16x16x32_bf16 v[96:99],a[124:127],a[92:95],0
buffer_load_dwordx4 v6,s[4:7],s20 offen offset:0 lds
v_mfma_f32_16x16x32_bf16 v[96:99],a[120:123],a[88:91],v[96:99]
v_exp_f32 v81,v81
v_mfma_f32_16x16x32_bf16 v[96:99],a[148:151],a[84:87],v[96:99]
v_exp_f32 v82,v82
v_mfma_f32_16x16x32_bf16 v[96:99],a[144:147],a[80:83],v[96:99]
v_fma_f32 v88,v88,s36,v15
v_fma_f32 v89,v89,s36,v15
v_mfma_f32_16x16x32_bf16 v[96:99],a[140:143],a[76:79],v[96:99]
v_exp_f32 v83,v83
v_mfma_f32_16x16x32_bf16 v[96:99],a[136:139],a[72:75],v[96:99]
v_exp_f32 v88,v88
v_mfma_f32_16x16x32_bf16 v[104:107],a[136:139],a[96:99],0
ds_read_b128 a[136:139],v0 offset:30848
v_cvt_pk_bf16_f32 v24,v80,v81
v_mfma_f32_16x16x32_bf16 v[104:107],a[140:143],a[100:103],v[104:107]
ds_read_b128 a[140:143],v1 offset:30848
v_cvt_pk_bf16_f32 v25,v82,v83
v_mfma_f32_16x16x32_bf16 v[104:107],a[144:147],a[104:107],v[104:107]
ds_read_b128 a[144:147],v0 offset:30976
v_mfma_f32_16x16x32_bf16 v[104:107],a[148:151],a[108:111],v[104:107]
ds_read_b128 a[148:151],v1 offset:30976
v_mfma_f32_16x16x32_bf16 v[104:107],a[120:123],a[112:115],v[104:107]
v_exp_f32 v89,v89
v_mfma_f32_16x16x32_bf16 v[104:107],a[124:127],a[116:119],v[104:107]
s_waitcnt lgkmcnt(4)
v_cvt_pk_bf16_f32 v28,v88,v89
v_mfma_f32_16x16x32_bf16 v[76:79],a[128:131],a[0:3],0
buffer_load_dwordx4 v7,s[4:7],s20 offen offset:1024 lds
v_mfma_f32_16x16x32_bf16 v[76:79],a[132:135],a[4:7],v[76:79]
s_waitcnt lgkmcnt(3)
v_mfma_f32_16x16x32_bf16 v[76:79],a[136:139],a[8:11],v[76:79]
s_waitcnt lgkmcnt(2)
v_mfma_f32_16x16x32_bf16 v[76:79],a[140:143],a[12:15],v[76:79]
s_waitcnt lgkmcnt(1)
v_mfma_f32_16x16x32_bf16 v[76:79],a[144:147],a[16:19],v[76:79]
s_waitcnt lgkmcnt(0)
v_mfma_f32_16x16x32_bf16 v[76:79],a[148:151],a[20:23],v[76:79]
v_mfma_f32_16x16x32_bf16 v[84:87],a[148:151],a[44:47],0
v_mfma_f32_16x16x32_bf16 v[84:87],a[144:147],a[40:43],v[84:87]
v_mfma_f32_16x16x32_bf16 v[84:87],a[140:143],a[36:39],v[84:87]
v_mfma_f32_16x16x32_bf16 v[84:87],a[136:139],a[32:35],v[84:87]
v_mfma_f32_16x16x32_bf16 v[84:87],a[132:135],a[28:31],v[84:87]
v_mfma_f32_16x16x32_bf16 v[84:87],a[128:131],a[24:27],v[84:87]
v_mfma_f32_16x16x32_bf16 v[92:95],a[128:131],a[48:51],0
buffer_load_dwordx4 v8,s[4:7],s20 offen offset:2048 lds
v_mfma_f32_16x16x32_bf16 v[92:95],a[132:135],a[52:55],v[92:95]
s_add_u32 s20,s20,12288
v_mfma_f32_16x16x32_bf16 v[92:95],a[136:139],a[56:59],v[92:95]
v_mfma_f32_16x16x32_bf16 v[92:95],a[140:143],a[60:63],v[92:95]
v_mfma_f32_16x16x32_bf16 v[92:95],a[144:147],a[64:67],v[92:95]
v_mfma_f32_16x16x32_bf16 v[92:95],a[148:151],a[68:71],v[92:95]
ds_read_b64_tr_b16 a[120:121],v2 offset:12288
v_mfma_f32_16x16x32_bf16 v[100:103],a[148:151],a[92:95],0
ds_read_b64_tr_b16 a[122:123],v2 offset:18432
v_mfma_f32_16x16x32_bf16 v[100:103],a[144:147],a[88:91],v[100:103]
v_mfma_f32_16x16x32_bf16 v[100:103],a[140:143],a[84:87],v[100:103]
ds_read_b64_tr_b16 a[124:125],v3 offset:12288
v_mfma_f32_16x16x32_bf16 v[100:103],a[136:139],a[80:83],v[100:103]
ds_read_b64_tr_b16 a[126:127],v3 offset:18432
v_mfma_f32_16x16x32_bf16 v[100:103],a[132:135],a[76:79],v[100:103]
v_mfma_f32_16x16x32_bf16 v[100:103],a[128:131],a[72:75],v[100:103]
v_mfma_f32_16x16x32_bf16 v[108:111],a[128:131],a[96:99],0
ds_read_b64_tr_b16 a[128:129],v4 offset:12288
v_mfma_f32_16x16x32_bf16 v[108:111],a[132:135],a[100:103],v[108:111]
ds_read_b64_tr_b16 a[130:131],v4 offset:18432
v_mfma_f32_16x16x32_bf16 v[108:111],a[136:139],a[104:107],v[108:111]
ds_read_b64_tr_b16 a[132:133],v5 offset:12288
v_mfma_f32_16x16x32_bf16 v[108:111],a[140:143],a[108:111],v[108:111]
ds_read_b64_tr_b16 a[134:135],v5 offset:18432
v_mfma_f32_16x16x32_bf16 v[108:111],a[144:147],a[112:115],v[108:111]
v_mfma_f32_16x16x32_bf16 v[108:111],a[148:151],a[116:119],v[108:111]
s_waitcnt lgkmcnt(4)
v_mfma_f32_16x16x32_bf16 v[160:163],a[120:123],v[44:47],v[160:163]
s_add_u32 m0,s23,12288
ds_read_b64_tr_b16 a[136:137],v2 offset:12416
v_fma_f32 v90,v90,s36,v15
v_mfma_f32_16x16x32_bf16 v[164:167],a[124:127],v[44:47],v[164:167]
ds_read_b64_tr_b16 a[138:139],v2 offset:18560
v_fma_f32 v91,v91,s36,v15
v_mfma_f32_16x16x32_bf16 v[212:215],a[124:127],v[48:51],v[212:215]
ds_read_b64_tr_b16 a[140:141],v3 offset:12416
v_fma_f32 v96,v96,s36,v16
v_mfma_f32_16x16x32_bf16 v[208:211],a[120:123],v[48:51],v[208:211]
ds_read_b64_tr_b16 a[142:143],v3 offset:18560
v_fma_f32 v97,v97,s36,v16
v_mfma_f32_16x16x32_bf16 v[112:115],a[120:123],v[52:55],v[112:115]
ds_read_b64_tr_b16 a[144:145],v4 offset:12416
v_fma_f32 v98,v98,s36,v16
v_mfma_f32_16x16x32_bf16 v[116:119],a[124:127],v[52:55],v[116:119]
ds_read_b64_tr_b16 a[146:147],v4 offset:18560
v_fma_f32 v99,v99,s36,v16
v_mfma_f32_16x16x32_bf16 a[164:167],a[124:127],v[56:59],a[164:167]
ds_read_b64_tr_b16 a[148:149],v5 offset:12416
v_fma_f32 v104,v104,s36,v17
v_mfma_f32_16x16x32_bf16 a[160:163],a[120:123],v[56:59],a[160:163]
ds_read_b64_tr_b16 a[150:151],v5 offset:18560
v_fma_f32 v105,v105,s36,v17
v_mfma_f32_16x16x32_bf16 a[208:211],a[120:123],v[40:43],a[208:211]
ds_read_b64_tr_b16 a[120:121],v2 offset:12544
v_fma_f32 v106,v106,s36,v17
v_mfma_f32_16x16x32_bf16 a[212:215],a[124:127],v[40:43],a[212:215]
s_waitcnt lgkmcnt(6)
ds_read_b64_tr_b16 a[122:123],v2 offset:18688
v_fma_f32 v107,v107,s36,v17
v_mfma_f32_16x16x32_bf16 a[216:219],a[128:131],v[40:43],a[216:219]
ds_read_b64_tr_b16 a[124:125],v3 offset:12544
v_fma_f32 v76,v76,s36,v13
v_mfma_f32_16x16x32_bf16 a[220:223],a[132:135],v[40:43],a[220:223]
ds_read_b64_tr_b16 a[126:127],v3 offset:18688
v_fma_f32 v77,v77,s36,v13
v_mfma_f32_16x16x32_bf16 a[172:175],a[132:135],v[56:59],a[172:175]
v_exp_f32 v90,v90
v_mfma_f32_16x16x32_bf16 a[168:171],a[128:131],v[56:59],a[168:171]
v_exp_f32 v91,v91
v_mfma_f32_16x16x32_bf16 v[120:123],a[128:131],v[52:55],v[120:123]
v_cvt_pk_bf16_f32 v29,v90,v91
v_fma_f32 v78,v78,s36,v13
v_mfma_f32_16x16x32_bf16 v[124:127],a[132:135],v[52:55],v[124:127]
v_exp_f32 v96,v96
v_mfma_f32_16x16x32_bf16 v[220:223],a[132:135],v[48:51],v[220:223]
v_exp_f32 v97,v97
v_mfma_f32_16x16x32_bf16 v[216:219],a[128:131],v[48:51],v[216:219]
v_exp_f32 v98,v98
v_mfma_f32_16x16x32_bf16 v[168:171],a[128:131],v[44:47],v[168:171]
ds_read_b64_tr_b16 a[128:129],v4 offset:12544
v_cvt_pk_bf16_f32 v32,v96,v97
v_mfma_f32_16x16x32_bf16 v[172:175],a[132:135],v[44:47],v[172:175]
ds_read_b64_tr_b16 a[130:131],v4 offset:18688
v_fma_f32 v79,v79,s36,v13
v_mfma_f32_16x16x32_bf16 v[176:179],a[136:139],v[44:47],v[176:179]
s_waitcnt lgkmcnt(2)
ds_read_b64_tr_b16 a[132:133],v5 offset:12544
v_fma_f32 v84,v84,s36,v14
v_mfma_f32_16x16x32_bf16 v[180:183],a[140:143],v[44:47],v[180:183]
ds_read_b64_tr_b16 a[134:135],v5 offset:18688
v_fma_f32 v85,v85,s36,v14
v_mfma_f32_16x16x32_bf16 v[228:231],a[140:143],v[48:51],v[228:231]
v_exp_f32 v99,v99
v_mfma_f32_16x16x32_bf16 v[224:227],a[136:139],v[48:51],v[224:227]
v_cvt_pk_bf16_f32 v33,v98,v99
v_fma_f32 v86,v86,s36,v14
v_mfma_f32_16x16x32_bf16 v[128:131],a[136:139],v[52:55],v[128:131]
v_exp_f32 v104,v104
v_mfma_f32_16x16x32_bf16 v[132:135],a[140:143],v[52:55],v[132:135]
v_exp_f32 v105,v105
v_mfma_f32_16x16x32_bf16 a[180:183],a[140:143],v[56:59],a[180:183]
v_exp_f32 v106,v106
v_mfma_f32_16x16x32_bf16 a[176:179],a[136:139],v[56:59],a[176:179]
v_exp_f32 v107,v107
v_mfma_f32_16x16x32_bf16 a[224:227],a[136:139],v[40:43],a[224:227]
v_cvt_pk_bf16_f32 v36,v104,v105
v_cvt_pk_bf16_f32 v37,v106,v107
v_mfma_f32_16x16x32_bf16 a[228:231],a[140:143],v[40:43],a[228:231]
v_exp_f32 v76,v76
v_mfma_f32_16x16x32_bf16 a[232:235],a[144:147],v[40:43],a[232:235]
v_exp_f32 v77,v77
v_mfma_f32_16x16x32_bf16 a[236:239],a[148:151],v[40:43],a[236:239]
v_exp_f32 v78,v78
v_mfma_f32_16x16x32_bf16 a[188:191],a[148:151],v[56:59],a[188:191]
v_exp_f32 v79,v79
v_mfma_f32_16x16x32_bf16 a[184:187],a[144:147],v[56:59],a[184:187]
v_cvt_pk_bf16_f32 v22,v76,v77
v_cvt_pk_bf16_f32 v23,v78,v79
v_mfma_f32_16x16x32_bf16 v[136:139],a[144:147],v[52:55],v[136:139]
v_fma_f32 v87,v87,s36,v14
v_fma_f32 v92,v92,s36,v15
v_mfma_f32_16x16x32_bf16 v[140:143],a[148:151],v[52:55],v[140:143]
v_exp_f32 v84,v84
v_mfma_f32_16x16x32_bf16 v[236:239],a[148:151],v[48:51],v[236:239]
v_exp_f32 v85,v85
v_mfma_f32_16x16x32_bf16 v[232:235],a[144:147],v[48:51],v[232:235]
v_exp_f32 v86,v86
v_mfma_f32_16x16x32_bf16 v[184:187],a[144:147],v[44:47],v[184:187]
v_exp_f32 v87,v87
v_mfma_f32_16x16x32_bf16 v[188:191],a[148:151],v[44:47],v[188:191]
v_cvt_pk_bf16_f32 v26,v84,v85
v_cvt_pk_bf16_f32 v27,v86,v87
v_mfma_f32_16x16x32_bf16 v[192:195],a[120:123],v[44:47],v[192:195]
s_waitcnt vmcnt(6) lgkmcnt(0)
v_fma_f32 v93,v93,s36,v15
v_fma_f32 v94,v94,s36,v15
v_smfmac_f32_16x16x64_bf16 v[60:63],a[152:155],v[20:27],v18
s_barrier
v_mfma_f32_16x16x32_bf16 v[196:199],a[124:127],v[44:47],v[196:199]
ds_read_b128 a[136:139],v0 offset:0
v_fma_f32 v95,v95,s36,v15
v_mfma_f32_16x16x32_bf16 v[244:247],a[124:127],v[48:51],v[244:247]
ds_read_b128 a[140:143],v1 offset:0
v_fma_f32 v100,v100,s36,v16
v_mfma_f32_16x16x32_bf16 v[240:243],a[120:123],v[48:51],v[240:243]
ds_read_b128 a[144:147],v0 offset:128
v_fma_f32 v101,v101,s36,v16
v_mfma_f32_16x16x32_bf16 v[144:147],a[120:123],v[52:55],v[144:147]
ds_read_b128 a[148:151],v1 offset:128
v_fma_f32 v102,v102,s36,v16
v_mfma_f32_16x16x32_bf16 v[148:151],a[124:127],v[52:55],v[148:151]
v_exp_f32 v92,v92
v_mfma_f32_16x16x32_bf16 a[196:199],a[124:127],v[56:59],a[196:199]
buffer_load_dwordx4 v6,s[8:11],s21 offen offset:0 lds
v_mfma_f32_16x16x32_bf16 a[192:195],a[120:123],v[56:59],a[192:195]
v_exp_f32 v93,v93
v_mfma_f32_16x16x32_bf16 a[240:243],a[120:123],v[40:43],a[240:243]
ds_read_b128 a[120:123],v0 offset:256
v_cvt_pk_bf16_f32 v30,v92,v93
v_mfma_f32_16x16x32_bf16 a[244:247],a[124:127],v[40:43],a[244:247]
ds_read_b128 a[124:127],v1 offset:256
v_fma_f32 v103,v103,s36,v16
v_mfma_f32_16x16x32_bf16 a[248:251],a[128:131],v[40:43],a[248:251]
v_exp_f32 v94,v94
v_mfma_f32_16x16x32_bf16 a[252:255],a[132:135],v[40:43],a[252:255]
v_exp_f32 v95,v95
v_mfma_f32_16x16x32_bf16 a[204:207],a[132:135],v[56:59],a[204:207]
v_cvt_pk_bf16_f32 v31,v94,v95
v_fma_f32 v108,v108,s36,v17
v_mfma_f32_16x16x32_bf16 a[200:203],a[128:131],v[56:59],a[200:203]
v_exp_f32 v100,v100
v_mfma_f32_16x16x32_bf16 v[152:155],a[128:131],v[52:55],v[152:155]
v_exp_f32 v101,v101
v_mfma_f32_16x16x32_bf16 v[156:159],a[132:135],v[52:55],v[156:159]
v_exp_f32 v102,v102
v_mfma_f32_16x16x32_bf16 v[252:255],a[132:135],v[48:51],v[252:255]
v_exp_f32 v103,v103
v_mfma_f32_16x16x32_bf16 v[248:251],a[128:131],v[48:51],v[248:251]
buffer_load_dwordx4 v7,s[8:11],s21 offen offset:1024 lds
v_mfma_f32_16x16x32_bf16 v[200:203],a[128:131],v[44:47],v[200:203]
ds_read_b128 a[128:131],v0 offset:6144
v_cvt_pk_bf16_f32 v34,v100,v101
v_mfma_f32_16x16x32_bf16 v[204:207],a[132:135],v[44:47],v[204:207]
s_waitcnt lgkmcnt(1)
ds_read_b128 a[132:135],v1 offset:6144
v_cvt_pk_bf16_f32 v35,v102,v103
v_mfma_f32_16x16x32_bf16 v[72:75],a[136:139],a[0:3],0
v_fma_f32 v109,v109,s36,v17
v_fma_f32 v110,v110,s36,v17
v_smfmac_f32_16x16x64_bf16 v[64:67],a[152:155],v[28:35],v18
v_fma_f32 v111,v111,s36,v17
v_mfma_f32_16x16x32_bf16 v[72:75],a[140:143],a[4:7],v[72:75]
v_exp_f32 v108,v108
v_mfma_f32_16x16x32_bf16 v[72:75],a[144:147],a[8:11],v[72:75]
v_exp_f32 v109,v109
v_mfma_f32_16x16x32_bf16 v[72:75],a[148:151],a[12:15],v[72:75]
v_exp_f32 v110,v110
v_mfma_f32_16x16x32_bf16 v[72:75],a[120:123],a[16:19],v[72:75]
v_exp_f32 v111,v111
v_mfma_f32_16x16x32_bf16 v[72:75],a[124:127],a[20:23],v[72:75]
v_cvt_pk_bf16_f32 v38,v108,v109
v_cvt_pk_bf16_f32 v39,v110,v111
v_mfma_f32_16x16x32_bf16 v[80:83],a[124:127],a[44:47],0
v_mfma_f32_16x16x32_bf16 v[80:83],a[120:123],a[40:43],v[80:83]
v_mfma_f32_16x16x32_bf16 v[80:83],a[148:151],a[36:39],v[80:83]
buffer_load_dwordx4 v8,s[8:11],s21 offen offset:2048 lds
v_mfma_f32_16x16x32_bf16 v[80:83],a[144:147],a[32:35],v[80:83]
s_add_u32 s21,s21,12288
v_fma_f32 v72,v72,s36,v13
v_fma_f32 v73,v73,s36,v13
v_mfma_f32_16x16x32_bf16 v[80:83],a[140:143],a[28:31],v[80:83]
s_add_u32 m0,s22,24576
v_fma_f32 v74,v74,s36,v13
v_fma_f32 v75,v75,s36,v13
v_mfma_f32_16x16x32_bf16 v[80:83],a[136:139],a[24:27],v[80:83]
v_exp_f32 v72,v72
v_mfma_f32_16x16x32_bf16 v[88:91],a[136:139],a[48:51],0
v_exp_f32 v73,v73
v_mfma_f32_16x16x32_bf16 v[88:91],a[140:143],a[52:55],v[88:91]
v_exp_f32 v74,v74
v_mfma_f32_16x16x32_bf16 v[88:91],a[144:147],a[56:59],v[88:91]
v_exp_f32 v75,v75
v_mfma_f32_16x16x32_bf16 v[88:91],a[148:151],a[60:63],v[88:91]
v_fma_f32 v80,v80,s36,v14
v_fma_f32 v81,v81,s36,v14
v_mfma_f32_16x16x32_bf16 v[88:91],a[120:123],a[64:67],v[88:91]
v_fma_f32 v82,v82,s36,v14
v_fma_f32 v83,v83,s36,v14
v_mfma_f32_16x16x32_bf16 v[88:91],a[124:127],a[68:71],v[88:91]
v_exp_f32 v80,v80
v_mfma_f32_16x16x32_bf16 v[96:99],a[124:127],a[92:95],0
v_exp_f32 v81,v81
v_mfma_f32_16x16x32_bf16 v[96:99],a[120:123],a[88:91],v[96:99]
v_exp_f32 v82,v82
v_mfma_f32_16x16x32_bf16 v[96:99],a[148:151],a[84:87],v[96:99]
buffer_load_dwordx4 v6,s[4:7],s20 offen offset:0 lds
v_mfma_f32_16x16x32_bf16 v[96:99],a[144:147],a[80:83],v[96:99]
v_fma_f32 v88,v88,s36,v15
v_fma_f32 v89,v89,s36,v15
v_mfma_f32_16x16x32_bf16 v[96:99],a[140:143],a[76:79],v[96:99]
v_exp_f32 v83,v83
v_mfma_f32_16x16x32_bf16 v[96:99],a[136:139],a[72:75],v[96:99]
v_exp_f32 v88,v88
v_mfma_f32_16x16x32_bf16 v[104:107],a[136:139],a[96:99],0
ds_read_b128 a[136:139],v0 offset:6272
v_cvt_pk_bf16_f32 v44,v72,v73
v_mfma_f32_16x16x32_bf16 v[104:107],a[140:143],a[100:103],v[104:107]
ds_read_b128 a[140:143],v1 offset:6272
v_cvt_pk_bf16_f32 v45,v74,v75
v_mfma_f32_16x16x32_bf16 v[104:107],a[144:147],a[104:107],v[104:107]
ds_read_b128 a[144:147],v0 offset:6400
v_cvt_pk_bf16_f32 v48,v80,v81
v_mfma_f32_16x16x32_bf16 v[104:107],a[148:151],a[108:111],v[104:107]
ds_read_b128 a[148:151],v1 offset:6400
v_cvt_pk_bf16_f32 v49,v82,v83
v_mfma_f32_16x16x32_bf16 v[104:107],a[120:123],a[112:115],v[104:107]
v_exp_f32 v89,v89
v_mfma_f32_16x16x32_bf16 v[104:107],a[124:127],a[116:119],v[104:107]
s_waitcnt lgkmcnt(4)
v_cvt_pk_bf16_f32 v52,v88,v89
v_mfma_f32_16x16x32_bf16 v[76:79],a[128:131],a[0:3],0
v_mfma_f32_16x16x32_bf16 v[76:79],a[132:135],a[4:7],v[76:79]
buffer_load_dwordx4 v7,s[4:7],s20 offen offset:1024 lds
s_waitcnt lgkmcnt(3)
v_mfma_f32_16x16x32_bf16 v[76:79],a[136:139],a[8:11],v[76:79]
s_waitcnt lgkmcnt(2)
v_mfma_f32_16x16x32_bf16 v[76:79],a[140:143],a[12:15],v[76:79]
s_waitcnt lgkmcnt(1)
v_mfma_f32_16x16x32_bf16 v[76:79],a[144:147],a[16:19],v[76:79]
s_waitcnt lgkmcnt(0)
v_mfma_f32_16x16x32_bf16 v[76:79],a[148:151],a[20:23],v[76:79]
v_mfma_f32_16x16x32_bf16 v[84:87],a[148:151],a[44:47],0
v_mfma_f32_16x16x32_bf16 v[84:87],a[144:147],a[40:43],v[84:87]
v_mfma_f32_16x16x32_bf16 v[84:87],a[140:143],a[36:39],v[84:87]
v_mfma_f32_16x16x32_bf16 v[84:87],a[136:139],a[32:35],v[84:87]
v_mfma_f32_16x16x32_bf16 v[84:87],a[132:135],a[28:31],v[84:87]
v_mfma_f32_16x16x32_bf16 v[84:87],a[128:131],a[24:27],v[84:87]
v_mfma_f32_16x16x32_bf16 v[92:95],a[128:131],a[48:51],0
v_mfma_f32_16x16x32_bf16 v[92:95],a[132:135],a[52:55],v[92:95]
buffer_load_dwordx4 v8,s[4:7],s20 offen offset:2048 lds
v_mfma_f32_16x16x32_bf16 v[92:95],a[136:139],a[56:59],v[92:95]
s_add_u32 s20,s20,12288
v_mfma_f32_16x16x32_bf16 v[92:95],a[140:143],a[60:63],v[92:95]
v_mfma_f32_16x16x32_bf16 v[92:95],a[144:147],a[64:67],v[92:95]
v_mfma_f32_16x16x32_bf16 v[92:95],a[148:151],a[68:71],v[92:95]
v_mfma_f32_16x16x32_bf16 v[100:103],a[148:151],a[92:95],0
v_mfma_f32_16x16x32_bf16 v[100:103],a[144:147],a[88:91],v[100:103]
ds_read_b64_tr_b16 a[120:121],v2 offset:24576
v_mfma_f32_16x16x32_bf16 v[100:103],a[140:143],a[84:87],v[100:103]
ds_read_b64_tr_b16 a[122:123],v2 offset:30720
v_mfma_f32_16x16x32_bf16 v[100:103],a[136:139],a[80:83],v[100:103]
ds_read_b64_tr_b16 a[124:125],v3 offset:24576
v_mfma_f32_16x16x32_bf16 v[100:103],a[132:135],a[76:79],v[100:103]
ds_read_b64_tr_b16 a[126:127],v3 offset:30720
v_mfma_f32_16x16x32_bf16 v[100:103],a[128:131],a[72:75],v[100:103]
v_mfma_f32_16x16x32_bf16 v[108:111],a[128:131],a[96:99],0
ds_read_b64_tr_b16 a[128:129],v4 offset:24576
v_mfma_f32_16x16x32_bf16 v[108:111],a[132:135],a[100:103],v[108:111]
ds_read_b64_tr_b16 a[130:131],v4 offset:30720
v_mfma_f32_16x16x32_bf16 v[108:111],a[136:139],a[104:107],v[108:111]
ds_read_b64_tr_b16 a[132:133],v5 offset:24576
v_mfma_f32_16x16x32_bf16 v[108:111],a[140:143],a[108:111],v[108:111]
ds_read_b64_tr_b16 a[134:135],v5 offset:30720
v_mfma_f32_16x16x32_bf16 v[108:111],a[144:147],a[112:115],v[108:111]
v_mfma_f32_16x16x32_bf16 v[108:111],a[148:151],a[116:119],v[108:111]
s_mov_b32 s38,0
s_branch L_loop5
L_tr44:
s_waitcnt vmcnt(43)
s_waitcnt lgkmcnt(3)
v_mfma_f32_16x16x32_bf16 v[160:163],a[120:123],v[20:23],v[160:163]
s_add_u32 m0,s24,0
ds_read_b128 a[4:7],v12 offset:0
v_fma_f32 v79,v79,s36,v13
v_mfma_f32_16x16x32_bf16 v[164:167],a[124:127],v[20:23],v[164:167]
ds_read_b128 a[12:15],v12 offset:128
v_fma_f32 v100,v100,s36,v16
v_mfma_f32_16x16x32_bf16 v[212:215],a[124:127],v[24:27],v[212:215]
ds_read_b128 a[20:23],v12 offset:256
v_fma_f32 v101,v101,s36,v16
v_mfma_f32_16x16x32_bf16 v[208:211],a[120:123],v[24:27],v[208:211]
ds_read_b128 a[8:11],v11 offset:128
v_fma_f32 v89,v89,s36,v15
v_mfma_f32_16x16x32_bf16 v[112:115],a[120:123],v[28:31],v[112:115]
ds_read_b128 a[0:3],v11 offset:0
v_fma_f32 v76,v76,s36,v13
v_mfma_f32_16x16x32_bf16 v[116:119],a[124:127],v[28:31],v[116:119]
ds_read_b128 a[16:19],v11 offset:256
v_fma_f32 v83,v83,s36,v14
v_mfma_f32_16x16x32_bf16 a[164:167],a[124:127],v[32:35],a[164:167]
ds_read_b64_tr_b16 a[138:139],v2 offset:30848
v_fma_f32 v90,v90,s36,v15
v_mfma_f32_16x16x32_bf16 a[160:163],a[120:123],v[32:35],a[160:163]
s_waitcnt lgkmcnt(6)
ds_read_b64_tr_b16 a[136:137],v2 offset:24704
v_fma_f32 v88,v88,s36,v15
v_mfma_f32_16x16x32_bf16 a[168:171],a[128:131],v[32:35],a[168:171]
ds_read_b64_tr_b16 a[142:143],v3 offset:30848
ds_read_b64_tr_b16 a[140:141],v3 offset:24704
ds_read_b64_tr_b16 a[146:147],v4 offset:30848
ds_read_b64_tr_b16 a[144:145],v4 offset:24704
ds_read_b64_tr_b16 a[150:151],v5 offset:30848
ds_read_b64_tr_b16 a[148:149],v5 offset:24704
ds_read_b128 a[32:35],v11 offset:6272
v_mfma_f32_16x16x32_bf16 a[172:175],a[132:135],v[32:35],a[172:175]
v_fma_f32 v91,v91,s36,v15
ds_read_b128 a[40:43],v11 offset:6400
v_mfma_f32_16x16x32_bf16 v[124:127],a[132:135],v[28:31],v[124:127]
s_waitcnt lgkmcnt(10)
buffer_load_dwordx4 v6,s[12:15],s28 offen offset:0 nt lds
v_mfma_f32_16x16x32_bf16 v[120:123],a[128:131],v[28:31],v[120:123]
ds_read_b64_tr_b16 a[122:123],v2 offset:30976
ds_read_b64_tr_b16 a[120:121],v2 offset:24832
ds_read_b64_tr_b16 a[124:125],v3 offset:24832
ds_read_b64_tr_b16 a[126:127],v3 offset:30976
ds_read_b128 a[44:47],v12 offset:6400
v_mfma_f32_16x16x32_bf16 v[216:219],a[128:131],v[24:27],v[216:219]
v_fma_f32 v93,v93,s36,v15
ds_read_b128 a[28:31],v12 offset:6144
v_mfma_f32_16x16x32_bf16 v[220:223],a[132:135],v[24:27],v[220:223]
v_fma_f32 v98,v98,s36,v16
ds_read_b128 a[36:39],v12 offset:6272
v_mfma_f32_16x16x32_bf16 v[172:175],a[132:135],v[20:23],v[172:175]
buffer_load_dwordx4 v7,s[12:15],s28 offen offset:1024 nt lds
v_mfma_f32_16x16x32_bf16 v[168:171],a[128:131],v[20:23],v[168:171]
s_waitcnt lgkmcnt(7)
ds_read_b64_tr_b16 a[130:131],v4 offset:30976
ds_read_b128 a[24:27],v11 offset:6144
v_mfma_f32_16x16x32_bf16 v[176:179],a[136:139],v[20:23],v[176:179]
v_fma_f32 v82,v82,s36,v14
v_exp_f32 v93,v93
v_mfma_f32_16x16x32_bf16 v[180:183],a[140:143],v[20:23],v[180:183]
ds_read_b64_tr_b16 a[128:129],v4 offset:24832
v_fma_f32 v85,v85,s36,v14
v_mfma_f32_16x16x32_bf16 v[228:231],a[140:143],v[24:27],v[228:231]
ds_read_b64_tr_b16 a[134:135],v5 offset:30976
v_exp_f32 v82,v82
v_mfma_f32_16x16x32_bf16 v[224:227],a[136:139],v[24:27],v[224:227]
ds_read_b64_tr_b16 a[132:133],v5 offset:24832
v_fma_f32 v84,v84,s36,v14
v_mfma_f32_16x16x32_bf16 v[128:131],a[136:139],v[28:31],v[128:131]
v_exp_f32 v84,v84
v_mfma_f32_16x16x32_bf16 v[132:135],a[140:143],v[28:31],v[132:135]
buffer_load_dwordx4 v8,s[12:15],s28 offen offset:2048 nt lds
v_mfma_f32_16x16x32_bf16 a[180:183],a[140:143],v[32:35],a[180:183]
s_add_u32 s28,s28,3072
v_fma_f32 v103,v103,s36,v16
v_exp_f32 v103,v103
v_mfma_f32_16x16x32_bf16 a[176:179],a[136:139],v[32:35],a[176:179]
s_add_u32 m0,s24,3072
v_fma_f32 v87,v87,s36,v14
v_exp_f32 v87,v87
v_mfma_f32_16x16x32_bf16 a[184:187],a[144:147],v[32:35],a[184:187]
v_fma_f32 v77,v77,s36,v13
v_exp_f32 v77,v77
v_mfma_f32_16x16x32_bf16 a[188:191],a[148:151],v[32:35],a[188:191]
v_fma_f32 v97,v97,s36,v16
v_exp_f32 v91,v91
v_mfma_f32_16x16x32_bf16 v[140:143],a[148:151],v[28:31],v[140:143]
v_fma_f32 v102,v102,s36,v16
v_exp_f32 v85,v85
v_mfma_f32_16x16x32_bf16 v[136:139],a[144:147],v[28:31],v[136:139]
v_exp_f32 v89,v89
v_mfma_f32_16x16x32_bf16 v[232:235],a[144:147],v[24:27],v[232:235]
buffer_load_dwordx4 v6,s[12:15],s28 offen offset:0 nt lds
v_mfma_f32_16x16x32_bf16 v[236:239],a[148:151],v[24:27],v[236:239]
v_fma_f32 v92,v92,s36,v15
v_exp_f32 v101,v101
v_mfma_f32_16x16x32_bf16 v[188:191],a[148:151],v[20:23],v[188:191]
v_fma_f32 v94,v94,s36,v15
v_fma_f32 v95,v95,s36,v15
v_mfma_f32_16x16x32_bf16 v[184:187],a[144:147],v[20:23],v[184:187]
s_waitcnt lgkmcnt(0)
v_exp_f32 v95,v95
v_mfma_f32_16x16x32_bf16 v[192:195],a[120:123],v[20:23],v[192:195]
v_fma_f32 v86,v86,s36,v14
v_fma_f32 v78,v78,s36,v13
v_mfma_f32_16x16x32_bf16 v[196:199],a[124:127],v[20:23],v[196:199]
v_exp_f32 v92,v92
v_mfma_f32_16x16x32_bf16 v[244:247],a[124:127],v[24:27],v[244:247]
v_exp_f32 v78,v78
v_mfma_f32_16x16x32_bf16 v[240:243],a[120:123],v[24:27],v[240:243]
buffer_load_dwordx4 v7,s[12:15],s28 offen offset:1024 nt lds
v_mfma_f32_16x16x32_bf16 v[144:147],a[120:123],v[28:31],v[144:147]
v_exp_f32 v94,v94
v_mfma_f32_16x16x32_bf16 v[148:151],a[124:127],v[28:31],v[148:151]
v_exp_f32 v90,v90
v_mfma_f32_16x16x32_bf16 a[196:199],a[124:127],v[32:35],a[196:199]
v_fma_f32 v96,v96,s36,v16
v_exp_f32 v96,v96
v_mfma_f32_16x16x32_bf16 a[192:195],a[120:123],v[32:35],a[192:195]
v_fma_f32 v99,v99,s36,v16
v_exp_f32 v83,v83
v_mfma_f32_16x16x32_bf16 a[200:203],a[128:131],v[32:35],a[200:203]
v_exp_f32 v97,v97
v_mfma_f32_16x16x32_bf16 a[204:207],a[132:135],v[32:35],a[204:207]
v_exp_f32 v88,v88
v_mfma_f32_16x16x32_bf16 v[156:159],a[132:135],v[28:31],v[156:159]
v_exp_f32 v98,v98
v_mfma_f32_16x16x32_bf16 v[152:155],a[128:131],v[28:31],v[152:155]
buffer_load_dwordx4 v8,s[12:15],s28 offen offset:2048 nt lds
s_waitcnt vmcnt(18)
s_barrier
v_mfma_f32_16x16x32_bf16 v[248:251],a[128:131],v[24:27],v[248:251]
s_add_u32 s28,s28,3072
ds_read_b64_tr_b16 a[138:139],v2 offset:6144
v_exp_f32 v79,v79
v_mfma_f32_16x16x32_bf16 v[252:255],a[132:135],v[24:27],v[252:255]
s_add_u32 m0,s22,0
ds_read_b64_tr_b16 a[136:137],v2 offset:0
buffer_load_dwordx4 v6,s[4:7],s25 offen offset:0 lds
v_mfma_f32_16x16x32_bf16 v[204:207],a[132:135],v[20:23],v[204:207]
buffer_load_dwordx4 v7,s[4:7],s25 offen offset:1024 lds
v_mfma_f32_16x16x32_bf16 v[200:203],a[128:131],v[20:23],v[200:203]
buffer_load_dwordx4 v8,s[4:7],s25 offen offset:2048 lds
ds_read_b64_tr_b16 a[142:143],v3 offset:6144
ds_read_b64_tr_b16 a[140:141],v3 offset:0
ds_read_b64_tr_b16 a[144:145],v4 offset:0
ds_read_b64_tr_b16 a[146:147],v4 offset:6144
ds_read_b64_tr_b16 a[148:149],v5 offset:0
ds_read_b64_tr_b16 a[150:151],v5 offset:6144
v_exp_f32 v100,v100
v_cvt_pk_bf16_f32 v47,v78,v79
v_cvt_pk_bf16_f32 v49,v82,v83
v_exp_f32 v76,v76
v_exp_f32 v102,v102
v_exp_f32 v86,v86
v_cvt_pk_bf16_f32 v59,v102,v103
v_exp_f32 v99,v99
v_cvt_pk_bf16_f32 v50,v84,v85
v_cvt_pk_bf16_f32 v57,v98,v99
v_cvt_pk_bf16_f32 v55,v94,v95
v_cvt_pk_bf16_f32 v54,v92,v93
v_cvt_pk_bf16_f32 v58,v100,v101
v_cvt_pk_bf16_f32 v51,v86,v87
v_cvt_pk_bf16_f32 v53,v90,v91
v_cvt_pk_bf16_f32 v46,v76,v77
v_cvt_pk_bf16_f32 v52,v88,v89
v_cvt_pk_bf16_f32 v56,v96,v97
v_smfmac_f32_16x16x64_bf16 v[60:63],a[152:155],v[44:51],v18
v_subrev_u32 v10,18432,v10
v_smfmac_f32_16x16x64_bf16 v[64:67],a[152:155],v[52:59],v18
s_waitcnt lgkmcnt(0)
v_mfma_f32_16x16x32_bf16 v[160:163],a[136:139],v[44:47],v[160:163]
s_add_u32 s87,s42,18432
ds_read_b64_tr_b16 a[120:121],v2 offset:128
v_mbcnt_lo_u32_b32 v35,-1,0
v_mfma_f32_16x16x32_bf16 v[164:167],a[140:143],v[44:47],v[164:167]
ds_read_b64_tr_b16 a[122:123],v2 offset:6272
v_mbcnt_hi_u32_b32 v35,-1,v35
v_mfma_f32_16x16x32_bf16 v[212:215],a[140:143],v[48:51],v[212:215]
ds_read_b64_tr_b16 a[124:125],v3 offset:128
v_and_b32 v34,7,v35
v_mfma_f32_16x16x32_bf16 v[208:211],a[136:139],v[48:51],v[208:211]
ds_read_b64_tr_b16 a[126:127],v3 offset:6272
v_lshrrev_b32 v19,5,v35
v_mfma_f32_16x16x32_bf16 v[112:115],a[136:139],v[52:55],v[112:115]
ds_read_b64_tr_b16 a[128:129],v4 offset:128
v_xor_b32 v34,v34,v19
v_mfma_f32_16x16x32_bf16 v[116:119],a[140:143],v[52:55],v[116:119]
ds_read_b64_tr_b16 a[130:131],v4 offset:6272
ds_read_b64_tr_b16 a[132:133],v5 offset:128
ds_read_b64_tr_b16 a[134:135],v5 offset:6272
v_mfma_f32_16x16x32_bf16 a[164:167],a[140:143],v[56:59],a[164:167]
ds_read_b64_tr_b16 a[140:141],v3 offset:256
v_and_b32 v19,15,v35
v_mfma_f32_16x16x32_bf16 a[160:163],a[136:139],v[56:59],a[160:163]
ds_read_b64_tr_b16 a[136:137],v2 offset:256
v_lshl_add_u32 v19,v19,7,s24
v_mfma_f32_16x16x32_bf16 a[168:171],a[144:147],v[56:59],a[168:171]
ds_read_b64_tr_b16 a[138:139],v2 offset:6400
v_lshl_add_u32 v19,v34,4,v19
v_mfma_f32_16x16x32_bf16 a[172:175],a[148:151],v[56:59],a[172:175]
ds_read_b64_tr_b16 a[142:143],v3 offset:6400
v_bfe_u32 v34,v35,4,1
v_mfma_f32_16x16x32_bf16 v[124:127],a[148:151],v[52:55],v[124:127]
v_lshl_add_u32 v32,v34,3,v19
v_bfe_u32 v19,v35,3,1
v_mfma_f32_16x16x32_bf16 v[120:123],a[144:147],v[52:55],v[120:123]
v_lshlrev_b32 v19,11,v19
v_xor_b32 v33,32,v32
v_mfma_f32_16x16x32_bf16 v[216:219],a[144:147],v[48:51],v[216:219]
v_add_u32 v36,v32,v19
v_xor_b32 v34,64,v32
v_mfma_f32_16x16x32_bf16 v[220:223],a[148:151],v[48:51],v[220:223]
v_add_u32 v37,v33,v19
v_xor_b32 v35,96,v32
v_mfma_f32_16x16x32_bf16 v[172:175],a[148:151],v[44:47],v[172:175]
ds_read_b64_tr_b16 a[148:149],v5 offset:256
v_add_u32 v38,v34,v19
v_mfma_f32_16x16x32_bf16 v[168:171],a[144:147],v[44:47],v[168:171]
s_waitcnt lgkmcnt(2)
ds_read_b64_tr_b16 a[144:145],v4 offset:256
v_add_u32 v39,v35,v19
v_mfma_f32_16x16x32_bf16 v[176:179],a[120:123],v[44:47],v[176:179]
ds_read_b64_tr_b16 a[146:147],v4 offset:6400
v_add_f32 v62,v62,v63
v_mfma_f32_16x16x32_bf16 v[180:183],a[124:127],v[44:47],v[180:183]
ds_read_b64_tr_b16 a[150:151],v5 offset:6400
v_rcp_f32 v62,v62
v_mfma_f32_16x16x32_bf16 v[228:231],a[124:127],v[48:51],v[228:231]
v_add_f32 v66,v66,v67
v_rcp_f32 v66,v66
v_mfma_f32_16x16x32_bf16 v[224:227],a[120:123],v[48:51],v[224:227]
v_accvgpr_read_b32 v80,a164
v_accvgpr_read_b32 v81,a165
v_mfma_f32_16x16x32_bf16 v[128:131],a[120:123],v[52:55],v[128:131]
v_accvgpr_read_b32 v82,a166
v_accvgpr_read_b32 v83,a167
v_mfma_f32_16x16x32_bf16 v[132:135],a[124:127],v[52:55],v[132:135]
v_accvgpr_read_b32 v72,a160
v_accvgpr_read_b32 v73,a161
v_mfma_f32_16x16x32_bf16 a[180:183],a[124:127],v[56:59],a[180:183]
v_accvgpr_read_b32 v74,a162
v_accvgpr_read_b32 v75,a163
v_accvgpr_read_b32 v88,a168
v_accvgpr_read_b32 v89,a169
v_accvgpr_read_b32 v90,a170
v_pk_mul_f32 v[208:209],v[208:209],v[62:63] op_sel_hi:[1,0]
v_pk_mul_f32 v[210:211],v[210:211],v[62:63] op_sel_hi:[1,0]
v_pk_mul_f32 v[224:225],v[224:225],v[62:63] op_sel_hi:[1,0]
v_pk_mul_f32 v[226:227],v[226:227],v[62:63] op_sel_hi:[1,0]
v_pk_mul_f32 v[212:213],v[212:213],v[62:63] op_sel_hi:[1,0]
v_pk_mul_f32 v[214:215],v[214:215],v[62:63] op_sel_hi:[1,0]
v_pk_mul_f32 v[228:229],v[228:229],v[62:63] op_sel_hi:[1,0]
v_pk_mul_f32 v[230:231],v[230:231],v[62:63] op_sel_hi:[1,0]
v_accvgpr_read_b32 v91,a171
v_accvgpr_read_b32 v96,a172
v_mfma_f32_16x16x32_bf16 a[176:179],a[120:123],v[56:59],a[176:179]
v_accvgpr_read_b32 v97,a173
v_accvgpr_read_b32 v98,a174
v_mfma_f32_16x16x32_bf16 a[184:187],a[128:131],v[56:59],a[184:187]
v_accvgpr_read_b32 v99,a175
v_accvgpr_read_b32 v84,a180
v_mfma_f32_16x16x32_bf16 a[188:191],a[132:135],v[56:59],a[188:191]
v_accvgpr_read_b32 v85,a181
v_accvgpr_read_b32 v86,a182
v_mfma_f32_16x16x32_bf16 v[140:143],a[132:135],v[52:55],v[140:143]
v_accvgpr_read_b32 v87,a183
v_accvgpr_read_b32 v76,a176
v_mfma_f32_16x16x32_bf16 v[136:139],a[128:131],v[52:55],v[136:139]
v_accvgpr_read_b32 v77,a177
v_accvgpr_read_b32 v78,a178
v_mfma_f32_16x16x32_bf16 v[232:235],a[128:131],v[48:51],v[232:235]
v_accvgpr_read_b32 v79,a179
v_accvgpr_read_b32 v92,a184
v_mfma_f32_16x16x32_bf16 v[236:239],a[132:135],v[48:51],v[236:239]
v_accvgpr_read_b32 v93,a185
v_accvgpr_read_b32 v94,a186
v_mfma_f32_16x16x32_bf16 v[188:191],a[132:135],v[44:47],v[188:191]
v_accvgpr_read_b32 v95,a187
v_accvgpr_read_b32 v100,a188
v_mfma_f32_16x16x32_bf16 v[184:187],a[128:131],v[44:47],v[184:187]
v_accvgpr_read_b32 v101,a189
v_accvgpr_read_b32 v102,a190
v_accvgpr_read_b32 v103,a191
v_add_f32 v64,v64,v65
v_rcp_f32 v64,v64
v_pk_mul_f32 v[216:217],v[216:217],v[62:63] op_sel_hi:[1,0]
v_pk_mul_f32 v[218:219],v[218:219],v[62:63] op_sel_hi:[1,0]
v_pk_mul_f32 v[232:233],v[232:233],v[62:63] op_sel_hi:[1,0]
v_pk_mul_f32 v[234:235],v[234:235],v[62:63] op_sel_hi:[1,0]
v_cvt_pk_bf16_f32 v208,v208,v209
v_cvt_pk_bf16_f32 v224,v224,v225
v_mfma_f32_16x16x32_bf16 v[192:195],a[136:139],v[44:47],v[192:195]
v_cvt_pk_bf16_f32 v212,v212,v213
v_cvt_pk_bf16_f32 v228,v228,v229
v_cvt_pk_bf16_f32 v209,v210,v211
v_cvt_pk_bf16_f32 v225,v226,v227
ds_write2st64_b64 v36,v[208:209],v[224:225] offset0:12 offset1:14
v_pk_mul_f32 v[220:221],v[220:221],v[62:63] op_sel_hi:[1,0]
v_pk_mul_f32 v[222:223],v[222:223],v[62:63] op_sel_hi:[1,0]
v_pk_mul_f32 v[236:237],v[236:237],v[62:63] op_sel_hi:[1,0]
v_pk_mul_f32 v[238:239],v[238:239],v[62:63] op_sel_hi:[1,0]
v_pk_mul_f32 v[72:73],v[72:73],v[66:67] op_sel_hi:[1,0]
v_pk_mul_f32 v[74:75],v[74:75],v[66:67] op_sel_hi:[1,0]
v_pk_mul_f32 v[76:77],v[76:77],v[66:67] op_sel_hi:[1,0]
v_pk_mul_f32 v[78:79],v[78:79],v[66:67] op_sel_hi:[1,0]
v_pk_mul_f32 v[80:81],v[80:81],v[66:67] op_sel_hi:[1,0]
v_pk_mul_f32 v[82:83],v[82:83],v[66:67] op_sel_hi:[1,0]
v_pk_mul_f32 v[84:85],v[84:85],v[66:67] op_sel_hi:[1,0]
v_pk_mul_f32 v[86:87],v[86:87],v[66:67] op_sel_hi:[1,0]
v_pk_mul_f32 v[88:89],v[88:89],v[66:67] op_sel_hi:[1,0]
v_pk_mul_f32 v[90:91],v[90:91],v[66:67] op_sel_hi:[1,0]
v_pk_mul_f32 v[92:93],v[92:93],v[66:67] op_sel_hi:[1,0]
v_pk_mul_f32 v[94:95],v[94:95],v[66:67] op_sel_hi:[1,0]
v_pk_mul_f32 v[96:97],v[96:97],v[66:67] op_sel_hi:[1,0]
v_pk_mul_f32 v[98:99],v[98:99],v[66:67] op_sel_hi:[1,0]
v_pk_mul_f32 v[100:101],v[100:101],v[66:67] op_sel_hi:[1,0]
v_pk_mul_f32 v[102:103],v[102:103],v[66:67] op_sel_hi:[1,0]
v_cvt_pk_bf16_f32 v216,v216,v217
v_cvt_pk_bf16_f32 v232,v232,v233
s_waitcnt lgkmcnt(1)
v_mfma_f32_16x16x32_bf16 v[196:199],a[140:143],v[44:47],v[196:199]
v_cvt_pk_bf16_f32 v213,v214,v215
v_cvt_pk_bf16_f32 v229,v230,v231
v_mfma_f32_16x16x32_bf16 v[244:247],a[140:143],v[48:51],v[244:247]
ds_write2st64_b64 v37,v[212:213],v[228:229] offset0:12 offset1:14
v_mfma_f32_16x16x32_bf16 v[240:243],a[136:139],v[48:51],v[240:243]
v_cvt_pk_bf16_f32 v220,v220,v221
v_cvt_pk_bf16_f32 v236,v236,v237
v_mfma_f32_16x16x32_bf16 v[144:147],a[136:139],v[52:55],v[144:147]
v_cvt_pk_bf16_f32 v217,v218,v219
v_cvt_pk_bf16_f32 v233,v234,v235
v_mfma_f32_16x16x32_bf16 v[148:151],a[140:143],v[52:55],v[148:151]
v_cvt_pk_bf16_f32 v72,v72,v73
v_cvt_pk_bf16_f32 v76,v76,v77
v_mfma_f32_16x16x32_bf16 a[196:199],a[140:143],v[56:59],a[196:199]
ds_write2st64_b64 v38,v[216:217],v[232:233] offset0:12 offset1:14
v_pk_mul_f32 v[240:241],v[240:241],v[62:63] op_sel_hi:[1,0]
v_pk_mul_f32 v[242:243],v[242:243],v[62:63] op_sel_hi:[1,0]
v_pk_mul_f32 v[112:113],v[112:113],v[64:65] op_sel_hi:[1,0]
v_pk_mul_f32 v[114:115],v[114:115],v[64:65] op_sel_hi:[1,0]
v_pk_mul_f32 v[244:245],v[244:245],v[62:63] op_sel_hi:[1,0]
v_pk_mul_f32 v[246:247],v[246:247],v[62:63] op_sel_hi:[1,0]
v_pk_mul_f32 v[116:117],v[116:117],v[64:65] op_sel_hi:[1,0]
v_pk_mul_f32 v[118:119],v[118:119],v[64:65] op_sel_hi:[1,0]
v_cvt_pk_bf16_f32 v221,v222,v223
v_cvt_pk_bf16_f32 v237,v238,v239
v_mfma_f32_16x16x32_bf16 a[192:195],a[136:139],v[56:59],a[192:195]
s_waitcnt vmcnt(15)
ds_read_b128 a[68:71],v12 offset:12544
v_cvt_pk_bf16_f32 v73,v74,v75
v_mfma_f32_16x16x32_bf16 a[200:203],a[144:147],v[56:59],a[200:203]
ds_read_b128 a[64:67],v11 offset:12544
v_cvt_pk_bf16_f32 v77,v78,v79
v_mfma_f32_16x16x32_bf16 a[204:207],a[148:151],v[56:59],a[204:207]
ds_read_b128 a[60:63],v12 offset:12416
v_accvgpr_read_b32 v212,a192
v_mfma_f32_16x16x32_bf16 v[156:159],a[148:151],v[52:55],v[156:159]
ds_read_b128 a[56:59],v11 offset:12416
v_accvgpr_read_b32 v213,a193
v_mfma_f32_16x16x32_bf16 v[152:155],a[144:147],v[52:55],v[152:155]
ds_read_b128 a[52:55],v12 offset:12288
v_accvgpr_read_b32 v214,a194
v_mfma_f32_16x16x32_bf16 v[248:251],a[144:147],v[48:51],v[248:251]
ds_read_b128 a[48:51],v11 offset:12288
v_accvgpr_read_b32 v215,a195
ds_write2st64_b64 v39,v[220:221],v[236:237] offset0:12 offset1:14
v_mfma_f32_16x16x32_bf16 v[252:255],a[148:151],v[48:51],v[252:255]
v_accvgpr_read_b32 v228,a196
v_accvgpr_read_b32 v229,a197
v_mfma_f32_16x16x32_bf16 v[204:207],a[148:151],v[44:47],v[204:207]
v_accvgpr_read_b32 v230,a198
v_accvgpr_read_b32 v231,a199
v_mfma_f32_16x16x32_bf16 v[200:203],a[144:147],v[44:47],v[200:203]
v_cvt_pk_bf16_f32 v80,v80,v81
ds_write2st64_b64 v32,v[72:73],v[76:77] offset0:36 offset1:40
v_pk_mul_f32 v[248:249],v[248:249],v[62:63] op_sel_hi:[1,0]
v_pk_mul_f32 v[250:251],v[250:251],v[62:63] op_sel_hi:[1,0]
v_pk_mul_f32 v[120:121],v[120:121],v[64:65] op_sel_hi:[1,0]
v_pk_mul_f32 v[122:123],v[122:123],v[64:65] op_sel_hi:[1,0]
v_cvt_pk_bf16_f32 v84,v84,v85
v_accvgpr_read_b32 v216,a200
v_accvgpr_read_b32 v217,a201
v_accvgpr_read_b32 v218,a202
v_accvgpr_read_b32 v219,a203
v_cvt_pk_bf16_f32 v81,v82,v83
v_cvt_pk_bf16_f32 v85,v86,v87
ds_write2st64_b64 v33,v[80:81],v[84:85] offset0:36 offset1:40
v_add_f32 v60,v60,v61
v_rcp_f32 v60,v60
v_accvgpr_read_b32 v232,a204
v_min3_f32 v61,v60,v62,v64
v_min_f32 v61,v61,v66
v_cmp_nlt_f32 vcc,s37,v61
v_accvgpr_read_b32 v233,a205
v_accvgpr_read_b32 v234,a206
v_accvgpr_read_b32 v235,a207
v_cvt_pk_bf16_f32 v88,v88,v89
v_cvt_pk_bf16_f32 v92,v92,v93
v_cvt_pk_bf16_f32 v89,v90,v91
v_cvt_pk_bf16_f32 v93,v94,v95
ds_write2st64_b64 v34,v[88:89],v[92:93] offset0:36 offset1:40
v_cvt_pk_bf16_f32 v96,v96,v97
v_cvt_pk_bf16_f32 v100,v100,v101
v_cvt_pk_bf16_f32 v97,v98,v99
v_cvt_pk_bf16_f32 v101,v102,v103
v_cvt_pk_bf16_f32 v240,v240,v241
v_cvt_pk_bf16_f32 v112,v112,v113
v_cvt_pk_bf16_f32 v244,v244,v245
v_cvt_pk_bf16_f32 v116,v116,v117
v_cvt_pk_bf16_f32 v241,v242,v243
v_cvt_pk_bf16_f32 v113,v114,v115
v_cvt_pk_bf16_f32 v248,v248,v249
ds_write2st64_b64 v35,v[96:97],v[100:101] offset0:36 offset1:40
v_cvt_pk_bf16_f32 v120,v120,v121
v_cvt_pk_bf16_f32 v245,v246,v247
v_cvt_pk_bf16_f32 v117,v118,v119
ds_read_b128 v[104:107],v10 offset:18432
v_cvt_pk_bf16_f32 v249,v250,v251
ds_read_b128 v[108:111],v10 offset:19456
v_cvt_pk_bf16_f32 v121,v122,v123
ds_read_b128 v[208:211],v10 offset:20480
s_cmp_lg_u64 vcc,0
ds_read_b128 v[224:227],v10 offset:21504
s_cselect_b32 s62,s32,0
ds_write2st64_b64 v36,v[240:241],v[112:113] offset0:16 offset1:24
s_or_b32 s31,s31,s62
s_lshl_b32 s32,s32,1
s_add_u32 m0,s23,0
s_waitcnt lgkmcnt(4)
buffer_store_dwordx4 v[104:107],v9,s[16:19],s87 offen offset:0 nt
s_waitcnt vmcnt(1)
s_barrier
ds_read_b128 a[140:143],v1 offset:256
ds_read_b128 a[136:139],v0 offset:256
s_waitcnt lgkmcnt(5)
buffer_store_dwordx4 v[108:111],v9,s[16:19],s87 offen offset:3072 nt
ds_read_b128 a[132:135],v1 offset:128
ds_read_b128 a[128:131],v0 offset:128
ds_read_b128 a[124:127],v1 offset:0
buffer_load_dwordx4 v6,s[8:11],s25 offen offset:0 lds
ds_write2st64_b64 v37,v[244:245],v[116:117] offset0:16 offset1:24
s_waitcnt lgkmcnt(5)
v_mfma_f32_16x16x32_bf16 v[72:75],a[140:143],a[20:23],0
ds_read_b128 a[120:123],v0 offset:0
buffer_store_dwordx4 v[208:211],v9,s[16:19],s87 offen offset:128 nt
ds_read_b128 a[144:147],v0 offset:6144
v_pk_mul_f32 v[252:253],v[252:253],v[62:63] op_sel_hi:[1,0]
ds_read_b128 a[148:151],v1 offset:6144
v_pk_mul_f32 v[254:255],v[254:255],v[62:63] op_sel_hi:[1,0]
v_pk_mul_f32 v[124:125],v[124:125],v[64:65] op_sel_hi:[1,0]
v_pk_mul_f32 v[126:127],v[126:127],v[64:65] op_sel_hi:[1,0]
ds_write2st64_b64 v38,v[248:249],v[120:121] offset0:16 offset1:24
v_pk_mul_f32 v[212:213],v[212:213],v[66:67] op_sel_hi:[1,0]
v_pk_mul_f32 v[214:215],v[214:215],v[66:67] op_sel_hi:[1,0]
v_pk_mov_b32 v[62:63],0,0
v_cvt_pk_bf16_f32 v252,v252,v253
v_cvt_pk_bf16_f32 v124,v124,v125
s_waitcnt lgkmcnt(4)
v_mfma_f32_16x16x32_bf16 v[72:75],a[136:139],a[16:19],v[72:75]
buffer_load_dwordx4 v7,s[8:11],s25 offen offset:1024 lds
buffer_store_dwordx4 v[224:227],v9,s[16:19],s87 offen offset:3200 nt
v_pk_mul_f32 v[228:229],v[228:229],v[66:67] op_sel_hi:[1,0]
v_pk_mul_f32 v[230:231],v[230:231],v[66:67] op_sel_hi:[1,0]
v_cvt_pk_bf16_f32 v212,v212,v213
v_cvt_pk_bf16_f32 v253,v254,v255
v_mfma_f32_16x16x32_bf16 v[72:75],a[132:135],a[12:15],v[72:75]
v_cvt_pk_bf16_f32 v125,v126,v127
v_cvt_pk_bf16_f32 v228,v228,v229
v_mfma_f32_16x16x32_bf16 v[72:75],a[128:131],a[8:11],v[72:75]
v_cvt_pk_bf16_f32 v213,v214,v215
v_cvt_pk_bf16_f32 v229,v230,v231
v_mfma_f32_16x16x32_bf16 v[72:75],a[124:127],a[4:7],v[72:75]
s_waitcnt lgkmcnt(0)
ds_write2st64_b64 v39,v[252:253],v[124:125] offset0:16 offset1:24
v_mfma_f32_16x16x32_bf16 v[72:75],a[120:123],a[0:3],v[72:75]
buffer_load_dwordx4 v8,s[8:11],s25 offen offset:2048 lds
v_pk_mul_f32 v[216:217],v[216:217],v[66:67] op_sel_hi:[1,0]
v_pk_mul_f32 v[218:219],v[218:219],v[66:67] op_sel_hi:[1,0]
v_cvt_pk_bf16_f32 v216,v216,v217
v_cvt_pk_bf16_f32 v217,v218,v219
v_mfma_f32_16x16x32_bf16 v[80:83],a[120:123],a[24:27],0
s_waitcnt vmcnt(10)
ds_read_b128 a[72:75],v11 offset:0
v_max3_f32 v44,v72,v73,v74
v_mfma_f32_16x16x32_bf16 v[80:83],a[124:127],a[28:31],v[80:83]
s_mov_b32 s27,s42
ds_read_b128 a[76:79],v12 offset:0
v_max_f32 v44,v44,v75
v_mfma_f32_16x16x32_bf16 v[80:83],a[128:131],a[32:35],v[80:83]
s_mov_b32 s42,s41
ds_read_b128 a[80:83],v11 offset:128
s_add_u32 s69,s69,1
ds_read_b128 a[84:87],v12 offset:128
v_pk_mul_f32 v[232:233],v[232:233],v[66:67] op_sel_hi:[1,0]
ds_read_b128 a[88:91],v11 offset:256
v_pk_mul_f32 v[234:235],v[234:235],v[66:67] op_sel_hi:[1,0]
ds_write_b64 v32,v[212:213] offset:18432
ds_read_b128 a[92:95],v12 offset:256
v_mfma_f32_16x16x32_bf16 v[80:83],a[132:135],a[36:39],v[80:83]
s_lshl_b32 s62,s69,5
v_cvt_pk_bf16_f32 v232,v232,v233
v_cvt_pk_bf16_f32 v233,v234,v235
v_mfma_f32_16x16x32_bf16 v[80:83],a[136:139],a[40:43],v[80:83]
s_add_u32 s62,s62,s34
ds_write_b64 v33,v[228:229] offset:18432
v_mfma_f32_16x16x32_bf16 v[80:83],a[140:143],a[44:47],v[80:83]
s_mul_i32 s63,s62,171
s_lshr_b32 s63,s63,9
s_mul_i32 s64,s63,3
ds_write_b64 v34,v[216:217] offset:18432
v_pk_mul_f32 v[128:129],v[128:129],v[64:65] op_sel_hi:[1,0]
v_pk_mul_f32 v[130:131],v[130:131],v[64:65] op_sel_hi:[1,0]
v_pk_mul_f32 v[144:145],v[144:145],v[64:65] op_sel_hi:[1,0]
v_pk_mul_f32 v[146:147],v[146:147],v[64:65] op_sel_hi:[1,0]
v_pk_mov_b32 v[66:67],0,0
v_max3_f32 v48,v80,v81,v82
v_max_f32 v48,v48,v83
v_mfma_f32_16x16x32_bf16 v[88:91],a[140:143],a[68:71],0
s_sub_u32 s62,s62,s64
ds_write_b64 v35,v[232:233] offset:18432
v_mfma_f32_16x16x32_bf16 v[88:91],a[136:139],a[64:67],v[88:91]
s_add_u32 s63,s63,s33
ds_read_b128 v[220:223],v10 offset:18432
v_permlane32_swap_b32 v44,v48
v_mfma_f32_16x16x32_bf16 v[88:91],a[132:135],a[60:63],v[88:91]
s_mul_i32 s30,s63,196608
ds_read_b128 v[236:239],v10 offset:19456
v_max_f32 v44,v44,v48
v_mov_b32 v48,v44
v_cvt_pk_bf16_f32 v128,v128,v129
v_cvt_pk_bf16_f32 v144,v144,v145
v_pk_mul_f32 v[132:133],v[132:133],v[64:65] op_sel_hi:[1,0]
v_pk_mul_f32 v[134:135],v[134:135],v[64:65] op_sel_hi:[1,0]
v_pk_mul_f32 v[148:149],v[148:149],v[64:65] op_sel_hi:[1,0]
v_pk_mul_f32 v[150:151],v[150:151],v[64:65] op_sel_hi:[1,0]
v_permlane16_swap_b32 v48,v44
v_max_f32 v44,v44,v48
v_mfma_f32_16x16x32_bf16 v[88:91],a[128:131],a[56:59],v[88:91]
s_mul_i32 s41,s63,325632
v_mul_f32_e64 v14,-s36,v44
v_mov_b32 v13,v14
v_mfma_f32_16x16x32_bf16 v[88:91],a[124:127],a[52:55],v[88:91]
s_lshl_b32 s63,s3,2
v_permlane32_swap_b32 v13,v14
v_mfma_f32_16x16x32_bf16 v[88:91],a[120:123],a[48:51],v[88:91]
s_add_u32 s64,s63,21
v_fma_f32 v72,v72,s36,v13
v_fma_f32 v73,v73,s36,v13
s_waitcnt lgkmcnt(2)
v_mfma_f32_16x16x32_bf16 v[96:99],a[120:123],a[72:75],0
s_cmp_eq_u32 s3,0
s_waitcnt lgkmcnt(1)
buffer_store_dwordx4 v[220:223],v9,s[16:19],s87 offen offset:256 nt
ds_read_b128 a[120:123],v0 offset:6272
v_fma_f32 v74,v74,s36,v13
v_pk_mul_f32 v[136:137],v[136:137],v[64:65] op_sel_hi:[1,0]
v_pk_mul_f32 v[138:139],v[138:139],v[64:65] op_sel_hi:[1,0]
v_pk_mul_f32 v[152:153],v[152:153],v[64:65] op_sel_hi:[1,0]
v_pk_mul_f32 v[154:155],v[154:155],v[64:65] op_sel_hi:[1,0]
v_fma_f32 v75,v75,s36,v13
v_exp_f32 v72,v72
v_mfma_f32_16x16x32_bf16 v[96:99],a[124:127],a[76:79],v[96:99]
s_cselect_b32 s64,20,s64
ds_read_b128 a[124:127],v1 offset:6272
v_exp_f32 v73,v73
v_mfma_f32_16x16x32_bf16 v[96:99],a[128:131],a[80:83],v[96:99]
s_cselect_b32 s40,1,0
ds_read_b128 a[128:131],v0 offset:6400
s_waitcnt lgkmcnt(3)
buffer_store_dwordx4 v[236:239],v9,s[16:19],s87 offen offset:3328 nt
v_exp_f32 v74,v74
v_exp_f32 v75,v75
v_mfma_f32_16x16x32_bf16 v[96:99],a[132:135],a[84:87],v[96:99]
s_add_u32 s65,s63,37
ds_read_b128 a[132:135],v1 offset:6400
v_cvt_pk_bf16_f32 v20,v72,v73
v_cvt_pk_bf16_f32 v21,v74,v75
v_fma_f32 v80,v80,s36,v14
v_fma_f32 v81,v81,s36,v14
v_pk_mul_f32 v[140:141],v[140:141],v[64:65] op_sel_hi:[1,0]
v_pk_mul_f32 v[142:143],v[142:143],v[64:65] op_sel_hi:[1,0]
v_pk_mul_f32 v[156:157],v[156:157],v[64:65] op_sel_hi:[1,0]
v_pk_mul_f32 v[158:159],v[158:159],v[64:65] op_sel_hi:[1,0]
v_pk_mov_b32 v[64:65],0,0
v_fma_f32 v82,v82,s36,v14
v_fma_f32 v83,v83,s36,v14
v_mfma_f32_16x16x32_bf16 v[96:99],a[136:139],a[88:91],v[96:99]
s_cmp_eq_u32 s62,2
ds_read_b128 a[136:139],v0 offset:12288
v_exp_f32 v80,v80
v_mfma_f32_16x16x32_bf16 v[96:99],a[140:143],a[92:95],v[96:99]
s_cselect_b32 s64,s65,s64
ds_read_b128 a[140:143],v1 offset:12288
v_exp_f32 v81,v81
v_mfma_f32_16x16x32_bf16 v[76:79],a[144:147],a[0:3],0
s_cselect_b32 s40,0,s40
v_exp_f32 v82,v82
v_exp_f32 v83,v83
v_cvt_pk_bf16_f32 v24,v80,v81
v_pk_mul_f32 v[160:161],v[160:161],v[60:61] op_sel_hi:[1,0]
v_pk_mul_f32 v[162:163],v[162:163],v[60:61] op_sel_hi:[1,0]
v_pk_mul_f32 v[176:177],v[176:177],v[60:61] op_sel_hi:[1,0]
v_pk_mul_f32 v[178:179],v[178:179],v[60:61] op_sel_hi:[1,0]
v_cvt_pk_bf16_f32 v25,v82,v83
v_max3_f32 v52,v88,v89,v90
v_mfma_f32_16x16x32_bf16 v[76:79],a[148:151],a[4:7],v[76:79]
s_add_u32 s65,s63,s3
v_max3_f32 v56,v96,v97,v98
v_max_f32 v52,v52,v91
s_waitcnt lgkmcnt(2)
v_mfma_f32_16x16x32_bf16 v[76:79],a[120:123],a[8:11],v[76:79]
s_cmp_eq_u32 s62,0
v_max_f32 v56,v56,v99
v_cvt_pk_bf16_f32 v129,v130,v131
v_mfma_f32_16x16x32_bf16 v[76:79],a[124:127],a[12:15],v[76:79]
s_cselect_b32 s64,s65,s64
v_permlane32_swap_b32 v52,v56
v_max_f32 v52,v52,v56
v_mov_b32 v56,v52
v_cvt_pk_bf16_f32 v145,v146,v147
ds_write2st64_b64 v36,v[128:129],v[144:145] offset0:26 offset1:28
v_pk_mul_f32 v[164:165],v[164:165],v[60:61] op_sel_hi:[1,0]
v_pk_mul_f32 v[166:167],v[166:167],v[60:61] op_sel_hi:[1,0]
v_pk_mul_f32 v[180:181],v[180:181],v[60:61] op_sel_hi:[1,0]
v_pk_mul_f32 v[182:183],v[182:183],v[60:61] op_sel_hi:[1,0]
v_permlane16_swap_b32 v56,v52
v_max_f32 v52,v52,v56
v_mfma_f32_16x16x32_bf16 v[76:79],a[128:131],a[16:19],v[76:79]
s_cselect_b32 s40,1,s40
v_mul_f32_e64 v16,-s36,v52
v_mov_b32 v15,v16
v_mfma_f32_16x16x32_bf16 v[76:79],a[132:135],a[20:23],v[76:79]
s_mul_i32 s64,s64,6144
v_permlane32_swap_b32 v15,v16
v_mfma_f32_16x16x32_bf16 v[84:87],a[132:135],a[44:47],0
s_add_u32 s41,s41,s64
v_fma_f32 v88,v88,s36,v15
v_fma_f32 v89,v89,s36,v15
v_mfma_f32_16x16x32_bf16 v[84:87],a[128:131],a[40:43],v[84:87]
s_cmp_ge_u32 s69,6
v_fma_f32 v90,v90,s36,v15
v_fma_f32 v91,v91,s36,v15
v_exp_f32 v88,v88
v_exp_f32 v89,v89
v_pk_mul_f32 v[168:169],v[168:169],v[60:61] op_sel_hi:[1,0]
v_pk_mul_f32 v[170:171],v[170:171],v[60:61] op_sel_hi:[1,0]
v_pk_mul_f32 v[184:185],v[184:185],v[60:61] op_sel_hi:[1,0]
v_pk_mul_f32 v[186:187],v[186:187],v[60:61] op_sel_hi:[1,0]
v_exp_f32 v90,v90
v_exp_f32 v91,v91
v_mfma_f32_16x16x32_bf16 v[84:87],a[124:127],a[36:39],v[84:87]
s_cselect_b32 s41,166723584,s41
v_cvt_pk_bf16_f32 v28,v88,v89
v_cvt_pk_bf16_f32 v29,v90,v91
v_mfma_f32_16x16x32_bf16 v[84:87],a[120:123],a[32:35],v[84:87]
s_cselect_b32 s30,100663296,s30
v_fma_f32 v96,v96,s36,v16
v_fma_f32 v97,v97,s36,v16
v_mfma_f32_16x16x32_bf16 v[84:87],a[148:151],a[28:31],v[84:87]
s_add_u32 s25,s30,s22
v_fma_f32 v98,v98,s36,v16
v_fma_f32 v99,v99,s36,v16
v_exp_f32 v96,v96
v_exp_f32 v97,v97
v_pk_mul_f32 v[172:173],v[172:173],v[60:61] op_sel_hi:[1,0]
v_pk_mul_f32 v[174:175],v[174:175],v[60:61] op_sel_hi:[1,0]
v_pk_mul_f32 v[188:189],v[188:189],v[60:61] op_sel_hi:[1,0]
v_pk_mul_f32 v[190:191],v[190:191],v[60:61] op_sel_hi:[1,0]
v_exp_f32 v98,v98
v_exp_f32 v99,v99
v_mfma_f32_16x16x32_bf16 v[84:87],a[144:147],a[24:27],v[84:87]
s_add_u32 s26,s25,12288
v_cvt_pk_bf16_f32 v32,v96,v97
v_cvt_pk_bf16_f32 v33,v98,v99
v_mfma_f32_16x16x32_bf16 v[92:95],a[144:147],a[48:51],0
s_add_u32 m0,s23,24576
v_fma_f32 v76,v76,s36,v13
v_fma_f32 v77,v77,s36,v13
v_mfma_f32_16x16x32_bf16 v[92:95],a[148:151],a[52:55],v[92:95]
s_mov_b32 s28,s41
buffer_load_dwordx4 v6,s[8:11],s21 offen offset:0 lds
buffer_load_dwordx4 v7,s[8:11],s21 offen offset:1024 lds
v_pk_mul_f32 v[192:193],v[192:193],v[60:61] op_sel_hi:[1,0]
v_pk_mul_f32 v[194:195],v[194:195],v[60:61] op_sel_hi:[1,0]
v_fma_f32 v78,v78,s36,v13
v_fma_f32 v79,v79,s36,v13
v_mfma_f32_16x16x32_bf16 v[92:95],a[120:123],a[56:59],v[92:95]
s_mov_b32 s29,s24
v_exp_f32 v76,v76
v_mfma_f32_16x16x32_bf16 v[92:95],a[124:127],a[60:63],v[92:95]
v_exp_f32 v77,v77
v_mfma_f32_16x16x32_bf16 v[92:95],a[128:131],a[64:67],v[92:95]
v_exp_f32 v78,v78
v_exp_f32 v79,v79
v_cvt_pk_bf16_f32 v22,v76,v77
v_pk_mul_f32 v[196:197],v[196:197],v[60:61] op_sel_hi:[1,0]
v_pk_mul_f32 v[198:199],v[198:199],v[60:61] op_sel_hi:[1,0]
v_cvt_pk_bf16_f32 v23,v78,v79
v_cvt_pk_bf16_f32 v132,v132,v133
v_mfma_f32_16x16x32_bf16 v[92:95],a[132:135],a[68:71],v[92:95]
buffer_load_dwordx4 v8,s[8:11],s21 offen offset:2048 lds
v_mfma_f32_16x16x32_bf16 v[100:103],a[132:135],a[92:95],0
s_add_u32 s21,s21,12288
ds_read_b128 a[132:135],v1 offset:18432
v_cvt_pk_bf16_f32 v148,v148,v149
v_mfma_f32_16x16x32_bf16 v[100:103],a[128:131],a[88:91],v[100:103]
s_add_u32 m0,s22,0
ds_read_b128 a[128:131],v0 offset:18432
v_cvt_pk_bf16_f32 v136,v136,v137
v_mfma_f32_16x16x32_bf16 v[100:103],a[124:127],a[84:87],v[100:103]
ds_read_b128 a[124:127],v1 offset:12544
v_cvt_pk_bf16_f32 v152,v152,v153
v_cvt_pk_bf16_f32 v133,v134,v135
v_cvt_pk_bf16_f32 v149,v150,v151
ds_write2st64_b64 v37,v[132:133],v[148:149] offset0:26 offset1:28
v_pk_mul_f32 v[200:201],v[200:201],v[60:61] op_sel_hi:[1,0]
v_pk_mul_f32 v[202:203],v[202:203],v[60:61] op_sel_hi:[1,0]
v_cvt_pk_bf16_f32 v140,v140,v141
v_cvt_pk_bf16_f32 v156,v156,v157
v_mfma_f32_16x16x32_bf16 v[100:103],a[120:123],a[80:83],v[100:103]
ds_read_b128 a[120:123],v0 offset:12544
v_cvt_pk_bf16_f32 v137,v138,v139
v_mfma_f32_16x16x32_bf16 v[100:103],a[148:151],a[76:79],v[100:103]
ds_read_b128 a[148:151],v1 offset:12416
v_cvt_pk_bf16_f32 v153,v154,v155
v_mfma_f32_16x16x32_bf16 v[100:103],a[144:147],a[72:75],v[100:103]
ds_read_b128 a[144:147],v0 offset:12416
v_cvt_pk_bf16_f32 v160,v160,v161
ds_write2st64_b64 v38,v[136:137],v[152:153] offset0:26 offset1:28
v_pk_mul_f32 v[204:205],v[204:205],v[60:61] op_sel_hi:[1,0]
v_pk_mul_f32 v[206:207],v[206:207],v[60:61] op_sel_hi:[1,0]
v_pk_mov_b32 v[60:61],0,0
v_cvt_pk_bf16_f32 v176,v176,v177
v_cvt_pk_bf16_f32 v141,v142,v143
s_waitcnt lgkmcnt(4)
v_mfma_f32_16x16x32_bf16 v[72:75],a[124:127],a[20:23],0
v_cvt_pk_bf16_f32 v157,v158,v159
v_cvt_pk_bf16_f32 v164,v164,v165
v_cvt_pk_bf16_f32 v180,v180,v181
v_cvt_pk_bf16_f32 v161,v162,v163
v_cvt_pk_bf16_f32 v177,v178,v179
v_cvt_pk_bf16_f32 v168,v168,v169
s_waitcnt lgkmcnt(3)
v_mfma_f32_16x16x32_bf16 v[72:75],a[120:123],a[16:19],v[72:75]
s_waitcnt lgkmcnt(1)
ds_write2st64_b64 v39,v[140:141],v[156:157] offset0:26 offset1:28
v_mfma_f32_16x16x32_bf16 v[72:75],a[148:151],a[12:15],v[72:75]
v_fma_f32 v84,v84,s36,v14
v_fma_f32 v85,v85,s36,v14
v_mfma_f32_16x16x32_bf16 v[72:75],a[144:147],a[8:11],v[72:75]
v_fma_f32 v86,v86,s36,v14
v_fma_f32 v87,v87,s36,v14
v_mfma_f32_16x16x32_bf16 v[72:75],a[140:143],a[4:7],v[72:75]
v_exp_f32 v84,v84
v_mfma_f32_16x16x32_bf16 v[72:75],a[136:139],a[0:3],v[72:75]
ds_write2st64_b64 v36,v[160:161],v[176:177] offset0:0 offset1:2
v_mfma_f32_16x16x32_bf16 v[80:83],a[136:139],a[24:27],0
v_exp_f32 v85,v85
v_mfma_f32_16x16x32_bf16 v[80:83],a[140:143],a[28:31],v[80:83]
v_exp_f32 v86,v86
v_mfma_f32_16x16x32_bf16 v[80:83],a[144:147],a[32:35],v[80:83]
v_exp_f32 v87,v87
v_mfma_f32_16x16x32_bf16 v[80:83],a[148:151],a[36:39],v[80:83]
v_cvt_pk_bf16_f32 v26,v84,v85
v_cvt_pk_bf16_f32 v27,v86,v87
v_mfma_f32_16x16x32_bf16 v[80:83],a[120:123],a[40:43],v[80:83]
v_fma_f32 v92,v92,s36,v15
v_fma_f32 v93,v93,s36,v15
v_smfmac_f32_16x16x64_bf16 v[60:63],a[152:155],v[20:27],v18
v_fma_f32 v94,v94,s36,v15
v_mfma_f32_16x16x32_bf16 v[80:83],a[124:127],a[44:47],v[80:83]
v_fma_f32 v95,v95,s36,v15
v_exp_f32 v92,v92
v_mfma_f32_16x16x32_bf16 v[88:91],a[124:127],a[68:71],0
v_exp_f32 v93,v93
v_mfma_f32_16x16x32_bf16 v[88:91],a[120:123],a[64:67],v[88:91]
v_exp_f32 v94,v94
v_mfma_f32_16x16x32_bf16 v[88:91],a[148:151],a[60:63],v[88:91]
v_exp_f32 v95,v95
v_mfma_f32_16x16x32_bf16 v[88:91],a[144:147],a[56:59],v[88:91]
v_cvt_pk_bf16_f32 v30,v92,v93
v_cvt_pk_bf16_f32 v31,v94,v95
v_mfma_f32_16x16x32_bf16 v[88:91],a[140:143],a[52:55],v[88:91]
v_fma_f32 v100,v100,s36,v16
v_fma_f32 v101,v101,s36,v16
v_mfma_f32_16x16x32_bf16 v[88:91],a[136:139],a[48:51],v[88:91]
v_fma_f32 v102,v102,s36,v16
v_fma_f32 v103,v103,s36,v16
v_mfma_f32_16x16x32_bf16 v[96:99],a[136:139],a[72:75],0
ds_read_b128 a[136:139],v0 offset:18560
v_exp_f32 v100,v100
v_mfma_f32_16x16x32_bf16 v[96:99],a[140:143],a[76:79],v[96:99]
ds_read_b128 a[140:143],v1 offset:18560
v_exp_f32 v101,v101
v_mfma_f32_16x16x32_bf16 v[96:99],a[144:147],a[80:83],v[96:99]
ds_read_b128 a[144:147],v0 offset:18688
v_exp_f32 v102,v102
v_mfma_f32_16x16x32_bf16 v[96:99],a[148:151],a[84:87],v[96:99]
ds_read_b128 a[148:151],v1 offset:18688
v_exp_f32 v103,v103
v_mfma_f32_16x16x32_bf16 v[96:99],a[120:123],a[88:91],v[96:99]
v_cvt_pk_bf16_f32 v34,v100,v101
v_cvt_pk_bf16_f32 v35,v102,v103
v_mfma_f32_16x16x32_bf16 v[96:99],a[124:127],a[92:95],v[96:99]
v_cvt_pk_bf16_f32 v184,v184,v185
v_cvt_pk_bf16_f32 v165,v166,v167
v_smfmac_f32_16x16x64_bf16 v[64:67],a[152:155],v[28:35],v18
v_cvt_pk_bf16_f32 v181,v182,v183
v_mfma_f32_16x16x32_bf16 v[76:79],a[128:131],a[0:3],0
ds_write2st64_b64 v37,v[164:165],v[180:181] offset0:0 offset1:2
v_mfma_f32_16x16x32_bf16 v[76:79],a[132:135],a[4:7],v[76:79]
s_waitcnt lgkmcnt(2)
v_cvt_pk_bf16_f32 v172,v172,v173
v_cvt_pk_bf16_f32 v188,v188,v189
v_mfma_f32_16x16x32_bf16 v[76:79],a[136:139],a[8:11],v[76:79]
v_cvt_pk_bf16_f32 v169,v170,v171
v_cvt_pk_bf16_f32 v185,v186,v187
v_mfma_f32_16x16x32_bf16 v[76:79],a[140:143],a[12:15],v[76:79]
v_cvt_pk_bf16_f32 v192,v192,v193
v_cvt_pk_bf16_f32 v173,v174,v175
v_mfma_f32_16x16x32_bf16 v[76:79],a[144:147],a[16:19],v[76:79]
s_waitcnt lgkmcnt(1)
ds_write2st64_b64 v38,v[168:169],v[184:185] offset0:0 offset1:2
v_mfma_f32_16x16x32_bf16 v[76:79],a[148:151],a[20:23],v[76:79]
v_cvt_pk_bf16_f32 v189,v190,v191
v_cvt_pk_bf16_f32 v196,v196,v197
v_mfma_f32_16x16x32_bf16 v[84:87],a[148:151],a[44:47],0
v_fma_f32 v72,v72,s36,v13
v_fma_f32 v73,v73,s36,v13
v_mfma_f32_16x16x32_bf16 v[84:87],a[144:147],a[40:43],v[84:87]
v_fma_f32 v74,v74,s36,v13
v_fma_f32 v75,v75,s36,v13
v_mfma_f32_16x16x32_bf16 v[84:87],a[140:143],a[36:39],v[84:87]
ds_write2st64_b64 v39,v[172:173],v[188:189] offset0:0 offset1:2
s_waitcnt vmcnt(5)
s_barrier
v_mfma_f32_16x16x32_bf16 v[84:87],a[136:139],a[32:35],v[84:87]
buffer_load_dwordx4 v6,s[4:7],s20 offen offset:0 lds
v_mfma_f32_16x16x32_bf16 v[84:87],a[132:135],a[28:31],v[84:87]
v_fma_f32 v80,v80,s36,v14
v_fma_f32 v81,v81,s36,v14
v_mfma_f32_16x16x32_bf16 v[84:87],a[128:131],a[24:27],v[84:87]
v_cvt_pk_bf16_f32 v193,v194,v195
v_cvt_pk_bf16_f32 v200,v200,v201
v_mfma_f32_16x16x32_bf16 v[92:95],a[128:131],a[48:51],0
ds_write_b64 v36,v[192:193] offset:2048
v_mfma_f32_16x16x32_bf16 v[92:95],a[132:135],a[52:55],v[92:95]
v_cvt_pk_bf16_f32 v197,v198,v199
v_exp_f32 v72,v72
v_mfma_f32_16x16x32_bf16 v[92:95],a[136:139],a[56:59],v[92:95]
buffer_load_dwordx4 v7,s[4:7],s20 offen offset:1024 lds
v_mfma_f32_16x16x32_bf16 v[92:95],a[140:143],a[60:63],v[92:95]
ds_write_b64 v37,v[196:197] offset:2048
v_mfma_f32_16x16x32_bf16 v[92:95],a[144:147],a[64:67],v[92:95]
v_exp_f32 v73,v73
v_mfma_f32_16x16x32_bf16 v[92:95],a[148:151],a[68:71],v[92:95]
ds_read_b64_tr_b16 a[120:121],v2 offset:0
v_exp_f32 v74,v74
v_mfma_f32_16x16x32_bf16 v[100:103],a[148:151],a[92:95],0
ds_read_b64_tr_b16 a[122:123],v2 offset:6144
v_exp_f32 v75,v75
v_mfma_f32_16x16x32_bf16 v[100:103],a[144:147],a[88:91],v[100:103]
buffer_load_dwordx4 v8,s[4:7],s20 offen offset:2048 lds
v_mfma_f32_16x16x32_bf16 v[100:103],a[140:143],a[84:87],v[100:103]
s_add_u32 s20,s20,12288
ds_read_b64_tr_b16 a[124:125],v3 offset:0
v_exp_f32 v80,v80
v_mfma_f32_16x16x32_bf16 v[100:103],a[136:139],a[80:83],v[100:103]
ds_read_b64_tr_b16 a[126:127],v3 offset:6144
v_exp_f32 v81,v81
v_mfma_f32_16x16x32_bf16 v[100:103],a[132:135],a[76:79],v[100:103]
ds_read_b64_tr_b16 a[132:133],v5 offset:0
v_cvt_pk_bf16_f32 v204,v204,v205
v_mfma_f32_16x16x32_bf16 v[100:103],a[128:131],a[72:75],v[100:103]
ds_read_b64_tr_b16 a[128:129],v4 offset:0
ds_read_b64_tr_b16 a[130:131],v4 offset:6144
ds_read_b64_tr_b16 a[134:135],v5 offset:6144
v_cvt_pk_bf16_f32 v201,v202,v203
ds_write_b64 v38,v[200:201] offset:2048
v_cvt_pk_bf16_f32 v205,v206,v207
v_cvt_pk_bf16_f32 v44,v72,v73
v_cvt_pk_bf16_f32 v45,v74,v75
v_cvt_pk_bf16_f32 v48,v80,v81
ds_write_b64 v39,v[204:205] offset:2048
s_waitcnt lgkmcnt(7)
v_mfma_f32_16x16x32_bf16 v[160:163],a[120:123],v[20:23],0
s_add_u32 m0,s23,0
ds_read_b64_tr_b16 a[136:137],v2 offset:128
v_fma_f32 v82,v82,s36,v14
s_waitcnt lgkmcnt(7)
v_mfma_f32_16x16x32_bf16 v[164:167],a[124:127],v[20:23],0
ds_read_b64_tr_b16 a[138:139],v2 offset:6272
v_fma_f32 v83,v83,s36,v14
v_mfma_f32_16x16x32_bf16 v[212:215],a[124:127],v[24:27],0
ds_read_b64_tr_b16 a[140:141],v3 offset:128
v_fma_f32 v88,v88,s36,v15
v_mfma_f32_16x16x32_bf16 v[208:211],a[120:123],v[24:27],0
ds_read_b64_tr_b16 a[142:143],v3 offset:6272
v_fma_f32 v89,v89,s36,v15
v_mfma_f32_16x16x32_bf16 v[112:115],a[120:123],v[28:31],0
ds_read_b64_tr_b16 a[144:145],v4 offset:128
v_fma_f32 v90,v90,s36,v15
v_mfma_f32_16x16x32_bf16 v[116:119],a[124:127],v[28:31],0
ds_read_b64_tr_b16 a[146:147],v4 offset:6272
v_fma_f32 v91,v91,s36,v15
v_mfma_f32_16x16x32_bf16 a[164:167],a[124:127],v[32:35],0
ds_read_b64_tr_b16 a[148:149],v5 offset:128
v_fma_f32 v96,v96,s36,v16
v_mfma_f32_16x16x32_bf16 a[160:163],a[120:123],v[32:35],0
s_waitcnt lgkmcnt(6)
ds_read_b64_tr_b16 a[150:151],v5 offset:6272
v_fma_f32 v97,v97,s36,v16
v_mfma_f32_16x16x32_bf16 a[168:171],a[128:131],v[32:35],0
ds_read_b64_tr_b16 a[120:121],v2 offset:256
v_fma_f32 v98,v98,s36,v16
v_mfma_f32_16x16x32_bf16 a[172:175],a[132:135],v[32:35],0
ds_read_b64_tr_b16 a[122:123],v2 offset:6400
v_fma_f32 v99,v99,s36,v16
v_mfma_f32_16x16x32_bf16 v[124:127],a[132:135],v[28:31],0
ds_read_b64_tr_b16 a[124:125],v3 offset:256
v_fma_f32 v76,v76,s36,v13
v_mfma_f32_16x16x32_bf16 v[120:123],a[128:131],v[28:31],0
ds_read_b64_tr_b16 a[126:127],v3 offset:6400
v_fma_f32 v77,v77,s36,v13
v_mfma_f32_16x16x32_bf16 v[216:219],a[128:131],v[24:27],0
v_exp_f32 v82,v82
v_mfma_f32_16x16x32_bf16 v[220:223],a[132:135],v[24:27],0
v_exp_f32 v83,v83
v_mfma_f32_16x16x32_bf16 v[172:175],a[132:135],v[20:23],0
ds_read_b64_tr_b16 a[132:133],v5 offset:256
v_cvt_pk_bf16_f32 v49,v82,v83
v_mfma_f32_16x16x32_bf16 v[168:171],a[128:131],v[20:23],0
s_waitcnt lgkmcnt(4)
ds_read_b64_tr_b16 a[128:129],v4 offset:256
v_fma_f32 v78,v78,s36,v13
v_mfma_f32_16x16x32_bf16 v[176:179],a[136:139],v[20:23],0
ds_read_b64_tr_b16 a[130:131],v4 offset:6400
v_fma_f32 v79,v79,s36,v13
v_mfma_f32_16x16x32_bf16 v[180:183],a[140:143],v[20:23],0
ds_read_b64_tr_b16 a[134:135],v5 offset:6400
v_fma_f32 v84,v84,s36,v14
v_mfma_f32_16x16x32_bf16 v[228:231],a[140:143],v[24:27],0
v_exp_f32 v88,v88
v_mfma_f32_16x16x32_bf16 v[224:227],a[136:139],v[24:27],0
v_exp_f32 v89,v89
v_mfma_f32_16x16x32_bf16 v[128:131],a[136:139],v[28:31],0
v_exp_f32 v90,v90
v_mfma_f32_16x16x32_bf16 v[132:135],a[140:143],v[28:31],0
v_exp_f32 v91,v91
v_mfma_f32_16x16x32_bf16 a[180:183],a[140:143],v[32:35],0
v_cvt_pk_bf16_f32 v52,v88,v89
v_cvt_pk_bf16_f32 v53,v90,v91
v_mfma_f32_16x16x32_bf16 a[176:179],a[136:139],v[32:35],0
v_exp_f32 v96,v96
v_mfma_f32_16x16x32_bf16 a[184:187],a[144:147],v[32:35],0
v_exp_f32 v97,v97
v_mfma_f32_16x16x32_bf16 a[188:191],a[148:151],v[32:35],0
v_exp_f32 v98,v98
v_mfma_f32_16x16x32_bf16 v[140:143],a[148:151],v[28:31],0
v_exp_f32 v99,v99
v_mfma_f32_16x16x32_bf16 v[136:139],a[144:147],v[28:31],0
v_cvt_pk_bf16_f32 v56,v96,v97
v_cvt_pk_bf16_f32 v57,v98,v99
v_mfma_f32_16x16x32_bf16 v[232:235],a[144:147],v[24:27],0
v_exp_f32 v76,v76
v_mfma_f32_16x16x32_bf16 v[236:239],a[148:151],v[24:27],0
v_exp_f32 v77,v77
v_mfma_f32_16x16x32_bf16 v[188:191],a[148:151],v[20:23],0
v_exp_f32 v78,v78
v_mfma_f32_16x16x32_bf16 v[184:187],a[144:147],v[20:23],0
s_waitcnt lgkmcnt(0)
v_exp_f32 v79,v79
v_mfma_f32_16x16x32_bf16 v[192:195],a[120:123],v[20:23],0
s_waitcnt vmcnt(24)
v_cvt_pk_bf16_f32 v46,v76,v77
v_cvt_pk_bf16_f32 v47,v78,v79
v_mfma_f32_16x16x32_bf16 v[196:199],a[124:127],v[20:23],0
s_barrier
v_mfma_f32_16x16x32_bf16 v[244:247],a[124:127],v[24:27],0
ds_read_b128 a[148:151],v1 offset:24704
v_fma_f32 v85,v85,s36,v14
v_mfma_f32_16x16x32_bf16 v[240:243],a[120:123],v[24:27],0
ds_read_b128 a[144:147],v0 offset:24704
v_fma_f32 v86,v86,s36,v14
v_mfma_f32_16x16x32_bf16 v[144:147],a[120:123],v[28:31],0
ds_read_b128 a[140:143],v1 offset:24576
v_fma_f32 v87,v87,s36,v14
v_mfma_f32_16x16x32_bf16 v[148:151],a[124:127],v[28:31],0
ds_read_b128 a[136:139],v0 offset:24576
v_fma_f32 v92,v92,s36,v15
v_mfma_f32_16x16x32_bf16 a[196:199],a[124:127],v[32:35],0
ds_read_b128 a[124:127],v1 offset:24832
v_fma_f32 v93,v93,s36,v15
v_mfma_f32_16x16x32_bf16 a[192:195],a[120:123],v[32:35],0
buffer_load_dwordx4 v6,s[8:11],s21 offen offset:0 lds
v_mfma_f32_16x16x32_bf16 a[200:203],a[128:131],v[32:35],0
ds_read_b128 a[120:123],v0 offset:24832
v_fma_f32 v94,v94,s36,v15
v_mfma_f32_16x16x32_bf16 a[204:207],a[132:135],v[32:35],0
v_exp_f32 v84,v84
v_mfma_f32_16x16x32_bf16 v[156:159],a[132:135],v[28:31],0
v_exp_f32 v85,v85
v_mfma_f32_16x16x32_bf16 v[152:155],a[128:131],v[28:31],0
v_exp_f32 v86,v86
v_mfma_f32_16x16x32_bf16 v[248:251],a[128:131],v[24:27],0
v_exp_f32 v87,v87
v_mfma_f32_16x16x32_bf16 v[252:255],a[132:135],v[24:27],0
v_cvt_pk_bf16_f32 v50,v84,v85
v_cvt_pk_bf16_f32 v51,v86,v87
v_mfma_f32_16x16x32_bf16 v[204:207],a[132:135],v[20:23],0
ds_read_b128 a[132:135],v1 offset:30720
v_fma_f32 v95,v95,s36,v15
v_smfmac_f32_16x16x64_bf16 v[60:63],a[152:155],v[44:51],v18
v_fma_f32 v100,v100,s36,v16
v_mfma_f32_16x16x32_bf16 v[200:203],a[128:131],v[20:23],0
buffer_load_dwordx4 v7,s[8:11],s21 offen offset:1024 lds
s_waitcnt lgkmcnt(1)
v_mfma_f32_16x16x32_bf16 v[72:75],a[124:127],a[20:23],0
ds_read_b128 a[128:131],v0 offset:30720
v_fma_f32 v101,v101,s36,v16
v_mfma_f32_16x16x32_bf16 v[72:75],a[120:123],a[16:19],v[72:75]
v_exp_f32 v92,v92
v_mfma_f32_16x16x32_bf16 v[72:75],a[148:151],a[12:15],v[72:75]
v_exp_f32 v93,v93
v_mfma_f32_16x16x32_bf16 v[72:75],a[144:147],a[8:11],v[72:75]
v_exp_f32 v94,v94
v_mfma_f32_16x16x32_bf16 v[72:75],a[140:143],a[4:7],v[72:75]
v_exp_f32 v95,v95
v_mfma_f32_16x16x32_bf16 v[72:75],a[136:139],a[0:3],v[72:75]
v_cvt_pk_bf16_f32 v54,v92,v93
v_cvt_pk_bf16_f32 v55,v94,v95
v_mfma_f32_16x16x32_bf16 v[80:83],a[136:139],a[24:27],0
v_fma_f32 v102,v102,s36,v16
v_fma_f32 v103,v103,s36,v16
v_mfma_f32_16x16x32_bf16 v[80:83],a[140:143],a[28:31],v[80:83]
v_exp_f32 v100,v100
v_mfma_f32_16x16x32_bf16 v[80:83],a[144:147],a[32:35],v[80:83]
buffer_load_dwordx4 v8,s[8:11],s21 offen offset:2048 lds
v_mfma_f32_16x16x32_bf16 v[80:83],a[148:151],a[36:39],v[80:83]
s_add_u32 s21,s21,12288
v_exp_f32 v101,v101
v_mfma_f32_16x16x32_bf16 v[80:83],a[120:123],a[40:43],v[80:83]
s_add_u32 m0,s22,12288
v_exp_f32 v102,v102
v_mfma_f32_16x16x32_bf16 v[80:83],a[124:127],a[44:47],v[80:83]
v_exp_f32 v103,v103
v_mfma_f32_16x16x32_bf16 v[88:91],a[124:127],a[68:71],0
v_cvt_pk_bf16_f32 v58,v100,v101
v_cvt_pk_bf16_f32 v59,v102,v103
v_mfma_f32_16x16x32_bf16 v[88:91],a[120:123],a[64:67],v[88:91]
v_fma_f32 v72,v72,s36,v13
v_fma_f32 v73,v73,s36,v13
v_smfmac_f32_16x16x64_bf16 v[64:67],a[152:155],v[52:59],v18
v_fma_f32 v74,v74,s36,v13
v_mfma_f32_16x16x32_bf16 v[88:91],a[148:151],a[60:63],v[88:91]
v_fma_f32 v75,v75,s36,v13
v_fma_f32 v80,v80,s36,v14
v_mfma_f32_16x16x32_bf16 v[88:91],a[144:147],a[56:59],v[88:91]
v_fma_f32 v81,v81,s36,v14
v_mfma_f32_16x16x32_bf16 v[88:91],a[140:143],a[52:55],v[88:91]
buffer_load_dwordx4 v6,s[4:7],s20 offen offset:0 lds
v_mfma_f32_16x16x32_bf16 v[88:91],a[136:139],a[48:51],v[88:91]
v_exp_f32 v72,v72
v_mfma_f32_16x16x32_bf16 v[96:99],a[136:139],a[72:75],0
ds_read_b128 a[136:139],v0 offset:30848
v_mfma_f32_16x16x32_bf16 v[96:99],a[140:143],a[76:79],v[96:99]
ds_read_b128 a[140:143],v1 offset:30848
v_mfma_f32_16x16x32_bf16 v[96:99],a[144:147],a[80:83],v[96:99]
ds_read_b128 a[144:147],v0 offset:30976
v_mfma_f32_16x16x32_bf16 v[96:99],a[148:151],a[84:87],v[96:99]
ds_read_b128 a[148:151],v1 offset:30976
v_mfma_f32_16x16x32_bf16 v[96:99],a[120:123],a[88:91],v[96:99]
v_exp_f32 v73,v73
v_mfma_f32_16x16x32_bf16 v[96:99],a[124:127],a[92:95],v[96:99]
s_waitcnt lgkmcnt(4)
v_exp_f32 v74,v74
v_mfma_f32_16x16x32_bf16 v[76:79],a[128:131],a[0:3],0
v_exp_f32 v75,v75
v_mfma_f32_16x16x32_bf16 v[76:79],a[132:135],a[4:7],v[76:79]
buffer_load_dwordx4 v7,s[4:7],s20 offen offset:1024 lds
s_waitcnt lgkmcnt(3)
v_mfma_f32_16x16x32_bf16 v[76:79],a[136:139],a[8:11],v[76:79]
s_waitcnt lgkmcnt(2)
v_exp_f32 v80,v80
v_mfma_f32_16x16x32_bf16 v[76:79],a[140:143],a[12:15],v[76:79]
s_waitcnt lgkmcnt(0)
v_exp_f32 v81,v81
v_mfma_f32_16x16x32_bf16 v[76:79],a[144:147],a[16:19],v[76:79]
v_cvt_pk_bf16_f32 v20,v72,v73
v_cvt_pk_bf16_f32 v21,v74,v75
v_mfma_f32_16x16x32_bf16 v[76:79],a[148:151],a[20:23],v[76:79]
v_cvt_pk_bf16_f32 v24,v80,v81
v_mfma_f32_16x16x32_bf16 v[84:87],a[148:151],a[44:47],0
v_mfma_f32_16x16x32_bf16 v[84:87],a[144:147],a[40:43],v[84:87]
v_mfma_f32_16x16x32_bf16 v[84:87],a[140:143],a[36:39],v[84:87]
v_mfma_f32_16x16x32_bf16 v[84:87],a[136:139],a[32:35],v[84:87]
v_mfma_f32_16x16x32_bf16 v[84:87],a[132:135],a[28:31],v[84:87]
buffer_load_dwordx4 v8,s[4:7],s20 offen offset:2048 lds
v_mfma_f32_16x16x32_bf16 v[84:87],a[128:131],a[24:27],v[84:87]
s_add_u32 s20,s20,12288
v_mfma_f32_16x16x32_bf16 v[92:95],a[128:131],a[48:51],0
ds_read_b64_tr_b16 a[120:121],v2 offset:12288
v_mfma_f32_16x16x32_bf16 v[92:95],a[132:135],a[52:55],v[92:95]
ds_read_b64_tr_b16 a[122:123],v2 offset:18432
v_mfma_f32_16x16x32_bf16 v[92:95],a[136:139],a[56:59],v[92:95]
ds_read_b64_tr_b16 a[124:125],v3 offset:12288
v_mfma_f32_16x16x32_bf16 v[92:95],a[140:143],a[60:63],v[92:95]
ds_read_b64_tr_b16 a[126:127],v3 offset:18432
v_mfma_f32_16x16x32_bf16 v[92:95],a[144:147],a[64:67],v[92:95]
v_mfma_f32_16x16x32_bf16 v[92:95],a[148:151],a[68:71],v[92:95]
v_mfma_f32_16x16x32_bf16 v[100:103],a[148:151],a[92:95],0
v_mfma_f32_16x16x32_bf16 v[100:103],a[144:147],a[88:91],v[100:103]
v_mfma_f32_16x16x32_bf16 v[100:103],a[140:143],a[84:87],v[100:103]
v_mfma_f32_16x16x32_bf16 v[100:103],a[136:139],a[80:83],v[100:103]
v_mfma_f32_16x16x32_bf16 v[100:103],a[132:135],a[76:79],v[100:103]
ds_read_b64_tr_b16 a[132:133],v5 offset:12288
v_mfma_f32_16x16x32_bf16 v[100:103],a[128:131],a[72:75],v[100:103]
s_waitcnt lgkmcnt(1)
ds_read_b64_tr_b16 a[128:129],v4 offset:12288
ds_read_b64_tr_b16 a[130:131],v4 offset:18432
ds_read_b64_tr_b16 a[134:135],v5 offset:18432
v_mfma_f32_16x16x32_bf16 v[160:163],a[120:123],v[44:47],v[160:163]
s_add_u32 m0,s23,12288
ds_read_b64_tr_b16 a[136:137],v2 offset:12416
v_fma_f32 v82,v82,s36,v14
v_mfma_f32_16x16x32_bf16 v[164:167],a[124:127],v[44:47],v[164:167]
ds_read_b64_tr_b16 a[138:139],v2 offset:18560
v_fma_f32 v83,v83,s36,v14
v_mfma_f32_16x16x32_bf16 v[212:215],a[124:127],v[48:51],v[212:215]
ds_read_b64_tr_b16 a[140:141],v3 offset:12416
v_fma_f32 v88,v88,s36,v15
v_mfma_f32_16x16x32_bf16 v[208:211],a[120:123],v[48:51],v[208:211]
ds_read_b64_tr_b16 a[142:143],v3 offset:18560
v_fma_f32 v89,v89,s36,v15
v_mfma_f32_16x16x32_bf16 v[112:115],a[120:123],v[52:55],v[112:115]
ds_read_b64_tr_b16 a[144:145],v4 offset:12416
v_fma_f32 v90,v90,s36,v15
v_mfma_f32_16x16x32_bf16 v[116:119],a[124:127],v[52:55],v[116:119]
ds_read_b64_tr_b16 a[146:147],v4 offset:18560
v_fma_f32 v91,v91,s36,v15
v_mfma_f32_16x16x32_bf16 a[164:167],a[124:127],v[56:59],a[164:167]
ds_read_b64_tr_b16 a[148:149],v5 offset:12416
v_fma_f32 v96,v96,s36,v16
v_mfma_f32_16x16x32_bf16 a[160:163],a[120:123],v[56:59],a[160:163]
s_waitcnt lgkmcnt(6)
ds_read_b64_tr_b16 a[150:151],v5 offset:18560
v_fma_f32 v97,v97,s36,v16
v_mfma_f32_16x16x32_bf16 a[168:171],a[128:131],v[56:59],a[168:171]
ds_read_b64_tr_b16 a[120:121],v2 offset:12544
v_fma_f32 v98,v98,s36,v16
v_mfma_f32_16x16x32_bf16 a[172:175],a[132:135],v[56:59],a[172:175]
ds_read_b64_tr_b16 a[122:123],v2 offset:18688
v_fma_f32 v99,v99,s36,v16
v_mfma_f32_16x16x32_bf16 v[124:127],a[132:135],v[52:55],v[124:127]
ds_read_b64_tr_b16 a[124:125],v3 offset:12544
v_fma_f32 v76,v76,s36,v13
v_mfma_f32_16x16x32_bf16 v[120:123],a[128:131],v[52:55],v[120:123]
ds_read_b64_tr_b16 a[126:127],v3 offset:18688
v_fma_f32 v77,v77,s36,v13
v_mfma_f32_16x16x32_bf16 v[216:219],a[128:131],v[48:51],v[216:219]
v_exp_f32 v82,v82
v_mfma_f32_16x16x32_bf16 v[220:223],a[132:135],v[48:51],v[220:223]
v_exp_f32 v83,v83
v_mfma_f32_16x16x32_bf16 v[172:175],a[132:135],v[44:47],v[172:175]
ds_read_b64_tr_b16 a[132:133],v5 offset:12544
v_cvt_pk_bf16_f32 v25,v82,v83
v_mfma_f32_16x16x32_bf16 v[168:171],a[128:131],v[44:47],v[168:171]
s_waitcnt lgkmcnt(4)
ds_read_b64_tr_b16 a[128:129],v4 offset:12544
v_fma_f32 v78,v78,s36,v13
v_mfma_f32_16x16x32_bf16 v[176:179],a[136:139],v[44:47],v[176:179]
ds_read_b64_tr_b16 a[130:131],v4 offset:18688
v_fma_f32 v79,v79,s36,v13
v_mfma_f32_16x16x32_bf16 v[180:183],a[140:143],v[44:47],v[180:183]
ds_read_b64_tr_b16 a[134:135],v5 offset:18688
v_fma_f32 v84,v84,s36,v14
v_mfma_f32_16x16x32_bf16 v[228:231],a[140:143],v[48:51],v[228:231]
v_exp_f32 v88,v88
v_mfma_f32_16x16x32_bf16 v[224:227],a[136:139],v[48:51],v[224:227]
v_exp_f32 v89,v89
v_mfma_f32_16x16x32_bf16 v[128:131],a[136:139],v[52:55],v[128:131]
v_exp_f32 v90,v90
v_mfma_f32_16x16x32_bf16 v[132:135],a[140:143],v[52:55],v[132:135]
v_exp_f32 v91,v91
v_mfma_f32_16x16x32_bf16 a[180:183],a[140:143],v[56:59],a[180:183]
v_cvt_pk_bf16_f32 v28,v88,v89
v_cvt_pk_bf16_f32 v29,v90,v91
v_mfma_f32_16x16x32_bf16 a[176:179],a[136:139],v[56:59],a[176:179]
v_exp_f32 v96,v96
v_mfma_f32_16x16x32_bf16 a[184:187],a[144:147],v[56:59],a[184:187]
v_exp_f32 v97,v97
v_mfma_f32_16x16x32_bf16 a[188:191],a[148:151],v[56:59],a[188:191]
v_exp_f32 v98,v98
v_mfma_f32_16x16x32_bf16 v[140:143],a[148:151],v[52:55],v[140:143]
v_exp_f32 v99,v99
v_mfma_f32_16x16x32_bf16 v[136:139],a[144:147],v[52:55],v[136:139]
v_cvt_pk_bf16_f32 v32,v96,v97
v_cvt_pk_bf16_f32 v33,v98,v99
v_mfma_f32_16x16x32_bf16 v[232:235],a[144:147],v[48:51],v[232:235]
v_exp_f32 v76,v76
v_mfma_f32_16x16x32_bf16 v[236:239],a[148:151],v[48:51],v[236:239]
v_exp_f32 v77,v77
v_mfma_f32_16x16x32_bf16 v[188:191],a[148:151],v[44:47],v[188:191]
v_exp_f32 v78,v78
v_mfma_f32_16x16x32_bf16 v[184:187],a[144:147],v[44:47],v[184:187]
s_waitcnt lgkmcnt(0)
v_exp_f32 v79,v79
v_mfma_f32_16x16x32_bf16 v[192:195],a[120:123],v[44:47],v[192:195]
s_waitcnt vmcnt(6)
v_cvt_pk_bf16_f32 v22,v76,v77
v_cvt_pk_bf16_f32 v23,v78,v79
v_mfma_f32_16x16x32_bf16 v[196:199],a[124:127],v[44:47],v[196:199]
s_barrier
v_mfma_f32_16x16x32_bf16 v[244:247],a[124:127],v[48:51],v[244:247]
ds_read_b128 a[148:151],v1 offset:128
v_fma_f32 v85,v85,s36,v14
v_mfma_f32_16x16x32_bf16 v[240:243],a[120:123],v[48:51],v[240:243]
ds_read_b128 a[144:147],v0 offset:128
v_fma_f32 v86,v86,s36,v14
v_mfma_f32_16x16x32_bf16 v[144:147],a[120:123],v[52:55],v[144:147]
ds_read_b128 a[140:143],v1 offset:0
v_fma_f32 v87,v87,s36,v14
v_mfma_f32_16x16x32_bf16 v[148:151],a[124:127],v[52:55],v[148:151]
ds_read_b128 a[136:139],v0 offset:0
v_fma_f32 v92,v92,s36,v15
v_mfma_f32_16x16x32_bf16 a[196:199],a[124:127],v[56:59],a[196:199]
ds_read_b128 a[124:127],v1 offset:256
v_fma_f32 v93,v93,s36,v15
v_mfma_f32_16x16x32_bf16 a[192:195],a[120:123],v[56:59],a[192:195]
buffer_load_dwordx4 v6,s[8:11],s21 offen offset:0 lds
v_mfma_f32_16x16x32_bf16 a[200:203],a[128:131],v[56:59],a[200:203]
ds_read_b128 a[120:123],v0 offset:256
v_fma_f32 v94,v94,s36,v15
v_mfma_f32_16x16x32_bf16 a[204:207],a[132:135],v[56:59],a[204:207]
v_exp_f32 v84,v84
v_mfma_f32_16x16x32_bf16 v[156:159],a[132:135],v[52:55],v[156:159]
v_exp_f32 v85,v85
v_mfma_f32_16x16x32_bf16 v[152:155],a[128:131],v[52:55],v[152:155]
v_exp_f32 v86,v86
v_mfma_f32_16x16x32_bf16 v[248:251],a[128:131],v[48:51],v[248:251]
v_exp_f32 v87,v87
v_mfma_f32_16x16x32_bf16 v[252:255],a[132:135],v[48:51],v[252:255]
v_cvt_pk_bf16_f32 v26,v84,v85
v_cvt_pk_bf16_f32 v27,v86,v87
v_mfma_f32_16x16x32_bf16 v[204:207],a[132:135],v[44:47],v[204:207]
ds_read_b128 a[132:135],v1 offset:6144
v_fma_f32 v95,v95,s36,v15
v_smfmac_f32_16x16x64_bf16 v[60:63],a[152:155],v[20:27],v18
v_fma_f32 v100,v100,s36,v16
v_mfma_f32_16x16x32_bf16 v[200:203],a[128:131],v[44:47],v[200:203]
buffer_load_dwordx4 v7,s[8:11],s21 offen offset:1024 lds
s_waitcnt lgkmcnt(1)
v_mfma_f32_16x16x32_bf16 v[72:75],a[124:127],a[20:23],0
ds_read_b128 a[128:131],v0 offset:6144
v_fma_f32 v101,v101,s36,v16
v_mfma_f32_16x16x32_bf16 v[72:75],a[120:123],a[16:19],v[72:75]
v_exp_f32 v92,v92
v_mfma_f32_16x16x32_bf16 v[72:75],a[148:151],a[12:15],v[72:75]
v_exp_f32 v93,v93
v_mfma_f32_16x16x32_bf16 v[72:75],a[144:147],a[8:11],v[72:75]
v_exp_f32 v94,v94
v_mfma_f32_16x16x32_bf16 v[72:75],a[140:143],a[4:7],v[72:75]
v_exp_f32 v95,v95
v_mfma_f32_16x16x32_bf16 v[72:75],a[136:139],a[0:3],v[72:75]
v_cvt_pk_bf16_f32 v30,v92,v93
v_cvt_pk_bf16_f32 v31,v94,v95
v_mfma_f32_16x16x32_bf16 v[80:83],a[136:139],a[24:27],0
v_fma_f32 v102,v102,s36,v16
v_fma_f32 v103,v103,s36,v16
v_mfma_f32_16x16x32_bf16 v[80:83],a[140:143],a[28:31],v[80:83]
v_exp_f32 v100,v100
v_mfma_f32_16x16x32_bf16 v[80:83],a[144:147],a[32:35],v[80:83]
buffer_load_dwordx4 v8,s[8:11],s21 offen offset:2048 lds
v_mfma_f32_16x16x32_bf16 v[80:83],a[148:151],a[36:39],v[80:83]
s_add_u32 s21,s21,12288
v_exp_f32 v101,v101
v_mfma_f32_16x16x32_bf16 v[80:83],a[120:123],a[40:43],v[80:83]
s_add_u32 m0,s22,24576
v_exp_f32 v102,v102
v_mfma_f32_16x16x32_bf16 v[80:83],a[124:127],a[44:47],v[80:83]
v_exp_f32 v103,v103
v_mfma_f32_16x16x32_bf16 v[88:91],a[124:127],a[68:71],0
v_cvt_pk_bf16_f32 v34,v100,v101
v_cvt_pk_bf16_f32 v35,v102,v103
v_mfma_f32_16x16x32_bf16 v[88:91],a[120:123],a[64:67],v[88:91]
v_fma_f32 v72,v72,s36,v13
v_fma_f32 v73,v73,s36,v13
v_smfmac_f32_16x16x64_bf16 v[64:67],a[152:155],v[28:35],v18
v_fma_f32 v74,v74,s36,v13
v_mfma_f32_16x16x32_bf16 v[88:91],a[148:151],a[60:63],v[88:91]
v_fma_f32 v75,v75,s36,v13
v_fma_f32 v80,v80,s36,v14
v_mfma_f32_16x16x32_bf16 v[88:91],a[144:147],a[56:59],v[88:91]
v_fma_f32 v81,v81,s36,v14
v_mfma_f32_16x16x32_bf16 v[88:91],a[140:143],a[52:55],v[88:91]
buffer_load_dwordx4 v6,s[4:7],s20 offen offset:0 lds
v_mfma_f32_16x16x32_bf16 v[88:91],a[136:139],a[48:51],v[88:91]
v_exp_f32 v72,v72
v_mfma_f32_16x16x32_bf16 v[96:99],a[136:139],a[72:75],0
ds_read_b128 a[136:139],v0 offset:6272
v_mfma_f32_16x16x32_bf16 v[96:99],a[140:143],a[76:79],v[96:99]
ds_read_b128 a[140:143],v1 offset:6272
v_mfma_f32_16x16x32_bf16 v[96:99],a[144:147],a[80:83],v[96:99]
ds_read_b128 a[144:147],v0 offset:6400
v_mfma_f32_16x16x32_bf16 v[96:99],a[148:151],a[84:87],v[96:99]
ds_read_b128 a[148:151],v1 offset:6400
v_mfma_f32_16x16x32_bf16 v[96:99],a[120:123],a[88:91],v[96:99]
v_exp_f32 v73,v73
v_mfma_f32_16x16x32_bf16 v[96:99],a[124:127],a[92:95],v[96:99]
s_waitcnt lgkmcnt(4)
v_exp_f32 v74,v74
v_mfma_f32_16x16x32_bf16 v[76:79],a[128:131],a[0:3],0
v_exp_f32 v75,v75
v_mfma_f32_16x16x32_bf16 v[76:79],a[132:135],a[4:7],v[76:79]
buffer_load_dwordx4 v7,s[4:7],s20 offen offset:1024 lds
s_waitcnt lgkmcnt(3)
v_mfma_f32_16x16x32_bf16 v[76:79],a[136:139],a[8:11],v[76:79]
s_waitcnt lgkmcnt(2)
v_exp_f32 v80,v80
v_mfma_f32_16x16x32_bf16 v[76:79],a[140:143],a[12:15],v[76:79]
s_waitcnt lgkmcnt(0)
v_exp_f32 v81,v81
v_mfma_f32_16x16x32_bf16 v[76:79],a[144:147],a[16:19],v[76:79]
v_cvt_pk_bf16_f32 v44,v72,v73
v_cvt_pk_bf16_f32 v45,v74,v75
v_mfma_f32_16x16x32_bf16 v[76:79],a[148:151],a[20:23],v[76:79]
v_cvt_pk_bf16_f32 v48,v80,v81
v_mfma_f32_16x16x32_bf16 v[84:87],a[148:151],a[44:47],0
v_mfma_f32_16x16x32_bf16 v[84:87],a[144:147],a[40:43],v[84:87]
v_mfma_f32_16x16x32_bf16 v[84:87],a[140:143],a[36:39],v[84:87]
v_mfma_f32_16x16x32_bf16 v[84:87],a[136:139],a[32:35],v[84:87]
v_mfma_f32_16x16x32_bf16 v[84:87],a[132:135],a[28:31],v[84:87]
buffer_load_dwordx4 v8,s[4:7],s20 offen offset:2048 lds
v_mfma_f32_16x16x32_bf16 v[84:87],a[128:131],a[24:27],v[84:87]
s_add_u32 s20,s20,12288
v_mfma_f32_16x16x32_bf16 v[92:95],a[128:131],a[48:51],0
ds_read_b64_tr_b16 a[120:121],v2 offset:24576
v_mfma_f32_16x16x32_bf16 v[92:95],a[132:135],a[52:55],v[92:95]
ds_read_b64_tr_b16 a[122:123],v2 offset:30720
v_mfma_f32_16x16x32_bf16 v[92:95],a[136:139],a[56:59],v[92:95]
ds_read_b64_tr_b16 a[124:125],v3 offset:24576
v_mfma_f32_16x16x32_bf16 v[92:95],a[140:143],a[60:63],v[92:95]
ds_read_b64_tr_b16 a[126:127],v3 offset:30720
v_mfma_f32_16x16x32_bf16 v[92:95],a[144:147],a[64:67],v[92:95]
v_mfma_f32_16x16x32_bf16 v[92:95],a[148:151],a[68:71],v[92:95]
v_mfma_f32_16x16x32_bf16 v[100:103],a[148:151],a[92:95],0
v_mfma_f32_16x16x32_bf16 v[100:103],a[144:147],a[88:91],v[100:103]
v_mfma_f32_16x16x32_bf16 v[100:103],a[140:143],a[84:87],v[100:103]
v_mfma_f32_16x16x32_bf16 v[100:103],a[136:139],a[80:83],v[100:103]
v_mfma_f32_16x16x32_bf16 v[100:103],a[132:135],a[76:79],v[100:103]
ds_read_b64_tr_b16 a[132:133],v5 offset:24576
v_mfma_f32_16x16x32_bf16 v[100:103],a[128:131],a[72:75],v[100:103]
ds_read_b64_tr_b16 a[128:129],v4 offset:24576
ds_read_b64_tr_b16 a[130:131],v4 offset:30720
ds_read_b64_tr_b16 a[134:135],v5 offset:30720
s_mov_b32 s38,0
s_branch L_loop4
L_end5:
s_waitcnt lgkmcnt(3)
v_mfma_f32_16x16x32_bf16 v[160:163],a[120:123],v[20:23],v[160:163]
ds_read_b64_tr_b16 a[136:137],v2 offset:24704
v_fma_f32 v90,v90,s36,v15
v_mfma_f32_16x16x32_bf16 v[164:167],a[124:127],v[20:23],v[164:167]
ds_read_b64_tr_b16 a[138:139],v2 offset:30848
v_fma_f32 v91,v91,s36,v15
v_mfma_f32_16x16x32_bf16 v[212:215],a[124:127],v[24:27],v[212:215]
ds_read_b64_tr_b16 a[140:141],v3 offset:24704
v_fma_f32 v96,v96,s36,v16
v_mfma_f32_16x16x32_bf16 v[208:211],a[120:123],v[24:27],v[208:211]
ds_read_b64_tr_b16 a[142:143],v3 offset:30848
v_fma_f32 v97,v97,s36,v16
v_mfma_f32_16x16x32_bf16 v[112:115],a[120:123],v[28:31],v[112:115]
ds_read_b64_tr_b16 a[144:145],v4 offset:24704
v_fma_f32 v98,v98,s36,v16
v_mfma_f32_16x16x32_bf16 v[116:119],a[124:127],v[28:31],v[116:119]
ds_read_b64_tr_b16 a[146:147],v4 offset:30848
ds_read_b64_tr_b16 a[148:149],v5 offset:24704
ds_read_b64_tr_b16 a[150:151],v5 offset:30848
v_mfma_f32_16x16x32_bf16 a[164:167],a[124:127],v[32:35],a[164:167]
v_fma_f32 v99,v99,s36,v16
v_fma_f32 v104,v104,s36,v17
v_mfma_f32_16x16x32_bf16 a[160:163],a[120:123],v[32:35],a[160:163]
v_fma_f32 v105,v105,s36,v17
v_fma_f32 v106,v106,s36,v17
v_mfma_f32_16x16x32_bf16 a[208:211],a[120:123],v[36:39],a[208:211]
ds_read_b64_tr_b16 a[120:121],v2 offset:24832
v_fma_f32 v107,v107,s36,v17
v_mfma_f32_16x16x32_bf16 a[212:215],a[124:127],v[36:39],a[212:215]
s_waitcnt lgkmcnt(6)
ds_read_b64_tr_b16 a[122:123],v2 offset:30976
v_fma_f32 v76,v76,s36,v13
v_mfma_f32_16x16x32_bf16 a[216:219],a[128:131],v[36:39],a[216:219]
ds_read_b64_tr_b16 a[124:125],v3 offset:24832
v_fma_f32 v77,v77,s36,v13
v_mfma_f32_16x16x32_bf16 a[220:223],a[132:135],v[36:39],a[220:223]
ds_read_b64_tr_b16 a[126:127],v3 offset:30976
v_fma_f32 v78,v78,s36,v13
v_mfma_f32_16x16x32_bf16 a[172:175],a[132:135],v[32:35],a[172:175]
v_fma_f32 v79,v79,s36,v13
v_fma_f32 v84,v84,s36,v14
v_mfma_f32_16x16x32_bf16 a[168:171],a[128:131],v[32:35],a[168:171]
v_fma_f32 v85,v85,s36,v14
v_fma_f32 v86,v86,s36,v14
v_mfma_f32_16x16x32_bf16 v[120:123],a[128:131],v[28:31],v[120:123]
v_fma_f32 v87,v87,s36,v14
v_fma_f32 v92,v92,s36,v15
v_mfma_f32_16x16x32_bf16 v[124:127],a[132:135],v[28:31],v[124:127]
v_fma_f32 v93,v93,s36,v15
v_fma_f32 v94,v94,s36,v15
v_mfma_f32_16x16x32_bf16 v[220:223],a[132:135],v[24:27],v[220:223]
v_fma_f32 v95,v95,s36,v15
v_fma_f32 v100,v100,s36,v16
v_mfma_f32_16x16x32_bf16 v[216:219],a[128:131],v[24:27],v[216:219]
v_fma_f32 v101,v101,s36,v16
v_fma_f32 v102,v102,s36,v16
v_mfma_f32_16x16x32_bf16 v[168:171],a[128:131],v[20:23],v[168:171]
ds_read_b64_tr_b16 a[128:129],v4 offset:24832
v_fma_f32 v103,v103,s36,v16
v_mfma_f32_16x16x32_bf16 v[172:175],a[132:135],v[20:23],v[172:175]
ds_read_b64_tr_b16 a[130:131],v4 offset:30976
v_fma_f32 v108,v108,s36,v17
v_mfma_f32_16x16x32_bf16 v[176:179],a[136:139],v[20:23],v[176:179]
s_waitcnt lgkmcnt(2)
ds_read_b64_tr_b16 a[132:133],v5 offset:24832
v_fma_f32 v109,v109,s36,v17
v_mfma_f32_16x16x32_bf16 v[180:183],a[140:143],v[20:23],v[180:183]
ds_read_b64_tr_b16 a[134:135],v5 offset:30976
v_fma_f32 v110,v110,s36,v17
v_mfma_f32_16x16x32_bf16 v[228:231],a[140:143],v[24:27],v[228:231]
v_fma_f32 v111,v111,s36,v17
v_exp_f32 v90,v90
v_mfma_f32_16x16x32_bf16 v[224:227],a[136:139],v[24:27],v[224:227]
v_exp_f32 v91,v91
v_mfma_f32_16x16x32_bf16 v[128:131],a[136:139],v[28:31],v[128:131]
v_exp_f32 v96,v96
v_mfma_f32_16x16x32_bf16 v[132:135],a[140:143],v[28:31],v[132:135]
v_exp_f32 v97,v97
v_mfma_f32_16x16x32_bf16 a[180:183],a[140:143],v[32:35],a[180:183]
v_exp_f32 v98,v98
v_mfma_f32_16x16x32_bf16 a[176:179],a[136:139],v[32:35],a[176:179]
v_exp_f32 v99,v99
v_mfma_f32_16x16x32_bf16 a[224:227],a[136:139],v[36:39],a[224:227]
v_exp_f32 v104,v104
v_mfma_f32_16x16x32_bf16 a[228:231],a[140:143],v[36:39],a[228:231]
v_exp_f32 v105,v105
v_mfma_f32_16x16x32_bf16 a[232:235],a[144:147],v[36:39],a[232:235]
v_exp_f32 v106,v106
v_mfma_f32_16x16x32_bf16 a[236:239],a[148:151],v[36:39],a[236:239]
v_exp_f32 v107,v107
v_mfma_f32_16x16x32_bf16 a[188:191],a[148:151],v[32:35],a[188:191]
v_exp_f32 v76,v76
v_mfma_f32_16x16x32_bf16 a[184:187],a[144:147],v[32:35],a[184:187]
v_exp_f32 v77,v77
v_mfma_f32_16x16x32_bf16 v[136:139],a[144:147],v[28:31],v[136:139]
v_exp_f32 v78,v78
v_mfma_f32_16x16x32_bf16 v[140:143],a[148:151],v[28:31],v[140:143]
v_exp_f32 v79,v79
v_mfma_f32_16x16x32_bf16 v[236:239],a[148:151],v[24:27],v[236:239]
v_exp_f32 v84,v84
v_mfma_f32_16x16x32_bf16 v[232:235],a[144:147],v[24:27],v[232:235]
v_exp_f32 v85,v85
v_mfma_f32_16x16x32_bf16 v[184:187],a[144:147],v[20:23],v[184:187]
v_exp_f32 v86,v86
v_mfma_f32_16x16x32_bf16 v[188:191],a[148:151],v[20:23],v[188:191]
v_exp_f32 v87,v87
v_mfma_f32_16x16x32_bf16 v[192:195],a[120:123],v[20:23],v[192:195]
v_exp_f32 v92,v92
v_mfma_f32_16x16x32_bf16 v[196:199],a[124:127],v[20:23],v[196:199]
v_exp_f32 v93,v93
v_mfma_f32_16x16x32_bf16 v[244:247],a[124:127],v[24:27],v[244:247]
v_exp_f32 v94,v94
v_mfma_f32_16x16x32_bf16 v[240:243],a[120:123],v[24:27],v[240:243]
v_exp_f32 v95,v95
v_mfma_f32_16x16x32_bf16 v[144:147],a[120:123],v[28:31],v[144:147]
v_exp_f32 v100,v100
v_mfma_f32_16x16x32_bf16 v[148:151],a[124:127],v[28:31],v[148:151]
v_exp_f32 v101,v101
v_mfma_f32_16x16x32_bf16 a[196:199],a[124:127],v[32:35],a[196:199]
v_exp_f32 v102,v102
v_mfma_f32_16x16x32_bf16 a[192:195],a[120:123],v[32:35],a[192:195]
v_exp_f32 v103,v103
v_mfma_f32_16x16x32_bf16 a[240:243],a[120:123],v[36:39],a[240:243]
v_exp_f32 v108,v108
s_waitcnt vmcnt(12) lgkmcnt(0)
s_barrier
v_mfma_f32_16x16x32_bf16 a[244:247],a[124:127],v[36:39],a[244:247]
v_exp_f32 v109,v109
v_mfma_f32_16x16x32_bf16 a[248:251],a[128:131],v[36:39],a[248:251]
v_exp_f32 v110,v110
v_mfma_f32_16x16x32_bf16 a[252:255],a[132:135],v[36:39],a[252:255]
v_exp_f32 v111,v111
v_mfma_f32_16x16x32_bf16 a[204:207],a[132:135],v[32:35],a[204:207]
v_cvt_pk_bf16_f32 v53,v90,v91
v_cvt_pk_bf16_f32 v56,v96,v97
v_mfma_f32_16x16x32_bf16 a[200:203],a[128:131],v[32:35],a[200:203]
v_cvt_pk_bf16_f32 v57,v98,v99
v_cvt_pk_bf16_f32 v40,v104,v105
v_mfma_f32_16x16x32_bf16 v[152:155],a[128:131],v[28:31],v[152:155]
v_cvt_pk_bf16_f32 v41,v106,v107
v_cvt_pk_bf16_f32 v46,v76,v77
v_mfma_f32_16x16x32_bf16 v[156:159],a[132:135],v[28:31],v[156:159]
v_cvt_pk_bf16_f32 v47,v78,v79
v_cvt_pk_bf16_f32 v50,v84,v85
v_mfma_f32_16x16x32_bf16 v[252:255],a[132:135],v[24:27],v[252:255]
v_cvt_pk_bf16_f32 v51,v86,v87
v_cvt_pk_bf16_f32 v54,v92,v93
v_mfma_f32_16x16x32_bf16 v[248:251],a[128:131],v[24:27],v[248:251]
v_cvt_pk_bf16_f32 v55,v94,v95
v_cvt_pk_bf16_f32 v58,v100,v101
v_smfmac_f32_16x16x64_bf16 v[60:63],a[152:155],v[44:51],v18
v_cvt_pk_bf16_f32 v59,v102,v103
v_mfma_f32_16x16x32_bf16 v[200:203],a[128:131],v[20:23],v[200:203]
v_cvt_pk_bf16_f32 v42,v108,v109
v_cvt_pk_bf16_f32 v43,v110,v111
v_smfmac_f32_16x16x64_bf16 v[64:67],a[152:155],v[52:59],v18
v_subrev_u32 v10,18432,v10
v_smfmac_f32_16x16x64_bf16 v[68:71],a[152:155],v[36:43],v18
v_mfma_f32_16x16x32_bf16 v[204:207],a[132:135],v[20:23],v[204:207]
ds_read_b64_tr_b16 a[136:137],v2 offset:0
ds_read_b64_tr_b16 a[138:139],v2 offset:6144
ds_read_b64_tr_b16 a[140:141],v3 offset:0
ds_read_b64_tr_b16 a[142:143],v3 offset:6144
ds_read_b64_tr_b16 a[144:145],v4 offset:0
ds_read_b64_tr_b16 a[146:147],v4 offset:6144
ds_read_b64_tr_b16 a[148:149],v5 offset:0
ds_read_b64_tr_b16 a[150:151],v5 offset:6144
s_waitcnt lgkmcnt(6)
v_mfma_f32_16x16x32_bf16 v[160:163],a[136:139],v[44:47],v[160:163]
s_waitcnt vmcnt(6)
ds_read_b64_tr_b16 a[122:123],v2 offset:6272
v_mbcnt_lo_u32_b32 v35,-1,0
s_waitcnt lgkmcnt(5)
v_mfma_f32_16x16x32_bf16 v[164:167],a[140:143],v[44:47],v[164:167]
s_add_u32 s84,s42,0
ds_read_b64_tr_b16 a[120:121],v2 offset:128
v_mbcnt_hi_u32_b32 v35,-1,v35
v_mfma_f32_16x16x32_bf16 v[212:215],a[140:143],v[48:51],v[212:215]
s_add_u32 s85,s42,6144
ds_read_b64_tr_b16 a[126:127],v3 offset:6272
v_and_b32 v34,7,v35
v_mfma_f32_16x16x32_bf16 v[208:211],a[136:139],v[48:51],v[208:211]
s_add_u32 s86,s42,12288
ds_read_b64_tr_b16 a[124:125],v3 offset:128
v_lshrrev_b32 v19,5,v35
v_mfma_f32_16x16x32_bf16 v[112:115],a[136:139],v[52:55],v[112:115]
s_add_u32 s87,s42,18432
ds_read_b64_tr_b16 a[130:131],v4 offset:6272
v_xor_b32 v34,v34,v19
v_mfma_f32_16x16x32_bf16 v[116:119],a[140:143],v[52:55],v[116:119]
s_add_u32 s66,s42,24576
ds_read_b64_tr_b16 a[128:129],v4 offset:128
ds_read_b64_tr_b16 a[132:133],v5 offset:128
ds_read_b64_tr_b16 a[134:135],v5 offset:6272
v_mfma_f32_16x16x32_bf16 a[164:167],a[140:143],v[56:59],a[164:167]
v_and_b32 v19,15,v35
v_lshl_add_u32 v19,v19,7,s24
v_mfma_f32_16x16x32_bf16 a[160:163],a[136:139],v[56:59],a[160:163]
v_lshl_add_u32 v19,v34,4,v19
v_bfe_u32 v34,v35,4,1
v_mfma_f32_16x16x32_bf16 a[208:211],a[136:139],v[40:43],a[208:211]
ds_read_b64_tr_b16 a[136:137],v2 offset:256
v_lshl_add_u32 v32,v34,3,v19
v_mfma_f32_16x16x32_bf16 a[212:215],a[140:143],v[40:43],a[212:215]
s_waitcnt lgkmcnt(6)
ds_read_b64_tr_b16 a[138:139],v2 offset:6400
v_bfe_u32 v19,v35,3,1
v_mfma_f32_16x16x32_bf16 a[216:219],a[144:147],v[40:43],a[216:219]
ds_read_b64_tr_b16 a[140:141],v3 offset:256
v_lshlrev_b32 v19,11,v19
v_mfma_f32_16x16x32_bf16 a[220:223],a[148:151],v[40:43],a[220:223]
ds_read_b64_tr_b16 a[142:143],v3 offset:6400
v_add_u32 v36,v32,v19
v_mfma_f32_16x16x32_bf16 a[172:175],a[148:151],v[56:59],a[172:175]
v_xor_b32 v34,64,v32
v_xor_b32 v33,32,v32
v_mfma_f32_16x16x32_bf16 a[168:171],a[144:147],v[56:59],a[168:171]
v_add_u32 v37,v33,v19
v_add_u32 v38,v34,v19
v_mfma_f32_16x16x32_bf16 v[120:123],a[144:147],v[52:55],v[120:123]
v_xor_b32 v35,96,v32
v_add_u32 v39,v35,v19
v_mfma_f32_16x16x32_bf16 v[124:127],a[148:151],v[52:55],v[124:127]
v_add_f32 v62,v62,v63
v_rcp_f32 v62,v62
v_mfma_f32_16x16x32_bf16 v[220:223],a[148:151],v[48:51],v[220:223]
v_add_f32 v68,v68,v69
v_add_f32 v68,v68,v70
v_mfma_f32_16x16x32_bf16 v[216:219],a[144:147],v[48:51],v[216:219]
v_add_f32 v68,v68,v71
v_rcp_f32 v68,v68
v_mfma_f32_16x16x32_bf16 v[168:171],a[144:147],v[44:47],v[168:171]
ds_read_b64_tr_b16 a[146:147],v4 offset:6400
v_add_f32 v66,v66,v67
v_mfma_f32_16x16x32_bf16 v[172:175],a[148:151],v[44:47],v[172:175]
ds_read_b64_tr_b16 a[144:145],v4 offset:256
v_rcp_f32 v66,v66
v_mfma_f32_16x16x32_bf16 v[176:179],a[120:123],v[44:47],v[176:179]
s_waitcnt lgkmcnt(2)
ds_read_b64_tr_b16 a[150:151],v5 offset:6400
v_accvgpr_read_b32 v100,a212
v_mfma_f32_16x16x32_bf16 v[180:183],a[124:127],v[44:47],v[180:183]
ds_read_b64_tr_b16 a[148:149],v5 offset:256
v_accvgpr_read_b32 v101,a213
v_mfma_f32_16x16x32_bf16 v[228:231],a[124:127],v[48:51],v[228:231]
v_accvgpr_read_b32 v110,a218
v_accvgpr_read_b32 v102,a214
v_mfma_f32_16x16x32_bf16 v[224:227],a[120:123],v[48:51],v[224:227]
v_accvgpr_read_b32 v98,a166
v_accvgpr_read_b32 v111,a219
v_mfma_f32_16x16x32_bf16 v[128:131],a[120:123],v[52:55],v[128:131]
v_accvgpr_read_b32 v94,a210
v_accvgpr_read_b32 v95,a211
v_mfma_f32_16x16x32_bf16 v[132:135],a[124:127],v[52:55],v[132:135]
v_accvgpr_read_b32 v89,a161
v_accvgpr_read_b32 v109,a217
v_mfma_f32_16x16x32_bf16 a[180:183],a[124:127],v[56:59],a[180:183]
v_accvgpr_read_b32 v97,a165
v_accvgpr_read_b32 v96,a164
v_accvgpr_read_b32 v88,a160
v_accvgpr_read_b32 v90,a162
v_accvgpr_read_b32 v104,a168
v_pk_mul_f32 v[228:229],v[228:229],v[62:63] op_sel_hi:[1,0]
v_pk_mul_f32 v[224:225],v[224:225],v[62:63] op_sel_hi:[1,0]
v_pk_mul_f32 v[230:231],v[230:231],v[62:63] op_sel_hi:[1,0]
v_pk_mul_f32 v[214:215],v[214:215],v[62:63] op_sel_hi:[1,0]
v_pk_mul_f32 v[210:211],v[210:211],v[62:63] op_sel_hi:[1,0]
v_pk_mul_f32 v[226:227],v[226:227],v[62:63] op_sel_hi:[1,0]
v_pk_mul_f32 v[208:209],v[208:209],v[62:63] op_sel_hi:[1,0]
v_pk_mul_f32 v[212:213],v[212:213],v[62:63] op_sel_hi:[1,0]
v_cvt_pk_bf16_f32 v208,v208,v209
v_cvt_pk_bf16_f32 v224,v224,v225
v_mfma_f32_16x16x32_bf16 a[176:179],a[120:123],v[56:59],a[176:179]
v_cvt_pk_bf16_f32 v225,v226,v227
v_cvt_pk_bf16_f32 v209,v210,v211
v_mfma_f32_16x16x32_bf16 a[224:227],a[120:123],v[40:43],a[224:227]
ds_write2st64_b64 v36,v[208:209],v[224:225] offset0:12 offset1:14
v_mfma_f32_16x16x32_bf16 a[228:231],a[124:127],v[40:43],a[228:231]
v_accvgpr_read_b32 v225,a221
v_accvgpr_read_b32 v208,a172
v_mfma_f32_16x16x32_bf16 a[232:235],a[128:131],v[40:43],a[232:235]
v_accvgpr_read_b32 v209,a173
v_accvgpr_read_b32 v107,a171
v_mfma_f32_16x16x32_bf16 a[236:239],a[132:135],v[40:43],a[236:239]
v_accvgpr_read_b32 v93,a209
v_accvgpr_read_b32 v226,a222
v_mfma_f32_16x16x32_bf16 a[188:191],a[132:135],v[56:59],a[188:191]
v_accvgpr_read_b32 v224,a220
v_accvgpr_read_b32 v210,a174
v_mfma_f32_16x16x32_bf16 a[184:187],a[128:131],v[56:59],a[184:187]
v_accvgpr_read_b32 v105,a169
v_accvgpr_read_b32 v227,a223
v_mfma_f32_16x16x32_bf16 v[136:139],a[128:131],v[52:55],v[136:139]
v_accvgpr_read_b32 v108,a216
v_accvgpr_read_b32 v91,a163
v_mfma_f32_16x16x32_bf16 v[140:143],a[132:135],v[52:55],v[140:143]
v_accvgpr_read_b32 v99,a167
v_accvgpr_read_b32 v106,a170
v_mfma_f32_16x16x32_bf16 v[236:239],a[132:135],v[48:51],v[236:239]
v_accvgpr_read_b32 v211,a175
v_accvgpr_read_b32 v92,a208
v_mfma_f32_16x16x32_bf16 v[232:235],a[128:131],v[48:51],v[232:235]
v_accvgpr_read_b32 v103,a215
v_add_f32 v64,v64,v65
v_mfma_f32_16x16x32_bf16 v[184:187],a[128:131],v[44:47],v[184:187]
v_rcp_f32 v64,v64
v_mfma_f32_16x16x32_bf16 v[188:191],a[132:135],v[44:47],v[188:191]
v_cvt_pk_bf16_f32 v212,v212,v213
v_cvt_pk_bf16_f32 v228,v228,v229
v_mfma_f32_16x16x32_bf16 v[192:195],a[136:139],v[44:47],v[192:195]
v_cvt_pk_bf16_f32 v229,v230,v231
v_cvt_pk_bf16_f32 v213,v214,v215
ds_write2st64_b64 v37,v[212:213],v[228:229] offset0:12 offset1:14
v_pk_mul_f32 v[238:239],v[238:239],v[62:63] op_sel_hi:[1,0]
v_pk_mul_f32 v[236:237],v[236:237],v[62:63] op_sel_hi:[1,0]
v_pk_mul_f32 v[108:109],v[108:109],v[68:69] op_sel_hi:[1,0]
v_pk_mul_f32 v[88:89],v[88:89],v[66:67] op_sel_hi:[1,0]
v_pk_mul_f32 v[232:233],v[232:233],v[62:63] op_sel_hi:[1,0]
v_pk_mul_f32 v[234:235],v[234:235],v[62:63] op_sel_hi:[1,0]
v_pk_mul_f32 v[218:219],v[218:219],v[62:63] op_sel_hi:[1,0]
v_pk_mul_f32 v[106:107],v[106:107],v[66:67] op_sel_hi:[1,0]
v_pk_mul_f32 v[216:217],v[216:217],v[62:63] op_sel_hi:[1,0]
v_pk_mul_f32 v[110:111],v[110:111],v[68:69] op_sel_hi:[1,0]
v_pk_mul_f32 v[94:95],v[94:95],v[68:69] op_sel_hi:[1,0]
v_pk_mul_f32 v[90:91],v[90:91],v[66:67] op_sel_hi:[1,0]
v_pk_mul_f32 v[226:227],v[226:227],v[68:69] op_sel_hi:[1,0]
v_pk_mul_f32 v[104:105],v[104:105],v[66:67] op_sel_hi:[1,0]
v_pk_mul_f32 v[222:223],v[222:223],v[62:63] op_sel_hi:[1,0]
v_pk_mul_f32 v[96:97],v[96:97],v[66:67] op_sel_hi:[1,0]
v_pk_mul_f32 v[208:209],v[208:209],v[66:67] op_sel_hi:[1,0]
v_pk_mul_f32 v[220:221],v[220:221],v[62:63] op_sel_hi:[1,0]
v_pk_mul_f32 v[210:211],v[210:211],v[66:67] op_sel_hi:[1,0]
v_pk_mul_f32 v[98:99],v[98:99],v[66:67] op_sel_hi:[1,0]
v_pk_mul_f32 v[224:225],v[224:225],v[68:69] op_sel_hi:[1,0]
v_pk_mul_f32 v[92:93],v[92:93],v[68:69] op_sel_hi:[1,0]
v_pk_mul_f32 v[102:103],v[102:103],v[68:69] op_sel_hi:[1,0]
v_pk_mul_f32 v[100:101],v[100:101],v[68:69] op_sel_hi:[1,0]
v_cvt_pk_bf16_f32 v236,v236,v237
v_cvt_pk_bf16_f32 v232,v232,v233
v_mfma_f32_16x16x32_bf16 v[196:199],a[140:143],v[44:47],v[196:199]
v_cvt_pk_bf16_f32 v220,v220,v221
v_cvt_pk_bf16_f32 v237,v238,v239
v_mfma_f32_16x16x32_bf16 v[244:247],a[140:143],v[48:51],v[244:247]
v_cvt_pk_bf16_f32 v233,v234,v235
v_cvt_pk_bf16_f32 v216,v216,v217
v_mfma_f32_16x16x32_bf16 v[240:243],a[136:139],v[48:51],v[240:243]
v_cvt_pk_bf16_f32 v217,v218,v219
v_cvt_pk_bf16_f32 v221,v222,v223
v_mfma_f32_16x16x32_bf16 v[144:147],a[136:139],v[52:55],v[144:147]
ds_write2st64_b64 v38,v[216:217],v[232:233] offset0:12 offset1:14
v_mfma_f32_16x16x32_bf16 v[148:151],a[140:143],v[52:55],v[148:151]
v_cvt_pk_bf16_f32 v92,v92,v93
v_cvt_pk_bf16_f32 v96,v96,v97
v_mfma_f32_16x16x32_bf16 a[196:199],a[140:143],v[56:59],a[196:199]
v_cvt_pk_bf16_f32 v104,v104,v105
v_cvt_pk_bf16_f32 v97,v98,v99
v_cvt_pk_bf16_f32 v88,v88,v89
v_cvt_pk_bf16_f32 v89,v90,v91
v_cvt_pk_bf16_f32 v108,v108,v109
ds_write2st64_b64 v39,v[220:221],v[236:237] offset0:12 offset1:14
v_pk_mul_f32 v[244:245],v[244:245],v[62:63] op_sel_hi:[1,0]
v_pk_mul_f32 v[118:119],v[118:119],v[64:65] op_sel_hi:[1,0]
v_pk_mul_f32 v[112:113],v[112:113],v[64:65] op_sel_hi:[1,0]
ds_read_b128 v[72:75],v10 offset:6144
v_pk_mul_f32 v[114:115],v[114:115],v[64:65] op_sel_hi:[1,0]
ds_read_b128 v[76:79],v10 offset:9216
v_pk_mul_f32 v[240:241],v[240:241],v[62:63] op_sel_hi:[1,0]
ds_read_b128 v[80:83],v10 offset:7168
v_pk_mul_f32 v[116:117],v[116:117],v[64:65] op_sel_hi:[1,0]
ds_read_b128 v[84:87],v10 offset:10240
v_pk_mul_f32 v[246:247],v[246:247],v[62:63] op_sel_hi:[1,0]
v_pk_mul_f32 v[242:243],v[242:243],v[62:63] op_sel_hi:[1,0]
v_cvt_pk_bf16_f32 v208,v208,v209
v_cvt_pk_bf16_f32 v93,v94,v95
v_mfma_f32_16x16x32_bf16 a[192:195],a[136:139],v[56:59],a[192:195]
ds_write2st64_b64 v32,v[88:89],v[92:93] offset0:36 offset1:40
v_mfma_f32_16x16x32_bf16 a[240:243],a[136:139],v[40:43],a[240:243]
v_cvt_pk_bf16_f32 v224,v224,v225
v_cvt_pk_bf16_f32 v109,v110,v111
v_mfma_f32_16x16x32_bf16 a[244:247],a[140:143],v[40:43],a[244:247]
s_waitcnt lgkmcnt(4)
buffer_store_dwordx4 v[72:75],v9,s[16:19],s85 offen offset:0 nt
v_cvt_pk_bf16_f32 v100,v100,v101
v_cvt_pk_bf16_f32 v225,v226,v227
v_cvt_pk_bf16_f32 v101,v102,v103
v_mfma_f32_16x16x32_bf16 a[248:251],a[144:147],v[40:43],a[248:251]
v_cvt_pk_bf16_f32 v105,v106,v107
v_cvt_pk_bf16_f32 v209,v210,v211
v_mfma_f32_16x16x32_bf16 a[252:255],a[148:151],v[40:43],a[252:255]
v_cvt_pk_bf16_f32 v112,v112,v113
v_cvt_pk_bf16_f32 v113,v114,v115
v_mfma_f32_16x16x32_bf16 a[204:207],a[148:151],v[56:59],a[204:207]
ds_write2st64_b64 v33,v[96:97],v[100:101] offset0:36 offset1:40
v_mfma_f32_16x16x32_bf16 a[200:203],a[144:147],v[56:59],a[200:203]
v_cvt_pk_bf16_f32 v116,v116,v117
v_cvt_pk_bf16_f32 v244,v244,v245
v_mfma_f32_16x16x32_bf16 v[152:155],a[144:147],v[52:55],v[152:155]
s_waitcnt lgkmcnt(1)
buffer_store_dwordx4 v[76:79],v9,s[16:19],s85 offen offset:3072 nt
v_cvt_pk_bf16_f32 v245,v246,v247
v_cvt_pk_bf16_f32 v240,v240,v241
v_cvt_pk_bf16_f32 v241,v242,v243
v_mfma_f32_16x16x32_bf16 v[156:159],a[148:151],v[52:55],v[156:159]
v_cvt_pk_bf16_f32 v117,v118,v119
v_accvgpr_read_b32 v77,a225
v_mfma_f32_16x16x32_bf16 v[252:255],a[148:151],v[48:51],v[252:255]
v_accvgpr_read_b32 v72,a176
v_accvgpr_read_b32 v97,a185
v_mfma_f32_16x16x32_bf16 v[248:251],a[144:147],v[48:51],v[248:251]
ds_write2st64_b64 v34,v[104:105],v[108:109] offset0:36 offset1:40
v_mfma_f32_16x16x32_bf16 v[200:203],a[144:147],v[44:47],v[200:203]
v_accvgpr_read_b32 v78,a226
v_accvgpr_read_b32 v79,a227
v_mfma_f32_16x16x32_bf16 v[204:207],a[148:151],v[44:47],v[204:207]
buffer_store_dwordx4 v[80:83],v9,s[16:19],s85 offen offset:128 nt
v_accvgpr_read_b32 v96,a184
v_accvgpr_read_b32 v101,a233
v_accvgpr_read_b32 v81,a181
v_pk_mul_f32 v[122:123],v[122:123],v[64:65] op_sel_hi:[1,0]
v_pk_mul_f32 v[250:251],v[250:251],v[62:63] op_sel_hi:[1,0]
v_pk_mul_f32 v[120:121],v[120:121],v[64:65] op_sel_hi:[1,0]
v_pk_mul_f32 v[252:253],v[252:253],v[62:63] op_sel_hi:[1,0]
v_pk_mul_f32 v[124:125],v[124:125],v[64:65] op_sel_hi:[1,0]
v_pk_mul_f32 v[248:249],v[248:249],v[62:63] op_sel_hi:[1,0]
ds_write2st64_b64 v35,v[208:209],v[224:225] offset0:36 offset1:40
v_pk_mul_f32 v[254:255],v[254:255],v[62:63] op_sel_hi:[1,0]
v_pk_mul_f32 v[126:127],v[126:127],v[64:65] op_sel_hi:[1,0]
v_pk_mul_f32 v[78:79],v[78:79],v[68:69] op_sel_hi:[1,0]
ds_read_b128 v[212:215],v10 offset:18432
buffer_store_dwordx4 v[84:87],v9,s[16:19],s85 offen offset:3200 nt
ds_read_b128 v[228:231],v10 offset:19456
v_pk_mul_f32 v[96:97],v[96:97],v[66:67] op_sel_hi:[1,0]
ds_read_b128 v[216:219],v10 offset:20480
v_pk_mul_f32 v[144:145],v[144:145],v[64:65] op_sel_hi:[1,0]
ds_read_b128 v[232:235],v10 offset:21504
v_pk_mul_f32 v[132:133],v[132:133],v[64:65] op_sel_hi:[1,0]
ds_write2st64_b64 v36,v[240:241],v[112:113] offset0:16 offset1:24
v_pk_mul_f32 v[146:147],v[146:147],v[64:65] op_sel_hi:[1,0]
v_pk_mul_f32 v[152:153],v[152:153],v[64:65] op_sel_hi:[1,0]
v_pk_mul_f32 v[128:129],v[128:129],v[64:65] op_sel_hi:[1,0]
v_pk_mul_f32 v[140:141],v[140:141],v[64:65] op_sel_hi:[1,0]
v_pk_mul_f32 v[138:139],v[138:139],v[64:65] op_sel_hi:[1,0]
v_pk_mul_f32 v[148:149],v[148:149],v[64:65] op_sel_hi:[1,0]
v_pk_mul_f32 v[130:131],v[130:131],v[64:65] op_sel_hi:[1,0]
s_waitcnt lgkmcnt(4)
buffer_store_dwordx4 v[212:215],v9,s[16:19],s87 offen offset:0 nt
v_pk_mul_f32 v[136:137],v[136:137],v[64:65] op_sel_hi:[1,0]
v_pk_mul_f32 v[150:151],v[150:151],v[64:65] op_sel_hi:[1,0]
v_pk_mul_f32 v[142:143],v[142:143],v[64:65] op_sel_hi:[1,0]
v_pk_mul_f32 v[134:135],v[134:135],v[64:65] op_sel_hi:[1,0]
v_pk_mul_f32 v[154:155],v[154:155],v[64:65] op_sel_hi:[1,0]
v_pk_mul_f32 v[156:157],v[156:157],v[64:65] op_sel_hi:[1,0]
v_pk_mul_f32 v[158:159],v[158:159],v[64:65] op_sel_hi:[1,0]
v_cvt_pk_bf16_f32 v120,v120,v121
v_cvt_pk_bf16_f32 v248,v248,v249
ds_write2st64_b64 v37,v[244:245],v[116:117] offset0:16 offset1:24
v_cvt_pk_bf16_f32 v121,v122,v123
v_cvt_pk_bf16_f32 v249,v250,v251
v_cvt_pk_bf16_f32 v252,v252,v253
s_waitcnt lgkmcnt(1)
buffer_store_dwordx4 v[228:231],v9,s[16:19],s87 offen offset:3072 nt
v_cvt_pk_bf16_f32 v124,v124,v125
v_cvt_pk_bf16_f32 v253,v254,v255
v_cvt_pk_bf16_f32 v125,v126,v127
v_accvgpr_read_b32 v84,a228
v_accvgpr_read_b32 v85,a229
v_pk_mul_f32 v[84:85],v[84:85],v[68:69] op_sel_hi:[1,0]
v_accvgpr_read_b32 v98,a186
v_accvgpr_read_b32 v76,a224
v_pk_mul_f32 v[76:77],v[76:77],v[68:69] op_sel_hi:[1,0]
ds_write2st64_b64 v38,v[248:249],v[120:121] offset0:16 offset1:24
v_cvt_pk_bf16_f32 v76,v76,v77
v_accvgpr_read_b32 v80,a180
v_pk_mul_f32 v[80:81],v[80:81],v[66:67] op_sel_hi:[1,0]
buffer_store_dwordx4 v[216:219],v9,s[16:19],s66 offen offset:0 nt
v_accvgpr_read_b32 v73,a177
v_pk_mul_f32 v[72:73],v[72:73],v[66:67] op_sel_hi:[1,0]
v_accvgpr_read_b32 v99,a187
v_pk_mul_f32 v[98:99],v[98:99],v[66:67] op_sel_hi:[1,0]
v_cvt_pk_bf16_f32 v72,v72,v73
v_accvgpr_read_b32 v109,a237
v_accvgpr_read_b32 v102,a234
v_accvgpr_read_b32 v103,a235
v_pk_mul_f32 v[102:103],v[102:103],v[68:69] op_sel_hi:[1,0]
ds_write2st64_b64 v39,v[252:253],v[124:125] offset0:16 offset1:24
v_accvgpr_read_b32 v100,a232
v_pk_mul_f32 v[100:101],v[100:101],v[68:69] op_sel_hi:[1,0]
v_accvgpr_read_b32 v75,a179
ds_read_b128 v[220:223],v10 offset:8192
buffer_store_dwordx4 v[232:235],v9,s[16:19],s66 offen offset:3072 nt
ds_read_b128 v[236:239],v10 offset:11264
v_cvt_pk_bf16_f32 v100,v100,v101
ds_read_b128 v[88:91],v10 offset:12288
v_accvgpr_read_b32 v106,a190
ds_read_b128 v[92:95],v10 offset:15360
v_accvgpr_read_b32 v104,a188
v_accvgpr_read_b32 v107,a191
v_pk_mul_f32 v[106:107],v[106:107],v[66:67] op_sel_hi:[1,0]
v_accvgpr_read_b32 v82,a182
v_accvgpr_read_b32 v74,a178
v_pk_mul_f32 v[74:75],v[74:75],v[66:67] op_sel_hi:[1,0]
v_accvgpr_read_b32 v87,a231
v_cvt_pk_bf16_f32 v73,v74,v75
v_cvt_pk_bf16_f32 v77,v78,v79
ds_write2st64_b64 v32,v[72:73],v[76:77] offset0:36 offset1:40
v_cvt_pk_bf16_f32 v84,v84,v85
v_accvgpr_read_b32 v105,a189
v_pk_mul_f32 v[104:105],v[104:105],v[66:67] op_sel_hi:[1,0]
s_waitcnt lgkmcnt(3)
buffer_store_dwordx4 v[220:223],v9,s[16:19],s85 offen offset:256 nt
v_accvgpr_read_b32 v108,a236
v_pk_mul_f32 v[108:109],v[108:109],v[68:69] op_sel_hi:[1,0]
v_cvt_pk_bf16_f32 v80,v80,v81
v_accvgpr_read_b32 v83,a183
v_pk_mul_f32 v[82:83],v[82:83],v[66:67] op_sel_hi:[1,0]
v_accvgpr_read_b32 v86,a230
v_pk_mul_f32 v[86:87],v[86:87],v[68:69] op_sel_hi:[1,0]
v_cvt_pk_bf16_f32 v81,v82,v83
v_accvgpr_read_b32 v111,a239
v_cvt_pk_bf16_f32 v108,v108,v109
v_cvt_pk_bf16_f32 v85,v86,v87
ds_write2st64_b64 v33,v[80:81],v[84:85] offset0:36 offset1:40
v_accvgpr_read_b32 v110,a238
v_pk_mul_f32 v[110:111],v[110:111],v[68:69] op_sel_hi:[1,0]
v_cvt_pk_bf16_f32 v96,v96,v97
buffer_store_dwordx4 v[236:239],v9,s[16:19],s85 offen offset:3328 nt
v_cvt_pk_bf16_f32 v97,v98,v99
v_cvt_pk_bf16_f32 v109,v110,v111
v_cvt_pk_bf16_f32 v104,v104,v105
v_cvt_pk_bf16_f32 v105,v106,v107
v_cvt_pk_bf16_f32 v101,v102,v103
v_cvt_pk_bf16_f32 v128,v128,v129
v_cvt_pk_bf16_f32 v129,v130,v131
v_cvt_pk_bf16_f32 v144,v144,v145
v_cvt_pk_bf16_f32 v148,v148,v149
ds_write2st64_b64 v34,v[96:97],v[100:101] offset0:36 offset1:40
v_cvt_pk_bf16_f32 v132,v132,v133
v_cvt_pk_bf16_f32 v133,v134,v135
v_cvt_pk_bf16_f32 v156,v156,v157
s_waitcnt lgkmcnt(1)
buffer_store_dwordx4 v[88:91],v9,s[16:19],s86 offen offset:0 nt
v_cvt_pk_bf16_f32 v145,v146,v147
v_cvt_pk_bf16_f32 v152,v152,v153
v_cvt_pk_bf16_f32 v149,v150,v151
v_cvt_pk_bf16_f32 v136,v136,v137
v_cvt_pk_bf16_f32 v137,v138,v139
v_cvt_pk_bf16_f32 v140,v140,v141
v_cvt_pk_bf16_f32 v141,v142,v143
v_cvt_pk_bf16_f32 v157,v158,v159
v_cvt_pk_bf16_f32 v153,v154,v155
ds_write2st64_b64 v35,v[104:105],v[108:109] offset0:36 offset1:40
v_accvgpr_read_b32 v245,a193
v_accvgpr_read_b32 v116,a240
v_accvgpr_read_b32 v118,a242
ds_read_b128 v[208:211],v10 offset:18432
buffer_store_dwordx4 v[92:95],v9,s[16:19],s86 offen offset:3072 nt
ds_read_b128 v[224:227],v10 offset:19456
v_accvgpr_read_b32 v244,a192
ds_read_b128 v[240:243],v10 offset:20480
v_pk_mul_f32 v[244:245],v[244:245],v[66:67] op_sel_hi:[1,0]
ds_read_b128 v[112:115],v10 offset:21504
v_accvgpr_read_b32 v121,a245
ds_write2st64_b64 v36,v[128:129],v[144:145] offset0:26 offset1:28
v_accvgpr_read_b32 v247,a195
v_accvgpr_read_b32 v252,a200
v_accvgpr_read_b32 v251,a199
v_accvgpr_read_b32 v117,a241
v_pk_mul_f32 v[116:117],v[116:117],v[68:69] op_sel_hi:[1,0]
v_accvgpr_read_b32 v119,a243
v_pk_mul_f32 v[118:119],v[118:119],v[68:69] op_sel_hi:[1,0]
s_waitcnt lgkmcnt(4)
buffer_store_dwordx4 v[208:211],v9,s[16:19],s87 offen offset:128 nt
v_cvt_pk_bf16_f32 v116,v116,v117
v_accvgpr_read_b32 v124,a248
v_accvgpr_read_b32 v254,a202
v_accvgpr_read_b32 v253,a201
v_pk_mul_f32 v[252:253],v[252:253],v[66:67] op_sel_hi:[1,0]
v_accvgpr_read_b32 v123,a247
v_accvgpr_read_b32 v72,a204
v_accvgpr_read_b32 v120,a244
v_pk_mul_f32 v[120:121],v[120:121],v[68:69] op_sel_hi:[1,0]
ds_write2st64_b64 v37,v[132:133],v[148:149] offset0:26 offset1:28
v_accvgpr_read_b32 v77,a253
v_accvgpr_read_b32 v248,a196
v_accvgpr_read_b32 v249,a197
s_waitcnt lgkmcnt(1)
buffer_store_dwordx4 v[224:227],v9,s[16:19],s87 offen offset:3200 nt
v_pk_mul_f32 v[248:249],v[248:249],v[66:67] op_sel_hi:[1,0]
v_accvgpr_read_b32 v250,a198
v_pk_mul_f32 v[250:251],v[250:251],v[66:67] op_sel_hi:[1,0]
v_cvt_pk_bf16_f32 v248,v248,v249
v_accvgpr_read_b32 v246,a194
v_pk_mul_f32 v[246:247],v[246:247],v[66:67] op_sel_hi:[1,0]
v_accvgpr_read_b32 v76,a252
v_pk_mul_f32 v[76:77],v[76:77],v[68:69] op_sel_hi:[1,0]
v_cvt_pk_bf16_f32 v249,v250,v251
ds_write2st64_b64 v38,v[136:137],v[152:153] offset0:26 offset1:28
v_cvt_pk_bf16_f32 v117,v118,v119
v_cvt_pk_bf16_f32 v76,v76,v77
v_cvt_pk_bf16_f32 v120,v120,v121
buffer_store_dwordx4 v[240:243],v9,s[16:19],s66 offen offset:128 nt
v_accvgpr_read_b32 v122,a246
v_pk_mul_f32 v[122:123],v[122:123],v[68:69] op_sel_hi:[1,0]
v_cvt_pk_bf16_f32 v244,v244,v245
v_cvt_pk_bf16_f32 v245,v246,v247
v_cvt_pk_bf16_f32 v121,v122,v123
v_cvt_pk_bf16_f32 v252,v252,v253
v_accvgpr_read_b32 v125,a249
v_pk_mul_f32 v[124:125],v[124:125],v[68:69] op_sel_hi:[1,0]
v_accvgpr_read_b32 v126,a250
ds_write2st64_b64 v39,v[140:141],v[156:157] offset0:26 offset1:28
v_cvt_pk_bf16_f32 v124,v124,v125
v_accvgpr_read_b32 v255,a203
v_pk_mul_f32 v[254:255],v[254:255],v[66:67] op_sel_hi:[1,0]
ds_read_b128 v[212:215],v10 offset:13312
buffer_store_dwordx4 v[112:115],v9,s[16:19],s66 offen offset:3200 nt
ds_read_b128 v[228:231],v10 offset:16384
v_accvgpr_read_b32 v75,a207
ds_read_b128 v[216:219],v10 offset:14336
v_accvgpr_read_b32 v127,a251
ds_read_b128 v[232:235],v10 offset:17408
v_pk_mul_f32 v[126:127],v[126:127],v[68:69] op_sel_hi:[1,0]
ds_write2st64_b64 v32,v[244:245],v[116:117] offset0:36 offset1:40
v_accvgpr_read_b32 v73,a205
v_pk_mul_f32 v[72:73],v[72:73],v[66:67] op_sel_hi:[1,0]
v_cvt_pk_bf16_f32 v253,v254,v255
v_cvt_pk_bf16_f32 v72,v72,v73
v_accvgpr_read_b32 v79,a255
v_cvt_pk_bf16_f32 v125,v126,v127
v_accvgpr_read_b32 v74,a206
s_waitcnt lgkmcnt(4)
buffer_store_dwordx4 v[212:215],v9,s[16:19],s86 offen offset:128 nt
v_pk_mul_f32 v[74:75],v[74:75],v[66:67] op_sel_hi:[1,0]
v_accvgpr_read_b32 v78,a254
v_pk_mul_f32 v[78:79],v[78:79],v[68:69] op_sel_hi:[1,0]
v_cvt_pk_bf16_f32 v73,v74,v75
v_cvt_pk_bf16_f32 v77,v78,v79
v_add_f32 v60,v60,v61
v_rcp_f32 v60,v60
ds_write2st64_b64 v33,v[248:249],v[120:121] offset0:36 offset1:40
v_pk_mul_f32 v[180:181],v[180:181],v[60:61] op_sel_hi:[1,0]
v_pk_mul_f32 v[178:179],v[178:179],v[60:61] op_sel_hi:[1,0]
v_pk_mul_f32 v[182:183],v[182:183],v[60:61] op_sel_hi:[1,0]
s_waitcnt lgkmcnt(1)
buffer_store_dwordx4 v[228:231],v9,s[16:19],s86 offen offset:3200 nt
v_pk_mul_f32 v[164:165],v[164:165],v[60:61] op_sel_hi:[1,0]
v_pk_mul_f32 v[162:163],v[162:163],v[60:61] op_sel_hi:[1,0]
v_pk_mul_f32 v[176:177],v[176:177],v[60:61] op_sel_hi:[1,0]
v_pk_mul_f32 v[160:161],v[160:161],v[60:61] op_sel_hi:[1,0]
v_pk_mul_f32 v[170:171],v[170:171],v[60:61] op_sel_hi:[1,0]
v_pk_mul_f32 v[184:185],v[184:185],v[60:61] op_sel_hi:[1,0]
v_pk_mul_f32 v[172:173],v[172:173],v[60:61] op_sel_hi:[1,0]
v_pk_mul_f32 v[174:175],v[174:175],v[60:61] op_sel_hi:[1,0]
v_pk_mul_f32 v[166:167],v[166:167],v[60:61] op_sel_hi:[1,0]
ds_write2st64_b64 v34,v[252:253],v[124:125] offset0:36 offset1:40
v_pk_mul_f32 v[168:169],v[168:169],v[60:61] op_sel_hi:[1,0]
v_pk_mul_f32 v[188:189],v[188:189],v[60:61] op_sel_hi:[1,0]
v_pk_mul_f32 v[186:187],v[186:187],v[60:61] op_sel_hi:[1,0]
buffer_store_dwordx4 v[216:219],v9,s[16:19],s86 offen offset:256 nt
v_pk_mul_f32 v[190:191],v[190:191],v[60:61] op_sel_hi:[1,0]
v_pk_mul_f32 v[192:193],v[192:193],v[60:61] op_sel_hi:[1,0]
v_pk_mul_f32 v[198:199],v[198:199],v[60:61] op_sel_hi:[1,0]
v_pk_mul_f32 v[194:195],v[194:195],v[60:61] op_sel_hi:[1,0]
v_pk_mul_f32 v[196:197],v[196:197],v[60:61] op_sel_hi:[1,0]
v_pk_mul_f32 v[202:203],v[202:203],v[60:61] op_sel_hi:[1,0]
v_pk_mul_f32 v[200:201],v[200:201],v[60:61] op_sel_hi:[1,0]
v_pk_mul_f32 v[204:205],v[204:205],v[60:61] op_sel_hi:[1,0]
v_pk_mul_f32 v[206:207],v[206:207],v[60:61] op_sel_hi:[1,0]
ds_write2st64_b64 v35,v[72:73],v[76:77] offset0:36 offset1:40
v_cvt_pk_bf16_f32 v176,v176,v177
v_cvt_pk_bf16_f32 v180,v180,v181
v_cvt_pk_bf16_f32 v160,v160,v161
ds_read_b128 v[80:83],v10 offset:18432
buffer_store_dwordx4 v[232:235],v9,s[16:19],s86 offen offset:3328 nt
ds_read_b128 v[84:87],v10 offset:19456
v_cvt_pk_bf16_f32 v161,v162,v163
ds_read_b128 v[88:91],v10 offset:20480
v_cvt_pk_bf16_f32 v188,v188,v189
ds_read_b128 v[92:95],v10 offset:21504
v_cvt_pk_bf16_f32 v168,v168,v169
v_cvt_pk_bf16_f32 v177,v178,v179
ds_write2st64_b64 v36,v[160:161],v[176:177] offset0:0 offset1:2
v_cvt_pk_bf16_f32 v164,v164,v165
v_cvt_pk_bf16_f32 v165,v166,v167
v_cvt_pk_bf16_f32 v189,v190,v191
v_cvt_pk_bf16_f32 v169,v170,v171
v_cvt_pk_bf16_f32 v181,v182,v183
v_cvt_pk_bf16_f32 v184,v184,v185
s_waitcnt lgkmcnt(4)
buffer_store_dwordx4 v[80:83],v9,s[16:19],s87 offen offset:256 nt
v_cvt_pk_bf16_f32 v185,v186,v187
v_cvt_pk_bf16_f32 v172,v172,v173
v_cvt_pk_bf16_f32 v173,v174,v175
v_cvt_pk_bf16_f32 v200,v200,v201
v_cvt_pk_bf16_f32 v196,v196,v197
v_cvt_pk_bf16_f32 v192,v192,v193
v_cvt_pk_bf16_f32 v193,v194,v195
v_cvt_pk_bf16_f32 v197,v198,v199
v_cvt_pk_bf16_f32 v201,v202,v203
ds_write2st64_b64 v37,v[164:165],v[180:181] offset0:0 offset1:2
v_cvt_pk_bf16_f32 v204,v204,v205
v_cvt_pk_bf16_f32 v205,v206,v207
v_min3_f32 v61,v60,v62,v64
s_waitcnt lgkmcnt(1)
buffer_store_dwordx4 v[84:87],v9,s[16:19],s87 offen offset:3328 nt
v_min3_f32 v61,v61,v66,v68
v_cmp_nlt_f32 vcc,s37,v61
ds_write2st64_b64 v38,v[168:169],v[184:185] offset0:0 offset1:2
buffer_store_dwordx4 v[88:91],v9,s[16:19],s66 offen offset:256 nt
ds_write2st64_b64 v39,v[172:173],v[188:189] offset0:0 offset1:2
ds_read_b128 v[220:223],v10 offset:0
buffer_store_dwordx4 v[92:95],v9,s[16:19],s66 offen offset:3328 nt
ds_read_b128 v[236:239],v10 offset:3072
s_cmp_lg_u64 vcc,0
ds_read_b128 v[96:99],v10 offset:1024
s_cselect_b32 s62,s32,0
ds_read_b128 v[100:103],v10 offset:4096
s_or_b32 s31,s31,s62
ds_write_b64 v36,v[192:193] offset:2048
s_lshl_b32 s32,s32,1
ds_write_b64 v37,v[196:197] offset:2048
s_waitcnt lgkmcnt(5)
buffer_store_dwordx4 v[220:223],v9,s[16:19],s84 offen offset:0 nt
ds_write_b64 v38,v[200:201] offset:2048
s_waitcnt lgkmcnt(2)
buffer_store_dwordx4 v[236:239],v9,s[16:19],s84 offen offset:3072 nt
ds_write_b64 v39,v[204:205] offset:2048
ds_read_b128 v[104:107],v10 offset:2048
buffer_store_dwordx4 v[96:99],v9,s[16:19],s84 offen offset:128 nt
ds_read_b128 v[108:111],v10 offset:5120
buffer_store_dwordx4 v[100:103],v9,s[16:19],s84 offen offset:3200 nt
s_waitcnt lgkmcnt(1)
buffer_store_dwordx4 v[104:107],v9,s[16:19],s84 offen offset:256 nt
s_waitcnt lgkmcnt(0)
buffer_store_dwordx4 v[108:111],v9,s[16:19],s84 offen offset:3328 nt
s_branch L_fin
L_end4:
s_waitcnt lgkmcnt(3)
v_mfma_f32_16x16x32_bf16 v[160:163],a[120:123],v[20:23],v[160:163]
ds_read_b64_tr_b16 a[136:137],v2 offset:24704
v_fma_f32 v102,v102,s36,v16
v_mfma_f32_16x16x32_bf16 v[164:167],a[124:127],v[20:23],v[164:167]
ds_read_b64_tr_b16 a[138:139],v2 offset:30848
v_fma_f32 v98,v98,s36,v16
v_mfma_f32_16x16x32_bf16 v[212:215],a[124:127],v[24:27],v[212:215]
ds_read_b64_tr_b16 a[140:141],v3 offset:24704
v_fma_f32 v76,v76,s36,v13
v_mfma_f32_16x16x32_bf16 v[208:211],a[120:123],v[24:27],v[208:211]
ds_read_b64_tr_b16 a[142:143],v3 offset:30848
v_fma_f32 v91,v91,s36,v15
v_mfma_f32_16x16x32_bf16 v[112:115],a[120:123],v[28:31],v[112:115]
ds_read_b64_tr_b16 a[144:145],v4 offset:24704
v_fma_f32 v95,v95,s36,v15
v_mfma_f32_16x16x32_bf16 v[116:119],a[124:127],v[28:31],v[116:119]
ds_read_b64_tr_b16 a[146:147],v4 offset:30848
v_fma_f32 v85,v85,s36,v14
v_mfma_f32_16x16x32_bf16 a[164:167],a[124:127],v[32:35],a[164:167]
ds_read_b64_tr_b16 a[148:149],v5 offset:24704
v_exp_f32 v76,v76
v_mfma_f32_16x16x32_bf16 a[160:163],a[120:123],v[32:35],a[160:163]
s_waitcnt lgkmcnt(6)
ds_read_b64_tr_b16 a[150:151],v5 offset:30848
v_fma_f32 v103,v103,s36,v16
v_mfma_f32_16x16x32_bf16 a[168:171],a[128:131],v[32:35],a[168:171]
ds_read_b64_tr_b16 a[120:121],v2 offset:24832
v_fma_f32 v79,v79,s36,v13
v_mfma_f32_16x16x32_bf16 a[172:175],a[132:135],v[32:35],a[172:175]
ds_read_b64_tr_b16 a[122:123],v2 offset:30976
v_fma_f32 v96,v96,s36,v16
v_mfma_f32_16x16x32_bf16 v[124:127],a[132:135],v[28:31],v[124:127]
ds_read_b64_tr_b16 a[124:125],v3 offset:24832
v_exp_f32 v102,v102
v_mfma_f32_16x16x32_bf16 v[120:123],a[128:131],v[28:31],v[120:123]
ds_read_b64_tr_b16 a[126:127],v3 offset:30976
v_fma_f32 v89,v89,s36,v15
v_mfma_f32_16x16x32_bf16 v[216:219],a[128:131],v[24:27],v[216:219]
v_fma_f32 v86,v86,s36,v14
v_fma_f32 v100,v100,s36,v16
v_mfma_f32_16x16x32_bf16 v[220:223],a[132:135],v[24:27],v[220:223]
v_exp_f32 v100,v100
v_mfma_f32_16x16x32_bf16 v[172:175],a[132:135],v[20:23],v[172:175]
ds_read_b64_tr_b16 a[132:133],v5 offset:24832
v_fma_f32 v84,v84,s36,v14
v_mfma_f32_16x16x32_bf16 v[168:171],a[128:131],v[20:23],v[168:171]
s_waitcnt lgkmcnt(4)
ds_read_b64_tr_b16 a[128:129],v4 offset:24832
v_exp_f32 v98,v98
v_mfma_f32_16x16x32_bf16 v[176:179],a[136:139],v[20:23],v[176:179]
ds_read_b64_tr_b16 a[130:131],v4 offset:30976
v_exp_f32 v79,v79
v_mfma_f32_16x16x32_bf16 v[180:183],a[140:143],v[20:23],v[180:183]
ds_read_b64_tr_b16 a[134:135],v5 offset:30976
v_exp_f32 v89,v89
v_mfma_f32_16x16x32_bf16 v[228:231],a[140:143],v[24:27],v[228:231]
v_fma_f32 v82,v82,s36,v14
v_exp_f32 v82,v82
v_mfma_f32_16x16x32_bf16 v[224:227],a[136:139],v[24:27],v[224:227]
v_fma_f32 v77,v77,s36,v13
v_exp_f32 v77,v77
v_mfma_f32_16x16x32_bf16 v[128:131],a[136:139],v[28:31],v[128:131]
v_fma_f32 v87,v87,s36,v14
v_exp_f32 v87,v87
v_mfma_f32_16x16x32_bf16 v[132:135],a[140:143],v[28:31],v[132:135]
v_exp_f32 v96,v96
v_mfma_f32_16x16x32_bf16 a[180:183],a[140:143],v[32:35],a[180:183]
v_fma_f32 v78,v78,s36,v13
v_fma_f32 v83,v83,s36,v14
v_mfma_f32_16x16x32_bf16 a[176:179],a[136:139],v[32:35],a[176:179]
v_fma_f32 v92,v92,s36,v15
v_exp_f32 v92,v92
v_mfma_f32_16x16x32_bf16 a[184:187],a[144:147],v[32:35],a[184:187]
v_fma_f32 v90,v90,s36,v15
v_exp_f32 v90,v90
v_mfma_f32_16x16x32_bf16 a[188:191],a[148:151],v[32:35],a[188:191]
v_fma_f32 v101,v101,s36,v16
v_exp_f32 v101,v101
v_mfma_f32_16x16x32_bf16 v[140:143],a[148:151],v[28:31],v[140:143]
v_fma_f32 v99,v99,s36,v16
v_exp_f32 v99,v99
v_mfma_f32_16x16x32_bf16 v[136:139],a[144:147],v[28:31],v[136:139]
v_exp_f32 v84,v84
v_mfma_f32_16x16x32_bf16 v[232:235],a[144:147],v[24:27],v[232:235]
v_fma_f32 v94,v94,s36,v15
v_fma_f32 v88,v88,s36,v15
v_mfma_f32_16x16x32_bf16 v[236:239],a[148:151],v[24:27],v[236:239]
v_fma_f32 v97,v97,s36,v16
v_exp_f32 v97,v97
v_mfma_f32_16x16x32_bf16 v[188:191],a[148:151],v[20:23],v[188:191]
v_fma_f32 v93,v93,s36,v15
v_exp_f32 v93,v93
v_mfma_f32_16x16x32_bf16 v[184:187],a[144:147],v[20:23],v[184:187]
s_waitcnt lgkmcnt(0)
v_exp_f32 v94,v94
v_mfma_f32_16x16x32_bf16 v[192:195],a[120:123],v[20:23],v[192:195]
v_exp_f32 v83,v83
v_mfma_f32_16x16x32_bf16 v[196:199],a[124:127],v[20:23],v[196:199]
v_exp_f32 v103,v103
v_mfma_f32_16x16x32_bf16 v[244:247],a[124:127],v[24:27],v[244:247]
v_exp_f32 v78,v78
v_mfma_f32_16x16x32_bf16 v[240:243],a[120:123],v[24:27],v[240:243]
v_exp_f32 v95,v95
v_mfma_f32_16x16x32_bf16 v[144:147],a[120:123],v[28:31],v[144:147]
v_cvt_pk_bf16_f32 v55,v94,v95
s_waitcnt vmcnt(12)
s_barrier
v_mfma_f32_16x16x32_bf16 v[148:151],a[124:127],v[28:31],v[148:151]
v_exp_f32 v91,v91
v_mfma_f32_16x16x32_bf16 a[196:199],a[124:127],v[32:35],a[196:199]
v_exp_f32 v85,v85
v_mfma_f32_16x16x32_bf16 a[192:195],a[120:123],v[32:35],a[192:195]
v_exp_f32 v88,v88
v_mfma_f32_16x16x32_bf16 a[200:203],a[128:131],v[32:35],a[200:203]
v_cvt_pk_bf16_f32 v52,v88,v89
v_exp_f32 v86,v86
v_mfma_f32_16x16x32_bf16 a[204:207],a[132:135],v[32:35],a[204:207]
v_cvt_pk_bf16_f32 v46,v76,v77
v_cvt_pk_bf16_f32 v49,v82,v83
v_mfma_f32_16x16x32_bf16 v[156:159],a[132:135],v[28:31],v[156:159]
v_cvt_pk_bf16_f32 v57,v98,v99
v_cvt_pk_bf16_f32 v47,v78,v79
v_mfma_f32_16x16x32_bf16 v[152:155],a[128:131],v[28:31],v[152:155]
v_cvt_pk_bf16_f32 v58,v100,v101
v_cvt_pk_bf16_f32 v59,v102,v103
v_mfma_f32_16x16x32_bf16 v[248:251],a[128:131],v[24:27],v[248:251]
v_cvt_pk_bf16_f32 v54,v92,v93
v_cvt_pk_bf16_f32 v50,v84,v85
v_mfma_f32_16x16x32_bf16 v[252:255],a[132:135],v[24:27],v[252:255]
v_cvt_pk_bf16_f32 v53,v90,v91
v_cvt_pk_bf16_f32 v51,v86,v87
v_mfma_f32_16x16x32_bf16 v[204:207],a[132:135],v[20:23],v[204:207]
v_cvt_pk_bf16_f32 v56,v96,v97
v_subrev_u32 v10,18432,v10
v_smfmac_f32_16x16x64_bf16 v[60:63],a[152:155],v[44:51],v18
ds_read_b64_tr_b16 a[138:139],v2 offset:6144
v_smfmac_f32_16x16x64_bf16 v[64:67],a[152:155],v[52:59],v18
ds_read_b64_tr_b16 a[136:137],v2 offset:0
v_mfma_f32_16x16x32_bf16 v[200:203],a[128:131],v[20:23],v[200:203]
ds_read_b64_tr_b16 a[142:143],v3 offset:6144
ds_read_b64_tr_b16 a[140:141],v3 offset:0
ds_read_b64_tr_b16 a[146:147],v4 offset:6144
ds_read_b64_tr_b16 a[144:145],v4 offset:0
ds_read_b64_tr_b16 a[150:151],v5 offset:6144
ds_read_b64_tr_b16 a[148:149],v5 offset:0
s_waitcnt lgkmcnt(6)
v_mfma_f32_16x16x32_bf16 v[160:163],a[136:139],v[44:47],v[160:163]
s_waitcnt vmcnt(6)
ds_read_b64_tr_b16 a[120:121],v2 offset:128
v_mbcnt_lo_u32_b32 v35,-1,0
s_waitcnt lgkmcnt(5)
v_mfma_f32_16x16x32_bf16 v[164:167],a[140:143],v[44:47],v[164:167]
s_add_u32 s84,s42,0
ds_read_b64_tr_b16 a[122:123],v2 offset:6272
v_mbcnt_hi_u32_b32 v35,-1,v35
v_mfma_f32_16x16x32_bf16 v[212:215],a[140:143],v[48:51],v[212:215]
s_add_u32 s85,s42,6144
ds_read_b64_tr_b16 a[124:125],v3 offset:128
v_and_b32 v34,7,v35
v_mfma_f32_16x16x32_bf16 v[208:211],a[136:139],v[48:51],v[208:211]
s_add_u32 s86,s42,12288
ds_read_b64_tr_b16 a[126:127],v3 offset:6272
v_lshrrev_b32 v19,5,v35
v_mfma_f32_16x16x32_bf16 v[112:115],a[136:139],v[52:55],v[112:115]
s_add_u32 s87,s42,18432
ds_read_b64_tr_b16 a[128:129],v4 offset:128
v_xor_b32 v34,v34,v19
v_mfma_f32_16x16x32_bf16 v[116:119],a[140:143],v[52:55],v[116:119]
ds_read_b64_tr_b16 a[130:131],v4 offset:6272
ds_read_b64_tr_b16 a[132:133],v5 offset:128
ds_read_b64_tr_b16 a[134:135],v5 offset:6272
v_mfma_f32_16x16x32_bf16 a[164:167],a[140:143],v[56:59],a[164:167]
ds_read_b64_tr_b16 a[140:141],v3 offset:256
v_and_b32 v19,15,v35
v_mfma_f32_16x16x32_bf16 a[160:163],a[136:139],v[56:59],a[160:163]
s_waitcnt lgkmcnt(8)
ds_read_b64_tr_b16 a[136:137],v2 offset:256
v_lshl_add_u32 v19,v19,7,s24
v_mfma_f32_16x16x32_bf16 a[168:171],a[144:147],v[56:59],a[168:171]
ds_read_b64_tr_b16 a[138:139],v2 offset:6400
v_lshl_add_u32 v19,v34,4,v19
v_mfma_f32_16x16x32_bf16 a[172:175],a[148:151],v[56:59],a[172:175]
ds_read_b64_tr_b16 a[142:143],v3 offset:6400
v_bfe_u32 v34,v35,4,1
v_mfma_f32_16x16x32_bf16 v[124:127],a[148:151],v[52:55],v[124:127]
v_lshl_add_u32 v32,v34,3,v19
v_bfe_u32 v19,v35,3,1
v_mfma_f32_16x16x32_bf16 v[120:123],a[144:147],v[52:55],v[120:123]
v_lshlrev_b32 v19,11,v19
v_add_u32 v36,v32,v19
v_mfma_f32_16x16x32_bf16 v[216:219],a[144:147],v[48:51],v[216:219]
v_xor_b32 v33,32,v32
v_xor_b32 v34,64,v32
v_mfma_f32_16x16x32_bf16 v[220:223],a[148:151],v[48:51],v[220:223]
v_add_u32 v37,v33,v19
v_xor_b32 v35,96,v32
v_mfma_f32_16x16x32_bf16 v[172:175],a[148:151],v[44:47],v[172:175]
ds_read_b64_tr_b16 a[148:149],v5 offset:256
v_add_u32 v38,v34,v19
v_mfma_f32_16x16x32_bf16 v[168:171],a[144:147],v[44:47],v[168:171]
s_waitcnt lgkmcnt(2)
ds_read_b64_tr_b16 a[144:145],v4 offset:256
v_add_u32 v39,v35,v19
v_mfma_f32_16x16x32_bf16 v[176:179],a[120:123],v[44:47],v[176:179]
ds_read_b64_tr_b16 a[146:147],v4 offset:6400
v_add_f32 v62,v62,v63
v_mfma_f32_16x16x32_bf16 v[180:183],a[124:127],v[44:47],v[180:183]
ds_read_b64_tr_b16 a[150:151],v5 offset:6400
v_rcp_f32 v62,v62
v_mfma_f32_16x16x32_bf16 v[228:231],a[124:127],v[48:51],v[228:231]
v_add_f32 v66,v66,v67
v_rcp_f32 v66,v66
v_mfma_f32_16x16x32_bf16 v[224:227],a[120:123],v[48:51],v[224:227]
v_accvgpr_read_b32 v96,a164
v_accvgpr_read_b32 v97,a165
v_mfma_f32_16x16x32_bf16 v[128:131],a[120:123],v[52:55],v[128:131]
v_accvgpr_read_b32 v98,a166
v_accvgpr_read_b32 v99,a167
v_mfma_f32_16x16x32_bf16 v[132:135],a[124:127],v[52:55],v[132:135]
v_accvgpr_read_b32 v88,a160
v_accvgpr_read_b32 v89,a161
v_mfma_f32_16x16x32_bf16 a[180:183],a[124:127],v[56:59],a[180:183]
v_accvgpr_read_b32 v90,a162
v_accvgpr_read_b32 v91,a163
v_accvgpr_read_b32 v104,a168
v_accvgpr_read_b32 v105,a169
v_accvgpr_read_b32 v106,a170
v_pk_mul_f32 v[208:209],v[208:209],v[62:63] op_sel_hi:[1,0]
v_pk_mul_f32 v[210:211],v[210:211],v[62:63] op_sel_hi:[1,0]
v_pk_mul_f32 v[224:225],v[224:225],v[62:63] op_sel_hi:[1,0]
v_pk_mul_f32 v[226:227],v[226:227],v[62:63] op_sel_hi:[1,0]
v_pk_mul_f32 v[212:213],v[212:213],v[62:63] op_sel_hi:[1,0]
v_pk_mul_f32 v[214:215],v[214:215],v[62:63] op_sel_hi:[1,0]
v_pk_mul_f32 v[228:229],v[228:229],v[62:63] op_sel_hi:[1,0]
v_pk_mul_f32 v[230:231],v[230:231],v[62:63] op_sel_hi:[1,0]
v_cvt_pk_bf16_f32 v208,v208,v209
v_cvt_pk_bf16_f32 v224,v224,v225
v_mfma_f32_16x16x32_bf16 a[176:179],a[120:123],v[56:59],a[176:179]
v_cvt_pk_bf16_f32 v209,v210,v211
v_cvt_pk_bf16_f32 v225,v226,v227
v_mfma_f32_16x16x32_bf16 a[184:187],a[128:131],v[56:59],a[184:187]
ds_write2st64_b64 v36,v[208:209],v[224:225] offset0:12 offset1:14
v_mfma_f32_16x16x32_bf16 a[188:191],a[132:135],v[56:59],a[188:191]
v_accvgpr_read_b32 v107,a171
v_accvgpr_read_b32 v100,a180
v_mfma_f32_16x16x32_bf16 v[140:143],a[132:135],v[52:55],v[140:143]
v_accvgpr_read_b32 v101,a181
v_accvgpr_read_b32 v102,a182
v_mfma_f32_16x16x32_bf16 v[136:139],a[128:131],v[52:55],v[136:139]
v_accvgpr_read_b32 v103,a183
v_accvgpr_read_b32 v92,a176
v_mfma_f32_16x16x32_bf16 v[232:235],a[128:131],v[48:51],v[232:235]
v_accvgpr_read_b32 v93,a177
v_accvgpr_read_b32 v94,a178
v_mfma_f32_16x16x32_bf16 v[236:239],a[132:135],v[48:51],v[236:239]
v_accvgpr_read_b32 v95,a179
v_accvgpr_read_b32 v210,a174
v_mfma_f32_16x16x32_bf16 v[188:191],a[132:135],v[44:47],v[188:191]
v_accvgpr_read_b32 v211,a175
v_accvgpr_read_b32 v108,a184
v_mfma_f32_16x16x32_bf16 v[184:187],a[128:131],v[44:47],v[184:187]
v_accvgpr_read_b32 v109,a185
v_accvgpr_read_b32 v110,a186
v_accvgpr_read_b32 v111,a187
v_accvgpr_read_b32 v208,a172
v_accvgpr_read_b32 v209,a173
v_pk_mul_f32 v[216:217],v[216:217],v[62:63] op_sel_hi:[1,0]
v_pk_mul_f32 v[218:219],v[218:219],v[62:63] op_sel_hi:[1,0]
v_pk_mul_f32 v[232:233],v[232:233],v[62:63] op_sel_hi:[1,0]
v_pk_mul_f32 v[234:235],v[234:235],v[62:63] op_sel_hi:[1,0]
v_accvgpr_read_b32 v224,a188
v_accvgpr_read_b32 v225,a189
v_mfma_f32_16x16x32_bf16 v[192:195],a[136:139],v[44:47],v[192:195]
v_accvgpr_read_b32 v226,a190
v_accvgpr_read_b32 v227,a191
v_add_f32 v64,v64,v65
v_rcp_f32 v64,v64
v_pk_mul_f32 v[220:221],v[220:221],v[62:63] op_sel_hi:[1,0]
v_pk_mul_f32 v[222:223],v[222:223],v[62:63] op_sel_hi:[1,0]
v_pk_mul_f32 v[236:237],v[236:237],v[62:63] op_sel_hi:[1,0]
v_pk_mul_f32 v[238:239],v[238:239],v[62:63] op_sel_hi:[1,0]
v_pk_mul_f32 v[88:89],v[88:89],v[66:67] op_sel_hi:[1,0]
v_pk_mul_f32 v[90:91],v[90:91],v[66:67] op_sel_hi:[1,0]
v_pk_mul_f32 v[92:93],v[92:93],v[66:67] op_sel_hi:[1,0]
v_pk_mul_f32 v[94:95],v[94:95],v[66:67] op_sel_hi:[1,0]
v_pk_mul_f32 v[96:97],v[96:97],v[66:67] op_sel_hi:[1,0]
v_pk_mul_f32 v[98:99],v[98:99],v[66:67] op_sel_hi:[1,0]
v_pk_mul_f32 v[100:101],v[100:101],v[66:67] op_sel_hi:[1,0]
v_pk_mul_f32 v[102:103],v[102:103],v[66:67] op_sel_hi:[1,0]
v_pk_mul_f32 v[104:105],v[104:105],v[66:67] op_sel_hi:[1,0]
v_pk_mul_f32 v[106:107],v[106:107],v[66:67] op_sel_hi:[1,0]
v_pk_mul_f32 v[108:109],v[108:109],v[66:67] op_sel_hi:[1,0]
v_pk_mul_f32 v[110:111],v[110:111],v[66:67] op_sel_hi:[1,0]
v_pk_mul_f32 v[208:209],v[208:209],v[66:67] op_sel_hi:[1,0]
v_pk_mul_f32 v[210:211],v[210:211],v[66:67] op_sel_hi:[1,0]
v_pk_mul_f32 v[224:225],v[224:225],v[66:67] op_sel_hi:[1,0]
v_pk_mul_f32 v[226:227],v[226:227],v[66:67] op_sel_hi:[1,0]
v_cvt_pk_bf16_f32 v212,v212,v213
v_cvt_pk_bf16_f32 v228,v228,v229
s_waitcnt lgkmcnt(0)
v_mfma_f32_16x16x32_bf16 v[196:199],a[140:143],v[44:47],v[196:199]
v_cvt_pk_bf16_f32 v216,v216,v217
v_cvt_pk_bf16_f32 v232,v232,v233
v_mfma_f32_16x16x32_bf16 v[244:247],a[140:143],v[48:51],v[244:247]
v_cvt_pk_bf16_f32 v213,v214,v215
v_cvt_pk_bf16_f32 v229,v230,v231
v_mfma_f32_16x16x32_bf16 v[240:243],a[136:139],v[48:51],v[240:243]
ds_write2st64_b64 v37,v[212:213],v[228:229] offset0:12 offset1:14
v_mfma_f32_16x16x32_bf16 v[144:147],a[136:139],v[52:55],v[144:147]
v_cvt_pk_bf16_f32 v220,v220,v221
v_cvt_pk_bf16_f32 v236,v236,v237
v_mfma_f32_16x16x32_bf16 v[148:151],a[140:143],v[52:55],v[148:151]
v_cvt_pk_bf16_f32 v217,v218,v219
v_cvt_pk_bf16_f32 v233,v234,v235
v_mfma_f32_16x16x32_bf16 a[196:199],a[140:143],v[56:59],a[196:199]
v_cvt_pk_bf16_f32 v221,v222,v223
ds_write2st64_b64 v38,v[216:217],v[232:233] offset0:12 offset1:14
v_pk_mul_f32 v[240:241],v[240:241],v[62:63] op_sel_hi:[1,0]
v_pk_mul_f32 v[242:243],v[242:243],v[62:63] op_sel_hi:[1,0]
v_pk_mul_f32 v[112:113],v[112:113],v[64:65] op_sel_hi:[1,0]
v_pk_mul_f32 v[114:115],v[114:115],v[64:65] op_sel_hi:[1,0]
v_pk_mul_f32 v[244:245],v[244:245],v[62:63] op_sel_hi:[1,0]
v_pk_mul_f32 v[246:247],v[246:247],v[62:63] op_sel_hi:[1,0]
v_pk_mul_f32 v[116:117],v[116:117],v[64:65] op_sel_hi:[1,0]
v_pk_mul_f32 v[118:119],v[118:119],v[64:65] op_sel_hi:[1,0]
v_cvt_pk_bf16_f32 v237,v238,v239
v_cvt_pk_bf16_f32 v88,v88,v89
v_mfma_f32_16x16x32_bf16 a[192:195],a[136:139],v[56:59],a[192:195]
v_cvt_pk_bf16_f32 v92,v92,v93
v_cvt_pk_bf16_f32 v96,v96,v97
v_mfma_f32_16x16x32_bf16 a[200:203],a[144:147],v[56:59],a[200:203]
ds_write2st64_b64 v39,v[220:221],v[236:237] offset0:12 offset1:14
v_mfma_f32_16x16x32_bf16 a[204:207],a[148:151],v[56:59],a[204:207]
v_cvt_pk_bf16_f32 v100,v100,v101
v_cvt_pk_bf16_f32 v89,v90,v91
v_mfma_f32_16x16x32_bf16 v[156:159],a[148:151],v[52:55],v[156:159]
ds_read_b128 v[72:75],v10 offset:6144
v_cvt_pk_bf16_f32 v93,v94,v95
v_mfma_f32_16x16x32_bf16 v[152:155],a[144:147],v[52:55],v[152:155]
ds_read_b128 v[76:79],v10 offset:9216
v_cvt_pk_bf16_f32 v104,v104,v105
v_mfma_f32_16x16x32_bf16 v[248:251],a[144:147],v[48:51],v[248:251]
ds_read_b128 v[80:83],v10 offset:7168
v_cvt_pk_bf16_f32 v108,v108,v109
v_mfma_f32_16x16x32_bf16 v[252:255],a[148:151],v[48:51],v[252:255]
ds_read_b128 v[84:87],v10 offset:10240
v_cvt_pk_bf16_f32 v97,v98,v99
v_mfma_f32_16x16x32_bf16 v[204:207],a[148:151],v[44:47],v[204:207]
ds_write2st64_b64 v32,v[88:89],v[92:93] offset0:36 offset1:40
v_mfma_f32_16x16x32_bf16 v[200:203],a[144:147],v[44:47],v[200:203]
v_cvt_pk_bf16_f32 v101,v102,v103
v_cvt_pk_bf16_f32 v208,v208,v209
v_cvt_pk_bf16_f32 v224,v224,v225
v_cvt_pk_bf16_f32 v105,v106,v107
v_cvt_pk_bf16_f32 v109,v110,v111
s_waitcnt lgkmcnt(4)
buffer_store_dwordx4 v[72:75],v9,s[16:19],s85 offen offset:0 nt
v_pk_mul_f32 v[248:249],v[248:249],v[62:63] op_sel_hi:[1,0]
v_pk_mul_f32 v[120:121],v[120:121],v[64:65] op_sel_hi:[1,0]
v_pk_mul_f32 v[250:251],v[250:251],v[62:63] op_sel_hi:[1,0]
v_pk_mul_f32 v[122:123],v[122:123],v[64:65] op_sel_hi:[1,0]
v_pk_mul_f32 v[252:253],v[252:253],v[62:63] op_sel_hi:[1,0]
v_pk_mul_f32 v[124:125],v[124:125],v[64:65] op_sel_hi:[1,0]
v_pk_mul_f32 v[254:255],v[254:255],v[62:63] op_sel_hi:[1,0]
v_pk_mul_f32 v[126:127],v[126:127],v[64:65] op_sel_hi:[1,0]
v_pk_mul_f32 v[128:129],v[128:129],v[64:65] op_sel_hi:[1,0]
ds_write2st64_b64 v33,v[96:97],v[100:101] offset0:36 offset1:40
v_pk_mul_f32 v[144:145],v[144:145],v[64:65] op_sel_hi:[1,0]
v_pk_mul_f32 v[130:131],v[130:131],v[64:65] op_sel_hi:[1,0]
v_pk_mul_f32 v[146:147],v[146:147],v[64:65] op_sel_hi:[1,0]
s_waitcnt lgkmcnt(1)
buffer_store_dwordx4 v[76:79],v9,s[16:19],s85 offen offset:3072 nt
v_pk_mul_f32 v[132:133],v[132:133],v[64:65] op_sel_hi:[1,0]
v_pk_mul_f32 v[148:149],v[148:149],v[64:65] op_sel_hi:[1,0]
v_pk_mul_f32 v[134:135],v[134:135],v[64:65] op_sel_hi:[1,0]
v_pk_mul_f32 v[150:151],v[150:151],v[64:65] op_sel_hi:[1,0]
v_pk_mul_f32 v[136:137],v[136:137],v[64:65] op_sel_hi:[1,0]
v_pk_mul_f32 v[152:153],v[152:153],v[64:65] op_sel_hi:[1,0]
v_pk_mul_f32 v[138:139],v[138:139],v[64:65] op_sel_hi:[1,0]
v_pk_mul_f32 v[154:155],v[154:155],v[64:65] op_sel_hi:[1,0]
v_pk_mul_f32 v[140:141],v[140:141],v[64:65] op_sel_hi:[1,0]
ds_write2st64_b64 v34,v[104:105],v[108:109] offset0:36 offset1:40
v_pk_mul_f32 v[156:157],v[156:157],v[64:65] op_sel_hi:[1,0]
v_pk_mul_f32 v[142:143],v[142:143],v[64:65] op_sel_hi:[1,0]
v_pk_mul_f32 v[158:159],v[158:159],v[64:65] op_sel_hi:[1,0]
buffer_store_dwordx4 v[80:83],v9,s[16:19],s85 offen offset:128 nt
v_cvt_pk_bf16_f32 v209,v210,v211
v_cvt_pk_bf16_f32 v225,v226,v227
v_cvt_pk_bf16_f32 v240,v240,v241
v_cvt_pk_bf16_f32 v112,v112,v113
v_cvt_pk_bf16_f32 v244,v244,v245
v_cvt_pk_bf16_f32 v116,v116,v117
v_cvt_pk_bf16_f32 v241,v242,v243
v_cvt_pk_bf16_f32 v113,v114,v115
v_cvt_pk_bf16_f32 v248,v248,v249
ds_write2st64_b64 v35,v[208:209],v[224:225] offset0:36 offset1:40
v_cvt_pk_bf16_f32 v120,v120,v121
v_cvt_pk_bf16_f32 v245,v246,v247
v_cvt_pk_bf16_f32 v117,v118,v119
ds_read_b128 v[212:215],v10 offset:18432
buffer_store_dwordx4 v[84:87],v9,s[16:19],s85 offen offset:3200 nt
ds_read_b128 v[228:231],v10 offset:19456
v_cvt_pk_bf16_f32 v252,v252,v253
ds_read_b128 v[216:219],v10 offset:20480
v_cvt_pk_bf16_f32 v124,v124,v125
ds_read_b128 v[232:235],v10 offset:21504
v_cvt_pk_bf16_f32 v249,v250,v251
ds_write2st64_b64 v36,v[240:241],v[112:113] offset0:16 offset1:24
v_cvt_pk_bf16_f32 v121,v122,v123
v_cvt_pk_bf16_f32 v253,v254,v255
v_cvt_pk_bf16_f32 v125,v126,v127
v_accvgpr_read_b32 v72,a192
v_accvgpr_read_b32 v73,a193
v_pk_mul_f32 v[72:73],v[72:73],v[66:67] op_sel_hi:[1,0]
v_accvgpr_read_b32 v74,a194
s_waitcnt lgkmcnt(4)
buffer_store_dwordx4 v[212:215],v9,s[16:19],s87 offen offset:0 nt
v_accvgpr_read_b32 v75,a195
v_pk_mul_f32 v[74:75],v[74:75],v[66:67] op_sel_hi:[1,0]
v_accvgpr_read_b32 v76,a196
v_accvgpr_read_b32 v77,a197
v_pk_mul_f32 v[76:77],v[76:77],v[66:67] op_sel_hi:[1,0]
v_accvgpr_read_b32 v78,a198
v_accvgpr_read_b32 v79,a199
v_pk_mul_f32 v[78:79],v[78:79],v[66:67] op_sel_hi:[1,0]
v_accvgpr_read_b32 v80,a200
ds_write2st64_b64 v37,v[244:245],v[116:117] offset0:16 offset1:24
v_accvgpr_read_b32 v81,a201
v_pk_mul_f32 v[80:81],v[80:81],v[66:67] op_sel_hi:[1,0]
v_cvt_pk_bf16_f32 v72,v72,v73
s_waitcnt lgkmcnt(1)
buffer_store_dwordx4 v[228:231],v9,s[16:19],s87 offen offset:3072 nt
v_accvgpr_read_b32 v82,a202
v_accvgpr_read_b32 v83,a203
v_pk_mul_f32 v[82:83],v[82:83],v[66:67] op_sel_hi:[1,0]
v_accvgpr_read_b32 v84,a204
v_accvgpr_read_b32 v85,a205
v_pk_mul_f32 v[84:85],v[84:85],v[66:67] op_sel_hi:[1,0]
v_cvt_pk_bf16_f32 v76,v76,v77
v_cvt_pk_bf16_f32 v73,v74,v75
v_accvgpr_read_b32 v86,a206
ds_write2st64_b64 v38,v[248:249],v[120:121] offset0:16 offset1:24
v_accvgpr_read_b32 v87,a207
v_pk_mul_f32 v[86:87],v[86:87],v[66:67] op_sel_hi:[1,0]
v_cvt_pk_bf16_f32 v80,v80,v81
buffer_store_dwordx4 v[216:219],v9,s[16:19],s87 offen offset:128 nt
v_cvt_pk_bf16_f32 v77,v78,v79
v_cvt_pk_bf16_f32 v84,v84,v85
v_cvt_pk_bf16_f32 v81,v82,v83
v_cvt_pk_bf16_f32 v85,v86,v87
v_cvt_pk_bf16_f32 v128,v128,v129
v_cvt_pk_bf16_f32 v144,v144,v145
v_cvt_pk_bf16_f32 v132,v132,v133
v_cvt_pk_bf16_f32 v148,v148,v149
v_cvt_pk_bf16_f32 v129,v130,v131
ds_write2st64_b64 v39,v[252:253],v[124:125] offset0:16 offset1:24
v_cvt_pk_bf16_f32 v145,v146,v147
v_cvt_pk_bf16_f32 v136,v136,v137
v_cvt_pk_bf16_f32 v152,v152,v153
ds_read_b128 v[220:223],v10 offset:8192
buffer_store_dwordx4 v[232:235],v9,s[16:19],s87 offen offset:3200 nt
ds_read_b128 v[236:239],v10 offset:11264
v_cvt_pk_bf16_f32 v133,v134,v135
ds_read_b128 v[88:91],v10 offset:12288
v_cvt_pk_bf16_f32 v149,v150,v151
ds_read_b128 v[92:95],v10 offset:15360
v_add_f32 v60,v60,v61
ds_write_b64 v32,v[72:73] offset:18432
v_cvt_pk_bf16_f32 v140,v140,v141
v_cvt_pk_bf16_f32 v156,v156,v157
v_cvt_pk_bf16_f32 v137,v138,v139
v_cvt_pk_bf16_f32 v153,v154,v155
ds_write_b64 v33,v[76:77] offset:18432
s_waitcnt lgkmcnt(5)
buffer_store_dwordx4 v[220:223],v9,s[16:19],s85 offen offset:256 nt
v_rcp_f32 v60,v60
v_cvt_pk_bf16_f32 v141,v142,v143
v_pk_mul_f32 v[160:161],v[160:161],v[60:61] op_sel_hi:[1,0]
v_pk_mul_f32 v[176:177],v[176:177],v[60:61] op_sel_hi:[1,0]
v_pk_mul_f32 v[162:163],v[162:163],v[60:61] op_sel_hi:[1,0]
v_pk_mul_f32 v[178:179],v[178:179],v[60:61] op_sel_hi:[1,0]
v_pk_mul_f32 v[164:165],v[164:165],v[60:61] op_sel_hi:[1,0]
v_pk_mul_f32 v[180:181],v[180:181],v[60:61] op_sel_hi:[1,0]
ds_write_b64 v34,v[80:81] offset:18432
s_waitcnt lgkmcnt(2)
buffer_store_dwordx4 v[236:239],v9,s[16:19],s85 offen offset:3328 nt
v_pk_mul_f32 v[166:167],v[166:167],v[60:61] op_sel_hi:[1,0]
v_pk_mul_f32 v[182:183],v[182:183],v[60:61] op_sel_hi:[1,0]
v_pk_mul_f32 v[168:169],v[168:169],v[60:61] op_sel_hi:[1,0]
v_pk_mul_f32 v[184:185],v[184:185],v[60:61] op_sel_hi:[1,0]
v_pk_mul_f32 v[170:171],v[170:171],v[60:61] op_sel_hi:[1,0]
v_pk_mul_f32 v[186:187],v[186:187],v[60:61] op_sel_hi:[1,0]
v_pk_mul_f32 v[172:173],v[172:173],v[60:61] op_sel_hi:[1,0]
v_pk_mul_f32 v[188:189],v[188:189],v[60:61] op_sel_hi:[1,0]
v_pk_mul_f32 v[174:175],v[174:175],v[60:61] op_sel_hi:[1,0]
ds_write_b64 v35,v[84:85] offset:18432
ds_read_b128 v[96:99],v10 offset:18432
buffer_store_dwordx4 v[88:91],v9,s[16:19],s86 offen offset:0 nt
ds_read_b128 v[100:103],v10 offset:19456
v_pk_mul_f32 v[190:191],v[190:191],v[60:61] op_sel_hi:[1,0]
v_pk_mul_f32 v[192:193],v[192:193],v[60:61] op_sel_hi:[1,0]
v_pk_mul_f32 v[194:195],v[194:195],v[60:61] op_sel_hi:[1,0]
v_pk_mul_f32 v[196:197],v[196:197],v[60:61] op_sel_hi:[1,0]
v_pk_mul_f32 v[198:199],v[198:199],v[60:61] op_sel_hi:[1,0]
v_pk_mul_f32 v[200:201],v[200:201],v[60:61] op_sel_hi:[1,0]
v_pk_mul_f32 v[202:203],v[202:203],v[60:61] op_sel_hi:[1,0]
ds_write2st64_b64 v36,v[128:129],v[144:145] offset0:26 offset1:28
v_pk_mul_f32 v[204:205],v[204:205],v[60:61] op_sel_hi:[1,0]
v_pk_mul_f32 v[206:207],v[206:207],v[60:61] op_sel_hi:[1,0]
v_cvt_pk_bf16_f32 v157,v158,v159
buffer_store_dwordx4 v[92:95],v9,s[16:19],s86 offen offset:3072 nt
v_cvt_pk_bf16_f32 v160,v160,v161
v_cvt_pk_bf16_f32 v176,v176,v177
v_cvt_pk_bf16_f32 v164,v164,v165
v_cvt_pk_bf16_f32 v180,v180,v181
v_cvt_pk_bf16_f32 v161,v162,v163
v_cvt_pk_bf16_f32 v177,v178,v179
v_cvt_pk_bf16_f32 v168,v168,v169
v_cvt_pk_bf16_f32 v184,v184,v185
v_cvt_pk_bf16_f32 v165,v166,v167
ds_write2st64_b64 v37,v[132:133],v[148:149] offset0:26 offset1:28
v_cvt_pk_bf16_f32 v181,v182,v183
v_cvt_pk_bf16_f32 v172,v172,v173
v_cvt_pk_bf16_f32 v188,v188,v189
s_waitcnt lgkmcnt(1)
buffer_store_dwordx4 v[96:99],v9,s[16:19],s87 offen offset:256 nt
v_cvt_pk_bf16_f32 v169,v170,v171
v_cvt_pk_bf16_f32 v185,v186,v187
v_cvt_pk_bf16_f32 v173,v174,v175
v_cvt_pk_bf16_f32 v189,v190,v191
v_cvt_pk_bf16_f32 v192,v192,v193
v_cvt_pk_bf16_f32 v196,v196,v197
v_cvt_pk_bf16_f32 v193,v194,v195
v_cvt_pk_bf16_f32 v200,v200,v201
v_cvt_pk_bf16_f32 v197,v198,v199
ds_write2st64_b64 v38,v[136:137],v[152:153] offset0:26 offset1:28
v_cvt_pk_bf16_f32 v204,v204,v205
v_cvt_pk_bf16_f32 v201,v202,v203
v_cvt_pk_bf16_f32 v205,v206,v207
buffer_store_dwordx4 v[100:103],v9,s[16:19],s87 offen offset:3328 nt
v_min3_f32 v61,v60,v62,v64
v_min_f32 v61,v61,v66
v_cmp_nlt_f32 vcc,s37,v61
ds_write2st64_b64 v39,v[140:141],v[156:157] offset0:26 offset1:28
ds_read_b128 v[104:107],v10 offset:13312
ds_read_b128 v[108:111],v10 offset:16384
ds_read_b128 v[208:211],v10 offset:14336
s_cmp_lg_u64 vcc,0
ds_read_b128 v[224:227],v10 offset:17408
s_cselect_b32 s62,s32,0
ds_write2st64_b64 v36,v[160:161],v[176:177] offset0:0 offset1:2
s_or_b32 s31,s31,s62
s_lshl_b32 s32,s32,1
s_waitcnt lgkmcnt(4)
buffer_store_dwordx4 v[104:107],v9,s[16:19],s86 offen offset:128 nt
ds_write2st64_b64 v37,v[164:165],v[180:181] offset0:0 offset1:2
s_waitcnt lgkmcnt(1)
buffer_store_dwordx4 v[108:111],v9,s[16:19],s86 offen offset:3200 nt
ds_write2st64_b64 v38,v[168:169],v[184:185] offset0:0 offset1:2
buffer_store_dwordx4 v[208:211],v9,s[16:19],s86 offen offset:256 nt
ds_write2st64_b64 v39,v[172:173],v[188:189] offset0:0 offset1:2
ds_read_b128 v[240:243],v10 offset:0
buffer_store_dwordx4 v[224:227],v9,s[16:19],s86 offen offset:3328 nt
ds_read_b128 v[112:115],v10 offset:3072
ds_read_b128 v[212:215],v10 offset:1024
ds_read_b128 v[228:231],v10 offset:4096
ds_write_b64 v36,v[192:193] offset:2048
ds_write_b64 v37,v[196:197] offset:2048
s_waitcnt lgkmcnt(5)
buffer_store_dwordx4 v[240:243],v9,s[16:19],s84 offen offset:0 nt
ds_write_b64 v38,v[200:201] offset:2048
s_waitcnt lgkmcnt(2)
buffer_store_dwordx4 v[112:115],v9,s[16:19],s84 offen offset:3072 nt
ds_write_b64 v39,v[204:205] offset:2048
ds_read_b128 v[216:219],v10 offset:2048
buffer_store_dwordx4 v[212:215],v9,s[16:19],s84 offen offset:128 nt
ds_read_b128 v[232:235],v10 offset:5120
buffer_store_dwordx4 v[228:231],v9,s[16:19],s84 offen offset:3200 nt
s_waitcnt lgkmcnt(1)
buffer_store_dwordx4 v[216:219],v9,s[16:19],s84 offen offset:256 nt
s_waitcnt lgkmcnt(0)
buffer_store_dwordx4 v[232:235],v9,s[16:19],s84 offen offset:3328 nt
s_branch L_fin
L_fin:
s_waitcnt vmcnt(0)
L_stamped:
s_cmp_lg_u32 s31,0
s_cbranch_scc1 L_fix
L_done:
L_end:
s_endpgm
L_fix:
s_sub_u32 s62,s24,36864
v_add_u32 v112,s62,v2
v_add_u32 v113,s62,v3
v_add_u32 v114,s62,v4
v_add_u32 v115,s62,v5
v_mbcnt_lo_u32_b32 v19,-1,0
v_mbcnt_hi_u32_b32 v19,-1,v19
v_and_b32 v81,15,v19
v_mul_u32_u24 v81,384,v81
v_lshrrev_b32 v82,4,v19
v_lshl_add_u32 v83,v82,3,v81
v_lshl_add_u32 v81,v82,4,v81
L_fix_pass:
s_ff1_i32_b32 s50,s31
s_bitset0_b32 s31,s50
s_lshl_b32 s62,s50,5
s_add_u32 s62,s62,s34
s_mul_i32 s63,s62,171
s_lshr_b32 s63,s63,9
s_mul_i32 s64,s63,3
s_sub_u32 s62,s62,s64
s_add_u32 s63,s63,s33
s_mul_i32 s30,s63,196608
s_mul_i32 s41,s63,325632
s_lshl_b32 s63,s3,2
s_add_u32 s64,s63,21
s_cmp_eq_u32 s3,0
s_cselect_b32 s64,20,s64
s_cselect_b32 s40,1,0
s_add_u32 s65,s63,37
s_cmp_eq_u32 s62,2
s_cselect_b32 s64,s65,s64
s_cselect_b32 s40,0,s40
s_add_u32 s65,s63,s3
s_cmp_eq_u32 s62,0
s_cselect_b32 s64,s65,s64
s_cselect_b32 s40,1,s40
s_mul_i32 s64,s64,6144
s_add_u32 s41,s41,s64
s_add_u32 s55,s40,4
s_mov_b32 s51,0
L_fix_tile:
buffer_load_dwordx4 a[0:3],v81,s[12:15],s41 offen offset:0
buffer_load_dwordx4 a[4:7],v81,s[12:15],s41 offen offset:64
buffer_load_dwordx4 a[8:11],v81,s[12:15],s41 offen offset:128
buffer_load_dwordx4 a[12:15],v81,s[12:15],s41 offen offset:192
buffer_load_dwordx4 a[16:19],v81,s[12:15],s41 offen offset:256
buffer_load_dwordx4 a[20:23],v81,s[12:15],s41 offen offset:320
v_mov_b32 v80,0xff800000
s_mov_b32 s53,s30
s_mov_b32 s52,0
L_fix_max:
s_mov_b32 s63,s53
s_add_u32 m0,s24,0
s_nop 0
buffer_load_dwordx4 v6,s[4:7],s63 offen offset:0 lds
buffer_load_dwordx4 v7,s[4:7],s63 offen offset:1024 lds
buffer_load_dwordx4 v8,s[4:7],s63 offen offset:2048 lds
s_add_u32 s63,s63,3072
s_add_u32 m0,s24,3072
s_nop 0
buffer_load_dwordx4 v6,s[4:7],s63 offen offset:0 lds
buffer_load_dwordx4 v7,s[4:7],s63 offen offset:1024 lds
buffer_load_dwordx4 v8,s[4:7],s63 offen offset:2048 lds
s_add_u32 s63,s63,3072
s_add_u32 m0,s24,6144
s_nop 0
buffer_load_dwordx4 v6,s[4:7],s63 offen offset:0 lds
buffer_load_dwordx4 v7,s[4:7],s63 offen offset:1024 lds
buffer_load_dwordx4 v8,s[4:7],s63 offen offset:2048 lds
s_add_u32 s63,s63,3072
s_add_u32 m0,s24,9216
s_nop 0
buffer_load_dwordx4 v6,s[4:7],s63 offen offset:0 lds
buffer_load_dwordx4 v7,s[4:7],s63 offen offset:1024 lds
buffer_load_dwordx4 v8,s[4:7],s63 offen offset:2048 lds
s_add_u32 s63,s63,3072
s_waitcnt vmcnt(0)
ds_read_b128 a[160:163],v11 offset:0
ds_read_b128 a[164:167],v12 offset:0
ds_read_b128 a[168:171],v11 offset:128
ds_read_b128 a[172:175],v12 offset:128
ds_read_b128 a[176:179],v11 offset:256
ds_read_b128 a[180:183],v12 offset:256
ds_read_b128 a[184:187],v11 offset:6144
ds_read_b128 a[188:191],v12 offset:6144
ds_read_b128 a[192:195],v11 offset:6272
ds_read_b128 a[196:199],v12 offset:6272
ds_read_b128 a[200:203],v11 offset:6400
ds_read_b128 a[204:207],v12 offset:6400
s_waitcnt lgkmcnt(0)
v_mfma_f32_16x16x32_bf16 v[72:75],a[160:163],a[0:3],0
v_mfma_f32_16x16x32_bf16 v[72:75],a[164:167],a[4:7],v[72:75]
v_mfma_f32_16x16x32_bf16 v[72:75],a[168:171],a[8:11],v[72:75]
v_mfma_f32_16x16x32_bf16 v[72:75],a[172:175],a[12:15],v[72:75]
v_mfma_f32_16x16x32_bf16 v[72:75],a[176:179],a[16:19],v[72:75]
v_mfma_f32_16x16x32_bf16 v[72:75],a[180:183],a[20:23],v[72:75]
v_mfma_f32_16x16x32_bf16 v[76:79],a[184:187],a[0:3],0
v_mfma_f32_16x16x32_bf16 v[76:79],a[188:191],a[4:7],v[76:79]
v_mfma_f32_16x16x32_bf16 v[76:79],a[192:195],a[8:11],v[76:79]
v_mfma_f32_16x16x32_bf16 v[76:79],a[196:199],a[12:15],v[76:79]
v_mfma_f32_16x16x32_bf16 v[76:79],a[200:203],a[16:19],v[76:79]
v_mfma_f32_16x16x32_bf16 v[76:79],a[204:207],a[20:23],v[76:79]
s_nop 7
v_max3_f32 v80,v80,v72,v73
v_max3_f32 v80,v80,v74,v75
v_max3_f32 v80,v80,v76,v77
v_max3_f32 v80,v80,v78,v79
s_add_u32 s53,s53,12288
s_add_u32 s52,s52,1
s_cmp_lt_u32 s52,16
s_cbranch_scc1 L_fix_max
v_mov_b32 v19,v80
s_nop 1
v_permlane32_swap_b32 v19,v80
v_max_f32 v80,v80,v19
v_mov_b32 v19,v80
s_nop 1
v_permlane16_swap_b32 v19,v80
v_max_f32 v80,v80,v19
v_mul_f32_e64 v13,-s36,v80
v_mov_b32 v160,0
v_mov_b32 v161,0
v_mov_b32 v162,0
v_mov_b32 v163,0
v_mov_b32 v164,0
v_mov_b32 v165,0
v_mov_b32 v166,0
v_mov_b32 v167,0
v_mov_b32 v168,0
v_mov_b32 v169,0
v_mov_b32 v170,0
v_mov_b32 v171,0
v_mov_b32 v172,0
v_mov_b32 v173,0
v_mov_b32 v174,0
v_mov_b32 v175,0
v_mov_b32 v176,0
v_mov_b32 v177,0
v_mov_b32 v178,0
v_mov_b32 v179,0
v_mov_b32 v180,0
v_mov_b32 v181,0
v_mov_b32 v182,0
v_mov_b32 v183,0
v_mov_b32 v184,0
v_mov_b32 v185,0
v_mov_b32 v186,0
v_mov_b32 v187,0
v_mov_b32 v188,0
v_mov_b32 v189,0
v_mov_b32 v190,0
v_mov_b32 v191,0
v_mov_b32 v192,0
v_mov_b32 v193,0
v_mov_b32 v194,0
v_mov_b32 v195,0
v_mov_b32 v196,0
v_mov_b32 v197,0
v_mov_b32 v198,0
v_mov_b32 v199,0
v_mov_b32 v200,0
v_mov_b32 v201,0
v_mov_b32 v202,0
v_mov_b32 v203,0
v_mov_b32 v204,0
v_mov_b32 v205,0
v_mov_b32 v206,0
v_mov_b32 v207,0
v_mov_b32 v60,0
v_mov_b32 v24,0
v_mov_b32 v61,0
v_mov_b32 v25,0
v_mov_b32 v62,0
v_mov_b32 v26,0
v_mov_b32 v63,0
v_mov_b32 v27,0
s_mov_b32 s53,s30
s_mov_b32 s52,0
L_fix_acc:
s_mov_b32 s63,s53
s_add_u32 m0,s24,0
s_nop 0
buffer_load_dwordx4 v6,s[4:7],s63 offen offset:0 lds
buffer_load_dwordx4 v7,s[4:7],s63 offen offset:1024 lds
buffer_load_dwordx4 v8,s[4:7],s63 offen offset:2048 lds
s_add_u32 s63,s63,3072
s_add_u32 m0,s24,3072
s_nop 0
buffer_load_dwordx4 v6,s[4:7],s63 offen offset:0 lds
buffer_load_dwordx4 v7,s[4:7],s63 offen offset:1024 lds
buffer_load_dwordx4 v8,s[4:7],s63 offen offset:2048 lds
s_add_u32 s63,s63,3072
s_add_u32 m0,s24,6144
s_nop 0
buffer_load_dwordx4 v6,s[4:7],s63 offen offset:0 lds
buffer_load_dwordx4 v7,s[4:7],s63 offen offset:1024 lds
buffer_load_dwordx4 v8,s[4:7],s63 offen offset:2048 lds
s_add_u32 s63,s63,3072
s_add_u32 m0,s24,9216
s_nop 0
buffer_load_dwordx4 v6,s[4:7],s63 offen offset:0 lds
buffer_load_dwordx4 v7,s[4:7],s63 offen offset:1024 lds
buffer_load_dwordx4 v8,s[4:7],s63 offen offset:2048 lds
s_add_u32 s63,s63,3072
s_waitcnt vmcnt(0)
ds_read_b128 a[160:163],v11 offset:0
ds_read_b128 a[164:167],v12 offset:0
ds_read_b128 a[168:171],v11 offset:128
ds_read_b128 a[172:175],v12 offset:128
ds_read_b128 a[176:179],v11 offset:256
ds_read_b128 a[180:183],v12 offset:256
ds_read_b128 a[184:187],v11 offset:6144
ds_read_b128 a[188:191],v12 offset:6144
ds_read_b128 a[192:195],v11 offset:6272
ds_read_b128 a[196:199],v12 offset:6272
ds_read_b128 a[200:203],v11 offset:6400
ds_read_b128 a[204:207],v12 offset:6400
s_waitcnt lgkmcnt(0)
v_mfma_f32_16x16x32_bf16 v[72:75],a[160:163],a[0:3],0
v_mfma_f32_16x16x32_bf16 v[72:75],a[164:167],a[4:7],v[72:75]
v_mfma_f32_16x16x32_bf16 v[72:75],a[168:171],a[8:11],v[72:75]
v_mfma_f32_16x16x32_bf16 v[72:75],a[172:175],a[12:15],v[72:75]
v_mfma_f32_16x16x32_bf16 v[72:75],a[176:179],a[16:19],v[72:75]
v_mfma_f32_16x16x32_bf16 v[72:75],a[180:183],a[20:23],v[72:75]
v_mfma_f32_16x16x32_bf16 v[76:79],a[184:187],a[0:3],0
v_mfma_f32_16x16x32_bf16 v[76:79],a[188:191],a[4:7],v[76:79]
v_mfma_f32_16x16x32_bf16 v[76:79],a[192:195],a[8:11],v[76:79]
v_mfma_f32_16x16x32_bf16 v[76:79],a[196:199],a[12:15],v[76:79]
v_mfma_f32_16x16x32_bf16 v[76:79],a[200:203],a[16:19],v[76:79]
v_mfma_f32_16x16x32_bf16 v[76:79],a[204:207],a[20:23],v[76:79]
s_nop 7
v_fma_f32 v72,v72,s36,v13
v_fma_f32 v73,v73,s36,v13
v_exp_f32 v72,v72
v_exp_f32 v73,v73
s_nop 0
v_cvt_pk_bf16_f32 v20,v72,v73
v_fma_f32 v74,v74,s36,v13
v_fma_f32 v75,v75,s36,v13
v_exp_f32 v74,v74
v_exp_f32 v75,v75
s_nop 0
v_cvt_pk_bf16_f32 v21,v74,v75
v_fma_f32 v76,v76,s36,v13
v_fma_f32 v77,v77,s36,v13
v_exp_f32 v76,v76
v_exp_f32 v77,v77
s_nop 0
v_cvt_pk_bf16_f32 v22,v76,v77
v_fma_f32 v78,v78,s36,v13
v_fma_f32 v79,v79,s36,v13
v_exp_f32 v78,v78
v_exp_f32 v79,v79
s_nop 0
v_cvt_pk_bf16_f32 v23,v78,v79
s_nop 1
v_smfmac_f32_16x16x64_bf16 v[60:63],a[152:155],v[20:27],v18
s_mov_b32 s63,s53
s_add_u32 m0,s24,0
s_nop 0
buffer_load_dwordx4 v6,s[8:11],s63 offen offset:0 lds
buffer_load_dwordx4 v7,s[8:11],s63 offen offset:1024 lds
buffer_load_dwordx4 v8,s[8:11],s63 offen offset:2048 lds
s_add_u32 s63,s63,3072
s_add_u32 m0,s24,3072
s_nop 0
buffer_load_dwordx4 v6,s[8:11],s63 offen offset:0 lds
buffer_load_dwordx4 v7,s[8:11],s63 offen offset:1024 lds
buffer_load_dwordx4 v8,s[8:11],s63 offen offset:2048 lds
s_add_u32 s63,s63,3072
s_add_u32 m0,s24,6144
s_nop 0
buffer_load_dwordx4 v6,s[8:11],s63 offen offset:0 lds
buffer_load_dwordx4 v7,s[8:11],s63 offen offset:1024 lds
buffer_load_dwordx4 v8,s[8:11],s63 offen offset:2048 lds
s_add_u32 s63,s63,3072
s_add_u32 m0,s24,9216
s_nop 0
buffer_load_dwordx4 v6,s[8:11],s63 offen offset:0 lds
buffer_load_dwordx4 v7,s[8:11],s63 offen offset:1024 lds
buffer_load_dwordx4 v8,s[8:11],s63 offen offset:2048 lds
s_add_u32 s63,s63,3072
s_waitcnt vmcnt(0)
ds_read_b64_tr_b16 a[160:161],v112 offset:0
ds_read_b64_tr_b16 a[162:163],v112 offset:6144
ds_read_b64_tr_b16 a[164:165],v113 offset:0
ds_read_b64_tr_b16 a[166:167],v113 offset:6144
ds_read_b64_tr_b16 a[168:169],v114 offset:0
ds_read_b64_tr_b16 a[170:171],v114 offset:6144
ds_read_b64_tr_b16 a[172:173],v115 offset:0
ds_read_b64_tr_b16 a[174:175],v115 offset:6144
ds_read_b64_tr_b16 a[176:177],v112 offset:128
ds_read_b64_tr_b16 a[178:179],v112 offset:6272
ds_read_b64_tr_b16 a[180:181],v113 offset:128
ds_read_b64_tr_b16 a[182:183],v113 offset:6272
ds_read_b64_tr_b16 a[184:185],v114 offset:128
ds_read_b64_tr_b16 a[186:187],v114 offset:6272
ds_read_b64_tr_b16 a[188:189],v115 offset:128
ds_read_b64_tr_b16 a[190:191],v115 offset:6272
ds_read_b64_tr_b16 a[192:193],v112 offset:256
ds_read_b64_tr_b16 a[194:195],v112 offset:6400
ds_read_b64_tr_b16 a[196:197],v113 offset:256
ds_read_b64_tr_b16 a[198:199],v113 offset:6400
ds_read_b64_tr_b16 a[200:201],v114 offset:256
ds_read_b64_tr_b16 a[202:203],v114 offset:6400
ds_read_b64_tr_b16 a[204:205],v115 offset:256
ds_read_b64_tr_b16 a[206:207],v115 offset:6400
s_waitcnt lgkmcnt(0)
v_mfma_f32_16x16x32_bf16 v[160:163],a[160:163],v[20:23],v[160:163]
v_mfma_f32_16x16x32_bf16 v[164:167],a[164:167],v[20:23],v[164:167]
v_mfma_f32_16x16x32_bf16 v[168:171],a[168:171],v[20:23],v[168:171]
v_mfma_f32_16x16x32_bf16 v[172:175],a[172:175],v[20:23],v[172:175]
v_mfma_f32_16x16x32_bf16 v[176:179],a[176:179],v[20:23],v[176:179]
v_mfma_f32_16x16x32_bf16 v[180:183],a[180:183],v[20:23],v[180:183]
v_mfma_f32_16x16x32_bf16 v[184:187],a[184:187],v[20:23],v[184:187]
v_mfma_f32_16x16x32_bf16 v[188:191],a[188:191],v[20:23],v[188:191]
v_mfma_f32_16x16x32_bf16 v[192:195],a[192:195],v[20:23],v[192:195]
v_mfma_f32_16x16x32_bf16 v[196:199],a[196:199],v[20:23],v[196:199]
v_mfma_f32_16x16x32_bf16 v[200:203],a[200:203],v[20:23],v[200:203]
v_mfma_f32_16x16x32_bf16 v[204:207],a[204:207],v[20:23],v[204:207]
s_add_u32 s53,s53,12288
s_add_u32 s52,s52,1
s_cmp_lt_u32 s52,16
s_cbranch_scc1 L_fix_acc
s_nop 7
v_add_f32 v19,v60,v61
v_rcp_f32 v19,v19
s_nop 0
v_mul_f32 v160,v160,v19
v_mul_f32 v161,v161,v19
v_mul_f32 v162,v162,v19
v_mul_f32 v163,v163,v19
v_cvt_pk_bf16_f32 v160,v160,v161
v_cvt_pk_bf16_f32 v161,v162,v163
buffer_store_dwordx2 v[160:161],v83,s[16:19],s41 offen offset:0
v_mul_f32 v164,v164,v19
v_mul_f32 v165,v165,v19
v_mul_f32 v166,v166,v19
v_mul_f32 v167,v167,v19
v_cvt_pk_bf16_f32 v164,v164,v165
v_cvt_pk_bf16_f32 v165,v166,v167
buffer_store_dwordx2 v[164:165],v83,s[16:19],s41 offen offset:32
v_mul_f32 v168,v168,v19
v_mul_f32 v169,v169,v19
v_mul_f32 v170,v170,v19
v_mul_f32 v171,v171,v19
v_cvt_pk_bf16_f32 v168,v168,v169
v_cvt_pk_bf16_f32 v169,v170,v171
buffer_store_dwordx2 v[168:169],v83,s[16:19],s41 offen offset:64
v_mul_f32 v172,v172,v19
v_mul_f32 v173,v173,v19
v_mul_f32 v174,v174,v19
v_mul_f32 v175,v175,v19
v_cvt_pk_bf16_f32 v172,v172,v173
v_cvt_pk_bf16_f32 v173,v174,v175
buffer_store_dwordx2 v[172:173],v83,s[16:19],s41 offen offset:96
v_mul_f32 v176,v176,v19
v_mul_f32 v177,v177,v19
v_mul_f32 v178,v178,v19
v_mul_f32 v179,v179,v19
v_cvt_pk_bf16_f32 v176,v176,v177
v_cvt_pk_bf16_f32 v177,v178,v179
buffer_store_dwordx2 v[176:177],v83,s[16:19],s41 offen offset:128
v_mul_f32 v180,v180,v19
v_mul_f32 v181,v181,v19
v_mul_f32 v182,v182,v19
v_mul_f32 v183,v183,v19
v_cvt_pk_bf16_f32 v180,v180,v181
v_cvt_pk_bf16_f32 v181,v182,v183
buffer_store_dwordx2 v[180:181],v83,s[16:19],s41 offen offset:160
v_mul_f32 v184,v184,v19
v_mul_f32 v185,v185,v19
v_mul_f32 v186,v186,v19
v_mul_f32 v187,v187,v19
v_cvt_pk_bf16_f32 v184,v184,v185
v_cvt_pk_bf16_f32 v185,v186,v187
buffer_store_dwordx2 v[184:185],v83,s[16:19],s41 offen offset:192
v_mul_f32 v188,v188,v19
v_mul_f32 v189,v189,v19
v_mul_f32 v190,v190,v19
v_mul_f32 v191,v191,v19
v_cvt_pk_bf16_f32 v188,v188,v189
v_cvt_pk_bf16_f32 v189,v190,v191
buffer_store_dwordx2 v[188:189],v83,s[16:19],s41 offen offset:224
v_mul_f32 v192,v192,v19
v_mul_f32 v193,v193,v19
v_mul_f32 v194,v194,v19
v_mul_f32 v195,v195,v19
v_cvt_pk_bf16_f32 v192,v192,v193
v_cvt_pk_bf16_f32 v193,v194,v195
buffer_store_dwordx2 v[192:193],v83,s[16:19],s41 offen offset:256
v_mul_f32 v196,v196,v19
v_mul_f32 v197,v197,v19
v_mul_f32 v198,v198,v19
v_mul_f32 v199,v199,v19
v_cvt_pk_bf16_f32 v196,v196,v197
v_cvt_pk_bf16_f32 v197,v198,v199
buffer_store_dwordx2 v[196:197],v83,s[16:19],s41 offen offset:288
v_mul_f32 v200,v200,v19
v_mul_f32 v201,v201,v19
v_mul_f32 v202,v202,v19
v_mul_f32 v203,v203,v19
v_cvt_pk_bf16_f32 v200,v200,v201
v_cvt_pk_bf16_f32 v201,v202,v203
buffer_store_dwordx2 v[200:201],v83,s[16:19],s41 offen offset:320
v_mul_f32 v204,v204,v19
v_mul_f32 v205,v205,v19
v_mul_f32 v206,v206,v19
v_mul_f32 v207,v207,v19
v_cvt_pk_bf16_f32 v204,v204,v205
v_cvt_pk_bf16_f32 v205,v206,v207
buffer_store_dwordx2 v[204:205],v83,s[16:19],s41 offen offset:352
s_waitcnt vmcnt(0)
s_add_u32 s41,s41,6144
s_add_u32 s51,s51,1
s_cmp_lt_u32 s51,s55
s_cbranch_scc1 L_fix_tile
s_cmp_lg_u32 s31,0
s_cbranch_scc1 L_fix_pass
s_branch L_done
L_codeend:
.section .rodata,"a"
.p2align 6
.amdhsa_kernel standalone__gqa_softmax__near_ridge_kernel
  .amdhsa_next_free_vgpr 512
  .amdhsa_next_free_sgpr 102
  .amdhsa_accum_offset 256
  .amdhsa_group_segment_fixed_size 0
  .amdhsa_kernarg_size 48
  .amdhsa_user_sgpr_count 2
  .amdhsa_user_sgpr_kernarg_segment_ptr 1
  .amdhsa_system_sgpr_workgroup_id_x 1
.end_amdhsa_kernel
```
